```python
import torch

def _softmax(x, axis=-1):
    return torch.softmax(x, dim=axis)

def _gelu(x):
    return torch.nn.functional.gelu(x, approximate='tanh')

def _silu(x):
    return torch.nn.functional.silu(x)

def _sigmoid(x):
    return torch.sigmoid(x)

def _layernorm(x, axis=-1, eps=1e-05):
    m = x.mean(dim=axis, keepdim=True)
    v = x.var(dim=axis, keepdim=True, unbiased=False)
    return (x - m) / torch.sqrt(v + eps)

def _scatter_add(tgt, idx, src, axis=0):
    return tgt.clone().index_add_(axis, idx, src)

def _segment_sum(src, seg, n):
    out = torch.zeros((n,) + src.shape[1:], dtype=src.dtype)
    return out.index_add_(0, seg, src)

def _pad(x, pw):
    flat = tuple((v for pair in reversed(pw) for v in pair))
    return torch.nn.functional.pad(x, flat)
kernel_name = 'concat_heads__memory_aug_recurrent_mem_tr__spectral_gfnet__prompt'

def setup_inputs():

    _w = lambda a: (lambda t: t.to(torch.bfloat16) if t.is_floating_point() else t)(torch.as_tensor(a))

    def _A_setup():
        B, S, Dm = (1, 2048, 1024)
        H, Dh = (32, 128)
        M, seg = (8, 32)
        seg = min(seg, S)
        S = S // seg * seg
        return {'x': _w((lambda *s: torch.randn(*s, dtype=torch.bfloat16) * 0.05)(B, S, Dm)), 'mem0': _w((lambda *s: torch.randn(*s, dtype=torch.bfloat16) * 0.4)(B, M, Dm)), 'Wq': _w((lambda *s: torch.randn(*s, dtype=torch.bfloat16) * 6.4)(Dm, H, Dh) * Dm ** (-0.5)), 'Wk': _w((lambda *s: torch.randn(*s, dtype=torch.bfloat16) * 6.4)(Dm, H, Dh) * Dm ** (-0.5)), 'Wv': _w((lambda *s: torch.randn(*s, dtype=torch.bfloat16) * 0.4)(Dm, H, Dh) * Dm ** (-0.5)), 'Wo': _w((lambda *s: torch.randn(*s, dtype=torch.bfloat16) * 0.4)(H, Dh, Dm) * (H * Dh) ** (-0.5)), 'seg_len': seg}
    _A_in = _A_setup()

    def _B_setup():
        B, S, D = (1, 2048, 1024)
        Df = D // 2 + 1
        return {'x': _w((lambda *s: torch.randn(*s, dtype=torch.bfloat16) * 0.05)(B, S, D)), 'w_r': _w((lambda *s: torch.randn(*s, dtype=torch.bfloat16) * 3.2)(S, Df) * 0.02), 'w_i': _w((lambda *s: torch.randn(*s, dtype=torch.bfloat16) * 3.2)(S, Df) * 0.02)}
    _B_in = _B_setup()
    return {'A_x': _A_in['x'], 'A_mem0': _A_in['mem0'], 'A_Wq': _A_in['Wq'], 'A_Wk': _A_in['Wk'], 'A_Wv': _A_in['Wv'], 'A_Wo': _A_in['Wo'], 'A_seg_len': _A_in['seg_len'], 'B_x': _B_in['x'], 'B_w_r': _B_in['w_r'], 'B_w_i': _B_in['w_i']}

def reference(A_x, A_mem0, A_Wq, A_Wk, A_Wv, A_Wo, A_seg_len, B_x, B_w_r, B_w_i):

    def _A_ref(x, mem0, Wq, Wk, Wv, Wo, seg_len):
        B, S, Dm = x.shape
        H, Dh = (Wq.shape[1], Wq.shape[2])
        M = mem0.shape[1]
        scale = Dh ** (-0.5)
        n_seg = S // seg_len
        L = M + seg_len
        idx = torch.arange(L)
        mask = (idx[:, None] < M) | (idx[:, None] >= idx[None, :])
        mem = mem0
        outs = []
        for s in range(n_seg):
            xs = x[:, s * seg_len:(s + 1) * seg_len, :].clone()
            h = torch.concatenate([mem, xs], axis=1)
            q = torch.einsum('btd,dhe->bhte', h, Wq)
            k = torch.einsum('btd,dhe->bhte', h, Wk)
            v = torch.einsum('btd,dhe->bhte', h, Wv)
            scores = torch.einsum('bhqe,bhke->bhqk', q, k) * scale
            scores = torch.where(mask[None, None], scores, -1000000000.0)
            p = _softmax(scores, axis=-1)
            o = torch.einsum('bhqk,bhke->bhqe', p, v)
            o = torch.einsum('bhte,hed->btd', o, Wo)
            mem = o[:, :M, :].clone()
            outs.append(o[:, M:, :])
        return torch.concatenate(outs, axis=1)

    def _B_ref(x, w_r, w_i):
        B, S, D = x.shape
        X = (lambda x, axes=(-2, -1): torch.fft.rfft2(x.float(), dim=axes))(x, axes=(-2, -1))
        W = w_r + 1j * w_i
        X = X * W
        y = (lambda x, s, axes=(-2, -1): torch.fft.irfft2(x, s=s, dim=axes).to(torch.bfloat16))(X, (S, D), axes=(-2, -1))
        return y
    a = _A_ref(A_x, A_mem0, A_Wq, A_Wk, A_Wv, A_Wo, A_seg_len)
    b = _B_ref(B_x, B_w_r, B_w_i)
    return torch.concatenate([a, b], axis=-1)
```

```asm
; @launch kernel=mega_kernel grid=(256,1,1) block=(256,1,1) lds=161792
.amdgcn_target "amdgcn-amd-amdhsa--gfx950"
.text
.globl mega_kernel
.p2align 8
.type mega_kernel,@function
mega_kernel:
    s_cmp_ge_u32 s2, 256
    s_cbranch_scc1 mega_kernel_exit
    s_load_dwordx2 s[84:85], s[0:1], 96
    s_load_dwordx2 s[88:89], s[0:1], 88
    s_getreg_b32 s93, hwreg(HW_REG_XCC_ID)
    s_and_b32 s93, s93, 7
    v_lshrrev_b32 v1, 6, v0
    v_mov_b32 v4, 0
    v_readfirstlane_b32 s80, v1
    v_mov_b32 v5, 0
    v_mov_b32 v6, 0
    v_mov_b32 v7, 0
    s_mov_b32 s83, 0
    s_lshl_b32 s101, s2, 2
    s_add_u32 s101, s101, s80
    s_lshl_b32 s101, s101, 8
    s_add_u32 s101, s101, 230686720
    s_waitcnt lgkmcnt(0)
    s_mov_b32 s86, 268435456
    s_mov_b32 s87, 0x00020000
    s_mov_b32 s90, 256
    s_mov_b32 s91, 0x00020000
    s_cmp_lg_u32 s80, 0
    s_cbranch_scc1 mega_kernel_tkd
    v_lshlrev_b32 v1, 15, v0
    s_lshl_b32 s81, s2, 7
    s_add_u32 s81, s81, 71303168
    s_mov_b64 exec, 3
    buffer_store_dword v4, v1, s[84:87], s81 offen sc1
    s_lshl_b32 s81, s93, 3
    s_lshl_b64 s[78:79], 1, s81
    v_mov_b32 v2, s78
    v_mov_b32 v3, s79
    s_mov_b64 exec, 1
    s_waitcnt vmcnt(0)
    buffer_atomic_add_x2 v[2:3], off, s[88:91], 0 sc0
    s_mov_b64 exec, -1
    s_cmp_ge_u32 s93, 2
    s_cbranch_scc1 mega_kernel_nopr
    v_lshlrev_b32 v1, 4, v0
    s_and_b32 s81, s2, 127
    s_lshl_b32 s81, s81, 14
    s_add_u32 s81, s81, 67108864
    s_add_u32 s77, s81, 8192
    buffer_store_dwordx4 v[4:7], v1, s[84:87], s81 offen sc1
    buffer_store_dwordx4 v[4:7], v1, s[84:87], s77 offen sc1
    s_waitcnt vmcnt(0)
    s_memtime s[70:71]
    buffer_store_dwordx4 v[4:7], v1, s[84:87], s81 offen sc1
    s_waitcnt vmcnt(0)
    s_memtime s[72:73]
    buffer_store_dwordx4 v[4:7], v1, s[84:87], s77 offen sc1
    s_waitcnt vmcnt(0)
    s_memtime s[74:75]
    s_waitcnt lgkmcnt(0)
    s_sub_u32 s74, s74, s72
    s_sub_u32 s72, s72, s70
    s_cmp_lt_u32 s74, s72
    s_cselect_b32 s81, 0x10001, 1
    v_mov_b32 v8, s81
    s_mov_b64 exec, 1
    buffer_atomic_add v8, off, s[88:91], 0 offset:12 sc1
    s_mov_b64 exec, -1
mega_kernel_nopr:
mega_kernel_tkw:
    buffer_load_dwordx2 v[6:7], off, s[88:91], 0 sc1
    s_waitcnt vmcnt(0)
    v_sad_u8 v1, v6, 0, 0
    v_sad_u8 v1, v7, 0, v1
    v_cmp_ne_u32 vcc, 256, v1
    s_cbranch_vccnz mega_kernel_tkw
    s_mov_b64 exec, 1
    ds_write_b64 v4, v[2:3]
    ds_write_b64 v4, v[6:7] offset:8
    s_mov_b64 exec, -1
    s_waitcnt lgkmcnt(0)
mega_kernel_tkd:
    s_barrier
    ds_read_b128 v[8:11], v4
    s_waitcnt lgkmcnt(0)
    v_sad_u8 v1, v8, 0, 0
    v_sad_u8 v1, v9, 0, v1
    v_readfirstlane_b32 s78, v8
    v_readfirstlane_b32 s79, v9
    v_readfirstlane_b32 s76, v10
    v_readfirstlane_b32 s77, v11
    v_readfirstlane_b32 s95, v1
    s_barrier
    s_and_b32 s100, s76, 255
    s_bfe_u32 s81, s76, 0x80008
    s_add_u32 s100, s100, s81
    s_lshl_b32 s81, s93, 3
    s_lshr_b64 s[78:79], s[78:79], s81
    s_and_b32 s94, s78, 255
    s_cmp_eq_u32 s76, 0x20202020
    s_cbranch_scc0 mega_kernel_slow
    s_cmp_eq_u32 s77, 0x20202020
    s_cbranch_scc0 mega_kernel_slow
    s_mov_b32 s30, s93
    s_mov_b32 s31, s94
    s_cmp_lt_u32 s93, 2
    s_cbranch_scc1 mega_kernel_recf
    s_sub_u32 s92, s93, 2
    s_lshl_b32 s92, s92, 5
    s_add_u32 s92, s92, s94
    s_branch mega_kernel_bulk
mega_kernel_slow:
    s_lshr_b32 s30, s95, 5
    s_and_b32 s31, s95, 31
    s_cmp_lt_u32 s95, 64
    s_cbranch_scc1 mega_kernel_recs
    s_sub_u32 s92, s95, 64
    s_branch mega_kernel_bulk
mega_kernel_exit:
    s_endpgm
mega_kernel_recf:
    s_load_dwordx2 s[4:5], s[0:1], 96
    s_load_dwordx2 s[12:13], s[0:1], 88
    s_load_dwordx2 s[50:51], s[0:1], 16
    s_load_dwordx2 s[52:53], s[0:1], 24
    s_load_dwordx2 s[54:55], s[0:1], 32
    s_load_dwordx2 s[56:57], s[0:1], 40
    s_load_dwordx2 s[58:59], s[0:1], 8
    v_lshrrev_b32 v3, 6, v0
    v_and_b32 v40, 63, v0
    v_readfirstlane_b32 s20, v3
    v_lshrrev_b32 v41, 4, v40
    v_and_b32 v42, 15, v40
    v_lshlrev_b32 v1, 4, v40
    s_mov_b32 s49, 0
    s_waitcnt lgkmcnt(0)
    s_mov_b32 s6, 268435456
    s_mov_b32 s7, 0x00020000
    s_mov_b32 s14, 256
    s_mov_b32 s15, 0x00020000
    s_mov_b32 s10, 8388608
    s_mov_b32 s11, 0x00020000
    s_mov_b32 s26, 0x00030003
    s_mov_b32 s27, 0x00030003
    s_mov_b32 s28, 0xcccccccc
    s_mov_b32 s29, 0xcccccccc
    s_mov_b32 s32, 0x33333333
    s_mov_b32 s33, 0x33333333
    s_mov_b32 s34, 0x3e0293ee
    v_mov_b32 v48, 0
    v_mov_b32 v49, 0
    v_mov_b32 v50, 0
    v_mov_b32 v51, 0
    v_lshlrev_b32 v52, 4, v0
    s_lshl_b32 s22, s30, 5
    s_add_u32 s22, s22, s31
    s_lshl_b32 s38, s22, 14
    s_xor_b32 s22, s22, 32
    s_lshl_b32 s37, s22, 14
    s_add_u32 s38, s38, 67108864
    s_add_u32 s37, s37, 67108864
    s_lshl_b32 s46, s30, 18
    s_add_u32 s46, s46, 70254592
    s_lshl_b32 s22, s31, 13
    s_add_u32 s47, s46, s22
    s_lshl_b32 s22, s20, 16
    s_add_u32 s46, s46, s22
    s_lshl_b32 s22, s31, 8
    s_add_u32 s46, s46, s22
    s_add_u32 s61, s46, 32768
    s_add_u32 s25, s47, 4096
    s_lshl_b32 s35, s30, 13
    s_add_u32 s35, s35, 69206016
    s_mov_b32 s16, s58
    s_mov_b32 s17, s59
    s_mov_b32 s18, 16384
    s_mov_b32 s19, 0x00020000
    v_lshrrev_b32 v53, 2, v42
    v_lshlrev_b32 v53, 1, v53
    v_and_b32 v54, 1, v42
    v_add_u32 v55, v53, v54
    v_bfe_u32 v53, v0, 3, 1
    v_lshlrev_b32 v53, 11, v53
    v_and_b32 v54, 3, v0
    v_lshl_add_u32 v53, v54, 5, v53
    v_bfe_u32 v54, v0, 4, 3
    v_lshl_add_u32 v53, v54, 2, v53
    v_bfe_u32 v54, v0, 2, 1
    v_lshl_add_u32 v53, v54, 1, v53
    s_lshl_b32 s22, s30, 10
    s_lshr_b32 s23, s31, 2
    s_lshl_b32 s23, s23, 7
    s_add_u32 s22, s22, s23
    s_and_b32 s23, s31, 3
    s_lshl_b32 s23, s23, 12
    s_add_u32 s22, s22, s23
    buffer_load_ushort v56, v53, s[16:19], s22 offen
    s_add_u32 s22, s38, 0
    buffer_store_dwordx4 v[48:51], v52, s[4:7], s22 offen sc1
    s_add_u32 s22, s38, 4096
    buffer_store_dwordx4 v[48:51], v52, s[4:7], s22 offen sc1
    s_add_u32 s22, s38, 8192
    buffer_store_dwordx4 v[48:51], v52, s[4:7], s22 offen sc1
    s_add_u32 s22, s38, 12288
    buffer_store_dwordx4 v[48:51], v52, s[4:7], s22 offen sc1
    s_add_u32 s22, s38, 1048576
    buffer_store_dwordx4 v[48:51], v52, s[4:7], s22 offen sc1
    s_add_u32 s22, s38, 1052672
    buffer_store_dwordx4 v[48:51], v52, s[4:7], s22 offen sc1
    s_add_u32 s22, s38, 1056768
    buffer_store_dwordx4 v[48:51], v52, s[4:7], s22 offen sc1
    s_add_u32 s22, s38, 1060864
    buffer_store_dwordx4 v[48:51], v52, s[4:7], s22 offen sc1
    s_add_u32 s22, s47, 0
    buffer_store_dwordx4 v[48:51], v52, s[4:7], s22 offen
    s_add_u32 s22, s47, 4096
    buffer_store_dwordx4 v[48:51], v52, s[4:7], s22 offen
    s_lshl_b32 s22, s20, 2
    v_xor_b32 v3, s22, v42
    v_lshlrev_b32 v3, 4, v3
    v_lshl_add_u32 v4, v41, 4, s20
    v_lshl_add_u32 v44, v4, 13, v3
    s_lshl_b32 s22, s30, 22
    s_lshl_b32 s23, s31, 8
    s_add_u32 s22, s22, s23
    v_add_u32 v44, s22, v44
    s_lshr_b32 s22, s20, 1
    s_lshl_b32 s22, s22, 5
    s_and_b32 s23, s20, 1
    s_lshl_b32 s23, s23, 2
    s_add_u32 s22, s22, s23
    s_lshl_b32 s23, s31, 7
    s_add_u32 s22, s22, s23
    v_add_u32 v4, s22, v41
    v_lshl_add_u32 v45, v4, 11, v3
    s_lshl_b32 s22, s30, 10
    v_add_u32 v45, s22, v45
    s_lshl_b32 s48, s20, 10
    s_mov_b32 s8, s50
    s_mov_b32 s9, s51
    s_add_u32 m0, s48, 0
    s_mov_b32 s22, 0
    buffer_load_dwordx4 v44, s[8:11], s22 offen lds
    s_add_u32 m0, s48, 4096
    s_mov_b32 s22, 32768
    buffer_load_dwordx4 v44, s[8:11], s22 offen lds
    s_add_u32 m0, s48, 8192
    s_mov_b32 s22, 65536
    buffer_load_dwordx4 v44, s[8:11], s22 offen lds
    s_add_u32 m0, s48, 12288
    s_mov_b32 s22, 98304
    buffer_load_dwordx4 v44, s[8:11], s22 offen lds
    s_add_u32 m0, s48, 16384
    s_mov_b32 s22, 524288
    buffer_load_dwordx4 v44, s[8:11], s22 offen lds
    s_add_u32 m0, s48, 20480
    s_mov_b32 s22, 557056
    buffer_load_dwordx4 v44, s[8:11], s22 offen lds
    s_add_u32 m0, s48, 24576
    s_mov_b32 s22, 589824
    buffer_load_dwordx4 v44, s[8:11], s22 offen lds
    s_add_u32 m0, s48, 28672
    s_mov_b32 s22, 622592
    buffer_load_dwordx4 v44, s[8:11], s22 offen lds
    s_add_u32 m0, s48, 32768
    s_mov_b32 s22, 1048576
    buffer_load_dwordx4 v44, s[8:11], s22 offen lds
    s_add_u32 m0, s48, 36864
    s_mov_b32 s22, 1081344
    buffer_load_dwordx4 v44, s[8:11], s22 offen lds
    s_add_u32 m0, s48, 40960
    s_mov_b32 s22, 1114112
    buffer_load_dwordx4 v44, s[8:11], s22 offen lds
    s_add_u32 m0, s48, 45056
    s_mov_b32 s22, 1146880
    buffer_load_dwordx4 v44, s[8:11], s22 offen lds
    s_add_u32 m0, s48, 49152
    s_mov_b32 s22, 1572864
    buffer_load_dwordx4 v44, s[8:11], s22 offen lds
    s_add_u32 m0, s48, 53248
    s_mov_b32 s22, 1605632
    buffer_load_dwordx4 v44, s[8:11], s22 offen lds
    s_add_u32 m0, s48, 57344
    s_mov_b32 s22, 1638400
    buffer_load_dwordx4 v44, s[8:11], s22 offen lds
    s_add_u32 m0, s48, 61440
    s_mov_b32 s22, 1671168
    buffer_load_dwordx4 v44, s[8:11], s22 offen lds
    s_add_u32 m0, s48, 65536
    s_mov_b32 s22, 2097152
    buffer_load_dwordx4 v44, s[8:11], s22 offen lds
    s_add_u32 m0, s48, 69632
    s_mov_b32 s22, 2129920
    buffer_load_dwordx4 v44, s[8:11], s22 offen lds
    s_add_u32 m0, s48, 73728
    s_mov_b32 s22, 2162688
    buffer_load_dwordx4 v44, s[8:11], s22 offen lds
    s_add_u32 m0, s48, 77824
    s_mov_b32 s22, 2195456
    buffer_load_dwordx4 v44, s[8:11], s22 offen lds
    s_add_u32 m0, s48, 81920
    s_mov_b32 s22, 2621440
    buffer_load_dwordx4 v44, s[8:11], s22 offen lds
    s_add_u32 m0, s48, 86016
    s_mov_b32 s22, 2654208
    buffer_load_dwordx4 v44, s[8:11], s22 offen lds
    s_add_u32 m0, s48, 90112
    s_mov_b32 s22, 2686976
    buffer_load_dwordx4 v44, s[8:11], s22 offen lds
    s_add_u32 m0, s48, 94208
    s_mov_b32 s22, 2719744
    buffer_load_dwordx4 v44, s[8:11], s22 offen lds
    s_add_u32 m0, s48, 98304
    s_mov_b32 s22, 3145728
    buffer_load_dwordx4 v44, s[8:11], s22 offen lds
    s_add_u32 m0, s48, 102400
    s_mov_b32 s22, 3178496
    buffer_load_dwordx4 v44, s[8:11], s22 offen lds
    s_add_u32 m0, s48, 106496
    s_mov_b32 s22, 3211264
    buffer_load_dwordx4 v44, s[8:11], s22 offen lds
    s_add_u32 m0, s48, 110592
    s_mov_b32 s22, 3244032
    buffer_load_dwordx4 v44, s[8:11], s22 offen lds
    s_add_u32 m0, s48, 114688
    s_mov_b32 s22, 3670016
    buffer_load_dwordx4 v44, s[8:11], s22 offen lds
    s_add_u32 m0, s48, 118784
    s_mov_b32 s22, 3702784
    buffer_load_dwordx4 v44, s[8:11], s22 offen lds
    s_add_u32 m0, s48, 122880
    s_mov_b32 s22, 3735552
    buffer_load_dwordx4 v44, s[8:11], s22 offen lds
    s_add_u32 m0, s48, 126976
    s_mov_b32 s22, 3768320
    buffer_load_dwordx4 v44, s[8:11], s22 offen lds
    v_mov_b32 v14, 0
    v_mov_b32 v15, 0
    v_mov_b32 v2, 0x4444
    v_mov_b32 v3, 0xeeee
    v_cndmask_b32 v2, v2, v3, s[28:29]
    s_lshl_b32 s22, s20, 12
    v_add_u32 v32, s22, v1
    v_add_u32 v33, 0x10000, v32
    v_add_u32 v5, 0x10000, v1
    v_add_u32 v6, 131072, v1
    v_and_b32 v3, 3, v42
    v_bfe_u32 v43, v40, 1, 1
    v_lshlrev_b32 v7, 13, v43
    v_and_b32 v43, 1, v40
    v_lshl_add_u32 v7, v43, 7, v7
    s_lshl_b32 s22, s31, 8
    s_add_u32 s23, s22, 71311360
    v_add_u32 v7, s23, v7
    s_cmp_lg_u32 s20, 0
    s_cbranch_scc1 mega_kernel_rf_flk
    s_lshl_b32 s23, s30, 7
    s_add_u32 s22, s22, s23
    s_add_u32 s22, s22, 71327744
    v_bfrev_b32 v7, 1
    v_writelane_b32 v7, s22, 0
mega_kernel_rf_flk:
    v_lshlrev_b32 v11, 3, v40
    v_lshlrev_b32 v10, 8, v55
    v_lshl_add_u32 v10, v41, 4, v10
    v_lshlrev_b32 v8, 13, v41
    v_lshl_add_u32 v8, v42, 4, v8
    v_lshrrev_b32 v9, 1, v41
    v_lshlrev_b32 v9, 5, v9
    v_and_b32 v4, 1, v42
    v_lshl_add_u32 v9, v4, 4, v9
    v_and_b32 v4, 1, v41
    v_lshl_add_u32 v9, v4, 3, v9
    s_lshl_b32 s22, s31, 8
    v_add_u32 v9, s22, v9
    v_lshrrev_b32 v4, 2, v42
    v_lshlrev_b32 v12, 8, v4
    v_lshl_add_u32 v12, v41, 6, v12
    v_lshl_add_u32 v12, v3, 4, v12
    v_lshlrev_b32 v13, 8, v41
    v_lshl_add_u32 v13, v42, 2, v13
    v_cmp_eq_u32 vcc, 0, v3
    v_mov_b32 v28, 0x3f803f80
    v_mov_b32 v29, 0x3f803f80
    v_cndmask_b32 v34, 0, 1, vcc
    v_mov_b32 v30, 0x3f803f80
    v_mov_b32 v31, 0x3f803f80
    v_and_b32 v49, 1, v42
    v_lshlrev_b32 v49, 4, v49
    v_mov_b32 v50, 0x3f80
    v_lshlrev_b32 v50, v49, v50
    v_lshrrev_b32 v51, 2, v42
    v_cmp_eq_u32 vcc, v51, v41
    v_mov_b32 v24, v50
    v_cndmask_b32 v52, 0, v50, s[28:29]
    v_cndmask_b32 v53, 0, v50, s[32:33]
    v_cndmask_b32 v16, 0, v52, vcc
    v_cndmask_b32 v17, 0, v53, vcc
    v_mov_b32 v25, v50
    v_mov_b32 v26, v50
    v_mov_b32 v27, v50
    v_bfe_u32 v60, v40, 3, 1
    v_bfe_u32 v49, v40, 2, 1
    v_and_b32 v50, 1, v41
    v_lshrrev_b32 v51, 1, v41
    v_lshlrev_b32 v52, 3, v60
    v_lshl_add_u32 v52, v50, 2, v52
    v_lshl_add_u32 v53, v51, 4, v52
    v_add_u32 v53, v53, v49
    v_and_b32 v54, 3, v40
    s_lshl_b32 s22, s20, 2
    v_add_u32 v55, s22, v54
    v_xor_b32 v55, v55, v52
    v_lshlrev_b32 v55, 4, v55
    v_lshl_add_u32 v46, v53, 8, v55
    v_lshlrev_b32 v55, 4, v52
    v_lshl_add_u32 v55, v54, 3, v55
    v_lshl_add_u32 v47, v53, 8, v55
    v_mov_b32 v60, -1
    v_lshlrev_b32 v61, 1, v0
    s_waitcnt vmcnt(32)
    v_min_u32 v56, 0xfffe, v56
    s_cmp_ge_u32 s20, 2
    s_cbranch_scc1 mega_kernel_rf_nomi
    s_lshl_b32 s23, s31, 8
    s_add_u32 s22, s35, s23
    s_add_u32 s23, s22, 16384
    buffer_store_short v60, v61, s[4:7], s23 offen
    buffer_store_short v56, v61, s[4:7], s22 offen
mega_kernel_rf_nomi:
    s_waitcnt vmcnt(28)
    s_barrier
    v_add_u32 v48, 0, v46
    ds_read_b64_tr_b16 a[0:1], v48 offset:0
    ds_read_b64_tr_b16 a[2:3], v48 offset:512
    ds_read_b64_tr_b16 a[4:5], v48 offset:8192
    ds_read_b64_tr_b16 a[6:7], v48 offset:8704
    ds_read_b64_tr_b16 a[8:9], v48 offset:8
    ds_read_b64_tr_b16 a[10:11], v48 offset:520
    ds_read_b64_tr_b16 a[12:13], v48 offset:8200
    ds_read_b64_tr_b16 a[14:15], v48 offset:8712
    s_waitcnt lgkmcnt(0)
    s_barrier
    s_mov_b32 s8, s52
    s_mov_b32 s9, s53
    s_add_u32 m0, s48, 0
    s_mov_b32 s22, 0
    buffer_load_dwordx4 v44, s[8:11], s22 offen lds
    s_add_u32 m0, s48, 4096
    s_mov_b32 s22, 32768
    buffer_load_dwordx4 v44, s[8:11], s22 offen lds
    s_add_u32 m0, s48, 8192
    s_mov_b32 s22, 65536
    buffer_load_dwordx4 v44, s[8:11], s22 offen lds
    s_add_u32 m0, s48, 12288
    s_mov_b32 s22, 98304
    buffer_load_dwordx4 v44, s[8:11], s22 offen lds
    s_waitcnt vmcnt(28)
    s_barrier
    v_add_u32 v48, 16384, v46
    ds_read_b64_tr_b16 a[16:17], v48 offset:0
    ds_read_b64_tr_b16 a[18:19], v48 offset:512
    ds_read_b64_tr_b16 a[20:21], v48 offset:8192
    ds_read_b64_tr_b16 a[22:23], v48 offset:8704
    ds_read_b64_tr_b16 a[24:25], v48 offset:8
    ds_read_b64_tr_b16 a[26:27], v48 offset:520
    ds_read_b64_tr_b16 a[28:29], v48 offset:8200
    ds_read_b64_tr_b16 a[30:31], v48 offset:8712
    s_waitcnt lgkmcnt(0)
    s_barrier
    s_add_u32 m0, s48, 16384
    s_mov_b32 s22, 524288
    buffer_load_dwordx4 v44, s[8:11], s22 offen lds
    s_add_u32 m0, s48, 20480
    s_mov_b32 s22, 557056
    buffer_load_dwordx4 v44, s[8:11], s22 offen lds
    s_add_u32 m0, s48, 24576
    s_mov_b32 s22, 589824
    buffer_load_dwordx4 v44, s[8:11], s22 offen lds
    s_add_u32 m0, s48, 28672
    s_mov_b32 s22, 622592
    buffer_load_dwordx4 v44, s[8:11], s22 offen lds
    s_waitcnt vmcnt(28)
    s_barrier
    v_add_u32 v48, 32768, v46
    ds_read_b64_tr_b16 a[32:33], v48 offset:0
    ds_read_b64_tr_b16 a[34:35], v48 offset:512
    ds_read_b64_tr_b16 a[36:37], v48 offset:8192
    ds_read_b64_tr_b16 a[38:39], v48 offset:8704
    ds_read_b64_tr_b16 a[40:41], v48 offset:8
    ds_read_b64_tr_b16 a[42:43], v48 offset:520
    ds_read_b64_tr_b16 a[44:45], v48 offset:8200
    ds_read_b64_tr_b16 a[46:47], v48 offset:8712
    s_waitcnt lgkmcnt(0)
    s_barrier
    s_add_u32 m0, s48, 32768
    s_mov_b32 s22, 1048576
    buffer_load_dwordx4 v44, s[8:11], s22 offen lds
    s_add_u32 m0, s48, 36864
    s_mov_b32 s22, 1081344
    buffer_load_dwordx4 v44, s[8:11], s22 offen lds
    s_add_u32 m0, s48, 40960
    s_mov_b32 s22, 1114112
    buffer_load_dwordx4 v44, s[8:11], s22 offen lds
    s_add_u32 m0, s48, 45056
    s_mov_b32 s22, 1146880
    buffer_load_dwordx4 v44, s[8:11], s22 offen lds
    s_waitcnt vmcnt(28)
    s_barrier
    v_add_u32 v48, 49152, v46
    ds_read_b64_tr_b16 a[48:49], v48 offset:0
    ds_read_b64_tr_b16 a[50:51], v48 offset:512
    ds_read_b64_tr_b16 a[52:53], v48 offset:8192
    ds_read_b64_tr_b16 a[54:55], v48 offset:8704
    ds_read_b64_tr_b16 a[56:57], v48 offset:8
    ds_read_b64_tr_b16 a[58:59], v48 offset:520
    ds_read_b64_tr_b16 a[60:61], v48 offset:8200
    ds_read_b64_tr_b16 a[62:63], v48 offset:8712
    s_waitcnt lgkmcnt(0)
    s_barrier
    s_add_u32 m0, s48, 49152
    s_mov_b32 s22, 1572864
    buffer_load_dwordx4 v44, s[8:11], s22 offen lds
    s_add_u32 m0, s48, 53248
    s_mov_b32 s22, 1605632
    buffer_load_dwordx4 v44, s[8:11], s22 offen lds
    s_add_u32 m0, s48, 57344
    s_mov_b32 s22, 1638400
    buffer_load_dwordx4 v44, s[8:11], s22 offen lds
    s_add_u32 m0, s48, 61440
    s_mov_b32 s22, 1671168
    buffer_load_dwordx4 v44, s[8:11], s22 offen lds
    s_waitcnt vmcnt(28)
    s_barrier
    v_add_u32 v48, 65536, v46
    ds_read_b64_tr_b16 a[64:65], v48 offset:0
    ds_read_b64_tr_b16 a[66:67], v48 offset:512
    ds_read_b64_tr_b16 a[68:69], v48 offset:8192
    ds_read_b64_tr_b16 a[70:71], v48 offset:8704
    ds_read_b64_tr_b16 a[72:73], v48 offset:8
    ds_read_b64_tr_b16 a[74:75], v48 offset:520
    ds_read_b64_tr_b16 a[76:77], v48 offset:8200
    ds_read_b64_tr_b16 a[78:79], v48 offset:8712
    s_waitcnt lgkmcnt(0)
    s_barrier
    s_add_u32 m0, s48, 65536
    s_mov_b32 s22, 2097152
    buffer_load_dwordx4 v44, s[8:11], s22 offen lds
    s_add_u32 m0, s48, 69632
    s_mov_b32 s22, 2129920
    buffer_load_dwordx4 v44, s[8:11], s22 offen lds
    s_add_u32 m0, s48, 73728
    s_mov_b32 s22, 2162688
    buffer_load_dwordx4 v44, s[8:11], s22 offen lds
    s_add_u32 m0, s48, 77824
    s_mov_b32 s22, 2195456
    buffer_load_dwordx4 v44, s[8:11], s22 offen lds
    s_waitcnt vmcnt(28)
    s_barrier
    v_add_u32 v48, 81920, v46
    ds_read_b64_tr_b16 a[80:81], v48 offset:0
    ds_read_b64_tr_b16 a[82:83], v48 offset:512
    ds_read_b64_tr_b16 a[84:85], v48 offset:8192
    ds_read_b64_tr_b16 a[86:87], v48 offset:8704
    ds_read_b64_tr_b16 a[88:89], v48 offset:8
    ds_read_b64_tr_b16 a[90:91], v48 offset:520
    ds_read_b64_tr_b16 a[92:93], v48 offset:8200
    ds_read_b64_tr_b16 a[94:95], v48 offset:8712
    s_waitcnt lgkmcnt(0)
    s_barrier
    s_add_u32 m0, s48, 81920
    s_mov_b32 s22, 2621440
    buffer_load_dwordx4 v44, s[8:11], s22 offen lds
    s_add_u32 m0, s48, 86016
    s_mov_b32 s22, 2654208
    buffer_load_dwordx4 v44, s[8:11], s22 offen lds
    s_add_u32 m0, s48, 90112
    s_mov_b32 s22, 2686976
    buffer_load_dwordx4 v44, s[8:11], s22 offen lds
    s_add_u32 m0, s48, 94208
    s_mov_b32 s22, 2719744
    buffer_load_dwordx4 v44, s[8:11], s22 offen lds
    s_waitcnt vmcnt(28)
    s_barrier
    v_add_u32 v48, 98304, v46
    ds_read_b64_tr_b16 a[96:97], v48 offset:0
    ds_read_b64_tr_b16 a[98:99], v48 offset:512
    ds_read_b64_tr_b16 a[100:101], v48 offset:8192
    ds_read_b64_tr_b16 a[102:103], v48 offset:8704
    ds_read_b64_tr_b16 a[104:105], v48 offset:8
    ds_read_b64_tr_b16 a[106:107], v48 offset:520
    ds_read_b64_tr_b16 a[108:109], v48 offset:8200
    ds_read_b64_tr_b16 a[110:111], v48 offset:8712
    s_waitcnt lgkmcnt(0)
    s_barrier
    s_add_u32 m0, s48, 98304
    s_mov_b32 s22, 3145728
    buffer_load_dwordx4 v44, s[8:11], s22 offen lds
    s_add_u32 m0, s48, 102400
    s_mov_b32 s22, 3178496
    buffer_load_dwordx4 v44, s[8:11], s22 offen lds
    s_add_u32 m0, s48, 106496
    s_mov_b32 s22, 3211264
    buffer_load_dwordx4 v44, s[8:11], s22 offen lds
    s_add_u32 m0, s48, 110592
    s_mov_b32 s22, 3244032
    buffer_load_dwordx4 v44, s[8:11], s22 offen lds
    s_waitcnt vmcnt(28)
    s_barrier
    v_add_u32 v48, 114688, v46
    ds_read_b64_tr_b16 a[112:113], v48 offset:0
    ds_read_b64_tr_b16 a[114:115], v48 offset:512
    ds_read_b64_tr_b16 a[116:117], v48 offset:8192
    ds_read_b64_tr_b16 a[118:119], v48 offset:8704
    ds_read_b64_tr_b16 a[120:121], v48 offset:8
    ds_read_b64_tr_b16 a[122:123], v48 offset:520
    ds_read_b64_tr_b16 a[124:125], v48 offset:8200
    ds_read_b64_tr_b16 a[126:127], v48 offset:8712
    s_waitcnt lgkmcnt(0)
    s_barrier
    s_add_u32 m0, s48, 114688
    s_mov_b32 s22, 3670016
    buffer_load_dwordx4 v44, s[8:11], s22 offen lds
    s_add_u32 m0, s48, 118784
    s_mov_b32 s22, 3702784
    buffer_load_dwordx4 v44, s[8:11], s22 offen lds
    s_add_u32 m0, s48, 122880
    s_mov_b32 s22, 3735552
    buffer_load_dwordx4 v44, s[8:11], s22 offen lds
    s_add_u32 m0, s48, 126976
    s_mov_b32 s22, 3768320
    buffer_load_dwordx4 v44, s[8:11], s22 offen lds
    s_waitcnt vmcnt(28)
    s_barrier
    v_add_u32 v48, 0, v46
    ds_read_b64_tr_b16 a[128:129], v48 offset:0
    ds_read_b64_tr_b16 a[130:131], v48 offset:512
    ds_read_b64_tr_b16 a[132:133], v48 offset:8192
    ds_read_b64_tr_b16 a[134:135], v48 offset:8704
    ds_read_b64_tr_b16 a[136:137], v48 offset:8
    ds_read_b64_tr_b16 a[138:139], v48 offset:520
    ds_read_b64_tr_b16 a[140:141], v48 offset:8200
    ds_read_b64_tr_b16 a[142:143], v48 offset:8712
    s_waitcnt lgkmcnt(0)
    s_barrier
    s_mov_b32 s8, s56
    s_mov_b32 s9, s57
    s_add_u32 m0, s48, 0
    s_mov_b32 s22, 0
    buffer_load_dwordx4 v45, s[8:11], s22 offen lds
    s_add_u32 m0, s48, 4096
    s_mov_b32 s22, 16384
    buffer_load_dwordx4 v45, s[8:11], s22 offen lds
    s_add_u32 m0, s48, 8192
    s_mov_b32 s22, 32768
    buffer_load_dwordx4 v45, s[8:11], s22 offen lds
    s_add_u32 m0, s48, 12288
    s_mov_b32 s22, 49152
    buffer_load_dwordx4 v45, s[8:11], s22 offen lds
    s_waitcnt vmcnt(28)
    s_barrier
    s_cmp_lg_u32 s20, 1
    s_cbranch_scc1 mega_kernel_rf_noin
    v_mov_b32 v53, 1
    s_mov_b64 exec, 1
    buffer_atomic_add v53, v14, s[12:15], 0 offen offset:8 sc1
    s_mov_b64 exec, -1
mega_kernel_rf_noin:
    v_add_u32 v48, 16384, v46
    ds_read_b64_tr_b16 a[144:145], v48 offset:0
    ds_read_b64_tr_b16 a[146:147], v48 offset:512
    ds_read_b64_tr_b16 a[148:149], v48 offset:8192
    ds_read_b64_tr_b16 a[150:151], v48 offset:8704
    ds_read_b64_tr_b16 a[152:153], v48 offset:8
    ds_read_b64_tr_b16 a[154:155], v48 offset:520
    ds_read_b64_tr_b16 a[156:157], v48 offset:8200
    ds_read_b64_tr_b16 a[158:159], v48 offset:8712
    s_waitcnt lgkmcnt(0)
    s_barrier
    s_add_u32 m0, s48, 16384
    s_mov_b32 s22, 256
    buffer_load_dwordx4 v45, s[8:11], s22 offen lds
    s_add_u32 m0, s48, 20480
    s_mov_b32 s22, 16640
    buffer_load_dwordx4 v45, s[8:11], s22 offen lds
    s_add_u32 m0, s48, 24576
    s_mov_b32 s22, 33024
    buffer_load_dwordx4 v45, s[8:11], s22 offen lds
    s_add_u32 m0, s48, 28672
    s_mov_b32 s22, 49408
    buffer_load_dwordx4 v45, s[8:11], s22 offen lds
    s_waitcnt vmcnt(28)
    s_barrier
    v_add_u32 v48, 32768, v46
    ds_read_b64_tr_b16 a[160:161], v48 offset:0
    ds_read_b64_tr_b16 a[162:163], v48 offset:512
    ds_read_b64_tr_b16 a[164:165], v48 offset:8192
    ds_read_b64_tr_b16 a[166:167], v48 offset:8704
    ds_read_b64_tr_b16 a[168:169], v48 offset:8
    ds_read_b64_tr_b16 a[170:171], v48 offset:520
    ds_read_b64_tr_b16 a[172:173], v48 offset:8200
    ds_read_b64_tr_b16 a[174:175], v48 offset:8712
    s_waitcnt lgkmcnt(0)
    s_barrier
    s_add_u32 m0, s48, 32768
    s_mov_b32 s22, 512
    buffer_load_dwordx4 v45, s[8:11], s22 offen lds
    s_add_u32 m0, s48, 36864
    s_mov_b32 s22, 16896
    buffer_load_dwordx4 v45, s[8:11], s22 offen lds
    s_add_u32 m0, s48, 40960
    s_mov_b32 s22, 33280
    buffer_load_dwordx4 v45, s[8:11], s22 offen lds
    s_add_u32 m0, s48, 45056
    s_mov_b32 s22, 49664
    buffer_load_dwordx4 v45, s[8:11], s22 offen lds
    s_waitcnt vmcnt(28)
    s_barrier
    v_add_u32 v48, 49152, v46
    ds_read_b64_tr_b16 a[176:177], v48 offset:0
    ds_read_b64_tr_b16 a[178:179], v48 offset:512
    ds_read_b64_tr_b16 a[180:181], v48 offset:8192
    ds_read_b64_tr_b16 a[182:183], v48 offset:8704
    ds_read_b64_tr_b16 a[184:185], v48 offset:8
    ds_read_b64_tr_b16 a[186:187], v48 offset:520
    ds_read_b64_tr_b16 a[188:189], v48 offset:8200
    ds_read_b64_tr_b16 a[190:191], v48 offset:8712
    s_waitcnt lgkmcnt(0)
    s_barrier
    s_add_u32 m0, s48, 49152
    s_mov_b32 s22, 768
    buffer_load_dwordx4 v45, s[8:11], s22 offen lds
    s_add_u32 m0, s48, 53248
    s_mov_b32 s22, 17152
    buffer_load_dwordx4 v45, s[8:11], s22 offen lds
    s_add_u32 m0, s48, 57344
    s_mov_b32 s22, 33536
    buffer_load_dwordx4 v45, s[8:11], s22 offen lds
    s_add_u32 m0, s48, 61440
    s_mov_b32 s22, 49920
    buffer_load_dwordx4 v45, s[8:11], s22 offen lds
    s_waitcnt vmcnt(28)
    s_barrier
    v_add_u32 v48, 65536, v46
    ds_read_b64_tr_b16 a[192:193], v48 offset:0
    ds_read_b64_tr_b16 a[194:195], v48 offset:512
    ds_read_b64_tr_b16 a[196:197], v48 offset:8192
    ds_read_b64_tr_b16 a[198:199], v48 offset:8704
    ds_read_b64_tr_b16 a[200:201], v48 offset:8
    ds_read_b64_tr_b16 a[202:203], v48 offset:520
    ds_read_b64_tr_b16 a[204:205], v48 offset:8200
    ds_read_b64_tr_b16 a[206:207], v48 offset:8712
    s_waitcnt lgkmcnt(0)
    s_barrier
    s_add_u32 m0, s48, 65536
    s_mov_b32 s22, 131072
    buffer_load_dwordx4 v45, s[8:11], s22 offen lds
    s_add_u32 m0, s48, 69632
    s_mov_b32 s22, 147456
    buffer_load_dwordx4 v45, s[8:11], s22 offen lds
    s_add_u32 m0, s48, 73728
    s_mov_b32 s22, 163840
    buffer_load_dwordx4 v45, s[8:11], s22 offen lds
    s_add_u32 m0, s48, 77824
    s_mov_b32 s22, 180224
    buffer_load_dwordx4 v45, s[8:11], s22 offen lds
    s_waitcnt vmcnt(28)
    s_barrier
    v_add_u32 v48, 81920, v46
    ds_read_b64_tr_b16 a[208:209], v48 offset:0
    ds_read_b64_tr_b16 a[210:211], v48 offset:512
    ds_read_b64_tr_b16 a[212:213], v48 offset:8192
    ds_read_b64_tr_b16 a[214:215], v48 offset:8704
    ds_read_b64_tr_b16 a[216:217], v48 offset:8
    ds_read_b64_tr_b16 a[218:219], v48 offset:520
    ds_read_b64_tr_b16 a[220:221], v48 offset:8200
    ds_read_b64_tr_b16 a[222:223], v48 offset:8712
    s_waitcnt lgkmcnt(0)
    s_barrier
    s_add_u32 m0, s48, 81920
    s_mov_b32 s22, 131328
    buffer_load_dwordx4 v45, s[8:11], s22 offen lds
    s_add_u32 m0, s48, 86016
    s_mov_b32 s22, 147712
    buffer_load_dwordx4 v45, s[8:11], s22 offen lds
    s_add_u32 m0, s48, 90112
    s_mov_b32 s22, 164096
    buffer_load_dwordx4 v45, s[8:11], s22 offen lds
    s_add_u32 m0, s48, 94208
    s_mov_b32 s22, 180480
    buffer_load_dwordx4 v45, s[8:11], s22 offen lds
    s_waitcnt vmcnt(28)
    s_barrier
    v_add_u32 v48, 98304, v46
    ds_read_b64_tr_b16 a[224:225], v48 offset:0
    ds_read_b64_tr_b16 a[226:227], v48 offset:512
    ds_read_b64_tr_b16 a[228:229], v48 offset:8192
    ds_read_b64_tr_b16 a[230:231], v48 offset:8704
    ds_read_b64_tr_b16 a[232:233], v48 offset:8
    ds_read_b64_tr_b16 a[234:235], v48 offset:520
    ds_read_b64_tr_b16 a[236:237], v48 offset:8200
    ds_read_b64_tr_b16 a[238:239], v48 offset:8712
    s_waitcnt lgkmcnt(0)
    s_barrier
    s_add_u32 m0, s48, 98304
    s_mov_b32 s22, 131584
    buffer_load_dwordx4 v45, s[8:11], s22 offen lds
    s_add_u32 m0, s48, 102400
    s_mov_b32 s22, 147968
    buffer_load_dwordx4 v45, s[8:11], s22 offen lds
    s_add_u32 m0, s48, 106496
    s_mov_b32 s22, 164352
    buffer_load_dwordx4 v45, s[8:11], s22 offen lds
    s_add_u32 m0, s48, 110592
    s_mov_b32 s22, 180736
    buffer_load_dwordx4 v45, s[8:11], s22 offen lds
    s_waitcnt vmcnt(28)
    s_barrier
    v_add_u32 v48, 114688, v46
    ds_read_b64_tr_b16 a[240:241], v48 offset:0
    ds_read_b64_tr_b16 a[242:243], v48 offset:512
    ds_read_b64_tr_b16 a[244:245], v48 offset:8192
    ds_read_b64_tr_b16 a[246:247], v48 offset:8704
    ds_read_b64_tr_b16 a[248:249], v48 offset:8
    ds_read_b64_tr_b16 a[250:251], v48 offset:520
    ds_read_b64_tr_b16 a[252:253], v48 offset:8200
    ds_read_b64_tr_b16 a[254:255], v48 offset:8712
    s_waitcnt lgkmcnt(0)
    s_barrier
    s_add_u32 m0, s48, 114688
    s_mov_b32 s22, 131840
    buffer_load_dwordx4 v45, s[8:11], s22 offen lds
    s_add_u32 m0, s48, 118784
    s_mov_b32 s22, 148224
    buffer_load_dwordx4 v45, s[8:11], s22 offen lds
    s_add_u32 m0, s48, 122880
    s_mov_b32 s22, 164608
    buffer_load_dwordx4 v45, s[8:11], s22 offen lds
    s_add_u32 m0, s48, 126976
    s_mov_b32 s22, 180992
    buffer_load_dwordx4 v45, s[8:11], s22 offen lds
    s_waitcnt vmcnt(28)
    s_barrier
    s_cmp_lg_u32 s20, 0
    s_cbranch_scc1 mega_kernel_rf_wo0
    v_xor_b32 v48, 0, v47
    v_add_u32 v48, 0, v48
    ds_read_b64_tr_b16 v[128:129], v48 offset:0
    ds_read_b64_tr_b16 v[130:131], v48 offset:512
    ds_read_b64_tr_b16 v[132:133], v48 offset:8192
    ds_read_b64_tr_b16 v[134:135], v48 offset:8704
    ds_read_b64_tr_b16 v[136:137], v48 offset:32
    ds_read_b64_tr_b16 v[138:139], v48 offset:544
    ds_read_b64_tr_b16 v[140:141], v48 offset:8224
    ds_read_b64_tr_b16 v[142:143], v48 offset:8736
    s_waitcnt lgkmcnt(0)
    v_xor_b32 v48, 64, v47
    v_add_u32 v48, 0, v48
    ds_read_b64_tr_b16 v[144:145], v48 offset:0
    ds_read_b64_tr_b16 v[146:147], v48 offset:512
    ds_read_b64_tr_b16 v[148:149], v48 offset:8192
    ds_read_b64_tr_b16 v[150:151], v48 offset:8704
    ds_read_b64_tr_b16 v[152:153], v48 offset:32
    ds_read_b64_tr_b16 v[154:155], v48 offset:544
    ds_read_b64_tr_b16 v[156:157], v48 offset:8224
    ds_read_b64_tr_b16 v[158:159], v48 offset:8736
    s_waitcnt lgkmcnt(0)
    v_xor_b32 v48, 128, v47
    v_add_u32 v48, 0, v48
    ds_read_b64_tr_b16 v[192:193], v48 offset:0
    ds_read_b64_tr_b16 v[194:195], v48 offset:512
    ds_read_b64_tr_b16 v[196:197], v48 offset:8192
    ds_read_b64_tr_b16 v[198:199], v48 offset:8704
    ds_read_b64_tr_b16 v[200:201], v48 offset:32
    ds_read_b64_tr_b16 v[202:203], v48 offset:544
    ds_read_b64_tr_b16 v[204:205], v48 offset:8224
    ds_read_b64_tr_b16 v[206:207], v48 offset:8736
    s_waitcnt lgkmcnt(0)
    v_xor_b32 v48, 192, v47
    v_add_u32 v48, 0, v48
    ds_read_b64_tr_b16 v[80:81], v48 offset:0
    ds_read_b64_tr_b16 v[82:83], v48 offset:512
    ds_read_b64_tr_b16 v[84:85], v48 offset:8192
    ds_read_b64_tr_b16 v[86:87], v48 offset:8704
    ds_read_b64_tr_b16 v[88:89], v48 offset:32
    ds_read_b64_tr_b16 v[90:91], v48 offset:544
    ds_read_b64_tr_b16 v[92:93], v48 offset:8224
    ds_read_b64_tr_b16 v[94:95], v48 offset:8736
    s_waitcnt lgkmcnt(0)
mega_kernel_rf_wo0:
    s_barrier
    s_mov_b32 s8, s54
    s_mov_b32 s9, s55
    s_add_u32 m0, s48, 0
    s_mov_b32 s22, 0
    buffer_load_dwordx4 v44, s[8:11], s22 offen lds
    s_add_u32 m0, s48, 4096
    s_mov_b32 s22, 32768
    buffer_load_dwordx4 v44, s[8:11], s22 offen lds
    s_add_u32 m0, s48, 8192
    s_mov_b32 s22, 65536
    buffer_load_dwordx4 v44, s[8:11], s22 offen lds
    s_add_u32 m0, s48, 12288
    s_mov_b32 s22, 98304
    buffer_load_dwordx4 v44, s[8:11], s22 offen lds
    s_waitcnt vmcnt(28)
    s_barrier
    s_cmp_lg_u32 s20, 1
    s_cbranch_scc1 mega_kernel_rf_wo1
    v_xor_b32 v48, 0, v47
    v_add_u32 v48, 16384, v48
    ds_read_b64_tr_b16 v[128:129], v48 offset:0
    ds_read_b64_tr_b16 v[130:131], v48 offset:512
    ds_read_b64_tr_b16 v[132:133], v48 offset:8192
    ds_read_b64_tr_b16 v[134:135], v48 offset:8704
    ds_read_b64_tr_b16 v[136:137], v48 offset:32
    ds_read_b64_tr_b16 v[138:139], v48 offset:544
    ds_read_b64_tr_b16 v[140:141], v48 offset:8224
    ds_read_b64_tr_b16 v[142:143], v48 offset:8736
    s_waitcnt lgkmcnt(0)
    v_xor_b32 v48, 64, v47
    v_add_u32 v48, 16384, v48
    ds_read_b64_tr_b16 v[144:145], v48 offset:0
    ds_read_b64_tr_b16 v[146:147], v48 offset:512
    ds_read_b64_tr_b16 v[148:149], v48 offset:8192
    ds_read_b64_tr_b16 v[150:151], v48 offset:8704
    ds_read_b64_tr_b16 v[152:153], v48 offset:32
    ds_read_b64_tr_b16 v[154:155], v48 offset:544
    ds_read_b64_tr_b16 v[156:157], v48 offset:8224
    ds_read_b64_tr_b16 v[158:159], v48 offset:8736
    s_waitcnt lgkmcnt(0)
    v_xor_b32 v48, 128, v47
    v_add_u32 v48, 16384, v48
    ds_read_b64_tr_b16 v[192:193], v48 offset:0
    ds_read_b64_tr_b16 v[194:195], v48 offset:512
    ds_read_b64_tr_b16 v[196:197], v48 offset:8192
    ds_read_b64_tr_b16 v[198:199], v48 offset:8704
    ds_read_b64_tr_b16 v[200:201], v48 offset:32
    ds_read_b64_tr_b16 v[202:203], v48 offset:544
    ds_read_b64_tr_b16 v[204:205], v48 offset:8224
    ds_read_b64_tr_b16 v[206:207], v48 offset:8736
    s_waitcnt lgkmcnt(0)
    v_xor_b32 v48, 192, v47
    v_add_u32 v48, 16384, v48
    ds_read_b64_tr_b16 v[80:81], v48 offset:0
    ds_read_b64_tr_b16 v[82:83], v48 offset:512
    ds_read_b64_tr_b16 v[84:85], v48 offset:8192
    ds_read_b64_tr_b16 v[86:87], v48 offset:8704
    ds_read_b64_tr_b16 v[88:89], v48 offset:32
    ds_read_b64_tr_b16 v[90:91], v48 offset:544
    ds_read_b64_tr_b16 v[92:93], v48 offset:8224
    ds_read_b64_tr_b16 v[94:95], v48 offset:8736
    s_waitcnt lgkmcnt(0)
mega_kernel_rf_wo1:
    s_barrier
    s_add_u32 m0, s48, 16384
    s_mov_b32 s22, 524288
    buffer_load_dwordx4 v44, s[8:11], s22 offen lds
    s_add_u32 m0, s48, 20480
    s_mov_b32 s22, 557056
    buffer_load_dwordx4 v44, s[8:11], s22 offen lds
    s_add_u32 m0, s48, 24576
    s_mov_b32 s22, 589824
    buffer_load_dwordx4 v44, s[8:11], s22 offen lds
    s_add_u32 m0, s48, 28672
    s_mov_b32 s22, 622592
    buffer_load_dwordx4 v44, s[8:11], s22 offen lds
    s_waitcnt vmcnt(28)
    s_barrier
    s_cmp_lg_u32 s20, 2
    s_cbranch_scc1 mega_kernel_rf_wo2
    v_xor_b32 v48, 0, v47
    v_add_u32 v48, 32768, v48
    ds_read_b64_tr_b16 v[128:129], v48 offset:0
    ds_read_b64_tr_b16 v[130:131], v48 offset:512
    ds_read_b64_tr_b16 v[132:133], v48 offset:8192
    ds_read_b64_tr_b16 v[134:135], v48 offset:8704
    ds_read_b64_tr_b16 v[136:137], v48 offset:32
    ds_read_b64_tr_b16 v[138:139], v48 offset:544
    ds_read_b64_tr_b16 v[140:141], v48 offset:8224
    ds_read_b64_tr_b16 v[142:143], v48 offset:8736
    s_waitcnt lgkmcnt(0)
    v_xor_b32 v48, 64, v47
    v_add_u32 v48, 32768, v48
    ds_read_b64_tr_b16 v[144:145], v48 offset:0
    ds_read_b64_tr_b16 v[146:147], v48 offset:512
    ds_read_b64_tr_b16 v[148:149], v48 offset:8192
    ds_read_b64_tr_b16 v[150:151], v48 offset:8704
    ds_read_b64_tr_b16 v[152:153], v48 offset:32
    ds_read_b64_tr_b16 v[154:155], v48 offset:544
    ds_read_b64_tr_b16 v[156:157], v48 offset:8224
    ds_read_b64_tr_b16 v[158:159], v48 offset:8736
    s_waitcnt lgkmcnt(0)
    v_xor_b32 v48, 128, v47
    v_add_u32 v48, 32768, v48
    ds_read_b64_tr_b16 v[192:193], v48 offset:0
    ds_read_b64_tr_b16 v[194:195], v48 offset:512
    ds_read_b64_tr_b16 v[196:197], v48 offset:8192
    ds_read_b64_tr_b16 v[198:199], v48 offset:8704
    ds_read_b64_tr_b16 v[200:201], v48 offset:32
    ds_read_b64_tr_b16 v[202:203], v48 offset:544
    ds_read_b64_tr_b16 v[204:205], v48 offset:8224
    ds_read_b64_tr_b16 v[206:207], v48 offset:8736
    s_waitcnt lgkmcnt(0)
    v_xor_b32 v48, 192, v47
    v_add_u32 v48, 32768, v48
    ds_read_b64_tr_b16 v[80:81], v48 offset:0
    ds_read_b64_tr_b16 v[82:83], v48 offset:512
    ds_read_b64_tr_b16 v[84:85], v48 offset:8192
    ds_read_b64_tr_b16 v[86:87], v48 offset:8704
    ds_read_b64_tr_b16 v[88:89], v48 offset:32
    ds_read_b64_tr_b16 v[90:91], v48 offset:544
    ds_read_b64_tr_b16 v[92:93], v48 offset:8224
    ds_read_b64_tr_b16 v[94:95], v48 offset:8736
    s_waitcnt lgkmcnt(0)
mega_kernel_rf_wo2:
    s_barrier
    s_add_u32 m0, s48, 32768
    s_mov_b32 s22, 1048576
    buffer_load_dwordx4 v44, s[8:11], s22 offen lds
    s_add_u32 m0, s48, 36864
    s_mov_b32 s22, 1081344
    buffer_load_dwordx4 v44, s[8:11], s22 offen lds
    s_add_u32 m0, s48, 40960
    s_mov_b32 s22, 1114112
    buffer_load_dwordx4 v44, s[8:11], s22 offen lds
    s_add_u32 m0, s48, 45056
    s_mov_b32 s22, 1146880
    buffer_load_dwordx4 v44, s[8:11], s22 offen lds
    s_waitcnt vmcnt(28)
    s_barrier
    s_cmp_lg_u32 s20, 3
    s_cbranch_scc1 mega_kernel_rf_wo3
    v_xor_b32 v48, 0, v47
    v_add_u32 v48, 49152, v48
    ds_read_b64_tr_b16 v[128:129], v48 offset:0
    ds_read_b64_tr_b16 v[130:131], v48 offset:512
    ds_read_b64_tr_b16 v[132:133], v48 offset:8192
    ds_read_b64_tr_b16 v[134:135], v48 offset:8704
    ds_read_b64_tr_b16 v[136:137], v48 offset:32
    ds_read_b64_tr_b16 v[138:139], v48 offset:544
    ds_read_b64_tr_b16 v[140:141], v48 offset:8224
    ds_read_b64_tr_b16 v[142:143], v48 offset:8736
    s_waitcnt lgkmcnt(0)
    v_xor_b32 v48, 64, v47
    v_add_u32 v48, 49152, v48
    ds_read_b64_tr_b16 v[144:145], v48 offset:0
    ds_read_b64_tr_b16 v[146:147], v48 offset:512
    ds_read_b64_tr_b16 v[148:149], v48 offset:8192
    ds_read_b64_tr_b16 v[150:151], v48 offset:8704
    ds_read_b64_tr_b16 v[152:153], v48 offset:32
    ds_read_b64_tr_b16 v[154:155], v48 offset:544
    ds_read_b64_tr_b16 v[156:157], v48 offset:8224
    ds_read_b64_tr_b16 v[158:159], v48 offset:8736
    s_waitcnt lgkmcnt(0)
    v_xor_b32 v48, 128, v47
    v_add_u32 v48, 49152, v48
    ds_read_b64_tr_b16 v[192:193], v48 offset:0
    ds_read_b64_tr_b16 v[194:195], v48 offset:512
    ds_read_b64_tr_b16 v[196:197], v48 offset:8192
    ds_read_b64_tr_b16 v[198:199], v48 offset:8704
    ds_read_b64_tr_b16 v[200:201], v48 offset:32
    ds_read_b64_tr_b16 v[202:203], v48 offset:544
    ds_read_b64_tr_b16 v[204:205], v48 offset:8224
    ds_read_b64_tr_b16 v[206:207], v48 offset:8736
    s_waitcnt lgkmcnt(0)
    v_xor_b32 v48, 192, v47
    v_add_u32 v48, 49152, v48
    ds_read_b64_tr_b16 v[80:81], v48 offset:0
    ds_read_b64_tr_b16 v[82:83], v48 offset:512
    ds_read_b64_tr_b16 v[84:85], v48 offset:8192
    ds_read_b64_tr_b16 v[86:87], v48 offset:8704
    ds_read_b64_tr_b16 v[88:89], v48 offset:32
    ds_read_b64_tr_b16 v[90:91], v48 offset:544
    ds_read_b64_tr_b16 v[92:93], v48 offset:8224
    ds_read_b64_tr_b16 v[94:95], v48 offset:8736
    s_waitcnt lgkmcnt(0)
mega_kernel_rf_wo3:
    s_barrier
    s_add_u32 m0, s48, 49152
    s_mov_b32 s22, 1572864
    buffer_load_dwordx4 v44, s[8:11], s22 offen lds
    s_add_u32 m0, s48, 53248
    s_mov_b32 s22, 1605632
    buffer_load_dwordx4 v44, s[8:11], s22 offen lds
    s_add_u32 m0, s48, 57344
    s_mov_b32 s22, 1638400
    buffer_load_dwordx4 v44, s[8:11], s22 offen lds
    s_add_u32 m0, s48, 61440
    s_mov_b32 s22, 1671168
    buffer_load_dwordx4 v44, s[8:11], s22 offen lds
    s_waitcnt vmcnt(28)
    s_barrier
    s_cmp_lg_u32 s20, 0
    s_cbranch_scc1 mega_kernel_rf_wo4
    v_xor_b32 v48, 0, v47
    v_add_u32 v48, 65536, v48
    ds_read_b64_tr_b16 v[160:161], v48 offset:0
    ds_read_b64_tr_b16 v[162:163], v48 offset:512
    ds_read_b64_tr_b16 v[164:165], v48 offset:8192
    ds_read_b64_tr_b16 v[166:167], v48 offset:8704
    ds_read_b64_tr_b16 v[168:169], v48 offset:32
    ds_read_b64_tr_b16 v[170:171], v48 offset:544
    ds_read_b64_tr_b16 v[172:173], v48 offset:8224
    ds_read_b64_tr_b16 v[174:175], v48 offset:8736
    s_waitcnt lgkmcnt(0)
    v_xor_b32 v48, 64, v47
    v_add_u32 v48, 65536, v48
    ds_read_b64_tr_b16 v[176:177], v48 offset:0
    ds_read_b64_tr_b16 v[178:179], v48 offset:512
    ds_read_b64_tr_b16 v[180:181], v48 offset:8192
    ds_read_b64_tr_b16 v[182:183], v48 offset:8704
    ds_read_b64_tr_b16 v[184:185], v48 offset:32
    ds_read_b64_tr_b16 v[186:187], v48 offset:544
    ds_read_b64_tr_b16 v[188:189], v48 offset:8224
    ds_read_b64_tr_b16 v[190:191], v48 offset:8736
    s_waitcnt lgkmcnt(0)
    v_xor_b32 v48, 128, v47
    v_add_u32 v48, 65536, v48
    ds_read_b64_tr_b16 v[96:97], v48 offset:0
    ds_read_b64_tr_b16 v[98:99], v48 offset:512
    ds_read_b64_tr_b16 v[100:101], v48 offset:8192
    ds_read_b64_tr_b16 v[102:103], v48 offset:8704
    ds_read_b64_tr_b16 v[104:105], v48 offset:32
    ds_read_b64_tr_b16 v[106:107], v48 offset:544
    ds_read_b64_tr_b16 v[108:109], v48 offset:8224
    ds_read_b64_tr_b16 v[110:111], v48 offset:8736
    s_waitcnt lgkmcnt(0)
    v_xor_b32 v48, 192, v47
    v_add_u32 v48, 65536, v48
    ds_read_b64_tr_b16 v[112:113], v48 offset:0
    ds_read_b64_tr_b16 v[114:115], v48 offset:512
    ds_read_b64_tr_b16 v[116:117], v48 offset:8192
    ds_read_b64_tr_b16 v[118:119], v48 offset:8704
    ds_read_b64_tr_b16 v[120:121], v48 offset:32
    ds_read_b64_tr_b16 v[122:123], v48 offset:544
    ds_read_b64_tr_b16 v[124:125], v48 offset:8224
    ds_read_b64_tr_b16 v[126:127], v48 offset:8736
    s_waitcnt lgkmcnt(0)
mega_kernel_rf_wo4:
    s_barrier
    s_add_u32 m0, s48, 65536
    s_mov_b32 s22, 2097152
    buffer_load_dwordx4 v44, s[8:11], s22 offen lds
    s_add_u32 m0, s48, 69632
    s_mov_b32 s22, 2129920
    buffer_load_dwordx4 v44, s[8:11], s22 offen lds
    s_add_u32 m0, s48, 73728
    s_mov_b32 s22, 2162688
    buffer_load_dwordx4 v44, s[8:11], s22 offen lds
    s_add_u32 m0, s48, 77824
    s_mov_b32 s22, 2195456
    buffer_load_dwordx4 v44, s[8:11], s22 offen lds
    s_waitcnt vmcnt(28)
    s_barrier
    s_cmp_lg_u32 s20, 1
    s_cbranch_scc1 mega_kernel_rf_wo5
    v_xor_b32 v48, 0, v47
    v_add_u32 v48, 81920, v48
    ds_read_b64_tr_b16 v[160:161], v48 offset:0
    ds_read_b64_tr_b16 v[162:163], v48 offset:512
    ds_read_b64_tr_b16 v[164:165], v48 offset:8192
    ds_read_b64_tr_b16 v[166:167], v48 offset:8704
    ds_read_b64_tr_b16 v[168:169], v48 offset:32
    ds_read_b64_tr_b16 v[170:171], v48 offset:544
    ds_read_b64_tr_b16 v[172:173], v48 offset:8224
    ds_read_b64_tr_b16 v[174:175], v48 offset:8736
    s_waitcnt lgkmcnt(0)
    v_xor_b32 v48, 64, v47
    v_add_u32 v48, 81920, v48
    ds_read_b64_tr_b16 v[176:177], v48 offset:0
    ds_read_b64_tr_b16 v[178:179], v48 offset:512
    ds_read_b64_tr_b16 v[180:181], v48 offset:8192
    ds_read_b64_tr_b16 v[182:183], v48 offset:8704
    ds_read_b64_tr_b16 v[184:185], v48 offset:32
    ds_read_b64_tr_b16 v[186:187], v48 offset:544
    ds_read_b64_tr_b16 v[188:189], v48 offset:8224
    ds_read_b64_tr_b16 v[190:191], v48 offset:8736
    s_waitcnt lgkmcnt(0)
    v_xor_b32 v48, 128, v47
    v_add_u32 v48, 81920, v48
    ds_read_b64_tr_b16 v[96:97], v48 offset:0
    ds_read_b64_tr_b16 v[98:99], v48 offset:512
    ds_read_b64_tr_b16 v[100:101], v48 offset:8192
    ds_read_b64_tr_b16 v[102:103], v48 offset:8704
    ds_read_b64_tr_b16 v[104:105], v48 offset:32
    ds_read_b64_tr_b16 v[106:107], v48 offset:544
    ds_read_b64_tr_b16 v[108:109], v48 offset:8224
    ds_read_b64_tr_b16 v[110:111], v48 offset:8736
    s_waitcnt lgkmcnt(0)
    v_xor_b32 v48, 192, v47
    v_add_u32 v48, 81920, v48
    ds_read_b64_tr_b16 v[112:113], v48 offset:0
    ds_read_b64_tr_b16 v[114:115], v48 offset:512
    ds_read_b64_tr_b16 v[116:117], v48 offset:8192
    ds_read_b64_tr_b16 v[118:119], v48 offset:8704
    ds_read_b64_tr_b16 v[120:121], v48 offset:32
    ds_read_b64_tr_b16 v[122:123], v48 offset:544
    ds_read_b64_tr_b16 v[124:125], v48 offset:8224
    ds_read_b64_tr_b16 v[126:127], v48 offset:8736
    s_waitcnt lgkmcnt(0)
mega_kernel_rf_wo5:
    s_barrier
    s_add_u32 m0, s48, 81920
    s_mov_b32 s22, 2621440
    buffer_load_dwordx4 v44, s[8:11], s22 offen lds
    s_add_u32 m0, s48, 86016
    s_mov_b32 s22, 2654208
    buffer_load_dwordx4 v44, s[8:11], s22 offen lds
    s_add_u32 m0, s48, 90112
    s_mov_b32 s22, 2686976
    buffer_load_dwordx4 v44, s[8:11], s22 offen lds
    s_add_u32 m0, s48, 94208
    s_mov_b32 s22, 2719744
    buffer_load_dwordx4 v44, s[8:11], s22 offen lds
    s_waitcnt vmcnt(28)
    s_barrier
    s_cmp_lg_u32 s20, 2
    s_cbranch_scc1 mega_kernel_rf_wo6
    v_xor_b32 v48, 0, v47
    v_add_u32 v48, 98304, v48
    ds_read_b64_tr_b16 v[160:161], v48 offset:0
    ds_read_b64_tr_b16 v[162:163], v48 offset:512
    ds_read_b64_tr_b16 v[164:165], v48 offset:8192
    ds_read_b64_tr_b16 v[166:167], v48 offset:8704
    ds_read_b64_tr_b16 v[168:169], v48 offset:32
    ds_read_b64_tr_b16 v[170:171], v48 offset:544
    ds_read_b64_tr_b16 v[172:173], v48 offset:8224
    ds_read_b64_tr_b16 v[174:175], v48 offset:8736
    s_waitcnt lgkmcnt(0)
    v_xor_b32 v48, 64, v47
    v_add_u32 v48, 98304, v48
    ds_read_b64_tr_b16 v[176:177], v48 offset:0
    ds_read_b64_tr_b16 v[178:179], v48 offset:512
    ds_read_b64_tr_b16 v[180:181], v48 offset:8192
    ds_read_b64_tr_b16 v[182:183], v48 offset:8704
    ds_read_b64_tr_b16 v[184:185], v48 offset:32
    ds_read_b64_tr_b16 v[186:187], v48 offset:544
    ds_read_b64_tr_b16 v[188:189], v48 offset:8224
    ds_read_b64_tr_b16 v[190:191], v48 offset:8736
    s_waitcnt lgkmcnt(0)
    v_xor_b32 v48, 128, v47
    v_add_u32 v48, 98304, v48
    ds_read_b64_tr_b16 v[96:97], v48 offset:0
    ds_read_b64_tr_b16 v[98:99], v48 offset:512
    ds_read_b64_tr_b16 v[100:101], v48 offset:8192
    ds_read_b64_tr_b16 v[102:103], v48 offset:8704
    ds_read_b64_tr_b16 v[104:105], v48 offset:32
    ds_read_b64_tr_b16 v[106:107], v48 offset:544
    ds_read_b64_tr_b16 v[108:109], v48 offset:8224
    ds_read_b64_tr_b16 v[110:111], v48 offset:8736
    s_waitcnt lgkmcnt(0)
    v_xor_b32 v48, 192, v47
    v_add_u32 v48, 98304, v48
    ds_read_b64_tr_b16 v[112:113], v48 offset:0
    ds_read_b64_tr_b16 v[114:115], v48 offset:512
    ds_read_b64_tr_b16 v[116:117], v48 offset:8192
    ds_read_b64_tr_b16 v[118:119], v48 offset:8704
    ds_read_b64_tr_b16 v[120:121], v48 offset:32
    ds_read_b64_tr_b16 v[122:123], v48 offset:544
    ds_read_b64_tr_b16 v[124:125], v48 offset:8224
    ds_read_b64_tr_b16 v[126:127], v48 offset:8736
    s_waitcnt lgkmcnt(0)
mega_kernel_rf_wo6:
    s_barrier
    s_add_u32 m0, s48, 98304
    s_mov_b32 s22, 3145728
    buffer_load_dwordx4 v44, s[8:11], s22 offen lds
    s_add_u32 m0, s48, 102400
    s_mov_b32 s22, 3178496
    buffer_load_dwordx4 v44, s[8:11], s22 offen lds
    s_add_u32 m0, s48, 106496
    s_mov_b32 s22, 3211264
    buffer_load_dwordx4 v44, s[8:11], s22 offen lds
    s_add_u32 m0, s48, 110592
    s_mov_b32 s22, 3244032
    buffer_load_dwordx4 v44, s[8:11], s22 offen lds
    s_waitcnt vmcnt(28)
    s_barrier
    s_cmp_lg_u32 s20, 3
    s_cbranch_scc1 mega_kernel_rf_wo7
    v_xor_b32 v48, 0, v47
    v_add_u32 v48, 114688, v48
    ds_read_b64_tr_b16 v[160:161], v48 offset:0
    ds_read_b64_tr_b16 v[162:163], v48 offset:512
    ds_read_b64_tr_b16 v[164:165], v48 offset:8192
    ds_read_b64_tr_b16 v[166:167], v48 offset:8704
    ds_read_b64_tr_b16 v[168:169], v48 offset:32
    ds_read_b64_tr_b16 v[170:171], v48 offset:544
    ds_read_b64_tr_b16 v[172:173], v48 offset:8224
    ds_read_b64_tr_b16 v[174:175], v48 offset:8736
    s_waitcnt lgkmcnt(0)
    v_xor_b32 v48, 64, v47
    v_add_u32 v48, 114688, v48
    ds_read_b64_tr_b16 v[176:177], v48 offset:0
    ds_read_b64_tr_b16 v[178:179], v48 offset:512
    ds_read_b64_tr_b16 v[180:181], v48 offset:8192
    ds_read_b64_tr_b16 v[182:183], v48 offset:8704
    ds_read_b64_tr_b16 v[184:185], v48 offset:32
    ds_read_b64_tr_b16 v[186:187], v48 offset:544
    ds_read_b64_tr_b16 v[188:189], v48 offset:8224
    ds_read_b64_tr_b16 v[190:191], v48 offset:8736
    s_waitcnt lgkmcnt(0)
    v_xor_b32 v48, 128, v47
    v_add_u32 v48, 114688, v48
    ds_read_b64_tr_b16 v[96:97], v48 offset:0
    ds_read_b64_tr_b16 v[98:99], v48 offset:512
    ds_read_b64_tr_b16 v[100:101], v48 offset:8192
    ds_read_b64_tr_b16 v[102:103], v48 offset:8704
    ds_read_b64_tr_b16 v[104:105], v48 offset:32
    ds_read_b64_tr_b16 v[106:107], v48 offset:544
    ds_read_b64_tr_b16 v[108:109], v48 offset:8224
    ds_read_b64_tr_b16 v[110:111], v48 offset:8736
    s_waitcnt lgkmcnt(0)
    v_xor_b32 v48, 192, v47
    v_add_u32 v48, 114688, v48
    ds_read_b64_tr_b16 v[112:113], v48 offset:0
    ds_read_b64_tr_b16 v[114:115], v48 offset:512
    ds_read_b64_tr_b16 v[116:117], v48 offset:8192
    ds_read_b64_tr_b16 v[118:119], v48 offset:8704
    ds_read_b64_tr_b16 v[120:121], v48 offset:32
    ds_read_b64_tr_b16 v[122:123], v48 offset:544
    ds_read_b64_tr_b16 v[124:125], v48 offset:8224
    ds_read_b64_tr_b16 v[126:127], v48 offset:8736
    s_waitcnt lgkmcnt(0)
mega_kernel_rf_wo7:
    s_barrier
    s_add_u32 m0, s48, 114688
    s_mov_b32 s22, 3670016
    buffer_load_dwordx4 v44, s[8:11], s22 offen lds
    s_add_u32 m0, s48, 118784
    s_mov_b32 s22, 3702784
    buffer_load_dwordx4 v44, s[8:11], s22 offen lds
    s_add_u32 m0, s48, 122880
    s_mov_b32 s22, 3735552
    buffer_load_dwordx4 v44, s[8:11], s22 offen lds
    s_add_u32 m0, s48, 126976
    s_mov_b32 s22, 3768320
    buffer_load_dwordx4 v44, s[8:11], s22 offen lds
    s_waitcnt vmcnt(28)
    s_barrier
    v_add_u32 v48, 0, v46
    ds_read_b64_tr_b16 v[64:65], v48 offset:0
    ds_read_b64_tr_b16 v[66:67], v48 offset:512
    ds_read_b64_tr_b16 v[68:69], v48 offset:8192
    ds_read_b64_tr_b16 v[70:71], v48 offset:8704
    ds_read_b64_tr_b16 v[72:73], v48 offset:8
    ds_read_b64_tr_b16 v[74:75], v48 offset:520
    ds_read_b64_tr_b16 v[76:77], v48 offset:8200
    ds_read_b64_tr_b16 v[78:79], v48 offset:8712
    s_waitcnt lgkmcnt(0)
    s_barrier
    ds_write_b128 v32, v[64:67] offset:0
    ds_write_b128 v32, v[68:71] offset:1024
    ds_write_b128 v32, v[72:75] offset:2048
    ds_write_b128 v32, v[76:79] offset:3072
    s_waitcnt lgkmcnt(0)
    s_waitcnt vmcnt(24)
    s_barrier
    v_add_u32 v48, 16384, v46
    ds_read_b64_tr_b16 v[64:65], v48 offset:0
    ds_read_b64_tr_b16 v[66:67], v48 offset:512
    ds_read_b64_tr_b16 v[68:69], v48 offset:8192
    ds_read_b64_tr_b16 v[70:71], v48 offset:8704
    ds_read_b64_tr_b16 v[72:73], v48 offset:8
    ds_read_b64_tr_b16 v[74:75], v48 offset:520
    ds_read_b64_tr_b16 v[76:77], v48 offset:8200
    ds_read_b64_tr_b16 v[78:79], v48 offset:8712
    s_waitcnt lgkmcnt(0)
    s_barrier
    ds_write_b128 v32, v[64:67] offset:16384
    ds_write_b128 v32, v[68:71] offset:17408
    ds_write_b128 v32, v[72:75] offset:18432
    ds_write_b128 v32, v[76:79] offset:19456
    s_waitcnt lgkmcnt(0)
    s_waitcnt vmcnt(20)
    s_barrier
    v_add_u32 v48, 32768, v46
    ds_read_b64_tr_b16 v[64:65], v48 offset:0
    ds_read_b64_tr_b16 v[66:67], v48 offset:512
    ds_read_b64_tr_b16 v[68:69], v48 offset:8192
    ds_read_b64_tr_b16 v[70:71], v48 offset:8704
    ds_read_b64_tr_b16 v[72:73], v48 offset:8
    ds_read_b64_tr_b16 v[74:75], v48 offset:520
    ds_read_b64_tr_b16 v[76:77], v48 offset:8200
    ds_read_b64_tr_b16 v[78:79], v48 offset:8712
    s_waitcnt lgkmcnt(0)
    s_barrier
    ds_write_b128 v32, v[64:67] offset:32768
    ds_write_b128 v32, v[68:71] offset:33792
    ds_write_b128 v32, v[72:75] offset:34816
    ds_write_b128 v32, v[76:79] offset:35840
    s_waitcnt lgkmcnt(0)
    s_waitcnt vmcnt(16)
    s_barrier
    v_add_u32 v48, 49152, v46
    ds_read_b64_tr_b16 v[64:65], v48 offset:0
    ds_read_b64_tr_b16 v[66:67], v48 offset:512
    ds_read_b64_tr_b16 v[68:69], v48 offset:8192
    ds_read_b64_tr_b16 v[70:71], v48 offset:8704
    ds_read_b64_tr_b16 v[72:73], v48 offset:8
    ds_read_b64_tr_b16 v[74:75], v48 offset:520
    ds_read_b64_tr_b16 v[76:77], v48 offset:8200
    ds_read_b64_tr_b16 v[78:79], v48 offset:8712
    s_waitcnt lgkmcnt(0)
    s_barrier
    ds_write_b128 v32, v[64:67] offset:49152
    ds_write_b128 v32, v[68:71] offset:50176
    ds_write_b128 v32, v[72:75] offset:51200
    ds_write_b128 v32, v[76:79] offset:52224
    s_waitcnt lgkmcnt(0)
    s_waitcnt vmcnt(12)
    s_barrier
    v_add_u32 v48, 65536, v46
    ds_read_b64_tr_b16 v[64:65], v48 offset:0
    ds_read_b64_tr_b16 v[66:67], v48 offset:512
    ds_read_b64_tr_b16 v[68:69], v48 offset:8192
    ds_read_b64_tr_b16 v[70:71], v48 offset:8704
    ds_read_b64_tr_b16 v[72:73], v48 offset:8
    ds_read_b64_tr_b16 v[74:75], v48 offset:520
    ds_read_b64_tr_b16 v[76:77], v48 offset:8200
    ds_read_b64_tr_b16 v[78:79], v48 offset:8712
    s_waitcnt lgkmcnt(0)
    s_barrier
    ds_write_b128 v33, v[64:67] offset:0
    ds_write_b128 v33, v[68:71] offset:1024
    ds_write_b128 v33, v[72:75] offset:2048
    ds_write_b128 v33, v[76:79] offset:3072
    s_waitcnt lgkmcnt(0)
    s_waitcnt vmcnt(8)
    s_barrier
    v_add_u32 v48, 81920, v46
    ds_read_b64_tr_b16 v[208:209], v48 offset:0
    ds_read_b64_tr_b16 v[210:211], v48 offset:512
    ds_read_b64_tr_b16 v[212:213], v48 offset:8192
    ds_read_b64_tr_b16 v[214:215], v48 offset:8704
    ds_read_b64_tr_b16 v[216:217], v48 offset:8
    ds_read_b64_tr_b16 v[218:219], v48 offset:520
    ds_read_b64_tr_b16 v[220:221], v48 offset:8200
    ds_read_b64_tr_b16 v[222:223], v48 offset:8712
    s_waitcnt lgkmcnt(0)
    s_barrier
    ds_write_b128 v33, v[80:83] offset:16384
    ds_write_b128 v33, v[84:87] offset:17408
    ds_write_b128 v33, v[88:91] offset:18432
    ds_write_b128 v33, v[92:95] offset:19456
    s_waitcnt lgkmcnt(0)
    s_waitcnt vmcnt(4)
    s_barrier
    v_add_u32 v48, 98304, v46
    ds_read_b64_tr_b16 v[224:225], v48 offset:0
    ds_read_b64_tr_b16 v[226:227], v48 offset:512
    ds_read_b64_tr_b16 v[228:229], v48 offset:8192
    ds_read_b64_tr_b16 v[230:231], v48 offset:8704
    ds_read_b64_tr_b16 v[232:233], v48 offset:8
    ds_read_b64_tr_b16 v[234:235], v48 offset:520
    ds_read_b64_tr_b16 v[236:237], v48 offset:8200
    ds_read_b64_tr_b16 v[238:239], v48 offset:8712
    s_waitcnt lgkmcnt(0)
    s_barrier
    ds_write_b128 v33, v[96:99] offset:32768
    ds_write_b128 v33, v[100:103] offset:33792
    ds_write_b128 v33, v[104:107] offset:34816
    ds_write_b128 v33, v[108:111] offset:35840
    s_waitcnt lgkmcnt(0)
    s_waitcnt vmcnt(0)
    s_barrier
    v_add_u32 v48, 114688, v46
    ds_read_b64_tr_b16 v[240:241], v48 offset:0
    ds_read_b64_tr_b16 v[242:243], v48 offset:512
    ds_read_b64_tr_b16 v[244:245], v48 offset:8192
    ds_read_b64_tr_b16 v[246:247], v48 offset:8704
    ds_read_b64_tr_b16 v[248:249], v48 offset:8
    ds_read_b64_tr_b16 v[250:251], v48 offset:520
    ds_read_b64_tr_b16 v[252:253], v48 offset:8200
    ds_read_b64_tr_b16 v[254:255], v48 offset:8712
    s_waitcnt lgkmcnt(0)
    s_barrier
    ds_write_b128 v33, v[112:115] offset:49152
    ds_write_b128 v33, v[116:119] offset:50176
    ds_write_b128 v33, v[120:123] offset:51200
    ds_write_b128 v33, v[124:127] offset:52224
    s_waitcnt lgkmcnt(0)
mega_kernel_rf_iw:
    buffer_load_dwordx2 v[48:49], v14, s[12:15], 0 offen offset:8 sc1
    s_waitcnt vmcnt(0)
    v_cmp_ne_u32 vcc, 64, v48
    s_cbranch_vccnz mega_kernel_rf_iw
    v_and_b32 v50, 0xffff, v49
    v_readfirstlane_b32 s60, v49
    v_cmp_ne_u32 vcc, s100, v50
    s_cbranch_vccnz mega_kernel_rf_iw
    s_lshr_b32 s60, s60, 15
    s_cmp_gt_u32 s60, s100
    s_cselect_b32 s60, 8192, 0
    s_bfe_u32 s22, s31, 0x10001
    s_lshl_b32 s22, s22, 12
    s_add_u32 s22, s22, s60
    s_lshl_b32 s23, s20, 10
    s_add_u32 s22, s22, s23
    s_add_u32 s38, s38, s22
    s_add_u32 s37, s37, s22
    s_xor_b32 s40, s38, 4096
    s_xor_b32 s39, s37, 4096
    s_xor_b32 s36, s35, 16384
    s_mov_b32 s21, 0
    s_cmp_eq_u32 s30, 0
    s_mov_b32 s22, 0x33003300
    s_cselect_b32 s16, 0x00330033, s22
    s_mov_b32 s17, s16
    s_cselect_b32 s18, -1, 0
    s_not_b32 s19, s18
    s_lshl_b32 s22, s31, 13
    s_lshl_b32 s23, s20, 11
    s_add_u32 s22, s22, s23
    s_add_u32 s43, s22, 16777216
    s_add_u32 s44, s22, 33554432
    s_lshl_b32 s45, s31, 12
    s_add_u32 s45, s45, 178257920
    s_mul_i32 s48, s20, 3072
    s_add_u32 m0, s48, 140288
    s_mov_b32 s41, 1
    s_mov_b32 s42, 1
    v_mov_b32 v0, v34
    v_bfrev_b32 v3, 1
    v_cndmask_b32 v10, v3, v10, s[16:17]
    v_cndmask_b32 v11, v3, v11, s[18:19]
    v_cndmask_b32 v9, v3, v9, s[26:27]
    s_sub_u32 s45, s45, 131072
    s_mov_b32 s50, 0
    s_cmp_lg_u32 s20, 3
    s_cbranch_scc1 mega_kernel_rf_kv0
mega_kernel_rf_kvb0:
    s_add_u32 s22, s21, 0
    s_min_u32 s22, s22, 63
    s_cmp_gt_u32 s50, s22
    s_cbranch_scc1 mega_kernel_rf_kvd0
    buffer_load_dword v48, v7, s[4:7], 0 offen sc1
    s_waitcnt vmcnt(0)
    v_readlane_b32 s50, v48, 0
    v_readlane_b32 s22, v48, 2
    v_readlane_b32 s23, v48, 1
    v_readlane_b32 s24, v48, 3
    s_nop 3
    s_min_u32 s50, s50, s22
    s_min_u32 s23, s23, s24
    s_lshl_b32 s50, s50, 1
    s_lshl_b32 s23, s23, 1
    s_add_u32 s23, s23, 1
    s_min_u32 s50, s50, s23
    s_branch mega_kernel_rf_kvb0
mega_kernel_rf_kvd0:
mega_kernel_rf_kv0:
    s_barrier
    s_cmp_eq_u32 s20, 1
    s_cbranch_scc1 mega_kernel_rf_w1_entry
    s_cmp_eq_u32 s20, 2
    s_cbranch_scc1 mega_kernel_rf_w2_entry
    s_cmp_eq_u32 s20, 3
    s_cbranch_scc1 mega_kernel_rf_w3_entry
mega_kernel_rf_w0_entry:
    v_mfma_f32_32x32x8_bf16 v[96:111], v[14:15], v[14:15], 0
    v_mfma_f32_16x16x16_bf16 v[112:115], v[14:15], v[14:15], 0
    v_mfma_f32_16x16x16_bf16 v[116:119], v[14:15], v[14:15], 0
    ds_read_b128 v[64:67], v1 offset:0
    ds_read_b128 v[68:71], v1 offset:1024
    ds_read_b128 v[72:75], v1 offset:2048
    ds_read_b128 v[76:79], v1 offset:3072
    ds_read_b128 v[80:83], v1 offset:16384
    ds_read_b128 v[84:87], v1 offset:17408
    ds_read_b128 v[88:91], v1 offset:18432
    ds_read_b128 v[92:95], v1 offset:19456
    buffer_load_dwordx4 v[120:123], v1, s[4:7], s44 offen
    buffer_load_dwordx4 v[124:127], v1, s[4:7], s44 offen offset:1024
    s_add_u32 s44, s44, 262144
mega_kernel_rf_w0_loop:
    s_add_u32 s22, s35, 0
    s_nop 15
    s_nop 15
    s_nop 7
    buffer_load_dwordx4 v[32:35], v12, s[4:7], s22 offen sc1
    buffer_load_dwordx4 v[36:39], v12, s[4:7], s22 offen offset:1024 sc1
mega_kernel_rf_w0_pa:
    s_waitcnt vmcnt(1)
    ds_write_b128 v6, v[32:35] offset:0
    s_waitcnt vmcnt(0)
    ds_write_b128 v6, v[36:39] offset:1024
    v_max3_u32 v3, v32, v34, v36
    v_max_u32 v3, v3, v38
    v_cmp_eq_u32 vcc, -1, v3
    v_smfmac_f32_16x16x64_bf16 v[96:99], v[32:35], a[0:7], v2
    v_smfmac_f32_16x16x64_bf16 v[100:103], v[32:35], a[8:15], v2
    v_smfmac_f32_16x16x64_bf16 v[104:107], v[32:35], a[128:135], v2
    s_cbranch_vccnz mega_kernel_rf_w0_pafail
    s_waitcnt lgkmcnt(0)
    s_barrier
    ds_read_b128 v[40:43], v6 offset:2048
    ds_read_b128 v[44:47], v6 offset:3072
    v_smfmac_f32_16x16x64_bf16 v[108:111], v[32:35], a[136:143], v2
    ds_read_b128 v[48:51], v6 offset:4096
    v_smfmac_f32_16x16x64_bf16 v[96:99], v[36:39], a[16:23], v2
    ds_read_b128 v[52:55], v6 offset:5120
    v_smfmac_f32_16x16x64_bf16 v[100:103], v[36:39], a[24:31], v2
    ds_read_b128 v[56:59], v6 offset:6144
    v_smfmac_f32_16x16x64_bf16 v[104:107], v[36:39], a[144:151], v2
    ds_read_b128 v[60:63], v6 offset:7168
    v_smfmac_f32_16x16x64_bf16 v[108:111], v[36:39], a[152:159], v2
    buffer_load_dwordx4 v1, s[4:7], s43 offen lds
    s_waitcnt lgkmcnt(5)
    v_smfmac_f32_16x16x64_bf16 v[96:99], v[40:43], a[32:39], v2
    v_smfmac_f32_16x16x64_bf16 v[100:103], v[40:43], a[40:47], v2
    v_smfmac_f32_16x16x64_bf16 v[104:107], v[40:43], a[160:167], v2
    v_smfmac_f32_16x16x64_bf16 v[108:111], v[40:43], a[168:175], v2
    buffer_load_dwordx4 v1, s[4:7], s43 offen offset:1024 lds
    s_waitcnt lgkmcnt(4)
    v_smfmac_f32_16x16x64_bf16 v[96:99], v[44:47], a[48:55], v2
    v_smfmac_f32_16x16x64_bf16 v[100:103], v[44:47], a[56:63], v2
    v_smfmac_f32_16x16x64_bf16 v[104:107], v[44:47], a[176:183], v2
    v_smfmac_f32_16x16x64_bf16 v[108:111], v[44:47], a[184:191], v2
    buffer_store_dwordx4 v[20:23], v10, s[4:7], s45 offen offset:0 sc1
    s_waitcnt lgkmcnt(3)
    v_smfmac_f32_16x16x64_bf16 v[96:99], v[48:51], a[64:71], v2
    v_smfmac_f32_16x16x64_bf16 v[100:103], v[48:51], a[72:79], v2
    v_smfmac_f32_16x16x64_bf16 v[104:107], v[48:51], a[192:199], v2
    v_smfmac_f32_16x16x64_bf16 v[108:111], v[48:51], a[200:207], v2
    buffer_store_dwordx2 v[18:19], v11, s[4:7], s45 offen offset:2048 sc1
    s_waitcnt lgkmcnt(2)
    v_smfmac_f32_16x16x64_bf16 v[96:99], v[52:55], a[80:87], v2
    v_smfmac_f32_16x16x64_bf16 v[100:103], v[52:55], a[88:95], v2
    v_smfmac_f32_16x16x64_bf16 v[104:107], v[52:55], a[208:215], v2
    v_smfmac_f32_16x16x64_bf16 v[108:111], v[52:55], a[216:223], v2
    s_waitcnt lgkmcnt(1)
    v_smfmac_f32_16x16x64_bf16 v[96:99], v[56:59], a[96:103], v2
    v_smfmac_f32_16x16x64_bf16 v[100:103], v[56:59], a[104:111], v2
    v_smfmac_f32_16x16x64_bf16 v[104:107], v[56:59], a[224:231], v2
    v_smfmac_f32_16x16x64_bf16 v[108:111], v[56:59], a[232:239], v2
    s_waitcnt lgkmcnt(0)
    v_smfmac_f32_16x16x64_bf16 v[96:99], v[60:63], a[112:119], v2
    v_smfmac_f32_16x16x64_bf16 v[100:103], v[60:63], a[120:127], v2
    v_smfmac_f32_16x16x64_bf16 v[104:107], v[60:63], a[240:247], v2
    v_smfmac_f32_16x16x64_bf16 v[108:111], v[60:63], a[248:255], v2
    s_nop 4
    v_pk_add_f32 v[96:97], v[96:97], v[98:99]
    v_pk_add_f32 v[100:101], v[100:101], v[102:103]
    v_pk_add_f32 v[104:105], v[104:105], v[106:107]
    v_pk_add_f32 v[108:109], v[108:109], v[110:111]
    v_cvt_pk_bf16_f32 v111, v108, v109
    v_cvt_pk_bf16_f32 v108, v96, v97
    v_cvt_pk_bf16_f32 v110, v100, v101
    v_cvt_pk_bf16_f32 v109, v104, v105
    v_and_or_b32 v108, v108, -2, s41
    buffer_store_dwordx4 v[108:111], v1, s[4:7], s37 offen sc1
    v_smfmac_f32_16x16x64_bf16 v[112:115], v[32:35], v[64:71], v2
    ds_read_b128 v[64:67], v1 offset:32768
    ds_read_b128 v[68:71], v1 offset:33792
    v_smfmac_f32_16x16x64_bf16 v[116:119], v[32:35], v[72:79], v2
    ds_read_b128 v[72:75], v1 offset:34816
    ds_read_b128 v[76:79], v1 offset:35840
    v_smfmac_f32_16x16x64_bf16 v[112:115], v[36:39], v[80:87], v2
    ds_read_b128 v[80:83], v1 offset:49152
    ds_read_b128 v[84:87], v1 offset:50176
    v_smfmac_f32_16x16x64_bf16 v[116:119], v[36:39], v[88:95], v2
    ds_read_b128 v[88:91], v1 offset:51200
    ds_read_b128 v[92:95], v1 offset:52224
    v_smfmac_f32_16x16x64_bf16 v[112:115], v[52:55], v[208:215], v2
    v_smfmac_f32_16x16x64_bf16 v[116:119], v[52:55], v[216:223], v2
    v_smfmac_f32_16x16x64_bf16 v[112:115], v[56:59], v[224:231], v2
    s_waitcnt lgkmcnt(6)
    v_smfmac_f32_16x16x64_bf16 v[112:115], v[40:43], v[64:71], v2
    ds_read_b128 v[64:67], v5 offset:0
    ds_read_b128 v[68:71], v5 offset:1024
    s_waitcnt lgkmcnt(6)
    v_smfmac_f32_16x16x64_bf16 v[116:119], v[40:43], v[72:79], v2
    ds_read_b128 v[72:75], v5 offset:2048
    ds_read_b128 v[76:79], v5 offset:3072
    v_smfmac_f32_16x16x64_bf16 v[116:119], v[56:59], v[232:239], v2
    v_smfmac_f32_16x16x64_bf16 v[112:115], v[60:63], v[240:247], v2
    v_smfmac_f32_16x16x64_bf16 v[116:119], v[60:63], v[248:255], v2
    s_waitcnt lgkmcnt(6)
    v_smfmac_f32_16x16x64_bf16 v[112:115], v[44:47], v[80:87], v2
    s_waitcnt lgkmcnt(4)
    v_smfmac_f32_16x16x64_bf16 v[116:119], v[44:47], v[88:95], v2
    s_waitcnt lgkmcnt(2)
    v_smfmac_f32_16x16x64_bf16 v[112:115], v[48:51], v[64:71], v2
    s_waitcnt lgkmcnt(0)
    v_smfmac_f32_16x16x64_bf16 v[116:119], v[48:51], v[72:79], v2
    v_mfma_f32_16x16x16_bf16 v[100:103], v[108:109], v[16:17], 0
    v_mfma_f32_16x16x16_bf16 v[104:107], v[110:111], v[16:17], 0
    s_nop 4
    v_add_f32 v112, v112, v114
    v_add_f32 v113, v113, v115
    v_add_f32 v114, v116, v118
    v_add_f32 v115, v117, v119
    v_and_or_b32 v112, v112, -2, s41
    s_waitcnt vmcnt(3)
    s_barrier
    ds_read_b128 v[32:35], v6 offset:9216
    ds_read_b128 v[36:39], v6 offset:10240
    ds_read_b128 v[40:43], v6 offset:12288
    ds_read_b128 v[44:47], v6 offset:13312
    ds_read_b128 v[48:51], v6 offset:15360
    ds_read_b128 v[52:55], v6 offset:16384
    ds_read_b128 v[56:59], v6 offset:18432
    ds_read_b128 v[60:63], v6 offset:19456
    buffer_load_dwordx4 v[96:99], v1, s[4:7], s38 offen sc1
    s_barrier
    buffer_store_dwordx4 v[112:115], v1, s[4:7], s39 offen sc1
    s_nop 15
    s_nop 15
    buffer_load_dwordx4 v[20:23], v1, s[4:7], s38 offen sc1
    s_waitcnt vmcnt(2)
    v_mfma_f32_16x16x16_bf16 v[80:83], v[96:97], v[16:17], v[100:103]
    v_mfma_f32_16x16x16_bf16 v[84:87], v[98:99], v[16:17], v[104:107]
    v_and_b32 v3, 1, v96
    v_cmp_ne_u32 vcc, s41, v3
    s_nop 4
    v_cvt_pk_bf16_f32 v64, v80, v81
    v_cvt_pk_bf16_f32 v65, v82, v83
    v_cvt_pk_bf16_f32 v66, v84, v85
    v_cvt_pk_bf16_f32 v67, v86, v87
    ds_write_b128 v6, v[64:67] offset:8192
    s_cbranch_vccnz mega_kernel_rf_w0_xslow
mega_kernel_rf_w0_xok:
    buffer_load_dwordx4 v[116:119], v1, s[4:7], s40 offen sc1
    s_waitcnt lgkmcnt(1)
    v_mfma_f32_16x16x32_bf16 v[80:83], v[32:35], v[64:67], 0
    s_waitcnt lgkmcnt(0)
    s_barrier
    ds_read_b128 v[68:71], v6 offset:11264
    ds_read_b128 v[72:75], v6 offset:14336
    ds_read_b128 v[76:79], v6 offset:17408
    v_mfma_f32_16x16x32_bf16 v[84:87], v[36:39], v[64:67], 0
    v_mfma_f32_16x16x32_bf16 v[88:91], v[64:67], v[64:67], 0
    buffer_load_dwordx4 v[20:23], v1, s[4:7], s40 offen sc1
    s_waitcnt lgkmcnt(2)
    v_mfma_f32_16x16x32_bf16 v[80:83], v[40:43], v[68:71], v[80:83]
    v_mfma_f32_16x16x32_bf16 v[84:87], v[44:47], v[68:71], v[84:87]
    v_mfma_f32_16x16x32_bf16 v[88:91], v[68:71], v[68:71], v[88:91]
    s_waitcnt lgkmcnt(1)
    v_mfma_f32_16x16x32_bf16 v[80:83], v[48:51], v[72:75], v[80:83]
    v_mfma_f32_16x16x32_bf16 v[84:87], v[52:55], v[72:75], v[84:87]
    v_mfma_f32_16x16x32_bf16 v[88:91], v[72:75], v[72:75], v[88:91]
    s_waitcnt lgkmcnt(0)
    v_mfma_f32_16x16x32_bf16 v[80:83], v[56:59], v[76:79], v[80:83]
    v_mfma_f32_16x16x32_bf16 v[84:87], v[60:63], v[76:79], v[84:87]
    v_mfma_f32_16x16x32_bf16 v[88:91], v[76:79], v[76:79], v[88:91]
    v_mfma_f32_32x32x4_2b_bf16 v[32:63], v[14:15], v[14:15], 0
    s_nop 4
    v_max3_f32 v4, v80, v81, v82
    v_max3_f32 v4, v4, v83, v84
    v_max3_f32 v4, v4, v85, v86
    v_max3_f32 v4, v4, v87, v88
    v_max_f32 v90, v4, v89
    v_max_f32 v4, v4, v89
    v_mov_b32 v73, 0
    s_nop 0
    v_permlane16_swap_b32 v4, v90
    v_max_f32 v4, v4, v90
    v_max_f32 v90, v4, v90
    s_nop 1
    v_permlane32_swap_b32 v4, v90
    v_max_f32 v4, v4, v90
    v_mul_f32 v4, s34, v4
    v_pk_fma_f32 v[80:81], v[80:81], s[34:35], v[4:5] op_sel_hi:[1,0,0] neg_lo:[0,0,1] neg_hi:[0,0,1]
    v_pk_fma_f32 v[82:83], v[82:83], s[34:35], v[4:5] op_sel_hi:[1,0,0] neg_lo:[0,0,1] neg_hi:[0,0,1]
    v_pk_fma_f32 v[84:85], v[84:85], s[34:35], v[4:5] op_sel_hi:[1,0,0] neg_lo:[0,0,1] neg_hi:[0,0,1]
    v_pk_fma_f32 v[86:87], v[86:87], s[34:35], v[4:5] op_sel_hi:[1,0,0] neg_lo:[0,0,1] neg_hi:[0,0,1]
    v_pk_fma_f32 v[88:89], v[88:89], s[34:35], v[4:5] op_sel_hi:[1,0,0] neg_lo:[0,0,1] neg_hi:[0,0,1]
    v_exp_f32 v80, v80
    v_exp_f32 v81, v81
    v_exp_f32 v82, v82
    v_cvt_pk_bf16_f32 v68, v80, v81
    v_exp_f32 v83, v83
    v_exp_f32 v84, v84
    v_cvt_pk_bf16_f32 v69, v82, v83
    v_exp_f32 v85, v85
    v_exp_f32 v86, v86
    v_cvt_pk_bf16_f32 v70, v84, v85
    v_exp_f32 v87, v87
    v_exp_f32 v88, v88
    v_cvt_pk_bf16_f32 v71, v86, v87
    v_exp_f32 v89, v89
    s_cmp_eq_u32 s21, 63
    v_mfma_f32_16x16x32_bf16 v[76:79], v[28:31], v[68:71], 0
    v_cvt_pk_bf16_f32 v72, v88, v89
    s_waitcnt vmcnt(1)
    v_and_b32 v3, 1, v116
    v_mfma_f32_16x16x32_bf16 v[100:103], v[120:123], v[68:71], 0
    v_cmp_ne_u32 vcc, s41, v3
    v_add_f32 v116, v112, v116
    v_mfma_f32_16x16x32_bf16 v[104:107], v[124:127], v[68:71], 0
    v_add_f32 v117, v113, v117
    v_add_f32 v118, v114, v118
    v_mfma_f32_16x16x16_bf16 v[76:79], v[28:29], v[72:73], v[76:79]
    v_add_f32 v119, v115, v119
    s_cbranch_vccnz mega_kernel_rf_w0_pv0
mega_kernel_rf_w0_pv2:
    v_cvt_pk_bf16_f32 v18, v116, v117
    v_cvt_pk_bf16_f32 v19, v118, v119
    v_cvt_pk_bf16_f32 v98, v118, v119
    v_mov_b32 v99, 0
    v_mfma_f32_16x16x16_bf16 v[100:103], v[18:19], v[72:73], v[100:103]
    s_nop 0
    v_mfma_f32_16x16x16_bf16 v[104:107], v[98:99], v[72:73], v[104:107]
    buffer_load_dwordx4 v[120:123], v1, s[4:7], s44 offen
    buffer_load_dwordx4 v[124:127], v1, s[4:7], s44 offen offset:1024
    s_cmp_eq_u32 s21, 63
    v_rcp_f32 v76, v76
    s_cbranch_scc1 mega_kernel_rf_w0_last
    s_mov_b64 exec, s[28:29]
    v_pk_mul_f32 v[100:101], v[100:101], v[76:77] op_sel_hi:[1,0]
    v_pk_mul_f32 v[102:103], v[102:103], v[76:77] op_sel_hi:[1,0]
    v_pk_mul_f32 v[104:105], v[104:105], v[76:77] op_sel_hi:[1,0]
    v_pk_mul_f32 v[106:107], v[106:107], v[76:77] op_sel_hi:[1,0]
    v_cvt_pk_bf16_f32 v72, v100, v101
    v_cvt_pk_bf16_f32 v73, v102, v103
    v_cvt_pk_bf16_f32 v74, v104, v105
    v_cvt_pk_bf16_f32 v75, v106, v107
    ds_write_b128 v6, v[72:75] offset:20448
    s_mov_b64 exec, -1
    ds_read_b128 v[88:91], v5 offset:16384
    ds_read_b128 v[92:95], v5 offset:17408
    ds_read_b128 v[80:83], v5 offset:18432
    ds_read_b128 v[84:87], v5 offset:19456
    ds_read_b128 v[112:115], v5 offset:32768
    ds_read_b128 v[116:119], v5 offset:33792
    v_mov_b32 v3, s21
    buffer_store_dword v3, v7, s[4:7], 0 offen sc1
    s_waitcnt lgkmcnt(6)
    s_barrier
    ds_read_b128 v[68:71], v6 offset:20480
    ds_read_b128 v[72:75], v6 offset:21504
    ds_read_b128 v[96:99], v5 offset:34816
    ds_read_b128 v[100:103], v5 offset:35840
    ds_read_b128 v[104:107], v5 offset:49152
    ds_read_b128 v[108:111], v5 offset:50176
    s_waitcnt lgkmcnt(5)
    v_smfmac_f32_16x16x64_bf16 v[32:35], v[68:71], v[128:135], v2
    s_add_u32 s21, s21, 1
    v_smfmac_f32_16x16x64_bf16 v[36:39], v[68:71], v[136:143], v2
    s_xor_b32 s38, s38, 1048576
    v_smfmac_f32_16x16x64_bf16 v[40:43], v[68:71], v[144:151], v2
    s_xor_b32 s37, s37, 1048576
    v_smfmac_f32_16x16x64_bf16 v[44:47], v[68:71], v[152:159], v2
    s_xor_b32 s40, s40, 1048576
    s_waitcnt lgkmcnt(4)
    v_smfmac_f32_16x16x64_bf16 v[32:35], v[72:75], v[160:167], v2
    s_xor_b32 s39, s39, 1048576
    v_smfmac_f32_16x16x64_bf16 v[36:39], v[72:75], v[168:175], v2
    s_lshr_b32 s41, s21, 1
    v_smfmac_f32_16x16x64_bf16 v[40:43], v[72:75], v[176:183], v2
    s_and_b32 s41, s41, 1
    v_smfmac_f32_16x16x64_bf16 v[44:47], v[72:75], v[184:191], v2
    s_xor_b32 s41, s41, 1
    v_smfmac_f32_16x16x64_bf16 v[48:51], v[68:71], v[192:199], v2
    s_xor_b32 s35, s35, 16384
    v_smfmac_f32_16x16x64_bf16 v[52:55], v[68:71], v[200:207], v2
    s_xor_b32 s36, s36, 16384
    s_waitcnt lgkmcnt(0)
    v_smfmac_f32_16x16x64_bf16 v[56:59], v[68:71], v[88:95], v2
    ds_read_b128 v[88:91], v5 offset:51200
    ds_read_b128 v[92:95], v5 offset:52224
    v_smfmac_f32_16x16x64_bf16 v[60:63], v[68:71], v[80:87], v2
    s_add_u32 s43, s43, 262144
    v_smfmac_f32_16x16x64_bf16 v[48:51], v[72:75], v[112:119], v2
    s_add_u32 s44, s44, 262144
    v_add_f32 v32, v32, v34
    v_add_f32 v33, v33, v35
    v_cvt_pk_bf16_f32 v32, v32, v33
    v_and_or_b32 v32, v32, -2, s42
    v_smfmac_f32_16x16x64_bf16 v[52:55], v[72:75], v[96:103], v2
    v_add_f32 v36, v36, v38
    v_add_f32 v37, v37, v39
    v_cvt_pk_bf16_f32 v33, v36, v37
    v_smfmac_f32_16x16x64_bf16 v[56:59], v[72:75], v[104:111], v2
    v_add_f32 v40, v40, v42
    v_add_f32 v41, v41, v43
    v_cvt_pk_bf16_f32 v34, v40, v41
    s_waitcnt lgkmcnt(0)
    v_smfmac_f32_16x16x64_bf16 v[60:63], v[72:75], v[88:95], v2
    v_add_f32 v44, v44, v46
    v_add_f32 v45, v45, v47
    v_cvt_pk_bf16_f32 v35, v44, v45
    buffer_store_dwordx4 v[32:35], v8, s[4:7], s46 offen
    v_pk_add_f32 v[48:49], v[48:49], v[50:51]
    v_cvt_pk_bf16_f32 v48, v48, v49
    v_and_or_b32 v48, v48, -2, s42
    v_pk_add_f32 v[52:53], v[52:53], v[54:55]
    v_cvt_pk_bf16_f32 v49, v52, v53
    v_pk_add_f32 v[56:57], v[56:57], v[58:59]
    v_cvt_pk_bf16_f32 v50, v56, v57
    v_pk_add_f32 v[60:61], v[60:61], v[62:63]
    v_cvt_pk_bf16_f32 v51, v60, v61
    buffer_store_dwordx4 v[48:51], v8, s[4:7], s61 offen
    s_waitcnt vmcnt(5)
    v_mov_b32 v20, v64
    v_mov_b32 v21, v65
    v_mov_b32 v22, v66
    v_mov_b32 v23, v67
    s_add_u32 s45, s45, 131072
    v_mfma_f32_32x32x8_bf16 v[96:111], v[14:15], v[14:15], 0
    v_mfma_f32_16x16x16_bf16 v[112:115], v[14:15], v[14:15], 0
    v_mfma_f32_16x16x16_bf16 v[116:119], v[14:15], v[14:15], 0
    ds_read_b128 v[64:67], v1 offset:0
    ds_read_b128 v[68:71], v1 offset:1024
    ds_read_b128 v[72:75], v1 offset:2048
    ds_read_b128 v[76:79], v1 offset:3072
    ds_read_b128 v[80:83], v1 offset:16384
    ds_read_b128 v[84:87], v1 offset:17408
    ds_read_b128 v[88:91], v1 offset:18432
    ds_read_b128 v[92:95], v1 offset:19456
    v_mov_b32 v58, -1
    v_mov_b32 v59, -1
    s_nop 15
    s_nop 15
    s_nop 15
mega_kernel_rf_w0_pc:
    buffer_load_dword v36, v13, s[4:7], s47 offen offset:0 sc1
    buffer_load_dword v37, v13, s[4:7], s47 offen offset:1024 sc1
    buffer_load_dword v38, v13, s[4:7], s47 offen offset:2048 sc1
    buffer_load_dword v39, v13, s[4:7], s47 offen offset:3072 sc1
    buffer_load_dword v40, v13, s[4:7], s25 offen offset:0 sc1
    buffer_load_dword v41, v13, s[4:7], s25 offen offset:1024 sc1
    buffer_load_dword v42, v13, s[4:7], s25 offen offset:2048 sc1
    buffer_load_dword v43, v13, s[4:7], s25 offen offset:3072 sc1
    s_waitcnt vmcnt(4)
    v_mfma_f32_16x16x32_bf16 v[52:55], v[36:39], v[24:27], 0
    v_bitop3_b32 v3, s42, v36, v37 bitop3:0x7e
    v_bitop3_b32 v4, s42, v38, v39 bitop3:0x7e
    s_waitcnt vmcnt(2)
    v_or_b32 v3, v3, v4
    v_bitop3_b32 v4, s42, v40, v41 bitop3:0x7e
    s_waitcnt vmcnt(0)
    v_mfma_f32_16x16x32_bf16 v[52:55], v[40:43], v[24:27], v[52:55]
    v_bitop3_b32 v56, s42, v42, v43 bitop3:0x7e
    v_or3_b32 v3, v3, v4, v56
    v_and_b32 v3, v0, v3
    v_cmp_ne_u32 vcc, 0, v3
    s_cbranch_vccnz mega_kernel_rf_w0_pc
    s_nop 2
    v_cvt_pk_bf16_f32 v56, v52, v53
    v_cvt_pk_bf16_f32 v57, v54, v55
    v_min_u32 v56, -2, v56
    s_mov_b64 exec, s[26:27]
    buffer_store_dwordx2 v[56:57], v9, s[4:7], s35 offen offset:0
    buffer_store_dwordx2 v[58:59], v9, s[4:7], s36 offen offset:0
    s_mov_b64 exec, -1
    s_xor_b32 s42, s42, 1
    s_branch mega_kernel_rf_w0_loop
mega_kernel_rf_w0_last:
    s_waitcnt vmcnt(0)
    v_mov_b32 v20, v64
    v_mov_b32 v21, v65
    v_mov_b32 v22, v66
    v_mov_b32 v23, v67
    s_add_u32 s45, s45, 131072
    buffer_store_dwordx4 v[20:23], v10, s[4:7], s45 offen offset:0 sc1
    buffer_store_dwordx2 v[18:19], v11, s[4:7], s45 offen offset:2048 sc1
    s_branch mega_kernel_rf_end
mega_kernel_rf_w0_pafail:
    buffer_load_dwordx4 v[32:35], v12, s[4:7], s22 offen sc1
    buffer_load_dwordx4 v[36:39], v12, s[4:7], s22 offen offset:1024 sc1
    s_nop 7
    v_mov_b32 v96, 0
    v_mov_b32 v97, 0
    v_mov_b32 v98, 0
    v_mov_b32 v99, 0
    v_mov_b32 v100, 0
    v_mov_b32 v101, 0
    v_mov_b32 v102, 0
    v_mov_b32 v103, 0
    v_mov_b32 v104, 0
    v_mov_b32 v105, 0
    v_mov_b32 v106, 0
    v_mov_b32 v107, 0
    s_branch mega_kernel_rf_w0_pa
mega_kernel_rf_w0_xslow:
    buffer_load_dwordx4 v[96:99], v1, s[4:7], s38 offen sc1
    s_waitcnt vmcnt(1)
    v_and_b32 v3, 1, v20
    v_cmp_ne_u32 vcc, s41, v3
    s_cbranch_vccz mega_kernel_rf_w0_xgot1
    buffer_load_dwordx4 v[20:23], v1, s[4:7], s38 offen sc1
mega_kernel_rf_w0_px:
    s_waitcnt vmcnt(1)
    v_and_b32 v3, 1, v96
    v_cmp_ne_u32 vcc, s41, v3
    s_cbranch_vccz mega_kernel_rf_w0_xgot0
    buffer_load_dwordx4 v[96:99], v1, s[4:7], s38 offen sc1
    s_waitcnt vmcnt(1)
    v_and_b32 v3, 1, v20
    v_cmp_ne_u32 vcc, s41, v3
    s_cbranch_vccz mega_kernel_rf_w0_xgot1
    buffer_load_dwordx4 v[20:23], v1, s[4:7], s38 offen sc1
    s_branch mega_kernel_rf_w0_px
mega_kernel_rf_w0_xgot0:
    v_mfma_f32_16x16x16_bf16 v[80:83], v[96:97], v[16:17], v[100:103]
    v_mfma_f32_16x16x16_bf16 v[84:87], v[98:99], v[16:17], v[104:107]
    v_and_b32 v3, 1, v96
    v_cmp_ne_u32 vcc, s41, v3
    s_nop 4
    v_cvt_pk_bf16_f32 v64, v80, v81
    v_cvt_pk_bf16_f32 v65, v82, v83
    v_cvt_pk_bf16_f32 v66, v84, v85
    v_cvt_pk_bf16_f32 v67, v86, v87
    ds_write_b128 v6, v[64:67] offset:8192
    s_branch mega_kernel_rf_w0_xok
mega_kernel_rf_w0_xgot1:
    v_mfma_f32_16x16x16_bf16 v[80:83], v[20:21], v[16:17], v[100:103]
    v_mfma_f32_16x16x16_bf16 v[84:87], v[22:23], v[16:17], v[104:107]
    v_and_b32 v3, 1, v20
    v_cmp_ne_u32 vcc, s41, v3
    s_nop 4
    v_cvt_pk_bf16_f32 v64, v80, v81
    v_cvt_pk_bf16_f32 v65, v82, v83
    v_cvt_pk_bf16_f32 v66, v84, v85
    v_cvt_pk_bf16_f32 v67, v86, v87
    ds_write_b128 v6, v[64:67] offset:8192
    s_branch mega_kernel_rf_w0_xok
mega_kernel_rf_w0_pv0:
    s_waitcnt vmcnt(0)
    s_branch mega_kernel_rf_w0_pv1
mega_kernel_rf_w0_pv:
    buffer_load_dwordx4 v[20:23], v1, s[4:7], s40 offen sc1
    s_waitcnt vmcnt(0)
mega_kernel_rf_w0_pv1:
    v_and_b32 v3, 1, v20
    v_cmp_ne_u32 vcc, s41, v3
    v_pk_add_f32 v[116:117], v[112:113], v[20:21]
    v_pk_add_f32 v[118:119], v[114:115], v[22:23]
    s_cbranch_vccnz mega_kernel_rf_w0_pv
    s_branch mega_kernel_rf_w0_pv2
mega_kernel_rf_w1_entry:
    v_mfma_f32_32x32x8_bf16 v[96:111], v[14:15], v[14:15], 0
    v_mfma_f32_16x16x16_bf16 v[112:115], v[14:15], v[14:15], 0
    v_mfma_f32_16x16x16_bf16 v[116:119], v[14:15], v[14:15], 0
    ds_read_b128 v[64:67], v1 offset:4096
    ds_read_b128 v[68:71], v1 offset:5120
    ds_read_b128 v[72:75], v1 offset:6144
    ds_read_b128 v[76:79], v1 offset:7168
    ds_read_b128 v[80:83], v1 offset:20480
    ds_read_b128 v[84:87], v1 offset:21504
    ds_read_b128 v[88:91], v1 offset:22528
    ds_read_b128 v[92:95], v1 offset:23552
    buffer_load_dwordx4 v[120:123], v1, s[4:7], s44 offen
    buffer_load_dwordx4 v[124:127], v1, s[4:7], s44 offen offset:1024
    s_add_u32 s44, s44, 262144
mega_kernel_rf_w1_loop:
    s_add_u32 s22, s35, 2048
    s_nop 15
    s_nop 15
    s_nop 7
    buffer_load_dwordx4 v[40:43], v12, s[4:7], s22 offen sc1
    buffer_load_dwordx4 v[44:47], v12, s[4:7], s22 offen offset:1024 sc1
mega_kernel_rf_w1_pa:
    s_waitcnt vmcnt(1)
    ds_write_b128 v6, v[40:43] offset:2048
    s_waitcnt vmcnt(0)
    ds_write_b128 v6, v[44:47] offset:3072
    v_max3_u32 v3, v40, v42, v44
    v_max_u32 v3, v3, v46
    v_cmp_eq_u32 vcc, -1, v3
    v_smfmac_f32_16x16x64_bf16 v[96:99], v[40:43], a[32:39], v2
    v_smfmac_f32_16x16x64_bf16 v[100:103], v[40:43], a[40:47], v2
    v_smfmac_f32_16x16x64_bf16 v[104:107], v[40:43], a[160:167], v2
    s_cbranch_vccnz mega_kernel_rf_w1_pafail
    s_waitcnt lgkmcnt(0)
    s_barrier
    ds_read_b128 v[48:51], v6 offset:4096
    ds_read_b128 v[52:55], v6 offset:5120
    v_smfmac_f32_16x16x64_bf16 v[108:111], v[40:43], a[168:175], v2
    ds_read_b128 v[56:59], v6 offset:6144
    v_smfmac_f32_16x16x64_bf16 v[96:99], v[44:47], a[48:55], v2
    ds_read_b128 v[60:63], v6 offset:7168
    v_smfmac_f32_16x16x64_bf16 v[100:103], v[44:47], a[56:63], v2
    ds_read_b128 v[32:35], v6 offset:0
    v_smfmac_f32_16x16x64_bf16 v[104:107], v[44:47], a[176:183], v2
    ds_read_b128 v[36:39], v6 offset:1024
    v_smfmac_f32_16x16x64_bf16 v[108:111], v[44:47], a[184:191], v2
    buffer_load_dwordx4 v1, s[4:7], s43 offen lds
    s_waitcnt lgkmcnt(5)
    v_smfmac_f32_16x16x64_bf16 v[96:99], v[48:51], a[64:71], v2
    v_smfmac_f32_16x16x64_bf16 v[100:103], v[48:51], a[72:79], v2
    v_smfmac_f32_16x16x64_bf16 v[104:107], v[48:51], a[192:199], v2
    v_smfmac_f32_16x16x64_bf16 v[108:111], v[48:51], a[200:207], v2
    buffer_load_dwordx4 v1, s[4:7], s43 offen offset:1024 lds
    s_waitcnt lgkmcnt(4)
    v_smfmac_f32_16x16x64_bf16 v[96:99], v[52:55], a[80:87], v2
    v_smfmac_f32_16x16x64_bf16 v[100:103], v[52:55], a[88:95], v2
    v_smfmac_f32_16x16x64_bf16 v[104:107], v[52:55], a[208:215], v2
    v_smfmac_f32_16x16x64_bf16 v[108:111], v[52:55], a[216:223], v2
    buffer_store_dwordx4 v[20:23], v10, s[4:7], s45 offen offset:64 sc1
    s_waitcnt lgkmcnt(3)
    v_smfmac_f32_16x16x64_bf16 v[96:99], v[56:59], a[96:103], v2
    v_smfmac_f32_16x16x64_bf16 v[100:103], v[56:59], a[104:111], v2
    v_smfmac_f32_16x16x64_bf16 v[104:107], v[56:59], a[224:231], v2
    v_smfmac_f32_16x16x64_bf16 v[108:111], v[56:59], a[232:239], v2
    buffer_store_dwordx2 v[18:19], v11, s[4:7], s45 offen offset:2560 sc1
    s_waitcnt lgkmcnt(2)
    v_smfmac_f32_16x16x64_bf16 v[96:99], v[60:63], a[112:119], v2
    v_smfmac_f32_16x16x64_bf16 v[100:103], v[60:63], a[120:127], v2
    v_smfmac_f32_16x16x64_bf16 v[104:107], v[60:63], a[240:247], v2
    v_smfmac_f32_16x16x64_bf16 v[108:111], v[60:63], a[248:255], v2
    s_waitcnt lgkmcnt(1)
    v_smfmac_f32_16x16x64_bf16 v[96:99], v[32:35], a[0:7], v2
    v_smfmac_f32_16x16x64_bf16 v[100:103], v[32:35], a[8:15], v2
    v_smfmac_f32_16x16x64_bf16 v[104:107], v[32:35], a[128:135], v2
    v_smfmac_f32_16x16x64_bf16 v[108:111], v[32:35], a[136:143], v2
    s_waitcnt lgkmcnt(0)
    v_smfmac_f32_16x16x64_bf16 v[96:99], v[36:39], a[16:23], v2
    v_smfmac_f32_16x16x64_bf16 v[100:103], v[36:39], a[24:31], v2
    v_smfmac_f32_16x16x64_bf16 v[104:107], v[36:39], a[144:151], v2
    v_smfmac_f32_16x16x64_bf16 v[108:111], v[36:39], a[152:159], v2
    s_nop 4
    v_pk_add_f32 v[96:97], v[96:97], v[98:99]
    v_pk_add_f32 v[100:101], v[100:101], v[102:103]
    v_pk_add_f32 v[104:105], v[104:105], v[106:107]
    v_pk_add_f32 v[108:109], v[108:109], v[110:111]
    v_cvt_pk_bf16_f32 v111, v108, v109
    v_cvt_pk_bf16_f32 v108, v96, v97
    v_cvt_pk_bf16_f32 v110, v100, v101
    v_cvt_pk_bf16_f32 v109, v104, v105
    v_and_or_b32 v108, v108, -2, s41
    buffer_store_dwordx4 v[108:111], v1, s[4:7], s37 offen sc1
    v_smfmac_f32_16x16x64_bf16 v[112:115], v[32:35], v[64:71], v2
    ds_read_b128 v[64:67], v1 offset:36864
    ds_read_b128 v[68:71], v1 offset:37888
    v_smfmac_f32_16x16x64_bf16 v[116:119], v[32:35], v[72:79], v2
    ds_read_b128 v[72:75], v1 offset:38912
    ds_read_b128 v[76:79], v1 offset:39936
    v_smfmac_f32_16x16x64_bf16 v[112:115], v[36:39], v[80:87], v2
    ds_read_b128 v[80:83], v1 offset:53248
    ds_read_b128 v[84:87], v1 offset:54272
    v_smfmac_f32_16x16x64_bf16 v[116:119], v[36:39], v[88:95], v2
    ds_read_b128 v[88:91], v1 offset:55296
    ds_read_b128 v[92:95], v1 offset:56320
    v_smfmac_f32_16x16x64_bf16 v[112:115], v[52:55], v[208:215], v2
    v_smfmac_f32_16x16x64_bf16 v[116:119], v[52:55], v[216:223], v2
    v_smfmac_f32_16x16x64_bf16 v[112:115], v[56:59], v[224:231], v2
    s_waitcnt lgkmcnt(6)
    v_smfmac_f32_16x16x64_bf16 v[112:115], v[40:43], v[64:71], v2
    ds_read_b128 v[64:67], v5 offset:4096
    ds_read_b128 v[68:71], v5 offset:5120
    s_waitcnt lgkmcnt(6)
    v_smfmac_f32_16x16x64_bf16 v[116:119], v[40:43], v[72:79], v2
    ds_read_b128 v[72:75], v5 offset:6144
    ds_read_b128 v[76:79], v5 offset:7168
    v_smfmac_f32_16x16x64_bf16 v[116:119], v[56:59], v[232:239], v2
    v_smfmac_f32_16x16x64_bf16 v[112:115], v[60:63], v[240:247], v2
    v_smfmac_f32_16x16x64_bf16 v[116:119], v[60:63], v[248:255], v2
    s_waitcnt lgkmcnt(6)
    v_smfmac_f32_16x16x64_bf16 v[112:115], v[44:47], v[80:87], v2
    s_waitcnt lgkmcnt(4)
    v_smfmac_f32_16x16x64_bf16 v[116:119], v[44:47], v[88:95], v2
    s_waitcnt lgkmcnt(2)
    v_smfmac_f32_16x16x64_bf16 v[112:115], v[48:51], v[64:71], v2
    s_waitcnt lgkmcnt(0)
    v_smfmac_f32_16x16x64_bf16 v[116:119], v[48:51], v[72:79], v2
    v_mfma_f32_16x16x16_bf16 v[100:103], v[108:109], v[16:17], 0
    v_mfma_f32_16x16x16_bf16 v[104:107], v[110:111], v[16:17], 0
    s_nop 4
    v_add_f32 v112, v112, v114
    v_add_f32 v113, v113, v115
    v_add_f32 v114, v116, v118
    v_add_f32 v115, v117, v119
    v_and_or_b32 v112, v112, -2, s41
    s_waitcnt vmcnt(3)
    s_barrier
    ds_read_b128 v[32:35], v6 offset:12288
    ds_read_b128 v[36:39], v6 offset:13312
    ds_read_b128 v[40:43], v6 offset:9216
    ds_read_b128 v[44:47], v6 offset:10240
    ds_read_b128 v[48:51], v6 offset:18432
    ds_read_b128 v[52:55], v6 offset:19456
    ds_read_b128 v[56:59], v6 offset:15360
    ds_read_b128 v[60:63], v6 offset:16384
    buffer_load_dwordx4 v[96:99], v1, s[4:7], s38 offen sc1
    s_barrier
    buffer_store_dwordx4 v[112:115], v1, s[4:7], s39 offen sc1
    s_nop 15
    s_nop 15
    buffer_load_dwordx4 v[20:23], v1, s[4:7], s38 offen sc1
    s_waitcnt vmcnt(2)
    v_mfma_f32_16x16x16_bf16 v[80:83], v[96:97], v[16:17], v[100:103]
    v_mfma_f32_16x16x16_bf16 v[84:87], v[98:99], v[16:17], v[104:107]
    v_and_b32 v3, 1, v96
    v_cmp_ne_u32 vcc, s41, v3
    s_nop 4
    v_cvt_pk_bf16_f32 v64, v80, v81
    v_cvt_pk_bf16_f32 v65, v82, v83
    v_cvt_pk_bf16_f32 v66, v84, v85
    v_cvt_pk_bf16_f32 v67, v86, v87
    ds_write_b128 v6, v[64:67] offset:11264
    s_cbranch_vccnz mega_kernel_rf_w1_xslow
mega_kernel_rf_w1_xok:
    buffer_load_dwordx4 v[116:119], v1, s[4:7], s40 offen sc1
    s_waitcnt lgkmcnt(1)
    v_mfma_f32_16x16x32_bf16 v[80:83], v[32:35], v[64:67], 0
    s_waitcnt lgkmcnt(0)
    s_barrier
    ds_read_b128 v[68:71], v6 offset:8192
    ds_read_b128 v[72:75], v6 offset:17408
    ds_read_b128 v[76:79], v6 offset:14336
    v_mfma_f32_16x16x32_bf16 v[84:87], v[36:39], v[64:67], 0
    v_mfma_f32_16x16x32_bf16 v[88:91], v[64:67], v[64:67], 0
    buffer_load_dwordx4 v[20:23], v1, s[4:7], s40 offen sc1
    s_waitcnt lgkmcnt(2)
    v_mfma_f32_16x16x32_bf16 v[80:83], v[40:43], v[68:71], v[80:83]
    v_mfma_f32_16x16x32_bf16 v[84:87], v[44:47], v[68:71], v[84:87]
    v_mfma_f32_16x16x32_bf16 v[88:91], v[68:71], v[68:71], v[88:91]
    s_waitcnt lgkmcnt(1)
    v_mfma_f32_16x16x32_bf16 v[80:83], v[48:51], v[72:75], v[80:83]
    v_mfma_f32_16x16x32_bf16 v[84:87], v[52:55], v[72:75], v[84:87]
    v_mfma_f32_16x16x32_bf16 v[88:91], v[72:75], v[72:75], v[88:91]
    s_waitcnt lgkmcnt(0)
    v_mfma_f32_16x16x32_bf16 v[80:83], v[56:59], v[76:79], v[80:83]
    v_mfma_f32_16x16x32_bf16 v[84:87], v[60:63], v[76:79], v[84:87]
    v_mfma_f32_16x16x32_bf16 v[88:91], v[76:79], v[76:79], v[88:91]
    v_mfma_f32_32x32x4_2b_bf16 v[32:63], v[14:15], v[14:15], 0
    s_nop 4
    v_max3_f32 v4, v80, v81, v82
    v_max3_f32 v4, v4, v83, v84
    v_max3_f32 v4, v4, v85, v86
    v_max3_f32 v4, v4, v87, v88
    v_max_f32 v90, v4, v89
    v_max_f32 v4, v4, v89
    v_mov_b32 v73, 0
    s_nop 0
    v_permlane16_swap_b32 v4, v90
    v_max_f32 v4, v4, v90
    v_max_f32 v90, v4, v90
    s_nop 1
    v_permlane32_swap_b32 v4, v90
    v_max_f32 v4, v4, v90
    v_mul_f32 v4, s34, v4
    v_pk_fma_f32 v[80:81], v[80:81], s[34:35], v[4:5] op_sel_hi:[1,0,0] neg_lo:[0,0,1] neg_hi:[0,0,1]
    v_pk_fma_f32 v[82:83], v[82:83], s[34:35], v[4:5] op_sel_hi:[1,0,0] neg_lo:[0,0,1] neg_hi:[0,0,1]
    v_pk_fma_f32 v[84:85], v[84:85], s[34:35], v[4:5] op_sel_hi:[1,0,0] neg_lo:[0,0,1] neg_hi:[0,0,1]
    v_pk_fma_f32 v[86:87], v[86:87], s[34:35], v[4:5] op_sel_hi:[1,0,0] neg_lo:[0,0,1] neg_hi:[0,0,1]
    v_pk_fma_f32 v[88:89], v[88:89], s[34:35], v[4:5] op_sel_hi:[1,0,0] neg_lo:[0,0,1] neg_hi:[0,0,1]
    v_exp_f32 v80, v80
    v_exp_f32 v81, v81
    v_exp_f32 v82, v82
    v_cvt_pk_bf16_f32 v68, v80, v81
    v_exp_f32 v83, v83
    v_exp_f32 v84, v84
    v_cvt_pk_bf16_f32 v69, v82, v83
    v_exp_f32 v85, v85
    v_exp_f32 v86, v86
    v_cvt_pk_bf16_f32 v70, v84, v85
    v_exp_f32 v87, v87
    v_exp_f32 v88, v88
    v_cvt_pk_bf16_f32 v71, v86, v87
    v_exp_f32 v89, v89
    s_cmp_eq_u32 s21, 63
    v_mfma_f32_16x16x32_bf16 v[76:79], v[28:31], v[68:71], 0
    v_cvt_pk_bf16_f32 v72, v88, v89
    s_waitcnt vmcnt(1)
    v_and_b32 v3, 1, v116
    v_mfma_f32_16x16x32_bf16 v[100:103], v[120:123], v[68:71], 0
    v_cmp_ne_u32 vcc, s41, v3
    v_add_f32 v116, v112, v116
    v_mfma_f32_16x16x32_bf16 v[104:107], v[124:127], v[68:71], 0
    v_add_f32 v117, v113, v117
    v_add_f32 v118, v114, v118
    v_mfma_f32_16x16x16_bf16 v[76:79], v[28:29], v[72:73], v[76:79]
    v_add_f32 v119, v115, v119
    s_cbranch_vccnz mega_kernel_rf_w1_pv0
mega_kernel_rf_w1_pv2:
    v_cvt_pk_bf16_f32 v18, v116, v117
    v_cvt_pk_bf16_f32 v19, v118, v119
    v_cvt_pk_bf16_f32 v98, v118, v119
    v_mov_b32 v99, 0
    v_mfma_f32_16x16x16_bf16 v[100:103], v[18:19], v[72:73], v[100:103]
    s_nop 0
    v_mfma_f32_16x16x16_bf16 v[104:107], v[98:99], v[72:73], v[104:107]
    buffer_load_dwordx4 v[120:123], v1, s[4:7], s44 offen
    buffer_load_dwordx4 v[124:127], v1, s[4:7], s44 offen offset:1024
    s_cmp_eq_u32 s21, 63
    v_rcp_f32 v76, v76
    s_cbranch_scc1 mega_kernel_rf_w1_last
    s_mov_b64 exec, s[28:29]
    v_pk_mul_f32 v[100:101], v[100:101], v[76:77] op_sel_hi:[1,0]
    v_pk_mul_f32 v[102:103], v[102:103], v[76:77] op_sel_hi:[1,0]
    v_pk_mul_f32 v[104:105], v[104:105], v[76:77] op_sel_hi:[1,0]
    v_pk_mul_f32 v[106:107], v[106:107], v[76:77] op_sel_hi:[1,0]
    v_cvt_pk_bf16_f32 v72, v100, v101
    v_cvt_pk_bf16_f32 v73, v102, v103
    v_cvt_pk_bf16_f32 v74, v104, v105
    v_cvt_pk_bf16_f32 v75, v106, v107
    ds_write_b128 v6, v[72:75] offset:20480
    s_mov_b64 exec, -1
    ds_read_b128 v[88:91], v5 offset:20480
    ds_read_b128 v[92:95], v5 offset:21504
    ds_read_b128 v[80:83], v5 offset:22528
    ds_read_b128 v[84:87], v5 offset:23552
    ds_read_b128 v[112:115], v5 offset:36864
    ds_read_b128 v[116:119], v5 offset:37888
    s_waitcnt lgkmcnt(6)
    s_barrier
    ds_read_b128 v[68:71], v6 offset:20480
    ds_read_b128 v[72:75], v6 offset:21504
    ds_read_b128 v[96:99], v5 offset:38912
    ds_read_b128 v[100:103], v5 offset:39936
    ds_read_b128 v[104:107], v5 offset:53248
    ds_read_b128 v[108:111], v5 offset:54272
    s_waitcnt lgkmcnt(5)
    v_smfmac_f32_16x16x64_bf16 v[32:35], v[68:71], v[128:135], v2
    s_add_u32 s21, s21, 1
    v_smfmac_f32_16x16x64_bf16 v[36:39], v[68:71], v[136:143], v2
    s_xor_b32 s38, s38, 1048576
    v_smfmac_f32_16x16x64_bf16 v[40:43], v[68:71], v[144:151], v2
    s_xor_b32 s37, s37, 1048576
    v_smfmac_f32_16x16x64_bf16 v[44:47], v[68:71], v[152:159], v2
    s_xor_b32 s40, s40, 1048576
    s_waitcnt lgkmcnt(4)
    v_smfmac_f32_16x16x64_bf16 v[32:35], v[72:75], v[160:167], v2
    s_xor_b32 s39, s39, 1048576
    v_smfmac_f32_16x16x64_bf16 v[36:39], v[72:75], v[168:175], v2
    s_lshr_b32 s41, s21, 1
    v_smfmac_f32_16x16x64_bf16 v[40:43], v[72:75], v[176:183], v2
    s_and_b32 s41, s41, 1
    v_smfmac_f32_16x16x64_bf16 v[44:47], v[72:75], v[184:191], v2
    s_xor_b32 s41, s41, 1
    v_smfmac_f32_16x16x64_bf16 v[48:51], v[68:71], v[192:199], v2
    s_xor_b32 s35, s35, 16384
    v_smfmac_f32_16x16x64_bf16 v[52:55], v[68:71], v[200:207], v2
    s_xor_b32 s36, s36, 16384
    s_waitcnt lgkmcnt(0)
    v_smfmac_f32_16x16x64_bf16 v[56:59], v[68:71], v[88:95], v2
    ds_read_b128 v[88:91], v5 offset:55296
    ds_read_b128 v[92:95], v5 offset:56320
    v_smfmac_f32_16x16x64_bf16 v[60:63], v[68:71], v[80:87], v2
    s_add_u32 s43, s43, 262144
    v_smfmac_f32_16x16x64_bf16 v[48:51], v[72:75], v[112:119], v2
    s_add_u32 s44, s44, 262144
    v_add_f32 v32, v32, v34
    v_add_f32 v33, v33, v35
    v_cvt_pk_bf16_f32 v32, v32, v33
    v_and_or_b32 v32, v32, -2, s42
    v_smfmac_f32_16x16x64_bf16 v[52:55], v[72:75], v[96:103], v2
    v_add_f32 v36, v36, v38
    v_add_f32 v37, v37, v39
    v_cvt_pk_bf16_f32 v33, v36, v37
    v_smfmac_f32_16x16x64_bf16 v[56:59], v[72:75], v[104:111], v2
    v_add_f32 v40, v40, v42
    v_add_f32 v41, v41, v43
    v_cvt_pk_bf16_f32 v34, v40, v41
    s_waitcnt lgkmcnt(0)
    v_smfmac_f32_16x16x64_bf16 v[60:63], v[72:75], v[88:95], v2
    v_add_f32 v44, v44, v46
    v_add_f32 v45, v45, v47
    v_cvt_pk_bf16_f32 v35, v44, v45
    buffer_store_dwordx4 v[32:35], v8, s[4:7], s46 offen
    v_pk_add_f32 v[48:49], v[48:49], v[50:51]
    v_cvt_pk_bf16_f32 v48, v48, v49
    v_and_or_b32 v48, v48, -2, s42
    v_pk_add_f32 v[52:53], v[52:53], v[54:55]
    v_cvt_pk_bf16_f32 v49, v52, v53
    v_pk_add_f32 v[56:57], v[56:57], v[58:59]
    v_cvt_pk_bf16_f32 v50, v56, v57
    v_pk_add_f32 v[60:61], v[60:61], v[62:63]
    v_cvt_pk_bf16_f32 v51, v60, v61
    buffer_store_dwordx4 v[48:51], v8, s[4:7], s61 offen
    s_waitcnt vmcnt(4)
    v_mov_b32 v20, v64
    v_mov_b32 v21, v65
    v_mov_b32 v22, v66
    v_mov_b32 v23, v67
    s_add_u32 s45, s45, 131072
    v_mfma_f32_32x32x8_bf16 v[96:111], v[14:15], v[14:15], 0
    v_mfma_f32_16x16x16_bf16 v[112:115], v[14:15], v[14:15], 0
    v_mfma_f32_16x16x16_bf16 v[116:119], v[14:15], v[14:15], 0
    ds_read_b128 v[64:67], v1 offset:4096
    ds_read_b128 v[68:71], v1 offset:5120
    ds_read_b128 v[72:75], v1 offset:6144
    ds_read_b128 v[76:79], v1 offset:7168
    ds_read_b128 v[80:83], v1 offset:20480
    ds_read_b128 v[84:87], v1 offset:21504
    ds_read_b128 v[88:91], v1 offset:22528
    ds_read_b128 v[92:95], v1 offset:23552
    v_mov_b32 v58, -1
    v_mov_b32 v59, -1
    s_nop 15
    s_nop 15
    s_nop 15
mega_kernel_rf_w1_pc:
    buffer_load_dword v36, v13, s[4:7], s47 offen offset:64 sc1
    buffer_load_dword v37, v13, s[4:7], s47 offen offset:1088 sc1
    buffer_load_dword v38, v13, s[4:7], s47 offen offset:2112 sc1
    buffer_load_dword v39, v13, s[4:7], s47 offen offset:3136 sc1
    buffer_load_dword v40, v13, s[4:7], s25 offen offset:64 sc1
    buffer_load_dword v41, v13, s[4:7], s25 offen offset:1088 sc1
    buffer_load_dword v42, v13, s[4:7], s25 offen offset:2112 sc1
    buffer_load_dword v43, v13, s[4:7], s25 offen offset:3136 sc1
    s_waitcnt vmcnt(4)
    v_mfma_f32_16x16x32_bf16 v[52:55], v[36:39], v[24:27], 0
    v_bitop3_b32 v3, s42, v36, v37 bitop3:0x7e
    v_bitop3_b32 v4, s42, v38, v39 bitop3:0x7e
    s_waitcnt vmcnt(2)
    v_or_b32 v3, v3, v4
    v_bitop3_b32 v4, s42, v40, v41 bitop3:0x7e
    s_waitcnt vmcnt(0)
    v_mfma_f32_16x16x32_bf16 v[52:55], v[40:43], v[24:27], v[52:55]
    v_bitop3_b32 v56, s42, v42, v43 bitop3:0x7e
    v_or3_b32 v3, v3, v4, v56
    v_and_b32 v3, v0, v3
    v_cmp_ne_u32 vcc, 0, v3
    s_cbranch_vccnz mega_kernel_rf_w1_pc
    s_nop 2
    v_cvt_pk_bf16_f32 v56, v52, v53
    v_cvt_pk_bf16_f32 v57, v54, v55
    v_min_u32 v56, -2, v56
    s_mov_b64 exec, s[26:27]
    buffer_store_dwordx2 v[56:57], v9, s[4:7], s35 offen offset:64
    buffer_store_dwordx2 v[58:59], v9, s[4:7], s36 offen offset:64
    s_mov_b64 exec, -1
    s_xor_b32 s42, s42, 1
    s_branch mega_kernel_rf_w1_loop
mega_kernel_rf_w1_last:
    s_waitcnt vmcnt(0)
    v_mov_b32 v20, v64
    v_mov_b32 v21, v65
    v_mov_b32 v22, v66
    v_mov_b32 v23, v67
    s_add_u32 s45, s45, 131072
    buffer_store_dwordx4 v[20:23], v10, s[4:7], s45 offen offset:64 sc1
    buffer_store_dwordx2 v[18:19], v11, s[4:7], s45 offen offset:2560 sc1
    s_branch mega_kernel_rf_end
mega_kernel_rf_w1_pafail:
    buffer_load_dwordx4 v[40:43], v12, s[4:7], s22 offen sc1
    buffer_load_dwordx4 v[44:47], v12, s[4:7], s22 offen offset:1024 sc1
    s_nop 7
    v_mov_b32 v96, 0
    v_mov_b32 v97, 0
    v_mov_b32 v98, 0
    v_mov_b32 v99, 0
    v_mov_b32 v100, 0
    v_mov_b32 v101, 0
    v_mov_b32 v102, 0
    v_mov_b32 v103, 0
    v_mov_b32 v104, 0
    v_mov_b32 v105, 0
    v_mov_b32 v106, 0
    v_mov_b32 v107, 0
    s_branch mega_kernel_rf_w1_pa
mega_kernel_rf_w1_xslow:
    buffer_load_dwordx4 v[96:99], v1, s[4:7], s38 offen sc1
    s_waitcnt vmcnt(1)
    v_and_b32 v3, 1, v20
    v_cmp_ne_u32 vcc, s41, v3
    s_cbranch_vccz mega_kernel_rf_w1_xgot1
    buffer_load_dwordx4 v[20:23], v1, s[4:7], s38 offen sc1
mega_kernel_rf_w1_px:
    s_waitcnt vmcnt(1)
    v_and_b32 v3, 1, v96
    v_cmp_ne_u32 vcc, s41, v3
    s_cbranch_vccz mega_kernel_rf_w1_xgot0
    buffer_load_dwordx4 v[96:99], v1, s[4:7], s38 offen sc1
    s_waitcnt vmcnt(1)
    v_and_b32 v3, 1, v20
    v_cmp_ne_u32 vcc, s41, v3
    s_cbranch_vccz mega_kernel_rf_w1_xgot1
    buffer_load_dwordx4 v[20:23], v1, s[4:7], s38 offen sc1
    s_branch mega_kernel_rf_w1_px
mega_kernel_rf_w1_xgot0:
    v_mfma_f32_16x16x16_bf16 v[80:83], v[96:97], v[16:17], v[100:103]
    v_mfma_f32_16x16x16_bf16 v[84:87], v[98:99], v[16:17], v[104:107]
    v_and_b32 v3, 1, v96
    v_cmp_ne_u32 vcc, s41, v3
    s_nop 4
    v_cvt_pk_bf16_f32 v64, v80, v81
    v_cvt_pk_bf16_f32 v65, v82, v83
    v_cvt_pk_bf16_f32 v66, v84, v85
    v_cvt_pk_bf16_f32 v67, v86, v87
    ds_write_b128 v6, v[64:67] offset:11264
    s_branch mega_kernel_rf_w1_xok
mega_kernel_rf_w1_xgot1:
    v_mfma_f32_16x16x16_bf16 v[80:83], v[20:21], v[16:17], v[100:103]
    v_mfma_f32_16x16x16_bf16 v[84:87], v[22:23], v[16:17], v[104:107]
    v_and_b32 v3, 1, v20
    v_cmp_ne_u32 vcc, s41, v3
    s_nop 4
    v_cvt_pk_bf16_f32 v64, v80, v81
    v_cvt_pk_bf16_f32 v65, v82, v83
    v_cvt_pk_bf16_f32 v66, v84, v85
    v_cvt_pk_bf16_f32 v67, v86, v87
    ds_write_b128 v6, v[64:67] offset:11264
    s_branch mega_kernel_rf_w1_xok
mega_kernel_rf_w1_pv0:
    s_waitcnt vmcnt(0)
    s_branch mega_kernel_rf_w1_pv1
mega_kernel_rf_w1_pv:
    buffer_load_dwordx4 v[20:23], v1, s[4:7], s40 offen sc1
    s_waitcnt vmcnt(0)
mega_kernel_rf_w1_pv1:
    v_and_b32 v3, 1, v20
    v_cmp_ne_u32 vcc, s41, v3
    v_pk_add_f32 v[116:117], v[112:113], v[20:21]
    v_pk_add_f32 v[118:119], v[114:115], v[22:23]
    s_cbranch_vccnz mega_kernel_rf_w1_pv
    s_branch mega_kernel_rf_w1_pv2
mega_kernel_rf_w2_entry:
    v_mfma_f32_32x32x8_bf16 v[96:111], v[14:15], v[14:15], 0
    v_mfma_f32_16x16x16_bf16 v[112:115], v[14:15], v[14:15], 0
    v_mfma_f32_16x16x16_bf16 v[116:119], v[14:15], v[14:15], 0
    ds_read_b128 v[64:67], v1 offset:8192
    ds_read_b128 v[68:71], v1 offset:9216
    ds_read_b128 v[72:75], v1 offset:10240
    ds_read_b128 v[76:79], v1 offset:11264
    ds_read_b128 v[80:83], v1 offset:24576
    ds_read_b128 v[84:87], v1 offset:25600
    ds_read_b128 v[88:91], v1 offset:26624
    ds_read_b128 v[92:95], v1 offset:27648
    buffer_load_dwordx4 v[120:123], v1, s[4:7], s44 offen
    buffer_load_dwordx4 v[124:127], v1, s[4:7], s44 offen offset:1024
    s_add_u32 s44, s44, 262144
mega_kernel_rf_w2_loop:
    s_add_u32 s22, s35, 4096
    s_nop 15
    s_nop 15
    s_nop 7
    buffer_load_dwordx4 v[48:51], v12, s[4:7], s22 offen sc1
    buffer_load_dwordx4 v[52:55], v12, s[4:7], s22 offen offset:1024 sc1
mega_kernel_rf_w2_pa:
    s_waitcnt vmcnt(1)
    ds_write_b128 v6, v[48:51] offset:4096
    s_waitcnt vmcnt(0)
    ds_write_b128 v6, v[52:55] offset:5120
    v_max3_u32 v3, v48, v50, v52
    v_max_u32 v3, v3, v54
    v_cmp_eq_u32 vcc, -1, v3
    v_smfmac_f32_16x16x64_bf16 v[96:99], v[48:51], a[64:71], v2
    v_smfmac_f32_16x16x64_bf16 v[100:103], v[48:51], a[72:79], v2
    v_smfmac_f32_16x16x64_bf16 v[104:107], v[48:51], a[192:199], v2
    s_cbranch_vccnz mega_kernel_rf_w2_pafail
    s_waitcnt lgkmcnt(0)
    s_barrier
    ds_read_b128 v[56:59], v6 offset:6144
    ds_read_b128 v[60:63], v6 offset:7168
    v_smfmac_f32_16x16x64_bf16 v[108:111], v[48:51], a[200:207], v2
    ds_read_b128 v[32:35], v6 offset:0
    v_smfmac_f32_16x16x64_bf16 v[96:99], v[52:55], a[80:87], v2
    ds_read_b128 v[36:39], v6 offset:1024
    v_smfmac_f32_16x16x64_bf16 v[100:103], v[52:55], a[88:95], v2
    ds_read_b128 v[40:43], v6 offset:2048
    v_smfmac_f32_16x16x64_bf16 v[104:107], v[52:55], a[208:215], v2
    ds_read_b128 v[44:47], v6 offset:3072
    v_smfmac_f32_16x16x64_bf16 v[108:111], v[52:55], a[216:223], v2
    buffer_load_dwordx4 v1, s[4:7], s43 offen lds
    s_waitcnt lgkmcnt(5)
    v_smfmac_f32_16x16x64_bf16 v[96:99], v[56:59], a[96:103], v2
    v_smfmac_f32_16x16x64_bf16 v[100:103], v[56:59], a[104:111], v2
    v_smfmac_f32_16x16x64_bf16 v[104:107], v[56:59], a[224:231], v2
    v_smfmac_f32_16x16x64_bf16 v[108:111], v[56:59], a[232:239], v2
    buffer_load_dwordx4 v1, s[4:7], s43 offen offset:1024 lds
    s_waitcnt lgkmcnt(4)
    v_smfmac_f32_16x16x64_bf16 v[96:99], v[60:63], a[112:119], v2
    v_smfmac_f32_16x16x64_bf16 v[100:103], v[60:63], a[120:127], v2
    v_smfmac_f32_16x16x64_bf16 v[104:107], v[60:63], a[240:247], v2
    v_smfmac_f32_16x16x64_bf16 v[108:111], v[60:63], a[248:255], v2
    buffer_store_dwordx4 v[20:23], v10, s[4:7], s45 offen offset:128 sc1
    s_waitcnt lgkmcnt(3)
    v_smfmac_f32_16x16x64_bf16 v[96:99], v[32:35], a[0:7], v2
    v_smfmac_f32_16x16x64_bf16 v[100:103], v[32:35], a[8:15], v2
    v_smfmac_f32_16x16x64_bf16 v[104:107], v[32:35], a[128:135], v2
    v_smfmac_f32_16x16x64_bf16 v[108:111], v[32:35], a[136:143], v2
    buffer_store_dwordx2 v[18:19], v11, s[4:7], s45 offen offset:3072 sc1
    s_waitcnt lgkmcnt(2)
    v_smfmac_f32_16x16x64_bf16 v[96:99], v[36:39], a[16:23], v2
    v_smfmac_f32_16x16x64_bf16 v[100:103], v[36:39], a[24:31], v2
    v_smfmac_f32_16x16x64_bf16 v[104:107], v[36:39], a[144:151], v2
    v_smfmac_f32_16x16x64_bf16 v[108:111], v[36:39], a[152:159], v2
    s_waitcnt lgkmcnt(1)
    v_smfmac_f32_16x16x64_bf16 v[96:99], v[40:43], a[32:39], v2
    v_smfmac_f32_16x16x64_bf16 v[100:103], v[40:43], a[40:47], v2
    v_smfmac_f32_16x16x64_bf16 v[104:107], v[40:43], a[160:167], v2
    v_smfmac_f32_16x16x64_bf16 v[108:111], v[40:43], a[168:175], v2
    s_waitcnt lgkmcnt(0)
    v_smfmac_f32_16x16x64_bf16 v[96:99], v[44:47], a[48:55], v2
    v_smfmac_f32_16x16x64_bf16 v[100:103], v[44:47], a[56:63], v2
    v_smfmac_f32_16x16x64_bf16 v[104:107], v[44:47], a[176:183], v2
    v_smfmac_f32_16x16x64_bf16 v[108:111], v[44:47], a[184:191], v2
    s_nop 4
    v_pk_add_f32 v[96:97], v[96:97], v[98:99]
    v_pk_add_f32 v[100:101], v[100:101], v[102:103]
    v_pk_add_f32 v[104:105], v[104:105], v[106:107]
    v_pk_add_f32 v[108:109], v[108:109], v[110:111]
    v_cvt_pk_bf16_f32 v111, v108, v109
    v_cvt_pk_bf16_f32 v108, v96, v97
    v_cvt_pk_bf16_f32 v110, v100, v101
    v_cvt_pk_bf16_f32 v109, v104, v105
    v_and_or_b32 v108, v108, -2, s41
    buffer_store_dwordx4 v[108:111], v1, s[4:7], s37 offen sc1
    v_smfmac_f32_16x16x64_bf16 v[112:115], v[32:35], v[64:71], v2
    ds_read_b128 v[64:67], v1 offset:40960
    ds_read_b128 v[68:71], v1 offset:41984
    v_smfmac_f32_16x16x64_bf16 v[116:119], v[32:35], v[72:79], v2
    ds_read_b128 v[72:75], v1 offset:43008
    ds_read_b128 v[76:79], v1 offset:44032
    v_smfmac_f32_16x16x64_bf16 v[112:115], v[36:39], v[80:87], v2
    ds_read_b128 v[80:83], v1 offset:57344
    ds_read_b128 v[84:87], v1 offset:58368
    v_smfmac_f32_16x16x64_bf16 v[116:119], v[36:39], v[88:95], v2
    ds_read_b128 v[88:91], v1 offset:59392
    ds_read_b128 v[92:95], v1 offset:60416
    v_smfmac_f32_16x16x64_bf16 v[112:115], v[52:55], v[208:215], v2
    v_smfmac_f32_16x16x64_bf16 v[116:119], v[52:55], v[216:223], v2
    v_smfmac_f32_16x16x64_bf16 v[112:115], v[56:59], v[224:231], v2
    s_waitcnt lgkmcnt(6)
    v_smfmac_f32_16x16x64_bf16 v[112:115], v[40:43], v[64:71], v2
    ds_read_b128 v[64:67], v5 offset:8192
    ds_read_b128 v[68:71], v5 offset:9216
    s_waitcnt lgkmcnt(6)
    v_smfmac_f32_16x16x64_bf16 v[116:119], v[40:43], v[72:79], v2
    ds_read_b128 v[72:75], v5 offset:10240
    ds_read_b128 v[76:79], v5 offset:11264
    v_smfmac_f32_16x16x64_bf16 v[116:119], v[56:59], v[232:239], v2
    v_smfmac_f32_16x16x64_bf16 v[112:115], v[60:63], v[240:247], v2
    v_smfmac_f32_16x16x64_bf16 v[116:119], v[60:63], v[248:255], v2
    s_waitcnt lgkmcnt(6)
    v_smfmac_f32_16x16x64_bf16 v[112:115], v[44:47], v[80:87], v2
    s_waitcnt lgkmcnt(4)
    v_smfmac_f32_16x16x64_bf16 v[116:119], v[44:47], v[88:95], v2
    s_waitcnt lgkmcnt(2)
    v_smfmac_f32_16x16x64_bf16 v[112:115], v[48:51], v[64:71], v2
    s_waitcnt lgkmcnt(0)
    v_smfmac_f32_16x16x64_bf16 v[116:119], v[48:51], v[72:79], v2
    v_mfma_f32_16x16x16_bf16 v[100:103], v[108:109], v[16:17], 0
    v_mfma_f32_16x16x16_bf16 v[104:107], v[110:111], v[16:17], 0
    s_nop 4
    v_add_f32 v112, v112, v114
    v_add_f32 v113, v113, v115
    v_add_f32 v114, v116, v118
    v_add_f32 v115, v117, v119
    v_and_or_b32 v112, v112, -2, s41
    s_waitcnt vmcnt(3)
    s_barrier
    ds_read_b128 v[32:35], v6 offset:15360
    ds_read_b128 v[36:39], v6 offset:16384
    ds_read_b128 v[40:43], v6 offset:18432
    ds_read_b128 v[44:47], v6 offset:19456
    ds_read_b128 v[48:51], v6 offset:9216
    ds_read_b128 v[52:55], v6 offset:10240
    ds_read_b128 v[56:59], v6 offset:12288
    ds_read_b128 v[60:63], v6 offset:13312
    buffer_load_dwordx4 v[96:99], v1, s[4:7], s38 offen sc1
    s_barrier
    buffer_store_dwordx4 v[112:115], v1, s[4:7], s39 offen sc1
    s_nop 15
    s_nop 15
    buffer_load_dwordx4 v[20:23], v1, s[4:7], s38 offen sc1
    s_waitcnt vmcnt(2)
    v_mfma_f32_16x16x16_bf16 v[80:83], v[96:97], v[16:17], v[100:103]
    v_mfma_f32_16x16x16_bf16 v[84:87], v[98:99], v[16:17], v[104:107]
    v_and_b32 v3, 1, v96
    v_cmp_ne_u32 vcc, s41, v3
    s_nop 4
    v_cvt_pk_bf16_f32 v64, v80, v81
    v_cvt_pk_bf16_f32 v65, v82, v83
    v_cvt_pk_bf16_f32 v66, v84, v85
    v_cvt_pk_bf16_f32 v67, v86, v87
    ds_write_b128 v6, v[64:67] offset:14336
    s_cbranch_vccnz mega_kernel_rf_w2_xslow
mega_kernel_rf_w2_xok:
    buffer_load_dwordx4 v[116:119], v1, s[4:7], s40 offen sc1
    s_waitcnt lgkmcnt(1)
    v_mfma_f32_16x16x32_bf16 v[80:83], v[32:35], v[64:67], 0
    s_waitcnt lgkmcnt(0)
    s_barrier
    ds_read_b128 v[68:71], v6 offset:17408
    ds_read_b128 v[72:75], v6 offset:8192
    ds_read_b128 v[76:79], v6 offset:11264
    v_mfma_f32_16x16x32_bf16 v[84:87], v[36:39], v[64:67], 0
    v_mfma_f32_16x16x32_bf16 v[88:91], v[64:67], v[64:67], 0
    buffer_load_dwordx4 v[20:23], v1, s[4:7], s40 offen sc1
    s_waitcnt lgkmcnt(2)
    v_mfma_f32_16x16x32_bf16 v[80:83], v[40:43], v[68:71], v[80:83]
    v_mfma_f32_16x16x32_bf16 v[84:87], v[44:47], v[68:71], v[84:87]
    v_mfma_f32_16x16x32_bf16 v[88:91], v[68:71], v[68:71], v[88:91]
    s_waitcnt lgkmcnt(1)
    v_mfma_f32_16x16x32_bf16 v[80:83], v[48:51], v[72:75], v[80:83]
    v_mfma_f32_16x16x32_bf16 v[84:87], v[52:55], v[72:75], v[84:87]
    v_mfma_f32_16x16x32_bf16 v[88:91], v[72:75], v[72:75], v[88:91]
    s_waitcnt lgkmcnt(0)
    v_mfma_f32_16x16x32_bf16 v[80:83], v[56:59], v[76:79], v[80:83]
    v_mfma_f32_16x16x32_bf16 v[84:87], v[60:63], v[76:79], v[84:87]
    v_mfma_f32_16x16x32_bf16 v[88:91], v[76:79], v[76:79], v[88:91]
    v_mfma_f32_32x32x4_2b_bf16 v[32:63], v[14:15], v[14:15], 0
    s_nop 4
    v_max3_f32 v4, v80, v81, v82
    v_max3_f32 v4, v4, v83, v84
    v_max3_f32 v4, v4, v85, v86
    v_max3_f32 v4, v4, v87, v88
    v_max_f32 v90, v4, v89
    v_max_f32 v4, v4, v89
    v_mov_b32 v73, 0
    s_nop 0
    v_permlane16_swap_b32 v4, v90
    v_max_f32 v4, v4, v90
    v_max_f32 v90, v4, v90
    s_nop 1
    v_permlane32_swap_b32 v4, v90
    v_max_f32 v4, v4, v90
    v_mul_f32 v4, s34, v4
    v_pk_fma_f32 v[80:81], v[80:81], s[34:35], v[4:5] op_sel_hi:[1,0,0] neg_lo:[0,0,1] neg_hi:[0,0,1]
    v_pk_fma_f32 v[82:83], v[82:83], s[34:35], v[4:5] op_sel_hi:[1,0,0] neg_lo:[0,0,1] neg_hi:[0,0,1]
    v_pk_fma_f32 v[84:85], v[84:85], s[34:35], v[4:5] op_sel_hi:[1,0,0] neg_lo:[0,0,1] neg_hi:[0,0,1]
    v_pk_fma_f32 v[86:87], v[86:87], s[34:35], v[4:5] op_sel_hi:[1,0,0] neg_lo:[0,0,1] neg_hi:[0,0,1]
    v_pk_fma_f32 v[88:89], v[88:89], s[34:35], v[4:5] op_sel_hi:[1,0,0] neg_lo:[0,0,1] neg_hi:[0,0,1]
    v_exp_f32 v80, v80
    v_exp_f32 v81, v81
    v_exp_f32 v82, v82
    v_cvt_pk_bf16_f32 v68, v80, v81
    v_exp_f32 v83, v83
    v_exp_f32 v84, v84
    v_cvt_pk_bf16_f32 v69, v82, v83
    v_exp_f32 v85, v85
    v_exp_f32 v86, v86
    v_cvt_pk_bf16_f32 v70, v84, v85
    v_exp_f32 v87, v87
    v_exp_f32 v88, v88
    v_cvt_pk_bf16_f32 v71, v86, v87
    v_exp_f32 v89, v89
    s_cmp_eq_u32 s21, 63
    v_mfma_f32_16x16x32_bf16 v[76:79], v[28:31], v[68:71], 0
    v_cvt_pk_bf16_f32 v72, v88, v89
    s_waitcnt vmcnt(1)
    v_and_b32 v3, 1, v116
    v_mfma_f32_16x16x32_bf16 v[100:103], v[120:123], v[68:71], 0
    v_cmp_ne_u32 vcc, s41, v3
    v_add_f32 v116, v112, v116
    v_mfma_f32_16x16x32_bf16 v[104:107], v[124:127], v[68:71], 0
    v_add_f32 v117, v113, v117
    v_add_f32 v118, v114, v118
    v_mfma_f32_16x16x16_bf16 v[76:79], v[28:29], v[72:73], v[76:79]
    v_add_f32 v119, v115, v119
    s_cbranch_vccnz mega_kernel_rf_w2_pv0
mega_kernel_rf_w2_pv2:
    v_cvt_pk_bf16_f32 v18, v116, v117
    v_cvt_pk_bf16_f32 v19, v118, v119
    v_cvt_pk_bf16_f32 v98, v118, v119
    v_mov_b32 v99, 0
    v_mfma_f32_16x16x16_bf16 v[100:103], v[18:19], v[72:73], v[100:103]
    s_nop 0
    v_mfma_f32_16x16x16_bf16 v[104:107], v[98:99], v[72:73], v[104:107]
    buffer_load_dwordx4 v[120:123], v1, s[4:7], s44 offen
    buffer_load_dwordx4 v[124:127], v1, s[4:7], s44 offen offset:1024
    s_cmp_eq_u32 s21, 63
    v_rcp_f32 v76, v76
    s_cbranch_scc1 mega_kernel_rf_w2_last
    s_mov_b64 exec, s[28:29]
    v_pk_mul_f32 v[100:101], v[100:101], v[76:77] op_sel_hi:[1,0]
    v_pk_mul_f32 v[102:103], v[102:103], v[76:77] op_sel_hi:[1,0]
    v_pk_mul_f32 v[104:105], v[104:105], v[76:77] op_sel_hi:[1,0]
    v_pk_mul_f32 v[106:107], v[106:107], v[76:77] op_sel_hi:[1,0]
    v_cvt_pk_bf16_f32 v72, v100, v101
    v_cvt_pk_bf16_f32 v73, v102, v103
    v_cvt_pk_bf16_f32 v74, v104, v105
    v_cvt_pk_bf16_f32 v75, v106, v107
    ds_write_b128 v6, v[72:75] offset:21472
    s_mov_b64 exec, -1
    ds_read_b128 v[88:91], v5 offset:24576
    ds_read_b128 v[92:95], v5 offset:25600
    ds_read_b128 v[80:83], v5 offset:26624
    ds_read_b128 v[84:87], v5 offset:27648
    ds_read_b128 v[112:115], v5 offset:40960
    ds_read_b128 v[116:119], v5 offset:41984
    s_waitcnt lgkmcnt(6)
    s_barrier
    ds_read_b128 v[68:71], v6 offset:20480
    ds_read_b128 v[72:75], v6 offset:21504
    ds_read_b128 v[96:99], v5 offset:43008
    ds_read_b128 v[100:103], v5 offset:44032
    ds_read_b128 v[104:107], v5 offset:57344
    ds_read_b128 v[108:111], v5 offset:58368
    s_waitcnt lgkmcnt(5)
    v_smfmac_f32_16x16x64_bf16 v[32:35], v[68:71], v[128:135], v2
    s_add_u32 s21, s21, 1
    v_smfmac_f32_16x16x64_bf16 v[36:39], v[68:71], v[136:143], v2
    s_xor_b32 s38, s38, 1048576
    v_smfmac_f32_16x16x64_bf16 v[40:43], v[68:71], v[144:151], v2
    s_xor_b32 s37, s37, 1048576
    v_smfmac_f32_16x16x64_bf16 v[44:47], v[68:71], v[152:159], v2
    s_xor_b32 s40, s40, 1048576
    s_waitcnt lgkmcnt(4)
    v_smfmac_f32_16x16x64_bf16 v[32:35], v[72:75], v[160:167], v2
    s_xor_b32 s39, s39, 1048576
    v_smfmac_f32_16x16x64_bf16 v[36:39], v[72:75], v[168:175], v2
    s_lshr_b32 s41, s21, 1
    v_smfmac_f32_16x16x64_bf16 v[40:43], v[72:75], v[176:183], v2
    s_and_b32 s41, s41, 1
    v_smfmac_f32_16x16x64_bf16 v[44:47], v[72:75], v[184:191], v2
    s_xor_b32 s41, s41, 1
    v_smfmac_f32_16x16x64_bf16 v[48:51], v[68:71], v[192:199], v2
    s_xor_b32 s35, s35, 16384
    v_smfmac_f32_16x16x64_bf16 v[52:55], v[68:71], v[200:207], v2
    s_xor_b32 s36, s36, 16384
    s_waitcnt lgkmcnt(0)
    v_smfmac_f32_16x16x64_bf16 v[56:59], v[68:71], v[88:95], v2
    ds_read_b128 v[88:91], v5 offset:59392
    ds_read_b128 v[92:95], v5 offset:60416
    v_smfmac_f32_16x16x64_bf16 v[60:63], v[68:71], v[80:87], v2
    s_add_u32 s43, s43, 262144
    v_smfmac_f32_16x16x64_bf16 v[48:51], v[72:75], v[112:119], v2
    s_add_u32 s44, s44, 262144
    v_add_f32 v32, v32, v34
    v_add_f32 v33, v33, v35
    v_cvt_pk_bf16_f32 v32, v32, v33
    v_and_or_b32 v32, v32, -2, s42
    v_smfmac_f32_16x16x64_bf16 v[52:55], v[72:75], v[96:103], v2
    v_add_f32 v36, v36, v38
    v_add_f32 v37, v37, v39
    v_cvt_pk_bf16_f32 v33, v36, v37
    v_smfmac_f32_16x16x64_bf16 v[56:59], v[72:75], v[104:111], v2
    v_add_f32 v40, v40, v42
    v_add_f32 v41, v41, v43
    v_cvt_pk_bf16_f32 v34, v40, v41
    s_waitcnt lgkmcnt(0)
    v_smfmac_f32_16x16x64_bf16 v[60:63], v[72:75], v[88:95], v2
    v_add_f32 v44, v44, v46
    v_add_f32 v45, v45, v47
    v_cvt_pk_bf16_f32 v35, v44, v45
    buffer_store_dwordx4 v[32:35], v8, s[4:7], s46 offen
    v_pk_add_f32 v[48:49], v[48:49], v[50:51]
    v_cvt_pk_bf16_f32 v48, v48, v49
    v_and_or_b32 v48, v48, -2, s42
    v_pk_add_f32 v[52:53], v[52:53], v[54:55]
    v_cvt_pk_bf16_f32 v49, v52, v53
    v_pk_add_f32 v[56:57], v[56:57], v[58:59]
    v_cvt_pk_bf16_f32 v50, v56, v57
    v_pk_add_f32 v[60:61], v[60:61], v[62:63]
    v_cvt_pk_bf16_f32 v51, v60, v61
    buffer_store_dwordx4 v[48:51], v8, s[4:7], s61 offen
    s_waitcnt vmcnt(4)
    v_mov_b32 v20, v64
    v_mov_b32 v21, v65
    v_mov_b32 v22, v66
    v_mov_b32 v23, v67
    s_add_u32 s45, s45, 131072
    v_mfma_f32_32x32x8_bf16 v[96:111], v[14:15], v[14:15], 0
    v_mfma_f32_16x16x16_bf16 v[112:115], v[14:15], v[14:15], 0
    v_mfma_f32_16x16x16_bf16 v[116:119], v[14:15], v[14:15], 0
    ds_read_b128 v[64:67], v1 offset:8192
    ds_read_b128 v[68:71], v1 offset:9216
    ds_read_b128 v[72:75], v1 offset:10240
    ds_read_b128 v[76:79], v1 offset:11264
    ds_read_b128 v[80:83], v1 offset:24576
    ds_read_b128 v[84:87], v1 offset:25600
    ds_read_b128 v[88:91], v1 offset:26624
    ds_read_b128 v[92:95], v1 offset:27648
    v_mov_b32 v58, -1
    v_mov_b32 v59, -1
    s_nop 15
    s_nop 15
    s_nop 15
mega_kernel_rf_w2_pc:
    buffer_load_dword v36, v13, s[4:7], s47 offen offset:128 sc1
    buffer_load_dword v37, v13, s[4:7], s47 offen offset:1152 sc1
    buffer_load_dword v38, v13, s[4:7], s47 offen offset:2176 sc1
    buffer_load_dword v39, v13, s[4:7], s47 offen offset:3200 sc1
    buffer_load_dword v40, v13, s[4:7], s25 offen offset:128 sc1
    buffer_load_dword v41, v13, s[4:7], s25 offen offset:1152 sc1
    buffer_load_dword v42, v13, s[4:7], s25 offen offset:2176 sc1
    buffer_load_dword v43, v13, s[4:7], s25 offen offset:3200 sc1
    s_waitcnt vmcnt(4)
    v_mfma_f32_16x16x32_bf16 v[52:55], v[36:39], v[24:27], 0
    v_bitop3_b32 v3, s42, v36, v37 bitop3:0x7e
    v_bitop3_b32 v4, s42, v38, v39 bitop3:0x7e
    s_waitcnt vmcnt(2)
    v_or_b32 v3, v3, v4
    v_bitop3_b32 v4, s42, v40, v41 bitop3:0x7e
    s_waitcnt vmcnt(0)
    v_mfma_f32_16x16x32_bf16 v[52:55], v[40:43], v[24:27], v[52:55]
    v_bitop3_b32 v56, s42, v42, v43 bitop3:0x7e
    v_or3_b32 v3, v3, v4, v56
    v_and_b32 v3, v0, v3
    v_cmp_ne_u32 vcc, 0, v3
    s_cbranch_vccnz mega_kernel_rf_w2_pc
    s_nop 2
    v_cvt_pk_bf16_f32 v56, v52, v53
    v_cvt_pk_bf16_f32 v57, v54, v55
    v_min_u32 v56, -2, v56
    s_mov_b64 exec, s[26:27]
    buffer_store_dwordx2 v[56:57], v9, s[4:7], s35 offen offset:128
    buffer_store_dwordx2 v[58:59], v9, s[4:7], s36 offen offset:128
    s_mov_b64 exec, -1
    s_xor_b32 s42, s42, 1
    s_branch mega_kernel_rf_w2_loop
mega_kernel_rf_w2_last:
    s_waitcnt vmcnt(0)
    v_mov_b32 v20, v64
    v_mov_b32 v21, v65
    v_mov_b32 v22, v66
    v_mov_b32 v23, v67
    s_add_u32 s45, s45, 131072
    buffer_store_dwordx4 v[20:23], v10, s[4:7], s45 offen offset:128 sc1
    buffer_store_dwordx2 v[18:19], v11, s[4:7], s45 offen offset:3072 sc1
    s_branch mega_kernel_rf_end
mega_kernel_rf_w2_pafail:
    buffer_load_dwordx4 v[48:51], v12, s[4:7], s22 offen sc1
    buffer_load_dwordx4 v[52:55], v12, s[4:7], s22 offen offset:1024 sc1
    s_nop 7
    v_mov_b32 v96, 0
    v_mov_b32 v97, 0
    v_mov_b32 v98, 0
    v_mov_b32 v99, 0
    v_mov_b32 v100, 0
    v_mov_b32 v101, 0
    v_mov_b32 v102, 0
    v_mov_b32 v103, 0
    v_mov_b32 v104, 0
    v_mov_b32 v105, 0
    v_mov_b32 v106, 0
    v_mov_b32 v107, 0
    s_branch mega_kernel_rf_w2_pa
mega_kernel_rf_w2_xslow:
    buffer_load_dwordx4 v[96:99], v1, s[4:7], s38 offen sc1
    s_waitcnt vmcnt(1)
    v_and_b32 v3, 1, v20
    v_cmp_ne_u32 vcc, s41, v3
    s_cbranch_vccz mega_kernel_rf_w2_xgot1
    buffer_load_dwordx4 v[20:23], v1, s[4:7], s38 offen sc1
mega_kernel_rf_w2_px:
    s_waitcnt vmcnt(1)
    v_and_b32 v3, 1, v96
    v_cmp_ne_u32 vcc, s41, v3
    s_cbranch_vccz mega_kernel_rf_w2_xgot0
    buffer_load_dwordx4 v[96:99], v1, s[4:7], s38 offen sc1
    s_waitcnt vmcnt(1)
    v_and_b32 v3, 1, v20
    v_cmp_ne_u32 vcc, s41, v3
    s_cbranch_vccz mega_kernel_rf_w2_xgot1
    buffer_load_dwordx4 v[20:23], v1, s[4:7], s38 offen sc1
    s_branch mega_kernel_rf_w2_px
mega_kernel_rf_w2_xgot0:
    v_mfma_f32_16x16x16_bf16 v[80:83], v[96:97], v[16:17], v[100:103]
    v_mfma_f32_16x16x16_bf16 v[84:87], v[98:99], v[16:17], v[104:107]
    v_and_b32 v3, 1, v96
    v_cmp_ne_u32 vcc, s41, v3
    s_nop 4
    v_cvt_pk_bf16_f32 v64, v80, v81
    v_cvt_pk_bf16_f32 v65, v82, v83
    v_cvt_pk_bf16_f32 v66, v84, v85
    v_cvt_pk_bf16_f32 v67, v86, v87
    ds_write_b128 v6, v[64:67] offset:14336
    s_branch mega_kernel_rf_w2_xok
mega_kernel_rf_w2_xgot1:
    v_mfma_f32_16x16x16_bf16 v[80:83], v[20:21], v[16:17], v[100:103]
    v_mfma_f32_16x16x16_bf16 v[84:87], v[22:23], v[16:17], v[104:107]
    v_and_b32 v3, 1, v20
    v_cmp_ne_u32 vcc, s41, v3
    s_nop 4
    v_cvt_pk_bf16_f32 v64, v80, v81
    v_cvt_pk_bf16_f32 v65, v82, v83
    v_cvt_pk_bf16_f32 v66, v84, v85
    v_cvt_pk_bf16_f32 v67, v86, v87
    ds_write_b128 v6, v[64:67] offset:14336
    s_branch mega_kernel_rf_w2_xok
mega_kernel_rf_w2_pv0:
    s_waitcnt vmcnt(0)
    s_branch mega_kernel_rf_w2_pv1
mega_kernel_rf_w2_pv:
    buffer_load_dwordx4 v[20:23], v1, s[4:7], s40 offen sc1
    s_waitcnt vmcnt(0)
mega_kernel_rf_w2_pv1:
    v_and_b32 v3, 1, v20
    v_cmp_ne_u32 vcc, s41, v3
    v_pk_add_f32 v[116:117], v[112:113], v[20:21]
    v_pk_add_f32 v[118:119], v[114:115], v[22:23]
    s_cbranch_vccnz mega_kernel_rf_w2_pv
    s_branch mega_kernel_rf_w2_pv2
mega_kernel_rf_w3_entry:
    v_mfma_f32_32x32x8_bf16 v[96:111], v[14:15], v[14:15], 0
    v_mfma_f32_16x16x16_bf16 v[112:115], v[14:15], v[14:15], 0
    v_mfma_f32_16x16x16_bf16 v[116:119], v[14:15], v[14:15], 0
    ds_read_b128 v[64:67], v1 offset:12288
    ds_read_b128 v[68:71], v1 offset:13312
    ds_read_b128 v[72:75], v1 offset:14336
    ds_read_b128 v[76:79], v1 offset:15360
    ds_read_b128 v[80:83], v1 offset:28672
    ds_read_b128 v[84:87], v1 offset:29696
    ds_read_b128 v[88:91], v1 offset:30720
    ds_read_b128 v[92:95], v1 offset:31744
    buffer_load_dwordx4 v[120:123], v1, s[4:7], s44 offen
    buffer_load_dwordx4 v[124:127], v1, s[4:7], s44 offen offset:1024
    s_add_u32 s44, s44, 262144
mega_kernel_rf_w3_loop:
    s_add_u32 s22, s35, 6144
    s_nop 15
    s_nop 15
    s_nop 7
    buffer_load_dwordx4 v[56:59], v12, s[4:7], s22 offen sc1
    buffer_load_dwordx4 v[60:63], v12, s[4:7], s22 offen offset:1024 sc1
mega_kernel_rf_w3_pa:
    s_waitcnt vmcnt(1)
    ds_write_b128 v6, v[56:59] offset:6144
    s_waitcnt vmcnt(0)
    ds_write_b128 v6, v[60:63] offset:7168
    v_max3_u32 v3, v56, v58, v60
    v_max_u32 v3, v3, v62
    v_cmp_eq_u32 vcc, -1, v3
    v_smfmac_f32_16x16x64_bf16 v[96:99], v[56:59], a[96:103], v2
    v_smfmac_f32_16x16x64_bf16 v[100:103], v[56:59], a[104:111], v2
    v_smfmac_f32_16x16x64_bf16 v[104:107], v[56:59], a[224:231], v2
    s_cbranch_vccnz mega_kernel_rf_w3_pafail
    s_waitcnt lgkmcnt(0)
    s_barrier
    ds_read_b128 v[32:35], v6 offset:0
    ds_read_b128 v[36:39], v6 offset:1024
    v_smfmac_f32_16x16x64_bf16 v[108:111], v[56:59], a[232:239], v2
    ds_read_b128 v[40:43], v6 offset:2048
    v_smfmac_f32_16x16x64_bf16 v[96:99], v[60:63], a[112:119], v2
    ds_read_b128 v[44:47], v6 offset:3072
    v_smfmac_f32_16x16x64_bf16 v[100:103], v[60:63], a[120:127], v2
    ds_read_b128 v[48:51], v6 offset:4096
    v_smfmac_f32_16x16x64_bf16 v[104:107], v[60:63], a[240:247], v2
    ds_read_b128 v[52:55], v6 offset:5120
    v_smfmac_f32_16x16x64_bf16 v[108:111], v[60:63], a[248:255], v2
    buffer_load_dwordx4 v1, s[4:7], s43 offen lds
    s_waitcnt lgkmcnt(5)
    v_smfmac_f32_16x16x64_bf16 v[96:99], v[32:35], a[0:7], v2
    v_smfmac_f32_16x16x64_bf16 v[100:103], v[32:35], a[8:15], v2
    v_smfmac_f32_16x16x64_bf16 v[104:107], v[32:35], a[128:135], v2
    v_smfmac_f32_16x16x64_bf16 v[108:111], v[32:35], a[136:143], v2
    buffer_load_dwordx4 v1, s[4:7], s43 offen offset:1024 lds
    s_waitcnt lgkmcnt(4)
    v_smfmac_f32_16x16x64_bf16 v[96:99], v[36:39], a[16:23], v2
    v_smfmac_f32_16x16x64_bf16 v[100:103], v[36:39], a[24:31], v2
    v_smfmac_f32_16x16x64_bf16 v[104:107], v[36:39], a[144:151], v2
    v_smfmac_f32_16x16x64_bf16 v[108:111], v[36:39], a[152:159], v2
    buffer_store_dwordx4 v[20:23], v10, s[4:7], s45 offen offset:192 sc1
    s_waitcnt lgkmcnt(3)
    v_smfmac_f32_16x16x64_bf16 v[96:99], v[40:43], a[32:39], v2
    v_smfmac_f32_16x16x64_bf16 v[100:103], v[40:43], a[40:47], v2
    v_smfmac_f32_16x16x64_bf16 v[104:107], v[40:43], a[160:167], v2
    v_smfmac_f32_16x16x64_bf16 v[108:111], v[40:43], a[168:175], v2
    buffer_store_dwordx2 v[18:19], v11, s[4:7], s45 offen offset:3584 sc1
    s_waitcnt lgkmcnt(2)
    v_smfmac_f32_16x16x64_bf16 v[96:99], v[44:47], a[48:55], v2
    v_smfmac_f32_16x16x64_bf16 v[100:103], v[44:47], a[56:63], v2
    v_smfmac_f32_16x16x64_bf16 v[104:107], v[44:47], a[176:183], v2
    v_smfmac_f32_16x16x64_bf16 v[108:111], v[44:47], a[184:191], v2
    buffer_load_dword v4, v7, s[4:7], 0 offen sc1
    s_waitcnt lgkmcnt(1)
    v_smfmac_f32_16x16x64_bf16 v[96:99], v[48:51], a[64:71], v2
    v_smfmac_f32_16x16x64_bf16 v[100:103], v[48:51], a[72:79], v2
    v_smfmac_f32_16x16x64_bf16 v[104:107], v[48:51], a[192:199], v2
    v_smfmac_f32_16x16x64_bf16 v[108:111], v[48:51], a[200:207], v2
    s_waitcnt lgkmcnt(0)
    v_smfmac_f32_16x16x64_bf16 v[96:99], v[52:55], a[80:87], v2
    v_smfmac_f32_16x16x64_bf16 v[100:103], v[52:55], a[88:95], v2
    v_smfmac_f32_16x16x64_bf16 v[104:107], v[52:55], a[208:215], v2
    v_smfmac_f32_16x16x64_bf16 v[108:111], v[52:55], a[216:223], v2
    s_nop 4
    v_pk_add_f32 v[96:97], v[96:97], v[98:99]
    v_pk_add_f32 v[100:101], v[100:101], v[102:103]
    v_pk_add_f32 v[104:105], v[104:105], v[106:107]
    v_pk_add_f32 v[108:109], v[108:109], v[110:111]
    v_cvt_pk_bf16_f32 v111, v108, v109
    v_cvt_pk_bf16_f32 v108, v96, v97
    v_cvt_pk_bf16_f32 v110, v100, v101
    v_cvt_pk_bf16_f32 v109, v104, v105
    v_and_or_b32 v108, v108, -2, s41
    buffer_store_dwordx4 v[108:111], v1, s[4:7], s37 offen sc1
    v_smfmac_f32_16x16x64_bf16 v[112:115], v[32:35], v[64:71], v2
    ds_read_b128 v[64:67], v1 offset:45056
    ds_read_b128 v[68:71], v1 offset:46080
    v_smfmac_f32_16x16x64_bf16 v[116:119], v[32:35], v[72:79], v2
    ds_read_b128 v[72:75], v1 offset:47104
    ds_read_b128 v[76:79], v1 offset:48128
    v_smfmac_f32_16x16x64_bf16 v[112:115], v[36:39], v[80:87], v2
    ds_read_b128 v[80:83], v1 offset:61440
    ds_read_b128 v[84:87], v1 offset:62464
    v_smfmac_f32_16x16x64_bf16 v[116:119], v[36:39], v[88:95], v2
    ds_read_b128 v[88:91], v1 offset:63488
    ds_read_b128 v[92:95], v1 offset:64512
    v_smfmac_f32_16x16x64_bf16 v[112:115], v[52:55], v[208:215], v2
    v_smfmac_f32_16x16x64_bf16 v[116:119], v[52:55], v[216:223], v2
    v_smfmac_f32_16x16x64_bf16 v[112:115], v[56:59], v[224:231], v2
    s_waitcnt lgkmcnt(6)
    v_smfmac_f32_16x16x64_bf16 v[112:115], v[40:43], v[64:71], v2
    ds_read_b128 v[64:67], v5 offset:12288
    ds_read_b128 v[68:71], v5 offset:13312
    s_waitcnt lgkmcnt(6)
    v_smfmac_f32_16x16x64_bf16 v[116:119], v[40:43], v[72:79], v2
    ds_read_b128 v[72:75], v5 offset:14336
    ds_read_b128 v[76:79], v5 offset:15360
    v_smfmac_f32_16x16x64_bf16 v[116:119], v[56:59], v[232:239], v2
    v_smfmac_f32_16x16x64_bf16 v[112:115], v[60:63], v[240:247], v2
    v_smfmac_f32_16x16x64_bf16 v[116:119], v[60:63], v[248:255], v2
    s_waitcnt lgkmcnt(6)
    v_smfmac_f32_16x16x64_bf16 v[112:115], v[44:47], v[80:87], v2
    s_waitcnt lgkmcnt(4)
    v_smfmac_f32_16x16x64_bf16 v[116:119], v[44:47], v[88:95], v2
    s_waitcnt lgkmcnt(2)
    v_smfmac_f32_16x16x64_bf16 v[112:115], v[48:51], v[64:71], v2
    s_waitcnt lgkmcnt(0)
    v_smfmac_f32_16x16x64_bf16 v[116:119], v[48:51], v[72:79], v2
    v_mfma_f32_16x16x16_bf16 v[100:103], v[108:109], v[16:17], 0
    v_mfma_f32_16x16x16_bf16 v[104:107], v[110:111], v[16:17], 0
    s_nop 4
    v_add_f32 v112, v112, v114
    v_add_f32 v113, v113, v115
    v_add_f32 v114, v116, v118
    v_add_f32 v115, v117, v119
    v_and_or_b32 v112, v112, -2, s41
    s_waitcnt vmcnt(4)
    s_barrier
    ds_read_b128 v[32:35], v6 offset:18432
    ds_read_b128 v[36:39], v6 offset:19456
    ds_read_b128 v[40:43], v6 offset:15360
    ds_read_b128 v[44:47], v6 offset:16384
    ds_read_b128 v[48:51], v6 offset:12288
    ds_read_b128 v[52:55], v6 offset:13312
    ds_read_b128 v[56:59], v6 offset:9216
    ds_read_b128 v[60:63], v6 offset:10240
    buffer_load_dwordx4 v[96:99], v1, s[4:7], s38 offen sc1
    s_barrier
    buffer_store_dwordx4 v[112:115], v1, s[4:7], s39 offen sc1
    s_nop 15
    s_nop 15
    buffer_load_dwordx4 v[20:23], v1, s[4:7], s38 offen sc1
    s_add_u32 s22, s21, 4
    s_cmp_gt_u32 s50, s22
    s_cbranch_scc1 mega_kernel_rf_w3_kvs
    s_waitcnt vmcnt(4)
    v_readlane_b32 s50, v4, 0
    v_readlane_b32 s22, v4, 2
    v_readlane_b32 s23, v4, 1
    v_readlane_b32 s24, v4, 3
    s_nop 3
    s_min_u32 s50, s50, s22
    s_min_u32 s23, s23, s24
    s_lshl_b32 s50, s50, 1
    s_lshl_b32 s23, s23, 1
    s_add_u32 s23, s23, 1
    s_min_u32 s50, s50, s23
mega_kernel_rf_kvb1:
    s_add_u32 s22, s21, 1
    s_min_u32 s22, s22, 63
    s_cmp_gt_u32 s50, s22
    s_cbranch_scc1 mega_kernel_rf_kvd1
    buffer_load_dword v4, v7, s[4:7], 0 offen sc1
    s_waitcnt vmcnt(0)
    v_readlane_b32 s50, v4, 0
    v_readlane_b32 s22, v4, 2
    v_readlane_b32 s23, v4, 1
    v_readlane_b32 s24, v4, 3
    s_nop 3
    s_min_u32 s50, s50, s22
    s_min_u32 s23, s23, s24
    s_lshl_b32 s50, s50, 1
    s_lshl_b32 s23, s23, 1
    s_add_u32 s23, s23, 1
    s_min_u32 s50, s50, s23
    s_branch mega_kernel_rf_kvb1
mega_kernel_rf_kvd1:
mega_kernel_rf_w3_kvs:
    s_waitcnt vmcnt(2)
    v_mfma_f32_16x16x16_bf16 v[80:83], v[96:97], v[16:17], v[100:103]
    v_mfma_f32_16x16x16_bf16 v[84:87], v[98:99], v[16:17], v[104:107]
    v_and_b32 v3, 1, v96
    v_cmp_ne_u32 vcc, s41, v3
    s_nop 4
    v_cvt_pk_bf16_f32 v64, v80, v81
    v_cvt_pk_bf16_f32 v65, v82, v83
    v_cvt_pk_bf16_f32 v66, v84, v85
    v_cvt_pk_bf16_f32 v67, v86, v87
    ds_write_b128 v6, v[64:67] offset:17408
    s_cbranch_vccnz mega_kernel_rf_w3_xslow
mega_kernel_rf_w3_xok:
    buffer_load_dwordx4 v[116:119], v1, s[4:7], s40 offen sc1
    s_waitcnt lgkmcnt(1)
    v_mfma_f32_16x16x32_bf16 v[80:83], v[32:35], v[64:67], 0
    s_waitcnt lgkmcnt(0)
    s_barrier
    ds_read_b128 v[68:71], v6 offset:14336
    ds_read_b128 v[72:75], v6 offset:11264
    ds_read_b128 v[76:79], v6 offset:8192
    v_mfma_f32_16x16x32_bf16 v[84:87], v[36:39], v[64:67], 0
    v_mfma_f32_16x16x32_bf16 v[88:91], v[64:67], v[64:67], 0
    buffer_load_dwordx4 v[20:23], v1, s[4:7], s40 offen sc1
    s_waitcnt lgkmcnt(2)
    v_mfma_f32_16x16x32_bf16 v[80:83], v[40:43], v[68:71], v[80:83]
    v_mfma_f32_16x16x32_bf16 v[84:87], v[44:47], v[68:71], v[84:87]
    v_mfma_f32_16x16x32_bf16 v[88:91], v[68:71], v[68:71], v[88:91]
    s_waitcnt lgkmcnt(1)
    v_mfma_f32_16x16x32_bf16 v[80:83], v[48:51], v[72:75], v[80:83]
    v_mfma_f32_16x16x32_bf16 v[84:87], v[52:55], v[72:75], v[84:87]
    v_mfma_f32_16x16x32_bf16 v[88:91], v[72:75], v[72:75], v[88:91]
    s_waitcnt lgkmcnt(0)
    v_mfma_f32_16x16x32_bf16 v[80:83], v[56:59], v[76:79], v[80:83]
    v_mfma_f32_16x16x32_bf16 v[84:87], v[60:63], v[76:79], v[84:87]
    v_mfma_f32_16x16x32_bf16 v[88:91], v[76:79], v[76:79], v[88:91]
    v_mfma_f32_32x32x4_2b_bf16 v[32:63], v[14:15], v[14:15], 0
    s_nop 4
    v_max3_f32 v4, v80, v81, v82
    v_max3_f32 v4, v4, v83, v84
    v_max3_f32 v4, v4, v85, v86
    v_max3_f32 v4, v4, v87, v88
    v_max_f32 v90, v4, v89
    v_max_f32 v4, v4, v89
    v_mov_b32 v73, 0
    s_nop 0
    v_permlane16_swap_b32 v4, v90
    v_max_f32 v4, v4, v90
    v_max_f32 v90, v4, v90
    s_nop 1
    v_permlane32_swap_b32 v4, v90
    v_max_f32 v4, v4, v90
    v_mul_f32 v4, s34, v4
    v_pk_fma_f32 v[80:81], v[80:81], s[34:35], v[4:5] op_sel_hi:[1,0,0] neg_lo:[0,0,1] neg_hi:[0,0,1]
    v_pk_fma_f32 v[82:83], v[82:83], s[34:35], v[4:5] op_sel_hi:[1,0,0] neg_lo:[0,0,1] neg_hi:[0,0,1]
    v_pk_fma_f32 v[84:85], v[84:85], s[34:35], v[4:5] op_sel_hi:[1,0,0] neg_lo:[0,0,1] neg_hi:[0,0,1]
    v_pk_fma_f32 v[86:87], v[86:87], s[34:35], v[4:5] op_sel_hi:[1,0,0] neg_lo:[0,0,1] neg_hi:[0,0,1]
    v_pk_fma_f32 v[88:89], v[88:89], s[34:35], v[4:5] op_sel_hi:[1,0,0] neg_lo:[0,0,1] neg_hi:[0,0,1]
    v_exp_f32 v80, v80
    v_exp_f32 v81, v81
    v_exp_f32 v82, v82
    v_cvt_pk_bf16_f32 v68, v80, v81
    v_exp_f32 v83, v83
    v_exp_f32 v84, v84
    v_cvt_pk_bf16_f32 v69, v82, v83
    v_exp_f32 v85, v85
    v_exp_f32 v86, v86
    v_cvt_pk_bf16_f32 v70, v84, v85
    v_exp_f32 v87, v87
    v_exp_f32 v88, v88
    v_cvt_pk_bf16_f32 v71, v86, v87
    v_exp_f32 v89, v89
    s_cmp_eq_u32 s21, 63
    v_mfma_f32_16x16x32_bf16 v[76:79], v[28:31], v[68:71], 0
    v_cvt_pk_bf16_f32 v72, v88, v89
    s_waitcnt vmcnt(1)
    v_and_b32 v3, 1, v116
    v_mfma_f32_16x16x32_bf16 v[100:103], v[120:123], v[68:71], 0
    v_cmp_ne_u32 vcc, s41, v3
    v_add_f32 v116, v112, v116
    v_mfma_f32_16x16x32_bf16 v[104:107], v[124:127], v[68:71], 0
    v_add_f32 v117, v113, v117
    v_add_f32 v118, v114, v118
    v_mfma_f32_16x16x16_bf16 v[76:79], v[28:29], v[72:73], v[76:79]
    v_add_f32 v119, v115, v119
    s_cbranch_vccnz mega_kernel_rf_w3_pv0
mega_kernel_rf_w3_pv2:
    v_cvt_pk_bf16_f32 v18, v116, v117
    v_cvt_pk_bf16_f32 v19, v118, v119
    v_cvt_pk_bf16_f32 v98, v118, v119
    v_mov_b32 v99, 0
    v_mfma_f32_16x16x16_bf16 v[100:103], v[18:19], v[72:73], v[100:103]
    s_nop 0
    v_mfma_f32_16x16x16_bf16 v[104:107], v[98:99], v[72:73], v[104:107]
    buffer_load_dwordx4 v[120:123], v1, s[4:7], s44 offen
    buffer_load_dwordx4 v[124:127], v1, s[4:7], s44 offen offset:1024
    s_cmp_eq_u32 s21, 63
    v_rcp_f32 v76, v76
    s_cbranch_scc1 mega_kernel_rf_w3_last
    s_mov_b64 exec, s[28:29]
    v_pk_mul_f32 v[100:101], v[100:101], v[76:77] op_sel_hi:[1,0]
    v_pk_mul_f32 v[102:103], v[102:103], v[76:77] op_sel_hi:[1,0]
    v_pk_mul_f32 v[104:105], v[104:105], v[76:77] op_sel_hi:[1,0]
    v_pk_mul_f32 v[106:107], v[106:107], v[76:77] op_sel_hi:[1,0]
    v_cvt_pk_bf16_f32 v72, v100, v101
    v_cvt_pk_bf16_f32 v73, v102, v103
    v_cvt_pk_bf16_f32 v74, v104, v105
    v_cvt_pk_bf16_f32 v75, v106, v107
    ds_write_b128 v6, v[72:75] offset:21504
    s_mov_b64 exec, -1
    ds_read_b128 v[88:91], v5 offset:28672
    ds_read_b128 v[92:95], v5 offset:29696
    ds_read_b128 v[80:83], v5 offset:30720
    ds_read_b128 v[84:87], v5 offset:31744
    ds_read_b128 v[112:115], v5 offset:45056
    ds_read_b128 v[116:119], v5 offset:46080
    s_waitcnt lgkmcnt(6)
    s_barrier
    ds_read_b128 v[68:71], v6 offset:20480
    ds_read_b128 v[72:75], v6 offset:21504
    ds_read_b128 v[96:99], v5 offset:47104
    ds_read_b128 v[100:103], v5 offset:48128
    ds_read_b128 v[104:107], v5 offset:61440
    ds_read_b128 v[108:111], v5 offset:62464
    s_waitcnt lgkmcnt(5)
    v_smfmac_f32_16x16x64_bf16 v[32:35], v[68:71], v[128:135], v2
    s_add_u32 s21, s21, 1
    v_smfmac_f32_16x16x64_bf16 v[36:39], v[68:71], v[136:143], v2
    s_xor_b32 s38, s38, 1048576
    v_smfmac_f32_16x16x64_bf16 v[40:43], v[68:71], v[144:151], v2
    s_xor_b32 s37, s37, 1048576
    v_smfmac_f32_16x16x64_bf16 v[44:47], v[68:71], v[152:159], v2
    s_xor_b32 s40, s40, 1048576
    s_waitcnt lgkmcnt(4)
    v_smfmac_f32_16x16x64_bf16 v[32:35], v[72:75], v[160:167], v2
    s_xor_b32 s39, s39, 1048576
    v_smfmac_f32_16x16x64_bf16 v[36:39], v[72:75], v[168:175], v2
    s_lshr_b32 s41, s21, 1
    v_smfmac_f32_16x16x64_bf16 v[40:43], v[72:75], v[176:183], v2
    s_and_b32 s41, s41, 1
    v_smfmac_f32_16x16x64_bf16 v[44:47], v[72:75], v[184:191], v2
    s_xor_b32 s41, s41, 1
    v_smfmac_f32_16x16x64_bf16 v[48:51], v[68:71], v[192:199], v2
    s_xor_b32 s35, s35, 16384
    v_smfmac_f32_16x16x64_bf16 v[52:55], v[68:71], v[200:207], v2
    s_xor_b32 s36, s36, 16384
    s_waitcnt lgkmcnt(0)
    v_smfmac_f32_16x16x64_bf16 v[56:59], v[68:71], v[88:95], v2
    ds_read_b128 v[88:91], v5 offset:63488
    ds_read_b128 v[92:95], v5 offset:64512
    v_smfmac_f32_16x16x64_bf16 v[60:63], v[68:71], v[80:87], v2
    s_add_u32 s43, s43, 262144
    v_smfmac_f32_16x16x64_bf16 v[48:51], v[72:75], v[112:119], v2
    s_add_u32 s44, s44, 262144
    v_add_f32 v32, v32, v34
    v_add_f32 v33, v33, v35
    v_cvt_pk_bf16_f32 v32, v32, v33
    v_and_or_b32 v32, v32, -2, s42
    v_smfmac_f32_16x16x64_bf16 v[52:55], v[72:75], v[96:103], v2
    v_add_f32 v36, v36, v38
    v_add_f32 v37, v37, v39
    v_cvt_pk_bf16_f32 v33, v36, v37
    v_smfmac_f32_16x16x64_bf16 v[56:59], v[72:75], v[104:111], v2
    v_add_f32 v40, v40, v42
    v_add_f32 v41, v41, v43
    v_cvt_pk_bf16_f32 v34, v40, v41
    s_waitcnt lgkmcnt(0)
    v_smfmac_f32_16x16x64_bf16 v[60:63], v[72:75], v[88:95], v2
    v_add_f32 v44, v44, v46
    v_add_f32 v45, v45, v47
    v_cvt_pk_bf16_f32 v35, v44, v45
    buffer_store_dwordx4 v[32:35], v8, s[4:7], s46 offen
    v_pk_add_f32 v[48:49], v[48:49], v[50:51]
    v_cvt_pk_bf16_f32 v48, v48, v49
    v_and_or_b32 v48, v48, -2, s42
    v_pk_add_f32 v[52:53], v[52:53], v[54:55]
    v_cvt_pk_bf16_f32 v49, v52, v53
    v_pk_add_f32 v[56:57], v[56:57], v[58:59]
    v_cvt_pk_bf16_f32 v50, v56, v57
    v_pk_add_f32 v[60:61], v[60:61], v[62:63]
    v_cvt_pk_bf16_f32 v51, v60, v61
    buffer_store_dwordx4 v[48:51], v8, s[4:7], s61 offen
    s_waitcnt vmcnt(4)
    v_mov_b32 v20, v64
    v_mov_b32 v21, v65
    v_mov_b32 v22, v66
    v_mov_b32 v23, v67
    s_add_u32 s45, s45, 131072
    v_mfma_f32_32x32x8_bf16 v[96:111], v[14:15], v[14:15], 0
    v_mfma_f32_16x16x16_bf16 v[112:115], v[14:15], v[14:15], 0
    v_mfma_f32_16x16x16_bf16 v[116:119], v[14:15], v[14:15], 0
    ds_read_b128 v[64:67], v1 offset:12288
    ds_read_b128 v[68:71], v1 offset:13312
    ds_read_b128 v[72:75], v1 offset:14336
    ds_read_b128 v[76:79], v1 offset:15360
    ds_read_b128 v[80:83], v1 offset:28672
    ds_read_b128 v[84:87], v1 offset:29696
    ds_read_b128 v[88:91], v1 offset:30720
    ds_read_b128 v[92:95], v1 offset:31744
    v_mov_b32 v58, -1
    v_mov_b32 v59, -1
    s_nop 15
    s_nop 15
    s_nop 15
mega_kernel_rf_w3_pc:
    buffer_load_dword v36, v13, s[4:7], s47 offen offset:192 sc1
    buffer_load_dword v37, v13, s[4:7], s47 offen offset:1216 sc1
    buffer_load_dword v38, v13, s[4:7], s47 offen offset:2240 sc1
    buffer_load_dword v39, v13, s[4:7], s47 offen offset:3264 sc1
    buffer_load_dword v40, v13, s[4:7], s25 offen offset:192 sc1
    buffer_load_dword v41, v13, s[4:7], s25 offen offset:1216 sc1
    buffer_load_dword v42, v13, s[4:7], s25 offen offset:2240 sc1
    buffer_load_dword v43, v13, s[4:7], s25 offen offset:3264 sc1
    s_waitcnt vmcnt(4)
    v_mfma_f32_16x16x32_bf16 v[52:55], v[36:39], v[24:27], 0
    v_bitop3_b32 v3, s42, v36, v37 bitop3:0x7e
    v_bitop3_b32 v4, s42, v38, v39 bitop3:0x7e
    s_waitcnt vmcnt(2)
    v_or_b32 v3, v3, v4
    v_bitop3_b32 v4, s42, v40, v41 bitop3:0x7e
    s_waitcnt vmcnt(0)
    v_mfma_f32_16x16x32_bf16 v[52:55], v[40:43], v[24:27], v[52:55]
    v_bitop3_b32 v56, s42, v42, v43 bitop3:0x7e
    v_or3_b32 v3, v3, v4, v56
    v_and_b32 v3, v0, v3
    v_cmp_ne_u32 vcc, 0, v3
    s_cbranch_vccnz mega_kernel_rf_w3_pc
    s_nop 2
    v_cvt_pk_bf16_f32 v56, v52, v53
    v_cvt_pk_bf16_f32 v57, v54, v55
    v_min_u32 v56, -2, v56
    s_mov_b64 exec, s[26:27]
    buffer_store_dwordx2 v[56:57], v9, s[4:7], s35 offen offset:192
    buffer_store_dwordx2 v[58:59], v9, s[4:7], s36 offen offset:192
    s_mov_b64 exec, -1
    s_xor_b32 s42, s42, 1
    s_branch mega_kernel_rf_w3_loop
mega_kernel_rf_w3_last:
    s_waitcnt vmcnt(0)
    v_mov_b32 v20, v64
    v_mov_b32 v21, v65
    v_mov_b32 v22, v66
    v_mov_b32 v23, v67
    s_add_u32 s45, s45, 131072
    buffer_store_dwordx4 v[20:23], v10, s[4:7], s45 offen offset:192 sc1
    buffer_store_dwordx2 v[18:19], v11, s[4:7], s45 offen offset:3584 sc1
    s_branch mega_kernel_rf_end
mega_kernel_rf_w3_pafail:
    buffer_load_dwordx4 v[56:59], v12, s[4:7], s22 offen sc1
    buffer_load_dwordx4 v[60:63], v12, s[4:7], s22 offen offset:1024 sc1
    s_nop 7
    v_mov_b32 v96, 0
    v_mov_b32 v97, 0
    v_mov_b32 v98, 0
    v_mov_b32 v99, 0
    v_mov_b32 v100, 0
    v_mov_b32 v101, 0
    v_mov_b32 v102, 0
    v_mov_b32 v103, 0
    v_mov_b32 v104, 0
    v_mov_b32 v105, 0
    v_mov_b32 v106, 0
    v_mov_b32 v107, 0
    s_branch mega_kernel_rf_w3_pa
mega_kernel_rf_w3_xslow:
    buffer_load_dwordx4 v[96:99], v1, s[4:7], s38 offen sc1
    s_waitcnt vmcnt(1)
    v_and_b32 v3, 1, v20
    v_cmp_ne_u32 vcc, s41, v3
    s_cbranch_vccz mega_kernel_rf_w3_xgot1
    buffer_load_dwordx4 v[20:23], v1, s[4:7], s38 offen sc1
mega_kernel_rf_w3_px:
    s_waitcnt vmcnt(1)
    v_and_b32 v3, 1, v96
    v_cmp_ne_u32 vcc, s41, v3
    s_cbranch_vccz mega_kernel_rf_w3_xgot0
    buffer_load_dwordx4 v[96:99], v1, s[4:7], s38 offen sc1
    s_waitcnt vmcnt(1)
    v_and_b32 v3, 1, v20
    v_cmp_ne_u32 vcc, s41, v3
    s_cbranch_vccz mega_kernel_rf_w3_xgot1
    buffer_load_dwordx4 v[20:23], v1, s[4:7], s38 offen sc1
    s_branch mega_kernel_rf_w3_px
mega_kernel_rf_w3_xgot0:
    v_mfma_f32_16x16x16_bf16 v[80:83], v[96:97], v[16:17], v[100:103]
    v_mfma_f32_16x16x16_bf16 v[84:87], v[98:99], v[16:17], v[104:107]
    v_and_b32 v3, 1, v96
    v_cmp_ne_u32 vcc, s41, v3
    s_nop 4
    v_cvt_pk_bf16_f32 v64, v80, v81
    v_cvt_pk_bf16_f32 v65, v82, v83
    v_cvt_pk_bf16_f32 v66, v84, v85
    v_cvt_pk_bf16_f32 v67, v86, v87
    ds_write_b128 v6, v[64:67] offset:17408
    s_branch mega_kernel_rf_w3_xok
mega_kernel_rf_w3_xgot1:
    v_mfma_f32_16x16x16_bf16 v[80:83], v[20:21], v[16:17], v[100:103]
    v_mfma_f32_16x16x16_bf16 v[84:87], v[22:23], v[16:17], v[104:107]
    v_and_b32 v3, 1, v20
    v_cmp_ne_u32 vcc, s41, v3
    s_nop 4
    v_cvt_pk_bf16_f32 v64, v80, v81
    v_cvt_pk_bf16_f32 v65, v82, v83
    v_cvt_pk_bf16_f32 v66, v84, v85
    v_cvt_pk_bf16_f32 v67, v86, v87
    ds_write_b128 v6, v[64:67] offset:17408
    s_branch mega_kernel_rf_w3_xok
mega_kernel_rf_w3_pv0:
    s_waitcnt vmcnt(0)
    s_branch mega_kernel_rf_w3_pv1
mega_kernel_rf_w3_pv:
    buffer_load_dwordx4 v[20:23], v1, s[4:7], s40 offen sc1
    s_waitcnt vmcnt(0)
mega_kernel_rf_w3_pv1:
    v_and_b32 v3, 1, v20
    v_cmp_ne_u32 vcc, s41, v3
    v_pk_add_f32 v[116:117], v[112:113], v[20:21]
    v_pk_add_f32 v[118:119], v[114:115], v[22:23]
    s_cbranch_vccnz mega_kernel_rf_w3_pv
    s_branch mega_kernel_rf_w3_pv2
mega_kernel_rf_end:
    s_mov_b64 exec, -1
    v_mov_b32 v3, 64
    s_waitcnt vmcnt(0)
    s_barrier
    s_cmp_lg_u32 s20, 0
    s_cbranch_scc1 mega_kernel_rf_end2
    buffer_store_dword v3, v7, s[4:7], 0 offen sc1
mega_kernel_rf_end2:
    s_waitcnt vmcnt(0)
    s_endpgm
mega_kernel_recs:
    s_load_dwordx2 s[4:5], s[0:1], 96
    s_load_dwordx2 s[12:13], s[0:1], 88
    s_load_dwordx2 s[50:51], s[0:1], 16
    s_load_dwordx2 s[52:53], s[0:1], 24
    s_load_dwordx2 s[54:55], s[0:1], 32
    s_load_dwordx2 s[56:57], s[0:1], 40
    s_load_dwordx2 s[58:59], s[0:1], 8
    v_lshrrev_b32 v3, 6, v0
    v_and_b32 v40, 63, v0
    v_readfirstlane_b32 s20, v3
    v_lshrrev_b32 v41, 4, v40
    v_and_b32 v42, 15, v40
    v_lshlrev_b32 v1, 4, v40
    s_mov_b32 s49, 0
    s_waitcnt lgkmcnt(0)
    s_mov_b32 s6, 268435456
    s_mov_b32 s7, 0x00020000
    s_mov_b32 s14, 256
    s_mov_b32 s15, 0x00020000
    s_mov_b32 s10, 8388608
    s_mov_b32 s11, 0x00020000
    s_mov_b32 s26, 0x00030003
    s_mov_b32 s27, 0x00030003
    s_mov_b32 s28, 0xcccccccc
    s_mov_b32 s29, 0xcccccccc
    s_mov_b32 s32, 0x33333333
    s_mov_b32 s33, 0x33333333
    s_mov_b32 s34, 0x3e0293ee
    v_mov_b32 v48, 0
    v_mov_b32 v49, 0
    v_mov_b32 v50, 0
    v_mov_b32 v51, 0
    v_lshlrev_b32 v52, 4, v0
    s_lshl_b32 s22, s30, 5
    s_add_u32 s22, s22, s31
    s_lshl_b32 s38, s22, 14
    s_xor_b32 s22, s22, 32
    s_lshl_b32 s37, s22, 14
    s_add_u32 s38, s38, 67108864
    s_add_u32 s37, s37, 67108864
    s_lshl_b32 s46, s30, 18
    s_add_u32 s46, s46, 70254592
    s_lshl_b32 s22, s31, 13
    s_add_u32 s47, s46, s22
    s_lshl_b32 s22, s20, 16
    s_add_u32 s46, s46, s22
    s_lshl_b32 s22, s31, 8
    s_add_u32 s46, s46, s22
    s_add_u32 s61, s46, 32768
    s_add_u32 s25, s47, 4096
    s_lshl_b32 s35, s30, 13
    s_add_u32 s35, s35, 69206016
    s_mov_b32 s16, s58
    s_mov_b32 s17, s59
    s_mov_b32 s18, 16384
    s_mov_b32 s19, 0x00020000
    v_lshrrev_b32 v53, 2, v42
    v_lshlrev_b32 v53, 1, v53
    v_and_b32 v54, 1, v42
    v_add_u32 v55, v53, v54
    v_bfe_u32 v53, v0, 3, 1
    v_lshlrev_b32 v53, 11, v53
    v_and_b32 v54, 3, v0
    v_lshl_add_u32 v53, v54, 5, v53
    v_bfe_u32 v54, v0, 4, 3
    v_lshl_add_u32 v53, v54, 2, v53
    v_bfe_u32 v54, v0, 2, 1
    v_lshl_add_u32 v53, v54, 1, v53
    s_lshl_b32 s22, s30, 10
    s_lshr_b32 s23, s31, 2
    s_lshl_b32 s23, s23, 7
    s_add_u32 s22, s22, s23
    s_and_b32 s23, s31, 3
    s_lshl_b32 s23, s23, 12
    s_add_u32 s22, s22, s23
    buffer_load_ushort v56, v53, s[16:19], s22 offen
    s_add_u32 s22, s38, 0
    buffer_store_dwordx4 v[48:51], v52, s[4:7], s22 offen sc1
    s_add_u32 s22, s38, 4096
    buffer_store_dwordx4 v[48:51], v52, s[4:7], s22 offen sc1
    s_add_u32 s22, s38, 8192
    buffer_store_dwordx4 v[48:51], v52, s[4:7], s22 offen sc1
    s_add_u32 s22, s38, 12288
    buffer_store_dwordx4 v[48:51], v52, s[4:7], s22 offen sc1
    s_add_u32 s22, s38, 1048576
    buffer_store_dwordx4 v[48:51], v52, s[4:7], s22 offen sc1
    s_add_u32 s22, s38, 1052672
    buffer_store_dwordx4 v[48:51], v52, s[4:7], s22 offen sc1
    s_add_u32 s22, s38, 1056768
    buffer_store_dwordx4 v[48:51], v52, s[4:7], s22 offen sc1
    s_add_u32 s22, s38, 1060864
    buffer_store_dwordx4 v[48:51], v52, s[4:7], s22 offen sc1
    s_add_u32 s22, s47, 0
    buffer_store_dwordx4 v[48:51], v52, s[4:7], s22 offen sc1
    s_add_u32 s22, s47, 4096
    buffer_store_dwordx4 v[48:51], v52, s[4:7], s22 offen sc1
    s_lshl_b32 s22, s20, 2
    v_xor_b32 v3, s22, v42
    v_lshlrev_b32 v3, 4, v3
    v_lshl_add_u32 v4, v41, 4, s20
    v_lshl_add_u32 v44, v4, 13, v3
    s_lshl_b32 s22, s30, 22
    s_lshl_b32 s23, s31, 8
    s_add_u32 s22, s22, s23
    v_add_u32 v44, s22, v44
    s_lshr_b32 s22, s20, 1
    s_lshl_b32 s22, s22, 5
    s_and_b32 s23, s20, 1
    s_lshl_b32 s23, s23, 2
    s_add_u32 s22, s22, s23
    s_lshl_b32 s23, s31, 7
    s_add_u32 s22, s22, s23
    v_add_u32 v4, s22, v41
    v_lshl_add_u32 v45, v4, 11, v3
    s_lshl_b32 s22, s30, 10
    v_add_u32 v45, s22, v45
    s_lshl_b32 s48, s20, 10
    s_mov_b32 s8, s50
    s_mov_b32 s9, s51
    s_add_u32 m0, s48, 0
    s_mov_b32 s22, 0
    buffer_load_dwordx4 v44, s[8:11], s22 offen lds
    s_add_u32 m0, s48, 4096
    s_mov_b32 s22, 32768
    buffer_load_dwordx4 v44, s[8:11], s22 offen lds
    s_add_u32 m0, s48, 8192
    s_mov_b32 s22, 65536
    buffer_load_dwordx4 v44, s[8:11], s22 offen lds
    s_add_u32 m0, s48, 12288
    s_mov_b32 s22, 98304
    buffer_load_dwordx4 v44, s[8:11], s22 offen lds
    s_add_u32 m0, s48, 16384
    s_mov_b32 s22, 524288
    buffer_load_dwordx4 v44, s[8:11], s22 offen lds
    s_add_u32 m0, s48, 20480
    s_mov_b32 s22, 557056
    buffer_load_dwordx4 v44, s[8:11], s22 offen lds
    s_add_u32 m0, s48, 24576
    s_mov_b32 s22, 589824
    buffer_load_dwordx4 v44, s[8:11], s22 offen lds
    s_add_u32 m0, s48, 28672
    s_mov_b32 s22, 622592
    buffer_load_dwordx4 v44, s[8:11], s22 offen lds
    s_add_u32 m0, s48, 32768
    s_mov_b32 s22, 1048576
    buffer_load_dwordx4 v44, s[8:11], s22 offen lds
    s_add_u32 m0, s48, 36864
    s_mov_b32 s22, 1081344
    buffer_load_dwordx4 v44, s[8:11], s22 offen lds
    s_add_u32 m0, s48, 40960
    s_mov_b32 s22, 1114112
    buffer_load_dwordx4 v44, s[8:11], s22 offen lds
    s_add_u32 m0, s48, 45056
    s_mov_b32 s22, 1146880
    buffer_load_dwordx4 v44, s[8:11], s22 offen lds
    s_add_u32 m0, s48, 49152
    s_mov_b32 s22, 1572864
    buffer_load_dwordx4 v44, s[8:11], s22 offen lds
    s_add_u32 m0, s48, 53248
    s_mov_b32 s22, 1605632
    buffer_load_dwordx4 v44, s[8:11], s22 offen lds
    s_add_u32 m0, s48, 57344
    s_mov_b32 s22, 1638400
    buffer_load_dwordx4 v44, s[8:11], s22 offen lds
    s_add_u32 m0, s48, 61440
    s_mov_b32 s22, 1671168
    buffer_load_dwordx4 v44, s[8:11], s22 offen lds
    s_add_u32 m0, s48, 65536
    s_mov_b32 s22, 2097152
    buffer_load_dwordx4 v44, s[8:11], s22 offen lds
    s_add_u32 m0, s48, 69632
    s_mov_b32 s22, 2129920
    buffer_load_dwordx4 v44, s[8:11], s22 offen lds
    s_add_u32 m0, s48, 73728
    s_mov_b32 s22, 2162688
    buffer_load_dwordx4 v44, s[8:11], s22 offen lds
    s_add_u32 m0, s48, 77824
    s_mov_b32 s22, 2195456
    buffer_load_dwordx4 v44, s[8:11], s22 offen lds
    s_add_u32 m0, s48, 81920
    s_mov_b32 s22, 2621440
    buffer_load_dwordx4 v44, s[8:11], s22 offen lds
    s_add_u32 m0, s48, 86016
    s_mov_b32 s22, 2654208
    buffer_load_dwordx4 v44, s[8:11], s22 offen lds
    s_add_u32 m0, s48, 90112
    s_mov_b32 s22, 2686976
    buffer_load_dwordx4 v44, s[8:11], s22 offen lds
    s_add_u32 m0, s48, 94208
    s_mov_b32 s22, 2719744
    buffer_load_dwordx4 v44, s[8:11], s22 offen lds
    s_add_u32 m0, s48, 98304
    s_mov_b32 s22, 3145728
    buffer_load_dwordx4 v44, s[8:11], s22 offen lds
    s_add_u32 m0, s48, 102400
    s_mov_b32 s22, 3178496
    buffer_load_dwordx4 v44, s[8:11], s22 offen lds
    s_add_u32 m0, s48, 106496
    s_mov_b32 s22, 3211264
    buffer_load_dwordx4 v44, s[8:11], s22 offen lds
    s_add_u32 m0, s48, 110592
    s_mov_b32 s22, 3244032
    buffer_load_dwordx4 v44, s[8:11], s22 offen lds
    s_add_u32 m0, s48, 114688
    s_mov_b32 s22, 3670016
    buffer_load_dwordx4 v44, s[8:11], s22 offen lds
    s_add_u32 m0, s48, 118784
    s_mov_b32 s22, 3702784
    buffer_load_dwordx4 v44, s[8:11], s22 offen lds
    s_add_u32 m0, s48, 122880
    s_mov_b32 s22, 3735552
    buffer_load_dwordx4 v44, s[8:11], s22 offen lds
    s_add_u32 m0, s48, 126976
    s_mov_b32 s22, 3768320
    buffer_load_dwordx4 v44, s[8:11], s22 offen lds
    v_mov_b32 v14, 0
    v_mov_b32 v15, 0
    v_mov_b32 v2, 0x4444
    v_mov_b32 v3, 0xeeee
    v_cndmask_b32 v2, v2, v3, s[28:29]
    s_lshl_b32 s22, s20, 12
    v_add_u32 v32, s22, v1
    v_add_u32 v33, 0x10000, v32
    v_add_u32 v5, 0x10000, v1
    v_add_u32 v6, 131072, v1
    v_and_b32 v3, 3, v42
    v_bfe_u32 v43, v40, 1, 1
    v_lshlrev_b32 v7, 13, v43
    v_and_b32 v43, 1, v40
    v_lshl_add_u32 v7, v43, 7, v7
    s_lshl_b32 s22, s31, 8
    s_add_u32 s23, s22, 71311360
    v_add_u32 v7, s23, v7
    s_cmp_lg_u32 s20, 0
    s_cbranch_scc1 mega_kernel_rs_flk
    s_lshl_b32 s23, s30, 7
    s_add_u32 s22, s22, s23
    s_add_u32 s22, s22, 71327744
    v_bfrev_b32 v7, 1
    v_writelane_b32 v7, s22, 0
mega_kernel_rs_flk:
    v_lshlrev_b32 v11, 3, v40
    v_lshlrev_b32 v10, 8, v55
    v_lshl_add_u32 v10, v41, 4, v10
    v_lshlrev_b32 v8, 13, v41
    v_lshl_add_u32 v8, v42, 4, v8
    v_lshrrev_b32 v9, 1, v41
    v_lshlrev_b32 v9, 5, v9
    v_and_b32 v4, 1, v42
    v_lshl_add_u32 v9, v4, 4, v9
    v_and_b32 v4, 1, v41
    v_lshl_add_u32 v9, v4, 3, v9
    s_lshl_b32 s22, s31, 8
    v_add_u32 v9, s22, v9
    v_lshrrev_b32 v4, 2, v42
    v_lshlrev_b32 v12, 8, v4
    v_lshl_add_u32 v12, v41, 6, v12
    v_lshl_add_u32 v12, v3, 4, v12
    v_lshlrev_b32 v13, 8, v41
    v_lshl_add_u32 v13, v42, 2, v13
    v_cmp_eq_u32 vcc, 0, v3
    v_mov_b32 v28, 0x3f803f80
    v_mov_b32 v29, 0x3f803f80
    v_cndmask_b32 v34, 0, 1, vcc
    v_mov_b32 v30, 0x3f803f80
    v_mov_b32 v31, 0x3f803f80
    v_and_b32 v49, 1, v42
    v_lshlrev_b32 v49, 4, v49
    v_mov_b32 v50, 0x3f80
    v_lshlrev_b32 v50, v49, v50
    v_lshrrev_b32 v51, 2, v42
    v_cmp_eq_u32 vcc, v51, v41
    v_mov_b32 v24, v50
    v_cndmask_b32 v52, 0, v50, s[28:29]
    v_cndmask_b32 v53, 0, v50, s[32:33]
    v_cndmask_b32 v16, 0, v52, vcc
    v_cndmask_b32 v17, 0, v53, vcc
    v_mov_b32 v25, v50
    v_mov_b32 v26, v50
    v_mov_b32 v27, v50
    v_bfe_u32 v60, v40, 3, 1
    v_bfe_u32 v49, v40, 2, 1
    v_and_b32 v50, 1, v41
    v_lshrrev_b32 v51, 1, v41
    v_lshlrev_b32 v52, 3, v60
    v_lshl_add_u32 v52, v50, 2, v52
    v_lshl_add_u32 v53, v51, 4, v52
    v_add_u32 v53, v53, v49
    v_and_b32 v54, 3, v40
    s_lshl_b32 s22, s20, 2
    v_add_u32 v55, s22, v54
    v_xor_b32 v55, v55, v52
    v_lshlrev_b32 v55, 4, v55
    v_lshl_add_u32 v46, v53, 8, v55
    v_lshlrev_b32 v55, 4, v52
    v_lshl_add_u32 v55, v54, 3, v55
    v_lshl_add_u32 v47, v53, 8, v55
    v_mov_b32 v60, -1
    v_lshlrev_b32 v61, 1, v0
    s_waitcnt vmcnt(32)
    v_min_u32 v56, 0xfffe, v56
    s_cmp_ge_u32 s20, 2
    s_cbranch_scc1 mega_kernel_rs_nomi
    s_lshl_b32 s23, s31, 8
    s_add_u32 s22, s35, s23
    s_add_u32 s23, s22, 16384
    buffer_store_short v60, v61, s[4:7], s23 offen sc1
    buffer_store_short v56, v61, s[4:7], s22 offen sc1
mega_kernel_rs_nomi:
    s_waitcnt vmcnt(28)
    s_barrier
    v_add_u32 v48, 0, v46
    ds_read_b64_tr_b16 a[0:1], v48 offset:0
    ds_read_b64_tr_b16 a[2:3], v48 offset:512
    ds_read_b64_tr_b16 a[4:5], v48 offset:8192
    ds_read_b64_tr_b16 a[6:7], v48 offset:8704
    ds_read_b64_tr_b16 a[8:9], v48 offset:8
    ds_read_b64_tr_b16 a[10:11], v48 offset:520
    ds_read_b64_tr_b16 a[12:13], v48 offset:8200
    ds_read_b64_tr_b16 a[14:15], v48 offset:8712
    s_waitcnt lgkmcnt(0)
    s_barrier
    s_mov_b32 s8, s52
    s_mov_b32 s9, s53
    s_add_u32 m0, s48, 0
    s_mov_b32 s22, 0
    buffer_load_dwordx4 v44, s[8:11], s22 offen lds
    s_add_u32 m0, s48, 4096
    s_mov_b32 s22, 32768
    buffer_load_dwordx4 v44, s[8:11], s22 offen lds
    s_add_u32 m0, s48, 8192
    s_mov_b32 s22, 65536
    buffer_load_dwordx4 v44, s[8:11], s22 offen lds
    s_add_u32 m0, s48, 12288
    s_mov_b32 s22, 98304
    buffer_load_dwordx4 v44, s[8:11], s22 offen lds
    s_waitcnt vmcnt(28)
    s_barrier
    v_add_u32 v48, 16384, v46
    ds_read_b64_tr_b16 a[16:17], v48 offset:0
    ds_read_b64_tr_b16 a[18:19], v48 offset:512
    ds_read_b64_tr_b16 a[20:21], v48 offset:8192
    ds_read_b64_tr_b16 a[22:23], v48 offset:8704
    ds_read_b64_tr_b16 a[24:25], v48 offset:8
    ds_read_b64_tr_b16 a[26:27], v48 offset:520
    ds_read_b64_tr_b16 a[28:29], v48 offset:8200
    ds_read_b64_tr_b16 a[30:31], v48 offset:8712
    s_waitcnt lgkmcnt(0)
    s_barrier
    s_add_u32 m0, s48, 16384
    s_mov_b32 s22, 524288
    buffer_load_dwordx4 v44, s[8:11], s22 offen lds
    s_add_u32 m0, s48, 20480
    s_mov_b32 s22, 557056
    buffer_load_dwordx4 v44, s[8:11], s22 offen lds
    s_add_u32 m0, s48, 24576
    s_mov_b32 s22, 589824
    buffer_load_dwordx4 v44, s[8:11], s22 offen lds
    s_add_u32 m0, s48, 28672
    s_mov_b32 s22, 622592
    buffer_load_dwordx4 v44, s[8:11], s22 offen lds
    s_waitcnt vmcnt(28)
    s_barrier
    v_add_u32 v48, 32768, v46
    ds_read_b64_tr_b16 a[32:33], v48 offset:0
    ds_read_b64_tr_b16 a[34:35], v48 offset:512
    ds_read_b64_tr_b16 a[36:37], v48 offset:8192
    ds_read_b64_tr_b16 a[38:39], v48 offset:8704
    ds_read_b64_tr_b16 a[40:41], v48 offset:8
    ds_read_b64_tr_b16 a[42:43], v48 offset:520
    ds_read_b64_tr_b16 a[44:45], v48 offset:8200
    ds_read_b64_tr_b16 a[46:47], v48 offset:8712
    s_waitcnt lgkmcnt(0)
    s_barrier
    s_add_u32 m0, s48, 32768
    s_mov_b32 s22, 1048576
    buffer_load_dwordx4 v44, s[8:11], s22 offen lds
    s_add_u32 m0, s48, 36864
    s_mov_b32 s22, 1081344
    buffer_load_dwordx4 v44, s[8:11], s22 offen lds
    s_add_u32 m0, s48, 40960
    s_mov_b32 s22, 1114112
    buffer_load_dwordx4 v44, s[8:11], s22 offen lds
    s_add_u32 m0, s48, 45056
    s_mov_b32 s22, 1146880
    buffer_load_dwordx4 v44, s[8:11], s22 offen lds
    s_waitcnt vmcnt(28)
    s_barrier
    v_add_u32 v48, 49152, v46
    ds_read_b64_tr_b16 a[48:49], v48 offset:0
    ds_read_b64_tr_b16 a[50:51], v48 offset:512
    ds_read_b64_tr_b16 a[52:53], v48 offset:8192
    ds_read_b64_tr_b16 a[54:55], v48 offset:8704
    ds_read_b64_tr_b16 a[56:57], v48 offset:8
    ds_read_b64_tr_b16 a[58:59], v48 offset:520
    ds_read_b64_tr_b16 a[60:61], v48 offset:8200
    ds_read_b64_tr_b16 a[62:63], v48 offset:8712
    s_waitcnt lgkmcnt(0)
    s_barrier
    s_add_u32 m0, s48, 49152
    s_mov_b32 s22, 1572864
    buffer_load_dwordx4 v44, s[8:11], s22 offen lds
    s_add_u32 m0, s48, 53248
    s_mov_b32 s22, 1605632
    buffer_load_dwordx4 v44, s[8:11], s22 offen lds
    s_add_u32 m0, s48, 57344
    s_mov_b32 s22, 1638400
    buffer_load_dwordx4 v44, s[8:11], s22 offen lds
    s_add_u32 m0, s48, 61440
    s_mov_b32 s22, 1671168
    buffer_load_dwordx4 v44, s[8:11], s22 offen lds
    s_waitcnt vmcnt(28)
    s_barrier
    v_add_u32 v48, 65536, v46
    ds_read_b64_tr_b16 a[64:65], v48 offset:0
    ds_read_b64_tr_b16 a[66:67], v48 offset:512
    ds_read_b64_tr_b16 a[68:69], v48 offset:8192
    ds_read_b64_tr_b16 a[70:71], v48 offset:8704
    ds_read_b64_tr_b16 a[72:73], v48 offset:8
    ds_read_b64_tr_b16 a[74:75], v48 offset:520
    ds_read_b64_tr_b16 a[76:77], v48 offset:8200
    ds_read_b64_tr_b16 a[78:79], v48 offset:8712
    s_waitcnt lgkmcnt(0)
    s_barrier
    s_add_u32 m0, s48, 65536
    s_mov_b32 s22, 2097152
    buffer_load_dwordx4 v44, s[8:11], s22 offen lds
    s_add_u32 m0, s48, 69632
    s_mov_b32 s22, 2129920
    buffer_load_dwordx4 v44, s[8:11], s22 offen lds
    s_add_u32 m0, s48, 73728
    s_mov_b32 s22, 2162688
    buffer_load_dwordx4 v44, s[8:11], s22 offen lds
    s_add_u32 m0, s48, 77824
    s_mov_b32 s22, 2195456
    buffer_load_dwordx4 v44, s[8:11], s22 offen lds
    s_waitcnt vmcnt(28)
    s_barrier
    v_add_u32 v48, 81920, v46
    ds_read_b64_tr_b16 a[80:81], v48 offset:0
    ds_read_b64_tr_b16 a[82:83], v48 offset:512
    ds_read_b64_tr_b16 a[84:85], v48 offset:8192
    ds_read_b64_tr_b16 a[86:87], v48 offset:8704
    ds_read_b64_tr_b16 a[88:89], v48 offset:8
    ds_read_b64_tr_b16 a[90:91], v48 offset:520
    ds_read_b64_tr_b16 a[92:93], v48 offset:8200
    ds_read_b64_tr_b16 a[94:95], v48 offset:8712
    s_waitcnt lgkmcnt(0)
    s_barrier
    s_add_u32 m0, s48, 81920
    s_mov_b32 s22, 2621440
    buffer_load_dwordx4 v44, s[8:11], s22 offen lds
    s_add_u32 m0, s48, 86016
    s_mov_b32 s22, 2654208
    buffer_load_dwordx4 v44, s[8:11], s22 offen lds
    s_add_u32 m0, s48, 90112
    s_mov_b32 s22, 2686976
    buffer_load_dwordx4 v44, s[8:11], s22 offen lds
    s_add_u32 m0, s48, 94208
    s_mov_b32 s22, 2719744
    buffer_load_dwordx4 v44, s[8:11], s22 offen lds
    s_waitcnt vmcnt(28)
    s_barrier
    v_add_u32 v48, 98304, v46
    ds_read_b64_tr_b16 a[96:97], v48 offset:0
    ds_read_b64_tr_b16 a[98:99], v48 offset:512
    ds_read_b64_tr_b16 a[100:101], v48 offset:8192
    ds_read_b64_tr_b16 a[102:103], v48 offset:8704
    ds_read_b64_tr_b16 a[104:105], v48 offset:8
    ds_read_b64_tr_b16 a[106:107], v48 offset:520
    ds_read_b64_tr_b16 a[108:109], v48 offset:8200
    ds_read_b64_tr_b16 a[110:111], v48 offset:8712
    s_waitcnt lgkmcnt(0)
    s_barrier
    s_add_u32 m0, s48, 98304
    s_mov_b32 s22, 3145728
    buffer_load_dwordx4 v44, s[8:11], s22 offen lds
    s_add_u32 m0, s48, 102400
    s_mov_b32 s22, 3178496
    buffer_load_dwordx4 v44, s[8:11], s22 offen lds
    s_add_u32 m0, s48, 106496
    s_mov_b32 s22, 3211264
    buffer_load_dwordx4 v44, s[8:11], s22 offen lds
    s_add_u32 m0, s48, 110592
    s_mov_b32 s22, 3244032
    buffer_load_dwordx4 v44, s[8:11], s22 offen lds
    s_waitcnt vmcnt(28)
    s_barrier
    v_add_u32 v48, 114688, v46
    ds_read_b64_tr_b16 a[112:113], v48 offset:0
    ds_read_b64_tr_b16 a[114:115], v48 offset:512
    ds_read_b64_tr_b16 a[116:117], v48 offset:8192
    ds_read_b64_tr_b16 a[118:119], v48 offset:8704
    ds_read_b64_tr_b16 a[120:121], v48 offset:8
    ds_read_b64_tr_b16 a[122:123], v48 offset:520
    ds_read_b64_tr_b16 a[124:125], v48 offset:8200
    ds_read_b64_tr_b16 a[126:127], v48 offset:8712
    s_waitcnt lgkmcnt(0)
    s_barrier
    s_add_u32 m0, s48, 114688
    s_mov_b32 s22, 3670016
    buffer_load_dwordx4 v44, s[8:11], s22 offen lds
    s_add_u32 m0, s48, 118784
    s_mov_b32 s22, 3702784
    buffer_load_dwordx4 v44, s[8:11], s22 offen lds
    s_add_u32 m0, s48, 122880
    s_mov_b32 s22, 3735552
    buffer_load_dwordx4 v44, s[8:11], s22 offen lds
    s_add_u32 m0, s48, 126976
    s_mov_b32 s22, 3768320
    buffer_load_dwordx4 v44, s[8:11], s22 offen lds
    s_waitcnt vmcnt(28)
    s_barrier
    v_add_u32 v48, 0, v46
    ds_read_b64_tr_b16 a[128:129], v48 offset:0
    ds_read_b64_tr_b16 a[130:131], v48 offset:512
    ds_read_b64_tr_b16 a[132:133], v48 offset:8192
    ds_read_b64_tr_b16 a[134:135], v48 offset:8704
    ds_read_b64_tr_b16 a[136:137], v48 offset:8
    ds_read_b64_tr_b16 a[138:139], v48 offset:520
    ds_read_b64_tr_b16 a[140:141], v48 offset:8200
    ds_read_b64_tr_b16 a[142:143], v48 offset:8712
    s_waitcnt lgkmcnt(0)
    s_barrier
    s_mov_b32 s8, s56
    s_mov_b32 s9, s57
    s_add_u32 m0, s48, 0
    s_mov_b32 s22, 0
    buffer_load_dwordx4 v45, s[8:11], s22 offen lds
    s_add_u32 m0, s48, 4096
    s_mov_b32 s22, 16384
    buffer_load_dwordx4 v45, s[8:11], s22 offen lds
    s_add_u32 m0, s48, 8192
    s_mov_b32 s22, 32768
    buffer_load_dwordx4 v45, s[8:11], s22 offen lds
    s_add_u32 m0, s48, 12288
    s_mov_b32 s22, 49152
    buffer_load_dwordx4 v45, s[8:11], s22 offen lds
    s_waitcnt vmcnt(28)
    s_barrier
    s_cmp_lg_u32 s20, 1
    s_cbranch_scc1 mega_kernel_rs_noin
    v_mov_b32 v53, 1
    s_mov_b64 exec, 1
    buffer_atomic_add v53, v14, s[12:15], 0 offen offset:8 sc1
    s_mov_b64 exec, -1
mega_kernel_rs_noin:
    v_add_u32 v48, 16384, v46
    ds_read_b64_tr_b16 a[144:145], v48 offset:0
    ds_read_b64_tr_b16 a[146:147], v48 offset:512
    ds_read_b64_tr_b16 a[148:149], v48 offset:8192
    ds_read_b64_tr_b16 a[150:151], v48 offset:8704
    ds_read_b64_tr_b16 a[152:153], v48 offset:8
    ds_read_b64_tr_b16 a[154:155], v48 offset:520
    ds_read_b64_tr_b16 a[156:157], v48 offset:8200
    ds_read_b64_tr_b16 a[158:159], v48 offset:8712
    s_waitcnt lgkmcnt(0)
    s_barrier
    s_add_u32 m0, s48, 16384
    s_mov_b32 s22, 256
    buffer_load_dwordx4 v45, s[8:11], s22 offen lds
    s_add_u32 m0, s48, 20480
    s_mov_b32 s22, 16640
    buffer_load_dwordx4 v45, s[8:11], s22 offen lds
    s_add_u32 m0, s48, 24576
    s_mov_b32 s22, 33024
    buffer_load_dwordx4 v45, s[8:11], s22 offen lds
    s_add_u32 m0, s48, 28672
    s_mov_b32 s22, 49408
    buffer_load_dwordx4 v45, s[8:11], s22 offen lds
    s_waitcnt vmcnt(28)
    s_barrier
    v_add_u32 v48, 32768, v46
    ds_read_b64_tr_b16 a[160:161], v48 offset:0
    ds_read_b64_tr_b16 a[162:163], v48 offset:512
    ds_read_b64_tr_b16 a[164:165], v48 offset:8192
    ds_read_b64_tr_b16 a[166:167], v48 offset:8704
    ds_read_b64_tr_b16 a[168:169], v48 offset:8
    ds_read_b64_tr_b16 a[170:171], v48 offset:520
    ds_read_b64_tr_b16 a[172:173], v48 offset:8200
    ds_read_b64_tr_b16 a[174:175], v48 offset:8712
    s_waitcnt lgkmcnt(0)
    s_barrier
    s_add_u32 m0, s48, 32768
    s_mov_b32 s22, 512
    buffer_load_dwordx4 v45, s[8:11], s22 offen lds
    s_add_u32 m0, s48, 36864
    s_mov_b32 s22, 16896
    buffer_load_dwordx4 v45, s[8:11], s22 offen lds
    s_add_u32 m0, s48, 40960
    s_mov_b32 s22, 33280
    buffer_load_dwordx4 v45, s[8:11], s22 offen lds
    s_add_u32 m0, s48, 45056
    s_mov_b32 s22, 49664
    buffer_load_dwordx4 v45, s[8:11], s22 offen lds
    s_waitcnt vmcnt(28)
    s_barrier
    v_add_u32 v48, 49152, v46
    ds_read_b64_tr_b16 a[176:177], v48 offset:0
    ds_read_b64_tr_b16 a[178:179], v48 offset:512
    ds_read_b64_tr_b16 a[180:181], v48 offset:8192
    ds_read_b64_tr_b16 a[182:183], v48 offset:8704
    ds_read_b64_tr_b16 a[184:185], v48 offset:8
    ds_read_b64_tr_b16 a[186:187], v48 offset:520
    ds_read_b64_tr_b16 a[188:189], v48 offset:8200
    ds_read_b64_tr_b16 a[190:191], v48 offset:8712
    s_waitcnt lgkmcnt(0)
    s_barrier
    s_add_u32 m0, s48, 49152
    s_mov_b32 s22, 768
    buffer_load_dwordx4 v45, s[8:11], s22 offen lds
    s_add_u32 m0, s48, 53248
    s_mov_b32 s22, 17152
    buffer_load_dwordx4 v45, s[8:11], s22 offen lds
    s_add_u32 m0, s48, 57344
    s_mov_b32 s22, 33536
    buffer_load_dwordx4 v45, s[8:11], s22 offen lds
    s_add_u32 m0, s48, 61440
    s_mov_b32 s22, 49920
    buffer_load_dwordx4 v45, s[8:11], s22 offen lds
    s_waitcnt vmcnt(28)
    s_barrier
    v_add_u32 v48, 65536, v46
    ds_read_b64_tr_b16 a[192:193], v48 offset:0
    ds_read_b64_tr_b16 a[194:195], v48 offset:512
    ds_read_b64_tr_b16 a[196:197], v48 offset:8192
    ds_read_b64_tr_b16 a[198:199], v48 offset:8704
    ds_read_b64_tr_b16 a[200:201], v48 offset:8
    ds_read_b64_tr_b16 a[202:203], v48 offset:520
    ds_read_b64_tr_b16 a[204:205], v48 offset:8200
    ds_read_b64_tr_b16 a[206:207], v48 offset:8712
    s_waitcnt lgkmcnt(0)
    s_barrier
    s_add_u32 m0, s48, 65536
    s_mov_b32 s22, 131072
    buffer_load_dwordx4 v45, s[8:11], s22 offen lds
    s_add_u32 m0, s48, 69632
    s_mov_b32 s22, 147456
    buffer_load_dwordx4 v45, s[8:11], s22 offen lds
    s_add_u32 m0, s48, 73728
    s_mov_b32 s22, 163840
    buffer_load_dwordx4 v45, s[8:11], s22 offen lds
    s_add_u32 m0, s48, 77824
    s_mov_b32 s22, 180224
    buffer_load_dwordx4 v45, s[8:11], s22 offen lds
    s_waitcnt vmcnt(28)
    s_barrier
    v_add_u32 v48, 81920, v46
    ds_read_b64_tr_b16 a[208:209], v48 offset:0
    ds_read_b64_tr_b16 a[210:211], v48 offset:512
    ds_read_b64_tr_b16 a[212:213], v48 offset:8192
    ds_read_b64_tr_b16 a[214:215], v48 offset:8704
    ds_read_b64_tr_b16 a[216:217], v48 offset:8
    ds_read_b64_tr_b16 a[218:219], v48 offset:520
    ds_read_b64_tr_b16 a[220:221], v48 offset:8200
    ds_read_b64_tr_b16 a[222:223], v48 offset:8712
    s_waitcnt lgkmcnt(0)
    s_barrier
    s_add_u32 m0, s48, 81920
    s_mov_b32 s22, 131328
    buffer_load_dwordx4 v45, s[8:11], s22 offen lds
    s_add_u32 m0, s48, 86016
    s_mov_b32 s22, 147712
    buffer_load_dwordx4 v45, s[8:11], s22 offen lds
    s_add_u32 m0, s48, 90112
    s_mov_b32 s22, 164096
    buffer_load_dwordx4 v45, s[8:11], s22 offen lds
    s_add_u32 m0, s48, 94208
    s_mov_b32 s22, 180480
    buffer_load_dwordx4 v45, s[8:11], s22 offen lds
    s_waitcnt vmcnt(28)
    s_barrier
    v_add_u32 v48, 98304, v46
    ds_read_b64_tr_b16 a[224:225], v48 offset:0
    ds_read_b64_tr_b16 a[226:227], v48 offset:512
    ds_read_b64_tr_b16 a[228:229], v48 offset:8192
    ds_read_b64_tr_b16 a[230:231], v48 offset:8704
    ds_read_b64_tr_b16 a[232:233], v48 offset:8
    ds_read_b64_tr_b16 a[234:235], v48 offset:520
    ds_read_b64_tr_b16 a[236:237], v48 offset:8200
    ds_read_b64_tr_b16 a[238:239], v48 offset:8712
    s_waitcnt lgkmcnt(0)
    s_barrier
    s_add_u32 m0, s48, 98304
    s_mov_b32 s22, 131584
    buffer_load_dwordx4 v45, s[8:11], s22 offen lds
    s_add_u32 m0, s48, 102400
    s_mov_b32 s22, 147968
    buffer_load_dwordx4 v45, s[8:11], s22 offen lds
    s_add_u32 m0, s48, 106496
    s_mov_b32 s22, 164352
    buffer_load_dwordx4 v45, s[8:11], s22 offen lds
    s_add_u32 m0, s48, 110592
    s_mov_b32 s22, 180736
    buffer_load_dwordx4 v45, s[8:11], s22 offen lds
    s_waitcnt vmcnt(28)
    s_barrier
    v_add_u32 v48, 114688, v46
    ds_read_b64_tr_b16 a[240:241], v48 offset:0
    ds_read_b64_tr_b16 a[242:243], v48 offset:512
    ds_read_b64_tr_b16 a[244:245], v48 offset:8192
    ds_read_b64_tr_b16 a[246:247], v48 offset:8704
    ds_read_b64_tr_b16 a[248:249], v48 offset:8
    ds_read_b64_tr_b16 a[250:251], v48 offset:520
    ds_read_b64_tr_b16 a[252:253], v48 offset:8200
    ds_read_b64_tr_b16 a[254:255], v48 offset:8712
    s_waitcnt lgkmcnt(0)
    s_barrier
    s_add_u32 m0, s48, 114688
    s_mov_b32 s22, 131840
    buffer_load_dwordx4 v45, s[8:11], s22 offen lds
    s_add_u32 m0, s48, 118784
    s_mov_b32 s22, 148224
    buffer_load_dwordx4 v45, s[8:11], s22 offen lds
    s_add_u32 m0, s48, 122880
    s_mov_b32 s22, 164608
    buffer_load_dwordx4 v45, s[8:11], s22 offen lds
    s_add_u32 m0, s48, 126976
    s_mov_b32 s22, 180992
    buffer_load_dwordx4 v45, s[8:11], s22 offen lds
    s_waitcnt vmcnt(28)
    s_barrier
    s_cmp_lg_u32 s20, 0
    s_cbranch_scc1 mega_kernel_rs_wo0
    v_xor_b32 v48, 0, v47
    v_add_u32 v48, 0, v48
    ds_read_b64_tr_b16 v[128:129], v48 offset:0
    ds_read_b64_tr_b16 v[130:131], v48 offset:512
    ds_read_b64_tr_b16 v[132:133], v48 offset:8192
    ds_read_b64_tr_b16 v[134:135], v48 offset:8704
    ds_read_b64_tr_b16 v[136:137], v48 offset:32
    ds_read_b64_tr_b16 v[138:139], v48 offset:544
    ds_read_b64_tr_b16 v[140:141], v48 offset:8224
    ds_read_b64_tr_b16 v[142:143], v48 offset:8736
    s_waitcnt lgkmcnt(0)
    v_xor_b32 v48, 64, v47
    v_add_u32 v48, 0, v48
    ds_read_b64_tr_b16 v[144:145], v48 offset:0
    ds_read_b64_tr_b16 v[146:147], v48 offset:512
    ds_read_b64_tr_b16 v[148:149], v48 offset:8192
    ds_read_b64_tr_b16 v[150:151], v48 offset:8704
    ds_read_b64_tr_b16 v[152:153], v48 offset:32
    ds_read_b64_tr_b16 v[154:155], v48 offset:544
    ds_read_b64_tr_b16 v[156:157], v48 offset:8224
    ds_read_b64_tr_b16 v[158:159], v48 offset:8736
    s_waitcnt lgkmcnt(0)
    v_xor_b32 v48, 128, v47
    v_add_u32 v48, 0, v48
    ds_read_b64_tr_b16 v[192:193], v48 offset:0
    ds_read_b64_tr_b16 v[194:195], v48 offset:512
    ds_read_b64_tr_b16 v[196:197], v48 offset:8192
    ds_read_b64_tr_b16 v[198:199], v48 offset:8704
    ds_read_b64_tr_b16 v[200:201], v48 offset:32
    ds_read_b64_tr_b16 v[202:203], v48 offset:544
    ds_read_b64_tr_b16 v[204:205], v48 offset:8224
    ds_read_b64_tr_b16 v[206:207], v48 offset:8736
    s_waitcnt lgkmcnt(0)
    v_xor_b32 v48, 192, v47
    v_add_u32 v48, 0, v48
    ds_read_b64_tr_b16 v[80:81], v48 offset:0
    ds_read_b64_tr_b16 v[82:83], v48 offset:512
    ds_read_b64_tr_b16 v[84:85], v48 offset:8192
    ds_read_b64_tr_b16 v[86:87], v48 offset:8704
    ds_read_b64_tr_b16 v[88:89], v48 offset:32
    ds_read_b64_tr_b16 v[90:91], v48 offset:544
    ds_read_b64_tr_b16 v[92:93], v48 offset:8224
    ds_read_b64_tr_b16 v[94:95], v48 offset:8736
    s_waitcnt lgkmcnt(0)
mega_kernel_rs_wo0:
    s_barrier
    s_mov_b32 s8, s54
    s_mov_b32 s9, s55
    s_add_u32 m0, s48, 0
    s_mov_b32 s22, 0
    buffer_load_dwordx4 v44, s[8:11], s22 offen lds
    s_add_u32 m0, s48, 4096
    s_mov_b32 s22, 32768
    buffer_load_dwordx4 v44, s[8:11], s22 offen lds
    s_add_u32 m0, s48, 8192
    s_mov_b32 s22, 65536
    buffer_load_dwordx4 v44, s[8:11], s22 offen lds
    s_add_u32 m0, s48, 12288
    s_mov_b32 s22, 98304
    buffer_load_dwordx4 v44, s[8:11], s22 offen lds
    s_waitcnt vmcnt(28)
    s_barrier
    s_cmp_lg_u32 s20, 1
    s_cbranch_scc1 mega_kernel_rs_wo1
    v_xor_b32 v48, 0, v47
    v_add_u32 v48, 16384, v48
    ds_read_b64_tr_b16 v[128:129], v48 offset:0
    ds_read_b64_tr_b16 v[130:131], v48 offset:512
    ds_read_b64_tr_b16 v[132:133], v48 offset:8192
    ds_read_b64_tr_b16 v[134:135], v48 offset:8704
    ds_read_b64_tr_b16 v[136:137], v48 offset:32
    ds_read_b64_tr_b16 v[138:139], v48 offset:544
    ds_read_b64_tr_b16 v[140:141], v48 offset:8224
    ds_read_b64_tr_b16 v[142:143], v48 offset:8736
    s_waitcnt lgkmcnt(0)
    v_xor_b32 v48, 64, v47
    v_add_u32 v48, 16384, v48
    ds_read_b64_tr_b16 v[144:145], v48 offset:0
    ds_read_b64_tr_b16 v[146:147], v48 offset:512
    ds_read_b64_tr_b16 v[148:149], v48 offset:8192
    ds_read_b64_tr_b16 v[150:151], v48 offset:8704
    ds_read_b64_tr_b16 v[152:153], v48 offset:32
    ds_read_b64_tr_b16 v[154:155], v48 offset:544
    ds_read_b64_tr_b16 v[156:157], v48 offset:8224
    ds_read_b64_tr_b16 v[158:159], v48 offset:8736
    s_waitcnt lgkmcnt(0)
    v_xor_b32 v48, 128, v47
    v_add_u32 v48, 16384, v48
    ds_read_b64_tr_b16 v[192:193], v48 offset:0
    ds_read_b64_tr_b16 v[194:195], v48 offset:512
    ds_read_b64_tr_b16 v[196:197], v48 offset:8192
    ds_read_b64_tr_b16 v[198:199], v48 offset:8704
    ds_read_b64_tr_b16 v[200:201], v48 offset:32
    ds_read_b64_tr_b16 v[202:203], v48 offset:544
    ds_read_b64_tr_b16 v[204:205], v48 offset:8224
    ds_read_b64_tr_b16 v[206:207], v48 offset:8736
    s_waitcnt lgkmcnt(0)
    v_xor_b32 v48, 192, v47
    v_add_u32 v48, 16384, v48
    ds_read_b64_tr_b16 v[80:81], v48 offset:0
    ds_read_b64_tr_b16 v[82:83], v48 offset:512
    ds_read_b64_tr_b16 v[84:85], v48 offset:8192
    ds_read_b64_tr_b16 v[86:87], v48 offset:8704
    ds_read_b64_tr_b16 v[88:89], v48 offset:32
    ds_read_b64_tr_b16 v[90:91], v48 offset:544
    ds_read_b64_tr_b16 v[92:93], v48 offset:8224
    ds_read_b64_tr_b16 v[94:95], v48 offset:8736
    s_waitcnt lgkmcnt(0)
mega_kernel_rs_wo1:
    s_barrier
    s_add_u32 m0, s48, 16384
    s_mov_b32 s22, 524288
    buffer_load_dwordx4 v44, s[8:11], s22 offen lds
    s_add_u32 m0, s48, 20480
    s_mov_b32 s22, 557056
    buffer_load_dwordx4 v44, s[8:11], s22 offen lds
    s_add_u32 m0, s48, 24576
    s_mov_b32 s22, 589824
    buffer_load_dwordx4 v44, s[8:11], s22 offen lds
    s_add_u32 m0, s48, 28672
    s_mov_b32 s22, 622592
    buffer_load_dwordx4 v44, s[8:11], s22 offen lds
    s_waitcnt vmcnt(28)
    s_barrier
    s_cmp_lg_u32 s20, 2
    s_cbranch_scc1 mega_kernel_rs_wo2
    v_xor_b32 v48, 0, v47
    v_add_u32 v48, 32768, v48
    ds_read_b64_tr_b16 v[128:129], v48 offset:0
    ds_read_b64_tr_b16 v[130:131], v48 offset:512
    ds_read_b64_tr_b16 v[132:133], v48 offset:8192
    ds_read_b64_tr_b16 v[134:135], v48 offset:8704
    ds_read_b64_tr_b16 v[136:137], v48 offset:32
    ds_read_b64_tr_b16 v[138:139], v48 offset:544
    ds_read_b64_tr_b16 v[140:141], v48 offset:8224
    ds_read_b64_tr_b16 v[142:143], v48 offset:8736
    s_waitcnt lgkmcnt(0)
    v_xor_b32 v48, 64, v47
    v_add_u32 v48, 32768, v48
    ds_read_b64_tr_b16 v[144:145], v48 offset:0
    ds_read_b64_tr_b16 v[146:147], v48 offset:512
    ds_read_b64_tr_b16 v[148:149], v48 offset:8192
    ds_read_b64_tr_b16 v[150:151], v48 offset:8704
    ds_read_b64_tr_b16 v[152:153], v48 offset:32
    ds_read_b64_tr_b16 v[154:155], v48 offset:544
    ds_read_b64_tr_b16 v[156:157], v48 offset:8224
    ds_read_b64_tr_b16 v[158:159], v48 offset:8736
    s_waitcnt lgkmcnt(0)
    v_xor_b32 v48, 128, v47
    v_add_u32 v48, 32768, v48
    ds_read_b64_tr_b16 v[192:193], v48 offset:0
    ds_read_b64_tr_b16 v[194:195], v48 offset:512
    ds_read_b64_tr_b16 v[196:197], v48 offset:8192
    ds_read_b64_tr_b16 v[198:199], v48 offset:8704
    ds_read_b64_tr_b16 v[200:201], v48 offset:32
    ds_read_b64_tr_b16 v[202:203], v48 offset:544
    ds_read_b64_tr_b16 v[204:205], v48 offset:8224
    ds_read_b64_tr_b16 v[206:207], v48 offset:8736
    s_waitcnt lgkmcnt(0)
    v_xor_b32 v48, 192, v47
    v_add_u32 v48, 32768, v48
    ds_read_b64_tr_b16 v[80:81], v48 offset:0
    ds_read_b64_tr_b16 v[82:83], v48 offset:512
    ds_read_b64_tr_b16 v[84:85], v48 offset:8192
    ds_read_b64_tr_b16 v[86:87], v48 offset:8704
    ds_read_b64_tr_b16 v[88:89], v48 offset:32
    ds_read_b64_tr_b16 v[90:91], v48 offset:544
    ds_read_b64_tr_b16 v[92:93], v48 offset:8224
    ds_read_b64_tr_b16 v[94:95], v48 offset:8736
    s_waitcnt lgkmcnt(0)
mega_kernel_rs_wo2:
    s_barrier
    s_add_u32 m0, s48, 32768
    s_mov_b32 s22, 1048576
    buffer_load_dwordx4 v44, s[8:11], s22 offen lds
    s_add_u32 m0, s48, 36864
    s_mov_b32 s22, 1081344
    buffer_load_dwordx4 v44, s[8:11], s22 offen lds
    s_add_u32 m0, s48, 40960
    s_mov_b32 s22, 1114112
    buffer_load_dwordx4 v44, s[8:11], s22 offen lds
    s_add_u32 m0, s48, 45056
    s_mov_b32 s22, 1146880
    buffer_load_dwordx4 v44, s[8:11], s22 offen lds
    s_waitcnt vmcnt(28)
    s_barrier
    s_cmp_lg_u32 s20, 3
    s_cbranch_scc1 mega_kernel_rs_wo3
    v_xor_b32 v48, 0, v47
    v_add_u32 v48, 49152, v48
    ds_read_b64_tr_b16 v[128:129], v48 offset:0
    ds_read_b64_tr_b16 v[130:131], v48 offset:512
    ds_read_b64_tr_b16 v[132:133], v48 offset:8192
    ds_read_b64_tr_b16 v[134:135], v48 offset:8704
    ds_read_b64_tr_b16 v[136:137], v48 offset:32
    ds_read_b64_tr_b16 v[138:139], v48 offset:544
    ds_read_b64_tr_b16 v[140:141], v48 offset:8224
    ds_read_b64_tr_b16 v[142:143], v48 offset:8736
    s_waitcnt lgkmcnt(0)
    v_xor_b32 v48, 64, v47
    v_add_u32 v48, 49152, v48
    ds_read_b64_tr_b16 v[144:145], v48 offset:0
    ds_read_b64_tr_b16 v[146:147], v48 offset:512
    ds_read_b64_tr_b16 v[148:149], v48 offset:8192
    ds_read_b64_tr_b16 v[150:151], v48 offset:8704
    ds_read_b64_tr_b16 v[152:153], v48 offset:32
    ds_read_b64_tr_b16 v[154:155], v48 offset:544
    ds_read_b64_tr_b16 v[156:157], v48 offset:8224
    ds_read_b64_tr_b16 v[158:159], v48 offset:8736
    s_waitcnt lgkmcnt(0)
    v_xor_b32 v48, 128, v47
    v_add_u32 v48, 49152, v48
    ds_read_b64_tr_b16 v[192:193], v48 offset:0
    ds_read_b64_tr_b16 v[194:195], v48 offset:512
    ds_read_b64_tr_b16 v[196:197], v48 offset:8192
    ds_read_b64_tr_b16 v[198:199], v48 offset:8704
    ds_read_b64_tr_b16 v[200:201], v48 offset:32
    ds_read_b64_tr_b16 v[202:203], v48 offset:544
    ds_read_b64_tr_b16 v[204:205], v48 offset:8224
    ds_read_b64_tr_b16 v[206:207], v48 offset:8736
    s_waitcnt lgkmcnt(0)
    v_xor_b32 v48, 192, v47
    v_add_u32 v48, 49152, v48
    ds_read_b64_tr_b16 v[80:81], v48 offset:0
    ds_read_b64_tr_b16 v[82:83], v48 offset:512
    ds_read_b64_tr_b16 v[84:85], v48 offset:8192
    ds_read_b64_tr_b16 v[86:87], v48 offset:8704
    ds_read_b64_tr_b16 v[88:89], v48 offset:32
    ds_read_b64_tr_b16 v[90:91], v48 offset:544
    ds_read_b64_tr_b16 v[92:93], v48 offset:8224
    ds_read_b64_tr_b16 v[94:95], v48 offset:8736
    s_waitcnt lgkmcnt(0)
mega_kernel_rs_wo3:
    s_barrier
    s_add_u32 m0, s48, 49152
    s_mov_b32 s22, 1572864
    buffer_load_dwordx4 v44, s[8:11], s22 offen lds
    s_add_u32 m0, s48, 53248
    s_mov_b32 s22, 1605632
    buffer_load_dwordx4 v44, s[8:11], s22 offen lds
    s_add_u32 m0, s48, 57344
    s_mov_b32 s22, 1638400
    buffer_load_dwordx4 v44, s[8:11], s22 offen lds
    s_add_u32 m0, s48, 61440
    s_mov_b32 s22, 1671168
    buffer_load_dwordx4 v44, s[8:11], s22 offen lds
    s_waitcnt vmcnt(28)
    s_barrier
    s_cmp_lg_u32 s20, 0
    s_cbranch_scc1 mega_kernel_rs_wo4
    v_xor_b32 v48, 0, v47
    v_add_u32 v48, 65536, v48
    ds_read_b64_tr_b16 v[160:161], v48 offset:0
    ds_read_b64_tr_b16 v[162:163], v48 offset:512
    ds_read_b64_tr_b16 v[164:165], v48 offset:8192
    ds_read_b64_tr_b16 v[166:167], v48 offset:8704
    ds_read_b64_tr_b16 v[168:169], v48 offset:32
    ds_read_b64_tr_b16 v[170:171], v48 offset:544
    ds_read_b64_tr_b16 v[172:173], v48 offset:8224
    ds_read_b64_tr_b16 v[174:175], v48 offset:8736
    s_waitcnt lgkmcnt(0)
    v_xor_b32 v48, 64, v47
    v_add_u32 v48, 65536, v48
    ds_read_b64_tr_b16 v[176:177], v48 offset:0
    ds_read_b64_tr_b16 v[178:179], v48 offset:512
    ds_read_b64_tr_b16 v[180:181], v48 offset:8192
    ds_read_b64_tr_b16 v[182:183], v48 offset:8704
    ds_read_b64_tr_b16 v[184:185], v48 offset:32
    ds_read_b64_tr_b16 v[186:187], v48 offset:544
    ds_read_b64_tr_b16 v[188:189], v48 offset:8224
    ds_read_b64_tr_b16 v[190:191], v48 offset:8736
    s_waitcnt lgkmcnt(0)
    v_xor_b32 v48, 128, v47
    v_add_u32 v48, 65536, v48
    ds_read_b64_tr_b16 v[96:97], v48 offset:0
    ds_read_b64_tr_b16 v[98:99], v48 offset:512
    ds_read_b64_tr_b16 v[100:101], v48 offset:8192
    ds_read_b64_tr_b16 v[102:103], v48 offset:8704
    ds_read_b64_tr_b16 v[104:105], v48 offset:32
    ds_read_b64_tr_b16 v[106:107], v48 offset:544
    ds_read_b64_tr_b16 v[108:109], v48 offset:8224
    ds_read_b64_tr_b16 v[110:111], v48 offset:8736
    s_waitcnt lgkmcnt(0)
    v_xor_b32 v48, 192, v47
    v_add_u32 v48, 65536, v48
    ds_read_b64_tr_b16 v[112:113], v48 offset:0
    ds_read_b64_tr_b16 v[114:115], v48 offset:512
    ds_read_b64_tr_b16 v[116:117], v48 offset:8192
    ds_read_b64_tr_b16 v[118:119], v48 offset:8704
    ds_read_b64_tr_b16 v[120:121], v48 offset:32
    ds_read_b64_tr_b16 v[122:123], v48 offset:544
    ds_read_b64_tr_b16 v[124:125], v48 offset:8224
    ds_read_b64_tr_b16 v[126:127], v48 offset:8736
    s_waitcnt lgkmcnt(0)
mega_kernel_rs_wo4:
    s_barrier
    s_add_u32 m0, s48, 65536
    s_mov_b32 s22, 2097152
    buffer_load_dwordx4 v44, s[8:11], s22 offen lds
    s_add_u32 m0, s48, 69632
    s_mov_b32 s22, 2129920
    buffer_load_dwordx4 v44, s[8:11], s22 offen lds
    s_add_u32 m0, s48, 73728
    s_mov_b32 s22, 2162688
    buffer_load_dwordx4 v44, s[8:11], s22 offen lds
    s_add_u32 m0, s48, 77824
    s_mov_b32 s22, 2195456
    buffer_load_dwordx4 v44, s[8:11], s22 offen lds
    s_waitcnt vmcnt(28)
    s_barrier
    s_cmp_lg_u32 s20, 1
    s_cbranch_scc1 mega_kernel_rs_wo5
    v_xor_b32 v48, 0, v47
    v_add_u32 v48, 81920, v48
    ds_read_b64_tr_b16 v[160:161], v48 offset:0
    ds_read_b64_tr_b16 v[162:163], v48 offset:512
    ds_read_b64_tr_b16 v[164:165], v48 offset:8192
    ds_read_b64_tr_b16 v[166:167], v48 offset:8704
    ds_read_b64_tr_b16 v[168:169], v48 offset:32
    ds_read_b64_tr_b16 v[170:171], v48 offset:544
    ds_read_b64_tr_b16 v[172:173], v48 offset:8224
    ds_read_b64_tr_b16 v[174:175], v48 offset:8736
    s_waitcnt lgkmcnt(0)
    v_xor_b32 v48, 64, v47
    v_add_u32 v48, 81920, v48
    ds_read_b64_tr_b16 v[176:177], v48 offset:0
    ds_read_b64_tr_b16 v[178:179], v48 offset:512
    ds_read_b64_tr_b16 v[180:181], v48 offset:8192
    ds_read_b64_tr_b16 v[182:183], v48 offset:8704
    ds_read_b64_tr_b16 v[184:185], v48 offset:32
    ds_read_b64_tr_b16 v[186:187], v48 offset:544
    ds_read_b64_tr_b16 v[188:189], v48 offset:8224
    ds_read_b64_tr_b16 v[190:191], v48 offset:8736
    s_waitcnt lgkmcnt(0)
    v_xor_b32 v48, 128, v47
    v_add_u32 v48, 81920, v48
    ds_read_b64_tr_b16 v[96:97], v48 offset:0
    ds_read_b64_tr_b16 v[98:99], v48 offset:512
    ds_read_b64_tr_b16 v[100:101], v48 offset:8192
    ds_read_b64_tr_b16 v[102:103], v48 offset:8704
    ds_read_b64_tr_b16 v[104:105], v48 offset:32
    ds_read_b64_tr_b16 v[106:107], v48 offset:544
    ds_read_b64_tr_b16 v[108:109], v48 offset:8224
    ds_read_b64_tr_b16 v[110:111], v48 offset:8736
    s_waitcnt lgkmcnt(0)
    v_xor_b32 v48, 192, v47
    v_add_u32 v48, 81920, v48
    ds_read_b64_tr_b16 v[112:113], v48 offset:0
    ds_read_b64_tr_b16 v[114:115], v48 offset:512
    ds_read_b64_tr_b16 v[116:117], v48 offset:8192
    ds_read_b64_tr_b16 v[118:119], v48 offset:8704
    ds_read_b64_tr_b16 v[120:121], v48 offset:32
    ds_read_b64_tr_b16 v[122:123], v48 offset:544
    ds_read_b64_tr_b16 v[124:125], v48 offset:8224
    ds_read_b64_tr_b16 v[126:127], v48 offset:8736
    s_waitcnt lgkmcnt(0)
mega_kernel_rs_wo5:
    s_barrier
    s_add_u32 m0, s48, 81920
    s_mov_b32 s22, 2621440
    buffer_load_dwordx4 v44, s[8:11], s22 offen lds
    s_add_u32 m0, s48, 86016
    s_mov_b32 s22, 2654208
    buffer_load_dwordx4 v44, s[8:11], s22 offen lds
    s_add_u32 m0, s48, 90112
    s_mov_b32 s22, 2686976
    buffer_load_dwordx4 v44, s[8:11], s22 offen lds
    s_add_u32 m0, s48, 94208
    s_mov_b32 s22, 2719744
    buffer_load_dwordx4 v44, s[8:11], s22 offen lds
    s_waitcnt vmcnt(28)
    s_barrier
    s_cmp_lg_u32 s20, 2
    s_cbranch_scc1 mega_kernel_rs_wo6
    v_xor_b32 v48, 0, v47
    v_add_u32 v48, 98304, v48
    ds_read_b64_tr_b16 v[160:161], v48 offset:0
    ds_read_b64_tr_b16 v[162:163], v48 offset:512
    ds_read_b64_tr_b16 v[164:165], v48 offset:8192
    ds_read_b64_tr_b16 v[166:167], v48 offset:8704
    ds_read_b64_tr_b16 v[168:169], v48 offset:32
    ds_read_b64_tr_b16 v[170:171], v48 offset:544
    ds_read_b64_tr_b16 v[172:173], v48 offset:8224
    ds_read_b64_tr_b16 v[174:175], v48 offset:8736
    s_waitcnt lgkmcnt(0)
    v_xor_b32 v48, 64, v47
    v_add_u32 v48, 98304, v48
    ds_read_b64_tr_b16 v[176:177], v48 offset:0
    ds_read_b64_tr_b16 v[178:179], v48 offset:512
    ds_read_b64_tr_b16 v[180:181], v48 offset:8192
    ds_read_b64_tr_b16 v[182:183], v48 offset:8704
    ds_read_b64_tr_b16 v[184:185], v48 offset:32
    ds_read_b64_tr_b16 v[186:187], v48 offset:544
    ds_read_b64_tr_b16 v[188:189], v48 offset:8224
    ds_read_b64_tr_b16 v[190:191], v48 offset:8736
    s_waitcnt lgkmcnt(0)
    v_xor_b32 v48, 128, v47
    v_add_u32 v48, 98304, v48
    ds_read_b64_tr_b16 v[96:97], v48 offset:0
    ds_read_b64_tr_b16 v[98:99], v48 offset:512
    ds_read_b64_tr_b16 v[100:101], v48 offset:8192
    ds_read_b64_tr_b16 v[102:103], v48 offset:8704
    ds_read_b64_tr_b16 v[104:105], v48 offset:32
    ds_read_b64_tr_b16 v[106:107], v48 offset:544
    ds_read_b64_tr_b16 v[108:109], v48 offset:8224
    ds_read_b64_tr_b16 v[110:111], v48 offset:8736
    s_waitcnt lgkmcnt(0)
    v_xor_b32 v48, 192, v47
    v_add_u32 v48, 98304, v48
    ds_read_b64_tr_b16 v[112:113], v48 offset:0
    ds_read_b64_tr_b16 v[114:115], v48 offset:512
    ds_read_b64_tr_b16 v[116:117], v48 offset:8192
    ds_read_b64_tr_b16 v[118:119], v48 offset:8704
    ds_read_b64_tr_b16 v[120:121], v48 offset:32
    ds_read_b64_tr_b16 v[122:123], v48 offset:544
    ds_read_b64_tr_b16 v[124:125], v48 offset:8224
    ds_read_b64_tr_b16 v[126:127], v48 offset:8736
    s_waitcnt lgkmcnt(0)
mega_kernel_rs_wo6:
    s_barrier
    s_add_u32 m0, s48, 98304
    s_mov_b32 s22, 3145728
    buffer_load_dwordx4 v44, s[8:11], s22 offen lds
    s_add_u32 m0, s48, 102400
    s_mov_b32 s22, 3178496
    buffer_load_dwordx4 v44, s[8:11], s22 offen lds
    s_add_u32 m0, s48, 106496
    s_mov_b32 s22, 3211264
    buffer_load_dwordx4 v44, s[8:11], s22 offen lds
    s_add_u32 m0, s48, 110592
    s_mov_b32 s22, 3244032
    buffer_load_dwordx4 v44, s[8:11], s22 offen lds
    s_waitcnt vmcnt(28)
    s_barrier
    s_cmp_lg_u32 s20, 3
    s_cbranch_scc1 mega_kernel_rs_wo7
    v_xor_b32 v48, 0, v47
    v_add_u32 v48, 114688, v48
    ds_read_b64_tr_b16 v[160:161], v48 offset:0
    ds_read_b64_tr_b16 v[162:163], v48 offset:512
    ds_read_b64_tr_b16 v[164:165], v48 offset:8192
    ds_read_b64_tr_b16 v[166:167], v48 offset:8704
    ds_read_b64_tr_b16 v[168:169], v48 offset:32
    ds_read_b64_tr_b16 v[170:171], v48 offset:544
    ds_read_b64_tr_b16 v[172:173], v48 offset:8224
    ds_read_b64_tr_b16 v[174:175], v48 offset:8736
    s_waitcnt lgkmcnt(0)
    v_xor_b32 v48, 64, v47
    v_add_u32 v48, 114688, v48
    ds_read_b64_tr_b16 v[176:177], v48 offset:0
    ds_read_b64_tr_b16 v[178:179], v48 offset:512
    ds_read_b64_tr_b16 v[180:181], v48 offset:8192
    ds_read_b64_tr_b16 v[182:183], v48 offset:8704
    ds_read_b64_tr_b16 v[184:185], v48 offset:32
    ds_read_b64_tr_b16 v[186:187], v48 offset:544
    ds_read_b64_tr_b16 v[188:189], v48 offset:8224
    ds_read_b64_tr_b16 v[190:191], v48 offset:8736
    s_waitcnt lgkmcnt(0)
    v_xor_b32 v48, 128, v47
    v_add_u32 v48, 114688, v48
    ds_read_b64_tr_b16 v[96:97], v48 offset:0
    ds_read_b64_tr_b16 v[98:99], v48 offset:512
    ds_read_b64_tr_b16 v[100:101], v48 offset:8192
    ds_read_b64_tr_b16 v[102:103], v48 offset:8704
    ds_read_b64_tr_b16 v[104:105], v48 offset:32
    ds_read_b64_tr_b16 v[106:107], v48 offset:544
    ds_read_b64_tr_b16 v[108:109], v48 offset:8224
    ds_read_b64_tr_b16 v[110:111], v48 offset:8736
    s_waitcnt lgkmcnt(0)
    v_xor_b32 v48, 192, v47
    v_add_u32 v48, 114688, v48
    ds_read_b64_tr_b16 v[112:113], v48 offset:0
    ds_read_b64_tr_b16 v[114:115], v48 offset:512
    ds_read_b64_tr_b16 v[116:117], v48 offset:8192
    ds_read_b64_tr_b16 v[118:119], v48 offset:8704
    ds_read_b64_tr_b16 v[120:121], v48 offset:32
    ds_read_b64_tr_b16 v[122:123], v48 offset:544
    ds_read_b64_tr_b16 v[124:125], v48 offset:8224
    ds_read_b64_tr_b16 v[126:127], v48 offset:8736
    s_waitcnt lgkmcnt(0)
mega_kernel_rs_wo7:
    s_barrier
    s_add_u32 m0, s48, 114688
    s_mov_b32 s22, 3670016
    buffer_load_dwordx4 v44, s[8:11], s22 offen lds
    s_add_u32 m0, s48, 118784
    s_mov_b32 s22, 3702784
    buffer_load_dwordx4 v44, s[8:11], s22 offen lds
    s_add_u32 m0, s48, 122880
    s_mov_b32 s22, 3735552
    buffer_load_dwordx4 v44, s[8:11], s22 offen lds
    s_add_u32 m0, s48, 126976
    s_mov_b32 s22, 3768320
    buffer_load_dwordx4 v44, s[8:11], s22 offen lds
    s_waitcnt vmcnt(28)
    s_barrier
    v_add_u32 v48, 0, v46
    ds_read_b64_tr_b16 v[64:65], v48 offset:0
    ds_read_b64_tr_b16 v[66:67], v48 offset:512
    ds_read_b64_tr_b16 v[68:69], v48 offset:8192
    ds_read_b64_tr_b16 v[70:71], v48 offset:8704
    ds_read_b64_tr_b16 v[72:73], v48 offset:8
    ds_read_b64_tr_b16 v[74:75], v48 offset:520
    ds_read_b64_tr_b16 v[76:77], v48 offset:8200
    ds_read_b64_tr_b16 v[78:79], v48 offset:8712
    s_waitcnt lgkmcnt(0)
    s_barrier
    ds_write_b128 v32, v[64:67] offset:0
    ds_write_b128 v32, v[68:71] offset:1024
    ds_write_b128 v32, v[72:75] offset:2048
    ds_write_b128 v32, v[76:79] offset:3072
    s_waitcnt lgkmcnt(0)
    s_waitcnt vmcnt(24)
    s_barrier
    v_add_u32 v48, 16384, v46
    ds_read_b64_tr_b16 v[64:65], v48 offset:0
    ds_read_b64_tr_b16 v[66:67], v48 offset:512
    ds_read_b64_tr_b16 v[68:69], v48 offset:8192
    ds_read_b64_tr_b16 v[70:71], v48 offset:8704
    ds_read_b64_tr_b16 v[72:73], v48 offset:8
    ds_read_b64_tr_b16 v[74:75], v48 offset:520
    ds_read_b64_tr_b16 v[76:77], v48 offset:8200
    ds_read_b64_tr_b16 v[78:79], v48 offset:8712
    s_waitcnt lgkmcnt(0)
    s_barrier
    ds_write_b128 v32, v[64:67] offset:16384
    ds_write_b128 v32, v[68:71] offset:17408
    ds_write_b128 v32, v[72:75] offset:18432
    ds_write_b128 v32, v[76:79] offset:19456
    s_waitcnt lgkmcnt(0)
    s_waitcnt vmcnt(20)
    s_barrier
    v_add_u32 v48, 32768, v46
    ds_read_b64_tr_b16 v[64:65], v48 offset:0
    ds_read_b64_tr_b16 v[66:67], v48 offset:512
    ds_read_b64_tr_b16 v[68:69], v48 offset:8192
    ds_read_b64_tr_b16 v[70:71], v48 offset:8704
    ds_read_b64_tr_b16 v[72:73], v48 offset:8
    ds_read_b64_tr_b16 v[74:75], v48 offset:520
    ds_read_b64_tr_b16 v[76:77], v48 offset:8200
    ds_read_b64_tr_b16 v[78:79], v48 offset:8712
    s_waitcnt lgkmcnt(0)
    s_barrier
    ds_write_b128 v32, v[64:67] offset:32768
    ds_write_b128 v32, v[68:71] offset:33792
    ds_write_b128 v32, v[72:75] offset:34816
    ds_write_b128 v32, v[76:79] offset:35840
    s_waitcnt lgkmcnt(0)
    s_waitcnt vmcnt(16)
    s_barrier
    v_add_u32 v48, 49152, v46
    ds_read_b64_tr_b16 v[64:65], v48 offset:0
    ds_read_b64_tr_b16 v[66:67], v48 offset:512
    ds_read_b64_tr_b16 v[68:69], v48 offset:8192
    ds_read_b64_tr_b16 v[70:71], v48 offset:8704
    ds_read_b64_tr_b16 v[72:73], v48 offset:8
    ds_read_b64_tr_b16 v[74:75], v48 offset:520
    ds_read_b64_tr_b16 v[76:77], v48 offset:8200
    ds_read_b64_tr_b16 v[78:79], v48 offset:8712
    s_waitcnt lgkmcnt(0)
    s_barrier
    ds_write_b128 v32, v[64:67] offset:49152
    ds_write_b128 v32, v[68:71] offset:50176
    ds_write_b128 v32, v[72:75] offset:51200
    ds_write_b128 v32, v[76:79] offset:52224
    s_waitcnt lgkmcnt(0)
    s_waitcnt vmcnt(12)
    s_barrier
    v_add_u32 v48, 65536, v46
    ds_read_b64_tr_b16 v[64:65], v48 offset:0
    ds_read_b64_tr_b16 v[66:67], v48 offset:512
    ds_read_b64_tr_b16 v[68:69], v48 offset:8192
    ds_read_b64_tr_b16 v[70:71], v48 offset:8704
    ds_read_b64_tr_b16 v[72:73], v48 offset:8
    ds_read_b64_tr_b16 v[74:75], v48 offset:520
    ds_read_b64_tr_b16 v[76:77], v48 offset:8200
    ds_read_b64_tr_b16 v[78:79], v48 offset:8712
    s_waitcnt lgkmcnt(0)
    s_barrier
    ds_write_b128 v33, v[64:67] offset:0
    ds_write_b128 v33, v[68:71] offset:1024
    ds_write_b128 v33, v[72:75] offset:2048
    ds_write_b128 v33, v[76:79] offset:3072
    s_waitcnt lgkmcnt(0)
    s_waitcnt vmcnt(8)
    s_barrier
    v_add_u32 v48, 81920, v46
    ds_read_b64_tr_b16 v[208:209], v48 offset:0
    ds_read_b64_tr_b16 v[210:211], v48 offset:512
    ds_read_b64_tr_b16 v[212:213], v48 offset:8192
    ds_read_b64_tr_b16 v[214:215], v48 offset:8704
    ds_read_b64_tr_b16 v[216:217], v48 offset:8
    ds_read_b64_tr_b16 v[218:219], v48 offset:520
    ds_read_b64_tr_b16 v[220:221], v48 offset:8200
    ds_read_b64_tr_b16 v[222:223], v48 offset:8712
    s_waitcnt lgkmcnt(0)
    s_barrier
    ds_write_b128 v33, v[80:83] offset:16384
    ds_write_b128 v33, v[84:87] offset:17408
    ds_write_b128 v33, v[88:91] offset:18432
    ds_write_b128 v33, v[92:95] offset:19456
    s_waitcnt lgkmcnt(0)
    s_waitcnt vmcnt(4)
    s_barrier
    v_add_u32 v48, 98304, v46
    ds_read_b64_tr_b16 v[224:225], v48 offset:0
    ds_read_b64_tr_b16 v[226:227], v48 offset:512
    ds_read_b64_tr_b16 v[228:229], v48 offset:8192
    ds_read_b64_tr_b16 v[230:231], v48 offset:8704
    ds_read_b64_tr_b16 v[232:233], v48 offset:8
    ds_read_b64_tr_b16 v[234:235], v48 offset:520
    ds_read_b64_tr_b16 v[236:237], v48 offset:8200
    ds_read_b64_tr_b16 v[238:239], v48 offset:8712
    s_waitcnt lgkmcnt(0)
    s_barrier
    ds_write_b128 v33, v[96:99] offset:32768
    ds_write_b128 v33, v[100:103] offset:33792
    ds_write_b128 v33, v[104:107] offset:34816
    ds_write_b128 v33, v[108:111] offset:35840
    s_waitcnt lgkmcnt(0)
    s_waitcnt vmcnt(0)
    s_barrier
    v_add_u32 v48, 114688, v46
    ds_read_b64_tr_b16 v[240:241], v48 offset:0
    ds_read_b64_tr_b16 v[242:243], v48 offset:512
    ds_read_b64_tr_b16 v[244:245], v48 offset:8192
    ds_read_b64_tr_b16 v[246:247], v48 offset:8704
    ds_read_b64_tr_b16 v[248:249], v48 offset:8
    ds_read_b64_tr_b16 v[250:251], v48 offset:520
    ds_read_b64_tr_b16 v[252:253], v48 offset:8200
    ds_read_b64_tr_b16 v[254:255], v48 offset:8712
    s_waitcnt lgkmcnt(0)
    s_barrier
    ds_write_b128 v33, v[112:115] offset:49152
    ds_write_b128 v33, v[116:119] offset:50176
    ds_write_b128 v33, v[120:123] offset:51200
    ds_write_b128 v33, v[124:127] offset:52224
    s_waitcnt lgkmcnt(0)
mega_kernel_rs_iw:
    buffer_load_dwordx2 v[48:49], v14, s[12:15], 0 offen offset:8 sc1
    s_waitcnt vmcnt(0)
    v_cmp_ne_u32 vcc, 64, v48
    s_cbranch_vccnz mega_kernel_rs_iw
    v_and_b32 v50, 0xffff, v49
    v_readfirstlane_b32 s60, v49
    v_cmp_ne_u32 vcc, s100, v50
    s_cbranch_vccnz mega_kernel_rs_iw
    s_lshr_b32 s60, s60, 15
    s_cmp_gt_u32 s60, s100
    s_cselect_b32 s60, 8192, 0
    s_bfe_u32 s22, s31, 0x10001
    s_lshl_b32 s22, s22, 12
    s_add_u32 s22, s22, s60
    s_lshl_b32 s23, s20, 10
    s_add_u32 s22, s22, s23
    s_add_u32 s38, s38, s22
    s_add_u32 s37, s37, s22
    s_xor_b32 s40, s38, 4096
    s_xor_b32 s39, s37, 4096
    s_xor_b32 s36, s35, 16384
    s_mov_b32 s21, 0
    s_cmp_eq_u32 s30, 0
    s_mov_b32 s22, 0x33003300
    s_cselect_b32 s16, 0x00330033, s22
    s_mov_b32 s17, s16
    s_cselect_b32 s18, -1, 0
    s_not_b32 s19, s18
    s_lshl_b32 s22, s31, 13
    s_lshl_b32 s23, s20, 11
    s_add_u32 s22, s22, s23
    s_add_u32 s43, s22, 16777216
    s_add_u32 s44, s22, 33554432
    s_lshl_b32 s45, s31, 12
    s_add_u32 s45, s45, 178257920
    s_mul_i32 s48, s20, 3072
    s_add_u32 m0, s48, 140288
    s_mov_b32 s41, 1
    s_mov_b32 s42, 1
    v_mov_b32 v0, v34
    v_bfrev_b32 v3, 1
    v_cndmask_b32 v10, v3, v10, s[16:17]
    v_cndmask_b32 v11, v3, v11, s[18:19]
    v_cndmask_b32 v9, v3, v9, s[26:27]
    s_sub_u32 s45, s45, 131072
    s_mov_b32 s50, 0
    s_cmp_lg_u32 s20, 3
    s_cbranch_scc1 mega_kernel_rs_kv0
mega_kernel_rs_kvb0:
    s_add_u32 s22, s21, 0
    s_min_u32 s22, s22, 63
    s_cmp_gt_u32 s50, s22
    s_cbranch_scc1 mega_kernel_rs_kvd0
    buffer_load_dword v48, v7, s[4:7], 0 offen sc1
    s_waitcnt vmcnt(0)
    v_readlane_b32 s50, v48, 0
    v_readlane_b32 s22, v48, 2
    v_readlane_b32 s23, v48, 1
    v_readlane_b32 s24, v48, 3
    s_nop 3
    s_min_u32 s50, s50, s22
    s_min_u32 s23, s23, s24
    s_lshl_b32 s50, s50, 1
    s_lshl_b32 s23, s23, 1
    s_add_u32 s23, s23, 1
    s_min_u32 s50, s50, s23
    s_branch mega_kernel_rs_kvb0
mega_kernel_rs_kvd0:
mega_kernel_rs_kv0:
    s_barrier
    s_cmp_eq_u32 s20, 1
    s_cbranch_scc1 mega_kernel_rs_w1_entry
    s_cmp_eq_u32 s20, 2
    s_cbranch_scc1 mega_kernel_rs_w2_entry
    s_cmp_eq_u32 s20, 3
    s_cbranch_scc1 mega_kernel_rs_w3_entry
mega_kernel_rs_w0_entry:
    v_mfma_f32_32x32x8_bf16 v[96:111], v[14:15], v[14:15], 0
    v_mfma_f32_16x16x16_bf16 v[112:115], v[14:15], v[14:15], 0
    v_mfma_f32_16x16x16_bf16 v[116:119], v[14:15], v[14:15], 0
    ds_read_b128 v[64:67], v1 offset:0
    ds_read_b128 v[68:71], v1 offset:1024
    ds_read_b128 v[72:75], v1 offset:2048
    ds_read_b128 v[76:79], v1 offset:3072
    ds_read_b128 v[80:83], v1 offset:16384
    ds_read_b128 v[84:87], v1 offset:17408
    ds_read_b128 v[88:91], v1 offset:18432
    ds_read_b128 v[92:95], v1 offset:19456
    buffer_load_dwordx4 v[120:123], v1, s[4:7], s44 offen
    buffer_load_dwordx4 v[124:127], v1, s[4:7], s44 offen offset:1024
    s_add_u32 s44, s44, 262144
mega_kernel_rs_w0_loop:
    s_add_u32 s22, s35, 0
    s_nop 15
    s_nop 15
    s_nop 7
    buffer_load_dwordx4 v[32:35], v12, s[4:7], s22 offen sc1
    buffer_load_dwordx4 v[36:39], v12, s[4:7], s22 offen offset:1024 sc1
mega_kernel_rs_w0_pa:
    s_waitcnt vmcnt(1)
    ds_write_b128 v6, v[32:35] offset:0
    s_waitcnt vmcnt(0)
    ds_write_b128 v6, v[36:39] offset:1024
    v_max3_u32 v3, v32, v34, v36
    v_max_u32 v3, v3, v38
    v_cmp_eq_u32 vcc, -1, v3
    v_smfmac_f32_16x16x64_bf16 v[96:99], v[32:35], a[0:7], v2
    v_smfmac_f32_16x16x64_bf16 v[100:103], v[32:35], a[8:15], v2
    v_smfmac_f32_16x16x64_bf16 v[104:107], v[32:35], a[128:135], v2
    s_cbranch_vccnz mega_kernel_rs_w0_pafail
    s_waitcnt lgkmcnt(0)
    s_barrier
    ds_read_b128 v[40:43], v6 offset:2048
    ds_read_b128 v[44:47], v6 offset:3072
    v_smfmac_f32_16x16x64_bf16 v[108:111], v[32:35], a[136:143], v2
    ds_read_b128 v[48:51], v6 offset:4096
    v_smfmac_f32_16x16x64_bf16 v[96:99], v[36:39], a[16:23], v2
    ds_read_b128 v[52:55], v6 offset:5120
    v_smfmac_f32_16x16x64_bf16 v[100:103], v[36:39], a[24:31], v2
    ds_read_b128 v[56:59], v6 offset:6144
    v_smfmac_f32_16x16x64_bf16 v[104:107], v[36:39], a[144:151], v2
    ds_read_b128 v[60:63], v6 offset:7168
    v_smfmac_f32_16x16x64_bf16 v[108:111], v[36:39], a[152:159], v2
    buffer_load_dwordx4 v1, s[4:7], s43 offen lds
    s_waitcnt lgkmcnt(5)
    v_smfmac_f32_16x16x64_bf16 v[96:99], v[40:43], a[32:39], v2
    v_smfmac_f32_16x16x64_bf16 v[100:103], v[40:43], a[40:47], v2
    v_smfmac_f32_16x16x64_bf16 v[104:107], v[40:43], a[160:167], v2
    v_smfmac_f32_16x16x64_bf16 v[108:111], v[40:43], a[168:175], v2
    buffer_load_dwordx4 v1, s[4:7], s43 offen offset:1024 lds
    s_waitcnt lgkmcnt(4)
    v_smfmac_f32_16x16x64_bf16 v[96:99], v[44:47], a[48:55], v2
    v_smfmac_f32_16x16x64_bf16 v[100:103], v[44:47], a[56:63], v2
    v_smfmac_f32_16x16x64_bf16 v[104:107], v[44:47], a[176:183], v2
    v_smfmac_f32_16x16x64_bf16 v[108:111], v[44:47], a[184:191], v2
    buffer_store_dwordx4 v[20:23], v10, s[4:7], s45 offen offset:0 sc1
    s_waitcnt lgkmcnt(3)
    v_smfmac_f32_16x16x64_bf16 v[96:99], v[48:51], a[64:71], v2
    v_smfmac_f32_16x16x64_bf16 v[100:103], v[48:51], a[72:79], v2
    v_smfmac_f32_16x16x64_bf16 v[104:107], v[48:51], a[192:199], v2
    v_smfmac_f32_16x16x64_bf16 v[108:111], v[48:51], a[200:207], v2
    buffer_store_dwordx2 v[18:19], v11, s[4:7], s45 offen offset:2048 sc1
    s_waitcnt lgkmcnt(2)
    v_smfmac_f32_16x16x64_bf16 v[96:99], v[52:55], a[80:87], v2
    v_smfmac_f32_16x16x64_bf16 v[100:103], v[52:55], a[88:95], v2
    v_smfmac_f32_16x16x64_bf16 v[104:107], v[52:55], a[208:215], v2
    v_smfmac_f32_16x16x64_bf16 v[108:111], v[52:55], a[216:223], v2
    s_waitcnt lgkmcnt(1)
    v_smfmac_f32_16x16x64_bf16 v[96:99], v[56:59], a[96:103], v2
    v_smfmac_f32_16x16x64_bf16 v[100:103], v[56:59], a[104:111], v2
    v_smfmac_f32_16x16x64_bf16 v[104:107], v[56:59], a[224:231], v2
    v_smfmac_f32_16x16x64_bf16 v[108:111], v[56:59], a[232:239], v2
    s_waitcnt lgkmcnt(0)
    v_smfmac_f32_16x16x64_bf16 v[96:99], v[60:63], a[112:119], v2
    v_smfmac_f32_16x16x64_bf16 v[100:103], v[60:63], a[120:127], v2
    v_smfmac_f32_16x16x64_bf16 v[104:107], v[60:63], a[240:247], v2
    v_smfmac_f32_16x16x64_bf16 v[108:111], v[60:63], a[248:255], v2
    s_nop 4
    v_pk_add_f32 v[96:97], v[96:97], v[98:99]
    v_pk_add_f32 v[100:101], v[100:101], v[102:103]
    v_pk_add_f32 v[104:105], v[104:105], v[106:107]
    v_pk_add_f32 v[108:109], v[108:109], v[110:111]
    v_cvt_pk_bf16_f32 v111, v108, v109
    v_cvt_pk_bf16_f32 v108, v96, v97
    v_cvt_pk_bf16_f32 v110, v100, v101
    v_cvt_pk_bf16_f32 v109, v104, v105
    v_and_or_b32 v108, v108, -2, s41
    buffer_store_dwordx4 v[108:111], v1, s[4:7], s37 offen sc1
    v_smfmac_f32_16x16x64_bf16 v[112:115], v[32:35], v[64:71], v2
    ds_read_b128 v[64:67], v1 offset:32768
    ds_read_b128 v[68:71], v1 offset:33792
    v_smfmac_f32_16x16x64_bf16 v[116:119], v[32:35], v[72:79], v2
    ds_read_b128 v[72:75], v1 offset:34816
    ds_read_b128 v[76:79], v1 offset:35840
    v_smfmac_f32_16x16x64_bf16 v[112:115], v[36:39], v[80:87], v2
    ds_read_b128 v[80:83], v1 offset:49152
    ds_read_b128 v[84:87], v1 offset:50176
    v_smfmac_f32_16x16x64_bf16 v[116:119], v[36:39], v[88:95], v2
    ds_read_b128 v[88:91], v1 offset:51200
    ds_read_b128 v[92:95], v1 offset:52224
    v_smfmac_f32_16x16x64_bf16 v[112:115], v[52:55], v[208:215], v2
    v_smfmac_f32_16x16x64_bf16 v[116:119], v[52:55], v[216:223], v2
    v_smfmac_f32_16x16x64_bf16 v[112:115], v[56:59], v[224:231], v2
    s_waitcnt lgkmcnt(6)
    v_smfmac_f32_16x16x64_bf16 v[112:115], v[40:43], v[64:71], v2
    ds_read_b128 v[64:67], v5 offset:0
    ds_read_b128 v[68:71], v5 offset:1024
    s_waitcnt lgkmcnt(6)
    v_smfmac_f32_16x16x64_bf16 v[116:119], v[40:43], v[72:79], v2
    ds_read_b128 v[72:75], v5 offset:2048
    ds_read_b128 v[76:79], v5 offset:3072
    v_smfmac_f32_16x16x64_bf16 v[116:119], v[56:59], v[232:239], v2
    v_smfmac_f32_16x16x64_bf16 v[112:115], v[60:63], v[240:247], v2
    v_smfmac_f32_16x16x64_bf16 v[116:119], v[60:63], v[248:255], v2
    s_waitcnt lgkmcnt(6)
    v_smfmac_f32_16x16x64_bf16 v[112:115], v[44:47], v[80:87], v2
    s_waitcnt lgkmcnt(4)
    v_smfmac_f32_16x16x64_bf16 v[116:119], v[44:47], v[88:95], v2
    s_waitcnt lgkmcnt(2)
    v_smfmac_f32_16x16x64_bf16 v[112:115], v[48:51], v[64:71], v2
    s_waitcnt lgkmcnt(0)
    v_smfmac_f32_16x16x64_bf16 v[116:119], v[48:51], v[72:79], v2
    v_mfma_f32_16x16x16_bf16 v[100:103], v[108:109], v[16:17], 0
    v_mfma_f32_16x16x16_bf16 v[104:107], v[110:111], v[16:17], 0
    s_nop 4
    v_add_f32 v112, v112, v114
    v_add_f32 v113, v113, v115
    v_add_f32 v114, v116, v118
    v_add_f32 v115, v117, v119
    v_and_or_b32 v112, v112, -2, s41
    s_waitcnt vmcnt(3)
    s_barrier
    ds_read_b128 v[32:35], v6 offset:9216
    ds_read_b128 v[36:39], v6 offset:10240
    ds_read_b128 v[40:43], v6 offset:12288
    ds_read_b128 v[44:47], v6 offset:13312
    ds_read_b128 v[48:51], v6 offset:15360
    ds_read_b128 v[52:55], v6 offset:16384
    ds_read_b128 v[56:59], v6 offset:18432
    ds_read_b128 v[60:63], v6 offset:19456
    buffer_load_dwordx4 v[96:99], v1, s[4:7], s38 offen sc1
    s_barrier
    buffer_store_dwordx4 v[112:115], v1, s[4:7], s39 offen sc1
    s_nop 15
    s_nop 15
    buffer_load_dwordx4 v[20:23], v1, s[4:7], s38 offen sc1
    s_waitcnt vmcnt(2)
    v_mfma_f32_16x16x16_bf16 v[80:83], v[96:97], v[16:17], v[100:103]
    v_mfma_f32_16x16x16_bf16 v[84:87], v[98:99], v[16:17], v[104:107]
    v_and_b32 v3, 1, v96
    v_cmp_ne_u32 vcc, s41, v3
    s_nop 4
    v_cvt_pk_bf16_f32 v64, v80, v81
    v_cvt_pk_bf16_f32 v65, v82, v83
    v_cvt_pk_bf16_f32 v66, v84, v85
    v_cvt_pk_bf16_f32 v67, v86, v87
    ds_write_b128 v6, v[64:67] offset:8192
    s_cbranch_vccnz mega_kernel_rs_w0_xslow
mega_kernel_rs_w0_xok:
    buffer_load_dwordx4 v[116:119], v1, s[4:7], s40 offen sc1
    s_waitcnt lgkmcnt(1)
    v_mfma_f32_16x16x32_bf16 v[80:83], v[32:35], v[64:67], 0
    s_waitcnt lgkmcnt(0)
    s_barrier
    ds_read_b128 v[68:71], v6 offset:11264
    ds_read_b128 v[72:75], v6 offset:14336
    ds_read_b128 v[76:79], v6 offset:17408
    v_mfma_f32_16x16x32_bf16 v[84:87], v[36:39], v[64:67], 0
    v_mfma_f32_16x16x32_bf16 v[88:91], v[64:67], v[64:67], 0
    buffer_load_dwordx4 v[20:23], v1, s[4:7], s40 offen sc1
    s_waitcnt lgkmcnt(2)
    v_mfma_f32_16x16x32_bf16 v[80:83], v[40:43], v[68:71], v[80:83]
    v_mfma_f32_16x16x32_bf16 v[84:87], v[44:47], v[68:71], v[84:87]
    v_mfma_f32_16x16x32_bf16 v[88:91], v[68:71], v[68:71], v[88:91]
    s_waitcnt lgkmcnt(1)
    v_mfma_f32_16x16x32_bf16 v[80:83], v[48:51], v[72:75], v[80:83]
    v_mfma_f32_16x16x32_bf16 v[84:87], v[52:55], v[72:75], v[84:87]
    v_mfma_f32_16x16x32_bf16 v[88:91], v[72:75], v[72:75], v[88:91]
    s_waitcnt lgkmcnt(0)
    v_mfma_f32_16x16x32_bf16 v[80:83], v[56:59], v[76:79], v[80:83]
    v_mfma_f32_16x16x32_bf16 v[84:87], v[60:63], v[76:79], v[84:87]
    v_mfma_f32_16x16x32_bf16 v[88:91], v[76:79], v[76:79], v[88:91]
    v_mfma_f32_32x32x4_2b_bf16 v[32:63], v[14:15], v[14:15], 0
    s_nop 4
    v_max3_f32 v4, v80, v81, v82
    v_max3_f32 v4, v4, v83, v84
    v_max3_f32 v4, v4, v85, v86
    v_max3_f32 v4, v4, v87, v88
    v_max_f32 v90, v4, v89
    v_max_f32 v4, v4, v89
    v_mov_b32 v73, 0
    s_nop 0
    v_permlane16_swap_b32 v4, v90
    v_max_f32 v4, v4, v90
    v_max_f32 v90, v4, v90
    s_nop 1
    v_permlane32_swap_b32 v4, v90
    v_max_f32 v4, v4, v90
    v_mul_f32 v4, s34, v4
    v_pk_fma_f32 v[80:81], v[80:81], s[34:35], v[4:5] op_sel_hi:[1,0,0] neg_lo:[0,0,1] neg_hi:[0,0,1]
    v_pk_fma_f32 v[82:83], v[82:83], s[34:35], v[4:5] op_sel_hi:[1,0,0] neg_lo:[0,0,1] neg_hi:[0,0,1]
    v_pk_fma_f32 v[84:85], v[84:85], s[34:35], v[4:5] op_sel_hi:[1,0,0] neg_lo:[0,0,1] neg_hi:[0,0,1]
    v_pk_fma_f32 v[86:87], v[86:87], s[34:35], v[4:5] op_sel_hi:[1,0,0] neg_lo:[0,0,1] neg_hi:[0,0,1]
    v_pk_fma_f32 v[88:89], v[88:89], s[34:35], v[4:5] op_sel_hi:[1,0,0] neg_lo:[0,0,1] neg_hi:[0,0,1]
    v_exp_f32 v80, v80
    v_exp_f32 v81, v81
    v_exp_f32 v82, v82
    v_cvt_pk_bf16_f32 v68, v80, v81
    v_exp_f32 v83, v83
    v_exp_f32 v84, v84
    v_cvt_pk_bf16_f32 v69, v82, v83
    v_exp_f32 v85, v85
    v_exp_f32 v86, v86
    v_cvt_pk_bf16_f32 v70, v84, v85
    v_exp_f32 v87, v87
    v_exp_f32 v88, v88
    v_cvt_pk_bf16_f32 v71, v86, v87
    v_exp_f32 v89, v89
    s_cmp_eq_u32 s21, 63
    v_mfma_f32_16x16x32_bf16 v[76:79], v[28:31], v[68:71], 0
    v_cvt_pk_bf16_f32 v72, v88, v89
    s_waitcnt vmcnt(1)
    v_and_b32 v3, 1, v116
    v_mfma_f32_16x16x32_bf16 v[100:103], v[120:123], v[68:71], 0
    v_cmp_ne_u32 vcc, s41, v3
    v_add_f32 v116, v112, v116
    v_mfma_f32_16x16x32_bf16 v[104:107], v[124:127], v[68:71], 0
    v_add_f32 v117, v113, v117
    v_add_f32 v118, v114, v118
    v_mfma_f32_16x16x16_bf16 v[76:79], v[28:29], v[72:73], v[76:79]
    v_add_f32 v119, v115, v119
    s_cbranch_vccnz mega_kernel_rs_w0_pv0
mega_kernel_rs_w0_pv2:
    v_cvt_pk_bf16_f32 v18, v116, v117
    v_cvt_pk_bf16_f32 v19, v118, v119
    v_cvt_pk_bf16_f32 v98, v118, v119
    v_mov_b32 v99, 0
    v_mfma_f32_16x16x16_bf16 v[100:103], v[18:19], v[72:73], v[100:103]
    s_nop 0
    v_mfma_f32_16x16x16_bf16 v[104:107], v[98:99], v[72:73], v[104:107]
    buffer_load_dwordx4 v[120:123], v1, s[4:7], s44 offen
    buffer_load_dwordx4 v[124:127], v1, s[4:7], s44 offen offset:1024
    s_cmp_eq_u32 s21, 63
    v_rcp_f32 v76, v76
    s_cbranch_scc1 mega_kernel_rs_w0_last
    s_mov_b64 exec, s[28:29]
    v_pk_mul_f32 v[100:101], v[100:101], v[76:77] op_sel_hi:[1,0]
    v_pk_mul_f32 v[102:103], v[102:103], v[76:77] op_sel_hi:[1,0]
    v_pk_mul_f32 v[104:105], v[104:105], v[76:77] op_sel_hi:[1,0]
    v_pk_mul_f32 v[106:107], v[106:107], v[76:77] op_sel_hi:[1,0]
    v_cvt_pk_bf16_f32 v72, v100, v101
    v_cvt_pk_bf16_f32 v73, v102, v103
    v_cvt_pk_bf16_f32 v74, v104, v105
    v_cvt_pk_bf16_f32 v75, v106, v107
    ds_write_b128 v6, v[72:75] offset:20448
    s_mov_b64 exec, -1
    ds_read_b128 v[88:91], v5 offset:16384
    ds_read_b128 v[92:95], v5 offset:17408
    ds_read_b128 v[80:83], v5 offset:18432
    ds_read_b128 v[84:87], v5 offset:19456
    ds_read_b128 v[112:115], v5 offset:32768
    ds_read_b128 v[116:119], v5 offset:33792
    v_mov_b32 v3, s21
    buffer_store_dword v3, v7, s[4:7], 0 offen sc1
    s_waitcnt lgkmcnt(6)
    s_barrier
    ds_read_b128 v[68:71], v6 offset:20480
    ds_read_b128 v[72:75], v6 offset:21504
    ds_read_b128 v[96:99], v5 offset:34816
    ds_read_b128 v[100:103], v5 offset:35840
    ds_read_b128 v[104:107], v5 offset:49152
    ds_read_b128 v[108:111], v5 offset:50176
    s_waitcnt lgkmcnt(5)
    v_smfmac_f32_16x16x64_bf16 v[32:35], v[68:71], v[128:135], v2
    s_add_u32 s21, s21, 1
    v_smfmac_f32_16x16x64_bf16 v[36:39], v[68:71], v[136:143], v2
    s_xor_b32 s38, s38, 1048576
    v_smfmac_f32_16x16x64_bf16 v[40:43], v[68:71], v[144:151], v2
    s_xor_b32 s37, s37, 1048576
    v_smfmac_f32_16x16x64_bf16 v[44:47], v[68:71], v[152:159], v2
    s_xor_b32 s40, s40, 1048576
    s_waitcnt lgkmcnt(4)
    v_smfmac_f32_16x16x64_bf16 v[32:35], v[72:75], v[160:167], v2
    s_xor_b32 s39, s39, 1048576
    v_smfmac_f32_16x16x64_bf16 v[36:39], v[72:75], v[168:175], v2
    s_lshr_b32 s41, s21, 1
    v_smfmac_f32_16x16x64_bf16 v[40:43], v[72:75], v[176:183], v2
    s_and_b32 s41, s41, 1
    v_smfmac_f32_16x16x64_bf16 v[44:47], v[72:75], v[184:191], v2
    s_xor_b32 s41, s41, 1
    v_smfmac_f32_16x16x64_bf16 v[48:51], v[68:71], v[192:199], v2
    s_xor_b32 s35, s35, 16384
    v_smfmac_f32_16x16x64_bf16 v[52:55], v[68:71], v[200:207], v2
    s_xor_b32 s36, s36, 16384
    s_waitcnt lgkmcnt(0)
    v_smfmac_f32_16x16x64_bf16 v[56:59], v[68:71], v[88:95], v2
    ds_read_b128 v[88:91], v5 offset:51200
    ds_read_b128 v[92:95], v5 offset:52224
    v_smfmac_f32_16x16x64_bf16 v[60:63], v[68:71], v[80:87], v2
    s_add_u32 s43, s43, 262144
    v_smfmac_f32_16x16x64_bf16 v[48:51], v[72:75], v[112:119], v2
    s_add_u32 s44, s44, 262144
    v_add_f32 v32, v32, v34
    v_add_f32 v33, v33, v35
    v_cvt_pk_bf16_f32 v32, v32, v33
    v_and_or_b32 v32, v32, -2, s42
    v_smfmac_f32_16x16x64_bf16 v[52:55], v[72:75], v[96:103], v2
    v_add_f32 v36, v36, v38
    v_add_f32 v37, v37, v39
    v_cvt_pk_bf16_f32 v33, v36, v37
    v_smfmac_f32_16x16x64_bf16 v[56:59], v[72:75], v[104:111], v2
    v_add_f32 v40, v40, v42
    v_add_f32 v41, v41, v43
    v_cvt_pk_bf16_f32 v34, v40, v41
    s_waitcnt lgkmcnt(0)
    v_smfmac_f32_16x16x64_bf16 v[60:63], v[72:75], v[88:95], v2
    v_add_f32 v44, v44, v46
    v_add_f32 v45, v45, v47
    v_cvt_pk_bf16_f32 v35, v44, v45
    buffer_store_dwordx4 v[32:35], v8, s[4:7], s46 offen sc1
    v_pk_add_f32 v[48:49], v[48:49], v[50:51]
    v_cvt_pk_bf16_f32 v48, v48, v49
    v_and_or_b32 v48, v48, -2, s42
    v_pk_add_f32 v[52:53], v[52:53], v[54:55]
    v_cvt_pk_bf16_f32 v49, v52, v53
    v_pk_add_f32 v[56:57], v[56:57], v[58:59]
    v_cvt_pk_bf16_f32 v50, v56, v57
    v_pk_add_f32 v[60:61], v[60:61], v[62:63]
    v_cvt_pk_bf16_f32 v51, v60, v61
    buffer_store_dwordx4 v[48:51], v8, s[4:7], s61 offen sc1
    s_waitcnt vmcnt(5)
    v_mov_b32 v20, v64
    v_mov_b32 v21, v65
    v_mov_b32 v22, v66
    v_mov_b32 v23, v67
    s_add_u32 s45, s45, 131072
    v_mfma_f32_32x32x8_bf16 v[96:111], v[14:15], v[14:15], 0
    v_mfma_f32_16x16x16_bf16 v[112:115], v[14:15], v[14:15], 0
    v_mfma_f32_16x16x16_bf16 v[116:119], v[14:15], v[14:15], 0
    ds_read_b128 v[64:67], v1 offset:0
    ds_read_b128 v[68:71], v1 offset:1024
    ds_read_b128 v[72:75], v1 offset:2048
    ds_read_b128 v[76:79], v1 offset:3072
    ds_read_b128 v[80:83], v1 offset:16384
    ds_read_b128 v[84:87], v1 offset:17408
    ds_read_b128 v[88:91], v1 offset:18432
    ds_read_b128 v[92:95], v1 offset:19456
    v_mov_b32 v58, -1
    v_mov_b32 v59, -1
    s_nop 15
    s_nop 15
    s_nop 15
mega_kernel_rs_w0_pc:
    buffer_load_dword v36, v13, s[4:7], s47 offen offset:0 sc1
    buffer_load_dword v37, v13, s[4:7], s47 offen offset:1024 sc1
    buffer_load_dword v38, v13, s[4:7], s47 offen offset:2048 sc1
    buffer_load_dword v39, v13, s[4:7], s47 offen offset:3072 sc1
    buffer_load_dword v40, v13, s[4:7], s25 offen offset:0 sc1
    buffer_load_dword v41, v13, s[4:7], s25 offen offset:1024 sc1
    buffer_load_dword v42, v13, s[4:7], s25 offen offset:2048 sc1
    buffer_load_dword v43, v13, s[4:7], s25 offen offset:3072 sc1
    s_waitcnt vmcnt(4)
    v_mfma_f32_16x16x32_bf16 v[52:55], v[36:39], v[24:27], 0
    v_bitop3_b32 v3, s42, v36, v37 bitop3:0x7e
    v_bitop3_b32 v4, s42, v38, v39 bitop3:0x7e
    s_waitcnt vmcnt(2)
    v_or_b32 v3, v3, v4
    v_bitop3_b32 v4, s42, v40, v41 bitop3:0x7e
    s_waitcnt vmcnt(0)
    v_mfma_f32_16x16x32_bf16 v[52:55], v[40:43], v[24:27], v[52:55]
    v_bitop3_b32 v56, s42, v42, v43 bitop3:0x7e
    v_or3_b32 v3, v3, v4, v56
    v_and_b32 v3, v0, v3
    v_cmp_ne_u32 vcc, 0, v3
    s_cbranch_vccnz mega_kernel_rs_w0_pc
    s_nop 2
    v_cvt_pk_bf16_f32 v56, v52, v53
    v_cvt_pk_bf16_f32 v57, v54, v55
    v_min_u32 v56, -2, v56
    s_mov_b64 exec, s[26:27]
    buffer_store_dwordx2 v[56:57], v9, s[4:7], s35 offen offset:0 sc1
    buffer_store_dwordx2 v[58:59], v9, s[4:7], s36 offen offset:0 sc1
    s_mov_b64 exec, -1
    s_xor_b32 s42, s42, 1
    s_branch mega_kernel_rs_w0_loop
mega_kernel_rs_w0_last:
    s_waitcnt vmcnt(0)
    v_mov_b32 v20, v64
    v_mov_b32 v21, v65
    v_mov_b32 v22, v66
    v_mov_b32 v23, v67
    s_add_u32 s45, s45, 131072
    buffer_store_dwordx4 v[20:23], v10, s[4:7], s45 offen offset:0 sc1
    buffer_store_dwordx2 v[18:19], v11, s[4:7], s45 offen offset:2048 sc1
    s_branch mega_kernel_rs_end
mega_kernel_rs_w0_pafail:
    buffer_load_dwordx4 v[32:35], v12, s[4:7], s22 offen sc1
    buffer_load_dwordx4 v[36:39], v12, s[4:7], s22 offen offset:1024 sc1
    s_nop 7
    v_mov_b32 v96, 0
    v_mov_b32 v97, 0
    v_mov_b32 v98, 0
    v_mov_b32 v99, 0
    v_mov_b32 v100, 0
    v_mov_b32 v101, 0
    v_mov_b32 v102, 0
    v_mov_b32 v103, 0
    v_mov_b32 v104, 0
    v_mov_b32 v105, 0
    v_mov_b32 v106, 0
    v_mov_b32 v107, 0
    s_branch mega_kernel_rs_w0_pa
mega_kernel_rs_w0_xslow:
    buffer_load_dwordx4 v[96:99], v1, s[4:7], s38 offen sc1
    s_waitcnt vmcnt(1)
    v_and_b32 v3, 1, v20
    v_cmp_ne_u32 vcc, s41, v3
    s_cbranch_vccz mega_kernel_rs_w0_xgot1
    buffer_load_dwordx4 v[20:23], v1, s[4:7], s38 offen sc1
mega_kernel_rs_w0_px:
    s_waitcnt vmcnt(1)
    v_and_b32 v3, 1, v96
    v_cmp_ne_u32 vcc, s41, v3
    s_cbranch_vccz mega_kernel_rs_w0_xgot0
    buffer_load_dwordx4 v[96:99], v1, s[4:7], s38 offen sc1
    s_waitcnt vmcnt(1)
    v_and_b32 v3, 1, v20
    v_cmp_ne_u32 vcc, s41, v3
    s_cbranch_vccz mega_kernel_rs_w0_xgot1
    buffer_load_dwordx4 v[20:23], v1, s[4:7], s38 offen sc1
    s_branch mega_kernel_rs_w0_px
mega_kernel_rs_w0_xgot0:
    v_mfma_f32_16x16x16_bf16 v[80:83], v[96:97], v[16:17], v[100:103]
    v_mfma_f32_16x16x16_bf16 v[84:87], v[98:99], v[16:17], v[104:107]
    v_and_b32 v3, 1, v96
    v_cmp_ne_u32 vcc, s41, v3
    s_nop 4
    v_cvt_pk_bf16_f32 v64, v80, v81
    v_cvt_pk_bf16_f32 v65, v82, v83
    v_cvt_pk_bf16_f32 v66, v84, v85
    v_cvt_pk_bf16_f32 v67, v86, v87
    ds_write_b128 v6, v[64:67] offset:8192
    s_branch mega_kernel_rs_w0_xok
mega_kernel_rs_w0_xgot1:
    v_mfma_f32_16x16x16_bf16 v[80:83], v[20:21], v[16:17], v[100:103]
    v_mfma_f32_16x16x16_bf16 v[84:87], v[22:23], v[16:17], v[104:107]
    v_and_b32 v3, 1, v20
    v_cmp_ne_u32 vcc, s41, v3
    s_nop 4
    v_cvt_pk_bf16_f32 v64, v80, v81
    v_cvt_pk_bf16_f32 v65, v82, v83
    v_cvt_pk_bf16_f32 v66, v84, v85
    v_cvt_pk_bf16_f32 v67, v86, v87
    ds_write_b128 v6, v[64:67] offset:8192
    s_branch mega_kernel_rs_w0_xok
mega_kernel_rs_w0_pv0:
    s_waitcnt vmcnt(0)
    s_branch mega_kernel_rs_w0_pv1
mega_kernel_rs_w0_pv:
    buffer_load_dwordx4 v[20:23], v1, s[4:7], s40 offen sc1
    s_waitcnt vmcnt(0)
mega_kernel_rs_w0_pv1:
    v_and_b32 v3, 1, v20
    v_cmp_ne_u32 vcc, s41, v3
    v_pk_add_f32 v[116:117], v[112:113], v[20:21]
    v_pk_add_f32 v[118:119], v[114:115], v[22:23]
    s_cbranch_vccnz mega_kernel_rs_w0_pv
    s_branch mega_kernel_rs_w0_pv2
mega_kernel_rs_w1_entry:
    v_mfma_f32_32x32x8_bf16 v[96:111], v[14:15], v[14:15], 0
    v_mfma_f32_16x16x16_bf16 v[112:115], v[14:15], v[14:15], 0
    v_mfma_f32_16x16x16_bf16 v[116:119], v[14:15], v[14:15], 0
    ds_read_b128 v[64:67], v1 offset:4096
    ds_read_b128 v[68:71], v1 offset:5120
    ds_read_b128 v[72:75], v1 offset:6144
    ds_read_b128 v[76:79], v1 offset:7168
    ds_read_b128 v[80:83], v1 offset:20480
    ds_read_b128 v[84:87], v1 offset:21504
    ds_read_b128 v[88:91], v1 offset:22528
    ds_read_b128 v[92:95], v1 offset:23552
    buffer_load_dwordx4 v[120:123], v1, s[4:7], s44 offen
    buffer_load_dwordx4 v[124:127], v1, s[4:7], s44 offen offset:1024
    s_add_u32 s44, s44, 262144
mega_kernel_rs_w1_loop:
    s_add_u32 s22, s35, 2048
    s_nop 15
    s_nop 15
    s_nop 7
    buffer_load_dwordx4 v[40:43], v12, s[4:7], s22 offen sc1
    buffer_load_dwordx4 v[44:47], v12, s[4:7], s22 offen offset:1024 sc1
mega_kernel_rs_w1_pa:
    s_waitcnt vmcnt(1)
    ds_write_b128 v6, v[40:43] offset:2048
    s_waitcnt vmcnt(0)
    ds_write_b128 v6, v[44:47] offset:3072
    v_max3_u32 v3, v40, v42, v44
    v_max_u32 v3, v3, v46
    v_cmp_eq_u32 vcc, -1, v3
    v_smfmac_f32_16x16x64_bf16 v[96:99], v[40:43], a[32:39], v2
    v_smfmac_f32_16x16x64_bf16 v[100:103], v[40:43], a[40:47], v2
    v_smfmac_f32_16x16x64_bf16 v[104:107], v[40:43], a[160:167], v2
    s_cbranch_vccnz mega_kernel_rs_w1_pafail
    s_waitcnt lgkmcnt(0)
    s_barrier
    ds_read_b128 v[48:51], v6 offset:4096
    ds_read_b128 v[52:55], v6 offset:5120
    v_smfmac_f32_16x16x64_bf16 v[108:111], v[40:43], a[168:175], v2
    ds_read_b128 v[56:59], v6 offset:6144
    v_smfmac_f32_16x16x64_bf16 v[96:99], v[44:47], a[48:55], v2
    ds_read_b128 v[60:63], v6 offset:7168
    v_smfmac_f32_16x16x64_bf16 v[100:103], v[44:47], a[56:63], v2
    ds_read_b128 v[32:35], v6 offset:0
    v_smfmac_f32_16x16x64_bf16 v[104:107], v[44:47], a[176:183], v2
    ds_read_b128 v[36:39], v6 offset:1024
    v_smfmac_f32_16x16x64_bf16 v[108:111], v[44:47], a[184:191], v2
    buffer_load_dwordx4 v1, s[4:7], s43 offen lds
    s_waitcnt lgkmcnt(5)
    v_smfmac_f32_16x16x64_bf16 v[96:99], v[48:51], a[64:71], v2
    v_smfmac_f32_16x16x64_bf16 v[100:103], v[48:51], a[72:79], v2
    v_smfmac_f32_16x16x64_bf16 v[104:107], v[48:51], a[192:199], v2
    v_smfmac_f32_16x16x64_bf16 v[108:111], v[48:51], a[200:207], v2
    buffer_load_dwordx4 v1, s[4:7], s43 offen offset:1024 lds
    s_waitcnt lgkmcnt(4)
    v_smfmac_f32_16x16x64_bf16 v[96:99], v[52:55], a[80:87], v2
    v_smfmac_f32_16x16x64_bf16 v[100:103], v[52:55], a[88:95], v2
    v_smfmac_f32_16x16x64_bf16 v[104:107], v[52:55], a[208:215], v2
    v_smfmac_f32_16x16x64_bf16 v[108:111], v[52:55], a[216:223], v2
    buffer_store_dwordx4 v[20:23], v10, s[4:7], s45 offen offset:64 sc1
    s_waitcnt lgkmcnt(3)
    v_smfmac_f32_16x16x64_bf16 v[96:99], v[56:59], a[96:103], v2
    v_smfmac_f32_16x16x64_bf16 v[100:103], v[56:59], a[104:111], v2
    v_smfmac_f32_16x16x64_bf16 v[104:107], v[56:59], a[224:231], v2
    v_smfmac_f32_16x16x64_bf16 v[108:111], v[56:59], a[232:239], v2
    buffer_store_dwordx2 v[18:19], v11, s[4:7], s45 offen offset:2560 sc1
    s_waitcnt lgkmcnt(2)
    v_smfmac_f32_16x16x64_bf16 v[96:99], v[60:63], a[112:119], v2
    v_smfmac_f32_16x16x64_bf16 v[100:103], v[60:63], a[120:127], v2
    v_smfmac_f32_16x16x64_bf16 v[104:107], v[60:63], a[240:247], v2
    v_smfmac_f32_16x16x64_bf16 v[108:111], v[60:63], a[248:255], v2
    s_waitcnt lgkmcnt(1)
    v_smfmac_f32_16x16x64_bf16 v[96:99], v[32:35], a[0:7], v2
    v_smfmac_f32_16x16x64_bf16 v[100:103], v[32:35], a[8:15], v2
    v_smfmac_f32_16x16x64_bf16 v[104:107], v[32:35], a[128:135], v2
    v_smfmac_f32_16x16x64_bf16 v[108:111], v[32:35], a[136:143], v2
    s_waitcnt lgkmcnt(0)
    v_smfmac_f32_16x16x64_bf16 v[96:99], v[36:39], a[16:23], v2
    v_smfmac_f32_16x16x64_bf16 v[100:103], v[36:39], a[24:31], v2
    v_smfmac_f32_16x16x64_bf16 v[104:107], v[36:39], a[144:151], v2
    v_smfmac_f32_16x16x64_bf16 v[108:111], v[36:39], a[152:159], v2
    s_nop 4
    v_pk_add_f32 v[96:97], v[96:97], v[98:99]
    v_pk_add_f32 v[100:101], v[100:101], v[102:103]
    v_pk_add_f32 v[104:105], v[104:105], v[106:107]
    v_pk_add_f32 v[108:109], v[108:109], v[110:111]
    v_cvt_pk_bf16_f32 v111, v108, v109
    v_cvt_pk_bf16_f32 v108, v96, v97
    v_cvt_pk_bf16_f32 v110, v100, v101
    v_cvt_pk_bf16_f32 v109, v104, v105
    v_and_or_b32 v108, v108, -2, s41
    buffer_store_dwordx4 v[108:111], v1, s[4:7], s37 offen sc1
    v_smfmac_f32_16x16x64_bf16 v[112:115], v[32:35], v[64:71], v2
    ds_read_b128 v[64:67], v1 offset:36864
    ds_read_b128 v[68:71], v1 offset:37888
    v_smfmac_f32_16x16x64_bf16 v[116:119], v[32:35], v[72:79], v2
    ds_read_b128 v[72:75], v1 offset:38912
    ds_read_b128 v[76:79], v1 offset:39936
    v_smfmac_f32_16x16x64_bf16 v[112:115], v[36:39], v[80:87], v2
    ds_read_b128 v[80:83], v1 offset:53248
    ds_read_b128 v[84:87], v1 offset:54272
    v_smfmac_f32_16x16x64_bf16 v[116:119], v[36:39], v[88:95], v2
    ds_read_b128 v[88:91], v1 offset:55296
    ds_read_b128 v[92:95], v1 offset:56320
    v_smfmac_f32_16x16x64_bf16 v[112:115], v[52:55], v[208:215], v2
    v_smfmac_f32_16x16x64_bf16 v[116:119], v[52:55], v[216:223], v2
    v_smfmac_f32_16x16x64_bf16 v[112:115], v[56:59], v[224:231], v2
    s_waitcnt lgkmcnt(6)
    v_smfmac_f32_16x16x64_bf16 v[112:115], v[40:43], v[64:71], v2
    ds_read_b128 v[64:67], v5 offset:4096
    ds_read_b128 v[68:71], v5 offset:5120
    s_waitcnt lgkmcnt(6)
    v_smfmac_f32_16x16x64_bf16 v[116:119], v[40:43], v[72:79], v2
    ds_read_b128 v[72:75], v5 offset:6144
    ds_read_b128 v[76:79], v5 offset:7168
    v_smfmac_f32_16x16x64_bf16 v[116:119], v[56:59], v[232:239], v2
    v_smfmac_f32_16x16x64_bf16 v[112:115], v[60:63], v[240:247], v2
    v_smfmac_f32_16x16x64_bf16 v[116:119], v[60:63], v[248:255], v2
    s_waitcnt lgkmcnt(6)
    v_smfmac_f32_16x16x64_bf16 v[112:115], v[44:47], v[80:87], v2
    s_waitcnt lgkmcnt(4)
    v_smfmac_f32_16x16x64_bf16 v[116:119], v[44:47], v[88:95], v2
    s_waitcnt lgkmcnt(2)
    v_smfmac_f32_16x16x64_bf16 v[112:115], v[48:51], v[64:71], v2
    s_waitcnt lgkmcnt(0)
    v_smfmac_f32_16x16x64_bf16 v[116:119], v[48:51], v[72:79], v2
    v_mfma_f32_16x16x16_bf16 v[100:103], v[108:109], v[16:17], 0
    v_mfma_f32_16x16x16_bf16 v[104:107], v[110:111], v[16:17], 0
    s_nop 4
    v_add_f32 v112, v112, v114
    v_add_f32 v113, v113, v115
    v_add_f32 v114, v116, v118
    v_add_f32 v115, v117, v119
    v_and_or_b32 v112, v112, -2, s41
    s_waitcnt vmcnt(3)
    s_barrier
    ds_read_b128 v[32:35], v6 offset:12288
    ds_read_b128 v[36:39], v6 offset:13312
    ds_read_b128 v[40:43], v6 offset:9216
    ds_read_b128 v[44:47], v6 offset:10240
    ds_read_b128 v[48:51], v6 offset:18432
    ds_read_b128 v[52:55], v6 offset:19456
    ds_read_b128 v[56:59], v6 offset:15360
    ds_read_b128 v[60:63], v6 offset:16384
    buffer_load_dwordx4 v[96:99], v1, s[4:7], s38 offen sc1
    s_barrier
    buffer_store_dwordx4 v[112:115], v1, s[4:7], s39 offen sc1
    s_nop 15
    s_nop 15
    buffer_load_dwordx4 v[20:23], v1, s[4:7], s38 offen sc1
    s_waitcnt vmcnt(2)
    v_mfma_f32_16x16x16_bf16 v[80:83], v[96:97], v[16:17], v[100:103]
    v_mfma_f32_16x16x16_bf16 v[84:87], v[98:99], v[16:17], v[104:107]
    v_and_b32 v3, 1, v96
    v_cmp_ne_u32 vcc, s41, v3
    s_nop 4
    v_cvt_pk_bf16_f32 v64, v80, v81
    v_cvt_pk_bf16_f32 v65, v82, v83
    v_cvt_pk_bf16_f32 v66, v84, v85
    v_cvt_pk_bf16_f32 v67, v86, v87
    ds_write_b128 v6, v[64:67] offset:11264
    s_cbranch_vccnz mega_kernel_rs_w1_xslow
mega_kernel_rs_w1_xok:
    buffer_load_dwordx4 v[116:119], v1, s[4:7], s40 offen sc1
    s_waitcnt lgkmcnt(1)
    v_mfma_f32_16x16x32_bf16 v[80:83], v[32:35], v[64:67], 0
    s_waitcnt lgkmcnt(0)
    s_barrier
    ds_read_b128 v[68:71], v6 offset:8192
    ds_read_b128 v[72:75], v6 offset:17408
    ds_read_b128 v[76:79], v6 offset:14336
    v_mfma_f32_16x16x32_bf16 v[84:87], v[36:39], v[64:67], 0
    v_mfma_f32_16x16x32_bf16 v[88:91], v[64:67], v[64:67], 0
    buffer_load_dwordx4 v[20:23], v1, s[4:7], s40 offen sc1
    s_waitcnt lgkmcnt(2)
    v_mfma_f32_16x16x32_bf16 v[80:83], v[40:43], v[68:71], v[80:83]
    v_mfma_f32_16x16x32_bf16 v[84:87], v[44:47], v[68:71], v[84:87]
    v_mfma_f32_16x16x32_bf16 v[88:91], v[68:71], v[68:71], v[88:91]
    s_waitcnt lgkmcnt(1)
    v_mfma_f32_16x16x32_bf16 v[80:83], v[48:51], v[72:75], v[80:83]
    v_mfma_f32_16x16x32_bf16 v[84:87], v[52:55], v[72:75], v[84:87]
    v_mfma_f32_16x16x32_bf16 v[88:91], v[72:75], v[72:75], v[88:91]
    s_waitcnt lgkmcnt(0)
    v_mfma_f32_16x16x32_bf16 v[80:83], v[56:59], v[76:79], v[80:83]
    v_mfma_f32_16x16x32_bf16 v[84:87], v[60:63], v[76:79], v[84:87]
    v_mfma_f32_16x16x32_bf16 v[88:91], v[76:79], v[76:79], v[88:91]
    v_mfma_f32_32x32x4_2b_bf16 v[32:63], v[14:15], v[14:15], 0
    s_nop 4
    v_max3_f32 v4, v80, v81, v82
    v_max3_f32 v4, v4, v83, v84
    v_max3_f32 v4, v4, v85, v86
    v_max3_f32 v4, v4, v87, v88
    v_max_f32 v90, v4, v89
    v_max_f32 v4, v4, v89
    v_mov_b32 v73, 0
    s_nop 0
    v_permlane16_swap_b32 v4, v90
    v_max_f32 v4, v4, v90
    v_max_f32 v90, v4, v90
    s_nop 1
    v_permlane32_swap_b32 v4, v90
    v_max_f32 v4, v4, v90
    v_mul_f32 v4, s34, v4
    v_pk_fma_f32 v[80:81], v[80:81], s[34:35], v[4:5] op_sel_hi:[1,0,0] neg_lo:[0,0,1] neg_hi:[0,0,1]
    v_pk_fma_f32 v[82:83], v[82:83], s[34:35], v[4:5] op_sel_hi:[1,0,0] neg_lo:[0,0,1] neg_hi:[0,0,1]
    v_pk_fma_f32 v[84:85], v[84:85], s[34:35], v[4:5] op_sel_hi:[1,0,0] neg_lo:[0,0,1] neg_hi:[0,0,1]
    v_pk_fma_f32 v[86:87], v[86:87], s[34:35], v[4:5] op_sel_hi:[1,0,0] neg_lo:[0,0,1] neg_hi:[0,0,1]
    v_pk_fma_f32 v[88:89], v[88:89], s[34:35], v[4:5] op_sel_hi:[1,0,0] neg_lo:[0,0,1] neg_hi:[0,0,1]
    v_exp_f32 v80, v80
    v_exp_f32 v81, v81
    v_exp_f32 v82, v82
    v_cvt_pk_bf16_f32 v68, v80, v81
    v_exp_f32 v83, v83
    v_exp_f32 v84, v84
    v_cvt_pk_bf16_f32 v69, v82, v83
    v_exp_f32 v85, v85
    v_exp_f32 v86, v86
    v_cvt_pk_bf16_f32 v70, v84, v85
    v_exp_f32 v87, v87
    v_exp_f32 v88, v88
    v_cvt_pk_bf16_f32 v71, v86, v87
    v_exp_f32 v89, v89
    s_cmp_eq_u32 s21, 63
    v_mfma_f32_16x16x32_bf16 v[76:79], v[28:31], v[68:71], 0
    v_cvt_pk_bf16_f32 v72, v88, v89
    s_waitcnt vmcnt(1)
    v_and_b32 v3, 1, v116
    v_mfma_f32_16x16x32_bf16 v[100:103], v[120:123], v[68:71], 0
    v_cmp_ne_u32 vcc, s41, v3
    v_add_f32 v116, v112, v116
    v_mfma_f32_16x16x32_bf16 v[104:107], v[124:127], v[68:71], 0
    v_add_f32 v117, v113, v117
    v_add_f32 v118, v114, v118
    v_mfma_f32_16x16x16_bf16 v[76:79], v[28:29], v[72:73], v[76:79]
    v_add_f32 v119, v115, v119
    s_cbranch_vccnz mega_kernel_rs_w1_pv0
mega_kernel_rs_w1_pv2:
    v_cvt_pk_bf16_f32 v18, v116, v117
    v_cvt_pk_bf16_f32 v19, v118, v119
    v_cvt_pk_bf16_f32 v98, v118, v119
    v_mov_b32 v99, 0
    v_mfma_f32_16x16x16_bf16 v[100:103], v[18:19], v[72:73], v[100:103]
    s_nop 0
    v_mfma_f32_16x16x16_bf16 v[104:107], v[98:99], v[72:73], v[104:107]
    buffer_load_dwordx4 v[120:123], v1, s[4:7], s44 offen
    buffer_load_dwordx4 v[124:127], v1, s[4:7], s44 offen offset:1024
    s_cmp_eq_u32 s21, 63
    v_rcp_f32 v76, v76
    s_cbranch_scc1 mega_kernel_rs_w1_last
    s_mov_b64 exec, s[28:29]
    v_pk_mul_f32 v[100:101], v[100:101], v[76:77] op_sel_hi:[1,0]
    v_pk_mul_f32 v[102:103], v[102:103], v[76:77] op_sel_hi:[1,0]
    v_pk_mul_f32 v[104:105], v[104:105], v[76:77] op_sel_hi:[1,0]
    v_pk_mul_f32 v[106:107], v[106:107], v[76:77] op_sel_hi:[1,0]
    v_cvt_pk_bf16_f32 v72, v100, v101
    v_cvt_pk_bf16_f32 v73, v102, v103
    v_cvt_pk_bf16_f32 v74, v104, v105
    v_cvt_pk_bf16_f32 v75, v106, v107
    ds_write_b128 v6, v[72:75] offset:20480
    s_mov_b64 exec, -1
    ds_read_b128 v[88:91], v5 offset:20480
    ds_read_b128 v[92:95], v5 offset:21504
    ds_read_b128 v[80:83], v5 offset:22528
    ds_read_b128 v[84:87], v5 offset:23552
    ds_read_b128 v[112:115], v5 offset:36864
    ds_read_b128 v[116:119], v5 offset:37888
    s_waitcnt lgkmcnt(6)
    s_barrier
    ds_read_b128 v[68:71], v6 offset:20480
    ds_read_b128 v[72:75], v6 offset:21504
    ds_read_b128 v[96:99], v5 offset:38912
    ds_read_b128 v[100:103], v5 offset:39936
    ds_read_b128 v[104:107], v5 offset:53248
    ds_read_b128 v[108:111], v5 offset:54272
    s_waitcnt lgkmcnt(5)
    v_smfmac_f32_16x16x64_bf16 v[32:35], v[68:71], v[128:135], v2
    s_add_u32 s21, s21, 1
    v_smfmac_f32_16x16x64_bf16 v[36:39], v[68:71], v[136:143], v2
    s_xor_b32 s38, s38, 1048576
    v_smfmac_f32_16x16x64_bf16 v[40:43], v[68:71], v[144:151], v2
    s_xor_b32 s37, s37, 1048576
    v_smfmac_f32_16x16x64_bf16 v[44:47], v[68:71], v[152:159], v2
    s_xor_b32 s40, s40, 1048576
    s_waitcnt lgkmcnt(4)
    v_smfmac_f32_16x16x64_bf16 v[32:35], v[72:75], v[160:167], v2
    s_xor_b32 s39, s39, 1048576
    v_smfmac_f32_16x16x64_bf16 v[36:39], v[72:75], v[168:175], v2
    s_lshr_b32 s41, s21, 1
    v_smfmac_f32_16x16x64_bf16 v[40:43], v[72:75], v[176:183], v2
    s_and_b32 s41, s41, 1
    v_smfmac_f32_16x16x64_bf16 v[44:47], v[72:75], v[184:191], v2
    s_xor_b32 s41, s41, 1
    v_smfmac_f32_16x16x64_bf16 v[48:51], v[68:71], v[192:199], v2
    s_xor_b32 s35, s35, 16384
    v_smfmac_f32_16x16x64_bf16 v[52:55], v[68:71], v[200:207], v2
    s_xor_b32 s36, s36, 16384
    s_waitcnt lgkmcnt(0)
    v_smfmac_f32_16x16x64_bf16 v[56:59], v[68:71], v[88:95], v2
    ds_read_b128 v[88:91], v5 offset:55296
    ds_read_b128 v[92:95], v5 offset:56320
    v_smfmac_f32_16x16x64_bf16 v[60:63], v[68:71], v[80:87], v2
    s_add_u32 s43, s43, 262144
    v_smfmac_f32_16x16x64_bf16 v[48:51], v[72:75], v[112:119], v2
    s_add_u32 s44, s44, 262144
    v_add_f32 v32, v32, v34
    v_add_f32 v33, v33, v35
    v_cvt_pk_bf16_f32 v32, v32, v33
    v_and_or_b32 v32, v32, -2, s42
    v_smfmac_f32_16x16x64_bf16 v[52:55], v[72:75], v[96:103], v2
    v_add_f32 v36, v36, v38
    v_add_f32 v37, v37, v39
    v_cvt_pk_bf16_f32 v33, v36, v37
    v_smfmac_f32_16x16x64_bf16 v[56:59], v[72:75], v[104:111], v2
    v_add_f32 v40, v40, v42
    v_add_f32 v41, v41, v43
    v_cvt_pk_bf16_f32 v34, v40, v41
    s_waitcnt lgkmcnt(0)
    v_smfmac_f32_16x16x64_bf16 v[60:63], v[72:75], v[88:95], v2
    v_add_f32 v44, v44, v46
    v_add_f32 v45, v45, v47
    v_cvt_pk_bf16_f32 v35, v44, v45
    buffer_store_dwordx4 v[32:35], v8, s[4:7], s46 offen sc1
    v_pk_add_f32 v[48:49], v[48:49], v[50:51]
    v_cvt_pk_bf16_f32 v48, v48, v49
    v_and_or_b32 v48, v48, -2, s42
    v_pk_add_f32 v[52:53], v[52:53], v[54:55]
    v_cvt_pk_bf16_f32 v49, v52, v53
    v_pk_add_f32 v[56:57], v[56:57], v[58:59]
    v_cvt_pk_bf16_f32 v50, v56, v57
    v_pk_add_f32 v[60:61], v[60:61], v[62:63]
    v_cvt_pk_bf16_f32 v51, v60, v61
    buffer_store_dwordx4 v[48:51], v8, s[4:7], s61 offen sc1
    s_waitcnt vmcnt(4)
    v_mov_b32 v20, v64
    v_mov_b32 v21, v65
    v_mov_b32 v22, v66
    v_mov_b32 v23, v67
    s_add_u32 s45, s45, 131072
    v_mfma_f32_32x32x8_bf16 v[96:111], v[14:15], v[14:15], 0
    v_mfma_f32_16x16x16_bf16 v[112:115], v[14:15], v[14:15], 0
    v_mfma_f32_16x16x16_bf16 v[116:119], v[14:15], v[14:15], 0
    ds_read_b128 v[64:67], v1 offset:4096
    ds_read_b128 v[68:71], v1 offset:5120
    ds_read_b128 v[72:75], v1 offset:6144
    ds_read_b128 v[76:79], v1 offset:7168
    ds_read_b128 v[80:83], v1 offset:20480
    ds_read_b128 v[84:87], v1 offset:21504
    ds_read_b128 v[88:91], v1 offset:22528
    ds_read_b128 v[92:95], v1 offset:23552
    v_mov_b32 v58, -1
    v_mov_b32 v59, -1
    s_nop 15
    s_nop 15
    s_nop 15
mega_kernel_rs_w1_pc:
    buffer_load_dword v36, v13, s[4:7], s47 offen offset:64 sc1
    buffer_load_dword v37, v13, s[4:7], s47 offen offset:1088 sc1
    buffer_load_dword v38, v13, s[4:7], s47 offen offset:2112 sc1
    buffer_load_dword v39, v13, s[4:7], s47 offen offset:3136 sc1
    buffer_load_dword v40, v13, s[4:7], s25 offen offset:64 sc1
    buffer_load_dword v41, v13, s[4:7], s25 offen offset:1088 sc1
    buffer_load_dword v42, v13, s[4:7], s25 offen offset:2112 sc1
    buffer_load_dword v43, v13, s[4:7], s25 offen offset:3136 sc1
    s_waitcnt vmcnt(4)
    v_mfma_f32_16x16x32_bf16 v[52:55], v[36:39], v[24:27], 0
    v_bitop3_b32 v3, s42, v36, v37 bitop3:0x7e
    v_bitop3_b32 v4, s42, v38, v39 bitop3:0x7e
    s_waitcnt vmcnt(2)
    v_or_b32 v3, v3, v4
    v_bitop3_b32 v4, s42, v40, v41 bitop3:0x7e
    s_waitcnt vmcnt(0)
    v_mfma_f32_16x16x32_bf16 v[52:55], v[40:43], v[24:27], v[52:55]
    v_bitop3_b32 v56, s42, v42, v43 bitop3:0x7e
    v_or3_b32 v3, v3, v4, v56
    v_and_b32 v3, v0, v3
    v_cmp_ne_u32 vcc, 0, v3
    s_cbranch_vccnz mega_kernel_rs_w1_pc
    s_nop 2
    v_cvt_pk_bf16_f32 v56, v52, v53
    v_cvt_pk_bf16_f32 v57, v54, v55
    v_min_u32 v56, -2, v56
    s_mov_b64 exec, s[26:27]
    buffer_store_dwordx2 v[56:57], v9, s[4:7], s35 offen offset:64 sc1
    buffer_store_dwordx2 v[58:59], v9, s[4:7], s36 offen offset:64 sc1
    s_mov_b64 exec, -1
    s_xor_b32 s42, s42, 1
    s_branch mega_kernel_rs_w1_loop
mega_kernel_rs_w1_last:
    s_waitcnt vmcnt(0)
    v_mov_b32 v20, v64
    v_mov_b32 v21, v65
    v_mov_b32 v22, v66
    v_mov_b32 v23, v67
    s_add_u32 s45, s45, 131072
    buffer_store_dwordx4 v[20:23], v10, s[4:7], s45 offen offset:64 sc1
    buffer_store_dwordx2 v[18:19], v11, s[4:7], s45 offen offset:2560 sc1
    s_branch mega_kernel_rs_end
mega_kernel_rs_w1_pafail:
    buffer_load_dwordx4 v[40:43], v12, s[4:7], s22 offen sc1
    buffer_load_dwordx4 v[44:47], v12, s[4:7], s22 offen offset:1024 sc1
    s_nop 7
    v_mov_b32 v96, 0
    v_mov_b32 v97, 0
    v_mov_b32 v98, 0
    v_mov_b32 v99, 0
    v_mov_b32 v100, 0
    v_mov_b32 v101, 0
    v_mov_b32 v102, 0
    v_mov_b32 v103, 0
    v_mov_b32 v104, 0
    v_mov_b32 v105, 0
    v_mov_b32 v106, 0
    v_mov_b32 v107, 0
    s_branch mega_kernel_rs_w1_pa
mega_kernel_rs_w1_xslow:
    buffer_load_dwordx4 v[96:99], v1, s[4:7], s38 offen sc1
    s_waitcnt vmcnt(1)
    v_and_b32 v3, 1, v20
    v_cmp_ne_u32 vcc, s41, v3
    s_cbranch_vccz mega_kernel_rs_w1_xgot1
    buffer_load_dwordx4 v[20:23], v1, s[4:7], s38 offen sc1
mega_kernel_rs_w1_px:
    s_waitcnt vmcnt(1)
    v_and_b32 v3, 1, v96
    v_cmp_ne_u32 vcc, s41, v3
    s_cbranch_vccz mega_kernel_rs_w1_xgot0
    buffer_load_dwordx4 v[96:99], v1, s[4:7], s38 offen sc1
    s_waitcnt vmcnt(1)
    v_and_b32 v3, 1, v20
    v_cmp_ne_u32 vcc, s41, v3
    s_cbranch_vccz mega_kernel_rs_w1_xgot1
    buffer_load_dwordx4 v[20:23], v1, s[4:7], s38 offen sc1
    s_branch mega_kernel_rs_w1_px
mega_kernel_rs_w1_xgot0:
    v_mfma_f32_16x16x16_bf16 v[80:83], v[96:97], v[16:17], v[100:103]
    v_mfma_f32_16x16x16_bf16 v[84:87], v[98:99], v[16:17], v[104:107]
    v_and_b32 v3, 1, v96
    v_cmp_ne_u32 vcc, s41, v3
    s_nop 4
    v_cvt_pk_bf16_f32 v64, v80, v81
    v_cvt_pk_bf16_f32 v65, v82, v83
    v_cvt_pk_bf16_f32 v66, v84, v85
    v_cvt_pk_bf16_f32 v67, v86, v87
    ds_write_b128 v6, v[64:67] offset:11264
    s_branch mega_kernel_rs_w1_xok
mega_kernel_rs_w1_xgot1:
    v_mfma_f32_16x16x16_bf16 v[80:83], v[20:21], v[16:17], v[100:103]
    v_mfma_f32_16x16x16_bf16 v[84:87], v[22:23], v[16:17], v[104:107]
    v_and_b32 v3, 1, v20
    v_cmp_ne_u32 vcc, s41, v3
    s_nop 4
    v_cvt_pk_bf16_f32 v64, v80, v81
    v_cvt_pk_bf16_f32 v65, v82, v83
    v_cvt_pk_bf16_f32 v66, v84, v85
    v_cvt_pk_bf16_f32 v67, v86, v87
    ds_write_b128 v6, v[64:67] offset:11264
    s_branch mega_kernel_rs_w1_xok
mega_kernel_rs_w1_pv0:
    s_waitcnt vmcnt(0)
    s_branch mega_kernel_rs_w1_pv1
mega_kernel_rs_w1_pv:
    buffer_load_dwordx4 v[20:23], v1, s[4:7], s40 offen sc1
    s_waitcnt vmcnt(0)
mega_kernel_rs_w1_pv1:
    v_and_b32 v3, 1, v20
    v_cmp_ne_u32 vcc, s41, v3
    v_pk_add_f32 v[116:117], v[112:113], v[20:21]
    v_pk_add_f32 v[118:119], v[114:115], v[22:23]
    s_cbranch_vccnz mega_kernel_rs_w1_pv
    s_branch mega_kernel_rs_w1_pv2
mega_kernel_rs_w2_entry:
    v_mfma_f32_32x32x8_bf16 v[96:111], v[14:15], v[14:15], 0
    v_mfma_f32_16x16x16_bf16 v[112:115], v[14:15], v[14:15], 0
    v_mfma_f32_16x16x16_bf16 v[116:119], v[14:15], v[14:15], 0
    ds_read_b128 v[64:67], v1 offset:8192
    ds_read_b128 v[68:71], v1 offset:9216
    ds_read_b128 v[72:75], v1 offset:10240
    ds_read_b128 v[76:79], v1 offset:11264
    ds_read_b128 v[80:83], v1 offset:24576
    ds_read_b128 v[84:87], v1 offset:25600
    ds_read_b128 v[88:91], v1 offset:26624
    ds_read_b128 v[92:95], v1 offset:27648
    buffer_load_dwordx4 v[120:123], v1, s[4:7], s44 offen
    buffer_load_dwordx4 v[124:127], v1, s[4:7], s44 offen offset:1024
    s_add_u32 s44, s44, 262144
mega_kernel_rs_w2_loop:
    s_add_u32 s22, s35, 4096
    s_nop 15
    s_nop 15
    s_nop 7
    buffer_load_dwordx4 v[48:51], v12, s[4:7], s22 offen sc1
    buffer_load_dwordx4 v[52:55], v12, s[4:7], s22 offen offset:1024 sc1
mega_kernel_rs_w2_pa:
    s_waitcnt vmcnt(1)
    ds_write_b128 v6, v[48:51] offset:4096
    s_waitcnt vmcnt(0)
    ds_write_b128 v6, v[52:55] offset:5120
    v_max3_u32 v3, v48, v50, v52
    v_max_u32 v3, v3, v54
    v_cmp_eq_u32 vcc, -1, v3
    v_smfmac_f32_16x16x64_bf16 v[96:99], v[48:51], a[64:71], v2
    v_smfmac_f32_16x16x64_bf16 v[100:103], v[48:51], a[72:79], v2
    v_smfmac_f32_16x16x64_bf16 v[104:107], v[48:51], a[192:199], v2
    s_cbranch_vccnz mega_kernel_rs_w2_pafail
    s_waitcnt lgkmcnt(0)
    s_barrier
    ds_read_b128 v[56:59], v6 offset:6144
    ds_read_b128 v[60:63], v6 offset:7168
    v_smfmac_f32_16x16x64_bf16 v[108:111], v[48:51], a[200:207], v2
    ds_read_b128 v[32:35], v6 offset:0
    v_smfmac_f32_16x16x64_bf16 v[96:99], v[52:55], a[80:87], v2
    ds_read_b128 v[36:39], v6 offset:1024
    v_smfmac_f32_16x16x64_bf16 v[100:103], v[52:55], a[88:95], v2
    ds_read_b128 v[40:43], v6 offset:2048
    v_smfmac_f32_16x16x64_bf16 v[104:107], v[52:55], a[208:215], v2
    ds_read_b128 v[44:47], v6 offset:3072
    v_smfmac_f32_16x16x64_bf16 v[108:111], v[52:55], a[216:223], v2
    buffer_load_dwordx4 v1, s[4:7], s43 offen lds
    s_waitcnt lgkmcnt(5)
    v_smfmac_f32_16x16x64_bf16 v[96:99], v[56:59], a[96:103], v2
    v_smfmac_f32_16x16x64_bf16 v[100:103], v[56:59], a[104:111], v2
    v_smfmac_f32_16x16x64_bf16 v[104:107], v[56:59], a[224:231], v2
    v_smfmac_f32_16x16x64_bf16 v[108:111], v[56:59], a[232:239], v2
    buffer_load_dwordx4 v1, s[4:7], s43 offen offset:1024 lds
    s_waitcnt lgkmcnt(4)
    v_smfmac_f32_16x16x64_bf16 v[96:99], v[60:63], a[112:119], v2
    v_smfmac_f32_16x16x64_bf16 v[100:103], v[60:63], a[120:127], v2
    v_smfmac_f32_16x16x64_bf16 v[104:107], v[60:63], a[240:247], v2
    v_smfmac_f32_16x16x64_bf16 v[108:111], v[60:63], a[248:255], v2
    buffer_store_dwordx4 v[20:23], v10, s[4:7], s45 offen offset:128 sc1
    s_waitcnt lgkmcnt(3)
    v_smfmac_f32_16x16x64_bf16 v[96:99], v[32:35], a[0:7], v2
    v_smfmac_f32_16x16x64_bf16 v[100:103], v[32:35], a[8:15], v2
    v_smfmac_f32_16x16x64_bf16 v[104:107], v[32:35], a[128:135], v2
    v_smfmac_f32_16x16x64_bf16 v[108:111], v[32:35], a[136:143], v2
    buffer_store_dwordx2 v[18:19], v11, s[4:7], s45 offen offset:3072 sc1
    s_waitcnt lgkmcnt(2)
    v_smfmac_f32_16x16x64_bf16 v[96:99], v[36:39], a[16:23], v2
    v_smfmac_f32_16x16x64_bf16 v[100:103], v[36:39], a[24:31], v2
    v_smfmac_f32_16x16x64_bf16 v[104:107], v[36:39], a[144:151], v2
    v_smfmac_f32_16x16x64_bf16 v[108:111], v[36:39], a[152:159], v2
    s_waitcnt lgkmcnt(1)
    v_smfmac_f32_16x16x64_bf16 v[96:99], v[40:43], a[32:39], v2
    v_smfmac_f32_16x16x64_bf16 v[100:103], v[40:43], a[40:47], v2
    v_smfmac_f32_16x16x64_bf16 v[104:107], v[40:43], a[160:167], v2
    v_smfmac_f32_16x16x64_bf16 v[108:111], v[40:43], a[168:175], v2
    s_waitcnt lgkmcnt(0)
    v_smfmac_f32_16x16x64_bf16 v[96:99], v[44:47], a[48:55], v2
    v_smfmac_f32_16x16x64_bf16 v[100:103], v[44:47], a[56:63], v2
    v_smfmac_f32_16x16x64_bf16 v[104:107], v[44:47], a[176:183], v2
    v_smfmac_f32_16x16x64_bf16 v[108:111], v[44:47], a[184:191], v2
    s_nop 4
    v_pk_add_f32 v[96:97], v[96:97], v[98:99]
    v_pk_add_f32 v[100:101], v[100:101], v[102:103]
    v_pk_add_f32 v[104:105], v[104:105], v[106:107]
    v_pk_add_f32 v[108:109], v[108:109], v[110:111]
    v_cvt_pk_bf16_f32 v111, v108, v109
    v_cvt_pk_bf16_f32 v108, v96, v97
    v_cvt_pk_bf16_f32 v110, v100, v101
    v_cvt_pk_bf16_f32 v109, v104, v105
    v_and_or_b32 v108, v108, -2, s41
    buffer_store_dwordx4 v[108:111], v1, s[4:7], s37 offen sc1
    v_smfmac_f32_16x16x64_bf16 v[112:115], v[32:35], v[64:71], v2
    ds_read_b128 v[64:67], v1 offset:40960
    ds_read_b128 v[68:71], v1 offset:41984
    v_smfmac_f32_16x16x64_bf16 v[116:119], v[32:35], v[72:79], v2
    ds_read_b128 v[72:75], v1 offset:43008
    ds_read_b128 v[76:79], v1 offset:44032
    v_smfmac_f32_16x16x64_bf16 v[112:115], v[36:39], v[80:87], v2
    ds_read_b128 v[80:83], v1 offset:57344
    ds_read_b128 v[84:87], v1 offset:58368
    v_smfmac_f32_16x16x64_bf16 v[116:119], v[36:39], v[88:95], v2
    ds_read_b128 v[88:91], v1 offset:59392
    ds_read_b128 v[92:95], v1 offset:60416
    v_smfmac_f32_16x16x64_bf16 v[112:115], v[52:55], v[208:215], v2
    v_smfmac_f32_16x16x64_bf16 v[116:119], v[52:55], v[216:223], v2
    v_smfmac_f32_16x16x64_bf16 v[112:115], v[56:59], v[224:231], v2
    s_waitcnt lgkmcnt(6)
    v_smfmac_f32_16x16x64_bf16 v[112:115], v[40:43], v[64:71], v2
    ds_read_b128 v[64:67], v5 offset:8192
    ds_read_b128 v[68:71], v5 offset:9216
    s_waitcnt lgkmcnt(6)
    v_smfmac_f32_16x16x64_bf16 v[116:119], v[40:43], v[72:79], v2
    ds_read_b128 v[72:75], v5 offset:10240
    ds_read_b128 v[76:79], v5 offset:11264
    v_smfmac_f32_16x16x64_bf16 v[116:119], v[56:59], v[232:239], v2
    v_smfmac_f32_16x16x64_bf16 v[112:115], v[60:63], v[240:247], v2
    v_smfmac_f32_16x16x64_bf16 v[116:119], v[60:63], v[248:255], v2
    s_waitcnt lgkmcnt(6)
    v_smfmac_f32_16x16x64_bf16 v[112:115], v[44:47], v[80:87], v2
    s_waitcnt lgkmcnt(4)
    v_smfmac_f32_16x16x64_bf16 v[116:119], v[44:47], v[88:95], v2
    s_waitcnt lgkmcnt(2)
    v_smfmac_f32_16x16x64_bf16 v[112:115], v[48:51], v[64:71], v2
    s_waitcnt lgkmcnt(0)
    v_smfmac_f32_16x16x64_bf16 v[116:119], v[48:51], v[72:79], v2
    v_mfma_f32_16x16x16_bf16 v[100:103], v[108:109], v[16:17], 0
    v_mfma_f32_16x16x16_bf16 v[104:107], v[110:111], v[16:17], 0
    s_nop 4
    v_add_f32 v112, v112, v114
    v_add_f32 v113, v113, v115
    v_add_f32 v114, v116, v118
    v_add_f32 v115, v117, v119
    v_and_or_b32 v112, v112, -2, s41
    s_waitcnt vmcnt(3)
    s_barrier
    ds_read_b128 v[32:35], v6 offset:15360
    ds_read_b128 v[36:39], v6 offset:16384
    ds_read_b128 v[40:43], v6 offset:18432
    ds_read_b128 v[44:47], v6 offset:19456
    ds_read_b128 v[48:51], v6 offset:9216
    ds_read_b128 v[52:55], v6 offset:10240
    ds_read_b128 v[56:59], v6 offset:12288
    ds_read_b128 v[60:63], v6 offset:13312
    buffer_load_dwordx4 v[96:99], v1, s[4:7], s38 offen sc1
    s_barrier
    buffer_store_dwordx4 v[112:115], v1, s[4:7], s39 offen sc1
    s_nop 15
    s_nop 15
    buffer_load_dwordx4 v[20:23], v1, s[4:7], s38 offen sc1
    s_waitcnt vmcnt(2)
    v_mfma_f32_16x16x16_bf16 v[80:83], v[96:97], v[16:17], v[100:103]
    v_mfma_f32_16x16x16_bf16 v[84:87], v[98:99], v[16:17], v[104:107]
    v_and_b32 v3, 1, v96
    v_cmp_ne_u32 vcc, s41, v3
    s_nop 4
    v_cvt_pk_bf16_f32 v64, v80, v81
    v_cvt_pk_bf16_f32 v65, v82, v83
    v_cvt_pk_bf16_f32 v66, v84, v85
    v_cvt_pk_bf16_f32 v67, v86, v87
    ds_write_b128 v6, v[64:67] offset:14336
    s_cbranch_vccnz mega_kernel_rs_w2_xslow
mega_kernel_rs_w2_xok:
    buffer_load_dwordx4 v[116:119], v1, s[4:7], s40 offen sc1
    s_waitcnt lgkmcnt(1)
    v_mfma_f32_16x16x32_bf16 v[80:83], v[32:35], v[64:67], 0
    s_waitcnt lgkmcnt(0)
    s_barrier
    ds_read_b128 v[68:71], v6 offset:17408
    ds_read_b128 v[72:75], v6 offset:8192
    ds_read_b128 v[76:79], v6 offset:11264
    v_mfma_f32_16x16x32_bf16 v[84:87], v[36:39], v[64:67], 0
    v_mfma_f32_16x16x32_bf16 v[88:91], v[64:67], v[64:67], 0
    buffer_load_dwordx4 v[20:23], v1, s[4:7], s40 offen sc1
    s_waitcnt lgkmcnt(2)
    v_mfma_f32_16x16x32_bf16 v[80:83], v[40:43], v[68:71], v[80:83]
    v_mfma_f32_16x16x32_bf16 v[84:87], v[44:47], v[68:71], v[84:87]
    v_mfma_f32_16x16x32_bf16 v[88:91], v[68:71], v[68:71], v[88:91]
    s_waitcnt lgkmcnt(1)
    v_mfma_f32_16x16x32_bf16 v[80:83], v[48:51], v[72:75], v[80:83]
    v_mfma_f32_16x16x32_bf16 v[84:87], v[52:55], v[72:75], v[84:87]
    v_mfma_f32_16x16x32_bf16 v[88:91], v[72:75], v[72:75], v[88:91]
    s_waitcnt lgkmcnt(0)
    v_mfma_f32_16x16x32_bf16 v[80:83], v[56:59], v[76:79], v[80:83]
    v_mfma_f32_16x16x32_bf16 v[84:87], v[60:63], v[76:79], v[84:87]
    v_mfma_f32_16x16x32_bf16 v[88:91], v[76:79], v[76:79], v[88:91]
    v_mfma_f32_32x32x4_2b_bf16 v[32:63], v[14:15], v[14:15], 0
    s_nop 4
    v_max3_f32 v4, v80, v81, v82
    v_max3_f32 v4, v4, v83, v84
    v_max3_f32 v4, v4, v85, v86
    v_max3_f32 v4, v4, v87, v88
    v_max_f32 v90, v4, v89
    v_max_f32 v4, v4, v89
    v_mov_b32 v73, 0
    s_nop 0
    v_permlane16_swap_b32 v4, v90
    v_max_f32 v4, v4, v90
    v_max_f32 v90, v4, v90
    s_nop 1
    v_permlane32_swap_b32 v4, v90
    v_max_f32 v4, v4, v90
    v_mul_f32 v4, s34, v4
    v_pk_fma_f32 v[80:81], v[80:81], s[34:35], v[4:5] op_sel_hi:[1,0,0] neg_lo:[0,0,1] neg_hi:[0,0,1]
    v_pk_fma_f32 v[82:83], v[82:83], s[34:35], v[4:5] op_sel_hi:[1,0,0] neg_lo:[0,0,1] neg_hi:[0,0,1]
    v_pk_fma_f32 v[84:85], v[84:85], s[34:35], v[4:5] op_sel_hi:[1,0,0] neg_lo:[0,0,1] neg_hi:[0,0,1]
    v_pk_fma_f32 v[86:87], v[86:87], s[34:35], v[4:5] op_sel_hi:[1,0,0] neg_lo:[0,0,1] neg_hi:[0,0,1]
    v_pk_fma_f32 v[88:89], v[88:89], s[34:35], v[4:5] op_sel_hi:[1,0,0] neg_lo:[0,0,1] neg_hi:[0,0,1]
    v_exp_f32 v80, v80
    v_exp_f32 v81, v81
    v_exp_f32 v82, v82
    v_cvt_pk_bf16_f32 v68, v80, v81
    v_exp_f32 v83, v83
    v_exp_f32 v84, v84
    v_cvt_pk_bf16_f32 v69, v82, v83
    v_exp_f32 v85, v85
    v_exp_f32 v86, v86
    v_cvt_pk_bf16_f32 v70, v84, v85
    v_exp_f32 v87, v87
    v_exp_f32 v88, v88
    v_cvt_pk_bf16_f32 v71, v86, v87
    v_exp_f32 v89, v89
    s_cmp_eq_u32 s21, 63
    v_mfma_f32_16x16x32_bf16 v[76:79], v[28:31], v[68:71], 0
    v_cvt_pk_bf16_f32 v72, v88, v89
    s_waitcnt vmcnt(1)
    v_and_b32 v3, 1, v116
    v_mfma_f32_16x16x32_bf16 v[100:103], v[120:123], v[68:71], 0
    v_cmp_ne_u32 vcc, s41, v3
    v_add_f32 v116, v112, v116
    v_mfma_f32_16x16x32_bf16 v[104:107], v[124:127], v[68:71], 0
    v_add_f32 v117, v113, v117
    v_add_f32 v118, v114, v118
    v_mfma_f32_16x16x16_bf16 v[76:79], v[28:29], v[72:73], v[76:79]
    v_add_f32 v119, v115, v119
    s_cbranch_vccnz mega_kernel_rs_w2_pv0
mega_kernel_rs_w2_pv2:
    v_cvt_pk_bf16_f32 v18, v116, v117
    v_cvt_pk_bf16_f32 v19, v118, v119
    v_cvt_pk_bf16_f32 v98, v118, v119
    v_mov_b32 v99, 0
    v_mfma_f32_16x16x16_bf16 v[100:103], v[18:19], v[72:73], v[100:103]
    s_nop 0
    v_mfma_f32_16x16x16_bf16 v[104:107], v[98:99], v[72:73], v[104:107]
    buffer_load_dwordx4 v[120:123], v1, s[4:7], s44 offen
    buffer_load_dwordx4 v[124:127], v1, s[4:7], s44 offen offset:1024
    s_cmp_eq_u32 s21, 63
    v_rcp_f32 v76, v76
    s_cbranch_scc1 mega_kernel_rs_w2_last
    s_mov_b64 exec, s[28:29]
    v_pk_mul_f32 v[100:101], v[100:101], v[76:77] op_sel_hi:[1,0]
    v_pk_mul_f32 v[102:103], v[102:103], v[76:77] op_sel_hi:[1,0]
    v_pk_mul_f32 v[104:105], v[104:105], v[76:77] op_sel_hi:[1,0]
    v_pk_mul_f32 v[106:107], v[106:107], v[76:77] op_sel_hi:[1,0]
    v_cvt_pk_bf16_f32 v72, v100, v101
    v_cvt_pk_bf16_f32 v73, v102, v103
    v_cvt_pk_bf16_f32 v74, v104, v105
    v_cvt_pk_bf16_f32 v75, v106, v107
    ds_write_b128 v6, v[72:75] offset:21472
    s_mov_b64 exec, -1
    ds_read_b128 v[88:91], v5 offset:24576
    ds_read_b128 v[92:95], v5 offset:25600
    ds_read_b128 v[80:83], v5 offset:26624
    ds_read_b128 v[84:87], v5 offset:27648
    ds_read_b128 v[112:115], v5 offset:40960
    ds_read_b128 v[116:119], v5 offset:41984
    s_waitcnt lgkmcnt(6)
    s_barrier
    ds_read_b128 v[68:71], v6 offset:20480
    ds_read_b128 v[72:75], v6 offset:21504
    ds_read_b128 v[96:99], v5 offset:43008
    ds_read_b128 v[100:103], v5 offset:44032
    ds_read_b128 v[104:107], v5 offset:57344
    ds_read_b128 v[108:111], v5 offset:58368
    s_waitcnt lgkmcnt(5)
    v_smfmac_f32_16x16x64_bf16 v[32:35], v[68:71], v[128:135], v2
    s_add_u32 s21, s21, 1
    v_smfmac_f32_16x16x64_bf16 v[36:39], v[68:71], v[136:143], v2
    s_xor_b32 s38, s38, 1048576
    v_smfmac_f32_16x16x64_bf16 v[40:43], v[68:71], v[144:151], v2
    s_xor_b32 s37, s37, 1048576
    v_smfmac_f32_16x16x64_bf16 v[44:47], v[68:71], v[152:159], v2
    s_xor_b32 s40, s40, 1048576
    s_waitcnt lgkmcnt(4)
    v_smfmac_f32_16x16x64_bf16 v[32:35], v[72:75], v[160:167], v2
    s_xor_b32 s39, s39, 1048576
    v_smfmac_f32_16x16x64_bf16 v[36:39], v[72:75], v[168:175], v2
    s_lshr_b32 s41, s21, 1
    v_smfmac_f32_16x16x64_bf16 v[40:43], v[72:75], v[176:183], v2
    s_and_b32 s41, s41, 1
    v_smfmac_f32_16x16x64_bf16 v[44:47], v[72:75], v[184:191], v2
    s_xor_b32 s41, s41, 1
    v_smfmac_f32_16x16x64_bf16 v[48:51], v[68:71], v[192:199], v2
    s_xor_b32 s35, s35, 16384
    v_smfmac_f32_16x16x64_bf16 v[52:55], v[68:71], v[200:207], v2
    s_xor_b32 s36, s36, 16384
    s_waitcnt lgkmcnt(0)
    v_smfmac_f32_16x16x64_bf16 v[56:59], v[68:71], v[88:95], v2
    ds_read_b128 v[88:91], v5 offset:59392
    ds_read_b128 v[92:95], v5 offset:60416
    v_smfmac_f32_16x16x64_bf16 v[60:63], v[68:71], v[80:87], v2
    s_add_u32 s43, s43, 262144
    v_smfmac_f32_16x16x64_bf16 v[48:51], v[72:75], v[112:119], v2
    s_add_u32 s44, s44, 262144
    v_add_f32 v32, v32, v34
    v_add_f32 v33, v33, v35
    v_cvt_pk_bf16_f32 v32, v32, v33
    v_and_or_b32 v32, v32, -2, s42
    v_smfmac_f32_16x16x64_bf16 v[52:55], v[72:75], v[96:103], v2
    v_add_f32 v36, v36, v38
    v_add_f32 v37, v37, v39
    v_cvt_pk_bf16_f32 v33, v36, v37
    v_smfmac_f32_16x16x64_bf16 v[56:59], v[72:75], v[104:111], v2
    v_add_f32 v40, v40, v42
    v_add_f32 v41, v41, v43
    v_cvt_pk_bf16_f32 v34, v40, v41
    s_waitcnt lgkmcnt(0)
    v_smfmac_f32_16x16x64_bf16 v[60:63], v[72:75], v[88:95], v2
    v_add_f32 v44, v44, v46
    v_add_f32 v45, v45, v47
    v_cvt_pk_bf16_f32 v35, v44, v45
    buffer_store_dwordx4 v[32:35], v8, s[4:7], s46 offen sc1
    v_pk_add_f32 v[48:49], v[48:49], v[50:51]
    v_cvt_pk_bf16_f32 v48, v48, v49
    v_and_or_b32 v48, v48, -2, s42
    v_pk_add_f32 v[52:53], v[52:53], v[54:55]
    v_cvt_pk_bf16_f32 v49, v52, v53
    v_pk_add_f32 v[56:57], v[56:57], v[58:59]
    v_cvt_pk_bf16_f32 v50, v56, v57
    v_pk_add_f32 v[60:61], v[60:61], v[62:63]
    v_cvt_pk_bf16_f32 v51, v60, v61
    buffer_store_dwordx4 v[48:51], v8, s[4:7], s61 offen sc1
    s_waitcnt vmcnt(4)
    v_mov_b32 v20, v64
    v_mov_b32 v21, v65
    v_mov_b32 v22, v66
    v_mov_b32 v23, v67
    s_add_u32 s45, s45, 131072
    v_mfma_f32_32x32x8_bf16 v[96:111], v[14:15], v[14:15], 0
    v_mfma_f32_16x16x16_bf16 v[112:115], v[14:15], v[14:15], 0
    v_mfma_f32_16x16x16_bf16 v[116:119], v[14:15], v[14:15], 0
    ds_read_b128 v[64:67], v1 offset:8192
    ds_read_b128 v[68:71], v1 offset:9216
    ds_read_b128 v[72:75], v1 offset:10240
    ds_read_b128 v[76:79], v1 offset:11264
    ds_read_b128 v[80:83], v1 offset:24576
    ds_read_b128 v[84:87], v1 offset:25600
    ds_read_b128 v[88:91], v1 offset:26624
    ds_read_b128 v[92:95], v1 offset:27648
    v_mov_b32 v58, -1
    v_mov_b32 v59, -1
    s_nop 15
    s_nop 15
    s_nop 15
mega_kernel_rs_w2_pc:
    buffer_load_dword v36, v13, s[4:7], s47 offen offset:128 sc1
    buffer_load_dword v37, v13, s[4:7], s47 offen offset:1152 sc1
    buffer_load_dword v38, v13, s[4:7], s47 offen offset:2176 sc1
    buffer_load_dword v39, v13, s[4:7], s47 offen offset:3200 sc1
    buffer_load_dword v40, v13, s[4:7], s25 offen offset:128 sc1
    buffer_load_dword v41, v13, s[4:7], s25 offen offset:1152 sc1
    buffer_load_dword v42, v13, s[4:7], s25 offen offset:2176 sc1
    buffer_load_dword v43, v13, s[4:7], s25 offen offset:3200 sc1
    s_waitcnt vmcnt(4)
    v_mfma_f32_16x16x32_bf16 v[52:55], v[36:39], v[24:27], 0
    v_bitop3_b32 v3, s42, v36, v37 bitop3:0x7e
    v_bitop3_b32 v4, s42, v38, v39 bitop3:0x7e
    s_waitcnt vmcnt(2)
    v_or_b32 v3, v3, v4
    v_bitop3_b32 v4, s42, v40, v41 bitop3:0x7e
    s_waitcnt vmcnt(0)
    v_mfma_f32_16x16x32_bf16 v[52:55], v[40:43], v[24:27], v[52:55]
    v_bitop3_b32 v56, s42, v42, v43 bitop3:0x7e
    v_or3_b32 v3, v3, v4, v56
    v_and_b32 v3, v0, v3
    v_cmp_ne_u32 vcc, 0, v3
    s_cbranch_vccnz mega_kernel_rs_w2_pc
    s_nop 2
    v_cvt_pk_bf16_f32 v56, v52, v53
    v_cvt_pk_bf16_f32 v57, v54, v55
    v_min_u32 v56, -2, v56
    s_mov_b64 exec, s[26:27]
    buffer_store_dwordx2 v[56:57], v9, s[4:7], s35 offen offset:128 sc1
    buffer_store_dwordx2 v[58:59], v9, s[4:7], s36 offen offset:128 sc1
    s_mov_b64 exec, -1
    s_xor_b32 s42, s42, 1
    s_branch mega_kernel_rs_w2_loop
mega_kernel_rs_w2_last:
    s_waitcnt vmcnt(0)
    v_mov_b32 v20, v64
    v_mov_b32 v21, v65
    v_mov_b32 v22, v66
    v_mov_b32 v23, v67
    s_add_u32 s45, s45, 131072
    buffer_store_dwordx4 v[20:23], v10, s[4:7], s45 offen offset:128 sc1
    buffer_store_dwordx2 v[18:19], v11, s[4:7], s45 offen offset:3072 sc1
    s_branch mega_kernel_rs_end
mega_kernel_rs_w2_pafail:
    buffer_load_dwordx4 v[48:51], v12, s[4:7], s22 offen sc1
    buffer_load_dwordx4 v[52:55], v12, s[4:7], s22 offen offset:1024 sc1
    s_nop 7
    v_mov_b32 v96, 0
    v_mov_b32 v97, 0
    v_mov_b32 v98, 0
    v_mov_b32 v99, 0
    v_mov_b32 v100, 0
    v_mov_b32 v101, 0
    v_mov_b32 v102, 0
    v_mov_b32 v103, 0
    v_mov_b32 v104, 0
    v_mov_b32 v105, 0
    v_mov_b32 v106, 0
    v_mov_b32 v107, 0
    s_branch mega_kernel_rs_w2_pa
mega_kernel_rs_w2_xslow:
    buffer_load_dwordx4 v[96:99], v1, s[4:7], s38 offen sc1
    s_waitcnt vmcnt(1)
    v_and_b32 v3, 1, v20
    v_cmp_ne_u32 vcc, s41, v3
    s_cbranch_vccz mega_kernel_rs_w2_xgot1
    buffer_load_dwordx4 v[20:23], v1, s[4:7], s38 offen sc1
mega_kernel_rs_w2_px:
    s_waitcnt vmcnt(1)
    v_and_b32 v3, 1, v96
    v_cmp_ne_u32 vcc, s41, v3
    s_cbranch_vccz mega_kernel_rs_w2_xgot0
    buffer_load_dwordx4 v[96:99], v1, s[4:7], s38 offen sc1
    s_waitcnt vmcnt(1)
    v_and_b32 v3, 1, v20
    v_cmp_ne_u32 vcc, s41, v3
    s_cbranch_vccz mega_kernel_rs_w2_xgot1
    buffer_load_dwordx4 v[20:23], v1, s[4:7], s38 offen sc1
    s_branch mega_kernel_rs_w2_px
mega_kernel_rs_w2_xgot0:
    v_mfma_f32_16x16x16_bf16 v[80:83], v[96:97], v[16:17], v[100:103]
    v_mfma_f32_16x16x16_bf16 v[84:87], v[98:99], v[16:17], v[104:107]
    v_and_b32 v3, 1, v96
    v_cmp_ne_u32 vcc, s41, v3
    s_nop 4
    v_cvt_pk_bf16_f32 v64, v80, v81
    v_cvt_pk_bf16_f32 v65, v82, v83
    v_cvt_pk_bf16_f32 v66, v84, v85
    v_cvt_pk_bf16_f32 v67, v86, v87
    ds_write_b128 v6, v[64:67] offset:14336
    s_branch mega_kernel_rs_w2_xok
mega_kernel_rs_w2_xgot1:
    v_mfma_f32_16x16x16_bf16 v[80:83], v[20:21], v[16:17], v[100:103]
    v_mfma_f32_16x16x16_bf16 v[84:87], v[22:23], v[16:17], v[104:107]
    v_and_b32 v3, 1, v20
    v_cmp_ne_u32 vcc, s41, v3
    s_nop 4
    v_cvt_pk_bf16_f32 v64, v80, v81
    v_cvt_pk_bf16_f32 v65, v82, v83
    v_cvt_pk_bf16_f32 v66, v84, v85
    v_cvt_pk_bf16_f32 v67, v86, v87
    ds_write_b128 v6, v[64:67] offset:14336
    s_branch mega_kernel_rs_w2_xok
mega_kernel_rs_w2_pv0:
    s_waitcnt vmcnt(0)
    s_branch mega_kernel_rs_w2_pv1
mega_kernel_rs_w2_pv:
    buffer_load_dwordx4 v[20:23], v1, s[4:7], s40 offen sc1
    s_waitcnt vmcnt(0)
mega_kernel_rs_w2_pv1:
    v_and_b32 v3, 1, v20
    v_cmp_ne_u32 vcc, s41, v3
    v_pk_add_f32 v[116:117], v[112:113], v[20:21]
    v_pk_add_f32 v[118:119], v[114:115], v[22:23]
    s_cbranch_vccnz mega_kernel_rs_w2_pv
    s_branch mega_kernel_rs_w2_pv2
mega_kernel_rs_w3_entry:
    v_mfma_f32_32x32x8_bf16 v[96:111], v[14:15], v[14:15], 0
    v_mfma_f32_16x16x16_bf16 v[112:115], v[14:15], v[14:15], 0
    v_mfma_f32_16x16x16_bf16 v[116:119], v[14:15], v[14:15], 0
    ds_read_b128 v[64:67], v1 offset:12288
    ds_read_b128 v[68:71], v1 offset:13312
    ds_read_b128 v[72:75], v1 offset:14336
    ds_read_b128 v[76:79], v1 offset:15360
    ds_read_b128 v[80:83], v1 offset:28672
    ds_read_b128 v[84:87], v1 offset:29696
    ds_read_b128 v[88:91], v1 offset:30720
    ds_read_b128 v[92:95], v1 offset:31744
    buffer_load_dwordx4 v[120:123], v1, s[4:7], s44 offen
    buffer_load_dwordx4 v[124:127], v1, s[4:7], s44 offen offset:1024
    s_add_u32 s44, s44, 262144
mega_kernel_rs_w3_loop:
    s_add_u32 s22, s35, 6144
    s_nop 15
    s_nop 15
    s_nop 7
    buffer_load_dwordx4 v[56:59], v12, s[4:7], s22 offen sc1
    buffer_load_dwordx4 v[60:63], v12, s[4:7], s22 offen offset:1024 sc1
mega_kernel_rs_w3_pa:
    s_waitcnt vmcnt(1)
    ds_write_b128 v6, v[56:59] offset:6144
    s_waitcnt vmcnt(0)
    ds_write_b128 v6, v[60:63] offset:7168
    v_max3_u32 v3, v56, v58, v60
    v_max_u32 v3, v3, v62
    v_cmp_eq_u32 vcc, -1, v3
    v_smfmac_f32_16x16x64_bf16 v[96:99], v[56:59], a[96:103], v2
    v_smfmac_f32_16x16x64_bf16 v[100:103], v[56:59], a[104:111], v2
    v_smfmac_f32_16x16x64_bf16 v[104:107], v[56:59], a[224:231], v2
    s_cbranch_vccnz mega_kernel_rs_w3_pafail
    s_waitcnt lgkmcnt(0)
    s_barrier
    ds_read_b128 v[32:35], v6 offset:0
    ds_read_b128 v[36:39], v6 offset:1024
    v_smfmac_f32_16x16x64_bf16 v[108:111], v[56:59], a[232:239], v2
    ds_read_b128 v[40:43], v6 offset:2048
    v_smfmac_f32_16x16x64_bf16 v[96:99], v[60:63], a[112:119], v2
    ds_read_b128 v[44:47], v6 offset:3072
    v_smfmac_f32_16x16x64_bf16 v[100:103], v[60:63], a[120:127], v2
    ds_read_b128 v[48:51], v6 offset:4096
    v_smfmac_f32_16x16x64_bf16 v[104:107], v[60:63], a[240:247], v2
    ds_read_b128 v[52:55], v6 offset:5120
    v_smfmac_f32_16x16x64_bf16 v[108:111], v[60:63], a[248:255], v2
    buffer_load_dwordx4 v1, s[4:7], s43 offen lds
    s_waitcnt lgkmcnt(5)
    v_smfmac_f32_16x16x64_bf16 v[96:99], v[32:35], a[0:7], v2
    v_smfmac_f32_16x16x64_bf16 v[100:103], v[32:35], a[8:15], v2
    v_smfmac_f32_16x16x64_bf16 v[104:107], v[32:35], a[128:135], v2
    v_smfmac_f32_16x16x64_bf16 v[108:111], v[32:35], a[136:143], v2
    buffer_load_dwordx4 v1, s[4:7], s43 offen offset:1024 lds
    s_waitcnt lgkmcnt(4)
    v_smfmac_f32_16x16x64_bf16 v[96:99], v[36:39], a[16:23], v2
    v_smfmac_f32_16x16x64_bf16 v[100:103], v[36:39], a[24:31], v2
    v_smfmac_f32_16x16x64_bf16 v[104:107], v[36:39], a[144:151], v2
    v_smfmac_f32_16x16x64_bf16 v[108:111], v[36:39], a[152:159], v2
    buffer_store_dwordx4 v[20:23], v10, s[4:7], s45 offen offset:192 sc1
    s_waitcnt lgkmcnt(3)
    v_smfmac_f32_16x16x64_bf16 v[96:99], v[40:43], a[32:39], v2
    v_smfmac_f32_16x16x64_bf16 v[100:103], v[40:43], a[40:47], v2
    v_smfmac_f32_16x16x64_bf16 v[104:107], v[40:43], a[160:167], v2
    v_smfmac_f32_16x16x64_bf16 v[108:111], v[40:43], a[168:175], v2
    buffer_store_dwordx2 v[18:19], v11, s[4:7], s45 offen offset:3584 sc1
    s_waitcnt lgkmcnt(2)
    v_smfmac_f32_16x16x64_bf16 v[96:99], v[44:47], a[48:55], v2
    v_smfmac_f32_16x16x64_bf16 v[100:103], v[44:47], a[56:63], v2
    v_smfmac_f32_16x16x64_bf16 v[104:107], v[44:47], a[176:183], v2
    v_smfmac_f32_16x16x64_bf16 v[108:111], v[44:47], a[184:191], v2
    buffer_load_dword v4, v7, s[4:7], 0 offen sc1
    s_waitcnt lgkmcnt(1)
    v_smfmac_f32_16x16x64_bf16 v[96:99], v[48:51], a[64:71], v2
    v_smfmac_f32_16x16x64_bf16 v[100:103], v[48:51], a[72:79], v2
    v_smfmac_f32_16x16x64_bf16 v[104:107], v[48:51], a[192:199], v2
    v_smfmac_f32_16x16x64_bf16 v[108:111], v[48:51], a[200:207], v2
    s_waitcnt lgkmcnt(0)
    v_smfmac_f32_16x16x64_bf16 v[96:99], v[52:55], a[80:87], v2
    v_smfmac_f32_16x16x64_bf16 v[100:103], v[52:55], a[88:95], v2
    v_smfmac_f32_16x16x64_bf16 v[104:107], v[52:55], a[208:215], v2
    v_smfmac_f32_16x16x64_bf16 v[108:111], v[52:55], a[216:223], v2
    s_nop 4
    v_pk_add_f32 v[96:97], v[96:97], v[98:99]
    v_pk_add_f32 v[100:101], v[100:101], v[102:103]
    v_pk_add_f32 v[104:105], v[104:105], v[106:107]
    v_pk_add_f32 v[108:109], v[108:109], v[110:111]
    v_cvt_pk_bf16_f32 v111, v108, v109
    v_cvt_pk_bf16_f32 v108, v96, v97
    v_cvt_pk_bf16_f32 v110, v100, v101
    v_cvt_pk_bf16_f32 v109, v104, v105
    v_and_or_b32 v108, v108, -2, s41
    buffer_store_dwordx4 v[108:111], v1, s[4:7], s37 offen sc1
    v_smfmac_f32_16x16x64_bf16 v[112:115], v[32:35], v[64:71], v2
    ds_read_b128 v[64:67], v1 offset:45056
    ds_read_b128 v[68:71], v1 offset:46080
    v_smfmac_f32_16x16x64_bf16 v[116:119], v[32:35], v[72:79], v2
    ds_read_b128 v[72:75], v1 offset:47104
    ds_read_b128 v[76:79], v1 offset:48128
    v_smfmac_f32_16x16x64_bf16 v[112:115], v[36:39], v[80:87], v2
    ds_read_b128 v[80:83], v1 offset:61440
    ds_read_b128 v[84:87], v1 offset:62464
    v_smfmac_f32_16x16x64_bf16 v[116:119], v[36:39], v[88:95], v2
    ds_read_b128 v[88:91], v1 offset:63488
    ds_read_b128 v[92:95], v1 offset:64512
    v_smfmac_f32_16x16x64_bf16 v[112:115], v[52:55], v[208:215], v2
    v_smfmac_f32_16x16x64_bf16 v[116:119], v[52:55], v[216:223], v2
    v_smfmac_f32_16x16x64_bf16 v[112:115], v[56:59], v[224:231], v2
    s_waitcnt lgkmcnt(6)
    v_smfmac_f32_16x16x64_bf16 v[112:115], v[40:43], v[64:71], v2
    ds_read_b128 v[64:67], v5 offset:12288
    ds_read_b128 v[68:71], v5 offset:13312
    s_waitcnt lgkmcnt(6)
    v_smfmac_f32_16x16x64_bf16 v[116:119], v[40:43], v[72:79], v2
    ds_read_b128 v[72:75], v5 offset:14336
    ds_read_b128 v[76:79], v5 offset:15360
    v_smfmac_f32_16x16x64_bf16 v[116:119], v[56:59], v[232:239], v2
    v_smfmac_f32_16x16x64_bf16 v[112:115], v[60:63], v[240:247], v2
    v_smfmac_f32_16x16x64_bf16 v[116:119], v[60:63], v[248:255], v2
    s_waitcnt lgkmcnt(6)
    v_smfmac_f32_16x16x64_bf16 v[112:115], v[44:47], v[80:87], v2
    s_waitcnt lgkmcnt(4)
    v_smfmac_f32_16x16x64_bf16 v[116:119], v[44:47], v[88:95], v2
    s_waitcnt lgkmcnt(2)
    v_smfmac_f32_16x16x64_bf16 v[112:115], v[48:51], v[64:71], v2
    s_waitcnt lgkmcnt(0)
    v_smfmac_f32_16x16x64_bf16 v[116:119], v[48:51], v[72:79], v2
    v_mfma_f32_16x16x16_bf16 v[100:103], v[108:109], v[16:17], 0
    v_mfma_f32_16x16x16_bf16 v[104:107], v[110:111], v[16:17], 0
    s_nop 4
    v_add_f32 v112, v112, v114
    v_add_f32 v113, v113, v115
    v_add_f32 v114, v116, v118
    v_add_f32 v115, v117, v119
    v_and_or_b32 v112, v112, -2, s41
    s_waitcnt vmcnt(4)
    s_barrier
    ds_read_b128 v[32:35], v6 offset:18432
    ds_read_b128 v[36:39], v6 offset:19456
    ds_read_b128 v[40:43], v6 offset:15360
    ds_read_b128 v[44:47], v6 offset:16384
    ds_read_b128 v[48:51], v6 offset:12288
    ds_read_b128 v[52:55], v6 offset:13312
    ds_read_b128 v[56:59], v6 offset:9216
    ds_read_b128 v[60:63], v6 offset:10240
    buffer_load_dwordx4 v[96:99], v1, s[4:7], s38 offen sc1
    s_barrier
    buffer_store_dwordx4 v[112:115], v1, s[4:7], s39 offen sc1
    s_nop 15
    s_nop 15
    buffer_load_dwordx4 v[20:23], v1, s[4:7], s38 offen sc1
    s_add_u32 s22, s21, 4
    s_cmp_gt_u32 s50, s22
    s_cbranch_scc1 mega_kernel_rs_w3_kvs
    s_waitcnt vmcnt(4)
    v_readlane_b32 s50, v4, 0
    v_readlane_b32 s22, v4, 2
    v_readlane_b32 s23, v4, 1
    v_readlane_b32 s24, v4, 3
    s_nop 3
    s_min_u32 s50, s50, s22
    s_min_u32 s23, s23, s24
    s_lshl_b32 s50, s50, 1
    s_lshl_b32 s23, s23, 1
    s_add_u32 s23, s23, 1
    s_min_u32 s50, s50, s23
mega_kernel_rs_kvb1:
    s_add_u32 s22, s21, 1
    s_min_u32 s22, s22, 63
    s_cmp_gt_u32 s50, s22
    s_cbranch_scc1 mega_kernel_rs_kvd1
    buffer_load_dword v4, v7, s[4:7], 0 offen sc1
    s_waitcnt vmcnt(0)
    v_readlane_b32 s50, v4, 0
    v_readlane_b32 s22, v4, 2
    v_readlane_b32 s23, v4, 1
    v_readlane_b32 s24, v4, 3
    s_nop 3
    s_min_u32 s50, s50, s22
    s_min_u32 s23, s23, s24
    s_lshl_b32 s50, s50, 1
    s_lshl_b32 s23, s23, 1
    s_add_u32 s23, s23, 1
    s_min_u32 s50, s50, s23
    s_branch mega_kernel_rs_kvb1
mega_kernel_rs_kvd1:
mega_kernel_rs_w3_kvs:
    s_waitcnt vmcnt(2)
    v_mfma_f32_16x16x16_bf16 v[80:83], v[96:97], v[16:17], v[100:103]
    v_mfma_f32_16x16x16_bf16 v[84:87], v[98:99], v[16:17], v[104:107]
    v_and_b32 v3, 1, v96
    v_cmp_ne_u32 vcc, s41, v3
    s_nop 4
    v_cvt_pk_bf16_f32 v64, v80, v81
    v_cvt_pk_bf16_f32 v65, v82, v83
    v_cvt_pk_bf16_f32 v66, v84, v85
    v_cvt_pk_bf16_f32 v67, v86, v87
    ds_write_b128 v6, v[64:67] offset:17408
    s_cbranch_vccnz mega_kernel_rs_w3_xslow
mega_kernel_rs_w3_xok:
    buffer_load_dwordx4 v[116:119], v1, s[4:7], s40 offen sc1
    s_waitcnt lgkmcnt(1)
    v_mfma_f32_16x16x32_bf16 v[80:83], v[32:35], v[64:67], 0
    s_waitcnt lgkmcnt(0)
    s_barrier
    ds_read_b128 v[68:71], v6 offset:14336
    ds_read_b128 v[72:75], v6 offset:11264
    ds_read_b128 v[76:79], v6 offset:8192
    v_mfma_f32_16x16x32_bf16 v[84:87], v[36:39], v[64:67], 0
    v_mfma_f32_16x16x32_bf16 v[88:91], v[64:67], v[64:67], 0
    buffer_load_dwordx4 v[20:23], v1, s[4:7], s40 offen sc1
    s_waitcnt lgkmcnt(2)
    v_mfma_f32_16x16x32_bf16 v[80:83], v[40:43], v[68:71], v[80:83]
    v_mfma_f32_16x16x32_bf16 v[84:87], v[44:47], v[68:71], v[84:87]
    v_mfma_f32_16x16x32_bf16 v[88:91], v[68:71], v[68:71], v[88:91]
    s_waitcnt lgkmcnt(1)
    v_mfma_f32_16x16x32_bf16 v[80:83], v[48:51], v[72:75], v[80:83]
    v_mfma_f32_16x16x32_bf16 v[84:87], v[52:55], v[72:75], v[84:87]
    v_mfma_f32_16x16x32_bf16 v[88:91], v[72:75], v[72:75], v[88:91]
    s_waitcnt lgkmcnt(0)
    v_mfma_f32_16x16x32_bf16 v[80:83], v[56:59], v[76:79], v[80:83]
    v_mfma_f32_16x16x32_bf16 v[84:87], v[60:63], v[76:79], v[84:87]
    v_mfma_f32_16x16x32_bf16 v[88:91], v[76:79], v[76:79], v[88:91]
    v_mfma_f32_32x32x4_2b_bf16 v[32:63], v[14:15], v[14:15], 0
    s_nop 4
    v_max3_f32 v4, v80, v81, v82
    v_max3_f32 v4, v4, v83, v84
    v_max3_f32 v4, v4, v85, v86
    v_max3_f32 v4, v4, v87, v88
    v_max_f32 v90, v4, v89
    v_max_f32 v4, v4, v89
    v_mov_b32 v73, 0
    s_nop 0
    v_permlane16_swap_b32 v4, v90
    v_max_f32 v4, v4, v90
    v_max_f32 v90, v4, v90
    s_nop 1
    v_permlane32_swap_b32 v4, v90
    v_max_f32 v4, v4, v90
    v_mul_f32 v4, s34, v4
    v_pk_fma_f32 v[80:81], v[80:81], s[34:35], v[4:5] op_sel_hi:[1,0,0] neg_lo:[0,0,1] neg_hi:[0,0,1]
    v_pk_fma_f32 v[82:83], v[82:83], s[34:35], v[4:5] op_sel_hi:[1,0,0] neg_lo:[0,0,1] neg_hi:[0,0,1]
    v_pk_fma_f32 v[84:85], v[84:85], s[34:35], v[4:5] op_sel_hi:[1,0,0] neg_lo:[0,0,1] neg_hi:[0,0,1]
    v_pk_fma_f32 v[86:87], v[86:87], s[34:35], v[4:5] op_sel_hi:[1,0,0] neg_lo:[0,0,1] neg_hi:[0,0,1]
    v_pk_fma_f32 v[88:89], v[88:89], s[34:35], v[4:5] op_sel_hi:[1,0,0] neg_lo:[0,0,1] neg_hi:[0,0,1]
    v_exp_f32 v80, v80
    v_exp_f32 v81, v81
    v_exp_f32 v82, v82
    v_cvt_pk_bf16_f32 v68, v80, v81
    v_exp_f32 v83, v83
    v_exp_f32 v84, v84
    v_cvt_pk_bf16_f32 v69, v82, v83
    v_exp_f32 v85, v85
    v_exp_f32 v86, v86
    v_cvt_pk_bf16_f32 v70, v84, v85
    v_exp_f32 v87, v87
    v_exp_f32 v88, v88
    v_cvt_pk_bf16_f32 v71, v86, v87
    v_exp_f32 v89, v89
    s_cmp_eq_u32 s21, 63
    v_mfma_f32_16x16x32_bf16 v[76:79], v[28:31], v[68:71], 0
    v_cvt_pk_bf16_f32 v72, v88, v89
    s_waitcnt vmcnt(1)
    v_and_b32 v3, 1, v116
    v_mfma_f32_16x16x32_bf16 v[100:103], v[120:123], v[68:71], 0
    v_cmp_ne_u32 vcc, s41, v3
    v_add_f32 v116, v112, v116
    v_mfma_f32_16x16x32_bf16 v[104:107], v[124:127], v[68:71], 0
    v_add_f32 v117, v113, v117
    v_add_f32 v118, v114, v118
    v_mfma_f32_16x16x16_bf16 v[76:79], v[28:29], v[72:73], v[76:79]
    v_add_f32 v119, v115, v119
    s_cbranch_vccnz mega_kernel_rs_w3_pv0
mega_kernel_rs_w3_pv2:
    v_cvt_pk_bf16_f32 v18, v116, v117
    v_cvt_pk_bf16_f32 v19, v118, v119
    v_cvt_pk_bf16_f32 v98, v118, v119
    v_mov_b32 v99, 0
    v_mfma_f32_16x16x16_bf16 v[100:103], v[18:19], v[72:73], v[100:103]
    s_nop 0
    v_mfma_f32_16x16x16_bf16 v[104:107], v[98:99], v[72:73], v[104:107]
    buffer_load_dwordx4 v[120:123], v1, s[4:7], s44 offen
    buffer_load_dwordx4 v[124:127], v1, s[4:7], s44 offen offset:1024
    s_cmp_eq_u32 s21, 63
    v_rcp_f32 v76, v76
    s_cbranch_scc1 mega_kernel_rs_w3_last
    s_mov_b64 exec, s[28:29]
    v_pk_mul_f32 v[100:101], v[100:101], v[76:77] op_sel_hi:[1,0]
    v_pk_mul_f32 v[102:103], v[102:103], v[76:77] op_sel_hi:[1,0]
    v_pk_mul_f32 v[104:105], v[104:105], v[76:77] op_sel_hi:[1,0]
    v_pk_mul_f32 v[106:107], v[106:107], v[76:77] op_sel_hi:[1,0]
    v_cvt_pk_bf16_f32 v72, v100, v101
    v_cvt_pk_bf16_f32 v73, v102, v103
    v_cvt_pk_bf16_f32 v74, v104, v105
    v_cvt_pk_bf16_f32 v75, v106, v107
    ds_write_b128 v6, v[72:75] offset:21504
    s_mov_b64 exec, -1
    ds_read_b128 v[88:91], v5 offset:28672
    ds_read_b128 v[92:95], v5 offset:29696
    ds_read_b128 v[80:83], v5 offset:30720
    ds_read_b128 v[84:87], v5 offset:31744
    ds_read_b128 v[112:115], v5 offset:45056
    ds_read_b128 v[116:119], v5 offset:46080
    s_waitcnt lgkmcnt(6)
    s_barrier
    ds_read_b128 v[68:71], v6 offset:20480
    ds_read_b128 v[72:75], v6 offset:21504
    ds_read_b128 v[96:99], v5 offset:47104
    ds_read_b128 v[100:103], v5 offset:48128
    ds_read_b128 v[104:107], v5 offset:61440
    ds_read_b128 v[108:111], v5 offset:62464
    s_waitcnt lgkmcnt(5)
    v_smfmac_f32_16x16x64_bf16 v[32:35], v[68:71], v[128:135], v2
    s_add_u32 s21, s21, 1
    v_smfmac_f32_16x16x64_bf16 v[36:39], v[68:71], v[136:143], v2
    s_xor_b32 s38, s38, 1048576
    v_smfmac_f32_16x16x64_bf16 v[40:43], v[68:71], v[144:151], v2
    s_xor_b32 s37, s37, 1048576
    v_smfmac_f32_16x16x64_bf16 v[44:47], v[68:71], v[152:159], v2
    s_xor_b32 s40, s40, 1048576
    s_waitcnt lgkmcnt(4)
    v_smfmac_f32_16x16x64_bf16 v[32:35], v[72:75], v[160:167], v2
    s_xor_b32 s39, s39, 1048576
    v_smfmac_f32_16x16x64_bf16 v[36:39], v[72:75], v[168:175], v2
    s_lshr_b32 s41, s21, 1
    v_smfmac_f32_16x16x64_bf16 v[40:43], v[72:75], v[176:183], v2
    s_and_b32 s41, s41, 1
    v_smfmac_f32_16x16x64_bf16 v[44:47], v[72:75], v[184:191], v2
    s_xor_b32 s41, s41, 1
    v_smfmac_f32_16x16x64_bf16 v[48:51], v[68:71], v[192:199], v2
    s_xor_b32 s35, s35, 16384
    v_smfmac_f32_16x16x64_bf16 v[52:55], v[68:71], v[200:207], v2
    s_xor_b32 s36, s36, 16384
    s_waitcnt lgkmcnt(0)
    v_smfmac_f32_16x16x64_bf16 v[56:59], v[68:71], v[88:95], v2
    ds_read_b128 v[88:91], v5 offset:63488
    ds_read_b128 v[92:95], v5 offset:64512
    v_smfmac_f32_16x16x64_bf16 v[60:63], v[68:71], v[80:87], v2
    s_add_u32 s43, s43, 262144
    v_smfmac_f32_16x16x64_bf16 v[48:51], v[72:75], v[112:119], v2
    s_add_u32 s44, s44, 262144
    v_add_f32 v32, v32, v34
    v_add_f32 v33, v33, v35
    v_cvt_pk_bf16_f32 v32, v32, v33
    v_and_or_b32 v32, v32, -2, s42
    v_smfmac_f32_16x16x64_bf16 v[52:55], v[72:75], v[96:103], v2
    v_add_f32 v36, v36, v38
    v_add_f32 v37, v37, v39
    v_cvt_pk_bf16_f32 v33, v36, v37
    v_smfmac_f32_16x16x64_bf16 v[56:59], v[72:75], v[104:111], v2
    v_add_f32 v40, v40, v42
    v_add_f32 v41, v41, v43
    v_cvt_pk_bf16_f32 v34, v40, v41
    s_waitcnt lgkmcnt(0)
    v_smfmac_f32_16x16x64_bf16 v[60:63], v[72:75], v[88:95], v2
    v_add_f32 v44, v44, v46
    v_add_f32 v45, v45, v47
    v_cvt_pk_bf16_f32 v35, v44, v45
    buffer_store_dwordx4 v[32:35], v8, s[4:7], s46 offen sc1
    v_pk_add_f32 v[48:49], v[48:49], v[50:51]
    v_cvt_pk_bf16_f32 v48, v48, v49
    v_and_or_b32 v48, v48, -2, s42
    v_pk_add_f32 v[52:53], v[52:53], v[54:55]
    v_cvt_pk_bf16_f32 v49, v52, v53
    v_pk_add_f32 v[56:57], v[56:57], v[58:59]
    v_cvt_pk_bf16_f32 v50, v56, v57
    v_pk_add_f32 v[60:61], v[60:61], v[62:63]
    v_cvt_pk_bf16_f32 v51, v60, v61
    buffer_store_dwordx4 v[48:51], v8, s[4:7], s61 offen sc1
    s_waitcnt vmcnt(4)
    v_mov_b32 v20, v64
    v_mov_b32 v21, v65
    v_mov_b32 v22, v66
    v_mov_b32 v23, v67
    s_add_u32 s45, s45, 131072
    v_mfma_f32_32x32x8_bf16 v[96:111], v[14:15], v[14:15], 0
    v_mfma_f32_16x16x16_bf16 v[112:115], v[14:15], v[14:15], 0
    v_mfma_f32_16x16x16_bf16 v[116:119], v[14:15], v[14:15], 0
    ds_read_b128 v[64:67], v1 offset:12288
    ds_read_b128 v[68:71], v1 offset:13312
    ds_read_b128 v[72:75], v1 offset:14336
    ds_read_b128 v[76:79], v1 offset:15360
    ds_read_b128 v[80:83], v1 offset:28672
    ds_read_b128 v[84:87], v1 offset:29696
    ds_read_b128 v[88:91], v1 offset:30720
    ds_read_b128 v[92:95], v1 offset:31744
    v_mov_b32 v58, -1
    v_mov_b32 v59, -1
    s_nop 15
    s_nop 15
    s_nop 15
mega_kernel_rs_w3_pc:
    buffer_load_dword v36, v13, s[4:7], s47 offen offset:192 sc1
    buffer_load_dword v37, v13, s[4:7], s47 offen offset:1216 sc1
    buffer_load_dword v38, v13, s[4:7], s47 offen offset:2240 sc1
    buffer_load_dword v39, v13, s[4:7], s47 offen offset:3264 sc1
    buffer_load_dword v40, v13, s[4:7], s25 offen offset:192 sc1
    buffer_load_dword v41, v13, s[4:7], s25 offen offset:1216 sc1
    buffer_load_dword v42, v13, s[4:7], s25 offen offset:2240 sc1
    buffer_load_dword v43, v13, s[4:7], s25 offen offset:3264 sc1
    s_waitcnt vmcnt(4)
    v_mfma_f32_16x16x32_bf16 v[52:55], v[36:39], v[24:27], 0
    v_bitop3_b32 v3, s42, v36, v37 bitop3:0x7e
    v_bitop3_b32 v4, s42, v38, v39 bitop3:0x7e
    s_waitcnt vmcnt(2)
    v_or_b32 v3, v3, v4
    v_bitop3_b32 v4, s42, v40, v41 bitop3:0x7e
    s_waitcnt vmcnt(0)
    v_mfma_f32_16x16x32_bf16 v[52:55], v[40:43], v[24:27], v[52:55]
    v_bitop3_b32 v56, s42, v42, v43 bitop3:0x7e
    v_or3_b32 v3, v3, v4, v56
    v_and_b32 v3, v0, v3
    v_cmp_ne_u32 vcc, 0, v3
    s_cbranch_vccnz mega_kernel_rs_w3_pc
    s_nop 2
    v_cvt_pk_bf16_f32 v56, v52, v53
    v_cvt_pk_bf16_f32 v57, v54, v55
    v_min_u32 v56, -2, v56
    s_mov_b64 exec, s[26:27]
    buffer_store_dwordx2 v[56:57], v9, s[4:7], s35 offen offset:192 sc1
    buffer_store_dwordx2 v[58:59], v9, s[4:7], s36 offen offset:192 sc1
    s_mov_b64 exec, -1
    s_xor_b32 s42, s42, 1
    s_branch mega_kernel_rs_w3_loop
mega_kernel_rs_w3_last:
    s_waitcnt vmcnt(0)
    v_mov_b32 v20, v64
    v_mov_b32 v21, v65
    v_mov_b32 v22, v66
    v_mov_b32 v23, v67
    s_add_u32 s45, s45, 131072
    buffer_store_dwordx4 v[20:23], v10, s[4:7], s45 offen offset:192 sc1
    buffer_store_dwordx2 v[18:19], v11, s[4:7], s45 offen offset:3584 sc1
    s_branch mega_kernel_rs_end
mega_kernel_rs_w3_pafail:
    buffer_load_dwordx4 v[56:59], v12, s[4:7], s22 offen sc1
    buffer_load_dwordx4 v[60:63], v12, s[4:7], s22 offen offset:1024 sc1
    s_nop 7
    v_mov_b32 v96, 0
    v_mov_b32 v97, 0
    v_mov_b32 v98, 0
    v_mov_b32 v99, 0
    v_mov_b32 v100, 0
    v_mov_b32 v101, 0
    v_mov_b32 v102, 0
    v_mov_b32 v103, 0
    v_mov_b32 v104, 0
    v_mov_b32 v105, 0
    v_mov_b32 v106, 0
    v_mov_b32 v107, 0
    s_branch mega_kernel_rs_w3_pa
mega_kernel_rs_w3_xslow:
    buffer_load_dwordx4 v[96:99], v1, s[4:7], s38 offen sc1
    s_waitcnt vmcnt(1)
    v_and_b32 v3, 1, v20
    v_cmp_ne_u32 vcc, s41, v3
    s_cbranch_vccz mega_kernel_rs_w3_xgot1
    buffer_load_dwordx4 v[20:23], v1, s[4:7], s38 offen sc1
mega_kernel_rs_w3_px:
    s_waitcnt vmcnt(1)
    v_and_b32 v3, 1, v96
    v_cmp_ne_u32 vcc, s41, v3
    s_cbranch_vccz mega_kernel_rs_w3_xgot0
    buffer_load_dwordx4 v[96:99], v1, s[4:7], s38 offen sc1
    s_waitcnt vmcnt(1)
    v_and_b32 v3, 1, v20
    v_cmp_ne_u32 vcc, s41, v3
    s_cbranch_vccz mega_kernel_rs_w3_xgot1
    buffer_load_dwordx4 v[20:23], v1, s[4:7], s38 offen sc1
    s_branch mega_kernel_rs_w3_px
mega_kernel_rs_w3_xgot0:
    v_mfma_f32_16x16x16_bf16 v[80:83], v[96:97], v[16:17], v[100:103]
    v_mfma_f32_16x16x16_bf16 v[84:87], v[98:99], v[16:17], v[104:107]
    v_and_b32 v3, 1, v96
    v_cmp_ne_u32 vcc, s41, v3
    s_nop 4
    v_cvt_pk_bf16_f32 v64, v80, v81
    v_cvt_pk_bf16_f32 v65, v82, v83
    v_cvt_pk_bf16_f32 v66, v84, v85
    v_cvt_pk_bf16_f32 v67, v86, v87
    ds_write_b128 v6, v[64:67] offset:17408
    s_branch mega_kernel_rs_w3_xok
mega_kernel_rs_w3_xgot1:
    v_mfma_f32_16x16x16_bf16 v[80:83], v[20:21], v[16:17], v[100:103]
    v_mfma_f32_16x16x16_bf16 v[84:87], v[22:23], v[16:17], v[104:107]
    v_and_b32 v3, 1, v20
    v_cmp_ne_u32 vcc, s41, v3
    s_nop 4
    v_cvt_pk_bf16_f32 v64, v80, v81
    v_cvt_pk_bf16_f32 v65, v82, v83
    v_cvt_pk_bf16_f32 v66, v84, v85
    v_cvt_pk_bf16_f32 v67, v86, v87
    ds_write_b128 v6, v[64:67] offset:17408
    s_branch mega_kernel_rs_w3_xok
mega_kernel_rs_w3_pv0:
    s_waitcnt vmcnt(0)
    s_branch mega_kernel_rs_w3_pv1
mega_kernel_rs_w3_pv:
    buffer_load_dwordx4 v[20:23], v1, s[4:7], s40 offen sc1
    s_waitcnt vmcnt(0)
mega_kernel_rs_w3_pv1:
    v_and_b32 v3, 1, v20
    v_cmp_ne_u32 vcc, s41, v3
    v_pk_add_f32 v[116:117], v[112:113], v[20:21]
    v_pk_add_f32 v[118:119], v[114:115], v[22:23]
    s_cbranch_vccnz mega_kernel_rs_w3_pv
    s_branch mega_kernel_rs_w3_pv2
mega_kernel_rs_end:
    s_mov_b64 exec, -1
    v_mov_b32 v3, 64
    s_waitcnt vmcnt(0)
    s_barrier
    s_cmp_lg_u32 s20, 0
    s_cbranch_scc1 mega_kernel_rs_end2
    buffer_store_dword v3, v7, s[4:7], 0 offen sc1
mega_kernel_rs_end2:
    s_waitcnt vmcnt(0)
    s_endpgm
mega_kernel_bulk:
    s_load_dwordx2 s[8:9], s[0:1], 0
    s_load_dwordx2 s[40:41], s[0:1], 16
    s_load_dwordx2 s[42:43], s[0:1], 24
    s_load_dwordx2 s[44:45], s[0:1], 32
    v_lshrrev_b32 v2, 6, v0
    v_and_b32 v1, 63, v0
    v_readfirstlane_b32 s16, v2
    s_lshr_b32 s17, s92, 6
    s_bfe_u32 s18, s92, 0x50001
    s_and_b32 s19, s92, 1
    s_waitcnt lgkmcnt(0)
    s_mov_b32 s10, 4194304
    s_mov_b32 s11, 0x00020000
    s_cmp_eq_u32 s17, 1
    s_cselect_b32 s12, s42, s40
    s_cselect_b32 s13, s43, s41
    s_cmp_eq_u32 s17, 2
    s_cselect_b32 s12, s44, s12
    s_cselect_b32 s13, s45, s13
    s_mov_b32 s14, 8388608
    s_mov_b32 s15, 0x00020000
    v_lshrrev_b32 v2, 4, v1
    v_and_b32 v3, 15, v1
    v_lshlrev_b32 v4, 2, v2
    v_xor_b32 v4, v4, v3
    v_lshlrev_b32 v4, 4, v4
    s_lshl_b32 s20, s16, 5
    v_add_u32 v11, s20, v2
    v_lshl_add_u32 v11, v11, 13, v4
    s_lshl_b32 s20, s18, 8
    v_add_u32 v11, s20, v11
    s_lshl_b32 s22, s16, 13
    s_add_u32 m0, s22, 0
    s_mov_b32 s20, 0
    buffer_load_dwordx4 v11, s[12:15], s20 offen lds
    s_add_u32 m0, s22, 1024
    s_mov_b32 s20, 32768
    buffer_load_dwordx4 v11, s[12:15], s20 offen lds
    s_add_u32 m0, s22, 2048
    s_mov_b32 s20, 65536
    buffer_load_dwordx4 v11, s[12:15], s20 offen lds
    s_add_u32 m0, s22, 3072
    s_mov_b32 s20, 98304
    buffer_load_dwordx4 v11, s[12:15], s20 offen lds
    s_add_u32 m0, s22, 4096
    s_mov_b32 s20, 131072
    buffer_load_dwordx4 v11, s[12:15], s20 offen lds
    s_add_u32 m0, s22, 5120
    s_mov_b32 s20, 163840
    buffer_load_dwordx4 v11, s[12:15], s20 offen lds
    s_add_u32 m0, s22, 6144
    s_mov_b32 s20, 196608
    buffer_load_dwordx4 v11, s[12:15], s20 offen lds
    s_add_u32 m0, s22, 7168
    s_mov_b32 s20, 229376
    buffer_load_dwordx4 v11, s[12:15], s20 offen lds
    s_add_u32 m0, s22, 32768
    s_mov_b32 s20, 1048576
    buffer_load_dwordx4 v11, s[12:15], s20 offen lds
    s_add_u32 m0, s22, 33792
    s_mov_b32 s20, 1081344
    buffer_load_dwordx4 v11, s[12:15], s20 offen lds
    s_add_u32 m0, s22, 34816
    s_mov_b32 s20, 1114112
    buffer_load_dwordx4 v11, s[12:15], s20 offen lds
    s_add_u32 m0, s22, 35840
    s_mov_b32 s20, 1146880
    buffer_load_dwordx4 v11, s[12:15], s20 offen lds
    s_add_u32 m0, s22, 36864
    s_mov_b32 s20, 1179648
    buffer_load_dwordx4 v11, s[12:15], s20 offen lds
    s_add_u32 m0, s22, 37888
    s_mov_b32 s20, 1212416
    buffer_load_dwordx4 v11, s[12:15], s20 offen lds
    s_add_u32 m0, s22, 38912
    s_mov_b32 s20, 1245184
    buffer_load_dwordx4 v11, s[12:15], s20 offen lds
    s_add_u32 m0, s22, 39936
    s_mov_b32 s20, 1277952
    buffer_load_dwordx4 v11, s[12:15], s20 offen lds
    s_add_u32 m0, s22, 65536
    s_mov_b32 s20, 2097152
    buffer_load_dwordx4 v11, s[12:15], s20 offen lds
    s_add_u32 m0, s22, 66560
    s_mov_b32 s20, 2129920
    buffer_load_dwordx4 v11, s[12:15], s20 offen lds
    s_add_u32 m0, s22, 67584
    s_mov_b32 s20, 2162688
    buffer_load_dwordx4 v11, s[12:15], s20 offen lds
    s_add_u32 m0, s22, 68608
    s_mov_b32 s20, 2195456
    buffer_load_dwordx4 v11, s[12:15], s20 offen lds
    s_add_u32 m0, s22, 69632
    s_mov_b32 s20, 2228224
    buffer_load_dwordx4 v11, s[12:15], s20 offen lds
    s_add_u32 m0, s22, 70656
    s_mov_b32 s20, 2260992
    buffer_load_dwordx4 v11, s[12:15], s20 offen lds
    s_add_u32 m0, s22, 71680
    s_mov_b32 s20, 2293760
    buffer_load_dwordx4 v11, s[12:15], s20 offen lds
    s_add_u32 m0, s22, 72704
    s_mov_b32 s20, 2326528
    buffer_load_dwordx4 v11, s[12:15], s20 offen lds
    s_add_u32 m0, s22, 98304
    s_mov_b32 s20, 3145728
    buffer_load_dwordx4 v11, s[12:15], s20 offen lds
    s_add_u32 m0, s22, 99328
    s_mov_b32 s20, 3178496
    buffer_load_dwordx4 v11, s[12:15], s20 offen lds
    s_add_u32 m0, s22, 100352
    s_mov_b32 s20, 3211264
    buffer_load_dwordx4 v11, s[12:15], s20 offen lds
    s_add_u32 m0, s22, 101376
    s_mov_b32 s20, 3244032
    buffer_load_dwordx4 v11, s[12:15], s20 offen lds
    s_add_u32 m0, s22, 102400
    s_mov_b32 s20, 3276800
    buffer_load_dwordx4 v11, s[12:15], s20 offen lds
    s_add_u32 m0, s22, 103424
    s_mov_b32 s20, 3309568
    buffer_load_dwordx4 v11, s[12:15], s20 offen lds
    s_add_u32 m0, s22, 104448
    s_mov_b32 s20, 3342336
    buffer_load_dwordx4 v11, s[12:15], s20 offen lds
    s_add_u32 m0, s22, 105472
    s_mov_b32 s20, 3375104
    buffer_load_dwordx4 v11, s[12:15], s20 offen lds
    v_and_b32 v3, 3, v1
    v_bfe_u32 v4, v1, 4, 1
    v_lshl_add_u32 v13, v3, 1, v4
    v_and_b32 v14, 1, v3
    v_lshlrev_b32 v14, 1, v14
    v_lshrrev_b32 v15, 1, v3
    v_add_u32 v14, v14, v15
    v_lshl_add_u32 v14, v4, 2, v14
    s_cmp_eq_u32 s17, 2
    s_cselect_b64 vcc, -1, 0
    v_cndmask_b32 v13, v14, v13, vcc
    v_bfe_u32 v14, v1, 2, 2
    v_xor_b32 v15, s16, v14
    v_lshlrev_b32 v15, 6, v15
    v_lshl_add_u32 v15, v13, 3, v15
    v_lshrrev_b32 v13, 5, v1
    v_lshl_add_u32 v13, v13, 3, v14
    v_lshl_add_u32 v12, v13, 8, v15
    v_and_b32 v3, 15, v1
    s_lshl_b32 s20, s16, 3
    v_add_u32 v13, s20, v2
    v_add_u32 v13, 0, v13
    v_and_b32 v14, 15, v13
    v_xor_b32 v14, v14, v3
    v_lshlrev_b32 v14, 4, v14
    v_lshl_add_u32 v6, v13, 11, v14
    v_add_u32 v13, s20, v2
    v_add_u32 v13, 4, v13
    v_and_b32 v14, 15, v13
    v_xor_b32 v14, v14, v3
    v_lshlrev_b32 v14, 4, v14
    v_lshl_add_u32 v7, v13, 11, v14
    v_and_b32 v13, 31, v1
    v_lshrrev_b32 v14, 5, v1
    v_xor_b32 v14, v14, v3
    v_lshlrev_b32 v14, 4, v14
    v_lshl_add_u32 v13, v13, 8, v14
    v_xor_b32 v16, 0, v13
    v_add_u32 v24, 0x10000, v16
    v_xor_b32 v17, 32, v13
    v_add_u32 v25, 0x10000, v17
    v_xor_b32 v18, 64, v13
    v_add_u32 v26, 0x10000, v18
    v_xor_b32 v19, 96, v13
    v_add_u32 v27, 0x10000, v19
    v_xor_b32 v20, 128, v13
    v_add_u32 v28, 0x10000, v20
    v_xor_b32 v21, 160, v13
    v_add_u32 v29, 0x10000, v21
    v_xor_b32 v22, 192, v13
    v_add_u32 v30, 0x10000, v22
    v_xor_b32 v23, 224, v13
    v_add_u32 v31, 0x10000, v23
    v_bfe_u32 v13, v1, 4, 1
    v_lshlrev_b32 v8, 10, v13
    v_lshrrev_b32 v13, 5, v1
    v_lshl_add_u32 v8, v13, 8, v8
    v_lshl_add_u32 v8, v3, 4, v8
    v_bfrev_b32 v13, 1
    s_lshl_b32 s20, s92, 7
    s_add_u32 s20, s20, 71303168
    v_mov_b32 v14, s20
    v_cmp_eq_u32 vcc, 0, v0
    s_lshl_b32 s24, s17, 24
    s_lshl_b32 s20, s19, 18
    v_cndmask_b32 v9, v13, v14, vcc
    s_add_u32 s24, s24, s20
    s_lshl_b32 s20, s18, 13
    s_add_u32 s24, s24, s20
    s_lshl_b32 s20, s16, 11
    s_add_u32 s24, s24, s20
    s_add_u32 s24, s24, 0
    s_lshl_b32 s23, s19, 16
    v_mov_b32 v10, 0
    s_lshl_b32 s21, s16, 11
    s_waitcnt vmcnt(24)
    s_barrier
    v_add_u32 v13, 0, v12
    ds_read_b64_tr_b16 a[0:1], v13 offset:0
    ds_read_b64_tr_b16 a[2:3], v13 offset:1024
    ds_read_b64_tr_b16 a[4:5], v13 offset:4096
    ds_read_b64_tr_b16 a[6:7], v13 offset:5120
    ds_read_b64_tr_b16 a[8:9], v13 offset:8192
    ds_read_b64_tr_b16 a[10:11], v13 offset:9216
    ds_read_b64_tr_b16 a[12:13], v13 offset:12288
    ds_read_b64_tr_b16 a[14:15], v13 offset:13312
    s_waitcnt lgkmcnt(0)
    ds_read_b64_tr_b16 a[16:17], v13 offset:16384
    ds_read_b64_tr_b16 a[18:19], v13 offset:17408
    ds_read_b64_tr_b16 a[20:21], v13 offset:20480
    ds_read_b64_tr_b16 a[22:23], v13 offset:21504
    ds_read_b64_tr_b16 a[24:25], v13 offset:24576
    ds_read_b64_tr_b16 a[26:27], v13 offset:25600
    ds_read_b64_tr_b16 a[28:29], v13 offset:28672
    ds_read_b64_tr_b16 a[30:31], v13 offset:29696
    s_waitcnt lgkmcnt(0)
    s_barrier
    s_add_u32 m0, s22, 0
    s_mov_b32 s20, 4194304
    buffer_load_dwordx4 v11, s[12:15], s20 offen lds
    s_add_u32 m0, s22, 1024
    s_mov_b32 s20, 4227072
    buffer_load_dwordx4 v11, s[12:15], s20 offen lds
    s_add_u32 m0, s22, 2048
    s_mov_b32 s20, 4259840
    buffer_load_dwordx4 v11, s[12:15], s20 offen lds
    s_add_u32 m0, s22, 3072
    s_mov_b32 s20, 4292608
    buffer_load_dwordx4 v11, s[12:15], s20 offen lds
    s_add_u32 m0, s22, 4096
    s_mov_b32 s20, 4325376
    buffer_load_dwordx4 v11, s[12:15], s20 offen lds
    s_add_u32 m0, s22, 5120
    s_mov_b32 s20, 4358144
    buffer_load_dwordx4 v11, s[12:15], s20 offen lds
    s_add_u32 m0, s22, 6144
    s_mov_b32 s20, 4390912
    buffer_load_dwordx4 v11, s[12:15], s20 offen lds
    s_add_u32 m0, s22, 7168
    s_mov_b32 s20, 4423680
    buffer_load_dwordx4 v11, s[12:15], s20 offen lds
    s_waitcnt vmcnt(24)
    s_barrier
    v_add_u32 v13, 32768, v12
    ds_read_b64_tr_b16 a[32:33], v13 offset:0
    ds_read_b64_tr_b16 a[34:35], v13 offset:1024
    ds_read_b64_tr_b16 a[36:37], v13 offset:4096
    ds_read_b64_tr_b16 a[38:39], v13 offset:5120
    ds_read_b64_tr_b16 a[40:41], v13 offset:8192
    ds_read_b64_tr_b16 a[42:43], v13 offset:9216
    ds_read_b64_tr_b16 a[44:45], v13 offset:12288
    ds_read_b64_tr_b16 a[46:47], v13 offset:13312
    s_waitcnt lgkmcnt(0)
    ds_read_b64_tr_b16 a[48:49], v13 offset:16384
    ds_read_b64_tr_b16 a[50:51], v13 offset:17408
    ds_read_b64_tr_b16 a[52:53], v13 offset:20480
    ds_read_b64_tr_b16 a[54:55], v13 offset:21504
    ds_read_b64_tr_b16 a[56:57], v13 offset:24576
    ds_read_b64_tr_b16 a[58:59], v13 offset:25600
    ds_read_b64_tr_b16 a[60:61], v13 offset:28672
    ds_read_b64_tr_b16 a[62:63], v13 offset:29696
    s_waitcnt lgkmcnt(0)
    s_barrier
    s_add_u32 m0, s22, 32768
    s_mov_b32 s20, 5242880
    buffer_load_dwordx4 v11, s[12:15], s20 offen lds
    s_add_u32 m0, s22, 33792
    s_mov_b32 s20, 5275648
    buffer_load_dwordx4 v11, s[12:15], s20 offen lds
    s_add_u32 m0, s22, 34816
    s_mov_b32 s20, 5308416
    buffer_load_dwordx4 v11, s[12:15], s20 offen lds
    s_add_u32 m0, s22, 35840
    s_mov_b32 s20, 5341184
    buffer_load_dwordx4 v11, s[12:15], s20 offen lds
    s_add_u32 m0, s22, 36864
    s_mov_b32 s20, 5373952
    buffer_load_dwordx4 v11, s[12:15], s20 offen lds
    s_add_u32 m0, s22, 37888
    s_mov_b32 s20, 5406720
    buffer_load_dwordx4 v11, s[12:15], s20 offen lds
    s_add_u32 m0, s22, 38912
    s_mov_b32 s20, 5439488
    buffer_load_dwordx4 v11, s[12:15], s20 offen lds
    s_add_u32 m0, s22, 39936
    s_mov_b32 s20, 5472256
    buffer_load_dwordx4 v11, s[12:15], s20 offen lds
    s_waitcnt vmcnt(24)
    s_barrier
    v_add_u32 v13, 65536, v12
    ds_read_b64_tr_b16 a[64:65], v13 offset:0
    ds_read_b64_tr_b16 a[66:67], v13 offset:1024
    ds_read_b64_tr_b16 a[68:69], v13 offset:4096
    ds_read_b64_tr_b16 a[70:71], v13 offset:5120
    ds_read_b64_tr_b16 a[72:73], v13 offset:8192
    ds_read_b64_tr_b16 a[74:75], v13 offset:9216
    ds_read_b64_tr_b16 a[76:77], v13 offset:12288
    ds_read_b64_tr_b16 a[78:79], v13 offset:13312
    s_waitcnt lgkmcnt(0)
    ds_read_b64_tr_b16 a[80:81], v13 offset:16384
    ds_read_b64_tr_b16 a[82:83], v13 offset:17408
    ds_read_b64_tr_b16 a[84:85], v13 offset:20480
    ds_read_b64_tr_b16 a[86:87], v13 offset:21504
    ds_read_b64_tr_b16 a[88:89], v13 offset:24576
    ds_read_b64_tr_b16 a[90:91], v13 offset:25600
    ds_read_b64_tr_b16 a[92:93], v13 offset:28672
    ds_read_b64_tr_b16 a[94:95], v13 offset:29696
    s_waitcnt lgkmcnt(0)
    s_barrier
    s_add_u32 m0, s22, 65536
    s_mov_b32 s20, 6291456
    buffer_load_dwordx4 v11, s[12:15], s20 offen lds
    s_add_u32 m0, s22, 66560
    s_mov_b32 s20, 6324224
    buffer_load_dwordx4 v11, s[12:15], s20 offen lds
    s_add_u32 m0, s22, 67584
    s_mov_b32 s20, 6356992
    buffer_load_dwordx4 v11, s[12:15], s20 offen lds
    s_add_u32 m0, s22, 68608
    s_mov_b32 s20, 6389760
    buffer_load_dwordx4 v11, s[12:15], s20 offen lds
    s_add_u32 m0, s22, 69632
    s_mov_b32 s20, 6422528
    buffer_load_dwordx4 v11, s[12:15], s20 offen lds
    s_add_u32 m0, s22, 70656
    s_mov_b32 s20, 6455296
    buffer_load_dwordx4 v11, s[12:15], s20 offen lds
    s_add_u32 m0, s22, 71680
    s_mov_b32 s20, 6488064
    buffer_load_dwordx4 v11, s[12:15], s20 offen lds
    s_add_u32 m0, s22, 72704
    s_mov_b32 s20, 6520832
    buffer_load_dwordx4 v11, s[12:15], s20 offen lds
    s_waitcnt vmcnt(24)
    s_barrier
    v_add_u32 v13, 98304, v12
    ds_read_b64_tr_b16 a[96:97], v13 offset:0
    ds_read_b64_tr_b16 a[98:99], v13 offset:1024
    ds_read_b64_tr_b16 a[100:101], v13 offset:4096
    ds_read_b64_tr_b16 a[102:103], v13 offset:5120
    ds_read_b64_tr_b16 a[104:105], v13 offset:8192
    ds_read_b64_tr_b16 a[106:107], v13 offset:9216
    ds_read_b64_tr_b16 a[108:109], v13 offset:12288
    ds_read_b64_tr_b16 a[110:111], v13 offset:13312
    s_waitcnt lgkmcnt(0)
    ds_read_b64_tr_b16 a[112:113], v13 offset:16384
    ds_read_b64_tr_b16 a[114:115], v13 offset:17408
    ds_read_b64_tr_b16 a[116:117], v13 offset:20480
    ds_read_b64_tr_b16 a[118:119], v13 offset:21504
    ds_read_b64_tr_b16 a[120:121], v13 offset:24576
    ds_read_b64_tr_b16 a[122:123], v13 offset:25600
    ds_read_b64_tr_b16 a[124:125], v13 offset:28672
    ds_read_b64_tr_b16 a[126:127], v13 offset:29696
    s_waitcnt lgkmcnt(0)
    s_barrier
    s_add_u32 m0, s22, 98304
    s_mov_b32 s20, 7340032
    buffer_load_dwordx4 v11, s[12:15], s20 offen lds
    s_add_u32 m0, s22, 99328
    s_mov_b32 s20, 7372800
    buffer_load_dwordx4 v11, s[12:15], s20 offen lds
    s_add_u32 m0, s22, 100352
    s_mov_b32 s20, 7405568
    buffer_load_dwordx4 v11, s[12:15], s20 offen lds
    s_add_u32 m0, s22, 101376
    s_mov_b32 s20, 7438336
    buffer_load_dwordx4 v11, s[12:15], s20 offen lds
    s_add_u32 m0, s22, 102400
    s_mov_b32 s20, 7471104
    buffer_load_dwordx4 v11, s[12:15], s20 offen lds
    s_add_u32 m0, s22, 103424
    s_mov_b32 s20, 7503872
    buffer_load_dwordx4 v11, s[12:15], s20 offen lds
    s_add_u32 m0, s22, 104448
    s_mov_b32 s20, 7536640
    buffer_load_dwordx4 v11, s[12:15], s20 offen lds
    s_add_u32 m0, s22, 105472
    s_mov_b32 s20, 7569408
    buffer_load_dwordx4 v11, s[12:15], s20 offen lds
    s_waitcnt vmcnt(24)
    s_barrier
    v_add_u32 v13, 0, v12
    ds_read_b64_tr_b16 a[128:129], v13 offset:0
    ds_read_b64_tr_b16 a[130:131], v13 offset:1024
    ds_read_b64_tr_b16 a[132:133], v13 offset:4096
    ds_read_b64_tr_b16 a[134:135], v13 offset:5120
    ds_read_b64_tr_b16 a[136:137], v13 offset:8192
    ds_read_b64_tr_b16 a[138:139], v13 offset:9216
    ds_read_b64_tr_b16 a[140:141], v13 offset:12288
    ds_read_b64_tr_b16 a[142:143], v13 offset:13312
    s_waitcnt lgkmcnt(0)
    ds_read_b64_tr_b16 a[144:145], v13 offset:16384
    ds_read_b64_tr_b16 a[146:147], v13 offset:17408
    ds_read_b64_tr_b16 a[148:149], v13 offset:20480
    ds_read_b64_tr_b16 a[150:151], v13 offset:21504
    ds_read_b64_tr_b16 a[152:153], v13 offset:24576
    ds_read_b64_tr_b16 a[154:155], v13 offset:25600
    ds_read_b64_tr_b16 a[156:157], v13 offset:28672
    ds_read_b64_tr_b16 a[158:159], v13 offset:29696
    s_waitcnt lgkmcnt(0)
    s_barrier
    s_add_u32 m0, s21, 0
    s_add_u32 s20, s23, 0
    buffer_load_dwordx4 v6, s[8:11], s20 offen lds
    s_add_u32 m0, s21, 1024
    s_add_u32 s20, s23, 0
    buffer_load_dwordx4 v7, s[8:11], s20 offen lds
    s_add_u32 m0, s21, 8192
    s_add_u32 s20, s23, 256
    buffer_load_dwordx4 v6, s[8:11], s20 offen lds
    s_add_u32 m0, s21, 9216
    s_add_u32 s20, s23, 256
    buffer_load_dwordx4 v7, s[8:11], s20 offen lds
    s_add_u32 m0, s21, 16384
    s_add_u32 s20, s23, 512
    buffer_load_dwordx4 v6, s[8:11], s20 offen lds
    s_add_u32 m0, s21, 17408
    s_add_u32 s20, s23, 512
    buffer_load_dwordx4 v7, s[8:11], s20 offen lds
    s_add_u32 m0, s21, 24576
    s_add_u32 s20, s23, 768
    buffer_load_dwordx4 v6, s[8:11], s20 offen lds
    s_add_u32 m0, s21, 25600
    s_add_u32 s20, s23, 768
    buffer_load_dwordx4 v7, s[8:11], s20 offen lds
    s_waitcnt vmcnt(24)
    s_barrier
    v_add_u32 v13, 32768, v12
    ds_read_b64_tr_b16 a[160:161], v13 offset:0
    ds_read_b64_tr_b16 a[162:163], v13 offset:1024
    ds_read_b64_tr_b16 a[164:165], v13 offset:4096
    ds_read_b64_tr_b16 a[166:167], v13 offset:5120
    ds_read_b64_tr_b16 a[168:169], v13 offset:8192
    ds_read_b64_tr_b16 a[170:171], v13 offset:9216
    ds_read_b64_tr_b16 a[172:173], v13 offset:12288
    ds_read_b64_tr_b16 a[174:175], v13 offset:13312
    s_waitcnt lgkmcnt(0)
    ds_read_b64_tr_b16 a[176:177], v13 offset:16384
    ds_read_b64_tr_b16 a[178:179], v13 offset:17408
    ds_read_b64_tr_b16 a[180:181], v13 offset:20480
    ds_read_b64_tr_b16 a[182:183], v13 offset:21504
    ds_read_b64_tr_b16 a[184:185], v13 offset:24576
    ds_read_b64_tr_b16 a[186:187], v13 offset:25600
    ds_read_b64_tr_b16 a[188:189], v13 offset:28672
    ds_read_b64_tr_b16 a[190:191], v13 offset:29696
    s_waitcnt lgkmcnt(0)
    s_barrier
    s_add_u32 m0, s21, 32768
    s_add_u32 s20, s23, 1024
    buffer_load_dwordx4 v6, s[8:11], s20 offen lds
    s_add_u32 m0, s21, 33792
    s_add_u32 s20, s23, 1024
    buffer_load_dwordx4 v7, s[8:11], s20 offen lds
    s_add_u32 m0, s21, 40960
    s_add_u32 s20, s23, 1280
    buffer_load_dwordx4 v6, s[8:11], s20 offen lds
    s_add_u32 m0, s21, 41984
    s_add_u32 s20, s23, 1280
    buffer_load_dwordx4 v7, s[8:11], s20 offen lds
    s_add_u32 m0, s21, 49152
    s_add_u32 s20, s23, 1536
    buffer_load_dwordx4 v6, s[8:11], s20 offen lds
    s_add_u32 m0, s21, 50176
    s_add_u32 s20, s23, 1536
    buffer_load_dwordx4 v7, s[8:11], s20 offen lds
    s_add_u32 m0, s21, 57344
    s_add_u32 s20, s23, 1792
    buffer_load_dwordx4 v6, s[8:11], s20 offen lds
    s_add_u32 m0, s21, 58368
    s_add_u32 s20, s23, 1792
    buffer_load_dwordx4 v7, s[8:11], s20 offen lds
    s_waitcnt vmcnt(24)
    s_barrier
    v_add_u32 v13, 65536, v12
    ds_read_b64_tr_b16 a[192:193], v13 offset:0
    ds_read_b64_tr_b16 a[194:195], v13 offset:1024
    ds_read_b64_tr_b16 a[196:197], v13 offset:4096
    ds_read_b64_tr_b16 a[198:199], v13 offset:5120
    ds_read_b64_tr_b16 a[200:201], v13 offset:8192
    ds_read_b64_tr_b16 a[202:203], v13 offset:9216
    ds_read_b64_tr_b16 a[204:205], v13 offset:12288
    ds_read_b64_tr_b16 a[206:207], v13 offset:13312
    s_waitcnt lgkmcnt(0)
    ds_read_b64_tr_b16 a[208:209], v13 offset:16384
    ds_read_b64_tr_b16 a[210:211], v13 offset:17408
    ds_read_b64_tr_b16 a[212:213], v13 offset:20480
    ds_read_b64_tr_b16 a[214:215], v13 offset:21504
    ds_read_b64_tr_b16 a[216:217], v13 offset:24576
    ds_read_b64_tr_b16 a[218:219], v13 offset:25600
    ds_read_b64_tr_b16 a[220:221], v13 offset:28672
    ds_read_b64_tr_b16 a[222:223], v13 offset:29696
    s_waitcnt lgkmcnt(0)
    s_barrier
    s_add_u32 s23, s23, 131072
    s_add_u32 m0, s21, 65536
    s_add_u32 s20, s23, 0
    buffer_load_dwordx4 v6, s[8:11], s20 offen lds
    s_add_u32 m0, s21, 66560
    s_add_u32 s20, s23, 0
    buffer_load_dwordx4 v7, s[8:11], s20 offen lds
    s_add_u32 m0, s21, 73728
    s_add_u32 s20, s23, 256
    buffer_load_dwordx4 v6, s[8:11], s20 offen lds
    s_add_u32 m0, s21, 74752
    s_add_u32 s20, s23, 256
    buffer_load_dwordx4 v7, s[8:11], s20 offen lds
    s_add_u32 m0, s21, 81920
    s_add_u32 s20, s23, 512
    buffer_load_dwordx4 v6, s[8:11], s20 offen lds
    s_add_u32 m0, s21, 82944
    s_add_u32 s20, s23, 512
    buffer_load_dwordx4 v7, s[8:11], s20 offen lds
    s_add_u32 m0, s21, 90112
    s_add_u32 s20, s23, 768
    buffer_load_dwordx4 v6, s[8:11], s20 offen lds
    s_add_u32 m0, s21, 91136
    s_add_u32 s20, s23, 768
    buffer_load_dwordx4 v7, s[8:11], s20 offen lds
    s_waitcnt vmcnt(24)
    s_barrier
    v_add_u32 v13, 98304, v12
    ds_read_b64_tr_b16 a[224:225], v13 offset:0
    ds_read_b64_tr_b16 a[226:227], v13 offset:1024
    ds_read_b64_tr_b16 a[228:229], v13 offset:4096
    ds_read_b64_tr_b16 a[230:231], v13 offset:5120
    ds_read_b64_tr_b16 a[232:233], v13 offset:8192
    ds_read_b64_tr_b16 a[234:235], v13 offset:9216
    ds_read_b64_tr_b16 a[236:237], v13 offset:12288
    ds_read_b64_tr_b16 a[238:239], v13 offset:13312
    s_waitcnt lgkmcnt(0)
    ds_read_b64_tr_b16 a[240:241], v13 offset:16384
    ds_read_b64_tr_b16 a[242:243], v13 offset:17408
    ds_read_b64_tr_b16 a[244:245], v13 offset:20480
    ds_read_b64_tr_b16 a[246:247], v13 offset:21504
    ds_read_b64_tr_b16 a[248:249], v13 offset:24576
    ds_read_b64_tr_b16 a[250:251], v13 offset:25600
    ds_read_b64_tr_b16 a[252:253], v13 offset:28672
    ds_read_b64_tr_b16 a[254:255], v13 offset:29696
    s_waitcnt lgkmcnt(0)
    s_barrier
    s_waitcnt vmcnt(16)
    s_barrier
    s_cmp_eq_u32 s17, 2
    s_cbranch_scc1 mega_kernel_q_v
    ds_read_b128 v[32:35], v16 offset:0
    ds_read_b128 v[36:39], v17 offset:0
    ds_read_b128 v[40:43], v18 offset:0
    ds_read_b128 v[44:47], v19 offset:0
    ds_read_b128 v[48:51], v20 offset:0
    ds_read_b128 v[52:55], v21 offset:0
    s_mov_b32 s25, 0
mega_kernel_q_qk_loop:
    s_waitcnt lgkmcnt(5)
    v_mfma_f32_32x32x16_bf16 v[64:79], a[0:3], v[32:35], 0
    ds_read_b128 v[56:59], v22 offset:0
    s_waitcnt lgkmcnt(5)
    v_mfma_f32_32x32x16_bf16 v[64:79], a[4:7], v[36:39], v[64:79]
    ds_read_b128 v[60:63], v23 offset:0
    s_waitcnt lgkmcnt(5)
    v_mfma_f32_32x32x16_bf16 v[64:79], a[8:11], v[40:43], v[64:79]
    ds_read_b128 v[32:35], v16 offset:8192
    s_cmp_eq_u32 s25, 0
    s_cbranch_scc1 mega_kernel_q_qk_sk2
    s_add_u32 m0, s21, 74752
    s_add_u32 s20, s23, 256
    buffer_load_dwordx4 v7, s[8:11], s20 offen lds
mega_kernel_q_qk_sk2:
    s_waitcnt lgkmcnt(5)
    v_mfma_f32_32x32x16_bf16 v[64:79], a[12:15], v[44:47], v[64:79]
    ds_read_b128 v[36:39], v17 offset:8192
    s_waitcnt lgkmcnt(5)
    v_mfma_f32_32x32x16_bf16 v[64:79], a[16:19], v[48:51], v[64:79]
    ds_read_b128 v[40:43], v18 offset:8192
    s_waitcnt lgkmcnt(5)
    v_mfma_f32_32x32x16_bf16 v[64:79], a[20:23], v[52:55], v[64:79]
    ds_read_b128 v[44:47], v19 offset:8192
    s_cmp_eq_u32 s25, 0
    s_cbranch_scc1 mega_kernel_q_qk_sk5
    s_add_u32 m0, s21, 81920
    s_add_u32 s20, s23, 512
    buffer_load_dwordx4 v6, s[8:11], s20 offen lds
mega_kernel_q_qk_sk5:
    s_waitcnt lgkmcnt(5)
    v_mfma_f32_32x32x16_bf16 v[64:79], a[24:27], v[56:59], v[64:79]
    ds_read_b128 v[48:51], v20 offset:8192
    s_waitcnt lgkmcnt(5)
    v_mfma_f32_32x32x16_bf16 v[64:79], a[28:31], v[60:63], v[64:79]
    ds_read_b128 v[52:55], v21 offset:8192
    s_waitcnt lgkmcnt(5)
    v_mfma_f32_32x32x16_bf16 v[64:79], a[32:35], v[32:35], v[64:79]
    ds_read_b128 v[56:59], v22 offset:8192
    s_cmp_eq_u32 s25, 0
    s_cbranch_scc1 mega_kernel_q_qk_sk8
    s_add_u32 m0, s21, 82944
    s_add_u32 s20, s23, 512
    buffer_load_dwordx4 v7, s[8:11], s20 offen lds
mega_kernel_q_qk_sk8:
    s_waitcnt lgkmcnt(5)
    v_mfma_f32_32x32x16_bf16 v[64:79], a[36:39], v[36:39], v[64:79]
    ds_read_b128 v[60:63], v23 offset:8192
    s_waitcnt lgkmcnt(5)
    v_mfma_f32_32x32x16_bf16 v[64:79], a[40:43], v[40:43], v[64:79]
    ds_read_b128 v[32:35], v16 offset:16384
    s_waitcnt lgkmcnt(5)
    v_mfma_f32_32x32x16_bf16 v[64:79], a[44:47], v[44:47], v[64:79]
    ds_read_b128 v[36:39], v17 offset:16384
    s_cmp_eq_u32 s25, 0
    s_cbranch_scc1 mega_kernel_q_qk_sk11
    s_add_u32 m0, s21, 90112
    s_add_u32 s20, s23, 768
    buffer_load_dwordx4 v6, s[8:11], s20 offen lds
mega_kernel_q_qk_sk11:
    s_waitcnt lgkmcnt(5)
    v_mfma_f32_32x32x16_bf16 v[64:79], a[48:51], v[48:51], v[64:79]
    ds_read_b128 v[40:43], v18 offset:16384
    s_waitcnt lgkmcnt(5)
    v_mfma_f32_32x32x16_bf16 v[64:79], a[52:55], v[52:55], v[64:79]
    ds_read_b128 v[44:47], v19 offset:16384
    s_waitcnt lgkmcnt(5)
    v_mfma_f32_32x32x16_bf16 v[64:79], a[56:59], v[56:59], v[64:79]
    ds_read_b128 v[48:51], v20 offset:16384
    s_cmp_eq_u32 s25, 0
    s_cbranch_scc1 mega_kernel_q_qk_sk14
    s_add_u32 m0, s21, 91136
    s_add_u32 s20, s23, 768
    buffer_load_dwordx4 v7, s[8:11], s20 offen lds
mega_kernel_q_qk_sk14:
    s_waitcnt lgkmcnt(5)
    v_mfma_f32_32x32x16_bf16 v[64:79], a[60:63], v[60:63], v[64:79]
    ds_read_b128 v[52:55], v21 offset:16384
    s_waitcnt lgkmcnt(5)
    v_mfma_f32_32x32x16_bf16 v[64:79], a[64:67], v[32:35], v[64:79]
    ds_read_b128 v[56:59], v22 offset:16384
    s_cmp_eq_u32 s25, 0
    s_cbranch_scc1 mega_kernel_q_qk_ne0
    v_cvt_pk_bf16_f32 v96, v80, v81
    v_cvt_pk_bf16_f32 v97, v82, v83
    v_cvt_pk_bf16_f32 v98, v84, v85
    v_cvt_pk_bf16_f32 v99, v86, v87
    buffer_store_dwordx4 v[96:99], v8, s[84:87], s24 offen offset:0 sc1
mega_kernel_q_qk_ne0:
    s_waitcnt lgkmcnt(5)
    v_mfma_f32_32x32x16_bf16 v[64:79], a[68:71], v[36:39], v[64:79]
    ds_read_b128 v[60:63], v23 offset:16384
    s_waitcnt lgkmcnt(5)
    v_mfma_f32_32x32x16_bf16 v[64:79], a[72:75], v[40:43], v[64:79]
    ds_read_b128 v[32:35], v16 offset:24576
    s_cmp_eq_u32 s25, 0
    s_cbranch_scc1 mega_kernel_q_qk_ne1
    v_cvt_pk_bf16_f32 v100, v88, v89
    v_cvt_pk_bf16_f32 v101, v90, v91
    v_cvt_pk_bf16_f32 v102, v92, v93
    v_cvt_pk_bf16_f32 v103, v94, v95
    buffer_store_dwordx4 v[100:103], v8, s[84:87], s24 offen offset:512 sc1
    s_add_u32 s24, s24, 524288
mega_kernel_q_qk_ne1:
    s_waitcnt lgkmcnt(5)
    v_mfma_f32_32x32x16_bf16 v[64:79], a[76:79], v[44:47], v[64:79]
    ds_read_b128 v[36:39], v17 offset:24576
    s_waitcnt lgkmcnt(5)
    v_mfma_f32_32x32x16_bf16 v[64:79], a[80:83], v[48:51], v[64:79]
    ds_read_b128 v[40:43], v18 offset:24576
    s_waitcnt lgkmcnt(5)
    v_mfma_f32_32x32x16_bf16 v[64:79], a[84:87], v[52:55], v[64:79]
    ds_read_b128 v[44:47], v19 offset:24576
    s_waitcnt lgkmcnt(5)
    v_mfma_f32_32x32x16_bf16 v[64:79], a[88:91], v[56:59], v[64:79]
    ds_read_b128 v[48:51], v20 offset:24576
    s_waitcnt lgkmcnt(5)
    v_mfma_f32_32x32x16_bf16 v[64:79], a[92:95], v[60:63], v[64:79]
    ds_read_b128 v[52:55], v21 offset:24576
    s_waitcnt vmcnt(8)
    s_barrier
    s_waitcnt lgkmcnt(5)
    v_mfma_f32_32x32x16_bf16 v[64:79], a[96:99], v[32:35], v[64:79]
    ds_read_b128 v[56:59], v22 offset:24576
    s_waitcnt lgkmcnt(5)
    v_mfma_f32_32x32x16_bf16 v[64:79], a[100:103], v[36:39], v[64:79]
    ds_read_b128 v[60:63], v23 offset:24576
    s_add_u32 m0, s21, 98304
    s_add_u32 s20, s23, 1024
    buffer_load_dwordx4 v6, s[8:11], s20 offen lds
    s_waitcnt lgkmcnt(5)
    v_mfma_f32_32x32x16_bf16 v[64:79], a[104:107], v[40:43], v[64:79]
    ds_read_b128 v[32:35], v16 offset:32768
    s_waitcnt lgkmcnt(5)
    v_mfma_f32_32x32x16_bf16 v[64:79], a[108:111], v[44:47], v[64:79]
    ds_read_b128 v[36:39], v17 offset:32768
    s_waitcnt lgkmcnt(5)
    v_mfma_f32_32x32x16_bf16 v[64:79], a[112:115], v[48:51], v[64:79]
    ds_read_b128 v[40:43], v18 offset:32768
    s_add_u32 m0, s21, 99328
    s_add_u32 s20, s23, 1024
    buffer_load_dwordx4 v7, s[8:11], s20 offen lds
    s_waitcnt lgkmcnt(5)
    v_mfma_f32_32x32x16_bf16 v[64:79], a[116:119], v[52:55], v[64:79]
    ds_read_b128 v[44:47], v19 offset:32768
    s_waitcnt lgkmcnt(5)
    v_mfma_f32_32x32x16_bf16 v[64:79], a[120:123], v[56:59], v[64:79]
    ds_read_b128 v[48:51], v20 offset:32768
    s_waitcnt lgkmcnt(5)
    v_mfma_f32_32x32x16_bf16 v[64:79], a[124:127], v[60:63], v[64:79]
    ds_read_b128 v[52:55], v21 offset:32768
    s_add_u32 m0, s21, 106496
    s_add_u32 s20, s23, 1280
    buffer_load_dwordx4 v6, s[8:11], s20 offen lds
    s_waitcnt lgkmcnt(5)
    v_mfma_f32_32x32x16_bf16 v[64:79], a[128:131], v[32:35], v[64:79]
    ds_read_b128 v[56:59], v22 offset:32768
    s_waitcnt lgkmcnt(5)
    v_mfma_f32_32x32x16_bf16 v[64:79], a[132:135], v[36:39], v[64:79]
    ds_read_b128 v[60:63], v23 offset:32768
    s_waitcnt lgkmcnt(5)
    v_mfma_f32_32x32x16_bf16 v[64:79], a[136:139], v[40:43], v[64:79]
    ds_read_b128 v[32:35], v16 offset:40960
    s_add_u32 m0, s21, 107520
    s_add_u32 s20, s23, 1280
    buffer_load_dwordx4 v7, s[8:11], s20 offen lds
    s_waitcnt lgkmcnt(5)
    v_mfma_f32_32x32x16_bf16 v[64:79], a[140:143], v[44:47], v[64:79]
    ds_read_b128 v[36:39], v17 offset:40960
    s_waitcnt lgkmcnt(5)
    v_mfma_f32_32x32x16_bf16 v[64:79], a[144:147], v[48:51], v[64:79]
    ds_read_b128 v[40:43], v18 offset:40960
    s_waitcnt lgkmcnt(5)
    v_mfma_f32_32x32x16_bf16 v[64:79], a[148:151], v[52:55], v[64:79]
    ds_read_b128 v[44:47], v19 offset:40960
    s_add_u32 m0, s21, 114688
    s_add_u32 s20, s23, 1536
    buffer_load_dwordx4 v6, s[8:11], s20 offen lds
    s_waitcnt lgkmcnt(5)
    v_mfma_f32_32x32x16_bf16 v[64:79], a[152:155], v[56:59], v[64:79]
    ds_read_b128 v[48:51], v20 offset:40960
    s_waitcnt lgkmcnt(5)
    v_mfma_f32_32x32x16_bf16 v[64:79], a[156:159], v[60:63], v[64:79]
    ds_read_b128 v[52:55], v21 offset:40960
    s_waitcnt lgkmcnt(5)
    v_mfma_f32_32x32x16_bf16 v[64:79], a[160:163], v[32:35], v[64:79]
    ds_read_b128 v[56:59], v22 offset:40960
    s_add_u32 m0, s21, 115712
    s_add_u32 s20, s23, 1536
    buffer_load_dwordx4 v7, s[8:11], s20 offen lds
    s_waitcnt lgkmcnt(5)
    v_mfma_f32_32x32x16_bf16 v[64:79], a[164:167], v[36:39], v[64:79]
    ds_read_b128 v[60:63], v23 offset:40960
    s_waitcnt lgkmcnt(5)
    v_mfma_f32_32x32x16_bf16 v[64:79], a[168:171], v[40:43], v[64:79]
    ds_read_b128 v[32:35], v16 offset:49152
    s_waitcnt lgkmcnt(5)
    v_mfma_f32_32x32x16_bf16 v[64:79], a[172:175], v[44:47], v[64:79]
    ds_read_b128 v[36:39], v17 offset:49152
    s_add_u32 m0, s21, 122880
    s_add_u32 s20, s23, 1792
    buffer_load_dwordx4 v6, s[8:11], s20 offen lds
    s_waitcnt lgkmcnt(5)
    v_mfma_f32_32x32x16_bf16 v[64:79], a[176:179], v[48:51], v[64:79]
    ds_read_b128 v[40:43], v18 offset:49152
    s_waitcnt lgkmcnt(5)
    v_mfma_f32_32x32x16_bf16 v[64:79], a[180:183], v[52:55], v[64:79]
    ds_read_b128 v[44:47], v19 offset:49152
    s_waitcnt lgkmcnt(5)
    v_mfma_f32_32x32x16_bf16 v[64:79], a[184:187], v[56:59], v[64:79]
    ds_read_b128 v[48:51], v20 offset:49152
    s_add_u32 m0, s21, 123904
    s_add_u32 s20, s23, 1792
    buffer_load_dwordx4 v7, s[8:11], s20 offen lds
    s_waitcnt lgkmcnt(5)
    v_mfma_f32_32x32x16_bf16 v[64:79], a[188:191], v[60:63], v[64:79]
    ds_read_b128 v[52:55], v21 offset:49152
    s_waitcnt lgkmcnt(5)
    v_mfma_f32_32x32x16_bf16 v[64:79], a[192:195], v[32:35], v[64:79]
    ds_read_b128 v[56:59], v22 offset:49152
    s_waitcnt lgkmcnt(5)
    v_mfma_f32_32x32x16_bf16 v[64:79], a[196:199], v[36:39], v[64:79]
    ds_read_b128 v[60:63], v23 offset:49152
    s_waitcnt lgkmcnt(5)
    v_mfma_f32_32x32x16_bf16 v[64:79], a[200:203], v[40:43], v[64:79]
    ds_read_b128 v[32:35], v16 offset:57344
    s_waitcnt lgkmcnt(5)
    v_mfma_f32_32x32x16_bf16 v[64:79], a[204:207], v[44:47], v[64:79]
    ds_read_b128 v[36:39], v17 offset:57344
    s_waitcnt lgkmcnt(5)
    v_mfma_f32_32x32x16_bf16 v[64:79], a[208:211], v[48:51], v[64:79]
    ds_read_b128 v[40:43], v18 offset:57344
    s_waitcnt lgkmcnt(5)
    v_mfma_f32_32x32x16_bf16 v[64:79], a[212:215], v[52:55], v[64:79]
    ds_read_b128 v[44:47], v19 offset:57344
    s_waitcnt lgkmcnt(5)
    v_mfma_f32_32x32x16_bf16 v[64:79], a[216:219], v[56:59], v[64:79]
    ds_read_b128 v[48:51], v20 offset:57344
    s_waitcnt lgkmcnt(5)
    v_mfma_f32_32x32x16_bf16 v[64:79], a[220:223], v[60:63], v[64:79]
    ds_read_b128 v[52:55], v21 offset:57344
    s_waitcnt vmcnt(8)
    s_barrier
    s_waitcnt lgkmcnt(5)
    v_mfma_f32_32x32x16_bf16 v[64:79], a[224:227], v[32:35], v[64:79]
    ds_read_b128 v[56:59], v22 offset:57344
    s_waitcnt lgkmcnt(5)
    v_mfma_f32_32x32x16_bf16 v[64:79], a[228:231], v[36:39], v[64:79]
    ds_read_b128 v[60:63], v23 offset:57344
    s_add_u32 s23, s23, 131072
    s_add_u32 m0, s21, 0
    s_add_u32 s20, s23, 0
    buffer_load_dwordx4 v6, s[8:11], s20 offen lds
    s_waitcnt lgkmcnt(5)
    v_mfma_f32_32x32x16_bf16 v[64:79], a[232:235], v[40:43], v[64:79]
    ds_read_b128 v[32:35], v24 offset:0
    s_cmp_eq_u32 s25, 0
    s_cbranch_scc1 mega_kernel_q_qk_nf
    v_add_u32 v10, 1, v10
    buffer_store_dword v10, v9, s[84:87], 0 offen sc1
mega_kernel_q_qk_nf:
    s_waitcnt lgkmcnt(5)
    v_mfma_f32_32x32x16_bf16 v[64:79], a[236:239], v[44:47], v[64:79]
    ds_read_b128 v[36:39], v25 offset:0
    s_waitcnt lgkmcnt(5)
    v_mfma_f32_32x32x16_bf16 v[64:79], a[240:243], v[48:51], v[64:79]
    ds_read_b128 v[40:43], v26 offset:0
    s_add_u32 m0, s21, 1024
    s_add_u32 s20, s23, 0
    buffer_load_dwordx4 v7, s[8:11], s20 offen lds
    s_waitcnt lgkmcnt(5)
    v_mfma_f32_32x32x16_bf16 v[64:79], a[244:247], v[52:55], v[64:79]
    ds_read_b128 v[44:47], v27 offset:0
    s_waitcnt lgkmcnt(5)
    v_mfma_f32_32x32x16_bf16 v[64:79], a[248:251], v[56:59], v[64:79]
    ds_read_b128 v[48:51], v28 offset:0
    s_waitcnt lgkmcnt(5)
    v_mfma_f32_32x32x16_bf16 v[64:79], a[252:255], v[60:63], v[64:79]
    ds_read_b128 v[52:55], v29 offset:0
    s_add_u32 m0, s21, 8192
    s_add_u32 s20, s23, 256
    buffer_load_dwordx4 v6, s[8:11], s20 offen lds
    s_waitcnt lgkmcnt(5)
    v_mfma_f32_32x32x16_bf16 v[80:95], a[0:3], v[32:35], 0
    ds_read_b128 v[56:59], v30 offset:0
    s_waitcnt lgkmcnt(5)
    v_mfma_f32_32x32x16_bf16 v[80:95], a[4:7], v[36:39], v[80:95]
    ds_read_b128 v[60:63], v31 offset:0
    s_waitcnt lgkmcnt(5)
    v_mfma_f32_32x32x16_bf16 v[80:95], a[8:11], v[40:43], v[80:95]
    ds_read_b128 v[32:35], v24 offset:8192
    s_add_u32 m0, s21, 9216
    s_add_u32 s20, s23, 256
    buffer_load_dwordx4 v7, s[8:11], s20 offen lds
    s_waitcnt lgkmcnt(5)
    v_mfma_f32_32x32x16_bf16 v[80:95], a[12:15], v[44:47], v[80:95]
    ds_read_b128 v[36:39], v25 offset:8192
    s_waitcnt lgkmcnt(5)
    v_mfma_f32_32x32x16_bf16 v[80:95], a[16:19], v[48:51], v[80:95]
    ds_read_b128 v[40:43], v26 offset:8192
    s_waitcnt lgkmcnt(5)
    v_mfma_f32_32x32x16_bf16 v[80:95], a[20:23], v[52:55], v[80:95]
    ds_read_b128 v[44:47], v27 offset:8192
    s_add_u32 m0, s21, 16384
    s_add_u32 s20, s23, 512
    buffer_load_dwordx4 v6, s[8:11], s20 offen lds
    s_waitcnt lgkmcnt(5)
    v_mfma_f32_32x32x16_bf16 v[80:95], a[24:27], v[56:59], v[80:95]
    ds_read_b128 v[48:51], v28 offset:8192
    s_waitcnt lgkmcnt(5)
    v_mfma_f32_32x32x16_bf16 v[80:95], a[28:31], v[60:63], v[80:95]
    ds_read_b128 v[52:55], v29 offset:8192
    s_waitcnt lgkmcnt(5)
    v_mfma_f32_32x32x16_bf16 v[80:95], a[32:35], v[32:35], v[80:95]
    ds_read_b128 v[56:59], v30 offset:8192
    s_add_u32 m0, s21, 17408
    s_add_u32 s20, s23, 512
    buffer_load_dwordx4 v7, s[8:11], s20 offen lds
    s_waitcnt lgkmcnt(5)
    v_mfma_f32_32x32x16_bf16 v[80:95], a[36:39], v[36:39], v[80:95]
    ds_read_b128 v[60:63], v31 offset:8192
    s_waitcnt lgkmcnt(5)
    v_mfma_f32_32x32x16_bf16 v[80:95], a[40:43], v[40:43], v[80:95]
    ds_read_b128 v[32:35], v24 offset:16384
    s_waitcnt lgkmcnt(5)
    v_mfma_f32_32x32x16_bf16 v[80:95], a[44:47], v[44:47], v[80:95]
    ds_read_b128 v[36:39], v25 offset:16384
    s_add_u32 m0, s21, 24576
    s_add_u32 s20, s23, 768
    buffer_load_dwordx4 v6, s[8:11], s20 offen lds
    s_waitcnt lgkmcnt(5)
    v_mfma_f32_32x32x16_bf16 v[80:95], a[48:51], v[48:51], v[80:95]
    ds_read_b128 v[40:43], v26 offset:16384
    s_waitcnt lgkmcnt(5)
    v_mfma_f32_32x32x16_bf16 v[80:95], a[52:55], v[52:55], v[80:95]
    ds_read_b128 v[44:47], v27 offset:16384
    s_waitcnt lgkmcnt(5)
    v_mfma_f32_32x32x16_bf16 v[80:95], a[56:59], v[56:59], v[80:95]
    ds_read_b128 v[48:51], v28 offset:16384
    s_add_u32 m0, s21, 25600
    s_add_u32 s20, s23, 768
    buffer_load_dwordx4 v7, s[8:11], s20 offen lds
    s_waitcnt lgkmcnt(5)
    v_mfma_f32_32x32x16_bf16 v[80:95], a[60:63], v[60:63], v[80:95]
    ds_read_b128 v[52:55], v29 offset:16384
    s_waitcnt lgkmcnt(5)
    v_mfma_f32_32x32x16_bf16 v[80:95], a[64:67], v[32:35], v[80:95]
    ds_read_b128 v[56:59], v30 offset:16384
    v_cvt_pk_bf16_f32 v96, v64, v65
    v_cvt_pk_bf16_f32 v97, v66, v67
    v_cvt_pk_bf16_f32 v98, v68, v69
    v_cvt_pk_bf16_f32 v99, v70, v71
    buffer_store_dwordx4 v[96:99], v8, s[84:87], s24 offen offset:0 sc1
    s_waitcnt lgkmcnt(5)
    v_mfma_f32_32x32x16_bf16 v[80:95], a[68:71], v[36:39], v[80:95]
    ds_read_b128 v[60:63], v31 offset:16384
    s_waitcnt lgkmcnt(5)
    v_mfma_f32_32x32x16_bf16 v[80:95], a[72:75], v[40:43], v[80:95]
    ds_read_b128 v[32:35], v24 offset:24576
    v_cvt_pk_bf16_f32 v100, v72, v73
    v_cvt_pk_bf16_f32 v101, v74, v75
    v_cvt_pk_bf16_f32 v102, v76, v77
    v_cvt_pk_bf16_f32 v103, v78, v79
    buffer_store_dwordx4 v[100:103], v8, s[84:87], s24 offen offset:512 sc1
    s_add_u32 s24, s24, 524288
    s_waitcnt lgkmcnt(5)
    v_mfma_f32_32x32x16_bf16 v[80:95], a[76:79], v[44:47], v[80:95]
    ds_read_b128 v[36:39], v25 offset:24576
    s_waitcnt lgkmcnt(5)
    v_mfma_f32_32x32x16_bf16 v[80:95], a[80:83], v[48:51], v[80:95]
    ds_read_b128 v[40:43], v26 offset:24576
    s_waitcnt lgkmcnt(5)
    v_mfma_f32_32x32x16_bf16 v[80:95], a[84:87], v[52:55], v[80:95]
    ds_read_b128 v[44:47], v27 offset:24576
    s_waitcnt lgkmcnt(5)
    v_mfma_f32_32x32x16_bf16 v[80:95], a[88:91], v[56:59], v[80:95]
    ds_read_b128 v[48:51], v28 offset:24576
    s_waitcnt lgkmcnt(5)
    v_mfma_f32_32x32x16_bf16 v[80:95], a[92:95], v[60:63], v[80:95]
    ds_read_b128 v[52:55], v29 offset:24576
    s_waitcnt vmcnt(8)
    s_barrier
    s_waitcnt lgkmcnt(5)
    v_mfma_f32_32x32x16_bf16 v[80:95], a[96:99], v[32:35], v[80:95]
    ds_read_b128 v[56:59], v30 offset:24576
    s_waitcnt lgkmcnt(5)
    v_mfma_f32_32x32x16_bf16 v[80:95], a[100:103], v[36:39], v[80:95]
    ds_read_b128 v[60:63], v31 offset:24576
    s_add_u32 m0, s21, 32768
    s_add_u32 s20, s23, 1024
    buffer_load_dwordx4 v6, s[8:11], s20 offen lds
    s_waitcnt lgkmcnt(5)
    v_mfma_f32_32x32x16_bf16 v[80:95], a[104:107], v[40:43], v[80:95]
    ds_read_b128 v[32:35], v24 offset:32768
    s_waitcnt lgkmcnt(5)
    v_mfma_f32_32x32x16_bf16 v[80:95], a[108:111], v[44:47], v[80:95]
    ds_read_b128 v[36:39], v25 offset:32768
    s_waitcnt lgkmcnt(5)
    v_mfma_f32_32x32x16_bf16 v[80:95], a[112:115], v[48:51], v[80:95]
    ds_read_b128 v[40:43], v26 offset:32768
    s_add_u32 m0, s21, 33792
    s_add_u32 s20, s23, 1024
    buffer_load_dwordx4 v7, s[8:11], s20 offen lds
    s_waitcnt lgkmcnt(5)
    v_mfma_f32_32x32x16_bf16 v[80:95], a[116:119], v[52:55], v[80:95]
    ds_read_b128 v[44:47], v27 offset:32768
    s_waitcnt lgkmcnt(5)
    v_mfma_f32_32x32x16_bf16 v[80:95], a[120:123], v[56:59], v[80:95]
    ds_read_b128 v[48:51], v28 offset:32768
    s_waitcnt lgkmcnt(5)
    v_mfma_f32_32x32x16_bf16 v[80:95], a[124:127], v[60:63], v[80:95]
    ds_read_b128 v[52:55], v29 offset:32768
    s_add_u32 m0, s21, 40960
    s_add_u32 s20, s23, 1280
    buffer_load_dwordx4 v6, s[8:11], s20 offen lds
    s_waitcnt lgkmcnt(5)
    v_mfma_f32_32x32x16_bf16 v[80:95], a[128:131], v[32:35], v[80:95]
    ds_read_b128 v[56:59], v30 offset:32768
    s_waitcnt lgkmcnt(5)
    v_mfma_f32_32x32x16_bf16 v[80:95], a[132:135], v[36:39], v[80:95]
    ds_read_b128 v[60:63], v31 offset:32768
    s_waitcnt lgkmcnt(5)
    v_mfma_f32_32x32x16_bf16 v[80:95], a[136:139], v[40:43], v[80:95]
    ds_read_b128 v[32:35], v24 offset:40960
    s_add_u32 m0, s21, 41984
    s_add_u32 s20, s23, 1280
    buffer_load_dwordx4 v7, s[8:11], s20 offen lds
    s_waitcnt lgkmcnt(5)
    v_mfma_f32_32x32x16_bf16 v[80:95], a[140:143], v[44:47], v[80:95]
    ds_read_b128 v[36:39], v25 offset:40960
    s_waitcnt lgkmcnt(5)
    v_mfma_f32_32x32x16_bf16 v[80:95], a[144:147], v[48:51], v[80:95]
    ds_read_b128 v[40:43], v26 offset:40960
    s_waitcnt lgkmcnt(5)
    v_mfma_f32_32x32x16_bf16 v[80:95], a[148:151], v[52:55], v[80:95]
    ds_read_b128 v[44:47], v27 offset:40960
    s_add_u32 m0, s21, 49152
    s_add_u32 s20, s23, 1536
    buffer_load_dwordx4 v6, s[8:11], s20 offen lds
    s_waitcnt lgkmcnt(5)
    v_mfma_f32_32x32x16_bf16 v[80:95], a[152:155], v[56:59], v[80:95]
    ds_read_b128 v[48:51], v28 offset:40960
    s_waitcnt lgkmcnt(5)
    v_mfma_f32_32x32x16_bf16 v[80:95], a[156:159], v[60:63], v[80:95]
    ds_read_b128 v[52:55], v29 offset:40960
    s_waitcnt lgkmcnt(5)
    v_mfma_f32_32x32x16_bf16 v[80:95], a[160:163], v[32:35], v[80:95]
    ds_read_b128 v[56:59], v30 offset:40960
    s_add_u32 m0, s21, 50176
    s_add_u32 s20, s23, 1536
    buffer_load_dwordx4 v7, s[8:11], s20 offen lds
    s_waitcnt lgkmcnt(5)
    v_mfma_f32_32x32x16_bf16 v[80:95], a[164:167], v[36:39], v[80:95]
    ds_read_b128 v[60:63], v31 offset:40960
    s_waitcnt lgkmcnt(5)
    v_mfma_f32_32x32x16_bf16 v[80:95], a[168:171], v[40:43], v[80:95]
    ds_read_b128 v[32:35], v24 offset:49152
    s_waitcnt lgkmcnt(5)
    v_mfma_f32_32x32x16_bf16 v[80:95], a[172:175], v[44:47], v[80:95]
    ds_read_b128 v[36:39], v25 offset:49152
    s_add_u32 m0, s21, 57344
    s_add_u32 s20, s23, 1792
    buffer_load_dwordx4 v6, s[8:11], s20 offen lds
    s_waitcnt lgkmcnt(5)
    v_mfma_f32_32x32x16_bf16 v[80:95], a[176:179], v[48:51], v[80:95]
    ds_read_b128 v[40:43], v26 offset:49152
    s_waitcnt lgkmcnt(5)
    v_mfma_f32_32x32x16_bf16 v[80:95], a[180:183], v[52:55], v[80:95]
    ds_read_b128 v[44:47], v27 offset:49152
    s_waitcnt lgkmcnt(5)
    v_mfma_f32_32x32x16_bf16 v[80:95], a[184:187], v[56:59], v[80:95]
    ds_read_b128 v[48:51], v28 offset:49152
    s_add_u32 m0, s21, 58368
    s_add_u32 s20, s23, 1792
    buffer_load_dwordx4 v7, s[8:11], s20 offen lds
    s_waitcnt lgkmcnt(5)
    v_mfma_f32_32x32x16_bf16 v[80:95], a[188:191], v[60:63], v[80:95]
    ds_read_b128 v[52:55], v29 offset:49152
    s_waitcnt lgkmcnt(5)
    v_mfma_f32_32x32x16_bf16 v[80:95], a[192:195], v[32:35], v[80:95]
    ds_read_b128 v[56:59], v30 offset:49152
    s_waitcnt lgkmcnt(5)
    v_mfma_f32_32x32x16_bf16 v[80:95], a[196:199], v[36:39], v[80:95]
    ds_read_b128 v[60:63], v31 offset:49152
    s_waitcnt lgkmcnt(5)
    v_mfma_f32_32x32x16_bf16 v[80:95], a[200:203], v[40:43], v[80:95]
    ds_read_b128 v[32:35], v24 offset:57344
    s_waitcnt lgkmcnt(5)
    v_mfma_f32_32x32x16_bf16 v[80:95], a[204:207], v[44:47], v[80:95]
    ds_read_b128 v[36:39], v25 offset:57344
    s_waitcnt lgkmcnt(5)
    v_mfma_f32_32x32x16_bf16 v[80:95], a[208:211], v[48:51], v[80:95]
    ds_read_b128 v[40:43], v26 offset:57344
    s_waitcnt lgkmcnt(5)
    v_mfma_f32_32x32x16_bf16 v[80:95], a[212:215], v[52:55], v[80:95]
    ds_read_b128 v[44:47], v27 offset:57344
    s_waitcnt lgkmcnt(5)
    v_mfma_f32_32x32x16_bf16 v[80:95], a[216:219], v[56:59], v[80:95]
    ds_read_b128 v[48:51], v28 offset:57344
    s_waitcnt lgkmcnt(5)
    v_mfma_f32_32x32x16_bf16 v[80:95], a[220:223], v[60:63], v[80:95]
    ds_read_b128 v[52:55], v29 offset:57344
    s_waitcnt vmcnt(8)
    s_barrier
    s_waitcnt lgkmcnt(5)
    v_mfma_f32_32x32x16_bf16 v[80:95], a[224:227], v[32:35], v[80:95]
    ds_read_b128 v[56:59], v30 offset:57344
    s_waitcnt lgkmcnt(5)
    v_mfma_f32_32x32x16_bf16 v[80:95], a[228:231], v[36:39], v[80:95]
    ds_read_b128 v[60:63], v31 offset:57344
    s_add_u32 s23, s23, 131072
    s_add_u32 m0, s21, 65536
    s_add_u32 s20, s23, 0
    buffer_load_dwordx4 v6, s[8:11], s20 offen lds
    s_waitcnt lgkmcnt(5)
    v_mfma_f32_32x32x16_bf16 v[80:95], a[232:235], v[40:43], v[80:95]
    ds_read_b128 v[32:35], v16 offset:0
    v_add_u32 v10, 1, v10
    buffer_store_dword v10, v9, s[84:87], 0 offen sc1
    s_waitcnt lgkmcnt(5)
    v_mfma_f32_32x32x16_bf16 v[80:95], a[236:239], v[44:47], v[80:95]
    ds_read_b128 v[36:39], v17 offset:0
    s_waitcnt lgkmcnt(5)
    v_mfma_f32_32x32x16_bf16 v[80:95], a[240:243], v[48:51], v[80:95]
    ds_read_b128 v[40:43], v18 offset:0
    s_add_u32 m0, s21, 66560
    s_add_u32 s20, s23, 0
    buffer_load_dwordx4 v7, s[8:11], s20 offen lds
    s_waitcnt lgkmcnt(5)
    v_mfma_f32_32x32x16_bf16 v[80:95], a[244:247], v[52:55], v[80:95]
    ds_read_b128 v[44:47], v19 offset:0
    s_waitcnt lgkmcnt(5)
    v_mfma_f32_32x32x16_bf16 v[80:95], a[248:251], v[56:59], v[80:95]
    ds_read_b128 v[48:51], v20 offset:0
    s_waitcnt lgkmcnt(5)
    v_mfma_f32_32x32x16_bf16 v[80:95], a[252:255], v[60:63], v[80:95]
    ds_read_b128 v[52:55], v21 offset:0
    s_add_u32 m0, s21, 73728
    s_add_u32 s20, s23, 256
    buffer_load_dwordx4 v6, s[8:11], s20 offen lds
    s_add_u32 s25, s25, 1
    s_cmp_lt_u32 s25, 16
    s_cbranch_scc1 mega_kernel_q_qk_loop
    s_nop 11
    v_cvt_pk_bf16_f32 v96, v80, v81
    v_cvt_pk_bf16_f32 v97, v82, v83
    v_cvt_pk_bf16_f32 v98, v84, v85
    v_cvt_pk_bf16_f32 v99, v86, v87
    buffer_store_dwordx4 v[96:99], v8, s[84:87], s24 offen offset:0 sc1
    v_cvt_pk_bf16_f32 v100, v88, v89
    v_cvt_pk_bf16_f32 v101, v90, v91
    v_cvt_pk_bf16_f32 v102, v92, v93
    v_cvt_pk_bf16_f32 v103, v94, v95
    buffer_store_dwordx4 v[100:103], v8, s[84:87], s24 offen offset:512 sc1
    s_add_u32 s24, s24, 524288
    s_waitcnt vmcnt(0) lgkmcnt(0)
    s_barrier
    v_add_u32 v10, 1, v10
    buffer_store_dword v10, v9, s[84:87], 0 offen sc1
    s_branch mega_kernel_q_done
mega_kernel_q_v:
    ds_read_b128 v[32:35], v16 offset:0
    ds_read_b128 v[36:39], v17 offset:0
    ds_read_b128 v[40:43], v18 offset:0
    ds_read_b128 v[44:47], v19 offset:0
    ds_read_b128 v[48:51], v20 offset:0
    ds_read_b128 v[52:55], v21 offset:0
    s_mov_b32 s25, 0
mega_kernel_q_v_loop:
    s_waitcnt lgkmcnt(5)
    v_mfma_f32_32x32x16_bf16 v[64:79], v[32:35], a[0:3], 0
    ds_read_b128 v[56:59], v22 offset:0
    s_waitcnt lgkmcnt(5)
    v_mfma_f32_32x32x16_bf16 v[64:79], v[36:39], a[4:7], v[64:79]
    ds_read_b128 v[60:63], v23 offset:0
    s_waitcnt lgkmcnt(5)
    v_mfma_f32_32x32x16_bf16 v[64:79], v[40:43], a[8:11], v[64:79]
    ds_read_b128 v[32:35], v16 offset:8192
    s_cmp_eq_u32 s25, 0
    s_cbranch_scc1 mega_kernel_q_v_sk2
    s_add_u32 m0, s21, 74752
    s_add_u32 s20, s23, 256
    buffer_load_dwordx4 v7, s[8:11], s20 offen lds
mega_kernel_q_v_sk2:
    s_waitcnt lgkmcnt(5)
    v_mfma_f32_32x32x16_bf16 v[64:79], v[44:47], a[12:15], v[64:79]
    ds_read_b128 v[36:39], v17 offset:8192
    s_waitcnt lgkmcnt(5)
    v_mfma_f32_32x32x16_bf16 v[64:79], v[48:51], a[16:19], v[64:79]
    ds_read_b128 v[40:43], v18 offset:8192
    s_waitcnt lgkmcnt(5)
    v_mfma_f32_32x32x16_bf16 v[64:79], v[52:55], a[20:23], v[64:79]
    ds_read_b128 v[44:47], v19 offset:8192
    s_cmp_eq_u32 s25, 0
    s_cbranch_scc1 mega_kernel_q_v_sk5
    s_add_u32 m0, s21, 81920
    s_add_u32 s20, s23, 512
    buffer_load_dwordx4 v6, s[8:11], s20 offen lds
mega_kernel_q_v_sk5:
    s_waitcnt lgkmcnt(5)
    v_mfma_f32_32x32x16_bf16 v[64:79], v[56:59], a[24:27], v[64:79]
    ds_read_b128 v[48:51], v20 offset:8192
    s_waitcnt lgkmcnt(5)
    v_mfma_f32_32x32x16_bf16 v[64:79], v[60:63], a[28:31], v[64:79]
    ds_read_b128 v[52:55], v21 offset:8192
    s_waitcnt lgkmcnt(5)
    v_mfma_f32_32x32x16_bf16 v[64:79], v[32:35], a[32:35], v[64:79]
    ds_read_b128 v[56:59], v22 offset:8192
    s_cmp_eq_u32 s25, 0
    s_cbranch_scc1 mega_kernel_q_v_sk8
    s_add_u32 m0, s21, 82944
    s_add_u32 s20, s23, 512
    buffer_load_dwordx4 v7, s[8:11], s20 offen lds
mega_kernel_q_v_sk8:
    s_waitcnt lgkmcnt(5)
    v_mfma_f32_32x32x16_bf16 v[64:79], v[36:39], a[36:39], v[64:79]
    ds_read_b128 v[60:63], v23 offset:8192
    s_waitcnt lgkmcnt(5)
    v_mfma_f32_32x32x16_bf16 v[64:79], v[40:43], a[40:43], v[64:79]
    ds_read_b128 v[32:35], v16 offset:16384
    s_waitcnt lgkmcnt(5)
    v_mfma_f32_32x32x16_bf16 v[64:79], v[44:47], a[44:47], v[64:79]
    ds_read_b128 v[36:39], v17 offset:16384
    s_cmp_eq_u32 s25, 0
    s_cbranch_scc1 mega_kernel_q_v_sk11
    s_add_u32 m0, s21, 90112
    s_add_u32 s20, s23, 768
    buffer_load_dwordx4 v6, s[8:11], s20 offen lds
mega_kernel_q_v_sk11:
    s_waitcnt lgkmcnt(5)
    v_mfma_f32_32x32x16_bf16 v[64:79], v[48:51], a[48:51], v[64:79]
    ds_read_b128 v[40:43], v18 offset:16384
    s_waitcnt lgkmcnt(5)
    v_mfma_f32_32x32x16_bf16 v[64:79], v[52:55], a[52:55], v[64:79]
    ds_read_b128 v[44:47], v19 offset:16384
    s_waitcnt lgkmcnt(5)
    v_mfma_f32_32x32x16_bf16 v[64:79], v[56:59], a[56:59], v[64:79]
    ds_read_b128 v[48:51], v20 offset:16384
    s_cmp_eq_u32 s25, 0
    s_cbranch_scc1 mega_kernel_q_v_sk14
    s_add_u32 m0, s21, 91136
    s_add_u32 s20, s23, 768
    buffer_load_dwordx4 v7, s[8:11], s20 offen lds
mega_kernel_q_v_sk14:
    s_waitcnt lgkmcnt(5)
    v_mfma_f32_32x32x16_bf16 v[64:79], v[60:63], a[60:63], v[64:79]
    ds_read_b128 v[52:55], v21 offset:16384
    s_waitcnt lgkmcnt(5)
    v_mfma_f32_32x32x16_bf16 v[64:79], v[32:35], a[64:67], v[64:79]
    ds_read_b128 v[56:59], v22 offset:16384
    s_cmp_eq_u32 s25, 0
    s_cbranch_scc1 mega_kernel_q_v_ne0
    v_cvt_pk_bf16_f32 v96, v80, v81
    v_cvt_pk_bf16_f32 v97, v82, v83
    v_cvt_pk_bf16_f32 v98, v88, v89
    v_cvt_pk_bf16_f32 v99, v90, v91
    buffer_store_dwordx4 v[96:99], v8, s[84:87], s24 offen offset:0 sc1
mega_kernel_q_v_ne0:
    s_waitcnt lgkmcnt(5)
    v_mfma_f32_32x32x16_bf16 v[64:79], v[36:39], a[68:71], v[64:79]
    ds_read_b128 v[60:63], v23 offset:16384
    s_waitcnt lgkmcnt(5)
    v_mfma_f32_32x32x16_bf16 v[64:79], v[40:43], a[72:75], v[64:79]
    ds_read_b128 v[32:35], v16 offset:24576
    s_cmp_eq_u32 s25, 0
    s_cbranch_scc1 mega_kernel_q_v_ne1
    v_cvt_pk_bf16_f32 v100, v84, v85
    v_cvt_pk_bf16_f32 v101, v86, v87
    v_cvt_pk_bf16_f32 v102, v92, v93
    v_cvt_pk_bf16_f32 v103, v94, v95
    buffer_store_dwordx4 v[100:103], v8, s[84:87], s24 offen offset:512 sc1
    s_add_u32 s24, s24, 524288
mega_kernel_q_v_ne1:
    s_waitcnt lgkmcnt(5)
    v_mfma_f32_32x32x16_bf16 v[64:79], v[44:47], a[76:79], v[64:79]
    ds_read_b128 v[36:39], v17 offset:24576
    s_waitcnt lgkmcnt(5)
    v_mfma_f32_32x32x16_bf16 v[64:79], v[48:51], a[80:83], v[64:79]
    ds_read_b128 v[40:43], v18 offset:24576
    s_waitcnt lgkmcnt(5)
    v_mfma_f32_32x32x16_bf16 v[64:79], v[52:55], a[84:87], v[64:79]
    ds_read_b128 v[44:47], v19 offset:24576
    s_waitcnt lgkmcnt(5)
    v_mfma_f32_32x32x16_bf16 v[64:79], v[56:59], a[88:91], v[64:79]
    ds_read_b128 v[48:51], v20 offset:24576
    s_waitcnt lgkmcnt(5)
    v_mfma_f32_32x32x16_bf16 v[64:79], v[60:63], a[92:95], v[64:79]
    ds_read_b128 v[52:55], v21 offset:24576
    s_waitcnt vmcnt(8)
    s_barrier
    s_waitcnt lgkmcnt(5)
    v_mfma_f32_32x32x16_bf16 v[64:79], v[32:35], a[96:99], v[64:79]
    ds_read_b128 v[56:59], v22 offset:24576
    s_waitcnt lgkmcnt(5)
    v_mfma_f32_32x32x16_bf16 v[64:79], v[36:39], a[100:103], v[64:79]
    ds_read_b128 v[60:63], v23 offset:24576
    s_add_u32 m0, s21, 98304
    s_add_u32 s20, s23, 1024
    buffer_load_dwordx4 v6, s[8:11], s20 offen lds
    s_waitcnt lgkmcnt(5)
    v_mfma_f32_32x32x16_bf16 v[64:79], v[40:43], a[104:107], v[64:79]
    ds_read_b128 v[32:35], v16 offset:32768
    s_waitcnt lgkmcnt(5)
    v_mfma_f32_32x32x16_bf16 v[64:79], v[44:47], a[108:111], v[64:79]
    ds_read_b128 v[36:39], v17 offset:32768
    s_waitcnt lgkmcnt(5)
    v_mfma_f32_32x32x16_bf16 v[64:79], v[48:51], a[112:115], v[64:79]
    ds_read_b128 v[40:43], v18 offset:32768
    s_add_u32 m0, s21, 99328
    s_add_u32 s20, s23, 1024
    buffer_load_dwordx4 v7, s[8:11], s20 offen lds
    s_waitcnt lgkmcnt(5)
    v_mfma_f32_32x32x16_bf16 v[64:79], v[52:55], a[116:119], v[64:79]
    ds_read_b128 v[44:47], v19 offset:32768
    s_waitcnt lgkmcnt(5)
    v_mfma_f32_32x32x16_bf16 v[64:79], v[56:59], a[120:123], v[64:79]
    ds_read_b128 v[48:51], v20 offset:32768
    s_waitcnt lgkmcnt(5)
    v_mfma_f32_32x32x16_bf16 v[64:79], v[60:63], a[124:127], v[64:79]
    ds_read_b128 v[52:55], v21 offset:32768
    s_add_u32 m0, s21, 106496
    s_add_u32 s20, s23, 1280
    buffer_load_dwordx4 v6, s[8:11], s20 offen lds
    s_waitcnt lgkmcnt(5)
    v_mfma_f32_32x32x16_bf16 v[64:79], v[32:35], a[128:131], v[64:79]
    ds_read_b128 v[56:59], v22 offset:32768
    s_waitcnt lgkmcnt(5)
    v_mfma_f32_32x32x16_bf16 v[64:79], v[36:39], a[132:135], v[64:79]
    ds_read_b128 v[60:63], v23 offset:32768
    s_waitcnt lgkmcnt(5)
    v_mfma_f32_32x32x16_bf16 v[64:79], v[40:43], a[136:139], v[64:79]
    ds_read_b128 v[32:35], v16 offset:40960
    s_add_u32 m0, s21, 107520
    s_add_u32 s20, s23, 1280
    buffer_load_dwordx4 v7, s[8:11], s20 offen lds
    s_waitcnt lgkmcnt(5)
    v_mfma_f32_32x32x16_bf16 v[64:79], v[44:47], a[140:143], v[64:79]
    ds_read_b128 v[36:39], v17 offset:40960
    s_waitcnt lgkmcnt(5)
    v_mfma_f32_32x32x16_bf16 v[64:79], v[48:51], a[144:147], v[64:79]
    ds_read_b128 v[40:43], v18 offset:40960
    s_waitcnt lgkmcnt(5)
    v_mfma_f32_32x32x16_bf16 v[64:79], v[52:55], a[148:151], v[64:79]
    ds_read_b128 v[44:47], v19 offset:40960
    s_add_u32 m0, s21, 114688
    s_add_u32 s20, s23, 1536
    buffer_load_dwordx4 v6, s[8:11], s20 offen lds
    s_waitcnt lgkmcnt(5)
    v_mfma_f32_32x32x16_bf16 v[64:79], v[56:59], a[152:155], v[64:79]
    ds_read_b128 v[48:51], v20 offset:40960
    s_waitcnt lgkmcnt(5)
    v_mfma_f32_32x32x16_bf16 v[64:79], v[60:63], a[156:159], v[64:79]
    ds_read_b128 v[52:55], v21 offset:40960
    s_waitcnt lgkmcnt(5)
    v_mfma_f32_32x32x16_bf16 v[64:79], v[32:35], a[160:163], v[64:79]
    ds_read_b128 v[56:59], v22 offset:40960
    s_add_u32 m0, s21, 115712
    s_add_u32 s20, s23, 1536
    buffer_load_dwordx4 v7, s[8:11], s20 offen lds
    s_waitcnt lgkmcnt(5)
    v_mfma_f32_32x32x16_bf16 v[64:79], v[36:39], a[164:167], v[64:79]
    ds_read_b128 v[60:63], v23 offset:40960
    s_waitcnt lgkmcnt(5)
    v_mfma_f32_32x32x16_bf16 v[64:79], v[40:43], a[168:171], v[64:79]
    ds_read_b128 v[32:35], v16 offset:49152
    s_waitcnt lgkmcnt(5)
    v_mfma_f32_32x32x16_bf16 v[64:79], v[44:47], a[172:175], v[64:79]
    ds_read_b128 v[36:39], v17 offset:49152
    s_add_u32 m0, s21, 122880
    s_add_u32 s20, s23, 1792
    buffer_load_dwordx4 v6, s[8:11], s20 offen lds
    s_waitcnt lgkmcnt(5)
    v_mfma_f32_32x32x16_bf16 v[64:79], v[48:51], a[176:179], v[64:79]
    ds_read_b128 v[40:43], v18 offset:49152
    s_waitcnt lgkmcnt(5)
    v_mfma_f32_32x32x16_bf16 v[64:79], v[52:55], a[180:183], v[64:79]
    ds_read_b128 v[44:47], v19 offset:49152
    s_waitcnt lgkmcnt(5)
    v_mfma_f32_32x32x16_bf16 v[64:79], v[56:59], a[184:187], v[64:79]
    ds_read_b128 v[48:51], v20 offset:49152
    s_add_u32 m0, s21, 123904
    s_add_u32 s20, s23, 1792
    buffer_load_dwordx4 v7, s[8:11], s20 offen lds
    s_waitcnt lgkmcnt(5)
    v_mfma_f32_32x32x16_bf16 v[64:79], v[60:63], a[188:191], v[64:79]
    ds_read_b128 v[52:55], v21 offset:49152
    s_waitcnt lgkmcnt(5)
    v_mfma_f32_32x32x16_bf16 v[64:79], v[32:35], a[192:195], v[64:79]
    ds_read_b128 v[56:59], v22 offset:49152
    s_waitcnt lgkmcnt(5)
    v_mfma_f32_32x32x16_bf16 v[64:79], v[36:39], a[196:199], v[64:79]
    ds_read_b128 v[60:63], v23 offset:49152
    s_waitcnt lgkmcnt(5)
    v_mfma_f32_32x32x16_bf16 v[64:79], v[40:43], a[200:203], v[64:79]
    ds_read_b128 v[32:35], v16 offset:57344
    s_waitcnt lgkmcnt(5)
    v_mfma_f32_32x32x16_bf16 v[64:79], v[44:47], a[204:207], v[64:79]
    ds_read_b128 v[36:39], v17 offset:57344
    s_waitcnt lgkmcnt(5)
    v_mfma_f32_32x32x16_bf16 v[64:79], v[48:51], a[208:211], v[64:79]
    ds_read_b128 v[40:43], v18 offset:57344
    s_waitcnt lgkmcnt(5)
    v_mfma_f32_32x32x16_bf16 v[64:79], v[52:55], a[212:215], v[64:79]
    ds_read_b128 v[44:47], v19 offset:57344
    s_waitcnt lgkmcnt(5)
    v_mfma_f32_32x32x16_bf16 v[64:79], v[56:59], a[216:219], v[64:79]
    ds_read_b128 v[48:51], v20 offset:57344
    s_waitcnt lgkmcnt(5)
    v_mfma_f32_32x32x16_bf16 v[64:79], v[60:63], a[220:223], v[64:79]
    ds_read_b128 v[52:55], v21 offset:57344
    s_waitcnt vmcnt(8)
    s_barrier
    s_waitcnt lgkmcnt(5)
    v_mfma_f32_32x32x16_bf16 v[64:79], v[32:35], a[224:227], v[64:79]
    ds_read_b128 v[56:59], v22 offset:57344
    s_waitcnt lgkmcnt(5)
    v_mfma_f32_32x32x16_bf16 v[64:79], v[36:39], a[228:231], v[64:79]
    ds_read_b128 v[60:63], v23 offset:57344
    s_add_u32 s23, s23, 131072
    s_add_u32 m0, s21, 0
    s_add_u32 s20, s23, 0
    buffer_load_dwordx4 v6, s[8:11], s20 offen lds
    s_waitcnt lgkmcnt(5)
    v_mfma_f32_32x32x16_bf16 v[64:79], v[40:43], a[232:235], v[64:79]
    ds_read_b128 v[32:35], v24 offset:0
    s_cmp_eq_u32 s25, 0
    s_cbranch_scc1 mega_kernel_q_v_nf
    v_add_u32 v10, 1, v10
    buffer_store_dword v10, v9, s[84:87], 0 offen sc1
mega_kernel_q_v_nf:
    s_waitcnt lgkmcnt(5)
    v_mfma_f32_32x32x16_bf16 v[64:79], v[44:47], a[236:239], v[64:79]
    ds_read_b128 v[36:39], v25 offset:0
    s_waitcnt lgkmcnt(5)
    v_mfma_f32_32x32x16_bf16 v[64:79], v[48:51], a[240:243], v[64:79]
    ds_read_b128 v[40:43], v26 offset:0
    s_add_u32 m0, s21, 1024
    s_add_u32 s20, s23, 0
    buffer_load_dwordx4 v7, s[8:11], s20 offen lds
    s_waitcnt lgkmcnt(5)
    v_mfma_f32_32x32x16_bf16 v[64:79], v[52:55], a[244:247], v[64:79]
    ds_read_b128 v[44:47], v27 offset:0
    s_waitcnt lgkmcnt(5)
    v_mfma_f32_32x32x16_bf16 v[64:79], v[56:59], a[248:251], v[64:79]
    ds_read_b128 v[48:51], v28 offset:0
    s_waitcnt lgkmcnt(5)
    v_mfma_f32_32x32x16_bf16 v[64:79], v[60:63], a[252:255], v[64:79]
    ds_read_b128 v[52:55], v29 offset:0
    s_add_u32 m0, s21, 8192
    s_add_u32 s20, s23, 256
    buffer_load_dwordx4 v6, s[8:11], s20 offen lds
    s_waitcnt lgkmcnt(5)
    v_mfma_f32_32x32x16_bf16 v[80:95], v[32:35], a[0:3], 0
    ds_read_b128 v[56:59], v30 offset:0
    s_waitcnt lgkmcnt(5)
    v_mfma_f32_32x32x16_bf16 v[80:95], v[36:39], a[4:7], v[80:95]
    ds_read_b128 v[60:63], v31 offset:0
    s_waitcnt lgkmcnt(5)
    v_mfma_f32_32x32x16_bf16 v[80:95], v[40:43], a[8:11], v[80:95]
    ds_read_b128 v[32:35], v24 offset:8192
    s_add_u32 m0, s21, 9216
    s_add_u32 s20, s23, 256
    buffer_load_dwordx4 v7, s[8:11], s20 offen lds
    s_waitcnt lgkmcnt(5)
    v_mfma_f32_32x32x16_bf16 v[80:95], v[44:47], a[12:15], v[80:95]
    ds_read_b128 v[36:39], v25 offset:8192
    s_waitcnt lgkmcnt(5)
    v_mfma_f32_32x32x16_bf16 v[80:95], v[48:51], a[16:19], v[80:95]
    ds_read_b128 v[40:43], v26 offset:8192
    s_waitcnt lgkmcnt(5)
    v_mfma_f32_32x32x16_bf16 v[80:95], v[52:55], a[20:23], v[80:95]
    ds_read_b128 v[44:47], v27 offset:8192
    s_add_u32 m0, s21, 16384
    s_add_u32 s20, s23, 512
    buffer_load_dwordx4 v6, s[8:11], s20 offen lds
    s_waitcnt lgkmcnt(5)
    v_mfma_f32_32x32x16_bf16 v[80:95], v[56:59], a[24:27], v[80:95]
    ds_read_b128 v[48:51], v28 offset:8192
    s_waitcnt lgkmcnt(5)
    v_mfma_f32_32x32x16_bf16 v[80:95], v[60:63], a[28:31], v[80:95]
    ds_read_b128 v[52:55], v29 offset:8192
    s_waitcnt lgkmcnt(5)
    v_mfma_f32_32x32x16_bf16 v[80:95], v[32:35], a[32:35], v[80:95]
    ds_read_b128 v[56:59], v30 offset:8192
    s_add_u32 m0, s21, 17408
    s_add_u32 s20, s23, 512
    buffer_load_dwordx4 v7, s[8:11], s20 offen lds
    s_waitcnt lgkmcnt(5)
    v_mfma_f32_32x32x16_bf16 v[80:95], v[36:39], a[36:39], v[80:95]
    ds_read_b128 v[60:63], v31 offset:8192
    s_waitcnt lgkmcnt(5)
    v_mfma_f32_32x32x16_bf16 v[80:95], v[40:43], a[40:43], v[80:95]
    ds_read_b128 v[32:35], v24 offset:16384
    s_waitcnt lgkmcnt(5)
    v_mfma_f32_32x32x16_bf16 v[80:95], v[44:47], a[44:47], v[80:95]
    ds_read_b128 v[36:39], v25 offset:16384
    s_add_u32 m0, s21, 24576
    s_add_u32 s20, s23, 768
    buffer_load_dwordx4 v6, s[8:11], s20 offen lds
    s_waitcnt lgkmcnt(5)
    v_mfma_f32_32x32x16_bf16 v[80:95], v[48:51], a[48:51], v[80:95]
    ds_read_b128 v[40:43], v26 offset:16384
    s_waitcnt lgkmcnt(5)
    v_mfma_f32_32x32x16_bf16 v[80:95], v[52:55], a[52:55], v[80:95]
    ds_read_b128 v[44:47], v27 offset:16384
    s_waitcnt lgkmcnt(5)
    v_mfma_f32_32x32x16_bf16 v[80:95], v[56:59], a[56:59], v[80:95]
    ds_read_b128 v[48:51], v28 offset:16384
    s_add_u32 m0, s21, 25600
    s_add_u32 s20, s23, 768
    buffer_load_dwordx4 v7, s[8:11], s20 offen lds
    s_waitcnt lgkmcnt(5)
    v_mfma_f32_32x32x16_bf16 v[80:95], v[60:63], a[60:63], v[80:95]
    ds_read_b128 v[52:55], v29 offset:16384
    s_waitcnt lgkmcnt(5)
    v_mfma_f32_32x32x16_bf16 v[80:95], v[32:35], a[64:67], v[80:95]
    ds_read_b128 v[56:59], v30 offset:16384
    v_cvt_pk_bf16_f32 v96, v64, v65
    v_cvt_pk_bf16_f32 v97, v66, v67
    v_cvt_pk_bf16_f32 v98, v72, v73
    v_cvt_pk_bf16_f32 v99, v74, v75
    buffer_store_dwordx4 v[96:99], v8, s[84:87], s24 offen offset:0 sc1
    s_waitcnt lgkmcnt(5)
    v_mfma_f32_32x32x16_bf16 v[80:95], v[36:39], a[68:71], v[80:95]
    ds_read_b128 v[60:63], v31 offset:16384
    s_waitcnt lgkmcnt(5)
    v_mfma_f32_32x32x16_bf16 v[80:95], v[40:43], a[72:75], v[80:95]
    ds_read_b128 v[32:35], v24 offset:24576
    v_cvt_pk_bf16_f32 v100, v68, v69
    v_cvt_pk_bf16_f32 v101, v70, v71
    v_cvt_pk_bf16_f32 v102, v76, v77
    v_cvt_pk_bf16_f32 v103, v78, v79
    buffer_store_dwordx4 v[100:103], v8, s[84:87], s24 offen offset:512 sc1
    s_add_u32 s24, s24, 524288
    s_waitcnt lgkmcnt(5)
    v_mfma_f32_32x32x16_bf16 v[80:95], v[44:47], a[76:79], v[80:95]
    ds_read_b128 v[36:39], v25 offset:24576
    s_waitcnt lgkmcnt(5)
    v_mfma_f32_32x32x16_bf16 v[80:95], v[48:51], a[80:83], v[80:95]
    ds_read_b128 v[40:43], v26 offset:24576
    s_waitcnt lgkmcnt(5)
    v_mfma_f32_32x32x16_bf16 v[80:95], v[52:55], a[84:87], v[80:95]
    ds_read_b128 v[44:47], v27 offset:24576
    s_waitcnt lgkmcnt(5)
    v_mfma_f32_32x32x16_bf16 v[80:95], v[56:59], a[88:91], v[80:95]
    ds_read_b128 v[48:51], v28 offset:24576
    s_waitcnt lgkmcnt(5)
    v_mfma_f32_32x32x16_bf16 v[80:95], v[60:63], a[92:95], v[80:95]
    ds_read_b128 v[52:55], v29 offset:24576
    s_waitcnt vmcnt(8)
    s_barrier
    s_waitcnt lgkmcnt(5)
    v_mfma_f32_32x32x16_bf16 v[80:95], v[32:35], a[96:99], v[80:95]
    ds_read_b128 v[56:59], v30 offset:24576
    s_waitcnt lgkmcnt(5)
    v_mfma_f32_32x32x16_bf16 v[80:95], v[36:39], a[100:103], v[80:95]
    ds_read_b128 v[60:63], v31 offset:24576
    s_add_u32 m0, s21, 32768
    s_add_u32 s20, s23, 1024
    buffer_load_dwordx4 v6, s[8:11], s20 offen lds
    s_waitcnt lgkmcnt(5)
    v_mfma_f32_32x32x16_bf16 v[80:95], v[40:43], a[104:107], v[80:95]
    ds_read_b128 v[32:35], v24 offset:32768
    s_waitcnt lgkmcnt(5)
    v_mfma_f32_32x32x16_bf16 v[80:95], v[44:47], a[108:111], v[80:95]
    ds_read_b128 v[36:39], v25 offset:32768
    s_waitcnt lgkmcnt(5)
    v_mfma_f32_32x32x16_bf16 v[80:95], v[48:51], a[112:115], v[80:95]
    ds_read_b128 v[40:43], v26 offset:32768
    s_add_u32 m0, s21, 33792
    s_add_u32 s20, s23, 1024
    buffer_load_dwordx4 v7, s[8:11], s20 offen lds
    s_waitcnt lgkmcnt(5)
    v_mfma_f32_32x32x16_bf16 v[80:95], v[52:55], a[116:119], v[80:95]
    ds_read_b128 v[44:47], v27 offset:32768
    s_waitcnt lgkmcnt(5)
    v_mfma_f32_32x32x16_bf16 v[80:95], v[56:59], a[120:123], v[80:95]
    ds_read_b128 v[48:51], v28 offset:32768
    s_waitcnt lgkmcnt(5)
    v_mfma_f32_32x32x16_bf16 v[80:95], v[60:63], a[124:127], v[80:95]
    ds_read_b128 v[52:55], v29 offset:32768
    s_add_u32 m0, s21, 40960
    s_add_u32 s20, s23, 1280
    buffer_load_dwordx4 v6, s[8:11], s20 offen lds
    s_waitcnt lgkmcnt(5)
    v_mfma_f32_32x32x16_bf16 v[80:95], v[32:35], a[128:131], v[80:95]
    ds_read_b128 v[56:59], v30 offset:32768
    s_waitcnt lgkmcnt(5)
    v_mfma_f32_32x32x16_bf16 v[80:95], v[36:39], a[132:135], v[80:95]
    ds_read_b128 v[60:63], v31 offset:32768
    s_waitcnt lgkmcnt(5)
    v_mfma_f32_32x32x16_bf16 v[80:95], v[40:43], a[136:139], v[80:95]
    ds_read_b128 v[32:35], v24 offset:40960
    s_add_u32 m0, s21, 41984
    s_add_u32 s20, s23, 1280
    buffer_load_dwordx4 v7, s[8:11], s20 offen lds
    s_waitcnt lgkmcnt(5)
    v_mfma_f32_32x32x16_bf16 v[80:95], v[44:47], a[140:143], v[80:95]
    ds_read_b128 v[36:39], v25 offset:40960
    s_waitcnt lgkmcnt(5)
    v_mfma_f32_32x32x16_bf16 v[80:95], v[48:51], a[144:147], v[80:95]
    ds_read_b128 v[40:43], v26 offset:40960
    s_waitcnt lgkmcnt(5)
    v_mfma_f32_32x32x16_bf16 v[80:95], v[52:55], a[148:151], v[80:95]
    ds_read_b128 v[44:47], v27 offset:40960
    s_add_u32 m0, s21, 49152
    s_add_u32 s20, s23, 1536
    buffer_load_dwordx4 v6, s[8:11], s20 offen lds
    s_waitcnt lgkmcnt(5)
    v_mfma_f32_32x32x16_bf16 v[80:95], v[56:59], a[152:155], v[80:95]
    ds_read_b128 v[48:51], v28 offset:40960
    s_waitcnt lgkmcnt(5)
    v_mfma_f32_32x32x16_bf16 v[80:95], v[60:63], a[156:159], v[80:95]
    ds_read_b128 v[52:55], v29 offset:40960
    s_waitcnt lgkmcnt(5)
    v_mfma_f32_32x32x16_bf16 v[80:95], v[32:35], a[160:163], v[80:95]
    ds_read_b128 v[56:59], v30 offset:40960
    s_add_u32 m0, s21, 50176
    s_add_u32 s20, s23, 1536
    buffer_load_dwordx4 v7, s[8:11], s20 offen lds
    s_waitcnt lgkmcnt(5)
    v_mfma_f32_32x32x16_bf16 v[80:95], v[36:39], a[164:167], v[80:95]
    ds_read_b128 v[60:63], v31 offset:40960
    s_waitcnt lgkmcnt(5)
    v_mfma_f32_32x32x16_bf16 v[80:95], v[40:43], a[168:171], v[80:95]
    ds_read_b128 v[32:35], v24 offset:49152
    s_waitcnt lgkmcnt(5)
    v_mfma_f32_32x32x16_bf16 v[80:95], v[44:47], a[172:175], v[80:95]
    ds_read_b128 v[36:39], v25 offset:49152
    s_add_u32 m0, s21, 57344
    s_add_u32 s20, s23, 1792
    buffer_load_dwordx4 v6, s[8:11], s20 offen lds
    s_waitcnt lgkmcnt(5)
    v_mfma_f32_32x32x16_bf16 v[80:95], v[48:51], a[176:179], v[80:95]
    ds_read_b128 v[40:43], v26 offset:49152
    s_waitcnt lgkmcnt(5)
    v_mfma_f32_32x32x16_bf16 v[80:95], v[52:55], a[180:183], v[80:95]
    ds_read_b128 v[44:47], v27 offset:49152
    s_waitcnt lgkmcnt(5)
    v_mfma_f32_32x32x16_bf16 v[80:95], v[56:59], a[184:187], v[80:95]
    ds_read_b128 v[48:51], v28 offset:49152
    s_add_u32 m0, s21, 58368
    s_add_u32 s20, s23, 1792
    buffer_load_dwordx4 v7, s[8:11], s20 offen lds
    s_waitcnt lgkmcnt(5)
    v_mfma_f32_32x32x16_bf16 v[80:95], v[60:63], a[188:191], v[80:95]
    ds_read_b128 v[52:55], v29 offset:49152
    s_waitcnt lgkmcnt(5)
    v_mfma_f32_32x32x16_bf16 v[80:95], v[32:35], a[192:195], v[80:95]
    ds_read_b128 v[56:59], v30 offset:49152
    s_waitcnt lgkmcnt(5)
    v_mfma_f32_32x32x16_bf16 v[80:95], v[36:39], a[196:199], v[80:95]
    ds_read_b128 v[60:63], v31 offset:49152
    s_waitcnt lgkmcnt(5)
    v_mfma_f32_32x32x16_bf16 v[80:95], v[40:43], a[200:203], v[80:95]
    ds_read_b128 v[32:35], v24 offset:57344
    s_waitcnt lgkmcnt(5)
    v_mfma_f32_32x32x16_bf16 v[80:95], v[44:47], a[204:207], v[80:95]
    ds_read_b128 v[36:39], v25 offset:57344
    s_waitcnt lgkmcnt(5)
    v_mfma_f32_32x32x16_bf16 v[80:95], v[48:51], a[208:211], v[80:95]
    ds_read_b128 v[40:43], v26 offset:57344
    s_waitcnt lgkmcnt(5)
    v_mfma_f32_32x32x16_bf16 v[80:95], v[52:55], a[212:215], v[80:95]
    ds_read_b128 v[44:47], v27 offset:57344
    s_waitcnt lgkmcnt(5)
    v_mfma_f32_32x32x16_bf16 v[80:95], v[56:59], a[216:219], v[80:95]
    ds_read_b128 v[48:51], v28 offset:57344
    s_waitcnt lgkmcnt(5)
    v_mfma_f32_32x32x16_bf16 v[80:95], v[60:63], a[220:223], v[80:95]
    ds_read_b128 v[52:55], v29 offset:57344
    s_waitcnt vmcnt(8)
    s_barrier
    s_waitcnt lgkmcnt(5)
    v_mfma_f32_32x32x16_bf16 v[80:95], v[32:35], a[224:227], v[80:95]
    ds_read_b128 v[56:59], v30 offset:57344
    s_waitcnt lgkmcnt(5)
    v_mfma_f32_32x32x16_bf16 v[80:95], v[36:39], a[228:231], v[80:95]
    ds_read_b128 v[60:63], v31 offset:57344
    s_add_u32 s23, s23, 131072
    s_add_u32 m0, s21, 65536
    s_add_u32 s20, s23, 0
    buffer_load_dwordx4 v6, s[8:11], s20 offen lds
    s_waitcnt lgkmcnt(5)
    v_mfma_f32_32x32x16_bf16 v[80:95], v[40:43], a[232:235], v[80:95]
    ds_read_b128 v[32:35], v16 offset:0
    v_add_u32 v10, 1, v10
    buffer_store_dword v10, v9, s[84:87], 0 offen sc1
    s_waitcnt lgkmcnt(5)
    v_mfma_f32_32x32x16_bf16 v[80:95], v[44:47], a[236:239], v[80:95]
    ds_read_b128 v[36:39], v17 offset:0
    s_waitcnt lgkmcnt(5)
    v_mfma_f32_32x32x16_bf16 v[80:95], v[48:51], a[240:243], v[80:95]
    ds_read_b128 v[40:43], v18 offset:0
    s_add_u32 m0, s21, 66560
    s_add_u32 s20, s23, 0
    buffer_load_dwordx4 v7, s[8:11], s20 offen lds
    s_waitcnt lgkmcnt(5)
    v_mfma_f32_32x32x16_bf16 v[80:95], v[52:55], a[244:247], v[80:95]
    ds_read_b128 v[44:47], v19 offset:0
    s_waitcnt lgkmcnt(5)
    v_mfma_f32_32x32x16_bf16 v[80:95], v[56:59], a[248:251], v[80:95]
    ds_read_b128 v[48:51], v20 offset:0
    s_waitcnt lgkmcnt(5)
    v_mfma_f32_32x32x16_bf16 v[80:95], v[60:63], a[252:255], v[80:95]
    ds_read_b128 v[52:55], v21 offset:0
    s_add_u32 m0, s21, 73728
    s_add_u32 s20, s23, 256
    buffer_load_dwordx4 v6, s[8:11], s20 offen lds
    s_add_u32 s25, s25, 1
    s_cmp_lt_u32 s25, 16
    s_cbranch_scc1 mega_kernel_q_v_loop
    s_nop 11
    v_cvt_pk_bf16_f32 v96, v80, v81
    v_cvt_pk_bf16_f32 v97, v82, v83
    v_cvt_pk_bf16_f32 v98, v88, v89
    v_cvt_pk_bf16_f32 v99, v90, v91
    buffer_store_dwordx4 v[96:99], v8, s[84:87], s24 offen offset:0 sc1
    v_cvt_pk_bf16_f32 v100, v84, v85
    v_cvt_pk_bf16_f32 v101, v86, v87
    v_cvt_pk_bf16_f32 v102, v92, v93
    v_cvt_pk_bf16_f32 v103, v94, v95
    buffer_store_dwordx4 v[100:103], v8, s[84:87], s24 offen offset:512 sc1
    s_add_u32 s24, s24, 524288
    s_waitcnt vmcnt(0) lgkmcnt(0)
    s_barrier
    v_add_u32 v10, 1, v10
    buffer_store_dword v10, v9, s[84:87], 0 offen sc1
mega_kernel_q_done:
    s_cmp_lt_u32 s92, 128
    s_cbranch_scc1 mega_kernel_fft
    s_sub_u32 s99, s92, 128
mega_kernel_f0l:
    s_barrier
    s_load_dwordx2 s[4:5], s[0:1], 64
    s_load_dwordx2 s[8:9], s[0:1], 72
    s_load_dwordx2 s[12:13], s[0:1], 96
    s_and_b32 s16, s99, 31
    s_lshr_b32 s17, s99, 5
    v_and_b32 v1, 63, v0
    v_lshrrev_b32 v2, 6, v0
    s_waitcnt lgkmcnt(0)
    s_mov_b32 s6, 2101248
    s_mov_b32 s7, 0x00020000
    s_mov_b32 s10, 2101248
    s_mov_b32 s11, 0x00020000
    s_add_u32 s12, s12, 121634816
    s_addc_u32 s13, s13, 0
    s_mov_b32 s14, 4202496
    s_mov_b32 s15, 0x00020000
    s_lshl_b32 s18, s16, 6
    v_add_u32 v3, s18, v2
    s_movk_i32 s19, 1026
    v_mul_lo_u32 v3, v3, s19
    s_lshl_b32 s18, s17, 7
    v_add_u32 v3, s18, v3
    v_lshl_add_u32 v3, v1, 1, v3
    s_mov_b32 s18, 0
    buffer_load_ushort v16, v3, s[4:7], s18 offen
    buffer_load_ushort v32, v3, s[8:11], s18 offen
    s_mov_b32 s18, 4104
    buffer_load_ushort v17, v3, s[4:7], s18 offen
    buffer_load_ushort v33, v3, s[8:11], s18 offen
    s_mov_b32 s18, 8208
    buffer_load_ushort v18, v3, s[4:7], s18 offen
    buffer_load_ushort v34, v3, s[8:11], s18 offen
    s_mov_b32 s18, 12312
    buffer_load_ushort v19, v3, s[4:7], s18 offen
    buffer_load_ushort v35, v3, s[8:11], s18 offen
    s_mov_b32 s18, 16416
    buffer_load_ushort v20, v3, s[4:7], s18 offen
    buffer_load_ushort v36, v3, s[8:11], s18 offen
    s_mov_b32 s18, 20520
    buffer_load_ushort v21, v3, s[4:7], s18 offen
    buffer_load_ushort v37, v3, s[8:11], s18 offen
    s_mov_b32 s18, 24624
    buffer_load_ushort v22, v3, s[4:7], s18 offen
    buffer_load_ushort v38, v3, s[8:11], s18 offen
    s_mov_b32 s18, 28728
    buffer_load_ushort v23, v3, s[4:7], s18 offen
    buffer_load_ushort v39, v3, s[8:11], s18 offen
    s_mov_b32 s18, 32832
    buffer_load_ushort v24, v3, s[4:7], s18 offen
    buffer_load_ushort v40, v3, s[8:11], s18 offen
    s_mov_b32 s18, 36936
    buffer_load_ushort v25, v3, s[4:7], s18 offen
    buffer_load_ushort v41, v3, s[8:11], s18 offen
    s_mov_b32 s18, 41040
    buffer_load_ushort v26, v3, s[4:7], s18 offen
    buffer_load_ushort v42, v3, s[8:11], s18 offen
    s_mov_b32 s18, 45144
    buffer_load_ushort v27, v3, s[4:7], s18 offen
    buffer_load_ushort v43, v3, s[8:11], s18 offen
    s_mov_b32 s18, 49248
    buffer_load_ushort v28, v3, s[4:7], s18 offen
    buffer_load_ushort v44, v3, s[8:11], s18 offen
    s_mov_b32 s18, 53352
    buffer_load_ushort v29, v3, s[4:7], s18 offen
    buffer_load_ushort v45, v3, s[8:11], s18 offen
    s_mov_b32 s18, 57456
    buffer_load_ushort v30, v3, s[4:7], s18 offen
    buffer_load_ushort v46, v3, s[8:11], s18 offen
    s_mov_b32 s18, 61560
    buffer_load_ushort v31, v3, s[4:7], s18 offen
    buffer_load_ushort v47, v3, s[8:11], s18 offen
    v_mul_u32_u24 v4, 65, v1
    v_add_u32 v4, v4, v2
    v_lshlrev_b32 v4, 2, v4
    s_waitcnt vmcnt(0)
    v_lshl_or_b32 v16, v32, 16, v16
    ds_write_b32 v4, v16 offset:0
    v_lshl_or_b32 v17, v33, 16, v17
    ds_write_b32 v4, v17 offset:16
    v_lshl_or_b32 v18, v34, 16, v18
    ds_write_b32 v4, v18 offset:32
    v_lshl_or_b32 v19, v35, 16, v19
    ds_write_b32 v4, v19 offset:48
    v_lshl_or_b32 v20, v36, 16, v20
    ds_write_b32 v4, v20 offset:64
    v_lshl_or_b32 v21, v37, 16, v21
    ds_write_b32 v4, v21 offset:80
    v_lshl_or_b32 v22, v38, 16, v22
    ds_write_b32 v4, v22 offset:96
    v_lshl_or_b32 v23, v39, 16, v23
    ds_write_b32 v4, v23 offset:112
    v_lshl_or_b32 v24, v40, 16, v24
    ds_write_b32 v4, v24 offset:128
    v_lshl_or_b32 v25, v41, 16, v25
    ds_write_b32 v4, v25 offset:144
    v_lshl_or_b32 v26, v42, 16, v26
    ds_write_b32 v4, v26 offset:160
    v_lshl_or_b32 v27, v43, 16, v27
    ds_write_b32 v4, v27 offset:176
    v_lshl_or_b32 v28, v44, 16, v28
    ds_write_b32 v4, v28 offset:192
    v_lshl_or_b32 v29, v45, 16, v29
    ds_write_b32 v4, v29 offset:208
    v_lshl_or_b32 v30, v46, 16, v30
    ds_write_b32 v4, v30 offset:224
    v_lshl_or_b32 v31, v47, 16, v31
    ds_write_b32 v4, v31 offset:240
    v_lshrrev_b32 v7, 4, v0
    v_and_b32 v8, 15, v0
    v_mul_u32_u24 v5, 65, v7
    v_lshl_add_u32 v5, v8, 2, v5
    v_lshlrev_b32 v5, 2, v5
    s_waitcnt lgkmcnt(0)
    s_barrier
    ds_read_b32 v16, v5 offset:0
    ds_read_b32 v17, v5 offset:4
    ds_read_b32 v18, v5 offset:8
    ds_read_b32 v19, v5 offset:12
    ds_read_b32 v20, v5 offset:4160
    ds_read_b32 v21, v5 offset:4164
    ds_read_b32 v22, v5 offset:4168
    ds_read_b32 v23, v5 offset:4172
    ds_read_b32 v24, v5 offset:8320
    ds_read_b32 v25, v5 offset:8324
    ds_read_b32 v26, v5 offset:8328
    ds_read_b32 v27, v5 offset:8332
    ds_read_b32 v28, v5 offset:12480
    ds_read_b32 v29, v5 offset:12484
    ds_read_b32 v30, v5 offset:12488
    ds_read_b32 v31, v5 offset:12492
    s_lshl_b32 s18, s17, 6
    v_add_u32 v6, s18, v7
    v_lshlrev_b32 v6, 13, v6
    s_lshl_b32 s18, s16, 8
    v_add_u32 v6, s18, v6
    v_lshl_add_u32 v6, v8, 4, v6
    s_waitcnt lgkmcnt(0)
    s_mov_b32 s18, 0
    buffer_store_dwordx4 v[16:19], v6, s[12:15], s18 offen sc1
    s_mov_b32 s18, 131072
    buffer_store_dwordx4 v[20:23], v6, s[12:15], s18 offen sc1
    s_mov_b32 s18, 262144
    buffer_store_dwordx4 v[24:27], v6, s[12:15], s18 offen sc1
    s_mov_b32 s18, 393216
    buffer_store_dwordx4 v[28:31], v6, s[12:15], s18 offen sc1
    s_add_u32 s99, s99, 64
    s_cmp_lt_u32 s99, 288
    s_cbranch_scc1 mega_kernel_f0l
    s_waitcnt vmcnt(0)
    s_barrier
    v_mov_b32 v2, 1
    v_cmp_eq_u32 vcc, 0, v0
    s_and_saveexec_b64 s[80:81], vcc
    s_cbranch_execz mega_kernel_sg64_0
    buffer_atomic_add v2, off, s[88:91], 0 offset:64 sc1
mega_kernel_sg64_0:
    s_mov_b64 exec, s[80:81]
    s_branch mega_kernel_xo
mega_kernel_fft:
    s_barrier
    s_load_dwordx2 s[4:5], s[0:1], 56
    s_load_dwordx2 s[8:9], s[0:1], 96
    v_and_b32 v1, 31, v0
    v_lshrrev_b32 v2, 5, v0
    v_cvt_f32_u32 v3, v1
    s_waitcnt lgkmcnt(0)
    s_mov_b32 s6, 4194304
    s_mov_b32 s7, 0x00020000
    s_mov_b32 s10, 268435456
    s_mov_b32 s11, 0x00020000
    s_lshl_b32 s12, s92, 15
    v_lshlrev_b32 v6, 12, v2
    v_lshl_add_u32 v6, v1, 1, v6
    buffer_load_ushort v16, v6, s[4:7], s12 offen offset:0
    buffer_load_ushort v48, v6, s[4:7], s12 offen offset:2048
    buffer_load_ushort v17, v6, s[4:7], s12 offen offset:64
    buffer_load_ushort v49, v6, s[4:7], s12 offen offset:2112
    buffer_load_ushort v18, v6, s[4:7], s12 offen offset:128
    buffer_load_ushort v50, v6, s[4:7], s12 offen offset:2176
    buffer_load_ushort v19, v6, s[4:7], s12 offen offset:192
    buffer_load_ushort v51, v6, s[4:7], s12 offen offset:2240
    buffer_load_ushort v20, v6, s[4:7], s12 offen offset:256
    buffer_load_ushort v52, v6, s[4:7], s12 offen offset:2304
    buffer_load_ushort v21, v6, s[4:7], s12 offen offset:320
    buffer_load_ushort v53, v6, s[4:7], s12 offen offset:2368
    buffer_load_ushort v22, v6, s[4:7], s12 offen offset:384
    buffer_load_ushort v54, v6, s[4:7], s12 offen offset:2432
    buffer_load_ushort v23, v6, s[4:7], s12 offen offset:448
    buffer_load_ushort v55, v6, s[4:7], s12 offen offset:2496
    buffer_load_ushort v24, v6, s[4:7], s12 offen offset:512
    buffer_load_ushort v56, v6, s[4:7], s12 offen offset:2560
    buffer_load_ushort v25, v6, s[4:7], s12 offen offset:576
    buffer_load_ushort v57, v6, s[4:7], s12 offen offset:2624
    buffer_load_ushort v26, v6, s[4:7], s12 offen offset:640
    buffer_load_ushort v58, v6, s[4:7], s12 offen offset:2688
    buffer_load_ushort v27, v6, s[4:7], s12 offen offset:704
    buffer_load_ushort v59, v6, s[4:7], s12 offen offset:2752
    buffer_load_ushort v28, v6, s[4:7], s12 offen offset:768
    buffer_load_ushort v60, v6, s[4:7], s12 offen offset:2816
    buffer_load_ushort v29, v6, s[4:7], s12 offen offset:832
    buffer_load_ushort v61, v6, s[4:7], s12 offen offset:2880
    buffer_load_ushort v30, v6, s[4:7], s12 offen offset:896
    buffer_load_ushort v62, v6, s[4:7], s12 offen offset:2944
    buffer_load_ushort v31, v6, s[4:7], s12 offen offset:960
    buffer_load_ushort v63, v6, s[4:7], s12 offen offset:3008
    buffer_load_ushort v32, v6, s[4:7], s12 offen offset:1024
    buffer_load_ushort v64, v6, s[4:7], s12 offen offset:3072
    buffer_load_ushort v33, v6, s[4:7], s12 offen offset:1088
    buffer_load_ushort v65, v6, s[4:7], s12 offen offset:3136
    buffer_load_ushort v34, v6, s[4:7], s12 offen offset:1152
    buffer_load_ushort v66, v6, s[4:7], s12 offen offset:3200
    buffer_load_ushort v35, v6, s[4:7], s12 offen offset:1216
    buffer_load_ushort v67, v6, s[4:7], s12 offen offset:3264
    buffer_load_ushort v36, v6, s[4:7], s12 offen offset:1280
    buffer_load_ushort v68, v6, s[4:7], s12 offen offset:3328
    buffer_load_ushort v37, v6, s[4:7], s12 offen offset:1344
    buffer_load_ushort v69, v6, s[4:7], s12 offen offset:3392
    buffer_load_ushort v38, v6, s[4:7], s12 offen offset:1408
    buffer_load_ushort v70, v6, s[4:7], s12 offen offset:3456
    buffer_load_ushort v39, v6, s[4:7], s12 offen offset:1472
    buffer_load_ushort v71, v6, s[4:7], s12 offen offset:3520
    buffer_load_ushort v40, v6, s[4:7], s12 offen offset:1536
    buffer_load_ushort v72, v6, s[4:7], s12 offen offset:3584
    buffer_load_ushort v41, v6, s[4:7], s12 offen offset:1600
    buffer_load_ushort v73, v6, s[4:7], s12 offen offset:3648
    buffer_load_ushort v42, v6, s[4:7], s12 offen offset:1664
    buffer_load_ushort v74, v6, s[4:7], s12 offen offset:3712
    buffer_load_ushort v43, v6, s[4:7], s12 offen offset:1728
    buffer_load_ushort v75, v6, s[4:7], s12 offen offset:3776
    buffer_load_ushort v44, v6, s[4:7], s12 offen offset:1792
    buffer_load_ushort v76, v6, s[4:7], s12 offen offset:3840
    buffer_load_ushort v45, v6, s[4:7], s12 offen offset:1856
    buffer_load_ushort v77, v6, s[4:7], s12 offen offset:3904
    buffer_load_ushort v46, v6, s[4:7], s12 offen offset:1920
    buffer_load_ushort v78, v6, s[4:7], s12 offen offset:3968
    buffer_load_ushort v47, v6, s[4:7], s12 offen offset:1984
    buffer_load_ushort v79, v6, s[4:7], s12 offen offset:4032
    s_movk_i32 s13, 8448
    v_mul_lo_u32 v7, v2, s13
    v_lshl_add_u32 v4, v1, 3, v7
    s_movk_i32 s13, 264
    v_mul_lo_u32 v5, v1, s13
    v_add_u32 v5, v5, v7
    s_waitcnt vmcnt(0)
    v_lshlrev_b32 v16, 16, v16
    v_lshlrev_b32 v48, 16, v48
    v_lshlrev_b32 v17, 16, v17
    v_lshlrev_b32 v49, 16, v49
    v_lshlrev_b32 v18, 16, v18
    v_lshlrev_b32 v50, 16, v50
    v_lshlrev_b32 v19, 16, v19
    v_lshlrev_b32 v51, 16, v51
    v_lshlrev_b32 v20, 16, v20
    v_lshlrev_b32 v52, 16, v52
    v_lshlrev_b32 v21, 16, v21
    v_lshlrev_b32 v53, 16, v53
    v_lshlrev_b32 v22, 16, v22
    v_lshlrev_b32 v54, 16, v54
    v_lshlrev_b32 v23, 16, v23
    v_lshlrev_b32 v55, 16, v55
    v_lshlrev_b32 v24, 16, v24
    v_lshlrev_b32 v56, 16, v56
    v_lshlrev_b32 v25, 16, v25
    v_lshlrev_b32 v57, 16, v57
    v_lshlrev_b32 v26, 16, v26
    v_lshlrev_b32 v58, 16, v58
    v_lshlrev_b32 v27, 16, v27
    v_lshlrev_b32 v59, 16, v59
    v_lshlrev_b32 v28, 16, v28
    v_lshlrev_b32 v60, 16, v60
    v_lshlrev_b32 v29, 16, v29
    v_lshlrev_b32 v61, 16, v61
    v_lshlrev_b32 v30, 16, v30
    v_lshlrev_b32 v62, 16, v62
    v_lshlrev_b32 v31, 16, v31
    v_lshlrev_b32 v63, 16, v63
    v_lshlrev_b32 v32, 16, v32
    v_lshlrev_b32 v64, 16, v64
    v_lshlrev_b32 v33, 16, v33
    v_lshlrev_b32 v65, 16, v65
    v_lshlrev_b32 v34, 16, v34
    v_lshlrev_b32 v66, 16, v66
    v_lshlrev_b32 v35, 16, v35
    v_lshlrev_b32 v67, 16, v67
    v_lshlrev_b32 v36, 16, v36
    v_lshlrev_b32 v68, 16, v68
    v_lshlrev_b32 v37, 16, v37
    v_lshlrev_b32 v69, 16, v69
    v_lshlrev_b32 v38, 16, v38
    v_lshlrev_b32 v70, 16, v70
    v_lshlrev_b32 v39, 16, v39
    v_lshlrev_b32 v71, 16, v71
    v_lshlrev_b32 v40, 16, v40
    v_lshlrev_b32 v72, 16, v72
    v_lshlrev_b32 v41, 16, v41
    v_lshlrev_b32 v73, 16, v73
    v_lshlrev_b32 v42, 16, v42
    v_lshlrev_b32 v74, 16, v74
    v_lshlrev_b32 v43, 16, v43
    v_lshlrev_b32 v75, 16, v75
    v_lshlrev_b32 v44, 16, v44
    v_lshlrev_b32 v76, 16, v76
    v_lshlrev_b32 v45, 16, v45
    v_lshlrev_b32 v77, 16, v77
    v_lshlrev_b32 v46, 16, v46
    v_lshlrev_b32 v78, 16, v78
    v_lshlrev_b32 v47, 16, v47
    v_lshlrev_b32 v79, 16, v79
    v_sub_f32 v80, v16, v32
    v_sub_f32 v81, v48, v64
    v_add_f32 v16, v16, v32
    v_add_f32 v48, v48, v64
    v_sub_f32 v32, v17, v33
    v_sub_f32 v64, v49, v65
    v_add_f32 v17, v17, v33
    v_add_f32 v49, v49, v65
    v_mul_f32 v33, 0x3f7b14be, v32
    v_mul_f32 v65, 0xbe47c5c2, v32
    v_fmac_f32 v33, 0x3e47c5c2, v64
    v_fmac_f32 v65, 0x3f7b14be, v64
    v_sub_f32 v32, v18, v34
    v_sub_f32 v64, v50, v66
    v_add_f32 v18, v18, v34
    v_add_f32 v50, v50, v66
    v_mul_f32 v34, 0x3f6c835e, v32
    v_mul_f32 v66, 0xbec3ef15, v32
    v_fmac_f32 v34, 0x3ec3ef15, v64
    v_fmac_f32 v66, 0x3f6c835e, v64
    v_sub_f32 v32, v19, v35
    v_sub_f32 v64, v51, v67
    v_add_f32 v19, v19, v35
    v_add_f32 v51, v51, v67
    v_mul_f32 v35, 0x3f54db31, v32
    v_mul_f32 v67, 0xbf0e39da, v32
    v_fmac_f32 v35, 0x3f0e39da, v64
    v_fmac_f32 v67, 0x3f54db31, v64
    v_sub_f32 v32, v20, v36
    v_sub_f32 v64, v52, v68
    v_add_f32 v20, v20, v36
    v_add_f32 v52, v52, v68
    v_mul_f32 v36, 0x3f3504f3, v32
    v_mul_f32 v68, 0xbf3504f3, v32
    v_fmac_f32 v36, 0x3f3504f3, v64
    v_fmac_f32 v68, 0x3f3504f3, v64
    v_sub_f32 v32, v21, v37
    v_sub_f32 v64, v53, v69
    v_add_f32 v21, v21, v37
    v_add_f32 v53, v53, v69
    v_mul_f32 v37, 0x3f0e39da, v32
    v_mul_f32 v69, 0xbf54db31, v32
    v_fmac_f32 v37, 0x3f54db31, v64
    v_fmac_f32 v69, 0x3f0e39da, v64
    v_sub_f32 v32, v22, v38
    v_sub_f32 v64, v54, v70
    v_add_f32 v22, v22, v38
    v_add_f32 v54, v54, v70
    v_mul_f32 v38, 0x3ec3ef15, v32
    v_mul_f32 v70, 0xbf6c835e, v32
    v_fmac_f32 v38, 0x3f6c835e, v64
    v_fmac_f32 v70, 0x3ec3ef15, v64
    v_sub_f32 v32, v23, v39
    v_sub_f32 v64, v55, v71
    v_add_f32 v23, v23, v39
    v_add_f32 v55, v55, v71
    v_mul_f32 v39, 0x3e47c5c2, v32
    v_mul_f32 v71, 0xbf7b14be, v32
    v_fmac_f32 v39, 0x3f7b14be, v64
    v_fmac_f32 v71, 0x3e47c5c2, v64
    v_sub_f32 v32, v56, v72
    v_sub_f32 v64, v40, v24
    v_add_f32 v24, v24, v40
    v_add_f32 v56, v56, v72
    v_sub_f32 v40, v25, v41
    v_sub_f32 v72, v57, v73
    v_add_f32 v25, v25, v41
    v_add_f32 v57, v57, v73
    v_mul_f32 v41, 0xbe47c5c2, v40
    v_mul_f32 v73, 0xbf7b14be, v40
    v_fmac_f32 v41, 0x3f7b14be, v72
    v_fmac_f32 v73, 0xbe47c5c2, v72
    v_sub_f32 v40, v26, v42
    v_sub_f32 v72, v58, v74
    v_add_f32 v26, v26, v42
    v_add_f32 v58, v58, v74
    v_mul_f32 v42, 0xbec3ef15, v40
    v_mul_f32 v74, 0xbf6c835e, v40
    v_fmac_f32 v42, 0x3f6c835e, v72
    v_fmac_f32 v74, 0xbec3ef15, v72
    v_sub_f32 v40, v27, v43
    v_sub_f32 v72, v59, v75
    v_add_f32 v27, v27, v43
    v_add_f32 v59, v59, v75
    v_mul_f32 v43, 0xbf0e39da, v40
    v_mul_f32 v75, 0xbf54db31, v40
    v_fmac_f32 v43, 0x3f54db31, v72
    v_fmac_f32 v75, 0xbf0e39da, v72
    v_sub_f32 v40, v28, v44
    v_sub_f32 v72, v60, v76
    v_add_f32 v28, v28, v44
    v_add_f32 v60, v60, v76
    v_mul_f32 v44, 0xbf3504f3, v40
    v_mul_f32 v76, 0xbf3504f3, v40
    v_fmac_f32 v44, 0x3f3504f3, v72
    v_fmac_f32 v76, 0xbf3504f3, v72
    v_sub_f32 v40, v29, v45
    v_sub_f32 v72, v61, v77
    v_add_f32 v29, v29, v45
    v_add_f32 v61, v61, v77
    v_mul_f32 v45, 0xbf54db31, v40
    v_mul_f32 v77, 0xbf0e39da, v40
    v_fmac_f32 v45, 0x3f0e39da, v72
    v_fmac_f32 v77, 0xbf54db31, v72
    v_sub_f32 v40, v30, v46
    v_sub_f32 v72, v62, v78
    v_add_f32 v30, v30, v46
    v_add_f32 v62, v62, v78
    v_mul_f32 v46, 0xbf6c835e, v40
    v_mul_f32 v78, 0xbec3ef15, v40
    v_fmac_f32 v46, 0x3ec3ef15, v72
    v_fmac_f32 v78, 0xbf6c835e, v72
    v_sub_f32 v40, v31, v47
    v_sub_f32 v72, v63, v79
    v_add_f32 v31, v31, v47
    v_add_f32 v63, v63, v79
    v_mul_f32 v47, 0xbf7b14be, v40
    v_mul_f32 v79, 0xbe47c5c2, v40
    v_fmac_f32 v47, 0x3e47c5c2, v72
    v_fmac_f32 v79, 0xbf7b14be, v72
    v_sub_f32 v40, v16, v24
    v_sub_f32 v72, v48, v56
    v_add_f32 v16, v16, v24
    v_add_f32 v48, v48, v56
    v_sub_f32 v24, v17, v25
    v_sub_f32 v56, v49, v57
    v_add_f32 v17, v17, v25
    v_add_f32 v49, v49, v57
    v_mul_f32 v25, 0x3f6c835e, v24
    v_mul_f32 v57, 0xbec3ef15, v24
    v_fmac_f32 v25, 0x3ec3ef15, v56
    v_fmac_f32 v57, 0x3f6c835e, v56
    v_sub_f32 v24, v18, v26
    v_sub_f32 v56, v50, v58
    v_add_f32 v18, v18, v26
    v_add_f32 v50, v50, v58
    v_mul_f32 v26, 0x3f3504f3, v24
    v_mul_f32 v58, 0xbf3504f3, v24
    v_fmac_f32 v26, 0x3f3504f3, v56
    v_fmac_f32 v58, 0x3f3504f3, v56
    v_sub_f32 v24, v19, v27
    v_sub_f32 v56, v51, v59
    v_add_f32 v19, v19, v27
    v_add_f32 v51, v51, v59
    v_mul_f32 v27, 0x3ec3ef15, v24
    v_mul_f32 v59, 0xbf6c835e, v24
    v_fmac_f32 v27, 0x3f6c835e, v56
    v_fmac_f32 v59, 0x3ec3ef15, v56
    v_sub_f32 v24, v52, v60
    v_sub_f32 v56, v28, v20
    v_add_f32 v20, v20, v28
    v_add_f32 v52, v52, v60
    v_sub_f32 v28, v21, v29
    v_sub_f32 v60, v53, v61
    v_add_f32 v21, v21, v29
    v_add_f32 v53, v53, v61
    v_mul_f32 v29, 0xbec3ef15, v28
    v_mul_f32 v61, 0xbf6c835e, v28
    v_fmac_f32 v29, 0x3f6c835e, v60
    v_fmac_f32 v61, 0xbec3ef15, v60
    v_sub_f32 v28, v22, v30
    v_sub_f32 v60, v54, v62
    v_add_f32 v22, v22, v30
    v_add_f32 v54, v54, v62
    v_mul_f32 v30, 0xbf3504f3, v28
    v_mul_f32 v62, 0xbf3504f3, v28
    v_fmac_f32 v30, 0x3f3504f3, v60
    v_fmac_f32 v62, 0xbf3504f3, v60
    v_sub_f32 v28, v23, v31
    v_sub_f32 v60, v55, v63
    v_add_f32 v23, v23, v31
    v_add_f32 v55, v55, v63
    v_mul_f32 v31, 0xbf6c835e, v28
    v_mul_f32 v63, 0xbec3ef15, v28
    v_fmac_f32 v31, 0x3ec3ef15, v60
    v_fmac_f32 v63, 0xbf6c835e, v60
    v_sub_f32 v28, v80, v32
    v_sub_f32 v60, v81, v64
    v_add_f32 v80, v80, v32
    v_add_f32 v81, v81, v64
    v_sub_f32 v32, v33, v41
    v_sub_f32 v64, v65, v73
    v_add_f32 v33, v33, v41
    v_add_f32 v65, v65, v73
    v_mul_f32 v41, 0x3f6c835e, v32
    v_mul_f32 v73, 0xbec3ef15, v32
    v_fmac_f32 v41, 0x3ec3ef15, v64
    v_fmac_f32 v73, 0x3f6c835e, v64
    v_sub_f32 v32, v34, v42
    v_sub_f32 v64, v66, v74
    v_add_f32 v34, v34, v42
    v_add_f32 v66, v66, v74
    v_mul_f32 v42, 0x3f3504f3, v32
    v_mul_f32 v74, 0xbf3504f3, v32
    v_fmac_f32 v42, 0x3f3504f3, v64
    v_fmac_f32 v74, 0x3f3504f3, v64
    v_sub_f32 v32, v35, v43
    v_sub_f32 v64, v67, v75
    v_add_f32 v35, v35, v43
    v_add_f32 v67, v67, v75
    v_mul_f32 v43, 0x3ec3ef15, v32
    v_mul_f32 v75, 0xbf6c835e, v32
    v_fmac_f32 v43, 0x3f6c835e, v64
    v_fmac_f32 v75, 0x3ec3ef15, v64
    v_sub_f32 v32, v68, v76
    v_sub_f32 v64, v44, v36
    v_add_f32 v36, v36, v44
    v_add_f32 v68, v68, v76
    v_sub_f32 v44, v37, v45
    v_sub_f32 v76, v69, v77
    v_add_f32 v37, v37, v45
    v_add_f32 v69, v69, v77
    v_mul_f32 v45, 0xbec3ef15, v44
    v_mul_f32 v77, 0xbf6c835e, v44
    v_fmac_f32 v45, 0x3f6c835e, v76
    v_fmac_f32 v77, 0xbec3ef15, v76
    v_sub_f32 v44, v38, v46
    v_sub_f32 v76, v70, v78
    v_add_f32 v38, v38, v46
    v_add_f32 v70, v70, v78
    v_mul_f32 v46, 0xbf3504f3, v44
    v_mul_f32 v78, 0xbf3504f3, v44
    v_fmac_f32 v46, 0x3f3504f3, v76
    v_fmac_f32 v78, 0xbf3504f3, v76
    v_sub_f32 v44, v39, v47
    v_sub_f32 v76, v71, v79
    v_add_f32 v39, v39, v47
    v_add_f32 v71, v71, v79
    v_mul_f32 v47, 0xbf6c835e, v44
    v_mul_f32 v79, 0xbec3ef15, v44
    v_fmac_f32 v47, 0x3ec3ef15, v76
    v_fmac_f32 v79, 0xbf6c835e, v76
    v_sub_f32 v44, v16, v20
    v_sub_f32 v76, v48, v52
    v_add_f32 v16, v16, v20
    v_add_f32 v48, v48, v52
    v_sub_f32 v20, v17, v21
    v_sub_f32 v52, v49, v53
    v_add_f32 v17, v17, v21
    v_add_f32 v49, v49, v53
    v_mul_f32 v21, 0x3f3504f3, v20
    v_mul_f32 v53, 0xbf3504f3, v20
    v_fmac_f32 v21, 0x3f3504f3, v52
    v_fmac_f32 v53, 0x3f3504f3, v52
    v_sub_f32 v20, v50, v54
    v_sub_f32 v52, v22, v18
    v_add_f32 v18, v18, v22
    v_add_f32 v50, v50, v54
    v_sub_f32 v22, v19, v23
    v_sub_f32 v54, v51, v55
    v_add_f32 v19, v19, v23
    v_add_f32 v51, v51, v55
    v_mul_f32 v23, 0xbf3504f3, v22
    v_mul_f32 v55, 0xbf3504f3, v22
    v_fmac_f32 v23, 0x3f3504f3, v54
    v_fmac_f32 v55, 0xbf3504f3, v54
    v_sub_f32 v22, v40, v24
    v_sub_f32 v54, v72, v56
    v_add_f32 v40, v40, v24
    v_add_f32 v72, v72, v56
    v_sub_f32 v24, v25, v29
    v_sub_f32 v56, v57, v61
    v_add_f32 v25, v25, v29
    v_add_f32 v57, v57, v61
    v_mul_f32 v29, 0x3f3504f3, v24
    v_mul_f32 v61, 0xbf3504f3, v24
    v_fmac_f32 v29, 0x3f3504f3, v56
    v_fmac_f32 v61, 0x3f3504f3, v56
    v_sub_f32 v24, v58, v62
    v_sub_f32 v56, v30, v26
    v_add_f32 v26, v26, v30
    v_add_f32 v58, v58, v62
    v_sub_f32 v30, v27, v31
    v_sub_f32 v62, v59, v63
    v_add_f32 v27, v27, v31
    v_add_f32 v59, v59, v63
    v_mul_f32 v31, 0xbf3504f3, v30
    v_mul_f32 v63, 0xbf3504f3, v30
    v_fmac_f32 v31, 0x3f3504f3, v62
    v_fmac_f32 v63, 0xbf3504f3, v62
    v_sub_f32 v30, v80, v36
    v_sub_f32 v62, v81, v68
    v_add_f32 v80, v80, v36
    v_add_f32 v81, v81, v68
    v_sub_f32 v36, v33, v37
    v_sub_f32 v68, v65, v69
    v_add_f32 v33, v33, v37
    v_add_f32 v65, v65, v69
    v_mul_f32 v37, 0x3f3504f3, v36
    v_mul_f32 v69, 0xbf3504f3, v36
    v_fmac_f32 v37, 0x3f3504f3, v68
    v_fmac_f32 v69, 0x3f3504f3, v68
    v_sub_f32 v36, v66, v70
    v_sub_f32 v68, v38, v34
    v_add_f32 v34, v34, v38
    v_add_f32 v66, v66, v70
    v_sub_f32 v38, v35, v39
    v_sub_f32 v70, v67, v71
    v_add_f32 v35, v35, v39
    v_add_f32 v67, v67, v71
    v_mul_f32 v39, 0xbf3504f3, v38
    v_mul_f32 v71, 0xbf3504f3, v38
    v_fmac_f32 v39, 0x3f3504f3, v70
    v_fmac_f32 v71, 0xbf3504f3, v70
    v_sub_f32 v38, v28, v32
    v_sub_f32 v70, v60, v64
    v_add_f32 v28, v28, v32
    v_add_f32 v60, v60, v64
    v_sub_f32 v32, v41, v45
    v_sub_f32 v64, v73, v77
    v_add_f32 v41, v41, v45
    v_add_f32 v73, v73, v77
    v_mul_f32 v45, 0x3f3504f3, v32
    v_mul_f32 v77, 0xbf3504f3, v32
    v_fmac_f32 v45, 0x3f3504f3, v64
    v_fmac_f32 v77, 0x3f3504f3, v64
    v_sub_f32 v32, v74, v78
    v_sub_f32 v64, v46, v42
    v_add_f32 v42, v42, v46
    v_add_f32 v74, v74, v78
    v_sub_f32 v46, v43, v47
    v_sub_f32 v78, v75, v79
    v_add_f32 v43, v43, v47
    v_add_f32 v75, v75, v79
    v_mul_f32 v47, 0xbf3504f3, v46
    v_mul_f32 v79, 0xbf3504f3, v46
    v_fmac_f32 v47, 0x3f3504f3, v78
    v_fmac_f32 v79, 0xbf3504f3, v78
    v_sub_f32 v46, v16, v18
    v_sub_f32 v78, v48, v50
    v_add_f32 v16, v16, v18
    v_add_f32 v48, v48, v50
    v_sub_f32 v18, v49, v51
    v_sub_f32 v50, v19, v17
    v_add_f32 v17, v17, v19
    v_add_f32 v49, v49, v51
    v_sub_f32 v19, v44, v20
    v_sub_f32 v51, v76, v52
    v_add_f32 v44, v44, v20
    v_add_f32 v76, v76, v52
    v_sub_f32 v20, v53, v55
    v_sub_f32 v52, v23, v21
    v_add_f32 v21, v21, v23
    v_add_f32 v53, v53, v55
    v_sub_f32 v23, v40, v26
    v_sub_f32 v55, v72, v58
    v_add_f32 v40, v40, v26
    v_add_f32 v72, v72, v58
    v_sub_f32 v26, v57, v59
    v_sub_f32 v58, v27, v25
    v_add_f32 v25, v25, v27
    v_add_f32 v57, v57, v59
    v_sub_f32 v27, v22, v24
    v_sub_f32 v59, v54, v56
    v_add_f32 v22, v22, v24
    v_add_f32 v54, v54, v56
    v_sub_f32 v24, v61, v63
    v_sub_f32 v56, v31, v29
    v_add_f32 v29, v29, v31
    v_add_f32 v61, v61, v63
    v_sub_f32 v31, v80, v34
    v_sub_f32 v63, v81, v66
    v_add_f32 v80, v80, v34
    v_add_f32 v81, v81, v66
    v_sub_f32 v34, v65, v67
    v_sub_f32 v66, v35, v33
    v_add_f32 v33, v33, v35
    v_add_f32 v65, v65, v67
    v_sub_f32 v35, v30, v36
    v_sub_f32 v67, v62, v68
    v_add_f32 v30, v30, v36
    v_add_f32 v62, v62, v68
    v_sub_f32 v36, v69, v71
    v_sub_f32 v68, v39, v37
    v_add_f32 v37, v37, v39
    v_add_f32 v69, v69, v71
    v_sub_f32 v39, v28, v42
    v_sub_f32 v71, v60, v74
    v_add_f32 v28, v28, v42
    v_add_f32 v60, v60, v74
    v_sub_f32 v42, v73, v75
    v_sub_f32 v74, v43, v41
    v_add_f32 v41, v41, v43
    v_add_f32 v73, v73, v75
    v_sub_f32 v43, v38, v32
    v_sub_f32 v75, v70, v64
    v_add_f32 v38, v38, v32
    v_add_f32 v70, v70, v64
    v_sub_f32 v32, v77, v79
    v_sub_f32 v64, v47, v45
    v_add_f32 v45, v45, v47
    v_add_f32 v77, v77, v79
    v_sub_f32 v47, v16, v17
    v_sub_f32 v79, v48, v49
    v_add_f32 v16, v16, v17
    v_add_f32 v48, v48, v49
    v_sub_f32 v17, v46, v18
    v_sub_f32 v49, v78, v50
    v_add_f32 v46, v46, v18
    v_add_f32 v78, v78, v50
    v_sub_f32 v18, v44, v21
    v_sub_f32 v50, v76, v53
    v_add_f32 v44, v44, v21
    v_add_f32 v76, v76, v53
    v_sub_f32 v21, v19, v20
    v_sub_f32 v53, v51, v52
    v_add_f32 v19, v19, v20
    v_add_f32 v51, v51, v52
    v_sub_f32 v20, v40, v25
    v_sub_f32 v52, v72, v57
    v_add_f32 v40, v40, v25
    v_add_f32 v72, v72, v57
    v_sub_f32 v25, v23, v26
    v_sub_f32 v57, v55, v58
    v_add_f32 v23, v23, v26
    v_add_f32 v55, v55, v58
    v_sub_f32 v26, v22, v29
    v_sub_f32 v58, v54, v61
    v_add_f32 v22, v22, v29
    v_add_f32 v54, v54, v61
    v_sub_f32 v29, v27, v24
    v_sub_f32 v61, v59, v56
    v_add_f32 v27, v27, v24
    v_add_f32 v59, v59, v56
    v_sub_f32 v24, v80, v33
    v_sub_f32 v56, v81, v65
    v_add_f32 v80, v80, v33
    v_add_f32 v81, v81, v65
    v_sub_f32 v33, v31, v34
    v_sub_f32 v65, v63, v66
    v_add_f32 v31, v31, v34
    v_add_f32 v63, v63, v66
    v_sub_f32 v34, v30, v37
    v_sub_f32 v66, v62, v69
    v_add_f32 v30, v30, v37
    v_add_f32 v62, v62, v69
    v_sub_f32 v37, v35, v36
    v_sub_f32 v69, v67, v68
    v_add_f32 v35, v35, v36
    v_add_f32 v67, v67, v68
    v_sub_f32 v36, v28, v41
    v_sub_f32 v68, v60, v73
    v_add_f32 v28, v28, v41
    v_add_f32 v60, v60, v73
    v_sub_f32 v41, v39, v42
    v_sub_f32 v73, v71, v74
    v_add_f32 v39, v39, v42
    v_add_f32 v71, v71, v74
    v_sub_f32 v42, v38, v45
    v_sub_f32 v74, v70, v77
    v_add_f32 v38, v38, v45
    v_add_f32 v70, v70, v77
    v_sub_f32 v45, v43, v32
    v_sub_f32 v77, v75, v64
    v_add_f32 v43, v43, v32
    v_add_f32 v75, v75, v64
    v_mul_f32 v32, 0xba800000, v3
    v_cos_f32 v64, v32
    v_sin_f32 v82, v32
    s_nop 0
    v_mul_f32 v83, v80, v64
    v_fma_f32 v83, -v81, v82, v83
    v_mul_f32 v81, v81, v64
    v_fmac_f32 v81, v80, v82
    v_mul_f32 v32, 0xbb000000, v3
    v_cos_f32 v64, v32
    v_sin_f32 v82, v32
    s_nop 0
    v_mul_f32 v80, v40, v64
    v_fma_f32 v80, -v72, v82, v80
    v_mul_f32 v72, v72, v64
    v_fmac_f32 v72, v40, v82
    v_mul_f32 v32, 0xbb400000, v3
    v_cos_f32 v64, v32
    v_sin_f32 v82, v32
    s_nop 0
    v_mul_f32 v40, v28, v64
    v_fma_f32 v40, -v60, v82, v40
    v_mul_f32 v60, v60, v64
    v_fmac_f32 v60, v28, v82
    v_mul_f32 v32, 0xbb800000, v3
    v_cos_f32 v64, v32
    v_sin_f32 v82, v32
    s_nop 0
    v_mul_f32 v28, v44, v64
    v_fma_f32 v28, -v76, v82, v28
    v_mul_f32 v76, v76, v64
    v_fmac_f32 v76, v44, v82
    v_mul_f32 v32, 0xbba00000, v3
    v_cos_f32 v64, v32
    v_sin_f32 v82, v32
    s_nop 0
    v_mul_f32 v44, v30, v64
    v_fma_f32 v44, -v62, v82, v44
    v_mul_f32 v62, v62, v64
    v_fmac_f32 v62, v30, v82
    v_mul_f32 v32, 0xbbc00000, v3
    v_cos_f32 v64, v32
    v_sin_f32 v82, v32
    s_nop 0
    v_mul_f32 v30, v22, v64
    v_fma_f32 v30, -v54, v82, v30
    v_mul_f32 v54, v54, v64
    v_fmac_f32 v54, v22, v82
    v_mul_f32 v32, 0xbbe00000, v3
    v_cos_f32 v64, v32
    v_sin_f32 v82, v32
    s_nop 0
    v_mul_f32 v22, v38, v64
    v_fma_f32 v22, -v70, v82, v22
    v_mul_f32 v70, v70, v64
    v_fmac_f32 v70, v38, v82
    v_mul_f32 v32, 0xbc000000, v3
    v_cos_f32 v64, v32
    v_sin_f32 v82, v32
    s_nop 0
    v_mul_f32 v38, v46, v64
    v_fma_f32 v38, -v78, v82, v38
    v_mul_f32 v78, v78, v64
    v_fmac_f32 v78, v46, v82
    v_mul_f32 v32, 0xbc100000, v3
    v_cos_f32 v64, v32
    v_sin_f32 v82, v32
    s_nop 0
    v_mul_f32 v46, v31, v64
    v_fma_f32 v46, -v63, v82, v46
    v_mul_f32 v63, v63, v64
    v_fmac_f32 v63, v31, v82
    v_mul_f32 v32, 0xbc200000, v3
    v_cos_f32 v64, v32
    v_sin_f32 v82, v32
    s_nop 0
    v_mul_f32 v31, v23, v64
    v_fma_f32 v31, -v55, v82, v31
    v_mul_f32 v55, v55, v64
    v_fmac_f32 v55, v23, v82
    v_mul_f32 v32, 0xbc300000, v3
    v_cos_f32 v64, v32
    v_sin_f32 v82, v32
    s_nop 0
    v_mul_f32 v23, v39, v64
    v_fma_f32 v23, -v71, v82, v23
    v_mul_f32 v71, v71, v64
    v_fmac_f32 v71, v39, v82
    v_mul_f32 v32, 0xbc400000, v3
    v_cos_f32 v64, v32
    v_sin_f32 v82, v32
    s_nop 0
    v_mul_f32 v39, v19, v64
    v_fma_f32 v39, -v51, v82, v39
    v_mul_f32 v51, v51, v64
    v_fmac_f32 v51, v19, v82
    v_mul_f32 v32, 0xbc500000, v3
    v_cos_f32 v64, v32
    v_sin_f32 v82, v32
    s_nop 0
    v_mul_f32 v19, v35, v64
    v_fma_f32 v19, -v67, v82, v19
    v_mul_f32 v67, v67, v64
    v_fmac_f32 v67, v35, v82
    v_mul_f32 v32, 0xbc600000, v3
    v_cos_f32 v64, v32
    v_sin_f32 v82, v32
    s_nop 0
    v_mul_f32 v35, v27, v64
    v_fma_f32 v35, -v59, v82, v35
    v_mul_f32 v59, v59, v64
    v_fmac_f32 v59, v27, v82
    v_mul_f32 v32, 0xbc700000, v3
    v_cos_f32 v64, v32
    v_sin_f32 v82, v32
    s_nop 0
    v_mul_f32 v27, v43, v64
    v_fma_f32 v27, -v75, v82, v27
    v_mul_f32 v75, v75, v64
    v_fmac_f32 v75, v43, v82
    v_mul_f32 v32, 0xbc800000, v3
    v_cos_f32 v64, v32
    v_sin_f32 v82, v32
    s_nop 0
    v_mul_f32 v43, v47, v64
    v_fma_f32 v43, -v79, v82, v43
    v_mul_f32 v79, v79, v64
    v_fmac_f32 v79, v47, v82
    v_mul_f32 v32, 0xbc880000, v3
    v_cos_f32 v64, v32
    v_sin_f32 v82, v32
    s_nop 0
    v_mul_f32 v47, v24, v64
    v_fma_f32 v47, -v56, v82, v47
    v_mul_f32 v56, v56, v64
    v_fmac_f32 v56, v24, v82
    v_mul_f32 v32, 0xbc900000, v3
    v_cos_f32 v64, v32
    v_sin_f32 v82, v32
    s_nop 0
    v_mul_f32 v24, v20, v64
    v_fma_f32 v24, -v52, v82, v24
    v_mul_f32 v52, v52, v64
    v_fmac_f32 v52, v20, v82
    v_mul_f32 v32, 0xbc980000, v3
    v_cos_f32 v64, v32
    v_sin_f32 v82, v32
    s_nop 0
    v_mul_f32 v20, v36, v64
    v_fma_f32 v20, -v68, v82, v20
    v_mul_f32 v68, v68, v64
    v_fmac_f32 v68, v36, v82
    v_mul_f32 v32, 0xbca00000, v3
    v_cos_f32 v64, v32
    v_sin_f32 v82, v32
    s_nop 0
    v_mul_f32 v36, v18, v64
    v_fma_f32 v36, -v50, v82, v36
    v_mul_f32 v50, v50, v64
    v_fmac_f32 v50, v18, v82
    v_mul_f32 v32, 0xbca80000, v3
    v_cos_f32 v64, v32
    v_sin_f32 v82, v32
    s_nop 0
    v_mul_f32 v18, v34, v64
    v_fma_f32 v18, -v66, v82, v18
    v_mul_f32 v66, v66, v64
    v_fmac_f32 v66, v34, v82
    v_mul_f32 v32, 0xbcb00000, v3
    v_cos_f32 v64, v32
    v_sin_f32 v82, v32
    s_nop 0
    v_mul_f32 v34, v26, v64
    v_fma_f32 v34, -v58, v82, v34
    v_mul_f32 v58, v58, v64
    v_fmac_f32 v58, v26, v82
    v_mul_f32 v32, 0xbcb80000, v3
    v_cos_f32 v64, v32
    v_sin_f32 v82, v32
    s_nop 0
    v_mul_f32 v26, v42, v64
    v_fma_f32 v26, -v74, v82, v26
    v_mul_f32 v74, v74, v64
    v_fmac_f32 v74, v42, v82
    v_mul_f32 v32, 0xbcc00000, v3
    v_cos_f32 v64, v32
    v_sin_f32 v82, v32
    s_nop 0
    v_mul_f32 v42, v17, v64
    v_fma_f32 v42, -v49, v82, v42
    v_mul_f32 v49, v49, v64
    v_fmac_f32 v49, v17, v82
    v_mul_f32 v32, 0xbcc80000, v3
    v_cos_f32 v64, v32
    v_sin_f32 v82, v32
    s_nop 0
    v_mul_f32 v17, v33, v64
    v_fma_f32 v17, -v65, v82, v17
    v_mul_f32 v65, v65, v64
    v_fmac_f32 v65, v33, v82
    v_mul_f32 v32, 0xbcd00000, v3
    v_cos_f32 v64, v32
    v_sin_f32 v82, v32
    s_nop 0
    v_mul_f32 v33, v25, v64
    v_fma_f32 v33, -v57, v82, v33
    v_mul_f32 v57, v57, v64
    v_fmac_f32 v57, v25, v82
    v_mul_f32 v32, 0xbcd80000, v3
    v_cos_f32 v64, v32
    v_sin_f32 v82, v32
    s_nop 0
    v_mul_f32 v25, v41, v64
    v_fma_f32 v25, -v73, v82, v25
    v_mul_f32 v73, v73, v64
    v_fmac_f32 v73, v41, v82
    v_mul_f32 v32, 0xbce00000, v3
    v_cos_f32 v64, v32
    v_sin_f32 v82, v32
    s_nop 0
    v_mul_f32 v41, v21, v64
    v_fma_f32 v41, -v53, v82, v41
    v_mul_f32 v53, v53, v64
    v_fmac_f32 v53, v21, v82
    v_mul_f32 v32, 0xbce80000, v3
    v_cos_f32 v64, v32
    v_sin_f32 v82, v32
    s_nop 0
    v_mul_f32 v21, v37, v64
    v_fma_f32 v21, -v69, v82, v21
    v_mul_f32 v69, v69, v64
    v_fmac_f32 v69, v37, v82
    v_mul_f32 v32, 0xbcf00000, v3
    v_cos_f32 v64, v32
    v_sin_f32 v82, v32
    s_nop 0
    v_mul_f32 v37, v29, v64
    v_fma_f32 v37, -v61, v82, v37
    v_mul_f32 v61, v61, v64
    v_fmac_f32 v61, v29, v82
    v_mul_f32 v32, 0xbcf80000, v3
    v_cos_f32 v64, v32
    v_sin_f32 v82, v32
    s_nop 0
    v_mul_f32 v29, v45, v64
    v_fma_f32 v29, -v77, v82, v29
    v_mul_f32 v77, v77, v64
    v_fmac_f32 v77, v45, v82
    ds_write_b32 v4, v16 offset:0
    ds_write_b32 v4, v48 offset:4
    ds_write_b32 v4, v83 offset:264
    ds_write_b32 v4, v81 offset:268
    ds_write_b32 v4, v80 offset:528
    ds_write_b32 v4, v72 offset:532
    ds_write_b32 v4, v40 offset:792
    ds_write_b32 v4, v60 offset:796
    ds_write_b32 v4, v28 offset:1056
    ds_write_b32 v4, v76 offset:1060
    ds_write_b32 v4, v44 offset:1320
    ds_write_b32 v4, v62 offset:1324
    ds_write_b32 v4, v30 offset:1584
    ds_write_b32 v4, v54 offset:1588
    ds_write_b32 v4, v22 offset:1848
    ds_write_b32 v4, v70 offset:1852
    ds_write_b32 v4, v38 offset:2112
    ds_write_b32 v4, v78 offset:2116
    ds_write_b32 v4, v46 offset:2376
    ds_write_b32 v4, v63 offset:2380
    ds_write_b32 v4, v31 offset:2640
    ds_write_b32 v4, v55 offset:2644
    ds_write_b32 v4, v23 offset:2904
    ds_write_b32 v4, v71 offset:2908
    ds_write_b32 v4, v39 offset:3168
    ds_write_b32 v4, v51 offset:3172
    ds_write_b32 v4, v19 offset:3432
    ds_write_b32 v4, v67 offset:3436
    ds_write_b32 v4, v35 offset:3696
    ds_write_b32 v4, v59 offset:3700
    ds_write_b32 v4, v27 offset:3960
    ds_write_b32 v4, v75 offset:3964
    ds_write_b32 v4, v43 offset:4224
    ds_write_b32 v4, v79 offset:4228
    ds_write_b32 v4, v47 offset:4488
    ds_write_b32 v4, v56 offset:4492
    ds_write_b32 v4, v24 offset:4752
    ds_write_b32 v4, v52 offset:4756
    ds_write_b32 v4, v20 offset:5016
    ds_write_b32 v4, v68 offset:5020
    ds_write_b32 v4, v36 offset:5280
    ds_write_b32 v4, v50 offset:5284
    ds_write_b32 v4, v18 offset:5544
    ds_write_b32 v4, v66 offset:5548
    ds_write_b32 v4, v34 offset:5808
    ds_write_b32 v4, v58 offset:5812
    ds_write_b32 v4, v26 offset:6072
    ds_write_b32 v4, v74 offset:6076
    ds_write_b32 v4, v42 offset:6336
    ds_write_b32 v4, v49 offset:6340
    ds_write_b32 v4, v17 offset:6600
    ds_write_b32 v4, v65 offset:6604
    ds_write_b32 v4, v33 offset:6864
    ds_write_b32 v4, v57 offset:6868
    ds_write_b32 v4, v25 offset:7128
    ds_write_b32 v4, v73 offset:7132
    ds_write_b32 v4, v41 offset:7392
    ds_write_b32 v4, v53 offset:7396
    ds_write_b32 v4, v21 offset:7656
    ds_write_b32 v4, v69 offset:7660
    ds_write_b32 v4, v37 offset:7920
    ds_write_b32 v4, v61 offset:7924
    ds_write_b32 v4, v29 offset:8184
    ds_write_b32 v4, v77 offset:8188
    s_waitcnt lgkmcnt(0)
    ds_read_b32 v16, v5 offset:0
    ds_read_b32 v48, v5 offset:4
    ds_read_b32 v83, v5 offset:8
    ds_read_b32 v81, v5 offset:12
    ds_read_b32 v80, v5 offset:16
    ds_read_b32 v72, v5 offset:20
    ds_read_b32 v40, v5 offset:24
    ds_read_b32 v60, v5 offset:28
    ds_read_b32 v28, v5 offset:32
    ds_read_b32 v76, v5 offset:36
    ds_read_b32 v44, v5 offset:40
    ds_read_b32 v62, v5 offset:44
    ds_read_b32 v30, v5 offset:48
    ds_read_b32 v54, v5 offset:52
    s_waitcnt lgkmcnt(0)
    ds_read_b32 v22, v5 offset:56
    ds_read_b32 v70, v5 offset:60
    ds_read_b32 v38, v5 offset:64
    ds_read_b32 v78, v5 offset:68
    ds_read_b32 v46, v5 offset:72
    ds_read_b32 v63, v5 offset:76
    ds_read_b32 v31, v5 offset:80
    ds_read_b32 v55, v5 offset:84
    ds_read_b32 v23, v5 offset:88
    ds_read_b32 v71, v5 offset:92
    ds_read_b32 v39, v5 offset:96
    ds_read_b32 v51, v5 offset:100
    ds_read_b32 v19, v5 offset:104
    ds_read_b32 v67, v5 offset:108
    s_waitcnt lgkmcnt(0)
    ds_read_b32 v35, v5 offset:112
    ds_read_b32 v59, v5 offset:116
    ds_read_b32 v27, v5 offset:120
    ds_read_b32 v75, v5 offset:124
    ds_read_b32 v43, v5 offset:128
    ds_read_b32 v79, v5 offset:132
    ds_read_b32 v47, v5 offset:136
    ds_read_b32 v56, v5 offset:140
    ds_read_b32 v24, v5 offset:144
    ds_read_b32 v52, v5 offset:148
    ds_read_b32 v20, v5 offset:152
    ds_read_b32 v68, v5 offset:156
    ds_read_b32 v36, v5 offset:160
    ds_read_b32 v50, v5 offset:164
    s_waitcnt lgkmcnt(0)
    ds_read_b32 v18, v5 offset:168
    ds_read_b32 v66, v5 offset:172
    ds_read_b32 v34, v5 offset:176
    ds_read_b32 v58, v5 offset:180
    ds_read_b32 v26, v5 offset:184
    ds_read_b32 v74, v5 offset:188
    ds_read_b32 v42, v5 offset:192
    ds_read_b32 v49, v5 offset:196
    ds_read_b32 v17, v5 offset:200
    ds_read_b32 v65, v5 offset:204
    ds_read_b32 v33, v5 offset:208
    ds_read_b32 v57, v5 offset:212
    ds_read_b32 v25, v5 offset:216
    ds_read_b32 v73, v5 offset:220
    s_waitcnt lgkmcnt(0)
    ds_read_b32 v41, v5 offset:224
    ds_read_b32 v53, v5 offset:228
    ds_read_b32 v21, v5 offset:232
    ds_read_b32 v69, v5 offset:236
    ds_read_b32 v37, v5 offset:240
    ds_read_b32 v61, v5 offset:244
    ds_read_b32 v29, v5 offset:248
    ds_read_b32 v77, v5 offset:252
    s_waitcnt lgkmcnt(0)
    v_sub_f32 v32, v16, v43
    v_sub_f32 v64, v48, v79
    v_add_f32 v16, v16, v43
    v_add_f32 v48, v48, v79
    v_sub_f32 v43, v83, v47
    v_sub_f32 v79, v81, v56
    v_add_f32 v83, v83, v47
    v_add_f32 v81, v81, v56
    v_mul_f32 v47, 0x3f7b14be, v43
    v_mul_f32 v56, 0xbe47c5c2, v43
    v_fmac_f32 v47, 0x3e47c5c2, v79
    v_fmac_f32 v56, 0x3f7b14be, v79
    v_sub_f32 v43, v80, v24
    v_sub_f32 v79, v72, v52
    v_add_f32 v80, v80, v24
    v_add_f32 v72, v72, v52
    v_mul_f32 v24, 0x3f6c835e, v43
    v_mul_f32 v52, 0xbec3ef15, v43
    v_fmac_f32 v24, 0x3ec3ef15, v79
    v_fmac_f32 v52, 0x3f6c835e, v79
    v_sub_f32 v43, v40, v20
    v_sub_f32 v79, v60, v68
    v_add_f32 v40, v40, v20
    v_add_f32 v60, v60, v68
    v_mul_f32 v20, 0x3f54db31, v43
    v_mul_f32 v68, 0xbf0e39da, v43
    v_fmac_f32 v20, 0x3f0e39da, v79
    v_fmac_f32 v68, 0x3f54db31, v79
    v_sub_f32 v43, v28, v36
    v_sub_f32 v79, v76, v50
    v_add_f32 v28, v28, v36
    v_add_f32 v76, v76, v50
    v_mul_f32 v36, 0x3f3504f3, v43
    v_mul_f32 v50, 0xbf3504f3, v43
    v_fmac_f32 v36, 0x3f3504f3, v79
    v_fmac_f32 v50, 0x3f3504f3, v79
    v_sub_f32 v43, v44, v18
    v_sub_f32 v79, v62, v66
    v_add_f32 v44, v44, v18
    v_add_f32 v62, v62, v66
    v_mul_f32 v18, 0x3f0e39da, v43
    v_mul_f32 v66, 0xbf54db31, v43
    v_fmac_f32 v18, 0x3f54db31, v79
    v_fmac_f32 v66, 0x3f0e39da, v79
    v_sub_f32 v43, v30, v34
    v_sub_f32 v79, v54, v58
    v_add_f32 v30, v30, v34
    v_add_f32 v54, v54, v58
    v_mul_f32 v34, 0x3ec3ef15, v43
    v_mul_f32 v58, 0xbf6c835e, v43
    v_fmac_f32 v34, 0x3f6c835e, v79
    v_fmac_f32 v58, 0x3ec3ef15, v79
    v_sub_f32 v43, v22, v26
    v_sub_f32 v79, v70, v74
    v_add_f32 v22, v22, v26
    v_add_f32 v70, v70, v74
    v_mul_f32 v26, 0x3e47c5c2, v43
    v_mul_f32 v74, 0xbf7b14be, v43
    v_fmac_f32 v26, 0x3f7b14be, v79
    v_fmac_f32 v74, 0x3e47c5c2, v79
    v_sub_f32 v43, v78, v49
    v_sub_f32 v79, v42, v38
    v_add_f32 v38, v38, v42
    v_add_f32 v78, v78, v49
    v_sub_f32 v42, v46, v17
    v_sub_f32 v49, v63, v65
    v_add_f32 v46, v46, v17
    v_add_f32 v63, v63, v65
    v_mul_f32 v17, 0xbe47c5c2, v42
    v_mul_f32 v65, 0xbf7b14be, v42
    v_fmac_f32 v17, 0x3f7b14be, v49
    v_fmac_f32 v65, 0xbe47c5c2, v49
    v_sub_f32 v42, v31, v33
    v_sub_f32 v49, v55, v57
    v_add_f32 v31, v31, v33
    v_add_f32 v55, v55, v57
    v_mul_f32 v33, 0xbec3ef15, v42
    v_mul_f32 v57, 0xbf6c835e, v42
    v_fmac_f32 v33, 0x3f6c835e, v49
    v_fmac_f32 v57, 0xbec3ef15, v49
    v_sub_f32 v42, v23, v25
    v_sub_f32 v49, v71, v73
    v_add_f32 v23, v23, v25
    v_add_f32 v71, v71, v73
    v_mul_f32 v25, 0xbf0e39da, v42
    v_mul_f32 v73, 0xbf54db31, v42
    v_fmac_f32 v25, 0x3f54db31, v49
    v_fmac_f32 v73, 0xbf0e39da, v49
    v_sub_f32 v42, v39, v41
    v_sub_f32 v49, v51, v53
    v_add_f32 v39, v39, v41
    v_add_f32 v51, v51, v53
    v_mul_f32 v41, 0xbf3504f3, v42
    v_mul_f32 v53, 0xbf3504f3, v42
    v_fmac_f32 v41, 0x3f3504f3, v49
    v_fmac_f32 v53, 0xbf3504f3, v49
    v_sub_f32 v42, v19, v21
    v_sub_f32 v49, v67, v69
    v_add_f32 v19, v19, v21
    v_add_f32 v67, v67, v69
    v_mul_f32 v21, 0xbf54db31, v42
    v_mul_f32 v69, 0xbf0e39da, v42
    v_fmac_f32 v21, 0x3f0e39da, v49
    v_fmac_f32 v69, 0xbf54db31, v49
    v_sub_f32 v42, v35, v37
    v_sub_f32 v49, v59, v61
    v_add_f32 v35, v35, v37
    v_add_f32 v59, v59, v61
    v_mul_f32 v37, 0xbf6c835e, v42
    v_mul_f32 v61, 0xbec3ef15, v42
    v_fmac_f32 v37, 0x3ec3ef15, v49
    v_fmac_f32 v61, 0xbf6c835e, v49
    v_sub_f32 v42, v27, v29
    v_sub_f32 v49, v75, v77
    v_add_f32 v27, v27, v29
    v_add_f32 v75, v75, v77
    v_mul_f32 v29, 0xbf7b14be, v42
    v_mul_f32 v77, 0xbe47c5c2, v42
    v_fmac_f32 v29, 0x3e47c5c2, v49
    v_fmac_f32 v77, 0xbf7b14be, v49
    v_sub_f32 v42, v16, v38
    v_sub_f32 v49, v48, v78
    v_add_f32 v16, v16, v38
    v_add_f32 v48, v48, v78
    v_sub_f32 v38, v83, v46
    v_sub_f32 v78, v81, v63
    v_add_f32 v83, v83, v46
    v_add_f32 v81, v81, v63
    v_mul_f32 v46, 0x3f6c835e, v38
    v_mul_f32 v63, 0xbec3ef15, v38
    v_fmac_f32 v46, 0x3ec3ef15, v78
    v_fmac_f32 v63, 0x3f6c835e, v78
    v_sub_f32 v38, v80, v31
    v_sub_f32 v78, v72, v55
    v_add_f32 v80, v80, v31
    v_add_f32 v72, v72, v55
    v_mul_f32 v31, 0x3f3504f3, v38
    v_mul_f32 v55, 0xbf3504f3, v38
    v_fmac_f32 v31, 0x3f3504f3, v78
    v_fmac_f32 v55, 0x3f3504f3, v78
    v_sub_f32 v38, v40, v23
    v_sub_f32 v78, v60, v71
    v_add_f32 v40, v40, v23
    v_add_f32 v60, v60, v71
    v_mul_f32 v23, 0x3ec3ef15, v38
    v_mul_f32 v71, 0xbf6c835e, v38
    v_fmac_f32 v23, 0x3f6c835e, v78
    v_fmac_f32 v71, 0x3ec3ef15, v78
    v_sub_f32 v38, v76, v51
    v_sub_f32 v78, v39, v28
    v_add_f32 v28, v28, v39
    v_add_f32 v76, v76, v51
    v_sub_f32 v39, v44, v19
    v_sub_f32 v51, v62, v67
    v_add_f32 v44, v44, v19
    v_add_f32 v62, v62, v67
    v_mul_f32 v19, 0xbec3ef15, v39
    v_mul_f32 v67, 0xbf6c835e, v39
    v_fmac_f32 v19, 0x3f6c835e, v51
    v_fmac_f32 v67, 0xbec3ef15, v51
    v_sub_f32 v39, v30, v35
    v_sub_f32 v51, v54, v59
    v_add_f32 v30, v30, v35
    v_add_f32 v54, v54, v59
    v_mul_f32 v35, 0xbf3504f3, v39
    v_mul_f32 v59, 0xbf3504f3, v39
    v_fmac_f32 v35, 0x3f3504f3, v51
    v_fmac_f32 v59, 0xbf3504f3, v51
    v_sub_f32 v39, v22, v27
    v_sub_f32 v51, v70, v75
    v_add_f32 v22, v22, v27
    v_add_f32 v70, v70, v75
    v_mul_f32 v27, 0xbf6c835e, v39
    v_mul_f32 v75, 0xbec3ef15, v39
    v_fmac_f32 v27, 0x3ec3ef15, v51
    v_fmac_f32 v75, 0xbf6c835e, v51
    v_sub_f32 v39, v32, v43
    v_sub_f32 v51, v64, v79
    v_add_f32 v32, v32, v43
    v_add_f32 v64, v64, v79
    v_sub_f32 v43, v47, v17
    v_sub_f32 v79, v56, v65
    v_add_f32 v47, v47, v17
    v_add_f32 v56, v56, v65
    v_mul_f32 v17, 0x3f6c835e, v43
    v_mul_f32 v65, 0xbec3ef15, v43
    v_fmac_f32 v17, 0x3ec3ef15, v79
    v_fmac_f32 v65, 0x3f6c835e, v79
    v_sub_f32 v43, v24, v33
    v_sub_f32 v79, v52, v57
    v_add_f32 v24, v24, v33
    v_add_f32 v52, v52, v57
    v_mul_f32 v33, 0x3f3504f3, v43
    v_mul_f32 v57, 0xbf3504f3, v43
    v_fmac_f32 v33, 0x3f3504f3, v79
    v_fmac_f32 v57, 0x3f3504f3, v79
    v_sub_f32 v43, v20, v25
    v_sub_f32 v79, v68, v73
    v_add_f32 v20, v20, v25
    v_add_f32 v68, v68, v73
    v_mul_f32 v25, 0x3ec3ef15, v43
    v_mul_f32 v73, 0xbf6c835e, v43
    v_fmac_f32 v25, 0x3f6c835e, v79
    v_fmac_f32 v73, 0x3ec3ef15, v79
    v_sub_f32 v43, v50, v53
    v_sub_f32 v79, v41, v36
    v_add_f32 v36, v36, v41
    v_add_f32 v50, v50, v53
    v_sub_f32 v41, v18, v21
    v_sub_f32 v53, v66, v69
    v_add_f32 v18, v18, v21
    v_add_f32 v66, v66, v69
    v_mul_f32 v21, 0xbec3ef15, v41
    v_mul_f32 v69, 0xbf6c835e, v41
    v_fmac_f32 v21, 0x3f6c835e, v53
    v_fmac_f32 v69, 0xbec3ef15, v53
    v_sub_f32 v41, v34, v37
    v_sub_f32 v53, v58, v61
    v_add_f32 v34, v34, v37
    v_add_f32 v58, v58, v61
    v_mul_f32 v37, 0xbf3504f3, v41
    v_mul_f32 v61, 0xbf3504f3, v41
    v_fmac_f32 v37, 0x3f3504f3, v53
    v_fmac_f32 v61, 0xbf3504f3, v53
    v_sub_f32 v41, v26, v29
    v_sub_f32 v53, v74, v77
    v_add_f32 v26, v26, v29
    v_add_f32 v74, v74, v77
    v_mul_f32 v29, 0xbf6c835e, v41
    v_mul_f32 v77, 0xbec3ef15, v41
    v_fmac_f32 v29, 0x3ec3ef15, v53
    v_fmac_f32 v77, 0xbf6c835e, v53
    v_sub_f32 v41, v16, v28
    v_sub_f32 v53, v48, v76
    v_add_f32 v16, v16, v28
    v_add_f32 v48, v48, v76
    v_sub_f32 v28, v83, v44
    v_sub_f32 v76, v81, v62
    v_add_f32 v83, v83, v44
    v_add_f32 v81, v81, v62
    v_mul_f32 v44, 0x3f3504f3, v28
    v_mul_f32 v62, 0xbf3504f3, v28
    v_fmac_f32 v44, 0x3f3504f3, v76
    v_fmac_f32 v62, 0x3f3504f3, v76
    v_sub_f32 v28, v72, v54
    v_sub_f32 v76, v30, v80
    v_add_f32 v80, v80, v30
    v_add_f32 v72, v72, v54
    v_sub_f32 v30, v40, v22
    v_sub_f32 v54, v60, v70
    v_add_f32 v40, v40, v22
    v_add_f32 v60, v60, v70
    v_mul_f32 v22, 0xbf3504f3, v30
    v_mul_f32 v70, 0xbf3504f3, v30
    v_fmac_f32 v22, 0x3f3504f3, v54
    v_fmac_f32 v70, 0xbf3504f3, v54
    v_sub_f32 v30, v42, v38
    v_sub_f32 v54, v49, v78
    v_add_f32 v42, v42, v38
    v_add_f32 v49, v49, v78
    v_sub_f32 v38, v46, v19
    v_sub_f32 v78, v63, v67
    v_add_f32 v46, v46, v19
    v_add_f32 v63, v63, v67
    v_mul_f32 v19, 0x3f3504f3, v38
    v_mul_f32 v67, 0xbf3504f3, v38
    v_fmac_f32 v19, 0x3f3504f3, v78
    v_fmac_f32 v67, 0x3f3504f3, v78
    v_sub_f32 v38, v55, v59
    v_sub_f32 v78, v35, v31
    v_add_f32 v31, v31, v35
    v_add_f32 v55, v55, v59
    v_sub_f32 v35, v23, v27
    v_sub_f32 v59, v71, v75
    v_add_f32 v23, v23, v27
    v_add_f32 v71, v71, v75
    v_mul_f32 v27, 0xbf3504f3, v35
    v_mul_f32 v75, 0xbf3504f3, v35
    v_fmac_f32 v27, 0x3f3504f3, v59
    v_fmac_f32 v75, 0xbf3504f3, v59
    v_sub_f32 v35, v32, v36
    v_sub_f32 v59, v64, v50
    v_add_f32 v32, v32, v36
    v_add_f32 v64, v64, v50
    v_sub_f32 v36, v47, v18
    v_sub_f32 v50, v56, v66
    v_add_f32 v47, v47, v18
    v_add_f32 v56, v56, v66
    v_mul_f32 v18, 0x3f3504f3, v36
    v_mul_f32 v66, 0xbf3504f3, v36
    v_fmac_f32 v18, 0x3f3504f3, v50
    v_fmac_f32 v66, 0x3f3504f3, v50
    v_sub_f32 v36, v52, v58
    v_sub_f32 v50, v34, v24
    v_add_f32 v24, v24, v34
    v_add_f32 v52, v52, v58
    v_sub_f32 v34, v20, v26
    v_sub_f32 v58, v68, v74
    v_add_f32 v20, v20, v26
    v_add_f32 v68, v68, v74
    v_mul_f32 v26, 0xbf3504f3, v34
    v_mul_f32 v74, 0xbf3504f3, v34
    v_fmac_f32 v26, 0x3f3504f3, v58
    v_fmac_f32 v74, 0xbf3504f3, v58
    v_sub_f32 v34, v39, v43
    v_sub_f32 v58, v51, v79
    v_add_f32 v39, v39, v43
    v_add_f32 v51, v51, v79
    v_sub_f32 v43, v17, v21
    v_sub_f32 v79, v65, v69
    v_add_f32 v17, v17, v21
    v_add_f32 v65, v65, v69
    v_mul_f32 v21, 0x3f3504f3, v43
    v_mul_f32 v69, 0xbf3504f3, v43
    v_fmac_f32 v21, 0x3f3504f3, v79
    v_fmac_f32 v69, 0x3f3504f3, v79
    v_sub_f32 v43, v57, v61
    v_sub_f32 v79, v37, v33
    v_add_f32 v33, v33, v37
    v_add_f32 v57, v57, v61
    v_sub_f32 v37, v25, v29
    v_sub_f32 v61, v73, v77
    v_add_f32 v25, v25, v29
    v_add_f32 v73, v73, v77
    v_mul_f32 v29, 0xbf3504f3, v37
    v_mul_f32 v77, 0xbf3504f3, v37
    v_fmac_f32 v29, 0x3f3504f3, v61
    v_fmac_f32 v77, 0xbf3504f3, v61
    v_sub_f32 v37, v16, v80
    v_sub_f32 v61, v48, v72
    v_add_f32 v16, v16, v80
    v_add_f32 v48, v48, v72
    v_sub_f32 v80, v81, v60
    v_sub_f32 v72, v40, v83
    v_add_f32 v83, v83, v40
    v_add_f32 v81, v81, v60
    v_sub_f32 v40, v41, v28
    v_sub_f32 v60, v53, v76
    v_add_f32 v41, v41, v28
    v_add_f32 v53, v53, v76
    v_sub_f32 v28, v62, v70
    v_sub_f32 v76, v22, v44
    v_add_f32 v44, v44, v22
    v_add_f32 v62, v62, v70
    v_sub_f32 v22, v42, v31
    v_sub_f32 v70, v49, v55
    v_add_f32 v42, v42, v31
    v_add_f32 v49, v49, v55
    v_sub_f32 v31, v63, v71
    v_sub_f32 v55, v23, v46
    v_add_f32 v46, v46, v23
    v_add_f32 v63, v63, v71
    v_sub_f32 v23, v30, v38
    v_sub_f32 v71, v54, v78
    v_add_f32 v30, v30, v38
    v_add_f32 v54, v54, v78
    v_sub_f32 v38, v67, v75
    v_sub_f32 v78, v27, v19
    v_add_f32 v19, v19, v27
    v_add_f32 v67, v67, v75
    v_sub_f32 v27, v32, v24
    v_sub_f32 v75, v64, v52
    v_add_f32 v32, v32, v24
    v_add_f32 v64, v64, v52
    v_sub_f32 v24, v56, v68
    v_sub_f32 v52, v20, v47
    v_add_f32 v47, v47, v20
    v_add_f32 v56, v56, v68
    v_sub_f32 v20, v35, v36
    v_sub_f32 v68, v59, v50
    v_add_f32 v35, v35, v36
    v_add_f32 v59, v59, v50
    v_sub_f32 v36, v66, v74
    v_sub_f32 v50, v26, v18
    v_add_f32 v18, v18, v26
    v_add_f32 v66, v66, v74
    v_sub_f32 v26, v39, v33
    v_sub_f32 v74, v51, v57
    v_add_f32 v39, v39, v33
    v_add_f32 v51, v51, v57
    v_sub_f32 v33, v65, v73
    v_sub_f32 v57, v25, v17
    v_add_f32 v17, v17, v25
    v_add_f32 v65, v65, v73
    v_sub_f32 v25, v34, v43
    v_sub_f32 v73, v58, v79
    v_add_f32 v34, v34, v43
    v_add_f32 v58, v58, v79
    v_sub_f32 v43, v69, v77
    v_sub_f32 v79, v29, v21
    v_add_f32 v21, v21, v29
    v_add_f32 v69, v69, v77
    v_sub_f32 v29, v16, v83
    v_sub_f32 v77, v48, v81
    v_add_f32 v16, v16, v83
    v_add_f32 v48, v48, v81
    v_sub_f32 v83, v37, v80
    v_sub_f32 v81, v61, v72
    v_add_f32 v37, v37, v80
    v_add_f32 v61, v61, v72
    v_sub_f32 v80, v41, v44
    v_sub_f32 v72, v53, v62
    v_add_f32 v41, v41, v44
    v_add_f32 v53, v53, v62
    v_sub_f32 v44, v40, v28
    v_sub_f32 v62, v60, v76
    v_add_f32 v40, v40, v28
    v_add_f32 v60, v60, v76
    v_sub_f32 v28, v42, v46
    v_sub_f32 v76, v49, v63
    v_add_f32 v42, v42, v46
    v_add_f32 v49, v49, v63
    v_sub_f32 v46, v22, v31
    v_sub_f32 v63, v70, v55
    v_add_f32 v22, v22, v31
    v_add_f32 v70, v70, v55
    v_sub_f32 v31, v30, v19
    v_sub_f32 v55, v54, v67
    v_add_f32 v30, v30, v19
    v_add_f32 v54, v54, v67
    v_sub_f32 v19, v23, v38
    v_sub_f32 v67, v71, v78
    v_add_f32 v23, v23, v38
    v_add_f32 v71, v71, v78
    v_sub_f32 v38, v32, v47
    v_sub_f32 v78, v64, v56
    v_add_f32 v32, v32, v47
    v_add_f32 v64, v64, v56
    v_sub_f32 v47, v27, v24
    v_sub_f32 v56, v75, v52
    v_add_f32 v27, v27, v24
    v_add_f32 v75, v75, v52
    v_sub_f32 v24, v35, v18
    v_sub_f32 v52, v59, v66
    v_add_f32 v35, v35, v18
    v_add_f32 v59, v59, v66
    v_sub_f32 v18, v20, v36
    v_sub_f32 v66, v68, v50
    v_add_f32 v20, v20, v36
    v_add_f32 v68, v68, v50
    v_sub_f32 v36, v39, v17
    v_sub_f32 v50, v51, v65
    v_add_f32 v39, v39, v17
    v_add_f32 v51, v51, v65
    v_sub_f32 v17, v26, v33
    v_sub_f32 v65, v74, v57
    v_add_f32 v26, v26, v33
    v_add_f32 v74, v74, v57
    v_sub_f32 v33, v34, v21
    v_sub_f32 v57, v58, v69
    v_add_f32 v34, v34, v21
    v_add_f32 v58, v58, v69
    v_sub_f32 v21, v25, v43
    v_sub_f32 v69, v73, v79
    v_add_f32 v25, v25, v43
    v_add_f32 v73, v73, v79
    ds_write_b32 v4, v16 offset:0
    ds_write_b32 v4, v48 offset:4
    ds_write_b32 v4, v32 offset:256
    ds_write_b32 v4, v64 offset:260
    ds_write_b32 v4, v42 offset:512
    ds_write_b32 v4, v49 offset:516
    ds_write_b32 v4, v39 offset:768
    ds_write_b32 v4, v51 offset:772
    ds_write_b32 v4, v41 offset:1024
    ds_write_b32 v4, v53 offset:1028
    ds_write_b32 v4, v35 offset:1280
    ds_write_b32 v4, v59 offset:1284
    ds_write_b32 v4, v30 offset:1536
    ds_write_b32 v4, v54 offset:1540
    ds_write_b32 v4, v34 offset:1792
    ds_write_b32 v4, v58 offset:1796
    ds_write_b32 v4, v37 offset:2048
    ds_write_b32 v4, v61 offset:2052
    ds_write_b32 v4, v27 offset:2304
    ds_write_b32 v4, v75 offset:2308
    ds_write_b32 v4, v22 offset:2560
    ds_write_b32 v4, v70 offset:2564
    ds_write_b32 v4, v26 offset:2816
    ds_write_b32 v4, v74 offset:2820
    ds_write_b32 v4, v40 offset:3072
    ds_write_b32 v4, v60 offset:3076
    ds_write_b32 v4, v20 offset:3328
    ds_write_b32 v4, v68 offset:3332
    ds_write_b32 v4, v23 offset:3584
    ds_write_b32 v4, v71 offset:3588
    ds_write_b32 v4, v25 offset:3840
    ds_write_b32 v4, v73 offset:3844
    ds_write_b32 v4, v29 offset:4096
    ds_write_b32 v4, v77 offset:4100
    ds_write_b32 v4, v38 offset:4352
    ds_write_b32 v4, v78 offset:4356
    ds_write_b32 v4, v28 offset:4608
    ds_write_b32 v4, v76 offset:4612
    ds_write_b32 v4, v36 offset:4864
    ds_write_b32 v4, v50 offset:4868
    ds_write_b32 v4, v80 offset:5120
    ds_write_b32 v4, v72 offset:5124
    ds_write_b32 v4, v24 offset:5376
    ds_write_b32 v4, v52 offset:5380
    ds_write_b32 v4, v31 offset:5632
    ds_write_b32 v4, v55 offset:5636
    ds_write_b32 v4, v33 offset:5888
    ds_write_b32 v4, v57 offset:5892
    ds_write_b32 v4, v83 offset:6144
    ds_write_b32 v4, v81 offset:6148
    ds_write_b32 v4, v47 offset:6400
    ds_write_b32 v4, v56 offset:6404
    ds_write_b32 v4, v46 offset:6656
    ds_write_b32 v4, v63 offset:6660
    ds_write_b32 v4, v17 offset:6912
    ds_write_b32 v4, v65 offset:6916
    ds_write_b32 v4, v44 offset:7168
    ds_write_b32 v4, v62 offset:7172
    ds_write_b32 v4, v18 offset:7424
    ds_write_b32 v4, v66 offset:7428
    ds_write_b32 v4, v19 offset:7680
    ds_write_b32 v4, v67 offset:7684
    ds_write_b32 v4, v21 offset:7936
    ds_write_b32 v4, v69 offset:7940
    s_waitcnt lgkmcnt(0)
    s_barrier
    v_and_b32 v6, 7, v0
    v_lshrrev_b32 v7, 3, v0
    s_movk_i32 s13, 8448
    v_mul_lo_u32 v8, v6, s13
    v_lshl_add_u32 v4, v7, 3, v8
    v_lshlrev_b32 v5, 14, v7
    v_lshl_add_u32 v5, v6, 4, v5
    s_lshl_b32 s12, s92, 7
    s_add_u32 s12, s12, 96468992
    v_sub_u32 v6, 1024, v7
    v_and_b32 v6, 1023, v6
    v_lshl_add_u32 v6, v6, 3, v8
    ds_read_b64 v[16:17], v4 offset:0
    ds_read_b64 v[18:19], v6
    s_waitcnt lgkmcnt(0)
    v_add_f32 v20, v16, v18
    v_sub_f32 v21, v17, v19
    v_add_f32 v22, v17, v19
    v_sub_f32 v23, v18, v16
    s_mov_b32 s13, s12
    s_add_u32 s13, s12, 0
    buffer_store_dwordx4 v[20:23], v5, s[8:11], s13 offen sc1
    s_nop 1
    v_sub_u32 v6, 992, v7
    v_and_b32 v6, 1023, v6
    v_lshl_add_u32 v6, v6, 3, v8
    ds_read_b64 v[16:17], v4 offset:256
    ds_read_b64 v[18:19], v6
    s_waitcnt lgkmcnt(0)
    v_add_f32 v20, v16, v18
    v_sub_f32 v21, v17, v19
    v_add_f32 v22, v17, v19
    v_sub_f32 v23, v18, v16
    s_mov_b32 s13, s12
    s_add_u32 s13, s12, 524288
    buffer_store_dwordx4 v[20:23], v5, s[8:11], s13 offen sc1
    s_nop 1
    v_sub_u32 v6, 960, v7
    v_and_b32 v6, 1023, v6
    v_lshl_add_u32 v6, v6, 3, v8
    ds_read_b64 v[16:17], v4 offset:512
    ds_read_b64 v[18:19], v6
    s_waitcnt lgkmcnt(0)
    v_add_f32 v20, v16, v18
    v_sub_f32 v21, v17, v19
    v_add_f32 v22, v17, v19
    v_sub_f32 v23, v18, v16
    s_mov_b32 s13, s12
    s_add_u32 s13, s12, 1048576
    buffer_store_dwordx4 v[20:23], v5, s[8:11], s13 offen sc1
    s_nop 1
    v_sub_u32 v6, 928, v7
    v_and_b32 v6, 1023, v6
    v_lshl_add_u32 v6, v6, 3, v8
    ds_read_b64 v[16:17], v4 offset:768
    ds_read_b64 v[18:19], v6
    s_waitcnt lgkmcnt(0)
    v_add_f32 v20, v16, v18
    v_sub_f32 v21, v17, v19
    v_add_f32 v22, v17, v19
    v_sub_f32 v23, v18, v16
    s_mov_b32 s13, s12
    s_add_u32 s13, s12, 1572864
    buffer_store_dwordx4 v[20:23], v5, s[8:11], s13 offen sc1
    s_nop 1
    v_sub_u32 v6, 896, v7
    v_and_b32 v6, 1023, v6
    v_lshl_add_u32 v6, v6, 3, v8
    ds_read_b64 v[16:17], v4 offset:1024
    ds_read_b64 v[18:19], v6
    s_waitcnt lgkmcnt(0)
    v_add_f32 v20, v16, v18
    v_sub_f32 v21, v17, v19
    v_add_f32 v22, v17, v19
    v_sub_f32 v23, v18, v16
    s_mov_b32 s13, s12
    s_add_u32 s13, s12, 2097152
    buffer_store_dwordx4 v[20:23], v5, s[8:11], s13 offen sc1
    s_nop 1
    v_sub_u32 v6, 864, v7
    v_and_b32 v6, 1023, v6
    v_lshl_add_u32 v6, v6, 3, v8
    ds_read_b64 v[16:17], v4 offset:1280
    ds_read_b64 v[18:19], v6
    s_waitcnt lgkmcnt(0)
    v_add_f32 v20, v16, v18
    v_sub_f32 v21, v17, v19
    v_add_f32 v22, v17, v19
    v_sub_f32 v23, v18, v16
    s_mov_b32 s13, s12
    s_add_u32 s13, s12, 2621440
    buffer_store_dwordx4 v[20:23], v5, s[8:11], s13 offen sc1
    s_nop 1
    v_sub_u32 v6, 832, v7
    v_and_b32 v6, 1023, v6
    v_lshl_add_u32 v6, v6, 3, v8
    ds_read_b64 v[16:17], v4 offset:1536
    ds_read_b64 v[18:19], v6
    s_waitcnt lgkmcnt(0)
    v_add_f32 v20, v16, v18
    v_sub_f32 v21, v17, v19
    v_add_f32 v22, v17, v19
    v_sub_f32 v23, v18, v16
    s_mov_b32 s13, s12
    s_add_u32 s13, s12, 3145728
    buffer_store_dwordx4 v[20:23], v5, s[8:11], s13 offen sc1
    s_nop 1
    v_sub_u32 v6, 800, v7
    v_and_b32 v6, 1023, v6
    v_lshl_add_u32 v6, v6, 3, v8
    ds_read_b64 v[16:17], v4 offset:1792
    ds_read_b64 v[18:19], v6
    s_waitcnt lgkmcnt(0)
    v_add_f32 v20, v16, v18
    v_sub_f32 v21, v17, v19
    v_add_f32 v22, v17, v19
    v_sub_f32 v23, v18, v16
    s_mov_b32 s13, s12
    s_add_u32 s13, s12, 3670016
    buffer_store_dwordx4 v[20:23], v5, s[8:11], s13 offen sc1
    s_nop 1
    v_sub_u32 v6, 768, v7
    v_and_b32 v6, 1023, v6
    v_lshl_add_u32 v6, v6, 3, v8
    ds_read_b64 v[16:17], v4 offset:2048
    ds_read_b64 v[18:19], v6
    s_waitcnt lgkmcnt(0)
    v_add_f32 v20, v16, v18
    v_sub_f32 v21, v17, v19
    v_add_f32 v22, v17, v19
    v_sub_f32 v23, v18, v16
    s_mov_b32 s13, s12
    s_add_u32 s13, s12, 4194304
    buffer_store_dwordx4 v[20:23], v5, s[8:11], s13 offen sc1
    s_nop 1
    v_sub_u32 v6, 736, v7
    v_and_b32 v6, 1023, v6
    v_lshl_add_u32 v6, v6, 3, v8
    ds_read_b64 v[16:17], v4 offset:2304
    ds_read_b64 v[18:19], v6
    s_waitcnt lgkmcnt(0)
    v_add_f32 v20, v16, v18
    v_sub_f32 v21, v17, v19
    v_add_f32 v22, v17, v19
    v_sub_f32 v23, v18, v16
    s_mov_b32 s13, s12
    s_add_u32 s13, s12, 4718592
    buffer_store_dwordx4 v[20:23], v5, s[8:11], s13 offen sc1
    s_nop 1
    v_sub_u32 v6, 704, v7
    v_and_b32 v6, 1023, v6
    v_lshl_add_u32 v6, v6, 3, v8
    ds_read_b64 v[16:17], v4 offset:2560
    ds_read_b64 v[18:19], v6
    s_waitcnt lgkmcnt(0)
    v_add_f32 v20, v16, v18
    v_sub_f32 v21, v17, v19
    v_add_f32 v22, v17, v19
    v_sub_f32 v23, v18, v16
    s_mov_b32 s13, s12
    s_add_u32 s13, s12, 5242880
    buffer_store_dwordx4 v[20:23], v5, s[8:11], s13 offen sc1
    s_nop 1
    v_sub_u32 v6, 672, v7
    v_and_b32 v6, 1023, v6
    v_lshl_add_u32 v6, v6, 3, v8
    ds_read_b64 v[16:17], v4 offset:2816
    ds_read_b64 v[18:19], v6
    s_waitcnt lgkmcnt(0)
    v_add_f32 v20, v16, v18
    v_sub_f32 v21, v17, v19
    v_add_f32 v22, v17, v19
    v_sub_f32 v23, v18, v16
    s_mov_b32 s13, s12
    s_add_u32 s13, s12, 5767168
    buffer_store_dwordx4 v[20:23], v5, s[8:11], s13 offen sc1
    s_nop 1
    v_sub_u32 v6, 640, v7
    v_and_b32 v6, 1023, v6
    v_lshl_add_u32 v6, v6, 3, v8
    ds_read_b64 v[16:17], v4 offset:3072
    ds_read_b64 v[18:19], v6
    s_waitcnt lgkmcnt(0)
    v_add_f32 v20, v16, v18
    v_sub_f32 v21, v17, v19
    v_add_f32 v22, v17, v19
    v_sub_f32 v23, v18, v16
    s_mov_b32 s13, s12
    s_add_u32 s13, s12, 6291456
    buffer_store_dwordx4 v[20:23], v5, s[8:11], s13 offen sc1
    s_nop 1
    v_sub_u32 v6, 608, v7
    v_and_b32 v6, 1023, v6
    v_lshl_add_u32 v6, v6, 3, v8
    ds_read_b64 v[16:17], v4 offset:3328
    ds_read_b64 v[18:19], v6
    s_waitcnt lgkmcnt(0)
    v_add_f32 v20, v16, v18
    v_sub_f32 v21, v17, v19
    v_add_f32 v22, v17, v19
    v_sub_f32 v23, v18, v16
    s_mov_b32 s13, s12
    s_add_u32 s13, s12, 6815744
    buffer_store_dwordx4 v[20:23], v5, s[8:11], s13 offen sc1
    s_nop 1
    v_sub_u32 v6, 576, v7
    v_and_b32 v6, 1023, v6
    v_lshl_add_u32 v6, v6, 3, v8
    ds_read_b64 v[16:17], v4 offset:3584
    ds_read_b64 v[18:19], v6
    s_waitcnt lgkmcnt(0)
    v_add_f32 v20, v16, v18
    v_sub_f32 v21, v17, v19
    v_add_f32 v22, v17, v19
    v_sub_f32 v23, v18, v16
    s_mov_b32 s13, s12
    s_add_u32 s13, s12, 7340032
    buffer_store_dwordx4 v[20:23], v5, s[8:11], s13 offen sc1
    s_nop 1
    v_sub_u32 v6, 544, v7
    v_and_b32 v6, 1023, v6
    v_lshl_add_u32 v6, v6, 3, v8
    ds_read_b64 v[16:17], v4 offset:3840
    ds_read_b64 v[18:19], v6
    s_waitcnt lgkmcnt(0)
    v_add_f32 v20, v16, v18
    v_sub_f32 v21, v17, v19
    v_add_f32 v22, v17, v19
    v_sub_f32 v23, v18, v16
    s_mov_b32 s13, s12
    s_add_u32 s13, s12, 7864320
    buffer_store_dwordx4 v[20:23], v5, s[8:11], s13 offen sc1
    s_nop 1
    v_sub_u32 v6, 512, v7
    v_and_b32 v6, 1023, v6
    v_lshl_add_u32 v6, v6, 3, v8
    ds_read_b64 v[16:17], v4 offset:4096
    ds_read_b64 v[18:19], v6
    s_waitcnt lgkmcnt(0)
    v_add_f32 v20, v16, v18
    v_sub_f32 v21, v17, v19
    v_add_f32 v22, v17, v19
    v_sub_f32 v23, v18, v16
    s_mov_b32 s13, s12
    v_cmp_eq_u32 vcc, 0, v7
    s_and_saveexec_b64 s[14:15], vcc
    s_add_u32 s13, s12, 8388608
    buffer_store_dwordx4 v[20:23], v5, s[8:11], s13 offen sc1
    s_nop 1
    s_mov_b64 exec, -1
    s_waitcnt vmcnt(0)
    s_barrier
    v_mov_b32 v2, 1
    v_cmp_eq_u32 vcc, 0, v0
    s_and_saveexec_b64 s[80:81], vcc
    s_cbranch_execz mega_kernel_sg64_1
    buffer_atomic_add v2, off, s[88:91], 0 offset:64 sc1
mega_kernel_sg64_1:
    s_mov_b64 exec, s[80:81]
mega_kernel_wf1:
    s_sleep 8
    buffer_load_dword v2, off, s[88:91], 0 offset:64 sc1
    s_waitcnt vmcnt(0)
    v_cmp_ne_u32 vcc, 192, v2
    s_cbranch_vccnz mega_kernel_wf1
    s_mov_b32 s99, s92
mega_kernel_f2l:
    s_barrier
    s_load_dwordx2 s[8:9], s[0:1], 96
    v_lshrrev_b32 v5, 6, v0
    v_and_b32 v1, 63, v0
    v_readfirstlane_b32 s12, v5
    s_lshl_b32 s13, s99, 2
    s_add_u32 s13, s13, s12
    s_cmp_ge_u32 s13, 513
    s_cbranch_scc1 mega_kernel_f2_end
    v_cvt_f32_u32 v2, v1
    s_waitcnt lgkmcnt(0)
    s_mov_b32 s10, 268435456
    s_mov_b32 s11, 0x00020000
    s_lshl_b32 s14, s13, 14
    s_add_u32 s15, s14, 96468992
    v_lshlrev_b32 v5, 3, v1
    s_add_u32 s16, s15, 0
    buffer_load_dwordx2 v[16:17], v5, s[8:11], s16 offen
    s_add_u32 s16, s15, 512
    buffer_load_dwordx2 v[18:19], v5, s[8:11], s16 offen
    s_add_u32 s16, s15, 1024
    buffer_load_dwordx2 v[20:21], v5, s[8:11], s16 offen
    s_add_u32 s16, s15, 1536
    buffer_load_dwordx2 v[22:23], v5, s[8:11], s16 offen
    s_add_u32 s16, s15, 2048
    buffer_load_dwordx2 v[24:25], v5, s[8:11], s16 offen
    s_add_u32 s16, s15, 2560
    buffer_load_dwordx2 v[26:27], v5, s[8:11], s16 offen
    s_add_u32 s16, s15, 3072
    buffer_load_dwordx2 v[28:29], v5, s[8:11], s16 offen
    s_add_u32 s16, s15, 3584
    buffer_load_dwordx2 v[30:31], v5, s[8:11], s16 offen
    s_add_u32 s16, s15, 4096
    buffer_load_dwordx2 v[32:33], v5, s[8:11], s16 offen
    s_add_u32 s16, s15, 4608
    buffer_load_dwordx2 v[34:35], v5, s[8:11], s16 offen
    s_add_u32 s16, s15, 5120
    buffer_load_dwordx2 v[36:37], v5, s[8:11], s16 offen
    s_add_u32 s16, s15, 5632
    buffer_load_dwordx2 v[38:39], v5, s[8:11], s16 offen
    s_add_u32 s16, s15, 6144
    buffer_load_dwordx2 v[40:41], v5, s[8:11], s16 offen
    s_add_u32 s16, s15, 6656
    buffer_load_dwordx2 v[42:43], v5, s[8:11], s16 offen
    s_add_u32 s16, s15, 7168
    buffer_load_dwordx2 v[44:45], v5, s[8:11], s16 offen
    s_add_u32 s16, s15, 7680
    buffer_load_dwordx2 v[46:47], v5, s[8:11], s16 offen
    s_add_u32 s16, s15, 8192
    buffer_load_dwordx2 v[48:49], v5, s[8:11], s16 offen
    s_add_u32 s16, s15, 8704
    buffer_load_dwordx2 v[50:51], v5, s[8:11], s16 offen
    s_add_u32 s16, s15, 9216
    buffer_load_dwordx2 v[52:53], v5, s[8:11], s16 offen
    s_add_u32 s16, s15, 9728
    buffer_load_dwordx2 v[54:55], v5, s[8:11], s16 offen
    s_add_u32 s16, s15, 10240
    buffer_load_dwordx2 v[56:57], v5, s[8:11], s16 offen
    s_add_u32 s16, s15, 10752
    buffer_load_dwordx2 v[58:59], v5, s[8:11], s16 offen
    s_add_u32 s16, s15, 11264
    buffer_load_dwordx2 v[60:61], v5, s[8:11], s16 offen
    s_add_u32 s16, s15, 11776
    buffer_load_dwordx2 v[62:63], v5, s[8:11], s16 offen
    s_add_u32 s16, s15, 12288
    buffer_load_dwordx2 v[64:65], v5, s[8:11], s16 offen
    s_add_u32 s16, s15, 12800
    buffer_load_dwordx2 v[66:67], v5, s[8:11], s16 offen
    s_add_u32 s16, s15, 13312
    buffer_load_dwordx2 v[68:69], v5, s[8:11], s16 offen
    s_add_u32 s16, s15, 13824
    buffer_load_dwordx2 v[70:71], v5, s[8:11], s16 offen
    s_add_u32 s16, s15, 14336
    buffer_load_dwordx2 v[72:73], v5, s[8:11], s16 offen
    s_add_u32 s16, s15, 14848
    buffer_load_dwordx2 v[74:75], v5, s[8:11], s16 offen
    s_add_u32 s16, s15, 15360
    buffer_load_dwordx2 v[76:77], v5, s[8:11], s16 offen
    s_add_u32 s16, s15, 15872
    buffer_load_dwordx2 v[78:79], v5, s[8:11], s16 offen
    s_mul_i32 s17, s12, 16896
    v_lshlrev_b32 v3, 3, v1
    v_add_u32 v3, s17, v3
    v_and_b32 v7, 1, v1
    v_lshrrev_b32 v6, 1, v1
    v_cvt_f32_u32 v8, v6
    v_cvt_f32_u32 v10, v7
    s_movk_i32 s18, 528
    v_mul_lo_u32 v4, v6, s18
    v_lshl_add_u32 v4, v7, 3, v4
    v_add_u32 v4, s17, v4
    v_mov_b32 v9, 1.0
    v_fma_f32 v9, v10, -2.0, v9
    v_lshlrev_b32 v5, 12, v7
    v_lshl_add_u32 v11, v6, 2, v5
    s_lshl_b32 s19, s13, 13
    s_add_u32 s19, s19, 121634816
    s_waitcnt vmcnt(0)
    v_sub_f32 v80, v16, v48
    v_sub_f32 v81, v17, v49
    v_add_f32 v16, v16, v48
    v_add_f32 v17, v17, v49
    v_sub_f32 v48, v18, v50
    v_sub_f32 v49, v19, v51
    v_add_f32 v18, v18, v50
    v_add_f32 v19, v19, v51
    v_mul_f32 v50, 0x3f7b14be, v48
    v_mul_f32 v51, 0xbe47c5c2, v48
    v_fmac_f32 v50, 0x3e47c5c2, v49
    v_fmac_f32 v51, 0x3f7b14be, v49
    v_sub_f32 v48, v20, v52
    v_sub_f32 v49, v21, v53
    v_add_f32 v20, v20, v52
    v_add_f32 v21, v21, v53
    v_mul_f32 v52, 0x3f6c835e, v48
    v_mul_f32 v53, 0xbec3ef15, v48
    v_fmac_f32 v52, 0x3ec3ef15, v49
    v_fmac_f32 v53, 0x3f6c835e, v49
    v_sub_f32 v48, v22, v54
    v_sub_f32 v49, v23, v55
    v_add_f32 v22, v22, v54
    v_add_f32 v23, v23, v55
    v_mul_f32 v54, 0x3f54db31, v48
    v_mul_f32 v55, 0xbf0e39da, v48
    v_fmac_f32 v54, 0x3f0e39da, v49
    v_fmac_f32 v55, 0x3f54db31, v49
    v_sub_f32 v48, v24, v56
    v_sub_f32 v49, v25, v57
    v_add_f32 v24, v24, v56
    v_add_f32 v25, v25, v57
    v_mul_f32 v56, 0x3f3504f3, v48
    v_mul_f32 v57, 0xbf3504f3, v48
    v_fmac_f32 v56, 0x3f3504f3, v49
    v_fmac_f32 v57, 0x3f3504f3, v49
    v_sub_f32 v48, v26, v58
    v_sub_f32 v49, v27, v59
    v_add_f32 v26, v26, v58
    v_add_f32 v27, v27, v59
    v_mul_f32 v58, 0x3f0e39da, v48
    v_mul_f32 v59, 0xbf54db31, v48
    v_fmac_f32 v58, 0x3f54db31, v49
    v_fmac_f32 v59, 0x3f0e39da, v49
    v_sub_f32 v48, v28, v60
    v_sub_f32 v49, v29, v61
    v_add_f32 v28, v28, v60
    v_add_f32 v29, v29, v61
    v_mul_f32 v60, 0x3ec3ef15, v48
    v_mul_f32 v61, 0xbf6c835e, v48
    v_fmac_f32 v60, 0x3f6c835e, v49
    v_fmac_f32 v61, 0x3ec3ef15, v49
    v_sub_f32 v48, v30, v62
    v_sub_f32 v49, v31, v63
    v_add_f32 v30, v30, v62
    v_add_f32 v31, v31, v63
    v_mul_f32 v62, 0x3e47c5c2, v48
    v_mul_f32 v63, 0xbf7b14be, v48
    v_fmac_f32 v62, 0x3f7b14be, v49
    v_fmac_f32 v63, 0x3e47c5c2, v49
    v_sub_f32 v48, v33, v65
    v_sub_f32 v49, v64, v32
    v_add_f32 v32, v32, v64
    v_add_f32 v33, v33, v65
    v_sub_f32 v64, v34, v66
    v_sub_f32 v65, v35, v67
    v_add_f32 v34, v34, v66
    v_add_f32 v35, v35, v67
    v_mul_f32 v66, 0xbe47c5c2, v64
    v_mul_f32 v67, 0xbf7b14be, v64
    v_fmac_f32 v66, 0x3f7b14be, v65
    v_fmac_f32 v67, 0xbe47c5c2, v65
    v_sub_f32 v64, v36, v68
    v_sub_f32 v65, v37, v69
    v_add_f32 v36, v36, v68
    v_add_f32 v37, v37, v69
    v_mul_f32 v68, 0xbec3ef15, v64
    v_mul_f32 v69, 0xbf6c835e, v64
    v_fmac_f32 v68, 0x3f6c835e, v65
    v_fmac_f32 v69, 0xbec3ef15, v65
    v_sub_f32 v64, v38, v70
    v_sub_f32 v65, v39, v71
    v_add_f32 v38, v38, v70
    v_add_f32 v39, v39, v71
    v_mul_f32 v70, 0xbf0e39da, v64
    v_mul_f32 v71, 0xbf54db31, v64
    v_fmac_f32 v70, 0x3f54db31, v65
    v_fmac_f32 v71, 0xbf0e39da, v65
    v_sub_f32 v64, v40, v72
    v_sub_f32 v65, v41, v73
    v_add_f32 v40, v40, v72
    v_add_f32 v41, v41, v73
    v_mul_f32 v72, 0xbf3504f3, v64
    v_mul_f32 v73, 0xbf3504f3, v64
    v_fmac_f32 v72, 0x3f3504f3, v65
    v_fmac_f32 v73, 0xbf3504f3, v65
    v_sub_f32 v64, v42, v74
    v_sub_f32 v65, v43, v75
    v_add_f32 v42, v42, v74
    v_add_f32 v43, v43, v75
    v_mul_f32 v74, 0xbf54db31, v64
    v_mul_f32 v75, 0xbf0e39da, v64
    v_fmac_f32 v74, 0x3f0e39da, v65
    v_fmac_f32 v75, 0xbf54db31, v65
    v_sub_f32 v64, v44, v76
    v_sub_f32 v65, v45, v77
    v_add_f32 v44, v44, v76
    v_add_f32 v45, v45, v77
    v_mul_f32 v76, 0xbf6c835e, v64
    v_mul_f32 v77, 0xbec3ef15, v64
    v_fmac_f32 v76, 0x3ec3ef15, v65
    v_fmac_f32 v77, 0xbf6c835e, v65
    v_sub_f32 v64, v46, v78
    v_sub_f32 v65, v47, v79
    v_add_f32 v46, v46, v78
    v_add_f32 v47, v47, v79
    v_mul_f32 v78, 0xbf7b14be, v64
    v_mul_f32 v79, 0xbe47c5c2, v64
    v_fmac_f32 v78, 0x3e47c5c2, v65
    v_fmac_f32 v79, 0xbf7b14be, v65
    v_sub_f32 v64, v16, v32
    v_sub_f32 v65, v17, v33
    v_add_f32 v16, v16, v32
    v_add_f32 v17, v17, v33
    v_sub_f32 v32, v18, v34
    v_sub_f32 v33, v19, v35
    v_add_f32 v18, v18, v34
    v_add_f32 v19, v19, v35
    v_mul_f32 v34, 0x3f6c835e, v32
    v_mul_f32 v35, 0xbec3ef15, v32
    v_fmac_f32 v34, 0x3ec3ef15, v33
    v_fmac_f32 v35, 0x3f6c835e, v33
    v_sub_f32 v32, v20, v36
    v_sub_f32 v33, v21, v37
    v_add_f32 v20, v20, v36
    v_add_f32 v21, v21, v37
    v_mul_f32 v36, 0x3f3504f3, v32
    v_mul_f32 v37, 0xbf3504f3, v32
    v_fmac_f32 v36, 0x3f3504f3, v33
    v_fmac_f32 v37, 0x3f3504f3, v33
    v_sub_f32 v32, v22, v38
    v_sub_f32 v33, v23, v39
    v_add_f32 v22, v22, v38
    v_add_f32 v23, v23, v39
    v_mul_f32 v38, 0x3ec3ef15, v32
    v_mul_f32 v39, 0xbf6c835e, v32
    v_fmac_f32 v38, 0x3f6c835e, v33
    v_fmac_f32 v39, 0x3ec3ef15, v33
    v_sub_f32 v32, v25, v41
    v_sub_f32 v33, v40, v24
    v_add_f32 v24, v24, v40
    v_add_f32 v25, v25, v41
    v_sub_f32 v40, v26, v42
    v_sub_f32 v41, v27, v43
    v_add_f32 v26, v26, v42
    v_add_f32 v27, v27, v43
    v_mul_f32 v42, 0xbec3ef15, v40
    v_mul_f32 v43, 0xbf6c835e, v40
    v_fmac_f32 v42, 0x3f6c835e, v41
    v_fmac_f32 v43, 0xbec3ef15, v41
    v_sub_f32 v40, v28, v44
    v_sub_f32 v41, v29, v45
    v_add_f32 v28, v28, v44
    v_add_f32 v29, v29, v45
    v_mul_f32 v44, 0xbf3504f3, v40
    v_mul_f32 v45, 0xbf3504f3, v40
    v_fmac_f32 v44, 0x3f3504f3, v41
    v_fmac_f32 v45, 0xbf3504f3, v41
    v_sub_f32 v40, v30, v46
    v_sub_f32 v41, v31, v47
    v_add_f32 v30, v30, v46
    v_add_f32 v31, v31, v47
    v_mul_f32 v46, 0xbf6c835e, v40
    v_mul_f32 v47, 0xbec3ef15, v40
    v_fmac_f32 v46, 0x3ec3ef15, v41
    v_fmac_f32 v47, 0xbf6c835e, v41
    v_sub_f32 v40, v80, v48
    v_sub_f32 v41, v81, v49
    v_add_f32 v80, v80, v48
    v_add_f32 v81, v81, v49
    v_sub_f32 v48, v50, v66
    v_sub_f32 v49, v51, v67
    v_add_f32 v50, v50, v66
    v_add_f32 v51, v51, v67
    v_mul_f32 v66, 0x3f6c835e, v48
    v_mul_f32 v67, 0xbec3ef15, v48
    v_fmac_f32 v66, 0x3ec3ef15, v49
    v_fmac_f32 v67, 0x3f6c835e, v49
    v_sub_f32 v48, v52, v68
    v_sub_f32 v49, v53, v69
    v_add_f32 v52, v52, v68
    v_add_f32 v53, v53, v69
    v_mul_f32 v68, 0x3f3504f3, v48
    v_mul_f32 v69, 0xbf3504f3, v48
    v_fmac_f32 v68, 0x3f3504f3, v49
    v_fmac_f32 v69, 0x3f3504f3, v49
    v_sub_f32 v48, v54, v70
    v_sub_f32 v49, v55, v71
    v_add_f32 v54, v54, v70
    v_add_f32 v55, v55, v71
    v_mul_f32 v70, 0x3ec3ef15, v48
    v_mul_f32 v71, 0xbf6c835e, v48
    v_fmac_f32 v70, 0x3f6c835e, v49
    v_fmac_f32 v71, 0x3ec3ef15, v49
    v_sub_f32 v48, v57, v73
    v_sub_f32 v49, v72, v56
    v_add_f32 v56, v56, v72
    v_add_f32 v57, v57, v73
    v_sub_f32 v72, v58, v74
    v_sub_f32 v73, v59, v75
    v_add_f32 v58, v58, v74
    v_add_f32 v59, v59, v75
    v_mul_f32 v74, 0xbec3ef15, v72
    v_mul_f32 v75, 0xbf6c835e, v72
    v_fmac_f32 v74, 0x3f6c835e, v73
    v_fmac_f32 v75, 0xbec3ef15, v73
    v_sub_f32 v72, v60, v76
    v_sub_f32 v73, v61, v77
    v_add_f32 v60, v60, v76
    v_add_f32 v61, v61, v77
    v_mul_f32 v76, 0xbf3504f3, v72
    v_mul_f32 v77, 0xbf3504f3, v72
    v_fmac_f32 v76, 0x3f3504f3, v73
    v_fmac_f32 v77, 0xbf3504f3, v73
    v_sub_f32 v72, v62, v78
    v_sub_f32 v73, v63, v79
    v_add_f32 v62, v62, v78
    v_add_f32 v63, v63, v79
    v_mul_f32 v78, 0xbf6c835e, v72
    v_mul_f32 v79, 0xbec3ef15, v72
    v_fmac_f32 v78, 0x3ec3ef15, v73
    v_fmac_f32 v79, 0xbf6c835e, v73
    v_sub_f32 v72, v16, v24
    v_sub_f32 v73, v17, v25
    v_add_f32 v16, v16, v24
    v_add_f32 v17, v17, v25
    v_sub_f32 v24, v18, v26
    v_sub_f32 v25, v19, v27
    v_add_f32 v18, v18, v26
    v_add_f32 v19, v19, v27
    v_mul_f32 v26, 0x3f3504f3, v24
    v_mul_f32 v27, 0xbf3504f3, v24
    v_fmac_f32 v26, 0x3f3504f3, v25
    v_fmac_f32 v27, 0x3f3504f3, v25
    v_sub_f32 v24, v21, v29
    v_sub_f32 v25, v28, v20
    v_add_f32 v20, v20, v28
    v_add_f32 v21, v21, v29
    v_sub_f32 v28, v22, v30
    v_sub_f32 v29, v23, v31
    v_add_f32 v22, v22, v30
    v_add_f32 v23, v23, v31
    v_mul_f32 v30, 0xbf3504f3, v28
    v_mul_f32 v31, 0xbf3504f3, v28
    v_fmac_f32 v30, 0x3f3504f3, v29
    v_fmac_f32 v31, 0xbf3504f3, v29
    v_sub_f32 v28, v64, v32
    v_sub_f32 v29, v65, v33
    v_add_f32 v64, v64, v32
    v_add_f32 v65, v65, v33
    v_sub_f32 v32, v34, v42
    v_sub_f32 v33, v35, v43
    v_add_f32 v34, v34, v42
    v_add_f32 v35, v35, v43
    v_mul_f32 v42, 0x3f3504f3, v32
    v_mul_f32 v43, 0xbf3504f3, v32
    v_fmac_f32 v42, 0x3f3504f3, v33
    v_fmac_f32 v43, 0x3f3504f3, v33
    v_sub_f32 v32, v37, v45
    v_sub_f32 v33, v44, v36
    v_add_f32 v36, v36, v44
    v_add_f32 v37, v37, v45
    v_sub_f32 v44, v38, v46
    v_sub_f32 v45, v39, v47
    v_add_f32 v38, v38, v46
    v_add_f32 v39, v39, v47
    v_mul_f32 v46, 0xbf3504f3, v44
    v_mul_f32 v47, 0xbf3504f3, v44
    v_fmac_f32 v46, 0x3f3504f3, v45
    v_fmac_f32 v47, 0xbf3504f3, v45
    v_sub_f32 v44, v80, v56
    v_sub_f32 v45, v81, v57
    v_add_f32 v80, v80, v56
    v_add_f32 v81, v81, v57
    v_sub_f32 v56, v50, v58
    v_sub_f32 v57, v51, v59
    v_add_f32 v50, v50, v58
    v_add_f32 v51, v51, v59
    v_mul_f32 v58, 0x3f3504f3, v56
    v_mul_f32 v59, 0xbf3504f3, v56
    v_fmac_f32 v58, 0x3f3504f3, v57
    v_fmac_f32 v59, 0x3f3504f3, v57
    v_sub_f32 v56, v53, v61
    v_sub_f32 v57, v60, v52
    v_add_f32 v52, v52, v60
    v_add_f32 v53, v53, v61
    v_sub_f32 v60, v54, v62
    v_sub_f32 v61, v55, v63
    v_add_f32 v54, v54, v62
    v_add_f32 v55, v55, v63
    v_mul_f32 v62, 0xbf3504f3, v60
    v_mul_f32 v63, 0xbf3504f3, v60
    v_fmac_f32 v62, 0x3f3504f3, v61
    v_fmac_f32 v63, 0xbf3504f3, v61
    v_sub_f32 v60, v40, v48
    v_sub_f32 v61, v41, v49
    v_add_f32 v40, v40, v48
    v_add_f32 v41, v41, v49
    v_sub_f32 v48, v66, v74
    v_sub_f32 v49, v67, v75
    v_add_f32 v66, v66, v74
    v_add_f32 v67, v67, v75
    v_mul_f32 v74, 0x3f3504f3, v48
    v_mul_f32 v75, 0xbf3504f3, v48
    v_fmac_f32 v74, 0x3f3504f3, v49
    v_fmac_f32 v75, 0x3f3504f3, v49
    v_sub_f32 v48, v69, v77
    v_sub_f32 v49, v76, v68
    v_add_f32 v68, v68, v76
    v_add_f32 v69, v69, v77
    v_sub_f32 v76, v70, v78
    v_sub_f32 v77, v71, v79
    v_add_f32 v70, v70, v78
    v_add_f32 v71, v71, v79
    v_mul_f32 v78, 0xbf3504f3, v76
    v_mul_f32 v79, 0xbf3504f3, v76
    v_fmac_f32 v78, 0x3f3504f3, v77
    v_fmac_f32 v79, 0xbf3504f3, v77
    v_sub_f32 v76, v16, v20
    v_sub_f32 v77, v17, v21
    v_add_f32 v16, v16, v20
    v_add_f32 v17, v17, v21
    v_sub_f32 v20, v19, v23
    v_sub_f32 v21, v22, v18
    v_add_f32 v18, v18, v22
    v_add_f32 v19, v19, v23
    v_sub_f32 v22, v72, v24
    v_sub_f32 v23, v73, v25
    v_add_f32 v72, v72, v24
    v_add_f32 v73, v73, v25
    v_sub_f32 v24, v27, v31
    v_sub_f32 v25, v30, v26
    v_add_f32 v26, v26, v30
    v_add_f32 v27, v27, v31
    v_sub_f32 v30, v64, v36
    v_sub_f32 v31, v65, v37
    v_add_f32 v64, v64, v36
    v_add_f32 v65, v65, v37
    v_sub_f32 v36, v35, v39
    v_sub_f32 v37, v38, v34
    v_add_f32 v34, v34, v38
    v_add_f32 v35, v35, v39
    v_sub_f32 v38, v28, v32
    v_sub_f32 v39, v29, v33
    v_add_f32 v28, v28, v32
    v_add_f32 v29, v29, v33
    v_sub_f32 v32, v43, v47
    v_sub_f32 v33, v46, v42
    v_add_f32 v42, v42, v46
    v_add_f32 v43, v43, v47
    v_sub_f32 v46, v80, v52
    v_sub_f32 v47, v81, v53
    v_add_f32 v80, v80, v52
    v_add_f32 v81, v81, v53
    v_sub_f32 v52, v51, v55
    v_sub_f32 v53, v54, v50
    v_add_f32 v50, v50, v54
    v_add_f32 v51, v51, v55
    v_sub_f32 v54, v44, v56
    v_sub_f32 v55, v45, v57
    v_add_f32 v44, v44, v56
    v_add_f32 v45, v45, v57
    v_sub_f32 v56, v59, v63
    v_sub_f32 v57, v62, v58
    v_add_f32 v58, v58, v62
    v_add_f32 v59, v59, v63
    v_sub_f32 v62, v40, v68
    v_sub_f32 v63, v41, v69
    v_add_f32 v40, v40, v68
    v_add_f32 v41, v41, v69
    v_sub_f32 v68, v67, v71
    v_sub_f32 v69, v70, v66
    v_add_f32 v66, v66, v70
    v_add_f32 v67, v67, v71
    v_sub_f32 v70, v60, v48
    v_sub_f32 v71, v61, v49
    v_add_f32 v60, v60, v48
    v_add_f32 v61, v61, v49
    v_sub_f32 v48, v75, v79
    v_sub_f32 v49, v78, v74
    v_add_f32 v74, v74, v78
    v_add_f32 v75, v75, v79
    v_sub_f32 v78, v16, v18
    v_sub_f32 v79, v17, v19
    v_add_f32 v16, v16, v18
    v_add_f32 v17, v17, v19
    v_sub_f32 v18, v76, v20
    v_sub_f32 v19, v77, v21
    v_add_f32 v76, v76, v20
    v_add_f32 v77, v77, v21
    v_sub_f32 v20, v72, v26
    v_sub_f32 v21, v73, v27
    v_add_f32 v72, v72, v26
    v_add_f32 v73, v73, v27
    v_sub_f32 v26, v22, v24
    v_sub_f32 v27, v23, v25
    v_add_f32 v22, v22, v24
    v_add_f32 v23, v23, v25
    v_sub_f32 v24, v64, v34
    v_sub_f32 v25, v65, v35
    v_add_f32 v64, v64, v34
    v_add_f32 v65, v65, v35
    v_sub_f32 v34, v30, v36
    v_sub_f32 v35, v31, v37
    v_add_f32 v30, v30, v36
    v_add_f32 v31, v31, v37
    v_sub_f32 v36, v28, v42
    v_sub_f32 v37, v29, v43
    v_add_f32 v28, v28, v42
    v_add_f32 v29, v29, v43
    v_sub_f32 v42, v38, v32
    v_sub_f32 v43, v39, v33
    v_add_f32 v38, v38, v32
    v_add_f32 v39, v39, v33
    v_sub_f32 v32, v80, v50
    v_sub_f32 v33, v81, v51
    v_add_f32 v80, v80, v50
    v_add_f32 v81, v81, v51
    v_sub_f32 v50, v46, v52
    v_sub_f32 v51, v47, v53
    v_add_f32 v46, v46, v52
    v_add_f32 v47, v47, v53
    v_sub_f32 v52, v44, v58
    v_sub_f32 v53, v45, v59
    v_add_f32 v44, v44, v58
    v_add_f32 v45, v45, v59
    v_sub_f32 v58, v54, v56
    v_sub_f32 v59, v55, v57
    v_add_f32 v54, v54, v56
    v_add_f32 v55, v55, v57
    v_sub_f32 v56, v40, v66
    v_sub_f32 v57, v41, v67
    v_add_f32 v40, v40, v66
    v_add_f32 v41, v41, v67
    v_sub_f32 v66, v62, v68
    v_sub_f32 v67, v63, v69
    v_add_f32 v62, v62, v68
    v_add_f32 v63, v63, v69
    v_sub_f32 v68, v60, v74
    v_sub_f32 v69, v61, v75
    v_add_f32 v60, v60, v74
    v_add_f32 v61, v61, v75
    v_sub_f32 v74, v70, v48
    v_sub_f32 v75, v71, v49
    v_add_f32 v70, v70, v48
    v_add_f32 v71, v71, v49
    v_mul_f32 v48, 0xba000000, v2
    v_cos_f32 v49, v48
    v_sin_f32 v82, v48
    s_nop 0
    v_mul_f32 v83, v80, v49
    v_fma_f32 v83, -v81, v82, v83
    v_mul_f32 v81, v81, v49
    v_fmac_f32 v81, v80, v82
    v_mul_f32 v48, 0xba800000, v2
    v_cos_f32 v49, v48
    v_sin_f32 v82, v48
    s_nop 0
    v_mul_f32 v80, v64, v49
    v_fma_f32 v80, -v65, v82, v80
    v_mul_f32 v65, v65, v49
    v_fmac_f32 v65, v64, v82
    v_mul_f32 v48, 0xbac00000, v2
    v_cos_f32 v49, v48
    v_sin_f32 v82, v48
    s_nop 0
    v_mul_f32 v64, v40, v49
    v_fma_f32 v64, -v41, v82, v64
    v_mul_f32 v41, v41, v49
    v_fmac_f32 v41, v40, v82
    v_mul_f32 v48, 0xbb000000, v2
    v_cos_f32 v49, v48
    v_sin_f32 v82, v48
    s_nop 0
    v_mul_f32 v40, v72, v49
    v_fma_f32 v40, -v73, v82, v40
    v_mul_f32 v73, v73, v49
    v_fmac_f32 v73, v72, v82
    v_mul_f32 v48, 0xbb200000, v2
    v_cos_f32 v49, v48
    v_sin_f32 v82, v48
    s_nop 0
    v_mul_f32 v72, v44, v49
    v_fma_f32 v72, -v45, v82, v72
    v_mul_f32 v45, v45, v49
    v_fmac_f32 v45, v44, v82
    v_mul_f32 v48, 0xbb400000, v2
    v_cos_f32 v49, v48
    v_sin_f32 v82, v48
    s_nop 0
    v_mul_f32 v44, v28, v49
    v_fma_f32 v44, -v29, v82, v44
    v_mul_f32 v29, v29, v49
    v_fmac_f32 v29, v28, v82
    v_mul_f32 v48, 0xbb600000, v2
    v_cos_f32 v49, v48
    v_sin_f32 v82, v48
    s_nop 0
    v_mul_f32 v28, v60, v49
    v_fma_f32 v28, -v61, v82, v28
    v_mul_f32 v61, v61, v49
    v_fmac_f32 v61, v60, v82
    v_mul_f32 v48, 0xbb800000, v2
    v_cos_f32 v49, v48
    v_sin_f32 v82, v48
    s_nop 0
    v_mul_f32 v60, v76, v49
    v_fma_f32 v60, -v77, v82, v60
    v_mul_f32 v77, v77, v49
    v_fmac_f32 v77, v76, v82
    v_mul_f32 v48, 0xbb900000, v2
    v_cos_f32 v49, v48
    v_sin_f32 v82, v48
    s_nop 0
    v_mul_f32 v76, v46, v49
    v_fma_f32 v76, -v47, v82, v76
    v_mul_f32 v47, v47, v49
    v_fmac_f32 v47, v46, v82
    v_mul_f32 v48, 0xbba00000, v2
    v_cos_f32 v49, v48
    v_sin_f32 v82, v48
    s_nop 0
    v_mul_f32 v46, v30, v49
    v_fma_f32 v46, -v31, v82, v46
    v_mul_f32 v31, v31, v49
    v_fmac_f32 v31, v30, v82
    v_mul_f32 v48, 0xbbb00000, v2
    v_cos_f32 v49, v48
    v_sin_f32 v82, v48
    s_nop 0
    v_mul_f32 v30, v62, v49
    v_fma_f32 v30, -v63, v82, v30
    v_mul_f32 v63, v63, v49
    v_fmac_f32 v63, v62, v82
    v_mul_f32 v48, 0xbbc00000, v2
    v_cos_f32 v49, v48
    v_sin_f32 v82, v48
    s_nop 0
    v_mul_f32 v62, v22, v49
    v_fma_f32 v62, -v23, v82, v62
    v_mul_f32 v23, v23, v49
    v_fmac_f32 v23, v22, v82
    v_mul_f32 v48, 0xbbd00000, v2
    v_cos_f32 v49, v48
    v_sin_f32 v82, v48
    s_nop 0
    v_mul_f32 v22, v54, v49
    v_fma_f32 v22, -v55, v82, v22
    v_mul_f32 v55, v55, v49
    v_fmac_f32 v55, v54, v82
    v_mul_f32 v48, 0xbbe00000, v2
    v_cos_f32 v49, v48
    v_sin_f32 v82, v48
    s_nop 0
    v_mul_f32 v54, v38, v49
    v_fma_f32 v54, -v39, v82, v54
    v_mul_f32 v39, v39, v49
    v_fmac_f32 v39, v38, v82
    v_mul_f32 v48, 0xbbf00000, v2
    v_cos_f32 v49, v48
    v_sin_f32 v82, v48
    s_nop 0
    v_mul_f32 v38, v70, v49
    v_fma_f32 v38, -v71, v82, v38
    v_mul_f32 v71, v71, v49
    v_fmac_f32 v71, v70, v82
    v_mul_f32 v48, 0xbc000000, v2
    v_cos_f32 v49, v48
    v_sin_f32 v82, v48
    s_nop 0
    v_mul_f32 v70, v78, v49
    v_fma_f32 v70, -v79, v82, v70
    v_mul_f32 v79, v79, v49
    v_fmac_f32 v79, v78, v82
    v_mul_f32 v48, 0xbc080000, v2
    v_cos_f32 v49, v48
    v_sin_f32 v82, v48
    s_nop 0
    v_mul_f32 v78, v32, v49
    v_fma_f32 v78, -v33, v82, v78
    v_mul_f32 v33, v33, v49
    v_fmac_f32 v33, v32, v82
    v_mul_f32 v48, 0xbc100000, v2
    v_cos_f32 v49, v48
    v_sin_f32 v82, v48
    s_nop 0
    v_mul_f32 v32, v24, v49
    v_fma_f32 v32, -v25, v82, v32
    v_mul_f32 v25, v25, v49
    v_fmac_f32 v25, v24, v82
    v_mul_f32 v48, 0xbc180000, v2
    v_cos_f32 v49, v48
    v_sin_f32 v82, v48
    s_nop 0
    v_mul_f32 v24, v56, v49
    v_fma_f32 v24, -v57, v82, v24
    v_mul_f32 v57, v57, v49
    v_fmac_f32 v57, v56, v82
    v_mul_f32 v48, 0xbc200000, v2
    v_cos_f32 v49, v48
    v_sin_f32 v82, v48
    s_nop 0
    v_mul_f32 v56, v20, v49
    v_fma_f32 v56, -v21, v82, v56
    v_mul_f32 v21, v21, v49
    v_fmac_f32 v21, v20, v82
    v_mul_f32 v48, 0xbc280000, v2
    v_cos_f32 v49, v48
    v_sin_f32 v82, v48
    s_nop 0
    v_mul_f32 v20, v52, v49
    v_fma_f32 v20, -v53, v82, v20
    v_mul_f32 v53, v53, v49
    v_fmac_f32 v53, v52, v82
    v_mul_f32 v48, 0xbc300000, v2
    v_cos_f32 v49, v48
    v_sin_f32 v82, v48
    s_nop 0
    v_mul_f32 v52, v36, v49
    v_fma_f32 v52, -v37, v82, v52
    v_mul_f32 v37, v37, v49
    v_fmac_f32 v37, v36, v82
    v_mul_f32 v48, 0xbc380000, v2
    v_cos_f32 v49, v48
    v_sin_f32 v82, v48
    s_nop 0
    v_mul_f32 v36, v68, v49
    v_fma_f32 v36, -v69, v82, v36
    v_mul_f32 v69, v69, v49
    v_fmac_f32 v69, v68, v82
    v_mul_f32 v48, 0xbc400000, v2
    v_cos_f32 v49, v48
    v_sin_f32 v82, v48
    s_nop 0
    v_mul_f32 v68, v18, v49
    v_fma_f32 v68, -v19, v82, v68
    v_mul_f32 v19, v19, v49
    v_fmac_f32 v19, v18, v82
    v_mul_f32 v48, 0xbc480000, v2
    v_cos_f32 v49, v48
    v_sin_f32 v82, v48
    s_nop 0
    v_mul_f32 v18, v50, v49
    v_fma_f32 v18, -v51, v82, v18
    v_mul_f32 v51, v51, v49
    v_fmac_f32 v51, v50, v82
    v_mul_f32 v48, 0xbc500000, v2
    v_cos_f32 v49, v48
    v_sin_f32 v82, v48
    s_nop 0
    v_mul_f32 v50, v34, v49
    v_fma_f32 v50, -v35, v82, v50
    v_mul_f32 v35, v35, v49
    v_fmac_f32 v35, v34, v82
    v_mul_f32 v48, 0xbc580000, v2
    v_cos_f32 v49, v48
    v_sin_f32 v82, v48
    s_nop 0
    v_mul_f32 v34, v66, v49
    v_fma_f32 v34, -v67, v82, v34
    v_mul_f32 v67, v67, v49
    v_fmac_f32 v67, v66, v82
    v_mul_f32 v48, 0xbc600000, v2
    v_cos_f32 v49, v48
    v_sin_f32 v82, v48
    s_nop 0
    v_mul_f32 v66, v26, v49
    v_fma_f32 v66, -v27, v82, v66
    v_mul_f32 v27, v27, v49
    v_fmac_f32 v27, v26, v82
    v_mul_f32 v48, 0xbc680000, v2
    v_cos_f32 v49, v48
    v_sin_f32 v82, v48
    s_nop 0
    v_mul_f32 v26, v58, v49
    v_fma_f32 v26, -v59, v82, v26
    v_mul_f32 v59, v59, v49
    v_fmac_f32 v59, v58, v82
    v_mul_f32 v48, 0xbc700000, v2
    v_cos_f32 v49, v48
    v_sin_f32 v82, v48
    s_nop 0
    v_mul_f32 v58, v42, v49
    v_fma_f32 v58, -v43, v82, v58
    v_mul_f32 v43, v43, v49
    v_fmac_f32 v43, v42, v82
    v_mul_f32 v48, 0xbc780000, v2
    v_cos_f32 v49, v48
    v_sin_f32 v82, v48
    s_nop 0
    v_mul_f32 v42, v74, v49
    v_fma_f32 v42, -v75, v82, v42
    v_mul_f32 v75, v75, v49
    v_fmac_f32 v75, v74, v82
    ds_write_b32 v3, v16 offset:0
    ds_write_b32 v3, v17 offset:4
    ds_write_b32 v3, v83 offset:528
    ds_write_b32 v3, v81 offset:532
    ds_write_b32 v3, v80 offset:1056
    ds_write_b32 v3, v65 offset:1060
    ds_write_b32 v3, v64 offset:1584
    ds_write_b32 v3, v41 offset:1588
    ds_write_b32 v3, v40 offset:2112
    ds_write_b32 v3, v73 offset:2116
    ds_write_b32 v3, v72 offset:2640
    ds_write_b32 v3, v45 offset:2644
    ds_write_b32 v3, v44 offset:3168
    ds_write_b32 v3, v29 offset:3172
    ds_write_b32 v3, v28 offset:3696
    ds_write_b32 v3, v61 offset:3700
    ds_write_b32 v3, v60 offset:4224
    ds_write_b32 v3, v77 offset:4228
    ds_write_b32 v3, v76 offset:4752
    ds_write_b32 v3, v47 offset:4756
    ds_write_b32 v3, v46 offset:5280
    ds_write_b32 v3, v31 offset:5284
    ds_write_b32 v3, v30 offset:5808
    ds_write_b32 v3, v63 offset:5812
    ds_write_b32 v3, v62 offset:6336
    ds_write_b32 v3, v23 offset:6340
    ds_write_b32 v3, v22 offset:6864
    ds_write_b32 v3, v55 offset:6868
    ds_write_b32 v3, v54 offset:7392
    ds_write_b32 v3, v39 offset:7396
    ds_write_b32 v3, v38 offset:7920
    ds_write_b32 v3, v71 offset:7924
    ds_write_b32 v3, v70 offset:8448
    ds_write_b32 v3, v79 offset:8452
    ds_write_b32 v3, v78 offset:8976
    ds_write_b32 v3, v33 offset:8980
    ds_write_b32 v3, v32 offset:9504
    ds_write_b32 v3, v25 offset:9508
    ds_write_b32 v3, v24 offset:10032
    ds_write_b32 v3, v57 offset:10036
    ds_write_b32 v3, v56 offset:10560
    ds_write_b32 v3, v21 offset:10564
    ds_write_b32 v3, v20 offset:11088
    ds_write_b32 v3, v53 offset:11092
    ds_write_b32 v3, v52 offset:11616
    ds_write_b32 v3, v37 offset:11620
    ds_write_b32 v3, v36 offset:12144
    ds_write_b32 v3, v69 offset:12148
    ds_write_b32 v3, v68 offset:12672
    ds_write_b32 v3, v19 offset:12676
    ds_write_b32 v3, v18 offset:13200
    ds_write_b32 v3, v51 offset:13204
    ds_write_b32 v3, v50 offset:13728
    ds_write_b32 v3, v35 offset:13732
    ds_write_b32 v3, v34 offset:14256
    ds_write_b32 v3, v67 offset:14260
    ds_write_b32 v3, v66 offset:14784
    ds_write_b32 v3, v27 offset:14788
    ds_write_b32 v3, v26 offset:15312
    ds_write_b32 v3, v59 offset:15316
    ds_write_b32 v3, v58 offset:15840
    ds_write_b32 v3, v43 offset:15844
    ds_write_b32 v3, v42 offset:16368
    ds_write_b32 v3, v75 offset:16372
    s_waitcnt lgkmcnt(0)
    ds_read_b32 v16, v4 offset:0
    ds_read_b32 v17, v4 offset:4
    ds_read_b32 v83, v4 offset:16
    ds_read_b32 v81, v4 offset:20
    ds_read_b32 v80, v4 offset:32
    ds_read_b32 v65, v4 offset:36
    ds_read_b32 v64, v4 offset:48
    ds_read_b32 v41, v4 offset:52
    ds_read_b32 v40, v4 offset:64
    ds_read_b32 v73, v4 offset:68
    ds_read_b32 v72, v4 offset:80
    ds_read_b32 v45, v4 offset:84
    ds_read_b32 v44, v4 offset:96
    ds_read_b32 v29, v4 offset:100
    s_waitcnt lgkmcnt(0)
    ds_read_b32 v28, v4 offset:112
    ds_read_b32 v61, v4 offset:116
    ds_read_b32 v60, v4 offset:128
    ds_read_b32 v77, v4 offset:132
    ds_read_b32 v76, v4 offset:144
    ds_read_b32 v47, v4 offset:148
    ds_read_b32 v46, v4 offset:160
    ds_read_b32 v31, v4 offset:164
    ds_read_b32 v30, v4 offset:176
    ds_read_b32 v63, v4 offset:180
    ds_read_b32 v62, v4 offset:192
    ds_read_b32 v23, v4 offset:196
    ds_read_b32 v22, v4 offset:208
    ds_read_b32 v55, v4 offset:212
    s_waitcnt lgkmcnt(0)
    ds_read_b32 v54, v4 offset:224
    ds_read_b32 v39, v4 offset:228
    ds_read_b32 v38, v4 offset:240
    ds_read_b32 v71, v4 offset:244
    ds_read_b32 v70, v4 offset:256
    ds_read_b32 v79, v4 offset:260
    ds_read_b32 v78, v4 offset:272
    ds_read_b32 v33, v4 offset:276
    ds_read_b32 v32, v4 offset:288
    ds_read_b32 v25, v4 offset:292
    ds_read_b32 v24, v4 offset:304
    ds_read_b32 v57, v4 offset:308
    ds_read_b32 v56, v4 offset:320
    ds_read_b32 v21, v4 offset:324
    s_waitcnt lgkmcnt(0)
    ds_read_b32 v20, v4 offset:336
    ds_read_b32 v53, v4 offset:340
    ds_read_b32 v52, v4 offset:352
    ds_read_b32 v37, v4 offset:356
    ds_read_b32 v36, v4 offset:368
    ds_read_b32 v69, v4 offset:372
    ds_read_b32 v68, v4 offset:384
    ds_read_b32 v19, v4 offset:388
    ds_read_b32 v18, v4 offset:400
    ds_read_b32 v51, v4 offset:404
    ds_read_b32 v50, v4 offset:416
    ds_read_b32 v35, v4 offset:420
    ds_read_b32 v34, v4 offset:432
    ds_read_b32 v67, v4 offset:436
    s_waitcnt lgkmcnt(0)
    ds_read_b32 v66, v4 offset:448
    ds_read_b32 v27, v4 offset:452
    ds_read_b32 v26, v4 offset:464
    ds_read_b32 v59, v4 offset:468
    ds_read_b32 v58, v4 offset:480
    ds_read_b32 v43, v4 offset:484
    ds_read_b32 v42, v4 offset:496
    ds_read_b32 v75, v4 offset:500
    s_waitcnt lgkmcnt(0)
    buffer_load_dword v88, v11, s[8:11], s19 offen offset:0
    buffer_load_dword v89, v11, s[8:11], s19 offen offset:128
    buffer_load_dword v90, v11, s[8:11], s19 offen offset:256
    buffer_load_dword v91, v11, s[8:11], s19 offen offset:384
    buffer_load_dword v92, v11, s[8:11], s19 offen offset:512
    buffer_load_dword v93, v11, s[8:11], s19 offen offset:640
    buffer_load_dword v94, v11, s[8:11], s19 offen offset:768
    buffer_load_dword v95, v11, s[8:11], s19 offen offset:896
    buffer_load_dword v96, v11, s[8:11], s19 offen offset:1024
    buffer_load_dword v97, v11, s[8:11], s19 offen offset:1152
    buffer_load_dword v98, v11, s[8:11], s19 offen offset:1280
    buffer_load_dword v99, v11, s[8:11], s19 offen offset:1408
    buffer_load_dword v100, v11, s[8:11], s19 offen offset:1536
    buffer_load_dword v101, v11, s[8:11], s19 offen offset:1664
    buffer_load_dword v102, v11, s[8:11], s19 offen offset:1792
    buffer_load_dword v103, v11, s[8:11], s19 offen offset:1920
    buffer_load_dword v104, v11, s[8:11], s19 offen offset:2048
    buffer_load_dword v105, v11, s[8:11], s19 offen offset:2176
    buffer_load_dword v106, v11, s[8:11], s19 offen offset:2304
    buffer_load_dword v107, v11, s[8:11], s19 offen offset:2432
    buffer_load_dword v108, v11, s[8:11], s19 offen offset:2560
    buffer_load_dword v109, v11, s[8:11], s19 offen offset:2688
    buffer_load_dword v110, v11, s[8:11], s19 offen offset:2816
    buffer_load_dword v111, v11, s[8:11], s19 offen offset:2944
    buffer_load_dword v112, v11, s[8:11], s19 offen offset:3072
    buffer_load_dword v113, v11, s[8:11], s19 offen offset:3200
    buffer_load_dword v114, v11, s[8:11], s19 offen offset:3328
    buffer_load_dword v115, v11, s[8:11], s19 offen offset:3456
    buffer_load_dword v116, v11, s[8:11], s19 offen offset:3584
    buffer_load_dword v117, v11, s[8:11], s19 offen offset:3712
    buffer_load_dword v118, v11, s[8:11], s19 offen offset:3840
    buffer_load_dword v119, v11, s[8:11], s19 offen offset:3968
    v_sub_f32 v48, v16, v70
    v_sub_f32 v49, v17, v79
    v_add_f32 v16, v16, v70
    v_add_f32 v17, v17, v79
    v_sub_f32 v70, v83, v78
    v_sub_f32 v79, v81, v33
    v_add_f32 v83, v83, v78
    v_add_f32 v81, v81, v33
    v_mul_f32 v78, 0x3f7b14be, v70
    v_mul_f32 v33, 0xbe47c5c2, v70
    v_fmac_f32 v78, 0x3e47c5c2, v79
    v_fmac_f32 v33, 0x3f7b14be, v79
    v_sub_f32 v70, v80, v32
    v_sub_f32 v79, v65, v25
    v_add_f32 v80, v80, v32
    v_add_f32 v65, v65, v25
    v_mul_f32 v32, 0x3f6c835e, v70
    v_mul_f32 v25, 0xbec3ef15, v70
    v_fmac_f32 v32, 0x3ec3ef15, v79
    v_fmac_f32 v25, 0x3f6c835e, v79
    v_sub_f32 v70, v64, v24
    v_sub_f32 v79, v41, v57
    v_add_f32 v64, v64, v24
    v_add_f32 v41, v41, v57
    v_mul_f32 v24, 0x3f54db31, v70
    v_mul_f32 v57, 0xbf0e39da, v70
    v_fmac_f32 v24, 0x3f0e39da, v79
    v_fmac_f32 v57, 0x3f54db31, v79
    v_sub_f32 v70, v40, v56
    v_sub_f32 v79, v73, v21
    v_add_f32 v40, v40, v56
    v_add_f32 v73, v73, v21
    v_mul_f32 v56, 0x3f3504f3, v70
    v_mul_f32 v21, 0xbf3504f3, v70
    v_fmac_f32 v56, 0x3f3504f3, v79
    v_fmac_f32 v21, 0x3f3504f3, v79
    v_sub_f32 v70, v72, v20
    v_sub_f32 v79, v45, v53
    v_add_f32 v72, v72, v20
    v_add_f32 v45, v45, v53
    v_mul_f32 v20, 0x3f0e39da, v70
    v_mul_f32 v53, 0xbf54db31, v70
    v_fmac_f32 v20, 0x3f54db31, v79
    v_fmac_f32 v53, 0x3f0e39da, v79
    v_sub_f32 v70, v44, v52
    v_sub_f32 v79, v29, v37
    v_add_f32 v44, v44, v52
    v_add_f32 v29, v29, v37
    v_mul_f32 v52, 0x3ec3ef15, v70
    v_mul_f32 v37, 0xbf6c835e, v70
    v_fmac_f32 v52, 0x3f6c835e, v79
    v_fmac_f32 v37, 0x3ec3ef15, v79
    v_sub_f32 v70, v28, v36
    v_sub_f32 v79, v61, v69
    v_add_f32 v28, v28, v36
    v_add_f32 v61, v61, v69
    v_mul_f32 v36, 0x3e47c5c2, v70
    v_mul_f32 v69, 0xbf7b14be, v70
    v_fmac_f32 v36, 0x3f7b14be, v79
    v_fmac_f32 v69, 0x3e47c5c2, v79
    v_sub_f32 v70, v77, v19
    v_sub_f32 v79, v68, v60
    v_add_f32 v60, v60, v68
    v_add_f32 v77, v77, v19
    v_sub_f32 v68, v76, v18
    v_sub_f32 v19, v47, v51
    v_add_f32 v76, v76, v18
    v_add_f32 v47, v47, v51
    v_mul_f32 v18, 0xbe47c5c2, v68
    v_mul_f32 v51, 0xbf7b14be, v68
    v_fmac_f32 v18, 0x3f7b14be, v19
    v_fmac_f32 v51, 0xbe47c5c2, v19
    v_sub_f32 v68, v46, v50
    v_sub_f32 v19, v31, v35
    v_add_f32 v46, v46, v50
    v_add_f32 v31, v31, v35
    v_mul_f32 v50, 0xbec3ef15, v68
    v_mul_f32 v35, 0xbf6c835e, v68
    v_fmac_f32 v50, 0x3f6c835e, v19
    v_fmac_f32 v35, 0xbec3ef15, v19
    v_sub_f32 v68, v30, v34
    v_sub_f32 v19, v63, v67
    v_add_f32 v30, v30, v34
    v_add_f32 v63, v63, v67
    v_mul_f32 v34, 0xbf0e39da, v68
    v_mul_f32 v67, 0xbf54db31, v68
    v_fmac_f32 v34, 0x3f54db31, v19
    v_fmac_f32 v67, 0xbf0e39da, v19
    v_sub_f32 v68, v62, v66
    v_sub_f32 v19, v23, v27
    v_add_f32 v62, v62, v66
    v_add_f32 v23, v23, v27
    v_mul_f32 v66, 0xbf3504f3, v68
    v_mul_f32 v27, 0xbf3504f3, v68
    v_fmac_f32 v66, 0x3f3504f3, v19
    v_fmac_f32 v27, 0xbf3504f3, v19
    v_sub_f32 v68, v22, v26
    v_sub_f32 v19, v55, v59
    v_add_f32 v22, v22, v26
    v_add_f32 v55, v55, v59
    v_mul_f32 v26, 0xbf54db31, v68
    v_mul_f32 v59, 0xbf0e39da, v68
    v_fmac_f32 v26, 0x3f0e39da, v19
    v_fmac_f32 v59, 0xbf54db31, v19
    v_sub_f32 v68, v54, v58
    v_sub_f32 v19, v39, v43
    v_add_f32 v54, v54, v58
    v_add_f32 v39, v39, v43
    v_mul_f32 v58, 0xbf6c835e, v68
    v_mul_f32 v43, 0xbec3ef15, v68
    v_fmac_f32 v58, 0x3ec3ef15, v19
    v_fmac_f32 v43, 0xbf6c835e, v19
    v_sub_f32 v68, v38, v42
    v_sub_f32 v19, v71, v75
    v_add_f32 v38, v38, v42
    v_add_f32 v71, v71, v75
    v_mul_f32 v42, 0xbf7b14be, v68
    v_mul_f32 v75, 0xbe47c5c2, v68
    v_fmac_f32 v42, 0x3e47c5c2, v19
    v_fmac_f32 v75, 0xbf7b14be, v19
    v_sub_f32 v68, v16, v60
    v_sub_f32 v19, v17, v77
    v_add_f32 v16, v16, v60
    v_add_f32 v17, v17, v77
    v_sub_f32 v60, v83, v76
    v_sub_f32 v77, v81, v47
    v_add_f32 v83, v83, v76
    v_add_f32 v81, v81, v47
    v_mul_f32 v76, 0x3f6c835e, v60
    v_mul_f32 v47, 0xbec3ef15, v60
    v_fmac_f32 v76, 0x3ec3ef15, v77
    v_fmac_f32 v47, 0x3f6c835e, v77
    v_sub_f32 v60, v80, v46
    v_sub_f32 v77, v65, v31
    v_add_f32 v80, v80, v46
    v_add_f32 v65, v65, v31
    v_mul_f32 v46, 0x3f3504f3, v60
    v_mul_f32 v31, 0xbf3504f3, v60
    v_fmac_f32 v46, 0x3f3504f3, v77
    v_fmac_f32 v31, 0x3f3504f3, v77
    v_sub_f32 v60, v64, v30
    v_sub_f32 v77, v41, v63
    v_add_f32 v64, v64, v30
    v_add_f32 v41, v41, v63
    v_mul_f32 v30, 0x3ec3ef15, v60
    v_mul_f32 v63, 0xbf6c835e, v60
    v_fmac_f32 v30, 0x3f6c835e, v77
    v_fmac_f32 v63, 0x3ec3ef15, v77
    v_sub_f32 v60, v73, v23
    v_sub_f32 v77, v62, v40
    v_add_f32 v40, v40, v62
    v_add_f32 v73, v73, v23
    v_sub_f32 v62, v72, v22
    v_sub_f32 v23, v45, v55
    v_add_f32 v72, v72, v22
    v_add_f32 v45, v45, v55
    v_mul_f32 v22, 0xbec3ef15, v62
    v_mul_f32 v55, 0xbf6c835e, v62
    v_fmac_f32 v22, 0x3f6c835e, v23
    v_fmac_f32 v55, 0xbec3ef15, v23
    v_sub_f32 v62, v44, v54
    v_sub_f32 v23, v29, v39
    v_add_f32 v44, v44, v54
    v_add_f32 v29, v29, v39
    v_mul_f32 v54, 0xbf3504f3, v62
    v_mul_f32 v39, 0xbf3504f3, v62
    v_fmac_f32 v54, 0x3f3504f3, v23
    v_fmac_f32 v39, 0xbf3504f3, v23
    v_sub_f32 v62, v28, v38
    v_sub_f32 v23, v61, v71
    v_add_f32 v28, v28, v38
    v_add_f32 v61, v61, v71
    v_mul_f32 v38, 0xbf6c835e, v62
    v_mul_f32 v71, 0xbec3ef15, v62
    v_fmac_f32 v38, 0x3ec3ef15, v23
    v_fmac_f32 v71, 0xbf6c835e, v23
    v_sub_f32 v62, v48, v70
    v_sub_f32 v23, v49, v79
    v_add_f32 v48, v48, v70
    v_add_f32 v49, v49, v79
    v_sub_f32 v70, v78, v18
    v_sub_f32 v79, v33, v51
    v_add_f32 v78, v78, v18
    v_add_f32 v33, v33, v51
    v_mul_f32 v18, 0x3f6c835e, v70
    v_mul_f32 v51, 0xbec3ef15, v70
    v_fmac_f32 v18, 0x3ec3ef15, v79
    v_fmac_f32 v51, 0x3f6c835e, v79
    v_sub_f32 v70, v32, v50
    v_sub_f32 v79, v25, v35
    v_add_f32 v32, v32, v50
    v_add_f32 v25, v25, v35
    v_mul_f32 v50, 0x3f3504f3, v70
    v_mul_f32 v35, 0xbf3504f3, v70
    v_fmac_f32 v50, 0x3f3504f3, v79
    v_fmac_f32 v35, 0x3f3504f3, v79
    v_sub_f32 v70, v24, v34
    v_sub_f32 v79, v57, v67
    v_add_f32 v24, v24, v34
    v_add_f32 v57, v57, v67
    v_mul_f32 v34, 0x3ec3ef15, v70
    v_mul_f32 v67, 0xbf6c835e, v70
    v_fmac_f32 v34, 0x3f6c835e, v79
    v_fmac_f32 v67, 0x3ec3ef15, v79
    v_sub_f32 v70, v21, v27
    v_sub_f32 v79, v66, v56
    v_add_f32 v56, v56, v66
    v_add_f32 v21, v21, v27
    v_sub_f32 v66, v20, v26
    v_sub_f32 v27, v53, v59
    v_add_f32 v20, v20, v26
    v_add_f32 v53, v53, v59
    v_mul_f32 v26, 0xbec3ef15, v66
    v_mul_f32 v59, 0xbf6c835e, v66
    v_fmac_f32 v26, 0x3f6c835e, v27
    v_fmac_f32 v59, 0xbec3ef15, v27
    v_sub_f32 v66, v52, v58
    v_sub_f32 v27, v37, v43
    v_add_f32 v52, v52, v58
    v_add_f32 v37, v37, v43
    v_mul_f32 v58, 0xbf3504f3, v66
    v_mul_f32 v43, 0xbf3504f3, v66
    v_fmac_f32 v58, 0x3f3504f3, v27
    v_fmac_f32 v43, 0xbf3504f3, v27
    v_sub_f32 v66, v36, v42
    v_sub_f32 v27, v69, v75
    v_add_f32 v36, v36, v42
    v_add_f32 v69, v69, v75
    v_mul_f32 v42, 0xbf6c835e, v66
    v_mul_f32 v75, 0xbec3ef15, v66
    v_fmac_f32 v42, 0x3ec3ef15, v27
    v_fmac_f32 v75, 0xbf6c835e, v27
    v_sub_f32 v66, v16, v40
    v_sub_f32 v27, v17, v73
    v_add_f32 v16, v16, v40
    v_add_f32 v17, v17, v73
    v_sub_f32 v40, v83, v72
    v_sub_f32 v73, v81, v45
    v_add_f32 v83, v83, v72
    v_add_f32 v81, v81, v45
    v_mul_f32 v72, 0x3f3504f3, v40
    v_mul_f32 v45, 0xbf3504f3, v40
    v_fmac_f32 v72, 0x3f3504f3, v73
    v_fmac_f32 v45, 0x3f3504f3, v73
    v_sub_f32 v40, v65, v29
    v_sub_f32 v73, v44, v80
    v_add_f32 v80, v80, v44
    v_add_f32 v65, v65, v29
    v_sub_f32 v44, v64, v28
    v_sub_f32 v29, v41, v61
    v_add_f32 v64, v64, v28
    v_add_f32 v41, v41, v61
    v_mul_f32 v28, 0xbf3504f3, v44
    v_mul_f32 v61, 0xbf3504f3, v44
    v_fmac_f32 v28, 0x3f3504f3, v29
    v_fmac_f32 v61, 0xbf3504f3, v29
    v_sub_f32 v44, v68, v60
    v_sub_f32 v29, v19, v77
    v_add_f32 v68, v68, v60
    v_add_f32 v19, v19, v77
    v_sub_f32 v60, v76, v22
    v_sub_f32 v77, v47, v55
    v_add_f32 v76, v76, v22
    v_add_f32 v47, v47, v55
    v_mul_f32 v22, 0x3f3504f3, v60
    v_mul_f32 v55, 0xbf3504f3, v60
    v_fmac_f32 v22, 0x3f3504f3, v77
    v_fmac_f32 v55, 0x3f3504f3, v77
    v_sub_f32 v60, v31, v39
    v_sub_f32 v77, v54, v46
    v_add_f32 v46, v46, v54
    v_add_f32 v31, v31, v39
    v_sub_f32 v54, v30, v38
    v_sub_f32 v39, v63, v71
    v_add_f32 v30, v30, v38
    v_add_f32 v63, v63, v71
    v_mul_f32 v38, 0xbf3504f3, v54
    v_mul_f32 v71, 0xbf3504f3, v54
    v_fmac_f32 v38, 0x3f3504f3, v39
    v_fmac_f32 v71, 0xbf3504f3, v39
    v_sub_f32 v54, v48, v56
    v_sub_f32 v39, v49, v21
    v_add_f32 v48, v48, v56
    v_add_f32 v49, v49, v21
    v_sub_f32 v56, v78, v20
    v_sub_f32 v21, v33, v53
    v_add_f32 v78, v78, v20
    v_add_f32 v33, v33, v53
    v_mul_f32 v20, 0x3f3504f3, v56
    v_mul_f32 v53, 0xbf3504f3, v56
    v_fmac_f32 v20, 0x3f3504f3, v21
    v_fmac_f32 v53, 0x3f3504f3, v21
    v_sub_f32 v56, v25, v37
    v_sub_f32 v21, v52, v32
    v_add_f32 v32, v32, v52
    v_add_f32 v25, v25, v37
    v_sub_f32 v52, v24, v36
    v_sub_f32 v37, v57, v69
    v_add_f32 v24, v24, v36
    v_add_f32 v57, v57, v69
    v_mul_f32 v36, 0xbf3504f3, v52
    v_mul_f32 v69, 0xbf3504f3, v52
    v_fmac_f32 v36, 0x3f3504f3, v37
    v_fmac_f32 v69, 0xbf3504f3, v37
    v_sub_f32 v52, v62, v70
    v_sub_f32 v37, v23, v79
    v_add_f32 v62, v62, v70
    v_add_f32 v23, v23, v79
    v_sub_f32 v70, v18, v26
    v_sub_f32 v79, v51, v59
    v_add_f32 v18, v18, v26
    v_add_f32 v51, v51, v59
    v_mul_f32 v26, 0x3f3504f3, v70
    v_mul_f32 v59, 0xbf3504f3, v70
    v_fmac_f32 v26, 0x3f3504f3, v79
    v_fmac_f32 v59, 0x3f3504f3, v79
    v_sub_f32 v70, v35, v43
    v_sub_f32 v79, v58, v50
    v_add_f32 v50, v50, v58
    v_add_f32 v35, v35, v43
    v_sub_f32 v58, v34, v42
    v_sub_f32 v43, v67, v75
    v_add_f32 v34, v34, v42
    v_add_f32 v67, v67, v75
    v_mul_f32 v42, 0xbf3504f3, v58
    v_mul_f32 v75, 0xbf3504f3, v58
    v_fmac_f32 v42, 0x3f3504f3, v43
    v_fmac_f32 v75, 0xbf3504f3, v43
    v_sub_f32 v58, v16, v80
    v_sub_f32 v43, v17, v65
    v_add_f32 v16, v16, v80
    v_add_f32 v17, v17, v65
    v_sub_f32 v80, v81, v41
    v_sub_f32 v65, v64, v83
    v_add_f32 v83, v83, v64
    v_add_f32 v81, v81, v41
    v_sub_f32 v64, v66, v40
    v_sub_f32 v41, v27, v73
    v_add_f32 v66, v66, v40
    v_add_f32 v27, v27, v73
    v_sub_f32 v40, v45, v61
    v_sub_f32 v73, v28, v72
    v_add_f32 v72, v72, v28
    v_add_f32 v45, v45, v61
    v_sub_f32 v28, v68, v46
    v_sub_f32 v61, v19, v31
    v_add_f32 v68, v68, v46
    v_add_f32 v19, v19, v31
    v_sub_f32 v46, v47, v63
    v_sub_f32 v31, v30, v76
    v_add_f32 v76, v76, v30
    v_add_f32 v47, v47, v63
    v_sub_f32 v30, v44, v60
    v_sub_f32 v63, v29, v77
    v_add_f32 v44, v44, v60
    v_add_f32 v29, v29, v77
    v_sub_f32 v60, v55, v71
    v_sub_f32 v77, v38, v22
    v_add_f32 v22, v22, v38
    v_add_f32 v55, v55, v71
    v_sub_f32 v38, v48, v32
    v_sub_f32 v71, v49, v25
    v_add_f32 v48, v48, v32
    v_add_f32 v49, v49, v25
    v_sub_f32 v32, v33, v57
    v_sub_f32 v25, v24, v78
    v_add_f32 v78, v78, v24
    v_add_f32 v33, v33, v57
    v_sub_f32 v24, v54, v56
    v_sub_f32 v57, v39, v21
    v_add_f32 v54, v54, v56
    v_add_f32 v39, v39, v21
    v_sub_f32 v56, v53, v69
    v_sub_f32 v21, v36, v20
    v_add_f32 v20, v20, v36
    v_add_f32 v53, v53, v69
    v_sub_f32 v36, v62, v50
    v_sub_f32 v69, v23, v35
    v_add_f32 v62, v62, v50
    v_add_f32 v23, v23, v35
    v_sub_f32 v50, v51, v67
    v_sub_f32 v35, v34, v18
    v_add_f32 v18, v18, v34
    v_add_f32 v51, v51, v67
    v_sub_f32 v34, v52, v70
    v_sub_f32 v67, v37, v79
    v_add_f32 v52, v52, v70
    v_add_f32 v37, v37, v79
    v_sub_f32 v70, v59, v75
    v_sub_f32 v79, v42, v26
    v_add_f32 v26, v26, v42
    v_add_f32 v59, v59, v75
    v_sub_f32 v42, v16, v83
    v_sub_f32 v75, v17, v81
    v_add_f32 v16, v16, v83
    v_add_f32 v17, v17, v81
    v_sub_f32 v83, v58, v80
    v_sub_f32 v81, v43, v65
    v_add_f32 v58, v58, v80
    v_add_f32 v43, v43, v65
    v_sub_f32 v80, v66, v72
    v_sub_f32 v65, v27, v45
    v_add_f32 v66, v66, v72
    v_add_f32 v27, v27, v45
    v_sub_f32 v72, v64, v40
    v_sub_f32 v45, v41, v73
    v_add_f32 v64, v64, v40
    v_add_f32 v41, v41, v73
    v_sub_f32 v40, v68, v76
    v_sub_f32 v73, v19, v47
    v_add_f32 v68, v68, v76
    v_add_f32 v19, v19, v47
    v_sub_f32 v76, v28, v46
    v_sub_f32 v47, v61, v31
    v_add_f32 v28, v28, v46
    v_add_f32 v61, v61, v31
    v_sub_f32 v46, v44, v22
    v_sub_f32 v31, v29, v55
    v_add_f32 v44, v44, v22
    v_add_f32 v29, v29, v55
    v_sub_f32 v22, v30, v60
    v_sub_f32 v55, v63, v77
    v_add_f32 v30, v30, v60
    v_add_f32 v63, v63, v77
    v_sub_f32 v60, v48, v78
    v_sub_f32 v77, v49, v33
    v_add_f32 v48, v48, v78
    v_add_f32 v49, v49, v33
    v_sub_f32 v78, v38, v32
    v_sub_f32 v33, v71, v25
    v_add_f32 v38, v38, v32
    v_add_f32 v71, v71, v25
    v_sub_f32 v32, v54, v20
    v_sub_f32 v25, v39, v53
    v_add_f32 v54, v54, v20
    v_add_f32 v39, v39, v53
    v_sub_f32 v20, v24, v56
    v_sub_f32 v53, v57, v21
    v_add_f32 v24, v24, v56
    v_add_f32 v57, v57, v21
    v_sub_f32 v56, v62, v18
    v_sub_f32 v21, v23, v51
    v_add_f32 v62, v62, v18
    v_add_f32 v23, v23, v51
    v_sub_f32 v18, v36, v50
    v_sub_f32 v51, v69, v35
    v_add_f32 v36, v36, v50
    v_add_f32 v69, v69, v35
    v_sub_f32 v50, v52, v26
    v_sub_f32 v35, v37, v59
    v_add_f32 v52, v52, v26
    v_add_f32 v37, v37, v59
    v_sub_f32 v26, v34, v70
    v_sub_f32 v59, v67, v79
    v_add_f32 v34, v34, v70
    v_add_f32 v67, v67, v79
    v_mul_f32 v70, 0xbc800000, v10
    v_cos_f32 v79, v70
    v_sin_f32 v82, v70
    s_nop 0
    v_mul_f32 v74, v48, v79
    v_fma_f32 v74, -v49, v82, v74
    v_mul_f32 v49, v49, v79
    v_fmac_f32 v49, v48, v82
    v_mul_f32 v70, 0xbd000000, v10
    v_cos_f32 v79, v70
    v_sin_f32 v82, v70
    s_nop 0
    v_mul_f32 v48, v68, v79
    v_fma_f32 v48, -v19, v82, v48
    v_mul_f32 v19, v19, v79
    v_fmac_f32 v19, v68, v82
    v_mul_f32 v70, 0xbd400000, v10
    v_cos_f32 v79, v70
    v_sin_f32 v82, v70
    s_nop 0
    v_mul_f32 v68, v62, v79
    v_fma_f32 v68, -v23, v82, v68
    v_mul_f32 v23, v23, v79
    v_fmac_f32 v23, v62, v82
    v_mul_f32 v70, 0xbd800000, v10
    v_cos_f32 v79, v70
    v_sin_f32 v82, v70
    s_nop 0
    v_mul_f32 v62, v66, v79
    v_fma_f32 v62, -v27, v82, v62
    v_mul_f32 v27, v27, v79
    v_fmac_f32 v27, v66, v82
    v_mul_f32 v70, 0xbda00000, v10
    v_cos_f32 v79, v70
    v_sin_f32 v82, v70
    s_nop 0
    v_mul_f32 v66, v54, v79
    v_fma_f32 v66, -v39, v82, v66
    v_mul_f32 v39, v39, v79
    v_fmac_f32 v39, v54, v82
    v_mul_f32 v70, 0xbdc00000, v10
    v_cos_f32 v79, v70
    v_sin_f32 v82, v70
    s_nop 0
    v_mul_f32 v54, v44, v79
    v_fma_f32 v54, -v29, v82, v54
    v_mul_f32 v29, v29, v79
    v_fmac_f32 v29, v44, v82
    v_mul_f32 v70, 0xbde00000, v10
    v_cos_f32 v79, v70
    v_sin_f32 v82, v70
    s_nop 0
    v_mul_f32 v44, v52, v79
    v_fma_f32 v44, -v37, v82, v44
    v_mul_f32 v37, v37, v79
    v_fmac_f32 v37, v52, v82
    v_mul_f32 v70, 0xbe000000, v10
    v_cos_f32 v79, v70
    v_sin_f32 v82, v70
    s_nop 0
    v_mul_f32 v52, v58, v79
    v_fma_f32 v52, -v43, v82, v52
    v_mul_f32 v43, v43, v79
    v_fmac_f32 v43, v58, v82
    v_mul_f32 v70, 0xbe100000, v10
    v_cos_f32 v79, v70
    v_sin_f32 v82, v70
    s_nop 0
    v_mul_f32 v58, v38, v79
    v_fma_f32 v58, -v71, v82, v58
    v_mul_f32 v71, v71, v79
    v_fmac_f32 v71, v38, v82
    v_mul_f32 v70, 0xbe200000, v10
    v_cos_f32 v79, v70
    v_sin_f32 v82, v70
    s_nop 0
    v_mul_f32 v38, v28, v79
    v_fma_f32 v38, -v61, v82, v38
    v_mul_f32 v61, v61, v79
    v_fmac_f32 v61, v28, v82
    v_mul_f32 v70, 0xbe300000, v10
    v_cos_f32 v79, v70
    v_sin_f32 v82, v70
    s_nop 0
    v_mul_f32 v28, v36, v79
    v_fma_f32 v28, -v69, v82, v28
    v_mul_f32 v69, v69, v79
    v_fmac_f32 v69, v36, v82
    v_mul_f32 v70, 0xbe400000, v10
    v_cos_f32 v79, v70
    v_sin_f32 v82, v70
    s_nop 0
    v_mul_f32 v36, v64, v79
    v_fma_f32 v36, -v41, v82, v36
    v_mul_f32 v41, v41, v79
    v_fmac_f32 v41, v64, v82
    v_mul_f32 v70, 0xbe500000, v10
    v_cos_f32 v79, v70
    v_sin_f32 v82, v70
    s_nop 0
    v_mul_f32 v64, v24, v79
    v_fma_f32 v64, -v57, v82, v64
    v_mul_f32 v57, v57, v79
    v_fmac_f32 v57, v24, v82
    v_mul_f32 v70, 0xbe600000, v10
    v_cos_f32 v79, v70
    v_sin_f32 v82, v70
    s_nop 0
    v_mul_f32 v24, v30, v79
    v_fma_f32 v24, -v63, v82, v24
    v_mul_f32 v63, v63, v79
    v_fmac_f32 v63, v30, v82
    v_mul_f32 v70, 0xbe700000, v10
    v_cos_f32 v79, v70
    v_sin_f32 v82, v70
    s_nop 0
    v_mul_f32 v30, v34, v79
    v_fma_f32 v30, -v67, v82, v30
    v_mul_f32 v67, v67, v79
    v_fmac_f32 v67, v34, v82
    v_mul_f32 v70, 0xbe800000, v10
    v_cos_f32 v79, v70
    v_sin_f32 v82, v70
    s_nop 0
    v_mul_f32 v34, v42, v79
    v_fma_f32 v34, -v75, v82, v34
    v_mul_f32 v75, v75, v79
    v_fmac_f32 v75, v42, v82
    v_mul_f32 v70, 0xbe880000, v10
    v_cos_f32 v79, v70
    v_sin_f32 v82, v70
    s_nop 0
    v_mul_f32 v42, v60, v79
    v_fma_f32 v42, -v77, v82, v42
    v_mul_f32 v77, v77, v79
    v_fmac_f32 v77, v60, v82
    v_mul_f32 v70, 0xbe900000, v10
    v_cos_f32 v79, v70
    v_sin_f32 v82, v70
    s_nop 0
    v_mul_f32 v60, v40, v79
    v_fma_f32 v60, -v73, v82, v60
    v_mul_f32 v73, v73, v79
    v_fmac_f32 v73, v40, v82
    v_mul_f32 v70, 0xbe980000, v10
    v_cos_f32 v79, v70
    v_sin_f32 v82, v70
    s_nop 0
    v_mul_f32 v40, v56, v79
    v_fma_f32 v40, -v21, v82, v40
    v_mul_f32 v21, v21, v79
    v_fmac_f32 v21, v56, v82
    v_mul_f32 v70, 0xbea00000, v10
    v_cos_f32 v79, v70
    v_sin_f32 v82, v70
    s_nop 0
    v_mul_f32 v56, v80, v79
    v_fma_f32 v56, -v65, v82, v56
    v_mul_f32 v65, v65, v79
    v_fmac_f32 v65, v80, v82
    v_mul_f32 v70, 0xbea80000, v10
    v_cos_f32 v79, v70
    v_sin_f32 v82, v70
    s_nop 0
    v_mul_f32 v80, v32, v79
    v_fma_f32 v80, -v25, v82, v80
    v_mul_f32 v25, v25, v79
    v_fmac_f32 v25, v32, v82
    v_mul_f32 v70, 0xbeb00000, v10
    v_cos_f32 v79, v70
    v_sin_f32 v82, v70
    s_nop 0
    v_mul_f32 v32, v46, v79
    v_fma_f32 v32, -v31, v82, v32
    v_mul_f32 v31, v31, v79
    v_fmac_f32 v31, v46, v82
    v_mul_f32 v70, 0xbeb80000, v10
    v_cos_f32 v79, v70
    v_sin_f32 v82, v70
    s_nop 0
    v_mul_f32 v46, v50, v79
    v_fma_f32 v46, -v35, v82, v46
    v_mul_f32 v35, v35, v79
    v_fmac_f32 v35, v50, v82
    v_mul_f32 v70, 0xbec00000, v10
    v_cos_f32 v79, v70
    v_sin_f32 v82, v70
    s_nop 0
    v_mul_f32 v50, v83, v79
    v_fma_f32 v50, -v81, v82, v50
    v_mul_f32 v81, v81, v79
    v_fmac_f32 v81, v83, v82
    v_mul_f32 v70, 0xbec80000, v10
    v_cos_f32 v79, v70
    v_sin_f32 v82, v70
    s_nop 0
    v_mul_f32 v83, v78, v79
    v_fma_f32 v83, -v33, v82, v83
    v_mul_f32 v33, v33, v79
    v_fmac_f32 v33, v78, v82
    v_mul_f32 v70, 0xbed00000, v10
    v_cos_f32 v79, v70
    v_sin_f32 v82, v70
    s_nop 0
    v_mul_f32 v78, v76, v79
    v_fma_f32 v78, -v47, v82, v78
    v_mul_f32 v47, v47, v79
    v_fmac_f32 v47, v76, v82
    v_mul_f32 v70, 0xbed80000, v10
    v_cos_f32 v79, v70
    v_sin_f32 v82, v70
    s_nop 0
    v_mul_f32 v76, v18, v79
    v_fma_f32 v76, -v51, v82, v76
    v_mul_f32 v51, v51, v79
    v_fmac_f32 v51, v18, v82
    v_mul_f32 v70, 0xbee00000, v10
    v_cos_f32 v79, v70
    v_sin_f32 v82, v70
    s_nop 0
    v_mul_f32 v18, v72, v79
    v_fma_f32 v18, -v45, v82, v18
    v_mul_f32 v45, v45, v79
    v_fmac_f32 v45, v72, v82
    v_mul_f32 v70, 0xbee80000, v10
    v_cos_f32 v79, v70
    v_sin_f32 v82, v70
    s_nop 0
    v_mul_f32 v72, v20, v79
    v_fma_f32 v72, -v53, v82, v72
    v_mul_f32 v53, v53, v79
    v_fmac_f32 v53, v20, v82
    v_mul_f32 v70, 0xbef00000, v10
    v_cos_f32 v79, v70
    v_sin_f32 v82, v70
    s_nop 0
    v_mul_f32 v20, v22, v79
    v_fma_f32 v20, -v55, v82, v20
    v_mul_f32 v55, v55, v79
    v_fmac_f32 v55, v22, v82
    v_mul_f32 v70, 0xbef80000, v10
    v_cos_f32 v79, v70
    v_sin_f32 v82, v70
    s_nop 0
    v_mul_f32 v22, v26, v79
    v_fma_f32 v22, -v59, v82, v22
    v_mul_f32 v59, v59, v79
    v_fmac_f32 v59, v26, v82
    s_nop 1
    v_mov_b32_dpp v70, v16 quad_perm:[1,0,3,2] row_mask:0xf bank_mask:0xf
    v_fma_f32 v16, v16, v9, v70
    v_mov_b32_dpp v70, v17 quad_perm:[1,0,3,2] row_mask:0xf bank_mask:0xf
    v_fma_f32 v17, v17, v9, v70
    v_mov_b32_dpp v70, v74 quad_perm:[1,0,3,2] row_mask:0xf bank_mask:0xf
    v_fma_f32 v74, v74, v9, v70
    v_mov_b32_dpp v70, v49 quad_perm:[1,0,3,2] row_mask:0xf bank_mask:0xf
    v_fma_f32 v49, v49, v9, v70
    v_mov_b32_dpp v70, v48 quad_perm:[1,0,3,2] row_mask:0xf bank_mask:0xf
    v_fma_f32 v48, v48, v9, v70
    v_mov_b32_dpp v70, v19 quad_perm:[1,0,3,2] row_mask:0xf bank_mask:0xf
    v_fma_f32 v19, v19, v9, v70
    v_mov_b32_dpp v70, v68 quad_perm:[1,0,3,2] row_mask:0xf bank_mask:0xf
    v_fma_f32 v68, v68, v9, v70
    v_mov_b32_dpp v70, v23 quad_perm:[1,0,3,2] row_mask:0xf bank_mask:0xf
    v_fma_f32 v23, v23, v9, v70
    v_mov_b32_dpp v70, v62 quad_perm:[1,0,3,2] row_mask:0xf bank_mask:0xf
    v_fma_f32 v62, v62, v9, v70
    v_mov_b32_dpp v70, v27 quad_perm:[1,0,3,2] row_mask:0xf bank_mask:0xf
    v_fma_f32 v27, v27, v9, v70
    v_mov_b32_dpp v70, v66 quad_perm:[1,0,3,2] row_mask:0xf bank_mask:0xf
    v_fma_f32 v66, v66, v9, v70
    v_mov_b32_dpp v70, v39 quad_perm:[1,0,3,2] row_mask:0xf bank_mask:0xf
    v_fma_f32 v39, v39, v9, v70
    v_mov_b32_dpp v70, v54 quad_perm:[1,0,3,2] row_mask:0xf bank_mask:0xf
    v_fma_f32 v54, v54, v9, v70
    v_mov_b32_dpp v70, v29 quad_perm:[1,0,3,2] row_mask:0xf bank_mask:0xf
    v_fma_f32 v29, v29, v9, v70
    v_mov_b32_dpp v70, v44 quad_perm:[1,0,3,2] row_mask:0xf bank_mask:0xf
    v_fma_f32 v44, v44, v9, v70
    v_mov_b32_dpp v70, v37 quad_perm:[1,0,3,2] row_mask:0xf bank_mask:0xf
    v_fma_f32 v37, v37, v9, v70
    v_mov_b32_dpp v70, v52 quad_perm:[1,0,3,2] row_mask:0xf bank_mask:0xf
    v_fma_f32 v52, v52, v9, v70
    v_mov_b32_dpp v70, v43 quad_perm:[1,0,3,2] row_mask:0xf bank_mask:0xf
    v_fma_f32 v43, v43, v9, v70
    v_mov_b32_dpp v70, v58 quad_perm:[1,0,3,2] row_mask:0xf bank_mask:0xf
    v_fma_f32 v58, v58, v9, v70
    v_mov_b32_dpp v70, v71 quad_perm:[1,0,3,2] row_mask:0xf bank_mask:0xf
    v_fma_f32 v71, v71, v9, v70
    v_mov_b32_dpp v70, v38 quad_perm:[1,0,3,2] row_mask:0xf bank_mask:0xf
    v_fma_f32 v38, v38, v9, v70
    v_mov_b32_dpp v70, v61 quad_perm:[1,0,3,2] row_mask:0xf bank_mask:0xf
    v_fma_f32 v61, v61, v9, v70
    v_mov_b32_dpp v70, v28 quad_perm:[1,0,3,2] row_mask:0xf bank_mask:0xf
    v_fma_f32 v28, v28, v9, v70
    v_mov_b32_dpp v70, v69 quad_perm:[1,0,3,2] row_mask:0xf bank_mask:0xf
    v_fma_f32 v69, v69, v9, v70
    v_mov_b32_dpp v70, v36 quad_perm:[1,0,3,2] row_mask:0xf bank_mask:0xf
    v_fma_f32 v36, v36, v9, v70
    v_mov_b32_dpp v70, v41 quad_perm:[1,0,3,2] row_mask:0xf bank_mask:0xf
    v_fma_f32 v41, v41, v9, v70
    v_mov_b32_dpp v70, v64 quad_perm:[1,0,3,2] row_mask:0xf bank_mask:0xf
    v_fma_f32 v64, v64, v9, v70
    v_mov_b32_dpp v70, v57 quad_perm:[1,0,3,2] row_mask:0xf bank_mask:0xf
    v_fma_f32 v57, v57, v9, v70
    v_mov_b32_dpp v70, v24 quad_perm:[1,0,3,2] row_mask:0xf bank_mask:0xf
    v_fma_f32 v24, v24, v9, v70
    v_mov_b32_dpp v70, v63 quad_perm:[1,0,3,2] row_mask:0xf bank_mask:0xf
    v_fma_f32 v63, v63, v9, v70
    v_mov_b32_dpp v70, v30 quad_perm:[1,0,3,2] row_mask:0xf bank_mask:0xf
    v_fma_f32 v30, v30, v9, v70
    v_mov_b32_dpp v70, v67 quad_perm:[1,0,3,2] row_mask:0xf bank_mask:0xf
    v_fma_f32 v67, v67, v9, v70
    v_mov_b32_dpp v70, v34 quad_perm:[1,0,3,2] row_mask:0xf bank_mask:0xf
    v_fma_f32 v34, v34, v9, v70
    v_mov_b32_dpp v70, v75 quad_perm:[1,0,3,2] row_mask:0xf bank_mask:0xf
    v_fma_f32 v75, v75, v9, v70
    v_mov_b32_dpp v70, v42 quad_perm:[1,0,3,2] row_mask:0xf bank_mask:0xf
    v_fma_f32 v42, v42, v9, v70
    v_mov_b32_dpp v70, v77 quad_perm:[1,0,3,2] row_mask:0xf bank_mask:0xf
    v_fma_f32 v77, v77, v9, v70
    v_mov_b32_dpp v70, v60 quad_perm:[1,0,3,2] row_mask:0xf bank_mask:0xf
    v_fma_f32 v60, v60, v9, v70
    v_mov_b32_dpp v70, v73 quad_perm:[1,0,3,2] row_mask:0xf bank_mask:0xf
    v_fma_f32 v73, v73, v9, v70
    v_mov_b32_dpp v70, v40 quad_perm:[1,0,3,2] row_mask:0xf bank_mask:0xf
    v_fma_f32 v40, v40, v9, v70
    v_mov_b32_dpp v70, v21 quad_perm:[1,0,3,2] row_mask:0xf bank_mask:0xf
    v_fma_f32 v21, v21, v9, v70
    v_mov_b32_dpp v70, v56 quad_perm:[1,0,3,2] row_mask:0xf bank_mask:0xf
    v_fma_f32 v56, v56, v9, v70
    v_mov_b32_dpp v70, v65 quad_perm:[1,0,3,2] row_mask:0xf bank_mask:0xf
    v_fma_f32 v65, v65, v9, v70
    v_mov_b32_dpp v70, v80 quad_perm:[1,0,3,2] row_mask:0xf bank_mask:0xf
    v_fma_f32 v80, v80, v9, v70
    v_mov_b32_dpp v70, v25 quad_perm:[1,0,3,2] row_mask:0xf bank_mask:0xf
    v_fma_f32 v25, v25, v9, v70
    v_mov_b32_dpp v70, v32 quad_perm:[1,0,3,2] row_mask:0xf bank_mask:0xf
    v_fma_f32 v32, v32, v9, v70
    v_mov_b32_dpp v70, v31 quad_perm:[1,0,3,2] row_mask:0xf bank_mask:0xf
    v_fma_f32 v31, v31, v9, v70
    v_mov_b32_dpp v70, v46 quad_perm:[1,0,3,2] row_mask:0xf bank_mask:0xf
    v_fma_f32 v46, v46, v9, v70
    v_mov_b32_dpp v70, v35 quad_perm:[1,0,3,2] row_mask:0xf bank_mask:0xf
    v_fma_f32 v35, v35, v9, v70
    v_mov_b32_dpp v70, v50 quad_perm:[1,0,3,2] row_mask:0xf bank_mask:0xf
    v_fma_f32 v50, v50, v9, v70
    v_mov_b32_dpp v70, v81 quad_perm:[1,0,3,2] row_mask:0xf bank_mask:0xf
    v_fma_f32 v81, v81, v9, v70
    v_mov_b32_dpp v70, v83 quad_perm:[1,0,3,2] row_mask:0xf bank_mask:0xf
    v_fma_f32 v83, v83, v9, v70
    v_mov_b32_dpp v70, v33 quad_perm:[1,0,3,2] row_mask:0xf bank_mask:0xf
    v_fma_f32 v33, v33, v9, v70
    v_mov_b32_dpp v70, v78 quad_perm:[1,0,3,2] row_mask:0xf bank_mask:0xf
    v_fma_f32 v78, v78, v9, v70
    v_mov_b32_dpp v70, v47 quad_perm:[1,0,3,2] row_mask:0xf bank_mask:0xf
    v_fma_f32 v47, v47, v9, v70
    v_mov_b32_dpp v70, v76 quad_perm:[1,0,3,2] row_mask:0xf bank_mask:0xf
    v_fma_f32 v76, v76, v9, v70
    v_mov_b32_dpp v70, v51 quad_perm:[1,0,3,2] row_mask:0xf bank_mask:0xf
    v_fma_f32 v51, v51, v9, v70
    v_mov_b32_dpp v70, v18 quad_perm:[1,0,3,2] row_mask:0xf bank_mask:0xf
    v_fma_f32 v18, v18, v9, v70
    v_mov_b32_dpp v70, v45 quad_perm:[1,0,3,2] row_mask:0xf bank_mask:0xf
    v_fma_f32 v45, v45, v9, v70
    v_mov_b32_dpp v70, v72 quad_perm:[1,0,3,2] row_mask:0xf bank_mask:0xf
    v_fma_f32 v72, v72, v9, v70
    v_mov_b32_dpp v70, v53 quad_perm:[1,0,3,2] row_mask:0xf bank_mask:0xf
    v_fma_f32 v53, v53, v9, v70
    v_mov_b32_dpp v70, v20 quad_perm:[1,0,3,2] row_mask:0xf bank_mask:0xf
    v_fma_f32 v20, v20, v9, v70
    v_mov_b32_dpp v70, v55 quad_perm:[1,0,3,2] row_mask:0xf bank_mask:0xf
    v_fma_f32 v55, v55, v9, v70
    v_mov_b32_dpp v70, v22 quad_perm:[1,0,3,2] row_mask:0xf bank_mask:0xf
    v_fma_f32 v22, v22, v9, v70
    v_mov_b32_dpp v70, v59 quad_perm:[1,0,3,2] row_mask:0xf bank_mask:0xf
    v_fma_f32 v59, v59, v9, v70
    s_waitcnt vmcnt(0)
    s_mov_b32 s20, 0x34800000
    v_lshlrev_b32 v70, 16, v88
    v_and_b32 v79, 0xffff0000, v88
    v_mul_f32 v70, s20, v70
    v_mul_f32 v79, s20, v79
    v_mul_f32 v82, v16, v70
    v_fma_f32 v82, -v17, v79, v82
    v_mul_f32 v17, v17, v70
    v_fmac_f32 v17, v16, v79
    v_lshlrev_b32 v70, 16, v89
    v_and_b32 v79, 0xffff0000, v89
    v_mul_f32 v70, s20, v70
    v_mul_f32 v79, s20, v79
    v_mul_f32 v16, v74, v70
    v_fma_f32 v16, -v49, v79, v16
    v_mul_f32 v49, v49, v70
    v_fmac_f32 v49, v74, v79
    v_lshlrev_b32 v70, 16, v90
    v_and_b32 v79, 0xffff0000, v90
    v_mul_f32 v70, s20, v70
    v_mul_f32 v79, s20, v79
    v_mul_f32 v74, v48, v70
    v_fma_f32 v74, -v19, v79, v74
    v_mul_f32 v19, v19, v70
    v_fmac_f32 v19, v48, v79
    v_lshlrev_b32 v70, 16, v91
    v_and_b32 v79, 0xffff0000, v91
    v_mul_f32 v70, s20, v70
    v_mul_f32 v79, s20, v79
    v_mul_f32 v48, v68, v70
    v_fma_f32 v48, -v23, v79, v48
    v_mul_f32 v23, v23, v70
    v_fmac_f32 v23, v68, v79
    v_lshlrev_b32 v70, 16, v92
    v_and_b32 v79, 0xffff0000, v92
    v_mul_f32 v70, s20, v70
    v_mul_f32 v79, s20, v79
    v_mul_f32 v68, v62, v70
    v_fma_f32 v68, -v27, v79, v68
    v_mul_f32 v27, v27, v70
    v_fmac_f32 v27, v62, v79
    v_lshlrev_b32 v70, 16, v93
    v_and_b32 v79, 0xffff0000, v93
    v_mul_f32 v70, s20, v70
    v_mul_f32 v79, s20, v79
    v_mul_f32 v62, v66, v70
    v_fma_f32 v62, -v39, v79, v62
    v_mul_f32 v39, v39, v70
    v_fmac_f32 v39, v66, v79
    v_lshlrev_b32 v70, 16, v94
    v_and_b32 v79, 0xffff0000, v94
    v_mul_f32 v70, s20, v70
    v_mul_f32 v79, s20, v79
    v_mul_f32 v66, v54, v70
    v_fma_f32 v66, -v29, v79, v66
    v_mul_f32 v29, v29, v70
    v_fmac_f32 v29, v54, v79
    v_lshlrev_b32 v70, 16, v95
    v_and_b32 v79, 0xffff0000, v95
    v_mul_f32 v70, s20, v70
    v_mul_f32 v79, s20, v79
    v_mul_f32 v54, v44, v70
    v_fma_f32 v54, -v37, v79, v54
    v_mul_f32 v37, v37, v70
    v_fmac_f32 v37, v44, v79
    v_lshlrev_b32 v70, 16, v96
    v_and_b32 v79, 0xffff0000, v96
    v_mul_f32 v70, s20, v70
    v_mul_f32 v79, s20, v79
    v_mul_f32 v44, v52, v70
    v_fma_f32 v44, -v43, v79, v44
    v_mul_f32 v43, v43, v70
    v_fmac_f32 v43, v52, v79
    v_lshlrev_b32 v70, 16, v97
    v_and_b32 v79, 0xffff0000, v97
    v_mul_f32 v70, s20, v70
    v_mul_f32 v79, s20, v79
    v_mul_f32 v52, v58, v70
    v_fma_f32 v52, -v71, v79, v52
    v_mul_f32 v71, v71, v70
    v_fmac_f32 v71, v58, v79
    v_lshlrev_b32 v70, 16, v98
    v_and_b32 v79, 0xffff0000, v98
    v_mul_f32 v70, s20, v70
    v_mul_f32 v79, s20, v79
    v_mul_f32 v58, v38, v70
    v_fma_f32 v58, -v61, v79, v58
    v_mul_f32 v61, v61, v70
    v_fmac_f32 v61, v38, v79
    v_lshlrev_b32 v70, 16, v99
    v_and_b32 v79, 0xffff0000, v99
    v_mul_f32 v70, s20, v70
    v_mul_f32 v79, s20, v79
    v_mul_f32 v38, v28, v70
    v_fma_f32 v38, -v69, v79, v38
    v_mul_f32 v69, v69, v70
    v_fmac_f32 v69, v28, v79
    v_lshlrev_b32 v70, 16, v100
    v_and_b32 v79, 0xffff0000, v100
    v_mul_f32 v70, s20, v70
    v_mul_f32 v79, s20, v79
    v_mul_f32 v28, v36, v70
    v_fma_f32 v28, -v41, v79, v28
    v_mul_f32 v41, v41, v70
    v_fmac_f32 v41, v36, v79
    v_lshlrev_b32 v70, 16, v101
    v_and_b32 v79, 0xffff0000, v101
    v_mul_f32 v70, s20, v70
    v_mul_f32 v79, s20, v79
    v_mul_f32 v36, v64, v70
    v_fma_f32 v36, -v57, v79, v36
    v_mul_f32 v57, v57, v70
    v_fmac_f32 v57, v64, v79
    v_lshlrev_b32 v70, 16, v102
    v_and_b32 v79, 0xffff0000, v102
    v_mul_f32 v70, s20, v70
    v_mul_f32 v79, s20, v79
    v_mul_f32 v64, v24, v70
    v_fma_f32 v64, -v63, v79, v64
    v_mul_f32 v63, v63, v70
    v_fmac_f32 v63, v24, v79
    v_lshlrev_b32 v70, 16, v103
    v_and_b32 v79, 0xffff0000, v103
    v_mul_f32 v70, s20, v70
    v_mul_f32 v79, s20, v79
    v_mul_f32 v24, v30, v70
    v_fma_f32 v24, -v67, v79, v24
    v_mul_f32 v67, v67, v70
    v_fmac_f32 v67, v30, v79
    v_lshlrev_b32 v70, 16, v104
    v_and_b32 v79, 0xffff0000, v104
    v_mul_f32 v70, s20, v70
    v_mul_f32 v79, s20, v79
    v_mul_f32 v30, v34, v70
    v_fma_f32 v30, -v75, v79, v30
    v_mul_f32 v75, v75, v70
    v_fmac_f32 v75, v34, v79
    v_lshlrev_b32 v70, 16, v105
    v_and_b32 v79, 0xffff0000, v105
    v_mul_f32 v70, s20, v70
    v_mul_f32 v79, s20, v79
    v_mul_f32 v34, v42, v70
    v_fma_f32 v34, -v77, v79, v34
    v_mul_f32 v77, v77, v70
    v_fmac_f32 v77, v42, v79
    v_lshlrev_b32 v70, 16, v106
    v_and_b32 v79, 0xffff0000, v106
    v_mul_f32 v70, s20, v70
    v_mul_f32 v79, s20, v79
    v_mul_f32 v42, v60, v70
    v_fma_f32 v42, -v73, v79, v42
    v_mul_f32 v73, v73, v70
    v_fmac_f32 v73, v60, v79
    v_lshlrev_b32 v70, 16, v107
    v_and_b32 v79, 0xffff0000, v107
    v_mul_f32 v70, s20, v70
    v_mul_f32 v79, s20, v79
    v_mul_f32 v60, v40, v70
    v_fma_f32 v60, -v21, v79, v60
    v_mul_f32 v21, v21, v70
    v_fmac_f32 v21, v40, v79
    v_lshlrev_b32 v70, 16, v108
    v_and_b32 v79, 0xffff0000, v108
    v_mul_f32 v70, s20, v70
    v_mul_f32 v79, s20, v79
    v_mul_f32 v40, v56, v70
    v_fma_f32 v40, -v65, v79, v40
    v_mul_f32 v65, v65, v70
    v_fmac_f32 v65, v56, v79
    v_lshlrev_b32 v70, 16, v109
    v_and_b32 v79, 0xffff0000, v109
    v_mul_f32 v70, s20, v70
    v_mul_f32 v79, s20, v79
    v_mul_f32 v56, v80, v70
    v_fma_f32 v56, -v25, v79, v56
    v_mul_f32 v25, v25, v70
    v_fmac_f32 v25, v80, v79
    v_lshlrev_b32 v70, 16, v110
    v_and_b32 v79, 0xffff0000, v110
    v_mul_f32 v70, s20, v70
    v_mul_f32 v79, s20, v79
    v_mul_f32 v80, v32, v70
    v_fma_f32 v80, -v31, v79, v80
    v_mul_f32 v31, v31, v70
    v_fmac_f32 v31, v32, v79
    v_lshlrev_b32 v70, 16, v111
    v_and_b32 v79, 0xffff0000, v111
    v_mul_f32 v70, s20, v70
    v_mul_f32 v79, s20, v79
    v_mul_f32 v32, v46, v70
    v_fma_f32 v32, -v35, v79, v32
    v_mul_f32 v35, v35, v70
    v_fmac_f32 v35, v46, v79
    v_lshlrev_b32 v70, 16, v112
    v_and_b32 v79, 0xffff0000, v112
    v_mul_f32 v70, s20, v70
    v_mul_f32 v79, s20, v79
    v_mul_f32 v46, v50, v70
    v_fma_f32 v46, -v81, v79, v46
    v_mul_f32 v81, v81, v70
    v_fmac_f32 v81, v50, v79
    v_lshlrev_b32 v70, 16, v113
    v_and_b32 v79, 0xffff0000, v113
    v_mul_f32 v70, s20, v70
    v_mul_f32 v79, s20, v79
    v_mul_f32 v50, v83, v70
    v_fma_f32 v50, -v33, v79, v50
    v_mul_f32 v33, v33, v70
    v_fmac_f32 v33, v83, v79
    v_lshlrev_b32 v70, 16, v114
    v_and_b32 v79, 0xffff0000, v114
    v_mul_f32 v70, s20, v70
    v_mul_f32 v79, s20, v79
    v_mul_f32 v83, v78, v70
    v_fma_f32 v83, -v47, v79, v83
    v_mul_f32 v47, v47, v70
    v_fmac_f32 v47, v78, v79
    v_lshlrev_b32 v70, 16, v115
    v_and_b32 v79, 0xffff0000, v115
    v_mul_f32 v70, s20, v70
    v_mul_f32 v79, s20, v79
    v_mul_f32 v78, v76, v70
    v_fma_f32 v78, -v51, v79, v78
    v_mul_f32 v51, v51, v70
    v_fmac_f32 v51, v76, v79
    v_lshlrev_b32 v70, 16, v116
    v_and_b32 v79, 0xffff0000, v116
    v_mul_f32 v70, s20, v70
    v_mul_f32 v79, s20, v79
    v_mul_f32 v76, v18, v70
    v_fma_f32 v76, -v45, v79, v76
    v_mul_f32 v45, v45, v70
    v_fmac_f32 v45, v18, v79
    v_lshlrev_b32 v70, 16, v117
    v_and_b32 v79, 0xffff0000, v117
    v_mul_f32 v70, s20, v70
    v_mul_f32 v79, s20, v79
    v_mul_f32 v18, v72, v70
    v_fma_f32 v18, -v53, v79, v18
    v_mul_f32 v53, v53, v70
    v_fmac_f32 v53, v72, v79
    v_lshlrev_b32 v70, 16, v118
    v_and_b32 v79, 0xffff0000, v118
    v_mul_f32 v70, s20, v70
    v_mul_f32 v79, s20, v79
    v_mul_f32 v72, v20, v70
    v_fma_f32 v72, -v55, v79, v72
    v_mul_f32 v55, v55, v70
    v_fmac_f32 v55, v20, v79
    v_lshlrev_b32 v70, 16, v119
    v_and_b32 v79, 0xffff0000, v119
    v_mul_f32 v70, s20, v70
    v_mul_f32 v79, s20, v79
    v_mul_f32 v20, v22, v70
    v_fma_f32 v20, -v59, v79, v20
    v_mul_f32 v59, v59, v70
    v_fmac_f32 v59, v22, v79
    s_nop 1
    v_mov_b32_dpp v70, v82 quad_perm:[1,0,3,2] row_mask:0xf bank_mask:0xf
    v_fma_f32 v82, v82, v9, v70
    v_mov_b32_dpp v70, v17 quad_perm:[1,0,3,2] row_mask:0xf bank_mask:0xf
    v_fma_f32 v17, v17, v9, v70
    v_mov_b32_dpp v70, v16 quad_perm:[1,0,3,2] row_mask:0xf bank_mask:0xf
    v_fma_f32 v16, v16, v9, v70
    v_mov_b32_dpp v70, v49 quad_perm:[1,0,3,2] row_mask:0xf bank_mask:0xf
    v_fma_f32 v49, v49, v9, v70
    v_mov_b32_dpp v70, v74 quad_perm:[1,0,3,2] row_mask:0xf bank_mask:0xf
    v_fma_f32 v74, v74, v9, v70
    v_mov_b32_dpp v70, v19 quad_perm:[1,0,3,2] row_mask:0xf bank_mask:0xf
    v_fma_f32 v19, v19, v9, v70
    v_mov_b32_dpp v70, v48 quad_perm:[1,0,3,2] row_mask:0xf bank_mask:0xf
    v_fma_f32 v48, v48, v9, v70
    v_mov_b32_dpp v70, v23 quad_perm:[1,0,3,2] row_mask:0xf bank_mask:0xf
    v_fma_f32 v23, v23, v9, v70
    v_mov_b32_dpp v70, v68 quad_perm:[1,0,3,2] row_mask:0xf bank_mask:0xf
    v_fma_f32 v68, v68, v9, v70
    v_mov_b32_dpp v70, v27 quad_perm:[1,0,3,2] row_mask:0xf bank_mask:0xf
    v_fma_f32 v27, v27, v9, v70
    v_mov_b32_dpp v70, v62 quad_perm:[1,0,3,2] row_mask:0xf bank_mask:0xf
    v_fma_f32 v62, v62, v9, v70
    v_mov_b32_dpp v70, v39 quad_perm:[1,0,3,2] row_mask:0xf bank_mask:0xf
    v_fma_f32 v39, v39, v9, v70
    v_mov_b32_dpp v70, v66 quad_perm:[1,0,3,2] row_mask:0xf bank_mask:0xf
    v_fma_f32 v66, v66, v9, v70
    v_mov_b32_dpp v70, v29 quad_perm:[1,0,3,2] row_mask:0xf bank_mask:0xf
    v_fma_f32 v29, v29, v9, v70
    v_mov_b32_dpp v70, v54 quad_perm:[1,0,3,2] row_mask:0xf bank_mask:0xf
    v_fma_f32 v54, v54, v9, v70
    v_mov_b32_dpp v70, v37 quad_perm:[1,0,3,2] row_mask:0xf bank_mask:0xf
    v_fma_f32 v37, v37, v9, v70
    v_mov_b32_dpp v70, v44 quad_perm:[1,0,3,2] row_mask:0xf bank_mask:0xf
    v_fma_f32 v44, v44, v9, v70
    v_mov_b32_dpp v70, v43 quad_perm:[1,0,3,2] row_mask:0xf bank_mask:0xf
    v_fma_f32 v43, v43, v9, v70
    v_mov_b32_dpp v70, v52 quad_perm:[1,0,3,2] row_mask:0xf bank_mask:0xf
    v_fma_f32 v52, v52, v9, v70
    v_mov_b32_dpp v70, v71 quad_perm:[1,0,3,2] row_mask:0xf bank_mask:0xf
    v_fma_f32 v71, v71, v9, v70
    v_mov_b32_dpp v70, v58 quad_perm:[1,0,3,2] row_mask:0xf bank_mask:0xf
    v_fma_f32 v58, v58, v9, v70
    v_mov_b32_dpp v70, v61 quad_perm:[1,0,3,2] row_mask:0xf bank_mask:0xf
    v_fma_f32 v61, v61, v9, v70
    v_mov_b32_dpp v70, v38 quad_perm:[1,0,3,2] row_mask:0xf bank_mask:0xf
    v_fma_f32 v38, v38, v9, v70
    v_mov_b32_dpp v70, v69 quad_perm:[1,0,3,2] row_mask:0xf bank_mask:0xf
    v_fma_f32 v69, v69, v9, v70
    v_mov_b32_dpp v70, v28 quad_perm:[1,0,3,2] row_mask:0xf bank_mask:0xf
    v_fma_f32 v28, v28, v9, v70
    v_mov_b32_dpp v70, v41 quad_perm:[1,0,3,2] row_mask:0xf bank_mask:0xf
    v_fma_f32 v41, v41, v9, v70
    v_mov_b32_dpp v70, v36 quad_perm:[1,0,3,2] row_mask:0xf bank_mask:0xf
    v_fma_f32 v36, v36, v9, v70
    v_mov_b32_dpp v70, v57 quad_perm:[1,0,3,2] row_mask:0xf bank_mask:0xf
    v_fma_f32 v57, v57, v9, v70
    v_mov_b32_dpp v70, v64 quad_perm:[1,0,3,2] row_mask:0xf bank_mask:0xf
    v_fma_f32 v64, v64, v9, v70
    v_mov_b32_dpp v70, v63 quad_perm:[1,0,3,2] row_mask:0xf bank_mask:0xf
    v_fma_f32 v63, v63, v9, v70
    v_mov_b32_dpp v70, v24 quad_perm:[1,0,3,2] row_mask:0xf bank_mask:0xf
    v_fma_f32 v24, v24, v9, v70
    v_mov_b32_dpp v70, v67 quad_perm:[1,0,3,2] row_mask:0xf bank_mask:0xf
    v_fma_f32 v67, v67, v9, v70
    v_mov_b32_dpp v70, v30 quad_perm:[1,0,3,2] row_mask:0xf bank_mask:0xf
    v_fma_f32 v30, v30, v9, v70
    v_mov_b32_dpp v70, v75 quad_perm:[1,0,3,2] row_mask:0xf bank_mask:0xf
    v_fma_f32 v75, v75, v9, v70
    v_mov_b32_dpp v70, v34 quad_perm:[1,0,3,2] row_mask:0xf bank_mask:0xf
    v_fma_f32 v34, v34, v9, v70
    v_mov_b32_dpp v70, v77 quad_perm:[1,0,3,2] row_mask:0xf bank_mask:0xf
    v_fma_f32 v77, v77, v9, v70
    v_mov_b32_dpp v70, v42 quad_perm:[1,0,3,2] row_mask:0xf bank_mask:0xf
    v_fma_f32 v42, v42, v9, v70
    v_mov_b32_dpp v70, v73 quad_perm:[1,0,3,2] row_mask:0xf bank_mask:0xf
    v_fma_f32 v73, v73, v9, v70
    v_mov_b32_dpp v70, v60 quad_perm:[1,0,3,2] row_mask:0xf bank_mask:0xf
    v_fma_f32 v60, v60, v9, v70
    v_mov_b32_dpp v70, v21 quad_perm:[1,0,3,2] row_mask:0xf bank_mask:0xf
    v_fma_f32 v21, v21, v9, v70
    v_mov_b32_dpp v70, v40 quad_perm:[1,0,3,2] row_mask:0xf bank_mask:0xf
    v_fma_f32 v40, v40, v9, v70
    v_mov_b32_dpp v70, v65 quad_perm:[1,0,3,2] row_mask:0xf bank_mask:0xf
    v_fma_f32 v65, v65, v9, v70
    v_mov_b32_dpp v70, v56 quad_perm:[1,0,3,2] row_mask:0xf bank_mask:0xf
    v_fma_f32 v56, v56, v9, v70
    v_mov_b32_dpp v70, v25 quad_perm:[1,0,3,2] row_mask:0xf bank_mask:0xf
    v_fma_f32 v25, v25, v9, v70
    v_mov_b32_dpp v70, v80 quad_perm:[1,0,3,2] row_mask:0xf bank_mask:0xf
    v_fma_f32 v80, v80, v9, v70
    v_mov_b32_dpp v70, v31 quad_perm:[1,0,3,2] row_mask:0xf bank_mask:0xf
    v_fma_f32 v31, v31, v9, v70
    v_mov_b32_dpp v70, v32 quad_perm:[1,0,3,2] row_mask:0xf bank_mask:0xf
    v_fma_f32 v32, v32, v9, v70
    v_mov_b32_dpp v70, v35 quad_perm:[1,0,3,2] row_mask:0xf bank_mask:0xf
    v_fma_f32 v35, v35, v9, v70
    v_mov_b32_dpp v70, v46 quad_perm:[1,0,3,2] row_mask:0xf bank_mask:0xf
    v_fma_f32 v46, v46, v9, v70
    v_mov_b32_dpp v70, v81 quad_perm:[1,0,3,2] row_mask:0xf bank_mask:0xf
    v_fma_f32 v81, v81, v9, v70
    v_mov_b32_dpp v70, v50 quad_perm:[1,0,3,2] row_mask:0xf bank_mask:0xf
    v_fma_f32 v50, v50, v9, v70
    v_mov_b32_dpp v70, v33 quad_perm:[1,0,3,2] row_mask:0xf bank_mask:0xf
    v_fma_f32 v33, v33, v9, v70
    v_mov_b32_dpp v70, v83 quad_perm:[1,0,3,2] row_mask:0xf bank_mask:0xf
    v_fma_f32 v83, v83, v9, v70
    v_mov_b32_dpp v70, v47 quad_perm:[1,0,3,2] row_mask:0xf bank_mask:0xf
    v_fma_f32 v47, v47, v9, v70
    v_mov_b32_dpp v70, v78 quad_perm:[1,0,3,2] row_mask:0xf bank_mask:0xf
    v_fma_f32 v78, v78, v9, v70
    v_mov_b32_dpp v70, v51 quad_perm:[1,0,3,2] row_mask:0xf bank_mask:0xf
    v_fma_f32 v51, v51, v9, v70
    v_mov_b32_dpp v70, v76 quad_perm:[1,0,3,2] row_mask:0xf bank_mask:0xf
    v_fma_f32 v76, v76, v9, v70
    v_mov_b32_dpp v70, v45 quad_perm:[1,0,3,2] row_mask:0xf bank_mask:0xf
    v_fma_f32 v45, v45, v9, v70
    v_mov_b32_dpp v70, v18 quad_perm:[1,0,3,2] row_mask:0xf bank_mask:0xf
    v_fma_f32 v18, v18, v9, v70
    v_mov_b32_dpp v70, v53 quad_perm:[1,0,3,2] row_mask:0xf bank_mask:0xf
    v_fma_f32 v53, v53, v9, v70
    v_mov_b32_dpp v70, v72 quad_perm:[1,0,3,2] row_mask:0xf bank_mask:0xf
    v_fma_f32 v72, v72, v9, v70
    v_mov_b32_dpp v70, v55 quad_perm:[1,0,3,2] row_mask:0xf bank_mask:0xf
    v_fma_f32 v55, v55, v9, v70
    v_mov_b32_dpp v70, v20 quad_perm:[1,0,3,2] row_mask:0xf bank_mask:0xf
    v_fma_f32 v20, v20, v9, v70
    v_mov_b32_dpp v70, v59 quad_perm:[1,0,3,2] row_mask:0xf bank_mask:0xf
    v_fma_f32 v59, v59, v9, v70
    v_mul_f32 v70, 0x3c800000, v10
    v_cos_f32 v79, v70
    v_sin_f32 v22, v70
    s_nop 0
    v_mul_f32 v26, v16, v79
    v_fma_f32 v26, -v49, v22, v26
    v_mul_f32 v49, v49, v79
    v_fmac_f32 v49, v16, v22
    v_mul_f32 v70, 0x3d000000, v10
    v_cos_f32 v79, v70
    v_sin_f32 v22, v70
    s_nop 0
    v_mul_f32 v16, v74, v79
    v_fma_f32 v16, -v19, v22, v16
    v_mul_f32 v19, v19, v79
    v_fmac_f32 v19, v74, v22
    v_mul_f32 v70, 0x3d400000, v10
    v_cos_f32 v79, v70
    v_sin_f32 v22, v70
    s_nop 0
    v_mul_f32 v74, v48, v79
    v_fma_f32 v74, -v23, v22, v74
    v_mul_f32 v23, v23, v79
    v_fmac_f32 v23, v48, v22
    v_mul_f32 v70, 0x3d800000, v10
    v_cos_f32 v79, v70
    v_sin_f32 v22, v70
    s_nop 0
    v_mul_f32 v48, v68, v79
    v_fma_f32 v48, -v27, v22, v48
    v_mul_f32 v27, v27, v79
    v_fmac_f32 v27, v68, v22
    v_mul_f32 v70, 0x3da00000, v10
    v_cos_f32 v79, v70
    v_sin_f32 v22, v70
    s_nop 0
    v_mul_f32 v68, v62, v79
    v_fma_f32 v68, -v39, v22, v68
    v_mul_f32 v39, v39, v79
    v_fmac_f32 v39, v62, v22
    v_mul_f32 v70, 0x3dc00000, v10
    v_cos_f32 v79, v70
    v_sin_f32 v22, v70
    s_nop 0
    v_mul_f32 v62, v66, v79
    v_fma_f32 v62, -v29, v22, v62
    v_mul_f32 v29, v29, v79
    v_fmac_f32 v29, v66, v22
    v_mul_f32 v70, 0x3de00000, v10
    v_cos_f32 v79, v70
    v_sin_f32 v22, v70
    s_nop 0
    v_mul_f32 v66, v54, v79
    v_fma_f32 v66, -v37, v22, v66
    v_mul_f32 v37, v37, v79
    v_fmac_f32 v37, v54, v22
    v_mul_f32 v70, 0x3e000000, v10
    v_cos_f32 v79, v70
    v_sin_f32 v22, v70
    s_nop 0
    v_mul_f32 v54, v44, v79
    v_fma_f32 v54, -v43, v22, v54
    v_mul_f32 v43, v43, v79
    v_fmac_f32 v43, v44, v22
    v_mul_f32 v70, 0x3e100000, v10
    v_cos_f32 v79, v70
    v_sin_f32 v22, v70
    s_nop 0
    v_mul_f32 v44, v52, v79
    v_fma_f32 v44, -v71, v22, v44
    v_mul_f32 v71, v71, v79
    v_fmac_f32 v71, v52, v22
    v_mul_f32 v70, 0x3e200000, v10
    v_cos_f32 v79, v70
    v_sin_f32 v22, v70
    s_nop 0
    v_mul_f32 v52, v58, v79
    v_fma_f32 v52, -v61, v22, v52
    v_mul_f32 v61, v61, v79
    v_fmac_f32 v61, v58, v22
    v_mul_f32 v70, 0x3e300000, v10
    v_cos_f32 v79, v70
    v_sin_f32 v22, v70
    s_nop 0
    v_mul_f32 v58, v38, v79
    v_fma_f32 v58, -v69, v22, v58
    v_mul_f32 v69, v69, v79
    v_fmac_f32 v69, v38, v22
    v_mul_f32 v70, 0x3e400000, v10
    v_cos_f32 v79, v70
    v_sin_f32 v22, v70
    s_nop 0
    v_mul_f32 v38, v28, v79
    v_fma_f32 v38, -v41, v22, v38
    v_mul_f32 v41, v41, v79
    v_fmac_f32 v41, v28, v22
    v_mul_f32 v70, 0x3e500000, v10
    v_cos_f32 v79, v70
    v_sin_f32 v22, v70
    s_nop 0
    v_mul_f32 v28, v36, v79
    v_fma_f32 v28, -v57, v22, v28
    v_mul_f32 v57, v57, v79
    v_fmac_f32 v57, v36, v22
    v_mul_f32 v70, 0x3e600000, v10
    v_cos_f32 v79, v70
    v_sin_f32 v22, v70
    s_nop 0
    v_mul_f32 v36, v64, v79
    v_fma_f32 v36, -v63, v22, v36
    v_mul_f32 v63, v63, v79
    v_fmac_f32 v63, v64, v22
    v_mul_f32 v70, 0x3e700000, v10
    v_cos_f32 v79, v70
    v_sin_f32 v22, v70
    s_nop 0
    v_mul_f32 v64, v24, v79
    v_fma_f32 v64, -v67, v22, v64
    v_mul_f32 v67, v67, v79
    v_fmac_f32 v67, v24, v22
    v_mul_f32 v70, 0x3e800000, v10
    v_cos_f32 v79, v70
    v_sin_f32 v22, v70
    s_nop 0
    v_mul_f32 v24, v30, v79
    v_fma_f32 v24, -v75, v22, v24
    v_mul_f32 v75, v75, v79
    v_fmac_f32 v75, v30, v22
    v_mul_f32 v70, 0x3e880000, v10
    v_cos_f32 v79, v70
    v_sin_f32 v22, v70
    s_nop 0
    v_mul_f32 v30, v34, v79
    v_fma_f32 v30, -v77, v22, v30
    v_mul_f32 v77, v77, v79
    v_fmac_f32 v77, v34, v22
    v_mul_f32 v70, 0x3e900000, v10
    v_cos_f32 v79, v70
    v_sin_f32 v22, v70
    s_nop 0
    v_mul_f32 v34, v42, v79
    v_fma_f32 v34, -v73, v22, v34
    v_mul_f32 v73, v73, v79
    v_fmac_f32 v73, v42, v22
    v_mul_f32 v70, 0x3e980000, v10
    v_cos_f32 v79, v70
    v_sin_f32 v22, v70
    s_nop 0
    v_mul_f32 v42, v60, v79
    v_fma_f32 v42, -v21, v22, v42
    v_mul_f32 v21, v21, v79
    v_fmac_f32 v21, v60, v22
    v_mul_f32 v70, 0x3ea00000, v10
    v_cos_f32 v79, v70
    v_sin_f32 v22, v70
    s_nop 0
    v_mul_f32 v60, v40, v79
    v_fma_f32 v60, -v65, v22, v60
    v_mul_f32 v65, v65, v79
    v_fmac_f32 v65, v40, v22
    v_mul_f32 v70, 0x3ea80000, v10
    v_cos_f32 v79, v70
    v_sin_f32 v22, v70
    s_nop 0
    v_mul_f32 v40, v56, v79
    v_fma_f32 v40, -v25, v22, v40
    v_mul_f32 v25, v25, v79
    v_fmac_f32 v25, v56, v22
    v_mul_f32 v70, 0x3eb00000, v10
    v_cos_f32 v79, v70
    v_sin_f32 v22, v70
    s_nop 0
    v_mul_f32 v56, v80, v79
    v_fma_f32 v56, -v31, v22, v56
    v_mul_f32 v31, v31, v79
    v_fmac_f32 v31, v80, v22
    v_mul_f32 v70, 0x3eb80000, v10
    v_cos_f32 v79, v70
    v_sin_f32 v22, v70
    s_nop 0
    v_mul_f32 v80, v32, v79
    v_fma_f32 v80, -v35, v22, v80
    v_mul_f32 v35, v35, v79
    v_fmac_f32 v35, v32, v22
    v_mul_f32 v70, 0x3ec00000, v10
    v_cos_f32 v79, v70
    v_sin_f32 v22, v70
    s_nop 0
    v_mul_f32 v32, v46, v79
    v_fma_f32 v32, -v81, v22, v32
    v_mul_f32 v81, v81, v79
    v_fmac_f32 v81, v46, v22
    v_mul_f32 v70, 0x3ec80000, v10
    v_cos_f32 v79, v70
    v_sin_f32 v22, v70
    s_nop 0
    v_mul_f32 v46, v50, v79
    v_fma_f32 v46, -v33, v22, v46
    v_mul_f32 v33, v33, v79
    v_fmac_f32 v33, v50, v22
    v_mul_f32 v70, 0x3ed00000, v10
    v_cos_f32 v79, v70
    v_sin_f32 v22, v70
    s_nop 0
    v_mul_f32 v50, v83, v79
    v_fma_f32 v50, -v47, v22, v50
    v_mul_f32 v47, v47, v79
    v_fmac_f32 v47, v83, v22
    v_mul_f32 v70, 0x3ed80000, v10
    v_cos_f32 v79, v70
    v_sin_f32 v22, v70
    s_nop 0
    v_mul_f32 v83, v78, v79
    v_fma_f32 v83, -v51, v22, v83
    v_mul_f32 v51, v51, v79
    v_fmac_f32 v51, v78, v22
    v_mul_f32 v70, 0x3ee00000, v10
    v_cos_f32 v79, v70
    v_sin_f32 v22, v70
    s_nop 0
    v_mul_f32 v78, v76, v79
    v_fma_f32 v78, -v45, v22, v78
    v_mul_f32 v45, v45, v79
    v_fmac_f32 v45, v76, v22
    v_mul_f32 v70, 0x3ee80000, v10
    v_cos_f32 v79, v70
    v_sin_f32 v22, v70
    s_nop 0
    v_mul_f32 v76, v18, v79
    v_fma_f32 v76, -v53, v22, v76
    v_mul_f32 v53, v53, v79
    v_fmac_f32 v53, v18, v22
    v_mul_f32 v70, 0x3ef00000, v10
    v_cos_f32 v79, v70
    v_sin_f32 v22, v70
    s_nop 0
    v_mul_f32 v18, v72, v79
    v_fma_f32 v18, -v55, v22, v18
    v_mul_f32 v55, v55, v79
    v_fmac_f32 v55, v72, v22
    v_mul_f32 v70, 0x3ef80000, v10
    v_cos_f32 v79, v70
    v_sin_f32 v22, v70
    s_nop 0
    v_mul_f32 v72, v20, v79
    v_fma_f32 v72, -v59, v22, v72
    v_mul_f32 v59, v59, v79
    v_fmac_f32 v59, v20, v22
    v_sub_f32 v70, v82, v24
    v_sub_f32 v79, v17, v75
    v_add_f32 v82, v82, v24
    v_add_f32 v17, v17, v75
    v_sub_f32 v24, v26, v30
    v_sub_f32 v75, v49, v77
    v_add_f32 v26, v26, v30
    v_add_f32 v49, v49, v77
    v_mul_f32 v30, 0x3f7b14be, v24
    v_mul_f32 v77, 0x3e47c5c2, v24
    v_fmac_f32 v30, 0xbe47c5c2, v75
    v_fmac_f32 v77, 0x3f7b14be, v75
    v_sub_f32 v24, v16, v34
    v_sub_f32 v75, v19, v73
    v_add_f32 v16, v16, v34
    v_add_f32 v19, v19, v73
    v_mul_f32 v34, 0x3f6c835e, v24
    v_mul_f32 v73, 0x3ec3ef15, v24
    v_fmac_f32 v34, 0xbec3ef15, v75
    v_fmac_f32 v73, 0x3f6c835e, v75
    v_sub_f32 v24, v74, v42
    v_sub_f32 v75, v23, v21
    v_add_f32 v74, v74, v42
    v_add_f32 v23, v23, v21
    v_mul_f32 v42, 0x3f54db31, v24
    v_mul_f32 v21, 0x3f0e39da, v24
    v_fmac_f32 v42, 0xbf0e39da, v75
    v_fmac_f32 v21, 0x3f54db31, v75
    v_sub_f32 v24, v48, v60
    v_sub_f32 v75, v27, v65
    v_add_f32 v48, v48, v60
    v_add_f32 v27, v27, v65
    v_mul_f32 v60, 0x3f3504f3, v24
    v_mul_f32 v65, 0x3f3504f3, v24
    v_fmac_f32 v60, 0xbf3504f3, v75
    v_fmac_f32 v65, 0x3f3504f3, v75
    v_sub_f32 v24, v68, v40
    v_sub_f32 v75, v39, v25
    v_add_f32 v68, v68, v40
    v_add_f32 v39, v39, v25
    v_mul_f32 v40, 0x3f0e39da, v24
    v_mul_f32 v25, 0x3f54db31, v24
    v_fmac_f32 v40, 0xbf54db31, v75
    v_fmac_f32 v25, 0x3f0e39da, v75
    v_sub_f32 v24, v62, v56
    v_sub_f32 v75, v29, v31
    v_add_f32 v62, v62, v56
    v_add_f32 v29, v29, v31
    v_mul_f32 v56, 0x3ec3ef15, v24
    v_mul_f32 v31, 0x3f6c835e, v24
    v_fmac_f32 v56, 0xbf6c835e, v75
    v_fmac_f32 v31, 0x3ec3ef15, v75
    v_sub_f32 v24, v66, v80
    v_sub_f32 v75, v37, v35
    v_add_f32 v66, v66, v80
    v_add_f32 v37, v37, v35
    v_mul_f32 v80, 0x3e47c5c2, v24
    v_mul_f32 v35, 0x3f7b14be, v24
    v_fmac_f32 v80, 0xbf7b14be, v75
    v_fmac_f32 v35, 0x3e47c5c2, v75
    v_sub_f32 v24, v81, v43
    v_sub_f32 v75, v54, v32
    v_add_f32 v54, v54, v32
    v_add_f32 v43, v43, v81
    v_sub_f32 v32, v44, v46
    v_sub_f32 v81, v71, v33
    v_add_f32 v44, v44, v46
    v_add_f32 v71, v71, v33
    v_mul_f32 v46, 0xbe47c5c2, v32
    v_mul_f32 v33, 0x3f7b14be, v32
    v_fmac_f32 v46, 0xbf7b14be, v81
    v_fmac_f32 v33, 0xbe47c5c2, v81
    v_sub_f32 v32, v52, v50
    v_sub_f32 v81, v61, v47
    v_add_f32 v52, v52, v50
    v_add_f32 v61, v61, v47
    v_mul_f32 v50, 0xbec3ef15, v32
    v_mul_f32 v47, 0x3f6c835e, v32
    v_fmac_f32 v50, 0xbf6c835e, v81
    v_fmac_f32 v47, 0xbec3ef15, v81
    v_sub_f32 v32, v58, v83
    v_sub_f32 v81, v69, v51
    v_add_f32 v58, v58, v83
    v_add_f32 v69, v69, v51
    v_mul_f32 v83, 0xbf0e39da, v32
    v_mul_f32 v51, 0x3f54db31, v32
    v_fmac_f32 v83, 0xbf54db31, v81
    v_fmac_f32 v51, 0xbf0e39da, v81
    v_sub_f32 v32, v38, v78
    v_sub_f32 v81, v41, v45
    v_add_f32 v38, v38, v78
    v_add_f32 v41, v41, v45
    v_mul_f32 v78, 0xbf3504f3, v32
    v_mul_f32 v45, 0x3f3504f3, v32
    v_fmac_f32 v78, 0xbf3504f3, v81
    v_fmac_f32 v45, 0xbf3504f3, v81
    v_sub_f32 v32, v28, v76
    v_sub_f32 v81, v57, v53
    v_add_f32 v28, v28, v76
    v_add_f32 v57, v57, v53
    v_mul_f32 v76, 0xbf54db31, v32
    v_mul_f32 v53, 0x3f0e39da, v32
    v_fmac_f32 v76, 0xbf0e39da, v81
    v_fmac_f32 v53, 0xbf54db31, v81
    v_sub_f32 v32, v36, v18
    v_sub_f32 v81, v63, v55
    v_add_f32 v36, v36, v18
    v_add_f32 v63, v63, v55
    v_mul_f32 v18, 0xbf6c835e, v32
    v_mul_f32 v55, 0x3ec3ef15, v32
    v_fmac_f32 v18, 0xbec3ef15, v81
    v_fmac_f32 v55, 0xbf6c835e, v81
    v_sub_f32 v32, v64, v72
    v_sub_f32 v81, v67, v59
    v_add_f32 v64, v64, v72
    v_add_f32 v67, v67, v59
    v_mul_f32 v72, 0xbf7b14be, v32
    v_mul_f32 v59, 0x3e47c5c2, v32
    v_fmac_f32 v72, 0xbe47c5c2, v81
    v_fmac_f32 v59, 0xbf7b14be, v81
    v_sub_f32 v32, v82, v54
    v_sub_f32 v81, v17, v43
    v_add_f32 v82, v82, v54
    v_add_f32 v17, v17, v43
    v_sub_f32 v54, v26, v44
    v_sub_f32 v43, v49, v71
    v_add_f32 v26, v26, v44
    v_add_f32 v49, v49, v71
    v_mul_f32 v44, 0x3f6c835e, v54
    v_mul_f32 v71, 0x3ec3ef15, v54
    v_fmac_f32 v44, 0xbec3ef15, v43
    v_fmac_f32 v71, 0x3f6c835e, v43
    v_sub_f32 v54, v16, v52
    v_sub_f32 v43, v19, v61
    v_add_f32 v16, v16, v52
    v_add_f32 v19, v19, v61
    v_mul_f32 v52, 0x3f3504f3, v54
    v_mul_f32 v61, 0x3f3504f3, v54
    v_fmac_f32 v52, 0xbf3504f3, v43
    v_fmac_f32 v61, 0x3f3504f3, v43
    v_sub_f32 v54, v74, v58
    v_sub_f32 v43, v23, v69
    v_add_f32 v74, v74, v58
    v_add_f32 v23, v23, v69
    v_mul_f32 v58, 0x3ec3ef15, v54
    v_mul_f32 v69, 0x3f6c835e, v54
    v_fmac_f32 v58, 0xbf6c835e, v43
    v_fmac_f32 v69, 0x3ec3ef15, v43
    v_sub_f32 v54, v41, v27
    v_sub_f32 v43, v48, v38
    v_add_f32 v48, v48, v38
    v_add_f32 v27, v27, v41
    v_sub_f32 v38, v68, v28
    v_sub_f32 v41, v39, v57
    v_add_f32 v68, v68, v28
    v_add_f32 v39, v39, v57
    v_mul_f32 v28, 0xbec3ef15, v38
    v_mul_f32 v57, 0x3f6c835e, v38
    v_fmac_f32 v28, 0xbf6c835e, v41
    v_fmac_f32 v57, 0xbec3ef15, v41
    v_sub_f32 v38, v62, v36
    v_sub_f32 v41, v29, v63
    v_add_f32 v62, v62, v36
    v_add_f32 v29, v29, v63
    v_mul_f32 v36, 0xbf3504f3, v38
    v_mul_f32 v63, 0x3f3504f3, v38
    v_fmac_f32 v36, 0xbf3504f3, v41
    v_fmac_f32 v63, 0xbf3504f3, v41
    v_sub_f32 v38, v66, v64
    v_sub_f32 v41, v37, v67
    v_add_f32 v66, v66, v64
    v_add_f32 v37, v37, v67
    v_mul_f32 v64, 0xbf6c835e, v38
    v_mul_f32 v67, 0x3ec3ef15, v38
    v_fmac_f32 v64, 0xbec3ef15, v41
    v_fmac_f32 v67, 0xbf6c835e, v41
    v_sub_f32 v38, v70, v24
    v_sub_f32 v41, v79, v75
    v_add_f32 v70, v70, v24
    v_add_f32 v79, v79, v75
    v_sub_f32 v24, v30, v46
    v_sub_f32 v75, v77, v33
    v_add_f32 v30, v30, v46
    v_add_f32 v77, v77, v33
    v_mul_f32 v46, 0x3f6c835e, v24
    v_mul_f32 v33, 0x3ec3ef15, v24
    v_fmac_f32 v46, 0xbec3ef15, v75
    v_fmac_f32 v33, 0x3f6c835e, v75
    v_sub_f32 v24, v34, v50
    v_sub_f32 v75, v73, v47
    v_add_f32 v34, v34, v50
    v_add_f32 v73, v73, v47
    v_mul_f32 v50, 0x3f3504f3, v24
    v_mul_f32 v47, 0x3f3504f3, v24
    v_fmac_f32 v50, 0xbf3504f3, v75
    v_fmac_f32 v47, 0x3f3504f3, v75
    v_sub_f32 v24, v42, v83
    v_sub_f32 v75, v21, v51
    v_add_f32 v42, v42, v83
    v_add_f32 v21, v21, v51
    v_mul_f32 v83, 0x3ec3ef15, v24
    v_mul_f32 v51, 0x3f6c835e, v24
    v_fmac_f32 v83, 0xbf6c835e, v75
    v_fmac_f32 v51, 0x3ec3ef15, v75
    v_sub_f32 v24, v45, v65
    v_sub_f32 v75, v60, v78
    v_add_f32 v60, v60, v78
    v_add_f32 v65, v65, v45
    v_sub_f32 v78, v40, v76
    v_sub_f32 v45, v25, v53
    v_add_f32 v40, v40, v76
    v_add_f32 v25, v25, v53
    v_mul_f32 v76, 0xbec3ef15, v78
    v_mul_f32 v53, 0x3f6c835e, v78
    v_fmac_f32 v76, 0xbf6c835e, v45
    v_fmac_f32 v53, 0xbec3ef15, v45
    v_sub_f32 v78, v56, v18
    v_sub_f32 v45, v31, v55
    v_add_f32 v56, v56, v18
    v_add_f32 v31, v31, v55
    v_mul_f32 v18, 0xbf3504f3, v78
    v_mul_f32 v55, 0x3f3504f3, v78
    v_fmac_f32 v18, 0xbf3504f3, v45
    v_fmac_f32 v55, 0xbf3504f3, v45
    v_sub_f32 v78, v80, v72
    v_sub_f32 v45, v35, v59
    v_add_f32 v80, v80, v72
    v_add_f32 v35, v35, v59
    v_mul_f32 v72, 0xbf6c835e, v78
    v_mul_f32 v59, 0x3ec3ef15, v78
    v_fmac_f32 v72, 0xbec3ef15, v45
    v_fmac_f32 v59, 0xbf6c835e, v45
    v_sub_f32 v78, v82, v48
    v_sub_f32 v45, v17, v27
    v_add_f32 v82, v82, v48
    v_add_f32 v17, v17, v27
    v_sub_f32 v48, v26, v68
    v_sub_f32 v27, v49, v39
    v_add_f32 v26, v26, v68
    v_add_f32 v49, v49, v39
    v_mul_f32 v68, 0x3f3504f3, v48
    v_mul_f32 v39, 0x3f3504f3, v48
    v_fmac_f32 v68, 0xbf3504f3, v27
    v_fmac_f32 v39, 0x3f3504f3, v27
    v_sub_f32 v48, v29, v19
    v_sub_f32 v27, v16, v62
    v_add_f32 v16, v16, v62
    v_add_f32 v19, v19, v29
    v_sub_f32 v62, v74, v66
    v_sub_f32 v29, v23, v37
    v_add_f32 v74, v74, v66
    v_add_f32 v23, v23, v37
    v_mul_f32 v66, 0xbf3504f3, v62
    v_mul_f32 v37, 0x3f3504f3, v62
    v_fmac_f32 v66, 0xbf3504f3, v29
    v_fmac_f32 v37, 0xbf3504f3, v29
    v_sub_f32 v62, v32, v54
    v_sub_f32 v29, v81, v43
    v_add_f32 v32, v32, v54
    v_add_f32 v81, v81, v43
    v_sub_f32 v54, v44, v28
    v_sub_f32 v43, v71, v57
    v_add_f32 v44, v44, v28
    v_add_f32 v71, v71, v57
    v_mul_f32 v28, 0x3f3504f3, v54
    v_mul_f32 v57, 0x3f3504f3, v54
    v_fmac_f32 v28, 0xbf3504f3, v43
    v_fmac_f32 v57, 0x3f3504f3, v43
    v_sub_f32 v54, v63, v61
    v_sub_f32 v43, v52, v36
    v_add_f32 v52, v52, v36
    v_add_f32 v61, v61, v63
    v_sub_f32 v36, v58, v64
    v_sub_f32 v63, v69, v67
    v_add_f32 v58, v58, v64
    v_add_f32 v69, v69, v67
    v_mul_f32 v64, 0xbf3504f3, v36
    v_mul_f32 v67, 0x3f3504f3, v36
    v_fmac_f32 v64, 0xbf3504f3, v63
    v_fmac_f32 v67, 0xbf3504f3, v63
    v_sub_f32 v36, v70, v60
    v_sub_f32 v63, v79, v65
    v_add_f32 v70, v70, v60
    v_add_f32 v79, v79, v65
    v_sub_f32 v60, v30, v40
    v_sub_f32 v65, v77, v25
    v_add_f32 v30, v30, v40
    v_add_f32 v77, v77, v25
    v_mul_f32 v40, 0x3f3504f3, v60
    v_mul_f32 v25, 0x3f3504f3, v60
    v_fmac_f32 v40, 0xbf3504f3, v65
    v_fmac_f32 v25, 0x3f3504f3, v65
    v_sub_f32 v60, v31, v73
    v_sub_f32 v65, v34, v56
    v_add_f32 v34, v34, v56
    v_add_f32 v73, v73, v31
    v_sub_f32 v56, v42, v80
    v_sub_f32 v31, v21, v35
    v_add_f32 v42, v42, v80
    v_add_f32 v21, v21, v35
    v_mul_f32 v80, 0xbf3504f3, v56
    v_mul_f32 v35, 0x3f3504f3, v56
    v_fmac_f32 v80, 0xbf3504f3, v31
    v_fmac_f32 v35, 0xbf3504f3, v31
    v_sub_f32 v56, v38, v24
    v_sub_f32 v31, v41, v75
    v_add_f32 v38, v38, v24
    v_add_f32 v41, v41, v75
    v_sub_f32 v24, v46, v76
    v_sub_f32 v75, v33, v53
    v_add_f32 v46, v46, v76
    v_add_f32 v33, v33, v53
    v_mul_f32 v76, 0x3f3504f3, v24
    v_mul_f32 v53, 0x3f3504f3, v24
    v_fmac_f32 v76, 0xbf3504f3, v75
    v_fmac_f32 v53, 0x3f3504f3, v75
    v_sub_f32 v24, v55, v47
    v_sub_f32 v75, v50, v18
    v_add_f32 v50, v50, v18
    v_add_f32 v47, v47, v55
    v_sub_f32 v18, v83, v72
    v_sub_f32 v55, v51, v59
    v_add_f32 v83, v83, v72
    v_add_f32 v51, v51, v59
    v_mul_f32 v72, 0xbf3504f3, v18
    v_mul_f32 v59, 0x3f3504f3, v18
    v_fmac_f32 v72, 0xbf3504f3, v55
    v_fmac_f32 v59, 0xbf3504f3, v55
    v_sub_f32 v18, v82, v16
    v_sub_f32 v55, v17, v19
    v_add_f32 v82, v82, v16
    v_add_f32 v17, v17, v19
    v_sub_f32 v16, v23, v49
    v_sub_f32 v19, v26, v74
    v_add_f32 v26, v26, v74
    v_add_f32 v49, v49, v23
    v_sub_f32 v74, v78, v48
    v_sub_f32 v23, v45, v27
    v_add_f32 v78, v78, v48
    v_add_f32 v45, v45, v27
    v_sub_f32 v48, v37, v39
    v_sub_f32 v27, v68, v66
    v_add_f32 v68, v68, v66
    v_add_f32 v39, v39, v37
    v_sub_f32 v66, v32, v52
    v_sub_f32 v37, v81, v61
    v_add_f32 v32, v32, v52
    v_add_f32 v81, v81, v61
    v_sub_f32 v52, v69, v71
    v_sub_f32 v61, v44, v58
    v_add_f32 v44, v44, v58
    v_add_f32 v71, v71, v69
    v_sub_f32 v58, v62, v54
    v_sub_f32 v69, v29, v43
    v_add_f32 v62, v62, v54
    v_add_f32 v29, v29, v43
    v_sub_f32 v54, v67, v57
    v_sub_f32 v43, v28, v64
    v_add_f32 v28, v28, v64
    v_add_f32 v57, v57, v67
    v_sub_f32 v64, v70, v34
    v_sub_f32 v67, v79, v73
    v_add_f32 v70, v70, v34
    v_add_f32 v79, v79, v73
    v_sub_f32 v34, v21, v77
    v_sub_f32 v73, v30, v42
    v_add_f32 v30, v30, v42
    v_add_f32 v77, v77, v21
    v_sub_f32 v42, v36, v60
    v_sub_f32 v21, v63, v65
    v_add_f32 v36, v36, v60
    v_add_f32 v63, v63, v65
    v_sub_f32 v60, v35, v25
    v_sub_f32 v65, v40, v80
    v_add_f32 v40, v40, v80
    v_add_f32 v25, v25, v35
    v_sub_f32 v80, v38, v50
    v_sub_f32 v35, v41, v47
    v_add_f32 v38, v38, v50
    v_add_f32 v41, v41, v47
    v_sub_f32 v50, v51, v33
    v_sub_f32 v47, v46, v83
    v_add_f32 v46, v46, v83
    v_add_f32 v33, v33, v51
    v_sub_f32 v83, v56, v24
    v_sub_f32 v51, v31, v75
    v_add_f32 v56, v56, v24
    v_add_f32 v31, v31, v75
    v_sub_f32 v24, v59, v53
    v_sub_f32 v75, v76, v72
    v_add_f32 v76, v76, v72
    v_add_f32 v53, v53, v59
    v_sub_f32 v72, v82, v26
    v_sub_f32 v59, v17, v49
    v_add_f32 v82, v82, v26
    v_add_f32 v17, v17, v49
    v_sub_f32 v26, v18, v16
    v_sub_f32 v49, v55, v19
    v_add_f32 v18, v18, v16
    v_add_f32 v55, v55, v19
    v_sub_f32 v16, v78, v68
    v_sub_f32 v19, v45, v39
    v_add_f32 v78, v78, v68
    v_add_f32 v45, v45, v39
    v_sub_f32 v68, v74, v48
    v_sub_f32 v39, v23, v27
    v_add_f32 v74, v74, v48
    v_add_f32 v23, v23, v27
    v_sub_f32 v48, v32, v44
    v_sub_f32 v27, v81, v71
    v_add_f32 v32, v32, v44
    v_add_f32 v81, v81, v71
    v_sub_f32 v44, v66, v52
    v_sub_f32 v71, v37, v61
    v_add_f32 v66, v66, v52
    v_add_f32 v37, v37, v61
    v_sub_f32 v52, v62, v28
    v_sub_f32 v61, v29, v57
    v_add_f32 v62, v62, v28
    v_add_f32 v29, v29, v57
    v_sub_f32 v28, v58, v54
    v_sub_f32 v57, v69, v43
    v_add_f32 v58, v58, v54
    v_add_f32 v69, v69, v43
    v_sub_f32 v54, v70, v30
    v_sub_f32 v43, v79, v77
    v_add_f32 v70, v70, v30
    v_add_f32 v79, v79, v77
    v_sub_f32 v30, v64, v34
    v_sub_f32 v77, v67, v73
    v_add_f32 v64, v64, v34
    v_add_f32 v67, v67, v73
    v_sub_f32 v34, v36, v40
    v_sub_f32 v73, v63, v25
    v_add_f32 v36, v36, v40
    v_add_f32 v63, v63, v25
    v_sub_f32 v40, v42, v60
    v_sub_f32 v25, v21, v65
    v_add_f32 v42, v42, v60
    v_add_f32 v21, v21, v65
    v_sub_f32 v60, v38, v46
    v_sub_f32 v65, v41, v33
    v_add_f32 v38, v38, v46
    v_add_f32 v41, v41, v33
    v_sub_f32 v46, v80, v50
    v_sub_f32 v33, v35, v47
    v_add_f32 v80, v80, v50
    v_add_f32 v35, v35, v47
    v_sub_f32 v50, v56, v76
    v_sub_f32 v47, v31, v53
    v_add_f32 v56, v56, v76
    v_add_f32 v31, v31, v53
    v_sub_f32 v76, v83, v24
    v_sub_f32 v53, v51, v75
    v_add_f32 v83, v83, v24
    v_add_f32 v51, v51, v75
    v_mul_f32 v12, v10, v8
    v_mul_f32 v12, 0x3a000000, v12
    v_mov_b32 v24, v12
    v_fmac_f32 v24, 0x00000000, v8
    v_cos_f32 v75, v24
    v_sin_f32 v22, v24
    s_nop 0
    v_mul_f32 v20, v82, v75
    v_fma_f32 v20, -v17, v22, v20
    v_mul_f32 v17, v17, v75
    v_fmac_f32 v17, v82, v22
    v_mov_b32 v24, v12
    v_fmac_f32 v24, 0x3a800000, v8
    v_cos_f32 v75, v24
    v_sin_f32 v22, v24
    s_nop 0
    v_mul_f32 v82, v70, v75
    v_fma_f32 v82, -v79, v22, v82
    v_mul_f32 v79, v79, v75
    v_fmac_f32 v79, v70, v22
    v_mov_b32 v24, v12
    v_fmac_f32 v24, 0x3b000000, v8
    v_cos_f32 v75, v24
    v_sin_f32 v22, v24
    s_nop 0
    v_mul_f32 v70, v32, v75
    v_fma_f32 v70, -v81, v22, v70
    v_mul_f32 v81, v81, v75
    v_fmac_f32 v81, v32, v22
    v_mov_b32 v24, v12
    v_fmac_f32 v24, 0x3b400000, v8
    v_cos_f32 v75, v24
    v_sin_f32 v22, v24
    s_nop 0
    v_mul_f32 v32, v38, v75
    v_fma_f32 v32, -v41, v22, v32
    v_mul_f32 v41, v41, v75
    v_fmac_f32 v41, v38, v22
    v_mov_b32 v24, v12
    v_fmac_f32 v24, 0x3b800000, v8
    v_cos_f32 v75, v24
    v_sin_f32 v22, v24
    s_nop 0
    v_mul_f32 v38, v78, v75
    v_fma_f32 v38, -v45, v22, v38
    v_mul_f32 v45, v45, v75
    v_fmac_f32 v45, v78, v22
    v_mov_b32 v24, v12
    v_fmac_f32 v24, 0x3ba00000, v8
    v_cos_f32 v75, v24
    v_sin_f32 v22, v24
    s_nop 0
    v_mul_f32 v78, v36, v75
    v_fma_f32 v78, -v63, v22, v78
    v_mul_f32 v63, v63, v75
    v_fmac_f32 v63, v36, v22
    v_mov_b32 v24, v12
    v_fmac_f32 v24, 0x3bc00000, v8
    v_cos_f32 v75, v24
    v_sin_f32 v22, v24
    s_nop 0
    v_mul_f32 v36, v62, v75
    v_fma_f32 v36, -v29, v22, v36
    v_mul_f32 v29, v29, v75
    v_fmac_f32 v29, v62, v22
    v_mov_b32 v24, v12
    v_fmac_f32 v24, 0x3be00000, v8
    v_cos_f32 v75, v24
    v_sin_f32 v22, v24
    s_nop 0
    v_mul_f32 v62, v56, v75
    v_fma_f32 v62, -v31, v22, v62
    v_mul_f32 v31, v31, v75
    v_fmac_f32 v31, v56, v22
    v_mov_b32 v24, v12
    v_fmac_f32 v24, 0x3c000000, v8
    v_cos_f32 v75, v24
    v_sin_f32 v22, v24
    s_nop 0
    v_mul_f32 v56, v18, v75
    v_fma_f32 v56, -v55, v22, v56
    v_mul_f32 v55, v55, v75
    v_fmac_f32 v55, v18, v22
    v_mov_b32 v24, v12
    v_fmac_f32 v24, 0x3c100000, v8
    v_cos_f32 v75, v24
    v_sin_f32 v22, v24
    s_nop 0
    v_mul_f32 v18, v64, v75
    v_fma_f32 v18, -v67, v22, v18
    v_mul_f32 v67, v67, v75
    v_fmac_f32 v67, v64, v22
    v_mov_b32 v24, v12
    v_fmac_f32 v24, 0x3c200000, v8
    v_cos_f32 v75, v24
    v_sin_f32 v22, v24
    s_nop 0
    v_mul_f32 v64, v66, v75
    v_fma_f32 v64, -v37, v22, v64
    v_mul_f32 v37, v37, v75
    v_fmac_f32 v37, v66, v22
    v_mov_b32 v24, v12
    v_fmac_f32 v24, 0x3c300000, v8
    v_cos_f32 v75, v24
    v_sin_f32 v22, v24
    s_nop 0
    v_mul_f32 v66, v80, v75
    v_fma_f32 v66, -v35, v22, v66
    v_mul_f32 v35, v35, v75
    v_fmac_f32 v35, v80, v22
    v_mov_b32 v24, v12
    v_fmac_f32 v24, 0x3c400000, v8
    v_cos_f32 v75, v24
    v_sin_f32 v22, v24
    s_nop 0
    v_mul_f32 v80, v74, v75
    v_fma_f32 v80, -v23, v22, v80
    v_mul_f32 v23, v23, v75
    v_fmac_f32 v23, v74, v22
    v_mov_b32 v24, v12
    v_fmac_f32 v24, 0x3c500000, v8
    v_cos_f32 v75, v24
    v_sin_f32 v22, v24
    s_nop 0
    v_mul_f32 v74, v42, v75
    v_fma_f32 v74, -v21, v22, v74
    v_mul_f32 v21, v21, v75
    v_fmac_f32 v21, v42, v22
    v_mov_b32 v24, v12
    v_fmac_f32 v24, 0x3c600000, v8
    v_cos_f32 v75, v24
    v_sin_f32 v22, v24
    s_nop 0
    v_mul_f32 v42, v58, v75
    v_fma_f32 v42, -v69, v22, v42
    v_mul_f32 v69, v69, v75
    v_fmac_f32 v69, v58, v22
    v_mov_b32 v24, v12
    v_fmac_f32 v24, 0x3c700000, v8
    v_cos_f32 v75, v24
    v_sin_f32 v22, v24
    s_nop 0
    v_mul_f32 v58, v83, v75
    v_fma_f32 v58, -v51, v22, v58
    v_mul_f32 v51, v51, v75
    v_fmac_f32 v51, v83, v22
    v_mov_b32 v24, v12
    v_fmac_f32 v24, 0x3c800000, v8
    v_cos_f32 v75, v24
    v_sin_f32 v22, v24
    s_nop 0
    v_mul_f32 v83, v72, v75
    v_fma_f32 v83, -v59, v22, v83
    v_mul_f32 v59, v59, v75
    v_fmac_f32 v59, v72, v22
    v_mov_b32 v24, v12
    v_fmac_f32 v24, 0x3c880000, v8
    v_cos_f32 v75, v24
    v_sin_f32 v22, v24
    s_nop 0
    v_mul_f32 v72, v54, v75
    v_fma_f32 v72, -v43, v22, v72
    v_mul_f32 v43, v43, v75
    v_fmac_f32 v43, v54, v22
    v_mov_b32 v24, v12
    v_fmac_f32 v24, 0x3c900000, v8
    v_cos_f32 v75, v24
    v_sin_f32 v22, v24
    s_nop 0
    v_mul_f32 v54, v48, v75
    v_fma_f32 v54, -v27, v22, v54
    v_mul_f32 v27, v27, v75
    v_fmac_f32 v27, v48, v22
    v_mov_b32 v24, v12
    v_fmac_f32 v24, 0x3c980000, v8
    v_cos_f32 v75, v24
    v_sin_f32 v22, v24
    s_nop 0
    v_mul_f32 v48, v60, v75
    v_fma_f32 v48, -v65, v22, v48
    v_mul_f32 v65, v65, v75
    v_fmac_f32 v65, v60, v22
    v_mov_b32 v24, v12
    v_fmac_f32 v24, 0x3ca00000, v8
    v_cos_f32 v75, v24
    v_sin_f32 v22, v24
    s_nop 0
    v_mul_f32 v60, v16, v75
    v_fma_f32 v60, -v19, v22, v60
    v_mul_f32 v19, v19, v75
    v_fmac_f32 v19, v16, v22
    v_mov_b32 v24, v12
    v_fmac_f32 v24, 0x3ca80000, v8
    v_cos_f32 v75, v24
    v_sin_f32 v22, v24
    s_nop 0
    v_mul_f32 v16, v34, v75
    v_fma_f32 v16, -v73, v22, v16
    v_mul_f32 v73, v73, v75
    v_fmac_f32 v73, v34, v22
    v_mov_b32 v24, v12
    v_fmac_f32 v24, 0x3cb00000, v8
    v_cos_f32 v75, v24
    v_sin_f32 v22, v24
    s_nop 0
    v_mul_f32 v34, v52, v75
    v_fma_f32 v34, -v61, v22, v34
    v_mul_f32 v61, v61, v75
    v_fmac_f32 v61, v52, v22
    v_mov_b32 v24, v12
    v_fmac_f32 v24, 0x3cb80000, v8
    v_cos_f32 v75, v24
    v_sin_f32 v22, v24
    s_nop 0
    v_mul_f32 v52, v50, v75
    v_fma_f32 v52, -v47, v22, v52
    v_mul_f32 v47, v47, v75
    v_fmac_f32 v47, v50, v22
    v_mov_b32 v24, v12
    v_fmac_f32 v24, 0x3cc00000, v8
    v_cos_f32 v75, v24
    v_sin_f32 v22, v24
    s_nop 0
    v_mul_f32 v50, v26, v75
    v_fma_f32 v50, -v49, v22, v50
    v_mul_f32 v49, v49, v75
    v_fmac_f32 v49, v26, v22
    v_mov_b32 v24, v12
    v_fmac_f32 v24, 0x3cc80000, v8
    v_cos_f32 v75, v24
    v_sin_f32 v22, v24
    s_nop 0
    v_mul_f32 v26, v30, v75
    v_fma_f32 v26, -v77, v22, v26
    v_mul_f32 v77, v77, v75
    v_fmac_f32 v77, v30, v22
    v_mov_b32 v24, v12
    v_fmac_f32 v24, 0x3cd00000, v8
    v_cos_f32 v75, v24
    v_sin_f32 v22, v24
    s_nop 0
    v_mul_f32 v30, v44, v75
    v_fma_f32 v30, -v71, v22, v30
    v_mul_f32 v71, v71, v75
    v_fmac_f32 v71, v44, v22
    v_mov_b32 v24, v12
    v_fmac_f32 v24, 0x3cd80000, v8
    v_cos_f32 v75, v24
    v_sin_f32 v22, v24
    s_nop 0
    v_mul_f32 v44, v46, v75
    v_fma_f32 v44, -v33, v22, v44
    v_mul_f32 v33, v33, v75
    v_fmac_f32 v33, v46, v22
    v_mov_b32 v24, v12
    v_fmac_f32 v24, 0x3ce00000, v8
    v_cos_f32 v75, v24
    v_sin_f32 v22, v24
    s_nop 0
    v_mul_f32 v46, v68, v75
    v_fma_f32 v46, -v39, v22, v46
    v_mul_f32 v39, v39, v75
    v_fmac_f32 v39, v68, v22
    v_mov_b32 v24, v12
    v_fmac_f32 v24, 0x3ce80000, v8
    v_cos_f32 v75, v24
    v_sin_f32 v22, v24
    s_nop 0
    v_mul_f32 v68, v40, v75
    v_fma_f32 v68, -v25, v22, v68
    v_mul_f32 v25, v25, v75
    v_fmac_f32 v25, v40, v22
    v_mov_b32 v24, v12
    v_fmac_f32 v24, 0x3cf00000, v8
    v_cos_f32 v75, v24
    v_sin_f32 v22, v24
    s_nop 0
    v_mul_f32 v40, v28, v75
    v_fma_f32 v40, -v57, v22, v40
    v_mul_f32 v57, v57, v75
    v_fmac_f32 v57, v28, v22
    v_mov_b32 v24, v12
    v_fmac_f32 v24, 0x3cf80000, v8
    v_cos_f32 v75, v24
    v_sin_f32 v22, v24
    s_nop 0
    v_mul_f32 v28, v76, v75
    v_fma_f32 v28, -v53, v22, v28
    v_mul_f32 v53, v53, v75
    v_fmac_f32 v53, v76, v22
    ds_write_b32 v4, v20 offset:0
    ds_write_b32 v4, v17 offset:4
    ds_write_b32 v4, v82 offset:16
    ds_write_b32 v4, v79 offset:20
    ds_write_b32 v4, v70 offset:32
    ds_write_b32 v4, v81 offset:36
    ds_write_b32 v4, v32 offset:48
    ds_write_b32 v4, v41 offset:52
    ds_write_b32 v4, v38 offset:64
    ds_write_b32 v4, v45 offset:68
    ds_write_b32 v4, v78 offset:80
    ds_write_b32 v4, v63 offset:84
    ds_write_b32 v4, v36 offset:96
    ds_write_b32 v4, v29 offset:100
    ds_write_b32 v4, v62 offset:112
    ds_write_b32 v4, v31 offset:116
    ds_write_b32 v4, v56 offset:128
    ds_write_b32 v4, v55 offset:132
    ds_write_b32 v4, v18 offset:144
    ds_write_b32 v4, v67 offset:148
    ds_write_b32 v4, v64 offset:160
    ds_write_b32 v4, v37 offset:164
    ds_write_b32 v4, v66 offset:176
    ds_write_b32 v4, v35 offset:180
    ds_write_b32 v4, v80 offset:192
    ds_write_b32 v4, v23 offset:196
    ds_write_b32 v4, v74 offset:208
    ds_write_b32 v4, v21 offset:212
    ds_write_b32 v4, v42 offset:224
    ds_write_b32 v4, v69 offset:228
    ds_write_b32 v4, v58 offset:240
    ds_write_b32 v4, v51 offset:244
    ds_write_b32 v4, v83 offset:256
    ds_write_b32 v4, v59 offset:260
    ds_write_b32 v4, v72 offset:272
    ds_write_b32 v4, v43 offset:276
    ds_write_b32 v4, v54 offset:288
    ds_write_b32 v4, v27 offset:292
    ds_write_b32 v4, v48 offset:304
    ds_write_b32 v4, v65 offset:308
    ds_write_b32 v4, v60 offset:320
    ds_write_b32 v4, v19 offset:324
    ds_write_b32 v4, v16 offset:336
    ds_write_b32 v4, v73 offset:340
    ds_write_b32 v4, v34 offset:352
    ds_write_b32 v4, v61 offset:356
    ds_write_b32 v4, v52 offset:368
    ds_write_b32 v4, v47 offset:372
    ds_write_b32 v4, v50 offset:384
    ds_write_b32 v4, v49 offset:388
    ds_write_b32 v4, v26 offset:400
    ds_write_b32 v4, v77 offset:404
    ds_write_b32 v4, v30 offset:416
    ds_write_b32 v4, v71 offset:420
    ds_write_b32 v4, v44 offset:432
    ds_write_b32 v4, v33 offset:436
    ds_write_b32 v4, v46 offset:448
    ds_write_b32 v4, v39 offset:452
    ds_write_b32 v4, v68 offset:464
    ds_write_b32 v4, v25 offset:468
    ds_write_b32 v4, v40 offset:480
    ds_write_b32 v4, v57 offset:484
    ds_write_b32 v4, v28 offset:496
    ds_write_b32 v4, v53 offset:500
    s_waitcnt lgkmcnt(0)
    ds_read_b32 v20, v3 offset:0
    ds_read_b32 v17, v3 offset:4
    ds_read_b32 v82, v3 offset:528
    ds_read_b32 v79, v3 offset:532
    ds_read_b32 v70, v3 offset:1056
    ds_read_b32 v81, v3 offset:1060
    ds_read_b32 v32, v3 offset:1584
    ds_read_b32 v41, v3 offset:1588
    ds_read_b32 v38, v3 offset:2112
    ds_read_b32 v45, v3 offset:2116
    ds_read_b32 v78, v3 offset:2640
    ds_read_b32 v63, v3 offset:2644
    ds_read_b32 v36, v3 offset:3168
    ds_read_b32 v29, v3 offset:3172
    s_waitcnt lgkmcnt(0)
    ds_read_b32 v62, v3 offset:3696
    ds_read_b32 v31, v3 offset:3700
    ds_read_b32 v56, v3 offset:4224
    ds_read_b32 v55, v3 offset:4228
    ds_read_b32 v18, v3 offset:4752
    ds_read_b32 v67, v3 offset:4756
    ds_read_b32 v64, v3 offset:5280
    ds_read_b32 v37, v3 offset:5284
    ds_read_b32 v66, v3 offset:5808
    ds_read_b32 v35, v3 offset:5812
    ds_read_b32 v80, v3 offset:6336
    ds_read_b32 v23, v3 offset:6340
    ds_read_b32 v74, v3 offset:6864
    ds_read_b32 v21, v3 offset:6868
    s_waitcnt lgkmcnt(0)
    ds_read_b32 v42, v3 offset:7392
    ds_read_b32 v69, v3 offset:7396
    ds_read_b32 v58, v3 offset:7920
    ds_read_b32 v51, v3 offset:7924
    ds_read_b32 v83, v3 offset:8448
    ds_read_b32 v59, v3 offset:8452
    ds_read_b32 v72, v3 offset:8976
    ds_read_b32 v43, v3 offset:8980
    ds_read_b32 v54, v3 offset:9504
    ds_read_b32 v27, v3 offset:9508
    ds_read_b32 v48, v3 offset:10032
    ds_read_b32 v65, v3 offset:10036
    ds_read_b32 v60, v3 offset:10560
    ds_read_b32 v19, v3 offset:10564
    s_waitcnt lgkmcnt(0)
    ds_read_b32 v16, v3 offset:11088
    ds_read_b32 v73, v3 offset:11092
    ds_read_b32 v34, v3 offset:11616
    ds_read_b32 v61, v3 offset:11620
    ds_read_b32 v52, v3 offset:12144
    ds_read_b32 v47, v3 offset:12148
    ds_read_b32 v50, v3 offset:12672
    ds_read_b32 v49, v3 offset:12676
    ds_read_b32 v26, v3 offset:13200
    ds_read_b32 v77, v3 offset:13204
    ds_read_b32 v30, v3 offset:13728
    ds_read_b32 v71, v3 offset:13732
    ds_read_b32 v44, v3 offset:14256
    ds_read_b32 v33, v3 offset:14260
    s_waitcnt lgkmcnt(0)
    ds_read_b32 v46, v3 offset:14784
    ds_read_b32 v39, v3 offset:14788
    ds_read_b32 v68, v3 offset:15312
    ds_read_b32 v25, v3 offset:15316
    ds_read_b32 v40, v3 offset:15840
    ds_read_b32 v57, v3 offset:15844
    ds_read_b32 v28, v3 offset:16368
    ds_read_b32 v53, v3 offset:16372
    s_waitcnt lgkmcnt(0)
    v_sub_f32 v24, v20, v83
    v_sub_f32 v75, v17, v59
    v_add_f32 v20, v20, v83
    v_add_f32 v17, v17, v59
    v_sub_f32 v83, v82, v72
    v_sub_f32 v59, v79, v43
    v_add_f32 v82, v82, v72
    v_add_f32 v79, v79, v43
    v_mul_f32 v72, 0x3f7b14be, v83
    v_mul_f32 v43, 0x3e47c5c2, v83
    v_fmac_f32 v72, 0xbe47c5c2, v59
    v_fmac_f32 v43, 0x3f7b14be, v59
    v_sub_f32 v83, v70, v54
    v_sub_f32 v59, v81, v27
    v_add_f32 v70, v70, v54
    v_add_f32 v81, v81, v27
    v_mul_f32 v54, 0x3f6c835e, v83
    v_mul_f32 v27, 0x3ec3ef15, v83
    v_fmac_f32 v54, 0xbec3ef15, v59
    v_fmac_f32 v27, 0x3f6c835e, v59
    v_sub_f32 v83, v32, v48
    v_sub_f32 v59, v41, v65
    v_add_f32 v32, v32, v48
    v_add_f32 v41, v41, v65
    v_mul_f32 v48, 0x3f54db31, v83
    v_mul_f32 v65, 0x3f0e39da, v83
    v_fmac_f32 v48, 0xbf0e39da, v59
    v_fmac_f32 v65, 0x3f54db31, v59
    v_sub_f32 v83, v38, v60
    v_sub_f32 v59, v45, v19
    v_add_f32 v38, v38, v60
    v_add_f32 v45, v45, v19
    v_mul_f32 v60, 0x3f3504f3, v83
    v_mul_f32 v19, 0x3f3504f3, v83
    v_fmac_f32 v60, 0xbf3504f3, v59
    v_fmac_f32 v19, 0x3f3504f3, v59
    v_sub_f32 v83, v78, v16
    v_sub_f32 v59, v63, v73
    v_add_f32 v78, v78, v16
    v_add_f32 v63, v63, v73
    v_mul_f32 v16, 0x3f0e39da, v83
    v_mul_f32 v73, 0x3f54db31, v83
    v_fmac_f32 v16, 0xbf54db31, v59
    v_fmac_f32 v73, 0x3f0e39da, v59
    v_sub_f32 v83, v36, v34
    v_sub_f32 v59, v29, v61
    v_add_f32 v36, v36, v34
    v_add_f32 v29, v29, v61
    v_mul_f32 v34, 0x3ec3ef15, v83
    v_mul_f32 v61, 0x3f6c835e, v83
    v_fmac_f32 v34, 0xbf6c835e, v59
    v_fmac_f32 v61, 0x3ec3ef15, v59
    v_sub_f32 v83, v62, v52
    v_sub_f32 v59, v31, v47
    v_add_f32 v62, v62, v52
    v_add_f32 v31, v31, v47
    v_mul_f32 v52, 0x3e47c5c2, v83
    v_mul_f32 v47, 0x3f7b14be, v83
    v_fmac_f32 v52, 0xbf7b14be, v59
    v_fmac_f32 v47, 0x3e47c5c2, v59
    v_sub_f32 v83, v49, v55
    v_sub_f32 v59, v56, v50
    v_add_f32 v56, v56, v50
    v_add_f32 v55, v55, v49
    v_sub_f32 v50, v18, v26
    v_sub_f32 v49, v67, v77
    v_add_f32 v18, v18, v26
    v_add_f32 v67, v67, v77
    v_mul_f32 v26, 0xbe47c5c2, v50
    v_mul_f32 v77, 0x3f7b14be, v50
    v_fmac_f32 v26, 0xbf7b14be, v49
    v_fmac_f32 v77, 0xbe47c5c2, v49
    v_sub_f32 v50, v64, v30
    v_sub_f32 v49, v37, v71
    v_add_f32 v64, v64, v30
    v_add_f32 v37, v37, v71
    v_mul_f32 v30, 0xbec3ef15, v50
    v_mul_f32 v71, 0x3f6c835e, v50
    v_fmac_f32 v30, 0xbf6c835e, v49
    v_fmac_f32 v71, 0xbec3ef15, v49
    v_sub_f32 v50, v66, v44
    v_sub_f32 v49, v35, v33
    v_add_f32 v66, v66, v44
    v_add_f32 v35, v35, v33
    v_mul_f32 v44, 0xbf0e39da, v50
    v_mul_f32 v33, 0x3f54db31, v50
    v_fmac_f32 v44, 0xbf54db31, v49
    v_fmac_f32 v33, 0xbf0e39da, v49
    v_sub_f32 v50, v80, v46
    v_sub_f32 v49, v23, v39
    v_add_f32 v80, v80, v46
    v_add_f32 v23, v23, v39
    v_mul_f32 v46, 0xbf3504f3, v50
    v_mul_f32 v39, 0x3f3504f3, v50
    v_fmac_f32 v46, 0xbf3504f3, v49
    v_fmac_f32 v39, 0xbf3504f3, v49
    v_sub_f32 v50, v74, v68
    v_sub_f32 v49, v21, v25
    v_add_f32 v74, v74, v68
    v_add_f32 v21, v21, v25
    v_mul_f32 v68, 0xbf54db31, v50
    v_mul_f32 v25, 0x3f0e39da, v50
    v_fmac_f32 v68, 0xbf0e39da, v49
    v_fmac_f32 v25, 0xbf54db31, v49
    v_sub_f32 v50, v42, v40
    v_sub_f32 v49, v69, v57
    v_add_f32 v42, v42, v40
    v_add_f32 v69, v69, v57
    v_mul_f32 v40, 0xbf6c835e, v50
    v_mul_f32 v57, 0x3ec3ef15, v50
    v_fmac_f32 v40, 0xbec3ef15, v49
    v_fmac_f32 v57, 0xbf6c835e, v49
    v_sub_f32 v50, v58, v28
    v_sub_f32 v49, v51, v53
    v_add_f32 v58, v58, v28
    v_add_f32 v51, v51, v53
    v_mul_f32 v28, 0xbf7b14be, v50
    v_mul_f32 v53, 0x3e47c5c2, v50
    v_fmac_f32 v28, 0xbe47c5c2, v49
    v_fmac_f32 v53, 0xbf7b14be, v49
    v_sub_f32 v50, v20, v56
    v_sub_f32 v49, v17, v55
    v_add_f32 v20, v20, v56
    v_add_f32 v17, v17, v55
    v_sub_f32 v56, v82, v18
    v_sub_f32 v55, v79, v67
    v_add_f32 v82, v82, v18
    v_add_f32 v79, v79, v67
    v_mul_f32 v18, 0x3f6c835e, v56
    v_mul_f32 v67, 0x3ec3ef15, v56
    v_fmac_f32 v18, 0xbec3ef15, v55
    v_fmac_f32 v67, 0x3f6c835e, v55
    v_sub_f32 v56, v70, v64
    v_sub_f32 v55, v81, v37
    v_add_f32 v70, v70, v64
    v_add_f32 v81, v81, v37
    v_mul_f32 v64, 0x3f3504f3, v56
    v_mul_f32 v37, 0x3f3504f3, v56
    v_fmac_f32 v64, 0xbf3504f3, v55
    v_fmac_f32 v37, 0x3f3504f3, v55
    v_sub_f32 v56, v32, v66
    v_sub_f32 v55, v41, v35
    v_add_f32 v32, v32, v66
    v_add_f32 v41, v41, v35
    v_mul_f32 v66, 0x3ec3ef15, v56
    v_mul_f32 v35, 0x3f6c835e, v56
    v_fmac_f32 v66, 0xbf6c835e, v55
    v_fmac_f32 v35, 0x3ec3ef15, v55
    v_sub_f32 v56, v23, v45
    v_sub_f32 v55, v38, v80
    v_add_f32 v38, v38, v80
    v_add_f32 v45, v45, v23
    v_sub_f32 v80, v78, v74
    v_sub_f32 v23, v63, v21
    v_add_f32 v78, v78, v74
    v_add_f32 v63, v63, v21
    v_mul_f32 v74, 0xbec3ef15, v80
    v_mul_f32 v21, 0x3f6c835e, v80
    v_fmac_f32 v74, 0xbf6c835e, v23
    v_fmac_f32 v21, 0xbec3ef15, v23
    v_sub_f32 v80, v36, v42
    v_sub_f32 v23, v29, v69
    v_add_f32 v36, v36, v42
    v_add_f32 v29, v29, v69
    v_mul_f32 v42, 0xbf3504f3, v80
    v_mul_f32 v69, 0x3f3504f3, v80
    v_fmac_f32 v42, 0xbf3504f3, v23
    v_fmac_f32 v69, 0xbf3504f3, v23
    v_sub_f32 v80, v62, v58
    v_sub_f32 v23, v31, v51
    v_add_f32 v62, v62, v58
    v_add_f32 v31, v31, v51
    v_mul_f32 v58, 0xbf6c835e, v80
    v_mul_f32 v51, 0x3ec3ef15, v80
    v_fmac_f32 v58, 0xbec3ef15, v23
    v_fmac_f32 v51, 0xbf6c835e, v23
    v_sub_f32 v80, v24, v83
    v_sub_f32 v23, v75, v59
    v_add_f32 v24, v24, v83
    v_add_f32 v75, v75, v59
    v_sub_f32 v83, v72, v26
    v_sub_f32 v59, v43, v77
    v_add_f32 v72, v72, v26
    v_add_f32 v43, v43, v77
    v_mul_f32 v26, 0x3f6c835e, v83
    v_mul_f32 v77, 0x3ec3ef15, v83
    v_fmac_f32 v26, 0xbec3ef15, v59
    v_fmac_f32 v77, 0x3f6c835e, v59
    v_sub_f32 v83, v54, v30
    v_sub_f32 v59, v27, v71
    v_add_f32 v54, v54, v30
    v_add_f32 v27, v27, v71
    v_mul_f32 v30, 0x3f3504f3, v83
    v_mul_f32 v71, 0x3f3504f3, v83
    v_fmac_f32 v30, 0xbf3504f3, v59
    v_fmac_f32 v71, 0x3f3504f3, v59
    v_sub_f32 v83, v48, v44
    v_sub_f32 v59, v65, v33
    v_add_f32 v48, v48, v44
    v_add_f32 v65, v65, v33
    v_mul_f32 v44, 0x3ec3ef15, v83
    v_mul_f32 v33, 0x3f6c835e, v83
    v_fmac_f32 v44, 0xbf6c835e, v59
    v_fmac_f32 v33, 0x3ec3ef15, v59
    v_sub_f32 v83, v39, v19
    v_sub_f32 v59, v60, v46
    v_add_f32 v60, v60, v46
    v_add_f32 v19, v19, v39
    v_sub_f32 v46, v16, v68
    v_sub_f32 v39, v73, v25
    v_add_f32 v16, v16, v68
    v_add_f32 v73, v73, v25
    v_mul_f32 v68, 0xbec3ef15, v46
    v_mul_f32 v25, 0x3f6c835e, v46
    v_fmac_f32 v68, 0xbf6c835e, v39
    v_fmac_f32 v25, 0xbec3ef15, v39
    v_sub_f32 v46, v34, v40
    v_sub_f32 v39, v61, v57
    v_add_f32 v34, v34, v40
    v_add_f32 v61, v61, v57
    v_mul_f32 v40, 0xbf3504f3, v46
    v_mul_f32 v57, 0x3f3504f3, v46
    v_fmac_f32 v40, 0xbf3504f3, v39
    v_fmac_f32 v57, 0xbf3504f3, v39
    v_sub_f32 v46, v52, v28
    v_sub_f32 v39, v47, v53
    v_add_f32 v52, v52, v28
    v_add_f32 v47, v47, v53
    v_mul_f32 v28, 0xbf6c835e, v46
    v_mul_f32 v53, 0x3ec3ef15, v46
    v_fmac_f32 v28, 0xbec3ef15, v39
    v_fmac_f32 v53, 0xbf6c835e, v39
    v_sub_f32 v46, v20, v38
    v_sub_f32 v39, v17, v45
    v_add_f32 v20, v20, v38
    v_add_f32 v17, v17, v45
    v_sub_f32 v38, v82, v78
    v_sub_f32 v45, v79, v63
    v_add_f32 v82, v82, v78
    v_add_f32 v79, v79, v63
    v_mul_f32 v78, 0x3f3504f3, v38
    v_mul_f32 v63, 0x3f3504f3, v38
    v_fmac_f32 v78, 0xbf3504f3, v45
    v_fmac_f32 v63, 0x3f3504f3, v45
    v_sub_f32 v38, v29, v81
    v_sub_f32 v45, v70, v36
    v_add_f32 v70, v70, v36
    v_add_f32 v81, v81, v29
    v_sub_f32 v36, v32, v62
    v_sub_f32 v29, v41, v31
    v_add_f32 v32, v32, v62
    v_add_f32 v41, v41, v31
    v_mul_f32 v62, 0xbf3504f3, v36
    v_mul_f32 v31, 0x3f3504f3, v36
    v_fmac_f32 v62, 0xbf3504f3, v29
    v_fmac_f32 v31, 0xbf3504f3, v29
    v_sub_f32 v36, v50, v56
    v_sub_f32 v29, v49, v55
    v_add_f32 v50, v50, v56
    v_add_f32 v49, v49, v55
    v_sub_f32 v56, v18, v74
    v_sub_f32 v55, v67, v21
    v_add_f32 v18, v18, v74
    v_add_f32 v67, v67, v21
    v_mul_f32 v74, 0x3f3504f3, v56
    v_mul_f32 v21, 0x3f3504f3, v56
    v_fmac_f32 v74, 0xbf3504f3, v55
    v_fmac_f32 v21, 0x3f3504f3, v55
    v_sub_f32 v56, v69, v37
    v_sub_f32 v55, v64, v42
    v_add_f32 v64, v64, v42
    v_add_f32 v37, v37, v69
    v_sub_f32 v42, v66, v58
    v_sub_f32 v69, v35, v51
    v_add_f32 v66, v66, v58
    v_add_f32 v35, v35, v51
    v_mul_f32 v58, 0xbf3504f3, v42
    v_mul_f32 v51, 0x3f3504f3, v42
    v_fmac_f32 v58, 0xbf3504f3, v69
    v_fmac_f32 v51, 0xbf3504f3, v69
    v_sub_f32 v42, v24, v60
    v_sub_f32 v69, v75, v19
    v_add_f32 v24, v24, v60
    v_add_f32 v75, v75, v19
    v_sub_f32 v60, v72, v16
    v_sub_f32 v19, v43, v73
    v_add_f32 v72, v72, v16
    v_add_f32 v43, v43, v73
    v_mul_f32 v16, 0x3f3504f3, v60
    v_mul_f32 v73, 0x3f3504f3, v60
    v_fmac_f32 v16, 0xbf3504f3, v19
    v_fmac_f32 v73, 0x3f3504f3, v19
    v_sub_f32 v60, v61, v27
    v_sub_f32 v19, v54, v34
    v_add_f32 v54, v54, v34
    v_add_f32 v27, v27, v61
    v_sub_f32 v34, v48, v52
    v_sub_f32 v61, v65, v47
    v_add_f32 v48, v48, v52
    v_add_f32 v65, v65, v47
    v_mul_f32 v52, 0xbf3504f3, v34
    v_mul_f32 v47, 0x3f3504f3, v34
    v_fmac_f32 v52, 0xbf3504f3, v61
    v_fmac_f32 v47, 0xbf3504f3, v61
    v_sub_f32 v34, v80, v83
    v_sub_f32 v61, v23, v59
    v_add_f32 v80, v80, v83
    v_add_f32 v23, v23, v59
    v_sub_f32 v83, v26, v68
    v_sub_f32 v59, v77, v25
    v_add_f32 v26, v26, v68
    v_add_f32 v77, v77, v25
    v_mul_f32 v68, 0x3f3504f3, v83
    v_mul_f32 v25, 0x3f3504f3, v83
    v_fmac_f32 v68, 0xbf3504f3, v59
    v_fmac_f32 v25, 0x3f3504f3, v59
    v_sub_f32 v83, v57, v71
    v_sub_f32 v59, v30, v40
    v_add_f32 v30, v30, v40
    v_add_f32 v71, v71, v57
    v_sub_f32 v40, v44, v28
    v_sub_f32 v57, v33, v53
    v_add_f32 v44, v44, v28
    v_add_f32 v33, v33, v53
    v_mul_f32 v28, 0xbf3504f3, v40
    v_mul_f32 v53, 0x3f3504f3, v40
    v_fmac_f32 v28, 0xbf3504f3, v57
    v_fmac_f32 v53, 0xbf3504f3, v57
    v_sub_f32 v40, v20, v70
    v_sub_f32 v57, v17, v81
    v_add_f32 v20, v20, v70
    v_add_f32 v17, v17, v81
    v_sub_f32 v70, v41, v79
    v_sub_f32 v81, v82, v32
    v_add_f32 v82, v82, v32
    v_add_f32 v79, v79, v41
    v_sub_f32 v32, v46, v38
    v_sub_f32 v41, v39, v45
    v_add_f32 v46, v46, v38
    v_add_f32 v39, v39, v45
    v_sub_f32 v38, v31, v63
    v_sub_f32 v45, v78, v62
    v_add_f32 v78, v78, v62
    v_add_f32 v63, v63, v31
    v_sub_f32 v62, v50, v64
    v_sub_f32 v31, v49, v37
    v_add_f32 v50, v50, v64
    v_add_f32 v49, v49, v37
    v_sub_f32 v64, v35, v67
    v_sub_f32 v37, v18, v66
    v_add_f32 v18, v18, v66
    v_add_f32 v67, v67, v35
    v_sub_f32 v66, v36, v56
    v_sub_f32 v35, v29, v55
    v_add_f32 v36, v36, v56
    v_add_f32 v29, v29, v55
    v_sub_f32 v56, v51, v21
    v_sub_f32 v55, v74, v58
    v_add_f32 v74, v74, v58
    v_add_f32 v21, v21, v51
    v_sub_f32 v58, v24, v54
    v_sub_f32 v51, v75, v27
    v_add_f32 v24, v24, v54
    v_add_f32 v75, v75, v27
    v_sub_f32 v54, v65, v43
    v_sub_f32 v27, v72, v48
    v_add_f32 v72, v72, v48
    v_add_f32 v43, v43, v65
    v_sub_f32 v48, v42, v60
    v_sub_f32 v65, v69, v19
    v_add_f32 v42, v42, v60
    v_add_f32 v69, v69, v19
    v_sub_f32 v60, v47, v73
    v_sub_f32 v19, v16, v52
    v_add_f32 v16, v16, v52
    v_add_f32 v73, v73, v47
    v_sub_f32 v52, v80, v30
    v_sub_f32 v47, v23, v71
    v_add_f32 v80, v80, v30
    v_add_f32 v23, v23, v71
    v_sub_f32 v30, v33, v77
    v_sub_f32 v71, v26, v44
    v_add_f32 v26, v26, v44
    v_add_f32 v77, v77, v33
    v_sub_f32 v44, v34, v83
    v_sub_f32 v33, v61, v59
    v_add_f32 v34, v34, v83
    v_add_f32 v61, v61, v59
    v_sub_f32 v83, v53, v25
    v_sub_f32 v59, v68, v28
    v_add_f32 v68, v68, v28
    v_add_f32 v25, v25, v53
    v_sub_f32 v28, v20, v82
    v_sub_f32 v53, v17, v79
    v_add_f32 v20, v20, v82
    v_add_f32 v17, v17, v79
    v_sub_f32 v82, v40, v70
    v_sub_f32 v79, v57, v81
    v_add_f32 v40, v40, v70
    v_add_f32 v57, v57, v81
    v_sub_f32 v70, v46, v78
    v_sub_f32 v81, v39, v63
    v_add_f32 v46, v46, v78
    v_add_f32 v39, v39, v63
    v_sub_f32 v78, v32, v38
    v_sub_f32 v63, v41, v45
    v_add_f32 v32, v32, v38
    v_add_f32 v41, v41, v45
    v_sub_f32 v38, v50, v18
    v_sub_f32 v45, v49, v67
    v_add_f32 v50, v50, v18
    v_add_f32 v49, v49, v67
    v_sub_f32 v18, v62, v64
    v_sub_f32 v67, v31, v37
    v_add_f32 v62, v62, v64
    v_add_f32 v31, v31, v37
    v_sub_f32 v64, v36, v74
    v_sub_f32 v37, v29, v21
    v_add_f32 v36, v36, v74
    v_add_f32 v29, v29, v21
    v_sub_f32 v74, v66, v56
    v_sub_f32 v21, v35, v55
    v_add_f32 v66, v66, v56
    v_add_f32 v35, v35, v55
    v_sub_f32 v56, v24, v72
    v_sub_f32 v55, v75, v43
    v_add_f32 v24, v24, v72
    v_add_f32 v75, v75, v43
    v_sub_f32 v72, v58, v54
    v_sub_f32 v43, v51, v27
    v_add_f32 v58, v58, v54
    v_add_f32 v51, v51, v27
    v_sub_f32 v54, v42, v16
    v_sub_f32 v27, v69, v73
    v_add_f32 v42, v42, v16
    v_add_f32 v69, v69, v73
    v_sub_f32 v16, v48, v60
    v_sub_f32 v73, v65, v19
    v_add_f32 v48, v48, v60
    v_add_f32 v65, v65, v19
    v_sub_f32 v60, v80, v26
    v_sub_f32 v19, v23, v77
    v_add_f32 v80, v80, v26
    v_add_f32 v23, v23, v77
    v_sub_f32 v26, v52, v30
    v_sub_f32 v77, v47, v71
    v_add_f32 v52, v52, v30
    v_add_f32 v47, v47, v71
    v_sub_f32 v30, v34, v68
    v_sub_f32 v71, v61, v25
    v_add_f32 v34, v34, v68
    v_add_f32 v61, v61, v25
    v_sub_f32 v68, v44, v83
    v_sub_f32 v25, v33, v59
    v_add_f32 v44, v44, v83
    v_add_f32 v33, v33, v59
    s_add_u32 s15, s14, 109051904
    v_lshlrev_b32 v5, 3, v1
    s_add_u32 s16, s15, 0
    v_mov_b32 v88, v20
    v_mov_b32 v89, v17
    buffer_store_dwordx2 v[88:89], v5, s[8:11], s16 offen sc1
    s_add_u32 s16, s15, 512
    v_mov_b32 v90, v24
    v_mov_b32 v91, v75
    buffer_store_dwordx2 v[90:91], v5, s[8:11], s16 offen sc1
    s_add_u32 s16, s15, 1024
    v_mov_b32 v92, v50
    v_mov_b32 v93, v49
    buffer_store_dwordx2 v[92:93], v5, s[8:11], s16 offen sc1
    s_add_u32 s16, s15, 1536
    v_mov_b32 v94, v80
    v_mov_b32 v95, v23
    buffer_store_dwordx2 v[94:95], v5, s[8:11], s16 offen sc1
    s_add_u32 s16, s15, 2048
    v_mov_b32 v96, v46
    v_mov_b32 v97, v39
    buffer_store_dwordx2 v[96:97], v5, s[8:11], s16 offen sc1
    s_add_u32 s16, s15, 2560
    v_mov_b32 v98, v42
    v_mov_b32 v99, v69
    buffer_store_dwordx2 v[98:99], v5, s[8:11], s16 offen sc1
    s_add_u32 s16, s15, 3072
    v_mov_b32 v100, v36
    v_mov_b32 v101, v29
    buffer_store_dwordx2 v[100:101], v5, s[8:11], s16 offen sc1
    s_add_u32 s16, s15, 3584
    v_mov_b32 v102, v34
    v_mov_b32 v103, v61
    buffer_store_dwordx2 v[102:103], v5, s[8:11], s16 offen sc1
    s_add_u32 s16, s15, 4096
    v_mov_b32 v88, v40
    v_mov_b32 v89, v57
    buffer_store_dwordx2 v[88:89], v5, s[8:11], s16 offen sc1
    s_add_u32 s16, s15, 4608
    v_mov_b32 v90, v58
    v_mov_b32 v91, v51
    buffer_store_dwordx2 v[90:91], v5, s[8:11], s16 offen sc1
    s_add_u32 s16, s15, 5120
    v_mov_b32 v92, v62
    v_mov_b32 v93, v31
    buffer_store_dwordx2 v[92:93], v5, s[8:11], s16 offen sc1
    s_add_u32 s16, s15, 5632
    v_mov_b32 v94, v52
    v_mov_b32 v95, v47
    buffer_store_dwordx2 v[94:95], v5, s[8:11], s16 offen sc1
    s_add_u32 s16, s15, 6144
    v_mov_b32 v96, v32
    v_mov_b32 v97, v41
    buffer_store_dwordx2 v[96:97], v5, s[8:11], s16 offen sc1
    s_add_u32 s16, s15, 6656
    v_mov_b32 v98, v48
    v_mov_b32 v99, v65
    buffer_store_dwordx2 v[98:99], v5, s[8:11], s16 offen sc1
    s_add_u32 s16, s15, 7168
    v_mov_b32 v100, v66
    v_mov_b32 v101, v35
    buffer_store_dwordx2 v[100:101], v5, s[8:11], s16 offen sc1
    s_add_u32 s16, s15, 7680
    v_mov_b32 v102, v44
    v_mov_b32 v103, v33
    buffer_store_dwordx2 v[102:103], v5, s[8:11], s16 offen sc1
    s_add_u32 s16, s15, 8192
    v_mov_b32 v88, v28
    v_mov_b32 v89, v53
    buffer_store_dwordx2 v[88:89], v5, s[8:11], s16 offen sc1
    s_add_u32 s16, s15, 8704
    v_mov_b32 v90, v56
    v_mov_b32 v91, v55
    buffer_store_dwordx2 v[90:91], v5, s[8:11], s16 offen sc1
    s_add_u32 s16, s15, 9216
    v_mov_b32 v92, v38
    v_mov_b32 v93, v45
    buffer_store_dwordx2 v[92:93], v5, s[8:11], s16 offen sc1
    s_add_u32 s16, s15, 9728
    v_mov_b32 v94, v60
    v_mov_b32 v95, v19
    buffer_store_dwordx2 v[94:95], v5, s[8:11], s16 offen sc1
    s_add_u32 s16, s15, 10240
    v_mov_b32 v96, v70
    v_mov_b32 v97, v81
    buffer_store_dwordx2 v[96:97], v5, s[8:11], s16 offen sc1
    s_add_u32 s16, s15, 10752
    v_mov_b32 v98, v54
    v_mov_b32 v99, v27
    buffer_store_dwordx2 v[98:99], v5, s[8:11], s16 offen sc1
    s_add_u32 s16, s15, 11264
    v_mov_b32 v100, v64
    v_mov_b32 v101, v37
    buffer_store_dwordx2 v[100:101], v5, s[8:11], s16 offen sc1
    s_add_u32 s16, s15, 11776
    v_mov_b32 v102, v30
    v_mov_b32 v103, v71
    buffer_store_dwordx2 v[102:103], v5, s[8:11], s16 offen sc1
    s_add_u32 s16, s15, 12288
    v_mov_b32 v88, v82
    v_mov_b32 v89, v79
    buffer_store_dwordx2 v[88:89], v5, s[8:11], s16 offen sc1
    s_add_u32 s16, s15, 12800
    v_mov_b32 v90, v72
    v_mov_b32 v91, v43
    buffer_store_dwordx2 v[90:91], v5, s[8:11], s16 offen sc1
    s_add_u32 s16, s15, 13312
    v_mov_b32 v92, v18
    v_mov_b32 v93, v67
    buffer_store_dwordx2 v[92:93], v5, s[8:11], s16 offen sc1
    s_add_u32 s16, s15, 13824
    v_mov_b32 v94, v26
    v_mov_b32 v95, v77
    buffer_store_dwordx2 v[94:95], v5, s[8:11], s16 offen sc1
    s_add_u32 s16, s15, 14336
    v_mov_b32 v96, v78
    v_mov_b32 v97, v63
    buffer_store_dwordx2 v[96:97], v5, s[8:11], s16 offen sc1
    s_add_u32 s16, s15, 14848
    v_mov_b32 v98, v16
    v_mov_b32 v99, v73
    buffer_store_dwordx2 v[98:99], v5, s[8:11], s16 offen sc1
    s_add_u32 s16, s15, 15360
    v_mov_b32 v100, v74
    v_mov_b32 v101, v21
    buffer_store_dwordx2 v[100:101], v5, s[8:11], s16 offen sc1
    s_add_u32 s16, s15, 15872
    v_mov_b32 v102, v68
    v_mov_b32 v103, v25
    buffer_store_dwordx2 v[102:103], v5, s[8:11], s16 offen sc1
mega_kernel_f2_end:
    s_waitcnt vmcnt(0)
    s_barrier
    v_mov_b32 v2, 1
    v_cmp_eq_u32 vcc, 0, v0
    s_and_saveexec_b64 s[80:81], vcc
    s_cbranch_execz mega_kernel_sg128_2
    buffer_atomic_add v2, off, s[88:91], 0 offset:128 sc1
mega_kernel_sg128_2:
    s_mov_b64 exec, s[80:81]
    s_cmp_eq_u32 s99, 0
    s_cbranch_scc0 mega_kernel_f2d
    s_mov_b32 s99, 128
    s_branch mega_kernel_f2l
mega_kernel_f2d:
mega_kernel_wf2:
    s_sleep 8
    buffer_load_dword v2, off, s[88:91], 0 offset:128 sc1
    s_waitcnt vmcnt(0)
    v_cmp_ne_u32 vcc, 129, v2
    s_cbranch_vccnz mega_kernel_wf2
    s_barrier
    s_load_dwordx2 s[4:5], s[0:1], 80
    s_load_dwordx2 s[8:9], s[0:1], 96
    v_and_b32 v6, 7, v0
    v_lshrrev_b32 v7, 3, v0
    s_movk_i32 s13, 8448
    v_mul_lo_u32 v8, v6, s13
    v_lshl_add_u32 v4, v7, 3, v8
    v_lshlrev_b32 v5, 14, v7
    v_lshl_add_u32 v5, v6, 4, v5
    s_lshl_b32 s12, s92, 7
    s_add_u32 s12, s12, 109051904
    s_waitcnt lgkmcnt(0)
    s_mov_b32 s6, 8388608
    s_mov_b32 s7, 0x00020000
    s_mov_b32 s10, 268435456
    s_mov_b32 s11, 0x00020000
    s_add_u32 s13, s12, 0
    buffer_load_dwordx4 v[16:19], v5, s[8:11], s13 offen
    s_add_u32 s13, s12, 524288
    buffer_load_dwordx4 v[20:23], v5, s[8:11], s13 offen
    s_add_u32 s13, s12, 1048576
    buffer_load_dwordx4 v[24:27], v5, s[8:11], s13 offen
    s_add_u32 s13, s12, 1572864
    buffer_load_dwordx4 v[28:31], v5, s[8:11], s13 offen
    s_add_u32 s13, s12, 2097152
    buffer_load_dwordx4 v[32:35], v5, s[8:11], s13 offen
    s_add_u32 s13, s12, 2621440
    buffer_load_dwordx4 v[36:39], v5, s[8:11], s13 offen
    s_add_u32 s13, s12, 3145728
    buffer_load_dwordx4 v[40:43], v5, s[8:11], s13 offen
    s_add_u32 s13, s12, 3670016
    buffer_load_dwordx4 v[44:47], v5, s[8:11], s13 offen
    s_add_u32 s13, s12, 4194304
    buffer_load_dwordx4 v[48:51], v5, s[8:11], s13 offen
    s_add_u32 s13, s12, 4718592
    buffer_load_dwordx4 v[52:55], v5, s[8:11], s13 offen
    s_add_u32 s13, s12, 5242880
    buffer_load_dwordx4 v[56:59], v5, s[8:11], s13 offen
    s_add_u32 s13, s12, 5767168
    buffer_load_dwordx4 v[60:63], v5, s[8:11], s13 offen
    s_add_u32 s13, s12, 6291456
    buffer_load_dwordx4 v[64:67], v5, s[8:11], s13 offen
    s_add_u32 s13, s12, 6815744
    buffer_load_dwordx4 v[68:71], v5, s[8:11], s13 offen
    s_add_u32 s13, s12, 7340032
    buffer_load_dwordx4 v[72:75], v5, s[8:11], s13 offen
    s_add_u32 s13, s12, 7864320
    buffer_load_dwordx4 v[76:79], v5, s[8:11], s13 offen
    s_add_u32 s13, s12, 8388608
    buffer_load_dwordx4 v[80:83], v5, s[8:11], s13 offen
    s_waitcnt vmcnt(0)
    v_cmp_eq_u32 vcc, 0, v7
    s_nop 1
    v_mov_b32 v9, 0
    v_cndmask_b32 v17, v17, v9, vcc
    v_cndmask_b32 v19, v19, v9, vcc
    v_cndmask_b32 v81, v81, v9, vcc
    v_cndmask_b32 v83, v83, v9, vcc
    v_sub_u32 v6, 1024, v7
    v_and_b32 v6, 1023, v6
    v_lshl_add_u32 v6, v6, 3, v8
    v_sub_f32 v10, v16, v19
    v_add_f32 v11, v17, v18
    v_add_f32 v12, v16, v19
    v_sub_f32 v13, v18, v17
    ds_write_b64 v4, v[10:11] offset:0
    ds_write_b64 v6, v[12:13]
    v_sub_u32 v6, 992, v7
    v_and_b32 v6, 1023, v6
    v_lshl_add_u32 v6, v6, 3, v8
    v_sub_f32 v10, v20, v23
    v_add_f32 v11, v21, v22
    v_add_f32 v12, v20, v23
    v_sub_f32 v13, v22, v21
    ds_write_b64 v4, v[10:11] offset:256
    ds_write_b64 v6, v[12:13]
    v_sub_u32 v6, 960, v7
    v_and_b32 v6, 1023, v6
    v_lshl_add_u32 v6, v6, 3, v8
    v_sub_f32 v10, v24, v27
    v_add_f32 v11, v25, v26
    v_add_f32 v12, v24, v27
    v_sub_f32 v13, v26, v25
    ds_write_b64 v4, v[10:11] offset:512
    ds_write_b64 v6, v[12:13]
    v_sub_u32 v6, 928, v7
    v_and_b32 v6, 1023, v6
    v_lshl_add_u32 v6, v6, 3, v8
    v_sub_f32 v10, v28, v31
    v_add_f32 v11, v29, v30
    v_add_f32 v12, v28, v31
    v_sub_f32 v13, v30, v29
    ds_write_b64 v4, v[10:11] offset:768
    ds_write_b64 v6, v[12:13]
    v_sub_u32 v6, 896, v7
    v_and_b32 v6, 1023, v6
    v_lshl_add_u32 v6, v6, 3, v8
    v_sub_f32 v10, v32, v35
    v_add_f32 v11, v33, v34
    v_add_f32 v12, v32, v35
    v_sub_f32 v13, v34, v33
    ds_write_b64 v4, v[10:11] offset:1024
    ds_write_b64 v6, v[12:13]
    v_sub_u32 v6, 864, v7
    v_and_b32 v6, 1023, v6
    v_lshl_add_u32 v6, v6, 3, v8
    v_sub_f32 v10, v36, v39
    v_add_f32 v11, v37, v38
    v_add_f32 v12, v36, v39
    v_sub_f32 v13, v38, v37
    ds_write_b64 v4, v[10:11] offset:1280
    ds_write_b64 v6, v[12:13]
    v_sub_u32 v6, 832, v7
    v_and_b32 v6, 1023, v6
    v_lshl_add_u32 v6, v6, 3, v8
    v_sub_f32 v10, v40, v43
    v_add_f32 v11, v41, v42
    v_add_f32 v12, v40, v43
    v_sub_f32 v13, v42, v41
    ds_write_b64 v4, v[10:11] offset:1536
    ds_write_b64 v6, v[12:13]
    v_sub_u32 v6, 800, v7
    v_and_b32 v6, 1023, v6
    v_lshl_add_u32 v6, v6, 3, v8
    v_sub_f32 v10, v44, v47
    v_add_f32 v11, v45, v46
    v_add_f32 v12, v44, v47
    v_sub_f32 v13, v46, v45
    ds_write_b64 v4, v[10:11] offset:1792
    ds_write_b64 v6, v[12:13]
    v_sub_u32 v6, 768, v7
    v_and_b32 v6, 1023, v6
    v_lshl_add_u32 v6, v6, 3, v8
    v_sub_f32 v10, v48, v51
    v_add_f32 v11, v49, v50
    v_add_f32 v12, v48, v51
    v_sub_f32 v13, v50, v49
    ds_write_b64 v4, v[10:11] offset:2048
    ds_write_b64 v6, v[12:13]
    v_sub_u32 v6, 736, v7
    v_and_b32 v6, 1023, v6
    v_lshl_add_u32 v6, v6, 3, v8
    v_sub_f32 v10, v52, v55
    v_add_f32 v11, v53, v54
    v_add_f32 v12, v52, v55
    v_sub_f32 v13, v54, v53
    ds_write_b64 v4, v[10:11] offset:2304
    ds_write_b64 v6, v[12:13]
    v_sub_u32 v6, 704, v7
    v_and_b32 v6, 1023, v6
    v_lshl_add_u32 v6, v6, 3, v8
    v_sub_f32 v10, v56, v59
    v_add_f32 v11, v57, v58
    v_add_f32 v12, v56, v59
    v_sub_f32 v13, v58, v57
    ds_write_b64 v4, v[10:11] offset:2560
    ds_write_b64 v6, v[12:13]
    v_sub_u32 v6, 672, v7
    v_and_b32 v6, 1023, v6
    v_lshl_add_u32 v6, v6, 3, v8
    v_sub_f32 v10, v60, v63
    v_add_f32 v11, v61, v62
    v_add_f32 v12, v60, v63
    v_sub_f32 v13, v62, v61
    ds_write_b64 v4, v[10:11] offset:2816
    ds_write_b64 v6, v[12:13]
    v_sub_u32 v6, 640, v7
    v_and_b32 v6, 1023, v6
    v_lshl_add_u32 v6, v6, 3, v8
    v_sub_f32 v10, v64, v67
    v_add_f32 v11, v65, v66
    v_add_f32 v12, v64, v67
    v_sub_f32 v13, v66, v65
    ds_write_b64 v4, v[10:11] offset:3072
    ds_write_b64 v6, v[12:13]
    v_sub_u32 v6, 608, v7
    v_and_b32 v6, 1023, v6
    v_lshl_add_u32 v6, v6, 3, v8
    v_sub_f32 v10, v68, v71
    v_add_f32 v11, v69, v70
    v_add_f32 v12, v68, v71
    v_sub_f32 v13, v70, v69
    ds_write_b64 v4, v[10:11] offset:3328
    ds_write_b64 v6, v[12:13]
    v_sub_u32 v6, 576, v7
    v_and_b32 v6, 1023, v6
    v_lshl_add_u32 v6, v6, 3, v8
    v_sub_f32 v10, v72, v75
    v_add_f32 v11, v73, v74
    v_add_f32 v12, v72, v75
    v_sub_f32 v13, v74, v73
    ds_write_b64 v4, v[10:11] offset:3584
    ds_write_b64 v6, v[12:13]
    v_sub_u32 v6, 544, v7
    v_and_b32 v6, 1023, v6
    v_lshl_add_u32 v6, v6, 3, v8
    v_sub_f32 v10, v76, v79
    v_add_f32 v11, v77, v78
    v_add_f32 v12, v76, v79
    v_sub_f32 v13, v78, v77
    ds_write_b64 v4, v[10:11] offset:3840
    ds_write_b64 v6, v[12:13]
    s_and_saveexec_b64 s[14:15], vcc
    v_sub_u32 v6, 512, v7
    v_and_b32 v6, 1023, v6
    v_lshl_add_u32 v6, v6, 3, v8
    v_sub_f32 v10, v80, v83
    v_add_f32 v11, v81, v82
    v_add_f32 v12, v80, v83
    v_sub_f32 v13, v82, v81
    ds_write_b64 v4, v[10:11] offset:4096
    ds_write_b64 v6, v[12:13]
    s_mov_b64 exec, s[14:15]
    s_waitcnt lgkmcnt(0)
    s_barrier
    v_and_b32 v1, 31, v0
    v_lshrrev_b32 v2, 5, v0
    v_cvt_f32_u32 v3, v1
    s_movk_i32 s13, 8448
    v_mul_lo_u32 v7, v2, s13
    v_lshl_add_u32 v4, v1, 3, v7
    s_movk_i32 s13, 264
    v_mul_lo_u32 v5, v1, s13
    v_add_u32 v5, v5, v7
    ds_read_b32 v16, v4 offset:0
    ds_read_b32 v48, v4 offset:4
    ds_read_b32 v17, v4 offset:256
    ds_read_b32 v49, v4 offset:260
    ds_read_b32 v18, v4 offset:512
    ds_read_b32 v50, v4 offset:516
    ds_read_b32 v19, v4 offset:768
    ds_read_b32 v51, v4 offset:772
    ds_read_b32 v20, v4 offset:1024
    ds_read_b32 v52, v4 offset:1028
    ds_read_b32 v21, v4 offset:1280
    ds_read_b32 v53, v4 offset:1284
    ds_read_b32 v22, v4 offset:1536
    ds_read_b32 v54, v4 offset:1540
    s_waitcnt lgkmcnt(0)
    ds_read_b32 v23, v4 offset:1792
    ds_read_b32 v55, v4 offset:1796
    ds_read_b32 v24, v4 offset:2048
    ds_read_b32 v56, v4 offset:2052
    ds_read_b32 v25, v4 offset:2304
    ds_read_b32 v57, v4 offset:2308
    ds_read_b32 v26, v4 offset:2560
    ds_read_b32 v58, v4 offset:2564
    ds_read_b32 v27, v4 offset:2816
    ds_read_b32 v59, v4 offset:2820
    ds_read_b32 v28, v4 offset:3072
    ds_read_b32 v60, v4 offset:3076
    ds_read_b32 v29, v4 offset:3328
    ds_read_b32 v61, v4 offset:3332
    s_waitcnt lgkmcnt(0)
    ds_read_b32 v30, v4 offset:3584
    ds_read_b32 v62, v4 offset:3588
    ds_read_b32 v31, v4 offset:3840
    ds_read_b32 v63, v4 offset:3844
    ds_read_b32 v32, v4 offset:4096
    ds_read_b32 v64, v4 offset:4100
    ds_read_b32 v33, v4 offset:4352
    ds_read_b32 v65, v4 offset:4356
    ds_read_b32 v34, v4 offset:4608
    ds_read_b32 v66, v4 offset:4612
    ds_read_b32 v35, v4 offset:4864
    ds_read_b32 v67, v4 offset:4868
    ds_read_b32 v36, v4 offset:5120
    ds_read_b32 v68, v4 offset:5124
    s_waitcnt lgkmcnt(0)
    ds_read_b32 v37, v4 offset:5376
    ds_read_b32 v69, v4 offset:5380
    ds_read_b32 v38, v4 offset:5632
    ds_read_b32 v70, v4 offset:5636
    ds_read_b32 v39, v4 offset:5888
    ds_read_b32 v71, v4 offset:5892
    ds_read_b32 v40, v4 offset:6144
    ds_read_b32 v72, v4 offset:6148
    ds_read_b32 v41, v4 offset:6400
    ds_read_b32 v73, v4 offset:6404
    ds_read_b32 v42, v4 offset:6656
    ds_read_b32 v74, v4 offset:6660
    ds_read_b32 v43, v4 offset:6912
    ds_read_b32 v75, v4 offset:6916
    s_waitcnt lgkmcnt(0)
    ds_read_b32 v44, v4 offset:7168
    ds_read_b32 v76, v4 offset:7172
    ds_read_b32 v45, v4 offset:7424
    ds_read_b32 v77, v4 offset:7428
    ds_read_b32 v46, v4 offset:7680
    ds_read_b32 v78, v4 offset:7684
    ds_read_b32 v47, v4 offset:7936
    ds_read_b32 v79, v4 offset:7940
    s_waitcnt lgkmcnt(0)
    v_sub_f32 v80, v16, v32
    v_sub_f32 v81, v48, v64
    v_add_f32 v16, v16, v32
    v_add_f32 v48, v48, v64
    v_sub_f32 v32, v17, v33
    v_sub_f32 v64, v49, v65
    v_add_f32 v17, v17, v33
    v_add_f32 v49, v49, v65
    v_mul_f32 v33, 0x3f7b14be, v32
    v_mul_f32 v65, 0x3e47c5c2, v32
    v_fmac_f32 v33, 0xbe47c5c2, v64
    v_fmac_f32 v65, 0x3f7b14be, v64
    v_sub_f32 v32, v18, v34
    v_sub_f32 v64, v50, v66
    v_add_f32 v18, v18, v34
    v_add_f32 v50, v50, v66
    v_mul_f32 v34, 0x3f6c835e, v32
    v_mul_f32 v66, 0x3ec3ef15, v32
    v_fmac_f32 v34, 0xbec3ef15, v64
    v_fmac_f32 v66, 0x3f6c835e, v64
    v_sub_f32 v32, v19, v35
    v_sub_f32 v64, v51, v67
    v_add_f32 v19, v19, v35
    v_add_f32 v51, v51, v67
    v_mul_f32 v35, 0x3f54db31, v32
    v_mul_f32 v67, 0x3f0e39da, v32
    v_fmac_f32 v35, 0xbf0e39da, v64
    v_fmac_f32 v67, 0x3f54db31, v64
    v_sub_f32 v32, v20, v36
    v_sub_f32 v64, v52, v68
    v_add_f32 v20, v20, v36
    v_add_f32 v52, v52, v68
    v_mul_f32 v36, 0x3f3504f3, v32
    v_mul_f32 v68, 0x3f3504f3, v32
    v_fmac_f32 v36, 0xbf3504f3, v64
    v_fmac_f32 v68, 0x3f3504f3, v64
    v_sub_f32 v32, v21, v37
    v_sub_f32 v64, v53, v69
    v_add_f32 v21, v21, v37
    v_add_f32 v53, v53, v69
    v_mul_f32 v37, 0x3f0e39da, v32
    v_mul_f32 v69, 0x3f54db31, v32
    v_fmac_f32 v37, 0xbf54db31, v64
    v_fmac_f32 v69, 0x3f0e39da, v64
    v_sub_f32 v32, v22, v38
    v_sub_f32 v64, v54, v70
    v_add_f32 v22, v22, v38
    v_add_f32 v54, v54, v70
    v_mul_f32 v38, 0x3ec3ef15, v32
    v_mul_f32 v70, 0x3f6c835e, v32
    v_fmac_f32 v38, 0xbf6c835e, v64
    v_fmac_f32 v70, 0x3ec3ef15, v64
    v_sub_f32 v32, v23, v39
    v_sub_f32 v64, v55, v71
    v_add_f32 v23, v23, v39
    v_add_f32 v55, v55, v71
    v_mul_f32 v39, 0x3e47c5c2, v32
    v_mul_f32 v71, 0x3f7b14be, v32
    v_fmac_f32 v39, 0xbf7b14be, v64
    v_fmac_f32 v71, 0x3e47c5c2, v64
    v_sub_f32 v32, v72, v56
    v_sub_f32 v64, v24, v40
    v_add_f32 v24, v24, v40
    v_add_f32 v56, v56, v72
    v_sub_f32 v40, v25, v41
    v_sub_f32 v72, v57, v73
    v_add_f32 v25, v25, v41
    v_add_f32 v57, v57, v73
    v_mul_f32 v41, 0xbe47c5c2, v40
    v_mul_f32 v73, 0x3f7b14be, v40
    v_fmac_f32 v41, 0xbf7b14be, v72
    v_fmac_f32 v73, 0xbe47c5c2, v72
    v_sub_f32 v40, v26, v42
    v_sub_f32 v72, v58, v74
    v_add_f32 v26, v26, v42
    v_add_f32 v58, v58, v74
    v_mul_f32 v42, 0xbec3ef15, v40
    v_mul_f32 v74, 0x3f6c835e, v40
    v_fmac_f32 v42, 0xbf6c835e, v72
    v_fmac_f32 v74, 0xbec3ef15, v72
    v_sub_f32 v40, v27, v43
    v_sub_f32 v72, v59, v75
    v_add_f32 v27, v27, v43
    v_add_f32 v59, v59, v75
    v_mul_f32 v43, 0xbf0e39da, v40
    v_mul_f32 v75, 0x3f54db31, v40
    v_fmac_f32 v43, 0xbf54db31, v72
    v_fmac_f32 v75, 0xbf0e39da, v72
    v_sub_f32 v40, v28, v44
    v_sub_f32 v72, v60, v76
    v_add_f32 v28, v28, v44
    v_add_f32 v60, v60, v76
    v_mul_f32 v44, 0xbf3504f3, v40
    v_mul_f32 v76, 0x3f3504f3, v40
    v_fmac_f32 v44, 0xbf3504f3, v72
    v_fmac_f32 v76, 0xbf3504f3, v72
    v_sub_f32 v40, v29, v45
    v_sub_f32 v72, v61, v77
    v_add_f32 v29, v29, v45
    v_add_f32 v61, v61, v77
    v_mul_f32 v45, 0xbf54db31, v40
    v_mul_f32 v77, 0x3f0e39da, v40
    v_fmac_f32 v45, 0xbf0e39da, v72
    v_fmac_f32 v77, 0xbf54db31, v72
    v_sub_f32 v40, v30, v46
    v_sub_f32 v72, v62, v78
    v_add_f32 v30, v30, v46
    v_add_f32 v62, v62, v78
    v_mul_f32 v46, 0xbf6c835e, v40
    v_mul_f32 v78, 0x3ec3ef15, v40
    v_fmac_f32 v46, 0xbec3ef15, v72
    v_fmac_f32 v78, 0xbf6c835e, v72
    v_sub_f32 v40, v31, v47
    v_sub_f32 v72, v63, v79
    v_add_f32 v31, v31, v47
    v_add_f32 v63, v63, v79
    v_mul_f32 v47, 0xbf7b14be, v40
    v_mul_f32 v79, 0x3e47c5c2, v40
    v_fmac_f32 v47, 0xbe47c5c2, v72
    v_fmac_f32 v79, 0xbf7b14be, v72
    v_sub_f32 v40, v16, v24
    v_sub_f32 v72, v48, v56
    v_add_f32 v16, v16, v24
    v_add_f32 v48, v48, v56
    v_sub_f32 v24, v17, v25
    v_sub_f32 v56, v49, v57
    v_add_f32 v17, v17, v25
    v_add_f32 v49, v49, v57
    v_mul_f32 v25, 0x3f6c835e, v24
    v_mul_f32 v57, 0x3ec3ef15, v24
    v_fmac_f32 v25, 0xbec3ef15, v56
    v_fmac_f32 v57, 0x3f6c835e, v56
    v_sub_f32 v24, v18, v26
    v_sub_f32 v56, v50, v58
    v_add_f32 v18, v18, v26
    v_add_f32 v50, v50, v58
    v_mul_f32 v26, 0x3f3504f3, v24
    v_mul_f32 v58, 0x3f3504f3, v24
    v_fmac_f32 v26, 0xbf3504f3, v56
    v_fmac_f32 v58, 0x3f3504f3, v56
    v_sub_f32 v24, v19, v27
    v_sub_f32 v56, v51, v59
    v_add_f32 v19, v19, v27
    v_add_f32 v51, v51, v59
    v_mul_f32 v27, 0x3ec3ef15, v24
    v_mul_f32 v59, 0x3f6c835e, v24
    v_fmac_f32 v27, 0xbf6c835e, v56
    v_fmac_f32 v59, 0x3ec3ef15, v56
    v_sub_f32 v24, v60, v52
    v_sub_f32 v56, v20, v28
    v_add_f32 v20, v20, v28
    v_add_f32 v52, v52, v60
    v_sub_f32 v28, v21, v29
    v_sub_f32 v60, v53, v61
    v_add_f32 v21, v21, v29
    v_add_f32 v53, v53, v61
    v_mul_f32 v29, 0xbec3ef15, v28
    v_mul_f32 v61, 0x3f6c835e, v28
    v_fmac_f32 v29, 0xbf6c835e, v60
    v_fmac_f32 v61, 0xbec3ef15, v60
    v_sub_f32 v28, v22, v30
    v_sub_f32 v60, v54, v62
    v_add_f32 v22, v22, v30
    v_add_f32 v54, v54, v62
    v_mul_f32 v30, 0xbf3504f3, v28
    v_mul_f32 v62, 0x3f3504f3, v28
    v_fmac_f32 v30, 0xbf3504f3, v60
    v_fmac_f32 v62, 0xbf3504f3, v60
    v_sub_f32 v28, v23, v31
    v_sub_f32 v60, v55, v63
    v_add_f32 v23, v23, v31
    v_add_f32 v55, v55, v63
    v_mul_f32 v31, 0xbf6c835e, v28
    v_mul_f32 v63, 0x3ec3ef15, v28
    v_fmac_f32 v31, 0xbec3ef15, v60
    v_fmac_f32 v63, 0xbf6c835e, v60
    v_sub_f32 v28, v80, v32
    v_sub_f32 v60, v81, v64
    v_add_f32 v80, v80, v32
    v_add_f32 v81, v81, v64
    v_sub_f32 v32, v33, v41
    v_sub_f32 v64, v65, v73
    v_add_f32 v33, v33, v41
    v_add_f32 v65, v65, v73
    v_mul_f32 v41, 0x3f6c835e, v32
    v_mul_f32 v73, 0x3ec3ef15, v32
    v_fmac_f32 v41, 0xbec3ef15, v64
    v_fmac_f32 v73, 0x3f6c835e, v64
    v_sub_f32 v32, v34, v42
    v_sub_f32 v64, v66, v74
    v_add_f32 v34, v34, v42
    v_add_f32 v66, v66, v74
    v_mul_f32 v42, 0x3f3504f3, v32
    v_mul_f32 v74, 0x3f3504f3, v32
    v_fmac_f32 v42, 0xbf3504f3, v64
    v_fmac_f32 v74, 0x3f3504f3, v64
    v_sub_f32 v32, v35, v43
    v_sub_f32 v64, v67, v75
    v_add_f32 v35, v35, v43
    v_add_f32 v67, v67, v75
    v_mul_f32 v43, 0x3ec3ef15, v32
    v_mul_f32 v75, 0x3f6c835e, v32
    v_fmac_f32 v43, 0xbf6c835e, v64
    v_fmac_f32 v75, 0x3ec3ef15, v64
    v_sub_f32 v32, v76, v68
    v_sub_f32 v64, v36, v44
    v_add_f32 v36, v36, v44
    v_add_f32 v68, v68, v76
    v_sub_f32 v44, v37, v45
    v_sub_f32 v76, v69, v77
    v_add_f32 v37, v37, v45
    v_add_f32 v69, v69, v77
    v_mul_f32 v45, 0xbec3ef15, v44
    v_mul_f32 v77, 0x3f6c835e, v44
    v_fmac_f32 v45, 0xbf6c835e, v76
    v_fmac_f32 v77, 0xbec3ef15, v76
    v_sub_f32 v44, v38, v46
    v_sub_f32 v76, v70, v78
    v_add_f32 v38, v38, v46
    v_add_f32 v70, v70, v78
    v_mul_f32 v46, 0xbf3504f3, v44
    v_mul_f32 v78, 0x3f3504f3, v44
    v_fmac_f32 v46, 0xbf3504f3, v76
    v_fmac_f32 v78, 0xbf3504f3, v76
    v_sub_f32 v44, v39, v47
    v_sub_f32 v76, v71, v79
    v_add_f32 v39, v39, v47
    v_add_f32 v71, v71, v79
    v_mul_f32 v47, 0xbf6c835e, v44
    v_mul_f32 v79, 0x3ec3ef15, v44
    v_fmac_f32 v47, 0xbec3ef15, v76
    v_fmac_f32 v79, 0xbf6c835e, v76
    v_sub_f32 v44, v16, v20
    v_sub_f32 v76, v48, v52
    v_add_f32 v16, v16, v20
    v_add_f32 v48, v48, v52
    v_sub_f32 v20, v17, v21
    v_sub_f32 v52, v49, v53
    v_add_f32 v17, v17, v21
    v_add_f32 v49, v49, v53
    v_mul_f32 v21, 0x3f3504f3, v20
    v_mul_f32 v53, 0x3f3504f3, v20
    v_fmac_f32 v21, 0xbf3504f3, v52
    v_fmac_f32 v53, 0x3f3504f3, v52
    v_sub_f32 v20, v54, v50
    v_sub_f32 v52, v18, v22
    v_add_f32 v18, v18, v22
    v_add_f32 v50, v50, v54
    v_sub_f32 v22, v19, v23
    v_sub_f32 v54, v51, v55
    v_add_f32 v19, v19, v23
    v_add_f32 v51, v51, v55
    v_mul_f32 v23, 0xbf3504f3, v22
    v_mul_f32 v55, 0x3f3504f3, v22
    v_fmac_f32 v23, 0xbf3504f3, v54
    v_fmac_f32 v55, 0xbf3504f3, v54
    v_sub_f32 v22, v40, v24
    v_sub_f32 v54, v72, v56
    v_add_f32 v40, v40, v24
    v_add_f32 v72, v72, v56
    v_sub_f32 v24, v25, v29
    v_sub_f32 v56, v57, v61
    v_add_f32 v25, v25, v29
    v_add_f32 v57, v57, v61
    v_mul_f32 v29, 0x3f3504f3, v24
    v_mul_f32 v61, 0x3f3504f3, v24
    v_fmac_f32 v29, 0xbf3504f3, v56
    v_fmac_f32 v61, 0x3f3504f3, v56
    v_sub_f32 v24, v62, v58
    v_sub_f32 v56, v26, v30
    v_add_f32 v26, v26, v30
    v_add_f32 v58, v58, v62
    v_sub_f32 v30, v27, v31
    v_sub_f32 v62, v59, v63
    v_add_f32 v27, v27, v31
    v_add_f32 v59, v59, v63
    v_mul_f32 v31, 0xbf3504f3, v30
    v_mul_f32 v63, 0x3f3504f3, v30
    v_fmac_f32 v31, 0xbf3504f3, v62
    v_fmac_f32 v63, 0xbf3504f3, v62
    v_sub_f32 v30, v80, v36
    v_sub_f32 v62, v81, v68
    v_add_f32 v80, v80, v36
    v_add_f32 v81, v81, v68
    v_sub_f32 v36, v33, v37
    v_sub_f32 v68, v65, v69
    v_add_f32 v33, v33, v37
    v_add_f32 v65, v65, v69
    v_mul_f32 v37, 0x3f3504f3, v36
    v_mul_f32 v69, 0x3f3504f3, v36
    v_fmac_f32 v37, 0xbf3504f3, v68
    v_fmac_f32 v69, 0x3f3504f3, v68
    v_sub_f32 v36, v70, v66
    v_sub_f32 v68, v34, v38
    v_add_f32 v34, v34, v38
    v_add_f32 v66, v66, v70
    v_sub_f32 v38, v35, v39
    v_sub_f32 v70, v67, v71
    v_add_f32 v35, v35, v39
    v_add_f32 v67, v67, v71
    v_mul_f32 v39, 0xbf3504f3, v38
    v_mul_f32 v71, 0x3f3504f3, v38
    v_fmac_f32 v39, 0xbf3504f3, v70
    v_fmac_f32 v71, 0xbf3504f3, v70
    v_sub_f32 v38, v28, v32
    v_sub_f32 v70, v60, v64
    v_add_f32 v28, v28, v32
    v_add_f32 v60, v60, v64
    v_sub_f32 v32, v41, v45
    v_sub_f32 v64, v73, v77
    v_add_f32 v41, v41, v45
    v_add_f32 v73, v73, v77
    v_mul_f32 v45, 0x3f3504f3, v32
    v_mul_f32 v77, 0x3f3504f3, v32
    v_fmac_f32 v45, 0xbf3504f3, v64
    v_fmac_f32 v77, 0x3f3504f3, v64
    v_sub_f32 v32, v78, v74
    v_sub_f32 v64, v42, v46
    v_add_f32 v42, v42, v46
    v_add_f32 v74, v74, v78
    v_sub_f32 v46, v43, v47
    v_sub_f32 v78, v75, v79
    v_add_f32 v43, v43, v47
    v_add_f32 v75, v75, v79
    v_mul_f32 v47, 0xbf3504f3, v46
    v_mul_f32 v79, 0x3f3504f3, v46
    v_fmac_f32 v47, 0xbf3504f3, v78
    v_fmac_f32 v79, 0xbf3504f3, v78
    v_sub_f32 v46, v16, v18
    v_sub_f32 v78, v48, v50
    v_add_f32 v16, v16, v18
    v_add_f32 v48, v48, v50
    v_sub_f32 v18, v51, v49
    v_sub_f32 v50, v17, v19
    v_add_f32 v17, v17, v19
    v_add_f32 v49, v49, v51
    v_sub_f32 v19, v44, v20
    v_sub_f32 v51, v76, v52
    v_add_f32 v44, v44, v20
    v_add_f32 v76, v76, v52
    v_sub_f32 v20, v55, v53
    v_sub_f32 v52, v21, v23
    v_add_f32 v21, v21, v23
    v_add_f32 v53, v53, v55
    v_sub_f32 v23, v40, v26
    v_sub_f32 v55, v72, v58
    v_add_f32 v40, v40, v26
    v_add_f32 v72, v72, v58
    v_sub_f32 v26, v59, v57
    v_sub_f32 v58, v25, v27
    v_add_f32 v25, v25, v27
    v_add_f32 v57, v57, v59
    v_sub_f32 v27, v22, v24
    v_sub_f32 v59, v54, v56
    v_add_f32 v22, v22, v24
    v_add_f32 v54, v54, v56
    v_sub_f32 v24, v63, v61
    v_sub_f32 v56, v29, v31
    v_add_f32 v29, v29, v31
    v_add_f32 v61, v61, v63
    v_sub_f32 v31, v80, v34
    v_sub_f32 v63, v81, v66
    v_add_f32 v80, v80, v34
    v_add_f32 v81, v81, v66
    v_sub_f32 v34, v67, v65
    v_sub_f32 v66, v33, v35
    v_add_f32 v33, v33, v35
    v_add_f32 v65, v65, v67
    v_sub_f32 v35, v30, v36
    v_sub_f32 v67, v62, v68
    v_add_f32 v30, v30, v36
    v_add_f32 v62, v62, v68
    v_sub_f32 v36, v71, v69
    v_sub_f32 v68, v37, v39
    v_add_f32 v37, v37, v39
    v_add_f32 v69, v69, v71
    v_sub_f32 v39, v28, v42
    v_sub_f32 v71, v60, v74
    v_add_f32 v28, v28, v42
    v_add_f32 v60, v60, v74
    v_sub_f32 v42, v75, v73
    v_sub_f32 v74, v41, v43
    v_add_f32 v41, v41, v43
    v_add_f32 v73, v73, v75
    v_sub_f32 v43, v38, v32
    v_sub_f32 v75, v70, v64
    v_add_f32 v38, v38, v32
    v_add_f32 v70, v70, v64
    v_sub_f32 v32, v79, v77
    v_sub_f32 v64, v45, v47
    v_add_f32 v45, v45, v47
    v_add_f32 v77, v77, v79
    v_sub_f32 v47, v16, v17
    v_sub_f32 v79, v48, v49
    v_add_f32 v16, v16, v17
    v_add_f32 v48, v48, v49
    v_sub_f32 v17, v46, v18
    v_sub_f32 v49, v78, v50
    v_add_f32 v46, v46, v18
    v_add_f32 v78, v78, v50
    v_sub_f32 v18, v44, v21
    v_sub_f32 v50, v76, v53
    v_add_f32 v44, v44, v21
    v_add_f32 v76, v76, v53
    v_sub_f32 v21, v19, v20
    v_sub_f32 v53, v51, v52
    v_add_f32 v19, v19, v20
    v_add_f32 v51, v51, v52
    v_sub_f32 v20, v40, v25
    v_sub_f32 v52, v72, v57
    v_add_f32 v40, v40, v25
    v_add_f32 v72, v72, v57
    v_sub_f32 v25, v23, v26
    v_sub_f32 v57, v55, v58
    v_add_f32 v23, v23, v26
    v_add_f32 v55, v55, v58
    v_sub_f32 v26, v22, v29
    v_sub_f32 v58, v54, v61
    v_add_f32 v22, v22, v29
    v_add_f32 v54, v54, v61
    v_sub_f32 v29, v27, v24
    v_sub_f32 v61, v59, v56
    v_add_f32 v27, v27, v24
    v_add_f32 v59, v59, v56
    v_sub_f32 v24, v80, v33
    v_sub_f32 v56, v81, v65
    v_add_f32 v80, v80, v33
    v_add_f32 v81, v81, v65
    v_sub_f32 v33, v31, v34
    v_sub_f32 v65, v63, v66
    v_add_f32 v31, v31, v34
    v_add_f32 v63, v63, v66
    v_sub_f32 v34, v30, v37
    v_sub_f32 v66, v62, v69
    v_add_f32 v30, v30, v37
    v_add_f32 v62, v62, v69
    v_sub_f32 v37, v35, v36
    v_sub_f32 v69, v67, v68
    v_add_f32 v35, v35, v36
    v_add_f32 v67, v67, v68
    v_sub_f32 v36, v28, v41
    v_sub_f32 v68, v60, v73
    v_add_f32 v28, v28, v41
    v_add_f32 v60, v60, v73
    v_sub_f32 v41, v39, v42
    v_sub_f32 v73, v71, v74
    v_add_f32 v39, v39, v42
    v_add_f32 v71, v71, v74
    v_sub_f32 v42, v38, v45
    v_sub_f32 v74, v70, v77
    v_add_f32 v38, v38, v45
    v_add_f32 v70, v70, v77
    v_sub_f32 v45, v43, v32
    v_sub_f32 v77, v75, v64
    v_add_f32 v43, v43, v32
    v_add_f32 v75, v75, v64
    v_mul_f32 v32, 0x3a800000, v3
    v_cos_f32 v64, v32
    v_sin_f32 v82, v32
    s_nop 0
    v_mul_f32 v83, v80, v64
    v_fma_f32 v83, -v81, v82, v83
    v_mul_f32 v81, v81, v64
    v_fmac_f32 v81, v80, v82
    v_mul_f32 v32, 0x3b000000, v3
    v_cos_f32 v64, v32
    v_sin_f32 v82, v32
    s_nop 0
    v_mul_f32 v80, v40, v64
    v_fma_f32 v80, -v72, v82, v80
    v_mul_f32 v72, v72, v64
    v_fmac_f32 v72, v40, v82
    v_mul_f32 v32, 0x3b400000, v3
    v_cos_f32 v64, v32
    v_sin_f32 v82, v32
    s_nop 0
    v_mul_f32 v40, v28, v64
    v_fma_f32 v40, -v60, v82, v40
    v_mul_f32 v60, v60, v64
    v_fmac_f32 v60, v28, v82
    v_mul_f32 v32, 0x3b800000, v3
    v_cos_f32 v64, v32
    v_sin_f32 v82, v32
    s_nop 0
    v_mul_f32 v28, v44, v64
    v_fma_f32 v28, -v76, v82, v28
    v_mul_f32 v76, v76, v64
    v_fmac_f32 v76, v44, v82
    v_mul_f32 v32, 0x3ba00000, v3
    v_cos_f32 v64, v32
    v_sin_f32 v82, v32
    s_nop 0
    v_mul_f32 v44, v30, v64
    v_fma_f32 v44, -v62, v82, v44
    v_mul_f32 v62, v62, v64
    v_fmac_f32 v62, v30, v82
    v_mul_f32 v32, 0x3bc00000, v3
    v_cos_f32 v64, v32
    v_sin_f32 v82, v32
    s_nop 0
    v_mul_f32 v30, v22, v64
    v_fma_f32 v30, -v54, v82, v30
    v_mul_f32 v54, v54, v64
    v_fmac_f32 v54, v22, v82
    v_mul_f32 v32, 0x3be00000, v3
    v_cos_f32 v64, v32
    v_sin_f32 v82, v32
    s_nop 0
    v_mul_f32 v22, v38, v64
    v_fma_f32 v22, -v70, v82, v22
    v_mul_f32 v70, v70, v64
    v_fmac_f32 v70, v38, v82
    v_mul_f32 v32, 0x3c000000, v3
    v_cos_f32 v64, v32
    v_sin_f32 v82, v32
    s_nop 0
    v_mul_f32 v38, v46, v64
    v_fma_f32 v38, -v78, v82, v38
    v_mul_f32 v78, v78, v64
    v_fmac_f32 v78, v46, v82
    v_mul_f32 v32, 0x3c100000, v3
    v_cos_f32 v64, v32
    v_sin_f32 v82, v32
    s_nop 0
    v_mul_f32 v46, v31, v64
    v_fma_f32 v46, -v63, v82, v46
    v_mul_f32 v63, v63, v64
    v_fmac_f32 v63, v31, v82
    v_mul_f32 v32, 0x3c200000, v3
    v_cos_f32 v64, v32
    v_sin_f32 v82, v32
    s_nop 0
    v_mul_f32 v31, v23, v64
    v_fma_f32 v31, -v55, v82, v31
    v_mul_f32 v55, v55, v64
    v_fmac_f32 v55, v23, v82
    v_mul_f32 v32, 0x3c300000, v3
    v_cos_f32 v64, v32
    v_sin_f32 v82, v32
    s_nop 0
    v_mul_f32 v23, v39, v64
    v_fma_f32 v23, -v71, v82, v23
    v_mul_f32 v71, v71, v64
    v_fmac_f32 v71, v39, v82
    v_mul_f32 v32, 0x3c400000, v3
    v_cos_f32 v64, v32
    v_sin_f32 v82, v32
    s_nop 0
    v_mul_f32 v39, v19, v64
    v_fma_f32 v39, -v51, v82, v39
    v_mul_f32 v51, v51, v64
    v_fmac_f32 v51, v19, v82
    v_mul_f32 v32, 0x3c500000, v3
    v_cos_f32 v64, v32
    v_sin_f32 v82, v32
    s_nop 0
    v_mul_f32 v19, v35, v64
    v_fma_f32 v19, -v67, v82, v19
    v_mul_f32 v67, v67, v64
    v_fmac_f32 v67, v35, v82
    v_mul_f32 v32, 0x3c600000, v3
    v_cos_f32 v64, v32
    v_sin_f32 v82, v32
    s_nop 0
    v_mul_f32 v35, v27, v64
    v_fma_f32 v35, -v59, v82, v35
    v_mul_f32 v59, v59, v64
    v_fmac_f32 v59, v27, v82
    v_mul_f32 v32, 0x3c700000, v3
    v_cos_f32 v64, v32
    v_sin_f32 v82, v32
    s_nop 0
    v_mul_f32 v27, v43, v64
    v_fma_f32 v27, -v75, v82, v27
    v_mul_f32 v75, v75, v64
    v_fmac_f32 v75, v43, v82
    v_mul_f32 v32, 0x3c800000, v3
    v_cos_f32 v64, v32
    v_sin_f32 v82, v32
    s_nop 0
    v_mul_f32 v43, v47, v64
    v_fma_f32 v43, -v79, v82, v43
    v_mul_f32 v79, v79, v64
    v_fmac_f32 v79, v47, v82
    v_mul_f32 v32, 0x3c880000, v3
    v_cos_f32 v64, v32
    v_sin_f32 v82, v32
    s_nop 0
    v_mul_f32 v47, v24, v64
    v_fma_f32 v47, -v56, v82, v47
    v_mul_f32 v56, v56, v64
    v_fmac_f32 v56, v24, v82
    v_mul_f32 v32, 0x3c900000, v3
    v_cos_f32 v64, v32
    v_sin_f32 v82, v32
    s_nop 0
    v_mul_f32 v24, v20, v64
    v_fma_f32 v24, -v52, v82, v24
    v_mul_f32 v52, v52, v64
    v_fmac_f32 v52, v20, v82
    v_mul_f32 v32, 0x3c980000, v3
    v_cos_f32 v64, v32
    v_sin_f32 v82, v32
    s_nop 0
    v_mul_f32 v20, v36, v64
    v_fma_f32 v20, -v68, v82, v20
    v_mul_f32 v68, v68, v64
    v_fmac_f32 v68, v36, v82
    v_mul_f32 v32, 0x3ca00000, v3
    v_cos_f32 v64, v32
    v_sin_f32 v82, v32
    s_nop 0
    v_mul_f32 v36, v18, v64
    v_fma_f32 v36, -v50, v82, v36
    v_mul_f32 v50, v50, v64
    v_fmac_f32 v50, v18, v82
    v_mul_f32 v32, 0x3ca80000, v3
    v_cos_f32 v64, v32
    v_sin_f32 v82, v32
    s_nop 0
    v_mul_f32 v18, v34, v64
    v_fma_f32 v18, -v66, v82, v18
    v_mul_f32 v66, v66, v64
    v_fmac_f32 v66, v34, v82
    v_mul_f32 v32, 0x3cb00000, v3
    v_cos_f32 v64, v32
    v_sin_f32 v82, v32
    s_nop 0
    v_mul_f32 v34, v26, v64
    v_fma_f32 v34, -v58, v82, v34
    v_mul_f32 v58, v58, v64
    v_fmac_f32 v58, v26, v82
    v_mul_f32 v32, 0x3cb80000, v3
    v_cos_f32 v64, v32
    v_sin_f32 v82, v32
    s_nop 0
    v_mul_f32 v26, v42, v64
    v_fma_f32 v26, -v74, v82, v26
    v_mul_f32 v74, v74, v64
    v_fmac_f32 v74, v42, v82
    v_mul_f32 v32, 0x3cc00000, v3
    v_cos_f32 v64, v32
    v_sin_f32 v82, v32
    s_nop 0
    v_mul_f32 v42, v17, v64
    v_fma_f32 v42, -v49, v82, v42
    v_mul_f32 v49, v49, v64
    v_fmac_f32 v49, v17, v82
    v_mul_f32 v32, 0x3cc80000, v3
    v_cos_f32 v64, v32
    v_sin_f32 v82, v32
    s_nop 0
    v_mul_f32 v17, v33, v64
    v_fma_f32 v17, -v65, v82, v17
    v_mul_f32 v65, v65, v64
    v_fmac_f32 v65, v33, v82
    v_mul_f32 v32, 0x3cd00000, v3
    v_cos_f32 v64, v32
    v_sin_f32 v82, v32
    s_nop 0
    v_mul_f32 v33, v25, v64
    v_fma_f32 v33, -v57, v82, v33
    v_mul_f32 v57, v57, v64
    v_fmac_f32 v57, v25, v82
    v_mul_f32 v32, 0x3cd80000, v3
    v_cos_f32 v64, v32
    v_sin_f32 v82, v32
    s_nop 0
    v_mul_f32 v25, v41, v64
    v_fma_f32 v25, -v73, v82, v25
    v_mul_f32 v73, v73, v64
    v_fmac_f32 v73, v41, v82
    v_mul_f32 v32, 0x3ce00000, v3
    v_cos_f32 v64, v32
    v_sin_f32 v82, v32
    s_nop 0
    v_mul_f32 v41, v21, v64
    v_fma_f32 v41, -v53, v82, v41
    v_mul_f32 v53, v53, v64
    v_fmac_f32 v53, v21, v82
    v_mul_f32 v32, 0x3ce80000, v3
    v_cos_f32 v64, v32
    v_sin_f32 v82, v32
    s_nop 0
    v_mul_f32 v21, v37, v64
    v_fma_f32 v21, -v69, v82, v21
    v_mul_f32 v69, v69, v64
    v_fmac_f32 v69, v37, v82
    v_mul_f32 v32, 0x3cf00000, v3
    v_cos_f32 v64, v32
    v_sin_f32 v82, v32
    s_nop 0
    v_mul_f32 v37, v29, v64
    v_fma_f32 v37, -v61, v82, v37
    v_mul_f32 v61, v61, v64
    v_fmac_f32 v61, v29, v82
    v_mul_f32 v32, 0x3cf80000, v3
    v_cos_f32 v64, v32
    v_sin_f32 v82, v32
    s_nop 0
    v_mul_f32 v29, v45, v64
    v_fma_f32 v29, -v77, v82, v29
    v_mul_f32 v77, v77, v64
    v_fmac_f32 v77, v45, v82
    ds_write_b32 v4, v16 offset:0
    ds_write_b32 v4, v48 offset:4
    ds_write_b32 v4, v83 offset:264
    ds_write_b32 v4, v81 offset:268
    ds_write_b32 v4, v80 offset:528
    ds_write_b32 v4, v72 offset:532
    ds_write_b32 v4, v40 offset:792
    ds_write_b32 v4, v60 offset:796
    ds_write_b32 v4, v28 offset:1056
    ds_write_b32 v4, v76 offset:1060
    ds_write_b32 v4, v44 offset:1320
    ds_write_b32 v4, v62 offset:1324
    ds_write_b32 v4, v30 offset:1584
    ds_write_b32 v4, v54 offset:1588
    ds_write_b32 v4, v22 offset:1848
    ds_write_b32 v4, v70 offset:1852
    ds_write_b32 v4, v38 offset:2112
    ds_write_b32 v4, v78 offset:2116
    ds_write_b32 v4, v46 offset:2376
    ds_write_b32 v4, v63 offset:2380
    ds_write_b32 v4, v31 offset:2640
    ds_write_b32 v4, v55 offset:2644
    ds_write_b32 v4, v23 offset:2904
    ds_write_b32 v4, v71 offset:2908
    ds_write_b32 v4, v39 offset:3168
    ds_write_b32 v4, v51 offset:3172
    ds_write_b32 v4, v19 offset:3432
    ds_write_b32 v4, v67 offset:3436
    ds_write_b32 v4, v35 offset:3696
    ds_write_b32 v4, v59 offset:3700
    ds_write_b32 v4, v27 offset:3960
    ds_write_b32 v4, v75 offset:3964
    ds_write_b32 v4, v43 offset:4224
    ds_write_b32 v4, v79 offset:4228
    ds_write_b32 v4, v47 offset:4488
    ds_write_b32 v4, v56 offset:4492
    ds_write_b32 v4, v24 offset:4752
    ds_write_b32 v4, v52 offset:4756
    ds_write_b32 v4, v20 offset:5016
    ds_write_b32 v4, v68 offset:5020
    ds_write_b32 v4, v36 offset:5280
    ds_write_b32 v4, v50 offset:5284
    ds_write_b32 v4, v18 offset:5544
    ds_write_b32 v4, v66 offset:5548
    ds_write_b32 v4, v34 offset:5808
    ds_write_b32 v4, v58 offset:5812
    ds_write_b32 v4, v26 offset:6072
    ds_write_b32 v4, v74 offset:6076
    ds_write_b32 v4, v42 offset:6336
    ds_write_b32 v4, v49 offset:6340
    ds_write_b32 v4, v17 offset:6600
    ds_write_b32 v4, v65 offset:6604
    ds_write_b32 v4, v33 offset:6864
    ds_write_b32 v4, v57 offset:6868
    ds_write_b32 v4, v25 offset:7128
    ds_write_b32 v4, v73 offset:7132
    ds_write_b32 v4, v41 offset:7392
    ds_write_b32 v4, v53 offset:7396
    ds_write_b32 v4, v21 offset:7656
    ds_write_b32 v4, v69 offset:7660
    ds_write_b32 v4, v37 offset:7920
    ds_write_b32 v4, v61 offset:7924
    ds_write_b32 v4, v29 offset:8184
    ds_write_b32 v4, v77 offset:8188
    s_waitcnt lgkmcnt(0)
    ds_read_b32 v16, v5 offset:0
    ds_read_b32 v48, v5 offset:4
    ds_read_b32 v83, v5 offset:8
    ds_read_b32 v81, v5 offset:12
    ds_read_b32 v80, v5 offset:16
    ds_read_b32 v72, v5 offset:20
    ds_read_b32 v40, v5 offset:24
    ds_read_b32 v60, v5 offset:28
    ds_read_b32 v28, v5 offset:32
    ds_read_b32 v76, v5 offset:36
    ds_read_b32 v44, v5 offset:40
    ds_read_b32 v62, v5 offset:44
    ds_read_b32 v30, v5 offset:48
    ds_read_b32 v54, v5 offset:52
    s_waitcnt lgkmcnt(0)
    ds_read_b32 v22, v5 offset:56
    ds_read_b32 v70, v5 offset:60
    ds_read_b32 v38, v5 offset:64
    ds_read_b32 v78, v5 offset:68
    ds_read_b32 v46, v5 offset:72
    ds_read_b32 v63, v5 offset:76
    ds_read_b32 v31, v5 offset:80
    ds_read_b32 v55, v5 offset:84
    ds_read_b32 v23, v5 offset:88
    ds_read_b32 v71, v5 offset:92
    ds_read_b32 v39, v5 offset:96
    ds_read_b32 v51, v5 offset:100
    ds_read_b32 v19, v5 offset:104
    ds_read_b32 v67, v5 offset:108
    s_waitcnt lgkmcnt(0)
    ds_read_b32 v35, v5 offset:112
    ds_read_b32 v59, v5 offset:116
    ds_read_b32 v27, v5 offset:120
    ds_read_b32 v75, v5 offset:124
    ds_read_b32 v43, v5 offset:128
    ds_read_b32 v79, v5 offset:132
    ds_read_b32 v47, v5 offset:136
    ds_read_b32 v56, v5 offset:140
    ds_read_b32 v24, v5 offset:144
    ds_read_b32 v52, v5 offset:148
    ds_read_b32 v20, v5 offset:152
    ds_read_b32 v68, v5 offset:156
    ds_read_b32 v36, v5 offset:160
    ds_read_b32 v50, v5 offset:164
    s_waitcnt lgkmcnt(0)
    ds_read_b32 v18, v5 offset:168
    ds_read_b32 v66, v5 offset:172
    ds_read_b32 v34, v5 offset:176
    ds_read_b32 v58, v5 offset:180
    ds_read_b32 v26, v5 offset:184
    ds_read_b32 v74, v5 offset:188
    ds_read_b32 v42, v5 offset:192
    ds_read_b32 v49, v5 offset:196
    ds_read_b32 v17, v5 offset:200
    ds_read_b32 v65, v5 offset:204
    ds_read_b32 v33, v5 offset:208
    ds_read_b32 v57, v5 offset:212
    ds_read_b32 v25, v5 offset:216
    ds_read_b32 v73, v5 offset:220
    s_waitcnt lgkmcnt(0)
    ds_read_b32 v41, v5 offset:224
    ds_read_b32 v53, v5 offset:228
    ds_read_b32 v21, v5 offset:232
    ds_read_b32 v69, v5 offset:236
    ds_read_b32 v37, v5 offset:240
    ds_read_b32 v61, v5 offset:244
    ds_read_b32 v29, v5 offset:248
    ds_read_b32 v77, v5 offset:252
    s_waitcnt lgkmcnt(0)
    v_sub_f32 v32, v16, v43
    v_sub_f32 v64, v48, v79
    v_add_f32 v16, v16, v43
    v_add_f32 v48, v48, v79
    v_sub_f32 v43, v83, v47
    v_sub_f32 v79, v81, v56
    v_add_f32 v83, v83, v47
    v_add_f32 v81, v81, v56
    v_mul_f32 v47, 0x3f7b14be, v43
    v_mul_f32 v56, 0x3e47c5c2, v43
    v_fmac_f32 v47, 0xbe47c5c2, v79
    v_fmac_f32 v56, 0x3f7b14be, v79
    v_sub_f32 v43, v80, v24
    v_sub_f32 v79, v72, v52
    v_add_f32 v80, v80, v24
    v_add_f32 v72, v72, v52
    v_mul_f32 v24, 0x3f6c835e, v43
    v_mul_f32 v52, 0x3ec3ef15, v43
    v_fmac_f32 v24, 0xbec3ef15, v79
    v_fmac_f32 v52, 0x3f6c835e, v79
    v_sub_f32 v43, v40, v20
    v_sub_f32 v79, v60, v68
    v_add_f32 v40, v40, v20
    v_add_f32 v60, v60, v68
    v_mul_f32 v20, 0x3f54db31, v43
    v_mul_f32 v68, 0x3f0e39da, v43
    v_fmac_f32 v20, 0xbf0e39da, v79
    v_fmac_f32 v68, 0x3f54db31, v79
    v_sub_f32 v43, v28, v36
    v_sub_f32 v79, v76, v50
    v_add_f32 v28, v28, v36
    v_add_f32 v76, v76, v50
    v_mul_f32 v36, 0x3f3504f3, v43
    v_mul_f32 v50, 0x3f3504f3, v43
    v_fmac_f32 v36, 0xbf3504f3, v79
    v_fmac_f32 v50, 0x3f3504f3, v79
    v_sub_f32 v43, v44, v18
    v_sub_f32 v79, v62, v66
    v_add_f32 v44, v44, v18
    v_add_f32 v62, v62, v66
    v_mul_f32 v18, 0x3f0e39da, v43
    v_mul_f32 v66, 0x3f54db31, v43
    v_fmac_f32 v18, 0xbf54db31, v79
    v_fmac_f32 v66, 0x3f0e39da, v79
    v_sub_f32 v43, v30, v34
    v_sub_f32 v79, v54, v58
    v_add_f32 v30, v30, v34
    v_add_f32 v54, v54, v58
    v_mul_f32 v34, 0x3ec3ef15, v43
    v_mul_f32 v58, 0x3f6c835e, v43
    v_fmac_f32 v34, 0xbf6c835e, v79
    v_fmac_f32 v58, 0x3ec3ef15, v79
    v_sub_f32 v43, v22, v26
    v_sub_f32 v79, v70, v74
    v_add_f32 v22, v22, v26
    v_add_f32 v70, v70, v74
    v_mul_f32 v26, 0x3e47c5c2, v43
    v_mul_f32 v74, 0x3f7b14be, v43
    v_fmac_f32 v26, 0xbf7b14be, v79
    v_fmac_f32 v74, 0x3e47c5c2, v79
    v_sub_f32 v43, v49, v78
    v_sub_f32 v79, v38, v42
    v_add_f32 v38, v38, v42
    v_add_f32 v78, v78, v49
    v_sub_f32 v42, v46, v17
    v_sub_f32 v49, v63, v65
    v_add_f32 v46, v46, v17
    v_add_f32 v63, v63, v65
    v_mul_f32 v17, 0xbe47c5c2, v42
    v_mul_f32 v65, 0x3f7b14be, v42
    v_fmac_f32 v17, 0xbf7b14be, v49
    v_fmac_f32 v65, 0xbe47c5c2, v49
    v_sub_f32 v42, v31, v33
    v_sub_f32 v49, v55, v57
    v_add_f32 v31, v31, v33
    v_add_f32 v55, v55, v57
    v_mul_f32 v33, 0xbec3ef15, v42
    v_mul_f32 v57, 0x3f6c835e, v42
    v_fmac_f32 v33, 0xbf6c835e, v49
    v_fmac_f32 v57, 0xbec3ef15, v49
    v_sub_f32 v42, v23, v25
    v_sub_f32 v49, v71, v73
    v_add_f32 v23, v23, v25
    v_add_f32 v71, v71, v73
    v_mul_f32 v25, 0xbf0e39da, v42
    v_mul_f32 v73, 0x3f54db31, v42
    v_fmac_f32 v25, 0xbf54db31, v49
    v_fmac_f32 v73, 0xbf0e39da, v49
    v_sub_f32 v42, v39, v41
    v_sub_f32 v49, v51, v53
    v_add_f32 v39, v39, v41
    v_add_f32 v51, v51, v53
    v_mul_f32 v41, 0xbf3504f3, v42
    v_mul_f32 v53, 0x3f3504f3, v42
    v_fmac_f32 v41, 0xbf3504f3, v49
    v_fmac_f32 v53, 0xbf3504f3, v49
    v_sub_f32 v42, v19, v21
    v_sub_f32 v49, v67, v69
    v_add_f32 v19, v19, v21
    v_add_f32 v67, v67, v69
    v_mul_f32 v21, 0xbf54db31, v42
    v_mul_f32 v69, 0x3f0e39da, v42
    v_fmac_f32 v21, 0xbf0e39da, v49
    v_fmac_f32 v69, 0xbf54db31, v49
    v_sub_f32 v42, v35, v37
    v_sub_f32 v49, v59, v61
    v_add_f32 v35, v35, v37
    v_add_f32 v59, v59, v61
    v_mul_f32 v37, 0xbf6c835e, v42
    v_mul_f32 v61, 0x3ec3ef15, v42
    v_fmac_f32 v37, 0xbec3ef15, v49
    v_fmac_f32 v61, 0xbf6c835e, v49
    v_sub_f32 v42, v27, v29
    v_sub_f32 v49, v75, v77
    v_add_f32 v27, v27, v29
    v_add_f32 v75, v75, v77
    v_mul_f32 v29, 0xbf7b14be, v42
    v_mul_f32 v77, 0x3e47c5c2, v42
    v_fmac_f32 v29, 0xbe47c5c2, v49
    v_fmac_f32 v77, 0xbf7b14be, v49
    v_sub_f32 v42, v16, v38
    v_sub_f32 v49, v48, v78
    v_add_f32 v16, v16, v38
    v_add_f32 v48, v48, v78
    v_sub_f32 v38, v83, v46
    v_sub_f32 v78, v81, v63
    v_add_f32 v83, v83, v46
    v_add_f32 v81, v81, v63
    v_mul_f32 v46, 0x3f6c835e, v38
    v_mul_f32 v63, 0x3ec3ef15, v38
    v_fmac_f32 v46, 0xbec3ef15, v78
    v_fmac_f32 v63, 0x3f6c835e, v78
    v_sub_f32 v38, v80, v31
    v_sub_f32 v78, v72, v55
    v_add_f32 v80, v80, v31
    v_add_f32 v72, v72, v55
    v_mul_f32 v31, 0x3f3504f3, v38
    v_mul_f32 v55, 0x3f3504f3, v38
    v_fmac_f32 v31, 0xbf3504f3, v78
    v_fmac_f32 v55, 0x3f3504f3, v78
    v_sub_f32 v38, v40, v23
    v_sub_f32 v78, v60, v71
    v_add_f32 v40, v40, v23
    v_add_f32 v60, v60, v71
    v_mul_f32 v23, 0x3ec3ef15, v38
    v_mul_f32 v71, 0x3f6c835e, v38
    v_fmac_f32 v23, 0xbf6c835e, v78
    v_fmac_f32 v71, 0x3ec3ef15, v78
    v_sub_f32 v38, v51, v76
    v_sub_f32 v78, v28, v39
    v_add_f32 v28, v28, v39
    v_add_f32 v76, v76, v51
    v_sub_f32 v39, v44, v19
    v_sub_f32 v51, v62, v67
    v_add_f32 v44, v44, v19
    v_add_f32 v62, v62, v67
    v_mul_f32 v19, 0xbec3ef15, v39
    v_mul_f32 v67, 0x3f6c835e, v39
    v_fmac_f32 v19, 0xbf6c835e, v51
    v_fmac_f32 v67, 0xbec3ef15, v51
    v_sub_f32 v39, v30, v35
    v_sub_f32 v51, v54, v59
    v_add_f32 v30, v30, v35
    v_add_f32 v54, v54, v59
    v_mul_f32 v35, 0xbf3504f3, v39
    v_mul_f32 v59, 0x3f3504f3, v39
    v_fmac_f32 v35, 0xbf3504f3, v51
    v_fmac_f32 v59, 0xbf3504f3, v51
    v_sub_f32 v39, v22, v27
    v_sub_f32 v51, v70, v75
    v_add_f32 v22, v22, v27
    v_add_f32 v70, v70, v75
    v_mul_f32 v27, 0xbf6c835e, v39
    v_mul_f32 v75, 0x3ec3ef15, v39
    v_fmac_f32 v27, 0xbec3ef15, v51
    v_fmac_f32 v75, 0xbf6c835e, v51
    v_sub_f32 v39, v32, v43
    v_sub_f32 v51, v64, v79
    v_add_f32 v32, v32, v43
    v_add_f32 v64, v64, v79
    v_sub_f32 v43, v47, v17
    v_sub_f32 v79, v56, v65
    v_add_f32 v47, v47, v17
    v_add_f32 v56, v56, v65
    v_mul_f32 v17, 0x3f6c835e, v43
    v_mul_f32 v65, 0x3ec3ef15, v43
    v_fmac_f32 v17, 0xbec3ef15, v79
    v_fmac_f32 v65, 0x3f6c835e, v79
    v_sub_f32 v43, v24, v33
    v_sub_f32 v79, v52, v57
    v_add_f32 v24, v24, v33
    v_add_f32 v52, v52, v57
    v_mul_f32 v33, 0x3f3504f3, v43
    v_mul_f32 v57, 0x3f3504f3, v43
    v_fmac_f32 v33, 0xbf3504f3, v79
    v_fmac_f32 v57, 0x3f3504f3, v79
    v_sub_f32 v43, v20, v25
    v_sub_f32 v79, v68, v73
    v_add_f32 v20, v20, v25
    v_add_f32 v68, v68, v73
    v_mul_f32 v25, 0x3ec3ef15, v43
    v_mul_f32 v73, 0x3f6c835e, v43
    v_fmac_f32 v25, 0xbf6c835e, v79
    v_fmac_f32 v73, 0x3ec3ef15, v79
    v_sub_f32 v43, v53, v50
    v_sub_f32 v79, v36, v41
    v_add_f32 v36, v36, v41
    v_add_f32 v50, v50, v53
    v_sub_f32 v41, v18, v21
    v_sub_f32 v53, v66, v69
    v_add_f32 v18, v18, v21
    v_add_f32 v66, v66, v69
    v_mul_f32 v21, 0xbec3ef15, v41
    v_mul_f32 v69, 0x3f6c835e, v41
    v_fmac_f32 v21, 0xbf6c835e, v53
    v_fmac_f32 v69, 0xbec3ef15, v53
    v_sub_f32 v41, v34, v37
    v_sub_f32 v53, v58, v61
    v_add_f32 v34, v34, v37
    v_add_f32 v58, v58, v61
    v_mul_f32 v37, 0xbf3504f3, v41
    v_mul_f32 v61, 0x3f3504f3, v41
    v_fmac_f32 v37, 0xbf3504f3, v53
    v_fmac_f32 v61, 0xbf3504f3, v53
    v_sub_f32 v41, v26, v29
    v_sub_f32 v53, v74, v77
    v_add_f32 v26, v26, v29
    v_add_f32 v74, v74, v77
    v_mul_f32 v29, 0xbf6c835e, v41
    v_mul_f32 v77, 0x3ec3ef15, v41
    v_fmac_f32 v29, 0xbec3ef15, v53
    v_fmac_f32 v77, 0xbf6c835e, v53
    v_sub_f32 v41, v16, v28
    v_sub_f32 v53, v48, v76
    v_add_f32 v16, v16, v28
    v_add_f32 v48, v48, v76
    v_sub_f32 v28, v83, v44
    v_sub_f32 v76, v81, v62
    v_add_f32 v83, v83, v44
    v_add_f32 v81, v81, v62
    v_mul_f32 v44, 0x3f3504f3, v28
    v_mul_f32 v62, 0x3f3504f3, v28
    v_fmac_f32 v44, 0xbf3504f3, v76
    v_fmac_f32 v62, 0x3f3504f3, v76
    v_sub_f32 v28, v54, v72
    v_sub_f32 v76, v80, v30
    v_add_f32 v80, v80, v30
    v_add_f32 v72, v72, v54
    v_sub_f32 v30, v40, v22
    v_sub_f32 v54, v60, v70
    v_add_f32 v40, v40, v22
    v_add_f32 v60, v60, v70
    v_mul_f32 v22, 0xbf3504f3, v30
    v_mul_f32 v70, 0x3f3504f3, v30
    v_fmac_f32 v22, 0xbf3504f3, v54
    v_fmac_f32 v70, 0xbf3504f3, v54
    v_sub_f32 v30, v42, v38
    v_sub_f32 v54, v49, v78
    v_add_f32 v42, v42, v38
    v_add_f32 v49, v49, v78
    v_sub_f32 v38, v46, v19
    v_sub_f32 v78, v63, v67
    v_add_f32 v46, v46, v19
    v_add_f32 v63, v63, v67
    v_mul_f32 v19, 0x3f3504f3, v38
    v_mul_f32 v67, 0x3f3504f3, v38
    v_fmac_f32 v19, 0xbf3504f3, v78
    v_fmac_f32 v67, 0x3f3504f3, v78
    v_sub_f32 v38, v59, v55
    v_sub_f32 v78, v31, v35
    v_add_f32 v31, v31, v35
    v_add_f32 v55, v55, v59
    v_sub_f32 v35, v23, v27
    v_sub_f32 v59, v71, v75
    v_add_f32 v23, v23, v27
    v_add_f32 v71, v71, v75
    v_mul_f32 v27, 0xbf3504f3, v35
    v_mul_f32 v75, 0x3f3504f3, v35
    v_fmac_f32 v27, 0xbf3504f3, v59
    v_fmac_f32 v75, 0xbf3504f3, v59
    v_sub_f32 v35, v32, v36
    v_sub_f32 v59, v64, v50
    v_add_f32 v32, v32, v36
    v_add_f32 v64, v64, v50
    v_sub_f32 v36, v47, v18
    v_sub_f32 v50, v56, v66
    v_add_f32 v47, v47, v18
    v_add_f32 v56, v56, v66
    v_mul_f32 v18, 0x3f3504f3, v36
    v_mul_f32 v66, 0x3f3504f3, v36
    v_fmac_f32 v18, 0xbf3504f3, v50
    v_fmac_f32 v66, 0x3f3504f3, v50
    v_sub_f32 v36, v58, v52
    v_sub_f32 v50, v24, v34
    v_add_f32 v24, v24, v34
    v_add_f32 v52, v52, v58
    v_sub_f32 v34, v20, v26
    v_sub_f32 v58, v68, v74
    v_add_f32 v20, v20, v26
    v_add_f32 v68, v68, v74
    v_mul_f32 v26, 0xbf3504f3, v34
    v_mul_f32 v74, 0x3f3504f3, v34
    v_fmac_f32 v26, 0xbf3504f3, v58
    v_fmac_f32 v74, 0xbf3504f3, v58
    v_sub_f32 v34, v39, v43
    v_sub_f32 v58, v51, v79
    v_add_f32 v39, v39, v43
    v_add_f32 v51, v51, v79
    v_sub_f32 v43, v17, v21
    v_sub_f32 v79, v65, v69
    v_add_f32 v17, v17, v21
    v_add_f32 v65, v65, v69
    v_mul_f32 v21, 0x3f3504f3, v43
    v_mul_f32 v69, 0x3f3504f3, v43
    v_fmac_f32 v21, 0xbf3504f3, v79
    v_fmac_f32 v69, 0x3f3504f3, v79
    v_sub_f32 v43, v61, v57
    v_sub_f32 v79, v33, v37
    v_add_f32 v33, v33, v37
    v_add_f32 v57, v57, v61
    v_sub_f32 v37, v25, v29
    v_sub_f32 v61, v73, v77
    v_add_f32 v25, v25, v29
    v_add_f32 v73, v73, v77
    v_mul_f32 v29, 0xbf3504f3, v37
    v_mul_f32 v77, 0x3f3504f3, v37
    v_fmac_f32 v29, 0xbf3504f3, v61
    v_fmac_f32 v77, 0xbf3504f3, v61
    v_sub_f32 v37, v16, v80
    v_sub_f32 v61, v48, v72
    v_add_f32 v16, v16, v80
    v_add_f32 v48, v48, v72
    v_sub_f32 v80, v60, v81
    v_sub_f32 v72, v83, v40
    v_add_f32 v83, v83, v40
    v_add_f32 v81, v81, v60
    v_sub_f32 v40, v41, v28
    v_sub_f32 v60, v53, v76
    v_add_f32 v41, v41, v28
    v_add_f32 v53, v53, v76
    v_sub_f32 v28, v70, v62
    v_sub_f32 v76, v44, v22
    v_add_f32 v44, v44, v22
    v_add_f32 v62, v62, v70
    v_sub_f32 v22, v42, v31
    v_sub_f32 v70, v49, v55
    v_add_f32 v42, v42, v31
    v_add_f32 v49, v49, v55
    v_sub_f32 v31, v71, v63
    v_sub_f32 v55, v46, v23
    v_add_f32 v46, v46, v23
    v_add_f32 v63, v63, v71
    v_sub_f32 v23, v30, v38
    v_sub_f32 v71, v54, v78
    v_add_f32 v30, v30, v38
    v_add_f32 v54, v54, v78
    v_sub_f32 v38, v75, v67
    v_sub_f32 v78, v19, v27
    v_add_f32 v19, v19, v27
    v_add_f32 v67, v67, v75
    v_sub_f32 v27, v32, v24
    v_sub_f32 v75, v64, v52
    v_add_f32 v32, v32, v24
    v_add_f32 v64, v64, v52
    v_sub_f32 v24, v68, v56
    v_sub_f32 v52, v47, v20
    v_add_f32 v47, v47, v20
    v_add_f32 v56, v56, v68
    v_sub_f32 v20, v35, v36
    v_sub_f32 v68, v59, v50
    v_add_f32 v35, v35, v36
    v_add_f32 v59, v59, v50
    v_sub_f32 v36, v74, v66
    v_sub_f32 v50, v18, v26
    v_add_f32 v18, v18, v26
    v_add_f32 v66, v66, v74
    v_sub_f32 v26, v39, v33
    v_sub_f32 v74, v51, v57
    v_add_f32 v39, v39, v33
    v_add_f32 v51, v51, v57
    v_sub_f32 v33, v73, v65
    v_sub_f32 v57, v17, v25
    v_add_f32 v17, v17, v25
    v_add_f32 v65, v65, v73
    v_sub_f32 v25, v34, v43
    v_sub_f32 v73, v58, v79
    v_add_f32 v34, v34, v43
    v_add_f32 v58, v58, v79
    v_sub_f32 v43, v77, v69
    v_sub_f32 v79, v21, v29
    v_add_f32 v21, v21, v29
    v_add_f32 v69, v69, v77
    v_sub_f32 v29, v16, v83
    v_sub_f32 v77, v48, v81
    v_add_f32 v16, v16, v83
    v_add_f32 v48, v48, v81
    v_sub_f32 v83, v37, v80
    v_sub_f32 v81, v61, v72
    v_add_f32 v37, v37, v80
    v_add_f32 v61, v61, v72
    v_sub_f32 v80, v41, v44
    v_sub_f32 v72, v53, v62
    v_add_f32 v41, v41, v44
    v_add_f32 v53, v53, v62
    v_sub_f32 v44, v40, v28
    v_sub_f32 v62, v60, v76
    v_add_f32 v40, v40, v28
    v_add_f32 v60, v60, v76
    v_sub_f32 v28, v42, v46
    v_sub_f32 v76, v49, v63
    v_add_f32 v42, v42, v46
    v_add_f32 v49, v49, v63
    v_sub_f32 v46, v22, v31
    v_sub_f32 v63, v70, v55
    v_add_f32 v22, v22, v31
    v_add_f32 v70, v70, v55
    v_sub_f32 v31, v30, v19
    v_sub_f32 v55, v54, v67
    v_add_f32 v30, v30, v19
    v_add_f32 v54, v54, v67
    v_sub_f32 v19, v23, v38
    v_sub_f32 v67, v71, v78
    v_add_f32 v23, v23, v38
    v_add_f32 v71, v71, v78
    v_sub_f32 v38, v32, v47
    v_sub_f32 v78, v64, v56
    v_add_f32 v32, v32, v47
    v_add_f32 v64, v64, v56
    v_sub_f32 v47, v27, v24
    v_sub_f32 v56, v75, v52
    v_add_f32 v27, v27, v24
    v_add_f32 v75, v75, v52
    v_sub_f32 v24, v35, v18
    v_sub_f32 v52, v59, v66
    v_add_f32 v35, v35, v18
    v_add_f32 v59, v59, v66
    v_sub_f32 v18, v20, v36
    v_sub_f32 v66, v68, v50
    v_add_f32 v20, v20, v36
    v_add_f32 v68, v68, v50
    v_sub_f32 v36, v39, v17
    v_sub_f32 v50, v51, v65
    v_add_f32 v39, v39, v17
    v_add_f32 v51, v51, v65
    v_sub_f32 v17, v26, v33
    v_sub_f32 v65, v74, v57
    v_add_f32 v26, v26, v33
    v_add_f32 v74, v74, v57
    v_sub_f32 v33, v34, v21
    v_sub_f32 v57, v58, v69
    v_add_f32 v34, v34, v21
    v_add_f32 v58, v58, v69
    v_sub_f32 v21, v25, v43
    v_sub_f32 v69, v73, v79
    v_add_f32 v25, v25, v43
    v_add_f32 v73, v73, v79
    v_lshl_add_u32 v6, v1, 2, v7
    ds_write_b32 v6, v16 offset:0
    ds_write_b32 v6, v48 offset:4096
    ds_write_b32 v6, v32 offset:128
    ds_write_b32 v6, v64 offset:4224
    ds_write_b32 v6, v42 offset:256
    ds_write_b32 v6, v49 offset:4352
    ds_write_b32 v6, v39 offset:384
    ds_write_b32 v6, v51 offset:4480
    ds_write_b32 v6, v41 offset:512
    ds_write_b32 v6, v53 offset:4608
    ds_write_b32 v6, v35 offset:640
    ds_write_b32 v6, v59 offset:4736
    ds_write_b32 v6, v30 offset:768
    ds_write_b32 v6, v54 offset:4864
    ds_write_b32 v6, v34 offset:896
    ds_write_b32 v6, v58 offset:4992
    ds_write_b32 v6, v37 offset:1024
    ds_write_b32 v6, v61 offset:5120
    ds_write_b32 v6, v27 offset:1152
    ds_write_b32 v6, v75 offset:5248
    ds_write_b32 v6, v22 offset:1280
    ds_write_b32 v6, v70 offset:5376
    ds_write_b32 v6, v26 offset:1408
    ds_write_b32 v6, v74 offset:5504
    ds_write_b32 v6, v40 offset:1536
    ds_write_b32 v6, v60 offset:5632
    ds_write_b32 v6, v20 offset:1664
    ds_write_b32 v6, v68 offset:5760
    ds_write_b32 v6, v23 offset:1792
    ds_write_b32 v6, v71 offset:5888
    ds_write_b32 v6, v25 offset:1920
    ds_write_b32 v6, v73 offset:6016
    ds_write_b32 v6, v29 offset:2048
    ds_write_b32 v6, v77 offset:6144
    ds_write_b32 v6, v38 offset:2176
    ds_write_b32 v6, v78 offset:6272
    ds_write_b32 v6, v28 offset:2304
    ds_write_b32 v6, v76 offset:6400
    ds_write_b32 v6, v36 offset:2432
    ds_write_b32 v6, v50 offset:6528
    ds_write_b32 v6, v80 offset:2560
    ds_write_b32 v6, v72 offset:6656
    ds_write_b32 v6, v24 offset:2688
    ds_write_b32 v6, v52 offset:6784
    ds_write_b32 v6, v31 offset:2816
    ds_write_b32 v6, v55 offset:6912
    ds_write_b32 v6, v33 offset:2944
    ds_write_b32 v6, v57 offset:7040
    ds_write_b32 v6, v83 offset:3072
    ds_write_b32 v6, v81 offset:7168
    ds_write_b32 v6, v47 offset:3200
    ds_write_b32 v6, v56 offset:7296
    ds_write_b32 v6, v46 offset:3328
    ds_write_b32 v6, v63 offset:7424
    ds_write_b32 v6, v17 offset:3456
    ds_write_b32 v6, v65 offset:7552
    ds_write_b32 v6, v44 offset:3584
    ds_write_b32 v6, v62 offset:7680
    ds_write_b32 v6, v18 offset:3712
    ds_write_b32 v6, v66 offset:7808
    ds_write_b32 v6, v19 offset:3840
    ds_write_b32 v6, v67 offset:7936
    ds_write_b32 v6, v21 offset:3968
    ds_write_b32 v6, v69 offset:8064
    s_waitcnt lgkmcnt(0)
    s_barrier
    v_and_b32 v6, 127, v0
    v_lshrrev_b32 v7, 7, v0
    v_lshlrev_b32 v8, 5, v6
    v_lshl_add_u32 v8, v7, 12, v8
    v_lshlrev_b32 v5, 4, v6
    v_lshl_add_u32 v5, v7, 12, v5
    v_add_u32 v5, 2048, v5
    s_lshl_b32 s12, s92, 16
    ds_read_b128 v[16:19], v8 offset:0
    ds_read_b128 v[20:23], v8 offset:16
    s_waitcnt lgkmcnt(0)
    v_cvt_pk_bf16_f32 v24, v16, v17
    v_cvt_pk_bf16_f32 v25, v18, v19
    v_cvt_pk_bf16_f32 v26, v20, v21
    v_cvt_pk_bf16_f32 v27, v22, v23
    s_add_u32 s13, s12, 0
    buffer_store_dwordx4 v[24:27], v5, s[4:7], s13 offen
    s_nop 1
    ds_read_b128 v[16:19], v8 offset:8448
    ds_read_b128 v[20:23], v8 offset:8464
    s_waitcnt lgkmcnt(0)
    v_cvt_pk_bf16_f32 v24, v16, v17
    v_cvt_pk_bf16_f32 v25, v18, v19
    v_cvt_pk_bf16_f32 v26, v20, v21
    v_cvt_pk_bf16_f32 v27, v22, v23
    s_add_u32 s13, s12, 8192
    buffer_store_dwordx4 v[24:27], v5, s[4:7], s13 offen
    s_nop 1
    ds_read_b128 v[16:19], v8 offset:16896
    ds_read_b128 v[20:23], v8 offset:16912
    s_waitcnt lgkmcnt(0)
    v_cvt_pk_bf16_f32 v24, v16, v17
    v_cvt_pk_bf16_f32 v25, v18, v19
    v_cvt_pk_bf16_f32 v26, v20, v21
    v_cvt_pk_bf16_f32 v27, v22, v23
    s_add_u32 s13, s12, 16384
    buffer_store_dwordx4 v[24:27], v5, s[4:7], s13 offen
    s_nop 1
    ds_read_b128 v[16:19], v8 offset:25344
    ds_read_b128 v[20:23], v8 offset:25360
    s_waitcnt lgkmcnt(0)
    v_cvt_pk_bf16_f32 v24, v16, v17
    v_cvt_pk_bf16_f32 v25, v18, v19
    v_cvt_pk_bf16_f32 v26, v20, v21
    v_cvt_pk_bf16_f32 v27, v22, v23
    s_add_u32 s13, s12, 24576
    buffer_store_dwordx4 v[24:27], v5, s[4:7], s13 offen
    s_nop 1
    ds_read_b128 v[16:19], v8 offset:33792
    ds_read_b128 v[20:23], v8 offset:33808
    s_waitcnt lgkmcnt(0)
    v_cvt_pk_bf16_f32 v24, v16, v17
    v_cvt_pk_bf16_f32 v25, v18, v19
    v_cvt_pk_bf16_f32 v26, v20, v21
    v_cvt_pk_bf16_f32 v27, v22, v23
    s_add_u32 s13, s12, 32768
    buffer_store_dwordx4 v[24:27], v5, s[4:7], s13 offen
    s_nop 1
    ds_read_b128 v[16:19], v8 offset:42240
    ds_read_b128 v[20:23], v8 offset:42256
    s_waitcnt lgkmcnt(0)
    v_cvt_pk_bf16_f32 v24, v16, v17
    v_cvt_pk_bf16_f32 v25, v18, v19
    v_cvt_pk_bf16_f32 v26, v20, v21
    v_cvt_pk_bf16_f32 v27, v22, v23
    s_add_u32 s13, s12, 40960
    buffer_store_dwordx4 v[24:27], v5, s[4:7], s13 offen
    s_nop 1
    ds_read_b128 v[16:19], v8 offset:50688
    ds_read_b128 v[20:23], v8 offset:50704
    s_waitcnt lgkmcnt(0)
    v_cvt_pk_bf16_f32 v24, v16, v17
    v_cvt_pk_bf16_f32 v25, v18, v19
    v_cvt_pk_bf16_f32 v26, v20, v21
    v_cvt_pk_bf16_f32 v27, v22, v23
    s_add_u32 s13, s12, 49152
    buffer_store_dwordx4 v[24:27], v5, s[4:7], s13 offen
    s_nop 1
    ds_read_b128 v[16:19], v8 offset:59136
    ds_read_b128 v[20:23], v8 offset:59152
    s_waitcnt lgkmcnt(0)
    v_cvt_pk_bf16_f32 v24, v16, v17
    v_cvt_pk_bf16_f32 v25, v18, v19
    v_cvt_pk_bf16_f32 v26, v20, v21
    v_cvt_pk_bf16_f32 v27, v22, v23
    s_add_u32 s13, s12, 57344
    buffer_store_dwordx4 v[24:27], v5, s[4:7], s13 offen
    s_nop 1
mega_kernel_xo:
    s_load_dwordx2 s[8:9], s[0:1], 40
    s_load_dwordx2 s[12:13], s[0:1], 80
    v_lshrrev_b32 v3, 6, v0
    v_and_b32 v1, 63, v0
    v_readfirstlane_b32 s16, v3
    s_lshr_b32 s17, s92, 5
    s_and_b32 s18, s92, 31
    v_lshlrev_b32 v2, 4, v1
    s_waitcnt lgkmcnt(0) vmcnt(0)
    s_barrier
    s_mov_b32 s10, 8388608
    s_mov_b32 s11, 0x00020000
    s_mov_b32 s14, 8388608
    s_mov_b32 s15, 0x00020000
    s_mov_b32 s24, 0x3e0293ee
    v_lshrrev_b32 v3, 2, v1
    v_lshlrev_b32 v3, 11, v3
    v_and_b32 v4, 3, v1
    v_lshl_add_u32 v3, v4, 4, v3
    s_lshl_b32 s20, s16, 21
    s_lshl_b32 s21, s18, 6
    s_add_u32 s20, s20, s21
    v_add_u32 v24, s20, v3
    s_lshl_b32 s44, s16, 15
    v_lshrrev_b32 v3, 5, v1
    v_bfe_u32 v5, v1, 2, 2
    v_lshl_add_u32 v3, v3, 3, v5
    v_lshlrev_b32 v25, 6, v3
    v_bfe_u32 v5, v1, 4, 1
    v_lshl_add_u32 v25, v5, 5, v25
    v_lshl_add_u32 v25, v4, 3, v25
    v_add_u32 v25, s44, v25
    s_add_u32 m0, s44, 0
    s_mov_b32 s20, 0
    buffer_load_dwordx4 v24, s[8:11], s20 offen lds
    s_add_u32 m0, s44, 1024
    s_mov_b32 s20, 32768
    buffer_load_dwordx4 v24, s[8:11], s20 offen lds
    s_add_u32 m0, s44, 2048
    s_mov_b32 s20, 65536
    buffer_load_dwordx4 v24, s[8:11], s20 offen lds
    s_add_u32 m0, s44, 3072
    s_mov_b32 s20, 98304
    buffer_load_dwordx4 v24, s[8:11], s20 offen lds
    s_add_u32 m0, s44, 4096
    s_mov_b32 s20, 131072
    buffer_load_dwordx4 v24, s[8:11], s20 offen lds
    s_add_u32 m0, s44, 5120
    s_mov_b32 s20, 163840
    buffer_load_dwordx4 v24, s[8:11], s20 offen lds
    s_add_u32 m0, s44, 6144
    s_mov_b32 s20, 196608
    buffer_load_dwordx4 v24, s[8:11], s20 offen lds
    s_add_u32 m0, s44, 7168
    s_mov_b32 s20, 229376
    buffer_load_dwordx4 v24, s[8:11], s20 offen lds
    s_add_u32 m0, s44, 8192
    s_mov_b32 s20, 262144
    buffer_load_dwordx4 v24, s[8:11], s20 offen lds
    s_add_u32 m0, s44, 9216
    s_mov_b32 s20, 294912
    buffer_load_dwordx4 v24, s[8:11], s20 offen lds
    s_add_u32 m0, s44, 10240
    s_mov_b32 s20, 327680
    buffer_load_dwordx4 v24, s[8:11], s20 offen lds
    s_add_u32 m0, s44, 11264
    s_mov_b32 s20, 360448
    buffer_load_dwordx4 v24, s[8:11], s20 offen lds
    s_add_u32 m0, s44, 12288
    s_mov_b32 s20, 393216
    buffer_load_dwordx4 v24, s[8:11], s20 offen lds
    s_add_u32 m0, s44, 13312
    s_mov_b32 s20, 425984
    buffer_load_dwordx4 v24, s[8:11], s20 offen lds
    s_add_u32 m0, s44, 14336
    s_mov_b32 s20, 458752
    buffer_load_dwordx4 v24, s[8:11], s20 offen lds
    s_add_u32 m0, s44, 15360
    s_mov_b32 s20, 491520
    buffer_load_dwordx4 v24, s[8:11], s20 offen lds
    s_add_u32 m0, s44, 16384
    s_mov_b32 s20, 524288
    buffer_load_dwordx4 v24, s[8:11], s20 offen lds
    s_add_u32 m0, s44, 17408
    s_mov_b32 s20, 557056
    buffer_load_dwordx4 v24, s[8:11], s20 offen lds
    s_add_u32 m0, s44, 18432
    s_mov_b32 s20, 589824
    buffer_load_dwordx4 v24, s[8:11], s20 offen lds
    s_add_u32 m0, s44, 19456
    s_mov_b32 s20, 622592
    buffer_load_dwordx4 v24, s[8:11], s20 offen lds
    s_add_u32 m0, s44, 20480
    s_mov_b32 s20, 655360
    buffer_load_dwordx4 v24, s[8:11], s20 offen lds
    s_add_u32 m0, s44, 21504
    s_mov_b32 s20, 688128
    buffer_load_dwordx4 v24, s[8:11], s20 offen lds
    s_add_u32 m0, s44, 22528
    s_mov_b32 s20, 720896
    buffer_load_dwordx4 v24, s[8:11], s20 offen lds
    s_add_u32 m0, s44, 23552
    s_mov_b32 s20, 753664
    buffer_load_dwordx4 v24, s[8:11], s20 offen lds
    s_add_u32 m0, s44, 24576
    s_mov_b32 s20, 786432
    buffer_load_dwordx4 v24, s[8:11], s20 offen lds
    s_add_u32 m0, s44, 25600
    s_mov_b32 s20, 819200
    buffer_load_dwordx4 v24, s[8:11], s20 offen lds
    s_add_u32 m0, s44, 26624
    s_mov_b32 s20, 851968
    buffer_load_dwordx4 v24, s[8:11], s20 offen lds
    s_add_u32 m0, s44, 27648
    s_mov_b32 s20, 884736
    buffer_load_dwordx4 v24, s[8:11], s20 offen lds
    s_add_u32 m0, s44, 28672
    s_mov_b32 s20, 917504
    buffer_load_dwordx4 v24, s[8:11], s20 offen lds
    s_add_u32 m0, s44, 29696
    s_mov_b32 s20, 950272
    buffer_load_dwordx4 v24, s[8:11], s20 offen lds
    s_add_u32 m0, s44, 30720
    s_mov_b32 s20, 983040
    buffer_load_dwordx4 v24, s[8:11], s20 offen lds
    s_add_u32 m0, s44, 31744
    s_mov_b32 s20, 1015808
    buffer_load_dwordx4 v24, s[8:11], s20 offen lds
    v_and_b32 v4, 15, v1
    v_lshrrev_b32 v5, 4, v1
    v_lshrrev_b32 v3, 2, v4
    v_lshlrev_b32 v3, 1, v3
    v_and_b32 v26, 1, v4
    v_add_u32 v3, v3, v26
    v_lshlrev_b32 v6, 8, v3
    v_lshl_add_u32 v6, v5, 4, v6
    s_lshr_b32 s20, s16, 1
    s_lshl_b32 s20, s20, 10
    s_add_u32 s20, s20, 2048
    v_lshlrev_b32 v7, 3, v1
    v_add_u32 v7, s20, v7
    v_lshlrev_b32 v8, 9, v5
    v_lshl_add_u32 v8, v4, 4, v8
    s_lshr_b32 s20, s16, 1
    s_lshl_b32 s20, s20, 12
    s_and_b32 s21, s16, 1
    s_lshl_b32 s21, s21, 8
    s_add_u32 s20, s20, s21
    v_add_u32 v8, s20, v8
    v_lshlrev_b32 v26, 2, v5
    v_sub_u32 v9, v4, v26
    s_lshr_b32 s21, s21, 4
    v_add_u32 v9, s21, v9
    v_add_u32 v10, -16, v9
    v_mov_b32 v11, 0xff7fffff
    v_mov_b32 v20, 0x3f803f80
    v_mov_b32 v21, 0x3f803f80
    v_mov_b32 v22, 0x3f803f80
    v_mov_b32 v23, 0x3f803f80
    v_and_b32 v26, 3, v1
    v_cmp_eq_u32 vcc, 3, v26
    s_lshl_b32 s20, s18, 8
    s_add_u32 s20, s20, 71303168
    v_cndmask_b32 v26, v26, 0, vcc
    v_lshlrev_b32 v12, 13, v26
    v_add_u32 v12, s20, v12
    v_and_b32 v26, 1, v1
    v_lshlrev_b32 v13, 7, v26
    s_add_u32 s20, s20, 24576
    v_add_u32 v13, s20, v13
    v_and_b32 v26, 7, v1
    s_lshl_b32 s20, s17, 5
    s_lshl_b32 s21, s16, 3
    s_add_u32 s20, s20, s21
    v_add_u32 v26, s20, v26
    v_lshlrev_b32 v14, 7, v26
    v_add_u32 v14, 71335936, v14
    v_bfrev_b32 v26, 1
    s_lshl_b32 s20, s92, 7
    s_add_u32 s20, s20, 71335936
    v_mov_b32 v27, s20
    v_cmp_eq_u32 vcc, 0, v0
    s_lshl_b32 s20, s16, 12
    v_add_u32 v17, s20, v2
    v_cndmask_b32 v15, v26, v27, vcc
    v_lshrrev_b32 v26, 3, v0
    v_and_b32 v27, 1, v0
    v_lshl_add_u32 v27, v27, 5, v26
    v_lshlrev_b32 v16, 4, v27
    v_bfe_u32 v27, v0, 1, 2
    v_lshl_add_u32 v16, v27, 10, v16
    v_lshlrev_b32 v18, 12, v26
    v_and_b32 v27, 7, v0
    v_lshl_add_u32 v18, v27, 3, v18
    s_lshl_b32 s20, s18, 6
    v_add_u32 v18, s20, v18
    s_waitcnt vmcnt(28)
    ds_read_b64_tr_b16 a[0:1], v25 offset:0
    ds_read_b64_tr_b16 a[2:3], v25 offset:256
    ds_read_b64_tr_b16 a[4:5], v25 offset:1024
    ds_read_b64_tr_b16 a[6:7], v25 offset:1280
    ds_read_b64_tr_b16 a[8:9], v25 offset:2048
    ds_read_b64_tr_b16 a[10:11], v25 offset:2304
    ds_read_b64_tr_b16 a[12:13], v25 offset:3072
    ds_read_b64_tr_b16 a[14:15], v25 offset:3328
    s_waitcnt lgkmcnt(0)
    s_add_u32 m0, s44, 0
    s_mov_b32 s20, 1048576
    buffer_load_dwordx4 v24, s[8:11], s20 offen lds
    s_add_u32 m0, s44, 1024
    s_mov_b32 s20, 1081344
    buffer_load_dwordx4 v24, s[8:11], s20 offen lds
    s_add_u32 m0, s44, 2048
    s_mov_b32 s20, 1114112
    buffer_load_dwordx4 v24, s[8:11], s20 offen lds
    s_add_u32 m0, s44, 3072
    s_mov_b32 s20, 1146880
    buffer_load_dwordx4 v24, s[8:11], s20 offen lds
    s_waitcnt vmcnt(28)
    ds_read_b64_tr_b16 a[16:17], v25 offset:4096
    ds_read_b64_tr_b16 a[18:19], v25 offset:4352
    ds_read_b64_tr_b16 a[20:21], v25 offset:5120
    ds_read_b64_tr_b16 a[22:23], v25 offset:5376
    ds_read_b64_tr_b16 a[24:25], v25 offset:6144
    ds_read_b64_tr_b16 a[26:27], v25 offset:6400
    ds_read_b64_tr_b16 a[28:29], v25 offset:7168
    ds_read_b64_tr_b16 a[30:31], v25 offset:7424
    s_waitcnt lgkmcnt(0)
    s_add_u32 m0, s44, 4096
    s_mov_b32 s20, 1179648
    buffer_load_dwordx4 v24, s[8:11], s20 offen lds
    s_add_u32 m0, s44, 5120
    s_mov_b32 s20, 1212416
    buffer_load_dwordx4 v24, s[8:11], s20 offen lds
    s_add_u32 m0, s44, 6144
    s_mov_b32 s20, 1245184
    buffer_load_dwordx4 v24, s[8:11], s20 offen lds
    s_add_u32 m0, s44, 7168
    s_mov_b32 s20, 1277952
    buffer_load_dwordx4 v24, s[8:11], s20 offen lds
    s_waitcnt vmcnt(28)
    ds_read_b64_tr_b16 a[32:33], v25 offset:8192
    ds_read_b64_tr_b16 a[34:35], v25 offset:8448
    ds_read_b64_tr_b16 a[36:37], v25 offset:9216
    ds_read_b64_tr_b16 a[38:39], v25 offset:9472
    ds_read_b64_tr_b16 a[40:41], v25 offset:10240
    ds_read_b64_tr_b16 a[42:43], v25 offset:10496
    ds_read_b64_tr_b16 a[44:45], v25 offset:11264
    ds_read_b64_tr_b16 a[46:47], v25 offset:11520
    s_waitcnt lgkmcnt(0)
    s_add_u32 m0, s44, 8192
    s_mov_b32 s20, 1310720
    buffer_load_dwordx4 v24, s[8:11], s20 offen lds
    s_add_u32 m0, s44, 9216
    s_mov_b32 s20, 1343488
    buffer_load_dwordx4 v24, s[8:11], s20 offen lds
    s_add_u32 m0, s44, 10240
    s_mov_b32 s20, 1376256
    buffer_load_dwordx4 v24, s[8:11], s20 offen lds
    s_add_u32 m0, s44, 11264
    s_mov_b32 s20, 1409024
    buffer_load_dwordx4 v24, s[8:11], s20 offen lds
    s_waitcnt vmcnt(28)
    ds_read_b64_tr_b16 a[48:49], v25 offset:12288
    ds_read_b64_tr_b16 a[50:51], v25 offset:12544
    ds_read_b64_tr_b16 a[52:53], v25 offset:13312
    ds_read_b64_tr_b16 a[54:55], v25 offset:13568
    ds_read_b64_tr_b16 a[56:57], v25 offset:14336
    ds_read_b64_tr_b16 a[58:59], v25 offset:14592
    ds_read_b64_tr_b16 a[60:61], v25 offset:15360
    ds_read_b64_tr_b16 a[62:63], v25 offset:15616
    s_waitcnt lgkmcnt(0)
    s_add_u32 m0, s44, 12288
    s_mov_b32 s20, 1441792
    buffer_load_dwordx4 v24, s[8:11], s20 offen lds
    s_add_u32 m0, s44, 13312
    s_mov_b32 s20, 1474560
    buffer_load_dwordx4 v24, s[8:11], s20 offen lds
    s_add_u32 m0, s44, 14336
    s_mov_b32 s20, 1507328
    buffer_load_dwordx4 v24, s[8:11], s20 offen lds
    s_add_u32 m0, s44, 15360
    s_mov_b32 s20, 1540096
    buffer_load_dwordx4 v24, s[8:11], s20 offen lds
    s_waitcnt vmcnt(28)
    ds_read_b64_tr_b16 a[64:65], v25 offset:16384
    ds_read_b64_tr_b16 a[66:67], v25 offset:16640
    ds_read_b64_tr_b16 a[68:69], v25 offset:17408
    ds_read_b64_tr_b16 a[70:71], v25 offset:17664
    ds_read_b64_tr_b16 a[72:73], v25 offset:18432
    ds_read_b64_tr_b16 a[74:75], v25 offset:18688
    ds_read_b64_tr_b16 a[76:77], v25 offset:19456
    ds_read_b64_tr_b16 a[78:79], v25 offset:19712
    s_waitcnt lgkmcnt(0)
    s_add_u32 m0, s44, 16384
    s_mov_b32 s20, 1572864
    buffer_load_dwordx4 v24, s[8:11], s20 offen lds
    s_add_u32 m0, s44, 17408
    s_mov_b32 s20, 1605632
    buffer_load_dwordx4 v24, s[8:11], s20 offen lds
    s_add_u32 m0, s44, 18432
    s_mov_b32 s20, 1638400
    buffer_load_dwordx4 v24, s[8:11], s20 offen lds
    s_add_u32 m0, s44, 19456
    s_mov_b32 s20, 1671168
    buffer_load_dwordx4 v24, s[8:11], s20 offen lds
    s_waitcnt vmcnt(28)
    ds_read_b64_tr_b16 a[80:81], v25 offset:20480
    ds_read_b64_tr_b16 a[82:83], v25 offset:20736
    ds_read_b64_tr_b16 a[84:85], v25 offset:21504
    ds_read_b64_tr_b16 a[86:87], v25 offset:21760
    ds_read_b64_tr_b16 a[88:89], v25 offset:22528
    ds_read_b64_tr_b16 a[90:91], v25 offset:22784
    ds_read_b64_tr_b16 a[92:93], v25 offset:23552
    ds_read_b64_tr_b16 a[94:95], v25 offset:23808
    s_waitcnt lgkmcnt(0)
    s_add_u32 m0, s44, 20480
    s_mov_b32 s20, 1703936
    buffer_load_dwordx4 v24, s[8:11], s20 offen lds
    s_add_u32 m0, s44, 21504
    s_mov_b32 s20, 1736704
    buffer_load_dwordx4 v24, s[8:11], s20 offen lds
    s_add_u32 m0, s44, 22528
    s_mov_b32 s20, 1769472
    buffer_load_dwordx4 v24, s[8:11], s20 offen lds
    s_add_u32 m0, s44, 23552
    s_mov_b32 s20, 1802240
    buffer_load_dwordx4 v24, s[8:11], s20 offen lds
    s_waitcnt vmcnt(28)
    ds_read_b64_tr_b16 a[96:97], v25 offset:24576
    ds_read_b64_tr_b16 a[98:99], v25 offset:24832
    ds_read_b64_tr_b16 a[100:101], v25 offset:25600
    ds_read_b64_tr_b16 a[102:103], v25 offset:25856
    ds_read_b64_tr_b16 a[104:105], v25 offset:26624
    ds_read_b64_tr_b16 a[106:107], v25 offset:26880
    ds_read_b64_tr_b16 a[108:109], v25 offset:27648
    ds_read_b64_tr_b16 a[110:111], v25 offset:27904
    s_waitcnt lgkmcnt(0)
    s_add_u32 m0, s44, 24576
    s_mov_b32 s20, 1835008
    buffer_load_dwordx4 v24, s[8:11], s20 offen lds
    s_add_u32 m0, s44, 25600
    s_mov_b32 s20, 1867776
    buffer_load_dwordx4 v24, s[8:11], s20 offen lds
    s_add_u32 m0, s44, 26624
    s_mov_b32 s20, 1900544
    buffer_load_dwordx4 v24, s[8:11], s20 offen lds
    s_add_u32 m0, s44, 27648
    s_mov_b32 s20, 1933312
    buffer_load_dwordx4 v24, s[8:11], s20 offen lds
    s_waitcnt vmcnt(28)
    ds_read_b64_tr_b16 a[112:113], v25 offset:28672
    ds_read_b64_tr_b16 a[114:115], v25 offset:28928
    ds_read_b64_tr_b16 a[116:117], v25 offset:29696
    ds_read_b64_tr_b16 a[118:119], v25 offset:29952
    ds_read_b64_tr_b16 a[120:121], v25 offset:30720
    ds_read_b64_tr_b16 a[122:123], v25 offset:30976
    ds_read_b64_tr_b16 a[124:125], v25 offset:31744
    ds_read_b64_tr_b16 a[126:127], v25 offset:32000
    s_waitcnt lgkmcnt(0)
    s_add_u32 m0, s44, 28672
    s_mov_b32 s20, 1966080
    buffer_load_dwordx4 v24, s[8:11], s20 offen lds
    s_add_u32 m0, s44, 29696
    s_mov_b32 s20, 1998848
    buffer_load_dwordx4 v24, s[8:11], s20 offen lds
    s_add_u32 m0, s44, 30720
    s_mov_b32 s20, 2031616
    buffer_load_dwordx4 v24, s[8:11], s20 offen lds
    s_add_u32 m0, s44, 31744
    s_mov_b32 s20, 2064384
    buffer_load_dwordx4 v24, s[8:11], s20 offen lds
    s_waitcnt vmcnt(28)
    ds_read_b64_tr_b16 a[128:129], v25 offset:0
    ds_read_b64_tr_b16 a[130:131], v25 offset:256
    ds_read_b64_tr_b16 a[132:133], v25 offset:1024
    ds_read_b64_tr_b16 a[134:135], v25 offset:1280
    ds_read_b64_tr_b16 a[136:137], v25 offset:2048
    ds_read_b64_tr_b16 a[138:139], v25 offset:2304
    ds_read_b64_tr_b16 a[140:141], v25 offset:3072
    ds_read_b64_tr_b16 a[142:143], v25 offset:3328
    s_waitcnt lgkmcnt(0)
    s_waitcnt vmcnt(24)
    ds_read_b64_tr_b16 a[144:145], v25 offset:4096
    ds_read_b64_tr_b16 a[146:147], v25 offset:4352
    ds_read_b64_tr_b16 a[148:149], v25 offset:5120
    ds_read_b64_tr_b16 a[150:151], v25 offset:5376
    ds_read_b64_tr_b16 a[152:153], v25 offset:6144
    ds_read_b64_tr_b16 a[154:155], v25 offset:6400
    ds_read_b64_tr_b16 a[156:157], v25 offset:7168
    ds_read_b64_tr_b16 a[158:159], v25 offset:7424
    s_waitcnt lgkmcnt(0)
    s_waitcnt vmcnt(20)
    ds_read_b64_tr_b16 a[160:161], v25 offset:8192
    ds_read_b64_tr_b16 a[162:163], v25 offset:8448
    ds_read_b64_tr_b16 a[164:165], v25 offset:9216
    ds_read_b64_tr_b16 a[166:167], v25 offset:9472
    ds_read_b64_tr_b16 a[168:169], v25 offset:10240
    ds_read_b64_tr_b16 a[170:171], v25 offset:10496
    ds_read_b64_tr_b16 a[172:173], v25 offset:11264
    ds_read_b64_tr_b16 a[174:175], v25 offset:11520
    s_waitcnt lgkmcnt(0)
    s_waitcnt vmcnt(16)
    ds_read_b64_tr_b16 a[176:177], v25 offset:12288
    ds_read_b64_tr_b16 a[178:179], v25 offset:12544
    ds_read_b64_tr_b16 a[180:181], v25 offset:13312
    ds_read_b64_tr_b16 a[182:183], v25 offset:13568
    ds_read_b64_tr_b16 a[184:185], v25 offset:14336
    ds_read_b64_tr_b16 a[186:187], v25 offset:14592
    ds_read_b64_tr_b16 a[188:189], v25 offset:15360
    ds_read_b64_tr_b16 a[190:191], v25 offset:15616
    s_waitcnt lgkmcnt(0)
    s_waitcnt vmcnt(12)
    ds_read_b64_tr_b16 a[192:193], v25 offset:16384
    ds_read_b64_tr_b16 a[194:195], v25 offset:16640
    ds_read_b64_tr_b16 a[196:197], v25 offset:17408
    ds_read_b64_tr_b16 a[198:199], v25 offset:17664
    ds_read_b64_tr_b16 a[200:201], v25 offset:18432
    ds_read_b64_tr_b16 a[202:203], v25 offset:18688
    ds_read_b64_tr_b16 a[204:205], v25 offset:19456
    ds_read_b64_tr_b16 a[206:207], v25 offset:19712
    s_waitcnt lgkmcnt(0)
    s_waitcnt vmcnt(8)
    ds_read_b64_tr_b16 a[208:209], v25 offset:20480
    ds_read_b64_tr_b16 a[210:211], v25 offset:20736
    ds_read_b64_tr_b16 a[212:213], v25 offset:21504
    ds_read_b64_tr_b16 a[214:215], v25 offset:21760
    ds_read_b64_tr_b16 a[216:217], v25 offset:22528
    ds_read_b64_tr_b16 a[218:219], v25 offset:22784
    ds_read_b64_tr_b16 a[220:221], v25 offset:23552
    ds_read_b64_tr_b16 a[222:223], v25 offset:23808
    s_waitcnt lgkmcnt(0)
    s_waitcnt vmcnt(4)
    ds_read_b64_tr_b16 a[224:225], v25 offset:24576
    ds_read_b64_tr_b16 a[226:227], v25 offset:24832
    ds_read_b64_tr_b16 a[228:229], v25 offset:25600
    ds_read_b64_tr_b16 a[230:231], v25 offset:25856
    ds_read_b64_tr_b16 a[232:233], v25 offset:26624
    ds_read_b64_tr_b16 a[234:235], v25 offset:26880
    ds_read_b64_tr_b16 a[236:237], v25 offset:27648
    ds_read_b64_tr_b16 a[238:239], v25 offset:27904
    s_waitcnt lgkmcnt(0)
    s_waitcnt vmcnt(0)
    ds_read_b64_tr_b16 a[240:241], v25 offset:28672
    ds_read_b64_tr_b16 a[242:243], v25 offset:28928
    ds_read_b64_tr_b16 a[244:245], v25 offset:29696
    ds_read_b64_tr_b16 a[246:247], v25 offset:29952
    ds_read_b64_tr_b16 a[248:249], v25 offset:30720
    ds_read_b64_tr_b16 a[250:251], v25 offset:30976
    ds_read_b64_tr_b16 a[252:253], v25 offset:31744
    ds_read_b64_tr_b16 a[254:255], v25 offset:32000
    s_waitcnt lgkmcnt(0)
    s_barrier
    s_add_u32 s22, s17, 12
    s_sub_u32 s20, s17, 4
    s_cmp_ge_u32 s17, 4
    s_cselect_b32 s22, s20, s22
    s_and_b32 s20, s22, 1
    s_lshl_b32 s20, s20, 7
    s_lshr_b32 s43, s22, 1
mega_kernel_x_gpa:
    buffer_load_dword v3, v12, s[84:87], s20 offen sc1
    s_waitcnt vmcnt(0)
    v_cmp_ge_u32 vcc, s43, v3
    s_cbranch_vccz mega_kernel_x_gka
    s_sleep 8
    s_branch mega_kernel_x_gpa
mega_kernel_x_gka:
    s_lshl_b32 s27, s22, 18
    s_lshl_b32 s20, s18, 13
    s_add_u32 s27, s27, s20
    s_and_b32 s20, s16, 1
    s_lshl_b32 s20, s20, 10
    s_add_u32 s26, s27, s20
    s_lshr_b32 s20, s16, 1
    s_lshl_b32 s20, s20, 12
    s_add_u32 s28, s27, s20
    s_add_u32 s28, s28, 33554432
    s_add_u32 s27, s27, 16777216
    s_add_u32 s20, s26, 4096
    s_add_u32 s21, s27, 4096
    buffer_load_dwordx4 v[24:27], v2, s[84:87], s26 offen offset:0
    buffer_load_dwordx4 v[28:31], v2, s[84:87], s26 offen offset:2048
    buffer_load_dwordx4 v[32:35], v2, s[84:87], s20 offen offset:0
    buffer_load_dwordx4 v[36:39], v2, s[84:87], s20 offen offset:2048
    buffer_load_dwordx4 v[40:43], v2, s[84:87], s27 offen offset:0
    buffer_load_dwordx4 v[44:47], v2, s[84:87], s27 offen offset:1024
    buffer_load_dwordx4 v[48:51], v2, s[84:87], s27 offen offset:2048
    buffer_load_dwordx4 v[52:55], v2, s[84:87], s27 offen offset:3072
    buffer_load_dwordx4 v[56:59], v2, s[84:87], s21 offen offset:0
    buffer_load_dwordx4 v[60:63], v2, s[84:87], s21 offen offset:1024
    buffer_load_dwordx4 v[64:67], v2, s[84:87], s21 offen offset:2048
    buffer_load_dwordx4 v[68:71], v2, s[84:87], s21 offen offset:3072
    buffer_load_dwordx4 v[72:75], v2, s[84:87], s28 offen offset:0
    buffer_load_dwordx4 v[76:79], v2, s[84:87], s28 offen offset:1024
    buffer_load_dwordx4 v[80:83], v2, s[84:87], s28 offen offset:2048
    buffer_load_dwordx4 v[84:87], v2, s[84:87], s28 offen offset:3072
mega_kernel_x_loop:
    s_waitcnt vmcnt(0)
    v_mfma_f32_16x16x32_bf16 v[112:115], v[40:43], v[24:27], 0
    v_mfma_f32_16x16x32_bf16 v[116:119], v[44:47], v[24:27], 0
    v_mfma_f32_16x16x32_bf16 v[112:115], v[48:51], v[28:31], v[112:115]
    v_mfma_f32_16x16x32_bf16 v[116:119], v[52:55], v[28:31], v[116:119]
    v_mfma_f32_16x16x32_bf16 v[112:115], v[56:59], v[32:35], v[112:115]
    v_mfma_f32_16x16x32_bf16 v[116:119], v[60:63], v[32:35], v[116:119]
    v_mfma_f32_16x16x32_bf16 v[112:115], v[64:67], v[36:39], v[112:115]
    v_mfma_f32_16x16x32_bf16 v[116:119], v[68:71], v[36:39], v[116:119]
    s_lshl_b32 s29, s22, 17
    s_lshl_b32 s20, s18, 12
    s_add_u32 s29, s29, s20
    s_add_u32 s29, s29, 178257920
    s_lshl_b32 s41, s22, 18
    s_add_u32 s41, s41, 50331648
    s_lshl_b32 s20, s18, 13
    s_add_u32 s40, s41, s20
    s_lshl_b32 s20, s16, 16
    s_add_u32 s41, s41, s20
    s_lshl_b32 s42, s22, 17
    v_cmp_gt_i32 vcc, 0, v9
    s_nop 1
    v_cndmask_b32 v112, v112, v11, vcc
    v_cmp_gt_i32 vcc, 1, v9
    s_nop 1
    v_cndmask_b32 v113, v113, v11, vcc
    v_cmp_gt_i32 vcc, 2, v9
    s_nop 1
    v_cndmask_b32 v114, v114, v11, vcc
    v_cmp_gt_i32 vcc, 3, v9
    s_nop 1
    v_cndmask_b32 v115, v115, v11, vcc
    v_cmp_gt_i32 vcc, 0, v10
    s_nop 1
    v_cndmask_b32 v116, v116, v11, vcc
    v_cmp_gt_i32 vcc, 1, v10
    s_nop 1
    v_cndmask_b32 v117, v117, v11, vcc
    v_cmp_gt_i32 vcc, 2, v10
    s_nop 1
    v_cndmask_b32 v118, v118, v11, vcc
    v_cmp_gt_i32 vcc, 3, v10
    s_nop 1
    v_cndmask_b32 v119, v119, v11, vcc
mega_kernel_x_rp:
    buffer_load_dword v3, v13, s[84:87], 0 offen sc1
    s_waitcnt vmcnt(0)
    v_cmp_ge_u32 vcc, s22, v3
    s_cbranch_vccz mega_kernel_x_rk
    s_sleep 4
    s_branch mega_kernel_x_rp
mega_kernel_x_rk:
    buffer_load_dwordx4 v[88:91], v6, s[84:87], s29 offen offset:0 sc1
    buffer_load_dwordx4 v[92:95], v6, s[84:87], s29 offen offset:64 sc1
    buffer_load_dwordx4 v[96:99], v6, s[84:87], s29 offen offset:128 sc1
    buffer_load_dwordx4 v[100:103], v6, s[84:87], s29 offen offset:192 sc1
    buffer_load_dwordx2 v[104:105], v7, s[84:87], s29 offen offset:0 sc1
    buffer_load_dwordx2 v[106:107], v7, s[84:87], s29 offen offset:512 sc1
    v_mov_b32 v129, 0
    v_mov_b32 v109, 0
    v_mov_b32 v111, 0
    s_waitcnt vmcnt(5)
    v_mfma_f32_16x16x32_bf16 v[120:123], v[88:91], v[24:27], 0
    s_waitcnt vmcnt(4)
    v_mfma_f32_16x16x32_bf16 v[120:123], v[92:95], v[28:31], v[120:123]
    s_waitcnt vmcnt(3)
    v_mfma_f32_16x16x32_bf16 v[120:123], v[96:99], v[32:35], v[120:123]
    s_waitcnt vmcnt(2)
    v_mfma_f32_16x16x32_bf16 v[120:123], v[100:103], v[36:39], v[120:123]
    v_max3_f32 v4, v112, v113, v114
    v_max3_f32 v4, v4, v115, v116
    v_max3_f32 v4, v4, v117, v118
    s_waitcnt vmcnt(0)
    v_mov_b32 v108, v105
    v_mov_b32 v110, v107
    s_nop 1
    v_max3_f32 v4, v4, v119, v120
    v_max_f32 v3, v4, v121
    v_max_f32 v4, v4, v121
    s_nop 1
    v_permlane16_swap_b32 v4, v3
    v_max_f32 v4, v4, v3
    v_max_f32 v3, v4, v3
    s_nop 1
    v_permlane32_swap_b32 v4, v3
    v_max_f32 v4, v4, v3
    v_mul_f32 v4, s24, v4
    v_fma_f32 v112, v112, s24, -v4
    v_fma_f32 v113, v113, s24, -v4
    v_fma_f32 v114, v114, s24, -v4
    v_fma_f32 v115, v115, s24, -v4
    v_fma_f32 v116, v116, s24, -v4
    v_fma_f32 v117, v117, s24, -v4
    v_fma_f32 v118, v118, s24, -v4
    v_fma_f32 v119, v119, s24, -v4
    v_fma_f32 v120, v120, s24, -v4
    v_fma_f32 v121, v121, s24, -v4
    v_exp_f32 v112, v112
    v_exp_f32 v113, v113
    v_exp_f32 v114, v114
    v_exp_f32 v115, v115
    v_exp_f32 v116, v116
    v_exp_f32 v117, v117
    v_exp_f32 v118, v118
    v_exp_f32 v119, v119
    v_exp_f32 v120, v120
    v_exp_f32 v121, v121
    s_nop 0
    v_cvt_pk_bf16_f32 v124, v112, v113
    v_cvt_pk_bf16_f32 v125, v114, v115
    v_cvt_pk_bf16_f32 v126, v116, v117
    v_cvt_pk_bf16_f32 v127, v118, v119
    v_cvt_pk_bf16_f32 v128, v120, v121
    s_nop 1
    v_mfma_f32_16x16x32_bf16 v[132:135], v[20:23], v[124:127], 0
    v_mfma_f32_16x16x32_bf16 v[88:91], v[72:75], v[124:127], 0
    v_mfma_f32_16x16x32_bf16 v[92:95], v[76:79], v[124:127], 0
    v_mfma_f32_16x16x32_bf16 v[96:99], v[80:83], v[124:127], 0
    v_mfma_f32_16x16x32_bf16 v[100:103], v[84:87], v[124:127], 0
    s_nop 1
    v_mfma_f32_16x16x16_bf16 v[132:135], v[20:21], v[128:129], v[132:135]
    v_mfma_f32_16x16x16_bf16 v[88:91], v[104:105], v[128:129], v[88:91]
    v_mfma_f32_16x16x16_bf16 v[92:95], v[108:109], v[128:129], v[92:95]
    v_mfma_f32_16x16x16_bf16 v[96:99], v[106:107], v[128:129], v[96:99]
    v_mfma_f32_16x16x16_bf16 v[100:103], v[110:111], v[128:129], v[100:103]
    s_nop 3
    v_rcp_f32 v132, v132
    s_nop 2
    v_pk_mul_f32 v[88:89], v[88:89], v[132:133] op_sel_hi:[1,0]
    v_pk_mul_f32 v[90:91], v[90:91], v[132:133] op_sel_hi:[1,0]
    v_pk_mul_f32 v[92:93], v[92:93], v[132:133] op_sel_hi:[1,0]
    v_pk_mul_f32 v[94:95], v[94:95], v[132:133] op_sel_hi:[1,0]
    v_pk_mul_f32 v[96:97], v[96:97], v[132:133] op_sel_hi:[1,0]
    v_pk_mul_f32 v[98:99], v[98:99], v[132:133] op_sel_hi:[1,0]
    v_pk_mul_f32 v[100:101], v[100:101], v[132:133] op_sel_hi:[1,0]
    v_pk_mul_f32 v[102:103], v[102:103], v[132:133] op_sel_hi:[1,0]
    v_cvt_pk_bf16_f32 v112, v88, v89
    v_cvt_pk_bf16_f32 v113, v90, v91
    v_cvt_pk_bf16_f32 v114, v92, v93
    v_cvt_pk_bf16_f32 v115, v94, v95
    v_cvt_pk_bf16_f32 v116, v96, v97
    v_cvt_pk_bf16_f32 v117, v98, v99
    v_cvt_pk_bf16_f32 v118, v100, v101
    v_cvt_pk_bf16_f32 v119, v102, v103
    buffer_store_dwordx4 v[112:115], v8, s[84:87], s40 offen sc1
    buffer_store_dwordx4 v[116:119], v8, s[84:87], s40 offen offset:2048 sc1
    s_add_u32 s43, s22, 1
    v_mov_b32 v4, s43
    s_waitcnt vmcnt(0)
    s_barrier
    buffer_store_dword v4, v15, s[84:87], 0 offen sc1
mega_kernel_x_xp:
    buffer_load_dword v3, v14, s[84:87], 0 offen sc1
    s_waitcnt vmcnt(0)
    v_cmp_ge_u32 vcc, s22, v3
    s_cbranch_vccnz mega_kernel_x_xp
    s_add_u32 s20, s41, 0
    buffer_load_dwordx4 v[136:139], v2, s[84:87], s20 offen offset:0
    buffer_load_dwordx4 v[140:143], v2, s[84:87], s20 offen offset:1024
    buffer_load_dwordx4 v[144:147], v2, s[84:87], s20 offen offset:2048
    buffer_load_dwordx4 v[148:151], v2, s[84:87], s20 offen offset:3072
    s_add_u32 s20, s41, 4096
    buffer_load_dwordx4 v[152:155], v2, s[84:87], s20 offen offset:0
    buffer_load_dwordx4 v[156:159], v2, s[84:87], s20 offen offset:1024
    buffer_load_dwordx4 v[160:163], v2, s[84:87], s20 offen offset:2048
    buffer_load_dwordx4 v[164:167], v2, s[84:87], s20 offen offset:3072
    s_add_u32 s20, s41, 8192
    buffer_load_dwordx4 v[168:171], v2, s[84:87], s20 offen offset:0
    buffer_load_dwordx4 v[172:175], v2, s[84:87], s20 offen offset:1024
    buffer_load_dwordx4 v[176:179], v2, s[84:87], s20 offen offset:2048
    buffer_load_dwordx4 v[180:183], v2, s[84:87], s20 offen offset:3072
    s_add_u32 s20, s41, 12288
    buffer_load_dwordx4 v[184:187], v2, s[84:87], s20 offen offset:0
    buffer_load_dwordx4 v[188:191], v2, s[84:87], s20 offen offset:1024
    buffer_load_dwordx4 v[192:195], v2, s[84:87], s20 offen offset:2048
    buffer_load_dwordx4 v[196:199], v2, s[84:87], s20 offen offset:3072
    s_add_u32 s20, s41, 16384
    buffer_load_dwordx4 v[200:203], v2, s[84:87], s20 offen offset:0
    buffer_load_dwordx4 v[204:207], v2, s[84:87], s20 offen offset:1024
    buffer_load_dwordx4 v[208:211], v2, s[84:87], s20 offen offset:2048
    buffer_load_dwordx4 v[212:215], v2, s[84:87], s20 offen offset:3072
    s_add_u32 s20, s41, 20480
    buffer_load_dwordx4 v[216:219], v2, s[84:87], s20 offen offset:0
    buffer_load_dwordx4 v[220:223], v2, s[84:87], s20 offen offset:1024
    buffer_load_dwordx4 v[224:227], v2, s[84:87], s20 offen offset:2048
    buffer_load_dwordx4 v[228:231], v2, s[84:87], s20 offen offset:3072
    s_add_u32 s20, s41, 24576
    buffer_load_dwordx4 v[232:235], v2, s[84:87], s20 offen offset:0
    buffer_load_dwordx4 v[236:239], v2, s[84:87], s20 offen offset:1024
    buffer_load_dwordx4 v[240:243], v2, s[84:87], s20 offen offset:2048
    buffer_load_dwordx4 v[244:247], v2, s[84:87], s20 offen offset:3072
    s_waitcnt vmcnt(27)
    v_mfma_f32_32x32x16_bf16 v[88:103], a[0:3], v[136:139], 0
    s_add_u32 s20, s41, 28672
    buffer_load_dwordx4 v[248:251], v2, s[84:87], s20 offen offset:0
    s_waitcnt vmcnt(27)
    v_mfma_f32_32x32x16_bf16 v[88:103], a[4:7], v[140:143], v[88:103]
    buffer_load_dwordx4 v[252:255], v2, s[84:87], s20 offen offset:1024
    s_waitcnt vmcnt(27)
    v_mfma_f32_32x32x16_bf16 v[88:103], a[8:11], v[144:147], v[88:103]
    buffer_load_dwordx4 v[136:139], v2, s[84:87], s20 offen offset:2048
    s_waitcnt vmcnt(27)
    v_mfma_f32_32x32x16_bf16 v[88:103], a[12:15], v[148:151], v[88:103]
    buffer_load_dwordx4 v[140:143], v2, s[84:87], s20 offen offset:3072
    s_waitcnt vmcnt(27)
    v_mfma_f32_32x32x16_bf16 v[88:103], a[16:19], v[152:155], v[88:103]
    s_add_u32 s20, s41, 32768
    buffer_load_dwordx4 v[144:147], v2, s[84:87], s20 offen offset:0
    s_waitcnt vmcnt(27)
    v_mfma_f32_32x32x16_bf16 v[88:103], a[20:23], v[156:159], v[88:103]
    buffer_load_dwordx4 v[148:151], v2, s[84:87], s20 offen offset:1024
    s_waitcnt vmcnt(27)
    v_mfma_f32_32x32x16_bf16 v[88:103], a[24:27], v[160:163], v[88:103]
    buffer_load_dwordx4 v[152:155], v2, s[84:87], s20 offen offset:2048
    s_waitcnt vmcnt(27)
    v_mfma_f32_32x32x16_bf16 v[88:103], a[28:31], v[164:167], v[88:103]
    buffer_load_dwordx4 v[156:159], v2, s[84:87], s20 offen offset:3072
    s_waitcnt vmcnt(27)
    v_mfma_f32_32x32x16_bf16 v[88:103], a[32:35], v[168:171], v[88:103]
    s_add_u32 s20, s41, 36864
    buffer_load_dwordx4 v[160:163], v2, s[84:87], s20 offen offset:0
    s_waitcnt vmcnt(27)
    v_mfma_f32_32x32x16_bf16 v[88:103], a[36:39], v[172:175], v[88:103]
    buffer_load_dwordx4 v[164:167], v2, s[84:87], s20 offen offset:1024
    s_waitcnt vmcnt(27)
    v_mfma_f32_32x32x16_bf16 v[88:103], a[40:43], v[176:179], v[88:103]
    buffer_load_dwordx4 v[168:171], v2, s[84:87], s20 offen offset:2048
    s_waitcnt vmcnt(27)
    v_mfma_f32_32x32x16_bf16 v[88:103], a[44:47], v[180:183], v[88:103]
    buffer_load_dwordx4 v[172:175], v2, s[84:87], s20 offen offset:3072
    s_waitcnt vmcnt(27)
    v_mfma_f32_32x32x16_bf16 v[88:103], a[48:51], v[184:187], v[88:103]
    s_add_u32 s20, s41, 40960
    buffer_load_dwordx4 v[176:179], v2, s[84:87], s20 offen offset:0
    s_waitcnt vmcnt(27)
    v_mfma_f32_32x32x16_bf16 v[88:103], a[52:55], v[188:191], v[88:103]
    buffer_load_dwordx4 v[180:183], v2, s[84:87], s20 offen offset:1024
    s_waitcnt vmcnt(27)
    v_mfma_f32_32x32x16_bf16 v[88:103], a[56:59], v[192:195], v[88:103]
    buffer_load_dwordx4 v[184:187], v2, s[84:87], s20 offen offset:2048
    s_waitcnt vmcnt(27)
    v_mfma_f32_32x32x16_bf16 v[88:103], a[60:63], v[196:199], v[88:103]
    buffer_load_dwordx4 v[188:191], v2, s[84:87], s20 offen offset:3072
    s_waitcnt vmcnt(27)
    v_mfma_f32_32x32x16_bf16 v[88:103], a[64:67], v[200:203], v[88:103]
    s_add_u32 s20, s41, 45056
    buffer_load_dwordx4 v[192:195], v2, s[84:87], s20 offen offset:0
    s_waitcnt vmcnt(27)
    v_mfma_f32_32x32x16_bf16 v[88:103], a[68:71], v[204:207], v[88:103]
    buffer_load_dwordx4 v[196:199], v2, s[84:87], s20 offen offset:1024
    s_waitcnt vmcnt(27)
    v_mfma_f32_32x32x16_bf16 v[88:103], a[72:75], v[208:211], v[88:103]
    buffer_load_dwordx4 v[200:203], v2, s[84:87], s20 offen offset:2048
    s_waitcnt vmcnt(27)
    v_mfma_f32_32x32x16_bf16 v[88:103], a[76:79], v[212:215], v[88:103]
    buffer_load_dwordx4 v[204:207], v2, s[84:87], s20 offen offset:3072
    s_waitcnt vmcnt(27)
    v_mfma_f32_32x32x16_bf16 v[88:103], a[80:83], v[216:219], v[88:103]
    s_add_u32 s20, s41, 49152
    buffer_load_dwordx4 v[208:211], v2, s[84:87], s20 offen offset:0
    s_waitcnt vmcnt(27)
    v_mfma_f32_32x32x16_bf16 v[88:103], a[84:87], v[220:223], v[88:103]
    buffer_load_dwordx4 v[212:215], v2, s[84:87], s20 offen offset:1024
    s_waitcnt vmcnt(27)
    v_mfma_f32_32x32x16_bf16 v[88:103], a[88:91], v[224:227], v[88:103]
    buffer_load_dwordx4 v[216:219], v2, s[84:87], s20 offen offset:2048
    s_waitcnt vmcnt(27)
    v_mfma_f32_32x32x16_bf16 v[88:103], a[92:95], v[228:231], v[88:103]
    buffer_load_dwordx4 v[220:223], v2, s[84:87], s20 offen offset:3072
    s_waitcnt vmcnt(27)
    v_mfma_f32_32x32x16_bf16 v[88:103], a[96:99], v[232:235], v[88:103]
    s_add_u32 s20, s41, 53248
    buffer_load_dwordx4 v[224:227], v2, s[84:87], s20 offen offset:0
    s_waitcnt vmcnt(27)
    v_mfma_f32_32x32x16_bf16 v[88:103], a[100:103], v[236:239], v[88:103]
    buffer_load_dwordx4 v[228:231], v2, s[84:87], s20 offen offset:1024
    s_waitcnt vmcnt(27)
    v_mfma_f32_32x32x16_bf16 v[88:103], a[104:107], v[240:243], v[88:103]
    buffer_load_dwordx4 v[232:235], v2, s[84:87], s20 offen offset:2048
    s_waitcnt vmcnt(27)
    v_mfma_f32_32x32x16_bf16 v[88:103], a[108:111], v[244:247], v[88:103]
    buffer_load_dwordx4 v[236:239], v2, s[84:87], s20 offen offset:3072
    s_waitcnt vmcnt(27)
    v_mfma_f32_32x32x16_bf16 v[88:103], a[112:115], v[248:251], v[88:103]
    s_add_u32 s20, s41, 57344
    buffer_load_dwordx4 v[240:243], v2, s[84:87], s20 offen offset:0
    s_waitcnt vmcnt(27)
    v_mfma_f32_32x32x16_bf16 v[88:103], a[116:119], v[252:255], v[88:103]
    buffer_load_dwordx4 v[244:247], v2, s[84:87], s20 offen offset:1024
    s_waitcnt vmcnt(27)
    v_mfma_f32_32x32x16_bf16 v[88:103], a[120:123], v[136:139], v[88:103]
    buffer_load_dwordx4 v[248:251], v2, s[84:87], s20 offen offset:2048
    s_waitcnt vmcnt(27)
    v_mfma_f32_32x32x16_bf16 v[88:103], a[124:127], v[140:143], v[88:103]
    buffer_load_dwordx4 v[252:255], v2, s[84:87], s20 offen offset:3072
    s_waitcnt vmcnt(27)
    v_mfma_f32_32x32x16_bf16 v[88:103], a[128:131], v[144:147], v[88:103]
    s_add_u32 s20, s41, 61440
    buffer_load_dwordx4 v[136:139], v2, s[84:87], s20 offen offset:0
    s_waitcnt vmcnt(27)
    v_mfma_f32_32x32x16_bf16 v[88:103], a[132:135], v[148:151], v[88:103]
    buffer_load_dwordx4 v[140:143], v2, s[84:87], s20 offen offset:1024
    s_waitcnt vmcnt(27)
    v_mfma_f32_32x32x16_bf16 v[88:103], a[136:139], v[152:155], v[88:103]
    buffer_load_dwordx4 v[144:147], v2, s[84:87], s20 offen offset:2048
    s_waitcnt vmcnt(27)
    v_mfma_f32_32x32x16_bf16 v[88:103], a[140:143], v[156:159], v[88:103]
    buffer_load_dwordx4 v[148:151], v2, s[84:87], s20 offen offset:3072
    s_waitcnt vmcnt(27)
    v_mfma_f32_32x32x16_bf16 v[88:103], a[144:147], v[160:163], v[88:103]
    s_waitcnt vmcnt(26)
    v_mfma_f32_32x32x16_bf16 v[88:103], a[148:151], v[164:167], v[88:103]
    s_waitcnt vmcnt(25)
    v_mfma_f32_32x32x16_bf16 v[88:103], a[152:155], v[168:171], v[88:103]
    s_waitcnt vmcnt(24)
    v_mfma_f32_32x32x16_bf16 v[88:103], a[156:159], v[172:175], v[88:103]
    s_waitcnt vmcnt(23)
    v_mfma_f32_32x32x16_bf16 v[88:103], a[160:163], v[176:179], v[88:103]
    s_waitcnt vmcnt(22)
    v_mfma_f32_32x32x16_bf16 v[88:103], a[164:167], v[180:183], v[88:103]
    s_waitcnt vmcnt(21)
    v_mfma_f32_32x32x16_bf16 v[88:103], a[168:171], v[184:187], v[88:103]
    s_waitcnt vmcnt(20)
    v_mfma_f32_32x32x16_bf16 v[88:103], a[172:175], v[188:191], v[88:103]
    s_waitcnt vmcnt(19)
    v_mfma_f32_32x32x16_bf16 v[88:103], a[176:179], v[192:195], v[88:103]
    s_waitcnt vmcnt(18)
    v_mfma_f32_32x32x16_bf16 v[88:103], a[180:183], v[196:199], v[88:103]
    s_waitcnt vmcnt(17)
    v_mfma_f32_32x32x16_bf16 v[88:103], a[184:187], v[200:203], v[88:103]
    s_waitcnt vmcnt(16)
    v_mfma_f32_32x32x16_bf16 v[88:103], a[188:191], v[204:207], v[88:103]
    s_waitcnt vmcnt(15)
    v_mfma_f32_32x32x16_bf16 v[88:103], a[192:195], v[208:211], v[88:103]
    s_waitcnt vmcnt(14)
    v_mfma_f32_32x32x16_bf16 v[88:103], a[196:199], v[212:215], v[88:103]
    s_waitcnt vmcnt(13)
    v_mfma_f32_32x32x16_bf16 v[88:103], a[200:203], v[216:219], v[88:103]
    s_waitcnt vmcnt(12)
    v_mfma_f32_32x32x16_bf16 v[88:103], a[204:207], v[220:223], v[88:103]
    s_waitcnt vmcnt(11)
    v_mfma_f32_32x32x16_bf16 v[88:103], a[208:211], v[224:227], v[88:103]
    s_waitcnt vmcnt(10)
    v_mfma_f32_32x32x16_bf16 v[88:103], a[212:215], v[228:231], v[88:103]
    s_waitcnt vmcnt(9)
    v_mfma_f32_32x32x16_bf16 v[88:103], a[216:219], v[232:235], v[88:103]
    s_waitcnt vmcnt(8)
    v_mfma_f32_32x32x16_bf16 v[88:103], a[220:223], v[236:239], v[88:103]
    s_waitcnt vmcnt(7)
    v_mfma_f32_32x32x16_bf16 v[88:103], a[224:227], v[240:243], v[88:103]
    s_waitcnt vmcnt(6)
    v_mfma_f32_32x32x16_bf16 v[88:103], a[228:231], v[244:247], v[88:103]
    s_waitcnt vmcnt(5)
    v_mfma_f32_32x32x16_bf16 v[88:103], a[232:235], v[248:251], v[88:103]
    s_waitcnt vmcnt(4)
    v_mfma_f32_32x32x16_bf16 v[88:103], a[236:239], v[252:255], v[88:103]
    s_waitcnt vmcnt(3)
    v_mfma_f32_32x32x16_bf16 v[88:103], a[240:243], v[136:139], v[88:103]
    s_waitcnt vmcnt(2)
    v_mfma_f32_32x32x16_bf16 v[88:103], a[244:247], v[140:143], v[88:103]
    s_waitcnt vmcnt(1)
    v_mfma_f32_32x32x16_bf16 v[88:103], a[248:251], v[144:147], v[88:103]
    s_waitcnt vmcnt(0)
    v_mfma_f32_32x32x16_bf16 v[88:103], a[252:255], v[148:151], v[88:103]
    s_add_u32 s20, s22, 2
    s_add_u32 s21, s17, 12
    s_cmp_lt_u32 s20, 12
    s_cselect_b32 s20, s20, s21
    s_add_u32 s21, s22, 6
    s_cmp_lt_u32 s22, 12
    s_cselect_b32 s22, s20, s21
    s_nop 5
    ds_write_b128 v17, v[88:91] offset:0
    ds_write_b128 v17, v[92:95] offset:1024
    ds_write_b128 v17, v[96:99] offset:2048
    ds_write_b128 v17, v[100:103] offset:3072
    s_waitcnt lgkmcnt(0)
    s_barrier
    ds_read_b128 v[88:91], v16 offset:0
    ds_read_b128 v[92:95], v16 offset:4096
    ds_read_b128 v[96:99], v16 offset:8192
    ds_read_b128 v[100:103], v16 offset:12288
    s_waitcnt lgkmcnt(0)
    v_pk_add_f32 v[88:89], v[88:89], v[92:93]
    v_pk_add_f32 v[90:91], v[90:91], v[94:95]
    v_pk_add_f32 v[96:97], v[96:97], v[100:101]
    v_pk_add_f32 v[98:99], v[98:99], v[102:103]
    v_pk_add_f32 v[88:89], v[88:89], v[96:97]
    v_pk_add_f32 v[90:91], v[90:91], v[98:99]
    v_cvt_pk_bf16_f32 v112, v88, v89
    v_cvt_pk_bf16_f32 v113, v90, v91
    buffer_store_dwordx2 v[112:113], v18, s[12:15], s42 offen
    s_cmp_ge_u32 s22, 64
    s_cbranch_scc1 mega_kernel_x_done
    s_and_b32 s20, s22, 1
    s_lshl_b32 s20, s20, 7
    s_lshr_b32 s43, s22, 1
mega_kernel_x_gpb:
    buffer_load_dword v3, v12, s[84:87], s20 offen sc1
    s_waitcnt vmcnt(0)
    v_cmp_ge_u32 vcc, s43, v3
    s_cbranch_vccz mega_kernel_x_gkb
    s_sleep 8
    s_branch mega_kernel_x_gpb
mega_kernel_x_gkb:
    s_lshl_b32 s27, s22, 18
    s_lshl_b32 s20, s18, 13
    s_add_u32 s27, s27, s20
    s_and_b32 s20, s16, 1
    s_lshl_b32 s20, s20, 10
    s_add_u32 s26, s27, s20
    s_lshr_b32 s20, s16, 1
    s_lshl_b32 s20, s20, 12
    s_add_u32 s28, s27, s20
    s_add_u32 s28, s28, 33554432
    s_add_u32 s27, s27, 16777216
    s_add_u32 s20, s26, 4096
    s_add_u32 s21, s27, 4096
    buffer_load_dwordx4 v[24:27], v2, s[84:87], s26 offen offset:0
    buffer_load_dwordx4 v[28:31], v2, s[84:87], s26 offen offset:2048
    buffer_load_dwordx4 v[32:35], v2, s[84:87], s20 offen offset:0
    buffer_load_dwordx4 v[36:39], v2, s[84:87], s20 offen offset:2048
    buffer_load_dwordx4 v[40:43], v2, s[84:87], s27 offen offset:0
    buffer_load_dwordx4 v[44:47], v2, s[84:87], s27 offen offset:1024
    buffer_load_dwordx4 v[48:51], v2, s[84:87], s27 offen offset:2048
    buffer_load_dwordx4 v[52:55], v2, s[84:87], s27 offen offset:3072
    buffer_load_dwordx4 v[56:59], v2, s[84:87], s21 offen offset:0
    buffer_load_dwordx4 v[60:63], v2, s[84:87], s21 offen offset:1024
    buffer_load_dwordx4 v[64:67], v2, s[84:87], s21 offen offset:2048
    buffer_load_dwordx4 v[68:71], v2, s[84:87], s21 offen offset:3072
    buffer_load_dwordx4 v[72:75], v2, s[84:87], s28 offen offset:0
    buffer_load_dwordx4 v[76:79], v2, s[84:87], s28 offen offset:1024
    buffer_load_dwordx4 v[80:83], v2, s[84:87], s28 offen offset:2048
    buffer_load_dwordx4 v[84:87], v2, s[84:87], s28 offen offset:3072
    s_branch mega_kernel_x_loop
mega_kernel_x_done:
    s_endpgm
.section .rodata,"a"
.p2align 6
.amdhsa_kernel mega_kernel
  .amdhsa_next_free_vgpr 512
  .amdhsa_next_free_sgpr 102
  .amdhsa_accum_offset 256
  .amdhsa_group_segment_fixed_size 0
  .amdhsa_kernarg_size 104
  .amdhsa_user_sgpr_count 2
  .amdhsa_user_sgpr_kernarg_segment_ptr 1
  .amdhsa_system_sgpr_workgroup_id_x 1
.end_amdhsa_kernel
```

```asm
; @launch kernel=mega_kernel grid=(256,1,1) block=(256,1,1) lds=161792
.amdgcn_target "amdgcn-amd-amdhsa--gfx950"
.text
.globl mega_kernel
.p2align 8
.type mega_kernel,@function
mega_kernel:
    s_cmp_ge_u32 s2, 256
    s_cbranch_scc1 mega_kernel_exit
    s_load_dwordx2 s[84:85], s[0:1], 96
    s_load_dwordx2 s[88:89], s[0:1], 88
    s_getreg_b32 s93, hwreg(HW_REG_XCC_ID)
    s_and_b32 s93, s93, 7
    v_lshrrev_b32 v1, 6, v0
    v_mov_b32 v4, 0
    v_readfirstlane_b32 s80, v1
    v_mov_b32 v5, 0
    v_mov_b32 v6, 0
    v_mov_b32 v7, 0
    s_mov_b32 s83, 0
    s_lshl_b32 s101, s2, 2
    s_add_u32 s101, s101, s80
    s_lshl_b32 s101, s101, 8
    s_add_u32 s101, s101, 230686720
    s_waitcnt lgkmcnt(0)
    s_mov_b32 s86, 268435456
    s_mov_b32 s87, 0x00020000
    s_mov_b32 s90, 256
    s_mov_b32 s91, 0x00020000
    s_mov_b32 s98, s80
    s_cmp_lg_u32 s80, 0
    s_cbranch_scc1 mega_kernel_st0
    v_mov_b32 v10, 1
    s_lshl_b32 s81, s93, 5
    s_mov_b64 exec, 1
    buffer_atomic_add v10, off, s[88:91], s81 offset:4 sc0
    s_lshl_b32 s81, s2, 7
    s_add_u32 s81, s81, 71303168
    s_mov_b64 exec, 3
    v_lshlrev_b32 v1, 15, v0
    buffer_store_dword v4, v1, s[84:87], s81 offen sc1
    s_mov_b64 exec, -1
mega_kernel_st0:
    s_load_dwordx2 s[72:73], s[0:1], 8
    v_mov_b32 v4, 0
    v_mov_b32 v5, 0
    v_mov_b32 v6, 0
    v_mov_b32 v7, 0
    v_lshlrev_b32 v1, 4, v0
    s_lshl_b32 s81, s2, 13
    s_add_u32 s81, s81, 67108864
    s_add_u32 s79, s81, 4096
    buffer_store_dwordx4 v[4:7], v1, s[84:87], s81 offen sc1
    buffer_store_dwordx4 v[4:7], v1, s[84:87], s79 offen sc1
    v_lshlrev_b32 v1, 3, v0
    s_lshl_b32 s81, s2, 11
    s_add_u32 s81, s81, 70254592
    buffer_store_dwordx2 v[4:5], v1, s[84:87], s81 offen sc1
    s_cmp_ge_u32 s2, 64
    s_cbranch_scc1 mega_kernel_gi
    v_bfe_u32 v2, v0, 3, 1
    v_lshlrev_b32 v2, 11, v2
    v_and_b32 v3, 3, v0
    v_lshl_add_u32 v2, v3, 5, v2
    v_bfe_u32 v3, v0, 4, 3
    v_lshl_add_u32 v2, v3, 2, v2
    v_bfe_u32 v3, v0, 2, 1
    v_lshl_add_u32 v2, v3, 1, v2
    s_lshr_b32 s81, s2, 2
    s_lshl_b32 s81, s81, 7
    s_and_b32 s79, s2, 3
    s_lshl_b32 s79, s79, 12
    s_add_u32 s81, s81, s79
    s_waitcnt lgkmcnt(0)
    s_mov_b32 s74, 16384
    s_mov_b32 s75, 0x00020000
    buffer_load_ushort v8, v2, s[72:75], s81 offen
    v_mov_b32 v9, -1
    v_and_b32 v1, 127, v0
    v_lshlrev_b32 v1, 1, v1
    v_lshrrev_b32 v3, 7, v0
    v_lshl_add_u32 v1, v3, 14, v1
    v_cmp_gt_u32 vcc, 128, v0
    s_lshl_b32 s81, s2, 8
    s_add_u32 s81, s81, 69206016
    s_waitcnt vmcnt(0)
    v_min_u32 v8, 0xfffe, v8
    v_cndmask_b32 v8, v9, v8, vcc
    buffer_store_short v8, v1, s[84:87], s81 offen sc1
mega_kernel_gi:
    s_waitcnt lgkmcnt(0)
    s_cmp_lg_u32 s80, 0
    s_cbranch_scc1 mega_kernel_st1
    s_mov_b64 exec, 1
    s_waitcnt vmcnt(4)
    ds_write_b32 v4, v10
    s_mov_b64 exec, -1
    s_waitcnt lgkmcnt(0)
mega_kernel_st1:
    s_barrier
    ds_read_b32 v2, v4
    s_waitcnt lgkmcnt(0)
    v_readfirstlane_b32 s94, v2
    s_barrier
    s_sub_u32 s81, s93, 2
    s_cmp_ge_u32 s81, 2
    s_cbranch_scc1 mega_kernel_nopr
    s_cmp_lg_u32 s80, 0
    s_cbranch_scc1 mega_kernel_prd
    v_lshlrev_b32 v1, 4, v0
    s_and_b32 s81, s2, 127
    s_lshl_b32 s81, s81, 14
    s_add_u32 s81, s81, 67108864
    s_add_u32 s77, s81, 8192
    buffer_store_dwordx4 v[4:7], v1, s[84:87], s81 offen sc1
    buffer_store_dwordx4 v[4:7], v1, s[84:87], s77 offen sc1
    s_waitcnt vmcnt(0)
    s_memtime s[70:71]
    buffer_store_dwordx4 v[4:7], v1, s[84:87], s81 offen sc1
    s_waitcnt vmcnt(0)
    s_memtime s[72:73]
    buffer_store_dwordx4 v[4:7], v1, s[84:87], s77 offen sc1
    s_waitcnt vmcnt(0)
    buffer_store_dwordx4 v[4:7], v1, s[84:87], s77 offen sc1
    s_waitcnt vmcnt(0)
    s_memtime s[74:75]
    buffer_store_dwordx4 v[4:7], v1, s[84:87], s81 offen sc1
    s_waitcnt vmcnt(0)
    s_memtime s[76:77]
    s_waitcnt lgkmcnt(0)
    s_sub_u32 s76, s76, s74
    s_sub_u32 s74, s74, s72
    s_sub_u32 s72, s72, s70
    s_add_u32 s72, s72, s76
    s_cmp_lt_u32 s74, s72
    s_cselect_b32 s81, 0x10001, 1
    v_mov_b32 v8, s81
    s_mov_b64 exec, 1
    buffer_atomic_add v8, off, s[88:91], 0 offset:204 sc1
    s_mov_b64 exec, -1
mega_kernel_prd:
    s_barrier
mega_kernel_nopr:
    s_mov_b32 s97, 0
    s_mov_b32 s100, 64
mega_kernel_fast:
    s_mov_b32 s96, 1
    s_mov_b32 s30, s93
    s_and_b32 s31, s94, 31
    s_cmp_lt_u32 s93, 2
    s_cbranch_scc1 mega_kernel_recf
    s_sub_u32 s92, s93, 2
    s_lshl_b32 s92, s92, 5
    s_add_u32 s92, s92, s31
    s_branch mega_kernel_bulk
mega_kernel_redo:
    s_waitcnt vmcnt(0) lgkmcnt(0)
    s_barrier
    v_readlane_b32 s100, v252, 2
    v_readlane_b32 s81, v252, 3
    s_mov_b32 s97, 1
    s_nop 2
    s_add_u32 s100, s100, s81
    s_mov_b32 s95, s94
    v_readlane_b32 s81, v252, 0
    s_cmp_gt_u32 s93, 0
    s_nop 2
    s_cselect_b32 s81, s81, 0
    s_add_u32 s95, s95, s81
    v_readlane_b32 s81, v252, 1
    s_cmp_gt_u32 s93, 1
    s_nop 2
    s_cselect_b32 s81, s81, 0
    s_add_u32 s95, s95, s81
    v_readlane_b32 s81, v252, 2
    s_cmp_gt_u32 s93, 2
    s_nop 2
    s_cselect_b32 s81, s81, 0
    s_add_u32 s95, s95, s81
    v_readlane_b32 s81, v252, 3
    s_cmp_gt_u32 s93, 3
    s_nop 2
    s_cselect_b32 s81, s81, 0
    s_add_u32 s95, s95, s81
    v_readlane_b32 s81, v252, 4
    s_cmp_gt_u32 s93, 4
    s_nop 2
    s_cselect_b32 s81, s81, 0
    s_add_u32 s95, s95, s81
    v_readlane_b32 s81, v252, 5
    s_cmp_gt_u32 s93, 5
    s_nop 2
    s_cselect_b32 s81, s81, 0
    s_add_u32 s95, s95, s81
    v_readlane_b32 s81, v252, 6
    s_cmp_gt_u32 s93, 6
    s_nop 2
    s_cselect_b32 s81, s81, 0
    s_add_u32 s95, s95, s81
mega_kernel_slow:
    s_mov_b32 s96, 0
    s_lshr_b32 s30, s95, 5
    s_and_b32 s31, s95, 31
    s_cmp_lt_u32 s95, 64
    s_cbranch_scc1 mega_kernel_recs
    s_sub_u32 s92, s95, 64
    s_branch mega_kernel_bulk
mega_kernel_exit:
    s_endpgm
mega_kernel_recf:
    s_load_dwordx2 s[4:5], s[0:1], 96
    s_load_dwordx2 s[12:13], s[0:1], 88
    s_load_dwordx2 s[50:51], s[0:1], 16
    s_load_dwordx2 s[52:53], s[0:1], 24
    s_load_dwordx2 s[54:55], s[0:1], 32
    s_load_dwordx2 s[56:57], s[0:1], 40
    s_load_dwordx2 s[58:59], s[0:1], 8
    v_lshrrev_b32 v3, 6, v0
    v_and_b32 v40, 63, v0
    v_readfirstlane_b32 s20, v3
    v_lshrrev_b32 v41, 4, v40
    v_and_b32 v42, 15, v40
    v_lshlrev_b32 v1, 4, v40
    s_mov_b32 s49, 0
    s_waitcnt lgkmcnt(0)
    s_mov_b32 s6, 268435456
    s_mov_b32 s7, 0x00020000
    s_mov_b32 s14, 256
    s_mov_b32 s15, 0x00020000
    s_mov_b32 s10, 8388608
    s_mov_b32 s11, 0x00020000
    s_mov_b32 s26, 0x00030003
    s_mov_b32 s27, 0x00030003
    s_mov_b32 s28, 0xcccccccc
    s_mov_b32 s29, 0xcccccccc
    s_mov_b32 s32, 0x33333333
    s_mov_b32 s33, 0x33333333
    s_mov_b32 s34, 0x3e0293ee
    s_lshl_b32 s22, s20, 2
    v_xor_b32 v3, s22, v42
    v_lshlrev_b32 v3, 4, v3
    v_lshl_add_u32 v4, v41, 4, s20
    v_lshl_add_u32 v44, v4, 13, v3
    s_lshl_b32 s22, s30, 22
    s_lshl_b32 s23, s31, 8
    s_add_u32 s22, s22, s23
    v_add_u32 v44, s22, v44
    s_lshr_b32 s22, s20, 1
    s_lshl_b32 s22, s22, 5
    s_and_b32 s23, s20, 1
    s_lshl_b32 s23, s23, 2
    s_add_u32 s22, s22, s23
    s_lshl_b32 s23, s31, 7
    s_add_u32 s22, s22, s23
    v_add_u32 v4, s22, v41
    v_lshl_add_u32 v45, v4, 11, v3
    s_lshl_b32 s22, s30, 10
    v_add_u32 v45, s22, v45
    s_lshl_b32 s48, s20, 10
    s_mov_b32 s8, s50
    s_mov_b32 s9, s51
    s_add_u32 m0, s48, 0
    s_mov_b32 s22, 0
    buffer_load_dwordx4 v44, s[8:11], s22 offen  lds
    s_add_u32 m0, s48, 4096
    s_mov_b32 s22, 32768
    buffer_load_dwordx4 v44, s[8:11], s22 offen  lds
    s_add_u32 m0, s48, 8192
    s_mov_b32 s22, 65536
    buffer_load_dwordx4 v44, s[8:11], s22 offen  lds
    s_add_u32 m0, s48, 12288
    s_mov_b32 s22, 98304
    buffer_load_dwordx4 v44, s[8:11], s22 offen  lds
    s_add_u32 m0, s48, 16384
    s_mov_b32 s22, 524288
    buffer_load_dwordx4 v44, s[8:11], s22 offen  lds
    s_add_u32 m0, s48, 20480
    s_mov_b32 s22, 557056
    buffer_load_dwordx4 v44, s[8:11], s22 offen  lds
    s_add_u32 m0, s48, 24576
    s_mov_b32 s22, 589824
    buffer_load_dwordx4 v44, s[8:11], s22 offen  lds
    s_add_u32 m0, s48, 28672
    s_mov_b32 s22, 622592
    buffer_load_dwordx4 v44, s[8:11], s22 offen  lds
    s_add_u32 m0, s48, 32768
    s_mov_b32 s22, 1048576
    buffer_load_dwordx4 v44, s[8:11], s22 offen  lds
    s_add_u32 m0, s48, 36864
    s_mov_b32 s22, 1081344
    buffer_load_dwordx4 v44, s[8:11], s22 offen  lds
    s_add_u32 m0, s48, 40960
    s_mov_b32 s22, 1114112
    buffer_load_dwordx4 v44, s[8:11], s22 offen  lds
    s_add_u32 m0, s48, 45056
    s_mov_b32 s22, 1146880
    buffer_load_dwordx4 v44, s[8:11], s22 offen  lds
    s_add_u32 m0, s48, 49152
    s_mov_b32 s22, 1572864
    buffer_load_dwordx4 v44, s[8:11], s22 offen  lds
    s_add_u32 m0, s48, 53248
    s_mov_b32 s22, 1605632
    buffer_load_dwordx4 v44, s[8:11], s22 offen  lds
    s_add_u32 m0, s48, 57344
    s_mov_b32 s22, 1638400
    buffer_load_dwordx4 v44, s[8:11], s22 offen  lds
    s_add_u32 m0, s48, 61440
    s_mov_b32 s22, 1671168
    buffer_load_dwordx4 v44, s[8:11], s22 offen  lds
    s_add_u32 m0, s48, 65536
    s_mov_b32 s22, 2097152
    buffer_load_dwordx4 v44, s[8:11], s22 offen  lds
    s_add_u32 m0, s48, 69632
    s_mov_b32 s22, 2129920
    buffer_load_dwordx4 v44, s[8:11], s22 offen  lds
    s_add_u32 m0, s48, 73728
    s_mov_b32 s22, 2162688
    buffer_load_dwordx4 v44, s[8:11], s22 offen  lds
    s_add_u32 m0, s48, 77824
    s_mov_b32 s22, 2195456
    buffer_load_dwordx4 v44, s[8:11], s22 offen  lds
    s_add_u32 m0, s48, 81920
    s_mov_b32 s22, 2621440
    buffer_load_dwordx4 v44, s[8:11], s22 offen  lds
    s_add_u32 m0, s48, 86016
    s_mov_b32 s22, 2654208
    buffer_load_dwordx4 v44, s[8:11], s22 offen  lds
    s_add_u32 m0, s48, 90112
    s_mov_b32 s22, 2686976
    buffer_load_dwordx4 v44, s[8:11], s22 offen  lds
    s_add_u32 m0, s48, 94208
    s_mov_b32 s22, 2719744
    buffer_load_dwordx4 v44, s[8:11], s22 offen  lds
    s_add_u32 m0, s48, 98304
    s_mov_b32 s22, 3145728
    buffer_load_dwordx4 v44, s[8:11], s22 offen  lds
    s_add_u32 m0, s48, 102400
    s_mov_b32 s22, 3178496
    buffer_load_dwordx4 v44, s[8:11], s22 offen  lds
    s_add_u32 m0, s48, 106496
    s_mov_b32 s22, 3211264
    buffer_load_dwordx4 v44, s[8:11], s22 offen  lds
    s_add_u32 m0, s48, 110592
    s_mov_b32 s22, 3244032
    buffer_load_dwordx4 v44, s[8:11], s22 offen  lds
    s_add_u32 m0, s48, 114688
    s_mov_b32 s22, 3670016
    buffer_load_dwordx4 v44, s[8:11], s22 offen  lds
    s_add_u32 m0, s48, 118784
    s_mov_b32 s22, 3702784
    buffer_load_dwordx4 v44, s[8:11], s22 offen  lds
    s_add_u32 m0, s48, 122880
    s_mov_b32 s22, 3735552
    buffer_load_dwordx4 v44, s[8:11], s22 offen  lds
    s_add_u32 m0, s48, 126976
    s_mov_b32 s22, 3768320
    buffer_load_dwordx4 v44, s[8:11], s22 offen  lds
    s_waitcnt vmcnt(32)
    s_barrier
    s_or_b32 s81, s97, s98
    s_cmp_lg_u32 s81, 0
    s_cbranch_scc1 mega_kernel_h0_1
    s_lshl_b32 s81, s93, 5
    v_mov_b32 v250, 1
    s_mov_b64 exec, 1
    buffer_atomic_add v250, off, s[88:91], s81 sc1
    s_mov_b64 exec, -1
mega_kernel_h0_1:
    s_lshl_b32 s22, s30, 5
    s_add_u32 s22, s22, s31
    s_lshl_b32 s38, s22, 14
    s_xor_b32 s22, s22, 32
    s_lshl_b32 s37, s22, 14
    s_add_u32 s38, s38, 67108864
    s_add_u32 s37, s37, 67108864
    s_lshl_b32 s46, s30, 18
    s_add_u32 s46, s46, 70254592
    s_lshl_b32 s22, s31, 13
    s_add_u32 s47, s46, s22
    s_lshl_b32 s22, s20, 16
    s_add_u32 s46, s46, s22
    s_lshl_b32 s22, s31, 8
    s_add_u32 s46, s46, s22
    s_add_u32 s61, s46, 32768
    s_add_u32 s25, s47, 4096
    s_lshl_b32 s35, s30, 13
    s_add_u32 s35, s35, 69206016
    v_lshrrev_b32 v53, 2, v42
    v_lshlrev_b32 v53, 1, v53
    v_and_b32 v54, 1, v42
    v_add_u32 v55, v53, v54
    v_mov_b32 v14, 0
    v_mov_b32 v15, 0
    v_mov_b32 v2, 0x4444
    v_mov_b32 v3, 0xeeee
    v_cndmask_b32 v2, v2, v3, s[28:29]
    s_lshl_b32 s22, s20, 12
    v_add_u32 v32, s22, v1
    v_add_u32 v33, 0x10000, v32
    v_add_u32 v5, 0x10000, v1
    v_add_u32 v6, 131072, v1
    v_and_b32 v3, 3, v42
    v_bfe_u32 v43, v40, 1, 1
    v_lshlrev_b32 v7, 13, v43
    v_and_b32 v43, 1, v40
    v_lshl_add_u32 v7, v43, 7, v7
    s_lshl_b32 s22, s31, 8
    s_add_u32 s23, s22, 71311360
    v_add_u32 v7, s23, v7
    s_cmp_lg_u32 s20, 0
    s_cbranch_scc1 mega_kernel_rf_flk
    s_lshl_b32 s23, s30, 7
    s_add_u32 s22, s22, s23
    s_add_u32 s22, s22, 71327744
    v_bfrev_b32 v7, 1
    v_writelane_b32 v7, s22, 0
mega_kernel_rf_flk:
    v_lshlrev_b32 v11, 3, v40
    v_lshlrev_b32 v10, 8, v55
    v_lshl_add_u32 v10, v41, 4, v10
    v_lshlrev_b32 v8, 13, v41
    v_lshl_add_u32 v8, v42, 4, v8
    v_lshrrev_b32 v9, 1, v41
    v_lshlrev_b32 v9, 5, v9
    v_and_b32 v4, 1, v42
    v_lshl_add_u32 v9, v4, 4, v9
    v_and_b32 v4, 1, v41
    v_lshl_add_u32 v9, v4, 3, v9
    s_lshl_b32 s22, s31, 8
    v_add_u32 v9, s22, v9
    v_lshrrev_b32 v4, 2, v42
    v_lshlrev_b32 v12, 8, v4
    v_lshl_add_u32 v12, v41, 6, v12
    v_lshl_add_u32 v12, v3, 4, v12
    v_lshlrev_b32 v13, 8, v41
    v_lshl_add_u32 v13, v42, 2, v13
    v_cmp_eq_u32 vcc, 0, v3
    v_mov_b32 v28, 0x3f803f80
    v_mov_b32 v29, 0x3f803f80
    v_cndmask_b32 v34, 0, 1, vcc
    v_mov_b32 v30, 0x3f803f80
    v_mov_b32 v31, 0x3f803f80
    v_and_b32 v49, 1, v42
    v_lshlrev_b32 v49, 4, v49
    v_mov_b32 v50, 0x3f80
    v_lshlrev_b32 v50, v49, v50
    v_lshrrev_b32 v51, 2, v42
    v_cmp_eq_u32 vcc, v51, v41
    v_mov_b32 v24, v50
    v_cndmask_b32 v52, 0, v50, s[28:29]
    v_cndmask_b32 v53, 0, v50, s[32:33]
    v_cndmask_b32 v16, 0, v52, vcc
    v_cndmask_b32 v17, 0, v53, vcc
    v_mov_b32 v25, v50
    v_mov_b32 v26, v50
    v_mov_b32 v27, v50
    v_bfe_u32 v60, v40, 3, 1
    v_bfe_u32 v49, v40, 2, 1
    v_and_b32 v50, 1, v41
    v_lshrrev_b32 v51, 1, v41
    v_lshlrev_b32 v52, 3, v60
    v_lshl_add_u32 v52, v50, 2, v52
    v_lshl_add_u32 v53, v51, 4, v52
    v_add_u32 v53, v53, v49
    v_and_b32 v54, 3, v40
    s_lshl_b32 s22, s20, 2
    v_add_u32 v55, s22, v54
    v_xor_b32 v55, v55, v52
    v_lshlrev_b32 v55, 4, v55
    v_lshl_add_u32 v46, v53, 8, v55
    v_lshlrev_b32 v55, 4, v52
    v_lshl_add_u32 v55, v54, 3, v55
    v_lshl_add_u32 v47, v53, 8, v55
    s_waitcnt vmcnt(28)
    s_barrier
    v_add_u32 v48, 0, v46
    ds_read_b64_tr_b16 a[0:1], v48 offset:0
    ds_read_b64_tr_b16 a[2:3], v48 offset:512
    ds_read_b64_tr_b16 a[4:5], v48 offset:8192
    ds_read_b64_tr_b16 a[6:7], v48 offset:8704
    ds_read_b64_tr_b16 a[8:9], v48 offset:8
    ds_read_b64_tr_b16 a[10:11], v48 offset:520
    ds_read_b64_tr_b16 a[12:13], v48 offset:8200
    ds_read_b64_tr_b16 a[14:15], v48 offset:8712
    s_waitcnt lgkmcnt(0)
    s_barrier
    s_mov_b32 s8, s52
    s_mov_b32 s9, s53
    s_add_u32 m0, s48, 0
    s_mov_b32 s22, 0
    buffer_load_dwordx4 v44, s[8:11], s22 offen  lds
    s_add_u32 m0, s48, 4096
    s_mov_b32 s22, 32768
    buffer_load_dwordx4 v44, s[8:11], s22 offen  lds
    s_add_u32 m0, s48, 8192
    s_mov_b32 s22, 65536
    buffer_load_dwordx4 v44, s[8:11], s22 offen  lds
    s_add_u32 m0, s48, 12288
    s_mov_b32 s22, 98304
    buffer_load_dwordx4 v44, s[8:11], s22 offen  lds
    s_waitcnt vmcnt(28)
    s_barrier
    v_add_u32 v48, 16384, v46
    ds_read_b64_tr_b16 a[16:17], v48 offset:0
    ds_read_b64_tr_b16 a[18:19], v48 offset:512
    ds_read_b64_tr_b16 a[20:21], v48 offset:8192
    ds_read_b64_tr_b16 a[22:23], v48 offset:8704
    ds_read_b64_tr_b16 a[24:25], v48 offset:8
    ds_read_b64_tr_b16 a[26:27], v48 offset:520
    ds_read_b64_tr_b16 a[28:29], v48 offset:8200
    ds_read_b64_tr_b16 a[30:31], v48 offset:8712
    s_waitcnt lgkmcnt(0)
    s_barrier
    s_add_u32 m0, s48, 16384
    s_mov_b32 s22, 524288
    buffer_load_dwordx4 v44, s[8:11], s22 offen  lds
    s_add_u32 m0, s48, 20480
    s_mov_b32 s22, 557056
    buffer_load_dwordx4 v44, s[8:11], s22 offen  lds
    s_add_u32 m0, s48, 24576
    s_mov_b32 s22, 589824
    buffer_load_dwordx4 v44, s[8:11], s22 offen  lds
    s_add_u32 m0, s48, 28672
    s_mov_b32 s22, 622592
    buffer_load_dwordx4 v44, s[8:11], s22 offen  lds
    s_waitcnt vmcnt(28)
    s_barrier
    v_add_u32 v48, 32768, v46
    ds_read_b64_tr_b16 a[32:33], v48 offset:0
    ds_read_b64_tr_b16 a[34:35], v48 offset:512
    ds_read_b64_tr_b16 a[36:37], v48 offset:8192
    ds_read_b64_tr_b16 a[38:39], v48 offset:8704
    ds_read_b64_tr_b16 a[40:41], v48 offset:8
    ds_read_b64_tr_b16 a[42:43], v48 offset:520
    ds_read_b64_tr_b16 a[44:45], v48 offset:8200
    ds_read_b64_tr_b16 a[46:47], v48 offset:8712
    s_waitcnt lgkmcnt(0)
    s_barrier
    s_add_u32 m0, s48, 32768
    s_mov_b32 s22, 1048576
    buffer_load_dwordx4 v44, s[8:11], s22 offen  lds
    s_add_u32 m0, s48, 36864
    s_mov_b32 s22, 1081344
    buffer_load_dwordx4 v44, s[8:11], s22 offen  lds
    s_add_u32 m0, s48, 40960
    s_mov_b32 s22, 1114112
    buffer_load_dwordx4 v44, s[8:11], s22 offen  lds
    s_add_u32 m0, s48, 45056
    s_mov_b32 s22, 1146880
    buffer_load_dwordx4 v44, s[8:11], s22 offen  lds
    s_waitcnt vmcnt(28)
    s_barrier
    v_add_u32 v48, 49152, v46
    ds_read_b64_tr_b16 a[48:49], v48 offset:0
    ds_read_b64_tr_b16 a[50:51], v48 offset:512
    ds_read_b64_tr_b16 a[52:53], v48 offset:8192
    ds_read_b64_tr_b16 a[54:55], v48 offset:8704
    ds_read_b64_tr_b16 a[56:57], v48 offset:8
    ds_read_b64_tr_b16 a[58:59], v48 offset:520
    ds_read_b64_tr_b16 a[60:61], v48 offset:8200
    ds_read_b64_tr_b16 a[62:63], v48 offset:8712
    s_waitcnt lgkmcnt(0)
    s_barrier
    s_add_u32 m0, s48, 49152
    s_mov_b32 s22, 1572864
    buffer_load_dwordx4 v44, s[8:11], s22 offen  lds
    s_add_u32 m0, s48, 53248
    s_mov_b32 s22, 1605632
    buffer_load_dwordx4 v44, s[8:11], s22 offen  lds
    s_add_u32 m0, s48, 57344
    s_mov_b32 s22, 1638400
    buffer_load_dwordx4 v44, s[8:11], s22 offen  lds
    s_add_u32 m0, s48, 61440
    s_mov_b32 s22, 1671168
    buffer_load_dwordx4 v44, s[8:11], s22 offen  lds
    s_waitcnt vmcnt(28)
    s_barrier
    v_add_u32 v48, 65536, v46
    ds_read_b64_tr_b16 a[64:65], v48 offset:0
    ds_read_b64_tr_b16 a[66:67], v48 offset:512
    ds_read_b64_tr_b16 a[68:69], v48 offset:8192
    ds_read_b64_tr_b16 a[70:71], v48 offset:8704
    ds_read_b64_tr_b16 a[72:73], v48 offset:8
    ds_read_b64_tr_b16 a[74:75], v48 offset:520
    ds_read_b64_tr_b16 a[76:77], v48 offset:8200
    ds_read_b64_tr_b16 a[78:79], v48 offset:8712
    s_waitcnt lgkmcnt(0)
    s_barrier
    s_add_u32 m0, s48, 65536
    s_mov_b32 s22, 2097152
    buffer_load_dwordx4 v44, s[8:11], s22 offen  lds
    s_add_u32 m0, s48, 69632
    s_mov_b32 s22, 2129920
    buffer_load_dwordx4 v44, s[8:11], s22 offen  lds
    s_add_u32 m0, s48, 73728
    s_mov_b32 s22, 2162688
    buffer_load_dwordx4 v44, s[8:11], s22 offen  lds
    s_add_u32 m0, s48, 77824
    s_mov_b32 s22, 2195456
    buffer_load_dwordx4 v44, s[8:11], s22 offen  lds
    s_waitcnt vmcnt(28)
    s_barrier
    v_add_u32 v48, 81920, v46
    ds_read_b64_tr_b16 a[80:81], v48 offset:0
    ds_read_b64_tr_b16 a[82:83], v48 offset:512
    ds_read_b64_tr_b16 a[84:85], v48 offset:8192
    ds_read_b64_tr_b16 a[86:87], v48 offset:8704
    ds_read_b64_tr_b16 a[88:89], v48 offset:8
    ds_read_b64_tr_b16 a[90:91], v48 offset:520
    ds_read_b64_tr_b16 a[92:93], v48 offset:8200
    ds_read_b64_tr_b16 a[94:95], v48 offset:8712
    s_waitcnt lgkmcnt(0)
    s_barrier
    s_add_u32 m0, s48, 81920
    s_mov_b32 s22, 2621440
    buffer_load_dwordx4 v44, s[8:11], s22 offen  lds
    s_add_u32 m0, s48, 86016
    s_mov_b32 s22, 2654208
    buffer_load_dwordx4 v44, s[8:11], s22 offen  lds
    s_add_u32 m0, s48, 90112
    s_mov_b32 s22, 2686976
    buffer_load_dwordx4 v44, s[8:11], s22 offen  lds
    s_add_u32 m0, s48, 94208
    s_mov_b32 s22, 2719744
    buffer_load_dwordx4 v44, s[8:11], s22 offen  lds
    s_waitcnt vmcnt(28)
    s_barrier
    v_add_u32 v48, 98304, v46
    ds_read_b64_tr_b16 a[96:97], v48 offset:0
    ds_read_b64_tr_b16 a[98:99], v48 offset:512
    ds_read_b64_tr_b16 a[100:101], v48 offset:8192
    ds_read_b64_tr_b16 a[102:103], v48 offset:8704
    ds_read_b64_tr_b16 a[104:105], v48 offset:8
    ds_read_b64_tr_b16 a[106:107], v48 offset:520
    ds_read_b64_tr_b16 a[108:109], v48 offset:8200
    ds_read_b64_tr_b16 a[110:111], v48 offset:8712
    s_waitcnt lgkmcnt(0)
    s_barrier
    s_add_u32 m0, s48, 98304
    s_mov_b32 s22, 3145728
    buffer_load_dwordx4 v44, s[8:11], s22 offen  lds
    s_add_u32 m0, s48, 102400
    s_mov_b32 s22, 3178496
    buffer_load_dwordx4 v44, s[8:11], s22 offen  lds
    s_add_u32 m0, s48, 106496
    s_mov_b32 s22, 3211264
    buffer_load_dwordx4 v44, s[8:11], s22 offen  lds
    s_add_u32 m0, s48, 110592
    s_mov_b32 s22, 3244032
    buffer_load_dwordx4 v44, s[8:11], s22 offen  lds
    s_waitcnt vmcnt(28)
    s_barrier
    v_add_u32 v48, 114688, v46
    ds_read_b64_tr_b16 a[112:113], v48 offset:0
    ds_read_b64_tr_b16 a[114:115], v48 offset:512
    ds_read_b64_tr_b16 a[116:117], v48 offset:8192
    ds_read_b64_tr_b16 a[118:119], v48 offset:8704
    ds_read_b64_tr_b16 a[120:121], v48 offset:8
    ds_read_b64_tr_b16 a[122:123], v48 offset:520
    ds_read_b64_tr_b16 a[124:125], v48 offset:8200
    ds_read_b64_tr_b16 a[126:127], v48 offset:8712
    s_waitcnt lgkmcnt(0)
    s_barrier
    s_add_u32 m0, s48, 114688
    s_mov_b32 s22, 3670016
    buffer_load_dwordx4 v44, s[8:11], s22 offen  lds
    s_add_u32 m0, s48, 118784
    s_mov_b32 s22, 3702784
    buffer_load_dwordx4 v44, s[8:11], s22 offen  lds
    s_add_u32 m0, s48, 122880
    s_mov_b32 s22, 3735552
    buffer_load_dwordx4 v44, s[8:11], s22 offen  lds
    s_add_u32 m0, s48, 126976
    s_mov_b32 s22, 3768320
    buffer_load_dwordx4 v44, s[8:11], s22 offen  lds
    s_waitcnt vmcnt(28)
    s_barrier
    v_add_u32 v48, 0, v46
    ds_read_b64_tr_b16 a[128:129], v48 offset:0
    ds_read_b64_tr_b16 a[130:131], v48 offset:512
    ds_read_b64_tr_b16 a[132:133], v48 offset:8192
    ds_read_b64_tr_b16 a[134:135], v48 offset:8704
    ds_read_b64_tr_b16 a[136:137], v48 offset:8
    ds_read_b64_tr_b16 a[138:139], v48 offset:520
    ds_read_b64_tr_b16 a[140:141], v48 offset:8200
    ds_read_b64_tr_b16 a[142:143], v48 offset:8712
    s_waitcnt lgkmcnt(0)
    s_barrier
    s_mov_b32 s8, s56
    s_mov_b32 s9, s57
    s_add_u32 m0, s48, 0
    s_mov_b32 s22, 0
    buffer_load_dwordx4 v45, s[8:11], s22 offen  lds
    s_add_u32 m0, s48, 4096
    s_mov_b32 s22, 16384
    buffer_load_dwordx4 v45, s[8:11], s22 offen  lds
    s_add_u32 m0, s48, 8192
    s_mov_b32 s22, 32768
    buffer_load_dwordx4 v45, s[8:11], s22 offen  lds
    s_add_u32 m0, s48, 12288
    s_mov_b32 s22, 49152
    buffer_load_dwordx4 v45, s[8:11], s22 offen  lds
    s_waitcnt vmcnt(28)
    s_barrier
    v_add_u32 v48, 16384, v46
    ds_read_b64_tr_b16 a[144:145], v48 offset:0
    ds_read_b64_tr_b16 a[146:147], v48 offset:512
    ds_read_b64_tr_b16 a[148:149], v48 offset:8192
    ds_read_b64_tr_b16 a[150:151], v48 offset:8704
    ds_read_b64_tr_b16 a[152:153], v48 offset:8
    ds_read_b64_tr_b16 a[154:155], v48 offset:520
    ds_read_b64_tr_b16 a[156:157], v48 offset:8200
    ds_read_b64_tr_b16 a[158:159], v48 offset:8712
    s_waitcnt lgkmcnt(0)
    s_barrier
    s_add_u32 m0, s48, 16384
    s_mov_b32 s22, 256
    buffer_load_dwordx4 v45, s[8:11], s22 offen  lds
    s_add_u32 m0, s48, 20480
    s_mov_b32 s22, 16640
    buffer_load_dwordx4 v45, s[8:11], s22 offen  lds
    s_add_u32 m0, s48, 24576
    s_mov_b32 s22, 33024
    buffer_load_dwordx4 v45, s[8:11], s22 offen  lds
    s_add_u32 m0, s48, 28672
    s_mov_b32 s22, 49408
    buffer_load_dwordx4 v45, s[8:11], s22 offen  lds
    s_waitcnt vmcnt(28)
    s_barrier
    v_add_u32 v48, 32768, v46
    ds_read_b64_tr_b16 a[160:161], v48 offset:0
    ds_read_b64_tr_b16 a[162:163], v48 offset:512
    ds_read_b64_tr_b16 a[164:165], v48 offset:8192
    ds_read_b64_tr_b16 a[166:167], v48 offset:8704
    ds_read_b64_tr_b16 a[168:169], v48 offset:8
    ds_read_b64_tr_b16 a[170:171], v48 offset:520
    ds_read_b64_tr_b16 a[172:173], v48 offset:8200
    ds_read_b64_tr_b16 a[174:175], v48 offset:8712
    s_waitcnt lgkmcnt(0)
    s_barrier
    s_add_u32 m0, s48, 32768
    s_mov_b32 s22, 512
    buffer_load_dwordx4 v45, s[8:11], s22 offen  lds
    s_add_u32 m0, s48, 36864
    s_mov_b32 s22, 16896
    buffer_load_dwordx4 v45, s[8:11], s22 offen  lds
    s_add_u32 m0, s48, 40960
    s_mov_b32 s22, 33280
    buffer_load_dwordx4 v45, s[8:11], s22 offen  lds
    s_add_u32 m0, s48, 45056
    s_mov_b32 s22, 49664
    buffer_load_dwordx4 v45, s[8:11], s22 offen  lds
    s_waitcnt vmcnt(28)
    s_barrier
    v_add_u32 v48, 49152, v46
    ds_read_b64_tr_b16 a[176:177], v48 offset:0
    ds_read_b64_tr_b16 a[178:179], v48 offset:512
    ds_read_b64_tr_b16 a[180:181], v48 offset:8192
    ds_read_b64_tr_b16 a[182:183], v48 offset:8704
    ds_read_b64_tr_b16 a[184:185], v48 offset:8
    ds_read_b64_tr_b16 a[186:187], v48 offset:520
    ds_read_b64_tr_b16 a[188:189], v48 offset:8200
    ds_read_b64_tr_b16 a[190:191], v48 offset:8712
    s_waitcnt lgkmcnt(0)
    s_barrier
    s_add_u32 m0, s48, 49152
    s_mov_b32 s22, 768
    buffer_load_dwordx4 v45, s[8:11], s22 offen  lds
    s_add_u32 m0, s48, 53248
    s_mov_b32 s22, 17152
    buffer_load_dwordx4 v45, s[8:11], s22 offen  lds
    s_add_u32 m0, s48, 57344
    s_mov_b32 s22, 33536
    buffer_load_dwordx4 v45, s[8:11], s22 offen  lds
    s_add_u32 m0, s48, 61440
    s_mov_b32 s22, 49920
    buffer_load_dwordx4 v45, s[8:11], s22 offen  lds
    s_waitcnt vmcnt(28)
    s_barrier
    v_and_b32 v254, 7, v0
    v_lshlrev_b32 v254, 5, v254
    buffer_load_dword v252, v254, s[88:91], 0 offen sc1
    buffer_load_dword v58, off, s[12:15], 0 offset:204 sc1
    v_add_u32 v48, 65536, v46
    ds_read_b64_tr_b16 a[192:193], v48 offset:0
    ds_read_b64_tr_b16 a[194:195], v48 offset:512
    ds_read_b64_tr_b16 a[196:197], v48 offset:8192
    ds_read_b64_tr_b16 a[198:199], v48 offset:8704
    ds_read_b64_tr_b16 a[200:201], v48 offset:8
    ds_read_b64_tr_b16 a[202:203], v48 offset:520
    ds_read_b64_tr_b16 a[204:205], v48 offset:8200
    ds_read_b64_tr_b16 a[206:207], v48 offset:8712
    s_waitcnt lgkmcnt(0)
    s_barrier
    s_add_u32 m0, s48, 65536
    s_mov_b32 s22, 131072
    buffer_load_dwordx4 v45, s[8:11], s22 offen  lds
    s_add_u32 m0, s48, 69632
    s_mov_b32 s22, 147456
    buffer_load_dwordx4 v45, s[8:11], s22 offen  lds
    s_add_u32 m0, s48, 73728
    s_mov_b32 s22, 163840
    buffer_load_dwordx4 v45, s[8:11], s22 offen  lds
    s_add_u32 m0, s48, 77824
    s_mov_b32 s22, 180224
    buffer_load_dwordx4 v45, s[8:11], s22 offen  lds
    s_waitcnt vmcnt(28)
    s_barrier
    v_add_u32 v48, 81920, v46
    ds_read_b64_tr_b16 a[208:209], v48 offset:0
    ds_read_b64_tr_b16 a[210:211], v48 offset:512
    ds_read_b64_tr_b16 a[212:213], v48 offset:8192
    ds_read_b64_tr_b16 a[214:215], v48 offset:8704
    ds_read_b64_tr_b16 a[216:217], v48 offset:8
    ds_read_b64_tr_b16 a[218:219], v48 offset:520
    ds_read_b64_tr_b16 a[220:221], v48 offset:8200
    ds_read_b64_tr_b16 a[222:223], v48 offset:8712
    s_waitcnt lgkmcnt(0)
    s_barrier
    s_add_u32 m0, s48, 81920
    s_mov_b32 s22, 131328
    buffer_load_dwordx4 v45, s[8:11], s22 offen  lds
    s_add_u32 m0, s48, 86016
    s_mov_b32 s22, 147712
    buffer_load_dwordx4 v45, s[8:11], s22 offen  lds
    s_add_u32 m0, s48, 90112
    s_mov_b32 s22, 164096
    buffer_load_dwordx4 v45, s[8:11], s22 offen  lds
    s_add_u32 m0, s48, 94208
    s_mov_b32 s22, 180480
    buffer_load_dwordx4 v45, s[8:11], s22 offen  lds
    s_waitcnt vmcnt(28)
    s_barrier
    v_add_u32 v48, 98304, v46
    ds_read_b64_tr_b16 a[224:225], v48 offset:0
    ds_read_b64_tr_b16 a[226:227], v48 offset:512
    ds_read_b64_tr_b16 a[228:229], v48 offset:8192
    ds_read_b64_tr_b16 a[230:231], v48 offset:8704
    ds_read_b64_tr_b16 a[232:233], v48 offset:8
    ds_read_b64_tr_b16 a[234:235], v48 offset:520
    ds_read_b64_tr_b16 a[236:237], v48 offset:8200
    ds_read_b64_tr_b16 a[238:239], v48 offset:8712
    s_waitcnt lgkmcnt(0)
    s_barrier
    s_add_u32 m0, s48, 98304
    s_mov_b32 s22, 131584
    buffer_load_dwordx4 v45, s[8:11], s22 offen  lds
    s_add_u32 m0, s48, 102400
    s_mov_b32 s22, 147968
    buffer_load_dwordx4 v45, s[8:11], s22 offen  lds
    s_add_u32 m0, s48, 106496
    s_mov_b32 s22, 164352
    buffer_load_dwordx4 v45, s[8:11], s22 offen  lds
    s_add_u32 m0, s48, 110592
    s_mov_b32 s22, 180736
    buffer_load_dwordx4 v45, s[8:11], s22 offen  lds
    s_waitcnt vmcnt(28)
    s_barrier
    v_add_u32 v48, 114688, v46
    ds_read_b64_tr_b16 a[240:241], v48 offset:0
    ds_read_b64_tr_b16 a[242:243], v48 offset:512
    ds_read_b64_tr_b16 a[244:245], v48 offset:8192
    ds_read_b64_tr_b16 a[246:247], v48 offset:8704
    ds_read_b64_tr_b16 a[248:249], v48 offset:8
    ds_read_b64_tr_b16 a[250:251], v48 offset:520
    ds_read_b64_tr_b16 a[252:253], v48 offset:8200
    ds_read_b64_tr_b16 a[254:255], v48 offset:8712
    s_waitcnt lgkmcnt(0)
    s_barrier
    s_add_u32 m0, s48, 114688
    s_mov_b32 s22, 131840
    buffer_load_dwordx4 v45, s[8:11], s22 offen  lds
    s_add_u32 m0, s48, 118784
    s_mov_b32 s22, 148224
    buffer_load_dwordx4 v45, s[8:11], s22 offen  lds
    s_add_u32 m0, s48, 122880
    s_mov_b32 s22, 164608
    buffer_load_dwordx4 v45, s[8:11], s22 offen  lds
    s_add_u32 m0, s48, 126976
    s_mov_b32 s22, 180992
    buffer_load_dwordx4 v45, s[8:11], s22 offen  lds
    s_waitcnt vmcnt(28)
    s_barrier
    s_cmp_lg_u32 s20, 0
    s_cbranch_scc1 mega_kernel_rf_wo0
    v_xor_b32 v48, 0, v47
    v_add_u32 v48, 0, v48
    ds_read_b64_tr_b16 v[128:129], v48 offset:0
    ds_read_b64_tr_b16 v[130:131], v48 offset:512
    ds_read_b64_tr_b16 v[132:133], v48 offset:8192
    ds_read_b64_tr_b16 v[134:135], v48 offset:8704
    ds_read_b64_tr_b16 v[136:137], v48 offset:32
    ds_read_b64_tr_b16 v[138:139], v48 offset:544
    ds_read_b64_tr_b16 v[140:141], v48 offset:8224
    ds_read_b64_tr_b16 v[142:143], v48 offset:8736
    s_waitcnt lgkmcnt(0)
    v_xor_b32 v48, 64, v47
    v_add_u32 v48, 0, v48
    ds_read_b64_tr_b16 v[144:145], v48 offset:0
    ds_read_b64_tr_b16 v[146:147], v48 offset:512
    ds_read_b64_tr_b16 v[148:149], v48 offset:8192
    ds_read_b64_tr_b16 v[150:151], v48 offset:8704
    ds_read_b64_tr_b16 v[152:153], v48 offset:32
    ds_read_b64_tr_b16 v[154:155], v48 offset:544
    ds_read_b64_tr_b16 v[156:157], v48 offset:8224
    ds_read_b64_tr_b16 v[158:159], v48 offset:8736
    s_waitcnt lgkmcnt(0)
    v_xor_b32 v48, 128, v47
    v_add_u32 v48, 0, v48
    ds_read_b64_tr_b16 v[192:193], v48 offset:0
    ds_read_b64_tr_b16 v[194:195], v48 offset:512
    ds_read_b64_tr_b16 v[196:197], v48 offset:8192
    ds_read_b64_tr_b16 v[198:199], v48 offset:8704
    ds_read_b64_tr_b16 v[200:201], v48 offset:32
    ds_read_b64_tr_b16 v[202:203], v48 offset:544
    ds_read_b64_tr_b16 v[204:205], v48 offset:8224
    ds_read_b64_tr_b16 v[206:207], v48 offset:8736
    s_waitcnt lgkmcnt(0)
    v_xor_b32 v48, 192, v47
    v_add_u32 v48, 0, v48
    ds_read_b64_tr_b16 v[80:81], v48 offset:0
    ds_read_b64_tr_b16 v[82:83], v48 offset:512
    ds_read_b64_tr_b16 v[84:85], v48 offset:8192
    ds_read_b64_tr_b16 v[86:87], v48 offset:8704
    ds_read_b64_tr_b16 v[88:89], v48 offset:32
    ds_read_b64_tr_b16 v[90:91], v48 offset:544
    ds_read_b64_tr_b16 v[92:93], v48 offset:8224
    ds_read_b64_tr_b16 v[94:95], v48 offset:8736
    s_waitcnt lgkmcnt(0)
mega_kernel_rf_wo0:
    s_barrier
    s_mov_b32 s8, s54
    s_mov_b32 s9, s55
    s_add_u32 m0, s48, 0
    s_mov_b32 s22, 0
    buffer_load_dwordx4 v44, s[8:11], s22 offen  lds
    s_add_u32 m0, s48, 4096
    s_mov_b32 s22, 32768
    buffer_load_dwordx4 v44, s[8:11], s22 offen  lds
    s_add_u32 m0, s48, 8192
    s_mov_b32 s22, 65536
    buffer_load_dwordx4 v44, s[8:11], s22 offen  lds
    s_add_u32 m0, s48, 12288
    s_mov_b32 s22, 98304
    buffer_load_dwordx4 v44, s[8:11], s22 offen  lds
    s_waitcnt vmcnt(28)
    s_barrier
    s_cmp_lg_u32 s20, 1
    s_cbranch_scc1 mega_kernel_rf_wo1
    v_xor_b32 v48, 0, v47
    v_add_u32 v48, 16384, v48
    ds_read_b64_tr_b16 v[128:129], v48 offset:0
    ds_read_b64_tr_b16 v[130:131], v48 offset:512
    ds_read_b64_tr_b16 v[132:133], v48 offset:8192
    ds_read_b64_tr_b16 v[134:135], v48 offset:8704
    ds_read_b64_tr_b16 v[136:137], v48 offset:32
    ds_read_b64_tr_b16 v[138:139], v48 offset:544
    ds_read_b64_tr_b16 v[140:141], v48 offset:8224
    ds_read_b64_tr_b16 v[142:143], v48 offset:8736
    s_waitcnt lgkmcnt(0)
    v_xor_b32 v48, 64, v47
    v_add_u32 v48, 16384, v48
    ds_read_b64_tr_b16 v[144:145], v48 offset:0
    ds_read_b64_tr_b16 v[146:147], v48 offset:512
    ds_read_b64_tr_b16 v[148:149], v48 offset:8192
    ds_read_b64_tr_b16 v[150:151], v48 offset:8704
    ds_read_b64_tr_b16 v[152:153], v48 offset:32
    ds_read_b64_tr_b16 v[154:155], v48 offset:544
    ds_read_b64_tr_b16 v[156:157], v48 offset:8224
    ds_read_b64_tr_b16 v[158:159], v48 offset:8736
    s_waitcnt lgkmcnt(0)
    v_xor_b32 v48, 128, v47
    v_add_u32 v48, 16384, v48
    ds_read_b64_tr_b16 v[192:193], v48 offset:0
    ds_read_b64_tr_b16 v[194:195], v48 offset:512
    ds_read_b64_tr_b16 v[196:197], v48 offset:8192
    ds_read_b64_tr_b16 v[198:199], v48 offset:8704
    ds_read_b64_tr_b16 v[200:201], v48 offset:32
    ds_read_b64_tr_b16 v[202:203], v48 offset:544
    ds_read_b64_tr_b16 v[204:205], v48 offset:8224
    ds_read_b64_tr_b16 v[206:207], v48 offset:8736
    s_waitcnt lgkmcnt(0)
    v_xor_b32 v48, 192, v47
    v_add_u32 v48, 16384, v48
    ds_read_b64_tr_b16 v[80:81], v48 offset:0
    ds_read_b64_tr_b16 v[82:83], v48 offset:512
    ds_read_b64_tr_b16 v[84:85], v48 offset:8192
    ds_read_b64_tr_b16 v[86:87], v48 offset:8704
    ds_read_b64_tr_b16 v[88:89], v48 offset:32
    ds_read_b64_tr_b16 v[90:91], v48 offset:544
    ds_read_b64_tr_b16 v[92:93], v48 offset:8224
    ds_read_b64_tr_b16 v[94:95], v48 offset:8736
    s_waitcnt lgkmcnt(0)
mega_kernel_rf_wo1:
    s_barrier
    s_add_u32 m0, s48, 16384
    s_mov_b32 s22, 524288
    buffer_load_dwordx4 v44, s[8:11], s22 offen  lds
    s_add_u32 m0, s48, 20480
    s_mov_b32 s22, 557056
    buffer_load_dwordx4 v44, s[8:11], s22 offen  lds
    s_add_u32 m0, s48, 24576
    s_mov_b32 s22, 589824
    buffer_load_dwordx4 v44, s[8:11], s22 offen  lds
    s_add_u32 m0, s48, 28672
    s_mov_b32 s22, 622592
    buffer_load_dwordx4 v44, s[8:11], s22 offen  lds
    s_waitcnt vmcnt(28)
    s_barrier
    s_cmp_lg_u32 s20, 2
    s_cbranch_scc1 mega_kernel_rf_wo2
    v_xor_b32 v48, 0, v47
    v_add_u32 v48, 32768, v48
    ds_read_b64_tr_b16 v[128:129], v48 offset:0
    ds_read_b64_tr_b16 v[130:131], v48 offset:512
    ds_read_b64_tr_b16 v[132:133], v48 offset:8192
    ds_read_b64_tr_b16 v[134:135], v48 offset:8704
    ds_read_b64_tr_b16 v[136:137], v48 offset:32
    ds_read_b64_tr_b16 v[138:139], v48 offset:544
    ds_read_b64_tr_b16 v[140:141], v48 offset:8224
    ds_read_b64_tr_b16 v[142:143], v48 offset:8736
    s_waitcnt lgkmcnt(0)
    v_xor_b32 v48, 64, v47
    v_add_u32 v48, 32768, v48
    ds_read_b64_tr_b16 v[144:145], v48 offset:0
    ds_read_b64_tr_b16 v[146:147], v48 offset:512
    ds_read_b64_tr_b16 v[148:149], v48 offset:8192
    ds_read_b64_tr_b16 v[150:151], v48 offset:8704
    ds_read_b64_tr_b16 v[152:153], v48 offset:32
    ds_read_b64_tr_b16 v[154:155], v48 offset:544
    ds_read_b64_tr_b16 v[156:157], v48 offset:8224
    ds_read_b64_tr_b16 v[158:159], v48 offset:8736
    s_waitcnt lgkmcnt(0)
    v_xor_b32 v48, 128, v47
    v_add_u32 v48, 32768, v48
    ds_read_b64_tr_b16 v[192:193], v48 offset:0
    ds_read_b64_tr_b16 v[194:195], v48 offset:512
    ds_read_b64_tr_b16 v[196:197], v48 offset:8192
    ds_read_b64_tr_b16 v[198:199], v48 offset:8704
    ds_read_b64_tr_b16 v[200:201], v48 offset:32
    ds_read_b64_tr_b16 v[202:203], v48 offset:544
    ds_read_b64_tr_b16 v[204:205], v48 offset:8224
    ds_read_b64_tr_b16 v[206:207], v48 offset:8736
    s_waitcnt lgkmcnt(0)
    v_xor_b32 v48, 192, v47
    v_add_u32 v48, 32768, v48
    ds_read_b64_tr_b16 v[80:81], v48 offset:0
    ds_read_b64_tr_b16 v[82:83], v48 offset:512
    ds_read_b64_tr_b16 v[84:85], v48 offset:8192
    ds_read_b64_tr_b16 v[86:87], v48 offset:8704
    ds_read_b64_tr_b16 v[88:89], v48 offset:32
    ds_read_b64_tr_b16 v[90:91], v48 offset:544
    ds_read_b64_tr_b16 v[92:93], v48 offset:8224
    ds_read_b64_tr_b16 v[94:95], v48 offset:8736
    s_waitcnt lgkmcnt(0)
mega_kernel_rf_wo2:
    s_barrier
    s_add_u32 m0, s48, 32768
    s_mov_b32 s22, 1048576
    buffer_load_dwordx4 v44, s[8:11], s22 offen  lds
    s_add_u32 m0, s48, 36864
    s_mov_b32 s22, 1081344
    buffer_load_dwordx4 v44, s[8:11], s22 offen  lds
    s_add_u32 m0, s48, 40960
    s_mov_b32 s22, 1114112
    buffer_load_dwordx4 v44, s[8:11], s22 offen  lds
    s_add_u32 m0, s48, 45056
    s_mov_b32 s22, 1146880
    buffer_load_dwordx4 v44, s[8:11], s22 offen  lds
    s_waitcnt vmcnt(28)
    s_barrier
    s_cmp_lg_u32 s20, 3
    s_cbranch_scc1 mega_kernel_rf_wo3
    v_xor_b32 v48, 0, v47
    v_add_u32 v48, 49152, v48
    ds_read_b64_tr_b16 v[128:129], v48 offset:0
    ds_read_b64_tr_b16 v[130:131], v48 offset:512
    ds_read_b64_tr_b16 v[132:133], v48 offset:8192
    ds_read_b64_tr_b16 v[134:135], v48 offset:8704
    ds_read_b64_tr_b16 v[136:137], v48 offset:32
    ds_read_b64_tr_b16 v[138:139], v48 offset:544
    ds_read_b64_tr_b16 v[140:141], v48 offset:8224
    ds_read_b64_tr_b16 v[142:143], v48 offset:8736
    s_waitcnt lgkmcnt(0)
    v_xor_b32 v48, 64, v47
    v_add_u32 v48, 49152, v48
    ds_read_b64_tr_b16 v[144:145], v48 offset:0
    ds_read_b64_tr_b16 v[146:147], v48 offset:512
    ds_read_b64_tr_b16 v[148:149], v48 offset:8192
    ds_read_b64_tr_b16 v[150:151], v48 offset:8704
    ds_read_b64_tr_b16 v[152:153], v48 offset:32
    ds_read_b64_tr_b16 v[154:155], v48 offset:544
    ds_read_b64_tr_b16 v[156:157], v48 offset:8224
    ds_read_b64_tr_b16 v[158:159], v48 offset:8736
    s_waitcnt lgkmcnt(0)
    v_xor_b32 v48, 128, v47
    v_add_u32 v48, 49152, v48
    ds_read_b64_tr_b16 v[192:193], v48 offset:0
    ds_read_b64_tr_b16 v[194:195], v48 offset:512
    ds_read_b64_tr_b16 v[196:197], v48 offset:8192
    ds_read_b64_tr_b16 v[198:199], v48 offset:8704
    ds_read_b64_tr_b16 v[200:201], v48 offset:32
    ds_read_b64_tr_b16 v[202:203], v48 offset:544
    ds_read_b64_tr_b16 v[204:205], v48 offset:8224
    ds_read_b64_tr_b16 v[206:207], v48 offset:8736
    s_waitcnt lgkmcnt(0)
    v_xor_b32 v48, 192, v47
    v_add_u32 v48, 49152, v48
    ds_read_b64_tr_b16 v[80:81], v48 offset:0
    ds_read_b64_tr_b16 v[82:83], v48 offset:512
    ds_read_b64_tr_b16 v[84:85], v48 offset:8192
    ds_read_b64_tr_b16 v[86:87], v48 offset:8704
    ds_read_b64_tr_b16 v[88:89], v48 offset:32
    ds_read_b64_tr_b16 v[90:91], v48 offset:544
    ds_read_b64_tr_b16 v[92:93], v48 offset:8224
    ds_read_b64_tr_b16 v[94:95], v48 offset:8736
    s_waitcnt lgkmcnt(0)
mega_kernel_rf_wo3:
    s_barrier
    s_add_u32 m0, s48, 49152
    s_mov_b32 s22, 1572864
    buffer_load_dwordx4 v44, s[8:11], s22 offen  lds
    s_add_u32 m0, s48, 53248
    s_mov_b32 s22, 1605632
    buffer_load_dwordx4 v44, s[8:11], s22 offen  lds
    s_add_u32 m0, s48, 57344
    s_mov_b32 s22, 1638400
    buffer_load_dwordx4 v44, s[8:11], s22 offen  lds
    s_add_u32 m0, s48, 61440
    s_mov_b32 s22, 1671168
    buffer_load_dwordx4 v44, s[8:11], s22 offen  lds
    s_waitcnt vmcnt(28)
    s_barrier
    s_cmp_lg_u32 s20, 0
    s_cbranch_scc1 mega_kernel_rf_wo4
    v_xor_b32 v48, 0, v47
    v_add_u32 v48, 65536, v48
    ds_read_b64_tr_b16 v[160:161], v48 offset:0
    ds_read_b64_tr_b16 v[162:163], v48 offset:512
    ds_read_b64_tr_b16 v[164:165], v48 offset:8192
    ds_read_b64_tr_b16 v[166:167], v48 offset:8704
    ds_read_b64_tr_b16 v[168:169], v48 offset:32
    ds_read_b64_tr_b16 v[170:171], v48 offset:544
    ds_read_b64_tr_b16 v[172:173], v48 offset:8224
    ds_read_b64_tr_b16 v[174:175], v48 offset:8736
    s_waitcnt lgkmcnt(0)
    v_xor_b32 v48, 64, v47
    v_add_u32 v48, 65536, v48
    ds_read_b64_tr_b16 v[176:177], v48 offset:0
    ds_read_b64_tr_b16 v[178:179], v48 offset:512
    ds_read_b64_tr_b16 v[180:181], v48 offset:8192
    ds_read_b64_tr_b16 v[182:183], v48 offset:8704
    ds_read_b64_tr_b16 v[184:185], v48 offset:32
    ds_read_b64_tr_b16 v[186:187], v48 offset:544
    ds_read_b64_tr_b16 v[188:189], v48 offset:8224
    ds_read_b64_tr_b16 v[190:191], v48 offset:8736
    s_waitcnt lgkmcnt(0)
    v_xor_b32 v48, 128, v47
    v_add_u32 v48, 65536, v48
    ds_read_b64_tr_b16 v[96:97], v48 offset:0
    ds_read_b64_tr_b16 v[98:99], v48 offset:512
    ds_read_b64_tr_b16 v[100:101], v48 offset:8192
    ds_read_b64_tr_b16 v[102:103], v48 offset:8704
    ds_read_b64_tr_b16 v[104:105], v48 offset:32
    ds_read_b64_tr_b16 v[106:107], v48 offset:544
    ds_read_b64_tr_b16 v[108:109], v48 offset:8224
    ds_read_b64_tr_b16 v[110:111], v48 offset:8736
    s_waitcnt lgkmcnt(0)
    v_xor_b32 v48, 192, v47
    v_add_u32 v48, 65536, v48
    ds_read_b64_tr_b16 v[112:113], v48 offset:0
    ds_read_b64_tr_b16 v[114:115], v48 offset:512
    ds_read_b64_tr_b16 v[116:117], v48 offset:8192
    ds_read_b64_tr_b16 v[118:119], v48 offset:8704
    ds_read_b64_tr_b16 v[120:121], v48 offset:32
    ds_read_b64_tr_b16 v[122:123], v48 offset:544
    ds_read_b64_tr_b16 v[124:125], v48 offset:8224
    ds_read_b64_tr_b16 v[126:127], v48 offset:8736
    s_waitcnt lgkmcnt(0)
mega_kernel_rf_wo4:
    s_barrier
    s_add_u32 m0, s48, 65536
    s_mov_b32 s22, 2097152
    buffer_load_dwordx4 v44, s[8:11], s22 offen  lds
    s_add_u32 m0, s48, 69632
    s_mov_b32 s22, 2129920
    buffer_load_dwordx4 v44, s[8:11], s22 offen  lds
    s_add_u32 m0, s48, 73728
    s_mov_b32 s22, 2162688
    buffer_load_dwordx4 v44, s[8:11], s22 offen  lds
    s_add_u32 m0, s48, 77824
    s_mov_b32 s22, 2195456
    buffer_load_dwordx4 v44, s[8:11], s22 offen  lds
    s_waitcnt vmcnt(28)
    s_barrier
    s_cmp_lg_u32 s20, 1
    s_cbranch_scc1 mega_kernel_rf_wo5
    v_xor_b32 v48, 0, v47
    v_add_u32 v48, 81920, v48
    ds_read_b64_tr_b16 v[160:161], v48 offset:0
    ds_read_b64_tr_b16 v[162:163], v48 offset:512
    ds_read_b64_tr_b16 v[164:165], v48 offset:8192
    ds_read_b64_tr_b16 v[166:167], v48 offset:8704
    ds_read_b64_tr_b16 v[168:169], v48 offset:32
    ds_read_b64_tr_b16 v[170:171], v48 offset:544
    ds_read_b64_tr_b16 v[172:173], v48 offset:8224
    ds_read_b64_tr_b16 v[174:175], v48 offset:8736
    s_waitcnt lgkmcnt(0)
    v_xor_b32 v48, 64, v47
    v_add_u32 v48, 81920, v48
    ds_read_b64_tr_b16 v[176:177], v48 offset:0
    ds_read_b64_tr_b16 v[178:179], v48 offset:512
    ds_read_b64_tr_b16 v[180:181], v48 offset:8192
    ds_read_b64_tr_b16 v[182:183], v48 offset:8704
    ds_read_b64_tr_b16 v[184:185], v48 offset:32
    ds_read_b64_tr_b16 v[186:187], v48 offset:544
    ds_read_b64_tr_b16 v[188:189], v48 offset:8224
    ds_read_b64_tr_b16 v[190:191], v48 offset:8736
    s_waitcnt lgkmcnt(0)
    v_xor_b32 v48, 128, v47
    v_add_u32 v48, 81920, v48
    ds_read_b64_tr_b16 v[96:97], v48 offset:0
    ds_read_b64_tr_b16 v[98:99], v48 offset:512
    ds_read_b64_tr_b16 v[100:101], v48 offset:8192
    ds_read_b64_tr_b16 v[102:103], v48 offset:8704
    ds_read_b64_tr_b16 v[104:105], v48 offset:32
    ds_read_b64_tr_b16 v[106:107], v48 offset:544
    ds_read_b64_tr_b16 v[108:109], v48 offset:8224
    ds_read_b64_tr_b16 v[110:111], v48 offset:8736
    s_waitcnt lgkmcnt(0)
    v_xor_b32 v48, 192, v47
    v_add_u32 v48, 81920, v48
    ds_read_b64_tr_b16 v[112:113], v48 offset:0
    ds_read_b64_tr_b16 v[114:115], v48 offset:512
    ds_read_b64_tr_b16 v[116:117], v48 offset:8192
    ds_read_b64_tr_b16 v[118:119], v48 offset:8704
    ds_read_b64_tr_b16 v[120:121], v48 offset:32
    ds_read_b64_tr_b16 v[122:123], v48 offset:544
    ds_read_b64_tr_b16 v[124:125], v48 offset:8224
    ds_read_b64_tr_b16 v[126:127], v48 offset:8736
    s_waitcnt lgkmcnt(0)
mega_kernel_rf_wo5:
    s_barrier
    s_add_u32 m0, s48, 81920
    s_mov_b32 s22, 2621440
    buffer_load_dwordx4 v44, s[8:11], s22 offen  lds
    s_add_u32 m0, s48, 86016
    s_mov_b32 s22, 2654208
    buffer_load_dwordx4 v44, s[8:11], s22 offen  lds
    s_add_u32 m0, s48, 90112
    s_mov_b32 s22, 2686976
    buffer_load_dwordx4 v44, s[8:11], s22 offen  lds
    s_add_u32 m0, s48, 94208
    s_mov_b32 s22, 2719744
    buffer_load_dwordx4 v44, s[8:11], s22 offen  lds
    s_waitcnt vmcnt(28)
    s_barrier
    s_cmp_lg_u32 s97, 0
    s_cbranch_scc1 mega_kernel_h2_2_ok
mega_kernel_h2_2_ev:
    v_cmp_ne_u32 vcc, 32, v252
    s_cbranch_vccz mega_kernel_h2_2_ok
    s_mov_b32 s78, 0
    v_readlane_b32 s81, v252, 0
    s_nop 3
    s_add_u32 s78, s78, s81
    v_readlane_b32 s81, v252, 1
    s_nop 3
    s_add_u32 s78, s78, s81
    v_readlane_b32 s81, v252, 2
    s_nop 3
    s_add_u32 s78, s78, s81
    v_readlane_b32 s81, v252, 3
    s_nop 3
    s_add_u32 s78, s78, s81
    v_readlane_b32 s81, v252, 4
    s_nop 3
    s_add_u32 s78, s78, s81
    v_readlane_b32 s81, v252, 5
    s_nop 3
    s_add_u32 s78, s78, s81
    v_readlane_b32 s81, v252, 6
    s_nop 3
    s_add_u32 s78, s78, s81
    v_readlane_b32 s81, v252, 7
    s_nop 3
    s_add_u32 s78, s78, s81
    s_cmp_eq_u32 s78, 256
    s_cbranch_scc1 mega_kernel_redo
    buffer_load_dword v252, v254, s[88:91], 0 offen sc1
    s_waitcnt vmcnt(0)
    s_branch mega_kernel_h2_2_ev
mega_kernel_h2_2_ok:
    s_cmp_lg_u32 s20, 2
    s_cbranch_scc1 mega_kernel_rf_wo6
    v_xor_b32 v48, 0, v47
    v_add_u32 v48, 98304, v48
    ds_read_b64_tr_b16 v[160:161], v48 offset:0
    ds_read_b64_tr_b16 v[162:163], v48 offset:512
    ds_read_b64_tr_b16 v[164:165], v48 offset:8192
    ds_read_b64_tr_b16 v[166:167], v48 offset:8704
    ds_read_b64_tr_b16 v[168:169], v48 offset:32
    ds_read_b64_tr_b16 v[170:171], v48 offset:544
    ds_read_b64_tr_b16 v[172:173], v48 offset:8224
    ds_read_b64_tr_b16 v[174:175], v48 offset:8736
    s_waitcnt lgkmcnt(0)
    v_xor_b32 v48, 64, v47
    v_add_u32 v48, 98304, v48
    ds_read_b64_tr_b16 v[176:177], v48 offset:0
    ds_read_b64_tr_b16 v[178:179], v48 offset:512
    ds_read_b64_tr_b16 v[180:181], v48 offset:8192
    ds_read_b64_tr_b16 v[182:183], v48 offset:8704
    ds_read_b64_tr_b16 v[184:185], v48 offset:32
    ds_read_b64_tr_b16 v[186:187], v48 offset:544
    ds_read_b64_tr_b16 v[188:189], v48 offset:8224
    ds_read_b64_tr_b16 v[190:191], v48 offset:8736
    s_waitcnt lgkmcnt(0)
    v_xor_b32 v48, 128, v47
    v_add_u32 v48, 98304, v48
    ds_read_b64_tr_b16 v[96:97], v48 offset:0
    ds_read_b64_tr_b16 v[98:99], v48 offset:512
    ds_read_b64_tr_b16 v[100:101], v48 offset:8192
    ds_read_b64_tr_b16 v[102:103], v48 offset:8704
    ds_read_b64_tr_b16 v[104:105], v48 offset:32
    ds_read_b64_tr_b16 v[106:107], v48 offset:544
    ds_read_b64_tr_b16 v[108:109], v48 offset:8224
    ds_read_b64_tr_b16 v[110:111], v48 offset:8736
    s_waitcnt lgkmcnt(0)
    v_xor_b32 v48, 192, v47
    v_add_u32 v48, 98304, v48
    ds_read_b64_tr_b16 v[112:113], v48 offset:0
    ds_read_b64_tr_b16 v[114:115], v48 offset:512
    ds_read_b64_tr_b16 v[116:117], v48 offset:8192
    ds_read_b64_tr_b16 v[118:119], v48 offset:8704
    ds_read_b64_tr_b16 v[120:121], v48 offset:32
    ds_read_b64_tr_b16 v[122:123], v48 offset:544
    ds_read_b64_tr_b16 v[124:125], v48 offset:8224
    ds_read_b64_tr_b16 v[126:127], v48 offset:8736
    s_waitcnt lgkmcnt(0)
mega_kernel_rf_wo6:
    s_barrier
    s_add_u32 m0, s48, 98304
    s_mov_b32 s22, 3145728
    buffer_load_dwordx4 v44, s[8:11], s22 offen  lds
    s_add_u32 m0, s48, 102400
    s_mov_b32 s22, 3178496
    buffer_load_dwordx4 v44, s[8:11], s22 offen  lds
    s_add_u32 m0, s48, 106496
    s_mov_b32 s22, 3211264
    buffer_load_dwordx4 v44, s[8:11], s22 offen  lds
    s_add_u32 m0, s48, 110592
    s_mov_b32 s22, 3244032
    buffer_load_dwordx4 v44, s[8:11], s22 offen  lds
    s_waitcnt vmcnt(28)
    s_barrier
    s_cmp_lg_u32 s20, 3
    s_cbranch_scc1 mega_kernel_rf_wo7
    v_xor_b32 v48, 0, v47
    v_add_u32 v48, 114688, v48
    ds_read_b64_tr_b16 v[160:161], v48 offset:0
    ds_read_b64_tr_b16 v[162:163], v48 offset:512
    ds_read_b64_tr_b16 v[164:165], v48 offset:8192
    ds_read_b64_tr_b16 v[166:167], v48 offset:8704
    ds_read_b64_tr_b16 v[168:169], v48 offset:32
    ds_read_b64_tr_b16 v[170:171], v48 offset:544
    ds_read_b64_tr_b16 v[172:173], v48 offset:8224
    ds_read_b64_tr_b16 v[174:175], v48 offset:8736
    s_waitcnt lgkmcnt(0)
    v_xor_b32 v48, 64, v47
    v_add_u32 v48, 114688, v48
    ds_read_b64_tr_b16 v[176:177], v48 offset:0
    ds_read_b64_tr_b16 v[178:179], v48 offset:512
    ds_read_b64_tr_b16 v[180:181], v48 offset:8192
    ds_read_b64_tr_b16 v[182:183], v48 offset:8704
    ds_read_b64_tr_b16 v[184:185], v48 offset:32
    ds_read_b64_tr_b16 v[186:187], v48 offset:544
    ds_read_b64_tr_b16 v[188:189], v48 offset:8224
    ds_read_b64_tr_b16 v[190:191], v48 offset:8736
    s_waitcnt lgkmcnt(0)
    v_xor_b32 v48, 128, v47
    v_add_u32 v48, 114688, v48
    ds_read_b64_tr_b16 v[96:97], v48 offset:0
    ds_read_b64_tr_b16 v[98:99], v48 offset:512
    ds_read_b64_tr_b16 v[100:101], v48 offset:8192
    ds_read_b64_tr_b16 v[102:103], v48 offset:8704
    ds_read_b64_tr_b16 v[104:105], v48 offset:32
    ds_read_b64_tr_b16 v[106:107], v48 offset:544
    ds_read_b64_tr_b16 v[108:109], v48 offset:8224
    ds_read_b64_tr_b16 v[110:111], v48 offset:8736
    s_waitcnt lgkmcnt(0)
    v_xor_b32 v48, 192, v47
    v_add_u32 v48, 114688, v48
    ds_read_b64_tr_b16 v[112:113], v48 offset:0
    ds_read_b64_tr_b16 v[114:115], v48 offset:512
    ds_read_b64_tr_b16 v[116:117], v48 offset:8192
    ds_read_b64_tr_b16 v[118:119], v48 offset:8704
    ds_read_b64_tr_b16 v[120:121], v48 offset:32
    ds_read_b64_tr_b16 v[122:123], v48 offset:544
    ds_read_b64_tr_b16 v[124:125], v48 offset:8224
    ds_read_b64_tr_b16 v[126:127], v48 offset:8736
    s_waitcnt lgkmcnt(0)
mega_kernel_rf_wo7:
    s_barrier
    s_add_u32 m0, s48, 114688
    s_mov_b32 s22, 3670016
    buffer_load_dwordx4 v44, s[8:11], s22 offen  lds
    s_add_u32 m0, s48, 118784
    s_mov_b32 s22, 3702784
    buffer_load_dwordx4 v44, s[8:11], s22 offen  lds
    s_add_u32 m0, s48, 122880
    s_mov_b32 s22, 3735552
    buffer_load_dwordx4 v44, s[8:11], s22 offen  lds
    s_add_u32 m0, s48, 126976
    s_mov_b32 s22, 3768320
    buffer_load_dwordx4 v44, s[8:11], s22 offen  lds
    s_waitcnt vmcnt(28)
    s_barrier
    v_add_u32 v48, 0, v46
    ds_read_b64_tr_b16 v[64:65], v48 offset:0
    ds_read_b64_tr_b16 v[66:67], v48 offset:512
    ds_read_b64_tr_b16 v[68:69], v48 offset:8192
    ds_read_b64_tr_b16 v[70:71], v48 offset:8704
    ds_read_b64_tr_b16 v[72:73], v48 offset:8
    ds_read_b64_tr_b16 v[74:75], v48 offset:520
    ds_read_b64_tr_b16 v[76:77], v48 offset:8200
    ds_read_b64_tr_b16 v[78:79], v48 offset:8712
    s_waitcnt lgkmcnt(0)
    s_barrier
    ds_write_b128 v32, v[64:67] offset:0
    ds_write_b128 v32, v[68:71] offset:1024
    ds_write_b128 v32, v[72:75] offset:2048
    ds_write_b128 v32, v[76:79] offset:3072
    s_waitcnt lgkmcnt(0)
    s_waitcnt vmcnt(24)
    s_barrier
    v_add_u32 v48, 16384, v46
    ds_read_b64_tr_b16 v[64:65], v48 offset:0
    ds_read_b64_tr_b16 v[66:67], v48 offset:512
    ds_read_b64_tr_b16 v[68:69], v48 offset:8192
    ds_read_b64_tr_b16 v[70:71], v48 offset:8704
    ds_read_b64_tr_b16 v[72:73], v48 offset:8
    ds_read_b64_tr_b16 v[74:75], v48 offset:520
    ds_read_b64_tr_b16 v[76:77], v48 offset:8200
    ds_read_b64_tr_b16 v[78:79], v48 offset:8712
    s_waitcnt lgkmcnt(0)
    s_barrier
    ds_write_b128 v32, v[64:67] offset:16384
    ds_write_b128 v32, v[68:71] offset:17408
    ds_write_b128 v32, v[72:75] offset:18432
    ds_write_b128 v32, v[76:79] offset:19456
    s_waitcnt lgkmcnt(0)
    s_waitcnt vmcnt(20)
    s_barrier
    s_getpc_b64 s[16:17]
mega_kernel_rf_pc0:
    s_add_u32 s16, s16, mega_kernel_rf_w0_entry - mega_kernel_rf_pc0
    s_addc_u32 s17, s17, 0
    v_lshlrev_b32 v49, 7, v0
    v_min_u32 v49, mega_kernel_rf_end - mega_kernel_rf_w0_entry, v49
    global_load_dword v50, v49, s[16:17]
    v_lshlrev_b32 v49, 7, v40
    s_xor_b32 s23, s35, 16384
    s_cmp_eq_u32 s20, 1
    s_cselect_b32 s22, s35, s47
    s_cmp_eq_u32 s20, 2
    s_cselect_b32 s22, s23, s22
    s_lshl_b32 s23, s31, 13
    s_add_u32 s23, s23, 178257920
    s_cmp_eq_u32 s20, 3
    s_cselect_b32 s22, s23, s22
    buffer_load_dword v51, v49, s[4:7], s22 offen sc1
    v_lshlrev_b32 v49, 13, v0
    v_and_b32 v49, 0x1fffff, v49
    s_mov_b32 s22, 67108864
    buffer_load_dword v52, v49, s[4:7], s22 offen sc1
    buffer_load_dword v57, v7, s[4:7], 0 offen sc1
    v_add_u32 v48, 32768, v46
    ds_read_b64_tr_b16 v[64:65], v48 offset:0
    ds_read_b64_tr_b16 v[66:67], v48 offset:512
    ds_read_b64_tr_b16 v[68:69], v48 offset:8192
    ds_read_b64_tr_b16 v[70:71], v48 offset:8704
    ds_read_b64_tr_b16 v[72:73], v48 offset:8
    ds_read_b64_tr_b16 v[74:75], v48 offset:520
    ds_read_b64_tr_b16 v[76:77], v48 offset:8200
    ds_read_b64_tr_b16 v[78:79], v48 offset:8712
    s_waitcnt lgkmcnt(0)
    s_barrier
    ds_write_b128 v32, v[64:67] offset:32768
    ds_write_b128 v32, v[68:71] offset:33792
    ds_write_b128 v32, v[72:75] offset:34816
    ds_write_b128 v32, v[76:79] offset:35840
    s_waitcnt lgkmcnt(0)
    s_waitcnt vmcnt(16)
    s_barrier
    v_add_u32 v48, 49152, v46
    ds_read_b64_tr_b16 v[64:65], v48 offset:0
    ds_read_b64_tr_b16 v[66:67], v48 offset:512
    ds_read_b64_tr_b16 v[68:69], v48 offset:8192
    ds_read_b64_tr_b16 v[70:71], v48 offset:8704
    ds_read_b64_tr_b16 v[72:73], v48 offset:8
    ds_read_b64_tr_b16 v[74:75], v48 offset:520
    ds_read_b64_tr_b16 v[76:77], v48 offset:8200
    ds_read_b64_tr_b16 v[78:79], v48 offset:8712
    s_waitcnt lgkmcnt(0)
    s_barrier
    ds_write_b128 v32, v[64:67] offset:49152
    ds_write_b128 v32, v[68:71] offset:50176
    ds_write_b128 v32, v[72:75] offset:51200
    ds_write_b128 v32, v[76:79] offset:52224
    s_waitcnt lgkmcnt(0)
    s_waitcnt vmcnt(12)
    s_barrier
    v_add_u32 v48, 65536, v46
    ds_read_b64_tr_b16 v[64:65], v48 offset:0
    ds_read_b64_tr_b16 v[66:67], v48 offset:512
    ds_read_b64_tr_b16 v[68:69], v48 offset:8192
    ds_read_b64_tr_b16 v[70:71], v48 offset:8704
    ds_read_b64_tr_b16 v[72:73], v48 offset:8
    ds_read_b64_tr_b16 v[74:75], v48 offset:520
    ds_read_b64_tr_b16 v[76:77], v48 offset:8200
    ds_read_b64_tr_b16 v[78:79], v48 offset:8712
    s_waitcnt lgkmcnt(0)
    s_barrier
    ds_write_b128 v33, v[64:67] offset:0
    ds_write_b128 v33, v[68:71] offset:1024
    ds_write_b128 v33, v[72:75] offset:2048
    ds_write_b128 v33, v[76:79] offset:3072
    s_waitcnt lgkmcnt(0)
    s_waitcnt vmcnt(8)
    s_barrier
    v_add_u32 v48, 81920, v46
    ds_read_b64_tr_b16 v[208:209], v48 offset:0
    ds_read_b64_tr_b16 v[210:211], v48 offset:512
    ds_read_b64_tr_b16 v[212:213], v48 offset:8192
    ds_read_b64_tr_b16 v[214:215], v48 offset:8704
    ds_read_b64_tr_b16 v[216:217], v48 offset:8
    ds_read_b64_tr_b16 v[218:219], v48 offset:520
    ds_read_b64_tr_b16 v[220:221], v48 offset:8200
    ds_read_b64_tr_b16 v[222:223], v48 offset:8712
    s_waitcnt lgkmcnt(0)
    s_barrier
    ds_write_b128 v33, v[80:83] offset:16384
    ds_write_b128 v33, v[84:87] offset:17408
    ds_write_b128 v33, v[88:91] offset:18432
    ds_write_b128 v33, v[92:95] offset:19456
    s_waitcnt lgkmcnt(0)
    s_waitcnt vmcnt(4)
    s_barrier
    v_add_u32 v48, 98304, v46
    ds_read_b64_tr_b16 v[224:225], v48 offset:0
    ds_read_b64_tr_b16 v[226:227], v48 offset:512
    ds_read_b64_tr_b16 v[228:229], v48 offset:8192
    ds_read_b64_tr_b16 v[230:231], v48 offset:8704
    ds_read_b64_tr_b16 v[232:233], v48 offset:8
    ds_read_b64_tr_b16 v[234:235], v48 offset:520
    ds_read_b64_tr_b16 v[236:237], v48 offset:8200
    ds_read_b64_tr_b16 v[238:239], v48 offset:8712
    s_waitcnt lgkmcnt(0)
    s_barrier
    ds_write_b128 v33, v[96:99] offset:32768
    ds_write_b128 v33, v[100:103] offset:33792
    ds_write_b128 v33, v[104:107] offset:34816
    ds_write_b128 v33, v[108:111] offset:35840
    s_waitcnt lgkmcnt(0)
    s_waitcnt vmcnt(0)
    s_barrier
    v_add_u32 v48, 114688, v46
    ds_read_b64_tr_b16 v[240:241], v48 offset:0
    ds_read_b64_tr_b16 v[242:243], v48 offset:512
    ds_read_b64_tr_b16 v[244:245], v48 offset:8192
    ds_read_b64_tr_b16 v[246:247], v48 offset:8704
    ds_read_b64_tr_b16 v[248:249], v48 offset:8
    ds_read_b64_tr_b16 v[250:251], v48 offset:520
    ds_read_b64_tr_b16 v[252:253], v48 offset:8200
    ds_read_b64_tr_b16 v[254:255], v48 offset:8712
    s_waitcnt lgkmcnt(0)
    s_barrier
    ds_write_b128 v33, v[112:115] offset:49152
    ds_write_b128 v33, v[116:119] offset:50176
    ds_write_b128 v33, v[120:123] offset:51200
    ds_write_b128 v33, v[124:127] offset:52224
    s_waitcnt lgkmcnt(0)
    s_branch mega_kernel_rf_iw1
mega_kernel_rf_iw:
    buffer_load_dword v58, off, s[12:15], 0 offset:204 sc1
    s_waitcnt vmcnt(0)
mega_kernel_rf_iw1:
    v_and_b32 v50, 0xffff, v58
    v_readfirstlane_b32 s60, v58
    v_cmp_ne_u32 vcc, s100, v50
    s_cbranch_vccnz mega_kernel_rf_iw
    s_lshr_b32 s60, s60, 15
    s_cmp_gt_u32 s60, s100
    s_cselect_b32 s60, 8192, 0
    s_bfe_u32 s22, s31, 0x10001
    s_lshl_b32 s22, s22, 12
    s_add_u32 s22, s22, s60
    s_lshl_b32 s23, s20, 10
    s_add_u32 s22, s22, s23
    s_add_u32 s38, s38, s22
    s_add_u32 s37, s37, s22
    s_xor_b32 s40, s38, 4096
    s_xor_b32 s39, s37, 4096
    s_xor_b32 s36, s35, 16384
    s_mov_b32 s21, 0
    s_cmp_eq_u32 s30, 0
    s_mov_b32 s22, 0x33003300
    s_cselect_b32 s16, 0x00330033, s22
    s_mov_b32 s17, s16
    s_cselect_b32 s18, -1, 0
    s_not_b32 s19, s18
    s_lshl_b32 s22, s31, 13
    s_lshl_b32 s23, s20, 11
    s_add_u32 s22, s22, s23
    s_add_u32 s43, s22, 16777216
    s_add_u32 s44, s22, 33554432
    s_lshl_b32 s45, s31, 13
    s_add_u32 s45, s45, 178257920
    s_mul_i32 s48, s20, 3072
    s_add_u32 m0, s48, 140288
    s_mov_b32 s41, 1
    s_mov_b32 s42, 1
    v_mov_b32 v0, v34
    v_bfrev_b32 v3, 1
    v_cndmask_b32 v10, v3, v10, s[16:17]
    v_cndmask_b32 v9, v3, v9, s[26:27]
    s_sub_u32 s45, s45, 262144
    s_lshl_b32 s51, s30, 11
    s_add_u32 s51, s51, s45
    s_mov_b32 s50, 0
    s_cmp_lg_u32 s20, 3
    s_cbranch_scc1 mega_kernel_rf_kv0
    v_readlane_b32 s50, v57, 0
    v_readlane_b32 s22, v57, 2
    v_readlane_b32 s23, v57, 1
    v_readlane_b32 s24, v57, 3
    s_nop 3
    s_min_u32 s50, s50, s22
    s_min_u32 s23, s23, s24
    s_lshl_b32 s50, s50, 1
    s_lshl_b32 s23, s23, 1
    s_add_u32 s23, s23, 1
    s_min_u32 s50, s50, s23
mega_kernel_rf_kvb0:
    s_add_u32 s22, s21, 0
    s_min_u32 s22, s22, 63
    s_cmp_gt_u32 s50, s22
    s_cbranch_scc1 mega_kernel_rf_kvd0
    buffer_load_dword v48, v7, s[4:7], 0 offen sc1
    s_waitcnt vmcnt(0)
    v_readlane_b32 s50, v48, 0
    v_readlane_b32 s22, v48, 2
    v_readlane_b32 s23, v48, 1
    v_readlane_b32 s24, v48, 3
    s_nop 3
    s_min_u32 s50, s50, s22
    s_min_u32 s23, s23, s24
    s_lshl_b32 s50, s50, 1
    s_lshl_b32 s23, s23, 1
    s_add_u32 s23, s23, 1
    s_min_u32 s50, s50, s23
    s_branch mega_kernel_rf_kvb0
mega_kernel_rf_kvd0:
mega_kernel_rf_kv0:
    s_barrier
    s_cmp_eq_u32 s20, 1
    s_cbranch_scc1 mega_kernel_rf_w1_entry
    s_cmp_eq_u32 s20, 2
    s_cbranch_scc1 mega_kernel_rf_w2_entry
    s_cmp_eq_u32 s20, 3
    s_cbranch_scc1 mega_kernel_rf_w3_entry
mega_kernel_rf_w0_entry:
    v_mfma_f32_32x32x8_bf16 v[96:111], v[14:15], v[14:15], 0
    v_mfma_f32_16x16x16_bf16 v[112:115], v[14:15], v[14:15], 0
    v_mfma_f32_16x16x16_bf16 v[116:119], v[14:15], v[14:15], 0
    ds_read_b128 v[64:67], v1 offset:0
    ds_read_b128 v[68:71], v1 offset:1024
    ds_read_b128 v[72:75], v1 offset:2048
    ds_read_b128 v[76:79], v1 offset:3072
    ds_read_b128 v[80:83], v1 offset:16384
    ds_read_b128 v[84:87], v1 offset:17408
    ds_read_b128 v[88:91], v1 offset:18432
    ds_read_b128 v[92:95], v1 offset:19456
    buffer_load_dwordx4 v[120:123], v1, s[4:7], s44 offen
    buffer_load_dwordx4 v[124:127], v1, s[4:7], s44 offen offset:1024
    s_add_u32 s44, s44, 262144
mega_kernel_rf_w0_loop:
    s_add_u32 s22, s35, 0
    s_waitcnt vmcnt(0)
    buffer_load_dwordx4 v[32:35], v12, s[4:7], s22 offen sc1
    buffer_load_dwordx4 v[36:39], v12, s[4:7], s22 offen offset:1024 sc1
mega_kernel_rf_w0_pa:
    s_waitcnt vmcnt(1)
    ds_write_b128 v6, v[32:35] offset:0
    s_waitcnt vmcnt(0)
    ds_write_b128 v6, v[36:39] offset:1024
    v_max3_u32 v3, v32, v34, v36
    v_max_u32 v3, v3, v38
    v_cmp_eq_u32 vcc, -1, v3
    v_smfmac_f32_16x16x64_bf16 v[96:99], v[32:35], a[0:7], v2
    v_smfmac_f32_16x16x64_bf16 v[100:103], v[32:35], a[8:15], v2
    v_smfmac_f32_16x16x64_bf16 v[104:107], v[32:35], a[128:135], v2
    s_cbranch_vccnz mega_kernel_rf_w0_pafail
    s_waitcnt lgkmcnt(0)
    s_barrier
    ds_read_b128 v[40:43], v6 offset:2048
    ds_read_b128 v[44:47], v6 offset:3072
    v_smfmac_f32_16x16x64_bf16 v[108:111], v[32:35], a[136:143], v2
    ds_read_b128 v[48:51], v6 offset:4096
    v_smfmac_f32_16x16x64_bf16 v[96:99], v[36:39], a[16:23], v2
    ds_read_b128 v[52:55], v6 offset:5120
    v_smfmac_f32_16x16x64_bf16 v[100:103], v[36:39], a[24:31], v2
    ds_read_b128 v[56:59], v6 offset:6144
    v_smfmac_f32_16x16x64_bf16 v[104:107], v[36:39], a[144:151], v2
    ds_read_b128 v[60:63], v6 offset:7168
    v_smfmac_f32_16x16x64_bf16 v[108:111], v[36:39], a[152:159], v2
    buffer_load_dwordx4 v1, s[4:7], s43 offen lds
    s_waitcnt lgkmcnt(5)
    v_smfmac_f32_16x16x64_bf16 v[96:99], v[40:43], a[32:39], v2
    v_smfmac_f32_16x16x64_bf16 v[100:103], v[40:43], a[40:47], v2
    v_smfmac_f32_16x16x64_bf16 v[104:107], v[40:43], a[160:167], v2
    v_smfmac_f32_16x16x64_bf16 v[108:111], v[40:43], a[168:175], v2
    buffer_load_dwordx4 v1, s[4:7], s43 offen offset:1024 lds
    s_waitcnt lgkmcnt(4)
    v_smfmac_f32_16x16x64_bf16 v[96:99], v[44:47], a[48:55], v2
    v_smfmac_f32_16x16x64_bf16 v[100:103], v[44:47], a[56:63], v2
    v_smfmac_f32_16x16x64_bf16 v[104:107], v[44:47], a[176:183], v2
    v_smfmac_f32_16x16x64_bf16 v[108:111], v[44:47], a[184:191], v2
    buffer_store_dwordx4 v[20:23], v10, s[4:7], s45 offen offset:0 sc1
    s_waitcnt lgkmcnt(3)
    v_smfmac_f32_16x16x64_bf16 v[96:99], v[48:51], a[64:71], v2
    v_smfmac_f32_16x16x64_bf16 v[100:103], v[48:51], a[72:79], v2
    v_smfmac_f32_16x16x64_bf16 v[104:107], v[48:51], a[192:199], v2
    v_smfmac_f32_16x16x64_bf16 v[108:111], v[48:51], a[200:207], v2
    buffer_store_dwordx2 v[18:19], v11, s[4:7], s51 offen offset:2048 sc1
    s_waitcnt lgkmcnt(2)
    v_smfmac_f32_16x16x64_bf16 v[96:99], v[52:55], a[80:87], v2
    v_smfmac_f32_16x16x64_bf16 v[100:103], v[52:55], a[88:95], v2
    v_smfmac_f32_16x16x64_bf16 v[104:107], v[52:55], a[208:215], v2
    v_smfmac_f32_16x16x64_bf16 v[108:111], v[52:55], a[216:223], v2
    s_waitcnt lgkmcnt(1)
    v_smfmac_f32_16x16x64_bf16 v[96:99], v[56:59], a[96:103], v2
    v_smfmac_f32_16x16x64_bf16 v[100:103], v[56:59], a[104:111], v2
    v_smfmac_f32_16x16x64_bf16 v[104:107], v[56:59], a[224:231], v2
    v_smfmac_f32_16x16x64_bf16 v[108:111], v[56:59], a[232:239], v2
    s_waitcnt lgkmcnt(0)
    v_smfmac_f32_16x16x64_bf16 v[96:99], v[60:63], a[112:119], v2
    v_smfmac_f32_16x16x64_bf16 v[100:103], v[60:63], a[120:127], v2
    v_smfmac_f32_16x16x64_bf16 v[104:107], v[60:63], a[240:247], v2
    v_smfmac_f32_16x16x64_bf16 v[108:111], v[60:63], a[248:255], v2
    s_nop 4
    v_pk_add_f32 v[96:97], v[96:97], v[98:99]
    v_pk_add_f32 v[100:101], v[100:101], v[102:103]
    v_pk_add_f32 v[104:105], v[104:105], v[106:107]
    v_pk_add_f32 v[108:109], v[108:109], v[110:111]
    v_cvt_pk_bf16_f32 v111, v108, v109
    v_cvt_pk_bf16_f32 v108, v96, v97
    v_cvt_pk_bf16_f32 v110, v100, v101
    v_cvt_pk_bf16_f32 v109, v104, v105
    v_and_or_b32 v108, v108, -2, s41
    buffer_store_dwordx4 v[108:111], v1, s[4:7], s37 offen sc1
    v_smfmac_f32_16x16x64_bf16 v[112:115], v[32:35], v[64:71], v2
    ds_read_b128 v[64:67], v1 offset:32768
    ds_read_b128 v[68:71], v1 offset:33792
    v_smfmac_f32_16x16x64_bf16 v[116:119], v[32:35], v[72:79], v2
    ds_read_b128 v[72:75], v1 offset:34816
    ds_read_b128 v[76:79], v1 offset:35840
    v_smfmac_f32_16x16x64_bf16 v[112:115], v[36:39], v[80:87], v2
    ds_read_b128 v[80:83], v1 offset:49152
    ds_read_b128 v[84:87], v1 offset:50176
    v_smfmac_f32_16x16x64_bf16 v[116:119], v[36:39], v[88:95], v2
    ds_read_b128 v[88:91], v1 offset:51200
    ds_read_b128 v[92:95], v1 offset:52224
    v_smfmac_f32_16x16x64_bf16 v[112:115], v[52:55], v[208:215], v2
    v_smfmac_f32_16x16x64_bf16 v[116:119], v[52:55], v[216:223], v2
    v_smfmac_f32_16x16x64_bf16 v[112:115], v[56:59], v[224:231], v2
    s_waitcnt lgkmcnt(6)
    v_smfmac_f32_16x16x64_bf16 v[112:115], v[40:43], v[64:71], v2
    ds_read_b128 v[64:67], v5 offset:0
    ds_read_b128 v[68:71], v5 offset:1024
    s_waitcnt lgkmcnt(6)
    v_smfmac_f32_16x16x64_bf16 v[116:119], v[40:43], v[72:79], v2
    ds_read_b128 v[72:75], v5 offset:2048
    ds_read_b128 v[76:79], v5 offset:3072
    v_smfmac_f32_16x16x64_bf16 v[116:119], v[56:59], v[232:239], v2
    v_smfmac_f32_16x16x64_bf16 v[112:115], v[60:63], v[240:247], v2
    v_smfmac_f32_16x16x64_bf16 v[116:119], v[60:63], v[248:255], v2
    s_waitcnt lgkmcnt(6)
    v_smfmac_f32_16x16x64_bf16 v[112:115], v[44:47], v[80:87], v2
    s_waitcnt lgkmcnt(4)
    v_smfmac_f32_16x16x64_bf16 v[116:119], v[44:47], v[88:95], v2
    s_waitcnt lgkmcnt(2)
    v_smfmac_f32_16x16x64_bf16 v[112:115], v[48:51], v[64:71], v2
    s_waitcnt lgkmcnt(0)
    v_smfmac_f32_16x16x64_bf16 v[116:119], v[48:51], v[72:79], v2
    v_mfma_f32_16x16x16_bf16 v[100:103], v[108:109], v[16:17], 0
    v_mfma_f32_16x16x16_bf16 v[104:107], v[110:111], v[16:17], 0
    s_nop 4
    v_add_f32 v112, v112, v114
    v_add_f32 v113, v113, v115
    v_add_f32 v114, v116, v118
    v_add_f32 v115, v117, v119
    v_cvt_pk_bf16_f32 v18, v112, v113
    v_cvt_pk_bf16_f32 v19, v114, v115
    v_and_or_b32 v18, v18, -2, s41
    v_mov_b32 v112, v18
    v_mov_b32 v114, v19
    v_mov_b32 v92, v28
    v_mov_b32 v93, 0
    s_waitcnt vmcnt(3)
    s_barrier
    ds_read_b128 v[32:35], v6 offset:9216
    ds_read_b128 v[36:39], v6 offset:10240
    ds_read_b128 v[40:43], v6 offset:12288
    ds_read_b128 v[44:47], v6 offset:13312
    ds_read_b128 v[48:51], v6 offset:15360
    ds_read_b128 v[52:55], v6 offset:16384
    ds_read_b128 v[56:59], v6 offset:18432
    ds_read_b128 v[60:63], v6 offset:19456
    buffer_load_dwordx4 v[96:99], v1, s[4:7], s38 offen sc1
    s_barrier
    buffer_store_dwordx2 v[18:19], v11, s[4:7], s39 offen sc1
    s_nop 15
    s_nop 15
    buffer_load_dwordx4 v[20:23], v1, s[4:7], s38 offen sc1
    s_waitcnt vmcnt(2)
    v_mfma_f32_16x16x16_bf16 v[80:83], v[96:97], v[16:17], v[100:103]
    v_mfma_f32_16x16x16_bf16 v[84:87], v[98:99], v[16:17], v[104:107]
    v_and_b32 v3, 1, v96
    v_cmp_ne_u32 vcc, s41, v3
    s_nop 4
    v_cvt_pk_bf16_f32 v64, v80, v81
    v_cvt_pk_bf16_f32 v65, v82, v83
    v_cvt_pk_bf16_f32 v66, v84, v85
    v_cvt_pk_bf16_f32 v67, v86, v87
    ds_write_b128 v6, v[64:67] offset:8192
    s_cbranch_vccnz mega_kernel_rf_w0_xslow
mega_kernel_rf_w0_xok:
    buffer_load_dwordx2 v[116:117], v11, s[4:7], s40 offen sc1
    s_waitcnt lgkmcnt(1)
    v_mfma_f32_16x16x32_bf16 v[80:83], v[32:35], v[64:67], 0
    s_waitcnt lgkmcnt(0)
    s_barrier
    ds_read_b128 v[68:71], v6 offset:11264
    ds_read_b128 v[72:75], v6 offset:14336
    ds_read_b128 v[76:79], v6 offset:17408
    v_mfma_f32_16x16x32_bf16 v[84:87], v[36:39], v[64:67], 0
    v_mfma_f32_16x16x32_bf16 v[88:91], v[64:67], v[64:67], 0
    buffer_load_dwordx2 v[20:21], v11, s[4:7], s40 offen sc1
    s_waitcnt lgkmcnt(2)
    v_mfma_f32_16x16x32_bf16 v[80:83], v[40:43], v[68:71], v[80:83]
    v_mfma_f32_16x16x32_bf16 v[84:87], v[44:47], v[68:71], v[84:87]
    v_mfma_f32_16x16x32_bf16 v[88:91], v[68:71], v[68:71], v[88:91]
    s_waitcnt lgkmcnt(1)
    v_mfma_f32_16x16x32_bf16 v[80:83], v[48:51], v[72:75], v[80:83]
    v_mfma_f32_16x16x32_bf16 v[84:87], v[52:55], v[72:75], v[84:87]
    v_mfma_f32_16x16x32_bf16 v[88:91], v[72:75], v[72:75], v[88:91]
    s_waitcnt lgkmcnt(0)
    v_mfma_f32_16x16x32_bf16 v[80:83], v[56:59], v[76:79], v[80:83]
    v_mfma_f32_16x16x32_bf16 v[84:87], v[60:63], v[76:79], v[84:87]
    v_mfma_f32_16x16x32_bf16 v[88:91], v[76:79], v[76:79], v[88:91]
    v_mfma_f32_32x32x4_2b_bf16 v[32:63], v[14:15], v[14:15], 0
    s_nop 4
    v_max3_f32 v4, v80, v81, v82
    v_max3_f32 v4, v4, v83, v84
    v_max3_f32 v4, v4, v85, v86
    v_max3_f32 v4, v4, v87, v88
    v_max_f32 v90, v4, v89
    v_max_f32 v4, v4, v89
    s_nop 0
    s_nop 0
    v_permlane16_swap_b32 v4, v90
    v_max_f32 v4, v4, v90
    v_max_f32 v90, v4, v90
    s_nop 1
    v_permlane32_swap_b32 v4, v90
    v_max_f32 v4, v4, v90
    v_mul_f32 v4, s34, v4
    v_pk_fma_f32 v[80:81], v[80:81], s[34:35], v[4:5] op_sel_hi:[1,0,0] neg_lo:[0,0,1] neg_hi:[0,0,1]
    v_pk_fma_f32 v[82:83], v[82:83], s[34:35], v[4:5] op_sel_hi:[1,0,0] neg_lo:[0,0,1] neg_hi:[0,0,1]
    v_pk_fma_f32 v[84:85], v[84:85], s[34:35], v[4:5] op_sel_hi:[1,0,0] neg_lo:[0,0,1] neg_hi:[0,0,1]
    v_pk_fma_f32 v[86:87], v[86:87], s[34:35], v[4:5] op_sel_hi:[1,0,0] neg_lo:[0,0,1] neg_hi:[0,0,1]
    v_pk_fma_f32 v[88:89], v[88:89], s[34:35], v[4:5] op_sel_hi:[1,0,0] neg_lo:[0,0,1] neg_hi:[0,0,1]
    v_exp_f32 v80, v80
    v_exp_f32 v81, v81
    v_exp_f32 v82, v82
    v_cvt_pk_bf16_f32 v68, v80, v81
    v_exp_f32 v83, v83
    v_exp_f32 v84, v84
    v_cvt_pk_bf16_f32 v69, v82, v83
    v_exp_f32 v85, v85
    v_exp_f32 v86, v86
    v_cvt_pk_bf16_f32 v70, v84, v85
    v_exp_f32 v87, v87
    v_exp_f32 v88, v88
    v_cvt_pk_bf16_f32 v71, v86, v87
    v_exp_f32 v89, v89
    s_cmp_eq_u32 s21, 63
    v_mfma_f32_16x16x32_bf16 v[76:79], v[28:31], v[68:71], 0
    v_cvt_pk_bf16_f32 v72, v88, v89
    v_cvt_pk_bf16_f32 v73, v88, v89
    v_mfma_f32_16x16x32_bf16 v[100:103], v[120:123], v[68:71], 0
    s_waitcnt vmcnt(1)
    v_and_b32 v3, 1, v116
    v_cmp_ne_u32 vcc, s41, v3
    v_mfma_f32_16x16x32_bf16 v[104:107], v[124:127], v[68:71], 0
    v_mov_b32 v113, v116
    v_mov_b32 v115, v117
    v_mfma_f32_16x16x16_bf16 v[76:79], v[92:93], v[72:73], v[76:79]
    s_cbranch_vccnz mega_kernel_rf_w0_pv0
mega_kernel_rf_w0_pv2:
    v_mfma_f32_16x16x16_bf16 v[100:103], v[112:113], v[72:73], v[100:103]
    v_mfma_f32_16x16x16_bf16 v[104:107], v[114:115], v[72:73], v[104:107]
    buffer_load_dwordx4 v[120:123], v1, s[4:7], s44 offen
    buffer_load_dwordx4 v[124:127], v1, s[4:7], s44 offen offset:1024
    s_cmp_eq_u32 s21, 63
    s_nop 1
    v_rcp_f32 v76, v76
    s_cbranch_scc1 mega_kernel_rf_w0_last
    s_mov_b64 exec, s[28:29]
    v_pk_mul_f32 v[100:101], v[100:101], v[76:77] op_sel_hi:[1,0]
    v_pk_mul_f32 v[102:103], v[102:103], v[76:77] op_sel_hi:[1,0]
    v_pk_mul_f32 v[104:105], v[104:105], v[76:77] op_sel_hi:[1,0]
    v_pk_mul_f32 v[106:107], v[106:107], v[76:77] op_sel_hi:[1,0]
    v_cvt_pk_bf16_f32 v72, v100, v101
    v_cvt_pk_bf16_f32 v73, v102, v103
    v_cvt_pk_bf16_f32 v74, v104, v105
    v_cvt_pk_bf16_f32 v75, v106, v107
    ds_write_b128 v6, v[72:75] offset:20448
    s_mov_b64 exec, -1
    ds_read_b128 v[88:91], v5 offset:16384
    ds_read_b128 v[92:95], v5 offset:17408
    ds_read_b128 v[80:83], v5 offset:18432
    ds_read_b128 v[84:87], v5 offset:19456
    ds_read_b128 v[112:115], v5 offset:32768
    ds_read_b128 v[116:119], v5 offset:33792
    v_mov_b32 v3, s21
    buffer_store_dword v3, v7, s[4:7], 0 offen sc1
    s_waitcnt lgkmcnt(6)
    s_barrier
    ds_read_b128 v[68:71], v6 offset:20480
    ds_read_b128 v[72:75], v6 offset:21504
    ds_read_b128 v[96:99], v5 offset:34816
    ds_read_b128 v[100:103], v5 offset:35840
    ds_read_b128 v[104:107], v5 offset:49152
    ds_read_b128 v[108:111], v5 offset:50176
    s_waitcnt lgkmcnt(5)
    v_smfmac_f32_16x16x64_bf16 v[32:35], v[68:71], v[128:135], v2
    s_add_u32 s21, s21, 1
    v_smfmac_f32_16x16x64_bf16 v[36:39], v[68:71], v[136:143], v2
    s_xor_b32 s38, s38, 1048576
    v_smfmac_f32_16x16x64_bf16 v[40:43], v[68:71], v[144:151], v2
    s_xor_b32 s37, s37, 1048576
    v_smfmac_f32_16x16x64_bf16 v[44:47], v[68:71], v[152:159], v2
    s_xor_b32 s40, s40, 1048576
    s_waitcnt lgkmcnt(4)
    v_smfmac_f32_16x16x64_bf16 v[32:35], v[72:75], v[160:167], v2
    s_xor_b32 s39, s39, 1048576
    v_smfmac_f32_16x16x64_bf16 v[36:39], v[72:75], v[168:175], v2
    s_lshr_b32 s41, s21, 1
    v_smfmac_f32_16x16x64_bf16 v[40:43], v[72:75], v[176:183], v2
    s_and_b32 s41, s41, 1
    v_smfmac_f32_16x16x64_bf16 v[44:47], v[72:75], v[184:191], v2
    s_xor_b32 s41, s41, 1
    v_smfmac_f32_16x16x64_bf16 v[48:51], v[68:71], v[192:199], v2
    s_xor_b32 s35, s35, 16384
    v_smfmac_f32_16x16x64_bf16 v[52:55], v[68:71], v[200:207], v2
    s_xor_b32 s36, s36, 16384
    s_waitcnt lgkmcnt(0)
    v_smfmac_f32_16x16x64_bf16 v[56:59], v[68:71], v[88:95], v2
    ds_read_b128 v[88:91], v5 offset:51200
    ds_read_b128 v[92:95], v5 offset:52224
    v_smfmac_f32_16x16x64_bf16 v[60:63], v[68:71], v[80:87], v2
    s_add_u32 s43, s43, 262144
    v_smfmac_f32_16x16x64_bf16 v[48:51], v[72:75], v[112:119], v2
    s_add_u32 s44, s44, 262144
    v_add_f32 v32, v32, v34
    v_add_f32 v33, v33, v35
    v_cvt_pk_bf16_f32 v32, v32, v33
    v_and_or_b32 v32, v32, -2, s42
    v_smfmac_f32_16x16x64_bf16 v[52:55], v[72:75], v[96:103], v2
    v_add_f32 v36, v36, v38
    v_add_f32 v37, v37, v39
    v_cvt_pk_bf16_f32 v33, v36, v37
    v_smfmac_f32_16x16x64_bf16 v[56:59], v[72:75], v[104:111], v2
    v_add_f32 v40, v40, v42
    v_add_f32 v41, v41, v43
    v_cvt_pk_bf16_f32 v34, v40, v41
    s_waitcnt lgkmcnt(0)
    v_smfmac_f32_16x16x64_bf16 v[60:63], v[72:75], v[88:95], v2
    v_add_f32 v44, v44, v46
    v_add_f32 v45, v45, v47
    v_cvt_pk_bf16_f32 v35, v44, v45
    buffer_store_dwordx4 v[32:35], v8, s[4:7], s46 offen
    v_pk_add_f32 v[48:49], v[48:49], v[50:51]
    v_cvt_pk_bf16_f32 v48, v48, v49
    v_and_or_b32 v48, v48, -2, s42
    v_pk_add_f32 v[52:53], v[52:53], v[54:55]
    v_cvt_pk_bf16_f32 v49, v52, v53
    v_pk_add_f32 v[56:57], v[56:57], v[58:59]
    v_cvt_pk_bf16_f32 v50, v56, v57
    v_pk_add_f32 v[60:61], v[60:61], v[62:63]
    v_cvt_pk_bf16_f32 v51, v60, v61
    buffer_store_dwordx4 v[48:51], v8, s[4:7], s61 offen
    s_waitcnt vmcnt(5)
    v_mov_b32 v20, v64
    v_mov_b32 v21, v65
    v_mov_b32 v22, v66
    v_mov_b32 v23, v67
    s_add_u32 s45, s45, 262144
    s_add_u32 s51, s51, 262144
    v_mfma_f32_32x32x8_bf16 v[96:111], v[14:15], v[14:15], 0
    v_mfma_f32_16x16x16_bf16 v[112:115], v[14:15], v[14:15], 0
    v_mfma_f32_16x16x16_bf16 v[116:119], v[14:15], v[14:15], 0
    ds_read_b128 v[64:67], v1 offset:0
    ds_read_b128 v[68:71], v1 offset:1024
    ds_read_b128 v[72:75], v1 offset:2048
    ds_read_b128 v[76:79], v1 offset:3072
    ds_read_b128 v[80:83], v1 offset:16384
    ds_read_b128 v[84:87], v1 offset:17408
    ds_read_b128 v[88:91], v1 offset:18432
    ds_read_b128 v[92:95], v1 offset:19456
    v_mov_b32 v58, -1
    v_mov_b32 v59, -1
    s_waitcnt vmcnt(0)
mega_kernel_rf_w0_pc:
    buffer_load_dword v36, v13, s[4:7], s47 offen offset:0 sc1
    buffer_load_dword v37, v13, s[4:7], s47 offen offset:1024 sc1
    buffer_load_dword v38, v13, s[4:7], s47 offen offset:2048 sc1
    buffer_load_dword v39, v13, s[4:7], s47 offen offset:3072 sc1
    buffer_load_dword v40, v13, s[4:7], s25 offen offset:0 sc1
    buffer_load_dword v41, v13, s[4:7], s25 offen offset:1024 sc1
    buffer_load_dword v42, v13, s[4:7], s25 offen offset:2048 sc1
    buffer_load_dword v43, v13, s[4:7], s25 offen offset:3072 sc1
    s_waitcnt vmcnt(4)
    v_mfma_f32_16x16x32_bf16 v[52:55], v[36:39], v[24:27], 0
    v_bitop3_b32 v3, s42, v36, v37 bitop3:0x7e
    v_bitop3_b32 v4, s42, v38, v39 bitop3:0x7e
    s_waitcnt vmcnt(2)
    v_or_b32 v3, v3, v4
    v_bitop3_b32 v4, s42, v40, v41 bitop3:0x7e
    s_waitcnt vmcnt(0)
    v_mfma_f32_16x16x32_bf16 v[52:55], v[40:43], v[24:27], v[52:55]
    v_bitop3_b32 v56, s42, v42, v43 bitop3:0x7e
    v_or3_b32 v3, v3, v4, v56
    v_and_b32 v3, v0, v3
    v_cmp_ne_u32 vcc, 0, v3
    s_cbranch_vccnz mega_kernel_rf_w0_pc
    s_nop 2
    v_cvt_pk_bf16_f32 v56, v52, v53
    v_cvt_pk_bf16_f32 v57, v54, v55
    v_min_u32 v56, -2, v56
    s_mov_b64 exec, s[26:27]
    buffer_store_dwordx2 v[56:57], v9, s[4:7], s35 offen offset:0
    buffer_store_dwordx2 v[58:59], v9, s[4:7], s36 offen offset:0
    s_mov_b64 exec, -1
    s_xor_b32 s42, s42, 1
    s_branch mega_kernel_rf_w0_loop
mega_kernel_rf_w0_last:
    s_waitcnt vmcnt(0)
    v_mov_b32 v20, v64
    v_mov_b32 v21, v65
    v_mov_b32 v22, v66
    v_mov_b32 v23, v67
    s_add_u32 s45, s45, 262144
    s_add_u32 s51, s51, 262144
    buffer_store_dwordx4 v[20:23], v10, s[4:7], s45 offen offset:0 sc1
    buffer_store_dwordx2 v[18:19], v11, s[4:7], s51 offen offset:2048 sc1
    s_branch mega_kernel_rf_end
mega_kernel_rf_w0_pafail:
    buffer_load_dwordx4 v[32:35], v12, s[4:7], s22 offen sc1
    buffer_load_dwordx4 v[36:39], v12, s[4:7], s22 offen offset:1024 sc1
    s_nop 7
    v_mov_b32 v96, 0
    v_mov_b32 v97, 0
    v_mov_b32 v98, 0
    v_mov_b32 v99, 0
    v_mov_b32 v100, 0
    v_mov_b32 v101, 0
    v_mov_b32 v102, 0
    v_mov_b32 v103, 0
    v_mov_b32 v104, 0
    v_mov_b32 v105, 0
    v_mov_b32 v106, 0
    v_mov_b32 v107, 0
    s_branch mega_kernel_rf_w0_pa
mega_kernel_rf_w0_xslow:
    buffer_load_dwordx4 v[96:99], v1, s[4:7], s38 offen sc1
    s_waitcnt vmcnt(1)
    v_and_b32 v3, 1, v20
    v_cmp_ne_u32 vcc, s41, v3
    s_cbranch_vccz mega_kernel_rf_w0_xgot1
    buffer_load_dwordx4 v[20:23], v1, s[4:7], s38 offen sc1
mega_kernel_rf_w0_px:
    s_waitcnt vmcnt(1)
    v_and_b32 v3, 1, v96
    v_cmp_ne_u32 vcc, s41, v3
    s_cbranch_vccz mega_kernel_rf_w0_xgot0
    buffer_load_dwordx4 v[96:99], v1, s[4:7], s38 offen sc1
    s_waitcnt vmcnt(1)
    v_and_b32 v3, 1, v20
    v_cmp_ne_u32 vcc, s41, v3
    s_cbranch_vccz mega_kernel_rf_w0_xgot1
    buffer_load_dwordx4 v[20:23], v1, s[4:7], s38 offen sc1
    s_branch mega_kernel_rf_w0_px
mega_kernel_rf_w0_xgot0:
    v_mfma_f32_16x16x16_bf16 v[80:83], v[96:97], v[16:17], v[100:103]
    v_mfma_f32_16x16x16_bf16 v[84:87], v[98:99], v[16:17], v[104:107]
    v_and_b32 v3, 1, v96
    v_cmp_ne_u32 vcc, s41, v3
    s_nop 4
    v_cvt_pk_bf16_f32 v64, v80, v81
    v_cvt_pk_bf16_f32 v65, v82, v83
    v_cvt_pk_bf16_f32 v66, v84, v85
    v_cvt_pk_bf16_f32 v67, v86, v87
    ds_write_b128 v6, v[64:67] offset:8192
    s_branch mega_kernel_rf_w0_xok
mega_kernel_rf_w0_xgot1:
    v_mfma_f32_16x16x16_bf16 v[80:83], v[20:21], v[16:17], v[100:103]
    v_mfma_f32_16x16x16_bf16 v[84:87], v[22:23], v[16:17], v[104:107]
    v_and_b32 v3, 1, v20
    v_cmp_ne_u32 vcc, s41, v3
    s_nop 4
    v_cvt_pk_bf16_f32 v64, v80, v81
    v_cvt_pk_bf16_f32 v65, v82, v83
    v_cvt_pk_bf16_f32 v66, v84, v85
    v_cvt_pk_bf16_f32 v67, v86, v87
    ds_write_b128 v6, v[64:67] offset:8192
    s_branch mega_kernel_rf_w0_xok
mega_kernel_rf_w0_pv0:
    s_waitcnt vmcnt(0)
    s_branch mega_kernel_rf_w0_pv1
mega_kernel_rf_w0_pv:
    buffer_load_dwordx2 v[20:21], v11, s[4:7], s40 offen sc1
    s_waitcnt vmcnt(0)
mega_kernel_rf_w0_pv1:
    v_and_b32 v3, 1, v20
    v_cmp_ne_u32 vcc, s41, v3
    v_mov_b32 v113, v20
    v_mov_b32 v115, v21
    s_cbranch_vccnz mega_kernel_rf_w0_pv
    s_branch mega_kernel_rf_w0_pv2
mega_kernel_rf_w1_entry:
    v_mfma_f32_32x32x8_bf16 v[96:111], v[14:15], v[14:15], 0
    v_mfma_f32_16x16x16_bf16 v[112:115], v[14:15], v[14:15], 0
    v_mfma_f32_16x16x16_bf16 v[116:119], v[14:15], v[14:15], 0
    ds_read_b128 v[64:67], v1 offset:4096
    ds_read_b128 v[68:71], v1 offset:5120
    ds_read_b128 v[72:75], v1 offset:6144
    ds_read_b128 v[76:79], v1 offset:7168
    ds_read_b128 v[80:83], v1 offset:20480
    ds_read_b128 v[84:87], v1 offset:21504
    ds_read_b128 v[88:91], v1 offset:22528
    ds_read_b128 v[92:95], v1 offset:23552
    buffer_load_dwordx4 v[120:123], v1, s[4:7], s44 offen
    buffer_load_dwordx4 v[124:127], v1, s[4:7], s44 offen offset:1024
    s_add_u32 s44, s44, 262144
mega_kernel_rf_w1_loop:
    s_add_u32 s22, s35, 2048
    s_waitcnt vmcnt(0)
    buffer_load_dwordx4 v[40:43], v12, s[4:7], s22 offen sc1
    buffer_load_dwordx4 v[44:47], v12, s[4:7], s22 offen offset:1024 sc1
mega_kernel_rf_w1_pa:
    s_waitcnt vmcnt(1)
    ds_write_b128 v6, v[40:43] offset:2048
    s_waitcnt vmcnt(0)
    ds_write_b128 v6, v[44:47] offset:3072
    v_max3_u32 v3, v40, v42, v44
    v_max_u32 v3, v3, v46
    v_cmp_eq_u32 vcc, -1, v3
    v_smfmac_f32_16x16x64_bf16 v[96:99], v[40:43], a[32:39], v2
    v_smfmac_f32_16x16x64_bf16 v[100:103], v[40:43], a[40:47], v2
    v_smfmac_f32_16x16x64_bf16 v[104:107], v[40:43], a[160:167], v2
    s_cbranch_vccnz mega_kernel_rf_w1_pafail
    s_waitcnt lgkmcnt(0)
    s_barrier
    ds_read_b128 v[48:51], v6 offset:4096
    ds_read_b128 v[52:55], v6 offset:5120
    v_smfmac_f32_16x16x64_bf16 v[108:111], v[40:43], a[168:175], v2
    ds_read_b128 v[56:59], v6 offset:6144
    v_smfmac_f32_16x16x64_bf16 v[96:99], v[44:47], a[48:55], v2
    ds_read_b128 v[60:63], v6 offset:7168
    v_smfmac_f32_16x16x64_bf16 v[100:103], v[44:47], a[56:63], v2
    ds_read_b128 v[32:35], v6 offset:0
    v_smfmac_f32_16x16x64_bf16 v[104:107], v[44:47], a[176:183], v2
    ds_read_b128 v[36:39], v6 offset:1024
    v_smfmac_f32_16x16x64_bf16 v[108:111], v[44:47], a[184:191], v2
    buffer_load_dwordx4 v1, s[4:7], s43 offen lds
    s_waitcnt lgkmcnt(5)
    v_smfmac_f32_16x16x64_bf16 v[96:99], v[48:51], a[64:71], v2
    v_smfmac_f32_16x16x64_bf16 v[100:103], v[48:51], a[72:79], v2
    v_smfmac_f32_16x16x64_bf16 v[104:107], v[48:51], a[192:199], v2
    v_smfmac_f32_16x16x64_bf16 v[108:111], v[48:51], a[200:207], v2
    buffer_load_dwordx4 v1, s[4:7], s43 offen offset:1024 lds
    s_waitcnt lgkmcnt(4)
    v_smfmac_f32_16x16x64_bf16 v[96:99], v[52:55], a[80:87], v2
    v_smfmac_f32_16x16x64_bf16 v[100:103], v[52:55], a[88:95], v2
    v_smfmac_f32_16x16x64_bf16 v[104:107], v[52:55], a[208:215], v2
    v_smfmac_f32_16x16x64_bf16 v[108:111], v[52:55], a[216:223], v2
    buffer_store_dwordx4 v[20:23], v10, s[4:7], s45 offen offset:64 sc1
    s_waitcnt lgkmcnt(3)
    v_smfmac_f32_16x16x64_bf16 v[96:99], v[56:59], a[96:103], v2
    v_smfmac_f32_16x16x64_bf16 v[100:103], v[56:59], a[104:111], v2
    v_smfmac_f32_16x16x64_bf16 v[104:107], v[56:59], a[224:231], v2
    v_smfmac_f32_16x16x64_bf16 v[108:111], v[56:59], a[232:239], v2
    buffer_store_dwordx2 v[18:19], v11, s[4:7], s51 offen offset:2560 sc1
    s_waitcnt lgkmcnt(2)
    v_smfmac_f32_16x16x64_bf16 v[96:99], v[60:63], a[112:119], v2
    v_smfmac_f32_16x16x64_bf16 v[100:103], v[60:63], a[120:127], v2
    v_smfmac_f32_16x16x64_bf16 v[104:107], v[60:63], a[240:247], v2
    v_smfmac_f32_16x16x64_bf16 v[108:111], v[60:63], a[248:255], v2
    s_waitcnt lgkmcnt(1)
    v_smfmac_f32_16x16x64_bf16 v[96:99], v[32:35], a[0:7], v2
    v_smfmac_f32_16x16x64_bf16 v[100:103], v[32:35], a[8:15], v2
    v_smfmac_f32_16x16x64_bf16 v[104:107], v[32:35], a[128:135], v2
    v_smfmac_f32_16x16x64_bf16 v[108:111], v[32:35], a[136:143], v2
    s_waitcnt lgkmcnt(0)
    v_smfmac_f32_16x16x64_bf16 v[96:99], v[36:39], a[16:23], v2
    v_smfmac_f32_16x16x64_bf16 v[100:103], v[36:39], a[24:31], v2
    v_smfmac_f32_16x16x64_bf16 v[104:107], v[36:39], a[144:151], v2
    v_smfmac_f32_16x16x64_bf16 v[108:111], v[36:39], a[152:159], v2
    s_nop 4
    v_pk_add_f32 v[96:97], v[96:97], v[98:99]
    v_pk_add_f32 v[100:101], v[100:101], v[102:103]
    v_pk_add_f32 v[104:105], v[104:105], v[106:107]
    v_pk_add_f32 v[108:109], v[108:109], v[110:111]
    v_cvt_pk_bf16_f32 v111, v108, v109
    v_cvt_pk_bf16_f32 v108, v96, v97
    v_cvt_pk_bf16_f32 v110, v100, v101
    v_cvt_pk_bf16_f32 v109, v104, v105
    v_and_or_b32 v108, v108, -2, s41
    buffer_store_dwordx4 v[108:111], v1, s[4:7], s37 offen sc1
    v_smfmac_f32_16x16x64_bf16 v[112:115], v[32:35], v[64:71], v2
    ds_read_b128 v[64:67], v1 offset:36864
    ds_read_b128 v[68:71], v1 offset:37888
    v_smfmac_f32_16x16x64_bf16 v[116:119], v[32:35], v[72:79], v2
    ds_read_b128 v[72:75], v1 offset:38912
    ds_read_b128 v[76:79], v1 offset:39936
    v_smfmac_f32_16x16x64_bf16 v[112:115], v[36:39], v[80:87], v2
    ds_read_b128 v[80:83], v1 offset:53248
    ds_read_b128 v[84:87], v1 offset:54272
    v_smfmac_f32_16x16x64_bf16 v[116:119], v[36:39], v[88:95], v2
    ds_read_b128 v[88:91], v1 offset:55296
    ds_read_b128 v[92:95], v1 offset:56320
    v_smfmac_f32_16x16x64_bf16 v[112:115], v[52:55], v[208:215], v2
    v_smfmac_f32_16x16x64_bf16 v[116:119], v[52:55], v[216:223], v2
    v_smfmac_f32_16x16x64_bf16 v[112:115], v[56:59], v[224:231], v2
    s_waitcnt lgkmcnt(6)
    v_smfmac_f32_16x16x64_bf16 v[112:115], v[40:43], v[64:71], v2
    ds_read_b128 v[64:67], v5 offset:4096
    ds_read_b128 v[68:71], v5 offset:5120
    s_waitcnt lgkmcnt(6)
    v_smfmac_f32_16x16x64_bf16 v[116:119], v[40:43], v[72:79], v2
    ds_read_b128 v[72:75], v5 offset:6144
    ds_read_b128 v[76:79], v5 offset:7168
    v_smfmac_f32_16x16x64_bf16 v[116:119], v[56:59], v[232:239], v2
    v_smfmac_f32_16x16x64_bf16 v[112:115], v[60:63], v[240:247], v2
    v_smfmac_f32_16x16x64_bf16 v[116:119], v[60:63], v[248:255], v2
    s_waitcnt lgkmcnt(6)
    v_smfmac_f32_16x16x64_bf16 v[112:115], v[44:47], v[80:87], v2
    s_waitcnt lgkmcnt(4)
    v_smfmac_f32_16x16x64_bf16 v[116:119], v[44:47], v[88:95], v2
    s_waitcnt lgkmcnt(2)
    v_smfmac_f32_16x16x64_bf16 v[112:115], v[48:51], v[64:71], v2
    s_waitcnt lgkmcnt(0)
    v_smfmac_f32_16x16x64_bf16 v[116:119], v[48:51], v[72:79], v2
    v_mfma_f32_16x16x16_bf16 v[100:103], v[108:109], v[16:17], 0
    v_mfma_f32_16x16x16_bf16 v[104:107], v[110:111], v[16:17], 0
    s_nop 4
    v_add_f32 v112, v112, v114
    v_add_f32 v113, v113, v115
    v_add_f32 v114, v116, v118
    v_add_f32 v115, v117, v119
    v_cvt_pk_bf16_f32 v18, v112, v113
    v_cvt_pk_bf16_f32 v19, v114, v115
    v_and_or_b32 v18, v18, -2, s41
    v_mov_b32 v112, v18
    v_mov_b32 v114, v19
    v_mov_b32 v92, v28
    v_mov_b32 v93, 0
    s_waitcnt vmcnt(3)
    s_barrier
    ds_read_b128 v[32:35], v6 offset:12288
    ds_read_b128 v[36:39], v6 offset:13312
    ds_read_b128 v[40:43], v6 offset:9216
    ds_read_b128 v[44:47], v6 offset:10240
    ds_read_b128 v[48:51], v6 offset:18432
    ds_read_b128 v[52:55], v6 offset:19456
    ds_read_b128 v[56:59], v6 offset:15360
    ds_read_b128 v[60:63], v6 offset:16384
    buffer_load_dwordx4 v[96:99], v1, s[4:7], s38 offen sc1
    s_barrier
    buffer_store_dwordx2 v[18:19], v11, s[4:7], s39 offen sc1
    s_nop 15
    s_nop 15
    buffer_load_dwordx4 v[20:23], v1, s[4:7], s38 offen sc1
    s_waitcnt vmcnt(2)
    v_mfma_f32_16x16x16_bf16 v[80:83], v[96:97], v[16:17], v[100:103]
    v_mfma_f32_16x16x16_bf16 v[84:87], v[98:99], v[16:17], v[104:107]
    v_and_b32 v3, 1, v96
    v_cmp_ne_u32 vcc, s41, v3
    s_nop 4
    v_cvt_pk_bf16_f32 v64, v80, v81
    v_cvt_pk_bf16_f32 v65, v82, v83
    v_cvt_pk_bf16_f32 v66, v84, v85
    v_cvt_pk_bf16_f32 v67, v86, v87
    ds_write_b128 v6, v[64:67] offset:11264
    s_cbranch_vccnz mega_kernel_rf_w1_xslow
mega_kernel_rf_w1_xok:
    buffer_load_dwordx2 v[116:117], v11, s[4:7], s40 offen sc1
    s_waitcnt lgkmcnt(1)
    v_mfma_f32_16x16x32_bf16 v[80:83], v[32:35], v[64:67], 0
    s_waitcnt lgkmcnt(0)
    s_barrier
    ds_read_b128 v[68:71], v6 offset:8192
    ds_read_b128 v[72:75], v6 offset:17408
    ds_read_b128 v[76:79], v6 offset:14336
    v_mfma_f32_16x16x32_bf16 v[84:87], v[36:39], v[64:67], 0
    v_mfma_f32_16x16x32_bf16 v[88:91], v[64:67], v[64:67], 0
    buffer_load_dwordx2 v[20:21], v11, s[4:7], s40 offen sc1
    s_waitcnt lgkmcnt(2)
    v_mfma_f32_16x16x32_bf16 v[80:83], v[40:43], v[68:71], v[80:83]
    v_mfma_f32_16x16x32_bf16 v[84:87], v[44:47], v[68:71], v[84:87]
    v_mfma_f32_16x16x32_bf16 v[88:91], v[68:71], v[68:71], v[88:91]
    s_waitcnt lgkmcnt(1)
    v_mfma_f32_16x16x32_bf16 v[80:83], v[48:51], v[72:75], v[80:83]
    v_mfma_f32_16x16x32_bf16 v[84:87], v[52:55], v[72:75], v[84:87]
    v_mfma_f32_16x16x32_bf16 v[88:91], v[72:75], v[72:75], v[88:91]
    s_waitcnt lgkmcnt(0)
    v_mfma_f32_16x16x32_bf16 v[80:83], v[56:59], v[76:79], v[80:83]
    v_mfma_f32_16x16x32_bf16 v[84:87], v[60:63], v[76:79], v[84:87]
    v_mfma_f32_16x16x32_bf16 v[88:91], v[76:79], v[76:79], v[88:91]
    v_mfma_f32_32x32x4_2b_bf16 v[32:63], v[14:15], v[14:15], 0
    s_nop 4
    v_max3_f32 v4, v80, v81, v82
    v_max3_f32 v4, v4, v83, v84
    v_max3_f32 v4, v4, v85, v86
    v_max3_f32 v4, v4, v87, v88
    v_max_f32 v90, v4, v89
    v_max_f32 v4, v4, v89
    s_nop 0
    s_nop 0
    v_permlane16_swap_b32 v4, v90
    v_max_f32 v4, v4, v90
    v_max_f32 v90, v4, v90
    s_nop 1
    v_permlane32_swap_b32 v4, v90
    v_max_f32 v4, v4, v90
    v_mul_f32 v4, s34, v4
    v_pk_fma_f32 v[80:81], v[80:81], s[34:35], v[4:5] op_sel_hi:[1,0,0] neg_lo:[0,0,1] neg_hi:[0,0,1]
    v_pk_fma_f32 v[82:83], v[82:83], s[34:35], v[4:5] op_sel_hi:[1,0,0] neg_lo:[0,0,1] neg_hi:[0,0,1]
    v_pk_fma_f32 v[84:85], v[84:85], s[34:35], v[4:5] op_sel_hi:[1,0,0] neg_lo:[0,0,1] neg_hi:[0,0,1]
    v_pk_fma_f32 v[86:87], v[86:87], s[34:35], v[4:5] op_sel_hi:[1,0,0] neg_lo:[0,0,1] neg_hi:[0,0,1]
    v_pk_fma_f32 v[88:89], v[88:89], s[34:35], v[4:5] op_sel_hi:[1,0,0] neg_lo:[0,0,1] neg_hi:[0,0,1]
    v_exp_f32 v80, v80
    v_exp_f32 v81, v81
    v_exp_f32 v82, v82
    v_cvt_pk_bf16_f32 v68, v80, v81
    v_exp_f32 v83, v83
    v_exp_f32 v84, v84
    v_cvt_pk_bf16_f32 v69, v82, v83
    v_exp_f32 v85, v85
    v_exp_f32 v86, v86
    v_cvt_pk_bf16_f32 v70, v84, v85
    v_exp_f32 v87, v87
    v_exp_f32 v88, v88
    v_cvt_pk_bf16_f32 v71, v86, v87
    v_exp_f32 v89, v89
    s_cmp_eq_u32 s21, 63
    v_mfma_f32_16x16x32_bf16 v[76:79], v[28:31], v[68:71], 0
    v_cvt_pk_bf16_f32 v72, v88, v89
    v_cvt_pk_bf16_f32 v73, v88, v89
    v_mfma_f32_16x16x32_bf16 v[100:103], v[120:123], v[68:71], 0
    s_waitcnt vmcnt(1)
    v_and_b32 v3, 1, v116
    v_cmp_ne_u32 vcc, s41, v3
    v_mfma_f32_16x16x32_bf16 v[104:107], v[124:127], v[68:71], 0
    v_mov_b32 v113, v116
    v_mov_b32 v115, v117
    v_mfma_f32_16x16x16_bf16 v[76:79], v[92:93], v[72:73], v[76:79]
    s_cbranch_vccnz mega_kernel_rf_w1_pv0
mega_kernel_rf_w1_pv2:
    v_mfma_f32_16x16x16_bf16 v[100:103], v[112:113], v[72:73], v[100:103]
    v_mfma_f32_16x16x16_bf16 v[104:107], v[114:115], v[72:73], v[104:107]
    buffer_load_dwordx4 v[120:123], v1, s[4:7], s44 offen
    buffer_load_dwordx4 v[124:127], v1, s[4:7], s44 offen offset:1024
    s_cmp_eq_u32 s21, 63
    s_nop 1
    v_rcp_f32 v76, v76
    s_cbranch_scc1 mega_kernel_rf_w1_last
    s_mov_b64 exec, s[28:29]
    v_pk_mul_f32 v[100:101], v[100:101], v[76:77] op_sel_hi:[1,0]
    v_pk_mul_f32 v[102:103], v[102:103], v[76:77] op_sel_hi:[1,0]
    v_pk_mul_f32 v[104:105], v[104:105], v[76:77] op_sel_hi:[1,0]
    v_pk_mul_f32 v[106:107], v[106:107], v[76:77] op_sel_hi:[1,0]
    v_cvt_pk_bf16_f32 v72, v100, v101
    v_cvt_pk_bf16_f32 v73, v102, v103
    v_cvt_pk_bf16_f32 v74, v104, v105
    v_cvt_pk_bf16_f32 v75, v106, v107
    ds_write_b128 v6, v[72:75] offset:20480
    s_mov_b64 exec, -1
    ds_read_b128 v[88:91], v5 offset:20480
    ds_read_b128 v[92:95], v5 offset:21504
    ds_read_b128 v[80:83], v5 offset:22528
    ds_read_b128 v[84:87], v5 offset:23552
    ds_read_b128 v[112:115], v5 offset:36864
    ds_read_b128 v[116:119], v5 offset:37888
    s_waitcnt lgkmcnt(6)
    s_barrier
    ds_read_b128 v[68:71], v6 offset:20480
    ds_read_b128 v[72:75], v6 offset:21504
    ds_read_b128 v[96:99], v5 offset:38912
    ds_read_b128 v[100:103], v5 offset:39936
    ds_read_b128 v[104:107], v5 offset:53248
    ds_read_b128 v[108:111], v5 offset:54272
    s_waitcnt lgkmcnt(5)
    v_smfmac_f32_16x16x64_bf16 v[32:35], v[68:71], v[128:135], v2
    s_add_u32 s21, s21, 1
    v_smfmac_f32_16x16x64_bf16 v[36:39], v[68:71], v[136:143], v2
    s_xor_b32 s38, s38, 1048576
    v_smfmac_f32_16x16x64_bf16 v[40:43], v[68:71], v[144:151], v2
    s_xor_b32 s37, s37, 1048576
    v_smfmac_f32_16x16x64_bf16 v[44:47], v[68:71], v[152:159], v2
    s_xor_b32 s40, s40, 1048576
    s_waitcnt lgkmcnt(4)
    v_smfmac_f32_16x16x64_bf16 v[32:35], v[72:75], v[160:167], v2
    s_xor_b32 s39, s39, 1048576
    v_smfmac_f32_16x16x64_bf16 v[36:39], v[72:75], v[168:175], v2
    s_lshr_b32 s41, s21, 1
    v_smfmac_f32_16x16x64_bf16 v[40:43], v[72:75], v[176:183], v2
    s_and_b32 s41, s41, 1
    v_smfmac_f32_16x16x64_bf16 v[44:47], v[72:75], v[184:191], v2
    s_xor_b32 s41, s41, 1
    v_smfmac_f32_16x16x64_bf16 v[48:51], v[68:71], v[192:199], v2
    s_xor_b32 s35, s35, 16384
    v_smfmac_f32_16x16x64_bf16 v[52:55], v[68:71], v[200:207], v2
    s_xor_b32 s36, s36, 16384
    s_waitcnt lgkmcnt(0)
    v_smfmac_f32_16x16x64_bf16 v[56:59], v[68:71], v[88:95], v2
    ds_read_b128 v[88:91], v5 offset:55296
    ds_read_b128 v[92:95], v5 offset:56320
    v_smfmac_f32_16x16x64_bf16 v[60:63], v[68:71], v[80:87], v2
    s_add_u32 s43, s43, 262144
    v_smfmac_f32_16x16x64_bf16 v[48:51], v[72:75], v[112:119], v2
    s_add_u32 s44, s44, 262144
    v_add_f32 v32, v32, v34
    v_add_f32 v33, v33, v35
    v_cvt_pk_bf16_f32 v32, v32, v33
    v_and_or_b32 v32, v32, -2, s42
    v_smfmac_f32_16x16x64_bf16 v[52:55], v[72:75], v[96:103], v2
    v_add_f32 v36, v36, v38
    v_add_f32 v37, v37, v39
    v_cvt_pk_bf16_f32 v33, v36, v37
    v_smfmac_f32_16x16x64_bf16 v[56:59], v[72:75], v[104:111], v2
    v_add_f32 v40, v40, v42
    v_add_f32 v41, v41, v43
    v_cvt_pk_bf16_f32 v34, v40, v41
    s_waitcnt lgkmcnt(0)
    v_smfmac_f32_16x16x64_bf16 v[60:63], v[72:75], v[88:95], v2
    v_add_f32 v44, v44, v46
    v_add_f32 v45, v45, v47
    v_cvt_pk_bf16_f32 v35, v44, v45
    buffer_store_dwordx4 v[32:35], v8, s[4:7], s46 offen
    v_pk_add_f32 v[48:49], v[48:49], v[50:51]
    v_cvt_pk_bf16_f32 v48, v48, v49
    v_and_or_b32 v48, v48, -2, s42
    v_pk_add_f32 v[52:53], v[52:53], v[54:55]
    v_cvt_pk_bf16_f32 v49, v52, v53
    v_pk_add_f32 v[56:57], v[56:57], v[58:59]
    v_cvt_pk_bf16_f32 v50, v56, v57
    v_pk_add_f32 v[60:61], v[60:61], v[62:63]
    v_cvt_pk_bf16_f32 v51, v60, v61
    buffer_store_dwordx4 v[48:51], v8, s[4:7], s61 offen
    s_waitcnt vmcnt(4)
    v_mov_b32 v20, v64
    v_mov_b32 v21, v65
    v_mov_b32 v22, v66
    v_mov_b32 v23, v67
    s_add_u32 s45, s45, 262144
    s_add_u32 s51, s51, 262144
    v_mfma_f32_32x32x8_bf16 v[96:111], v[14:15], v[14:15], 0
    v_mfma_f32_16x16x16_bf16 v[112:115], v[14:15], v[14:15], 0
    v_mfma_f32_16x16x16_bf16 v[116:119], v[14:15], v[14:15], 0
    ds_read_b128 v[64:67], v1 offset:4096
    ds_read_b128 v[68:71], v1 offset:5120
    ds_read_b128 v[72:75], v1 offset:6144
    ds_read_b128 v[76:79], v1 offset:7168
    ds_read_b128 v[80:83], v1 offset:20480
    ds_read_b128 v[84:87], v1 offset:21504
    ds_read_b128 v[88:91], v1 offset:22528
    ds_read_b128 v[92:95], v1 offset:23552
    v_mov_b32 v58, -1
    v_mov_b32 v59, -1
    s_waitcnt vmcnt(0)
mega_kernel_rf_w1_pc:
    buffer_load_dword v36, v13, s[4:7], s47 offen offset:64 sc1
    buffer_load_dword v37, v13, s[4:7], s47 offen offset:1088 sc1
    buffer_load_dword v38, v13, s[4:7], s47 offen offset:2112 sc1
    buffer_load_dword v39, v13, s[4:7], s47 offen offset:3136 sc1
    buffer_load_dword v40, v13, s[4:7], s25 offen offset:64 sc1
    buffer_load_dword v41, v13, s[4:7], s25 offen offset:1088 sc1
    buffer_load_dword v42, v13, s[4:7], s25 offen offset:2112 sc1
    buffer_load_dword v43, v13, s[4:7], s25 offen offset:3136 sc1
    s_waitcnt vmcnt(4)
    v_mfma_f32_16x16x32_bf16 v[52:55], v[36:39], v[24:27], 0
    v_bitop3_b32 v3, s42, v36, v37 bitop3:0x7e
    v_bitop3_b32 v4, s42, v38, v39 bitop3:0x7e
    s_waitcnt vmcnt(2)
    v_or_b32 v3, v3, v4
    v_bitop3_b32 v4, s42, v40, v41 bitop3:0x7e
    s_waitcnt vmcnt(0)
    v_mfma_f32_16x16x32_bf16 v[52:55], v[40:43], v[24:27], v[52:55]
    v_bitop3_b32 v56, s42, v42, v43 bitop3:0x7e
    v_or3_b32 v3, v3, v4, v56
    v_and_b32 v3, v0, v3
    v_cmp_ne_u32 vcc, 0, v3
    s_cbranch_vccnz mega_kernel_rf_w1_pc
    s_nop 2
    v_cvt_pk_bf16_f32 v56, v52, v53
    v_cvt_pk_bf16_f32 v57, v54, v55
    v_min_u32 v56, -2, v56
    s_mov_b64 exec, s[26:27]
    buffer_store_dwordx2 v[56:57], v9, s[4:7], s35 offen offset:64
    buffer_store_dwordx2 v[58:59], v9, s[4:7], s36 offen offset:64
    s_mov_b64 exec, -1
    s_xor_b32 s42, s42, 1
    s_branch mega_kernel_rf_w1_loop
mega_kernel_rf_w1_last:
    s_waitcnt vmcnt(0)
    v_mov_b32 v20, v64
    v_mov_b32 v21, v65
    v_mov_b32 v22, v66
    v_mov_b32 v23, v67
    s_add_u32 s45, s45, 262144
    s_add_u32 s51, s51, 262144
    buffer_store_dwordx4 v[20:23], v10, s[4:7], s45 offen offset:64 sc1
    buffer_store_dwordx2 v[18:19], v11, s[4:7], s51 offen offset:2560 sc1
    s_branch mega_kernel_rf_end
mega_kernel_rf_w1_pafail:
    buffer_load_dwordx4 v[40:43], v12, s[4:7], s22 offen sc1
    buffer_load_dwordx4 v[44:47], v12, s[4:7], s22 offen offset:1024 sc1
    s_nop 7
    v_mov_b32 v96, 0
    v_mov_b32 v97, 0
    v_mov_b32 v98, 0
    v_mov_b32 v99, 0
    v_mov_b32 v100, 0
    v_mov_b32 v101, 0
    v_mov_b32 v102, 0
    v_mov_b32 v103, 0
    v_mov_b32 v104, 0
    v_mov_b32 v105, 0
    v_mov_b32 v106, 0
    v_mov_b32 v107, 0
    s_branch mega_kernel_rf_w1_pa
mega_kernel_rf_w1_xslow:
    buffer_load_dwordx4 v[96:99], v1, s[4:7], s38 offen sc1
    s_waitcnt vmcnt(1)
    v_and_b32 v3, 1, v20
    v_cmp_ne_u32 vcc, s41, v3
    s_cbranch_vccz mega_kernel_rf_w1_xgot1
    buffer_load_dwordx4 v[20:23], v1, s[4:7], s38 offen sc1
mega_kernel_rf_w1_px:
    s_waitcnt vmcnt(1)
    v_and_b32 v3, 1, v96
    v_cmp_ne_u32 vcc, s41, v3
    s_cbranch_vccz mega_kernel_rf_w1_xgot0
    buffer_load_dwordx4 v[96:99], v1, s[4:7], s38 offen sc1
    s_waitcnt vmcnt(1)
    v_and_b32 v3, 1, v20
    v_cmp_ne_u32 vcc, s41, v3
    s_cbranch_vccz mega_kernel_rf_w1_xgot1
    buffer_load_dwordx4 v[20:23], v1, s[4:7], s38 offen sc1
    s_branch mega_kernel_rf_w1_px
mega_kernel_rf_w1_xgot0:
    v_mfma_f32_16x16x16_bf16 v[80:83], v[96:97], v[16:17], v[100:103]
    v_mfma_f32_16x16x16_bf16 v[84:87], v[98:99], v[16:17], v[104:107]
    v_and_b32 v3, 1, v96
    v_cmp_ne_u32 vcc, s41, v3
    s_nop 4
    v_cvt_pk_bf16_f32 v64, v80, v81
    v_cvt_pk_bf16_f32 v65, v82, v83
    v_cvt_pk_bf16_f32 v66, v84, v85
    v_cvt_pk_bf16_f32 v67, v86, v87
    ds_write_b128 v6, v[64:67] offset:11264
    s_branch mega_kernel_rf_w1_xok
mega_kernel_rf_w1_xgot1:
    v_mfma_f32_16x16x16_bf16 v[80:83], v[20:21], v[16:17], v[100:103]
    v_mfma_f32_16x16x16_bf16 v[84:87], v[22:23], v[16:17], v[104:107]
    v_and_b32 v3, 1, v20
    v_cmp_ne_u32 vcc, s41, v3
    s_nop 4
    v_cvt_pk_bf16_f32 v64, v80, v81
    v_cvt_pk_bf16_f32 v65, v82, v83
    v_cvt_pk_bf16_f32 v66, v84, v85
    v_cvt_pk_bf16_f32 v67, v86, v87
    ds_write_b128 v6, v[64:67] offset:11264
    s_branch mega_kernel_rf_w1_xok
mega_kernel_rf_w1_pv0:
    s_waitcnt vmcnt(0)
    s_branch mega_kernel_rf_w1_pv1
mega_kernel_rf_w1_pv:
    buffer_load_dwordx2 v[20:21], v11, s[4:7], s40 offen sc1
    s_waitcnt vmcnt(0)
mega_kernel_rf_w1_pv1:
    v_and_b32 v3, 1, v20
    v_cmp_ne_u32 vcc, s41, v3
    v_mov_b32 v113, v20
    v_mov_b32 v115, v21
    s_cbranch_vccnz mega_kernel_rf_w1_pv
    s_branch mega_kernel_rf_w1_pv2
mega_kernel_rf_w2_entry:
    v_mfma_f32_32x32x8_bf16 v[96:111], v[14:15], v[14:15], 0
    v_mfma_f32_16x16x16_bf16 v[112:115], v[14:15], v[14:15], 0
    v_mfma_f32_16x16x16_bf16 v[116:119], v[14:15], v[14:15], 0
    ds_read_b128 v[64:67], v1 offset:8192
    ds_read_b128 v[68:71], v1 offset:9216
    ds_read_b128 v[72:75], v1 offset:10240
    ds_read_b128 v[76:79], v1 offset:11264
    ds_read_b128 v[80:83], v1 offset:24576
    ds_read_b128 v[84:87], v1 offset:25600
    ds_read_b128 v[88:91], v1 offset:26624
    ds_read_b128 v[92:95], v1 offset:27648
    buffer_load_dwordx4 v[120:123], v1, s[4:7], s44 offen
    buffer_load_dwordx4 v[124:127], v1, s[4:7], s44 offen offset:1024
    s_add_u32 s44, s44, 262144
mega_kernel_rf_w2_loop:
    s_add_u32 s22, s35, 4096
    s_waitcnt vmcnt(0)
    buffer_load_dwordx4 v[48:51], v12, s[4:7], s22 offen sc1
    buffer_load_dwordx4 v[52:55], v12, s[4:7], s22 offen offset:1024 sc1
mega_kernel_rf_w2_pa:
    s_waitcnt vmcnt(1)
    ds_write_b128 v6, v[48:51] offset:4096
    s_waitcnt vmcnt(0)
    ds_write_b128 v6, v[52:55] offset:5120
    v_max3_u32 v3, v48, v50, v52
    v_max_u32 v3, v3, v54
    v_cmp_eq_u32 vcc, -1, v3
    v_smfmac_f32_16x16x64_bf16 v[96:99], v[48:51], a[64:71], v2
    v_smfmac_f32_16x16x64_bf16 v[100:103], v[48:51], a[72:79], v2
    v_smfmac_f32_16x16x64_bf16 v[104:107], v[48:51], a[192:199], v2
    s_cbranch_vccnz mega_kernel_rf_w2_pafail
    s_waitcnt lgkmcnt(0)
    s_barrier
    ds_read_b128 v[56:59], v6 offset:6144
    ds_read_b128 v[60:63], v6 offset:7168
    v_smfmac_f32_16x16x64_bf16 v[108:111], v[48:51], a[200:207], v2
    ds_read_b128 v[32:35], v6 offset:0
    v_smfmac_f32_16x16x64_bf16 v[96:99], v[52:55], a[80:87], v2
    ds_read_b128 v[36:39], v6 offset:1024
    v_smfmac_f32_16x16x64_bf16 v[100:103], v[52:55], a[88:95], v2
    ds_read_b128 v[40:43], v6 offset:2048
    v_smfmac_f32_16x16x64_bf16 v[104:107], v[52:55], a[208:215], v2
    ds_read_b128 v[44:47], v6 offset:3072
    v_smfmac_f32_16x16x64_bf16 v[108:111], v[52:55], a[216:223], v2
    buffer_load_dwordx4 v1, s[4:7], s43 offen lds
    s_waitcnt lgkmcnt(5)
    v_smfmac_f32_16x16x64_bf16 v[96:99], v[56:59], a[96:103], v2
    v_smfmac_f32_16x16x64_bf16 v[100:103], v[56:59], a[104:111], v2
    v_smfmac_f32_16x16x64_bf16 v[104:107], v[56:59], a[224:231], v2
    v_smfmac_f32_16x16x64_bf16 v[108:111], v[56:59], a[232:239], v2
    buffer_load_dwordx4 v1, s[4:7], s43 offen offset:1024 lds
    s_waitcnt lgkmcnt(4)
    v_smfmac_f32_16x16x64_bf16 v[96:99], v[60:63], a[112:119], v2
    v_smfmac_f32_16x16x64_bf16 v[100:103], v[60:63], a[120:127], v2
    v_smfmac_f32_16x16x64_bf16 v[104:107], v[60:63], a[240:247], v2
    v_smfmac_f32_16x16x64_bf16 v[108:111], v[60:63], a[248:255], v2
    buffer_store_dwordx4 v[20:23], v10, s[4:7], s45 offen offset:128 sc1
    s_waitcnt lgkmcnt(3)
    v_smfmac_f32_16x16x64_bf16 v[96:99], v[32:35], a[0:7], v2
    v_smfmac_f32_16x16x64_bf16 v[100:103], v[32:35], a[8:15], v2
    v_smfmac_f32_16x16x64_bf16 v[104:107], v[32:35], a[128:135], v2
    v_smfmac_f32_16x16x64_bf16 v[108:111], v[32:35], a[136:143], v2
    buffer_store_dwordx2 v[18:19], v11, s[4:7], s51 offen offset:3072 sc1
    s_waitcnt lgkmcnt(2)
    v_smfmac_f32_16x16x64_bf16 v[96:99], v[36:39], a[16:23], v2
    v_smfmac_f32_16x16x64_bf16 v[100:103], v[36:39], a[24:31], v2
    v_smfmac_f32_16x16x64_bf16 v[104:107], v[36:39], a[144:151], v2
    v_smfmac_f32_16x16x64_bf16 v[108:111], v[36:39], a[152:159], v2
    s_waitcnt lgkmcnt(1)
    v_smfmac_f32_16x16x64_bf16 v[96:99], v[40:43], a[32:39], v2
    v_smfmac_f32_16x16x64_bf16 v[100:103], v[40:43], a[40:47], v2
    v_smfmac_f32_16x16x64_bf16 v[104:107], v[40:43], a[160:167], v2
    v_smfmac_f32_16x16x64_bf16 v[108:111], v[40:43], a[168:175], v2
    s_waitcnt lgkmcnt(0)
    v_smfmac_f32_16x16x64_bf16 v[96:99], v[44:47], a[48:55], v2
    v_smfmac_f32_16x16x64_bf16 v[100:103], v[44:47], a[56:63], v2
    v_smfmac_f32_16x16x64_bf16 v[104:107], v[44:47], a[176:183], v2
    v_smfmac_f32_16x16x64_bf16 v[108:111], v[44:47], a[184:191], v2
    s_nop 4
    v_pk_add_f32 v[96:97], v[96:97], v[98:99]
    v_pk_add_f32 v[100:101], v[100:101], v[102:103]
    v_pk_add_f32 v[104:105], v[104:105], v[106:107]
    v_pk_add_f32 v[108:109], v[108:109], v[110:111]
    v_cvt_pk_bf16_f32 v111, v108, v109
    v_cvt_pk_bf16_f32 v108, v96, v97
    v_cvt_pk_bf16_f32 v110, v100, v101
    v_cvt_pk_bf16_f32 v109, v104, v105
    v_and_or_b32 v108, v108, -2, s41
    buffer_store_dwordx4 v[108:111], v1, s[4:7], s37 offen sc1
    v_smfmac_f32_16x16x64_bf16 v[112:115], v[32:35], v[64:71], v2
    ds_read_b128 v[64:67], v1 offset:40960
    ds_read_b128 v[68:71], v1 offset:41984
    v_smfmac_f32_16x16x64_bf16 v[116:119], v[32:35], v[72:79], v2
    ds_read_b128 v[72:75], v1 offset:43008
    ds_read_b128 v[76:79], v1 offset:44032
    v_smfmac_f32_16x16x64_bf16 v[112:115], v[36:39], v[80:87], v2
    ds_read_b128 v[80:83], v1 offset:57344
    ds_read_b128 v[84:87], v1 offset:58368
    v_smfmac_f32_16x16x64_bf16 v[116:119], v[36:39], v[88:95], v2
    ds_read_b128 v[88:91], v1 offset:59392
    ds_read_b128 v[92:95], v1 offset:60416
    v_smfmac_f32_16x16x64_bf16 v[112:115], v[52:55], v[208:215], v2
    v_smfmac_f32_16x16x64_bf16 v[116:119], v[52:55], v[216:223], v2
    v_smfmac_f32_16x16x64_bf16 v[112:115], v[56:59], v[224:231], v2
    s_waitcnt lgkmcnt(6)
    v_smfmac_f32_16x16x64_bf16 v[112:115], v[40:43], v[64:71], v2
    ds_read_b128 v[64:67], v5 offset:8192
    ds_read_b128 v[68:71], v5 offset:9216
    s_waitcnt lgkmcnt(6)
    v_smfmac_f32_16x16x64_bf16 v[116:119], v[40:43], v[72:79], v2
    ds_read_b128 v[72:75], v5 offset:10240
    ds_read_b128 v[76:79], v5 offset:11264
    v_smfmac_f32_16x16x64_bf16 v[116:119], v[56:59], v[232:239], v2
    v_smfmac_f32_16x16x64_bf16 v[112:115], v[60:63], v[240:247], v2
    v_smfmac_f32_16x16x64_bf16 v[116:119], v[60:63], v[248:255], v2
    s_waitcnt lgkmcnt(6)
    v_smfmac_f32_16x16x64_bf16 v[112:115], v[44:47], v[80:87], v2
    s_waitcnt lgkmcnt(4)
    v_smfmac_f32_16x16x64_bf16 v[116:119], v[44:47], v[88:95], v2
    s_waitcnt lgkmcnt(2)
    v_smfmac_f32_16x16x64_bf16 v[112:115], v[48:51], v[64:71], v2
    s_waitcnt lgkmcnt(0)
    v_smfmac_f32_16x16x64_bf16 v[116:119], v[48:51], v[72:79], v2
    v_mfma_f32_16x16x16_bf16 v[100:103], v[108:109], v[16:17], 0
    v_mfma_f32_16x16x16_bf16 v[104:107], v[110:111], v[16:17], 0
    s_nop 4
    v_add_f32 v112, v112, v114
    v_add_f32 v113, v113, v115
    v_add_f32 v114, v116, v118
    v_add_f32 v115, v117, v119
    v_cvt_pk_bf16_f32 v18, v112, v113
    v_cvt_pk_bf16_f32 v19, v114, v115
    v_and_or_b32 v18, v18, -2, s41
    v_mov_b32 v112, v18
    v_mov_b32 v114, v19
    v_mov_b32 v92, v28
    v_mov_b32 v93, 0
    s_waitcnt vmcnt(3)
    s_barrier
    ds_read_b128 v[32:35], v6 offset:15360
    ds_read_b128 v[36:39], v6 offset:16384
    ds_read_b128 v[40:43], v6 offset:18432
    ds_read_b128 v[44:47], v6 offset:19456
    ds_read_b128 v[48:51], v6 offset:9216
    ds_read_b128 v[52:55], v6 offset:10240
    ds_read_b128 v[56:59], v6 offset:12288
    ds_read_b128 v[60:63], v6 offset:13312
    buffer_load_dwordx4 v[96:99], v1, s[4:7], s38 offen sc1
    s_barrier
    buffer_store_dwordx2 v[18:19], v11, s[4:7], s39 offen sc1
    s_nop 15
    s_nop 15
    buffer_load_dwordx4 v[20:23], v1, s[4:7], s38 offen sc1
    s_waitcnt vmcnt(2)
    v_mfma_f32_16x16x16_bf16 v[80:83], v[96:97], v[16:17], v[100:103]
    v_mfma_f32_16x16x16_bf16 v[84:87], v[98:99], v[16:17], v[104:107]
    v_and_b32 v3, 1, v96
    v_cmp_ne_u32 vcc, s41, v3
    s_nop 4
    v_cvt_pk_bf16_f32 v64, v80, v81
    v_cvt_pk_bf16_f32 v65, v82, v83
    v_cvt_pk_bf16_f32 v66, v84, v85
    v_cvt_pk_bf16_f32 v67, v86, v87
    ds_write_b128 v6, v[64:67] offset:14336
    s_cbranch_vccnz mega_kernel_rf_w2_xslow
mega_kernel_rf_w2_xok:
    buffer_load_dwordx2 v[116:117], v11, s[4:7], s40 offen sc1
    s_waitcnt lgkmcnt(1)
    v_mfma_f32_16x16x32_bf16 v[80:83], v[32:35], v[64:67], 0
    s_waitcnt lgkmcnt(0)
    s_barrier
    ds_read_b128 v[68:71], v6 offset:17408
    ds_read_b128 v[72:75], v6 offset:8192
    ds_read_b128 v[76:79], v6 offset:11264
    v_mfma_f32_16x16x32_bf16 v[84:87], v[36:39], v[64:67], 0
    v_mfma_f32_16x16x32_bf16 v[88:91], v[64:67], v[64:67], 0
    buffer_load_dwordx2 v[20:21], v11, s[4:7], s40 offen sc1
    s_waitcnt lgkmcnt(2)
    v_mfma_f32_16x16x32_bf16 v[80:83], v[40:43], v[68:71], v[80:83]
    v_mfma_f32_16x16x32_bf16 v[84:87], v[44:47], v[68:71], v[84:87]
    v_mfma_f32_16x16x32_bf16 v[88:91], v[68:71], v[68:71], v[88:91]
    s_waitcnt lgkmcnt(1)
    v_mfma_f32_16x16x32_bf16 v[80:83], v[48:51], v[72:75], v[80:83]
    v_mfma_f32_16x16x32_bf16 v[84:87], v[52:55], v[72:75], v[84:87]
    v_mfma_f32_16x16x32_bf16 v[88:91], v[72:75], v[72:75], v[88:91]
    s_waitcnt lgkmcnt(0)
    v_mfma_f32_16x16x32_bf16 v[80:83], v[56:59], v[76:79], v[80:83]
    v_mfma_f32_16x16x32_bf16 v[84:87], v[60:63], v[76:79], v[84:87]
    v_mfma_f32_16x16x32_bf16 v[88:91], v[76:79], v[76:79], v[88:91]
    v_mfma_f32_32x32x4_2b_bf16 v[32:63], v[14:15], v[14:15], 0
    s_nop 4
    v_max3_f32 v4, v80, v81, v82
    v_max3_f32 v4, v4, v83, v84
    v_max3_f32 v4, v4, v85, v86
    v_max3_f32 v4, v4, v87, v88
    v_max_f32 v90, v4, v89
    v_max_f32 v4, v4, v89
    s_nop 0
    s_nop 0
    v_permlane16_swap_b32 v4, v90
    v_max_f32 v4, v4, v90
    v_max_f32 v90, v4, v90
    s_nop 1
    v_permlane32_swap_b32 v4, v90
    v_max_f32 v4, v4, v90
    v_mul_f32 v4, s34, v4
    v_pk_fma_f32 v[80:81], v[80:81], s[34:35], v[4:5] op_sel_hi:[1,0,0] neg_lo:[0,0,1] neg_hi:[0,0,1]
    v_pk_fma_f32 v[82:83], v[82:83], s[34:35], v[4:5] op_sel_hi:[1,0,0] neg_lo:[0,0,1] neg_hi:[0,0,1]
    v_pk_fma_f32 v[84:85], v[84:85], s[34:35], v[4:5] op_sel_hi:[1,0,0] neg_lo:[0,0,1] neg_hi:[0,0,1]
    v_pk_fma_f32 v[86:87], v[86:87], s[34:35], v[4:5] op_sel_hi:[1,0,0] neg_lo:[0,0,1] neg_hi:[0,0,1]
    v_pk_fma_f32 v[88:89], v[88:89], s[34:35], v[4:5] op_sel_hi:[1,0,0] neg_lo:[0,0,1] neg_hi:[0,0,1]
    v_exp_f32 v80, v80
    v_exp_f32 v81, v81
    v_exp_f32 v82, v82
    v_cvt_pk_bf16_f32 v68, v80, v81
    v_exp_f32 v83, v83
    v_exp_f32 v84, v84
    v_cvt_pk_bf16_f32 v69, v82, v83
    v_exp_f32 v85, v85
    v_exp_f32 v86, v86
    v_cvt_pk_bf16_f32 v70, v84, v85
    v_exp_f32 v87, v87
    v_exp_f32 v88, v88
    v_cvt_pk_bf16_f32 v71, v86, v87
    v_exp_f32 v89, v89
    s_cmp_eq_u32 s21, 63
    v_mfma_f32_16x16x32_bf16 v[76:79], v[28:31], v[68:71], 0
    v_cvt_pk_bf16_f32 v72, v88, v89
    v_cvt_pk_bf16_f32 v73, v88, v89
    v_mfma_f32_16x16x32_bf16 v[100:103], v[120:123], v[68:71], 0
    s_waitcnt vmcnt(1)
    v_and_b32 v3, 1, v116
    v_cmp_ne_u32 vcc, s41, v3
    v_mfma_f32_16x16x32_bf16 v[104:107], v[124:127], v[68:71], 0
    v_mov_b32 v113, v116
    v_mov_b32 v115, v117
    v_mfma_f32_16x16x16_bf16 v[76:79], v[92:93], v[72:73], v[76:79]
    s_cbranch_vccnz mega_kernel_rf_w2_pv0
mega_kernel_rf_w2_pv2:
    v_mfma_f32_16x16x16_bf16 v[100:103], v[112:113], v[72:73], v[100:103]
    v_mfma_f32_16x16x16_bf16 v[104:107], v[114:115], v[72:73], v[104:107]
    buffer_load_dwordx4 v[120:123], v1, s[4:7], s44 offen
    buffer_load_dwordx4 v[124:127], v1, s[4:7], s44 offen offset:1024
    s_cmp_eq_u32 s21, 63
    s_nop 1
    v_rcp_f32 v76, v76
    s_cbranch_scc1 mega_kernel_rf_w2_last
    s_mov_b64 exec, s[28:29]
    v_pk_mul_f32 v[100:101], v[100:101], v[76:77] op_sel_hi:[1,0]
    v_pk_mul_f32 v[102:103], v[102:103], v[76:77] op_sel_hi:[1,0]
    v_pk_mul_f32 v[104:105], v[104:105], v[76:77] op_sel_hi:[1,0]
    v_pk_mul_f32 v[106:107], v[106:107], v[76:77] op_sel_hi:[1,0]
    v_cvt_pk_bf16_f32 v72, v100, v101
    v_cvt_pk_bf16_f32 v73, v102, v103
    v_cvt_pk_bf16_f32 v74, v104, v105
    v_cvt_pk_bf16_f32 v75, v106, v107
    ds_write_b128 v6, v[72:75] offset:21472
    s_mov_b64 exec, -1
    ds_read_b128 v[88:91], v5 offset:24576
    ds_read_b128 v[92:95], v5 offset:25600
    ds_read_b128 v[80:83], v5 offset:26624
    ds_read_b128 v[84:87], v5 offset:27648
    ds_read_b128 v[112:115], v5 offset:40960
    ds_read_b128 v[116:119], v5 offset:41984
    s_waitcnt lgkmcnt(6)
    s_barrier
    ds_read_b128 v[68:71], v6 offset:20480
    ds_read_b128 v[72:75], v6 offset:21504
    ds_read_b128 v[96:99], v5 offset:43008
    ds_read_b128 v[100:103], v5 offset:44032
    ds_read_b128 v[104:107], v5 offset:57344
    ds_read_b128 v[108:111], v5 offset:58368
    s_waitcnt lgkmcnt(5)
    v_smfmac_f32_16x16x64_bf16 v[32:35], v[68:71], v[128:135], v2
    s_add_u32 s21, s21, 1
    v_smfmac_f32_16x16x64_bf16 v[36:39], v[68:71], v[136:143], v2
    s_xor_b32 s38, s38, 1048576
    v_smfmac_f32_16x16x64_bf16 v[40:43], v[68:71], v[144:151], v2
    s_xor_b32 s37, s37, 1048576
    v_smfmac_f32_16x16x64_bf16 v[44:47], v[68:71], v[152:159], v2
    s_xor_b32 s40, s40, 1048576
    s_waitcnt lgkmcnt(4)
    v_smfmac_f32_16x16x64_bf16 v[32:35], v[72:75], v[160:167], v2
    s_xor_b32 s39, s39, 1048576
    v_smfmac_f32_16x16x64_bf16 v[36:39], v[72:75], v[168:175], v2
    s_lshr_b32 s41, s21, 1
    v_smfmac_f32_16x16x64_bf16 v[40:43], v[72:75], v[176:183], v2
    s_and_b32 s41, s41, 1
    v_smfmac_f32_16x16x64_bf16 v[44:47], v[72:75], v[184:191], v2
    s_xor_b32 s41, s41, 1
    v_smfmac_f32_16x16x64_bf16 v[48:51], v[68:71], v[192:199], v2
    s_xor_b32 s35, s35, 16384
    v_smfmac_f32_16x16x64_bf16 v[52:55], v[68:71], v[200:207], v2
    s_xor_b32 s36, s36, 16384
    s_waitcnt lgkmcnt(0)
    v_smfmac_f32_16x16x64_bf16 v[56:59], v[68:71], v[88:95], v2
    ds_read_b128 v[88:91], v5 offset:59392
    ds_read_b128 v[92:95], v5 offset:60416
    v_smfmac_f32_16x16x64_bf16 v[60:63], v[68:71], v[80:87], v2
    s_add_u32 s43, s43, 262144
    v_smfmac_f32_16x16x64_bf16 v[48:51], v[72:75], v[112:119], v2
    s_add_u32 s44, s44, 262144
    v_add_f32 v32, v32, v34
    v_add_f32 v33, v33, v35
    v_cvt_pk_bf16_f32 v32, v32, v33
    v_and_or_b32 v32, v32, -2, s42
    v_smfmac_f32_16x16x64_bf16 v[52:55], v[72:75], v[96:103], v2
    v_add_f32 v36, v36, v38
    v_add_f32 v37, v37, v39
    v_cvt_pk_bf16_f32 v33, v36, v37
    v_smfmac_f32_16x16x64_bf16 v[56:59], v[72:75], v[104:111], v2
    v_add_f32 v40, v40, v42
    v_add_f32 v41, v41, v43
    v_cvt_pk_bf16_f32 v34, v40, v41
    s_waitcnt lgkmcnt(0)
    v_smfmac_f32_16x16x64_bf16 v[60:63], v[72:75], v[88:95], v2
    v_add_f32 v44, v44, v46
    v_add_f32 v45, v45, v47
    v_cvt_pk_bf16_f32 v35, v44, v45
    buffer_store_dwordx4 v[32:35], v8, s[4:7], s46 offen
    v_pk_add_f32 v[48:49], v[48:49], v[50:51]
    v_cvt_pk_bf16_f32 v48, v48, v49
    v_and_or_b32 v48, v48, -2, s42
    v_pk_add_f32 v[52:53], v[52:53], v[54:55]
    v_cvt_pk_bf16_f32 v49, v52, v53
    v_pk_add_f32 v[56:57], v[56:57], v[58:59]
    v_cvt_pk_bf16_f32 v50, v56, v57
    v_pk_add_f32 v[60:61], v[60:61], v[62:63]
    v_cvt_pk_bf16_f32 v51, v60, v61
    buffer_store_dwordx4 v[48:51], v8, s[4:7], s61 offen
    s_waitcnt vmcnt(4)
    v_mov_b32 v20, v64
    v_mov_b32 v21, v65
    v_mov_b32 v22, v66
    v_mov_b32 v23, v67
    s_add_u32 s45, s45, 262144
    s_add_u32 s51, s51, 262144
    v_mfma_f32_32x32x8_bf16 v[96:111], v[14:15], v[14:15], 0
    v_mfma_f32_16x16x16_bf16 v[112:115], v[14:15], v[14:15], 0
    v_mfma_f32_16x16x16_bf16 v[116:119], v[14:15], v[14:15], 0
    ds_read_b128 v[64:67], v1 offset:8192
    ds_read_b128 v[68:71], v1 offset:9216
    ds_read_b128 v[72:75], v1 offset:10240
    ds_read_b128 v[76:79], v1 offset:11264
    ds_read_b128 v[80:83], v1 offset:24576
    ds_read_b128 v[84:87], v1 offset:25600
    ds_read_b128 v[88:91], v1 offset:26624
    ds_read_b128 v[92:95], v1 offset:27648
    v_mov_b32 v58, -1
    v_mov_b32 v59, -1
    s_waitcnt vmcnt(0)
mega_kernel_rf_w2_pc:
    buffer_load_dword v36, v13, s[4:7], s47 offen offset:128 sc1
    buffer_load_dword v37, v13, s[4:7], s47 offen offset:1152 sc1
    buffer_load_dword v38, v13, s[4:7], s47 offen offset:2176 sc1
    buffer_load_dword v39, v13, s[4:7], s47 offen offset:3200 sc1
    buffer_load_dword v40, v13, s[4:7], s25 offen offset:128 sc1
    buffer_load_dword v41, v13, s[4:7], s25 offen offset:1152 sc1
    buffer_load_dword v42, v13, s[4:7], s25 offen offset:2176 sc1
    buffer_load_dword v43, v13, s[4:7], s25 offen offset:3200 sc1
    s_waitcnt vmcnt(4)
    v_mfma_f32_16x16x32_bf16 v[52:55], v[36:39], v[24:27], 0
    v_bitop3_b32 v3, s42, v36, v37 bitop3:0x7e
    v_bitop3_b32 v4, s42, v38, v39 bitop3:0x7e
    s_waitcnt vmcnt(2)
    v_or_b32 v3, v3, v4
    v_bitop3_b32 v4, s42, v40, v41 bitop3:0x7e
    s_waitcnt vmcnt(0)
    v_mfma_f32_16x16x32_bf16 v[52:55], v[40:43], v[24:27], v[52:55]
    v_bitop3_b32 v56, s42, v42, v43 bitop3:0x7e
    v_or3_b32 v3, v3, v4, v56
    v_and_b32 v3, v0, v3
    v_cmp_ne_u32 vcc, 0, v3
    s_cbranch_vccnz mega_kernel_rf_w2_pc
    s_nop 2
    v_cvt_pk_bf16_f32 v56, v52, v53
    v_cvt_pk_bf16_f32 v57, v54, v55
    v_min_u32 v56, -2, v56
    s_mov_b64 exec, s[26:27]
    buffer_store_dwordx2 v[56:57], v9, s[4:7], s35 offen offset:128
    buffer_store_dwordx2 v[58:59], v9, s[4:7], s36 offen offset:128
    s_mov_b64 exec, -1
    s_xor_b32 s42, s42, 1
    s_branch mega_kernel_rf_w2_loop
mega_kernel_rf_w2_last:
    s_waitcnt vmcnt(0)
    v_mov_b32 v20, v64
    v_mov_b32 v21, v65
    v_mov_b32 v22, v66
    v_mov_b32 v23, v67
    s_add_u32 s45, s45, 262144
    s_add_u32 s51, s51, 262144
    buffer_store_dwordx4 v[20:23], v10, s[4:7], s45 offen offset:128 sc1
    buffer_store_dwordx2 v[18:19], v11, s[4:7], s51 offen offset:3072 sc1
    s_branch mega_kernel_rf_end
mega_kernel_rf_w2_pafail:
    buffer_load_dwordx4 v[48:51], v12, s[4:7], s22 offen sc1
    buffer_load_dwordx4 v[52:55], v12, s[4:7], s22 offen offset:1024 sc1
    s_nop 7
    v_mov_b32 v96, 0
    v_mov_b32 v97, 0
    v_mov_b32 v98, 0
    v_mov_b32 v99, 0
    v_mov_b32 v100, 0
    v_mov_b32 v101, 0
    v_mov_b32 v102, 0
    v_mov_b32 v103, 0
    v_mov_b32 v104, 0
    v_mov_b32 v105, 0
    v_mov_b32 v106, 0
    v_mov_b32 v107, 0
    s_branch mega_kernel_rf_w2_pa
mega_kernel_rf_w2_xslow:
    buffer_load_dwordx4 v[96:99], v1, s[4:7], s38 offen sc1
    s_waitcnt vmcnt(1)
    v_and_b32 v3, 1, v20
    v_cmp_ne_u32 vcc, s41, v3
    s_cbranch_vccz mega_kernel_rf_w2_xgot1
    buffer_load_dwordx4 v[20:23], v1, s[4:7], s38 offen sc1
mega_kernel_rf_w2_px:
    s_waitcnt vmcnt(1)
    v_and_b32 v3, 1, v96
    v_cmp_ne_u32 vcc, s41, v3
    s_cbranch_vccz mega_kernel_rf_w2_xgot0
    buffer_load_dwordx4 v[96:99], v1, s[4:7], s38 offen sc1
    s_waitcnt vmcnt(1)
    v_and_b32 v3, 1, v20
    v_cmp_ne_u32 vcc, s41, v3
    s_cbranch_vccz mega_kernel_rf_w2_xgot1
    buffer_load_dwordx4 v[20:23], v1, s[4:7], s38 offen sc1
    s_branch mega_kernel_rf_w2_px
mega_kernel_rf_w2_xgot0:
    v_mfma_f32_16x16x16_bf16 v[80:83], v[96:97], v[16:17], v[100:103]
    v_mfma_f32_16x16x16_bf16 v[84:87], v[98:99], v[16:17], v[104:107]
    v_and_b32 v3, 1, v96
    v_cmp_ne_u32 vcc, s41, v3
    s_nop 4
    v_cvt_pk_bf16_f32 v64, v80, v81
    v_cvt_pk_bf16_f32 v65, v82, v83
    v_cvt_pk_bf16_f32 v66, v84, v85
    v_cvt_pk_bf16_f32 v67, v86, v87
    ds_write_b128 v6, v[64:67] offset:14336
    s_branch mega_kernel_rf_w2_xok
mega_kernel_rf_w2_xgot1:
    v_mfma_f32_16x16x16_bf16 v[80:83], v[20:21], v[16:17], v[100:103]
    v_mfma_f32_16x16x16_bf16 v[84:87], v[22:23], v[16:17], v[104:107]
    v_and_b32 v3, 1, v20
    v_cmp_ne_u32 vcc, s41, v3
    s_nop 4
    v_cvt_pk_bf16_f32 v64, v80, v81
    v_cvt_pk_bf16_f32 v65, v82, v83
    v_cvt_pk_bf16_f32 v66, v84, v85
    v_cvt_pk_bf16_f32 v67, v86, v87
    ds_write_b128 v6, v[64:67] offset:14336
    s_branch mega_kernel_rf_w2_xok
mega_kernel_rf_w2_pv0:
    s_waitcnt vmcnt(0)
    s_branch mega_kernel_rf_w2_pv1
mega_kernel_rf_w2_pv:
    buffer_load_dwordx2 v[20:21], v11, s[4:7], s40 offen sc1
    s_waitcnt vmcnt(0)
mega_kernel_rf_w2_pv1:
    v_and_b32 v3, 1, v20
    v_cmp_ne_u32 vcc, s41, v3
    v_mov_b32 v113, v20
    v_mov_b32 v115, v21
    s_cbranch_vccnz mega_kernel_rf_w2_pv
    s_branch mega_kernel_rf_w2_pv2
mega_kernel_rf_w3_entry:
    v_mfma_f32_32x32x8_bf16 v[96:111], v[14:15], v[14:15], 0
    v_mfma_f32_16x16x16_bf16 v[112:115], v[14:15], v[14:15], 0
    v_mfma_f32_16x16x16_bf16 v[116:119], v[14:15], v[14:15], 0
    ds_read_b128 v[64:67], v1 offset:12288
    ds_read_b128 v[68:71], v1 offset:13312
    ds_read_b128 v[72:75], v1 offset:14336
    ds_read_b128 v[76:79], v1 offset:15360
    ds_read_b128 v[80:83], v1 offset:28672
    ds_read_b128 v[84:87], v1 offset:29696
    ds_read_b128 v[88:91], v1 offset:30720
    ds_read_b128 v[92:95], v1 offset:31744
    buffer_load_dwordx4 v[120:123], v1, s[4:7], s44 offen
    buffer_load_dwordx4 v[124:127], v1, s[4:7], s44 offen offset:1024
    s_add_u32 s44, s44, 262144
mega_kernel_rf_w3_loop:
    s_add_u32 s22, s35, 6144
    s_waitcnt vmcnt(0)
    buffer_load_dwordx4 v[56:59], v12, s[4:7], s22 offen sc1
    buffer_load_dwordx4 v[60:63], v12, s[4:7], s22 offen offset:1024 sc1
mega_kernel_rf_w3_pa:
    s_waitcnt vmcnt(1)
    ds_write_b128 v6, v[56:59] offset:6144
    s_waitcnt vmcnt(0)
    ds_write_b128 v6, v[60:63] offset:7168
    v_max3_u32 v3, v56, v58, v60
    v_max_u32 v3, v3, v62
    v_cmp_eq_u32 vcc, -1, v3
    v_smfmac_f32_16x16x64_bf16 v[96:99], v[56:59], a[96:103], v2
    v_smfmac_f32_16x16x64_bf16 v[100:103], v[56:59], a[104:111], v2
    v_smfmac_f32_16x16x64_bf16 v[104:107], v[56:59], a[224:231], v2
    s_cbranch_vccnz mega_kernel_rf_w3_pafail
    s_waitcnt lgkmcnt(0)
    s_barrier
    ds_read_b128 v[32:35], v6 offset:0
    ds_read_b128 v[36:39], v6 offset:1024
    v_smfmac_f32_16x16x64_bf16 v[108:111], v[56:59], a[232:239], v2
    ds_read_b128 v[40:43], v6 offset:2048
    v_smfmac_f32_16x16x64_bf16 v[96:99], v[60:63], a[112:119], v2
    ds_read_b128 v[44:47], v6 offset:3072
    v_smfmac_f32_16x16x64_bf16 v[100:103], v[60:63], a[120:127], v2
    ds_read_b128 v[48:51], v6 offset:4096
    v_smfmac_f32_16x16x64_bf16 v[104:107], v[60:63], a[240:247], v2
    ds_read_b128 v[52:55], v6 offset:5120
    v_smfmac_f32_16x16x64_bf16 v[108:111], v[60:63], a[248:255], v2
    buffer_load_dwordx4 v1, s[4:7], s43 offen lds
    s_waitcnt lgkmcnt(5)
    v_smfmac_f32_16x16x64_bf16 v[96:99], v[32:35], a[0:7], v2
    v_smfmac_f32_16x16x64_bf16 v[100:103], v[32:35], a[8:15], v2
    v_smfmac_f32_16x16x64_bf16 v[104:107], v[32:35], a[128:135], v2
    v_smfmac_f32_16x16x64_bf16 v[108:111], v[32:35], a[136:143], v2
    buffer_load_dwordx4 v1, s[4:7], s43 offen offset:1024 lds
    s_waitcnt lgkmcnt(4)
    v_smfmac_f32_16x16x64_bf16 v[96:99], v[36:39], a[16:23], v2
    v_smfmac_f32_16x16x64_bf16 v[100:103], v[36:39], a[24:31], v2
    v_smfmac_f32_16x16x64_bf16 v[104:107], v[36:39], a[144:151], v2
    v_smfmac_f32_16x16x64_bf16 v[108:111], v[36:39], a[152:159], v2
    buffer_store_dwordx4 v[20:23], v10, s[4:7], s45 offen offset:192 sc1
    s_waitcnt lgkmcnt(3)
    v_smfmac_f32_16x16x64_bf16 v[96:99], v[40:43], a[32:39], v2
    v_smfmac_f32_16x16x64_bf16 v[100:103], v[40:43], a[40:47], v2
    v_smfmac_f32_16x16x64_bf16 v[104:107], v[40:43], a[160:167], v2
    v_smfmac_f32_16x16x64_bf16 v[108:111], v[40:43], a[168:175], v2
    buffer_store_dwordx2 v[18:19], v11, s[4:7], s51 offen offset:3584 sc1
    s_waitcnt lgkmcnt(2)
    v_smfmac_f32_16x16x64_bf16 v[96:99], v[44:47], a[48:55], v2
    v_smfmac_f32_16x16x64_bf16 v[100:103], v[44:47], a[56:63], v2
    v_smfmac_f32_16x16x64_bf16 v[104:107], v[44:47], a[176:183], v2
    v_smfmac_f32_16x16x64_bf16 v[108:111], v[44:47], a[184:191], v2
    buffer_load_dword v4, v7, s[4:7], 0 offen sc1
    s_waitcnt lgkmcnt(1)
    v_smfmac_f32_16x16x64_bf16 v[96:99], v[48:51], a[64:71], v2
    v_smfmac_f32_16x16x64_bf16 v[100:103], v[48:51], a[72:79], v2
    v_smfmac_f32_16x16x64_bf16 v[104:107], v[48:51], a[192:199], v2
    v_smfmac_f32_16x16x64_bf16 v[108:111], v[48:51], a[200:207], v2
    s_waitcnt lgkmcnt(0)
    v_smfmac_f32_16x16x64_bf16 v[96:99], v[52:55], a[80:87], v2
    v_smfmac_f32_16x16x64_bf16 v[100:103], v[52:55], a[88:95], v2
    v_smfmac_f32_16x16x64_bf16 v[104:107], v[52:55], a[208:215], v2
    v_smfmac_f32_16x16x64_bf16 v[108:111], v[52:55], a[216:223], v2
    s_nop 4
    v_pk_add_f32 v[96:97], v[96:97], v[98:99]
    v_pk_add_f32 v[100:101], v[100:101], v[102:103]
    v_pk_add_f32 v[104:105], v[104:105], v[106:107]
    v_pk_add_f32 v[108:109], v[108:109], v[110:111]
    v_cvt_pk_bf16_f32 v111, v108, v109
    v_cvt_pk_bf16_f32 v108, v96, v97
    v_cvt_pk_bf16_f32 v110, v100, v101
    v_cvt_pk_bf16_f32 v109, v104, v105
    v_and_or_b32 v108, v108, -2, s41
    buffer_store_dwordx4 v[108:111], v1, s[4:7], s37 offen sc1
    v_smfmac_f32_16x16x64_bf16 v[112:115], v[32:35], v[64:71], v2
    ds_read_b128 v[64:67], v1 offset:45056
    ds_read_b128 v[68:71], v1 offset:46080
    v_smfmac_f32_16x16x64_bf16 v[116:119], v[32:35], v[72:79], v2
    ds_read_b128 v[72:75], v1 offset:47104
    ds_read_b128 v[76:79], v1 offset:48128
    v_smfmac_f32_16x16x64_bf16 v[112:115], v[36:39], v[80:87], v2
    ds_read_b128 v[80:83], v1 offset:61440
    ds_read_b128 v[84:87], v1 offset:62464
    v_smfmac_f32_16x16x64_bf16 v[116:119], v[36:39], v[88:95], v2
    ds_read_b128 v[88:91], v1 offset:63488
    ds_read_b128 v[92:95], v1 offset:64512
    v_smfmac_f32_16x16x64_bf16 v[112:115], v[52:55], v[208:215], v2
    v_smfmac_f32_16x16x64_bf16 v[116:119], v[52:55], v[216:223], v2
    v_smfmac_f32_16x16x64_bf16 v[112:115], v[56:59], v[224:231], v2
    s_waitcnt lgkmcnt(6)
    v_smfmac_f32_16x16x64_bf16 v[112:115], v[40:43], v[64:71], v2
    ds_read_b128 v[64:67], v5 offset:12288
    ds_read_b128 v[68:71], v5 offset:13312
    s_waitcnt lgkmcnt(6)
    v_smfmac_f32_16x16x64_bf16 v[116:119], v[40:43], v[72:79], v2
    ds_read_b128 v[72:75], v5 offset:14336
    ds_read_b128 v[76:79], v5 offset:15360
    v_smfmac_f32_16x16x64_bf16 v[116:119], v[56:59], v[232:239], v2
    v_smfmac_f32_16x16x64_bf16 v[112:115], v[60:63], v[240:247], v2
    v_smfmac_f32_16x16x64_bf16 v[116:119], v[60:63], v[248:255], v2
    s_waitcnt lgkmcnt(6)
    v_smfmac_f32_16x16x64_bf16 v[112:115], v[44:47], v[80:87], v2
    s_waitcnt lgkmcnt(4)
    v_smfmac_f32_16x16x64_bf16 v[116:119], v[44:47], v[88:95], v2
    s_waitcnt lgkmcnt(2)
    v_smfmac_f32_16x16x64_bf16 v[112:115], v[48:51], v[64:71], v2
    s_waitcnt lgkmcnt(0)
    v_smfmac_f32_16x16x64_bf16 v[116:119], v[48:51], v[72:79], v2
    v_mfma_f32_16x16x16_bf16 v[100:103], v[108:109], v[16:17], 0
    v_mfma_f32_16x16x16_bf16 v[104:107], v[110:111], v[16:17], 0
    s_nop 4
    v_add_f32 v112, v112, v114
    v_add_f32 v113, v113, v115
    v_add_f32 v114, v116, v118
    v_add_f32 v115, v117, v119
    v_cvt_pk_bf16_f32 v18, v112, v113
    v_cvt_pk_bf16_f32 v19, v114, v115
    v_and_or_b32 v18, v18, -2, s41
    v_mov_b32 v112, v18
    v_mov_b32 v114, v19
    v_mov_b32 v92, v28
    v_mov_b32 v93, 0
    s_waitcnt vmcnt(4)
    s_barrier
    ds_read_b128 v[32:35], v6 offset:18432
    ds_read_b128 v[36:39], v6 offset:19456
    ds_read_b128 v[40:43], v6 offset:15360
    ds_read_b128 v[44:47], v6 offset:16384
    ds_read_b128 v[48:51], v6 offset:12288
    ds_read_b128 v[52:55], v6 offset:13312
    ds_read_b128 v[56:59], v6 offset:9216
    ds_read_b128 v[60:63], v6 offset:10240
    buffer_load_dwordx4 v[96:99], v1, s[4:7], s38 offen sc1
    s_barrier
    buffer_store_dwordx2 v[18:19], v11, s[4:7], s39 offen sc1
    s_nop 15
    s_nop 15
    buffer_load_dwordx4 v[20:23], v1, s[4:7], s38 offen sc1
    s_add_u32 s22, s21, 4
    s_cmp_gt_u32 s50, s22
    s_cbranch_scc1 mega_kernel_rf_w3_kvs
    s_waitcnt vmcnt(4)
    v_readlane_b32 s50, v4, 0
    v_readlane_b32 s22, v4, 2
    v_readlane_b32 s23, v4, 1
    v_readlane_b32 s24, v4, 3
    s_nop 3
    s_min_u32 s50, s50, s22
    s_min_u32 s23, s23, s24
    s_lshl_b32 s50, s50, 1
    s_lshl_b32 s23, s23, 1
    s_add_u32 s23, s23, 1
    s_min_u32 s50, s50, s23
mega_kernel_rf_kvb1:
    s_add_u32 s22, s21, 1
    s_min_u32 s22, s22, 63
    s_cmp_gt_u32 s50, s22
    s_cbranch_scc1 mega_kernel_rf_kvd1
    buffer_load_dword v4, v7, s[4:7], 0 offen sc1
    s_waitcnt vmcnt(0)
    v_readlane_b32 s50, v4, 0
    v_readlane_b32 s22, v4, 2
    v_readlane_b32 s23, v4, 1
    v_readlane_b32 s24, v4, 3
    s_nop 3
    s_min_u32 s50, s50, s22
    s_min_u32 s23, s23, s24
    s_lshl_b32 s50, s50, 1
    s_lshl_b32 s23, s23, 1
    s_add_u32 s23, s23, 1
    s_min_u32 s50, s50, s23
    s_branch mega_kernel_rf_kvb1
mega_kernel_rf_kvd1:
mega_kernel_rf_w3_kvs:
    s_waitcnt vmcnt(2)
    v_mfma_f32_16x16x16_bf16 v[80:83], v[96:97], v[16:17], v[100:103]
    v_mfma_f32_16x16x16_bf16 v[84:87], v[98:99], v[16:17], v[104:107]
    v_and_b32 v3, 1, v96
    v_cmp_ne_u32 vcc, s41, v3
    s_nop 4
    v_cvt_pk_bf16_f32 v64, v80, v81
    v_cvt_pk_bf16_f32 v65, v82, v83
    v_cvt_pk_bf16_f32 v66, v84, v85
    v_cvt_pk_bf16_f32 v67, v86, v87
    ds_write_b128 v6, v[64:67] offset:17408
    s_cbranch_vccnz mega_kernel_rf_w3_xslow
mega_kernel_rf_w3_xok:
    buffer_load_dwordx2 v[116:117], v11, s[4:7], s40 offen sc1
    s_waitcnt lgkmcnt(1)
    v_mfma_f32_16x16x32_bf16 v[80:83], v[32:35], v[64:67], 0
    s_waitcnt lgkmcnt(0)
    s_barrier
    ds_read_b128 v[68:71], v6 offset:14336
    ds_read_b128 v[72:75], v6 offset:11264
    ds_read_b128 v[76:79], v6 offset:8192
    v_mfma_f32_16x16x32_bf16 v[84:87], v[36:39], v[64:67], 0
    v_mfma_f32_16x16x32_bf16 v[88:91], v[64:67], v[64:67], 0
    buffer_load_dwordx2 v[20:21], v11, s[4:7], s40 offen sc1
    s_waitcnt lgkmcnt(2)
    v_mfma_f32_16x16x32_bf16 v[80:83], v[40:43], v[68:71], v[80:83]
    v_mfma_f32_16x16x32_bf16 v[84:87], v[44:47], v[68:71], v[84:87]
    v_mfma_f32_16x16x32_bf16 v[88:91], v[68:71], v[68:71], v[88:91]
    s_waitcnt lgkmcnt(1)
    v_mfma_f32_16x16x32_bf16 v[80:83], v[48:51], v[72:75], v[80:83]
    v_mfma_f32_16x16x32_bf16 v[84:87], v[52:55], v[72:75], v[84:87]
    v_mfma_f32_16x16x32_bf16 v[88:91], v[72:75], v[72:75], v[88:91]
    s_waitcnt lgkmcnt(0)
    v_mfma_f32_16x16x32_bf16 v[80:83], v[56:59], v[76:79], v[80:83]
    v_mfma_f32_16x16x32_bf16 v[84:87], v[60:63], v[76:79], v[84:87]
    v_mfma_f32_16x16x32_bf16 v[88:91], v[76:79], v[76:79], v[88:91]
    v_mfma_f32_32x32x4_2b_bf16 v[32:63], v[14:15], v[14:15], 0
    s_nop 4
    v_max3_f32 v4, v80, v81, v82
    v_max3_f32 v4, v4, v83, v84
    v_max3_f32 v4, v4, v85, v86
    v_max3_f32 v4, v4, v87, v88
    v_max_f32 v90, v4, v89
    v_max_f32 v4, v4, v89
    s_nop 0
    s_nop 0
    v_permlane16_swap_b32 v4, v90
    v_max_f32 v4, v4, v90
    v_max_f32 v90, v4, v90
    s_nop 1
    v_permlane32_swap_b32 v4, v90
    v_max_f32 v4, v4, v90
    v_mul_f32 v4, s34, v4
    v_pk_fma_f32 v[80:81], v[80:81], s[34:35], v[4:5] op_sel_hi:[1,0,0] neg_lo:[0,0,1] neg_hi:[0,0,1]
    v_pk_fma_f32 v[82:83], v[82:83], s[34:35], v[4:5] op_sel_hi:[1,0,0] neg_lo:[0,0,1] neg_hi:[0,0,1]
    v_pk_fma_f32 v[84:85], v[84:85], s[34:35], v[4:5] op_sel_hi:[1,0,0] neg_lo:[0,0,1] neg_hi:[0,0,1]
    v_pk_fma_f32 v[86:87], v[86:87], s[34:35], v[4:5] op_sel_hi:[1,0,0] neg_lo:[0,0,1] neg_hi:[0,0,1]
    v_pk_fma_f32 v[88:89], v[88:89], s[34:35], v[4:5] op_sel_hi:[1,0,0] neg_lo:[0,0,1] neg_hi:[0,0,1]
    v_exp_f32 v80, v80
    v_exp_f32 v81, v81
    v_exp_f32 v82, v82
    v_cvt_pk_bf16_f32 v68, v80, v81
    v_exp_f32 v83, v83
    v_exp_f32 v84, v84
    v_cvt_pk_bf16_f32 v69, v82, v83
    v_exp_f32 v85, v85
    v_exp_f32 v86, v86
    v_cvt_pk_bf16_f32 v70, v84, v85
    v_exp_f32 v87, v87
    v_exp_f32 v88, v88
    v_cvt_pk_bf16_f32 v71, v86, v87
    v_exp_f32 v89, v89
    s_cmp_eq_u32 s21, 63
    v_mfma_f32_16x16x32_bf16 v[76:79], v[28:31], v[68:71], 0
    v_cvt_pk_bf16_f32 v72, v88, v89
    v_cvt_pk_bf16_f32 v73, v88, v89
    v_mfma_f32_16x16x32_bf16 v[100:103], v[120:123], v[68:71], 0
    s_waitcnt vmcnt(1)
    v_and_b32 v3, 1, v116
    v_cmp_ne_u32 vcc, s41, v3
    v_mfma_f32_16x16x32_bf16 v[104:107], v[124:127], v[68:71], 0
    v_mov_b32 v113, v116
    v_mov_b32 v115, v117
    v_mfma_f32_16x16x16_bf16 v[76:79], v[92:93], v[72:73], v[76:79]
    s_cbranch_vccnz mega_kernel_rf_w3_pv0
mega_kernel_rf_w3_pv2:
    v_mfma_f32_16x16x16_bf16 v[100:103], v[112:113], v[72:73], v[100:103]
    v_mfma_f32_16x16x16_bf16 v[104:107], v[114:115], v[72:73], v[104:107]
    buffer_load_dwordx4 v[120:123], v1, s[4:7], s44 offen
    buffer_load_dwordx4 v[124:127], v1, s[4:7], s44 offen offset:1024
    s_cmp_eq_u32 s21, 63
    s_nop 1
    v_rcp_f32 v76, v76
    s_cbranch_scc1 mega_kernel_rf_w3_last
    s_mov_b64 exec, s[28:29]
    v_pk_mul_f32 v[100:101], v[100:101], v[76:77] op_sel_hi:[1,0]
    v_pk_mul_f32 v[102:103], v[102:103], v[76:77] op_sel_hi:[1,0]
    v_pk_mul_f32 v[104:105], v[104:105], v[76:77] op_sel_hi:[1,0]
    v_pk_mul_f32 v[106:107], v[106:107], v[76:77] op_sel_hi:[1,0]
    v_cvt_pk_bf16_f32 v72, v100, v101
    v_cvt_pk_bf16_f32 v73, v102, v103
    v_cvt_pk_bf16_f32 v74, v104, v105
    v_cvt_pk_bf16_f32 v75, v106, v107
    ds_write_b128 v6, v[72:75] offset:21504
    s_mov_b64 exec, -1
    ds_read_b128 v[88:91], v5 offset:28672
    ds_read_b128 v[92:95], v5 offset:29696
    ds_read_b128 v[80:83], v5 offset:30720
    ds_read_b128 v[84:87], v5 offset:31744
    ds_read_b128 v[112:115], v5 offset:45056
    ds_read_b128 v[116:119], v5 offset:46080
    s_waitcnt lgkmcnt(6)
    s_barrier
    ds_read_b128 v[68:71], v6 offset:20480
    ds_read_b128 v[72:75], v6 offset:21504
    ds_read_b128 v[96:99], v5 offset:47104
    ds_read_b128 v[100:103], v5 offset:48128
    ds_read_b128 v[104:107], v5 offset:61440
    ds_read_b128 v[108:111], v5 offset:62464
    s_waitcnt lgkmcnt(5)
    v_smfmac_f32_16x16x64_bf16 v[32:35], v[68:71], v[128:135], v2
    s_add_u32 s21, s21, 1
    v_smfmac_f32_16x16x64_bf16 v[36:39], v[68:71], v[136:143], v2
    s_xor_b32 s38, s38, 1048576
    v_smfmac_f32_16x16x64_bf16 v[40:43], v[68:71], v[144:151], v2
    s_xor_b32 s37, s37, 1048576
    v_smfmac_f32_16x16x64_bf16 v[44:47], v[68:71], v[152:159], v2
    s_xor_b32 s40, s40, 1048576
    s_waitcnt lgkmcnt(4)
    v_smfmac_f32_16x16x64_bf16 v[32:35], v[72:75], v[160:167], v2
    s_xor_b32 s39, s39, 1048576
    v_smfmac_f32_16x16x64_bf16 v[36:39], v[72:75], v[168:175], v2
    s_lshr_b32 s41, s21, 1
    v_smfmac_f32_16x16x64_bf16 v[40:43], v[72:75], v[176:183], v2
    s_and_b32 s41, s41, 1
    v_smfmac_f32_16x16x64_bf16 v[44:47], v[72:75], v[184:191], v2
    s_xor_b32 s41, s41, 1
    v_smfmac_f32_16x16x64_bf16 v[48:51], v[68:71], v[192:199], v2
    s_xor_b32 s35, s35, 16384
    v_smfmac_f32_16x16x64_bf16 v[52:55], v[68:71], v[200:207], v2
    s_xor_b32 s36, s36, 16384
    s_waitcnt lgkmcnt(0)
    v_smfmac_f32_16x16x64_bf16 v[56:59], v[68:71], v[88:95], v2
    ds_read_b128 v[88:91], v5 offset:63488
    ds_read_b128 v[92:95], v5 offset:64512
    v_smfmac_f32_16x16x64_bf16 v[60:63], v[68:71], v[80:87], v2
    s_add_u32 s43, s43, 262144
    v_smfmac_f32_16x16x64_bf16 v[48:51], v[72:75], v[112:119], v2
    s_add_u32 s44, s44, 262144
    v_add_f32 v32, v32, v34
    v_add_f32 v33, v33, v35
    v_cvt_pk_bf16_f32 v32, v32, v33
    v_and_or_b32 v32, v32, -2, s42
    v_smfmac_f32_16x16x64_bf16 v[52:55], v[72:75], v[96:103], v2
    v_add_f32 v36, v36, v38
    v_add_f32 v37, v37, v39
    v_cvt_pk_bf16_f32 v33, v36, v37
    v_smfmac_f32_16x16x64_bf16 v[56:59], v[72:75], v[104:111], v2
    v_add_f32 v40, v40, v42
    v_add_f32 v41, v41, v43
    v_cvt_pk_bf16_f32 v34, v40, v41
    s_waitcnt lgkmcnt(0)
    v_smfmac_f32_16x16x64_bf16 v[60:63], v[72:75], v[88:95], v2
    v_add_f32 v44, v44, v46
    v_add_f32 v45, v45, v47
    v_cvt_pk_bf16_f32 v35, v44, v45
    buffer_store_dwordx4 v[32:35], v8, s[4:7], s46 offen
    v_pk_add_f32 v[48:49], v[48:49], v[50:51]
    v_cvt_pk_bf16_f32 v48, v48, v49
    v_and_or_b32 v48, v48, -2, s42
    v_pk_add_f32 v[52:53], v[52:53], v[54:55]
    v_cvt_pk_bf16_f32 v49, v52, v53
    v_pk_add_f32 v[56:57], v[56:57], v[58:59]
    v_cvt_pk_bf16_f32 v50, v56, v57
    v_pk_add_f32 v[60:61], v[60:61], v[62:63]
    v_cvt_pk_bf16_f32 v51, v60, v61
    buffer_store_dwordx4 v[48:51], v8, s[4:7], s61 offen
    s_waitcnt vmcnt(4)
    v_mov_b32 v20, v64
    v_mov_b32 v21, v65
    v_mov_b32 v22, v66
    v_mov_b32 v23, v67
    s_add_u32 s45, s45, 262144
    s_add_u32 s51, s51, 262144
    v_mfma_f32_32x32x8_bf16 v[96:111], v[14:15], v[14:15], 0
    v_mfma_f32_16x16x16_bf16 v[112:115], v[14:15], v[14:15], 0
    v_mfma_f32_16x16x16_bf16 v[116:119], v[14:15], v[14:15], 0
    ds_read_b128 v[64:67], v1 offset:12288
    ds_read_b128 v[68:71], v1 offset:13312
    ds_read_b128 v[72:75], v1 offset:14336
    ds_read_b128 v[76:79], v1 offset:15360
    ds_read_b128 v[80:83], v1 offset:28672
    ds_read_b128 v[84:87], v1 offset:29696
    ds_read_b128 v[88:91], v1 offset:30720
    ds_read_b128 v[92:95], v1 offset:31744
    v_mov_b32 v58, -1
    v_mov_b32 v59, -1
    s_waitcnt vmcnt(0)
mega_kernel_rf_w3_pc:
    buffer_load_dword v36, v13, s[4:7], s47 offen offset:192 sc1
    buffer_load_dword v37, v13, s[4:7], s47 offen offset:1216 sc1
    buffer_load_dword v38, v13, s[4:7], s47 offen offset:2240 sc1
    buffer_load_dword v39, v13, s[4:7], s47 offen offset:3264 sc1
    buffer_load_dword v40, v13, s[4:7], s25 offen offset:192 sc1
    buffer_load_dword v41, v13, s[4:7], s25 offen offset:1216 sc1
    buffer_load_dword v42, v13, s[4:7], s25 offen offset:2240 sc1
    buffer_load_dword v43, v13, s[4:7], s25 offen offset:3264 sc1
    s_waitcnt vmcnt(4)
    v_mfma_f32_16x16x32_bf16 v[52:55], v[36:39], v[24:27], 0
    v_bitop3_b32 v3, s42, v36, v37 bitop3:0x7e
    v_bitop3_b32 v4, s42, v38, v39 bitop3:0x7e
    s_waitcnt vmcnt(2)
    v_or_b32 v3, v3, v4
    v_bitop3_b32 v4, s42, v40, v41 bitop3:0x7e
    s_waitcnt vmcnt(0)
    v_mfma_f32_16x16x32_bf16 v[52:55], v[40:43], v[24:27], v[52:55]
    v_bitop3_b32 v56, s42, v42, v43 bitop3:0x7e
    v_or3_b32 v3, v3, v4, v56
    v_and_b32 v3, v0, v3
    v_cmp_ne_u32 vcc, 0, v3
    s_cbranch_vccnz mega_kernel_rf_w3_pc
    s_nop 2
    v_cvt_pk_bf16_f32 v56, v52, v53
    v_cvt_pk_bf16_f32 v57, v54, v55
    v_min_u32 v56, -2, v56
    s_mov_b64 exec, s[26:27]
    buffer_store_dwordx2 v[56:57], v9, s[4:7], s35 offen offset:192
    buffer_store_dwordx2 v[58:59], v9, s[4:7], s36 offen offset:192
    s_mov_b64 exec, -1
    s_xor_b32 s42, s42, 1
    s_branch mega_kernel_rf_w3_loop
mega_kernel_rf_w3_last:
    s_waitcnt vmcnt(0)
    v_mov_b32 v20, v64
    v_mov_b32 v21, v65
    v_mov_b32 v22, v66
    v_mov_b32 v23, v67
    s_add_u32 s45, s45, 262144
    s_add_u32 s51, s51, 262144
    buffer_store_dwordx4 v[20:23], v10, s[4:7], s45 offen offset:192 sc1
    buffer_store_dwordx2 v[18:19], v11, s[4:7], s51 offen offset:3584 sc1
    s_branch mega_kernel_rf_end
mega_kernel_rf_w3_pafail:
    buffer_load_dwordx4 v[56:59], v12, s[4:7], s22 offen sc1
    buffer_load_dwordx4 v[60:63], v12, s[4:7], s22 offen offset:1024 sc1
    s_nop 7
    v_mov_b32 v96, 0
    v_mov_b32 v97, 0
    v_mov_b32 v98, 0
    v_mov_b32 v99, 0
    v_mov_b32 v100, 0
    v_mov_b32 v101, 0
    v_mov_b32 v102, 0
    v_mov_b32 v103, 0
    v_mov_b32 v104, 0
    v_mov_b32 v105, 0
    v_mov_b32 v106, 0
    v_mov_b32 v107, 0
    s_branch mega_kernel_rf_w3_pa
mega_kernel_rf_w3_xslow:
    buffer_load_dwordx4 v[96:99], v1, s[4:7], s38 offen sc1
    s_waitcnt vmcnt(1)
    v_and_b32 v3, 1, v20
    v_cmp_ne_u32 vcc, s41, v3
    s_cbranch_vccz mega_kernel_rf_w3_xgot1
    buffer_load_dwordx4 v[20:23], v1, s[4:7], s38 offen sc1
mega_kernel_rf_w3_px:
    s_waitcnt vmcnt(1)
    v_and_b32 v3, 1, v96
    v_cmp_ne_u32 vcc, s41, v3
    s_cbranch_vccz mega_kernel_rf_w3_xgot0
    buffer_load_dwordx4 v[96:99], v1, s[4:7], s38 offen sc1
    s_waitcnt vmcnt(1)
    v_and_b32 v3, 1, v20
    v_cmp_ne_u32 vcc, s41, v3
    s_cbranch_vccz mega_kernel_rf_w3_xgot1
    buffer_load_dwordx4 v[20:23], v1, s[4:7], s38 offen sc1
    s_branch mega_kernel_rf_w3_px
mega_kernel_rf_w3_xgot0:
    v_mfma_f32_16x16x16_bf16 v[80:83], v[96:97], v[16:17], v[100:103]
    v_mfma_f32_16x16x16_bf16 v[84:87], v[98:99], v[16:17], v[104:107]
    v_and_b32 v3, 1, v96
    v_cmp_ne_u32 vcc, s41, v3
    s_nop 4
    v_cvt_pk_bf16_f32 v64, v80, v81
    v_cvt_pk_bf16_f32 v65, v82, v83
    v_cvt_pk_bf16_f32 v66, v84, v85
    v_cvt_pk_bf16_f32 v67, v86, v87
    ds_write_b128 v6, v[64:67] offset:17408
    s_branch mega_kernel_rf_w3_xok
mega_kernel_rf_w3_xgot1:
    v_mfma_f32_16x16x16_bf16 v[80:83], v[20:21], v[16:17], v[100:103]
    v_mfma_f32_16x16x16_bf16 v[84:87], v[22:23], v[16:17], v[104:107]
    v_and_b32 v3, 1, v20
    v_cmp_ne_u32 vcc, s41, v3
    s_nop 4
    v_cvt_pk_bf16_f32 v64, v80, v81
    v_cvt_pk_bf16_f32 v65, v82, v83
    v_cvt_pk_bf16_f32 v66, v84, v85
    v_cvt_pk_bf16_f32 v67, v86, v87
    ds_write_b128 v6, v[64:67] offset:17408
    s_branch mega_kernel_rf_w3_xok
mega_kernel_rf_w3_pv0:
    s_waitcnt vmcnt(0)
    s_branch mega_kernel_rf_w3_pv1
mega_kernel_rf_w3_pv:
    buffer_load_dwordx2 v[20:21], v11, s[4:7], s40 offen sc1
    s_waitcnt vmcnt(0)
mega_kernel_rf_w3_pv1:
    v_and_b32 v3, 1, v20
    v_cmp_ne_u32 vcc, s41, v3
    v_mov_b32 v113, v20
    v_mov_b32 v115, v21
    s_cbranch_vccnz mega_kernel_rf_w3_pv
    s_branch mega_kernel_rf_w3_pv2
mega_kernel_rf_end:
    s_mov_b64 exec, -1
    v_mov_b32 v3, 64
    s_waitcnt vmcnt(0)
    s_barrier
    s_cmp_lg_u32 s20, 0
    s_cbranch_scc1 mega_kernel_rf_end2
    buffer_store_dword v3, v7, s[4:7], 0 offen sc1
mega_kernel_rf_end2:
    s_waitcnt vmcnt(0)
    s_endpgm
mega_kernel_recs:
    s_load_dwordx2 s[4:5], s[0:1], 96
    s_load_dwordx2 s[12:13], s[0:1], 88
    s_load_dwordx2 s[50:51], s[0:1], 16
    s_load_dwordx2 s[52:53], s[0:1], 24
    s_load_dwordx2 s[54:55], s[0:1], 32
    s_load_dwordx2 s[56:57], s[0:1], 40
    s_load_dwordx2 s[58:59], s[0:1], 8
    v_lshrrev_b32 v3, 6, v0
    v_and_b32 v40, 63, v0
    v_readfirstlane_b32 s20, v3
    v_lshrrev_b32 v41, 4, v40
    v_and_b32 v42, 15, v40
    v_lshlrev_b32 v1, 4, v40
    s_mov_b32 s49, 0
    s_waitcnt lgkmcnt(0)
    s_mov_b32 s6, 268435456
    s_mov_b32 s7, 0x00020000
    s_mov_b32 s14, 256
    s_mov_b32 s15, 0x00020000
    s_mov_b32 s10, 8388608
    s_mov_b32 s11, 0x00020000
    s_mov_b32 s26, 0x00030003
    s_mov_b32 s27, 0x00030003
    s_mov_b32 s28, 0xcccccccc
    s_mov_b32 s29, 0xcccccccc
    s_mov_b32 s32, 0x33333333
    s_mov_b32 s33, 0x33333333
    s_mov_b32 s34, 0x3e0293ee
    s_lshl_b32 s22, s20, 2
    v_xor_b32 v3, s22, v42
    v_lshlrev_b32 v3, 4, v3
    v_lshl_add_u32 v4, v41, 4, s20
    v_lshl_add_u32 v44, v4, 13, v3
    s_lshl_b32 s22, s30, 22
    s_lshl_b32 s23, s31, 8
    s_add_u32 s22, s22, s23
    v_add_u32 v44, s22, v44
    s_lshr_b32 s22, s20, 1
    s_lshl_b32 s22, s22, 5
    s_and_b32 s23, s20, 1
    s_lshl_b32 s23, s23, 2
    s_add_u32 s22, s22, s23
    s_lshl_b32 s23, s31, 7
    s_add_u32 s22, s22, s23
    v_add_u32 v4, s22, v41
    v_lshl_add_u32 v45, v4, 11, v3
    s_lshl_b32 s22, s30, 10
    v_add_u32 v45, s22, v45
    s_lshl_b32 s48, s20, 10
    s_mov_b32 s8, s50
    s_mov_b32 s9, s51
    s_add_u32 m0, s48, 0
    s_mov_b32 s22, 0
    buffer_load_dwordx4 v44, s[8:11], s22 offen  lds
    s_add_u32 m0, s48, 4096
    s_mov_b32 s22, 32768
    buffer_load_dwordx4 v44, s[8:11], s22 offen  lds
    s_add_u32 m0, s48, 8192
    s_mov_b32 s22, 65536
    buffer_load_dwordx4 v44, s[8:11], s22 offen  lds
    s_add_u32 m0, s48, 12288
    s_mov_b32 s22, 98304
    buffer_load_dwordx4 v44, s[8:11], s22 offen  lds
    s_add_u32 m0, s48, 16384
    s_mov_b32 s22, 524288
    buffer_load_dwordx4 v44, s[8:11], s22 offen  lds
    s_add_u32 m0, s48, 20480
    s_mov_b32 s22, 557056
    buffer_load_dwordx4 v44, s[8:11], s22 offen  lds
    s_add_u32 m0, s48, 24576
    s_mov_b32 s22, 589824
    buffer_load_dwordx4 v44, s[8:11], s22 offen  lds
    s_add_u32 m0, s48, 28672
    s_mov_b32 s22, 622592
    buffer_load_dwordx4 v44, s[8:11], s22 offen  lds
    s_add_u32 m0, s48, 32768
    s_mov_b32 s22, 1048576
    buffer_load_dwordx4 v44, s[8:11], s22 offen  lds
    s_add_u32 m0, s48, 36864
    s_mov_b32 s22, 1081344
    buffer_load_dwordx4 v44, s[8:11], s22 offen  lds
    s_add_u32 m0, s48, 40960
    s_mov_b32 s22, 1114112
    buffer_load_dwordx4 v44, s[8:11], s22 offen  lds
    s_add_u32 m0, s48, 45056
    s_mov_b32 s22, 1146880
    buffer_load_dwordx4 v44, s[8:11], s22 offen  lds
    s_add_u32 m0, s48, 49152
    s_mov_b32 s22, 1572864
    buffer_load_dwordx4 v44, s[8:11], s22 offen  lds
    s_add_u32 m0, s48, 53248
    s_mov_b32 s22, 1605632
    buffer_load_dwordx4 v44, s[8:11], s22 offen  lds
    s_add_u32 m0, s48, 57344
    s_mov_b32 s22, 1638400
    buffer_load_dwordx4 v44, s[8:11], s22 offen  lds
    s_add_u32 m0, s48, 61440
    s_mov_b32 s22, 1671168
    buffer_load_dwordx4 v44, s[8:11], s22 offen  lds
    s_add_u32 m0, s48, 65536
    s_mov_b32 s22, 2097152
    buffer_load_dwordx4 v44, s[8:11], s22 offen  lds
    s_add_u32 m0, s48, 69632
    s_mov_b32 s22, 2129920
    buffer_load_dwordx4 v44, s[8:11], s22 offen  lds
    s_add_u32 m0, s48, 73728
    s_mov_b32 s22, 2162688
    buffer_load_dwordx4 v44, s[8:11], s22 offen  lds
    s_add_u32 m0, s48, 77824
    s_mov_b32 s22, 2195456
    buffer_load_dwordx4 v44, s[8:11], s22 offen  lds
    s_add_u32 m0, s48, 81920
    s_mov_b32 s22, 2621440
    buffer_load_dwordx4 v44, s[8:11], s22 offen  lds
    s_add_u32 m0, s48, 86016
    s_mov_b32 s22, 2654208
    buffer_load_dwordx4 v44, s[8:11], s22 offen  lds
    s_add_u32 m0, s48, 90112
    s_mov_b32 s22, 2686976
    buffer_load_dwordx4 v44, s[8:11], s22 offen  lds
    s_add_u32 m0, s48, 94208
    s_mov_b32 s22, 2719744
    buffer_load_dwordx4 v44, s[8:11], s22 offen  lds
    s_add_u32 m0, s48, 98304
    s_mov_b32 s22, 3145728
    buffer_load_dwordx4 v44, s[8:11], s22 offen  lds
    s_add_u32 m0, s48, 102400
    s_mov_b32 s22, 3178496
    buffer_load_dwordx4 v44, s[8:11], s22 offen  lds
    s_add_u32 m0, s48, 106496
    s_mov_b32 s22, 3211264
    buffer_load_dwordx4 v44, s[8:11], s22 offen  lds
    s_add_u32 m0, s48, 110592
    s_mov_b32 s22, 3244032
    buffer_load_dwordx4 v44, s[8:11], s22 offen  lds
    s_add_u32 m0, s48, 114688
    s_mov_b32 s22, 3670016
    buffer_load_dwordx4 v44, s[8:11], s22 offen  lds
    s_add_u32 m0, s48, 118784
    s_mov_b32 s22, 3702784
    buffer_load_dwordx4 v44, s[8:11], s22 offen  lds
    s_add_u32 m0, s48, 122880
    s_mov_b32 s22, 3735552
    buffer_load_dwordx4 v44, s[8:11], s22 offen  lds
    s_add_u32 m0, s48, 126976
    s_mov_b32 s22, 3768320
    buffer_load_dwordx4 v44, s[8:11], s22 offen  lds
    s_lshl_b32 s22, s30, 5
    s_add_u32 s22, s22, s31
    s_lshl_b32 s38, s22, 14
    s_xor_b32 s22, s22, 32
    s_lshl_b32 s37, s22, 14
    s_add_u32 s38, s38, 67108864
    s_add_u32 s37, s37, 67108864
    s_lshl_b32 s46, s30, 18
    s_add_u32 s46, s46, 70254592
    s_lshl_b32 s22, s31, 13
    s_add_u32 s47, s46, s22
    s_lshl_b32 s22, s20, 16
    s_add_u32 s46, s46, s22
    s_lshl_b32 s22, s31, 8
    s_add_u32 s46, s46, s22
    s_add_u32 s61, s46, 32768
    s_add_u32 s25, s47, 4096
    s_lshl_b32 s35, s30, 13
    s_add_u32 s35, s35, 69206016
    v_lshrrev_b32 v53, 2, v42
    v_lshlrev_b32 v53, 1, v53
    v_and_b32 v54, 1, v42
    v_add_u32 v55, v53, v54
    v_mov_b32 v14, 0
    v_mov_b32 v15, 0
    v_mov_b32 v2, 0x4444
    v_mov_b32 v3, 0xeeee
    v_cndmask_b32 v2, v2, v3, s[28:29]
    s_lshl_b32 s22, s20, 12
    v_add_u32 v32, s22, v1
    v_add_u32 v33, 0x10000, v32
    v_add_u32 v5, 0x10000, v1
    v_add_u32 v6, 131072, v1
    v_and_b32 v3, 3, v42
    v_bfe_u32 v43, v40, 1, 1
    v_lshlrev_b32 v7, 13, v43
    v_and_b32 v43, 1, v40
    v_lshl_add_u32 v7, v43, 7, v7
    s_lshl_b32 s22, s31, 8
    s_add_u32 s23, s22, 71311360
    v_add_u32 v7, s23, v7
    s_cmp_lg_u32 s20, 0
    s_cbranch_scc1 mega_kernel_rs_flk
    s_lshl_b32 s23, s30, 7
    s_add_u32 s22, s22, s23
    s_add_u32 s22, s22, 71327744
    v_bfrev_b32 v7, 1
    v_writelane_b32 v7, s22, 0
mega_kernel_rs_flk:
    v_lshlrev_b32 v11, 3, v40
    v_lshlrev_b32 v10, 8, v55
    v_lshl_add_u32 v10, v41, 4, v10
    v_lshlrev_b32 v8, 13, v41
    v_lshl_add_u32 v8, v42, 4, v8
    v_lshrrev_b32 v9, 1, v41
    v_lshlrev_b32 v9, 5, v9
    v_and_b32 v4, 1, v42
    v_lshl_add_u32 v9, v4, 4, v9
    v_and_b32 v4, 1, v41
    v_lshl_add_u32 v9, v4, 3, v9
    s_lshl_b32 s22, s31, 8
    v_add_u32 v9, s22, v9
    v_lshrrev_b32 v4, 2, v42
    v_lshlrev_b32 v12, 8, v4
    v_lshl_add_u32 v12, v41, 6, v12
    v_lshl_add_u32 v12, v3, 4, v12
    v_lshlrev_b32 v13, 8, v41
    v_lshl_add_u32 v13, v42, 2, v13
    v_cmp_eq_u32 vcc, 0, v3
    v_mov_b32 v28, 0x3f803f80
    v_mov_b32 v29, 0x3f803f80
    v_cndmask_b32 v34, 0, 1, vcc
    v_mov_b32 v30, 0x3f803f80
    v_mov_b32 v31, 0x3f803f80
    v_and_b32 v49, 1, v42
    v_lshlrev_b32 v49, 4, v49
    v_mov_b32 v50, 0x3f80
    v_lshlrev_b32 v50, v49, v50
    v_lshrrev_b32 v51, 2, v42
    v_cmp_eq_u32 vcc, v51, v41
    v_mov_b32 v24, v50
    v_cndmask_b32 v52, 0, v50, s[28:29]
    v_cndmask_b32 v53, 0, v50, s[32:33]
    v_cndmask_b32 v16, 0, v52, vcc
    v_cndmask_b32 v17, 0, v53, vcc
    v_mov_b32 v25, v50
    v_mov_b32 v26, v50
    v_mov_b32 v27, v50
    v_bfe_u32 v60, v40, 3, 1
    v_bfe_u32 v49, v40, 2, 1
    v_and_b32 v50, 1, v41
    v_lshrrev_b32 v51, 1, v41
    v_lshlrev_b32 v52, 3, v60
    v_lshl_add_u32 v52, v50, 2, v52
    v_lshl_add_u32 v53, v51, 4, v52
    v_add_u32 v53, v53, v49
    v_and_b32 v54, 3, v40
    s_lshl_b32 s22, s20, 2
    v_add_u32 v55, s22, v54
    v_xor_b32 v55, v55, v52
    v_lshlrev_b32 v55, 4, v55
    v_lshl_add_u32 v46, v53, 8, v55
    v_lshlrev_b32 v55, 4, v52
    v_lshl_add_u32 v55, v54, 3, v55
    v_lshl_add_u32 v47, v53, 8, v55
    s_waitcnt vmcnt(28)
    s_barrier
    v_add_u32 v48, 0, v46
    ds_read_b64_tr_b16 a[0:1], v48 offset:0
    ds_read_b64_tr_b16 a[2:3], v48 offset:512
    ds_read_b64_tr_b16 a[4:5], v48 offset:8192
    ds_read_b64_tr_b16 a[6:7], v48 offset:8704
    ds_read_b64_tr_b16 a[8:9], v48 offset:8
    ds_read_b64_tr_b16 a[10:11], v48 offset:520
    ds_read_b64_tr_b16 a[12:13], v48 offset:8200
    ds_read_b64_tr_b16 a[14:15], v48 offset:8712
    s_waitcnt lgkmcnt(0)
    s_barrier
    s_mov_b32 s8, s52
    s_mov_b32 s9, s53
    s_add_u32 m0, s48, 0
    s_mov_b32 s22, 0
    buffer_load_dwordx4 v44, s[8:11], s22 offen  lds
    s_add_u32 m0, s48, 4096
    s_mov_b32 s22, 32768
    buffer_load_dwordx4 v44, s[8:11], s22 offen  lds
    s_add_u32 m0, s48, 8192
    s_mov_b32 s22, 65536
    buffer_load_dwordx4 v44, s[8:11], s22 offen  lds
    s_add_u32 m0, s48, 12288
    s_mov_b32 s22, 98304
    buffer_load_dwordx4 v44, s[8:11], s22 offen  lds
    s_waitcnt vmcnt(28)
    s_barrier
    v_add_u32 v48, 16384, v46
    ds_read_b64_tr_b16 a[16:17], v48 offset:0
    ds_read_b64_tr_b16 a[18:19], v48 offset:512
    ds_read_b64_tr_b16 a[20:21], v48 offset:8192
    ds_read_b64_tr_b16 a[22:23], v48 offset:8704
    ds_read_b64_tr_b16 a[24:25], v48 offset:8
    ds_read_b64_tr_b16 a[26:27], v48 offset:520
    ds_read_b64_tr_b16 a[28:29], v48 offset:8200
    ds_read_b64_tr_b16 a[30:31], v48 offset:8712
    s_waitcnt lgkmcnt(0)
    s_barrier
    s_add_u32 m0, s48, 16384
    s_mov_b32 s22, 524288
    buffer_load_dwordx4 v44, s[8:11], s22 offen  lds
    s_add_u32 m0, s48, 20480
    s_mov_b32 s22, 557056
    buffer_load_dwordx4 v44, s[8:11], s22 offen  lds
    s_add_u32 m0, s48, 24576
    s_mov_b32 s22, 589824
    buffer_load_dwordx4 v44, s[8:11], s22 offen  lds
    s_add_u32 m0, s48, 28672
    s_mov_b32 s22, 622592
    buffer_load_dwordx4 v44, s[8:11], s22 offen  lds
    s_waitcnt vmcnt(28)
    s_barrier
    v_add_u32 v48, 32768, v46
    ds_read_b64_tr_b16 a[32:33], v48 offset:0
    ds_read_b64_tr_b16 a[34:35], v48 offset:512
    ds_read_b64_tr_b16 a[36:37], v48 offset:8192
    ds_read_b64_tr_b16 a[38:39], v48 offset:8704
    ds_read_b64_tr_b16 a[40:41], v48 offset:8
    ds_read_b64_tr_b16 a[42:43], v48 offset:520
    ds_read_b64_tr_b16 a[44:45], v48 offset:8200
    ds_read_b64_tr_b16 a[46:47], v48 offset:8712
    s_waitcnt lgkmcnt(0)
    s_barrier
    s_add_u32 m0, s48, 32768
    s_mov_b32 s22, 1048576
    buffer_load_dwordx4 v44, s[8:11], s22 offen  lds
    s_add_u32 m0, s48, 36864
    s_mov_b32 s22, 1081344
    buffer_load_dwordx4 v44, s[8:11], s22 offen  lds
    s_add_u32 m0, s48, 40960
    s_mov_b32 s22, 1114112
    buffer_load_dwordx4 v44, s[8:11], s22 offen  lds
    s_add_u32 m0, s48, 45056
    s_mov_b32 s22, 1146880
    buffer_load_dwordx4 v44, s[8:11], s22 offen  lds
    s_waitcnt vmcnt(28)
    s_barrier
    v_add_u32 v48, 49152, v46
    ds_read_b64_tr_b16 a[48:49], v48 offset:0
    ds_read_b64_tr_b16 a[50:51], v48 offset:512
    ds_read_b64_tr_b16 a[52:53], v48 offset:8192
    ds_read_b64_tr_b16 a[54:55], v48 offset:8704
    ds_read_b64_tr_b16 a[56:57], v48 offset:8
    ds_read_b64_tr_b16 a[58:59], v48 offset:520
    ds_read_b64_tr_b16 a[60:61], v48 offset:8200
    ds_read_b64_tr_b16 a[62:63], v48 offset:8712
    s_waitcnt lgkmcnt(0)
    s_barrier
    s_add_u32 m0, s48, 49152
    s_mov_b32 s22, 1572864
    buffer_load_dwordx4 v44, s[8:11], s22 offen  lds
    s_add_u32 m0, s48, 53248
    s_mov_b32 s22, 1605632
    buffer_load_dwordx4 v44, s[8:11], s22 offen  lds
    s_add_u32 m0, s48, 57344
    s_mov_b32 s22, 1638400
    buffer_load_dwordx4 v44, s[8:11], s22 offen  lds
    s_add_u32 m0, s48, 61440
    s_mov_b32 s22, 1671168
    buffer_load_dwordx4 v44, s[8:11], s22 offen  lds
    s_waitcnt vmcnt(28)
    s_barrier
    v_add_u32 v48, 65536, v46
    ds_read_b64_tr_b16 a[64:65], v48 offset:0
    ds_read_b64_tr_b16 a[66:67], v48 offset:512
    ds_read_b64_tr_b16 a[68:69], v48 offset:8192
    ds_read_b64_tr_b16 a[70:71], v48 offset:8704
    ds_read_b64_tr_b16 a[72:73], v48 offset:8
    ds_read_b64_tr_b16 a[74:75], v48 offset:520
    ds_read_b64_tr_b16 a[76:77], v48 offset:8200
    ds_read_b64_tr_b16 a[78:79], v48 offset:8712
    s_waitcnt lgkmcnt(0)
    s_barrier
    s_add_u32 m0, s48, 65536
    s_mov_b32 s22, 2097152
    buffer_load_dwordx4 v44, s[8:11], s22 offen  lds
    s_add_u32 m0, s48, 69632
    s_mov_b32 s22, 2129920
    buffer_load_dwordx4 v44, s[8:11], s22 offen  lds
    s_add_u32 m0, s48, 73728
    s_mov_b32 s22, 2162688
    buffer_load_dwordx4 v44, s[8:11], s22 offen  lds
    s_add_u32 m0, s48, 77824
    s_mov_b32 s22, 2195456
    buffer_load_dwordx4 v44, s[8:11], s22 offen  lds
    s_waitcnt vmcnt(28)
    s_barrier
    v_add_u32 v48, 81920, v46
    ds_read_b64_tr_b16 a[80:81], v48 offset:0
    ds_read_b64_tr_b16 a[82:83], v48 offset:512
    ds_read_b64_tr_b16 a[84:85], v48 offset:8192
    ds_read_b64_tr_b16 a[86:87], v48 offset:8704
    ds_read_b64_tr_b16 a[88:89], v48 offset:8
    ds_read_b64_tr_b16 a[90:91], v48 offset:520
    ds_read_b64_tr_b16 a[92:93], v48 offset:8200
    ds_read_b64_tr_b16 a[94:95], v48 offset:8712
    s_waitcnt lgkmcnt(0)
    s_barrier
    s_add_u32 m0, s48, 81920
    s_mov_b32 s22, 2621440
    buffer_load_dwordx4 v44, s[8:11], s22 offen  lds
    s_add_u32 m0, s48, 86016
    s_mov_b32 s22, 2654208
    buffer_load_dwordx4 v44, s[8:11], s22 offen  lds
    s_add_u32 m0, s48, 90112
    s_mov_b32 s22, 2686976
    buffer_load_dwordx4 v44, s[8:11], s22 offen  lds
    s_add_u32 m0, s48, 94208
    s_mov_b32 s22, 2719744
    buffer_load_dwordx4 v44, s[8:11], s22 offen  lds
    s_waitcnt vmcnt(28)
    s_barrier
    v_add_u32 v48, 98304, v46
    ds_read_b64_tr_b16 a[96:97], v48 offset:0
    ds_read_b64_tr_b16 a[98:99], v48 offset:512
    ds_read_b64_tr_b16 a[100:101], v48 offset:8192
    ds_read_b64_tr_b16 a[102:103], v48 offset:8704
    ds_read_b64_tr_b16 a[104:105], v48 offset:8
    ds_read_b64_tr_b16 a[106:107], v48 offset:520
    ds_read_b64_tr_b16 a[108:109], v48 offset:8200
    ds_read_b64_tr_b16 a[110:111], v48 offset:8712
    s_waitcnt lgkmcnt(0)
    s_barrier
    s_add_u32 m0, s48, 98304
    s_mov_b32 s22, 3145728
    buffer_load_dwordx4 v44, s[8:11], s22 offen  lds
    s_add_u32 m0, s48, 102400
    s_mov_b32 s22, 3178496
    buffer_load_dwordx4 v44, s[8:11], s22 offen  lds
    s_add_u32 m0, s48, 106496
    s_mov_b32 s22, 3211264
    buffer_load_dwordx4 v44, s[8:11], s22 offen  lds
    s_add_u32 m0, s48, 110592
    s_mov_b32 s22, 3244032
    buffer_load_dwordx4 v44, s[8:11], s22 offen  lds
    s_waitcnt vmcnt(28)
    s_barrier
    v_add_u32 v48, 114688, v46
    ds_read_b64_tr_b16 a[112:113], v48 offset:0
    ds_read_b64_tr_b16 a[114:115], v48 offset:512
    ds_read_b64_tr_b16 a[116:117], v48 offset:8192
    ds_read_b64_tr_b16 a[118:119], v48 offset:8704
    ds_read_b64_tr_b16 a[120:121], v48 offset:8
    ds_read_b64_tr_b16 a[122:123], v48 offset:520
    ds_read_b64_tr_b16 a[124:125], v48 offset:8200
    ds_read_b64_tr_b16 a[126:127], v48 offset:8712
    s_waitcnt lgkmcnt(0)
    s_barrier
    s_add_u32 m0, s48, 114688
    s_mov_b32 s22, 3670016
    buffer_load_dwordx4 v44, s[8:11], s22 offen  lds
    s_add_u32 m0, s48, 118784
    s_mov_b32 s22, 3702784
    buffer_load_dwordx4 v44, s[8:11], s22 offen  lds
    s_add_u32 m0, s48, 122880
    s_mov_b32 s22, 3735552
    buffer_load_dwordx4 v44, s[8:11], s22 offen  lds
    s_add_u32 m0, s48, 126976
    s_mov_b32 s22, 3768320
    buffer_load_dwordx4 v44, s[8:11], s22 offen  lds
    s_waitcnt vmcnt(28)
    s_barrier
    v_add_u32 v48, 0, v46
    ds_read_b64_tr_b16 a[128:129], v48 offset:0
    ds_read_b64_tr_b16 a[130:131], v48 offset:512
    ds_read_b64_tr_b16 a[132:133], v48 offset:8192
    ds_read_b64_tr_b16 a[134:135], v48 offset:8704
    ds_read_b64_tr_b16 a[136:137], v48 offset:8
    ds_read_b64_tr_b16 a[138:139], v48 offset:520
    ds_read_b64_tr_b16 a[140:141], v48 offset:8200
    ds_read_b64_tr_b16 a[142:143], v48 offset:8712
    s_waitcnt lgkmcnt(0)
    s_barrier
    s_mov_b32 s8, s56
    s_mov_b32 s9, s57
    s_add_u32 m0, s48, 0
    s_mov_b32 s22, 0
    buffer_load_dwordx4 v45, s[8:11], s22 offen  lds
    s_add_u32 m0, s48, 4096
    s_mov_b32 s22, 16384
    buffer_load_dwordx4 v45, s[8:11], s22 offen  lds
    s_add_u32 m0, s48, 8192
    s_mov_b32 s22, 32768
    buffer_load_dwordx4 v45, s[8:11], s22 offen  lds
    s_add_u32 m0, s48, 12288
    s_mov_b32 s22, 49152
    buffer_load_dwordx4 v45, s[8:11], s22 offen  lds
    s_waitcnt vmcnt(28)
    s_barrier
    v_add_u32 v48, 16384, v46
    ds_read_b64_tr_b16 a[144:145], v48 offset:0
    ds_read_b64_tr_b16 a[146:147], v48 offset:512
    ds_read_b64_tr_b16 a[148:149], v48 offset:8192
    ds_read_b64_tr_b16 a[150:151], v48 offset:8704
    ds_read_b64_tr_b16 a[152:153], v48 offset:8
    ds_read_b64_tr_b16 a[154:155], v48 offset:520
    ds_read_b64_tr_b16 a[156:157], v48 offset:8200
    ds_read_b64_tr_b16 a[158:159], v48 offset:8712
    s_waitcnt lgkmcnt(0)
    s_barrier
    s_add_u32 m0, s48, 16384
    s_mov_b32 s22, 256
    buffer_load_dwordx4 v45, s[8:11], s22 offen  lds
    s_add_u32 m0, s48, 20480
    s_mov_b32 s22, 16640
    buffer_load_dwordx4 v45, s[8:11], s22 offen  lds
    s_add_u32 m0, s48, 24576
    s_mov_b32 s22, 33024
    buffer_load_dwordx4 v45, s[8:11], s22 offen  lds
    s_add_u32 m0, s48, 28672
    s_mov_b32 s22, 49408
    buffer_load_dwordx4 v45, s[8:11], s22 offen  lds
    s_waitcnt vmcnt(28)
    s_barrier
    v_add_u32 v48, 32768, v46
    ds_read_b64_tr_b16 a[160:161], v48 offset:0
    ds_read_b64_tr_b16 a[162:163], v48 offset:512
    ds_read_b64_tr_b16 a[164:165], v48 offset:8192
    ds_read_b64_tr_b16 a[166:167], v48 offset:8704
    ds_read_b64_tr_b16 a[168:169], v48 offset:8
    ds_read_b64_tr_b16 a[170:171], v48 offset:520
    ds_read_b64_tr_b16 a[172:173], v48 offset:8200
    ds_read_b64_tr_b16 a[174:175], v48 offset:8712
    s_waitcnt lgkmcnt(0)
    s_barrier
    s_add_u32 m0, s48, 32768
    s_mov_b32 s22, 512
    buffer_load_dwordx4 v45, s[8:11], s22 offen  lds
    s_add_u32 m0, s48, 36864
    s_mov_b32 s22, 16896
    buffer_load_dwordx4 v45, s[8:11], s22 offen  lds
    s_add_u32 m0, s48, 40960
    s_mov_b32 s22, 33280
    buffer_load_dwordx4 v45, s[8:11], s22 offen  lds
    s_add_u32 m0, s48, 45056
    s_mov_b32 s22, 49664
    buffer_load_dwordx4 v45, s[8:11], s22 offen  lds
    s_waitcnt vmcnt(28)
    s_barrier
    v_add_u32 v48, 49152, v46
    ds_read_b64_tr_b16 a[176:177], v48 offset:0
    ds_read_b64_tr_b16 a[178:179], v48 offset:512
    ds_read_b64_tr_b16 a[180:181], v48 offset:8192
    ds_read_b64_tr_b16 a[182:183], v48 offset:8704
    ds_read_b64_tr_b16 a[184:185], v48 offset:8
    ds_read_b64_tr_b16 a[186:187], v48 offset:520
    ds_read_b64_tr_b16 a[188:189], v48 offset:8200
    ds_read_b64_tr_b16 a[190:191], v48 offset:8712
    s_waitcnt lgkmcnt(0)
    s_barrier
    s_add_u32 m0, s48, 49152
    s_mov_b32 s22, 768
    buffer_load_dwordx4 v45, s[8:11], s22 offen  lds
    s_add_u32 m0, s48, 53248
    s_mov_b32 s22, 17152
    buffer_load_dwordx4 v45, s[8:11], s22 offen  lds
    s_add_u32 m0, s48, 57344
    s_mov_b32 s22, 33536
    buffer_load_dwordx4 v45, s[8:11], s22 offen  lds
    s_add_u32 m0, s48, 61440
    s_mov_b32 s22, 49920
    buffer_load_dwordx4 v45, s[8:11], s22 offen  lds
    s_waitcnt vmcnt(28)
    s_barrier
    v_add_u32 v48, 65536, v46
    ds_read_b64_tr_b16 a[192:193], v48 offset:0
    ds_read_b64_tr_b16 a[194:195], v48 offset:512
    ds_read_b64_tr_b16 a[196:197], v48 offset:8192
    ds_read_b64_tr_b16 a[198:199], v48 offset:8704
    ds_read_b64_tr_b16 a[200:201], v48 offset:8
    ds_read_b64_tr_b16 a[202:203], v48 offset:520
    ds_read_b64_tr_b16 a[204:205], v48 offset:8200
    ds_read_b64_tr_b16 a[206:207], v48 offset:8712
    s_waitcnt lgkmcnt(0)
    s_barrier
    s_add_u32 m0, s48, 65536
    s_mov_b32 s22, 131072
    buffer_load_dwordx4 v45, s[8:11], s22 offen  lds
    s_add_u32 m0, s48, 69632
    s_mov_b32 s22, 147456
    buffer_load_dwordx4 v45, s[8:11], s22 offen  lds
    s_add_u32 m0, s48, 73728
    s_mov_b32 s22, 163840
    buffer_load_dwordx4 v45, s[8:11], s22 offen  lds
    s_add_u32 m0, s48, 77824
    s_mov_b32 s22, 180224
    buffer_load_dwordx4 v45, s[8:11], s22 offen  lds
    s_waitcnt vmcnt(28)
    s_barrier
    v_add_u32 v48, 81920, v46
    ds_read_b64_tr_b16 a[208:209], v48 offset:0
    ds_read_b64_tr_b16 a[210:211], v48 offset:512
    ds_read_b64_tr_b16 a[212:213], v48 offset:8192
    ds_read_b64_tr_b16 a[214:215], v48 offset:8704
    ds_read_b64_tr_b16 a[216:217], v48 offset:8
    ds_read_b64_tr_b16 a[218:219], v48 offset:520
    ds_read_b64_tr_b16 a[220:221], v48 offset:8200
    ds_read_b64_tr_b16 a[222:223], v48 offset:8712
    s_waitcnt lgkmcnt(0)
    s_barrier
    s_add_u32 m0, s48, 81920
    s_mov_b32 s22, 131328
    buffer_load_dwordx4 v45, s[8:11], s22 offen  lds
    s_add_u32 m0, s48, 86016
    s_mov_b32 s22, 147712
    buffer_load_dwordx4 v45, s[8:11], s22 offen  lds
    s_add_u32 m0, s48, 90112
    s_mov_b32 s22, 164096
    buffer_load_dwordx4 v45, s[8:11], s22 offen  lds
    s_add_u32 m0, s48, 94208
    s_mov_b32 s22, 180480
    buffer_load_dwordx4 v45, s[8:11], s22 offen  lds
    s_waitcnt vmcnt(28)
    s_barrier
    v_add_u32 v48, 98304, v46
    ds_read_b64_tr_b16 a[224:225], v48 offset:0
    ds_read_b64_tr_b16 a[226:227], v48 offset:512
    ds_read_b64_tr_b16 a[228:229], v48 offset:8192
    ds_read_b64_tr_b16 a[230:231], v48 offset:8704
    ds_read_b64_tr_b16 a[232:233], v48 offset:8
    ds_read_b64_tr_b16 a[234:235], v48 offset:520
    ds_read_b64_tr_b16 a[236:237], v48 offset:8200
    ds_read_b64_tr_b16 a[238:239], v48 offset:8712
    s_waitcnt lgkmcnt(0)
    s_barrier
    s_add_u32 m0, s48, 98304
    s_mov_b32 s22, 131584
    buffer_load_dwordx4 v45, s[8:11], s22 offen  lds
    s_add_u32 m0, s48, 102400
    s_mov_b32 s22, 147968
    buffer_load_dwordx4 v45, s[8:11], s22 offen  lds
    s_add_u32 m0, s48, 106496
    s_mov_b32 s22, 164352
    buffer_load_dwordx4 v45, s[8:11], s22 offen  lds
    s_add_u32 m0, s48, 110592
    s_mov_b32 s22, 180736
    buffer_load_dwordx4 v45, s[8:11], s22 offen  lds
    s_waitcnt vmcnt(28)
    s_barrier
    v_add_u32 v48, 114688, v46
    ds_read_b64_tr_b16 a[240:241], v48 offset:0
    ds_read_b64_tr_b16 a[242:243], v48 offset:512
    ds_read_b64_tr_b16 a[244:245], v48 offset:8192
    ds_read_b64_tr_b16 a[246:247], v48 offset:8704
    ds_read_b64_tr_b16 a[248:249], v48 offset:8
    ds_read_b64_tr_b16 a[250:251], v48 offset:520
    ds_read_b64_tr_b16 a[252:253], v48 offset:8200
    ds_read_b64_tr_b16 a[254:255], v48 offset:8712
    s_waitcnt lgkmcnt(0)
    s_barrier
    s_add_u32 m0, s48, 114688
    s_mov_b32 s22, 131840
    buffer_load_dwordx4 v45, s[8:11], s22 offen  lds
    s_add_u32 m0, s48, 118784
    s_mov_b32 s22, 148224
    buffer_load_dwordx4 v45, s[8:11], s22 offen  lds
    s_add_u32 m0, s48, 122880
    s_mov_b32 s22, 164608
    buffer_load_dwordx4 v45, s[8:11], s22 offen  lds
    s_add_u32 m0, s48, 126976
    s_mov_b32 s22, 180992
    buffer_load_dwordx4 v45, s[8:11], s22 offen  lds
    s_waitcnt vmcnt(28)
    s_barrier
    s_cmp_lg_u32 s20, 0
    s_cbranch_scc1 mega_kernel_rs_wo0
    v_xor_b32 v48, 0, v47
    v_add_u32 v48, 0, v48
    ds_read_b64_tr_b16 v[128:129], v48 offset:0
    ds_read_b64_tr_b16 v[130:131], v48 offset:512
    ds_read_b64_tr_b16 v[132:133], v48 offset:8192
    ds_read_b64_tr_b16 v[134:135], v48 offset:8704
    ds_read_b64_tr_b16 v[136:137], v48 offset:32
    ds_read_b64_tr_b16 v[138:139], v48 offset:544
    ds_read_b64_tr_b16 v[140:141], v48 offset:8224
    ds_read_b64_tr_b16 v[142:143], v48 offset:8736
    s_waitcnt lgkmcnt(0)
    v_xor_b32 v48, 64, v47
    v_add_u32 v48, 0, v48
    ds_read_b64_tr_b16 v[144:145], v48 offset:0
    ds_read_b64_tr_b16 v[146:147], v48 offset:512
    ds_read_b64_tr_b16 v[148:149], v48 offset:8192
    ds_read_b64_tr_b16 v[150:151], v48 offset:8704
    ds_read_b64_tr_b16 v[152:153], v48 offset:32
    ds_read_b64_tr_b16 v[154:155], v48 offset:544
    ds_read_b64_tr_b16 v[156:157], v48 offset:8224
    ds_read_b64_tr_b16 v[158:159], v48 offset:8736
    s_waitcnt lgkmcnt(0)
    v_xor_b32 v48, 128, v47
    v_add_u32 v48, 0, v48
    ds_read_b64_tr_b16 v[192:193], v48 offset:0
    ds_read_b64_tr_b16 v[194:195], v48 offset:512
    ds_read_b64_tr_b16 v[196:197], v48 offset:8192
    ds_read_b64_tr_b16 v[198:199], v48 offset:8704
    ds_read_b64_tr_b16 v[200:201], v48 offset:32
    ds_read_b64_tr_b16 v[202:203], v48 offset:544
    ds_read_b64_tr_b16 v[204:205], v48 offset:8224
    ds_read_b64_tr_b16 v[206:207], v48 offset:8736
    s_waitcnt lgkmcnt(0)
    v_xor_b32 v48, 192, v47
    v_add_u32 v48, 0, v48
    ds_read_b64_tr_b16 v[80:81], v48 offset:0
    ds_read_b64_tr_b16 v[82:83], v48 offset:512
    ds_read_b64_tr_b16 v[84:85], v48 offset:8192
    ds_read_b64_tr_b16 v[86:87], v48 offset:8704
    ds_read_b64_tr_b16 v[88:89], v48 offset:32
    ds_read_b64_tr_b16 v[90:91], v48 offset:544
    ds_read_b64_tr_b16 v[92:93], v48 offset:8224
    ds_read_b64_tr_b16 v[94:95], v48 offset:8736
    s_waitcnt lgkmcnt(0)
mega_kernel_rs_wo0:
    s_barrier
    s_mov_b32 s8, s54
    s_mov_b32 s9, s55
    s_add_u32 m0, s48, 0
    s_mov_b32 s22, 0
    buffer_load_dwordx4 v44, s[8:11], s22 offen  lds
    s_add_u32 m0, s48, 4096
    s_mov_b32 s22, 32768
    buffer_load_dwordx4 v44, s[8:11], s22 offen  lds
    s_add_u32 m0, s48, 8192
    s_mov_b32 s22, 65536
    buffer_load_dwordx4 v44, s[8:11], s22 offen  lds
    s_add_u32 m0, s48, 12288
    s_mov_b32 s22, 98304
    buffer_load_dwordx4 v44, s[8:11], s22 offen  lds
    s_waitcnt vmcnt(28)
    s_barrier
    s_cmp_lg_u32 s20, 1
    s_cbranch_scc1 mega_kernel_rs_wo1
    v_xor_b32 v48, 0, v47
    v_add_u32 v48, 16384, v48
    ds_read_b64_tr_b16 v[128:129], v48 offset:0
    ds_read_b64_tr_b16 v[130:131], v48 offset:512
    ds_read_b64_tr_b16 v[132:133], v48 offset:8192
    ds_read_b64_tr_b16 v[134:135], v48 offset:8704
    ds_read_b64_tr_b16 v[136:137], v48 offset:32
    ds_read_b64_tr_b16 v[138:139], v48 offset:544
    ds_read_b64_tr_b16 v[140:141], v48 offset:8224
    ds_read_b64_tr_b16 v[142:143], v48 offset:8736
    s_waitcnt lgkmcnt(0)
    v_xor_b32 v48, 64, v47
    v_add_u32 v48, 16384, v48
    ds_read_b64_tr_b16 v[144:145], v48 offset:0
    ds_read_b64_tr_b16 v[146:147], v48 offset:512
    ds_read_b64_tr_b16 v[148:149], v48 offset:8192
    ds_read_b64_tr_b16 v[150:151], v48 offset:8704
    ds_read_b64_tr_b16 v[152:153], v48 offset:32
    ds_read_b64_tr_b16 v[154:155], v48 offset:544
    ds_read_b64_tr_b16 v[156:157], v48 offset:8224
    ds_read_b64_tr_b16 v[158:159], v48 offset:8736
    s_waitcnt lgkmcnt(0)
    v_xor_b32 v48, 128, v47
    v_add_u32 v48, 16384, v48
    ds_read_b64_tr_b16 v[192:193], v48 offset:0
    ds_read_b64_tr_b16 v[194:195], v48 offset:512
    ds_read_b64_tr_b16 v[196:197], v48 offset:8192
    ds_read_b64_tr_b16 v[198:199], v48 offset:8704
    ds_read_b64_tr_b16 v[200:201], v48 offset:32
    ds_read_b64_tr_b16 v[202:203], v48 offset:544
    ds_read_b64_tr_b16 v[204:205], v48 offset:8224
    ds_read_b64_tr_b16 v[206:207], v48 offset:8736
    s_waitcnt lgkmcnt(0)
    v_xor_b32 v48, 192, v47
    v_add_u32 v48, 16384, v48
    ds_read_b64_tr_b16 v[80:81], v48 offset:0
    ds_read_b64_tr_b16 v[82:83], v48 offset:512
    ds_read_b64_tr_b16 v[84:85], v48 offset:8192
    ds_read_b64_tr_b16 v[86:87], v48 offset:8704
    ds_read_b64_tr_b16 v[88:89], v48 offset:32
    ds_read_b64_tr_b16 v[90:91], v48 offset:544
    ds_read_b64_tr_b16 v[92:93], v48 offset:8224
    ds_read_b64_tr_b16 v[94:95], v48 offset:8736
    s_waitcnt lgkmcnt(0)
mega_kernel_rs_wo1:
    s_barrier
    s_add_u32 m0, s48, 16384
    s_mov_b32 s22, 524288
    buffer_load_dwordx4 v44, s[8:11], s22 offen  lds
    s_add_u32 m0, s48, 20480
    s_mov_b32 s22, 557056
    buffer_load_dwordx4 v44, s[8:11], s22 offen  lds
    s_add_u32 m0, s48, 24576
    s_mov_b32 s22, 589824
    buffer_load_dwordx4 v44, s[8:11], s22 offen  lds
    s_add_u32 m0, s48, 28672
    s_mov_b32 s22, 622592
    buffer_load_dwordx4 v44, s[8:11], s22 offen  lds
    s_waitcnt vmcnt(28)
    s_barrier
    s_cmp_lg_u32 s20, 2
    s_cbranch_scc1 mega_kernel_rs_wo2
    v_xor_b32 v48, 0, v47
    v_add_u32 v48, 32768, v48
    ds_read_b64_tr_b16 v[128:129], v48 offset:0
    ds_read_b64_tr_b16 v[130:131], v48 offset:512
    ds_read_b64_tr_b16 v[132:133], v48 offset:8192
    ds_read_b64_tr_b16 v[134:135], v48 offset:8704
    ds_read_b64_tr_b16 v[136:137], v48 offset:32
    ds_read_b64_tr_b16 v[138:139], v48 offset:544
    ds_read_b64_tr_b16 v[140:141], v48 offset:8224
    ds_read_b64_tr_b16 v[142:143], v48 offset:8736
    s_waitcnt lgkmcnt(0)
    v_xor_b32 v48, 64, v47
    v_add_u32 v48, 32768, v48
    ds_read_b64_tr_b16 v[144:145], v48 offset:0
    ds_read_b64_tr_b16 v[146:147], v48 offset:512
    ds_read_b64_tr_b16 v[148:149], v48 offset:8192
    ds_read_b64_tr_b16 v[150:151], v48 offset:8704
    ds_read_b64_tr_b16 v[152:153], v48 offset:32
    ds_read_b64_tr_b16 v[154:155], v48 offset:544
    ds_read_b64_tr_b16 v[156:157], v48 offset:8224
    ds_read_b64_tr_b16 v[158:159], v48 offset:8736
    s_waitcnt lgkmcnt(0)
    v_xor_b32 v48, 128, v47
    v_add_u32 v48, 32768, v48
    ds_read_b64_tr_b16 v[192:193], v48 offset:0
    ds_read_b64_tr_b16 v[194:195], v48 offset:512
    ds_read_b64_tr_b16 v[196:197], v48 offset:8192
    ds_read_b64_tr_b16 v[198:199], v48 offset:8704
    ds_read_b64_tr_b16 v[200:201], v48 offset:32
    ds_read_b64_tr_b16 v[202:203], v48 offset:544
    ds_read_b64_tr_b16 v[204:205], v48 offset:8224
    ds_read_b64_tr_b16 v[206:207], v48 offset:8736
    s_waitcnt lgkmcnt(0)
    v_xor_b32 v48, 192, v47
    v_add_u32 v48, 32768, v48
    ds_read_b64_tr_b16 v[80:81], v48 offset:0
    ds_read_b64_tr_b16 v[82:83], v48 offset:512
    ds_read_b64_tr_b16 v[84:85], v48 offset:8192
    ds_read_b64_tr_b16 v[86:87], v48 offset:8704
    ds_read_b64_tr_b16 v[88:89], v48 offset:32
    ds_read_b64_tr_b16 v[90:91], v48 offset:544
    ds_read_b64_tr_b16 v[92:93], v48 offset:8224
    ds_read_b64_tr_b16 v[94:95], v48 offset:8736
    s_waitcnt lgkmcnt(0)
mega_kernel_rs_wo2:
    s_barrier
    s_add_u32 m0, s48, 32768
    s_mov_b32 s22, 1048576
    buffer_load_dwordx4 v44, s[8:11], s22 offen  lds
    s_add_u32 m0, s48, 36864
    s_mov_b32 s22, 1081344
    buffer_load_dwordx4 v44, s[8:11], s22 offen  lds
    s_add_u32 m0, s48, 40960
    s_mov_b32 s22, 1114112
    buffer_load_dwordx4 v44, s[8:11], s22 offen  lds
    s_add_u32 m0, s48, 45056
    s_mov_b32 s22, 1146880
    buffer_load_dwordx4 v44, s[8:11], s22 offen  lds
    s_waitcnt vmcnt(28)
    s_barrier
    s_cmp_lg_u32 s20, 3
    s_cbranch_scc1 mega_kernel_rs_wo3
    v_xor_b32 v48, 0, v47
    v_add_u32 v48, 49152, v48
    ds_read_b64_tr_b16 v[128:129], v48 offset:0
    ds_read_b64_tr_b16 v[130:131], v48 offset:512
    ds_read_b64_tr_b16 v[132:133], v48 offset:8192
    ds_read_b64_tr_b16 v[134:135], v48 offset:8704
    ds_read_b64_tr_b16 v[136:137], v48 offset:32
    ds_read_b64_tr_b16 v[138:139], v48 offset:544
    ds_read_b64_tr_b16 v[140:141], v48 offset:8224
    ds_read_b64_tr_b16 v[142:143], v48 offset:8736
    s_waitcnt lgkmcnt(0)
    v_xor_b32 v48, 64, v47
    v_add_u32 v48, 49152, v48
    ds_read_b64_tr_b16 v[144:145], v48 offset:0
    ds_read_b64_tr_b16 v[146:147], v48 offset:512
    ds_read_b64_tr_b16 v[148:149], v48 offset:8192
    ds_read_b64_tr_b16 v[150:151], v48 offset:8704
    ds_read_b64_tr_b16 v[152:153], v48 offset:32
    ds_read_b64_tr_b16 v[154:155], v48 offset:544
    ds_read_b64_tr_b16 v[156:157], v48 offset:8224
    ds_read_b64_tr_b16 v[158:159], v48 offset:8736
    s_waitcnt lgkmcnt(0)
    v_xor_b32 v48, 128, v47
    v_add_u32 v48, 49152, v48
    ds_read_b64_tr_b16 v[192:193], v48 offset:0
    ds_read_b64_tr_b16 v[194:195], v48 offset:512
    ds_read_b64_tr_b16 v[196:197], v48 offset:8192
    ds_read_b64_tr_b16 v[198:199], v48 offset:8704
    ds_read_b64_tr_b16 v[200:201], v48 offset:32
    ds_read_b64_tr_b16 v[202:203], v48 offset:544
    ds_read_b64_tr_b16 v[204:205], v48 offset:8224
    ds_read_b64_tr_b16 v[206:207], v48 offset:8736
    s_waitcnt lgkmcnt(0)
    v_xor_b32 v48, 192, v47
    v_add_u32 v48, 49152, v48
    ds_read_b64_tr_b16 v[80:81], v48 offset:0
    ds_read_b64_tr_b16 v[82:83], v48 offset:512
    ds_read_b64_tr_b16 v[84:85], v48 offset:8192
    ds_read_b64_tr_b16 v[86:87], v48 offset:8704
    ds_read_b64_tr_b16 v[88:89], v48 offset:32
    ds_read_b64_tr_b16 v[90:91], v48 offset:544
    ds_read_b64_tr_b16 v[92:93], v48 offset:8224
    ds_read_b64_tr_b16 v[94:95], v48 offset:8736
    s_waitcnt lgkmcnt(0)
mega_kernel_rs_wo3:
    s_barrier
    s_add_u32 m0, s48, 49152
    s_mov_b32 s22, 1572864
    buffer_load_dwordx4 v44, s[8:11], s22 offen  lds
    s_add_u32 m0, s48, 53248
    s_mov_b32 s22, 1605632
    buffer_load_dwordx4 v44, s[8:11], s22 offen  lds
    s_add_u32 m0, s48, 57344
    s_mov_b32 s22, 1638400
    buffer_load_dwordx4 v44, s[8:11], s22 offen  lds
    s_add_u32 m0, s48, 61440
    s_mov_b32 s22, 1671168
    buffer_load_dwordx4 v44, s[8:11], s22 offen  lds
    s_waitcnt vmcnt(28)
    s_barrier
    s_cmp_lg_u32 s20, 0
    s_cbranch_scc1 mega_kernel_rs_wo4
    v_xor_b32 v48, 0, v47
    v_add_u32 v48, 65536, v48
    ds_read_b64_tr_b16 v[160:161], v48 offset:0
    ds_read_b64_tr_b16 v[162:163], v48 offset:512
    ds_read_b64_tr_b16 v[164:165], v48 offset:8192
    ds_read_b64_tr_b16 v[166:167], v48 offset:8704
    ds_read_b64_tr_b16 v[168:169], v48 offset:32
    ds_read_b64_tr_b16 v[170:171], v48 offset:544
    ds_read_b64_tr_b16 v[172:173], v48 offset:8224
    ds_read_b64_tr_b16 v[174:175], v48 offset:8736
    s_waitcnt lgkmcnt(0)
    v_xor_b32 v48, 64, v47
    v_add_u32 v48, 65536, v48
    ds_read_b64_tr_b16 v[176:177], v48 offset:0
    ds_read_b64_tr_b16 v[178:179], v48 offset:512
    ds_read_b64_tr_b16 v[180:181], v48 offset:8192
    ds_read_b64_tr_b16 v[182:183], v48 offset:8704
    ds_read_b64_tr_b16 v[184:185], v48 offset:32
    ds_read_b64_tr_b16 v[186:187], v48 offset:544
    ds_read_b64_tr_b16 v[188:189], v48 offset:8224
    ds_read_b64_tr_b16 v[190:191], v48 offset:8736
    s_waitcnt lgkmcnt(0)
    v_xor_b32 v48, 128, v47
    v_add_u32 v48, 65536, v48
    ds_read_b64_tr_b16 v[96:97], v48 offset:0
    ds_read_b64_tr_b16 v[98:99], v48 offset:512
    ds_read_b64_tr_b16 v[100:101], v48 offset:8192
    ds_read_b64_tr_b16 v[102:103], v48 offset:8704
    ds_read_b64_tr_b16 v[104:105], v48 offset:32
    ds_read_b64_tr_b16 v[106:107], v48 offset:544
    ds_read_b64_tr_b16 v[108:109], v48 offset:8224
    ds_read_b64_tr_b16 v[110:111], v48 offset:8736
    s_waitcnt lgkmcnt(0)
    v_xor_b32 v48, 192, v47
    v_add_u32 v48, 65536, v48
    ds_read_b64_tr_b16 v[112:113], v48 offset:0
    ds_read_b64_tr_b16 v[114:115], v48 offset:512
    ds_read_b64_tr_b16 v[116:117], v48 offset:8192
    ds_read_b64_tr_b16 v[118:119], v48 offset:8704
    ds_read_b64_tr_b16 v[120:121], v48 offset:32
    ds_read_b64_tr_b16 v[122:123], v48 offset:544
    ds_read_b64_tr_b16 v[124:125], v48 offset:8224
    ds_read_b64_tr_b16 v[126:127], v48 offset:8736
    s_waitcnt lgkmcnt(0)
mega_kernel_rs_wo4:
    s_barrier
    s_add_u32 m0, s48, 65536
    s_mov_b32 s22, 2097152
    buffer_load_dwordx4 v44, s[8:11], s22 offen  lds
    s_add_u32 m0, s48, 69632
    s_mov_b32 s22, 2129920
    buffer_load_dwordx4 v44, s[8:11], s22 offen  lds
    s_add_u32 m0, s48, 73728
    s_mov_b32 s22, 2162688
    buffer_load_dwordx4 v44, s[8:11], s22 offen  lds
    s_add_u32 m0, s48, 77824
    s_mov_b32 s22, 2195456
    buffer_load_dwordx4 v44, s[8:11], s22 offen  lds
    s_waitcnt vmcnt(28)
    s_barrier
    s_cmp_lg_u32 s20, 1
    s_cbranch_scc1 mega_kernel_rs_wo5
    v_xor_b32 v48, 0, v47
    v_add_u32 v48, 81920, v48
    ds_read_b64_tr_b16 v[160:161], v48 offset:0
    ds_read_b64_tr_b16 v[162:163], v48 offset:512
    ds_read_b64_tr_b16 v[164:165], v48 offset:8192
    ds_read_b64_tr_b16 v[166:167], v48 offset:8704
    ds_read_b64_tr_b16 v[168:169], v48 offset:32
    ds_read_b64_tr_b16 v[170:171], v48 offset:544
    ds_read_b64_tr_b16 v[172:173], v48 offset:8224
    ds_read_b64_tr_b16 v[174:175], v48 offset:8736
    s_waitcnt lgkmcnt(0)
    v_xor_b32 v48, 64, v47
    v_add_u32 v48, 81920, v48
    ds_read_b64_tr_b16 v[176:177], v48 offset:0
    ds_read_b64_tr_b16 v[178:179], v48 offset:512
    ds_read_b64_tr_b16 v[180:181], v48 offset:8192
    ds_read_b64_tr_b16 v[182:183], v48 offset:8704
    ds_read_b64_tr_b16 v[184:185], v48 offset:32
    ds_read_b64_tr_b16 v[186:187], v48 offset:544
    ds_read_b64_tr_b16 v[188:189], v48 offset:8224
    ds_read_b64_tr_b16 v[190:191], v48 offset:8736
    s_waitcnt lgkmcnt(0)
    v_xor_b32 v48, 128, v47
    v_add_u32 v48, 81920, v48
    ds_read_b64_tr_b16 v[96:97], v48 offset:0
    ds_read_b64_tr_b16 v[98:99], v48 offset:512
    ds_read_b64_tr_b16 v[100:101], v48 offset:8192
    ds_read_b64_tr_b16 v[102:103], v48 offset:8704
    ds_read_b64_tr_b16 v[104:105], v48 offset:32
    ds_read_b64_tr_b16 v[106:107], v48 offset:544
    ds_read_b64_tr_b16 v[108:109], v48 offset:8224
    ds_read_b64_tr_b16 v[110:111], v48 offset:8736
    s_waitcnt lgkmcnt(0)
    v_xor_b32 v48, 192, v47
    v_add_u32 v48, 81920, v48
    ds_read_b64_tr_b16 v[112:113], v48 offset:0
    ds_read_b64_tr_b16 v[114:115], v48 offset:512
    ds_read_b64_tr_b16 v[116:117], v48 offset:8192
    ds_read_b64_tr_b16 v[118:119], v48 offset:8704
    ds_read_b64_tr_b16 v[120:121], v48 offset:32
    ds_read_b64_tr_b16 v[122:123], v48 offset:544
    ds_read_b64_tr_b16 v[124:125], v48 offset:8224
    ds_read_b64_tr_b16 v[126:127], v48 offset:8736
    s_waitcnt lgkmcnt(0)
mega_kernel_rs_wo5:
    s_barrier
    s_add_u32 m0, s48, 81920
    s_mov_b32 s22, 2621440
    buffer_load_dwordx4 v44, s[8:11], s22 offen  lds
    s_add_u32 m0, s48, 86016
    s_mov_b32 s22, 2654208
    buffer_load_dwordx4 v44, s[8:11], s22 offen  lds
    s_add_u32 m0, s48, 90112
    s_mov_b32 s22, 2686976
    buffer_load_dwordx4 v44, s[8:11], s22 offen  lds
    s_add_u32 m0, s48, 94208
    s_mov_b32 s22, 2719744
    buffer_load_dwordx4 v44, s[8:11], s22 offen  lds
    s_waitcnt vmcnt(28)
    s_barrier
    s_cmp_lg_u32 s20, 2
    s_cbranch_scc1 mega_kernel_rs_wo6
    v_xor_b32 v48, 0, v47
    v_add_u32 v48, 98304, v48
    ds_read_b64_tr_b16 v[160:161], v48 offset:0
    ds_read_b64_tr_b16 v[162:163], v48 offset:512
    ds_read_b64_tr_b16 v[164:165], v48 offset:8192
    ds_read_b64_tr_b16 v[166:167], v48 offset:8704
    ds_read_b64_tr_b16 v[168:169], v48 offset:32
    ds_read_b64_tr_b16 v[170:171], v48 offset:544
    ds_read_b64_tr_b16 v[172:173], v48 offset:8224
    ds_read_b64_tr_b16 v[174:175], v48 offset:8736
    s_waitcnt lgkmcnt(0)
    v_xor_b32 v48, 64, v47
    v_add_u32 v48, 98304, v48
    ds_read_b64_tr_b16 v[176:177], v48 offset:0
    ds_read_b64_tr_b16 v[178:179], v48 offset:512
    ds_read_b64_tr_b16 v[180:181], v48 offset:8192
    ds_read_b64_tr_b16 v[182:183], v48 offset:8704
    ds_read_b64_tr_b16 v[184:185], v48 offset:32
    ds_read_b64_tr_b16 v[186:187], v48 offset:544
    ds_read_b64_tr_b16 v[188:189], v48 offset:8224
    ds_read_b64_tr_b16 v[190:191], v48 offset:8736
    s_waitcnt lgkmcnt(0)
    v_xor_b32 v48, 128, v47
    v_add_u32 v48, 98304, v48
    ds_read_b64_tr_b16 v[96:97], v48 offset:0
    ds_read_b64_tr_b16 v[98:99], v48 offset:512
    ds_read_b64_tr_b16 v[100:101], v48 offset:8192
    ds_read_b64_tr_b16 v[102:103], v48 offset:8704
    ds_read_b64_tr_b16 v[104:105], v48 offset:32
    ds_read_b64_tr_b16 v[106:107], v48 offset:544
    ds_read_b64_tr_b16 v[108:109], v48 offset:8224
    ds_read_b64_tr_b16 v[110:111], v48 offset:8736
    s_waitcnt lgkmcnt(0)
    v_xor_b32 v48, 192, v47
    v_add_u32 v48, 98304, v48
    ds_read_b64_tr_b16 v[112:113], v48 offset:0
    ds_read_b64_tr_b16 v[114:115], v48 offset:512
    ds_read_b64_tr_b16 v[116:117], v48 offset:8192
    ds_read_b64_tr_b16 v[118:119], v48 offset:8704
    ds_read_b64_tr_b16 v[120:121], v48 offset:32
    ds_read_b64_tr_b16 v[122:123], v48 offset:544
    ds_read_b64_tr_b16 v[124:125], v48 offset:8224
    ds_read_b64_tr_b16 v[126:127], v48 offset:8736
    s_waitcnt lgkmcnt(0)
mega_kernel_rs_wo6:
    s_barrier
    s_add_u32 m0, s48, 98304
    s_mov_b32 s22, 3145728
    buffer_load_dwordx4 v44, s[8:11], s22 offen  lds
    s_add_u32 m0, s48, 102400
    s_mov_b32 s22, 3178496
    buffer_load_dwordx4 v44, s[8:11], s22 offen  lds
    s_add_u32 m0, s48, 106496
    s_mov_b32 s22, 3211264
    buffer_load_dwordx4 v44, s[8:11], s22 offen  lds
    s_add_u32 m0, s48, 110592
    s_mov_b32 s22, 3244032
    buffer_load_dwordx4 v44, s[8:11], s22 offen  lds
    s_waitcnt vmcnt(28)
    s_barrier
    s_cmp_lg_u32 s20, 3
    s_cbranch_scc1 mega_kernel_rs_wo7
    v_xor_b32 v48, 0, v47
    v_add_u32 v48, 114688, v48
    ds_read_b64_tr_b16 v[160:161], v48 offset:0
    ds_read_b64_tr_b16 v[162:163], v48 offset:512
    ds_read_b64_tr_b16 v[164:165], v48 offset:8192
    ds_read_b64_tr_b16 v[166:167], v48 offset:8704
    ds_read_b64_tr_b16 v[168:169], v48 offset:32
    ds_read_b64_tr_b16 v[170:171], v48 offset:544
    ds_read_b64_tr_b16 v[172:173], v48 offset:8224
    ds_read_b64_tr_b16 v[174:175], v48 offset:8736
    s_waitcnt lgkmcnt(0)
    v_xor_b32 v48, 64, v47
    v_add_u32 v48, 114688, v48
    ds_read_b64_tr_b16 v[176:177], v48 offset:0
    ds_read_b64_tr_b16 v[178:179], v48 offset:512
    ds_read_b64_tr_b16 v[180:181], v48 offset:8192
    ds_read_b64_tr_b16 v[182:183], v48 offset:8704
    ds_read_b64_tr_b16 v[184:185], v48 offset:32
    ds_read_b64_tr_b16 v[186:187], v48 offset:544
    ds_read_b64_tr_b16 v[188:189], v48 offset:8224
    ds_read_b64_tr_b16 v[190:191], v48 offset:8736
    s_waitcnt lgkmcnt(0)
    v_xor_b32 v48, 128, v47
    v_add_u32 v48, 114688, v48
    ds_read_b64_tr_b16 v[96:97], v48 offset:0
    ds_read_b64_tr_b16 v[98:99], v48 offset:512
    ds_read_b64_tr_b16 v[100:101], v48 offset:8192
    ds_read_b64_tr_b16 v[102:103], v48 offset:8704
    ds_read_b64_tr_b16 v[104:105], v48 offset:32
    ds_read_b64_tr_b16 v[106:107], v48 offset:544
    ds_read_b64_tr_b16 v[108:109], v48 offset:8224
    ds_read_b64_tr_b16 v[110:111], v48 offset:8736
    s_waitcnt lgkmcnt(0)
    v_xor_b32 v48, 192, v47
    v_add_u32 v48, 114688, v48
    ds_read_b64_tr_b16 v[112:113], v48 offset:0
    ds_read_b64_tr_b16 v[114:115], v48 offset:512
    ds_read_b64_tr_b16 v[116:117], v48 offset:8192
    ds_read_b64_tr_b16 v[118:119], v48 offset:8704
    ds_read_b64_tr_b16 v[120:121], v48 offset:32
    ds_read_b64_tr_b16 v[122:123], v48 offset:544
    ds_read_b64_tr_b16 v[124:125], v48 offset:8224
    ds_read_b64_tr_b16 v[126:127], v48 offset:8736
    s_waitcnt lgkmcnt(0)
mega_kernel_rs_wo7:
    s_barrier
    s_add_u32 m0, s48, 114688
    s_mov_b32 s22, 3670016
    buffer_load_dwordx4 v44, s[8:11], s22 offen  lds
    s_add_u32 m0, s48, 118784
    s_mov_b32 s22, 3702784
    buffer_load_dwordx4 v44, s[8:11], s22 offen  lds
    s_add_u32 m0, s48, 122880
    s_mov_b32 s22, 3735552
    buffer_load_dwordx4 v44, s[8:11], s22 offen  lds
    s_add_u32 m0, s48, 126976
    s_mov_b32 s22, 3768320
    buffer_load_dwordx4 v44, s[8:11], s22 offen  lds
    s_waitcnt vmcnt(28)
    s_barrier
    v_add_u32 v48, 0, v46
    ds_read_b64_tr_b16 v[64:65], v48 offset:0
    ds_read_b64_tr_b16 v[66:67], v48 offset:512
    ds_read_b64_tr_b16 v[68:69], v48 offset:8192
    ds_read_b64_tr_b16 v[70:71], v48 offset:8704
    ds_read_b64_tr_b16 v[72:73], v48 offset:8
    ds_read_b64_tr_b16 v[74:75], v48 offset:520
    ds_read_b64_tr_b16 v[76:77], v48 offset:8200
    ds_read_b64_tr_b16 v[78:79], v48 offset:8712
    s_waitcnt lgkmcnt(0)
    s_barrier
    ds_write_b128 v32, v[64:67] offset:0
    ds_write_b128 v32, v[68:71] offset:1024
    ds_write_b128 v32, v[72:75] offset:2048
    ds_write_b128 v32, v[76:79] offset:3072
    s_waitcnt lgkmcnt(0)
    s_waitcnt vmcnt(24)
    s_barrier
    v_add_u32 v48, 16384, v46
    ds_read_b64_tr_b16 v[64:65], v48 offset:0
    ds_read_b64_tr_b16 v[66:67], v48 offset:512
    ds_read_b64_tr_b16 v[68:69], v48 offset:8192
    ds_read_b64_tr_b16 v[70:71], v48 offset:8704
    ds_read_b64_tr_b16 v[72:73], v48 offset:8
    ds_read_b64_tr_b16 v[74:75], v48 offset:520
    ds_read_b64_tr_b16 v[76:77], v48 offset:8200
    ds_read_b64_tr_b16 v[78:79], v48 offset:8712
    s_waitcnt lgkmcnt(0)
    s_barrier
    ds_write_b128 v32, v[64:67] offset:16384
    ds_write_b128 v32, v[68:71] offset:17408
    ds_write_b128 v32, v[72:75] offset:18432
    ds_write_b128 v32, v[76:79] offset:19456
    s_waitcnt lgkmcnt(0)
    s_waitcnt vmcnt(20)
    s_barrier
    s_getpc_b64 s[16:17]
mega_kernel_rs_pc0:
    s_add_u32 s16, s16, mega_kernel_rs_w0_entry - mega_kernel_rs_pc0
    s_addc_u32 s17, s17, 0
    v_lshlrev_b32 v49, 7, v0
    v_min_u32 v49, mega_kernel_rs_end - mega_kernel_rs_w0_entry, v49
    global_load_dword v50, v49, s[16:17]
    v_lshlrev_b32 v49, 7, v40
    s_xor_b32 s23, s35, 16384
    s_cmp_eq_u32 s20, 1
    s_cselect_b32 s22, s35, s47
    s_cmp_eq_u32 s20, 2
    s_cselect_b32 s22, s23, s22
    s_lshl_b32 s23, s31, 13
    s_add_u32 s23, s23, 178257920
    s_cmp_eq_u32 s20, 3
    s_cselect_b32 s22, s23, s22
    buffer_load_dword v51, v49, s[4:7], s22 offen sc1
    v_lshlrev_b32 v49, 13, v0
    v_and_b32 v49, 0x1fffff, v49
    s_mov_b32 s22, 67108864
    buffer_load_dword v52, v49, s[4:7], s22 offen sc1
    buffer_load_dword v57, v7, s[4:7], 0 offen sc1
    v_add_u32 v48, 32768, v46
    ds_read_b64_tr_b16 v[64:65], v48 offset:0
    ds_read_b64_tr_b16 v[66:67], v48 offset:512
    ds_read_b64_tr_b16 v[68:69], v48 offset:8192
    ds_read_b64_tr_b16 v[70:71], v48 offset:8704
    ds_read_b64_tr_b16 v[72:73], v48 offset:8
    ds_read_b64_tr_b16 v[74:75], v48 offset:520
    ds_read_b64_tr_b16 v[76:77], v48 offset:8200
    ds_read_b64_tr_b16 v[78:79], v48 offset:8712
    s_waitcnt lgkmcnt(0)
    s_barrier
    ds_write_b128 v32, v[64:67] offset:32768
    ds_write_b128 v32, v[68:71] offset:33792
    ds_write_b128 v32, v[72:75] offset:34816
    ds_write_b128 v32, v[76:79] offset:35840
    s_waitcnt lgkmcnt(0)
    s_waitcnt vmcnt(16)
    s_barrier
    v_add_u32 v48, 49152, v46
    ds_read_b64_tr_b16 v[64:65], v48 offset:0
    ds_read_b64_tr_b16 v[66:67], v48 offset:512
    ds_read_b64_tr_b16 v[68:69], v48 offset:8192
    ds_read_b64_tr_b16 v[70:71], v48 offset:8704
    ds_read_b64_tr_b16 v[72:73], v48 offset:8
    ds_read_b64_tr_b16 v[74:75], v48 offset:520
    ds_read_b64_tr_b16 v[76:77], v48 offset:8200
    ds_read_b64_tr_b16 v[78:79], v48 offset:8712
    s_waitcnt lgkmcnt(0)
    s_barrier
    ds_write_b128 v32, v[64:67] offset:49152
    ds_write_b128 v32, v[68:71] offset:50176
    ds_write_b128 v32, v[72:75] offset:51200
    ds_write_b128 v32, v[76:79] offset:52224
    s_waitcnt lgkmcnt(0)
    s_waitcnt vmcnt(12)
    s_barrier
    v_add_u32 v48, 65536, v46
    ds_read_b64_tr_b16 v[64:65], v48 offset:0
    ds_read_b64_tr_b16 v[66:67], v48 offset:512
    ds_read_b64_tr_b16 v[68:69], v48 offset:8192
    ds_read_b64_tr_b16 v[70:71], v48 offset:8704
    ds_read_b64_tr_b16 v[72:73], v48 offset:8
    ds_read_b64_tr_b16 v[74:75], v48 offset:520
    ds_read_b64_tr_b16 v[76:77], v48 offset:8200
    ds_read_b64_tr_b16 v[78:79], v48 offset:8712
    s_waitcnt lgkmcnt(0)
    s_barrier
    ds_write_b128 v33, v[64:67] offset:0
    ds_write_b128 v33, v[68:71] offset:1024
    ds_write_b128 v33, v[72:75] offset:2048
    ds_write_b128 v33, v[76:79] offset:3072
    s_waitcnt lgkmcnt(0)
    s_waitcnt vmcnt(8)
    s_barrier
    v_add_u32 v48, 81920, v46
    ds_read_b64_tr_b16 v[208:209], v48 offset:0
    ds_read_b64_tr_b16 v[210:211], v48 offset:512
    ds_read_b64_tr_b16 v[212:213], v48 offset:8192
    ds_read_b64_tr_b16 v[214:215], v48 offset:8704
    ds_read_b64_tr_b16 v[216:217], v48 offset:8
    ds_read_b64_tr_b16 v[218:219], v48 offset:520
    ds_read_b64_tr_b16 v[220:221], v48 offset:8200
    ds_read_b64_tr_b16 v[222:223], v48 offset:8712
    s_waitcnt lgkmcnt(0)
    s_barrier
    ds_write_b128 v33, v[80:83] offset:16384
    ds_write_b128 v33, v[84:87] offset:17408
    ds_write_b128 v33, v[88:91] offset:18432
    ds_write_b128 v33, v[92:95] offset:19456
    s_waitcnt lgkmcnt(0)
    s_waitcnt vmcnt(4)
    s_barrier
    v_add_u32 v48, 98304, v46
    ds_read_b64_tr_b16 v[224:225], v48 offset:0
    ds_read_b64_tr_b16 v[226:227], v48 offset:512
    ds_read_b64_tr_b16 v[228:229], v48 offset:8192
    ds_read_b64_tr_b16 v[230:231], v48 offset:8704
    ds_read_b64_tr_b16 v[232:233], v48 offset:8
    ds_read_b64_tr_b16 v[234:235], v48 offset:520
    ds_read_b64_tr_b16 v[236:237], v48 offset:8200
    ds_read_b64_tr_b16 v[238:239], v48 offset:8712
    s_waitcnt lgkmcnt(0)
    s_barrier
    ds_write_b128 v33, v[96:99] offset:32768
    ds_write_b128 v33, v[100:103] offset:33792
    ds_write_b128 v33, v[104:107] offset:34816
    ds_write_b128 v33, v[108:111] offset:35840
    s_waitcnt lgkmcnt(0)
    s_waitcnt vmcnt(0)
    s_barrier
    v_add_u32 v48, 114688, v46
    ds_read_b64_tr_b16 v[240:241], v48 offset:0
    ds_read_b64_tr_b16 v[242:243], v48 offset:512
    ds_read_b64_tr_b16 v[244:245], v48 offset:8192
    ds_read_b64_tr_b16 v[246:247], v48 offset:8704
    ds_read_b64_tr_b16 v[248:249], v48 offset:8
    ds_read_b64_tr_b16 v[250:251], v48 offset:520
    ds_read_b64_tr_b16 v[252:253], v48 offset:8200
    ds_read_b64_tr_b16 v[254:255], v48 offset:8712
    s_waitcnt lgkmcnt(0)
    s_barrier
    ds_write_b128 v33, v[112:115] offset:49152
    ds_write_b128 v33, v[116:119] offset:50176
    ds_write_b128 v33, v[120:123] offset:51200
    ds_write_b128 v33, v[124:127] offset:52224
    s_waitcnt lgkmcnt(0)
mega_kernel_rs_iw:
    buffer_load_dword v58, off, s[12:15], 0 offset:204 sc1
    s_waitcnt vmcnt(0)
mega_kernel_rs_iw1:
    v_and_b32 v50, 0xffff, v58
    v_readfirstlane_b32 s60, v58
    v_cmp_ne_u32 vcc, s100, v50
    s_cbranch_vccnz mega_kernel_rs_iw
    s_lshr_b32 s60, s60, 15
    s_cmp_gt_u32 s60, s100
    s_cselect_b32 s60, 8192, 0
    s_bfe_u32 s22, s31, 0x10001
    s_lshl_b32 s22, s22, 12
    s_add_u32 s22, s22, s60
    s_lshl_b32 s23, s20, 10
    s_add_u32 s22, s22, s23
    s_add_u32 s38, s38, s22
    s_add_u32 s37, s37, s22
    s_xor_b32 s40, s38, 4096
    s_xor_b32 s39, s37, 4096
    s_xor_b32 s36, s35, 16384
    s_mov_b32 s21, 0
    s_cmp_eq_u32 s30, 0
    s_mov_b32 s22, 0x33003300
    s_cselect_b32 s16, 0x00330033, s22
    s_mov_b32 s17, s16
    s_cselect_b32 s18, -1, 0
    s_not_b32 s19, s18
    s_lshl_b32 s22, s31, 13
    s_lshl_b32 s23, s20, 11
    s_add_u32 s22, s22, s23
    s_add_u32 s43, s22, 16777216
    s_add_u32 s44, s22, 33554432
    s_lshl_b32 s45, s31, 13
    s_add_u32 s45, s45, 178257920
    s_mul_i32 s48, s20, 3072
    s_add_u32 m0, s48, 140288
    s_mov_b32 s41, 1
    s_mov_b32 s42, 1
    v_mov_b32 v0, v34
    v_bfrev_b32 v3, 1
    v_cndmask_b32 v10, v3, v10, s[16:17]
    v_cndmask_b32 v9, v3, v9, s[26:27]
    s_sub_u32 s45, s45, 262144
    s_lshl_b32 s51, s30, 11
    s_add_u32 s51, s51, s45
    s_mov_b32 s50, 0
    s_cmp_lg_u32 s20, 3
    s_cbranch_scc1 mega_kernel_rs_kv0
    v_readlane_b32 s50, v57, 0
    v_readlane_b32 s22, v57, 2
    v_readlane_b32 s23, v57, 1
    v_readlane_b32 s24, v57, 3
    s_nop 3
    s_min_u32 s50, s50, s22
    s_min_u32 s23, s23, s24
    s_lshl_b32 s50, s50, 1
    s_lshl_b32 s23, s23, 1
    s_add_u32 s23, s23, 1
    s_min_u32 s50, s50, s23
mega_kernel_rs_kvb0:
    s_add_u32 s22, s21, 0
    s_min_u32 s22, s22, 63
    s_cmp_gt_u32 s50, s22
    s_cbranch_scc1 mega_kernel_rs_kvd0
    buffer_load_dword v48, v7, s[4:7], 0 offen sc1
    s_waitcnt vmcnt(0)
    v_readlane_b32 s50, v48, 0
    v_readlane_b32 s22, v48, 2
    v_readlane_b32 s23, v48, 1
    v_readlane_b32 s24, v48, 3
    s_nop 3
    s_min_u32 s50, s50, s22
    s_min_u32 s23, s23, s24
    s_lshl_b32 s50, s50, 1
    s_lshl_b32 s23, s23, 1
    s_add_u32 s23, s23, 1
    s_min_u32 s50, s50, s23
    s_branch mega_kernel_rs_kvb0
mega_kernel_rs_kvd0:
mega_kernel_rs_kv0:
    s_barrier
    s_cmp_eq_u32 s20, 1
    s_cbranch_scc1 mega_kernel_rs_w1_entry
    s_cmp_eq_u32 s20, 2
    s_cbranch_scc1 mega_kernel_rs_w2_entry
    s_cmp_eq_u32 s20, 3
    s_cbranch_scc1 mega_kernel_rs_w3_entry
mega_kernel_rs_w0_entry:
    v_mfma_f32_32x32x8_bf16 v[96:111], v[14:15], v[14:15], 0
    v_mfma_f32_16x16x16_bf16 v[112:115], v[14:15], v[14:15], 0
    v_mfma_f32_16x16x16_bf16 v[116:119], v[14:15], v[14:15], 0
    ds_read_b128 v[64:67], v1 offset:0
    ds_read_b128 v[68:71], v1 offset:1024
    ds_read_b128 v[72:75], v1 offset:2048
    ds_read_b128 v[76:79], v1 offset:3072
    ds_read_b128 v[80:83], v1 offset:16384
    ds_read_b128 v[84:87], v1 offset:17408
    ds_read_b128 v[88:91], v1 offset:18432
    ds_read_b128 v[92:95], v1 offset:19456
    buffer_load_dwordx4 v[120:123], v1, s[4:7], s44 offen
    buffer_load_dwordx4 v[124:127], v1, s[4:7], s44 offen offset:1024
    s_add_u32 s44, s44, 262144
mega_kernel_rs_w0_loop:
    s_add_u32 s22, s35, 0
    s_waitcnt vmcnt(0)
    buffer_load_dwordx4 v[32:35], v12, s[4:7], s22 offen sc1
    buffer_load_dwordx4 v[36:39], v12, s[4:7], s22 offen offset:1024 sc1
mega_kernel_rs_w0_pa:
    s_waitcnt vmcnt(1)
    ds_write_b128 v6, v[32:35] offset:0
    s_waitcnt vmcnt(0)
    ds_write_b128 v6, v[36:39] offset:1024
    v_max3_u32 v3, v32, v34, v36
    v_max_u32 v3, v3, v38
    v_cmp_eq_u32 vcc, -1, v3
    v_smfmac_f32_16x16x64_bf16 v[96:99], v[32:35], a[0:7], v2
    v_smfmac_f32_16x16x64_bf16 v[100:103], v[32:35], a[8:15], v2
    v_smfmac_f32_16x16x64_bf16 v[104:107], v[32:35], a[128:135], v2
    s_cbranch_vccnz mega_kernel_rs_w0_pafail
    s_waitcnt lgkmcnt(0)
    s_barrier
    ds_read_b128 v[40:43], v6 offset:2048
    ds_read_b128 v[44:47], v6 offset:3072
    v_smfmac_f32_16x16x64_bf16 v[108:111], v[32:35], a[136:143], v2
    ds_read_b128 v[48:51], v6 offset:4096
    v_smfmac_f32_16x16x64_bf16 v[96:99], v[36:39], a[16:23], v2
    ds_read_b128 v[52:55], v6 offset:5120
    v_smfmac_f32_16x16x64_bf16 v[100:103], v[36:39], a[24:31], v2
    ds_read_b128 v[56:59], v6 offset:6144
    v_smfmac_f32_16x16x64_bf16 v[104:107], v[36:39], a[144:151], v2
    ds_read_b128 v[60:63], v6 offset:7168
    v_smfmac_f32_16x16x64_bf16 v[108:111], v[36:39], a[152:159], v2
    buffer_load_dwordx4 v1, s[4:7], s43 offen lds
    s_waitcnt lgkmcnt(5)
    v_smfmac_f32_16x16x64_bf16 v[96:99], v[40:43], a[32:39], v2
    v_smfmac_f32_16x16x64_bf16 v[100:103], v[40:43], a[40:47], v2
    v_smfmac_f32_16x16x64_bf16 v[104:107], v[40:43], a[160:167], v2
    v_smfmac_f32_16x16x64_bf16 v[108:111], v[40:43], a[168:175], v2
    buffer_load_dwordx4 v1, s[4:7], s43 offen offset:1024 lds
    s_waitcnt lgkmcnt(4)
    v_smfmac_f32_16x16x64_bf16 v[96:99], v[44:47], a[48:55], v2
    v_smfmac_f32_16x16x64_bf16 v[100:103], v[44:47], a[56:63], v2
    v_smfmac_f32_16x16x64_bf16 v[104:107], v[44:47], a[176:183], v2
    v_smfmac_f32_16x16x64_bf16 v[108:111], v[44:47], a[184:191], v2
    buffer_store_dwordx4 v[20:23], v10, s[4:7], s45 offen offset:0 sc1
    s_waitcnt lgkmcnt(3)
    v_smfmac_f32_16x16x64_bf16 v[96:99], v[48:51], a[64:71], v2
    v_smfmac_f32_16x16x64_bf16 v[100:103], v[48:51], a[72:79], v2
    v_smfmac_f32_16x16x64_bf16 v[104:107], v[48:51], a[192:199], v2
    v_smfmac_f32_16x16x64_bf16 v[108:111], v[48:51], a[200:207], v2
    buffer_store_dwordx2 v[18:19], v11, s[4:7], s51 offen offset:2048 sc1
    s_waitcnt lgkmcnt(2)
    v_smfmac_f32_16x16x64_bf16 v[96:99], v[52:55], a[80:87], v2
    v_smfmac_f32_16x16x64_bf16 v[100:103], v[52:55], a[88:95], v2
    v_smfmac_f32_16x16x64_bf16 v[104:107], v[52:55], a[208:215], v2
    v_smfmac_f32_16x16x64_bf16 v[108:111], v[52:55], a[216:223], v2
    s_waitcnt lgkmcnt(1)
    v_smfmac_f32_16x16x64_bf16 v[96:99], v[56:59], a[96:103], v2
    v_smfmac_f32_16x16x64_bf16 v[100:103], v[56:59], a[104:111], v2
    v_smfmac_f32_16x16x64_bf16 v[104:107], v[56:59], a[224:231], v2
    v_smfmac_f32_16x16x64_bf16 v[108:111], v[56:59], a[232:239], v2
    s_waitcnt lgkmcnt(0)
    v_smfmac_f32_16x16x64_bf16 v[96:99], v[60:63], a[112:119], v2
    v_smfmac_f32_16x16x64_bf16 v[100:103], v[60:63], a[120:127], v2
    v_smfmac_f32_16x16x64_bf16 v[104:107], v[60:63], a[240:247], v2
    v_smfmac_f32_16x16x64_bf16 v[108:111], v[60:63], a[248:255], v2
    s_nop 4
    v_pk_add_f32 v[96:97], v[96:97], v[98:99]
    v_pk_add_f32 v[100:101], v[100:101], v[102:103]
    v_pk_add_f32 v[104:105], v[104:105], v[106:107]
    v_pk_add_f32 v[108:109], v[108:109], v[110:111]
    v_cvt_pk_bf16_f32 v111, v108, v109
    v_cvt_pk_bf16_f32 v108, v96, v97
    v_cvt_pk_bf16_f32 v110, v100, v101
    v_cvt_pk_bf16_f32 v109, v104, v105
    v_and_or_b32 v108, v108, -2, s41
    buffer_store_dwordx4 v[108:111], v1, s[4:7], s37 offen sc1
    v_smfmac_f32_16x16x64_bf16 v[112:115], v[32:35], v[64:71], v2
    ds_read_b128 v[64:67], v1 offset:32768
    ds_read_b128 v[68:71], v1 offset:33792
    v_smfmac_f32_16x16x64_bf16 v[116:119], v[32:35], v[72:79], v2
    ds_read_b128 v[72:75], v1 offset:34816
    ds_read_b128 v[76:79], v1 offset:35840
    v_smfmac_f32_16x16x64_bf16 v[112:115], v[36:39], v[80:87], v2
    ds_read_b128 v[80:83], v1 offset:49152
    ds_read_b128 v[84:87], v1 offset:50176
    v_smfmac_f32_16x16x64_bf16 v[116:119], v[36:39], v[88:95], v2
    ds_read_b128 v[88:91], v1 offset:51200
    ds_read_b128 v[92:95], v1 offset:52224
    v_smfmac_f32_16x16x64_bf16 v[112:115], v[52:55], v[208:215], v2
    v_smfmac_f32_16x16x64_bf16 v[116:119], v[52:55], v[216:223], v2
    v_smfmac_f32_16x16x64_bf16 v[112:115], v[56:59], v[224:231], v2
    s_waitcnt lgkmcnt(6)
    v_smfmac_f32_16x16x64_bf16 v[112:115], v[40:43], v[64:71], v2
    ds_read_b128 v[64:67], v5 offset:0
    ds_read_b128 v[68:71], v5 offset:1024
    s_waitcnt lgkmcnt(6)
    v_smfmac_f32_16x16x64_bf16 v[116:119], v[40:43], v[72:79], v2
    ds_read_b128 v[72:75], v5 offset:2048
    ds_read_b128 v[76:79], v5 offset:3072
    v_smfmac_f32_16x16x64_bf16 v[116:119], v[56:59], v[232:239], v2
    v_smfmac_f32_16x16x64_bf16 v[112:115], v[60:63], v[240:247], v2
    v_smfmac_f32_16x16x64_bf16 v[116:119], v[60:63], v[248:255], v2
    s_waitcnt lgkmcnt(6)
    v_smfmac_f32_16x16x64_bf16 v[112:115], v[44:47], v[80:87], v2
    s_waitcnt lgkmcnt(4)
    v_smfmac_f32_16x16x64_bf16 v[116:119], v[44:47], v[88:95], v2
    s_waitcnt lgkmcnt(2)
    v_smfmac_f32_16x16x64_bf16 v[112:115], v[48:51], v[64:71], v2
    s_waitcnt lgkmcnt(0)
    v_smfmac_f32_16x16x64_bf16 v[116:119], v[48:51], v[72:79], v2
    v_mfma_f32_16x16x16_bf16 v[100:103], v[108:109], v[16:17], 0
    v_mfma_f32_16x16x16_bf16 v[104:107], v[110:111], v[16:17], 0
    s_nop 4
    v_add_f32 v112, v112, v114
    v_add_f32 v113, v113, v115
    v_add_f32 v114, v116, v118
    v_add_f32 v115, v117, v119
    v_cvt_pk_bf16_f32 v18, v112, v113
    v_cvt_pk_bf16_f32 v19, v114, v115
    v_and_or_b32 v18, v18, -2, s41
    v_mov_b32 v112, v18
    v_mov_b32 v114, v19
    v_mov_b32 v92, v28
    v_mov_b32 v93, 0
    s_waitcnt vmcnt(3)
    s_barrier
    ds_read_b128 v[32:35], v6 offset:9216
    ds_read_b128 v[36:39], v6 offset:10240
    ds_read_b128 v[40:43], v6 offset:12288
    ds_read_b128 v[44:47], v6 offset:13312
    ds_read_b128 v[48:51], v6 offset:15360
    ds_read_b128 v[52:55], v6 offset:16384
    ds_read_b128 v[56:59], v6 offset:18432
    ds_read_b128 v[60:63], v6 offset:19456
    buffer_load_dwordx4 v[96:99], v1, s[4:7], s38 offen sc1
    s_barrier
    buffer_store_dwordx2 v[18:19], v11, s[4:7], s39 offen sc1
    s_nop 15
    s_nop 15
    buffer_load_dwordx4 v[20:23], v1, s[4:7], s38 offen sc1
    s_waitcnt vmcnt(2)
    v_mfma_f32_16x16x16_bf16 v[80:83], v[96:97], v[16:17], v[100:103]
    v_mfma_f32_16x16x16_bf16 v[84:87], v[98:99], v[16:17], v[104:107]
    v_and_b32 v3, 1, v96
    v_cmp_ne_u32 vcc, s41, v3
    s_nop 4
    v_cvt_pk_bf16_f32 v64, v80, v81
    v_cvt_pk_bf16_f32 v65, v82, v83
    v_cvt_pk_bf16_f32 v66, v84, v85
    v_cvt_pk_bf16_f32 v67, v86, v87
    ds_write_b128 v6, v[64:67] offset:8192
    s_cbranch_vccnz mega_kernel_rs_w0_xslow
mega_kernel_rs_w0_xok:
    buffer_load_dwordx2 v[116:117], v11, s[4:7], s40 offen sc1
    s_waitcnt lgkmcnt(1)
    v_mfma_f32_16x16x32_bf16 v[80:83], v[32:35], v[64:67], 0
    s_waitcnt lgkmcnt(0)
    s_barrier
    ds_read_b128 v[68:71], v6 offset:11264
    ds_read_b128 v[72:75], v6 offset:14336
    ds_read_b128 v[76:79], v6 offset:17408
    v_mfma_f32_16x16x32_bf16 v[84:87], v[36:39], v[64:67], 0
    v_mfma_f32_16x16x32_bf16 v[88:91], v[64:67], v[64:67], 0
    buffer_load_dwordx2 v[20:21], v11, s[4:7], s40 offen sc1
    s_waitcnt lgkmcnt(2)
    v_mfma_f32_16x16x32_bf16 v[80:83], v[40:43], v[68:71], v[80:83]
    v_mfma_f32_16x16x32_bf16 v[84:87], v[44:47], v[68:71], v[84:87]
    v_mfma_f32_16x16x32_bf16 v[88:91], v[68:71], v[68:71], v[88:91]
    s_waitcnt lgkmcnt(1)
    v_mfma_f32_16x16x32_bf16 v[80:83], v[48:51], v[72:75], v[80:83]
    v_mfma_f32_16x16x32_bf16 v[84:87], v[52:55], v[72:75], v[84:87]
    v_mfma_f32_16x16x32_bf16 v[88:91], v[72:75], v[72:75], v[88:91]
    s_waitcnt lgkmcnt(0)
    v_mfma_f32_16x16x32_bf16 v[80:83], v[56:59], v[76:79], v[80:83]
    v_mfma_f32_16x16x32_bf16 v[84:87], v[60:63], v[76:79], v[84:87]
    v_mfma_f32_16x16x32_bf16 v[88:91], v[76:79], v[76:79], v[88:91]
    v_mfma_f32_32x32x4_2b_bf16 v[32:63], v[14:15], v[14:15], 0
    s_nop 4
    v_max3_f32 v4, v80, v81, v82
    v_max3_f32 v4, v4, v83, v84
    v_max3_f32 v4, v4, v85, v86
    v_max3_f32 v4, v4, v87, v88
    v_max_f32 v90, v4, v89
    v_max_f32 v4, v4, v89
    s_nop 0
    s_nop 0
    v_permlane16_swap_b32 v4, v90
    v_max_f32 v4, v4, v90
    v_max_f32 v90, v4, v90
    s_nop 1
    v_permlane32_swap_b32 v4, v90
    v_max_f32 v4, v4, v90
    v_mul_f32 v4, s34, v4
    v_pk_fma_f32 v[80:81], v[80:81], s[34:35], v[4:5] op_sel_hi:[1,0,0] neg_lo:[0,0,1] neg_hi:[0,0,1]
    v_pk_fma_f32 v[82:83], v[82:83], s[34:35], v[4:5] op_sel_hi:[1,0,0] neg_lo:[0,0,1] neg_hi:[0,0,1]
    v_pk_fma_f32 v[84:85], v[84:85], s[34:35], v[4:5] op_sel_hi:[1,0,0] neg_lo:[0,0,1] neg_hi:[0,0,1]
    v_pk_fma_f32 v[86:87], v[86:87], s[34:35], v[4:5] op_sel_hi:[1,0,0] neg_lo:[0,0,1] neg_hi:[0,0,1]
    v_pk_fma_f32 v[88:89], v[88:89], s[34:35], v[4:5] op_sel_hi:[1,0,0] neg_lo:[0,0,1] neg_hi:[0,0,1]
    v_exp_f32 v80, v80
    v_exp_f32 v81, v81
    v_exp_f32 v82, v82
    v_cvt_pk_bf16_f32 v68, v80, v81
    v_exp_f32 v83, v83
    v_exp_f32 v84, v84
    v_cvt_pk_bf16_f32 v69, v82, v83
    v_exp_f32 v85, v85
    v_exp_f32 v86, v86
    v_cvt_pk_bf16_f32 v70, v84, v85
    v_exp_f32 v87, v87
    v_exp_f32 v88, v88
    v_cvt_pk_bf16_f32 v71, v86, v87
    v_exp_f32 v89, v89
    s_cmp_eq_u32 s21, 63
    v_mfma_f32_16x16x32_bf16 v[76:79], v[28:31], v[68:71], 0
    v_cvt_pk_bf16_f32 v72, v88, v89
    v_cvt_pk_bf16_f32 v73, v88, v89
    v_mfma_f32_16x16x32_bf16 v[100:103], v[120:123], v[68:71], 0
    s_waitcnt vmcnt(1)
    v_and_b32 v3, 1, v116
    v_cmp_ne_u32 vcc, s41, v3
    v_mfma_f32_16x16x32_bf16 v[104:107], v[124:127], v[68:71], 0
    v_mov_b32 v113, v116
    v_mov_b32 v115, v117
    v_mfma_f32_16x16x16_bf16 v[76:79], v[92:93], v[72:73], v[76:79]
    s_cbranch_vccnz mega_kernel_rs_w0_pv0
mega_kernel_rs_w0_pv2:
    v_mfma_f32_16x16x16_bf16 v[100:103], v[112:113], v[72:73], v[100:103]
    v_mfma_f32_16x16x16_bf16 v[104:107], v[114:115], v[72:73], v[104:107]
    buffer_load_dwordx4 v[120:123], v1, s[4:7], s44 offen
    buffer_load_dwordx4 v[124:127], v1, s[4:7], s44 offen offset:1024
    s_cmp_eq_u32 s21, 63
    s_nop 1
    v_rcp_f32 v76, v76
    s_cbranch_scc1 mega_kernel_rs_w0_last
    s_mov_b64 exec, s[28:29]
    v_pk_mul_f32 v[100:101], v[100:101], v[76:77] op_sel_hi:[1,0]
    v_pk_mul_f32 v[102:103], v[102:103], v[76:77] op_sel_hi:[1,0]
    v_pk_mul_f32 v[104:105], v[104:105], v[76:77] op_sel_hi:[1,0]
    v_pk_mul_f32 v[106:107], v[106:107], v[76:77] op_sel_hi:[1,0]
    v_cvt_pk_bf16_f32 v72, v100, v101
    v_cvt_pk_bf16_f32 v73, v102, v103
    v_cvt_pk_bf16_f32 v74, v104, v105
    v_cvt_pk_bf16_f32 v75, v106, v107
    ds_write_b128 v6, v[72:75] offset:20448
    s_mov_b64 exec, -1
    ds_read_b128 v[88:91], v5 offset:16384
    ds_read_b128 v[92:95], v5 offset:17408
    ds_read_b128 v[80:83], v5 offset:18432
    ds_read_b128 v[84:87], v5 offset:19456
    ds_read_b128 v[112:115], v5 offset:32768
    ds_read_b128 v[116:119], v5 offset:33792
    v_mov_b32 v3, s21
    buffer_store_dword v3, v7, s[4:7], 0 offen sc1
    s_waitcnt lgkmcnt(6)
    s_barrier
    ds_read_b128 v[68:71], v6 offset:20480
    ds_read_b128 v[72:75], v6 offset:21504
    ds_read_b128 v[96:99], v5 offset:34816
    ds_read_b128 v[100:103], v5 offset:35840
    ds_read_b128 v[104:107], v5 offset:49152
    ds_read_b128 v[108:111], v5 offset:50176
    s_waitcnt lgkmcnt(5)
    v_smfmac_f32_16x16x64_bf16 v[32:35], v[68:71], v[128:135], v2
    s_add_u32 s21, s21, 1
    v_smfmac_f32_16x16x64_bf16 v[36:39], v[68:71], v[136:143], v2
    s_xor_b32 s38, s38, 1048576
    v_smfmac_f32_16x16x64_bf16 v[40:43], v[68:71], v[144:151], v2
    s_xor_b32 s37, s37, 1048576
    v_smfmac_f32_16x16x64_bf16 v[44:47], v[68:71], v[152:159], v2
    s_xor_b32 s40, s40, 1048576
    s_waitcnt lgkmcnt(4)
    v_smfmac_f32_16x16x64_bf16 v[32:35], v[72:75], v[160:167], v2
    s_xor_b32 s39, s39, 1048576
    v_smfmac_f32_16x16x64_bf16 v[36:39], v[72:75], v[168:175], v2
    s_lshr_b32 s41, s21, 1
    v_smfmac_f32_16x16x64_bf16 v[40:43], v[72:75], v[176:183], v2
    s_and_b32 s41, s41, 1
    v_smfmac_f32_16x16x64_bf16 v[44:47], v[72:75], v[184:191], v2
    s_xor_b32 s41, s41, 1
    v_smfmac_f32_16x16x64_bf16 v[48:51], v[68:71], v[192:199], v2
    s_xor_b32 s35, s35, 16384
    v_smfmac_f32_16x16x64_bf16 v[52:55], v[68:71], v[200:207], v2
    s_xor_b32 s36, s36, 16384
    s_waitcnt lgkmcnt(0)
    v_smfmac_f32_16x16x64_bf16 v[56:59], v[68:71], v[88:95], v2
    ds_read_b128 v[88:91], v5 offset:51200
    ds_read_b128 v[92:95], v5 offset:52224
    v_smfmac_f32_16x16x64_bf16 v[60:63], v[68:71], v[80:87], v2
    s_add_u32 s43, s43, 262144
    v_smfmac_f32_16x16x64_bf16 v[48:51], v[72:75], v[112:119], v2
    s_add_u32 s44, s44, 262144
    v_add_f32 v32, v32, v34
    v_add_f32 v33, v33, v35
    v_cvt_pk_bf16_f32 v32, v32, v33
    v_and_or_b32 v32, v32, -2, s42
    v_smfmac_f32_16x16x64_bf16 v[52:55], v[72:75], v[96:103], v2
    v_add_f32 v36, v36, v38
    v_add_f32 v37, v37, v39
    v_cvt_pk_bf16_f32 v33, v36, v37
    v_smfmac_f32_16x16x64_bf16 v[56:59], v[72:75], v[104:111], v2
    v_add_f32 v40, v40, v42
    v_add_f32 v41, v41, v43
    v_cvt_pk_bf16_f32 v34, v40, v41
    s_waitcnt lgkmcnt(0)
    v_smfmac_f32_16x16x64_bf16 v[60:63], v[72:75], v[88:95], v2
    v_add_f32 v44, v44, v46
    v_add_f32 v45, v45, v47
    v_cvt_pk_bf16_f32 v35, v44, v45
    buffer_store_dwordx4 v[32:35], v8, s[4:7], s46 offen sc1
    v_pk_add_f32 v[48:49], v[48:49], v[50:51]
    v_cvt_pk_bf16_f32 v48, v48, v49
    v_and_or_b32 v48, v48, -2, s42
    v_pk_add_f32 v[52:53], v[52:53], v[54:55]
    v_cvt_pk_bf16_f32 v49, v52, v53
    v_pk_add_f32 v[56:57], v[56:57], v[58:59]
    v_cvt_pk_bf16_f32 v50, v56, v57
    v_pk_add_f32 v[60:61], v[60:61], v[62:63]
    v_cvt_pk_bf16_f32 v51, v60, v61
    buffer_store_dwordx4 v[48:51], v8, s[4:7], s61 offen sc1
    s_waitcnt vmcnt(5)
    v_mov_b32 v20, v64
    v_mov_b32 v21, v65
    v_mov_b32 v22, v66
    v_mov_b32 v23, v67
    s_add_u32 s45, s45, 262144
    s_add_u32 s51, s51, 262144
    v_mfma_f32_32x32x8_bf16 v[96:111], v[14:15], v[14:15], 0
    v_mfma_f32_16x16x16_bf16 v[112:115], v[14:15], v[14:15], 0
    v_mfma_f32_16x16x16_bf16 v[116:119], v[14:15], v[14:15], 0
    ds_read_b128 v[64:67], v1 offset:0
    ds_read_b128 v[68:71], v1 offset:1024
    ds_read_b128 v[72:75], v1 offset:2048
    ds_read_b128 v[76:79], v1 offset:3072
    ds_read_b128 v[80:83], v1 offset:16384
    ds_read_b128 v[84:87], v1 offset:17408
    ds_read_b128 v[88:91], v1 offset:18432
    ds_read_b128 v[92:95], v1 offset:19456
    v_mov_b32 v58, -1
    v_mov_b32 v59, -1
    s_waitcnt vmcnt(0)
mega_kernel_rs_w0_pc:
    buffer_load_dword v36, v13, s[4:7], s47 offen offset:0 sc1
    buffer_load_dword v37, v13, s[4:7], s47 offen offset:1024 sc1
    buffer_load_dword v38, v13, s[4:7], s47 offen offset:2048 sc1
    buffer_load_dword v39, v13, s[4:7], s47 offen offset:3072 sc1
    buffer_load_dword v40, v13, s[4:7], s25 offen offset:0 sc1
    buffer_load_dword v41, v13, s[4:7], s25 offen offset:1024 sc1
    buffer_load_dword v42, v13, s[4:7], s25 offen offset:2048 sc1
    buffer_load_dword v43, v13, s[4:7], s25 offen offset:3072 sc1
    s_waitcnt vmcnt(4)
    v_mfma_f32_16x16x32_bf16 v[52:55], v[36:39], v[24:27], 0
    v_bitop3_b32 v3, s42, v36, v37 bitop3:0x7e
    v_bitop3_b32 v4, s42, v38, v39 bitop3:0x7e
    s_waitcnt vmcnt(2)
    v_or_b32 v3, v3, v4
    v_bitop3_b32 v4, s42, v40, v41 bitop3:0x7e
    s_waitcnt vmcnt(0)
    v_mfma_f32_16x16x32_bf16 v[52:55], v[40:43], v[24:27], v[52:55]
    v_bitop3_b32 v56, s42, v42, v43 bitop3:0x7e
    v_or3_b32 v3, v3, v4, v56
    v_and_b32 v3, v0, v3
    v_cmp_ne_u32 vcc, 0, v3
    s_cbranch_vccnz mega_kernel_rs_w0_pc
    s_nop 2
    v_cvt_pk_bf16_f32 v56, v52, v53
    v_cvt_pk_bf16_f32 v57, v54, v55
    v_min_u32 v56, -2, v56
    s_mov_b64 exec, s[26:27]
    buffer_store_dwordx2 v[56:57], v9, s[4:7], s35 offen offset:0 sc1
    buffer_store_dwordx2 v[58:59], v9, s[4:7], s36 offen offset:0 sc1
    s_mov_b64 exec, -1
    s_xor_b32 s42, s42, 1
    s_branch mega_kernel_rs_w0_loop
mega_kernel_rs_w0_last:
    s_waitcnt vmcnt(0)
    v_mov_b32 v20, v64
    v_mov_b32 v21, v65
    v_mov_b32 v22, v66
    v_mov_b32 v23, v67
    s_add_u32 s45, s45, 262144
    s_add_u32 s51, s51, 262144
    buffer_store_dwordx4 v[20:23], v10, s[4:7], s45 offen offset:0 sc1
    buffer_store_dwordx2 v[18:19], v11, s[4:7], s51 offen offset:2048 sc1
    s_branch mega_kernel_rs_end
mega_kernel_rs_w0_pafail:
    buffer_load_dwordx4 v[32:35], v12, s[4:7], s22 offen sc1
    buffer_load_dwordx4 v[36:39], v12, s[4:7], s22 offen offset:1024 sc1
    s_nop 7
    v_mov_b32 v96, 0
    v_mov_b32 v97, 0
    v_mov_b32 v98, 0
    v_mov_b32 v99, 0
    v_mov_b32 v100, 0
    v_mov_b32 v101, 0
    v_mov_b32 v102, 0
    v_mov_b32 v103, 0
    v_mov_b32 v104, 0
    v_mov_b32 v105, 0
    v_mov_b32 v106, 0
    v_mov_b32 v107, 0
    s_branch mega_kernel_rs_w0_pa
mega_kernel_rs_w0_xslow:
    buffer_load_dwordx4 v[96:99], v1, s[4:7], s38 offen sc1
    s_waitcnt vmcnt(1)
    v_and_b32 v3, 1, v20
    v_cmp_ne_u32 vcc, s41, v3
    s_cbranch_vccz mega_kernel_rs_w0_xgot1
    buffer_load_dwordx4 v[20:23], v1, s[4:7], s38 offen sc1
mega_kernel_rs_w0_px:
    s_waitcnt vmcnt(1)
    v_and_b32 v3, 1, v96
    v_cmp_ne_u32 vcc, s41, v3
    s_cbranch_vccz mega_kernel_rs_w0_xgot0
    buffer_load_dwordx4 v[96:99], v1, s[4:7], s38 offen sc1
    s_waitcnt vmcnt(1)
    v_and_b32 v3, 1, v20
    v_cmp_ne_u32 vcc, s41, v3
    s_cbranch_vccz mega_kernel_rs_w0_xgot1
    buffer_load_dwordx4 v[20:23], v1, s[4:7], s38 offen sc1
    s_branch mega_kernel_rs_w0_px
mega_kernel_rs_w0_xgot0:
    v_mfma_f32_16x16x16_bf16 v[80:83], v[96:97], v[16:17], v[100:103]
    v_mfma_f32_16x16x16_bf16 v[84:87], v[98:99], v[16:17], v[104:107]
    v_and_b32 v3, 1, v96
    v_cmp_ne_u32 vcc, s41, v3
    s_nop 4
    v_cvt_pk_bf16_f32 v64, v80, v81
    v_cvt_pk_bf16_f32 v65, v82, v83
    v_cvt_pk_bf16_f32 v66, v84, v85
    v_cvt_pk_bf16_f32 v67, v86, v87
    ds_write_b128 v6, v[64:67] offset:8192
    s_branch mega_kernel_rs_w0_xok
mega_kernel_rs_w0_xgot1:
    v_mfma_f32_16x16x16_bf16 v[80:83], v[20:21], v[16:17], v[100:103]
    v_mfma_f32_16x16x16_bf16 v[84:87], v[22:23], v[16:17], v[104:107]
    v_and_b32 v3, 1, v20
    v_cmp_ne_u32 vcc, s41, v3
    s_nop 4
    v_cvt_pk_bf16_f32 v64, v80, v81
    v_cvt_pk_bf16_f32 v65, v82, v83
    v_cvt_pk_bf16_f32 v66, v84, v85
    v_cvt_pk_bf16_f32 v67, v86, v87
    ds_write_b128 v6, v[64:67] offset:8192
    s_branch mega_kernel_rs_w0_xok
mega_kernel_rs_w0_pv0:
    s_waitcnt vmcnt(0)
    s_branch mega_kernel_rs_w0_pv1
mega_kernel_rs_w0_pv:
    buffer_load_dwordx2 v[20:21], v11, s[4:7], s40 offen sc1
    s_waitcnt vmcnt(0)
mega_kernel_rs_w0_pv1:
    v_and_b32 v3, 1, v20
    v_cmp_ne_u32 vcc, s41, v3
    v_mov_b32 v113, v20
    v_mov_b32 v115, v21
    s_cbranch_vccnz mega_kernel_rs_w0_pv
    s_branch mega_kernel_rs_w0_pv2
mega_kernel_rs_w1_entry:
    v_mfma_f32_32x32x8_bf16 v[96:111], v[14:15], v[14:15], 0
    v_mfma_f32_16x16x16_bf16 v[112:115], v[14:15], v[14:15], 0
    v_mfma_f32_16x16x16_bf16 v[116:119], v[14:15], v[14:15], 0
    ds_read_b128 v[64:67], v1 offset:4096
    ds_read_b128 v[68:71], v1 offset:5120
    ds_read_b128 v[72:75], v1 offset:6144
    ds_read_b128 v[76:79], v1 offset:7168
    ds_read_b128 v[80:83], v1 offset:20480
    ds_read_b128 v[84:87], v1 offset:21504
    ds_read_b128 v[88:91], v1 offset:22528
    ds_read_b128 v[92:95], v1 offset:23552
    buffer_load_dwordx4 v[120:123], v1, s[4:7], s44 offen
    buffer_load_dwordx4 v[124:127], v1, s[4:7], s44 offen offset:1024
    s_add_u32 s44, s44, 262144
mega_kernel_rs_w1_loop:
    s_add_u32 s22, s35, 2048
    s_waitcnt vmcnt(0)
    buffer_load_dwordx4 v[40:43], v12, s[4:7], s22 offen sc1
    buffer_load_dwordx4 v[44:47], v12, s[4:7], s22 offen offset:1024 sc1
mega_kernel_rs_w1_pa:
    s_waitcnt vmcnt(1)
    ds_write_b128 v6, v[40:43] offset:2048
    s_waitcnt vmcnt(0)
    ds_write_b128 v6, v[44:47] offset:3072
    v_max3_u32 v3, v40, v42, v44
    v_max_u32 v3, v3, v46
    v_cmp_eq_u32 vcc, -1, v3
    v_smfmac_f32_16x16x64_bf16 v[96:99], v[40:43], a[32:39], v2
    v_smfmac_f32_16x16x64_bf16 v[100:103], v[40:43], a[40:47], v2
    v_smfmac_f32_16x16x64_bf16 v[104:107], v[40:43], a[160:167], v2
    s_cbranch_vccnz mega_kernel_rs_w1_pafail
    s_waitcnt lgkmcnt(0)
    s_barrier
    ds_read_b128 v[48:51], v6 offset:4096
    ds_read_b128 v[52:55], v6 offset:5120
    v_smfmac_f32_16x16x64_bf16 v[108:111], v[40:43], a[168:175], v2
    ds_read_b128 v[56:59], v6 offset:6144
    v_smfmac_f32_16x16x64_bf16 v[96:99], v[44:47], a[48:55], v2
    ds_read_b128 v[60:63], v6 offset:7168
    v_smfmac_f32_16x16x64_bf16 v[100:103], v[44:47], a[56:63], v2
    ds_read_b128 v[32:35], v6 offset:0
    v_smfmac_f32_16x16x64_bf16 v[104:107], v[44:47], a[176:183], v2
    ds_read_b128 v[36:39], v6 offset:1024
    v_smfmac_f32_16x16x64_bf16 v[108:111], v[44:47], a[184:191], v2
    buffer_load_dwordx4 v1, s[4:7], s43 offen lds
    s_waitcnt lgkmcnt(5)
    v_smfmac_f32_16x16x64_bf16 v[96:99], v[48:51], a[64:71], v2
    v_smfmac_f32_16x16x64_bf16 v[100:103], v[48:51], a[72:79], v2
    v_smfmac_f32_16x16x64_bf16 v[104:107], v[48:51], a[192:199], v2
    v_smfmac_f32_16x16x64_bf16 v[108:111], v[48:51], a[200:207], v2
    buffer_load_dwordx4 v1, s[4:7], s43 offen offset:1024 lds
    s_waitcnt lgkmcnt(4)
    v_smfmac_f32_16x16x64_bf16 v[96:99], v[52:55], a[80:87], v2
    v_smfmac_f32_16x16x64_bf16 v[100:103], v[52:55], a[88:95], v2
    v_smfmac_f32_16x16x64_bf16 v[104:107], v[52:55], a[208:215], v2
    v_smfmac_f32_16x16x64_bf16 v[108:111], v[52:55], a[216:223], v2
    buffer_store_dwordx4 v[20:23], v10, s[4:7], s45 offen offset:64 sc1
    s_waitcnt lgkmcnt(3)
    v_smfmac_f32_16x16x64_bf16 v[96:99], v[56:59], a[96:103], v2
    v_smfmac_f32_16x16x64_bf16 v[100:103], v[56:59], a[104:111], v2
    v_smfmac_f32_16x16x64_bf16 v[104:107], v[56:59], a[224:231], v2
    v_smfmac_f32_16x16x64_bf16 v[108:111], v[56:59], a[232:239], v2
    buffer_store_dwordx2 v[18:19], v11, s[4:7], s51 offen offset:2560 sc1
    s_waitcnt lgkmcnt(2)
    v_smfmac_f32_16x16x64_bf16 v[96:99], v[60:63], a[112:119], v2
    v_smfmac_f32_16x16x64_bf16 v[100:103], v[60:63], a[120:127], v2
    v_smfmac_f32_16x16x64_bf16 v[104:107], v[60:63], a[240:247], v2
    v_smfmac_f32_16x16x64_bf16 v[108:111], v[60:63], a[248:255], v2
    s_waitcnt lgkmcnt(1)
    v_smfmac_f32_16x16x64_bf16 v[96:99], v[32:35], a[0:7], v2
    v_smfmac_f32_16x16x64_bf16 v[100:103], v[32:35], a[8:15], v2
    v_smfmac_f32_16x16x64_bf16 v[104:107], v[32:35], a[128:135], v2
    v_smfmac_f32_16x16x64_bf16 v[108:111], v[32:35], a[136:143], v2
    s_waitcnt lgkmcnt(0)
    v_smfmac_f32_16x16x64_bf16 v[96:99], v[36:39], a[16:23], v2
    v_smfmac_f32_16x16x64_bf16 v[100:103], v[36:39], a[24:31], v2
    v_smfmac_f32_16x16x64_bf16 v[104:107], v[36:39], a[144:151], v2
    v_smfmac_f32_16x16x64_bf16 v[108:111], v[36:39], a[152:159], v2
    s_nop 4
    v_pk_add_f32 v[96:97], v[96:97], v[98:99]
    v_pk_add_f32 v[100:101], v[100:101], v[102:103]
    v_pk_add_f32 v[104:105], v[104:105], v[106:107]
    v_pk_add_f32 v[108:109], v[108:109], v[110:111]
    v_cvt_pk_bf16_f32 v111, v108, v109
    v_cvt_pk_bf16_f32 v108, v96, v97
    v_cvt_pk_bf16_f32 v110, v100, v101
    v_cvt_pk_bf16_f32 v109, v104, v105
    v_and_or_b32 v108, v108, -2, s41
    buffer_store_dwordx4 v[108:111], v1, s[4:7], s37 offen sc1
    v_smfmac_f32_16x16x64_bf16 v[112:115], v[32:35], v[64:71], v2
    ds_read_b128 v[64:67], v1 offset:36864
    ds_read_b128 v[68:71], v1 offset:37888
    v_smfmac_f32_16x16x64_bf16 v[116:119], v[32:35], v[72:79], v2
    ds_read_b128 v[72:75], v1 offset:38912
    ds_read_b128 v[76:79], v1 offset:39936
    v_smfmac_f32_16x16x64_bf16 v[112:115], v[36:39], v[80:87], v2
    ds_read_b128 v[80:83], v1 offset:53248
    ds_read_b128 v[84:87], v1 offset:54272
    v_smfmac_f32_16x16x64_bf16 v[116:119], v[36:39], v[88:95], v2
    ds_read_b128 v[88:91], v1 offset:55296
    ds_read_b128 v[92:95], v1 offset:56320
    v_smfmac_f32_16x16x64_bf16 v[112:115], v[52:55], v[208:215], v2
    v_smfmac_f32_16x16x64_bf16 v[116:119], v[52:55], v[216:223], v2
    v_smfmac_f32_16x16x64_bf16 v[112:115], v[56:59], v[224:231], v2
    s_waitcnt lgkmcnt(6)
    v_smfmac_f32_16x16x64_bf16 v[112:115], v[40:43], v[64:71], v2
    ds_read_b128 v[64:67], v5 offset:4096
    ds_read_b128 v[68:71], v5 offset:5120
    s_waitcnt lgkmcnt(6)
    v_smfmac_f32_16x16x64_bf16 v[116:119], v[40:43], v[72:79], v2
    ds_read_b128 v[72:75], v5 offset:6144
    ds_read_b128 v[76:79], v5 offset:7168
    v_smfmac_f32_16x16x64_bf16 v[116:119], v[56:59], v[232:239], v2
    v_smfmac_f32_16x16x64_bf16 v[112:115], v[60:63], v[240:247], v2
    v_smfmac_f32_16x16x64_bf16 v[116:119], v[60:63], v[248:255], v2
    s_waitcnt lgkmcnt(6)
    v_smfmac_f32_16x16x64_bf16 v[112:115], v[44:47], v[80:87], v2
    s_waitcnt lgkmcnt(4)
    v_smfmac_f32_16x16x64_bf16 v[116:119], v[44:47], v[88:95], v2
    s_waitcnt lgkmcnt(2)
    v_smfmac_f32_16x16x64_bf16 v[112:115], v[48:51], v[64:71], v2
    s_waitcnt lgkmcnt(0)
    v_smfmac_f32_16x16x64_bf16 v[116:119], v[48:51], v[72:79], v2
    v_mfma_f32_16x16x16_bf16 v[100:103], v[108:109], v[16:17], 0
    v_mfma_f32_16x16x16_bf16 v[104:107], v[110:111], v[16:17], 0
    s_nop 4
    v_add_f32 v112, v112, v114
    v_add_f32 v113, v113, v115
    v_add_f32 v114, v116, v118
    v_add_f32 v115, v117, v119
    v_cvt_pk_bf16_f32 v18, v112, v113
    v_cvt_pk_bf16_f32 v19, v114, v115
    v_and_or_b32 v18, v18, -2, s41
    v_mov_b32 v112, v18
    v_mov_b32 v114, v19
    v_mov_b32 v92, v28
    v_mov_b32 v93, 0
    s_waitcnt vmcnt(3)
    s_barrier
    ds_read_b128 v[32:35], v6 offset:12288
    ds_read_b128 v[36:39], v6 offset:13312
    ds_read_b128 v[40:43], v6 offset:9216
    ds_read_b128 v[44:47], v6 offset:10240
    ds_read_b128 v[48:51], v6 offset:18432
    ds_read_b128 v[52:55], v6 offset:19456
    ds_read_b128 v[56:59], v6 offset:15360
    ds_read_b128 v[60:63], v6 offset:16384
    buffer_load_dwordx4 v[96:99], v1, s[4:7], s38 offen sc1
    s_barrier
    buffer_store_dwordx2 v[18:19], v11, s[4:7], s39 offen sc1
    s_nop 15
    s_nop 15
    buffer_load_dwordx4 v[20:23], v1, s[4:7], s38 offen sc1
    s_waitcnt vmcnt(2)
    v_mfma_f32_16x16x16_bf16 v[80:83], v[96:97], v[16:17], v[100:103]
    v_mfma_f32_16x16x16_bf16 v[84:87], v[98:99], v[16:17], v[104:107]
    v_and_b32 v3, 1, v96
    v_cmp_ne_u32 vcc, s41, v3
    s_nop 4
    v_cvt_pk_bf16_f32 v64, v80, v81
    v_cvt_pk_bf16_f32 v65, v82, v83
    v_cvt_pk_bf16_f32 v66, v84, v85
    v_cvt_pk_bf16_f32 v67, v86, v87
    ds_write_b128 v6, v[64:67] offset:11264
    s_cbranch_vccnz mega_kernel_rs_w1_xslow
mega_kernel_rs_w1_xok:
    buffer_load_dwordx2 v[116:117], v11, s[4:7], s40 offen sc1
    s_waitcnt lgkmcnt(1)
    v_mfma_f32_16x16x32_bf16 v[80:83], v[32:35], v[64:67], 0
    s_waitcnt lgkmcnt(0)
    s_barrier
    ds_read_b128 v[68:71], v6 offset:8192
    ds_read_b128 v[72:75], v6 offset:17408
    ds_read_b128 v[76:79], v6 offset:14336
    v_mfma_f32_16x16x32_bf16 v[84:87], v[36:39], v[64:67], 0
    v_mfma_f32_16x16x32_bf16 v[88:91], v[64:67], v[64:67], 0
    buffer_load_dwordx2 v[20:21], v11, s[4:7], s40 offen sc1
    s_waitcnt lgkmcnt(2)
    v_mfma_f32_16x16x32_bf16 v[80:83], v[40:43], v[68:71], v[80:83]
    v_mfma_f32_16x16x32_bf16 v[84:87], v[44:47], v[68:71], v[84:87]
    v_mfma_f32_16x16x32_bf16 v[88:91], v[68:71], v[68:71], v[88:91]
    s_waitcnt lgkmcnt(1)
    v_mfma_f32_16x16x32_bf16 v[80:83], v[48:51], v[72:75], v[80:83]
    v_mfma_f32_16x16x32_bf16 v[84:87], v[52:55], v[72:75], v[84:87]
    v_mfma_f32_16x16x32_bf16 v[88:91], v[72:75], v[72:75], v[88:91]
    s_waitcnt lgkmcnt(0)
    v_mfma_f32_16x16x32_bf16 v[80:83], v[56:59], v[76:79], v[80:83]
    v_mfma_f32_16x16x32_bf16 v[84:87], v[60:63], v[76:79], v[84:87]
    v_mfma_f32_16x16x32_bf16 v[88:91], v[76:79], v[76:79], v[88:91]
    v_mfma_f32_32x32x4_2b_bf16 v[32:63], v[14:15], v[14:15], 0
    s_nop 4
    v_max3_f32 v4, v80, v81, v82
    v_max3_f32 v4, v4, v83, v84
    v_max3_f32 v4, v4, v85, v86
    v_max3_f32 v4, v4, v87, v88
    v_max_f32 v90, v4, v89
    v_max_f32 v4, v4, v89
    s_nop 0
    s_nop 0
    v_permlane16_swap_b32 v4, v90
    v_max_f32 v4, v4, v90
    v_max_f32 v90, v4, v90
    s_nop 1
    v_permlane32_swap_b32 v4, v90
    v_max_f32 v4, v4, v90
    v_mul_f32 v4, s34, v4
    v_pk_fma_f32 v[80:81], v[80:81], s[34:35], v[4:5] op_sel_hi:[1,0,0] neg_lo:[0,0,1] neg_hi:[0,0,1]
    v_pk_fma_f32 v[82:83], v[82:83], s[34:35], v[4:5] op_sel_hi:[1,0,0] neg_lo:[0,0,1] neg_hi:[0,0,1]
    v_pk_fma_f32 v[84:85], v[84:85], s[34:35], v[4:5] op_sel_hi:[1,0,0] neg_lo:[0,0,1] neg_hi:[0,0,1]
    v_pk_fma_f32 v[86:87], v[86:87], s[34:35], v[4:5] op_sel_hi:[1,0,0] neg_lo:[0,0,1] neg_hi:[0,0,1]
    v_pk_fma_f32 v[88:89], v[88:89], s[34:35], v[4:5] op_sel_hi:[1,0,0] neg_lo:[0,0,1] neg_hi:[0,0,1]
    v_exp_f32 v80, v80
    v_exp_f32 v81, v81
    v_exp_f32 v82, v82
    v_cvt_pk_bf16_f32 v68, v80, v81
    v_exp_f32 v83, v83
    v_exp_f32 v84, v84
    v_cvt_pk_bf16_f32 v69, v82, v83
    v_exp_f32 v85, v85
    v_exp_f32 v86, v86
    v_cvt_pk_bf16_f32 v70, v84, v85
    v_exp_f32 v87, v87
    v_exp_f32 v88, v88
    v_cvt_pk_bf16_f32 v71, v86, v87
    v_exp_f32 v89, v89
    s_cmp_eq_u32 s21, 63
    v_mfma_f32_16x16x32_bf16 v[76:79], v[28:31], v[68:71], 0
    v_cvt_pk_bf16_f32 v72, v88, v89
    v_cvt_pk_bf16_f32 v73, v88, v89
    v_mfma_f32_16x16x32_bf16 v[100:103], v[120:123], v[68:71], 0
    s_waitcnt vmcnt(1)
    v_and_b32 v3, 1, v116
    v_cmp_ne_u32 vcc, s41, v3
    v_mfma_f32_16x16x32_bf16 v[104:107], v[124:127], v[68:71], 0
    v_mov_b32 v113, v116
    v_mov_b32 v115, v117
    v_mfma_f32_16x16x16_bf16 v[76:79], v[92:93], v[72:73], v[76:79]
    s_cbranch_vccnz mega_kernel_rs_w1_pv0
mega_kernel_rs_w1_pv2:
    v_mfma_f32_16x16x16_bf16 v[100:103], v[112:113], v[72:73], v[100:103]
    v_mfma_f32_16x16x16_bf16 v[104:107], v[114:115], v[72:73], v[104:107]
    buffer_load_dwordx4 v[120:123], v1, s[4:7], s44 offen
    buffer_load_dwordx4 v[124:127], v1, s[4:7], s44 offen offset:1024
    s_cmp_eq_u32 s21, 63
    s_nop 1
    v_rcp_f32 v76, v76
    s_cbranch_scc1 mega_kernel_rs_w1_last
    s_mov_b64 exec, s[28:29]
    v_pk_mul_f32 v[100:101], v[100:101], v[76:77] op_sel_hi:[1,0]
    v_pk_mul_f32 v[102:103], v[102:103], v[76:77] op_sel_hi:[1,0]
    v_pk_mul_f32 v[104:105], v[104:105], v[76:77] op_sel_hi:[1,0]
    v_pk_mul_f32 v[106:107], v[106:107], v[76:77] op_sel_hi:[1,0]
    v_cvt_pk_bf16_f32 v72, v100, v101
    v_cvt_pk_bf16_f32 v73, v102, v103
    v_cvt_pk_bf16_f32 v74, v104, v105
    v_cvt_pk_bf16_f32 v75, v106, v107
    ds_write_b128 v6, v[72:75] offset:20480
    s_mov_b64 exec, -1
    ds_read_b128 v[88:91], v5 offset:20480
    ds_read_b128 v[92:95], v5 offset:21504
    ds_read_b128 v[80:83], v5 offset:22528
    ds_read_b128 v[84:87], v5 offset:23552
    ds_read_b128 v[112:115], v5 offset:36864
    ds_read_b128 v[116:119], v5 offset:37888
    s_waitcnt lgkmcnt(6)
    s_barrier
    ds_read_b128 v[68:71], v6 offset:20480
    ds_read_b128 v[72:75], v6 offset:21504
    ds_read_b128 v[96:99], v5 offset:38912
    ds_read_b128 v[100:103], v5 offset:39936
    ds_read_b128 v[104:107], v5 offset:53248
    ds_read_b128 v[108:111], v5 offset:54272
    s_waitcnt lgkmcnt(5)
    v_smfmac_f32_16x16x64_bf16 v[32:35], v[68:71], v[128:135], v2
    s_add_u32 s21, s21, 1
    v_smfmac_f32_16x16x64_bf16 v[36:39], v[68:71], v[136:143], v2
    s_xor_b32 s38, s38, 1048576
    v_smfmac_f32_16x16x64_bf16 v[40:43], v[68:71], v[144:151], v2
    s_xor_b32 s37, s37, 1048576
    v_smfmac_f32_16x16x64_bf16 v[44:47], v[68:71], v[152:159], v2
    s_xor_b32 s40, s40, 1048576
    s_waitcnt lgkmcnt(4)
    v_smfmac_f32_16x16x64_bf16 v[32:35], v[72:75], v[160:167], v2
    s_xor_b32 s39, s39, 1048576
    v_smfmac_f32_16x16x64_bf16 v[36:39], v[72:75], v[168:175], v2
    s_lshr_b32 s41, s21, 1
    v_smfmac_f32_16x16x64_bf16 v[40:43], v[72:75], v[176:183], v2
    s_and_b32 s41, s41, 1
    v_smfmac_f32_16x16x64_bf16 v[44:47], v[72:75], v[184:191], v2
    s_xor_b32 s41, s41, 1
    v_smfmac_f32_16x16x64_bf16 v[48:51], v[68:71], v[192:199], v2
    s_xor_b32 s35, s35, 16384
    v_smfmac_f32_16x16x64_bf16 v[52:55], v[68:71], v[200:207], v2
    s_xor_b32 s36, s36, 16384
    s_waitcnt lgkmcnt(0)
    v_smfmac_f32_16x16x64_bf16 v[56:59], v[68:71], v[88:95], v2
    ds_read_b128 v[88:91], v5 offset:55296
    ds_read_b128 v[92:95], v5 offset:56320
    v_smfmac_f32_16x16x64_bf16 v[60:63], v[68:71], v[80:87], v2
    s_add_u32 s43, s43, 262144
    v_smfmac_f32_16x16x64_bf16 v[48:51], v[72:75], v[112:119], v2
    s_add_u32 s44, s44, 262144
    v_add_f32 v32, v32, v34
    v_add_f32 v33, v33, v35
    v_cvt_pk_bf16_f32 v32, v32, v33
    v_and_or_b32 v32, v32, -2, s42
    v_smfmac_f32_16x16x64_bf16 v[52:55], v[72:75], v[96:103], v2
    v_add_f32 v36, v36, v38
    v_add_f32 v37, v37, v39
    v_cvt_pk_bf16_f32 v33, v36, v37
    v_smfmac_f32_16x16x64_bf16 v[56:59], v[72:75], v[104:111], v2
    v_add_f32 v40, v40, v42
    v_add_f32 v41, v41, v43
    v_cvt_pk_bf16_f32 v34, v40, v41
    s_waitcnt lgkmcnt(0)
    v_smfmac_f32_16x16x64_bf16 v[60:63], v[72:75], v[88:95], v2
    v_add_f32 v44, v44, v46
    v_add_f32 v45, v45, v47
    v_cvt_pk_bf16_f32 v35, v44, v45
    buffer_store_dwordx4 v[32:35], v8, s[4:7], s46 offen sc1
    v_pk_add_f32 v[48:49], v[48:49], v[50:51]
    v_cvt_pk_bf16_f32 v48, v48, v49
    v_and_or_b32 v48, v48, -2, s42
    v_pk_add_f32 v[52:53], v[52:53], v[54:55]
    v_cvt_pk_bf16_f32 v49, v52, v53
    v_pk_add_f32 v[56:57], v[56:57], v[58:59]
    v_cvt_pk_bf16_f32 v50, v56, v57
    v_pk_add_f32 v[60:61], v[60:61], v[62:63]
    v_cvt_pk_bf16_f32 v51, v60, v61
    buffer_store_dwordx4 v[48:51], v8, s[4:7], s61 offen sc1
    s_waitcnt vmcnt(4)
    v_mov_b32 v20, v64
    v_mov_b32 v21, v65
    v_mov_b32 v22, v66
    v_mov_b32 v23, v67
    s_add_u32 s45, s45, 262144
    s_add_u32 s51, s51, 262144
    v_mfma_f32_32x32x8_bf16 v[96:111], v[14:15], v[14:15], 0
    v_mfma_f32_16x16x16_bf16 v[112:115], v[14:15], v[14:15], 0
    v_mfma_f32_16x16x16_bf16 v[116:119], v[14:15], v[14:15], 0
    ds_read_b128 v[64:67], v1 offset:4096
    ds_read_b128 v[68:71], v1 offset:5120
    ds_read_b128 v[72:75], v1 offset:6144
    ds_read_b128 v[76:79], v1 offset:7168
    ds_read_b128 v[80:83], v1 offset:20480
    ds_read_b128 v[84:87], v1 offset:21504
    ds_read_b128 v[88:91], v1 offset:22528
    ds_read_b128 v[92:95], v1 offset:23552
    v_mov_b32 v58, -1
    v_mov_b32 v59, -1
    s_waitcnt vmcnt(0)
mega_kernel_rs_w1_pc:
    buffer_load_dword v36, v13, s[4:7], s47 offen offset:64 sc1
    buffer_load_dword v37, v13, s[4:7], s47 offen offset:1088 sc1
    buffer_load_dword v38, v13, s[4:7], s47 offen offset:2112 sc1
    buffer_load_dword v39, v13, s[4:7], s47 offen offset:3136 sc1
    buffer_load_dword v40, v13, s[4:7], s25 offen offset:64 sc1
    buffer_load_dword v41, v13, s[4:7], s25 offen offset:1088 sc1
    buffer_load_dword v42, v13, s[4:7], s25 offen offset:2112 sc1
    buffer_load_dword v43, v13, s[4:7], s25 offen offset:3136 sc1
    s_waitcnt vmcnt(4)
    v_mfma_f32_16x16x32_bf16 v[52:55], v[36:39], v[24:27], 0
    v_bitop3_b32 v3, s42, v36, v37 bitop3:0x7e
    v_bitop3_b32 v4, s42, v38, v39 bitop3:0x7e
    s_waitcnt vmcnt(2)
    v_or_b32 v3, v3, v4
    v_bitop3_b32 v4, s42, v40, v41 bitop3:0x7e
    s_waitcnt vmcnt(0)
    v_mfma_f32_16x16x32_bf16 v[52:55], v[40:43], v[24:27], v[52:55]
    v_bitop3_b32 v56, s42, v42, v43 bitop3:0x7e
    v_or3_b32 v3, v3, v4, v56
    v_and_b32 v3, v0, v3
    v_cmp_ne_u32 vcc, 0, v3
    s_cbranch_vccnz mega_kernel_rs_w1_pc
    s_nop 2
    v_cvt_pk_bf16_f32 v56, v52, v53
    v_cvt_pk_bf16_f32 v57, v54, v55
    v_min_u32 v56, -2, v56
    s_mov_b64 exec, s[26:27]
    buffer_store_dwordx2 v[56:57], v9, s[4:7], s35 offen offset:64 sc1
    buffer_store_dwordx2 v[58:59], v9, s[4:7], s36 offen offset:64 sc1
    s_mov_b64 exec, -1
    s_xor_b32 s42, s42, 1
    s_branch mega_kernel_rs_w1_loop
mega_kernel_rs_w1_last:
    s_waitcnt vmcnt(0)
    v_mov_b32 v20, v64
    v_mov_b32 v21, v65
    v_mov_b32 v22, v66
    v_mov_b32 v23, v67
    s_add_u32 s45, s45, 262144
    s_add_u32 s51, s51, 262144
    buffer_store_dwordx4 v[20:23], v10, s[4:7], s45 offen offset:64 sc1
    buffer_store_dwordx2 v[18:19], v11, s[4:7], s51 offen offset:2560 sc1
    s_branch mega_kernel_rs_end
mega_kernel_rs_w1_pafail:
    buffer_load_dwordx4 v[40:43], v12, s[4:7], s22 offen sc1
    buffer_load_dwordx4 v[44:47], v12, s[4:7], s22 offen offset:1024 sc1
    s_nop 7
    v_mov_b32 v96, 0
    v_mov_b32 v97, 0
    v_mov_b32 v98, 0
    v_mov_b32 v99, 0
    v_mov_b32 v100, 0
    v_mov_b32 v101, 0
    v_mov_b32 v102, 0
    v_mov_b32 v103, 0
    v_mov_b32 v104, 0
    v_mov_b32 v105, 0
    v_mov_b32 v106, 0
    v_mov_b32 v107, 0
    s_branch mega_kernel_rs_w1_pa
mega_kernel_rs_w1_xslow:
    buffer_load_dwordx4 v[96:99], v1, s[4:7], s38 offen sc1
    s_waitcnt vmcnt(1)
    v_and_b32 v3, 1, v20
    v_cmp_ne_u32 vcc, s41, v3
    s_cbranch_vccz mega_kernel_rs_w1_xgot1
    buffer_load_dwordx4 v[20:23], v1, s[4:7], s38 offen sc1
mega_kernel_rs_w1_px:
    s_waitcnt vmcnt(1)
    v_and_b32 v3, 1, v96
    v_cmp_ne_u32 vcc, s41, v3
    s_cbranch_vccz mega_kernel_rs_w1_xgot0
    buffer_load_dwordx4 v[96:99], v1, s[4:7], s38 offen sc1
    s_waitcnt vmcnt(1)
    v_and_b32 v3, 1, v20
    v_cmp_ne_u32 vcc, s41, v3
    s_cbranch_vccz mega_kernel_rs_w1_xgot1
    buffer_load_dwordx4 v[20:23], v1, s[4:7], s38 offen sc1
    s_branch mega_kernel_rs_w1_px
mega_kernel_rs_w1_xgot0:
    v_mfma_f32_16x16x16_bf16 v[80:83], v[96:97], v[16:17], v[100:103]
    v_mfma_f32_16x16x16_bf16 v[84:87], v[98:99], v[16:17], v[104:107]
    v_and_b32 v3, 1, v96
    v_cmp_ne_u32 vcc, s41, v3
    s_nop 4
    v_cvt_pk_bf16_f32 v64, v80, v81
    v_cvt_pk_bf16_f32 v65, v82, v83
    v_cvt_pk_bf16_f32 v66, v84, v85
    v_cvt_pk_bf16_f32 v67, v86, v87
    ds_write_b128 v6, v[64:67] offset:11264
    s_branch mega_kernel_rs_w1_xok
mega_kernel_rs_w1_xgot1:
    v_mfma_f32_16x16x16_bf16 v[80:83], v[20:21], v[16:17], v[100:103]
    v_mfma_f32_16x16x16_bf16 v[84:87], v[22:23], v[16:17], v[104:107]
    v_and_b32 v3, 1, v20
    v_cmp_ne_u32 vcc, s41, v3
    s_nop 4
    v_cvt_pk_bf16_f32 v64, v80, v81
    v_cvt_pk_bf16_f32 v65, v82, v83
    v_cvt_pk_bf16_f32 v66, v84, v85
    v_cvt_pk_bf16_f32 v67, v86, v87
    ds_write_b128 v6, v[64:67] offset:11264
    s_branch mega_kernel_rs_w1_xok
mega_kernel_rs_w1_pv0:
    s_waitcnt vmcnt(0)
    s_branch mega_kernel_rs_w1_pv1
mega_kernel_rs_w1_pv:
    buffer_load_dwordx2 v[20:21], v11, s[4:7], s40 offen sc1
    s_waitcnt vmcnt(0)
mega_kernel_rs_w1_pv1:
    v_and_b32 v3, 1, v20
    v_cmp_ne_u32 vcc, s41, v3
    v_mov_b32 v113, v20
    v_mov_b32 v115, v21
    s_cbranch_vccnz mega_kernel_rs_w1_pv
    s_branch mega_kernel_rs_w1_pv2
mega_kernel_rs_w2_entry:
    v_mfma_f32_32x32x8_bf16 v[96:111], v[14:15], v[14:15], 0
    v_mfma_f32_16x16x16_bf16 v[112:115], v[14:15], v[14:15], 0
    v_mfma_f32_16x16x16_bf16 v[116:119], v[14:15], v[14:15], 0
    ds_read_b128 v[64:67], v1 offset:8192
    ds_read_b128 v[68:71], v1 offset:9216
    ds_read_b128 v[72:75], v1 offset:10240
    ds_read_b128 v[76:79], v1 offset:11264
    ds_read_b128 v[80:83], v1 offset:24576
    ds_read_b128 v[84:87], v1 offset:25600
    ds_read_b128 v[88:91], v1 offset:26624
    ds_read_b128 v[92:95], v1 offset:27648
    buffer_load_dwordx4 v[120:123], v1, s[4:7], s44 offen
    buffer_load_dwordx4 v[124:127], v1, s[4:7], s44 offen offset:1024
    s_add_u32 s44, s44, 262144
mega_kernel_rs_w2_loop:
    s_add_u32 s22, s35, 4096
    s_waitcnt vmcnt(0)
    buffer_load_dwordx4 v[48:51], v12, s[4:7], s22 offen sc1
    buffer_load_dwordx4 v[52:55], v12, s[4:7], s22 offen offset:1024 sc1
mega_kernel_rs_w2_pa:
    s_waitcnt vmcnt(1)
    ds_write_b128 v6, v[48:51] offset:4096
    s_waitcnt vmcnt(0)
    ds_write_b128 v6, v[52:55] offset:5120
    v_max3_u32 v3, v48, v50, v52
    v_max_u32 v3, v3, v54
    v_cmp_eq_u32 vcc, -1, v3
    v_smfmac_f32_16x16x64_bf16 v[96:99], v[48:51], a[64:71], v2
    v_smfmac_f32_16x16x64_bf16 v[100:103], v[48:51], a[72:79], v2
    v_smfmac_f32_16x16x64_bf16 v[104:107], v[48:51], a[192:199], v2
    s_cbranch_vccnz mega_kernel_rs_w2_pafail
    s_waitcnt lgkmcnt(0)
    s_barrier
    ds_read_b128 v[56:59], v6 offset:6144
    ds_read_b128 v[60:63], v6 offset:7168
    v_smfmac_f32_16x16x64_bf16 v[108:111], v[48:51], a[200:207], v2
    ds_read_b128 v[32:35], v6 offset:0
    v_smfmac_f32_16x16x64_bf16 v[96:99], v[52:55], a[80:87], v2
    ds_read_b128 v[36:39], v6 offset:1024
    v_smfmac_f32_16x16x64_bf16 v[100:103], v[52:55], a[88:95], v2
    ds_read_b128 v[40:43], v6 offset:2048
    v_smfmac_f32_16x16x64_bf16 v[104:107], v[52:55], a[208:215], v2
    ds_read_b128 v[44:47], v6 offset:3072
    v_smfmac_f32_16x16x64_bf16 v[108:111], v[52:55], a[216:223], v2
    buffer_load_dwordx4 v1, s[4:7], s43 offen lds
    s_waitcnt lgkmcnt(5)
    v_smfmac_f32_16x16x64_bf16 v[96:99], v[56:59], a[96:103], v2
    v_smfmac_f32_16x16x64_bf16 v[100:103], v[56:59], a[104:111], v2
    v_smfmac_f32_16x16x64_bf16 v[104:107], v[56:59], a[224:231], v2
    v_smfmac_f32_16x16x64_bf16 v[108:111], v[56:59], a[232:239], v2
    buffer_load_dwordx4 v1, s[4:7], s43 offen offset:1024 lds
    s_waitcnt lgkmcnt(4)
    v_smfmac_f32_16x16x64_bf16 v[96:99], v[60:63], a[112:119], v2
    v_smfmac_f32_16x16x64_bf16 v[100:103], v[60:63], a[120:127], v2
    v_smfmac_f32_16x16x64_bf16 v[104:107], v[60:63], a[240:247], v2
    v_smfmac_f32_16x16x64_bf16 v[108:111], v[60:63], a[248:255], v2
    buffer_store_dwordx4 v[20:23], v10, s[4:7], s45 offen offset:128 sc1
    s_waitcnt lgkmcnt(3)
    v_smfmac_f32_16x16x64_bf16 v[96:99], v[32:35], a[0:7], v2
    v_smfmac_f32_16x16x64_bf16 v[100:103], v[32:35], a[8:15], v2
    v_smfmac_f32_16x16x64_bf16 v[104:107], v[32:35], a[128:135], v2
    v_smfmac_f32_16x16x64_bf16 v[108:111], v[32:35], a[136:143], v2
    buffer_store_dwordx2 v[18:19], v11, s[4:7], s51 offen offset:3072 sc1
    s_waitcnt lgkmcnt(2)
    v_smfmac_f32_16x16x64_bf16 v[96:99], v[36:39], a[16:23], v2
    v_smfmac_f32_16x16x64_bf16 v[100:103], v[36:39], a[24:31], v2
    v_smfmac_f32_16x16x64_bf16 v[104:107], v[36:39], a[144:151], v2
    v_smfmac_f32_16x16x64_bf16 v[108:111], v[36:39], a[152:159], v2
    s_waitcnt lgkmcnt(1)
    v_smfmac_f32_16x16x64_bf16 v[96:99], v[40:43], a[32:39], v2
    v_smfmac_f32_16x16x64_bf16 v[100:103], v[40:43], a[40:47], v2
    v_smfmac_f32_16x16x64_bf16 v[104:107], v[40:43], a[160:167], v2
    v_smfmac_f32_16x16x64_bf16 v[108:111], v[40:43], a[168:175], v2
    s_waitcnt lgkmcnt(0)
    v_smfmac_f32_16x16x64_bf16 v[96:99], v[44:47], a[48:55], v2
    v_smfmac_f32_16x16x64_bf16 v[100:103], v[44:47], a[56:63], v2
    v_smfmac_f32_16x16x64_bf16 v[104:107], v[44:47], a[176:183], v2
    v_smfmac_f32_16x16x64_bf16 v[108:111], v[44:47], a[184:191], v2
    s_nop 4
    v_pk_add_f32 v[96:97], v[96:97], v[98:99]
    v_pk_add_f32 v[100:101], v[100:101], v[102:103]
    v_pk_add_f32 v[104:105], v[104:105], v[106:107]
    v_pk_add_f32 v[108:109], v[108:109], v[110:111]
    v_cvt_pk_bf16_f32 v111, v108, v109
    v_cvt_pk_bf16_f32 v108, v96, v97
    v_cvt_pk_bf16_f32 v110, v100, v101
    v_cvt_pk_bf16_f32 v109, v104, v105
    v_and_or_b32 v108, v108, -2, s41
    buffer_store_dwordx4 v[108:111], v1, s[4:7], s37 offen sc1
    v_smfmac_f32_16x16x64_bf16 v[112:115], v[32:35], v[64:71], v2
    ds_read_b128 v[64:67], v1 offset:40960
    ds_read_b128 v[68:71], v1 offset:41984
    v_smfmac_f32_16x16x64_bf16 v[116:119], v[32:35], v[72:79], v2
    ds_read_b128 v[72:75], v1 offset:43008
    ds_read_b128 v[76:79], v1 offset:44032
    v_smfmac_f32_16x16x64_bf16 v[112:115], v[36:39], v[80:87], v2
    ds_read_b128 v[80:83], v1 offset:57344
    ds_read_b128 v[84:87], v1 offset:58368
    v_smfmac_f32_16x16x64_bf16 v[116:119], v[36:39], v[88:95], v2
    ds_read_b128 v[88:91], v1 offset:59392
    ds_read_b128 v[92:95], v1 offset:60416
    v_smfmac_f32_16x16x64_bf16 v[112:115], v[52:55], v[208:215], v2
    v_smfmac_f32_16x16x64_bf16 v[116:119], v[52:55], v[216:223], v2
    v_smfmac_f32_16x16x64_bf16 v[112:115], v[56:59], v[224:231], v2
    s_waitcnt lgkmcnt(6)
    v_smfmac_f32_16x16x64_bf16 v[112:115], v[40:43], v[64:71], v2
    ds_read_b128 v[64:67], v5 offset:8192
    ds_read_b128 v[68:71], v5 offset:9216
    s_waitcnt lgkmcnt(6)
    v_smfmac_f32_16x16x64_bf16 v[116:119], v[40:43], v[72:79], v2
    ds_read_b128 v[72:75], v5 offset:10240
    ds_read_b128 v[76:79], v5 offset:11264
    v_smfmac_f32_16x16x64_bf16 v[116:119], v[56:59], v[232:239], v2
    v_smfmac_f32_16x16x64_bf16 v[112:115], v[60:63], v[240:247], v2
    v_smfmac_f32_16x16x64_bf16 v[116:119], v[60:63], v[248:255], v2
    s_waitcnt lgkmcnt(6)
    v_smfmac_f32_16x16x64_bf16 v[112:115], v[44:47], v[80:87], v2
    s_waitcnt lgkmcnt(4)
    v_smfmac_f32_16x16x64_bf16 v[116:119], v[44:47], v[88:95], v2
    s_waitcnt lgkmcnt(2)
    v_smfmac_f32_16x16x64_bf16 v[112:115], v[48:51], v[64:71], v2
    s_waitcnt lgkmcnt(0)
    v_smfmac_f32_16x16x64_bf16 v[116:119], v[48:51], v[72:79], v2
    v_mfma_f32_16x16x16_bf16 v[100:103], v[108:109], v[16:17], 0
    v_mfma_f32_16x16x16_bf16 v[104:107], v[110:111], v[16:17], 0
    s_nop 4
    v_add_f32 v112, v112, v114
    v_add_f32 v113, v113, v115
    v_add_f32 v114, v116, v118
    v_add_f32 v115, v117, v119
    v_cvt_pk_bf16_f32 v18, v112, v113
    v_cvt_pk_bf16_f32 v19, v114, v115
    v_and_or_b32 v18, v18, -2, s41
    v_mov_b32 v112, v18
    v_mov_b32 v114, v19
    v_mov_b32 v92, v28
    v_mov_b32 v93, 0
    s_waitcnt vmcnt(3)
    s_barrier
    ds_read_b128 v[32:35], v6 offset:15360
    ds_read_b128 v[36:39], v6 offset:16384
    ds_read_b128 v[40:43], v6 offset:18432
    ds_read_b128 v[44:47], v6 offset:19456
    ds_read_b128 v[48:51], v6 offset:9216
    ds_read_b128 v[52:55], v6 offset:10240
    ds_read_b128 v[56:59], v6 offset:12288
    ds_read_b128 v[60:63], v6 offset:13312
    buffer_load_dwordx4 v[96:99], v1, s[4:7], s38 offen sc1
    s_barrier
    buffer_store_dwordx2 v[18:19], v11, s[4:7], s39 offen sc1
    s_nop 15
    s_nop 15
    buffer_load_dwordx4 v[20:23], v1, s[4:7], s38 offen sc1
    s_waitcnt vmcnt(2)
    v_mfma_f32_16x16x16_bf16 v[80:83], v[96:97], v[16:17], v[100:103]
    v_mfma_f32_16x16x16_bf16 v[84:87], v[98:99], v[16:17], v[104:107]
    v_and_b32 v3, 1, v96
    v_cmp_ne_u32 vcc, s41, v3
    s_nop 4
    v_cvt_pk_bf16_f32 v64, v80, v81
    v_cvt_pk_bf16_f32 v65, v82, v83
    v_cvt_pk_bf16_f32 v66, v84, v85
    v_cvt_pk_bf16_f32 v67, v86, v87
    ds_write_b128 v6, v[64:67] offset:14336
    s_cbranch_vccnz mega_kernel_rs_w2_xslow
mega_kernel_rs_w2_xok:
    buffer_load_dwordx2 v[116:117], v11, s[4:7], s40 offen sc1
    s_waitcnt lgkmcnt(1)
    v_mfma_f32_16x16x32_bf16 v[80:83], v[32:35], v[64:67], 0
    s_waitcnt lgkmcnt(0)
    s_barrier
    ds_read_b128 v[68:71], v6 offset:17408
    ds_read_b128 v[72:75], v6 offset:8192
    ds_read_b128 v[76:79], v6 offset:11264
    v_mfma_f32_16x16x32_bf16 v[84:87], v[36:39], v[64:67], 0
    v_mfma_f32_16x16x32_bf16 v[88:91], v[64:67], v[64:67], 0
    buffer_load_dwordx2 v[20:21], v11, s[4:7], s40 offen sc1
    s_waitcnt lgkmcnt(2)
    v_mfma_f32_16x16x32_bf16 v[80:83], v[40:43], v[68:71], v[80:83]
    v_mfma_f32_16x16x32_bf16 v[84:87], v[44:47], v[68:71], v[84:87]
    v_mfma_f32_16x16x32_bf16 v[88:91], v[68:71], v[68:71], v[88:91]
    s_waitcnt lgkmcnt(1)
    v_mfma_f32_16x16x32_bf16 v[80:83], v[48:51], v[72:75], v[80:83]
    v_mfma_f32_16x16x32_bf16 v[84:87], v[52:55], v[72:75], v[84:87]
    v_mfma_f32_16x16x32_bf16 v[88:91], v[72:75], v[72:75], v[88:91]
    s_waitcnt lgkmcnt(0)
    v_mfma_f32_16x16x32_bf16 v[80:83], v[56:59], v[76:79], v[80:83]
    v_mfma_f32_16x16x32_bf16 v[84:87], v[60:63], v[76:79], v[84:87]
    v_mfma_f32_16x16x32_bf16 v[88:91], v[76:79], v[76:79], v[88:91]
    v_mfma_f32_32x32x4_2b_bf16 v[32:63], v[14:15], v[14:15], 0
    s_nop 4
    v_max3_f32 v4, v80, v81, v82
    v_max3_f32 v4, v4, v83, v84
    v_max3_f32 v4, v4, v85, v86
    v_max3_f32 v4, v4, v87, v88
    v_max_f32 v90, v4, v89
    v_max_f32 v4, v4, v89
    s_nop 0
    s_nop 0
    v_permlane16_swap_b32 v4, v90
    v_max_f32 v4, v4, v90
    v_max_f32 v90, v4, v90
    s_nop 1
    v_permlane32_swap_b32 v4, v90
    v_max_f32 v4, v4, v90
    v_mul_f32 v4, s34, v4
    v_pk_fma_f32 v[80:81], v[80:81], s[34:35], v[4:5] op_sel_hi:[1,0,0] neg_lo:[0,0,1] neg_hi:[0,0,1]
    v_pk_fma_f32 v[82:83], v[82:83], s[34:35], v[4:5] op_sel_hi:[1,0,0] neg_lo:[0,0,1] neg_hi:[0,0,1]
    v_pk_fma_f32 v[84:85], v[84:85], s[34:35], v[4:5] op_sel_hi:[1,0,0] neg_lo:[0,0,1] neg_hi:[0,0,1]
    v_pk_fma_f32 v[86:87], v[86:87], s[34:35], v[4:5] op_sel_hi:[1,0,0] neg_lo:[0,0,1] neg_hi:[0,0,1]
    v_pk_fma_f32 v[88:89], v[88:89], s[34:35], v[4:5] op_sel_hi:[1,0,0] neg_lo:[0,0,1] neg_hi:[0,0,1]
    v_exp_f32 v80, v80
    v_exp_f32 v81, v81
    v_exp_f32 v82, v82
    v_cvt_pk_bf16_f32 v68, v80, v81
    v_exp_f32 v83, v83
    v_exp_f32 v84, v84
    v_cvt_pk_bf16_f32 v69, v82, v83
    v_exp_f32 v85, v85
    v_exp_f32 v86, v86
    v_cvt_pk_bf16_f32 v70, v84, v85
    v_exp_f32 v87, v87
    v_exp_f32 v88, v88
    v_cvt_pk_bf16_f32 v71, v86, v87
    v_exp_f32 v89, v89
    s_cmp_eq_u32 s21, 63
    v_mfma_f32_16x16x32_bf16 v[76:79], v[28:31], v[68:71], 0
    v_cvt_pk_bf16_f32 v72, v88, v89
    v_cvt_pk_bf16_f32 v73, v88, v89
    v_mfma_f32_16x16x32_bf16 v[100:103], v[120:123], v[68:71], 0
    s_waitcnt vmcnt(1)
    v_and_b32 v3, 1, v116
    v_cmp_ne_u32 vcc, s41, v3
    v_mfma_f32_16x16x32_bf16 v[104:107], v[124:127], v[68:71], 0
    v_mov_b32 v113, v116
    v_mov_b32 v115, v117
    v_mfma_f32_16x16x16_bf16 v[76:79], v[92:93], v[72:73], v[76:79]
    s_cbranch_vccnz mega_kernel_rs_w2_pv0
mega_kernel_rs_w2_pv2:
    v_mfma_f32_16x16x16_bf16 v[100:103], v[112:113], v[72:73], v[100:103]
    v_mfma_f32_16x16x16_bf16 v[104:107], v[114:115], v[72:73], v[104:107]
    buffer_load_dwordx4 v[120:123], v1, s[4:7], s44 offen
    buffer_load_dwordx4 v[124:127], v1, s[4:7], s44 offen offset:1024
    s_cmp_eq_u32 s21, 63
    s_nop 1
    v_rcp_f32 v76, v76
    s_cbranch_scc1 mega_kernel_rs_w2_last
    s_mov_b64 exec, s[28:29]
    v_pk_mul_f32 v[100:101], v[100:101], v[76:77] op_sel_hi:[1,0]
    v_pk_mul_f32 v[102:103], v[102:103], v[76:77] op_sel_hi:[1,0]
    v_pk_mul_f32 v[104:105], v[104:105], v[76:77] op_sel_hi:[1,0]
    v_pk_mul_f32 v[106:107], v[106:107], v[76:77] op_sel_hi:[1,0]
    v_cvt_pk_bf16_f32 v72, v100, v101
    v_cvt_pk_bf16_f32 v73, v102, v103
    v_cvt_pk_bf16_f32 v74, v104, v105
    v_cvt_pk_bf16_f32 v75, v106, v107
    ds_write_b128 v6, v[72:75] offset:21472
    s_mov_b64 exec, -1
    ds_read_b128 v[88:91], v5 offset:24576
    ds_read_b128 v[92:95], v5 offset:25600
    ds_read_b128 v[80:83], v5 offset:26624
    ds_read_b128 v[84:87], v5 offset:27648
    ds_read_b128 v[112:115], v5 offset:40960
    ds_read_b128 v[116:119], v5 offset:41984
    s_waitcnt lgkmcnt(6)
    s_barrier
    ds_read_b128 v[68:71], v6 offset:20480
    ds_read_b128 v[72:75], v6 offset:21504
    ds_read_b128 v[96:99], v5 offset:43008
    ds_read_b128 v[100:103], v5 offset:44032
    ds_read_b128 v[104:107], v5 offset:57344
    ds_read_b128 v[108:111], v5 offset:58368
    s_waitcnt lgkmcnt(5)
    v_smfmac_f32_16x16x64_bf16 v[32:35], v[68:71], v[128:135], v2
    s_add_u32 s21, s21, 1
    v_smfmac_f32_16x16x64_bf16 v[36:39], v[68:71], v[136:143], v2
    s_xor_b32 s38, s38, 1048576
    v_smfmac_f32_16x16x64_bf16 v[40:43], v[68:71], v[144:151], v2
    s_xor_b32 s37, s37, 1048576
    v_smfmac_f32_16x16x64_bf16 v[44:47], v[68:71], v[152:159], v2
    s_xor_b32 s40, s40, 1048576
    s_waitcnt lgkmcnt(4)
    v_smfmac_f32_16x16x64_bf16 v[32:35], v[72:75], v[160:167], v2
    s_xor_b32 s39, s39, 1048576
    v_smfmac_f32_16x16x64_bf16 v[36:39], v[72:75], v[168:175], v2
    s_lshr_b32 s41, s21, 1
    v_smfmac_f32_16x16x64_bf16 v[40:43], v[72:75], v[176:183], v2
    s_and_b32 s41, s41, 1
    v_smfmac_f32_16x16x64_bf16 v[44:47], v[72:75], v[184:191], v2
    s_xor_b32 s41, s41, 1
    v_smfmac_f32_16x16x64_bf16 v[48:51], v[68:71], v[192:199], v2
    s_xor_b32 s35, s35, 16384
    v_smfmac_f32_16x16x64_bf16 v[52:55], v[68:71], v[200:207], v2
    s_xor_b32 s36, s36, 16384
    s_waitcnt lgkmcnt(0)
    v_smfmac_f32_16x16x64_bf16 v[56:59], v[68:71], v[88:95], v2
    ds_read_b128 v[88:91], v5 offset:59392
    ds_read_b128 v[92:95], v5 offset:60416
    v_smfmac_f32_16x16x64_bf16 v[60:63], v[68:71], v[80:87], v2
    s_add_u32 s43, s43, 262144
    v_smfmac_f32_16x16x64_bf16 v[48:51], v[72:75], v[112:119], v2
    s_add_u32 s44, s44, 262144
    v_add_f32 v32, v32, v34
    v_add_f32 v33, v33, v35
    v_cvt_pk_bf16_f32 v32, v32, v33
    v_and_or_b32 v32, v32, -2, s42
    v_smfmac_f32_16x16x64_bf16 v[52:55], v[72:75], v[96:103], v2
    v_add_f32 v36, v36, v38
    v_add_f32 v37, v37, v39
    v_cvt_pk_bf16_f32 v33, v36, v37
    v_smfmac_f32_16x16x64_bf16 v[56:59], v[72:75], v[104:111], v2
    v_add_f32 v40, v40, v42
    v_add_f32 v41, v41, v43
    v_cvt_pk_bf16_f32 v34, v40, v41
    s_waitcnt lgkmcnt(0)
    v_smfmac_f32_16x16x64_bf16 v[60:63], v[72:75], v[88:95], v2
    v_add_f32 v44, v44, v46
    v_add_f32 v45, v45, v47
    v_cvt_pk_bf16_f32 v35, v44, v45
    buffer_store_dwordx4 v[32:35], v8, s[4:7], s46 offen sc1
    v_pk_add_f32 v[48:49], v[48:49], v[50:51]
    v_cvt_pk_bf16_f32 v48, v48, v49
    v_and_or_b32 v48, v48, -2, s42
    v_pk_add_f32 v[52:53], v[52:53], v[54:55]
    v_cvt_pk_bf16_f32 v49, v52, v53
    v_pk_add_f32 v[56:57], v[56:57], v[58:59]
    v_cvt_pk_bf16_f32 v50, v56, v57
    v_pk_add_f32 v[60:61], v[60:61], v[62:63]
    v_cvt_pk_bf16_f32 v51, v60, v61
    buffer_store_dwordx4 v[48:51], v8, s[4:7], s61 offen sc1
    s_waitcnt vmcnt(4)
    v_mov_b32 v20, v64
    v_mov_b32 v21, v65
    v_mov_b32 v22, v66
    v_mov_b32 v23, v67
    s_add_u32 s45, s45, 262144
    s_add_u32 s51, s51, 262144
    v_mfma_f32_32x32x8_bf16 v[96:111], v[14:15], v[14:15], 0
    v_mfma_f32_16x16x16_bf16 v[112:115], v[14:15], v[14:15], 0
    v_mfma_f32_16x16x16_bf16 v[116:119], v[14:15], v[14:15], 0
    ds_read_b128 v[64:67], v1 offset:8192
    ds_read_b128 v[68:71], v1 offset:9216
    ds_read_b128 v[72:75], v1 offset:10240
    ds_read_b128 v[76:79], v1 offset:11264
    ds_read_b128 v[80:83], v1 offset:24576
    ds_read_b128 v[84:87], v1 offset:25600
    ds_read_b128 v[88:91], v1 offset:26624
    ds_read_b128 v[92:95], v1 offset:27648
    v_mov_b32 v58, -1
    v_mov_b32 v59, -1
    s_waitcnt vmcnt(0)
mega_kernel_rs_w2_pc:
    buffer_load_dword v36, v13, s[4:7], s47 offen offset:128 sc1
    buffer_load_dword v37, v13, s[4:7], s47 offen offset:1152 sc1
    buffer_load_dword v38, v13, s[4:7], s47 offen offset:2176 sc1
    buffer_load_dword v39, v13, s[4:7], s47 offen offset:3200 sc1
    buffer_load_dword v40, v13, s[4:7], s25 offen offset:128 sc1
    buffer_load_dword v41, v13, s[4:7], s25 offen offset:1152 sc1
    buffer_load_dword v42, v13, s[4:7], s25 offen offset:2176 sc1
    buffer_load_dword v43, v13, s[4:7], s25 offen offset:3200 sc1
    s_waitcnt vmcnt(4)
    v_mfma_f32_16x16x32_bf16 v[52:55], v[36:39], v[24:27], 0
    v_bitop3_b32 v3, s42, v36, v37 bitop3:0x7e
    v_bitop3_b32 v4, s42, v38, v39 bitop3:0x7e
    s_waitcnt vmcnt(2)
    v_or_b32 v3, v3, v4
    v_bitop3_b32 v4, s42, v40, v41 bitop3:0x7e
    s_waitcnt vmcnt(0)
    v_mfma_f32_16x16x32_bf16 v[52:55], v[40:43], v[24:27], v[52:55]
    v_bitop3_b32 v56, s42, v42, v43 bitop3:0x7e
    v_or3_b32 v3, v3, v4, v56
    v_and_b32 v3, v0, v3
    v_cmp_ne_u32 vcc, 0, v3
    s_cbranch_vccnz mega_kernel_rs_w2_pc
    s_nop 2
    v_cvt_pk_bf16_f32 v56, v52, v53
    v_cvt_pk_bf16_f32 v57, v54, v55
    v_min_u32 v56, -2, v56
    s_mov_b64 exec, s[26:27]
    buffer_store_dwordx2 v[56:57], v9, s[4:7], s35 offen offset:128 sc1
    buffer_store_dwordx2 v[58:59], v9, s[4:7], s36 offen offset:128 sc1
    s_mov_b64 exec, -1
    s_xor_b32 s42, s42, 1
    s_branch mega_kernel_rs_w2_loop
mega_kernel_rs_w2_last:
    s_waitcnt vmcnt(0)
    v_mov_b32 v20, v64
    v_mov_b32 v21, v65
    v_mov_b32 v22, v66
    v_mov_b32 v23, v67
    s_add_u32 s45, s45, 262144
    s_add_u32 s51, s51, 262144
    buffer_store_dwordx4 v[20:23], v10, s[4:7], s45 offen offset:128 sc1
    buffer_store_dwordx2 v[18:19], v11, s[4:7], s51 offen offset:3072 sc1
    s_branch mega_kernel_rs_end
mega_kernel_rs_w2_pafail:
    buffer_load_dwordx4 v[48:51], v12, s[4:7], s22 offen sc1
    buffer_load_dwordx4 v[52:55], v12, s[4:7], s22 offen offset:1024 sc1
    s_nop 7
    v_mov_b32 v96, 0
    v_mov_b32 v97, 0
    v_mov_b32 v98, 0
    v_mov_b32 v99, 0
    v_mov_b32 v100, 0
    v_mov_b32 v101, 0
    v_mov_b32 v102, 0
    v_mov_b32 v103, 0
    v_mov_b32 v104, 0
    v_mov_b32 v105, 0
    v_mov_b32 v106, 0
    v_mov_b32 v107, 0
    s_branch mega_kernel_rs_w2_pa
mega_kernel_rs_w2_xslow:
    buffer_load_dwordx4 v[96:99], v1, s[4:7], s38 offen sc1
    s_waitcnt vmcnt(1)
    v_and_b32 v3, 1, v20
    v_cmp_ne_u32 vcc, s41, v3
    s_cbranch_vccz mega_kernel_rs_w2_xgot1
    buffer_load_dwordx4 v[20:23], v1, s[4:7], s38 offen sc1
mega_kernel_rs_w2_px:
    s_waitcnt vmcnt(1)
    v_and_b32 v3, 1, v96
    v_cmp_ne_u32 vcc, s41, v3
    s_cbranch_vccz mega_kernel_rs_w2_xgot0
    buffer_load_dwordx4 v[96:99], v1, s[4:7], s38 offen sc1
    s_waitcnt vmcnt(1)
    v_and_b32 v3, 1, v20
    v_cmp_ne_u32 vcc, s41, v3
    s_cbranch_vccz mega_kernel_rs_w2_xgot1
    buffer_load_dwordx4 v[20:23], v1, s[4:7], s38 offen sc1
    s_branch mega_kernel_rs_w2_px
mega_kernel_rs_w2_xgot0:
    v_mfma_f32_16x16x16_bf16 v[80:83], v[96:97], v[16:17], v[100:103]
    v_mfma_f32_16x16x16_bf16 v[84:87], v[98:99], v[16:17], v[104:107]
    v_and_b32 v3, 1, v96
    v_cmp_ne_u32 vcc, s41, v3
    s_nop 4
    v_cvt_pk_bf16_f32 v64, v80, v81
    v_cvt_pk_bf16_f32 v65, v82, v83
    v_cvt_pk_bf16_f32 v66, v84, v85
    v_cvt_pk_bf16_f32 v67, v86, v87
    ds_write_b128 v6, v[64:67] offset:14336
    s_branch mega_kernel_rs_w2_xok
mega_kernel_rs_w2_xgot1:
    v_mfma_f32_16x16x16_bf16 v[80:83], v[20:21], v[16:17], v[100:103]
    v_mfma_f32_16x16x16_bf16 v[84:87], v[22:23], v[16:17], v[104:107]
    v_and_b32 v3, 1, v20
    v_cmp_ne_u32 vcc, s41, v3
    s_nop 4
    v_cvt_pk_bf16_f32 v64, v80, v81
    v_cvt_pk_bf16_f32 v65, v82, v83
    v_cvt_pk_bf16_f32 v66, v84, v85
    v_cvt_pk_bf16_f32 v67, v86, v87
    ds_write_b128 v6, v[64:67] offset:14336
    s_branch mega_kernel_rs_w2_xok
mega_kernel_rs_w2_pv0:
    s_waitcnt vmcnt(0)
    s_branch mega_kernel_rs_w2_pv1
mega_kernel_rs_w2_pv:
    buffer_load_dwordx2 v[20:21], v11, s[4:7], s40 offen sc1
    s_waitcnt vmcnt(0)
mega_kernel_rs_w2_pv1:
    v_and_b32 v3, 1, v20
    v_cmp_ne_u32 vcc, s41, v3
    v_mov_b32 v113, v20
    v_mov_b32 v115, v21
    s_cbranch_vccnz mega_kernel_rs_w2_pv
    s_branch mega_kernel_rs_w2_pv2
mega_kernel_rs_w3_entry:
    v_mfma_f32_32x32x8_bf16 v[96:111], v[14:15], v[14:15], 0
    v_mfma_f32_16x16x16_bf16 v[112:115], v[14:15], v[14:15], 0
    v_mfma_f32_16x16x16_bf16 v[116:119], v[14:15], v[14:15], 0
    ds_read_b128 v[64:67], v1 offset:12288
    ds_read_b128 v[68:71], v1 offset:13312
    ds_read_b128 v[72:75], v1 offset:14336
    ds_read_b128 v[76:79], v1 offset:15360
    ds_read_b128 v[80:83], v1 offset:28672
    ds_read_b128 v[84:87], v1 offset:29696
    ds_read_b128 v[88:91], v1 offset:30720
    ds_read_b128 v[92:95], v1 offset:31744
    buffer_load_dwordx4 v[120:123], v1, s[4:7], s44 offen
    buffer_load_dwordx4 v[124:127], v1, s[4:7], s44 offen offset:1024
    s_add_u32 s44, s44, 262144
mega_kernel_rs_w3_loop:
    s_add_u32 s22, s35, 6144
    s_waitcnt vmcnt(0)
    buffer_load_dwordx4 v[56:59], v12, s[4:7], s22 offen sc1
    buffer_load_dwordx4 v[60:63], v12, s[4:7], s22 offen offset:1024 sc1
mega_kernel_rs_w3_pa:
    s_waitcnt vmcnt(1)
    ds_write_b128 v6, v[56:59] offset:6144
    s_waitcnt vmcnt(0)
    ds_write_b128 v6, v[60:63] offset:7168
    v_max3_u32 v3, v56, v58, v60
    v_max_u32 v3, v3, v62
    v_cmp_eq_u32 vcc, -1, v3
    v_smfmac_f32_16x16x64_bf16 v[96:99], v[56:59], a[96:103], v2
    v_smfmac_f32_16x16x64_bf16 v[100:103], v[56:59], a[104:111], v2
    v_smfmac_f32_16x16x64_bf16 v[104:107], v[56:59], a[224:231], v2
    s_cbranch_vccnz mega_kernel_rs_w3_pafail
    s_waitcnt lgkmcnt(0)
    s_barrier
    ds_read_b128 v[32:35], v6 offset:0
    ds_read_b128 v[36:39], v6 offset:1024
    v_smfmac_f32_16x16x64_bf16 v[108:111], v[56:59], a[232:239], v2
    ds_read_b128 v[40:43], v6 offset:2048
    v_smfmac_f32_16x16x64_bf16 v[96:99], v[60:63], a[112:119], v2
    ds_read_b128 v[44:47], v6 offset:3072
    v_smfmac_f32_16x16x64_bf16 v[100:103], v[60:63], a[120:127], v2
    ds_read_b128 v[48:51], v6 offset:4096
    v_smfmac_f32_16x16x64_bf16 v[104:107], v[60:63], a[240:247], v2
    ds_read_b128 v[52:55], v6 offset:5120
    v_smfmac_f32_16x16x64_bf16 v[108:111], v[60:63], a[248:255], v2
    buffer_load_dwordx4 v1, s[4:7], s43 offen lds
    s_waitcnt lgkmcnt(5)
    v_smfmac_f32_16x16x64_bf16 v[96:99], v[32:35], a[0:7], v2
    v_smfmac_f32_16x16x64_bf16 v[100:103], v[32:35], a[8:15], v2
    v_smfmac_f32_16x16x64_bf16 v[104:107], v[32:35], a[128:135], v2
    v_smfmac_f32_16x16x64_bf16 v[108:111], v[32:35], a[136:143], v2
    buffer_load_dwordx4 v1, s[4:7], s43 offen offset:1024 lds
    s_waitcnt lgkmcnt(4)
    v_smfmac_f32_16x16x64_bf16 v[96:99], v[36:39], a[16:23], v2
    v_smfmac_f32_16x16x64_bf16 v[100:103], v[36:39], a[24:31], v2
    v_smfmac_f32_16x16x64_bf16 v[104:107], v[36:39], a[144:151], v2
    v_smfmac_f32_16x16x64_bf16 v[108:111], v[36:39], a[152:159], v2
    buffer_store_dwordx4 v[20:23], v10, s[4:7], s45 offen offset:192 sc1
    s_waitcnt lgkmcnt(3)
    v_smfmac_f32_16x16x64_bf16 v[96:99], v[40:43], a[32:39], v2
    v_smfmac_f32_16x16x64_bf16 v[100:103], v[40:43], a[40:47], v2
    v_smfmac_f32_16x16x64_bf16 v[104:107], v[40:43], a[160:167], v2
    v_smfmac_f32_16x16x64_bf16 v[108:111], v[40:43], a[168:175], v2
    buffer_store_dwordx2 v[18:19], v11, s[4:7], s51 offen offset:3584 sc1
    s_waitcnt lgkmcnt(2)
    v_smfmac_f32_16x16x64_bf16 v[96:99], v[44:47], a[48:55], v2
    v_smfmac_f32_16x16x64_bf16 v[100:103], v[44:47], a[56:63], v2
    v_smfmac_f32_16x16x64_bf16 v[104:107], v[44:47], a[176:183], v2
    v_smfmac_f32_16x16x64_bf16 v[108:111], v[44:47], a[184:191], v2
    buffer_load_dword v4, v7, s[4:7], 0 offen sc1
    s_waitcnt lgkmcnt(1)
    v_smfmac_f32_16x16x64_bf16 v[96:99], v[48:51], a[64:71], v2
    v_smfmac_f32_16x16x64_bf16 v[100:103], v[48:51], a[72:79], v2
    v_smfmac_f32_16x16x64_bf16 v[104:107], v[48:51], a[192:199], v2
    v_smfmac_f32_16x16x64_bf16 v[108:111], v[48:51], a[200:207], v2
    s_waitcnt lgkmcnt(0)
    v_smfmac_f32_16x16x64_bf16 v[96:99], v[52:55], a[80:87], v2
    v_smfmac_f32_16x16x64_bf16 v[100:103], v[52:55], a[88:95], v2
    v_smfmac_f32_16x16x64_bf16 v[104:107], v[52:55], a[208:215], v2
    v_smfmac_f32_16x16x64_bf16 v[108:111], v[52:55], a[216:223], v2
    s_nop 4
    v_pk_add_f32 v[96:97], v[96:97], v[98:99]
    v_pk_add_f32 v[100:101], v[100:101], v[102:103]
    v_pk_add_f32 v[104:105], v[104:105], v[106:107]
    v_pk_add_f32 v[108:109], v[108:109], v[110:111]
    v_cvt_pk_bf16_f32 v111, v108, v109
    v_cvt_pk_bf16_f32 v108, v96, v97
    v_cvt_pk_bf16_f32 v110, v100, v101
    v_cvt_pk_bf16_f32 v109, v104, v105
    v_and_or_b32 v108, v108, -2, s41
    buffer_store_dwordx4 v[108:111], v1, s[4:7], s37 offen sc1
    v_smfmac_f32_16x16x64_bf16 v[112:115], v[32:35], v[64:71], v2
    ds_read_b128 v[64:67], v1 offset:45056
    ds_read_b128 v[68:71], v1 offset:46080
    v_smfmac_f32_16x16x64_bf16 v[116:119], v[32:35], v[72:79], v2
    ds_read_b128 v[72:75], v1 offset:47104
    ds_read_b128 v[76:79], v1 offset:48128
    v_smfmac_f32_16x16x64_bf16 v[112:115], v[36:39], v[80:87], v2
    ds_read_b128 v[80:83], v1 offset:61440
    ds_read_b128 v[84:87], v1 offset:62464
    v_smfmac_f32_16x16x64_bf16 v[116:119], v[36:39], v[88:95], v2
    ds_read_b128 v[88:91], v1 offset:63488
    ds_read_b128 v[92:95], v1 offset:64512
    v_smfmac_f32_16x16x64_bf16 v[112:115], v[52:55], v[208:215], v2
    v_smfmac_f32_16x16x64_bf16 v[116:119], v[52:55], v[216:223], v2
    v_smfmac_f32_16x16x64_bf16 v[112:115], v[56:59], v[224:231], v2
    s_waitcnt lgkmcnt(6)
    v_smfmac_f32_16x16x64_bf16 v[112:115], v[40:43], v[64:71], v2
    ds_read_b128 v[64:67], v5 offset:12288
    ds_read_b128 v[68:71], v5 offset:13312
    s_waitcnt lgkmcnt(6)
    v_smfmac_f32_16x16x64_bf16 v[116:119], v[40:43], v[72:79], v2
    ds_read_b128 v[72:75], v5 offset:14336
    ds_read_b128 v[76:79], v5 offset:15360
    v_smfmac_f32_16x16x64_bf16 v[116:119], v[56:59], v[232:239], v2
    v_smfmac_f32_16x16x64_bf16 v[112:115], v[60:63], v[240:247], v2
    v_smfmac_f32_16x16x64_bf16 v[116:119], v[60:63], v[248:255], v2
    s_waitcnt lgkmcnt(6)
    v_smfmac_f32_16x16x64_bf16 v[112:115], v[44:47], v[80:87], v2
    s_waitcnt lgkmcnt(4)
    v_smfmac_f32_16x16x64_bf16 v[116:119], v[44:47], v[88:95], v2
    s_waitcnt lgkmcnt(2)
    v_smfmac_f32_16x16x64_bf16 v[112:115], v[48:51], v[64:71], v2
    s_waitcnt lgkmcnt(0)
    v_smfmac_f32_16x16x64_bf16 v[116:119], v[48:51], v[72:79], v2
    v_mfma_f32_16x16x16_bf16 v[100:103], v[108:109], v[16:17], 0
    v_mfma_f32_16x16x16_bf16 v[104:107], v[110:111], v[16:17], 0
    s_nop 4
    v_add_f32 v112, v112, v114
    v_add_f32 v113, v113, v115
    v_add_f32 v114, v116, v118
    v_add_f32 v115, v117, v119
    v_cvt_pk_bf16_f32 v18, v112, v113
    v_cvt_pk_bf16_f32 v19, v114, v115
    v_and_or_b32 v18, v18, -2, s41
    v_mov_b32 v112, v18
    v_mov_b32 v114, v19
    v_mov_b32 v92, v28
    v_mov_b32 v93, 0
    s_waitcnt vmcnt(4)
    s_barrier
    ds_read_b128 v[32:35], v6 offset:18432
    ds_read_b128 v[36:39], v6 offset:19456
    ds_read_b128 v[40:43], v6 offset:15360
    ds_read_b128 v[44:47], v6 offset:16384
    ds_read_b128 v[48:51], v6 offset:12288
    ds_read_b128 v[52:55], v6 offset:13312
    ds_read_b128 v[56:59], v6 offset:9216
    ds_read_b128 v[60:63], v6 offset:10240
    buffer_load_dwordx4 v[96:99], v1, s[4:7], s38 offen sc1
    s_barrier
    buffer_store_dwordx2 v[18:19], v11, s[4:7], s39 offen sc1
    s_nop 15
    s_nop 15
    buffer_load_dwordx4 v[20:23], v1, s[4:7], s38 offen sc1
    s_add_u32 s22, s21, 4
    s_cmp_gt_u32 s50, s22
    s_cbranch_scc1 mega_kernel_rs_w3_kvs
    s_waitcnt vmcnt(4)
    v_readlane_b32 s50, v4, 0
    v_readlane_b32 s22, v4, 2
    v_readlane_b32 s23, v4, 1
    v_readlane_b32 s24, v4, 3
    s_nop 3
    s_min_u32 s50, s50, s22
    s_min_u32 s23, s23, s24
    s_lshl_b32 s50, s50, 1
    s_lshl_b32 s23, s23, 1
    s_add_u32 s23, s23, 1
    s_min_u32 s50, s50, s23
mega_kernel_rs_kvb1:
    s_add_u32 s22, s21, 1
    s_min_u32 s22, s22, 63
    s_cmp_gt_u32 s50, s22
    s_cbranch_scc1 mega_kernel_rs_kvd1
    buffer_load_dword v4, v7, s[4:7], 0 offen sc1
    s_waitcnt vmcnt(0)
    v_readlane_b32 s50, v4, 0
    v_readlane_b32 s22, v4, 2
    v_readlane_b32 s23, v4, 1
    v_readlane_b32 s24, v4, 3
    s_nop 3
    s_min_u32 s50, s50, s22
    s_min_u32 s23, s23, s24
    s_lshl_b32 s50, s50, 1
    s_lshl_b32 s23, s23, 1
    s_add_u32 s23, s23, 1
    s_min_u32 s50, s50, s23
    s_branch mega_kernel_rs_kvb1
mega_kernel_rs_kvd1:
mega_kernel_rs_w3_kvs:
    s_waitcnt vmcnt(2)
    v_mfma_f32_16x16x16_bf16 v[80:83], v[96:97], v[16:17], v[100:103]
    v_mfma_f32_16x16x16_bf16 v[84:87], v[98:99], v[16:17], v[104:107]
    v_and_b32 v3, 1, v96
    v_cmp_ne_u32 vcc, s41, v3
    s_nop 4
    v_cvt_pk_bf16_f32 v64, v80, v81
    v_cvt_pk_bf16_f32 v65, v82, v83
    v_cvt_pk_bf16_f32 v66, v84, v85
    v_cvt_pk_bf16_f32 v67, v86, v87
    ds_write_b128 v6, v[64:67] offset:17408
    s_cbranch_vccnz mega_kernel_rs_w3_xslow
mega_kernel_rs_w3_xok:
    buffer_load_dwordx2 v[116:117], v11, s[4:7], s40 offen sc1
    s_waitcnt lgkmcnt(1)
    v_mfma_f32_16x16x32_bf16 v[80:83], v[32:35], v[64:67], 0
    s_waitcnt lgkmcnt(0)
    s_barrier
    ds_read_b128 v[68:71], v6 offset:14336
    ds_read_b128 v[72:75], v6 offset:11264
    ds_read_b128 v[76:79], v6 offset:8192
    v_mfma_f32_16x16x32_bf16 v[84:87], v[36:39], v[64:67], 0
    v_mfma_f32_16x16x32_bf16 v[88:91], v[64:67], v[64:67], 0
    buffer_load_dwordx2 v[20:21], v11, s[4:7], s40 offen sc1
    s_waitcnt lgkmcnt(2)
    v_mfma_f32_16x16x32_bf16 v[80:83], v[40:43], v[68:71], v[80:83]
    v_mfma_f32_16x16x32_bf16 v[84:87], v[44:47], v[68:71], v[84:87]
    v_mfma_f32_16x16x32_bf16 v[88:91], v[68:71], v[68:71], v[88:91]
    s_waitcnt lgkmcnt(1)
    v_mfma_f32_16x16x32_bf16 v[80:83], v[48:51], v[72:75], v[80:83]
    v_mfma_f32_16x16x32_bf16 v[84:87], v[52:55], v[72:75], v[84:87]
    v_mfma_f32_16x16x32_bf16 v[88:91], v[72:75], v[72:75], v[88:91]
    s_waitcnt lgkmcnt(0)
    v_mfma_f32_16x16x32_bf16 v[80:83], v[56:59], v[76:79], v[80:83]
    v_mfma_f32_16x16x32_bf16 v[84:87], v[60:63], v[76:79], v[84:87]
    v_mfma_f32_16x16x32_bf16 v[88:91], v[76:79], v[76:79], v[88:91]
    v_mfma_f32_32x32x4_2b_bf16 v[32:63], v[14:15], v[14:15], 0
    s_nop 4
    v_max3_f32 v4, v80, v81, v82
    v_max3_f32 v4, v4, v83, v84
    v_max3_f32 v4, v4, v85, v86
    v_max3_f32 v4, v4, v87, v88
    v_max_f32 v90, v4, v89
    v_max_f32 v4, v4, v89
    s_nop 0
    s_nop 0
    v_permlane16_swap_b32 v4, v90
    v_max_f32 v4, v4, v90
    v_max_f32 v90, v4, v90
    s_nop 1
    v_permlane32_swap_b32 v4, v90
    v_max_f32 v4, v4, v90
    v_mul_f32 v4, s34, v4
    v_pk_fma_f32 v[80:81], v[80:81], s[34:35], v[4:5] op_sel_hi:[1,0,0] neg_lo:[0,0,1] neg_hi:[0,0,1]
    v_pk_fma_f32 v[82:83], v[82:83], s[34:35], v[4:5] op_sel_hi:[1,0,0] neg_lo:[0,0,1] neg_hi:[0,0,1]
    v_pk_fma_f32 v[84:85], v[84:85], s[34:35], v[4:5] op_sel_hi:[1,0,0] neg_lo:[0,0,1] neg_hi:[0,0,1]
    v_pk_fma_f32 v[86:87], v[86:87], s[34:35], v[4:5] op_sel_hi:[1,0,0] neg_lo:[0,0,1] neg_hi:[0,0,1]
    v_pk_fma_f32 v[88:89], v[88:89], s[34:35], v[4:5] op_sel_hi:[1,0,0] neg_lo:[0,0,1] neg_hi:[0,0,1]
    v_exp_f32 v80, v80
    v_exp_f32 v81, v81
    v_exp_f32 v82, v82
    v_cvt_pk_bf16_f32 v68, v80, v81
    v_exp_f32 v83, v83
    v_exp_f32 v84, v84
    v_cvt_pk_bf16_f32 v69, v82, v83
    v_exp_f32 v85, v85
    v_exp_f32 v86, v86
    v_cvt_pk_bf16_f32 v70, v84, v85
    v_exp_f32 v87, v87
    v_exp_f32 v88, v88
    v_cvt_pk_bf16_f32 v71, v86, v87
    v_exp_f32 v89, v89
    s_cmp_eq_u32 s21, 63
    v_mfma_f32_16x16x32_bf16 v[76:79], v[28:31], v[68:71], 0
    v_cvt_pk_bf16_f32 v72, v88, v89
    v_cvt_pk_bf16_f32 v73, v88, v89
    v_mfma_f32_16x16x32_bf16 v[100:103], v[120:123], v[68:71], 0
    s_waitcnt vmcnt(1)
    v_and_b32 v3, 1, v116
    v_cmp_ne_u32 vcc, s41, v3
    v_mfma_f32_16x16x32_bf16 v[104:107], v[124:127], v[68:71], 0
    v_mov_b32 v113, v116
    v_mov_b32 v115, v117
    v_mfma_f32_16x16x16_bf16 v[76:79], v[92:93], v[72:73], v[76:79]
    s_cbranch_vccnz mega_kernel_rs_w3_pv0
mega_kernel_rs_w3_pv2:
    v_mfma_f32_16x16x16_bf16 v[100:103], v[112:113], v[72:73], v[100:103]
    v_mfma_f32_16x16x16_bf16 v[104:107], v[114:115], v[72:73], v[104:107]
    buffer_load_dwordx4 v[120:123], v1, s[4:7], s44 offen
    buffer_load_dwordx4 v[124:127], v1, s[4:7], s44 offen offset:1024
    s_cmp_eq_u32 s21, 63
    s_nop 1
    v_rcp_f32 v76, v76
    s_cbranch_scc1 mega_kernel_rs_w3_last
    s_mov_b64 exec, s[28:29]
    v_pk_mul_f32 v[100:101], v[100:101], v[76:77] op_sel_hi:[1,0]
    v_pk_mul_f32 v[102:103], v[102:103], v[76:77] op_sel_hi:[1,0]
    v_pk_mul_f32 v[104:105], v[104:105], v[76:77] op_sel_hi:[1,0]
    v_pk_mul_f32 v[106:107], v[106:107], v[76:77] op_sel_hi:[1,0]
    v_cvt_pk_bf16_f32 v72, v100, v101
    v_cvt_pk_bf16_f32 v73, v102, v103
    v_cvt_pk_bf16_f32 v74, v104, v105
    v_cvt_pk_bf16_f32 v75, v106, v107
    ds_write_b128 v6, v[72:75] offset:21504
    s_mov_b64 exec, -1
    ds_read_b128 v[88:91], v5 offset:28672
    ds_read_b128 v[92:95], v5 offset:29696
    ds_read_b128 v[80:83], v5 offset:30720
    ds_read_b128 v[84:87], v5 offset:31744
    ds_read_b128 v[112:115], v5 offset:45056
    ds_read_b128 v[116:119], v5 offset:46080
    s_waitcnt lgkmcnt(6)
    s_barrier
    ds_read_b128 v[68:71], v6 offset:20480
    ds_read_b128 v[72:75], v6 offset:21504
    ds_read_b128 v[96:99], v5 offset:47104
    ds_read_b128 v[100:103], v5 offset:48128
    ds_read_b128 v[104:107], v5 offset:61440
    ds_read_b128 v[108:111], v5 offset:62464
    s_waitcnt lgkmcnt(5)
    v_smfmac_f32_16x16x64_bf16 v[32:35], v[68:71], v[128:135], v2
    s_add_u32 s21, s21, 1
    v_smfmac_f32_16x16x64_bf16 v[36:39], v[68:71], v[136:143], v2
    s_xor_b32 s38, s38, 1048576
    v_smfmac_f32_16x16x64_bf16 v[40:43], v[68:71], v[144:151], v2
    s_xor_b32 s37, s37, 1048576
    v_smfmac_f32_16x16x64_bf16 v[44:47], v[68:71], v[152:159], v2
    s_xor_b32 s40, s40, 1048576
    s_waitcnt lgkmcnt(4)
    v_smfmac_f32_16x16x64_bf16 v[32:35], v[72:75], v[160:167], v2
    s_xor_b32 s39, s39, 1048576
    v_smfmac_f32_16x16x64_bf16 v[36:39], v[72:75], v[168:175], v2
    s_lshr_b32 s41, s21, 1
    v_smfmac_f32_16x16x64_bf16 v[40:43], v[72:75], v[176:183], v2
    s_and_b32 s41, s41, 1
    v_smfmac_f32_16x16x64_bf16 v[44:47], v[72:75], v[184:191], v2
    s_xor_b32 s41, s41, 1
    v_smfmac_f32_16x16x64_bf16 v[48:51], v[68:71], v[192:199], v2
    s_xor_b32 s35, s35, 16384
    v_smfmac_f32_16x16x64_bf16 v[52:55], v[68:71], v[200:207], v2
    s_xor_b32 s36, s36, 16384
    s_waitcnt lgkmcnt(0)
    v_smfmac_f32_16x16x64_bf16 v[56:59], v[68:71], v[88:95], v2
    ds_read_b128 v[88:91], v5 offset:63488
    ds_read_b128 v[92:95], v5 offset:64512
    v_smfmac_f32_16x16x64_bf16 v[60:63], v[68:71], v[80:87], v2
    s_add_u32 s43, s43, 262144
    v_smfmac_f32_16x16x64_bf16 v[48:51], v[72:75], v[112:119], v2
    s_add_u32 s44, s44, 262144
    v_add_f32 v32, v32, v34
    v_add_f32 v33, v33, v35
    v_cvt_pk_bf16_f32 v32, v32, v33
    v_and_or_b32 v32, v32, -2, s42
    v_smfmac_f32_16x16x64_bf16 v[52:55], v[72:75], v[96:103], v2
    v_add_f32 v36, v36, v38
    v_add_f32 v37, v37, v39
    v_cvt_pk_bf16_f32 v33, v36, v37
    v_smfmac_f32_16x16x64_bf16 v[56:59], v[72:75], v[104:111], v2
    v_add_f32 v40, v40, v42
    v_add_f32 v41, v41, v43
    v_cvt_pk_bf16_f32 v34, v40, v41
    s_waitcnt lgkmcnt(0)
    v_smfmac_f32_16x16x64_bf16 v[60:63], v[72:75], v[88:95], v2
    v_add_f32 v44, v44, v46
    v_add_f32 v45, v45, v47
    v_cvt_pk_bf16_f32 v35, v44, v45
    buffer_store_dwordx4 v[32:35], v8, s[4:7], s46 offen sc1
    v_pk_add_f32 v[48:49], v[48:49], v[50:51]
    v_cvt_pk_bf16_f32 v48, v48, v49
    v_and_or_b32 v48, v48, -2, s42
    v_pk_add_f32 v[52:53], v[52:53], v[54:55]
    v_cvt_pk_bf16_f32 v49, v52, v53
    v_pk_add_f32 v[56:57], v[56:57], v[58:59]
    v_cvt_pk_bf16_f32 v50, v56, v57
    v_pk_add_f32 v[60:61], v[60:61], v[62:63]
    v_cvt_pk_bf16_f32 v51, v60, v61
    buffer_store_dwordx4 v[48:51], v8, s[4:7], s61 offen sc1
    s_waitcnt vmcnt(4)
    v_mov_b32 v20, v64
    v_mov_b32 v21, v65
    v_mov_b32 v22, v66
    v_mov_b32 v23, v67
    s_add_u32 s45, s45, 262144
    s_add_u32 s51, s51, 262144
    v_mfma_f32_32x32x8_bf16 v[96:111], v[14:15], v[14:15], 0
    v_mfma_f32_16x16x16_bf16 v[112:115], v[14:15], v[14:15], 0
    v_mfma_f32_16x16x16_bf16 v[116:119], v[14:15], v[14:15], 0
    ds_read_b128 v[64:67], v1 offset:12288
    ds_read_b128 v[68:71], v1 offset:13312
    ds_read_b128 v[72:75], v1 offset:14336
    ds_read_b128 v[76:79], v1 offset:15360
    ds_read_b128 v[80:83], v1 offset:28672
    ds_read_b128 v[84:87], v1 offset:29696
    ds_read_b128 v[88:91], v1 offset:30720
    ds_read_b128 v[92:95], v1 offset:31744
    v_mov_b32 v58, -1
    v_mov_b32 v59, -1
    s_waitcnt vmcnt(0)
mega_kernel_rs_w3_pc:
    buffer_load_dword v36, v13, s[4:7], s47 offen offset:192 sc1
    buffer_load_dword v37, v13, s[4:7], s47 offen offset:1216 sc1
    buffer_load_dword v38, v13, s[4:7], s47 offen offset:2240 sc1
    buffer_load_dword v39, v13, s[4:7], s47 offen offset:3264 sc1
    buffer_load_dword v40, v13, s[4:7], s25 offen offset:192 sc1
    buffer_load_dword v41, v13, s[4:7], s25 offen offset:1216 sc1
    buffer_load_dword v42, v13, s[4:7], s25 offen offset:2240 sc1
    buffer_load_dword v43, v13, s[4:7], s25 offen offset:3264 sc1
    s_waitcnt vmcnt(4)
    v_mfma_f32_16x16x32_bf16 v[52:55], v[36:39], v[24:27], 0
    v_bitop3_b32 v3, s42, v36, v37 bitop3:0x7e
    v_bitop3_b32 v4, s42, v38, v39 bitop3:0x7e
    s_waitcnt vmcnt(2)
    v_or_b32 v3, v3, v4
    v_bitop3_b32 v4, s42, v40, v41 bitop3:0x7e
    s_waitcnt vmcnt(0)
    v_mfma_f32_16x16x32_bf16 v[52:55], v[40:43], v[24:27], v[52:55]
    v_bitop3_b32 v56, s42, v42, v43 bitop3:0x7e
    v_or3_b32 v3, v3, v4, v56
    v_and_b32 v3, v0, v3
    v_cmp_ne_u32 vcc, 0, v3
    s_cbranch_vccnz mega_kernel_rs_w3_pc
    s_nop 2
    v_cvt_pk_bf16_f32 v56, v52, v53
    v_cvt_pk_bf16_f32 v57, v54, v55
    v_min_u32 v56, -2, v56
    s_mov_b64 exec, s[26:27]
    buffer_store_dwordx2 v[56:57], v9, s[4:7], s35 offen offset:192 sc1
    buffer_store_dwordx2 v[58:59], v9, s[4:7], s36 offen offset:192 sc1
    s_mov_b64 exec, -1
    s_xor_b32 s42, s42, 1
    s_branch mega_kernel_rs_w3_loop
mega_kernel_rs_w3_last:
    s_waitcnt vmcnt(0)
    v_mov_b32 v20, v64
    v_mov_b32 v21, v65
    v_mov_b32 v22, v66
    v_mov_b32 v23, v67
    s_add_u32 s45, s45, 262144
    s_add_u32 s51, s51, 262144
    buffer_store_dwordx4 v[20:23], v10, s[4:7], s45 offen offset:192 sc1
    buffer_store_dwordx2 v[18:19], v11, s[4:7], s51 offen offset:3584 sc1
    s_branch mega_kernel_rs_end
mega_kernel_rs_w3_pafail:
    buffer_load_dwordx4 v[56:59], v12, s[4:7], s22 offen sc1
    buffer_load_dwordx4 v[60:63], v12, s[4:7], s22 offen offset:1024 sc1
    s_nop 7
    v_mov_b32 v96, 0
    v_mov_b32 v97, 0
    v_mov_b32 v98, 0
    v_mov_b32 v99, 0
    v_mov_b32 v100, 0
    v_mov_b32 v101, 0
    v_mov_b32 v102, 0
    v_mov_b32 v103, 0
    v_mov_b32 v104, 0
    v_mov_b32 v105, 0
    v_mov_b32 v106, 0
    v_mov_b32 v107, 0
    s_branch mega_kernel_rs_w3_pa
mega_kernel_rs_w3_xslow:
    buffer_load_dwordx4 v[96:99], v1, s[4:7], s38 offen sc1
    s_waitcnt vmcnt(1)
    v_and_b32 v3, 1, v20
    v_cmp_ne_u32 vcc, s41, v3
    s_cbranch_vccz mega_kernel_rs_w3_xgot1
    buffer_load_dwordx4 v[20:23], v1, s[4:7], s38 offen sc1
mega_kernel_rs_w3_px:
    s_waitcnt vmcnt(1)
    v_and_b32 v3, 1, v96
    v_cmp_ne_u32 vcc, s41, v3
    s_cbranch_vccz mega_kernel_rs_w3_xgot0
    buffer_load_dwordx4 v[96:99], v1, s[4:7], s38 offen sc1
    s_waitcnt vmcnt(1)
    v_and_b32 v3, 1, v20
    v_cmp_ne_u32 vcc, s41, v3
    s_cbranch_vccz mega_kernel_rs_w3_xgot1
    buffer_load_dwordx4 v[20:23], v1, s[4:7], s38 offen sc1
    s_branch mega_kernel_rs_w3_px
mega_kernel_rs_w3_xgot0:
    v_mfma_f32_16x16x16_bf16 v[80:83], v[96:97], v[16:17], v[100:103]
    v_mfma_f32_16x16x16_bf16 v[84:87], v[98:99], v[16:17], v[104:107]
    v_and_b32 v3, 1, v96
    v_cmp_ne_u32 vcc, s41, v3
    s_nop 4
    v_cvt_pk_bf16_f32 v64, v80, v81
    v_cvt_pk_bf16_f32 v65, v82, v83
    v_cvt_pk_bf16_f32 v66, v84, v85
    v_cvt_pk_bf16_f32 v67, v86, v87
    ds_write_b128 v6, v[64:67] offset:17408
    s_branch mega_kernel_rs_w3_xok
mega_kernel_rs_w3_xgot1:
    v_mfma_f32_16x16x16_bf16 v[80:83], v[20:21], v[16:17], v[100:103]
    v_mfma_f32_16x16x16_bf16 v[84:87], v[22:23], v[16:17], v[104:107]
    v_and_b32 v3, 1, v20
    v_cmp_ne_u32 vcc, s41, v3
    s_nop 4
    v_cvt_pk_bf16_f32 v64, v80, v81
    v_cvt_pk_bf16_f32 v65, v82, v83
    v_cvt_pk_bf16_f32 v66, v84, v85
    v_cvt_pk_bf16_f32 v67, v86, v87
    ds_write_b128 v6, v[64:67] offset:17408
    s_branch mega_kernel_rs_w3_xok
mega_kernel_rs_w3_pv0:
    s_waitcnt vmcnt(0)
    s_branch mega_kernel_rs_w3_pv1
mega_kernel_rs_w3_pv:
    buffer_load_dwordx2 v[20:21], v11, s[4:7], s40 offen sc1
    s_waitcnt vmcnt(0)
mega_kernel_rs_w3_pv1:
    v_and_b32 v3, 1, v20
    v_cmp_ne_u32 vcc, s41, v3
    v_mov_b32 v113, v20
    v_mov_b32 v115, v21
    s_cbranch_vccnz mega_kernel_rs_w3_pv
    s_branch mega_kernel_rs_w3_pv2
mega_kernel_rs_end:
    s_mov_b64 exec, -1
    v_mov_b32 v3, 64
    s_waitcnt vmcnt(0)
    s_barrier
    s_cmp_lg_u32 s20, 0
    s_cbranch_scc1 mega_kernel_rs_end2
    buffer_store_dword v3, v7, s[4:7], 0 offen sc1
mega_kernel_rs_end2:
    s_waitcnt vmcnt(0)
    s_endpgm
mega_kernel_bulk:
    s_load_dwordx2 s[8:9], s[0:1], 0
    s_load_dwordx2 s[40:41], s[0:1], 16
    s_load_dwordx2 s[42:43], s[0:1], 24
    s_load_dwordx2 s[44:45], s[0:1], 32
    v_lshrrev_b32 v2, 6, v0
    v_and_b32 v1, 63, v0
    v_readfirstlane_b32 s16, v2
    s_lshr_b32 s17, s92, 6
    s_bfe_u32 s18, s92, 0x50001
    s_and_b32 s19, s92, 1
    s_waitcnt lgkmcnt(0)
    s_mov_b32 s10, 4194304
    s_mov_b32 s11, 0x00020000
    s_cmp_eq_u32 s17, 1
    s_cselect_b32 s12, s42, s40
    s_cselect_b32 s13, s43, s41
    s_cmp_eq_u32 s17, 2
    s_cselect_b32 s12, s44, s12
    s_cselect_b32 s13, s45, s13
    s_mov_b32 s14, 8388608
    s_mov_b32 s15, 0x00020000
    v_lshrrev_b32 v2, 4, v1
    v_and_b32 v3, 15, v1
    v_lshlrev_b32 v4, 2, v2
    v_xor_b32 v4, v4, v3
    v_lshlrev_b32 v4, 4, v4
    s_lshl_b32 s20, s16, 5
    v_add_u32 v11, s20, v2
    v_lshl_add_u32 v11, v11, 13, v4
    s_lshl_b32 s20, s18, 8
    v_add_u32 v11, s20, v11
    s_lshl_b32 s22, s16, 13
    s_add_u32 m0, s22, 0
    s_mov_b32 s20, 0
    buffer_load_dwordx4 v11, s[12:15], s20 offen lds
    s_add_u32 m0, s22, 1024
    s_mov_b32 s20, 32768
    buffer_load_dwordx4 v11, s[12:15], s20 offen lds
    s_add_u32 m0, s22, 2048
    s_mov_b32 s20, 65536
    buffer_load_dwordx4 v11, s[12:15], s20 offen lds
    s_add_u32 m0, s22, 3072
    s_mov_b32 s20, 98304
    buffer_load_dwordx4 v11, s[12:15], s20 offen lds
    s_add_u32 m0, s22, 4096
    s_mov_b32 s20, 131072
    buffer_load_dwordx4 v11, s[12:15], s20 offen lds
    s_add_u32 m0, s22, 5120
    s_mov_b32 s20, 163840
    buffer_load_dwordx4 v11, s[12:15], s20 offen lds
    s_add_u32 m0, s22, 6144
    s_mov_b32 s20, 196608
    buffer_load_dwordx4 v11, s[12:15], s20 offen lds
    s_add_u32 m0, s22, 7168
    s_mov_b32 s20, 229376
    buffer_load_dwordx4 v11, s[12:15], s20 offen lds
    s_add_u32 m0, s22, 32768
    s_mov_b32 s20, 1048576
    buffer_load_dwordx4 v11, s[12:15], s20 offen lds
    s_add_u32 m0, s22, 33792
    s_mov_b32 s20, 1081344
    buffer_load_dwordx4 v11, s[12:15], s20 offen lds
    s_add_u32 m0, s22, 34816
    s_mov_b32 s20, 1114112
    buffer_load_dwordx4 v11, s[12:15], s20 offen lds
    s_add_u32 m0, s22, 35840
    s_mov_b32 s20, 1146880
    buffer_load_dwordx4 v11, s[12:15], s20 offen lds
    s_add_u32 m0, s22, 36864
    s_mov_b32 s20, 1179648
    buffer_load_dwordx4 v11, s[12:15], s20 offen lds
    s_add_u32 m0, s22, 37888
    s_mov_b32 s20, 1212416
    buffer_load_dwordx4 v11, s[12:15], s20 offen lds
    s_add_u32 m0, s22, 38912
    s_mov_b32 s20, 1245184
    buffer_load_dwordx4 v11, s[12:15], s20 offen lds
    s_add_u32 m0, s22, 39936
    s_mov_b32 s20, 1277952
    buffer_load_dwordx4 v11, s[12:15], s20 offen lds
    s_add_u32 m0, s22, 65536
    s_mov_b32 s20, 2097152
    buffer_load_dwordx4 v11, s[12:15], s20 offen lds
    s_add_u32 m0, s22, 66560
    s_mov_b32 s20, 2129920
    buffer_load_dwordx4 v11, s[12:15], s20 offen lds
    s_add_u32 m0, s22, 67584
    s_mov_b32 s20, 2162688
    buffer_load_dwordx4 v11, s[12:15], s20 offen lds
    s_add_u32 m0, s22, 68608
    s_mov_b32 s20, 2195456
    buffer_load_dwordx4 v11, s[12:15], s20 offen lds
    s_add_u32 m0, s22, 69632
    s_mov_b32 s20, 2228224
    buffer_load_dwordx4 v11, s[12:15], s20 offen lds
    s_add_u32 m0, s22, 70656
    s_mov_b32 s20, 2260992
    buffer_load_dwordx4 v11, s[12:15], s20 offen lds
    s_add_u32 m0, s22, 71680
    s_mov_b32 s20, 2293760
    buffer_load_dwordx4 v11, s[12:15], s20 offen lds
    s_add_u32 m0, s22, 72704
    s_mov_b32 s20, 2326528
    buffer_load_dwordx4 v11, s[12:15], s20 offen lds
    s_add_u32 m0, s22, 98304
    s_mov_b32 s20, 3145728
    buffer_load_dwordx4 v11, s[12:15], s20 offen lds
    s_add_u32 m0, s22, 99328
    s_mov_b32 s20, 3178496
    buffer_load_dwordx4 v11, s[12:15], s20 offen lds
    s_add_u32 m0, s22, 100352
    s_mov_b32 s20, 3211264
    buffer_load_dwordx4 v11, s[12:15], s20 offen lds
    s_add_u32 m0, s22, 101376
    s_mov_b32 s20, 3244032
    buffer_load_dwordx4 v11, s[12:15], s20 offen lds
    s_add_u32 m0, s22, 102400
    s_mov_b32 s20, 3276800
    buffer_load_dwordx4 v11, s[12:15], s20 offen lds
    s_add_u32 m0, s22, 103424
    s_mov_b32 s20, 3309568
    buffer_load_dwordx4 v11, s[12:15], s20 offen lds
    s_add_u32 m0, s22, 104448
    s_mov_b32 s20, 3342336
    buffer_load_dwordx4 v11, s[12:15], s20 offen lds
    s_add_u32 m0, s22, 105472
    s_mov_b32 s20, 3375104
    buffer_load_dwordx4 v11, s[12:15], s20 offen lds
    s_waitcnt vmcnt(32)
    s_barrier
    s_or_b32 s81, s97, s98
    s_cmp_lg_u32 s81, 0
    s_cbranch_scc1 mega_kernel_h0_3
    s_lshl_b32 s81, s93, 5
    v_mov_b32 v250, 1
    s_mov_b64 exec, 1
    buffer_atomic_add v250, off, s[88:91], s81 sc1
    s_mov_b64 exec, -1
mega_kernel_h0_3:
    v_and_b32 v3, 3, v1
    v_bfe_u32 v4, v1, 4, 1
    v_lshl_add_u32 v13, v3, 1, v4
    v_and_b32 v14, 1, v3
    v_lshlrev_b32 v14, 1, v14
    v_lshrrev_b32 v15, 1, v3
    v_add_u32 v14, v14, v15
    v_lshl_add_u32 v14, v4, 2, v14
    s_cmp_eq_u32 s17, 2
    s_cselect_b64 vcc, -1, 0
    v_cndmask_b32 v13, v14, v13, vcc
    v_bfe_u32 v14, v1, 2, 2
    v_xor_b32 v15, s16, v14
    v_lshlrev_b32 v15, 6, v15
    v_lshl_add_u32 v15, v13, 3, v15
    v_lshrrev_b32 v13, 5, v1
    v_lshl_add_u32 v13, v13, 3, v14
    v_lshl_add_u32 v12, v13, 8, v15
    v_and_b32 v3, 15, v1
    s_lshl_b32 s20, s16, 3
    v_add_u32 v13, s20, v2
    v_add_u32 v13, 0, v13
    v_and_b32 v14, 15, v13
    v_xor_b32 v14, v14, v3
    v_lshlrev_b32 v14, 4, v14
    v_lshl_add_u32 v6, v13, 11, v14
    v_add_u32 v13, s20, v2
    v_add_u32 v13, 4, v13
    v_and_b32 v14, 15, v13
    v_xor_b32 v14, v14, v3
    v_lshlrev_b32 v14, 4, v14
    v_lshl_add_u32 v7, v13, 11, v14
    v_and_b32 v13, 31, v1
    v_lshrrev_b32 v14, 5, v1
    v_xor_b32 v14, v14, v3
    v_lshlrev_b32 v14, 4, v14
    v_lshl_add_u32 v13, v13, 8, v14
    v_xor_b32 v16, 0, v13
    v_add_u32 v24, 0x10000, v16
    v_xor_b32 v17, 32, v13
    v_add_u32 v25, 0x10000, v17
    v_xor_b32 v18, 64, v13
    v_add_u32 v26, 0x10000, v18
    v_xor_b32 v19, 96, v13
    v_add_u32 v27, 0x10000, v19
    v_xor_b32 v20, 128, v13
    v_add_u32 v28, 0x10000, v20
    v_xor_b32 v21, 160, v13
    v_add_u32 v29, 0x10000, v21
    v_xor_b32 v22, 192, v13
    v_add_u32 v30, 0x10000, v22
    v_xor_b32 v23, 224, v13
    v_add_u32 v31, 0x10000, v23
    v_bfe_u32 v13, v1, 4, 1
    v_lshlrev_b32 v8, 10, v13
    v_lshrrev_b32 v13, 5, v1
    v_lshl_add_u32 v8, v13, 8, v8
    v_lshl_add_u32 v8, v3, 4, v8
    v_bfrev_b32 v13, 1
    s_lshl_b32 s20, s92, 7
    s_add_u32 s20, s20, 71303168
    v_mov_b32 v14, s20
    v_cmp_eq_u32 vcc, 0, v0
    s_lshl_b32 s24, s17, 24
    s_lshl_b32 s20, s19, 18
    v_cndmask_b32 v9, v13, v14, vcc
    s_add_u32 s24, s24, s20
    s_lshl_b32 s20, s18, 13
    s_add_u32 s24, s24, s20
    s_lshl_b32 s20, s16, 11
    s_add_u32 s24, s24, s20
    s_add_u32 s24, s24, 0
    s_lshl_b32 s23, s19, 16
    v_mov_b32 v10, 0
    s_lshl_b32 s21, s16, 11
    s_waitcnt vmcnt(24)
    s_barrier
    v_add_u32 v13, 0, v12
    ds_read_b64_tr_b16 a[0:1], v13 offset:0
    ds_read_b64_tr_b16 a[2:3], v13 offset:1024
    ds_read_b64_tr_b16 a[4:5], v13 offset:4096
    ds_read_b64_tr_b16 a[6:7], v13 offset:5120
    ds_read_b64_tr_b16 a[8:9], v13 offset:8192
    ds_read_b64_tr_b16 a[10:11], v13 offset:9216
    ds_read_b64_tr_b16 a[12:13], v13 offset:12288
    ds_read_b64_tr_b16 a[14:15], v13 offset:13312
    s_waitcnt lgkmcnt(0)
    ds_read_b64_tr_b16 a[16:17], v13 offset:16384
    ds_read_b64_tr_b16 a[18:19], v13 offset:17408
    ds_read_b64_tr_b16 a[20:21], v13 offset:20480
    ds_read_b64_tr_b16 a[22:23], v13 offset:21504
    ds_read_b64_tr_b16 a[24:25], v13 offset:24576
    ds_read_b64_tr_b16 a[26:27], v13 offset:25600
    ds_read_b64_tr_b16 a[28:29], v13 offset:28672
    ds_read_b64_tr_b16 a[30:31], v13 offset:29696
    s_waitcnt lgkmcnt(0)
    s_barrier
    s_add_u32 m0, s22, 0
    s_mov_b32 s20, 4194304
    buffer_load_dwordx4 v11, s[12:15], s20 offen lds
    s_add_u32 m0, s22, 1024
    s_mov_b32 s20, 4227072
    buffer_load_dwordx4 v11, s[12:15], s20 offen lds
    s_add_u32 m0, s22, 2048
    s_mov_b32 s20, 4259840
    buffer_load_dwordx4 v11, s[12:15], s20 offen lds
    s_add_u32 m0, s22, 3072
    s_mov_b32 s20, 4292608
    buffer_load_dwordx4 v11, s[12:15], s20 offen lds
    s_add_u32 m0, s22, 4096
    s_mov_b32 s20, 4325376
    buffer_load_dwordx4 v11, s[12:15], s20 offen lds
    s_add_u32 m0, s22, 5120
    s_mov_b32 s20, 4358144
    buffer_load_dwordx4 v11, s[12:15], s20 offen lds
    s_add_u32 m0, s22, 6144
    s_mov_b32 s20, 4390912
    buffer_load_dwordx4 v11, s[12:15], s20 offen lds
    s_add_u32 m0, s22, 7168
    s_mov_b32 s20, 4423680
    buffer_load_dwordx4 v11, s[12:15], s20 offen lds
    s_waitcnt vmcnt(24)
    s_barrier
    v_add_u32 v13, 32768, v12
    ds_read_b64_tr_b16 a[32:33], v13 offset:0
    ds_read_b64_tr_b16 a[34:35], v13 offset:1024
    ds_read_b64_tr_b16 a[36:37], v13 offset:4096
    ds_read_b64_tr_b16 a[38:39], v13 offset:5120
    ds_read_b64_tr_b16 a[40:41], v13 offset:8192
    ds_read_b64_tr_b16 a[42:43], v13 offset:9216
    ds_read_b64_tr_b16 a[44:45], v13 offset:12288
    ds_read_b64_tr_b16 a[46:47], v13 offset:13312
    s_waitcnt lgkmcnt(0)
    ds_read_b64_tr_b16 a[48:49], v13 offset:16384
    ds_read_b64_tr_b16 a[50:51], v13 offset:17408
    ds_read_b64_tr_b16 a[52:53], v13 offset:20480
    ds_read_b64_tr_b16 a[54:55], v13 offset:21504
    ds_read_b64_tr_b16 a[56:57], v13 offset:24576
    ds_read_b64_tr_b16 a[58:59], v13 offset:25600
    ds_read_b64_tr_b16 a[60:61], v13 offset:28672
    ds_read_b64_tr_b16 a[62:63], v13 offset:29696
    s_waitcnt lgkmcnt(0)
    s_barrier
    s_add_u32 m0, s22, 32768
    s_mov_b32 s20, 5242880
    buffer_load_dwordx4 v11, s[12:15], s20 offen lds
    s_add_u32 m0, s22, 33792
    s_mov_b32 s20, 5275648
    buffer_load_dwordx4 v11, s[12:15], s20 offen lds
    s_add_u32 m0, s22, 34816
    s_mov_b32 s20, 5308416
    buffer_load_dwordx4 v11, s[12:15], s20 offen lds
    s_add_u32 m0, s22, 35840
    s_mov_b32 s20, 5341184
    buffer_load_dwordx4 v11, s[12:15], s20 offen lds
    s_add_u32 m0, s22, 36864
    s_mov_b32 s20, 5373952
    buffer_load_dwordx4 v11, s[12:15], s20 offen lds
    s_add_u32 m0, s22, 37888
    s_mov_b32 s20, 5406720
    buffer_load_dwordx4 v11, s[12:15], s20 offen lds
    s_add_u32 m0, s22, 38912
    s_mov_b32 s20, 5439488
    buffer_load_dwordx4 v11, s[12:15], s20 offen lds
    s_add_u32 m0, s22, 39936
    s_mov_b32 s20, 5472256
    buffer_load_dwordx4 v11, s[12:15], s20 offen lds
    s_waitcnt vmcnt(24)
    s_barrier
    v_add_u32 v13, 65536, v12
    ds_read_b64_tr_b16 a[64:65], v13 offset:0
    ds_read_b64_tr_b16 a[66:67], v13 offset:1024
    ds_read_b64_tr_b16 a[68:69], v13 offset:4096
    ds_read_b64_tr_b16 a[70:71], v13 offset:5120
    ds_read_b64_tr_b16 a[72:73], v13 offset:8192
    ds_read_b64_tr_b16 a[74:75], v13 offset:9216
    ds_read_b64_tr_b16 a[76:77], v13 offset:12288
    ds_read_b64_tr_b16 a[78:79], v13 offset:13312
    s_waitcnt lgkmcnt(0)
    ds_read_b64_tr_b16 a[80:81], v13 offset:16384
    ds_read_b64_tr_b16 a[82:83], v13 offset:17408
    ds_read_b64_tr_b16 a[84:85], v13 offset:20480
    ds_read_b64_tr_b16 a[86:87], v13 offset:21504
    ds_read_b64_tr_b16 a[88:89], v13 offset:24576
    ds_read_b64_tr_b16 a[90:91], v13 offset:25600
    ds_read_b64_tr_b16 a[92:93], v13 offset:28672
    ds_read_b64_tr_b16 a[94:95], v13 offset:29696
    s_waitcnt lgkmcnt(0)
    s_barrier
    s_add_u32 m0, s22, 65536
    s_mov_b32 s20, 6291456
    buffer_load_dwordx4 v11, s[12:15], s20 offen lds
    s_add_u32 m0, s22, 66560
    s_mov_b32 s20, 6324224
    buffer_load_dwordx4 v11, s[12:15], s20 offen lds
    s_add_u32 m0, s22, 67584
    s_mov_b32 s20, 6356992
    buffer_load_dwordx4 v11, s[12:15], s20 offen lds
    s_add_u32 m0, s22, 68608
    s_mov_b32 s20, 6389760
    buffer_load_dwordx4 v11, s[12:15], s20 offen lds
    s_add_u32 m0, s22, 69632
    s_mov_b32 s20, 6422528
    buffer_load_dwordx4 v11, s[12:15], s20 offen lds
    s_add_u32 m0, s22, 70656
    s_mov_b32 s20, 6455296
    buffer_load_dwordx4 v11, s[12:15], s20 offen lds
    s_add_u32 m0, s22, 71680
    s_mov_b32 s20, 6488064
    buffer_load_dwordx4 v11, s[12:15], s20 offen lds
    s_add_u32 m0, s22, 72704
    s_mov_b32 s20, 6520832
    buffer_load_dwordx4 v11, s[12:15], s20 offen lds
    s_waitcnt vmcnt(24)
    s_barrier
    v_and_b32 v254, 7, v0
    v_lshlrev_b32 v254, 5, v254
    buffer_load_dword v252, v254, s[88:91], 0 offen sc1
    v_add_u32 v13, 98304, v12
    ds_read_b64_tr_b16 a[96:97], v13 offset:0
    ds_read_b64_tr_b16 a[98:99], v13 offset:1024
    ds_read_b64_tr_b16 a[100:101], v13 offset:4096
    ds_read_b64_tr_b16 a[102:103], v13 offset:5120
    ds_read_b64_tr_b16 a[104:105], v13 offset:8192
    ds_read_b64_tr_b16 a[106:107], v13 offset:9216
    ds_read_b64_tr_b16 a[108:109], v13 offset:12288
    ds_read_b64_tr_b16 a[110:111], v13 offset:13312
    s_waitcnt lgkmcnt(0)
    ds_read_b64_tr_b16 a[112:113], v13 offset:16384
    ds_read_b64_tr_b16 a[114:115], v13 offset:17408
    ds_read_b64_tr_b16 a[116:117], v13 offset:20480
    ds_read_b64_tr_b16 a[118:119], v13 offset:21504
    ds_read_b64_tr_b16 a[120:121], v13 offset:24576
    ds_read_b64_tr_b16 a[122:123], v13 offset:25600
    ds_read_b64_tr_b16 a[124:125], v13 offset:28672
    ds_read_b64_tr_b16 a[126:127], v13 offset:29696
    s_waitcnt lgkmcnt(0)
    s_barrier
    s_add_u32 m0, s22, 98304
    s_mov_b32 s20, 7340032
    buffer_load_dwordx4 v11, s[12:15], s20 offen lds
    s_add_u32 m0, s22, 99328
    s_mov_b32 s20, 7372800
    buffer_load_dwordx4 v11, s[12:15], s20 offen lds
    s_add_u32 m0, s22, 100352
    s_mov_b32 s20, 7405568
    buffer_load_dwordx4 v11, s[12:15], s20 offen lds
    s_add_u32 m0, s22, 101376
    s_mov_b32 s20, 7438336
    buffer_load_dwordx4 v11, s[12:15], s20 offen lds
    s_add_u32 m0, s22, 102400
    s_mov_b32 s20, 7471104
    buffer_load_dwordx4 v11, s[12:15], s20 offen lds
    s_add_u32 m0, s22, 103424
    s_mov_b32 s20, 7503872
    buffer_load_dwordx4 v11, s[12:15], s20 offen lds
    s_add_u32 m0, s22, 104448
    s_mov_b32 s20, 7536640
    buffer_load_dwordx4 v11, s[12:15], s20 offen lds
    s_add_u32 m0, s22, 105472
    s_mov_b32 s20, 7569408
    buffer_load_dwordx4 v11, s[12:15], s20 offen lds
    s_waitcnt vmcnt(24)
    s_barrier
    v_add_u32 v13, 0, v12
    ds_read_b64_tr_b16 a[128:129], v13 offset:0
    ds_read_b64_tr_b16 a[130:131], v13 offset:1024
    ds_read_b64_tr_b16 a[132:133], v13 offset:4096
    ds_read_b64_tr_b16 a[134:135], v13 offset:5120
    ds_read_b64_tr_b16 a[136:137], v13 offset:8192
    ds_read_b64_tr_b16 a[138:139], v13 offset:9216
    ds_read_b64_tr_b16 a[140:141], v13 offset:12288
    ds_read_b64_tr_b16 a[142:143], v13 offset:13312
    s_waitcnt lgkmcnt(0)
    ds_read_b64_tr_b16 a[144:145], v13 offset:16384
    ds_read_b64_tr_b16 a[146:147], v13 offset:17408
    ds_read_b64_tr_b16 a[148:149], v13 offset:20480
    ds_read_b64_tr_b16 a[150:151], v13 offset:21504
    ds_read_b64_tr_b16 a[152:153], v13 offset:24576
    ds_read_b64_tr_b16 a[154:155], v13 offset:25600
    ds_read_b64_tr_b16 a[156:157], v13 offset:28672
    ds_read_b64_tr_b16 a[158:159], v13 offset:29696
    s_waitcnt lgkmcnt(0)
    s_barrier
    s_add_u32 m0, s21, 0
    s_add_u32 s20, s23, 0
    buffer_load_dwordx4 v6, s[8:11], s20 offen lds
    s_add_u32 m0, s21, 1024
    s_add_u32 s20, s23, 0
    buffer_load_dwordx4 v7, s[8:11], s20 offen lds
    s_add_u32 m0, s21, 8192
    s_add_u32 s20, s23, 256
    buffer_load_dwordx4 v6, s[8:11], s20 offen lds
    s_add_u32 m0, s21, 9216
    s_add_u32 s20, s23, 256
    buffer_load_dwordx4 v7, s[8:11], s20 offen lds
    s_add_u32 m0, s21, 16384
    s_add_u32 s20, s23, 512
    buffer_load_dwordx4 v6, s[8:11], s20 offen lds
    s_add_u32 m0, s21, 17408
    s_add_u32 s20, s23, 512
    buffer_load_dwordx4 v7, s[8:11], s20 offen lds
    s_add_u32 m0, s21, 24576
    s_add_u32 s20, s23, 768
    buffer_load_dwordx4 v6, s[8:11], s20 offen lds
    s_add_u32 m0, s21, 25600
    s_add_u32 s20, s23, 768
    buffer_load_dwordx4 v7, s[8:11], s20 offen lds
    s_waitcnt vmcnt(24)
    s_barrier
    v_add_u32 v13, 32768, v12
    ds_read_b64_tr_b16 a[160:161], v13 offset:0
    ds_read_b64_tr_b16 a[162:163], v13 offset:1024
    ds_read_b64_tr_b16 a[164:165], v13 offset:4096
    ds_read_b64_tr_b16 a[166:167], v13 offset:5120
    ds_read_b64_tr_b16 a[168:169], v13 offset:8192
    ds_read_b64_tr_b16 a[170:171], v13 offset:9216
    ds_read_b64_tr_b16 a[172:173], v13 offset:12288
    ds_read_b64_tr_b16 a[174:175], v13 offset:13312
    s_waitcnt lgkmcnt(0)
    ds_read_b64_tr_b16 a[176:177], v13 offset:16384
    ds_read_b64_tr_b16 a[178:179], v13 offset:17408
    ds_read_b64_tr_b16 a[180:181], v13 offset:20480
    ds_read_b64_tr_b16 a[182:183], v13 offset:21504
    ds_read_b64_tr_b16 a[184:185], v13 offset:24576
    ds_read_b64_tr_b16 a[186:187], v13 offset:25600
    ds_read_b64_tr_b16 a[188:189], v13 offset:28672
    ds_read_b64_tr_b16 a[190:191], v13 offset:29696
    s_waitcnt lgkmcnt(0)
    s_barrier
    s_add_u32 m0, s21, 32768
    s_add_u32 s20, s23, 1024
    buffer_load_dwordx4 v6, s[8:11], s20 offen lds
    s_add_u32 m0, s21, 33792
    s_add_u32 s20, s23, 1024
    buffer_load_dwordx4 v7, s[8:11], s20 offen lds
    s_add_u32 m0, s21, 40960
    s_add_u32 s20, s23, 1280
    buffer_load_dwordx4 v6, s[8:11], s20 offen lds
    s_add_u32 m0, s21, 41984
    s_add_u32 s20, s23, 1280
    buffer_load_dwordx4 v7, s[8:11], s20 offen lds
    s_add_u32 m0, s21, 49152
    s_add_u32 s20, s23, 1536
    buffer_load_dwordx4 v6, s[8:11], s20 offen lds
    s_add_u32 m0, s21, 50176
    s_add_u32 s20, s23, 1536
    buffer_load_dwordx4 v7, s[8:11], s20 offen lds
    s_add_u32 m0, s21, 57344
    s_add_u32 s20, s23, 1792
    buffer_load_dwordx4 v6, s[8:11], s20 offen lds
    s_add_u32 m0, s21, 58368
    s_add_u32 s20, s23, 1792
    buffer_load_dwordx4 v7, s[8:11], s20 offen lds
    s_waitcnt vmcnt(24)
    s_barrier
    v_add_u32 v13, 65536, v12
    ds_read_b64_tr_b16 a[192:193], v13 offset:0
    ds_read_b64_tr_b16 a[194:195], v13 offset:1024
    ds_read_b64_tr_b16 a[196:197], v13 offset:4096
    ds_read_b64_tr_b16 a[198:199], v13 offset:5120
    ds_read_b64_tr_b16 a[200:201], v13 offset:8192
    ds_read_b64_tr_b16 a[202:203], v13 offset:9216
    ds_read_b64_tr_b16 a[204:205], v13 offset:12288
    ds_read_b64_tr_b16 a[206:207], v13 offset:13312
    s_waitcnt lgkmcnt(0)
    ds_read_b64_tr_b16 a[208:209], v13 offset:16384
    ds_read_b64_tr_b16 a[210:211], v13 offset:17408
    ds_read_b64_tr_b16 a[212:213], v13 offset:20480
    ds_read_b64_tr_b16 a[214:215], v13 offset:21504
    ds_read_b64_tr_b16 a[216:217], v13 offset:24576
    ds_read_b64_tr_b16 a[218:219], v13 offset:25600
    ds_read_b64_tr_b16 a[220:221], v13 offset:28672
    ds_read_b64_tr_b16 a[222:223], v13 offset:29696
    s_waitcnt lgkmcnt(0)
    s_barrier
    s_add_u32 s23, s23, 131072
    s_add_u32 m0, s21, 65536
    s_add_u32 s20, s23, 0
    buffer_load_dwordx4 v6, s[8:11], s20 offen lds
    s_add_u32 m0, s21, 66560
    s_add_u32 s20, s23, 0
    buffer_load_dwordx4 v7, s[8:11], s20 offen lds
    s_add_u32 m0, s21, 73728
    s_add_u32 s20, s23, 256
    buffer_load_dwordx4 v6, s[8:11], s20 offen lds
    s_add_u32 m0, s21, 74752
    s_add_u32 s20, s23, 256
    buffer_load_dwordx4 v7, s[8:11], s20 offen lds
    s_add_u32 m0, s21, 81920
    s_add_u32 s20, s23, 512
    buffer_load_dwordx4 v6, s[8:11], s20 offen lds
    s_add_u32 m0, s21, 82944
    s_add_u32 s20, s23, 512
    buffer_load_dwordx4 v7, s[8:11], s20 offen lds
    s_add_u32 m0, s21, 90112
    s_add_u32 s20, s23, 768
    buffer_load_dwordx4 v6, s[8:11], s20 offen lds
    s_add_u32 m0, s21, 91136
    s_add_u32 s20, s23, 768
    buffer_load_dwordx4 v7, s[8:11], s20 offen lds
    s_waitcnt vmcnt(24)
    s_barrier
    s_cmp_lg_u32 s97, 0
    s_cbranch_scc1 mega_kernel_h2_4_ok
mega_kernel_h2_4_ev:
    v_cmp_ne_u32 vcc, 32, v252
    s_cbranch_vccz mega_kernel_h2_4_ok
    s_mov_b32 s78, 0
    v_readlane_b32 s81, v252, 0
    s_nop 3
    s_add_u32 s78, s78, s81
    v_readlane_b32 s81, v252, 1
    s_nop 3
    s_add_u32 s78, s78, s81
    v_readlane_b32 s81, v252, 2
    s_nop 3
    s_add_u32 s78, s78, s81
    v_readlane_b32 s81, v252, 3
    s_nop 3
    s_add_u32 s78, s78, s81
    v_readlane_b32 s81, v252, 4
    s_nop 3
    s_add_u32 s78, s78, s81
    v_readlane_b32 s81, v252, 5
    s_nop 3
    s_add_u32 s78, s78, s81
    v_readlane_b32 s81, v252, 6
    s_nop 3
    s_add_u32 s78, s78, s81
    v_readlane_b32 s81, v252, 7
    s_nop 3
    s_add_u32 s78, s78, s81
    s_cmp_eq_u32 s78, 256
    s_cbranch_scc1 mega_kernel_redo
    buffer_load_dword v252, v254, s[88:91], 0 offen sc1
    s_waitcnt vmcnt(0)
    s_branch mega_kernel_h2_4_ev
mega_kernel_h2_4_ok:
    v_add_u32 v13, 98304, v12
    ds_read_b64_tr_b16 a[224:225], v13 offset:0
    ds_read_b64_tr_b16 a[226:227], v13 offset:1024
    ds_read_b64_tr_b16 a[228:229], v13 offset:4096
    ds_read_b64_tr_b16 a[230:231], v13 offset:5120
    ds_read_b64_tr_b16 a[232:233], v13 offset:8192
    ds_read_b64_tr_b16 a[234:235], v13 offset:9216
    ds_read_b64_tr_b16 a[236:237], v13 offset:12288
    ds_read_b64_tr_b16 a[238:239], v13 offset:13312
    s_waitcnt lgkmcnt(0)
    ds_read_b64_tr_b16 a[240:241], v13 offset:16384
    ds_read_b64_tr_b16 a[242:243], v13 offset:17408
    ds_read_b64_tr_b16 a[244:245], v13 offset:20480
    ds_read_b64_tr_b16 a[246:247], v13 offset:21504
    ds_read_b64_tr_b16 a[248:249], v13 offset:24576
    ds_read_b64_tr_b16 a[250:251], v13 offset:25600
    ds_read_b64_tr_b16 a[252:253], v13 offset:28672
    ds_read_b64_tr_b16 a[254:255], v13 offset:29696
    s_waitcnt lgkmcnt(0)
    s_barrier
    s_waitcnt vmcnt(16)
    s_barrier
    s_cmp_eq_u32 s17, 2
    s_cbranch_scc1 mega_kernel_q_v
    ds_read_b128 v[32:35], v16 offset:0
    ds_read_b128 v[36:39], v17 offset:0
    ds_read_b128 v[40:43], v18 offset:0
    ds_read_b128 v[44:47], v19 offset:0
    ds_read_b128 v[48:51], v20 offset:0
    ds_read_b128 v[52:55], v21 offset:0
    s_mov_b32 s25, 0
mega_kernel_q_qk_loop:
    s_waitcnt lgkmcnt(5)
    v_mfma_f32_32x32x16_bf16 v[64:79], a[0:3], v[32:35], 0
    ds_read_b128 v[56:59], v22 offset:0
    s_waitcnt lgkmcnt(5)
    v_mfma_f32_32x32x16_bf16 v[64:79], a[4:7], v[36:39], v[64:79]
    ds_read_b128 v[60:63], v23 offset:0
    s_waitcnt lgkmcnt(5)
    v_mfma_f32_32x32x16_bf16 v[64:79], a[8:11], v[40:43], v[64:79]
    ds_read_b128 v[32:35], v16 offset:8192
    s_cmp_eq_u32 s25, 0
    s_cbranch_scc1 mega_kernel_q_qk_sk2
    s_add_u32 m0, s21, 74752
    s_add_u32 s20, s23, 256
    buffer_load_dwordx4 v7, s[8:11], s20 offen lds
mega_kernel_q_qk_sk2:
    s_waitcnt lgkmcnt(5)
    v_mfma_f32_32x32x16_bf16 v[64:79], a[12:15], v[44:47], v[64:79]
    ds_read_b128 v[36:39], v17 offset:8192
    s_waitcnt lgkmcnt(5)
    v_mfma_f32_32x32x16_bf16 v[64:79], a[16:19], v[48:51], v[64:79]
    ds_read_b128 v[40:43], v18 offset:8192
    s_waitcnt lgkmcnt(5)
    v_mfma_f32_32x32x16_bf16 v[64:79], a[20:23], v[52:55], v[64:79]
    ds_read_b128 v[44:47], v19 offset:8192
    s_cmp_eq_u32 s25, 0
    s_cbranch_scc1 mega_kernel_q_qk_sk5
    s_add_u32 m0, s21, 81920
    s_add_u32 s20, s23, 512
    buffer_load_dwordx4 v6, s[8:11], s20 offen lds
mega_kernel_q_qk_sk5:
    s_waitcnt lgkmcnt(5)
    v_mfma_f32_32x32x16_bf16 v[64:79], a[24:27], v[56:59], v[64:79]
    ds_read_b128 v[48:51], v20 offset:8192
    s_waitcnt lgkmcnt(5)
    v_mfma_f32_32x32x16_bf16 v[64:79], a[28:31], v[60:63], v[64:79]
    ds_read_b128 v[52:55], v21 offset:8192
    s_waitcnt lgkmcnt(5)
    v_mfma_f32_32x32x16_bf16 v[64:79], a[32:35], v[32:35], v[64:79]
    ds_read_b128 v[56:59], v22 offset:8192
    s_cmp_eq_u32 s25, 0
    s_cbranch_scc1 mega_kernel_q_qk_sk8
    s_add_u32 m0, s21, 82944
    s_add_u32 s20, s23, 512
    buffer_load_dwordx4 v7, s[8:11], s20 offen lds
mega_kernel_q_qk_sk8:
    s_waitcnt lgkmcnt(5)
    v_mfma_f32_32x32x16_bf16 v[64:79], a[36:39], v[36:39], v[64:79]
    ds_read_b128 v[60:63], v23 offset:8192
    s_waitcnt lgkmcnt(5)
    v_mfma_f32_32x32x16_bf16 v[64:79], a[40:43], v[40:43], v[64:79]
    ds_read_b128 v[32:35], v16 offset:16384
    s_waitcnt lgkmcnt(5)
    v_mfma_f32_32x32x16_bf16 v[64:79], a[44:47], v[44:47], v[64:79]
    ds_read_b128 v[36:39], v17 offset:16384
    s_cmp_eq_u32 s25, 0
    s_cbranch_scc1 mega_kernel_q_qk_sk11
    s_add_u32 m0, s21, 90112
    s_add_u32 s20, s23, 768
    buffer_load_dwordx4 v6, s[8:11], s20 offen lds
mega_kernel_q_qk_sk11:
    s_waitcnt lgkmcnt(5)
    v_mfma_f32_32x32x16_bf16 v[64:79], a[48:51], v[48:51], v[64:79]
    ds_read_b128 v[40:43], v18 offset:16384
    s_waitcnt lgkmcnt(5)
    v_mfma_f32_32x32x16_bf16 v[64:79], a[52:55], v[52:55], v[64:79]
    ds_read_b128 v[44:47], v19 offset:16384
    s_waitcnt lgkmcnt(5)
    v_mfma_f32_32x32x16_bf16 v[64:79], a[56:59], v[56:59], v[64:79]
    ds_read_b128 v[48:51], v20 offset:16384
    s_cmp_eq_u32 s25, 0
    s_cbranch_scc1 mega_kernel_q_qk_sk14
    s_add_u32 m0, s21, 91136
    s_add_u32 s20, s23, 768
    buffer_load_dwordx4 v7, s[8:11], s20 offen lds
mega_kernel_q_qk_sk14:
    s_waitcnt lgkmcnt(5)
    v_mfma_f32_32x32x16_bf16 v[64:79], a[60:63], v[60:63], v[64:79]
    ds_read_b128 v[52:55], v21 offset:16384
    s_waitcnt lgkmcnt(5)
    v_mfma_f32_32x32x16_bf16 v[64:79], a[64:67], v[32:35], v[64:79]
    ds_read_b128 v[56:59], v22 offset:16384
    s_cmp_eq_u32 s25, 0
    s_cbranch_scc1 mega_kernel_q_qk_ne0
    v_cvt_pk_bf16_f32 v96, v80, v81
    v_cvt_pk_bf16_f32 v97, v82, v83
    v_cvt_pk_bf16_f32 v98, v84, v85
    v_cvt_pk_bf16_f32 v99, v86, v87
    buffer_store_dwordx4 v[96:99], v8, s[84:87], s24 offen offset:0 sc1
mega_kernel_q_qk_ne0:
    s_waitcnt lgkmcnt(5)
    v_mfma_f32_32x32x16_bf16 v[64:79], a[68:71], v[36:39], v[64:79]
    ds_read_b128 v[60:63], v23 offset:16384
    s_waitcnt lgkmcnt(5)
    v_mfma_f32_32x32x16_bf16 v[64:79], a[72:75], v[40:43], v[64:79]
    ds_read_b128 v[32:35], v16 offset:24576
    s_cmp_eq_u32 s25, 0
    s_cbranch_scc1 mega_kernel_q_qk_ne1
    v_cvt_pk_bf16_f32 v100, v88, v89
    v_cvt_pk_bf16_f32 v101, v90, v91
    v_cvt_pk_bf16_f32 v102, v92, v93
    v_cvt_pk_bf16_f32 v103, v94, v95
    buffer_store_dwordx4 v[100:103], v8, s[84:87], s24 offen offset:512 sc1
    s_add_u32 s24, s24, 524288
mega_kernel_q_qk_ne1:
    s_waitcnt lgkmcnt(5)
    v_mfma_f32_32x32x16_bf16 v[64:79], a[76:79], v[44:47], v[64:79]
    ds_read_b128 v[36:39], v17 offset:24576
    s_waitcnt lgkmcnt(5)
    v_mfma_f32_32x32x16_bf16 v[64:79], a[80:83], v[48:51], v[64:79]
    ds_read_b128 v[40:43], v18 offset:24576
    s_waitcnt lgkmcnt(5)
    v_mfma_f32_32x32x16_bf16 v[64:79], a[84:87], v[52:55], v[64:79]
    ds_read_b128 v[44:47], v19 offset:24576
    s_waitcnt lgkmcnt(5)
    v_mfma_f32_32x32x16_bf16 v[64:79], a[88:91], v[56:59], v[64:79]
    ds_read_b128 v[48:51], v20 offset:24576
    s_waitcnt lgkmcnt(5)
    v_mfma_f32_32x32x16_bf16 v[64:79], a[92:95], v[60:63], v[64:79]
    ds_read_b128 v[52:55], v21 offset:24576
    s_waitcnt vmcnt(8)
    s_barrier
    s_waitcnt lgkmcnt(5)
    v_mfma_f32_32x32x16_bf16 v[64:79], a[96:99], v[32:35], v[64:79]
    ds_read_b128 v[56:59], v22 offset:24576
    s_waitcnt lgkmcnt(5)
    v_mfma_f32_32x32x16_bf16 v[64:79], a[100:103], v[36:39], v[64:79]
    ds_read_b128 v[60:63], v23 offset:24576
    s_add_u32 m0, s21, 98304
    s_add_u32 s20, s23, 1024
    buffer_load_dwordx4 v6, s[8:11], s20 offen lds
    s_waitcnt lgkmcnt(5)
    v_mfma_f32_32x32x16_bf16 v[64:79], a[104:107], v[40:43], v[64:79]
    ds_read_b128 v[32:35], v16 offset:32768
    s_waitcnt lgkmcnt(5)
    v_mfma_f32_32x32x16_bf16 v[64:79], a[108:111], v[44:47], v[64:79]
    ds_read_b128 v[36:39], v17 offset:32768
    s_waitcnt lgkmcnt(5)
    v_mfma_f32_32x32x16_bf16 v[64:79], a[112:115], v[48:51], v[64:79]
    ds_read_b128 v[40:43], v18 offset:32768
    s_add_u32 m0, s21, 99328
    s_add_u32 s20, s23, 1024
    buffer_load_dwordx4 v7, s[8:11], s20 offen lds
    s_waitcnt lgkmcnt(5)
    v_mfma_f32_32x32x16_bf16 v[64:79], a[116:119], v[52:55], v[64:79]
    ds_read_b128 v[44:47], v19 offset:32768
    s_waitcnt lgkmcnt(5)
    v_mfma_f32_32x32x16_bf16 v[64:79], a[120:123], v[56:59], v[64:79]
    ds_read_b128 v[48:51], v20 offset:32768
    s_waitcnt lgkmcnt(5)
    v_mfma_f32_32x32x16_bf16 v[64:79], a[124:127], v[60:63], v[64:79]
    ds_read_b128 v[52:55], v21 offset:32768
    s_add_u32 m0, s21, 106496
    s_add_u32 s20, s23, 1280
    buffer_load_dwordx4 v6, s[8:11], s20 offen lds
    s_waitcnt lgkmcnt(5)
    v_mfma_f32_32x32x16_bf16 v[64:79], a[128:131], v[32:35], v[64:79]
    ds_read_b128 v[56:59], v22 offset:32768
    s_waitcnt lgkmcnt(5)
    v_mfma_f32_32x32x16_bf16 v[64:79], a[132:135], v[36:39], v[64:79]
    ds_read_b128 v[60:63], v23 offset:32768
    s_waitcnt lgkmcnt(5)
    v_mfma_f32_32x32x16_bf16 v[64:79], a[136:139], v[40:43], v[64:79]
    ds_read_b128 v[32:35], v16 offset:40960
    s_add_u32 m0, s21, 107520
    s_add_u32 s20, s23, 1280
    buffer_load_dwordx4 v7, s[8:11], s20 offen lds
    s_waitcnt lgkmcnt(5)
    v_mfma_f32_32x32x16_bf16 v[64:79], a[140:143], v[44:47], v[64:79]
    ds_read_b128 v[36:39], v17 offset:40960
    s_waitcnt lgkmcnt(5)
    v_mfma_f32_32x32x16_bf16 v[64:79], a[144:147], v[48:51], v[64:79]
    ds_read_b128 v[40:43], v18 offset:40960
    s_waitcnt lgkmcnt(5)
    v_mfma_f32_32x32x16_bf16 v[64:79], a[148:151], v[52:55], v[64:79]
    ds_read_b128 v[44:47], v19 offset:40960
    s_add_u32 m0, s21, 114688
    s_add_u32 s20, s23, 1536
    buffer_load_dwordx4 v6, s[8:11], s20 offen lds
    s_waitcnt lgkmcnt(5)
    v_mfma_f32_32x32x16_bf16 v[64:79], a[152:155], v[56:59], v[64:79]
    ds_read_b128 v[48:51], v20 offset:40960
    s_waitcnt lgkmcnt(5)
    v_mfma_f32_32x32x16_bf16 v[64:79], a[156:159], v[60:63], v[64:79]
    ds_read_b128 v[52:55], v21 offset:40960
    s_waitcnt lgkmcnt(5)
    v_mfma_f32_32x32x16_bf16 v[64:79], a[160:163], v[32:35], v[64:79]
    ds_read_b128 v[56:59], v22 offset:40960
    s_add_u32 m0, s21, 115712
    s_add_u32 s20, s23, 1536
    buffer_load_dwordx4 v7, s[8:11], s20 offen lds
    s_waitcnt lgkmcnt(5)
    v_mfma_f32_32x32x16_bf16 v[64:79], a[164:167], v[36:39], v[64:79]
    ds_read_b128 v[60:63], v23 offset:40960
    s_waitcnt lgkmcnt(5)
    v_mfma_f32_32x32x16_bf16 v[64:79], a[168:171], v[40:43], v[64:79]
    ds_read_b128 v[32:35], v16 offset:49152
    s_waitcnt lgkmcnt(5)
    v_mfma_f32_32x32x16_bf16 v[64:79], a[172:175], v[44:47], v[64:79]
    ds_read_b128 v[36:39], v17 offset:49152
    s_add_u32 m0, s21, 122880
    s_add_u32 s20, s23, 1792
    buffer_load_dwordx4 v6, s[8:11], s20 offen lds
    s_waitcnt lgkmcnt(5)
    v_mfma_f32_32x32x16_bf16 v[64:79], a[176:179], v[48:51], v[64:79]
    ds_read_b128 v[40:43], v18 offset:49152
    s_waitcnt lgkmcnt(5)
    v_mfma_f32_32x32x16_bf16 v[64:79], a[180:183], v[52:55], v[64:79]
    ds_read_b128 v[44:47], v19 offset:49152
    s_waitcnt lgkmcnt(5)
    v_mfma_f32_32x32x16_bf16 v[64:79], a[184:187], v[56:59], v[64:79]
    ds_read_b128 v[48:51], v20 offset:49152
    s_add_u32 m0, s21, 123904
    s_add_u32 s20, s23, 1792
    buffer_load_dwordx4 v7, s[8:11], s20 offen lds
    s_waitcnt lgkmcnt(5)
    v_mfma_f32_32x32x16_bf16 v[64:79], a[188:191], v[60:63], v[64:79]
    ds_read_b128 v[52:55], v21 offset:49152
    s_waitcnt lgkmcnt(5)
    v_mfma_f32_32x32x16_bf16 v[64:79], a[192:195], v[32:35], v[64:79]
    ds_read_b128 v[56:59], v22 offset:49152
    s_waitcnt lgkmcnt(5)
    v_mfma_f32_32x32x16_bf16 v[64:79], a[196:199], v[36:39], v[64:79]
    ds_read_b128 v[60:63], v23 offset:49152
    s_waitcnt lgkmcnt(5)
    v_mfma_f32_32x32x16_bf16 v[64:79], a[200:203], v[40:43], v[64:79]
    ds_read_b128 v[32:35], v16 offset:57344
    s_waitcnt lgkmcnt(5)
    v_mfma_f32_32x32x16_bf16 v[64:79], a[204:207], v[44:47], v[64:79]
    ds_read_b128 v[36:39], v17 offset:57344
    s_waitcnt lgkmcnt(5)
    v_mfma_f32_32x32x16_bf16 v[64:79], a[208:211], v[48:51], v[64:79]
    ds_read_b128 v[40:43], v18 offset:57344
    s_waitcnt lgkmcnt(5)
    v_mfma_f32_32x32x16_bf16 v[64:79], a[212:215], v[52:55], v[64:79]
    ds_read_b128 v[44:47], v19 offset:57344
    s_waitcnt lgkmcnt(5)
    v_mfma_f32_32x32x16_bf16 v[64:79], a[216:219], v[56:59], v[64:79]
    ds_read_b128 v[48:51], v20 offset:57344
    s_waitcnt lgkmcnt(5)
    v_mfma_f32_32x32x16_bf16 v[64:79], a[220:223], v[60:63], v[64:79]
    ds_read_b128 v[52:55], v21 offset:57344
    s_waitcnt vmcnt(8)
    s_barrier
    s_waitcnt lgkmcnt(5)
    v_mfma_f32_32x32x16_bf16 v[64:79], a[224:227], v[32:35], v[64:79]
    ds_read_b128 v[56:59], v22 offset:57344
    s_waitcnt lgkmcnt(5)
    v_mfma_f32_32x32x16_bf16 v[64:79], a[228:231], v[36:39], v[64:79]
    ds_read_b128 v[60:63], v23 offset:57344
    s_add_u32 s23, s23, 131072
    s_add_u32 m0, s21, 0
    s_add_u32 s20, s23, 0
    buffer_load_dwordx4 v6, s[8:11], s20 offen lds
    s_waitcnt lgkmcnt(5)
    v_mfma_f32_32x32x16_bf16 v[64:79], a[232:235], v[40:43], v[64:79]
    ds_read_b128 v[32:35], v24 offset:0
    s_cmp_eq_u32 s25, 0
    s_cbranch_scc1 mega_kernel_q_qk_nf
    v_add_u32 v10, 1, v10
    buffer_store_dword v10, v9, s[84:87], 0 offen sc1
mega_kernel_q_qk_nf:
    s_waitcnt lgkmcnt(5)
    v_mfma_f32_32x32x16_bf16 v[64:79], a[236:239], v[44:47], v[64:79]
    ds_read_b128 v[36:39], v25 offset:0
    s_waitcnt lgkmcnt(5)
    v_mfma_f32_32x32x16_bf16 v[64:79], a[240:243], v[48:51], v[64:79]
    ds_read_b128 v[40:43], v26 offset:0
    s_add_u32 m0, s21, 1024
    s_add_u32 s20, s23, 0
    buffer_load_dwordx4 v7, s[8:11], s20 offen lds
    s_waitcnt lgkmcnt(5)
    v_mfma_f32_32x32x16_bf16 v[64:79], a[244:247], v[52:55], v[64:79]
    ds_read_b128 v[44:47], v27 offset:0
    s_waitcnt lgkmcnt(5)
    v_mfma_f32_32x32x16_bf16 v[64:79], a[248:251], v[56:59], v[64:79]
    ds_read_b128 v[48:51], v28 offset:0
    s_waitcnt lgkmcnt(5)
    v_mfma_f32_32x32x16_bf16 v[64:79], a[252:255], v[60:63], v[64:79]
    ds_read_b128 v[52:55], v29 offset:0
    s_add_u32 m0, s21, 8192
    s_add_u32 s20, s23, 256
    buffer_load_dwordx4 v6, s[8:11], s20 offen lds
    s_waitcnt lgkmcnt(5)
    v_mfma_f32_32x32x16_bf16 v[80:95], a[0:3], v[32:35], 0
    ds_read_b128 v[56:59], v30 offset:0
    s_waitcnt lgkmcnt(5)
    v_mfma_f32_32x32x16_bf16 v[80:95], a[4:7], v[36:39], v[80:95]
    ds_read_b128 v[60:63], v31 offset:0
    s_waitcnt lgkmcnt(5)
    v_mfma_f32_32x32x16_bf16 v[80:95], a[8:11], v[40:43], v[80:95]
    ds_read_b128 v[32:35], v24 offset:8192
    s_add_u32 m0, s21, 9216
    s_add_u32 s20, s23, 256
    buffer_load_dwordx4 v7, s[8:11], s20 offen lds
    s_waitcnt lgkmcnt(5)
    v_mfma_f32_32x32x16_bf16 v[80:95], a[12:15], v[44:47], v[80:95]
    ds_read_b128 v[36:39], v25 offset:8192
    s_waitcnt lgkmcnt(5)
    v_mfma_f32_32x32x16_bf16 v[80:95], a[16:19], v[48:51], v[80:95]
    ds_read_b128 v[40:43], v26 offset:8192
    s_waitcnt lgkmcnt(5)
    v_mfma_f32_32x32x16_bf16 v[80:95], a[20:23], v[52:55], v[80:95]
    ds_read_b128 v[44:47], v27 offset:8192
    s_add_u32 m0, s21, 16384
    s_add_u32 s20, s23, 512
    buffer_load_dwordx4 v6, s[8:11], s20 offen lds
    s_waitcnt lgkmcnt(5)
    v_mfma_f32_32x32x16_bf16 v[80:95], a[24:27], v[56:59], v[80:95]
    ds_read_b128 v[48:51], v28 offset:8192
    s_waitcnt lgkmcnt(5)
    v_mfma_f32_32x32x16_bf16 v[80:95], a[28:31], v[60:63], v[80:95]
    ds_read_b128 v[52:55], v29 offset:8192
    s_waitcnt lgkmcnt(5)
    v_mfma_f32_32x32x16_bf16 v[80:95], a[32:35], v[32:35], v[80:95]
    ds_read_b128 v[56:59], v30 offset:8192
    s_add_u32 m0, s21, 17408
    s_add_u32 s20, s23, 512
    buffer_load_dwordx4 v7, s[8:11], s20 offen lds
    s_waitcnt lgkmcnt(5)
    v_mfma_f32_32x32x16_bf16 v[80:95], a[36:39], v[36:39], v[80:95]
    ds_read_b128 v[60:63], v31 offset:8192
    s_waitcnt lgkmcnt(5)
    v_mfma_f32_32x32x16_bf16 v[80:95], a[40:43], v[40:43], v[80:95]
    ds_read_b128 v[32:35], v24 offset:16384
    s_waitcnt lgkmcnt(5)
    v_mfma_f32_32x32x16_bf16 v[80:95], a[44:47], v[44:47], v[80:95]
    ds_read_b128 v[36:39], v25 offset:16384
    s_add_u32 m0, s21, 24576
    s_add_u32 s20, s23, 768
    buffer_load_dwordx4 v6, s[8:11], s20 offen lds
    s_waitcnt lgkmcnt(5)
    v_mfma_f32_32x32x16_bf16 v[80:95], a[48:51], v[48:51], v[80:95]
    ds_read_b128 v[40:43], v26 offset:16384
    s_waitcnt lgkmcnt(5)
    v_mfma_f32_32x32x16_bf16 v[80:95], a[52:55], v[52:55], v[80:95]
    ds_read_b128 v[44:47], v27 offset:16384
    s_waitcnt lgkmcnt(5)
    v_mfma_f32_32x32x16_bf16 v[80:95], a[56:59], v[56:59], v[80:95]
    ds_read_b128 v[48:51], v28 offset:16384
    s_add_u32 m0, s21, 25600
    s_add_u32 s20, s23, 768
    buffer_load_dwordx4 v7, s[8:11], s20 offen lds
    s_waitcnt lgkmcnt(5)
    v_mfma_f32_32x32x16_bf16 v[80:95], a[60:63], v[60:63], v[80:95]
    ds_read_b128 v[52:55], v29 offset:16384
    s_waitcnt lgkmcnt(5)
    v_mfma_f32_32x32x16_bf16 v[80:95], a[64:67], v[32:35], v[80:95]
    ds_read_b128 v[56:59], v30 offset:16384
    v_cvt_pk_bf16_f32 v96, v64, v65
    v_cvt_pk_bf16_f32 v97, v66, v67
    v_cvt_pk_bf16_f32 v98, v68, v69
    v_cvt_pk_bf16_f32 v99, v70, v71
    buffer_store_dwordx4 v[96:99], v8, s[84:87], s24 offen offset:0 sc1
    s_waitcnt lgkmcnt(5)
    v_mfma_f32_32x32x16_bf16 v[80:95], a[68:71], v[36:39], v[80:95]
    ds_read_b128 v[60:63], v31 offset:16384
    s_waitcnt lgkmcnt(5)
    v_mfma_f32_32x32x16_bf16 v[80:95], a[72:75], v[40:43], v[80:95]
    ds_read_b128 v[32:35], v24 offset:24576
    v_cvt_pk_bf16_f32 v100, v72, v73
    v_cvt_pk_bf16_f32 v101, v74, v75
    v_cvt_pk_bf16_f32 v102, v76, v77
    v_cvt_pk_bf16_f32 v103, v78, v79
    buffer_store_dwordx4 v[100:103], v8, s[84:87], s24 offen offset:512 sc1
    s_add_u32 s24, s24, 524288
    s_waitcnt lgkmcnt(5)
    v_mfma_f32_32x32x16_bf16 v[80:95], a[76:79], v[44:47], v[80:95]
    ds_read_b128 v[36:39], v25 offset:24576
    s_waitcnt lgkmcnt(5)
    v_mfma_f32_32x32x16_bf16 v[80:95], a[80:83], v[48:51], v[80:95]
    ds_read_b128 v[40:43], v26 offset:24576
    s_waitcnt lgkmcnt(5)
    v_mfma_f32_32x32x16_bf16 v[80:95], a[84:87], v[52:55], v[80:95]
    ds_read_b128 v[44:47], v27 offset:24576
    s_waitcnt lgkmcnt(5)
    v_mfma_f32_32x32x16_bf16 v[80:95], a[88:91], v[56:59], v[80:95]
    ds_read_b128 v[48:51], v28 offset:24576
    s_waitcnt lgkmcnt(5)
    v_mfma_f32_32x32x16_bf16 v[80:95], a[92:95], v[60:63], v[80:95]
    ds_read_b128 v[52:55], v29 offset:24576
    s_waitcnt vmcnt(8)
    s_barrier
    s_waitcnt lgkmcnt(5)
    v_mfma_f32_32x32x16_bf16 v[80:95], a[96:99], v[32:35], v[80:95]
    ds_read_b128 v[56:59], v30 offset:24576
    s_waitcnt lgkmcnt(5)
    v_mfma_f32_32x32x16_bf16 v[80:95], a[100:103], v[36:39], v[80:95]
    ds_read_b128 v[60:63], v31 offset:24576
    s_add_u32 m0, s21, 32768
    s_add_u32 s20, s23, 1024
    buffer_load_dwordx4 v6, s[8:11], s20 offen lds
    s_waitcnt lgkmcnt(5)
    v_mfma_f32_32x32x16_bf16 v[80:95], a[104:107], v[40:43], v[80:95]
    ds_read_b128 v[32:35], v24 offset:32768
    s_waitcnt lgkmcnt(5)
    v_mfma_f32_32x32x16_bf16 v[80:95], a[108:111], v[44:47], v[80:95]
    ds_read_b128 v[36:39], v25 offset:32768
    s_waitcnt lgkmcnt(5)
    v_mfma_f32_32x32x16_bf16 v[80:95], a[112:115], v[48:51], v[80:95]
    ds_read_b128 v[40:43], v26 offset:32768
    s_add_u32 m0, s21, 33792
    s_add_u32 s20, s23, 1024
    buffer_load_dwordx4 v7, s[8:11], s20 offen lds
    s_waitcnt lgkmcnt(5)
    v_mfma_f32_32x32x16_bf16 v[80:95], a[116:119], v[52:55], v[80:95]
    ds_read_b128 v[44:47], v27 offset:32768
    s_waitcnt lgkmcnt(5)
    v_mfma_f32_32x32x16_bf16 v[80:95], a[120:123], v[56:59], v[80:95]
    ds_read_b128 v[48:51], v28 offset:32768
    s_waitcnt lgkmcnt(5)
    v_mfma_f32_32x32x16_bf16 v[80:95], a[124:127], v[60:63], v[80:95]
    ds_read_b128 v[52:55], v29 offset:32768
    s_add_u32 m0, s21, 40960
    s_add_u32 s20, s23, 1280
    buffer_load_dwordx4 v6, s[8:11], s20 offen lds
    s_waitcnt lgkmcnt(5)
    v_mfma_f32_32x32x16_bf16 v[80:95], a[128:131], v[32:35], v[80:95]
    ds_read_b128 v[56:59], v30 offset:32768
    s_waitcnt lgkmcnt(5)
    v_mfma_f32_32x32x16_bf16 v[80:95], a[132:135], v[36:39], v[80:95]
    ds_read_b128 v[60:63], v31 offset:32768
    s_waitcnt lgkmcnt(5)
    v_mfma_f32_32x32x16_bf16 v[80:95], a[136:139], v[40:43], v[80:95]
    ds_read_b128 v[32:35], v24 offset:40960
    s_add_u32 m0, s21, 41984
    s_add_u32 s20, s23, 1280
    buffer_load_dwordx4 v7, s[8:11], s20 offen lds
    s_waitcnt lgkmcnt(5)
    v_mfma_f32_32x32x16_bf16 v[80:95], a[140:143], v[44:47], v[80:95]
    ds_read_b128 v[36:39], v25 offset:40960
    s_waitcnt lgkmcnt(5)
    v_mfma_f32_32x32x16_bf16 v[80:95], a[144:147], v[48:51], v[80:95]
    ds_read_b128 v[40:43], v26 offset:40960
    s_waitcnt lgkmcnt(5)
    v_mfma_f32_32x32x16_bf16 v[80:95], a[148:151], v[52:55], v[80:95]
    ds_read_b128 v[44:47], v27 offset:40960
    s_add_u32 m0, s21, 49152
    s_add_u32 s20, s23, 1536
    buffer_load_dwordx4 v6, s[8:11], s20 offen lds
    s_waitcnt lgkmcnt(5)
    v_mfma_f32_32x32x16_bf16 v[80:95], a[152:155], v[56:59], v[80:95]
    ds_read_b128 v[48:51], v28 offset:40960
    s_waitcnt lgkmcnt(5)
    v_mfma_f32_32x32x16_bf16 v[80:95], a[156:159], v[60:63], v[80:95]
    ds_read_b128 v[52:55], v29 offset:40960
    s_waitcnt lgkmcnt(5)
    v_mfma_f32_32x32x16_bf16 v[80:95], a[160:163], v[32:35], v[80:95]
    ds_read_b128 v[56:59], v30 offset:40960
    s_add_u32 m0, s21, 50176
    s_add_u32 s20, s23, 1536
    buffer_load_dwordx4 v7, s[8:11], s20 offen lds
    s_waitcnt lgkmcnt(5)
    v_mfma_f32_32x32x16_bf16 v[80:95], a[164:167], v[36:39], v[80:95]
    ds_read_b128 v[60:63], v31 offset:40960
    s_waitcnt lgkmcnt(5)
    v_mfma_f32_32x32x16_bf16 v[80:95], a[168:171], v[40:43], v[80:95]
    ds_read_b128 v[32:35], v24 offset:49152
    s_waitcnt lgkmcnt(5)
    v_mfma_f32_32x32x16_bf16 v[80:95], a[172:175], v[44:47], v[80:95]
    ds_read_b128 v[36:39], v25 offset:49152
    s_add_u32 m0, s21, 57344
    s_add_u32 s20, s23, 1792
    buffer_load_dwordx4 v6, s[8:11], s20 offen lds
    s_waitcnt lgkmcnt(5)
    v_mfma_f32_32x32x16_bf16 v[80:95], a[176:179], v[48:51], v[80:95]
    ds_read_b128 v[40:43], v26 offset:49152
    s_waitcnt lgkmcnt(5)
    v_mfma_f32_32x32x16_bf16 v[80:95], a[180:183], v[52:55], v[80:95]
    ds_read_b128 v[44:47], v27 offset:49152
    s_waitcnt lgkmcnt(5)
    v_mfma_f32_32x32x16_bf16 v[80:95], a[184:187], v[56:59], v[80:95]
    ds_read_b128 v[48:51], v28 offset:49152
    s_add_u32 m0, s21, 58368
    s_add_u32 s20, s23, 1792
    buffer_load_dwordx4 v7, s[8:11], s20 offen lds
    s_waitcnt lgkmcnt(5)
    v_mfma_f32_32x32x16_bf16 v[80:95], a[188:191], v[60:63], v[80:95]
    ds_read_b128 v[52:55], v29 offset:49152
    s_waitcnt lgkmcnt(5)
    v_mfma_f32_32x32x16_bf16 v[80:95], a[192:195], v[32:35], v[80:95]
    ds_read_b128 v[56:59], v30 offset:49152
    s_waitcnt lgkmcnt(5)
    v_mfma_f32_32x32x16_bf16 v[80:95], a[196:199], v[36:39], v[80:95]
    ds_read_b128 v[60:63], v31 offset:49152
    s_waitcnt lgkmcnt(5)
    v_mfma_f32_32x32x16_bf16 v[80:95], a[200:203], v[40:43], v[80:95]
    ds_read_b128 v[32:35], v24 offset:57344
    s_waitcnt lgkmcnt(5)
    v_mfma_f32_32x32x16_bf16 v[80:95], a[204:207], v[44:47], v[80:95]
    ds_read_b128 v[36:39], v25 offset:57344
    s_waitcnt lgkmcnt(5)
    v_mfma_f32_32x32x16_bf16 v[80:95], a[208:211], v[48:51], v[80:95]
    ds_read_b128 v[40:43], v26 offset:57344
    s_waitcnt lgkmcnt(5)
    v_mfma_f32_32x32x16_bf16 v[80:95], a[212:215], v[52:55], v[80:95]
    ds_read_b128 v[44:47], v27 offset:57344
    s_waitcnt lgkmcnt(5)
    v_mfma_f32_32x32x16_bf16 v[80:95], a[216:219], v[56:59], v[80:95]
    ds_read_b128 v[48:51], v28 offset:57344
    s_waitcnt lgkmcnt(5)
    v_mfma_f32_32x32x16_bf16 v[80:95], a[220:223], v[60:63], v[80:95]
    ds_read_b128 v[52:55], v29 offset:57344
    s_waitcnt vmcnt(8)
    s_barrier
    s_waitcnt lgkmcnt(5)
    v_mfma_f32_32x32x16_bf16 v[80:95], a[224:227], v[32:35], v[80:95]
    ds_read_b128 v[56:59], v30 offset:57344
    s_waitcnt lgkmcnt(5)
    v_mfma_f32_32x32x16_bf16 v[80:95], a[228:231], v[36:39], v[80:95]
    ds_read_b128 v[60:63], v31 offset:57344
    s_add_u32 s23, s23, 131072
    s_add_u32 m0, s21, 65536
    s_add_u32 s20, s23, 0
    buffer_load_dwordx4 v6, s[8:11], s20 offen lds
    s_waitcnt lgkmcnt(5)
    v_mfma_f32_32x32x16_bf16 v[80:95], a[232:235], v[40:43], v[80:95]
    ds_read_b128 v[32:35], v16 offset:0
    v_add_u32 v10, 1, v10
    buffer_store_dword v10, v9, s[84:87], 0 offen sc1
    s_waitcnt lgkmcnt(5)
    v_mfma_f32_32x32x16_bf16 v[80:95], a[236:239], v[44:47], v[80:95]
    ds_read_b128 v[36:39], v17 offset:0
    s_waitcnt lgkmcnt(5)
    v_mfma_f32_32x32x16_bf16 v[80:95], a[240:243], v[48:51], v[80:95]
    ds_read_b128 v[40:43], v18 offset:0
    s_add_u32 m0, s21, 66560
    s_add_u32 s20, s23, 0
    buffer_load_dwordx4 v7, s[8:11], s20 offen lds
    s_waitcnt lgkmcnt(5)
    v_mfma_f32_32x32x16_bf16 v[80:95], a[244:247], v[52:55], v[80:95]
    ds_read_b128 v[44:47], v19 offset:0
    s_waitcnt lgkmcnt(5)
    v_mfma_f32_32x32x16_bf16 v[80:95], a[248:251], v[56:59], v[80:95]
    ds_read_b128 v[48:51], v20 offset:0
    s_waitcnt lgkmcnt(5)
    v_mfma_f32_32x32x16_bf16 v[80:95], a[252:255], v[60:63], v[80:95]
    ds_read_b128 v[52:55], v21 offset:0
    s_add_u32 m0, s21, 73728
    s_add_u32 s20, s23, 256
    buffer_load_dwordx4 v6, s[8:11], s20 offen lds
    s_add_u32 s25, s25, 1
    s_cmp_lt_u32 s25, 16
    s_cbranch_scc1 mega_kernel_q_qk_loop
    s_nop 11
    v_cvt_pk_bf16_f32 v96, v80, v81
    v_cvt_pk_bf16_f32 v97, v82, v83
    v_cvt_pk_bf16_f32 v98, v84, v85
    v_cvt_pk_bf16_f32 v99, v86, v87
    buffer_store_dwordx4 v[96:99], v8, s[84:87], s24 offen offset:0 sc1
    v_cvt_pk_bf16_f32 v100, v88, v89
    v_cvt_pk_bf16_f32 v101, v90, v91
    v_cvt_pk_bf16_f32 v102, v92, v93
    v_cvt_pk_bf16_f32 v103, v94, v95
    buffer_store_dwordx4 v[100:103], v8, s[84:87], s24 offen offset:512 sc1
    s_add_u32 s24, s24, 524288
    s_waitcnt vmcnt(0) lgkmcnt(0)
    s_barrier
    v_add_u32 v10, 1, v10
    buffer_store_dword v10, v9, s[84:87], 0 offen sc1
    s_branch mega_kernel_q_done
mega_kernel_q_v:
    ds_read_b128 v[32:35], v16 offset:0
    ds_read_b128 v[36:39], v17 offset:0
    ds_read_b128 v[40:43], v18 offset:0
    ds_read_b128 v[44:47], v19 offset:0
    ds_read_b128 v[48:51], v20 offset:0
    ds_read_b128 v[52:55], v21 offset:0
    s_mov_b32 s25, 0
mega_kernel_q_v_loop:
    s_waitcnt lgkmcnt(5)
    v_mfma_f32_32x32x16_bf16 v[64:79], v[32:35], a[0:3], 0
    ds_read_b128 v[56:59], v22 offset:0
    s_waitcnt lgkmcnt(5)
    v_mfma_f32_32x32x16_bf16 v[64:79], v[36:39], a[4:7], v[64:79]
    ds_read_b128 v[60:63], v23 offset:0
    s_waitcnt lgkmcnt(5)
    v_mfma_f32_32x32x16_bf16 v[64:79], v[40:43], a[8:11], v[64:79]
    ds_read_b128 v[32:35], v16 offset:8192
    s_cmp_eq_u32 s25, 0
    s_cbranch_scc1 mega_kernel_q_v_sk2
    s_add_u32 m0, s21, 74752
    s_add_u32 s20, s23, 256
    buffer_load_dwordx4 v7, s[8:11], s20 offen lds
mega_kernel_q_v_sk2:
    s_waitcnt lgkmcnt(5)
    v_mfma_f32_32x32x16_bf16 v[64:79], v[44:47], a[12:15], v[64:79]
    ds_read_b128 v[36:39], v17 offset:8192
    s_waitcnt lgkmcnt(5)
    v_mfma_f32_32x32x16_bf16 v[64:79], v[48:51], a[16:19], v[64:79]
    ds_read_b128 v[40:43], v18 offset:8192
    s_waitcnt lgkmcnt(5)
    v_mfma_f32_32x32x16_bf16 v[64:79], v[52:55], a[20:23], v[64:79]
    ds_read_b128 v[44:47], v19 offset:8192
    s_cmp_eq_u32 s25, 0
    s_cbranch_scc1 mega_kernel_q_v_sk5
    s_add_u32 m0, s21, 81920
    s_add_u32 s20, s23, 512
    buffer_load_dwordx4 v6, s[8:11], s20 offen lds
mega_kernel_q_v_sk5:
    s_waitcnt lgkmcnt(5)
    v_mfma_f32_32x32x16_bf16 v[64:79], v[56:59], a[24:27], v[64:79]
    ds_read_b128 v[48:51], v20 offset:8192
    s_waitcnt lgkmcnt(5)
    v_mfma_f32_32x32x16_bf16 v[64:79], v[60:63], a[28:31], v[64:79]
    ds_read_b128 v[52:55], v21 offset:8192
    s_waitcnt lgkmcnt(5)
    v_mfma_f32_32x32x16_bf16 v[64:79], v[32:35], a[32:35], v[64:79]
    ds_read_b128 v[56:59], v22 offset:8192
    s_cmp_eq_u32 s25, 0
    s_cbranch_scc1 mega_kernel_q_v_sk8
    s_add_u32 m0, s21, 82944
    s_add_u32 s20, s23, 512
    buffer_load_dwordx4 v7, s[8:11], s20 offen lds
mega_kernel_q_v_sk8:
    s_waitcnt lgkmcnt(5)
    v_mfma_f32_32x32x16_bf16 v[64:79], v[36:39], a[36:39], v[64:79]
    ds_read_b128 v[60:63], v23 offset:8192
    s_waitcnt lgkmcnt(5)
    v_mfma_f32_32x32x16_bf16 v[64:79], v[40:43], a[40:43], v[64:79]
    ds_read_b128 v[32:35], v16 offset:16384
    s_waitcnt lgkmcnt(5)
    v_mfma_f32_32x32x16_bf16 v[64:79], v[44:47], a[44:47], v[64:79]
    ds_read_b128 v[36:39], v17 offset:16384
    s_cmp_eq_u32 s25, 0
    s_cbranch_scc1 mega_kernel_q_v_sk11
    s_add_u32 m0, s21, 90112
    s_add_u32 s20, s23, 768
    buffer_load_dwordx4 v6, s[8:11], s20 offen lds
mega_kernel_q_v_sk11:
    s_waitcnt lgkmcnt(5)
    v_mfma_f32_32x32x16_bf16 v[64:79], v[48:51], a[48:51], v[64:79]
    ds_read_b128 v[40:43], v18 offset:16384
    s_waitcnt lgkmcnt(5)
    v_mfma_f32_32x32x16_bf16 v[64:79], v[52:55], a[52:55], v[64:79]
    ds_read_b128 v[44:47], v19 offset:16384
    s_waitcnt lgkmcnt(5)
    v_mfma_f32_32x32x16_bf16 v[64:79], v[56:59], a[56:59], v[64:79]
    ds_read_b128 v[48:51], v20 offset:16384
    s_cmp_eq_u32 s25, 0
    s_cbranch_scc1 mega_kernel_q_v_sk14
    s_add_u32 m0, s21, 91136
    s_add_u32 s20, s23, 768
    buffer_load_dwordx4 v7, s[8:11], s20 offen lds
mega_kernel_q_v_sk14:
    s_waitcnt lgkmcnt(5)
    v_mfma_f32_32x32x16_bf16 v[64:79], v[60:63], a[60:63], v[64:79]
    ds_read_b128 v[52:55], v21 offset:16384
    s_waitcnt lgkmcnt(5)
    v_mfma_f32_32x32x16_bf16 v[64:79], v[32:35], a[64:67], v[64:79]
    ds_read_b128 v[56:59], v22 offset:16384
    s_cmp_eq_u32 s25, 0
    s_cbranch_scc1 mega_kernel_q_v_ne0
    v_cvt_pk_bf16_f32 v96, v80, v81
    v_cvt_pk_bf16_f32 v97, v82, v83
    v_cvt_pk_bf16_f32 v98, v88, v89
    v_cvt_pk_bf16_f32 v99, v90, v91
    buffer_store_dwordx4 v[96:99], v8, s[84:87], s24 offen offset:0 sc1
mega_kernel_q_v_ne0:
    s_waitcnt lgkmcnt(5)
    v_mfma_f32_32x32x16_bf16 v[64:79], v[36:39], a[68:71], v[64:79]
    ds_read_b128 v[60:63], v23 offset:16384
    s_waitcnt lgkmcnt(5)
    v_mfma_f32_32x32x16_bf16 v[64:79], v[40:43], a[72:75], v[64:79]
    ds_read_b128 v[32:35], v16 offset:24576
    s_cmp_eq_u32 s25, 0
    s_cbranch_scc1 mega_kernel_q_v_ne1
    v_cvt_pk_bf16_f32 v100, v84, v85
    v_cvt_pk_bf16_f32 v101, v86, v87
    v_cvt_pk_bf16_f32 v102, v92, v93
    v_cvt_pk_bf16_f32 v103, v94, v95
    buffer_store_dwordx4 v[100:103], v8, s[84:87], s24 offen offset:512 sc1
    s_add_u32 s24, s24, 524288
mega_kernel_q_v_ne1:
    s_waitcnt lgkmcnt(5)
    v_mfma_f32_32x32x16_bf16 v[64:79], v[44:47], a[76:79], v[64:79]
    ds_read_b128 v[36:39], v17 offset:24576
    s_waitcnt lgkmcnt(5)
    v_mfma_f32_32x32x16_bf16 v[64:79], v[48:51], a[80:83], v[64:79]
    ds_read_b128 v[40:43], v18 offset:24576
    s_waitcnt lgkmcnt(5)
    v_mfma_f32_32x32x16_bf16 v[64:79], v[52:55], a[84:87], v[64:79]
    ds_read_b128 v[44:47], v19 offset:24576
    s_waitcnt lgkmcnt(5)
    v_mfma_f32_32x32x16_bf16 v[64:79], v[56:59], a[88:91], v[64:79]
    ds_read_b128 v[48:51], v20 offset:24576
    s_waitcnt lgkmcnt(5)
    v_mfma_f32_32x32x16_bf16 v[64:79], v[60:63], a[92:95], v[64:79]
    ds_read_b128 v[52:55], v21 offset:24576
    s_waitcnt vmcnt(8)
    s_barrier
    s_waitcnt lgkmcnt(5)
    v_mfma_f32_32x32x16_bf16 v[64:79], v[32:35], a[96:99], v[64:79]
    ds_read_b128 v[56:59], v22 offset:24576
    s_waitcnt lgkmcnt(5)
    v_mfma_f32_32x32x16_bf16 v[64:79], v[36:39], a[100:103], v[64:79]
    ds_read_b128 v[60:63], v23 offset:24576
    s_add_u32 m0, s21, 98304
    s_add_u32 s20, s23, 1024
    buffer_load_dwordx4 v6, s[8:11], s20 offen lds
    s_waitcnt lgkmcnt(5)
    v_mfma_f32_32x32x16_bf16 v[64:79], v[40:43], a[104:107], v[64:79]
    ds_read_b128 v[32:35], v16 offset:32768
    s_waitcnt lgkmcnt(5)
    v_mfma_f32_32x32x16_bf16 v[64:79], v[44:47], a[108:111], v[64:79]
    ds_read_b128 v[36:39], v17 offset:32768
    s_waitcnt lgkmcnt(5)
    v_mfma_f32_32x32x16_bf16 v[64:79], v[48:51], a[112:115], v[64:79]
    ds_read_b128 v[40:43], v18 offset:32768
    s_add_u32 m0, s21, 99328
    s_add_u32 s20, s23, 1024
    buffer_load_dwordx4 v7, s[8:11], s20 offen lds
    s_waitcnt lgkmcnt(5)
    v_mfma_f32_32x32x16_bf16 v[64:79], v[52:55], a[116:119], v[64:79]
    ds_read_b128 v[44:47], v19 offset:32768
    s_waitcnt lgkmcnt(5)
    v_mfma_f32_32x32x16_bf16 v[64:79], v[56:59], a[120:123], v[64:79]
    ds_read_b128 v[48:51], v20 offset:32768
    s_waitcnt lgkmcnt(5)
    v_mfma_f32_32x32x16_bf16 v[64:79], v[60:63], a[124:127], v[64:79]
    ds_read_b128 v[52:55], v21 offset:32768
    s_add_u32 m0, s21, 106496
    s_add_u32 s20, s23, 1280
    buffer_load_dwordx4 v6, s[8:11], s20 offen lds
    s_waitcnt lgkmcnt(5)
    v_mfma_f32_32x32x16_bf16 v[64:79], v[32:35], a[128:131], v[64:79]
    ds_read_b128 v[56:59], v22 offset:32768
    s_waitcnt lgkmcnt(5)
    v_mfma_f32_32x32x16_bf16 v[64:79], v[36:39], a[132:135], v[64:79]
    ds_read_b128 v[60:63], v23 offset:32768
    s_waitcnt lgkmcnt(5)
    v_mfma_f32_32x32x16_bf16 v[64:79], v[40:43], a[136:139], v[64:79]
    ds_read_b128 v[32:35], v16 offset:40960
    s_add_u32 m0, s21, 107520
    s_add_u32 s20, s23, 1280
    buffer_load_dwordx4 v7, s[8:11], s20 offen lds
    s_waitcnt lgkmcnt(5)
    v_mfma_f32_32x32x16_bf16 v[64:79], v[44:47], a[140:143], v[64:79]
    ds_read_b128 v[36:39], v17 offset:40960
    s_waitcnt lgkmcnt(5)
    v_mfma_f32_32x32x16_bf16 v[64:79], v[48:51], a[144:147], v[64:79]
    ds_read_b128 v[40:43], v18 offset:40960
    s_waitcnt lgkmcnt(5)
    v_mfma_f32_32x32x16_bf16 v[64:79], v[52:55], a[148:151], v[64:79]
    ds_read_b128 v[44:47], v19 offset:40960
    s_add_u32 m0, s21, 114688
    s_add_u32 s20, s23, 1536
    buffer_load_dwordx4 v6, s[8:11], s20 offen lds
    s_waitcnt lgkmcnt(5)
    v_mfma_f32_32x32x16_bf16 v[64:79], v[56:59], a[152:155], v[64:79]
    ds_read_b128 v[48:51], v20 offset:40960
    s_waitcnt lgkmcnt(5)
    v_mfma_f32_32x32x16_bf16 v[64:79], v[60:63], a[156:159], v[64:79]
    ds_read_b128 v[52:55], v21 offset:40960
    s_waitcnt lgkmcnt(5)
    v_mfma_f32_32x32x16_bf16 v[64:79], v[32:35], a[160:163], v[64:79]
    ds_read_b128 v[56:59], v22 offset:40960
    s_add_u32 m0, s21, 115712
    s_add_u32 s20, s23, 1536
    buffer_load_dwordx4 v7, s[8:11], s20 offen lds
    s_waitcnt lgkmcnt(5)
    v_mfma_f32_32x32x16_bf16 v[64:79], v[36:39], a[164:167], v[64:79]
    ds_read_b128 v[60:63], v23 offset:40960
    s_waitcnt lgkmcnt(5)
    v_mfma_f32_32x32x16_bf16 v[64:79], v[40:43], a[168:171], v[64:79]
    ds_read_b128 v[32:35], v16 offset:49152
    s_waitcnt lgkmcnt(5)
    v_mfma_f32_32x32x16_bf16 v[64:79], v[44:47], a[172:175], v[64:79]
    ds_read_b128 v[36:39], v17 offset:49152
    s_add_u32 m0, s21, 122880
    s_add_u32 s20, s23, 1792
    buffer_load_dwordx4 v6, s[8:11], s20 offen lds
    s_waitcnt lgkmcnt(5)
    v_mfma_f32_32x32x16_bf16 v[64:79], v[48:51], a[176:179], v[64:79]
    ds_read_b128 v[40:43], v18 offset:49152
    s_waitcnt lgkmcnt(5)
    v_mfma_f32_32x32x16_bf16 v[64:79], v[52:55], a[180:183], v[64:79]
    ds_read_b128 v[44:47], v19 offset:49152
    s_waitcnt lgkmcnt(5)
    v_mfma_f32_32x32x16_bf16 v[64:79], v[56:59], a[184:187], v[64:79]
    ds_read_b128 v[48:51], v20 offset:49152
    s_add_u32 m0, s21, 123904
    s_add_u32 s20, s23, 1792
    buffer_load_dwordx4 v7, s[8:11], s20 offen lds
    s_waitcnt lgkmcnt(5)
    v_mfma_f32_32x32x16_bf16 v[64:79], v[60:63], a[188:191], v[64:79]
    ds_read_b128 v[52:55], v21 offset:49152
    s_waitcnt lgkmcnt(5)
    v_mfma_f32_32x32x16_bf16 v[64:79], v[32:35], a[192:195], v[64:79]
    ds_read_b128 v[56:59], v22 offset:49152
    s_waitcnt lgkmcnt(5)
    v_mfma_f32_32x32x16_bf16 v[64:79], v[36:39], a[196:199], v[64:79]
    ds_read_b128 v[60:63], v23 offset:49152
    s_waitcnt lgkmcnt(5)
    v_mfma_f32_32x32x16_bf16 v[64:79], v[40:43], a[200:203], v[64:79]
    ds_read_b128 v[32:35], v16 offset:57344
    s_waitcnt lgkmcnt(5)
    v_mfma_f32_32x32x16_bf16 v[64:79], v[44:47], a[204:207], v[64:79]
    ds_read_b128 v[36:39], v17 offset:57344
    s_waitcnt lgkmcnt(5)
    v_mfma_f32_32x32x16_bf16 v[64:79], v[48:51], a[208:211], v[64:79]
    ds_read_b128 v[40:43], v18 offset:57344
    s_waitcnt lgkmcnt(5)
    v_mfma_f32_32x32x16_bf16 v[64:79], v[52:55], a[212:215], v[64:79]
    ds_read_b128 v[44:47], v19 offset:57344
    s_waitcnt lgkmcnt(5)
    v_mfma_f32_32x32x16_bf16 v[64:79], v[56:59], a[216:219], v[64:79]
    ds_read_b128 v[48:51], v20 offset:57344
    s_waitcnt lgkmcnt(5)
    v_mfma_f32_32x32x16_bf16 v[64:79], v[60:63], a[220:223], v[64:79]
    ds_read_b128 v[52:55], v21 offset:57344
    s_waitcnt vmcnt(8)
    s_barrier
    s_waitcnt lgkmcnt(5)
    v_mfma_f32_32x32x16_bf16 v[64:79], v[32:35], a[224:227], v[64:79]
    ds_read_b128 v[56:59], v22 offset:57344
    s_waitcnt lgkmcnt(5)
    v_mfma_f32_32x32x16_bf16 v[64:79], v[36:39], a[228:231], v[64:79]
    ds_read_b128 v[60:63], v23 offset:57344
    s_add_u32 s23, s23, 131072
    s_add_u32 m0, s21, 0
    s_add_u32 s20, s23, 0
    buffer_load_dwordx4 v6, s[8:11], s20 offen lds
    s_waitcnt lgkmcnt(5)
    v_mfma_f32_32x32x16_bf16 v[64:79], v[40:43], a[232:235], v[64:79]
    ds_read_b128 v[32:35], v24 offset:0
    s_cmp_eq_u32 s25, 0
    s_cbranch_scc1 mega_kernel_q_v_nf
    v_add_u32 v10, 1, v10
    buffer_store_dword v10, v9, s[84:87], 0 offen sc1
mega_kernel_q_v_nf:
    s_waitcnt lgkmcnt(5)
    v_mfma_f32_32x32x16_bf16 v[64:79], v[44:47], a[236:239], v[64:79]
    ds_read_b128 v[36:39], v25 offset:0
    s_waitcnt lgkmcnt(5)
    v_mfma_f32_32x32x16_bf16 v[64:79], v[48:51], a[240:243], v[64:79]
    ds_read_b128 v[40:43], v26 offset:0
    s_add_u32 m0, s21, 1024
    s_add_u32 s20, s23, 0
    buffer_load_dwordx4 v7, s[8:11], s20 offen lds
    s_waitcnt lgkmcnt(5)
    v_mfma_f32_32x32x16_bf16 v[64:79], v[52:55], a[244:247], v[64:79]
    ds_read_b128 v[44:47], v27 offset:0
    s_waitcnt lgkmcnt(5)
    v_mfma_f32_32x32x16_bf16 v[64:79], v[56:59], a[248:251], v[64:79]
    ds_read_b128 v[48:51], v28 offset:0
    s_waitcnt lgkmcnt(5)
    v_mfma_f32_32x32x16_bf16 v[64:79], v[60:63], a[252:255], v[64:79]
    ds_read_b128 v[52:55], v29 offset:0
    s_add_u32 m0, s21, 8192
    s_add_u32 s20, s23, 256
    buffer_load_dwordx4 v6, s[8:11], s20 offen lds
    s_waitcnt lgkmcnt(5)
    v_mfma_f32_32x32x16_bf16 v[80:95], v[32:35], a[0:3], 0
    ds_read_b128 v[56:59], v30 offset:0
    s_waitcnt lgkmcnt(5)
    v_mfma_f32_32x32x16_bf16 v[80:95], v[36:39], a[4:7], v[80:95]
    ds_read_b128 v[60:63], v31 offset:0
    s_waitcnt lgkmcnt(5)
    v_mfma_f32_32x32x16_bf16 v[80:95], v[40:43], a[8:11], v[80:95]
    ds_read_b128 v[32:35], v24 offset:8192
    s_add_u32 m0, s21, 9216
    s_add_u32 s20, s23, 256
    buffer_load_dwordx4 v7, s[8:11], s20 offen lds
    s_waitcnt lgkmcnt(5)
    v_mfma_f32_32x32x16_bf16 v[80:95], v[44:47], a[12:15], v[80:95]
    ds_read_b128 v[36:39], v25 offset:8192
    s_waitcnt lgkmcnt(5)
    v_mfma_f32_32x32x16_bf16 v[80:95], v[48:51], a[16:19], v[80:95]
    ds_read_b128 v[40:43], v26 offset:8192
    s_waitcnt lgkmcnt(5)
    v_mfma_f32_32x32x16_bf16 v[80:95], v[52:55], a[20:23], v[80:95]
    ds_read_b128 v[44:47], v27 offset:8192
    s_add_u32 m0, s21, 16384
    s_add_u32 s20, s23, 512
    buffer_load_dwordx4 v6, s[8:11], s20 offen lds
    s_waitcnt lgkmcnt(5)
    v_mfma_f32_32x32x16_bf16 v[80:95], v[56:59], a[24:27], v[80:95]
    ds_read_b128 v[48:51], v28 offset:8192
    s_waitcnt lgkmcnt(5)
    v_mfma_f32_32x32x16_bf16 v[80:95], v[60:63], a[28:31], v[80:95]
    ds_read_b128 v[52:55], v29 offset:8192
    s_waitcnt lgkmcnt(5)
    v_mfma_f32_32x32x16_bf16 v[80:95], v[32:35], a[32:35], v[80:95]
    ds_read_b128 v[56:59], v30 offset:8192
    s_add_u32 m0, s21, 17408
    s_add_u32 s20, s23, 512
    buffer_load_dwordx4 v7, s[8:11], s20 offen lds
    s_waitcnt lgkmcnt(5)
    v_mfma_f32_32x32x16_bf16 v[80:95], v[36:39], a[36:39], v[80:95]
    ds_read_b128 v[60:63], v31 offset:8192
    s_waitcnt lgkmcnt(5)
    v_mfma_f32_32x32x16_bf16 v[80:95], v[40:43], a[40:43], v[80:95]
    ds_read_b128 v[32:35], v24 offset:16384
    s_waitcnt lgkmcnt(5)
    v_mfma_f32_32x32x16_bf16 v[80:95], v[44:47], a[44:47], v[80:95]
    ds_read_b128 v[36:39], v25 offset:16384
    s_add_u32 m0, s21, 24576
    s_add_u32 s20, s23, 768
    buffer_load_dwordx4 v6, s[8:11], s20 offen lds
    s_waitcnt lgkmcnt(5)
    v_mfma_f32_32x32x16_bf16 v[80:95], v[48:51], a[48:51], v[80:95]
    ds_read_b128 v[40:43], v26 offset:16384
    s_waitcnt lgkmcnt(5)
    v_mfma_f32_32x32x16_bf16 v[80:95], v[52:55], a[52:55], v[80:95]
    ds_read_b128 v[44:47], v27 offset:16384
    s_waitcnt lgkmcnt(5)
    v_mfma_f32_32x32x16_bf16 v[80:95], v[56:59], a[56:59], v[80:95]
    ds_read_b128 v[48:51], v28 offset:16384
    s_add_u32 m0, s21, 25600
    s_add_u32 s20, s23, 768
    buffer_load_dwordx4 v7, s[8:11], s20 offen lds
    s_waitcnt lgkmcnt(5)
    v_mfma_f32_32x32x16_bf16 v[80:95], v[60:63], a[60:63], v[80:95]
    ds_read_b128 v[52:55], v29 offset:16384
    s_waitcnt lgkmcnt(5)
    v_mfma_f32_32x32x16_bf16 v[80:95], v[32:35], a[64:67], v[80:95]
    ds_read_b128 v[56:59], v30 offset:16384
    v_cvt_pk_bf16_f32 v96, v64, v65
    v_cvt_pk_bf16_f32 v97, v66, v67
    v_cvt_pk_bf16_f32 v98, v72, v73
    v_cvt_pk_bf16_f32 v99, v74, v75
    buffer_store_dwordx4 v[96:99], v8, s[84:87], s24 offen offset:0 sc1
    s_waitcnt lgkmcnt(5)
    v_mfma_f32_32x32x16_bf16 v[80:95], v[36:39], a[68:71], v[80:95]
    ds_read_b128 v[60:63], v31 offset:16384
    s_waitcnt lgkmcnt(5)
    v_mfma_f32_32x32x16_bf16 v[80:95], v[40:43], a[72:75], v[80:95]
    ds_read_b128 v[32:35], v24 offset:24576
    v_cvt_pk_bf16_f32 v100, v68, v69
    v_cvt_pk_bf16_f32 v101, v70, v71
    v_cvt_pk_bf16_f32 v102, v76, v77
    v_cvt_pk_bf16_f32 v103, v78, v79
    buffer_store_dwordx4 v[100:103], v8, s[84:87], s24 offen offset:512 sc1
    s_add_u32 s24, s24, 524288
    s_waitcnt lgkmcnt(5)
    v_mfma_f32_32x32x16_bf16 v[80:95], v[44:47], a[76:79], v[80:95]
    ds_read_b128 v[36:39], v25 offset:24576
    s_waitcnt lgkmcnt(5)
    v_mfma_f32_32x32x16_bf16 v[80:95], v[48:51], a[80:83], v[80:95]
    ds_read_b128 v[40:43], v26 offset:24576
    s_waitcnt lgkmcnt(5)
    v_mfma_f32_32x32x16_bf16 v[80:95], v[52:55], a[84:87], v[80:95]
    ds_read_b128 v[44:47], v27 offset:24576
    s_waitcnt lgkmcnt(5)
    v_mfma_f32_32x32x16_bf16 v[80:95], v[56:59], a[88:91], v[80:95]
    ds_read_b128 v[48:51], v28 offset:24576
    s_waitcnt lgkmcnt(5)
    v_mfma_f32_32x32x16_bf16 v[80:95], v[60:63], a[92:95], v[80:95]
    ds_read_b128 v[52:55], v29 offset:24576
    s_waitcnt vmcnt(8)
    s_barrier
    s_waitcnt lgkmcnt(5)
    v_mfma_f32_32x32x16_bf16 v[80:95], v[32:35], a[96:99], v[80:95]
    ds_read_b128 v[56:59], v30 offset:24576
    s_waitcnt lgkmcnt(5)
    v_mfma_f32_32x32x16_bf16 v[80:95], v[36:39], a[100:103], v[80:95]
    ds_read_b128 v[60:63], v31 offset:24576
    s_add_u32 m0, s21, 32768
    s_add_u32 s20, s23, 1024
    buffer_load_dwordx4 v6, s[8:11], s20 offen lds
    s_waitcnt lgkmcnt(5)
    v_mfma_f32_32x32x16_bf16 v[80:95], v[40:43], a[104:107], v[80:95]
    ds_read_b128 v[32:35], v24 offset:32768
    s_waitcnt lgkmcnt(5)
    v_mfma_f32_32x32x16_bf16 v[80:95], v[44:47], a[108:111], v[80:95]
    ds_read_b128 v[36:39], v25 offset:32768
    s_waitcnt lgkmcnt(5)
    v_mfma_f32_32x32x16_bf16 v[80:95], v[48:51], a[112:115], v[80:95]
    ds_read_b128 v[40:43], v26 offset:32768
    s_add_u32 m0, s21, 33792
    s_add_u32 s20, s23, 1024
    buffer_load_dwordx4 v7, s[8:11], s20 offen lds
    s_waitcnt lgkmcnt(5)
    v_mfma_f32_32x32x16_bf16 v[80:95], v[52:55], a[116:119], v[80:95]
    ds_read_b128 v[44:47], v27 offset:32768
    s_waitcnt lgkmcnt(5)
    v_mfma_f32_32x32x16_bf16 v[80:95], v[56:59], a[120:123], v[80:95]
    ds_read_b128 v[48:51], v28 offset:32768
    s_waitcnt lgkmcnt(5)
    v_mfma_f32_32x32x16_bf16 v[80:95], v[60:63], a[124:127], v[80:95]
    ds_read_b128 v[52:55], v29 offset:32768
    s_add_u32 m0, s21, 40960
    s_add_u32 s20, s23, 1280
    buffer_load_dwordx4 v6, s[8:11], s20 offen lds
    s_waitcnt lgkmcnt(5)
    v_mfma_f32_32x32x16_bf16 v[80:95], v[32:35], a[128:131], v[80:95]
    ds_read_b128 v[56:59], v30 offset:32768
    s_waitcnt lgkmcnt(5)
    v_mfma_f32_32x32x16_bf16 v[80:95], v[36:39], a[132:135], v[80:95]
    ds_read_b128 v[60:63], v31 offset:32768
    s_waitcnt lgkmcnt(5)
    v_mfma_f32_32x32x16_bf16 v[80:95], v[40:43], a[136:139], v[80:95]
    ds_read_b128 v[32:35], v24 offset:40960
    s_add_u32 m0, s21, 41984
    s_add_u32 s20, s23, 1280
    buffer_load_dwordx4 v7, s[8:11], s20 offen lds
    s_waitcnt lgkmcnt(5)
    v_mfma_f32_32x32x16_bf16 v[80:95], v[44:47], a[140:143], v[80:95]
    ds_read_b128 v[36:39], v25 offset:40960
    s_waitcnt lgkmcnt(5)
    v_mfma_f32_32x32x16_bf16 v[80:95], v[48:51], a[144:147], v[80:95]
    ds_read_b128 v[40:43], v26 offset:40960
    s_waitcnt lgkmcnt(5)
    v_mfma_f32_32x32x16_bf16 v[80:95], v[52:55], a[148:151], v[80:95]
    ds_read_b128 v[44:47], v27 offset:40960
    s_add_u32 m0, s21, 49152
    s_add_u32 s20, s23, 1536
    buffer_load_dwordx4 v6, s[8:11], s20 offen lds
    s_waitcnt lgkmcnt(5)
    v_mfma_f32_32x32x16_bf16 v[80:95], v[56:59], a[152:155], v[80:95]
    ds_read_b128 v[48:51], v28 offset:40960
    s_waitcnt lgkmcnt(5)
    v_mfma_f32_32x32x16_bf16 v[80:95], v[60:63], a[156:159], v[80:95]
    ds_read_b128 v[52:55], v29 offset:40960
    s_waitcnt lgkmcnt(5)
    v_mfma_f32_32x32x16_bf16 v[80:95], v[32:35], a[160:163], v[80:95]
    ds_read_b128 v[56:59], v30 offset:40960
    s_add_u32 m0, s21, 50176
    s_add_u32 s20, s23, 1536
    buffer_load_dwordx4 v7, s[8:11], s20 offen lds
    s_waitcnt lgkmcnt(5)
    v_mfma_f32_32x32x16_bf16 v[80:95], v[36:39], a[164:167], v[80:95]
    ds_read_b128 v[60:63], v31 offset:40960
    s_waitcnt lgkmcnt(5)
    v_mfma_f32_32x32x16_bf16 v[80:95], v[40:43], a[168:171], v[80:95]
    ds_read_b128 v[32:35], v24 offset:49152
    s_waitcnt lgkmcnt(5)
    v_mfma_f32_32x32x16_bf16 v[80:95], v[44:47], a[172:175], v[80:95]
    ds_read_b128 v[36:39], v25 offset:49152
    s_add_u32 m0, s21, 57344
    s_add_u32 s20, s23, 1792
    buffer_load_dwordx4 v6, s[8:11], s20 offen lds
    s_waitcnt lgkmcnt(5)
    v_mfma_f32_32x32x16_bf16 v[80:95], v[48:51], a[176:179], v[80:95]
    ds_read_b128 v[40:43], v26 offset:49152
    s_waitcnt lgkmcnt(5)
    v_mfma_f32_32x32x16_bf16 v[80:95], v[52:55], a[180:183], v[80:95]
    ds_read_b128 v[44:47], v27 offset:49152
    s_waitcnt lgkmcnt(5)
    v_mfma_f32_32x32x16_bf16 v[80:95], v[56:59], a[184:187], v[80:95]
    ds_read_b128 v[48:51], v28 offset:49152
    s_add_u32 m0, s21, 58368
    s_add_u32 s20, s23, 1792
    buffer_load_dwordx4 v7, s[8:11], s20 offen lds
    s_waitcnt lgkmcnt(5)
    v_mfma_f32_32x32x16_bf16 v[80:95], v[60:63], a[188:191], v[80:95]
    ds_read_b128 v[52:55], v29 offset:49152
    s_waitcnt lgkmcnt(5)
    v_mfma_f32_32x32x16_bf16 v[80:95], v[32:35], a[192:195], v[80:95]
    ds_read_b128 v[56:59], v30 offset:49152
    s_waitcnt lgkmcnt(5)
    v_mfma_f32_32x32x16_bf16 v[80:95], v[36:39], a[196:199], v[80:95]
    ds_read_b128 v[60:63], v31 offset:49152
    s_waitcnt lgkmcnt(5)
    v_mfma_f32_32x32x16_bf16 v[80:95], v[40:43], a[200:203], v[80:95]
    ds_read_b128 v[32:35], v24 offset:57344
    s_waitcnt lgkmcnt(5)
    v_mfma_f32_32x32x16_bf16 v[80:95], v[44:47], a[204:207], v[80:95]
    ds_read_b128 v[36:39], v25 offset:57344
    s_waitcnt lgkmcnt(5)
    v_mfma_f32_32x32x16_bf16 v[80:95], v[48:51], a[208:211], v[80:95]
    ds_read_b128 v[40:43], v26 offset:57344
    s_waitcnt lgkmcnt(5)
    v_mfma_f32_32x32x16_bf16 v[80:95], v[52:55], a[212:215], v[80:95]
    ds_read_b128 v[44:47], v27 offset:57344
    s_waitcnt lgkmcnt(5)
    v_mfma_f32_32x32x16_bf16 v[80:95], v[56:59], a[216:219], v[80:95]
    ds_read_b128 v[48:51], v28 offset:57344
    s_waitcnt lgkmcnt(5)
    v_mfma_f32_32x32x16_bf16 v[80:95], v[60:63], a[220:223], v[80:95]
    ds_read_b128 v[52:55], v29 offset:57344
    s_waitcnt vmcnt(8)
    s_barrier
    s_waitcnt lgkmcnt(5)
    v_mfma_f32_32x32x16_bf16 v[80:95], v[32:35], a[224:227], v[80:95]
    ds_read_b128 v[56:59], v30 offset:57344
    s_waitcnt lgkmcnt(5)
    v_mfma_f32_32x32x16_bf16 v[80:95], v[36:39], a[228:231], v[80:95]
    ds_read_b128 v[60:63], v31 offset:57344
    s_add_u32 s23, s23, 131072
    s_add_u32 m0, s21, 65536
    s_add_u32 s20, s23, 0
    buffer_load_dwordx4 v6, s[8:11], s20 offen lds
    s_waitcnt lgkmcnt(5)
    v_mfma_f32_32x32x16_bf16 v[80:95], v[40:43], a[232:235], v[80:95]
    ds_read_b128 v[32:35], v16 offset:0
    v_add_u32 v10, 1, v10
    buffer_store_dword v10, v9, s[84:87], 0 offen sc1
    s_waitcnt lgkmcnt(5)
    v_mfma_f32_32x32x16_bf16 v[80:95], v[44:47], a[236:239], v[80:95]
    ds_read_b128 v[36:39], v17 offset:0
    s_waitcnt lgkmcnt(5)
    v_mfma_f32_32x32x16_bf16 v[80:95], v[48:51], a[240:243], v[80:95]
    ds_read_b128 v[40:43], v18 offset:0
    s_add_u32 m0, s21, 66560
    s_add_u32 s20, s23, 0
    buffer_load_dwordx4 v7, s[8:11], s20 offen lds
    s_waitcnt lgkmcnt(5)
    v_mfma_f32_32x32x16_bf16 v[80:95], v[52:55], a[244:247], v[80:95]
    ds_read_b128 v[44:47], v19 offset:0
    s_waitcnt lgkmcnt(5)
    v_mfma_f32_32x32x16_bf16 v[80:95], v[56:59], a[248:251], v[80:95]
    ds_read_b128 v[48:51], v20 offset:0
    s_waitcnt lgkmcnt(5)
    v_mfma_f32_32x32x16_bf16 v[80:95], v[60:63], a[252:255], v[80:95]
    ds_read_b128 v[52:55], v21 offset:0
    s_add_u32 m0, s21, 73728
    s_add_u32 s20, s23, 256
    buffer_load_dwordx4 v6, s[8:11], s20 offen lds
    s_add_u32 s25, s25, 1
    s_cmp_lt_u32 s25, 16
    s_cbranch_scc1 mega_kernel_q_v_loop
    s_nop 11
    v_cvt_pk_bf16_f32 v96, v80, v81
    v_cvt_pk_bf16_f32 v97, v82, v83
    v_cvt_pk_bf16_f32 v98, v88, v89
    v_cvt_pk_bf16_f32 v99, v90, v91
    buffer_store_dwordx4 v[96:99], v8, s[84:87], s24 offen offset:0 sc1
    v_cvt_pk_bf16_f32 v100, v84, v85
    v_cvt_pk_bf16_f32 v101, v86, v87
    v_cvt_pk_bf16_f32 v102, v92, v93
    v_cvt_pk_bf16_f32 v103, v94, v95
    buffer_store_dwordx4 v[100:103], v8, s[84:87], s24 offen offset:512 sc1
    s_add_u32 s24, s24, 524288
    s_waitcnt vmcnt(0) lgkmcnt(0)
    s_barrier
    v_add_u32 v10, 1, v10
    buffer_store_dword v10, v9, s[84:87], 0 offen sc1
mega_kernel_q_done:
    s_cmp_lt_u32 s92, 128
    s_cbranch_scc1 mega_kernel_f1
    s_sub_u32 s99, s92, 128
mega_kernel_f0l:
    s_barrier
    s_load_dwordx2 s[4:5], s[0:1], 64
    s_load_dwordx2 s[8:9], s[0:1], 72
    s_load_dwordx2 s[12:13], s[0:1], 96
    s_and_b32 s16, s99, 31
    s_lshr_b32 s17, s99, 5
    v_and_b32 v1, 63, v0
    v_lshrrev_b32 v2, 6, v0
    s_waitcnt lgkmcnt(0)
    s_mov_b32 s6, 2101248
    s_mov_b32 s7, 0x00020000
    s_mov_b32 s10, 2101248
    s_mov_b32 s11, 0x00020000
    s_add_u32 s12, s12, 121634816
    s_addc_u32 s13, s13, 0
    s_mov_b32 s14, 4202496
    s_mov_b32 s15, 0x00020000
    s_lshl_b32 s18, s16, 6
    v_add_u32 v3, s18, v2
    s_movk_i32 s19, 1026
    v_mul_lo_u32 v3, v3, s19
    s_lshl_b32 s18, s17, 7
    v_add_u32 v3, s18, v3
    v_lshl_add_u32 v3, v1, 1, v3
    s_mov_b32 s18, 0
    buffer_load_ushort v16, v3, s[4:7], s18 offen
    buffer_load_ushort v32, v3, s[8:11], s18 offen
    s_mov_b32 s18, 4104
    buffer_load_ushort v17, v3, s[4:7], s18 offen
    buffer_load_ushort v33, v3, s[8:11], s18 offen
    s_mov_b32 s18, 8208
    buffer_load_ushort v18, v3, s[4:7], s18 offen
    buffer_load_ushort v34, v3, s[8:11], s18 offen
    s_mov_b32 s18, 12312
    buffer_load_ushort v19, v3, s[4:7], s18 offen
    buffer_load_ushort v35, v3, s[8:11], s18 offen
    s_mov_b32 s18, 16416
    buffer_load_ushort v20, v3, s[4:7], s18 offen
    buffer_load_ushort v36, v3, s[8:11], s18 offen
    s_mov_b32 s18, 20520
    buffer_load_ushort v21, v3, s[4:7], s18 offen
    buffer_load_ushort v37, v3, s[8:11], s18 offen
    s_mov_b32 s18, 24624
    buffer_load_ushort v22, v3, s[4:7], s18 offen
    buffer_load_ushort v38, v3, s[8:11], s18 offen
    s_mov_b32 s18, 28728
    buffer_load_ushort v23, v3, s[4:7], s18 offen
    buffer_load_ushort v39, v3, s[8:11], s18 offen
    s_mov_b32 s18, 32832
    buffer_load_ushort v24, v3, s[4:7], s18 offen
    buffer_load_ushort v40, v3, s[8:11], s18 offen
    s_mov_b32 s18, 36936
    buffer_load_ushort v25, v3, s[4:7], s18 offen
    buffer_load_ushort v41, v3, s[8:11], s18 offen
    s_mov_b32 s18, 41040
    buffer_load_ushort v26, v3, s[4:7], s18 offen
    buffer_load_ushort v42, v3, s[8:11], s18 offen
    s_mov_b32 s18, 45144
    buffer_load_ushort v27, v3, s[4:7], s18 offen
    buffer_load_ushort v43, v3, s[8:11], s18 offen
    s_mov_b32 s18, 49248
    buffer_load_ushort v28, v3, s[4:7], s18 offen
    buffer_load_ushort v44, v3, s[8:11], s18 offen
    s_mov_b32 s18, 53352
    buffer_load_ushort v29, v3, s[4:7], s18 offen
    buffer_load_ushort v45, v3, s[8:11], s18 offen
    s_mov_b32 s18, 57456
    buffer_load_ushort v30, v3, s[4:7], s18 offen
    buffer_load_ushort v46, v3, s[8:11], s18 offen
    s_mov_b32 s18, 61560
    buffer_load_ushort v31, v3, s[4:7], s18 offen
    buffer_load_ushort v47, v3, s[8:11], s18 offen
    v_mul_u32_u24 v4, 65, v1
    v_add_u32 v4, v4, v2
    v_lshlrev_b32 v4, 2, v4
    s_waitcnt vmcnt(0)
    v_lshl_or_b32 v16, v32, 16, v16
    ds_write_b32 v4, v16 offset:0
    v_lshl_or_b32 v17, v33, 16, v17
    ds_write_b32 v4, v17 offset:16
    v_lshl_or_b32 v18, v34, 16, v18
    ds_write_b32 v4, v18 offset:32
    v_lshl_or_b32 v19, v35, 16, v19
    ds_write_b32 v4, v19 offset:48
    v_lshl_or_b32 v20, v36, 16, v20
    ds_write_b32 v4, v20 offset:64
    v_lshl_or_b32 v21, v37, 16, v21
    ds_write_b32 v4, v21 offset:80
    v_lshl_or_b32 v22, v38, 16, v22
    ds_write_b32 v4, v22 offset:96
    v_lshl_or_b32 v23, v39, 16, v23
    ds_write_b32 v4, v23 offset:112
    v_lshl_or_b32 v24, v40, 16, v24
    ds_write_b32 v4, v24 offset:128
    v_lshl_or_b32 v25, v41, 16, v25
    ds_write_b32 v4, v25 offset:144
    v_lshl_or_b32 v26, v42, 16, v26
    ds_write_b32 v4, v26 offset:160
    v_lshl_or_b32 v27, v43, 16, v27
    ds_write_b32 v4, v27 offset:176
    v_lshl_or_b32 v28, v44, 16, v28
    ds_write_b32 v4, v28 offset:192
    v_lshl_or_b32 v29, v45, 16, v29
    ds_write_b32 v4, v29 offset:208
    v_lshl_or_b32 v30, v46, 16, v30
    ds_write_b32 v4, v30 offset:224
    v_lshl_or_b32 v31, v47, 16, v31
    ds_write_b32 v4, v31 offset:240
    v_lshrrev_b32 v7, 4, v0
    v_and_b32 v8, 15, v0
    v_mul_u32_u24 v5, 65, v7
    v_lshl_add_u32 v5, v8, 2, v5
    v_lshlrev_b32 v5, 2, v5
    s_waitcnt lgkmcnt(0)
    s_barrier
    ds_read_b32 v16, v5 offset:0
    ds_read_b32 v17, v5 offset:4
    ds_read_b32 v18, v5 offset:8
    ds_read_b32 v19, v5 offset:12
    ds_read_b32 v20, v5 offset:4160
    ds_read_b32 v21, v5 offset:4164
    ds_read_b32 v22, v5 offset:4168
    ds_read_b32 v23, v5 offset:4172
    ds_read_b32 v24, v5 offset:8320
    ds_read_b32 v25, v5 offset:8324
    ds_read_b32 v26, v5 offset:8328
    ds_read_b32 v27, v5 offset:8332
    ds_read_b32 v28, v5 offset:12480
    ds_read_b32 v29, v5 offset:12484
    ds_read_b32 v30, v5 offset:12488
    ds_read_b32 v31, v5 offset:12492
    s_lshl_b32 s18, s17, 6
    v_add_u32 v6, s18, v7
    v_lshlrev_b32 v6, 13, v6
    s_lshl_b32 s18, s16, 8
    v_add_u32 v6, s18, v6
    v_lshl_add_u32 v6, v8, 4, v6
    s_waitcnt lgkmcnt(0)
    s_mov_b32 s18, 0
    buffer_store_dwordx4 v[16:19], v6, s[12:15], s18 offen sc1
    s_mov_b32 s18, 131072
    buffer_store_dwordx4 v[20:23], v6, s[12:15], s18 offen sc1
    s_mov_b32 s18, 262144
    buffer_store_dwordx4 v[24:27], v6, s[12:15], s18 offen sc1
    s_mov_b32 s18, 393216
    buffer_store_dwordx4 v[28:31], v6, s[12:15], s18 offen sc1
    s_add_u32 s99, s99, 64
    s_cmp_lt_u32 s99, 288
    s_cbranch_scc1 mega_kernel_f0l
    s_branch mega_kernel_f1d
mega_kernel_f1:
    s_barrier
    s_load_dwordx2 s[4:5], s[0:1], 56
    s_load_dwordx2 s[8:9], s[0:1], 96
    v_and_b32 v1, 31, v0
    v_lshrrev_b32 v2, 5, v0
    v_cvt_f32_u32 v3, v1
    s_waitcnt lgkmcnt(0)
    s_mov_b32 s6, 4194304
    s_mov_b32 s7, 0x00020000
    s_mov_b32 s10, 268435456
    s_mov_b32 s11, 0x00020000
    s_lshl_b32 s12, s92, 15
    v_lshlrev_b32 v6, 12, v2
    v_lshl_add_u32 v6, v1, 1, v6
    buffer_load_ushort v16, v6, s[4:7], s12 offen offset:0
    buffer_load_ushort v48, v6, s[4:7], s12 offen offset:2048
    buffer_load_ushort v17, v6, s[4:7], s12 offen offset:64
    buffer_load_ushort v49, v6, s[4:7], s12 offen offset:2112
    buffer_load_ushort v18, v6, s[4:7], s12 offen offset:128
    buffer_load_ushort v50, v6, s[4:7], s12 offen offset:2176
    buffer_load_ushort v19, v6, s[4:7], s12 offen offset:192
    buffer_load_ushort v51, v6, s[4:7], s12 offen offset:2240
    buffer_load_ushort v20, v6, s[4:7], s12 offen offset:256
    buffer_load_ushort v52, v6, s[4:7], s12 offen offset:2304
    buffer_load_ushort v21, v6, s[4:7], s12 offen offset:320
    buffer_load_ushort v53, v6, s[4:7], s12 offen offset:2368
    buffer_load_ushort v22, v6, s[4:7], s12 offen offset:384
    buffer_load_ushort v54, v6, s[4:7], s12 offen offset:2432
    buffer_load_ushort v23, v6, s[4:7], s12 offen offset:448
    buffer_load_ushort v55, v6, s[4:7], s12 offen offset:2496
    buffer_load_ushort v24, v6, s[4:7], s12 offen offset:512
    buffer_load_ushort v56, v6, s[4:7], s12 offen offset:2560
    buffer_load_ushort v25, v6, s[4:7], s12 offen offset:576
    buffer_load_ushort v57, v6, s[4:7], s12 offen offset:2624
    buffer_load_ushort v26, v6, s[4:7], s12 offen offset:640
    buffer_load_ushort v58, v6, s[4:7], s12 offen offset:2688
    buffer_load_ushort v27, v6, s[4:7], s12 offen offset:704
    buffer_load_ushort v59, v6, s[4:7], s12 offen offset:2752
    buffer_load_ushort v28, v6, s[4:7], s12 offen offset:768
    buffer_load_ushort v60, v6, s[4:7], s12 offen offset:2816
    buffer_load_ushort v29, v6, s[4:7], s12 offen offset:832
    buffer_load_ushort v61, v6, s[4:7], s12 offen offset:2880
    buffer_load_ushort v30, v6, s[4:7], s12 offen offset:896
    buffer_load_ushort v62, v6, s[4:7], s12 offen offset:2944
    buffer_load_ushort v31, v6, s[4:7], s12 offen offset:960
    buffer_load_ushort v63, v6, s[4:7], s12 offen offset:3008
    buffer_load_ushort v32, v6, s[4:7], s12 offen offset:1024
    buffer_load_ushort v64, v6, s[4:7], s12 offen offset:3072
    buffer_load_ushort v33, v6, s[4:7], s12 offen offset:1088
    buffer_load_ushort v65, v6, s[4:7], s12 offen offset:3136
    buffer_load_ushort v34, v6, s[4:7], s12 offen offset:1152
    buffer_load_ushort v66, v6, s[4:7], s12 offen offset:3200
    buffer_load_ushort v35, v6, s[4:7], s12 offen offset:1216
    buffer_load_ushort v67, v6, s[4:7], s12 offen offset:3264
    buffer_load_ushort v36, v6, s[4:7], s12 offen offset:1280
    buffer_load_ushort v68, v6, s[4:7], s12 offen offset:3328
    buffer_load_ushort v37, v6, s[4:7], s12 offen offset:1344
    buffer_load_ushort v69, v6, s[4:7], s12 offen offset:3392
    buffer_load_ushort v38, v6, s[4:7], s12 offen offset:1408
    buffer_load_ushort v70, v6, s[4:7], s12 offen offset:3456
    buffer_load_ushort v39, v6, s[4:7], s12 offen offset:1472
    buffer_load_ushort v71, v6, s[4:7], s12 offen offset:3520
    buffer_load_ushort v40, v6, s[4:7], s12 offen offset:1536
    buffer_load_ushort v72, v6, s[4:7], s12 offen offset:3584
    buffer_load_ushort v41, v6, s[4:7], s12 offen offset:1600
    buffer_load_ushort v73, v6, s[4:7], s12 offen offset:3648
    buffer_load_ushort v42, v6, s[4:7], s12 offen offset:1664
    buffer_load_ushort v74, v6, s[4:7], s12 offen offset:3712
    buffer_load_ushort v43, v6, s[4:7], s12 offen offset:1728
    buffer_load_ushort v75, v6, s[4:7], s12 offen offset:3776
    buffer_load_ushort v44, v6, s[4:7], s12 offen offset:1792
    buffer_load_ushort v76, v6, s[4:7], s12 offen offset:3840
    buffer_load_ushort v45, v6, s[4:7], s12 offen offset:1856
    buffer_load_ushort v77, v6, s[4:7], s12 offen offset:3904
    buffer_load_ushort v46, v6, s[4:7], s12 offen offset:1920
    buffer_load_ushort v78, v6, s[4:7], s12 offen offset:3968
    buffer_load_ushort v47, v6, s[4:7], s12 offen offset:1984
    buffer_load_ushort v79, v6, s[4:7], s12 offen offset:4032
    s_movk_i32 s13, 8448
    v_mul_lo_u32 v7, v2, s13
    v_lshl_add_u32 v4, v1, 3, v7
    s_movk_i32 s13, 264
    v_mul_lo_u32 v5, v1, s13
    v_add_u32 v5, v5, v7
    s_waitcnt vmcnt(0)
    v_lshlrev_b32 v16, 16, v16
    v_lshlrev_b32 v48, 16, v48
    v_lshlrev_b32 v17, 16, v17
    v_lshlrev_b32 v49, 16, v49
    v_lshlrev_b32 v18, 16, v18
    v_lshlrev_b32 v50, 16, v50
    v_lshlrev_b32 v19, 16, v19
    v_lshlrev_b32 v51, 16, v51
    v_lshlrev_b32 v20, 16, v20
    v_lshlrev_b32 v52, 16, v52
    v_lshlrev_b32 v21, 16, v21
    v_lshlrev_b32 v53, 16, v53
    v_lshlrev_b32 v22, 16, v22
    v_lshlrev_b32 v54, 16, v54
    v_lshlrev_b32 v23, 16, v23
    v_lshlrev_b32 v55, 16, v55
    v_lshlrev_b32 v24, 16, v24
    v_lshlrev_b32 v56, 16, v56
    v_lshlrev_b32 v25, 16, v25
    v_lshlrev_b32 v57, 16, v57
    v_lshlrev_b32 v26, 16, v26
    v_lshlrev_b32 v58, 16, v58
    v_lshlrev_b32 v27, 16, v27
    v_lshlrev_b32 v59, 16, v59
    v_lshlrev_b32 v28, 16, v28
    v_lshlrev_b32 v60, 16, v60
    v_lshlrev_b32 v29, 16, v29
    v_lshlrev_b32 v61, 16, v61
    v_lshlrev_b32 v30, 16, v30
    v_lshlrev_b32 v62, 16, v62
    v_lshlrev_b32 v31, 16, v31
    v_lshlrev_b32 v63, 16, v63
    v_lshlrev_b32 v32, 16, v32
    v_lshlrev_b32 v64, 16, v64
    v_lshlrev_b32 v33, 16, v33
    v_lshlrev_b32 v65, 16, v65
    v_lshlrev_b32 v34, 16, v34
    v_lshlrev_b32 v66, 16, v66
    v_lshlrev_b32 v35, 16, v35
    v_lshlrev_b32 v67, 16, v67
    v_lshlrev_b32 v36, 16, v36
    v_lshlrev_b32 v68, 16, v68
    v_lshlrev_b32 v37, 16, v37
    v_lshlrev_b32 v69, 16, v69
    v_lshlrev_b32 v38, 16, v38
    v_lshlrev_b32 v70, 16, v70
    v_lshlrev_b32 v39, 16, v39
    v_lshlrev_b32 v71, 16, v71
    v_lshlrev_b32 v40, 16, v40
    v_lshlrev_b32 v72, 16, v72
    v_lshlrev_b32 v41, 16, v41
    v_lshlrev_b32 v73, 16, v73
    v_lshlrev_b32 v42, 16, v42
    v_lshlrev_b32 v74, 16, v74
    v_lshlrev_b32 v43, 16, v43
    v_lshlrev_b32 v75, 16, v75
    v_lshlrev_b32 v44, 16, v44
    v_lshlrev_b32 v76, 16, v76
    v_lshlrev_b32 v45, 16, v45
    v_lshlrev_b32 v77, 16, v77
    v_lshlrev_b32 v46, 16, v46
    v_lshlrev_b32 v78, 16, v78
    v_lshlrev_b32 v47, 16, v47
    v_lshlrev_b32 v79, 16, v79
    v_sub_f32 v80, v16, v32
    v_sub_f32 v81, v48, v64
    v_add_f32 v16, v16, v32
    v_add_f32 v48, v48, v64
    v_sub_f32 v32, v17, v33
    v_sub_f32 v64, v49, v65
    v_add_f32 v17, v17, v33
    v_add_f32 v49, v49, v65
    v_mul_f32 v33, 0x3f7b14be, v32
    v_mul_f32 v65, 0xbe47c5c2, v32
    v_fmac_f32 v33, 0x3e47c5c2, v64
    v_fmac_f32 v65, 0x3f7b14be, v64
    v_sub_f32 v32, v18, v34
    v_sub_f32 v64, v50, v66
    v_add_f32 v18, v18, v34
    v_add_f32 v50, v50, v66
    v_mul_f32 v34, 0x3f6c835e, v32
    v_mul_f32 v66, 0xbec3ef15, v32
    v_fmac_f32 v34, 0x3ec3ef15, v64
    v_fmac_f32 v66, 0x3f6c835e, v64
    v_sub_f32 v32, v19, v35
    v_sub_f32 v64, v51, v67
    v_add_f32 v19, v19, v35
    v_add_f32 v51, v51, v67
    v_mul_f32 v35, 0x3f54db31, v32
    v_mul_f32 v67, 0xbf0e39da, v32
    v_fmac_f32 v35, 0x3f0e39da, v64
    v_fmac_f32 v67, 0x3f54db31, v64
    v_sub_f32 v32, v20, v36
    v_sub_f32 v64, v52, v68
    v_add_f32 v20, v20, v36
    v_add_f32 v52, v52, v68
    v_mul_f32 v36, 0x3f3504f3, v32
    v_mul_f32 v68, 0xbf3504f3, v32
    v_fmac_f32 v36, 0x3f3504f3, v64
    v_fmac_f32 v68, 0x3f3504f3, v64
    v_sub_f32 v32, v21, v37
    v_sub_f32 v64, v53, v69
    v_add_f32 v21, v21, v37
    v_add_f32 v53, v53, v69
    v_mul_f32 v37, 0x3f0e39da, v32
    v_mul_f32 v69, 0xbf54db31, v32
    v_fmac_f32 v37, 0x3f54db31, v64
    v_fmac_f32 v69, 0x3f0e39da, v64
    v_sub_f32 v32, v22, v38
    v_sub_f32 v64, v54, v70
    v_add_f32 v22, v22, v38
    v_add_f32 v54, v54, v70
    v_mul_f32 v38, 0x3ec3ef15, v32
    v_mul_f32 v70, 0xbf6c835e, v32
    v_fmac_f32 v38, 0x3f6c835e, v64
    v_fmac_f32 v70, 0x3ec3ef15, v64
    v_sub_f32 v32, v23, v39
    v_sub_f32 v64, v55, v71
    v_add_f32 v23, v23, v39
    v_add_f32 v55, v55, v71
    v_mul_f32 v39, 0x3e47c5c2, v32
    v_mul_f32 v71, 0xbf7b14be, v32
    v_fmac_f32 v39, 0x3f7b14be, v64
    v_fmac_f32 v71, 0x3e47c5c2, v64
    v_sub_f32 v32, v56, v72
    v_sub_f32 v64, v40, v24
    v_add_f32 v24, v24, v40
    v_add_f32 v56, v56, v72
    v_sub_f32 v40, v25, v41
    v_sub_f32 v72, v57, v73
    v_add_f32 v25, v25, v41
    v_add_f32 v57, v57, v73
    v_mul_f32 v41, 0xbe47c5c2, v40
    v_mul_f32 v73, 0xbf7b14be, v40
    v_fmac_f32 v41, 0x3f7b14be, v72
    v_fmac_f32 v73, 0xbe47c5c2, v72
    v_sub_f32 v40, v26, v42
    v_sub_f32 v72, v58, v74
    v_add_f32 v26, v26, v42
    v_add_f32 v58, v58, v74
    v_mul_f32 v42, 0xbec3ef15, v40
    v_mul_f32 v74, 0xbf6c835e, v40
    v_fmac_f32 v42, 0x3f6c835e, v72
    v_fmac_f32 v74, 0xbec3ef15, v72
    v_sub_f32 v40, v27, v43
    v_sub_f32 v72, v59, v75
    v_add_f32 v27, v27, v43
    v_add_f32 v59, v59, v75
    v_mul_f32 v43, 0xbf0e39da, v40
    v_mul_f32 v75, 0xbf54db31, v40
    v_fmac_f32 v43, 0x3f54db31, v72
    v_fmac_f32 v75, 0xbf0e39da, v72
    v_sub_f32 v40, v28, v44
    v_sub_f32 v72, v60, v76
    v_add_f32 v28, v28, v44
    v_add_f32 v60, v60, v76
    v_mul_f32 v44, 0xbf3504f3, v40
    v_mul_f32 v76, 0xbf3504f3, v40
    v_fmac_f32 v44, 0x3f3504f3, v72
    v_fmac_f32 v76, 0xbf3504f3, v72
    v_sub_f32 v40, v29, v45
    v_sub_f32 v72, v61, v77
    v_add_f32 v29, v29, v45
    v_add_f32 v61, v61, v77
    v_mul_f32 v45, 0xbf54db31, v40
    v_mul_f32 v77, 0xbf0e39da, v40
    v_fmac_f32 v45, 0x3f0e39da, v72
    v_fmac_f32 v77, 0xbf54db31, v72
    v_sub_f32 v40, v30, v46
    v_sub_f32 v72, v62, v78
    v_add_f32 v30, v30, v46
    v_add_f32 v62, v62, v78
    v_mul_f32 v46, 0xbf6c835e, v40
    v_mul_f32 v78, 0xbec3ef15, v40
    v_fmac_f32 v46, 0x3ec3ef15, v72
    v_fmac_f32 v78, 0xbf6c835e, v72
    v_sub_f32 v40, v31, v47
    v_sub_f32 v72, v63, v79
    v_add_f32 v31, v31, v47
    v_add_f32 v63, v63, v79
    v_mul_f32 v47, 0xbf7b14be, v40
    v_mul_f32 v79, 0xbe47c5c2, v40
    v_fmac_f32 v47, 0x3e47c5c2, v72
    v_fmac_f32 v79, 0xbf7b14be, v72
    v_sub_f32 v40, v16, v24
    v_sub_f32 v72, v48, v56
    v_add_f32 v16, v16, v24
    v_add_f32 v48, v48, v56
    v_sub_f32 v24, v17, v25
    v_sub_f32 v56, v49, v57
    v_add_f32 v17, v17, v25
    v_add_f32 v49, v49, v57
    v_mul_f32 v25, 0x3f6c835e, v24
    v_mul_f32 v57, 0xbec3ef15, v24
    v_fmac_f32 v25, 0x3ec3ef15, v56
    v_fmac_f32 v57, 0x3f6c835e, v56
    v_sub_f32 v24, v18, v26
    v_sub_f32 v56, v50, v58
    v_add_f32 v18, v18, v26
    v_add_f32 v50, v50, v58
    v_mul_f32 v26, 0x3f3504f3, v24
    v_mul_f32 v58, 0xbf3504f3, v24
    v_fmac_f32 v26, 0x3f3504f3, v56
    v_fmac_f32 v58, 0x3f3504f3, v56
    v_sub_f32 v24, v19, v27
    v_sub_f32 v56, v51, v59
    v_add_f32 v19, v19, v27
    v_add_f32 v51, v51, v59
    v_mul_f32 v27, 0x3ec3ef15, v24
    v_mul_f32 v59, 0xbf6c835e, v24
    v_fmac_f32 v27, 0x3f6c835e, v56
    v_fmac_f32 v59, 0x3ec3ef15, v56
    v_sub_f32 v24, v52, v60
    v_sub_f32 v56, v28, v20
    v_add_f32 v20, v20, v28
    v_add_f32 v52, v52, v60
    v_sub_f32 v28, v21, v29
    v_sub_f32 v60, v53, v61
    v_add_f32 v21, v21, v29
    v_add_f32 v53, v53, v61
    v_mul_f32 v29, 0xbec3ef15, v28
    v_mul_f32 v61, 0xbf6c835e, v28
    v_fmac_f32 v29, 0x3f6c835e, v60
    v_fmac_f32 v61, 0xbec3ef15, v60
    v_sub_f32 v28, v22, v30
    v_sub_f32 v60, v54, v62
    v_add_f32 v22, v22, v30
    v_add_f32 v54, v54, v62
    v_mul_f32 v30, 0xbf3504f3, v28
    v_mul_f32 v62, 0xbf3504f3, v28
    v_fmac_f32 v30, 0x3f3504f3, v60
    v_fmac_f32 v62, 0xbf3504f3, v60
    v_sub_f32 v28, v23, v31
    v_sub_f32 v60, v55, v63
    v_add_f32 v23, v23, v31
    v_add_f32 v55, v55, v63
    v_mul_f32 v31, 0xbf6c835e, v28
    v_mul_f32 v63, 0xbec3ef15, v28
    v_fmac_f32 v31, 0x3ec3ef15, v60
    v_fmac_f32 v63, 0xbf6c835e, v60
    v_sub_f32 v28, v80, v32
    v_sub_f32 v60, v81, v64
    v_add_f32 v80, v80, v32
    v_add_f32 v81, v81, v64
    v_sub_f32 v32, v33, v41
    v_sub_f32 v64, v65, v73
    v_add_f32 v33, v33, v41
    v_add_f32 v65, v65, v73
    v_mul_f32 v41, 0x3f6c835e, v32
    v_mul_f32 v73, 0xbec3ef15, v32
    v_fmac_f32 v41, 0x3ec3ef15, v64
    v_fmac_f32 v73, 0x3f6c835e, v64
    v_sub_f32 v32, v34, v42
    v_sub_f32 v64, v66, v74
    v_add_f32 v34, v34, v42
    v_add_f32 v66, v66, v74
    v_mul_f32 v42, 0x3f3504f3, v32
    v_mul_f32 v74, 0xbf3504f3, v32
    v_fmac_f32 v42, 0x3f3504f3, v64
    v_fmac_f32 v74, 0x3f3504f3, v64
    v_sub_f32 v32, v35, v43
    v_sub_f32 v64, v67, v75
    v_add_f32 v35, v35, v43
    v_add_f32 v67, v67, v75
    v_mul_f32 v43, 0x3ec3ef15, v32
    v_mul_f32 v75, 0xbf6c835e, v32
    v_fmac_f32 v43, 0x3f6c835e, v64
    v_fmac_f32 v75, 0x3ec3ef15, v64
    v_sub_f32 v32, v68, v76
    v_sub_f32 v64, v44, v36
    v_add_f32 v36, v36, v44
    v_add_f32 v68, v68, v76
    v_sub_f32 v44, v37, v45
    v_sub_f32 v76, v69, v77
    v_add_f32 v37, v37, v45
    v_add_f32 v69, v69, v77
    v_mul_f32 v45, 0xbec3ef15, v44
    v_mul_f32 v77, 0xbf6c835e, v44
    v_fmac_f32 v45, 0x3f6c835e, v76
    v_fmac_f32 v77, 0xbec3ef15, v76
    v_sub_f32 v44, v38, v46
    v_sub_f32 v76, v70, v78
    v_add_f32 v38, v38, v46
    v_add_f32 v70, v70, v78
    v_mul_f32 v46, 0xbf3504f3, v44
    v_mul_f32 v78, 0xbf3504f3, v44
    v_fmac_f32 v46, 0x3f3504f3, v76
    v_fmac_f32 v78, 0xbf3504f3, v76
    v_sub_f32 v44, v39, v47
    v_sub_f32 v76, v71, v79
    v_add_f32 v39, v39, v47
    v_add_f32 v71, v71, v79
    v_mul_f32 v47, 0xbf6c835e, v44
    v_mul_f32 v79, 0xbec3ef15, v44
    v_fmac_f32 v47, 0x3ec3ef15, v76
    v_fmac_f32 v79, 0xbf6c835e, v76
    v_sub_f32 v44, v16, v20
    v_sub_f32 v76, v48, v52
    v_add_f32 v16, v16, v20
    v_add_f32 v48, v48, v52
    v_sub_f32 v20, v17, v21
    v_sub_f32 v52, v49, v53
    v_add_f32 v17, v17, v21
    v_add_f32 v49, v49, v53
    v_mul_f32 v21, 0x3f3504f3, v20
    v_mul_f32 v53, 0xbf3504f3, v20
    v_fmac_f32 v21, 0x3f3504f3, v52
    v_fmac_f32 v53, 0x3f3504f3, v52
    v_sub_f32 v20, v50, v54
    v_sub_f32 v52, v22, v18
    v_add_f32 v18, v18, v22
    v_add_f32 v50, v50, v54
    v_sub_f32 v22, v19, v23
    v_sub_f32 v54, v51, v55
    v_add_f32 v19, v19, v23
    v_add_f32 v51, v51, v55
    v_mul_f32 v23, 0xbf3504f3, v22
    v_mul_f32 v55, 0xbf3504f3, v22
    v_fmac_f32 v23, 0x3f3504f3, v54
    v_fmac_f32 v55, 0xbf3504f3, v54
    v_sub_f32 v22, v40, v24
    v_sub_f32 v54, v72, v56
    v_add_f32 v40, v40, v24
    v_add_f32 v72, v72, v56
    v_sub_f32 v24, v25, v29
    v_sub_f32 v56, v57, v61
    v_add_f32 v25, v25, v29
    v_add_f32 v57, v57, v61
    v_mul_f32 v29, 0x3f3504f3, v24
    v_mul_f32 v61, 0xbf3504f3, v24
    v_fmac_f32 v29, 0x3f3504f3, v56
    v_fmac_f32 v61, 0x3f3504f3, v56
    v_sub_f32 v24, v58, v62
    v_sub_f32 v56, v30, v26
    v_add_f32 v26, v26, v30
    v_add_f32 v58, v58, v62
    v_sub_f32 v30, v27, v31
    v_sub_f32 v62, v59, v63
    v_add_f32 v27, v27, v31
    v_add_f32 v59, v59, v63
    v_mul_f32 v31, 0xbf3504f3, v30
    v_mul_f32 v63, 0xbf3504f3, v30
    v_fmac_f32 v31, 0x3f3504f3, v62
    v_fmac_f32 v63, 0xbf3504f3, v62
    v_sub_f32 v30, v80, v36
    v_sub_f32 v62, v81, v68
    v_add_f32 v80, v80, v36
    v_add_f32 v81, v81, v68
    v_sub_f32 v36, v33, v37
    v_sub_f32 v68, v65, v69
    v_add_f32 v33, v33, v37
    v_add_f32 v65, v65, v69
    v_mul_f32 v37, 0x3f3504f3, v36
    v_mul_f32 v69, 0xbf3504f3, v36
    v_fmac_f32 v37, 0x3f3504f3, v68
    v_fmac_f32 v69, 0x3f3504f3, v68
    v_sub_f32 v36, v66, v70
    v_sub_f32 v68, v38, v34
    v_add_f32 v34, v34, v38
    v_add_f32 v66, v66, v70
    v_sub_f32 v38, v35, v39
    v_sub_f32 v70, v67, v71
    v_add_f32 v35, v35, v39
    v_add_f32 v67, v67, v71
    v_mul_f32 v39, 0xbf3504f3, v38
    v_mul_f32 v71, 0xbf3504f3, v38
    v_fmac_f32 v39, 0x3f3504f3, v70
    v_fmac_f32 v71, 0xbf3504f3, v70
    v_sub_f32 v38, v28, v32
    v_sub_f32 v70, v60, v64
    v_add_f32 v28, v28, v32
    v_add_f32 v60, v60, v64
    v_sub_f32 v32, v41, v45
    v_sub_f32 v64, v73, v77
    v_add_f32 v41, v41, v45
    v_add_f32 v73, v73, v77
    v_mul_f32 v45, 0x3f3504f3, v32
    v_mul_f32 v77, 0xbf3504f3, v32
    v_fmac_f32 v45, 0x3f3504f3, v64
    v_fmac_f32 v77, 0x3f3504f3, v64
    v_sub_f32 v32, v74, v78
    v_sub_f32 v64, v46, v42
    v_add_f32 v42, v42, v46
    v_add_f32 v74, v74, v78
    v_sub_f32 v46, v43, v47
    v_sub_f32 v78, v75, v79
    v_add_f32 v43, v43, v47
    v_add_f32 v75, v75, v79
    v_mul_f32 v47, 0xbf3504f3, v46
    v_mul_f32 v79, 0xbf3504f3, v46
    v_fmac_f32 v47, 0x3f3504f3, v78
    v_fmac_f32 v79, 0xbf3504f3, v78
    v_sub_f32 v46, v16, v18
    v_sub_f32 v78, v48, v50
    v_add_f32 v16, v16, v18
    v_add_f32 v48, v48, v50
    v_sub_f32 v18, v49, v51
    v_sub_f32 v50, v19, v17
    v_add_f32 v17, v17, v19
    v_add_f32 v49, v49, v51
    v_sub_f32 v19, v44, v20
    v_sub_f32 v51, v76, v52
    v_add_f32 v44, v44, v20
    v_add_f32 v76, v76, v52
    v_sub_f32 v20, v53, v55
    v_sub_f32 v52, v23, v21
    v_add_f32 v21, v21, v23
    v_add_f32 v53, v53, v55
    v_sub_f32 v23, v40, v26
    v_sub_f32 v55, v72, v58
    v_add_f32 v40, v40, v26
    v_add_f32 v72, v72, v58
    v_sub_f32 v26, v57, v59
    v_sub_f32 v58, v27, v25
    v_add_f32 v25, v25, v27
    v_add_f32 v57, v57, v59
    v_sub_f32 v27, v22, v24
    v_sub_f32 v59, v54, v56
    v_add_f32 v22, v22, v24
    v_add_f32 v54, v54, v56
    v_sub_f32 v24, v61, v63
    v_sub_f32 v56, v31, v29
    v_add_f32 v29, v29, v31
    v_add_f32 v61, v61, v63
    v_sub_f32 v31, v80, v34
    v_sub_f32 v63, v81, v66
    v_add_f32 v80, v80, v34
    v_add_f32 v81, v81, v66
    v_sub_f32 v34, v65, v67
    v_sub_f32 v66, v35, v33
    v_add_f32 v33, v33, v35
    v_add_f32 v65, v65, v67
    v_sub_f32 v35, v30, v36
    v_sub_f32 v67, v62, v68
    v_add_f32 v30, v30, v36
    v_add_f32 v62, v62, v68
    v_sub_f32 v36, v69, v71
    v_sub_f32 v68, v39, v37
    v_add_f32 v37, v37, v39
    v_add_f32 v69, v69, v71
    v_sub_f32 v39, v28, v42
    v_sub_f32 v71, v60, v74
    v_add_f32 v28, v28, v42
    v_add_f32 v60, v60, v74
    v_sub_f32 v42, v73, v75
    v_sub_f32 v74, v43, v41
    v_add_f32 v41, v41, v43
    v_add_f32 v73, v73, v75
    v_sub_f32 v43, v38, v32
    v_sub_f32 v75, v70, v64
    v_add_f32 v38, v38, v32
    v_add_f32 v70, v70, v64
    v_sub_f32 v32, v77, v79
    v_sub_f32 v64, v47, v45
    v_add_f32 v45, v45, v47
    v_add_f32 v77, v77, v79
    v_sub_f32 v47, v16, v17
    v_sub_f32 v79, v48, v49
    v_add_f32 v16, v16, v17
    v_add_f32 v48, v48, v49
    v_sub_f32 v17, v46, v18
    v_sub_f32 v49, v78, v50
    v_add_f32 v46, v46, v18
    v_add_f32 v78, v78, v50
    v_sub_f32 v18, v44, v21
    v_sub_f32 v50, v76, v53
    v_add_f32 v44, v44, v21
    v_add_f32 v76, v76, v53
    v_sub_f32 v21, v19, v20
    v_sub_f32 v53, v51, v52
    v_add_f32 v19, v19, v20
    v_add_f32 v51, v51, v52
    v_sub_f32 v20, v40, v25
    v_sub_f32 v52, v72, v57
    v_add_f32 v40, v40, v25
    v_add_f32 v72, v72, v57
    v_sub_f32 v25, v23, v26
    v_sub_f32 v57, v55, v58
    v_add_f32 v23, v23, v26
    v_add_f32 v55, v55, v58
    v_sub_f32 v26, v22, v29
    v_sub_f32 v58, v54, v61
    v_add_f32 v22, v22, v29
    v_add_f32 v54, v54, v61
    v_sub_f32 v29, v27, v24
    v_sub_f32 v61, v59, v56
    v_add_f32 v27, v27, v24
    v_add_f32 v59, v59, v56
    v_sub_f32 v24, v80, v33
    v_sub_f32 v56, v81, v65
    v_add_f32 v80, v80, v33
    v_add_f32 v81, v81, v65
    v_sub_f32 v33, v31, v34
    v_sub_f32 v65, v63, v66
    v_add_f32 v31, v31, v34
    v_add_f32 v63, v63, v66
    v_sub_f32 v34, v30, v37
    v_sub_f32 v66, v62, v69
    v_add_f32 v30, v30, v37
    v_add_f32 v62, v62, v69
    v_sub_f32 v37, v35, v36
    v_sub_f32 v69, v67, v68
    v_add_f32 v35, v35, v36
    v_add_f32 v67, v67, v68
    v_sub_f32 v36, v28, v41
    v_sub_f32 v68, v60, v73
    v_add_f32 v28, v28, v41
    v_add_f32 v60, v60, v73
    v_sub_f32 v41, v39, v42
    v_sub_f32 v73, v71, v74
    v_add_f32 v39, v39, v42
    v_add_f32 v71, v71, v74
    v_sub_f32 v42, v38, v45
    v_sub_f32 v74, v70, v77
    v_add_f32 v38, v38, v45
    v_add_f32 v70, v70, v77
    v_sub_f32 v45, v43, v32
    v_sub_f32 v77, v75, v64
    v_add_f32 v43, v43, v32
    v_add_f32 v75, v75, v64
    v_mul_f32 v32, 0xba800000, v3
    v_cos_f32 v64, v32
    v_sin_f32 v82, v32
    s_nop 0
    v_mul_f32 v83, v80, v64
    v_fma_f32 v83, -v81, v82, v83
    v_mul_f32 v81, v81, v64
    v_fmac_f32 v81, v80, v82
    v_mul_f32 v32, 0xbb000000, v3
    v_cos_f32 v64, v32
    v_sin_f32 v82, v32
    s_nop 0
    v_mul_f32 v80, v40, v64
    v_fma_f32 v80, -v72, v82, v80
    v_mul_f32 v72, v72, v64
    v_fmac_f32 v72, v40, v82
    v_mul_f32 v32, 0xbb400000, v3
    v_cos_f32 v64, v32
    v_sin_f32 v82, v32
    s_nop 0
    v_mul_f32 v40, v28, v64
    v_fma_f32 v40, -v60, v82, v40
    v_mul_f32 v60, v60, v64
    v_fmac_f32 v60, v28, v82
    v_mul_f32 v32, 0xbb800000, v3
    v_cos_f32 v64, v32
    v_sin_f32 v82, v32
    s_nop 0
    v_mul_f32 v28, v44, v64
    v_fma_f32 v28, -v76, v82, v28
    v_mul_f32 v76, v76, v64
    v_fmac_f32 v76, v44, v82
    v_mul_f32 v32, 0xbba00000, v3
    v_cos_f32 v64, v32
    v_sin_f32 v82, v32
    s_nop 0
    v_mul_f32 v44, v30, v64
    v_fma_f32 v44, -v62, v82, v44
    v_mul_f32 v62, v62, v64
    v_fmac_f32 v62, v30, v82
    v_mul_f32 v32, 0xbbc00000, v3
    v_cos_f32 v64, v32
    v_sin_f32 v82, v32
    s_nop 0
    v_mul_f32 v30, v22, v64
    v_fma_f32 v30, -v54, v82, v30
    v_mul_f32 v54, v54, v64
    v_fmac_f32 v54, v22, v82
    v_mul_f32 v32, 0xbbe00000, v3
    v_cos_f32 v64, v32
    v_sin_f32 v82, v32
    s_nop 0
    v_mul_f32 v22, v38, v64
    v_fma_f32 v22, -v70, v82, v22
    v_mul_f32 v70, v70, v64
    v_fmac_f32 v70, v38, v82
    v_mul_f32 v32, 0xbc000000, v3
    v_cos_f32 v64, v32
    v_sin_f32 v82, v32
    s_nop 0
    v_mul_f32 v38, v46, v64
    v_fma_f32 v38, -v78, v82, v38
    v_mul_f32 v78, v78, v64
    v_fmac_f32 v78, v46, v82
    v_mul_f32 v32, 0xbc100000, v3
    v_cos_f32 v64, v32
    v_sin_f32 v82, v32
    s_nop 0
    v_mul_f32 v46, v31, v64
    v_fma_f32 v46, -v63, v82, v46
    v_mul_f32 v63, v63, v64
    v_fmac_f32 v63, v31, v82
    v_mul_f32 v32, 0xbc200000, v3
    v_cos_f32 v64, v32
    v_sin_f32 v82, v32
    s_nop 0
    v_mul_f32 v31, v23, v64
    v_fma_f32 v31, -v55, v82, v31
    v_mul_f32 v55, v55, v64
    v_fmac_f32 v55, v23, v82
    v_mul_f32 v32, 0xbc300000, v3
    v_cos_f32 v64, v32
    v_sin_f32 v82, v32
    s_nop 0
    v_mul_f32 v23, v39, v64
    v_fma_f32 v23, -v71, v82, v23
    v_mul_f32 v71, v71, v64
    v_fmac_f32 v71, v39, v82
    v_mul_f32 v32, 0xbc400000, v3
    v_cos_f32 v64, v32
    v_sin_f32 v82, v32
    s_nop 0
    v_mul_f32 v39, v19, v64
    v_fma_f32 v39, -v51, v82, v39
    v_mul_f32 v51, v51, v64
    v_fmac_f32 v51, v19, v82
    v_mul_f32 v32, 0xbc500000, v3
    v_cos_f32 v64, v32
    v_sin_f32 v82, v32
    s_nop 0
    v_mul_f32 v19, v35, v64
    v_fma_f32 v19, -v67, v82, v19
    v_mul_f32 v67, v67, v64
    v_fmac_f32 v67, v35, v82
    v_mul_f32 v32, 0xbc600000, v3
    v_cos_f32 v64, v32
    v_sin_f32 v82, v32
    s_nop 0
    v_mul_f32 v35, v27, v64
    v_fma_f32 v35, -v59, v82, v35
    v_mul_f32 v59, v59, v64
    v_fmac_f32 v59, v27, v82
    v_mul_f32 v32, 0xbc700000, v3
    v_cos_f32 v64, v32
    v_sin_f32 v82, v32
    s_nop 0
    v_mul_f32 v27, v43, v64
    v_fma_f32 v27, -v75, v82, v27
    v_mul_f32 v75, v75, v64
    v_fmac_f32 v75, v43, v82
    v_mul_f32 v32, 0xbc800000, v3
    v_cos_f32 v64, v32
    v_sin_f32 v82, v32
    s_nop 0
    v_mul_f32 v43, v47, v64
    v_fma_f32 v43, -v79, v82, v43
    v_mul_f32 v79, v79, v64
    v_fmac_f32 v79, v47, v82
    v_mul_f32 v32, 0xbc880000, v3
    v_cos_f32 v64, v32
    v_sin_f32 v82, v32
    s_nop 0
    v_mul_f32 v47, v24, v64
    v_fma_f32 v47, -v56, v82, v47
    v_mul_f32 v56, v56, v64
    v_fmac_f32 v56, v24, v82
    v_mul_f32 v32, 0xbc900000, v3
    v_cos_f32 v64, v32
    v_sin_f32 v82, v32
    s_nop 0
    v_mul_f32 v24, v20, v64
    v_fma_f32 v24, -v52, v82, v24
    v_mul_f32 v52, v52, v64
    v_fmac_f32 v52, v20, v82
    v_mul_f32 v32, 0xbc980000, v3
    v_cos_f32 v64, v32
    v_sin_f32 v82, v32
    s_nop 0
    v_mul_f32 v20, v36, v64
    v_fma_f32 v20, -v68, v82, v20
    v_mul_f32 v68, v68, v64
    v_fmac_f32 v68, v36, v82
    v_mul_f32 v32, 0xbca00000, v3
    v_cos_f32 v64, v32
    v_sin_f32 v82, v32
    s_nop 0
    v_mul_f32 v36, v18, v64
    v_fma_f32 v36, -v50, v82, v36
    v_mul_f32 v50, v50, v64
    v_fmac_f32 v50, v18, v82
    v_mul_f32 v32, 0xbca80000, v3
    v_cos_f32 v64, v32
    v_sin_f32 v82, v32
    s_nop 0
    v_mul_f32 v18, v34, v64
    v_fma_f32 v18, -v66, v82, v18
    v_mul_f32 v66, v66, v64
    v_fmac_f32 v66, v34, v82
    v_mul_f32 v32, 0xbcb00000, v3
    v_cos_f32 v64, v32
    v_sin_f32 v82, v32
    s_nop 0
    v_mul_f32 v34, v26, v64
    v_fma_f32 v34, -v58, v82, v34
    v_mul_f32 v58, v58, v64
    v_fmac_f32 v58, v26, v82
    v_mul_f32 v32, 0xbcb80000, v3
    v_cos_f32 v64, v32
    v_sin_f32 v82, v32
    s_nop 0
    v_mul_f32 v26, v42, v64
    v_fma_f32 v26, -v74, v82, v26
    v_mul_f32 v74, v74, v64
    v_fmac_f32 v74, v42, v82
    v_mul_f32 v32, 0xbcc00000, v3
    v_cos_f32 v64, v32
    v_sin_f32 v82, v32
    s_nop 0
    v_mul_f32 v42, v17, v64
    v_fma_f32 v42, -v49, v82, v42
    v_mul_f32 v49, v49, v64
    v_fmac_f32 v49, v17, v82
    v_mul_f32 v32, 0xbcc80000, v3
    v_cos_f32 v64, v32
    v_sin_f32 v82, v32
    s_nop 0
    v_mul_f32 v17, v33, v64
    v_fma_f32 v17, -v65, v82, v17
    v_mul_f32 v65, v65, v64
    v_fmac_f32 v65, v33, v82
    v_mul_f32 v32, 0xbcd00000, v3
    v_cos_f32 v64, v32
    v_sin_f32 v82, v32
    s_nop 0
    v_mul_f32 v33, v25, v64
    v_fma_f32 v33, -v57, v82, v33
    v_mul_f32 v57, v57, v64
    v_fmac_f32 v57, v25, v82
    v_mul_f32 v32, 0xbcd80000, v3
    v_cos_f32 v64, v32
    v_sin_f32 v82, v32
    s_nop 0
    v_mul_f32 v25, v41, v64
    v_fma_f32 v25, -v73, v82, v25
    v_mul_f32 v73, v73, v64
    v_fmac_f32 v73, v41, v82
    v_mul_f32 v32, 0xbce00000, v3
    v_cos_f32 v64, v32
    v_sin_f32 v82, v32
    s_nop 0
    v_mul_f32 v41, v21, v64
    v_fma_f32 v41, -v53, v82, v41
    v_mul_f32 v53, v53, v64
    v_fmac_f32 v53, v21, v82
    v_mul_f32 v32, 0xbce80000, v3
    v_cos_f32 v64, v32
    v_sin_f32 v82, v32
    s_nop 0
    v_mul_f32 v21, v37, v64
    v_fma_f32 v21, -v69, v82, v21
    v_mul_f32 v69, v69, v64
    v_fmac_f32 v69, v37, v82
    v_mul_f32 v32, 0xbcf00000, v3
    v_cos_f32 v64, v32
    v_sin_f32 v82, v32
    s_nop 0
    v_mul_f32 v37, v29, v64
    v_fma_f32 v37, -v61, v82, v37
    v_mul_f32 v61, v61, v64
    v_fmac_f32 v61, v29, v82
    v_mul_f32 v32, 0xbcf80000, v3
    v_cos_f32 v64, v32
    v_sin_f32 v82, v32
    s_nop 0
    v_mul_f32 v29, v45, v64
    v_fma_f32 v29, -v77, v82, v29
    v_mul_f32 v77, v77, v64
    v_fmac_f32 v77, v45, v82
    ds_write_b32 v4, v16 offset:0
    ds_write_b32 v4, v48 offset:4
    ds_write_b32 v4, v83 offset:264
    ds_write_b32 v4, v81 offset:268
    ds_write_b32 v4, v80 offset:528
    ds_write_b32 v4, v72 offset:532
    ds_write_b32 v4, v40 offset:792
    ds_write_b32 v4, v60 offset:796
    ds_write_b32 v4, v28 offset:1056
    ds_write_b32 v4, v76 offset:1060
    ds_write_b32 v4, v44 offset:1320
    ds_write_b32 v4, v62 offset:1324
    ds_write_b32 v4, v30 offset:1584
    ds_write_b32 v4, v54 offset:1588
    ds_write_b32 v4, v22 offset:1848
    ds_write_b32 v4, v70 offset:1852
    ds_write_b32 v4, v38 offset:2112
    ds_write_b32 v4, v78 offset:2116
    ds_write_b32 v4, v46 offset:2376
    ds_write_b32 v4, v63 offset:2380
    ds_write_b32 v4, v31 offset:2640
    ds_write_b32 v4, v55 offset:2644
    ds_write_b32 v4, v23 offset:2904
    ds_write_b32 v4, v71 offset:2908
    ds_write_b32 v4, v39 offset:3168
    ds_write_b32 v4, v51 offset:3172
    ds_write_b32 v4, v19 offset:3432
    ds_write_b32 v4, v67 offset:3436
    ds_write_b32 v4, v35 offset:3696
    ds_write_b32 v4, v59 offset:3700
    ds_write_b32 v4, v27 offset:3960
    ds_write_b32 v4, v75 offset:3964
    ds_write_b32 v4, v43 offset:4224
    ds_write_b32 v4, v79 offset:4228
    ds_write_b32 v4, v47 offset:4488
    ds_write_b32 v4, v56 offset:4492
    ds_write_b32 v4, v24 offset:4752
    ds_write_b32 v4, v52 offset:4756
    ds_write_b32 v4, v20 offset:5016
    ds_write_b32 v4, v68 offset:5020
    ds_write_b32 v4, v36 offset:5280
    ds_write_b32 v4, v50 offset:5284
    ds_write_b32 v4, v18 offset:5544
    ds_write_b32 v4, v66 offset:5548
    ds_write_b32 v4, v34 offset:5808
    ds_write_b32 v4, v58 offset:5812
    ds_write_b32 v4, v26 offset:6072
    ds_write_b32 v4, v74 offset:6076
    ds_write_b32 v4, v42 offset:6336
    ds_write_b32 v4, v49 offset:6340
    ds_write_b32 v4, v17 offset:6600
    ds_write_b32 v4, v65 offset:6604
    ds_write_b32 v4, v33 offset:6864
    ds_write_b32 v4, v57 offset:6868
    ds_write_b32 v4, v25 offset:7128
    ds_write_b32 v4, v73 offset:7132
    ds_write_b32 v4, v41 offset:7392
    ds_write_b32 v4, v53 offset:7396
    ds_write_b32 v4, v21 offset:7656
    ds_write_b32 v4, v69 offset:7660
    ds_write_b32 v4, v37 offset:7920
    ds_write_b32 v4, v61 offset:7924
    ds_write_b32 v4, v29 offset:8184
    ds_write_b32 v4, v77 offset:8188
    s_waitcnt lgkmcnt(0)
    ds_read_b32 v16, v5 offset:0
    ds_read_b32 v48, v5 offset:4
    ds_read_b32 v83, v5 offset:8
    ds_read_b32 v81, v5 offset:12
    ds_read_b32 v80, v5 offset:16
    ds_read_b32 v72, v5 offset:20
    ds_read_b32 v40, v5 offset:24
    ds_read_b32 v60, v5 offset:28
    ds_read_b32 v28, v5 offset:32
    ds_read_b32 v76, v5 offset:36
    ds_read_b32 v44, v5 offset:40
    ds_read_b32 v62, v5 offset:44
    ds_read_b32 v30, v5 offset:48
    ds_read_b32 v54, v5 offset:52
    s_waitcnt lgkmcnt(0)
    ds_read_b32 v22, v5 offset:56
    ds_read_b32 v70, v5 offset:60
    ds_read_b32 v38, v5 offset:64
    ds_read_b32 v78, v5 offset:68
    ds_read_b32 v46, v5 offset:72
    ds_read_b32 v63, v5 offset:76
    ds_read_b32 v31, v5 offset:80
    ds_read_b32 v55, v5 offset:84
    ds_read_b32 v23, v5 offset:88
    ds_read_b32 v71, v5 offset:92
    ds_read_b32 v39, v5 offset:96
    ds_read_b32 v51, v5 offset:100
    ds_read_b32 v19, v5 offset:104
    ds_read_b32 v67, v5 offset:108
    s_waitcnt lgkmcnt(0)
    ds_read_b32 v35, v5 offset:112
    ds_read_b32 v59, v5 offset:116
    ds_read_b32 v27, v5 offset:120
    ds_read_b32 v75, v5 offset:124
    ds_read_b32 v43, v5 offset:128
    ds_read_b32 v79, v5 offset:132
    ds_read_b32 v47, v5 offset:136
    ds_read_b32 v56, v5 offset:140
    ds_read_b32 v24, v5 offset:144
    ds_read_b32 v52, v5 offset:148
    ds_read_b32 v20, v5 offset:152
    ds_read_b32 v68, v5 offset:156
    ds_read_b32 v36, v5 offset:160
    ds_read_b32 v50, v5 offset:164
    s_waitcnt lgkmcnt(0)
    ds_read_b32 v18, v5 offset:168
    ds_read_b32 v66, v5 offset:172
    ds_read_b32 v34, v5 offset:176
    ds_read_b32 v58, v5 offset:180
    ds_read_b32 v26, v5 offset:184
    ds_read_b32 v74, v5 offset:188
    ds_read_b32 v42, v5 offset:192
    ds_read_b32 v49, v5 offset:196
    ds_read_b32 v17, v5 offset:200
    ds_read_b32 v65, v5 offset:204
    ds_read_b32 v33, v5 offset:208
    ds_read_b32 v57, v5 offset:212
    ds_read_b32 v25, v5 offset:216
    ds_read_b32 v73, v5 offset:220
    s_waitcnt lgkmcnt(0)
    ds_read_b32 v41, v5 offset:224
    ds_read_b32 v53, v5 offset:228
    ds_read_b32 v21, v5 offset:232
    ds_read_b32 v69, v5 offset:236
    ds_read_b32 v37, v5 offset:240
    ds_read_b32 v61, v5 offset:244
    ds_read_b32 v29, v5 offset:248
    ds_read_b32 v77, v5 offset:252
    s_waitcnt lgkmcnt(0)
    v_sub_f32 v32, v16, v43
    v_sub_f32 v64, v48, v79
    v_add_f32 v16, v16, v43
    v_add_f32 v48, v48, v79
    v_sub_f32 v43, v83, v47
    v_sub_f32 v79, v81, v56
    v_add_f32 v83, v83, v47
    v_add_f32 v81, v81, v56
    v_mul_f32 v47, 0x3f7b14be, v43
    v_mul_f32 v56, 0xbe47c5c2, v43
    v_fmac_f32 v47, 0x3e47c5c2, v79
    v_fmac_f32 v56, 0x3f7b14be, v79
    v_sub_f32 v43, v80, v24
    v_sub_f32 v79, v72, v52
    v_add_f32 v80, v80, v24
    v_add_f32 v72, v72, v52
    v_mul_f32 v24, 0x3f6c835e, v43
    v_mul_f32 v52, 0xbec3ef15, v43
    v_fmac_f32 v24, 0x3ec3ef15, v79
    v_fmac_f32 v52, 0x3f6c835e, v79
    v_sub_f32 v43, v40, v20
    v_sub_f32 v79, v60, v68
    v_add_f32 v40, v40, v20
    v_add_f32 v60, v60, v68
    v_mul_f32 v20, 0x3f54db31, v43
    v_mul_f32 v68, 0xbf0e39da, v43
    v_fmac_f32 v20, 0x3f0e39da, v79
    v_fmac_f32 v68, 0x3f54db31, v79
    v_sub_f32 v43, v28, v36
    v_sub_f32 v79, v76, v50
    v_add_f32 v28, v28, v36
    v_add_f32 v76, v76, v50
    v_mul_f32 v36, 0x3f3504f3, v43
    v_mul_f32 v50, 0xbf3504f3, v43
    v_fmac_f32 v36, 0x3f3504f3, v79
    v_fmac_f32 v50, 0x3f3504f3, v79
    v_sub_f32 v43, v44, v18
    v_sub_f32 v79, v62, v66
    v_add_f32 v44, v44, v18
    v_add_f32 v62, v62, v66
    v_mul_f32 v18, 0x3f0e39da, v43
    v_mul_f32 v66, 0xbf54db31, v43
    v_fmac_f32 v18, 0x3f54db31, v79
    v_fmac_f32 v66, 0x3f0e39da, v79
    v_sub_f32 v43, v30, v34
    v_sub_f32 v79, v54, v58
    v_add_f32 v30, v30, v34
    v_add_f32 v54, v54, v58
    v_mul_f32 v34, 0x3ec3ef15, v43
    v_mul_f32 v58, 0xbf6c835e, v43
    v_fmac_f32 v34, 0x3f6c835e, v79
    v_fmac_f32 v58, 0x3ec3ef15, v79
    v_sub_f32 v43, v22, v26
    v_sub_f32 v79, v70, v74
    v_add_f32 v22, v22, v26
    v_add_f32 v70, v70, v74
    v_mul_f32 v26, 0x3e47c5c2, v43
    v_mul_f32 v74, 0xbf7b14be, v43
    v_fmac_f32 v26, 0x3f7b14be, v79
    v_fmac_f32 v74, 0x3e47c5c2, v79
    v_sub_f32 v43, v78, v49
    v_sub_f32 v79, v42, v38
    v_add_f32 v38, v38, v42
    v_add_f32 v78, v78, v49
    v_sub_f32 v42, v46, v17
    v_sub_f32 v49, v63, v65
    v_add_f32 v46, v46, v17
    v_add_f32 v63, v63, v65
    v_mul_f32 v17, 0xbe47c5c2, v42
    v_mul_f32 v65, 0xbf7b14be, v42
    v_fmac_f32 v17, 0x3f7b14be, v49
    v_fmac_f32 v65, 0xbe47c5c2, v49
    v_sub_f32 v42, v31, v33
    v_sub_f32 v49, v55, v57
    v_add_f32 v31, v31, v33
    v_add_f32 v55, v55, v57
    v_mul_f32 v33, 0xbec3ef15, v42
    v_mul_f32 v57, 0xbf6c835e, v42
    v_fmac_f32 v33, 0x3f6c835e, v49
    v_fmac_f32 v57, 0xbec3ef15, v49
    v_sub_f32 v42, v23, v25
    v_sub_f32 v49, v71, v73
    v_add_f32 v23, v23, v25
    v_add_f32 v71, v71, v73
    v_mul_f32 v25, 0xbf0e39da, v42
    v_mul_f32 v73, 0xbf54db31, v42
    v_fmac_f32 v25, 0x3f54db31, v49
    v_fmac_f32 v73, 0xbf0e39da, v49
    v_sub_f32 v42, v39, v41
    v_sub_f32 v49, v51, v53
    v_add_f32 v39, v39, v41
    v_add_f32 v51, v51, v53
    v_mul_f32 v41, 0xbf3504f3, v42
    v_mul_f32 v53, 0xbf3504f3, v42
    v_fmac_f32 v41, 0x3f3504f3, v49
    v_fmac_f32 v53, 0xbf3504f3, v49
    v_sub_f32 v42, v19, v21
    v_sub_f32 v49, v67, v69
    v_add_f32 v19, v19, v21
    v_add_f32 v67, v67, v69
    v_mul_f32 v21, 0xbf54db31, v42
    v_mul_f32 v69, 0xbf0e39da, v42
    v_fmac_f32 v21, 0x3f0e39da, v49
    v_fmac_f32 v69, 0xbf54db31, v49
    v_sub_f32 v42, v35, v37
    v_sub_f32 v49, v59, v61
    v_add_f32 v35, v35, v37
    v_add_f32 v59, v59, v61
    v_mul_f32 v37, 0xbf6c835e, v42
    v_mul_f32 v61, 0xbec3ef15, v42
    v_fmac_f32 v37, 0x3ec3ef15, v49
    v_fmac_f32 v61, 0xbf6c835e, v49
    v_sub_f32 v42, v27, v29
    v_sub_f32 v49, v75, v77
    v_add_f32 v27, v27, v29
    v_add_f32 v75, v75, v77
    v_mul_f32 v29, 0xbf7b14be, v42
    v_mul_f32 v77, 0xbe47c5c2, v42
    v_fmac_f32 v29, 0x3e47c5c2, v49
    v_fmac_f32 v77, 0xbf7b14be, v49
    v_sub_f32 v42, v16, v38
    v_sub_f32 v49, v48, v78
    v_add_f32 v16, v16, v38
    v_add_f32 v48, v48, v78
    v_sub_f32 v38, v83, v46
    v_sub_f32 v78, v81, v63
    v_add_f32 v83, v83, v46
    v_add_f32 v81, v81, v63
    v_mul_f32 v46, 0x3f6c835e, v38
    v_mul_f32 v63, 0xbec3ef15, v38
    v_fmac_f32 v46, 0x3ec3ef15, v78
    v_fmac_f32 v63, 0x3f6c835e, v78
    v_sub_f32 v38, v80, v31
    v_sub_f32 v78, v72, v55
    v_add_f32 v80, v80, v31
    v_add_f32 v72, v72, v55
    v_mul_f32 v31, 0x3f3504f3, v38
    v_mul_f32 v55, 0xbf3504f3, v38
    v_fmac_f32 v31, 0x3f3504f3, v78
    v_fmac_f32 v55, 0x3f3504f3, v78
    v_sub_f32 v38, v40, v23
    v_sub_f32 v78, v60, v71
    v_add_f32 v40, v40, v23
    v_add_f32 v60, v60, v71
    v_mul_f32 v23, 0x3ec3ef15, v38
    v_mul_f32 v71, 0xbf6c835e, v38
    v_fmac_f32 v23, 0x3f6c835e, v78
    v_fmac_f32 v71, 0x3ec3ef15, v78
    v_sub_f32 v38, v76, v51
    v_sub_f32 v78, v39, v28
    v_add_f32 v28, v28, v39
    v_add_f32 v76, v76, v51
    v_sub_f32 v39, v44, v19
    v_sub_f32 v51, v62, v67
    v_add_f32 v44, v44, v19
    v_add_f32 v62, v62, v67
    v_mul_f32 v19, 0xbec3ef15, v39
    v_mul_f32 v67, 0xbf6c835e, v39
    v_fmac_f32 v19, 0x3f6c835e, v51
    v_fmac_f32 v67, 0xbec3ef15, v51
    v_sub_f32 v39, v30, v35
    v_sub_f32 v51, v54, v59
    v_add_f32 v30, v30, v35
    v_add_f32 v54, v54, v59
    v_mul_f32 v35, 0xbf3504f3, v39
    v_mul_f32 v59, 0xbf3504f3, v39
    v_fmac_f32 v35, 0x3f3504f3, v51
    v_fmac_f32 v59, 0xbf3504f3, v51
    v_sub_f32 v39, v22, v27
    v_sub_f32 v51, v70, v75
    v_add_f32 v22, v22, v27
    v_add_f32 v70, v70, v75
    v_mul_f32 v27, 0xbf6c835e, v39
    v_mul_f32 v75, 0xbec3ef15, v39
    v_fmac_f32 v27, 0x3ec3ef15, v51
    v_fmac_f32 v75, 0xbf6c835e, v51
    v_sub_f32 v39, v32, v43
    v_sub_f32 v51, v64, v79
    v_add_f32 v32, v32, v43
    v_add_f32 v64, v64, v79
    v_sub_f32 v43, v47, v17
    v_sub_f32 v79, v56, v65
    v_add_f32 v47, v47, v17
    v_add_f32 v56, v56, v65
    v_mul_f32 v17, 0x3f6c835e, v43
    v_mul_f32 v65, 0xbec3ef15, v43
    v_fmac_f32 v17, 0x3ec3ef15, v79
    v_fmac_f32 v65, 0x3f6c835e, v79
    v_sub_f32 v43, v24, v33
    v_sub_f32 v79, v52, v57
    v_add_f32 v24, v24, v33
    v_add_f32 v52, v52, v57
    v_mul_f32 v33, 0x3f3504f3, v43
    v_mul_f32 v57, 0xbf3504f3, v43
    v_fmac_f32 v33, 0x3f3504f3, v79
    v_fmac_f32 v57, 0x3f3504f3, v79
    v_sub_f32 v43, v20, v25
    v_sub_f32 v79, v68, v73
    v_add_f32 v20, v20, v25
    v_add_f32 v68, v68, v73
    v_mul_f32 v25, 0x3ec3ef15, v43
    v_mul_f32 v73, 0xbf6c835e, v43
    v_fmac_f32 v25, 0x3f6c835e, v79
    v_fmac_f32 v73, 0x3ec3ef15, v79
    v_sub_f32 v43, v50, v53
    v_sub_f32 v79, v41, v36
    v_add_f32 v36, v36, v41
    v_add_f32 v50, v50, v53
    v_sub_f32 v41, v18, v21
    v_sub_f32 v53, v66, v69
    v_add_f32 v18, v18, v21
    v_add_f32 v66, v66, v69
    v_mul_f32 v21, 0xbec3ef15, v41
    v_mul_f32 v69, 0xbf6c835e, v41
    v_fmac_f32 v21, 0x3f6c835e, v53
    v_fmac_f32 v69, 0xbec3ef15, v53
    v_sub_f32 v41, v34, v37
    v_sub_f32 v53, v58, v61
    v_add_f32 v34, v34, v37
    v_add_f32 v58, v58, v61
    v_mul_f32 v37, 0xbf3504f3, v41
    v_mul_f32 v61, 0xbf3504f3, v41
    v_fmac_f32 v37, 0x3f3504f3, v53
    v_fmac_f32 v61, 0xbf3504f3, v53
    v_sub_f32 v41, v26, v29
    v_sub_f32 v53, v74, v77
    v_add_f32 v26, v26, v29
    v_add_f32 v74, v74, v77
    v_mul_f32 v29, 0xbf6c835e, v41
    v_mul_f32 v77, 0xbec3ef15, v41
    v_fmac_f32 v29, 0x3ec3ef15, v53
    v_fmac_f32 v77, 0xbf6c835e, v53
    v_sub_f32 v41, v16, v28
    v_sub_f32 v53, v48, v76
    v_add_f32 v16, v16, v28
    v_add_f32 v48, v48, v76
    v_sub_f32 v28, v83, v44
    v_sub_f32 v76, v81, v62
    v_add_f32 v83, v83, v44
    v_add_f32 v81, v81, v62
    v_mul_f32 v44, 0x3f3504f3, v28
    v_mul_f32 v62, 0xbf3504f3, v28
    v_fmac_f32 v44, 0x3f3504f3, v76
    v_fmac_f32 v62, 0x3f3504f3, v76
    v_sub_f32 v28, v72, v54
    v_sub_f32 v76, v30, v80
    v_add_f32 v80, v80, v30
    v_add_f32 v72, v72, v54
    v_sub_f32 v30, v40, v22
    v_sub_f32 v54, v60, v70
    v_add_f32 v40, v40, v22
    v_add_f32 v60, v60, v70
    v_mul_f32 v22, 0xbf3504f3, v30
    v_mul_f32 v70, 0xbf3504f3, v30
    v_fmac_f32 v22, 0x3f3504f3, v54
    v_fmac_f32 v70, 0xbf3504f3, v54
    v_sub_f32 v30, v42, v38
    v_sub_f32 v54, v49, v78
    v_add_f32 v42, v42, v38
    v_add_f32 v49, v49, v78
    v_sub_f32 v38, v46, v19
    v_sub_f32 v78, v63, v67
    v_add_f32 v46, v46, v19
    v_add_f32 v63, v63, v67
    v_mul_f32 v19, 0x3f3504f3, v38
    v_mul_f32 v67, 0xbf3504f3, v38
    v_fmac_f32 v19, 0x3f3504f3, v78
    v_fmac_f32 v67, 0x3f3504f3, v78
    v_sub_f32 v38, v55, v59
    v_sub_f32 v78, v35, v31
    v_add_f32 v31, v31, v35
    v_add_f32 v55, v55, v59
    v_sub_f32 v35, v23, v27
    v_sub_f32 v59, v71, v75
    v_add_f32 v23, v23, v27
    v_add_f32 v71, v71, v75
    v_mul_f32 v27, 0xbf3504f3, v35
    v_mul_f32 v75, 0xbf3504f3, v35
    v_fmac_f32 v27, 0x3f3504f3, v59
    v_fmac_f32 v75, 0xbf3504f3, v59
    v_sub_f32 v35, v32, v36
    v_sub_f32 v59, v64, v50
    v_add_f32 v32, v32, v36
    v_add_f32 v64, v64, v50
    v_sub_f32 v36, v47, v18
    v_sub_f32 v50, v56, v66
    v_add_f32 v47, v47, v18
    v_add_f32 v56, v56, v66
    v_mul_f32 v18, 0x3f3504f3, v36
    v_mul_f32 v66, 0xbf3504f3, v36
    v_fmac_f32 v18, 0x3f3504f3, v50
    v_fmac_f32 v66, 0x3f3504f3, v50
    v_sub_f32 v36, v52, v58
    v_sub_f32 v50, v34, v24
    v_add_f32 v24, v24, v34
    v_add_f32 v52, v52, v58
    v_sub_f32 v34, v20, v26
    v_sub_f32 v58, v68, v74
    v_add_f32 v20, v20, v26
    v_add_f32 v68, v68, v74
    v_mul_f32 v26, 0xbf3504f3, v34
    v_mul_f32 v74, 0xbf3504f3, v34
    v_fmac_f32 v26, 0x3f3504f3, v58
    v_fmac_f32 v74, 0xbf3504f3, v58
    v_sub_f32 v34, v39, v43
    v_sub_f32 v58, v51, v79
    v_add_f32 v39, v39, v43
    v_add_f32 v51, v51, v79
    v_sub_f32 v43, v17, v21
    v_sub_f32 v79, v65, v69
    v_add_f32 v17, v17, v21
    v_add_f32 v65, v65, v69
    v_mul_f32 v21, 0x3f3504f3, v43
    v_mul_f32 v69, 0xbf3504f3, v43
    v_fmac_f32 v21, 0x3f3504f3, v79
    v_fmac_f32 v69, 0x3f3504f3, v79
    v_sub_f32 v43, v57, v61
    v_sub_f32 v79, v37, v33
    v_add_f32 v33, v33, v37
    v_add_f32 v57, v57, v61
    v_sub_f32 v37, v25, v29
    v_sub_f32 v61, v73, v77
    v_add_f32 v25, v25, v29
    v_add_f32 v73, v73, v77
    v_mul_f32 v29, 0xbf3504f3, v37
    v_mul_f32 v77, 0xbf3504f3, v37
    v_fmac_f32 v29, 0x3f3504f3, v61
    v_fmac_f32 v77, 0xbf3504f3, v61
    v_sub_f32 v37, v16, v80
    v_sub_f32 v61, v48, v72
    v_add_f32 v16, v16, v80
    v_add_f32 v48, v48, v72
    v_sub_f32 v80, v81, v60
    v_sub_f32 v72, v40, v83
    v_add_f32 v83, v83, v40
    v_add_f32 v81, v81, v60
    v_sub_f32 v40, v41, v28
    v_sub_f32 v60, v53, v76
    v_add_f32 v41, v41, v28
    v_add_f32 v53, v53, v76
    v_sub_f32 v28, v62, v70
    v_sub_f32 v76, v22, v44
    v_add_f32 v44, v44, v22
    v_add_f32 v62, v62, v70
    v_sub_f32 v22, v42, v31
    v_sub_f32 v70, v49, v55
    v_add_f32 v42, v42, v31
    v_add_f32 v49, v49, v55
    v_sub_f32 v31, v63, v71
    v_sub_f32 v55, v23, v46
    v_add_f32 v46, v46, v23
    v_add_f32 v63, v63, v71
    v_sub_f32 v23, v30, v38
    v_sub_f32 v71, v54, v78
    v_add_f32 v30, v30, v38
    v_add_f32 v54, v54, v78
    v_sub_f32 v38, v67, v75
    v_sub_f32 v78, v27, v19
    v_add_f32 v19, v19, v27
    v_add_f32 v67, v67, v75
    v_sub_f32 v27, v32, v24
    v_sub_f32 v75, v64, v52
    v_add_f32 v32, v32, v24
    v_add_f32 v64, v64, v52
    v_sub_f32 v24, v56, v68
    v_sub_f32 v52, v20, v47
    v_add_f32 v47, v47, v20
    v_add_f32 v56, v56, v68
    v_sub_f32 v20, v35, v36
    v_sub_f32 v68, v59, v50
    v_add_f32 v35, v35, v36
    v_add_f32 v59, v59, v50
    v_sub_f32 v36, v66, v74
    v_sub_f32 v50, v26, v18
    v_add_f32 v18, v18, v26
    v_add_f32 v66, v66, v74
    v_sub_f32 v26, v39, v33
    v_sub_f32 v74, v51, v57
    v_add_f32 v39, v39, v33
    v_add_f32 v51, v51, v57
    v_sub_f32 v33, v65, v73
    v_sub_f32 v57, v25, v17
    v_add_f32 v17, v17, v25
    v_add_f32 v65, v65, v73
    v_sub_f32 v25, v34, v43
    v_sub_f32 v73, v58, v79
    v_add_f32 v34, v34, v43
    v_add_f32 v58, v58, v79
    v_sub_f32 v43, v69, v77
    v_sub_f32 v79, v29, v21
    v_add_f32 v21, v21, v29
    v_add_f32 v69, v69, v77
    v_sub_f32 v29, v16, v83
    v_sub_f32 v77, v48, v81
    v_add_f32 v16, v16, v83
    v_add_f32 v48, v48, v81
    v_sub_f32 v83, v37, v80
    v_sub_f32 v81, v61, v72
    v_add_f32 v37, v37, v80
    v_add_f32 v61, v61, v72
    v_sub_f32 v80, v41, v44
    v_sub_f32 v72, v53, v62
    v_add_f32 v41, v41, v44
    v_add_f32 v53, v53, v62
    v_sub_f32 v44, v40, v28
    v_sub_f32 v62, v60, v76
    v_add_f32 v40, v40, v28
    v_add_f32 v60, v60, v76
    v_sub_f32 v28, v42, v46
    v_sub_f32 v76, v49, v63
    v_add_f32 v42, v42, v46
    v_add_f32 v49, v49, v63
    v_sub_f32 v46, v22, v31
    v_sub_f32 v63, v70, v55
    v_add_f32 v22, v22, v31
    v_add_f32 v70, v70, v55
    v_sub_f32 v31, v30, v19
    v_sub_f32 v55, v54, v67
    v_add_f32 v30, v30, v19
    v_add_f32 v54, v54, v67
    v_sub_f32 v19, v23, v38
    v_sub_f32 v67, v71, v78
    v_add_f32 v23, v23, v38
    v_add_f32 v71, v71, v78
    v_sub_f32 v38, v32, v47
    v_sub_f32 v78, v64, v56
    v_add_f32 v32, v32, v47
    v_add_f32 v64, v64, v56
    v_sub_f32 v47, v27, v24
    v_sub_f32 v56, v75, v52
    v_add_f32 v27, v27, v24
    v_add_f32 v75, v75, v52
    v_sub_f32 v24, v35, v18
    v_sub_f32 v52, v59, v66
    v_add_f32 v35, v35, v18
    v_add_f32 v59, v59, v66
    v_sub_f32 v18, v20, v36
    v_sub_f32 v66, v68, v50
    v_add_f32 v20, v20, v36
    v_add_f32 v68, v68, v50
    v_sub_f32 v36, v39, v17
    v_sub_f32 v50, v51, v65
    v_add_f32 v39, v39, v17
    v_add_f32 v51, v51, v65
    v_sub_f32 v17, v26, v33
    v_sub_f32 v65, v74, v57
    v_add_f32 v26, v26, v33
    v_add_f32 v74, v74, v57
    v_sub_f32 v33, v34, v21
    v_sub_f32 v57, v58, v69
    v_add_f32 v34, v34, v21
    v_add_f32 v58, v58, v69
    v_sub_f32 v21, v25, v43
    v_sub_f32 v69, v73, v79
    v_add_f32 v25, v25, v43
    v_add_f32 v73, v73, v79
    ds_write_b32 v4, v16 offset:0
    ds_write_b32 v4, v48 offset:4
    ds_write_b32 v4, v32 offset:256
    ds_write_b32 v4, v64 offset:260
    ds_write_b32 v4, v42 offset:512
    ds_write_b32 v4, v49 offset:516
    ds_write_b32 v4, v39 offset:768
    ds_write_b32 v4, v51 offset:772
    ds_write_b32 v4, v41 offset:1024
    ds_write_b32 v4, v53 offset:1028
    ds_write_b32 v4, v35 offset:1280
    ds_write_b32 v4, v59 offset:1284
    ds_write_b32 v4, v30 offset:1536
    ds_write_b32 v4, v54 offset:1540
    ds_write_b32 v4, v34 offset:1792
    ds_write_b32 v4, v58 offset:1796
    ds_write_b32 v4, v37 offset:2048
    ds_write_b32 v4, v61 offset:2052
    ds_write_b32 v4, v27 offset:2304
    ds_write_b32 v4, v75 offset:2308
    ds_write_b32 v4, v22 offset:2560
    ds_write_b32 v4, v70 offset:2564
    ds_write_b32 v4, v26 offset:2816
    ds_write_b32 v4, v74 offset:2820
    ds_write_b32 v4, v40 offset:3072
    ds_write_b32 v4, v60 offset:3076
    ds_write_b32 v4, v20 offset:3328
    ds_write_b32 v4, v68 offset:3332
    ds_write_b32 v4, v23 offset:3584
    ds_write_b32 v4, v71 offset:3588
    ds_write_b32 v4, v25 offset:3840
    ds_write_b32 v4, v73 offset:3844
    ds_write_b32 v4, v29 offset:4096
    ds_write_b32 v4, v77 offset:4100
    ds_write_b32 v4, v38 offset:4352
    ds_write_b32 v4, v78 offset:4356
    ds_write_b32 v4, v28 offset:4608
    ds_write_b32 v4, v76 offset:4612
    ds_write_b32 v4, v36 offset:4864
    ds_write_b32 v4, v50 offset:4868
    ds_write_b32 v4, v80 offset:5120
    ds_write_b32 v4, v72 offset:5124
    ds_write_b32 v4, v24 offset:5376
    ds_write_b32 v4, v52 offset:5380
    ds_write_b32 v4, v31 offset:5632
    ds_write_b32 v4, v55 offset:5636
    ds_write_b32 v4, v33 offset:5888
    ds_write_b32 v4, v57 offset:5892
    ds_write_b32 v4, v83 offset:6144
    ds_write_b32 v4, v81 offset:6148
    ds_write_b32 v4, v47 offset:6400
    ds_write_b32 v4, v56 offset:6404
    ds_write_b32 v4, v46 offset:6656
    ds_write_b32 v4, v63 offset:6660
    ds_write_b32 v4, v17 offset:6912
    ds_write_b32 v4, v65 offset:6916
    ds_write_b32 v4, v44 offset:7168
    ds_write_b32 v4, v62 offset:7172
    ds_write_b32 v4, v18 offset:7424
    ds_write_b32 v4, v66 offset:7428
    ds_write_b32 v4, v19 offset:7680
    ds_write_b32 v4, v67 offset:7684
    ds_write_b32 v4, v21 offset:7936
    ds_write_b32 v4, v69 offset:7940
    s_waitcnt lgkmcnt(0)
    s_barrier
    v_and_b32 v6, 7, v0
    v_lshrrev_b32 v7, 3, v0
    s_movk_i32 s13, 8448
    v_mul_lo_u32 v8, v6, s13
    v_lshl_add_u32 v4, v7, 3, v8
    v_lshlrev_b32 v5, 14, v7
    v_lshl_add_u32 v5, v6, 4, v5
    s_lshl_b32 s12, s92, 7
    s_add_u32 s12, s12, 96468992
    v_sub_u32 v6, 1024, v7
    v_and_b32 v6, 1023, v6
    v_lshl_add_u32 v6, v6, 3, v8
    ds_read_b64 v[16:17], v4 offset:0
    ds_read_b64 v[18:19], v6
    s_waitcnt lgkmcnt(0)
    v_add_f32 v20, v16, v18
    v_sub_f32 v21, v17, v19
    v_add_f32 v22, v17, v19
    v_sub_f32 v23, v18, v16
    s_mov_b32 s13, s12
    s_add_u32 s13, s12, 0
    buffer_store_dwordx4 v[20:23], v5, s[8:11], s13 offen sc1
    s_nop 1
    v_sub_u32 v6, 992, v7
    v_and_b32 v6, 1023, v6
    v_lshl_add_u32 v6, v6, 3, v8
    ds_read_b64 v[16:17], v4 offset:256
    ds_read_b64 v[18:19], v6
    s_waitcnt lgkmcnt(0)
    v_add_f32 v20, v16, v18
    v_sub_f32 v21, v17, v19
    v_add_f32 v22, v17, v19
    v_sub_f32 v23, v18, v16
    s_mov_b32 s13, s12
    s_add_u32 s13, s12, 524288
    buffer_store_dwordx4 v[20:23], v5, s[8:11], s13 offen sc1
    s_nop 1
    v_sub_u32 v6, 960, v7
    v_and_b32 v6, 1023, v6
    v_lshl_add_u32 v6, v6, 3, v8
    ds_read_b64 v[16:17], v4 offset:512
    ds_read_b64 v[18:19], v6
    s_waitcnt lgkmcnt(0)
    v_add_f32 v20, v16, v18
    v_sub_f32 v21, v17, v19
    v_add_f32 v22, v17, v19
    v_sub_f32 v23, v18, v16
    s_mov_b32 s13, s12
    s_add_u32 s13, s12, 1048576
    buffer_store_dwordx4 v[20:23], v5, s[8:11], s13 offen sc1
    s_nop 1
    v_sub_u32 v6, 928, v7
    v_and_b32 v6, 1023, v6
    v_lshl_add_u32 v6, v6, 3, v8
    ds_read_b64 v[16:17], v4 offset:768
    ds_read_b64 v[18:19], v6
    s_waitcnt lgkmcnt(0)
    v_add_f32 v20, v16, v18
    v_sub_f32 v21, v17, v19
    v_add_f32 v22, v17, v19
    v_sub_f32 v23, v18, v16
    s_mov_b32 s13, s12
    s_add_u32 s13, s12, 1572864
    buffer_store_dwordx4 v[20:23], v5, s[8:11], s13 offen sc1
    s_nop 1
    v_sub_u32 v6, 896, v7
    v_and_b32 v6, 1023, v6
    v_lshl_add_u32 v6, v6, 3, v8
    ds_read_b64 v[16:17], v4 offset:1024
    ds_read_b64 v[18:19], v6
    s_waitcnt lgkmcnt(0)
    v_add_f32 v20, v16, v18
    v_sub_f32 v21, v17, v19
    v_add_f32 v22, v17, v19
    v_sub_f32 v23, v18, v16
    s_mov_b32 s13, s12
    s_add_u32 s13, s12, 2097152
    buffer_store_dwordx4 v[20:23], v5, s[8:11], s13 offen sc1
    s_nop 1
    v_sub_u32 v6, 864, v7
    v_and_b32 v6, 1023, v6
    v_lshl_add_u32 v6, v6, 3, v8
    ds_read_b64 v[16:17], v4 offset:1280
    ds_read_b64 v[18:19], v6
    s_waitcnt lgkmcnt(0)
    v_add_f32 v20, v16, v18
    v_sub_f32 v21, v17, v19
    v_add_f32 v22, v17, v19
    v_sub_f32 v23, v18, v16
    s_mov_b32 s13, s12
    s_add_u32 s13, s12, 2621440
    buffer_store_dwordx4 v[20:23], v5, s[8:11], s13 offen sc1
    s_nop 1
    v_sub_u32 v6, 832, v7
    v_and_b32 v6, 1023, v6
    v_lshl_add_u32 v6, v6, 3, v8
    ds_read_b64 v[16:17], v4 offset:1536
    ds_read_b64 v[18:19], v6
    s_waitcnt lgkmcnt(0)
    v_add_f32 v20, v16, v18
    v_sub_f32 v21, v17, v19
    v_add_f32 v22, v17, v19
    v_sub_f32 v23, v18, v16
    s_mov_b32 s13, s12
    s_add_u32 s13, s12, 3145728
    buffer_store_dwordx4 v[20:23], v5, s[8:11], s13 offen sc1
    s_nop 1
    v_sub_u32 v6, 800, v7
    v_and_b32 v6, 1023, v6
    v_lshl_add_u32 v6, v6, 3, v8
    ds_read_b64 v[16:17], v4 offset:1792
    ds_read_b64 v[18:19], v6
    s_waitcnt lgkmcnt(0)
    v_add_f32 v20, v16, v18
    v_sub_f32 v21, v17, v19
    v_add_f32 v22, v17, v19
    v_sub_f32 v23, v18, v16
    s_mov_b32 s13, s12
    s_add_u32 s13, s12, 3670016
    buffer_store_dwordx4 v[20:23], v5, s[8:11], s13 offen sc1
    s_nop 1
    v_sub_u32 v6, 768, v7
    v_and_b32 v6, 1023, v6
    v_lshl_add_u32 v6, v6, 3, v8
    ds_read_b64 v[16:17], v4 offset:2048
    ds_read_b64 v[18:19], v6
    s_waitcnt lgkmcnt(0)
    v_add_f32 v20, v16, v18
    v_sub_f32 v21, v17, v19
    v_add_f32 v22, v17, v19
    v_sub_f32 v23, v18, v16
    s_mov_b32 s13, s12
    s_add_u32 s13, s12, 4194304
    buffer_store_dwordx4 v[20:23], v5, s[8:11], s13 offen sc1
    s_nop 1
    v_sub_u32 v6, 736, v7
    v_and_b32 v6, 1023, v6
    v_lshl_add_u32 v6, v6, 3, v8
    ds_read_b64 v[16:17], v4 offset:2304
    ds_read_b64 v[18:19], v6
    s_waitcnt lgkmcnt(0)
    v_add_f32 v20, v16, v18
    v_sub_f32 v21, v17, v19
    v_add_f32 v22, v17, v19
    v_sub_f32 v23, v18, v16
    s_mov_b32 s13, s12
    s_add_u32 s13, s12, 4718592
    buffer_store_dwordx4 v[20:23], v5, s[8:11], s13 offen sc1
    s_nop 1
    v_sub_u32 v6, 704, v7
    v_and_b32 v6, 1023, v6
    v_lshl_add_u32 v6, v6, 3, v8
    ds_read_b64 v[16:17], v4 offset:2560
    ds_read_b64 v[18:19], v6
    s_waitcnt lgkmcnt(0)
    v_add_f32 v20, v16, v18
    v_sub_f32 v21, v17, v19
    v_add_f32 v22, v17, v19
    v_sub_f32 v23, v18, v16
    s_mov_b32 s13, s12
    s_add_u32 s13, s12, 5242880
    buffer_store_dwordx4 v[20:23], v5, s[8:11], s13 offen sc1
    s_nop 1
    v_sub_u32 v6, 672, v7
    v_and_b32 v6, 1023, v6
    v_lshl_add_u32 v6, v6, 3, v8
    ds_read_b64 v[16:17], v4 offset:2816
    ds_read_b64 v[18:19], v6
    s_waitcnt lgkmcnt(0)
    v_add_f32 v20, v16, v18
    v_sub_f32 v21, v17, v19
    v_add_f32 v22, v17, v19
    v_sub_f32 v23, v18, v16
    s_mov_b32 s13, s12
    s_add_u32 s13, s12, 5767168
    buffer_store_dwordx4 v[20:23], v5, s[8:11], s13 offen sc1
    s_nop 1
    v_sub_u32 v6, 640, v7
    v_and_b32 v6, 1023, v6
    v_lshl_add_u32 v6, v6, 3, v8
    ds_read_b64 v[16:17], v4 offset:3072
    ds_read_b64 v[18:19], v6
    s_waitcnt lgkmcnt(0)
    v_add_f32 v20, v16, v18
    v_sub_f32 v21, v17, v19
    v_add_f32 v22, v17, v19
    v_sub_f32 v23, v18, v16
    s_mov_b32 s13, s12
    s_add_u32 s13, s12, 6291456
    buffer_store_dwordx4 v[20:23], v5, s[8:11], s13 offen sc1
    s_nop 1
    v_sub_u32 v6, 608, v7
    v_and_b32 v6, 1023, v6
    v_lshl_add_u32 v6, v6, 3, v8
    ds_read_b64 v[16:17], v4 offset:3328
    ds_read_b64 v[18:19], v6
    s_waitcnt lgkmcnt(0)
    v_add_f32 v20, v16, v18
    v_sub_f32 v21, v17, v19
    v_add_f32 v22, v17, v19
    v_sub_f32 v23, v18, v16
    s_mov_b32 s13, s12
    s_add_u32 s13, s12, 6815744
    buffer_store_dwordx4 v[20:23], v5, s[8:11], s13 offen sc1
    s_nop 1
    v_sub_u32 v6, 576, v7
    v_and_b32 v6, 1023, v6
    v_lshl_add_u32 v6, v6, 3, v8
    ds_read_b64 v[16:17], v4 offset:3584
    ds_read_b64 v[18:19], v6
    s_waitcnt lgkmcnt(0)
    v_add_f32 v20, v16, v18
    v_sub_f32 v21, v17, v19
    v_add_f32 v22, v17, v19
    v_sub_f32 v23, v18, v16
    s_mov_b32 s13, s12
    s_add_u32 s13, s12, 7340032
    buffer_store_dwordx4 v[20:23], v5, s[8:11], s13 offen sc1
    s_nop 1
    v_sub_u32 v6, 544, v7
    v_and_b32 v6, 1023, v6
    v_lshl_add_u32 v6, v6, 3, v8
    ds_read_b64 v[16:17], v4 offset:3840
    ds_read_b64 v[18:19], v6
    s_waitcnt lgkmcnt(0)
    v_add_f32 v20, v16, v18
    v_sub_f32 v21, v17, v19
    v_add_f32 v22, v17, v19
    v_sub_f32 v23, v18, v16
    s_mov_b32 s13, s12
    s_add_u32 s13, s12, 7864320
    buffer_store_dwordx4 v[20:23], v5, s[8:11], s13 offen sc1
    s_nop 1
    v_sub_u32 v6, 512, v7
    v_and_b32 v6, 1023, v6
    v_lshl_add_u32 v6, v6, 3, v8
    ds_read_b64 v[16:17], v4 offset:4096
    ds_read_b64 v[18:19], v6
    s_waitcnt lgkmcnt(0)
    v_add_f32 v20, v16, v18
    v_sub_f32 v21, v17, v19
    v_add_f32 v22, v17, v19
    v_sub_f32 v23, v18, v16
    s_mov_b32 s13, s12
    v_cmp_eq_u32 vcc, 0, v7
    s_and_saveexec_b64 s[14:15], vcc
    s_add_u32 s13, s12, 8388608
    buffer_store_dwordx4 v[20:23], v5, s[8:11], s13 offen sc1
    s_nop 1
    s_mov_b64 exec, -1
mega_kernel_f1d:
    s_waitcnt vmcnt(0)
    s_barrier
    v_mov_b32 v2, 1
    v_cmp_eq_u32 vcc, 0, v0
    s_and_saveexec_b64 s[80:81], vcc
    s_cbranch_execz mega_kernel_sg72_4
    buffer_atomic_add v2, off, s[88:91], 0 offset:72 sc1
mega_kernel_sg72_4:
    s_mov_b64 exec, s[80:81]
    s_cmp_ge_u32 s92, 128
    s_cbranch_scc1 mega_kernel_xo
mega_kernel_wf1:
    s_sleep 8
    buffer_load_dword v2, off, s[88:91], 0 offset:72 sc1
    s_waitcnt vmcnt(0)
    v_cmp_ne_u32 vcc, 192, v2
    s_cbranch_vccnz mega_kernel_wf1
    s_mov_b32 s99, s92
mega_kernel_f2l:
    s_barrier
    s_load_dwordx2 s[8:9], s[0:1], 96
    v_lshrrev_b32 v5, 6, v0
    v_and_b32 v1, 63, v0
    v_readfirstlane_b32 s12, v5
    s_lshl_b32 s13, s99, 2
    s_add_u32 s13, s13, s12
    s_cmp_ge_u32 s13, 513
    s_cbranch_scc1 mega_kernel_f2_end
    v_cvt_f32_u32 v2, v1
    s_waitcnt lgkmcnt(0)
    s_mov_b32 s10, 268435456
    s_mov_b32 s11, 0x00020000
    s_lshl_b32 s14, s13, 14
    s_add_u32 s15, s14, 96468992
    v_lshlrev_b32 v5, 3, v1
    s_add_u32 s16, s15, 0
    buffer_load_dwordx2 v[16:17], v5, s[8:11], s16 offen
    s_add_u32 s16, s15, 512
    buffer_load_dwordx2 v[18:19], v5, s[8:11], s16 offen
    s_add_u32 s16, s15, 1024
    buffer_load_dwordx2 v[20:21], v5, s[8:11], s16 offen
    s_add_u32 s16, s15, 1536
    buffer_load_dwordx2 v[22:23], v5, s[8:11], s16 offen
    s_add_u32 s16, s15, 2048
    buffer_load_dwordx2 v[24:25], v5, s[8:11], s16 offen
    s_add_u32 s16, s15, 2560
    buffer_load_dwordx2 v[26:27], v5, s[8:11], s16 offen
    s_add_u32 s16, s15, 3072
    buffer_load_dwordx2 v[28:29], v5, s[8:11], s16 offen
    s_add_u32 s16, s15, 3584
    buffer_load_dwordx2 v[30:31], v5, s[8:11], s16 offen
    s_add_u32 s16, s15, 4096
    buffer_load_dwordx2 v[32:33], v5, s[8:11], s16 offen
    s_add_u32 s16, s15, 4608
    buffer_load_dwordx2 v[34:35], v5, s[8:11], s16 offen
    s_add_u32 s16, s15, 5120
    buffer_load_dwordx2 v[36:37], v5, s[8:11], s16 offen
    s_add_u32 s16, s15, 5632
    buffer_load_dwordx2 v[38:39], v5, s[8:11], s16 offen
    s_add_u32 s16, s15, 6144
    buffer_load_dwordx2 v[40:41], v5, s[8:11], s16 offen
    s_add_u32 s16, s15, 6656
    buffer_load_dwordx2 v[42:43], v5, s[8:11], s16 offen
    s_add_u32 s16, s15, 7168
    buffer_load_dwordx2 v[44:45], v5, s[8:11], s16 offen
    s_add_u32 s16, s15, 7680
    buffer_load_dwordx2 v[46:47], v5, s[8:11], s16 offen
    s_add_u32 s16, s15, 8192
    buffer_load_dwordx2 v[48:49], v5, s[8:11], s16 offen
    s_add_u32 s16, s15, 8704
    buffer_load_dwordx2 v[50:51], v5, s[8:11], s16 offen
    s_add_u32 s16, s15, 9216
    buffer_load_dwordx2 v[52:53], v5, s[8:11], s16 offen
    s_add_u32 s16, s15, 9728
    buffer_load_dwordx2 v[54:55], v5, s[8:11], s16 offen
    s_add_u32 s16, s15, 10240
    buffer_load_dwordx2 v[56:57], v5, s[8:11], s16 offen
    s_add_u32 s16, s15, 10752
    buffer_load_dwordx2 v[58:59], v5, s[8:11], s16 offen
    s_add_u32 s16, s15, 11264
    buffer_load_dwordx2 v[60:61], v5, s[8:11], s16 offen
    s_add_u32 s16, s15, 11776
    buffer_load_dwordx2 v[62:63], v5, s[8:11], s16 offen
    s_add_u32 s16, s15, 12288
    buffer_load_dwordx2 v[64:65], v5, s[8:11], s16 offen
    s_add_u32 s16, s15, 12800
    buffer_load_dwordx2 v[66:67], v5, s[8:11], s16 offen
    s_add_u32 s16, s15, 13312
    buffer_load_dwordx2 v[68:69], v5, s[8:11], s16 offen
    s_add_u32 s16, s15, 13824
    buffer_load_dwordx2 v[70:71], v5, s[8:11], s16 offen
    s_add_u32 s16, s15, 14336
    buffer_load_dwordx2 v[72:73], v5, s[8:11], s16 offen
    s_add_u32 s16, s15, 14848
    buffer_load_dwordx2 v[74:75], v5, s[8:11], s16 offen
    s_add_u32 s16, s15, 15360
    buffer_load_dwordx2 v[76:77], v5, s[8:11], s16 offen
    s_add_u32 s16, s15, 15872
    buffer_load_dwordx2 v[78:79], v5, s[8:11], s16 offen
    s_mul_i32 s17, s12, 16896
    v_lshlrev_b32 v3, 3, v1
    v_add_u32 v3, s17, v3
    v_and_b32 v7, 1, v1
    v_lshrrev_b32 v6, 1, v1
    v_cvt_f32_u32 v8, v6
    v_cvt_f32_u32 v10, v7
    s_movk_i32 s18, 528
    v_mul_lo_u32 v4, v6, s18
    v_lshl_add_u32 v4, v7, 3, v4
    v_add_u32 v4, s17, v4
    v_mov_b32 v9, 1.0
    v_fma_f32 v9, v10, -2.0, v9
    v_lshlrev_b32 v5, 12, v7
    v_lshl_add_u32 v11, v6, 2, v5
    s_lshl_b32 s19, s13, 13
    s_add_u32 s19, s19, 121634816
    s_waitcnt vmcnt(0)
    v_sub_f32 v80, v16, v48
    v_sub_f32 v81, v17, v49
    v_add_f32 v16, v16, v48
    v_add_f32 v17, v17, v49
    v_sub_f32 v48, v18, v50
    v_sub_f32 v49, v19, v51
    v_add_f32 v18, v18, v50
    v_add_f32 v19, v19, v51
    v_mul_f32 v50, 0x3f7b14be, v48
    v_mul_f32 v51, 0xbe47c5c2, v48
    v_fmac_f32 v50, 0x3e47c5c2, v49
    v_fmac_f32 v51, 0x3f7b14be, v49
    v_sub_f32 v48, v20, v52
    v_sub_f32 v49, v21, v53
    v_add_f32 v20, v20, v52
    v_add_f32 v21, v21, v53
    v_mul_f32 v52, 0x3f6c835e, v48
    v_mul_f32 v53, 0xbec3ef15, v48
    v_fmac_f32 v52, 0x3ec3ef15, v49
    v_fmac_f32 v53, 0x3f6c835e, v49
    v_sub_f32 v48, v22, v54
    v_sub_f32 v49, v23, v55
    v_add_f32 v22, v22, v54
    v_add_f32 v23, v23, v55
    v_mul_f32 v54, 0x3f54db31, v48
    v_mul_f32 v55, 0xbf0e39da, v48
    v_fmac_f32 v54, 0x3f0e39da, v49
    v_fmac_f32 v55, 0x3f54db31, v49
    v_sub_f32 v48, v24, v56
    v_sub_f32 v49, v25, v57
    v_add_f32 v24, v24, v56
    v_add_f32 v25, v25, v57
    v_mul_f32 v56, 0x3f3504f3, v48
    v_mul_f32 v57, 0xbf3504f3, v48
    v_fmac_f32 v56, 0x3f3504f3, v49
    v_fmac_f32 v57, 0x3f3504f3, v49
    v_sub_f32 v48, v26, v58
    v_sub_f32 v49, v27, v59
    v_add_f32 v26, v26, v58
    v_add_f32 v27, v27, v59
    v_mul_f32 v58, 0x3f0e39da, v48
    v_mul_f32 v59, 0xbf54db31, v48
    v_fmac_f32 v58, 0x3f54db31, v49
    v_fmac_f32 v59, 0x3f0e39da, v49
    v_sub_f32 v48, v28, v60
    v_sub_f32 v49, v29, v61
    v_add_f32 v28, v28, v60
    v_add_f32 v29, v29, v61
    v_mul_f32 v60, 0x3ec3ef15, v48
    v_mul_f32 v61, 0xbf6c835e, v48
    v_fmac_f32 v60, 0x3f6c835e, v49
    v_fmac_f32 v61, 0x3ec3ef15, v49
    v_sub_f32 v48, v30, v62
    v_sub_f32 v49, v31, v63
    v_add_f32 v30, v30, v62
    v_add_f32 v31, v31, v63
    v_mul_f32 v62, 0x3e47c5c2, v48
    v_mul_f32 v63, 0xbf7b14be, v48
    v_fmac_f32 v62, 0x3f7b14be, v49
    v_fmac_f32 v63, 0x3e47c5c2, v49
    v_sub_f32 v48, v33, v65
    v_sub_f32 v49, v64, v32
    v_add_f32 v32, v32, v64
    v_add_f32 v33, v33, v65
    v_sub_f32 v64, v34, v66
    v_sub_f32 v65, v35, v67
    v_add_f32 v34, v34, v66
    v_add_f32 v35, v35, v67
    v_mul_f32 v66, 0xbe47c5c2, v64
    v_mul_f32 v67, 0xbf7b14be, v64
    v_fmac_f32 v66, 0x3f7b14be, v65
    v_fmac_f32 v67, 0xbe47c5c2, v65
    v_sub_f32 v64, v36, v68
    v_sub_f32 v65, v37, v69
    v_add_f32 v36, v36, v68
    v_add_f32 v37, v37, v69
    v_mul_f32 v68, 0xbec3ef15, v64
    v_mul_f32 v69, 0xbf6c835e, v64
    v_fmac_f32 v68, 0x3f6c835e, v65
    v_fmac_f32 v69, 0xbec3ef15, v65
    v_sub_f32 v64, v38, v70
    v_sub_f32 v65, v39, v71
    v_add_f32 v38, v38, v70
    v_add_f32 v39, v39, v71
    v_mul_f32 v70, 0xbf0e39da, v64
    v_mul_f32 v71, 0xbf54db31, v64
    v_fmac_f32 v70, 0x3f54db31, v65
    v_fmac_f32 v71, 0xbf0e39da, v65
    v_sub_f32 v64, v40, v72
    v_sub_f32 v65, v41, v73
    v_add_f32 v40, v40, v72
    v_add_f32 v41, v41, v73
    v_mul_f32 v72, 0xbf3504f3, v64
    v_mul_f32 v73, 0xbf3504f3, v64
    v_fmac_f32 v72, 0x3f3504f3, v65
    v_fmac_f32 v73, 0xbf3504f3, v65
    v_sub_f32 v64, v42, v74
    v_sub_f32 v65, v43, v75
    v_add_f32 v42, v42, v74
    v_add_f32 v43, v43, v75
    v_mul_f32 v74, 0xbf54db31, v64
    v_mul_f32 v75, 0xbf0e39da, v64
    v_fmac_f32 v74, 0x3f0e39da, v65
    v_fmac_f32 v75, 0xbf54db31, v65
    v_sub_f32 v64, v44, v76
    v_sub_f32 v65, v45, v77
    v_add_f32 v44, v44, v76
    v_add_f32 v45, v45, v77
    v_mul_f32 v76, 0xbf6c835e, v64
    v_mul_f32 v77, 0xbec3ef15, v64
    v_fmac_f32 v76, 0x3ec3ef15, v65
    v_fmac_f32 v77, 0xbf6c835e, v65
    v_sub_f32 v64, v46, v78
    v_sub_f32 v65, v47, v79
    v_add_f32 v46, v46, v78
    v_add_f32 v47, v47, v79
    v_mul_f32 v78, 0xbf7b14be, v64
    v_mul_f32 v79, 0xbe47c5c2, v64
    v_fmac_f32 v78, 0x3e47c5c2, v65
    v_fmac_f32 v79, 0xbf7b14be, v65
    v_sub_f32 v64, v16, v32
    v_sub_f32 v65, v17, v33
    v_add_f32 v16, v16, v32
    v_add_f32 v17, v17, v33
    v_sub_f32 v32, v18, v34
    v_sub_f32 v33, v19, v35
    v_add_f32 v18, v18, v34
    v_add_f32 v19, v19, v35
    v_mul_f32 v34, 0x3f6c835e, v32
    v_mul_f32 v35, 0xbec3ef15, v32
    v_fmac_f32 v34, 0x3ec3ef15, v33
    v_fmac_f32 v35, 0x3f6c835e, v33
    v_sub_f32 v32, v20, v36
    v_sub_f32 v33, v21, v37
    v_add_f32 v20, v20, v36
    v_add_f32 v21, v21, v37
    v_mul_f32 v36, 0x3f3504f3, v32
    v_mul_f32 v37, 0xbf3504f3, v32
    v_fmac_f32 v36, 0x3f3504f3, v33
    v_fmac_f32 v37, 0x3f3504f3, v33
    v_sub_f32 v32, v22, v38
    v_sub_f32 v33, v23, v39
    v_add_f32 v22, v22, v38
    v_add_f32 v23, v23, v39
    v_mul_f32 v38, 0x3ec3ef15, v32
    v_mul_f32 v39, 0xbf6c835e, v32
    v_fmac_f32 v38, 0x3f6c835e, v33
    v_fmac_f32 v39, 0x3ec3ef15, v33
    v_sub_f32 v32, v25, v41
    v_sub_f32 v33, v40, v24
    v_add_f32 v24, v24, v40
    v_add_f32 v25, v25, v41
    v_sub_f32 v40, v26, v42
    v_sub_f32 v41, v27, v43
    v_add_f32 v26, v26, v42
    v_add_f32 v27, v27, v43
    v_mul_f32 v42, 0xbec3ef15, v40
    v_mul_f32 v43, 0xbf6c835e, v40
    v_fmac_f32 v42, 0x3f6c835e, v41
    v_fmac_f32 v43, 0xbec3ef15, v41
    v_sub_f32 v40, v28, v44
    v_sub_f32 v41, v29, v45
    v_add_f32 v28, v28, v44
    v_add_f32 v29, v29, v45
    v_mul_f32 v44, 0xbf3504f3, v40
    v_mul_f32 v45, 0xbf3504f3, v40
    v_fmac_f32 v44, 0x3f3504f3, v41
    v_fmac_f32 v45, 0xbf3504f3, v41
    v_sub_f32 v40, v30, v46
    v_sub_f32 v41, v31, v47
    v_add_f32 v30, v30, v46
    v_add_f32 v31, v31, v47
    v_mul_f32 v46, 0xbf6c835e, v40
    v_mul_f32 v47, 0xbec3ef15, v40
    v_fmac_f32 v46, 0x3ec3ef15, v41
    v_fmac_f32 v47, 0xbf6c835e, v41
    v_sub_f32 v40, v80, v48
    v_sub_f32 v41, v81, v49
    v_add_f32 v80, v80, v48
    v_add_f32 v81, v81, v49
    v_sub_f32 v48, v50, v66
    v_sub_f32 v49, v51, v67
    v_add_f32 v50, v50, v66
    v_add_f32 v51, v51, v67
    v_mul_f32 v66, 0x3f6c835e, v48
    v_mul_f32 v67, 0xbec3ef15, v48
    v_fmac_f32 v66, 0x3ec3ef15, v49
    v_fmac_f32 v67, 0x3f6c835e, v49
    v_sub_f32 v48, v52, v68
    v_sub_f32 v49, v53, v69
    v_add_f32 v52, v52, v68
    v_add_f32 v53, v53, v69
    v_mul_f32 v68, 0x3f3504f3, v48
    v_mul_f32 v69, 0xbf3504f3, v48
    v_fmac_f32 v68, 0x3f3504f3, v49
    v_fmac_f32 v69, 0x3f3504f3, v49
    v_sub_f32 v48, v54, v70
    v_sub_f32 v49, v55, v71
    v_add_f32 v54, v54, v70
    v_add_f32 v55, v55, v71
    v_mul_f32 v70, 0x3ec3ef15, v48
    v_mul_f32 v71, 0xbf6c835e, v48
    v_fmac_f32 v70, 0x3f6c835e, v49
    v_fmac_f32 v71, 0x3ec3ef15, v49
    v_sub_f32 v48, v57, v73
    v_sub_f32 v49, v72, v56
    v_add_f32 v56, v56, v72
    v_add_f32 v57, v57, v73
    v_sub_f32 v72, v58, v74
    v_sub_f32 v73, v59, v75
    v_add_f32 v58, v58, v74
    v_add_f32 v59, v59, v75
    v_mul_f32 v74, 0xbec3ef15, v72
    v_mul_f32 v75, 0xbf6c835e, v72
    v_fmac_f32 v74, 0x3f6c835e, v73
    v_fmac_f32 v75, 0xbec3ef15, v73
    v_sub_f32 v72, v60, v76
    v_sub_f32 v73, v61, v77
    v_add_f32 v60, v60, v76
    v_add_f32 v61, v61, v77
    v_mul_f32 v76, 0xbf3504f3, v72
    v_mul_f32 v77, 0xbf3504f3, v72
    v_fmac_f32 v76, 0x3f3504f3, v73
    v_fmac_f32 v77, 0xbf3504f3, v73
    v_sub_f32 v72, v62, v78
    v_sub_f32 v73, v63, v79
    v_add_f32 v62, v62, v78
    v_add_f32 v63, v63, v79
    v_mul_f32 v78, 0xbf6c835e, v72
    v_mul_f32 v79, 0xbec3ef15, v72
    v_fmac_f32 v78, 0x3ec3ef15, v73
    v_fmac_f32 v79, 0xbf6c835e, v73
    v_sub_f32 v72, v16, v24
    v_sub_f32 v73, v17, v25
    v_add_f32 v16, v16, v24
    v_add_f32 v17, v17, v25
    v_sub_f32 v24, v18, v26
    v_sub_f32 v25, v19, v27
    v_add_f32 v18, v18, v26
    v_add_f32 v19, v19, v27
    v_mul_f32 v26, 0x3f3504f3, v24
    v_mul_f32 v27, 0xbf3504f3, v24
    v_fmac_f32 v26, 0x3f3504f3, v25
    v_fmac_f32 v27, 0x3f3504f3, v25
    v_sub_f32 v24, v21, v29
    v_sub_f32 v25, v28, v20
    v_add_f32 v20, v20, v28
    v_add_f32 v21, v21, v29
    v_sub_f32 v28, v22, v30
    v_sub_f32 v29, v23, v31
    v_add_f32 v22, v22, v30
    v_add_f32 v23, v23, v31
    v_mul_f32 v30, 0xbf3504f3, v28
    v_mul_f32 v31, 0xbf3504f3, v28
    v_fmac_f32 v30, 0x3f3504f3, v29
    v_fmac_f32 v31, 0xbf3504f3, v29
    v_sub_f32 v28, v64, v32
    v_sub_f32 v29, v65, v33
    v_add_f32 v64, v64, v32
    v_add_f32 v65, v65, v33
    v_sub_f32 v32, v34, v42
    v_sub_f32 v33, v35, v43
    v_add_f32 v34, v34, v42
    v_add_f32 v35, v35, v43
    v_mul_f32 v42, 0x3f3504f3, v32
    v_mul_f32 v43, 0xbf3504f3, v32
    v_fmac_f32 v42, 0x3f3504f3, v33
    v_fmac_f32 v43, 0x3f3504f3, v33
    v_sub_f32 v32, v37, v45
    v_sub_f32 v33, v44, v36
    v_add_f32 v36, v36, v44
    v_add_f32 v37, v37, v45
    v_sub_f32 v44, v38, v46
    v_sub_f32 v45, v39, v47
    v_add_f32 v38, v38, v46
    v_add_f32 v39, v39, v47
    v_mul_f32 v46, 0xbf3504f3, v44
    v_mul_f32 v47, 0xbf3504f3, v44
    v_fmac_f32 v46, 0x3f3504f3, v45
    v_fmac_f32 v47, 0xbf3504f3, v45
    v_sub_f32 v44, v80, v56
    v_sub_f32 v45, v81, v57
    v_add_f32 v80, v80, v56
    v_add_f32 v81, v81, v57
    v_sub_f32 v56, v50, v58
    v_sub_f32 v57, v51, v59
    v_add_f32 v50, v50, v58
    v_add_f32 v51, v51, v59
    v_mul_f32 v58, 0x3f3504f3, v56
    v_mul_f32 v59, 0xbf3504f3, v56
    v_fmac_f32 v58, 0x3f3504f3, v57
    v_fmac_f32 v59, 0x3f3504f3, v57
    v_sub_f32 v56, v53, v61
    v_sub_f32 v57, v60, v52
    v_add_f32 v52, v52, v60
    v_add_f32 v53, v53, v61
    v_sub_f32 v60, v54, v62
    v_sub_f32 v61, v55, v63
    v_add_f32 v54, v54, v62
    v_add_f32 v55, v55, v63
    v_mul_f32 v62, 0xbf3504f3, v60
    v_mul_f32 v63, 0xbf3504f3, v60
    v_fmac_f32 v62, 0x3f3504f3, v61
    v_fmac_f32 v63, 0xbf3504f3, v61
    v_sub_f32 v60, v40, v48
    v_sub_f32 v61, v41, v49
    v_add_f32 v40, v40, v48
    v_add_f32 v41, v41, v49
    v_sub_f32 v48, v66, v74
    v_sub_f32 v49, v67, v75
    v_add_f32 v66, v66, v74
    v_add_f32 v67, v67, v75
    v_mul_f32 v74, 0x3f3504f3, v48
    v_mul_f32 v75, 0xbf3504f3, v48
    v_fmac_f32 v74, 0x3f3504f3, v49
    v_fmac_f32 v75, 0x3f3504f3, v49
    v_sub_f32 v48, v69, v77
    v_sub_f32 v49, v76, v68
    v_add_f32 v68, v68, v76
    v_add_f32 v69, v69, v77
    v_sub_f32 v76, v70, v78
    v_sub_f32 v77, v71, v79
    v_add_f32 v70, v70, v78
    v_add_f32 v71, v71, v79
    v_mul_f32 v78, 0xbf3504f3, v76
    v_mul_f32 v79, 0xbf3504f3, v76
    v_fmac_f32 v78, 0x3f3504f3, v77
    v_fmac_f32 v79, 0xbf3504f3, v77
    v_sub_f32 v76, v16, v20
    v_sub_f32 v77, v17, v21
    v_add_f32 v16, v16, v20
    v_add_f32 v17, v17, v21
    v_sub_f32 v20, v19, v23
    v_sub_f32 v21, v22, v18
    v_add_f32 v18, v18, v22
    v_add_f32 v19, v19, v23
    v_sub_f32 v22, v72, v24
    v_sub_f32 v23, v73, v25
    v_add_f32 v72, v72, v24
    v_add_f32 v73, v73, v25
    v_sub_f32 v24, v27, v31
    v_sub_f32 v25, v30, v26
    v_add_f32 v26, v26, v30
    v_add_f32 v27, v27, v31
    v_sub_f32 v30, v64, v36
    v_sub_f32 v31, v65, v37
    v_add_f32 v64, v64, v36
    v_add_f32 v65, v65, v37
    v_sub_f32 v36, v35, v39
    v_sub_f32 v37, v38, v34
    v_add_f32 v34, v34, v38
    v_add_f32 v35, v35, v39
    v_sub_f32 v38, v28, v32
    v_sub_f32 v39, v29, v33
    v_add_f32 v28, v28, v32
    v_add_f32 v29, v29, v33
    v_sub_f32 v32, v43, v47
    v_sub_f32 v33, v46, v42
    v_add_f32 v42, v42, v46
    v_add_f32 v43, v43, v47
    v_sub_f32 v46, v80, v52
    v_sub_f32 v47, v81, v53
    v_add_f32 v80, v80, v52
    v_add_f32 v81, v81, v53
    v_sub_f32 v52, v51, v55
    v_sub_f32 v53, v54, v50
    v_add_f32 v50, v50, v54
    v_add_f32 v51, v51, v55
    v_sub_f32 v54, v44, v56
    v_sub_f32 v55, v45, v57
    v_add_f32 v44, v44, v56
    v_add_f32 v45, v45, v57
    v_sub_f32 v56, v59, v63
    v_sub_f32 v57, v62, v58
    v_add_f32 v58, v58, v62
    v_add_f32 v59, v59, v63
    v_sub_f32 v62, v40, v68
    v_sub_f32 v63, v41, v69
    v_add_f32 v40, v40, v68
    v_add_f32 v41, v41, v69
    v_sub_f32 v68, v67, v71
    v_sub_f32 v69, v70, v66
    v_add_f32 v66, v66, v70
    v_add_f32 v67, v67, v71
    v_sub_f32 v70, v60, v48
    v_sub_f32 v71, v61, v49
    v_add_f32 v60, v60, v48
    v_add_f32 v61, v61, v49
    v_sub_f32 v48, v75, v79
    v_sub_f32 v49, v78, v74
    v_add_f32 v74, v74, v78
    v_add_f32 v75, v75, v79
    v_sub_f32 v78, v16, v18
    v_sub_f32 v79, v17, v19
    v_add_f32 v16, v16, v18
    v_add_f32 v17, v17, v19
    v_sub_f32 v18, v76, v20
    v_sub_f32 v19, v77, v21
    v_add_f32 v76, v76, v20
    v_add_f32 v77, v77, v21
    v_sub_f32 v20, v72, v26
    v_sub_f32 v21, v73, v27
    v_add_f32 v72, v72, v26
    v_add_f32 v73, v73, v27
    v_sub_f32 v26, v22, v24
    v_sub_f32 v27, v23, v25
    v_add_f32 v22, v22, v24
    v_add_f32 v23, v23, v25
    v_sub_f32 v24, v64, v34
    v_sub_f32 v25, v65, v35
    v_add_f32 v64, v64, v34
    v_add_f32 v65, v65, v35
    v_sub_f32 v34, v30, v36
    v_sub_f32 v35, v31, v37
    v_add_f32 v30, v30, v36
    v_add_f32 v31, v31, v37
    v_sub_f32 v36, v28, v42
    v_sub_f32 v37, v29, v43
    v_add_f32 v28, v28, v42
    v_add_f32 v29, v29, v43
    v_sub_f32 v42, v38, v32
    v_sub_f32 v43, v39, v33
    v_add_f32 v38, v38, v32
    v_add_f32 v39, v39, v33
    v_sub_f32 v32, v80, v50
    v_sub_f32 v33, v81, v51
    v_add_f32 v80, v80, v50
    v_add_f32 v81, v81, v51
    v_sub_f32 v50, v46, v52
    v_sub_f32 v51, v47, v53
    v_add_f32 v46, v46, v52
    v_add_f32 v47, v47, v53
    v_sub_f32 v52, v44, v58
    v_sub_f32 v53, v45, v59
    v_add_f32 v44, v44, v58
    v_add_f32 v45, v45, v59
    v_sub_f32 v58, v54, v56
    v_sub_f32 v59, v55, v57
    v_add_f32 v54, v54, v56
    v_add_f32 v55, v55, v57
    v_sub_f32 v56, v40, v66
    v_sub_f32 v57, v41, v67
    v_add_f32 v40, v40, v66
    v_add_f32 v41, v41, v67
    v_sub_f32 v66, v62, v68
    v_sub_f32 v67, v63, v69
    v_add_f32 v62, v62, v68
    v_add_f32 v63, v63, v69
    v_sub_f32 v68, v60, v74
    v_sub_f32 v69, v61, v75
    v_add_f32 v60, v60, v74
    v_add_f32 v61, v61, v75
    v_sub_f32 v74, v70, v48
    v_sub_f32 v75, v71, v49
    v_add_f32 v70, v70, v48
    v_add_f32 v71, v71, v49
    v_mul_f32 v48, 0xba000000, v2
    v_cos_f32 v49, v48
    v_sin_f32 v82, v48
    s_nop 0
    v_mul_f32 v83, v80, v49
    v_fma_f32 v83, -v81, v82, v83
    v_mul_f32 v81, v81, v49
    v_fmac_f32 v81, v80, v82
    v_mul_f32 v48, 0xba800000, v2
    v_cos_f32 v49, v48
    v_sin_f32 v82, v48
    s_nop 0
    v_mul_f32 v80, v64, v49
    v_fma_f32 v80, -v65, v82, v80
    v_mul_f32 v65, v65, v49
    v_fmac_f32 v65, v64, v82
    v_mul_f32 v48, 0xbac00000, v2
    v_cos_f32 v49, v48
    v_sin_f32 v82, v48
    s_nop 0
    v_mul_f32 v64, v40, v49
    v_fma_f32 v64, -v41, v82, v64
    v_mul_f32 v41, v41, v49
    v_fmac_f32 v41, v40, v82
    v_mul_f32 v48, 0xbb000000, v2
    v_cos_f32 v49, v48
    v_sin_f32 v82, v48
    s_nop 0
    v_mul_f32 v40, v72, v49
    v_fma_f32 v40, -v73, v82, v40
    v_mul_f32 v73, v73, v49
    v_fmac_f32 v73, v72, v82
    v_mul_f32 v48, 0xbb200000, v2
    v_cos_f32 v49, v48
    v_sin_f32 v82, v48
    s_nop 0
    v_mul_f32 v72, v44, v49
    v_fma_f32 v72, -v45, v82, v72
    v_mul_f32 v45, v45, v49
    v_fmac_f32 v45, v44, v82
    v_mul_f32 v48, 0xbb400000, v2
    v_cos_f32 v49, v48
    v_sin_f32 v82, v48
    s_nop 0
    v_mul_f32 v44, v28, v49
    v_fma_f32 v44, -v29, v82, v44
    v_mul_f32 v29, v29, v49
    v_fmac_f32 v29, v28, v82
    v_mul_f32 v48, 0xbb600000, v2
    v_cos_f32 v49, v48
    v_sin_f32 v82, v48
    s_nop 0
    v_mul_f32 v28, v60, v49
    v_fma_f32 v28, -v61, v82, v28
    v_mul_f32 v61, v61, v49
    v_fmac_f32 v61, v60, v82
    v_mul_f32 v48, 0xbb800000, v2
    v_cos_f32 v49, v48
    v_sin_f32 v82, v48
    s_nop 0
    v_mul_f32 v60, v76, v49
    v_fma_f32 v60, -v77, v82, v60
    v_mul_f32 v77, v77, v49
    v_fmac_f32 v77, v76, v82
    v_mul_f32 v48, 0xbb900000, v2
    v_cos_f32 v49, v48
    v_sin_f32 v82, v48
    s_nop 0
    v_mul_f32 v76, v46, v49
    v_fma_f32 v76, -v47, v82, v76
    v_mul_f32 v47, v47, v49
    v_fmac_f32 v47, v46, v82
    v_mul_f32 v48, 0xbba00000, v2
    v_cos_f32 v49, v48
    v_sin_f32 v82, v48
    s_nop 0
    v_mul_f32 v46, v30, v49
    v_fma_f32 v46, -v31, v82, v46
    v_mul_f32 v31, v31, v49
    v_fmac_f32 v31, v30, v82
    v_mul_f32 v48, 0xbbb00000, v2
    v_cos_f32 v49, v48
    v_sin_f32 v82, v48
    s_nop 0
    v_mul_f32 v30, v62, v49
    v_fma_f32 v30, -v63, v82, v30
    v_mul_f32 v63, v63, v49
    v_fmac_f32 v63, v62, v82
    v_mul_f32 v48, 0xbbc00000, v2
    v_cos_f32 v49, v48
    v_sin_f32 v82, v48
    s_nop 0
    v_mul_f32 v62, v22, v49
    v_fma_f32 v62, -v23, v82, v62
    v_mul_f32 v23, v23, v49
    v_fmac_f32 v23, v22, v82
    v_mul_f32 v48, 0xbbd00000, v2
    v_cos_f32 v49, v48
    v_sin_f32 v82, v48
    s_nop 0
    v_mul_f32 v22, v54, v49
    v_fma_f32 v22, -v55, v82, v22
    v_mul_f32 v55, v55, v49
    v_fmac_f32 v55, v54, v82
    v_mul_f32 v48, 0xbbe00000, v2
    v_cos_f32 v49, v48
    v_sin_f32 v82, v48
    s_nop 0
    v_mul_f32 v54, v38, v49
    v_fma_f32 v54, -v39, v82, v54
    v_mul_f32 v39, v39, v49
    v_fmac_f32 v39, v38, v82
    v_mul_f32 v48, 0xbbf00000, v2
    v_cos_f32 v49, v48
    v_sin_f32 v82, v48
    s_nop 0
    v_mul_f32 v38, v70, v49
    v_fma_f32 v38, -v71, v82, v38
    v_mul_f32 v71, v71, v49
    v_fmac_f32 v71, v70, v82
    v_mul_f32 v48, 0xbc000000, v2
    v_cos_f32 v49, v48
    v_sin_f32 v82, v48
    s_nop 0
    v_mul_f32 v70, v78, v49
    v_fma_f32 v70, -v79, v82, v70
    v_mul_f32 v79, v79, v49
    v_fmac_f32 v79, v78, v82
    v_mul_f32 v48, 0xbc080000, v2
    v_cos_f32 v49, v48
    v_sin_f32 v82, v48
    s_nop 0
    v_mul_f32 v78, v32, v49
    v_fma_f32 v78, -v33, v82, v78
    v_mul_f32 v33, v33, v49
    v_fmac_f32 v33, v32, v82
    v_mul_f32 v48, 0xbc100000, v2
    v_cos_f32 v49, v48
    v_sin_f32 v82, v48
    s_nop 0
    v_mul_f32 v32, v24, v49
    v_fma_f32 v32, -v25, v82, v32
    v_mul_f32 v25, v25, v49
    v_fmac_f32 v25, v24, v82
    v_mul_f32 v48, 0xbc180000, v2
    v_cos_f32 v49, v48
    v_sin_f32 v82, v48
    s_nop 0
    v_mul_f32 v24, v56, v49
    v_fma_f32 v24, -v57, v82, v24
    v_mul_f32 v57, v57, v49
    v_fmac_f32 v57, v56, v82
    v_mul_f32 v48, 0xbc200000, v2
    v_cos_f32 v49, v48
    v_sin_f32 v82, v48
    s_nop 0
    v_mul_f32 v56, v20, v49
    v_fma_f32 v56, -v21, v82, v56
    v_mul_f32 v21, v21, v49
    v_fmac_f32 v21, v20, v82
    v_mul_f32 v48, 0xbc280000, v2
    v_cos_f32 v49, v48
    v_sin_f32 v82, v48
    s_nop 0
    v_mul_f32 v20, v52, v49
    v_fma_f32 v20, -v53, v82, v20
    v_mul_f32 v53, v53, v49
    v_fmac_f32 v53, v52, v82
    v_mul_f32 v48, 0xbc300000, v2
    v_cos_f32 v49, v48
    v_sin_f32 v82, v48
    s_nop 0
    v_mul_f32 v52, v36, v49
    v_fma_f32 v52, -v37, v82, v52
    v_mul_f32 v37, v37, v49
    v_fmac_f32 v37, v36, v82
    v_mul_f32 v48, 0xbc380000, v2
    v_cos_f32 v49, v48
    v_sin_f32 v82, v48
    s_nop 0
    v_mul_f32 v36, v68, v49
    v_fma_f32 v36, -v69, v82, v36
    v_mul_f32 v69, v69, v49
    v_fmac_f32 v69, v68, v82
    v_mul_f32 v48, 0xbc400000, v2
    v_cos_f32 v49, v48
    v_sin_f32 v82, v48
    s_nop 0
    v_mul_f32 v68, v18, v49
    v_fma_f32 v68, -v19, v82, v68
    v_mul_f32 v19, v19, v49
    v_fmac_f32 v19, v18, v82
    v_mul_f32 v48, 0xbc480000, v2
    v_cos_f32 v49, v48
    v_sin_f32 v82, v48
    s_nop 0
    v_mul_f32 v18, v50, v49
    v_fma_f32 v18, -v51, v82, v18
    v_mul_f32 v51, v51, v49
    v_fmac_f32 v51, v50, v82
    v_mul_f32 v48, 0xbc500000, v2
    v_cos_f32 v49, v48
    v_sin_f32 v82, v48
    s_nop 0
    v_mul_f32 v50, v34, v49
    v_fma_f32 v50, -v35, v82, v50
    v_mul_f32 v35, v35, v49
    v_fmac_f32 v35, v34, v82
    v_mul_f32 v48, 0xbc580000, v2
    v_cos_f32 v49, v48
    v_sin_f32 v82, v48
    s_nop 0
    v_mul_f32 v34, v66, v49
    v_fma_f32 v34, -v67, v82, v34
    v_mul_f32 v67, v67, v49
    v_fmac_f32 v67, v66, v82
    v_mul_f32 v48, 0xbc600000, v2
    v_cos_f32 v49, v48
    v_sin_f32 v82, v48
    s_nop 0
    v_mul_f32 v66, v26, v49
    v_fma_f32 v66, -v27, v82, v66
    v_mul_f32 v27, v27, v49
    v_fmac_f32 v27, v26, v82
    v_mul_f32 v48, 0xbc680000, v2
    v_cos_f32 v49, v48
    v_sin_f32 v82, v48
    s_nop 0
    v_mul_f32 v26, v58, v49
    v_fma_f32 v26, -v59, v82, v26
    v_mul_f32 v59, v59, v49
    v_fmac_f32 v59, v58, v82
    v_mul_f32 v48, 0xbc700000, v2
    v_cos_f32 v49, v48
    v_sin_f32 v82, v48
    s_nop 0
    v_mul_f32 v58, v42, v49
    v_fma_f32 v58, -v43, v82, v58
    v_mul_f32 v43, v43, v49
    v_fmac_f32 v43, v42, v82
    v_mul_f32 v48, 0xbc780000, v2
    v_cos_f32 v49, v48
    v_sin_f32 v82, v48
    s_nop 0
    v_mul_f32 v42, v74, v49
    v_fma_f32 v42, -v75, v82, v42
    v_mul_f32 v75, v75, v49
    v_fmac_f32 v75, v74, v82
    ds_write_b32 v3, v16 offset:0
    ds_write_b32 v3, v17 offset:4
    ds_write_b32 v3, v83 offset:528
    ds_write_b32 v3, v81 offset:532
    ds_write_b32 v3, v80 offset:1056
    ds_write_b32 v3, v65 offset:1060
    ds_write_b32 v3, v64 offset:1584
    ds_write_b32 v3, v41 offset:1588
    ds_write_b32 v3, v40 offset:2112
    ds_write_b32 v3, v73 offset:2116
    ds_write_b32 v3, v72 offset:2640
    ds_write_b32 v3, v45 offset:2644
    ds_write_b32 v3, v44 offset:3168
    ds_write_b32 v3, v29 offset:3172
    ds_write_b32 v3, v28 offset:3696
    ds_write_b32 v3, v61 offset:3700
    ds_write_b32 v3, v60 offset:4224
    ds_write_b32 v3, v77 offset:4228
    ds_write_b32 v3, v76 offset:4752
    ds_write_b32 v3, v47 offset:4756
    ds_write_b32 v3, v46 offset:5280
    ds_write_b32 v3, v31 offset:5284
    ds_write_b32 v3, v30 offset:5808
    ds_write_b32 v3, v63 offset:5812
    ds_write_b32 v3, v62 offset:6336
    ds_write_b32 v3, v23 offset:6340
    ds_write_b32 v3, v22 offset:6864
    ds_write_b32 v3, v55 offset:6868
    ds_write_b32 v3, v54 offset:7392
    ds_write_b32 v3, v39 offset:7396
    ds_write_b32 v3, v38 offset:7920
    ds_write_b32 v3, v71 offset:7924
    ds_write_b32 v3, v70 offset:8448
    ds_write_b32 v3, v79 offset:8452
    ds_write_b32 v3, v78 offset:8976
    ds_write_b32 v3, v33 offset:8980
    ds_write_b32 v3, v32 offset:9504
    ds_write_b32 v3, v25 offset:9508
    ds_write_b32 v3, v24 offset:10032
    ds_write_b32 v3, v57 offset:10036
    ds_write_b32 v3, v56 offset:10560
    ds_write_b32 v3, v21 offset:10564
    ds_write_b32 v3, v20 offset:11088
    ds_write_b32 v3, v53 offset:11092
    ds_write_b32 v3, v52 offset:11616
    ds_write_b32 v3, v37 offset:11620
    ds_write_b32 v3, v36 offset:12144
    ds_write_b32 v3, v69 offset:12148
    ds_write_b32 v3, v68 offset:12672
    ds_write_b32 v3, v19 offset:12676
    ds_write_b32 v3, v18 offset:13200
    ds_write_b32 v3, v51 offset:13204
    ds_write_b32 v3, v50 offset:13728
    ds_write_b32 v3, v35 offset:13732
    ds_write_b32 v3, v34 offset:14256
    ds_write_b32 v3, v67 offset:14260
    ds_write_b32 v3, v66 offset:14784
    ds_write_b32 v3, v27 offset:14788
    ds_write_b32 v3, v26 offset:15312
    ds_write_b32 v3, v59 offset:15316
    ds_write_b32 v3, v58 offset:15840
    ds_write_b32 v3, v43 offset:15844
    ds_write_b32 v3, v42 offset:16368
    ds_write_b32 v3, v75 offset:16372
    s_waitcnt lgkmcnt(0)
    ds_read_b32 v16, v4 offset:0
    ds_read_b32 v17, v4 offset:4
    ds_read_b32 v83, v4 offset:16
    ds_read_b32 v81, v4 offset:20
    ds_read_b32 v80, v4 offset:32
    ds_read_b32 v65, v4 offset:36
    ds_read_b32 v64, v4 offset:48
    ds_read_b32 v41, v4 offset:52
    ds_read_b32 v40, v4 offset:64
    ds_read_b32 v73, v4 offset:68
    ds_read_b32 v72, v4 offset:80
    ds_read_b32 v45, v4 offset:84
    ds_read_b32 v44, v4 offset:96
    ds_read_b32 v29, v4 offset:100
    s_waitcnt lgkmcnt(0)
    ds_read_b32 v28, v4 offset:112
    ds_read_b32 v61, v4 offset:116
    ds_read_b32 v60, v4 offset:128
    ds_read_b32 v77, v4 offset:132
    ds_read_b32 v76, v4 offset:144
    ds_read_b32 v47, v4 offset:148
    ds_read_b32 v46, v4 offset:160
    ds_read_b32 v31, v4 offset:164
    ds_read_b32 v30, v4 offset:176
    ds_read_b32 v63, v4 offset:180
    ds_read_b32 v62, v4 offset:192
    ds_read_b32 v23, v4 offset:196
    ds_read_b32 v22, v4 offset:208
    ds_read_b32 v55, v4 offset:212
    s_waitcnt lgkmcnt(0)
    ds_read_b32 v54, v4 offset:224
    ds_read_b32 v39, v4 offset:228
    ds_read_b32 v38, v4 offset:240
    ds_read_b32 v71, v4 offset:244
    ds_read_b32 v70, v4 offset:256
    ds_read_b32 v79, v4 offset:260
    ds_read_b32 v78, v4 offset:272
    ds_read_b32 v33, v4 offset:276
    ds_read_b32 v32, v4 offset:288
    ds_read_b32 v25, v4 offset:292
    ds_read_b32 v24, v4 offset:304
    ds_read_b32 v57, v4 offset:308
    ds_read_b32 v56, v4 offset:320
    ds_read_b32 v21, v4 offset:324
    s_waitcnt lgkmcnt(0)
    ds_read_b32 v20, v4 offset:336
    ds_read_b32 v53, v4 offset:340
    ds_read_b32 v52, v4 offset:352
    ds_read_b32 v37, v4 offset:356
    ds_read_b32 v36, v4 offset:368
    ds_read_b32 v69, v4 offset:372
    ds_read_b32 v68, v4 offset:384
    ds_read_b32 v19, v4 offset:388
    ds_read_b32 v18, v4 offset:400
    ds_read_b32 v51, v4 offset:404
    ds_read_b32 v50, v4 offset:416
    ds_read_b32 v35, v4 offset:420
    ds_read_b32 v34, v4 offset:432
    ds_read_b32 v67, v4 offset:436
    s_waitcnt lgkmcnt(0)
    ds_read_b32 v66, v4 offset:448
    ds_read_b32 v27, v4 offset:452
    ds_read_b32 v26, v4 offset:464
    ds_read_b32 v59, v4 offset:468
    ds_read_b32 v58, v4 offset:480
    ds_read_b32 v43, v4 offset:484
    ds_read_b32 v42, v4 offset:496
    ds_read_b32 v75, v4 offset:500
    s_waitcnt lgkmcnt(0)
    buffer_load_dword v88, v11, s[8:11], s19 offen offset:0
    buffer_load_dword v89, v11, s[8:11], s19 offen offset:128
    buffer_load_dword v90, v11, s[8:11], s19 offen offset:256
    buffer_load_dword v91, v11, s[8:11], s19 offen offset:384
    buffer_load_dword v92, v11, s[8:11], s19 offen offset:512
    buffer_load_dword v93, v11, s[8:11], s19 offen offset:640
    buffer_load_dword v94, v11, s[8:11], s19 offen offset:768
    buffer_load_dword v95, v11, s[8:11], s19 offen offset:896
    buffer_load_dword v96, v11, s[8:11], s19 offen offset:1024
    buffer_load_dword v97, v11, s[8:11], s19 offen offset:1152
    buffer_load_dword v98, v11, s[8:11], s19 offen offset:1280
    buffer_load_dword v99, v11, s[8:11], s19 offen offset:1408
    buffer_load_dword v100, v11, s[8:11], s19 offen offset:1536
    buffer_load_dword v101, v11, s[8:11], s19 offen offset:1664
    buffer_load_dword v102, v11, s[8:11], s19 offen offset:1792
    buffer_load_dword v103, v11, s[8:11], s19 offen offset:1920
    buffer_load_dword v104, v11, s[8:11], s19 offen offset:2048
    buffer_load_dword v105, v11, s[8:11], s19 offen offset:2176
    buffer_load_dword v106, v11, s[8:11], s19 offen offset:2304
    buffer_load_dword v107, v11, s[8:11], s19 offen offset:2432
    buffer_load_dword v108, v11, s[8:11], s19 offen offset:2560
    buffer_load_dword v109, v11, s[8:11], s19 offen offset:2688
    buffer_load_dword v110, v11, s[8:11], s19 offen offset:2816
    buffer_load_dword v111, v11, s[8:11], s19 offen offset:2944
    buffer_load_dword v112, v11, s[8:11], s19 offen offset:3072
    buffer_load_dword v113, v11, s[8:11], s19 offen offset:3200
    buffer_load_dword v114, v11, s[8:11], s19 offen offset:3328
    buffer_load_dword v115, v11, s[8:11], s19 offen offset:3456
    buffer_load_dword v116, v11, s[8:11], s19 offen offset:3584
    buffer_load_dword v117, v11, s[8:11], s19 offen offset:3712
    buffer_load_dword v118, v11, s[8:11], s19 offen offset:3840
    buffer_load_dword v119, v11, s[8:11], s19 offen offset:3968
    v_sub_f32 v48, v16, v70
    v_sub_f32 v49, v17, v79
    v_add_f32 v16, v16, v70
    v_add_f32 v17, v17, v79
    v_sub_f32 v70, v83, v78
    v_sub_f32 v79, v81, v33
    v_add_f32 v83, v83, v78
    v_add_f32 v81, v81, v33
    v_mul_f32 v78, 0x3f7b14be, v70
    v_mul_f32 v33, 0xbe47c5c2, v70
    v_fmac_f32 v78, 0x3e47c5c2, v79
    v_fmac_f32 v33, 0x3f7b14be, v79
    v_sub_f32 v70, v80, v32
    v_sub_f32 v79, v65, v25
    v_add_f32 v80, v80, v32
    v_add_f32 v65, v65, v25
    v_mul_f32 v32, 0x3f6c835e, v70
    v_mul_f32 v25, 0xbec3ef15, v70
    v_fmac_f32 v32, 0x3ec3ef15, v79
    v_fmac_f32 v25, 0x3f6c835e, v79
    v_sub_f32 v70, v64, v24
    v_sub_f32 v79, v41, v57
    v_add_f32 v64, v64, v24
    v_add_f32 v41, v41, v57
    v_mul_f32 v24, 0x3f54db31, v70
    v_mul_f32 v57, 0xbf0e39da, v70
    v_fmac_f32 v24, 0x3f0e39da, v79
    v_fmac_f32 v57, 0x3f54db31, v79
    v_sub_f32 v70, v40, v56
    v_sub_f32 v79, v73, v21
    v_add_f32 v40, v40, v56
    v_add_f32 v73, v73, v21
    v_mul_f32 v56, 0x3f3504f3, v70
    v_mul_f32 v21, 0xbf3504f3, v70
    v_fmac_f32 v56, 0x3f3504f3, v79
    v_fmac_f32 v21, 0x3f3504f3, v79
    v_sub_f32 v70, v72, v20
    v_sub_f32 v79, v45, v53
    v_add_f32 v72, v72, v20
    v_add_f32 v45, v45, v53
    v_mul_f32 v20, 0x3f0e39da, v70
    v_mul_f32 v53, 0xbf54db31, v70
    v_fmac_f32 v20, 0x3f54db31, v79
    v_fmac_f32 v53, 0x3f0e39da, v79
    v_sub_f32 v70, v44, v52
    v_sub_f32 v79, v29, v37
    v_add_f32 v44, v44, v52
    v_add_f32 v29, v29, v37
    v_mul_f32 v52, 0x3ec3ef15, v70
    v_mul_f32 v37, 0xbf6c835e, v70
    v_fmac_f32 v52, 0x3f6c835e, v79
    v_fmac_f32 v37, 0x3ec3ef15, v79
    v_sub_f32 v70, v28, v36
    v_sub_f32 v79, v61, v69
    v_add_f32 v28, v28, v36
    v_add_f32 v61, v61, v69
    v_mul_f32 v36, 0x3e47c5c2, v70
    v_mul_f32 v69, 0xbf7b14be, v70
    v_fmac_f32 v36, 0x3f7b14be, v79
    v_fmac_f32 v69, 0x3e47c5c2, v79
    v_sub_f32 v70, v77, v19
    v_sub_f32 v79, v68, v60
    v_add_f32 v60, v60, v68
    v_add_f32 v77, v77, v19
    v_sub_f32 v68, v76, v18
    v_sub_f32 v19, v47, v51
    v_add_f32 v76, v76, v18
    v_add_f32 v47, v47, v51
    v_mul_f32 v18, 0xbe47c5c2, v68
    v_mul_f32 v51, 0xbf7b14be, v68
    v_fmac_f32 v18, 0x3f7b14be, v19
    v_fmac_f32 v51, 0xbe47c5c2, v19
    v_sub_f32 v68, v46, v50
    v_sub_f32 v19, v31, v35
    v_add_f32 v46, v46, v50
    v_add_f32 v31, v31, v35
    v_mul_f32 v50, 0xbec3ef15, v68
    v_mul_f32 v35, 0xbf6c835e, v68
    v_fmac_f32 v50, 0x3f6c835e, v19
    v_fmac_f32 v35, 0xbec3ef15, v19
    v_sub_f32 v68, v30, v34
    v_sub_f32 v19, v63, v67
    v_add_f32 v30, v30, v34
    v_add_f32 v63, v63, v67
    v_mul_f32 v34, 0xbf0e39da, v68
    v_mul_f32 v67, 0xbf54db31, v68
    v_fmac_f32 v34, 0x3f54db31, v19
    v_fmac_f32 v67, 0xbf0e39da, v19
    v_sub_f32 v68, v62, v66
    v_sub_f32 v19, v23, v27
    v_add_f32 v62, v62, v66
    v_add_f32 v23, v23, v27
    v_mul_f32 v66, 0xbf3504f3, v68
    v_mul_f32 v27, 0xbf3504f3, v68
    v_fmac_f32 v66, 0x3f3504f3, v19
    v_fmac_f32 v27, 0xbf3504f3, v19
    v_sub_f32 v68, v22, v26
    v_sub_f32 v19, v55, v59
    v_add_f32 v22, v22, v26
    v_add_f32 v55, v55, v59
    v_mul_f32 v26, 0xbf54db31, v68
    v_mul_f32 v59, 0xbf0e39da, v68
    v_fmac_f32 v26, 0x3f0e39da, v19
    v_fmac_f32 v59, 0xbf54db31, v19
    v_sub_f32 v68, v54, v58
    v_sub_f32 v19, v39, v43
    v_add_f32 v54, v54, v58
    v_add_f32 v39, v39, v43
    v_mul_f32 v58, 0xbf6c835e, v68
    v_mul_f32 v43, 0xbec3ef15, v68
    v_fmac_f32 v58, 0x3ec3ef15, v19
    v_fmac_f32 v43, 0xbf6c835e, v19
    v_sub_f32 v68, v38, v42
    v_sub_f32 v19, v71, v75
    v_add_f32 v38, v38, v42
    v_add_f32 v71, v71, v75
    v_mul_f32 v42, 0xbf7b14be, v68
    v_mul_f32 v75, 0xbe47c5c2, v68
    v_fmac_f32 v42, 0x3e47c5c2, v19
    v_fmac_f32 v75, 0xbf7b14be, v19
    v_sub_f32 v68, v16, v60
    v_sub_f32 v19, v17, v77
    v_add_f32 v16, v16, v60
    v_add_f32 v17, v17, v77
    v_sub_f32 v60, v83, v76
    v_sub_f32 v77, v81, v47
    v_add_f32 v83, v83, v76
    v_add_f32 v81, v81, v47
    v_mul_f32 v76, 0x3f6c835e, v60
    v_mul_f32 v47, 0xbec3ef15, v60
    v_fmac_f32 v76, 0x3ec3ef15, v77
    v_fmac_f32 v47, 0x3f6c835e, v77
    v_sub_f32 v60, v80, v46
    v_sub_f32 v77, v65, v31
    v_add_f32 v80, v80, v46
    v_add_f32 v65, v65, v31
    v_mul_f32 v46, 0x3f3504f3, v60
    v_mul_f32 v31, 0xbf3504f3, v60
    v_fmac_f32 v46, 0x3f3504f3, v77
    v_fmac_f32 v31, 0x3f3504f3, v77
    v_sub_f32 v60, v64, v30
    v_sub_f32 v77, v41, v63
    v_add_f32 v64, v64, v30
    v_add_f32 v41, v41, v63
    v_mul_f32 v30, 0x3ec3ef15, v60
    v_mul_f32 v63, 0xbf6c835e, v60
    v_fmac_f32 v30, 0x3f6c835e, v77
    v_fmac_f32 v63, 0x3ec3ef15, v77
    v_sub_f32 v60, v73, v23
    v_sub_f32 v77, v62, v40
    v_add_f32 v40, v40, v62
    v_add_f32 v73, v73, v23
    v_sub_f32 v62, v72, v22
    v_sub_f32 v23, v45, v55
    v_add_f32 v72, v72, v22
    v_add_f32 v45, v45, v55
    v_mul_f32 v22, 0xbec3ef15, v62
    v_mul_f32 v55, 0xbf6c835e, v62
    v_fmac_f32 v22, 0x3f6c835e, v23
    v_fmac_f32 v55, 0xbec3ef15, v23
    v_sub_f32 v62, v44, v54
    v_sub_f32 v23, v29, v39
    v_add_f32 v44, v44, v54
    v_add_f32 v29, v29, v39
    v_mul_f32 v54, 0xbf3504f3, v62
    v_mul_f32 v39, 0xbf3504f3, v62
    v_fmac_f32 v54, 0x3f3504f3, v23
    v_fmac_f32 v39, 0xbf3504f3, v23
    v_sub_f32 v62, v28, v38
    v_sub_f32 v23, v61, v71
    v_add_f32 v28, v28, v38
    v_add_f32 v61, v61, v71
    v_mul_f32 v38, 0xbf6c835e, v62
    v_mul_f32 v71, 0xbec3ef15, v62
    v_fmac_f32 v38, 0x3ec3ef15, v23
    v_fmac_f32 v71, 0xbf6c835e, v23
    v_sub_f32 v62, v48, v70
    v_sub_f32 v23, v49, v79
    v_add_f32 v48, v48, v70
    v_add_f32 v49, v49, v79
    v_sub_f32 v70, v78, v18
    v_sub_f32 v79, v33, v51
    v_add_f32 v78, v78, v18
    v_add_f32 v33, v33, v51
    v_mul_f32 v18, 0x3f6c835e, v70
    v_mul_f32 v51, 0xbec3ef15, v70
    v_fmac_f32 v18, 0x3ec3ef15, v79
    v_fmac_f32 v51, 0x3f6c835e, v79
    v_sub_f32 v70, v32, v50
    v_sub_f32 v79, v25, v35
    v_add_f32 v32, v32, v50
    v_add_f32 v25, v25, v35
    v_mul_f32 v50, 0x3f3504f3, v70
    v_mul_f32 v35, 0xbf3504f3, v70
    v_fmac_f32 v50, 0x3f3504f3, v79
    v_fmac_f32 v35, 0x3f3504f3, v79
    v_sub_f32 v70, v24, v34
    v_sub_f32 v79, v57, v67
    v_add_f32 v24, v24, v34
    v_add_f32 v57, v57, v67
    v_mul_f32 v34, 0x3ec3ef15, v70
    v_mul_f32 v67, 0xbf6c835e, v70
    v_fmac_f32 v34, 0x3f6c835e, v79
    v_fmac_f32 v67, 0x3ec3ef15, v79
    v_sub_f32 v70, v21, v27
    v_sub_f32 v79, v66, v56
    v_add_f32 v56, v56, v66
    v_add_f32 v21, v21, v27
    v_sub_f32 v66, v20, v26
    v_sub_f32 v27, v53, v59
    v_add_f32 v20, v20, v26
    v_add_f32 v53, v53, v59
    v_mul_f32 v26, 0xbec3ef15, v66
    v_mul_f32 v59, 0xbf6c835e, v66
    v_fmac_f32 v26, 0x3f6c835e, v27
    v_fmac_f32 v59, 0xbec3ef15, v27
    v_sub_f32 v66, v52, v58
    v_sub_f32 v27, v37, v43
    v_add_f32 v52, v52, v58
    v_add_f32 v37, v37, v43
    v_mul_f32 v58, 0xbf3504f3, v66
    v_mul_f32 v43, 0xbf3504f3, v66
    v_fmac_f32 v58, 0x3f3504f3, v27
    v_fmac_f32 v43, 0xbf3504f3, v27
    v_sub_f32 v66, v36, v42
    v_sub_f32 v27, v69, v75
    v_add_f32 v36, v36, v42
    v_add_f32 v69, v69, v75
    v_mul_f32 v42, 0xbf6c835e, v66
    v_mul_f32 v75, 0xbec3ef15, v66
    v_fmac_f32 v42, 0x3ec3ef15, v27
    v_fmac_f32 v75, 0xbf6c835e, v27
    v_sub_f32 v66, v16, v40
    v_sub_f32 v27, v17, v73
    v_add_f32 v16, v16, v40
    v_add_f32 v17, v17, v73
    v_sub_f32 v40, v83, v72
    v_sub_f32 v73, v81, v45
    v_add_f32 v83, v83, v72
    v_add_f32 v81, v81, v45
    v_mul_f32 v72, 0x3f3504f3, v40
    v_mul_f32 v45, 0xbf3504f3, v40
    v_fmac_f32 v72, 0x3f3504f3, v73
    v_fmac_f32 v45, 0x3f3504f3, v73
    v_sub_f32 v40, v65, v29
    v_sub_f32 v73, v44, v80
    v_add_f32 v80, v80, v44
    v_add_f32 v65, v65, v29
    v_sub_f32 v44, v64, v28
    v_sub_f32 v29, v41, v61
    v_add_f32 v64, v64, v28
    v_add_f32 v41, v41, v61
    v_mul_f32 v28, 0xbf3504f3, v44
    v_mul_f32 v61, 0xbf3504f3, v44
    v_fmac_f32 v28, 0x3f3504f3, v29
    v_fmac_f32 v61, 0xbf3504f3, v29
    v_sub_f32 v44, v68, v60
    v_sub_f32 v29, v19, v77
    v_add_f32 v68, v68, v60
    v_add_f32 v19, v19, v77
    v_sub_f32 v60, v76, v22
    v_sub_f32 v77, v47, v55
    v_add_f32 v76, v76, v22
    v_add_f32 v47, v47, v55
    v_mul_f32 v22, 0x3f3504f3, v60
    v_mul_f32 v55, 0xbf3504f3, v60
    v_fmac_f32 v22, 0x3f3504f3, v77
    v_fmac_f32 v55, 0x3f3504f3, v77
    v_sub_f32 v60, v31, v39
    v_sub_f32 v77, v54, v46
    v_add_f32 v46, v46, v54
    v_add_f32 v31, v31, v39
    v_sub_f32 v54, v30, v38
    v_sub_f32 v39, v63, v71
    v_add_f32 v30, v30, v38
    v_add_f32 v63, v63, v71
    v_mul_f32 v38, 0xbf3504f3, v54
    v_mul_f32 v71, 0xbf3504f3, v54
    v_fmac_f32 v38, 0x3f3504f3, v39
    v_fmac_f32 v71, 0xbf3504f3, v39
    v_sub_f32 v54, v48, v56
    v_sub_f32 v39, v49, v21
    v_add_f32 v48, v48, v56
    v_add_f32 v49, v49, v21
    v_sub_f32 v56, v78, v20
    v_sub_f32 v21, v33, v53
    v_add_f32 v78, v78, v20
    v_add_f32 v33, v33, v53
    v_mul_f32 v20, 0x3f3504f3, v56
    v_mul_f32 v53, 0xbf3504f3, v56
    v_fmac_f32 v20, 0x3f3504f3, v21
    v_fmac_f32 v53, 0x3f3504f3, v21
    v_sub_f32 v56, v25, v37
    v_sub_f32 v21, v52, v32
    v_add_f32 v32, v32, v52
    v_add_f32 v25, v25, v37
    v_sub_f32 v52, v24, v36
    v_sub_f32 v37, v57, v69
    v_add_f32 v24, v24, v36
    v_add_f32 v57, v57, v69
    v_mul_f32 v36, 0xbf3504f3, v52
    v_mul_f32 v69, 0xbf3504f3, v52
    v_fmac_f32 v36, 0x3f3504f3, v37
    v_fmac_f32 v69, 0xbf3504f3, v37
    v_sub_f32 v52, v62, v70
    v_sub_f32 v37, v23, v79
    v_add_f32 v62, v62, v70
    v_add_f32 v23, v23, v79
    v_sub_f32 v70, v18, v26
    v_sub_f32 v79, v51, v59
    v_add_f32 v18, v18, v26
    v_add_f32 v51, v51, v59
    v_mul_f32 v26, 0x3f3504f3, v70
    v_mul_f32 v59, 0xbf3504f3, v70
    v_fmac_f32 v26, 0x3f3504f3, v79
    v_fmac_f32 v59, 0x3f3504f3, v79
    v_sub_f32 v70, v35, v43
    v_sub_f32 v79, v58, v50
    v_add_f32 v50, v50, v58
    v_add_f32 v35, v35, v43
    v_sub_f32 v58, v34, v42
    v_sub_f32 v43, v67, v75
    v_add_f32 v34, v34, v42
    v_add_f32 v67, v67, v75
    v_mul_f32 v42, 0xbf3504f3, v58
    v_mul_f32 v75, 0xbf3504f3, v58
    v_fmac_f32 v42, 0x3f3504f3, v43
    v_fmac_f32 v75, 0xbf3504f3, v43
    v_sub_f32 v58, v16, v80
    v_sub_f32 v43, v17, v65
    v_add_f32 v16, v16, v80
    v_add_f32 v17, v17, v65
    v_sub_f32 v80, v81, v41
    v_sub_f32 v65, v64, v83
    v_add_f32 v83, v83, v64
    v_add_f32 v81, v81, v41
    v_sub_f32 v64, v66, v40
    v_sub_f32 v41, v27, v73
    v_add_f32 v66, v66, v40
    v_add_f32 v27, v27, v73
    v_sub_f32 v40, v45, v61
    v_sub_f32 v73, v28, v72
    v_add_f32 v72, v72, v28
    v_add_f32 v45, v45, v61
    v_sub_f32 v28, v68, v46
    v_sub_f32 v61, v19, v31
    v_add_f32 v68, v68, v46
    v_add_f32 v19, v19, v31
    v_sub_f32 v46, v47, v63
    v_sub_f32 v31, v30, v76
    v_add_f32 v76, v76, v30
    v_add_f32 v47, v47, v63
    v_sub_f32 v30, v44, v60
    v_sub_f32 v63, v29, v77
    v_add_f32 v44, v44, v60
    v_add_f32 v29, v29, v77
    v_sub_f32 v60, v55, v71
    v_sub_f32 v77, v38, v22
    v_add_f32 v22, v22, v38
    v_add_f32 v55, v55, v71
    v_sub_f32 v38, v48, v32
    v_sub_f32 v71, v49, v25
    v_add_f32 v48, v48, v32
    v_add_f32 v49, v49, v25
    v_sub_f32 v32, v33, v57
    v_sub_f32 v25, v24, v78
    v_add_f32 v78, v78, v24
    v_add_f32 v33, v33, v57
    v_sub_f32 v24, v54, v56
    v_sub_f32 v57, v39, v21
    v_add_f32 v54, v54, v56
    v_add_f32 v39, v39, v21
    v_sub_f32 v56, v53, v69
    v_sub_f32 v21, v36, v20
    v_add_f32 v20, v20, v36
    v_add_f32 v53, v53, v69
    v_sub_f32 v36, v62, v50
    v_sub_f32 v69, v23, v35
    v_add_f32 v62, v62, v50
    v_add_f32 v23, v23, v35
    v_sub_f32 v50, v51, v67
    v_sub_f32 v35, v34, v18
    v_add_f32 v18, v18, v34
    v_add_f32 v51, v51, v67
    v_sub_f32 v34, v52, v70
    v_sub_f32 v67, v37, v79
    v_add_f32 v52, v52, v70
    v_add_f32 v37, v37, v79
    v_sub_f32 v70, v59, v75
    v_sub_f32 v79, v42, v26
    v_add_f32 v26, v26, v42
    v_add_f32 v59, v59, v75
    v_sub_f32 v42, v16, v83
    v_sub_f32 v75, v17, v81
    v_add_f32 v16, v16, v83
    v_add_f32 v17, v17, v81
    v_sub_f32 v83, v58, v80
    v_sub_f32 v81, v43, v65
    v_add_f32 v58, v58, v80
    v_add_f32 v43, v43, v65
    v_sub_f32 v80, v66, v72
    v_sub_f32 v65, v27, v45
    v_add_f32 v66, v66, v72
    v_add_f32 v27, v27, v45
    v_sub_f32 v72, v64, v40
    v_sub_f32 v45, v41, v73
    v_add_f32 v64, v64, v40
    v_add_f32 v41, v41, v73
    v_sub_f32 v40, v68, v76
    v_sub_f32 v73, v19, v47
    v_add_f32 v68, v68, v76
    v_add_f32 v19, v19, v47
    v_sub_f32 v76, v28, v46
    v_sub_f32 v47, v61, v31
    v_add_f32 v28, v28, v46
    v_add_f32 v61, v61, v31
    v_sub_f32 v46, v44, v22
    v_sub_f32 v31, v29, v55
    v_add_f32 v44, v44, v22
    v_add_f32 v29, v29, v55
    v_sub_f32 v22, v30, v60
    v_sub_f32 v55, v63, v77
    v_add_f32 v30, v30, v60
    v_add_f32 v63, v63, v77
    v_sub_f32 v60, v48, v78
    v_sub_f32 v77, v49, v33
    v_add_f32 v48, v48, v78
    v_add_f32 v49, v49, v33
    v_sub_f32 v78, v38, v32
    v_sub_f32 v33, v71, v25
    v_add_f32 v38, v38, v32
    v_add_f32 v71, v71, v25
    v_sub_f32 v32, v54, v20
    v_sub_f32 v25, v39, v53
    v_add_f32 v54, v54, v20
    v_add_f32 v39, v39, v53
    v_sub_f32 v20, v24, v56
    v_sub_f32 v53, v57, v21
    v_add_f32 v24, v24, v56
    v_add_f32 v57, v57, v21
    v_sub_f32 v56, v62, v18
    v_sub_f32 v21, v23, v51
    v_add_f32 v62, v62, v18
    v_add_f32 v23, v23, v51
    v_sub_f32 v18, v36, v50
    v_sub_f32 v51, v69, v35
    v_add_f32 v36, v36, v50
    v_add_f32 v69, v69, v35
    v_sub_f32 v50, v52, v26
    v_sub_f32 v35, v37, v59
    v_add_f32 v52, v52, v26
    v_add_f32 v37, v37, v59
    v_sub_f32 v26, v34, v70
    v_sub_f32 v59, v67, v79
    v_add_f32 v34, v34, v70
    v_add_f32 v67, v67, v79
    v_mul_f32 v70, 0xbc800000, v10
    v_cos_f32 v79, v70
    v_sin_f32 v82, v70
    s_nop 0
    v_mul_f32 v74, v48, v79
    v_fma_f32 v74, -v49, v82, v74
    v_mul_f32 v49, v49, v79
    v_fmac_f32 v49, v48, v82
    v_mul_f32 v70, 0xbd000000, v10
    v_cos_f32 v79, v70
    v_sin_f32 v82, v70
    s_nop 0
    v_mul_f32 v48, v68, v79
    v_fma_f32 v48, -v19, v82, v48
    v_mul_f32 v19, v19, v79
    v_fmac_f32 v19, v68, v82
    v_mul_f32 v70, 0xbd400000, v10
    v_cos_f32 v79, v70
    v_sin_f32 v82, v70
    s_nop 0
    v_mul_f32 v68, v62, v79
    v_fma_f32 v68, -v23, v82, v68
    v_mul_f32 v23, v23, v79
    v_fmac_f32 v23, v62, v82
    v_mul_f32 v70, 0xbd800000, v10
    v_cos_f32 v79, v70
    v_sin_f32 v82, v70
    s_nop 0
    v_mul_f32 v62, v66, v79
    v_fma_f32 v62, -v27, v82, v62
    v_mul_f32 v27, v27, v79
    v_fmac_f32 v27, v66, v82
    v_mul_f32 v70, 0xbda00000, v10
    v_cos_f32 v79, v70
    v_sin_f32 v82, v70
    s_nop 0
    v_mul_f32 v66, v54, v79
    v_fma_f32 v66, -v39, v82, v66
    v_mul_f32 v39, v39, v79
    v_fmac_f32 v39, v54, v82
    v_mul_f32 v70, 0xbdc00000, v10
    v_cos_f32 v79, v70
    v_sin_f32 v82, v70
    s_nop 0
    v_mul_f32 v54, v44, v79
    v_fma_f32 v54, -v29, v82, v54
    v_mul_f32 v29, v29, v79
    v_fmac_f32 v29, v44, v82
    v_mul_f32 v70, 0xbde00000, v10
    v_cos_f32 v79, v70
    v_sin_f32 v82, v70
    s_nop 0
    v_mul_f32 v44, v52, v79
    v_fma_f32 v44, -v37, v82, v44
    v_mul_f32 v37, v37, v79
    v_fmac_f32 v37, v52, v82
    v_mul_f32 v70, 0xbe000000, v10
    v_cos_f32 v79, v70
    v_sin_f32 v82, v70
    s_nop 0
    v_mul_f32 v52, v58, v79
    v_fma_f32 v52, -v43, v82, v52
    v_mul_f32 v43, v43, v79
    v_fmac_f32 v43, v58, v82
    v_mul_f32 v70, 0xbe100000, v10
    v_cos_f32 v79, v70
    v_sin_f32 v82, v70
    s_nop 0
    v_mul_f32 v58, v38, v79
    v_fma_f32 v58, -v71, v82, v58
    v_mul_f32 v71, v71, v79
    v_fmac_f32 v71, v38, v82
    v_mul_f32 v70, 0xbe200000, v10
    v_cos_f32 v79, v70
    v_sin_f32 v82, v70
    s_nop 0
    v_mul_f32 v38, v28, v79
    v_fma_f32 v38, -v61, v82, v38
    v_mul_f32 v61, v61, v79
    v_fmac_f32 v61, v28, v82
    v_mul_f32 v70, 0xbe300000, v10
    v_cos_f32 v79, v70
    v_sin_f32 v82, v70
    s_nop 0
    v_mul_f32 v28, v36, v79
    v_fma_f32 v28, -v69, v82, v28
    v_mul_f32 v69, v69, v79
    v_fmac_f32 v69, v36, v82
    v_mul_f32 v70, 0xbe400000, v10
    v_cos_f32 v79, v70
    v_sin_f32 v82, v70
    s_nop 0
    v_mul_f32 v36, v64, v79
    v_fma_f32 v36, -v41, v82, v36
    v_mul_f32 v41, v41, v79
    v_fmac_f32 v41, v64, v82
    v_mul_f32 v70, 0xbe500000, v10
    v_cos_f32 v79, v70
    v_sin_f32 v82, v70
    s_nop 0
    v_mul_f32 v64, v24, v79
    v_fma_f32 v64, -v57, v82, v64
    v_mul_f32 v57, v57, v79
    v_fmac_f32 v57, v24, v82
    v_mul_f32 v70, 0xbe600000, v10
    v_cos_f32 v79, v70
    v_sin_f32 v82, v70
    s_nop 0
    v_mul_f32 v24, v30, v79
    v_fma_f32 v24, -v63, v82, v24
    v_mul_f32 v63, v63, v79
    v_fmac_f32 v63, v30, v82
    v_mul_f32 v70, 0xbe700000, v10
    v_cos_f32 v79, v70
    v_sin_f32 v82, v70
    s_nop 0
    v_mul_f32 v30, v34, v79
    v_fma_f32 v30, -v67, v82, v30
    v_mul_f32 v67, v67, v79
    v_fmac_f32 v67, v34, v82
    v_mul_f32 v70, 0xbe800000, v10
    v_cos_f32 v79, v70
    v_sin_f32 v82, v70
    s_nop 0
    v_mul_f32 v34, v42, v79
    v_fma_f32 v34, -v75, v82, v34
    v_mul_f32 v75, v75, v79
    v_fmac_f32 v75, v42, v82
    v_mul_f32 v70, 0xbe880000, v10
    v_cos_f32 v79, v70
    v_sin_f32 v82, v70
    s_nop 0
    v_mul_f32 v42, v60, v79
    v_fma_f32 v42, -v77, v82, v42
    v_mul_f32 v77, v77, v79
    v_fmac_f32 v77, v60, v82
    v_mul_f32 v70, 0xbe900000, v10
    v_cos_f32 v79, v70
    v_sin_f32 v82, v70
    s_nop 0
    v_mul_f32 v60, v40, v79
    v_fma_f32 v60, -v73, v82, v60
    v_mul_f32 v73, v73, v79
    v_fmac_f32 v73, v40, v82
    v_mul_f32 v70, 0xbe980000, v10
    v_cos_f32 v79, v70
    v_sin_f32 v82, v70
    s_nop 0
    v_mul_f32 v40, v56, v79
    v_fma_f32 v40, -v21, v82, v40
    v_mul_f32 v21, v21, v79
    v_fmac_f32 v21, v56, v82
    v_mul_f32 v70, 0xbea00000, v10
    v_cos_f32 v79, v70
    v_sin_f32 v82, v70
    s_nop 0
    v_mul_f32 v56, v80, v79
    v_fma_f32 v56, -v65, v82, v56
    v_mul_f32 v65, v65, v79
    v_fmac_f32 v65, v80, v82
    v_mul_f32 v70, 0xbea80000, v10
    v_cos_f32 v79, v70
    v_sin_f32 v82, v70
    s_nop 0
    v_mul_f32 v80, v32, v79
    v_fma_f32 v80, -v25, v82, v80
    v_mul_f32 v25, v25, v79
    v_fmac_f32 v25, v32, v82
    v_mul_f32 v70, 0xbeb00000, v10
    v_cos_f32 v79, v70
    v_sin_f32 v82, v70
    s_nop 0
    v_mul_f32 v32, v46, v79
    v_fma_f32 v32, -v31, v82, v32
    v_mul_f32 v31, v31, v79
    v_fmac_f32 v31, v46, v82
    v_mul_f32 v70, 0xbeb80000, v10
    v_cos_f32 v79, v70
    v_sin_f32 v82, v70
    s_nop 0
    v_mul_f32 v46, v50, v79
    v_fma_f32 v46, -v35, v82, v46
    v_mul_f32 v35, v35, v79
    v_fmac_f32 v35, v50, v82
    v_mul_f32 v70, 0xbec00000, v10
    v_cos_f32 v79, v70
    v_sin_f32 v82, v70
    s_nop 0
    v_mul_f32 v50, v83, v79
    v_fma_f32 v50, -v81, v82, v50
    v_mul_f32 v81, v81, v79
    v_fmac_f32 v81, v83, v82
    v_mul_f32 v70, 0xbec80000, v10
    v_cos_f32 v79, v70
    v_sin_f32 v82, v70
    s_nop 0
    v_mul_f32 v83, v78, v79
    v_fma_f32 v83, -v33, v82, v83
    v_mul_f32 v33, v33, v79
    v_fmac_f32 v33, v78, v82
    v_mul_f32 v70, 0xbed00000, v10
    v_cos_f32 v79, v70
    v_sin_f32 v82, v70
    s_nop 0
    v_mul_f32 v78, v76, v79
    v_fma_f32 v78, -v47, v82, v78
    v_mul_f32 v47, v47, v79
    v_fmac_f32 v47, v76, v82
    v_mul_f32 v70, 0xbed80000, v10
    v_cos_f32 v79, v70
    v_sin_f32 v82, v70
    s_nop 0
    v_mul_f32 v76, v18, v79
    v_fma_f32 v76, -v51, v82, v76
    v_mul_f32 v51, v51, v79
    v_fmac_f32 v51, v18, v82
    v_mul_f32 v70, 0xbee00000, v10
    v_cos_f32 v79, v70
    v_sin_f32 v82, v70
    s_nop 0
    v_mul_f32 v18, v72, v79
    v_fma_f32 v18, -v45, v82, v18
    v_mul_f32 v45, v45, v79
    v_fmac_f32 v45, v72, v82
    v_mul_f32 v70, 0xbee80000, v10
    v_cos_f32 v79, v70
    v_sin_f32 v82, v70
    s_nop 0
    v_mul_f32 v72, v20, v79
    v_fma_f32 v72, -v53, v82, v72
    v_mul_f32 v53, v53, v79
    v_fmac_f32 v53, v20, v82
    v_mul_f32 v70, 0xbef00000, v10
    v_cos_f32 v79, v70
    v_sin_f32 v82, v70
    s_nop 0
    v_mul_f32 v20, v22, v79
    v_fma_f32 v20, -v55, v82, v20
    v_mul_f32 v55, v55, v79
    v_fmac_f32 v55, v22, v82
    v_mul_f32 v70, 0xbef80000, v10
    v_cos_f32 v79, v70
    v_sin_f32 v82, v70
    s_nop 0
    v_mul_f32 v22, v26, v79
    v_fma_f32 v22, -v59, v82, v22
    v_mul_f32 v59, v59, v79
    v_fmac_f32 v59, v26, v82
    s_nop 1
    v_mov_b32_dpp v70, v16 quad_perm:[1,0,3,2] row_mask:0xf bank_mask:0xf
    v_fma_f32 v16, v16, v9, v70
    v_mov_b32_dpp v70, v17 quad_perm:[1,0,3,2] row_mask:0xf bank_mask:0xf
    v_fma_f32 v17, v17, v9, v70
    v_mov_b32_dpp v70, v74 quad_perm:[1,0,3,2] row_mask:0xf bank_mask:0xf
    v_fma_f32 v74, v74, v9, v70
    v_mov_b32_dpp v70, v49 quad_perm:[1,0,3,2] row_mask:0xf bank_mask:0xf
    v_fma_f32 v49, v49, v9, v70
    v_mov_b32_dpp v70, v48 quad_perm:[1,0,3,2] row_mask:0xf bank_mask:0xf
    v_fma_f32 v48, v48, v9, v70
    v_mov_b32_dpp v70, v19 quad_perm:[1,0,3,2] row_mask:0xf bank_mask:0xf
    v_fma_f32 v19, v19, v9, v70
    v_mov_b32_dpp v70, v68 quad_perm:[1,0,3,2] row_mask:0xf bank_mask:0xf
    v_fma_f32 v68, v68, v9, v70
    v_mov_b32_dpp v70, v23 quad_perm:[1,0,3,2] row_mask:0xf bank_mask:0xf
    v_fma_f32 v23, v23, v9, v70
    v_mov_b32_dpp v70, v62 quad_perm:[1,0,3,2] row_mask:0xf bank_mask:0xf
    v_fma_f32 v62, v62, v9, v70
    v_mov_b32_dpp v70, v27 quad_perm:[1,0,3,2] row_mask:0xf bank_mask:0xf
    v_fma_f32 v27, v27, v9, v70
    v_mov_b32_dpp v70, v66 quad_perm:[1,0,3,2] row_mask:0xf bank_mask:0xf
    v_fma_f32 v66, v66, v9, v70
    v_mov_b32_dpp v70, v39 quad_perm:[1,0,3,2] row_mask:0xf bank_mask:0xf
    v_fma_f32 v39, v39, v9, v70
    v_mov_b32_dpp v70, v54 quad_perm:[1,0,3,2] row_mask:0xf bank_mask:0xf
    v_fma_f32 v54, v54, v9, v70
    v_mov_b32_dpp v70, v29 quad_perm:[1,0,3,2] row_mask:0xf bank_mask:0xf
    v_fma_f32 v29, v29, v9, v70
    v_mov_b32_dpp v70, v44 quad_perm:[1,0,3,2] row_mask:0xf bank_mask:0xf
    v_fma_f32 v44, v44, v9, v70
    v_mov_b32_dpp v70, v37 quad_perm:[1,0,3,2] row_mask:0xf bank_mask:0xf
    v_fma_f32 v37, v37, v9, v70
    v_mov_b32_dpp v70, v52 quad_perm:[1,0,3,2] row_mask:0xf bank_mask:0xf
    v_fma_f32 v52, v52, v9, v70
    v_mov_b32_dpp v70, v43 quad_perm:[1,0,3,2] row_mask:0xf bank_mask:0xf
    v_fma_f32 v43, v43, v9, v70
    v_mov_b32_dpp v70, v58 quad_perm:[1,0,3,2] row_mask:0xf bank_mask:0xf
    v_fma_f32 v58, v58, v9, v70
    v_mov_b32_dpp v70, v71 quad_perm:[1,0,3,2] row_mask:0xf bank_mask:0xf
    v_fma_f32 v71, v71, v9, v70
    v_mov_b32_dpp v70, v38 quad_perm:[1,0,3,2] row_mask:0xf bank_mask:0xf
    v_fma_f32 v38, v38, v9, v70
    v_mov_b32_dpp v70, v61 quad_perm:[1,0,3,2] row_mask:0xf bank_mask:0xf
    v_fma_f32 v61, v61, v9, v70
    v_mov_b32_dpp v70, v28 quad_perm:[1,0,3,2] row_mask:0xf bank_mask:0xf
    v_fma_f32 v28, v28, v9, v70
    v_mov_b32_dpp v70, v69 quad_perm:[1,0,3,2] row_mask:0xf bank_mask:0xf
    v_fma_f32 v69, v69, v9, v70
    v_mov_b32_dpp v70, v36 quad_perm:[1,0,3,2] row_mask:0xf bank_mask:0xf
    v_fma_f32 v36, v36, v9, v70
    v_mov_b32_dpp v70, v41 quad_perm:[1,0,3,2] row_mask:0xf bank_mask:0xf
    v_fma_f32 v41, v41, v9, v70
    v_mov_b32_dpp v70, v64 quad_perm:[1,0,3,2] row_mask:0xf bank_mask:0xf
    v_fma_f32 v64, v64, v9, v70
    v_mov_b32_dpp v70, v57 quad_perm:[1,0,3,2] row_mask:0xf bank_mask:0xf
    v_fma_f32 v57, v57, v9, v70
    v_mov_b32_dpp v70, v24 quad_perm:[1,0,3,2] row_mask:0xf bank_mask:0xf
    v_fma_f32 v24, v24, v9, v70
    v_mov_b32_dpp v70, v63 quad_perm:[1,0,3,2] row_mask:0xf bank_mask:0xf
    v_fma_f32 v63, v63, v9, v70
    v_mov_b32_dpp v70, v30 quad_perm:[1,0,3,2] row_mask:0xf bank_mask:0xf
    v_fma_f32 v30, v30, v9, v70
    v_mov_b32_dpp v70, v67 quad_perm:[1,0,3,2] row_mask:0xf bank_mask:0xf
    v_fma_f32 v67, v67, v9, v70
    v_mov_b32_dpp v70, v34 quad_perm:[1,0,3,2] row_mask:0xf bank_mask:0xf
    v_fma_f32 v34, v34, v9, v70
    v_mov_b32_dpp v70, v75 quad_perm:[1,0,3,2] row_mask:0xf bank_mask:0xf
    v_fma_f32 v75, v75, v9, v70
    v_mov_b32_dpp v70, v42 quad_perm:[1,0,3,2] row_mask:0xf bank_mask:0xf
    v_fma_f32 v42, v42, v9, v70
    v_mov_b32_dpp v70, v77 quad_perm:[1,0,3,2] row_mask:0xf bank_mask:0xf
    v_fma_f32 v77, v77, v9, v70
    v_mov_b32_dpp v70, v60 quad_perm:[1,0,3,2] row_mask:0xf bank_mask:0xf
    v_fma_f32 v60, v60, v9, v70
    v_mov_b32_dpp v70, v73 quad_perm:[1,0,3,2] row_mask:0xf bank_mask:0xf
    v_fma_f32 v73, v73, v9, v70
    v_mov_b32_dpp v70, v40 quad_perm:[1,0,3,2] row_mask:0xf bank_mask:0xf
    v_fma_f32 v40, v40, v9, v70
    v_mov_b32_dpp v70, v21 quad_perm:[1,0,3,2] row_mask:0xf bank_mask:0xf
    v_fma_f32 v21, v21, v9, v70
    v_mov_b32_dpp v70, v56 quad_perm:[1,0,3,2] row_mask:0xf bank_mask:0xf
    v_fma_f32 v56, v56, v9, v70
    v_mov_b32_dpp v70, v65 quad_perm:[1,0,3,2] row_mask:0xf bank_mask:0xf
    v_fma_f32 v65, v65, v9, v70
    v_mov_b32_dpp v70, v80 quad_perm:[1,0,3,2] row_mask:0xf bank_mask:0xf
    v_fma_f32 v80, v80, v9, v70
    v_mov_b32_dpp v70, v25 quad_perm:[1,0,3,2] row_mask:0xf bank_mask:0xf
    v_fma_f32 v25, v25, v9, v70
    v_mov_b32_dpp v70, v32 quad_perm:[1,0,3,2] row_mask:0xf bank_mask:0xf
    v_fma_f32 v32, v32, v9, v70
    v_mov_b32_dpp v70, v31 quad_perm:[1,0,3,2] row_mask:0xf bank_mask:0xf
    v_fma_f32 v31, v31, v9, v70
    v_mov_b32_dpp v70, v46 quad_perm:[1,0,3,2] row_mask:0xf bank_mask:0xf
    v_fma_f32 v46, v46, v9, v70
    v_mov_b32_dpp v70, v35 quad_perm:[1,0,3,2] row_mask:0xf bank_mask:0xf
    v_fma_f32 v35, v35, v9, v70
    v_mov_b32_dpp v70, v50 quad_perm:[1,0,3,2] row_mask:0xf bank_mask:0xf
    v_fma_f32 v50, v50, v9, v70
    v_mov_b32_dpp v70, v81 quad_perm:[1,0,3,2] row_mask:0xf bank_mask:0xf
    v_fma_f32 v81, v81, v9, v70
    v_mov_b32_dpp v70, v83 quad_perm:[1,0,3,2] row_mask:0xf bank_mask:0xf
    v_fma_f32 v83, v83, v9, v70
    v_mov_b32_dpp v70, v33 quad_perm:[1,0,3,2] row_mask:0xf bank_mask:0xf
    v_fma_f32 v33, v33, v9, v70
    v_mov_b32_dpp v70, v78 quad_perm:[1,0,3,2] row_mask:0xf bank_mask:0xf
    v_fma_f32 v78, v78, v9, v70
    v_mov_b32_dpp v70, v47 quad_perm:[1,0,3,2] row_mask:0xf bank_mask:0xf
    v_fma_f32 v47, v47, v9, v70
    v_mov_b32_dpp v70, v76 quad_perm:[1,0,3,2] row_mask:0xf bank_mask:0xf
    v_fma_f32 v76, v76, v9, v70
    v_mov_b32_dpp v70, v51 quad_perm:[1,0,3,2] row_mask:0xf bank_mask:0xf
    v_fma_f32 v51, v51, v9, v70
    v_mov_b32_dpp v70, v18 quad_perm:[1,0,3,2] row_mask:0xf bank_mask:0xf
    v_fma_f32 v18, v18, v9, v70
    v_mov_b32_dpp v70, v45 quad_perm:[1,0,3,2] row_mask:0xf bank_mask:0xf
    v_fma_f32 v45, v45, v9, v70
    v_mov_b32_dpp v70, v72 quad_perm:[1,0,3,2] row_mask:0xf bank_mask:0xf
    v_fma_f32 v72, v72, v9, v70
    v_mov_b32_dpp v70, v53 quad_perm:[1,0,3,2] row_mask:0xf bank_mask:0xf
    v_fma_f32 v53, v53, v9, v70
    v_mov_b32_dpp v70, v20 quad_perm:[1,0,3,2] row_mask:0xf bank_mask:0xf
    v_fma_f32 v20, v20, v9, v70
    v_mov_b32_dpp v70, v55 quad_perm:[1,0,3,2] row_mask:0xf bank_mask:0xf
    v_fma_f32 v55, v55, v9, v70
    v_mov_b32_dpp v70, v22 quad_perm:[1,0,3,2] row_mask:0xf bank_mask:0xf
    v_fma_f32 v22, v22, v9, v70
    v_mov_b32_dpp v70, v59 quad_perm:[1,0,3,2] row_mask:0xf bank_mask:0xf
    v_fma_f32 v59, v59, v9, v70
    s_waitcnt vmcnt(0)
    s_mov_b32 s20, 0x34800000
    v_lshlrev_b32 v70, 16, v88
    v_and_b32 v79, 0xffff0000, v88
    v_mul_f32 v70, s20, v70
    v_mul_f32 v79, s20, v79
    v_mul_f32 v82, v16, v70
    v_fma_f32 v82, -v17, v79, v82
    v_mul_f32 v17, v17, v70
    v_fmac_f32 v17, v16, v79
    v_lshlrev_b32 v70, 16, v89
    v_and_b32 v79, 0xffff0000, v89
    v_mul_f32 v70, s20, v70
    v_mul_f32 v79, s20, v79
    v_mul_f32 v16, v74, v70
    v_fma_f32 v16, -v49, v79, v16
    v_mul_f32 v49, v49, v70
    v_fmac_f32 v49, v74, v79
    v_lshlrev_b32 v70, 16, v90
    v_and_b32 v79, 0xffff0000, v90
    v_mul_f32 v70, s20, v70
    v_mul_f32 v79, s20, v79
    v_mul_f32 v74, v48, v70
    v_fma_f32 v74, -v19, v79, v74
    v_mul_f32 v19, v19, v70
    v_fmac_f32 v19, v48, v79
    v_lshlrev_b32 v70, 16, v91
    v_and_b32 v79, 0xffff0000, v91
    v_mul_f32 v70, s20, v70
    v_mul_f32 v79, s20, v79
    v_mul_f32 v48, v68, v70
    v_fma_f32 v48, -v23, v79, v48
    v_mul_f32 v23, v23, v70
    v_fmac_f32 v23, v68, v79
    v_lshlrev_b32 v70, 16, v92
    v_and_b32 v79, 0xffff0000, v92
    v_mul_f32 v70, s20, v70
    v_mul_f32 v79, s20, v79
    v_mul_f32 v68, v62, v70
    v_fma_f32 v68, -v27, v79, v68
    v_mul_f32 v27, v27, v70
    v_fmac_f32 v27, v62, v79
    v_lshlrev_b32 v70, 16, v93
    v_and_b32 v79, 0xffff0000, v93
    v_mul_f32 v70, s20, v70
    v_mul_f32 v79, s20, v79
    v_mul_f32 v62, v66, v70
    v_fma_f32 v62, -v39, v79, v62
    v_mul_f32 v39, v39, v70
    v_fmac_f32 v39, v66, v79
    v_lshlrev_b32 v70, 16, v94
    v_and_b32 v79, 0xffff0000, v94
    v_mul_f32 v70, s20, v70
    v_mul_f32 v79, s20, v79
    v_mul_f32 v66, v54, v70
    v_fma_f32 v66, -v29, v79, v66
    v_mul_f32 v29, v29, v70
    v_fmac_f32 v29, v54, v79
    v_lshlrev_b32 v70, 16, v95
    v_and_b32 v79, 0xffff0000, v95
    v_mul_f32 v70, s20, v70
    v_mul_f32 v79, s20, v79
    v_mul_f32 v54, v44, v70
    v_fma_f32 v54, -v37, v79, v54
    v_mul_f32 v37, v37, v70
    v_fmac_f32 v37, v44, v79
    v_lshlrev_b32 v70, 16, v96
    v_and_b32 v79, 0xffff0000, v96
    v_mul_f32 v70, s20, v70
    v_mul_f32 v79, s20, v79
    v_mul_f32 v44, v52, v70
    v_fma_f32 v44, -v43, v79, v44
    v_mul_f32 v43, v43, v70
    v_fmac_f32 v43, v52, v79
    v_lshlrev_b32 v70, 16, v97
    v_and_b32 v79, 0xffff0000, v97
    v_mul_f32 v70, s20, v70
    v_mul_f32 v79, s20, v79
    v_mul_f32 v52, v58, v70
    v_fma_f32 v52, -v71, v79, v52
    v_mul_f32 v71, v71, v70
    v_fmac_f32 v71, v58, v79
    v_lshlrev_b32 v70, 16, v98
    v_and_b32 v79, 0xffff0000, v98
    v_mul_f32 v70, s20, v70
    v_mul_f32 v79, s20, v79
    v_mul_f32 v58, v38, v70
    v_fma_f32 v58, -v61, v79, v58
    v_mul_f32 v61, v61, v70
    v_fmac_f32 v61, v38, v79
    v_lshlrev_b32 v70, 16, v99
    v_and_b32 v79, 0xffff0000, v99
    v_mul_f32 v70, s20, v70
    v_mul_f32 v79, s20, v79
    v_mul_f32 v38, v28, v70
    v_fma_f32 v38, -v69, v79, v38
    v_mul_f32 v69, v69, v70
    v_fmac_f32 v69, v28, v79
    v_lshlrev_b32 v70, 16, v100
    v_and_b32 v79, 0xffff0000, v100
    v_mul_f32 v70, s20, v70
    v_mul_f32 v79, s20, v79
    v_mul_f32 v28, v36, v70
    v_fma_f32 v28, -v41, v79, v28
    v_mul_f32 v41, v41, v70
    v_fmac_f32 v41, v36, v79
    v_lshlrev_b32 v70, 16, v101
    v_and_b32 v79, 0xffff0000, v101
    v_mul_f32 v70, s20, v70
    v_mul_f32 v79, s20, v79
    v_mul_f32 v36, v64, v70
    v_fma_f32 v36, -v57, v79, v36
    v_mul_f32 v57, v57, v70
    v_fmac_f32 v57, v64, v79
    v_lshlrev_b32 v70, 16, v102
    v_and_b32 v79, 0xffff0000, v102
    v_mul_f32 v70, s20, v70
    v_mul_f32 v79, s20, v79
    v_mul_f32 v64, v24, v70
    v_fma_f32 v64, -v63, v79, v64
    v_mul_f32 v63, v63, v70
    v_fmac_f32 v63, v24, v79
    v_lshlrev_b32 v70, 16, v103
    v_and_b32 v79, 0xffff0000, v103
    v_mul_f32 v70, s20, v70
    v_mul_f32 v79, s20, v79
    v_mul_f32 v24, v30, v70
    v_fma_f32 v24, -v67, v79, v24
    v_mul_f32 v67, v67, v70
    v_fmac_f32 v67, v30, v79
    v_lshlrev_b32 v70, 16, v104
    v_and_b32 v79, 0xffff0000, v104
    v_mul_f32 v70, s20, v70
    v_mul_f32 v79, s20, v79
    v_mul_f32 v30, v34, v70
    v_fma_f32 v30, -v75, v79, v30
    v_mul_f32 v75, v75, v70
    v_fmac_f32 v75, v34, v79
    v_lshlrev_b32 v70, 16, v105
    v_and_b32 v79, 0xffff0000, v105
    v_mul_f32 v70, s20, v70
    v_mul_f32 v79, s20, v79
    v_mul_f32 v34, v42, v70
    v_fma_f32 v34, -v77, v79, v34
    v_mul_f32 v77, v77, v70
    v_fmac_f32 v77, v42, v79
    v_lshlrev_b32 v70, 16, v106
    v_and_b32 v79, 0xffff0000, v106
    v_mul_f32 v70, s20, v70
    v_mul_f32 v79, s20, v79
    v_mul_f32 v42, v60, v70
    v_fma_f32 v42, -v73, v79, v42
    v_mul_f32 v73, v73, v70
    v_fmac_f32 v73, v60, v79
    v_lshlrev_b32 v70, 16, v107
    v_and_b32 v79, 0xffff0000, v107
    v_mul_f32 v70, s20, v70
    v_mul_f32 v79, s20, v79
    v_mul_f32 v60, v40, v70
    v_fma_f32 v60, -v21, v79, v60
    v_mul_f32 v21, v21, v70
    v_fmac_f32 v21, v40, v79
    v_lshlrev_b32 v70, 16, v108
    v_and_b32 v79, 0xffff0000, v108
    v_mul_f32 v70, s20, v70
    v_mul_f32 v79, s20, v79
    v_mul_f32 v40, v56, v70
    v_fma_f32 v40, -v65, v79, v40
    v_mul_f32 v65, v65, v70
    v_fmac_f32 v65, v56, v79
    v_lshlrev_b32 v70, 16, v109
    v_and_b32 v79, 0xffff0000, v109
    v_mul_f32 v70, s20, v70
    v_mul_f32 v79, s20, v79
    v_mul_f32 v56, v80, v70
    v_fma_f32 v56, -v25, v79, v56
    v_mul_f32 v25, v25, v70
    v_fmac_f32 v25, v80, v79
    v_lshlrev_b32 v70, 16, v110
    v_and_b32 v79, 0xffff0000, v110
    v_mul_f32 v70, s20, v70
    v_mul_f32 v79, s20, v79
    v_mul_f32 v80, v32, v70
    v_fma_f32 v80, -v31, v79, v80
    v_mul_f32 v31, v31, v70
    v_fmac_f32 v31, v32, v79
    v_lshlrev_b32 v70, 16, v111
    v_and_b32 v79, 0xffff0000, v111
    v_mul_f32 v70, s20, v70
    v_mul_f32 v79, s20, v79
    v_mul_f32 v32, v46, v70
    v_fma_f32 v32, -v35, v79, v32
    v_mul_f32 v35, v35, v70
    v_fmac_f32 v35, v46, v79
    v_lshlrev_b32 v70, 16, v112
    v_and_b32 v79, 0xffff0000, v112
    v_mul_f32 v70, s20, v70
    v_mul_f32 v79, s20, v79
    v_mul_f32 v46, v50, v70
    v_fma_f32 v46, -v81, v79, v46
    v_mul_f32 v81, v81, v70
    v_fmac_f32 v81, v50, v79
    v_lshlrev_b32 v70, 16, v113
    v_and_b32 v79, 0xffff0000, v113
    v_mul_f32 v70, s20, v70
    v_mul_f32 v79, s20, v79
    v_mul_f32 v50, v83, v70
    v_fma_f32 v50, -v33, v79, v50
    v_mul_f32 v33, v33, v70
    v_fmac_f32 v33, v83, v79
    v_lshlrev_b32 v70, 16, v114
    v_and_b32 v79, 0xffff0000, v114
    v_mul_f32 v70, s20, v70
    v_mul_f32 v79, s20, v79
    v_mul_f32 v83, v78, v70
    v_fma_f32 v83, -v47, v79, v83
    v_mul_f32 v47, v47, v70
    v_fmac_f32 v47, v78, v79
    v_lshlrev_b32 v70, 16, v115
    v_and_b32 v79, 0xffff0000, v115
    v_mul_f32 v70, s20, v70
    v_mul_f32 v79, s20, v79
    v_mul_f32 v78, v76, v70
    v_fma_f32 v78, -v51, v79, v78
    v_mul_f32 v51, v51, v70
    v_fmac_f32 v51, v76, v79
    v_lshlrev_b32 v70, 16, v116
    v_and_b32 v79, 0xffff0000, v116
    v_mul_f32 v70, s20, v70
    v_mul_f32 v79, s20, v79
    v_mul_f32 v76, v18, v70
    v_fma_f32 v76, -v45, v79, v76
    v_mul_f32 v45, v45, v70
    v_fmac_f32 v45, v18, v79
    v_lshlrev_b32 v70, 16, v117
    v_and_b32 v79, 0xffff0000, v117
    v_mul_f32 v70, s20, v70
    v_mul_f32 v79, s20, v79
    v_mul_f32 v18, v72, v70
    v_fma_f32 v18, -v53, v79, v18
    v_mul_f32 v53, v53, v70
    v_fmac_f32 v53, v72, v79
    v_lshlrev_b32 v70, 16, v118
    v_and_b32 v79, 0xffff0000, v118
    v_mul_f32 v70, s20, v70
    v_mul_f32 v79, s20, v79
    v_mul_f32 v72, v20, v70
    v_fma_f32 v72, -v55, v79, v72
    v_mul_f32 v55, v55, v70
    v_fmac_f32 v55, v20, v79
    v_lshlrev_b32 v70, 16, v119
    v_and_b32 v79, 0xffff0000, v119
    v_mul_f32 v70, s20, v70
    v_mul_f32 v79, s20, v79
    v_mul_f32 v20, v22, v70
    v_fma_f32 v20, -v59, v79, v20
    v_mul_f32 v59, v59, v70
    v_fmac_f32 v59, v22, v79
    s_nop 1
    v_mov_b32_dpp v70, v82 quad_perm:[1,0,3,2] row_mask:0xf bank_mask:0xf
    v_fma_f32 v82, v82, v9, v70
    v_mov_b32_dpp v70, v17 quad_perm:[1,0,3,2] row_mask:0xf bank_mask:0xf
    v_fma_f32 v17, v17, v9, v70
    v_mov_b32_dpp v70, v16 quad_perm:[1,0,3,2] row_mask:0xf bank_mask:0xf
    v_fma_f32 v16, v16, v9, v70
    v_mov_b32_dpp v70, v49 quad_perm:[1,0,3,2] row_mask:0xf bank_mask:0xf
    v_fma_f32 v49, v49, v9, v70
    v_mov_b32_dpp v70, v74 quad_perm:[1,0,3,2] row_mask:0xf bank_mask:0xf
    v_fma_f32 v74, v74, v9, v70
    v_mov_b32_dpp v70, v19 quad_perm:[1,0,3,2] row_mask:0xf bank_mask:0xf
    v_fma_f32 v19, v19, v9, v70
    v_mov_b32_dpp v70, v48 quad_perm:[1,0,3,2] row_mask:0xf bank_mask:0xf
    v_fma_f32 v48, v48, v9, v70
    v_mov_b32_dpp v70, v23 quad_perm:[1,0,3,2] row_mask:0xf bank_mask:0xf
    v_fma_f32 v23, v23, v9, v70
    v_mov_b32_dpp v70, v68 quad_perm:[1,0,3,2] row_mask:0xf bank_mask:0xf
    v_fma_f32 v68, v68, v9, v70
    v_mov_b32_dpp v70, v27 quad_perm:[1,0,3,2] row_mask:0xf bank_mask:0xf
    v_fma_f32 v27, v27, v9, v70
    v_mov_b32_dpp v70, v62 quad_perm:[1,0,3,2] row_mask:0xf bank_mask:0xf
    v_fma_f32 v62, v62, v9, v70
    v_mov_b32_dpp v70, v39 quad_perm:[1,0,3,2] row_mask:0xf bank_mask:0xf
    v_fma_f32 v39, v39, v9, v70
    v_mov_b32_dpp v70, v66 quad_perm:[1,0,3,2] row_mask:0xf bank_mask:0xf
    v_fma_f32 v66, v66, v9, v70
    v_mov_b32_dpp v70, v29 quad_perm:[1,0,3,2] row_mask:0xf bank_mask:0xf
    v_fma_f32 v29, v29, v9, v70
    v_mov_b32_dpp v70, v54 quad_perm:[1,0,3,2] row_mask:0xf bank_mask:0xf
    v_fma_f32 v54, v54, v9, v70
    v_mov_b32_dpp v70, v37 quad_perm:[1,0,3,2] row_mask:0xf bank_mask:0xf
    v_fma_f32 v37, v37, v9, v70
    v_mov_b32_dpp v70, v44 quad_perm:[1,0,3,2] row_mask:0xf bank_mask:0xf
    v_fma_f32 v44, v44, v9, v70
    v_mov_b32_dpp v70, v43 quad_perm:[1,0,3,2] row_mask:0xf bank_mask:0xf
    v_fma_f32 v43, v43, v9, v70
    v_mov_b32_dpp v70, v52 quad_perm:[1,0,3,2] row_mask:0xf bank_mask:0xf
    v_fma_f32 v52, v52, v9, v70
    v_mov_b32_dpp v70, v71 quad_perm:[1,0,3,2] row_mask:0xf bank_mask:0xf
    v_fma_f32 v71, v71, v9, v70
    v_mov_b32_dpp v70, v58 quad_perm:[1,0,3,2] row_mask:0xf bank_mask:0xf
    v_fma_f32 v58, v58, v9, v70
    v_mov_b32_dpp v70, v61 quad_perm:[1,0,3,2] row_mask:0xf bank_mask:0xf
    v_fma_f32 v61, v61, v9, v70
    v_mov_b32_dpp v70, v38 quad_perm:[1,0,3,2] row_mask:0xf bank_mask:0xf
    v_fma_f32 v38, v38, v9, v70
    v_mov_b32_dpp v70, v69 quad_perm:[1,0,3,2] row_mask:0xf bank_mask:0xf
    v_fma_f32 v69, v69, v9, v70
    v_mov_b32_dpp v70, v28 quad_perm:[1,0,3,2] row_mask:0xf bank_mask:0xf
    v_fma_f32 v28, v28, v9, v70
    v_mov_b32_dpp v70, v41 quad_perm:[1,0,3,2] row_mask:0xf bank_mask:0xf
    v_fma_f32 v41, v41, v9, v70
    v_mov_b32_dpp v70, v36 quad_perm:[1,0,3,2] row_mask:0xf bank_mask:0xf
    v_fma_f32 v36, v36, v9, v70
    v_mov_b32_dpp v70, v57 quad_perm:[1,0,3,2] row_mask:0xf bank_mask:0xf
    v_fma_f32 v57, v57, v9, v70
    v_mov_b32_dpp v70, v64 quad_perm:[1,0,3,2] row_mask:0xf bank_mask:0xf
    v_fma_f32 v64, v64, v9, v70
    v_mov_b32_dpp v70, v63 quad_perm:[1,0,3,2] row_mask:0xf bank_mask:0xf
    v_fma_f32 v63, v63, v9, v70
    v_mov_b32_dpp v70, v24 quad_perm:[1,0,3,2] row_mask:0xf bank_mask:0xf
    v_fma_f32 v24, v24, v9, v70
    v_mov_b32_dpp v70, v67 quad_perm:[1,0,3,2] row_mask:0xf bank_mask:0xf
    v_fma_f32 v67, v67, v9, v70
    v_mov_b32_dpp v70, v30 quad_perm:[1,0,3,2] row_mask:0xf bank_mask:0xf
    v_fma_f32 v30, v30, v9, v70
    v_mov_b32_dpp v70, v75 quad_perm:[1,0,3,2] row_mask:0xf bank_mask:0xf
    v_fma_f32 v75, v75, v9, v70
    v_mov_b32_dpp v70, v34 quad_perm:[1,0,3,2] row_mask:0xf bank_mask:0xf
    v_fma_f32 v34, v34, v9, v70
    v_mov_b32_dpp v70, v77 quad_perm:[1,0,3,2] row_mask:0xf bank_mask:0xf
    v_fma_f32 v77, v77, v9, v70
    v_mov_b32_dpp v70, v42 quad_perm:[1,0,3,2] row_mask:0xf bank_mask:0xf
    v_fma_f32 v42, v42, v9, v70
    v_mov_b32_dpp v70, v73 quad_perm:[1,0,3,2] row_mask:0xf bank_mask:0xf
    v_fma_f32 v73, v73, v9, v70
    v_mov_b32_dpp v70, v60 quad_perm:[1,0,3,2] row_mask:0xf bank_mask:0xf
    v_fma_f32 v60, v60, v9, v70
    v_mov_b32_dpp v70, v21 quad_perm:[1,0,3,2] row_mask:0xf bank_mask:0xf
    v_fma_f32 v21, v21, v9, v70
    v_mov_b32_dpp v70, v40 quad_perm:[1,0,3,2] row_mask:0xf bank_mask:0xf
    v_fma_f32 v40, v40, v9, v70
    v_mov_b32_dpp v70, v65 quad_perm:[1,0,3,2] row_mask:0xf bank_mask:0xf
    v_fma_f32 v65, v65, v9, v70
    v_mov_b32_dpp v70, v56 quad_perm:[1,0,3,2] row_mask:0xf bank_mask:0xf
    v_fma_f32 v56, v56, v9, v70
    v_mov_b32_dpp v70, v25 quad_perm:[1,0,3,2] row_mask:0xf bank_mask:0xf
    v_fma_f32 v25, v25, v9, v70
    v_mov_b32_dpp v70, v80 quad_perm:[1,0,3,2] row_mask:0xf bank_mask:0xf
    v_fma_f32 v80, v80, v9, v70
    v_mov_b32_dpp v70, v31 quad_perm:[1,0,3,2] row_mask:0xf bank_mask:0xf
    v_fma_f32 v31, v31, v9, v70
    v_mov_b32_dpp v70, v32 quad_perm:[1,0,3,2] row_mask:0xf bank_mask:0xf
    v_fma_f32 v32, v32, v9, v70
    v_mov_b32_dpp v70, v35 quad_perm:[1,0,3,2] row_mask:0xf bank_mask:0xf
    v_fma_f32 v35, v35, v9, v70
    v_mov_b32_dpp v70, v46 quad_perm:[1,0,3,2] row_mask:0xf bank_mask:0xf
    v_fma_f32 v46, v46, v9, v70
    v_mov_b32_dpp v70, v81 quad_perm:[1,0,3,2] row_mask:0xf bank_mask:0xf
    v_fma_f32 v81, v81, v9, v70
    v_mov_b32_dpp v70, v50 quad_perm:[1,0,3,2] row_mask:0xf bank_mask:0xf
    v_fma_f32 v50, v50, v9, v70
    v_mov_b32_dpp v70, v33 quad_perm:[1,0,3,2] row_mask:0xf bank_mask:0xf
    v_fma_f32 v33, v33, v9, v70
    v_mov_b32_dpp v70, v83 quad_perm:[1,0,3,2] row_mask:0xf bank_mask:0xf
    v_fma_f32 v83, v83, v9, v70
    v_mov_b32_dpp v70, v47 quad_perm:[1,0,3,2] row_mask:0xf bank_mask:0xf
    v_fma_f32 v47, v47, v9, v70
    v_mov_b32_dpp v70, v78 quad_perm:[1,0,3,2] row_mask:0xf bank_mask:0xf
    v_fma_f32 v78, v78, v9, v70
    v_mov_b32_dpp v70, v51 quad_perm:[1,0,3,2] row_mask:0xf bank_mask:0xf
    v_fma_f32 v51, v51, v9, v70
    v_mov_b32_dpp v70, v76 quad_perm:[1,0,3,2] row_mask:0xf bank_mask:0xf
    v_fma_f32 v76, v76, v9, v70
    v_mov_b32_dpp v70, v45 quad_perm:[1,0,3,2] row_mask:0xf bank_mask:0xf
    v_fma_f32 v45, v45, v9, v70
    v_mov_b32_dpp v70, v18 quad_perm:[1,0,3,2] row_mask:0xf bank_mask:0xf
    v_fma_f32 v18, v18, v9, v70
    v_mov_b32_dpp v70, v53 quad_perm:[1,0,3,2] row_mask:0xf bank_mask:0xf
    v_fma_f32 v53, v53, v9, v70
    v_mov_b32_dpp v70, v72 quad_perm:[1,0,3,2] row_mask:0xf bank_mask:0xf
    v_fma_f32 v72, v72, v9, v70
    v_mov_b32_dpp v70, v55 quad_perm:[1,0,3,2] row_mask:0xf bank_mask:0xf
    v_fma_f32 v55, v55, v9, v70
    v_mov_b32_dpp v70, v20 quad_perm:[1,0,3,2] row_mask:0xf bank_mask:0xf
    v_fma_f32 v20, v20, v9, v70
    v_mov_b32_dpp v70, v59 quad_perm:[1,0,3,2] row_mask:0xf bank_mask:0xf
    v_fma_f32 v59, v59, v9, v70
    v_mul_f32 v70, 0x3c800000, v10
    v_cos_f32 v79, v70
    v_sin_f32 v22, v70
    s_nop 0
    v_mul_f32 v26, v16, v79
    v_fma_f32 v26, -v49, v22, v26
    v_mul_f32 v49, v49, v79
    v_fmac_f32 v49, v16, v22
    v_mul_f32 v70, 0x3d000000, v10
    v_cos_f32 v79, v70
    v_sin_f32 v22, v70
    s_nop 0
    v_mul_f32 v16, v74, v79
    v_fma_f32 v16, -v19, v22, v16
    v_mul_f32 v19, v19, v79
    v_fmac_f32 v19, v74, v22
    v_mul_f32 v70, 0x3d400000, v10
    v_cos_f32 v79, v70
    v_sin_f32 v22, v70
    s_nop 0
    v_mul_f32 v74, v48, v79
    v_fma_f32 v74, -v23, v22, v74
    v_mul_f32 v23, v23, v79
    v_fmac_f32 v23, v48, v22
    v_mul_f32 v70, 0x3d800000, v10
    v_cos_f32 v79, v70
    v_sin_f32 v22, v70
    s_nop 0
    v_mul_f32 v48, v68, v79
    v_fma_f32 v48, -v27, v22, v48
    v_mul_f32 v27, v27, v79
    v_fmac_f32 v27, v68, v22
    v_mul_f32 v70, 0x3da00000, v10
    v_cos_f32 v79, v70
    v_sin_f32 v22, v70
    s_nop 0
    v_mul_f32 v68, v62, v79
    v_fma_f32 v68, -v39, v22, v68
    v_mul_f32 v39, v39, v79
    v_fmac_f32 v39, v62, v22
    v_mul_f32 v70, 0x3dc00000, v10
    v_cos_f32 v79, v70
    v_sin_f32 v22, v70
    s_nop 0
    v_mul_f32 v62, v66, v79
    v_fma_f32 v62, -v29, v22, v62
    v_mul_f32 v29, v29, v79
    v_fmac_f32 v29, v66, v22
    v_mul_f32 v70, 0x3de00000, v10
    v_cos_f32 v79, v70
    v_sin_f32 v22, v70
    s_nop 0
    v_mul_f32 v66, v54, v79
    v_fma_f32 v66, -v37, v22, v66
    v_mul_f32 v37, v37, v79
    v_fmac_f32 v37, v54, v22
    v_mul_f32 v70, 0x3e000000, v10
    v_cos_f32 v79, v70
    v_sin_f32 v22, v70
    s_nop 0
    v_mul_f32 v54, v44, v79
    v_fma_f32 v54, -v43, v22, v54
    v_mul_f32 v43, v43, v79
    v_fmac_f32 v43, v44, v22
    v_mul_f32 v70, 0x3e100000, v10
    v_cos_f32 v79, v70
    v_sin_f32 v22, v70
    s_nop 0
    v_mul_f32 v44, v52, v79
    v_fma_f32 v44, -v71, v22, v44
    v_mul_f32 v71, v71, v79
    v_fmac_f32 v71, v52, v22
    v_mul_f32 v70, 0x3e200000, v10
    v_cos_f32 v79, v70
    v_sin_f32 v22, v70
    s_nop 0
    v_mul_f32 v52, v58, v79
    v_fma_f32 v52, -v61, v22, v52
    v_mul_f32 v61, v61, v79
    v_fmac_f32 v61, v58, v22
    v_mul_f32 v70, 0x3e300000, v10
    v_cos_f32 v79, v70
    v_sin_f32 v22, v70
    s_nop 0
    v_mul_f32 v58, v38, v79
    v_fma_f32 v58, -v69, v22, v58
    v_mul_f32 v69, v69, v79
    v_fmac_f32 v69, v38, v22
    v_mul_f32 v70, 0x3e400000, v10
    v_cos_f32 v79, v70
    v_sin_f32 v22, v70
    s_nop 0
    v_mul_f32 v38, v28, v79
    v_fma_f32 v38, -v41, v22, v38
    v_mul_f32 v41, v41, v79
    v_fmac_f32 v41, v28, v22
    v_mul_f32 v70, 0x3e500000, v10
    v_cos_f32 v79, v70
    v_sin_f32 v22, v70
    s_nop 0
    v_mul_f32 v28, v36, v79
    v_fma_f32 v28, -v57, v22, v28
    v_mul_f32 v57, v57, v79
    v_fmac_f32 v57, v36, v22
    v_mul_f32 v70, 0x3e600000, v10
    v_cos_f32 v79, v70
    v_sin_f32 v22, v70
    s_nop 0
    v_mul_f32 v36, v64, v79
    v_fma_f32 v36, -v63, v22, v36
    v_mul_f32 v63, v63, v79
    v_fmac_f32 v63, v64, v22
    v_mul_f32 v70, 0x3e700000, v10
    v_cos_f32 v79, v70
    v_sin_f32 v22, v70
    s_nop 0
    v_mul_f32 v64, v24, v79
    v_fma_f32 v64, -v67, v22, v64
    v_mul_f32 v67, v67, v79
    v_fmac_f32 v67, v24, v22
    v_mul_f32 v70, 0x3e800000, v10
    v_cos_f32 v79, v70
    v_sin_f32 v22, v70
    s_nop 0
    v_mul_f32 v24, v30, v79
    v_fma_f32 v24, -v75, v22, v24
    v_mul_f32 v75, v75, v79
    v_fmac_f32 v75, v30, v22
    v_mul_f32 v70, 0x3e880000, v10
    v_cos_f32 v79, v70
    v_sin_f32 v22, v70
    s_nop 0
    v_mul_f32 v30, v34, v79
    v_fma_f32 v30, -v77, v22, v30
    v_mul_f32 v77, v77, v79
    v_fmac_f32 v77, v34, v22
    v_mul_f32 v70, 0x3e900000, v10
    v_cos_f32 v79, v70
    v_sin_f32 v22, v70
    s_nop 0
    v_mul_f32 v34, v42, v79
    v_fma_f32 v34, -v73, v22, v34
    v_mul_f32 v73, v73, v79
    v_fmac_f32 v73, v42, v22
    v_mul_f32 v70, 0x3e980000, v10
    v_cos_f32 v79, v70
    v_sin_f32 v22, v70
    s_nop 0
    v_mul_f32 v42, v60, v79
    v_fma_f32 v42, -v21, v22, v42
    v_mul_f32 v21, v21, v79
    v_fmac_f32 v21, v60, v22
    v_mul_f32 v70, 0x3ea00000, v10
    v_cos_f32 v79, v70
    v_sin_f32 v22, v70
    s_nop 0
    v_mul_f32 v60, v40, v79
    v_fma_f32 v60, -v65, v22, v60
    v_mul_f32 v65, v65, v79
    v_fmac_f32 v65, v40, v22
    v_mul_f32 v70, 0x3ea80000, v10
    v_cos_f32 v79, v70
    v_sin_f32 v22, v70
    s_nop 0
    v_mul_f32 v40, v56, v79
    v_fma_f32 v40, -v25, v22, v40
    v_mul_f32 v25, v25, v79
    v_fmac_f32 v25, v56, v22
    v_mul_f32 v70, 0x3eb00000, v10
    v_cos_f32 v79, v70
    v_sin_f32 v22, v70
    s_nop 0
    v_mul_f32 v56, v80, v79
    v_fma_f32 v56, -v31, v22, v56
    v_mul_f32 v31, v31, v79
    v_fmac_f32 v31, v80, v22
    v_mul_f32 v70, 0x3eb80000, v10
    v_cos_f32 v79, v70
    v_sin_f32 v22, v70
    s_nop 0
    v_mul_f32 v80, v32, v79
    v_fma_f32 v80, -v35, v22, v80
    v_mul_f32 v35, v35, v79
    v_fmac_f32 v35, v32, v22
    v_mul_f32 v70, 0x3ec00000, v10
    v_cos_f32 v79, v70
    v_sin_f32 v22, v70
    s_nop 0
    v_mul_f32 v32, v46, v79
    v_fma_f32 v32, -v81, v22, v32
    v_mul_f32 v81, v81, v79
    v_fmac_f32 v81, v46, v22
    v_mul_f32 v70, 0x3ec80000, v10
    v_cos_f32 v79, v70
    v_sin_f32 v22, v70
    s_nop 0
    v_mul_f32 v46, v50, v79
    v_fma_f32 v46, -v33, v22, v46
    v_mul_f32 v33, v33, v79
    v_fmac_f32 v33, v50, v22
    v_mul_f32 v70, 0x3ed00000, v10
    v_cos_f32 v79, v70
    v_sin_f32 v22, v70
    s_nop 0
    v_mul_f32 v50, v83, v79
    v_fma_f32 v50, -v47, v22, v50
    v_mul_f32 v47, v47, v79
    v_fmac_f32 v47, v83, v22
    v_mul_f32 v70, 0x3ed80000, v10
    v_cos_f32 v79, v70
    v_sin_f32 v22, v70
    s_nop 0
    v_mul_f32 v83, v78, v79
    v_fma_f32 v83, -v51, v22, v83
    v_mul_f32 v51, v51, v79
    v_fmac_f32 v51, v78, v22
    v_mul_f32 v70, 0x3ee00000, v10
    v_cos_f32 v79, v70
    v_sin_f32 v22, v70
    s_nop 0
    v_mul_f32 v78, v76, v79
    v_fma_f32 v78, -v45, v22, v78
    v_mul_f32 v45, v45, v79
    v_fmac_f32 v45, v76, v22
    v_mul_f32 v70, 0x3ee80000, v10
    v_cos_f32 v79, v70
    v_sin_f32 v22, v70
    s_nop 0
    v_mul_f32 v76, v18, v79
    v_fma_f32 v76, -v53, v22, v76
    v_mul_f32 v53, v53, v79
    v_fmac_f32 v53, v18, v22
    v_mul_f32 v70, 0x3ef00000, v10
    v_cos_f32 v79, v70
    v_sin_f32 v22, v70
    s_nop 0
    v_mul_f32 v18, v72, v79
    v_fma_f32 v18, -v55, v22, v18
    v_mul_f32 v55, v55, v79
    v_fmac_f32 v55, v72, v22
    v_mul_f32 v70, 0x3ef80000, v10
    v_cos_f32 v79, v70
    v_sin_f32 v22, v70
    s_nop 0
    v_mul_f32 v72, v20, v79
    v_fma_f32 v72, -v59, v22, v72
    v_mul_f32 v59, v59, v79
    v_fmac_f32 v59, v20, v22
    v_sub_f32 v70, v82, v24
    v_sub_f32 v79, v17, v75
    v_add_f32 v82, v82, v24
    v_add_f32 v17, v17, v75
    v_sub_f32 v24, v26, v30
    v_sub_f32 v75, v49, v77
    v_add_f32 v26, v26, v30
    v_add_f32 v49, v49, v77
    v_mul_f32 v30, 0x3f7b14be, v24
    v_mul_f32 v77, 0x3e47c5c2, v24
    v_fmac_f32 v30, 0xbe47c5c2, v75
    v_fmac_f32 v77, 0x3f7b14be, v75
    v_sub_f32 v24, v16, v34
    v_sub_f32 v75, v19, v73
    v_add_f32 v16, v16, v34
    v_add_f32 v19, v19, v73
    v_mul_f32 v34, 0x3f6c835e, v24
    v_mul_f32 v73, 0x3ec3ef15, v24
    v_fmac_f32 v34, 0xbec3ef15, v75
    v_fmac_f32 v73, 0x3f6c835e, v75
    v_sub_f32 v24, v74, v42
    v_sub_f32 v75, v23, v21
    v_add_f32 v74, v74, v42
    v_add_f32 v23, v23, v21
    v_mul_f32 v42, 0x3f54db31, v24
    v_mul_f32 v21, 0x3f0e39da, v24
    v_fmac_f32 v42, 0xbf0e39da, v75
    v_fmac_f32 v21, 0x3f54db31, v75
    v_sub_f32 v24, v48, v60
    v_sub_f32 v75, v27, v65
    v_add_f32 v48, v48, v60
    v_add_f32 v27, v27, v65
    v_mul_f32 v60, 0x3f3504f3, v24
    v_mul_f32 v65, 0x3f3504f3, v24
    v_fmac_f32 v60, 0xbf3504f3, v75
    v_fmac_f32 v65, 0x3f3504f3, v75
    v_sub_f32 v24, v68, v40
    v_sub_f32 v75, v39, v25
    v_add_f32 v68, v68, v40
    v_add_f32 v39, v39, v25
    v_mul_f32 v40, 0x3f0e39da, v24
    v_mul_f32 v25, 0x3f54db31, v24
    v_fmac_f32 v40, 0xbf54db31, v75
    v_fmac_f32 v25, 0x3f0e39da, v75
    v_sub_f32 v24, v62, v56
    v_sub_f32 v75, v29, v31
    v_add_f32 v62, v62, v56
    v_add_f32 v29, v29, v31
    v_mul_f32 v56, 0x3ec3ef15, v24
    v_mul_f32 v31, 0x3f6c835e, v24
    v_fmac_f32 v56, 0xbf6c835e, v75
    v_fmac_f32 v31, 0x3ec3ef15, v75
    v_sub_f32 v24, v66, v80
    v_sub_f32 v75, v37, v35
    v_add_f32 v66, v66, v80
    v_add_f32 v37, v37, v35
    v_mul_f32 v80, 0x3e47c5c2, v24
    v_mul_f32 v35, 0x3f7b14be, v24
    v_fmac_f32 v80, 0xbf7b14be, v75
    v_fmac_f32 v35, 0x3e47c5c2, v75
    v_sub_f32 v24, v81, v43
    v_sub_f32 v75, v54, v32
    v_add_f32 v54, v54, v32
    v_add_f32 v43, v43, v81
    v_sub_f32 v32, v44, v46
    v_sub_f32 v81, v71, v33
    v_add_f32 v44, v44, v46
    v_add_f32 v71, v71, v33
    v_mul_f32 v46, 0xbe47c5c2, v32
    v_mul_f32 v33, 0x3f7b14be, v32
    v_fmac_f32 v46, 0xbf7b14be, v81
    v_fmac_f32 v33, 0xbe47c5c2, v81
    v_sub_f32 v32, v52, v50
    v_sub_f32 v81, v61, v47
    v_add_f32 v52, v52, v50
    v_add_f32 v61, v61, v47
    v_mul_f32 v50, 0xbec3ef15, v32
    v_mul_f32 v47, 0x3f6c835e, v32
    v_fmac_f32 v50, 0xbf6c835e, v81
    v_fmac_f32 v47, 0xbec3ef15, v81
    v_sub_f32 v32, v58, v83
    v_sub_f32 v81, v69, v51
    v_add_f32 v58, v58, v83
    v_add_f32 v69, v69, v51
    v_mul_f32 v83, 0xbf0e39da, v32
    v_mul_f32 v51, 0x3f54db31, v32
    v_fmac_f32 v83, 0xbf54db31, v81
    v_fmac_f32 v51, 0xbf0e39da, v81
    v_sub_f32 v32, v38, v78
    v_sub_f32 v81, v41, v45
    v_add_f32 v38, v38, v78
    v_add_f32 v41, v41, v45
    v_mul_f32 v78, 0xbf3504f3, v32
    v_mul_f32 v45, 0x3f3504f3, v32
    v_fmac_f32 v78, 0xbf3504f3, v81
    v_fmac_f32 v45, 0xbf3504f3, v81
    v_sub_f32 v32, v28, v76
    v_sub_f32 v81, v57, v53
    v_add_f32 v28, v28, v76
    v_add_f32 v57, v57, v53
    v_mul_f32 v76, 0xbf54db31, v32
    v_mul_f32 v53, 0x3f0e39da, v32
    v_fmac_f32 v76, 0xbf0e39da, v81
    v_fmac_f32 v53, 0xbf54db31, v81
    v_sub_f32 v32, v36, v18
    v_sub_f32 v81, v63, v55
    v_add_f32 v36, v36, v18
    v_add_f32 v63, v63, v55
    v_mul_f32 v18, 0xbf6c835e, v32
    v_mul_f32 v55, 0x3ec3ef15, v32
    v_fmac_f32 v18, 0xbec3ef15, v81
    v_fmac_f32 v55, 0xbf6c835e, v81
    v_sub_f32 v32, v64, v72
    v_sub_f32 v81, v67, v59
    v_add_f32 v64, v64, v72
    v_add_f32 v67, v67, v59
    v_mul_f32 v72, 0xbf7b14be, v32
    v_mul_f32 v59, 0x3e47c5c2, v32
    v_fmac_f32 v72, 0xbe47c5c2, v81
    v_fmac_f32 v59, 0xbf7b14be, v81
    v_sub_f32 v32, v82, v54
    v_sub_f32 v81, v17, v43
    v_add_f32 v82, v82, v54
    v_add_f32 v17, v17, v43
    v_sub_f32 v54, v26, v44
    v_sub_f32 v43, v49, v71
    v_add_f32 v26, v26, v44
    v_add_f32 v49, v49, v71
    v_mul_f32 v44, 0x3f6c835e, v54
    v_mul_f32 v71, 0x3ec3ef15, v54
    v_fmac_f32 v44, 0xbec3ef15, v43
    v_fmac_f32 v71, 0x3f6c835e, v43
    v_sub_f32 v54, v16, v52
    v_sub_f32 v43, v19, v61
    v_add_f32 v16, v16, v52
    v_add_f32 v19, v19, v61
    v_mul_f32 v52, 0x3f3504f3, v54
    v_mul_f32 v61, 0x3f3504f3, v54
    v_fmac_f32 v52, 0xbf3504f3, v43
    v_fmac_f32 v61, 0x3f3504f3, v43
    v_sub_f32 v54, v74, v58
    v_sub_f32 v43, v23, v69
    v_add_f32 v74, v74, v58
    v_add_f32 v23, v23, v69
    v_mul_f32 v58, 0x3ec3ef15, v54
    v_mul_f32 v69, 0x3f6c835e, v54
    v_fmac_f32 v58, 0xbf6c835e, v43
    v_fmac_f32 v69, 0x3ec3ef15, v43
    v_sub_f32 v54, v41, v27
    v_sub_f32 v43, v48, v38
    v_add_f32 v48, v48, v38
    v_add_f32 v27, v27, v41
    v_sub_f32 v38, v68, v28
    v_sub_f32 v41, v39, v57
    v_add_f32 v68, v68, v28
    v_add_f32 v39, v39, v57
    v_mul_f32 v28, 0xbec3ef15, v38
    v_mul_f32 v57, 0x3f6c835e, v38
    v_fmac_f32 v28, 0xbf6c835e, v41
    v_fmac_f32 v57, 0xbec3ef15, v41
    v_sub_f32 v38, v62, v36
    v_sub_f32 v41, v29, v63
    v_add_f32 v62, v62, v36
    v_add_f32 v29, v29, v63
    v_mul_f32 v36, 0xbf3504f3, v38
    v_mul_f32 v63, 0x3f3504f3, v38
    v_fmac_f32 v36, 0xbf3504f3, v41
    v_fmac_f32 v63, 0xbf3504f3, v41
    v_sub_f32 v38, v66, v64
    v_sub_f32 v41, v37, v67
    v_add_f32 v66, v66, v64
    v_add_f32 v37, v37, v67
    v_mul_f32 v64, 0xbf6c835e, v38
    v_mul_f32 v67, 0x3ec3ef15, v38
    v_fmac_f32 v64, 0xbec3ef15, v41
    v_fmac_f32 v67, 0xbf6c835e, v41
    v_sub_f32 v38, v70, v24
    v_sub_f32 v41, v79, v75
    v_add_f32 v70, v70, v24
    v_add_f32 v79, v79, v75
    v_sub_f32 v24, v30, v46
    v_sub_f32 v75, v77, v33
    v_add_f32 v30, v30, v46
    v_add_f32 v77, v77, v33
    v_mul_f32 v46, 0x3f6c835e, v24
    v_mul_f32 v33, 0x3ec3ef15, v24
    v_fmac_f32 v46, 0xbec3ef15, v75
    v_fmac_f32 v33, 0x3f6c835e, v75
    v_sub_f32 v24, v34, v50
    v_sub_f32 v75, v73, v47
    v_add_f32 v34, v34, v50
    v_add_f32 v73, v73, v47
    v_mul_f32 v50, 0x3f3504f3, v24
    v_mul_f32 v47, 0x3f3504f3, v24
    v_fmac_f32 v50, 0xbf3504f3, v75
    v_fmac_f32 v47, 0x3f3504f3, v75
    v_sub_f32 v24, v42, v83
    v_sub_f32 v75, v21, v51
    v_add_f32 v42, v42, v83
    v_add_f32 v21, v21, v51
    v_mul_f32 v83, 0x3ec3ef15, v24
    v_mul_f32 v51, 0x3f6c835e, v24
    v_fmac_f32 v83, 0xbf6c835e, v75
    v_fmac_f32 v51, 0x3ec3ef15, v75
    v_sub_f32 v24, v45, v65
    v_sub_f32 v75, v60, v78
    v_add_f32 v60, v60, v78
    v_add_f32 v65, v65, v45
    v_sub_f32 v78, v40, v76
    v_sub_f32 v45, v25, v53
    v_add_f32 v40, v40, v76
    v_add_f32 v25, v25, v53
    v_mul_f32 v76, 0xbec3ef15, v78
    v_mul_f32 v53, 0x3f6c835e, v78
    v_fmac_f32 v76, 0xbf6c835e, v45
    v_fmac_f32 v53, 0xbec3ef15, v45
    v_sub_f32 v78, v56, v18
    v_sub_f32 v45, v31, v55
    v_add_f32 v56, v56, v18
    v_add_f32 v31, v31, v55
    v_mul_f32 v18, 0xbf3504f3, v78
    v_mul_f32 v55, 0x3f3504f3, v78
    v_fmac_f32 v18, 0xbf3504f3, v45
    v_fmac_f32 v55, 0xbf3504f3, v45
    v_sub_f32 v78, v80, v72
    v_sub_f32 v45, v35, v59
    v_add_f32 v80, v80, v72
    v_add_f32 v35, v35, v59
    v_mul_f32 v72, 0xbf6c835e, v78
    v_mul_f32 v59, 0x3ec3ef15, v78
    v_fmac_f32 v72, 0xbec3ef15, v45
    v_fmac_f32 v59, 0xbf6c835e, v45
    v_sub_f32 v78, v82, v48
    v_sub_f32 v45, v17, v27
    v_add_f32 v82, v82, v48
    v_add_f32 v17, v17, v27
    v_sub_f32 v48, v26, v68
    v_sub_f32 v27, v49, v39
    v_add_f32 v26, v26, v68
    v_add_f32 v49, v49, v39
    v_mul_f32 v68, 0x3f3504f3, v48
    v_mul_f32 v39, 0x3f3504f3, v48
    v_fmac_f32 v68, 0xbf3504f3, v27
    v_fmac_f32 v39, 0x3f3504f3, v27
    v_sub_f32 v48, v29, v19
    v_sub_f32 v27, v16, v62
    v_add_f32 v16, v16, v62
    v_add_f32 v19, v19, v29
    v_sub_f32 v62, v74, v66
    v_sub_f32 v29, v23, v37
    v_add_f32 v74, v74, v66
    v_add_f32 v23, v23, v37
    v_mul_f32 v66, 0xbf3504f3, v62
    v_mul_f32 v37, 0x3f3504f3, v62
    v_fmac_f32 v66, 0xbf3504f3, v29
    v_fmac_f32 v37, 0xbf3504f3, v29
    v_sub_f32 v62, v32, v54
    v_sub_f32 v29, v81, v43
    v_add_f32 v32, v32, v54
    v_add_f32 v81, v81, v43
    v_sub_f32 v54, v44, v28
    v_sub_f32 v43, v71, v57
    v_add_f32 v44, v44, v28
    v_add_f32 v71, v71, v57
    v_mul_f32 v28, 0x3f3504f3, v54
    v_mul_f32 v57, 0x3f3504f3, v54
    v_fmac_f32 v28, 0xbf3504f3, v43
    v_fmac_f32 v57, 0x3f3504f3, v43
    v_sub_f32 v54, v63, v61
    v_sub_f32 v43, v52, v36
    v_add_f32 v52, v52, v36
    v_add_f32 v61, v61, v63
    v_sub_f32 v36, v58, v64
    v_sub_f32 v63, v69, v67
    v_add_f32 v58, v58, v64
    v_add_f32 v69, v69, v67
    v_mul_f32 v64, 0xbf3504f3, v36
    v_mul_f32 v67, 0x3f3504f3, v36
    v_fmac_f32 v64, 0xbf3504f3, v63
    v_fmac_f32 v67, 0xbf3504f3, v63
    v_sub_f32 v36, v70, v60
    v_sub_f32 v63, v79, v65
    v_add_f32 v70, v70, v60
    v_add_f32 v79, v79, v65
    v_sub_f32 v60, v30, v40
    v_sub_f32 v65, v77, v25
    v_add_f32 v30, v30, v40
    v_add_f32 v77, v77, v25
    v_mul_f32 v40, 0x3f3504f3, v60
    v_mul_f32 v25, 0x3f3504f3, v60
    v_fmac_f32 v40, 0xbf3504f3, v65
    v_fmac_f32 v25, 0x3f3504f3, v65
    v_sub_f32 v60, v31, v73
    v_sub_f32 v65, v34, v56
    v_add_f32 v34, v34, v56
    v_add_f32 v73, v73, v31
    v_sub_f32 v56, v42, v80
    v_sub_f32 v31, v21, v35
    v_add_f32 v42, v42, v80
    v_add_f32 v21, v21, v35
    v_mul_f32 v80, 0xbf3504f3, v56
    v_mul_f32 v35, 0x3f3504f3, v56
    v_fmac_f32 v80, 0xbf3504f3, v31
    v_fmac_f32 v35, 0xbf3504f3, v31
    v_sub_f32 v56, v38, v24
    v_sub_f32 v31, v41, v75
    v_add_f32 v38, v38, v24
    v_add_f32 v41, v41, v75
    v_sub_f32 v24, v46, v76
    v_sub_f32 v75, v33, v53
    v_add_f32 v46, v46, v76
    v_add_f32 v33, v33, v53
    v_mul_f32 v76, 0x3f3504f3, v24
    v_mul_f32 v53, 0x3f3504f3, v24
    v_fmac_f32 v76, 0xbf3504f3, v75
    v_fmac_f32 v53, 0x3f3504f3, v75
    v_sub_f32 v24, v55, v47
    v_sub_f32 v75, v50, v18
    v_add_f32 v50, v50, v18
    v_add_f32 v47, v47, v55
    v_sub_f32 v18, v83, v72
    v_sub_f32 v55, v51, v59
    v_add_f32 v83, v83, v72
    v_add_f32 v51, v51, v59
    v_mul_f32 v72, 0xbf3504f3, v18
    v_mul_f32 v59, 0x3f3504f3, v18
    v_fmac_f32 v72, 0xbf3504f3, v55
    v_fmac_f32 v59, 0xbf3504f3, v55
    v_sub_f32 v18, v82, v16
    v_sub_f32 v55, v17, v19
    v_add_f32 v82, v82, v16
    v_add_f32 v17, v17, v19
    v_sub_f32 v16, v23, v49
    v_sub_f32 v19, v26, v74
    v_add_f32 v26, v26, v74
    v_add_f32 v49, v49, v23
    v_sub_f32 v74, v78, v48
    v_sub_f32 v23, v45, v27
    v_add_f32 v78, v78, v48
    v_add_f32 v45, v45, v27
    v_sub_f32 v48, v37, v39
    v_sub_f32 v27, v68, v66
    v_add_f32 v68, v68, v66
    v_add_f32 v39, v39, v37
    v_sub_f32 v66, v32, v52
    v_sub_f32 v37, v81, v61
    v_add_f32 v32, v32, v52
    v_add_f32 v81, v81, v61
    v_sub_f32 v52, v69, v71
    v_sub_f32 v61, v44, v58
    v_add_f32 v44, v44, v58
    v_add_f32 v71, v71, v69
    v_sub_f32 v58, v62, v54
    v_sub_f32 v69, v29, v43
    v_add_f32 v62, v62, v54
    v_add_f32 v29, v29, v43
    v_sub_f32 v54, v67, v57
    v_sub_f32 v43, v28, v64
    v_add_f32 v28, v28, v64
    v_add_f32 v57, v57, v67
    v_sub_f32 v64, v70, v34
    v_sub_f32 v67, v79, v73
    v_add_f32 v70, v70, v34
    v_add_f32 v79, v79, v73
    v_sub_f32 v34, v21, v77
    v_sub_f32 v73, v30, v42
    v_add_f32 v30, v30, v42
    v_add_f32 v77, v77, v21
    v_sub_f32 v42, v36, v60
    v_sub_f32 v21, v63, v65
    v_add_f32 v36, v36, v60
    v_add_f32 v63, v63, v65
    v_sub_f32 v60, v35, v25
    v_sub_f32 v65, v40, v80
    v_add_f32 v40, v40, v80
    v_add_f32 v25, v25, v35
    v_sub_f32 v80, v38, v50
    v_sub_f32 v35, v41, v47
    v_add_f32 v38, v38, v50
    v_add_f32 v41, v41, v47
    v_sub_f32 v50, v51, v33
    v_sub_f32 v47, v46, v83
    v_add_f32 v46, v46, v83
    v_add_f32 v33, v33, v51
    v_sub_f32 v83, v56, v24
    v_sub_f32 v51, v31, v75
    v_add_f32 v56, v56, v24
    v_add_f32 v31, v31, v75
    v_sub_f32 v24, v59, v53
    v_sub_f32 v75, v76, v72
    v_add_f32 v76, v76, v72
    v_add_f32 v53, v53, v59
    v_sub_f32 v72, v82, v26
    v_sub_f32 v59, v17, v49
    v_add_f32 v82, v82, v26
    v_add_f32 v17, v17, v49
    v_sub_f32 v26, v18, v16
    v_sub_f32 v49, v55, v19
    v_add_f32 v18, v18, v16
    v_add_f32 v55, v55, v19
    v_sub_f32 v16, v78, v68
    v_sub_f32 v19, v45, v39
    v_add_f32 v78, v78, v68
    v_add_f32 v45, v45, v39
    v_sub_f32 v68, v74, v48
    v_sub_f32 v39, v23, v27
    v_add_f32 v74, v74, v48
    v_add_f32 v23, v23, v27
    v_sub_f32 v48, v32, v44
    v_sub_f32 v27, v81, v71
    v_add_f32 v32, v32, v44
    v_add_f32 v81, v81, v71
    v_sub_f32 v44, v66, v52
    v_sub_f32 v71, v37, v61
    v_add_f32 v66, v66, v52
    v_add_f32 v37, v37, v61
    v_sub_f32 v52, v62, v28
    v_sub_f32 v61, v29, v57
    v_add_f32 v62, v62, v28
    v_add_f32 v29, v29, v57
    v_sub_f32 v28, v58, v54
    v_sub_f32 v57, v69, v43
    v_add_f32 v58, v58, v54
    v_add_f32 v69, v69, v43
    v_sub_f32 v54, v70, v30
    v_sub_f32 v43, v79, v77
    v_add_f32 v70, v70, v30
    v_add_f32 v79, v79, v77
    v_sub_f32 v30, v64, v34
    v_sub_f32 v77, v67, v73
    v_add_f32 v64, v64, v34
    v_add_f32 v67, v67, v73
    v_sub_f32 v34, v36, v40
    v_sub_f32 v73, v63, v25
    v_add_f32 v36, v36, v40
    v_add_f32 v63, v63, v25
    v_sub_f32 v40, v42, v60
    v_sub_f32 v25, v21, v65
    v_add_f32 v42, v42, v60
    v_add_f32 v21, v21, v65
    v_sub_f32 v60, v38, v46
    v_sub_f32 v65, v41, v33
    v_add_f32 v38, v38, v46
    v_add_f32 v41, v41, v33
    v_sub_f32 v46, v80, v50
    v_sub_f32 v33, v35, v47
    v_add_f32 v80, v80, v50
    v_add_f32 v35, v35, v47
    v_sub_f32 v50, v56, v76
    v_sub_f32 v47, v31, v53
    v_add_f32 v56, v56, v76
    v_add_f32 v31, v31, v53
    v_sub_f32 v76, v83, v24
    v_sub_f32 v53, v51, v75
    v_add_f32 v83, v83, v24
    v_add_f32 v51, v51, v75
    v_mul_f32 v12, v10, v8
    v_mul_f32 v12, 0x3a000000, v12
    v_mov_b32 v24, v12
    v_fmac_f32 v24, 0x00000000, v8
    v_cos_f32 v75, v24
    v_sin_f32 v22, v24
    s_nop 0
    v_mul_f32 v20, v82, v75
    v_fma_f32 v20, -v17, v22, v20
    v_mul_f32 v17, v17, v75
    v_fmac_f32 v17, v82, v22
    v_mov_b32 v24, v12
    v_fmac_f32 v24, 0x3a800000, v8
    v_cos_f32 v75, v24
    v_sin_f32 v22, v24
    s_nop 0
    v_mul_f32 v82, v70, v75
    v_fma_f32 v82, -v79, v22, v82
    v_mul_f32 v79, v79, v75
    v_fmac_f32 v79, v70, v22
    v_mov_b32 v24, v12
    v_fmac_f32 v24, 0x3b000000, v8
    v_cos_f32 v75, v24
    v_sin_f32 v22, v24
    s_nop 0
    v_mul_f32 v70, v32, v75
    v_fma_f32 v70, -v81, v22, v70
    v_mul_f32 v81, v81, v75
    v_fmac_f32 v81, v32, v22
    v_mov_b32 v24, v12
    v_fmac_f32 v24, 0x3b400000, v8
    v_cos_f32 v75, v24
    v_sin_f32 v22, v24
    s_nop 0
    v_mul_f32 v32, v38, v75
    v_fma_f32 v32, -v41, v22, v32
    v_mul_f32 v41, v41, v75
    v_fmac_f32 v41, v38, v22
    v_mov_b32 v24, v12
    v_fmac_f32 v24, 0x3b800000, v8
    v_cos_f32 v75, v24
    v_sin_f32 v22, v24
    s_nop 0
    v_mul_f32 v38, v78, v75
    v_fma_f32 v38, -v45, v22, v38
    v_mul_f32 v45, v45, v75
    v_fmac_f32 v45, v78, v22
    v_mov_b32 v24, v12
    v_fmac_f32 v24, 0x3ba00000, v8
    v_cos_f32 v75, v24
    v_sin_f32 v22, v24
    s_nop 0
    v_mul_f32 v78, v36, v75
    v_fma_f32 v78, -v63, v22, v78
    v_mul_f32 v63, v63, v75
    v_fmac_f32 v63, v36, v22
    v_mov_b32 v24, v12
    v_fmac_f32 v24, 0x3bc00000, v8
    v_cos_f32 v75, v24
    v_sin_f32 v22, v24
    s_nop 0
    v_mul_f32 v36, v62, v75
    v_fma_f32 v36, -v29, v22, v36
    v_mul_f32 v29, v29, v75
    v_fmac_f32 v29, v62, v22
    v_mov_b32 v24, v12
    v_fmac_f32 v24, 0x3be00000, v8
    v_cos_f32 v75, v24
    v_sin_f32 v22, v24
    s_nop 0
    v_mul_f32 v62, v56, v75
    v_fma_f32 v62, -v31, v22, v62
    v_mul_f32 v31, v31, v75
    v_fmac_f32 v31, v56, v22
    v_mov_b32 v24, v12
    v_fmac_f32 v24, 0x3c000000, v8
    v_cos_f32 v75, v24
    v_sin_f32 v22, v24
    s_nop 0
    v_mul_f32 v56, v18, v75
    v_fma_f32 v56, -v55, v22, v56
    v_mul_f32 v55, v55, v75
    v_fmac_f32 v55, v18, v22
    v_mov_b32 v24, v12
    v_fmac_f32 v24, 0x3c100000, v8
    v_cos_f32 v75, v24
    v_sin_f32 v22, v24
    s_nop 0
    v_mul_f32 v18, v64, v75
    v_fma_f32 v18, -v67, v22, v18
    v_mul_f32 v67, v67, v75
    v_fmac_f32 v67, v64, v22
    v_mov_b32 v24, v12
    v_fmac_f32 v24, 0x3c200000, v8
    v_cos_f32 v75, v24
    v_sin_f32 v22, v24
    s_nop 0
    v_mul_f32 v64, v66, v75
    v_fma_f32 v64, -v37, v22, v64
    v_mul_f32 v37, v37, v75
    v_fmac_f32 v37, v66, v22
    v_mov_b32 v24, v12
    v_fmac_f32 v24, 0x3c300000, v8
    v_cos_f32 v75, v24
    v_sin_f32 v22, v24
    s_nop 0
    v_mul_f32 v66, v80, v75
    v_fma_f32 v66, -v35, v22, v66
    v_mul_f32 v35, v35, v75
    v_fmac_f32 v35, v80, v22
    v_mov_b32 v24, v12
    v_fmac_f32 v24, 0x3c400000, v8
    v_cos_f32 v75, v24
    v_sin_f32 v22, v24
    s_nop 0
    v_mul_f32 v80, v74, v75
    v_fma_f32 v80, -v23, v22, v80
    v_mul_f32 v23, v23, v75
    v_fmac_f32 v23, v74, v22
    v_mov_b32 v24, v12
    v_fmac_f32 v24, 0x3c500000, v8
    v_cos_f32 v75, v24
    v_sin_f32 v22, v24
    s_nop 0
    v_mul_f32 v74, v42, v75
    v_fma_f32 v74, -v21, v22, v74
    v_mul_f32 v21, v21, v75
    v_fmac_f32 v21, v42, v22
    v_mov_b32 v24, v12
    v_fmac_f32 v24, 0x3c600000, v8
    v_cos_f32 v75, v24
    v_sin_f32 v22, v24
    s_nop 0
    v_mul_f32 v42, v58, v75
    v_fma_f32 v42, -v69, v22, v42
    v_mul_f32 v69, v69, v75
    v_fmac_f32 v69, v58, v22
    v_mov_b32 v24, v12
    v_fmac_f32 v24, 0x3c700000, v8
    v_cos_f32 v75, v24
    v_sin_f32 v22, v24
    s_nop 0
    v_mul_f32 v58, v83, v75
    v_fma_f32 v58, -v51, v22, v58
    v_mul_f32 v51, v51, v75
    v_fmac_f32 v51, v83, v22
    v_mov_b32 v24, v12
    v_fmac_f32 v24, 0x3c800000, v8
    v_cos_f32 v75, v24
    v_sin_f32 v22, v24
    s_nop 0
    v_mul_f32 v83, v72, v75
    v_fma_f32 v83, -v59, v22, v83
    v_mul_f32 v59, v59, v75
    v_fmac_f32 v59, v72, v22
    v_mov_b32 v24, v12
    v_fmac_f32 v24, 0x3c880000, v8
    v_cos_f32 v75, v24
    v_sin_f32 v22, v24
    s_nop 0
    v_mul_f32 v72, v54, v75
    v_fma_f32 v72, -v43, v22, v72
    v_mul_f32 v43, v43, v75
    v_fmac_f32 v43, v54, v22
    v_mov_b32 v24, v12
    v_fmac_f32 v24, 0x3c900000, v8
    v_cos_f32 v75, v24
    v_sin_f32 v22, v24
    s_nop 0
    v_mul_f32 v54, v48, v75
    v_fma_f32 v54, -v27, v22, v54
    v_mul_f32 v27, v27, v75
    v_fmac_f32 v27, v48, v22
    v_mov_b32 v24, v12
    v_fmac_f32 v24, 0x3c980000, v8
    v_cos_f32 v75, v24
    v_sin_f32 v22, v24
    s_nop 0
    v_mul_f32 v48, v60, v75
    v_fma_f32 v48, -v65, v22, v48
    v_mul_f32 v65, v65, v75
    v_fmac_f32 v65, v60, v22
    v_mov_b32 v24, v12
    v_fmac_f32 v24, 0x3ca00000, v8
    v_cos_f32 v75, v24
    v_sin_f32 v22, v24
    s_nop 0
    v_mul_f32 v60, v16, v75
    v_fma_f32 v60, -v19, v22, v60
    v_mul_f32 v19, v19, v75
    v_fmac_f32 v19, v16, v22
    v_mov_b32 v24, v12
    v_fmac_f32 v24, 0x3ca80000, v8
    v_cos_f32 v75, v24
    v_sin_f32 v22, v24
    s_nop 0
    v_mul_f32 v16, v34, v75
    v_fma_f32 v16, -v73, v22, v16
    v_mul_f32 v73, v73, v75
    v_fmac_f32 v73, v34, v22
    v_mov_b32 v24, v12
    v_fmac_f32 v24, 0x3cb00000, v8
    v_cos_f32 v75, v24
    v_sin_f32 v22, v24
    s_nop 0
    v_mul_f32 v34, v52, v75
    v_fma_f32 v34, -v61, v22, v34
    v_mul_f32 v61, v61, v75
    v_fmac_f32 v61, v52, v22
    v_mov_b32 v24, v12
    v_fmac_f32 v24, 0x3cb80000, v8
    v_cos_f32 v75, v24
    v_sin_f32 v22, v24
    s_nop 0
    v_mul_f32 v52, v50, v75
    v_fma_f32 v52, -v47, v22, v52
    v_mul_f32 v47, v47, v75
    v_fmac_f32 v47, v50, v22
    v_mov_b32 v24, v12
    v_fmac_f32 v24, 0x3cc00000, v8
    v_cos_f32 v75, v24
    v_sin_f32 v22, v24
    s_nop 0
    v_mul_f32 v50, v26, v75
    v_fma_f32 v50, -v49, v22, v50
    v_mul_f32 v49, v49, v75
    v_fmac_f32 v49, v26, v22
    v_mov_b32 v24, v12
    v_fmac_f32 v24, 0x3cc80000, v8
    v_cos_f32 v75, v24
    v_sin_f32 v22, v24
    s_nop 0
    v_mul_f32 v26, v30, v75
    v_fma_f32 v26, -v77, v22, v26
    v_mul_f32 v77, v77, v75
    v_fmac_f32 v77, v30, v22
    v_mov_b32 v24, v12
    v_fmac_f32 v24, 0x3cd00000, v8
    v_cos_f32 v75, v24
    v_sin_f32 v22, v24
    s_nop 0
    v_mul_f32 v30, v44, v75
    v_fma_f32 v30, -v71, v22, v30
    v_mul_f32 v71, v71, v75
    v_fmac_f32 v71, v44, v22
    v_mov_b32 v24, v12
    v_fmac_f32 v24, 0x3cd80000, v8
    v_cos_f32 v75, v24
    v_sin_f32 v22, v24
    s_nop 0
    v_mul_f32 v44, v46, v75
    v_fma_f32 v44, -v33, v22, v44
    v_mul_f32 v33, v33, v75
    v_fmac_f32 v33, v46, v22
    v_mov_b32 v24, v12
    v_fmac_f32 v24, 0x3ce00000, v8
    v_cos_f32 v75, v24
    v_sin_f32 v22, v24
    s_nop 0
    v_mul_f32 v46, v68, v75
    v_fma_f32 v46, -v39, v22, v46
    v_mul_f32 v39, v39, v75
    v_fmac_f32 v39, v68, v22
    v_mov_b32 v24, v12
    v_fmac_f32 v24, 0x3ce80000, v8
    v_cos_f32 v75, v24
    v_sin_f32 v22, v24
    s_nop 0
    v_mul_f32 v68, v40, v75
    v_fma_f32 v68, -v25, v22, v68
    v_mul_f32 v25, v25, v75
    v_fmac_f32 v25, v40, v22
    v_mov_b32 v24, v12
    v_fmac_f32 v24, 0x3cf00000, v8
    v_cos_f32 v75, v24
    v_sin_f32 v22, v24
    s_nop 0
    v_mul_f32 v40, v28, v75
    v_fma_f32 v40, -v57, v22, v40
    v_mul_f32 v57, v57, v75
    v_fmac_f32 v57, v28, v22
    v_mov_b32 v24, v12
    v_fmac_f32 v24, 0x3cf80000, v8
    v_cos_f32 v75, v24
    v_sin_f32 v22, v24
    s_nop 0
    v_mul_f32 v28, v76, v75
    v_fma_f32 v28, -v53, v22, v28
    v_mul_f32 v53, v53, v75
    v_fmac_f32 v53, v76, v22
    ds_write_b32 v4, v20 offset:0
    ds_write_b32 v4, v17 offset:4
    ds_write_b32 v4, v82 offset:16
    ds_write_b32 v4, v79 offset:20
    ds_write_b32 v4, v70 offset:32
    ds_write_b32 v4, v81 offset:36
    ds_write_b32 v4, v32 offset:48
    ds_write_b32 v4, v41 offset:52
    ds_write_b32 v4, v38 offset:64
    ds_write_b32 v4, v45 offset:68
    ds_write_b32 v4, v78 offset:80
    ds_write_b32 v4, v63 offset:84
    ds_write_b32 v4, v36 offset:96
    ds_write_b32 v4, v29 offset:100
    ds_write_b32 v4, v62 offset:112
    ds_write_b32 v4, v31 offset:116
    ds_write_b32 v4, v56 offset:128
    ds_write_b32 v4, v55 offset:132
    ds_write_b32 v4, v18 offset:144
    ds_write_b32 v4, v67 offset:148
    ds_write_b32 v4, v64 offset:160
    ds_write_b32 v4, v37 offset:164
    ds_write_b32 v4, v66 offset:176
    ds_write_b32 v4, v35 offset:180
    ds_write_b32 v4, v80 offset:192
    ds_write_b32 v4, v23 offset:196
    ds_write_b32 v4, v74 offset:208
    ds_write_b32 v4, v21 offset:212
    ds_write_b32 v4, v42 offset:224
    ds_write_b32 v4, v69 offset:228
    ds_write_b32 v4, v58 offset:240
    ds_write_b32 v4, v51 offset:244
    ds_write_b32 v4, v83 offset:256
    ds_write_b32 v4, v59 offset:260
    ds_write_b32 v4, v72 offset:272
    ds_write_b32 v4, v43 offset:276
    ds_write_b32 v4, v54 offset:288
    ds_write_b32 v4, v27 offset:292
    ds_write_b32 v4, v48 offset:304
    ds_write_b32 v4, v65 offset:308
    ds_write_b32 v4, v60 offset:320
    ds_write_b32 v4, v19 offset:324
    ds_write_b32 v4, v16 offset:336
    ds_write_b32 v4, v73 offset:340
    ds_write_b32 v4, v34 offset:352
    ds_write_b32 v4, v61 offset:356
    ds_write_b32 v4, v52 offset:368
    ds_write_b32 v4, v47 offset:372
    ds_write_b32 v4, v50 offset:384
    ds_write_b32 v4, v49 offset:388
    ds_write_b32 v4, v26 offset:400
    ds_write_b32 v4, v77 offset:404
    ds_write_b32 v4, v30 offset:416
    ds_write_b32 v4, v71 offset:420
    ds_write_b32 v4, v44 offset:432
    ds_write_b32 v4, v33 offset:436
    ds_write_b32 v4, v46 offset:448
    ds_write_b32 v4, v39 offset:452
    ds_write_b32 v4, v68 offset:464
    ds_write_b32 v4, v25 offset:468
    ds_write_b32 v4, v40 offset:480
    ds_write_b32 v4, v57 offset:484
    ds_write_b32 v4, v28 offset:496
    ds_write_b32 v4, v53 offset:500
    s_waitcnt lgkmcnt(0)
    ds_read_b32 v20, v3 offset:0
    ds_read_b32 v17, v3 offset:4
    ds_read_b32 v82, v3 offset:528
    ds_read_b32 v79, v3 offset:532
    ds_read_b32 v70, v3 offset:1056
    ds_read_b32 v81, v3 offset:1060
    ds_read_b32 v32, v3 offset:1584
    ds_read_b32 v41, v3 offset:1588
    ds_read_b32 v38, v3 offset:2112
    ds_read_b32 v45, v3 offset:2116
    ds_read_b32 v78, v3 offset:2640
    ds_read_b32 v63, v3 offset:2644
    ds_read_b32 v36, v3 offset:3168
    ds_read_b32 v29, v3 offset:3172
    s_waitcnt lgkmcnt(0)
    ds_read_b32 v62, v3 offset:3696
    ds_read_b32 v31, v3 offset:3700
    ds_read_b32 v56, v3 offset:4224
    ds_read_b32 v55, v3 offset:4228
    ds_read_b32 v18, v3 offset:4752
    ds_read_b32 v67, v3 offset:4756
    ds_read_b32 v64, v3 offset:5280
    ds_read_b32 v37, v3 offset:5284
    ds_read_b32 v66, v3 offset:5808
    ds_read_b32 v35, v3 offset:5812
    ds_read_b32 v80, v3 offset:6336
    ds_read_b32 v23, v3 offset:6340
    ds_read_b32 v74, v3 offset:6864
    ds_read_b32 v21, v3 offset:6868
    s_waitcnt lgkmcnt(0)
    ds_read_b32 v42, v3 offset:7392
    ds_read_b32 v69, v3 offset:7396
    ds_read_b32 v58, v3 offset:7920
    ds_read_b32 v51, v3 offset:7924
    ds_read_b32 v83, v3 offset:8448
    ds_read_b32 v59, v3 offset:8452
    ds_read_b32 v72, v3 offset:8976
    ds_read_b32 v43, v3 offset:8980
    ds_read_b32 v54, v3 offset:9504
    ds_read_b32 v27, v3 offset:9508
    ds_read_b32 v48, v3 offset:10032
    ds_read_b32 v65, v3 offset:10036
    ds_read_b32 v60, v3 offset:10560
    ds_read_b32 v19, v3 offset:10564
    s_waitcnt lgkmcnt(0)
    ds_read_b32 v16, v3 offset:11088
    ds_read_b32 v73, v3 offset:11092
    ds_read_b32 v34, v3 offset:11616
    ds_read_b32 v61, v3 offset:11620
    ds_read_b32 v52, v3 offset:12144
    ds_read_b32 v47, v3 offset:12148
    ds_read_b32 v50, v3 offset:12672
    ds_read_b32 v49, v3 offset:12676
    ds_read_b32 v26, v3 offset:13200
    ds_read_b32 v77, v3 offset:13204
    ds_read_b32 v30, v3 offset:13728
    ds_read_b32 v71, v3 offset:13732
    ds_read_b32 v44, v3 offset:14256
    ds_read_b32 v33, v3 offset:14260
    s_waitcnt lgkmcnt(0)
    ds_read_b32 v46, v3 offset:14784
    ds_read_b32 v39, v3 offset:14788
    ds_read_b32 v68, v3 offset:15312
    ds_read_b32 v25, v3 offset:15316
    ds_read_b32 v40, v3 offset:15840
    ds_read_b32 v57, v3 offset:15844
    ds_read_b32 v28, v3 offset:16368
    ds_read_b32 v53, v3 offset:16372
    s_waitcnt lgkmcnt(0)
    v_sub_f32 v24, v20, v83
    v_sub_f32 v75, v17, v59
    v_add_f32 v20, v20, v83
    v_add_f32 v17, v17, v59
    v_sub_f32 v83, v82, v72
    v_sub_f32 v59, v79, v43
    v_add_f32 v82, v82, v72
    v_add_f32 v79, v79, v43
    v_mul_f32 v72, 0x3f7b14be, v83
    v_mul_f32 v43, 0x3e47c5c2, v83
    v_fmac_f32 v72, 0xbe47c5c2, v59
    v_fmac_f32 v43, 0x3f7b14be, v59
    v_sub_f32 v83, v70, v54
    v_sub_f32 v59, v81, v27
    v_add_f32 v70, v70, v54
    v_add_f32 v81, v81, v27
    v_mul_f32 v54, 0x3f6c835e, v83
    v_mul_f32 v27, 0x3ec3ef15, v83
    v_fmac_f32 v54, 0xbec3ef15, v59
    v_fmac_f32 v27, 0x3f6c835e, v59
    v_sub_f32 v83, v32, v48
    v_sub_f32 v59, v41, v65
    v_add_f32 v32, v32, v48
    v_add_f32 v41, v41, v65
    v_mul_f32 v48, 0x3f54db31, v83
    v_mul_f32 v65, 0x3f0e39da, v83
    v_fmac_f32 v48, 0xbf0e39da, v59
    v_fmac_f32 v65, 0x3f54db31, v59
    v_sub_f32 v83, v38, v60
    v_sub_f32 v59, v45, v19
    v_add_f32 v38, v38, v60
    v_add_f32 v45, v45, v19
    v_mul_f32 v60, 0x3f3504f3, v83
    v_mul_f32 v19, 0x3f3504f3, v83
    v_fmac_f32 v60, 0xbf3504f3, v59
    v_fmac_f32 v19, 0x3f3504f3, v59
    v_sub_f32 v83, v78, v16
    v_sub_f32 v59, v63, v73
    v_add_f32 v78, v78, v16
    v_add_f32 v63, v63, v73
    v_mul_f32 v16, 0x3f0e39da, v83
    v_mul_f32 v73, 0x3f54db31, v83
    v_fmac_f32 v16, 0xbf54db31, v59
    v_fmac_f32 v73, 0x3f0e39da, v59
    v_sub_f32 v83, v36, v34
    v_sub_f32 v59, v29, v61
    v_add_f32 v36, v36, v34
    v_add_f32 v29, v29, v61
    v_mul_f32 v34, 0x3ec3ef15, v83
    v_mul_f32 v61, 0x3f6c835e, v83
    v_fmac_f32 v34, 0xbf6c835e, v59
    v_fmac_f32 v61, 0x3ec3ef15, v59
    v_sub_f32 v83, v62, v52
    v_sub_f32 v59, v31, v47
    v_add_f32 v62, v62, v52
    v_add_f32 v31, v31, v47
    v_mul_f32 v52, 0x3e47c5c2, v83
    v_mul_f32 v47, 0x3f7b14be, v83
    v_fmac_f32 v52, 0xbf7b14be, v59
    v_fmac_f32 v47, 0x3e47c5c2, v59
    v_sub_f32 v83, v49, v55
    v_sub_f32 v59, v56, v50
    v_add_f32 v56, v56, v50
    v_add_f32 v55, v55, v49
    v_sub_f32 v50, v18, v26
    v_sub_f32 v49, v67, v77
    v_add_f32 v18, v18, v26
    v_add_f32 v67, v67, v77
    v_mul_f32 v26, 0xbe47c5c2, v50
    v_mul_f32 v77, 0x3f7b14be, v50
    v_fmac_f32 v26, 0xbf7b14be, v49
    v_fmac_f32 v77, 0xbe47c5c2, v49
    v_sub_f32 v50, v64, v30
    v_sub_f32 v49, v37, v71
    v_add_f32 v64, v64, v30
    v_add_f32 v37, v37, v71
    v_mul_f32 v30, 0xbec3ef15, v50
    v_mul_f32 v71, 0x3f6c835e, v50
    v_fmac_f32 v30, 0xbf6c835e, v49
    v_fmac_f32 v71, 0xbec3ef15, v49
    v_sub_f32 v50, v66, v44
    v_sub_f32 v49, v35, v33
    v_add_f32 v66, v66, v44
    v_add_f32 v35, v35, v33
    v_mul_f32 v44, 0xbf0e39da, v50
    v_mul_f32 v33, 0x3f54db31, v50
    v_fmac_f32 v44, 0xbf54db31, v49
    v_fmac_f32 v33, 0xbf0e39da, v49
    v_sub_f32 v50, v80, v46
    v_sub_f32 v49, v23, v39
    v_add_f32 v80, v80, v46
    v_add_f32 v23, v23, v39
    v_mul_f32 v46, 0xbf3504f3, v50
    v_mul_f32 v39, 0x3f3504f3, v50
    v_fmac_f32 v46, 0xbf3504f3, v49
    v_fmac_f32 v39, 0xbf3504f3, v49
    v_sub_f32 v50, v74, v68
    v_sub_f32 v49, v21, v25
    v_add_f32 v74, v74, v68
    v_add_f32 v21, v21, v25
    v_mul_f32 v68, 0xbf54db31, v50
    v_mul_f32 v25, 0x3f0e39da, v50
    v_fmac_f32 v68, 0xbf0e39da, v49
    v_fmac_f32 v25, 0xbf54db31, v49
    v_sub_f32 v50, v42, v40
    v_sub_f32 v49, v69, v57
    v_add_f32 v42, v42, v40
    v_add_f32 v69, v69, v57
    v_mul_f32 v40, 0xbf6c835e, v50
    v_mul_f32 v57, 0x3ec3ef15, v50
    v_fmac_f32 v40, 0xbec3ef15, v49
    v_fmac_f32 v57, 0xbf6c835e, v49
    v_sub_f32 v50, v58, v28
    v_sub_f32 v49, v51, v53
    v_add_f32 v58, v58, v28
    v_add_f32 v51, v51, v53
    v_mul_f32 v28, 0xbf7b14be, v50
    v_mul_f32 v53, 0x3e47c5c2, v50
    v_fmac_f32 v28, 0xbe47c5c2, v49
    v_fmac_f32 v53, 0xbf7b14be, v49
    v_sub_f32 v50, v20, v56
    v_sub_f32 v49, v17, v55
    v_add_f32 v20, v20, v56
    v_add_f32 v17, v17, v55
    v_sub_f32 v56, v82, v18
    v_sub_f32 v55, v79, v67
    v_add_f32 v82, v82, v18
    v_add_f32 v79, v79, v67
    v_mul_f32 v18, 0x3f6c835e, v56
    v_mul_f32 v67, 0x3ec3ef15, v56
    v_fmac_f32 v18, 0xbec3ef15, v55
    v_fmac_f32 v67, 0x3f6c835e, v55
    v_sub_f32 v56, v70, v64
    v_sub_f32 v55, v81, v37
    v_add_f32 v70, v70, v64
    v_add_f32 v81, v81, v37
    v_mul_f32 v64, 0x3f3504f3, v56
    v_mul_f32 v37, 0x3f3504f3, v56
    v_fmac_f32 v64, 0xbf3504f3, v55
    v_fmac_f32 v37, 0x3f3504f3, v55
    v_sub_f32 v56, v32, v66
    v_sub_f32 v55, v41, v35
    v_add_f32 v32, v32, v66
    v_add_f32 v41, v41, v35
    v_mul_f32 v66, 0x3ec3ef15, v56
    v_mul_f32 v35, 0x3f6c835e, v56
    v_fmac_f32 v66, 0xbf6c835e, v55
    v_fmac_f32 v35, 0x3ec3ef15, v55
    v_sub_f32 v56, v23, v45
    v_sub_f32 v55, v38, v80
    v_add_f32 v38, v38, v80
    v_add_f32 v45, v45, v23
    v_sub_f32 v80, v78, v74
    v_sub_f32 v23, v63, v21
    v_add_f32 v78, v78, v74
    v_add_f32 v63, v63, v21
    v_mul_f32 v74, 0xbec3ef15, v80
    v_mul_f32 v21, 0x3f6c835e, v80
    v_fmac_f32 v74, 0xbf6c835e, v23
    v_fmac_f32 v21, 0xbec3ef15, v23
    v_sub_f32 v80, v36, v42
    v_sub_f32 v23, v29, v69
    v_add_f32 v36, v36, v42
    v_add_f32 v29, v29, v69
    v_mul_f32 v42, 0xbf3504f3, v80
    v_mul_f32 v69, 0x3f3504f3, v80
    v_fmac_f32 v42, 0xbf3504f3, v23
    v_fmac_f32 v69, 0xbf3504f3, v23
    v_sub_f32 v80, v62, v58
    v_sub_f32 v23, v31, v51
    v_add_f32 v62, v62, v58
    v_add_f32 v31, v31, v51
    v_mul_f32 v58, 0xbf6c835e, v80
    v_mul_f32 v51, 0x3ec3ef15, v80
    v_fmac_f32 v58, 0xbec3ef15, v23
    v_fmac_f32 v51, 0xbf6c835e, v23
    v_sub_f32 v80, v24, v83
    v_sub_f32 v23, v75, v59
    v_add_f32 v24, v24, v83
    v_add_f32 v75, v75, v59
    v_sub_f32 v83, v72, v26
    v_sub_f32 v59, v43, v77
    v_add_f32 v72, v72, v26
    v_add_f32 v43, v43, v77
    v_mul_f32 v26, 0x3f6c835e, v83
    v_mul_f32 v77, 0x3ec3ef15, v83
    v_fmac_f32 v26, 0xbec3ef15, v59
    v_fmac_f32 v77, 0x3f6c835e, v59
    v_sub_f32 v83, v54, v30
    v_sub_f32 v59, v27, v71
    v_add_f32 v54, v54, v30
    v_add_f32 v27, v27, v71
    v_mul_f32 v30, 0x3f3504f3, v83
    v_mul_f32 v71, 0x3f3504f3, v83
    v_fmac_f32 v30, 0xbf3504f3, v59
    v_fmac_f32 v71, 0x3f3504f3, v59
    v_sub_f32 v83, v48, v44
    v_sub_f32 v59, v65, v33
    v_add_f32 v48, v48, v44
    v_add_f32 v65, v65, v33
    v_mul_f32 v44, 0x3ec3ef15, v83
    v_mul_f32 v33, 0x3f6c835e, v83
    v_fmac_f32 v44, 0xbf6c835e, v59
    v_fmac_f32 v33, 0x3ec3ef15, v59
    v_sub_f32 v83, v39, v19
    v_sub_f32 v59, v60, v46
    v_add_f32 v60, v60, v46
    v_add_f32 v19, v19, v39
    v_sub_f32 v46, v16, v68
    v_sub_f32 v39, v73, v25
    v_add_f32 v16, v16, v68
    v_add_f32 v73, v73, v25
    v_mul_f32 v68, 0xbec3ef15, v46
    v_mul_f32 v25, 0x3f6c835e, v46
    v_fmac_f32 v68, 0xbf6c835e, v39
    v_fmac_f32 v25, 0xbec3ef15, v39
    v_sub_f32 v46, v34, v40
    v_sub_f32 v39, v61, v57
    v_add_f32 v34, v34, v40
    v_add_f32 v61, v61, v57
    v_mul_f32 v40, 0xbf3504f3, v46
    v_mul_f32 v57, 0x3f3504f3, v46
    v_fmac_f32 v40, 0xbf3504f3, v39
    v_fmac_f32 v57, 0xbf3504f3, v39
    v_sub_f32 v46, v52, v28
    v_sub_f32 v39, v47, v53
    v_add_f32 v52, v52, v28
    v_add_f32 v47, v47, v53
    v_mul_f32 v28, 0xbf6c835e, v46
    v_mul_f32 v53, 0x3ec3ef15, v46
    v_fmac_f32 v28, 0xbec3ef15, v39
    v_fmac_f32 v53, 0xbf6c835e, v39
    v_sub_f32 v46, v20, v38
    v_sub_f32 v39, v17, v45
    v_add_f32 v20, v20, v38
    v_add_f32 v17, v17, v45
    v_sub_f32 v38, v82, v78
    v_sub_f32 v45, v79, v63
    v_add_f32 v82, v82, v78
    v_add_f32 v79, v79, v63
    v_mul_f32 v78, 0x3f3504f3, v38
    v_mul_f32 v63, 0x3f3504f3, v38
    v_fmac_f32 v78, 0xbf3504f3, v45
    v_fmac_f32 v63, 0x3f3504f3, v45
    v_sub_f32 v38, v29, v81
    v_sub_f32 v45, v70, v36
    v_add_f32 v70, v70, v36
    v_add_f32 v81, v81, v29
    v_sub_f32 v36, v32, v62
    v_sub_f32 v29, v41, v31
    v_add_f32 v32, v32, v62
    v_add_f32 v41, v41, v31
    v_mul_f32 v62, 0xbf3504f3, v36
    v_mul_f32 v31, 0x3f3504f3, v36
    v_fmac_f32 v62, 0xbf3504f3, v29
    v_fmac_f32 v31, 0xbf3504f3, v29
    v_sub_f32 v36, v50, v56
    v_sub_f32 v29, v49, v55
    v_add_f32 v50, v50, v56
    v_add_f32 v49, v49, v55
    v_sub_f32 v56, v18, v74
    v_sub_f32 v55, v67, v21
    v_add_f32 v18, v18, v74
    v_add_f32 v67, v67, v21
    v_mul_f32 v74, 0x3f3504f3, v56
    v_mul_f32 v21, 0x3f3504f3, v56
    v_fmac_f32 v74, 0xbf3504f3, v55
    v_fmac_f32 v21, 0x3f3504f3, v55
    v_sub_f32 v56, v69, v37
    v_sub_f32 v55, v64, v42
    v_add_f32 v64, v64, v42
    v_add_f32 v37, v37, v69
    v_sub_f32 v42, v66, v58
    v_sub_f32 v69, v35, v51
    v_add_f32 v66, v66, v58
    v_add_f32 v35, v35, v51
    v_mul_f32 v58, 0xbf3504f3, v42
    v_mul_f32 v51, 0x3f3504f3, v42
    v_fmac_f32 v58, 0xbf3504f3, v69
    v_fmac_f32 v51, 0xbf3504f3, v69
    v_sub_f32 v42, v24, v60
    v_sub_f32 v69, v75, v19
    v_add_f32 v24, v24, v60
    v_add_f32 v75, v75, v19
    v_sub_f32 v60, v72, v16
    v_sub_f32 v19, v43, v73
    v_add_f32 v72, v72, v16
    v_add_f32 v43, v43, v73
    v_mul_f32 v16, 0x3f3504f3, v60
    v_mul_f32 v73, 0x3f3504f3, v60
    v_fmac_f32 v16, 0xbf3504f3, v19
    v_fmac_f32 v73, 0x3f3504f3, v19
    v_sub_f32 v60, v61, v27
    v_sub_f32 v19, v54, v34
    v_add_f32 v54, v54, v34
    v_add_f32 v27, v27, v61
    v_sub_f32 v34, v48, v52
    v_sub_f32 v61, v65, v47
    v_add_f32 v48, v48, v52
    v_add_f32 v65, v65, v47
    v_mul_f32 v52, 0xbf3504f3, v34
    v_mul_f32 v47, 0x3f3504f3, v34
    v_fmac_f32 v52, 0xbf3504f3, v61
    v_fmac_f32 v47, 0xbf3504f3, v61
    v_sub_f32 v34, v80, v83
    v_sub_f32 v61, v23, v59
    v_add_f32 v80, v80, v83
    v_add_f32 v23, v23, v59
    v_sub_f32 v83, v26, v68
    v_sub_f32 v59, v77, v25
    v_add_f32 v26, v26, v68
    v_add_f32 v77, v77, v25
    v_mul_f32 v68, 0x3f3504f3, v83
    v_mul_f32 v25, 0x3f3504f3, v83
    v_fmac_f32 v68, 0xbf3504f3, v59
    v_fmac_f32 v25, 0x3f3504f3, v59
    v_sub_f32 v83, v57, v71
    v_sub_f32 v59, v30, v40
    v_add_f32 v30, v30, v40
    v_add_f32 v71, v71, v57
    v_sub_f32 v40, v44, v28
    v_sub_f32 v57, v33, v53
    v_add_f32 v44, v44, v28
    v_add_f32 v33, v33, v53
    v_mul_f32 v28, 0xbf3504f3, v40
    v_mul_f32 v53, 0x3f3504f3, v40
    v_fmac_f32 v28, 0xbf3504f3, v57
    v_fmac_f32 v53, 0xbf3504f3, v57
    v_sub_f32 v40, v20, v70
    v_sub_f32 v57, v17, v81
    v_add_f32 v20, v20, v70
    v_add_f32 v17, v17, v81
    v_sub_f32 v70, v41, v79
    v_sub_f32 v81, v82, v32
    v_add_f32 v82, v82, v32
    v_add_f32 v79, v79, v41
    v_sub_f32 v32, v46, v38
    v_sub_f32 v41, v39, v45
    v_add_f32 v46, v46, v38
    v_add_f32 v39, v39, v45
    v_sub_f32 v38, v31, v63
    v_sub_f32 v45, v78, v62
    v_add_f32 v78, v78, v62
    v_add_f32 v63, v63, v31
    v_sub_f32 v62, v50, v64
    v_sub_f32 v31, v49, v37
    v_add_f32 v50, v50, v64
    v_add_f32 v49, v49, v37
    v_sub_f32 v64, v35, v67
    v_sub_f32 v37, v18, v66
    v_add_f32 v18, v18, v66
    v_add_f32 v67, v67, v35
    v_sub_f32 v66, v36, v56
    v_sub_f32 v35, v29, v55
    v_add_f32 v36, v36, v56
    v_add_f32 v29, v29, v55
    v_sub_f32 v56, v51, v21
    v_sub_f32 v55, v74, v58
    v_add_f32 v74, v74, v58
    v_add_f32 v21, v21, v51
    v_sub_f32 v58, v24, v54
    v_sub_f32 v51, v75, v27
    v_add_f32 v24, v24, v54
    v_add_f32 v75, v75, v27
    v_sub_f32 v54, v65, v43
    v_sub_f32 v27, v72, v48
    v_add_f32 v72, v72, v48
    v_add_f32 v43, v43, v65
    v_sub_f32 v48, v42, v60
    v_sub_f32 v65, v69, v19
    v_add_f32 v42, v42, v60
    v_add_f32 v69, v69, v19
    v_sub_f32 v60, v47, v73
    v_sub_f32 v19, v16, v52
    v_add_f32 v16, v16, v52
    v_add_f32 v73, v73, v47
    v_sub_f32 v52, v80, v30
    v_sub_f32 v47, v23, v71
    v_add_f32 v80, v80, v30
    v_add_f32 v23, v23, v71
    v_sub_f32 v30, v33, v77
    v_sub_f32 v71, v26, v44
    v_add_f32 v26, v26, v44
    v_add_f32 v77, v77, v33
    v_sub_f32 v44, v34, v83
    v_sub_f32 v33, v61, v59
    v_add_f32 v34, v34, v83
    v_add_f32 v61, v61, v59
    v_sub_f32 v83, v53, v25
    v_sub_f32 v59, v68, v28
    v_add_f32 v68, v68, v28
    v_add_f32 v25, v25, v53
    v_sub_f32 v28, v20, v82
    v_sub_f32 v53, v17, v79
    v_add_f32 v20, v20, v82
    v_add_f32 v17, v17, v79
    v_sub_f32 v82, v40, v70
    v_sub_f32 v79, v57, v81
    v_add_f32 v40, v40, v70
    v_add_f32 v57, v57, v81
    v_sub_f32 v70, v46, v78
    v_sub_f32 v81, v39, v63
    v_add_f32 v46, v46, v78
    v_add_f32 v39, v39, v63
    v_sub_f32 v78, v32, v38
    v_sub_f32 v63, v41, v45
    v_add_f32 v32, v32, v38
    v_add_f32 v41, v41, v45
    v_sub_f32 v38, v50, v18
    v_sub_f32 v45, v49, v67
    v_add_f32 v50, v50, v18
    v_add_f32 v49, v49, v67
    v_sub_f32 v18, v62, v64
    v_sub_f32 v67, v31, v37
    v_add_f32 v62, v62, v64
    v_add_f32 v31, v31, v37
    v_sub_f32 v64, v36, v74
    v_sub_f32 v37, v29, v21
    v_add_f32 v36, v36, v74
    v_add_f32 v29, v29, v21
    v_sub_f32 v74, v66, v56
    v_sub_f32 v21, v35, v55
    v_add_f32 v66, v66, v56
    v_add_f32 v35, v35, v55
    v_sub_f32 v56, v24, v72
    v_sub_f32 v55, v75, v43
    v_add_f32 v24, v24, v72
    v_add_f32 v75, v75, v43
    v_sub_f32 v72, v58, v54
    v_sub_f32 v43, v51, v27
    v_add_f32 v58, v58, v54
    v_add_f32 v51, v51, v27
    v_sub_f32 v54, v42, v16
    v_sub_f32 v27, v69, v73
    v_add_f32 v42, v42, v16
    v_add_f32 v69, v69, v73
    v_sub_f32 v16, v48, v60
    v_sub_f32 v73, v65, v19
    v_add_f32 v48, v48, v60
    v_add_f32 v65, v65, v19
    v_sub_f32 v60, v80, v26
    v_sub_f32 v19, v23, v77
    v_add_f32 v80, v80, v26
    v_add_f32 v23, v23, v77
    v_sub_f32 v26, v52, v30
    v_sub_f32 v77, v47, v71
    v_add_f32 v52, v52, v30
    v_add_f32 v47, v47, v71
    v_sub_f32 v30, v34, v68
    v_sub_f32 v71, v61, v25
    v_add_f32 v34, v34, v68
    v_add_f32 v61, v61, v25
    v_sub_f32 v68, v44, v83
    v_sub_f32 v25, v33, v59
    v_add_f32 v44, v44, v83
    v_add_f32 v33, v33, v59
    s_add_u32 s15, s14, 109051904
    v_lshlrev_b32 v5, 3, v1
    s_add_u32 s16, s15, 0
    v_mov_b32 v88, v20
    v_mov_b32 v89, v17
    buffer_store_dwordx2 v[88:89], v5, s[8:11], s16 offen sc1
    s_add_u32 s16, s15, 512
    v_mov_b32 v90, v24
    v_mov_b32 v91, v75
    buffer_store_dwordx2 v[90:91], v5, s[8:11], s16 offen sc1
    s_add_u32 s16, s15, 1024
    v_mov_b32 v92, v50
    v_mov_b32 v93, v49
    buffer_store_dwordx2 v[92:93], v5, s[8:11], s16 offen sc1
    s_add_u32 s16, s15, 1536
    v_mov_b32 v94, v80
    v_mov_b32 v95, v23
    buffer_store_dwordx2 v[94:95], v5, s[8:11], s16 offen sc1
    s_add_u32 s16, s15, 2048
    v_mov_b32 v96, v46
    v_mov_b32 v97, v39
    buffer_store_dwordx2 v[96:97], v5, s[8:11], s16 offen sc1
    s_add_u32 s16, s15, 2560
    v_mov_b32 v98, v42
    v_mov_b32 v99, v69
    buffer_store_dwordx2 v[98:99], v5, s[8:11], s16 offen sc1
    s_add_u32 s16, s15, 3072
    v_mov_b32 v100, v36
    v_mov_b32 v101, v29
    buffer_store_dwordx2 v[100:101], v5, s[8:11], s16 offen sc1
    s_add_u32 s16, s15, 3584
    v_mov_b32 v102, v34
    v_mov_b32 v103, v61
    buffer_store_dwordx2 v[102:103], v5, s[8:11], s16 offen sc1
    s_add_u32 s16, s15, 4096
    v_mov_b32 v88, v40
    v_mov_b32 v89, v57
    buffer_store_dwordx2 v[88:89], v5, s[8:11], s16 offen sc1
    s_add_u32 s16, s15, 4608
    v_mov_b32 v90, v58
    v_mov_b32 v91, v51
    buffer_store_dwordx2 v[90:91], v5, s[8:11], s16 offen sc1
    s_add_u32 s16, s15, 5120
    v_mov_b32 v92, v62
    v_mov_b32 v93, v31
    buffer_store_dwordx2 v[92:93], v5, s[8:11], s16 offen sc1
    s_add_u32 s16, s15, 5632
    v_mov_b32 v94, v52
    v_mov_b32 v95, v47
    buffer_store_dwordx2 v[94:95], v5, s[8:11], s16 offen sc1
    s_add_u32 s16, s15, 6144
    v_mov_b32 v96, v32
    v_mov_b32 v97, v41
    buffer_store_dwordx2 v[96:97], v5, s[8:11], s16 offen sc1
    s_add_u32 s16, s15, 6656
    v_mov_b32 v98, v48
    v_mov_b32 v99, v65
    buffer_store_dwordx2 v[98:99], v5, s[8:11], s16 offen sc1
    s_add_u32 s16, s15, 7168
    v_mov_b32 v100, v66
    v_mov_b32 v101, v35
    buffer_store_dwordx2 v[100:101], v5, s[8:11], s16 offen sc1
    s_add_u32 s16, s15, 7680
    v_mov_b32 v102, v44
    v_mov_b32 v103, v33
    buffer_store_dwordx2 v[102:103], v5, s[8:11], s16 offen sc1
    s_add_u32 s16, s15, 8192
    v_mov_b32 v88, v28
    v_mov_b32 v89, v53
    buffer_store_dwordx2 v[88:89], v5, s[8:11], s16 offen sc1
    s_add_u32 s16, s15, 8704
    v_mov_b32 v90, v56
    v_mov_b32 v91, v55
    buffer_store_dwordx2 v[90:91], v5, s[8:11], s16 offen sc1
    s_add_u32 s16, s15, 9216
    v_mov_b32 v92, v38
    v_mov_b32 v93, v45
    buffer_store_dwordx2 v[92:93], v5, s[8:11], s16 offen sc1
    s_add_u32 s16, s15, 9728
    v_mov_b32 v94, v60
    v_mov_b32 v95, v19
    buffer_store_dwordx2 v[94:95], v5, s[8:11], s16 offen sc1
    s_add_u32 s16, s15, 10240
    v_mov_b32 v96, v70
    v_mov_b32 v97, v81
    buffer_store_dwordx2 v[96:97], v5, s[8:11], s16 offen sc1
    s_add_u32 s16, s15, 10752
    v_mov_b32 v98, v54
    v_mov_b32 v99, v27
    buffer_store_dwordx2 v[98:99], v5, s[8:11], s16 offen sc1
    s_add_u32 s16, s15, 11264
    v_mov_b32 v100, v64
    v_mov_b32 v101, v37
    buffer_store_dwordx2 v[100:101], v5, s[8:11], s16 offen sc1
    s_add_u32 s16, s15, 11776
    v_mov_b32 v102, v30
    v_mov_b32 v103, v71
    buffer_store_dwordx2 v[102:103], v5, s[8:11], s16 offen sc1
    s_add_u32 s16, s15, 12288
    v_mov_b32 v88, v82
    v_mov_b32 v89, v79
    buffer_store_dwordx2 v[88:89], v5, s[8:11], s16 offen sc1
    s_add_u32 s16, s15, 12800
    v_mov_b32 v90, v72
    v_mov_b32 v91, v43
    buffer_store_dwordx2 v[90:91], v5, s[8:11], s16 offen sc1
    s_add_u32 s16, s15, 13312
    v_mov_b32 v92, v18
    v_mov_b32 v93, v67
    buffer_store_dwordx2 v[92:93], v5, s[8:11], s16 offen sc1
    s_add_u32 s16, s15, 13824
    v_mov_b32 v94, v26
    v_mov_b32 v95, v77
    buffer_store_dwordx2 v[94:95], v5, s[8:11], s16 offen sc1
    s_add_u32 s16, s15, 14336
    v_mov_b32 v96, v78
    v_mov_b32 v97, v63
    buffer_store_dwordx2 v[96:97], v5, s[8:11], s16 offen sc1
    s_add_u32 s16, s15, 14848
    v_mov_b32 v98, v16
    v_mov_b32 v99, v73
    buffer_store_dwordx2 v[98:99], v5, s[8:11], s16 offen sc1
    s_add_u32 s16, s15, 15360
    v_mov_b32 v100, v74
    v_mov_b32 v101, v21
    buffer_store_dwordx2 v[100:101], v5, s[8:11], s16 offen sc1
    s_add_u32 s16, s15, 15872
    v_mov_b32 v102, v68
    v_mov_b32 v103, v25
    buffer_store_dwordx2 v[102:103], v5, s[8:11], s16 offen sc1
mega_kernel_f2_end:
    s_waitcnt vmcnt(0)
    s_barrier
    v_mov_b32 v2, 1
    v_cmp_eq_u32 vcc, 0, v0
    s_and_saveexec_b64 s[80:81], vcc
    s_cbranch_execz mega_kernel_sg136_5
    buffer_atomic_add v2, off, s[88:91], 0 offset:136 sc1
mega_kernel_sg136_5:
    s_mov_b64 exec, s[80:81]
    s_cmp_eq_u32 s99, 0
    s_cbranch_scc0 mega_kernel_f2d
    s_mov_b32 s99, 128
    s_branch mega_kernel_f2l
mega_kernel_f2d:
mega_kernel_wf2:
    s_sleep 8
    buffer_load_dword v2, off, s[88:91], 0 offset:136 sc1
    s_waitcnt vmcnt(0)
    v_cmp_ne_u32 vcc, 129, v2
    s_cbranch_vccnz mega_kernel_wf2
    s_barrier
    s_load_dwordx2 s[4:5], s[0:1], 80
    s_load_dwordx2 s[8:9], s[0:1], 96
    v_and_b32 v6, 7, v0
    v_lshrrev_b32 v7, 3, v0
    s_movk_i32 s13, 8448
    v_mul_lo_u32 v8, v6, s13
    v_lshl_add_u32 v4, v7, 3, v8
    v_lshlrev_b32 v5, 14, v7
    v_lshl_add_u32 v5, v6, 4, v5
    s_lshl_b32 s12, s92, 7
    s_add_u32 s12, s12, 109051904
    s_waitcnt lgkmcnt(0)
    s_mov_b32 s6, 8388608
    s_mov_b32 s7, 0x00020000
    s_mov_b32 s10, 268435456
    s_mov_b32 s11, 0x00020000
    s_add_u32 s13, s12, 0
    buffer_load_dwordx4 v[16:19], v5, s[8:11], s13 offen
    s_add_u32 s13, s12, 524288
    buffer_load_dwordx4 v[20:23], v5, s[8:11], s13 offen
    s_add_u32 s13, s12, 1048576
    buffer_load_dwordx4 v[24:27], v5, s[8:11], s13 offen
    s_add_u32 s13, s12, 1572864
    buffer_load_dwordx4 v[28:31], v5, s[8:11], s13 offen
    s_add_u32 s13, s12, 2097152
    buffer_load_dwordx4 v[32:35], v5, s[8:11], s13 offen
    s_add_u32 s13, s12, 2621440
    buffer_load_dwordx4 v[36:39], v5, s[8:11], s13 offen
    s_add_u32 s13, s12, 3145728
    buffer_load_dwordx4 v[40:43], v5, s[8:11], s13 offen
    s_add_u32 s13, s12, 3670016
    buffer_load_dwordx4 v[44:47], v5, s[8:11], s13 offen
    s_add_u32 s13, s12, 4194304
    buffer_load_dwordx4 v[48:51], v5, s[8:11], s13 offen
    s_add_u32 s13, s12, 4718592
    buffer_load_dwordx4 v[52:55], v5, s[8:11], s13 offen
    s_add_u32 s13, s12, 5242880
    buffer_load_dwordx4 v[56:59], v5, s[8:11], s13 offen
    s_add_u32 s13, s12, 5767168
    buffer_load_dwordx4 v[60:63], v5, s[8:11], s13 offen
    s_add_u32 s13, s12, 6291456
    buffer_load_dwordx4 v[64:67], v5, s[8:11], s13 offen
    s_add_u32 s13, s12, 6815744
    buffer_load_dwordx4 v[68:71], v5, s[8:11], s13 offen
    s_add_u32 s13, s12, 7340032
    buffer_load_dwordx4 v[72:75], v5, s[8:11], s13 offen
    s_add_u32 s13, s12, 7864320
    buffer_load_dwordx4 v[76:79], v5, s[8:11], s13 offen
    s_add_u32 s13, s12, 8388608
    buffer_load_dwordx4 v[80:83], v5, s[8:11], s13 offen
    s_waitcnt vmcnt(0)
    v_cmp_eq_u32 vcc, 0, v7
    s_nop 1
    v_mov_b32 v9, 0
    v_cndmask_b32 v17, v17, v9, vcc
    v_cndmask_b32 v19, v19, v9, vcc
    v_cndmask_b32 v81, v81, v9, vcc
    v_cndmask_b32 v83, v83, v9, vcc
    v_sub_u32 v6, 1024, v7
    v_and_b32 v6, 1023, v6
    v_lshl_add_u32 v6, v6, 3, v8
    v_sub_f32 v10, v16, v19
    v_add_f32 v11, v17, v18
    v_add_f32 v12, v16, v19
    v_sub_f32 v13, v18, v17
    ds_write_b64 v4, v[10:11] offset:0
    ds_write_b64 v6, v[12:13]
    v_sub_u32 v6, 992, v7
    v_and_b32 v6, 1023, v6
    v_lshl_add_u32 v6, v6, 3, v8
    v_sub_f32 v10, v20, v23
    v_add_f32 v11, v21, v22
    v_add_f32 v12, v20, v23
    v_sub_f32 v13, v22, v21
    ds_write_b64 v4, v[10:11] offset:256
    ds_write_b64 v6, v[12:13]
    v_sub_u32 v6, 960, v7
    v_and_b32 v6, 1023, v6
    v_lshl_add_u32 v6, v6, 3, v8
    v_sub_f32 v10, v24, v27
    v_add_f32 v11, v25, v26
    v_add_f32 v12, v24, v27
    v_sub_f32 v13, v26, v25
    ds_write_b64 v4, v[10:11] offset:512
    ds_write_b64 v6, v[12:13]
    v_sub_u32 v6, 928, v7
    v_and_b32 v6, 1023, v6
    v_lshl_add_u32 v6, v6, 3, v8
    v_sub_f32 v10, v28, v31
    v_add_f32 v11, v29, v30
    v_add_f32 v12, v28, v31
    v_sub_f32 v13, v30, v29
    ds_write_b64 v4, v[10:11] offset:768
    ds_write_b64 v6, v[12:13]
    v_sub_u32 v6, 896, v7
    v_and_b32 v6, 1023, v6
    v_lshl_add_u32 v6, v6, 3, v8
    v_sub_f32 v10, v32, v35
    v_add_f32 v11, v33, v34
    v_add_f32 v12, v32, v35
    v_sub_f32 v13, v34, v33
    ds_write_b64 v4, v[10:11] offset:1024
    ds_write_b64 v6, v[12:13]
    v_sub_u32 v6, 864, v7
    v_and_b32 v6, 1023, v6
    v_lshl_add_u32 v6, v6, 3, v8
    v_sub_f32 v10, v36, v39
    v_add_f32 v11, v37, v38
    v_add_f32 v12, v36, v39
    v_sub_f32 v13, v38, v37
    ds_write_b64 v4, v[10:11] offset:1280
    ds_write_b64 v6, v[12:13]
    v_sub_u32 v6, 832, v7
    v_and_b32 v6, 1023, v6
    v_lshl_add_u32 v6, v6, 3, v8
    v_sub_f32 v10, v40, v43
    v_add_f32 v11, v41, v42
    v_add_f32 v12, v40, v43
    v_sub_f32 v13, v42, v41
    ds_write_b64 v4, v[10:11] offset:1536
    ds_write_b64 v6, v[12:13]
    v_sub_u32 v6, 800, v7
    v_and_b32 v6, 1023, v6
    v_lshl_add_u32 v6, v6, 3, v8
    v_sub_f32 v10, v44, v47
    v_add_f32 v11, v45, v46
    v_add_f32 v12, v44, v47
    v_sub_f32 v13, v46, v45
    ds_write_b64 v4, v[10:11] offset:1792
    ds_write_b64 v6, v[12:13]
    v_sub_u32 v6, 768, v7
    v_and_b32 v6, 1023, v6
    v_lshl_add_u32 v6, v6, 3, v8
    v_sub_f32 v10, v48, v51
    v_add_f32 v11, v49, v50
    v_add_f32 v12, v48, v51
    v_sub_f32 v13, v50, v49
    ds_write_b64 v4, v[10:11] offset:2048
    ds_write_b64 v6, v[12:13]
    v_sub_u32 v6, 736, v7
    v_and_b32 v6, 1023, v6
    v_lshl_add_u32 v6, v6, 3, v8
    v_sub_f32 v10, v52, v55
    v_add_f32 v11, v53, v54
    v_add_f32 v12, v52, v55
    v_sub_f32 v13, v54, v53
    ds_write_b64 v4, v[10:11] offset:2304
    ds_write_b64 v6, v[12:13]
    v_sub_u32 v6, 704, v7
    v_and_b32 v6, 1023, v6
    v_lshl_add_u32 v6, v6, 3, v8
    v_sub_f32 v10, v56, v59
    v_add_f32 v11, v57, v58
    v_add_f32 v12, v56, v59
    v_sub_f32 v13, v58, v57
    ds_write_b64 v4, v[10:11] offset:2560
    ds_write_b64 v6, v[12:13]
    v_sub_u32 v6, 672, v7
    v_and_b32 v6, 1023, v6
    v_lshl_add_u32 v6, v6, 3, v8
    v_sub_f32 v10, v60, v63
    v_add_f32 v11, v61, v62
    v_add_f32 v12, v60, v63
    v_sub_f32 v13, v62, v61
    ds_write_b64 v4, v[10:11] offset:2816
    ds_write_b64 v6, v[12:13]
    v_sub_u32 v6, 640, v7
    v_and_b32 v6, 1023, v6
    v_lshl_add_u32 v6, v6, 3, v8
    v_sub_f32 v10, v64, v67
    v_add_f32 v11, v65, v66
    v_add_f32 v12, v64, v67
    v_sub_f32 v13, v66, v65
    ds_write_b64 v4, v[10:11] offset:3072
    ds_write_b64 v6, v[12:13]
    v_sub_u32 v6, 608, v7
    v_and_b32 v6, 1023, v6
    v_lshl_add_u32 v6, v6, 3, v8
    v_sub_f32 v10, v68, v71
    v_add_f32 v11, v69, v70
    v_add_f32 v12, v68, v71
    v_sub_f32 v13, v70, v69
    ds_write_b64 v4, v[10:11] offset:3328
    ds_write_b64 v6, v[12:13]
    v_sub_u32 v6, 576, v7
    v_and_b32 v6, 1023, v6
    v_lshl_add_u32 v6, v6, 3, v8
    v_sub_f32 v10, v72, v75
    v_add_f32 v11, v73, v74
    v_add_f32 v12, v72, v75
    v_sub_f32 v13, v74, v73
    ds_write_b64 v4, v[10:11] offset:3584
    ds_write_b64 v6, v[12:13]
    v_sub_u32 v6, 544, v7
    v_and_b32 v6, 1023, v6
    v_lshl_add_u32 v6, v6, 3, v8
    v_sub_f32 v10, v76, v79
    v_add_f32 v11, v77, v78
    v_add_f32 v12, v76, v79
    v_sub_f32 v13, v78, v77
    ds_write_b64 v4, v[10:11] offset:3840
    ds_write_b64 v6, v[12:13]
    s_and_saveexec_b64 s[14:15], vcc
    v_sub_u32 v6, 512, v7
    v_and_b32 v6, 1023, v6
    v_lshl_add_u32 v6, v6, 3, v8
    v_sub_f32 v10, v80, v83
    v_add_f32 v11, v81, v82
    v_add_f32 v12, v80, v83
    v_sub_f32 v13, v82, v81
    ds_write_b64 v4, v[10:11] offset:4096
    ds_write_b64 v6, v[12:13]
    s_mov_b64 exec, s[14:15]
    s_waitcnt lgkmcnt(0)
    s_barrier
    v_and_b32 v1, 31, v0
    v_lshrrev_b32 v2, 5, v0
    v_cvt_f32_u32 v3, v1
    s_movk_i32 s13, 8448
    v_mul_lo_u32 v7, v2, s13
    v_lshl_add_u32 v4, v1, 3, v7
    s_movk_i32 s13, 264
    v_mul_lo_u32 v5, v1, s13
    v_add_u32 v5, v5, v7
    ds_read_b32 v16, v4 offset:0
    ds_read_b32 v48, v4 offset:4
    ds_read_b32 v17, v4 offset:256
    ds_read_b32 v49, v4 offset:260
    ds_read_b32 v18, v4 offset:512
    ds_read_b32 v50, v4 offset:516
    ds_read_b32 v19, v4 offset:768
    ds_read_b32 v51, v4 offset:772
    ds_read_b32 v20, v4 offset:1024
    ds_read_b32 v52, v4 offset:1028
    ds_read_b32 v21, v4 offset:1280
    ds_read_b32 v53, v4 offset:1284
    ds_read_b32 v22, v4 offset:1536
    ds_read_b32 v54, v4 offset:1540
    s_waitcnt lgkmcnt(0)
    ds_read_b32 v23, v4 offset:1792
    ds_read_b32 v55, v4 offset:1796
    ds_read_b32 v24, v4 offset:2048
    ds_read_b32 v56, v4 offset:2052
    ds_read_b32 v25, v4 offset:2304
    ds_read_b32 v57, v4 offset:2308
    ds_read_b32 v26, v4 offset:2560
    ds_read_b32 v58, v4 offset:2564
    ds_read_b32 v27, v4 offset:2816
    ds_read_b32 v59, v4 offset:2820
    ds_read_b32 v28, v4 offset:3072
    ds_read_b32 v60, v4 offset:3076
    ds_read_b32 v29, v4 offset:3328
    ds_read_b32 v61, v4 offset:3332
    s_waitcnt lgkmcnt(0)
    ds_read_b32 v30, v4 offset:3584
    ds_read_b32 v62, v4 offset:3588
    ds_read_b32 v31, v4 offset:3840
    ds_read_b32 v63, v4 offset:3844
    ds_read_b32 v32, v4 offset:4096
    ds_read_b32 v64, v4 offset:4100
    ds_read_b32 v33, v4 offset:4352
    ds_read_b32 v65, v4 offset:4356
    ds_read_b32 v34, v4 offset:4608
    ds_read_b32 v66, v4 offset:4612
    ds_read_b32 v35, v4 offset:4864
    ds_read_b32 v67, v4 offset:4868
    ds_read_b32 v36, v4 offset:5120
    ds_read_b32 v68, v4 offset:5124
    s_waitcnt lgkmcnt(0)
    ds_read_b32 v37, v4 offset:5376
    ds_read_b32 v69, v4 offset:5380
    ds_read_b32 v38, v4 offset:5632
    ds_read_b32 v70, v4 offset:5636
    ds_read_b32 v39, v4 offset:5888
    ds_read_b32 v71, v4 offset:5892
    ds_read_b32 v40, v4 offset:6144
    ds_read_b32 v72, v4 offset:6148
    ds_read_b32 v41, v4 offset:6400
    ds_read_b32 v73, v4 offset:6404
    ds_read_b32 v42, v4 offset:6656
    ds_read_b32 v74, v4 offset:6660
    ds_read_b32 v43, v4 offset:6912
    ds_read_b32 v75, v4 offset:6916
    s_waitcnt lgkmcnt(0)
    ds_read_b32 v44, v4 offset:7168
    ds_read_b32 v76, v4 offset:7172
    ds_read_b32 v45, v4 offset:7424
    ds_read_b32 v77, v4 offset:7428
    ds_read_b32 v46, v4 offset:7680
    ds_read_b32 v78, v4 offset:7684
    ds_read_b32 v47, v4 offset:7936
    ds_read_b32 v79, v4 offset:7940
    s_waitcnt lgkmcnt(0)
    v_sub_f32 v80, v16, v32
    v_sub_f32 v81, v48, v64
    v_add_f32 v16, v16, v32
    v_add_f32 v48, v48, v64
    v_sub_f32 v32, v17, v33
    v_sub_f32 v64, v49, v65
    v_add_f32 v17, v17, v33
    v_add_f32 v49, v49, v65
    v_mul_f32 v33, 0x3f7b14be, v32
    v_mul_f32 v65, 0x3e47c5c2, v32
    v_fmac_f32 v33, 0xbe47c5c2, v64
    v_fmac_f32 v65, 0x3f7b14be, v64
    v_sub_f32 v32, v18, v34
    v_sub_f32 v64, v50, v66
    v_add_f32 v18, v18, v34
    v_add_f32 v50, v50, v66
    v_mul_f32 v34, 0x3f6c835e, v32
    v_mul_f32 v66, 0x3ec3ef15, v32
    v_fmac_f32 v34, 0xbec3ef15, v64
    v_fmac_f32 v66, 0x3f6c835e, v64
    v_sub_f32 v32, v19, v35
    v_sub_f32 v64, v51, v67
    v_add_f32 v19, v19, v35
    v_add_f32 v51, v51, v67
    v_mul_f32 v35, 0x3f54db31, v32
    v_mul_f32 v67, 0x3f0e39da, v32
    v_fmac_f32 v35, 0xbf0e39da, v64
    v_fmac_f32 v67, 0x3f54db31, v64
    v_sub_f32 v32, v20, v36
    v_sub_f32 v64, v52, v68
    v_add_f32 v20, v20, v36
    v_add_f32 v52, v52, v68
    v_mul_f32 v36, 0x3f3504f3, v32
    v_mul_f32 v68, 0x3f3504f3, v32
    v_fmac_f32 v36, 0xbf3504f3, v64
    v_fmac_f32 v68, 0x3f3504f3, v64
    v_sub_f32 v32, v21, v37
    v_sub_f32 v64, v53, v69
    v_add_f32 v21, v21, v37
    v_add_f32 v53, v53, v69
    v_mul_f32 v37, 0x3f0e39da, v32
    v_mul_f32 v69, 0x3f54db31, v32
    v_fmac_f32 v37, 0xbf54db31, v64
    v_fmac_f32 v69, 0x3f0e39da, v64
    v_sub_f32 v32, v22, v38
    v_sub_f32 v64, v54, v70
    v_add_f32 v22, v22, v38
    v_add_f32 v54, v54, v70
    v_mul_f32 v38, 0x3ec3ef15, v32
    v_mul_f32 v70, 0x3f6c835e, v32
    v_fmac_f32 v38, 0xbf6c835e, v64
    v_fmac_f32 v70, 0x3ec3ef15, v64
    v_sub_f32 v32, v23, v39
    v_sub_f32 v64, v55, v71
    v_add_f32 v23, v23, v39
    v_add_f32 v55, v55, v71
    v_mul_f32 v39, 0x3e47c5c2, v32
    v_mul_f32 v71, 0x3f7b14be, v32
    v_fmac_f32 v39, 0xbf7b14be, v64
    v_fmac_f32 v71, 0x3e47c5c2, v64
    v_sub_f32 v32, v72, v56
    v_sub_f32 v64, v24, v40
    v_add_f32 v24, v24, v40
    v_add_f32 v56, v56, v72
    v_sub_f32 v40, v25, v41
    v_sub_f32 v72, v57, v73
    v_add_f32 v25, v25, v41
    v_add_f32 v57, v57, v73
    v_mul_f32 v41, 0xbe47c5c2, v40
    v_mul_f32 v73, 0x3f7b14be, v40
    v_fmac_f32 v41, 0xbf7b14be, v72
    v_fmac_f32 v73, 0xbe47c5c2, v72
    v_sub_f32 v40, v26, v42
    v_sub_f32 v72, v58, v74
    v_add_f32 v26, v26, v42
    v_add_f32 v58, v58, v74
    v_mul_f32 v42, 0xbec3ef15, v40
    v_mul_f32 v74, 0x3f6c835e, v40
    v_fmac_f32 v42, 0xbf6c835e, v72
    v_fmac_f32 v74, 0xbec3ef15, v72
    v_sub_f32 v40, v27, v43
    v_sub_f32 v72, v59, v75
    v_add_f32 v27, v27, v43
    v_add_f32 v59, v59, v75
    v_mul_f32 v43, 0xbf0e39da, v40
    v_mul_f32 v75, 0x3f54db31, v40
    v_fmac_f32 v43, 0xbf54db31, v72
    v_fmac_f32 v75, 0xbf0e39da, v72
    v_sub_f32 v40, v28, v44
    v_sub_f32 v72, v60, v76
    v_add_f32 v28, v28, v44
    v_add_f32 v60, v60, v76
    v_mul_f32 v44, 0xbf3504f3, v40
    v_mul_f32 v76, 0x3f3504f3, v40
    v_fmac_f32 v44, 0xbf3504f3, v72
    v_fmac_f32 v76, 0xbf3504f3, v72
    v_sub_f32 v40, v29, v45
    v_sub_f32 v72, v61, v77
    v_add_f32 v29, v29, v45
    v_add_f32 v61, v61, v77
    v_mul_f32 v45, 0xbf54db31, v40
    v_mul_f32 v77, 0x3f0e39da, v40
    v_fmac_f32 v45, 0xbf0e39da, v72
    v_fmac_f32 v77, 0xbf54db31, v72
    v_sub_f32 v40, v30, v46
    v_sub_f32 v72, v62, v78
    v_add_f32 v30, v30, v46
    v_add_f32 v62, v62, v78
    v_mul_f32 v46, 0xbf6c835e, v40
    v_mul_f32 v78, 0x3ec3ef15, v40
    v_fmac_f32 v46, 0xbec3ef15, v72
    v_fmac_f32 v78, 0xbf6c835e, v72
    v_sub_f32 v40, v31, v47
    v_sub_f32 v72, v63, v79
    v_add_f32 v31, v31, v47
    v_add_f32 v63, v63, v79
    v_mul_f32 v47, 0xbf7b14be, v40
    v_mul_f32 v79, 0x3e47c5c2, v40
    v_fmac_f32 v47, 0xbe47c5c2, v72
    v_fmac_f32 v79, 0xbf7b14be, v72
    v_sub_f32 v40, v16, v24
    v_sub_f32 v72, v48, v56
    v_add_f32 v16, v16, v24
    v_add_f32 v48, v48, v56
    v_sub_f32 v24, v17, v25
    v_sub_f32 v56, v49, v57
    v_add_f32 v17, v17, v25
    v_add_f32 v49, v49, v57
    v_mul_f32 v25, 0x3f6c835e, v24
    v_mul_f32 v57, 0x3ec3ef15, v24
    v_fmac_f32 v25, 0xbec3ef15, v56
    v_fmac_f32 v57, 0x3f6c835e, v56
    v_sub_f32 v24, v18, v26
    v_sub_f32 v56, v50, v58
    v_add_f32 v18, v18, v26
    v_add_f32 v50, v50, v58
    v_mul_f32 v26, 0x3f3504f3, v24
    v_mul_f32 v58, 0x3f3504f3, v24
    v_fmac_f32 v26, 0xbf3504f3, v56
    v_fmac_f32 v58, 0x3f3504f3, v56
    v_sub_f32 v24, v19, v27
    v_sub_f32 v56, v51, v59
    v_add_f32 v19, v19, v27
    v_add_f32 v51, v51, v59
    v_mul_f32 v27, 0x3ec3ef15, v24
    v_mul_f32 v59, 0x3f6c835e, v24
    v_fmac_f32 v27, 0xbf6c835e, v56
    v_fmac_f32 v59, 0x3ec3ef15, v56
    v_sub_f32 v24, v60, v52
    v_sub_f32 v56, v20, v28
    v_add_f32 v20, v20, v28
    v_add_f32 v52, v52, v60
    v_sub_f32 v28, v21, v29
    v_sub_f32 v60, v53, v61
    v_add_f32 v21, v21, v29
    v_add_f32 v53, v53, v61
    v_mul_f32 v29, 0xbec3ef15, v28
    v_mul_f32 v61, 0x3f6c835e, v28
    v_fmac_f32 v29, 0xbf6c835e, v60
    v_fmac_f32 v61, 0xbec3ef15, v60
    v_sub_f32 v28, v22, v30
    v_sub_f32 v60, v54, v62
    v_add_f32 v22, v22, v30
    v_add_f32 v54, v54, v62
    v_mul_f32 v30, 0xbf3504f3, v28
    v_mul_f32 v62, 0x3f3504f3, v28
    v_fmac_f32 v30, 0xbf3504f3, v60
    v_fmac_f32 v62, 0xbf3504f3, v60
    v_sub_f32 v28, v23, v31
    v_sub_f32 v60, v55, v63
    v_add_f32 v23, v23, v31
    v_add_f32 v55, v55, v63
    v_mul_f32 v31, 0xbf6c835e, v28
    v_mul_f32 v63, 0x3ec3ef15, v28
    v_fmac_f32 v31, 0xbec3ef15, v60
    v_fmac_f32 v63, 0xbf6c835e, v60
    v_sub_f32 v28, v80, v32
    v_sub_f32 v60, v81, v64
    v_add_f32 v80, v80, v32
    v_add_f32 v81, v81, v64
    v_sub_f32 v32, v33, v41
    v_sub_f32 v64, v65, v73
    v_add_f32 v33, v33, v41
    v_add_f32 v65, v65, v73
    v_mul_f32 v41, 0x3f6c835e, v32
    v_mul_f32 v73, 0x3ec3ef15, v32
    v_fmac_f32 v41, 0xbec3ef15, v64
    v_fmac_f32 v73, 0x3f6c835e, v64
    v_sub_f32 v32, v34, v42
    v_sub_f32 v64, v66, v74
    v_add_f32 v34, v34, v42
    v_add_f32 v66, v66, v74
    v_mul_f32 v42, 0x3f3504f3, v32
    v_mul_f32 v74, 0x3f3504f3, v32
    v_fmac_f32 v42, 0xbf3504f3, v64
    v_fmac_f32 v74, 0x3f3504f3, v64
    v_sub_f32 v32, v35, v43
    v_sub_f32 v64, v67, v75
    v_add_f32 v35, v35, v43
    v_add_f32 v67, v67, v75
    v_mul_f32 v43, 0x3ec3ef15, v32
    v_mul_f32 v75, 0x3f6c835e, v32
    v_fmac_f32 v43, 0xbf6c835e, v64
    v_fmac_f32 v75, 0x3ec3ef15, v64
    v_sub_f32 v32, v76, v68
    v_sub_f32 v64, v36, v44
    v_add_f32 v36, v36, v44
    v_add_f32 v68, v68, v76
    v_sub_f32 v44, v37, v45
    v_sub_f32 v76, v69, v77
    v_add_f32 v37, v37, v45
    v_add_f32 v69, v69, v77
    v_mul_f32 v45, 0xbec3ef15, v44
    v_mul_f32 v77, 0x3f6c835e, v44
    v_fmac_f32 v45, 0xbf6c835e, v76
    v_fmac_f32 v77, 0xbec3ef15, v76
    v_sub_f32 v44, v38, v46
    v_sub_f32 v76, v70, v78
    v_add_f32 v38, v38, v46
    v_add_f32 v70, v70, v78
    v_mul_f32 v46, 0xbf3504f3, v44
    v_mul_f32 v78, 0x3f3504f3, v44
    v_fmac_f32 v46, 0xbf3504f3, v76
    v_fmac_f32 v78, 0xbf3504f3, v76
    v_sub_f32 v44, v39, v47
    v_sub_f32 v76, v71, v79
    v_add_f32 v39, v39, v47
    v_add_f32 v71, v71, v79
    v_mul_f32 v47, 0xbf6c835e, v44
    v_mul_f32 v79, 0x3ec3ef15, v44
    v_fmac_f32 v47, 0xbec3ef15, v76
    v_fmac_f32 v79, 0xbf6c835e, v76
    v_sub_f32 v44, v16, v20
    v_sub_f32 v76, v48, v52
    v_add_f32 v16, v16, v20
    v_add_f32 v48, v48, v52
    v_sub_f32 v20, v17, v21
    v_sub_f32 v52, v49, v53
    v_add_f32 v17, v17, v21
    v_add_f32 v49, v49, v53
    v_mul_f32 v21, 0x3f3504f3, v20
    v_mul_f32 v53, 0x3f3504f3, v20
    v_fmac_f32 v21, 0xbf3504f3, v52
    v_fmac_f32 v53, 0x3f3504f3, v52
    v_sub_f32 v20, v54, v50
    v_sub_f32 v52, v18, v22
    v_add_f32 v18, v18, v22
    v_add_f32 v50, v50, v54
    v_sub_f32 v22, v19, v23
    v_sub_f32 v54, v51, v55
    v_add_f32 v19, v19, v23
    v_add_f32 v51, v51, v55
    v_mul_f32 v23, 0xbf3504f3, v22
    v_mul_f32 v55, 0x3f3504f3, v22
    v_fmac_f32 v23, 0xbf3504f3, v54
    v_fmac_f32 v55, 0xbf3504f3, v54
    v_sub_f32 v22, v40, v24
    v_sub_f32 v54, v72, v56
    v_add_f32 v40, v40, v24
    v_add_f32 v72, v72, v56
    v_sub_f32 v24, v25, v29
    v_sub_f32 v56, v57, v61
    v_add_f32 v25, v25, v29
    v_add_f32 v57, v57, v61
    v_mul_f32 v29, 0x3f3504f3, v24
    v_mul_f32 v61, 0x3f3504f3, v24
    v_fmac_f32 v29, 0xbf3504f3, v56
    v_fmac_f32 v61, 0x3f3504f3, v56
    v_sub_f32 v24, v62, v58
    v_sub_f32 v56, v26, v30
    v_add_f32 v26, v26, v30
    v_add_f32 v58, v58, v62
    v_sub_f32 v30, v27, v31
    v_sub_f32 v62, v59, v63
    v_add_f32 v27, v27, v31
    v_add_f32 v59, v59, v63
    v_mul_f32 v31, 0xbf3504f3, v30
    v_mul_f32 v63, 0x3f3504f3, v30
    v_fmac_f32 v31, 0xbf3504f3, v62
    v_fmac_f32 v63, 0xbf3504f3, v62
    v_sub_f32 v30, v80, v36
    v_sub_f32 v62, v81, v68
    v_add_f32 v80, v80, v36
    v_add_f32 v81, v81, v68
    v_sub_f32 v36, v33, v37
    v_sub_f32 v68, v65, v69
    v_add_f32 v33, v33, v37
    v_add_f32 v65, v65, v69
    v_mul_f32 v37, 0x3f3504f3, v36
    v_mul_f32 v69, 0x3f3504f3, v36
    v_fmac_f32 v37, 0xbf3504f3, v68
    v_fmac_f32 v69, 0x3f3504f3, v68
    v_sub_f32 v36, v70, v66
    v_sub_f32 v68, v34, v38
    v_add_f32 v34, v34, v38
    v_add_f32 v66, v66, v70
    v_sub_f32 v38, v35, v39
    v_sub_f32 v70, v67, v71
    v_add_f32 v35, v35, v39
    v_add_f32 v67, v67, v71
    v_mul_f32 v39, 0xbf3504f3, v38
    v_mul_f32 v71, 0x3f3504f3, v38
    v_fmac_f32 v39, 0xbf3504f3, v70
    v_fmac_f32 v71, 0xbf3504f3, v70
    v_sub_f32 v38, v28, v32
    v_sub_f32 v70, v60, v64
    v_add_f32 v28, v28, v32
    v_add_f32 v60, v60, v64
    v_sub_f32 v32, v41, v45
    v_sub_f32 v64, v73, v77
    v_add_f32 v41, v41, v45
    v_add_f32 v73, v73, v77
    v_mul_f32 v45, 0x3f3504f3, v32
    v_mul_f32 v77, 0x3f3504f3, v32
    v_fmac_f32 v45, 0xbf3504f3, v64
    v_fmac_f32 v77, 0x3f3504f3, v64
    v_sub_f32 v32, v78, v74
    v_sub_f32 v64, v42, v46
    v_add_f32 v42, v42, v46
    v_add_f32 v74, v74, v78
    v_sub_f32 v46, v43, v47
    v_sub_f32 v78, v75, v79
    v_add_f32 v43, v43, v47
    v_add_f32 v75, v75, v79
    v_mul_f32 v47, 0xbf3504f3, v46
    v_mul_f32 v79, 0x3f3504f3, v46
    v_fmac_f32 v47, 0xbf3504f3, v78
    v_fmac_f32 v79, 0xbf3504f3, v78
    v_sub_f32 v46, v16, v18
    v_sub_f32 v78, v48, v50
    v_add_f32 v16, v16, v18
    v_add_f32 v48, v48, v50
    v_sub_f32 v18, v51, v49
    v_sub_f32 v50, v17, v19
    v_add_f32 v17, v17, v19
    v_add_f32 v49, v49, v51
    v_sub_f32 v19, v44, v20
    v_sub_f32 v51, v76, v52
    v_add_f32 v44, v44, v20
    v_add_f32 v76, v76, v52
    v_sub_f32 v20, v55, v53
    v_sub_f32 v52, v21, v23
    v_add_f32 v21, v21, v23
    v_add_f32 v53, v53, v55
    v_sub_f32 v23, v40, v26
    v_sub_f32 v55, v72, v58
    v_add_f32 v40, v40, v26
    v_add_f32 v72, v72, v58
    v_sub_f32 v26, v59, v57
    v_sub_f32 v58, v25, v27
    v_add_f32 v25, v25, v27
    v_add_f32 v57, v57, v59
    v_sub_f32 v27, v22, v24
    v_sub_f32 v59, v54, v56
    v_add_f32 v22, v22, v24
    v_add_f32 v54, v54, v56
    v_sub_f32 v24, v63, v61
    v_sub_f32 v56, v29, v31
    v_add_f32 v29, v29, v31
    v_add_f32 v61, v61, v63
    v_sub_f32 v31, v80, v34
    v_sub_f32 v63, v81, v66
    v_add_f32 v80, v80, v34
    v_add_f32 v81, v81, v66
    v_sub_f32 v34, v67, v65
    v_sub_f32 v66, v33, v35
    v_add_f32 v33, v33, v35
    v_add_f32 v65, v65, v67
    v_sub_f32 v35, v30, v36
    v_sub_f32 v67, v62, v68
    v_add_f32 v30, v30, v36
    v_add_f32 v62, v62, v68
    v_sub_f32 v36, v71, v69
    v_sub_f32 v68, v37, v39
    v_add_f32 v37, v37, v39
    v_add_f32 v69, v69, v71
    v_sub_f32 v39, v28, v42
    v_sub_f32 v71, v60, v74
    v_add_f32 v28, v28, v42
    v_add_f32 v60, v60, v74
    v_sub_f32 v42, v75, v73
    v_sub_f32 v74, v41, v43
    v_add_f32 v41, v41, v43
    v_add_f32 v73, v73, v75
    v_sub_f32 v43, v38, v32
    v_sub_f32 v75, v70, v64
    v_add_f32 v38, v38, v32
    v_add_f32 v70, v70, v64
    v_sub_f32 v32, v79, v77
    v_sub_f32 v64, v45, v47
    v_add_f32 v45, v45, v47
    v_add_f32 v77, v77, v79
    v_sub_f32 v47, v16, v17
    v_sub_f32 v79, v48, v49
    v_add_f32 v16, v16, v17
    v_add_f32 v48, v48, v49
    v_sub_f32 v17, v46, v18
    v_sub_f32 v49, v78, v50
    v_add_f32 v46, v46, v18
    v_add_f32 v78, v78, v50
    v_sub_f32 v18, v44, v21
    v_sub_f32 v50, v76, v53
    v_add_f32 v44, v44, v21
    v_add_f32 v76, v76, v53
    v_sub_f32 v21, v19, v20
    v_sub_f32 v53, v51, v52
    v_add_f32 v19, v19, v20
    v_add_f32 v51, v51, v52
    v_sub_f32 v20, v40, v25
    v_sub_f32 v52, v72, v57
    v_add_f32 v40, v40, v25
    v_add_f32 v72, v72, v57
    v_sub_f32 v25, v23, v26
    v_sub_f32 v57, v55, v58
    v_add_f32 v23, v23, v26
    v_add_f32 v55, v55, v58
    v_sub_f32 v26, v22, v29
    v_sub_f32 v58, v54, v61
    v_add_f32 v22, v22, v29
    v_add_f32 v54, v54, v61
    v_sub_f32 v29, v27, v24
    v_sub_f32 v61, v59, v56
    v_add_f32 v27, v27, v24
    v_add_f32 v59, v59, v56
    v_sub_f32 v24, v80, v33
    v_sub_f32 v56, v81, v65
    v_add_f32 v80, v80, v33
    v_add_f32 v81, v81, v65
    v_sub_f32 v33, v31, v34
    v_sub_f32 v65, v63, v66
    v_add_f32 v31, v31, v34
    v_add_f32 v63, v63, v66
    v_sub_f32 v34, v30, v37
    v_sub_f32 v66, v62, v69
    v_add_f32 v30, v30, v37
    v_add_f32 v62, v62, v69
    v_sub_f32 v37, v35, v36
    v_sub_f32 v69, v67, v68
    v_add_f32 v35, v35, v36
    v_add_f32 v67, v67, v68
    v_sub_f32 v36, v28, v41
    v_sub_f32 v68, v60, v73
    v_add_f32 v28, v28, v41
    v_add_f32 v60, v60, v73
    v_sub_f32 v41, v39, v42
    v_sub_f32 v73, v71, v74
    v_add_f32 v39, v39, v42
    v_add_f32 v71, v71, v74
    v_sub_f32 v42, v38, v45
    v_sub_f32 v74, v70, v77
    v_add_f32 v38, v38, v45
    v_add_f32 v70, v70, v77
    v_sub_f32 v45, v43, v32
    v_sub_f32 v77, v75, v64
    v_add_f32 v43, v43, v32
    v_add_f32 v75, v75, v64
    v_mul_f32 v32, 0x3a800000, v3
    v_cos_f32 v64, v32
    v_sin_f32 v82, v32
    s_nop 0
    v_mul_f32 v83, v80, v64
    v_fma_f32 v83, -v81, v82, v83
    v_mul_f32 v81, v81, v64
    v_fmac_f32 v81, v80, v82
    v_mul_f32 v32, 0x3b000000, v3
    v_cos_f32 v64, v32
    v_sin_f32 v82, v32
    s_nop 0
    v_mul_f32 v80, v40, v64
    v_fma_f32 v80, -v72, v82, v80
    v_mul_f32 v72, v72, v64
    v_fmac_f32 v72, v40, v82
    v_mul_f32 v32, 0x3b400000, v3
    v_cos_f32 v64, v32
    v_sin_f32 v82, v32
    s_nop 0
    v_mul_f32 v40, v28, v64
    v_fma_f32 v40, -v60, v82, v40
    v_mul_f32 v60, v60, v64
    v_fmac_f32 v60, v28, v82
    v_mul_f32 v32, 0x3b800000, v3
    v_cos_f32 v64, v32
    v_sin_f32 v82, v32
    s_nop 0
    v_mul_f32 v28, v44, v64
    v_fma_f32 v28, -v76, v82, v28
    v_mul_f32 v76, v76, v64
    v_fmac_f32 v76, v44, v82
    v_mul_f32 v32, 0x3ba00000, v3
    v_cos_f32 v64, v32
    v_sin_f32 v82, v32
    s_nop 0
    v_mul_f32 v44, v30, v64
    v_fma_f32 v44, -v62, v82, v44
    v_mul_f32 v62, v62, v64
    v_fmac_f32 v62, v30, v82
    v_mul_f32 v32, 0x3bc00000, v3
    v_cos_f32 v64, v32
    v_sin_f32 v82, v32
    s_nop 0
    v_mul_f32 v30, v22, v64
    v_fma_f32 v30, -v54, v82, v30
    v_mul_f32 v54, v54, v64
    v_fmac_f32 v54, v22, v82
    v_mul_f32 v32, 0x3be00000, v3
    v_cos_f32 v64, v32
    v_sin_f32 v82, v32
    s_nop 0
    v_mul_f32 v22, v38, v64
    v_fma_f32 v22, -v70, v82, v22
    v_mul_f32 v70, v70, v64
    v_fmac_f32 v70, v38, v82
    v_mul_f32 v32, 0x3c000000, v3
    v_cos_f32 v64, v32
    v_sin_f32 v82, v32
    s_nop 0
    v_mul_f32 v38, v46, v64
    v_fma_f32 v38, -v78, v82, v38
    v_mul_f32 v78, v78, v64
    v_fmac_f32 v78, v46, v82
    v_mul_f32 v32, 0x3c100000, v3
    v_cos_f32 v64, v32
    v_sin_f32 v82, v32
    s_nop 0
    v_mul_f32 v46, v31, v64
    v_fma_f32 v46, -v63, v82, v46
    v_mul_f32 v63, v63, v64
    v_fmac_f32 v63, v31, v82
    v_mul_f32 v32, 0x3c200000, v3
    v_cos_f32 v64, v32
    v_sin_f32 v82, v32
    s_nop 0
    v_mul_f32 v31, v23, v64
    v_fma_f32 v31, -v55, v82, v31
    v_mul_f32 v55, v55, v64
    v_fmac_f32 v55, v23, v82
    v_mul_f32 v32, 0x3c300000, v3
    v_cos_f32 v64, v32
    v_sin_f32 v82, v32
    s_nop 0
    v_mul_f32 v23, v39, v64
    v_fma_f32 v23, -v71, v82, v23
    v_mul_f32 v71, v71, v64
    v_fmac_f32 v71, v39, v82
    v_mul_f32 v32, 0x3c400000, v3
    v_cos_f32 v64, v32
    v_sin_f32 v82, v32
    s_nop 0
    v_mul_f32 v39, v19, v64
    v_fma_f32 v39, -v51, v82, v39
    v_mul_f32 v51, v51, v64
    v_fmac_f32 v51, v19, v82
    v_mul_f32 v32, 0x3c500000, v3
    v_cos_f32 v64, v32
    v_sin_f32 v82, v32
    s_nop 0
    v_mul_f32 v19, v35, v64
    v_fma_f32 v19, -v67, v82, v19
    v_mul_f32 v67, v67, v64
    v_fmac_f32 v67, v35, v82
    v_mul_f32 v32, 0x3c600000, v3
    v_cos_f32 v64, v32
    v_sin_f32 v82, v32
    s_nop 0
    v_mul_f32 v35, v27, v64
    v_fma_f32 v35, -v59, v82, v35
    v_mul_f32 v59, v59, v64
    v_fmac_f32 v59, v27, v82
    v_mul_f32 v32, 0x3c700000, v3
    v_cos_f32 v64, v32
    v_sin_f32 v82, v32
    s_nop 0
    v_mul_f32 v27, v43, v64
    v_fma_f32 v27, -v75, v82, v27
    v_mul_f32 v75, v75, v64
    v_fmac_f32 v75, v43, v82
    v_mul_f32 v32, 0x3c800000, v3
    v_cos_f32 v64, v32
    v_sin_f32 v82, v32
    s_nop 0
    v_mul_f32 v43, v47, v64
    v_fma_f32 v43, -v79, v82, v43
    v_mul_f32 v79, v79, v64
    v_fmac_f32 v79, v47, v82
    v_mul_f32 v32, 0x3c880000, v3
    v_cos_f32 v64, v32
    v_sin_f32 v82, v32
    s_nop 0
    v_mul_f32 v47, v24, v64
    v_fma_f32 v47, -v56, v82, v47
    v_mul_f32 v56, v56, v64
    v_fmac_f32 v56, v24, v82
    v_mul_f32 v32, 0x3c900000, v3
    v_cos_f32 v64, v32
    v_sin_f32 v82, v32
    s_nop 0
    v_mul_f32 v24, v20, v64
    v_fma_f32 v24, -v52, v82, v24
    v_mul_f32 v52, v52, v64
    v_fmac_f32 v52, v20, v82
    v_mul_f32 v32, 0x3c980000, v3
    v_cos_f32 v64, v32
    v_sin_f32 v82, v32
    s_nop 0
    v_mul_f32 v20, v36, v64
    v_fma_f32 v20, -v68, v82, v20
    v_mul_f32 v68, v68, v64
    v_fmac_f32 v68, v36, v82
    v_mul_f32 v32, 0x3ca00000, v3
    v_cos_f32 v64, v32
    v_sin_f32 v82, v32
    s_nop 0
    v_mul_f32 v36, v18, v64
    v_fma_f32 v36, -v50, v82, v36
    v_mul_f32 v50, v50, v64
    v_fmac_f32 v50, v18, v82
    v_mul_f32 v32, 0x3ca80000, v3
    v_cos_f32 v64, v32
    v_sin_f32 v82, v32
    s_nop 0
    v_mul_f32 v18, v34, v64
    v_fma_f32 v18, -v66, v82, v18
    v_mul_f32 v66, v66, v64
    v_fmac_f32 v66, v34, v82
    v_mul_f32 v32, 0x3cb00000, v3
    v_cos_f32 v64, v32
    v_sin_f32 v82, v32
    s_nop 0
    v_mul_f32 v34, v26, v64
    v_fma_f32 v34, -v58, v82, v34
    v_mul_f32 v58, v58, v64
    v_fmac_f32 v58, v26, v82
    v_mul_f32 v32, 0x3cb80000, v3
    v_cos_f32 v64, v32
    v_sin_f32 v82, v32
    s_nop 0
    v_mul_f32 v26, v42, v64
    v_fma_f32 v26, -v74, v82, v26
    v_mul_f32 v74, v74, v64
    v_fmac_f32 v74, v42, v82
    v_mul_f32 v32, 0x3cc00000, v3
    v_cos_f32 v64, v32
    v_sin_f32 v82, v32
    s_nop 0
    v_mul_f32 v42, v17, v64
    v_fma_f32 v42, -v49, v82, v42
    v_mul_f32 v49, v49, v64
    v_fmac_f32 v49, v17, v82
    v_mul_f32 v32, 0x3cc80000, v3
    v_cos_f32 v64, v32
    v_sin_f32 v82, v32
    s_nop 0
    v_mul_f32 v17, v33, v64
    v_fma_f32 v17, -v65, v82, v17
    v_mul_f32 v65, v65, v64
    v_fmac_f32 v65, v33, v82
    v_mul_f32 v32, 0x3cd00000, v3
    v_cos_f32 v64, v32
    v_sin_f32 v82, v32
    s_nop 0
    v_mul_f32 v33, v25, v64
    v_fma_f32 v33, -v57, v82, v33
    v_mul_f32 v57, v57, v64
    v_fmac_f32 v57, v25, v82
    v_mul_f32 v32, 0x3cd80000, v3
    v_cos_f32 v64, v32
    v_sin_f32 v82, v32
    s_nop 0
    v_mul_f32 v25, v41, v64
    v_fma_f32 v25, -v73, v82, v25
    v_mul_f32 v73, v73, v64
    v_fmac_f32 v73, v41, v82
    v_mul_f32 v32, 0x3ce00000, v3
    v_cos_f32 v64, v32
    v_sin_f32 v82, v32
    s_nop 0
    v_mul_f32 v41, v21, v64
    v_fma_f32 v41, -v53, v82, v41
    v_mul_f32 v53, v53, v64
    v_fmac_f32 v53, v21, v82
    v_mul_f32 v32, 0x3ce80000, v3
    v_cos_f32 v64, v32
    v_sin_f32 v82, v32
    s_nop 0
    v_mul_f32 v21, v37, v64
    v_fma_f32 v21, -v69, v82, v21
    v_mul_f32 v69, v69, v64
    v_fmac_f32 v69, v37, v82
    v_mul_f32 v32, 0x3cf00000, v3
    v_cos_f32 v64, v32
    v_sin_f32 v82, v32
    s_nop 0
    v_mul_f32 v37, v29, v64
    v_fma_f32 v37, -v61, v82, v37
    v_mul_f32 v61, v61, v64
    v_fmac_f32 v61, v29, v82
    v_mul_f32 v32, 0x3cf80000, v3
    v_cos_f32 v64, v32
    v_sin_f32 v82, v32
    s_nop 0
    v_mul_f32 v29, v45, v64
    v_fma_f32 v29, -v77, v82, v29
    v_mul_f32 v77, v77, v64
    v_fmac_f32 v77, v45, v82
    ds_write_b32 v4, v16 offset:0
    ds_write_b32 v4, v48 offset:4
    ds_write_b32 v4, v83 offset:264
    ds_write_b32 v4, v81 offset:268
    ds_write_b32 v4, v80 offset:528
    ds_write_b32 v4, v72 offset:532
    ds_write_b32 v4, v40 offset:792
    ds_write_b32 v4, v60 offset:796
    ds_write_b32 v4, v28 offset:1056
    ds_write_b32 v4, v76 offset:1060
    ds_write_b32 v4, v44 offset:1320
    ds_write_b32 v4, v62 offset:1324
    ds_write_b32 v4, v30 offset:1584
    ds_write_b32 v4, v54 offset:1588
    ds_write_b32 v4, v22 offset:1848
    ds_write_b32 v4, v70 offset:1852
    ds_write_b32 v4, v38 offset:2112
    ds_write_b32 v4, v78 offset:2116
    ds_write_b32 v4, v46 offset:2376
    ds_write_b32 v4, v63 offset:2380
    ds_write_b32 v4, v31 offset:2640
    ds_write_b32 v4, v55 offset:2644
    ds_write_b32 v4, v23 offset:2904
    ds_write_b32 v4, v71 offset:2908
    ds_write_b32 v4, v39 offset:3168
    ds_write_b32 v4, v51 offset:3172
    ds_write_b32 v4, v19 offset:3432
    ds_write_b32 v4, v67 offset:3436
    ds_write_b32 v4, v35 offset:3696
    ds_write_b32 v4, v59 offset:3700
    ds_write_b32 v4, v27 offset:3960
    ds_write_b32 v4, v75 offset:3964
    ds_write_b32 v4, v43 offset:4224
    ds_write_b32 v4, v79 offset:4228
    ds_write_b32 v4, v47 offset:4488
    ds_write_b32 v4, v56 offset:4492
    ds_write_b32 v4, v24 offset:4752
    ds_write_b32 v4, v52 offset:4756
    ds_write_b32 v4, v20 offset:5016
    ds_write_b32 v4, v68 offset:5020
    ds_write_b32 v4, v36 offset:5280
    ds_write_b32 v4, v50 offset:5284
    ds_write_b32 v4, v18 offset:5544
    ds_write_b32 v4, v66 offset:5548
    ds_write_b32 v4, v34 offset:5808
    ds_write_b32 v4, v58 offset:5812
    ds_write_b32 v4, v26 offset:6072
    ds_write_b32 v4, v74 offset:6076
    ds_write_b32 v4, v42 offset:6336
    ds_write_b32 v4, v49 offset:6340
    ds_write_b32 v4, v17 offset:6600
    ds_write_b32 v4, v65 offset:6604
    ds_write_b32 v4, v33 offset:6864
    ds_write_b32 v4, v57 offset:6868
    ds_write_b32 v4, v25 offset:7128
    ds_write_b32 v4, v73 offset:7132
    ds_write_b32 v4, v41 offset:7392
    ds_write_b32 v4, v53 offset:7396
    ds_write_b32 v4, v21 offset:7656
    ds_write_b32 v4, v69 offset:7660
    ds_write_b32 v4, v37 offset:7920
    ds_write_b32 v4, v61 offset:7924
    ds_write_b32 v4, v29 offset:8184
    ds_write_b32 v4, v77 offset:8188
    s_waitcnt lgkmcnt(0)
    ds_read_b32 v16, v5 offset:0
    ds_read_b32 v48, v5 offset:4
    ds_read_b32 v83, v5 offset:8
    ds_read_b32 v81, v5 offset:12
    ds_read_b32 v80, v5 offset:16
    ds_read_b32 v72, v5 offset:20
    ds_read_b32 v40, v5 offset:24
    ds_read_b32 v60, v5 offset:28
    ds_read_b32 v28, v5 offset:32
    ds_read_b32 v76, v5 offset:36
    ds_read_b32 v44, v5 offset:40
    ds_read_b32 v62, v5 offset:44
    ds_read_b32 v30, v5 offset:48
    ds_read_b32 v54, v5 offset:52
    s_waitcnt lgkmcnt(0)
    ds_read_b32 v22, v5 offset:56
    ds_read_b32 v70, v5 offset:60
    ds_read_b32 v38, v5 offset:64
    ds_read_b32 v78, v5 offset:68
    ds_read_b32 v46, v5 offset:72
    ds_read_b32 v63, v5 offset:76
    ds_read_b32 v31, v5 offset:80
    ds_read_b32 v55, v5 offset:84
    ds_read_b32 v23, v5 offset:88
    ds_read_b32 v71, v5 offset:92
    ds_read_b32 v39, v5 offset:96
    ds_read_b32 v51, v5 offset:100
    ds_read_b32 v19, v5 offset:104
    ds_read_b32 v67, v5 offset:108
    s_waitcnt lgkmcnt(0)
    ds_read_b32 v35, v5 offset:112
    ds_read_b32 v59, v5 offset:116
    ds_read_b32 v27, v5 offset:120
    ds_read_b32 v75, v5 offset:124
    ds_read_b32 v43, v5 offset:128
    ds_read_b32 v79, v5 offset:132
    ds_read_b32 v47, v5 offset:136
    ds_read_b32 v56, v5 offset:140
    ds_read_b32 v24, v5 offset:144
    ds_read_b32 v52, v5 offset:148
    ds_read_b32 v20, v5 offset:152
    ds_read_b32 v68, v5 offset:156
    ds_read_b32 v36, v5 offset:160
    ds_read_b32 v50, v5 offset:164
    s_waitcnt lgkmcnt(0)
    ds_read_b32 v18, v5 offset:168
    ds_read_b32 v66, v5 offset:172
    ds_read_b32 v34, v5 offset:176
    ds_read_b32 v58, v5 offset:180
    ds_read_b32 v26, v5 offset:184
    ds_read_b32 v74, v5 offset:188
    ds_read_b32 v42, v5 offset:192
    ds_read_b32 v49, v5 offset:196
    ds_read_b32 v17, v5 offset:200
    ds_read_b32 v65, v5 offset:204
    ds_read_b32 v33, v5 offset:208
    ds_read_b32 v57, v5 offset:212
    ds_read_b32 v25, v5 offset:216
    ds_read_b32 v73, v5 offset:220
    s_waitcnt lgkmcnt(0)
    ds_read_b32 v41, v5 offset:224
    ds_read_b32 v53, v5 offset:228
    ds_read_b32 v21, v5 offset:232
    ds_read_b32 v69, v5 offset:236
    ds_read_b32 v37, v5 offset:240
    ds_read_b32 v61, v5 offset:244
    ds_read_b32 v29, v5 offset:248
    ds_read_b32 v77, v5 offset:252
    s_waitcnt lgkmcnt(0)
    v_sub_f32 v32, v16, v43
    v_sub_f32 v64, v48, v79
    v_add_f32 v16, v16, v43
    v_add_f32 v48, v48, v79
    v_sub_f32 v43, v83, v47
    v_sub_f32 v79, v81, v56
    v_add_f32 v83, v83, v47
    v_add_f32 v81, v81, v56
    v_mul_f32 v47, 0x3f7b14be, v43
    v_mul_f32 v56, 0x3e47c5c2, v43
    v_fmac_f32 v47, 0xbe47c5c2, v79
    v_fmac_f32 v56, 0x3f7b14be, v79
    v_sub_f32 v43, v80, v24
    v_sub_f32 v79, v72, v52
    v_add_f32 v80, v80, v24
    v_add_f32 v72, v72, v52
    v_mul_f32 v24, 0x3f6c835e, v43
    v_mul_f32 v52, 0x3ec3ef15, v43
    v_fmac_f32 v24, 0xbec3ef15, v79
    v_fmac_f32 v52, 0x3f6c835e, v79
    v_sub_f32 v43, v40, v20
    v_sub_f32 v79, v60, v68
    v_add_f32 v40, v40, v20
    v_add_f32 v60, v60, v68
    v_mul_f32 v20, 0x3f54db31, v43
    v_mul_f32 v68, 0x3f0e39da, v43
    v_fmac_f32 v20, 0xbf0e39da, v79
    v_fmac_f32 v68, 0x3f54db31, v79
    v_sub_f32 v43, v28, v36
    v_sub_f32 v79, v76, v50
    v_add_f32 v28, v28, v36
    v_add_f32 v76, v76, v50
    v_mul_f32 v36, 0x3f3504f3, v43
    v_mul_f32 v50, 0x3f3504f3, v43
    v_fmac_f32 v36, 0xbf3504f3, v79
    v_fmac_f32 v50, 0x3f3504f3, v79
    v_sub_f32 v43, v44, v18
    v_sub_f32 v79, v62, v66
    v_add_f32 v44, v44, v18
    v_add_f32 v62, v62, v66
    v_mul_f32 v18, 0x3f0e39da, v43
    v_mul_f32 v66, 0x3f54db31, v43
    v_fmac_f32 v18, 0xbf54db31, v79
    v_fmac_f32 v66, 0x3f0e39da, v79
    v_sub_f32 v43, v30, v34
    v_sub_f32 v79, v54, v58
    v_add_f32 v30, v30, v34
    v_add_f32 v54, v54, v58
    v_mul_f32 v34, 0x3ec3ef15, v43
    v_mul_f32 v58, 0x3f6c835e, v43
    v_fmac_f32 v34, 0xbf6c835e, v79
    v_fmac_f32 v58, 0x3ec3ef15, v79
    v_sub_f32 v43, v22, v26
    v_sub_f32 v79, v70, v74
    v_add_f32 v22, v22, v26
    v_add_f32 v70, v70, v74
    v_mul_f32 v26, 0x3e47c5c2, v43
    v_mul_f32 v74, 0x3f7b14be, v43
    v_fmac_f32 v26, 0xbf7b14be, v79
    v_fmac_f32 v74, 0x3e47c5c2, v79
    v_sub_f32 v43, v49, v78
    v_sub_f32 v79, v38, v42
    v_add_f32 v38, v38, v42
    v_add_f32 v78, v78, v49
    v_sub_f32 v42, v46, v17
    v_sub_f32 v49, v63, v65
    v_add_f32 v46, v46, v17
    v_add_f32 v63, v63, v65
    v_mul_f32 v17, 0xbe47c5c2, v42
    v_mul_f32 v65, 0x3f7b14be, v42
    v_fmac_f32 v17, 0xbf7b14be, v49
    v_fmac_f32 v65, 0xbe47c5c2, v49
    v_sub_f32 v42, v31, v33
    v_sub_f32 v49, v55, v57
    v_add_f32 v31, v31, v33
    v_add_f32 v55, v55, v57
    v_mul_f32 v33, 0xbec3ef15, v42
    v_mul_f32 v57, 0x3f6c835e, v42
    v_fmac_f32 v33, 0xbf6c835e, v49
    v_fmac_f32 v57, 0xbec3ef15, v49
    v_sub_f32 v42, v23, v25
    v_sub_f32 v49, v71, v73
    v_add_f32 v23, v23, v25
    v_add_f32 v71, v71, v73
    v_mul_f32 v25, 0xbf0e39da, v42
    v_mul_f32 v73, 0x3f54db31, v42
    v_fmac_f32 v25, 0xbf54db31, v49
    v_fmac_f32 v73, 0xbf0e39da, v49
    v_sub_f32 v42, v39, v41
    v_sub_f32 v49, v51, v53
    v_add_f32 v39, v39, v41
    v_add_f32 v51, v51, v53
    v_mul_f32 v41, 0xbf3504f3, v42
    v_mul_f32 v53, 0x3f3504f3, v42
    v_fmac_f32 v41, 0xbf3504f3, v49
    v_fmac_f32 v53, 0xbf3504f3, v49
    v_sub_f32 v42, v19, v21
    v_sub_f32 v49, v67, v69
    v_add_f32 v19, v19, v21
    v_add_f32 v67, v67, v69
    v_mul_f32 v21, 0xbf54db31, v42
    v_mul_f32 v69, 0x3f0e39da, v42
    v_fmac_f32 v21, 0xbf0e39da, v49
    v_fmac_f32 v69, 0xbf54db31, v49
    v_sub_f32 v42, v35, v37
    v_sub_f32 v49, v59, v61
    v_add_f32 v35, v35, v37
    v_add_f32 v59, v59, v61
    v_mul_f32 v37, 0xbf6c835e, v42
    v_mul_f32 v61, 0x3ec3ef15, v42
    v_fmac_f32 v37, 0xbec3ef15, v49
    v_fmac_f32 v61, 0xbf6c835e, v49
    v_sub_f32 v42, v27, v29
    v_sub_f32 v49, v75, v77
    v_add_f32 v27, v27, v29
    v_add_f32 v75, v75, v77
    v_mul_f32 v29, 0xbf7b14be, v42
    v_mul_f32 v77, 0x3e47c5c2, v42
    v_fmac_f32 v29, 0xbe47c5c2, v49
    v_fmac_f32 v77, 0xbf7b14be, v49
    v_sub_f32 v42, v16, v38
    v_sub_f32 v49, v48, v78
    v_add_f32 v16, v16, v38
    v_add_f32 v48, v48, v78
    v_sub_f32 v38, v83, v46
    v_sub_f32 v78, v81, v63
    v_add_f32 v83, v83, v46
    v_add_f32 v81, v81, v63
    v_mul_f32 v46, 0x3f6c835e, v38
    v_mul_f32 v63, 0x3ec3ef15, v38
    v_fmac_f32 v46, 0xbec3ef15, v78
    v_fmac_f32 v63, 0x3f6c835e, v78
    v_sub_f32 v38, v80, v31
    v_sub_f32 v78, v72, v55
    v_add_f32 v80, v80, v31
    v_add_f32 v72, v72, v55
    v_mul_f32 v31, 0x3f3504f3, v38
    v_mul_f32 v55, 0x3f3504f3, v38
    v_fmac_f32 v31, 0xbf3504f3, v78
    v_fmac_f32 v55, 0x3f3504f3, v78
    v_sub_f32 v38, v40, v23
    v_sub_f32 v78, v60, v71
    v_add_f32 v40, v40, v23
    v_add_f32 v60, v60, v71
    v_mul_f32 v23, 0x3ec3ef15, v38
    v_mul_f32 v71, 0x3f6c835e, v38
    v_fmac_f32 v23, 0xbf6c835e, v78
    v_fmac_f32 v71, 0x3ec3ef15, v78
    v_sub_f32 v38, v51, v76
    v_sub_f32 v78, v28, v39
    v_add_f32 v28, v28, v39
    v_add_f32 v76, v76, v51
    v_sub_f32 v39, v44, v19
    v_sub_f32 v51, v62, v67
    v_add_f32 v44, v44, v19
    v_add_f32 v62, v62, v67
    v_mul_f32 v19, 0xbec3ef15, v39
    v_mul_f32 v67, 0x3f6c835e, v39
    v_fmac_f32 v19, 0xbf6c835e, v51
    v_fmac_f32 v67, 0xbec3ef15, v51
    v_sub_f32 v39, v30, v35
    v_sub_f32 v51, v54, v59
    v_add_f32 v30, v30, v35
    v_add_f32 v54, v54, v59
    v_mul_f32 v35, 0xbf3504f3, v39
    v_mul_f32 v59, 0x3f3504f3, v39
    v_fmac_f32 v35, 0xbf3504f3, v51
    v_fmac_f32 v59, 0xbf3504f3, v51
    v_sub_f32 v39, v22, v27
    v_sub_f32 v51, v70, v75
    v_add_f32 v22, v22, v27
    v_add_f32 v70, v70, v75
    v_mul_f32 v27, 0xbf6c835e, v39
    v_mul_f32 v75, 0x3ec3ef15, v39
    v_fmac_f32 v27, 0xbec3ef15, v51
    v_fmac_f32 v75, 0xbf6c835e, v51
    v_sub_f32 v39, v32, v43
    v_sub_f32 v51, v64, v79
    v_add_f32 v32, v32, v43
    v_add_f32 v64, v64, v79
    v_sub_f32 v43, v47, v17
    v_sub_f32 v79, v56, v65
    v_add_f32 v47, v47, v17
    v_add_f32 v56, v56, v65
    v_mul_f32 v17, 0x3f6c835e, v43
    v_mul_f32 v65, 0x3ec3ef15, v43
    v_fmac_f32 v17, 0xbec3ef15, v79
    v_fmac_f32 v65, 0x3f6c835e, v79
    v_sub_f32 v43, v24, v33
    v_sub_f32 v79, v52, v57
    v_add_f32 v24, v24, v33
    v_add_f32 v52, v52, v57
    v_mul_f32 v33, 0x3f3504f3, v43
    v_mul_f32 v57, 0x3f3504f3, v43
    v_fmac_f32 v33, 0xbf3504f3, v79
    v_fmac_f32 v57, 0x3f3504f3, v79
    v_sub_f32 v43, v20, v25
    v_sub_f32 v79, v68, v73
    v_add_f32 v20, v20, v25
    v_add_f32 v68, v68, v73
    v_mul_f32 v25, 0x3ec3ef15, v43
    v_mul_f32 v73, 0x3f6c835e, v43
    v_fmac_f32 v25, 0xbf6c835e, v79
    v_fmac_f32 v73, 0x3ec3ef15, v79
    v_sub_f32 v43, v53, v50
    v_sub_f32 v79, v36, v41
    v_add_f32 v36, v36, v41
    v_add_f32 v50, v50, v53
    v_sub_f32 v41, v18, v21
    v_sub_f32 v53, v66, v69
    v_add_f32 v18, v18, v21
    v_add_f32 v66, v66, v69
    v_mul_f32 v21, 0xbec3ef15, v41
    v_mul_f32 v69, 0x3f6c835e, v41
    v_fmac_f32 v21, 0xbf6c835e, v53
    v_fmac_f32 v69, 0xbec3ef15, v53
    v_sub_f32 v41, v34, v37
    v_sub_f32 v53, v58, v61
    v_add_f32 v34, v34, v37
    v_add_f32 v58, v58, v61
    v_mul_f32 v37, 0xbf3504f3, v41
    v_mul_f32 v61, 0x3f3504f3, v41
    v_fmac_f32 v37, 0xbf3504f3, v53
    v_fmac_f32 v61, 0xbf3504f3, v53
    v_sub_f32 v41, v26, v29
    v_sub_f32 v53, v74, v77
    v_add_f32 v26, v26, v29
    v_add_f32 v74, v74, v77
    v_mul_f32 v29, 0xbf6c835e, v41
    v_mul_f32 v77, 0x3ec3ef15, v41
    v_fmac_f32 v29, 0xbec3ef15, v53
    v_fmac_f32 v77, 0xbf6c835e, v53
    v_sub_f32 v41, v16, v28
    v_sub_f32 v53, v48, v76
    v_add_f32 v16, v16, v28
    v_add_f32 v48, v48, v76
    v_sub_f32 v28, v83, v44
    v_sub_f32 v76, v81, v62
    v_add_f32 v83, v83, v44
    v_add_f32 v81, v81, v62
    v_mul_f32 v44, 0x3f3504f3, v28
    v_mul_f32 v62, 0x3f3504f3, v28
    v_fmac_f32 v44, 0xbf3504f3, v76
    v_fmac_f32 v62, 0x3f3504f3, v76
    v_sub_f32 v28, v54, v72
    v_sub_f32 v76, v80, v30
    v_add_f32 v80, v80, v30
    v_add_f32 v72, v72, v54
    v_sub_f32 v30, v40, v22
    v_sub_f32 v54, v60, v70
    v_add_f32 v40, v40, v22
    v_add_f32 v60, v60, v70
    v_mul_f32 v22, 0xbf3504f3, v30
    v_mul_f32 v70, 0x3f3504f3, v30
    v_fmac_f32 v22, 0xbf3504f3, v54
    v_fmac_f32 v70, 0xbf3504f3, v54
    v_sub_f32 v30, v42, v38
    v_sub_f32 v54, v49, v78
    v_add_f32 v42, v42, v38
    v_add_f32 v49, v49, v78
    v_sub_f32 v38, v46, v19
    v_sub_f32 v78, v63, v67
    v_add_f32 v46, v46, v19
    v_add_f32 v63, v63, v67
    v_mul_f32 v19, 0x3f3504f3, v38
    v_mul_f32 v67, 0x3f3504f3, v38
    v_fmac_f32 v19, 0xbf3504f3, v78
    v_fmac_f32 v67, 0x3f3504f3, v78
    v_sub_f32 v38, v59, v55
    v_sub_f32 v78, v31, v35
    v_add_f32 v31, v31, v35
    v_add_f32 v55, v55, v59
    v_sub_f32 v35, v23, v27
    v_sub_f32 v59, v71, v75
    v_add_f32 v23, v23, v27
    v_add_f32 v71, v71, v75
    v_mul_f32 v27, 0xbf3504f3, v35
    v_mul_f32 v75, 0x3f3504f3, v35
    v_fmac_f32 v27, 0xbf3504f3, v59
    v_fmac_f32 v75, 0xbf3504f3, v59
    v_sub_f32 v35, v32, v36
    v_sub_f32 v59, v64, v50
    v_add_f32 v32, v32, v36
    v_add_f32 v64, v64, v50
    v_sub_f32 v36, v47, v18
    v_sub_f32 v50, v56, v66
    v_add_f32 v47, v47, v18
    v_add_f32 v56, v56, v66
    v_mul_f32 v18, 0x3f3504f3, v36
    v_mul_f32 v66, 0x3f3504f3, v36
    v_fmac_f32 v18, 0xbf3504f3, v50
    v_fmac_f32 v66, 0x3f3504f3, v50
    v_sub_f32 v36, v58, v52
    v_sub_f32 v50, v24, v34
    v_add_f32 v24, v24, v34
    v_add_f32 v52, v52, v58
    v_sub_f32 v34, v20, v26
    v_sub_f32 v58, v68, v74
    v_add_f32 v20, v20, v26
    v_add_f32 v68, v68, v74
    v_mul_f32 v26, 0xbf3504f3, v34
    v_mul_f32 v74, 0x3f3504f3, v34
    v_fmac_f32 v26, 0xbf3504f3, v58
    v_fmac_f32 v74, 0xbf3504f3, v58
    v_sub_f32 v34, v39, v43
    v_sub_f32 v58, v51, v79
    v_add_f32 v39, v39, v43
    v_add_f32 v51, v51, v79
    v_sub_f32 v43, v17, v21
    v_sub_f32 v79, v65, v69
    v_add_f32 v17, v17, v21
    v_add_f32 v65, v65, v69
    v_mul_f32 v21, 0x3f3504f3, v43
    v_mul_f32 v69, 0x3f3504f3, v43
    v_fmac_f32 v21, 0xbf3504f3, v79
    v_fmac_f32 v69, 0x3f3504f3, v79
    v_sub_f32 v43, v61, v57
    v_sub_f32 v79, v33, v37
    v_add_f32 v33, v33, v37
    v_add_f32 v57, v57, v61
    v_sub_f32 v37, v25, v29
    v_sub_f32 v61, v73, v77
    v_add_f32 v25, v25, v29
    v_add_f32 v73, v73, v77
    v_mul_f32 v29, 0xbf3504f3, v37
    v_mul_f32 v77, 0x3f3504f3, v37
    v_fmac_f32 v29, 0xbf3504f3, v61
    v_fmac_f32 v77, 0xbf3504f3, v61
    v_sub_f32 v37, v16, v80
    v_sub_f32 v61, v48, v72
    v_add_f32 v16, v16, v80
    v_add_f32 v48, v48, v72
    v_sub_f32 v80, v60, v81
    v_sub_f32 v72, v83, v40
    v_add_f32 v83, v83, v40
    v_add_f32 v81, v81, v60
    v_sub_f32 v40, v41, v28
    v_sub_f32 v60, v53, v76
    v_add_f32 v41, v41, v28
    v_add_f32 v53, v53, v76
    v_sub_f32 v28, v70, v62
    v_sub_f32 v76, v44, v22
    v_add_f32 v44, v44, v22
    v_add_f32 v62, v62, v70
    v_sub_f32 v22, v42, v31
    v_sub_f32 v70, v49, v55
    v_add_f32 v42, v42, v31
    v_add_f32 v49, v49, v55
    v_sub_f32 v31, v71, v63
    v_sub_f32 v55, v46, v23
    v_add_f32 v46, v46, v23
    v_add_f32 v63, v63, v71
    v_sub_f32 v23, v30, v38
    v_sub_f32 v71, v54, v78
    v_add_f32 v30, v30, v38
    v_add_f32 v54, v54, v78
    v_sub_f32 v38, v75, v67
    v_sub_f32 v78, v19, v27
    v_add_f32 v19, v19, v27
    v_add_f32 v67, v67, v75
    v_sub_f32 v27, v32, v24
    v_sub_f32 v75, v64, v52
    v_add_f32 v32, v32, v24
    v_add_f32 v64, v64, v52
    v_sub_f32 v24, v68, v56
    v_sub_f32 v52, v47, v20
    v_add_f32 v47, v47, v20
    v_add_f32 v56, v56, v68
    v_sub_f32 v20, v35, v36
    v_sub_f32 v68, v59, v50
    v_add_f32 v35, v35, v36
    v_add_f32 v59, v59, v50
    v_sub_f32 v36, v74, v66
    v_sub_f32 v50, v18, v26
    v_add_f32 v18, v18, v26
    v_add_f32 v66, v66, v74
    v_sub_f32 v26, v39, v33
    v_sub_f32 v74, v51, v57
    v_add_f32 v39, v39, v33
    v_add_f32 v51, v51, v57
    v_sub_f32 v33, v73, v65
    v_sub_f32 v57, v17, v25
    v_add_f32 v17, v17, v25
    v_add_f32 v65, v65, v73
    v_sub_f32 v25, v34, v43
    v_sub_f32 v73, v58, v79
    v_add_f32 v34, v34, v43
    v_add_f32 v58, v58, v79
    v_sub_f32 v43, v77, v69
    v_sub_f32 v79, v21, v29
    v_add_f32 v21, v21, v29
    v_add_f32 v69, v69, v77
    v_sub_f32 v29, v16, v83
    v_sub_f32 v77, v48, v81
    v_add_f32 v16, v16, v83
    v_add_f32 v48, v48, v81
    v_sub_f32 v83, v37, v80
    v_sub_f32 v81, v61, v72
    v_add_f32 v37, v37, v80
    v_add_f32 v61, v61, v72
    v_sub_f32 v80, v41, v44
    v_sub_f32 v72, v53, v62
    v_add_f32 v41, v41, v44
    v_add_f32 v53, v53, v62
    v_sub_f32 v44, v40, v28
    v_sub_f32 v62, v60, v76
    v_add_f32 v40, v40, v28
    v_add_f32 v60, v60, v76
    v_sub_f32 v28, v42, v46
    v_sub_f32 v76, v49, v63
    v_add_f32 v42, v42, v46
    v_add_f32 v49, v49, v63
    v_sub_f32 v46, v22, v31
    v_sub_f32 v63, v70, v55
    v_add_f32 v22, v22, v31
    v_add_f32 v70, v70, v55
    v_sub_f32 v31, v30, v19
    v_sub_f32 v55, v54, v67
    v_add_f32 v30, v30, v19
    v_add_f32 v54, v54, v67
    v_sub_f32 v19, v23, v38
    v_sub_f32 v67, v71, v78
    v_add_f32 v23, v23, v38
    v_add_f32 v71, v71, v78
    v_sub_f32 v38, v32, v47
    v_sub_f32 v78, v64, v56
    v_add_f32 v32, v32, v47
    v_add_f32 v64, v64, v56
    v_sub_f32 v47, v27, v24
    v_sub_f32 v56, v75, v52
    v_add_f32 v27, v27, v24
    v_add_f32 v75, v75, v52
    v_sub_f32 v24, v35, v18
    v_sub_f32 v52, v59, v66
    v_add_f32 v35, v35, v18
    v_add_f32 v59, v59, v66
    v_sub_f32 v18, v20, v36
    v_sub_f32 v66, v68, v50
    v_add_f32 v20, v20, v36
    v_add_f32 v68, v68, v50
    v_sub_f32 v36, v39, v17
    v_sub_f32 v50, v51, v65
    v_add_f32 v39, v39, v17
    v_add_f32 v51, v51, v65
    v_sub_f32 v17, v26, v33
    v_sub_f32 v65, v74, v57
    v_add_f32 v26, v26, v33
    v_add_f32 v74, v74, v57
    v_sub_f32 v33, v34, v21
    v_sub_f32 v57, v58, v69
    v_add_f32 v34, v34, v21
    v_add_f32 v58, v58, v69
    v_sub_f32 v21, v25, v43
    v_sub_f32 v69, v73, v79
    v_add_f32 v25, v25, v43
    v_add_f32 v73, v73, v79
    v_lshl_add_u32 v6, v1, 2, v7
    ds_write_b32 v6, v16 offset:0
    ds_write_b32 v6, v48 offset:4096
    ds_write_b32 v6, v32 offset:128
    ds_write_b32 v6, v64 offset:4224
    ds_write_b32 v6, v42 offset:256
    ds_write_b32 v6, v49 offset:4352
    ds_write_b32 v6, v39 offset:384
    ds_write_b32 v6, v51 offset:4480
    ds_write_b32 v6, v41 offset:512
    ds_write_b32 v6, v53 offset:4608
    ds_write_b32 v6, v35 offset:640
    ds_write_b32 v6, v59 offset:4736
    ds_write_b32 v6, v30 offset:768
    ds_write_b32 v6, v54 offset:4864
    ds_write_b32 v6, v34 offset:896
    ds_write_b32 v6, v58 offset:4992
    ds_write_b32 v6, v37 offset:1024
    ds_write_b32 v6, v61 offset:5120
    ds_write_b32 v6, v27 offset:1152
    ds_write_b32 v6, v75 offset:5248
    ds_write_b32 v6, v22 offset:1280
    ds_write_b32 v6, v70 offset:5376
    ds_write_b32 v6, v26 offset:1408
    ds_write_b32 v6, v74 offset:5504
    ds_write_b32 v6, v40 offset:1536
    ds_write_b32 v6, v60 offset:5632
    ds_write_b32 v6, v20 offset:1664
    ds_write_b32 v6, v68 offset:5760
    ds_write_b32 v6, v23 offset:1792
    ds_write_b32 v6, v71 offset:5888
    ds_write_b32 v6, v25 offset:1920
    ds_write_b32 v6, v73 offset:6016
    ds_write_b32 v6, v29 offset:2048
    ds_write_b32 v6, v77 offset:6144
    ds_write_b32 v6, v38 offset:2176
    ds_write_b32 v6, v78 offset:6272
    ds_write_b32 v6, v28 offset:2304
    ds_write_b32 v6, v76 offset:6400
    ds_write_b32 v6, v36 offset:2432
    ds_write_b32 v6, v50 offset:6528
    ds_write_b32 v6, v80 offset:2560
    ds_write_b32 v6, v72 offset:6656
    ds_write_b32 v6, v24 offset:2688
    ds_write_b32 v6, v52 offset:6784
    ds_write_b32 v6, v31 offset:2816
    ds_write_b32 v6, v55 offset:6912
    ds_write_b32 v6, v33 offset:2944
    ds_write_b32 v6, v57 offset:7040
    ds_write_b32 v6, v83 offset:3072
    ds_write_b32 v6, v81 offset:7168
    ds_write_b32 v6, v47 offset:3200
    ds_write_b32 v6, v56 offset:7296
    ds_write_b32 v6, v46 offset:3328
    ds_write_b32 v6, v63 offset:7424
    ds_write_b32 v6, v17 offset:3456
    ds_write_b32 v6, v65 offset:7552
    ds_write_b32 v6, v44 offset:3584
    ds_write_b32 v6, v62 offset:7680
    ds_write_b32 v6, v18 offset:3712
    ds_write_b32 v6, v66 offset:7808
    ds_write_b32 v6, v19 offset:3840
    ds_write_b32 v6, v67 offset:7936
    ds_write_b32 v6, v21 offset:3968
    ds_write_b32 v6, v69 offset:8064
    s_waitcnt lgkmcnt(0)
    s_barrier
    v_and_b32 v6, 127, v0
    v_lshrrev_b32 v7, 7, v0
    v_lshlrev_b32 v8, 5, v6
    v_lshl_add_u32 v8, v7, 12, v8
    v_lshlrev_b32 v5, 4, v6
    v_lshl_add_u32 v5, v7, 12, v5
    v_add_u32 v5, 2048, v5
    s_lshl_b32 s12, s92, 16
    ds_read_b128 v[16:19], v8 offset:0
    ds_read_b128 v[20:23], v8 offset:16
    s_waitcnt lgkmcnt(0)
    v_cvt_pk_bf16_f32 v24, v16, v17
    v_cvt_pk_bf16_f32 v25, v18, v19
    v_cvt_pk_bf16_f32 v26, v20, v21
    v_cvt_pk_bf16_f32 v27, v22, v23
    s_add_u32 s13, s12, 0
    buffer_store_dwordx4 v[24:27], v5, s[4:7], s13 offen
    s_nop 1
    ds_read_b128 v[16:19], v8 offset:8448
    ds_read_b128 v[20:23], v8 offset:8464
    s_waitcnt lgkmcnt(0)
    v_cvt_pk_bf16_f32 v24, v16, v17
    v_cvt_pk_bf16_f32 v25, v18, v19
    v_cvt_pk_bf16_f32 v26, v20, v21
    v_cvt_pk_bf16_f32 v27, v22, v23
    s_add_u32 s13, s12, 8192
    buffer_store_dwordx4 v[24:27], v5, s[4:7], s13 offen
    s_nop 1
    ds_read_b128 v[16:19], v8 offset:16896
    ds_read_b128 v[20:23], v8 offset:16912
    s_waitcnt lgkmcnt(0)
    v_cvt_pk_bf16_f32 v24, v16, v17
    v_cvt_pk_bf16_f32 v25, v18, v19
    v_cvt_pk_bf16_f32 v26, v20, v21
    v_cvt_pk_bf16_f32 v27, v22, v23
    s_add_u32 s13, s12, 16384
    buffer_store_dwordx4 v[24:27], v5, s[4:7], s13 offen
    s_nop 1
    ds_read_b128 v[16:19], v8 offset:25344
    ds_read_b128 v[20:23], v8 offset:25360
    s_waitcnt lgkmcnt(0)
    v_cvt_pk_bf16_f32 v24, v16, v17
    v_cvt_pk_bf16_f32 v25, v18, v19
    v_cvt_pk_bf16_f32 v26, v20, v21
    v_cvt_pk_bf16_f32 v27, v22, v23
    s_add_u32 s13, s12, 24576
    buffer_store_dwordx4 v[24:27], v5, s[4:7], s13 offen
    s_nop 1
    ds_read_b128 v[16:19], v8 offset:33792
    ds_read_b128 v[20:23], v8 offset:33808
    s_waitcnt lgkmcnt(0)
    v_cvt_pk_bf16_f32 v24, v16, v17
    v_cvt_pk_bf16_f32 v25, v18, v19
    v_cvt_pk_bf16_f32 v26, v20, v21
    v_cvt_pk_bf16_f32 v27, v22, v23
    s_add_u32 s13, s12, 32768
    buffer_store_dwordx4 v[24:27], v5, s[4:7], s13 offen
    s_nop 1
    ds_read_b128 v[16:19], v8 offset:42240
    ds_read_b128 v[20:23], v8 offset:42256
    s_waitcnt lgkmcnt(0)
    v_cvt_pk_bf16_f32 v24, v16, v17
    v_cvt_pk_bf16_f32 v25, v18, v19
    v_cvt_pk_bf16_f32 v26, v20, v21
    v_cvt_pk_bf16_f32 v27, v22, v23
    s_add_u32 s13, s12, 40960
    buffer_store_dwordx4 v[24:27], v5, s[4:7], s13 offen
    s_nop 1
    ds_read_b128 v[16:19], v8 offset:50688
    ds_read_b128 v[20:23], v8 offset:50704
    s_waitcnt lgkmcnt(0)
    v_cvt_pk_bf16_f32 v24, v16, v17
    v_cvt_pk_bf16_f32 v25, v18, v19
    v_cvt_pk_bf16_f32 v26, v20, v21
    v_cvt_pk_bf16_f32 v27, v22, v23
    s_add_u32 s13, s12, 49152
    buffer_store_dwordx4 v[24:27], v5, s[4:7], s13 offen
    s_nop 1
    ds_read_b128 v[16:19], v8 offset:59136
    ds_read_b128 v[20:23], v8 offset:59152
    s_waitcnt lgkmcnt(0)
    v_cvt_pk_bf16_f32 v24, v16, v17
    v_cvt_pk_bf16_f32 v25, v18, v19
    v_cvt_pk_bf16_f32 v26, v20, v21
    v_cvt_pk_bf16_f32 v27, v22, v23
    s_add_u32 s13, s12, 57344
    buffer_store_dwordx4 v[24:27], v5, s[4:7], s13 offen
    s_nop 1
mega_kernel_xo:
    s_load_dwordx2 s[8:9], s[0:1], 40
    s_load_dwordx2 s[12:13], s[0:1], 80
    v_lshrrev_b32 v3, 6, v0
    v_and_b32 v1, 63, v0
    v_readfirstlane_b32 s16, v3
    s_lshr_b32 s17, s92, 5
    s_and_b32 s18, s92, 31
    v_lshlrev_b32 v2, 4, v1
    s_waitcnt lgkmcnt(0) vmcnt(0)
    s_barrier
    s_mov_b32 s10, 8388608
    s_mov_b32 s11, 0x00020000
    s_mov_b32 s14, 8388608
    s_mov_b32 s15, 0x00020000
    s_mov_b32 s24, 0x3e0293ee
    v_lshrrev_b32 v3, 2, v1
    v_lshlrev_b32 v3, 11, v3
    v_and_b32 v4, 3, v1
    v_lshl_add_u32 v3, v4, 4, v3
    s_lshl_b32 s20, s16, 21
    s_lshl_b32 s21, s18, 6
    s_add_u32 s20, s20, s21
    v_add_u32 v24, s20, v3
    s_lshl_b32 s44, s16, 15
    v_lshrrev_b32 v3, 5, v1
    v_bfe_u32 v5, v1, 2, 2
    v_lshl_add_u32 v3, v3, 3, v5
    v_lshlrev_b32 v25, 6, v3
    v_bfe_u32 v5, v1, 4, 1
    v_lshl_add_u32 v25, v5, 5, v25
    v_lshl_add_u32 v25, v4, 3, v25
    v_add_u32 v25, s44, v25
    s_lshl_b32 s47, s17, 2
    s_add_u32 s20, s47, s16
    s_lshl_b32 s20, s20, 18
    s_lshl_b32 s21, s18, 13
    s_add_u32 s20, s20, s21
    s_add_u32 s20, s20, 50331648
    v_lshlrev_b32 v26, 7, v1
    buffer_load_dword v28, v26, s[84:87], s20 offen sc1
    s_add_u32 m0, s44, 0
    s_mov_b32 s20, 0
    buffer_load_dwordx4 v24, s[8:11], s20 offen lds
    s_add_u32 m0, s44, 1024
    s_mov_b32 s20, 32768
    buffer_load_dwordx4 v24, s[8:11], s20 offen lds
    s_add_u32 m0, s44, 2048
    s_mov_b32 s20, 65536
    buffer_load_dwordx4 v24, s[8:11], s20 offen lds
    s_add_u32 m0, s44, 3072
    s_mov_b32 s20, 98304
    buffer_load_dwordx4 v24, s[8:11], s20 offen lds
    s_add_u32 m0, s44, 4096
    s_mov_b32 s20, 131072
    buffer_load_dwordx4 v24, s[8:11], s20 offen lds
    s_add_u32 m0, s44, 5120
    s_mov_b32 s20, 163840
    buffer_load_dwordx4 v24, s[8:11], s20 offen lds
    s_add_u32 m0, s44, 6144
    s_mov_b32 s20, 196608
    buffer_load_dwordx4 v24, s[8:11], s20 offen lds
    s_add_u32 m0, s44, 7168
    s_mov_b32 s20, 229376
    buffer_load_dwordx4 v24, s[8:11], s20 offen lds
    s_add_u32 m0, s44, 8192
    s_mov_b32 s20, 262144
    buffer_load_dwordx4 v24, s[8:11], s20 offen lds
    s_add_u32 m0, s44, 9216
    s_mov_b32 s20, 294912
    buffer_load_dwordx4 v24, s[8:11], s20 offen lds
    s_add_u32 m0, s44, 10240
    s_mov_b32 s20, 327680
    buffer_load_dwordx4 v24, s[8:11], s20 offen lds
    s_add_u32 m0, s44, 11264
    s_mov_b32 s20, 360448
    buffer_load_dwordx4 v24, s[8:11], s20 offen lds
    s_add_u32 m0, s44, 12288
    s_mov_b32 s20, 393216
    buffer_load_dwordx4 v24, s[8:11], s20 offen lds
    s_add_u32 m0, s44, 13312
    s_mov_b32 s20, 425984
    buffer_load_dwordx4 v24, s[8:11], s20 offen lds
    s_add_u32 m0, s44, 14336
    s_mov_b32 s20, 458752
    buffer_load_dwordx4 v24, s[8:11], s20 offen lds
    s_add_u32 m0, s44, 15360
    s_mov_b32 s20, 491520
    buffer_load_dwordx4 v24, s[8:11], s20 offen lds
    s_add_u32 m0, s44, 16384
    s_mov_b32 s20, 524288
    buffer_load_dwordx4 v24, s[8:11], s20 offen lds
    s_add_u32 m0, s44, 17408
    s_mov_b32 s20, 557056
    buffer_load_dwordx4 v24, s[8:11], s20 offen lds
    s_add_u32 m0, s44, 18432
    s_mov_b32 s20, 589824
    buffer_load_dwordx4 v24, s[8:11], s20 offen lds
    s_add_u32 m0, s44, 19456
    s_mov_b32 s20, 622592
    buffer_load_dwordx4 v24, s[8:11], s20 offen lds
    s_add_u32 m0, s44, 20480
    s_mov_b32 s20, 655360
    buffer_load_dwordx4 v24, s[8:11], s20 offen lds
    s_add_u32 m0, s44, 21504
    s_mov_b32 s20, 688128
    buffer_load_dwordx4 v24, s[8:11], s20 offen lds
    s_add_u32 m0, s44, 22528
    s_mov_b32 s20, 720896
    buffer_load_dwordx4 v24, s[8:11], s20 offen lds
    s_add_u32 m0, s44, 23552
    s_mov_b32 s20, 753664
    buffer_load_dwordx4 v24, s[8:11], s20 offen lds
    s_add_u32 m0, s44, 24576
    s_mov_b32 s20, 786432
    buffer_load_dwordx4 v24, s[8:11], s20 offen lds
    s_add_u32 m0, s44, 25600
    s_mov_b32 s20, 819200
    buffer_load_dwordx4 v24, s[8:11], s20 offen lds
    s_add_u32 m0, s44, 26624
    s_mov_b32 s20, 851968
    buffer_load_dwordx4 v24, s[8:11], s20 offen lds
    s_add_u32 m0, s44, 27648
    s_mov_b32 s20, 884736
    buffer_load_dwordx4 v24, s[8:11], s20 offen lds
    s_add_u32 m0, s44, 28672
    s_mov_b32 s20, 917504
    buffer_load_dwordx4 v24, s[8:11], s20 offen lds
    s_add_u32 m0, s44, 29696
    s_mov_b32 s20, 950272
    buffer_load_dwordx4 v24, s[8:11], s20 offen lds
    s_add_u32 m0, s44, 30720
    s_mov_b32 s20, 983040
    buffer_load_dwordx4 v24, s[8:11], s20 offen lds
    s_add_u32 m0, s44, 31744
    s_mov_b32 s20, 1015808
    buffer_load_dwordx4 v24, s[8:11], s20 offen lds
    v_and_b32 v4, 15, v1
    v_lshrrev_b32 v5, 4, v1
    v_lshrrev_b32 v3, 2, v4
    v_lshlrev_b32 v3, 1, v3
    v_and_b32 v26, 1, v4
    v_add_u32 v3, v3, v26
    v_lshlrev_b32 v6, 8, v3
    v_lshl_add_u32 v6, v5, 4, v6
    s_lshr_b32 s20, s16, 1
    s_lshl_b32 s20, s20, 10
    s_add_u32 s20, s20, 2048
    v_lshlrev_b32 v7, 3, v1
    v_add_u32 v7, s20, v7
    v_lshlrev_b32 v8, 9, v5
    v_lshl_add_u32 v8, v4, 4, v8
    s_lshr_b32 s20, s16, 1
    s_lshl_b32 s20, s20, 12
    s_and_b32 s21, s16, 1
    s_lshl_b32 s21, s21, 8
    s_add_u32 s20, s20, s21
    v_add_u32 v8, s20, v8
    v_lshlrev_b32 v26, 2, v5
    v_sub_u32 v9, v4, v26
    s_lshr_b32 s21, s21, 4
    v_add_u32 v9, s21, v9
    v_add_u32 v10, -16, v9
    v_mov_b32 v11, 0xff7fffff
    v_mov_b32 v20, 0x3f803f80
    v_mov_b32 v21, 0x3f803f80
    v_mov_b32 v22, 0x3f803f80
    v_mov_b32 v23, 0x3f803f80
    v_and_b32 v26, 3, v1
    v_cmp_eq_u32 vcc, 3, v26
    s_lshl_b32 s20, s18, 8
    s_add_u32 s20, s20, 71303168
    v_cndmask_b32 v26, v26, 0, vcc
    v_lshlrev_b32 v12, 13, v26
    v_add_u32 v12, s20, v12
    v_and_b32 v26, 1, v1
    v_lshlrev_b32 v13, 7, v26
    s_add_u32 s20, s20, 24576
    v_add_u32 v13, s20, v13
    v_and_b32 v26, 7, v1
    s_lshl_b32 s20, s17, 5
    s_lshl_b32 s21, s16, 3
    s_add_u32 s20, s20, s21
    v_add_u32 v26, s20, v26
    v_lshlrev_b32 v14, 7, v26
    v_add_u32 v14, 71335936, v14
    v_bfrev_b32 v26, 1
    s_lshl_b32 s20, s92, 7
    s_add_u32 s20, s20, 71335936
    v_mov_b32 v27, s20
    v_cmp_eq_u32 vcc, 0, v0
    s_lshl_b32 s20, s16, 12
    v_add_u32 v17, s20, v2
    v_cndmask_b32 v15, v26, v27, vcc
    v_lshrrev_b32 v26, 3, v0
    v_and_b32 v27, 1, v0
    v_lshl_add_u32 v27, v27, 5, v26
    v_lshlrev_b32 v16, 4, v27
    v_bfe_u32 v27, v0, 1, 2
    v_lshl_add_u32 v16, v27, 10, v16
    v_lshlrev_b32 v18, 12, v26
    v_and_b32 v27, 7, v0
    v_lshl_add_u32 v18, v27, 3, v18
    s_lshl_b32 s20, s18, 6
    v_add_u32 v18, s20, v18
    s_waitcnt vmcnt(28)
    ds_read_b64_tr_b16 a[0:1], v25 offset:0
    ds_read_b64_tr_b16 a[2:3], v25 offset:256
    ds_read_b64_tr_b16 a[4:5], v25 offset:1024
    ds_read_b64_tr_b16 a[6:7], v25 offset:1280
    ds_read_b64_tr_b16 a[8:9], v25 offset:2048
    ds_read_b64_tr_b16 a[10:11], v25 offset:2304
    ds_read_b64_tr_b16 a[12:13], v25 offset:3072
    ds_read_b64_tr_b16 a[14:15], v25 offset:3328
    s_waitcnt lgkmcnt(0)
    s_add_u32 m0, s44, 0
    s_mov_b32 s20, 1048576
    buffer_load_dwordx4 v24, s[8:11], s20 offen lds
    s_add_u32 m0, s44, 1024
    s_mov_b32 s20, 1081344
    buffer_load_dwordx4 v24, s[8:11], s20 offen lds
    s_add_u32 m0, s44, 2048
    s_mov_b32 s20, 1114112
    buffer_load_dwordx4 v24, s[8:11], s20 offen lds
    s_add_u32 m0, s44, 3072
    s_mov_b32 s20, 1146880
    buffer_load_dwordx4 v24, s[8:11], s20 offen lds
    s_waitcnt vmcnt(28)
    ds_read_b64_tr_b16 a[16:17], v25 offset:4096
    ds_read_b64_tr_b16 a[18:19], v25 offset:4352
    ds_read_b64_tr_b16 a[20:21], v25 offset:5120
    ds_read_b64_tr_b16 a[22:23], v25 offset:5376
    ds_read_b64_tr_b16 a[24:25], v25 offset:6144
    ds_read_b64_tr_b16 a[26:27], v25 offset:6400
    ds_read_b64_tr_b16 a[28:29], v25 offset:7168
    ds_read_b64_tr_b16 a[30:31], v25 offset:7424
    s_waitcnt lgkmcnt(0)
    s_add_u32 m0, s44, 4096
    s_mov_b32 s20, 1179648
    buffer_load_dwordx4 v24, s[8:11], s20 offen lds
    s_add_u32 m0, s44, 5120
    s_mov_b32 s20, 1212416
    buffer_load_dwordx4 v24, s[8:11], s20 offen lds
    s_add_u32 m0, s44, 6144
    s_mov_b32 s20, 1245184
    buffer_load_dwordx4 v24, s[8:11], s20 offen lds
    s_add_u32 m0, s44, 7168
    s_mov_b32 s20, 1277952
    buffer_load_dwordx4 v24, s[8:11], s20 offen lds
    s_waitcnt vmcnt(28)
    ds_read_b64_tr_b16 a[32:33], v25 offset:8192
    ds_read_b64_tr_b16 a[34:35], v25 offset:8448
    ds_read_b64_tr_b16 a[36:37], v25 offset:9216
    ds_read_b64_tr_b16 a[38:39], v25 offset:9472
    ds_read_b64_tr_b16 a[40:41], v25 offset:10240
    ds_read_b64_tr_b16 a[42:43], v25 offset:10496
    ds_read_b64_tr_b16 a[44:45], v25 offset:11264
    ds_read_b64_tr_b16 a[46:47], v25 offset:11520
    s_waitcnt lgkmcnt(0)
    s_add_u32 m0, s44, 8192
    s_mov_b32 s20, 1310720
    buffer_load_dwordx4 v24, s[8:11], s20 offen lds
    s_add_u32 m0, s44, 9216
    s_mov_b32 s20, 1343488
    buffer_load_dwordx4 v24, s[8:11], s20 offen lds
    s_add_u32 m0, s44, 10240
    s_mov_b32 s20, 1376256
    buffer_load_dwordx4 v24, s[8:11], s20 offen lds
    s_add_u32 m0, s44, 11264
    s_mov_b32 s20, 1409024
    buffer_load_dwordx4 v24, s[8:11], s20 offen lds
    s_waitcnt vmcnt(28)
    ds_read_b64_tr_b16 a[48:49], v25 offset:12288
    ds_read_b64_tr_b16 a[50:51], v25 offset:12544
    ds_read_b64_tr_b16 a[52:53], v25 offset:13312
    ds_read_b64_tr_b16 a[54:55], v25 offset:13568
    ds_read_b64_tr_b16 a[56:57], v25 offset:14336
    ds_read_b64_tr_b16 a[58:59], v25 offset:14592
    ds_read_b64_tr_b16 a[60:61], v25 offset:15360
    ds_read_b64_tr_b16 a[62:63], v25 offset:15616
    s_waitcnt lgkmcnt(0)
    s_add_u32 m0, s44, 12288
    s_mov_b32 s20, 1441792
    buffer_load_dwordx4 v24, s[8:11], s20 offen lds
    s_add_u32 m0, s44, 13312
    s_mov_b32 s20, 1474560
    buffer_load_dwordx4 v24, s[8:11], s20 offen lds
    s_add_u32 m0, s44, 14336
    s_mov_b32 s20, 1507328
    buffer_load_dwordx4 v24, s[8:11], s20 offen lds
    s_add_u32 m0, s44, 15360
    s_mov_b32 s20, 1540096
    buffer_load_dwordx4 v24, s[8:11], s20 offen lds
    s_waitcnt vmcnt(28)
    ds_read_b64_tr_b16 a[64:65], v25 offset:16384
    ds_read_b64_tr_b16 a[66:67], v25 offset:16640
    ds_read_b64_tr_b16 a[68:69], v25 offset:17408
    ds_read_b64_tr_b16 a[70:71], v25 offset:17664
    ds_read_b64_tr_b16 a[72:73], v25 offset:18432
    ds_read_b64_tr_b16 a[74:75], v25 offset:18688
    ds_read_b64_tr_b16 a[76:77], v25 offset:19456
    ds_read_b64_tr_b16 a[78:79], v25 offset:19712
    s_waitcnt lgkmcnt(0)
    s_add_u32 m0, s44, 16384
    s_mov_b32 s20, 1572864
    buffer_load_dwordx4 v24, s[8:11], s20 offen lds
    s_add_u32 m0, s44, 17408
    s_mov_b32 s20, 1605632
    buffer_load_dwordx4 v24, s[8:11], s20 offen lds
    s_add_u32 m0, s44, 18432
    s_mov_b32 s20, 1638400
    buffer_load_dwordx4 v24, s[8:11], s20 offen lds
    s_add_u32 m0, s44, 19456
    s_mov_b32 s20, 1671168
    buffer_load_dwordx4 v24, s[8:11], s20 offen lds
    s_waitcnt vmcnt(28)
    ds_read_b64_tr_b16 a[80:81], v25 offset:20480
    ds_read_b64_tr_b16 a[82:83], v25 offset:20736
    ds_read_b64_tr_b16 a[84:85], v25 offset:21504
    ds_read_b64_tr_b16 a[86:87], v25 offset:21760
    ds_read_b64_tr_b16 a[88:89], v25 offset:22528
    ds_read_b64_tr_b16 a[90:91], v25 offset:22784
    ds_read_b64_tr_b16 a[92:93], v25 offset:23552
    ds_read_b64_tr_b16 a[94:95], v25 offset:23808
    s_waitcnt lgkmcnt(0)
    s_add_u32 m0, s44, 20480
    s_mov_b32 s20, 1703936
    buffer_load_dwordx4 v24, s[8:11], s20 offen lds
    s_add_u32 m0, s44, 21504
    s_mov_b32 s20, 1736704
    buffer_load_dwordx4 v24, s[8:11], s20 offen lds
    s_add_u32 m0, s44, 22528
    s_mov_b32 s20, 1769472
    buffer_load_dwordx4 v24, s[8:11], s20 offen lds
    s_add_u32 m0, s44, 23552
    s_mov_b32 s20, 1802240
    buffer_load_dwordx4 v24, s[8:11], s20 offen lds
    s_waitcnt vmcnt(28)
    ds_read_b64_tr_b16 a[96:97], v25 offset:24576
    ds_read_b64_tr_b16 a[98:99], v25 offset:24832
    ds_read_b64_tr_b16 a[100:101], v25 offset:25600
    ds_read_b64_tr_b16 a[102:103], v25 offset:25856
    ds_read_b64_tr_b16 a[104:105], v25 offset:26624
    ds_read_b64_tr_b16 a[106:107], v25 offset:26880
    ds_read_b64_tr_b16 a[108:109], v25 offset:27648
    ds_read_b64_tr_b16 a[110:111], v25 offset:27904
    s_waitcnt lgkmcnt(0)
    s_add_u32 m0, s44, 24576
    s_mov_b32 s20, 1835008
    buffer_load_dwordx4 v24, s[8:11], s20 offen lds
    s_add_u32 m0, s44, 25600
    s_mov_b32 s20, 1867776
    buffer_load_dwordx4 v24, s[8:11], s20 offen lds
    s_add_u32 m0, s44, 26624
    s_mov_b32 s20, 1900544
    buffer_load_dwordx4 v24, s[8:11], s20 offen lds
    s_add_u32 m0, s44, 27648
    s_mov_b32 s20, 1933312
    buffer_load_dwordx4 v24, s[8:11], s20 offen lds
    s_waitcnt vmcnt(28)
    ds_read_b64_tr_b16 a[112:113], v25 offset:28672
    ds_read_b64_tr_b16 a[114:115], v25 offset:28928
    ds_read_b64_tr_b16 a[116:117], v25 offset:29696
    ds_read_b64_tr_b16 a[118:119], v25 offset:29952
    ds_read_b64_tr_b16 a[120:121], v25 offset:30720
    ds_read_b64_tr_b16 a[122:123], v25 offset:30976
    ds_read_b64_tr_b16 a[124:125], v25 offset:31744
    ds_read_b64_tr_b16 a[126:127], v25 offset:32000
    s_waitcnt lgkmcnt(0)
    s_add_u32 m0, s44, 28672
    s_mov_b32 s20, 1966080
    buffer_load_dwordx4 v24, s[8:11], s20 offen lds
    s_add_u32 m0, s44, 29696
    s_mov_b32 s20, 1998848
    buffer_load_dwordx4 v24, s[8:11], s20 offen lds
    s_add_u32 m0, s44, 30720
    s_mov_b32 s20, 2031616
    buffer_load_dwordx4 v24, s[8:11], s20 offen lds
    s_add_u32 m0, s44, 31744
    s_mov_b32 s20, 2064384
    buffer_load_dwordx4 v24, s[8:11], s20 offen lds
    s_waitcnt vmcnt(28)
    ds_read_b64_tr_b16 a[128:129], v25 offset:0
    ds_read_b64_tr_b16 a[130:131], v25 offset:256
    ds_read_b64_tr_b16 a[132:133], v25 offset:1024
    ds_read_b64_tr_b16 a[134:135], v25 offset:1280
    ds_read_b64_tr_b16 a[136:137], v25 offset:2048
    ds_read_b64_tr_b16 a[138:139], v25 offset:2304
    ds_read_b64_tr_b16 a[140:141], v25 offset:3072
    ds_read_b64_tr_b16 a[142:143], v25 offset:3328
    s_waitcnt lgkmcnt(0)
    s_waitcnt vmcnt(24)
    ds_read_b64_tr_b16 a[144:145], v25 offset:4096
    ds_read_b64_tr_b16 a[146:147], v25 offset:4352
    ds_read_b64_tr_b16 a[148:149], v25 offset:5120
    ds_read_b64_tr_b16 a[150:151], v25 offset:5376
    ds_read_b64_tr_b16 a[152:153], v25 offset:6144
    ds_read_b64_tr_b16 a[154:155], v25 offset:6400
    ds_read_b64_tr_b16 a[156:157], v25 offset:7168
    ds_read_b64_tr_b16 a[158:159], v25 offset:7424
    s_waitcnt lgkmcnt(0)
    s_waitcnt vmcnt(20)
    ds_read_b64_tr_b16 a[160:161], v25 offset:8192
    ds_read_b64_tr_b16 a[162:163], v25 offset:8448
    ds_read_b64_tr_b16 a[164:165], v25 offset:9216
    ds_read_b64_tr_b16 a[166:167], v25 offset:9472
    ds_read_b64_tr_b16 a[168:169], v25 offset:10240
    ds_read_b64_tr_b16 a[170:171], v25 offset:10496
    ds_read_b64_tr_b16 a[172:173], v25 offset:11264
    ds_read_b64_tr_b16 a[174:175], v25 offset:11520
    s_waitcnt lgkmcnt(0)
    s_waitcnt vmcnt(16)
    ds_read_b64_tr_b16 a[176:177], v25 offset:12288
    ds_read_b64_tr_b16 a[178:179], v25 offset:12544
    ds_read_b64_tr_b16 a[180:181], v25 offset:13312
    ds_read_b64_tr_b16 a[182:183], v25 offset:13568
    ds_read_b64_tr_b16 a[184:185], v25 offset:14336
    ds_read_b64_tr_b16 a[186:187], v25 offset:14592
    ds_read_b64_tr_b16 a[188:189], v25 offset:15360
    ds_read_b64_tr_b16 a[190:191], v25 offset:15616
    s_waitcnt lgkmcnt(0)
    s_waitcnt vmcnt(12)
    ds_read_b64_tr_b16 a[192:193], v25 offset:16384
    ds_read_b64_tr_b16 a[194:195], v25 offset:16640
    ds_read_b64_tr_b16 a[196:197], v25 offset:17408
    ds_read_b64_tr_b16 a[198:199], v25 offset:17664
    ds_read_b64_tr_b16 a[200:201], v25 offset:18432
    ds_read_b64_tr_b16 a[202:203], v25 offset:18688
    ds_read_b64_tr_b16 a[204:205], v25 offset:19456
    ds_read_b64_tr_b16 a[206:207], v25 offset:19712
    s_waitcnt lgkmcnt(0)
    s_waitcnt vmcnt(8)
    ds_read_b64_tr_b16 a[208:209], v25 offset:20480
    ds_read_b64_tr_b16 a[210:211], v25 offset:20736
    ds_read_b64_tr_b16 a[212:213], v25 offset:21504
    ds_read_b64_tr_b16 a[214:215], v25 offset:21760
    ds_read_b64_tr_b16 a[216:217], v25 offset:22528
    ds_read_b64_tr_b16 a[218:219], v25 offset:22784
    ds_read_b64_tr_b16 a[220:221], v25 offset:23552
    ds_read_b64_tr_b16 a[222:223], v25 offset:23808
    s_waitcnt lgkmcnt(0)
    s_waitcnt vmcnt(4)
    ds_read_b64_tr_b16 a[224:225], v25 offset:24576
    ds_read_b64_tr_b16 a[226:227], v25 offset:24832
    ds_read_b64_tr_b16 a[228:229], v25 offset:25600
    ds_read_b64_tr_b16 a[230:231], v25 offset:25856
    ds_read_b64_tr_b16 a[232:233], v25 offset:26624
    ds_read_b64_tr_b16 a[234:235], v25 offset:26880
    ds_read_b64_tr_b16 a[236:237], v25 offset:27648
    ds_read_b64_tr_b16 a[238:239], v25 offset:27904
    s_waitcnt lgkmcnt(0)
    s_waitcnt vmcnt(0)
    ds_read_b64_tr_b16 a[240:241], v25 offset:28672
    ds_read_b64_tr_b16 a[242:243], v25 offset:28928
    ds_read_b64_tr_b16 a[244:245], v25 offset:29696
    ds_read_b64_tr_b16 a[246:247], v25 offset:29952
    ds_read_b64_tr_b16 a[248:249], v25 offset:30720
    ds_read_b64_tr_b16 a[250:251], v25 offset:30976
    ds_read_b64_tr_b16 a[252:253], v25 offset:31744
    ds_read_b64_tr_b16 a[254:255], v25 offset:32000
    s_waitcnt lgkmcnt(0)
    s_barrier
    s_add_u32 s22, s17, 12
    s_sub_u32 s20, s17, 4
    s_cmp_ge_u32 s17, 4
    s_cselect_b32 s22, s20, s22
    s_and_b32 s20, s22, 1
    s_lshl_b32 s20, s20, 7
    s_lshr_b32 s43, s22, 1
mega_kernel_x_gpa:
    buffer_load_dword v3, v12, s[84:87], s20 offen sc1
    s_waitcnt vmcnt(0)
    v_cmp_ge_u32 vcc, s43, v3
    s_cbranch_vccz mega_kernel_x_gka
    s_sleep 8
    s_branch mega_kernel_x_gpa
mega_kernel_x_gka:
    s_lshl_b32 s27, s22, 18
    s_lshl_b32 s20, s18, 13
    s_add_u32 s27, s27, s20
    s_and_b32 s20, s16, 1
    s_lshl_b32 s20, s20, 10
    s_add_u32 s26, s27, s20
    s_lshr_b32 s20, s16, 1
    s_lshl_b32 s20, s20, 12
    s_add_u32 s28, s27, s20
    s_add_u32 s28, s28, 33554432
    s_add_u32 s27, s27, 16777216
    s_add_u32 s20, s26, 4096
    s_add_u32 s21, s27, 4096
    buffer_load_dwordx4 v[24:27], v2, s[84:87], s26 offen offset:0
    buffer_load_dwordx4 v[28:31], v2, s[84:87], s26 offen offset:2048
    buffer_load_dwordx4 v[32:35], v2, s[84:87], s20 offen offset:0
    buffer_load_dwordx4 v[36:39], v2, s[84:87], s20 offen offset:2048
    buffer_load_dwordx4 v[40:43], v2, s[84:87], s27 offen offset:0
    buffer_load_dwordx4 v[44:47], v2, s[84:87], s27 offen offset:1024
    buffer_load_dwordx4 v[48:51], v2, s[84:87], s27 offen offset:2048
    buffer_load_dwordx4 v[52:55], v2, s[84:87], s27 offen offset:3072
    buffer_load_dwordx4 v[56:59], v2, s[84:87], s21 offen offset:0
    buffer_load_dwordx4 v[60:63], v2, s[84:87], s21 offen offset:1024
    buffer_load_dwordx4 v[64:67], v2, s[84:87], s21 offen offset:2048
    buffer_load_dwordx4 v[68:71], v2, s[84:87], s21 offen offset:3072
    buffer_load_dwordx4 v[72:75], v2, s[84:87], s28 offen offset:0
    buffer_load_dwordx4 v[76:79], v2, s[84:87], s28 offen offset:1024
    buffer_load_dwordx4 v[80:83], v2, s[84:87], s28 offen offset:2048
    buffer_load_dwordx4 v[84:87], v2, s[84:87], s28 offen offset:3072
    s_mov_b32 s46, 0
mega_kernel_x_att:
    s_waitcnt vmcnt(0)
    v_mfma_f32_16x16x32_bf16 v[112:115], v[40:43], v[24:27], 0
    v_mfma_f32_16x16x32_bf16 v[116:119], v[44:47], v[24:27], 0
    v_mfma_f32_16x16x32_bf16 v[112:115], v[48:51], v[28:31], v[112:115]
    v_mfma_f32_16x16x32_bf16 v[116:119], v[52:55], v[28:31], v[116:119]
    v_mfma_f32_16x16x32_bf16 v[112:115], v[56:59], v[32:35], v[112:115]
    v_mfma_f32_16x16x32_bf16 v[116:119], v[60:63], v[32:35], v[116:119]
    v_mfma_f32_16x16x32_bf16 v[112:115], v[64:67], v[36:39], v[112:115]
    v_mfma_f32_16x16x32_bf16 v[116:119], v[68:71], v[36:39], v[116:119]
    s_lshl_b32 s29, s22, 18
    s_lshl_b32 s20, s18, 13
    s_add_u32 s29, s29, s20
    s_add_u32 s29, s29, 178257920
    s_lshl_b32 s40, s47, 18
    s_add_u32 s40, s40, 50331648
    s_lshl_b32 s20, s18, 13
    s_add_u32 s40, s40, s20
    s_nop 1
    v_cmp_gt_i32 vcc, 0, v9
    s_nop 1
    v_cndmask_b32 v112, v112, v11, vcc
    v_cmp_gt_i32 vcc, 1, v9
    s_nop 1
    v_cndmask_b32 v113, v113, v11, vcc
    v_cmp_gt_i32 vcc, 2, v9
    s_nop 1
    v_cndmask_b32 v114, v114, v11, vcc
    v_cmp_gt_i32 vcc, 3, v9
    s_nop 1
    v_cndmask_b32 v115, v115, v11, vcc
    v_cmp_gt_i32 vcc, 0, v10
    s_nop 1
    v_cndmask_b32 v116, v116, v11, vcc
    v_cmp_gt_i32 vcc, 1, v10
    s_nop 1
    v_cndmask_b32 v117, v117, v11, vcc
    v_cmp_gt_i32 vcc, 2, v10
    s_nop 1
    v_cndmask_b32 v118, v118, v11, vcc
    v_cmp_gt_i32 vcc, 3, v10
    s_nop 1
    v_cndmask_b32 v119, v119, v11, vcc
mega_kernel_x_rp:
    buffer_load_dword v3, v13, s[84:87], 0 offen sc1
    s_waitcnt vmcnt(0)
    v_cmp_ge_u32 vcc, s22, v3
    s_cbranch_vccz mega_kernel_x_rk
    s_sleep 4
    s_branch mega_kernel_x_rp
mega_kernel_x_rk:
    buffer_load_dwordx4 v[88:91], v6, s[84:87], s29 offen offset:0 sc1
    buffer_load_dwordx4 v[92:95], v6, s[84:87], s29 offen offset:64 sc1
    buffer_load_dwordx4 v[96:99], v6, s[84:87], s29 offen offset:128 sc1
    buffer_load_dwordx4 v[100:103], v6, s[84:87], s29 offen offset:192 sc1
    buffer_load_dwordx2 v[104:105], v7, s[84:87], s29 offen offset:0 sc1
    buffer_load_dwordx2 v[106:107], v7, s[84:87], s29 offen offset:2048 sc1
    buffer_load_dwordx2 v[108:109], v7, s[84:87], s29 offen offset:512 sc1
    buffer_load_dwordx2 v[110:111], v7, s[84:87], s29 offen offset:2560 sc1
    v_mov_b32 v130, v20
    v_mov_b32 v131, 0
    s_waitcnt vmcnt(7)
    v_mfma_f32_16x16x32_bf16 v[120:123], v[88:91], v[24:27], 0
    s_waitcnt vmcnt(6)
    v_mfma_f32_16x16x32_bf16 v[120:123], v[92:95], v[28:31], v[120:123]
    s_waitcnt vmcnt(5)
    v_mfma_f32_16x16x32_bf16 v[120:123], v[96:99], v[32:35], v[120:123]
    s_waitcnt vmcnt(4)
    v_mfma_f32_16x16x32_bf16 v[120:123], v[100:103], v[36:39], v[120:123]
    v_max3_f32 v4, v112, v113, v114
    v_max3_f32 v4, v4, v115, v116
    v_max3_f32 v4, v4, v117, v118
    s_waitcnt vmcnt(0)
    v_swap_b32 v105, v106
    v_swap_b32 v109, v110
    s_nop 1
    v_max3_f32 v4, v4, v119, v120
    v_max_f32 v3, v4, v121
    v_max_f32 v4, v4, v121
    s_nop 1
    v_permlane16_swap_b32 v4, v3
    v_max_f32 v4, v4, v3
    v_max_f32 v3, v4, v3
    s_nop 1
    v_permlane32_swap_b32 v4, v3
    v_max_f32 v4, v4, v3
    v_mul_f32 v4, s24, v4
    v_fma_f32 v112, v112, s24, -v4
    v_fma_f32 v113, v113, s24, -v4
    v_fma_f32 v114, v114, s24, -v4
    v_fma_f32 v115, v115, s24, -v4
    v_fma_f32 v116, v116, s24, -v4
    v_fma_f32 v117, v117, s24, -v4
    v_fma_f32 v118, v118, s24, -v4
    v_fma_f32 v119, v119, s24, -v4
    v_fma_f32 v120, v120, s24, -v4
    v_fma_f32 v121, v121, s24, -v4
    v_exp_f32 v112, v112
    v_exp_f32 v113, v113
    v_exp_f32 v114, v114
    v_exp_f32 v115, v115
    v_exp_f32 v116, v116
    v_exp_f32 v117, v117
    v_exp_f32 v118, v118
    v_exp_f32 v119, v119
    v_exp_f32 v120, v120
    v_exp_f32 v121, v121
    s_nop 0
    v_cvt_pk_bf16_f32 v124, v112, v113
    v_cvt_pk_bf16_f32 v125, v114, v115
    v_cvt_pk_bf16_f32 v126, v116, v117
    v_cvt_pk_bf16_f32 v127, v118, v119
    v_cvt_pk_bf16_f32 v128, v120, v121
    v_mov_b32 v129, v128
    s_nop 1
    v_mfma_f32_16x16x32_bf16 v[132:135], v[20:23], v[124:127], 0
    v_mfma_f32_16x16x32_bf16 v[88:91], v[72:75], v[124:127], 0
    v_mfma_f32_16x16x32_bf16 v[92:95], v[76:79], v[124:127], 0
    v_mfma_f32_16x16x32_bf16 v[96:99], v[80:83], v[124:127], 0
    v_mfma_f32_16x16x32_bf16 v[100:103], v[84:87], v[124:127], 0
    s_nop 1
    v_mfma_f32_16x16x16_bf16 v[132:135], v[130:131], v[128:129], v[132:135]
    v_mfma_f32_16x16x16_bf16 v[88:91], v[104:105], v[128:129], v[88:91]
    v_mfma_f32_16x16x16_bf16 v[92:95], v[106:107], v[128:129], v[92:95]
    v_mfma_f32_16x16x16_bf16 v[96:99], v[108:109], v[128:129], v[96:99]
    v_mfma_f32_16x16x16_bf16 v[100:103], v[110:111], v[128:129], v[100:103]
    s_nop 3
    v_rcp_f32 v132, v132
    s_nop 2
    v_pk_mul_f32 v[88:89], v[88:89], v[132:133] op_sel_hi:[1,0]
    v_pk_mul_f32 v[90:91], v[90:91], v[132:133] op_sel_hi:[1,0]
    v_pk_mul_f32 v[92:93], v[92:93], v[132:133] op_sel_hi:[1,0]
    v_pk_mul_f32 v[94:95], v[94:95], v[132:133] op_sel_hi:[1,0]
    v_pk_mul_f32 v[96:97], v[96:97], v[132:133] op_sel_hi:[1,0]
    v_pk_mul_f32 v[98:99], v[98:99], v[132:133] op_sel_hi:[1,0]
    v_pk_mul_f32 v[100:101], v[100:101], v[132:133] op_sel_hi:[1,0]
    v_pk_mul_f32 v[102:103], v[102:103], v[132:133] op_sel_hi:[1,0]
    v_cvt_pk_bf16_f32 v112, v88, v89
    v_cvt_pk_bf16_f32 v113, v90, v91
    v_cvt_pk_bf16_f32 v114, v92, v93
    v_cvt_pk_bf16_f32 v115, v94, v95
    v_cvt_pk_bf16_f32 v116, v96, v97
    v_cvt_pk_bf16_f32 v117, v98, v99
    v_cvt_pk_bf16_f32 v118, v100, v101
    v_cvt_pk_bf16_f32 v119, v102, v103
    s_add_u32 s43, s22, 1
    v_mov_b32 v4, s43
    s_cmp_eq_u32 s96, 1
    s_cbranch_scc1 mega_kernel_x_of
    buffer_store_dwordx4 v[112:115], v8, s[84:87], s40 offen sc1
    buffer_store_dwordx4 v[116:119], v8, s[84:87], s40 offen offset:2048 sc1
    s_waitcnt vmcnt(0)
    s_barrier
    buffer_store_dword v4, v15, s[84:87], 0 offen sc1
    s_branch mega_kernel_x_od
mega_kernel_x_of:
    buffer_store_dwordx4 v[112:115], v8, s[84:87], s40 offen
    buffer_store_dwordx4 v[116:119], v8, s[84:87], s40 offen offset:2048
    s_waitcnt vmcnt(0)
    s_barrier
    buffer_store_dword v4, v15, s[84:87], 0 offen
mega_kernel_x_od:
    s_cmp_eq_u32 s46, 1
    s_cbranch_scc1 mega_kernel_x_proj
mega_kernel_x_adv:
    s_mov_b32 s45, s22
    s_mov_b32 s48, s47
    s_add_u32 s20, s47, 1
    s_and_b32 s20, s20, 3
    s_andn2_b32 s47, s47, 3
    s_or_b32 s47, s47, s20
    s_add_u32 s20, s22, 2
    s_add_u32 s21, s17, 12
    s_cmp_lt_u32 s20, 12
    s_cselect_b32 s20, s20, s21
    s_add_u32 s21, s22, 6
    s_cmp_lt_u32 s22, 12
    s_cselect_b32 s22, s20, s21
    s_mov_b32 s46, 0
    s_cmp_ge_u32 s22, 64
    s_cbranch_scc1 mega_kernel_x_proj
    buffer_load_dword v5, v13, s[84:87], 0 offen sc1
    s_and_b32 s20, s22, 1
    s_lshl_b32 s20, s20, 7
    s_lshr_b32 s43, s22, 1
mega_kernel_x_gpb:
    buffer_load_dword v3, v12, s[84:87], s20 offen sc1
    s_waitcnt vmcnt(0)
    v_cmp_ge_u32 vcc, s43, v3
    s_cbranch_vccz mega_kernel_x_gkb
    s_sleep 8
    s_branch mega_kernel_x_gpb
mega_kernel_x_gkb:
    s_lshl_b32 s27, s22, 18
    s_lshl_b32 s20, s18, 13
    s_add_u32 s27, s27, s20
    s_and_b32 s20, s16, 1
    s_lshl_b32 s20, s20, 10
    s_add_u32 s26, s27, s20
    s_lshr_b32 s20, s16, 1
    s_lshl_b32 s20, s20, 12
    s_add_u32 s28, s27, s20
    s_add_u32 s28, s28, 33554432
    s_add_u32 s27, s27, 16777216
    s_add_u32 s20, s26, 4096
    s_add_u32 s21, s27, 4096
    buffer_load_dwordx4 v[24:27], v2, s[84:87], s26 offen offset:0
    buffer_load_dwordx4 v[28:31], v2, s[84:87], s26 offen offset:2048
    buffer_load_dwordx4 v[32:35], v2, s[84:87], s20 offen offset:0
    buffer_load_dwordx4 v[36:39], v2, s[84:87], s20 offen offset:2048
    buffer_load_dwordx4 v[40:43], v2, s[84:87], s27 offen offset:0
    buffer_load_dwordx4 v[44:47], v2, s[84:87], s27 offen offset:1024
    buffer_load_dwordx4 v[48:51], v2, s[84:87], s27 offen offset:2048
    buffer_load_dwordx4 v[52:55], v2, s[84:87], s27 offen offset:3072
    buffer_load_dwordx4 v[56:59], v2, s[84:87], s21 offen offset:0
    buffer_load_dwordx4 v[60:63], v2, s[84:87], s21 offen offset:1024
    buffer_load_dwordx4 v[64:67], v2, s[84:87], s21 offen offset:2048
    buffer_load_dwordx4 v[68:71], v2, s[84:87], s21 offen offset:3072
    buffer_load_dwordx4 v[72:75], v2, s[84:87], s28 offen offset:0
    buffer_load_dwordx4 v[76:79], v2, s[84:87], s28 offen offset:1024
    buffer_load_dwordx4 v[80:83], v2, s[84:87], s28 offen offset:2048
    buffer_load_dwordx4 v[84:87], v2, s[84:87], s28 offen offset:3072
    v_cmp_ge_u32 vcc, s22, v5
    v_mov_b32 v4, 16384
    s_cmp_eq_u64 vcc, 0
    s_cselect_b32 s20, 1, 0
    v_mov_b32 v3, s20
    s_cmp_lg_u32 s16, 0
    s_cbranch_scc1 mega_kernel_x_nd
    ds_write_b32 v4, v3
    s_waitcnt lgkmcnt(0)
mega_kernel_x_nd:
    s_barrier
    ds_read_b32 v3, v4
    s_waitcnt lgkmcnt(0)
    v_readfirstlane_b32 s46, v3
    s_nop 3
    s_cmp_eq_u32 s46, 1
    s_cbranch_scc1 mega_kernel_x_att
mega_kernel_x_proj:
    s_lshl_b32 s41, s48, 18
    s_add_u32 s41, s41, 50331648
    s_lshl_b32 s20, s16, 16
    s_add_u32 s41, s41, s20
    s_lshl_b32 s42, s45, 17
mega_kernel_x_xp:
    buffer_load_dword v3, v14, s[84:87], 0 offen sc1
    s_waitcnt vmcnt(0)
    v_cmp_ge_u32 vcc, s45, v3
    s_cbranch_vccnz mega_kernel_x_xp
    s_add_u32 s20, s41, 0
    buffer_load_dwordx4 v[136:139], v2, s[84:87], s20 offen offset:0 sc1
    buffer_load_dwordx4 v[140:143], v2, s[84:87], s20 offen offset:1024 sc1
    buffer_load_dwordx4 v[144:147], v2, s[84:87], s20 offen offset:2048 sc1
    buffer_load_dwordx4 v[148:151], v2, s[84:87], s20 offen offset:3072 sc1
    s_add_u32 s20, s41, 4096
    buffer_load_dwordx4 v[152:155], v2, s[84:87], s20 offen offset:0 sc1
    buffer_load_dwordx4 v[156:159], v2, s[84:87], s20 offen offset:1024 sc1
    buffer_load_dwordx4 v[160:163], v2, s[84:87], s20 offen offset:2048 sc1
    buffer_load_dwordx4 v[164:167], v2, s[84:87], s20 offen offset:3072 sc1
    s_add_u32 s20, s41, 8192
    buffer_load_dwordx4 v[168:171], v2, s[84:87], s20 offen offset:0 sc1
    buffer_load_dwordx4 v[172:175], v2, s[84:87], s20 offen offset:1024 sc1
    buffer_load_dwordx4 v[176:179], v2, s[84:87], s20 offen offset:2048 sc1
    buffer_load_dwordx4 v[180:183], v2, s[84:87], s20 offen offset:3072 sc1
    s_add_u32 s20, s41, 12288
    buffer_load_dwordx4 v[184:187], v2, s[84:87], s20 offen offset:0 sc1
    buffer_load_dwordx4 v[188:191], v2, s[84:87], s20 offen offset:1024 sc1
    buffer_load_dwordx4 v[192:195], v2, s[84:87], s20 offen offset:2048 sc1
    buffer_load_dwordx4 v[196:199], v2, s[84:87], s20 offen offset:3072 sc1
    s_add_u32 s20, s41, 16384
    buffer_load_dwordx4 v[200:203], v2, s[84:87], s20 offen offset:0 sc1
    buffer_load_dwordx4 v[204:207], v2, s[84:87], s20 offen offset:1024 sc1
    buffer_load_dwordx4 v[208:211], v2, s[84:87], s20 offen offset:2048 sc1
    buffer_load_dwordx4 v[212:215], v2, s[84:87], s20 offen offset:3072 sc1
    s_add_u32 s20, s41, 20480
    buffer_load_dwordx4 v[216:219], v2, s[84:87], s20 offen offset:0 sc1
    buffer_load_dwordx4 v[220:223], v2, s[84:87], s20 offen offset:1024 sc1
    buffer_load_dwordx4 v[224:227], v2, s[84:87], s20 offen offset:2048 sc1
    buffer_load_dwordx4 v[228:231], v2, s[84:87], s20 offen offset:3072 sc1
    s_add_u32 s20, s41, 24576
    buffer_load_dwordx4 v[232:235], v2, s[84:87], s20 offen offset:0 sc1
    buffer_load_dwordx4 v[236:239], v2, s[84:87], s20 offen offset:1024 sc1
    buffer_load_dwordx4 v[240:243], v2, s[84:87], s20 offen offset:2048 sc1
    buffer_load_dwordx4 v[244:247], v2, s[84:87], s20 offen offset:3072 sc1
    s_waitcnt vmcnt(27)
    v_mfma_f32_32x32x16_bf16 v[88:103], a[0:3], v[136:139], 0
    s_add_u32 s20, s41, 28672
    buffer_load_dwordx4 v[248:251], v2, s[84:87], s20 offen offset:0 sc1
    s_waitcnt vmcnt(27)
    v_mfma_f32_32x32x16_bf16 v[88:103], a[4:7], v[140:143], v[88:103]
    buffer_load_dwordx4 v[252:255], v2, s[84:87], s20 offen offset:1024 sc1
    s_waitcnt vmcnt(27)
    v_mfma_f32_32x32x16_bf16 v[88:103], a[8:11], v[144:147], v[88:103]
    buffer_load_dwordx4 v[136:139], v2, s[84:87], s20 offen offset:2048 sc1
    s_waitcnt vmcnt(27)
    v_mfma_f32_32x32x16_bf16 v[88:103], a[12:15], v[148:151], v[88:103]
    buffer_load_dwordx4 v[140:143], v2, s[84:87], s20 offen offset:3072 sc1
    s_waitcnt vmcnt(27)
    v_mfma_f32_32x32x16_bf16 v[88:103], a[16:19], v[152:155], v[88:103]
    s_add_u32 s20, s41, 32768
    buffer_load_dwordx4 v[144:147], v2, s[84:87], s20 offen offset:0 sc1
    s_waitcnt vmcnt(27)
    v_mfma_f32_32x32x16_bf16 v[88:103], a[20:23], v[156:159], v[88:103]
    buffer_load_dwordx4 v[148:151], v2, s[84:87], s20 offen offset:1024 sc1
    s_waitcnt vmcnt(27)
    v_mfma_f32_32x32x16_bf16 v[88:103], a[24:27], v[160:163], v[88:103]
    buffer_load_dwordx4 v[152:155], v2, s[84:87], s20 offen offset:2048 sc1
    s_waitcnt vmcnt(27)
    v_mfma_f32_32x32x16_bf16 v[88:103], a[28:31], v[164:167], v[88:103]
    buffer_load_dwordx4 v[156:159], v2, s[84:87], s20 offen offset:3072 sc1
    s_waitcnt vmcnt(27)
    v_mfma_f32_32x32x16_bf16 v[88:103], a[32:35], v[168:171], v[88:103]
    s_add_u32 s20, s41, 36864
    buffer_load_dwordx4 v[160:163], v2, s[84:87], s20 offen offset:0 sc1
    s_waitcnt vmcnt(27)
    v_mfma_f32_32x32x16_bf16 v[88:103], a[36:39], v[172:175], v[88:103]
    buffer_load_dwordx4 v[164:167], v2, s[84:87], s20 offen offset:1024 sc1
    s_waitcnt vmcnt(27)
    v_mfma_f32_32x32x16_bf16 v[88:103], a[40:43], v[176:179], v[88:103]
    buffer_load_dwordx4 v[168:171], v2, s[84:87], s20 offen offset:2048 sc1
    s_waitcnt vmcnt(27)
    v_mfma_f32_32x32x16_bf16 v[88:103], a[44:47], v[180:183], v[88:103]
    buffer_load_dwordx4 v[172:175], v2, s[84:87], s20 offen offset:3072 sc1
    s_waitcnt vmcnt(27)
    v_mfma_f32_32x32x16_bf16 v[88:103], a[48:51], v[184:187], v[88:103]
    s_add_u32 s20, s41, 40960
    buffer_load_dwordx4 v[176:179], v2, s[84:87], s20 offen offset:0 sc1
    s_waitcnt vmcnt(27)
    v_mfma_f32_32x32x16_bf16 v[88:103], a[52:55], v[188:191], v[88:103]
    buffer_load_dwordx4 v[180:183], v2, s[84:87], s20 offen offset:1024 sc1
    s_waitcnt vmcnt(27)
    v_mfma_f32_32x32x16_bf16 v[88:103], a[56:59], v[192:195], v[88:103]
    buffer_load_dwordx4 v[184:187], v2, s[84:87], s20 offen offset:2048 sc1
    s_waitcnt vmcnt(27)
    v_mfma_f32_32x32x16_bf16 v[88:103], a[60:63], v[196:199], v[88:103]
    buffer_load_dwordx4 v[188:191], v2, s[84:87], s20 offen offset:3072 sc1
    s_waitcnt vmcnt(27)
    v_mfma_f32_32x32x16_bf16 v[88:103], a[64:67], v[200:203], v[88:103]
    s_add_u32 s20, s41, 45056
    buffer_load_dwordx4 v[192:195], v2, s[84:87], s20 offen offset:0 sc1
    s_waitcnt vmcnt(27)
    v_mfma_f32_32x32x16_bf16 v[88:103], a[68:71], v[204:207], v[88:103]
    buffer_load_dwordx4 v[196:199], v2, s[84:87], s20 offen offset:1024 sc1
    s_waitcnt vmcnt(27)
    v_mfma_f32_32x32x16_bf16 v[88:103], a[72:75], v[208:211], v[88:103]
    buffer_load_dwordx4 v[200:203], v2, s[84:87], s20 offen offset:2048 sc1
    s_waitcnt vmcnt(27)
    v_mfma_f32_32x32x16_bf16 v[88:103], a[76:79], v[212:215], v[88:103]
    buffer_load_dwordx4 v[204:207], v2, s[84:87], s20 offen offset:3072 sc1
    s_waitcnt vmcnt(27)
    v_mfma_f32_32x32x16_bf16 v[88:103], a[80:83], v[216:219], v[88:103]
    s_add_u32 s20, s41, 49152
    buffer_load_dwordx4 v[208:211], v2, s[84:87], s20 offen offset:0 sc1
    s_waitcnt vmcnt(27)
    v_mfma_f32_32x32x16_bf16 v[88:103], a[84:87], v[220:223], v[88:103]
    buffer_load_dwordx4 v[212:215], v2, s[84:87], s20 offen offset:1024 sc1
    s_waitcnt vmcnt(27)
    v_mfma_f32_32x32x16_bf16 v[88:103], a[88:91], v[224:227], v[88:103]
    buffer_load_dwordx4 v[216:219], v2, s[84:87], s20 offen offset:2048 sc1
    s_waitcnt vmcnt(27)
    v_mfma_f32_32x32x16_bf16 v[88:103], a[92:95], v[228:231], v[88:103]
    buffer_load_dwordx4 v[220:223], v2, s[84:87], s20 offen offset:3072 sc1
    s_waitcnt vmcnt(27)
    v_mfma_f32_32x32x16_bf16 v[88:103], a[96:99], v[232:235], v[88:103]
    s_add_u32 s20, s41, 53248
    buffer_load_dwordx4 v[224:227], v2, s[84:87], s20 offen offset:0 sc1
    s_waitcnt vmcnt(27)
    v_mfma_f32_32x32x16_bf16 v[88:103], a[100:103], v[236:239], v[88:103]
    buffer_load_dwordx4 v[228:231], v2, s[84:87], s20 offen offset:1024 sc1
    s_waitcnt vmcnt(27)
    v_mfma_f32_32x32x16_bf16 v[88:103], a[104:107], v[240:243], v[88:103]
    buffer_load_dwordx4 v[232:235], v2, s[84:87], s20 offen offset:2048 sc1
    s_waitcnt vmcnt(27)
    v_mfma_f32_32x32x16_bf16 v[88:103], a[108:111], v[244:247], v[88:103]
    buffer_load_dwordx4 v[236:239], v2, s[84:87], s20 offen offset:3072 sc1
    s_waitcnt vmcnt(27)
    v_mfma_f32_32x32x16_bf16 v[88:103], a[112:115], v[248:251], v[88:103]
    s_add_u32 s20, s41, 57344
    buffer_load_dwordx4 v[240:243], v2, s[84:87], s20 offen offset:0 sc1
    s_waitcnt vmcnt(27)
    v_mfma_f32_32x32x16_bf16 v[88:103], a[116:119], v[252:255], v[88:103]
    buffer_load_dwordx4 v[244:247], v2, s[84:87], s20 offen offset:1024 sc1
    s_waitcnt vmcnt(27)
    v_mfma_f32_32x32x16_bf16 v[88:103], a[120:123], v[136:139], v[88:103]
    buffer_load_dwordx4 v[248:251], v2, s[84:87], s20 offen offset:2048 sc1
    s_waitcnt vmcnt(27)
    v_mfma_f32_32x32x16_bf16 v[88:103], a[124:127], v[140:143], v[88:103]
    buffer_load_dwordx4 v[252:255], v2, s[84:87], s20 offen offset:3072 sc1
    s_waitcnt vmcnt(27)
    v_mfma_f32_32x32x16_bf16 v[88:103], a[128:131], v[144:147], v[88:103]
    s_add_u32 s20, s41, 61440
    buffer_load_dwordx4 v[136:139], v2, s[84:87], s20 offen offset:0 sc1
    s_waitcnt vmcnt(27)
    v_mfma_f32_32x32x16_bf16 v[88:103], a[132:135], v[148:151], v[88:103]
    buffer_load_dwordx4 v[140:143], v2, s[84:87], s20 offen offset:1024 sc1
    s_waitcnt vmcnt(27)
    v_mfma_f32_32x32x16_bf16 v[88:103], a[136:139], v[152:155], v[88:103]
    buffer_load_dwordx4 v[144:147], v2, s[84:87], s20 offen offset:2048 sc1
    s_waitcnt vmcnt(27)
    v_mfma_f32_32x32x16_bf16 v[88:103], a[140:143], v[156:159], v[88:103]
    buffer_load_dwordx4 v[148:151], v2, s[84:87], s20 offen offset:3072 sc1
    s_waitcnt vmcnt(27)
    v_mfma_f32_32x32x16_bf16 v[88:103], a[144:147], v[160:163], v[88:103]
    s_waitcnt vmcnt(26)
    v_mfma_f32_32x32x16_bf16 v[88:103], a[148:151], v[164:167], v[88:103]
    s_waitcnt vmcnt(25)
    v_mfma_f32_32x32x16_bf16 v[88:103], a[152:155], v[168:171], v[88:103]
    s_waitcnt vmcnt(24)
    v_mfma_f32_32x32x16_bf16 v[88:103], a[156:159], v[172:175], v[88:103]
    s_waitcnt vmcnt(23)
    v_mfma_f32_32x32x16_bf16 v[88:103], a[160:163], v[176:179], v[88:103]
    s_waitcnt vmcnt(22)
    v_mfma_f32_32x32x16_bf16 v[88:103], a[164:167], v[180:183], v[88:103]
    s_waitcnt vmcnt(21)
    v_mfma_f32_32x32x16_bf16 v[88:103], a[168:171], v[184:187], v[88:103]
    s_waitcnt vmcnt(20)
    v_mfma_f32_32x32x16_bf16 v[88:103], a[172:175], v[188:191], v[88:103]
    s_waitcnt vmcnt(19)
    v_mfma_f32_32x32x16_bf16 v[88:103], a[176:179], v[192:195], v[88:103]
    s_waitcnt vmcnt(18)
    v_mfma_f32_32x32x16_bf16 v[88:103], a[180:183], v[196:199], v[88:103]
    s_waitcnt vmcnt(17)
    v_mfma_f32_32x32x16_bf16 v[88:103], a[184:187], v[200:203], v[88:103]
    s_waitcnt vmcnt(16)
    v_mfma_f32_32x32x16_bf16 v[88:103], a[188:191], v[204:207], v[88:103]
    s_waitcnt vmcnt(15)
    v_mfma_f32_32x32x16_bf16 v[88:103], a[192:195], v[208:211], v[88:103]
    s_waitcnt vmcnt(14)
    v_mfma_f32_32x32x16_bf16 v[88:103], a[196:199], v[212:215], v[88:103]
    s_waitcnt vmcnt(13)
    v_mfma_f32_32x32x16_bf16 v[88:103], a[200:203], v[216:219], v[88:103]
    s_waitcnt vmcnt(12)
    v_mfma_f32_32x32x16_bf16 v[88:103], a[204:207], v[220:223], v[88:103]
    s_waitcnt vmcnt(11)
    v_mfma_f32_32x32x16_bf16 v[88:103], a[208:211], v[224:227], v[88:103]
    s_waitcnt vmcnt(10)
    v_mfma_f32_32x32x16_bf16 v[88:103], a[212:215], v[228:231], v[88:103]
    s_waitcnt vmcnt(9)
    v_mfma_f32_32x32x16_bf16 v[88:103], a[216:219], v[232:235], v[88:103]
    s_waitcnt vmcnt(8)
    v_mfma_f32_32x32x16_bf16 v[88:103], a[220:223], v[236:239], v[88:103]
    s_waitcnt vmcnt(7)
    v_mfma_f32_32x32x16_bf16 v[88:103], a[224:227], v[240:243], v[88:103]
    s_waitcnt vmcnt(6)
    v_mfma_f32_32x32x16_bf16 v[88:103], a[228:231], v[244:247], v[88:103]
    s_waitcnt vmcnt(5)
    v_mfma_f32_32x32x16_bf16 v[88:103], a[232:235], v[248:251], v[88:103]
    s_waitcnt vmcnt(4)
    v_mfma_f32_32x32x16_bf16 v[88:103], a[236:239], v[252:255], v[88:103]
    s_waitcnt vmcnt(3)
    v_mfma_f32_32x32x16_bf16 v[88:103], a[240:243], v[136:139], v[88:103]
    s_waitcnt vmcnt(2)
    v_mfma_f32_32x32x16_bf16 v[88:103], a[244:247], v[140:143], v[88:103]
    s_waitcnt vmcnt(1)
    v_mfma_f32_32x32x16_bf16 v[88:103], a[248:251], v[144:147], v[88:103]
    s_waitcnt vmcnt(0)
    v_mfma_f32_32x32x16_bf16 v[88:103], a[252:255], v[148:151], v[88:103]
    s_nop 11
    s_barrier
    ds_write_b128 v17, v[88:91] offset:0
    ds_write_b128 v17, v[92:95] offset:1024
    ds_write_b128 v17, v[96:99] offset:2048
    ds_write_b128 v17, v[100:103] offset:3072
    s_waitcnt lgkmcnt(0)
    s_barrier
    ds_read_b128 v[88:91], v16 offset:0
    ds_read_b128 v[92:95], v16 offset:4096
    ds_read_b128 v[96:99], v16 offset:8192
    ds_read_b128 v[100:103], v16 offset:12288
    s_waitcnt lgkmcnt(0)
    v_pk_add_f32 v[88:89], v[88:89], v[92:93]
    v_pk_add_f32 v[90:91], v[90:91], v[94:95]
    v_pk_add_f32 v[96:97], v[96:97], v[100:101]
    v_pk_add_f32 v[98:99], v[98:99], v[102:103]
    v_pk_add_f32 v[88:89], v[88:89], v[96:97]
    v_pk_add_f32 v[90:91], v[90:91], v[98:99]
    v_cvt_pk_bf16_f32 v112, v88, v89
    v_cvt_pk_bf16_f32 v113, v90, v91
    buffer_store_dwordx2 v[112:113], v18, s[12:15], s42 offen
    s_cmp_ge_u32 s22, 64
    s_cbranch_scc1 mega_kernel_x_done
    s_cmp_eq_u32 s46, 1
    s_cbranch_scc1 mega_kernel_x_adv
    s_branch mega_kernel_x_att
mega_kernel_x_done:
    s_endpgm
.section .rodata,"a"
.p2align 6
.amdhsa_kernel mega_kernel
  .amdhsa_next_free_vgpr 512
  .amdhsa_next_free_sgpr 102
  .amdhsa_accum_offset 256
  .amdhsa_group_segment_fixed_size 0
  .amdhsa_kernarg_size 104
  .amdhsa_user_sgpr_count 2
  .amdhsa_user_sgpr_kernarg_segment_ptr 1
  .amdhsa_system_sgpr_workgroup_id_x 1
.end_amdhsa_kernel
```

```asm
; @launch kernel=mega_kernel grid=(256,1,1) block=(256,1,1) lds=161792
.amdgcn_target "amdgcn-amd-amdhsa--gfx950"
.text
.globl mega_kernel
.p2align 8
.type mega_kernel,@function
mega_kernel:
    s_cmp_ge_u32 s2, 256
    s_cbranch_scc1 mega_kernel_exit
    s_load_dwordx2 s[84:85], s[0:1], 96
    s_load_dwordx2 s[88:89], s[0:1], 88
    s_getreg_b32 s93, hwreg(HW_REG_XCC_ID)
    s_and_b32 s93, s93, 7
    v_lshrrev_b32 v1, 6, v0
    v_mov_b32 v4, 0
    v_readfirstlane_b32 s80, v1
    v_mov_b32 v5, 0
    v_mov_b32 v6, 0
    v_mov_b32 v7, 0
    s_mov_b32 s83, 0
    s_lshl_b32 s101, s2, 2
    s_add_u32 s101, s101, s80
    s_lshl_b32 s101, s101, 8
    s_add_u32 s101, s101, 230686720
    s_waitcnt lgkmcnt(0)
    s_mov_b32 s86, 268435456
    s_mov_b32 s87, 0x00020000
    s_mov_b32 s90, 256
    s_mov_b32 s91, 0x00020000
    s_mov_b32 s98, s80
    s_cmp_lg_u32 s80, 0
    s_cbranch_scc1 mega_kernel_st0
    v_mov_b32 v10, 1
    s_lshl_b32 s81, s93, 5
    s_mov_b64 exec, 1
    buffer_atomic_add v10, off, s[88:91], s81 offset:4 sc0
    s_lshl_b32 s81, s2, 7
    s_add_u32 s81, s81, 71303168
    s_mov_b64 exec, 3
    v_lshlrev_b32 v1, 15, v0
    buffer_store_dword v4, v1, s[84:87], s81 offen sc1
    s_mov_b64 exec, -1
mega_kernel_st0:
    s_load_dwordx2 s[72:73], s[0:1], 8
    v_mov_b32 v4, 0
    v_mov_b32 v5, 0
    v_mov_b32 v6, 0
    v_mov_b32 v7, 0
    v_lshlrev_b32 v1, 4, v0
    s_lshl_b32 s81, s2, 13
    s_add_u32 s81, s81, 67108864
    s_add_u32 s79, s81, 4096
    buffer_store_dwordx4 v[4:7], v1, s[84:87], s81 offen sc1
    buffer_store_dwordx4 v[4:7], v1, s[84:87], s79 offen sc1
    v_lshlrev_b32 v1, 3, v0
    s_lshl_b32 s81, s2, 11
    s_add_u32 s81, s81, 70254592
    buffer_store_dwordx2 v[4:5], v1, s[84:87], s81 offen sc1
    s_cmp_ge_u32 s2, 64
    s_cbranch_scc1 mega_kernel_gi
    v_bfe_u32 v2, v0, 3, 1
    v_lshlrev_b32 v2, 11, v2
    v_and_b32 v3, 3, v0
    v_lshl_add_u32 v2, v3, 5, v2
    v_bfe_u32 v3, v0, 4, 3
    v_lshl_add_u32 v2, v3, 2, v2
    v_bfe_u32 v3, v0, 2, 1
    v_lshl_add_u32 v2, v3, 1, v2
    s_lshr_b32 s81, s2, 2
    s_lshl_b32 s81, s81, 7
    s_and_b32 s79, s2, 3
    s_lshl_b32 s79, s79, 12
    s_add_u32 s81, s81, s79
    s_waitcnt lgkmcnt(0)
    s_mov_b32 s74, 16384
    s_mov_b32 s75, 0x00020000
    buffer_load_ushort v8, v2, s[72:75], s81 offen
    v_mov_b32 v9, -1
    v_and_b32 v1, 127, v0
    v_lshlrev_b32 v1, 1, v1
    v_lshrrev_b32 v3, 7, v0
    v_lshl_add_u32 v1, v3, 14, v1
    v_cmp_gt_u32 vcc, 128, v0
    s_lshl_b32 s81, s2, 8
    s_add_u32 s81, s81, 69206016
    s_waitcnt vmcnt(0)
    v_min_u32 v8, 0xfffe, v8
    v_cndmask_b32 v8, v9, v8, vcc
    buffer_store_short v8, v1, s[84:87], s81 offen sc1
mega_kernel_gi:
    s_waitcnt lgkmcnt(0)
    s_cmp_lg_u32 s80, 0
    s_cbranch_scc1 mega_kernel_st1
    s_mov_b64 exec, 1
    s_waitcnt vmcnt(4)
    ds_write_b32 v4, v10
    s_mov_b64 exec, -1
    s_waitcnt lgkmcnt(0)
mega_kernel_st1:
    s_barrier
    ds_read_b32 v2, v4
    s_waitcnt lgkmcnt(0)
    v_readfirstlane_b32 s94, v2
    s_barrier
    s_sub_u32 s81, s93, 2
    s_cmp_ge_u32 s81, 2
    s_cbranch_scc1 mega_kernel_nopr
    s_cmp_lg_u32 s80, 0
    s_cbranch_scc1 mega_kernel_prd
    v_lshlrev_b32 v1, 4, v0
    s_and_b32 s81, s2, 127
    s_lshl_b32 s81, s81, 14
    s_add_u32 s81, s81, 67108864
    s_add_u32 s77, s81, 8192
    buffer_store_dwordx4 v[4:7], v1, s[84:87], s81 offen sc1
    buffer_store_dwordx4 v[4:7], v1, s[84:87], s77 offen sc1
    s_waitcnt vmcnt(0)
    s_memtime s[70:71]
    buffer_store_dwordx4 v[4:7], v1, s[84:87], s81 offen sc1
    s_waitcnt vmcnt(0)
    s_memtime s[72:73]
    buffer_store_dwordx4 v[4:7], v1, s[84:87], s77 offen sc1
    s_waitcnt vmcnt(0)
    buffer_store_dwordx4 v[4:7], v1, s[84:87], s77 offen sc1
    s_waitcnt vmcnt(0)
    s_memtime s[74:75]
    buffer_store_dwordx4 v[4:7], v1, s[84:87], s81 offen sc1
    s_waitcnt vmcnt(0)
    s_memtime s[76:77]
    s_waitcnt lgkmcnt(0)
    s_sub_u32 s76, s76, s74
    s_sub_u32 s74, s74, s72
    s_sub_u32 s72, s72, s70
    s_add_u32 s72, s72, s76
    s_cmp_lt_u32 s74, s72
    s_cselect_b32 s81, 0x10001, 1
    v_mov_b32 v8, s81
    s_mov_b64 exec, 1
    buffer_atomic_add v8, off, s[88:91], 0 offset:204 sc1
    s_mov_b64 exec, -1
mega_kernel_prd:
    s_barrier
mega_kernel_nopr:
    s_mov_b32 s97, 0
    s_mov_b32 s100, 64
mega_kernel_fast:
    s_mov_b32 s96, 1
    s_mov_b32 s30, s93
    s_and_b32 s31, s94, 31
    s_cmp_lt_u32 s93, 2
    s_cbranch_scc1 mega_kernel_recf
    s_sub_u32 s92, s93, 2
    s_lshl_b32 s92, s92, 5
    s_add_u32 s92, s92, s31
    s_branch mega_kernel_bulk
mega_kernel_redo:
    s_waitcnt vmcnt(0) lgkmcnt(0)
    s_barrier
    v_readlane_b32 s100, v252, 2
    v_readlane_b32 s81, v252, 3
    s_mov_b32 s97, 1
    s_nop 2
    s_add_u32 s100, s100, s81
    s_mov_b32 s95, s94
    v_readlane_b32 s81, v252, 0
    s_cmp_gt_u32 s93, 0
    s_nop 2
    s_cselect_b32 s81, s81, 0
    s_add_u32 s95, s95, s81
    v_readlane_b32 s81, v252, 1
    s_cmp_gt_u32 s93, 1
    s_nop 2
    s_cselect_b32 s81, s81, 0
    s_add_u32 s95, s95, s81
    v_readlane_b32 s81, v252, 2
    s_cmp_gt_u32 s93, 2
    s_nop 2
    s_cselect_b32 s81, s81, 0
    s_add_u32 s95, s95, s81
    v_readlane_b32 s81, v252, 3
    s_cmp_gt_u32 s93, 3
    s_nop 2
    s_cselect_b32 s81, s81, 0
    s_add_u32 s95, s95, s81
    v_readlane_b32 s81, v252, 4
    s_cmp_gt_u32 s93, 4
    s_nop 2
    s_cselect_b32 s81, s81, 0
    s_add_u32 s95, s95, s81
    v_readlane_b32 s81, v252, 5
    s_cmp_gt_u32 s93, 5
    s_nop 2
    s_cselect_b32 s81, s81, 0
    s_add_u32 s95, s95, s81
    v_readlane_b32 s81, v252, 6
    s_cmp_gt_u32 s93, 6
    s_nop 2
    s_cselect_b32 s81, s81, 0
    s_add_u32 s95, s95, s81
mega_kernel_slow:
    s_mov_b32 s96, 0
    s_lshr_b32 s30, s95, 5
    s_and_b32 s31, s95, 31
    s_cmp_lt_u32 s95, 64
    s_cbranch_scc1 mega_kernel_recs
    s_sub_u32 s92, s95, 64
    s_branch mega_kernel_bulk
mega_kernel_exit:
    s_endpgm
mega_kernel_recf:
    s_load_dwordx2 s[4:5], s[0:1], 96
    s_load_dwordx2 s[12:13], s[0:1], 88
    s_load_dwordx2 s[50:51], s[0:1], 16
    s_load_dwordx2 s[52:53], s[0:1], 24
    s_load_dwordx2 s[54:55], s[0:1], 32
    s_load_dwordx2 s[56:57], s[0:1], 40
    s_load_dwordx2 s[58:59], s[0:1], 8
    v_lshrrev_b32 v3, 6, v0
    v_and_b32 v40, 63, v0
    v_readfirstlane_b32 s20, v3
    v_lshrrev_b32 v41, 4, v40
    v_and_b32 v42, 15, v40
    v_lshlrev_b32 v1, 4, v40
    s_mov_b32 s49, 0
    s_waitcnt lgkmcnt(0)
    s_mov_b32 s6, 268435456
    s_mov_b32 s7, 0x00020000
    s_mov_b32 s14, 256
    s_mov_b32 s15, 0x00020000
    s_mov_b32 s10, 8388608
    s_mov_b32 s11, 0x00020000
    s_mov_b32 s26, 0x00030003
    s_mov_b32 s27, 0x00030003
    s_mov_b32 s28, 0xcccccccc
    s_mov_b32 s29, 0xcccccccc
    s_mov_b32 s32, 0x33333333
    s_mov_b32 s33, 0x33333333
    s_mov_b32 s34, 0x3e0293ee
    s_lshl_b32 s22, s20, 2
    v_xor_b32 v3, s22, v42
    v_lshlrev_b32 v3, 4, v3
    v_lshl_add_u32 v4, v41, 4, s20
    v_lshl_add_u32 v44, v4, 13, v3
    s_lshl_b32 s22, s30, 22
    s_lshl_b32 s23, s31, 8
    s_add_u32 s22, s22, s23
    v_add_u32 v44, s22, v44
    s_lshr_b32 s22, s20, 1
    s_lshl_b32 s22, s22, 5
    s_and_b32 s23, s20, 1
    s_lshl_b32 s23, s23, 2
    s_add_u32 s22, s22, s23
    s_lshl_b32 s23, s31, 7
    s_add_u32 s22, s22, s23
    v_add_u32 v4, s22, v41
    v_lshl_add_u32 v45, v4, 11, v3
    s_lshl_b32 s22, s30, 10
    v_add_u32 v45, s22, v45
    s_lshl_b32 s48, s20, 10
    s_mov_b32 s8, s50
    s_mov_b32 s9, s51
    s_add_u32 m0, s48, 0
    s_mov_b32 s22, 0
    buffer_load_dwordx4 v44, s[8:11], s22 offen  lds
    s_add_u32 m0, s48, 4096
    s_mov_b32 s22, 32768
    buffer_load_dwordx4 v44, s[8:11], s22 offen  lds
    s_add_u32 m0, s48, 8192
    s_mov_b32 s22, 65536
    buffer_load_dwordx4 v44, s[8:11], s22 offen  lds
    s_add_u32 m0, s48, 12288
    s_mov_b32 s22, 98304
    buffer_load_dwordx4 v44, s[8:11], s22 offen  lds
    s_add_u32 m0, s48, 16384
    s_mov_b32 s22, 524288
    buffer_load_dwordx4 v44, s[8:11], s22 offen  lds
    s_add_u32 m0, s48, 20480
    s_mov_b32 s22, 557056
    buffer_load_dwordx4 v44, s[8:11], s22 offen  lds
    s_add_u32 m0, s48, 24576
    s_mov_b32 s22, 589824
    buffer_load_dwordx4 v44, s[8:11], s22 offen  lds
    s_add_u32 m0, s48, 28672
    s_mov_b32 s22, 622592
    buffer_load_dwordx4 v44, s[8:11], s22 offen  lds
    s_add_u32 m0, s48, 32768
    s_mov_b32 s22, 1048576
    buffer_load_dwordx4 v44, s[8:11], s22 offen  lds
    s_add_u32 m0, s48, 36864
    s_mov_b32 s22, 1081344
    buffer_load_dwordx4 v44, s[8:11], s22 offen  lds
    s_add_u32 m0, s48, 40960
    s_mov_b32 s22, 1114112
    buffer_load_dwordx4 v44, s[8:11], s22 offen  lds
    s_add_u32 m0, s48, 45056
    s_mov_b32 s22, 1146880
    buffer_load_dwordx4 v44, s[8:11], s22 offen  lds
    s_add_u32 m0, s48, 49152
    s_mov_b32 s22, 1572864
    buffer_load_dwordx4 v44, s[8:11], s22 offen  lds
    s_add_u32 m0, s48, 53248
    s_mov_b32 s22, 1605632
    buffer_load_dwordx4 v44, s[8:11], s22 offen  lds
    s_add_u32 m0, s48, 57344
    s_mov_b32 s22, 1638400
    buffer_load_dwordx4 v44, s[8:11], s22 offen  lds
    s_add_u32 m0, s48, 61440
    s_mov_b32 s22, 1671168
    buffer_load_dwordx4 v44, s[8:11], s22 offen  lds
    s_add_u32 m0, s48, 65536
    s_mov_b32 s22, 2097152
    buffer_load_dwordx4 v44, s[8:11], s22 offen  lds
    s_add_u32 m0, s48, 69632
    s_mov_b32 s22, 2129920
    buffer_load_dwordx4 v44, s[8:11], s22 offen  lds
    s_add_u32 m0, s48, 73728
    s_mov_b32 s22, 2162688
    buffer_load_dwordx4 v44, s[8:11], s22 offen  lds
    s_add_u32 m0, s48, 77824
    s_mov_b32 s22, 2195456
    buffer_load_dwordx4 v44, s[8:11], s22 offen  lds
    s_add_u32 m0, s48, 81920
    s_mov_b32 s22, 2621440
    buffer_load_dwordx4 v44, s[8:11], s22 offen  lds
    s_add_u32 m0, s48, 86016
    s_mov_b32 s22, 2654208
    buffer_load_dwordx4 v44, s[8:11], s22 offen  lds
    s_add_u32 m0, s48, 90112
    s_mov_b32 s22, 2686976
    buffer_load_dwordx4 v44, s[8:11], s22 offen  lds
    s_add_u32 m0, s48, 94208
    s_mov_b32 s22, 2719744
    buffer_load_dwordx4 v44, s[8:11], s22 offen  lds
    s_add_u32 m0, s48, 98304
    s_mov_b32 s22, 3145728
    buffer_load_dwordx4 v44, s[8:11], s22 offen  lds
    s_add_u32 m0, s48, 102400
    s_mov_b32 s22, 3178496
    buffer_load_dwordx4 v44, s[8:11], s22 offen  lds
    s_add_u32 m0, s48, 106496
    s_mov_b32 s22, 3211264
    buffer_load_dwordx4 v44, s[8:11], s22 offen  lds
    s_add_u32 m0, s48, 110592
    s_mov_b32 s22, 3244032
    buffer_load_dwordx4 v44, s[8:11], s22 offen  lds
    s_add_u32 m0, s48, 114688
    s_mov_b32 s22, 3670016
    buffer_load_dwordx4 v44, s[8:11], s22 offen  lds
    s_add_u32 m0, s48, 118784
    s_mov_b32 s22, 3702784
    buffer_load_dwordx4 v44, s[8:11], s22 offen  lds
    s_add_u32 m0, s48, 122880
    s_mov_b32 s22, 3735552
    buffer_load_dwordx4 v44, s[8:11], s22 offen  lds
    s_add_u32 m0, s48, 126976
    s_mov_b32 s22, 3768320
    buffer_load_dwordx4 v44, s[8:11], s22 offen  lds
    s_waitcnt vmcnt(32)
    s_barrier
    s_or_b32 s81, s97, s98
    s_cmp_lg_u32 s81, 0
    s_cbranch_scc1 mega_kernel_h0_1
    s_lshl_b32 s81, s93, 5
    v_mov_b32 v250, 1
    s_mov_b64 exec, 1
    buffer_atomic_add v250, off, s[88:91], s81 sc1
    s_mov_b64 exec, -1
mega_kernel_h0_1:
    s_lshl_b32 s22, s30, 5
    s_add_u32 s22, s22, s31
    s_lshl_b32 s38, s22, 14
    s_xor_b32 s22, s22, 32
    s_lshl_b32 s37, s22, 14
    s_add_u32 s38, s38, 67108864
    s_add_u32 s37, s37, 67108864
    s_lshl_b32 s46, s30, 18
    s_add_u32 s46, s46, 70254592
    s_lshl_b32 s22, s31, 13
    s_add_u32 s47, s46, s22
    s_lshl_b32 s22, s20, 16
    s_add_u32 s46, s46, s22
    s_lshl_b32 s22, s31, 8
    s_add_u32 s46, s46, s22
    s_add_u32 s61, s46, 32768
    s_add_u32 s25, s47, 4096
    s_lshl_b32 s35, s30, 13
    s_add_u32 s35, s35, 69206016
    v_lshrrev_b32 v53, 2, v42
    v_lshlrev_b32 v53, 1, v53
    v_and_b32 v54, 1, v42
    v_add_u32 v55, v53, v54
    v_mov_b32 v14, 0
    v_mov_b32 v15, 0
    v_mov_b32 v2, 0x4444
    v_mov_b32 v3, 0xeeee
    v_cndmask_b32 v2, v2, v3, s[28:29]
    s_lshl_b32 s22, s20, 12
    v_add_u32 v32, s22, v1
    v_add_u32 v33, 0x10000, v32
    v_add_u32 v5, 0x10000, v1
    v_add_u32 v6, 131072, v1
    v_and_b32 v3, 3, v42
    v_bfe_u32 v43, v40, 1, 1
    v_lshlrev_b32 v7, 13, v43
    v_and_b32 v43, 1, v40
    v_lshl_add_u32 v7, v43, 7, v7
    s_lshl_b32 s22, s31, 8
    s_add_u32 s23, s22, 71311360
    v_add_u32 v7, s23, v7
    s_cmp_lg_u32 s20, 0
    s_cbranch_scc1 mega_kernel_rf_flk
    s_lshl_b32 s23, s30, 7
    s_add_u32 s22, s22, s23
    s_add_u32 s22, s22, 71327744
    v_bfrev_b32 v7, 1
    v_writelane_b32 v7, s22, 0
mega_kernel_rf_flk:
    v_lshlrev_b32 v11, 3, v40
    v_lshlrev_b32 v10, 8, v55
    v_lshl_add_u32 v10, v41, 4, v10
    v_lshlrev_b32 v8, 13, v41
    v_lshl_add_u32 v8, v42, 4, v8
    v_lshrrev_b32 v9, 1, v41
    v_lshlrev_b32 v9, 5, v9
    v_and_b32 v4, 1, v42
    v_lshl_add_u32 v9, v4, 4, v9
    v_and_b32 v4, 1, v41
    v_lshl_add_u32 v9, v4, 3, v9
    s_lshl_b32 s22, s31, 8
    v_add_u32 v9, s22, v9
    v_lshrrev_b32 v4, 2, v42
    v_lshlrev_b32 v12, 8, v4
    v_lshl_add_u32 v12, v41, 6, v12
    v_lshl_add_u32 v12, v3, 4, v12
    v_lshlrev_b32 v13, 8, v41
    v_lshl_add_u32 v13, v42, 2, v13
    v_cmp_eq_u32 vcc, 0, v3
    v_mov_b32 v28, 0x3f803f80
    v_mov_b32 v29, 0x3f803f80
    v_cndmask_b32 v34, 0, 1, vcc
    v_mov_b32 v30, 0x3f803f80
    v_mov_b32 v31, 0x3f803f80
    v_and_b32 v49, 1, v42
    v_lshlrev_b32 v49, 4, v49
    v_mov_b32 v50, 0x3f80
    v_lshlrev_b32 v50, v49, v50
    v_lshrrev_b32 v51, 2, v42
    v_cmp_eq_u32 vcc, v51, v41
    v_mov_b32 v24, v50
    v_cndmask_b32 v52, 0, v50, s[28:29]
    v_cndmask_b32 v53, 0, v50, s[32:33]
    v_cndmask_b32 v16, 0, v52, vcc
    v_cndmask_b32 v17, 0, v53, vcc
    v_mov_b32 v25, v50
    v_mov_b32 v26, v50
    v_mov_b32 v27, v50
    v_bfe_u32 v60, v40, 3, 1
    v_bfe_u32 v49, v40, 2, 1
    v_and_b32 v50, 1, v41
    v_lshrrev_b32 v51, 1, v41
    v_lshlrev_b32 v52, 3, v60
    v_lshl_add_u32 v52, v50, 2, v52
    v_lshl_add_u32 v53, v51, 4, v52
    v_add_u32 v53, v53, v49
    v_and_b32 v54, 3, v40
    s_lshl_b32 s22, s20, 2
    v_add_u32 v55, s22, v54
    v_xor_b32 v55, v55, v52
    v_lshlrev_b32 v55, 4, v55
    v_lshl_add_u32 v46, v53, 8, v55
    v_lshlrev_b32 v55, 4, v52
    v_lshl_add_u32 v55, v54, 3, v55
    v_lshl_add_u32 v47, v53, 8, v55
    s_waitcnt vmcnt(28)
    s_barrier
    v_add_u32 v48, 0, v46
    ds_read_b64_tr_b16 a[0:1], v48 offset:0
    ds_read_b64_tr_b16 a[2:3], v48 offset:512
    ds_read_b64_tr_b16 a[4:5], v48 offset:8192
    ds_read_b64_tr_b16 a[6:7], v48 offset:8704
    ds_read_b64_tr_b16 a[8:9], v48 offset:8
    ds_read_b64_tr_b16 a[10:11], v48 offset:520
    ds_read_b64_tr_b16 a[12:13], v48 offset:8200
    ds_read_b64_tr_b16 a[14:15], v48 offset:8712
    s_waitcnt lgkmcnt(0)
    s_barrier
    s_mov_b32 s8, s52
    s_mov_b32 s9, s53
    s_add_u32 m0, s48, 0
    s_mov_b32 s22, 0
    buffer_load_dwordx4 v44, s[8:11], s22 offen  lds
    s_add_u32 m0, s48, 4096
    s_mov_b32 s22, 32768
    buffer_load_dwordx4 v44, s[8:11], s22 offen  lds
    s_add_u32 m0, s48, 8192
    s_mov_b32 s22, 65536
    buffer_load_dwordx4 v44, s[8:11], s22 offen  lds
    s_add_u32 m0, s48, 12288
    s_mov_b32 s22, 98304
    buffer_load_dwordx4 v44, s[8:11], s22 offen  lds
    s_waitcnt vmcnt(28)
    s_barrier
    v_add_u32 v48, 16384, v46
    ds_read_b64_tr_b16 a[16:17], v48 offset:0
    ds_read_b64_tr_b16 a[18:19], v48 offset:512
    ds_read_b64_tr_b16 a[20:21], v48 offset:8192
    ds_read_b64_tr_b16 a[22:23], v48 offset:8704
    ds_read_b64_tr_b16 a[24:25], v48 offset:8
    ds_read_b64_tr_b16 a[26:27], v48 offset:520
    ds_read_b64_tr_b16 a[28:29], v48 offset:8200
    ds_read_b64_tr_b16 a[30:31], v48 offset:8712
    s_waitcnt lgkmcnt(0)
    s_barrier
    s_add_u32 m0, s48, 16384
    s_mov_b32 s22, 524288
    buffer_load_dwordx4 v44, s[8:11], s22 offen  lds
    s_add_u32 m0, s48, 20480
    s_mov_b32 s22, 557056
    buffer_load_dwordx4 v44, s[8:11], s22 offen  lds
    s_add_u32 m0, s48, 24576
    s_mov_b32 s22, 589824
    buffer_load_dwordx4 v44, s[8:11], s22 offen  lds
    s_add_u32 m0, s48, 28672
    s_mov_b32 s22, 622592
    buffer_load_dwordx4 v44, s[8:11], s22 offen  lds
    s_waitcnt vmcnt(28)
    s_barrier
    v_add_u32 v48, 32768, v46
    ds_read_b64_tr_b16 a[32:33], v48 offset:0
    ds_read_b64_tr_b16 a[34:35], v48 offset:512
    ds_read_b64_tr_b16 a[36:37], v48 offset:8192
    ds_read_b64_tr_b16 a[38:39], v48 offset:8704
    ds_read_b64_tr_b16 a[40:41], v48 offset:8
    ds_read_b64_tr_b16 a[42:43], v48 offset:520
    ds_read_b64_tr_b16 a[44:45], v48 offset:8200
    ds_read_b64_tr_b16 a[46:47], v48 offset:8712
    s_waitcnt lgkmcnt(0)
    s_barrier
    s_add_u32 m0, s48, 32768
    s_mov_b32 s22, 1048576
    buffer_load_dwordx4 v44, s[8:11], s22 offen  lds
    s_add_u32 m0, s48, 36864
    s_mov_b32 s22, 1081344
    buffer_load_dwordx4 v44, s[8:11], s22 offen  lds
    s_add_u32 m0, s48, 40960
    s_mov_b32 s22, 1114112
    buffer_load_dwordx4 v44, s[8:11], s22 offen  lds
    s_add_u32 m0, s48, 45056
    s_mov_b32 s22, 1146880
    buffer_load_dwordx4 v44, s[8:11], s22 offen  lds
    s_waitcnt vmcnt(28)
    s_barrier
    v_add_u32 v48, 49152, v46
    ds_read_b64_tr_b16 a[48:49], v48 offset:0
    ds_read_b64_tr_b16 a[50:51], v48 offset:512
    ds_read_b64_tr_b16 a[52:53], v48 offset:8192
    ds_read_b64_tr_b16 a[54:55], v48 offset:8704
    ds_read_b64_tr_b16 a[56:57], v48 offset:8
    ds_read_b64_tr_b16 a[58:59], v48 offset:520
    ds_read_b64_tr_b16 a[60:61], v48 offset:8200
    ds_read_b64_tr_b16 a[62:63], v48 offset:8712
    s_waitcnt lgkmcnt(0)
    s_barrier
    s_add_u32 m0, s48, 49152
    s_mov_b32 s22, 1572864
    buffer_load_dwordx4 v44, s[8:11], s22 offen  lds
    s_add_u32 m0, s48, 53248
    s_mov_b32 s22, 1605632
    buffer_load_dwordx4 v44, s[8:11], s22 offen  lds
    s_add_u32 m0, s48, 57344
    s_mov_b32 s22, 1638400
    buffer_load_dwordx4 v44, s[8:11], s22 offen  lds
    s_add_u32 m0, s48, 61440
    s_mov_b32 s22, 1671168
    buffer_load_dwordx4 v44, s[8:11], s22 offen  lds
    s_waitcnt vmcnt(28)
    s_barrier
    v_add_u32 v48, 65536, v46
    ds_read_b64_tr_b16 a[64:65], v48 offset:0
    ds_read_b64_tr_b16 a[66:67], v48 offset:512
    ds_read_b64_tr_b16 a[68:69], v48 offset:8192
    ds_read_b64_tr_b16 a[70:71], v48 offset:8704
    ds_read_b64_tr_b16 a[72:73], v48 offset:8
    ds_read_b64_tr_b16 a[74:75], v48 offset:520
    ds_read_b64_tr_b16 a[76:77], v48 offset:8200
    ds_read_b64_tr_b16 a[78:79], v48 offset:8712
    s_waitcnt lgkmcnt(0)
    s_barrier
    s_add_u32 m0, s48, 65536
    s_mov_b32 s22, 2097152
    buffer_load_dwordx4 v44, s[8:11], s22 offen  lds
    s_add_u32 m0, s48, 69632
    s_mov_b32 s22, 2129920
    buffer_load_dwordx4 v44, s[8:11], s22 offen  lds
    s_add_u32 m0, s48, 73728
    s_mov_b32 s22, 2162688
    buffer_load_dwordx4 v44, s[8:11], s22 offen  lds
    s_add_u32 m0, s48, 77824
    s_mov_b32 s22, 2195456
    buffer_load_dwordx4 v44, s[8:11], s22 offen  lds
    s_waitcnt vmcnt(28)
    s_barrier
    v_add_u32 v48, 81920, v46
    ds_read_b64_tr_b16 a[80:81], v48 offset:0
    ds_read_b64_tr_b16 a[82:83], v48 offset:512
    ds_read_b64_tr_b16 a[84:85], v48 offset:8192
    ds_read_b64_tr_b16 a[86:87], v48 offset:8704
    ds_read_b64_tr_b16 a[88:89], v48 offset:8
    ds_read_b64_tr_b16 a[90:91], v48 offset:520
    ds_read_b64_tr_b16 a[92:93], v48 offset:8200
    ds_read_b64_tr_b16 a[94:95], v48 offset:8712
    s_waitcnt lgkmcnt(0)
    s_barrier
    s_add_u32 m0, s48, 81920
    s_mov_b32 s22, 2621440
    buffer_load_dwordx4 v44, s[8:11], s22 offen  lds
    s_add_u32 m0, s48, 86016
    s_mov_b32 s22, 2654208
    buffer_load_dwordx4 v44, s[8:11], s22 offen  lds
    s_add_u32 m0, s48, 90112
    s_mov_b32 s22, 2686976
    buffer_load_dwordx4 v44, s[8:11], s22 offen  lds
    s_add_u32 m0, s48, 94208
    s_mov_b32 s22, 2719744
    buffer_load_dwordx4 v44, s[8:11], s22 offen  lds
    s_waitcnt vmcnt(28)
    s_barrier
    v_add_u32 v48, 98304, v46
    ds_read_b64_tr_b16 a[96:97], v48 offset:0
    ds_read_b64_tr_b16 a[98:99], v48 offset:512
    ds_read_b64_tr_b16 a[100:101], v48 offset:8192
    ds_read_b64_tr_b16 a[102:103], v48 offset:8704
    ds_read_b64_tr_b16 a[104:105], v48 offset:8
    ds_read_b64_tr_b16 a[106:107], v48 offset:520
    ds_read_b64_tr_b16 a[108:109], v48 offset:8200
    ds_read_b64_tr_b16 a[110:111], v48 offset:8712
    s_waitcnt lgkmcnt(0)
    s_barrier
    s_add_u32 m0, s48, 98304
    s_mov_b32 s22, 3145728
    buffer_load_dwordx4 v44, s[8:11], s22 offen  lds
    s_add_u32 m0, s48, 102400
    s_mov_b32 s22, 3178496
    buffer_load_dwordx4 v44, s[8:11], s22 offen  lds
    s_add_u32 m0, s48, 106496
    s_mov_b32 s22, 3211264
    buffer_load_dwordx4 v44, s[8:11], s22 offen  lds
    s_add_u32 m0, s48, 110592
    s_mov_b32 s22, 3244032
    buffer_load_dwordx4 v44, s[8:11], s22 offen  lds
    s_waitcnt vmcnt(28)
    s_barrier
    v_add_u32 v48, 114688, v46
    ds_read_b64_tr_b16 a[112:113], v48 offset:0
    ds_read_b64_tr_b16 a[114:115], v48 offset:512
    ds_read_b64_tr_b16 a[116:117], v48 offset:8192
    ds_read_b64_tr_b16 a[118:119], v48 offset:8704
    ds_read_b64_tr_b16 a[120:121], v48 offset:8
    ds_read_b64_tr_b16 a[122:123], v48 offset:520
    ds_read_b64_tr_b16 a[124:125], v48 offset:8200
    ds_read_b64_tr_b16 a[126:127], v48 offset:8712
    s_waitcnt lgkmcnt(0)
    s_barrier
    s_add_u32 m0, s48, 114688
    s_mov_b32 s22, 3670016
    buffer_load_dwordx4 v44, s[8:11], s22 offen  lds
    s_add_u32 m0, s48, 118784
    s_mov_b32 s22, 3702784
    buffer_load_dwordx4 v44, s[8:11], s22 offen  lds
    s_add_u32 m0, s48, 122880
    s_mov_b32 s22, 3735552
    buffer_load_dwordx4 v44, s[8:11], s22 offen  lds
    s_add_u32 m0, s48, 126976
    s_mov_b32 s22, 3768320
    buffer_load_dwordx4 v44, s[8:11], s22 offen  lds
    s_waitcnt vmcnt(28)
    s_barrier
    v_add_u32 v48, 0, v46
    ds_read_b64_tr_b16 a[128:129], v48 offset:0
    ds_read_b64_tr_b16 a[130:131], v48 offset:512
    ds_read_b64_tr_b16 a[132:133], v48 offset:8192
    ds_read_b64_tr_b16 a[134:135], v48 offset:8704
    ds_read_b64_tr_b16 a[136:137], v48 offset:8
    ds_read_b64_tr_b16 a[138:139], v48 offset:520
    ds_read_b64_tr_b16 a[140:141], v48 offset:8200
    ds_read_b64_tr_b16 a[142:143], v48 offset:8712
    s_waitcnt lgkmcnt(0)
    s_barrier
    s_mov_b32 s8, s56
    s_mov_b32 s9, s57
    s_add_u32 m0, s48, 0
    s_mov_b32 s22, 0
    buffer_load_dwordx4 v45, s[8:11], s22 offen  lds
    s_add_u32 m0, s48, 4096
    s_mov_b32 s22, 16384
    buffer_load_dwordx4 v45, s[8:11], s22 offen  lds
    s_add_u32 m0, s48, 8192
    s_mov_b32 s22, 32768
    buffer_load_dwordx4 v45, s[8:11], s22 offen  lds
    s_add_u32 m0, s48, 12288
    s_mov_b32 s22, 49152
    buffer_load_dwordx4 v45, s[8:11], s22 offen  lds
    s_waitcnt vmcnt(28)
    s_barrier
    v_add_u32 v48, 16384, v46
    ds_read_b64_tr_b16 a[144:145], v48 offset:0
    ds_read_b64_tr_b16 a[146:147], v48 offset:512
    ds_read_b64_tr_b16 a[148:149], v48 offset:8192
    ds_read_b64_tr_b16 a[150:151], v48 offset:8704
    ds_read_b64_tr_b16 a[152:153], v48 offset:8
    ds_read_b64_tr_b16 a[154:155], v48 offset:520
    ds_read_b64_tr_b16 a[156:157], v48 offset:8200
    ds_read_b64_tr_b16 a[158:159], v48 offset:8712
    s_waitcnt lgkmcnt(0)
    s_barrier
    s_add_u32 m0, s48, 16384
    s_mov_b32 s22, 256
    buffer_load_dwordx4 v45, s[8:11], s22 offen  lds
    s_add_u32 m0, s48, 20480
    s_mov_b32 s22, 16640
    buffer_load_dwordx4 v45, s[8:11], s22 offen  lds
    s_add_u32 m0, s48, 24576
    s_mov_b32 s22, 33024
    buffer_load_dwordx4 v45, s[8:11], s22 offen  lds
    s_add_u32 m0, s48, 28672
    s_mov_b32 s22, 49408
    buffer_load_dwordx4 v45, s[8:11], s22 offen  lds
    s_waitcnt vmcnt(28)
    s_barrier
    v_add_u32 v48, 32768, v46
    ds_read_b64_tr_b16 a[160:161], v48 offset:0
    ds_read_b64_tr_b16 a[162:163], v48 offset:512
    ds_read_b64_tr_b16 a[164:165], v48 offset:8192
    ds_read_b64_tr_b16 a[166:167], v48 offset:8704
    ds_read_b64_tr_b16 a[168:169], v48 offset:8
    ds_read_b64_tr_b16 a[170:171], v48 offset:520
    ds_read_b64_tr_b16 a[172:173], v48 offset:8200
    ds_read_b64_tr_b16 a[174:175], v48 offset:8712
    s_waitcnt lgkmcnt(0)
    s_barrier
    s_add_u32 m0, s48, 32768
    s_mov_b32 s22, 512
    buffer_load_dwordx4 v45, s[8:11], s22 offen  lds
    s_add_u32 m0, s48, 36864
    s_mov_b32 s22, 16896
    buffer_load_dwordx4 v45, s[8:11], s22 offen  lds
    s_add_u32 m0, s48, 40960
    s_mov_b32 s22, 33280
    buffer_load_dwordx4 v45, s[8:11], s22 offen  lds
    s_add_u32 m0, s48, 45056
    s_mov_b32 s22, 49664
    buffer_load_dwordx4 v45, s[8:11], s22 offen  lds
    s_waitcnt vmcnt(28)
    s_barrier
    v_add_u32 v48, 49152, v46
    ds_read_b64_tr_b16 a[176:177], v48 offset:0
    ds_read_b64_tr_b16 a[178:179], v48 offset:512
    ds_read_b64_tr_b16 a[180:181], v48 offset:8192
    ds_read_b64_tr_b16 a[182:183], v48 offset:8704
    ds_read_b64_tr_b16 a[184:185], v48 offset:8
    ds_read_b64_tr_b16 a[186:187], v48 offset:520
    ds_read_b64_tr_b16 a[188:189], v48 offset:8200
    ds_read_b64_tr_b16 a[190:191], v48 offset:8712
    s_waitcnt lgkmcnt(0)
    s_barrier
    s_add_u32 m0, s48, 49152
    s_mov_b32 s22, 768
    buffer_load_dwordx4 v45, s[8:11], s22 offen  lds
    s_add_u32 m0, s48, 53248
    s_mov_b32 s22, 17152
    buffer_load_dwordx4 v45, s[8:11], s22 offen  lds
    s_add_u32 m0, s48, 57344
    s_mov_b32 s22, 33536
    buffer_load_dwordx4 v45, s[8:11], s22 offen  lds
    s_add_u32 m0, s48, 61440
    s_mov_b32 s22, 49920
    buffer_load_dwordx4 v45, s[8:11], s22 offen  lds
    s_waitcnt vmcnt(28)
    s_barrier
    v_and_b32 v254, 7, v0
    v_lshlrev_b32 v254, 5, v254
    buffer_load_dword v252, v254, s[88:91], 0 offen sc1
    buffer_load_dword v58, off, s[12:15], 0 offset:204 sc1
    v_add_u32 v48, 65536, v46
    ds_read_b64_tr_b16 a[192:193], v48 offset:0
    ds_read_b64_tr_b16 a[194:195], v48 offset:512
    ds_read_b64_tr_b16 a[196:197], v48 offset:8192
    ds_read_b64_tr_b16 a[198:199], v48 offset:8704
    ds_read_b64_tr_b16 a[200:201], v48 offset:8
    ds_read_b64_tr_b16 a[202:203], v48 offset:520
    ds_read_b64_tr_b16 a[204:205], v48 offset:8200
    ds_read_b64_tr_b16 a[206:207], v48 offset:8712
    s_waitcnt lgkmcnt(0)
    s_barrier
    s_add_u32 m0, s48, 65536
    s_mov_b32 s22, 131072
    buffer_load_dwordx4 v45, s[8:11], s22 offen  lds
    s_add_u32 m0, s48, 69632
    s_mov_b32 s22, 147456
    buffer_load_dwordx4 v45, s[8:11], s22 offen  lds
    s_add_u32 m0, s48, 73728
    s_mov_b32 s22, 163840
    buffer_load_dwordx4 v45, s[8:11], s22 offen  lds
    s_add_u32 m0, s48, 77824
    s_mov_b32 s22, 180224
    buffer_load_dwordx4 v45, s[8:11], s22 offen  lds
    s_waitcnt vmcnt(28)
    s_barrier
    v_add_u32 v48, 81920, v46
    ds_read_b64_tr_b16 a[208:209], v48 offset:0
    ds_read_b64_tr_b16 a[210:211], v48 offset:512
    ds_read_b64_tr_b16 a[212:213], v48 offset:8192
    ds_read_b64_tr_b16 a[214:215], v48 offset:8704
    ds_read_b64_tr_b16 a[216:217], v48 offset:8
    ds_read_b64_tr_b16 a[218:219], v48 offset:520
    ds_read_b64_tr_b16 a[220:221], v48 offset:8200
    ds_read_b64_tr_b16 a[222:223], v48 offset:8712
    s_waitcnt lgkmcnt(0)
    s_barrier
    s_add_u32 m0, s48, 81920
    s_mov_b32 s22, 131328
    buffer_load_dwordx4 v45, s[8:11], s22 offen  lds
    s_add_u32 m0, s48, 86016
    s_mov_b32 s22, 147712
    buffer_load_dwordx4 v45, s[8:11], s22 offen  lds
    s_add_u32 m0, s48, 90112
    s_mov_b32 s22, 164096
    buffer_load_dwordx4 v45, s[8:11], s22 offen  lds
    s_add_u32 m0, s48, 94208
    s_mov_b32 s22, 180480
    buffer_load_dwordx4 v45, s[8:11], s22 offen  lds
    s_waitcnt vmcnt(28)
    s_barrier
    v_add_u32 v48, 98304, v46
    ds_read_b64_tr_b16 a[224:225], v48 offset:0
    ds_read_b64_tr_b16 a[226:227], v48 offset:512
    ds_read_b64_tr_b16 a[228:229], v48 offset:8192
    ds_read_b64_tr_b16 a[230:231], v48 offset:8704
    ds_read_b64_tr_b16 a[232:233], v48 offset:8
    ds_read_b64_tr_b16 a[234:235], v48 offset:520
    ds_read_b64_tr_b16 a[236:237], v48 offset:8200
    ds_read_b64_tr_b16 a[238:239], v48 offset:8712
    s_waitcnt lgkmcnt(0)
    s_barrier
    s_add_u32 m0, s48, 98304
    s_mov_b32 s22, 131584
    buffer_load_dwordx4 v45, s[8:11], s22 offen  lds
    s_add_u32 m0, s48, 102400
    s_mov_b32 s22, 147968
    buffer_load_dwordx4 v45, s[8:11], s22 offen  lds
    s_add_u32 m0, s48, 106496
    s_mov_b32 s22, 164352
    buffer_load_dwordx4 v45, s[8:11], s22 offen  lds
    s_add_u32 m0, s48, 110592
    s_mov_b32 s22, 180736
    buffer_load_dwordx4 v45, s[8:11], s22 offen  lds
    s_waitcnt vmcnt(28)
    s_barrier
    v_add_u32 v48, 114688, v46
    ds_read_b64_tr_b16 a[240:241], v48 offset:0
    ds_read_b64_tr_b16 a[242:243], v48 offset:512
    ds_read_b64_tr_b16 a[244:245], v48 offset:8192
    ds_read_b64_tr_b16 a[246:247], v48 offset:8704
    ds_read_b64_tr_b16 a[248:249], v48 offset:8
    ds_read_b64_tr_b16 a[250:251], v48 offset:520
    ds_read_b64_tr_b16 a[252:253], v48 offset:8200
    ds_read_b64_tr_b16 a[254:255], v48 offset:8712
    s_waitcnt lgkmcnt(0)
    s_barrier
    s_add_u32 m0, s48, 114688
    s_mov_b32 s22, 131840
    buffer_load_dwordx4 v45, s[8:11], s22 offen  lds
    s_add_u32 m0, s48, 118784
    s_mov_b32 s22, 148224
    buffer_load_dwordx4 v45, s[8:11], s22 offen  lds
    s_add_u32 m0, s48, 122880
    s_mov_b32 s22, 164608
    buffer_load_dwordx4 v45, s[8:11], s22 offen  lds
    s_add_u32 m0, s48, 126976
    s_mov_b32 s22, 180992
    buffer_load_dwordx4 v45, s[8:11], s22 offen  lds
    s_waitcnt vmcnt(28)
    s_barrier
    s_cmp_lg_u32 s20, 0
    s_cbranch_scc1 mega_kernel_rf_wo0
    v_xor_b32 v48, 0, v47
    v_add_u32 v48, 0, v48
    ds_read_b64_tr_b16 v[128:129], v48 offset:0
    ds_read_b64_tr_b16 v[130:131], v48 offset:512
    ds_read_b64_tr_b16 v[132:133], v48 offset:8192
    ds_read_b64_tr_b16 v[134:135], v48 offset:8704
    ds_read_b64_tr_b16 v[136:137], v48 offset:32
    ds_read_b64_tr_b16 v[138:139], v48 offset:544
    ds_read_b64_tr_b16 v[140:141], v48 offset:8224
    ds_read_b64_tr_b16 v[142:143], v48 offset:8736
    s_waitcnt lgkmcnt(0)
    v_xor_b32 v48, 64, v47
    v_add_u32 v48, 0, v48
    ds_read_b64_tr_b16 v[144:145], v48 offset:0
    ds_read_b64_tr_b16 v[146:147], v48 offset:512
    ds_read_b64_tr_b16 v[148:149], v48 offset:8192
    ds_read_b64_tr_b16 v[150:151], v48 offset:8704
    ds_read_b64_tr_b16 v[152:153], v48 offset:32
    ds_read_b64_tr_b16 v[154:155], v48 offset:544
    ds_read_b64_tr_b16 v[156:157], v48 offset:8224
    ds_read_b64_tr_b16 v[158:159], v48 offset:8736
    s_waitcnt lgkmcnt(0)
    v_xor_b32 v48, 128, v47
    v_add_u32 v48, 0, v48
    ds_read_b64_tr_b16 v[192:193], v48 offset:0
    ds_read_b64_tr_b16 v[194:195], v48 offset:512
    ds_read_b64_tr_b16 v[196:197], v48 offset:8192
    ds_read_b64_tr_b16 v[198:199], v48 offset:8704
    ds_read_b64_tr_b16 v[200:201], v48 offset:32
    ds_read_b64_tr_b16 v[202:203], v48 offset:544
    ds_read_b64_tr_b16 v[204:205], v48 offset:8224
    ds_read_b64_tr_b16 v[206:207], v48 offset:8736
    s_waitcnt lgkmcnt(0)
    v_xor_b32 v48, 192, v47
    v_add_u32 v48, 0, v48
    ds_read_b64_tr_b16 v[80:81], v48 offset:0
    ds_read_b64_tr_b16 v[82:83], v48 offset:512
    ds_read_b64_tr_b16 v[84:85], v48 offset:8192
    ds_read_b64_tr_b16 v[86:87], v48 offset:8704
    ds_read_b64_tr_b16 v[88:89], v48 offset:32
    ds_read_b64_tr_b16 v[90:91], v48 offset:544
    ds_read_b64_tr_b16 v[92:93], v48 offset:8224
    ds_read_b64_tr_b16 v[94:95], v48 offset:8736
    s_waitcnt lgkmcnt(0)
mega_kernel_rf_wo0:
    s_barrier
    s_mov_b32 s8, s54
    s_mov_b32 s9, s55
    s_add_u32 m0, s48, 0
    s_mov_b32 s22, 0
    buffer_load_dwordx4 v44, s[8:11], s22 offen  lds
    s_add_u32 m0, s48, 4096
    s_mov_b32 s22, 32768
    buffer_load_dwordx4 v44, s[8:11], s22 offen  lds
    s_add_u32 m0, s48, 8192
    s_mov_b32 s22, 65536
    buffer_load_dwordx4 v44, s[8:11], s22 offen  lds
    s_add_u32 m0, s48, 12288
    s_mov_b32 s22, 98304
    buffer_load_dwordx4 v44, s[8:11], s22 offen  lds
    s_waitcnt vmcnt(28)
    s_barrier
    s_cmp_lg_u32 s20, 1
    s_cbranch_scc1 mega_kernel_rf_wo1
    v_xor_b32 v48, 0, v47
    v_add_u32 v48, 16384, v48
    ds_read_b64_tr_b16 v[128:129], v48 offset:0
    ds_read_b64_tr_b16 v[130:131], v48 offset:512
    ds_read_b64_tr_b16 v[132:133], v48 offset:8192
    ds_read_b64_tr_b16 v[134:135], v48 offset:8704
    ds_read_b64_tr_b16 v[136:137], v48 offset:32
    ds_read_b64_tr_b16 v[138:139], v48 offset:544
    ds_read_b64_tr_b16 v[140:141], v48 offset:8224
    ds_read_b64_tr_b16 v[142:143], v48 offset:8736
    s_waitcnt lgkmcnt(0)
    v_xor_b32 v48, 64, v47
    v_add_u32 v48, 16384, v48
    ds_read_b64_tr_b16 v[144:145], v48 offset:0
    ds_read_b64_tr_b16 v[146:147], v48 offset:512
    ds_read_b64_tr_b16 v[148:149], v48 offset:8192
    ds_read_b64_tr_b16 v[150:151], v48 offset:8704
    ds_read_b64_tr_b16 v[152:153], v48 offset:32
    ds_read_b64_tr_b16 v[154:155], v48 offset:544
    ds_read_b64_tr_b16 v[156:157], v48 offset:8224
    ds_read_b64_tr_b16 v[158:159], v48 offset:8736
    s_waitcnt lgkmcnt(0)
    v_xor_b32 v48, 128, v47
    v_add_u32 v48, 16384, v48
    ds_read_b64_tr_b16 v[192:193], v48 offset:0
    ds_read_b64_tr_b16 v[194:195], v48 offset:512
    ds_read_b64_tr_b16 v[196:197], v48 offset:8192
    ds_read_b64_tr_b16 v[198:199], v48 offset:8704
    ds_read_b64_tr_b16 v[200:201], v48 offset:32
    ds_read_b64_tr_b16 v[202:203], v48 offset:544
    ds_read_b64_tr_b16 v[204:205], v48 offset:8224
    ds_read_b64_tr_b16 v[206:207], v48 offset:8736
    s_waitcnt lgkmcnt(0)
    v_xor_b32 v48, 192, v47
    v_add_u32 v48, 16384, v48
    ds_read_b64_tr_b16 v[80:81], v48 offset:0
    ds_read_b64_tr_b16 v[82:83], v48 offset:512
    ds_read_b64_tr_b16 v[84:85], v48 offset:8192
    ds_read_b64_tr_b16 v[86:87], v48 offset:8704
    ds_read_b64_tr_b16 v[88:89], v48 offset:32
    ds_read_b64_tr_b16 v[90:91], v48 offset:544
    ds_read_b64_tr_b16 v[92:93], v48 offset:8224
    ds_read_b64_tr_b16 v[94:95], v48 offset:8736
    s_waitcnt lgkmcnt(0)
mega_kernel_rf_wo1:
    s_barrier
    s_add_u32 m0, s48, 16384
    s_mov_b32 s22, 524288
    buffer_load_dwordx4 v44, s[8:11], s22 offen  lds
    s_add_u32 m0, s48, 20480
    s_mov_b32 s22, 557056
    buffer_load_dwordx4 v44, s[8:11], s22 offen  lds
    s_add_u32 m0, s48, 24576
    s_mov_b32 s22, 589824
    buffer_load_dwordx4 v44, s[8:11], s22 offen  lds
    s_add_u32 m0, s48, 28672
    s_mov_b32 s22, 622592
    buffer_load_dwordx4 v44, s[8:11], s22 offen  lds
    s_waitcnt vmcnt(28)
    s_barrier
    s_cmp_lg_u32 s20, 2
    s_cbranch_scc1 mega_kernel_rf_wo2
    v_xor_b32 v48, 0, v47
    v_add_u32 v48, 32768, v48
    ds_read_b64_tr_b16 v[128:129], v48 offset:0
    ds_read_b64_tr_b16 v[130:131], v48 offset:512
    ds_read_b64_tr_b16 v[132:133], v48 offset:8192
    ds_read_b64_tr_b16 v[134:135], v48 offset:8704
    ds_read_b64_tr_b16 v[136:137], v48 offset:32
    ds_read_b64_tr_b16 v[138:139], v48 offset:544
    ds_read_b64_tr_b16 v[140:141], v48 offset:8224
    ds_read_b64_tr_b16 v[142:143], v48 offset:8736
    s_waitcnt lgkmcnt(0)
    v_xor_b32 v48, 64, v47
    v_add_u32 v48, 32768, v48
    ds_read_b64_tr_b16 v[144:145], v48 offset:0
    ds_read_b64_tr_b16 v[146:147], v48 offset:512
    ds_read_b64_tr_b16 v[148:149], v48 offset:8192
    ds_read_b64_tr_b16 v[150:151], v48 offset:8704
    ds_read_b64_tr_b16 v[152:153], v48 offset:32
    ds_read_b64_tr_b16 v[154:155], v48 offset:544
    ds_read_b64_tr_b16 v[156:157], v48 offset:8224
    ds_read_b64_tr_b16 v[158:159], v48 offset:8736
    s_waitcnt lgkmcnt(0)
    v_xor_b32 v48, 128, v47
    v_add_u32 v48, 32768, v48
    ds_read_b64_tr_b16 v[192:193], v48 offset:0
    ds_read_b64_tr_b16 v[194:195], v48 offset:512
    ds_read_b64_tr_b16 v[196:197], v48 offset:8192
    ds_read_b64_tr_b16 v[198:199], v48 offset:8704
    ds_read_b64_tr_b16 v[200:201], v48 offset:32
    ds_read_b64_tr_b16 v[202:203], v48 offset:544
    ds_read_b64_tr_b16 v[204:205], v48 offset:8224
    ds_read_b64_tr_b16 v[206:207], v48 offset:8736
    s_waitcnt lgkmcnt(0)
    v_xor_b32 v48, 192, v47
    v_add_u32 v48, 32768, v48
    ds_read_b64_tr_b16 v[80:81], v48 offset:0
    ds_read_b64_tr_b16 v[82:83], v48 offset:512
    ds_read_b64_tr_b16 v[84:85], v48 offset:8192
    ds_read_b64_tr_b16 v[86:87], v48 offset:8704
    ds_read_b64_tr_b16 v[88:89], v48 offset:32
    ds_read_b64_tr_b16 v[90:91], v48 offset:544
    ds_read_b64_tr_b16 v[92:93], v48 offset:8224
    ds_read_b64_tr_b16 v[94:95], v48 offset:8736
    s_waitcnt lgkmcnt(0)
mega_kernel_rf_wo2:
    s_barrier
    s_add_u32 m0, s48, 32768
    s_mov_b32 s22, 1048576
    buffer_load_dwordx4 v44, s[8:11], s22 offen  lds
    s_add_u32 m0, s48, 36864
    s_mov_b32 s22, 1081344
    buffer_load_dwordx4 v44, s[8:11], s22 offen  lds
    s_add_u32 m0, s48, 40960
    s_mov_b32 s22, 1114112
    buffer_load_dwordx4 v44, s[8:11], s22 offen  lds
    s_add_u32 m0, s48, 45056
    s_mov_b32 s22, 1146880
    buffer_load_dwordx4 v44, s[8:11], s22 offen  lds
    s_waitcnt vmcnt(28)
    s_barrier
    s_cmp_lg_u32 s20, 3
    s_cbranch_scc1 mega_kernel_rf_wo3
    v_xor_b32 v48, 0, v47
    v_add_u32 v48, 49152, v48
    ds_read_b64_tr_b16 v[128:129], v48 offset:0
    ds_read_b64_tr_b16 v[130:131], v48 offset:512
    ds_read_b64_tr_b16 v[132:133], v48 offset:8192
    ds_read_b64_tr_b16 v[134:135], v48 offset:8704
    ds_read_b64_tr_b16 v[136:137], v48 offset:32
    ds_read_b64_tr_b16 v[138:139], v48 offset:544
    ds_read_b64_tr_b16 v[140:141], v48 offset:8224
    ds_read_b64_tr_b16 v[142:143], v48 offset:8736
    s_waitcnt lgkmcnt(0)
    v_xor_b32 v48, 64, v47
    v_add_u32 v48, 49152, v48
    ds_read_b64_tr_b16 v[144:145], v48 offset:0
    ds_read_b64_tr_b16 v[146:147], v48 offset:512
    ds_read_b64_tr_b16 v[148:149], v48 offset:8192
    ds_read_b64_tr_b16 v[150:151], v48 offset:8704
    ds_read_b64_tr_b16 v[152:153], v48 offset:32
    ds_read_b64_tr_b16 v[154:155], v48 offset:544
    ds_read_b64_tr_b16 v[156:157], v48 offset:8224
    ds_read_b64_tr_b16 v[158:159], v48 offset:8736
    s_waitcnt lgkmcnt(0)
    v_xor_b32 v48, 128, v47
    v_add_u32 v48, 49152, v48
    ds_read_b64_tr_b16 v[192:193], v48 offset:0
    ds_read_b64_tr_b16 v[194:195], v48 offset:512
    ds_read_b64_tr_b16 v[196:197], v48 offset:8192
    ds_read_b64_tr_b16 v[198:199], v48 offset:8704
    ds_read_b64_tr_b16 v[200:201], v48 offset:32
    ds_read_b64_tr_b16 v[202:203], v48 offset:544
    ds_read_b64_tr_b16 v[204:205], v48 offset:8224
    ds_read_b64_tr_b16 v[206:207], v48 offset:8736
    s_waitcnt lgkmcnt(0)
    v_xor_b32 v48, 192, v47
    v_add_u32 v48, 49152, v48
    ds_read_b64_tr_b16 v[80:81], v48 offset:0
    ds_read_b64_tr_b16 v[82:83], v48 offset:512
    ds_read_b64_tr_b16 v[84:85], v48 offset:8192
    ds_read_b64_tr_b16 v[86:87], v48 offset:8704
    ds_read_b64_tr_b16 v[88:89], v48 offset:32
    ds_read_b64_tr_b16 v[90:91], v48 offset:544
    ds_read_b64_tr_b16 v[92:93], v48 offset:8224
    ds_read_b64_tr_b16 v[94:95], v48 offset:8736
    s_waitcnt lgkmcnt(0)
mega_kernel_rf_wo3:
    s_barrier
    s_add_u32 m0, s48, 49152
    s_mov_b32 s22, 1572864
    buffer_load_dwordx4 v44, s[8:11], s22 offen  lds
    s_add_u32 m0, s48, 53248
    s_mov_b32 s22, 1605632
    buffer_load_dwordx4 v44, s[8:11], s22 offen  lds
    s_add_u32 m0, s48, 57344
    s_mov_b32 s22, 1638400
    buffer_load_dwordx4 v44, s[8:11], s22 offen  lds
    s_add_u32 m0, s48, 61440
    s_mov_b32 s22, 1671168
    buffer_load_dwordx4 v44, s[8:11], s22 offen  lds
    s_waitcnt vmcnt(28)
    s_barrier
    s_cmp_lg_u32 s20, 0
    s_cbranch_scc1 mega_kernel_rf_wo4
    v_xor_b32 v48, 0, v47
    v_add_u32 v48, 65536, v48
    ds_read_b64_tr_b16 v[160:161], v48 offset:0
    ds_read_b64_tr_b16 v[162:163], v48 offset:512
    ds_read_b64_tr_b16 v[164:165], v48 offset:8192
    ds_read_b64_tr_b16 v[166:167], v48 offset:8704
    ds_read_b64_tr_b16 v[168:169], v48 offset:32
    ds_read_b64_tr_b16 v[170:171], v48 offset:544
    ds_read_b64_tr_b16 v[172:173], v48 offset:8224
    ds_read_b64_tr_b16 v[174:175], v48 offset:8736
    s_waitcnt lgkmcnt(0)
    v_xor_b32 v48, 64, v47
    v_add_u32 v48, 65536, v48
    ds_read_b64_tr_b16 v[176:177], v48 offset:0
    ds_read_b64_tr_b16 v[178:179], v48 offset:512
    ds_read_b64_tr_b16 v[180:181], v48 offset:8192
    ds_read_b64_tr_b16 v[182:183], v48 offset:8704
    ds_read_b64_tr_b16 v[184:185], v48 offset:32
    ds_read_b64_tr_b16 v[186:187], v48 offset:544
    ds_read_b64_tr_b16 v[188:189], v48 offset:8224
    ds_read_b64_tr_b16 v[190:191], v48 offset:8736
    s_waitcnt lgkmcnt(0)
    v_xor_b32 v48, 128, v47
    v_add_u32 v48, 65536, v48
    ds_read_b64_tr_b16 v[96:97], v48 offset:0
    ds_read_b64_tr_b16 v[98:99], v48 offset:512
    ds_read_b64_tr_b16 v[100:101], v48 offset:8192
    ds_read_b64_tr_b16 v[102:103], v48 offset:8704
    ds_read_b64_tr_b16 v[104:105], v48 offset:32
    ds_read_b64_tr_b16 v[106:107], v48 offset:544
    ds_read_b64_tr_b16 v[108:109], v48 offset:8224
    ds_read_b64_tr_b16 v[110:111], v48 offset:8736
    s_waitcnt lgkmcnt(0)
    v_xor_b32 v48, 192, v47
    v_add_u32 v48, 65536, v48
    ds_read_b64_tr_b16 v[112:113], v48 offset:0
    ds_read_b64_tr_b16 v[114:115], v48 offset:512
    ds_read_b64_tr_b16 v[116:117], v48 offset:8192
    ds_read_b64_tr_b16 v[118:119], v48 offset:8704
    ds_read_b64_tr_b16 v[120:121], v48 offset:32
    ds_read_b64_tr_b16 v[122:123], v48 offset:544
    ds_read_b64_tr_b16 v[124:125], v48 offset:8224
    ds_read_b64_tr_b16 v[126:127], v48 offset:8736
    s_waitcnt lgkmcnt(0)
mega_kernel_rf_wo4:
    s_barrier
    s_add_u32 m0, s48, 65536
    s_mov_b32 s22, 2097152
    buffer_load_dwordx4 v44, s[8:11], s22 offen  lds
    s_add_u32 m0, s48, 69632
    s_mov_b32 s22, 2129920
    buffer_load_dwordx4 v44, s[8:11], s22 offen  lds
    s_add_u32 m0, s48, 73728
    s_mov_b32 s22, 2162688
    buffer_load_dwordx4 v44, s[8:11], s22 offen  lds
    s_add_u32 m0, s48, 77824
    s_mov_b32 s22, 2195456
    buffer_load_dwordx4 v44, s[8:11], s22 offen  lds
    s_waitcnt vmcnt(28)
    s_barrier
    s_cmp_lg_u32 s20, 1
    s_cbranch_scc1 mega_kernel_rf_wo5
    v_xor_b32 v48, 0, v47
    v_add_u32 v48, 81920, v48
    ds_read_b64_tr_b16 v[160:161], v48 offset:0
    ds_read_b64_tr_b16 v[162:163], v48 offset:512
    ds_read_b64_tr_b16 v[164:165], v48 offset:8192
    ds_read_b64_tr_b16 v[166:167], v48 offset:8704
    ds_read_b64_tr_b16 v[168:169], v48 offset:32
    ds_read_b64_tr_b16 v[170:171], v48 offset:544
    ds_read_b64_tr_b16 v[172:173], v48 offset:8224
    ds_read_b64_tr_b16 v[174:175], v48 offset:8736
    s_waitcnt lgkmcnt(0)
    v_xor_b32 v48, 64, v47
    v_add_u32 v48, 81920, v48
    ds_read_b64_tr_b16 v[176:177], v48 offset:0
    ds_read_b64_tr_b16 v[178:179], v48 offset:512
    ds_read_b64_tr_b16 v[180:181], v48 offset:8192
    ds_read_b64_tr_b16 v[182:183], v48 offset:8704
    ds_read_b64_tr_b16 v[184:185], v48 offset:32
    ds_read_b64_tr_b16 v[186:187], v48 offset:544
    ds_read_b64_tr_b16 v[188:189], v48 offset:8224
    ds_read_b64_tr_b16 v[190:191], v48 offset:8736
    s_waitcnt lgkmcnt(0)
    v_xor_b32 v48, 128, v47
    v_add_u32 v48, 81920, v48
    ds_read_b64_tr_b16 v[96:97], v48 offset:0
    ds_read_b64_tr_b16 v[98:99], v48 offset:512
    ds_read_b64_tr_b16 v[100:101], v48 offset:8192
    ds_read_b64_tr_b16 v[102:103], v48 offset:8704
    ds_read_b64_tr_b16 v[104:105], v48 offset:32
    ds_read_b64_tr_b16 v[106:107], v48 offset:544
    ds_read_b64_tr_b16 v[108:109], v48 offset:8224
    ds_read_b64_tr_b16 v[110:111], v48 offset:8736
    s_waitcnt lgkmcnt(0)
    v_xor_b32 v48, 192, v47
    v_add_u32 v48, 81920, v48
    ds_read_b64_tr_b16 v[112:113], v48 offset:0
    ds_read_b64_tr_b16 v[114:115], v48 offset:512
    ds_read_b64_tr_b16 v[116:117], v48 offset:8192
    ds_read_b64_tr_b16 v[118:119], v48 offset:8704
    ds_read_b64_tr_b16 v[120:121], v48 offset:32
    ds_read_b64_tr_b16 v[122:123], v48 offset:544
    ds_read_b64_tr_b16 v[124:125], v48 offset:8224
    ds_read_b64_tr_b16 v[126:127], v48 offset:8736
    s_waitcnt lgkmcnt(0)
mega_kernel_rf_wo5:
    s_barrier
    s_add_u32 m0, s48, 81920
    s_mov_b32 s22, 2621440
    buffer_load_dwordx4 v44, s[8:11], s22 offen  lds
    s_add_u32 m0, s48, 86016
    s_mov_b32 s22, 2654208
    buffer_load_dwordx4 v44, s[8:11], s22 offen  lds
    s_add_u32 m0, s48, 90112
    s_mov_b32 s22, 2686976
    buffer_load_dwordx4 v44, s[8:11], s22 offen  lds
    s_add_u32 m0, s48, 94208
    s_mov_b32 s22, 2719744
    buffer_load_dwordx4 v44, s[8:11], s22 offen  lds
    s_waitcnt vmcnt(28)
    s_barrier
    s_cmp_lg_u32 s97, 0
    s_cbranch_scc1 mega_kernel_h2_2_ok
mega_kernel_h2_2_ev:
    v_cmp_ne_u32 vcc, 32, v252
    s_cbranch_vccz mega_kernel_h2_2_ok
    s_mov_b32 s78, 0
    v_readlane_b32 s81, v252, 0
    s_nop 3
    s_add_u32 s78, s78, s81
    v_readlane_b32 s81, v252, 1
    s_nop 3
    s_add_u32 s78, s78, s81
    v_readlane_b32 s81, v252, 2
    s_nop 3
    s_add_u32 s78, s78, s81
    v_readlane_b32 s81, v252, 3
    s_nop 3
    s_add_u32 s78, s78, s81
    v_readlane_b32 s81, v252, 4
    s_nop 3
    s_add_u32 s78, s78, s81
    v_readlane_b32 s81, v252, 5
    s_nop 3
    s_add_u32 s78, s78, s81
    v_readlane_b32 s81, v252, 6
    s_nop 3
    s_add_u32 s78, s78, s81
    v_readlane_b32 s81, v252, 7
    s_nop 3
    s_add_u32 s78, s78, s81
    s_cmp_eq_u32 s78, 256
    s_cbranch_scc1 mega_kernel_redo
    buffer_load_dword v252, v254, s[88:91], 0 offen sc1
    s_waitcnt vmcnt(0)
    s_branch mega_kernel_h2_2_ev
mega_kernel_h2_2_ok:
    s_cmp_lg_u32 s20, 2
    s_cbranch_scc1 mega_kernel_rf_wo6
    v_xor_b32 v48, 0, v47
    v_add_u32 v48, 98304, v48
    ds_read_b64_tr_b16 v[160:161], v48 offset:0
    ds_read_b64_tr_b16 v[162:163], v48 offset:512
    ds_read_b64_tr_b16 v[164:165], v48 offset:8192
    ds_read_b64_tr_b16 v[166:167], v48 offset:8704
    ds_read_b64_tr_b16 v[168:169], v48 offset:32
    ds_read_b64_tr_b16 v[170:171], v48 offset:544
    ds_read_b64_tr_b16 v[172:173], v48 offset:8224
    ds_read_b64_tr_b16 v[174:175], v48 offset:8736
    s_waitcnt lgkmcnt(0)
    v_xor_b32 v48, 64, v47
    v_add_u32 v48, 98304, v48
    ds_read_b64_tr_b16 v[176:177], v48 offset:0
    ds_read_b64_tr_b16 v[178:179], v48 offset:512
    ds_read_b64_tr_b16 v[180:181], v48 offset:8192
    ds_read_b64_tr_b16 v[182:183], v48 offset:8704
    ds_read_b64_tr_b16 v[184:185], v48 offset:32
    ds_read_b64_tr_b16 v[186:187], v48 offset:544
    ds_read_b64_tr_b16 v[188:189], v48 offset:8224
    ds_read_b64_tr_b16 v[190:191], v48 offset:8736
    s_waitcnt lgkmcnt(0)
    v_xor_b32 v48, 128, v47
    v_add_u32 v48, 98304, v48
    ds_read_b64_tr_b16 v[96:97], v48 offset:0
    ds_read_b64_tr_b16 v[98:99], v48 offset:512
    ds_read_b64_tr_b16 v[100:101], v48 offset:8192
    ds_read_b64_tr_b16 v[102:103], v48 offset:8704
    ds_read_b64_tr_b16 v[104:105], v48 offset:32
    ds_read_b64_tr_b16 v[106:107], v48 offset:544
    ds_read_b64_tr_b16 v[108:109], v48 offset:8224
    ds_read_b64_tr_b16 v[110:111], v48 offset:8736
    s_waitcnt lgkmcnt(0)
    v_xor_b32 v48, 192, v47
    v_add_u32 v48, 98304, v48
    ds_read_b64_tr_b16 v[112:113], v48 offset:0
    ds_read_b64_tr_b16 v[114:115], v48 offset:512
    ds_read_b64_tr_b16 v[116:117], v48 offset:8192
    ds_read_b64_tr_b16 v[118:119], v48 offset:8704
    ds_read_b64_tr_b16 v[120:121], v48 offset:32
    ds_read_b64_tr_b16 v[122:123], v48 offset:544
    ds_read_b64_tr_b16 v[124:125], v48 offset:8224
    ds_read_b64_tr_b16 v[126:127], v48 offset:8736
    s_waitcnt lgkmcnt(0)
mega_kernel_rf_wo6:
    s_barrier
    s_add_u32 m0, s48, 98304
    s_mov_b32 s22, 3145728
    buffer_load_dwordx4 v44, s[8:11], s22 offen  lds
    s_add_u32 m0, s48, 102400
    s_mov_b32 s22, 3178496
    buffer_load_dwordx4 v44, s[8:11], s22 offen  lds
    s_add_u32 m0, s48, 106496
    s_mov_b32 s22, 3211264
    buffer_load_dwordx4 v44, s[8:11], s22 offen  lds
    s_add_u32 m0, s48, 110592
    s_mov_b32 s22, 3244032
    buffer_load_dwordx4 v44, s[8:11], s22 offen  lds
    s_waitcnt vmcnt(28)
    s_barrier
    s_cmp_lg_u32 s20, 3
    s_cbranch_scc1 mega_kernel_rf_wo7
    v_xor_b32 v48, 0, v47
    v_add_u32 v48, 114688, v48
    ds_read_b64_tr_b16 v[160:161], v48 offset:0
    ds_read_b64_tr_b16 v[162:163], v48 offset:512
    ds_read_b64_tr_b16 v[164:165], v48 offset:8192
    ds_read_b64_tr_b16 v[166:167], v48 offset:8704
    ds_read_b64_tr_b16 v[168:169], v48 offset:32
    ds_read_b64_tr_b16 v[170:171], v48 offset:544
    ds_read_b64_tr_b16 v[172:173], v48 offset:8224
    ds_read_b64_tr_b16 v[174:175], v48 offset:8736
    s_waitcnt lgkmcnt(0)
    v_xor_b32 v48, 64, v47
    v_add_u32 v48, 114688, v48
    ds_read_b64_tr_b16 v[176:177], v48 offset:0
    ds_read_b64_tr_b16 v[178:179], v48 offset:512
    ds_read_b64_tr_b16 v[180:181], v48 offset:8192
    ds_read_b64_tr_b16 v[182:183], v48 offset:8704
    ds_read_b64_tr_b16 v[184:185], v48 offset:32
    ds_read_b64_tr_b16 v[186:187], v48 offset:544
    ds_read_b64_tr_b16 v[188:189], v48 offset:8224
    ds_read_b64_tr_b16 v[190:191], v48 offset:8736
    s_waitcnt lgkmcnt(0)
    v_xor_b32 v48, 128, v47
    v_add_u32 v48, 114688, v48
    ds_read_b64_tr_b16 v[96:97], v48 offset:0
    ds_read_b64_tr_b16 v[98:99], v48 offset:512
    ds_read_b64_tr_b16 v[100:101], v48 offset:8192
    ds_read_b64_tr_b16 v[102:103], v48 offset:8704
    ds_read_b64_tr_b16 v[104:105], v48 offset:32
    ds_read_b64_tr_b16 v[106:107], v48 offset:544
    ds_read_b64_tr_b16 v[108:109], v48 offset:8224
    ds_read_b64_tr_b16 v[110:111], v48 offset:8736
    s_waitcnt lgkmcnt(0)
    v_xor_b32 v48, 192, v47
    v_add_u32 v48, 114688, v48
    ds_read_b64_tr_b16 v[112:113], v48 offset:0
    ds_read_b64_tr_b16 v[114:115], v48 offset:512
    ds_read_b64_tr_b16 v[116:117], v48 offset:8192
    ds_read_b64_tr_b16 v[118:119], v48 offset:8704
    ds_read_b64_tr_b16 v[120:121], v48 offset:32
    ds_read_b64_tr_b16 v[122:123], v48 offset:544
    ds_read_b64_tr_b16 v[124:125], v48 offset:8224
    ds_read_b64_tr_b16 v[126:127], v48 offset:8736
    s_waitcnt lgkmcnt(0)
mega_kernel_rf_wo7:
    s_barrier
    s_add_u32 m0, s48, 114688
    s_mov_b32 s22, 3670016
    buffer_load_dwordx4 v44, s[8:11], s22 offen  lds
    s_add_u32 m0, s48, 118784
    s_mov_b32 s22, 3702784
    buffer_load_dwordx4 v44, s[8:11], s22 offen  lds
    s_add_u32 m0, s48, 122880
    s_mov_b32 s22, 3735552
    buffer_load_dwordx4 v44, s[8:11], s22 offen  lds
    s_add_u32 m0, s48, 126976
    s_mov_b32 s22, 3768320
    buffer_load_dwordx4 v44, s[8:11], s22 offen  lds
    s_waitcnt vmcnt(28)
    s_barrier
    v_add_u32 v48, 0, v46
    ds_read_b64_tr_b16 v[64:65], v48 offset:0
    ds_read_b64_tr_b16 v[66:67], v48 offset:512
    ds_read_b64_tr_b16 v[68:69], v48 offset:8192
    ds_read_b64_tr_b16 v[70:71], v48 offset:8704
    ds_read_b64_tr_b16 v[72:73], v48 offset:8
    ds_read_b64_tr_b16 v[74:75], v48 offset:520
    ds_read_b64_tr_b16 v[76:77], v48 offset:8200
    ds_read_b64_tr_b16 v[78:79], v48 offset:8712
    s_waitcnt lgkmcnt(0)
    s_barrier
    ds_write_b128 v32, v[64:67] offset:0
    ds_write_b128 v32, v[68:71] offset:1024
    ds_write_b128 v32, v[72:75] offset:2048
    ds_write_b128 v32, v[76:79] offset:3072
    s_waitcnt lgkmcnt(0)
    s_waitcnt vmcnt(24)
    s_barrier
    v_add_u32 v48, 16384, v46
    ds_read_b64_tr_b16 v[64:65], v48 offset:0
    ds_read_b64_tr_b16 v[66:67], v48 offset:512
    ds_read_b64_tr_b16 v[68:69], v48 offset:8192
    ds_read_b64_tr_b16 v[70:71], v48 offset:8704
    ds_read_b64_tr_b16 v[72:73], v48 offset:8
    ds_read_b64_tr_b16 v[74:75], v48 offset:520
    ds_read_b64_tr_b16 v[76:77], v48 offset:8200
    ds_read_b64_tr_b16 v[78:79], v48 offset:8712
    s_waitcnt lgkmcnt(0)
    s_barrier
    ds_write_b128 v32, v[64:67] offset:16384
    ds_write_b128 v32, v[68:71] offset:17408
    ds_write_b128 v32, v[72:75] offset:18432
    ds_write_b128 v32, v[76:79] offset:19456
    s_waitcnt lgkmcnt(0)
    s_waitcnt vmcnt(20)
    s_barrier
    s_getpc_b64 s[16:17]
mega_kernel_rf_pc0:
    s_add_u32 s16, s16, mega_kernel_rf_w0_entry - mega_kernel_rf_pc0
    s_addc_u32 s17, s17, 0
    v_lshlrev_b32 v49, 7, v0
    v_min_u32 v49, mega_kernel_rf_end - mega_kernel_rf_w0_entry, v49
    global_load_dword v50, v49, s[16:17]
    v_lshlrev_b32 v49, 7, v40
    s_xor_b32 s23, s35, 16384
    s_cmp_eq_u32 s20, 1
    s_cselect_b32 s22, s35, s47
    s_cmp_eq_u32 s20, 2
    s_cselect_b32 s22, s23, s22
    s_lshl_b32 s23, s31, 13
    s_add_u32 s23, s23, 178257920
    s_cmp_eq_u32 s20, 3
    s_cselect_b32 s22, s23, s22
    buffer_load_dword v51, v49, s[4:7], s22 offen sc1
    v_lshlrev_b32 v49, 13, v0
    v_and_b32 v49, 0x1fffff, v49
    s_mov_b32 s22, 67108864
    buffer_load_dword v52, v49, s[4:7], s22 offen sc1
    buffer_load_dword v57, v7, s[4:7], 0 offen sc1
    v_add_u32 v48, 32768, v46
    ds_read_b64_tr_b16 v[64:65], v48 offset:0
    ds_read_b64_tr_b16 v[66:67], v48 offset:512
    ds_read_b64_tr_b16 v[68:69], v48 offset:8192
    ds_read_b64_tr_b16 v[70:71], v48 offset:8704
    ds_read_b64_tr_b16 v[72:73], v48 offset:8
    ds_read_b64_tr_b16 v[74:75], v48 offset:520
    ds_read_b64_tr_b16 v[76:77], v48 offset:8200
    ds_read_b64_tr_b16 v[78:79], v48 offset:8712
    s_waitcnt lgkmcnt(0)
    s_barrier
    ds_write_b128 v32, v[64:67] offset:32768
    ds_write_b128 v32, v[68:71] offset:33792
    ds_write_b128 v32, v[72:75] offset:34816
    ds_write_b128 v32, v[76:79] offset:35840
    s_waitcnt lgkmcnt(0)
    s_waitcnt vmcnt(16)
    s_barrier
    v_add_u32 v48, 49152, v46
    ds_read_b64_tr_b16 v[64:65], v48 offset:0
    ds_read_b64_tr_b16 v[66:67], v48 offset:512
    ds_read_b64_tr_b16 v[68:69], v48 offset:8192
    ds_read_b64_tr_b16 v[70:71], v48 offset:8704
    ds_read_b64_tr_b16 v[72:73], v48 offset:8
    ds_read_b64_tr_b16 v[74:75], v48 offset:520
    ds_read_b64_tr_b16 v[76:77], v48 offset:8200
    ds_read_b64_tr_b16 v[78:79], v48 offset:8712
    s_waitcnt lgkmcnt(0)
    s_barrier
    ds_write_b128 v32, v[64:67] offset:49152
    ds_write_b128 v32, v[68:71] offset:50176
    ds_write_b128 v32, v[72:75] offset:51200
    ds_write_b128 v32, v[76:79] offset:52224
    s_waitcnt lgkmcnt(0)
    s_waitcnt vmcnt(12)
    s_barrier
    v_add_u32 v48, 65536, v46
    ds_read_b64_tr_b16 v[64:65], v48 offset:0
    ds_read_b64_tr_b16 v[66:67], v48 offset:512
    ds_read_b64_tr_b16 v[68:69], v48 offset:8192
    ds_read_b64_tr_b16 v[70:71], v48 offset:8704
    ds_read_b64_tr_b16 v[72:73], v48 offset:8
    ds_read_b64_tr_b16 v[74:75], v48 offset:520
    ds_read_b64_tr_b16 v[76:77], v48 offset:8200
    ds_read_b64_tr_b16 v[78:79], v48 offset:8712
    s_waitcnt lgkmcnt(0)
    s_barrier
    ds_write_b128 v33, v[64:67] offset:0
    ds_write_b128 v33, v[68:71] offset:1024
    ds_write_b128 v33, v[72:75] offset:2048
    ds_write_b128 v33, v[76:79] offset:3072
    s_waitcnt lgkmcnt(0)
    s_waitcnt vmcnt(8)
    s_barrier
    v_add_u32 v48, 81920, v46
    ds_read_b64_tr_b16 v[208:209], v48 offset:0
    ds_read_b64_tr_b16 v[210:211], v48 offset:512
    ds_read_b64_tr_b16 v[212:213], v48 offset:8192
    ds_read_b64_tr_b16 v[214:215], v48 offset:8704
    ds_read_b64_tr_b16 v[216:217], v48 offset:8
    ds_read_b64_tr_b16 v[218:219], v48 offset:520
    ds_read_b64_tr_b16 v[220:221], v48 offset:8200
    ds_read_b64_tr_b16 v[222:223], v48 offset:8712
    s_waitcnt lgkmcnt(0)
    s_barrier
    ds_write_b128 v33, v[80:83] offset:16384
    ds_write_b128 v33, v[84:87] offset:17408
    ds_write_b128 v33, v[88:91] offset:18432
    ds_write_b128 v33, v[92:95] offset:19456
    s_waitcnt lgkmcnt(0)
    s_waitcnt vmcnt(4)
    s_barrier
    v_add_u32 v48, 98304, v46
    ds_read_b64_tr_b16 v[224:225], v48 offset:0
    ds_read_b64_tr_b16 v[226:227], v48 offset:512
    ds_read_b64_tr_b16 v[228:229], v48 offset:8192
    ds_read_b64_tr_b16 v[230:231], v48 offset:8704
    ds_read_b64_tr_b16 v[232:233], v48 offset:8
    ds_read_b64_tr_b16 v[234:235], v48 offset:520
    ds_read_b64_tr_b16 v[236:237], v48 offset:8200
    ds_read_b64_tr_b16 v[238:239], v48 offset:8712
    s_waitcnt lgkmcnt(0)
    s_barrier
    ds_write_b128 v33, v[96:99] offset:32768
    ds_write_b128 v33, v[100:103] offset:33792
    ds_write_b128 v33, v[104:107] offset:34816
    ds_write_b128 v33, v[108:111] offset:35840
    s_waitcnt lgkmcnt(0)
    s_waitcnt vmcnt(0)
    s_barrier
    v_add_u32 v48, 114688, v46
    ds_read_b64_tr_b16 v[240:241], v48 offset:0
    ds_read_b64_tr_b16 v[242:243], v48 offset:512
    ds_read_b64_tr_b16 v[244:245], v48 offset:8192
    ds_read_b64_tr_b16 v[246:247], v48 offset:8704
    ds_read_b64_tr_b16 v[248:249], v48 offset:8
    ds_read_b64_tr_b16 v[250:251], v48 offset:520
    ds_read_b64_tr_b16 v[252:253], v48 offset:8200
    ds_read_b64_tr_b16 v[254:255], v48 offset:8712
    s_waitcnt lgkmcnt(0)
    s_barrier
    ds_write_b128 v33, v[112:115] offset:49152
    ds_write_b128 v33, v[116:119] offset:50176
    ds_write_b128 v33, v[120:123] offset:51200
    ds_write_b128 v33, v[124:127] offset:52224
    s_waitcnt lgkmcnt(0)
    s_branch mega_kernel_rf_iw1
mega_kernel_rf_iw:
    buffer_load_dword v58, off, s[12:15], 0 offset:204 sc1
    s_waitcnt vmcnt(0)
mega_kernel_rf_iw1:
    v_and_b32 v50, 0xffff, v58
    v_readfirstlane_b32 s60, v58
    v_cmp_ne_u32 vcc, s100, v50
    s_cbranch_vccnz mega_kernel_rf_iw
    s_lshr_b32 s60, s60, 15
    s_cmp_gt_u32 s60, s100
    s_cselect_b32 s60, 8192, 0
    s_bfe_u32 s22, s31, 0x10001
    s_lshl_b32 s22, s22, 12
    s_add_u32 s22, s22, s60
    s_lshl_b32 s23, s20, 10
    s_add_u32 s22, s22, s23
    s_add_u32 s38, s38, s22
    s_add_u32 s37, s37, s22
    s_xor_b32 s40, s38, 4096
    s_xor_b32 s39, s37, 4096
    s_xor_b32 s36, s35, 16384
    s_mov_b32 s21, 0
    s_cmp_eq_u32 s30, 0
    s_mov_b32 s22, 0x33003300
    s_cselect_b32 s16, 0x00330033, s22
    s_mov_b32 s17, s16
    s_cselect_b32 s18, -1, 0
    s_not_b32 s19, s18
    s_lshl_b32 s22, s31, 13
    s_lshl_b32 s23, s20, 11
    s_add_u32 s22, s22, s23
    s_add_u32 s43, s22, 16777216
    s_add_u32 s44, s22, 33554432
    s_lshl_b32 s45, s31, 13
    s_add_u32 s45, s45, 178257920
    s_mul_i32 s48, s20, 3072
    s_add_u32 m0, s48, 140288
    s_mov_b32 s41, 1
    s_mov_b32 s42, 1
    v_mov_b32 v0, v34
    v_bfrev_b32 v3, 1
    v_cndmask_b32 v10, v3, v10, s[16:17]
    v_cndmask_b32 v9, v3, v9, s[26:27]
    s_sub_u32 s45, s45, 262144
    s_lshl_b32 s51, s30, 11
    s_add_u32 s51, s51, s45
    s_mov_b32 s50, 0
    s_cmp_lg_u32 s20, 3
    s_cbranch_scc1 mega_kernel_rf_kv0
    v_readlane_b32 s50, v57, 0
    v_readlane_b32 s22, v57, 2
    v_readlane_b32 s23, v57, 1
    v_readlane_b32 s24, v57, 3
    s_nop 3
    s_min_u32 s50, s50, s22
    s_min_u32 s23, s23, s24
    s_lshl_b32 s50, s50, 1
    s_lshl_b32 s23, s23, 1
    s_add_u32 s23, s23, 1
    s_min_u32 s50, s50, s23
mega_kernel_rf_kvb0:
    s_add_u32 s22, s21, 0
    s_min_u32 s22, s22, 63
    s_cmp_gt_u32 s50, s22
    s_cbranch_scc1 mega_kernel_rf_kvd0
    buffer_load_dword v48, v7, s[4:7], 0 offen sc1
    s_waitcnt vmcnt(0)
    v_readlane_b32 s50, v48, 0
    v_readlane_b32 s22, v48, 2
    v_readlane_b32 s23, v48, 1
    v_readlane_b32 s24, v48, 3
    s_nop 3
    s_min_u32 s50, s50, s22
    s_min_u32 s23, s23, s24
    s_lshl_b32 s50, s50, 1
    s_lshl_b32 s23, s23, 1
    s_add_u32 s23, s23, 1
    s_min_u32 s50, s50, s23
    s_branch mega_kernel_rf_kvb0
mega_kernel_rf_kvd0:
mega_kernel_rf_kv0:
    s_barrier
    s_cmp_eq_u32 s20, 1
    s_cbranch_scc1 mega_kernel_rf_w1_entry
    s_cmp_eq_u32 s20, 2
    s_cbranch_scc1 mega_kernel_rf_w2_entry
    s_cmp_eq_u32 s20, 3
    s_cbranch_scc1 mega_kernel_rf_w3_entry
mega_kernel_rf_w0_entry:
    v_mfma_f32_32x32x8_bf16 v[96:111], v[14:15], v[14:15], 0
    v_mfma_f32_16x16x16_bf16 v[112:115], v[14:15], v[14:15], 0
    v_mfma_f32_16x16x16_bf16 v[116:119], v[14:15], v[14:15], 0
    ds_read_b128 v[64:67], v1 offset:0
    ds_read_b128 v[68:71], v1 offset:1024
    ds_read_b128 v[72:75], v1 offset:2048
    ds_read_b128 v[76:79], v1 offset:3072
    ds_read_b128 v[80:83], v1 offset:16384
    ds_read_b128 v[84:87], v1 offset:17408
    ds_read_b128 v[88:91], v1 offset:18432
    ds_read_b128 v[92:95], v1 offset:19456
    buffer_load_dwordx4 v[120:123], v1, s[4:7], s44 offen
    buffer_load_dwordx4 v[124:127], v1, s[4:7], s44 offen offset:1024
    s_add_u32 s44, s44, 262144
mega_kernel_rf_w0_loop:
    s_add_u32 s22, s35, 0
    s_waitcnt vmcnt(0)
    buffer_load_dwordx4 v[32:35], v12, s[4:7], s22 offen sc1
    buffer_load_dwordx4 v[36:39], v12, s[4:7], s22 offen offset:1024 sc1
mega_kernel_rf_w0_pa:
    s_waitcnt vmcnt(1)
    ds_write_b128 v6, v[32:35] offset:0
    s_waitcnt vmcnt(0)
    ds_write_b128 v6, v[36:39] offset:1024
    v_max3_u32 v3, v32, v34, v36
    v_max_u32 v3, v3, v38
    v_cmp_eq_u32 vcc, -1, v3
    v_smfmac_f32_16x16x64_bf16 v[96:99], v[32:35], a[0:7], v2
    v_smfmac_f32_16x16x64_bf16 v[100:103], v[32:35], a[8:15], v2
    v_smfmac_f32_16x16x64_bf16 v[104:107], v[32:35], a[128:135], v2
    s_cbranch_vccnz mega_kernel_rf_w0_pafail
    s_waitcnt lgkmcnt(0)
    s_barrier
    ds_read_b128 v[40:43], v6 offset:2048
    ds_read_b128 v[44:47], v6 offset:3072
    v_smfmac_f32_16x16x64_bf16 v[108:111], v[32:35], a[136:143], v2
    ds_read_b128 v[48:51], v6 offset:4096
    v_smfmac_f32_16x16x64_bf16 v[96:99], v[36:39], a[16:23], v2
    ds_read_b128 v[52:55], v6 offset:5120
    v_smfmac_f32_16x16x64_bf16 v[100:103], v[36:39], a[24:31], v2
    ds_read_b128 v[56:59], v6 offset:6144
    v_smfmac_f32_16x16x64_bf16 v[104:107], v[36:39], a[144:151], v2
    ds_read_b128 v[60:63], v6 offset:7168
    v_smfmac_f32_16x16x64_bf16 v[108:111], v[36:39], a[152:159], v2
    buffer_load_dwordx4 v1, s[4:7], s43 offen lds
    s_waitcnt lgkmcnt(5)
    v_smfmac_f32_16x16x64_bf16 v[96:99], v[40:43], a[32:39], v2
    v_smfmac_f32_16x16x64_bf16 v[100:103], v[40:43], a[40:47], v2
    v_smfmac_f32_16x16x64_bf16 v[104:107], v[40:43], a[160:167], v2
    v_smfmac_f32_16x16x64_bf16 v[108:111], v[40:43], a[168:175], v2
    buffer_load_dwordx4 v1, s[4:7], s43 offen offset:1024 lds
    s_waitcnt lgkmcnt(4)
    v_smfmac_f32_16x16x64_bf16 v[96:99], v[44:47], a[48:55], v2
    v_smfmac_f32_16x16x64_bf16 v[100:103], v[44:47], a[56:63], v2
    v_smfmac_f32_16x16x64_bf16 v[104:107], v[44:47], a[176:183], v2
    v_smfmac_f32_16x16x64_bf16 v[108:111], v[44:47], a[184:191], v2
    buffer_store_dwordx4 v[20:23], v10, s[4:7], s45 offen offset:0 sc1
    s_waitcnt lgkmcnt(3)
    v_smfmac_f32_16x16x64_bf16 v[96:99], v[48:51], a[64:71], v2
    v_smfmac_f32_16x16x64_bf16 v[100:103], v[48:51], a[72:79], v2
    v_smfmac_f32_16x16x64_bf16 v[104:107], v[48:51], a[192:199], v2
    v_smfmac_f32_16x16x64_bf16 v[108:111], v[48:51], a[200:207], v2
    buffer_store_dwordx2 v[18:19], v11, s[4:7], s51 offen offset:2048 sc1
    s_waitcnt lgkmcnt(2)
    v_smfmac_f32_16x16x64_bf16 v[96:99], v[52:55], a[80:87], v2
    v_smfmac_f32_16x16x64_bf16 v[100:103], v[52:55], a[88:95], v2
    v_smfmac_f32_16x16x64_bf16 v[104:107], v[52:55], a[208:215], v2
    v_smfmac_f32_16x16x64_bf16 v[108:111], v[52:55], a[216:223], v2
    s_waitcnt lgkmcnt(1)
    v_smfmac_f32_16x16x64_bf16 v[96:99], v[56:59], a[96:103], v2
    v_smfmac_f32_16x16x64_bf16 v[100:103], v[56:59], a[104:111], v2
    v_smfmac_f32_16x16x64_bf16 v[104:107], v[56:59], a[224:231], v2
    v_smfmac_f32_16x16x64_bf16 v[108:111], v[56:59], a[232:239], v2
    s_waitcnt lgkmcnt(0)
    v_smfmac_f32_16x16x64_bf16 v[96:99], v[60:63], a[112:119], v2
    v_smfmac_f32_16x16x64_bf16 v[100:103], v[60:63], a[120:127], v2
    v_smfmac_f32_16x16x64_bf16 v[104:107], v[60:63], a[240:247], v2
    v_smfmac_f32_16x16x64_bf16 v[108:111], v[60:63], a[248:255], v2
    s_nop 4
    v_pk_add_f32 v[96:97], v[96:97], v[98:99]
    v_pk_add_f32 v[100:101], v[100:101], v[102:103]
    v_pk_add_f32 v[104:105], v[104:105], v[106:107]
    v_pk_add_f32 v[108:109], v[108:109], v[110:111]
    v_cvt_pk_bf16_f32 v111, v108, v109
    v_cvt_pk_bf16_f32 v108, v96, v97
    v_cvt_pk_bf16_f32 v110, v100, v101
    v_cvt_pk_bf16_f32 v109, v104, v105
    v_and_or_b32 v108, v108, -2, s41
    buffer_store_dwordx4 v[108:111], v1, s[4:7], s37 offen sc1
    v_smfmac_f32_16x16x64_bf16 v[112:115], v[32:35], v[64:71], v2
    ds_read_b128 v[64:67], v1 offset:32768
    ds_read_b128 v[68:71], v1 offset:33792
    v_smfmac_f32_16x16x64_bf16 v[116:119], v[32:35], v[72:79], v2
    ds_read_b128 v[72:75], v1 offset:34816
    ds_read_b128 v[76:79], v1 offset:35840
    v_smfmac_f32_16x16x64_bf16 v[112:115], v[36:39], v[80:87], v2
    ds_read_b128 v[80:83], v1 offset:49152
    ds_read_b128 v[84:87], v1 offset:50176
    v_smfmac_f32_16x16x64_bf16 v[116:119], v[36:39], v[88:95], v2
    ds_read_b128 v[88:91], v1 offset:51200
    ds_read_b128 v[92:95], v1 offset:52224
    v_smfmac_f32_16x16x64_bf16 v[112:115], v[52:55], v[208:215], v2
    v_smfmac_f32_16x16x64_bf16 v[116:119], v[52:55], v[216:223], v2
    v_smfmac_f32_16x16x64_bf16 v[112:115], v[56:59], v[224:231], v2
    s_waitcnt lgkmcnt(6)
    v_smfmac_f32_16x16x64_bf16 v[112:115], v[40:43], v[64:71], v2
    ds_read_b128 v[64:67], v5 offset:0
    ds_read_b128 v[68:71], v5 offset:1024
    s_waitcnt lgkmcnt(6)
    v_smfmac_f32_16x16x64_bf16 v[116:119], v[40:43], v[72:79], v2
    ds_read_b128 v[72:75], v5 offset:2048
    ds_read_b128 v[76:79], v5 offset:3072
    v_smfmac_f32_16x16x64_bf16 v[116:119], v[56:59], v[232:239], v2
    v_smfmac_f32_16x16x64_bf16 v[112:115], v[60:63], v[240:247], v2
    v_smfmac_f32_16x16x64_bf16 v[116:119], v[60:63], v[248:255], v2
    s_waitcnt lgkmcnt(6)
    v_smfmac_f32_16x16x64_bf16 v[112:115], v[44:47], v[80:87], v2
    s_waitcnt lgkmcnt(4)
    v_smfmac_f32_16x16x64_bf16 v[116:119], v[44:47], v[88:95], v2
    s_waitcnt lgkmcnt(2)
    v_smfmac_f32_16x16x64_bf16 v[112:115], v[48:51], v[64:71], v2
    s_waitcnt lgkmcnt(0)
    v_smfmac_f32_16x16x64_bf16 v[116:119], v[48:51], v[72:79], v2
    v_mfma_f32_16x16x16_bf16 v[100:103], v[108:109], v[16:17], 0
    v_mfma_f32_16x16x16_bf16 v[104:107], v[110:111], v[16:17], 0
    s_nop 4
    v_add_f32 v112, v112, v114
    v_add_f32 v113, v113, v115
    v_add_f32 v114, v116, v118
    v_add_f32 v115, v117, v119
    v_cvt_pk_bf16_f32 v18, v112, v113
    v_cvt_pk_bf16_f32 v19, v114, v115
    v_and_or_b32 v18, v18, -2, s41
    v_mov_b32 v112, v18
    v_mov_b32 v114, v19
    v_mov_b32 v92, v28
    v_mov_b32 v93, 0
    s_waitcnt vmcnt(3)
    s_barrier
    ds_read_b128 v[32:35], v6 offset:9216
    ds_read_b128 v[36:39], v6 offset:10240
    ds_read_b128 v[40:43], v6 offset:12288
    ds_read_b128 v[44:47], v6 offset:13312
    ds_read_b128 v[48:51], v6 offset:15360
    ds_read_b128 v[52:55], v6 offset:16384
    ds_read_b128 v[56:59], v6 offset:18432
    ds_read_b128 v[60:63], v6 offset:19456
    buffer_load_dwordx4 v[96:99], v1, s[4:7], s38 offen sc1
    s_barrier
    buffer_store_dwordx2 v[18:19], v11, s[4:7], s39 offen sc1
    s_nop 15
    s_nop 15
    buffer_load_dwordx4 v[20:23], v1, s[4:7], s38 offen sc1
    s_waitcnt vmcnt(2)
    v_mfma_f32_16x16x16_bf16 v[80:83], v[96:97], v[16:17], v[100:103]
    v_mfma_f32_16x16x16_bf16 v[84:87], v[98:99], v[16:17], v[104:107]
    v_and_b32 v3, 1, v96
    v_cmp_ne_u32 vcc, s41, v3
    s_nop 4
    v_cvt_pk_bf16_f32 v64, v80, v81
    v_cvt_pk_bf16_f32 v65, v82, v83
    v_cvt_pk_bf16_f32 v66, v84, v85
    v_cvt_pk_bf16_f32 v67, v86, v87
    ds_write_b128 v6, v[64:67] offset:8192
    s_cbranch_vccnz mega_kernel_rf_w0_xslow
mega_kernel_rf_w0_xok:
    s_cmp_eq_u32 s21, 63
    s_cbranch_scc1 mega_kernel_rf_w0_last
    buffer_load_dwordx2 v[116:117], v11, s[4:7], s40 offen sc1
    s_waitcnt lgkmcnt(1)
    v_mfma_f32_16x16x32_bf16 v[80:83], v[32:35], v[64:67], 0
    s_waitcnt lgkmcnt(0)
    s_barrier
    ds_read_b128 v[68:71], v6 offset:11264
    ds_read_b128 v[72:75], v6 offset:14336
    ds_read_b128 v[76:79], v6 offset:17408
    v_mfma_f32_16x16x32_bf16 v[84:87], v[36:39], v[64:67], 0
    v_mfma_f32_16x16x32_bf16 v[88:91], v[64:67], v[64:67], 0
    buffer_load_dwordx2 v[20:21], v11, s[4:7], s40 offen sc1
    s_waitcnt lgkmcnt(2)
    v_mfma_f32_16x16x32_bf16 v[80:83], v[40:43], v[68:71], v[80:83]
    v_mfma_f32_16x16x32_bf16 v[84:87], v[44:47], v[68:71], v[84:87]
    v_mfma_f32_16x16x32_bf16 v[88:91], v[68:71], v[68:71], v[88:91]
    s_waitcnt lgkmcnt(1)
    v_mfma_f32_16x16x32_bf16 v[80:83], v[48:51], v[72:75], v[80:83]
    v_mfma_f32_16x16x32_bf16 v[84:87], v[52:55], v[72:75], v[84:87]
    v_mfma_f32_16x16x32_bf16 v[88:91], v[72:75], v[72:75], v[88:91]
    s_waitcnt lgkmcnt(0)
    v_mfma_f32_16x16x32_bf16 v[80:83], v[56:59], v[76:79], v[80:83]
    v_mfma_f32_16x16x32_bf16 v[84:87], v[60:63], v[76:79], v[84:87]
    v_mfma_f32_16x16x32_bf16 v[88:91], v[76:79], v[76:79], v[88:91]
    v_mfma_f32_32x32x4_2b_bf16 v[32:63], v[14:15], v[14:15], 0
    s_nop 4
    v_max3_f32 v4, v80, v81, v82
    v_max3_f32 v4, v4, v83, v84
    v_max3_f32 v4, v4, v85, v86
    v_max3_f32 v4, v4, v87, v88
    v_max_f32 v90, v4, v89
    v_max_f32 v4, v4, v89
    s_nop 0
    s_nop 0
    v_permlane16_swap_b32 v4, v90
    v_max_f32 v4, v4, v90
    v_max_f32 v90, v4, v90
    s_nop 1
    v_permlane32_swap_b32 v4, v90
    v_max_f32 v4, v4, v90
    v_mul_f32 v4, s34, v4
    v_pk_fma_f32 v[80:81], v[80:81], s[34:35], v[4:5] op_sel_hi:[1,0,0] neg_lo:[0,0,1] neg_hi:[0,0,1]
    v_pk_fma_f32 v[82:83], v[82:83], s[34:35], v[4:5] op_sel_hi:[1,0,0] neg_lo:[0,0,1] neg_hi:[0,0,1]
    v_pk_fma_f32 v[84:85], v[84:85], s[34:35], v[4:5] op_sel_hi:[1,0,0] neg_lo:[0,0,1] neg_hi:[0,0,1]
    v_pk_fma_f32 v[86:87], v[86:87], s[34:35], v[4:5] op_sel_hi:[1,0,0] neg_lo:[0,0,1] neg_hi:[0,0,1]
    v_pk_fma_f32 v[88:89], v[88:89], s[34:35], v[4:5] op_sel_hi:[1,0,0] neg_lo:[0,0,1] neg_hi:[0,0,1]
    v_exp_f32 v80, v80
    v_exp_f32 v81, v81
    v_exp_f32 v82, v82
    v_cvt_pk_bf16_f32 v68, v80, v81
    v_exp_f32 v83, v83
    v_exp_f32 v84, v84
    v_cvt_pk_bf16_f32 v69, v82, v83
    v_exp_f32 v85, v85
    v_exp_f32 v86, v86
    v_cvt_pk_bf16_f32 v70, v84, v85
    v_exp_f32 v87, v87
    v_exp_f32 v88, v88
    v_cvt_pk_bf16_f32 v71, v86, v87
    v_exp_f32 v89, v89
    s_nop 0
    v_mfma_f32_16x16x32_bf16 v[76:79], v[28:31], v[68:71], 0
    v_cvt_pk_bf16_f32 v72, v88, v89
    v_cvt_pk_bf16_f32 v73, v88, v89
    v_mfma_f32_16x16x32_bf16 v[100:103], v[120:123], v[68:71], 0
    s_waitcnt vmcnt(1)
    v_and_b32 v3, 1, v116
    v_cmp_ne_u32 vcc, s41, v3
    v_mfma_f32_16x16x32_bf16 v[104:107], v[124:127], v[68:71], 0
    v_mov_b32 v113, v116
    v_mov_b32 v115, v117
    v_mfma_f32_16x16x16_bf16 v[76:79], v[92:93], v[72:73], v[76:79]
    s_cbranch_vccnz mega_kernel_rf_w0_pv0
mega_kernel_rf_w0_pv2:
    v_mfma_f32_16x16x16_bf16 v[100:103], v[112:113], v[72:73], v[100:103]
    v_mfma_f32_16x16x16_bf16 v[104:107], v[114:115], v[72:73], v[104:107]
    buffer_load_dwordx4 v[120:123], v1, s[4:7], s44 offen
    buffer_load_dwordx4 v[124:127], v1, s[4:7], s44 offen offset:1024
    s_nop 2
    v_rcp_f32 v76, v76
    s_mov_b64 exec, s[28:29]
    v_pk_mul_f32 v[100:101], v[100:101], v[76:77] op_sel_hi:[1,0]
    v_pk_mul_f32 v[102:103], v[102:103], v[76:77] op_sel_hi:[1,0]
    v_pk_mul_f32 v[104:105], v[104:105], v[76:77] op_sel_hi:[1,0]
    v_pk_mul_f32 v[106:107], v[106:107], v[76:77] op_sel_hi:[1,0]
    v_cvt_pk_bf16_f32 v72, v100, v101
    v_cvt_pk_bf16_f32 v73, v102, v103
    v_cvt_pk_bf16_f32 v74, v104, v105
    v_cvt_pk_bf16_f32 v75, v106, v107
    ds_write_b128 v6, v[72:75] offset:20448
    s_mov_b64 exec, -1
    ds_read_b128 v[88:91], v5 offset:16384
    ds_read_b128 v[92:95], v5 offset:17408
    ds_read_b128 v[80:83], v5 offset:18432
    ds_read_b128 v[84:87], v5 offset:19456
    ds_read_b128 v[112:115], v5 offset:32768
    ds_read_b128 v[116:119], v5 offset:33792
    v_mov_b32 v3, s21
    buffer_store_dword v3, v7, s[4:7], 0 offen sc1
    s_waitcnt lgkmcnt(6)
    s_barrier
    ds_read_b128 v[68:71], v6 offset:20480
    ds_read_b128 v[72:75], v6 offset:21504
    ds_read_b128 v[96:99], v5 offset:34816
    ds_read_b128 v[100:103], v5 offset:35840
    ds_read_b128 v[104:107], v5 offset:49152
    ds_read_b128 v[108:111], v5 offset:50176
    s_waitcnt lgkmcnt(5)
    v_smfmac_f32_16x16x64_bf16 v[32:35], v[68:71], v[128:135], v2
    s_add_u32 s21, s21, 1
    v_smfmac_f32_16x16x64_bf16 v[36:39], v[68:71], v[136:143], v2
    s_xor_b32 s38, s38, 1048576
    v_smfmac_f32_16x16x64_bf16 v[40:43], v[68:71], v[144:151], v2
    s_xor_b32 s37, s37, 1048576
    v_smfmac_f32_16x16x64_bf16 v[44:47], v[68:71], v[152:159], v2
    s_xor_b32 s40, s40, 1048576
    s_waitcnt lgkmcnt(4)
    v_smfmac_f32_16x16x64_bf16 v[32:35], v[72:75], v[160:167], v2
    s_xor_b32 s39, s39, 1048576
    v_smfmac_f32_16x16x64_bf16 v[36:39], v[72:75], v[168:175], v2
    s_lshr_b32 s41, s21, 1
    v_smfmac_f32_16x16x64_bf16 v[40:43], v[72:75], v[176:183], v2
    s_and_b32 s41, s41, 1
    v_smfmac_f32_16x16x64_bf16 v[44:47], v[72:75], v[184:191], v2
    s_xor_b32 s41, s41, 1
    v_smfmac_f32_16x16x64_bf16 v[48:51], v[68:71], v[192:199], v2
    s_xor_b32 s35, s35, 16384
    v_smfmac_f32_16x16x64_bf16 v[52:55], v[68:71], v[200:207], v2
    s_xor_b32 s36, s36, 16384
    s_waitcnt lgkmcnt(0)
    v_smfmac_f32_16x16x64_bf16 v[56:59], v[68:71], v[88:95], v2
    ds_read_b128 v[88:91], v5 offset:51200
    ds_read_b128 v[92:95], v5 offset:52224
    v_smfmac_f32_16x16x64_bf16 v[60:63], v[68:71], v[80:87], v2
    s_add_u32 s43, s43, 262144
    v_smfmac_f32_16x16x64_bf16 v[48:51], v[72:75], v[112:119], v2
    s_add_u32 s44, s44, 262144
    v_add_f32 v32, v32, v34
    v_add_f32 v33, v33, v35
    v_cvt_pk_bf16_f32 v32, v32, v33
    v_and_or_b32 v32, v32, -2, s42
    v_smfmac_f32_16x16x64_bf16 v[52:55], v[72:75], v[96:103], v2
    v_add_f32 v36, v36, v38
    v_add_f32 v37, v37, v39
    v_cvt_pk_bf16_f32 v33, v36, v37
    v_smfmac_f32_16x16x64_bf16 v[56:59], v[72:75], v[104:111], v2
    v_add_f32 v40, v40, v42
    v_add_f32 v41, v41, v43
    v_cvt_pk_bf16_f32 v34, v40, v41
    s_waitcnt lgkmcnt(0)
    v_smfmac_f32_16x16x64_bf16 v[60:63], v[72:75], v[88:95], v2
    v_add_f32 v44, v44, v46
    v_add_f32 v45, v45, v47
    v_cvt_pk_bf16_f32 v35, v44, v45
    buffer_store_dwordx4 v[32:35], v8, s[4:7], s46 offen
    v_pk_add_f32 v[48:49], v[48:49], v[50:51]
    v_cvt_pk_bf16_f32 v48, v48, v49
    v_and_or_b32 v48, v48, -2, s42
    v_pk_add_f32 v[52:53], v[52:53], v[54:55]
    v_cvt_pk_bf16_f32 v49, v52, v53
    v_pk_add_f32 v[56:57], v[56:57], v[58:59]
    v_cvt_pk_bf16_f32 v50, v56, v57
    v_pk_add_f32 v[60:61], v[60:61], v[62:63]
    v_cvt_pk_bf16_f32 v51, v60, v61
    buffer_store_dwordx4 v[48:51], v8, s[4:7], s61 offen
    s_waitcnt vmcnt(5)
    v_mov_b32 v20, v64
    v_mov_b32 v21, v65
    v_mov_b32 v22, v66
    v_mov_b32 v23, v67
    s_add_u32 s45, s45, 262144
    s_add_u32 s51, s51, 262144
    v_mfma_f32_32x32x8_bf16 v[96:111], v[14:15], v[14:15], 0
    v_mfma_f32_16x16x16_bf16 v[112:115], v[14:15], v[14:15], 0
    v_mfma_f32_16x16x16_bf16 v[116:119], v[14:15], v[14:15], 0
    ds_read_b128 v[64:67], v1 offset:0
    ds_read_b128 v[68:71], v1 offset:1024
    ds_read_b128 v[72:75], v1 offset:2048
    ds_read_b128 v[76:79], v1 offset:3072
    ds_read_b128 v[80:83], v1 offset:16384
    ds_read_b128 v[84:87], v1 offset:17408
    ds_read_b128 v[88:91], v1 offset:18432
    ds_read_b128 v[92:95], v1 offset:19456
    v_mov_b32 v58, -1
    v_mov_b32 v59, -1
    s_waitcnt vmcnt(0)
mega_kernel_rf_w0_pc:
    buffer_load_dword v36, v13, s[4:7], s47 offen offset:0 sc1
    buffer_load_dword v37, v13, s[4:7], s47 offen offset:1024 sc1
    buffer_load_dword v38, v13, s[4:7], s47 offen offset:2048 sc1
    buffer_load_dword v39, v13, s[4:7], s47 offen offset:3072 sc1
    buffer_load_dword v40, v13, s[4:7], s25 offen offset:0 sc1
    buffer_load_dword v41, v13, s[4:7], s25 offen offset:1024 sc1
    buffer_load_dword v42, v13, s[4:7], s25 offen offset:2048 sc1
    buffer_load_dword v43, v13, s[4:7], s25 offen offset:3072 sc1
    s_waitcnt vmcnt(4)
    v_mfma_f32_16x16x32_bf16 v[52:55], v[36:39], v[24:27], 0
    v_bitop3_b32 v3, s42, v36, v37 bitop3:0x7e
    v_bitop3_b32 v4, s42, v38, v39 bitop3:0x7e
    s_waitcnt vmcnt(2)
    v_or_b32 v3, v3, v4
    v_bitop3_b32 v4, s42, v40, v41 bitop3:0x7e
    s_waitcnt vmcnt(0)
    v_mfma_f32_16x16x32_bf16 v[52:55], v[40:43], v[24:27], v[52:55]
    v_bitop3_b32 v56, s42, v42, v43 bitop3:0x7e
    v_or3_b32 v3, v3, v4, v56
    v_and_b32 v3, v0, v3
    v_cmp_ne_u32 vcc, 0, v3
    s_cbranch_vccnz mega_kernel_rf_w0_pc
    s_nop 2
    v_cvt_pk_bf16_f32 v56, v52, v53
    v_cvt_pk_bf16_f32 v57, v54, v55
    v_min_u32 v56, -2, v56
    s_mov_b64 exec, s[26:27]
    buffer_store_dwordx2 v[56:57], v9, s[4:7], s35 offen offset:0
    buffer_store_dwordx2 v[58:59], v9, s[4:7], s36 offen offset:0
    s_mov_b64 exec, -1
    s_xor_b32 s42, s42, 1
    s_branch mega_kernel_rf_w0_loop
mega_kernel_rf_w0_last:
    s_add_u32 s45, s45, 262144
    s_add_u32 s51, s51, 262144
    buffer_store_dwordx4 v[64:67], v10, s[4:7], s45 offen offset:0 sc1
    buffer_store_dwordx2 v[18:19], v11, s[4:7], s51 offen offset:2048 sc1
    s_branch mega_kernel_rf_end
mega_kernel_rf_w0_pafail:
    buffer_load_dwordx4 v[32:35], v12, s[4:7], s22 offen sc1
    buffer_load_dwordx4 v[36:39], v12, s[4:7], s22 offen offset:1024 sc1
    s_nop 7
    v_mov_b32 v96, 0
    v_mov_b32 v97, 0
    v_mov_b32 v98, 0
    v_mov_b32 v99, 0
    v_mov_b32 v100, 0
    v_mov_b32 v101, 0
    v_mov_b32 v102, 0
    v_mov_b32 v103, 0
    v_mov_b32 v104, 0
    v_mov_b32 v105, 0
    v_mov_b32 v106, 0
    v_mov_b32 v107, 0
    s_branch mega_kernel_rf_w0_pa
mega_kernel_rf_w0_xslow:
    buffer_load_dwordx4 v[96:99], v1, s[4:7], s38 offen sc1
    s_waitcnt vmcnt(1)
    v_and_b32 v3, 1, v20
    v_cmp_ne_u32 vcc, s41, v3
    s_cbranch_vccz mega_kernel_rf_w0_xgot1
    buffer_load_dwordx4 v[20:23], v1, s[4:7], s38 offen sc1
mega_kernel_rf_w0_px:
    s_waitcnt vmcnt(1)
    v_and_b32 v3, 1, v96
    v_cmp_ne_u32 vcc, s41, v3
    s_cbranch_vccz mega_kernel_rf_w0_xgot0
    buffer_load_dwordx4 v[96:99], v1, s[4:7], s38 offen sc1
    s_waitcnt vmcnt(1)
    v_and_b32 v3, 1, v20
    v_cmp_ne_u32 vcc, s41, v3
    s_cbranch_vccz mega_kernel_rf_w0_xgot1
    buffer_load_dwordx4 v[20:23], v1, s[4:7], s38 offen sc1
    s_branch mega_kernel_rf_w0_px
mega_kernel_rf_w0_xgot0:
    v_mfma_f32_16x16x16_bf16 v[80:83], v[96:97], v[16:17], v[100:103]
    v_mfma_f32_16x16x16_bf16 v[84:87], v[98:99], v[16:17], v[104:107]
    v_and_b32 v3, 1, v96
    v_cmp_ne_u32 vcc, s41, v3
    s_nop 4
    v_cvt_pk_bf16_f32 v64, v80, v81
    v_cvt_pk_bf16_f32 v65, v82, v83
    v_cvt_pk_bf16_f32 v66, v84, v85
    v_cvt_pk_bf16_f32 v67, v86, v87
    ds_write_b128 v6, v[64:67] offset:8192
    s_branch mega_kernel_rf_w0_xok
mega_kernel_rf_w0_xgot1:
    v_mfma_f32_16x16x16_bf16 v[80:83], v[20:21], v[16:17], v[100:103]
    v_mfma_f32_16x16x16_bf16 v[84:87], v[22:23], v[16:17], v[104:107]
    v_and_b32 v3, 1, v20
    v_cmp_ne_u32 vcc, s41, v3
    s_nop 4
    v_cvt_pk_bf16_f32 v64, v80, v81
    v_cvt_pk_bf16_f32 v65, v82, v83
    v_cvt_pk_bf16_f32 v66, v84, v85
    v_cvt_pk_bf16_f32 v67, v86, v87
    ds_write_b128 v6, v[64:67] offset:8192
    s_branch mega_kernel_rf_w0_xok
mega_kernel_rf_w0_pv0:
    s_waitcnt vmcnt(0)
    s_branch mega_kernel_rf_w0_pv1
mega_kernel_rf_w0_pv:
    buffer_load_dwordx2 v[20:21], v11, s[4:7], s40 offen sc1
    s_waitcnt vmcnt(0)
mega_kernel_rf_w0_pv1:
    v_and_b32 v3, 1, v20
    v_cmp_ne_u32 vcc, s41, v3
    v_mov_b32 v113, v20
    v_mov_b32 v115, v21
    s_cbranch_vccnz mega_kernel_rf_w0_pv
    s_branch mega_kernel_rf_w0_pv2
mega_kernel_rf_w1_entry:
    v_mfma_f32_32x32x8_bf16 v[96:111], v[14:15], v[14:15], 0
    v_mfma_f32_16x16x16_bf16 v[112:115], v[14:15], v[14:15], 0
    v_mfma_f32_16x16x16_bf16 v[116:119], v[14:15], v[14:15], 0
    ds_read_b128 v[64:67], v1 offset:4096
    ds_read_b128 v[68:71], v1 offset:5120
    ds_read_b128 v[72:75], v1 offset:6144
    ds_read_b128 v[76:79], v1 offset:7168
    ds_read_b128 v[80:83], v1 offset:20480
    ds_read_b128 v[84:87], v1 offset:21504
    ds_read_b128 v[88:91], v1 offset:22528
    ds_read_b128 v[92:95], v1 offset:23552
    buffer_load_dwordx4 v[120:123], v1, s[4:7], s44 offen
    buffer_load_dwordx4 v[124:127], v1, s[4:7], s44 offen offset:1024
    s_add_u32 s44, s44, 262144
mega_kernel_rf_w1_loop:
    s_add_u32 s22, s35, 2048
    s_waitcnt vmcnt(0)
    buffer_load_dwordx4 v[40:43], v12, s[4:7], s22 offen sc1
    buffer_load_dwordx4 v[44:47], v12, s[4:7], s22 offen offset:1024 sc1
mega_kernel_rf_w1_pa:
    s_waitcnt vmcnt(1)
    ds_write_b128 v6, v[40:43] offset:2048
    s_waitcnt vmcnt(0)
    ds_write_b128 v6, v[44:47] offset:3072
    v_max3_u32 v3, v40, v42, v44
    v_max_u32 v3, v3, v46
    v_cmp_eq_u32 vcc, -1, v3
    v_smfmac_f32_16x16x64_bf16 v[96:99], v[40:43], a[32:39], v2
    v_smfmac_f32_16x16x64_bf16 v[100:103], v[40:43], a[40:47], v2
    v_smfmac_f32_16x16x64_bf16 v[104:107], v[40:43], a[160:167], v2
    s_cbranch_vccnz mega_kernel_rf_w1_pafail
    s_waitcnt lgkmcnt(0)
    s_barrier
    ds_read_b128 v[48:51], v6 offset:4096
    ds_read_b128 v[52:55], v6 offset:5120
    v_smfmac_f32_16x16x64_bf16 v[108:111], v[40:43], a[168:175], v2
    ds_read_b128 v[56:59], v6 offset:6144
    v_smfmac_f32_16x16x64_bf16 v[96:99], v[44:47], a[48:55], v2
    ds_read_b128 v[60:63], v6 offset:7168
    v_smfmac_f32_16x16x64_bf16 v[100:103], v[44:47], a[56:63], v2
    ds_read_b128 v[32:35], v6 offset:0
    v_smfmac_f32_16x16x64_bf16 v[104:107], v[44:47], a[176:183], v2
    ds_read_b128 v[36:39], v6 offset:1024
    v_smfmac_f32_16x16x64_bf16 v[108:111], v[44:47], a[184:191], v2
    buffer_load_dwordx4 v1, s[4:7], s43 offen lds
    s_waitcnt lgkmcnt(5)
    v_smfmac_f32_16x16x64_bf16 v[96:99], v[48:51], a[64:71], v2
    v_smfmac_f32_16x16x64_bf16 v[100:103], v[48:51], a[72:79], v2
    v_smfmac_f32_16x16x64_bf16 v[104:107], v[48:51], a[192:199], v2
    v_smfmac_f32_16x16x64_bf16 v[108:111], v[48:51], a[200:207], v2
    buffer_load_dwordx4 v1, s[4:7], s43 offen offset:1024 lds
    s_waitcnt lgkmcnt(4)
    v_smfmac_f32_16x16x64_bf16 v[96:99], v[52:55], a[80:87], v2
    v_smfmac_f32_16x16x64_bf16 v[100:103], v[52:55], a[88:95], v2
    v_smfmac_f32_16x16x64_bf16 v[104:107], v[52:55], a[208:215], v2
    v_smfmac_f32_16x16x64_bf16 v[108:111], v[52:55], a[216:223], v2
    buffer_store_dwordx4 v[20:23], v10, s[4:7], s45 offen offset:64 sc1
    s_waitcnt lgkmcnt(3)
    v_smfmac_f32_16x16x64_bf16 v[96:99], v[56:59], a[96:103], v2
    v_smfmac_f32_16x16x64_bf16 v[100:103], v[56:59], a[104:111], v2
    v_smfmac_f32_16x16x64_bf16 v[104:107], v[56:59], a[224:231], v2
    v_smfmac_f32_16x16x64_bf16 v[108:111], v[56:59], a[232:239], v2
    buffer_store_dwordx2 v[18:19], v11, s[4:7], s51 offen offset:2560 sc1
    s_waitcnt lgkmcnt(2)
    v_smfmac_f32_16x16x64_bf16 v[96:99], v[60:63], a[112:119], v2
    v_smfmac_f32_16x16x64_bf16 v[100:103], v[60:63], a[120:127], v2
    v_smfmac_f32_16x16x64_bf16 v[104:107], v[60:63], a[240:247], v2
    v_smfmac_f32_16x16x64_bf16 v[108:111], v[60:63], a[248:255], v2
    s_waitcnt lgkmcnt(1)
    v_smfmac_f32_16x16x64_bf16 v[96:99], v[32:35], a[0:7], v2
    v_smfmac_f32_16x16x64_bf16 v[100:103], v[32:35], a[8:15], v2
    v_smfmac_f32_16x16x64_bf16 v[104:107], v[32:35], a[128:135], v2
    v_smfmac_f32_16x16x64_bf16 v[108:111], v[32:35], a[136:143], v2
    s_waitcnt lgkmcnt(0)
    v_smfmac_f32_16x16x64_bf16 v[96:99], v[36:39], a[16:23], v2
    v_smfmac_f32_16x16x64_bf16 v[100:103], v[36:39], a[24:31], v2
    v_smfmac_f32_16x16x64_bf16 v[104:107], v[36:39], a[144:151], v2
    v_smfmac_f32_16x16x64_bf16 v[108:111], v[36:39], a[152:159], v2
    s_nop 4
    v_pk_add_f32 v[96:97], v[96:97], v[98:99]
    v_pk_add_f32 v[100:101], v[100:101], v[102:103]
    v_pk_add_f32 v[104:105], v[104:105], v[106:107]
    v_pk_add_f32 v[108:109], v[108:109], v[110:111]
    v_cvt_pk_bf16_f32 v111, v108, v109
    v_cvt_pk_bf16_f32 v108, v96, v97
    v_cvt_pk_bf16_f32 v110, v100, v101
    v_cvt_pk_bf16_f32 v109, v104, v105
    v_and_or_b32 v108, v108, -2, s41
    buffer_store_dwordx4 v[108:111], v1, s[4:7], s37 offen sc1
    v_smfmac_f32_16x16x64_bf16 v[112:115], v[32:35], v[64:71], v2
    ds_read_b128 v[64:67], v1 offset:36864
    ds_read_b128 v[68:71], v1 offset:37888
    v_smfmac_f32_16x16x64_bf16 v[116:119], v[32:35], v[72:79], v2
    ds_read_b128 v[72:75], v1 offset:38912
    ds_read_b128 v[76:79], v1 offset:39936
    v_smfmac_f32_16x16x64_bf16 v[112:115], v[36:39], v[80:87], v2
    ds_read_b128 v[80:83], v1 offset:53248
    ds_read_b128 v[84:87], v1 offset:54272
    v_smfmac_f32_16x16x64_bf16 v[116:119], v[36:39], v[88:95], v2
    ds_read_b128 v[88:91], v1 offset:55296
    ds_read_b128 v[92:95], v1 offset:56320
    v_smfmac_f32_16x16x64_bf16 v[112:115], v[52:55], v[208:215], v2
    v_smfmac_f32_16x16x64_bf16 v[116:119], v[52:55], v[216:223], v2
    v_smfmac_f32_16x16x64_bf16 v[112:115], v[56:59], v[224:231], v2
    s_waitcnt lgkmcnt(6)
    v_smfmac_f32_16x16x64_bf16 v[112:115], v[40:43], v[64:71], v2
    ds_read_b128 v[64:67], v5 offset:4096
    ds_read_b128 v[68:71], v5 offset:5120
    s_waitcnt lgkmcnt(6)
    v_smfmac_f32_16x16x64_bf16 v[116:119], v[40:43], v[72:79], v2
    ds_read_b128 v[72:75], v5 offset:6144
    ds_read_b128 v[76:79], v5 offset:7168
    v_smfmac_f32_16x16x64_bf16 v[116:119], v[56:59], v[232:239], v2
    v_smfmac_f32_16x16x64_bf16 v[112:115], v[60:63], v[240:247], v2
    v_smfmac_f32_16x16x64_bf16 v[116:119], v[60:63], v[248:255], v2
    s_waitcnt lgkmcnt(6)
    v_smfmac_f32_16x16x64_bf16 v[112:115], v[44:47], v[80:87], v2
    s_waitcnt lgkmcnt(4)
    v_smfmac_f32_16x16x64_bf16 v[116:119], v[44:47], v[88:95], v2
    s_waitcnt lgkmcnt(2)
    v_smfmac_f32_16x16x64_bf16 v[112:115], v[48:51], v[64:71], v2
    s_waitcnt lgkmcnt(0)
    v_smfmac_f32_16x16x64_bf16 v[116:119], v[48:51], v[72:79], v2
    v_mfma_f32_16x16x16_bf16 v[100:103], v[108:109], v[16:17], 0
    v_mfma_f32_16x16x16_bf16 v[104:107], v[110:111], v[16:17], 0
    s_nop 4
    v_add_f32 v112, v112, v114
    v_add_f32 v113, v113, v115
    v_add_f32 v114, v116, v118
    v_add_f32 v115, v117, v119
    v_cvt_pk_bf16_f32 v18, v112, v113
    v_cvt_pk_bf16_f32 v19, v114, v115
    v_and_or_b32 v18, v18, -2, s41
    v_mov_b32 v112, v18
    v_mov_b32 v114, v19
    v_mov_b32 v92, v28
    v_mov_b32 v93, 0
    s_waitcnt vmcnt(3)
    s_barrier
    ds_read_b128 v[32:35], v6 offset:12288
    ds_read_b128 v[36:39], v6 offset:13312
    ds_read_b128 v[40:43], v6 offset:9216
    ds_read_b128 v[44:47], v6 offset:10240
    ds_read_b128 v[48:51], v6 offset:18432
    ds_read_b128 v[52:55], v6 offset:19456
    ds_read_b128 v[56:59], v6 offset:15360
    ds_read_b128 v[60:63], v6 offset:16384
    buffer_load_dwordx4 v[96:99], v1, s[4:7], s38 offen sc1
    s_barrier
    buffer_store_dwordx2 v[18:19], v11, s[4:7], s39 offen sc1
    s_nop 15
    s_nop 15
    buffer_load_dwordx4 v[20:23], v1, s[4:7], s38 offen sc1
    s_waitcnt vmcnt(2)
    v_mfma_f32_16x16x16_bf16 v[80:83], v[96:97], v[16:17], v[100:103]
    v_mfma_f32_16x16x16_bf16 v[84:87], v[98:99], v[16:17], v[104:107]
    v_and_b32 v3, 1, v96
    v_cmp_ne_u32 vcc, s41, v3
    s_nop 4
    v_cvt_pk_bf16_f32 v64, v80, v81
    v_cvt_pk_bf16_f32 v65, v82, v83
    v_cvt_pk_bf16_f32 v66, v84, v85
    v_cvt_pk_bf16_f32 v67, v86, v87
    ds_write_b128 v6, v[64:67] offset:11264
    s_cbranch_vccnz mega_kernel_rf_w1_xslow
mega_kernel_rf_w1_xok:
    s_cmp_eq_u32 s21, 63
    s_cbranch_scc1 mega_kernel_rf_w1_last
    buffer_load_dwordx2 v[116:117], v11, s[4:7], s40 offen sc1
    s_waitcnt lgkmcnt(1)
    v_mfma_f32_16x16x32_bf16 v[80:83], v[32:35], v[64:67], 0
    s_waitcnt lgkmcnt(0)
    s_barrier
    ds_read_b128 v[68:71], v6 offset:8192
    ds_read_b128 v[72:75], v6 offset:17408
    ds_read_b128 v[76:79], v6 offset:14336
    v_mfma_f32_16x16x32_bf16 v[84:87], v[36:39], v[64:67], 0
    v_mfma_f32_16x16x32_bf16 v[88:91], v[64:67], v[64:67], 0
    buffer_load_dwordx2 v[20:21], v11, s[4:7], s40 offen sc1
    s_waitcnt lgkmcnt(2)
    v_mfma_f32_16x16x32_bf16 v[80:83], v[40:43], v[68:71], v[80:83]
    v_mfma_f32_16x16x32_bf16 v[84:87], v[44:47], v[68:71], v[84:87]
    v_mfma_f32_16x16x32_bf16 v[88:91], v[68:71], v[68:71], v[88:91]
    s_waitcnt lgkmcnt(1)
    v_mfma_f32_16x16x32_bf16 v[80:83], v[48:51], v[72:75], v[80:83]
    v_mfma_f32_16x16x32_bf16 v[84:87], v[52:55], v[72:75], v[84:87]
    v_mfma_f32_16x16x32_bf16 v[88:91], v[72:75], v[72:75], v[88:91]
    s_waitcnt lgkmcnt(0)
    v_mfma_f32_16x16x32_bf16 v[80:83], v[56:59], v[76:79], v[80:83]
    v_mfma_f32_16x16x32_bf16 v[84:87], v[60:63], v[76:79], v[84:87]
    v_mfma_f32_16x16x32_bf16 v[88:91], v[76:79], v[76:79], v[88:91]
    v_mfma_f32_32x32x4_2b_bf16 v[32:63], v[14:15], v[14:15], 0
    s_nop 4
    v_max3_f32 v4, v80, v81, v82
    v_max3_f32 v4, v4, v83, v84
    v_max3_f32 v4, v4, v85, v86
    v_max3_f32 v4, v4, v87, v88
    v_max_f32 v90, v4, v89
    v_max_f32 v4, v4, v89
    s_nop 0
    s_nop 0
    v_permlane16_swap_b32 v4, v90
    v_max_f32 v4, v4, v90
    v_max_f32 v90, v4, v90
    s_nop 1
    v_permlane32_swap_b32 v4, v90
    v_max_f32 v4, v4, v90
    v_mul_f32 v4, s34, v4
    v_pk_fma_f32 v[80:81], v[80:81], s[34:35], v[4:5] op_sel_hi:[1,0,0] neg_lo:[0,0,1] neg_hi:[0,0,1]
    v_pk_fma_f32 v[82:83], v[82:83], s[34:35], v[4:5] op_sel_hi:[1,0,0] neg_lo:[0,0,1] neg_hi:[0,0,1]
    v_pk_fma_f32 v[84:85], v[84:85], s[34:35], v[4:5] op_sel_hi:[1,0,0] neg_lo:[0,0,1] neg_hi:[0,0,1]
    v_pk_fma_f32 v[86:87], v[86:87], s[34:35], v[4:5] op_sel_hi:[1,0,0] neg_lo:[0,0,1] neg_hi:[0,0,1]
    v_pk_fma_f32 v[88:89], v[88:89], s[34:35], v[4:5] op_sel_hi:[1,0,0] neg_lo:[0,0,1] neg_hi:[0,0,1]
    v_exp_f32 v80, v80
    v_exp_f32 v81, v81
    v_exp_f32 v82, v82
    v_cvt_pk_bf16_f32 v68, v80, v81
    v_exp_f32 v83, v83
    v_exp_f32 v84, v84
    v_cvt_pk_bf16_f32 v69, v82, v83
    v_exp_f32 v85, v85
    v_exp_f32 v86, v86
    v_cvt_pk_bf16_f32 v70, v84, v85
    v_exp_f32 v87, v87
    v_exp_f32 v88, v88
    v_cvt_pk_bf16_f32 v71, v86, v87
    v_exp_f32 v89, v89
    s_nop 0
    v_mfma_f32_16x16x32_bf16 v[76:79], v[28:31], v[68:71], 0
    v_cvt_pk_bf16_f32 v72, v88, v89
    v_cvt_pk_bf16_f32 v73, v88, v89
    v_mfma_f32_16x16x32_bf16 v[100:103], v[120:123], v[68:71], 0
    s_waitcnt vmcnt(1)
    v_and_b32 v3, 1, v116
    v_cmp_ne_u32 vcc, s41, v3
    v_mfma_f32_16x16x32_bf16 v[104:107], v[124:127], v[68:71], 0
    v_mov_b32 v113, v116
    v_mov_b32 v115, v117
    v_mfma_f32_16x16x16_bf16 v[76:79], v[92:93], v[72:73], v[76:79]
    s_cbranch_vccnz mega_kernel_rf_w1_pv0
mega_kernel_rf_w1_pv2:
    v_mfma_f32_16x16x16_bf16 v[100:103], v[112:113], v[72:73], v[100:103]
    v_mfma_f32_16x16x16_bf16 v[104:107], v[114:115], v[72:73], v[104:107]
    buffer_load_dwordx4 v[120:123], v1, s[4:7], s44 offen
    buffer_load_dwordx4 v[124:127], v1, s[4:7], s44 offen offset:1024
    s_nop 2
    v_rcp_f32 v76, v76
    s_mov_b64 exec, s[28:29]
    v_pk_mul_f32 v[100:101], v[100:101], v[76:77] op_sel_hi:[1,0]
    v_pk_mul_f32 v[102:103], v[102:103], v[76:77] op_sel_hi:[1,0]
    v_pk_mul_f32 v[104:105], v[104:105], v[76:77] op_sel_hi:[1,0]
    v_pk_mul_f32 v[106:107], v[106:107], v[76:77] op_sel_hi:[1,0]
    v_cvt_pk_bf16_f32 v72, v100, v101
    v_cvt_pk_bf16_f32 v73, v102, v103
    v_cvt_pk_bf16_f32 v74, v104, v105
    v_cvt_pk_bf16_f32 v75, v106, v107
    ds_write_b128 v6, v[72:75] offset:20480
    s_mov_b64 exec, -1
    ds_read_b128 v[88:91], v5 offset:20480
    ds_read_b128 v[92:95], v5 offset:21504
    ds_read_b128 v[80:83], v5 offset:22528
    ds_read_b128 v[84:87], v5 offset:23552
    ds_read_b128 v[112:115], v5 offset:36864
    ds_read_b128 v[116:119], v5 offset:37888
    s_waitcnt lgkmcnt(6)
    s_barrier
    ds_read_b128 v[68:71], v6 offset:20480
    ds_read_b128 v[72:75], v6 offset:21504
    ds_read_b128 v[96:99], v5 offset:38912
    ds_read_b128 v[100:103], v5 offset:39936
    ds_read_b128 v[104:107], v5 offset:53248
    ds_read_b128 v[108:111], v5 offset:54272
    s_waitcnt lgkmcnt(5)
    v_smfmac_f32_16x16x64_bf16 v[32:35], v[68:71], v[128:135], v2
    s_add_u32 s21, s21, 1
    v_smfmac_f32_16x16x64_bf16 v[36:39], v[68:71], v[136:143], v2
    s_xor_b32 s38, s38, 1048576
    v_smfmac_f32_16x16x64_bf16 v[40:43], v[68:71], v[144:151], v2
    s_xor_b32 s37, s37, 1048576
    v_smfmac_f32_16x16x64_bf16 v[44:47], v[68:71], v[152:159], v2
    s_xor_b32 s40, s40, 1048576
    s_waitcnt lgkmcnt(4)
    v_smfmac_f32_16x16x64_bf16 v[32:35], v[72:75], v[160:167], v2
    s_xor_b32 s39, s39, 1048576
    v_smfmac_f32_16x16x64_bf16 v[36:39], v[72:75], v[168:175], v2
    s_lshr_b32 s41, s21, 1
    v_smfmac_f32_16x16x64_bf16 v[40:43], v[72:75], v[176:183], v2
    s_and_b32 s41, s41, 1
    v_smfmac_f32_16x16x64_bf16 v[44:47], v[72:75], v[184:191], v2
    s_xor_b32 s41, s41, 1
    v_smfmac_f32_16x16x64_bf16 v[48:51], v[68:71], v[192:199], v2
    s_xor_b32 s35, s35, 16384
    v_smfmac_f32_16x16x64_bf16 v[52:55], v[68:71], v[200:207], v2
    s_xor_b32 s36, s36, 16384
    s_waitcnt lgkmcnt(0)
    v_smfmac_f32_16x16x64_bf16 v[56:59], v[68:71], v[88:95], v2
    ds_read_b128 v[88:91], v5 offset:55296
    ds_read_b128 v[92:95], v5 offset:56320
    v_smfmac_f32_16x16x64_bf16 v[60:63], v[68:71], v[80:87], v2
    s_add_u32 s43, s43, 262144
    v_smfmac_f32_16x16x64_bf16 v[48:51], v[72:75], v[112:119], v2
    s_add_u32 s44, s44, 262144
    v_add_f32 v32, v32, v34
    v_add_f32 v33, v33, v35
    v_cvt_pk_bf16_f32 v32, v32, v33
    v_and_or_b32 v32, v32, -2, s42
    v_smfmac_f32_16x16x64_bf16 v[52:55], v[72:75], v[96:103], v2
    v_add_f32 v36, v36, v38
    v_add_f32 v37, v37, v39
    v_cvt_pk_bf16_f32 v33, v36, v37
    v_smfmac_f32_16x16x64_bf16 v[56:59], v[72:75], v[104:111], v2
    v_add_f32 v40, v40, v42
    v_add_f32 v41, v41, v43
    v_cvt_pk_bf16_f32 v34, v40, v41
    s_waitcnt lgkmcnt(0)
    v_smfmac_f32_16x16x64_bf16 v[60:63], v[72:75], v[88:95], v2
    v_add_f32 v44, v44, v46
    v_add_f32 v45, v45, v47
    v_cvt_pk_bf16_f32 v35, v44, v45
    buffer_store_dwordx4 v[32:35], v8, s[4:7], s46 offen
    v_pk_add_f32 v[48:49], v[48:49], v[50:51]
    v_cvt_pk_bf16_f32 v48, v48, v49
    v_and_or_b32 v48, v48, -2, s42
    v_pk_add_f32 v[52:53], v[52:53], v[54:55]
    v_cvt_pk_bf16_f32 v49, v52, v53
    v_pk_add_f32 v[56:57], v[56:57], v[58:59]
    v_cvt_pk_bf16_f32 v50, v56, v57
    v_pk_add_f32 v[60:61], v[60:61], v[62:63]
    v_cvt_pk_bf16_f32 v51, v60, v61
    buffer_store_dwordx4 v[48:51], v8, s[4:7], s61 offen
    s_waitcnt vmcnt(4)
    v_mov_b32 v20, v64
    v_mov_b32 v21, v65
    v_mov_b32 v22, v66
    v_mov_b32 v23, v67
    s_add_u32 s45, s45, 262144
    s_add_u32 s51, s51, 262144
    v_mfma_f32_32x32x8_bf16 v[96:111], v[14:15], v[14:15], 0
    v_mfma_f32_16x16x16_bf16 v[112:115], v[14:15], v[14:15], 0
    v_mfma_f32_16x16x16_bf16 v[116:119], v[14:15], v[14:15], 0
    ds_read_b128 v[64:67], v1 offset:4096
    ds_read_b128 v[68:71], v1 offset:5120
    ds_read_b128 v[72:75], v1 offset:6144
    ds_read_b128 v[76:79], v1 offset:7168
    ds_read_b128 v[80:83], v1 offset:20480
    ds_read_b128 v[84:87], v1 offset:21504
    ds_read_b128 v[88:91], v1 offset:22528
    ds_read_b128 v[92:95], v1 offset:23552
    v_mov_b32 v58, -1
    v_mov_b32 v59, -1
    s_waitcnt vmcnt(0)
mega_kernel_rf_w1_pc:
    buffer_load_dword v36, v13, s[4:7], s47 offen offset:64 sc1
    buffer_load_dword v37, v13, s[4:7], s47 offen offset:1088 sc1
    buffer_load_dword v38, v13, s[4:7], s47 offen offset:2112 sc1
    buffer_load_dword v39, v13, s[4:7], s47 offen offset:3136 sc1
    buffer_load_dword v40, v13, s[4:7], s25 offen offset:64 sc1
    buffer_load_dword v41, v13, s[4:7], s25 offen offset:1088 sc1
    buffer_load_dword v42, v13, s[4:7], s25 offen offset:2112 sc1
    buffer_load_dword v43, v13, s[4:7], s25 offen offset:3136 sc1
    s_waitcnt vmcnt(4)
    v_mfma_f32_16x16x32_bf16 v[52:55], v[36:39], v[24:27], 0
    v_bitop3_b32 v3, s42, v36, v37 bitop3:0x7e
    v_bitop3_b32 v4, s42, v38, v39 bitop3:0x7e
    s_waitcnt vmcnt(2)
    v_or_b32 v3, v3, v4
    v_bitop3_b32 v4, s42, v40, v41 bitop3:0x7e
    s_waitcnt vmcnt(0)
    v_mfma_f32_16x16x32_bf16 v[52:55], v[40:43], v[24:27], v[52:55]
    v_bitop3_b32 v56, s42, v42, v43 bitop3:0x7e
    v_or3_b32 v3, v3, v4, v56
    v_and_b32 v3, v0, v3
    v_cmp_ne_u32 vcc, 0, v3
    s_cbranch_vccnz mega_kernel_rf_w1_pc
    s_nop 2
    v_cvt_pk_bf16_f32 v56, v52, v53
    v_cvt_pk_bf16_f32 v57, v54, v55
    v_min_u32 v56, -2, v56
    s_mov_b64 exec, s[26:27]
    buffer_store_dwordx2 v[56:57], v9, s[4:7], s35 offen offset:64
    buffer_store_dwordx2 v[58:59], v9, s[4:7], s36 offen offset:64
    s_mov_b64 exec, -1
    s_xor_b32 s42, s42, 1
    s_branch mega_kernel_rf_w1_loop
mega_kernel_rf_w1_last:
    s_add_u32 s45, s45, 262144
    s_add_u32 s51, s51, 262144
    buffer_store_dwordx4 v[64:67], v10, s[4:7], s45 offen offset:64 sc1
    buffer_store_dwordx2 v[18:19], v11, s[4:7], s51 offen offset:2560 sc1
    s_branch mega_kernel_rf_end
mega_kernel_rf_w1_pafail:
    buffer_load_dwordx4 v[40:43], v12, s[4:7], s22 offen sc1
    buffer_load_dwordx4 v[44:47], v12, s[4:7], s22 offen offset:1024 sc1
    s_nop 7
    v_mov_b32 v96, 0
    v_mov_b32 v97, 0
    v_mov_b32 v98, 0
    v_mov_b32 v99, 0
    v_mov_b32 v100, 0
    v_mov_b32 v101, 0
    v_mov_b32 v102, 0
    v_mov_b32 v103, 0
    v_mov_b32 v104, 0
    v_mov_b32 v105, 0
    v_mov_b32 v106, 0
    v_mov_b32 v107, 0
    s_branch mega_kernel_rf_w1_pa
mega_kernel_rf_w1_xslow:
    buffer_load_dwordx4 v[96:99], v1, s[4:7], s38 offen sc1
    s_waitcnt vmcnt(1)
    v_and_b32 v3, 1, v20
    v_cmp_ne_u32 vcc, s41, v3
    s_cbranch_vccz mega_kernel_rf_w1_xgot1
    buffer_load_dwordx4 v[20:23], v1, s[4:7], s38 offen sc1
mega_kernel_rf_w1_px:
    s_waitcnt vmcnt(1)
    v_and_b32 v3, 1, v96
    v_cmp_ne_u32 vcc, s41, v3
    s_cbranch_vccz mega_kernel_rf_w1_xgot0
    buffer_load_dwordx4 v[96:99], v1, s[4:7], s38 offen sc1
    s_waitcnt vmcnt(1)
    v_and_b32 v3, 1, v20
    v_cmp_ne_u32 vcc, s41, v3
    s_cbranch_vccz mega_kernel_rf_w1_xgot1
    buffer_load_dwordx4 v[20:23], v1, s[4:7], s38 offen sc1
    s_branch mega_kernel_rf_w1_px
mega_kernel_rf_w1_xgot0:
    v_mfma_f32_16x16x16_bf16 v[80:83], v[96:97], v[16:17], v[100:103]
    v_mfma_f32_16x16x16_bf16 v[84:87], v[98:99], v[16:17], v[104:107]
    v_and_b32 v3, 1, v96
    v_cmp_ne_u32 vcc, s41, v3
    s_nop 4
    v_cvt_pk_bf16_f32 v64, v80, v81
    v_cvt_pk_bf16_f32 v65, v82, v83
    v_cvt_pk_bf16_f32 v66, v84, v85
    v_cvt_pk_bf16_f32 v67, v86, v87
    ds_write_b128 v6, v[64:67] offset:11264
    s_branch mega_kernel_rf_w1_xok
mega_kernel_rf_w1_xgot1:
    v_mfma_f32_16x16x16_bf16 v[80:83], v[20:21], v[16:17], v[100:103]
    v_mfma_f32_16x16x16_bf16 v[84:87], v[22:23], v[16:17], v[104:107]
    v_and_b32 v3, 1, v20
    v_cmp_ne_u32 vcc, s41, v3
    s_nop 4
    v_cvt_pk_bf16_f32 v64, v80, v81
    v_cvt_pk_bf16_f32 v65, v82, v83
    v_cvt_pk_bf16_f32 v66, v84, v85
    v_cvt_pk_bf16_f32 v67, v86, v87
    ds_write_b128 v6, v[64:67] offset:11264
    s_branch mega_kernel_rf_w1_xok
mega_kernel_rf_w1_pv0:
    s_waitcnt vmcnt(0)
    s_branch mega_kernel_rf_w1_pv1
mega_kernel_rf_w1_pv:
    buffer_load_dwordx2 v[20:21], v11, s[4:7], s40 offen sc1
    s_waitcnt vmcnt(0)
mega_kernel_rf_w1_pv1:
    v_and_b32 v3, 1, v20
    v_cmp_ne_u32 vcc, s41, v3
    v_mov_b32 v113, v20
    v_mov_b32 v115, v21
    s_cbranch_vccnz mega_kernel_rf_w1_pv
    s_branch mega_kernel_rf_w1_pv2
mega_kernel_rf_w2_entry:
    v_mfma_f32_32x32x8_bf16 v[96:111], v[14:15], v[14:15], 0
    v_mfma_f32_16x16x16_bf16 v[112:115], v[14:15], v[14:15], 0
    v_mfma_f32_16x16x16_bf16 v[116:119], v[14:15], v[14:15], 0
    ds_read_b128 v[64:67], v1 offset:8192
    ds_read_b128 v[68:71], v1 offset:9216
    ds_read_b128 v[72:75], v1 offset:10240
    ds_read_b128 v[76:79], v1 offset:11264
    ds_read_b128 v[80:83], v1 offset:24576
    ds_read_b128 v[84:87], v1 offset:25600
    ds_read_b128 v[88:91], v1 offset:26624
    ds_read_b128 v[92:95], v1 offset:27648
    buffer_load_dwordx4 v[120:123], v1, s[4:7], s44 offen
    buffer_load_dwordx4 v[124:127], v1, s[4:7], s44 offen offset:1024
    s_add_u32 s44, s44, 262144
mega_kernel_rf_w2_loop:
    s_add_u32 s22, s35, 4096
    s_waitcnt vmcnt(0)
    buffer_load_dwordx4 v[48:51], v12, s[4:7], s22 offen sc1
    buffer_load_dwordx4 v[52:55], v12, s[4:7], s22 offen offset:1024 sc1
mega_kernel_rf_w2_pa:
    s_waitcnt vmcnt(1)
    ds_write_b128 v6, v[48:51] offset:4096
    s_waitcnt vmcnt(0)
    ds_write_b128 v6, v[52:55] offset:5120
    v_max3_u32 v3, v48, v50, v52
    v_max_u32 v3, v3, v54
    v_cmp_eq_u32 vcc, -1, v3
    v_smfmac_f32_16x16x64_bf16 v[96:99], v[48:51], a[64:71], v2
    v_smfmac_f32_16x16x64_bf16 v[100:103], v[48:51], a[72:79], v2
    v_smfmac_f32_16x16x64_bf16 v[104:107], v[48:51], a[192:199], v2
    s_cbranch_vccnz mega_kernel_rf_w2_pafail
    s_waitcnt lgkmcnt(0)
    s_barrier
    ds_read_b128 v[56:59], v6 offset:6144
    ds_read_b128 v[60:63], v6 offset:7168
    v_smfmac_f32_16x16x64_bf16 v[108:111], v[48:51], a[200:207], v2
    ds_read_b128 v[32:35], v6 offset:0
    v_smfmac_f32_16x16x64_bf16 v[96:99], v[52:55], a[80:87], v2
    ds_read_b128 v[36:39], v6 offset:1024
    v_smfmac_f32_16x16x64_bf16 v[100:103], v[52:55], a[88:95], v2
    ds_read_b128 v[40:43], v6 offset:2048
    v_smfmac_f32_16x16x64_bf16 v[104:107], v[52:55], a[208:215], v2
    ds_read_b128 v[44:47], v6 offset:3072
    v_smfmac_f32_16x16x64_bf16 v[108:111], v[52:55], a[216:223], v2
    buffer_load_dwordx4 v1, s[4:7], s43 offen lds
    s_waitcnt lgkmcnt(5)
    v_smfmac_f32_16x16x64_bf16 v[96:99], v[56:59], a[96:103], v2
    v_smfmac_f32_16x16x64_bf16 v[100:103], v[56:59], a[104:111], v2
    v_smfmac_f32_16x16x64_bf16 v[104:107], v[56:59], a[224:231], v2
    v_smfmac_f32_16x16x64_bf16 v[108:111], v[56:59], a[232:239], v2
    buffer_load_dwordx4 v1, s[4:7], s43 offen offset:1024 lds
    s_waitcnt lgkmcnt(4)
    v_smfmac_f32_16x16x64_bf16 v[96:99], v[60:63], a[112:119], v2
    v_smfmac_f32_16x16x64_bf16 v[100:103], v[60:63], a[120:127], v2
    v_smfmac_f32_16x16x64_bf16 v[104:107], v[60:63], a[240:247], v2
    v_smfmac_f32_16x16x64_bf16 v[108:111], v[60:63], a[248:255], v2
    buffer_store_dwordx4 v[20:23], v10, s[4:7], s45 offen offset:128 sc1
    s_waitcnt lgkmcnt(3)
    v_smfmac_f32_16x16x64_bf16 v[96:99], v[32:35], a[0:7], v2
    v_smfmac_f32_16x16x64_bf16 v[100:103], v[32:35], a[8:15], v2
    v_smfmac_f32_16x16x64_bf16 v[104:107], v[32:35], a[128:135], v2
    v_smfmac_f32_16x16x64_bf16 v[108:111], v[32:35], a[136:143], v2
    buffer_store_dwordx2 v[18:19], v11, s[4:7], s51 offen offset:3072 sc1
    s_waitcnt lgkmcnt(2)
    v_smfmac_f32_16x16x64_bf16 v[96:99], v[36:39], a[16:23], v2
    v_smfmac_f32_16x16x64_bf16 v[100:103], v[36:39], a[24:31], v2
    v_smfmac_f32_16x16x64_bf16 v[104:107], v[36:39], a[144:151], v2
    v_smfmac_f32_16x16x64_bf16 v[108:111], v[36:39], a[152:159], v2
    s_waitcnt lgkmcnt(1)
    v_smfmac_f32_16x16x64_bf16 v[96:99], v[40:43], a[32:39], v2
    v_smfmac_f32_16x16x64_bf16 v[100:103], v[40:43], a[40:47], v2
    v_smfmac_f32_16x16x64_bf16 v[104:107], v[40:43], a[160:167], v2
    v_smfmac_f32_16x16x64_bf16 v[108:111], v[40:43], a[168:175], v2
    s_waitcnt lgkmcnt(0)
    v_smfmac_f32_16x16x64_bf16 v[96:99], v[44:47], a[48:55], v2
    v_smfmac_f32_16x16x64_bf16 v[100:103], v[44:47], a[56:63], v2
    v_smfmac_f32_16x16x64_bf16 v[104:107], v[44:47], a[176:183], v2
    v_smfmac_f32_16x16x64_bf16 v[108:111], v[44:47], a[184:191], v2
    s_nop 4
    v_pk_add_f32 v[96:97], v[96:97], v[98:99]
    v_pk_add_f32 v[100:101], v[100:101], v[102:103]
    v_pk_add_f32 v[104:105], v[104:105], v[106:107]
    v_pk_add_f32 v[108:109], v[108:109], v[110:111]
    v_cvt_pk_bf16_f32 v111, v108, v109
    v_cvt_pk_bf16_f32 v108, v96, v97
    v_cvt_pk_bf16_f32 v110, v100, v101
    v_cvt_pk_bf16_f32 v109, v104, v105
    v_and_or_b32 v108, v108, -2, s41
    buffer_store_dwordx4 v[108:111], v1, s[4:7], s37 offen sc1
    v_smfmac_f32_16x16x64_bf16 v[112:115], v[32:35], v[64:71], v2
    ds_read_b128 v[64:67], v1 offset:40960
    ds_read_b128 v[68:71], v1 offset:41984
    v_smfmac_f32_16x16x64_bf16 v[116:119], v[32:35], v[72:79], v2
    ds_read_b128 v[72:75], v1 offset:43008
    ds_read_b128 v[76:79], v1 offset:44032
    v_smfmac_f32_16x16x64_bf16 v[112:115], v[36:39], v[80:87], v2
    ds_read_b128 v[80:83], v1 offset:57344
    ds_read_b128 v[84:87], v1 offset:58368
    v_smfmac_f32_16x16x64_bf16 v[116:119], v[36:39], v[88:95], v2
    ds_read_b128 v[88:91], v1 offset:59392
    ds_read_b128 v[92:95], v1 offset:60416
    v_smfmac_f32_16x16x64_bf16 v[112:115], v[52:55], v[208:215], v2
    v_smfmac_f32_16x16x64_bf16 v[116:119], v[52:55], v[216:223], v2
    v_smfmac_f32_16x16x64_bf16 v[112:115], v[56:59], v[224:231], v2
    s_waitcnt lgkmcnt(6)
    v_smfmac_f32_16x16x64_bf16 v[112:115], v[40:43], v[64:71], v2
    ds_read_b128 v[64:67], v5 offset:8192
    ds_read_b128 v[68:71], v5 offset:9216
    s_waitcnt lgkmcnt(6)
    v_smfmac_f32_16x16x64_bf16 v[116:119], v[40:43], v[72:79], v2
    ds_read_b128 v[72:75], v5 offset:10240
    ds_read_b128 v[76:79], v5 offset:11264
    v_smfmac_f32_16x16x64_bf16 v[116:119], v[56:59], v[232:239], v2
    v_smfmac_f32_16x16x64_bf16 v[112:115], v[60:63], v[240:247], v2
    v_smfmac_f32_16x16x64_bf16 v[116:119], v[60:63], v[248:255], v2
    s_waitcnt lgkmcnt(6)
    v_smfmac_f32_16x16x64_bf16 v[112:115], v[44:47], v[80:87], v2
    s_waitcnt lgkmcnt(4)
    v_smfmac_f32_16x16x64_bf16 v[116:119], v[44:47], v[88:95], v2
    s_waitcnt lgkmcnt(2)
    v_smfmac_f32_16x16x64_bf16 v[112:115], v[48:51], v[64:71], v2
    s_waitcnt lgkmcnt(0)
    v_smfmac_f32_16x16x64_bf16 v[116:119], v[48:51], v[72:79], v2
    v_mfma_f32_16x16x16_bf16 v[100:103], v[108:109], v[16:17], 0
    v_mfma_f32_16x16x16_bf16 v[104:107], v[110:111], v[16:17], 0
    s_nop 4
    v_add_f32 v112, v112, v114
    v_add_f32 v113, v113, v115
    v_add_f32 v114, v116, v118
    v_add_f32 v115, v117, v119
    v_cvt_pk_bf16_f32 v18, v112, v113
    v_cvt_pk_bf16_f32 v19, v114, v115
    v_and_or_b32 v18, v18, -2, s41
    v_mov_b32 v112, v18
    v_mov_b32 v114, v19
    v_mov_b32 v92, v28
    v_mov_b32 v93, 0
    s_waitcnt vmcnt(3)
    s_barrier
    ds_read_b128 v[32:35], v6 offset:15360
    ds_read_b128 v[36:39], v6 offset:16384
    ds_read_b128 v[40:43], v6 offset:18432
    ds_read_b128 v[44:47], v6 offset:19456
    ds_read_b128 v[48:51], v6 offset:9216
    ds_read_b128 v[52:55], v6 offset:10240
    ds_read_b128 v[56:59], v6 offset:12288
    ds_read_b128 v[60:63], v6 offset:13312
    buffer_load_dwordx4 v[96:99], v1, s[4:7], s38 offen sc1
    s_barrier
    buffer_store_dwordx2 v[18:19], v11, s[4:7], s39 offen sc1
    s_nop 15
    s_nop 15
    buffer_load_dwordx4 v[20:23], v1, s[4:7], s38 offen sc1
    s_waitcnt vmcnt(2)
    v_mfma_f32_16x16x16_bf16 v[80:83], v[96:97], v[16:17], v[100:103]
    v_mfma_f32_16x16x16_bf16 v[84:87], v[98:99], v[16:17], v[104:107]
    v_and_b32 v3, 1, v96
    v_cmp_ne_u32 vcc, s41, v3
    s_nop 4
    v_cvt_pk_bf16_f32 v64, v80, v81
    v_cvt_pk_bf16_f32 v65, v82, v83
    v_cvt_pk_bf16_f32 v66, v84, v85
    v_cvt_pk_bf16_f32 v67, v86, v87
    ds_write_b128 v6, v[64:67] offset:14336
    s_cbranch_vccnz mega_kernel_rf_w2_xslow
mega_kernel_rf_w2_xok:
    s_cmp_eq_u32 s21, 63
    s_cbranch_scc1 mega_kernel_rf_w2_last
    buffer_load_dwordx2 v[116:117], v11, s[4:7], s40 offen sc1
    s_waitcnt lgkmcnt(1)
    v_mfma_f32_16x16x32_bf16 v[80:83], v[32:35], v[64:67], 0
    s_waitcnt lgkmcnt(0)
    s_barrier
    ds_read_b128 v[68:71], v6 offset:17408
    ds_read_b128 v[72:75], v6 offset:8192
    ds_read_b128 v[76:79], v6 offset:11264
    v_mfma_f32_16x16x32_bf16 v[84:87], v[36:39], v[64:67], 0
    v_mfma_f32_16x16x32_bf16 v[88:91], v[64:67], v[64:67], 0
    buffer_load_dwordx2 v[20:21], v11, s[4:7], s40 offen sc1
    s_waitcnt lgkmcnt(2)
    v_mfma_f32_16x16x32_bf16 v[80:83], v[40:43], v[68:71], v[80:83]
    v_mfma_f32_16x16x32_bf16 v[84:87], v[44:47], v[68:71], v[84:87]
    v_mfma_f32_16x16x32_bf16 v[88:91], v[68:71], v[68:71], v[88:91]
    s_waitcnt lgkmcnt(1)
    v_mfma_f32_16x16x32_bf16 v[80:83], v[48:51], v[72:75], v[80:83]
    v_mfma_f32_16x16x32_bf16 v[84:87], v[52:55], v[72:75], v[84:87]
    v_mfma_f32_16x16x32_bf16 v[88:91], v[72:75], v[72:75], v[88:91]
    s_waitcnt lgkmcnt(0)
    v_mfma_f32_16x16x32_bf16 v[80:83], v[56:59], v[76:79], v[80:83]
    v_mfma_f32_16x16x32_bf16 v[84:87], v[60:63], v[76:79], v[84:87]
    v_mfma_f32_16x16x32_bf16 v[88:91], v[76:79], v[76:79], v[88:91]
    v_mfma_f32_32x32x4_2b_bf16 v[32:63], v[14:15], v[14:15], 0
    s_nop 4
    v_max3_f32 v4, v80, v81, v82
    v_max3_f32 v4, v4, v83, v84
    v_max3_f32 v4, v4, v85, v86
    v_max3_f32 v4, v4, v87, v88
    v_max_f32 v90, v4, v89
    v_max_f32 v4, v4, v89
    s_nop 0
    s_nop 0
    v_permlane16_swap_b32 v4, v90
    v_max_f32 v4, v4, v90
    v_max_f32 v90, v4, v90
    s_nop 1
    v_permlane32_swap_b32 v4, v90
    v_max_f32 v4, v4, v90
    v_mul_f32 v4, s34, v4
    v_pk_fma_f32 v[80:81], v[80:81], s[34:35], v[4:5] op_sel_hi:[1,0,0] neg_lo:[0,0,1] neg_hi:[0,0,1]
    v_pk_fma_f32 v[82:83], v[82:83], s[34:35], v[4:5] op_sel_hi:[1,0,0] neg_lo:[0,0,1] neg_hi:[0,0,1]
    v_pk_fma_f32 v[84:85], v[84:85], s[34:35], v[4:5] op_sel_hi:[1,0,0] neg_lo:[0,0,1] neg_hi:[0,0,1]
    v_pk_fma_f32 v[86:87], v[86:87], s[34:35], v[4:5] op_sel_hi:[1,0,0] neg_lo:[0,0,1] neg_hi:[0,0,1]
    v_pk_fma_f32 v[88:89], v[88:89], s[34:35], v[4:5] op_sel_hi:[1,0,0] neg_lo:[0,0,1] neg_hi:[0,0,1]
    v_exp_f32 v80, v80
    v_exp_f32 v81, v81
    v_exp_f32 v82, v82
    v_cvt_pk_bf16_f32 v68, v80, v81
    v_exp_f32 v83, v83
    v_exp_f32 v84, v84
    v_cvt_pk_bf16_f32 v69, v82, v83
    v_exp_f32 v85, v85
    v_exp_f32 v86, v86
    v_cvt_pk_bf16_f32 v70, v84, v85
    v_exp_f32 v87, v87
    v_exp_f32 v88, v88
    v_cvt_pk_bf16_f32 v71, v86, v87
    v_exp_f32 v89, v89
    s_nop 0
    v_mfma_f32_16x16x32_bf16 v[76:79], v[28:31], v[68:71], 0
    v_cvt_pk_bf16_f32 v72, v88, v89
    v_cvt_pk_bf16_f32 v73, v88, v89
    v_mfma_f32_16x16x32_bf16 v[100:103], v[120:123], v[68:71], 0
    s_waitcnt vmcnt(1)
    v_and_b32 v3, 1, v116
    v_cmp_ne_u32 vcc, s41, v3
    v_mfma_f32_16x16x32_bf16 v[104:107], v[124:127], v[68:71], 0
    v_mov_b32 v113, v116
    v_mov_b32 v115, v117
    v_mfma_f32_16x16x16_bf16 v[76:79], v[92:93], v[72:73], v[76:79]
    s_cbranch_vccnz mega_kernel_rf_w2_pv0
mega_kernel_rf_w2_pv2:
    v_mfma_f32_16x16x16_bf16 v[100:103], v[112:113], v[72:73], v[100:103]
    v_mfma_f32_16x16x16_bf16 v[104:107], v[114:115], v[72:73], v[104:107]
    buffer_load_dwordx4 v[120:123], v1, s[4:7], s44 offen
    buffer_load_dwordx4 v[124:127], v1, s[4:7], s44 offen offset:1024
    s_nop 2
    v_rcp_f32 v76, v76
    s_mov_b64 exec, s[28:29]
    v_pk_mul_f32 v[100:101], v[100:101], v[76:77] op_sel_hi:[1,0]
    v_pk_mul_f32 v[102:103], v[102:103], v[76:77] op_sel_hi:[1,0]
    v_pk_mul_f32 v[104:105], v[104:105], v[76:77] op_sel_hi:[1,0]
    v_pk_mul_f32 v[106:107], v[106:107], v[76:77] op_sel_hi:[1,0]
    v_cvt_pk_bf16_f32 v72, v100, v101
    v_cvt_pk_bf16_f32 v73, v102, v103
    v_cvt_pk_bf16_f32 v74, v104, v105
    v_cvt_pk_bf16_f32 v75, v106, v107
    ds_write_b128 v6, v[72:75] offset:21472
    s_mov_b64 exec, -1
    ds_read_b128 v[88:91], v5 offset:24576
    ds_read_b128 v[92:95], v5 offset:25600
    ds_read_b128 v[80:83], v5 offset:26624
    ds_read_b128 v[84:87], v5 offset:27648
    ds_read_b128 v[112:115], v5 offset:40960
    ds_read_b128 v[116:119], v5 offset:41984
    s_waitcnt lgkmcnt(6)
    s_barrier
    ds_read_b128 v[68:71], v6 offset:20480
    ds_read_b128 v[72:75], v6 offset:21504
    ds_read_b128 v[96:99], v5 offset:43008
    ds_read_b128 v[100:103], v5 offset:44032
    ds_read_b128 v[104:107], v5 offset:57344
    ds_read_b128 v[108:111], v5 offset:58368
    s_waitcnt lgkmcnt(5)
    v_smfmac_f32_16x16x64_bf16 v[32:35], v[68:71], v[128:135], v2
    s_add_u32 s21, s21, 1
    v_smfmac_f32_16x16x64_bf16 v[36:39], v[68:71], v[136:143], v2
    s_xor_b32 s38, s38, 1048576
    v_smfmac_f32_16x16x64_bf16 v[40:43], v[68:71], v[144:151], v2
    s_xor_b32 s37, s37, 1048576
    v_smfmac_f32_16x16x64_bf16 v[44:47], v[68:71], v[152:159], v2
    s_xor_b32 s40, s40, 1048576
    s_waitcnt lgkmcnt(4)
    v_smfmac_f32_16x16x64_bf16 v[32:35], v[72:75], v[160:167], v2
    s_xor_b32 s39, s39, 1048576
    v_smfmac_f32_16x16x64_bf16 v[36:39], v[72:75], v[168:175], v2
    s_lshr_b32 s41, s21, 1
    v_smfmac_f32_16x16x64_bf16 v[40:43], v[72:75], v[176:183], v2
    s_and_b32 s41, s41, 1
    v_smfmac_f32_16x16x64_bf16 v[44:47], v[72:75], v[184:191], v2
    s_xor_b32 s41, s41, 1
    v_smfmac_f32_16x16x64_bf16 v[48:51], v[68:71], v[192:199], v2
    s_xor_b32 s35, s35, 16384
    v_smfmac_f32_16x16x64_bf16 v[52:55], v[68:71], v[200:207], v2
    s_xor_b32 s36, s36, 16384
    s_waitcnt lgkmcnt(0)
    v_smfmac_f32_16x16x64_bf16 v[56:59], v[68:71], v[88:95], v2
    ds_read_b128 v[88:91], v5 offset:59392
    ds_read_b128 v[92:95], v5 offset:60416
    v_smfmac_f32_16x16x64_bf16 v[60:63], v[68:71], v[80:87], v2
    s_add_u32 s43, s43, 262144
    v_smfmac_f32_16x16x64_bf16 v[48:51], v[72:75], v[112:119], v2
    s_add_u32 s44, s44, 262144
    v_add_f32 v32, v32, v34
    v_add_f32 v33, v33, v35
    v_cvt_pk_bf16_f32 v32, v32, v33
    v_and_or_b32 v32, v32, -2, s42
    v_smfmac_f32_16x16x64_bf16 v[52:55], v[72:75], v[96:103], v2
    v_add_f32 v36, v36, v38
    v_add_f32 v37, v37, v39
    v_cvt_pk_bf16_f32 v33, v36, v37
    v_smfmac_f32_16x16x64_bf16 v[56:59], v[72:75], v[104:111], v2
    v_add_f32 v40, v40, v42
    v_add_f32 v41, v41, v43
    v_cvt_pk_bf16_f32 v34, v40, v41
    s_waitcnt lgkmcnt(0)
    v_smfmac_f32_16x16x64_bf16 v[60:63], v[72:75], v[88:95], v2
    v_add_f32 v44, v44, v46
    v_add_f32 v45, v45, v47
    v_cvt_pk_bf16_f32 v35, v44, v45
    buffer_store_dwordx4 v[32:35], v8, s[4:7], s46 offen
    v_pk_add_f32 v[48:49], v[48:49], v[50:51]
    v_cvt_pk_bf16_f32 v48, v48, v49
    v_and_or_b32 v48, v48, -2, s42
    v_pk_add_f32 v[52:53], v[52:53], v[54:55]
    v_cvt_pk_bf16_f32 v49, v52, v53
    v_pk_add_f32 v[56:57], v[56:57], v[58:59]
    v_cvt_pk_bf16_f32 v50, v56, v57
    v_pk_add_f32 v[60:61], v[60:61], v[62:63]
    v_cvt_pk_bf16_f32 v51, v60, v61
    buffer_store_dwordx4 v[48:51], v8, s[4:7], s61 offen
    s_waitcnt vmcnt(4)
    v_mov_b32 v20, v64
    v_mov_b32 v21, v65
    v_mov_b32 v22, v66
    v_mov_b32 v23, v67
    s_add_u32 s45, s45, 262144
    s_add_u32 s51, s51, 262144
    v_mfma_f32_32x32x8_bf16 v[96:111], v[14:15], v[14:15], 0
    v_mfma_f32_16x16x16_bf16 v[112:115], v[14:15], v[14:15], 0
    v_mfma_f32_16x16x16_bf16 v[116:119], v[14:15], v[14:15], 0
    ds_read_b128 v[64:67], v1 offset:8192
    ds_read_b128 v[68:71], v1 offset:9216
    ds_read_b128 v[72:75], v1 offset:10240
    ds_read_b128 v[76:79], v1 offset:11264
    ds_read_b128 v[80:83], v1 offset:24576
    ds_read_b128 v[84:87], v1 offset:25600
    ds_read_b128 v[88:91], v1 offset:26624
    ds_read_b128 v[92:95], v1 offset:27648
    v_mov_b32 v58, -1
    v_mov_b32 v59, -1
    s_waitcnt vmcnt(0)
mega_kernel_rf_w2_pc:
    buffer_load_dword v36, v13, s[4:7], s47 offen offset:128 sc1
    buffer_load_dword v37, v13, s[4:7], s47 offen offset:1152 sc1
    buffer_load_dword v38, v13, s[4:7], s47 offen offset:2176 sc1
    buffer_load_dword v39, v13, s[4:7], s47 offen offset:3200 sc1
    buffer_load_dword v40, v13, s[4:7], s25 offen offset:128 sc1
    buffer_load_dword v41, v13, s[4:7], s25 offen offset:1152 sc1
    buffer_load_dword v42, v13, s[4:7], s25 offen offset:2176 sc1
    buffer_load_dword v43, v13, s[4:7], s25 offen offset:3200 sc1
    s_waitcnt vmcnt(4)
    v_mfma_f32_16x16x32_bf16 v[52:55], v[36:39], v[24:27], 0
    v_bitop3_b32 v3, s42, v36, v37 bitop3:0x7e
    v_bitop3_b32 v4, s42, v38, v39 bitop3:0x7e
    s_waitcnt vmcnt(2)
    v_or_b32 v3, v3, v4
    v_bitop3_b32 v4, s42, v40, v41 bitop3:0x7e
    s_waitcnt vmcnt(0)
    v_mfma_f32_16x16x32_bf16 v[52:55], v[40:43], v[24:27], v[52:55]
    v_bitop3_b32 v56, s42, v42, v43 bitop3:0x7e
    v_or3_b32 v3, v3, v4, v56
    v_and_b32 v3, v0, v3
    v_cmp_ne_u32 vcc, 0, v3
    s_cbranch_vccnz mega_kernel_rf_w2_pc
    s_nop 2
    v_cvt_pk_bf16_f32 v56, v52, v53
    v_cvt_pk_bf16_f32 v57, v54, v55
    v_min_u32 v56, -2, v56
    s_mov_b64 exec, s[26:27]
    buffer_store_dwordx2 v[56:57], v9, s[4:7], s35 offen offset:128
    buffer_store_dwordx2 v[58:59], v9, s[4:7], s36 offen offset:128
    s_mov_b64 exec, -1
    s_xor_b32 s42, s42, 1
    s_branch mega_kernel_rf_w2_loop
mega_kernel_rf_w2_last:
    s_add_u32 s45, s45, 262144
    s_add_u32 s51, s51, 262144
    buffer_store_dwordx4 v[64:67], v10, s[4:7], s45 offen offset:128 sc1
    buffer_store_dwordx2 v[18:19], v11, s[4:7], s51 offen offset:3072 sc1
    s_branch mega_kernel_rf_end
mega_kernel_rf_w2_pafail:
    buffer_load_dwordx4 v[48:51], v12, s[4:7], s22 offen sc1
    buffer_load_dwordx4 v[52:55], v12, s[4:7], s22 offen offset:1024 sc1
    s_nop 7
    v_mov_b32 v96, 0
    v_mov_b32 v97, 0
    v_mov_b32 v98, 0
    v_mov_b32 v99, 0
    v_mov_b32 v100, 0
    v_mov_b32 v101, 0
    v_mov_b32 v102, 0
    v_mov_b32 v103, 0
    v_mov_b32 v104, 0
    v_mov_b32 v105, 0
    v_mov_b32 v106, 0
    v_mov_b32 v107, 0
    s_branch mega_kernel_rf_w2_pa
mega_kernel_rf_w2_xslow:
    buffer_load_dwordx4 v[96:99], v1, s[4:7], s38 offen sc1
    s_waitcnt vmcnt(1)
    v_and_b32 v3, 1, v20
    v_cmp_ne_u32 vcc, s41, v3
    s_cbranch_vccz mega_kernel_rf_w2_xgot1
    buffer_load_dwordx4 v[20:23], v1, s[4:7], s38 offen sc1
mega_kernel_rf_w2_px:
    s_waitcnt vmcnt(1)
    v_and_b32 v3, 1, v96
    v_cmp_ne_u32 vcc, s41, v3
    s_cbranch_vccz mega_kernel_rf_w2_xgot0
    buffer_load_dwordx4 v[96:99], v1, s[4:7], s38 offen sc1
    s_waitcnt vmcnt(1)
    v_and_b32 v3, 1, v20
    v_cmp_ne_u32 vcc, s41, v3
    s_cbranch_vccz mega_kernel_rf_w2_xgot1
    buffer_load_dwordx4 v[20:23], v1, s[4:7], s38 offen sc1
    s_branch mega_kernel_rf_w2_px
mega_kernel_rf_w2_xgot0:
    v_mfma_f32_16x16x16_bf16 v[80:83], v[96:97], v[16:17], v[100:103]
    v_mfma_f32_16x16x16_bf16 v[84:87], v[98:99], v[16:17], v[104:107]
    v_and_b32 v3, 1, v96
    v_cmp_ne_u32 vcc, s41, v3
    s_nop 4
    v_cvt_pk_bf16_f32 v64, v80, v81
    v_cvt_pk_bf16_f32 v65, v82, v83
    v_cvt_pk_bf16_f32 v66, v84, v85
    v_cvt_pk_bf16_f32 v67, v86, v87
    ds_write_b128 v6, v[64:67] offset:14336
    s_branch mega_kernel_rf_w2_xok
mega_kernel_rf_w2_xgot1:
    v_mfma_f32_16x16x16_bf16 v[80:83], v[20:21], v[16:17], v[100:103]
    v_mfma_f32_16x16x16_bf16 v[84:87], v[22:23], v[16:17], v[104:107]
    v_and_b32 v3, 1, v20
    v_cmp_ne_u32 vcc, s41, v3
    s_nop 4
    v_cvt_pk_bf16_f32 v64, v80, v81
    v_cvt_pk_bf16_f32 v65, v82, v83
    v_cvt_pk_bf16_f32 v66, v84, v85
    v_cvt_pk_bf16_f32 v67, v86, v87
    ds_write_b128 v6, v[64:67] offset:14336
    s_branch mega_kernel_rf_w2_xok
mega_kernel_rf_w2_pv0:
    s_waitcnt vmcnt(0)
    s_branch mega_kernel_rf_w2_pv1
mega_kernel_rf_w2_pv:
    buffer_load_dwordx2 v[20:21], v11, s[4:7], s40 offen sc1
    s_waitcnt vmcnt(0)
mega_kernel_rf_w2_pv1:
    v_and_b32 v3, 1, v20
    v_cmp_ne_u32 vcc, s41, v3
    v_mov_b32 v113, v20
    v_mov_b32 v115, v21
    s_cbranch_vccnz mega_kernel_rf_w2_pv
    s_branch mega_kernel_rf_w2_pv2
mega_kernel_rf_w3_entry:
    v_mfma_f32_32x32x8_bf16 v[96:111], v[14:15], v[14:15], 0
    v_mfma_f32_16x16x16_bf16 v[112:115], v[14:15], v[14:15], 0
    v_mfma_f32_16x16x16_bf16 v[116:119], v[14:15], v[14:15], 0
    ds_read_b128 v[64:67], v1 offset:12288
    ds_read_b128 v[68:71], v1 offset:13312
    ds_read_b128 v[72:75], v1 offset:14336
    ds_read_b128 v[76:79], v1 offset:15360
    ds_read_b128 v[80:83], v1 offset:28672
    ds_read_b128 v[84:87], v1 offset:29696
    ds_read_b128 v[88:91], v1 offset:30720
    ds_read_b128 v[92:95], v1 offset:31744
    buffer_load_dwordx4 v[120:123], v1, s[4:7], s44 offen
    buffer_load_dwordx4 v[124:127], v1, s[4:7], s44 offen offset:1024
    s_add_u32 s44, s44, 262144
mega_kernel_rf_w3_loop:
    s_add_u32 s22, s35, 6144
    s_waitcnt vmcnt(0)
    buffer_load_dwordx4 v[56:59], v12, s[4:7], s22 offen sc1
    buffer_load_dwordx4 v[60:63], v12, s[4:7], s22 offen offset:1024 sc1
mega_kernel_rf_w3_pa:
    s_waitcnt vmcnt(1)
    ds_write_b128 v6, v[56:59] offset:6144
    s_waitcnt vmcnt(0)
    ds_write_b128 v6, v[60:63] offset:7168
    v_max3_u32 v3, v56, v58, v60
    v_max_u32 v3, v3, v62
    v_cmp_eq_u32 vcc, -1, v3
    v_smfmac_f32_16x16x64_bf16 v[96:99], v[56:59], a[96:103], v2
    v_smfmac_f32_16x16x64_bf16 v[100:103], v[56:59], a[104:111], v2
    v_smfmac_f32_16x16x64_bf16 v[104:107], v[56:59], a[224:231], v2
    s_cbranch_vccnz mega_kernel_rf_w3_pafail
    s_waitcnt lgkmcnt(0)
    s_barrier
    ds_read_b128 v[32:35], v6 offset:0
    ds_read_b128 v[36:39], v6 offset:1024
    v_smfmac_f32_16x16x64_bf16 v[108:111], v[56:59], a[232:239], v2
    ds_read_b128 v[40:43], v6 offset:2048
    v_smfmac_f32_16x16x64_bf16 v[96:99], v[60:63], a[112:119], v2
    ds_read_b128 v[44:47], v6 offset:3072
    v_smfmac_f32_16x16x64_bf16 v[100:103], v[60:63], a[120:127], v2
    ds_read_b128 v[48:51], v6 offset:4096
    v_smfmac_f32_16x16x64_bf16 v[104:107], v[60:63], a[240:247], v2
    ds_read_b128 v[52:55], v6 offset:5120
    v_smfmac_f32_16x16x64_bf16 v[108:111], v[60:63], a[248:255], v2
    buffer_load_dwordx4 v1, s[4:7], s43 offen lds
    s_waitcnt lgkmcnt(5)
    v_smfmac_f32_16x16x64_bf16 v[96:99], v[32:35], a[0:7], v2
    v_smfmac_f32_16x16x64_bf16 v[100:103], v[32:35], a[8:15], v2
    v_smfmac_f32_16x16x64_bf16 v[104:107], v[32:35], a[128:135], v2
    v_smfmac_f32_16x16x64_bf16 v[108:111], v[32:35], a[136:143], v2
    buffer_load_dwordx4 v1, s[4:7], s43 offen offset:1024 lds
    s_waitcnt lgkmcnt(4)
    v_smfmac_f32_16x16x64_bf16 v[96:99], v[36:39], a[16:23], v2
    v_smfmac_f32_16x16x64_bf16 v[100:103], v[36:39], a[24:31], v2
    v_smfmac_f32_16x16x64_bf16 v[104:107], v[36:39], a[144:151], v2
    v_smfmac_f32_16x16x64_bf16 v[108:111], v[36:39], a[152:159], v2
    buffer_store_dwordx4 v[20:23], v10, s[4:7], s45 offen offset:192 sc1
    s_waitcnt lgkmcnt(3)
    v_smfmac_f32_16x16x64_bf16 v[96:99], v[40:43], a[32:39], v2
    v_smfmac_f32_16x16x64_bf16 v[100:103], v[40:43], a[40:47], v2
    v_smfmac_f32_16x16x64_bf16 v[104:107], v[40:43], a[160:167], v2
    v_smfmac_f32_16x16x64_bf16 v[108:111], v[40:43], a[168:175], v2
    buffer_store_dwordx2 v[18:19], v11, s[4:7], s51 offen offset:3584 sc1
    s_waitcnt lgkmcnt(2)
    v_smfmac_f32_16x16x64_bf16 v[96:99], v[44:47], a[48:55], v2
    v_smfmac_f32_16x16x64_bf16 v[100:103], v[44:47], a[56:63], v2
    v_smfmac_f32_16x16x64_bf16 v[104:107], v[44:47], a[176:183], v2
    v_smfmac_f32_16x16x64_bf16 v[108:111], v[44:47], a[184:191], v2
    buffer_load_dword v4, v7, s[4:7], 0 offen sc1
    s_waitcnt lgkmcnt(1)
    v_smfmac_f32_16x16x64_bf16 v[96:99], v[48:51], a[64:71], v2
    v_smfmac_f32_16x16x64_bf16 v[100:103], v[48:51], a[72:79], v2
    v_smfmac_f32_16x16x64_bf16 v[104:107], v[48:51], a[192:199], v2
    v_smfmac_f32_16x16x64_bf16 v[108:111], v[48:51], a[200:207], v2
    s_waitcnt lgkmcnt(0)
    v_smfmac_f32_16x16x64_bf16 v[96:99], v[52:55], a[80:87], v2
    v_smfmac_f32_16x16x64_bf16 v[100:103], v[52:55], a[88:95], v2
    v_smfmac_f32_16x16x64_bf16 v[104:107], v[52:55], a[208:215], v2
    v_smfmac_f32_16x16x64_bf16 v[108:111], v[52:55], a[216:223], v2
    s_nop 4
    v_pk_add_f32 v[96:97], v[96:97], v[98:99]
    v_pk_add_f32 v[100:101], v[100:101], v[102:103]
    v_pk_add_f32 v[104:105], v[104:105], v[106:107]
    v_pk_add_f32 v[108:109], v[108:109], v[110:111]
    v_cvt_pk_bf16_f32 v111, v108, v109
    v_cvt_pk_bf16_f32 v108, v96, v97
    v_cvt_pk_bf16_f32 v110, v100, v101
    v_cvt_pk_bf16_f32 v109, v104, v105
    v_and_or_b32 v108, v108, -2, s41
    buffer_store_dwordx4 v[108:111], v1, s[4:7], s37 offen sc1
    v_smfmac_f32_16x16x64_bf16 v[112:115], v[32:35], v[64:71], v2
    ds_read_b128 v[64:67], v1 offset:45056
    ds_read_b128 v[68:71], v1 offset:46080
    v_smfmac_f32_16x16x64_bf16 v[116:119], v[32:35], v[72:79], v2
    ds_read_b128 v[72:75], v1 offset:47104
    ds_read_b128 v[76:79], v1 offset:48128
    v_smfmac_f32_16x16x64_bf16 v[112:115], v[36:39], v[80:87], v2
    ds_read_b128 v[80:83], v1 offset:61440
    ds_read_b128 v[84:87], v1 offset:62464
    v_smfmac_f32_16x16x64_bf16 v[116:119], v[36:39], v[88:95], v2
    ds_read_b128 v[88:91], v1 offset:63488
    ds_read_b128 v[92:95], v1 offset:64512
    v_smfmac_f32_16x16x64_bf16 v[112:115], v[52:55], v[208:215], v2
    v_smfmac_f32_16x16x64_bf16 v[116:119], v[52:55], v[216:223], v2
    v_smfmac_f32_16x16x64_bf16 v[112:115], v[56:59], v[224:231], v2
    s_waitcnt lgkmcnt(6)
    v_smfmac_f32_16x16x64_bf16 v[112:115], v[40:43], v[64:71], v2
    ds_read_b128 v[64:67], v5 offset:12288
    ds_read_b128 v[68:71], v5 offset:13312
    s_waitcnt lgkmcnt(6)
    v_smfmac_f32_16x16x64_bf16 v[116:119], v[40:43], v[72:79], v2
    ds_read_b128 v[72:75], v5 offset:14336
    ds_read_b128 v[76:79], v5 offset:15360
    v_smfmac_f32_16x16x64_bf16 v[116:119], v[56:59], v[232:239], v2
    v_smfmac_f32_16x16x64_bf16 v[112:115], v[60:63], v[240:247], v2
    v_smfmac_f32_16x16x64_bf16 v[116:119], v[60:63], v[248:255], v2
    s_waitcnt lgkmcnt(6)
    v_smfmac_f32_16x16x64_bf16 v[112:115], v[44:47], v[80:87], v2
    s_waitcnt lgkmcnt(4)
    v_smfmac_f32_16x16x64_bf16 v[116:119], v[44:47], v[88:95], v2
    s_waitcnt lgkmcnt(2)
    v_smfmac_f32_16x16x64_bf16 v[112:115], v[48:51], v[64:71], v2
    s_waitcnt lgkmcnt(0)
    v_smfmac_f32_16x16x64_bf16 v[116:119], v[48:51], v[72:79], v2
    v_mfma_f32_16x16x16_bf16 v[100:103], v[108:109], v[16:17], 0
    v_mfma_f32_16x16x16_bf16 v[104:107], v[110:111], v[16:17], 0
    s_nop 4
    v_add_f32 v112, v112, v114
    v_add_f32 v113, v113, v115
    v_add_f32 v114, v116, v118
    v_add_f32 v115, v117, v119
    v_cvt_pk_bf16_f32 v18, v112, v113
    v_cvt_pk_bf16_f32 v19, v114, v115
    v_and_or_b32 v18, v18, -2, s41
    v_mov_b32 v112, v18
    v_mov_b32 v114, v19
    v_mov_b32 v92, v28
    v_mov_b32 v93, 0
    s_waitcnt vmcnt(4)
    s_barrier
    ds_read_b128 v[32:35], v6 offset:18432
    ds_read_b128 v[36:39], v6 offset:19456
    ds_read_b128 v[40:43], v6 offset:15360
    ds_read_b128 v[44:47], v6 offset:16384
    ds_read_b128 v[48:51], v6 offset:12288
    ds_read_b128 v[52:55], v6 offset:13312
    ds_read_b128 v[56:59], v6 offset:9216
    ds_read_b128 v[60:63], v6 offset:10240
    buffer_load_dwordx4 v[96:99], v1, s[4:7], s38 offen sc1
    s_barrier
    buffer_store_dwordx2 v[18:19], v11, s[4:7], s39 offen sc1
    s_nop 15
    s_nop 15
    buffer_load_dwordx4 v[20:23], v1, s[4:7], s38 offen sc1
    s_add_u32 s22, s21, 4
    s_cmp_gt_u32 s50, s22
    s_cbranch_scc1 mega_kernel_rf_w3_kvs
    s_waitcnt vmcnt(4)
    v_readlane_b32 s50, v4, 0
    v_readlane_b32 s22, v4, 2
    v_readlane_b32 s23, v4, 1
    v_readlane_b32 s24, v4, 3
    s_nop 3
    s_min_u32 s50, s50, s22
    s_min_u32 s23, s23, s24
    s_lshl_b32 s50, s50, 1
    s_lshl_b32 s23, s23, 1
    s_add_u32 s23, s23, 1
    s_min_u32 s50, s50, s23
mega_kernel_rf_kvb1:
    s_add_u32 s22, s21, 1
    s_min_u32 s22, s22, 63
    s_cmp_gt_u32 s50, s22
    s_cbranch_scc1 mega_kernel_rf_kvd1
    buffer_load_dword v4, v7, s[4:7], 0 offen sc1
    s_waitcnt vmcnt(0)
    v_readlane_b32 s50, v4, 0
    v_readlane_b32 s22, v4, 2
    v_readlane_b32 s23, v4, 1
    v_readlane_b32 s24, v4, 3
    s_nop 3
    s_min_u32 s50, s50, s22
    s_min_u32 s23, s23, s24
    s_lshl_b32 s50, s50, 1
    s_lshl_b32 s23, s23, 1
    s_add_u32 s23, s23, 1
    s_min_u32 s50, s50, s23
    s_branch mega_kernel_rf_kvb1
mega_kernel_rf_kvd1:
mega_kernel_rf_w3_kvs:
    s_waitcnt vmcnt(2)
    v_mfma_f32_16x16x16_bf16 v[80:83], v[96:97], v[16:17], v[100:103]
    v_mfma_f32_16x16x16_bf16 v[84:87], v[98:99], v[16:17], v[104:107]
    v_and_b32 v3, 1, v96
    v_cmp_ne_u32 vcc, s41, v3
    s_nop 4
    v_cvt_pk_bf16_f32 v64, v80, v81
    v_cvt_pk_bf16_f32 v65, v82, v83
    v_cvt_pk_bf16_f32 v66, v84, v85
    v_cvt_pk_bf16_f32 v67, v86, v87
    ds_write_b128 v6, v[64:67] offset:17408
    s_cbranch_vccnz mega_kernel_rf_w3_xslow
mega_kernel_rf_w3_xok:
    s_cmp_eq_u32 s21, 63
    s_cbranch_scc1 mega_kernel_rf_w3_last
    buffer_load_dwordx2 v[116:117], v11, s[4:7], s40 offen sc1
    s_waitcnt lgkmcnt(1)
    v_mfma_f32_16x16x32_bf16 v[80:83], v[32:35], v[64:67], 0
    s_waitcnt lgkmcnt(0)
    s_barrier
    ds_read_b128 v[68:71], v6 offset:14336
    ds_read_b128 v[72:75], v6 offset:11264
    ds_read_b128 v[76:79], v6 offset:8192
    v_mfma_f32_16x16x32_bf16 v[84:87], v[36:39], v[64:67], 0
    v_mfma_f32_16x16x32_bf16 v[88:91], v[64:67], v[64:67], 0
    buffer_load_dwordx2 v[20:21], v11, s[4:7], s40 offen sc1
    s_waitcnt lgkmcnt(2)
    v_mfma_f32_16x16x32_bf16 v[80:83], v[40:43], v[68:71], v[80:83]
    v_mfma_f32_16x16x32_bf16 v[84:87], v[44:47], v[68:71], v[84:87]
    v_mfma_f32_16x16x32_bf16 v[88:91], v[68:71], v[68:71], v[88:91]
    s_waitcnt lgkmcnt(1)
    v_mfma_f32_16x16x32_bf16 v[80:83], v[48:51], v[72:75], v[80:83]
    v_mfma_f32_16x16x32_bf16 v[84:87], v[52:55], v[72:75], v[84:87]
    v_mfma_f32_16x16x32_bf16 v[88:91], v[72:75], v[72:75], v[88:91]
    s_waitcnt lgkmcnt(0)
    v_mfma_f32_16x16x32_bf16 v[80:83], v[56:59], v[76:79], v[80:83]
    v_mfma_f32_16x16x32_bf16 v[84:87], v[60:63], v[76:79], v[84:87]
    v_mfma_f32_16x16x32_bf16 v[88:91], v[76:79], v[76:79], v[88:91]
    v_mfma_f32_32x32x4_2b_bf16 v[32:63], v[14:15], v[14:15], 0
    s_nop 4
    v_max3_f32 v4, v80, v81, v82
    v_max3_f32 v4, v4, v83, v84
    v_max3_f32 v4, v4, v85, v86
    v_max3_f32 v4, v4, v87, v88
    v_max_f32 v90, v4, v89
    v_max_f32 v4, v4, v89
    s_nop 0
    s_nop 0
    v_permlane16_swap_b32 v4, v90
    v_max_f32 v4, v4, v90
    v_max_f32 v90, v4, v90
    s_nop 1
    v_permlane32_swap_b32 v4, v90
    v_max_f32 v4, v4, v90
    v_mul_f32 v4, s34, v4
    v_pk_fma_f32 v[80:81], v[80:81], s[34:35], v[4:5] op_sel_hi:[1,0,0] neg_lo:[0,0,1] neg_hi:[0,0,1]
    v_pk_fma_f32 v[82:83], v[82:83], s[34:35], v[4:5] op_sel_hi:[1,0,0] neg_lo:[0,0,1] neg_hi:[0,0,1]
    v_pk_fma_f32 v[84:85], v[84:85], s[34:35], v[4:5] op_sel_hi:[1,0,0] neg_lo:[0,0,1] neg_hi:[0,0,1]
    v_pk_fma_f32 v[86:87], v[86:87], s[34:35], v[4:5] op_sel_hi:[1,0,0] neg_lo:[0,0,1] neg_hi:[0,0,1]
    v_pk_fma_f32 v[88:89], v[88:89], s[34:35], v[4:5] op_sel_hi:[1,0,0] neg_lo:[0,0,1] neg_hi:[0,0,1]
    v_exp_f32 v80, v80
    v_exp_f32 v81, v81
    v_exp_f32 v82, v82
    v_cvt_pk_bf16_f32 v68, v80, v81
    v_exp_f32 v83, v83
    v_exp_f32 v84, v84
    v_cvt_pk_bf16_f32 v69, v82, v83
    v_exp_f32 v85, v85
    v_exp_f32 v86, v86
    v_cvt_pk_bf16_f32 v70, v84, v85
    v_exp_f32 v87, v87
    v_exp_f32 v88, v88
    v_cvt_pk_bf16_f32 v71, v86, v87
    v_exp_f32 v89, v89
    s_nop 0
    v_mfma_f32_16x16x32_bf16 v[76:79], v[28:31], v[68:71], 0
    v_cvt_pk_bf16_f32 v72, v88, v89
    v_cvt_pk_bf16_f32 v73, v88, v89
    v_mfma_f32_16x16x32_bf16 v[100:103], v[120:123], v[68:71], 0
    s_waitcnt vmcnt(1)
    v_and_b32 v3, 1, v116
    v_cmp_ne_u32 vcc, s41, v3
    v_mfma_f32_16x16x32_bf16 v[104:107], v[124:127], v[68:71], 0
    v_mov_b32 v113, v116
    v_mov_b32 v115, v117
    v_mfma_f32_16x16x16_bf16 v[76:79], v[92:93], v[72:73], v[76:79]
    s_cbranch_vccnz mega_kernel_rf_w3_pv0
mega_kernel_rf_w3_pv2:
    v_mfma_f32_16x16x16_bf16 v[100:103], v[112:113], v[72:73], v[100:103]
    v_mfma_f32_16x16x16_bf16 v[104:107], v[114:115], v[72:73], v[104:107]
    buffer_load_dwordx4 v[120:123], v1, s[4:7], s44 offen
    buffer_load_dwordx4 v[124:127], v1, s[4:7], s44 offen offset:1024
    s_nop 2
    v_rcp_f32 v76, v76
    s_mov_b64 exec, s[28:29]
    v_pk_mul_f32 v[100:101], v[100:101], v[76:77] op_sel_hi:[1,0]
    v_pk_mul_f32 v[102:103], v[102:103], v[76:77] op_sel_hi:[1,0]
    v_pk_mul_f32 v[104:105], v[104:105], v[76:77] op_sel_hi:[1,0]
    v_pk_mul_f32 v[106:107], v[106:107], v[76:77] op_sel_hi:[1,0]
    v_cvt_pk_bf16_f32 v72, v100, v101
    v_cvt_pk_bf16_f32 v73, v102, v103
    v_cvt_pk_bf16_f32 v74, v104, v105
    v_cvt_pk_bf16_f32 v75, v106, v107
    ds_write_b128 v6, v[72:75] offset:21504
    s_mov_b64 exec, -1
    ds_read_b128 v[88:91], v5 offset:28672
    ds_read_b128 v[92:95], v5 offset:29696
    ds_read_b128 v[80:83], v5 offset:30720
    ds_read_b128 v[84:87], v5 offset:31744
    ds_read_b128 v[112:115], v5 offset:45056
    ds_read_b128 v[116:119], v5 offset:46080
    s_waitcnt lgkmcnt(6)
    s_barrier
    ds_read_b128 v[68:71], v6 offset:20480
    ds_read_b128 v[72:75], v6 offset:21504
    ds_read_b128 v[96:99], v5 offset:47104
    ds_read_b128 v[100:103], v5 offset:48128
    ds_read_b128 v[104:107], v5 offset:61440
    ds_read_b128 v[108:111], v5 offset:62464
    s_waitcnt lgkmcnt(5)
    v_smfmac_f32_16x16x64_bf16 v[32:35], v[68:71], v[128:135], v2
    s_add_u32 s21, s21, 1
    v_smfmac_f32_16x16x64_bf16 v[36:39], v[68:71], v[136:143], v2
    s_xor_b32 s38, s38, 1048576
    v_smfmac_f32_16x16x64_bf16 v[40:43], v[68:71], v[144:151], v2
    s_xor_b32 s37, s37, 1048576
    v_smfmac_f32_16x16x64_bf16 v[44:47], v[68:71], v[152:159], v2
    s_xor_b32 s40, s40, 1048576
    s_waitcnt lgkmcnt(4)
    v_smfmac_f32_16x16x64_bf16 v[32:35], v[72:75], v[160:167], v2
    s_xor_b32 s39, s39, 1048576
    v_smfmac_f32_16x16x64_bf16 v[36:39], v[72:75], v[168:175], v2
    s_lshr_b32 s41, s21, 1
    v_smfmac_f32_16x16x64_bf16 v[40:43], v[72:75], v[176:183], v2
    s_and_b32 s41, s41, 1
    v_smfmac_f32_16x16x64_bf16 v[44:47], v[72:75], v[184:191], v2
    s_xor_b32 s41, s41, 1
    v_smfmac_f32_16x16x64_bf16 v[48:51], v[68:71], v[192:199], v2
    s_xor_b32 s35, s35, 16384
    v_smfmac_f32_16x16x64_bf16 v[52:55], v[68:71], v[200:207], v2
    s_xor_b32 s36, s36, 16384
    s_waitcnt lgkmcnt(0)
    v_smfmac_f32_16x16x64_bf16 v[56:59], v[68:71], v[88:95], v2
    ds_read_b128 v[88:91], v5 offset:63488
    ds_read_b128 v[92:95], v5 offset:64512
    v_smfmac_f32_16x16x64_bf16 v[60:63], v[68:71], v[80:87], v2
    s_add_u32 s43, s43, 262144
    v_smfmac_f32_16x16x64_bf16 v[48:51], v[72:75], v[112:119], v2
    s_add_u32 s44, s44, 262144
    v_add_f32 v32, v32, v34
    v_add_f32 v33, v33, v35
    v_cvt_pk_bf16_f32 v32, v32, v33
    v_and_or_b32 v32, v32, -2, s42
    v_smfmac_f32_16x16x64_bf16 v[52:55], v[72:75], v[96:103], v2
    v_add_f32 v36, v36, v38
    v_add_f32 v37, v37, v39
    v_cvt_pk_bf16_f32 v33, v36, v37
    v_smfmac_f32_16x16x64_bf16 v[56:59], v[72:75], v[104:111], v2
    v_add_f32 v40, v40, v42
    v_add_f32 v41, v41, v43
    v_cvt_pk_bf16_f32 v34, v40, v41
    s_waitcnt lgkmcnt(0)
    v_smfmac_f32_16x16x64_bf16 v[60:63], v[72:75], v[88:95], v2
    v_add_f32 v44, v44, v46
    v_add_f32 v45, v45, v47
    v_cvt_pk_bf16_f32 v35, v44, v45
    buffer_store_dwordx4 v[32:35], v8, s[4:7], s46 offen
    v_pk_add_f32 v[48:49], v[48:49], v[50:51]
    v_cvt_pk_bf16_f32 v48, v48, v49
    v_and_or_b32 v48, v48, -2, s42
    v_pk_add_f32 v[52:53], v[52:53], v[54:55]
    v_cvt_pk_bf16_f32 v49, v52, v53
    v_pk_add_f32 v[56:57], v[56:57], v[58:59]
    v_cvt_pk_bf16_f32 v50, v56, v57
    v_pk_add_f32 v[60:61], v[60:61], v[62:63]
    v_cvt_pk_bf16_f32 v51, v60, v61
    buffer_store_dwordx4 v[48:51], v8, s[4:7], s61 offen
    s_waitcnt vmcnt(4)
    v_mov_b32 v20, v64
    v_mov_b32 v21, v65
    v_mov_b32 v22, v66
    v_mov_b32 v23, v67
    s_add_u32 s45, s45, 262144
    s_add_u32 s51, s51, 262144
    v_mfma_f32_32x32x8_bf16 v[96:111], v[14:15], v[14:15], 0
    v_mfma_f32_16x16x16_bf16 v[112:115], v[14:15], v[14:15], 0
    v_mfma_f32_16x16x16_bf16 v[116:119], v[14:15], v[14:15], 0
    ds_read_b128 v[64:67], v1 offset:12288
    ds_read_b128 v[68:71], v1 offset:13312
    ds_read_b128 v[72:75], v1 offset:14336
    ds_read_b128 v[76:79], v1 offset:15360
    ds_read_b128 v[80:83], v1 offset:28672
    ds_read_b128 v[84:87], v1 offset:29696
    ds_read_b128 v[88:91], v1 offset:30720
    ds_read_b128 v[92:95], v1 offset:31744
    v_mov_b32 v58, -1
    v_mov_b32 v59, -1
    s_waitcnt vmcnt(0)
mega_kernel_rf_w3_pc:
    buffer_load_dword v36, v13, s[4:7], s47 offen offset:192 sc1
    buffer_load_dword v37, v13, s[4:7], s47 offen offset:1216 sc1
    buffer_load_dword v38, v13, s[4:7], s47 offen offset:2240 sc1
    buffer_load_dword v39, v13, s[4:7], s47 offen offset:3264 sc1
    buffer_load_dword v40, v13, s[4:7], s25 offen offset:192 sc1
    buffer_load_dword v41, v13, s[4:7], s25 offen offset:1216 sc1
    buffer_load_dword v42, v13, s[4:7], s25 offen offset:2240 sc1
    buffer_load_dword v43, v13, s[4:7], s25 offen offset:3264 sc1
    s_waitcnt vmcnt(4)
    v_mfma_f32_16x16x32_bf16 v[52:55], v[36:39], v[24:27], 0
    v_bitop3_b32 v3, s42, v36, v37 bitop3:0x7e
    v_bitop3_b32 v4, s42, v38, v39 bitop3:0x7e
    s_waitcnt vmcnt(2)
    v_or_b32 v3, v3, v4
    v_bitop3_b32 v4, s42, v40, v41 bitop3:0x7e
    s_waitcnt vmcnt(0)
    v_mfma_f32_16x16x32_bf16 v[52:55], v[40:43], v[24:27], v[52:55]
    v_bitop3_b32 v56, s42, v42, v43 bitop3:0x7e
    v_or3_b32 v3, v3, v4, v56
    v_and_b32 v3, v0, v3
    v_cmp_ne_u32 vcc, 0, v3
    s_cbranch_vccnz mega_kernel_rf_w3_pc
    s_nop 2
    v_cvt_pk_bf16_f32 v56, v52, v53
    v_cvt_pk_bf16_f32 v57, v54, v55
    v_min_u32 v56, -2, v56
    s_mov_b64 exec, s[26:27]
    buffer_store_dwordx2 v[56:57], v9, s[4:7], s35 offen offset:192
    buffer_store_dwordx2 v[58:59], v9, s[4:7], s36 offen offset:192
    s_mov_b64 exec, -1
    s_xor_b32 s42, s42, 1
    s_branch mega_kernel_rf_w3_loop
mega_kernel_rf_w3_last:
    s_add_u32 s45, s45, 262144
    s_add_u32 s51, s51, 262144
    buffer_store_dwordx4 v[64:67], v10, s[4:7], s45 offen offset:192 sc1
    buffer_store_dwordx2 v[18:19], v11, s[4:7], s51 offen offset:3584 sc1
    s_branch mega_kernel_rf_end
mega_kernel_rf_w3_pafail:
    buffer_load_dwordx4 v[56:59], v12, s[4:7], s22 offen sc1
    buffer_load_dwordx4 v[60:63], v12, s[4:7], s22 offen offset:1024 sc1
    s_nop 7
    v_mov_b32 v96, 0
    v_mov_b32 v97, 0
    v_mov_b32 v98, 0
    v_mov_b32 v99, 0
    v_mov_b32 v100, 0
    v_mov_b32 v101, 0
    v_mov_b32 v102, 0
    v_mov_b32 v103, 0
    v_mov_b32 v104, 0
    v_mov_b32 v105, 0
    v_mov_b32 v106, 0
    v_mov_b32 v107, 0
    s_branch mega_kernel_rf_w3_pa
mega_kernel_rf_w3_xslow:
    buffer_load_dwordx4 v[96:99], v1, s[4:7], s38 offen sc1
    s_waitcnt vmcnt(1)
    v_and_b32 v3, 1, v20
    v_cmp_ne_u32 vcc, s41, v3
    s_cbranch_vccz mega_kernel_rf_w3_xgot1
    buffer_load_dwordx4 v[20:23], v1, s[4:7], s38 offen sc1
mega_kernel_rf_w3_px:
    s_waitcnt vmcnt(1)
    v_and_b32 v3, 1, v96
    v_cmp_ne_u32 vcc, s41, v3
    s_cbranch_vccz mega_kernel_rf_w3_xgot0
    buffer_load_dwordx4 v[96:99], v1, s[4:7], s38 offen sc1
    s_waitcnt vmcnt(1)
    v_and_b32 v3, 1, v20
    v_cmp_ne_u32 vcc, s41, v3
    s_cbranch_vccz mega_kernel_rf_w3_xgot1
    buffer_load_dwordx4 v[20:23], v1, s[4:7], s38 offen sc1
    s_branch mega_kernel_rf_w3_px
mega_kernel_rf_w3_xgot0:
    v_mfma_f32_16x16x16_bf16 v[80:83], v[96:97], v[16:17], v[100:103]
    v_mfma_f32_16x16x16_bf16 v[84:87], v[98:99], v[16:17], v[104:107]
    v_and_b32 v3, 1, v96
    v_cmp_ne_u32 vcc, s41, v3
    s_nop 4
    v_cvt_pk_bf16_f32 v64, v80, v81
    v_cvt_pk_bf16_f32 v65, v82, v83
    v_cvt_pk_bf16_f32 v66, v84, v85
    v_cvt_pk_bf16_f32 v67, v86, v87
    ds_write_b128 v6, v[64:67] offset:17408
    s_branch mega_kernel_rf_w3_xok
mega_kernel_rf_w3_xgot1:
    v_mfma_f32_16x16x16_bf16 v[80:83], v[20:21], v[16:17], v[100:103]
    v_mfma_f32_16x16x16_bf16 v[84:87], v[22:23], v[16:17], v[104:107]
    v_and_b32 v3, 1, v20
    v_cmp_ne_u32 vcc, s41, v3
    s_nop 4
    v_cvt_pk_bf16_f32 v64, v80, v81
    v_cvt_pk_bf16_f32 v65, v82, v83
    v_cvt_pk_bf16_f32 v66, v84, v85
    v_cvt_pk_bf16_f32 v67, v86, v87
    ds_write_b128 v6, v[64:67] offset:17408
    s_branch mega_kernel_rf_w3_xok
mega_kernel_rf_w3_pv0:
    s_waitcnt vmcnt(0)
    s_branch mega_kernel_rf_w3_pv1
mega_kernel_rf_w3_pv:
    buffer_load_dwordx2 v[20:21], v11, s[4:7], s40 offen sc1
    s_waitcnt vmcnt(0)
mega_kernel_rf_w3_pv1:
    v_and_b32 v3, 1, v20
    v_cmp_ne_u32 vcc, s41, v3
    v_mov_b32 v113, v20
    v_mov_b32 v115, v21
    s_cbranch_vccnz mega_kernel_rf_w3_pv
    s_branch mega_kernel_rf_w3_pv2
mega_kernel_rf_end:
    s_mov_b64 exec, -1
    v_mov_b32 v3, 64
    s_waitcnt vmcnt(0)
    s_barrier
    s_cmp_lg_u32 s20, 0
    s_cbranch_scc1 mega_kernel_rf_end2
    buffer_store_dword v3, v7, s[4:7], 0 offen sc1
mega_kernel_rf_end2:
    s_waitcnt vmcnt(0)
    s_endpgm
mega_kernel_recs:
    s_load_dwordx2 s[4:5], s[0:1], 96
    s_load_dwordx2 s[12:13], s[0:1], 88
    s_load_dwordx2 s[50:51], s[0:1], 16
    s_load_dwordx2 s[52:53], s[0:1], 24
    s_load_dwordx2 s[54:55], s[0:1], 32
    s_load_dwordx2 s[56:57], s[0:1], 40
    s_load_dwordx2 s[58:59], s[0:1], 8
    v_lshrrev_b32 v3, 6, v0
    v_and_b32 v40, 63, v0
    v_readfirstlane_b32 s20, v3
    v_lshrrev_b32 v41, 4, v40
    v_and_b32 v42, 15, v40
    v_lshlrev_b32 v1, 4, v40
    s_mov_b32 s49, 0
    s_waitcnt lgkmcnt(0)
    s_mov_b32 s6, 268435456
    s_mov_b32 s7, 0x00020000
    s_mov_b32 s14, 256
    s_mov_b32 s15, 0x00020000
    s_mov_b32 s10, 8388608
    s_mov_b32 s11, 0x00020000
    s_mov_b32 s26, 0x00030003
    s_mov_b32 s27, 0x00030003
    s_mov_b32 s28, 0xcccccccc
    s_mov_b32 s29, 0xcccccccc
    s_mov_b32 s32, 0x33333333
    s_mov_b32 s33, 0x33333333
    s_mov_b32 s34, 0x3e0293ee
    s_lshl_b32 s22, s20, 2
    v_xor_b32 v3, s22, v42
    v_lshlrev_b32 v3, 4, v3
    v_lshl_add_u32 v4, v41, 4, s20
    v_lshl_add_u32 v44, v4, 13, v3
    s_lshl_b32 s22, s30, 22
    s_lshl_b32 s23, s31, 8
    s_add_u32 s22, s22, s23
    v_add_u32 v44, s22, v44
    s_lshr_b32 s22, s20, 1
    s_lshl_b32 s22, s22, 5
    s_and_b32 s23, s20, 1
    s_lshl_b32 s23, s23, 2
    s_add_u32 s22, s22, s23
    s_lshl_b32 s23, s31, 7
    s_add_u32 s22, s22, s23
    v_add_u32 v4, s22, v41
    v_lshl_add_u32 v45, v4, 11, v3
    s_lshl_b32 s22, s30, 10
    v_add_u32 v45, s22, v45
    s_lshl_b32 s48, s20, 10
    s_mov_b32 s8, s50
    s_mov_b32 s9, s51
    s_add_u32 m0, s48, 0
    s_mov_b32 s22, 0
    buffer_load_dwordx4 v44, s[8:11], s22 offen  lds
    s_add_u32 m0, s48, 4096
    s_mov_b32 s22, 32768
    buffer_load_dwordx4 v44, s[8:11], s22 offen  lds
    s_add_u32 m0, s48, 8192
    s_mov_b32 s22, 65536
    buffer_load_dwordx4 v44, s[8:11], s22 offen  lds
    s_add_u32 m0, s48, 12288
    s_mov_b32 s22, 98304
    buffer_load_dwordx4 v44, s[8:11], s22 offen  lds
    s_add_u32 m0, s48, 16384
    s_mov_b32 s22, 524288
    buffer_load_dwordx4 v44, s[8:11], s22 offen  lds
    s_add_u32 m0, s48, 20480
    s_mov_b32 s22, 557056
    buffer_load_dwordx4 v44, s[8:11], s22 offen  lds
    s_add_u32 m0, s48, 24576
    s_mov_b32 s22, 589824
    buffer_load_dwordx4 v44, s[8:11], s22 offen  lds
    s_add_u32 m0, s48, 28672
    s_mov_b32 s22, 622592
    buffer_load_dwordx4 v44, s[8:11], s22 offen  lds
    s_add_u32 m0, s48, 32768
    s_mov_b32 s22, 1048576
    buffer_load_dwordx4 v44, s[8:11], s22 offen  lds
    s_add_u32 m0, s48, 36864
    s_mov_b32 s22, 1081344
    buffer_load_dwordx4 v44, s[8:11], s22 offen  lds
    s_add_u32 m0, s48, 40960
    s_mov_b32 s22, 1114112
    buffer_load_dwordx4 v44, s[8:11], s22 offen  lds
    s_add_u32 m0, s48, 45056
    s_mov_b32 s22, 1146880
    buffer_load_dwordx4 v44, s[8:11], s22 offen  lds
    s_add_u32 m0, s48, 49152
    s_mov_b32 s22, 1572864
    buffer_load_dwordx4 v44, s[8:11], s22 offen  lds
    s_add_u32 m0, s48, 53248
    s_mov_b32 s22, 1605632
    buffer_load_dwordx4 v44, s[8:11], s22 offen  lds
    s_add_u32 m0, s48, 57344
    s_mov_b32 s22, 1638400
    buffer_load_dwordx4 v44, s[8:11], s22 offen  lds
    s_add_u32 m0, s48, 61440
    s_mov_b32 s22, 1671168
    buffer_load_dwordx4 v44, s[8:11], s22 offen  lds
    s_add_u32 m0, s48, 65536
    s_mov_b32 s22, 2097152
    buffer_load_dwordx4 v44, s[8:11], s22 offen  lds
    s_add_u32 m0, s48, 69632
    s_mov_b32 s22, 2129920
    buffer_load_dwordx4 v44, s[8:11], s22 offen  lds
    s_add_u32 m0, s48, 73728
    s_mov_b32 s22, 2162688
    buffer_load_dwordx4 v44, s[8:11], s22 offen  lds
    s_add_u32 m0, s48, 77824
    s_mov_b32 s22, 2195456
    buffer_load_dwordx4 v44, s[8:11], s22 offen  lds
    s_add_u32 m0, s48, 81920
    s_mov_b32 s22, 2621440
    buffer_load_dwordx4 v44, s[8:11], s22 offen  lds
    s_add_u32 m0, s48, 86016
    s_mov_b32 s22, 2654208
    buffer_load_dwordx4 v44, s[8:11], s22 offen  lds
    s_add_u32 m0, s48, 90112
    s_mov_b32 s22, 2686976
    buffer_load_dwordx4 v44, s[8:11], s22 offen  lds
    s_add_u32 m0, s48, 94208
    s_mov_b32 s22, 2719744
    buffer_load_dwordx4 v44, s[8:11], s22 offen  lds
    s_add_u32 m0, s48, 98304
    s_mov_b32 s22, 3145728
    buffer_load_dwordx4 v44, s[8:11], s22 offen  lds
    s_add_u32 m0, s48, 102400
    s_mov_b32 s22, 3178496
    buffer_load_dwordx4 v44, s[8:11], s22 offen  lds
    s_add_u32 m0, s48, 106496
    s_mov_b32 s22, 3211264
    buffer_load_dwordx4 v44, s[8:11], s22 offen  lds
    s_add_u32 m0, s48, 110592
    s_mov_b32 s22, 3244032
    buffer_load_dwordx4 v44, s[8:11], s22 offen  lds
    s_add_u32 m0, s48, 114688
    s_mov_b32 s22, 3670016
    buffer_load_dwordx4 v44, s[8:11], s22 offen  lds
    s_add_u32 m0, s48, 118784
    s_mov_b32 s22, 3702784
    buffer_load_dwordx4 v44, s[8:11], s22 offen  lds
    s_add_u32 m0, s48, 122880
    s_mov_b32 s22, 3735552
    buffer_load_dwordx4 v44, s[8:11], s22 offen  lds
    s_add_u32 m0, s48, 126976
    s_mov_b32 s22, 3768320
    buffer_load_dwordx4 v44, s[8:11], s22 offen  lds
    s_lshl_b32 s22, s30, 5
    s_add_u32 s22, s22, s31
    s_lshl_b32 s38, s22, 14
    s_xor_b32 s22, s22, 32
    s_lshl_b32 s37, s22, 14
    s_add_u32 s38, s38, 67108864
    s_add_u32 s37, s37, 67108864
    s_lshl_b32 s46, s30, 18
    s_add_u32 s46, s46, 70254592
    s_lshl_b32 s22, s31, 13
    s_add_u32 s47, s46, s22
    s_lshl_b32 s22, s20, 16
    s_add_u32 s46, s46, s22
    s_lshl_b32 s22, s31, 8
    s_add_u32 s46, s46, s22
    s_add_u32 s61, s46, 32768
    s_add_u32 s25, s47, 4096
    s_lshl_b32 s35, s30, 13
    s_add_u32 s35, s35, 69206016
    v_lshrrev_b32 v53, 2, v42
    v_lshlrev_b32 v53, 1, v53
    v_and_b32 v54, 1, v42
    v_add_u32 v55, v53, v54
    v_mov_b32 v14, 0
    v_mov_b32 v15, 0
    v_mov_b32 v2, 0x4444
    v_mov_b32 v3, 0xeeee
    v_cndmask_b32 v2, v2, v3, s[28:29]
    s_lshl_b32 s22, s20, 12
    v_add_u32 v32, s22, v1
    v_add_u32 v33, 0x10000, v32
    v_add_u32 v5, 0x10000, v1
    v_add_u32 v6, 131072, v1
    v_and_b32 v3, 3, v42
    v_bfe_u32 v43, v40, 1, 1
    v_lshlrev_b32 v7, 13, v43
    v_and_b32 v43, 1, v40
    v_lshl_add_u32 v7, v43, 7, v7
    s_lshl_b32 s22, s31, 8
    s_add_u32 s23, s22, 71311360
    v_add_u32 v7, s23, v7
    s_cmp_lg_u32 s20, 0
    s_cbranch_scc1 mega_kernel_rs_flk
    s_lshl_b32 s23, s30, 7
    s_add_u32 s22, s22, s23
    s_add_u32 s22, s22, 71327744
    v_bfrev_b32 v7, 1
    v_writelane_b32 v7, s22, 0
mega_kernel_rs_flk:
    v_lshlrev_b32 v11, 3, v40
    v_lshlrev_b32 v10, 8, v55
    v_lshl_add_u32 v10, v41, 4, v10
    v_lshlrev_b32 v8, 13, v41
    v_lshl_add_u32 v8, v42, 4, v8
    v_lshrrev_b32 v9, 1, v41
    v_lshlrev_b32 v9, 5, v9
    v_and_b32 v4, 1, v42
    v_lshl_add_u32 v9, v4, 4, v9
    v_and_b32 v4, 1, v41
    v_lshl_add_u32 v9, v4, 3, v9
    s_lshl_b32 s22, s31, 8
    v_add_u32 v9, s22, v9
    v_lshrrev_b32 v4, 2, v42
    v_lshlrev_b32 v12, 8, v4
    v_lshl_add_u32 v12, v41, 6, v12
    v_lshl_add_u32 v12, v3, 4, v12
    v_lshlrev_b32 v13, 8, v41
    v_lshl_add_u32 v13, v42, 2, v13
    v_cmp_eq_u32 vcc, 0, v3
    v_mov_b32 v28, 0x3f803f80
    v_mov_b32 v29, 0x3f803f80
    v_cndmask_b32 v34, 0, 1, vcc
    v_mov_b32 v30, 0x3f803f80
    v_mov_b32 v31, 0x3f803f80
    v_and_b32 v49, 1, v42
    v_lshlrev_b32 v49, 4, v49
    v_mov_b32 v50, 0x3f80
    v_lshlrev_b32 v50, v49, v50
    v_lshrrev_b32 v51, 2, v42
    v_cmp_eq_u32 vcc, v51, v41
    v_mov_b32 v24, v50
    v_cndmask_b32 v52, 0, v50, s[28:29]
    v_cndmask_b32 v53, 0, v50, s[32:33]
    v_cndmask_b32 v16, 0, v52, vcc
    v_cndmask_b32 v17, 0, v53, vcc
    v_mov_b32 v25, v50
    v_mov_b32 v26, v50
    v_mov_b32 v27, v50
    v_bfe_u32 v60, v40, 3, 1
    v_bfe_u32 v49, v40, 2, 1
    v_and_b32 v50, 1, v41
    v_lshrrev_b32 v51, 1, v41
    v_lshlrev_b32 v52, 3, v60
    v_lshl_add_u32 v52, v50, 2, v52
    v_lshl_add_u32 v53, v51, 4, v52
    v_add_u32 v53, v53, v49
    v_and_b32 v54, 3, v40
    s_lshl_b32 s22, s20, 2
    v_add_u32 v55, s22, v54
    v_xor_b32 v55, v55, v52
    v_lshlrev_b32 v55, 4, v55
    v_lshl_add_u32 v46, v53, 8, v55
    v_lshlrev_b32 v55, 4, v52
    v_lshl_add_u32 v55, v54, 3, v55
    v_lshl_add_u32 v47, v53, 8, v55
    s_waitcnt vmcnt(28)
    s_barrier
    v_add_u32 v48, 0, v46
    ds_read_b64_tr_b16 a[0:1], v48 offset:0
    ds_read_b64_tr_b16 a[2:3], v48 offset:512
    ds_read_b64_tr_b16 a[4:5], v48 offset:8192
    ds_read_b64_tr_b16 a[6:7], v48 offset:8704
    ds_read_b64_tr_b16 a[8:9], v48 offset:8
    ds_read_b64_tr_b16 a[10:11], v48 offset:520
    ds_read_b64_tr_b16 a[12:13], v48 offset:8200
    ds_read_b64_tr_b16 a[14:15], v48 offset:8712
    s_waitcnt lgkmcnt(0)
    s_barrier
    s_mov_b32 s8, s52
    s_mov_b32 s9, s53
    s_add_u32 m0, s48, 0
    s_mov_b32 s22, 0
    buffer_load_dwordx4 v44, s[8:11], s22 offen  lds
    s_add_u32 m0, s48, 4096
    s_mov_b32 s22, 32768
    buffer_load_dwordx4 v44, s[8:11], s22 offen  lds
    s_add_u32 m0, s48, 8192
    s_mov_b32 s22, 65536
    buffer_load_dwordx4 v44, s[8:11], s22 offen  lds
    s_add_u32 m0, s48, 12288
    s_mov_b32 s22, 98304
    buffer_load_dwordx4 v44, s[8:11], s22 offen  lds
    s_waitcnt vmcnt(28)
    s_barrier
    v_add_u32 v48, 16384, v46
    ds_read_b64_tr_b16 a[16:17], v48 offset:0
    ds_read_b64_tr_b16 a[18:19], v48 offset:512
    ds_read_b64_tr_b16 a[20:21], v48 offset:8192
    ds_read_b64_tr_b16 a[22:23], v48 offset:8704
    ds_read_b64_tr_b16 a[24:25], v48 offset:8
    ds_read_b64_tr_b16 a[26:27], v48 offset:520
    ds_read_b64_tr_b16 a[28:29], v48 offset:8200
    ds_read_b64_tr_b16 a[30:31], v48 offset:8712
    s_waitcnt lgkmcnt(0)
    s_barrier
    s_add_u32 m0, s48, 16384
    s_mov_b32 s22, 524288
    buffer_load_dwordx4 v44, s[8:11], s22 offen  lds
    s_add_u32 m0, s48, 20480
    s_mov_b32 s22, 557056
    buffer_load_dwordx4 v44, s[8:11], s22 offen  lds
    s_add_u32 m0, s48, 24576
    s_mov_b32 s22, 589824
    buffer_load_dwordx4 v44, s[8:11], s22 offen  lds
    s_add_u32 m0, s48, 28672
    s_mov_b32 s22, 622592
    buffer_load_dwordx4 v44, s[8:11], s22 offen  lds
    s_waitcnt vmcnt(28)
    s_barrier
    v_add_u32 v48, 32768, v46
    ds_read_b64_tr_b16 a[32:33], v48 offset:0
    ds_read_b64_tr_b16 a[34:35], v48 offset:512
    ds_read_b64_tr_b16 a[36:37], v48 offset:8192
    ds_read_b64_tr_b16 a[38:39], v48 offset:8704
    ds_read_b64_tr_b16 a[40:41], v48 offset:8
    ds_read_b64_tr_b16 a[42:43], v48 offset:520
    ds_read_b64_tr_b16 a[44:45], v48 offset:8200
    ds_read_b64_tr_b16 a[46:47], v48 offset:8712
    s_waitcnt lgkmcnt(0)
    s_barrier
    s_add_u32 m0, s48, 32768
    s_mov_b32 s22, 1048576
    buffer_load_dwordx4 v44, s[8:11], s22 offen  lds
    s_add_u32 m0, s48, 36864
    s_mov_b32 s22, 1081344
    buffer_load_dwordx4 v44, s[8:11], s22 offen  lds
    s_add_u32 m0, s48, 40960
    s_mov_b32 s22, 1114112
    buffer_load_dwordx4 v44, s[8:11], s22 offen  lds
    s_add_u32 m0, s48, 45056
    s_mov_b32 s22, 1146880
    buffer_load_dwordx4 v44, s[8:11], s22 offen  lds
    s_waitcnt vmcnt(28)
    s_barrier
    v_add_u32 v48, 49152, v46
    ds_read_b64_tr_b16 a[48:49], v48 offset:0
    ds_read_b64_tr_b16 a[50:51], v48 offset:512
    ds_read_b64_tr_b16 a[52:53], v48 offset:8192
    ds_read_b64_tr_b16 a[54:55], v48 offset:8704
    ds_read_b64_tr_b16 a[56:57], v48 offset:8
    ds_read_b64_tr_b16 a[58:59], v48 offset:520
    ds_read_b64_tr_b16 a[60:61], v48 offset:8200
    ds_read_b64_tr_b16 a[62:63], v48 offset:8712
    s_waitcnt lgkmcnt(0)
    s_barrier
    s_add_u32 m0, s48, 49152
    s_mov_b32 s22, 1572864
    buffer_load_dwordx4 v44, s[8:11], s22 offen  lds
    s_add_u32 m0, s48, 53248
    s_mov_b32 s22, 1605632
    buffer_load_dwordx4 v44, s[8:11], s22 offen  lds
    s_add_u32 m0, s48, 57344
    s_mov_b32 s22, 1638400
    buffer_load_dwordx4 v44, s[8:11], s22 offen  lds
    s_add_u32 m0, s48, 61440
    s_mov_b32 s22, 1671168
    buffer_load_dwordx4 v44, s[8:11], s22 offen  lds
    s_waitcnt vmcnt(28)
    s_barrier
    v_add_u32 v48, 65536, v46
    ds_read_b64_tr_b16 a[64:65], v48 offset:0
    ds_read_b64_tr_b16 a[66:67], v48 offset:512
    ds_read_b64_tr_b16 a[68:69], v48 offset:8192
    ds_read_b64_tr_b16 a[70:71], v48 offset:8704
    ds_read_b64_tr_b16 a[72:73], v48 offset:8
    ds_read_b64_tr_b16 a[74:75], v48 offset:520
    ds_read_b64_tr_b16 a[76:77], v48 offset:8200
    ds_read_b64_tr_b16 a[78:79], v48 offset:8712
    s_waitcnt lgkmcnt(0)
    s_barrier
    s_add_u32 m0, s48, 65536
    s_mov_b32 s22, 2097152
    buffer_load_dwordx4 v44, s[8:11], s22 offen  lds
    s_add_u32 m0, s48, 69632
    s_mov_b32 s22, 2129920
    buffer_load_dwordx4 v44, s[8:11], s22 offen  lds
    s_add_u32 m0, s48, 73728
    s_mov_b32 s22, 2162688
    buffer_load_dwordx4 v44, s[8:11], s22 offen  lds
    s_add_u32 m0, s48, 77824
    s_mov_b32 s22, 2195456
    buffer_load_dwordx4 v44, s[8:11], s22 offen  lds
    s_waitcnt vmcnt(28)
    s_barrier
    v_add_u32 v48, 81920, v46
    ds_read_b64_tr_b16 a[80:81], v48 offset:0
    ds_read_b64_tr_b16 a[82:83], v48 offset:512
    ds_read_b64_tr_b16 a[84:85], v48 offset:8192
    ds_read_b64_tr_b16 a[86:87], v48 offset:8704
    ds_read_b64_tr_b16 a[88:89], v48 offset:8
    ds_read_b64_tr_b16 a[90:91], v48 offset:520
    ds_read_b64_tr_b16 a[92:93], v48 offset:8200
    ds_read_b64_tr_b16 a[94:95], v48 offset:8712
    s_waitcnt lgkmcnt(0)
    s_barrier
    s_add_u32 m0, s48, 81920
    s_mov_b32 s22, 2621440
    buffer_load_dwordx4 v44, s[8:11], s22 offen  lds
    s_add_u32 m0, s48, 86016
    s_mov_b32 s22, 2654208
    buffer_load_dwordx4 v44, s[8:11], s22 offen  lds
    s_add_u32 m0, s48, 90112
    s_mov_b32 s22, 2686976
    buffer_load_dwordx4 v44, s[8:11], s22 offen  lds
    s_add_u32 m0, s48, 94208
    s_mov_b32 s22, 2719744
    buffer_load_dwordx4 v44, s[8:11], s22 offen  lds
    s_waitcnt vmcnt(28)
    s_barrier
    v_add_u32 v48, 98304, v46
    ds_read_b64_tr_b16 a[96:97], v48 offset:0
    ds_read_b64_tr_b16 a[98:99], v48 offset:512
    ds_read_b64_tr_b16 a[100:101], v48 offset:8192
    ds_read_b64_tr_b16 a[102:103], v48 offset:8704
    ds_read_b64_tr_b16 a[104:105], v48 offset:8
    ds_read_b64_tr_b16 a[106:107], v48 offset:520
    ds_read_b64_tr_b16 a[108:109], v48 offset:8200
    ds_read_b64_tr_b16 a[110:111], v48 offset:8712
    s_waitcnt lgkmcnt(0)
    s_barrier
    s_add_u32 m0, s48, 98304
    s_mov_b32 s22, 3145728
    buffer_load_dwordx4 v44, s[8:11], s22 offen  lds
    s_add_u32 m0, s48, 102400
    s_mov_b32 s22, 3178496
    buffer_load_dwordx4 v44, s[8:11], s22 offen  lds
    s_add_u32 m0, s48, 106496
    s_mov_b32 s22, 3211264
    buffer_load_dwordx4 v44, s[8:11], s22 offen  lds
    s_add_u32 m0, s48, 110592
    s_mov_b32 s22, 3244032
    buffer_load_dwordx4 v44, s[8:11], s22 offen  lds
    s_waitcnt vmcnt(28)
    s_barrier
    v_add_u32 v48, 114688, v46
    ds_read_b64_tr_b16 a[112:113], v48 offset:0
    ds_read_b64_tr_b16 a[114:115], v48 offset:512
    ds_read_b64_tr_b16 a[116:117], v48 offset:8192
    ds_read_b64_tr_b16 a[118:119], v48 offset:8704
    ds_read_b64_tr_b16 a[120:121], v48 offset:8
    ds_read_b64_tr_b16 a[122:123], v48 offset:520
    ds_read_b64_tr_b16 a[124:125], v48 offset:8200
    ds_read_b64_tr_b16 a[126:127], v48 offset:8712
    s_waitcnt lgkmcnt(0)
    s_barrier
    s_add_u32 m0, s48, 114688
    s_mov_b32 s22, 3670016
    buffer_load_dwordx4 v44, s[8:11], s22 offen  lds
    s_add_u32 m0, s48, 118784
    s_mov_b32 s22, 3702784
    buffer_load_dwordx4 v44, s[8:11], s22 offen  lds
    s_add_u32 m0, s48, 122880
    s_mov_b32 s22, 3735552
    buffer_load_dwordx4 v44, s[8:11], s22 offen  lds
    s_add_u32 m0, s48, 126976
    s_mov_b32 s22, 3768320
    buffer_load_dwordx4 v44, s[8:11], s22 offen  lds
    s_waitcnt vmcnt(28)
    s_barrier
    v_add_u32 v48, 0, v46
    ds_read_b64_tr_b16 a[128:129], v48 offset:0
    ds_read_b64_tr_b16 a[130:131], v48 offset:512
    ds_read_b64_tr_b16 a[132:133], v48 offset:8192
    ds_read_b64_tr_b16 a[134:135], v48 offset:8704
    ds_read_b64_tr_b16 a[136:137], v48 offset:8
    ds_read_b64_tr_b16 a[138:139], v48 offset:520
    ds_read_b64_tr_b16 a[140:141], v48 offset:8200
    ds_read_b64_tr_b16 a[142:143], v48 offset:8712
    s_waitcnt lgkmcnt(0)
    s_barrier
    s_mov_b32 s8, s56
    s_mov_b32 s9, s57
    s_add_u32 m0, s48, 0
    s_mov_b32 s22, 0
    buffer_load_dwordx4 v45, s[8:11], s22 offen  lds
    s_add_u32 m0, s48, 4096
    s_mov_b32 s22, 16384
    buffer_load_dwordx4 v45, s[8:11], s22 offen  lds
    s_add_u32 m0, s48, 8192
    s_mov_b32 s22, 32768
    buffer_load_dwordx4 v45, s[8:11], s22 offen  lds
    s_add_u32 m0, s48, 12288
    s_mov_b32 s22, 49152
    buffer_load_dwordx4 v45, s[8:11], s22 offen  lds
    s_waitcnt vmcnt(28)
    s_barrier
    v_add_u32 v48, 16384, v46
    ds_read_b64_tr_b16 a[144:145], v48 offset:0
    ds_read_b64_tr_b16 a[146:147], v48 offset:512
    ds_read_b64_tr_b16 a[148:149], v48 offset:8192
    ds_read_b64_tr_b16 a[150:151], v48 offset:8704
    ds_read_b64_tr_b16 a[152:153], v48 offset:8
    ds_read_b64_tr_b16 a[154:155], v48 offset:520
    ds_read_b64_tr_b16 a[156:157], v48 offset:8200
    ds_read_b64_tr_b16 a[158:159], v48 offset:8712
    s_waitcnt lgkmcnt(0)
    s_barrier
    s_add_u32 m0, s48, 16384
    s_mov_b32 s22, 256
    buffer_load_dwordx4 v45, s[8:11], s22 offen  lds
    s_add_u32 m0, s48, 20480
    s_mov_b32 s22, 16640
    buffer_load_dwordx4 v45, s[8:11], s22 offen  lds
    s_add_u32 m0, s48, 24576
    s_mov_b32 s22, 33024
    buffer_load_dwordx4 v45, s[8:11], s22 offen  lds
    s_add_u32 m0, s48, 28672
    s_mov_b32 s22, 49408
    buffer_load_dwordx4 v45, s[8:11], s22 offen  lds
    s_waitcnt vmcnt(28)
    s_barrier
    v_add_u32 v48, 32768, v46
    ds_read_b64_tr_b16 a[160:161], v48 offset:0
    ds_read_b64_tr_b16 a[162:163], v48 offset:512
    ds_read_b64_tr_b16 a[164:165], v48 offset:8192
    ds_read_b64_tr_b16 a[166:167], v48 offset:8704
    ds_read_b64_tr_b16 a[168:169], v48 offset:8
    ds_read_b64_tr_b16 a[170:171], v48 offset:520
    ds_read_b64_tr_b16 a[172:173], v48 offset:8200
    ds_read_b64_tr_b16 a[174:175], v48 offset:8712
    s_waitcnt lgkmcnt(0)
    s_barrier
    s_add_u32 m0, s48, 32768
    s_mov_b32 s22, 512
    buffer_load_dwordx4 v45, s[8:11], s22 offen  lds
    s_add_u32 m0, s48, 36864
    s_mov_b32 s22, 16896
    buffer_load_dwordx4 v45, s[8:11], s22 offen  lds
    s_add_u32 m0, s48, 40960
    s_mov_b32 s22, 33280
    buffer_load_dwordx4 v45, s[8:11], s22 offen  lds
    s_add_u32 m0, s48, 45056
    s_mov_b32 s22, 49664
    buffer_load_dwordx4 v45, s[8:11], s22 offen  lds
    s_waitcnt vmcnt(28)
    s_barrier
    v_add_u32 v48, 49152, v46
    ds_read_b64_tr_b16 a[176:177], v48 offset:0
    ds_read_b64_tr_b16 a[178:179], v48 offset:512
    ds_read_b64_tr_b16 a[180:181], v48 offset:8192
    ds_read_b64_tr_b16 a[182:183], v48 offset:8704
    ds_read_b64_tr_b16 a[184:185], v48 offset:8
    ds_read_b64_tr_b16 a[186:187], v48 offset:520
    ds_read_b64_tr_b16 a[188:189], v48 offset:8200
    ds_read_b64_tr_b16 a[190:191], v48 offset:8712
    s_waitcnt lgkmcnt(0)
    s_barrier
    s_add_u32 m0, s48, 49152
    s_mov_b32 s22, 768
    buffer_load_dwordx4 v45, s[8:11], s22 offen  lds
    s_add_u32 m0, s48, 53248
    s_mov_b32 s22, 17152
    buffer_load_dwordx4 v45, s[8:11], s22 offen  lds
    s_add_u32 m0, s48, 57344
    s_mov_b32 s22, 33536
    buffer_load_dwordx4 v45, s[8:11], s22 offen  lds
    s_add_u32 m0, s48, 61440
    s_mov_b32 s22, 49920
    buffer_load_dwordx4 v45, s[8:11], s22 offen  lds
    s_waitcnt vmcnt(28)
    s_barrier
    v_add_u32 v48, 65536, v46
    ds_read_b64_tr_b16 a[192:193], v48 offset:0
    ds_read_b64_tr_b16 a[194:195], v48 offset:512
    ds_read_b64_tr_b16 a[196:197], v48 offset:8192
    ds_read_b64_tr_b16 a[198:199], v48 offset:8704
    ds_read_b64_tr_b16 a[200:201], v48 offset:8
    ds_read_b64_tr_b16 a[202:203], v48 offset:520
    ds_read_b64_tr_b16 a[204:205], v48 offset:8200
    ds_read_b64_tr_b16 a[206:207], v48 offset:8712
    s_waitcnt lgkmcnt(0)
    s_barrier
    s_add_u32 m0, s48, 65536
    s_mov_b32 s22, 131072
    buffer_load_dwordx4 v45, s[8:11], s22 offen  lds
    s_add_u32 m0, s48, 69632
    s_mov_b32 s22, 147456
    buffer_load_dwordx4 v45, s[8:11], s22 offen  lds
    s_add_u32 m0, s48, 73728
    s_mov_b32 s22, 163840
    buffer_load_dwordx4 v45, s[8:11], s22 offen  lds
    s_add_u32 m0, s48, 77824
    s_mov_b32 s22, 180224
    buffer_load_dwordx4 v45, s[8:11], s22 offen  lds
    s_waitcnt vmcnt(28)
    s_barrier
    v_add_u32 v48, 81920, v46
    ds_read_b64_tr_b16 a[208:209], v48 offset:0
    ds_read_b64_tr_b16 a[210:211], v48 offset:512
    ds_read_b64_tr_b16 a[212:213], v48 offset:8192
    ds_read_b64_tr_b16 a[214:215], v48 offset:8704
    ds_read_b64_tr_b16 a[216:217], v48 offset:8
    ds_read_b64_tr_b16 a[218:219], v48 offset:520
    ds_read_b64_tr_b16 a[220:221], v48 offset:8200
    ds_read_b64_tr_b16 a[222:223], v48 offset:8712
    s_waitcnt lgkmcnt(0)
    s_barrier
    s_add_u32 m0, s48, 81920
    s_mov_b32 s22, 131328
    buffer_load_dwordx4 v45, s[8:11], s22 offen  lds
    s_add_u32 m0, s48, 86016
    s_mov_b32 s22, 147712
    buffer_load_dwordx4 v45, s[8:11], s22 offen  lds
    s_add_u32 m0, s48, 90112
    s_mov_b32 s22, 164096
    buffer_load_dwordx4 v45, s[8:11], s22 offen  lds
    s_add_u32 m0, s48, 94208
    s_mov_b32 s22, 180480
    buffer_load_dwordx4 v45, s[8:11], s22 offen  lds
    s_waitcnt vmcnt(28)
    s_barrier
    v_add_u32 v48, 98304, v46
    ds_read_b64_tr_b16 a[224:225], v48 offset:0
    ds_read_b64_tr_b16 a[226:227], v48 offset:512
    ds_read_b64_tr_b16 a[228:229], v48 offset:8192
    ds_read_b64_tr_b16 a[230:231], v48 offset:8704
    ds_read_b64_tr_b16 a[232:233], v48 offset:8
    ds_read_b64_tr_b16 a[234:235], v48 offset:520
    ds_read_b64_tr_b16 a[236:237], v48 offset:8200
    ds_read_b64_tr_b16 a[238:239], v48 offset:8712
    s_waitcnt lgkmcnt(0)
    s_barrier
    s_add_u32 m0, s48, 98304
    s_mov_b32 s22, 131584
    buffer_load_dwordx4 v45, s[8:11], s22 offen  lds
    s_add_u32 m0, s48, 102400
    s_mov_b32 s22, 147968
    buffer_load_dwordx4 v45, s[8:11], s22 offen  lds
    s_add_u32 m0, s48, 106496
    s_mov_b32 s22, 164352
    buffer_load_dwordx4 v45, s[8:11], s22 offen  lds
    s_add_u32 m0, s48, 110592
    s_mov_b32 s22, 180736
    buffer_load_dwordx4 v45, s[8:11], s22 offen  lds
    s_waitcnt vmcnt(28)
    s_barrier
    v_add_u32 v48, 114688, v46
    ds_read_b64_tr_b16 a[240:241], v48 offset:0
    ds_read_b64_tr_b16 a[242:243], v48 offset:512
    ds_read_b64_tr_b16 a[244:245], v48 offset:8192
    ds_read_b64_tr_b16 a[246:247], v48 offset:8704
    ds_read_b64_tr_b16 a[248:249], v48 offset:8
    ds_read_b64_tr_b16 a[250:251], v48 offset:520
    ds_read_b64_tr_b16 a[252:253], v48 offset:8200
    ds_read_b64_tr_b16 a[254:255], v48 offset:8712
    s_waitcnt lgkmcnt(0)
    s_barrier
    s_add_u32 m0, s48, 114688
    s_mov_b32 s22, 131840
    buffer_load_dwordx4 v45, s[8:11], s22 offen  lds
    s_add_u32 m0, s48, 118784
    s_mov_b32 s22, 148224
    buffer_load_dwordx4 v45, s[8:11], s22 offen  lds
    s_add_u32 m0, s48, 122880
    s_mov_b32 s22, 164608
    buffer_load_dwordx4 v45, s[8:11], s22 offen  lds
    s_add_u32 m0, s48, 126976
    s_mov_b32 s22, 180992
    buffer_load_dwordx4 v45, s[8:11], s22 offen  lds
    s_waitcnt vmcnt(28)
    s_barrier
    s_cmp_lg_u32 s20, 0
    s_cbranch_scc1 mega_kernel_rs_wo0
    v_xor_b32 v48, 0, v47
    v_add_u32 v48, 0, v48
    ds_read_b64_tr_b16 v[128:129], v48 offset:0
    ds_read_b64_tr_b16 v[130:131], v48 offset:512
    ds_read_b64_tr_b16 v[132:133], v48 offset:8192
    ds_read_b64_tr_b16 v[134:135], v48 offset:8704
    ds_read_b64_tr_b16 v[136:137], v48 offset:32
    ds_read_b64_tr_b16 v[138:139], v48 offset:544
    ds_read_b64_tr_b16 v[140:141], v48 offset:8224
    ds_read_b64_tr_b16 v[142:143], v48 offset:8736
    s_waitcnt lgkmcnt(0)
    v_xor_b32 v48, 64, v47
    v_add_u32 v48, 0, v48
    ds_read_b64_tr_b16 v[144:145], v48 offset:0
    ds_read_b64_tr_b16 v[146:147], v48 offset:512
    ds_read_b64_tr_b16 v[148:149], v48 offset:8192
    ds_read_b64_tr_b16 v[150:151], v48 offset:8704
    ds_read_b64_tr_b16 v[152:153], v48 offset:32
    ds_read_b64_tr_b16 v[154:155], v48 offset:544
    ds_read_b64_tr_b16 v[156:157], v48 offset:8224
    ds_read_b64_tr_b16 v[158:159], v48 offset:8736
    s_waitcnt lgkmcnt(0)
    v_xor_b32 v48, 128, v47
    v_add_u32 v48, 0, v48
    ds_read_b64_tr_b16 v[192:193], v48 offset:0
    ds_read_b64_tr_b16 v[194:195], v48 offset:512
    ds_read_b64_tr_b16 v[196:197], v48 offset:8192
    ds_read_b64_tr_b16 v[198:199], v48 offset:8704
    ds_read_b64_tr_b16 v[200:201], v48 offset:32
    ds_read_b64_tr_b16 v[202:203], v48 offset:544
    ds_read_b64_tr_b16 v[204:205], v48 offset:8224
    ds_read_b64_tr_b16 v[206:207], v48 offset:8736
    s_waitcnt lgkmcnt(0)
    v_xor_b32 v48, 192, v47
    v_add_u32 v48, 0, v48
    ds_read_b64_tr_b16 v[80:81], v48 offset:0
    ds_read_b64_tr_b16 v[82:83], v48 offset:512
    ds_read_b64_tr_b16 v[84:85], v48 offset:8192
    ds_read_b64_tr_b16 v[86:87], v48 offset:8704
    ds_read_b64_tr_b16 v[88:89], v48 offset:32
    ds_read_b64_tr_b16 v[90:91], v48 offset:544
    ds_read_b64_tr_b16 v[92:93], v48 offset:8224
    ds_read_b64_tr_b16 v[94:95], v48 offset:8736
    s_waitcnt lgkmcnt(0)
mega_kernel_rs_wo0:
    s_barrier
    s_mov_b32 s8, s54
    s_mov_b32 s9, s55
    s_add_u32 m0, s48, 0
    s_mov_b32 s22, 0
    buffer_load_dwordx4 v44, s[8:11], s22 offen  lds
    s_add_u32 m0, s48, 4096
    s_mov_b32 s22, 32768
    buffer_load_dwordx4 v44, s[8:11], s22 offen  lds
    s_add_u32 m0, s48, 8192
    s_mov_b32 s22, 65536
    buffer_load_dwordx4 v44, s[8:11], s22 offen  lds
    s_add_u32 m0, s48, 12288
    s_mov_b32 s22, 98304
    buffer_load_dwordx4 v44, s[8:11], s22 offen  lds
    s_waitcnt vmcnt(28)
    s_barrier
    s_cmp_lg_u32 s20, 1
    s_cbranch_scc1 mega_kernel_rs_wo1
    v_xor_b32 v48, 0, v47
    v_add_u32 v48, 16384, v48
    ds_read_b64_tr_b16 v[128:129], v48 offset:0
    ds_read_b64_tr_b16 v[130:131], v48 offset:512
    ds_read_b64_tr_b16 v[132:133], v48 offset:8192
    ds_read_b64_tr_b16 v[134:135], v48 offset:8704
    ds_read_b64_tr_b16 v[136:137], v48 offset:32
    ds_read_b64_tr_b16 v[138:139], v48 offset:544
    ds_read_b64_tr_b16 v[140:141], v48 offset:8224
    ds_read_b64_tr_b16 v[142:143], v48 offset:8736
    s_waitcnt lgkmcnt(0)
    v_xor_b32 v48, 64, v47
    v_add_u32 v48, 16384, v48
    ds_read_b64_tr_b16 v[144:145], v48 offset:0
    ds_read_b64_tr_b16 v[146:147], v48 offset:512
    ds_read_b64_tr_b16 v[148:149], v48 offset:8192
    ds_read_b64_tr_b16 v[150:151], v48 offset:8704
    ds_read_b64_tr_b16 v[152:153], v48 offset:32
    ds_read_b64_tr_b16 v[154:155], v48 offset:544
    ds_read_b64_tr_b16 v[156:157], v48 offset:8224
    ds_read_b64_tr_b16 v[158:159], v48 offset:8736
    s_waitcnt lgkmcnt(0)
    v_xor_b32 v48, 128, v47
    v_add_u32 v48, 16384, v48
    ds_read_b64_tr_b16 v[192:193], v48 offset:0
    ds_read_b64_tr_b16 v[194:195], v48 offset:512
    ds_read_b64_tr_b16 v[196:197], v48 offset:8192
    ds_read_b64_tr_b16 v[198:199], v48 offset:8704
    ds_read_b64_tr_b16 v[200:201], v48 offset:32
    ds_read_b64_tr_b16 v[202:203], v48 offset:544
    ds_read_b64_tr_b16 v[204:205], v48 offset:8224
    ds_read_b64_tr_b16 v[206:207], v48 offset:8736
    s_waitcnt lgkmcnt(0)
    v_xor_b32 v48, 192, v47
    v_add_u32 v48, 16384, v48
    ds_read_b64_tr_b16 v[80:81], v48 offset:0
    ds_read_b64_tr_b16 v[82:83], v48 offset:512
    ds_read_b64_tr_b16 v[84:85], v48 offset:8192
    ds_read_b64_tr_b16 v[86:87], v48 offset:8704
    ds_read_b64_tr_b16 v[88:89], v48 offset:32
    ds_read_b64_tr_b16 v[90:91], v48 offset:544
    ds_read_b64_tr_b16 v[92:93], v48 offset:8224
    ds_read_b64_tr_b16 v[94:95], v48 offset:8736
    s_waitcnt lgkmcnt(0)
mega_kernel_rs_wo1:
    s_barrier
    s_add_u32 m0, s48, 16384
    s_mov_b32 s22, 524288
    buffer_load_dwordx4 v44, s[8:11], s22 offen  lds
    s_add_u32 m0, s48, 20480
    s_mov_b32 s22, 557056
    buffer_load_dwordx4 v44, s[8:11], s22 offen  lds
    s_add_u32 m0, s48, 24576
    s_mov_b32 s22, 589824
    buffer_load_dwordx4 v44, s[8:11], s22 offen  lds
    s_add_u32 m0, s48, 28672
    s_mov_b32 s22, 622592
    buffer_load_dwordx4 v44, s[8:11], s22 offen  lds
    s_waitcnt vmcnt(28)
    s_barrier
    s_cmp_lg_u32 s20, 2
    s_cbranch_scc1 mega_kernel_rs_wo2
    v_xor_b32 v48, 0, v47
    v_add_u32 v48, 32768, v48
    ds_read_b64_tr_b16 v[128:129], v48 offset:0
    ds_read_b64_tr_b16 v[130:131], v48 offset:512
    ds_read_b64_tr_b16 v[132:133], v48 offset:8192
    ds_read_b64_tr_b16 v[134:135], v48 offset:8704
    ds_read_b64_tr_b16 v[136:137], v48 offset:32
    ds_read_b64_tr_b16 v[138:139], v48 offset:544
    ds_read_b64_tr_b16 v[140:141], v48 offset:8224
    ds_read_b64_tr_b16 v[142:143], v48 offset:8736
    s_waitcnt lgkmcnt(0)
    v_xor_b32 v48, 64, v47
    v_add_u32 v48, 32768, v48
    ds_read_b64_tr_b16 v[144:145], v48 offset:0
    ds_read_b64_tr_b16 v[146:147], v48 offset:512
    ds_read_b64_tr_b16 v[148:149], v48 offset:8192
    ds_read_b64_tr_b16 v[150:151], v48 offset:8704
    ds_read_b64_tr_b16 v[152:153], v48 offset:32
    ds_read_b64_tr_b16 v[154:155], v48 offset:544
    ds_read_b64_tr_b16 v[156:157], v48 offset:8224
    ds_read_b64_tr_b16 v[158:159], v48 offset:8736
    s_waitcnt lgkmcnt(0)
    v_xor_b32 v48, 128, v47
    v_add_u32 v48, 32768, v48
    ds_read_b64_tr_b16 v[192:193], v48 offset:0
    ds_read_b64_tr_b16 v[194:195], v48 offset:512
    ds_read_b64_tr_b16 v[196:197], v48 offset:8192
    ds_read_b64_tr_b16 v[198:199], v48 offset:8704
    ds_read_b64_tr_b16 v[200:201], v48 offset:32
    ds_read_b64_tr_b16 v[202:203], v48 offset:544
    ds_read_b64_tr_b16 v[204:205], v48 offset:8224
    ds_read_b64_tr_b16 v[206:207], v48 offset:8736
    s_waitcnt lgkmcnt(0)
    v_xor_b32 v48, 192, v47
    v_add_u32 v48, 32768, v48
    ds_read_b64_tr_b16 v[80:81], v48 offset:0
    ds_read_b64_tr_b16 v[82:83], v48 offset:512
    ds_read_b64_tr_b16 v[84:85], v48 offset:8192
    ds_read_b64_tr_b16 v[86:87], v48 offset:8704
    ds_read_b64_tr_b16 v[88:89], v48 offset:32
    ds_read_b64_tr_b16 v[90:91], v48 offset:544
    ds_read_b64_tr_b16 v[92:93], v48 offset:8224
    ds_read_b64_tr_b16 v[94:95], v48 offset:8736
    s_waitcnt lgkmcnt(0)
mega_kernel_rs_wo2:
    s_barrier
    s_add_u32 m0, s48, 32768
    s_mov_b32 s22, 1048576
    buffer_load_dwordx4 v44, s[8:11], s22 offen  lds
    s_add_u32 m0, s48, 36864
    s_mov_b32 s22, 1081344
    buffer_load_dwordx4 v44, s[8:11], s22 offen  lds
    s_add_u32 m0, s48, 40960
    s_mov_b32 s22, 1114112
    buffer_load_dwordx4 v44, s[8:11], s22 offen  lds
    s_add_u32 m0, s48, 45056
    s_mov_b32 s22, 1146880
    buffer_load_dwordx4 v44, s[8:11], s22 offen  lds
    s_waitcnt vmcnt(28)
    s_barrier
    s_cmp_lg_u32 s20, 3
    s_cbranch_scc1 mega_kernel_rs_wo3
    v_xor_b32 v48, 0, v47
    v_add_u32 v48, 49152, v48
    ds_read_b64_tr_b16 v[128:129], v48 offset:0
    ds_read_b64_tr_b16 v[130:131], v48 offset:512
    ds_read_b64_tr_b16 v[132:133], v48 offset:8192
    ds_read_b64_tr_b16 v[134:135], v48 offset:8704
    ds_read_b64_tr_b16 v[136:137], v48 offset:32
    ds_read_b64_tr_b16 v[138:139], v48 offset:544
    ds_read_b64_tr_b16 v[140:141], v48 offset:8224
    ds_read_b64_tr_b16 v[142:143], v48 offset:8736
    s_waitcnt lgkmcnt(0)
    v_xor_b32 v48, 64, v47
    v_add_u32 v48, 49152, v48
    ds_read_b64_tr_b16 v[144:145], v48 offset:0
    ds_read_b64_tr_b16 v[146:147], v48 offset:512
    ds_read_b64_tr_b16 v[148:149], v48 offset:8192
    ds_read_b64_tr_b16 v[150:151], v48 offset:8704
    ds_read_b64_tr_b16 v[152:153], v48 offset:32
    ds_read_b64_tr_b16 v[154:155], v48 offset:544
    ds_read_b64_tr_b16 v[156:157], v48 offset:8224
    ds_read_b64_tr_b16 v[158:159], v48 offset:8736
    s_waitcnt lgkmcnt(0)
    v_xor_b32 v48, 128, v47
    v_add_u32 v48, 49152, v48
    ds_read_b64_tr_b16 v[192:193], v48 offset:0
    ds_read_b64_tr_b16 v[194:195], v48 offset:512
    ds_read_b64_tr_b16 v[196:197], v48 offset:8192
    ds_read_b64_tr_b16 v[198:199], v48 offset:8704
    ds_read_b64_tr_b16 v[200:201], v48 offset:32
    ds_read_b64_tr_b16 v[202:203], v48 offset:544
    ds_read_b64_tr_b16 v[204:205], v48 offset:8224
    ds_read_b64_tr_b16 v[206:207], v48 offset:8736
    s_waitcnt lgkmcnt(0)
    v_xor_b32 v48, 192, v47
    v_add_u32 v48, 49152, v48
    ds_read_b64_tr_b16 v[80:81], v48 offset:0
    ds_read_b64_tr_b16 v[82:83], v48 offset:512
    ds_read_b64_tr_b16 v[84:85], v48 offset:8192
    ds_read_b64_tr_b16 v[86:87], v48 offset:8704
    ds_read_b64_tr_b16 v[88:89], v48 offset:32
    ds_read_b64_tr_b16 v[90:91], v48 offset:544
    ds_read_b64_tr_b16 v[92:93], v48 offset:8224
    ds_read_b64_tr_b16 v[94:95], v48 offset:8736
    s_waitcnt lgkmcnt(0)
mega_kernel_rs_wo3:
    s_barrier
    s_add_u32 m0, s48, 49152
    s_mov_b32 s22, 1572864
    buffer_load_dwordx4 v44, s[8:11], s22 offen  lds
    s_add_u32 m0, s48, 53248
    s_mov_b32 s22, 1605632
    buffer_load_dwordx4 v44, s[8:11], s22 offen  lds
    s_add_u32 m0, s48, 57344
    s_mov_b32 s22, 1638400
    buffer_load_dwordx4 v44, s[8:11], s22 offen  lds
    s_add_u32 m0, s48, 61440
    s_mov_b32 s22, 1671168
    buffer_load_dwordx4 v44, s[8:11], s22 offen  lds
    s_waitcnt vmcnt(28)
    s_barrier
    s_cmp_lg_u32 s20, 0
    s_cbranch_scc1 mega_kernel_rs_wo4
    v_xor_b32 v48, 0, v47
    v_add_u32 v48, 65536, v48
    ds_read_b64_tr_b16 v[160:161], v48 offset:0
    ds_read_b64_tr_b16 v[162:163], v48 offset:512
    ds_read_b64_tr_b16 v[164:165], v48 offset:8192
    ds_read_b64_tr_b16 v[166:167], v48 offset:8704
    ds_read_b64_tr_b16 v[168:169], v48 offset:32
    ds_read_b64_tr_b16 v[170:171], v48 offset:544
    ds_read_b64_tr_b16 v[172:173], v48 offset:8224
    ds_read_b64_tr_b16 v[174:175], v48 offset:8736
    s_waitcnt lgkmcnt(0)
    v_xor_b32 v48, 64, v47
    v_add_u32 v48, 65536, v48
    ds_read_b64_tr_b16 v[176:177], v48 offset:0
    ds_read_b64_tr_b16 v[178:179], v48 offset:512
    ds_read_b64_tr_b16 v[180:181], v48 offset:8192
    ds_read_b64_tr_b16 v[182:183], v48 offset:8704
    ds_read_b64_tr_b16 v[184:185], v48 offset:32
    ds_read_b64_tr_b16 v[186:187], v48 offset:544
    ds_read_b64_tr_b16 v[188:189], v48 offset:8224
    ds_read_b64_tr_b16 v[190:191], v48 offset:8736
    s_waitcnt lgkmcnt(0)
    v_xor_b32 v48, 128, v47
    v_add_u32 v48, 65536, v48
    ds_read_b64_tr_b16 v[96:97], v48 offset:0
    ds_read_b64_tr_b16 v[98:99], v48 offset:512
    ds_read_b64_tr_b16 v[100:101], v48 offset:8192
    ds_read_b64_tr_b16 v[102:103], v48 offset:8704
    ds_read_b64_tr_b16 v[104:105], v48 offset:32
    ds_read_b64_tr_b16 v[106:107], v48 offset:544
    ds_read_b64_tr_b16 v[108:109], v48 offset:8224
    ds_read_b64_tr_b16 v[110:111], v48 offset:8736
    s_waitcnt lgkmcnt(0)
    v_xor_b32 v48, 192, v47
    v_add_u32 v48, 65536, v48
    ds_read_b64_tr_b16 v[112:113], v48 offset:0
    ds_read_b64_tr_b16 v[114:115], v48 offset:512
    ds_read_b64_tr_b16 v[116:117], v48 offset:8192
    ds_read_b64_tr_b16 v[118:119], v48 offset:8704
    ds_read_b64_tr_b16 v[120:121], v48 offset:32
    ds_read_b64_tr_b16 v[122:123], v48 offset:544
    ds_read_b64_tr_b16 v[124:125], v48 offset:8224
    ds_read_b64_tr_b16 v[126:127], v48 offset:8736
    s_waitcnt lgkmcnt(0)
mega_kernel_rs_wo4:
    s_barrier
    s_add_u32 m0, s48, 65536
    s_mov_b32 s22, 2097152
    buffer_load_dwordx4 v44, s[8:11], s22 offen  lds
    s_add_u32 m0, s48, 69632
    s_mov_b32 s22, 2129920
    buffer_load_dwordx4 v44, s[8:11], s22 offen  lds
    s_add_u32 m0, s48, 73728
    s_mov_b32 s22, 2162688
    buffer_load_dwordx4 v44, s[8:11], s22 offen  lds
    s_add_u32 m0, s48, 77824
    s_mov_b32 s22, 2195456
    buffer_load_dwordx4 v44, s[8:11], s22 offen  lds
    s_waitcnt vmcnt(28)
    s_barrier
    s_cmp_lg_u32 s20, 1
    s_cbranch_scc1 mega_kernel_rs_wo5
    v_xor_b32 v48, 0, v47
    v_add_u32 v48, 81920, v48
    ds_read_b64_tr_b16 v[160:161], v48 offset:0
    ds_read_b64_tr_b16 v[162:163], v48 offset:512
    ds_read_b64_tr_b16 v[164:165], v48 offset:8192
    ds_read_b64_tr_b16 v[166:167], v48 offset:8704
    ds_read_b64_tr_b16 v[168:169], v48 offset:32
    ds_read_b64_tr_b16 v[170:171], v48 offset:544
    ds_read_b64_tr_b16 v[172:173], v48 offset:8224
    ds_read_b64_tr_b16 v[174:175], v48 offset:8736
    s_waitcnt lgkmcnt(0)
    v_xor_b32 v48, 64, v47
    v_add_u32 v48, 81920, v48
    ds_read_b64_tr_b16 v[176:177], v48 offset:0
    ds_read_b64_tr_b16 v[178:179], v48 offset:512
    ds_read_b64_tr_b16 v[180:181], v48 offset:8192
    ds_read_b64_tr_b16 v[182:183], v48 offset:8704
    ds_read_b64_tr_b16 v[184:185], v48 offset:32
    ds_read_b64_tr_b16 v[186:187], v48 offset:544
    ds_read_b64_tr_b16 v[188:189], v48 offset:8224
    ds_read_b64_tr_b16 v[190:191], v48 offset:8736
    s_waitcnt lgkmcnt(0)
    v_xor_b32 v48, 128, v47
    v_add_u32 v48, 81920, v48
    ds_read_b64_tr_b16 v[96:97], v48 offset:0
    ds_read_b64_tr_b16 v[98:99], v48 offset:512
    ds_read_b64_tr_b16 v[100:101], v48 offset:8192
    ds_read_b64_tr_b16 v[102:103], v48 offset:8704
    ds_read_b64_tr_b16 v[104:105], v48 offset:32
    ds_read_b64_tr_b16 v[106:107], v48 offset:544
    ds_read_b64_tr_b16 v[108:109], v48 offset:8224
    ds_read_b64_tr_b16 v[110:111], v48 offset:8736
    s_waitcnt lgkmcnt(0)
    v_xor_b32 v48, 192, v47
    v_add_u32 v48, 81920, v48
    ds_read_b64_tr_b16 v[112:113], v48 offset:0
    ds_read_b64_tr_b16 v[114:115], v48 offset:512
    ds_read_b64_tr_b16 v[116:117], v48 offset:8192
    ds_read_b64_tr_b16 v[118:119], v48 offset:8704
    ds_read_b64_tr_b16 v[120:121], v48 offset:32
    ds_read_b64_tr_b16 v[122:123], v48 offset:544
    ds_read_b64_tr_b16 v[124:125], v48 offset:8224
    ds_read_b64_tr_b16 v[126:127], v48 offset:8736
    s_waitcnt lgkmcnt(0)
mega_kernel_rs_wo5:
    s_barrier
    s_add_u32 m0, s48, 81920
    s_mov_b32 s22, 2621440
    buffer_load_dwordx4 v44, s[8:11], s22 offen  lds
    s_add_u32 m0, s48, 86016
    s_mov_b32 s22, 2654208
    buffer_load_dwordx4 v44, s[8:11], s22 offen  lds
    s_add_u32 m0, s48, 90112
    s_mov_b32 s22, 2686976
    buffer_load_dwordx4 v44, s[8:11], s22 offen  lds
    s_add_u32 m0, s48, 94208
    s_mov_b32 s22, 2719744
    buffer_load_dwordx4 v44, s[8:11], s22 offen  lds
    s_waitcnt vmcnt(28)
    s_barrier
    s_cmp_lg_u32 s20, 2
    s_cbranch_scc1 mega_kernel_rs_wo6
    v_xor_b32 v48, 0, v47
    v_add_u32 v48, 98304, v48
    ds_read_b64_tr_b16 v[160:161], v48 offset:0
    ds_read_b64_tr_b16 v[162:163], v48 offset:512
    ds_read_b64_tr_b16 v[164:165], v48 offset:8192
    ds_read_b64_tr_b16 v[166:167], v48 offset:8704
    ds_read_b64_tr_b16 v[168:169], v48 offset:32
    ds_read_b64_tr_b16 v[170:171], v48 offset:544
    ds_read_b64_tr_b16 v[172:173], v48 offset:8224
    ds_read_b64_tr_b16 v[174:175], v48 offset:8736
    s_waitcnt lgkmcnt(0)
    v_xor_b32 v48, 64, v47
    v_add_u32 v48, 98304, v48
    ds_read_b64_tr_b16 v[176:177], v48 offset:0
    ds_read_b64_tr_b16 v[178:179], v48 offset:512
    ds_read_b64_tr_b16 v[180:181], v48 offset:8192
    ds_read_b64_tr_b16 v[182:183], v48 offset:8704
    ds_read_b64_tr_b16 v[184:185], v48 offset:32
    ds_read_b64_tr_b16 v[186:187], v48 offset:544
    ds_read_b64_tr_b16 v[188:189], v48 offset:8224
    ds_read_b64_tr_b16 v[190:191], v48 offset:8736
    s_waitcnt lgkmcnt(0)
    v_xor_b32 v48, 128, v47
    v_add_u32 v48, 98304, v48
    ds_read_b64_tr_b16 v[96:97], v48 offset:0
    ds_read_b64_tr_b16 v[98:99], v48 offset:512
    ds_read_b64_tr_b16 v[100:101], v48 offset:8192
    ds_read_b64_tr_b16 v[102:103], v48 offset:8704
    ds_read_b64_tr_b16 v[104:105], v48 offset:32
    ds_read_b64_tr_b16 v[106:107], v48 offset:544
    ds_read_b64_tr_b16 v[108:109], v48 offset:8224
    ds_read_b64_tr_b16 v[110:111], v48 offset:8736
    s_waitcnt lgkmcnt(0)
    v_xor_b32 v48, 192, v47
    v_add_u32 v48, 98304, v48
    ds_read_b64_tr_b16 v[112:113], v48 offset:0
    ds_read_b64_tr_b16 v[114:115], v48 offset:512
    ds_read_b64_tr_b16 v[116:117], v48 offset:8192
    ds_read_b64_tr_b16 v[118:119], v48 offset:8704
    ds_read_b64_tr_b16 v[120:121], v48 offset:32
    ds_read_b64_tr_b16 v[122:123], v48 offset:544
    ds_read_b64_tr_b16 v[124:125], v48 offset:8224
    ds_read_b64_tr_b16 v[126:127], v48 offset:8736
    s_waitcnt lgkmcnt(0)
mega_kernel_rs_wo6:
    s_barrier
    s_add_u32 m0, s48, 98304
    s_mov_b32 s22, 3145728
    buffer_load_dwordx4 v44, s[8:11], s22 offen  lds
    s_add_u32 m0, s48, 102400
    s_mov_b32 s22, 3178496
    buffer_load_dwordx4 v44, s[8:11], s22 offen  lds
    s_add_u32 m0, s48, 106496
    s_mov_b32 s22, 3211264
    buffer_load_dwordx4 v44, s[8:11], s22 offen  lds
    s_add_u32 m0, s48, 110592
    s_mov_b32 s22, 3244032
    buffer_load_dwordx4 v44, s[8:11], s22 offen  lds
    s_waitcnt vmcnt(28)
    s_barrier
    s_cmp_lg_u32 s20, 3
    s_cbranch_scc1 mega_kernel_rs_wo7
    v_xor_b32 v48, 0, v47
    v_add_u32 v48, 114688, v48
    ds_read_b64_tr_b16 v[160:161], v48 offset:0
    ds_read_b64_tr_b16 v[162:163], v48 offset:512
    ds_read_b64_tr_b16 v[164:165], v48 offset:8192
    ds_read_b64_tr_b16 v[166:167], v48 offset:8704
    ds_read_b64_tr_b16 v[168:169], v48 offset:32
    ds_read_b64_tr_b16 v[170:171], v48 offset:544
    ds_read_b64_tr_b16 v[172:173], v48 offset:8224
    ds_read_b64_tr_b16 v[174:175], v48 offset:8736
    s_waitcnt lgkmcnt(0)
    v_xor_b32 v48, 64, v47
    v_add_u32 v48, 114688, v48
    ds_read_b64_tr_b16 v[176:177], v48 offset:0
    ds_read_b64_tr_b16 v[178:179], v48 offset:512
    ds_read_b64_tr_b16 v[180:181], v48 offset:8192
    ds_read_b64_tr_b16 v[182:183], v48 offset:8704
    ds_read_b64_tr_b16 v[184:185], v48 offset:32
    ds_read_b64_tr_b16 v[186:187], v48 offset:544
    ds_read_b64_tr_b16 v[188:189], v48 offset:8224
    ds_read_b64_tr_b16 v[190:191], v48 offset:8736
    s_waitcnt lgkmcnt(0)
    v_xor_b32 v48, 128, v47
    v_add_u32 v48, 114688, v48
    ds_read_b64_tr_b16 v[96:97], v48 offset:0
    ds_read_b64_tr_b16 v[98:99], v48 offset:512
    ds_read_b64_tr_b16 v[100:101], v48 offset:8192
    ds_read_b64_tr_b16 v[102:103], v48 offset:8704
    ds_read_b64_tr_b16 v[104:105], v48 offset:32
    ds_read_b64_tr_b16 v[106:107], v48 offset:544
    ds_read_b64_tr_b16 v[108:109], v48 offset:8224
    ds_read_b64_tr_b16 v[110:111], v48 offset:8736
    s_waitcnt lgkmcnt(0)
    v_xor_b32 v48, 192, v47
    v_add_u32 v48, 114688, v48
    ds_read_b64_tr_b16 v[112:113], v48 offset:0
    ds_read_b64_tr_b16 v[114:115], v48 offset:512
    ds_read_b64_tr_b16 v[116:117], v48 offset:8192
    ds_read_b64_tr_b16 v[118:119], v48 offset:8704
    ds_read_b64_tr_b16 v[120:121], v48 offset:32
    ds_read_b64_tr_b16 v[122:123], v48 offset:544
    ds_read_b64_tr_b16 v[124:125], v48 offset:8224
    ds_read_b64_tr_b16 v[126:127], v48 offset:8736
    s_waitcnt lgkmcnt(0)
mega_kernel_rs_wo7:
    s_barrier
    s_add_u32 m0, s48, 114688
    s_mov_b32 s22, 3670016
    buffer_load_dwordx4 v44, s[8:11], s22 offen  lds
    s_add_u32 m0, s48, 118784
    s_mov_b32 s22, 3702784
    buffer_load_dwordx4 v44, s[8:11], s22 offen  lds
    s_add_u32 m0, s48, 122880
    s_mov_b32 s22, 3735552
    buffer_load_dwordx4 v44, s[8:11], s22 offen  lds
    s_add_u32 m0, s48, 126976
    s_mov_b32 s22, 3768320
    buffer_load_dwordx4 v44, s[8:11], s22 offen  lds
    s_waitcnt vmcnt(28)
    s_barrier
    v_add_u32 v48, 0, v46
    ds_read_b64_tr_b16 v[64:65], v48 offset:0
    ds_read_b64_tr_b16 v[66:67], v48 offset:512
    ds_read_b64_tr_b16 v[68:69], v48 offset:8192
    ds_read_b64_tr_b16 v[70:71], v48 offset:8704
    ds_read_b64_tr_b16 v[72:73], v48 offset:8
    ds_read_b64_tr_b16 v[74:75], v48 offset:520
    ds_read_b64_tr_b16 v[76:77], v48 offset:8200
    ds_read_b64_tr_b16 v[78:79], v48 offset:8712
    s_waitcnt lgkmcnt(0)
    s_barrier
    ds_write_b128 v32, v[64:67] offset:0
    ds_write_b128 v32, v[68:71] offset:1024
    ds_write_b128 v32, v[72:75] offset:2048
    ds_write_b128 v32, v[76:79] offset:3072
    s_waitcnt lgkmcnt(0)
    s_waitcnt vmcnt(24)
    s_barrier
    v_add_u32 v48, 16384, v46
    ds_read_b64_tr_b16 v[64:65], v48 offset:0
    ds_read_b64_tr_b16 v[66:67], v48 offset:512
    ds_read_b64_tr_b16 v[68:69], v48 offset:8192
    ds_read_b64_tr_b16 v[70:71], v48 offset:8704
    ds_read_b64_tr_b16 v[72:73], v48 offset:8
    ds_read_b64_tr_b16 v[74:75], v48 offset:520
    ds_read_b64_tr_b16 v[76:77], v48 offset:8200
    ds_read_b64_tr_b16 v[78:79], v48 offset:8712
    s_waitcnt lgkmcnt(0)
    s_barrier
    ds_write_b128 v32, v[64:67] offset:16384
    ds_write_b128 v32, v[68:71] offset:17408
    ds_write_b128 v32, v[72:75] offset:18432
    ds_write_b128 v32, v[76:79] offset:19456
    s_waitcnt lgkmcnt(0)
    s_waitcnt vmcnt(20)
    s_barrier
    s_getpc_b64 s[16:17]
mega_kernel_rs_pc0:
    s_add_u32 s16, s16, mega_kernel_rs_w0_entry - mega_kernel_rs_pc0
    s_addc_u32 s17, s17, 0
    v_lshlrev_b32 v49, 7, v0
    v_min_u32 v49, mega_kernel_rs_end - mega_kernel_rs_w0_entry, v49
    global_load_dword v50, v49, s[16:17]
    v_lshlrev_b32 v49, 7, v40
    s_xor_b32 s23, s35, 16384
    s_cmp_eq_u32 s20, 1
    s_cselect_b32 s22, s35, s47
    s_cmp_eq_u32 s20, 2
    s_cselect_b32 s22, s23, s22
    s_lshl_b32 s23, s31, 13
    s_add_u32 s23, s23, 178257920
    s_cmp_eq_u32 s20, 3
    s_cselect_b32 s22, s23, s22
    buffer_load_dword v51, v49, s[4:7], s22 offen sc1
    v_lshlrev_b32 v49, 13, v0
    v_and_b32 v49, 0x1fffff, v49
    s_mov_b32 s22, 67108864
    buffer_load_dword v52, v49, s[4:7], s22 offen sc1
    buffer_load_dword v57, v7, s[4:7], 0 offen sc1
    v_add_u32 v48, 32768, v46
    ds_read_b64_tr_b16 v[64:65], v48 offset:0
    ds_read_b64_tr_b16 v[66:67], v48 offset:512
    ds_read_b64_tr_b16 v[68:69], v48 offset:8192
    ds_read_b64_tr_b16 v[70:71], v48 offset:8704
    ds_read_b64_tr_b16 v[72:73], v48 offset:8
    ds_read_b64_tr_b16 v[74:75], v48 offset:520
    ds_read_b64_tr_b16 v[76:77], v48 offset:8200
    ds_read_b64_tr_b16 v[78:79], v48 offset:8712
    s_waitcnt lgkmcnt(0)
    s_barrier
    ds_write_b128 v32, v[64:67] offset:32768
    ds_write_b128 v32, v[68:71] offset:33792
    ds_write_b128 v32, v[72:75] offset:34816
    ds_write_b128 v32, v[76:79] offset:35840
    s_waitcnt lgkmcnt(0)
    s_waitcnt vmcnt(16)
    s_barrier
    v_add_u32 v48, 49152, v46
    ds_read_b64_tr_b16 v[64:65], v48 offset:0
    ds_read_b64_tr_b16 v[66:67], v48 offset:512
    ds_read_b64_tr_b16 v[68:69], v48 offset:8192
    ds_read_b64_tr_b16 v[70:71], v48 offset:8704
    ds_read_b64_tr_b16 v[72:73], v48 offset:8
    ds_read_b64_tr_b16 v[74:75], v48 offset:520
    ds_read_b64_tr_b16 v[76:77], v48 offset:8200
    ds_read_b64_tr_b16 v[78:79], v48 offset:8712
    s_waitcnt lgkmcnt(0)
    s_barrier
    ds_write_b128 v32, v[64:67] offset:49152
    ds_write_b128 v32, v[68:71] offset:50176
    ds_write_b128 v32, v[72:75] offset:51200
    ds_write_b128 v32, v[76:79] offset:52224
    s_waitcnt lgkmcnt(0)
    s_waitcnt vmcnt(12)
    s_barrier
    v_add_u32 v48, 65536, v46
    ds_read_b64_tr_b16 v[64:65], v48 offset:0
    ds_read_b64_tr_b16 v[66:67], v48 offset:512
    ds_read_b64_tr_b16 v[68:69], v48 offset:8192
    ds_read_b64_tr_b16 v[70:71], v48 offset:8704
    ds_read_b64_tr_b16 v[72:73], v48 offset:8
    ds_read_b64_tr_b16 v[74:75], v48 offset:520
    ds_read_b64_tr_b16 v[76:77], v48 offset:8200
    ds_read_b64_tr_b16 v[78:79], v48 offset:8712
    s_waitcnt lgkmcnt(0)
    s_barrier
    ds_write_b128 v33, v[64:67] offset:0
    ds_write_b128 v33, v[68:71] offset:1024
    ds_write_b128 v33, v[72:75] offset:2048
    ds_write_b128 v33, v[76:79] offset:3072
    s_waitcnt lgkmcnt(0)
    s_waitcnt vmcnt(8)
    s_barrier
    v_add_u32 v48, 81920, v46
    ds_read_b64_tr_b16 v[208:209], v48 offset:0
    ds_read_b64_tr_b16 v[210:211], v48 offset:512
    ds_read_b64_tr_b16 v[212:213], v48 offset:8192
    ds_read_b64_tr_b16 v[214:215], v48 offset:8704
    ds_read_b64_tr_b16 v[216:217], v48 offset:8
    ds_read_b64_tr_b16 v[218:219], v48 offset:520
    ds_read_b64_tr_b16 v[220:221], v48 offset:8200
    ds_read_b64_tr_b16 v[222:223], v48 offset:8712
    s_waitcnt lgkmcnt(0)
    s_barrier
    ds_write_b128 v33, v[80:83] offset:16384
    ds_write_b128 v33, v[84:87] offset:17408
    ds_write_b128 v33, v[88:91] offset:18432
    ds_write_b128 v33, v[92:95] offset:19456
    s_waitcnt lgkmcnt(0)
    s_waitcnt vmcnt(4)
    s_barrier
    v_add_u32 v48, 98304, v46
    ds_read_b64_tr_b16 v[224:225], v48 offset:0
    ds_read_b64_tr_b16 v[226:227], v48 offset:512
    ds_read_b64_tr_b16 v[228:229], v48 offset:8192
    ds_read_b64_tr_b16 v[230:231], v48 offset:8704
    ds_read_b64_tr_b16 v[232:233], v48 offset:8
    ds_read_b64_tr_b16 v[234:235], v48 offset:520
    ds_read_b64_tr_b16 v[236:237], v48 offset:8200
    ds_read_b64_tr_b16 v[238:239], v48 offset:8712
    s_waitcnt lgkmcnt(0)
    s_barrier
    ds_write_b128 v33, v[96:99] offset:32768
    ds_write_b128 v33, v[100:103] offset:33792
    ds_write_b128 v33, v[104:107] offset:34816
    ds_write_b128 v33, v[108:111] offset:35840
    s_waitcnt lgkmcnt(0)
    s_waitcnt vmcnt(0)
    s_barrier
    v_add_u32 v48, 114688, v46
    ds_read_b64_tr_b16 v[240:241], v48 offset:0
    ds_read_b64_tr_b16 v[242:243], v48 offset:512
    ds_read_b64_tr_b16 v[244:245], v48 offset:8192
    ds_read_b64_tr_b16 v[246:247], v48 offset:8704
    ds_read_b64_tr_b16 v[248:249], v48 offset:8
    ds_read_b64_tr_b16 v[250:251], v48 offset:520
    ds_read_b64_tr_b16 v[252:253], v48 offset:8200
    ds_read_b64_tr_b16 v[254:255], v48 offset:8712
    s_waitcnt lgkmcnt(0)
    s_barrier
    ds_write_b128 v33, v[112:115] offset:49152
    ds_write_b128 v33, v[116:119] offset:50176
    ds_write_b128 v33, v[120:123] offset:51200
    ds_write_b128 v33, v[124:127] offset:52224
    s_waitcnt lgkmcnt(0)
mega_kernel_rs_iw:
    buffer_load_dword v58, off, s[12:15], 0 offset:204 sc1
    s_waitcnt vmcnt(0)
mega_kernel_rs_iw1:
    v_and_b32 v50, 0xffff, v58
    v_readfirstlane_b32 s60, v58
    v_cmp_ne_u32 vcc, s100, v50
    s_cbranch_vccnz mega_kernel_rs_iw
    s_lshr_b32 s60, s60, 15
    s_cmp_gt_u32 s60, s100
    s_cselect_b32 s60, 8192, 0
    s_bfe_u32 s22, s31, 0x10001
    s_lshl_b32 s22, s22, 12
    s_add_u32 s22, s22, s60
    s_lshl_b32 s23, s20, 10
    s_add_u32 s22, s22, s23
    s_add_u32 s38, s38, s22
    s_add_u32 s37, s37, s22
    s_xor_b32 s40, s38, 4096
    s_xor_b32 s39, s37, 4096
    s_xor_b32 s36, s35, 16384
    s_mov_b32 s21, 0
    s_cmp_eq_u32 s30, 0
    s_mov_b32 s22, 0x33003300
    s_cselect_b32 s16, 0x00330033, s22
    s_mov_b32 s17, s16
    s_cselect_b32 s18, -1, 0
    s_not_b32 s19, s18
    s_lshl_b32 s22, s31, 13
    s_lshl_b32 s23, s20, 11
    s_add_u32 s22, s22, s23
    s_add_u32 s43, s22, 16777216
    s_add_u32 s44, s22, 33554432
    s_lshl_b32 s45, s31, 13
    s_add_u32 s45, s45, 178257920
    s_mul_i32 s48, s20, 3072
    s_add_u32 m0, s48, 140288
    s_mov_b32 s41, 1
    s_mov_b32 s42, 1
    v_mov_b32 v0, v34
    v_bfrev_b32 v3, 1
    v_cndmask_b32 v10, v3, v10, s[16:17]
    v_cndmask_b32 v9, v3, v9, s[26:27]
    s_sub_u32 s45, s45, 262144
    s_lshl_b32 s51, s30, 11
    s_add_u32 s51, s51, s45
    s_mov_b32 s50, 0
    s_cmp_lg_u32 s20, 3
    s_cbranch_scc1 mega_kernel_rs_kv0
    v_readlane_b32 s50, v57, 0
    v_readlane_b32 s22, v57, 2
    v_readlane_b32 s23, v57, 1
    v_readlane_b32 s24, v57, 3
    s_nop 3
    s_min_u32 s50, s50, s22
    s_min_u32 s23, s23, s24
    s_lshl_b32 s50, s50, 1
    s_lshl_b32 s23, s23, 1
    s_add_u32 s23, s23, 1
    s_min_u32 s50, s50, s23
mega_kernel_rs_kvb0:
    s_add_u32 s22, s21, 0
    s_min_u32 s22, s22, 63
    s_cmp_gt_u32 s50, s22
    s_cbranch_scc1 mega_kernel_rs_kvd0
    buffer_load_dword v48, v7, s[4:7], 0 offen sc1
    s_waitcnt vmcnt(0)
    v_readlane_b32 s50, v48, 0
    v_readlane_b32 s22, v48, 2
    v_readlane_b32 s23, v48, 1
    v_readlane_b32 s24, v48, 3
    s_nop 3
    s_min_u32 s50, s50, s22
    s_min_u32 s23, s23, s24
    s_lshl_b32 s50, s50, 1
    s_lshl_b32 s23, s23, 1
    s_add_u32 s23, s23, 1
    s_min_u32 s50, s50, s23
    s_branch mega_kernel_rs_kvb0
mega_kernel_rs_kvd0:
mega_kernel_rs_kv0:
    s_barrier
    s_cmp_eq_u32 s20, 1
    s_cbranch_scc1 mega_kernel_rs_w1_entry
    s_cmp_eq_u32 s20, 2
    s_cbranch_scc1 mega_kernel_rs_w2_entry
    s_cmp_eq_u32 s20, 3
    s_cbranch_scc1 mega_kernel_rs_w3_entry
mega_kernel_rs_w0_entry:
    v_mfma_f32_32x32x8_bf16 v[96:111], v[14:15], v[14:15], 0
    v_mfma_f32_16x16x16_bf16 v[112:115], v[14:15], v[14:15], 0
    v_mfma_f32_16x16x16_bf16 v[116:119], v[14:15], v[14:15], 0
    ds_read_b128 v[64:67], v1 offset:0
    ds_read_b128 v[68:71], v1 offset:1024
    ds_read_b128 v[72:75], v1 offset:2048
    ds_read_b128 v[76:79], v1 offset:3072
    ds_read_b128 v[80:83], v1 offset:16384
    ds_read_b128 v[84:87], v1 offset:17408
    ds_read_b128 v[88:91], v1 offset:18432
    ds_read_b128 v[92:95], v1 offset:19456
    buffer_load_dwordx4 v[120:123], v1, s[4:7], s44 offen
    buffer_load_dwordx4 v[124:127], v1, s[4:7], s44 offen offset:1024
    s_add_u32 s44, s44, 262144
mega_kernel_rs_w0_loop:
    s_add_u32 s22, s35, 0
    s_waitcnt vmcnt(0)
    buffer_load_dwordx4 v[32:35], v12, s[4:7], s22 offen sc1
    buffer_load_dwordx4 v[36:39], v12, s[4:7], s22 offen offset:1024 sc1
mega_kernel_rs_w0_pa:
    s_waitcnt vmcnt(1)
    ds_write_b128 v6, v[32:35] offset:0
    s_waitcnt vmcnt(0)
    ds_write_b128 v6, v[36:39] offset:1024
    v_max3_u32 v3, v32, v34, v36
    v_max_u32 v3, v3, v38
    v_cmp_eq_u32 vcc, -1, v3
    v_smfmac_f32_16x16x64_bf16 v[96:99], v[32:35], a[0:7], v2
    v_smfmac_f32_16x16x64_bf16 v[100:103], v[32:35], a[8:15], v2
    v_smfmac_f32_16x16x64_bf16 v[104:107], v[32:35], a[128:135], v2
    s_cbranch_vccnz mega_kernel_rs_w0_pafail
    s_waitcnt lgkmcnt(0)
    s_barrier
    ds_read_b128 v[40:43], v6 offset:2048
    ds_read_b128 v[44:47], v6 offset:3072
    v_smfmac_f32_16x16x64_bf16 v[108:111], v[32:35], a[136:143], v2
    ds_read_b128 v[48:51], v6 offset:4096
    v_smfmac_f32_16x16x64_bf16 v[96:99], v[36:39], a[16:23], v2
    ds_read_b128 v[52:55], v6 offset:5120
    v_smfmac_f32_16x16x64_bf16 v[100:103], v[36:39], a[24:31], v2
    ds_read_b128 v[56:59], v6 offset:6144
    v_smfmac_f32_16x16x64_bf16 v[104:107], v[36:39], a[144:151], v2
    ds_read_b128 v[60:63], v6 offset:7168
    v_smfmac_f32_16x16x64_bf16 v[108:111], v[36:39], a[152:159], v2
    buffer_load_dwordx4 v1, s[4:7], s43 offen lds
    s_waitcnt lgkmcnt(5)
    v_smfmac_f32_16x16x64_bf16 v[96:99], v[40:43], a[32:39], v2
    v_smfmac_f32_16x16x64_bf16 v[100:103], v[40:43], a[40:47], v2
    v_smfmac_f32_16x16x64_bf16 v[104:107], v[40:43], a[160:167], v2
    v_smfmac_f32_16x16x64_bf16 v[108:111], v[40:43], a[168:175], v2
    buffer_load_dwordx4 v1, s[4:7], s43 offen offset:1024 lds
    s_waitcnt lgkmcnt(4)
    v_smfmac_f32_16x16x64_bf16 v[96:99], v[44:47], a[48:55], v2
    v_smfmac_f32_16x16x64_bf16 v[100:103], v[44:47], a[56:63], v2
    v_smfmac_f32_16x16x64_bf16 v[104:107], v[44:47], a[176:183], v2
    v_smfmac_f32_16x16x64_bf16 v[108:111], v[44:47], a[184:191], v2
    buffer_store_dwordx4 v[20:23], v10, s[4:7], s45 offen offset:0 sc1
    s_waitcnt lgkmcnt(3)
    v_smfmac_f32_16x16x64_bf16 v[96:99], v[48:51], a[64:71], v2
    v_smfmac_f32_16x16x64_bf16 v[100:103], v[48:51], a[72:79], v2
    v_smfmac_f32_16x16x64_bf16 v[104:107], v[48:51], a[192:199], v2
    v_smfmac_f32_16x16x64_bf16 v[108:111], v[48:51], a[200:207], v2
    buffer_store_dwordx2 v[18:19], v11, s[4:7], s51 offen offset:2048 sc1
    s_waitcnt lgkmcnt(2)
    v_smfmac_f32_16x16x64_bf16 v[96:99], v[52:55], a[80:87], v2
    v_smfmac_f32_16x16x64_bf16 v[100:103], v[52:55], a[88:95], v2
    v_smfmac_f32_16x16x64_bf16 v[104:107], v[52:55], a[208:215], v2
    v_smfmac_f32_16x16x64_bf16 v[108:111], v[52:55], a[216:223], v2
    s_waitcnt lgkmcnt(1)
    v_smfmac_f32_16x16x64_bf16 v[96:99], v[56:59], a[96:103], v2
    v_smfmac_f32_16x16x64_bf16 v[100:103], v[56:59], a[104:111], v2
    v_smfmac_f32_16x16x64_bf16 v[104:107], v[56:59], a[224:231], v2
    v_smfmac_f32_16x16x64_bf16 v[108:111], v[56:59], a[232:239], v2
    s_waitcnt lgkmcnt(0)
    v_smfmac_f32_16x16x64_bf16 v[96:99], v[60:63], a[112:119], v2
    v_smfmac_f32_16x16x64_bf16 v[100:103], v[60:63], a[120:127], v2
    v_smfmac_f32_16x16x64_bf16 v[104:107], v[60:63], a[240:247], v2
    v_smfmac_f32_16x16x64_bf16 v[108:111], v[60:63], a[248:255], v2
    s_nop 4
    v_pk_add_f32 v[96:97], v[96:97], v[98:99]
    v_pk_add_f32 v[100:101], v[100:101], v[102:103]
    v_pk_add_f32 v[104:105], v[104:105], v[106:107]
    v_pk_add_f32 v[108:109], v[108:109], v[110:111]
    v_cvt_pk_bf16_f32 v111, v108, v109
    v_cvt_pk_bf16_f32 v108, v96, v97
    v_cvt_pk_bf16_f32 v110, v100, v101
    v_cvt_pk_bf16_f32 v109, v104, v105
    v_and_or_b32 v108, v108, -2, s41
    buffer_store_dwordx4 v[108:111], v1, s[4:7], s37 offen sc1
    v_smfmac_f32_16x16x64_bf16 v[112:115], v[32:35], v[64:71], v2
    ds_read_b128 v[64:67], v1 offset:32768
    ds_read_b128 v[68:71], v1 offset:33792
    v_smfmac_f32_16x16x64_bf16 v[116:119], v[32:35], v[72:79], v2
    ds_read_b128 v[72:75], v1 offset:34816
    ds_read_b128 v[76:79], v1 offset:35840
    v_smfmac_f32_16x16x64_bf16 v[112:115], v[36:39], v[80:87], v2
    ds_read_b128 v[80:83], v1 offset:49152
    ds_read_b128 v[84:87], v1 offset:50176
    v_smfmac_f32_16x16x64_bf16 v[116:119], v[36:39], v[88:95], v2
    ds_read_b128 v[88:91], v1 offset:51200
    ds_read_b128 v[92:95], v1 offset:52224
    v_smfmac_f32_16x16x64_bf16 v[112:115], v[52:55], v[208:215], v2
    v_smfmac_f32_16x16x64_bf16 v[116:119], v[52:55], v[216:223], v2
    v_smfmac_f32_16x16x64_bf16 v[112:115], v[56:59], v[224:231], v2
    s_waitcnt lgkmcnt(6)
    v_smfmac_f32_16x16x64_bf16 v[112:115], v[40:43], v[64:71], v2
    ds_read_b128 v[64:67], v5 offset:0
    ds_read_b128 v[68:71], v5 offset:1024
    s_waitcnt lgkmcnt(6)
    v_smfmac_f32_16x16x64_bf16 v[116:119], v[40:43], v[72:79], v2
    ds_read_b128 v[72:75], v5 offset:2048
    ds_read_b128 v[76:79], v5 offset:3072
    v_smfmac_f32_16x16x64_bf16 v[116:119], v[56:59], v[232:239], v2
    v_smfmac_f32_16x16x64_bf16 v[112:115], v[60:63], v[240:247], v2
    v_smfmac_f32_16x16x64_bf16 v[116:119], v[60:63], v[248:255], v2
    s_waitcnt lgkmcnt(6)
    v_smfmac_f32_16x16x64_bf16 v[112:115], v[44:47], v[80:87], v2
    s_waitcnt lgkmcnt(4)
    v_smfmac_f32_16x16x64_bf16 v[116:119], v[44:47], v[88:95], v2
    s_waitcnt lgkmcnt(2)
    v_smfmac_f32_16x16x64_bf16 v[112:115], v[48:51], v[64:71], v2
    s_waitcnt lgkmcnt(0)
    v_smfmac_f32_16x16x64_bf16 v[116:119], v[48:51], v[72:79], v2
    v_mfma_f32_16x16x16_bf16 v[100:103], v[108:109], v[16:17], 0
    v_mfma_f32_16x16x16_bf16 v[104:107], v[110:111], v[16:17], 0
    s_nop 4
    v_add_f32 v112, v112, v114
    v_add_f32 v113, v113, v115
    v_add_f32 v114, v116, v118
    v_add_f32 v115, v117, v119
    v_cvt_pk_bf16_f32 v18, v112, v113
    v_cvt_pk_bf16_f32 v19, v114, v115
    v_and_or_b32 v18, v18, -2, s41
    v_mov_b32 v112, v18
    v_mov_b32 v114, v19
    v_mov_b32 v92, v28
    v_mov_b32 v93, 0
    s_waitcnt vmcnt(3)
    s_barrier
    ds_read_b128 v[32:35], v6 offset:9216
    ds_read_b128 v[36:39], v6 offset:10240
    ds_read_b128 v[40:43], v6 offset:12288
    ds_read_b128 v[44:47], v6 offset:13312
    ds_read_b128 v[48:51], v6 offset:15360
    ds_read_b128 v[52:55], v6 offset:16384
    ds_read_b128 v[56:59], v6 offset:18432
    ds_read_b128 v[60:63], v6 offset:19456
    buffer_load_dwordx4 v[96:99], v1, s[4:7], s38 offen sc1
    s_barrier
    buffer_store_dwordx2 v[18:19], v11, s[4:7], s39 offen sc1
    s_nop 15
    s_nop 15
    buffer_load_dwordx4 v[20:23], v1, s[4:7], s38 offen sc1
    s_waitcnt vmcnt(2)
    v_mfma_f32_16x16x16_bf16 v[80:83], v[96:97], v[16:17], v[100:103]
    v_mfma_f32_16x16x16_bf16 v[84:87], v[98:99], v[16:17], v[104:107]
    v_and_b32 v3, 1, v96
    v_cmp_ne_u32 vcc, s41, v3
    s_nop 4
    v_cvt_pk_bf16_f32 v64, v80, v81
    v_cvt_pk_bf16_f32 v65, v82, v83
    v_cvt_pk_bf16_f32 v66, v84, v85
    v_cvt_pk_bf16_f32 v67, v86, v87
    ds_write_b128 v6, v[64:67] offset:8192
    s_cbranch_vccnz mega_kernel_rs_w0_xslow
mega_kernel_rs_w0_xok:
    s_cmp_eq_u32 s21, 63
    s_cbranch_scc1 mega_kernel_rs_w0_last
    buffer_load_dwordx2 v[116:117], v11, s[4:7], s40 offen sc1
    s_waitcnt lgkmcnt(1)
    v_mfma_f32_16x16x32_bf16 v[80:83], v[32:35], v[64:67], 0
    s_waitcnt lgkmcnt(0)
    s_barrier
    ds_read_b128 v[68:71], v6 offset:11264
    ds_read_b128 v[72:75], v6 offset:14336
    ds_read_b128 v[76:79], v6 offset:17408
    v_mfma_f32_16x16x32_bf16 v[84:87], v[36:39], v[64:67], 0
    v_mfma_f32_16x16x32_bf16 v[88:91], v[64:67], v[64:67], 0
    buffer_load_dwordx2 v[20:21], v11, s[4:7], s40 offen sc1
    s_waitcnt lgkmcnt(2)
    v_mfma_f32_16x16x32_bf16 v[80:83], v[40:43], v[68:71], v[80:83]
    v_mfma_f32_16x16x32_bf16 v[84:87], v[44:47], v[68:71], v[84:87]
    v_mfma_f32_16x16x32_bf16 v[88:91], v[68:71], v[68:71], v[88:91]
    s_waitcnt lgkmcnt(1)
    v_mfma_f32_16x16x32_bf16 v[80:83], v[48:51], v[72:75], v[80:83]
    v_mfma_f32_16x16x32_bf16 v[84:87], v[52:55], v[72:75], v[84:87]
    v_mfma_f32_16x16x32_bf16 v[88:91], v[72:75], v[72:75], v[88:91]
    s_waitcnt lgkmcnt(0)
    v_mfma_f32_16x16x32_bf16 v[80:83], v[56:59], v[76:79], v[80:83]
    v_mfma_f32_16x16x32_bf16 v[84:87], v[60:63], v[76:79], v[84:87]
    v_mfma_f32_16x16x32_bf16 v[88:91], v[76:79], v[76:79], v[88:91]
    v_mfma_f32_32x32x4_2b_bf16 v[32:63], v[14:15], v[14:15], 0
    s_nop 4
    v_max3_f32 v4, v80, v81, v82
    v_max3_f32 v4, v4, v83, v84
    v_max3_f32 v4, v4, v85, v86
    v_max3_f32 v4, v4, v87, v88
    v_max_f32 v90, v4, v89
    v_max_f32 v4, v4, v89
    s_nop 0
    s_nop 0
    v_permlane16_swap_b32 v4, v90
    v_max_f32 v4, v4, v90
    v_max_f32 v90, v4, v90
    s_nop 1
    v_permlane32_swap_b32 v4, v90
    v_max_f32 v4, v4, v90
    v_mul_f32 v4, s34, v4
    v_pk_fma_f32 v[80:81], v[80:81], s[34:35], v[4:5] op_sel_hi:[1,0,0] neg_lo:[0,0,1] neg_hi:[0,0,1]
    v_pk_fma_f32 v[82:83], v[82:83], s[34:35], v[4:5] op_sel_hi:[1,0,0] neg_lo:[0,0,1] neg_hi:[0,0,1]
    v_pk_fma_f32 v[84:85], v[84:85], s[34:35], v[4:5] op_sel_hi:[1,0,0] neg_lo:[0,0,1] neg_hi:[0,0,1]
    v_pk_fma_f32 v[86:87], v[86:87], s[34:35], v[4:5] op_sel_hi:[1,0,0] neg_lo:[0,0,1] neg_hi:[0,0,1]
    v_pk_fma_f32 v[88:89], v[88:89], s[34:35], v[4:5] op_sel_hi:[1,0,0] neg_lo:[0,0,1] neg_hi:[0,0,1]
    v_exp_f32 v80, v80
    v_exp_f32 v81, v81
    v_exp_f32 v82, v82
    v_cvt_pk_bf16_f32 v68, v80, v81
    v_exp_f32 v83, v83
    v_exp_f32 v84, v84
    v_cvt_pk_bf16_f32 v69, v82, v83
    v_exp_f32 v85, v85
    v_exp_f32 v86, v86
    v_cvt_pk_bf16_f32 v70, v84, v85
    v_exp_f32 v87, v87
    v_exp_f32 v88, v88
    v_cvt_pk_bf16_f32 v71, v86, v87
    v_exp_f32 v89, v89
    s_nop 0
    v_mfma_f32_16x16x32_bf16 v[76:79], v[28:31], v[68:71], 0
    v_cvt_pk_bf16_f32 v72, v88, v89
    v_cvt_pk_bf16_f32 v73, v88, v89
    v_mfma_f32_16x16x32_bf16 v[100:103], v[120:123], v[68:71], 0
    s_waitcnt vmcnt(1)
    v_and_b32 v3, 1, v116
    v_cmp_ne_u32 vcc, s41, v3
    v_mfma_f32_16x16x32_bf16 v[104:107], v[124:127], v[68:71], 0
    v_mov_b32 v113, v116
    v_mov_b32 v115, v117
    v_mfma_f32_16x16x16_bf16 v[76:79], v[92:93], v[72:73], v[76:79]
    s_cbranch_vccnz mega_kernel_rs_w0_pv0
mega_kernel_rs_w0_pv2:
    v_mfma_f32_16x16x16_bf16 v[100:103], v[112:113], v[72:73], v[100:103]
    v_mfma_f32_16x16x16_bf16 v[104:107], v[114:115], v[72:73], v[104:107]
    buffer_load_dwordx4 v[120:123], v1, s[4:7], s44 offen
    buffer_load_dwordx4 v[124:127], v1, s[4:7], s44 offen offset:1024
    s_nop 2
    v_rcp_f32 v76, v76
    s_mov_b64 exec, s[28:29]
    v_pk_mul_f32 v[100:101], v[100:101], v[76:77] op_sel_hi:[1,0]
    v_pk_mul_f32 v[102:103], v[102:103], v[76:77] op_sel_hi:[1,0]
    v_pk_mul_f32 v[104:105], v[104:105], v[76:77] op_sel_hi:[1,0]
    v_pk_mul_f32 v[106:107], v[106:107], v[76:77] op_sel_hi:[1,0]
    v_cvt_pk_bf16_f32 v72, v100, v101
    v_cvt_pk_bf16_f32 v73, v102, v103
    v_cvt_pk_bf16_f32 v74, v104, v105
    v_cvt_pk_bf16_f32 v75, v106, v107
    ds_write_b128 v6, v[72:75] offset:20448
    s_mov_b64 exec, -1
    ds_read_b128 v[88:91], v5 offset:16384
    ds_read_b128 v[92:95], v5 offset:17408
    ds_read_b128 v[80:83], v5 offset:18432
    ds_read_b128 v[84:87], v5 offset:19456
    ds_read_b128 v[112:115], v5 offset:32768
    ds_read_b128 v[116:119], v5 offset:33792
    v_mov_b32 v3, s21
    buffer_store_dword v3, v7, s[4:7], 0 offen sc1
    s_waitcnt lgkmcnt(6)
    s_barrier
    ds_read_b128 v[68:71], v6 offset:20480
    ds_read_b128 v[72:75], v6 offset:21504
    ds_read_b128 v[96:99], v5 offset:34816
    ds_read_b128 v[100:103], v5 offset:35840
    ds_read_b128 v[104:107], v5 offset:49152
    ds_read_b128 v[108:111], v5 offset:50176
    s_waitcnt lgkmcnt(5)
    v_smfmac_f32_16x16x64_bf16 v[32:35], v[68:71], v[128:135], v2
    s_add_u32 s21, s21, 1
    v_smfmac_f32_16x16x64_bf16 v[36:39], v[68:71], v[136:143], v2
    s_xor_b32 s38, s38, 1048576
    v_smfmac_f32_16x16x64_bf16 v[40:43], v[68:71], v[144:151], v2
    s_xor_b32 s37, s37, 1048576
    v_smfmac_f32_16x16x64_bf16 v[44:47], v[68:71], v[152:159], v2
    s_xor_b32 s40, s40, 1048576
    s_waitcnt lgkmcnt(4)
    v_smfmac_f32_16x16x64_bf16 v[32:35], v[72:75], v[160:167], v2
    s_xor_b32 s39, s39, 1048576
    v_smfmac_f32_16x16x64_bf16 v[36:39], v[72:75], v[168:175], v2
    s_lshr_b32 s41, s21, 1
    v_smfmac_f32_16x16x64_bf16 v[40:43], v[72:75], v[176:183], v2
    s_and_b32 s41, s41, 1
    v_smfmac_f32_16x16x64_bf16 v[44:47], v[72:75], v[184:191], v2
    s_xor_b32 s41, s41, 1
    v_smfmac_f32_16x16x64_bf16 v[48:51], v[68:71], v[192:199], v2
    s_xor_b32 s35, s35, 16384
    v_smfmac_f32_16x16x64_bf16 v[52:55], v[68:71], v[200:207], v2
    s_xor_b32 s36, s36, 16384
    s_waitcnt lgkmcnt(0)
    v_smfmac_f32_16x16x64_bf16 v[56:59], v[68:71], v[88:95], v2
    ds_read_b128 v[88:91], v5 offset:51200
    ds_read_b128 v[92:95], v5 offset:52224
    v_smfmac_f32_16x16x64_bf16 v[60:63], v[68:71], v[80:87], v2
    s_add_u32 s43, s43, 262144
    v_smfmac_f32_16x16x64_bf16 v[48:51], v[72:75], v[112:119], v2
    s_add_u32 s44, s44, 262144
    v_add_f32 v32, v32, v34
    v_add_f32 v33, v33, v35
    v_cvt_pk_bf16_f32 v32, v32, v33
    v_and_or_b32 v32, v32, -2, s42
    v_smfmac_f32_16x16x64_bf16 v[52:55], v[72:75], v[96:103], v2
    v_add_f32 v36, v36, v38
    v_add_f32 v37, v37, v39
    v_cvt_pk_bf16_f32 v33, v36, v37
    v_smfmac_f32_16x16x64_bf16 v[56:59], v[72:75], v[104:111], v2
    v_add_f32 v40, v40, v42
    v_add_f32 v41, v41, v43
    v_cvt_pk_bf16_f32 v34, v40, v41
    s_waitcnt lgkmcnt(0)
    v_smfmac_f32_16x16x64_bf16 v[60:63], v[72:75], v[88:95], v2
    v_add_f32 v44, v44, v46
    v_add_f32 v45, v45, v47
    v_cvt_pk_bf16_f32 v35, v44, v45
    buffer_store_dwordx4 v[32:35], v8, s[4:7], s46 offen sc1
    v_pk_add_f32 v[48:49], v[48:49], v[50:51]
    v_cvt_pk_bf16_f32 v48, v48, v49
    v_and_or_b32 v48, v48, -2, s42
    v_pk_add_f32 v[52:53], v[52:53], v[54:55]
    v_cvt_pk_bf16_f32 v49, v52, v53
    v_pk_add_f32 v[56:57], v[56:57], v[58:59]
    v_cvt_pk_bf16_f32 v50, v56, v57
    v_pk_add_f32 v[60:61], v[60:61], v[62:63]
    v_cvt_pk_bf16_f32 v51, v60, v61
    buffer_store_dwordx4 v[48:51], v8, s[4:7], s61 offen sc1
    s_waitcnt vmcnt(5)
    v_mov_b32 v20, v64
    v_mov_b32 v21, v65
    v_mov_b32 v22, v66
    v_mov_b32 v23, v67
    s_add_u32 s45, s45, 262144
    s_add_u32 s51, s51, 262144
    v_mfma_f32_32x32x8_bf16 v[96:111], v[14:15], v[14:15], 0
    v_mfma_f32_16x16x16_bf16 v[112:115], v[14:15], v[14:15], 0
    v_mfma_f32_16x16x16_bf16 v[116:119], v[14:15], v[14:15], 0
    ds_read_b128 v[64:67], v1 offset:0
    ds_read_b128 v[68:71], v1 offset:1024
    ds_read_b128 v[72:75], v1 offset:2048
    ds_read_b128 v[76:79], v1 offset:3072
    ds_read_b128 v[80:83], v1 offset:16384
    ds_read_b128 v[84:87], v1 offset:17408
    ds_read_b128 v[88:91], v1 offset:18432
    ds_read_b128 v[92:95], v1 offset:19456
    v_mov_b32 v58, -1
    v_mov_b32 v59, -1
    s_waitcnt vmcnt(0)
mega_kernel_rs_w0_pc:
    buffer_load_dword v36, v13, s[4:7], s47 offen offset:0 sc1
    buffer_load_dword v37, v13, s[4:7], s47 offen offset:1024 sc1
    buffer_load_dword v38, v13, s[4:7], s47 offen offset:2048 sc1
    buffer_load_dword v39, v13, s[4:7], s47 offen offset:3072 sc1
    buffer_load_dword v40, v13, s[4:7], s25 offen offset:0 sc1
    buffer_load_dword v41, v13, s[4:7], s25 offen offset:1024 sc1
    buffer_load_dword v42, v13, s[4:7], s25 offen offset:2048 sc1
    buffer_load_dword v43, v13, s[4:7], s25 offen offset:3072 sc1
    s_waitcnt vmcnt(4)
    v_mfma_f32_16x16x32_bf16 v[52:55], v[36:39], v[24:27], 0
    v_bitop3_b32 v3, s42, v36, v37 bitop3:0x7e
    v_bitop3_b32 v4, s42, v38, v39 bitop3:0x7e
    s_waitcnt vmcnt(2)
    v_or_b32 v3, v3, v4
    v_bitop3_b32 v4, s42, v40, v41 bitop3:0x7e
    s_waitcnt vmcnt(0)
    v_mfma_f32_16x16x32_bf16 v[52:55], v[40:43], v[24:27], v[52:55]
    v_bitop3_b32 v56, s42, v42, v43 bitop3:0x7e
    v_or3_b32 v3, v3, v4, v56
    v_and_b32 v3, v0, v3
    v_cmp_ne_u32 vcc, 0, v3
    s_cbranch_vccnz mega_kernel_rs_w0_pc
    s_nop 2
    v_cvt_pk_bf16_f32 v56, v52, v53
    v_cvt_pk_bf16_f32 v57, v54, v55
    v_min_u32 v56, -2, v56
    s_mov_b64 exec, s[26:27]
    buffer_store_dwordx2 v[56:57], v9, s[4:7], s35 offen offset:0 sc1
    buffer_store_dwordx2 v[58:59], v9, s[4:7], s36 offen offset:0 sc1
    s_mov_b64 exec, -1
    s_xor_b32 s42, s42, 1
    s_branch mega_kernel_rs_w0_loop
mega_kernel_rs_w0_last:
    s_add_u32 s45, s45, 262144
    s_add_u32 s51, s51, 262144
    buffer_store_dwordx4 v[64:67], v10, s[4:7], s45 offen offset:0 sc1
    buffer_store_dwordx2 v[18:19], v11, s[4:7], s51 offen offset:2048 sc1
    s_branch mega_kernel_rs_end
mega_kernel_rs_w0_pafail:
    buffer_load_dwordx4 v[32:35], v12, s[4:7], s22 offen sc1
    buffer_load_dwordx4 v[36:39], v12, s[4:7], s22 offen offset:1024 sc1
    s_nop 7
    v_mov_b32 v96, 0
    v_mov_b32 v97, 0
    v_mov_b32 v98, 0
    v_mov_b32 v99, 0
    v_mov_b32 v100, 0
    v_mov_b32 v101, 0
    v_mov_b32 v102, 0
    v_mov_b32 v103, 0
    v_mov_b32 v104, 0
    v_mov_b32 v105, 0
    v_mov_b32 v106, 0
    v_mov_b32 v107, 0
    s_branch mega_kernel_rs_w0_pa
mega_kernel_rs_w0_xslow:
    buffer_load_dwordx4 v[96:99], v1, s[4:7], s38 offen sc1
    s_waitcnt vmcnt(1)
    v_and_b32 v3, 1, v20
    v_cmp_ne_u32 vcc, s41, v3
    s_cbranch_vccz mega_kernel_rs_w0_xgot1
    buffer_load_dwordx4 v[20:23], v1, s[4:7], s38 offen sc1
mega_kernel_rs_w0_px:
    s_waitcnt vmcnt(1)
    v_and_b32 v3, 1, v96
    v_cmp_ne_u32 vcc, s41, v3
    s_cbranch_vccz mega_kernel_rs_w0_xgot0
    buffer_load_dwordx4 v[96:99], v1, s[4:7], s38 offen sc1
    s_waitcnt vmcnt(1)
    v_and_b32 v3, 1, v20
    v_cmp_ne_u32 vcc, s41, v3
    s_cbranch_vccz mega_kernel_rs_w0_xgot1
    buffer_load_dwordx4 v[20:23], v1, s[4:7], s38 offen sc1
    s_branch mega_kernel_rs_w0_px
mega_kernel_rs_w0_xgot0:
    v_mfma_f32_16x16x16_bf16 v[80:83], v[96:97], v[16:17], v[100:103]
    v_mfma_f32_16x16x16_bf16 v[84:87], v[98:99], v[16:17], v[104:107]
    v_and_b32 v3, 1, v96
    v_cmp_ne_u32 vcc, s41, v3
    s_nop 4
    v_cvt_pk_bf16_f32 v64, v80, v81
    v_cvt_pk_bf16_f32 v65, v82, v83
    v_cvt_pk_bf16_f32 v66, v84, v85
    v_cvt_pk_bf16_f32 v67, v86, v87
    ds_write_b128 v6, v[64:67] offset:8192
    s_branch mega_kernel_rs_w0_xok
mega_kernel_rs_w0_xgot1:
    v_mfma_f32_16x16x16_bf16 v[80:83], v[20:21], v[16:17], v[100:103]
    v_mfma_f32_16x16x16_bf16 v[84:87], v[22:23], v[16:17], v[104:107]
    v_and_b32 v3, 1, v20
    v_cmp_ne_u32 vcc, s41, v3
    s_nop 4
    v_cvt_pk_bf16_f32 v64, v80, v81
    v_cvt_pk_bf16_f32 v65, v82, v83
    v_cvt_pk_bf16_f32 v66, v84, v85
    v_cvt_pk_bf16_f32 v67, v86, v87
    ds_write_b128 v6, v[64:67] offset:8192
    s_branch mega_kernel_rs_w0_xok
mega_kernel_rs_w0_pv0:
    s_waitcnt vmcnt(0)
    s_branch mega_kernel_rs_w0_pv1
mega_kernel_rs_w0_pv:
    buffer_load_dwordx2 v[20:21], v11, s[4:7], s40 offen sc1
    s_waitcnt vmcnt(0)
mega_kernel_rs_w0_pv1:
    v_and_b32 v3, 1, v20
    v_cmp_ne_u32 vcc, s41, v3
    v_mov_b32 v113, v20
    v_mov_b32 v115, v21
    s_cbranch_vccnz mega_kernel_rs_w0_pv
    s_branch mega_kernel_rs_w0_pv2
mega_kernel_rs_w1_entry:
    v_mfma_f32_32x32x8_bf16 v[96:111], v[14:15], v[14:15], 0
    v_mfma_f32_16x16x16_bf16 v[112:115], v[14:15], v[14:15], 0
    v_mfma_f32_16x16x16_bf16 v[116:119], v[14:15], v[14:15], 0
    ds_read_b128 v[64:67], v1 offset:4096
    ds_read_b128 v[68:71], v1 offset:5120
    ds_read_b128 v[72:75], v1 offset:6144
    ds_read_b128 v[76:79], v1 offset:7168
    ds_read_b128 v[80:83], v1 offset:20480
    ds_read_b128 v[84:87], v1 offset:21504
    ds_read_b128 v[88:91], v1 offset:22528
    ds_read_b128 v[92:95], v1 offset:23552
    buffer_load_dwordx4 v[120:123], v1, s[4:7], s44 offen
    buffer_load_dwordx4 v[124:127], v1, s[4:7], s44 offen offset:1024
    s_add_u32 s44, s44, 262144
mega_kernel_rs_w1_loop:
    s_add_u32 s22, s35, 2048
    s_waitcnt vmcnt(0)
    buffer_load_dwordx4 v[40:43], v12, s[4:7], s22 offen sc1
    buffer_load_dwordx4 v[44:47], v12, s[4:7], s22 offen offset:1024 sc1
mega_kernel_rs_w1_pa:
    s_waitcnt vmcnt(1)
    ds_write_b128 v6, v[40:43] offset:2048
    s_waitcnt vmcnt(0)
    ds_write_b128 v6, v[44:47] offset:3072
    v_max3_u32 v3, v40, v42, v44
    v_max_u32 v3, v3, v46
    v_cmp_eq_u32 vcc, -1, v3
    v_smfmac_f32_16x16x64_bf16 v[96:99], v[40:43], a[32:39], v2
    v_smfmac_f32_16x16x64_bf16 v[100:103], v[40:43], a[40:47], v2
    v_smfmac_f32_16x16x64_bf16 v[104:107], v[40:43], a[160:167], v2
    s_cbranch_vccnz mega_kernel_rs_w1_pafail
    s_waitcnt lgkmcnt(0)
    s_barrier
    ds_read_b128 v[48:51], v6 offset:4096
    ds_read_b128 v[52:55], v6 offset:5120
    v_smfmac_f32_16x16x64_bf16 v[108:111], v[40:43], a[168:175], v2
    ds_read_b128 v[56:59], v6 offset:6144
    v_smfmac_f32_16x16x64_bf16 v[96:99], v[44:47], a[48:55], v2
    ds_read_b128 v[60:63], v6 offset:7168
    v_smfmac_f32_16x16x64_bf16 v[100:103], v[44:47], a[56:63], v2
    ds_read_b128 v[32:35], v6 offset:0
    v_smfmac_f32_16x16x64_bf16 v[104:107], v[44:47], a[176:183], v2
    ds_read_b128 v[36:39], v6 offset:1024
    v_smfmac_f32_16x16x64_bf16 v[108:111], v[44:47], a[184:191], v2
    buffer_load_dwordx4 v1, s[4:7], s43 offen lds
    s_waitcnt lgkmcnt(5)
    v_smfmac_f32_16x16x64_bf16 v[96:99], v[48:51], a[64:71], v2
    v_smfmac_f32_16x16x64_bf16 v[100:103], v[48:51], a[72:79], v2
    v_smfmac_f32_16x16x64_bf16 v[104:107], v[48:51], a[192:199], v2
    v_smfmac_f32_16x16x64_bf16 v[108:111], v[48:51], a[200:207], v2
    buffer_load_dwordx4 v1, s[4:7], s43 offen offset:1024 lds
    s_waitcnt lgkmcnt(4)
    v_smfmac_f32_16x16x64_bf16 v[96:99], v[52:55], a[80:87], v2
    v_smfmac_f32_16x16x64_bf16 v[100:103], v[52:55], a[88:95], v2
    v_smfmac_f32_16x16x64_bf16 v[104:107], v[52:55], a[208:215], v2
    v_smfmac_f32_16x16x64_bf16 v[108:111], v[52:55], a[216:223], v2
    buffer_store_dwordx4 v[20:23], v10, s[4:7], s45 offen offset:64 sc1
    s_waitcnt lgkmcnt(3)
    v_smfmac_f32_16x16x64_bf16 v[96:99], v[56:59], a[96:103], v2
    v_smfmac_f32_16x16x64_bf16 v[100:103], v[56:59], a[104:111], v2
    v_smfmac_f32_16x16x64_bf16 v[104:107], v[56:59], a[224:231], v2
    v_smfmac_f32_16x16x64_bf16 v[108:111], v[56:59], a[232:239], v2
    buffer_store_dwordx2 v[18:19], v11, s[4:7], s51 offen offset:2560 sc1
    s_waitcnt lgkmcnt(2)
    v_smfmac_f32_16x16x64_bf16 v[96:99], v[60:63], a[112:119], v2
    v_smfmac_f32_16x16x64_bf16 v[100:103], v[60:63], a[120:127], v2
    v_smfmac_f32_16x16x64_bf16 v[104:107], v[60:63], a[240:247], v2
    v_smfmac_f32_16x16x64_bf16 v[108:111], v[60:63], a[248:255], v2
    s_waitcnt lgkmcnt(1)
    v_smfmac_f32_16x16x64_bf16 v[96:99], v[32:35], a[0:7], v2
    v_smfmac_f32_16x16x64_bf16 v[100:103], v[32:35], a[8:15], v2
    v_smfmac_f32_16x16x64_bf16 v[104:107], v[32:35], a[128:135], v2
    v_smfmac_f32_16x16x64_bf16 v[108:111], v[32:35], a[136:143], v2
    s_waitcnt lgkmcnt(0)
    v_smfmac_f32_16x16x64_bf16 v[96:99], v[36:39], a[16:23], v2
    v_smfmac_f32_16x16x64_bf16 v[100:103], v[36:39], a[24:31], v2
    v_smfmac_f32_16x16x64_bf16 v[104:107], v[36:39], a[144:151], v2
    v_smfmac_f32_16x16x64_bf16 v[108:111], v[36:39], a[152:159], v2
    s_nop 4
    v_pk_add_f32 v[96:97], v[96:97], v[98:99]
    v_pk_add_f32 v[100:101], v[100:101], v[102:103]
    v_pk_add_f32 v[104:105], v[104:105], v[106:107]
    v_pk_add_f32 v[108:109], v[108:109], v[110:111]
    v_cvt_pk_bf16_f32 v111, v108, v109
    v_cvt_pk_bf16_f32 v108, v96, v97
    v_cvt_pk_bf16_f32 v110, v100, v101
    v_cvt_pk_bf16_f32 v109, v104, v105
    v_and_or_b32 v108, v108, -2, s41
    buffer_store_dwordx4 v[108:111], v1, s[4:7], s37 offen sc1
    v_smfmac_f32_16x16x64_bf16 v[112:115], v[32:35], v[64:71], v2
    ds_read_b128 v[64:67], v1 offset:36864
    ds_read_b128 v[68:71], v1 offset:37888
    v_smfmac_f32_16x16x64_bf16 v[116:119], v[32:35], v[72:79], v2
    ds_read_b128 v[72:75], v1 offset:38912
    ds_read_b128 v[76:79], v1 offset:39936
    v_smfmac_f32_16x16x64_bf16 v[112:115], v[36:39], v[80:87], v2
    ds_read_b128 v[80:83], v1 offset:53248
    ds_read_b128 v[84:87], v1 offset:54272
    v_smfmac_f32_16x16x64_bf16 v[116:119], v[36:39], v[88:95], v2
    ds_read_b128 v[88:91], v1 offset:55296
    ds_read_b128 v[92:95], v1 offset:56320
    v_smfmac_f32_16x16x64_bf16 v[112:115], v[52:55], v[208:215], v2
    v_smfmac_f32_16x16x64_bf16 v[116:119], v[52:55], v[216:223], v2
    v_smfmac_f32_16x16x64_bf16 v[112:115], v[56:59], v[224:231], v2
    s_waitcnt lgkmcnt(6)
    v_smfmac_f32_16x16x64_bf16 v[112:115], v[40:43], v[64:71], v2
    ds_read_b128 v[64:67], v5 offset:4096
    ds_read_b128 v[68:71], v5 offset:5120
    s_waitcnt lgkmcnt(6)
    v_smfmac_f32_16x16x64_bf16 v[116:119], v[40:43], v[72:79], v2
    ds_read_b128 v[72:75], v5 offset:6144
    ds_read_b128 v[76:79], v5 offset:7168
    v_smfmac_f32_16x16x64_bf16 v[116:119], v[56:59], v[232:239], v2
    v_smfmac_f32_16x16x64_bf16 v[112:115], v[60:63], v[240:247], v2
    v_smfmac_f32_16x16x64_bf16 v[116:119], v[60:63], v[248:255], v2
    s_waitcnt lgkmcnt(6)
    v_smfmac_f32_16x16x64_bf16 v[112:115], v[44:47], v[80:87], v2
    s_waitcnt lgkmcnt(4)
    v_smfmac_f32_16x16x64_bf16 v[116:119], v[44:47], v[88:95], v2
    s_waitcnt lgkmcnt(2)
    v_smfmac_f32_16x16x64_bf16 v[112:115], v[48:51], v[64:71], v2
    s_waitcnt lgkmcnt(0)
    v_smfmac_f32_16x16x64_bf16 v[116:119], v[48:51], v[72:79], v2
    v_mfma_f32_16x16x16_bf16 v[100:103], v[108:109], v[16:17], 0
    v_mfma_f32_16x16x16_bf16 v[104:107], v[110:111], v[16:17], 0
    s_nop 4
    v_add_f32 v112, v112, v114
    v_add_f32 v113, v113, v115
    v_add_f32 v114, v116, v118
    v_add_f32 v115, v117, v119
    v_cvt_pk_bf16_f32 v18, v112, v113
    v_cvt_pk_bf16_f32 v19, v114, v115
    v_and_or_b32 v18, v18, -2, s41
    v_mov_b32 v112, v18
    v_mov_b32 v114, v19
    v_mov_b32 v92, v28
    v_mov_b32 v93, 0
    s_waitcnt vmcnt(3)
    s_barrier
    ds_read_b128 v[32:35], v6 offset:12288
    ds_read_b128 v[36:39], v6 offset:13312
    ds_read_b128 v[40:43], v6 offset:9216
    ds_read_b128 v[44:47], v6 offset:10240
    ds_read_b128 v[48:51], v6 offset:18432
    ds_read_b128 v[52:55], v6 offset:19456
    ds_read_b128 v[56:59], v6 offset:15360
    ds_read_b128 v[60:63], v6 offset:16384
    buffer_load_dwordx4 v[96:99], v1, s[4:7], s38 offen sc1
    s_barrier
    buffer_store_dwordx2 v[18:19], v11, s[4:7], s39 offen sc1
    s_nop 15
    s_nop 15
    buffer_load_dwordx4 v[20:23], v1, s[4:7], s38 offen sc1
    s_waitcnt vmcnt(2)
    v_mfma_f32_16x16x16_bf16 v[80:83], v[96:97], v[16:17], v[100:103]
    v_mfma_f32_16x16x16_bf16 v[84:87], v[98:99], v[16:17], v[104:107]
    v_and_b32 v3, 1, v96
    v_cmp_ne_u32 vcc, s41, v3
    s_nop 4
    v_cvt_pk_bf16_f32 v64, v80, v81
    v_cvt_pk_bf16_f32 v65, v82, v83
    v_cvt_pk_bf16_f32 v66, v84, v85
    v_cvt_pk_bf16_f32 v67, v86, v87
    ds_write_b128 v6, v[64:67] offset:11264
    s_cbranch_vccnz mega_kernel_rs_w1_xslow
mega_kernel_rs_w1_xok:
    s_cmp_eq_u32 s21, 63
    s_cbranch_scc1 mega_kernel_rs_w1_last
    buffer_load_dwordx2 v[116:117], v11, s[4:7], s40 offen sc1
    s_waitcnt lgkmcnt(1)
    v_mfma_f32_16x16x32_bf16 v[80:83], v[32:35], v[64:67], 0
    s_waitcnt lgkmcnt(0)
    s_barrier
    ds_read_b128 v[68:71], v6 offset:8192
    ds_read_b128 v[72:75], v6 offset:17408
    ds_read_b128 v[76:79], v6 offset:14336
    v_mfma_f32_16x16x32_bf16 v[84:87], v[36:39], v[64:67], 0
    v_mfma_f32_16x16x32_bf16 v[88:91], v[64:67], v[64:67], 0
    buffer_load_dwordx2 v[20:21], v11, s[4:7], s40 offen sc1
    s_waitcnt lgkmcnt(2)
    v_mfma_f32_16x16x32_bf16 v[80:83], v[40:43], v[68:71], v[80:83]
    v_mfma_f32_16x16x32_bf16 v[84:87], v[44:47], v[68:71], v[84:87]
    v_mfma_f32_16x16x32_bf16 v[88:91], v[68:71], v[68:71], v[88:91]
    s_waitcnt lgkmcnt(1)
    v_mfma_f32_16x16x32_bf16 v[80:83], v[48:51], v[72:75], v[80:83]
    v_mfma_f32_16x16x32_bf16 v[84:87], v[52:55], v[72:75], v[84:87]
    v_mfma_f32_16x16x32_bf16 v[88:91], v[72:75], v[72:75], v[88:91]
    s_waitcnt lgkmcnt(0)
    v_mfma_f32_16x16x32_bf16 v[80:83], v[56:59], v[76:79], v[80:83]
    v_mfma_f32_16x16x32_bf16 v[84:87], v[60:63], v[76:79], v[84:87]
    v_mfma_f32_16x16x32_bf16 v[88:91], v[76:79], v[76:79], v[88:91]
    v_mfma_f32_32x32x4_2b_bf16 v[32:63], v[14:15], v[14:15], 0
    s_nop 4
    v_max3_f32 v4, v80, v81, v82
    v_max3_f32 v4, v4, v83, v84
    v_max3_f32 v4, v4, v85, v86
    v_max3_f32 v4, v4, v87, v88
    v_max_f32 v90, v4, v89
    v_max_f32 v4, v4, v89
    s_nop 0
    s_nop 0
    v_permlane16_swap_b32 v4, v90
    v_max_f32 v4, v4, v90
    v_max_f32 v90, v4, v90
    s_nop 1
    v_permlane32_swap_b32 v4, v90
    v_max_f32 v4, v4, v90
    v_mul_f32 v4, s34, v4
    v_pk_fma_f32 v[80:81], v[80:81], s[34:35], v[4:5] op_sel_hi:[1,0,0] neg_lo:[0,0,1] neg_hi:[0,0,1]
    v_pk_fma_f32 v[82:83], v[82:83], s[34:35], v[4:5] op_sel_hi:[1,0,0] neg_lo:[0,0,1] neg_hi:[0,0,1]
    v_pk_fma_f32 v[84:85], v[84:85], s[34:35], v[4:5] op_sel_hi:[1,0,0] neg_lo:[0,0,1] neg_hi:[0,0,1]
    v_pk_fma_f32 v[86:87], v[86:87], s[34:35], v[4:5] op_sel_hi:[1,0,0] neg_lo:[0,0,1] neg_hi:[0,0,1]
    v_pk_fma_f32 v[88:89], v[88:89], s[34:35], v[4:5] op_sel_hi:[1,0,0] neg_lo:[0,0,1] neg_hi:[0,0,1]
    v_exp_f32 v80, v80
    v_exp_f32 v81, v81
    v_exp_f32 v82, v82
    v_cvt_pk_bf16_f32 v68, v80, v81
    v_exp_f32 v83, v83
    v_exp_f32 v84, v84
    v_cvt_pk_bf16_f32 v69, v82, v83
    v_exp_f32 v85, v85
    v_exp_f32 v86, v86
    v_cvt_pk_bf16_f32 v70, v84, v85
    v_exp_f32 v87, v87
    v_exp_f32 v88, v88
    v_cvt_pk_bf16_f32 v71, v86, v87
    v_exp_f32 v89, v89
    s_nop 0
    v_mfma_f32_16x16x32_bf16 v[76:79], v[28:31], v[68:71], 0
    v_cvt_pk_bf16_f32 v72, v88, v89
    v_cvt_pk_bf16_f32 v73, v88, v89
    v_mfma_f32_16x16x32_bf16 v[100:103], v[120:123], v[68:71], 0
    s_waitcnt vmcnt(1)
    v_and_b32 v3, 1, v116
    v_cmp_ne_u32 vcc, s41, v3
    v_mfma_f32_16x16x32_bf16 v[104:107], v[124:127], v[68:71], 0
    v_mov_b32 v113, v116
    v_mov_b32 v115, v117
    v_mfma_f32_16x16x16_bf16 v[76:79], v[92:93], v[72:73], v[76:79]
    s_cbranch_vccnz mega_kernel_rs_w1_pv0
mega_kernel_rs_w1_pv2:
    v_mfma_f32_16x16x16_bf16 v[100:103], v[112:113], v[72:73], v[100:103]
    v_mfma_f32_16x16x16_bf16 v[104:107], v[114:115], v[72:73], v[104:107]
    buffer_load_dwordx4 v[120:123], v1, s[4:7], s44 offen
    buffer_load_dwordx4 v[124:127], v1, s[4:7], s44 offen offset:1024
    s_nop 2
    v_rcp_f32 v76, v76
    s_mov_b64 exec, s[28:29]
    v_pk_mul_f32 v[100:101], v[100:101], v[76:77] op_sel_hi:[1,0]
    v_pk_mul_f32 v[102:103], v[102:103], v[76:77] op_sel_hi:[1,0]
    v_pk_mul_f32 v[104:105], v[104:105], v[76:77] op_sel_hi:[1,0]
    v_pk_mul_f32 v[106:107], v[106:107], v[76:77] op_sel_hi:[1,0]
    v_cvt_pk_bf16_f32 v72, v100, v101
    v_cvt_pk_bf16_f32 v73, v102, v103
    v_cvt_pk_bf16_f32 v74, v104, v105
    v_cvt_pk_bf16_f32 v75, v106, v107
    ds_write_b128 v6, v[72:75] offset:20480
    s_mov_b64 exec, -1
    ds_read_b128 v[88:91], v5 offset:20480
    ds_read_b128 v[92:95], v5 offset:21504
    ds_read_b128 v[80:83], v5 offset:22528
    ds_read_b128 v[84:87], v5 offset:23552
    ds_read_b128 v[112:115], v5 offset:36864
    ds_read_b128 v[116:119], v5 offset:37888
    s_waitcnt lgkmcnt(6)
    s_barrier
    ds_read_b128 v[68:71], v6 offset:20480
    ds_read_b128 v[72:75], v6 offset:21504
    ds_read_b128 v[96:99], v5 offset:38912
    ds_read_b128 v[100:103], v5 offset:39936
    ds_read_b128 v[104:107], v5 offset:53248
    ds_read_b128 v[108:111], v5 offset:54272
    s_waitcnt lgkmcnt(5)
    v_smfmac_f32_16x16x64_bf16 v[32:35], v[68:71], v[128:135], v2
    s_add_u32 s21, s21, 1
    v_smfmac_f32_16x16x64_bf16 v[36:39], v[68:71], v[136:143], v2
    s_xor_b32 s38, s38, 1048576
    v_smfmac_f32_16x16x64_bf16 v[40:43], v[68:71], v[144:151], v2
    s_xor_b32 s37, s37, 1048576
    v_smfmac_f32_16x16x64_bf16 v[44:47], v[68:71], v[152:159], v2
    s_xor_b32 s40, s40, 1048576
    s_waitcnt lgkmcnt(4)
    v_smfmac_f32_16x16x64_bf16 v[32:35], v[72:75], v[160:167], v2
    s_xor_b32 s39, s39, 1048576
    v_smfmac_f32_16x16x64_bf16 v[36:39], v[72:75], v[168:175], v2
    s_lshr_b32 s41, s21, 1
    v_smfmac_f32_16x16x64_bf16 v[40:43], v[72:75], v[176:183], v2
    s_and_b32 s41, s41, 1
    v_smfmac_f32_16x16x64_bf16 v[44:47], v[72:75], v[184:191], v2
    s_xor_b32 s41, s41, 1
    v_smfmac_f32_16x16x64_bf16 v[48:51], v[68:71], v[192:199], v2
    s_xor_b32 s35, s35, 16384
    v_smfmac_f32_16x16x64_bf16 v[52:55], v[68:71], v[200:207], v2
    s_xor_b32 s36, s36, 16384
    s_waitcnt lgkmcnt(0)
    v_smfmac_f32_16x16x64_bf16 v[56:59], v[68:71], v[88:95], v2
    ds_read_b128 v[88:91], v5 offset:55296
    ds_read_b128 v[92:95], v5 offset:56320
    v_smfmac_f32_16x16x64_bf16 v[60:63], v[68:71], v[80:87], v2
    s_add_u32 s43, s43, 262144
    v_smfmac_f32_16x16x64_bf16 v[48:51], v[72:75], v[112:119], v2
    s_add_u32 s44, s44, 262144
    v_add_f32 v32, v32, v34
    v_add_f32 v33, v33, v35
    v_cvt_pk_bf16_f32 v32, v32, v33
    v_and_or_b32 v32, v32, -2, s42
    v_smfmac_f32_16x16x64_bf16 v[52:55], v[72:75], v[96:103], v2
    v_add_f32 v36, v36, v38
    v_add_f32 v37, v37, v39
    v_cvt_pk_bf16_f32 v33, v36, v37
    v_smfmac_f32_16x16x64_bf16 v[56:59], v[72:75], v[104:111], v2
    v_add_f32 v40, v40, v42
    v_add_f32 v41, v41, v43
    v_cvt_pk_bf16_f32 v34, v40, v41
    s_waitcnt lgkmcnt(0)
    v_smfmac_f32_16x16x64_bf16 v[60:63], v[72:75], v[88:95], v2
    v_add_f32 v44, v44, v46
    v_add_f32 v45, v45, v47
    v_cvt_pk_bf16_f32 v35, v44, v45
    buffer_store_dwordx4 v[32:35], v8, s[4:7], s46 offen sc1
    v_pk_add_f32 v[48:49], v[48:49], v[50:51]
    v_cvt_pk_bf16_f32 v48, v48, v49
    v_and_or_b32 v48, v48, -2, s42
    v_pk_add_f32 v[52:53], v[52:53], v[54:55]
    v_cvt_pk_bf16_f32 v49, v52, v53
    v_pk_add_f32 v[56:57], v[56:57], v[58:59]
    v_cvt_pk_bf16_f32 v50, v56, v57
    v_pk_add_f32 v[60:61], v[60:61], v[62:63]
    v_cvt_pk_bf16_f32 v51, v60, v61
    buffer_store_dwordx4 v[48:51], v8, s[4:7], s61 offen sc1
    s_waitcnt vmcnt(4)
    v_mov_b32 v20, v64
    v_mov_b32 v21, v65
    v_mov_b32 v22, v66
    v_mov_b32 v23, v67
    s_add_u32 s45, s45, 262144
    s_add_u32 s51, s51, 262144
    v_mfma_f32_32x32x8_bf16 v[96:111], v[14:15], v[14:15], 0
    v_mfma_f32_16x16x16_bf16 v[112:115], v[14:15], v[14:15], 0
    v_mfma_f32_16x16x16_bf16 v[116:119], v[14:15], v[14:15], 0
    ds_read_b128 v[64:67], v1 offset:4096
    ds_read_b128 v[68:71], v1 offset:5120
    ds_read_b128 v[72:75], v1 offset:6144
    ds_read_b128 v[76:79], v1 offset:7168
    ds_read_b128 v[80:83], v1 offset:20480
    ds_read_b128 v[84:87], v1 offset:21504
    ds_read_b128 v[88:91], v1 offset:22528
    ds_read_b128 v[92:95], v1 offset:23552
    v_mov_b32 v58, -1
    v_mov_b32 v59, -1
    s_waitcnt vmcnt(0)
mega_kernel_rs_w1_pc:
    buffer_load_dword v36, v13, s[4:7], s47 offen offset:64 sc1
    buffer_load_dword v37, v13, s[4:7], s47 offen offset:1088 sc1
    buffer_load_dword v38, v13, s[4:7], s47 offen offset:2112 sc1
    buffer_load_dword v39, v13, s[4:7], s47 offen offset:3136 sc1
    buffer_load_dword v40, v13, s[4:7], s25 offen offset:64 sc1
    buffer_load_dword v41, v13, s[4:7], s25 offen offset:1088 sc1
    buffer_load_dword v42, v13, s[4:7], s25 offen offset:2112 sc1
    buffer_load_dword v43, v13, s[4:7], s25 offen offset:3136 sc1
    s_waitcnt vmcnt(4)
    v_mfma_f32_16x16x32_bf16 v[52:55], v[36:39], v[24:27], 0
    v_bitop3_b32 v3, s42, v36, v37 bitop3:0x7e
    v_bitop3_b32 v4, s42, v38, v39 bitop3:0x7e
    s_waitcnt vmcnt(2)
    v_or_b32 v3, v3, v4
    v_bitop3_b32 v4, s42, v40, v41 bitop3:0x7e
    s_waitcnt vmcnt(0)
    v_mfma_f32_16x16x32_bf16 v[52:55], v[40:43], v[24:27], v[52:55]
    v_bitop3_b32 v56, s42, v42, v43 bitop3:0x7e
    v_or3_b32 v3, v3, v4, v56
    v_and_b32 v3, v0, v3
    v_cmp_ne_u32 vcc, 0, v3
    s_cbranch_vccnz mega_kernel_rs_w1_pc
    s_nop 2
    v_cvt_pk_bf16_f32 v56, v52, v53
    v_cvt_pk_bf16_f32 v57, v54, v55
    v_min_u32 v56, -2, v56
    s_mov_b64 exec, s[26:27]
    buffer_store_dwordx2 v[56:57], v9, s[4:7], s35 offen offset:64 sc1
    buffer_store_dwordx2 v[58:59], v9, s[4:7], s36 offen offset:64 sc1
    s_mov_b64 exec, -1
    s_xor_b32 s42, s42, 1
    s_branch mega_kernel_rs_w1_loop
mega_kernel_rs_w1_last:
    s_add_u32 s45, s45, 262144
    s_add_u32 s51, s51, 262144
    buffer_store_dwordx4 v[64:67], v10, s[4:7], s45 offen offset:64 sc1
    buffer_store_dwordx2 v[18:19], v11, s[4:7], s51 offen offset:2560 sc1
    s_branch mega_kernel_rs_end
mega_kernel_rs_w1_pafail:
    buffer_load_dwordx4 v[40:43], v12, s[4:7], s22 offen sc1
    buffer_load_dwordx4 v[44:47], v12, s[4:7], s22 offen offset:1024 sc1
    s_nop 7
    v_mov_b32 v96, 0
    v_mov_b32 v97, 0
    v_mov_b32 v98, 0
    v_mov_b32 v99, 0
    v_mov_b32 v100, 0
    v_mov_b32 v101, 0
    v_mov_b32 v102, 0
    v_mov_b32 v103, 0
    v_mov_b32 v104, 0
    v_mov_b32 v105, 0
    v_mov_b32 v106, 0
    v_mov_b32 v107, 0
    s_branch mega_kernel_rs_w1_pa
mega_kernel_rs_w1_xslow:
    buffer_load_dwordx4 v[96:99], v1, s[4:7], s38 offen sc1
    s_waitcnt vmcnt(1)
    v_and_b32 v3, 1, v20
    v_cmp_ne_u32 vcc, s41, v3
    s_cbranch_vccz mega_kernel_rs_w1_xgot1
    buffer_load_dwordx4 v[20:23], v1, s[4:7], s38 offen sc1
mega_kernel_rs_w1_px:
    s_waitcnt vmcnt(1)
    v_and_b32 v3, 1, v96
    v_cmp_ne_u32 vcc, s41, v3
    s_cbranch_vccz mega_kernel_rs_w1_xgot0
    buffer_load_dwordx4 v[96:99], v1, s[4:7], s38 offen sc1
    s_waitcnt vmcnt(1)
    v_and_b32 v3, 1, v20
    v_cmp_ne_u32 vcc, s41, v3
    s_cbranch_vccz mega_kernel_rs_w1_xgot1
    buffer_load_dwordx4 v[20:23], v1, s[4:7], s38 offen sc1
    s_branch mega_kernel_rs_w1_px
mega_kernel_rs_w1_xgot0:
    v_mfma_f32_16x16x16_bf16 v[80:83], v[96:97], v[16:17], v[100:103]
    v_mfma_f32_16x16x16_bf16 v[84:87], v[98:99], v[16:17], v[104:107]
    v_and_b32 v3, 1, v96
    v_cmp_ne_u32 vcc, s41, v3
    s_nop 4
    v_cvt_pk_bf16_f32 v64, v80, v81
    v_cvt_pk_bf16_f32 v65, v82, v83
    v_cvt_pk_bf16_f32 v66, v84, v85
    v_cvt_pk_bf16_f32 v67, v86, v87
    ds_write_b128 v6, v[64:67] offset:11264
    s_branch mega_kernel_rs_w1_xok
mega_kernel_rs_w1_xgot1:
    v_mfma_f32_16x16x16_bf16 v[80:83], v[20:21], v[16:17], v[100:103]
    v_mfma_f32_16x16x16_bf16 v[84:87], v[22:23], v[16:17], v[104:107]
    v_and_b32 v3, 1, v20
    v_cmp_ne_u32 vcc, s41, v3
    s_nop 4
    v_cvt_pk_bf16_f32 v64, v80, v81
    v_cvt_pk_bf16_f32 v65, v82, v83
    v_cvt_pk_bf16_f32 v66, v84, v85
    v_cvt_pk_bf16_f32 v67, v86, v87
    ds_write_b128 v6, v[64:67] offset:11264
    s_branch mega_kernel_rs_w1_xok
mega_kernel_rs_w1_pv0:
    s_waitcnt vmcnt(0)
    s_branch mega_kernel_rs_w1_pv1
mega_kernel_rs_w1_pv:
    buffer_load_dwordx2 v[20:21], v11, s[4:7], s40 offen sc1
    s_waitcnt vmcnt(0)
mega_kernel_rs_w1_pv1:
    v_and_b32 v3, 1, v20
    v_cmp_ne_u32 vcc, s41, v3
    v_mov_b32 v113, v20
    v_mov_b32 v115, v21
    s_cbranch_vccnz mega_kernel_rs_w1_pv
    s_branch mega_kernel_rs_w1_pv2
mega_kernel_rs_w2_entry:
    v_mfma_f32_32x32x8_bf16 v[96:111], v[14:15], v[14:15], 0
    v_mfma_f32_16x16x16_bf16 v[112:115], v[14:15], v[14:15], 0
    v_mfma_f32_16x16x16_bf16 v[116:119], v[14:15], v[14:15], 0
    ds_read_b128 v[64:67], v1 offset:8192
    ds_read_b128 v[68:71], v1 offset:9216
    ds_read_b128 v[72:75], v1 offset:10240
    ds_read_b128 v[76:79], v1 offset:11264
    ds_read_b128 v[80:83], v1 offset:24576
    ds_read_b128 v[84:87], v1 offset:25600
    ds_read_b128 v[88:91], v1 offset:26624
    ds_read_b128 v[92:95], v1 offset:27648
    buffer_load_dwordx4 v[120:123], v1, s[4:7], s44 offen
    buffer_load_dwordx4 v[124:127], v1, s[4:7], s44 offen offset:1024
    s_add_u32 s44, s44, 262144
mega_kernel_rs_w2_loop:
    s_add_u32 s22, s35, 4096
    s_waitcnt vmcnt(0)
    buffer_load_dwordx4 v[48:51], v12, s[4:7], s22 offen sc1
    buffer_load_dwordx4 v[52:55], v12, s[4:7], s22 offen offset:1024 sc1
mega_kernel_rs_w2_pa:
    s_waitcnt vmcnt(1)
    ds_write_b128 v6, v[48:51] offset:4096
    s_waitcnt vmcnt(0)
    ds_write_b128 v6, v[52:55] offset:5120
    v_max3_u32 v3, v48, v50, v52
    v_max_u32 v3, v3, v54
    v_cmp_eq_u32 vcc, -1, v3
    v_smfmac_f32_16x16x64_bf16 v[96:99], v[48:51], a[64:71], v2
    v_smfmac_f32_16x16x64_bf16 v[100:103], v[48:51], a[72:79], v2
    v_smfmac_f32_16x16x64_bf16 v[104:107], v[48:51], a[192:199], v2
    s_cbranch_vccnz mega_kernel_rs_w2_pafail
    s_waitcnt lgkmcnt(0)
    s_barrier
    ds_read_b128 v[56:59], v6 offset:6144
    ds_read_b128 v[60:63], v6 offset:7168
    v_smfmac_f32_16x16x64_bf16 v[108:111], v[48:51], a[200:207], v2
    ds_read_b128 v[32:35], v6 offset:0
    v_smfmac_f32_16x16x64_bf16 v[96:99], v[52:55], a[80:87], v2
    ds_read_b128 v[36:39], v6 offset:1024
    v_smfmac_f32_16x16x64_bf16 v[100:103], v[52:55], a[88:95], v2
    ds_read_b128 v[40:43], v6 offset:2048
    v_smfmac_f32_16x16x64_bf16 v[104:107], v[52:55], a[208:215], v2
    ds_read_b128 v[44:47], v6 offset:3072
    v_smfmac_f32_16x16x64_bf16 v[108:111], v[52:55], a[216:223], v2
    buffer_load_dwordx4 v1, s[4:7], s43 offen lds
    s_waitcnt lgkmcnt(5)
    v_smfmac_f32_16x16x64_bf16 v[96:99], v[56:59], a[96:103], v2
    v_smfmac_f32_16x16x64_bf16 v[100:103], v[56:59], a[104:111], v2
    v_smfmac_f32_16x16x64_bf16 v[104:107], v[56:59], a[224:231], v2
    v_smfmac_f32_16x16x64_bf16 v[108:111], v[56:59], a[232:239], v2
    buffer_load_dwordx4 v1, s[4:7], s43 offen offset:1024 lds
    s_waitcnt lgkmcnt(4)
    v_smfmac_f32_16x16x64_bf16 v[96:99], v[60:63], a[112:119], v2
    v_smfmac_f32_16x16x64_bf16 v[100:103], v[60:63], a[120:127], v2
    v_smfmac_f32_16x16x64_bf16 v[104:107], v[60:63], a[240:247], v2
    v_smfmac_f32_16x16x64_bf16 v[108:111], v[60:63], a[248:255], v2
    buffer_store_dwordx4 v[20:23], v10, s[4:7], s45 offen offset:128 sc1
    s_waitcnt lgkmcnt(3)
    v_smfmac_f32_16x16x64_bf16 v[96:99], v[32:35], a[0:7], v2
    v_smfmac_f32_16x16x64_bf16 v[100:103], v[32:35], a[8:15], v2
    v_smfmac_f32_16x16x64_bf16 v[104:107], v[32:35], a[128:135], v2
    v_smfmac_f32_16x16x64_bf16 v[108:111], v[32:35], a[136:143], v2
    buffer_store_dwordx2 v[18:19], v11, s[4:7], s51 offen offset:3072 sc1
    s_waitcnt lgkmcnt(2)
    v_smfmac_f32_16x16x64_bf16 v[96:99], v[36:39], a[16:23], v2
    v_smfmac_f32_16x16x64_bf16 v[100:103], v[36:39], a[24:31], v2
    v_smfmac_f32_16x16x64_bf16 v[104:107], v[36:39], a[144:151], v2
    v_smfmac_f32_16x16x64_bf16 v[108:111], v[36:39], a[152:159], v2
    s_waitcnt lgkmcnt(1)
    v_smfmac_f32_16x16x64_bf16 v[96:99], v[40:43], a[32:39], v2
    v_smfmac_f32_16x16x64_bf16 v[100:103], v[40:43], a[40:47], v2
    v_smfmac_f32_16x16x64_bf16 v[104:107], v[40:43], a[160:167], v2
    v_smfmac_f32_16x16x64_bf16 v[108:111], v[40:43], a[168:175], v2
    s_waitcnt lgkmcnt(0)
    v_smfmac_f32_16x16x64_bf16 v[96:99], v[44:47], a[48:55], v2
    v_smfmac_f32_16x16x64_bf16 v[100:103], v[44:47], a[56:63], v2
    v_smfmac_f32_16x16x64_bf16 v[104:107], v[44:47], a[176:183], v2
    v_smfmac_f32_16x16x64_bf16 v[108:111], v[44:47], a[184:191], v2
    s_nop 4
    v_pk_add_f32 v[96:97], v[96:97], v[98:99]
    v_pk_add_f32 v[100:101], v[100:101], v[102:103]
    v_pk_add_f32 v[104:105], v[104:105], v[106:107]
    v_pk_add_f32 v[108:109], v[108:109], v[110:111]
    v_cvt_pk_bf16_f32 v111, v108, v109
    v_cvt_pk_bf16_f32 v108, v96, v97
    v_cvt_pk_bf16_f32 v110, v100, v101
    v_cvt_pk_bf16_f32 v109, v104, v105
    v_and_or_b32 v108, v108, -2, s41
    buffer_store_dwordx4 v[108:111], v1, s[4:7], s37 offen sc1
    v_smfmac_f32_16x16x64_bf16 v[112:115], v[32:35], v[64:71], v2
    ds_read_b128 v[64:67], v1 offset:40960
    ds_read_b128 v[68:71], v1 offset:41984
    v_smfmac_f32_16x16x64_bf16 v[116:119], v[32:35], v[72:79], v2
    ds_read_b128 v[72:75], v1 offset:43008
    ds_read_b128 v[76:79], v1 offset:44032
    v_smfmac_f32_16x16x64_bf16 v[112:115], v[36:39], v[80:87], v2
    ds_read_b128 v[80:83], v1 offset:57344
    ds_read_b128 v[84:87], v1 offset:58368
    v_smfmac_f32_16x16x64_bf16 v[116:119], v[36:39], v[88:95], v2
    ds_read_b128 v[88:91], v1 offset:59392
    ds_read_b128 v[92:95], v1 offset:60416
    v_smfmac_f32_16x16x64_bf16 v[112:115], v[52:55], v[208:215], v2
    v_smfmac_f32_16x16x64_bf16 v[116:119], v[52:55], v[216:223], v2
    v_smfmac_f32_16x16x64_bf16 v[112:115], v[56:59], v[224:231], v2
    s_waitcnt lgkmcnt(6)
    v_smfmac_f32_16x16x64_bf16 v[112:115], v[40:43], v[64:71], v2
    ds_read_b128 v[64:67], v5 offset:8192
    ds_read_b128 v[68:71], v5 offset:9216
    s_waitcnt lgkmcnt(6)
    v_smfmac_f32_16x16x64_bf16 v[116:119], v[40:43], v[72:79], v2
    ds_read_b128 v[72:75], v5 offset:10240
    ds_read_b128 v[76:79], v5 offset:11264
    v_smfmac_f32_16x16x64_bf16 v[116:119], v[56:59], v[232:239], v2
    v_smfmac_f32_16x16x64_bf16 v[112:115], v[60:63], v[240:247], v2
    v_smfmac_f32_16x16x64_bf16 v[116:119], v[60:63], v[248:255], v2
    s_waitcnt lgkmcnt(6)
    v_smfmac_f32_16x16x64_bf16 v[112:115], v[44:47], v[80:87], v2
    s_waitcnt lgkmcnt(4)
    v_smfmac_f32_16x16x64_bf16 v[116:119], v[44:47], v[88:95], v2
    s_waitcnt lgkmcnt(2)
    v_smfmac_f32_16x16x64_bf16 v[112:115], v[48:51], v[64:71], v2
    s_waitcnt lgkmcnt(0)
    v_smfmac_f32_16x16x64_bf16 v[116:119], v[48:51], v[72:79], v2
    v_mfma_f32_16x16x16_bf16 v[100:103], v[108:109], v[16:17], 0
    v_mfma_f32_16x16x16_bf16 v[104:107], v[110:111], v[16:17], 0
    s_nop 4
    v_add_f32 v112, v112, v114
    v_add_f32 v113, v113, v115
    v_add_f32 v114, v116, v118
    v_add_f32 v115, v117, v119
    v_cvt_pk_bf16_f32 v18, v112, v113
    v_cvt_pk_bf16_f32 v19, v114, v115
    v_and_or_b32 v18, v18, -2, s41
    v_mov_b32 v112, v18
    v_mov_b32 v114, v19
    v_mov_b32 v92, v28
    v_mov_b32 v93, 0
    s_waitcnt vmcnt(3)
    s_barrier
    ds_read_b128 v[32:35], v6 offset:15360
    ds_read_b128 v[36:39], v6 offset:16384
    ds_read_b128 v[40:43], v6 offset:18432
    ds_read_b128 v[44:47], v6 offset:19456
    ds_read_b128 v[48:51], v6 offset:9216
    ds_read_b128 v[52:55], v6 offset:10240
    ds_read_b128 v[56:59], v6 offset:12288
    ds_read_b128 v[60:63], v6 offset:13312
    buffer_load_dwordx4 v[96:99], v1, s[4:7], s38 offen sc1
    s_barrier
    buffer_store_dwordx2 v[18:19], v11, s[4:7], s39 offen sc1
    s_nop 15
    s_nop 15
    buffer_load_dwordx4 v[20:23], v1, s[4:7], s38 offen sc1
    s_waitcnt vmcnt(2)
    v_mfma_f32_16x16x16_bf16 v[80:83], v[96:97], v[16:17], v[100:103]
    v_mfma_f32_16x16x16_bf16 v[84:87], v[98:99], v[16:17], v[104:107]
    v_and_b32 v3, 1, v96
    v_cmp_ne_u32 vcc, s41, v3
    s_nop 4
    v_cvt_pk_bf16_f32 v64, v80, v81
    v_cvt_pk_bf16_f32 v65, v82, v83
    v_cvt_pk_bf16_f32 v66, v84, v85
    v_cvt_pk_bf16_f32 v67, v86, v87
    ds_write_b128 v6, v[64:67] offset:14336
    s_cbranch_vccnz mega_kernel_rs_w2_xslow
mega_kernel_rs_w2_xok:
    s_cmp_eq_u32 s21, 63
    s_cbranch_scc1 mega_kernel_rs_w2_last
    buffer_load_dwordx2 v[116:117], v11, s[4:7], s40 offen sc1
    s_waitcnt lgkmcnt(1)
    v_mfma_f32_16x16x32_bf16 v[80:83], v[32:35], v[64:67], 0
    s_waitcnt lgkmcnt(0)
    s_barrier
    ds_read_b128 v[68:71], v6 offset:17408
    ds_read_b128 v[72:75], v6 offset:8192
    ds_read_b128 v[76:79], v6 offset:11264
    v_mfma_f32_16x16x32_bf16 v[84:87], v[36:39], v[64:67], 0
    v_mfma_f32_16x16x32_bf16 v[88:91], v[64:67], v[64:67], 0
    buffer_load_dwordx2 v[20:21], v11, s[4:7], s40 offen sc1
    s_waitcnt lgkmcnt(2)
    v_mfma_f32_16x16x32_bf16 v[80:83], v[40:43], v[68:71], v[80:83]
    v_mfma_f32_16x16x32_bf16 v[84:87], v[44:47], v[68:71], v[84:87]
    v_mfma_f32_16x16x32_bf16 v[88:91], v[68:71], v[68:71], v[88:91]
    s_waitcnt lgkmcnt(1)
    v_mfma_f32_16x16x32_bf16 v[80:83], v[48:51], v[72:75], v[80:83]
    v_mfma_f32_16x16x32_bf16 v[84:87], v[52:55], v[72:75], v[84:87]
    v_mfma_f32_16x16x32_bf16 v[88:91], v[72:75], v[72:75], v[88:91]
    s_waitcnt lgkmcnt(0)
    v_mfma_f32_16x16x32_bf16 v[80:83], v[56:59], v[76:79], v[80:83]
    v_mfma_f32_16x16x32_bf16 v[84:87], v[60:63], v[76:79], v[84:87]
    v_mfma_f32_16x16x32_bf16 v[88:91], v[76:79], v[76:79], v[88:91]
    v_mfma_f32_32x32x4_2b_bf16 v[32:63], v[14:15], v[14:15], 0
    s_nop 4
    v_max3_f32 v4, v80, v81, v82
    v_max3_f32 v4, v4, v83, v84
    v_max3_f32 v4, v4, v85, v86
    v_max3_f32 v4, v4, v87, v88
    v_max_f32 v90, v4, v89
    v_max_f32 v4, v4, v89
    s_nop 0
    s_nop 0
    v_permlane16_swap_b32 v4, v90
    v_max_f32 v4, v4, v90
    v_max_f32 v90, v4, v90
    s_nop 1
    v_permlane32_swap_b32 v4, v90
    v_max_f32 v4, v4, v90
    v_mul_f32 v4, s34, v4
    v_pk_fma_f32 v[80:81], v[80:81], s[34:35], v[4:5] op_sel_hi:[1,0,0] neg_lo:[0,0,1] neg_hi:[0,0,1]
    v_pk_fma_f32 v[82:83], v[82:83], s[34:35], v[4:5] op_sel_hi:[1,0,0] neg_lo:[0,0,1] neg_hi:[0,0,1]
    v_pk_fma_f32 v[84:85], v[84:85], s[34:35], v[4:5] op_sel_hi:[1,0,0] neg_lo:[0,0,1] neg_hi:[0,0,1]
    v_pk_fma_f32 v[86:87], v[86:87], s[34:35], v[4:5] op_sel_hi:[1,0,0] neg_lo:[0,0,1] neg_hi:[0,0,1]
    v_pk_fma_f32 v[88:89], v[88:89], s[34:35], v[4:5] op_sel_hi:[1,0,0] neg_lo:[0,0,1] neg_hi:[0,0,1]
    v_exp_f32 v80, v80
    v_exp_f32 v81, v81
    v_exp_f32 v82, v82
    v_cvt_pk_bf16_f32 v68, v80, v81
    v_exp_f32 v83, v83
    v_exp_f32 v84, v84
    v_cvt_pk_bf16_f32 v69, v82, v83
    v_exp_f32 v85, v85
    v_exp_f32 v86, v86
    v_cvt_pk_bf16_f32 v70, v84, v85
    v_exp_f32 v87, v87
    v_exp_f32 v88, v88
    v_cvt_pk_bf16_f32 v71, v86, v87
    v_exp_f32 v89, v89
    s_nop 0
    v_mfma_f32_16x16x32_bf16 v[76:79], v[28:31], v[68:71], 0
    v_cvt_pk_bf16_f32 v72, v88, v89
    v_cvt_pk_bf16_f32 v73, v88, v89
    v_mfma_f32_16x16x32_bf16 v[100:103], v[120:123], v[68:71], 0
    s_waitcnt vmcnt(1)
    v_and_b32 v3, 1, v116
    v_cmp_ne_u32 vcc, s41, v3
    v_mfma_f32_16x16x32_bf16 v[104:107], v[124:127], v[68:71], 0
    v_mov_b32 v113, v116
    v_mov_b32 v115, v117
    v_mfma_f32_16x16x16_bf16 v[76:79], v[92:93], v[72:73], v[76:79]
    s_cbranch_vccnz mega_kernel_rs_w2_pv0
mega_kernel_rs_w2_pv2:
    v_mfma_f32_16x16x16_bf16 v[100:103], v[112:113], v[72:73], v[100:103]
    v_mfma_f32_16x16x16_bf16 v[104:107], v[114:115], v[72:73], v[104:107]
    buffer_load_dwordx4 v[120:123], v1, s[4:7], s44 offen
    buffer_load_dwordx4 v[124:127], v1, s[4:7], s44 offen offset:1024
    s_nop 2
    v_rcp_f32 v76, v76
    s_mov_b64 exec, s[28:29]
    v_pk_mul_f32 v[100:101], v[100:101], v[76:77] op_sel_hi:[1,0]
    v_pk_mul_f32 v[102:103], v[102:103], v[76:77] op_sel_hi:[1,0]
    v_pk_mul_f32 v[104:105], v[104:105], v[76:77] op_sel_hi:[1,0]
    v_pk_mul_f32 v[106:107], v[106:107], v[76:77] op_sel_hi:[1,0]
    v_cvt_pk_bf16_f32 v72, v100, v101
    v_cvt_pk_bf16_f32 v73, v102, v103
    v_cvt_pk_bf16_f32 v74, v104, v105
    v_cvt_pk_bf16_f32 v75, v106, v107
    ds_write_b128 v6, v[72:75] offset:21472
    s_mov_b64 exec, -1
    ds_read_b128 v[88:91], v5 offset:24576
    ds_read_b128 v[92:95], v5 offset:25600
    ds_read_b128 v[80:83], v5 offset:26624
    ds_read_b128 v[84:87], v5 offset:27648
    ds_read_b128 v[112:115], v5 offset:40960
    ds_read_b128 v[116:119], v5 offset:41984
    s_waitcnt lgkmcnt(6)
    s_barrier
    ds_read_b128 v[68:71], v6 offset:20480
    ds_read_b128 v[72:75], v6 offset:21504
    ds_read_b128 v[96:99], v5 offset:43008
    ds_read_b128 v[100:103], v5 offset:44032
    ds_read_b128 v[104:107], v5 offset:57344
    ds_read_b128 v[108:111], v5 offset:58368
    s_waitcnt lgkmcnt(5)
    v_smfmac_f32_16x16x64_bf16 v[32:35], v[68:71], v[128:135], v2
    s_add_u32 s21, s21, 1
    v_smfmac_f32_16x16x64_bf16 v[36:39], v[68:71], v[136:143], v2
    s_xor_b32 s38, s38, 1048576
    v_smfmac_f32_16x16x64_bf16 v[40:43], v[68:71], v[144:151], v2
    s_xor_b32 s37, s37, 1048576
    v_smfmac_f32_16x16x64_bf16 v[44:47], v[68:71], v[152:159], v2
    s_xor_b32 s40, s40, 1048576
    s_waitcnt lgkmcnt(4)
    v_smfmac_f32_16x16x64_bf16 v[32:35], v[72:75], v[160:167], v2
    s_xor_b32 s39, s39, 1048576
    v_smfmac_f32_16x16x64_bf16 v[36:39], v[72:75], v[168:175], v2
    s_lshr_b32 s41, s21, 1
    v_smfmac_f32_16x16x64_bf16 v[40:43], v[72:75], v[176:183], v2
    s_and_b32 s41, s41, 1
    v_smfmac_f32_16x16x64_bf16 v[44:47], v[72:75], v[184:191], v2
    s_xor_b32 s41, s41, 1
    v_smfmac_f32_16x16x64_bf16 v[48:51], v[68:71], v[192:199], v2
    s_xor_b32 s35, s35, 16384
    v_smfmac_f32_16x16x64_bf16 v[52:55], v[68:71], v[200:207], v2
    s_xor_b32 s36, s36, 16384
    s_waitcnt lgkmcnt(0)
    v_smfmac_f32_16x16x64_bf16 v[56:59], v[68:71], v[88:95], v2
    ds_read_b128 v[88:91], v5 offset:59392
    ds_read_b128 v[92:95], v5 offset:60416
    v_smfmac_f32_16x16x64_bf16 v[60:63], v[68:71], v[80:87], v2
    s_add_u32 s43, s43, 262144
    v_smfmac_f32_16x16x64_bf16 v[48:51], v[72:75], v[112:119], v2
    s_add_u32 s44, s44, 262144
    v_add_f32 v32, v32, v34
    v_add_f32 v33, v33, v35
    v_cvt_pk_bf16_f32 v32, v32, v33
    v_and_or_b32 v32, v32, -2, s42
    v_smfmac_f32_16x16x64_bf16 v[52:55], v[72:75], v[96:103], v2
    v_add_f32 v36, v36, v38
    v_add_f32 v37, v37, v39
    v_cvt_pk_bf16_f32 v33, v36, v37
    v_smfmac_f32_16x16x64_bf16 v[56:59], v[72:75], v[104:111], v2
    v_add_f32 v40, v40, v42
    v_add_f32 v41, v41, v43
    v_cvt_pk_bf16_f32 v34, v40, v41
    s_waitcnt lgkmcnt(0)
    v_smfmac_f32_16x16x64_bf16 v[60:63], v[72:75], v[88:95], v2
    v_add_f32 v44, v44, v46
    v_add_f32 v45, v45, v47
    v_cvt_pk_bf16_f32 v35, v44, v45
    buffer_store_dwordx4 v[32:35], v8, s[4:7], s46 offen sc1
    v_pk_add_f32 v[48:49], v[48:49], v[50:51]
    v_cvt_pk_bf16_f32 v48, v48, v49
    v_and_or_b32 v48, v48, -2, s42
    v_pk_add_f32 v[52:53], v[52:53], v[54:55]
    v_cvt_pk_bf16_f32 v49, v52, v53
    v_pk_add_f32 v[56:57], v[56:57], v[58:59]
    v_cvt_pk_bf16_f32 v50, v56, v57
    v_pk_add_f32 v[60:61], v[60:61], v[62:63]
    v_cvt_pk_bf16_f32 v51, v60, v61
    buffer_store_dwordx4 v[48:51], v8, s[4:7], s61 offen sc1
    s_waitcnt vmcnt(4)
    v_mov_b32 v20, v64
    v_mov_b32 v21, v65
    v_mov_b32 v22, v66
    v_mov_b32 v23, v67
    s_add_u32 s45, s45, 262144
    s_add_u32 s51, s51, 262144
    v_mfma_f32_32x32x8_bf16 v[96:111], v[14:15], v[14:15], 0
    v_mfma_f32_16x16x16_bf16 v[112:115], v[14:15], v[14:15], 0
    v_mfma_f32_16x16x16_bf16 v[116:119], v[14:15], v[14:15], 0
    ds_read_b128 v[64:67], v1 offset:8192
    ds_read_b128 v[68:71], v1 offset:9216
    ds_read_b128 v[72:75], v1 offset:10240
    ds_read_b128 v[76:79], v1 offset:11264
    ds_read_b128 v[80:83], v1 offset:24576
    ds_read_b128 v[84:87], v1 offset:25600
    ds_read_b128 v[88:91], v1 offset:26624
    ds_read_b128 v[92:95], v1 offset:27648
    v_mov_b32 v58, -1
    v_mov_b32 v59, -1
    s_waitcnt vmcnt(0)
mega_kernel_rs_w2_pc:
    buffer_load_dword v36, v13, s[4:7], s47 offen offset:128 sc1
    buffer_load_dword v37, v13, s[4:7], s47 offen offset:1152 sc1
    buffer_load_dword v38, v13, s[4:7], s47 offen offset:2176 sc1
    buffer_load_dword v39, v13, s[4:7], s47 offen offset:3200 sc1
    buffer_load_dword v40, v13, s[4:7], s25 offen offset:128 sc1
    buffer_load_dword v41, v13, s[4:7], s25 offen offset:1152 sc1
    buffer_load_dword v42, v13, s[4:7], s25 offen offset:2176 sc1
    buffer_load_dword v43, v13, s[4:7], s25 offen offset:3200 sc1
    s_waitcnt vmcnt(4)
    v_mfma_f32_16x16x32_bf16 v[52:55], v[36:39], v[24:27], 0
    v_bitop3_b32 v3, s42, v36, v37 bitop3:0x7e
    v_bitop3_b32 v4, s42, v38, v39 bitop3:0x7e
    s_waitcnt vmcnt(2)
    v_or_b32 v3, v3, v4
    v_bitop3_b32 v4, s42, v40, v41 bitop3:0x7e
    s_waitcnt vmcnt(0)
    v_mfma_f32_16x16x32_bf16 v[52:55], v[40:43], v[24:27], v[52:55]
    v_bitop3_b32 v56, s42, v42, v43 bitop3:0x7e
    v_or3_b32 v3, v3, v4, v56
    v_and_b32 v3, v0, v3
    v_cmp_ne_u32 vcc, 0, v3
    s_cbranch_vccnz mega_kernel_rs_w2_pc
    s_nop 2
    v_cvt_pk_bf16_f32 v56, v52, v53
    v_cvt_pk_bf16_f32 v57, v54, v55
    v_min_u32 v56, -2, v56
    s_mov_b64 exec, s[26:27]
    buffer_store_dwordx2 v[56:57], v9, s[4:7], s35 offen offset:128 sc1
    buffer_store_dwordx2 v[58:59], v9, s[4:7], s36 offen offset:128 sc1
    s_mov_b64 exec, -1
    s_xor_b32 s42, s42, 1
    s_branch mega_kernel_rs_w2_loop
mega_kernel_rs_w2_last:
    s_add_u32 s45, s45, 262144
    s_add_u32 s51, s51, 262144
    buffer_store_dwordx4 v[64:67], v10, s[4:7], s45 offen offset:128 sc1
    buffer_store_dwordx2 v[18:19], v11, s[4:7], s51 offen offset:3072 sc1
    s_branch mega_kernel_rs_end
mega_kernel_rs_w2_pafail:
    buffer_load_dwordx4 v[48:51], v12, s[4:7], s22 offen sc1
    buffer_load_dwordx4 v[52:55], v12, s[4:7], s22 offen offset:1024 sc1
    s_nop 7
    v_mov_b32 v96, 0
    v_mov_b32 v97, 0
    v_mov_b32 v98, 0
    v_mov_b32 v99, 0
    v_mov_b32 v100, 0
    v_mov_b32 v101, 0
    v_mov_b32 v102, 0
    v_mov_b32 v103, 0
    v_mov_b32 v104, 0
    v_mov_b32 v105, 0
    v_mov_b32 v106, 0
    v_mov_b32 v107, 0
    s_branch mega_kernel_rs_w2_pa
mega_kernel_rs_w2_xslow:
    buffer_load_dwordx4 v[96:99], v1, s[4:7], s38 offen sc1
    s_waitcnt vmcnt(1)
    v_and_b32 v3, 1, v20
    v_cmp_ne_u32 vcc, s41, v3
    s_cbranch_vccz mega_kernel_rs_w2_xgot1
    buffer_load_dwordx4 v[20:23], v1, s[4:7], s38 offen sc1
mega_kernel_rs_w2_px:
    s_waitcnt vmcnt(1)
    v_and_b32 v3, 1, v96
    v_cmp_ne_u32 vcc, s41, v3
    s_cbranch_vccz mega_kernel_rs_w2_xgot0
    buffer_load_dwordx4 v[96:99], v1, s[4:7], s38 offen sc1
    s_waitcnt vmcnt(1)
    v_and_b32 v3, 1, v20
    v_cmp_ne_u32 vcc, s41, v3
    s_cbranch_vccz mega_kernel_rs_w2_xgot1
    buffer_load_dwordx4 v[20:23], v1, s[4:7], s38 offen sc1
    s_branch mega_kernel_rs_w2_px
mega_kernel_rs_w2_xgot0:
    v_mfma_f32_16x16x16_bf16 v[80:83], v[96:97], v[16:17], v[100:103]
    v_mfma_f32_16x16x16_bf16 v[84:87], v[98:99], v[16:17], v[104:107]
    v_and_b32 v3, 1, v96
    v_cmp_ne_u32 vcc, s41, v3
    s_nop 4
    v_cvt_pk_bf16_f32 v64, v80, v81
    v_cvt_pk_bf16_f32 v65, v82, v83
    v_cvt_pk_bf16_f32 v66, v84, v85
    v_cvt_pk_bf16_f32 v67, v86, v87
    ds_write_b128 v6, v[64:67] offset:14336
    s_branch mega_kernel_rs_w2_xok
mega_kernel_rs_w2_xgot1:
    v_mfma_f32_16x16x16_bf16 v[80:83], v[20:21], v[16:17], v[100:103]
    v_mfma_f32_16x16x16_bf16 v[84:87], v[22:23], v[16:17], v[104:107]
    v_and_b32 v3, 1, v20
    v_cmp_ne_u32 vcc, s41, v3
    s_nop 4
    v_cvt_pk_bf16_f32 v64, v80, v81
    v_cvt_pk_bf16_f32 v65, v82, v83
    v_cvt_pk_bf16_f32 v66, v84, v85
    v_cvt_pk_bf16_f32 v67, v86, v87
    ds_write_b128 v6, v[64:67] offset:14336
    s_branch mega_kernel_rs_w2_xok
mega_kernel_rs_w2_pv0:
    s_waitcnt vmcnt(0)
    s_branch mega_kernel_rs_w2_pv1
mega_kernel_rs_w2_pv:
    buffer_load_dwordx2 v[20:21], v11, s[4:7], s40 offen sc1
    s_waitcnt vmcnt(0)
mega_kernel_rs_w2_pv1:
    v_and_b32 v3, 1, v20
    v_cmp_ne_u32 vcc, s41, v3
    v_mov_b32 v113, v20
    v_mov_b32 v115, v21
    s_cbranch_vccnz mega_kernel_rs_w2_pv
    s_branch mega_kernel_rs_w2_pv2
mega_kernel_rs_w3_entry:
    v_mfma_f32_32x32x8_bf16 v[96:111], v[14:15], v[14:15], 0
    v_mfma_f32_16x16x16_bf16 v[112:115], v[14:15], v[14:15], 0
    v_mfma_f32_16x16x16_bf16 v[116:119], v[14:15], v[14:15], 0
    ds_read_b128 v[64:67], v1 offset:12288
    ds_read_b128 v[68:71], v1 offset:13312
    ds_read_b128 v[72:75], v1 offset:14336
    ds_read_b128 v[76:79], v1 offset:15360
    ds_read_b128 v[80:83], v1 offset:28672
    ds_read_b128 v[84:87], v1 offset:29696
    ds_read_b128 v[88:91], v1 offset:30720
    ds_read_b128 v[92:95], v1 offset:31744
    buffer_load_dwordx4 v[120:123], v1, s[4:7], s44 offen
    buffer_load_dwordx4 v[124:127], v1, s[4:7], s44 offen offset:1024
    s_add_u32 s44, s44, 262144
mega_kernel_rs_w3_loop:
    s_add_u32 s22, s35, 6144
    s_waitcnt vmcnt(0)
    buffer_load_dwordx4 v[56:59], v12, s[4:7], s22 offen sc1
    buffer_load_dwordx4 v[60:63], v12, s[4:7], s22 offen offset:1024 sc1
mega_kernel_rs_w3_pa:
    s_waitcnt vmcnt(1)
    ds_write_b128 v6, v[56:59] offset:6144
    s_waitcnt vmcnt(0)
    ds_write_b128 v6, v[60:63] offset:7168
    v_max3_u32 v3, v56, v58, v60
    v_max_u32 v3, v3, v62
    v_cmp_eq_u32 vcc, -1, v3
    v_smfmac_f32_16x16x64_bf16 v[96:99], v[56:59], a[96:103], v2
    v_smfmac_f32_16x16x64_bf16 v[100:103], v[56:59], a[104:111], v2
    v_smfmac_f32_16x16x64_bf16 v[104:107], v[56:59], a[224:231], v2
    s_cbranch_vccnz mega_kernel_rs_w3_pafail
    s_waitcnt lgkmcnt(0)
    s_barrier
    ds_read_b128 v[32:35], v6 offset:0
    ds_read_b128 v[36:39], v6 offset:1024
    v_smfmac_f32_16x16x64_bf16 v[108:111], v[56:59], a[232:239], v2
    ds_read_b128 v[40:43], v6 offset:2048
    v_smfmac_f32_16x16x64_bf16 v[96:99], v[60:63], a[112:119], v2
    ds_read_b128 v[44:47], v6 offset:3072
    v_smfmac_f32_16x16x64_bf16 v[100:103], v[60:63], a[120:127], v2
    ds_read_b128 v[48:51], v6 offset:4096
    v_smfmac_f32_16x16x64_bf16 v[104:107], v[60:63], a[240:247], v2
    ds_read_b128 v[52:55], v6 offset:5120
    v_smfmac_f32_16x16x64_bf16 v[108:111], v[60:63], a[248:255], v2
    buffer_load_dwordx4 v1, s[4:7], s43 offen lds
    s_waitcnt lgkmcnt(5)
    v_smfmac_f32_16x16x64_bf16 v[96:99], v[32:35], a[0:7], v2
    v_smfmac_f32_16x16x64_bf16 v[100:103], v[32:35], a[8:15], v2
    v_smfmac_f32_16x16x64_bf16 v[104:107], v[32:35], a[128:135], v2
    v_smfmac_f32_16x16x64_bf16 v[108:111], v[32:35], a[136:143], v2
    buffer_load_dwordx4 v1, s[4:7], s43 offen offset:1024 lds
    s_waitcnt lgkmcnt(4)
    v_smfmac_f32_16x16x64_bf16 v[96:99], v[36:39], a[16:23], v2
    v_smfmac_f32_16x16x64_bf16 v[100:103], v[36:39], a[24:31], v2
    v_smfmac_f32_16x16x64_bf16 v[104:107], v[36:39], a[144:151], v2
    v_smfmac_f32_16x16x64_bf16 v[108:111], v[36:39], a[152:159], v2
    buffer_store_dwordx4 v[20:23], v10, s[4:7], s45 offen offset:192 sc1
    s_waitcnt lgkmcnt(3)
    v_smfmac_f32_16x16x64_bf16 v[96:99], v[40:43], a[32:39], v2
    v_smfmac_f32_16x16x64_bf16 v[100:103], v[40:43], a[40:47], v2
    v_smfmac_f32_16x16x64_bf16 v[104:107], v[40:43], a[160:167], v2
    v_smfmac_f32_16x16x64_bf16 v[108:111], v[40:43], a[168:175], v2
    buffer_store_dwordx2 v[18:19], v11, s[4:7], s51 offen offset:3584 sc1
    s_waitcnt lgkmcnt(2)
    v_smfmac_f32_16x16x64_bf16 v[96:99], v[44:47], a[48:55], v2
    v_smfmac_f32_16x16x64_bf16 v[100:103], v[44:47], a[56:63], v2
    v_smfmac_f32_16x16x64_bf16 v[104:107], v[44:47], a[176:183], v2
    v_smfmac_f32_16x16x64_bf16 v[108:111], v[44:47], a[184:191], v2
    buffer_load_dword v4, v7, s[4:7], 0 offen sc1
    s_waitcnt lgkmcnt(1)
    v_smfmac_f32_16x16x64_bf16 v[96:99], v[48:51], a[64:71], v2
    v_smfmac_f32_16x16x64_bf16 v[100:103], v[48:51], a[72:79], v2
    v_smfmac_f32_16x16x64_bf16 v[104:107], v[48:51], a[192:199], v2
    v_smfmac_f32_16x16x64_bf16 v[108:111], v[48:51], a[200:207], v2
    s_waitcnt lgkmcnt(0)
    v_smfmac_f32_16x16x64_bf16 v[96:99], v[52:55], a[80:87], v2
    v_smfmac_f32_16x16x64_bf16 v[100:103], v[52:55], a[88:95], v2
    v_smfmac_f32_16x16x64_bf16 v[104:107], v[52:55], a[208:215], v2
    v_smfmac_f32_16x16x64_bf16 v[108:111], v[52:55], a[216:223], v2
    s_nop 4
    v_pk_add_f32 v[96:97], v[96:97], v[98:99]
    v_pk_add_f32 v[100:101], v[100:101], v[102:103]
    v_pk_add_f32 v[104:105], v[104:105], v[106:107]
    v_pk_add_f32 v[108:109], v[108:109], v[110:111]
    v_cvt_pk_bf16_f32 v111, v108, v109
    v_cvt_pk_bf16_f32 v108, v96, v97
    v_cvt_pk_bf16_f32 v110, v100, v101
    v_cvt_pk_bf16_f32 v109, v104, v105
    v_and_or_b32 v108, v108, -2, s41
    buffer_store_dwordx4 v[108:111], v1, s[4:7], s37 offen sc1
    v_smfmac_f32_16x16x64_bf16 v[112:115], v[32:35], v[64:71], v2
    ds_read_b128 v[64:67], v1 offset:45056
    ds_read_b128 v[68:71], v1 offset:46080
    v_smfmac_f32_16x16x64_bf16 v[116:119], v[32:35], v[72:79], v2
    ds_read_b128 v[72:75], v1 offset:47104
    ds_read_b128 v[76:79], v1 offset:48128
    v_smfmac_f32_16x16x64_bf16 v[112:115], v[36:39], v[80:87], v2
    ds_read_b128 v[80:83], v1 offset:61440
    ds_read_b128 v[84:87], v1 offset:62464
    v_smfmac_f32_16x16x64_bf16 v[116:119], v[36:39], v[88:95], v2
    ds_read_b128 v[88:91], v1 offset:63488
    ds_read_b128 v[92:95], v1 offset:64512
    v_smfmac_f32_16x16x64_bf16 v[112:115], v[52:55], v[208:215], v2
    v_smfmac_f32_16x16x64_bf16 v[116:119], v[52:55], v[216:223], v2
    v_smfmac_f32_16x16x64_bf16 v[112:115], v[56:59], v[224:231], v2
    s_waitcnt lgkmcnt(6)
    v_smfmac_f32_16x16x64_bf16 v[112:115], v[40:43], v[64:71], v2
    ds_read_b128 v[64:67], v5 offset:12288
    ds_read_b128 v[68:71], v5 offset:13312
    s_waitcnt lgkmcnt(6)
    v_smfmac_f32_16x16x64_bf16 v[116:119], v[40:43], v[72:79], v2
    ds_read_b128 v[72:75], v5 offset:14336
    ds_read_b128 v[76:79], v5 offset:15360
    v_smfmac_f32_16x16x64_bf16 v[116:119], v[56:59], v[232:239], v2
    v_smfmac_f32_16x16x64_bf16 v[112:115], v[60:63], v[240:247], v2
    v_smfmac_f32_16x16x64_bf16 v[116:119], v[60:63], v[248:255], v2
    s_waitcnt lgkmcnt(6)
    v_smfmac_f32_16x16x64_bf16 v[112:115], v[44:47], v[80:87], v2
    s_waitcnt lgkmcnt(4)
    v_smfmac_f32_16x16x64_bf16 v[116:119], v[44:47], v[88:95], v2
    s_waitcnt lgkmcnt(2)
    v_smfmac_f32_16x16x64_bf16 v[112:115], v[48:51], v[64:71], v2
    s_waitcnt lgkmcnt(0)
    v_smfmac_f32_16x16x64_bf16 v[116:119], v[48:51], v[72:79], v2
    v_mfma_f32_16x16x16_bf16 v[100:103], v[108:109], v[16:17], 0
    v_mfma_f32_16x16x16_bf16 v[104:107], v[110:111], v[16:17], 0
    s_nop 4
    v_add_f32 v112, v112, v114
    v_add_f32 v113, v113, v115
    v_add_f32 v114, v116, v118
    v_add_f32 v115, v117, v119
    v_cvt_pk_bf16_f32 v18, v112, v113
    v_cvt_pk_bf16_f32 v19, v114, v115
    v_and_or_b32 v18, v18, -2, s41
    v_mov_b32 v112, v18
    v_mov_b32 v114, v19
    v_mov_b32 v92, v28
    v_mov_b32 v93, 0
    s_waitcnt vmcnt(4)
    s_barrier
    ds_read_b128 v[32:35], v6 offset:18432
    ds_read_b128 v[36:39], v6 offset:19456
    ds_read_b128 v[40:43], v6 offset:15360
    ds_read_b128 v[44:47], v6 offset:16384
    ds_read_b128 v[48:51], v6 offset:12288
    ds_read_b128 v[52:55], v6 offset:13312
    ds_read_b128 v[56:59], v6 offset:9216
    ds_read_b128 v[60:63], v6 offset:10240
    buffer_load_dwordx4 v[96:99], v1, s[4:7], s38 offen sc1
    s_barrier
    buffer_store_dwordx2 v[18:19], v11, s[4:7], s39 offen sc1
    s_nop 15
    s_nop 15
    buffer_load_dwordx4 v[20:23], v1, s[4:7], s38 offen sc1
    s_add_u32 s22, s21, 4
    s_cmp_gt_u32 s50, s22
    s_cbranch_scc1 mega_kernel_rs_w3_kvs
    s_waitcnt vmcnt(4)
    v_readlane_b32 s50, v4, 0
    v_readlane_b32 s22, v4, 2
    v_readlane_b32 s23, v4, 1
    v_readlane_b32 s24, v4, 3
    s_nop 3
    s_min_u32 s50, s50, s22
    s_min_u32 s23, s23, s24
    s_lshl_b32 s50, s50, 1
    s_lshl_b32 s23, s23, 1
    s_add_u32 s23, s23, 1
    s_min_u32 s50, s50, s23
mega_kernel_rs_kvb1:
    s_add_u32 s22, s21, 1
    s_min_u32 s22, s22, 63
    s_cmp_gt_u32 s50, s22
    s_cbranch_scc1 mega_kernel_rs_kvd1
    buffer_load_dword v4, v7, s[4:7], 0 offen sc1
    s_waitcnt vmcnt(0)
    v_readlane_b32 s50, v4, 0
    v_readlane_b32 s22, v4, 2
    v_readlane_b32 s23, v4, 1
    v_readlane_b32 s24, v4, 3
    s_nop 3
    s_min_u32 s50, s50, s22
    s_min_u32 s23, s23, s24
    s_lshl_b32 s50, s50, 1
    s_lshl_b32 s23, s23, 1
    s_add_u32 s23, s23, 1
    s_min_u32 s50, s50, s23
    s_branch mega_kernel_rs_kvb1
mega_kernel_rs_kvd1:
mega_kernel_rs_w3_kvs:
    s_waitcnt vmcnt(2)
    v_mfma_f32_16x16x16_bf16 v[80:83], v[96:97], v[16:17], v[100:103]
    v_mfma_f32_16x16x16_bf16 v[84:87], v[98:99], v[16:17], v[104:107]
    v_and_b32 v3, 1, v96
    v_cmp_ne_u32 vcc, s41, v3
    s_nop 4
    v_cvt_pk_bf16_f32 v64, v80, v81
    v_cvt_pk_bf16_f32 v65, v82, v83
    v_cvt_pk_bf16_f32 v66, v84, v85
    v_cvt_pk_bf16_f32 v67, v86, v87
    ds_write_b128 v6, v[64:67] offset:17408
    s_cbranch_vccnz mega_kernel_rs_w3_xslow
mega_kernel_rs_w3_xok:
    s_cmp_eq_u32 s21, 63
    s_cbranch_scc1 mega_kernel_rs_w3_last
    buffer_load_dwordx2 v[116:117], v11, s[4:7], s40 offen sc1
    s_waitcnt lgkmcnt(1)
    v_mfma_f32_16x16x32_bf16 v[80:83], v[32:35], v[64:67], 0
    s_waitcnt lgkmcnt(0)
    s_barrier
    ds_read_b128 v[68:71], v6 offset:14336
    ds_read_b128 v[72:75], v6 offset:11264
    ds_read_b128 v[76:79], v6 offset:8192
    v_mfma_f32_16x16x32_bf16 v[84:87], v[36:39], v[64:67], 0
    v_mfma_f32_16x16x32_bf16 v[88:91], v[64:67], v[64:67], 0
    buffer_load_dwordx2 v[20:21], v11, s[4:7], s40 offen sc1
    s_waitcnt lgkmcnt(2)
    v_mfma_f32_16x16x32_bf16 v[80:83], v[40:43], v[68:71], v[80:83]
    v_mfma_f32_16x16x32_bf16 v[84:87], v[44:47], v[68:71], v[84:87]
    v_mfma_f32_16x16x32_bf16 v[88:91], v[68:71], v[68:71], v[88:91]
    s_waitcnt lgkmcnt(1)
    v_mfma_f32_16x16x32_bf16 v[80:83], v[48:51], v[72:75], v[80:83]
    v_mfma_f32_16x16x32_bf16 v[84:87], v[52:55], v[72:75], v[84:87]
    v_mfma_f32_16x16x32_bf16 v[88:91], v[72:75], v[72:75], v[88:91]
    s_waitcnt lgkmcnt(0)
    v_mfma_f32_16x16x32_bf16 v[80:83], v[56:59], v[76:79], v[80:83]
    v_mfma_f32_16x16x32_bf16 v[84:87], v[60:63], v[76:79], v[84:87]
    v_mfma_f32_16x16x32_bf16 v[88:91], v[76:79], v[76:79], v[88:91]
    v_mfma_f32_32x32x4_2b_bf16 v[32:63], v[14:15], v[14:15], 0
    s_nop 4
    v_max3_f32 v4, v80, v81, v82
    v_max3_f32 v4, v4, v83, v84
    v_max3_f32 v4, v4, v85, v86
    v_max3_f32 v4, v4, v87, v88
    v_max_f32 v90, v4, v89
    v_max_f32 v4, v4, v89
    s_nop 0
    s_nop 0
    v_permlane16_swap_b32 v4, v90
    v_max_f32 v4, v4, v90
    v_max_f32 v90, v4, v90
    s_nop 1
    v_permlane32_swap_b32 v4, v90
    v_max_f32 v4, v4, v90
    v_mul_f32 v4, s34, v4
    v_pk_fma_f32 v[80:81], v[80:81], s[34:35], v[4:5] op_sel_hi:[1,0,0] neg_lo:[0,0,1] neg_hi:[0,0,1]
    v_pk_fma_f32 v[82:83], v[82:83], s[34:35], v[4:5] op_sel_hi:[1,0,0] neg_lo:[0,0,1] neg_hi:[0,0,1]
    v_pk_fma_f32 v[84:85], v[84:85], s[34:35], v[4:5] op_sel_hi:[1,0,0] neg_lo:[0,0,1] neg_hi:[0,0,1]
    v_pk_fma_f32 v[86:87], v[86:87], s[34:35], v[4:5] op_sel_hi:[1,0,0] neg_lo:[0,0,1] neg_hi:[0,0,1]
    v_pk_fma_f32 v[88:89], v[88:89], s[34:35], v[4:5] op_sel_hi:[1,0,0] neg_lo:[0,0,1] neg_hi:[0,0,1]
    v_exp_f32 v80, v80
    v_exp_f32 v81, v81
    v_exp_f32 v82, v82
    v_cvt_pk_bf16_f32 v68, v80, v81
    v_exp_f32 v83, v83
    v_exp_f32 v84, v84
    v_cvt_pk_bf16_f32 v69, v82, v83
    v_exp_f32 v85, v85
    v_exp_f32 v86, v86
    v_cvt_pk_bf16_f32 v70, v84, v85
    v_exp_f32 v87, v87
    v_exp_f32 v88, v88
    v_cvt_pk_bf16_f32 v71, v86, v87
    v_exp_f32 v89, v89
    s_nop 0
    v_mfma_f32_16x16x32_bf16 v[76:79], v[28:31], v[68:71], 0
    v_cvt_pk_bf16_f32 v72, v88, v89
    v_cvt_pk_bf16_f32 v73, v88, v89
    v_mfma_f32_16x16x32_bf16 v[100:103], v[120:123], v[68:71], 0
    s_waitcnt vmcnt(1)
    v_and_b32 v3, 1, v116
    v_cmp_ne_u32 vcc, s41, v3
    v_mfma_f32_16x16x32_bf16 v[104:107], v[124:127], v[68:71], 0
    v_mov_b32 v113, v116
    v_mov_b32 v115, v117
    v_mfma_f32_16x16x16_bf16 v[76:79], v[92:93], v[72:73], v[76:79]
    s_cbranch_vccnz mega_kernel_rs_w3_pv0
mega_kernel_rs_w3_pv2:
    v_mfma_f32_16x16x16_bf16 v[100:103], v[112:113], v[72:73], v[100:103]
    v_mfma_f32_16x16x16_bf16 v[104:107], v[114:115], v[72:73], v[104:107]
    buffer_load_dwordx4 v[120:123], v1, s[4:7], s44 offen
    buffer_load_dwordx4 v[124:127], v1, s[4:7], s44 offen offset:1024
    s_nop 2
    v_rcp_f32 v76, v76
    s_mov_b64 exec, s[28:29]
    v_pk_mul_f32 v[100:101], v[100:101], v[76:77] op_sel_hi:[1,0]
    v_pk_mul_f32 v[102:103], v[102:103], v[76:77] op_sel_hi:[1,0]
    v_pk_mul_f32 v[104:105], v[104:105], v[76:77] op_sel_hi:[1,0]
    v_pk_mul_f32 v[106:107], v[106:107], v[76:77] op_sel_hi:[1,0]
    v_cvt_pk_bf16_f32 v72, v100, v101
    v_cvt_pk_bf16_f32 v73, v102, v103
    v_cvt_pk_bf16_f32 v74, v104, v105
    v_cvt_pk_bf16_f32 v75, v106, v107
    ds_write_b128 v6, v[72:75] offset:21504
    s_mov_b64 exec, -1
    ds_read_b128 v[88:91], v5 offset:28672
    ds_read_b128 v[92:95], v5 offset:29696
    ds_read_b128 v[80:83], v5 offset:30720
    ds_read_b128 v[84:87], v5 offset:31744
    ds_read_b128 v[112:115], v5 offset:45056
    ds_read_b128 v[116:119], v5 offset:46080
    s_waitcnt lgkmcnt(6)
    s_barrier
    ds_read_b128 v[68:71], v6 offset:20480
    ds_read_b128 v[72:75], v6 offset:21504
    ds_read_b128 v[96:99], v5 offset:47104
    ds_read_b128 v[100:103], v5 offset:48128
    ds_read_b128 v[104:107], v5 offset:61440
    ds_read_b128 v[108:111], v5 offset:62464
    s_waitcnt lgkmcnt(5)
    v_smfmac_f32_16x16x64_bf16 v[32:35], v[68:71], v[128:135], v2
    s_add_u32 s21, s21, 1
    v_smfmac_f32_16x16x64_bf16 v[36:39], v[68:71], v[136:143], v2
    s_xor_b32 s38, s38, 1048576
    v_smfmac_f32_16x16x64_bf16 v[40:43], v[68:71], v[144:151], v2
    s_xor_b32 s37, s37, 1048576
    v_smfmac_f32_16x16x64_bf16 v[44:47], v[68:71], v[152:159], v2
    s_xor_b32 s40, s40, 1048576
    s_waitcnt lgkmcnt(4)
    v_smfmac_f32_16x16x64_bf16 v[32:35], v[72:75], v[160:167], v2
    s_xor_b32 s39, s39, 1048576
    v_smfmac_f32_16x16x64_bf16 v[36:39], v[72:75], v[168:175], v2
    s_lshr_b32 s41, s21, 1
    v_smfmac_f32_16x16x64_bf16 v[40:43], v[72:75], v[176:183], v2
    s_and_b32 s41, s41, 1
    v_smfmac_f32_16x16x64_bf16 v[44:47], v[72:75], v[184:191], v2
    s_xor_b32 s41, s41, 1
    v_smfmac_f32_16x16x64_bf16 v[48:51], v[68:71], v[192:199], v2
    s_xor_b32 s35, s35, 16384
    v_smfmac_f32_16x16x64_bf16 v[52:55], v[68:71], v[200:207], v2
    s_xor_b32 s36, s36, 16384
    s_waitcnt lgkmcnt(0)
    v_smfmac_f32_16x16x64_bf16 v[56:59], v[68:71], v[88:95], v2
    ds_read_b128 v[88:91], v5 offset:63488
    ds_read_b128 v[92:95], v5 offset:64512
    v_smfmac_f32_16x16x64_bf16 v[60:63], v[68:71], v[80:87], v2
    s_add_u32 s43, s43, 262144
    v_smfmac_f32_16x16x64_bf16 v[48:51], v[72:75], v[112:119], v2
    s_add_u32 s44, s44, 262144
    v_add_f32 v32, v32, v34
    v_add_f32 v33, v33, v35
    v_cvt_pk_bf16_f32 v32, v32, v33
    v_and_or_b32 v32, v32, -2, s42
    v_smfmac_f32_16x16x64_bf16 v[52:55], v[72:75], v[96:103], v2
    v_add_f32 v36, v36, v38
    v_add_f32 v37, v37, v39
    v_cvt_pk_bf16_f32 v33, v36, v37
    v_smfmac_f32_16x16x64_bf16 v[56:59], v[72:75], v[104:111], v2
    v_add_f32 v40, v40, v42
    v_add_f32 v41, v41, v43
    v_cvt_pk_bf16_f32 v34, v40, v41
    s_waitcnt lgkmcnt(0)
    v_smfmac_f32_16x16x64_bf16 v[60:63], v[72:75], v[88:95], v2
    v_add_f32 v44, v44, v46
    v_add_f32 v45, v45, v47
    v_cvt_pk_bf16_f32 v35, v44, v45
    buffer_store_dwordx4 v[32:35], v8, s[4:7], s46 offen sc1
    v_pk_add_f32 v[48:49], v[48:49], v[50:51]
    v_cvt_pk_bf16_f32 v48, v48, v49
    v_and_or_b32 v48, v48, -2, s42
    v_pk_add_f32 v[52:53], v[52:53], v[54:55]
    v_cvt_pk_bf16_f32 v49, v52, v53
    v_pk_add_f32 v[56:57], v[56:57], v[58:59]
    v_cvt_pk_bf16_f32 v50, v56, v57
    v_pk_add_f32 v[60:61], v[60:61], v[62:63]
    v_cvt_pk_bf16_f32 v51, v60, v61
    buffer_store_dwordx4 v[48:51], v8, s[4:7], s61 offen sc1
    s_waitcnt vmcnt(4)
    v_mov_b32 v20, v64
    v_mov_b32 v21, v65
    v_mov_b32 v22, v66
    v_mov_b32 v23, v67
    s_add_u32 s45, s45, 262144
    s_add_u32 s51, s51, 262144
    v_mfma_f32_32x32x8_bf16 v[96:111], v[14:15], v[14:15], 0
    v_mfma_f32_16x16x16_bf16 v[112:115], v[14:15], v[14:15], 0
    v_mfma_f32_16x16x16_bf16 v[116:119], v[14:15], v[14:15], 0
    ds_read_b128 v[64:67], v1 offset:12288
    ds_read_b128 v[68:71], v1 offset:13312
    ds_read_b128 v[72:75], v1 offset:14336
    ds_read_b128 v[76:79], v1 offset:15360
    ds_read_b128 v[80:83], v1 offset:28672
    ds_read_b128 v[84:87], v1 offset:29696
    ds_read_b128 v[88:91], v1 offset:30720
    ds_read_b128 v[92:95], v1 offset:31744
    v_mov_b32 v58, -1
    v_mov_b32 v59, -1
    s_waitcnt vmcnt(0)
mega_kernel_rs_w3_pc:
    buffer_load_dword v36, v13, s[4:7], s47 offen offset:192 sc1
    buffer_load_dword v37, v13, s[4:7], s47 offen offset:1216 sc1
    buffer_load_dword v38, v13, s[4:7], s47 offen offset:2240 sc1
    buffer_load_dword v39, v13, s[4:7], s47 offen offset:3264 sc1
    buffer_load_dword v40, v13, s[4:7], s25 offen offset:192 sc1
    buffer_load_dword v41, v13, s[4:7], s25 offen offset:1216 sc1
    buffer_load_dword v42, v13, s[4:7], s25 offen offset:2240 sc1
    buffer_load_dword v43, v13, s[4:7], s25 offen offset:3264 sc1
    s_waitcnt vmcnt(4)
    v_mfma_f32_16x16x32_bf16 v[52:55], v[36:39], v[24:27], 0
    v_bitop3_b32 v3, s42, v36, v37 bitop3:0x7e
    v_bitop3_b32 v4, s42, v38, v39 bitop3:0x7e
    s_waitcnt vmcnt(2)
    v_or_b32 v3, v3, v4
    v_bitop3_b32 v4, s42, v40, v41 bitop3:0x7e
    s_waitcnt vmcnt(0)
    v_mfma_f32_16x16x32_bf16 v[52:55], v[40:43], v[24:27], v[52:55]
    v_bitop3_b32 v56, s42, v42, v43 bitop3:0x7e
    v_or3_b32 v3, v3, v4, v56
    v_and_b32 v3, v0, v3
    v_cmp_ne_u32 vcc, 0, v3
    s_cbranch_vccnz mega_kernel_rs_w3_pc
    s_nop 2
    v_cvt_pk_bf16_f32 v56, v52, v53
    v_cvt_pk_bf16_f32 v57, v54, v55
    v_min_u32 v56, -2, v56
    s_mov_b64 exec, s[26:27]
    buffer_store_dwordx2 v[56:57], v9, s[4:7], s35 offen offset:192 sc1
    buffer_store_dwordx2 v[58:59], v9, s[4:7], s36 offen offset:192 sc1
    s_mov_b64 exec, -1
    s_xor_b32 s42, s42, 1
    s_branch mega_kernel_rs_w3_loop
mega_kernel_rs_w3_last:
    s_add_u32 s45, s45, 262144
    s_add_u32 s51, s51, 262144
    buffer_store_dwordx4 v[64:67], v10, s[4:7], s45 offen offset:192 sc1
    buffer_store_dwordx2 v[18:19], v11, s[4:7], s51 offen offset:3584 sc1
    s_branch mega_kernel_rs_end
mega_kernel_rs_w3_pafail:
    buffer_load_dwordx4 v[56:59], v12, s[4:7], s22 offen sc1
    buffer_load_dwordx4 v[60:63], v12, s[4:7], s22 offen offset:1024 sc1
    s_nop 7
    v_mov_b32 v96, 0
    v_mov_b32 v97, 0
    v_mov_b32 v98, 0
    v_mov_b32 v99, 0
    v_mov_b32 v100, 0
    v_mov_b32 v101, 0
    v_mov_b32 v102, 0
    v_mov_b32 v103, 0
    v_mov_b32 v104, 0
    v_mov_b32 v105, 0
    v_mov_b32 v106, 0
    v_mov_b32 v107, 0
    s_branch mega_kernel_rs_w3_pa
mega_kernel_rs_w3_xslow:
    buffer_load_dwordx4 v[96:99], v1, s[4:7], s38 offen sc1
    s_waitcnt vmcnt(1)
    v_and_b32 v3, 1, v20
    v_cmp_ne_u32 vcc, s41, v3
    s_cbranch_vccz mega_kernel_rs_w3_xgot1
    buffer_load_dwordx4 v[20:23], v1, s[4:7], s38 offen sc1
mega_kernel_rs_w3_px:
    s_waitcnt vmcnt(1)
    v_and_b32 v3, 1, v96
    v_cmp_ne_u32 vcc, s41, v3
    s_cbranch_vccz mega_kernel_rs_w3_xgot0
    buffer_load_dwordx4 v[96:99], v1, s[4:7], s38 offen sc1
    s_waitcnt vmcnt(1)
    v_and_b32 v3, 1, v20
    v_cmp_ne_u32 vcc, s41, v3
    s_cbranch_vccz mega_kernel_rs_w3_xgot1
    buffer_load_dwordx4 v[20:23], v1, s[4:7], s38 offen sc1
    s_branch mega_kernel_rs_w3_px
mega_kernel_rs_w3_xgot0:
    v_mfma_f32_16x16x16_bf16 v[80:83], v[96:97], v[16:17], v[100:103]
    v_mfma_f32_16x16x16_bf16 v[84:87], v[98:99], v[16:17], v[104:107]
    v_and_b32 v3, 1, v96
    v_cmp_ne_u32 vcc, s41, v3
    s_nop 4
    v_cvt_pk_bf16_f32 v64, v80, v81
    v_cvt_pk_bf16_f32 v65, v82, v83
    v_cvt_pk_bf16_f32 v66, v84, v85
    v_cvt_pk_bf16_f32 v67, v86, v87
    ds_write_b128 v6, v[64:67] offset:17408
    s_branch mega_kernel_rs_w3_xok
mega_kernel_rs_w3_xgot1:
    v_mfma_f32_16x16x16_bf16 v[80:83], v[20:21], v[16:17], v[100:103]
    v_mfma_f32_16x16x16_bf16 v[84:87], v[22:23], v[16:17], v[104:107]
    v_and_b32 v3, 1, v20
    v_cmp_ne_u32 vcc, s41, v3
    s_nop 4
    v_cvt_pk_bf16_f32 v64, v80, v81
    v_cvt_pk_bf16_f32 v65, v82, v83
    v_cvt_pk_bf16_f32 v66, v84, v85
    v_cvt_pk_bf16_f32 v67, v86, v87
    ds_write_b128 v6, v[64:67] offset:17408
    s_branch mega_kernel_rs_w3_xok
mega_kernel_rs_w3_pv0:
    s_waitcnt vmcnt(0)
    s_branch mega_kernel_rs_w3_pv1
mega_kernel_rs_w3_pv:
    buffer_load_dwordx2 v[20:21], v11, s[4:7], s40 offen sc1
    s_waitcnt vmcnt(0)
mega_kernel_rs_w3_pv1:
    v_and_b32 v3, 1, v20
    v_cmp_ne_u32 vcc, s41, v3
    v_mov_b32 v113, v20
    v_mov_b32 v115, v21
    s_cbranch_vccnz mega_kernel_rs_w3_pv
    s_branch mega_kernel_rs_w3_pv2
mega_kernel_rs_end:
    s_mov_b64 exec, -1
    v_mov_b32 v3, 64
    s_waitcnt vmcnt(0)
    s_barrier
    s_cmp_lg_u32 s20, 0
    s_cbranch_scc1 mega_kernel_rs_end2
    buffer_store_dword v3, v7, s[4:7], 0 offen sc1
mega_kernel_rs_end2:
    s_waitcnt vmcnt(0)
    s_endpgm
mega_kernel_bulk:
    s_load_dwordx2 s[8:9], s[0:1], 0
    s_load_dwordx2 s[40:41], s[0:1], 16
    s_load_dwordx2 s[42:43], s[0:1], 24
    s_load_dwordx2 s[44:45], s[0:1], 32
    v_lshrrev_b32 v2, 6, v0
    v_and_b32 v1, 63, v0
    v_readfirstlane_b32 s16, v2
    s_lshr_b32 s17, s92, 6
    s_bfe_u32 s18, s92, 0x50001
    s_and_b32 s19, s92, 1
    s_waitcnt lgkmcnt(0)
    s_mov_b32 s10, 4194304
    s_mov_b32 s11, 0x00020000
    s_cmp_eq_u32 s17, 1
    s_cselect_b32 s12, s42, s40
    s_cselect_b32 s13, s43, s41
    s_cmp_eq_u32 s17, 2
    s_cselect_b32 s12, s44, s12
    s_cselect_b32 s13, s45, s13
    s_mov_b32 s14, 8388608
    s_mov_b32 s15, 0x00020000
    v_lshrrev_b32 v2, 4, v1
    v_and_b32 v3, 15, v1
    v_lshlrev_b32 v4, 2, v2
    v_xor_b32 v4, v4, v3
    v_lshlrev_b32 v4, 4, v4
    s_lshl_b32 s20, s16, 5
    v_add_u32 v11, s20, v2
    v_lshl_add_u32 v11, v11, 13, v4
    s_lshl_b32 s20, s18, 8
    v_add_u32 v11, s20, v11
    s_lshl_b32 s22, s16, 13
    s_add_u32 m0, s22, 0
    s_mov_b32 s20, 0
    buffer_load_dwordx4 v11, s[12:15], s20 offen lds
    s_add_u32 m0, s22, 1024
    s_mov_b32 s20, 32768
    buffer_load_dwordx4 v11, s[12:15], s20 offen lds
    s_add_u32 m0, s22, 2048
    s_mov_b32 s20, 65536
    buffer_load_dwordx4 v11, s[12:15], s20 offen lds
    s_add_u32 m0, s22, 3072
    s_mov_b32 s20, 98304
    buffer_load_dwordx4 v11, s[12:15], s20 offen lds
    s_add_u32 m0, s22, 4096
    s_mov_b32 s20, 131072
    buffer_load_dwordx4 v11, s[12:15], s20 offen lds
    s_add_u32 m0, s22, 5120
    s_mov_b32 s20, 163840
    buffer_load_dwordx4 v11, s[12:15], s20 offen lds
    s_add_u32 m0, s22, 6144
    s_mov_b32 s20, 196608
    buffer_load_dwordx4 v11, s[12:15], s20 offen lds
    s_add_u32 m0, s22, 7168
    s_mov_b32 s20, 229376
    buffer_load_dwordx4 v11, s[12:15], s20 offen lds
    s_add_u32 m0, s22, 32768
    s_mov_b32 s20, 1048576
    buffer_load_dwordx4 v11, s[12:15], s20 offen lds
    s_add_u32 m0, s22, 33792
    s_mov_b32 s20, 1081344
    buffer_load_dwordx4 v11, s[12:15], s20 offen lds
    s_add_u32 m0, s22, 34816
    s_mov_b32 s20, 1114112
    buffer_load_dwordx4 v11, s[12:15], s20 offen lds
    s_add_u32 m0, s22, 35840
    s_mov_b32 s20, 1146880
    buffer_load_dwordx4 v11, s[12:15], s20 offen lds
    s_add_u32 m0, s22, 36864
    s_mov_b32 s20, 1179648
    buffer_load_dwordx4 v11, s[12:15], s20 offen lds
    s_add_u32 m0, s22, 37888
    s_mov_b32 s20, 1212416
    buffer_load_dwordx4 v11, s[12:15], s20 offen lds
    s_add_u32 m0, s22, 38912
    s_mov_b32 s20, 1245184
    buffer_load_dwordx4 v11, s[12:15], s20 offen lds
    s_add_u32 m0, s22, 39936
    s_mov_b32 s20, 1277952
    buffer_load_dwordx4 v11, s[12:15], s20 offen lds
    s_add_u32 m0, s22, 65536
    s_mov_b32 s20, 2097152
    buffer_load_dwordx4 v11, s[12:15], s20 offen lds
    s_add_u32 m0, s22, 66560
    s_mov_b32 s20, 2129920
    buffer_load_dwordx4 v11, s[12:15], s20 offen lds
    s_add_u32 m0, s22, 67584
    s_mov_b32 s20, 2162688
    buffer_load_dwordx4 v11, s[12:15], s20 offen lds
    s_add_u32 m0, s22, 68608
    s_mov_b32 s20, 2195456
    buffer_load_dwordx4 v11, s[12:15], s20 offen lds
    s_add_u32 m0, s22, 69632
    s_mov_b32 s20, 2228224
    buffer_load_dwordx4 v11, s[12:15], s20 offen lds
    s_add_u32 m0, s22, 70656
    s_mov_b32 s20, 2260992
    buffer_load_dwordx4 v11, s[12:15], s20 offen lds
    s_add_u32 m0, s22, 71680
    s_mov_b32 s20, 2293760
    buffer_load_dwordx4 v11, s[12:15], s20 offen lds
    s_add_u32 m0, s22, 72704
    s_mov_b32 s20, 2326528
    buffer_load_dwordx4 v11, s[12:15], s20 offen lds
    s_add_u32 m0, s22, 98304
    s_mov_b32 s20, 3145728
    buffer_load_dwordx4 v11, s[12:15], s20 offen lds
    s_add_u32 m0, s22, 99328
    s_mov_b32 s20, 3178496
    buffer_load_dwordx4 v11, s[12:15], s20 offen lds
    s_add_u32 m0, s22, 100352
    s_mov_b32 s20, 3211264
    buffer_load_dwordx4 v11, s[12:15], s20 offen lds
    s_add_u32 m0, s22, 101376
    s_mov_b32 s20, 3244032
    buffer_load_dwordx4 v11, s[12:15], s20 offen lds
    s_add_u32 m0, s22, 102400
    s_mov_b32 s20, 3276800
    buffer_load_dwordx4 v11, s[12:15], s20 offen lds
    s_add_u32 m0, s22, 103424
    s_mov_b32 s20, 3309568
    buffer_load_dwordx4 v11, s[12:15], s20 offen lds
    s_add_u32 m0, s22, 104448
    s_mov_b32 s20, 3342336
    buffer_load_dwordx4 v11, s[12:15], s20 offen lds
    s_add_u32 m0, s22, 105472
    s_mov_b32 s20, 3375104
    buffer_load_dwordx4 v11, s[12:15], s20 offen lds
    s_waitcnt vmcnt(32)
    s_barrier
    s_or_b32 s81, s97, s98
    s_cmp_lg_u32 s81, 0
    s_cbranch_scc1 mega_kernel_h0_3
    s_lshl_b32 s81, s93, 5
    v_mov_b32 v250, 1
    s_mov_b64 exec, 1
    buffer_atomic_add v250, off, s[88:91], s81 sc1
    s_mov_b64 exec, -1
mega_kernel_h0_3:
    v_and_b32 v3, 3, v1
    v_bfe_u32 v4, v1, 4, 1
    v_lshl_add_u32 v13, v3, 1, v4
    v_and_b32 v14, 1, v3
    v_lshlrev_b32 v14, 1, v14
    v_lshrrev_b32 v15, 1, v3
    v_add_u32 v14, v14, v15
    v_lshl_add_u32 v14, v4, 2, v14
    s_cmp_eq_u32 s17, 2
    s_cselect_b64 vcc, -1, 0
    v_cndmask_b32 v13, v14, v13, vcc
    v_bfe_u32 v14, v1, 2, 2
    v_xor_b32 v15, s16, v14
    v_lshlrev_b32 v15, 6, v15
    v_lshl_add_u32 v15, v13, 3, v15
    v_lshrrev_b32 v13, 5, v1
    v_lshl_add_u32 v13, v13, 3, v14
    v_lshl_add_u32 v12, v13, 8, v15
    v_and_b32 v3, 15, v1
    s_lshl_b32 s20, s16, 3
    v_add_u32 v13, s20, v2
    v_add_u32 v13, 0, v13
    v_and_b32 v14, 15, v13
    v_xor_b32 v14, v14, v3
    v_lshlrev_b32 v14, 4, v14
    v_lshl_add_u32 v6, v13, 11, v14
    v_add_u32 v13, s20, v2
    v_add_u32 v13, 4, v13
    v_and_b32 v14, 15, v13
    v_xor_b32 v14, v14, v3
    v_lshlrev_b32 v14, 4, v14
    v_lshl_add_u32 v7, v13, 11, v14
    v_and_b32 v13, 31, v1
    v_lshrrev_b32 v14, 5, v1
    v_xor_b32 v14, v14, v3
    v_lshlrev_b32 v14, 4, v14
    v_lshl_add_u32 v13, v13, 8, v14
    v_xor_b32 v16, 0, v13
    v_add_u32 v24, 0x10000, v16
    v_xor_b32 v17, 32, v13
    v_add_u32 v25, 0x10000, v17
    v_xor_b32 v18, 64, v13
    v_add_u32 v26, 0x10000, v18
    v_xor_b32 v19, 96, v13
    v_add_u32 v27, 0x10000, v19
    v_xor_b32 v20, 128, v13
    v_add_u32 v28, 0x10000, v20
    v_xor_b32 v21, 160, v13
    v_add_u32 v29, 0x10000, v21
    v_xor_b32 v22, 192, v13
    v_add_u32 v30, 0x10000, v22
    v_xor_b32 v23, 224, v13
    v_add_u32 v31, 0x10000, v23
    v_bfe_u32 v13, v1, 4, 1
    v_lshlrev_b32 v8, 10, v13
    v_lshrrev_b32 v13, 5, v1
    v_lshl_add_u32 v8, v13, 8, v8
    v_lshl_add_u32 v8, v3, 4, v8
    v_bfrev_b32 v13, 1
    s_lshl_b32 s20, s92, 7
    s_add_u32 s20, s20, 71303168
    v_mov_b32 v14, s20
    v_cmp_eq_u32 vcc, 0, v0
    s_lshl_b32 s24, s17, 24
    s_lshl_b32 s20, s19, 18
    v_cndmask_b32 v9, v13, v14, vcc
    s_add_u32 s24, s24, s20
    s_lshl_b32 s20, s18, 13
    s_add_u32 s24, s24, s20
    s_lshl_b32 s20, s16, 11
    s_add_u32 s24, s24, s20
    s_add_u32 s24, s24, 0
    s_lshl_b32 s23, s19, 16
    v_mov_b32 v10, 0
    s_lshl_b32 s21, s16, 11
    s_waitcnt vmcnt(24)
    s_barrier
    v_add_u32 v13, 0, v12
    ds_read_b64_tr_b16 a[0:1], v13 offset:0
    ds_read_b64_tr_b16 a[2:3], v13 offset:1024
    ds_read_b64_tr_b16 a[4:5], v13 offset:4096
    ds_read_b64_tr_b16 a[6:7], v13 offset:5120
    ds_read_b64_tr_b16 a[8:9], v13 offset:8192
    ds_read_b64_tr_b16 a[10:11], v13 offset:9216
    ds_read_b64_tr_b16 a[12:13], v13 offset:12288
    ds_read_b64_tr_b16 a[14:15], v13 offset:13312
    s_waitcnt lgkmcnt(0)
    ds_read_b64_tr_b16 a[16:17], v13 offset:16384
    ds_read_b64_tr_b16 a[18:19], v13 offset:17408
    ds_read_b64_tr_b16 a[20:21], v13 offset:20480
    ds_read_b64_tr_b16 a[22:23], v13 offset:21504
    ds_read_b64_tr_b16 a[24:25], v13 offset:24576
    ds_read_b64_tr_b16 a[26:27], v13 offset:25600
    ds_read_b64_tr_b16 a[28:29], v13 offset:28672
    ds_read_b64_tr_b16 a[30:31], v13 offset:29696
    s_waitcnt lgkmcnt(0)
    s_barrier
    s_add_u32 m0, s22, 0
    s_mov_b32 s20, 4194304
    buffer_load_dwordx4 v11, s[12:15], s20 offen lds
    s_add_u32 m0, s22, 1024
    s_mov_b32 s20, 4227072
    buffer_load_dwordx4 v11, s[12:15], s20 offen lds
    s_add_u32 m0, s22, 2048
    s_mov_b32 s20, 4259840
    buffer_load_dwordx4 v11, s[12:15], s20 offen lds
    s_add_u32 m0, s22, 3072
    s_mov_b32 s20, 4292608
    buffer_load_dwordx4 v11, s[12:15], s20 offen lds
    s_add_u32 m0, s22, 4096
    s_mov_b32 s20, 4325376
    buffer_load_dwordx4 v11, s[12:15], s20 offen lds
    s_add_u32 m0, s22, 5120
    s_mov_b32 s20, 4358144
    buffer_load_dwordx4 v11, s[12:15], s20 offen lds
    s_add_u32 m0, s22, 6144
    s_mov_b32 s20, 4390912
    buffer_load_dwordx4 v11, s[12:15], s20 offen lds
    s_add_u32 m0, s22, 7168
    s_mov_b32 s20, 4423680
    buffer_load_dwordx4 v11, s[12:15], s20 offen lds
    s_waitcnt vmcnt(24)
    s_barrier
    v_add_u32 v13, 32768, v12
    ds_read_b64_tr_b16 a[32:33], v13 offset:0
    ds_read_b64_tr_b16 a[34:35], v13 offset:1024
    ds_read_b64_tr_b16 a[36:37], v13 offset:4096
    ds_read_b64_tr_b16 a[38:39], v13 offset:5120
    ds_read_b64_tr_b16 a[40:41], v13 offset:8192
    ds_read_b64_tr_b16 a[42:43], v13 offset:9216
    ds_read_b64_tr_b16 a[44:45], v13 offset:12288
    ds_read_b64_tr_b16 a[46:47], v13 offset:13312
    s_waitcnt lgkmcnt(0)
    ds_read_b64_tr_b16 a[48:49], v13 offset:16384
    ds_read_b64_tr_b16 a[50:51], v13 offset:17408
    ds_read_b64_tr_b16 a[52:53], v13 offset:20480
    ds_read_b64_tr_b16 a[54:55], v13 offset:21504
    ds_read_b64_tr_b16 a[56:57], v13 offset:24576
    ds_read_b64_tr_b16 a[58:59], v13 offset:25600
    ds_read_b64_tr_b16 a[60:61], v13 offset:28672
    ds_read_b64_tr_b16 a[62:63], v13 offset:29696
    s_waitcnt lgkmcnt(0)
    s_barrier
    s_add_u32 m0, s22, 32768
    s_mov_b32 s20, 5242880
    buffer_load_dwordx4 v11, s[12:15], s20 offen lds
    s_add_u32 m0, s22, 33792
    s_mov_b32 s20, 5275648
    buffer_load_dwordx4 v11, s[12:15], s20 offen lds
    s_add_u32 m0, s22, 34816
    s_mov_b32 s20, 5308416
    buffer_load_dwordx4 v11, s[12:15], s20 offen lds
    s_add_u32 m0, s22, 35840
    s_mov_b32 s20, 5341184
    buffer_load_dwordx4 v11, s[12:15], s20 offen lds
    s_add_u32 m0, s22, 36864
    s_mov_b32 s20, 5373952
    buffer_load_dwordx4 v11, s[12:15], s20 offen lds
    s_add_u32 m0, s22, 37888
    s_mov_b32 s20, 5406720
    buffer_load_dwordx4 v11, s[12:15], s20 offen lds
    s_add_u32 m0, s22, 38912
    s_mov_b32 s20, 5439488
    buffer_load_dwordx4 v11, s[12:15], s20 offen lds
    s_add_u32 m0, s22, 39936
    s_mov_b32 s20, 5472256
    buffer_load_dwordx4 v11, s[12:15], s20 offen lds
    s_waitcnt vmcnt(24)
    s_barrier
    v_add_u32 v13, 65536, v12
    ds_read_b64_tr_b16 a[64:65], v13 offset:0
    ds_read_b64_tr_b16 a[66:67], v13 offset:1024
    ds_read_b64_tr_b16 a[68:69], v13 offset:4096
    ds_read_b64_tr_b16 a[70:71], v13 offset:5120
    ds_read_b64_tr_b16 a[72:73], v13 offset:8192
    ds_read_b64_tr_b16 a[74:75], v13 offset:9216
    ds_read_b64_tr_b16 a[76:77], v13 offset:12288
    ds_read_b64_tr_b16 a[78:79], v13 offset:13312
    s_waitcnt lgkmcnt(0)
    ds_read_b64_tr_b16 a[80:81], v13 offset:16384
    ds_read_b64_tr_b16 a[82:83], v13 offset:17408
    ds_read_b64_tr_b16 a[84:85], v13 offset:20480
    ds_read_b64_tr_b16 a[86:87], v13 offset:21504
    ds_read_b64_tr_b16 a[88:89], v13 offset:24576
    ds_read_b64_tr_b16 a[90:91], v13 offset:25600
    ds_read_b64_tr_b16 a[92:93], v13 offset:28672
    ds_read_b64_tr_b16 a[94:95], v13 offset:29696
    s_waitcnt lgkmcnt(0)
    s_barrier
    s_add_u32 m0, s22, 65536
    s_mov_b32 s20, 6291456
    buffer_load_dwordx4 v11, s[12:15], s20 offen lds
    s_add_u32 m0, s22, 66560
    s_mov_b32 s20, 6324224
    buffer_load_dwordx4 v11, s[12:15], s20 offen lds
    s_add_u32 m0, s22, 67584
    s_mov_b32 s20, 6356992
    buffer_load_dwordx4 v11, s[12:15], s20 offen lds
    s_add_u32 m0, s22, 68608
    s_mov_b32 s20, 6389760
    buffer_load_dwordx4 v11, s[12:15], s20 offen lds
    s_add_u32 m0, s22, 69632
    s_mov_b32 s20, 6422528
    buffer_load_dwordx4 v11, s[12:15], s20 offen lds
    s_add_u32 m0, s22, 70656
    s_mov_b32 s20, 6455296
    buffer_load_dwordx4 v11, s[12:15], s20 offen lds
    s_add_u32 m0, s22, 71680
    s_mov_b32 s20, 6488064
    buffer_load_dwordx4 v11, s[12:15], s20 offen lds
    s_add_u32 m0, s22, 72704
    s_mov_b32 s20, 6520832
    buffer_load_dwordx4 v11, s[12:15], s20 offen lds
    s_waitcnt vmcnt(24)
    s_barrier
    v_and_b32 v254, 7, v0
    v_lshlrev_b32 v254, 5, v254
    buffer_load_dword v252, v254, s[88:91], 0 offen sc1
    v_add_u32 v13, 98304, v12
    ds_read_b64_tr_b16 a[96:97], v13 offset:0
    ds_read_b64_tr_b16 a[98:99], v13 offset:1024
    ds_read_b64_tr_b16 a[100:101], v13 offset:4096
    ds_read_b64_tr_b16 a[102:103], v13 offset:5120
    ds_read_b64_tr_b16 a[104:105], v13 offset:8192
    ds_read_b64_tr_b16 a[106:107], v13 offset:9216
    ds_read_b64_tr_b16 a[108:109], v13 offset:12288
    ds_read_b64_tr_b16 a[110:111], v13 offset:13312
    s_waitcnt lgkmcnt(0)
    ds_read_b64_tr_b16 a[112:113], v13 offset:16384
    ds_read_b64_tr_b16 a[114:115], v13 offset:17408
    ds_read_b64_tr_b16 a[116:117], v13 offset:20480
    ds_read_b64_tr_b16 a[118:119], v13 offset:21504
    ds_read_b64_tr_b16 a[120:121], v13 offset:24576
    ds_read_b64_tr_b16 a[122:123], v13 offset:25600
    ds_read_b64_tr_b16 a[124:125], v13 offset:28672
    ds_read_b64_tr_b16 a[126:127], v13 offset:29696
    s_waitcnt lgkmcnt(0)
    s_barrier
    s_add_u32 m0, s22, 98304
    s_mov_b32 s20, 7340032
    buffer_load_dwordx4 v11, s[12:15], s20 offen lds
    s_add_u32 m0, s22, 99328
    s_mov_b32 s20, 7372800
    buffer_load_dwordx4 v11, s[12:15], s20 offen lds
    s_add_u32 m0, s22, 100352
    s_mov_b32 s20, 7405568
    buffer_load_dwordx4 v11, s[12:15], s20 offen lds
    s_add_u32 m0, s22, 101376
    s_mov_b32 s20, 7438336
    buffer_load_dwordx4 v11, s[12:15], s20 offen lds
    s_add_u32 m0, s22, 102400
    s_mov_b32 s20, 7471104
    buffer_load_dwordx4 v11, s[12:15], s20 offen lds
    s_add_u32 m0, s22, 103424
    s_mov_b32 s20, 7503872
    buffer_load_dwordx4 v11, s[12:15], s20 offen lds
    s_add_u32 m0, s22, 104448
    s_mov_b32 s20, 7536640
    buffer_load_dwordx4 v11, s[12:15], s20 offen lds
    s_add_u32 m0, s22, 105472
    s_mov_b32 s20, 7569408
    buffer_load_dwordx4 v11, s[12:15], s20 offen lds
    s_waitcnt vmcnt(24)
    s_barrier
    v_add_u32 v13, 0, v12
    ds_read_b64_tr_b16 a[128:129], v13 offset:0
    ds_read_b64_tr_b16 a[130:131], v13 offset:1024
    ds_read_b64_tr_b16 a[132:133], v13 offset:4096
    ds_read_b64_tr_b16 a[134:135], v13 offset:5120
    ds_read_b64_tr_b16 a[136:137], v13 offset:8192
    ds_read_b64_tr_b16 a[138:139], v13 offset:9216
    ds_read_b64_tr_b16 a[140:141], v13 offset:12288
    ds_read_b64_tr_b16 a[142:143], v13 offset:13312
    s_waitcnt lgkmcnt(0)
    ds_read_b64_tr_b16 a[144:145], v13 offset:16384
    ds_read_b64_tr_b16 a[146:147], v13 offset:17408
    ds_read_b64_tr_b16 a[148:149], v13 offset:20480
    ds_read_b64_tr_b16 a[150:151], v13 offset:21504
    ds_read_b64_tr_b16 a[152:153], v13 offset:24576
    ds_read_b64_tr_b16 a[154:155], v13 offset:25600
    ds_read_b64_tr_b16 a[156:157], v13 offset:28672
    ds_read_b64_tr_b16 a[158:159], v13 offset:29696
    s_waitcnt lgkmcnt(0)
    s_barrier
    s_add_u32 m0, s21, 0
    s_add_u32 s20, s23, 0
    buffer_load_dwordx4 v6, s[8:11], s20 offen lds
    s_add_u32 m0, s21, 1024
    s_add_u32 s20, s23, 0
    buffer_load_dwordx4 v7, s[8:11], s20 offen lds
    s_add_u32 m0, s21, 8192
    s_add_u32 s20, s23, 256
    buffer_load_dwordx4 v6, s[8:11], s20 offen lds
    s_add_u32 m0, s21, 9216
    s_add_u32 s20, s23, 256
    buffer_load_dwordx4 v7, s[8:11], s20 offen lds
    s_add_u32 m0, s21, 16384
    s_add_u32 s20, s23, 512
    buffer_load_dwordx4 v6, s[8:11], s20 offen lds
    s_add_u32 m0, s21, 17408
    s_add_u32 s20, s23, 512
    buffer_load_dwordx4 v7, s[8:11], s20 offen lds
    s_add_u32 m0, s21, 24576
    s_add_u32 s20, s23, 768
    buffer_load_dwordx4 v6, s[8:11], s20 offen lds
    s_add_u32 m0, s21, 25600
    s_add_u32 s20, s23, 768
    buffer_load_dwordx4 v7, s[8:11], s20 offen lds
    s_waitcnt vmcnt(24)
    s_barrier
    v_add_u32 v13, 32768, v12
    ds_read_b64_tr_b16 a[160:161], v13 offset:0
    ds_read_b64_tr_b16 a[162:163], v13 offset:1024
    ds_read_b64_tr_b16 a[164:165], v13 offset:4096
    ds_read_b64_tr_b16 a[166:167], v13 offset:5120
    ds_read_b64_tr_b16 a[168:169], v13 offset:8192
    ds_read_b64_tr_b16 a[170:171], v13 offset:9216
    ds_read_b64_tr_b16 a[172:173], v13 offset:12288
    ds_read_b64_tr_b16 a[174:175], v13 offset:13312
    s_waitcnt lgkmcnt(0)
    ds_read_b64_tr_b16 a[176:177], v13 offset:16384
    ds_read_b64_tr_b16 a[178:179], v13 offset:17408
    ds_read_b64_tr_b16 a[180:181], v13 offset:20480
    ds_read_b64_tr_b16 a[182:183], v13 offset:21504
    ds_read_b64_tr_b16 a[184:185], v13 offset:24576
    ds_read_b64_tr_b16 a[186:187], v13 offset:25600
    ds_read_b64_tr_b16 a[188:189], v13 offset:28672
    ds_read_b64_tr_b16 a[190:191], v13 offset:29696
    s_waitcnt lgkmcnt(0)
    s_barrier
    s_add_u32 m0, s21, 32768
    s_add_u32 s20, s23, 1024
    buffer_load_dwordx4 v6, s[8:11], s20 offen lds
    s_add_u32 m0, s21, 33792
    s_add_u32 s20, s23, 1024
    buffer_load_dwordx4 v7, s[8:11], s20 offen lds
    s_add_u32 m0, s21, 40960
    s_add_u32 s20, s23, 1280
    buffer_load_dwordx4 v6, s[8:11], s20 offen lds
    s_add_u32 m0, s21, 41984
    s_add_u32 s20, s23, 1280
    buffer_load_dwordx4 v7, s[8:11], s20 offen lds
    s_add_u32 m0, s21, 49152
    s_add_u32 s20, s23, 1536
    buffer_load_dwordx4 v6, s[8:11], s20 offen lds
    s_add_u32 m0, s21, 50176
    s_add_u32 s20, s23, 1536
    buffer_load_dwordx4 v7, s[8:11], s20 offen lds
    s_add_u32 m0, s21, 57344
    s_add_u32 s20, s23, 1792
    buffer_load_dwordx4 v6, s[8:11], s20 offen lds
    s_add_u32 m0, s21, 58368
    s_add_u32 s20, s23, 1792
    buffer_load_dwordx4 v7, s[8:11], s20 offen lds
    s_waitcnt vmcnt(24)
    s_barrier
    v_add_u32 v13, 65536, v12
    ds_read_b64_tr_b16 a[192:193], v13 offset:0
    ds_read_b64_tr_b16 a[194:195], v13 offset:1024
    ds_read_b64_tr_b16 a[196:197], v13 offset:4096
    ds_read_b64_tr_b16 a[198:199], v13 offset:5120
    ds_read_b64_tr_b16 a[200:201], v13 offset:8192
    ds_read_b64_tr_b16 a[202:203], v13 offset:9216
    ds_read_b64_tr_b16 a[204:205], v13 offset:12288
    ds_read_b64_tr_b16 a[206:207], v13 offset:13312
    s_waitcnt lgkmcnt(0)
    ds_read_b64_tr_b16 a[208:209], v13 offset:16384
    ds_read_b64_tr_b16 a[210:211], v13 offset:17408
    ds_read_b64_tr_b16 a[212:213], v13 offset:20480
    ds_read_b64_tr_b16 a[214:215], v13 offset:21504
    ds_read_b64_tr_b16 a[216:217], v13 offset:24576
    ds_read_b64_tr_b16 a[218:219], v13 offset:25600
    ds_read_b64_tr_b16 a[220:221], v13 offset:28672
    ds_read_b64_tr_b16 a[222:223], v13 offset:29696
    s_waitcnt lgkmcnt(0)
    s_barrier
    s_add_u32 s23, s23, 131072
    s_add_u32 m0, s21, 65536
    s_add_u32 s20, s23, 0
    buffer_load_dwordx4 v6, s[8:11], s20 offen lds
    s_add_u32 m0, s21, 66560
    s_add_u32 s20, s23, 0
    buffer_load_dwordx4 v7, s[8:11], s20 offen lds
    s_add_u32 m0, s21, 73728
    s_add_u32 s20, s23, 256
    buffer_load_dwordx4 v6, s[8:11], s20 offen lds
    s_add_u32 m0, s21, 74752
    s_add_u32 s20, s23, 256
    buffer_load_dwordx4 v7, s[8:11], s20 offen lds
    s_add_u32 m0, s21, 81920
    s_add_u32 s20, s23, 512
    buffer_load_dwordx4 v6, s[8:11], s20 offen lds
    s_add_u32 m0, s21, 82944
    s_add_u32 s20, s23, 512
    buffer_load_dwordx4 v7, s[8:11], s20 offen lds
    s_add_u32 m0, s21, 90112
    s_add_u32 s20, s23, 768
    buffer_load_dwordx4 v6, s[8:11], s20 offen lds
    s_add_u32 m0, s21, 91136
    s_add_u32 s20, s23, 768
    buffer_load_dwordx4 v7, s[8:11], s20 offen lds
    s_waitcnt vmcnt(24)
    s_barrier
    s_cmp_lg_u32 s97, 0
    s_cbranch_scc1 mega_kernel_h2_4_ok
mega_kernel_h2_4_ev:
    v_cmp_ne_u32 vcc, 32, v252
    s_cbranch_vccz mega_kernel_h2_4_ok
    s_mov_b32 s78, 0
    v_readlane_b32 s81, v252, 0
    s_nop 3
    s_add_u32 s78, s78, s81
    v_readlane_b32 s81, v252, 1
    s_nop 3
    s_add_u32 s78, s78, s81
    v_readlane_b32 s81, v252, 2
    s_nop 3
    s_add_u32 s78, s78, s81
    v_readlane_b32 s81, v252, 3
    s_nop 3
    s_add_u32 s78, s78, s81
    v_readlane_b32 s81, v252, 4
    s_nop 3
    s_add_u32 s78, s78, s81
    v_readlane_b32 s81, v252, 5
    s_nop 3
    s_add_u32 s78, s78, s81
    v_readlane_b32 s81, v252, 6
    s_nop 3
    s_add_u32 s78, s78, s81
    v_readlane_b32 s81, v252, 7
    s_nop 3
    s_add_u32 s78, s78, s81
    s_cmp_eq_u32 s78, 256
    s_cbranch_scc1 mega_kernel_redo
    buffer_load_dword v252, v254, s[88:91], 0 offen sc1
    s_waitcnt vmcnt(0)
    s_branch mega_kernel_h2_4_ev
mega_kernel_h2_4_ok:
    v_add_u32 v13, 98304, v12
    ds_read_b64_tr_b16 a[224:225], v13 offset:0
    ds_read_b64_tr_b16 a[226:227], v13 offset:1024
    ds_read_b64_tr_b16 a[228:229], v13 offset:4096
    ds_read_b64_tr_b16 a[230:231], v13 offset:5120
    ds_read_b64_tr_b16 a[232:233], v13 offset:8192
    ds_read_b64_tr_b16 a[234:235], v13 offset:9216
    ds_read_b64_tr_b16 a[236:237], v13 offset:12288
    ds_read_b64_tr_b16 a[238:239], v13 offset:13312
    s_waitcnt lgkmcnt(0)
    ds_read_b64_tr_b16 a[240:241], v13 offset:16384
    ds_read_b64_tr_b16 a[242:243], v13 offset:17408
    ds_read_b64_tr_b16 a[244:245], v13 offset:20480
    ds_read_b64_tr_b16 a[246:247], v13 offset:21504
    ds_read_b64_tr_b16 a[248:249], v13 offset:24576
    ds_read_b64_tr_b16 a[250:251], v13 offset:25600
    ds_read_b64_tr_b16 a[252:253], v13 offset:28672
    ds_read_b64_tr_b16 a[254:255], v13 offset:29696
    s_waitcnt lgkmcnt(0)
    s_barrier
    s_waitcnt vmcnt(16)
    s_barrier
    s_cmp_eq_u32 s17, 2
    s_cbranch_scc1 mega_kernel_q_v
    ds_read_b128 v[32:35], v16 offset:0
    ds_read_b128 v[36:39], v17 offset:0
    ds_read_b128 v[40:43], v18 offset:0
    ds_read_b128 v[44:47], v19 offset:0
    ds_read_b128 v[48:51], v20 offset:0
    ds_read_b128 v[52:55], v21 offset:0
    s_mov_b32 s25, 0
mega_kernel_q_qk_loop:
    s_waitcnt lgkmcnt(5)
    v_mfma_f32_32x32x16_bf16 v[64:79], a[0:3], v[32:35], 0
    ds_read_b128 v[56:59], v22 offset:0
    s_waitcnt lgkmcnt(5)
    v_mfma_f32_32x32x16_bf16 v[64:79], a[4:7], v[36:39], v[64:79]
    ds_read_b128 v[60:63], v23 offset:0
    s_waitcnt lgkmcnt(5)
    v_mfma_f32_32x32x16_bf16 v[64:79], a[8:11], v[40:43], v[64:79]
    ds_read_b128 v[32:35], v16 offset:8192
    s_cmp_eq_u32 s25, 0
    s_cbranch_scc1 mega_kernel_q_qk_sk2
    s_add_u32 m0, s21, 74752
    s_add_u32 s20, s23, 256
    buffer_load_dwordx4 v7, s[8:11], s20 offen lds
mega_kernel_q_qk_sk2:
    s_waitcnt lgkmcnt(5)
    v_mfma_f32_32x32x16_bf16 v[64:79], a[12:15], v[44:47], v[64:79]
    ds_read_b128 v[36:39], v17 offset:8192
    s_waitcnt lgkmcnt(5)
    v_mfma_f32_32x32x16_bf16 v[64:79], a[16:19], v[48:51], v[64:79]
    ds_read_b128 v[40:43], v18 offset:8192
    s_waitcnt lgkmcnt(5)
    v_mfma_f32_32x32x16_bf16 v[64:79], a[20:23], v[52:55], v[64:79]
    ds_read_b128 v[44:47], v19 offset:8192
    s_cmp_eq_u32 s25, 0
    s_cbranch_scc1 mega_kernel_q_qk_sk5
    s_add_u32 m0, s21, 81920
    s_add_u32 s20, s23, 512
    buffer_load_dwordx4 v6, s[8:11], s20 offen lds
mega_kernel_q_qk_sk5:
    s_waitcnt lgkmcnt(5)
    v_mfma_f32_32x32x16_bf16 v[64:79], a[24:27], v[56:59], v[64:79]
    ds_read_b128 v[48:51], v20 offset:8192
    s_waitcnt lgkmcnt(5)
    v_mfma_f32_32x32x16_bf16 v[64:79], a[28:31], v[60:63], v[64:79]
    ds_read_b128 v[52:55], v21 offset:8192
    s_waitcnt lgkmcnt(5)
    v_mfma_f32_32x32x16_bf16 v[64:79], a[32:35], v[32:35], v[64:79]
    ds_read_b128 v[56:59], v22 offset:8192
    s_cmp_eq_u32 s25, 0
    s_cbranch_scc1 mega_kernel_q_qk_sk8
    s_add_u32 m0, s21, 82944
    s_add_u32 s20, s23, 512
    buffer_load_dwordx4 v7, s[8:11], s20 offen lds
mega_kernel_q_qk_sk8:
    s_waitcnt lgkmcnt(5)
    v_mfma_f32_32x32x16_bf16 v[64:79], a[36:39], v[36:39], v[64:79]
    ds_read_b128 v[60:63], v23 offset:8192
    s_waitcnt lgkmcnt(5)
    v_mfma_f32_32x32x16_bf16 v[64:79], a[40:43], v[40:43], v[64:79]
    ds_read_b128 v[32:35], v16 offset:16384
    s_waitcnt lgkmcnt(5)
    v_mfma_f32_32x32x16_bf16 v[64:79], a[44:47], v[44:47], v[64:79]
    ds_read_b128 v[36:39], v17 offset:16384
    s_cmp_eq_u32 s25, 0
    s_cbranch_scc1 mega_kernel_q_qk_sk11
    s_add_u32 m0, s21, 90112
    s_add_u32 s20, s23, 768
    buffer_load_dwordx4 v6, s[8:11], s20 offen lds
mega_kernel_q_qk_sk11:
    s_waitcnt lgkmcnt(5)
    v_mfma_f32_32x32x16_bf16 v[64:79], a[48:51], v[48:51], v[64:79]
    ds_read_b128 v[40:43], v18 offset:16384
    s_waitcnt lgkmcnt(5)
    v_mfma_f32_32x32x16_bf16 v[64:79], a[52:55], v[52:55], v[64:79]
    ds_read_b128 v[44:47], v19 offset:16384
    s_waitcnt lgkmcnt(5)
    v_mfma_f32_32x32x16_bf16 v[64:79], a[56:59], v[56:59], v[64:79]
    ds_read_b128 v[48:51], v20 offset:16384
    s_cmp_eq_u32 s25, 0
    s_cbranch_scc1 mega_kernel_q_qk_sk14
    s_add_u32 m0, s21, 91136
    s_add_u32 s20, s23, 768
    buffer_load_dwordx4 v7, s[8:11], s20 offen lds
mega_kernel_q_qk_sk14:
    s_waitcnt lgkmcnt(5)
    v_mfma_f32_32x32x16_bf16 v[64:79], a[60:63], v[60:63], v[64:79]
    ds_read_b128 v[52:55], v21 offset:16384
    s_waitcnt lgkmcnt(5)
    v_mfma_f32_32x32x16_bf16 v[64:79], a[64:67], v[32:35], v[64:79]
    ds_read_b128 v[56:59], v22 offset:16384
    s_cmp_eq_u32 s25, 0
    s_cbranch_scc1 mega_kernel_q_qk_ne0
    v_cvt_pk_bf16_f32 v96, v80, v81
    v_cvt_pk_bf16_f32 v97, v82, v83
    v_cvt_pk_bf16_f32 v98, v84, v85
    v_cvt_pk_bf16_f32 v99, v86, v87
    buffer_store_dwordx4 v[96:99], v8, s[84:87], s24 offen offset:0 sc1
mega_kernel_q_qk_ne0:
    s_waitcnt lgkmcnt(5)
    v_mfma_f32_32x32x16_bf16 v[64:79], a[68:71], v[36:39], v[64:79]
    ds_read_b128 v[60:63], v23 offset:16384
    s_waitcnt lgkmcnt(5)
    v_mfma_f32_32x32x16_bf16 v[64:79], a[72:75], v[40:43], v[64:79]
    ds_read_b128 v[32:35], v16 offset:24576
    s_cmp_eq_u32 s25, 0
    s_cbranch_scc1 mega_kernel_q_qk_ne1
    v_cvt_pk_bf16_f32 v100, v88, v89
    v_cvt_pk_bf16_f32 v101, v90, v91
    v_cvt_pk_bf16_f32 v102, v92, v93
    v_cvt_pk_bf16_f32 v103, v94, v95
    buffer_store_dwordx4 v[100:103], v8, s[84:87], s24 offen offset:512 sc1
    s_add_u32 s24, s24, 524288
mega_kernel_q_qk_ne1:
    s_waitcnt lgkmcnt(5)
    v_mfma_f32_32x32x16_bf16 v[64:79], a[76:79], v[44:47], v[64:79]
    ds_read_b128 v[36:39], v17 offset:24576
    s_waitcnt lgkmcnt(5)
    v_mfma_f32_32x32x16_bf16 v[64:79], a[80:83], v[48:51], v[64:79]
    ds_read_b128 v[40:43], v18 offset:24576
    s_waitcnt lgkmcnt(5)
    v_mfma_f32_32x32x16_bf16 v[64:79], a[84:87], v[52:55], v[64:79]
    ds_read_b128 v[44:47], v19 offset:24576
    s_waitcnt lgkmcnt(5)
    v_mfma_f32_32x32x16_bf16 v[64:79], a[88:91], v[56:59], v[64:79]
    ds_read_b128 v[48:51], v20 offset:24576
    s_waitcnt lgkmcnt(5)
    v_mfma_f32_32x32x16_bf16 v[64:79], a[92:95], v[60:63], v[64:79]
    ds_read_b128 v[52:55], v21 offset:24576
    s_waitcnt vmcnt(8)
    s_barrier
    s_waitcnt lgkmcnt(5)
    v_mfma_f32_32x32x16_bf16 v[64:79], a[96:99], v[32:35], v[64:79]
    ds_read_b128 v[56:59], v22 offset:24576
    s_waitcnt lgkmcnt(5)
    v_mfma_f32_32x32x16_bf16 v[64:79], a[100:103], v[36:39], v[64:79]
    ds_read_b128 v[60:63], v23 offset:24576
    s_add_u32 m0, s21, 98304
    s_add_u32 s20, s23, 1024
    buffer_load_dwordx4 v6, s[8:11], s20 offen lds
    s_waitcnt lgkmcnt(5)
    v_mfma_f32_32x32x16_bf16 v[64:79], a[104:107], v[40:43], v[64:79]
    ds_read_b128 v[32:35], v16 offset:32768
    s_waitcnt lgkmcnt(5)
    v_mfma_f32_32x32x16_bf16 v[64:79], a[108:111], v[44:47], v[64:79]
    ds_read_b128 v[36:39], v17 offset:32768
    s_waitcnt lgkmcnt(5)
    v_mfma_f32_32x32x16_bf16 v[64:79], a[112:115], v[48:51], v[64:79]
    ds_read_b128 v[40:43], v18 offset:32768
    s_add_u32 m0, s21, 99328
    s_add_u32 s20, s23, 1024
    buffer_load_dwordx4 v7, s[8:11], s20 offen lds
    s_waitcnt lgkmcnt(5)
    v_mfma_f32_32x32x16_bf16 v[64:79], a[116:119], v[52:55], v[64:79]
    ds_read_b128 v[44:47], v19 offset:32768
    s_waitcnt lgkmcnt(5)
    v_mfma_f32_32x32x16_bf16 v[64:79], a[120:123], v[56:59], v[64:79]
    ds_read_b128 v[48:51], v20 offset:32768
    s_waitcnt lgkmcnt(5)
    v_mfma_f32_32x32x16_bf16 v[64:79], a[124:127], v[60:63], v[64:79]
    ds_read_b128 v[52:55], v21 offset:32768
    s_add_u32 m0, s21, 106496
    s_add_u32 s20, s23, 1280
    buffer_load_dwordx4 v6, s[8:11], s20 offen lds
    s_waitcnt lgkmcnt(5)
    v_mfma_f32_32x32x16_bf16 v[64:79], a[128:131], v[32:35], v[64:79]
    ds_read_b128 v[56:59], v22 offset:32768
    s_waitcnt lgkmcnt(5)
    v_mfma_f32_32x32x16_bf16 v[64:79], a[132:135], v[36:39], v[64:79]
    ds_read_b128 v[60:63], v23 offset:32768
    s_waitcnt lgkmcnt(5)
    v_mfma_f32_32x32x16_bf16 v[64:79], a[136:139], v[40:43], v[64:79]
    ds_read_b128 v[32:35], v16 offset:40960
    s_add_u32 m0, s21, 107520
    s_add_u32 s20, s23, 1280
    buffer_load_dwordx4 v7, s[8:11], s20 offen lds
    s_waitcnt lgkmcnt(5)
    v_mfma_f32_32x32x16_bf16 v[64:79], a[140:143], v[44:47], v[64:79]
    ds_read_b128 v[36:39], v17 offset:40960
    s_waitcnt lgkmcnt(5)
    v_mfma_f32_32x32x16_bf16 v[64:79], a[144:147], v[48:51], v[64:79]
    ds_read_b128 v[40:43], v18 offset:40960
    s_waitcnt lgkmcnt(5)
    v_mfma_f32_32x32x16_bf16 v[64:79], a[148:151], v[52:55], v[64:79]
    ds_read_b128 v[44:47], v19 offset:40960
    s_add_u32 m0, s21, 114688
    s_add_u32 s20, s23, 1536
    buffer_load_dwordx4 v6, s[8:11], s20 offen lds
    s_waitcnt lgkmcnt(5)
    v_mfma_f32_32x32x16_bf16 v[64:79], a[152:155], v[56:59], v[64:79]
    ds_read_b128 v[48:51], v20 offset:40960
    s_waitcnt lgkmcnt(5)
    v_mfma_f32_32x32x16_bf16 v[64:79], a[156:159], v[60:63], v[64:79]
    ds_read_b128 v[52:55], v21 offset:40960
    s_waitcnt lgkmcnt(5)
    v_mfma_f32_32x32x16_bf16 v[64:79], a[160:163], v[32:35], v[64:79]
    ds_read_b128 v[56:59], v22 offset:40960
    s_add_u32 m0, s21, 115712
    s_add_u32 s20, s23, 1536
    buffer_load_dwordx4 v7, s[8:11], s20 offen lds
    s_waitcnt lgkmcnt(5)
    v_mfma_f32_32x32x16_bf16 v[64:79], a[164:167], v[36:39], v[64:79]
    ds_read_b128 v[60:63], v23 offset:40960
    s_waitcnt lgkmcnt(5)
    v_mfma_f32_32x32x16_bf16 v[64:79], a[168:171], v[40:43], v[64:79]
    ds_read_b128 v[32:35], v16 offset:49152
    s_waitcnt lgkmcnt(5)
    v_mfma_f32_32x32x16_bf16 v[64:79], a[172:175], v[44:47], v[64:79]
    ds_read_b128 v[36:39], v17 offset:49152
    s_add_u32 m0, s21, 122880
    s_add_u32 s20, s23, 1792
    buffer_load_dwordx4 v6, s[8:11], s20 offen lds
    s_waitcnt lgkmcnt(5)
    v_mfma_f32_32x32x16_bf16 v[64:79], a[176:179], v[48:51], v[64:79]
    ds_read_b128 v[40:43], v18 offset:49152
    s_waitcnt lgkmcnt(5)
    v_mfma_f32_32x32x16_bf16 v[64:79], a[180:183], v[52:55], v[64:79]
    ds_read_b128 v[44:47], v19 offset:49152
    s_waitcnt lgkmcnt(5)
    v_mfma_f32_32x32x16_bf16 v[64:79], a[184:187], v[56:59], v[64:79]
    ds_read_b128 v[48:51], v20 offset:49152
    s_add_u32 m0, s21, 123904
    s_add_u32 s20, s23, 1792
    buffer_load_dwordx4 v7, s[8:11], s20 offen lds
    s_waitcnt lgkmcnt(5)
    v_mfma_f32_32x32x16_bf16 v[64:79], a[188:191], v[60:63], v[64:79]
    ds_read_b128 v[52:55], v21 offset:49152
    s_waitcnt lgkmcnt(5)
    v_mfma_f32_32x32x16_bf16 v[64:79], a[192:195], v[32:35], v[64:79]
    ds_read_b128 v[56:59], v22 offset:49152
    s_waitcnt lgkmcnt(5)
    v_mfma_f32_32x32x16_bf16 v[64:79], a[196:199], v[36:39], v[64:79]
    ds_read_b128 v[60:63], v23 offset:49152
    s_waitcnt lgkmcnt(5)
    v_mfma_f32_32x32x16_bf16 v[64:79], a[200:203], v[40:43], v[64:79]
    ds_read_b128 v[32:35], v16 offset:57344
    s_waitcnt lgkmcnt(5)
    v_mfma_f32_32x32x16_bf16 v[64:79], a[204:207], v[44:47], v[64:79]
    ds_read_b128 v[36:39], v17 offset:57344
    s_waitcnt lgkmcnt(5)
    v_mfma_f32_32x32x16_bf16 v[64:79], a[208:211], v[48:51], v[64:79]
    ds_read_b128 v[40:43], v18 offset:57344
    s_waitcnt lgkmcnt(5)
    v_mfma_f32_32x32x16_bf16 v[64:79], a[212:215], v[52:55], v[64:79]
    ds_read_b128 v[44:47], v19 offset:57344
    s_waitcnt lgkmcnt(5)
    v_mfma_f32_32x32x16_bf16 v[64:79], a[216:219], v[56:59], v[64:79]
    ds_read_b128 v[48:51], v20 offset:57344
    s_waitcnt lgkmcnt(5)
    v_mfma_f32_32x32x16_bf16 v[64:79], a[220:223], v[60:63], v[64:79]
    ds_read_b128 v[52:55], v21 offset:57344
    s_waitcnt vmcnt(8)
    s_barrier
    s_waitcnt lgkmcnt(5)
    v_mfma_f32_32x32x16_bf16 v[64:79], a[224:227], v[32:35], v[64:79]
    ds_read_b128 v[56:59], v22 offset:57344
    s_waitcnt lgkmcnt(5)
    v_mfma_f32_32x32x16_bf16 v[64:79], a[228:231], v[36:39], v[64:79]
    ds_read_b128 v[60:63], v23 offset:57344
    s_add_u32 s23, s23, 131072
    s_add_u32 m0, s21, 0
    s_add_u32 s20, s23, 0
    buffer_load_dwordx4 v6, s[8:11], s20 offen lds
    s_waitcnt lgkmcnt(5)
    v_mfma_f32_32x32x16_bf16 v[64:79], a[232:235], v[40:43], v[64:79]
    ds_read_b128 v[32:35], v24 offset:0
    s_cmp_eq_u32 s25, 0
    s_cbranch_scc1 mega_kernel_q_qk_nf
    v_add_u32 v10, 1, v10
    buffer_store_dword v10, v9, s[84:87], 0 offen sc1
mega_kernel_q_qk_nf:
    s_waitcnt lgkmcnt(5)
    v_mfma_f32_32x32x16_bf16 v[64:79], a[236:239], v[44:47], v[64:79]
    ds_read_b128 v[36:39], v25 offset:0
    s_waitcnt lgkmcnt(5)
    v_mfma_f32_32x32x16_bf16 v[64:79], a[240:243], v[48:51], v[64:79]
    ds_read_b128 v[40:43], v26 offset:0
    s_add_u32 m0, s21, 1024
    s_add_u32 s20, s23, 0
    buffer_load_dwordx4 v7, s[8:11], s20 offen lds
    s_waitcnt lgkmcnt(5)
    v_mfma_f32_32x32x16_bf16 v[64:79], a[244:247], v[52:55], v[64:79]
    ds_read_b128 v[44:47], v27 offset:0
    s_waitcnt lgkmcnt(5)
    v_mfma_f32_32x32x16_bf16 v[64:79], a[248:251], v[56:59], v[64:79]
    ds_read_b128 v[48:51], v28 offset:0
    s_waitcnt lgkmcnt(5)
    v_mfma_f32_32x32x16_bf16 v[64:79], a[252:255], v[60:63], v[64:79]
    ds_read_b128 v[52:55], v29 offset:0
    s_add_u32 m0, s21, 8192
    s_add_u32 s20, s23, 256
    buffer_load_dwordx4 v6, s[8:11], s20 offen lds
    s_waitcnt lgkmcnt(5)
    v_mfma_f32_32x32x16_bf16 v[80:95], a[0:3], v[32:35], 0
    ds_read_b128 v[56:59], v30 offset:0
    s_waitcnt lgkmcnt(5)
    v_mfma_f32_32x32x16_bf16 v[80:95], a[4:7], v[36:39], v[80:95]
    ds_read_b128 v[60:63], v31 offset:0
    s_waitcnt lgkmcnt(5)
    v_mfma_f32_32x32x16_bf16 v[80:95], a[8:11], v[40:43], v[80:95]
    ds_read_b128 v[32:35], v24 offset:8192
    s_add_u32 m0, s21, 9216
    s_add_u32 s20, s23, 256
    buffer_load_dwordx4 v7, s[8:11], s20 offen lds
    s_waitcnt lgkmcnt(5)
    v_mfma_f32_32x32x16_bf16 v[80:95], a[12:15], v[44:47], v[80:95]
    ds_read_b128 v[36:39], v25 offset:8192
    s_waitcnt lgkmcnt(5)
    v_mfma_f32_32x32x16_bf16 v[80:95], a[16:19], v[48:51], v[80:95]
    ds_read_b128 v[40:43], v26 offset:8192
    s_waitcnt lgkmcnt(5)
    v_mfma_f32_32x32x16_bf16 v[80:95], a[20:23], v[52:55], v[80:95]
    ds_read_b128 v[44:47], v27 offset:8192
    s_add_u32 m0, s21, 16384
    s_add_u32 s20, s23, 512
    buffer_load_dwordx4 v6, s[8:11], s20 offen lds
    s_waitcnt lgkmcnt(5)
    v_mfma_f32_32x32x16_bf16 v[80:95], a[24:27], v[56:59], v[80:95]
    ds_read_b128 v[48:51], v28 offset:8192
    s_waitcnt lgkmcnt(5)
    v_mfma_f32_32x32x16_bf16 v[80:95], a[28:31], v[60:63], v[80:95]
    ds_read_b128 v[52:55], v29 offset:8192
    s_waitcnt lgkmcnt(5)
    v_mfma_f32_32x32x16_bf16 v[80:95], a[32:35], v[32:35], v[80:95]
    ds_read_b128 v[56:59], v30 offset:8192
    s_add_u32 m0, s21, 17408
    s_add_u32 s20, s23, 512
    buffer_load_dwordx4 v7, s[8:11], s20 offen lds
    s_waitcnt lgkmcnt(5)
    v_mfma_f32_32x32x16_bf16 v[80:95], a[36:39], v[36:39], v[80:95]
    ds_read_b128 v[60:63], v31 offset:8192
    s_waitcnt lgkmcnt(5)
    v_mfma_f32_32x32x16_bf16 v[80:95], a[40:43], v[40:43], v[80:95]
    ds_read_b128 v[32:35], v24 offset:16384
    s_waitcnt lgkmcnt(5)
    v_mfma_f32_32x32x16_bf16 v[80:95], a[44:47], v[44:47], v[80:95]
    ds_read_b128 v[36:39], v25 offset:16384
    s_add_u32 m0, s21, 24576
    s_add_u32 s20, s23, 768
    buffer_load_dwordx4 v6, s[8:11], s20 offen lds
    s_waitcnt lgkmcnt(5)
    v_mfma_f32_32x32x16_bf16 v[80:95], a[48:51], v[48:51], v[80:95]
    ds_read_b128 v[40:43], v26 offset:16384
    s_waitcnt lgkmcnt(5)
    v_mfma_f32_32x32x16_bf16 v[80:95], a[52:55], v[52:55], v[80:95]
    ds_read_b128 v[44:47], v27 offset:16384
    s_waitcnt lgkmcnt(5)
    v_mfma_f32_32x32x16_bf16 v[80:95], a[56:59], v[56:59], v[80:95]
    ds_read_b128 v[48:51], v28 offset:16384
    s_add_u32 m0, s21, 25600
    s_add_u32 s20, s23, 768
    buffer_load_dwordx4 v7, s[8:11], s20 offen lds
    s_waitcnt lgkmcnt(5)
    v_mfma_f32_32x32x16_bf16 v[80:95], a[60:63], v[60:63], v[80:95]
    ds_read_b128 v[52:55], v29 offset:16384
    s_waitcnt lgkmcnt(5)
    v_mfma_f32_32x32x16_bf16 v[80:95], a[64:67], v[32:35], v[80:95]
    ds_read_b128 v[56:59], v30 offset:16384
    v_cvt_pk_bf16_f32 v96, v64, v65
    v_cvt_pk_bf16_f32 v97, v66, v67
    v_cvt_pk_bf16_f32 v98, v68, v69
    v_cvt_pk_bf16_f32 v99, v70, v71
    buffer_store_dwordx4 v[96:99], v8, s[84:87], s24 offen offset:0 sc1
    s_waitcnt lgkmcnt(5)
    v_mfma_f32_32x32x16_bf16 v[80:95], a[68:71], v[36:39], v[80:95]
    ds_read_b128 v[60:63], v31 offset:16384
    s_waitcnt lgkmcnt(5)
    v_mfma_f32_32x32x16_bf16 v[80:95], a[72:75], v[40:43], v[80:95]
    ds_read_b128 v[32:35], v24 offset:24576
    v_cvt_pk_bf16_f32 v100, v72, v73
    v_cvt_pk_bf16_f32 v101, v74, v75
    v_cvt_pk_bf16_f32 v102, v76, v77
    v_cvt_pk_bf16_f32 v103, v78, v79
    buffer_store_dwordx4 v[100:103], v8, s[84:87], s24 offen offset:512 sc1
    s_add_u32 s24, s24, 524288
    s_waitcnt lgkmcnt(5)
    v_mfma_f32_32x32x16_bf16 v[80:95], a[76:79], v[44:47], v[80:95]
    ds_read_b128 v[36:39], v25 offset:24576
    s_waitcnt lgkmcnt(5)
    v_mfma_f32_32x32x16_bf16 v[80:95], a[80:83], v[48:51], v[80:95]
    ds_read_b128 v[40:43], v26 offset:24576
    s_waitcnt lgkmcnt(5)
    v_mfma_f32_32x32x16_bf16 v[80:95], a[84:87], v[52:55], v[80:95]
    ds_read_b128 v[44:47], v27 offset:24576
    s_waitcnt lgkmcnt(5)
    v_mfma_f32_32x32x16_bf16 v[80:95], a[88:91], v[56:59], v[80:95]
    ds_read_b128 v[48:51], v28 offset:24576
    s_waitcnt lgkmcnt(5)
    v_mfma_f32_32x32x16_bf16 v[80:95], a[92:95], v[60:63], v[80:95]
    ds_read_b128 v[52:55], v29 offset:24576
    s_waitcnt vmcnt(8)
    s_barrier
    s_waitcnt lgkmcnt(5)
    v_mfma_f32_32x32x16_bf16 v[80:95], a[96:99], v[32:35], v[80:95]
    ds_read_b128 v[56:59], v30 offset:24576
    s_waitcnt lgkmcnt(5)
    v_mfma_f32_32x32x16_bf16 v[80:95], a[100:103], v[36:39], v[80:95]
    ds_read_b128 v[60:63], v31 offset:24576
    s_add_u32 m0, s21, 32768
    s_add_u32 s20, s23, 1024
    buffer_load_dwordx4 v6, s[8:11], s20 offen lds
    s_waitcnt lgkmcnt(5)
    v_mfma_f32_32x32x16_bf16 v[80:95], a[104:107], v[40:43], v[80:95]
    ds_read_b128 v[32:35], v24 offset:32768
    s_waitcnt lgkmcnt(5)
    v_mfma_f32_32x32x16_bf16 v[80:95], a[108:111], v[44:47], v[80:95]
    ds_read_b128 v[36:39], v25 offset:32768
    s_waitcnt lgkmcnt(5)
    v_mfma_f32_32x32x16_bf16 v[80:95], a[112:115], v[48:51], v[80:95]
    ds_read_b128 v[40:43], v26 offset:32768
    s_add_u32 m0, s21, 33792
    s_add_u32 s20, s23, 1024
    buffer_load_dwordx4 v7, s[8:11], s20 offen lds
    s_waitcnt lgkmcnt(5)
    v_mfma_f32_32x32x16_bf16 v[80:95], a[116:119], v[52:55], v[80:95]
    ds_read_b128 v[44:47], v27 offset:32768
    s_waitcnt lgkmcnt(5)
    v_mfma_f32_32x32x16_bf16 v[80:95], a[120:123], v[56:59], v[80:95]
    ds_read_b128 v[48:51], v28 offset:32768
    s_waitcnt lgkmcnt(5)
    v_mfma_f32_32x32x16_bf16 v[80:95], a[124:127], v[60:63], v[80:95]
    ds_read_b128 v[52:55], v29 offset:32768
    s_add_u32 m0, s21, 40960
    s_add_u32 s20, s23, 1280
    buffer_load_dwordx4 v6, s[8:11], s20 offen lds
    s_waitcnt lgkmcnt(5)
    v_mfma_f32_32x32x16_bf16 v[80:95], a[128:131], v[32:35], v[80:95]
    ds_read_b128 v[56:59], v30 offset:32768
    s_waitcnt lgkmcnt(5)
    v_mfma_f32_32x32x16_bf16 v[80:95], a[132:135], v[36:39], v[80:95]
    ds_read_b128 v[60:63], v31 offset:32768
    s_waitcnt lgkmcnt(5)
    v_mfma_f32_32x32x16_bf16 v[80:95], a[136:139], v[40:43], v[80:95]
    ds_read_b128 v[32:35], v24 offset:40960
    s_add_u32 m0, s21, 41984
    s_add_u32 s20, s23, 1280
    buffer_load_dwordx4 v7, s[8:11], s20 offen lds
    s_waitcnt lgkmcnt(5)
    v_mfma_f32_32x32x16_bf16 v[80:95], a[140:143], v[44:47], v[80:95]
    ds_read_b128 v[36:39], v25 offset:40960
    s_waitcnt lgkmcnt(5)
    v_mfma_f32_32x32x16_bf16 v[80:95], a[144:147], v[48:51], v[80:95]
    ds_read_b128 v[40:43], v26 offset:40960
    s_waitcnt lgkmcnt(5)
    v_mfma_f32_32x32x16_bf16 v[80:95], a[148:151], v[52:55], v[80:95]
    ds_read_b128 v[44:47], v27 offset:40960
    s_add_u32 m0, s21, 49152
    s_add_u32 s20, s23, 1536
    buffer_load_dwordx4 v6, s[8:11], s20 offen lds
    s_waitcnt lgkmcnt(5)
    v_mfma_f32_32x32x16_bf16 v[80:95], a[152:155], v[56:59], v[80:95]
    ds_read_b128 v[48:51], v28 offset:40960
    s_waitcnt lgkmcnt(5)
    v_mfma_f32_32x32x16_bf16 v[80:95], a[156:159], v[60:63], v[80:95]
    ds_read_b128 v[52:55], v29 offset:40960
    s_waitcnt lgkmcnt(5)
    v_mfma_f32_32x32x16_bf16 v[80:95], a[160:163], v[32:35], v[80:95]
    ds_read_b128 v[56:59], v30 offset:40960
    s_add_u32 m0, s21, 50176
    s_add_u32 s20, s23, 1536
    buffer_load_dwordx4 v7, s[8:11], s20 offen lds
    s_waitcnt lgkmcnt(5)
    v_mfma_f32_32x32x16_bf16 v[80:95], a[164:167], v[36:39], v[80:95]
    ds_read_b128 v[60:63], v31 offset:40960
    s_waitcnt lgkmcnt(5)
    v_mfma_f32_32x32x16_bf16 v[80:95], a[168:171], v[40:43], v[80:95]
    ds_read_b128 v[32:35], v24 offset:49152
    s_waitcnt lgkmcnt(5)
    v_mfma_f32_32x32x16_bf16 v[80:95], a[172:175], v[44:47], v[80:95]
    ds_read_b128 v[36:39], v25 offset:49152
    s_add_u32 m0, s21, 57344
    s_add_u32 s20, s23, 1792
    buffer_load_dwordx4 v6, s[8:11], s20 offen lds
    s_waitcnt lgkmcnt(5)
    v_mfma_f32_32x32x16_bf16 v[80:95], a[176:179], v[48:51], v[80:95]
    ds_read_b128 v[40:43], v26 offset:49152
    s_waitcnt lgkmcnt(5)
    v_mfma_f32_32x32x16_bf16 v[80:95], a[180:183], v[52:55], v[80:95]
    ds_read_b128 v[44:47], v27 offset:49152
    s_waitcnt lgkmcnt(5)
    v_mfma_f32_32x32x16_bf16 v[80:95], a[184:187], v[56:59], v[80:95]
    ds_read_b128 v[48:51], v28 offset:49152
    s_add_u32 m0, s21, 58368
    s_add_u32 s20, s23, 1792
    buffer_load_dwordx4 v7, s[8:11], s20 offen lds
    s_waitcnt lgkmcnt(5)
    v_mfma_f32_32x32x16_bf16 v[80:95], a[188:191], v[60:63], v[80:95]
    ds_read_b128 v[52:55], v29 offset:49152
    s_waitcnt lgkmcnt(5)
    v_mfma_f32_32x32x16_bf16 v[80:95], a[192:195], v[32:35], v[80:95]
    ds_read_b128 v[56:59], v30 offset:49152
    s_waitcnt lgkmcnt(5)
    v_mfma_f32_32x32x16_bf16 v[80:95], a[196:199], v[36:39], v[80:95]
    ds_read_b128 v[60:63], v31 offset:49152
    s_waitcnt lgkmcnt(5)
    v_mfma_f32_32x32x16_bf16 v[80:95], a[200:203], v[40:43], v[80:95]
    ds_read_b128 v[32:35], v24 offset:57344
    s_waitcnt lgkmcnt(5)
    v_mfma_f32_32x32x16_bf16 v[80:95], a[204:207], v[44:47], v[80:95]
    ds_read_b128 v[36:39], v25 offset:57344
    s_waitcnt lgkmcnt(5)
    v_mfma_f32_32x32x16_bf16 v[80:95], a[208:211], v[48:51], v[80:95]
    ds_read_b128 v[40:43], v26 offset:57344
    s_waitcnt lgkmcnt(5)
    v_mfma_f32_32x32x16_bf16 v[80:95], a[212:215], v[52:55], v[80:95]
    ds_read_b128 v[44:47], v27 offset:57344
    s_waitcnt lgkmcnt(5)
    v_mfma_f32_32x32x16_bf16 v[80:95], a[216:219], v[56:59], v[80:95]
    ds_read_b128 v[48:51], v28 offset:57344
    s_waitcnt lgkmcnt(5)
    v_mfma_f32_32x32x16_bf16 v[80:95], a[220:223], v[60:63], v[80:95]
    ds_read_b128 v[52:55], v29 offset:57344
    s_waitcnt vmcnt(8)
    s_barrier
    s_waitcnt lgkmcnt(5)
    v_mfma_f32_32x32x16_bf16 v[80:95], a[224:227], v[32:35], v[80:95]
    ds_read_b128 v[56:59], v30 offset:57344
    s_waitcnt lgkmcnt(5)
    v_mfma_f32_32x32x16_bf16 v[80:95], a[228:231], v[36:39], v[80:95]
    ds_read_b128 v[60:63], v31 offset:57344
    s_add_u32 s23, s23, 131072
    s_add_u32 m0, s21, 65536
    s_add_u32 s20, s23, 0
    buffer_load_dwordx4 v6, s[8:11], s20 offen lds
    s_waitcnt lgkmcnt(5)
    v_mfma_f32_32x32x16_bf16 v[80:95], a[232:235], v[40:43], v[80:95]
    ds_read_b128 v[32:35], v16 offset:0
    v_add_u32 v10, 1, v10
    buffer_store_dword v10, v9, s[84:87], 0 offen sc1
    s_waitcnt lgkmcnt(5)
    v_mfma_f32_32x32x16_bf16 v[80:95], a[236:239], v[44:47], v[80:95]
    ds_read_b128 v[36:39], v17 offset:0
    s_waitcnt lgkmcnt(5)
    v_mfma_f32_32x32x16_bf16 v[80:95], a[240:243], v[48:51], v[80:95]
    ds_read_b128 v[40:43], v18 offset:0
    s_add_u32 m0, s21, 66560
    s_add_u32 s20, s23, 0
    buffer_load_dwordx4 v7, s[8:11], s20 offen lds
    s_waitcnt lgkmcnt(5)
    v_mfma_f32_32x32x16_bf16 v[80:95], a[244:247], v[52:55], v[80:95]
    ds_read_b128 v[44:47], v19 offset:0
    s_waitcnt lgkmcnt(5)
    v_mfma_f32_32x32x16_bf16 v[80:95], a[248:251], v[56:59], v[80:95]
    ds_read_b128 v[48:51], v20 offset:0
    s_waitcnt lgkmcnt(5)
    v_mfma_f32_32x32x16_bf16 v[80:95], a[252:255], v[60:63], v[80:95]
    ds_read_b128 v[52:55], v21 offset:0
    s_add_u32 m0, s21, 73728
    s_add_u32 s20, s23, 256
    buffer_load_dwordx4 v6, s[8:11], s20 offen lds
    s_add_u32 s25, s25, 1
    s_cmp_lt_u32 s25, 16
    s_cbranch_scc1 mega_kernel_q_qk_loop
    s_nop 11
    v_cvt_pk_bf16_f32 v96, v80, v81
    v_cvt_pk_bf16_f32 v97, v82, v83
    v_cvt_pk_bf16_f32 v98, v84, v85
    v_cvt_pk_bf16_f32 v99, v86, v87
    buffer_store_dwordx4 v[96:99], v8, s[84:87], s24 offen offset:0 sc1
    v_cvt_pk_bf16_f32 v100, v88, v89
    v_cvt_pk_bf16_f32 v101, v90, v91
    v_cvt_pk_bf16_f32 v102, v92, v93
    v_cvt_pk_bf16_f32 v103, v94, v95
    buffer_store_dwordx4 v[100:103], v8, s[84:87], s24 offen offset:512 sc1
    s_add_u32 s24, s24, 524288
    s_waitcnt vmcnt(0) lgkmcnt(0)
    s_barrier
    v_add_u32 v10, 1, v10
    buffer_store_dword v10, v9, s[84:87], 0 offen sc1
    s_branch mega_kernel_q_done
mega_kernel_q_v:
    ds_read_b128 v[32:35], v16 offset:0
    ds_read_b128 v[36:39], v17 offset:0
    ds_read_b128 v[40:43], v18 offset:0
    ds_read_b128 v[44:47], v19 offset:0
    ds_read_b128 v[48:51], v20 offset:0
    ds_read_b128 v[52:55], v21 offset:0
    s_mov_b32 s25, 0
mega_kernel_q_v_loop:
    s_waitcnt lgkmcnt(5)
    v_mfma_f32_32x32x16_bf16 v[64:79], v[32:35], a[0:3], 0
    ds_read_b128 v[56:59], v22 offset:0
    s_waitcnt lgkmcnt(5)
    v_mfma_f32_32x32x16_bf16 v[64:79], v[36:39], a[4:7], v[64:79]
    ds_read_b128 v[60:63], v23 offset:0
    s_waitcnt lgkmcnt(5)
    v_mfma_f32_32x32x16_bf16 v[64:79], v[40:43], a[8:11], v[64:79]
    ds_read_b128 v[32:35], v16 offset:8192
    s_cmp_eq_u32 s25, 0
    s_cbranch_scc1 mega_kernel_q_v_sk2
    s_add_u32 m0, s21, 74752
    s_add_u32 s20, s23, 256
    buffer_load_dwordx4 v7, s[8:11], s20 offen lds
mega_kernel_q_v_sk2:
    s_waitcnt lgkmcnt(5)
    v_mfma_f32_32x32x16_bf16 v[64:79], v[44:47], a[12:15], v[64:79]
    ds_read_b128 v[36:39], v17 offset:8192
    s_waitcnt lgkmcnt(5)
    v_mfma_f32_32x32x16_bf16 v[64:79], v[48:51], a[16:19], v[64:79]
    ds_read_b128 v[40:43], v18 offset:8192
    s_waitcnt lgkmcnt(5)
    v_mfma_f32_32x32x16_bf16 v[64:79], v[52:55], a[20:23], v[64:79]
    ds_read_b128 v[44:47], v19 offset:8192
    s_cmp_eq_u32 s25, 0
    s_cbranch_scc1 mega_kernel_q_v_sk5
    s_add_u32 m0, s21, 81920
    s_add_u32 s20, s23, 512
    buffer_load_dwordx4 v6, s[8:11], s20 offen lds
mega_kernel_q_v_sk5:
    s_waitcnt lgkmcnt(5)
    v_mfma_f32_32x32x16_bf16 v[64:79], v[56:59], a[24:27], v[64:79]
    ds_read_b128 v[48:51], v20 offset:8192
    s_waitcnt lgkmcnt(5)
    v_mfma_f32_32x32x16_bf16 v[64:79], v[60:63], a[28:31], v[64:79]
    ds_read_b128 v[52:55], v21 offset:8192
    s_waitcnt lgkmcnt(5)
    v_mfma_f32_32x32x16_bf16 v[64:79], v[32:35], a[32:35], v[64:79]
    ds_read_b128 v[56:59], v22 offset:8192
    s_cmp_eq_u32 s25, 0
    s_cbranch_scc1 mega_kernel_q_v_sk8
    s_add_u32 m0, s21, 82944
    s_add_u32 s20, s23, 512
    buffer_load_dwordx4 v7, s[8:11], s20 offen lds
mega_kernel_q_v_sk8:
    s_waitcnt lgkmcnt(5)
    v_mfma_f32_32x32x16_bf16 v[64:79], v[36:39], a[36:39], v[64:79]
    ds_read_b128 v[60:63], v23 offset:8192
    s_waitcnt lgkmcnt(5)
    v_mfma_f32_32x32x16_bf16 v[64:79], v[40:43], a[40:43], v[64:79]
    ds_read_b128 v[32:35], v16 offset:16384
    s_waitcnt lgkmcnt(5)
    v_mfma_f32_32x32x16_bf16 v[64:79], v[44:47], a[44:47], v[64:79]
    ds_read_b128 v[36:39], v17 offset:16384
    s_cmp_eq_u32 s25, 0
    s_cbranch_scc1 mega_kernel_q_v_sk11
    s_add_u32 m0, s21, 90112
    s_add_u32 s20, s23, 768
    buffer_load_dwordx4 v6, s[8:11], s20 offen lds
mega_kernel_q_v_sk11:
    s_waitcnt lgkmcnt(5)
    v_mfma_f32_32x32x16_bf16 v[64:79], v[48:51], a[48:51], v[64:79]
    ds_read_b128 v[40:43], v18 offset:16384
    s_waitcnt lgkmcnt(5)
    v_mfma_f32_32x32x16_bf16 v[64:79], v[52:55], a[52:55], v[64:79]
    ds_read_b128 v[44:47], v19 offset:16384
    s_waitcnt lgkmcnt(5)
    v_mfma_f32_32x32x16_bf16 v[64:79], v[56:59], a[56:59], v[64:79]
    ds_read_b128 v[48:51], v20 offset:16384
    s_cmp_eq_u32 s25, 0
    s_cbranch_scc1 mega_kernel_q_v_sk14
    s_add_u32 m0, s21, 91136
    s_add_u32 s20, s23, 768
    buffer_load_dwordx4 v7, s[8:11], s20 offen lds
mega_kernel_q_v_sk14:
    s_waitcnt lgkmcnt(5)
    v_mfma_f32_32x32x16_bf16 v[64:79], v[60:63], a[60:63], v[64:79]
    ds_read_b128 v[52:55], v21 offset:16384
    s_waitcnt lgkmcnt(5)
    v_mfma_f32_32x32x16_bf16 v[64:79], v[32:35], a[64:67], v[64:79]
    ds_read_b128 v[56:59], v22 offset:16384
    s_cmp_eq_u32 s25, 0
    s_cbranch_scc1 mega_kernel_q_v_ne0
    v_cvt_pk_bf16_f32 v96, v80, v81
    v_cvt_pk_bf16_f32 v97, v82, v83
    v_cvt_pk_bf16_f32 v98, v88, v89
    v_cvt_pk_bf16_f32 v99, v90, v91
    buffer_store_dwordx4 v[96:99], v8, s[84:87], s24 offen offset:0 sc1
mega_kernel_q_v_ne0:
    s_waitcnt lgkmcnt(5)
    v_mfma_f32_32x32x16_bf16 v[64:79], v[36:39], a[68:71], v[64:79]
    ds_read_b128 v[60:63], v23 offset:16384
    s_waitcnt lgkmcnt(5)
    v_mfma_f32_32x32x16_bf16 v[64:79], v[40:43], a[72:75], v[64:79]
    ds_read_b128 v[32:35], v16 offset:24576
    s_cmp_eq_u32 s25, 0
    s_cbranch_scc1 mega_kernel_q_v_ne1
    v_cvt_pk_bf16_f32 v100, v84, v85
    v_cvt_pk_bf16_f32 v101, v86, v87
    v_cvt_pk_bf16_f32 v102, v92, v93
    v_cvt_pk_bf16_f32 v103, v94, v95
    buffer_store_dwordx4 v[100:103], v8, s[84:87], s24 offen offset:512 sc1
    s_add_u32 s24, s24, 524288
mega_kernel_q_v_ne1:
    s_waitcnt lgkmcnt(5)
    v_mfma_f32_32x32x16_bf16 v[64:79], v[44:47], a[76:79], v[64:79]
    ds_read_b128 v[36:39], v17 offset:24576
    s_waitcnt lgkmcnt(5)
    v_mfma_f32_32x32x16_bf16 v[64:79], v[48:51], a[80:83], v[64:79]
    ds_read_b128 v[40:43], v18 offset:24576
    s_waitcnt lgkmcnt(5)
    v_mfma_f32_32x32x16_bf16 v[64:79], v[52:55], a[84:87], v[64:79]
    ds_read_b128 v[44:47], v19 offset:24576
    s_waitcnt lgkmcnt(5)
    v_mfma_f32_32x32x16_bf16 v[64:79], v[56:59], a[88:91], v[64:79]
    ds_read_b128 v[48:51], v20 offset:24576
    s_waitcnt lgkmcnt(5)
    v_mfma_f32_32x32x16_bf16 v[64:79], v[60:63], a[92:95], v[64:79]
    ds_read_b128 v[52:55], v21 offset:24576
    s_waitcnt vmcnt(8)
    s_barrier
    s_waitcnt lgkmcnt(5)
    v_mfma_f32_32x32x16_bf16 v[64:79], v[32:35], a[96:99], v[64:79]
    ds_read_b128 v[56:59], v22 offset:24576
    s_waitcnt lgkmcnt(5)
    v_mfma_f32_32x32x16_bf16 v[64:79], v[36:39], a[100:103], v[64:79]
    ds_read_b128 v[60:63], v23 offset:24576
    s_add_u32 m0, s21, 98304
    s_add_u32 s20, s23, 1024
    buffer_load_dwordx4 v6, s[8:11], s20 offen lds
    s_waitcnt lgkmcnt(5)
    v_mfma_f32_32x32x16_bf16 v[64:79], v[40:43], a[104:107], v[64:79]
    ds_read_b128 v[32:35], v16 offset:32768
    s_waitcnt lgkmcnt(5)
    v_mfma_f32_32x32x16_bf16 v[64:79], v[44:47], a[108:111], v[64:79]
    ds_read_b128 v[36:39], v17 offset:32768
    s_waitcnt lgkmcnt(5)
    v_mfma_f32_32x32x16_bf16 v[64:79], v[48:51], a[112:115], v[64:79]
    ds_read_b128 v[40:43], v18 offset:32768
    s_add_u32 m0, s21, 99328
    s_add_u32 s20, s23, 1024
    buffer_load_dwordx4 v7, s[8:11], s20 offen lds
    s_waitcnt lgkmcnt(5)
    v_mfma_f32_32x32x16_bf16 v[64:79], v[52:55], a[116:119], v[64:79]
    ds_read_b128 v[44:47], v19 offset:32768
    s_waitcnt lgkmcnt(5)
    v_mfma_f32_32x32x16_bf16 v[64:79], v[56:59], a[120:123], v[64:79]
    ds_read_b128 v[48:51], v20 offset:32768
    s_waitcnt lgkmcnt(5)
    v_mfma_f32_32x32x16_bf16 v[64:79], v[60:63], a[124:127], v[64:79]
    ds_read_b128 v[52:55], v21 offset:32768
    s_add_u32 m0, s21, 106496
    s_add_u32 s20, s23, 1280
    buffer_load_dwordx4 v6, s[8:11], s20 offen lds
    s_waitcnt lgkmcnt(5)
    v_mfma_f32_32x32x16_bf16 v[64:79], v[32:35], a[128:131], v[64:79]
    ds_read_b128 v[56:59], v22 offset:32768
    s_waitcnt lgkmcnt(5)
    v_mfma_f32_32x32x16_bf16 v[64:79], v[36:39], a[132:135], v[64:79]
    ds_read_b128 v[60:63], v23 offset:32768
    s_waitcnt lgkmcnt(5)
    v_mfma_f32_32x32x16_bf16 v[64:79], v[40:43], a[136:139], v[64:79]
    ds_read_b128 v[32:35], v16 offset:40960
    s_add_u32 m0, s21, 107520
    s_add_u32 s20, s23, 1280
    buffer_load_dwordx4 v7, s[8:11], s20 offen lds
    s_waitcnt lgkmcnt(5)
    v_mfma_f32_32x32x16_bf16 v[64:79], v[44:47], a[140:143], v[64:79]
    ds_read_b128 v[36:39], v17 offset:40960
    s_waitcnt lgkmcnt(5)
    v_mfma_f32_32x32x16_bf16 v[64:79], v[48:51], a[144:147], v[64:79]
    ds_read_b128 v[40:43], v18 offset:40960
    s_waitcnt lgkmcnt(5)
    v_mfma_f32_32x32x16_bf16 v[64:79], v[52:55], a[148:151], v[64:79]
    ds_read_b128 v[44:47], v19 offset:40960
    s_add_u32 m0, s21, 114688
    s_add_u32 s20, s23, 1536
    buffer_load_dwordx4 v6, s[8:11], s20 offen lds
    s_waitcnt lgkmcnt(5)
    v_mfma_f32_32x32x16_bf16 v[64:79], v[56:59], a[152:155], v[64:79]
    ds_read_b128 v[48:51], v20 offset:40960
    s_waitcnt lgkmcnt(5)
    v_mfma_f32_32x32x16_bf16 v[64:79], v[60:63], a[156:159], v[64:79]
    ds_read_b128 v[52:55], v21 offset:40960
    s_waitcnt lgkmcnt(5)
    v_mfma_f32_32x32x16_bf16 v[64:79], v[32:35], a[160:163], v[64:79]
    ds_read_b128 v[56:59], v22 offset:40960
    s_add_u32 m0, s21, 115712
    s_add_u32 s20, s23, 1536
    buffer_load_dwordx4 v7, s[8:11], s20 offen lds
    s_waitcnt lgkmcnt(5)
    v_mfma_f32_32x32x16_bf16 v[64:79], v[36:39], a[164:167], v[64:79]
    ds_read_b128 v[60:63], v23 offset:40960
    s_waitcnt lgkmcnt(5)
    v_mfma_f32_32x32x16_bf16 v[64:79], v[40:43], a[168:171], v[64:79]
    ds_read_b128 v[32:35], v16 offset:49152
    s_waitcnt lgkmcnt(5)
    v_mfma_f32_32x32x16_bf16 v[64:79], v[44:47], a[172:175], v[64:79]
    ds_read_b128 v[36:39], v17 offset:49152
    s_add_u32 m0, s21, 122880
    s_add_u32 s20, s23, 1792
    buffer_load_dwordx4 v6, s[8:11], s20 offen lds
    s_waitcnt lgkmcnt(5)
    v_mfma_f32_32x32x16_bf16 v[64:79], v[48:51], a[176:179], v[64:79]
    ds_read_b128 v[40:43], v18 offset:49152
    s_waitcnt lgkmcnt(5)
    v_mfma_f32_32x32x16_bf16 v[64:79], v[52:55], a[180:183], v[64:79]
    ds_read_b128 v[44:47], v19 offset:49152
    s_waitcnt lgkmcnt(5)
    v_mfma_f32_32x32x16_bf16 v[64:79], v[56:59], a[184:187], v[64:79]
    ds_read_b128 v[48:51], v20 offset:49152
    s_add_u32 m0, s21, 123904
    s_add_u32 s20, s23, 1792
    buffer_load_dwordx4 v7, s[8:11], s20 offen lds
    s_waitcnt lgkmcnt(5)
    v_mfma_f32_32x32x16_bf16 v[64:79], v[60:63], a[188:191], v[64:79]
    ds_read_b128 v[52:55], v21 offset:49152
    s_waitcnt lgkmcnt(5)
    v_mfma_f32_32x32x16_bf16 v[64:79], v[32:35], a[192:195], v[64:79]
    ds_read_b128 v[56:59], v22 offset:49152
    s_waitcnt lgkmcnt(5)
    v_mfma_f32_32x32x16_bf16 v[64:79], v[36:39], a[196:199], v[64:79]
    ds_read_b128 v[60:63], v23 offset:49152
    s_waitcnt lgkmcnt(5)
    v_mfma_f32_32x32x16_bf16 v[64:79], v[40:43], a[200:203], v[64:79]
    ds_read_b128 v[32:35], v16 offset:57344
    s_waitcnt lgkmcnt(5)
    v_mfma_f32_32x32x16_bf16 v[64:79], v[44:47], a[204:207], v[64:79]
    ds_read_b128 v[36:39], v17 offset:57344
    s_waitcnt lgkmcnt(5)
    v_mfma_f32_32x32x16_bf16 v[64:79], v[48:51], a[208:211], v[64:79]
    ds_read_b128 v[40:43], v18 offset:57344
    s_waitcnt lgkmcnt(5)
    v_mfma_f32_32x32x16_bf16 v[64:79], v[52:55], a[212:215], v[64:79]
    ds_read_b128 v[44:47], v19 offset:57344
    s_waitcnt lgkmcnt(5)
    v_mfma_f32_32x32x16_bf16 v[64:79], v[56:59], a[216:219], v[64:79]
    ds_read_b128 v[48:51], v20 offset:57344
    s_waitcnt lgkmcnt(5)
    v_mfma_f32_32x32x16_bf16 v[64:79], v[60:63], a[220:223], v[64:79]
    ds_read_b128 v[52:55], v21 offset:57344
    s_waitcnt vmcnt(8)
    s_barrier
    s_waitcnt lgkmcnt(5)
    v_mfma_f32_32x32x16_bf16 v[64:79], v[32:35], a[224:227], v[64:79]
    ds_read_b128 v[56:59], v22 offset:57344
    s_waitcnt lgkmcnt(5)
    v_mfma_f32_32x32x16_bf16 v[64:79], v[36:39], a[228:231], v[64:79]
    ds_read_b128 v[60:63], v23 offset:57344
    s_add_u32 s23, s23, 131072
    s_add_u32 m0, s21, 0
    s_add_u32 s20, s23, 0
    buffer_load_dwordx4 v6, s[8:11], s20 offen lds
    s_waitcnt lgkmcnt(5)
    v_mfma_f32_32x32x16_bf16 v[64:79], v[40:43], a[232:235], v[64:79]
    ds_read_b128 v[32:35], v24 offset:0
    s_cmp_eq_u32 s25, 0
    s_cbranch_scc1 mega_kernel_q_v_nf
    v_add_u32 v10, 1, v10
    buffer_store_dword v10, v9, s[84:87], 0 offen sc1
mega_kernel_q_v_nf:
    s_waitcnt lgkmcnt(5)
    v_mfma_f32_32x32x16_bf16 v[64:79], v[44:47], a[236:239], v[64:79]
    ds_read_b128 v[36:39], v25 offset:0
    s_waitcnt lgkmcnt(5)
    v_mfma_f32_32x32x16_bf16 v[64:79], v[48:51], a[240:243], v[64:79]
    ds_read_b128 v[40:43], v26 offset:0
    s_add_u32 m0, s21, 1024
    s_add_u32 s20, s23, 0
    buffer_load_dwordx4 v7, s[8:11], s20 offen lds
    s_waitcnt lgkmcnt(5)
    v_mfma_f32_32x32x16_bf16 v[64:79], v[52:55], a[244:247], v[64:79]
    ds_read_b128 v[44:47], v27 offset:0
    s_waitcnt lgkmcnt(5)
    v_mfma_f32_32x32x16_bf16 v[64:79], v[56:59], a[248:251], v[64:79]
    ds_read_b128 v[48:51], v28 offset:0
    s_waitcnt lgkmcnt(5)
    v_mfma_f32_32x32x16_bf16 v[64:79], v[60:63], a[252:255], v[64:79]
    ds_read_b128 v[52:55], v29 offset:0
    s_add_u32 m0, s21, 8192
    s_add_u32 s20, s23, 256
    buffer_load_dwordx4 v6, s[8:11], s20 offen lds
    s_waitcnt lgkmcnt(5)
    v_mfma_f32_32x32x16_bf16 v[80:95], v[32:35], a[0:3], 0
    ds_read_b128 v[56:59], v30 offset:0
    s_waitcnt lgkmcnt(5)
    v_mfma_f32_32x32x16_bf16 v[80:95], v[36:39], a[4:7], v[80:95]
    ds_read_b128 v[60:63], v31 offset:0
    s_waitcnt lgkmcnt(5)
    v_mfma_f32_32x32x16_bf16 v[80:95], v[40:43], a[8:11], v[80:95]
    ds_read_b128 v[32:35], v24 offset:8192
    s_add_u32 m0, s21, 9216
    s_add_u32 s20, s23, 256
    buffer_load_dwordx4 v7, s[8:11], s20 offen lds
    s_waitcnt lgkmcnt(5)
    v_mfma_f32_32x32x16_bf16 v[80:95], v[44:47], a[12:15], v[80:95]
    ds_read_b128 v[36:39], v25 offset:8192
    s_waitcnt lgkmcnt(5)
    v_mfma_f32_32x32x16_bf16 v[80:95], v[48:51], a[16:19], v[80:95]
    ds_read_b128 v[40:43], v26 offset:8192
    s_waitcnt lgkmcnt(5)
    v_mfma_f32_32x32x16_bf16 v[80:95], v[52:55], a[20:23], v[80:95]
    ds_read_b128 v[44:47], v27 offset:8192
    s_add_u32 m0, s21, 16384
    s_add_u32 s20, s23, 512
    buffer_load_dwordx4 v6, s[8:11], s20 offen lds
    s_waitcnt lgkmcnt(5)
    v_mfma_f32_32x32x16_bf16 v[80:95], v[56:59], a[24:27], v[80:95]
    ds_read_b128 v[48:51], v28 offset:8192
    s_waitcnt lgkmcnt(5)
    v_mfma_f32_32x32x16_bf16 v[80:95], v[60:63], a[28:31], v[80:95]
    ds_read_b128 v[52:55], v29 offset:8192
    s_waitcnt lgkmcnt(5)
    v_mfma_f32_32x32x16_bf16 v[80:95], v[32:35], a[32:35], v[80:95]
    ds_read_b128 v[56:59], v30 offset:8192
    s_add_u32 m0, s21, 17408
    s_add_u32 s20, s23, 512
    buffer_load_dwordx4 v7, s[8:11], s20 offen lds
    s_waitcnt lgkmcnt(5)
    v_mfma_f32_32x32x16_bf16 v[80:95], v[36:39], a[36:39], v[80:95]
    ds_read_b128 v[60:63], v31 offset:8192
    s_waitcnt lgkmcnt(5)
    v_mfma_f32_32x32x16_bf16 v[80:95], v[40:43], a[40:43], v[80:95]
    ds_read_b128 v[32:35], v24 offset:16384
    s_waitcnt lgkmcnt(5)
    v_mfma_f32_32x32x16_bf16 v[80:95], v[44:47], a[44:47], v[80:95]
    ds_read_b128 v[36:39], v25 offset:16384
    s_add_u32 m0, s21, 24576
    s_add_u32 s20, s23, 768
    buffer_load_dwordx4 v6, s[8:11], s20 offen lds
    s_waitcnt lgkmcnt(5)
    v_mfma_f32_32x32x16_bf16 v[80:95], v[48:51], a[48:51], v[80:95]
    ds_read_b128 v[40:43], v26 offset:16384
    s_waitcnt lgkmcnt(5)
    v_mfma_f32_32x32x16_bf16 v[80:95], v[52:55], a[52:55], v[80:95]
    ds_read_b128 v[44:47], v27 offset:16384
    s_waitcnt lgkmcnt(5)
    v_mfma_f32_32x32x16_bf16 v[80:95], v[56:59], a[56:59], v[80:95]
    ds_read_b128 v[48:51], v28 offset:16384
    s_add_u32 m0, s21, 25600
    s_add_u32 s20, s23, 768
    buffer_load_dwordx4 v7, s[8:11], s20 offen lds
    s_waitcnt lgkmcnt(5)
    v_mfma_f32_32x32x16_bf16 v[80:95], v[60:63], a[60:63], v[80:95]
    ds_read_b128 v[52:55], v29 offset:16384
    s_waitcnt lgkmcnt(5)
    v_mfma_f32_32x32x16_bf16 v[80:95], v[32:35], a[64:67], v[80:95]
    ds_read_b128 v[56:59], v30 offset:16384
    v_cvt_pk_bf16_f32 v96, v64, v65
    v_cvt_pk_bf16_f32 v97, v66, v67
    v_cvt_pk_bf16_f32 v98, v72, v73
    v_cvt_pk_bf16_f32 v99, v74, v75
    buffer_store_dwordx4 v[96:99], v8, s[84:87], s24 offen offset:0 sc1
    s_waitcnt lgkmcnt(5)
    v_mfma_f32_32x32x16_bf16 v[80:95], v[36:39], a[68:71], v[80:95]
    ds_read_b128 v[60:63], v31 offset:16384
    s_waitcnt lgkmcnt(5)
    v_mfma_f32_32x32x16_bf16 v[80:95], v[40:43], a[72:75], v[80:95]
    ds_read_b128 v[32:35], v24 offset:24576
    v_cvt_pk_bf16_f32 v100, v68, v69
    v_cvt_pk_bf16_f32 v101, v70, v71
    v_cvt_pk_bf16_f32 v102, v76, v77
    v_cvt_pk_bf16_f32 v103, v78, v79
    buffer_store_dwordx4 v[100:103], v8, s[84:87], s24 offen offset:512 sc1
    s_add_u32 s24, s24, 524288
    s_waitcnt lgkmcnt(5)
    v_mfma_f32_32x32x16_bf16 v[80:95], v[44:47], a[76:79], v[80:95]
    ds_read_b128 v[36:39], v25 offset:24576
    s_waitcnt lgkmcnt(5)
    v_mfma_f32_32x32x16_bf16 v[80:95], v[48:51], a[80:83], v[80:95]
    ds_read_b128 v[40:43], v26 offset:24576
    s_waitcnt lgkmcnt(5)
    v_mfma_f32_32x32x16_bf16 v[80:95], v[52:55], a[84:87], v[80:95]
    ds_read_b128 v[44:47], v27 offset:24576
    s_waitcnt lgkmcnt(5)
    v_mfma_f32_32x32x16_bf16 v[80:95], v[56:59], a[88:91], v[80:95]
    ds_read_b128 v[48:51], v28 offset:24576
    s_waitcnt lgkmcnt(5)
    v_mfma_f32_32x32x16_bf16 v[80:95], v[60:63], a[92:95], v[80:95]
    ds_read_b128 v[52:55], v29 offset:24576
    s_waitcnt vmcnt(8)
    s_barrier
    s_waitcnt lgkmcnt(5)
    v_mfma_f32_32x32x16_bf16 v[80:95], v[32:35], a[96:99], v[80:95]
    ds_read_b128 v[56:59], v30 offset:24576
    s_waitcnt lgkmcnt(5)
    v_mfma_f32_32x32x16_bf16 v[80:95], v[36:39], a[100:103], v[80:95]
    ds_read_b128 v[60:63], v31 offset:24576
    s_add_u32 m0, s21, 32768
    s_add_u32 s20, s23, 1024
    buffer_load_dwordx4 v6, s[8:11], s20 offen lds
    s_waitcnt lgkmcnt(5)
    v_mfma_f32_32x32x16_bf16 v[80:95], v[40:43], a[104:107], v[80:95]
    ds_read_b128 v[32:35], v24 offset:32768
    s_waitcnt lgkmcnt(5)
    v_mfma_f32_32x32x16_bf16 v[80:95], v[44:47], a[108:111], v[80:95]
    ds_read_b128 v[36:39], v25 offset:32768
    s_waitcnt lgkmcnt(5)
    v_mfma_f32_32x32x16_bf16 v[80:95], v[48:51], a[112:115], v[80:95]
    ds_read_b128 v[40:43], v26 offset:32768
    s_add_u32 m0, s21, 33792
    s_add_u32 s20, s23, 1024
    buffer_load_dwordx4 v7, s[8:11], s20 offen lds
    s_waitcnt lgkmcnt(5)
    v_mfma_f32_32x32x16_bf16 v[80:95], v[52:55], a[116:119], v[80:95]
    ds_read_b128 v[44:47], v27 offset:32768
    s_waitcnt lgkmcnt(5)
    v_mfma_f32_32x32x16_bf16 v[80:95], v[56:59], a[120:123], v[80:95]
    ds_read_b128 v[48:51], v28 offset:32768
    s_waitcnt lgkmcnt(5)
    v_mfma_f32_32x32x16_bf16 v[80:95], v[60:63], a[124:127], v[80:95]
    ds_read_b128 v[52:55], v29 offset:32768
    s_add_u32 m0, s21, 40960
    s_add_u32 s20, s23, 1280
    buffer_load_dwordx4 v6, s[8:11], s20 offen lds
    s_waitcnt lgkmcnt(5)
    v_mfma_f32_32x32x16_bf16 v[80:95], v[32:35], a[128:131], v[80:95]
    ds_read_b128 v[56:59], v30 offset:32768
    s_waitcnt lgkmcnt(5)
    v_mfma_f32_32x32x16_bf16 v[80:95], v[36:39], a[132:135], v[80:95]
    ds_read_b128 v[60:63], v31 offset:32768
    s_waitcnt lgkmcnt(5)
    v_mfma_f32_32x32x16_bf16 v[80:95], v[40:43], a[136:139], v[80:95]
    ds_read_b128 v[32:35], v24 offset:40960
    s_add_u32 m0, s21, 41984
    s_add_u32 s20, s23, 1280
    buffer_load_dwordx4 v7, s[8:11], s20 offen lds
    s_waitcnt lgkmcnt(5)
    v_mfma_f32_32x32x16_bf16 v[80:95], v[44:47], a[140:143], v[80:95]
    ds_read_b128 v[36:39], v25 offset:40960
    s_waitcnt lgkmcnt(5)
    v_mfma_f32_32x32x16_bf16 v[80:95], v[48:51], a[144:147], v[80:95]
    ds_read_b128 v[40:43], v26 offset:40960
    s_waitcnt lgkmcnt(5)
    v_mfma_f32_32x32x16_bf16 v[80:95], v[52:55], a[148:151], v[80:95]
    ds_read_b128 v[44:47], v27 offset:40960
    s_add_u32 m0, s21, 49152
    s_add_u32 s20, s23, 1536
    buffer_load_dwordx4 v6, s[8:11], s20 offen lds
    s_waitcnt lgkmcnt(5)
    v_mfma_f32_32x32x16_bf16 v[80:95], v[56:59], a[152:155], v[80:95]
    ds_read_b128 v[48:51], v28 offset:40960
    s_waitcnt lgkmcnt(5)
    v_mfma_f32_32x32x16_bf16 v[80:95], v[60:63], a[156:159], v[80:95]
    ds_read_b128 v[52:55], v29 offset:40960
    s_waitcnt lgkmcnt(5)
    v_mfma_f32_32x32x16_bf16 v[80:95], v[32:35], a[160:163], v[80:95]
    ds_read_b128 v[56:59], v30 offset:40960
    s_add_u32 m0, s21, 50176
    s_add_u32 s20, s23, 1536
    buffer_load_dwordx4 v7, s[8:11], s20 offen lds
    s_waitcnt lgkmcnt(5)
    v_mfma_f32_32x32x16_bf16 v[80:95], v[36:39], a[164:167], v[80:95]
    ds_read_b128 v[60:63], v31 offset:40960
    s_waitcnt lgkmcnt(5)
    v_mfma_f32_32x32x16_bf16 v[80:95], v[40:43], a[168:171], v[80:95]
    ds_read_b128 v[32:35], v24 offset:49152
    s_waitcnt lgkmcnt(5)
    v_mfma_f32_32x32x16_bf16 v[80:95], v[44:47], a[172:175], v[80:95]
    ds_read_b128 v[36:39], v25 offset:49152
    s_add_u32 m0, s21, 57344
    s_add_u32 s20, s23, 1792
    buffer_load_dwordx4 v6, s[8:11], s20 offen lds
    s_waitcnt lgkmcnt(5)
    v_mfma_f32_32x32x16_bf16 v[80:95], v[48:51], a[176:179], v[80:95]
    ds_read_b128 v[40:43], v26 offset:49152
    s_waitcnt lgkmcnt(5)
    v_mfma_f32_32x32x16_bf16 v[80:95], v[52:55], a[180:183], v[80:95]
    ds_read_b128 v[44:47], v27 offset:49152
    s_waitcnt lgkmcnt(5)
    v_mfma_f32_32x32x16_bf16 v[80:95], v[56:59], a[184:187], v[80:95]
    ds_read_b128 v[48:51], v28 offset:49152
    s_add_u32 m0, s21, 58368
    s_add_u32 s20, s23, 1792
    buffer_load_dwordx4 v7, s[8:11], s20 offen lds
    s_waitcnt lgkmcnt(5)
    v_mfma_f32_32x32x16_bf16 v[80:95], v[60:63], a[188:191], v[80:95]
    ds_read_b128 v[52:55], v29 offset:49152
    s_waitcnt lgkmcnt(5)
    v_mfma_f32_32x32x16_bf16 v[80:95], v[32:35], a[192:195], v[80:95]
    ds_read_b128 v[56:59], v30 offset:49152
    s_waitcnt lgkmcnt(5)
    v_mfma_f32_32x32x16_bf16 v[80:95], v[36:39], a[196:199], v[80:95]
    ds_read_b128 v[60:63], v31 offset:49152
    s_waitcnt lgkmcnt(5)
    v_mfma_f32_32x32x16_bf16 v[80:95], v[40:43], a[200:203], v[80:95]
    ds_read_b128 v[32:35], v24 offset:57344
    s_waitcnt lgkmcnt(5)
    v_mfma_f32_32x32x16_bf16 v[80:95], v[44:47], a[204:207], v[80:95]
    ds_read_b128 v[36:39], v25 offset:57344
    s_waitcnt lgkmcnt(5)
    v_mfma_f32_32x32x16_bf16 v[80:95], v[48:51], a[208:211], v[80:95]
    ds_read_b128 v[40:43], v26 offset:57344
    s_waitcnt lgkmcnt(5)
    v_mfma_f32_32x32x16_bf16 v[80:95], v[52:55], a[212:215], v[80:95]
    ds_read_b128 v[44:47], v27 offset:57344
    s_waitcnt lgkmcnt(5)
    v_mfma_f32_32x32x16_bf16 v[80:95], v[56:59], a[216:219], v[80:95]
    ds_read_b128 v[48:51], v28 offset:57344
    s_waitcnt lgkmcnt(5)
    v_mfma_f32_32x32x16_bf16 v[80:95], v[60:63], a[220:223], v[80:95]
    ds_read_b128 v[52:55], v29 offset:57344
    s_waitcnt vmcnt(8)
    s_barrier
    s_waitcnt lgkmcnt(5)
    v_mfma_f32_32x32x16_bf16 v[80:95], v[32:35], a[224:227], v[80:95]
    ds_read_b128 v[56:59], v30 offset:57344
    s_waitcnt lgkmcnt(5)
    v_mfma_f32_32x32x16_bf16 v[80:95], v[36:39], a[228:231], v[80:95]
    ds_read_b128 v[60:63], v31 offset:57344
    s_add_u32 s23, s23, 131072
    s_add_u32 m0, s21, 65536
    s_add_u32 s20, s23, 0
    buffer_load_dwordx4 v6, s[8:11], s20 offen lds
    s_waitcnt lgkmcnt(5)
    v_mfma_f32_32x32x16_bf16 v[80:95], v[40:43], a[232:235], v[80:95]
    ds_read_b128 v[32:35], v16 offset:0
    v_add_u32 v10, 1, v10
    buffer_store_dword v10, v9, s[84:87], 0 offen sc1
    s_waitcnt lgkmcnt(5)
    v_mfma_f32_32x32x16_bf16 v[80:95], v[44:47], a[236:239], v[80:95]
    ds_read_b128 v[36:39], v17 offset:0
    s_waitcnt lgkmcnt(5)
    v_mfma_f32_32x32x16_bf16 v[80:95], v[48:51], a[240:243], v[80:95]
    ds_read_b128 v[40:43], v18 offset:0
    s_add_u32 m0, s21, 66560
    s_add_u32 s20, s23, 0
    buffer_load_dwordx4 v7, s[8:11], s20 offen lds
    s_waitcnt lgkmcnt(5)
    v_mfma_f32_32x32x16_bf16 v[80:95], v[52:55], a[244:247], v[80:95]
    ds_read_b128 v[44:47], v19 offset:0
    s_waitcnt lgkmcnt(5)
    v_mfma_f32_32x32x16_bf16 v[80:95], v[56:59], a[248:251], v[80:95]
    ds_read_b128 v[48:51], v20 offset:0
    s_waitcnt lgkmcnt(5)
    v_mfma_f32_32x32x16_bf16 v[80:95], v[60:63], a[252:255], v[80:95]
    ds_read_b128 v[52:55], v21 offset:0
    s_add_u32 m0, s21, 73728
    s_add_u32 s20, s23, 256
    buffer_load_dwordx4 v6, s[8:11], s20 offen lds
    s_add_u32 s25, s25, 1
    s_cmp_lt_u32 s25, 16
    s_cbranch_scc1 mega_kernel_q_v_loop
    s_nop 11
    v_cvt_pk_bf16_f32 v96, v80, v81
    v_cvt_pk_bf16_f32 v97, v82, v83
    v_cvt_pk_bf16_f32 v98, v88, v89
    v_cvt_pk_bf16_f32 v99, v90, v91
    buffer_store_dwordx4 v[96:99], v8, s[84:87], s24 offen offset:0 sc1
    v_cvt_pk_bf16_f32 v100, v84, v85
    v_cvt_pk_bf16_f32 v101, v86, v87
    v_cvt_pk_bf16_f32 v102, v92, v93
    v_cvt_pk_bf16_f32 v103, v94, v95
    buffer_store_dwordx4 v[100:103], v8, s[84:87], s24 offen offset:512 sc1
    s_add_u32 s24, s24, 524288
    s_waitcnt vmcnt(0) lgkmcnt(0)
    s_barrier
    v_add_u32 v10, 1, v10
    buffer_store_dword v10, v9, s[84:87], 0 offen sc1
mega_kernel_q_done:
    s_cmp_lt_u32 s92, 128
    s_cbranch_scc1 mega_kernel_f1
    s_sub_u32 s99, s92, 128
mega_kernel_f0l:
    s_barrier
    s_load_dwordx2 s[4:5], s[0:1], 64
    s_load_dwordx2 s[8:9], s[0:1], 72
    s_load_dwordx2 s[12:13], s[0:1], 96
    s_and_b32 s16, s99, 31
    s_lshr_b32 s17, s99, 5
    v_and_b32 v1, 63, v0
    v_lshrrev_b32 v2, 6, v0
    s_waitcnt lgkmcnt(0)
    s_mov_b32 s6, 2101248
    s_mov_b32 s7, 0x00020000
    s_mov_b32 s10, 2101248
    s_mov_b32 s11, 0x00020000
    s_add_u32 s12, s12, 121634816
    s_addc_u32 s13, s13, 0
    s_mov_b32 s14, 4202496
    s_mov_b32 s15, 0x00020000
    s_lshl_b32 s18, s16, 6
    v_add_u32 v3, s18, v2
    s_movk_i32 s19, 1026
    v_mul_lo_u32 v3, v3, s19
    s_lshl_b32 s18, s17, 7
    v_add_u32 v3, s18, v3
    v_lshl_add_u32 v3, v1, 1, v3
    s_mov_b32 s18, 0
    buffer_load_ushort v16, v3, s[4:7], s18 offen
    buffer_load_ushort v32, v3, s[8:11], s18 offen
    s_mov_b32 s18, 4104
    buffer_load_ushort v17, v3, s[4:7], s18 offen
    buffer_load_ushort v33, v3, s[8:11], s18 offen
    s_mov_b32 s18, 8208
    buffer_load_ushort v18, v3, s[4:7], s18 offen
    buffer_load_ushort v34, v3, s[8:11], s18 offen
    s_mov_b32 s18, 12312
    buffer_load_ushort v19, v3, s[4:7], s18 offen
    buffer_load_ushort v35, v3, s[8:11], s18 offen
    s_mov_b32 s18, 16416
    buffer_load_ushort v20, v3, s[4:7], s18 offen
    buffer_load_ushort v36, v3, s[8:11], s18 offen
    s_mov_b32 s18, 20520
    buffer_load_ushort v21, v3, s[4:7], s18 offen
    buffer_load_ushort v37, v3, s[8:11], s18 offen
    s_mov_b32 s18, 24624
    buffer_load_ushort v22, v3, s[4:7], s18 offen
    buffer_load_ushort v38, v3, s[8:11], s18 offen
    s_mov_b32 s18, 28728
    buffer_load_ushort v23, v3, s[4:7], s18 offen
    buffer_load_ushort v39, v3, s[8:11], s18 offen
    s_mov_b32 s18, 32832
    buffer_load_ushort v24, v3, s[4:7], s18 offen
    buffer_load_ushort v40, v3, s[8:11], s18 offen
    s_mov_b32 s18, 36936
    buffer_load_ushort v25, v3, s[4:7], s18 offen
    buffer_load_ushort v41, v3, s[8:11], s18 offen
    s_mov_b32 s18, 41040
    buffer_load_ushort v26, v3, s[4:7], s18 offen
    buffer_load_ushort v42, v3, s[8:11], s18 offen
    s_mov_b32 s18, 45144
    buffer_load_ushort v27, v3, s[4:7], s18 offen
    buffer_load_ushort v43, v3, s[8:11], s18 offen
    s_mov_b32 s18, 49248
    buffer_load_ushort v28, v3, s[4:7], s18 offen
    buffer_load_ushort v44, v3, s[8:11], s18 offen
    s_mov_b32 s18, 53352
    buffer_load_ushort v29, v3, s[4:7], s18 offen
    buffer_load_ushort v45, v3, s[8:11], s18 offen
    s_mov_b32 s18, 57456
    buffer_load_ushort v30, v3, s[4:7], s18 offen
    buffer_load_ushort v46, v3, s[8:11], s18 offen
    s_mov_b32 s18, 61560
    buffer_load_ushort v31, v3, s[4:7], s18 offen
    buffer_load_ushort v47, v3, s[8:11], s18 offen
    v_mul_u32_u24 v4, 65, v1
    v_add_u32 v4, v4, v2
    v_lshlrev_b32 v4, 2, v4
    s_waitcnt vmcnt(0)
    v_lshl_or_b32 v16, v32, 16, v16
    ds_write_b32 v4, v16 offset:0
    v_lshl_or_b32 v17, v33, 16, v17
    ds_write_b32 v4, v17 offset:16
    v_lshl_or_b32 v18, v34, 16, v18
    ds_write_b32 v4, v18 offset:32
    v_lshl_or_b32 v19, v35, 16, v19
    ds_write_b32 v4, v19 offset:48
    v_lshl_or_b32 v20, v36, 16, v20
    ds_write_b32 v4, v20 offset:64
    v_lshl_or_b32 v21, v37, 16, v21
    ds_write_b32 v4, v21 offset:80
    v_lshl_or_b32 v22, v38, 16, v22
    ds_write_b32 v4, v22 offset:96
    v_lshl_or_b32 v23, v39, 16, v23
    ds_write_b32 v4, v23 offset:112
    v_lshl_or_b32 v24, v40, 16, v24
    ds_write_b32 v4, v24 offset:128
    v_lshl_or_b32 v25, v41, 16, v25
    ds_write_b32 v4, v25 offset:144
    v_lshl_or_b32 v26, v42, 16, v26
    ds_write_b32 v4, v26 offset:160
    v_lshl_or_b32 v27, v43, 16, v27
    ds_write_b32 v4, v27 offset:176
    v_lshl_or_b32 v28, v44, 16, v28
    ds_write_b32 v4, v28 offset:192
    v_lshl_or_b32 v29, v45, 16, v29
    ds_write_b32 v4, v29 offset:208
    v_lshl_or_b32 v30, v46, 16, v30
    ds_write_b32 v4, v30 offset:224
    v_lshl_or_b32 v31, v47, 16, v31
    ds_write_b32 v4, v31 offset:240
    v_lshrrev_b32 v7, 4, v0
    v_and_b32 v8, 15, v0
    v_mul_u32_u24 v5, 65, v7
    v_lshl_add_u32 v5, v8, 2, v5
    v_lshlrev_b32 v5, 2, v5
    s_waitcnt lgkmcnt(0)
    s_barrier
    ds_read_b32 v16, v5 offset:0
    ds_read_b32 v17, v5 offset:4
    ds_read_b32 v18, v5 offset:8
    ds_read_b32 v19, v5 offset:12
    ds_read_b32 v20, v5 offset:4160
    ds_read_b32 v21, v5 offset:4164
    ds_read_b32 v22, v5 offset:4168
    ds_read_b32 v23, v5 offset:4172
    ds_read_b32 v24, v5 offset:8320
    ds_read_b32 v25, v5 offset:8324
    ds_read_b32 v26, v5 offset:8328
    ds_read_b32 v27, v5 offset:8332
    ds_read_b32 v28, v5 offset:12480
    ds_read_b32 v29, v5 offset:12484
    ds_read_b32 v30, v5 offset:12488
    ds_read_b32 v31, v5 offset:12492
    s_lshl_b32 s18, s17, 6
    v_add_u32 v6, s18, v7
    v_lshlrev_b32 v6, 13, v6
    s_lshl_b32 s18, s16, 8
    v_add_u32 v6, s18, v6
    v_lshl_add_u32 v6, v8, 4, v6
    s_waitcnt lgkmcnt(0)
    s_mov_b32 s18, 0
    buffer_store_dwordx4 v[16:19], v6, s[12:15], s18 offen sc1
    s_mov_b32 s18, 131072
    buffer_store_dwordx4 v[20:23], v6, s[12:15], s18 offen sc1
    s_mov_b32 s18, 262144
    buffer_store_dwordx4 v[24:27], v6, s[12:15], s18 offen sc1
    s_mov_b32 s18, 393216
    buffer_store_dwordx4 v[28:31], v6, s[12:15], s18 offen sc1
    s_add_u32 s99, s99, 64
    s_cmp_lt_u32 s99, 288
    s_cbranch_scc1 mega_kernel_f0l
    s_branch mega_kernel_f1d
mega_kernel_f1:
    s_barrier
    s_load_dwordx2 s[4:5], s[0:1], 56
    s_load_dwordx2 s[8:9], s[0:1], 96
    v_and_b32 v1, 31, v0
    v_lshrrev_b32 v2, 5, v0
    v_cvt_f32_u32 v3, v1
    s_waitcnt lgkmcnt(0)
    s_mov_b32 s6, 4194304
    s_mov_b32 s7, 0x00020000
    s_mov_b32 s10, 268435456
    s_mov_b32 s11, 0x00020000
    s_lshl_b32 s12, s92, 15
    v_lshlrev_b32 v6, 12, v2
    v_lshl_add_u32 v6, v1, 1, v6
    buffer_load_ushort v16, v6, s[4:7], s12 offen offset:0
    buffer_load_ushort v48, v6, s[4:7], s12 offen offset:2048
    buffer_load_ushort v17, v6, s[4:7], s12 offen offset:64
    buffer_load_ushort v49, v6, s[4:7], s12 offen offset:2112
    buffer_load_ushort v18, v6, s[4:7], s12 offen offset:128
    buffer_load_ushort v50, v6, s[4:7], s12 offen offset:2176
    buffer_load_ushort v19, v6, s[4:7], s12 offen offset:192
    buffer_load_ushort v51, v6, s[4:7], s12 offen offset:2240
    buffer_load_ushort v20, v6, s[4:7], s12 offen offset:256
    buffer_load_ushort v52, v6, s[4:7], s12 offen offset:2304
    buffer_load_ushort v21, v6, s[4:7], s12 offen offset:320
    buffer_load_ushort v53, v6, s[4:7], s12 offen offset:2368
    buffer_load_ushort v22, v6, s[4:7], s12 offen offset:384
    buffer_load_ushort v54, v6, s[4:7], s12 offen offset:2432
    buffer_load_ushort v23, v6, s[4:7], s12 offen offset:448
    buffer_load_ushort v55, v6, s[4:7], s12 offen offset:2496
    buffer_load_ushort v24, v6, s[4:7], s12 offen offset:512
    buffer_load_ushort v56, v6, s[4:7], s12 offen offset:2560
    buffer_load_ushort v25, v6, s[4:7], s12 offen offset:576
    buffer_load_ushort v57, v6, s[4:7], s12 offen offset:2624
    buffer_load_ushort v26, v6, s[4:7], s12 offen offset:640
    buffer_load_ushort v58, v6, s[4:7], s12 offen offset:2688
    buffer_load_ushort v27, v6, s[4:7], s12 offen offset:704
    buffer_load_ushort v59, v6, s[4:7], s12 offen offset:2752
    buffer_load_ushort v28, v6, s[4:7], s12 offen offset:768
    buffer_load_ushort v60, v6, s[4:7], s12 offen offset:2816
    buffer_load_ushort v29, v6, s[4:7], s12 offen offset:832
    buffer_load_ushort v61, v6, s[4:7], s12 offen offset:2880
    buffer_load_ushort v30, v6, s[4:7], s12 offen offset:896
    buffer_load_ushort v62, v6, s[4:7], s12 offen offset:2944
    buffer_load_ushort v31, v6, s[4:7], s12 offen offset:960
    buffer_load_ushort v63, v6, s[4:7], s12 offen offset:3008
    buffer_load_ushort v32, v6, s[4:7], s12 offen offset:1024
    buffer_load_ushort v64, v6, s[4:7], s12 offen offset:3072
    buffer_load_ushort v33, v6, s[4:7], s12 offen offset:1088
    buffer_load_ushort v65, v6, s[4:7], s12 offen offset:3136
    buffer_load_ushort v34, v6, s[4:7], s12 offen offset:1152
    buffer_load_ushort v66, v6, s[4:7], s12 offen offset:3200
    buffer_load_ushort v35, v6, s[4:7], s12 offen offset:1216
    buffer_load_ushort v67, v6, s[4:7], s12 offen offset:3264
    buffer_load_ushort v36, v6, s[4:7], s12 offen offset:1280
    buffer_load_ushort v68, v6, s[4:7], s12 offen offset:3328
    buffer_load_ushort v37, v6, s[4:7], s12 offen offset:1344
    buffer_load_ushort v69, v6, s[4:7], s12 offen offset:3392
    buffer_load_ushort v38, v6, s[4:7], s12 offen offset:1408
    buffer_load_ushort v70, v6, s[4:7], s12 offen offset:3456
    buffer_load_ushort v39, v6, s[4:7], s12 offen offset:1472
    buffer_load_ushort v71, v6, s[4:7], s12 offen offset:3520
    buffer_load_ushort v40, v6, s[4:7], s12 offen offset:1536
    buffer_load_ushort v72, v6, s[4:7], s12 offen offset:3584
    buffer_load_ushort v41, v6, s[4:7], s12 offen offset:1600
    buffer_load_ushort v73, v6, s[4:7], s12 offen offset:3648
    buffer_load_ushort v42, v6, s[4:7], s12 offen offset:1664
    buffer_load_ushort v74, v6, s[4:7], s12 offen offset:3712
    buffer_load_ushort v43, v6, s[4:7], s12 offen offset:1728
    buffer_load_ushort v75, v6, s[4:7], s12 offen offset:3776
    buffer_load_ushort v44, v6, s[4:7], s12 offen offset:1792
    buffer_load_ushort v76, v6, s[4:7], s12 offen offset:3840
    buffer_load_ushort v45, v6, s[4:7], s12 offen offset:1856
    buffer_load_ushort v77, v6, s[4:7], s12 offen offset:3904
    buffer_load_ushort v46, v6, s[4:7], s12 offen offset:1920
    buffer_load_ushort v78, v6, s[4:7], s12 offen offset:3968
    buffer_load_ushort v47, v6, s[4:7], s12 offen offset:1984
    buffer_load_ushort v79, v6, s[4:7], s12 offen offset:4032
    s_movk_i32 s13, 8448
    v_mul_lo_u32 v7, v2, s13
    v_lshl_add_u32 v4, v1, 3, v7
    s_movk_i32 s13, 264
    v_mul_lo_u32 v5, v1, s13
    v_add_u32 v5, v5, v7
    s_waitcnt vmcnt(0)
    v_lshlrev_b32 v16, 16, v16
    v_lshlrev_b32 v48, 16, v48
    v_lshlrev_b32 v17, 16, v17
    v_lshlrev_b32 v49, 16, v49
    v_lshlrev_b32 v18, 16, v18
    v_lshlrev_b32 v50, 16, v50
    v_lshlrev_b32 v19, 16, v19
    v_lshlrev_b32 v51, 16, v51
    v_lshlrev_b32 v20, 16, v20
    v_lshlrev_b32 v52, 16, v52
    v_lshlrev_b32 v21, 16, v21
    v_lshlrev_b32 v53, 16, v53
    v_lshlrev_b32 v22, 16, v22
    v_lshlrev_b32 v54, 16, v54
    v_lshlrev_b32 v23, 16, v23
    v_lshlrev_b32 v55, 16, v55
    v_lshlrev_b32 v24, 16, v24
    v_lshlrev_b32 v56, 16, v56
    v_lshlrev_b32 v25, 16, v25
    v_lshlrev_b32 v57, 16, v57
    v_lshlrev_b32 v26, 16, v26
    v_lshlrev_b32 v58, 16, v58
    v_lshlrev_b32 v27, 16, v27
    v_lshlrev_b32 v59, 16, v59
    v_lshlrev_b32 v28, 16, v28
    v_lshlrev_b32 v60, 16, v60
    v_lshlrev_b32 v29, 16, v29
    v_lshlrev_b32 v61, 16, v61
    v_lshlrev_b32 v30, 16, v30
    v_lshlrev_b32 v62, 16, v62
    v_lshlrev_b32 v31, 16, v31
    v_lshlrev_b32 v63, 16, v63
    v_lshlrev_b32 v32, 16, v32
    v_lshlrev_b32 v64, 16, v64
    v_lshlrev_b32 v33, 16, v33
    v_lshlrev_b32 v65, 16, v65
    v_lshlrev_b32 v34, 16, v34
    v_lshlrev_b32 v66, 16, v66
    v_lshlrev_b32 v35, 16, v35
    v_lshlrev_b32 v67, 16, v67
    v_lshlrev_b32 v36, 16, v36
    v_lshlrev_b32 v68, 16, v68
    v_lshlrev_b32 v37, 16, v37
    v_lshlrev_b32 v69, 16, v69
    v_lshlrev_b32 v38, 16, v38
    v_lshlrev_b32 v70, 16, v70
    v_lshlrev_b32 v39, 16, v39
    v_lshlrev_b32 v71, 16, v71
    v_lshlrev_b32 v40, 16, v40
    v_lshlrev_b32 v72, 16, v72
    v_lshlrev_b32 v41, 16, v41
    v_lshlrev_b32 v73, 16, v73
    v_lshlrev_b32 v42, 16, v42
    v_lshlrev_b32 v74, 16, v74
    v_lshlrev_b32 v43, 16, v43
    v_lshlrev_b32 v75, 16, v75
    v_lshlrev_b32 v44, 16, v44
    v_lshlrev_b32 v76, 16, v76
    v_lshlrev_b32 v45, 16, v45
    v_lshlrev_b32 v77, 16, v77
    v_lshlrev_b32 v46, 16, v46
    v_lshlrev_b32 v78, 16, v78
    v_lshlrev_b32 v47, 16, v47
    v_lshlrev_b32 v79, 16, v79
    v_sub_f32 v80, v16, v32
    v_sub_f32 v81, v48, v64
    v_add_f32 v16, v16, v32
    v_add_f32 v48, v48, v64
    v_sub_f32 v32, v17, v33
    v_sub_f32 v64, v49, v65
    v_add_f32 v17, v17, v33
    v_add_f32 v49, v49, v65
    v_mul_f32 v33, 0x3f7b14be, v32
    v_mul_f32 v65, 0xbe47c5c2, v32
    v_fmac_f32 v33, 0x3e47c5c2, v64
    v_fmac_f32 v65, 0x3f7b14be, v64
    v_sub_f32 v32, v18, v34
    v_sub_f32 v64, v50, v66
    v_add_f32 v18, v18, v34
    v_add_f32 v50, v50, v66
    v_mul_f32 v34, 0x3f6c835e, v32
    v_mul_f32 v66, 0xbec3ef15, v32
    v_fmac_f32 v34, 0x3ec3ef15, v64
    v_fmac_f32 v66, 0x3f6c835e, v64
    v_sub_f32 v32, v19, v35
    v_sub_f32 v64, v51, v67
    v_add_f32 v19, v19, v35
    v_add_f32 v51, v51, v67
    v_mul_f32 v35, 0x3f54db31, v32
    v_mul_f32 v67, 0xbf0e39da, v32
    v_fmac_f32 v35, 0x3f0e39da, v64
    v_fmac_f32 v67, 0x3f54db31, v64
    v_sub_f32 v32, v20, v36
    v_sub_f32 v64, v52, v68
    v_add_f32 v20, v20, v36
    v_add_f32 v52, v52, v68
    v_mul_f32 v36, 0x3f3504f3, v32
    v_mul_f32 v68, 0xbf3504f3, v32
    v_fmac_f32 v36, 0x3f3504f3, v64
    v_fmac_f32 v68, 0x3f3504f3, v64
    v_sub_f32 v32, v21, v37
    v_sub_f32 v64, v53, v69
    v_add_f32 v21, v21, v37
    v_add_f32 v53, v53, v69
    v_mul_f32 v37, 0x3f0e39da, v32
    v_mul_f32 v69, 0xbf54db31, v32
    v_fmac_f32 v37, 0x3f54db31, v64
    v_fmac_f32 v69, 0x3f0e39da, v64
    v_sub_f32 v32, v22, v38
    v_sub_f32 v64, v54, v70
    v_add_f32 v22, v22, v38
    v_add_f32 v54, v54, v70
    v_mul_f32 v38, 0x3ec3ef15, v32
    v_mul_f32 v70, 0xbf6c835e, v32
    v_fmac_f32 v38, 0x3f6c835e, v64
    v_fmac_f32 v70, 0x3ec3ef15, v64
    v_sub_f32 v32, v23, v39
    v_sub_f32 v64, v55, v71
    v_add_f32 v23, v23, v39
    v_add_f32 v55, v55, v71
    v_mul_f32 v39, 0x3e47c5c2, v32
    v_mul_f32 v71, 0xbf7b14be, v32
    v_fmac_f32 v39, 0x3f7b14be, v64
    v_fmac_f32 v71, 0x3e47c5c2, v64
    v_sub_f32 v32, v56, v72
    v_sub_f32 v64, v40, v24
    v_add_f32 v24, v24, v40
    v_add_f32 v56, v56, v72
    v_sub_f32 v40, v25, v41
    v_sub_f32 v72, v57, v73
    v_add_f32 v25, v25, v41
    v_add_f32 v57, v57, v73
    v_mul_f32 v41, 0xbe47c5c2, v40
    v_mul_f32 v73, 0xbf7b14be, v40
    v_fmac_f32 v41, 0x3f7b14be, v72
    v_fmac_f32 v73, 0xbe47c5c2, v72
    v_sub_f32 v40, v26, v42
    v_sub_f32 v72, v58, v74
    v_add_f32 v26, v26, v42
    v_add_f32 v58, v58, v74
    v_mul_f32 v42, 0xbec3ef15, v40
    v_mul_f32 v74, 0xbf6c835e, v40
    v_fmac_f32 v42, 0x3f6c835e, v72
    v_fmac_f32 v74, 0xbec3ef15, v72
    v_sub_f32 v40, v27, v43
    v_sub_f32 v72, v59, v75
    v_add_f32 v27, v27, v43
    v_add_f32 v59, v59, v75
    v_mul_f32 v43, 0xbf0e39da, v40
    v_mul_f32 v75, 0xbf54db31, v40
    v_fmac_f32 v43, 0x3f54db31, v72
    v_fmac_f32 v75, 0xbf0e39da, v72
    v_sub_f32 v40, v28, v44
    v_sub_f32 v72, v60, v76
    v_add_f32 v28, v28, v44
    v_add_f32 v60, v60, v76
    v_mul_f32 v44, 0xbf3504f3, v40
    v_mul_f32 v76, 0xbf3504f3, v40
    v_fmac_f32 v44, 0x3f3504f3, v72
    v_fmac_f32 v76, 0xbf3504f3, v72
    v_sub_f32 v40, v29, v45
    v_sub_f32 v72, v61, v77
    v_add_f32 v29, v29, v45
    v_add_f32 v61, v61, v77
    v_mul_f32 v45, 0xbf54db31, v40
    v_mul_f32 v77, 0xbf0e39da, v40
    v_fmac_f32 v45, 0x3f0e39da, v72
    v_fmac_f32 v77, 0xbf54db31, v72
    v_sub_f32 v40, v30, v46
    v_sub_f32 v72, v62, v78
    v_add_f32 v30, v30, v46
    v_add_f32 v62, v62, v78
    v_mul_f32 v46, 0xbf6c835e, v40
    v_mul_f32 v78, 0xbec3ef15, v40
    v_fmac_f32 v46, 0x3ec3ef15, v72
    v_fmac_f32 v78, 0xbf6c835e, v72
    v_sub_f32 v40, v31, v47
    v_sub_f32 v72, v63, v79
    v_add_f32 v31, v31, v47
    v_add_f32 v63, v63, v79
    v_mul_f32 v47, 0xbf7b14be, v40
    v_mul_f32 v79, 0xbe47c5c2, v40
    v_fmac_f32 v47, 0x3e47c5c2, v72
    v_fmac_f32 v79, 0xbf7b14be, v72
    v_sub_f32 v40, v16, v24
    v_sub_f32 v72, v48, v56
    v_add_f32 v16, v16, v24
    v_add_f32 v48, v48, v56
    v_sub_f32 v24, v17, v25
    v_sub_f32 v56, v49, v57
    v_add_f32 v17, v17, v25
    v_add_f32 v49, v49, v57
    v_mul_f32 v25, 0x3f6c835e, v24
    v_mul_f32 v57, 0xbec3ef15, v24
    v_fmac_f32 v25, 0x3ec3ef15, v56
    v_fmac_f32 v57, 0x3f6c835e, v56
    v_sub_f32 v24, v18, v26
    v_sub_f32 v56, v50, v58
    v_add_f32 v18, v18, v26
    v_add_f32 v50, v50, v58
    v_mul_f32 v26, 0x3f3504f3, v24
    v_mul_f32 v58, 0xbf3504f3, v24
    v_fmac_f32 v26, 0x3f3504f3, v56
    v_fmac_f32 v58, 0x3f3504f3, v56
    v_sub_f32 v24, v19, v27
    v_sub_f32 v56, v51, v59
    v_add_f32 v19, v19, v27
    v_add_f32 v51, v51, v59
    v_mul_f32 v27, 0x3ec3ef15, v24
    v_mul_f32 v59, 0xbf6c835e, v24
    v_fmac_f32 v27, 0x3f6c835e, v56
    v_fmac_f32 v59, 0x3ec3ef15, v56
    v_sub_f32 v24, v52, v60
    v_sub_f32 v56, v28, v20
    v_add_f32 v20, v20, v28
    v_add_f32 v52, v52, v60
    v_sub_f32 v28, v21, v29
    v_sub_f32 v60, v53, v61
    v_add_f32 v21, v21, v29
    v_add_f32 v53, v53, v61
    v_mul_f32 v29, 0xbec3ef15, v28
    v_mul_f32 v61, 0xbf6c835e, v28
    v_fmac_f32 v29, 0x3f6c835e, v60
    v_fmac_f32 v61, 0xbec3ef15, v60
    v_sub_f32 v28, v22, v30
    v_sub_f32 v60, v54, v62
    v_add_f32 v22, v22, v30
    v_add_f32 v54, v54, v62
    v_mul_f32 v30, 0xbf3504f3, v28
    v_mul_f32 v62, 0xbf3504f3, v28
    v_fmac_f32 v30, 0x3f3504f3, v60
    v_fmac_f32 v62, 0xbf3504f3, v60
    v_sub_f32 v28, v23, v31
    v_sub_f32 v60, v55, v63
    v_add_f32 v23, v23, v31
    v_add_f32 v55, v55, v63
    v_mul_f32 v31, 0xbf6c835e, v28
    v_mul_f32 v63, 0xbec3ef15, v28
    v_fmac_f32 v31, 0x3ec3ef15, v60
    v_fmac_f32 v63, 0xbf6c835e, v60
    v_sub_f32 v28, v80, v32
    v_sub_f32 v60, v81, v64
    v_add_f32 v80, v80, v32
    v_add_f32 v81, v81, v64
    v_sub_f32 v32, v33, v41
    v_sub_f32 v64, v65, v73
    v_add_f32 v33, v33, v41
    v_add_f32 v65, v65, v73
    v_mul_f32 v41, 0x3f6c835e, v32
    v_mul_f32 v73, 0xbec3ef15, v32
    v_fmac_f32 v41, 0x3ec3ef15, v64
    v_fmac_f32 v73, 0x3f6c835e, v64
    v_sub_f32 v32, v34, v42
    v_sub_f32 v64, v66, v74
    v_add_f32 v34, v34, v42
    v_add_f32 v66, v66, v74
    v_mul_f32 v42, 0x3f3504f3, v32
    v_mul_f32 v74, 0xbf3504f3, v32
    v_fmac_f32 v42, 0x3f3504f3, v64
    v_fmac_f32 v74, 0x3f3504f3, v64
    v_sub_f32 v32, v35, v43
    v_sub_f32 v64, v67, v75
    v_add_f32 v35, v35, v43
    v_add_f32 v67, v67, v75
    v_mul_f32 v43, 0x3ec3ef15, v32
    v_mul_f32 v75, 0xbf6c835e, v32
    v_fmac_f32 v43, 0x3f6c835e, v64
    v_fmac_f32 v75, 0x3ec3ef15, v64
    v_sub_f32 v32, v68, v76
    v_sub_f32 v64, v44, v36
    v_add_f32 v36, v36, v44
    v_add_f32 v68, v68, v76
    v_sub_f32 v44, v37, v45
    v_sub_f32 v76, v69, v77
    v_add_f32 v37, v37, v45
    v_add_f32 v69, v69, v77
    v_mul_f32 v45, 0xbec3ef15, v44
    v_mul_f32 v77, 0xbf6c835e, v44
    v_fmac_f32 v45, 0x3f6c835e, v76
    v_fmac_f32 v77, 0xbec3ef15, v76
    v_sub_f32 v44, v38, v46
    v_sub_f32 v76, v70, v78
    v_add_f32 v38, v38, v46
    v_add_f32 v70, v70, v78
    v_mul_f32 v46, 0xbf3504f3, v44
    v_mul_f32 v78, 0xbf3504f3, v44
    v_fmac_f32 v46, 0x3f3504f3, v76
    v_fmac_f32 v78, 0xbf3504f3, v76
    v_sub_f32 v44, v39, v47
    v_sub_f32 v76, v71, v79
    v_add_f32 v39, v39, v47
    v_add_f32 v71, v71, v79
    v_mul_f32 v47, 0xbf6c835e, v44
    v_mul_f32 v79, 0xbec3ef15, v44
    v_fmac_f32 v47, 0x3ec3ef15, v76
    v_fmac_f32 v79, 0xbf6c835e, v76
    v_sub_f32 v44, v16, v20
    v_sub_f32 v76, v48, v52
    v_add_f32 v16, v16, v20
    v_add_f32 v48, v48, v52
    v_sub_f32 v20, v17, v21
    v_sub_f32 v52, v49, v53
    v_add_f32 v17, v17, v21
    v_add_f32 v49, v49, v53
    v_mul_f32 v21, 0x3f3504f3, v20
    v_mul_f32 v53, 0xbf3504f3, v20
    v_fmac_f32 v21, 0x3f3504f3, v52
    v_fmac_f32 v53, 0x3f3504f3, v52
    v_sub_f32 v20, v50, v54
    v_sub_f32 v52, v22, v18
    v_add_f32 v18, v18, v22
    v_add_f32 v50, v50, v54
    v_sub_f32 v22, v19, v23
    v_sub_f32 v54, v51, v55
    v_add_f32 v19, v19, v23
    v_add_f32 v51, v51, v55
    v_mul_f32 v23, 0xbf3504f3, v22
    v_mul_f32 v55, 0xbf3504f3, v22
    v_fmac_f32 v23, 0x3f3504f3, v54
    v_fmac_f32 v55, 0xbf3504f3, v54
    v_sub_f32 v22, v40, v24
    v_sub_f32 v54, v72, v56
    v_add_f32 v40, v40, v24
    v_add_f32 v72, v72, v56
    v_sub_f32 v24, v25, v29
    v_sub_f32 v56, v57, v61
    v_add_f32 v25, v25, v29
    v_add_f32 v57, v57, v61
    v_mul_f32 v29, 0x3f3504f3, v24
    v_mul_f32 v61, 0xbf3504f3, v24
    v_fmac_f32 v29, 0x3f3504f3, v56
    v_fmac_f32 v61, 0x3f3504f3, v56
    v_sub_f32 v24, v58, v62
    v_sub_f32 v56, v30, v26
    v_add_f32 v26, v26, v30
    v_add_f32 v58, v58, v62
    v_sub_f32 v30, v27, v31
    v_sub_f32 v62, v59, v63
    v_add_f32 v27, v27, v31
    v_add_f32 v59, v59, v63
    v_mul_f32 v31, 0xbf3504f3, v30
    v_mul_f32 v63, 0xbf3504f3, v30
    v_fmac_f32 v31, 0x3f3504f3, v62
    v_fmac_f32 v63, 0xbf3504f3, v62
    v_sub_f32 v30, v80, v36
    v_sub_f32 v62, v81, v68
    v_add_f32 v80, v80, v36
    v_add_f32 v81, v81, v68
    v_sub_f32 v36, v33, v37
    v_sub_f32 v68, v65, v69
    v_add_f32 v33, v33, v37
    v_add_f32 v65, v65, v69
    v_mul_f32 v37, 0x3f3504f3, v36
    v_mul_f32 v69, 0xbf3504f3, v36
    v_fmac_f32 v37, 0x3f3504f3, v68
    v_fmac_f32 v69, 0x3f3504f3, v68
    v_sub_f32 v36, v66, v70
    v_sub_f32 v68, v38, v34
    v_add_f32 v34, v34, v38
    v_add_f32 v66, v66, v70
    v_sub_f32 v38, v35, v39
    v_sub_f32 v70, v67, v71
    v_add_f32 v35, v35, v39
    v_add_f32 v67, v67, v71
    v_mul_f32 v39, 0xbf3504f3, v38
    v_mul_f32 v71, 0xbf3504f3, v38
    v_fmac_f32 v39, 0x3f3504f3, v70
    v_fmac_f32 v71, 0xbf3504f3, v70
    v_sub_f32 v38, v28, v32
    v_sub_f32 v70, v60, v64
    v_add_f32 v28, v28, v32
    v_add_f32 v60, v60, v64
    v_sub_f32 v32, v41, v45
    v_sub_f32 v64, v73, v77
    v_add_f32 v41, v41, v45
    v_add_f32 v73, v73, v77
    v_mul_f32 v45, 0x3f3504f3, v32
    v_mul_f32 v77, 0xbf3504f3, v32
    v_fmac_f32 v45, 0x3f3504f3, v64
    v_fmac_f32 v77, 0x3f3504f3, v64
    v_sub_f32 v32, v74, v78
    v_sub_f32 v64, v46, v42
    v_add_f32 v42, v42, v46
    v_add_f32 v74, v74, v78
    v_sub_f32 v46, v43, v47
    v_sub_f32 v78, v75, v79
    v_add_f32 v43, v43, v47
    v_add_f32 v75, v75, v79
    v_mul_f32 v47, 0xbf3504f3, v46
    v_mul_f32 v79, 0xbf3504f3, v46
    v_fmac_f32 v47, 0x3f3504f3, v78
    v_fmac_f32 v79, 0xbf3504f3, v78
    v_sub_f32 v46, v16, v18
    v_sub_f32 v78, v48, v50
    v_add_f32 v16, v16, v18
    v_add_f32 v48, v48, v50
    v_sub_f32 v18, v49, v51
    v_sub_f32 v50, v19, v17
    v_add_f32 v17, v17, v19
    v_add_f32 v49, v49, v51
    v_sub_f32 v19, v44, v20
    v_sub_f32 v51, v76, v52
    v_add_f32 v44, v44, v20
    v_add_f32 v76, v76, v52
    v_sub_f32 v20, v53, v55
    v_sub_f32 v52, v23, v21
    v_add_f32 v21, v21, v23
    v_add_f32 v53, v53, v55
    v_sub_f32 v23, v40, v26
    v_sub_f32 v55, v72, v58
    v_add_f32 v40, v40, v26
    v_add_f32 v72, v72, v58
    v_sub_f32 v26, v57, v59
    v_sub_f32 v58, v27, v25
    v_add_f32 v25, v25, v27
    v_add_f32 v57, v57, v59
    v_sub_f32 v27, v22, v24
    v_sub_f32 v59, v54, v56
    v_add_f32 v22, v22, v24
    v_add_f32 v54, v54, v56
    v_sub_f32 v24, v61, v63
    v_sub_f32 v56, v31, v29
    v_add_f32 v29, v29, v31
    v_add_f32 v61, v61, v63
    v_sub_f32 v31, v80, v34
    v_sub_f32 v63, v81, v66
    v_add_f32 v80, v80, v34
    v_add_f32 v81, v81, v66
    v_sub_f32 v34, v65, v67
    v_sub_f32 v66, v35, v33
    v_add_f32 v33, v33, v35
    v_add_f32 v65, v65, v67
    v_sub_f32 v35, v30, v36
    v_sub_f32 v67, v62, v68
    v_add_f32 v30, v30, v36
    v_add_f32 v62, v62, v68
    v_sub_f32 v36, v69, v71
    v_sub_f32 v68, v39, v37
    v_add_f32 v37, v37, v39
    v_add_f32 v69, v69, v71
    v_sub_f32 v39, v28, v42
    v_sub_f32 v71, v60, v74
    v_add_f32 v28, v28, v42
    v_add_f32 v60, v60, v74
    v_sub_f32 v42, v73, v75
    v_sub_f32 v74, v43, v41
    v_add_f32 v41, v41, v43
    v_add_f32 v73, v73, v75
    v_sub_f32 v43, v38, v32
    v_sub_f32 v75, v70, v64
    v_add_f32 v38, v38, v32
    v_add_f32 v70, v70, v64
    v_sub_f32 v32, v77, v79
    v_sub_f32 v64, v47, v45
    v_add_f32 v45, v45, v47
    v_add_f32 v77, v77, v79
    v_sub_f32 v47, v16, v17
    v_sub_f32 v79, v48, v49
    v_add_f32 v16, v16, v17
    v_add_f32 v48, v48, v49
    v_sub_f32 v17, v46, v18
    v_sub_f32 v49, v78, v50
    v_add_f32 v46, v46, v18
    v_add_f32 v78, v78, v50
    v_sub_f32 v18, v44, v21
    v_sub_f32 v50, v76, v53
    v_add_f32 v44, v44, v21
    v_add_f32 v76, v76, v53
    v_sub_f32 v21, v19, v20
    v_sub_f32 v53, v51, v52
    v_add_f32 v19, v19, v20
    v_add_f32 v51, v51, v52
    v_sub_f32 v20, v40, v25
    v_sub_f32 v52, v72, v57
    v_add_f32 v40, v40, v25
    v_add_f32 v72, v72, v57
    v_sub_f32 v25, v23, v26
    v_sub_f32 v57, v55, v58
    v_add_f32 v23, v23, v26
    v_add_f32 v55, v55, v58
    v_sub_f32 v26, v22, v29
    v_sub_f32 v58, v54, v61
    v_add_f32 v22, v22, v29
    v_add_f32 v54, v54, v61
    v_sub_f32 v29, v27, v24
    v_sub_f32 v61, v59, v56
    v_add_f32 v27, v27, v24
    v_add_f32 v59, v59, v56
    v_sub_f32 v24, v80, v33
    v_sub_f32 v56, v81, v65
    v_add_f32 v80, v80, v33
    v_add_f32 v81, v81, v65
    v_sub_f32 v33, v31, v34
    v_sub_f32 v65, v63, v66
    v_add_f32 v31, v31, v34
    v_add_f32 v63, v63, v66
    v_sub_f32 v34, v30, v37
    v_sub_f32 v66, v62, v69
    v_add_f32 v30, v30, v37
    v_add_f32 v62, v62, v69
    v_sub_f32 v37, v35, v36
    v_sub_f32 v69, v67, v68
    v_add_f32 v35, v35, v36
    v_add_f32 v67, v67, v68
    v_sub_f32 v36, v28, v41
    v_sub_f32 v68, v60, v73
    v_add_f32 v28, v28, v41
    v_add_f32 v60, v60, v73
    v_sub_f32 v41, v39, v42
    v_sub_f32 v73, v71, v74
    v_add_f32 v39, v39, v42
    v_add_f32 v71, v71, v74
    v_sub_f32 v42, v38, v45
    v_sub_f32 v74, v70, v77
    v_add_f32 v38, v38, v45
    v_add_f32 v70, v70, v77
    v_sub_f32 v45, v43, v32
    v_sub_f32 v77, v75, v64
    v_add_f32 v43, v43, v32
    v_add_f32 v75, v75, v64
    v_mul_f32 v32, 0xba800000, v3
    v_cos_f32 v64, v32
    v_sin_f32 v82, v32
    s_nop 0
    v_mul_f32 v83, v80, v64
    v_fma_f32 v83, -v81, v82, v83
    v_mul_f32 v81, v81, v64
    v_fmac_f32 v81, v80, v82
    v_mul_f32 v32, 0xbb000000, v3
    v_cos_f32 v64, v32
    v_sin_f32 v82, v32
    s_nop 0
    v_mul_f32 v80, v40, v64
    v_fma_f32 v80, -v72, v82, v80
    v_mul_f32 v72, v72, v64
    v_fmac_f32 v72, v40, v82
    v_mul_f32 v32, 0xbb400000, v3
    v_cos_f32 v64, v32
    v_sin_f32 v82, v32
    s_nop 0
    v_mul_f32 v40, v28, v64
    v_fma_f32 v40, -v60, v82, v40
    v_mul_f32 v60, v60, v64
    v_fmac_f32 v60, v28, v82
    v_mul_f32 v32, 0xbb800000, v3
    v_cos_f32 v64, v32
    v_sin_f32 v82, v32
    s_nop 0
    v_mul_f32 v28, v44, v64
    v_fma_f32 v28, -v76, v82, v28
    v_mul_f32 v76, v76, v64
    v_fmac_f32 v76, v44, v82
    v_mul_f32 v32, 0xbba00000, v3
    v_cos_f32 v64, v32
    v_sin_f32 v82, v32
    s_nop 0
    v_mul_f32 v44, v30, v64
    v_fma_f32 v44, -v62, v82, v44
    v_mul_f32 v62, v62, v64
    v_fmac_f32 v62, v30, v82
    v_mul_f32 v32, 0xbbc00000, v3
    v_cos_f32 v64, v32
    v_sin_f32 v82, v32
    s_nop 0
    v_mul_f32 v30, v22, v64
    v_fma_f32 v30, -v54, v82, v30
    v_mul_f32 v54, v54, v64
    v_fmac_f32 v54, v22, v82
    v_mul_f32 v32, 0xbbe00000, v3
    v_cos_f32 v64, v32
    v_sin_f32 v82, v32
    s_nop 0
    v_mul_f32 v22, v38, v64
    v_fma_f32 v22, -v70, v82, v22
    v_mul_f32 v70, v70, v64
    v_fmac_f32 v70, v38, v82
    v_mul_f32 v32, 0xbc000000, v3
    v_cos_f32 v64, v32
    v_sin_f32 v82, v32
    s_nop 0
    v_mul_f32 v38, v46, v64
    v_fma_f32 v38, -v78, v82, v38
    v_mul_f32 v78, v78, v64
    v_fmac_f32 v78, v46, v82
    v_mul_f32 v32, 0xbc100000, v3
    v_cos_f32 v64, v32
    v_sin_f32 v82, v32
    s_nop 0
    v_mul_f32 v46, v31, v64
    v_fma_f32 v46, -v63, v82, v46
    v_mul_f32 v63, v63, v64
    v_fmac_f32 v63, v31, v82
    v_mul_f32 v32, 0xbc200000, v3
    v_cos_f32 v64, v32
    v_sin_f32 v82, v32
    s_nop 0
    v_mul_f32 v31, v23, v64
    v_fma_f32 v31, -v55, v82, v31
    v_mul_f32 v55, v55, v64
    v_fmac_f32 v55, v23, v82
    v_mul_f32 v32, 0xbc300000, v3
    v_cos_f32 v64, v32
    v_sin_f32 v82, v32
    s_nop 0
    v_mul_f32 v23, v39, v64
    v_fma_f32 v23, -v71, v82, v23
    v_mul_f32 v71, v71, v64
    v_fmac_f32 v71, v39, v82
    v_mul_f32 v32, 0xbc400000, v3
    v_cos_f32 v64, v32
    v_sin_f32 v82, v32
    s_nop 0
    v_mul_f32 v39, v19, v64
    v_fma_f32 v39, -v51, v82, v39
    v_mul_f32 v51, v51, v64
    v_fmac_f32 v51, v19, v82
    v_mul_f32 v32, 0xbc500000, v3
    v_cos_f32 v64, v32
    v_sin_f32 v82, v32
    s_nop 0
    v_mul_f32 v19, v35, v64
    v_fma_f32 v19, -v67, v82, v19
    v_mul_f32 v67, v67, v64
    v_fmac_f32 v67, v35, v82
    v_mul_f32 v32, 0xbc600000, v3
    v_cos_f32 v64, v32
    v_sin_f32 v82, v32
    s_nop 0
    v_mul_f32 v35, v27, v64
    v_fma_f32 v35, -v59, v82, v35
    v_mul_f32 v59, v59, v64
    v_fmac_f32 v59, v27, v82
    v_mul_f32 v32, 0xbc700000, v3
    v_cos_f32 v64, v32
    v_sin_f32 v82, v32
    s_nop 0
    v_mul_f32 v27, v43, v64
    v_fma_f32 v27, -v75, v82, v27
    v_mul_f32 v75, v75, v64
    v_fmac_f32 v75, v43, v82
    v_mul_f32 v32, 0xbc800000, v3
    v_cos_f32 v64, v32
    v_sin_f32 v82, v32
    s_nop 0
    v_mul_f32 v43, v47, v64
    v_fma_f32 v43, -v79, v82, v43
    v_mul_f32 v79, v79, v64
    v_fmac_f32 v79, v47, v82
    v_mul_f32 v32, 0xbc880000, v3
    v_cos_f32 v64, v32
    v_sin_f32 v82, v32
    s_nop 0
    v_mul_f32 v47, v24, v64
    v_fma_f32 v47, -v56, v82, v47
    v_mul_f32 v56, v56, v64
    v_fmac_f32 v56, v24, v82
    v_mul_f32 v32, 0xbc900000, v3
    v_cos_f32 v64, v32
    v_sin_f32 v82, v32
    s_nop 0
    v_mul_f32 v24, v20, v64
    v_fma_f32 v24, -v52, v82, v24
    v_mul_f32 v52, v52, v64
    v_fmac_f32 v52, v20, v82
    v_mul_f32 v32, 0xbc980000, v3
    v_cos_f32 v64, v32
    v_sin_f32 v82, v32
    s_nop 0
    v_mul_f32 v20, v36, v64
    v_fma_f32 v20, -v68, v82, v20
    v_mul_f32 v68, v68, v64
    v_fmac_f32 v68, v36, v82
    v_mul_f32 v32, 0xbca00000, v3
    v_cos_f32 v64, v32
    v_sin_f32 v82, v32
    s_nop 0
    v_mul_f32 v36, v18, v64
    v_fma_f32 v36, -v50, v82, v36
    v_mul_f32 v50, v50, v64
    v_fmac_f32 v50, v18, v82
    v_mul_f32 v32, 0xbca80000, v3
    v_cos_f32 v64, v32
    v_sin_f32 v82, v32
    s_nop 0
    v_mul_f32 v18, v34, v64
    v_fma_f32 v18, -v66, v82, v18
    v_mul_f32 v66, v66, v64
    v_fmac_f32 v66, v34, v82
    v_mul_f32 v32, 0xbcb00000, v3
    v_cos_f32 v64, v32
    v_sin_f32 v82, v32
    s_nop 0
    v_mul_f32 v34, v26, v64
    v_fma_f32 v34, -v58, v82, v34
    v_mul_f32 v58, v58, v64
    v_fmac_f32 v58, v26, v82
    v_mul_f32 v32, 0xbcb80000, v3
    v_cos_f32 v64, v32
    v_sin_f32 v82, v32
    s_nop 0
    v_mul_f32 v26, v42, v64
    v_fma_f32 v26, -v74, v82, v26
    v_mul_f32 v74, v74, v64
    v_fmac_f32 v74, v42, v82
    v_mul_f32 v32, 0xbcc00000, v3
    v_cos_f32 v64, v32
    v_sin_f32 v82, v32
    s_nop 0
    v_mul_f32 v42, v17, v64
    v_fma_f32 v42, -v49, v82, v42
    v_mul_f32 v49, v49, v64
    v_fmac_f32 v49, v17, v82
    v_mul_f32 v32, 0xbcc80000, v3
    v_cos_f32 v64, v32
    v_sin_f32 v82, v32
    s_nop 0
    v_mul_f32 v17, v33, v64
    v_fma_f32 v17, -v65, v82, v17
    v_mul_f32 v65, v65, v64
    v_fmac_f32 v65, v33, v82
    v_mul_f32 v32, 0xbcd00000, v3
    v_cos_f32 v64, v32
    v_sin_f32 v82, v32
    s_nop 0
    v_mul_f32 v33, v25, v64
    v_fma_f32 v33, -v57, v82, v33
    v_mul_f32 v57, v57, v64
    v_fmac_f32 v57, v25, v82
    v_mul_f32 v32, 0xbcd80000, v3
    v_cos_f32 v64, v32
    v_sin_f32 v82, v32
    s_nop 0
    v_mul_f32 v25, v41, v64
    v_fma_f32 v25, -v73, v82, v25
    v_mul_f32 v73, v73, v64
    v_fmac_f32 v73, v41, v82
    v_mul_f32 v32, 0xbce00000, v3
    v_cos_f32 v64, v32
    v_sin_f32 v82, v32
    s_nop 0
    v_mul_f32 v41, v21, v64
    v_fma_f32 v41, -v53, v82, v41
    v_mul_f32 v53, v53, v64
    v_fmac_f32 v53, v21, v82
    v_mul_f32 v32, 0xbce80000, v3
    v_cos_f32 v64, v32
    v_sin_f32 v82, v32
    s_nop 0
    v_mul_f32 v21, v37, v64
    v_fma_f32 v21, -v69, v82, v21
    v_mul_f32 v69, v69, v64
    v_fmac_f32 v69, v37, v82
    v_mul_f32 v32, 0xbcf00000, v3
    v_cos_f32 v64, v32
    v_sin_f32 v82, v32
    s_nop 0
    v_mul_f32 v37, v29, v64
    v_fma_f32 v37, -v61, v82, v37
    v_mul_f32 v61, v61, v64
    v_fmac_f32 v61, v29, v82
    v_mul_f32 v32, 0xbcf80000, v3
    v_cos_f32 v64, v32
    v_sin_f32 v82, v32
    s_nop 0
    v_mul_f32 v29, v45, v64
    v_fma_f32 v29, -v77, v82, v29
    v_mul_f32 v77, v77, v64
    v_fmac_f32 v77, v45, v82
    ds_write_b32 v4, v16 offset:0
    ds_write_b32 v4, v48 offset:4
    ds_write_b32 v4, v83 offset:264
    ds_write_b32 v4, v81 offset:268
    ds_write_b32 v4, v80 offset:528
    ds_write_b32 v4, v72 offset:532
    ds_write_b32 v4, v40 offset:792
    ds_write_b32 v4, v60 offset:796
    ds_write_b32 v4, v28 offset:1056
    ds_write_b32 v4, v76 offset:1060
    ds_write_b32 v4, v44 offset:1320
    ds_write_b32 v4, v62 offset:1324
    ds_write_b32 v4, v30 offset:1584
    ds_write_b32 v4, v54 offset:1588
    ds_write_b32 v4, v22 offset:1848
    ds_write_b32 v4, v70 offset:1852
    ds_write_b32 v4, v38 offset:2112
    ds_write_b32 v4, v78 offset:2116
    ds_write_b32 v4, v46 offset:2376
    ds_write_b32 v4, v63 offset:2380
    ds_write_b32 v4, v31 offset:2640
    ds_write_b32 v4, v55 offset:2644
    ds_write_b32 v4, v23 offset:2904
    ds_write_b32 v4, v71 offset:2908
    ds_write_b32 v4, v39 offset:3168
    ds_write_b32 v4, v51 offset:3172
    ds_write_b32 v4, v19 offset:3432
    ds_write_b32 v4, v67 offset:3436
    ds_write_b32 v4, v35 offset:3696
    ds_write_b32 v4, v59 offset:3700
    ds_write_b32 v4, v27 offset:3960
    ds_write_b32 v4, v75 offset:3964
    ds_write_b32 v4, v43 offset:4224
    ds_write_b32 v4, v79 offset:4228
    ds_write_b32 v4, v47 offset:4488
    ds_write_b32 v4, v56 offset:4492
    ds_write_b32 v4, v24 offset:4752
    ds_write_b32 v4, v52 offset:4756
    ds_write_b32 v4, v20 offset:5016
    ds_write_b32 v4, v68 offset:5020
    ds_write_b32 v4, v36 offset:5280
    ds_write_b32 v4, v50 offset:5284
    ds_write_b32 v4, v18 offset:5544
    ds_write_b32 v4, v66 offset:5548
    ds_write_b32 v4, v34 offset:5808
    ds_write_b32 v4, v58 offset:5812
    ds_write_b32 v4, v26 offset:6072
    ds_write_b32 v4, v74 offset:6076
    ds_write_b32 v4, v42 offset:6336
    ds_write_b32 v4, v49 offset:6340
    ds_write_b32 v4, v17 offset:6600
    ds_write_b32 v4, v65 offset:6604
    ds_write_b32 v4, v33 offset:6864
    ds_write_b32 v4, v57 offset:6868
    ds_write_b32 v4, v25 offset:7128
    ds_write_b32 v4, v73 offset:7132
    ds_write_b32 v4, v41 offset:7392
    ds_write_b32 v4, v53 offset:7396
    ds_write_b32 v4, v21 offset:7656
    ds_write_b32 v4, v69 offset:7660
    ds_write_b32 v4, v37 offset:7920
    ds_write_b32 v4, v61 offset:7924
    ds_write_b32 v4, v29 offset:8184
    ds_write_b32 v4, v77 offset:8188
    s_waitcnt lgkmcnt(0)
    ds_read_b32 v16, v5 offset:0
    ds_read_b32 v48, v5 offset:4
    ds_read_b32 v83, v5 offset:8
    ds_read_b32 v81, v5 offset:12
    ds_read_b32 v80, v5 offset:16
    ds_read_b32 v72, v5 offset:20
    ds_read_b32 v40, v5 offset:24
    ds_read_b32 v60, v5 offset:28
    ds_read_b32 v28, v5 offset:32
    ds_read_b32 v76, v5 offset:36
    ds_read_b32 v44, v5 offset:40
    ds_read_b32 v62, v5 offset:44
    ds_read_b32 v30, v5 offset:48
    ds_read_b32 v54, v5 offset:52
    s_waitcnt lgkmcnt(0)
    ds_read_b32 v22, v5 offset:56
    ds_read_b32 v70, v5 offset:60
    ds_read_b32 v38, v5 offset:64
    ds_read_b32 v78, v5 offset:68
    ds_read_b32 v46, v5 offset:72
    ds_read_b32 v63, v5 offset:76
    ds_read_b32 v31, v5 offset:80
    ds_read_b32 v55, v5 offset:84
    ds_read_b32 v23, v5 offset:88
    ds_read_b32 v71, v5 offset:92
    ds_read_b32 v39, v5 offset:96
    ds_read_b32 v51, v5 offset:100
    ds_read_b32 v19, v5 offset:104
    ds_read_b32 v67, v5 offset:108
    s_waitcnt lgkmcnt(0)
    ds_read_b32 v35, v5 offset:112
    ds_read_b32 v59, v5 offset:116
    ds_read_b32 v27, v5 offset:120
    ds_read_b32 v75, v5 offset:124
    ds_read_b32 v43, v5 offset:128
    ds_read_b32 v79, v5 offset:132
    ds_read_b32 v47, v5 offset:136
    ds_read_b32 v56, v5 offset:140
    ds_read_b32 v24, v5 offset:144
    ds_read_b32 v52, v5 offset:148
    ds_read_b32 v20, v5 offset:152
    ds_read_b32 v68, v5 offset:156
    ds_read_b32 v36, v5 offset:160
    ds_read_b32 v50, v5 offset:164
    s_waitcnt lgkmcnt(0)
    ds_read_b32 v18, v5 offset:168
    ds_read_b32 v66, v5 offset:172
    ds_read_b32 v34, v5 offset:176
    ds_read_b32 v58, v5 offset:180
    ds_read_b32 v26, v5 offset:184
    ds_read_b32 v74, v5 offset:188
    ds_read_b32 v42, v5 offset:192
    ds_read_b32 v49, v5 offset:196
    ds_read_b32 v17, v5 offset:200
    ds_read_b32 v65, v5 offset:204
    ds_read_b32 v33, v5 offset:208
    ds_read_b32 v57, v5 offset:212
    ds_read_b32 v25, v5 offset:216
    ds_read_b32 v73, v5 offset:220
    s_waitcnt lgkmcnt(0)
    ds_read_b32 v41, v5 offset:224
    ds_read_b32 v53, v5 offset:228
    ds_read_b32 v21, v5 offset:232
    ds_read_b32 v69, v5 offset:236
    ds_read_b32 v37, v5 offset:240
    ds_read_b32 v61, v5 offset:244
    ds_read_b32 v29, v5 offset:248
    ds_read_b32 v77, v5 offset:252
    s_waitcnt lgkmcnt(0)
    v_sub_f32 v32, v16, v43
    v_sub_f32 v64, v48, v79
    v_add_f32 v16, v16, v43
    v_add_f32 v48, v48, v79
    v_sub_f32 v43, v83, v47
    v_sub_f32 v79, v81, v56
    v_add_f32 v83, v83, v47
    v_add_f32 v81, v81, v56
    v_mul_f32 v47, 0x3f7b14be, v43
    v_mul_f32 v56, 0xbe47c5c2, v43
    v_fmac_f32 v47, 0x3e47c5c2, v79
    v_fmac_f32 v56, 0x3f7b14be, v79
    v_sub_f32 v43, v80, v24
    v_sub_f32 v79, v72, v52
    v_add_f32 v80, v80, v24
    v_add_f32 v72, v72, v52
    v_mul_f32 v24, 0x3f6c835e, v43
    v_mul_f32 v52, 0xbec3ef15, v43
    v_fmac_f32 v24, 0x3ec3ef15, v79
    v_fmac_f32 v52, 0x3f6c835e, v79
    v_sub_f32 v43, v40, v20
    v_sub_f32 v79, v60, v68
    v_add_f32 v40, v40, v20
    v_add_f32 v60, v60, v68
    v_mul_f32 v20, 0x3f54db31, v43
    v_mul_f32 v68, 0xbf0e39da, v43
    v_fmac_f32 v20, 0x3f0e39da, v79
    v_fmac_f32 v68, 0x3f54db31, v79
    v_sub_f32 v43, v28, v36
    v_sub_f32 v79, v76, v50
    v_add_f32 v28, v28, v36
    v_add_f32 v76, v76, v50
    v_mul_f32 v36, 0x3f3504f3, v43
    v_mul_f32 v50, 0xbf3504f3, v43
    v_fmac_f32 v36, 0x3f3504f3, v79
    v_fmac_f32 v50, 0x3f3504f3, v79
    v_sub_f32 v43, v44, v18
    v_sub_f32 v79, v62, v66
    v_add_f32 v44, v44, v18
    v_add_f32 v62, v62, v66
    v_mul_f32 v18, 0x3f0e39da, v43
    v_mul_f32 v66, 0xbf54db31, v43
    v_fmac_f32 v18, 0x3f54db31, v79
    v_fmac_f32 v66, 0x3f0e39da, v79
    v_sub_f32 v43, v30, v34
    v_sub_f32 v79, v54, v58
    v_add_f32 v30, v30, v34
    v_add_f32 v54, v54, v58
    v_mul_f32 v34, 0x3ec3ef15, v43
    v_mul_f32 v58, 0xbf6c835e, v43
    v_fmac_f32 v34, 0x3f6c835e, v79
    v_fmac_f32 v58, 0x3ec3ef15, v79
    v_sub_f32 v43, v22, v26
    v_sub_f32 v79, v70, v74
    v_add_f32 v22, v22, v26
    v_add_f32 v70, v70, v74
    v_mul_f32 v26, 0x3e47c5c2, v43
    v_mul_f32 v74, 0xbf7b14be, v43
    v_fmac_f32 v26, 0x3f7b14be, v79
    v_fmac_f32 v74, 0x3e47c5c2, v79
    v_sub_f32 v43, v78, v49
    v_sub_f32 v79, v42, v38
    v_add_f32 v38, v38, v42
    v_add_f32 v78, v78, v49
    v_sub_f32 v42, v46, v17
    v_sub_f32 v49, v63, v65
    v_add_f32 v46, v46, v17
    v_add_f32 v63, v63, v65
    v_mul_f32 v17, 0xbe47c5c2, v42
    v_mul_f32 v65, 0xbf7b14be, v42
    v_fmac_f32 v17, 0x3f7b14be, v49
    v_fmac_f32 v65, 0xbe47c5c2, v49
    v_sub_f32 v42, v31, v33
    v_sub_f32 v49, v55, v57
    v_add_f32 v31, v31, v33
    v_add_f32 v55, v55, v57
    v_mul_f32 v33, 0xbec3ef15, v42
    v_mul_f32 v57, 0xbf6c835e, v42
    v_fmac_f32 v33, 0x3f6c835e, v49
    v_fmac_f32 v57, 0xbec3ef15, v49
    v_sub_f32 v42, v23, v25
    v_sub_f32 v49, v71, v73
    v_add_f32 v23, v23, v25
    v_add_f32 v71, v71, v73
    v_mul_f32 v25, 0xbf0e39da, v42
    v_mul_f32 v73, 0xbf54db31, v42
    v_fmac_f32 v25, 0x3f54db31, v49
    v_fmac_f32 v73, 0xbf0e39da, v49
    v_sub_f32 v42, v39, v41
    v_sub_f32 v49, v51, v53
    v_add_f32 v39, v39, v41
    v_add_f32 v51, v51, v53
    v_mul_f32 v41, 0xbf3504f3, v42
    v_mul_f32 v53, 0xbf3504f3, v42
    v_fmac_f32 v41, 0x3f3504f3, v49
    v_fmac_f32 v53, 0xbf3504f3, v49
    v_sub_f32 v42, v19, v21
    v_sub_f32 v49, v67, v69
    v_add_f32 v19, v19, v21
    v_add_f32 v67, v67, v69
    v_mul_f32 v21, 0xbf54db31, v42
    v_mul_f32 v69, 0xbf0e39da, v42
    v_fmac_f32 v21, 0x3f0e39da, v49
    v_fmac_f32 v69, 0xbf54db31, v49
    v_sub_f32 v42, v35, v37
    v_sub_f32 v49, v59, v61
    v_add_f32 v35, v35, v37
    v_add_f32 v59, v59, v61
    v_mul_f32 v37, 0xbf6c835e, v42
    v_mul_f32 v61, 0xbec3ef15, v42
    v_fmac_f32 v37, 0x3ec3ef15, v49
    v_fmac_f32 v61, 0xbf6c835e, v49
    v_sub_f32 v42, v27, v29
    v_sub_f32 v49, v75, v77
    v_add_f32 v27, v27, v29
    v_add_f32 v75, v75, v77
    v_mul_f32 v29, 0xbf7b14be, v42
    v_mul_f32 v77, 0xbe47c5c2, v42
    v_fmac_f32 v29, 0x3e47c5c2, v49
    v_fmac_f32 v77, 0xbf7b14be, v49
    v_sub_f32 v42, v16, v38
    v_sub_f32 v49, v48, v78
    v_add_f32 v16, v16, v38
    v_add_f32 v48, v48, v78
    v_sub_f32 v38, v83, v46
    v_sub_f32 v78, v81, v63
    v_add_f32 v83, v83, v46
    v_add_f32 v81, v81, v63
    v_mul_f32 v46, 0x3f6c835e, v38
    v_mul_f32 v63, 0xbec3ef15, v38
    v_fmac_f32 v46, 0x3ec3ef15, v78
    v_fmac_f32 v63, 0x3f6c835e, v78
    v_sub_f32 v38, v80, v31
    v_sub_f32 v78, v72, v55
    v_add_f32 v80, v80, v31
    v_add_f32 v72, v72, v55
    v_mul_f32 v31, 0x3f3504f3, v38
    v_mul_f32 v55, 0xbf3504f3, v38
    v_fmac_f32 v31, 0x3f3504f3, v78
    v_fmac_f32 v55, 0x3f3504f3, v78
    v_sub_f32 v38, v40, v23
    v_sub_f32 v78, v60, v71
    v_add_f32 v40, v40, v23
    v_add_f32 v60, v60, v71
    v_mul_f32 v23, 0x3ec3ef15, v38
    v_mul_f32 v71, 0xbf6c835e, v38
    v_fmac_f32 v23, 0x3f6c835e, v78
    v_fmac_f32 v71, 0x3ec3ef15, v78
    v_sub_f32 v38, v76, v51
    v_sub_f32 v78, v39, v28
    v_add_f32 v28, v28, v39
    v_add_f32 v76, v76, v51
    v_sub_f32 v39, v44, v19
    v_sub_f32 v51, v62, v67
    v_add_f32 v44, v44, v19
    v_add_f32 v62, v62, v67
    v_mul_f32 v19, 0xbec3ef15, v39
    v_mul_f32 v67, 0xbf6c835e, v39
    v_fmac_f32 v19, 0x3f6c835e, v51
    v_fmac_f32 v67, 0xbec3ef15, v51
    v_sub_f32 v39, v30, v35
    v_sub_f32 v51, v54, v59
    v_add_f32 v30, v30, v35
    v_add_f32 v54, v54, v59
    v_mul_f32 v35, 0xbf3504f3, v39
    v_mul_f32 v59, 0xbf3504f3, v39
    v_fmac_f32 v35, 0x3f3504f3, v51
    v_fmac_f32 v59, 0xbf3504f3, v51
    v_sub_f32 v39, v22, v27
    v_sub_f32 v51, v70, v75
    v_add_f32 v22, v22, v27
    v_add_f32 v70, v70, v75
    v_mul_f32 v27, 0xbf6c835e, v39
    v_mul_f32 v75, 0xbec3ef15, v39
    v_fmac_f32 v27, 0x3ec3ef15, v51
    v_fmac_f32 v75, 0xbf6c835e, v51
    v_sub_f32 v39, v32, v43
    v_sub_f32 v51, v64, v79
    v_add_f32 v32, v32, v43
    v_add_f32 v64, v64, v79
    v_sub_f32 v43, v47, v17
    v_sub_f32 v79, v56, v65
    v_add_f32 v47, v47, v17
    v_add_f32 v56, v56, v65
    v_mul_f32 v17, 0x3f6c835e, v43
    v_mul_f32 v65, 0xbec3ef15, v43
    v_fmac_f32 v17, 0x3ec3ef15, v79
    v_fmac_f32 v65, 0x3f6c835e, v79
    v_sub_f32 v43, v24, v33
    v_sub_f32 v79, v52, v57
    v_add_f32 v24, v24, v33
    v_add_f32 v52, v52, v57
    v_mul_f32 v33, 0x3f3504f3, v43
    v_mul_f32 v57, 0xbf3504f3, v43
    v_fmac_f32 v33, 0x3f3504f3, v79
    v_fmac_f32 v57, 0x3f3504f3, v79
    v_sub_f32 v43, v20, v25
    v_sub_f32 v79, v68, v73
    v_add_f32 v20, v20, v25
    v_add_f32 v68, v68, v73
    v_mul_f32 v25, 0x3ec3ef15, v43
    v_mul_f32 v73, 0xbf6c835e, v43
    v_fmac_f32 v25, 0x3f6c835e, v79
    v_fmac_f32 v73, 0x3ec3ef15, v79
    v_sub_f32 v43, v50, v53
    v_sub_f32 v79, v41, v36
    v_add_f32 v36, v36, v41
    v_add_f32 v50, v50, v53
    v_sub_f32 v41, v18, v21
    v_sub_f32 v53, v66, v69
    v_add_f32 v18, v18, v21
    v_add_f32 v66, v66, v69
    v_mul_f32 v21, 0xbec3ef15, v41
    v_mul_f32 v69, 0xbf6c835e, v41
    v_fmac_f32 v21, 0x3f6c835e, v53
    v_fmac_f32 v69, 0xbec3ef15, v53
    v_sub_f32 v41, v34, v37
    v_sub_f32 v53, v58, v61
    v_add_f32 v34, v34, v37
    v_add_f32 v58, v58, v61
    v_mul_f32 v37, 0xbf3504f3, v41
    v_mul_f32 v61, 0xbf3504f3, v41
    v_fmac_f32 v37, 0x3f3504f3, v53
    v_fmac_f32 v61, 0xbf3504f3, v53
    v_sub_f32 v41, v26, v29
    v_sub_f32 v53, v74, v77
    v_add_f32 v26, v26, v29
    v_add_f32 v74, v74, v77
    v_mul_f32 v29, 0xbf6c835e, v41
    v_mul_f32 v77, 0xbec3ef15, v41
    v_fmac_f32 v29, 0x3ec3ef15, v53
    v_fmac_f32 v77, 0xbf6c835e, v53
    v_sub_f32 v41, v16, v28
    v_sub_f32 v53, v48, v76
    v_add_f32 v16, v16, v28
    v_add_f32 v48, v48, v76
    v_sub_f32 v28, v83, v44
    v_sub_f32 v76, v81, v62
    v_add_f32 v83, v83, v44
    v_add_f32 v81, v81, v62
    v_mul_f32 v44, 0x3f3504f3, v28
    v_mul_f32 v62, 0xbf3504f3, v28
    v_fmac_f32 v44, 0x3f3504f3, v76
    v_fmac_f32 v62, 0x3f3504f3, v76
    v_sub_f32 v28, v72, v54
    v_sub_f32 v76, v30, v80
    v_add_f32 v80, v80, v30
    v_add_f32 v72, v72, v54
    v_sub_f32 v30, v40, v22
    v_sub_f32 v54, v60, v70
    v_add_f32 v40, v40, v22
    v_add_f32 v60, v60, v70
    v_mul_f32 v22, 0xbf3504f3, v30
    v_mul_f32 v70, 0xbf3504f3, v30
    v_fmac_f32 v22, 0x3f3504f3, v54
    v_fmac_f32 v70, 0xbf3504f3, v54
    v_sub_f32 v30, v42, v38
    v_sub_f32 v54, v49, v78
    v_add_f32 v42, v42, v38
    v_add_f32 v49, v49, v78
    v_sub_f32 v38, v46, v19
    v_sub_f32 v78, v63, v67
    v_add_f32 v46, v46, v19
    v_add_f32 v63, v63, v67
    v_mul_f32 v19, 0x3f3504f3, v38
    v_mul_f32 v67, 0xbf3504f3, v38
    v_fmac_f32 v19, 0x3f3504f3, v78
    v_fmac_f32 v67, 0x3f3504f3, v78
    v_sub_f32 v38, v55, v59
    v_sub_f32 v78, v35, v31
    v_add_f32 v31, v31, v35
    v_add_f32 v55, v55, v59
    v_sub_f32 v35, v23, v27
    v_sub_f32 v59, v71, v75
    v_add_f32 v23, v23, v27
    v_add_f32 v71, v71, v75
    v_mul_f32 v27, 0xbf3504f3, v35
    v_mul_f32 v75, 0xbf3504f3, v35
    v_fmac_f32 v27, 0x3f3504f3, v59
    v_fmac_f32 v75, 0xbf3504f3, v59
    v_sub_f32 v35, v32, v36
    v_sub_f32 v59, v64, v50
    v_add_f32 v32, v32, v36
    v_add_f32 v64, v64, v50
    v_sub_f32 v36, v47, v18
    v_sub_f32 v50, v56, v66
    v_add_f32 v47, v47, v18
    v_add_f32 v56, v56, v66
    v_mul_f32 v18, 0x3f3504f3, v36
    v_mul_f32 v66, 0xbf3504f3, v36
    v_fmac_f32 v18, 0x3f3504f3, v50
    v_fmac_f32 v66, 0x3f3504f3, v50
    v_sub_f32 v36, v52, v58
    v_sub_f32 v50, v34, v24
    v_add_f32 v24, v24, v34
    v_add_f32 v52, v52, v58
    v_sub_f32 v34, v20, v26
    v_sub_f32 v58, v68, v74
    v_add_f32 v20, v20, v26
    v_add_f32 v68, v68, v74
    v_mul_f32 v26, 0xbf3504f3, v34
    v_mul_f32 v74, 0xbf3504f3, v34
    v_fmac_f32 v26, 0x3f3504f3, v58
    v_fmac_f32 v74, 0xbf3504f3, v58
    v_sub_f32 v34, v39, v43
    v_sub_f32 v58, v51, v79
    v_add_f32 v39, v39, v43
    v_add_f32 v51, v51, v79
    v_sub_f32 v43, v17, v21
    v_sub_f32 v79, v65, v69
    v_add_f32 v17, v17, v21
    v_add_f32 v65, v65, v69
    v_mul_f32 v21, 0x3f3504f3, v43
    v_mul_f32 v69, 0xbf3504f3, v43
    v_fmac_f32 v21, 0x3f3504f3, v79
    v_fmac_f32 v69, 0x3f3504f3, v79
    v_sub_f32 v43, v57, v61
    v_sub_f32 v79, v37, v33
    v_add_f32 v33, v33, v37
    v_add_f32 v57, v57, v61
    v_sub_f32 v37, v25, v29
    v_sub_f32 v61, v73, v77
    v_add_f32 v25, v25, v29
    v_add_f32 v73, v73, v77
    v_mul_f32 v29, 0xbf3504f3, v37
    v_mul_f32 v77, 0xbf3504f3, v37
    v_fmac_f32 v29, 0x3f3504f3, v61
    v_fmac_f32 v77, 0xbf3504f3, v61
    v_sub_f32 v37, v16, v80
    v_sub_f32 v61, v48, v72
    v_add_f32 v16, v16, v80
    v_add_f32 v48, v48, v72
    v_sub_f32 v80, v81, v60
    v_sub_f32 v72, v40, v83
    v_add_f32 v83, v83, v40
    v_add_f32 v81, v81, v60
    v_sub_f32 v40, v41, v28
    v_sub_f32 v60, v53, v76
    v_add_f32 v41, v41, v28
    v_add_f32 v53, v53, v76
    v_sub_f32 v28, v62, v70
    v_sub_f32 v76, v22, v44
    v_add_f32 v44, v44, v22
    v_add_f32 v62, v62, v70
    v_sub_f32 v22, v42, v31
    v_sub_f32 v70, v49, v55
    v_add_f32 v42, v42, v31
    v_add_f32 v49, v49, v55
    v_sub_f32 v31, v63, v71
    v_sub_f32 v55, v23, v46
    v_add_f32 v46, v46, v23
    v_add_f32 v63, v63, v71
    v_sub_f32 v23, v30, v38
    v_sub_f32 v71, v54, v78
    v_add_f32 v30, v30, v38
    v_add_f32 v54, v54, v78
    v_sub_f32 v38, v67, v75
    v_sub_f32 v78, v27, v19
    v_add_f32 v19, v19, v27
    v_add_f32 v67, v67, v75
    v_sub_f32 v27, v32, v24
    v_sub_f32 v75, v64, v52
    v_add_f32 v32, v32, v24
    v_add_f32 v64, v64, v52
    v_sub_f32 v24, v56, v68
    v_sub_f32 v52, v20, v47
    v_add_f32 v47, v47, v20
    v_add_f32 v56, v56, v68
    v_sub_f32 v20, v35, v36
    v_sub_f32 v68, v59, v50
    v_add_f32 v35, v35, v36
    v_add_f32 v59, v59, v50
    v_sub_f32 v36, v66, v74
    v_sub_f32 v50, v26, v18
    v_add_f32 v18, v18, v26
    v_add_f32 v66, v66, v74
    v_sub_f32 v26, v39, v33
    v_sub_f32 v74, v51, v57
    v_add_f32 v39, v39, v33
    v_add_f32 v51, v51, v57
    v_sub_f32 v33, v65, v73
    v_sub_f32 v57, v25, v17
    v_add_f32 v17, v17, v25
    v_add_f32 v65, v65, v73
    v_sub_f32 v25, v34, v43
    v_sub_f32 v73, v58, v79
    v_add_f32 v34, v34, v43
    v_add_f32 v58, v58, v79
    v_sub_f32 v43, v69, v77
    v_sub_f32 v79, v29, v21
    v_add_f32 v21, v21, v29
    v_add_f32 v69, v69, v77
    v_sub_f32 v29, v16, v83
    v_sub_f32 v77, v48, v81
    v_add_f32 v16, v16, v83
    v_add_f32 v48, v48, v81
    v_sub_f32 v83, v37, v80
    v_sub_f32 v81, v61, v72
    v_add_f32 v37, v37, v80
    v_add_f32 v61, v61, v72
    v_sub_f32 v80, v41, v44
    v_sub_f32 v72, v53, v62
    v_add_f32 v41, v41, v44
    v_add_f32 v53, v53, v62
    v_sub_f32 v44, v40, v28
    v_sub_f32 v62, v60, v76
    v_add_f32 v40, v40, v28
    v_add_f32 v60, v60, v76
    v_sub_f32 v28, v42, v46
    v_sub_f32 v76, v49, v63
    v_add_f32 v42, v42, v46
    v_add_f32 v49, v49, v63
    v_sub_f32 v46, v22, v31
    v_sub_f32 v63, v70, v55
    v_add_f32 v22, v22, v31
    v_add_f32 v70, v70, v55
    v_sub_f32 v31, v30, v19
    v_sub_f32 v55, v54, v67
    v_add_f32 v30, v30, v19
    v_add_f32 v54, v54, v67
    v_sub_f32 v19, v23, v38
    v_sub_f32 v67, v71, v78
    v_add_f32 v23, v23, v38
    v_add_f32 v71, v71, v78
    v_sub_f32 v38, v32, v47
    v_sub_f32 v78, v64, v56
    v_add_f32 v32, v32, v47
    v_add_f32 v64, v64, v56
    v_sub_f32 v47, v27, v24
    v_sub_f32 v56, v75, v52
    v_add_f32 v27, v27, v24
    v_add_f32 v75, v75, v52
    v_sub_f32 v24, v35, v18
    v_sub_f32 v52, v59, v66
    v_add_f32 v35, v35, v18
    v_add_f32 v59, v59, v66
    v_sub_f32 v18, v20, v36
    v_sub_f32 v66, v68, v50
    v_add_f32 v20, v20, v36
    v_add_f32 v68, v68, v50
    v_sub_f32 v36, v39, v17
    v_sub_f32 v50, v51, v65
    v_add_f32 v39, v39, v17
    v_add_f32 v51, v51, v65
    v_sub_f32 v17, v26, v33
    v_sub_f32 v65, v74, v57
    v_add_f32 v26, v26, v33
    v_add_f32 v74, v74, v57
    v_sub_f32 v33, v34, v21
    v_sub_f32 v57, v58, v69
    v_add_f32 v34, v34, v21
    v_add_f32 v58, v58, v69
    v_sub_f32 v21, v25, v43
    v_sub_f32 v69, v73, v79
    v_add_f32 v25, v25, v43
    v_add_f32 v73, v73, v79
    ds_write_b32 v4, v16 offset:0
    ds_write_b32 v4, v48 offset:4
    ds_write_b32 v4, v32 offset:256
    ds_write_b32 v4, v64 offset:260
    ds_write_b32 v4, v42 offset:512
    ds_write_b32 v4, v49 offset:516
    ds_write_b32 v4, v39 offset:768
    ds_write_b32 v4, v51 offset:772
    ds_write_b32 v4, v41 offset:1024
    ds_write_b32 v4, v53 offset:1028
    ds_write_b32 v4, v35 offset:1280
    ds_write_b32 v4, v59 offset:1284
    ds_write_b32 v4, v30 offset:1536
    ds_write_b32 v4, v54 offset:1540
    ds_write_b32 v4, v34 offset:1792
    ds_write_b32 v4, v58 offset:1796
    ds_write_b32 v4, v37 offset:2048
    ds_write_b32 v4, v61 offset:2052
    ds_write_b32 v4, v27 offset:2304
    ds_write_b32 v4, v75 offset:2308
    ds_write_b32 v4, v22 offset:2560
    ds_write_b32 v4, v70 offset:2564
    ds_write_b32 v4, v26 offset:2816
    ds_write_b32 v4, v74 offset:2820
    ds_write_b32 v4, v40 offset:3072
    ds_write_b32 v4, v60 offset:3076
    ds_write_b32 v4, v20 offset:3328
    ds_write_b32 v4, v68 offset:3332
    ds_write_b32 v4, v23 offset:3584
    ds_write_b32 v4, v71 offset:3588
    ds_write_b32 v4, v25 offset:3840
    ds_write_b32 v4, v73 offset:3844
    ds_write_b32 v4, v29 offset:4096
    ds_write_b32 v4, v77 offset:4100
    ds_write_b32 v4, v38 offset:4352
    ds_write_b32 v4, v78 offset:4356
    ds_write_b32 v4, v28 offset:4608
    ds_write_b32 v4, v76 offset:4612
    ds_write_b32 v4, v36 offset:4864
    ds_write_b32 v4, v50 offset:4868
    ds_write_b32 v4, v80 offset:5120
    ds_write_b32 v4, v72 offset:5124
    ds_write_b32 v4, v24 offset:5376
    ds_write_b32 v4, v52 offset:5380
    ds_write_b32 v4, v31 offset:5632
    ds_write_b32 v4, v55 offset:5636
    ds_write_b32 v4, v33 offset:5888
    ds_write_b32 v4, v57 offset:5892
    ds_write_b32 v4, v83 offset:6144
    ds_write_b32 v4, v81 offset:6148
    ds_write_b32 v4, v47 offset:6400
    ds_write_b32 v4, v56 offset:6404
    ds_write_b32 v4, v46 offset:6656
    ds_write_b32 v4, v63 offset:6660
    ds_write_b32 v4, v17 offset:6912
    ds_write_b32 v4, v65 offset:6916
    ds_write_b32 v4, v44 offset:7168
    ds_write_b32 v4, v62 offset:7172
    ds_write_b32 v4, v18 offset:7424
    ds_write_b32 v4, v66 offset:7428
    ds_write_b32 v4, v19 offset:7680
    ds_write_b32 v4, v67 offset:7684
    ds_write_b32 v4, v21 offset:7936
    ds_write_b32 v4, v69 offset:7940
    s_waitcnt lgkmcnt(0)
    s_barrier
    v_and_b32 v6, 7, v0
    v_lshrrev_b32 v7, 3, v0
    s_movk_i32 s13, 8448
    v_mul_lo_u32 v8, v6, s13
    v_lshl_add_u32 v4, v7, 3, v8
    v_lshlrev_b32 v5, 14, v7
    v_lshl_add_u32 v5, v6, 4, v5
    s_lshl_b32 s12, s92, 7
    s_add_u32 s12, s12, 96468992
    v_sub_u32 v6, 1024, v7
    v_and_b32 v6, 1023, v6
    v_lshl_add_u32 v6, v6, 3, v8
    ds_read_b64 v[16:17], v4 offset:0
    ds_read_b64 v[18:19], v6
    s_waitcnt lgkmcnt(0)
    v_add_f32 v20, v16, v18
    v_sub_f32 v21, v17, v19
    v_add_f32 v22, v17, v19
    v_sub_f32 v23, v18, v16
    s_mov_b32 s13, s12
    s_add_u32 s13, s12, 0
    buffer_store_dwordx4 v[20:23], v5, s[8:11], s13 offen sc1
    s_nop 1
    v_sub_u32 v6, 992, v7
    v_and_b32 v6, 1023, v6
    v_lshl_add_u32 v6, v6, 3, v8
    ds_read_b64 v[16:17], v4 offset:256
    ds_read_b64 v[18:19], v6
    s_waitcnt lgkmcnt(0)
    v_add_f32 v20, v16, v18
    v_sub_f32 v21, v17, v19
    v_add_f32 v22, v17, v19
    v_sub_f32 v23, v18, v16
    s_mov_b32 s13, s12
    s_add_u32 s13, s12, 524288
    buffer_store_dwordx4 v[20:23], v5, s[8:11], s13 offen sc1
    s_nop 1
    v_sub_u32 v6, 960, v7
    v_and_b32 v6, 1023, v6
    v_lshl_add_u32 v6, v6, 3, v8
    ds_read_b64 v[16:17], v4 offset:512
    ds_read_b64 v[18:19], v6
    s_waitcnt lgkmcnt(0)
    v_add_f32 v20, v16, v18
    v_sub_f32 v21, v17, v19
    v_add_f32 v22, v17, v19
    v_sub_f32 v23, v18, v16
    s_mov_b32 s13, s12
    s_add_u32 s13, s12, 1048576
    buffer_store_dwordx4 v[20:23], v5, s[8:11], s13 offen sc1
    s_nop 1
    v_sub_u32 v6, 928, v7
    v_and_b32 v6, 1023, v6
    v_lshl_add_u32 v6, v6, 3, v8
    ds_read_b64 v[16:17], v4 offset:768
    ds_read_b64 v[18:19], v6
    s_waitcnt lgkmcnt(0)
    v_add_f32 v20, v16, v18
    v_sub_f32 v21, v17, v19
    v_add_f32 v22, v17, v19
    v_sub_f32 v23, v18, v16
    s_mov_b32 s13, s12
    s_add_u32 s13, s12, 1572864
    buffer_store_dwordx4 v[20:23], v5, s[8:11], s13 offen sc1
    s_nop 1
    v_sub_u32 v6, 896, v7
    v_and_b32 v6, 1023, v6
    v_lshl_add_u32 v6, v6, 3, v8
    ds_read_b64 v[16:17], v4 offset:1024
    ds_read_b64 v[18:19], v6
    s_waitcnt lgkmcnt(0)
    v_add_f32 v20, v16, v18
    v_sub_f32 v21, v17, v19
    v_add_f32 v22, v17, v19
    v_sub_f32 v23, v18, v16
    s_mov_b32 s13, s12
    s_add_u32 s13, s12, 2097152
    buffer_store_dwordx4 v[20:23], v5, s[8:11], s13 offen sc1
    s_nop 1
    v_sub_u32 v6, 864, v7
    v_and_b32 v6, 1023, v6
    v_lshl_add_u32 v6, v6, 3, v8
    ds_read_b64 v[16:17], v4 offset:1280
    ds_read_b64 v[18:19], v6
    s_waitcnt lgkmcnt(0)
    v_add_f32 v20, v16, v18
    v_sub_f32 v21, v17, v19
    v_add_f32 v22, v17, v19
    v_sub_f32 v23, v18, v16
    s_mov_b32 s13, s12
    s_add_u32 s13, s12, 2621440
    buffer_store_dwordx4 v[20:23], v5, s[8:11], s13 offen sc1
    s_nop 1
    v_sub_u32 v6, 832, v7
    v_and_b32 v6, 1023, v6
    v_lshl_add_u32 v6, v6, 3, v8
    ds_read_b64 v[16:17], v4 offset:1536
    ds_read_b64 v[18:19], v6
    s_waitcnt lgkmcnt(0)
    v_add_f32 v20, v16, v18
    v_sub_f32 v21, v17, v19
    v_add_f32 v22, v17, v19
    v_sub_f32 v23, v18, v16
    s_mov_b32 s13, s12
    s_add_u32 s13, s12, 3145728
    buffer_store_dwordx4 v[20:23], v5, s[8:11], s13 offen sc1
    s_nop 1
    v_sub_u32 v6, 800, v7
    v_and_b32 v6, 1023, v6
    v_lshl_add_u32 v6, v6, 3, v8
    ds_read_b64 v[16:17], v4 offset:1792
    ds_read_b64 v[18:19], v6
    s_waitcnt lgkmcnt(0)
    v_add_f32 v20, v16, v18
    v_sub_f32 v21, v17, v19
    v_add_f32 v22, v17, v19
    v_sub_f32 v23, v18, v16
    s_mov_b32 s13, s12
    s_add_u32 s13, s12, 3670016
    buffer_store_dwordx4 v[20:23], v5, s[8:11], s13 offen sc1
    s_nop 1
    v_sub_u32 v6, 768, v7
    v_and_b32 v6, 1023, v6
    v_lshl_add_u32 v6, v6, 3, v8
    ds_read_b64 v[16:17], v4 offset:2048
    ds_read_b64 v[18:19], v6
    s_waitcnt lgkmcnt(0)
    v_add_f32 v20, v16, v18
    v_sub_f32 v21, v17, v19
    v_add_f32 v22, v17, v19
    v_sub_f32 v23, v18, v16
    s_mov_b32 s13, s12
    s_add_u32 s13, s12, 4194304
    buffer_store_dwordx4 v[20:23], v5, s[8:11], s13 offen sc1
    s_nop 1
    v_sub_u32 v6, 736, v7
    v_and_b32 v6, 1023, v6
    v_lshl_add_u32 v6, v6, 3, v8
    ds_read_b64 v[16:17], v4 offset:2304
    ds_read_b64 v[18:19], v6
    s_waitcnt lgkmcnt(0)
    v_add_f32 v20, v16, v18
    v_sub_f32 v21, v17, v19
    v_add_f32 v22, v17, v19
    v_sub_f32 v23, v18, v16
    s_mov_b32 s13, s12
    s_add_u32 s13, s12, 4718592
    buffer_store_dwordx4 v[20:23], v5, s[8:11], s13 offen sc1
    s_nop 1
    v_sub_u32 v6, 704, v7
    v_and_b32 v6, 1023, v6
    v_lshl_add_u32 v6, v6, 3, v8
    ds_read_b64 v[16:17], v4 offset:2560
    ds_read_b64 v[18:19], v6
    s_waitcnt lgkmcnt(0)
    v_add_f32 v20, v16, v18
    v_sub_f32 v21, v17, v19
    v_add_f32 v22, v17, v19
    v_sub_f32 v23, v18, v16
    s_mov_b32 s13, s12
    s_add_u32 s13, s12, 5242880
    buffer_store_dwordx4 v[20:23], v5, s[8:11], s13 offen sc1
    s_nop 1
    v_sub_u32 v6, 672, v7
    v_and_b32 v6, 1023, v6
    v_lshl_add_u32 v6, v6, 3, v8
    ds_read_b64 v[16:17], v4 offset:2816
    ds_read_b64 v[18:19], v6
    s_waitcnt lgkmcnt(0)
    v_add_f32 v20, v16, v18
    v_sub_f32 v21, v17, v19
    v_add_f32 v22, v17, v19
    v_sub_f32 v23, v18, v16
    s_mov_b32 s13, s12
    s_add_u32 s13, s12, 5767168
    buffer_store_dwordx4 v[20:23], v5, s[8:11], s13 offen sc1
    s_nop 1
    v_sub_u32 v6, 640, v7
    v_and_b32 v6, 1023, v6
    v_lshl_add_u32 v6, v6, 3, v8
    ds_read_b64 v[16:17], v4 offset:3072
    ds_read_b64 v[18:19], v6
    s_waitcnt lgkmcnt(0)
    v_add_f32 v20, v16, v18
    v_sub_f32 v21, v17, v19
    v_add_f32 v22, v17, v19
    v_sub_f32 v23, v18, v16
    s_mov_b32 s13, s12
    s_add_u32 s13, s12, 6291456
    buffer_store_dwordx4 v[20:23], v5, s[8:11], s13 offen sc1
    s_nop 1
    v_sub_u32 v6, 608, v7
    v_and_b32 v6, 1023, v6
    v_lshl_add_u32 v6, v6, 3, v8
    ds_read_b64 v[16:17], v4 offset:3328
    ds_read_b64 v[18:19], v6
    s_waitcnt lgkmcnt(0)
    v_add_f32 v20, v16, v18
    v_sub_f32 v21, v17, v19
    v_add_f32 v22, v17, v19
    v_sub_f32 v23, v18, v16
    s_mov_b32 s13, s12
    s_add_u32 s13, s12, 6815744
    buffer_store_dwordx4 v[20:23], v5, s[8:11], s13 offen sc1
    s_nop 1
    v_sub_u32 v6, 576, v7
    v_and_b32 v6, 1023, v6
    v_lshl_add_u32 v6, v6, 3, v8
    ds_read_b64 v[16:17], v4 offset:3584
    ds_read_b64 v[18:19], v6
    s_waitcnt lgkmcnt(0)
    v_add_f32 v20, v16, v18
    v_sub_f32 v21, v17, v19
    v_add_f32 v22, v17, v19
    v_sub_f32 v23, v18, v16
    s_mov_b32 s13, s12
    s_add_u32 s13, s12, 7340032
    buffer_store_dwordx4 v[20:23], v5, s[8:11], s13 offen sc1
    s_nop 1
    v_sub_u32 v6, 544, v7
    v_and_b32 v6, 1023, v6
    v_lshl_add_u32 v6, v6, 3, v8
    ds_read_b64 v[16:17], v4 offset:3840
    ds_read_b64 v[18:19], v6
    s_waitcnt lgkmcnt(0)
    v_add_f32 v20, v16, v18
    v_sub_f32 v21, v17, v19
    v_add_f32 v22, v17, v19
    v_sub_f32 v23, v18, v16
    s_mov_b32 s13, s12
    s_add_u32 s13, s12, 7864320
    buffer_store_dwordx4 v[20:23], v5, s[8:11], s13 offen sc1
    s_nop 1
    v_sub_u32 v6, 512, v7
    v_and_b32 v6, 1023, v6
    v_lshl_add_u32 v6, v6, 3, v8
    ds_read_b64 v[16:17], v4 offset:4096
    ds_read_b64 v[18:19], v6
    s_waitcnt lgkmcnt(0)
    v_add_f32 v20, v16, v18
    v_sub_f32 v21, v17, v19
    v_add_f32 v22, v17, v19
    v_sub_f32 v23, v18, v16
    s_mov_b32 s13, s12
    v_cmp_eq_u32 vcc, 0, v7
    s_and_saveexec_b64 s[14:15], vcc
    s_add_u32 s13, s12, 8388608
    buffer_store_dwordx4 v[20:23], v5, s[8:11], s13 offen sc1
    s_nop 1
    s_mov_b64 exec, -1
mega_kernel_f1d:
    s_waitcnt vmcnt(0)
    s_barrier
    v_mov_b32 v2, 1
    v_cmp_eq_u32 vcc, 0, v0
    s_and_saveexec_b64 s[80:81], vcc
    s_cbranch_execz mega_kernel_sg72_4
    buffer_atomic_add v2, off, s[88:91], 0 offset:72 sc1
mega_kernel_sg72_4:
    s_mov_b64 exec, s[80:81]
    s_cmp_ge_u32 s92, 128
    s_cbranch_scc1 mega_kernel_xo
mega_kernel_wf1:
    s_sleep 8
    buffer_load_dword v2, off, s[88:91], 0 offset:72 sc1
    s_waitcnt vmcnt(0)
    v_cmp_ne_u32 vcc, 192, v2
    s_cbranch_vccnz mega_kernel_wf1
    s_mov_b32 s99, s92
    s_barrier
mega_kernel_f2_in:
    s_load_dwordx2 s[8:9], s[0:1], 96
    v_lshrrev_b32 v5, 6, v0
    v_and_b32 v1, 63, v0
    v_readfirstlane_b32 s12, v5
    s_lshl_b32 s13, s99, 2
    s_add_u32 s13, s13, s12
    s_cmp_ge_u32 s13, 513
    s_cbranch_scc1 mega_kernel_f2_end
    v_cvt_f32_u32 v2, v1
    s_waitcnt lgkmcnt(0)
    s_mov_b32 s10, 268435456
    s_mov_b32 s11, 0x00020000
    s_lshl_b32 s14, s13, 14
    s_add_u32 s15, s14, 96468992
    v_lshlrev_b32 v5, 3, v1
    s_add_u32 s16, s15, 0
    buffer_load_dwordx2 v[16:17], v5, s[8:11], s16 offen
    s_add_u32 s16, s15, 512
    buffer_load_dwordx2 v[18:19], v5, s[8:11], s16 offen
    s_add_u32 s16, s15, 1024
    buffer_load_dwordx2 v[20:21], v5, s[8:11], s16 offen
    s_add_u32 s16, s15, 1536
    buffer_load_dwordx2 v[22:23], v5, s[8:11], s16 offen
    s_add_u32 s16, s15, 2048
    buffer_load_dwordx2 v[24:25], v5, s[8:11], s16 offen
    s_add_u32 s16, s15, 2560
    buffer_load_dwordx2 v[26:27], v5, s[8:11], s16 offen
    s_add_u32 s16, s15, 3072
    buffer_load_dwordx2 v[28:29], v5, s[8:11], s16 offen
    s_add_u32 s16, s15, 3584
    buffer_load_dwordx2 v[30:31], v5, s[8:11], s16 offen
    s_add_u32 s16, s15, 4096
    buffer_load_dwordx2 v[32:33], v5, s[8:11], s16 offen
    s_add_u32 s16, s15, 4608
    buffer_load_dwordx2 v[34:35], v5, s[8:11], s16 offen
    s_add_u32 s16, s15, 5120
    buffer_load_dwordx2 v[36:37], v5, s[8:11], s16 offen
    s_add_u32 s16, s15, 5632
    buffer_load_dwordx2 v[38:39], v5, s[8:11], s16 offen
    s_add_u32 s16, s15, 6144
    buffer_load_dwordx2 v[40:41], v5, s[8:11], s16 offen
    s_add_u32 s16, s15, 6656
    buffer_load_dwordx2 v[42:43], v5, s[8:11], s16 offen
    s_add_u32 s16, s15, 7168
    buffer_load_dwordx2 v[44:45], v5, s[8:11], s16 offen
    s_add_u32 s16, s15, 7680
    buffer_load_dwordx2 v[46:47], v5, s[8:11], s16 offen
    s_add_u32 s16, s15, 8192
    buffer_load_dwordx2 v[48:49], v5, s[8:11], s16 offen
    s_add_u32 s16, s15, 8704
    buffer_load_dwordx2 v[50:51], v5, s[8:11], s16 offen
    s_add_u32 s16, s15, 9216
    buffer_load_dwordx2 v[52:53], v5, s[8:11], s16 offen
    s_add_u32 s16, s15, 9728
    buffer_load_dwordx2 v[54:55], v5, s[8:11], s16 offen
    s_add_u32 s16, s15, 10240
    buffer_load_dwordx2 v[56:57], v5, s[8:11], s16 offen
    s_add_u32 s16, s15, 10752
    buffer_load_dwordx2 v[58:59], v5, s[8:11], s16 offen
    s_add_u32 s16, s15, 11264
    buffer_load_dwordx2 v[60:61], v5, s[8:11], s16 offen
    s_add_u32 s16, s15, 11776
    buffer_load_dwordx2 v[62:63], v5, s[8:11], s16 offen
    s_add_u32 s16, s15, 12288
    buffer_load_dwordx2 v[64:65], v5, s[8:11], s16 offen
    s_add_u32 s16, s15, 12800
    buffer_load_dwordx2 v[66:67], v5, s[8:11], s16 offen
    s_add_u32 s16, s15, 13312
    buffer_load_dwordx2 v[68:69], v5, s[8:11], s16 offen
    s_add_u32 s16, s15, 13824
    buffer_load_dwordx2 v[70:71], v5, s[8:11], s16 offen
    s_add_u32 s16, s15, 14336
    buffer_load_dwordx2 v[72:73], v5, s[8:11], s16 offen
    s_add_u32 s16, s15, 14848
    buffer_load_dwordx2 v[74:75], v5, s[8:11], s16 offen
    s_add_u32 s16, s15, 15360
    buffer_load_dwordx2 v[76:77], v5, s[8:11], s16 offen
    s_add_u32 s16, s15, 15872
    buffer_load_dwordx2 v[78:79], v5, s[8:11], s16 offen
    s_mul_i32 s17, s12, 16896
    v_lshlrev_b32 v3, 3, v1
    v_add_u32 v3, s17, v3
    v_and_b32 v7, 1, v1
    v_lshrrev_b32 v6, 1, v1
    v_cvt_f32_u32 v8, v6
    v_cvt_f32_u32 v10, v7
    s_movk_i32 s18, 528
    v_mul_lo_u32 v4, v6, s18
    v_lshl_add_u32 v4, v7, 3, v4
    v_add_u32 v4, s17, v4
    v_mov_b32 v9, 1.0
    v_fma_f32 v9, v10, -2.0, v9
    v_lshlrev_b32 v5, 12, v7
    v_lshl_add_u32 v11, v6, 2, v5
    s_lshl_b32 s19, s13, 13
    s_add_u32 s19, s19, 121634816
    s_waitcnt vmcnt(0)
    v_sub_f32 v80, v16, v48
    v_sub_f32 v81, v17, v49
    v_add_f32 v16, v16, v48
    v_add_f32 v17, v17, v49
    v_sub_f32 v48, v18, v50
    v_sub_f32 v49, v19, v51
    v_add_f32 v18, v18, v50
    v_add_f32 v19, v19, v51
    v_mul_f32 v50, 0x3f7b14be, v48
    v_mul_f32 v51, 0xbe47c5c2, v48
    v_fmac_f32 v50, 0x3e47c5c2, v49
    v_fmac_f32 v51, 0x3f7b14be, v49
    v_sub_f32 v48, v20, v52
    v_sub_f32 v49, v21, v53
    v_add_f32 v20, v20, v52
    v_add_f32 v21, v21, v53
    v_mul_f32 v52, 0x3f6c835e, v48
    v_mul_f32 v53, 0xbec3ef15, v48
    v_fmac_f32 v52, 0x3ec3ef15, v49
    v_fmac_f32 v53, 0x3f6c835e, v49
    v_sub_f32 v48, v22, v54
    v_sub_f32 v49, v23, v55
    v_add_f32 v22, v22, v54
    v_add_f32 v23, v23, v55
    v_mul_f32 v54, 0x3f54db31, v48
    v_mul_f32 v55, 0xbf0e39da, v48
    v_fmac_f32 v54, 0x3f0e39da, v49
    v_fmac_f32 v55, 0x3f54db31, v49
    v_sub_f32 v48, v24, v56
    v_sub_f32 v49, v25, v57
    v_add_f32 v24, v24, v56
    v_add_f32 v25, v25, v57
    v_mul_f32 v56, 0x3f3504f3, v48
    v_mul_f32 v57, 0xbf3504f3, v48
    v_fmac_f32 v56, 0x3f3504f3, v49
    v_fmac_f32 v57, 0x3f3504f3, v49
    v_sub_f32 v48, v26, v58
    v_sub_f32 v49, v27, v59
    v_add_f32 v26, v26, v58
    v_add_f32 v27, v27, v59
    v_mul_f32 v58, 0x3f0e39da, v48
    v_mul_f32 v59, 0xbf54db31, v48
    v_fmac_f32 v58, 0x3f54db31, v49
    v_fmac_f32 v59, 0x3f0e39da, v49
    v_sub_f32 v48, v28, v60
    v_sub_f32 v49, v29, v61
    v_add_f32 v28, v28, v60
    v_add_f32 v29, v29, v61
    v_mul_f32 v60, 0x3ec3ef15, v48
    v_mul_f32 v61, 0xbf6c835e, v48
    v_fmac_f32 v60, 0x3f6c835e, v49
    v_fmac_f32 v61, 0x3ec3ef15, v49
    v_sub_f32 v48, v30, v62
    v_sub_f32 v49, v31, v63
    v_add_f32 v30, v30, v62
    v_add_f32 v31, v31, v63
    v_mul_f32 v62, 0x3e47c5c2, v48
    v_mul_f32 v63, 0xbf7b14be, v48
    v_fmac_f32 v62, 0x3f7b14be, v49
    v_fmac_f32 v63, 0x3e47c5c2, v49
    v_sub_f32 v48, v33, v65
    v_sub_f32 v49, v64, v32
    v_add_f32 v32, v32, v64
    v_add_f32 v33, v33, v65
    v_sub_f32 v64, v34, v66
    v_sub_f32 v65, v35, v67
    v_add_f32 v34, v34, v66
    v_add_f32 v35, v35, v67
    v_mul_f32 v66, 0xbe47c5c2, v64
    v_mul_f32 v67, 0xbf7b14be, v64
    v_fmac_f32 v66, 0x3f7b14be, v65
    v_fmac_f32 v67, 0xbe47c5c2, v65
    v_sub_f32 v64, v36, v68
    v_sub_f32 v65, v37, v69
    v_add_f32 v36, v36, v68
    v_add_f32 v37, v37, v69
    v_mul_f32 v68, 0xbec3ef15, v64
    v_mul_f32 v69, 0xbf6c835e, v64
    v_fmac_f32 v68, 0x3f6c835e, v65
    v_fmac_f32 v69, 0xbec3ef15, v65
    v_sub_f32 v64, v38, v70
    v_sub_f32 v65, v39, v71
    v_add_f32 v38, v38, v70
    v_add_f32 v39, v39, v71
    v_mul_f32 v70, 0xbf0e39da, v64
    v_mul_f32 v71, 0xbf54db31, v64
    v_fmac_f32 v70, 0x3f54db31, v65
    v_fmac_f32 v71, 0xbf0e39da, v65
    v_sub_f32 v64, v40, v72
    v_sub_f32 v65, v41, v73
    v_add_f32 v40, v40, v72
    v_add_f32 v41, v41, v73
    v_mul_f32 v72, 0xbf3504f3, v64
    v_mul_f32 v73, 0xbf3504f3, v64
    v_fmac_f32 v72, 0x3f3504f3, v65
    v_fmac_f32 v73, 0xbf3504f3, v65
    v_sub_f32 v64, v42, v74
    v_sub_f32 v65, v43, v75
    v_add_f32 v42, v42, v74
    v_add_f32 v43, v43, v75
    v_mul_f32 v74, 0xbf54db31, v64
    v_mul_f32 v75, 0xbf0e39da, v64
    v_fmac_f32 v74, 0x3f0e39da, v65
    v_fmac_f32 v75, 0xbf54db31, v65
    v_sub_f32 v64, v44, v76
    v_sub_f32 v65, v45, v77
    v_add_f32 v44, v44, v76
    v_add_f32 v45, v45, v77
    v_mul_f32 v76, 0xbf6c835e, v64
    v_mul_f32 v77, 0xbec3ef15, v64
    v_fmac_f32 v76, 0x3ec3ef15, v65
    v_fmac_f32 v77, 0xbf6c835e, v65
    v_sub_f32 v64, v46, v78
    v_sub_f32 v65, v47, v79
    v_add_f32 v46, v46, v78
    v_add_f32 v47, v47, v79
    v_mul_f32 v78, 0xbf7b14be, v64
    v_mul_f32 v79, 0xbe47c5c2, v64
    v_fmac_f32 v78, 0x3e47c5c2, v65
    v_fmac_f32 v79, 0xbf7b14be, v65
    v_sub_f32 v64, v16, v32
    v_sub_f32 v65, v17, v33
    v_add_f32 v16, v16, v32
    v_add_f32 v17, v17, v33
    v_sub_f32 v32, v18, v34
    v_sub_f32 v33, v19, v35
    v_add_f32 v18, v18, v34
    v_add_f32 v19, v19, v35
    v_mul_f32 v34, 0x3f6c835e, v32
    v_mul_f32 v35, 0xbec3ef15, v32
    v_fmac_f32 v34, 0x3ec3ef15, v33
    v_fmac_f32 v35, 0x3f6c835e, v33
    v_sub_f32 v32, v20, v36
    v_sub_f32 v33, v21, v37
    v_add_f32 v20, v20, v36
    v_add_f32 v21, v21, v37
    v_mul_f32 v36, 0x3f3504f3, v32
    v_mul_f32 v37, 0xbf3504f3, v32
    v_fmac_f32 v36, 0x3f3504f3, v33
    v_fmac_f32 v37, 0x3f3504f3, v33
    v_sub_f32 v32, v22, v38
    v_sub_f32 v33, v23, v39
    v_add_f32 v22, v22, v38
    v_add_f32 v23, v23, v39
    v_mul_f32 v38, 0x3ec3ef15, v32
    v_mul_f32 v39, 0xbf6c835e, v32
    v_fmac_f32 v38, 0x3f6c835e, v33
    v_fmac_f32 v39, 0x3ec3ef15, v33
    v_sub_f32 v32, v25, v41
    v_sub_f32 v33, v40, v24
    v_add_f32 v24, v24, v40
    v_add_f32 v25, v25, v41
    v_sub_f32 v40, v26, v42
    v_sub_f32 v41, v27, v43
    v_add_f32 v26, v26, v42
    v_add_f32 v27, v27, v43
    v_mul_f32 v42, 0xbec3ef15, v40
    v_mul_f32 v43, 0xbf6c835e, v40
    v_fmac_f32 v42, 0x3f6c835e, v41
    v_fmac_f32 v43, 0xbec3ef15, v41
    v_sub_f32 v40, v28, v44
    v_sub_f32 v41, v29, v45
    v_add_f32 v28, v28, v44
    v_add_f32 v29, v29, v45
    v_mul_f32 v44, 0xbf3504f3, v40
    v_mul_f32 v45, 0xbf3504f3, v40
    v_fmac_f32 v44, 0x3f3504f3, v41
    v_fmac_f32 v45, 0xbf3504f3, v41
    v_sub_f32 v40, v30, v46
    v_sub_f32 v41, v31, v47
    v_add_f32 v30, v30, v46
    v_add_f32 v31, v31, v47
    v_mul_f32 v46, 0xbf6c835e, v40
    v_mul_f32 v47, 0xbec3ef15, v40
    v_fmac_f32 v46, 0x3ec3ef15, v41
    v_fmac_f32 v47, 0xbf6c835e, v41
    v_sub_f32 v40, v80, v48
    v_sub_f32 v41, v81, v49
    v_add_f32 v80, v80, v48
    v_add_f32 v81, v81, v49
    v_sub_f32 v48, v50, v66
    v_sub_f32 v49, v51, v67
    v_add_f32 v50, v50, v66
    v_add_f32 v51, v51, v67
    v_mul_f32 v66, 0x3f6c835e, v48
    v_mul_f32 v67, 0xbec3ef15, v48
    v_fmac_f32 v66, 0x3ec3ef15, v49
    v_fmac_f32 v67, 0x3f6c835e, v49
    v_sub_f32 v48, v52, v68
    v_sub_f32 v49, v53, v69
    v_add_f32 v52, v52, v68
    v_add_f32 v53, v53, v69
    v_mul_f32 v68, 0x3f3504f3, v48
    v_mul_f32 v69, 0xbf3504f3, v48
    v_fmac_f32 v68, 0x3f3504f3, v49
    v_fmac_f32 v69, 0x3f3504f3, v49
    v_sub_f32 v48, v54, v70
    v_sub_f32 v49, v55, v71
    v_add_f32 v54, v54, v70
    v_add_f32 v55, v55, v71
    v_mul_f32 v70, 0x3ec3ef15, v48
    v_mul_f32 v71, 0xbf6c835e, v48
    v_fmac_f32 v70, 0x3f6c835e, v49
    v_fmac_f32 v71, 0x3ec3ef15, v49
    v_sub_f32 v48, v57, v73
    v_sub_f32 v49, v72, v56
    v_add_f32 v56, v56, v72
    v_add_f32 v57, v57, v73
    v_sub_f32 v72, v58, v74
    v_sub_f32 v73, v59, v75
    v_add_f32 v58, v58, v74
    v_add_f32 v59, v59, v75
    v_mul_f32 v74, 0xbec3ef15, v72
    v_mul_f32 v75, 0xbf6c835e, v72
    v_fmac_f32 v74, 0x3f6c835e, v73
    v_fmac_f32 v75, 0xbec3ef15, v73
    v_sub_f32 v72, v60, v76
    v_sub_f32 v73, v61, v77
    v_add_f32 v60, v60, v76
    v_add_f32 v61, v61, v77
    v_mul_f32 v76, 0xbf3504f3, v72
    v_mul_f32 v77, 0xbf3504f3, v72
    v_fmac_f32 v76, 0x3f3504f3, v73
    v_fmac_f32 v77, 0xbf3504f3, v73
    v_sub_f32 v72, v62, v78
    v_sub_f32 v73, v63, v79
    v_add_f32 v62, v62, v78
    v_add_f32 v63, v63, v79
    v_mul_f32 v78, 0xbf6c835e, v72
    v_mul_f32 v79, 0xbec3ef15, v72
    v_fmac_f32 v78, 0x3ec3ef15, v73
    v_fmac_f32 v79, 0xbf6c835e, v73
    v_sub_f32 v72, v16, v24
    v_sub_f32 v73, v17, v25
    v_add_f32 v16, v16, v24
    v_add_f32 v17, v17, v25
    v_sub_f32 v24, v18, v26
    v_sub_f32 v25, v19, v27
    v_add_f32 v18, v18, v26
    v_add_f32 v19, v19, v27
    v_mul_f32 v26, 0x3f3504f3, v24
    v_mul_f32 v27, 0xbf3504f3, v24
    v_fmac_f32 v26, 0x3f3504f3, v25
    v_fmac_f32 v27, 0x3f3504f3, v25
    v_sub_f32 v24, v21, v29
    v_sub_f32 v25, v28, v20
    v_add_f32 v20, v20, v28
    v_add_f32 v21, v21, v29
    v_sub_f32 v28, v22, v30
    v_sub_f32 v29, v23, v31
    v_add_f32 v22, v22, v30
    v_add_f32 v23, v23, v31
    v_mul_f32 v30, 0xbf3504f3, v28
    v_mul_f32 v31, 0xbf3504f3, v28
    v_fmac_f32 v30, 0x3f3504f3, v29
    v_fmac_f32 v31, 0xbf3504f3, v29
    v_sub_f32 v28, v64, v32
    v_sub_f32 v29, v65, v33
    v_add_f32 v64, v64, v32
    v_add_f32 v65, v65, v33
    v_sub_f32 v32, v34, v42
    v_sub_f32 v33, v35, v43
    v_add_f32 v34, v34, v42
    v_add_f32 v35, v35, v43
    v_mul_f32 v42, 0x3f3504f3, v32
    v_mul_f32 v43, 0xbf3504f3, v32
    v_fmac_f32 v42, 0x3f3504f3, v33
    v_fmac_f32 v43, 0x3f3504f3, v33
    v_sub_f32 v32, v37, v45
    v_sub_f32 v33, v44, v36
    v_add_f32 v36, v36, v44
    v_add_f32 v37, v37, v45
    v_sub_f32 v44, v38, v46
    v_sub_f32 v45, v39, v47
    v_add_f32 v38, v38, v46
    v_add_f32 v39, v39, v47
    v_mul_f32 v46, 0xbf3504f3, v44
    v_mul_f32 v47, 0xbf3504f3, v44
    v_fmac_f32 v46, 0x3f3504f3, v45
    v_fmac_f32 v47, 0xbf3504f3, v45
    v_sub_f32 v44, v80, v56
    v_sub_f32 v45, v81, v57
    v_add_f32 v80, v80, v56
    v_add_f32 v81, v81, v57
    v_sub_f32 v56, v50, v58
    v_sub_f32 v57, v51, v59
    v_add_f32 v50, v50, v58
    v_add_f32 v51, v51, v59
    v_mul_f32 v58, 0x3f3504f3, v56
    v_mul_f32 v59, 0xbf3504f3, v56
    v_fmac_f32 v58, 0x3f3504f3, v57
    v_fmac_f32 v59, 0x3f3504f3, v57
    v_sub_f32 v56, v53, v61
    v_sub_f32 v57, v60, v52
    v_add_f32 v52, v52, v60
    v_add_f32 v53, v53, v61
    v_sub_f32 v60, v54, v62
    v_sub_f32 v61, v55, v63
    v_add_f32 v54, v54, v62
    v_add_f32 v55, v55, v63
    v_mul_f32 v62, 0xbf3504f3, v60
    v_mul_f32 v63, 0xbf3504f3, v60
    v_fmac_f32 v62, 0x3f3504f3, v61
    v_fmac_f32 v63, 0xbf3504f3, v61
    v_sub_f32 v60, v40, v48
    v_sub_f32 v61, v41, v49
    v_add_f32 v40, v40, v48
    v_add_f32 v41, v41, v49
    v_sub_f32 v48, v66, v74
    v_sub_f32 v49, v67, v75
    v_add_f32 v66, v66, v74
    v_add_f32 v67, v67, v75
    v_mul_f32 v74, 0x3f3504f3, v48
    v_mul_f32 v75, 0xbf3504f3, v48
    v_fmac_f32 v74, 0x3f3504f3, v49
    v_fmac_f32 v75, 0x3f3504f3, v49
    v_sub_f32 v48, v69, v77
    v_sub_f32 v49, v76, v68
    v_add_f32 v68, v68, v76
    v_add_f32 v69, v69, v77
    v_sub_f32 v76, v70, v78
    v_sub_f32 v77, v71, v79
    v_add_f32 v70, v70, v78
    v_add_f32 v71, v71, v79
    v_mul_f32 v78, 0xbf3504f3, v76
    v_mul_f32 v79, 0xbf3504f3, v76
    v_fmac_f32 v78, 0x3f3504f3, v77
    v_fmac_f32 v79, 0xbf3504f3, v77
    v_sub_f32 v76, v16, v20
    v_sub_f32 v77, v17, v21
    v_add_f32 v16, v16, v20
    v_add_f32 v17, v17, v21
    v_sub_f32 v20, v19, v23
    v_sub_f32 v21, v22, v18
    v_add_f32 v18, v18, v22
    v_add_f32 v19, v19, v23
    v_sub_f32 v22, v72, v24
    v_sub_f32 v23, v73, v25
    v_add_f32 v72, v72, v24
    v_add_f32 v73, v73, v25
    v_sub_f32 v24, v27, v31
    v_sub_f32 v25, v30, v26
    v_add_f32 v26, v26, v30
    v_add_f32 v27, v27, v31
    v_sub_f32 v30, v64, v36
    v_sub_f32 v31, v65, v37
    v_add_f32 v64, v64, v36
    v_add_f32 v65, v65, v37
    v_sub_f32 v36, v35, v39
    v_sub_f32 v37, v38, v34
    v_add_f32 v34, v34, v38
    v_add_f32 v35, v35, v39
    v_sub_f32 v38, v28, v32
    v_sub_f32 v39, v29, v33
    v_add_f32 v28, v28, v32
    v_add_f32 v29, v29, v33
    v_sub_f32 v32, v43, v47
    v_sub_f32 v33, v46, v42
    v_add_f32 v42, v42, v46
    v_add_f32 v43, v43, v47
    v_sub_f32 v46, v80, v52
    v_sub_f32 v47, v81, v53
    v_add_f32 v80, v80, v52
    v_add_f32 v81, v81, v53
    v_sub_f32 v52, v51, v55
    v_sub_f32 v53, v54, v50
    v_add_f32 v50, v50, v54
    v_add_f32 v51, v51, v55
    v_sub_f32 v54, v44, v56
    v_sub_f32 v55, v45, v57
    v_add_f32 v44, v44, v56
    v_add_f32 v45, v45, v57
    v_sub_f32 v56, v59, v63
    v_sub_f32 v57, v62, v58
    v_add_f32 v58, v58, v62
    v_add_f32 v59, v59, v63
    v_sub_f32 v62, v40, v68
    v_sub_f32 v63, v41, v69
    v_add_f32 v40, v40, v68
    v_add_f32 v41, v41, v69
    v_sub_f32 v68, v67, v71
    v_sub_f32 v69, v70, v66
    v_add_f32 v66, v66, v70
    v_add_f32 v67, v67, v71
    v_sub_f32 v70, v60, v48
    v_sub_f32 v71, v61, v49
    v_add_f32 v60, v60, v48
    v_add_f32 v61, v61, v49
    v_sub_f32 v48, v75, v79
    v_sub_f32 v49, v78, v74
    v_add_f32 v74, v74, v78
    v_add_f32 v75, v75, v79
    v_sub_f32 v78, v16, v18
    v_sub_f32 v79, v17, v19
    v_add_f32 v16, v16, v18
    v_add_f32 v17, v17, v19
    v_sub_f32 v18, v76, v20
    v_sub_f32 v19, v77, v21
    v_add_f32 v76, v76, v20
    v_add_f32 v77, v77, v21
    v_sub_f32 v20, v72, v26
    v_sub_f32 v21, v73, v27
    v_add_f32 v72, v72, v26
    v_add_f32 v73, v73, v27
    v_sub_f32 v26, v22, v24
    v_sub_f32 v27, v23, v25
    v_add_f32 v22, v22, v24
    v_add_f32 v23, v23, v25
    v_sub_f32 v24, v64, v34
    v_sub_f32 v25, v65, v35
    v_add_f32 v64, v64, v34
    v_add_f32 v65, v65, v35
    v_sub_f32 v34, v30, v36
    v_sub_f32 v35, v31, v37
    v_add_f32 v30, v30, v36
    v_add_f32 v31, v31, v37
    v_sub_f32 v36, v28, v42
    v_sub_f32 v37, v29, v43
    v_add_f32 v28, v28, v42
    v_add_f32 v29, v29, v43
    v_sub_f32 v42, v38, v32
    v_sub_f32 v43, v39, v33
    v_add_f32 v38, v38, v32
    v_add_f32 v39, v39, v33
    v_sub_f32 v32, v80, v50
    v_sub_f32 v33, v81, v51
    v_add_f32 v80, v80, v50
    v_add_f32 v81, v81, v51
    v_sub_f32 v50, v46, v52
    v_sub_f32 v51, v47, v53
    v_add_f32 v46, v46, v52
    v_add_f32 v47, v47, v53
    v_sub_f32 v52, v44, v58
    v_sub_f32 v53, v45, v59
    v_add_f32 v44, v44, v58
    v_add_f32 v45, v45, v59
    v_sub_f32 v58, v54, v56
    v_sub_f32 v59, v55, v57
    v_add_f32 v54, v54, v56
    v_add_f32 v55, v55, v57
    v_sub_f32 v56, v40, v66
    v_sub_f32 v57, v41, v67
    v_add_f32 v40, v40, v66
    v_add_f32 v41, v41, v67
    v_sub_f32 v66, v62, v68
    v_sub_f32 v67, v63, v69
    v_add_f32 v62, v62, v68
    v_add_f32 v63, v63, v69
    v_sub_f32 v68, v60, v74
    v_sub_f32 v69, v61, v75
    v_add_f32 v60, v60, v74
    v_add_f32 v61, v61, v75
    v_sub_f32 v74, v70, v48
    v_sub_f32 v75, v71, v49
    v_add_f32 v70, v70, v48
    v_add_f32 v71, v71, v49
    v_mul_f32 v48, 0xba000000, v2
    v_cos_f32 v49, v48
    v_sin_f32 v82, v48
    s_nop 0
    v_mul_f32 v83, v80, v49
    v_fma_f32 v83, -v81, v82, v83
    v_mul_f32 v81, v81, v49
    v_fmac_f32 v81, v80, v82
    v_mul_f32 v48, 0xba800000, v2
    v_cos_f32 v49, v48
    v_sin_f32 v82, v48
    s_nop 0
    v_mul_f32 v80, v64, v49
    v_fma_f32 v80, -v65, v82, v80
    v_mul_f32 v65, v65, v49
    v_fmac_f32 v65, v64, v82
    v_mul_f32 v48, 0xbac00000, v2
    v_cos_f32 v49, v48
    v_sin_f32 v82, v48
    s_nop 0
    v_mul_f32 v64, v40, v49
    v_fma_f32 v64, -v41, v82, v64
    v_mul_f32 v41, v41, v49
    v_fmac_f32 v41, v40, v82
    v_mul_f32 v48, 0xbb000000, v2
    v_cos_f32 v49, v48
    v_sin_f32 v82, v48
    s_nop 0
    v_mul_f32 v40, v72, v49
    v_fma_f32 v40, -v73, v82, v40
    v_mul_f32 v73, v73, v49
    v_fmac_f32 v73, v72, v82
    v_mul_f32 v48, 0xbb200000, v2
    v_cos_f32 v49, v48
    v_sin_f32 v82, v48
    s_nop 0
    v_mul_f32 v72, v44, v49
    v_fma_f32 v72, -v45, v82, v72
    v_mul_f32 v45, v45, v49
    v_fmac_f32 v45, v44, v82
    v_mul_f32 v48, 0xbb400000, v2
    v_cos_f32 v49, v48
    v_sin_f32 v82, v48
    s_nop 0
    v_mul_f32 v44, v28, v49
    v_fma_f32 v44, -v29, v82, v44
    v_mul_f32 v29, v29, v49
    v_fmac_f32 v29, v28, v82
    v_mul_f32 v48, 0xbb600000, v2
    v_cos_f32 v49, v48
    v_sin_f32 v82, v48
    s_nop 0
    v_mul_f32 v28, v60, v49
    v_fma_f32 v28, -v61, v82, v28
    v_mul_f32 v61, v61, v49
    v_fmac_f32 v61, v60, v82
    v_mul_f32 v48, 0xbb800000, v2
    v_cos_f32 v49, v48
    v_sin_f32 v82, v48
    s_nop 0
    v_mul_f32 v60, v76, v49
    v_fma_f32 v60, -v77, v82, v60
    v_mul_f32 v77, v77, v49
    v_fmac_f32 v77, v76, v82
    v_mul_f32 v48, 0xbb900000, v2
    v_cos_f32 v49, v48
    v_sin_f32 v82, v48
    s_nop 0
    v_mul_f32 v76, v46, v49
    v_fma_f32 v76, -v47, v82, v76
    v_mul_f32 v47, v47, v49
    v_fmac_f32 v47, v46, v82
    v_mul_f32 v48, 0xbba00000, v2
    v_cos_f32 v49, v48
    v_sin_f32 v82, v48
    s_nop 0
    v_mul_f32 v46, v30, v49
    v_fma_f32 v46, -v31, v82, v46
    v_mul_f32 v31, v31, v49
    v_fmac_f32 v31, v30, v82
    v_mul_f32 v48, 0xbbb00000, v2
    v_cos_f32 v49, v48
    v_sin_f32 v82, v48
    s_nop 0
    v_mul_f32 v30, v62, v49
    v_fma_f32 v30, -v63, v82, v30
    v_mul_f32 v63, v63, v49
    v_fmac_f32 v63, v62, v82
    v_mul_f32 v48, 0xbbc00000, v2
    v_cos_f32 v49, v48
    v_sin_f32 v82, v48
    s_nop 0
    v_mul_f32 v62, v22, v49
    v_fma_f32 v62, -v23, v82, v62
    v_mul_f32 v23, v23, v49
    v_fmac_f32 v23, v22, v82
    v_mul_f32 v48, 0xbbd00000, v2
    v_cos_f32 v49, v48
    v_sin_f32 v82, v48
    s_nop 0
    v_mul_f32 v22, v54, v49
    v_fma_f32 v22, -v55, v82, v22
    v_mul_f32 v55, v55, v49
    v_fmac_f32 v55, v54, v82
    v_mul_f32 v48, 0xbbe00000, v2
    v_cos_f32 v49, v48
    v_sin_f32 v82, v48
    s_nop 0
    v_mul_f32 v54, v38, v49
    v_fma_f32 v54, -v39, v82, v54
    v_mul_f32 v39, v39, v49
    v_fmac_f32 v39, v38, v82
    v_mul_f32 v48, 0xbbf00000, v2
    v_cos_f32 v49, v48
    v_sin_f32 v82, v48
    s_nop 0
    v_mul_f32 v38, v70, v49
    v_fma_f32 v38, -v71, v82, v38
    v_mul_f32 v71, v71, v49
    v_fmac_f32 v71, v70, v82
    v_mul_f32 v48, 0xbc000000, v2
    v_cos_f32 v49, v48
    v_sin_f32 v82, v48
    s_nop 0
    v_mul_f32 v70, v78, v49
    v_fma_f32 v70, -v79, v82, v70
    v_mul_f32 v79, v79, v49
    v_fmac_f32 v79, v78, v82
    v_mul_f32 v48, 0xbc080000, v2
    v_cos_f32 v49, v48
    v_sin_f32 v82, v48
    s_nop 0
    v_mul_f32 v78, v32, v49
    v_fma_f32 v78, -v33, v82, v78
    v_mul_f32 v33, v33, v49
    v_fmac_f32 v33, v32, v82
    v_mul_f32 v48, 0xbc100000, v2
    v_cos_f32 v49, v48
    v_sin_f32 v82, v48
    s_nop 0
    v_mul_f32 v32, v24, v49
    v_fma_f32 v32, -v25, v82, v32
    v_mul_f32 v25, v25, v49
    v_fmac_f32 v25, v24, v82
    v_mul_f32 v48, 0xbc180000, v2
    v_cos_f32 v49, v48
    v_sin_f32 v82, v48
    s_nop 0
    v_mul_f32 v24, v56, v49
    v_fma_f32 v24, -v57, v82, v24
    v_mul_f32 v57, v57, v49
    v_fmac_f32 v57, v56, v82
    v_mul_f32 v48, 0xbc200000, v2
    v_cos_f32 v49, v48
    v_sin_f32 v82, v48
    s_nop 0
    v_mul_f32 v56, v20, v49
    v_fma_f32 v56, -v21, v82, v56
    v_mul_f32 v21, v21, v49
    v_fmac_f32 v21, v20, v82
    v_mul_f32 v48, 0xbc280000, v2
    v_cos_f32 v49, v48
    v_sin_f32 v82, v48
    s_nop 0
    v_mul_f32 v20, v52, v49
    v_fma_f32 v20, -v53, v82, v20
    v_mul_f32 v53, v53, v49
    v_fmac_f32 v53, v52, v82
    v_mul_f32 v48, 0xbc300000, v2
    v_cos_f32 v49, v48
    v_sin_f32 v82, v48
    s_nop 0
    v_mul_f32 v52, v36, v49
    v_fma_f32 v52, -v37, v82, v52
    v_mul_f32 v37, v37, v49
    v_fmac_f32 v37, v36, v82
    v_mul_f32 v48, 0xbc380000, v2
    v_cos_f32 v49, v48
    v_sin_f32 v82, v48
    s_nop 0
    v_mul_f32 v36, v68, v49
    v_fma_f32 v36, -v69, v82, v36
    v_mul_f32 v69, v69, v49
    v_fmac_f32 v69, v68, v82
    v_mul_f32 v48, 0xbc400000, v2
    v_cos_f32 v49, v48
    v_sin_f32 v82, v48
    s_nop 0
    v_mul_f32 v68, v18, v49
    v_fma_f32 v68, -v19, v82, v68
    v_mul_f32 v19, v19, v49
    v_fmac_f32 v19, v18, v82
    v_mul_f32 v48, 0xbc480000, v2
    v_cos_f32 v49, v48
    v_sin_f32 v82, v48
    s_nop 0
    v_mul_f32 v18, v50, v49
    v_fma_f32 v18, -v51, v82, v18
    v_mul_f32 v51, v51, v49
    v_fmac_f32 v51, v50, v82
    v_mul_f32 v48, 0xbc500000, v2
    v_cos_f32 v49, v48
    v_sin_f32 v82, v48
    s_nop 0
    v_mul_f32 v50, v34, v49
    v_fma_f32 v50, -v35, v82, v50
    v_mul_f32 v35, v35, v49
    v_fmac_f32 v35, v34, v82
    v_mul_f32 v48, 0xbc580000, v2
    v_cos_f32 v49, v48
    v_sin_f32 v82, v48
    s_nop 0
    v_mul_f32 v34, v66, v49
    v_fma_f32 v34, -v67, v82, v34
    v_mul_f32 v67, v67, v49
    v_fmac_f32 v67, v66, v82
    v_mul_f32 v48, 0xbc600000, v2
    v_cos_f32 v49, v48
    v_sin_f32 v82, v48
    s_nop 0
    v_mul_f32 v66, v26, v49
    v_fma_f32 v66, -v27, v82, v66
    v_mul_f32 v27, v27, v49
    v_fmac_f32 v27, v26, v82
    v_mul_f32 v48, 0xbc680000, v2
    v_cos_f32 v49, v48
    v_sin_f32 v82, v48
    s_nop 0
    v_mul_f32 v26, v58, v49
    v_fma_f32 v26, -v59, v82, v26
    v_mul_f32 v59, v59, v49
    v_fmac_f32 v59, v58, v82
    v_mul_f32 v48, 0xbc700000, v2
    v_cos_f32 v49, v48
    v_sin_f32 v82, v48
    s_nop 0
    v_mul_f32 v58, v42, v49
    v_fma_f32 v58, -v43, v82, v58
    v_mul_f32 v43, v43, v49
    v_fmac_f32 v43, v42, v82
    v_mul_f32 v48, 0xbc780000, v2
    v_cos_f32 v49, v48
    v_sin_f32 v82, v48
    s_nop 0
    v_mul_f32 v42, v74, v49
    v_fma_f32 v42, -v75, v82, v42
    v_mul_f32 v75, v75, v49
    v_fmac_f32 v75, v74, v82
    ds_write_b32 v3, v16 offset:0
    ds_write_b32 v3, v17 offset:4
    ds_write_b32 v3, v83 offset:528
    ds_write_b32 v3, v81 offset:532
    ds_write_b32 v3, v80 offset:1056
    ds_write_b32 v3, v65 offset:1060
    ds_write_b32 v3, v64 offset:1584
    ds_write_b32 v3, v41 offset:1588
    ds_write_b32 v3, v40 offset:2112
    ds_write_b32 v3, v73 offset:2116
    ds_write_b32 v3, v72 offset:2640
    ds_write_b32 v3, v45 offset:2644
    ds_write_b32 v3, v44 offset:3168
    ds_write_b32 v3, v29 offset:3172
    ds_write_b32 v3, v28 offset:3696
    ds_write_b32 v3, v61 offset:3700
    ds_write_b32 v3, v60 offset:4224
    ds_write_b32 v3, v77 offset:4228
    ds_write_b32 v3, v76 offset:4752
    ds_write_b32 v3, v47 offset:4756
    ds_write_b32 v3, v46 offset:5280
    ds_write_b32 v3, v31 offset:5284
    ds_write_b32 v3, v30 offset:5808
    ds_write_b32 v3, v63 offset:5812
    ds_write_b32 v3, v62 offset:6336
    ds_write_b32 v3, v23 offset:6340
    ds_write_b32 v3, v22 offset:6864
    ds_write_b32 v3, v55 offset:6868
    ds_write_b32 v3, v54 offset:7392
    ds_write_b32 v3, v39 offset:7396
    ds_write_b32 v3, v38 offset:7920
    ds_write_b32 v3, v71 offset:7924
    ds_write_b32 v3, v70 offset:8448
    ds_write_b32 v3, v79 offset:8452
    ds_write_b32 v3, v78 offset:8976
    ds_write_b32 v3, v33 offset:8980
    ds_write_b32 v3, v32 offset:9504
    ds_write_b32 v3, v25 offset:9508
    ds_write_b32 v3, v24 offset:10032
    ds_write_b32 v3, v57 offset:10036
    ds_write_b32 v3, v56 offset:10560
    ds_write_b32 v3, v21 offset:10564
    ds_write_b32 v3, v20 offset:11088
    ds_write_b32 v3, v53 offset:11092
    ds_write_b32 v3, v52 offset:11616
    ds_write_b32 v3, v37 offset:11620
    ds_write_b32 v3, v36 offset:12144
    ds_write_b32 v3, v69 offset:12148
    ds_write_b32 v3, v68 offset:12672
    ds_write_b32 v3, v19 offset:12676
    ds_write_b32 v3, v18 offset:13200
    ds_write_b32 v3, v51 offset:13204
    ds_write_b32 v3, v50 offset:13728
    ds_write_b32 v3, v35 offset:13732
    ds_write_b32 v3, v34 offset:14256
    ds_write_b32 v3, v67 offset:14260
    ds_write_b32 v3, v66 offset:14784
    ds_write_b32 v3, v27 offset:14788
    ds_write_b32 v3, v26 offset:15312
    ds_write_b32 v3, v59 offset:15316
    ds_write_b32 v3, v58 offset:15840
    ds_write_b32 v3, v43 offset:15844
    ds_write_b32 v3, v42 offset:16368
    ds_write_b32 v3, v75 offset:16372
    s_waitcnt lgkmcnt(0)
    ds_read_b32 v16, v4 offset:0
    ds_read_b32 v17, v4 offset:4
    ds_read_b32 v83, v4 offset:16
    ds_read_b32 v81, v4 offset:20
    ds_read_b32 v80, v4 offset:32
    ds_read_b32 v65, v4 offset:36
    ds_read_b32 v64, v4 offset:48
    ds_read_b32 v41, v4 offset:52
    ds_read_b32 v40, v4 offset:64
    ds_read_b32 v73, v4 offset:68
    ds_read_b32 v72, v4 offset:80
    ds_read_b32 v45, v4 offset:84
    ds_read_b32 v44, v4 offset:96
    ds_read_b32 v29, v4 offset:100
    s_waitcnt lgkmcnt(0)
    ds_read_b32 v28, v4 offset:112
    ds_read_b32 v61, v4 offset:116
    ds_read_b32 v60, v4 offset:128
    ds_read_b32 v77, v4 offset:132
    ds_read_b32 v76, v4 offset:144
    ds_read_b32 v47, v4 offset:148
    ds_read_b32 v46, v4 offset:160
    ds_read_b32 v31, v4 offset:164
    ds_read_b32 v30, v4 offset:176
    ds_read_b32 v63, v4 offset:180
    ds_read_b32 v62, v4 offset:192
    ds_read_b32 v23, v4 offset:196
    ds_read_b32 v22, v4 offset:208
    ds_read_b32 v55, v4 offset:212
    s_waitcnt lgkmcnt(0)
    ds_read_b32 v54, v4 offset:224
    ds_read_b32 v39, v4 offset:228
    ds_read_b32 v38, v4 offset:240
    ds_read_b32 v71, v4 offset:244
    ds_read_b32 v70, v4 offset:256
    ds_read_b32 v79, v4 offset:260
    ds_read_b32 v78, v4 offset:272
    ds_read_b32 v33, v4 offset:276
    ds_read_b32 v32, v4 offset:288
    ds_read_b32 v25, v4 offset:292
    ds_read_b32 v24, v4 offset:304
    ds_read_b32 v57, v4 offset:308
    ds_read_b32 v56, v4 offset:320
    ds_read_b32 v21, v4 offset:324
    s_waitcnt lgkmcnt(0)
    ds_read_b32 v20, v4 offset:336
    ds_read_b32 v53, v4 offset:340
    ds_read_b32 v52, v4 offset:352
    ds_read_b32 v37, v4 offset:356
    ds_read_b32 v36, v4 offset:368
    ds_read_b32 v69, v4 offset:372
    ds_read_b32 v68, v4 offset:384
    ds_read_b32 v19, v4 offset:388
    ds_read_b32 v18, v4 offset:400
    ds_read_b32 v51, v4 offset:404
    ds_read_b32 v50, v4 offset:416
    ds_read_b32 v35, v4 offset:420
    ds_read_b32 v34, v4 offset:432
    ds_read_b32 v67, v4 offset:436
    s_waitcnt lgkmcnt(0)
    ds_read_b32 v66, v4 offset:448
    ds_read_b32 v27, v4 offset:452
    ds_read_b32 v26, v4 offset:464
    ds_read_b32 v59, v4 offset:468
    ds_read_b32 v58, v4 offset:480
    ds_read_b32 v43, v4 offset:484
    ds_read_b32 v42, v4 offset:496
    ds_read_b32 v75, v4 offset:500
    s_waitcnt lgkmcnt(0)
    buffer_load_dword v88, v11, s[8:11], s19 offen offset:0
    buffer_load_dword v89, v11, s[8:11], s19 offen offset:128
    buffer_load_dword v90, v11, s[8:11], s19 offen offset:256
    buffer_load_dword v91, v11, s[8:11], s19 offen offset:384
    buffer_load_dword v92, v11, s[8:11], s19 offen offset:512
    buffer_load_dword v93, v11, s[8:11], s19 offen offset:640
    buffer_load_dword v94, v11, s[8:11], s19 offen offset:768
    buffer_load_dword v95, v11, s[8:11], s19 offen offset:896
    buffer_load_dword v96, v11, s[8:11], s19 offen offset:1024
    buffer_load_dword v97, v11, s[8:11], s19 offen offset:1152
    buffer_load_dword v98, v11, s[8:11], s19 offen offset:1280
    buffer_load_dword v99, v11, s[8:11], s19 offen offset:1408
    buffer_load_dword v100, v11, s[8:11], s19 offen offset:1536
    buffer_load_dword v101, v11, s[8:11], s19 offen offset:1664
    buffer_load_dword v102, v11, s[8:11], s19 offen offset:1792
    buffer_load_dword v103, v11, s[8:11], s19 offen offset:1920
    buffer_load_dword v104, v11, s[8:11], s19 offen offset:2048
    buffer_load_dword v105, v11, s[8:11], s19 offen offset:2176
    buffer_load_dword v106, v11, s[8:11], s19 offen offset:2304
    buffer_load_dword v107, v11, s[8:11], s19 offen offset:2432
    buffer_load_dword v108, v11, s[8:11], s19 offen offset:2560
    buffer_load_dword v109, v11, s[8:11], s19 offen offset:2688
    buffer_load_dword v110, v11, s[8:11], s19 offen offset:2816
    buffer_load_dword v111, v11, s[8:11], s19 offen offset:2944
    buffer_load_dword v112, v11, s[8:11], s19 offen offset:3072
    buffer_load_dword v113, v11, s[8:11], s19 offen offset:3200
    buffer_load_dword v114, v11, s[8:11], s19 offen offset:3328
    buffer_load_dword v115, v11, s[8:11], s19 offen offset:3456
    buffer_load_dword v116, v11, s[8:11], s19 offen offset:3584
    buffer_load_dword v117, v11, s[8:11], s19 offen offset:3712
    buffer_load_dword v118, v11, s[8:11], s19 offen offset:3840
    buffer_load_dword v119, v11, s[8:11], s19 offen offset:3968
    v_sub_f32 v48, v16, v70
    v_sub_f32 v49, v17, v79
    v_add_f32 v16, v16, v70
    v_add_f32 v17, v17, v79
    v_sub_f32 v70, v83, v78
    v_sub_f32 v79, v81, v33
    v_add_f32 v83, v83, v78
    v_add_f32 v81, v81, v33
    v_mul_f32 v78, 0x3f7b14be, v70
    v_mul_f32 v33, 0xbe47c5c2, v70
    v_fmac_f32 v78, 0x3e47c5c2, v79
    v_fmac_f32 v33, 0x3f7b14be, v79
    v_sub_f32 v70, v80, v32
    v_sub_f32 v79, v65, v25
    v_add_f32 v80, v80, v32
    v_add_f32 v65, v65, v25
    v_mul_f32 v32, 0x3f6c835e, v70
    v_mul_f32 v25, 0xbec3ef15, v70
    v_fmac_f32 v32, 0x3ec3ef15, v79
    v_fmac_f32 v25, 0x3f6c835e, v79
    v_sub_f32 v70, v64, v24
    v_sub_f32 v79, v41, v57
    v_add_f32 v64, v64, v24
    v_add_f32 v41, v41, v57
    v_mul_f32 v24, 0x3f54db31, v70
    v_mul_f32 v57, 0xbf0e39da, v70
    v_fmac_f32 v24, 0x3f0e39da, v79
    v_fmac_f32 v57, 0x3f54db31, v79
    v_sub_f32 v70, v40, v56
    v_sub_f32 v79, v73, v21
    v_add_f32 v40, v40, v56
    v_add_f32 v73, v73, v21
    v_mul_f32 v56, 0x3f3504f3, v70
    v_mul_f32 v21, 0xbf3504f3, v70
    v_fmac_f32 v56, 0x3f3504f3, v79
    v_fmac_f32 v21, 0x3f3504f3, v79
    v_sub_f32 v70, v72, v20
    v_sub_f32 v79, v45, v53
    v_add_f32 v72, v72, v20
    v_add_f32 v45, v45, v53
    v_mul_f32 v20, 0x3f0e39da, v70
    v_mul_f32 v53, 0xbf54db31, v70
    v_fmac_f32 v20, 0x3f54db31, v79
    v_fmac_f32 v53, 0x3f0e39da, v79
    v_sub_f32 v70, v44, v52
    v_sub_f32 v79, v29, v37
    v_add_f32 v44, v44, v52
    v_add_f32 v29, v29, v37
    v_mul_f32 v52, 0x3ec3ef15, v70
    v_mul_f32 v37, 0xbf6c835e, v70
    v_fmac_f32 v52, 0x3f6c835e, v79
    v_fmac_f32 v37, 0x3ec3ef15, v79
    v_sub_f32 v70, v28, v36
    v_sub_f32 v79, v61, v69
    v_add_f32 v28, v28, v36
    v_add_f32 v61, v61, v69
    v_mul_f32 v36, 0x3e47c5c2, v70
    v_mul_f32 v69, 0xbf7b14be, v70
    v_fmac_f32 v36, 0x3f7b14be, v79
    v_fmac_f32 v69, 0x3e47c5c2, v79
    v_sub_f32 v70, v77, v19
    v_sub_f32 v79, v68, v60
    v_add_f32 v60, v60, v68
    v_add_f32 v77, v77, v19
    v_sub_f32 v68, v76, v18
    v_sub_f32 v19, v47, v51
    v_add_f32 v76, v76, v18
    v_add_f32 v47, v47, v51
    v_mul_f32 v18, 0xbe47c5c2, v68
    v_mul_f32 v51, 0xbf7b14be, v68
    v_fmac_f32 v18, 0x3f7b14be, v19
    v_fmac_f32 v51, 0xbe47c5c2, v19
    v_sub_f32 v68, v46, v50
    v_sub_f32 v19, v31, v35
    v_add_f32 v46, v46, v50
    v_add_f32 v31, v31, v35
    v_mul_f32 v50, 0xbec3ef15, v68
    v_mul_f32 v35, 0xbf6c835e, v68
    v_fmac_f32 v50, 0x3f6c835e, v19
    v_fmac_f32 v35, 0xbec3ef15, v19
    v_sub_f32 v68, v30, v34
    v_sub_f32 v19, v63, v67
    v_add_f32 v30, v30, v34
    v_add_f32 v63, v63, v67
    v_mul_f32 v34, 0xbf0e39da, v68
    v_mul_f32 v67, 0xbf54db31, v68
    v_fmac_f32 v34, 0x3f54db31, v19
    v_fmac_f32 v67, 0xbf0e39da, v19
    v_sub_f32 v68, v62, v66
    v_sub_f32 v19, v23, v27
    v_add_f32 v62, v62, v66
    v_add_f32 v23, v23, v27
    v_mul_f32 v66, 0xbf3504f3, v68
    v_mul_f32 v27, 0xbf3504f3, v68
    v_fmac_f32 v66, 0x3f3504f3, v19
    v_fmac_f32 v27, 0xbf3504f3, v19
    v_sub_f32 v68, v22, v26
    v_sub_f32 v19, v55, v59
    v_add_f32 v22, v22, v26
    v_add_f32 v55, v55, v59
    v_mul_f32 v26, 0xbf54db31, v68
    v_mul_f32 v59, 0xbf0e39da, v68
    v_fmac_f32 v26, 0x3f0e39da, v19
    v_fmac_f32 v59, 0xbf54db31, v19
    v_sub_f32 v68, v54, v58
    v_sub_f32 v19, v39, v43
    v_add_f32 v54, v54, v58
    v_add_f32 v39, v39, v43
    v_mul_f32 v58, 0xbf6c835e, v68
    v_mul_f32 v43, 0xbec3ef15, v68
    v_fmac_f32 v58, 0x3ec3ef15, v19
    v_fmac_f32 v43, 0xbf6c835e, v19
    v_sub_f32 v68, v38, v42
    v_sub_f32 v19, v71, v75
    v_add_f32 v38, v38, v42
    v_add_f32 v71, v71, v75
    v_mul_f32 v42, 0xbf7b14be, v68
    v_mul_f32 v75, 0xbe47c5c2, v68
    v_fmac_f32 v42, 0x3e47c5c2, v19
    v_fmac_f32 v75, 0xbf7b14be, v19
    v_sub_f32 v68, v16, v60
    v_sub_f32 v19, v17, v77
    v_add_f32 v16, v16, v60
    v_add_f32 v17, v17, v77
    v_sub_f32 v60, v83, v76
    v_sub_f32 v77, v81, v47
    v_add_f32 v83, v83, v76
    v_add_f32 v81, v81, v47
    v_mul_f32 v76, 0x3f6c835e, v60
    v_mul_f32 v47, 0xbec3ef15, v60
    v_fmac_f32 v76, 0x3ec3ef15, v77
    v_fmac_f32 v47, 0x3f6c835e, v77
    v_sub_f32 v60, v80, v46
    v_sub_f32 v77, v65, v31
    v_add_f32 v80, v80, v46
    v_add_f32 v65, v65, v31
    v_mul_f32 v46, 0x3f3504f3, v60
    v_mul_f32 v31, 0xbf3504f3, v60
    v_fmac_f32 v46, 0x3f3504f3, v77
    v_fmac_f32 v31, 0x3f3504f3, v77
    v_sub_f32 v60, v64, v30
    v_sub_f32 v77, v41, v63
    v_add_f32 v64, v64, v30
    v_add_f32 v41, v41, v63
    v_mul_f32 v30, 0x3ec3ef15, v60
    v_mul_f32 v63, 0xbf6c835e, v60
    v_fmac_f32 v30, 0x3f6c835e, v77
    v_fmac_f32 v63, 0x3ec3ef15, v77
    v_sub_f32 v60, v73, v23
    v_sub_f32 v77, v62, v40
    v_add_f32 v40, v40, v62
    v_add_f32 v73, v73, v23
    v_sub_f32 v62, v72, v22
    v_sub_f32 v23, v45, v55
    v_add_f32 v72, v72, v22
    v_add_f32 v45, v45, v55
    v_mul_f32 v22, 0xbec3ef15, v62
    v_mul_f32 v55, 0xbf6c835e, v62
    v_fmac_f32 v22, 0x3f6c835e, v23
    v_fmac_f32 v55, 0xbec3ef15, v23
    v_sub_f32 v62, v44, v54
    v_sub_f32 v23, v29, v39
    v_add_f32 v44, v44, v54
    v_add_f32 v29, v29, v39
    v_mul_f32 v54, 0xbf3504f3, v62
    v_mul_f32 v39, 0xbf3504f3, v62
    v_fmac_f32 v54, 0x3f3504f3, v23
    v_fmac_f32 v39, 0xbf3504f3, v23
    v_sub_f32 v62, v28, v38
    v_sub_f32 v23, v61, v71
    v_add_f32 v28, v28, v38
    v_add_f32 v61, v61, v71
    v_mul_f32 v38, 0xbf6c835e, v62
    v_mul_f32 v71, 0xbec3ef15, v62
    v_fmac_f32 v38, 0x3ec3ef15, v23
    v_fmac_f32 v71, 0xbf6c835e, v23
    v_sub_f32 v62, v48, v70
    v_sub_f32 v23, v49, v79
    v_add_f32 v48, v48, v70
    v_add_f32 v49, v49, v79
    v_sub_f32 v70, v78, v18
    v_sub_f32 v79, v33, v51
    v_add_f32 v78, v78, v18
    v_add_f32 v33, v33, v51
    v_mul_f32 v18, 0x3f6c835e, v70
    v_mul_f32 v51, 0xbec3ef15, v70
    v_fmac_f32 v18, 0x3ec3ef15, v79
    v_fmac_f32 v51, 0x3f6c835e, v79
    v_sub_f32 v70, v32, v50
    v_sub_f32 v79, v25, v35
    v_add_f32 v32, v32, v50
    v_add_f32 v25, v25, v35
    v_mul_f32 v50, 0x3f3504f3, v70
    v_mul_f32 v35, 0xbf3504f3, v70
    v_fmac_f32 v50, 0x3f3504f3, v79
    v_fmac_f32 v35, 0x3f3504f3, v79
    v_sub_f32 v70, v24, v34
    v_sub_f32 v79, v57, v67
    v_add_f32 v24, v24, v34
    v_add_f32 v57, v57, v67
    v_mul_f32 v34, 0x3ec3ef15, v70
    v_mul_f32 v67, 0xbf6c835e, v70
    v_fmac_f32 v34, 0x3f6c835e, v79
    v_fmac_f32 v67, 0x3ec3ef15, v79
    v_sub_f32 v70, v21, v27
    v_sub_f32 v79, v66, v56
    v_add_f32 v56, v56, v66
    v_add_f32 v21, v21, v27
    v_sub_f32 v66, v20, v26
    v_sub_f32 v27, v53, v59
    v_add_f32 v20, v20, v26
    v_add_f32 v53, v53, v59
    v_mul_f32 v26, 0xbec3ef15, v66
    v_mul_f32 v59, 0xbf6c835e, v66
    v_fmac_f32 v26, 0x3f6c835e, v27
    v_fmac_f32 v59, 0xbec3ef15, v27
    v_sub_f32 v66, v52, v58
    v_sub_f32 v27, v37, v43
    v_add_f32 v52, v52, v58
    v_add_f32 v37, v37, v43
    v_mul_f32 v58, 0xbf3504f3, v66
    v_mul_f32 v43, 0xbf3504f3, v66
    v_fmac_f32 v58, 0x3f3504f3, v27
    v_fmac_f32 v43, 0xbf3504f3, v27
    v_sub_f32 v66, v36, v42
    v_sub_f32 v27, v69, v75
    v_add_f32 v36, v36, v42
    v_add_f32 v69, v69, v75
    v_mul_f32 v42, 0xbf6c835e, v66
    v_mul_f32 v75, 0xbec3ef15, v66
    v_fmac_f32 v42, 0x3ec3ef15, v27
    v_fmac_f32 v75, 0xbf6c835e, v27
    v_sub_f32 v66, v16, v40
    v_sub_f32 v27, v17, v73
    v_add_f32 v16, v16, v40
    v_add_f32 v17, v17, v73
    v_sub_f32 v40, v83, v72
    v_sub_f32 v73, v81, v45
    v_add_f32 v83, v83, v72
    v_add_f32 v81, v81, v45
    v_mul_f32 v72, 0x3f3504f3, v40
    v_mul_f32 v45, 0xbf3504f3, v40
    v_fmac_f32 v72, 0x3f3504f3, v73
    v_fmac_f32 v45, 0x3f3504f3, v73
    v_sub_f32 v40, v65, v29
    v_sub_f32 v73, v44, v80
    v_add_f32 v80, v80, v44
    v_add_f32 v65, v65, v29
    v_sub_f32 v44, v64, v28
    v_sub_f32 v29, v41, v61
    v_add_f32 v64, v64, v28
    v_add_f32 v41, v41, v61
    v_mul_f32 v28, 0xbf3504f3, v44
    v_mul_f32 v61, 0xbf3504f3, v44
    v_fmac_f32 v28, 0x3f3504f3, v29
    v_fmac_f32 v61, 0xbf3504f3, v29
    v_sub_f32 v44, v68, v60
    v_sub_f32 v29, v19, v77
    v_add_f32 v68, v68, v60
    v_add_f32 v19, v19, v77
    v_sub_f32 v60, v76, v22
    v_sub_f32 v77, v47, v55
    v_add_f32 v76, v76, v22
    v_add_f32 v47, v47, v55
    v_mul_f32 v22, 0x3f3504f3, v60
    v_mul_f32 v55, 0xbf3504f3, v60
    v_fmac_f32 v22, 0x3f3504f3, v77
    v_fmac_f32 v55, 0x3f3504f3, v77
    v_sub_f32 v60, v31, v39
    v_sub_f32 v77, v54, v46
    v_add_f32 v46, v46, v54
    v_add_f32 v31, v31, v39
    v_sub_f32 v54, v30, v38
    v_sub_f32 v39, v63, v71
    v_add_f32 v30, v30, v38
    v_add_f32 v63, v63, v71
    v_mul_f32 v38, 0xbf3504f3, v54
    v_mul_f32 v71, 0xbf3504f3, v54
    v_fmac_f32 v38, 0x3f3504f3, v39
    v_fmac_f32 v71, 0xbf3504f3, v39
    v_sub_f32 v54, v48, v56
    v_sub_f32 v39, v49, v21
    v_add_f32 v48, v48, v56
    v_add_f32 v49, v49, v21
    v_sub_f32 v56, v78, v20
    v_sub_f32 v21, v33, v53
    v_add_f32 v78, v78, v20
    v_add_f32 v33, v33, v53
    v_mul_f32 v20, 0x3f3504f3, v56
    v_mul_f32 v53, 0xbf3504f3, v56
    v_fmac_f32 v20, 0x3f3504f3, v21
    v_fmac_f32 v53, 0x3f3504f3, v21
    v_sub_f32 v56, v25, v37
    v_sub_f32 v21, v52, v32
    v_add_f32 v32, v32, v52
    v_add_f32 v25, v25, v37
    v_sub_f32 v52, v24, v36
    v_sub_f32 v37, v57, v69
    v_add_f32 v24, v24, v36
    v_add_f32 v57, v57, v69
    v_mul_f32 v36, 0xbf3504f3, v52
    v_mul_f32 v69, 0xbf3504f3, v52
    v_fmac_f32 v36, 0x3f3504f3, v37
    v_fmac_f32 v69, 0xbf3504f3, v37
    v_sub_f32 v52, v62, v70
    v_sub_f32 v37, v23, v79
    v_add_f32 v62, v62, v70
    v_add_f32 v23, v23, v79
    v_sub_f32 v70, v18, v26
    v_sub_f32 v79, v51, v59
    v_add_f32 v18, v18, v26
    v_add_f32 v51, v51, v59
    v_mul_f32 v26, 0x3f3504f3, v70
    v_mul_f32 v59, 0xbf3504f3, v70
    v_fmac_f32 v26, 0x3f3504f3, v79
    v_fmac_f32 v59, 0x3f3504f3, v79
    v_sub_f32 v70, v35, v43
    v_sub_f32 v79, v58, v50
    v_add_f32 v50, v50, v58
    v_add_f32 v35, v35, v43
    v_sub_f32 v58, v34, v42
    v_sub_f32 v43, v67, v75
    v_add_f32 v34, v34, v42
    v_add_f32 v67, v67, v75
    v_mul_f32 v42, 0xbf3504f3, v58
    v_mul_f32 v75, 0xbf3504f3, v58
    v_fmac_f32 v42, 0x3f3504f3, v43
    v_fmac_f32 v75, 0xbf3504f3, v43
    v_sub_f32 v58, v16, v80
    v_sub_f32 v43, v17, v65
    v_add_f32 v16, v16, v80
    v_add_f32 v17, v17, v65
    v_sub_f32 v80, v81, v41
    v_sub_f32 v65, v64, v83
    v_add_f32 v83, v83, v64
    v_add_f32 v81, v81, v41
    v_sub_f32 v64, v66, v40
    v_sub_f32 v41, v27, v73
    v_add_f32 v66, v66, v40
    v_add_f32 v27, v27, v73
    v_sub_f32 v40, v45, v61
    v_sub_f32 v73, v28, v72
    v_add_f32 v72, v72, v28
    v_add_f32 v45, v45, v61
    v_sub_f32 v28, v68, v46
    v_sub_f32 v61, v19, v31
    v_add_f32 v68, v68, v46
    v_add_f32 v19, v19, v31
    v_sub_f32 v46, v47, v63
    v_sub_f32 v31, v30, v76
    v_add_f32 v76, v76, v30
    v_add_f32 v47, v47, v63
    v_sub_f32 v30, v44, v60
    v_sub_f32 v63, v29, v77
    v_add_f32 v44, v44, v60
    v_add_f32 v29, v29, v77
    v_sub_f32 v60, v55, v71
    v_sub_f32 v77, v38, v22
    v_add_f32 v22, v22, v38
    v_add_f32 v55, v55, v71
    v_sub_f32 v38, v48, v32
    v_sub_f32 v71, v49, v25
    v_add_f32 v48, v48, v32
    v_add_f32 v49, v49, v25
    v_sub_f32 v32, v33, v57
    v_sub_f32 v25, v24, v78
    v_add_f32 v78, v78, v24
    v_add_f32 v33, v33, v57
    v_sub_f32 v24, v54, v56
    v_sub_f32 v57, v39, v21
    v_add_f32 v54, v54, v56
    v_add_f32 v39, v39, v21
    v_sub_f32 v56, v53, v69
    v_sub_f32 v21, v36, v20
    v_add_f32 v20, v20, v36
    v_add_f32 v53, v53, v69
    v_sub_f32 v36, v62, v50
    v_sub_f32 v69, v23, v35
    v_add_f32 v62, v62, v50
    v_add_f32 v23, v23, v35
    v_sub_f32 v50, v51, v67
    v_sub_f32 v35, v34, v18
    v_add_f32 v18, v18, v34
    v_add_f32 v51, v51, v67
    v_sub_f32 v34, v52, v70
    v_sub_f32 v67, v37, v79
    v_add_f32 v52, v52, v70
    v_add_f32 v37, v37, v79
    v_sub_f32 v70, v59, v75
    v_sub_f32 v79, v42, v26
    v_add_f32 v26, v26, v42
    v_add_f32 v59, v59, v75
    v_sub_f32 v42, v16, v83
    v_sub_f32 v75, v17, v81
    v_add_f32 v16, v16, v83
    v_add_f32 v17, v17, v81
    v_sub_f32 v83, v58, v80
    v_sub_f32 v81, v43, v65
    v_add_f32 v58, v58, v80
    v_add_f32 v43, v43, v65
    v_sub_f32 v80, v66, v72
    v_sub_f32 v65, v27, v45
    v_add_f32 v66, v66, v72
    v_add_f32 v27, v27, v45
    v_sub_f32 v72, v64, v40
    v_sub_f32 v45, v41, v73
    v_add_f32 v64, v64, v40
    v_add_f32 v41, v41, v73
    v_sub_f32 v40, v68, v76
    v_sub_f32 v73, v19, v47
    v_add_f32 v68, v68, v76
    v_add_f32 v19, v19, v47
    v_sub_f32 v76, v28, v46
    v_sub_f32 v47, v61, v31
    v_add_f32 v28, v28, v46
    v_add_f32 v61, v61, v31
    v_sub_f32 v46, v44, v22
    v_sub_f32 v31, v29, v55
    v_add_f32 v44, v44, v22
    v_add_f32 v29, v29, v55
    v_sub_f32 v22, v30, v60
    v_sub_f32 v55, v63, v77
    v_add_f32 v30, v30, v60
    v_add_f32 v63, v63, v77
    v_sub_f32 v60, v48, v78
    v_sub_f32 v77, v49, v33
    v_add_f32 v48, v48, v78
    v_add_f32 v49, v49, v33
    v_sub_f32 v78, v38, v32
    v_sub_f32 v33, v71, v25
    v_add_f32 v38, v38, v32
    v_add_f32 v71, v71, v25
    v_sub_f32 v32, v54, v20
    v_sub_f32 v25, v39, v53
    v_add_f32 v54, v54, v20
    v_add_f32 v39, v39, v53
    v_sub_f32 v20, v24, v56
    v_sub_f32 v53, v57, v21
    v_add_f32 v24, v24, v56
    v_add_f32 v57, v57, v21
    v_sub_f32 v56, v62, v18
    v_sub_f32 v21, v23, v51
    v_add_f32 v62, v62, v18
    v_add_f32 v23, v23, v51
    v_sub_f32 v18, v36, v50
    v_sub_f32 v51, v69, v35
    v_add_f32 v36, v36, v50
    v_add_f32 v69, v69, v35
    v_sub_f32 v50, v52, v26
    v_sub_f32 v35, v37, v59
    v_add_f32 v52, v52, v26
    v_add_f32 v37, v37, v59
    v_sub_f32 v26, v34, v70
    v_sub_f32 v59, v67, v79
    v_add_f32 v34, v34, v70
    v_add_f32 v67, v67, v79
    v_mul_f32 v70, 0xbc800000, v10
    v_cos_f32 v79, v70
    v_sin_f32 v82, v70
    s_nop 0
    v_mul_f32 v74, v48, v79
    v_fma_f32 v74, -v49, v82, v74
    v_mul_f32 v49, v49, v79
    v_fmac_f32 v49, v48, v82
    v_mul_f32 v70, 0xbd000000, v10
    v_cos_f32 v79, v70
    v_sin_f32 v82, v70
    s_nop 0
    v_mul_f32 v48, v68, v79
    v_fma_f32 v48, -v19, v82, v48
    v_mul_f32 v19, v19, v79
    v_fmac_f32 v19, v68, v82
    v_mul_f32 v70, 0xbd400000, v10
    v_cos_f32 v79, v70
    v_sin_f32 v82, v70
    s_nop 0
    v_mul_f32 v68, v62, v79
    v_fma_f32 v68, -v23, v82, v68
    v_mul_f32 v23, v23, v79
    v_fmac_f32 v23, v62, v82
    v_mul_f32 v70, 0xbd800000, v10
    v_cos_f32 v79, v70
    v_sin_f32 v82, v70
    s_nop 0
    v_mul_f32 v62, v66, v79
    v_fma_f32 v62, -v27, v82, v62
    v_mul_f32 v27, v27, v79
    v_fmac_f32 v27, v66, v82
    v_mul_f32 v70, 0xbda00000, v10
    v_cos_f32 v79, v70
    v_sin_f32 v82, v70
    s_nop 0
    v_mul_f32 v66, v54, v79
    v_fma_f32 v66, -v39, v82, v66
    v_mul_f32 v39, v39, v79
    v_fmac_f32 v39, v54, v82
    v_mul_f32 v70, 0xbdc00000, v10
    v_cos_f32 v79, v70
    v_sin_f32 v82, v70
    s_nop 0
    v_mul_f32 v54, v44, v79
    v_fma_f32 v54, -v29, v82, v54
    v_mul_f32 v29, v29, v79
    v_fmac_f32 v29, v44, v82
    v_mul_f32 v70, 0xbde00000, v10
    v_cos_f32 v79, v70
    v_sin_f32 v82, v70
    s_nop 0
    v_mul_f32 v44, v52, v79
    v_fma_f32 v44, -v37, v82, v44
    v_mul_f32 v37, v37, v79
    v_fmac_f32 v37, v52, v82
    v_mul_f32 v70, 0xbe000000, v10
    v_cos_f32 v79, v70
    v_sin_f32 v82, v70
    s_nop 0
    v_mul_f32 v52, v58, v79
    v_fma_f32 v52, -v43, v82, v52
    v_mul_f32 v43, v43, v79
    v_fmac_f32 v43, v58, v82
    v_mul_f32 v70, 0xbe100000, v10
    v_cos_f32 v79, v70
    v_sin_f32 v82, v70
    s_nop 0
    v_mul_f32 v58, v38, v79
    v_fma_f32 v58, -v71, v82, v58
    v_mul_f32 v71, v71, v79
    v_fmac_f32 v71, v38, v82
    v_mul_f32 v70, 0xbe200000, v10
    v_cos_f32 v79, v70
    v_sin_f32 v82, v70
    s_nop 0
    v_mul_f32 v38, v28, v79
    v_fma_f32 v38, -v61, v82, v38
    v_mul_f32 v61, v61, v79
    v_fmac_f32 v61, v28, v82
    v_mul_f32 v70, 0xbe300000, v10
    v_cos_f32 v79, v70
    v_sin_f32 v82, v70
    s_nop 0
    v_mul_f32 v28, v36, v79
    v_fma_f32 v28, -v69, v82, v28
    v_mul_f32 v69, v69, v79
    v_fmac_f32 v69, v36, v82
    v_mul_f32 v70, 0xbe400000, v10
    v_cos_f32 v79, v70
    v_sin_f32 v82, v70
    s_nop 0
    v_mul_f32 v36, v64, v79
    v_fma_f32 v36, -v41, v82, v36
    v_mul_f32 v41, v41, v79
    v_fmac_f32 v41, v64, v82
    v_mul_f32 v70, 0xbe500000, v10
    v_cos_f32 v79, v70
    v_sin_f32 v82, v70
    s_nop 0
    v_mul_f32 v64, v24, v79
    v_fma_f32 v64, -v57, v82, v64
    v_mul_f32 v57, v57, v79
    v_fmac_f32 v57, v24, v82
    v_mul_f32 v70, 0xbe600000, v10
    v_cos_f32 v79, v70
    v_sin_f32 v82, v70
    s_nop 0
    v_mul_f32 v24, v30, v79
    v_fma_f32 v24, -v63, v82, v24
    v_mul_f32 v63, v63, v79
    v_fmac_f32 v63, v30, v82
    v_mul_f32 v70, 0xbe700000, v10
    v_cos_f32 v79, v70
    v_sin_f32 v82, v70
    s_nop 0
    v_mul_f32 v30, v34, v79
    v_fma_f32 v30, -v67, v82, v30
    v_mul_f32 v67, v67, v79
    v_fmac_f32 v67, v34, v82
    v_mul_f32 v70, 0xbe800000, v10
    v_cos_f32 v79, v70
    v_sin_f32 v82, v70
    s_nop 0
    v_mul_f32 v34, v42, v79
    v_fma_f32 v34, -v75, v82, v34
    v_mul_f32 v75, v75, v79
    v_fmac_f32 v75, v42, v82
    v_mul_f32 v70, 0xbe880000, v10
    v_cos_f32 v79, v70
    v_sin_f32 v82, v70
    s_nop 0
    v_mul_f32 v42, v60, v79
    v_fma_f32 v42, -v77, v82, v42
    v_mul_f32 v77, v77, v79
    v_fmac_f32 v77, v60, v82
    v_mul_f32 v70, 0xbe900000, v10
    v_cos_f32 v79, v70
    v_sin_f32 v82, v70
    s_nop 0
    v_mul_f32 v60, v40, v79
    v_fma_f32 v60, -v73, v82, v60
    v_mul_f32 v73, v73, v79
    v_fmac_f32 v73, v40, v82
    v_mul_f32 v70, 0xbe980000, v10
    v_cos_f32 v79, v70
    v_sin_f32 v82, v70
    s_nop 0
    v_mul_f32 v40, v56, v79
    v_fma_f32 v40, -v21, v82, v40
    v_mul_f32 v21, v21, v79
    v_fmac_f32 v21, v56, v82
    v_mul_f32 v70, 0xbea00000, v10
    v_cos_f32 v79, v70
    v_sin_f32 v82, v70
    s_nop 0
    v_mul_f32 v56, v80, v79
    v_fma_f32 v56, -v65, v82, v56
    v_mul_f32 v65, v65, v79
    v_fmac_f32 v65, v80, v82
    v_mul_f32 v70, 0xbea80000, v10
    v_cos_f32 v79, v70
    v_sin_f32 v82, v70
    s_nop 0
    v_mul_f32 v80, v32, v79
    v_fma_f32 v80, -v25, v82, v80
    v_mul_f32 v25, v25, v79
    v_fmac_f32 v25, v32, v82
    v_mul_f32 v70, 0xbeb00000, v10
    v_cos_f32 v79, v70
    v_sin_f32 v82, v70
    s_nop 0
    v_mul_f32 v32, v46, v79
    v_fma_f32 v32, -v31, v82, v32
    v_mul_f32 v31, v31, v79
    v_fmac_f32 v31, v46, v82
    v_mul_f32 v70, 0xbeb80000, v10
    v_cos_f32 v79, v70
    v_sin_f32 v82, v70
    s_nop 0
    v_mul_f32 v46, v50, v79
    v_fma_f32 v46, -v35, v82, v46
    v_mul_f32 v35, v35, v79
    v_fmac_f32 v35, v50, v82
    v_mul_f32 v70, 0xbec00000, v10
    v_cos_f32 v79, v70
    v_sin_f32 v82, v70
    s_nop 0
    v_mul_f32 v50, v83, v79
    v_fma_f32 v50, -v81, v82, v50
    v_mul_f32 v81, v81, v79
    v_fmac_f32 v81, v83, v82
    v_mul_f32 v70, 0xbec80000, v10
    v_cos_f32 v79, v70
    v_sin_f32 v82, v70
    s_nop 0
    v_mul_f32 v83, v78, v79
    v_fma_f32 v83, -v33, v82, v83
    v_mul_f32 v33, v33, v79
    v_fmac_f32 v33, v78, v82
    v_mul_f32 v70, 0xbed00000, v10
    v_cos_f32 v79, v70
    v_sin_f32 v82, v70
    s_nop 0
    v_mul_f32 v78, v76, v79
    v_fma_f32 v78, -v47, v82, v78
    v_mul_f32 v47, v47, v79
    v_fmac_f32 v47, v76, v82
    v_mul_f32 v70, 0xbed80000, v10
    v_cos_f32 v79, v70
    v_sin_f32 v82, v70
    s_nop 0
    v_mul_f32 v76, v18, v79
    v_fma_f32 v76, -v51, v82, v76
    v_mul_f32 v51, v51, v79
    v_fmac_f32 v51, v18, v82
    v_mul_f32 v70, 0xbee00000, v10
    v_cos_f32 v79, v70
    v_sin_f32 v82, v70
    s_nop 0
    v_mul_f32 v18, v72, v79
    v_fma_f32 v18, -v45, v82, v18
    v_mul_f32 v45, v45, v79
    v_fmac_f32 v45, v72, v82
    v_mul_f32 v70, 0xbee80000, v10
    v_cos_f32 v79, v70
    v_sin_f32 v82, v70
    s_nop 0
    v_mul_f32 v72, v20, v79
    v_fma_f32 v72, -v53, v82, v72
    v_mul_f32 v53, v53, v79
    v_fmac_f32 v53, v20, v82
    v_mul_f32 v70, 0xbef00000, v10
    v_cos_f32 v79, v70
    v_sin_f32 v82, v70
    s_nop 0
    v_mul_f32 v20, v22, v79
    v_fma_f32 v20, -v55, v82, v20
    v_mul_f32 v55, v55, v79
    v_fmac_f32 v55, v22, v82
    v_mul_f32 v70, 0xbef80000, v10
    v_cos_f32 v79, v70
    v_sin_f32 v82, v70
    s_nop 0
    v_mul_f32 v22, v26, v79
    v_fma_f32 v22, -v59, v82, v22
    v_mul_f32 v59, v59, v79
    v_fmac_f32 v59, v26, v82
    s_nop 1
    v_mov_b32_dpp v70, v16 quad_perm:[1,0,3,2] row_mask:0xf bank_mask:0xf
    v_fma_f32 v16, v16, v9, v70
    v_mov_b32_dpp v70, v17 quad_perm:[1,0,3,2] row_mask:0xf bank_mask:0xf
    v_fma_f32 v17, v17, v9, v70
    v_mov_b32_dpp v70, v74 quad_perm:[1,0,3,2] row_mask:0xf bank_mask:0xf
    v_fma_f32 v74, v74, v9, v70
    v_mov_b32_dpp v70, v49 quad_perm:[1,0,3,2] row_mask:0xf bank_mask:0xf
    v_fma_f32 v49, v49, v9, v70
    v_mov_b32_dpp v70, v48 quad_perm:[1,0,3,2] row_mask:0xf bank_mask:0xf
    v_fma_f32 v48, v48, v9, v70
    v_mov_b32_dpp v70, v19 quad_perm:[1,0,3,2] row_mask:0xf bank_mask:0xf
    v_fma_f32 v19, v19, v9, v70
    v_mov_b32_dpp v70, v68 quad_perm:[1,0,3,2] row_mask:0xf bank_mask:0xf
    v_fma_f32 v68, v68, v9, v70
    v_mov_b32_dpp v70, v23 quad_perm:[1,0,3,2] row_mask:0xf bank_mask:0xf
    v_fma_f32 v23, v23, v9, v70
    v_mov_b32_dpp v70, v62 quad_perm:[1,0,3,2] row_mask:0xf bank_mask:0xf
    v_fma_f32 v62, v62, v9, v70
    v_mov_b32_dpp v70, v27 quad_perm:[1,0,3,2] row_mask:0xf bank_mask:0xf
    v_fma_f32 v27, v27, v9, v70
    v_mov_b32_dpp v70, v66 quad_perm:[1,0,3,2] row_mask:0xf bank_mask:0xf
    v_fma_f32 v66, v66, v9, v70
    v_mov_b32_dpp v70, v39 quad_perm:[1,0,3,2] row_mask:0xf bank_mask:0xf
    v_fma_f32 v39, v39, v9, v70
    v_mov_b32_dpp v70, v54 quad_perm:[1,0,3,2] row_mask:0xf bank_mask:0xf
    v_fma_f32 v54, v54, v9, v70
    v_mov_b32_dpp v70, v29 quad_perm:[1,0,3,2] row_mask:0xf bank_mask:0xf
    v_fma_f32 v29, v29, v9, v70
    v_mov_b32_dpp v70, v44 quad_perm:[1,0,3,2] row_mask:0xf bank_mask:0xf
    v_fma_f32 v44, v44, v9, v70
    v_mov_b32_dpp v70, v37 quad_perm:[1,0,3,2] row_mask:0xf bank_mask:0xf
    v_fma_f32 v37, v37, v9, v70
    v_mov_b32_dpp v70, v52 quad_perm:[1,0,3,2] row_mask:0xf bank_mask:0xf
    v_fma_f32 v52, v52, v9, v70
    v_mov_b32_dpp v70, v43 quad_perm:[1,0,3,2] row_mask:0xf bank_mask:0xf
    v_fma_f32 v43, v43, v9, v70
    v_mov_b32_dpp v70, v58 quad_perm:[1,0,3,2] row_mask:0xf bank_mask:0xf
    v_fma_f32 v58, v58, v9, v70
    v_mov_b32_dpp v70, v71 quad_perm:[1,0,3,2] row_mask:0xf bank_mask:0xf
    v_fma_f32 v71, v71, v9, v70
    v_mov_b32_dpp v70, v38 quad_perm:[1,0,3,2] row_mask:0xf bank_mask:0xf
    v_fma_f32 v38, v38, v9, v70
    v_mov_b32_dpp v70, v61 quad_perm:[1,0,3,2] row_mask:0xf bank_mask:0xf
    v_fma_f32 v61, v61, v9, v70
    v_mov_b32_dpp v70, v28 quad_perm:[1,0,3,2] row_mask:0xf bank_mask:0xf
    v_fma_f32 v28, v28, v9, v70
    v_mov_b32_dpp v70, v69 quad_perm:[1,0,3,2] row_mask:0xf bank_mask:0xf
    v_fma_f32 v69, v69, v9, v70
    v_mov_b32_dpp v70, v36 quad_perm:[1,0,3,2] row_mask:0xf bank_mask:0xf
    v_fma_f32 v36, v36, v9, v70
    v_mov_b32_dpp v70, v41 quad_perm:[1,0,3,2] row_mask:0xf bank_mask:0xf
    v_fma_f32 v41, v41, v9, v70
    v_mov_b32_dpp v70, v64 quad_perm:[1,0,3,2] row_mask:0xf bank_mask:0xf
    v_fma_f32 v64, v64, v9, v70
    v_mov_b32_dpp v70, v57 quad_perm:[1,0,3,2] row_mask:0xf bank_mask:0xf
    v_fma_f32 v57, v57, v9, v70
    v_mov_b32_dpp v70, v24 quad_perm:[1,0,3,2] row_mask:0xf bank_mask:0xf
    v_fma_f32 v24, v24, v9, v70
    v_mov_b32_dpp v70, v63 quad_perm:[1,0,3,2] row_mask:0xf bank_mask:0xf
    v_fma_f32 v63, v63, v9, v70
    v_mov_b32_dpp v70, v30 quad_perm:[1,0,3,2] row_mask:0xf bank_mask:0xf
    v_fma_f32 v30, v30, v9, v70
    v_mov_b32_dpp v70, v67 quad_perm:[1,0,3,2] row_mask:0xf bank_mask:0xf
    v_fma_f32 v67, v67, v9, v70
    v_mov_b32_dpp v70, v34 quad_perm:[1,0,3,2] row_mask:0xf bank_mask:0xf
    v_fma_f32 v34, v34, v9, v70
    v_mov_b32_dpp v70, v75 quad_perm:[1,0,3,2] row_mask:0xf bank_mask:0xf
    v_fma_f32 v75, v75, v9, v70
    v_mov_b32_dpp v70, v42 quad_perm:[1,0,3,2] row_mask:0xf bank_mask:0xf
    v_fma_f32 v42, v42, v9, v70
    v_mov_b32_dpp v70, v77 quad_perm:[1,0,3,2] row_mask:0xf bank_mask:0xf
    v_fma_f32 v77, v77, v9, v70
    v_mov_b32_dpp v70, v60 quad_perm:[1,0,3,2] row_mask:0xf bank_mask:0xf
    v_fma_f32 v60, v60, v9, v70
    v_mov_b32_dpp v70, v73 quad_perm:[1,0,3,2] row_mask:0xf bank_mask:0xf
    v_fma_f32 v73, v73, v9, v70
    v_mov_b32_dpp v70, v40 quad_perm:[1,0,3,2] row_mask:0xf bank_mask:0xf
    v_fma_f32 v40, v40, v9, v70
    v_mov_b32_dpp v70, v21 quad_perm:[1,0,3,2] row_mask:0xf bank_mask:0xf
    v_fma_f32 v21, v21, v9, v70
    v_mov_b32_dpp v70, v56 quad_perm:[1,0,3,2] row_mask:0xf bank_mask:0xf
    v_fma_f32 v56, v56, v9, v70
    v_mov_b32_dpp v70, v65 quad_perm:[1,0,3,2] row_mask:0xf bank_mask:0xf
    v_fma_f32 v65, v65, v9, v70
    v_mov_b32_dpp v70, v80 quad_perm:[1,0,3,2] row_mask:0xf bank_mask:0xf
    v_fma_f32 v80, v80, v9, v70
    v_mov_b32_dpp v70, v25 quad_perm:[1,0,3,2] row_mask:0xf bank_mask:0xf
    v_fma_f32 v25, v25, v9, v70
    v_mov_b32_dpp v70, v32 quad_perm:[1,0,3,2] row_mask:0xf bank_mask:0xf
    v_fma_f32 v32, v32, v9, v70
    v_mov_b32_dpp v70, v31 quad_perm:[1,0,3,2] row_mask:0xf bank_mask:0xf
    v_fma_f32 v31, v31, v9, v70
    v_mov_b32_dpp v70, v46 quad_perm:[1,0,3,2] row_mask:0xf bank_mask:0xf
    v_fma_f32 v46, v46, v9, v70
    v_mov_b32_dpp v70, v35 quad_perm:[1,0,3,2] row_mask:0xf bank_mask:0xf
    v_fma_f32 v35, v35, v9, v70
    v_mov_b32_dpp v70, v50 quad_perm:[1,0,3,2] row_mask:0xf bank_mask:0xf
    v_fma_f32 v50, v50, v9, v70
    v_mov_b32_dpp v70, v81 quad_perm:[1,0,3,2] row_mask:0xf bank_mask:0xf
    v_fma_f32 v81, v81, v9, v70
    v_mov_b32_dpp v70, v83 quad_perm:[1,0,3,2] row_mask:0xf bank_mask:0xf
    v_fma_f32 v83, v83, v9, v70
    v_mov_b32_dpp v70, v33 quad_perm:[1,0,3,2] row_mask:0xf bank_mask:0xf
    v_fma_f32 v33, v33, v9, v70
    v_mov_b32_dpp v70, v78 quad_perm:[1,0,3,2] row_mask:0xf bank_mask:0xf
    v_fma_f32 v78, v78, v9, v70
    v_mov_b32_dpp v70, v47 quad_perm:[1,0,3,2] row_mask:0xf bank_mask:0xf
    v_fma_f32 v47, v47, v9, v70
    v_mov_b32_dpp v70, v76 quad_perm:[1,0,3,2] row_mask:0xf bank_mask:0xf
    v_fma_f32 v76, v76, v9, v70
    v_mov_b32_dpp v70, v51 quad_perm:[1,0,3,2] row_mask:0xf bank_mask:0xf
    v_fma_f32 v51, v51, v9, v70
    v_mov_b32_dpp v70, v18 quad_perm:[1,0,3,2] row_mask:0xf bank_mask:0xf
    v_fma_f32 v18, v18, v9, v70
    v_mov_b32_dpp v70, v45 quad_perm:[1,0,3,2] row_mask:0xf bank_mask:0xf
    v_fma_f32 v45, v45, v9, v70
    v_mov_b32_dpp v70, v72 quad_perm:[1,0,3,2] row_mask:0xf bank_mask:0xf
    v_fma_f32 v72, v72, v9, v70
    v_mov_b32_dpp v70, v53 quad_perm:[1,0,3,2] row_mask:0xf bank_mask:0xf
    v_fma_f32 v53, v53, v9, v70
    v_mov_b32_dpp v70, v20 quad_perm:[1,0,3,2] row_mask:0xf bank_mask:0xf
    v_fma_f32 v20, v20, v9, v70
    v_mov_b32_dpp v70, v55 quad_perm:[1,0,3,2] row_mask:0xf bank_mask:0xf
    v_fma_f32 v55, v55, v9, v70
    v_mov_b32_dpp v70, v22 quad_perm:[1,0,3,2] row_mask:0xf bank_mask:0xf
    v_fma_f32 v22, v22, v9, v70
    v_mov_b32_dpp v70, v59 quad_perm:[1,0,3,2] row_mask:0xf bank_mask:0xf
    v_fma_f32 v59, v59, v9, v70
    s_waitcnt vmcnt(0)
    s_mov_b32 s20, 0x34800000
    v_lshlrev_b32 v70, 16, v88
    v_and_b32 v79, 0xffff0000, v88
    v_mul_f32 v70, s20, v70
    v_mul_f32 v79, s20, v79
    v_mul_f32 v82, v16, v70
    v_fma_f32 v82, -v17, v79, v82
    v_mul_f32 v17, v17, v70
    v_fmac_f32 v17, v16, v79
    v_lshlrev_b32 v70, 16, v89
    v_and_b32 v79, 0xffff0000, v89
    v_mul_f32 v70, s20, v70
    v_mul_f32 v79, s20, v79
    v_mul_f32 v16, v74, v70
    v_fma_f32 v16, -v49, v79, v16
    v_mul_f32 v49, v49, v70
    v_fmac_f32 v49, v74, v79
    v_lshlrev_b32 v70, 16, v90
    v_and_b32 v79, 0xffff0000, v90
    v_mul_f32 v70, s20, v70
    v_mul_f32 v79, s20, v79
    v_mul_f32 v74, v48, v70
    v_fma_f32 v74, -v19, v79, v74
    v_mul_f32 v19, v19, v70
    v_fmac_f32 v19, v48, v79
    v_lshlrev_b32 v70, 16, v91
    v_and_b32 v79, 0xffff0000, v91
    v_mul_f32 v70, s20, v70
    v_mul_f32 v79, s20, v79
    v_mul_f32 v48, v68, v70
    v_fma_f32 v48, -v23, v79, v48
    v_mul_f32 v23, v23, v70
    v_fmac_f32 v23, v68, v79
    v_lshlrev_b32 v70, 16, v92
    v_and_b32 v79, 0xffff0000, v92
    v_mul_f32 v70, s20, v70
    v_mul_f32 v79, s20, v79
    v_mul_f32 v68, v62, v70
    v_fma_f32 v68, -v27, v79, v68
    v_mul_f32 v27, v27, v70
    v_fmac_f32 v27, v62, v79
    v_lshlrev_b32 v70, 16, v93
    v_and_b32 v79, 0xffff0000, v93
    v_mul_f32 v70, s20, v70
    v_mul_f32 v79, s20, v79
    v_mul_f32 v62, v66, v70
    v_fma_f32 v62, -v39, v79, v62
    v_mul_f32 v39, v39, v70
    v_fmac_f32 v39, v66, v79
    v_lshlrev_b32 v70, 16, v94
    v_and_b32 v79, 0xffff0000, v94
    v_mul_f32 v70, s20, v70
    v_mul_f32 v79, s20, v79
    v_mul_f32 v66, v54, v70
    v_fma_f32 v66, -v29, v79, v66
    v_mul_f32 v29, v29, v70
    v_fmac_f32 v29, v54, v79
    v_lshlrev_b32 v70, 16, v95
    v_and_b32 v79, 0xffff0000, v95
    v_mul_f32 v70, s20, v70
    v_mul_f32 v79, s20, v79
    v_mul_f32 v54, v44, v70
    v_fma_f32 v54, -v37, v79, v54
    v_mul_f32 v37, v37, v70
    v_fmac_f32 v37, v44, v79
    v_lshlrev_b32 v70, 16, v96
    v_and_b32 v79, 0xffff0000, v96
    v_mul_f32 v70, s20, v70
    v_mul_f32 v79, s20, v79
    v_mul_f32 v44, v52, v70
    v_fma_f32 v44, -v43, v79, v44
    v_mul_f32 v43, v43, v70
    v_fmac_f32 v43, v52, v79
    v_lshlrev_b32 v70, 16, v97
    v_and_b32 v79, 0xffff0000, v97
    v_mul_f32 v70, s20, v70
    v_mul_f32 v79, s20, v79
    v_mul_f32 v52, v58, v70
    v_fma_f32 v52, -v71, v79, v52
    v_mul_f32 v71, v71, v70
    v_fmac_f32 v71, v58, v79
    v_lshlrev_b32 v70, 16, v98
    v_and_b32 v79, 0xffff0000, v98
    v_mul_f32 v70, s20, v70
    v_mul_f32 v79, s20, v79
    v_mul_f32 v58, v38, v70
    v_fma_f32 v58, -v61, v79, v58
    v_mul_f32 v61, v61, v70
    v_fmac_f32 v61, v38, v79
    v_lshlrev_b32 v70, 16, v99
    v_and_b32 v79, 0xffff0000, v99
    v_mul_f32 v70, s20, v70
    v_mul_f32 v79, s20, v79
    v_mul_f32 v38, v28, v70
    v_fma_f32 v38, -v69, v79, v38
    v_mul_f32 v69, v69, v70
    v_fmac_f32 v69, v28, v79
    v_lshlrev_b32 v70, 16, v100
    v_and_b32 v79, 0xffff0000, v100
    v_mul_f32 v70, s20, v70
    v_mul_f32 v79, s20, v79
    v_mul_f32 v28, v36, v70
    v_fma_f32 v28, -v41, v79, v28
    v_mul_f32 v41, v41, v70
    v_fmac_f32 v41, v36, v79
    v_lshlrev_b32 v70, 16, v101
    v_and_b32 v79, 0xffff0000, v101
    v_mul_f32 v70, s20, v70
    v_mul_f32 v79, s20, v79
    v_mul_f32 v36, v64, v70
    v_fma_f32 v36, -v57, v79, v36
    v_mul_f32 v57, v57, v70
    v_fmac_f32 v57, v64, v79
    v_lshlrev_b32 v70, 16, v102
    v_and_b32 v79, 0xffff0000, v102
    v_mul_f32 v70, s20, v70
    v_mul_f32 v79, s20, v79
    v_mul_f32 v64, v24, v70
    v_fma_f32 v64, -v63, v79, v64
    v_mul_f32 v63, v63, v70
    v_fmac_f32 v63, v24, v79
    v_lshlrev_b32 v70, 16, v103
    v_and_b32 v79, 0xffff0000, v103
    v_mul_f32 v70, s20, v70
    v_mul_f32 v79, s20, v79
    v_mul_f32 v24, v30, v70
    v_fma_f32 v24, -v67, v79, v24
    v_mul_f32 v67, v67, v70
    v_fmac_f32 v67, v30, v79
    v_lshlrev_b32 v70, 16, v104
    v_and_b32 v79, 0xffff0000, v104
    v_mul_f32 v70, s20, v70
    v_mul_f32 v79, s20, v79
    v_mul_f32 v30, v34, v70
    v_fma_f32 v30, -v75, v79, v30
    v_mul_f32 v75, v75, v70
    v_fmac_f32 v75, v34, v79
    v_lshlrev_b32 v70, 16, v105
    v_and_b32 v79, 0xffff0000, v105
    v_mul_f32 v70, s20, v70
    v_mul_f32 v79, s20, v79
    v_mul_f32 v34, v42, v70
    v_fma_f32 v34, -v77, v79, v34
    v_mul_f32 v77, v77, v70
    v_fmac_f32 v77, v42, v79
    v_lshlrev_b32 v70, 16, v106
    v_and_b32 v79, 0xffff0000, v106
    v_mul_f32 v70, s20, v70
    v_mul_f32 v79, s20, v79
    v_mul_f32 v42, v60, v70
    v_fma_f32 v42, -v73, v79, v42
    v_mul_f32 v73, v73, v70
    v_fmac_f32 v73, v60, v79
    v_lshlrev_b32 v70, 16, v107
    v_and_b32 v79, 0xffff0000, v107
    v_mul_f32 v70, s20, v70
    v_mul_f32 v79, s20, v79
    v_mul_f32 v60, v40, v70
    v_fma_f32 v60, -v21, v79, v60
    v_mul_f32 v21, v21, v70
    v_fmac_f32 v21, v40, v79
    v_lshlrev_b32 v70, 16, v108
    v_and_b32 v79, 0xffff0000, v108
    v_mul_f32 v70, s20, v70
    v_mul_f32 v79, s20, v79
    v_mul_f32 v40, v56, v70
    v_fma_f32 v40, -v65, v79, v40
    v_mul_f32 v65, v65, v70
    v_fmac_f32 v65, v56, v79
    v_lshlrev_b32 v70, 16, v109
    v_and_b32 v79, 0xffff0000, v109
    v_mul_f32 v70, s20, v70
    v_mul_f32 v79, s20, v79
    v_mul_f32 v56, v80, v70
    v_fma_f32 v56, -v25, v79, v56
    v_mul_f32 v25, v25, v70
    v_fmac_f32 v25, v80, v79
    v_lshlrev_b32 v70, 16, v110
    v_and_b32 v79, 0xffff0000, v110
    v_mul_f32 v70, s20, v70
    v_mul_f32 v79, s20, v79
    v_mul_f32 v80, v32, v70
    v_fma_f32 v80, -v31, v79, v80
    v_mul_f32 v31, v31, v70
    v_fmac_f32 v31, v32, v79
    v_lshlrev_b32 v70, 16, v111
    v_and_b32 v79, 0xffff0000, v111
    v_mul_f32 v70, s20, v70
    v_mul_f32 v79, s20, v79
    v_mul_f32 v32, v46, v70
    v_fma_f32 v32, -v35, v79, v32
    v_mul_f32 v35, v35, v70
    v_fmac_f32 v35, v46, v79
    v_lshlrev_b32 v70, 16, v112
    v_and_b32 v79, 0xffff0000, v112
    v_mul_f32 v70, s20, v70
    v_mul_f32 v79, s20, v79
    v_mul_f32 v46, v50, v70
    v_fma_f32 v46, -v81, v79, v46
    v_mul_f32 v81, v81, v70
    v_fmac_f32 v81, v50, v79
    v_lshlrev_b32 v70, 16, v113
    v_and_b32 v79, 0xffff0000, v113
    v_mul_f32 v70, s20, v70
    v_mul_f32 v79, s20, v79
    v_mul_f32 v50, v83, v70
    v_fma_f32 v50, -v33, v79, v50
    v_mul_f32 v33, v33, v70
    v_fmac_f32 v33, v83, v79
    v_lshlrev_b32 v70, 16, v114
    v_and_b32 v79, 0xffff0000, v114
    v_mul_f32 v70, s20, v70
    v_mul_f32 v79, s20, v79
    v_mul_f32 v83, v78, v70
    v_fma_f32 v83, -v47, v79, v83
    v_mul_f32 v47, v47, v70
    v_fmac_f32 v47, v78, v79
    v_lshlrev_b32 v70, 16, v115
    v_and_b32 v79, 0xffff0000, v115
    v_mul_f32 v70, s20, v70
    v_mul_f32 v79, s20, v79
    v_mul_f32 v78, v76, v70
    v_fma_f32 v78, -v51, v79, v78
    v_mul_f32 v51, v51, v70
    v_fmac_f32 v51, v76, v79
    v_lshlrev_b32 v70, 16, v116
    v_and_b32 v79, 0xffff0000, v116
    v_mul_f32 v70, s20, v70
    v_mul_f32 v79, s20, v79
    v_mul_f32 v76, v18, v70
    v_fma_f32 v76, -v45, v79, v76
    v_mul_f32 v45, v45, v70
    v_fmac_f32 v45, v18, v79
    v_lshlrev_b32 v70, 16, v117
    v_and_b32 v79, 0xffff0000, v117
    v_mul_f32 v70, s20, v70
    v_mul_f32 v79, s20, v79
    v_mul_f32 v18, v72, v70
    v_fma_f32 v18, -v53, v79, v18
    v_mul_f32 v53, v53, v70
    v_fmac_f32 v53, v72, v79
    v_lshlrev_b32 v70, 16, v118
    v_and_b32 v79, 0xffff0000, v118
    v_mul_f32 v70, s20, v70
    v_mul_f32 v79, s20, v79
    v_mul_f32 v72, v20, v70
    v_fma_f32 v72, -v55, v79, v72
    v_mul_f32 v55, v55, v70
    v_fmac_f32 v55, v20, v79
    v_lshlrev_b32 v70, 16, v119
    v_and_b32 v79, 0xffff0000, v119
    v_mul_f32 v70, s20, v70
    v_mul_f32 v79, s20, v79
    v_mul_f32 v20, v22, v70
    v_fma_f32 v20, -v59, v79, v20
    v_mul_f32 v59, v59, v70
    v_fmac_f32 v59, v22, v79
    s_nop 1
    v_mov_b32_dpp v70, v82 quad_perm:[1,0,3,2] row_mask:0xf bank_mask:0xf
    v_fma_f32 v82, v82, v9, v70
    v_mov_b32_dpp v70, v17 quad_perm:[1,0,3,2] row_mask:0xf bank_mask:0xf
    v_fma_f32 v17, v17, v9, v70
    v_mov_b32_dpp v70, v16 quad_perm:[1,0,3,2] row_mask:0xf bank_mask:0xf
    v_fma_f32 v16, v16, v9, v70
    v_mov_b32_dpp v70, v49 quad_perm:[1,0,3,2] row_mask:0xf bank_mask:0xf
    v_fma_f32 v49, v49, v9, v70
    v_mov_b32_dpp v70, v74 quad_perm:[1,0,3,2] row_mask:0xf bank_mask:0xf
    v_fma_f32 v74, v74, v9, v70
    v_mov_b32_dpp v70, v19 quad_perm:[1,0,3,2] row_mask:0xf bank_mask:0xf
    v_fma_f32 v19, v19, v9, v70
    v_mov_b32_dpp v70, v48 quad_perm:[1,0,3,2] row_mask:0xf bank_mask:0xf
    v_fma_f32 v48, v48, v9, v70
    v_mov_b32_dpp v70, v23 quad_perm:[1,0,3,2] row_mask:0xf bank_mask:0xf
    v_fma_f32 v23, v23, v9, v70
    v_mov_b32_dpp v70, v68 quad_perm:[1,0,3,2] row_mask:0xf bank_mask:0xf
    v_fma_f32 v68, v68, v9, v70
    v_mov_b32_dpp v70, v27 quad_perm:[1,0,3,2] row_mask:0xf bank_mask:0xf
    v_fma_f32 v27, v27, v9, v70
    v_mov_b32_dpp v70, v62 quad_perm:[1,0,3,2] row_mask:0xf bank_mask:0xf
    v_fma_f32 v62, v62, v9, v70
    v_mov_b32_dpp v70, v39 quad_perm:[1,0,3,2] row_mask:0xf bank_mask:0xf
    v_fma_f32 v39, v39, v9, v70
    v_mov_b32_dpp v70, v66 quad_perm:[1,0,3,2] row_mask:0xf bank_mask:0xf
    v_fma_f32 v66, v66, v9, v70
    v_mov_b32_dpp v70, v29 quad_perm:[1,0,3,2] row_mask:0xf bank_mask:0xf
    v_fma_f32 v29, v29, v9, v70
    v_mov_b32_dpp v70, v54 quad_perm:[1,0,3,2] row_mask:0xf bank_mask:0xf
    v_fma_f32 v54, v54, v9, v70
    v_mov_b32_dpp v70, v37 quad_perm:[1,0,3,2] row_mask:0xf bank_mask:0xf
    v_fma_f32 v37, v37, v9, v70
    v_mov_b32_dpp v70, v44 quad_perm:[1,0,3,2] row_mask:0xf bank_mask:0xf
    v_fma_f32 v44, v44, v9, v70
    v_mov_b32_dpp v70, v43 quad_perm:[1,0,3,2] row_mask:0xf bank_mask:0xf
    v_fma_f32 v43, v43, v9, v70
    v_mov_b32_dpp v70, v52 quad_perm:[1,0,3,2] row_mask:0xf bank_mask:0xf
    v_fma_f32 v52, v52, v9, v70
    v_mov_b32_dpp v70, v71 quad_perm:[1,0,3,2] row_mask:0xf bank_mask:0xf
    v_fma_f32 v71, v71, v9, v70
    v_mov_b32_dpp v70, v58 quad_perm:[1,0,3,2] row_mask:0xf bank_mask:0xf
    v_fma_f32 v58, v58, v9, v70
    v_mov_b32_dpp v70, v61 quad_perm:[1,0,3,2] row_mask:0xf bank_mask:0xf
    v_fma_f32 v61, v61, v9, v70
    v_mov_b32_dpp v70, v38 quad_perm:[1,0,3,2] row_mask:0xf bank_mask:0xf
    v_fma_f32 v38, v38, v9, v70
    v_mov_b32_dpp v70, v69 quad_perm:[1,0,3,2] row_mask:0xf bank_mask:0xf
    v_fma_f32 v69, v69, v9, v70
    v_mov_b32_dpp v70, v28 quad_perm:[1,0,3,2] row_mask:0xf bank_mask:0xf
    v_fma_f32 v28, v28, v9, v70
    v_mov_b32_dpp v70, v41 quad_perm:[1,0,3,2] row_mask:0xf bank_mask:0xf
    v_fma_f32 v41, v41, v9, v70
    v_mov_b32_dpp v70, v36 quad_perm:[1,0,3,2] row_mask:0xf bank_mask:0xf
    v_fma_f32 v36, v36, v9, v70
    v_mov_b32_dpp v70, v57 quad_perm:[1,0,3,2] row_mask:0xf bank_mask:0xf
    v_fma_f32 v57, v57, v9, v70
    v_mov_b32_dpp v70, v64 quad_perm:[1,0,3,2] row_mask:0xf bank_mask:0xf
    v_fma_f32 v64, v64, v9, v70
    v_mov_b32_dpp v70, v63 quad_perm:[1,0,3,2] row_mask:0xf bank_mask:0xf
    v_fma_f32 v63, v63, v9, v70
    v_mov_b32_dpp v70, v24 quad_perm:[1,0,3,2] row_mask:0xf bank_mask:0xf
    v_fma_f32 v24, v24, v9, v70
    v_mov_b32_dpp v70, v67 quad_perm:[1,0,3,2] row_mask:0xf bank_mask:0xf
    v_fma_f32 v67, v67, v9, v70
    v_mov_b32_dpp v70, v30 quad_perm:[1,0,3,2] row_mask:0xf bank_mask:0xf
    v_fma_f32 v30, v30, v9, v70
    v_mov_b32_dpp v70, v75 quad_perm:[1,0,3,2] row_mask:0xf bank_mask:0xf
    v_fma_f32 v75, v75, v9, v70
    v_mov_b32_dpp v70, v34 quad_perm:[1,0,3,2] row_mask:0xf bank_mask:0xf
    v_fma_f32 v34, v34, v9, v70
    v_mov_b32_dpp v70, v77 quad_perm:[1,0,3,2] row_mask:0xf bank_mask:0xf
    v_fma_f32 v77, v77, v9, v70
    v_mov_b32_dpp v70, v42 quad_perm:[1,0,3,2] row_mask:0xf bank_mask:0xf
    v_fma_f32 v42, v42, v9, v70
    v_mov_b32_dpp v70, v73 quad_perm:[1,0,3,2] row_mask:0xf bank_mask:0xf
    v_fma_f32 v73, v73, v9, v70
    v_mov_b32_dpp v70, v60 quad_perm:[1,0,3,2] row_mask:0xf bank_mask:0xf
    v_fma_f32 v60, v60, v9, v70
    v_mov_b32_dpp v70, v21 quad_perm:[1,0,3,2] row_mask:0xf bank_mask:0xf
    v_fma_f32 v21, v21, v9, v70
    v_mov_b32_dpp v70, v40 quad_perm:[1,0,3,2] row_mask:0xf bank_mask:0xf
    v_fma_f32 v40, v40, v9, v70
    v_mov_b32_dpp v70, v65 quad_perm:[1,0,3,2] row_mask:0xf bank_mask:0xf
    v_fma_f32 v65, v65, v9, v70
    v_mov_b32_dpp v70, v56 quad_perm:[1,0,3,2] row_mask:0xf bank_mask:0xf
    v_fma_f32 v56, v56, v9, v70
    v_mov_b32_dpp v70, v25 quad_perm:[1,0,3,2] row_mask:0xf bank_mask:0xf
    v_fma_f32 v25, v25, v9, v70
    v_mov_b32_dpp v70, v80 quad_perm:[1,0,3,2] row_mask:0xf bank_mask:0xf
    v_fma_f32 v80, v80, v9, v70
    v_mov_b32_dpp v70, v31 quad_perm:[1,0,3,2] row_mask:0xf bank_mask:0xf
    v_fma_f32 v31, v31, v9, v70
    v_mov_b32_dpp v70, v32 quad_perm:[1,0,3,2] row_mask:0xf bank_mask:0xf
    v_fma_f32 v32, v32, v9, v70
    v_mov_b32_dpp v70, v35 quad_perm:[1,0,3,2] row_mask:0xf bank_mask:0xf
    v_fma_f32 v35, v35, v9, v70
    v_mov_b32_dpp v70, v46 quad_perm:[1,0,3,2] row_mask:0xf bank_mask:0xf
    v_fma_f32 v46, v46, v9, v70
    v_mov_b32_dpp v70, v81 quad_perm:[1,0,3,2] row_mask:0xf bank_mask:0xf
    v_fma_f32 v81, v81, v9, v70
    v_mov_b32_dpp v70, v50 quad_perm:[1,0,3,2] row_mask:0xf bank_mask:0xf
    v_fma_f32 v50, v50, v9, v70
    v_mov_b32_dpp v70, v33 quad_perm:[1,0,3,2] row_mask:0xf bank_mask:0xf
    v_fma_f32 v33, v33, v9, v70
    v_mov_b32_dpp v70, v83 quad_perm:[1,0,3,2] row_mask:0xf bank_mask:0xf
    v_fma_f32 v83, v83, v9, v70
    v_mov_b32_dpp v70, v47 quad_perm:[1,0,3,2] row_mask:0xf bank_mask:0xf
    v_fma_f32 v47, v47, v9, v70
    v_mov_b32_dpp v70, v78 quad_perm:[1,0,3,2] row_mask:0xf bank_mask:0xf
    v_fma_f32 v78, v78, v9, v70
    v_mov_b32_dpp v70, v51 quad_perm:[1,0,3,2] row_mask:0xf bank_mask:0xf
    v_fma_f32 v51, v51, v9, v70
    v_mov_b32_dpp v70, v76 quad_perm:[1,0,3,2] row_mask:0xf bank_mask:0xf
    v_fma_f32 v76, v76, v9, v70
    v_mov_b32_dpp v70, v45 quad_perm:[1,0,3,2] row_mask:0xf bank_mask:0xf
    v_fma_f32 v45, v45, v9, v70
    v_mov_b32_dpp v70, v18 quad_perm:[1,0,3,2] row_mask:0xf bank_mask:0xf
    v_fma_f32 v18, v18, v9, v70
    v_mov_b32_dpp v70, v53 quad_perm:[1,0,3,2] row_mask:0xf bank_mask:0xf
    v_fma_f32 v53, v53, v9, v70
    v_mov_b32_dpp v70, v72 quad_perm:[1,0,3,2] row_mask:0xf bank_mask:0xf
    v_fma_f32 v72, v72, v9, v70
    v_mov_b32_dpp v70, v55 quad_perm:[1,0,3,2] row_mask:0xf bank_mask:0xf
    v_fma_f32 v55, v55, v9, v70
    v_mov_b32_dpp v70, v20 quad_perm:[1,0,3,2] row_mask:0xf bank_mask:0xf
    v_fma_f32 v20, v20, v9, v70
    v_mov_b32_dpp v70, v59 quad_perm:[1,0,3,2] row_mask:0xf bank_mask:0xf
    v_fma_f32 v59, v59, v9, v70
    v_mul_f32 v70, 0x3c800000, v10
    v_cos_f32 v79, v70
    v_sin_f32 v22, v70
    s_nop 0
    v_mul_f32 v26, v16, v79
    v_fma_f32 v26, -v49, v22, v26
    v_mul_f32 v49, v49, v79
    v_fmac_f32 v49, v16, v22
    v_mul_f32 v70, 0x3d000000, v10
    v_cos_f32 v79, v70
    v_sin_f32 v22, v70
    s_nop 0
    v_mul_f32 v16, v74, v79
    v_fma_f32 v16, -v19, v22, v16
    v_mul_f32 v19, v19, v79
    v_fmac_f32 v19, v74, v22
    v_mul_f32 v70, 0x3d400000, v10
    v_cos_f32 v79, v70
    v_sin_f32 v22, v70
    s_nop 0
    v_mul_f32 v74, v48, v79
    v_fma_f32 v74, -v23, v22, v74
    v_mul_f32 v23, v23, v79
    v_fmac_f32 v23, v48, v22
    v_mul_f32 v70, 0x3d800000, v10
    v_cos_f32 v79, v70
    v_sin_f32 v22, v70
    s_nop 0
    v_mul_f32 v48, v68, v79
    v_fma_f32 v48, -v27, v22, v48
    v_mul_f32 v27, v27, v79
    v_fmac_f32 v27, v68, v22
    v_mul_f32 v70, 0x3da00000, v10
    v_cos_f32 v79, v70
    v_sin_f32 v22, v70
    s_nop 0
    v_mul_f32 v68, v62, v79
    v_fma_f32 v68, -v39, v22, v68
    v_mul_f32 v39, v39, v79
    v_fmac_f32 v39, v62, v22
    v_mul_f32 v70, 0x3dc00000, v10
    v_cos_f32 v79, v70
    v_sin_f32 v22, v70
    s_nop 0
    v_mul_f32 v62, v66, v79
    v_fma_f32 v62, -v29, v22, v62
    v_mul_f32 v29, v29, v79
    v_fmac_f32 v29, v66, v22
    v_mul_f32 v70, 0x3de00000, v10
    v_cos_f32 v79, v70
    v_sin_f32 v22, v70
    s_nop 0
    v_mul_f32 v66, v54, v79
    v_fma_f32 v66, -v37, v22, v66
    v_mul_f32 v37, v37, v79
    v_fmac_f32 v37, v54, v22
    v_mul_f32 v70, 0x3e000000, v10
    v_cos_f32 v79, v70
    v_sin_f32 v22, v70
    s_nop 0
    v_mul_f32 v54, v44, v79
    v_fma_f32 v54, -v43, v22, v54
    v_mul_f32 v43, v43, v79
    v_fmac_f32 v43, v44, v22
    v_mul_f32 v70, 0x3e100000, v10
    v_cos_f32 v79, v70
    v_sin_f32 v22, v70
    s_nop 0
    v_mul_f32 v44, v52, v79
    v_fma_f32 v44, -v71, v22, v44
    v_mul_f32 v71, v71, v79
    v_fmac_f32 v71, v52, v22
    v_mul_f32 v70, 0x3e200000, v10
    v_cos_f32 v79, v70
    v_sin_f32 v22, v70
    s_nop 0
    v_mul_f32 v52, v58, v79
    v_fma_f32 v52, -v61, v22, v52
    v_mul_f32 v61, v61, v79
    v_fmac_f32 v61, v58, v22
    v_mul_f32 v70, 0x3e300000, v10
    v_cos_f32 v79, v70
    v_sin_f32 v22, v70
    s_nop 0
    v_mul_f32 v58, v38, v79
    v_fma_f32 v58, -v69, v22, v58
    v_mul_f32 v69, v69, v79
    v_fmac_f32 v69, v38, v22
    v_mul_f32 v70, 0x3e400000, v10
    v_cos_f32 v79, v70
    v_sin_f32 v22, v70
    s_nop 0
    v_mul_f32 v38, v28, v79
    v_fma_f32 v38, -v41, v22, v38
    v_mul_f32 v41, v41, v79
    v_fmac_f32 v41, v28, v22
    v_mul_f32 v70, 0x3e500000, v10
    v_cos_f32 v79, v70
    v_sin_f32 v22, v70
    s_nop 0
    v_mul_f32 v28, v36, v79
    v_fma_f32 v28, -v57, v22, v28
    v_mul_f32 v57, v57, v79
    v_fmac_f32 v57, v36, v22
    v_mul_f32 v70, 0x3e600000, v10
    v_cos_f32 v79, v70
    v_sin_f32 v22, v70
    s_nop 0
    v_mul_f32 v36, v64, v79
    v_fma_f32 v36, -v63, v22, v36
    v_mul_f32 v63, v63, v79
    v_fmac_f32 v63, v64, v22
    v_mul_f32 v70, 0x3e700000, v10
    v_cos_f32 v79, v70
    v_sin_f32 v22, v70
    s_nop 0
    v_mul_f32 v64, v24, v79
    v_fma_f32 v64, -v67, v22, v64
    v_mul_f32 v67, v67, v79
    v_fmac_f32 v67, v24, v22
    v_mul_f32 v70, 0x3e800000, v10
    v_cos_f32 v79, v70
    v_sin_f32 v22, v70
    s_nop 0
    v_mul_f32 v24, v30, v79
    v_fma_f32 v24, -v75, v22, v24
    v_mul_f32 v75, v75, v79
    v_fmac_f32 v75, v30, v22
    v_mul_f32 v70, 0x3e880000, v10
    v_cos_f32 v79, v70
    v_sin_f32 v22, v70
    s_nop 0
    v_mul_f32 v30, v34, v79
    v_fma_f32 v30, -v77, v22, v30
    v_mul_f32 v77, v77, v79
    v_fmac_f32 v77, v34, v22
    v_mul_f32 v70, 0x3e900000, v10
    v_cos_f32 v79, v70
    v_sin_f32 v22, v70
    s_nop 0
    v_mul_f32 v34, v42, v79
    v_fma_f32 v34, -v73, v22, v34
    v_mul_f32 v73, v73, v79
    v_fmac_f32 v73, v42, v22
    v_mul_f32 v70, 0x3e980000, v10
    v_cos_f32 v79, v70
    v_sin_f32 v22, v70
    s_nop 0
    v_mul_f32 v42, v60, v79
    v_fma_f32 v42, -v21, v22, v42
    v_mul_f32 v21, v21, v79
    v_fmac_f32 v21, v60, v22
    v_mul_f32 v70, 0x3ea00000, v10
    v_cos_f32 v79, v70
    v_sin_f32 v22, v70
    s_nop 0
    v_mul_f32 v60, v40, v79
    v_fma_f32 v60, -v65, v22, v60
    v_mul_f32 v65, v65, v79
    v_fmac_f32 v65, v40, v22
    v_mul_f32 v70, 0x3ea80000, v10
    v_cos_f32 v79, v70
    v_sin_f32 v22, v70
    s_nop 0
    v_mul_f32 v40, v56, v79
    v_fma_f32 v40, -v25, v22, v40
    v_mul_f32 v25, v25, v79
    v_fmac_f32 v25, v56, v22
    v_mul_f32 v70, 0x3eb00000, v10
    v_cos_f32 v79, v70
    v_sin_f32 v22, v70
    s_nop 0
    v_mul_f32 v56, v80, v79
    v_fma_f32 v56, -v31, v22, v56
    v_mul_f32 v31, v31, v79
    v_fmac_f32 v31, v80, v22
    v_mul_f32 v70, 0x3eb80000, v10
    v_cos_f32 v79, v70
    v_sin_f32 v22, v70
    s_nop 0
    v_mul_f32 v80, v32, v79
    v_fma_f32 v80, -v35, v22, v80
    v_mul_f32 v35, v35, v79
    v_fmac_f32 v35, v32, v22
    v_mul_f32 v70, 0x3ec00000, v10
    v_cos_f32 v79, v70
    v_sin_f32 v22, v70
    s_nop 0
    v_mul_f32 v32, v46, v79
    v_fma_f32 v32, -v81, v22, v32
    v_mul_f32 v81, v81, v79
    v_fmac_f32 v81, v46, v22
    v_mul_f32 v70, 0x3ec80000, v10
    v_cos_f32 v79, v70
    v_sin_f32 v22, v70
    s_nop 0
    v_mul_f32 v46, v50, v79
    v_fma_f32 v46, -v33, v22, v46
    v_mul_f32 v33, v33, v79
    v_fmac_f32 v33, v50, v22
    v_mul_f32 v70, 0x3ed00000, v10
    v_cos_f32 v79, v70
    v_sin_f32 v22, v70
    s_nop 0
    v_mul_f32 v50, v83, v79
    v_fma_f32 v50, -v47, v22, v50
    v_mul_f32 v47, v47, v79
    v_fmac_f32 v47, v83, v22
    v_mul_f32 v70, 0x3ed80000, v10
    v_cos_f32 v79, v70
    v_sin_f32 v22, v70
    s_nop 0
    v_mul_f32 v83, v78, v79
    v_fma_f32 v83, -v51, v22, v83
    v_mul_f32 v51, v51, v79
    v_fmac_f32 v51, v78, v22
    v_mul_f32 v70, 0x3ee00000, v10
    v_cos_f32 v79, v70
    v_sin_f32 v22, v70
    s_nop 0
    v_mul_f32 v78, v76, v79
    v_fma_f32 v78, -v45, v22, v78
    v_mul_f32 v45, v45, v79
    v_fmac_f32 v45, v76, v22
    v_mul_f32 v70, 0x3ee80000, v10
    v_cos_f32 v79, v70
    v_sin_f32 v22, v70
    s_nop 0
    v_mul_f32 v76, v18, v79
    v_fma_f32 v76, -v53, v22, v76
    v_mul_f32 v53, v53, v79
    v_fmac_f32 v53, v18, v22
    v_mul_f32 v70, 0x3ef00000, v10
    v_cos_f32 v79, v70
    v_sin_f32 v22, v70
    s_nop 0
    v_mul_f32 v18, v72, v79
    v_fma_f32 v18, -v55, v22, v18
    v_mul_f32 v55, v55, v79
    v_fmac_f32 v55, v72, v22
    v_mul_f32 v70, 0x3ef80000, v10
    v_cos_f32 v79, v70
    v_sin_f32 v22, v70
    s_nop 0
    v_mul_f32 v72, v20, v79
    v_fma_f32 v72, -v59, v22, v72
    v_mul_f32 v59, v59, v79
    v_fmac_f32 v59, v20, v22
    v_sub_f32 v70, v82, v24
    v_sub_f32 v79, v17, v75
    v_add_f32 v82, v82, v24
    v_add_f32 v17, v17, v75
    v_sub_f32 v24, v26, v30
    v_sub_f32 v75, v49, v77
    v_add_f32 v26, v26, v30
    v_add_f32 v49, v49, v77
    v_mul_f32 v30, 0x3f7b14be, v24
    v_mul_f32 v77, 0x3e47c5c2, v24
    v_fmac_f32 v30, 0xbe47c5c2, v75
    v_fmac_f32 v77, 0x3f7b14be, v75
    v_sub_f32 v24, v16, v34
    v_sub_f32 v75, v19, v73
    v_add_f32 v16, v16, v34
    v_add_f32 v19, v19, v73
    v_mul_f32 v34, 0x3f6c835e, v24
    v_mul_f32 v73, 0x3ec3ef15, v24
    v_fmac_f32 v34, 0xbec3ef15, v75
    v_fmac_f32 v73, 0x3f6c835e, v75
    v_sub_f32 v24, v74, v42
    v_sub_f32 v75, v23, v21
    v_add_f32 v74, v74, v42
    v_add_f32 v23, v23, v21
    v_mul_f32 v42, 0x3f54db31, v24
    v_mul_f32 v21, 0x3f0e39da, v24
    v_fmac_f32 v42, 0xbf0e39da, v75
    v_fmac_f32 v21, 0x3f54db31, v75
    v_sub_f32 v24, v48, v60
    v_sub_f32 v75, v27, v65
    v_add_f32 v48, v48, v60
    v_add_f32 v27, v27, v65
    v_mul_f32 v60, 0x3f3504f3, v24
    v_mul_f32 v65, 0x3f3504f3, v24
    v_fmac_f32 v60, 0xbf3504f3, v75
    v_fmac_f32 v65, 0x3f3504f3, v75
    v_sub_f32 v24, v68, v40
    v_sub_f32 v75, v39, v25
    v_add_f32 v68, v68, v40
    v_add_f32 v39, v39, v25
    v_mul_f32 v40, 0x3f0e39da, v24
    v_mul_f32 v25, 0x3f54db31, v24
    v_fmac_f32 v40, 0xbf54db31, v75
    v_fmac_f32 v25, 0x3f0e39da, v75
    v_sub_f32 v24, v62, v56
    v_sub_f32 v75, v29, v31
    v_add_f32 v62, v62, v56
    v_add_f32 v29, v29, v31
    v_mul_f32 v56, 0x3ec3ef15, v24
    v_mul_f32 v31, 0x3f6c835e, v24
    v_fmac_f32 v56, 0xbf6c835e, v75
    v_fmac_f32 v31, 0x3ec3ef15, v75
    v_sub_f32 v24, v66, v80
    v_sub_f32 v75, v37, v35
    v_add_f32 v66, v66, v80
    v_add_f32 v37, v37, v35
    v_mul_f32 v80, 0x3e47c5c2, v24
    v_mul_f32 v35, 0x3f7b14be, v24
    v_fmac_f32 v80, 0xbf7b14be, v75
    v_fmac_f32 v35, 0x3e47c5c2, v75
    v_sub_f32 v24, v81, v43
    v_sub_f32 v75, v54, v32
    v_add_f32 v54, v54, v32
    v_add_f32 v43, v43, v81
    v_sub_f32 v32, v44, v46
    v_sub_f32 v81, v71, v33
    v_add_f32 v44, v44, v46
    v_add_f32 v71, v71, v33
    v_mul_f32 v46, 0xbe47c5c2, v32
    v_mul_f32 v33, 0x3f7b14be, v32
    v_fmac_f32 v46, 0xbf7b14be, v81
    v_fmac_f32 v33, 0xbe47c5c2, v81
    v_sub_f32 v32, v52, v50
    v_sub_f32 v81, v61, v47
    v_add_f32 v52, v52, v50
    v_add_f32 v61, v61, v47
    v_mul_f32 v50, 0xbec3ef15, v32
    v_mul_f32 v47, 0x3f6c835e, v32
    v_fmac_f32 v50, 0xbf6c835e, v81
    v_fmac_f32 v47, 0xbec3ef15, v81
    v_sub_f32 v32, v58, v83
    v_sub_f32 v81, v69, v51
    v_add_f32 v58, v58, v83
    v_add_f32 v69, v69, v51
    v_mul_f32 v83, 0xbf0e39da, v32
    v_mul_f32 v51, 0x3f54db31, v32
    v_fmac_f32 v83, 0xbf54db31, v81
    v_fmac_f32 v51, 0xbf0e39da, v81
    v_sub_f32 v32, v38, v78
    v_sub_f32 v81, v41, v45
    v_add_f32 v38, v38, v78
    v_add_f32 v41, v41, v45
    v_mul_f32 v78, 0xbf3504f3, v32
    v_mul_f32 v45, 0x3f3504f3, v32
    v_fmac_f32 v78, 0xbf3504f3, v81
    v_fmac_f32 v45, 0xbf3504f3, v81
    v_sub_f32 v32, v28, v76
    v_sub_f32 v81, v57, v53
    v_add_f32 v28, v28, v76
    v_add_f32 v57, v57, v53
    v_mul_f32 v76, 0xbf54db31, v32
    v_mul_f32 v53, 0x3f0e39da, v32
    v_fmac_f32 v76, 0xbf0e39da, v81
    v_fmac_f32 v53, 0xbf54db31, v81
    v_sub_f32 v32, v36, v18
    v_sub_f32 v81, v63, v55
    v_add_f32 v36, v36, v18
    v_add_f32 v63, v63, v55
    v_mul_f32 v18, 0xbf6c835e, v32
    v_mul_f32 v55, 0x3ec3ef15, v32
    v_fmac_f32 v18, 0xbec3ef15, v81
    v_fmac_f32 v55, 0xbf6c835e, v81
    v_sub_f32 v32, v64, v72
    v_sub_f32 v81, v67, v59
    v_add_f32 v64, v64, v72
    v_add_f32 v67, v67, v59
    v_mul_f32 v72, 0xbf7b14be, v32
    v_mul_f32 v59, 0x3e47c5c2, v32
    v_fmac_f32 v72, 0xbe47c5c2, v81
    v_fmac_f32 v59, 0xbf7b14be, v81
    v_sub_f32 v32, v82, v54
    v_sub_f32 v81, v17, v43
    v_add_f32 v82, v82, v54
    v_add_f32 v17, v17, v43
    v_sub_f32 v54, v26, v44
    v_sub_f32 v43, v49, v71
    v_add_f32 v26, v26, v44
    v_add_f32 v49, v49, v71
    v_mul_f32 v44, 0x3f6c835e, v54
    v_mul_f32 v71, 0x3ec3ef15, v54
    v_fmac_f32 v44, 0xbec3ef15, v43
    v_fmac_f32 v71, 0x3f6c835e, v43
    v_sub_f32 v54, v16, v52
    v_sub_f32 v43, v19, v61
    v_add_f32 v16, v16, v52
    v_add_f32 v19, v19, v61
    v_mul_f32 v52, 0x3f3504f3, v54
    v_mul_f32 v61, 0x3f3504f3, v54
    v_fmac_f32 v52, 0xbf3504f3, v43
    v_fmac_f32 v61, 0x3f3504f3, v43
    v_sub_f32 v54, v74, v58
    v_sub_f32 v43, v23, v69
    v_add_f32 v74, v74, v58
    v_add_f32 v23, v23, v69
    v_mul_f32 v58, 0x3ec3ef15, v54
    v_mul_f32 v69, 0x3f6c835e, v54
    v_fmac_f32 v58, 0xbf6c835e, v43
    v_fmac_f32 v69, 0x3ec3ef15, v43
    v_sub_f32 v54, v41, v27
    v_sub_f32 v43, v48, v38
    v_add_f32 v48, v48, v38
    v_add_f32 v27, v27, v41
    v_sub_f32 v38, v68, v28
    v_sub_f32 v41, v39, v57
    v_add_f32 v68, v68, v28
    v_add_f32 v39, v39, v57
    v_mul_f32 v28, 0xbec3ef15, v38
    v_mul_f32 v57, 0x3f6c835e, v38
    v_fmac_f32 v28, 0xbf6c835e, v41
    v_fmac_f32 v57, 0xbec3ef15, v41
    v_sub_f32 v38, v62, v36
    v_sub_f32 v41, v29, v63
    v_add_f32 v62, v62, v36
    v_add_f32 v29, v29, v63
    v_mul_f32 v36, 0xbf3504f3, v38
    v_mul_f32 v63, 0x3f3504f3, v38
    v_fmac_f32 v36, 0xbf3504f3, v41
    v_fmac_f32 v63, 0xbf3504f3, v41
    v_sub_f32 v38, v66, v64
    v_sub_f32 v41, v37, v67
    v_add_f32 v66, v66, v64
    v_add_f32 v37, v37, v67
    v_mul_f32 v64, 0xbf6c835e, v38
    v_mul_f32 v67, 0x3ec3ef15, v38
    v_fmac_f32 v64, 0xbec3ef15, v41
    v_fmac_f32 v67, 0xbf6c835e, v41
    v_sub_f32 v38, v70, v24
    v_sub_f32 v41, v79, v75
    v_add_f32 v70, v70, v24
    v_add_f32 v79, v79, v75
    v_sub_f32 v24, v30, v46
    v_sub_f32 v75, v77, v33
    v_add_f32 v30, v30, v46
    v_add_f32 v77, v77, v33
    v_mul_f32 v46, 0x3f6c835e, v24
    v_mul_f32 v33, 0x3ec3ef15, v24
    v_fmac_f32 v46, 0xbec3ef15, v75
    v_fmac_f32 v33, 0x3f6c835e, v75
    v_sub_f32 v24, v34, v50
    v_sub_f32 v75, v73, v47
    v_add_f32 v34, v34, v50
    v_add_f32 v73, v73, v47
    v_mul_f32 v50, 0x3f3504f3, v24
    v_mul_f32 v47, 0x3f3504f3, v24
    v_fmac_f32 v50, 0xbf3504f3, v75
    v_fmac_f32 v47, 0x3f3504f3, v75
    v_sub_f32 v24, v42, v83
    v_sub_f32 v75, v21, v51
    v_add_f32 v42, v42, v83
    v_add_f32 v21, v21, v51
    v_mul_f32 v83, 0x3ec3ef15, v24
    v_mul_f32 v51, 0x3f6c835e, v24
    v_fmac_f32 v83, 0xbf6c835e, v75
    v_fmac_f32 v51, 0x3ec3ef15, v75
    v_sub_f32 v24, v45, v65
    v_sub_f32 v75, v60, v78
    v_add_f32 v60, v60, v78
    v_add_f32 v65, v65, v45
    v_sub_f32 v78, v40, v76
    v_sub_f32 v45, v25, v53
    v_add_f32 v40, v40, v76
    v_add_f32 v25, v25, v53
    v_mul_f32 v76, 0xbec3ef15, v78
    v_mul_f32 v53, 0x3f6c835e, v78
    v_fmac_f32 v76, 0xbf6c835e, v45
    v_fmac_f32 v53, 0xbec3ef15, v45
    v_sub_f32 v78, v56, v18
    v_sub_f32 v45, v31, v55
    v_add_f32 v56, v56, v18
    v_add_f32 v31, v31, v55
    v_mul_f32 v18, 0xbf3504f3, v78
    v_mul_f32 v55, 0x3f3504f3, v78
    v_fmac_f32 v18, 0xbf3504f3, v45
    v_fmac_f32 v55, 0xbf3504f3, v45
    v_sub_f32 v78, v80, v72
    v_sub_f32 v45, v35, v59
    v_add_f32 v80, v80, v72
    v_add_f32 v35, v35, v59
    v_mul_f32 v72, 0xbf6c835e, v78
    v_mul_f32 v59, 0x3ec3ef15, v78
    v_fmac_f32 v72, 0xbec3ef15, v45
    v_fmac_f32 v59, 0xbf6c835e, v45
    v_sub_f32 v78, v82, v48
    v_sub_f32 v45, v17, v27
    v_add_f32 v82, v82, v48
    v_add_f32 v17, v17, v27
    v_sub_f32 v48, v26, v68
    v_sub_f32 v27, v49, v39
    v_add_f32 v26, v26, v68
    v_add_f32 v49, v49, v39
    v_mul_f32 v68, 0x3f3504f3, v48
    v_mul_f32 v39, 0x3f3504f3, v48
    v_fmac_f32 v68, 0xbf3504f3, v27
    v_fmac_f32 v39, 0x3f3504f3, v27
    v_sub_f32 v48, v29, v19
    v_sub_f32 v27, v16, v62
    v_add_f32 v16, v16, v62
    v_add_f32 v19, v19, v29
    v_sub_f32 v62, v74, v66
    v_sub_f32 v29, v23, v37
    v_add_f32 v74, v74, v66
    v_add_f32 v23, v23, v37
    v_mul_f32 v66, 0xbf3504f3, v62
    v_mul_f32 v37, 0x3f3504f3, v62
    v_fmac_f32 v66, 0xbf3504f3, v29
    v_fmac_f32 v37, 0xbf3504f3, v29
    v_sub_f32 v62, v32, v54
    v_sub_f32 v29, v81, v43
    v_add_f32 v32, v32, v54
    v_add_f32 v81, v81, v43
    v_sub_f32 v54, v44, v28
    v_sub_f32 v43, v71, v57
    v_add_f32 v44, v44, v28
    v_add_f32 v71, v71, v57
    v_mul_f32 v28, 0x3f3504f3, v54
    v_mul_f32 v57, 0x3f3504f3, v54
    v_fmac_f32 v28, 0xbf3504f3, v43
    v_fmac_f32 v57, 0x3f3504f3, v43
    v_sub_f32 v54, v63, v61
    v_sub_f32 v43, v52, v36
    v_add_f32 v52, v52, v36
    v_add_f32 v61, v61, v63
    v_sub_f32 v36, v58, v64
    v_sub_f32 v63, v69, v67
    v_add_f32 v58, v58, v64
    v_add_f32 v69, v69, v67
    v_mul_f32 v64, 0xbf3504f3, v36
    v_mul_f32 v67, 0x3f3504f3, v36
    v_fmac_f32 v64, 0xbf3504f3, v63
    v_fmac_f32 v67, 0xbf3504f3, v63
    v_sub_f32 v36, v70, v60
    v_sub_f32 v63, v79, v65
    v_add_f32 v70, v70, v60
    v_add_f32 v79, v79, v65
    v_sub_f32 v60, v30, v40
    v_sub_f32 v65, v77, v25
    v_add_f32 v30, v30, v40
    v_add_f32 v77, v77, v25
    v_mul_f32 v40, 0x3f3504f3, v60
    v_mul_f32 v25, 0x3f3504f3, v60
    v_fmac_f32 v40, 0xbf3504f3, v65
    v_fmac_f32 v25, 0x3f3504f3, v65
    v_sub_f32 v60, v31, v73
    v_sub_f32 v65, v34, v56
    v_add_f32 v34, v34, v56
    v_add_f32 v73, v73, v31
    v_sub_f32 v56, v42, v80
    v_sub_f32 v31, v21, v35
    v_add_f32 v42, v42, v80
    v_add_f32 v21, v21, v35
    v_mul_f32 v80, 0xbf3504f3, v56
    v_mul_f32 v35, 0x3f3504f3, v56
    v_fmac_f32 v80, 0xbf3504f3, v31
    v_fmac_f32 v35, 0xbf3504f3, v31
    v_sub_f32 v56, v38, v24
    v_sub_f32 v31, v41, v75
    v_add_f32 v38, v38, v24
    v_add_f32 v41, v41, v75
    v_sub_f32 v24, v46, v76
    v_sub_f32 v75, v33, v53
    v_add_f32 v46, v46, v76
    v_add_f32 v33, v33, v53
    v_mul_f32 v76, 0x3f3504f3, v24
    v_mul_f32 v53, 0x3f3504f3, v24
    v_fmac_f32 v76, 0xbf3504f3, v75
    v_fmac_f32 v53, 0x3f3504f3, v75
    v_sub_f32 v24, v55, v47
    v_sub_f32 v75, v50, v18
    v_add_f32 v50, v50, v18
    v_add_f32 v47, v47, v55
    v_sub_f32 v18, v83, v72
    v_sub_f32 v55, v51, v59
    v_add_f32 v83, v83, v72
    v_add_f32 v51, v51, v59
    v_mul_f32 v72, 0xbf3504f3, v18
    v_mul_f32 v59, 0x3f3504f3, v18
    v_fmac_f32 v72, 0xbf3504f3, v55
    v_fmac_f32 v59, 0xbf3504f3, v55
    v_sub_f32 v18, v82, v16
    v_sub_f32 v55, v17, v19
    v_add_f32 v82, v82, v16
    v_add_f32 v17, v17, v19
    v_sub_f32 v16, v23, v49
    v_sub_f32 v19, v26, v74
    v_add_f32 v26, v26, v74
    v_add_f32 v49, v49, v23
    v_sub_f32 v74, v78, v48
    v_sub_f32 v23, v45, v27
    v_add_f32 v78, v78, v48
    v_add_f32 v45, v45, v27
    v_sub_f32 v48, v37, v39
    v_sub_f32 v27, v68, v66
    v_add_f32 v68, v68, v66
    v_add_f32 v39, v39, v37
    v_sub_f32 v66, v32, v52
    v_sub_f32 v37, v81, v61
    v_add_f32 v32, v32, v52
    v_add_f32 v81, v81, v61
    v_sub_f32 v52, v69, v71
    v_sub_f32 v61, v44, v58
    v_add_f32 v44, v44, v58
    v_add_f32 v71, v71, v69
    v_sub_f32 v58, v62, v54
    v_sub_f32 v69, v29, v43
    v_add_f32 v62, v62, v54
    v_add_f32 v29, v29, v43
    v_sub_f32 v54, v67, v57
    v_sub_f32 v43, v28, v64
    v_add_f32 v28, v28, v64
    v_add_f32 v57, v57, v67
    v_sub_f32 v64, v70, v34
    v_sub_f32 v67, v79, v73
    v_add_f32 v70, v70, v34
    v_add_f32 v79, v79, v73
    v_sub_f32 v34, v21, v77
    v_sub_f32 v73, v30, v42
    v_add_f32 v30, v30, v42
    v_add_f32 v77, v77, v21
    v_sub_f32 v42, v36, v60
    v_sub_f32 v21, v63, v65
    v_add_f32 v36, v36, v60
    v_add_f32 v63, v63, v65
    v_sub_f32 v60, v35, v25
    v_sub_f32 v65, v40, v80
    v_add_f32 v40, v40, v80
    v_add_f32 v25, v25, v35
    v_sub_f32 v80, v38, v50
    v_sub_f32 v35, v41, v47
    v_add_f32 v38, v38, v50
    v_add_f32 v41, v41, v47
    v_sub_f32 v50, v51, v33
    v_sub_f32 v47, v46, v83
    v_add_f32 v46, v46, v83
    v_add_f32 v33, v33, v51
    v_sub_f32 v83, v56, v24
    v_sub_f32 v51, v31, v75
    v_add_f32 v56, v56, v24
    v_add_f32 v31, v31, v75
    v_sub_f32 v24, v59, v53
    v_sub_f32 v75, v76, v72
    v_add_f32 v76, v76, v72
    v_add_f32 v53, v53, v59
    v_sub_f32 v72, v82, v26
    v_sub_f32 v59, v17, v49
    v_add_f32 v82, v82, v26
    v_add_f32 v17, v17, v49
    v_sub_f32 v26, v18, v16
    v_sub_f32 v49, v55, v19
    v_add_f32 v18, v18, v16
    v_add_f32 v55, v55, v19
    v_sub_f32 v16, v78, v68
    v_sub_f32 v19, v45, v39
    v_add_f32 v78, v78, v68
    v_add_f32 v45, v45, v39
    v_sub_f32 v68, v74, v48
    v_sub_f32 v39, v23, v27
    v_add_f32 v74, v74, v48
    v_add_f32 v23, v23, v27
    v_sub_f32 v48, v32, v44
    v_sub_f32 v27, v81, v71
    v_add_f32 v32, v32, v44
    v_add_f32 v81, v81, v71
    v_sub_f32 v44, v66, v52
    v_sub_f32 v71, v37, v61
    v_add_f32 v66, v66, v52
    v_add_f32 v37, v37, v61
    v_sub_f32 v52, v62, v28
    v_sub_f32 v61, v29, v57
    v_add_f32 v62, v62, v28
    v_add_f32 v29, v29, v57
    v_sub_f32 v28, v58, v54
    v_sub_f32 v57, v69, v43
    v_add_f32 v58, v58, v54
    v_add_f32 v69, v69, v43
    v_sub_f32 v54, v70, v30
    v_sub_f32 v43, v79, v77
    v_add_f32 v70, v70, v30
    v_add_f32 v79, v79, v77
    v_sub_f32 v30, v64, v34
    v_sub_f32 v77, v67, v73
    v_add_f32 v64, v64, v34
    v_add_f32 v67, v67, v73
    v_sub_f32 v34, v36, v40
    v_sub_f32 v73, v63, v25
    v_add_f32 v36, v36, v40
    v_add_f32 v63, v63, v25
    v_sub_f32 v40, v42, v60
    v_sub_f32 v25, v21, v65
    v_add_f32 v42, v42, v60
    v_add_f32 v21, v21, v65
    v_sub_f32 v60, v38, v46
    v_sub_f32 v65, v41, v33
    v_add_f32 v38, v38, v46
    v_add_f32 v41, v41, v33
    v_sub_f32 v46, v80, v50
    v_sub_f32 v33, v35, v47
    v_add_f32 v80, v80, v50
    v_add_f32 v35, v35, v47
    v_sub_f32 v50, v56, v76
    v_sub_f32 v47, v31, v53
    v_add_f32 v56, v56, v76
    v_add_f32 v31, v31, v53
    v_sub_f32 v76, v83, v24
    v_sub_f32 v53, v51, v75
    v_add_f32 v83, v83, v24
    v_add_f32 v51, v51, v75
    v_mul_f32 v12, v10, v8
    v_mul_f32 v12, 0x3a000000, v12
    v_mov_b32 v24, v12
    v_fmac_f32 v24, 0x00000000, v8
    v_cos_f32 v75, v24
    v_sin_f32 v22, v24
    s_nop 0
    v_mul_f32 v20, v82, v75
    v_fma_f32 v20, -v17, v22, v20
    v_mul_f32 v17, v17, v75
    v_fmac_f32 v17, v82, v22
    v_mov_b32 v24, v12
    v_fmac_f32 v24, 0x3a800000, v8
    v_cos_f32 v75, v24
    v_sin_f32 v22, v24
    s_nop 0
    v_mul_f32 v82, v70, v75
    v_fma_f32 v82, -v79, v22, v82
    v_mul_f32 v79, v79, v75
    v_fmac_f32 v79, v70, v22
    v_mov_b32 v24, v12
    v_fmac_f32 v24, 0x3b000000, v8
    v_cos_f32 v75, v24
    v_sin_f32 v22, v24
    s_nop 0
    v_mul_f32 v70, v32, v75
    v_fma_f32 v70, -v81, v22, v70
    v_mul_f32 v81, v81, v75
    v_fmac_f32 v81, v32, v22
    v_mov_b32 v24, v12
    v_fmac_f32 v24, 0x3b400000, v8
    v_cos_f32 v75, v24
    v_sin_f32 v22, v24
    s_nop 0
    v_mul_f32 v32, v38, v75
    v_fma_f32 v32, -v41, v22, v32
    v_mul_f32 v41, v41, v75
    v_fmac_f32 v41, v38, v22
    v_mov_b32 v24, v12
    v_fmac_f32 v24, 0x3b800000, v8
    v_cos_f32 v75, v24
    v_sin_f32 v22, v24
    s_nop 0
    v_mul_f32 v38, v78, v75
    v_fma_f32 v38, -v45, v22, v38
    v_mul_f32 v45, v45, v75
    v_fmac_f32 v45, v78, v22
    v_mov_b32 v24, v12
    v_fmac_f32 v24, 0x3ba00000, v8
    v_cos_f32 v75, v24
    v_sin_f32 v22, v24
    s_nop 0
    v_mul_f32 v78, v36, v75
    v_fma_f32 v78, -v63, v22, v78
    v_mul_f32 v63, v63, v75
    v_fmac_f32 v63, v36, v22
    v_mov_b32 v24, v12
    v_fmac_f32 v24, 0x3bc00000, v8
    v_cos_f32 v75, v24
    v_sin_f32 v22, v24
    s_nop 0
    v_mul_f32 v36, v62, v75
    v_fma_f32 v36, -v29, v22, v36
    v_mul_f32 v29, v29, v75
    v_fmac_f32 v29, v62, v22
    v_mov_b32 v24, v12
    v_fmac_f32 v24, 0x3be00000, v8
    v_cos_f32 v75, v24
    v_sin_f32 v22, v24
    s_nop 0
    v_mul_f32 v62, v56, v75
    v_fma_f32 v62, -v31, v22, v62
    v_mul_f32 v31, v31, v75
    v_fmac_f32 v31, v56, v22
    v_mov_b32 v24, v12
    v_fmac_f32 v24, 0x3c000000, v8
    v_cos_f32 v75, v24
    v_sin_f32 v22, v24
    s_nop 0
    v_mul_f32 v56, v18, v75
    v_fma_f32 v56, -v55, v22, v56
    v_mul_f32 v55, v55, v75
    v_fmac_f32 v55, v18, v22
    v_mov_b32 v24, v12
    v_fmac_f32 v24, 0x3c100000, v8
    v_cos_f32 v75, v24
    v_sin_f32 v22, v24
    s_nop 0
    v_mul_f32 v18, v64, v75
    v_fma_f32 v18, -v67, v22, v18
    v_mul_f32 v67, v67, v75
    v_fmac_f32 v67, v64, v22
    v_mov_b32 v24, v12
    v_fmac_f32 v24, 0x3c200000, v8
    v_cos_f32 v75, v24
    v_sin_f32 v22, v24
    s_nop 0
    v_mul_f32 v64, v66, v75
    v_fma_f32 v64, -v37, v22, v64
    v_mul_f32 v37, v37, v75
    v_fmac_f32 v37, v66, v22
    v_mov_b32 v24, v12
    v_fmac_f32 v24, 0x3c300000, v8
    v_cos_f32 v75, v24
    v_sin_f32 v22, v24
    s_nop 0
    v_mul_f32 v66, v80, v75
    v_fma_f32 v66, -v35, v22, v66
    v_mul_f32 v35, v35, v75
    v_fmac_f32 v35, v80, v22
    v_mov_b32 v24, v12
    v_fmac_f32 v24, 0x3c400000, v8
    v_cos_f32 v75, v24
    v_sin_f32 v22, v24
    s_nop 0
    v_mul_f32 v80, v74, v75
    v_fma_f32 v80, -v23, v22, v80
    v_mul_f32 v23, v23, v75
    v_fmac_f32 v23, v74, v22
    v_mov_b32 v24, v12
    v_fmac_f32 v24, 0x3c500000, v8
    v_cos_f32 v75, v24
    v_sin_f32 v22, v24
    s_nop 0
    v_mul_f32 v74, v42, v75
    v_fma_f32 v74, -v21, v22, v74
    v_mul_f32 v21, v21, v75
    v_fmac_f32 v21, v42, v22
    v_mov_b32 v24, v12
    v_fmac_f32 v24, 0x3c600000, v8
    v_cos_f32 v75, v24
    v_sin_f32 v22, v24
    s_nop 0
    v_mul_f32 v42, v58, v75
    v_fma_f32 v42, -v69, v22, v42
    v_mul_f32 v69, v69, v75
    v_fmac_f32 v69, v58, v22
    v_mov_b32 v24, v12
    v_fmac_f32 v24, 0x3c700000, v8
    v_cos_f32 v75, v24
    v_sin_f32 v22, v24
    s_nop 0
    v_mul_f32 v58, v83, v75
    v_fma_f32 v58, -v51, v22, v58
    v_mul_f32 v51, v51, v75
    v_fmac_f32 v51, v83, v22
    v_mov_b32 v24, v12
    v_fmac_f32 v24, 0x3c800000, v8
    v_cos_f32 v75, v24
    v_sin_f32 v22, v24
    s_nop 0
    v_mul_f32 v83, v72, v75
    v_fma_f32 v83, -v59, v22, v83
    v_mul_f32 v59, v59, v75
    v_fmac_f32 v59, v72, v22
    v_mov_b32 v24, v12
    v_fmac_f32 v24, 0x3c880000, v8
    v_cos_f32 v75, v24
    v_sin_f32 v22, v24
    s_nop 0
    v_mul_f32 v72, v54, v75
    v_fma_f32 v72, -v43, v22, v72
    v_mul_f32 v43, v43, v75
    v_fmac_f32 v43, v54, v22
    v_mov_b32 v24, v12
    v_fmac_f32 v24, 0x3c900000, v8
    v_cos_f32 v75, v24
    v_sin_f32 v22, v24
    s_nop 0
    v_mul_f32 v54, v48, v75
    v_fma_f32 v54, -v27, v22, v54
    v_mul_f32 v27, v27, v75
    v_fmac_f32 v27, v48, v22
    v_mov_b32 v24, v12
    v_fmac_f32 v24, 0x3c980000, v8
    v_cos_f32 v75, v24
    v_sin_f32 v22, v24
    s_nop 0
    v_mul_f32 v48, v60, v75
    v_fma_f32 v48, -v65, v22, v48
    v_mul_f32 v65, v65, v75
    v_fmac_f32 v65, v60, v22
    v_mov_b32 v24, v12
    v_fmac_f32 v24, 0x3ca00000, v8
    v_cos_f32 v75, v24
    v_sin_f32 v22, v24
    s_nop 0
    v_mul_f32 v60, v16, v75
    v_fma_f32 v60, -v19, v22, v60
    v_mul_f32 v19, v19, v75
    v_fmac_f32 v19, v16, v22
    v_mov_b32 v24, v12
    v_fmac_f32 v24, 0x3ca80000, v8
    v_cos_f32 v75, v24
    v_sin_f32 v22, v24
    s_nop 0
    v_mul_f32 v16, v34, v75
    v_fma_f32 v16, -v73, v22, v16
    v_mul_f32 v73, v73, v75
    v_fmac_f32 v73, v34, v22
    v_mov_b32 v24, v12
    v_fmac_f32 v24, 0x3cb00000, v8
    v_cos_f32 v75, v24
    v_sin_f32 v22, v24
    s_nop 0
    v_mul_f32 v34, v52, v75
    v_fma_f32 v34, -v61, v22, v34
    v_mul_f32 v61, v61, v75
    v_fmac_f32 v61, v52, v22
    v_mov_b32 v24, v12
    v_fmac_f32 v24, 0x3cb80000, v8
    v_cos_f32 v75, v24
    v_sin_f32 v22, v24
    s_nop 0
    v_mul_f32 v52, v50, v75
    v_fma_f32 v52, -v47, v22, v52
    v_mul_f32 v47, v47, v75
    v_fmac_f32 v47, v50, v22
    v_mov_b32 v24, v12
    v_fmac_f32 v24, 0x3cc00000, v8
    v_cos_f32 v75, v24
    v_sin_f32 v22, v24
    s_nop 0
    v_mul_f32 v50, v26, v75
    v_fma_f32 v50, -v49, v22, v50
    v_mul_f32 v49, v49, v75
    v_fmac_f32 v49, v26, v22
    v_mov_b32 v24, v12
    v_fmac_f32 v24, 0x3cc80000, v8
    v_cos_f32 v75, v24
    v_sin_f32 v22, v24
    s_nop 0
    v_mul_f32 v26, v30, v75
    v_fma_f32 v26, -v77, v22, v26
    v_mul_f32 v77, v77, v75
    v_fmac_f32 v77, v30, v22
    v_mov_b32 v24, v12
    v_fmac_f32 v24, 0x3cd00000, v8
    v_cos_f32 v75, v24
    v_sin_f32 v22, v24
    s_nop 0
    v_mul_f32 v30, v44, v75
    v_fma_f32 v30, -v71, v22, v30
    v_mul_f32 v71, v71, v75
    v_fmac_f32 v71, v44, v22
    v_mov_b32 v24, v12
    v_fmac_f32 v24, 0x3cd80000, v8
    v_cos_f32 v75, v24
    v_sin_f32 v22, v24
    s_nop 0
    v_mul_f32 v44, v46, v75
    v_fma_f32 v44, -v33, v22, v44
    v_mul_f32 v33, v33, v75
    v_fmac_f32 v33, v46, v22
    v_mov_b32 v24, v12
    v_fmac_f32 v24, 0x3ce00000, v8
    v_cos_f32 v75, v24
    v_sin_f32 v22, v24
    s_nop 0
    v_mul_f32 v46, v68, v75
    v_fma_f32 v46, -v39, v22, v46
    v_mul_f32 v39, v39, v75
    v_fmac_f32 v39, v68, v22
    v_mov_b32 v24, v12
    v_fmac_f32 v24, 0x3ce80000, v8
    v_cos_f32 v75, v24
    v_sin_f32 v22, v24
    s_nop 0
    v_mul_f32 v68, v40, v75
    v_fma_f32 v68, -v25, v22, v68
    v_mul_f32 v25, v25, v75
    v_fmac_f32 v25, v40, v22
    v_mov_b32 v24, v12
    v_fmac_f32 v24, 0x3cf00000, v8
    v_cos_f32 v75, v24
    v_sin_f32 v22, v24
    s_nop 0
    v_mul_f32 v40, v28, v75
    v_fma_f32 v40, -v57, v22, v40
    v_mul_f32 v57, v57, v75
    v_fmac_f32 v57, v28, v22
    v_mov_b32 v24, v12
    v_fmac_f32 v24, 0x3cf80000, v8
    v_cos_f32 v75, v24
    v_sin_f32 v22, v24
    s_nop 0
    v_mul_f32 v28, v76, v75
    v_fma_f32 v28, -v53, v22, v28
    v_mul_f32 v53, v53, v75
    v_fmac_f32 v53, v76, v22
    ds_write_b32 v4, v20 offset:0
    ds_write_b32 v4, v17 offset:4
    ds_write_b32 v4, v82 offset:16
    ds_write_b32 v4, v79 offset:20
    ds_write_b32 v4, v70 offset:32
    ds_write_b32 v4, v81 offset:36
    ds_write_b32 v4, v32 offset:48
    ds_write_b32 v4, v41 offset:52
    ds_write_b32 v4, v38 offset:64
    ds_write_b32 v4, v45 offset:68
    ds_write_b32 v4, v78 offset:80
    ds_write_b32 v4, v63 offset:84
    ds_write_b32 v4, v36 offset:96
    ds_write_b32 v4, v29 offset:100
    ds_write_b32 v4, v62 offset:112
    ds_write_b32 v4, v31 offset:116
    ds_write_b32 v4, v56 offset:128
    ds_write_b32 v4, v55 offset:132
    ds_write_b32 v4, v18 offset:144
    ds_write_b32 v4, v67 offset:148
    ds_write_b32 v4, v64 offset:160
    ds_write_b32 v4, v37 offset:164
    ds_write_b32 v4, v66 offset:176
    ds_write_b32 v4, v35 offset:180
    ds_write_b32 v4, v80 offset:192
    ds_write_b32 v4, v23 offset:196
    ds_write_b32 v4, v74 offset:208
    ds_write_b32 v4, v21 offset:212
    ds_write_b32 v4, v42 offset:224
    ds_write_b32 v4, v69 offset:228
    ds_write_b32 v4, v58 offset:240
    ds_write_b32 v4, v51 offset:244
    ds_write_b32 v4, v83 offset:256
    ds_write_b32 v4, v59 offset:260
    ds_write_b32 v4, v72 offset:272
    ds_write_b32 v4, v43 offset:276
    ds_write_b32 v4, v54 offset:288
    ds_write_b32 v4, v27 offset:292
    ds_write_b32 v4, v48 offset:304
    ds_write_b32 v4, v65 offset:308
    ds_write_b32 v4, v60 offset:320
    ds_write_b32 v4, v19 offset:324
    ds_write_b32 v4, v16 offset:336
    ds_write_b32 v4, v73 offset:340
    ds_write_b32 v4, v34 offset:352
    ds_write_b32 v4, v61 offset:356
    ds_write_b32 v4, v52 offset:368
    ds_write_b32 v4, v47 offset:372
    ds_write_b32 v4, v50 offset:384
    ds_write_b32 v4, v49 offset:388
    ds_write_b32 v4, v26 offset:400
    ds_write_b32 v4, v77 offset:404
    ds_write_b32 v4, v30 offset:416
    ds_write_b32 v4, v71 offset:420
    ds_write_b32 v4, v44 offset:432
    ds_write_b32 v4, v33 offset:436
    ds_write_b32 v4, v46 offset:448
    ds_write_b32 v4, v39 offset:452
    ds_write_b32 v4, v68 offset:464
    ds_write_b32 v4, v25 offset:468
    ds_write_b32 v4, v40 offset:480
    ds_write_b32 v4, v57 offset:484
    ds_write_b32 v4, v28 offset:496
    ds_write_b32 v4, v53 offset:500
    s_waitcnt lgkmcnt(0)
    ds_read_b32 v20, v3 offset:0
    ds_read_b32 v17, v3 offset:4
    ds_read_b32 v82, v3 offset:528
    ds_read_b32 v79, v3 offset:532
    ds_read_b32 v70, v3 offset:1056
    ds_read_b32 v81, v3 offset:1060
    ds_read_b32 v32, v3 offset:1584
    ds_read_b32 v41, v3 offset:1588
    ds_read_b32 v38, v3 offset:2112
    ds_read_b32 v45, v3 offset:2116
    ds_read_b32 v78, v3 offset:2640
    ds_read_b32 v63, v3 offset:2644
    ds_read_b32 v36, v3 offset:3168
    ds_read_b32 v29, v3 offset:3172
    s_waitcnt lgkmcnt(0)
    ds_read_b32 v62, v3 offset:3696
    ds_read_b32 v31, v3 offset:3700
    ds_read_b32 v56, v3 offset:4224
    ds_read_b32 v55, v3 offset:4228
    ds_read_b32 v18, v3 offset:4752
    ds_read_b32 v67, v3 offset:4756
    ds_read_b32 v64, v3 offset:5280
    ds_read_b32 v37, v3 offset:5284
    ds_read_b32 v66, v3 offset:5808
    ds_read_b32 v35, v3 offset:5812
    ds_read_b32 v80, v3 offset:6336
    ds_read_b32 v23, v3 offset:6340
    ds_read_b32 v74, v3 offset:6864
    ds_read_b32 v21, v3 offset:6868
    s_waitcnt lgkmcnt(0)
    ds_read_b32 v42, v3 offset:7392
    ds_read_b32 v69, v3 offset:7396
    ds_read_b32 v58, v3 offset:7920
    ds_read_b32 v51, v3 offset:7924
    ds_read_b32 v83, v3 offset:8448
    ds_read_b32 v59, v3 offset:8452
    ds_read_b32 v72, v3 offset:8976
    ds_read_b32 v43, v3 offset:8980
    ds_read_b32 v54, v3 offset:9504
    ds_read_b32 v27, v3 offset:9508
    ds_read_b32 v48, v3 offset:10032
    ds_read_b32 v65, v3 offset:10036
    ds_read_b32 v60, v3 offset:10560
    ds_read_b32 v19, v3 offset:10564
    s_waitcnt lgkmcnt(0)
    ds_read_b32 v16, v3 offset:11088
    ds_read_b32 v73, v3 offset:11092
    ds_read_b32 v34, v3 offset:11616
    ds_read_b32 v61, v3 offset:11620
    ds_read_b32 v52, v3 offset:12144
    ds_read_b32 v47, v3 offset:12148
    ds_read_b32 v50, v3 offset:12672
    ds_read_b32 v49, v3 offset:12676
    ds_read_b32 v26, v3 offset:13200
    ds_read_b32 v77, v3 offset:13204
    ds_read_b32 v30, v3 offset:13728
    ds_read_b32 v71, v3 offset:13732
    ds_read_b32 v44, v3 offset:14256
    ds_read_b32 v33, v3 offset:14260
    s_waitcnt lgkmcnt(0)
    ds_read_b32 v46, v3 offset:14784
    ds_read_b32 v39, v3 offset:14788
    ds_read_b32 v68, v3 offset:15312
    ds_read_b32 v25, v3 offset:15316
    ds_read_b32 v40, v3 offset:15840
    ds_read_b32 v57, v3 offset:15844
    ds_read_b32 v28, v3 offset:16368
    ds_read_b32 v53, v3 offset:16372
    s_waitcnt lgkmcnt(0)
    v_sub_f32 v24, v20, v83
    v_sub_f32 v75, v17, v59
    v_add_f32 v20, v20, v83
    v_add_f32 v17, v17, v59
    v_sub_f32 v83, v82, v72
    v_sub_f32 v59, v79, v43
    v_add_f32 v82, v82, v72
    v_add_f32 v79, v79, v43
    v_mul_f32 v72, 0x3f7b14be, v83
    v_mul_f32 v43, 0x3e47c5c2, v83
    v_fmac_f32 v72, 0xbe47c5c2, v59
    v_fmac_f32 v43, 0x3f7b14be, v59
    v_sub_f32 v83, v70, v54
    v_sub_f32 v59, v81, v27
    v_add_f32 v70, v70, v54
    v_add_f32 v81, v81, v27
    v_mul_f32 v54, 0x3f6c835e, v83
    v_mul_f32 v27, 0x3ec3ef15, v83
    v_fmac_f32 v54, 0xbec3ef15, v59
    v_fmac_f32 v27, 0x3f6c835e, v59
    v_sub_f32 v83, v32, v48
    v_sub_f32 v59, v41, v65
    v_add_f32 v32, v32, v48
    v_add_f32 v41, v41, v65
    v_mul_f32 v48, 0x3f54db31, v83
    v_mul_f32 v65, 0x3f0e39da, v83
    v_fmac_f32 v48, 0xbf0e39da, v59
    v_fmac_f32 v65, 0x3f54db31, v59
    v_sub_f32 v83, v38, v60
    v_sub_f32 v59, v45, v19
    v_add_f32 v38, v38, v60
    v_add_f32 v45, v45, v19
    v_mul_f32 v60, 0x3f3504f3, v83
    v_mul_f32 v19, 0x3f3504f3, v83
    v_fmac_f32 v60, 0xbf3504f3, v59
    v_fmac_f32 v19, 0x3f3504f3, v59
    v_sub_f32 v83, v78, v16
    v_sub_f32 v59, v63, v73
    v_add_f32 v78, v78, v16
    v_add_f32 v63, v63, v73
    v_mul_f32 v16, 0x3f0e39da, v83
    v_mul_f32 v73, 0x3f54db31, v83
    v_fmac_f32 v16, 0xbf54db31, v59
    v_fmac_f32 v73, 0x3f0e39da, v59
    v_sub_f32 v83, v36, v34
    v_sub_f32 v59, v29, v61
    v_add_f32 v36, v36, v34
    v_add_f32 v29, v29, v61
    v_mul_f32 v34, 0x3ec3ef15, v83
    v_mul_f32 v61, 0x3f6c835e, v83
    v_fmac_f32 v34, 0xbf6c835e, v59
    v_fmac_f32 v61, 0x3ec3ef15, v59
    v_sub_f32 v83, v62, v52
    v_sub_f32 v59, v31, v47
    v_add_f32 v62, v62, v52
    v_add_f32 v31, v31, v47
    v_mul_f32 v52, 0x3e47c5c2, v83
    v_mul_f32 v47, 0x3f7b14be, v83
    v_fmac_f32 v52, 0xbf7b14be, v59
    v_fmac_f32 v47, 0x3e47c5c2, v59
    v_sub_f32 v83, v49, v55
    v_sub_f32 v59, v56, v50
    v_add_f32 v56, v56, v50
    v_add_f32 v55, v55, v49
    v_sub_f32 v50, v18, v26
    v_sub_f32 v49, v67, v77
    v_add_f32 v18, v18, v26
    v_add_f32 v67, v67, v77
    v_mul_f32 v26, 0xbe47c5c2, v50
    v_mul_f32 v77, 0x3f7b14be, v50
    v_fmac_f32 v26, 0xbf7b14be, v49
    v_fmac_f32 v77, 0xbe47c5c2, v49
    v_sub_f32 v50, v64, v30
    v_sub_f32 v49, v37, v71
    v_add_f32 v64, v64, v30
    v_add_f32 v37, v37, v71
    v_mul_f32 v30, 0xbec3ef15, v50
    v_mul_f32 v71, 0x3f6c835e, v50
    v_fmac_f32 v30, 0xbf6c835e, v49
    v_fmac_f32 v71, 0xbec3ef15, v49
    v_sub_f32 v50, v66, v44
    v_sub_f32 v49, v35, v33
    v_add_f32 v66, v66, v44
    v_add_f32 v35, v35, v33
    v_mul_f32 v44, 0xbf0e39da, v50
    v_mul_f32 v33, 0x3f54db31, v50
    v_fmac_f32 v44, 0xbf54db31, v49
    v_fmac_f32 v33, 0xbf0e39da, v49
    v_sub_f32 v50, v80, v46
    v_sub_f32 v49, v23, v39
    v_add_f32 v80, v80, v46
    v_add_f32 v23, v23, v39
    v_mul_f32 v46, 0xbf3504f3, v50
    v_mul_f32 v39, 0x3f3504f3, v50
    v_fmac_f32 v46, 0xbf3504f3, v49
    v_fmac_f32 v39, 0xbf3504f3, v49
    v_sub_f32 v50, v74, v68
    v_sub_f32 v49, v21, v25
    v_add_f32 v74, v74, v68
    v_add_f32 v21, v21, v25
    v_mul_f32 v68, 0xbf54db31, v50
    v_mul_f32 v25, 0x3f0e39da, v50
    v_fmac_f32 v68, 0xbf0e39da, v49
    v_fmac_f32 v25, 0xbf54db31, v49
    v_sub_f32 v50, v42, v40
    v_sub_f32 v49, v69, v57
    v_add_f32 v42, v42, v40
    v_add_f32 v69, v69, v57
    v_mul_f32 v40, 0xbf6c835e, v50
    v_mul_f32 v57, 0x3ec3ef15, v50
    v_fmac_f32 v40, 0xbec3ef15, v49
    v_fmac_f32 v57, 0xbf6c835e, v49
    v_sub_f32 v50, v58, v28
    v_sub_f32 v49, v51, v53
    v_add_f32 v58, v58, v28
    v_add_f32 v51, v51, v53
    v_mul_f32 v28, 0xbf7b14be, v50
    v_mul_f32 v53, 0x3e47c5c2, v50
    v_fmac_f32 v28, 0xbe47c5c2, v49
    v_fmac_f32 v53, 0xbf7b14be, v49
    v_sub_f32 v50, v20, v56
    v_sub_f32 v49, v17, v55
    v_add_f32 v20, v20, v56
    v_add_f32 v17, v17, v55
    v_sub_f32 v56, v82, v18
    v_sub_f32 v55, v79, v67
    v_add_f32 v82, v82, v18
    v_add_f32 v79, v79, v67
    v_mul_f32 v18, 0x3f6c835e, v56
    v_mul_f32 v67, 0x3ec3ef15, v56
    v_fmac_f32 v18, 0xbec3ef15, v55
    v_fmac_f32 v67, 0x3f6c835e, v55
    v_sub_f32 v56, v70, v64
    v_sub_f32 v55, v81, v37
    v_add_f32 v70, v70, v64
    v_add_f32 v81, v81, v37
    v_mul_f32 v64, 0x3f3504f3, v56
    v_mul_f32 v37, 0x3f3504f3, v56
    v_fmac_f32 v64, 0xbf3504f3, v55
    v_fmac_f32 v37, 0x3f3504f3, v55
    v_sub_f32 v56, v32, v66
    v_sub_f32 v55, v41, v35
    v_add_f32 v32, v32, v66
    v_add_f32 v41, v41, v35
    v_mul_f32 v66, 0x3ec3ef15, v56
    v_mul_f32 v35, 0x3f6c835e, v56
    v_fmac_f32 v66, 0xbf6c835e, v55
    v_fmac_f32 v35, 0x3ec3ef15, v55
    v_sub_f32 v56, v23, v45
    v_sub_f32 v55, v38, v80
    v_add_f32 v38, v38, v80
    v_add_f32 v45, v45, v23
    v_sub_f32 v80, v78, v74
    v_sub_f32 v23, v63, v21
    v_add_f32 v78, v78, v74
    v_add_f32 v63, v63, v21
    v_mul_f32 v74, 0xbec3ef15, v80
    v_mul_f32 v21, 0x3f6c835e, v80
    v_fmac_f32 v74, 0xbf6c835e, v23
    v_fmac_f32 v21, 0xbec3ef15, v23
    v_sub_f32 v80, v36, v42
    v_sub_f32 v23, v29, v69
    v_add_f32 v36, v36, v42
    v_add_f32 v29, v29, v69
    v_mul_f32 v42, 0xbf3504f3, v80
    v_mul_f32 v69, 0x3f3504f3, v80
    v_fmac_f32 v42, 0xbf3504f3, v23
    v_fmac_f32 v69, 0xbf3504f3, v23
    v_sub_f32 v80, v62, v58
    v_sub_f32 v23, v31, v51
    v_add_f32 v62, v62, v58
    v_add_f32 v31, v31, v51
    v_mul_f32 v58, 0xbf6c835e, v80
    v_mul_f32 v51, 0x3ec3ef15, v80
    v_fmac_f32 v58, 0xbec3ef15, v23
    v_fmac_f32 v51, 0xbf6c835e, v23
    v_sub_f32 v80, v24, v83
    v_sub_f32 v23, v75, v59
    v_add_f32 v24, v24, v83
    v_add_f32 v75, v75, v59
    v_sub_f32 v83, v72, v26
    v_sub_f32 v59, v43, v77
    v_add_f32 v72, v72, v26
    v_add_f32 v43, v43, v77
    v_mul_f32 v26, 0x3f6c835e, v83
    v_mul_f32 v77, 0x3ec3ef15, v83
    v_fmac_f32 v26, 0xbec3ef15, v59
    v_fmac_f32 v77, 0x3f6c835e, v59
    v_sub_f32 v83, v54, v30
    v_sub_f32 v59, v27, v71
    v_add_f32 v54, v54, v30
    v_add_f32 v27, v27, v71
    v_mul_f32 v30, 0x3f3504f3, v83
    v_mul_f32 v71, 0x3f3504f3, v83
    v_fmac_f32 v30, 0xbf3504f3, v59
    v_fmac_f32 v71, 0x3f3504f3, v59
    v_sub_f32 v83, v48, v44
    v_sub_f32 v59, v65, v33
    v_add_f32 v48, v48, v44
    v_add_f32 v65, v65, v33
    v_mul_f32 v44, 0x3ec3ef15, v83
    v_mul_f32 v33, 0x3f6c835e, v83
    v_fmac_f32 v44, 0xbf6c835e, v59
    v_fmac_f32 v33, 0x3ec3ef15, v59
    v_sub_f32 v83, v39, v19
    v_sub_f32 v59, v60, v46
    v_add_f32 v60, v60, v46
    v_add_f32 v19, v19, v39
    v_sub_f32 v46, v16, v68
    v_sub_f32 v39, v73, v25
    v_add_f32 v16, v16, v68
    v_add_f32 v73, v73, v25
    v_mul_f32 v68, 0xbec3ef15, v46
    v_mul_f32 v25, 0x3f6c835e, v46
    v_fmac_f32 v68, 0xbf6c835e, v39
    v_fmac_f32 v25, 0xbec3ef15, v39
    v_sub_f32 v46, v34, v40
    v_sub_f32 v39, v61, v57
    v_add_f32 v34, v34, v40
    v_add_f32 v61, v61, v57
    v_mul_f32 v40, 0xbf3504f3, v46
    v_mul_f32 v57, 0x3f3504f3, v46
    v_fmac_f32 v40, 0xbf3504f3, v39
    v_fmac_f32 v57, 0xbf3504f3, v39
    v_sub_f32 v46, v52, v28
    v_sub_f32 v39, v47, v53
    v_add_f32 v52, v52, v28
    v_add_f32 v47, v47, v53
    v_mul_f32 v28, 0xbf6c835e, v46
    v_mul_f32 v53, 0x3ec3ef15, v46
    v_fmac_f32 v28, 0xbec3ef15, v39
    v_fmac_f32 v53, 0xbf6c835e, v39
    v_sub_f32 v46, v20, v38
    v_sub_f32 v39, v17, v45
    v_add_f32 v20, v20, v38
    v_add_f32 v17, v17, v45
    v_sub_f32 v38, v82, v78
    v_sub_f32 v45, v79, v63
    v_add_f32 v82, v82, v78
    v_add_f32 v79, v79, v63
    v_mul_f32 v78, 0x3f3504f3, v38
    v_mul_f32 v63, 0x3f3504f3, v38
    v_fmac_f32 v78, 0xbf3504f3, v45
    v_fmac_f32 v63, 0x3f3504f3, v45
    v_sub_f32 v38, v29, v81
    v_sub_f32 v45, v70, v36
    v_add_f32 v70, v70, v36
    v_add_f32 v81, v81, v29
    v_sub_f32 v36, v32, v62
    v_sub_f32 v29, v41, v31
    v_add_f32 v32, v32, v62
    v_add_f32 v41, v41, v31
    v_mul_f32 v62, 0xbf3504f3, v36
    v_mul_f32 v31, 0x3f3504f3, v36
    v_fmac_f32 v62, 0xbf3504f3, v29
    v_fmac_f32 v31, 0xbf3504f3, v29
    v_sub_f32 v36, v50, v56
    v_sub_f32 v29, v49, v55
    v_add_f32 v50, v50, v56
    v_add_f32 v49, v49, v55
    v_sub_f32 v56, v18, v74
    v_sub_f32 v55, v67, v21
    v_add_f32 v18, v18, v74
    v_add_f32 v67, v67, v21
    v_mul_f32 v74, 0x3f3504f3, v56
    v_mul_f32 v21, 0x3f3504f3, v56
    v_fmac_f32 v74, 0xbf3504f3, v55
    v_fmac_f32 v21, 0x3f3504f3, v55
    v_sub_f32 v56, v69, v37
    v_sub_f32 v55, v64, v42
    v_add_f32 v64, v64, v42
    v_add_f32 v37, v37, v69
    v_sub_f32 v42, v66, v58
    v_sub_f32 v69, v35, v51
    v_add_f32 v66, v66, v58
    v_add_f32 v35, v35, v51
    v_mul_f32 v58, 0xbf3504f3, v42
    v_mul_f32 v51, 0x3f3504f3, v42
    v_fmac_f32 v58, 0xbf3504f3, v69
    v_fmac_f32 v51, 0xbf3504f3, v69
    v_sub_f32 v42, v24, v60
    v_sub_f32 v69, v75, v19
    v_add_f32 v24, v24, v60
    v_add_f32 v75, v75, v19
    v_sub_f32 v60, v72, v16
    v_sub_f32 v19, v43, v73
    v_add_f32 v72, v72, v16
    v_add_f32 v43, v43, v73
    v_mul_f32 v16, 0x3f3504f3, v60
    v_mul_f32 v73, 0x3f3504f3, v60
    v_fmac_f32 v16, 0xbf3504f3, v19
    v_fmac_f32 v73, 0x3f3504f3, v19
    v_sub_f32 v60, v61, v27
    v_sub_f32 v19, v54, v34
    v_add_f32 v54, v54, v34
    v_add_f32 v27, v27, v61
    v_sub_f32 v34, v48, v52
    v_sub_f32 v61, v65, v47
    v_add_f32 v48, v48, v52
    v_add_f32 v65, v65, v47
    v_mul_f32 v52, 0xbf3504f3, v34
    v_mul_f32 v47, 0x3f3504f3, v34
    v_fmac_f32 v52, 0xbf3504f3, v61
    v_fmac_f32 v47, 0xbf3504f3, v61
    v_sub_f32 v34, v80, v83
    v_sub_f32 v61, v23, v59
    v_add_f32 v80, v80, v83
    v_add_f32 v23, v23, v59
    v_sub_f32 v83, v26, v68
    v_sub_f32 v59, v77, v25
    v_add_f32 v26, v26, v68
    v_add_f32 v77, v77, v25
    v_mul_f32 v68, 0x3f3504f3, v83
    v_mul_f32 v25, 0x3f3504f3, v83
    v_fmac_f32 v68, 0xbf3504f3, v59
    v_fmac_f32 v25, 0x3f3504f3, v59
    v_sub_f32 v83, v57, v71
    v_sub_f32 v59, v30, v40
    v_add_f32 v30, v30, v40
    v_add_f32 v71, v71, v57
    v_sub_f32 v40, v44, v28
    v_sub_f32 v57, v33, v53
    v_add_f32 v44, v44, v28
    v_add_f32 v33, v33, v53
    v_mul_f32 v28, 0xbf3504f3, v40
    v_mul_f32 v53, 0x3f3504f3, v40
    v_fmac_f32 v28, 0xbf3504f3, v57
    v_fmac_f32 v53, 0xbf3504f3, v57
    v_sub_f32 v40, v20, v70
    v_sub_f32 v57, v17, v81
    v_add_f32 v20, v20, v70
    v_add_f32 v17, v17, v81
    v_sub_f32 v70, v41, v79
    v_sub_f32 v81, v82, v32
    v_add_f32 v82, v82, v32
    v_add_f32 v79, v79, v41
    v_sub_f32 v32, v46, v38
    v_sub_f32 v41, v39, v45
    v_add_f32 v46, v46, v38
    v_add_f32 v39, v39, v45
    v_sub_f32 v38, v31, v63
    v_sub_f32 v45, v78, v62
    v_add_f32 v78, v78, v62
    v_add_f32 v63, v63, v31
    v_sub_f32 v62, v50, v64
    v_sub_f32 v31, v49, v37
    v_add_f32 v50, v50, v64
    v_add_f32 v49, v49, v37
    v_sub_f32 v64, v35, v67
    v_sub_f32 v37, v18, v66
    v_add_f32 v18, v18, v66
    v_add_f32 v67, v67, v35
    v_sub_f32 v66, v36, v56
    v_sub_f32 v35, v29, v55
    v_add_f32 v36, v36, v56
    v_add_f32 v29, v29, v55
    v_sub_f32 v56, v51, v21
    v_sub_f32 v55, v74, v58
    v_add_f32 v74, v74, v58
    v_add_f32 v21, v21, v51
    v_sub_f32 v58, v24, v54
    v_sub_f32 v51, v75, v27
    v_add_f32 v24, v24, v54
    v_add_f32 v75, v75, v27
    v_sub_f32 v54, v65, v43
    v_sub_f32 v27, v72, v48
    v_add_f32 v72, v72, v48
    v_add_f32 v43, v43, v65
    v_sub_f32 v48, v42, v60
    v_sub_f32 v65, v69, v19
    v_add_f32 v42, v42, v60
    v_add_f32 v69, v69, v19
    v_sub_f32 v60, v47, v73
    v_sub_f32 v19, v16, v52
    v_add_f32 v16, v16, v52
    v_add_f32 v73, v73, v47
    v_sub_f32 v52, v80, v30
    v_sub_f32 v47, v23, v71
    v_add_f32 v80, v80, v30
    v_add_f32 v23, v23, v71
    v_sub_f32 v30, v33, v77
    v_sub_f32 v71, v26, v44
    v_add_f32 v26, v26, v44
    v_add_f32 v77, v77, v33
    v_sub_f32 v44, v34, v83
    v_sub_f32 v33, v61, v59
    v_add_f32 v34, v34, v83
    v_add_f32 v61, v61, v59
    v_sub_f32 v83, v53, v25
    v_sub_f32 v59, v68, v28
    v_add_f32 v68, v68, v28
    v_add_f32 v25, v25, v53
    v_sub_f32 v28, v20, v82
    v_sub_f32 v53, v17, v79
    v_add_f32 v20, v20, v82
    v_add_f32 v17, v17, v79
    v_sub_f32 v82, v40, v70
    v_sub_f32 v79, v57, v81
    v_add_f32 v40, v40, v70
    v_add_f32 v57, v57, v81
    v_sub_f32 v70, v46, v78
    v_sub_f32 v81, v39, v63
    v_add_f32 v46, v46, v78
    v_add_f32 v39, v39, v63
    v_sub_f32 v78, v32, v38
    v_sub_f32 v63, v41, v45
    v_add_f32 v32, v32, v38
    v_add_f32 v41, v41, v45
    v_sub_f32 v38, v50, v18
    v_sub_f32 v45, v49, v67
    v_add_f32 v50, v50, v18
    v_add_f32 v49, v49, v67
    v_sub_f32 v18, v62, v64
    v_sub_f32 v67, v31, v37
    v_add_f32 v62, v62, v64
    v_add_f32 v31, v31, v37
    v_sub_f32 v64, v36, v74
    v_sub_f32 v37, v29, v21
    v_add_f32 v36, v36, v74
    v_add_f32 v29, v29, v21
    v_sub_f32 v74, v66, v56
    v_sub_f32 v21, v35, v55
    v_add_f32 v66, v66, v56
    v_add_f32 v35, v35, v55
    v_sub_f32 v56, v24, v72
    v_sub_f32 v55, v75, v43
    v_add_f32 v24, v24, v72
    v_add_f32 v75, v75, v43
    v_sub_f32 v72, v58, v54
    v_sub_f32 v43, v51, v27
    v_add_f32 v58, v58, v54
    v_add_f32 v51, v51, v27
    v_sub_f32 v54, v42, v16
    v_sub_f32 v27, v69, v73
    v_add_f32 v42, v42, v16
    v_add_f32 v69, v69, v73
    v_sub_f32 v16, v48, v60
    v_sub_f32 v73, v65, v19
    v_add_f32 v48, v48, v60
    v_add_f32 v65, v65, v19
    v_sub_f32 v60, v80, v26
    v_sub_f32 v19, v23, v77
    v_add_f32 v80, v80, v26
    v_add_f32 v23, v23, v77
    v_sub_f32 v26, v52, v30
    v_sub_f32 v77, v47, v71
    v_add_f32 v52, v52, v30
    v_add_f32 v47, v47, v71
    v_sub_f32 v30, v34, v68
    v_sub_f32 v71, v61, v25
    v_add_f32 v34, v34, v68
    v_add_f32 v61, v61, v25
    v_sub_f32 v68, v44, v83
    v_sub_f32 v25, v33, v59
    v_add_f32 v44, v44, v83
    v_add_f32 v33, v33, v59
    s_add_u32 s15, s14, 109051904
    v_lshlrev_b32 v5, 3, v1
    s_add_u32 s16, s15, 0
    v_mov_b32 v88, v20
    v_mov_b32 v89, v17
    buffer_store_dwordx2 v[88:89], v5, s[8:11], s16 offen sc1
    s_add_u32 s16, s15, 512
    v_mov_b32 v90, v24
    v_mov_b32 v91, v75
    buffer_store_dwordx2 v[90:91], v5, s[8:11], s16 offen sc1
    s_add_u32 s16, s15, 1024
    v_mov_b32 v92, v50
    v_mov_b32 v93, v49
    buffer_store_dwordx2 v[92:93], v5, s[8:11], s16 offen sc1
    s_add_u32 s16, s15, 1536
    v_mov_b32 v94, v80
    v_mov_b32 v95, v23
    buffer_store_dwordx2 v[94:95], v5, s[8:11], s16 offen sc1
    s_add_u32 s16, s15, 2048
    v_mov_b32 v96, v46
    v_mov_b32 v97, v39
    buffer_store_dwordx2 v[96:97], v5, s[8:11], s16 offen sc1
    s_add_u32 s16, s15, 2560
    v_mov_b32 v98, v42
    v_mov_b32 v99, v69
    buffer_store_dwordx2 v[98:99], v5, s[8:11], s16 offen sc1
    s_add_u32 s16, s15, 3072
    v_mov_b32 v100, v36
    v_mov_b32 v101, v29
    buffer_store_dwordx2 v[100:101], v5, s[8:11], s16 offen sc1
    s_add_u32 s16, s15, 3584
    v_mov_b32 v102, v34
    v_mov_b32 v103, v61
    buffer_store_dwordx2 v[102:103], v5, s[8:11], s16 offen sc1
    s_add_u32 s16, s15, 4096
    v_mov_b32 v88, v40
    v_mov_b32 v89, v57
    buffer_store_dwordx2 v[88:89], v5, s[8:11], s16 offen sc1
    s_add_u32 s16, s15, 4608
    v_mov_b32 v90, v58
    v_mov_b32 v91, v51
    buffer_store_dwordx2 v[90:91], v5, s[8:11], s16 offen sc1
    s_add_u32 s16, s15, 5120
    v_mov_b32 v92, v62
    v_mov_b32 v93, v31
    buffer_store_dwordx2 v[92:93], v5, s[8:11], s16 offen sc1
    s_add_u32 s16, s15, 5632
    v_mov_b32 v94, v52
    v_mov_b32 v95, v47
    buffer_store_dwordx2 v[94:95], v5, s[8:11], s16 offen sc1
    s_add_u32 s16, s15, 6144
    v_mov_b32 v96, v32
    v_mov_b32 v97, v41
    buffer_store_dwordx2 v[96:97], v5, s[8:11], s16 offen sc1
    s_add_u32 s16, s15, 6656
    v_mov_b32 v98, v48
    v_mov_b32 v99, v65
    buffer_store_dwordx2 v[98:99], v5, s[8:11], s16 offen sc1
    s_add_u32 s16, s15, 7168
    v_mov_b32 v100, v66
    v_mov_b32 v101, v35
    buffer_store_dwordx2 v[100:101], v5, s[8:11], s16 offen sc1
    s_add_u32 s16, s15, 7680
    v_mov_b32 v102, v44
    v_mov_b32 v103, v33
    buffer_store_dwordx2 v[102:103], v5, s[8:11], s16 offen sc1
    s_add_u32 s16, s15, 8192
    v_mov_b32 v88, v28
    v_mov_b32 v89, v53
    buffer_store_dwordx2 v[88:89], v5, s[8:11], s16 offen sc1
    s_add_u32 s16, s15, 8704
    v_mov_b32 v90, v56
    v_mov_b32 v91, v55
    buffer_store_dwordx2 v[90:91], v5, s[8:11], s16 offen sc1
    s_add_u32 s16, s15, 9216
    v_mov_b32 v92, v38
    v_mov_b32 v93, v45
    buffer_store_dwordx2 v[92:93], v5, s[8:11], s16 offen sc1
    s_add_u32 s16, s15, 9728
    v_mov_b32 v94, v60
    v_mov_b32 v95, v19
    buffer_store_dwordx2 v[94:95], v5, s[8:11], s16 offen sc1
    s_add_u32 s16, s15, 10240
    v_mov_b32 v96, v70
    v_mov_b32 v97, v81
    buffer_store_dwordx2 v[96:97], v5, s[8:11], s16 offen sc1
    s_add_u32 s16, s15, 10752
    v_mov_b32 v98, v54
    v_mov_b32 v99, v27
    buffer_store_dwordx2 v[98:99], v5, s[8:11], s16 offen sc1
    s_add_u32 s16, s15, 11264
    v_mov_b32 v100, v64
    v_mov_b32 v101, v37
    buffer_store_dwordx2 v[100:101], v5, s[8:11], s16 offen sc1
    s_add_u32 s16, s15, 11776
    v_mov_b32 v102, v30
    v_mov_b32 v103, v71
    buffer_store_dwordx2 v[102:103], v5, s[8:11], s16 offen sc1
    s_add_u32 s16, s15, 12288
    v_mov_b32 v88, v82
    v_mov_b32 v89, v79
    buffer_store_dwordx2 v[88:89], v5, s[8:11], s16 offen sc1
    s_add_u32 s16, s15, 12800
    v_mov_b32 v90, v72
    v_mov_b32 v91, v43
    buffer_store_dwordx2 v[90:91], v5, s[8:11], s16 offen sc1
    s_add_u32 s16, s15, 13312
    v_mov_b32 v92, v18
    v_mov_b32 v93, v67
    buffer_store_dwordx2 v[92:93], v5, s[8:11], s16 offen sc1
    s_add_u32 s16, s15, 13824
    v_mov_b32 v94, v26
    v_mov_b32 v95, v77
    buffer_store_dwordx2 v[94:95], v5, s[8:11], s16 offen sc1
    s_add_u32 s16, s15, 14336
    v_mov_b32 v96, v78
    v_mov_b32 v97, v63
    buffer_store_dwordx2 v[96:97], v5, s[8:11], s16 offen sc1
    s_add_u32 s16, s15, 14848
    v_mov_b32 v98, v16
    v_mov_b32 v99, v73
    buffer_store_dwordx2 v[98:99], v5, s[8:11], s16 offen sc1
    s_add_u32 s16, s15, 15360
    v_mov_b32 v100, v74
    v_mov_b32 v101, v21
    buffer_store_dwordx2 v[100:101], v5, s[8:11], s16 offen sc1
    s_add_u32 s16, s15, 15872
    v_mov_b32 v102, v68
    v_mov_b32 v103, v25
    buffer_store_dwordx2 v[102:103], v5, s[8:11], s16 offen sc1
mega_kernel_f2_end:
    s_cmp_eq_u32 s99, 128
    s_cbranch_scc1 mega_kernel_f2ret
    s_waitcnt vmcnt(0)
    s_barrier
    v_mov_b32 v2, 1
    v_cmp_eq_u32 vcc, 0, v0
    s_and_saveexec_b64 s[80:81], vcc
    s_cbranch_execz mega_kernel_sg136_5
    buffer_atomic_add v2, off, s[88:91], 0 offset:136 sc1
mega_kernel_sg136_5:
    s_mov_b64 exec, s[80:81]
mega_kernel_wf2:
    s_sleep 8
    buffer_load_dword v2, off, s[88:91], 0 offset:136 sc1
    s_waitcnt vmcnt(0)
    v_cmp_ne_u32 vcc, 129, v2
    s_cbranch_vccnz mega_kernel_wf2
    s_barrier
    s_load_dwordx2 s[4:5], s[0:1], 80
    s_load_dwordx2 s[8:9], s[0:1], 96
    v_and_b32 v6, 7, v0
    v_lshrrev_b32 v7, 3, v0
    s_movk_i32 s13, 8448
    v_mul_lo_u32 v8, v6, s13
    v_lshl_add_u32 v4, v7, 3, v8
    v_lshlrev_b32 v5, 14, v7
    v_lshl_add_u32 v5, v6, 4, v5
    s_lshl_b32 s12, s92, 7
    s_add_u32 s12, s12, 109051904
    s_waitcnt lgkmcnt(0)
    s_mov_b32 s6, 8388608
    s_mov_b32 s7, 0x00020000
    s_mov_b32 s10, 268435456
    s_mov_b32 s11, 0x00020000
    s_add_u32 s13, s12, 0
    buffer_load_dwordx4 v[16:19], v5, s[8:11], s13 offen
    s_add_u32 s13, s12, 524288
    buffer_load_dwordx4 v[20:23], v5, s[8:11], s13 offen
    s_add_u32 s13, s12, 1048576
    buffer_load_dwordx4 v[24:27], v5, s[8:11], s13 offen
    s_add_u32 s13, s12, 1572864
    buffer_load_dwordx4 v[28:31], v5, s[8:11], s13 offen
    s_add_u32 s13, s12, 2097152
    buffer_load_dwordx4 v[32:35], v5, s[8:11], s13 offen
    s_add_u32 s13, s12, 2621440
    buffer_load_dwordx4 v[36:39], v5, s[8:11], s13 offen
    s_add_u32 s13, s12, 3145728
    buffer_load_dwordx4 v[40:43], v5, s[8:11], s13 offen
    s_add_u32 s13, s12, 3670016
    buffer_load_dwordx4 v[44:47], v5, s[8:11], s13 offen
    s_add_u32 s13, s12, 4194304
    buffer_load_dwordx4 v[48:51], v5, s[8:11], s13 offen
    s_add_u32 s13, s12, 4718592
    buffer_load_dwordx4 v[52:55], v5, s[8:11], s13 offen
    s_add_u32 s13, s12, 5242880
    buffer_load_dwordx4 v[56:59], v5, s[8:11], s13 offen
    s_add_u32 s13, s12, 5767168
    buffer_load_dwordx4 v[60:63], v5, s[8:11], s13 offen
    s_add_u32 s13, s12, 6291456
    buffer_load_dwordx4 v[64:67], v5, s[8:11], s13 offen
    s_add_u32 s13, s12, 6815744
    buffer_load_dwordx4 v[68:71], v5, s[8:11], s13 offen
    s_add_u32 s13, s12, 7340032
    buffer_load_dwordx4 v[72:75], v5, s[8:11], s13 offen
    s_add_u32 s13, s12, 7864320
    buffer_load_dwordx4 v[76:79], v5, s[8:11], s13 offen
    s_add_u32 s13, s12, 8388608
    buffer_load_dwordx4 v[80:83], v5, s[8:11], s13 offen
    s_waitcnt vmcnt(0)
    v_cmp_eq_u32 vcc, 0, v7
    s_nop 1
    v_mov_b32 v9, 0
    v_cndmask_b32 v17, v17, v9, vcc
    v_cndmask_b32 v19, v19, v9, vcc
    v_cndmask_b32 v81, v81, v9, vcc
    v_cndmask_b32 v83, v83, v9, vcc
    v_sub_u32 v6, 1024, v7
    v_and_b32 v6, 1023, v6
    v_lshl_add_u32 v6, v6, 3, v8
    v_sub_f32 v10, v16, v19
    v_add_f32 v11, v17, v18
    v_add_f32 v12, v16, v19
    v_sub_f32 v13, v18, v17
    ds_write_b64 v4, v[10:11] offset:0
    ds_write_b64 v6, v[12:13]
    v_sub_u32 v6, 992, v7
    v_and_b32 v6, 1023, v6
    v_lshl_add_u32 v6, v6, 3, v8
    v_sub_f32 v10, v20, v23
    v_add_f32 v11, v21, v22
    v_add_f32 v12, v20, v23
    v_sub_f32 v13, v22, v21
    ds_write_b64 v4, v[10:11] offset:256
    ds_write_b64 v6, v[12:13]
    v_sub_u32 v6, 960, v7
    v_and_b32 v6, 1023, v6
    v_lshl_add_u32 v6, v6, 3, v8
    v_sub_f32 v10, v24, v27
    v_add_f32 v11, v25, v26
    v_add_f32 v12, v24, v27
    v_sub_f32 v13, v26, v25
    ds_write_b64 v4, v[10:11] offset:512
    ds_write_b64 v6, v[12:13]
    v_sub_u32 v6, 928, v7
    v_and_b32 v6, 1023, v6
    v_lshl_add_u32 v6, v6, 3, v8
    v_sub_f32 v10, v28, v31
    v_add_f32 v11, v29, v30
    v_add_f32 v12, v28, v31
    v_sub_f32 v13, v30, v29
    ds_write_b64 v4, v[10:11] offset:768
    ds_write_b64 v6, v[12:13]
    v_sub_u32 v6, 896, v7
    v_and_b32 v6, 1023, v6
    v_lshl_add_u32 v6, v6, 3, v8
    v_sub_f32 v10, v32, v35
    v_add_f32 v11, v33, v34
    v_add_f32 v12, v32, v35
    v_sub_f32 v13, v34, v33
    ds_write_b64 v4, v[10:11] offset:1024
    ds_write_b64 v6, v[12:13]
    v_sub_u32 v6, 864, v7
    v_and_b32 v6, 1023, v6
    v_lshl_add_u32 v6, v6, 3, v8
    v_sub_f32 v10, v36, v39
    v_add_f32 v11, v37, v38
    v_add_f32 v12, v36, v39
    v_sub_f32 v13, v38, v37
    ds_write_b64 v4, v[10:11] offset:1280
    ds_write_b64 v6, v[12:13]
    v_sub_u32 v6, 832, v7
    v_and_b32 v6, 1023, v6
    v_lshl_add_u32 v6, v6, 3, v8
    v_sub_f32 v10, v40, v43
    v_add_f32 v11, v41, v42
    v_add_f32 v12, v40, v43
    v_sub_f32 v13, v42, v41
    ds_write_b64 v4, v[10:11] offset:1536
    ds_write_b64 v6, v[12:13]
    v_sub_u32 v6, 800, v7
    v_and_b32 v6, 1023, v6
    v_lshl_add_u32 v6, v6, 3, v8
    v_sub_f32 v10, v44, v47
    v_add_f32 v11, v45, v46
    v_add_f32 v12, v44, v47
    v_sub_f32 v13, v46, v45
    ds_write_b64 v4, v[10:11] offset:1792
    ds_write_b64 v6, v[12:13]
    v_sub_u32 v6, 768, v7
    v_and_b32 v6, 1023, v6
    v_lshl_add_u32 v6, v6, 3, v8
    v_sub_f32 v10, v48, v51
    v_add_f32 v11, v49, v50
    v_add_f32 v12, v48, v51
    v_sub_f32 v13, v50, v49
    ds_write_b64 v4, v[10:11] offset:2048
    ds_write_b64 v6, v[12:13]
    v_sub_u32 v6, 736, v7
    v_and_b32 v6, 1023, v6
    v_lshl_add_u32 v6, v6, 3, v8
    v_sub_f32 v10, v52, v55
    v_add_f32 v11, v53, v54
    v_add_f32 v12, v52, v55
    v_sub_f32 v13, v54, v53
    ds_write_b64 v4, v[10:11] offset:2304
    ds_write_b64 v6, v[12:13]
    v_sub_u32 v6, 704, v7
    v_and_b32 v6, 1023, v6
    v_lshl_add_u32 v6, v6, 3, v8
    v_sub_f32 v10, v56, v59
    v_add_f32 v11, v57, v58
    v_add_f32 v12, v56, v59
    v_sub_f32 v13, v58, v57
    ds_write_b64 v4, v[10:11] offset:2560
    ds_write_b64 v6, v[12:13]
    v_sub_u32 v6, 672, v7
    v_and_b32 v6, 1023, v6
    v_lshl_add_u32 v6, v6, 3, v8
    v_sub_f32 v10, v60, v63
    v_add_f32 v11, v61, v62
    v_add_f32 v12, v60, v63
    v_sub_f32 v13, v62, v61
    ds_write_b64 v4, v[10:11] offset:2816
    ds_write_b64 v6, v[12:13]
    v_sub_u32 v6, 640, v7
    v_and_b32 v6, 1023, v6
    v_lshl_add_u32 v6, v6, 3, v8
    v_sub_f32 v10, v64, v67
    v_add_f32 v11, v65, v66
    v_add_f32 v12, v64, v67
    v_sub_f32 v13, v66, v65
    ds_write_b64 v4, v[10:11] offset:3072
    ds_write_b64 v6, v[12:13]
    v_sub_u32 v6, 608, v7
    v_and_b32 v6, 1023, v6
    v_lshl_add_u32 v6, v6, 3, v8
    v_sub_f32 v10, v68, v71
    v_add_f32 v11, v69, v70
    v_add_f32 v12, v68, v71
    v_sub_f32 v13, v70, v69
    ds_write_b64 v4, v[10:11] offset:3328
    ds_write_b64 v6, v[12:13]
    v_sub_u32 v6, 576, v7
    v_and_b32 v6, 1023, v6
    v_lshl_add_u32 v6, v6, 3, v8
    v_sub_f32 v10, v72, v75
    v_add_f32 v11, v73, v74
    v_add_f32 v12, v72, v75
    v_sub_f32 v13, v74, v73
    ds_write_b64 v4, v[10:11] offset:3584
    ds_write_b64 v6, v[12:13]
    v_sub_u32 v6, 544, v7
    v_and_b32 v6, 1023, v6
    v_lshl_add_u32 v6, v6, 3, v8
    v_sub_f32 v10, v76, v79
    v_add_f32 v11, v77, v78
    v_add_f32 v12, v76, v79
    v_sub_f32 v13, v78, v77
    ds_write_b64 v4, v[10:11] offset:3840
    ds_write_b64 v6, v[12:13]
    s_and_saveexec_b64 s[14:15], vcc
    v_sub_u32 v6, 512, v7
    v_and_b32 v6, 1023, v6
    v_lshl_add_u32 v6, v6, 3, v8
    v_sub_f32 v10, v80, v83
    v_add_f32 v11, v81, v82
    v_add_f32 v12, v80, v83
    v_sub_f32 v13, v82, v81
    ds_write_b64 v4, v[10:11] offset:4096
    ds_write_b64 v6, v[12:13]
    s_mov_b64 exec, s[14:15]
    s_waitcnt lgkmcnt(0)
    s_barrier
    v_and_b32 v1, 31, v0
    v_lshrrev_b32 v2, 5, v0
    v_cvt_f32_u32 v3, v1
    s_movk_i32 s13, 8448
    v_mul_lo_u32 v7, v2, s13
    v_lshl_add_u32 v4, v1, 3, v7
    s_movk_i32 s13, 264
    v_mul_lo_u32 v5, v1, s13
    v_add_u32 v5, v5, v7
    ds_read_b32 v16, v4 offset:0
    ds_read_b32 v48, v4 offset:4
    ds_read_b32 v17, v4 offset:256
    ds_read_b32 v49, v4 offset:260
    ds_read_b32 v18, v4 offset:512
    ds_read_b32 v50, v4 offset:516
    ds_read_b32 v19, v4 offset:768
    ds_read_b32 v51, v4 offset:772
    ds_read_b32 v20, v4 offset:1024
    ds_read_b32 v52, v4 offset:1028
    ds_read_b32 v21, v4 offset:1280
    ds_read_b32 v53, v4 offset:1284
    ds_read_b32 v22, v4 offset:1536
    ds_read_b32 v54, v4 offset:1540
    s_waitcnt lgkmcnt(0)
    ds_read_b32 v23, v4 offset:1792
    ds_read_b32 v55, v4 offset:1796
    ds_read_b32 v24, v4 offset:2048
    ds_read_b32 v56, v4 offset:2052
    ds_read_b32 v25, v4 offset:2304
    ds_read_b32 v57, v4 offset:2308
    ds_read_b32 v26, v4 offset:2560
    ds_read_b32 v58, v4 offset:2564
    ds_read_b32 v27, v4 offset:2816
    ds_read_b32 v59, v4 offset:2820
    ds_read_b32 v28, v4 offset:3072
    ds_read_b32 v60, v4 offset:3076
    ds_read_b32 v29, v4 offset:3328
    ds_read_b32 v61, v4 offset:3332
    s_waitcnt lgkmcnt(0)
    ds_read_b32 v30, v4 offset:3584
    ds_read_b32 v62, v4 offset:3588
    ds_read_b32 v31, v4 offset:3840
    ds_read_b32 v63, v4 offset:3844
    ds_read_b32 v32, v4 offset:4096
    ds_read_b32 v64, v4 offset:4100
    ds_read_b32 v33, v4 offset:4352
    ds_read_b32 v65, v4 offset:4356
    ds_read_b32 v34, v4 offset:4608
    ds_read_b32 v66, v4 offset:4612
    ds_read_b32 v35, v4 offset:4864
    ds_read_b32 v67, v4 offset:4868
    ds_read_b32 v36, v4 offset:5120
    ds_read_b32 v68, v4 offset:5124
    s_waitcnt lgkmcnt(0)
    ds_read_b32 v37, v4 offset:5376
    ds_read_b32 v69, v4 offset:5380
    ds_read_b32 v38, v4 offset:5632
    ds_read_b32 v70, v4 offset:5636
    ds_read_b32 v39, v4 offset:5888
    ds_read_b32 v71, v4 offset:5892
    ds_read_b32 v40, v4 offset:6144
    ds_read_b32 v72, v4 offset:6148
    ds_read_b32 v41, v4 offset:6400
    ds_read_b32 v73, v4 offset:6404
    ds_read_b32 v42, v4 offset:6656
    ds_read_b32 v74, v4 offset:6660
    ds_read_b32 v43, v4 offset:6912
    ds_read_b32 v75, v4 offset:6916
    s_waitcnt lgkmcnt(0)
    ds_read_b32 v44, v4 offset:7168
    ds_read_b32 v76, v4 offset:7172
    ds_read_b32 v45, v4 offset:7424
    ds_read_b32 v77, v4 offset:7428
    ds_read_b32 v46, v4 offset:7680
    ds_read_b32 v78, v4 offset:7684
    ds_read_b32 v47, v4 offset:7936
    ds_read_b32 v79, v4 offset:7940
    s_waitcnt lgkmcnt(0)
    v_sub_f32 v80, v16, v32
    v_sub_f32 v81, v48, v64
    v_add_f32 v16, v16, v32
    v_add_f32 v48, v48, v64
    v_sub_f32 v32, v17, v33
    v_sub_f32 v64, v49, v65
    v_add_f32 v17, v17, v33
    v_add_f32 v49, v49, v65
    v_mul_f32 v33, 0x3f7b14be, v32
    v_mul_f32 v65, 0x3e47c5c2, v32
    v_fmac_f32 v33, 0xbe47c5c2, v64
    v_fmac_f32 v65, 0x3f7b14be, v64
    v_sub_f32 v32, v18, v34
    v_sub_f32 v64, v50, v66
    v_add_f32 v18, v18, v34
    v_add_f32 v50, v50, v66
    v_mul_f32 v34, 0x3f6c835e, v32
    v_mul_f32 v66, 0x3ec3ef15, v32
    v_fmac_f32 v34, 0xbec3ef15, v64
    v_fmac_f32 v66, 0x3f6c835e, v64
    v_sub_f32 v32, v19, v35
    v_sub_f32 v64, v51, v67
    v_add_f32 v19, v19, v35
    v_add_f32 v51, v51, v67
    v_mul_f32 v35, 0x3f54db31, v32
    v_mul_f32 v67, 0x3f0e39da, v32
    v_fmac_f32 v35, 0xbf0e39da, v64
    v_fmac_f32 v67, 0x3f54db31, v64
    v_sub_f32 v32, v20, v36
    v_sub_f32 v64, v52, v68
    v_add_f32 v20, v20, v36
    v_add_f32 v52, v52, v68
    v_mul_f32 v36, 0x3f3504f3, v32
    v_mul_f32 v68, 0x3f3504f3, v32
    v_fmac_f32 v36, 0xbf3504f3, v64
    v_fmac_f32 v68, 0x3f3504f3, v64
    v_sub_f32 v32, v21, v37
    v_sub_f32 v64, v53, v69
    v_add_f32 v21, v21, v37
    v_add_f32 v53, v53, v69
    v_mul_f32 v37, 0x3f0e39da, v32
    v_mul_f32 v69, 0x3f54db31, v32
    v_fmac_f32 v37, 0xbf54db31, v64
    v_fmac_f32 v69, 0x3f0e39da, v64
    v_sub_f32 v32, v22, v38
    v_sub_f32 v64, v54, v70
    v_add_f32 v22, v22, v38
    v_add_f32 v54, v54, v70
    v_mul_f32 v38, 0x3ec3ef15, v32
    v_mul_f32 v70, 0x3f6c835e, v32
    v_fmac_f32 v38, 0xbf6c835e, v64
    v_fmac_f32 v70, 0x3ec3ef15, v64
    v_sub_f32 v32, v23, v39
    v_sub_f32 v64, v55, v71
    v_add_f32 v23, v23, v39
    v_add_f32 v55, v55, v71
    v_mul_f32 v39, 0x3e47c5c2, v32
    v_mul_f32 v71, 0x3f7b14be, v32
    v_fmac_f32 v39, 0xbf7b14be, v64
    v_fmac_f32 v71, 0x3e47c5c2, v64
    v_sub_f32 v32, v72, v56
    v_sub_f32 v64, v24, v40
    v_add_f32 v24, v24, v40
    v_add_f32 v56, v56, v72
    v_sub_f32 v40, v25, v41
    v_sub_f32 v72, v57, v73
    v_add_f32 v25, v25, v41
    v_add_f32 v57, v57, v73
    v_mul_f32 v41, 0xbe47c5c2, v40
    v_mul_f32 v73, 0x3f7b14be, v40
    v_fmac_f32 v41, 0xbf7b14be, v72
    v_fmac_f32 v73, 0xbe47c5c2, v72
    v_sub_f32 v40, v26, v42
    v_sub_f32 v72, v58, v74
    v_add_f32 v26, v26, v42
    v_add_f32 v58, v58, v74
    v_mul_f32 v42, 0xbec3ef15, v40
    v_mul_f32 v74, 0x3f6c835e, v40
    v_fmac_f32 v42, 0xbf6c835e, v72
    v_fmac_f32 v74, 0xbec3ef15, v72
    v_sub_f32 v40, v27, v43
    v_sub_f32 v72, v59, v75
    v_add_f32 v27, v27, v43
    v_add_f32 v59, v59, v75
    v_mul_f32 v43, 0xbf0e39da, v40
    v_mul_f32 v75, 0x3f54db31, v40
    v_fmac_f32 v43, 0xbf54db31, v72
    v_fmac_f32 v75, 0xbf0e39da, v72
    v_sub_f32 v40, v28, v44
    v_sub_f32 v72, v60, v76
    v_add_f32 v28, v28, v44
    v_add_f32 v60, v60, v76
    v_mul_f32 v44, 0xbf3504f3, v40
    v_mul_f32 v76, 0x3f3504f3, v40
    v_fmac_f32 v44, 0xbf3504f3, v72
    v_fmac_f32 v76, 0xbf3504f3, v72
    v_sub_f32 v40, v29, v45
    v_sub_f32 v72, v61, v77
    v_add_f32 v29, v29, v45
    v_add_f32 v61, v61, v77
    v_mul_f32 v45, 0xbf54db31, v40
    v_mul_f32 v77, 0x3f0e39da, v40
    v_fmac_f32 v45, 0xbf0e39da, v72
    v_fmac_f32 v77, 0xbf54db31, v72
    v_sub_f32 v40, v30, v46
    v_sub_f32 v72, v62, v78
    v_add_f32 v30, v30, v46
    v_add_f32 v62, v62, v78
    v_mul_f32 v46, 0xbf6c835e, v40
    v_mul_f32 v78, 0x3ec3ef15, v40
    v_fmac_f32 v46, 0xbec3ef15, v72
    v_fmac_f32 v78, 0xbf6c835e, v72
    v_sub_f32 v40, v31, v47
    v_sub_f32 v72, v63, v79
    v_add_f32 v31, v31, v47
    v_add_f32 v63, v63, v79
    v_mul_f32 v47, 0xbf7b14be, v40
    v_mul_f32 v79, 0x3e47c5c2, v40
    v_fmac_f32 v47, 0xbe47c5c2, v72
    v_fmac_f32 v79, 0xbf7b14be, v72
    v_sub_f32 v40, v16, v24
    v_sub_f32 v72, v48, v56
    v_add_f32 v16, v16, v24
    v_add_f32 v48, v48, v56
    v_sub_f32 v24, v17, v25
    v_sub_f32 v56, v49, v57
    v_add_f32 v17, v17, v25
    v_add_f32 v49, v49, v57
    v_mul_f32 v25, 0x3f6c835e, v24
    v_mul_f32 v57, 0x3ec3ef15, v24
    v_fmac_f32 v25, 0xbec3ef15, v56
    v_fmac_f32 v57, 0x3f6c835e, v56
    v_sub_f32 v24, v18, v26
    v_sub_f32 v56, v50, v58
    v_add_f32 v18, v18, v26
    v_add_f32 v50, v50, v58
    v_mul_f32 v26, 0x3f3504f3, v24
    v_mul_f32 v58, 0x3f3504f3, v24
    v_fmac_f32 v26, 0xbf3504f3, v56
    v_fmac_f32 v58, 0x3f3504f3, v56
    v_sub_f32 v24, v19, v27
    v_sub_f32 v56, v51, v59
    v_add_f32 v19, v19, v27
    v_add_f32 v51, v51, v59
    v_mul_f32 v27, 0x3ec3ef15, v24
    v_mul_f32 v59, 0x3f6c835e, v24
    v_fmac_f32 v27, 0xbf6c835e, v56
    v_fmac_f32 v59, 0x3ec3ef15, v56
    v_sub_f32 v24, v60, v52
    v_sub_f32 v56, v20, v28
    v_add_f32 v20, v20, v28
    v_add_f32 v52, v52, v60
    v_sub_f32 v28, v21, v29
    v_sub_f32 v60, v53, v61
    v_add_f32 v21, v21, v29
    v_add_f32 v53, v53, v61
    v_mul_f32 v29, 0xbec3ef15, v28
    v_mul_f32 v61, 0x3f6c835e, v28
    v_fmac_f32 v29, 0xbf6c835e, v60
    v_fmac_f32 v61, 0xbec3ef15, v60
    v_sub_f32 v28, v22, v30
    v_sub_f32 v60, v54, v62
    v_add_f32 v22, v22, v30
    v_add_f32 v54, v54, v62
    v_mul_f32 v30, 0xbf3504f3, v28
    v_mul_f32 v62, 0x3f3504f3, v28
    v_fmac_f32 v30, 0xbf3504f3, v60
    v_fmac_f32 v62, 0xbf3504f3, v60
    v_sub_f32 v28, v23, v31
    v_sub_f32 v60, v55, v63
    v_add_f32 v23, v23, v31
    v_add_f32 v55, v55, v63
    v_mul_f32 v31, 0xbf6c835e, v28
    v_mul_f32 v63, 0x3ec3ef15, v28
    v_fmac_f32 v31, 0xbec3ef15, v60
    v_fmac_f32 v63, 0xbf6c835e, v60
    v_sub_f32 v28, v80, v32
    v_sub_f32 v60, v81, v64
    v_add_f32 v80, v80, v32
    v_add_f32 v81, v81, v64
    v_sub_f32 v32, v33, v41
    v_sub_f32 v64, v65, v73
    v_add_f32 v33, v33, v41
    v_add_f32 v65, v65, v73
    v_mul_f32 v41, 0x3f6c835e, v32
    v_mul_f32 v73, 0x3ec3ef15, v32
    v_fmac_f32 v41, 0xbec3ef15, v64
    v_fmac_f32 v73, 0x3f6c835e, v64
    v_sub_f32 v32, v34, v42
    v_sub_f32 v64, v66, v74
    v_add_f32 v34, v34, v42
    v_add_f32 v66, v66, v74
    v_mul_f32 v42, 0x3f3504f3, v32
    v_mul_f32 v74, 0x3f3504f3, v32
    v_fmac_f32 v42, 0xbf3504f3, v64
    v_fmac_f32 v74, 0x3f3504f3, v64
    v_sub_f32 v32, v35, v43
    v_sub_f32 v64, v67, v75
    v_add_f32 v35, v35, v43
    v_add_f32 v67, v67, v75
    v_mul_f32 v43, 0x3ec3ef15, v32
    v_mul_f32 v75, 0x3f6c835e, v32
    v_fmac_f32 v43, 0xbf6c835e, v64
    v_fmac_f32 v75, 0x3ec3ef15, v64
    v_sub_f32 v32, v76, v68
    v_sub_f32 v64, v36, v44
    v_add_f32 v36, v36, v44
    v_add_f32 v68, v68, v76
    v_sub_f32 v44, v37, v45
    v_sub_f32 v76, v69, v77
    v_add_f32 v37, v37, v45
    v_add_f32 v69, v69, v77
    v_mul_f32 v45, 0xbec3ef15, v44
    v_mul_f32 v77, 0x3f6c835e, v44
    v_fmac_f32 v45, 0xbf6c835e, v76
    v_fmac_f32 v77, 0xbec3ef15, v76
    v_sub_f32 v44, v38, v46
    v_sub_f32 v76, v70, v78
    v_add_f32 v38, v38, v46
    v_add_f32 v70, v70, v78
    v_mul_f32 v46, 0xbf3504f3, v44
    v_mul_f32 v78, 0x3f3504f3, v44
    v_fmac_f32 v46, 0xbf3504f3, v76
    v_fmac_f32 v78, 0xbf3504f3, v76
    v_sub_f32 v44, v39, v47
    v_sub_f32 v76, v71, v79
    v_add_f32 v39, v39, v47
    v_add_f32 v71, v71, v79
    v_mul_f32 v47, 0xbf6c835e, v44
    v_mul_f32 v79, 0x3ec3ef15, v44
    v_fmac_f32 v47, 0xbec3ef15, v76
    v_fmac_f32 v79, 0xbf6c835e, v76
    v_sub_f32 v44, v16, v20
    v_sub_f32 v76, v48, v52
    v_add_f32 v16, v16, v20
    v_add_f32 v48, v48, v52
    v_sub_f32 v20, v17, v21
    v_sub_f32 v52, v49, v53
    v_add_f32 v17, v17, v21
    v_add_f32 v49, v49, v53
    v_mul_f32 v21, 0x3f3504f3, v20
    v_mul_f32 v53, 0x3f3504f3, v20
    v_fmac_f32 v21, 0xbf3504f3, v52
    v_fmac_f32 v53, 0x3f3504f3, v52
    v_sub_f32 v20, v54, v50
    v_sub_f32 v52, v18, v22
    v_add_f32 v18, v18, v22
    v_add_f32 v50, v50, v54
    v_sub_f32 v22, v19, v23
    v_sub_f32 v54, v51, v55
    v_add_f32 v19, v19, v23
    v_add_f32 v51, v51, v55
    v_mul_f32 v23, 0xbf3504f3, v22
    v_mul_f32 v55, 0x3f3504f3, v22
    v_fmac_f32 v23, 0xbf3504f3, v54
    v_fmac_f32 v55, 0xbf3504f3, v54
    v_sub_f32 v22, v40, v24
    v_sub_f32 v54, v72, v56
    v_add_f32 v40, v40, v24
    v_add_f32 v72, v72, v56
    v_sub_f32 v24, v25, v29
    v_sub_f32 v56, v57, v61
    v_add_f32 v25, v25, v29
    v_add_f32 v57, v57, v61
    v_mul_f32 v29, 0x3f3504f3, v24
    v_mul_f32 v61, 0x3f3504f3, v24
    v_fmac_f32 v29, 0xbf3504f3, v56
    v_fmac_f32 v61, 0x3f3504f3, v56
    v_sub_f32 v24, v62, v58
    v_sub_f32 v56, v26, v30
    v_add_f32 v26, v26, v30
    v_add_f32 v58, v58, v62
    v_sub_f32 v30, v27, v31
    v_sub_f32 v62, v59, v63
    v_add_f32 v27, v27, v31
    v_add_f32 v59, v59, v63
    v_mul_f32 v31, 0xbf3504f3, v30
    v_mul_f32 v63, 0x3f3504f3, v30
    v_fmac_f32 v31, 0xbf3504f3, v62
    v_fmac_f32 v63, 0xbf3504f3, v62
    v_sub_f32 v30, v80, v36
    v_sub_f32 v62, v81, v68
    v_add_f32 v80, v80, v36
    v_add_f32 v81, v81, v68
    v_sub_f32 v36, v33, v37
    v_sub_f32 v68, v65, v69
    v_add_f32 v33, v33, v37
    v_add_f32 v65, v65, v69
    v_mul_f32 v37, 0x3f3504f3, v36
    v_mul_f32 v69, 0x3f3504f3, v36
    v_fmac_f32 v37, 0xbf3504f3, v68
    v_fmac_f32 v69, 0x3f3504f3, v68
    v_sub_f32 v36, v70, v66
    v_sub_f32 v68, v34, v38
    v_add_f32 v34, v34, v38
    v_add_f32 v66, v66, v70
    v_sub_f32 v38, v35, v39
    v_sub_f32 v70, v67, v71
    v_add_f32 v35, v35, v39
    v_add_f32 v67, v67, v71
    v_mul_f32 v39, 0xbf3504f3, v38
    v_mul_f32 v71, 0x3f3504f3, v38
    v_fmac_f32 v39, 0xbf3504f3, v70
    v_fmac_f32 v71, 0xbf3504f3, v70
    v_sub_f32 v38, v28, v32
    v_sub_f32 v70, v60, v64
    v_add_f32 v28, v28, v32
    v_add_f32 v60, v60, v64
    v_sub_f32 v32, v41, v45
    v_sub_f32 v64, v73, v77
    v_add_f32 v41, v41, v45
    v_add_f32 v73, v73, v77
    v_mul_f32 v45, 0x3f3504f3, v32
    v_mul_f32 v77, 0x3f3504f3, v32
    v_fmac_f32 v45, 0xbf3504f3, v64
    v_fmac_f32 v77, 0x3f3504f3, v64
    v_sub_f32 v32, v78, v74
    v_sub_f32 v64, v42, v46
    v_add_f32 v42, v42, v46
    v_add_f32 v74, v74, v78
    v_sub_f32 v46, v43, v47
    v_sub_f32 v78, v75, v79
    v_add_f32 v43, v43, v47
    v_add_f32 v75, v75, v79
    v_mul_f32 v47, 0xbf3504f3, v46
    v_mul_f32 v79, 0x3f3504f3, v46
    v_fmac_f32 v47, 0xbf3504f3, v78
    v_fmac_f32 v79, 0xbf3504f3, v78
    v_sub_f32 v46, v16, v18
    v_sub_f32 v78, v48, v50
    v_add_f32 v16, v16, v18
    v_add_f32 v48, v48, v50
    v_sub_f32 v18, v51, v49
    v_sub_f32 v50, v17, v19
    v_add_f32 v17, v17, v19
    v_add_f32 v49, v49, v51
    v_sub_f32 v19, v44, v20
    v_sub_f32 v51, v76, v52
    v_add_f32 v44, v44, v20
    v_add_f32 v76, v76, v52
    v_sub_f32 v20, v55, v53
    v_sub_f32 v52, v21, v23
    v_add_f32 v21, v21, v23
    v_add_f32 v53, v53, v55
    v_sub_f32 v23, v40, v26
    v_sub_f32 v55, v72, v58
    v_add_f32 v40, v40, v26
    v_add_f32 v72, v72, v58
    v_sub_f32 v26, v59, v57
    v_sub_f32 v58, v25, v27
    v_add_f32 v25, v25, v27
    v_add_f32 v57, v57, v59
    v_sub_f32 v27, v22, v24
    v_sub_f32 v59, v54, v56
    v_add_f32 v22, v22, v24
    v_add_f32 v54, v54, v56
    v_sub_f32 v24, v63, v61
    v_sub_f32 v56, v29, v31
    v_add_f32 v29, v29, v31
    v_add_f32 v61, v61, v63
    v_sub_f32 v31, v80, v34
    v_sub_f32 v63, v81, v66
    v_add_f32 v80, v80, v34
    v_add_f32 v81, v81, v66
    v_sub_f32 v34, v67, v65
    v_sub_f32 v66, v33, v35
    v_add_f32 v33, v33, v35
    v_add_f32 v65, v65, v67
    v_sub_f32 v35, v30, v36
    v_sub_f32 v67, v62, v68
    v_add_f32 v30, v30, v36
    v_add_f32 v62, v62, v68
    v_sub_f32 v36, v71, v69
    v_sub_f32 v68, v37, v39
    v_add_f32 v37, v37, v39
    v_add_f32 v69, v69, v71
    v_sub_f32 v39, v28, v42
    v_sub_f32 v71, v60, v74
    v_add_f32 v28, v28, v42
    v_add_f32 v60, v60, v74
    v_sub_f32 v42, v75, v73
    v_sub_f32 v74, v41, v43
    v_add_f32 v41, v41, v43
    v_add_f32 v73, v73, v75
    v_sub_f32 v43, v38, v32
    v_sub_f32 v75, v70, v64
    v_add_f32 v38, v38, v32
    v_add_f32 v70, v70, v64
    v_sub_f32 v32, v79, v77
    v_sub_f32 v64, v45, v47
    v_add_f32 v45, v45, v47
    v_add_f32 v77, v77, v79
    v_sub_f32 v47, v16, v17
    v_sub_f32 v79, v48, v49
    v_add_f32 v16, v16, v17
    v_add_f32 v48, v48, v49
    v_sub_f32 v17, v46, v18
    v_sub_f32 v49, v78, v50
    v_add_f32 v46, v46, v18
    v_add_f32 v78, v78, v50
    v_sub_f32 v18, v44, v21
    v_sub_f32 v50, v76, v53
    v_add_f32 v44, v44, v21
    v_add_f32 v76, v76, v53
    v_sub_f32 v21, v19, v20
    v_sub_f32 v53, v51, v52
    v_add_f32 v19, v19, v20
    v_add_f32 v51, v51, v52
    v_sub_f32 v20, v40, v25
    v_sub_f32 v52, v72, v57
    v_add_f32 v40, v40, v25
    v_add_f32 v72, v72, v57
    v_sub_f32 v25, v23, v26
    v_sub_f32 v57, v55, v58
    v_add_f32 v23, v23, v26
    v_add_f32 v55, v55, v58
    v_sub_f32 v26, v22, v29
    v_sub_f32 v58, v54, v61
    v_add_f32 v22, v22, v29
    v_add_f32 v54, v54, v61
    v_sub_f32 v29, v27, v24
    v_sub_f32 v61, v59, v56
    v_add_f32 v27, v27, v24
    v_add_f32 v59, v59, v56
    v_sub_f32 v24, v80, v33
    v_sub_f32 v56, v81, v65
    v_add_f32 v80, v80, v33
    v_add_f32 v81, v81, v65
    v_sub_f32 v33, v31, v34
    v_sub_f32 v65, v63, v66
    v_add_f32 v31, v31, v34
    v_add_f32 v63, v63, v66
    v_sub_f32 v34, v30, v37
    v_sub_f32 v66, v62, v69
    v_add_f32 v30, v30, v37
    v_add_f32 v62, v62, v69
    v_sub_f32 v37, v35, v36
    v_sub_f32 v69, v67, v68
    v_add_f32 v35, v35, v36
    v_add_f32 v67, v67, v68
    v_sub_f32 v36, v28, v41
    v_sub_f32 v68, v60, v73
    v_add_f32 v28, v28, v41
    v_add_f32 v60, v60, v73
    v_sub_f32 v41, v39, v42
    v_sub_f32 v73, v71, v74
    v_add_f32 v39, v39, v42
    v_add_f32 v71, v71, v74
    v_sub_f32 v42, v38, v45
    v_sub_f32 v74, v70, v77
    v_add_f32 v38, v38, v45
    v_add_f32 v70, v70, v77
    v_sub_f32 v45, v43, v32
    v_sub_f32 v77, v75, v64
    v_add_f32 v43, v43, v32
    v_add_f32 v75, v75, v64
    v_mul_f32 v32, 0x3a800000, v3
    v_cos_f32 v64, v32
    v_sin_f32 v82, v32
    s_nop 0
    v_mul_f32 v83, v80, v64
    v_fma_f32 v83, -v81, v82, v83
    v_mul_f32 v81, v81, v64
    v_fmac_f32 v81, v80, v82
    v_mul_f32 v32, 0x3b000000, v3
    v_cos_f32 v64, v32
    v_sin_f32 v82, v32
    s_nop 0
    v_mul_f32 v80, v40, v64
    v_fma_f32 v80, -v72, v82, v80
    v_mul_f32 v72, v72, v64
    v_fmac_f32 v72, v40, v82
    v_mul_f32 v32, 0x3b400000, v3
    v_cos_f32 v64, v32
    v_sin_f32 v82, v32
    s_nop 0
    v_mul_f32 v40, v28, v64
    v_fma_f32 v40, -v60, v82, v40
    v_mul_f32 v60, v60, v64
    v_fmac_f32 v60, v28, v82
    v_mul_f32 v32, 0x3b800000, v3
    v_cos_f32 v64, v32
    v_sin_f32 v82, v32
    s_nop 0
    v_mul_f32 v28, v44, v64
    v_fma_f32 v28, -v76, v82, v28
    v_mul_f32 v76, v76, v64
    v_fmac_f32 v76, v44, v82
    v_mul_f32 v32, 0x3ba00000, v3
    v_cos_f32 v64, v32
    v_sin_f32 v82, v32
    s_nop 0
    v_mul_f32 v44, v30, v64
    v_fma_f32 v44, -v62, v82, v44
    v_mul_f32 v62, v62, v64
    v_fmac_f32 v62, v30, v82
    v_mul_f32 v32, 0x3bc00000, v3
    v_cos_f32 v64, v32
    v_sin_f32 v82, v32
    s_nop 0
    v_mul_f32 v30, v22, v64
    v_fma_f32 v30, -v54, v82, v30
    v_mul_f32 v54, v54, v64
    v_fmac_f32 v54, v22, v82
    v_mul_f32 v32, 0x3be00000, v3
    v_cos_f32 v64, v32
    v_sin_f32 v82, v32
    s_nop 0
    v_mul_f32 v22, v38, v64
    v_fma_f32 v22, -v70, v82, v22
    v_mul_f32 v70, v70, v64
    v_fmac_f32 v70, v38, v82
    v_mul_f32 v32, 0x3c000000, v3
    v_cos_f32 v64, v32
    v_sin_f32 v82, v32
    s_nop 0
    v_mul_f32 v38, v46, v64
    v_fma_f32 v38, -v78, v82, v38
    v_mul_f32 v78, v78, v64
    v_fmac_f32 v78, v46, v82
    v_mul_f32 v32, 0x3c100000, v3
    v_cos_f32 v64, v32
    v_sin_f32 v82, v32
    s_nop 0
    v_mul_f32 v46, v31, v64
    v_fma_f32 v46, -v63, v82, v46
    v_mul_f32 v63, v63, v64
    v_fmac_f32 v63, v31, v82
    v_mul_f32 v32, 0x3c200000, v3
    v_cos_f32 v64, v32
    v_sin_f32 v82, v32
    s_nop 0
    v_mul_f32 v31, v23, v64
    v_fma_f32 v31, -v55, v82, v31
    v_mul_f32 v55, v55, v64
    v_fmac_f32 v55, v23, v82
    v_mul_f32 v32, 0x3c300000, v3
    v_cos_f32 v64, v32
    v_sin_f32 v82, v32
    s_nop 0
    v_mul_f32 v23, v39, v64
    v_fma_f32 v23, -v71, v82, v23
    v_mul_f32 v71, v71, v64
    v_fmac_f32 v71, v39, v82
    v_mul_f32 v32, 0x3c400000, v3
    v_cos_f32 v64, v32
    v_sin_f32 v82, v32
    s_nop 0
    v_mul_f32 v39, v19, v64
    v_fma_f32 v39, -v51, v82, v39
    v_mul_f32 v51, v51, v64
    v_fmac_f32 v51, v19, v82
    v_mul_f32 v32, 0x3c500000, v3
    v_cos_f32 v64, v32
    v_sin_f32 v82, v32
    s_nop 0
    v_mul_f32 v19, v35, v64
    v_fma_f32 v19, -v67, v82, v19
    v_mul_f32 v67, v67, v64
    v_fmac_f32 v67, v35, v82
    v_mul_f32 v32, 0x3c600000, v3
    v_cos_f32 v64, v32
    v_sin_f32 v82, v32
    s_nop 0
    v_mul_f32 v35, v27, v64
    v_fma_f32 v35, -v59, v82, v35
    v_mul_f32 v59, v59, v64
    v_fmac_f32 v59, v27, v82
    v_mul_f32 v32, 0x3c700000, v3
    v_cos_f32 v64, v32
    v_sin_f32 v82, v32
    s_nop 0
    v_mul_f32 v27, v43, v64
    v_fma_f32 v27, -v75, v82, v27
    v_mul_f32 v75, v75, v64
    v_fmac_f32 v75, v43, v82
    v_mul_f32 v32, 0x3c800000, v3
    v_cos_f32 v64, v32
    v_sin_f32 v82, v32
    s_nop 0
    v_mul_f32 v43, v47, v64
    v_fma_f32 v43, -v79, v82, v43
    v_mul_f32 v79, v79, v64
    v_fmac_f32 v79, v47, v82
    v_mul_f32 v32, 0x3c880000, v3
    v_cos_f32 v64, v32
    v_sin_f32 v82, v32
    s_nop 0
    v_mul_f32 v47, v24, v64
    v_fma_f32 v47, -v56, v82, v47
    v_mul_f32 v56, v56, v64
    v_fmac_f32 v56, v24, v82
    v_mul_f32 v32, 0x3c900000, v3
    v_cos_f32 v64, v32
    v_sin_f32 v82, v32
    s_nop 0
    v_mul_f32 v24, v20, v64
    v_fma_f32 v24, -v52, v82, v24
    v_mul_f32 v52, v52, v64
    v_fmac_f32 v52, v20, v82
    v_mul_f32 v32, 0x3c980000, v3
    v_cos_f32 v64, v32
    v_sin_f32 v82, v32
    s_nop 0
    v_mul_f32 v20, v36, v64
    v_fma_f32 v20, -v68, v82, v20
    v_mul_f32 v68, v68, v64
    v_fmac_f32 v68, v36, v82
    v_mul_f32 v32, 0x3ca00000, v3
    v_cos_f32 v64, v32
    v_sin_f32 v82, v32
    s_nop 0
    v_mul_f32 v36, v18, v64
    v_fma_f32 v36, -v50, v82, v36
    v_mul_f32 v50, v50, v64
    v_fmac_f32 v50, v18, v82
    v_mul_f32 v32, 0x3ca80000, v3
    v_cos_f32 v64, v32
    v_sin_f32 v82, v32
    s_nop 0
    v_mul_f32 v18, v34, v64
    v_fma_f32 v18, -v66, v82, v18
    v_mul_f32 v66, v66, v64
    v_fmac_f32 v66, v34, v82
    v_mul_f32 v32, 0x3cb00000, v3
    v_cos_f32 v64, v32
    v_sin_f32 v82, v32
    s_nop 0
    v_mul_f32 v34, v26, v64
    v_fma_f32 v34, -v58, v82, v34
    v_mul_f32 v58, v58, v64
    v_fmac_f32 v58, v26, v82
    v_mul_f32 v32, 0x3cb80000, v3
    v_cos_f32 v64, v32
    v_sin_f32 v82, v32
    s_nop 0
    v_mul_f32 v26, v42, v64
    v_fma_f32 v26, -v74, v82, v26
    v_mul_f32 v74, v74, v64
    v_fmac_f32 v74, v42, v82
    v_mul_f32 v32, 0x3cc00000, v3
    v_cos_f32 v64, v32
    v_sin_f32 v82, v32
    s_nop 0
    v_mul_f32 v42, v17, v64
    v_fma_f32 v42, -v49, v82, v42
    v_mul_f32 v49, v49, v64
    v_fmac_f32 v49, v17, v82
    v_mul_f32 v32, 0x3cc80000, v3
    v_cos_f32 v64, v32
    v_sin_f32 v82, v32
    s_nop 0
    v_mul_f32 v17, v33, v64
    v_fma_f32 v17, -v65, v82, v17
    v_mul_f32 v65, v65, v64
    v_fmac_f32 v65, v33, v82
    v_mul_f32 v32, 0x3cd00000, v3
    v_cos_f32 v64, v32
    v_sin_f32 v82, v32
    s_nop 0
    v_mul_f32 v33, v25, v64
    v_fma_f32 v33, -v57, v82, v33
    v_mul_f32 v57, v57, v64
    v_fmac_f32 v57, v25, v82
    v_mul_f32 v32, 0x3cd80000, v3
    v_cos_f32 v64, v32
    v_sin_f32 v82, v32
    s_nop 0
    v_mul_f32 v25, v41, v64
    v_fma_f32 v25, -v73, v82, v25
    v_mul_f32 v73, v73, v64
    v_fmac_f32 v73, v41, v82
    v_mul_f32 v32, 0x3ce00000, v3
    v_cos_f32 v64, v32
    v_sin_f32 v82, v32
    s_nop 0
    v_mul_f32 v41, v21, v64
    v_fma_f32 v41, -v53, v82, v41
    v_mul_f32 v53, v53, v64
    v_fmac_f32 v53, v21, v82
    v_mul_f32 v32, 0x3ce80000, v3
    v_cos_f32 v64, v32
    v_sin_f32 v82, v32
    s_nop 0
    v_mul_f32 v21, v37, v64
    v_fma_f32 v21, -v69, v82, v21
    v_mul_f32 v69, v69, v64
    v_fmac_f32 v69, v37, v82
    v_mul_f32 v32, 0x3cf00000, v3
    v_cos_f32 v64, v32
    v_sin_f32 v82, v32
    s_nop 0
    v_mul_f32 v37, v29, v64
    v_fma_f32 v37, -v61, v82, v37
    v_mul_f32 v61, v61, v64
    v_fmac_f32 v61, v29, v82
    v_mul_f32 v32, 0x3cf80000, v3
    v_cos_f32 v64, v32
    v_sin_f32 v82, v32
    s_nop 0
    v_mul_f32 v29, v45, v64
    v_fma_f32 v29, -v77, v82, v29
    v_mul_f32 v77, v77, v64
    v_fmac_f32 v77, v45, v82
    ds_write_b32 v4, v16 offset:0
    ds_write_b32 v4, v48 offset:4
    ds_write_b32 v4, v83 offset:264
    ds_write_b32 v4, v81 offset:268
    ds_write_b32 v4, v80 offset:528
    ds_write_b32 v4, v72 offset:532
    ds_write_b32 v4, v40 offset:792
    ds_write_b32 v4, v60 offset:796
    ds_write_b32 v4, v28 offset:1056
    ds_write_b32 v4, v76 offset:1060
    ds_write_b32 v4, v44 offset:1320
    ds_write_b32 v4, v62 offset:1324
    ds_write_b32 v4, v30 offset:1584
    ds_write_b32 v4, v54 offset:1588
    ds_write_b32 v4, v22 offset:1848
    ds_write_b32 v4, v70 offset:1852
    ds_write_b32 v4, v38 offset:2112
    ds_write_b32 v4, v78 offset:2116
    ds_write_b32 v4, v46 offset:2376
    ds_write_b32 v4, v63 offset:2380
    ds_write_b32 v4, v31 offset:2640
    ds_write_b32 v4, v55 offset:2644
    ds_write_b32 v4, v23 offset:2904
    ds_write_b32 v4, v71 offset:2908
    ds_write_b32 v4, v39 offset:3168
    ds_write_b32 v4, v51 offset:3172
    ds_write_b32 v4, v19 offset:3432
    ds_write_b32 v4, v67 offset:3436
    ds_write_b32 v4, v35 offset:3696
    ds_write_b32 v4, v59 offset:3700
    ds_write_b32 v4, v27 offset:3960
    ds_write_b32 v4, v75 offset:3964
    ds_write_b32 v4, v43 offset:4224
    ds_write_b32 v4, v79 offset:4228
    ds_write_b32 v4, v47 offset:4488
    ds_write_b32 v4, v56 offset:4492
    ds_write_b32 v4, v24 offset:4752
    ds_write_b32 v4, v52 offset:4756
    ds_write_b32 v4, v20 offset:5016
    ds_write_b32 v4, v68 offset:5020
    ds_write_b32 v4, v36 offset:5280
    ds_write_b32 v4, v50 offset:5284
    ds_write_b32 v4, v18 offset:5544
    ds_write_b32 v4, v66 offset:5548
    ds_write_b32 v4, v34 offset:5808
    ds_write_b32 v4, v58 offset:5812
    ds_write_b32 v4, v26 offset:6072
    ds_write_b32 v4, v74 offset:6076
    ds_write_b32 v4, v42 offset:6336
    ds_write_b32 v4, v49 offset:6340
    ds_write_b32 v4, v17 offset:6600
    ds_write_b32 v4, v65 offset:6604
    ds_write_b32 v4, v33 offset:6864
    ds_write_b32 v4, v57 offset:6868
    ds_write_b32 v4, v25 offset:7128
    ds_write_b32 v4, v73 offset:7132
    ds_write_b32 v4, v41 offset:7392
    ds_write_b32 v4, v53 offset:7396
    ds_write_b32 v4, v21 offset:7656
    ds_write_b32 v4, v69 offset:7660
    ds_write_b32 v4, v37 offset:7920
    ds_write_b32 v4, v61 offset:7924
    ds_write_b32 v4, v29 offset:8184
    ds_write_b32 v4, v77 offset:8188
    s_waitcnt lgkmcnt(0)
    ds_read_b32 v16, v5 offset:0
    ds_read_b32 v48, v5 offset:4
    ds_read_b32 v83, v5 offset:8
    ds_read_b32 v81, v5 offset:12
    ds_read_b32 v80, v5 offset:16
    ds_read_b32 v72, v5 offset:20
    ds_read_b32 v40, v5 offset:24
    ds_read_b32 v60, v5 offset:28
    ds_read_b32 v28, v5 offset:32
    ds_read_b32 v76, v5 offset:36
    ds_read_b32 v44, v5 offset:40
    ds_read_b32 v62, v5 offset:44
    ds_read_b32 v30, v5 offset:48
    ds_read_b32 v54, v5 offset:52
    s_waitcnt lgkmcnt(0)
    ds_read_b32 v22, v5 offset:56
    ds_read_b32 v70, v5 offset:60
    ds_read_b32 v38, v5 offset:64
    ds_read_b32 v78, v5 offset:68
    ds_read_b32 v46, v5 offset:72
    ds_read_b32 v63, v5 offset:76
    ds_read_b32 v31, v5 offset:80
    ds_read_b32 v55, v5 offset:84
    ds_read_b32 v23, v5 offset:88
    ds_read_b32 v71, v5 offset:92
    ds_read_b32 v39, v5 offset:96
    ds_read_b32 v51, v5 offset:100
    ds_read_b32 v19, v5 offset:104
    ds_read_b32 v67, v5 offset:108
    s_waitcnt lgkmcnt(0)
    ds_read_b32 v35, v5 offset:112
    ds_read_b32 v59, v5 offset:116
    ds_read_b32 v27, v5 offset:120
    ds_read_b32 v75, v5 offset:124
    ds_read_b32 v43, v5 offset:128
    ds_read_b32 v79, v5 offset:132
    ds_read_b32 v47, v5 offset:136
    ds_read_b32 v56, v5 offset:140
    ds_read_b32 v24, v5 offset:144
    ds_read_b32 v52, v5 offset:148
    ds_read_b32 v20, v5 offset:152
    ds_read_b32 v68, v5 offset:156
    ds_read_b32 v36, v5 offset:160
    ds_read_b32 v50, v5 offset:164
    s_waitcnt lgkmcnt(0)
    ds_read_b32 v18, v5 offset:168
    ds_read_b32 v66, v5 offset:172
    ds_read_b32 v34, v5 offset:176
    ds_read_b32 v58, v5 offset:180
    ds_read_b32 v26, v5 offset:184
    ds_read_b32 v74, v5 offset:188
    ds_read_b32 v42, v5 offset:192
    ds_read_b32 v49, v5 offset:196
    ds_read_b32 v17, v5 offset:200
    ds_read_b32 v65, v5 offset:204
    ds_read_b32 v33, v5 offset:208
    ds_read_b32 v57, v5 offset:212
    ds_read_b32 v25, v5 offset:216
    ds_read_b32 v73, v5 offset:220
    s_waitcnt lgkmcnt(0)
    ds_read_b32 v41, v5 offset:224
    ds_read_b32 v53, v5 offset:228
    ds_read_b32 v21, v5 offset:232
    ds_read_b32 v69, v5 offset:236
    ds_read_b32 v37, v5 offset:240
    ds_read_b32 v61, v5 offset:244
    ds_read_b32 v29, v5 offset:248
    ds_read_b32 v77, v5 offset:252
    s_waitcnt lgkmcnt(0)
    v_sub_f32 v32, v16, v43
    v_sub_f32 v64, v48, v79
    v_add_f32 v16, v16, v43
    v_add_f32 v48, v48, v79
    v_sub_f32 v43, v83, v47
    v_sub_f32 v79, v81, v56
    v_add_f32 v83, v83, v47
    v_add_f32 v81, v81, v56
    v_mul_f32 v47, 0x3f7b14be, v43
    v_mul_f32 v56, 0x3e47c5c2, v43
    v_fmac_f32 v47, 0xbe47c5c2, v79
    v_fmac_f32 v56, 0x3f7b14be, v79
    v_sub_f32 v43, v80, v24
    v_sub_f32 v79, v72, v52
    v_add_f32 v80, v80, v24
    v_add_f32 v72, v72, v52
    v_mul_f32 v24, 0x3f6c835e, v43
    v_mul_f32 v52, 0x3ec3ef15, v43
    v_fmac_f32 v24, 0xbec3ef15, v79
    v_fmac_f32 v52, 0x3f6c835e, v79
    v_sub_f32 v43, v40, v20
    v_sub_f32 v79, v60, v68
    v_add_f32 v40, v40, v20
    v_add_f32 v60, v60, v68
    v_mul_f32 v20, 0x3f54db31, v43
    v_mul_f32 v68, 0x3f0e39da, v43
    v_fmac_f32 v20, 0xbf0e39da, v79
    v_fmac_f32 v68, 0x3f54db31, v79
    v_sub_f32 v43, v28, v36
    v_sub_f32 v79, v76, v50
    v_add_f32 v28, v28, v36
    v_add_f32 v76, v76, v50
    v_mul_f32 v36, 0x3f3504f3, v43
    v_mul_f32 v50, 0x3f3504f3, v43
    v_fmac_f32 v36, 0xbf3504f3, v79
    v_fmac_f32 v50, 0x3f3504f3, v79
    v_sub_f32 v43, v44, v18
    v_sub_f32 v79, v62, v66
    v_add_f32 v44, v44, v18
    v_add_f32 v62, v62, v66
    v_mul_f32 v18, 0x3f0e39da, v43
    v_mul_f32 v66, 0x3f54db31, v43
    v_fmac_f32 v18, 0xbf54db31, v79
    v_fmac_f32 v66, 0x3f0e39da, v79
    v_sub_f32 v43, v30, v34
    v_sub_f32 v79, v54, v58
    v_add_f32 v30, v30, v34
    v_add_f32 v54, v54, v58
    v_mul_f32 v34, 0x3ec3ef15, v43
    v_mul_f32 v58, 0x3f6c835e, v43
    v_fmac_f32 v34, 0xbf6c835e, v79
    v_fmac_f32 v58, 0x3ec3ef15, v79
    v_sub_f32 v43, v22, v26
    v_sub_f32 v79, v70, v74
    v_add_f32 v22, v22, v26
    v_add_f32 v70, v70, v74
    v_mul_f32 v26, 0x3e47c5c2, v43
    v_mul_f32 v74, 0x3f7b14be, v43
    v_fmac_f32 v26, 0xbf7b14be, v79
    v_fmac_f32 v74, 0x3e47c5c2, v79
    v_sub_f32 v43, v49, v78
    v_sub_f32 v79, v38, v42
    v_add_f32 v38, v38, v42
    v_add_f32 v78, v78, v49
    v_sub_f32 v42, v46, v17
    v_sub_f32 v49, v63, v65
    v_add_f32 v46, v46, v17
    v_add_f32 v63, v63, v65
    v_mul_f32 v17, 0xbe47c5c2, v42
    v_mul_f32 v65, 0x3f7b14be, v42
    v_fmac_f32 v17, 0xbf7b14be, v49
    v_fmac_f32 v65, 0xbe47c5c2, v49
    v_sub_f32 v42, v31, v33
    v_sub_f32 v49, v55, v57
    v_add_f32 v31, v31, v33
    v_add_f32 v55, v55, v57
    v_mul_f32 v33, 0xbec3ef15, v42
    v_mul_f32 v57, 0x3f6c835e, v42
    v_fmac_f32 v33, 0xbf6c835e, v49
    v_fmac_f32 v57, 0xbec3ef15, v49
    v_sub_f32 v42, v23, v25
    v_sub_f32 v49, v71, v73
    v_add_f32 v23, v23, v25
    v_add_f32 v71, v71, v73
    v_mul_f32 v25, 0xbf0e39da, v42
    v_mul_f32 v73, 0x3f54db31, v42
    v_fmac_f32 v25, 0xbf54db31, v49
    v_fmac_f32 v73, 0xbf0e39da, v49
    v_sub_f32 v42, v39, v41
    v_sub_f32 v49, v51, v53
    v_add_f32 v39, v39, v41
    v_add_f32 v51, v51, v53
    v_mul_f32 v41, 0xbf3504f3, v42
    v_mul_f32 v53, 0x3f3504f3, v42
    v_fmac_f32 v41, 0xbf3504f3, v49
    v_fmac_f32 v53, 0xbf3504f3, v49
    v_sub_f32 v42, v19, v21
    v_sub_f32 v49, v67, v69
    v_add_f32 v19, v19, v21
    v_add_f32 v67, v67, v69
    v_mul_f32 v21, 0xbf54db31, v42
    v_mul_f32 v69, 0x3f0e39da, v42
    v_fmac_f32 v21, 0xbf0e39da, v49
    v_fmac_f32 v69, 0xbf54db31, v49
    v_sub_f32 v42, v35, v37
    v_sub_f32 v49, v59, v61
    v_add_f32 v35, v35, v37
    v_add_f32 v59, v59, v61
    v_mul_f32 v37, 0xbf6c835e, v42
    v_mul_f32 v61, 0x3ec3ef15, v42
    v_fmac_f32 v37, 0xbec3ef15, v49
    v_fmac_f32 v61, 0xbf6c835e, v49
    v_sub_f32 v42, v27, v29
    v_sub_f32 v49, v75, v77
    v_add_f32 v27, v27, v29
    v_add_f32 v75, v75, v77
    v_mul_f32 v29, 0xbf7b14be, v42
    v_mul_f32 v77, 0x3e47c5c2, v42
    v_fmac_f32 v29, 0xbe47c5c2, v49
    v_fmac_f32 v77, 0xbf7b14be, v49
    v_sub_f32 v42, v16, v38
    v_sub_f32 v49, v48, v78
    v_add_f32 v16, v16, v38
    v_add_f32 v48, v48, v78
    v_sub_f32 v38, v83, v46
    v_sub_f32 v78, v81, v63
    v_add_f32 v83, v83, v46
    v_add_f32 v81, v81, v63
    v_mul_f32 v46, 0x3f6c835e, v38
    v_mul_f32 v63, 0x3ec3ef15, v38
    v_fmac_f32 v46, 0xbec3ef15, v78
    v_fmac_f32 v63, 0x3f6c835e, v78
    v_sub_f32 v38, v80, v31
    v_sub_f32 v78, v72, v55
    v_add_f32 v80, v80, v31
    v_add_f32 v72, v72, v55
    v_mul_f32 v31, 0x3f3504f3, v38
    v_mul_f32 v55, 0x3f3504f3, v38
    v_fmac_f32 v31, 0xbf3504f3, v78
    v_fmac_f32 v55, 0x3f3504f3, v78
    v_sub_f32 v38, v40, v23
    v_sub_f32 v78, v60, v71
    v_add_f32 v40, v40, v23
    v_add_f32 v60, v60, v71
    v_mul_f32 v23, 0x3ec3ef15, v38
    v_mul_f32 v71, 0x3f6c835e, v38
    v_fmac_f32 v23, 0xbf6c835e, v78
    v_fmac_f32 v71, 0x3ec3ef15, v78
    v_sub_f32 v38, v51, v76
    v_sub_f32 v78, v28, v39
    v_add_f32 v28, v28, v39
    v_add_f32 v76, v76, v51
    v_sub_f32 v39, v44, v19
    v_sub_f32 v51, v62, v67
    v_add_f32 v44, v44, v19
    v_add_f32 v62, v62, v67
    v_mul_f32 v19, 0xbec3ef15, v39
    v_mul_f32 v67, 0x3f6c835e, v39
    v_fmac_f32 v19, 0xbf6c835e, v51
    v_fmac_f32 v67, 0xbec3ef15, v51
    v_sub_f32 v39, v30, v35
    v_sub_f32 v51, v54, v59
    v_add_f32 v30, v30, v35
    v_add_f32 v54, v54, v59
    v_mul_f32 v35, 0xbf3504f3, v39
    v_mul_f32 v59, 0x3f3504f3, v39
    v_fmac_f32 v35, 0xbf3504f3, v51
    v_fmac_f32 v59, 0xbf3504f3, v51
    v_sub_f32 v39, v22, v27
    v_sub_f32 v51, v70, v75
    v_add_f32 v22, v22, v27
    v_add_f32 v70, v70, v75
    v_mul_f32 v27, 0xbf6c835e, v39
    v_mul_f32 v75, 0x3ec3ef15, v39
    v_fmac_f32 v27, 0xbec3ef15, v51
    v_fmac_f32 v75, 0xbf6c835e, v51
    v_sub_f32 v39, v32, v43
    v_sub_f32 v51, v64, v79
    v_add_f32 v32, v32, v43
    v_add_f32 v64, v64, v79
    v_sub_f32 v43, v47, v17
    v_sub_f32 v79, v56, v65
    v_add_f32 v47, v47, v17
    v_add_f32 v56, v56, v65
    v_mul_f32 v17, 0x3f6c835e, v43
    v_mul_f32 v65, 0x3ec3ef15, v43
    v_fmac_f32 v17, 0xbec3ef15, v79
    v_fmac_f32 v65, 0x3f6c835e, v79
    v_sub_f32 v43, v24, v33
    v_sub_f32 v79, v52, v57
    v_add_f32 v24, v24, v33
    v_add_f32 v52, v52, v57
    v_mul_f32 v33, 0x3f3504f3, v43
    v_mul_f32 v57, 0x3f3504f3, v43
    v_fmac_f32 v33, 0xbf3504f3, v79
    v_fmac_f32 v57, 0x3f3504f3, v79
    v_sub_f32 v43, v20, v25
    v_sub_f32 v79, v68, v73
    v_add_f32 v20, v20, v25
    v_add_f32 v68, v68, v73
    v_mul_f32 v25, 0x3ec3ef15, v43
    v_mul_f32 v73, 0x3f6c835e, v43
    v_fmac_f32 v25, 0xbf6c835e, v79
    v_fmac_f32 v73, 0x3ec3ef15, v79
    v_sub_f32 v43, v53, v50
    v_sub_f32 v79, v36, v41
    v_add_f32 v36, v36, v41
    v_add_f32 v50, v50, v53
    v_sub_f32 v41, v18, v21
    v_sub_f32 v53, v66, v69
    v_add_f32 v18, v18, v21
    v_add_f32 v66, v66, v69
    v_mul_f32 v21, 0xbec3ef15, v41
    v_mul_f32 v69, 0x3f6c835e, v41
    v_fmac_f32 v21, 0xbf6c835e, v53
    v_fmac_f32 v69, 0xbec3ef15, v53
    v_sub_f32 v41, v34, v37
    v_sub_f32 v53, v58, v61
    v_add_f32 v34, v34, v37
    v_add_f32 v58, v58, v61
    v_mul_f32 v37, 0xbf3504f3, v41
    v_mul_f32 v61, 0x3f3504f3, v41
    v_fmac_f32 v37, 0xbf3504f3, v53
    v_fmac_f32 v61, 0xbf3504f3, v53
    v_sub_f32 v41, v26, v29
    v_sub_f32 v53, v74, v77
    v_add_f32 v26, v26, v29
    v_add_f32 v74, v74, v77
    v_mul_f32 v29, 0xbf6c835e, v41
    v_mul_f32 v77, 0x3ec3ef15, v41
    v_fmac_f32 v29, 0xbec3ef15, v53
    v_fmac_f32 v77, 0xbf6c835e, v53
    v_sub_f32 v41, v16, v28
    v_sub_f32 v53, v48, v76
    v_add_f32 v16, v16, v28
    v_add_f32 v48, v48, v76
    v_sub_f32 v28, v83, v44
    v_sub_f32 v76, v81, v62
    v_add_f32 v83, v83, v44
    v_add_f32 v81, v81, v62
    v_mul_f32 v44, 0x3f3504f3, v28
    v_mul_f32 v62, 0x3f3504f3, v28
    v_fmac_f32 v44, 0xbf3504f3, v76
    v_fmac_f32 v62, 0x3f3504f3, v76
    v_sub_f32 v28, v54, v72
    v_sub_f32 v76, v80, v30
    v_add_f32 v80, v80, v30
    v_add_f32 v72, v72, v54
    v_sub_f32 v30, v40, v22
    v_sub_f32 v54, v60, v70
    v_add_f32 v40, v40, v22
    v_add_f32 v60, v60, v70
    v_mul_f32 v22, 0xbf3504f3, v30
    v_mul_f32 v70, 0x3f3504f3, v30
    v_fmac_f32 v22, 0xbf3504f3, v54
    v_fmac_f32 v70, 0xbf3504f3, v54
    v_sub_f32 v30, v42, v38
    v_sub_f32 v54, v49, v78
    v_add_f32 v42, v42, v38
    v_add_f32 v49, v49, v78
    v_sub_f32 v38, v46, v19
    v_sub_f32 v78, v63, v67
    v_add_f32 v46, v46, v19
    v_add_f32 v63, v63, v67
    v_mul_f32 v19, 0x3f3504f3, v38
    v_mul_f32 v67, 0x3f3504f3, v38
    v_fmac_f32 v19, 0xbf3504f3, v78
    v_fmac_f32 v67, 0x3f3504f3, v78
    v_sub_f32 v38, v59, v55
    v_sub_f32 v78, v31, v35
    v_add_f32 v31, v31, v35
    v_add_f32 v55, v55, v59
    v_sub_f32 v35, v23, v27
    v_sub_f32 v59, v71, v75
    v_add_f32 v23, v23, v27
    v_add_f32 v71, v71, v75
    v_mul_f32 v27, 0xbf3504f3, v35
    v_mul_f32 v75, 0x3f3504f3, v35
    v_fmac_f32 v27, 0xbf3504f3, v59
    v_fmac_f32 v75, 0xbf3504f3, v59
    v_sub_f32 v35, v32, v36
    v_sub_f32 v59, v64, v50
    v_add_f32 v32, v32, v36
    v_add_f32 v64, v64, v50
    v_sub_f32 v36, v47, v18
    v_sub_f32 v50, v56, v66
    v_add_f32 v47, v47, v18
    v_add_f32 v56, v56, v66
    v_mul_f32 v18, 0x3f3504f3, v36
    v_mul_f32 v66, 0x3f3504f3, v36
    v_fmac_f32 v18, 0xbf3504f3, v50
    v_fmac_f32 v66, 0x3f3504f3, v50
    v_sub_f32 v36, v58, v52
    v_sub_f32 v50, v24, v34
    v_add_f32 v24, v24, v34
    v_add_f32 v52, v52, v58
    v_sub_f32 v34, v20, v26
    v_sub_f32 v58, v68, v74
    v_add_f32 v20, v20, v26
    v_add_f32 v68, v68, v74
    v_mul_f32 v26, 0xbf3504f3, v34
    v_mul_f32 v74, 0x3f3504f3, v34
    v_fmac_f32 v26, 0xbf3504f3, v58
    v_fmac_f32 v74, 0xbf3504f3, v58
    v_sub_f32 v34, v39, v43
    v_sub_f32 v58, v51, v79
    v_add_f32 v39, v39, v43
    v_add_f32 v51, v51, v79
    v_sub_f32 v43, v17, v21
    v_sub_f32 v79, v65, v69
    v_add_f32 v17, v17, v21
    v_add_f32 v65, v65, v69
    v_mul_f32 v21, 0x3f3504f3, v43
    v_mul_f32 v69, 0x3f3504f3, v43
    v_fmac_f32 v21, 0xbf3504f3, v79
    v_fmac_f32 v69, 0x3f3504f3, v79
    v_sub_f32 v43, v61, v57
    v_sub_f32 v79, v33, v37
    v_add_f32 v33, v33, v37
    v_add_f32 v57, v57, v61
    v_sub_f32 v37, v25, v29
    v_sub_f32 v61, v73, v77
    v_add_f32 v25, v25, v29
    v_add_f32 v73, v73, v77
    v_mul_f32 v29, 0xbf3504f3, v37
    v_mul_f32 v77, 0x3f3504f3, v37
    v_fmac_f32 v29, 0xbf3504f3, v61
    v_fmac_f32 v77, 0xbf3504f3, v61
    v_sub_f32 v37, v16, v80
    v_sub_f32 v61, v48, v72
    v_add_f32 v16, v16, v80
    v_add_f32 v48, v48, v72
    v_sub_f32 v80, v60, v81
    v_sub_f32 v72, v83, v40
    v_add_f32 v83, v83, v40
    v_add_f32 v81, v81, v60
    v_sub_f32 v40, v41, v28
    v_sub_f32 v60, v53, v76
    v_add_f32 v41, v41, v28
    v_add_f32 v53, v53, v76
    v_sub_f32 v28, v70, v62
    v_sub_f32 v76, v44, v22
    v_add_f32 v44, v44, v22
    v_add_f32 v62, v62, v70
    v_sub_f32 v22, v42, v31
    v_sub_f32 v70, v49, v55
    v_add_f32 v42, v42, v31
    v_add_f32 v49, v49, v55
    v_sub_f32 v31, v71, v63
    v_sub_f32 v55, v46, v23
    v_add_f32 v46, v46, v23
    v_add_f32 v63, v63, v71
    v_sub_f32 v23, v30, v38
    v_sub_f32 v71, v54, v78
    v_add_f32 v30, v30, v38
    v_add_f32 v54, v54, v78
    v_sub_f32 v38, v75, v67
    v_sub_f32 v78, v19, v27
    v_add_f32 v19, v19, v27
    v_add_f32 v67, v67, v75
    v_sub_f32 v27, v32, v24
    v_sub_f32 v75, v64, v52
    v_add_f32 v32, v32, v24
    v_add_f32 v64, v64, v52
    v_sub_f32 v24, v68, v56
    v_sub_f32 v52, v47, v20
    v_add_f32 v47, v47, v20
    v_add_f32 v56, v56, v68
    v_sub_f32 v20, v35, v36
    v_sub_f32 v68, v59, v50
    v_add_f32 v35, v35, v36
    v_add_f32 v59, v59, v50
    v_sub_f32 v36, v74, v66
    v_sub_f32 v50, v18, v26
    v_add_f32 v18, v18, v26
    v_add_f32 v66, v66, v74
    v_sub_f32 v26, v39, v33
    v_sub_f32 v74, v51, v57
    v_add_f32 v39, v39, v33
    v_add_f32 v51, v51, v57
    v_sub_f32 v33, v73, v65
    v_sub_f32 v57, v17, v25
    v_add_f32 v17, v17, v25
    v_add_f32 v65, v65, v73
    v_sub_f32 v25, v34, v43
    v_sub_f32 v73, v58, v79
    v_add_f32 v34, v34, v43
    v_add_f32 v58, v58, v79
    v_sub_f32 v43, v77, v69
    v_sub_f32 v79, v21, v29
    v_add_f32 v21, v21, v29
    v_add_f32 v69, v69, v77
    v_sub_f32 v29, v16, v83
    v_sub_f32 v77, v48, v81
    v_add_f32 v16, v16, v83
    v_add_f32 v48, v48, v81
    v_sub_f32 v83, v37, v80
    v_sub_f32 v81, v61, v72
    v_add_f32 v37, v37, v80
    v_add_f32 v61, v61, v72
    v_sub_f32 v80, v41, v44
    v_sub_f32 v72, v53, v62
    v_add_f32 v41, v41, v44
    v_add_f32 v53, v53, v62
    v_sub_f32 v44, v40, v28
    v_sub_f32 v62, v60, v76
    v_add_f32 v40, v40, v28
    v_add_f32 v60, v60, v76
    v_sub_f32 v28, v42, v46
    v_sub_f32 v76, v49, v63
    v_add_f32 v42, v42, v46
    v_add_f32 v49, v49, v63
    v_sub_f32 v46, v22, v31
    v_sub_f32 v63, v70, v55
    v_add_f32 v22, v22, v31
    v_add_f32 v70, v70, v55
    v_sub_f32 v31, v30, v19
    v_sub_f32 v55, v54, v67
    v_add_f32 v30, v30, v19
    v_add_f32 v54, v54, v67
    v_sub_f32 v19, v23, v38
    v_sub_f32 v67, v71, v78
    v_add_f32 v23, v23, v38
    v_add_f32 v71, v71, v78
    v_sub_f32 v38, v32, v47
    v_sub_f32 v78, v64, v56
    v_add_f32 v32, v32, v47
    v_add_f32 v64, v64, v56
    v_sub_f32 v47, v27, v24
    v_sub_f32 v56, v75, v52
    v_add_f32 v27, v27, v24
    v_add_f32 v75, v75, v52
    v_sub_f32 v24, v35, v18
    v_sub_f32 v52, v59, v66
    v_add_f32 v35, v35, v18
    v_add_f32 v59, v59, v66
    v_sub_f32 v18, v20, v36
    v_sub_f32 v66, v68, v50
    v_add_f32 v20, v20, v36
    v_add_f32 v68, v68, v50
    v_sub_f32 v36, v39, v17
    v_sub_f32 v50, v51, v65
    v_add_f32 v39, v39, v17
    v_add_f32 v51, v51, v65
    v_sub_f32 v17, v26, v33
    v_sub_f32 v65, v74, v57
    v_add_f32 v26, v26, v33
    v_add_f32 v74, v74, v57
    v_sub_f32 v33, v34, v21
    v_sub_f32 v57, v58, v69
    v_add_f32 v34, v34, v21
    v_add_f32 v58, v58, v69
    v_sub_f32 v21, v25, v43
    v_sub_f32 v69, v73, v79
    v_add_f32 v25, v25, v43
    v_add_f32 v73, v73, v79
    v_lshl_add_u32 v6, v1, 2, v7
    ds_write_b32 v6, v16 offset:0
    ds_write_b32 v6, v48 offset:4096
    ds_write_b32 v6, v32 offset:128
    ds_write_b32 v6, v64 offset:4224
    ds_write_b32 v6, v42 offset:256
    ds_write_b32 v6, v49 offset:4352
    ds_write_b32 v6, v39 offset:384
    ds_write_b32 v6, v51 offset:4480
    ds_write_b32 v6, v41 offset:512
    ds_write_b32 v6, v53 offset:4608
    ds_write_b32 v6, v35 offset:640
    ds_write_b32 v6, v59 offset:4736
    ds_write_b32 v6, v30 offset:768
    ds_write_b32 v6, v54 offset:4864
    ds_write_b32 v6, v34 offset:896
    ds_write_b32 v6, v58 offset:4992
    ds_write_b32 v6, v37 offset:1024
    ds_write_b32 v6, v61 offset:5120
    ds_write_b32 v6, v27 offset:1152
    ds_write_b32 v6, v75 offset:5248
    ds_write_b32 v6, v22 offset:1280
    ds_write_b32 v6, v70 offset:5376
    ds_write_b32 v6, v26 offset:1408
    ds_write_b32 v6, v74 offset:5504
    ds_write_b32 v6, v40 offset:1536
    ds_write_b32 v6, v60 offset:5632
    ds_write_b32 v6, v20 offset:1664
    ds_write_b32 v6, v68 offset:5760
    ds_write_b32 v6, v23 offset:1792
    ds_write_b32 v6, v71 offset:5888
    ds_write_b32 v6, v25 offset:1920
    ds_write_b32 v6, v73 offset:6016
    ds_write_b32 v6, v29 offset:2048
    ds_write_b32 v6, v77 offset:6144
    ds_write_b32 v6, v38 offset:2176
    ds_write_b32 v6, v78 offset:6272
    ds_write_b32 v6, v28 offset:2304
    ds_write_b32 v6, v76 offset:6400
    ds_write_b32 v6, v36 offset:2432
    ds_write_b32 v6, v50 offset:6528
    ds_write_b32 v6, v80 offset:2560
    ds_write_b32 v6, v72 offset:6656
    ds_write_b32 v6, v24 offset:2688
    ds_write_b32 v6, v52 offset:6784
    ds_write_b32 v6, v31 offset:2816
    ds_write_b32 v6, v55 offset:6912
    ds_write_b32 v6, v33 offset:2944
    ds_write_b32 v6, v57 offset:7040
    ds_write_b32 v6, v83 offset:3072
    ds_write_b32 v6, v81 offset:7168
    ds_write_b32 v6, v47 offset:3200
    ds_write_b32 v6, v56 offset:7296
    ds_write_b32 v6, v46 offset:3328
    ds_write_b32 v6, v63 offset:7424
    ds_write_b32 v6, v17 offset:3456
    ds_write_b32 v6, v65 offset:7552
    ds_write_b32 v6, v44 offset:3584
    ds_write_b32 v6, v62 offset:7680
    ds_write_b32 v6, v18 offset:3712
    ds_write_b32 v6, v66 offset:7808
    ds_write_b32 v6, v19 offset:3840
    ds_write_b32 v6, v67 offset:7936
    ds_write_b32 v6, v21 offset:3968
    ds_write_b32 v6, v69 offset:8064
    s_waitcnt lgkmcnt(0)
    s_barrier
    v_and_b32 v6, 127, v0
    v_lshrrev_b32 v7, 7, v0
    v_lshlrev_b32 v8, 5, v6
    v_lshl_add_u32 v8, v7, 12, v8
    v_lshlrev_b32 v5, 4, v6
    v_lshl_add_u32 v5, v7, 12, v5
    v_add_u32 v5, 2048, v5
    s_lshl_b32 s12, s92, 16
    ds_read_b128 v[16:19], v8 offset:0
    ds_read_b128 v[20:23], v8 offset:16
    s_waitcnt lgkmcnt(0)
    v_cvt_pk_bf16_f32 v24, v16, v17
    v_cvt_pk_bf16_f32 v25, v18, v19
    v_cvt_pk_bf16_f32 v26, v20, v21
    v_cvt_pk_bf16_f32 v27, v22, v23
    s_add_u32 s13, s12, 0
    buffer_store_dwordx4 v[24:27], v5, s[4:7], s13 offen
    s_nop 1
    ds_read_b128 v[16:19], v8 offset:8448
    ds_read_b128 v[20:23], v8 offset:8464
    s_waitcnt lgkmcnt(0)
    v_cvt_pk_bf16_f32 v24, v16, v17
    v_cvt_pk_bf16_f32 v25, v18, v19
    v_cvt_pk_bf16_f32 v26, v20, v21
    v_cvt_pk_bf16_f32 v27, v22, v23
    s_add_u32 s13, s12, 8192
    buffer_store_dwordx4 v[24:27], v5, s[4:7], s13 offen
    s_nop 1
    ds_read_b128 v[16:19], v8 offset:16896
    ds_read_b128 v[20:23], v8 offset:16912
    s_waitcnt lgkmcnt(0)
    v_cvt_pk_bf16_f32 v24, v16, v17
    v_cvt_pk_bf16_f32 v25, v18, v19
    v_cvt_pk_bf16_f32 v26, v20, v21
    v_cvt_pk_bf16_f32 v27, v22, v23
    s_add_u32 s13, s12, 16384
    buffer_store_dwordx4 v[24:27], v5, s[4:7], s13 offen
    s_nop 1
    ds_read_b128 v[16:19], v8 offset:25344
    ds_read_b128 v[20:23], v8 offset:25360
    s_waitcnt lgkmcnt(0)
    v_cvt_pk_bf16_f32 v24, v16, v17
    v_cvt_pk_bf16_f32 v25, v18, v19
    v_cvt_pk_bf16_f32 v26, v20, v21
    v_cvt_pk_bf16_f32 v27, v22, v23
    s_add_u32 s13, s12, 24576
    buffer_store_dwordx4 v[24:27], v5, s[4:7], s13 offen
    s_nop 1
    ds_read_b128 v[16:19], v8 offset:33792
    ds_read_b128 v[20:23], v8 offset:33808
    s_waitcnt lgkmcnt(0)
    v_cvt_pk_bf16_f32 v24, v16, v17
    v_cvt_pk_bf16_f32 v25, v18, v19
    v_cvt_pk_bf16_f32 v26, v20, v21
    v_cvt_pk_bf16_f32 v27, v22, v23
    s_add_u32 s13, s12, 32768
    buffer_store_dwordx4 v[24:27], v5, s[4:7], s13 offen
    s_nop 1
    ds_read_b128 v[16:19], v8 offset:42240
    ds_read_b128 v[20:23], v8 offset:42256
    s_waitcnt lgkmcnt(0)
    v_cvt_pk_bf16_f32 v24, v16, v17
    v_cvt_pk_bf16_f32 v25, v18, v19
    v_cvt_pk_bf16_f32 v26, v20, v21
    v_cvt_pk_bf16_f32 v27, v22, v23
    s_add_u32 s13, s12, 40960
    buffer_store_dwordx4 v[24:27], v5, s[4:7], s13 offen
    s_nop 1
    ds_read_b128 v[16:19], v8 offset:50688
    ds_read_b128 v[20:23], v8 offset:50704
    s_waitcnt lgkmcnt(0)
    v_cvt_pk_bf16_f32 v24, v16, v17
    v_cvt_pk_bf16_f32 v25, v18, v19
    v_cvt_pk_bf16_f32 v26, v20, v21
    v_cvt_pk_bf16_f32 v27, v22, v23
    s_add_u32 s13, s12, 49152
    buffer_store_dwordx4 v[24:27], v5, s[4:7], s13 offen
    s_nop 1
    ds_read_b128 v[16:19], v8 offset:59136
    ds_read_b128 v[20:23], v8 offset:59152
    s_waitcnt lgkmcnt(0)
    v_cvt_pk_bf16_f32 v24, v16, v17
    v_cvt_pk_bf16_f32 v25, v18, v19
    v_cvt_pk_bf16_f32 v26, v20, v21
    v_cvt_pk_bf16_f32 v27, v22, v23
    s_add_u32 s13, s12, 57344
    buffer_store_dwordx4 v[24:27], v5, s[4:7], s13 offen
    s_nop 1
mega_kernel_xo:
    s_waitcnt vmcnt(0) lgkmcnt(0)
    s_barrier
    s_cmp_lg_u32 s92, 128
    s_cbranch_scc1 mega_kernel_xo2
    s_cmp_lg_u32 s98, 0
    s_cbranch_scc1 mega_kernel_xo2
mega_kernel_wf1b:
    s_sleep 8
    buffer_load_dword v2, off, s[88:91], 0 offset:72 sc1
    s_waitcnt vmcnt(0)
    v_cmp_ne_u32 vcc, 192, v2
    s_cbranch_vccnz mega_kernel_wf1b
    s_mov_b32 s99, 128
    s_branch mega_kernel_f2_in
mega_kernel_f2ret:
    s_waitcnt vmcnt(0)
    v_mov_b32 v2, 1
    s_mov_b64 exec, 1
    buffer_atomic_add v2, off, s[88:91], 0 offset:136 sc1
    s_mov_b64 exec, -1
mega_kernel_xo2:
    s_load_dwordx2 s[8:9], s[0:1], 40
    s_load_dwordx2 s[12:13], s[0:1], 80
    v_lshrrev_b32 v3, 6, v0
    v_and_b32 v1, 63, v0
    v_readfirstlane_b32 s16, v3
    s_lshr_b32 s17, s92, 5
    s_and_b32 s18, s92, 31
    v_lshlrev_b32 v2, 4, v1
    s_waitcnt lgkmcnt(0)
    s_mov_b32 s10, 8388608
    s_mov_b32 s11, 0x00020000
    s_mov_b32 s14, 8388608
    s_mov_b32 s15, 0x00020000
    s_mov_b32 s24, 0x3e0293ee
    v_lshrrev_b32 v3, 2, v1
    v_lshlrev_b32 v3, 11, v3
    v_and_b32 v4, 3, v1
    v_lshl_add_u32 v3, v4, 4, v3
    s_lshl_b32 s20, s16, 21
    s_lshl_b32 s21, s18, 6
    s_add_u32 s20, s20, s21
    v_add_u32 v24, s20, v3
    s_lshl_b32 s44, s16, 15
    s_lshr_b32 s50, s18, 1
    s_lshl_b32 s50, s50, 12
    v_lshrrev_b32 v3, 5, v1
    v_bfe_u32 v5, v1, 2, 2
    v_lshl_add_u32 v3, v3, 3, v5
    v_lshlrev_b32 v25, 6, v3
    v_bfe_u32 v5, v1, 4, 1
    v_lshl_add_u32 v25, v5, 5, v25
    v_lshl_add_u32 v25, v4, 3, v25
    v_add_u32 v25, s44, v25
    s_lshl_b32 s47, s17, 2
    s_add_u32 s20, s47, s16
    s_lshl_b32 s20, s20, 18
    s_lshl_b32 s21, s18, 13
    s_add_u32 s20, s20, s21
    s_add_u32 s20, s20, 50331648
    v_lshlrev_b32 v26, 7, v1
    buffer_load_dword v28, v26, s[84:87], s20 offen sc1
    s_add_u32 m0, s44, 0
    s_add_u32 s20, s50, 0
    s_and_b32 s20, s20, 0xffff
    s_lshl_b32 s20, s20, 5
    buffer_load_dwordx4 v24, s[8:11], s20 offen lds
    s_add_u32 m0, s44, 1024
    s_add_u32 s20, s50, 1024
    s_and_b32 s20, s20, 0xffff
    s_lshl_b32 s20, s20, 5
    buffer_load_dwordx4 v24, s[8:11], s20 offen lds
    s_add_u32 m0, s44, 2048
    s_add_u32 s20, s50, 2048
    s_and_b32 s20, s20, 0xffff
    s_lshl_b32 s20, s20, 5
    buffer_load_dwordx4 v24, s[8:11], s20 offen lds
    s_add_u32 m0, s44, 3072
    s_add_u32 s20, s50, 3072
    s_and_b32 s20, s20, 0xffff
    s_lshl_b32 s20, s20, 5
    buffer_load_dwordx4 v24, s[8:11], s20 offen lds
    s_add_u32 m0, s44, 4096
    s_add_u32 s20, s50, 4096
    s_and_b32 s20, s20, 0xffff
    s_lshl_b32 s20, s20, 5
    buffer_load_dwordx4 v24, s[8:11], s20 offen lds
    s_add_u32 m0, s44, 5120
    s_add_u32 s20, s50, 5120
    s_and_b32 s20, s20, 0xffff
    s_lshl_b32 s20, s20, 5
    buffer_load_dwordx4 v24, s[8:11], s20 offen lds
    s_add_u32 m0, s44, 6144
    s_add_u32 s20, s50, 6144
    s_and_b32 s20, s20, 0xffff
    s_lshl_b32 s20, s20, 5
    buffer_load_dwordx4 v24, s[8:11], s20 offen lds
    s_add_u32 m0, s44, 7168
    s_add_u32 s20, s50, 7168
    s_and_b32 s20, s20, 0xffff
    s_lshl_b32 s20, s20, 5
    buffer_load_dwordx4 v24, s[8:11], s20 offen lds
    s_add_u32 m0, s44, 8192
    s_add_u32 s20, s50, 8192
    s_and_b32 s20, s20, 0xffff
    s_lshl_b32 s20, s20, 5
    buffer_load_dwordx4 v24, s[8:11], s20 offen lds
    s_add_u32 m0, s44, 9216
    s_add_u32 s20, s50, 9216
    s_and_b32 s20, s20, 0xffff
    s_lshl_b32 s20, s20, 5
    buffer_load_dwordx4 v24, s[8:11], s20 offen lds
    s_add_u32 m0, s44, 10240
    s_add_u32 s20, s50, 10240
    s_and_b32 s20, s20, 0xffff
    s_lshl_b32 s20, s20, 5
    buffer_load_dwordx4 v24, s[8:11], s20 offen lds
    s_add_u32 m0, s44, 11264
    s_add_u32 s20, s50, 11264
    s_and_b32 s20, s20, 0xffff
    s_lshl_b32 s20, s20, 5
    buffer_load_dwordx4 v24, s[8:11], s20 offen lds
    s_add_u32 m0, s44, 12288
    s_add_u32 s20, s50, 12288
    s_and_b32 s20, s20, 0xffff
    s_lshl_b32 s20, s20, 5
    buffer_load_dwordx4 v24, s[8:11], s20 offen lds
    s_add_u32 m0, s44, 13312
    s_add_u32 s20, s50, 13312
    s_and_b32 s20, s20, 0xffff
    s_lshl_b32 s20, s20, 5
    buffer_load_dwordx4 v24, s[8:11], s20 offen lds
    s_add_u32 m0, s44, 14336
    s_add_u32 s20, s50, 14336
    s_and_b32 s20, s20, 0xffff
    s_lshl_b32 s20, s20, 5
    buffer_load_dwordx4 v24, s[8:11], s20 offen lds
    s_add_u32 m0, s44, 15360
    s_add_u32 s20, s50, 15360
    s_and_b32 s20, s20, 0xffff
    s_lshl_b32 s20, s20, 5
    buffer_load_dwordx4 v24, s[8:11], s20 offen lds
    s_add_u32 m0, s44, 16384
    s_add_u32 s20, s50, 16384
    s_and_b32 s20, s20, 0xffff
    s_lshl_b32 s20, s20, 5
    buffer_load_dwordx4 v24, s[8:11], s20 offen lds
    s_add_u32 m0, s44, 17408
    s_add_u32 s20, s50, 17408
    s_and_b32 s20, s20, 0xffff
    s_lshl_b32 s20, s20, 5
    buffer_load_dwordx4 v24, s[8:11], s20 offen lds
    s_add_u32 m0, s44, 18432
    s_add_u32 s20, s50, 18432
    s_and_b32 s20, s20, 0xffff
    s_lshl_b32 s20, s20, 5
    buffer_load_dwordx4 v24, s[8:11], s20 offen lds
    s_add_u32 m0, s44, 19456
    s_add_u32 s20, s50, 19456
    s_and_b32 s20, s20, 0xffff
    s_lshl_b32 s20, s20, 5
    buffer_load_dwordx4 v24, s[8:11], s20 offen lds
    s_add_u32 m0, s44, 20480
    s_add_u32 s20, s50, 20480
    s_and_b32 s20, s20, 0xffff
    s_lshl_b32 s20, s20, 5
    buffer_load_dwordx4 v24, s[8:11], s20 offen lds
    s_add_u32 m0, s44, 21504
    s_add_u32 s20, s50, 21504
    s_and_b32 s20, s20, 0xffff
    s_lshl_b32 s20, s20, 5
    buffer_load_dwordx4 v24, s[8:11], s20 offen lds
    s_add_u32 m0, s44, 22528
    s_add_u32 s20, s50, 22528
    s_and_b32 s20, s20, 0xffff
    s_lshl_b32 s20, s20, 5
    buffer_load_dwordx4 v24, s[8:11], s20 offen lds
    s_add_u32 m0, s44, 23552
    s_add_u32 s20, s50, 23552
    s_and_b32 s20, s20, 0xffff
    s_lshl_b32 s20, s20, 5
    buffer_load_dwordx4 v24, s[8:11], s20 offen lds
    s_add_u32 m0, s44, 24576
    s_add_u32 s20, s50, 24576
    s_and_b32 s20, s20, 0xffff
    s_lshl_b32 s20, s20, 5
    buffer_load_dwordx4 v24, s[8:11], s20 offen lds
    s_add_u32 m0, s44, 25600
    s_add_u32 s20, s50, 25600
    s_and_b32 s20, s20, 0xffff
    s_lshl_b32 s20, s20, 5
    buffer_load_dwordx4 v24, s[8:11], s20 offen lds
    s_add_u32 m0, s44, 26624
    s_add_u32 s20, s50, 26624
    s_and_b32 s20, s20, 0xffff
    s_lshl_b32 s20, s20, 5
    buffer_load_dwordx4 v24, s[8:11], s20 offen lds
    s_add_u32 m0, s44, 27648
    s_add_u32 s20, s50, 27648
    s_and_b32 s20, s20, 0xffff
    s_lshl_b32 s20, s20, 5
    buffer_load_dwordx4 v24, s[8:11], s20 offen lds
    s_add_u32 m0, s44, 28672
    s_add_u32 s20, s50, 28672
    s_and_b32 s20, s20, 0xffff
    s_lshl_b32 s20, s20, 5
    buffer_load_dwordx4 v24, s[8:11], s20 offen lds
    s_add_u32 m0, s44, 29696
    s_add_u32 s20, s50, 29696
    s_and_b32 s20, s20, 0xffff
    s_lshl_b32 s20, s20, 5
    buffer_load_dwordx4 v24, s[8:11], s20 offen lds
    s_add_u32 m0, s44, 30720
    s_add_u32 s20, s50, 30720
    s_and_b32 s20, s20, 0xffff
    s_lshl_b32 s20, s20, 5
    buffer_load_dwordx4 v24, s[8:11], s20 offen lds
    s_add_u32 m0, s44, 31744
    s_add_u32 s20, s50, 31744
    s_and_b32 s20, s20, 0xffff
    s_lshl_b32 s20, s20, 5
    buffer_load_dwordx4 v24, s[8:11], s20 offen lds
    v_and_b32 v4, 15, v1
    v_lshrrev_b32 v5, 4, v1
    v_lshrrev_b32 v3, 2, v4
    v_lshlrev_b32 v3, 1, v3
    v_and_b32 v26, 1, v4
    v_add_u32 v3, v3, v26
    v_lshlrev_b32 v6, 8, v3
    v_lshl_add_u32 v6, v5, 4, v6
    s_lshr_b32 s20, s16, 1
    s_lshl_b32 s20, s20, 10
    s_add_u32 s20, s20, 2048
    v_lshlrev_b32 v7, 3, v1
    v_add_u32 v7, s20, v7
    v_lshlrev_b32 v8, 9, v5
    v_lshl_add_u32 v8, v4, 4, v8
    s_lshr_b32 s20, s16, 1
    s_lshl_b32 s20, s20, 12
    s_and_b32 s21, s16, 1
    s_lshl_b32 s21, s21, 8
    s_add_u32 s20, s20, s21
    v_add_u32 v8, s20, v8
    v_lshlrev_b32 v26, 2, v5
    v_sub_u32 v9, v4, v26
    s_lshr_b32 s21, s21, 4
    v_add_u32 v9, s21, v9
    v_add_u32 v10, -16, v9
    v_mov_b32 v11, 0xff7fffff
    v_mov_b32 v20, 0x3f803f80
    v_mov_b32 v21, 0x3f803f80
    v_mov_b32 v22, 0x3f803f80
    v_mov_b32 v23, 0x3f803f80
    v_bfe_u32 v26, v1, 1, 2
    v_min_u32 v26, 2, v26
    s_lshl_b32 s20, s18, 8
    s_add_u32 s20, s20, 71303168
    v_lshlrev_b32 v12, 13, v26
    v_and_b32 v26, 1, v1
    v_lshl_add_u32 v12, v26, 7, v12
    v_add_u32 v12, s20, v12
    v_and_b32 v26, 1, v1
    v_lshlrev_b32 v13, 7, v26
    s_add_u32 s20, s20, 24576
    v_add_u32 v13, s20, v13
    v_and_b32 v26, 7, v1
    s_lshl_b32 s20, s17, 5
    s_lshl_b32 s21, s16, 3
    s_add_u32 s20, s20, s21
    v_add_u32 v26, s20, v26
    v_lshlrev_b32 v14, 7, v26
    v_add_u32 v14, 71335936, v14
    v_bfrev_b32 v26, 1
    s_lshl_b32 s20, s92, 7
    s_add_u32 s20, s20, 71335936
    v_mov_b32 v27, s20
    v_cmp_eq_u32 vcc, 0, v0
    s_lshl_b32 s20, s16, 12
    v_add_u32 v17, s20, v2
    v_cndmask_b32 v15, v26, v27, vcc
    v_lshrrev_b32 v26, 3, v0
    v_and_b32 v27, 1, v0
    v_lshl_add_u32 v27, v27, 5, v26
    v_lshlrev_b32 v16, 4, v27
    v_bfe_u32 v27, v0, 1, 2
    v_lshl_add_u32 v16, v27, 10, v16
    v_lshlrev_b32 v18, 12, v26
    v_and_b32 v27, 7, v0
    v_lshl_add_u32 v18, v27, 3, v18
    s_lshl_b32 s20, s18, 6
    v_add_u32 v18, s20, v18
    s_waitcnt vmcnt(28)
    ds_read_b64_tr_b16 a[0:1], v25 offset:0
    ds_read_b64_tr_b16 a[2:3], v25 offset:256
    ds_read_b64_tr_b16 a[4:5], v25 offset:1024
    ds_read_b64_tr_b16 a[6:7], v25 offset:1280
    ds_read_b64_tr_b16 a[8:9], v25 offset:2048
    ds_read_b64_tr_b16 a[10:11], v25 offset:2304
    ds_read_b64_tr_b16 a[12:13], v25 offset:3072
    ds_read_b64_tr_b16 a[14:15], v25 offset:3328
    s_waitcnt lgkmcnt(0)
    s_add_u32 m0, s44, 0
    s_add_u32 s20, s50, 32768
    s_and_b32 s20, s20, 0xffff
    s_lshl_b32 s20, s20, 5
    buffer_load_dwordx4 v24, s[8:11], s20 offen lds
    s_add_u32 m0, s44, 1024
    s_add_u32 s20, s50, 33792
    s_and_b32 s20, s20, 0xffff
    s_lshl_b32 s20, s20, 5
    buffer_load_dwordx4 v24, s[8:11], s20 offen lds
    s_add_u32 m0, s44, 2048
    s_add_u32 s20, s50, 34816
    s_and_b32 s20, s20, 0xffff
    s_lshl_b32 s20, s20, 5
    buffer_load_dwordx4 v24, s[8:11], s20 offen lds
    s_add_u32 m0, s44, 3072
    s_add_u32 s20, s50, 35840
    s_and_b32 s20, s20, 0xffff
    s_lshl_b32 s20, s20, 5
    buffer_load_dwordx4 v24, s[8:11], s20 offen lds
    s_waitcnt vmcnt(28)
    ds_read_b64_tr_b16 a[16:17], v25 offset:4096
    ds_read_b64_tr_b16 a[18:19], v25 offset:4352
    ds_read_b64_tr_b16 a[20:21], v25 offset:5120
    ds_read_b64_tr_b16 a[22:23], v25 offset:5376
    ds_read_b64_tr_b16 a[24:25], v25 offset:6144
    ds_read_b64_tr_b16 a[26:27], v25 offset:6400
    ds_read_b64_tr_b16 a[28:29], v25 offset:7168
    ds_read_b64_tr_b16 a[30:31], v25 offset:7424
    s_waitcnt lgkmcnt(0)
    s_add_u32 m0, s44, 4096
    s_add_u32 s20, s50, 36864
    s_and_b32 s20, s20, 0xffff
    s_lshl_b32 s20, s20, 5
    buffer_load_dwordx4 v24, s[8:11], s20 offen lds
    s_add_u32 m0, s44, 5120
    s_add_u32 s20, s50, 37888
    s_and_b32 s20, s20, 0xffff
    s_lshl_b32 s20, s20, 5
    buffer_load_dwordx4 v24, s[8:11], s20 offen lds
    s_add_u32 m0, s44, 6144
    s_add_u32 s20, s50, 38912
    s_and_b32 s20, s20, 0xffff
    s_lshl_b32 s20, s20, 5
    buffer_load_dwordx4 v24, s[8:11], s20 offen lds
    s_add_u32 m0, s44, 7168
    s_add_u32 s20, s50, 39936
    s_and_b32 s20, s20, 0xffff
    s_lshl_b32 s20, s20, 5
    buffer_load_dwordx4 v24, s[8:11], s20 offen lds
    s_waitcnt vmcnt(28)
    ds_read_b64_tr_b16 a[32:33], v25 offset:8192
    ds_read_b64_tr_b16 a[34:35], v25 offset:8448
    ds_read_b64_tr_b16 a[36:37], v25 offset:9216
    ds_read_b64_tr_b16 a[38:39], v25 offset:9472
    ds_read_b64_tr_b16 a[40:41], v25 offset:10240
    ds_read_b64_tr_b16 a[42:43], v25 offset:10496
    ds_read_b64_tr_b16 a[44:45], v25 offset:11264
    ds_read_b64_tr_b16 a[46:47], v25 offset:11520
    s_waitcnt lgkmcnt(0)
    s_add_u32 m0, s44, 8192
    s_add_u32 s20, s50, 40960
    s_and_b32 s20, s20, 0xffff
    s_lshl_b32 s20, s20, 5
    buffer_load_dwordx4 v24, s[8:11], s20 offen lds
    s_add_u32 m0, s44, 9216
    s_add_u32 s20, s50, 41984
    s_and_b32 s20, s20, 0xffff
    s_lshl_b32 s20, s20, 5
    buffer_load_dwordx4 v24, s[8:11], s20 offen lds
    s_add_u32 m0, s44, 10240
    s_add_u32 s20, s50, 43008
    s_and_b32 s20, s20, 0xffff
    s_lshl_b32 s20, s20, 5
    buffer_load_dwordx4 v24, s[8:11], s20 offen lds
    s_add_u32 m0, s44, 11264
    s_add_u32 s20, s50, 44032
    s_and_b32 s20, s20, 0xffff
    s_lshl_b32 s20, s20, 5
    buffer_load_dwordx4 v24, s[8:11], s20 offen lds
    s_waitcnt vmcnt(28)
    ds_read_b64_tr_b16 a[48:49], v25 offset:12288
    ds_read_b64_tr_b16 a[50:51], v25 offset:12544
    ds_read_b64_tr_b16 a[52:53], v25 offset:13312
    ds_read_b64_tr_b16 a[54:55], v25 offset:13568
    ds_read_b64_tr_b16 a[56:57], v25 offset:14336
    ds_read_b64_tr_b16 a[58:59], v25 offset:14592
    ds_read_b64_tr_b16 a[60:61], v25 offset:15360
    ds_read_b64_tr_b16 a[62:63], v25 offset:15616
    s_waitcnt lgkmcnt(0)
    s_add_u32 m0, s44, 12288
    s_add_u32 s20, s50, 45056
    s_and_b32 s20, s20, 0xffff
    s_lshl_b32 s20, s20, 5
    buffer_load_dwordx4 v24, s[8:11], s20 offen lds
    s_add_u32 m0, s44, 13312
    s_add_u32 s20, s50, 46080
    s_and_b32 s20, s20, 0xffff
    s_lshl_b32 s20, s20, 5
    buffer_load_dwordx4 v24, s[8:11], s20 offen lds
    s_add_u32 m0, s44, 14336
    s_add_u32 s20, s50, 47104
    s_and_b32 s20, s20, 0xffff
    s_lshl_b32 s20, s20, 5
    buffer_load_dwordx4 v24, s[8:11], s20 offen lds
    s_add_u32 m0, s44, 15360
    s_add_u32 s20, s50, 48128
    s_and_b32 s20, s20, 0xffff
    s_lshl_b32 s20, s20, 5
    buffer_load_dwordx4 v24, s[8:11], s20 offen lds
    s_waitcnt vmcnt(28)
    ds_read_b64_tr_b16 a[64:65], v25 offset:16384
    ds_read_b64_tr_b16 a[66:67], v25 offset:16640
    ds_read_b64_tr_b16 a[68:69], v25 offset:17408
    ds_read_b64_tr_b16 a[70:71], v25 offset:17664
    ds_read_b64_tr_b16 a[72:73], v25 offset:18432
    ds_read_b64_tr_b16 a[74:75], v25 offset:18688
    ds_read_b64_tr_b16 a[76:77], v25 offset:19456
    ds_read_b64_tr_b16 a[78:79], v25 offset:19712
    s_waitcnt lgkmcnt(0)
    s_add_u32 m0, s44, 16384
    s_add_u32 s20, s50, 49152
    s_and_b32 s20, s20, 0xffff
    s_lshl_b32 s20, s20, 5
    buffer_load_dwordx4 v24, s[8:11], s20 offen lds
    s_add_u32 m0, s44, 17408
    s_add_u32 s20, s50, 50176
    s_and_b32 s20, s20, 0xffff
    s_lshl_b32 s20, s20, 5
    buffer_load_dwordx4 v24, s[8:11], s20 offen lds
    s_add_u32 m0, s44, 18432
    s_add_u32 s20, s50, 51200
    s_and_b32 s20, s20, 0xffff
    s_lshl_b32 s20, s20, 5
    buffer_load_dwordx4 v24, s[8:11], s20 offen lds
    s_add_u32 m0, s44, 19456
    s_add_u32 s20, s50, 52224
    s_and_b32 s20, s20, 0xffff
    s_lshl_b32 s20, s20, 5
    buffer_load_dwordx4 v24, s[8:11], s20 offen lds
    s_waitcnt vmcnt(28)
    ds_read_b64_tr_b16 a[80:81], v25 offset:20480
    ds_read_b64_tr_b16 a[82:83], v25 offset:20736
    ds_read_b64_tr_b16 a[84:85], v25 offset:21504
    ds_read_b64_tr_b16 a[86:87], v25 offset:21760
    ds_read_b64_tr_b16 a[88:89], v25 offset:22528
    ds_read_b64_tr_b16 a[90:91], v25 offset:22784
    ds_read_b64_tr_b16 a[92:93], v25 offset:23552
    ds_read_b64_tr_b16 a[94:95], v25 offset:23808
    s_waitcnt lgkmcnt(0)
    s_add_u32 m0, s44, 20480
    s_add_u32 s20, s50, 53248
    s_and_b32 s20, s20, 0xffff
    s_lshl_b32 s20, s20, 5
    buffer_load_dwordx4 v24, s[8:11], s20 offen lds
    s_add_u32 m0, s44, 21504
    s_add_u32 s20, s50, 54272
    s_and_b32 s20, s20, 0xffff
    s_lshl_b32 s20, s20, 5
    buffer_load_dwordx4 v24, s[8:11], s20 offen lds
    s_add_u32 m0, s44, 22528
    s_add_u32 s20, s50, 55296
    s_and_b32 s20, s20, 0xffff
    s_lshl_b32 s20, s20, 5
    buffer_load_dwordx4 v24, s[8:11], s20 offen lds
    s_add_u32 m0, s44, 23552
    s_add_u32 s20, s50, 56320
    s_and_b32 s20, s20, 0xffff
    s_lshl_b32 s20, s20, 5
    buffer_load_dwordx4 v24, s[8:11], s20 offen lds
    s_waitcnt vmcnt(28)
    ds_read_b64_tr_b16 a[96:97], v25 offset:24576
    ds_read_b64_tr_b16 a[98:99], v25 offset:24832
    ds_read_b64_tr_b16 a[100:101], v25 offset:25600
    ds_read_b64_tr_b16 a[102:103], v25 offset:25856
    ds_read_b64_tr_b16 a[104:105], v25 offset:26624
    ds_read_b64_tr_b16 a[106:107], v25 offset:26880
    ds_read_b64_tr_b16 a[108:109], v25 offset:27648
    ds_read_b64_tr_b16 a[110:111], v25 offset:27904
    s_waitcnt lgkmcnt(0)
    s_add_u32 m0, s44, 24576
    s_add_u32 s20, s50, 57344
    s_and_b32 s20, s20, 0xffff
    s_lshl_b32 s20, s20, 5
    buffer_load_dwordx4 v24, s[8:11], s20 offen lds
    s_add_u32 m0, s44, 25600
    s_add_u32 s20, s50, 58368
    s_and_b32 s20, s20, 0xffff
    s_lshl_b32 s20, s20, 5
    buffer_load_dwordx4 v24, s[8:11], s20 offen lds
    s_add_u32 m0, s44, 26624
    s_add_u32 s20, s50, 59392
    s_and_b32 s20, s20, 0xffff
    s_lshl_b32 s20, s20, 5
    buffer_load_dwordx4 v24, s[8:11], s20 offen lds
    s_add_u32 m0, s44, 27648
    s_add_u32 s20, s50, 60416
    s_and_b32 s20, s20, 0xffff
    s_lshl_b32 s20, s20, 5
    buffer_load_dwordx4 v24, s[8:11], s20 offen lds
    s_waitcnt vmcnt(28)
    ds_read_b64_tr_b16 a[112:113], v25 offset:28672
    ds_read_b64_tr_b16 a[114:115], v25 offset:28928
    ds_read_b64_tr_b16 a[116:117], v25 offset:29696
    ds_read_b64_tr_b16 a[118:119], v25 offset:29952
    ds_read_b64_tr_b16 a[120:121], v25 offset:30720
    ds_read_b64_tr_b16 a[122:123], v25 offset:30976
    ds_read_b64_tr_b16 a[124:125], v25 offset:31744
    ds_read_b64_tr_b16 a[126:127], v25 offset:32000
    s_waitcnt lgkmcnt(0)
    s_add_u32 m0, s44, 28672
    s_add_u32 s20, s50, 61440
    s_and_b32 s20, s20, 0xffff
    s_lshl_b32 s20, s20, 5
    buffer_load_dwordx4 v24, s[8:11], s20 offen lds
    s_add_u32 m0, s44, 29696
    s_add_u32 s20, s50, 62464
    s_and_b32 s20, s20, 0xffff
    s_lshl_b32 s20, s20, 5
    buffer_load_dwordx4 v24, s[8:11], s20 offen lds
    s_add_u32 m0, s44, 30720
    s_add_u32 s20, s50, 63488
    s_and_b32 s20, s20, 0xffff
    s_lshl_b32 s20, s20, 5
    buffer_load_dwordx4 v24, s[8:11], s20 offen lds
    s_add_u32 m0, s44, 31744
    s_add_u32 s20, s50, 64512
    s_and_b32 s20, s20, 0xffff
    s_lshl_b32 s20, s20, 5
    buffer_load_dwordx4 v24, s[8:11], s20 offen lds
    s_waitcnt vmcnt(28)
    ds_read_b64_tr_b16 a[128:129], v25 offset:0
    ds_read_b64_tr_b16 a[130:131], v25 offset:256
    ds_read_b64_tr_b16 a[132:133], v25 offset:1024
    ds_read_b64_tr_b16 a[134:135], v25 offset:1280
    ds_read_b64_tr_b16 a[136:137], v25 offset:2048
    ds_read_b64_tr_b16 a[138:139], v25 offset:2304
    ds_read_b64_tr_b16 a[140:141], v25 offset:3072
    ds_read_b64_tr_b16 a[142:143], v25 offset:3328
    s_waitcnt lgkmcnt(0)
    s_waitcnt vmcnt(24)
    ds_read_b64_tr_b16 a[144:145], v25 offset:4096
    ds_read_b64_tr_b16 a[146:147], v25 offset:4352
    ds_read_b64_tr_b16 a[148:149], v25 offset:5120
    ds_read_b64_tr_b16 a[150:151], v25 offset:5376
    ds_read_b64_tr_b16 a[152:153], v25 offset:6144
    ds_read_b64_tr_b16 a[154:155], v25 offset:6400
    ds_read_b64_tr_b16 a[156:157], v25 offset:7168
    ds_read_b64_tr_b16 a[158:159], v25 offset:7424
    s_waitcnt lgkmcnt(0)
    s_waitcnt vmcnt(20)
    ds_read_b64_tr_b16 a[160:161], v25 offset:8192
    ds_read_b64_tr_b16 a[162:163], v25 offset:8448
    ds_read_b64_tr_b16 a[164:165], v25 offset:9216
    ds_read_b64_tr_b16 a[166:167], v25 offset:9472
    ds_read_b64_tr_b16 a[168:169], v25 offset:10240
    ds_read_b64_tr_b16 a[170:171], v25 offset:10496
    ds_read_b64_tr_b16 a[172:173], v25 offset:11264
    ds_read_b64_tr_b16 a[174:175], v25 offset:11520
    s_waitcnt lgkmcnt(0)
    s_waitcnt vmcnt(16)
    ds_read_b64_tr_b16 a[176:177], v25 offset:12288
    ds_read_b64_tr_b16 a[178:179], v25 offset:12544
    ds_read_b64_tr_b16 a[180:181], v25 offset:13312
    ds_read_b64_tr_b16 a[182:183], v25 offset:13568
    ds_read_b64_tr_b16 a[184:185], v25 offset:14336
    ds_read_b64_tr_b16 a[186:187], v25 offset:14592
    ds_read_b64_tr_b16 a[188:189], v25 offset:15360
    ds_read_b64_tr_b16 a[190:191], v25 offset:15616
    s_waitcnt lgkmcnt(0)
    s_waitcnt vmcnt(12)
    ds_read_b64_tr_b16 a[192:193], v25 offset:16384
    ds_read_b64_tr_b16 a[194:195], v25 offset:16640
    ds_read_b64_tr_b16 a[196:197], v25 offset:17408
    ds_read_b64_tr_b16 a[198:199], v25 offset:17664
    ds_read_b64_tr_b16 a[200:201], v25 offset:18432
    ds_read_b64_tr_b16 a[202:203], v25 offset:18688
    ds_read_b64_tr_b16 a[204:205], v25 offset:19456
    ds_read_b64_tr_b16 a[206:207], v25 offset:19712
    s_waitcnt lgkmcnt(0)
    s_waitcnt vmcnt(8)
    ds_read_b64_tr_b16 a[208:209], v25 offset:20480
    ds_read_b64_tr_b16 a[210:211], v25 offset:20736
    ds_read_b64_tr_b16 a[212:213], v25 offset:21504
    ds_read_b64_tr_b16 a[214:215], v25 offset:21760
    ds_read_b64_tr_b16 a[216:217], v25 offset:22528
    ds_read_b64_tr_b16 a[218:219], v25 offset:22784
    ds_read_b64_tr_b16 a[220:221], v25 offset:23552
    ds_read_b64_tr_b16 a[222:223], v25 offset:23808
    s_waitcnt lgkmcnt(0)
    s_waitcnt vmcnt(4)
    ds_read_b64_tr_b16 a[224:225], v25 offset:24576
    ds_read_b64_tr_b16 a[226:227], v25 offset:24832
    ds_read_b64_tr_b16 a[228:229], v25 offset:25600
    ds_read_b64_tr_b16 a[230:231], v25 offset:25856
    ds_read_b64_tr_b16 a[232:233], v25 offset:26624
    ds_read_b64_tr_b16 a[234:235], v25 offset:26880
    ds_read_b64_tr_b16 a[236:237], v25 offset:27648
    ds_read_b64_tr_b16 a[238:239], v25 offset:27904
    s_waitcnt lgkmcnt(0)
    s_waitcnt vmcnt(0)
    ds_read_b64_tr_b16 a[240:241], v25 offset:28672
    ds_read_b64_tr_b16 a[242:243], v25 offset:28928
    ds_read_b64_tr_b16 a[244:245], v25 offset:29696
    ds_read_b64_tr_b16 a[246:247], v25 offset:29952
    ds_read_b64_tr_b16 a[248:249], v25 offset:30720
    ds_read_b64_tr_b16 a[250:251], v25 offset:30976
    ds_read_b64_tr_b16 a[252:253], v25 offset:31744
    ds_read_b64_tr_b16 a[254:255], v25 offset:32000
    s_waitcnt lgkmcnt(0)
    s_barrier
    s_add_u32 s22, s17, 16
    s_sub_u32 s20, s17, 4
    s_cmp_ge_u32 s17, 4
    s_cselect_b32 s22, s20, s22
mega_kernel_x_gp:
    buffer_load_dword v3, v12, s[84:87], 0 offen sc1
    s_waitcnt vmcnt(0)
    v_cmp_ne_u32 vcc, 32, v3
    s_cbranch_vccz mega_kernel_x_gk
    s_sleep 8
    s_branch mega_kernel_x_gp
mega_kernel_x_gk:
    s_mov_b32 s46, 0
    s_lshl_b32 s27, s22, 18
    s_lshl_b32 s20, s18, 13
    s_add_u32 s27, s27, s20
    s_add_u32 s29, s27, 178257920
    s_and_b32 s20, s16, 1
    s_lshl_b32 s20, s20, 10
    s_add_u32 s26, s27, s20
    s_lshr_b32 s20, s16, 1
    s_lshl_b32 s20, s20, 12
    s_add_u32 s28, s27, s20
    s_add_u32 s28, s28, 33554432
    s_add_u32 s27, s27, 16777216
    s_add_u32 s48, s26, 4096
    s_add_u32 s49, s27, 4096
mega_kernel_x_ldq:
    buffer_load_dwordx4 v[24:27], v2, s[84:87], s26 offen offset:0
    buffer_load_dwordx4 v[28:31], v2, s[84:87], s26 offen offset:2048
    buffer_load_dwordx4 v[32:35], v2, s[84:87], s48 offen offset:0
    buffer_load_dwordx4 v[36:39], v2, s[84:87], s48 offen offset:2048
    buffer_load_dwordx4 v[40:43], v2, s[84:87], s27 offen offset:0
    buffer_load_dwordx4 v[44:47], v2, s[84:87], s27 offen offset:1024
    buffer_load_dwordx4 v[48:51], v2, s[84:87], s27 offen offset:2048
    buffer_load_dwordx4 v[52:55], v2, s[84:87], s27 offen offset:3072
    buffer_load_dwordx4 v[56:59], v2, s[84:87], s49 offen offset:0
    buffer_load_dwordx4 v[60:63], v2, s[84:87], s49 offen offset:1024
    buffer_load_dwordx4 v[64:67], v2, s[84:87], s49 offen offset:2048
    buffer_load_dwordx4 v[68:71], v2, s[84:87], s49 offen offset:3072
    buffer_load_dwordx4 v[72:75], v2, s[84:87], s28 offen offset:0
    buffer_load_dwordx4 v[76:79], v2, s[84:87], s28 offen offset:1024
    buffer_load_dwordx4 v[80:83], v2, s[84:87], s28 offen offset:2048
    buffer_load_dwordx4 v[84:87], v2, s[84:87], s28 offen offset:3072
mega_kernel_x_att:
    s_waitcnt vmcnt(0)
    v_mfma_f32_16x16x32_bf16 v[112:115], v[40:43], v[24:27], 0
    v_mfma_f32_16x16x32_bf16 v[116:119], v[44:47], v[24:27], 0
    v_mfma_f32_16x16x32_bf16 v[112:115], v[48:51], v[28:31], v[112:115]
    v_mfma_f32_16x16x32_bf16 v[116:119], v[52:55], v[28:31], v[116:119]
    v_mfma_f32_16x16x32_bf16 v[112:115], v[56:59], v[32:35], v[112:115]
    v_mfma_f32_16x16x32_bf16 v[116:119], v[60:63], v[32:35], v[116:119]
    v_mfma_f32_16x16x32_bf16 v[112:115], v[64:67], v[36:39], v[112:115]
    v_mfma_f32_16x16x32_bf16 v[116:119], v[68:71], v[36:39], v[116:119]
    s_lshl_b32 s41, s47, 18
    s_add_u32 s41, s41, 50331648
    s_lshl_b32 s20, s18, 13
    s_add_u32 s40, s41, s20
    s_lshl_b32 s20, s16, 16
    s_add_u32 s41, s41, s20
    s_lshl_b32 s42, s22, 17
    v_mov_b32 v130, v20
    v_mov_b32 v131, 0
    v_cmp_gt_i32 vcc, 0, v9
    s_nop 1
    v_cndmask_b32 v112, v112, v11, vcc
    v_cmp_gt_i32 vcc, 1, v9
    s_nop 1
    v_cndmask_b32 v113, v113, v11, vcc
    v_cmp_gt_i32 vcc, 2, v9
    s_nop 1
    v_cndmask_b32 v114, v114, v11, vcc
    v_cmp_gt_i32 vcc, 3, v9
    s_nop 1
    v_cndmask_b32 v115, v115, v11, vcc
    v_cmp_gt_i32 vcc, 0, v10
    s_nop 1
    v_cndmask_b32 v116, v116, v11, vcc
    v_cmp_gt_i32 vcc, 1, v10
    s_nop 1
    v_cndmask_b32 v117, v117, v11, vcc
    v_cmp_gt_i32 vcc, 2, v10
    s_nop 1
    v_cndmask_b32 v118, v118, v11, vcc
    v_cmp_gt_i32 vcc, 3, v10
    s_nop 1
    v_cndmask_b32 v119, v119, v11, vcc
    s_cmp_eq_u32 s46, 1
    s_cbranch_scc1 mega_kernel_x_rd
mega_kernel_x_rp:
    buffer_load_dword v3, v13, s[84:87], 0 offen sc1
    s_waitcnt vmcnt(0)
    v_cmp_ge_u32 vcc, s22, v3
    s_cbranch_vccz mega_kernel_x_rk
    s_sleep 2
    s_branch mega_kernel_x_rp
mega_kernel_x_rk:
    buffer_load_dwordx4 v[88:91], v6, s[84:87], s29 offen offset:0 sc1
    buffer_load_dwordx4 v[92:95], v6, s[84:87], s29 offen offset:64 sc1
    buffer_load_dwordx4 v[96:99], v6, s[84:87], s29 offen offset:128 sc1
    buffer_load_dwordx4 v[100:103], v6, s[84:87], s29 offen offset:192 sc1
    buffer_load_dwordx2 v[104:105], v7, s[84:87], s29 offen offset:0 sc1
    buffer_load_dwordx2 v[106:107], v7, s[84:87], s29 offen offset:2048 sc1
    buffer_load_dwordx2 v[108:109], v7, s[84:87], s29 offen offset:512 sc1
    buffer_load_dwordx2 v[110:111], v7, s[84:87], s29 offen offset:2560 sc1
mega_kernel_x_rd:
    s_waitcnt vmcnt(7)
    v_mfma_f32_16x16x32_bf16 v[120:123], v[88:91], v[24:27], 0
    s_waitcnt vmcnt(6)
    v_mfma_f32_16x16x32_bf16 v[120:123], v[92:95], v[28:31], v[120:123]
    s_waitcnt vmcnt(5)
    v_mfma_f32_16x16x32_bf16 v[120:123], v[96:99], v[32:35], v[120:123]
    s_waitcnt vmcnt(4)
    v_mfma_f32_16x16x32_bf16 v[120:123], v[100:103], v[36:39], v[120:123]
    v_max3_f32 v4, v112, v113, v114
    v_max3_f32 v4, v4, v115, v116
    v_max3_f32 v4, v4, v117, v118
    s_waitcnt vmcnt(0)
    v_swap_b32 v105, v106
    v_swap_b32 v109, v110
    s_nop 1
    v_max3_f32 v4, v4, v119, v120
    v_max_f32 v3, v4, v121
    v_max_f32 v4, v4, v121
    s_nop 1
    v_permlane16_swap_b32 v4, v3
    v_max_f32 v4, v4, v3
    v_max_f32 v3, v4, v3
    s_nop 1
    v_permlane32_swap_b32 v4, v3
    v_max_f32 v4, v4, v3
    v_mul_f32 v4, s24, v4
    v_fma_f32 v112, v112, s24, -v4
    v_fma_f32 v113, v113, s24, -v4
    v_fma_f32 v114, v114, s24, -v4
    v_fma_f32 v115, v115, s24, -v4
    v_fma_f32 v116, v116, s24, -v4
    v_fma_f32 v117, v117, s24, -v4
    v_fma_f32 v118, v118, s24, -v4
    v_fma_f32 v119, v119, s24, -v4
    v_fma_f32 v120, v120, s24, -v4
    v_fma_f32 v121, v121, s24, -v4
    v_exp_f32 v112, v112
    v_exp_f32 v113, v113
    v_exp_f32 v114, v114
    v_exp_f32 v115, v115
    v_exp_f32 v116, v116
    v_exp_f32 v117, v117
    v_exp_f32 v118, v118
    v_exp_f32 v119, v119
    v_exp_f32 v120, v120
    v_exp_f32 v121, v121
    s_nop 0
    v_cvt_pk_bf16_f32 v124, v112, v113
    v_cvt_pk_bf16_f32 v125, v114, v115
    v_cvt_pk_bf16_f32 v126, v116, v117
    v_cvt_pk_bf16_f32 v127, v118, v119
    v_cvt_pk_bf16_f32 v128, v120, v121
    v_mov_b32 v129, v128
    s_nop 1
    v_mfma_f32_16x16x32_bf16 v[132:135], v[20:23], v[124:127], 0
    v_mfma_f32_16x16x32_bf16 v[88:91], v[72:75], v[124:127], 0
    v_mfma_f32_16x16x32_bf16 v[92:95], v[76:79], v[124:127], 0
    v_mfma_f32_16x16x32_bf16 v[96:99], v[80:83], v[124:127], 0
    v_mfma_f32_16x16x32_bf16 v[100:103], v[84:87], v[124:127], 0
    s_nop 1
    v_mfma_f32_16x16x16_bf16 v[132:135], v[130:131], v[128:129], v[132:135]
    v_mfma_f32_16x16x16_bf16 v[88:91], v[104:105], v[128:129], v[88:91]
    v_mfma_f32_16x16x16_bf16 v[92:95], v[106:107], v[128:129], v[92:95]
    v_mfma_f32_16x16x16_bf16 v[96:99], v[108:109], v[128:129], v[96:99]
    v_mfma_f32_16x16x16_bf16 v[100:103], v[110:111], v[128:129], v[100:103]
    s_nop 3
    v_rcp_f32 v132, v132
    s_nop 2
    v_pk_mul_f32 v[88:89], v[88:89], v[132:133] op_sel_hi:[1,0]
    v_pk_mul_f32 v[90:91], v[90:91], v[132:133] op_sel_hi:[1,0]
    v_pk_mul_f32 v[92:93], v[92:93], v[132:133] op_sel_hi:[1,0]
    v_pk_mul_f32 v[94:95], v[94:95], v[132:133] op_sel_hi:[1,0]
    v_pk_mul_f32 v[96:97], v[96:97], v[132:133] op_sel_hi:[1,0]
    v_pk_mul_f32 v[98:99], v[98:99], v[132:133] op_sel_hi:[1,0]
    v_pk_mul_f32 v[100:101], v[100:101], v[132:133] op_sel_hi:[1,0]
    v_pk_mul_f32 v[102:103], v[102:103], v[132:133] op_sel_hi:[1,0]
    v_cvt_pk_bf16_f32 v112, v88, v89
    v_cvt_pk_bf16_f32 v113, v90, v91
    v_cvt_pk_bf16_f32 v114, v92, v93
    v_cvt_pk_bf16_f32 v115, v94, v95
    v_cvt_pk_bf16_f32 v116, v96, v97
    v_cvt_pk_bf16_f32 v117, v98, v99
    v_cvt_pk_bf16_f32 v118, v100, v101
    v_cvt_pk_bf16_f32 v119, v102, v103
    s_add_u32 s43, s22, 1
    v_mov_b32 v4, s43
    s_cmp_eq_u32 s96, 1
    s_cbranch_scc1 mega_kernel_x_of
    buffer_store_dwordx4 v[112:115], v8, s[84:87], s40 offen sc1
    buffer_store_dwordx4 v[116:119], v8, s[84:87], s40 offen offset:2048 sc1
    s_waitcnt vmcnt(0)
    s_barrier
    buffer_store_dword v4, v15, s[84:87], 0 offen sc1
    s_branch mega_kernel_x_od
mega_kernel_x_of:
    buffer_store_dwordx4 v[112:115], v8, s[84:87], s40 offen
    buffer_store_dwordx4 v[116:119], v8, s[84:87], s40 offen offset:2048
    s_waitcnt vmcnt(0)
    s_barrier
    buffer_store_dword v4, v15, s[84:87], 0 offen
mega_kernel_x_od:
    s_mov_b32 s45, s22
    s_add_u32 s20, s47, 1
    s_and_b32 s20, s20, 3
    s_andn2_b32 s47, s47, 3
    s_or_b32 s47, s47, s20
    s_add_u32 s20, s22, 2
    s_add_u32 s21, s17, 16
    s_cmp_lt_u32 s20, 16
    s_cselect_b32 s20, s20, s21
    s_add_u32 s21, s22, 6
    s_cmp_lt_u32 s22, 16
    s_cselect_b32 s22, s20, s21
    s_lshl_b32 s27, s22, 18
    s_lshl_b32 s20, s18, 13
    s_add_u32 s27, s27, s20
    s_add_u32 s29, s27, 178257920
    s_and_b32 s20, s16, 1
    s_lshl_b32 s20, s20, 10
    s_add_u32 s26, s27, s20
    s_lshr_b32 s20, s16, 1
    s_lshl_b32 s20, s20, 12
    s_add_u32 s28, s27, s20
    s_add_u32 s28, s28, 33554432
    s_add_u32 s27, s27, 16777216
    s_add_u32 s48, s26, 4096
    s_add_u32 s49, s27, 4096
mega_kernel_x_xp:
    buffer_load_dword v3, v14, s[84:87], 0 offen sc1
    s_waitcnt vmcnt(0)
    v_cmp_ge_u32 vcc, s45, v3
    s_cbranch_vccnz mega_kernel_x_xp
    s_add_u32 s20, s50, 0
    s_and_b32 s20, s20, 0xffff
    s_add_u32 s20, s20, s41
    buffer_load_dwordx4 v[136:139], v2, s[84:87], s20 offen offset:0 sc1
    buffer_load_dwordx4 v[140:143], v2, s[84:87], s20 offen offset:1024 sc1
    buffer_load_dwordx4 v[144:147], v2, s[84:87], s20 offen offset:2048 sc1
    buffer_load_dwordx4 v[148:151], v2, s[84:87], s20 offen offset:3072 sc1
    s_add_u32 s20, s50, 4096
    s_and_b32 s20, s20, 0xffff
    s_add_u32 s20, s20, s41
    buffer_load_dwordx4 v[152:155], v2, s[84:87], s20 offen offset:0 sc1
    buffer_load_dwordx4 v[156:159], v2, s[84:87], s20 offen offset:1024 sc1
    buffer_load_dwordx4 v[160:163], v2, s[84:87], s20 offen offset:2048 sc1
    buffer_load_dwordx4 v[164:167], v2, s[84:87], s20 offen offset:3072 sc1
    s_add_u32 s20, s50, 8192
    s_and_b32 s20, s20, 0xffff
    s_add_u32 s20, s20, s41
    buffer_load_dwordx4 v[168:171], v2, s[84:87], s20 offen offset:0 sc1
    buffer_load_dwordx4 v[172:175], v2, s[84:87], s20 offen offset:1024 sc1
    buffer_load_dwordx4 v[176:179], v2, s[84:87], s20 offen offset:2048 sc1
    buffer_load_dwordx4 v[180:183], v2, s[84:87], s20 offen offset:3072 sc1
    s_add_u32 s20, s50, 12288
    s_and_b32 s20, s20, 0xffff
    s_add_u32 s20, s20, s41
    buffer_load_dwordx4 v[184:187], v2, s[84:87], s20 offen offset:0 sc1
    buffer_load_dwordx4 v[188:191], v2, s[84:87], s20 offen offset:1024 sc1
    buffer_load_dwordx4 v[192:195], v2, s[84:87], s20 offen offset:2048 sc1
    buffer_load_dwordx4 v[196:199], v2, s[84:87], s20 offen offset:3072 sc1
    s_add_u32 s20, s50, 16384
    s_and_b32 s20, s20, 0xffff
    s_add_u32 s20, s20, s41
    buffer_load_dwordx4 v[200:203], v2, s[84:87], s20 offen offset:0 sc1
    buffer_load_dwordx4 v[204:207], v2, s[84:87], s20 offen offset:1024 sc1
    buffer_load_dwordx4 v[208:211], v2, s[84:87], s20 offen offset:2048 sc1
    buffer_load_dwordx4 v[212:215], v2, s[84:87], s20 offen offset:3072 sc1
    s_add_u32 s20, s50, 20480
    s_and_b32 s20, s20, 0xffff
    s_add_u32 s20, s20, s41
    buffer_load_dwordx4 v[216:219], v2, s[84:87], s20 offen offset:0 sc1
    buffer_load_dwordx4 v[220:223], v2, s[84:87], s20 offen offset:1024 sc1
    buffer_load_dwordx4 v[224:227], v2, s[84:87], s20 offen offset:2048 sc1
    buffer_load_dwordx4 v[228:231], v2, s[84:87], s20 offen offset:3072 sc1
    s_add_u32 s20, s50, 24576
    s_and_b32 s20, s20, 0xffff
    s_add_u32 s20, s20, s41
    buffer_load_dwordx4 v[232:235], v2, s[84:87], s20 offen offset:0 sc1
    buffer_load_dwordx4 v[236:239], v2, s[84:87], s20 offen offset:1024 sc1
    buffer_load_dwordx4 v[240:243], v2, s[84:87], s20 offen offset:2048 sc1
    buffer_load_dwordx4 v[244:247], v2, s[84:87], s20 offen offset:3072 sc1
    buffer_load_dword v5, v13, s[84:87], 0 offen sc1
    s_waitcnt vmcnt(28)
    v_mfma_f32_32x32x16_bf16 v[112:127], a[0:3], v[136:139], 0
    s_add_u32 s20, s50, 28672
    s_and_b32 s20, s20, 0xffff
    s_add_u32 s20, s20, s41
    buffer_load_dwordx4 v[248:251], v2, s[84:87], s20 offen offset:0 sc1
    s_waitcnt vmcnt(28)
    v_mfma_f32_32x32x16_bf16 v[112:127], a[4:7], v[140:143], v[112:127]
    buffer_load_dwordx4 v[252:255], v2, s[84:87], s20 offen offset:1024 sc1
    s_waitcnt vmcnt(28)
    v_mfma_f32_32x32x16_bf16 v[112:127], a[8:11], v[144:147], v[112:127]
    buffer_load_dwordx4 v[136:139], v2, s[84:87], s20 offen offset:2048 sc1
    s_waitcnt vmcnt(28)
    v_mfma_f32_32x32x16_bf16 v[112:127], a[12:15], v[148:151], v[112:127]
    buffer_load_dwordx4 v[140:143], v2, s[84:87], s20 offen offset:3072 sc1
    s_waitcnt vmcnt(28)
    v_mfma_f32_32x32x16_bf16 v[112:127], a[16:19], v[152:155], v[112:127]
    s_add_u32 s20, s50, 32768
    s_and_b32 s20, s20, 0xffff
    s_add_u32 s20, s20, s41
    buffer_load_dwordx4 v[144:147], v2, s[84:87], s20 offen offset:0 sc1
    s_waitcnt vmcnt(28)
    v_mfma_f32_32x32x16_bf16 v[112:127], a[20:23], v[156:159], v[112:127]
    buffer_load_dwordx4 v[148:151], v2, s[84:87], s20 offen offset:1024 sc1
    s_waitcnt vmcnt(28)
    v_mfma_f32_32x32x16_bf16 v[112:127], a[24:27], v[160:163], v[112:127]
    buffer_load_dwordx4 v[152:155], v2, s[84:87], s20 offen offset:2048 sc1
    s_waitcnt vmcnt(28)
    v_mfma_f32_32x32x16_bf16 v[112:127], a[28:31], v[164:167], v[112:127]
    buffer_load_dwordx4 v[156:159], v2, s[84:87], s20 offen offset:3072 sc1
    s_waitcnt vmcnt(28)
    v_mfma_f32_32x32x16_bf16 v[112:127], a[32:35], v[168:171], v[112:127]
    s_add_u32 s20, s50, 36864
    s_and_b32 s20, s20, 0xffff
    s_add_u32 s20, s20, s41
    buffer_load_dwordx4 v[160:163], v2, s[84:87], s20 offen offset:0 sc1
    s_waitcnt vmcnt(28)
    v_mfma_f32_32x32x16_bf16 v[112:127], a[36:39], v[172:175], v[112:127]
    buffer_load_dwordx4 v[164:167], v2, s[84:87], s20 offen offset:1024 sc1
    s_waitcnt vmcnt(28)
    v_mfma_f32_32x32x16_bf16 v[112:127], a[40:43], v[176:179], v[112:127]
    buffer_load_dwordx4 v[168:171], v2, s[84:87], s20 offen offset:2048 sc1
    s_waitcnt vmcnt(28)
    v_mfma_f32_32x32x16_bf16 v[112:127], a[44:47], v[180:183], v[112:127]
    buffer_load_dwordx4 v[172:175], v2, s[84:87], s20 offen offset:3072 sc1
    s_waitcnt vmcnt(28)
    v_mfma_f32_32x32x16_bf16 v[112:127], a[48:51], v[184:187], v[112:127]
    s_add_u32 s20, s50, 40960
    s_and_b32 s20, s20, 0xffff
    s_add_u32 s20, s20, s41
    buffer_load_dwordx4 v[176:179], v2, s[84:87], s20 offen offset:0 sc1
    s_waitcnt vmcnt(28)
    v_mfma_f32_32x32x16_bf16 v[112:127], a[52:55], v[188:191], v[112:127]
    buffer_load_dwordx4 v[180:183], v2, s[84:87], s20 offen offset:1024 sc1
    s_waitcnt vmcnt(28)
    v_mfma_f32_32x32x16_bf16 v[112:127], a[56:59], v[192:195], v[112:127]
    buffer_load_dwordx4 v[184:187], v2, s[84:87], s20 offen offset:2048 sc1
    s_waitcnt vmcnt(28)
    v_mfma_f32_32x32x16_bf16 v[112:127], a[60:63], v[196:199], v[112:127]
    buffer_load_dwordx4 v[188:191], v2, s[84:87], s20 offen offset:3072 sc1
    s_waitcnt vmcnt(28)
    v_mfma_f32_32x32x16_bf16 v[112:127], a[64:67], v[200:203], v[112:127]
    s_add_u32 s20, s50, 45056
    s_and_b32 s20, s20, 0xffff
    s_add_u32 s20, s20, s41
    buffer_load_dwordx4 v[192:195], v2, s[84:87], s20 offen offset:0 sc1
    s_waitcnt vmcnt(28)
    v_mfma_f32_32x32x16_bf16 v[112:127], a[68:71], v[204:207], v[112:127]
    buffer_load_dwordx4 v[196:199], v2, s[84:87], s20 offen offset:1024 sc1
    s_waitcnt vmcnt(28)
    v_mfma_f32_32x32x16_bf16 v[112:127], a[72:75], v[208:211], v[112:127]
    buffer_load_dwordx4 v[200:203], v2, s[84:87], s20 offen offset:2048 sc1
    s_waitcnt vmcnt(28)
    v_mfma_f32_32x32x16_bf16 v[112:127], a[76:79], v[212:215], v[112:127]
    buffer_load_dwordx4 v[204:207], v2, s[84:87], s20 offen offset:3072 sc1
    s_waitcnt vmcnt(28)
    v_mfma_f32_32x32x16_bf16 v[112:127], a[80:83], v[216:219], v[112:127]
    s_add_u32 s20, s50, 49152
    s_and_b32 s20, s20, 0xffff
    s_add_u32 s20, s20, s41
    buffer_load_dwordx4 v[208:211], v2, s[84:87], s20 offen offset:0 sc1
    s_waitcnt vmcnt(28)
    v_mfma_f32_32x32x16_bf16 v[112:127], a[84:87], v[220:223], v[112:127]
    buffer_load_dwordx4 v[212:215], v2, s[84:87], s20 offen offset:1024 sc1
    s_waitcnt vmcnt(28)
    v_mfma_f32_32x32x16_bf16 v[112:127], a[88:91], v[224:227], v[112:127]
    buffer_load_dwordx4 v[216:219], v2, s[84:87], s20 offen offset:2048 sc1
    s_waitcnt vmcnt(28)
    v_mfma_f32_32x32x16_bf16 v[112:127], a[92:95], v[228:231], v[112:127]
    buffer_load_dwordx4 v[220:223], v2, s[84:87], s20 offen offset:3072 sc1
    s_waitcnt vmcnt(28)
    v_mfma_f32_32x32x16_bf16 v[112:127], a[96:99], v[232:235], v[112:127]
    s_add_u32 s20, s50, 53248
    s_and_b32 s20, s20, 0xffff
    s_add_u32 s20, s20, s41
    buffer_load_dwordx4 v[224:227], v2, s[84:87], s20 offen offset:0 sc1
    s_waitcnt vmcnt(28)
    v_mfma_f32_32x32x16_bf16 v[112:127], a[100:103], v[236:239], v[112:127]
    buffer_load_dwordx4 v[228:231], v2, s[84:87], s20 offen offset:1024 sc1
    s_waitcnt vmcnt(28)
    v_mfma_f32_32x32x16_bf16 v[112:127], a[104:107], v[240:243], v[112:127]
    buffer_load_dwordx4 v[232:235], v2, s[84:87], s20 offen offset:2048 sc1
    s_waitcnt vmcnt(28)
    v_mfma_f32_32x32x16_bf16 v[112:127], a[108:111], v[244:247], v[112:127]
    buffer_load_dwordx4 v[236:239], v2, s[84:87], s20 offen offset:3072 sc1
    s_waitcnt vmcnt(27)
    v_mfma_f32_32x32x16_bf16 v[112:127], a[112:115], v[248:251], v[112:127]
    s_add_u32 s20, s50, 57344
    s_and_b32 s20, s20, 0xffff
    s_add_u32 s20, s20, s41
    buffer_load_dwordx4 v[240:243], v2, s[84:87], s20 offen offset:0 sc1
    v_cmp_ge_u32 vcc, s22, v5
    s_waitcnt vmcnt(27)
    v_mfma_f32_32x32x16_bf16 v[112:127], a[116:119], v[252:255], v[112:127]
    buffer_load_dwordx4 v[244:247], v2, s[84:87], s20 offen offset:1024 sc1
    s_cmp_eq_u64 vcc, 0
    s_cselect_b32 s46, 1, 0
    s_waitcnt vmcnt(27)
    v_mfma_f32_32x32x16_bf16 v[112:127], a[120:123], v[136:139], v[112:127]
    buffer_load_dwordx4 v[248:251], v2, s[84:87], s20 offen offset:2048 sc1
    s_waitcnt vmcnt(27)
    v_mfma_f32_32x32x16_bf16 v[112:127], a[124:127], v[140:143], v[112:127]
    buffer_load_dwordx4 v[252:255], v2, s[84:87], s20 offen offset:3072 sc1
    s_waitcnt vmcnt(27)
    v_mfma_f32_32x32x16_bf16 v[112:127], a[128:131], v[144:147], v[112:127]
    s_add_u32 s20, s50, 61440
    s_and_b32 s20, s20, 0xffff
    s_add_u32 s20, s20, s41
    buffer_load_dwordx4 v[136:139], v2, s[84:87], s20 offen offset:0 sc1
    s_waitcnt vmcnt(27)
    v_mfma_f32_32x32x16_bf16 v[112:127], a[132:135], v[148:151], v[112:127]
    buffer_load_dwordx4 v[140:143], v2, s[84:87], s20 offen offset:1024 sc1
    s_waitcnt vmcnt(27)
    v_mfma_f32_32x32x16_bf16 v[112:127], a[136:139], v[152:155], v[112:127]
    buffer_load_dwordx4 v[144:147], v2, s[84:87], s20 offen offset:2048 sc1
    s_waitcnt vmcnt(27)
    v_mfma_f32_32x32x16_bf16 v[112:127], a[140:143], v[156:159], v[112:127]
    buffer_load_dwordx4 v[148:151], v2, s[84:87], s20 offen offset:3072 sc1
    s_cmp_eq_u32 s46, 1
    s_cbranch_scc1 mega_kernel_x_pfx
    s_waitcnt vmcnt(27)
    v_mfma_f32_32x32x16_bf16 v[112:127], a[144:147], v[160:163], v[112:127]
    s_waitcnt vmcnt(26)
    v_mfma_f32_32x32x16_bf16 v[112:127], a[148:151], v[164:167], v[112:127]
    s_waitcnt vmcnt(25)
    v_mfma_f32_32x32x16_bf16 v[112:127], a[152:155], v[168:171], v[112:127]
    s_waitcnt vmcnt(24)
    v_mfma_f32_32x32x16_bf16 v[112:127], a[156:159], v[172:175], v[112:127]
    s_waitcnt vmcnt(23)
    v_mfma_f32_32x32x16_bf16 v[112:127], a[160:163], v[176:179], v[112:127]
    s_waitcnt vmcnt(22)
    v_mfma_f32_32x32x16_bf16 v[112:127], a[164:167], v[180:183], v[112:127]
    s_waitcnt vmcnt(21)
    v_mfma_f32_32x32x16_bf16 v[112:127], a[168:171], v[184:187], v[112:127]
    s_waitcnt vmcnt(20)
    v_mfma_f32_32x32x16_bf16 v[112:127], a[172:175], v[188:191], v[112:127]
    s_waitcnt vmcnt(19)
    v_mfma_f32_32x32x16_bf16 v[112:127], a[176:179], v[192:195], v[112:127]
    s_waitcnt vmcnt(18)
    v_mfma_f32_32x32x16_bf16 v[112:127], a[180:183], v[196:199], v[112:127]
    s_waitcnt vmcnt(17)
    v_mfma_f32_32x32x16_bf16 v[112:127], a[184:187], v[200:203], v[112:127]
    s_waitcnt vmcnt(16)
    v_mfma_f32_32x32x16_bf16 v[112:127], a[188:191], v[204:207], v[112:127]
    s_waitcnt vmcnt(15)
    v_mfma_f32_32x32x16_bf16 v[112:127], a[192:195], v[208:211], v[112:127]
    s_waitcnt vmcnt(14)
    v_mfma_f32_32x32x16_bf16 v[112:127], a[196:199], v[212:215], v[112:127]
    s_waitcnt vmcnt(13)
    v_mfma_f32_32x32x16_bf16 v[112:127], a[200:203], v[216:219], v[112:127]
    s_waitcnt vmcnt(12)
    v_mfma_f32_32x32x16_bf16 v[112:127], a[204:207], v[220:223], v[112:127]
    s_waitcnt vmcnt(11)
    v_mfma_f32_32x32x16_bf16 v[112:127], a[208:211], v[224:227], v[112:127]
    s_waitcnt vmcnt(10)
    v_mfma_f32_32x32x16_bf16 v[112:127], a[212:215], v[228:231], v[112:127]
    s_waitcnt vmcnt(9)
    v_mfma_f32_32x32x16_bf16 v[112:127], a[216:219], v[232:235], v[112:127]
    s_waitcnt vmcnt(8)
    v_mfma_f32_32x32x16_bf16 v[112:127], a[220:223], v[236:239], v[112:127]
    s_waitcnt vmcnt(7)
    v_mfma_f32_32x32x16_bf16 v[112:127], a[224:227], v[240:243], v[112:127]
    s_waitcnt vmcnt(6)
    v_mfma_f32_32x32x16_bf16 v[112:127], a[228:231], v[244:247], v[112:127]
    s_waitcnt vmcnt(5)
    v_mfma_f32_32x32x16_bf16 v[112:127], a[232:235], v[248:251], v[112:127]
    s_waitcnt vmcnt(4)
    v_mfma_f32_32x32x16_bf16 v[112:127], a[236:239], v[252:255], v[112:127]
    s_waitcnt vmcnt(3)
    v_mfma_f32_32x32x16_bf16 v[112:127], a[240:243], v[136:139], v[112:127]
    s_waitcnt vmcnt(2)
    v_mfma_f32_32x32x16_bf16 v[112:127], a[244:247], v[140:143], v[112:127]
    s_waitcnt vmcnt(1)
    v_mfma_f32_32x32x16_bf16 v[112:127], a[248:251], v[144:147], v[112:127]
    s_waitcnt vmcnt(0)
    v_mfma_f32_32x32x16_bf16 v[112:127], a[252:255], v[148:151], v[112:127]
    s_branch mega_kernel_x_pfd
mega_kernel_x_pfx:
    s_waitcnt vmcnt(27)
    v_mfma_f32_32x32x16_bf16 v[112:127], a[144:147], v[160:163], v[112:127]
    buffer_load_dwordx4 v[24:27], v2, s[84:87], s26 offen offset:0
    buffer_load_dwordx4 v[28:31], v2, s[84:87], s26 offen offset:2048
    s_waitcnt vmcnt(28)
    v_mfma_f32_32x32x16_bf16 v[112:127], a[148:151], v[164:167], v[112:127]
    buffer_load_dwordx4 v[32:35], v2, s[84:87], s48 offen offset:0
    buffer_load_dwordx4 v[36:39], v2, s[84:87], s48 offen offset:2048
    s_waitcnt vmcnt(29)
    v_mfma_f32_32x32x16_bf16 v[112:127], a[152:155], v[168:171], v[112:127]
    buffer_load_dwordx4 v[40:43], v2, s[84:87], s27 offen offset:0
    buffer_load_dwordx4 v[44:47], v2, s[84:87], s27 offen offset:1024
    s_waitcnt vmcnt(30)
    v_mfma_f32_32x32x16_bf16 v[112:127], a[156:159], v[172:175], v[112:127]
    buffer_load_dwordx4 v[48:51], v2, s[84:87], s27 offen offset:2048
    buffer_load_dwordx4 v[52:55], v2, s[84:87], s27 offen offset:3072
    s_waitcnt vmcnt(31)
    v_mfma_f32_32x32x16_bf16 v[112:127], a[160:163], v[176:179], v[112:127]
    buffer_load_dwordx4 v[56:59], v2, s[84:87], s49 offen offset:0
    buffer_load_dwordx4 v[60:63], v2, s[84:87], s49 offen offset:1024
    s_waitcnt vmcnt(32)
    v_mfma_f32_32x32x16_bf16 v[112:127], a[164:167], v[180:183], v[112:127]
    buffer_load_dwordx4 v[64:67], v2, s[84:87], s49 offen offset:2048
    buffer_load_dwordx4 v[68:71], v2, s[84:87], s49 offen offset:3072
    s_waitcnt vmcnt(33)
    v_mfma_f32_32x32x16_bf16 v[112:127], a[168:171], v[184:187], v[112:127]
    buffer_load_dwordx4 v[72:75], v2, s[84:87], s28 offen offset:0
    buffer_load_dwordx4 v[76:79], v2, s[84:87], s28 offen offset:1024
    s_waitcnt vmcnt(34)
    v_mfma_f32_32x32x16_bf16 v[112:127], a[172:175], v[188:191], v[112:127]
    buffer_load_dwordx4 v[80:83], v2, s[84:87], s28 offen offset:2048
    buffer_load_dwordx4 v[84:87], v2, s[84:87], s28 offen offset:3072
    s_waitcnt vmcnt(35)
    v_mfma_f32_32x32x16_bf16 v[112:127], a[176:179], v[192:195], v[112:127]
    buffer_load_dwordx4 v[88:91], v6, s[84:87], s29 offen offset:0 sc1
    buffer_load_dwordx4 v[92:95], v6, s[84:87], s29 offen offset:64 sc1
    s_waitcnt vmcnt(36)
    v_mfma_f32_32x32x16_bf16 v[112:127], a[180:183], v[196:199], v[112:127]
    buffer_load_dwordx4 v[96:99], v6, s[84:87], s29 offen offset:128 sc1
    buffer_load_dwordx4 v[100:103], v6, s[84:87], s29 offen offset:192 sc1
    s_waitcnt vmcnt(37)
    v_mfma_f32_32x32x16_bf16 v[112:127], a[184:187], v[200:203], v[112:127]
    buffer_load_dwordx2 v[104:105], v7, s[84:87], s29 offen offset:0 sc1
    buffer_load_dwordx2 v[106:107], v7, s[84:87], s29 offen offset:2048 sc1
    s_waitcnt vmcnt(38)
    v_mfma_f32_32x32x16_bf16 v[112:127], a[188:191], v[204:207], v[112:127]
    buffer_load_dwordx2 v[108:109], v7, s[84:87], s29 offen offset:512 sc1
    buffer_load_dwordx2 v[110:111], v7, s[84:87], s29 offen offset:2560 sc1
    s_waitcnt vmcnt(39)
    v_mfma_f32_32x32x16_bf16 v[112:127], a[192:195], v[208:211], v[112:127]
    s_waitcnt vmcnt(38)
    v_mfma_f32_32x32x16_bf16 v[112:127], a[196:199], v[212:215], v[112:127]
    s_waitcnt vmcnt(37)
    v_mfma_f32_32x32x16_bf16 v[112:127], a[200:203], v[216:219], v[112:127]
    s_waitcnt vmcnt(36)
    v_mfma_f32_32x32x16_bf16 v[112:127], a[204:207], v[220:223], v[112:127]
    s_waitcnt vmcnt(35)
    v_mfma_f32_32x32x16_bf16 v[112:127], a[208:211], v[224:227], v[112:127]
    s_waitcnt vmcnt(34)
    v_mfma_f32_32x32x16_bf16 v[112:127], a[212:215], v[228:231], v[112:127]
    s_waitcnt vmcnt(33)
    v_mfma_f32_32x32x16_bf16 v[112:127], a[216:219], v[232:235], v[112:127]
    s_waitcnt vmcnt(32)
    v_mfma_f32_32x32x16_bf16 v[112:127], a[220:223], v[236:239], v[112:127]
    s_waitcnt vmcnt(31)
    v_mfma_f32_32x32x16_bf16 v[112:127], a[224:227], v[240:243], v[112:127]
    s_waitcnt vmcnt(30)
    v_mfma_f32_32x32x16_bf16 v[112:127], a[228:231], v[244:247], v[112:127]
    s_waitcnt vmcnt(29)
    v_mfma_f32_32x32x16_bf16 v[112:127], a[232:235], v[248:251], v[112:127]
    s_waitcnt vmcnt(28)
    v_mfma_f32_32x32x16_bf16 v[112:127], a[236:239], v[252:255], v[112:127]
    s_waitcnt vmcnt(27)
    v_mfma_f32_32x32x16_bf16 v[112:127], a[240:243], v[136:139], v[112:127]
    s_waitcnt vmcnt(26)
    v_mfma_f32_32x32x16_bf16 v[112:127], a[244:247], v[140:143], v[112:127]
    s_waitcnt vmcnt(25)
    v_mfma_f32_32x32x16_bf16 v[112:127], a[248:251], v[144:147], v[112:127]
    s_waitcnt vmcnt(24)
    v_mfma_f32_32x32x16_bf16 v[112:127], a[252:255], v[148:151], v[112:127]
mega_kernel_x_pfd:
    s_nop 11
    ds_write_b128 v17, v[112:115] offset:0
    ds_write_b128 v17, v[116:119] offset:1024
    ds_write_b128 v17, v[120:123] offset:2048
    ds_write_b128 v17, v[124:127] offset:3072
    s_waitcnt lgkmcnt(0)
    s_barrier
    ds_read_b128 v[112:115], v16 offset:0
    ds_read_b128 v[116:119], v16 offset:4096
    ds_read_b128 v[120:123], v16 offset:8192
    ds_read_b128 v[124:127], v16 offset:12288
    s_waitcnt lgkmcnt(0)
    v_pk_add_f32 v[112:113], v[112:113], v[116:117]
    v_pk_add_f32 v[114:115], v[114:115], v[118:119]
    v_pk_add_f32 v[120:121], v[120:121], v[124:125]
    v_pk_add_f32 v[122:123], v[122:123], v[126:127]
    v_pk_add_f32 v[112:113], v[112:113], v[120:121]
    v_pk_add_f32 v[114:115], v[114:115], v[122:123]
    v_cvt_pk_bf16_f32 v132, v112, v113
    v_cvt_pk_bf16_f32 v133, v114, v115
    buffer_store_dwordx2 v[132:133], v18, s[12:15], s42 offen
    s_cmp_eq_u32 s46, 1
    s_cbranch_scc1 mega_kernel_x_att
    s_cmp_lt_u32 s22, 64
    s_cbranch_scc1 mega_kernel_x_ldq
    s_endpgm
.section .rodata,"a"
.p2align 6
.amdhsa_kernel mega_kernel
  .amdhsa_next_free_vgpr 512
  .amdhsa_next_free_sgpr 102
  .amdhsa_accum_offset 256
  .amdhsa_group_segment_fixed_size 0
  .amdhsa_kernarg_size 104
  .amdhsa_user_sgpr_count 2
  .amdhsa_user_sgpr_kernarg_segment_ptr 1
  .amdhsa_system_sgpr_workgroup_id_x 1
.end_amdhsa_kernel
```

```asm
; @launch kernel=mega_kernel grid=(256,1,1) block=(256,1,1) lds=161792
.amdgcn_target "amdgcn-amd-amdhsa--gfx950"
.text
.globl mega_kernel
.p2align 8
.type mega_kernel,@function
mega_kernel:
    s_cmp_ge_u32 s2, 256
    s_cbranch_scc1 mega_kernel_exit
    s_load_dwordx2 s[84:85], s[0:1], 96
    s_load_dwordx2 s[88:89], s[0:1], 88
    s_getreg_b32 s93, hwreg(HW_REG_XCC_ID)
    s_and_b32 s93, s93, 7
    s_lshl_b32 s93, s93, 2
    s_lshr_b32 s93, 0x76543210, s93
    s_and_b32 s93, s93, 7
    v_lshrrev_b32 v1, 6, v0
    v_mov_b32 v4, 0
    v_readfirstlane_b32 s80, v1
    v_mov_b32 v5, 0
    v_mov_b32 v6, 0
    v_mov_b32 v7, 0
    s_mov_b32 s83, 0
    s_lshl_b32 s101, s2, 2
    s_add_u32 s101, s101, s80
    s_lshl_b32 s101, s101, 8
    s_add_u32 s101, s101, 230686720
    s_waitcnt lgkmcnt(0)
    s_mov_b32 s86, 268435456
    s_mov_b32 s87, 0x00020000
    s_mov_b32 s90, 256
    s_mov_b32 s91, 0x00020000
    s_mov_b32 s98, s80
    s_cmp_lg_u32 s80, 0
    s_cbranch_scc1 mega_kernel_st0
    v_mov_b32 v10, 1
    s_lshl_b32 s81, s93, 5
    s_mov_b64 exec, 1
    buffer_atomic_add v10, off, s[88:91], s81 offset:4 sc0
    s_lshl_b32 s81, s2, 7
    s_add_u32 s81, s81, 71303168
    s_mov_b64 exec, 3
    v_lshlrev_b32 v1, 15, v0
    buffer_store_dword v4, v1, s[84:87], s81 offen sc1
    s_mov_b64 exec, -1
mega_kernel_st0:
    s_load_dwordx2 s[72:73], s[0:1], 8
    v_mov_b32 v4, 0
    v_mov_b32 v5, 0
    v_mov_b32 v6, 0
    v_mov_b32 v7, 0
    v_lshlrev_b32 v1, 4, v0
    s_lshl_b32 s81, s2, 13
    s_add_u32 s81, s81, 67108864
    s_add_u32 s79, s81, 4096
    buffer_store_dwordx4 v[4:7], v1, s[84:87], s81 offen sc1
    buffer_store_dwordx4 v[4:7], v1, s[84:87], s79 offen sc1
    s_lshl_b32 s81, s2, 12
    s_add_u32 s81, s81, 70254592
    buffer_store_dwordx4 v[4:7], v1, s[84:87], s81 offen sc1
    s_cmp_ge_u32 s2, 64
    s_cbranch_scc1 mega_kernel_gi
    v_bfe_u32 v2, v0, 3, 1
    v_lshlrev_b32 v2, 11, v2
    v_and_b32 v3, 3, v0
    v_lshl_add_u32 v2, v3, 5, v2
    v_bfe_u32 v3, v0, 4, 3
    v_lshl_add_u32 v2, v3, 2, v2
    v_bfe_u32 v3, v0, 2, 1
    v_lshl_add_u32 v2, v3, 1, v2
    s_lshr_b32 s81, s2, 2
    s_lshl_b32 s81, s81, 7
    s_and_b32 s79, s2, 3
    s_lshl_b32 s79, s79, 12
    s_add_u32 s81, s81, s79
    s_waitcnt lgkmcnt(0)
    s_mov_b32 s74, 16384
    s_mov_b32 s75, 0x00020000
    buffer_load_ushort v8, v2, s[72:75], s81 offen
    v_mov_b32 v9, -1
    v_and_b32 v1, 31, v0
    v_lshlrev_b32 v1, 1, v1
    v_bfe_u32 v3, v0, 5, 2
    v_lshl_add_u32 v1, v3, 8, v1
    v_lshrrev_b32 v3, 7, v0
    v_lshl_add_u32 v1, v3, 14, v1
    v_cmp_gt_u32 vcc, 128, v0
    s_lshr_b32 s81, s2, 2
    s_lshl_b32 s81, s81, 10
    s_and_b32 s79, s2, 3
    s_lshl_b32 s79, s79, 6
    s_add_u32 s81, s81, s79
    s_add_u32 s81, s81, 69206016
    s_waitcnt vmcnt(0)
    v_min_u32 v8, 0xfffe, v8
    v_cndmask_b32 v8, v9, v8, vcc
    buffer_store_short v8, v1, s[84:87], s81 offen sc1
mega_kernel_gi:
    s_waitcnt lgkmcnt(0)
    s_cmp_lg_u32 s80, 0
    s_cbranch_scc1 mega_kernel_st1
    s_mov_b64 exec, 1
    s_waitcnt vmcnt(4)
    ds_write_b32 v4, v10
    s_mov_b64 exec, -1
    s_waitcnt lgkmcnt(0)
mega_kernel_st1:
    s_barrier
    ds_read_b32 v2, v4
    s_waitcnt lgkmcnt(0)
    v_readfirstlane_b32 s94, v2
    s_waitcnt vmcnt(0)
    s_barrier
    s_cmp_lg_u32 s80, 0
    s_cbranch_scc1 mega_kernel_st2
    s_lshl_b32 s81, s93, 5
    v_mov_b32 v10, 1
    s_mov_b64 exec, 1
    buffer_atomic_add v10, off, s[88:91], s81 sc1
    s_mov_b64 exec, -1
mega_kernel_st2:
    s_sub_u32 s81, s93, 2
    s_cmp_ge_u32 s81, 2
    s_cbranch_scc1 mega_kernel_nopr
    s_cmp_lg_u32 s80, 0
    s_cbranch_scc1 mega_kernel_prd
    v_lshlrev_b32 v1, 4, v0
    s_and_b32 s81, s2, 127
    s_lshl_b32 s81, s81, 14
    s_add_u32 s81, s81, 67108864
    s_add_u32 s77, s81, 8192
    buffer_store_dwordx4 v[4:7], v1, s[84:87], s81 offen sc1
    buffer_store_dwordx4 v[4:7], v1, s[84:87], s77 offen sc1
    s_waitcnt vmcnt(0)
    s_memtime s[70:71]
    buffer_store_dwordx4 v[4:7], v1, s[84:87], s81 offen sc1
    s_waitcnt vmcnt(0)
    s_memtime s[72:73]
    buffer_store_dwordx4 v[4:7], v1, s[84:87], s77 offen sc1
    s_waitcnt vmcnt(0)
    buffer_store_dwordx4 v[4:7], v1, s[84:87], s77 offen sc1
    s_waitcnt vmcnt(0)
    s_memtime s[74:75]
    buffer_store_dwordx4 v[4:7], v1, s[84:87], s81 offen sc1
    s_waitcnt vmcnt(0)
    s_memtime s[76:77]
    s_waitcnt lgkmcnt(0)
    s_sub_u32 s76, s76, s74
    s_sub_u32 s74, s74, s72
    s_sub_u32 s72, s72, s70
    s_add_u32 s72, s72, s76
    s_cmp_lt_u32 s74, s72
    s_cselect_b32 s81, 0x10001, 1
    v_mov_b32 v8, s81
    s_mov_b64 exec, 1
    buffer_atomic_add v8, off, s[88:91], 0 offset:204 sc1
    s_mov_b64 exec, -1
mega_kernel_prd:
    s_barrier
mega_kernel_nopr:
    s_mov_b32 s97, 0
    s_mov_b32 s100, 64
mega_kernel_fast:
    s_mov_b32 s96, 1
    s_mov_b32 s30, s93
    s_and_b32 s31, s94, 31
    s_cmp_lt_u32 s93, 2
    s_cbranch_scc1 mega_kernel_recf
    s_sub_u32 s92, s93, 2
    s_lshl_b32 s92, s92, 5
    s_add_u32 s92, s92, s31
    s_branch mega_kernel_bulk
mega_kernel_redo:
    s_waitcnt vmcnt(0) lgkmcnt(0)
    s_barrier
    v_readlane_b32 s100, v252, 2
    v_readlane_b32 s81, v252, 3
    s_mov_b32 s97, 1
    s_nop 2
    s_add_u32 s100, s100, s81
    s_mov_b32 s95, s94
    v_readlane_b32 s81, v252, 0
    s_cmp_gt_u32 s93, 0
    s_nop 2
    s_cselect_b32 s81, s81, 0
    s_add_u32 s95, s95, s81
    v_readlane_b32 s81, v252, 1
    s_cmp_gt_u32 s93, 1
    s_nop 2
    s_cselect_b32 s81, s81, 0
    s_add_u32 s95, s95, s81
    v_readlane_b32 s81, v252, 2
    s_cmp_gt_u32 s93, 2
    s_nop 2
    s_cselect_b32 s81, s81, 0
    s_add_u32 s95, s95, s81
    v_readlane_b32 s81, v252, 3
    s_cmp_gt_u32 s93, 3
    s_nop 2
    s_cselect_b32 s81, s81, 0
    s_add_u32 s95, s95, s81
    v_readlane_b32 s81, v252, 4
    s_cmp_gt_u32 s93, 4
    s_nop 2
    s_cselect_b32 s81, s81, 0
    s_add_u32 s95, s95, s81
    v_readlane_b32 s81, v252, 5
    s_cmp_gt_u32 s93, 5
    s_nop 2
    s_cselect_b32 s81, s81, 0
    s_add_u32 s95, s95, s81
    v_readlane_b32 s81, v252, 6
    s_cmp_gt_u32 s93, 6
    s_nop 2
    s_cselect_b32 s81, s81, 0
    s_add_u32 s95, s95, s81
mega_kernel_slow:
    s_mov_b32 s96, 0
    s_lshr_b32 s30, s95, 5
    s_and_b32 s31, s95, 31
    s_cmp_lt_u32 s95, 64
    s_cbranch_scc1 mega_kernel_recs
    s_sub_u32 s92, s95, 64
    s_branch mega_kernel_bulk
mega_kernel_exit:
    s_endpgm
mega_kernel_recf:
    s_load_dwordx2 s[4:5], s[0:1], 96
    s_load_dwordx2 s[12:13], s[0:1], 88
    s_load_dwordx2 s[50:51], s[0:1], 16
    s_load_dwordx2 s[52:53], s[0:1], 24
    s_load_dwordx2 s[54:55], s[0:1], 32
    s_load_dwordx2 s[56:57], s[0:1], 40
    s_load_dwordx2 s[58:59], s[0:1], 8
    v_lshrrev_b32 v3, 6, v0
    v_and_b32 v40, 63, v0
    v_readfirstlane_b32 s20, v3
    v_lshrrev_b32 v41, 4, v40
    v_and_b32 v42, 15, v40
    v_lshlrev_b32 v1, 4, v40
    s_mov_b32 s49, 0
    s_waitcnt lgkmcnt(0)
    s_mov_b32 s6, 268435456
    s_mov_b32 s7, 0x00020000
    s_mov_b32 s14, 256
    s_mov_b32 s15, 0x00020000
    s_mov_b32 s10, 8388608
    s_mov_b32 s11, 0x00020000
    s_mov_b32 s26, 0x00030003
    s_mov_b32 s27, 0x00030003
    s_mov_b32 s28, 0xcccccccc
    s_mov_b32 s29, 0xcccccccc
    s_mov_b32 s32, 0x33333333
    s_mov_b32 s33, 0x33333333
    s_mov_b32 s34, 0x3e0293ee
    s_lshl_b32 s22, s20, 2
    v_xor_b32 v3, s22, v42
    v_lshlrev_b32 v3, 4, v3
    v_lshl_add_u32 v4, v41, 4, s20
    v_lshl_add_u32 v44, v4, 13, v3
    s_lshl_b32 s22, s30, 22
    s_lshl_b32 s23, s31, 8
    s_add_u32 s22, s22, s23
    v_add_u32 v44, s22, v44
    s_lshr_b32 s22, s20, 1
    s_lshl_b32 s22, s22, 5
    s_and_b32 s23, s20, 1
    s_lshl_b32 s23, s23, 2
    s_add_u32 s22, s22, s23
    s_lshl_b32 s23, s31, 7
    s_add_u32 s22, s22, s23
    v_add_u32 v4, s22, v41
    v_lshl_add_u32 v45, v4, 11, v3
    s_lshl_b32 s22, s30, 10
    v_add_u32 v45, s22, v45
    s_lshl_b32 s48, s20, 10
    s_mov_b32 s8, s50
    s_mov_b32 s9, s51
    s_add_u32 m0, s48, 0
    s_mov_b32 s22, 0
    buffer_load_dwordx4 v44, s[8:11], s22 offen  lds
    s_add_u32 m0, s48, 4096
    s_mov_b32 s22, 32768
    buffer_load_dwordx4 v44, s[8:11], s22 offen  lds
    s_add_u32 m0, s48, 8192
    s_mov_b32 s22, 65536
    buffer_load_dwordx4 v44, s[8:11], s22 offen  lds
    s_add_u32 m0, s48, 12288
    s_mov_b32 s22, 98304
    buffer_load_dwordx4 v44, s[8:11], s22 offen  lds
    s_add_u32 m0, s48, 16384
    s_mov_b32 s22, 524288
    buffer_load_dwordx4 v44, s[8:11], s22 offen  lds
    s_add_u32 m0, s48, 20480
    s_mov_b32 s22, 557056
    buffer_load_dwordx4 v44, s[8:11], s22 offen  lds
    s_add_u32 m0, s48, 24576
    s_mov_b32 s22, 589824
    buffer_load_dwordx4 v44, s[8:11], s22 offen  lds
    s_add_u32 m0, s48, 28672
    s_mov_b32 s22, 622592
    buffer_load_dwordx4 v44, s[8:11], s22 offen  lds
    s_add_u32 m0, s48, 32768
    s_mov_b32 s22, 1048576
    buffer_load_dwordx4 v44, s[8:11], s22 offen  lds
    s_add_u32 m0, s48, 36864
    s_mov_b32 s22, 1081344
    buffer_load_dwordx4 v44, s[8:11], s22 offen  lds
    s_add_u32 m0, s48, 40960
    s_mov_b32 s22, 1114112
    buffer_load_dwordx4 v44, s[8:11], s22 offen  lds
    s_add_u32 m0, s48, 45056
    s_mov_b32 s22, 1146880
    buffer_load_dwordx4 v44, s[8:11], s22 offen  lds
    s_add_u32 m0, s48, 49152
    s_mov_b32 s22, 1572864
    buffer_load_dwordx4 v44, s[8:11], s22 offen  lds
    s_add_u32 m0, s48, 53248
    s_mov_b32 s22, 1605632
    buffer_load_dwordx4 v44, s[8:11], s22 offen  lds
    s_add_u32 m0, s48, 57344
    s_mov_b32 s22, 1638400
    buffer_load_dwordx4 v44, s[8:11], s22 offen  lds
    s_add_u32 m0, s48, 61440
    s_mov_b32 s22, 1671168
    buffer_load_dwordx4 v44, s[8:11], s22 offen  lds
    s_add_u32 m0, s48, 65536
    s_mov_b32 s22, 2097152
    buffer_load_dwordx4 v44, s[8:11], s22 offen  lds
    s_add_u32 m0, s48, 69632
    s_mov_b32 s22, 2129920
    buffer_load_dwordx4 v44, s[8:11], s22 offen  lds
    s_add_u32 m0, s48, 73728
    s_mov_b32 s22, 2162688
    buffer_load_dwordx4 v44, s[8:11], s22 offen  lds
    s_add_u32 m0, s48, 77824
    s_mov_b32 s22, 2195456
    buffer_load_dwordx4 v44, s[8:11], s22 offen  lds
    s_add_u32 m0, s48, 81920
    s_mov_b32 s22, 2621440
    buffer_load_dwordx4 v44, s[8:11], s22 offen  lds
    s_add_u32 m0, s48, 86016
    s_mov_b32 s22, 2654208
    buffer_load_dwordx4 v44, s[8:11], s22 offen  lds
    s_add_u32 m0, s48, 90112
    s_mov_b32 s22, 2686976
    buffer_load_dwordx4 v44, s[8:11], s22 offen  lds
    s_add_u32 m0, s48, 94208
    s_mov_b32 s22, 2719744
    buffer_load_dwordx4 v44, s[8:11], s22 offen  lds
    s_add_u32 m0, s48, 98304
    s_mov_b32 s22, 3145728
    buffer_load_dwordx4 v44, s[8:11], s22 offen  lds
    s_add_u32 m0, s48, 102400
    s_mov_b32 s22, 3178496
    buffer_load_dwordx4 v44, s[8:11], s22 offen  lds
    s_add_u32 m0, s48, 106496
    s_mov_b32 s22, 3211264
    buffer_load_dwordx4 v44, s[8:11], s22 offen  lds
    s_add_u32 m0, s48, 110592
    s_mov_b32 s22, 3244032
    buffer_load_dwordx4 v44, s[8:11], s22 offen  lds
    s_add_u32 m0, s48, 114688
    s_mov_b32 s22, 3670016
    buffer_load_dwordx4 v44, s[8:11], s22 offen  lds
    s_add_u32 m0, s48, 118784
    s_mov_b32 s22, 3702784
    buffer_load_dwordx4 v44, s[8:11], s22 offen  lds
    s_add_u32 m0, s48, 122880
    s_mov_b32 s22, 3735552
    buffer_load_dwordx4 v44, s[8:11], s22 offen  lds
    s_add_u32 m0, s48, 126976
    s_mov_b32 s22, 3768320
    buffer_load_dwordx4 v44, s[8:11], s22 offen  lds
    s_lshl_b32 s22, s30, 5
    s_add_u32 s22, s22, s31
    s_lshl_b32 s38, s22, 14
    s_xor_b32 s22, s22, 32
    s_lshl_b32 s37, s22, 14
    s_add_u32 s38, s38, 67108864
    s_add_u32 s37, s37, 67108864
    s_lshl_b32 s46, s30, 19
    s_add_u32 s46, s46, 70254592
    s_mul_i32 s22, s31, 8448
    s_add_u32 s47, s46, s22
    s_mul_i32 s22, s20, 67584
    s_add_u32 s46, s46, s22
    s_lshl_b32 s22, s31, 6
    s_add_u32 s46, s46, s22
    s_add_u32 s61, s46, 33792
    s_mul_i32 s22, s20, 2048
    s_add_u32 s25, s47, s22
    s_lshl_b32 s35, s30, 13
    s_add_u32 s35, s35, 69206016
    v_lshrrev_b32 v53, 2, v42
    v_lshlrev_b32 v53, 1, v53
    v_and_b32 v54, 1, v42
    v_add_u32 v55, v53, v54
    v_mov_b32 v14, 0
    v_mov_b32 v15, 0
    v_mov_b32 v2, 0x4444
    v_mov_b32 v3, 0xeeee
    v_cndmask_b32 v2, v2, v3, s[28:29]
    s_lshl_b32 s22, s20, 12
    v_add_u32 v32, s22, v1
    v_add_u32 v33, 0x10000, v32
    v_add_u32 v5, 0x10000, v1
    v_add_u32 v6, 131072, v1
    v_and_b32 v3, 3, v42
    v_bfe_u32 v43, v40, 1, 1
    v_lshlrev_b32 v7, 13, v43
    v_and_b32 v43, 1, v40
    v_lshl_add_u32 v7, v43, 7, v7
    s_lshl_b32 s22, s31, 8
    s_add_u32 s23, s22, 71311360
    v_add_u32 v7, s23, v7
    s_cmp_lg_u32 s20, 0
    s_cbranch_scc1 mega_kernel_rf_flk
    s_lshl_b32 s23, s30, 7
    s_add_u32 s22, s22, s23
    s_add_u32 s22, s22, 71327744
    v_bfrev_b32 v7, 1
    v_writelane_b32 v7, s22, 0
mega_kernel_rf_flk:
    v_lshlrev_b32 v11, 3, v40
    v_lshlrev_b32 v10, 8, v55
    v_lshl_add_u32 v10, v41, 4, v10
    v_mul_u32_u24 v8, 8448, v41
    v_lshl_add_u32 v8, v3, 4, v8
    v_lshrrev_b32 v4, 2, v42
    v_mul_u32_u24 v4, 2048, v4
    v_add_u32 v8, v4, v8
    v_lshrrev_b32 v9, 1, v41
    v_lshlrev_b32 v9, 5, v9
    v_and_b32 v4, 1, v42
    v_lshl_add_u32 v9, v4, 4, v9
    v_and_b32 v4, 1, v41
    v_lshl_add_u32 v9, v4, 3, v9
    s_lshr_b32 s22, s31, 2
    s_lshl_b32 s22, s22, 10
    s_and_b32 s23, s31, 3
    s_lshl_b32 s23, s23, 6
    s_add_u32 s22, s22, s23
    v_add_u32 v9, s22, v9
    v_lshrrev_b32 v4, 2, v42
    v_lshlrev_b32 v12, 8, v4
    v_lshl_add_u32 v12, v41, 6, v12
    v_lshl_add_u32 v12, v3, 4, v12
    v_lshlrev_b32 v13, 6, v41
    v_lshl_add_u32 v13, v42, 2, v13
    v_cmp_eq_u32 vcc, 0, v3
    v_mov_b32 v28, 0x3f803f80
    v_mov_b32 v29, 0x3f803f80
    v_cndmask_b32 v34, 0, 1, vcc
    v_mov_b32 v30, 0x3f803f80
    v_mov_b32 v31, 0x3f803f80
    v_and_b32 v49, 1, v42
    v_lshlrev_b32 v49, 4, v49
    v_mov_b32 v50, 0x3f80
    v_lshlrev_b32 v50, v49, v50
    v_lshrrev_b32 v51, 2, v42
    v_cmp_eq_u32 vcc, v51, v41
    v_mov_b32 v24, v50
    v_cndmask_b32 v52, 0, v50, s[28:29]
    v_cndmask_b32 v53, 0, v50, s[32:33]
    v_cndmask_b32 v16, 0, v52, vcc
    v_cndmask_b32 v17, 0, v53, vcc
    v_mov_b32 v25, v50
    v_mov_b32 v26, v50
    v_mov_b32 v27, v50
    v_bfe_u32 v60, v40, 3, 1
    v_bfe_u32 v49, v40, 2, 1
    v_and_b32 v50, 1, v41
    v_lshrrev_b32 v51, 1, v41
    v_lshlrev_b32 v52, 3, v60
    v_lshl_add_u32 v52, v50, 2, v52
    v_lshl_add_u32 v53, v51, 4, v52
    v_add_u32 v53, v53, v49
    v_and_b32 v54, 3, v40
    s_lshl_b32 s22, s20, 2
    v_add_u32 v55, s22, v54
    v_xor_b32 v55, v55, v52
    v_lshlrev_b32 v55, 4, v55
    v_lshl_add_u32 v46, v53, 8, v55
    v_lshlrev_b32 v55, 4, v52
    v_lshl_add_u32 v55, v54, 3, v55
    v_lshl_add_u32 v47, v53, 8, v55
    s_waitcnt vmcnt(28)
    s_barrier
    v_add_u32 v48, 0, v46
    ds_read_b64_tr_b16 a[0:1], v48 offset:0
    ds_read_b64_tr_b16 a[2:3], v48 offset:512
    ds_read_b64_tr_b16 a[4:5], v48 offset:8192
    ds_read_b64_tr_b16 a[6:7], v48 offset:8704
    ds_read_b64_tr_b16 a[8:9], v48 offset:8
    ds_read_b64_tr_b16 a[10:11], v48 offset:520
    ds_read_b64_tr_b16 a[12:13], v48 offset:8200
    ds_read_b64_tr_b16 a[14:15], v48 offset:8712
    s_waitcnt lgkmcnt(0)
    s_barrier
    s_mov_b32 s8, s52
    s_mov_b32 s9, s53
    s_add_u32 m0, s48, 0
    s_mov_b32 s22, 0
    buffer_load_dwordx4 v44, s[8:11], s22 offen  lds
    s_add_u32 m0, s48, 4096
    s_mov_b32 s22, 32768
    buffer_load_dwordx4 v44, s[8:11], s22 offen  lds
    s_add_u32 m0, s48, 8192
    s_mov_b32 s22, 65536
    buffer_load_dwordx4 v44, s[8:11], s22 offen  lds
    s_add_u32 m0, s48, 12288
    s_mov_b32 s22, 98304
    buffer_load_dwordx4 v44, s[8:11], s22 offen  lds
    s_waitcnt vmcnt(28)
    s_barrier
    v_add_u32 v48, 16384, v46
    ds_read_b64_tr_b16 a[16:17], v48 offset:0
    ds_read_b64_tr_b16 a[18:19], v48 offset:512
    ds_read_b64_tr_b16 a[20:21], v48 offset:8192
    ds_read_b64_tr_b16 a[22:23], v48 offset:8704
    ds_read_b64_tr_b16 a[24:25], v48 offset:8
    ds_read_b64_tr_b16 a[26:27], v48 offset:520
    ds_read_b64_tr_b16 a[28:29], v48 offset:8200
    ds_read_b64_tr_b16 a[30:31], v48 offset:8712
    s_waitcnt lgkmcnt(0)
    s_barrier
    s_add_u32 m0, s48, 16384
    s_mov_b32 s22, 524288
    buffer_load_dwordx4 v44, s[8:11], s22 offen  lds
    s_add_u32 m0, s48, 20480
    s_mov_b32 s22, 557056
    buffer_load_dwordx4 v44, s[8:11], s22 offen  lds
    s_add_u32 m0, s48, 24576
    s_mov_b32 s22, 589824
    buffer_load_dwordx4 v44, s[8:11], s22 offen  lds
    s_add_u32 m0, s48, 28672
    s_mov_b32 s22, 622592
    buffer_load_dwordx4 v44, s[8:11], s22 offen  lds
    s_waitcnt vmcnt(28)
    s_barrier
    v_add_u32 v48, 32768, v46
    ds_read_b64_tr_b16 a[32:33], v48 offset:0
    ds_read_b64_tr_b16 a[34:35], v48 offset:512
    ds_read_b64_tr_b16 a[36:37], v48 offset:8192
    ds_read_b64_tr_b16 a[38:39], v48 offset:8704
    ds_read_b64_tr_b16 a[40:41], v48 offset:8
    ds_read_b64_tr_b16 a[42:43], v48 offset:520
    ds_read_b64_tr_b16 a[44:45], v48 offset:8200
    ds_read_b64_tr_b16 a[46:47], v48 offset:8712
    s_waitcnt lgkmcnt(0)
    s_barrier
    s_add_u32 m0, s48, 32768
    s_mov_b32 s22, 1048576
    buffer_load_dwordx4 v44, s[8:11], s22 offen  lds
    s_add_u32 m0, s48, 36864
    s_mov_b32 s22, 1081344
    buffer_load_dwordx4 v44, s[8:11], s22 offen  lds
    s_add_u32 m0, s48, 40960
    s_mov_b32 s22, 1114112
    buffer_load_dwordx4 v44, s[8:11], s22 offen  lds
    s_add_u32 m0, s48, 45056
    s_mov_b32 s22, 1146880
    buffer_load_dwordx4 v44, s[8:11], s22 offen  lds
    s_waitcnt vmcnt(28)
    s_barrier
    v_add_u32 v48, 49152, v46
    ds_read_b64_tr_b16 a[48:49], v48 offset:0
    ds_read_b64_tr_b16 a[50:51], v48 offset:512
    ds_read_b64_tr_b16 a[52:53], v48 offset:8192
    ds_read_b64_tr_b16 a[54:55], v48 offset:8704
    ds_read_b64_tr_b16 a[56:57], v48 offset:8
    ds_read_b64_tr_b16 a[58:59], v48 offset:520
    ds_read_b64_tr_b16 a[60:61], v48 offset:8200
    ds_read_b64_tr_b16 a[62:63], v48 offset:8712
    s_waitcnt lgkmcnt(0)
    s_barrier
    s_add_u32 m0, s48, 49152
    s_mov_b32 s22, 1572864
    buffer_load_dwordx4 v44, s[8:11], s22 offen  lds
    s_add_u32 m0, s48, 53248
    s_mov_b32 s22, 1605632
    buffer_load_dwordx4 v44, s[8:11], s22 offen  lds
    s_add_u32 m0, s48, 57344
    s_mov_b32 s22, 1638400
    buffer_load_dwordx4 v44, s[8:11], s22 offen  lds
    s_add_u32 m0, s48, 61440
    s_mov_b32 s22, 1671168
    buffer_load_dwordx4 v44, s[8:11], s22 offen  lds
    s_waitcnt vmcnt(28)
    s_barrier
    v_add_u32 v48, 65536, v46
    ds_read_b64_tr_b16 a[64:65], v48 offset:0
    ds_read_b64_tr_b16 a[66:67], v48 offset:512
    ds_read_b64_tr_b16 a[68:69], v48 offset:8192
    ds_read_b64_tr_b16 a[70:71], v48 offset:8704
    ds_read_b64_tr_b16 a[72:73], v48 offset:8
    ds_read_b64_tr_b16 a[74:75], v48 offset:520
    ds_read_b64_tr_b16 a[76:77], v48 offset:8200
    ds_read_b64_tr_b16 a[78:79], v48 offset:8712
    s_waitcnt lgkmcnt(0)
    s_barrier
    s_add_u32 m0, s48, 65536
    s_mov_b32 s22, 2097152
    buffer_load_dwordx4 v44, s[8:11], s22 offen  lds
    s_add_u32 m0, s48, 69632
    s_mov_b32 s22, 2129920
    buffer_load_dwordx4 v44, s[8:11], s22 offen  lds
    s_add_u32 m0, s48, 73728
    s_mov_b32 s22, 2162688
    buffer_load_dwordx4 v44, s[8:11], s22 offen  lds
    s_add_u32 m0, s48, 77824
    s_mov_b32 s22, 2195456
    buffer_load_dwordx4 v44, s[8:11], s22 offen  lds
    s_waitcnt vmcnt(28)
    s_barrier
    v_add_u32 v48, 81920, v46
    ds_read_b64_tr_b16 a[80:81], v48 offset:0
    ds_read_b64_tr_b16 a[82:83], v48 offset:512
    ds_read_b64_tr_b16 a[84:85], v48 offset:8192
    ds_read_b64_tr_b16 a[86:87], v48 offset:8704
    ds_read_b64_tr_b16 a[88:89], v48 offset:8
    ds_read_b64_tr_b16 a[90:91], v48 offset:520
    ds_read_b64_tr_b16 a[92:93], v48 offset:8200
    ds_read_b64_tr_b16 a[94:95], v48 offset:8712
    s_waitcnt lgkmcnt(0)
    s_barrier
    s_add_u32 m0, s48, 81920
    s_mov_b32 s22, 2621440
    buffer_load_dwordx4 v44, s[8:11], s22 offen  lds
    s_add_u32 m0, s48, 86016
    s_mov_b32 s22, 2654208
    buffer_load_dwordx4 v44, s[8:11], s22 offen  lds
    s_add_u32 m0, s48, 90112
    s_mov_b32 s22, 2686976
    buffer_load_dwordx4 v44, s[8:11], s22 offen  lds
    s_add_u32 m0, s48, 94208
    s_mov_b32 s22, 2719744
    buffer_load_dwordx4 v44, s[8:11], s22 offen  lds
    s_waitcnt vmcnt(28)
    s_barrier
    v_add_u32 v48, 98304, v46
    ds_read_b64_tr_b16 a[96:97], v48 offset:0
    ds_read_b64_tr_b16 a[98:99], v48 offset:512
    ds_read_b64_tr_b16 a[100:101], v48 offset:8192
    ds_read_b64_tr_b16 a[102:103], v48 offset:8704
    ds_read_b64_tr_b16 a[104:105], v48 offset:8
    ds_read_b64_tr_b16 a[106:107], v48 offset:520
    ds_read_b64_tr_b16 a[108:109], v48 offset:8200
    ds_read_b64_tr_b16 a[110:111], v48 offset:8712
    s_waitcnt lgkmcnt(0)
    s_barrier
    s_add_u32 m0, s48, 98304
    s_mov_b32 s22, 3145728
    buffer_load_dwordx4 v44, s[8:11], s22 offen  lds
    s_add_u32 m0, s48, 102400
    s_mov_b32 s22, 3178496
    buffer_load_dwordx4 v44, s[8:11], s22 offen  lds
    s_add_u32 m0, s48, 106496
    s_mov_b32 s22, 3211264
    buffer_load_dwordx4 v44, s[8:11], s22 offen  lds
    s_add_u32 m0, s48, 110592
    s_mov_b32 s22, 3244032
    buffer_load_dwordx4 v44, s[8:11], s22 offen  lds
    s_waitcnt vmcnt(28)
    s_barrier
    v_add_u32 v48, 114688, v46
    ds_read_b64_tr_b16 a[112:113], v48 offset:0
    ds_read_b64_tr_b16 a[114:115], v48 offset:512
    ds_read_b64_tr_b16 a[116:117], v48 offset:8192
    ds_read_b64_tr_b16 a[118:119], v48 offset:8704
    ds_read_b64_tr_b16 a[120:121], v48 offset:8
    ds_read_b64_tr_b16 a[122:123], v48 offset:520
    ds_read_b64_tr_b16 a[124:125], v48 offset:8200
    ds_read_b64_tr_b16 a[126:127], v48 offset:8712
    s_waitcnt lgkmcnt(0)
    s_barrier
    s_add_u32 m0, s48, 114688
    s_mov_b32 s22, 3670016
    buffer_load_dwordx4 v44, s[8:11], s22 offen  lds
    s_add_u32 m0, s48, 118784
    s_mov_b32 s22, 3702784
    buffer_load_dwordx4 v44, s[8:11], s22 offen  lds
    s_add_u32 m0, s48, 122880
    s_mov_b32 s22, 3735552
    buffer_load_dwordx4 v44, s[8:11], s22 offen  lds
    s_add_u32 m0, s48, 126976
    s_mov_b32 s22, 3768320
    buffer_load_dwordx4 v44, s[8:11], s22 offen  lds
    s_waitcnt vmcnt(28)
    s_barrier
    v_add_u32 v48, 0, v46
    ds_read_b64_tr_b16 a[128:129], v48 offset:0
    ds_read_b64_tr_b16 a[130:131], v48 offset:512
    ds_read_b64_tr_b16 a[132:133], v48 offset:8192
    ds_read_b64_tr_b16 a[134:135], v48 offset:8704
    ds_read_b64_tr_b16 a[136:137], v48 offset:8
    ds_read_b64_tr_b16 a[138:139], v48 offset:520
    ds_read_b64_tr_b16 a[140:141], v48 offset:8200
    ds_read_b64_tr_b16 a[142:143], v48 offset:8712
    s_waitcnt lgkmcnt(0)
    s_barrier
    s_mov_b32 s8, s56
    s_mov_b32 s9, s57
    s_add_u32 m0, s48, 0
    s_mov_b32 s22, 0
    buffer_load_dwordx4 v45, s[8:11], s22 offen  lds
    s_add_u32 m0, s48, 4096
    s_mov_b32 s22, 16384
    buffer_load_dwordx4 v45, s[8:11], s22 offen  lds
    s_add_u32 m0, s48, 8192
    s_mov_b32 s22, 32768
    buffer_load_dwordx4 v45, s[8:11], s22 offen  lds
    s_add_u32 m0, s48, 12288
    s_mov_b32 s22, 49152
    buffer_load_dwordx4 v45, s[8:11], s22 offen  lds
    s_waitcnt vmcnt(28)
    s_barrier
    v_add_u32 v48, 16384, v46
    ds_read_b64_tr_b16 a[144:145], v48 offset:0
    ds_read_b64_tr_b16 a[146:147], v48 offset:512
    ds_read_b64_tr_b16 a[148:149], v48 offset:8192
    ds_read_b64_tr_b16 a[150:151], v48 offset:8704
    ds_read_b64_tr_b16 a[152:153], v48 offset:8
    ds_read_b64_tr_b16 a[154:155], v48 offset:520
    ds_read_b64_tr_b16 a[156:157], v48 offset:8200
    ds_read_b64_tr_b16 a[158:159], v48 offset:8712
    s_waitcnt lgkmcnt(0)
    s_barrier
    s_add_u32 m0, s48, 16384
    s_mov_b32 s22, 256
    buffer_load_dwordx4 v45, s[8:11], s22 offen  lds
    s_add_u32 m0, s48, 20480
    s_mov_b32 s22, 16640
    buffer_load_dwordx4 v45, s[8:11], s22 offen  lds
    s_add_u32 m0, s48, 24576
    s_mov_b32 s22, 33024
    buffer_load_dwordx4 v45, s[8:11], s22 offen  lds
    s_add_u32 m0, s48, 28672
    s_mov_b32 s22, 49408
    buffer_load_dwordx4 v45, s[8:11], s22 offen  lds
    s_waitcnt vmcnt(28)
    s_barrier
    v_add_u32 v48, 32768, v46
    ds_read_b64_tr_b16 a[160:161], v48 offset:0
    ds_read_b64_tr_b16 a[162:163], v48 offset:512
    ds_read_b64_tr_b16 a[164:165], v48 offset:8192
    ds_read_b64_tr_b16 a[166:167], v48 offset:8704
    ds_read_b64_tr_b16 a[168:169], v48 offset:8
    ds_read_b64_tr_b16 a[170:171], v48 offset:520
    ds_read_b64_tr_b16 a[172:173], v48 offset:8200
    ds_read_b64_tr_b16 a[174:175], v48 offset:8712
    s_waitcnt lgkmcnt(0)
    s_barrier
    s_add_u32 m0, s48, 32768
    s_mov_b32 s22, 512
    buffer_load_dwordx4 v45, s[8:11], s22 offen  lds
    s_add_u32 m0, s48, 36864
    s_mov_b32 s22, 16896
    buffer_load_dwordx4 v45, s[8:11], s22 offen  lds
    s_add_u32 m0, s48, 40960
    s_mov_b32 s22, 33280
    buffer_load_dwordx4 v45, s[8:11], s22 offen  lds
    s_add_u32 m0, s48, 45056
    s_mov_b32 s22, 49664
    buffer_load_dwordx4 v45, s[8:11], s22 offen  lds
    s_waitcnt vmcnt(28)
    s_barrier
    v_add_u32 v48, 49152, v46
    ds_read_b64_tr_b16 a[176:177], v48 offset:0
    ds_read_b64_tr_b16 a[178:179], v48 offset:512
    ds_read_b64_tr_b16 a[180:181], v48 offset:8192
    ds_read_b64_tr_b16 a[182:183], v48 offset:8704
    ds_read_b64_tr_b16 a[184:185], v48 offset:8
    ds_read_b64_tr_b16 a[186:187], v48 offset:520
    ds_read_b64_tr_b16 a[188:189], v48 offset:8200
    ds_read_b64_tr_b16 a[190:191], v48 offset:8712
    s_waitcnt lgkmcnt(0)
    s_barrier
    s_add_u32 m0, s48, 49152
    s_mov_b32 s22, 768
    buffer_load_dwordx4 v45, s[8:11], s22 offen  lds
    s_add_u32 m0, s48, 53248
    s_mov_b32 s22, 17152
    buffer_load_dwordx4 v45, s[8:11], s22 offen  lds
    s_add_u32 m0, s48, 57344
    s_mov_b32 s22, 33536
    buffer_load_dwordx4 v45, s[8:11], s22 offen  lds
    s_add_u32 m0, s48, 61440
    s_mov_b32 s22, 49920
    buffer_load_dwordx4 v45, s[8:11], s22 offen  lds
    s_waitcnt vmcnt(28)
    s_barrier
    v_and_b32 v254, 7, v0
    v_lshlrev_b32 v254, 5, v254
    buffer_load_dword v252, v254, s[88:91], 0 offen sc1
    buffer_load_dword v58, off, s[12:15], 0 offset:204 sc1
    v_add_u32 v48, 65536, v46
    ds_read_b64_tr_b16 a[192:193], v48 offset:0
    ds_read_b64_tr_b16 a[194:195], v48 offset:512
    ds_read_b64_tr_b16 a[196:197], v48 offset:8192
    ds_read_b64_tr_b16 a[198:199], v48 offset:8704
    ds_read_b64_tr_b16 a[200:201], v48 offset:8
    ds_read_b64_tr_b16 a[202:203], v48 offset:520
    ds_read_b64_tr_b16 a[204:205], v48 offset:8200
    ds_read_b64_tr_b16 a[206:207], v48 offset:8712
    s_waitcnt lgkmcnt(0)
    s_barrier
    s_add_u32 m0, s48, 65536
    s_mov_b32 s22, 131072
    buffer_load_dwordx4 v45, s[8:11], s22 offen  lds
    s_add_u32 m0, s48, 69632
    s_mov_b32 s22, 147456
    buffer_load_dwordx4 v45, s[8:11], s22 offen  lds
    s_add_u32 m0, s48, 73728
    s_mov_b32 s22, 163840
    buffer_load_dwordx4 v45, s[8:11], s22 offen  lds
    s_add_u32 m0, s48, 77824
    s_mov_b32 s22, 180224
    buffer_load_dwordx4 v45, s[8:11], s22 offen  lds
    s_waitcnt vmcnt(28)
    s_barrier
    v_add_u32 v48, 81920, v46
    ds_read_b64_tr_b16 a[208:209], v48 offset:0
    ds_read_b64_tr_b16 a[210:211], v48 offset:512
    ds_read_b64_tr_b16 a[212:213], v48 offset:8192
    ds_read_b64_tr_b16 a[214:215], v48 offset:8704
    ds_read_b64_tr_b16 a[216:217], v48 offset:8
    ds_read_b64_tr_b16 a[218:219], v48 offset:520
    ds_read_b64_tr_b16 a[220:221], v48 offset:8200
    ds_read_b64_tr_b16 a[222:223], v48 offset:8712
    s_waitcnt lgkmcnt(0)
    s_barrier
    s_add_u32 m0, s48, 81920
    s_mov_b32 s22, 131328
    buffer_load_dwordx4 v45, s[8:11], s22 offen  lds
    s_add_u32 m0, s48, 86016
    s_mov_b32 s22, 147712
    buffer_load_dwordx4 v45, s[8:11], s22 offen  lds
    s_add_u32 m0, s48, 90112
    s_mov_b32 s22, 164096
    buffer_load_dwordx4 v45, s[8:11], s22 offen  lds
    s_add_u32 m0, s48, 94208
    s_mov_b32 s22, 180480
    buffer_load_dwordx4 v45, s[8:11], s22 offen  lds
    s_waitcnt vmcnt(28)
    s_barrier
    v_add_u32 v48, 98304, v46
    ds_read_b64_tr_b16 a[224:225], v48 offset:0
    ds_read_b64_tr_b16 a[226:227], v48 offset:512
    ds_read_b64_tr_b16 a[228:229], v48 offset:8192
    ds_read_b64_tr_b16 a[230:231], v48 offset:8704
    ds_read_b64_tr_b16 a[232:233], v48 offset:8
    ds_read_b64_tr_b16 a[234:235], v48 offset:520
    ds_read_b64_tr_b16 a[236:237], v48 offset:8200
    ds_read_b64_tr_b16 a[238:239], v48 offset:8712
    s_waitcnt lgkmcnt(0)
    s_barrier
    s_add_u32 m0, s48, 98304
    s_mov_b32 s22, 131584
    buffer_load_dwordx4 v45, s[8:11], s22 offen  lds
    s_add_u32 m0, s48, 102400
    s_mov_b32 s22, 147968
    buffer_load_dwordx4 v45, s[8:11], s22 offen  lds
    s_add_u32 m0, s48, 106496
    s_mov_b32 s22, 164352
    buffer_load_dwordx4 v45, s[8:11], s22 offen  lds
    s_add_u32 m0, s48, 110592
    s_mov_b32 s22, 180736
    buffer_load_dwordx4 v45, s[8:11], s22 offen  lds
    s_waitcnt vmcnt(28)
    s_barrier
    v_add_u32 v48, 114688, v46
    ds_read_b64_tr_b16 a[240:241], v48 offset:0
    ds_read_b64_tr_b16 a[242:243], v48 offset:512
    ds_read_b64_tr_b16 a[244:245], v48 offset:8192
    ds_read_b64_tr_b16 a[246:247], v48 offset:8704
    ds_read_b64_tr_b16 a[248:249], v48 offset:8
    ds_read_b64_tr_b16 a[250:251], v48 offset:520
    ds_read_b64_tr_b16 a[252:253], v48 offset:8200
    ds_read_b64_tr_b16 a[254:255], v48 offset:8712
    s_waitcnt lgkmcnt(0)
    s_barrier
    s_add_u32 m0, s48, 114688
    s_mov_b32 s22, 131840
    buffer_load_dwordx4 v45, s[8:11], s22 offen  lds
    s_add_u32 m0, s48, 118784
    s_mov_b32 s22, 148224
    buffer_load_dwordx4 v45, s[8:11], s22 offen  lds
    s_add_u32 m0, s48, 122880
    s_mov_b32 s22, 164608
    buffer_load_dwordx4 v45, s[8:11], s22 offen  lds
    s_add_u32 m0, s48, 126976
    s_mov_b32 s22, 180992
    buffer_load_dwordx4 v45, s[8:11], s22 offen  lds
    s_waitcnt vmcnt(28)
    s_barrier
    s_cmp_lg_u32 s20, 0
    s_cbranch_scc1 mega_kernel_rf_wo0
    v_xor_b32 v48, 0, v47
    v_add_u32 v48, 0, v48
    ds_read_b64_tr_b16 v[128:129], v48 offset:0
    ds_read_b64_tr_b16 v[130:131], v48 offset:512
    ds_read_b64_tr_b16 v[132:133], v48 offset:8192
    ds_read_b64_tr_b16 v[134:135], v48 offset:8704
    ds_read_b64_tr_b16 v[144:145], v48 offset:32
    ds_read_b64_tr_b16 v[146:147], v48 offset:544
    ds_read_b64_tr_b16 v[148:149], v48 offset:8224
    ds_read_b64_tr_b16 v[150:151], v48 offset:8736
    s_waitcnt lgkmcnt(0)
    v_xor_b32 v48, 64, v47
    v_add_u32 v48, 0, v48
    ds_read_b64_tr_b16 v[160:161], v48 offset:0
    ds_read_b64_tr_b16 v[162:163], v48 offset:512
    ds_read_b64_tr_b16 v[164:165], v48 offset:8192
    ds_read_b64_tr_b16 v[166:167], v48 offset:8704
    ds_read_b64_tr_b16 v[176:177], v48 offset:32
    ds_read_b64_tr_b16 v[178:179], v48 offset:544
    ds_read_b64_tr_b16 v[180:181], v48 offset:8224
    ds_read_b64_tr_b16 v[182:183], v48 offset:8736
    s_waitcnt lgkmcnt(0)
    v_xor_b32 v48, 128, v47
    v_add_u32 v48, 0, v48
    ds_read_b64_tr_b16 v[192:193], v48 offset:0
    ds_read_b64_tr_b16 v[194:195], v48 offset:512
    ds_read_b64_tr_b16 v[196:197], v48 offset:8192
    ds_read_b64_tr_b16 v[198:199], v48 offset:8704
    ds_read_b64_tr_b16 v[80:81], v48 offset:32
    ds_read_b64_tr_b16 v[82:83], v48 offset:544
    ds_read_b64_tr_b16 v[84:85], v48 offset:8224
    ds_read_b64_tr_b16 v[86:87], v48 offset:8736
    s_waitcnt lgkmcnt(0)
    v_xor_b32 v48, 192, v47
    v_add_u32 v48, 0, v48
    ds_read_b64_tr_b16 v[96:97], v48 offset:0
    ds_read_b64_tr_b16 v[98:99], v48 offset:512
    ds_read_b64_tr_b16 v[100:101], v48 offset:8192
    ds_read_b64_tr_b16 v[102:103], v48 offset:8704
    ds_read_b64_tr_b16 v[112:113], v48 offset:32
    ds_read_b64_tr_b16 v[114:115], v48 offset:544
    ds_read_b64_tr_b16 v[116:117], v48 offset:8224
    ds_read_b64_tr_b16 v[118:119], v48 offset:8736
    s_waitcnt lgkmcnt(0)
mega_kernel_rf_wo0:
    s_barrier
    s_mov_b32 s8, s54
    s_mov_b32 s9, s55
    s_add_u32 m0, s48, 0
    s_mov_b32 s22, 0
    buffer_load_dwordx4 v44, s[8:11], s22 offen  lds
    s_add_u32 m0, s48, 4096
    s_mov_b32 s22, 32768
    buffer_load_dwordx4 v44, s[8:11], s22 offen  lds
    s_add_u32 m0, s48, 8192
    s_mov_b32 s22, 65536
    buffer_load_dwordx4 v44, s[8:11], s22 offen  lds
    s_add_u32 m0, s48, 12288
    s_mov_b32 s22, 98304
    buffer_load_dwordx4 v44, s[8:11], s22 offen  lds
    s_waitcnt vmcnt(28)
    s_barrier
    s_cmp_lg_u32 s20, 1
    s_cbranch_scc1 mega_kernel_rf_wo1
    v_xor_b32 v48, 0, v47
    v_add_u32 v48, 16384, v48
    ds_read_b64_tr_b16 v[128:129], v48 offset:0
    ds_read_b64_tr_b16 v[130:131], v48 offset:512
    ds_read_b64_tr_b16 v[132:133], v48 offset:8192
    ds_read_b64_tr_b16 v[134:135], v48 offset:8704
    ds_read_b64_tr_b16 v[144:145], v48 offset:32
    ds_read_b64_tr_b16 v[146:147], v48 offset:544
    ds_read_b64_tr_b16 v[148:149], v48 offset:8224
    ds_read_b64_tr_b16 v[150:151], v48 offset:8736
    s_waitcnt lgkmcnt(0)
    v_xor_b32 v48, 64, v47
    v_add_u32 v48, 16384, v48
    ds_read_b64_tr_b16 v[160:161], v48 offset:0
    ds_read_b64_tr_b16 v[162:163], v48 offset:512
    ds_read_b64_tr_b16 v[164:165], v48 offset:8192
    ds_read_b64_tr_b16 v[166:167], v48 offset:8704
    ds_read_b64_tr_b16 v[176:177], v48 offset:32
    ds_read_b64_tr_b16 v[178:179], v48 offset:544
    ds_read_b64_tr_b16 v[180:181], v48 offset:8224
    ds_read_b64_tr_b16 v[182:183], v48 offset:8736
    s_waitcnt lgkmcnt(0)
    v_xor_b32 v48, 128, v47
    v_add_u32 v48, 16384, v48
    ds_read_b64_tr_b16 v[192:193], v48 offset:0
    ds_read_b64_tr_b16 v[194:195], v48 offset:512
    ds_read_b64_tr_b16 v[196:197], v48 offset:8192
    ds_read_b64_tr_b16 v[198:199], v48 offset:8704
    ds_read_b64_tr_b16 v[80:81], v48 offset:32
    ds_read_b64_tr_b16 v[82:83], v48 offset:544
    ds_read_b64_tr_b16 v[84:85], v48 offset:8224
    ds_read_b64_tr_b16 v[86:87], v48 offset:8736
    s_waitcnt lgkmcnt(0)
    v_xor_b32 v48, 192, v47
    v_add_u32 v48, 16384, v48
    ds_read_b64_tr_b16 v[96:97], v48 offset:0
    ds_read_b64_tr_b16 v[98:99], v48 offset:512
    ds_read_b64_tr_b16 v[100:101], v48 offset:8192
    ds_read_b64_tr_b16 v[102:103], v48 offset:8704
    ds_read_b64_tr_b16 v[112:113], v48 offset:32
    ds_read_b64_tr_b16 v[114:115], v48 offset:544
    ds_read_b64_tr_b16 v[116:117], v48 offset:8224
    ds_read_b64_tr_b16 v[118:119], v48 offset:8736
    s_waitcnt lgkmcnt(0)
mega_kernel_rf_wo1:
    s_barrier
    s_add_u32 m0, s48, 16384
    s_mov_b32 s22, 524288
    buffer_load_dwordx4 v44, s[8:11], s22 offen  lds
    s_add_u32 m0, s48, 20480
    s_mov_b32 s22, 557056
    buffer_load_dwordx4 v44, s[8:11], s22 offen  lds
    s_add_u32 m0, s48, 24576
    s_mov_b32 s22, 589824
    buffer_load_dwordx4 v44, s[8:11], s22 offen  lds
    s_add_u32 m0, s48, 28672
    s_mov_b32 s22, 622592
    buffer_load_dwordx4 v44, s[8:11], s22 offen  lds
    s_waitcnt vmcnt(28)
    s_barrier
    s_cmp_lg_u32 s20, 2
    s_cbranch_scc1 mega_kernel_rf_wo2
    v_xor_b32 v48, 0, v47
    v_add_u32 v48, 32768, v48
    ds_read_b64_tr_b16 v[128:129], v48 offset:0
    ds_read_b64_tr_b16 v[130:131], v48 offset:512
    ds_read_b64_tr_b16 v[132:133], v48 offset:8192
    ds_read_b64_tr_b16 v[134:135], v48 offset:8704
    ds_read_b64_tr_b16 v[144:145], v48 offset:32
    ds_read_b64_tr_b16 v[146:147], v48 offset:544
    ds_read_b64_tr_b16 v[148:149], v48 offset:8224
    ds_read_b64_tr_b16 v[150:151], v48 offset:8736
    s_waitcnt lgkmcnt(0)
    v_xor_b32 v48, 64, v47
    v_add_u32 v48, 32768, v48
    ds_read_b64_tr_b16 v[160:161], v48 offset:0
    ds_read_b64_tr_b16 v[162:163], v48 offset:512
    ds_read_b64_tr_b16 v[164:165], v48 offset:8192
    ds_read_b64_tr_b16 v[166:167], v48 offset:8704
    ds_read_b64_tr_b16 v[176:177], v48 offset:32
    ds_read_b64_tr_b16 v[178:179], v48 offset:544
    ds_read_b64_tr_b16 v[180:181], v48 offset:8224
    ds_read_b64_tr_b16 v[182:183], v48 offset:8736
    s_waitcnt lgkmcnt(0)
    v_xor_b32 v48, 128, v47
    v_add_u32 v48, 32768, v48
    ds_read_b64_tr_b16 v[192:193], v48 offset:0
    ds_read_b64_tr_b16 v[194:195], v48 offset:512
    ds_read_b64_tr_b16 v[196:197], v48 offset:8192
    ds_read_b64_tr_b16 v[198:199], v48 offset:8704
    ds_read_b64_tr_b16 v[80:81], v48 offset:32
    ds_read_b64_tr_b16 v[82:83], v48 offset:544
    ds_read_b64_tr_b16 v[84:85], v48 offset:8224
    ds_read_b64_tr_b16 v[86:87], v48 offset:8736
    s_waitcnt lgkmcnt(0)
    v_xor_b32 v48, 192, v47
    v_add_u32 v48, 32768, v48
    ds_read_b64_tr_b16 v[96:97], v48 offset:0
    ds_read_b64_tr_b16 v[98:99], v48 offset:512
    ds_read_b64_tr_b16 v[100:101], v48 offset:8192
    ds_read_b64_tr_b16 v[102:103], v48 offset:8704
    ds_read_b64_tr_b16 v[112:113], v48 offset:32
    ds_read_b64_tr_b16 v[114:115], v48 offset:544
    ds_read_b64_tr_b16 v[116:117], v48 offset:8224
    ds_read_b64_tr_b16 v[118:119], v48 offset:8736
    s_waitcnt lgkmcnt(0)
mega_kernel_rf_wo2:
    s_barrier
    s_add_u32 m0, s48, 32768
    s_mov_b32 s22, 1048576
    buffer_load_dwordx4 v44, s[8:11], s22 offen  lds
    s_add_u32 m0, s48, 36864
    s_mov_b32 s22, 1081344
    buffer_load_dwordx4 v44, s[8:11], s22 offen  lds
    s_add_u32 m0, s48, 40960
    s_mov_b32 s22, 1114112
    buffer_load_dwordx4 v44, s[8:11], s22 offen  lds
    s_add_u32 m0, s48, 45056
    s_mov_b32 s22, 1146880
    buffer_load_dwordx4 v44, s[8:11], s22 offen  lds
    s_waitcnt vmcnt(28)
    s_barrier
    s_cmp_lg_u32 s20, 3
    s_cbranch_scc1 mega_kernel_rf_wo3
    v_xor_b32 v48, 0, v47
    v_add_u32 v48, 49152, v48
    ds_read_b64_tr_b16 v[128:129], v48 offset:0
    ds_read_b64_tr_b16 v[130:131], v48 offset:512
    ds_read_b64_tr_b16 v[132:133], v48 offset:8192
    ds_read_b64_tr_b16 v[134:135], v48 offset:8704
    ds_read_b64_tr_b16 v[144:145], v48 offset:32
    ds_read_b64_tr_b16 v[146:147], v48 offset:544
    ds_read_b64_tr_b16 v[148:149], v48 offset:8224
    ds_read_b64_tr_b16 v[150:151], v48 offset:8736
    s_waitcnt lgkmcnt(0)
    v_xor_b32 v48, 64, v47
    v_add_u32 v48, 49152, v48
    ds_read_b64_tr_b16 v[160:161], v48 offset:0
    ds_read_b64_tr_b16 v[162:163], v48 offset:512
    ds_read_b64_tr_b16 v[164:165], v48 offset:8192
    ds_read_b64_tr_b16 v[166:167], v48 offset:8704
    ds_read_b64_tr_b16 v[176:177], v48 offset:32
    ds_read_b64_tr_b16 v[178:179], v48 offset:544
    ds_read_b64_tr_b16 v[180:181], v48 offset:8224
    ds_read_b64_tr_b16 v[182:183], v48 offset:8736
    s_waitcnt lgkmcnt(0)
    v_xor_b32 v48, 128, v47
    v_add_u32 v48, 49152, v48
    ds_read_b64_tr_b16 v[192:193], v48 offset:0
    ds_read_b64_tr_b16 v[194:195], v48 offset:512
    ds_read_b64_tr_b16 v[196:197], v48 offset:8192
    ds_read_b64_tr_b16 v[198:199], v48 offset:8704
    ds_read_b64_tr_b16 v[80:81], v48 offset:32
    ds_read_b64_tr_b16 v[82:83], v48 offset:544
    ds_read_b64_tr_b16 v[84:85], v48 offset:8224
    ds_read_b64_tr_b16 v[86:87], v48 offset:8736
    s_waitcnt lgkmcnt(0)
    v_xor_b32 v48, 192, v47
    v_add_u32 v48, 49152, v48
    ds_read_b64_tr_b16 v[96:97], v48 offset:0
    ds_read_b64_tr_b16 v[98:99], v48 offset:512
    ds_read_b64_tr_b16 v[100:101], v48 offset:8192
    ds_read_b64_tr_b16 v[102:103], v48 offset:8704
    ds_read_b64_tr_b16 v[112:113], v48 offset:32
    ds_read_b64_tr_b16 v[114:115], v48 offset:544
    ds_read_b64_tr_b16 v[116:117], v48 offset:8224
    ds_read_b64_tr_b16 v[118:119], v48 offset:8736
    s_waitcnt lgkmcnt(0)
mega_kernel_rf_wo3:
    s_barrier
    s_add_u32 m0, s48, 49152
    s_mov_b32 s22, 1572864
    buffer_load_dwordx4 v44, s[8:11], s22 offen  lds
    s_add_u32 m0, s48, 53248
    s_mov_b32 s22, 1605632
    buffer_load_dwordx4 v44, s[8:11], s22 offen  lds
    s_add_u32 m0, s48, 57344
    s_mov_b32 s22, 1638400
    buffer_load_dwordx4 v44, s[8:11], s22 offen  lds
    s_add_u32 m0, s48, 61440
    s_mov_b32 s22, 1671168
    buffer_load_dwordx4 v44, s[8:11], s22 offen  lds
    s_waitcnt vmcnt(28)
    s_barrier
    s_cmp_lg_u32 s20, 0
    s_cbranch_scc1 mega_kernel_rf_wo4
    v_xor_b32 v48, 0, v47
    v_add_u32 v48, 65536, v48
    ds_read_b64_tr_b16 v[136:137], v48 offset:0
    ds_read_b64_tr_b16 v[138:139], v48 offset:512
    ds_read_b64_tr_b16 v[140:141], v48 offset:8192
    ds_read_b64_tr_b16 v[142:143], v48 offset:8704
    ds_read_b64_tr_b16 v[152:153], v48 offset:32
    ds_read_b64_tr_b16 v[154:155], v48 offset:544
    ds_read_b64_tr_b16 v[156:157], v48 offset:8224
    ds_read_b64_tr_b16 v[158:159], v48 offset:8736
    s_waitcnt lgkmcnt(0)
    v_xor_b32 v48, 64, v47
    v_add_u32 v48, 65536, v48
    ds_read_b64_tr_b16 v[168:169], v48 offset:0
    ds_read_b64_tr_b16 v[170:171], v48 offset:512
    ds_read_b64_tr_b16 v[172:173], v48 offset:8192
    ds_read_b64_tr_b16 v[174:175], v48 offset:8704
    ds_read_b64_tr_b16 v[184:185], v48 offset:32
    ds_read_b64_tr_b16 v[186:187], v48 offset:544
    ds_read_b64_tr_b16 v[188:189], v48 offset:8224
    ds_read_b64_tr_b16 v[190:191], v48 offset:8736
    s_waitcnt lgkmcnt(0)
    v_xor_b32 v48, 128, v47
    v_add_u32 v48, 65536, v48
    ds_read_b64_tr_b16 v[200:201], v48 offset:0
    ds_read_b64_tr_b16 v[202:203], v48 offset:512
    ds_read_b64_tr_b16 v[204:205], v48 offset:8192
    ds_read_b64_tr_b16 v[206:207], v48 offset:8704
    ds_read_b64_tr_b16 v[88:89], v48 offset:32
    ds_read_b64_tr_b16 v[90:91], v48 offset:544
    ds_read_b64_tr_b16 v[92:93], v48 offset:8224
    ds_read_b64_tr_b16 v[94:95], v48 offset:8736
    s_waitcnt lgkmcnt(0)
    v_xor_b32 v48, 192, v47
    v_add_u32 v48, 65536, v48
    ds_read_b64_tr_b16 v[104:105], v48 offset:0
    ds_read_b64_tr_b16 v[106:107], v48 offset:512
    ds_read_b64_tr_b16 v[108:109], v48 offset:8192
    ds_read_b64_tr_b16 v[110:111], v48 offset:8704
    ds_read_b64_tr_b16 v[120:121], v48 offset:32
    ds_read_b64_tr_b16 v[122:123], v48 offset:544
    ds_read_b64_tr_b16 v[124:125], v48 offset:8224
    ds_read_b64_tr_b16 v[126:127], v48 offset:8736
    s_waitcnt lgkmcnt(0)
mega_kernel_rf_wo4:
    s_barrier
    s_add_u32 m0, s48, 65536
    s_mov_b32 s22, 2097152
    buffer_load_dwordx4 v44, s[8:11], s22 offen  lds
    s_add_u32 m0, s48, 69632
    s_mov_b32 s22, 2129920
    buffer_load_dwordx4 v44, s[8:11], s22 offen  lds
    s_add_u32 m0, s48, 73728
    s_mov_b32 s22, 2162688
    buffer_load_dwordx4 v44, s[8:11], s22 offen  lds
    s_add_u32 m0, s48, 77824
    s_mov_b32 s22, 2195456
    buffer_load_dwordx4 v44, s[8:11], s22 offen  lds
    s_waitcnt vmcnt(28)
    s_barrier
    s_cmp_lg_u32 s20, 1
    s_cbranch_scc1 mega_kernel_rf_wo5
    v_xor_b32 v48, 0, v47
    v_add_u32 v48, 81920, v48
    ds_read_b64_tr_b16 v[136:137], v48 offset:0
    ds_read_b64_tr_b16 v[138:139], v48 offset:512
    ds_read_b64_tr_b16 v[140:141], v48 offset:8192
    ds_read_b64_tr_b16 v[142:143], v48 offset:8704
    ds_read_b64_tr_b16 v[152:153], v48 offset:32
    ds_read_b64_tr_b16 v[154:155], v48 offset:544
    ds_read_b64_tr_b16 v[156:157], v48 offset:8224
    ds_read_b64_tr_b16 v[158:159], v48 offset:8736
    s_waitcnt lgkmcnt(0)
    v_xor_b32 v48, 64, v47
    v_add_u32 v48, 81920, v48
    ds_read_b64_tr_b16 v[168:169], v48 offset:0
    ds_read_b64_tr_b16 v[170:171], v48 offset:512
    ds_read_b64_tr_b16 v[172:173], v48 offset:8192
    ds_read_b64_tr_b16 v[174:175], v48 offset:8704
    ds_read_b64_tr_b16 v[184:185], v48 offset:32
    ds_read_b64_tr_b16 v[186:187], v48 offset:544
    ds_read_b64_tr_b16 v[188:189], v48 offset:8224
    ds_read_b64_tr_b16 v[190:191], v48 offset:8736
    s_waitcnt lgkmcnt(0)
    v_xor_b32 v48, 128, v47
    v_add_u32 v48, 81920, v48
    ds_read_b64_tr_b16 v[200:201], v48 offset:0
    ds_read_b64_tr_b16 v[202:203], v48 offset:512
    ds_read_b64_tr_b16 v[204:205], v48 offset:8192
    ds_read_b64_tr_b16 v[206:207], v48 offset:8704
    ds_read_b64_tr_b16 v[88:89], v48 offset:32
    ds_read_b64_tr_b16 v[90:91], v48 offset:544
    ds_read_b64_tr_b16 v[92:93], v48 offset:8224
    ds_read_b64_tr_b16 v[94:95], v48 offset:8736
    s_waitcnt lgkmcnt(0)
    v_xor_b32 v48, 192, v47
    v_add_u32 v48, 81920, v48
    ds_read_b64_tr_b16 v[104:105], v48 offset:0
    ds_read_b64_tr_b16 v[106:107], v48 offset:512
    ds_read_b64_tr_b16 v[108:109], v48 offset:8192
    ds_read_b64_tr_b16 v[110:111], v48 offset:8704
    ds_read_b64_tr_b16 v[120:121], v48 offset:32
    ds_read_b64_tr_b16 v[122:123], v48 offset:544
    ds_read_b64_tr_b16 v[124:125], v48 offset:8224
    ds_read_b64_tr_b16 v[126:127], v48 offset:8736
    s_waitcnt lgkmcnt(0)
mega_kernel_rf_wo5:
    s_barrier
    s_add_u32 m0, s48, 81920
    s_mov_b32 s22, 2621440
    buffer_load_dwordx4 v44, s[8:11], s22 offen  lds
    s_add_u32 m0, s48, 86016
    s_mov_b32 s22, 2654208
    buffer_load_dwordx4 v44, s[8:11], s22 offen  lds
    s_add_u32 m0, s48, 90112
    s_mov_b32 s22, 2686976
    buffer_load_dwordx4 v44, s[8:11], s22 offen  lds
    s_add_u32 m0, s48, 94208
    s_mov_b32 s22, 2719744
    buffer_load_dwordx4 v44, s[8:11], s22 offen  lds
    s_waitcnt vmcnt(28)
    s_barrier
    s_cmp_lg_u32 s97, 0
    s_cbranch_scc1 mega_kernel_h2_1_ok
mega_kernel_h2_1_ev:
    v_cmp_ne_u32 vcc, 32, v252
    s_cbranch_vccz mega_kernel_h2_1_ok
    s_mov_b32 s78, 0
    v_readlane_b32 s81, v252, 0
    s_nop 3
    s_add_u32 s78, s78, s81
    v_readlane_b32 s81, v252, 1
    s_nop 3
    s_add_u32 s78, s78, s81
    v_readlane_b32 s81, v252, 2
    s_nop 3
    s_add_u32 s78, s78, s81
    v_readlane_b32 s81, v252, 3
    s_nop 3
    s_add_u32 s78, s78, s81
    v_readlane_b32 s81, v252, 4
    s_nop 3
    s_add_u32 s78, s78, s81
    v_readlane_b32 s81, v252, 5
    s_nop 3
    s_add_u32 s78, s78, s81
    v_readlane_b32 s81, v252, 6
    s_nop 3
    s_add_u32 s78, s78, s81
    v_readlane_b32 s81, v252, 7
    s_nop 3
    s_add_u32 s78, s78, s81
    s_cmp_eq_u32 s78, 256
    s_cbranch_scc1 mega_kernel_redo
    buffer_load_dword v252, v254, s[88:91], 0 offen sc1
    s_waitcnt vmcnt(0)
    s_branch mega_kernel_h2_1_ev
mega_kernel_h2_1_ok:
    s_cmp_lg_u32 s20, 2
    s_cbranch_scc1 mega_kernel_rf_wo6
    v_xor_b32 v48, 0, v47
    v_add_u32 v48, 98304, v48
    ds_read_b64_tr_b16 v[136:137], v48 offset:0
    ds_read_b64_tr_b16 v[138:139], v48 offset:512
    ds_read_b64_tr_b16 v[140:141], v48 offset:8192
    ds_read_b64_tr_b16 v[142:143], v48 offset:8704
    ds_read_b64_tr_b16 v[152:153], v48 offset:32
    ds_read_b64_tr_b16 v[154:155], v48 offset:544
    ds_read_b64_tr_b16 v[156:157], v48 offset:8224
    ds_read_b64_tr_b16 v[158:159], v48 offset:8736
    s_waitcnt lgkmcnt(0)
    v_xor_b32 v48, 64, v47
    v_add_u32 v48, 98304, v48
    ds_read_b64_tr_b16 v[168:169], v48 offset:0
    ds_read_b64_tr_b16 v[170:171], v48 offset:512
    ds_read_b64_tr_b16 v[172:173], v48 offset:8192
    ds_read_b64_tr_b16 v[174:175], v48 offset:8704
    ds_read_b64_tr_b16 v[184:185], v48 offset:32
    ds_read_b64_tr_b16 v[186:187], v48 offset:544
    ds_read_b64_tr_b16 v[188:189], v48 offset:8224
    ds_read_b64_tr_b16 v[190:191], v48 offset:8736
    s_waitcnt lgkmcnt(0)
    v_xor_b32 v48, 128, v47
    v_add_u32 v48, 98304, v48
    ds_read_b64_tr_b16 v[200:201], v48 offset:0
    ds_read_b64_tr_b16 v[202:203], v48 offset:512
    ds_read_b64_tr_b16 v[204:205], v48 offset:8192
    ds_read_b64_tr_b16 v[206:207], v48 offset:8704
    ds_read_b64_tr_b16 v[88:89], v48 offset:32
    ds_read_b64_tr_b16 v[90:91], v48 offset:544
    ds_read_b64_tr_b16 v[92:93], v48 offset:8224
    ds_read_b64_tr_b16 v[94:95], v48 offset:8736
    s_waitcnt lgkmcnt(0)
    v_xor_b32 v48, 192, v47
    v_add_u32 v48, 98304, v48
    ds_read_b64_tr_b16 v[104:105], v48 offset:0
    ds_read_b64_tr_b16 v[106:107], v48 offset:512
    ds_read_b64_tr_b16 v[108:109], v48 offset:8192
    ds_read_b64_tr_b16 v[110:111], v48 offset:8704
    ds_read_b64_tr_b16 v[120:121], v48 offset:32
    ds_read_b64_tr_b16 v[122:123], v48 offset:544
    ds_read_b64_tr_b16 v[124:125], v48 offset:8224
    ds_read_b64_tr_b16 v[126:127], v48 offset:8736
    s_waitcnt lgkmcnt(0)
mega_kernel_rf_wo6:
    s_barrier
    s_add_u32 m0, s48, 98304
    s_mov_b32 s22, 3145728
    buffer_load_dwordx4 v44, s[8:11], s22 offen  lds
    s_add_u32 m0, s48, 102400
    s_mov_b32 s22, 3178496
    buffer_load_dwordx4 v44, s[8:11], s22 offen  lds
    s_add_u32 m0, s48, 106496
    s_mov_b32 s22, 3211264
    buffer_load_dwordx4 v44, s[8:11], s22 offen  lds
    s_add_u32 m0, s48, 110592
    s_mov_b32 s22, 3244032
    buffer_load_dwordx4 v44, s[8:11], s22 offen  lds
    s_waitcnt vmcnt(28)
    s_barrier
    s_cmp_lg_u32 s20, 3
    s_cbranch_scc1 mega_kernel_rf_wo7
    v_xor_b32 v48, 0, v47
    v_add_u32 v48, 114688, v48
    ds_read_b64_tr_b16 v[136:137], v48 offset:0
    ds_read_b64_tr_b16 v[138:139], v48 offset:512
    ds_read_b64_tr_b16 v[140:141], v48 offset:8192
    ds_read_b64_tr_b16 v[142:143], v48 offset:8704
    ds_read_b64_tr_b16 v[152:153], v48 offset:32
    ds_read_b64_tr_b16 v[154:155], v48 offset:544
    ds_read_b64_tr_b16 v[156:157], v48 offset:8224
    ds_read_b64_tr_b16 v[158:159], v48 offset:8736
    s_waitcnt lgkmcnt(0)
    v_xor_b32 v48, 64, v47
    v_add_u32 v48, 114688, v48
    ds_read_b64_tr_b16 v[168:169], v48 offset:0
    ds_read_b64_tr_b16 v[170:171], v48 offset:512
    ds_read_b64_tr_b16 v[172:173], v48 offset:8192
    ds_read_b64_tr_b16 v[174:175], v48 offset:8704
    ds_read_b64_tr_b16 v[184:185], v48 offset:32
    ds_read_b64_tr_b16 v[186:187], v48 offset:544
    ds_read_b64_tr_b16 v[188:189], v48 offset:8224
    ds_read_b64_tr_b16 v[190:191], v48 offset:8736
    s_waitcnt lgkmcnt(0)
    v_xor_b32 v48, 128, v47
    v_add_u32 v48, 114688, v48
    ds_read_b64_tr_b16 v[200:201], v48 offset:0
    ds_read_b64_tr_b16 v[202:203], v48 offset:512
    ds_read_b64_tr_b16 v[204:205], v48 offset:8192
    ds_read_b64_tr_b16 v[206:207], v48 offset:8704
    ds_read_b64_tr_b16 v[88:89], v48 offset:32
    ds_read_b64_tr_b16 v[90:91], v48 offset:544
    ds_read_b64_tr_b16 v[92:93], v48 offset:8224
    ds_read_b64_tr_b16 v[94:95], v48 offset:8736
    s_waitcnt lgkmcnt(0)
    v_xor_b32 v48, 192, v47
    v_add_u32 v48, 114688, v48
    ds_read_b64_tr_b16 v[104:105], v48 offset:0
    ds_read_b64_tr_b16 v[106:107], v48 offset:512
    ds_read_b64_tr_b16 v[108:109], v48 offset:8192
    ds_read_b64_tr_b16 v[110:111], v48 offset:8704
    ds_read_b64_tr_b16 v[120:121], v48 offset:32
    ds_read_b64_tr_b16 v[122:123], v48 offset:544
    ds_read_b64_tr_b16 v[124:125], v48 offset:8224
    ds_read_b64_tr_b16 v[126:127], v48 offset:8736
    s_waitcnt lgkmcnt(0)
mega_kernel_rf_wo7:
    s_barrier
    s_add_u32 m0, s48, 114688
    s_mov_b32 s22, 3670016
    buffer_load_dwordx4 v44, s[8:11], s22 offen  lds
    s_add_u32 m0, s48, 118784
    s_mov_b32 s22, 3702784
    buffer_load_dwordx4 v44, s[8:11], s22 offen  lds
    s_add_u32 m0, s48, 122880
    s_mov_b32 s22, 3735552
    buffer_load_dwordx4 v44, s[8:11], s22 offen  lds
    s_add_u32 m0, s48, 126976
    s_mov_b32 s22, 3768320
    buffer_load_dwordx4 v44, s[8:11], s22 offen  lds
    s_waitcnt vmcnt(28)
    s_barrier
    v_add_u32 v48, 0, v46
    ds_read_b64_tr_b16 v[64:65], v48 offset:0
    ds_read_b64_tr_b16 v[66:67], v48 offset:512
    ds_read_b64_tr_b16 v[68:69], v48 offset:8192
    ds_read_b64_tr_b16 v[70:71], v48 offset:8704
    ds_read_b64_tr_b16 v[72:73], v48 offset:8
    ds_read_b64_tr_b16 v[74:75], v48 offset:520
    ds_read_b64_tr_b16 v[76:77], v48 offset:8200
    ds_read_b64_tr_b16 v[78:79], v48 offset:8712
    s_waitcnt lgkmcnt(0)
    s_barrier
    ds_write_b128 v32, v[64:67] offset:0
    ds_write_b128 v32, v[68:71] offset:1024
    ds_write_b128 v32, v[72:75] offset:2048
    ds_write_b128 v32, v[76:79] offset:3072
    s_waitcnt lgkmcnt(0)
    s_waitcnt vmcnt(24)
    s_barrier
    v_add_u32 v48, 16384, v46
    ds_read_b64_tr_b16 v[64:65], v48 offset:0
    ds_read_b64_tr_b16 v[66:67], v48 offset:512
    ds_read_b64_tr_b16 v[68:69], v48 offset:8192
    ds_read_b64_tr_b16 v[70:71], v48 offset:8704
    ds_read_b64_tr_b16 v[72:73], v48 offset:8
    ds_read_b64_tr_b16 v[74:75], v48 offset:520
    ds_read_b64_tr_b16 v[76:77], v48 offset:8200
    ds_read_b64_tr_b16 v[78:79], v48 offset:8712
    s_waitcnt lgkmcnt(0)
    s_barrier
    ds_write_b128 v32, v[64:67] offset:16384
    ds_write_b128 v32, v[68:71] offset:17408
    ds_write_b128 v32, v[72:75] offset:18432
    ds_write_b128 v32, v[76:79] offset:19456
    s_waitcnt lgkmcnt(0)
    s_waitcnt vmcnt(20)
    s_barrier
    s_getpc_b64 s[16:17]
mega_kernel_rf_pc0:
    s_add_u32 s16, s16, mega_kernel_rf_w0_entry - mega_kernel_rf_pc0
    s_addc_u32 s17, s17, 0
    v_lshlrev_b32 v49, 7, v0
    v_min_u32 v49, mega_kernel_rf_end - mega_kernel_rf_w0_entry, v49
    global_load_dword v50, v49, s[16:17]
    v_lshlrev_b32 v49, 7, v40
    s_xor_b32 s23, s35, 16384
    s_cmp_eq_u32 s20, 1
    s_cselect_b32 s22, s35, s47
    s_cmp_eq_u32 s20, 2
    s_cselect_b32 s22, s23, s22
    s_lshl_b32 s23, s31, 13
    s_add_u32 s23, s23, 178257920
    s_cmp_eq_u32 s20, 3
    s_cselect_b32 s22, s23, s22
    buffer_load_dword v51, v49, s[4:7], s22 offen sc1
    v_lshlrev_b32 v49, 13, v0
    v_and_b32 v49, 0x1fffff, v49
    s_mov_b32 s22, 67108864
    buffer_load_dword v52, v49, s[4:7], s22 offen sc1
    buffer_load_dword v57, v7, s[4:7], 0 offen sc1
    v_add_u32 v48, 32768, v46
    ds_read_b64_tr_b16 v[64:65], v48 offset:0
    ds_read_b64_tr_b16 v[66:67], v48 offset:512
    ds_read_b64_tr_b16 v[68:69], v48 offset:8192
    ds_read_b64_tr_b16 v[70:71], v48 offset:8704
    ds_read_b64_tr_b16 v[72:73], v48 offset:8
    ds_read_b64_tr_b16 v[74:75], v48 offset:520
    ds_read_b64_tr_b16 v[76:77], v48 offset:8200
    ds_read_b64_tr_b16 v[78:79], v48 offset:8712
    s_waitcnt lgkmcnt(0)
    s_barrier
    ds_write_b128 v32, v[64:67] offset:32768
    ds_write_b128 v32, v[68:71] offset:33792
    ds_write_b128 v32, v[72:75] offset:34816
    ds_write_b128 v32, v[76:79] offset:35840
    s_waitcnt lgkmcnt(0)
    s_waitcnt vmcnt(16)
    s_barrier
    v_add_u32 v48, 49152, v46
    ds_read_b64_tr_b16 v[64:65], v48 offset:0
    ds_read_b64_tr_b16 v[66:67], v48 offset:512
    ds_read_b64_tr_b16 v[68:69], v48 offset:8192
    ds_read_b64_tr_b16 v[70:71], v48 offset:8704
    ds_read_b64_tr_b16 v[72:73], v48 offset:8
    ds_read_b64_tr_b16 v[74:75], v48 offset:520
    ds_read_b64_tr_b16 v[76:77], v48 offset:8200
    ds_read_b64_tr_b16 v[78:79], v48 offset:8712
    s_waitcnt lgkmcnt(0)
    s_barrier
    ds_write_b128 v32, v[64:67] offset:49152
    ds_write_b128 v32, v[68:71] offset:50176
    ds_write_b128 v32, v[72:75] offset:51200
    ds_write_b128 v32, v[76:79] offset:52224
    s_waitcnt lgkmcnt(0)
    s_waitcnt vmcnt(12)
    s_barrier
    v_add_u32 v48, 65536, v46
    ds_read_b64_tr_b16 v[64:65], v48 offset:0
    ds_read_b64_tr_b16 v[66:67], v48 offset:512
    ds_read_b64_tr_b16 v[68:69], v48 offset:8192
    ds_read_b64_tr_b16 v[70:71], v48 offset:8704
    ds_read_b64_tr_b16 v[72:73], v48 offset:8
    ds_read_b64_tr_b16 v[74:75], v48 offset:520
    ds_read_b64_tr_b16 v[76:77], v48 offset:8200
    ds_read_b64_tr_b16 v[78:79], v48 offset:8712
    s_waitcnt lgkmcnt(0)
    s_barrier
    ds_write_b128 v33, v[64:67] offset:0
    ds_write_b128 v33, v[68:71] offset:1024
    ds_write_b128 v33, v[72:75] offset:2048
    ds_write_b128 v33, v[76:79] offset:3072
    s_waitcnt lgkmcnt(0)
    s_waitcnt vmcnt(8)
    s_barrier
    v_add_u32 v48, 81920, v46
    ds_read_b64_tr_b16 v[208:209], v48 offset:0
    ds_read_b64_tr_b16 v[210:211], v48 offset:512
    ds_read_b64_tr_b16 v[212:213], v48 offset:8192
    ds_read_b64_tr_b16 v[214:215], v48 offset:8704
    ds_read_b64_tr_b16 v[216:217], v48 offset:8
    ds_read_b64_tr_b16 v[218:219], v48 offset:520
    ds_read_b64_tr_b16 v[220:221], v48 offset:8200
    ds_read_b64_tr_b16 v[222:223], v48 offset:8712
    s_waitcnt lgkmcnt(0)
    s_barrier
    ds_write_b128 v33, v[80:83] offset:16384
    ds_write_b128 v33, v[84:87] offset:17408
    ds_write_b128 v33, v[88:91] offset:18432
    ds_write_b128 v33, v[92:95] offset:19456
    s_waitcnt lgkmcnt(0)
    s_waitcnt vmcnt(4)
    s_barrier
    v_add_u32 v48, 98304, v46
    ds_read_b64_tr_b16 v[224:225], v48 offset:0
    ds_read_b64_tr_b16 v[226:227], v48 offset:512
    ds_read_b64_tr_b16 v[228:229], v48 offset:8192
    ds_read_b64_tr_b16 v[230:231], v48 offset:8704
    ds_read_b64_tr_b16 v[232:233], v48 offset:8
    ds_read_b64_tr_b16 v[234:235], v48 offset:520
    ds_read_b64_tr_b16 v[236:237], v48 offset:8200
    ds_read_b64_tr_b16 v[238:239], v48 offset:8712
    s_waitcnt lgkmcnt(0)
    s_barrier
    ds_write_b128 v33, v[96:99] offset:32768
    ds_write_b128 v33, v[100:103] offset:33792
    ds_write_b128 v33, v[104:107] offset:34816
    ds_write_b128 v33, v[108:111] offset:35840
    s_waitcnt lgkmcnt(0)
    s_waitcnt vmcnt(0)
    s_barrier
    v_add_u32 v48, 114688, v46
    ds_read_b64_tr_b16 v[240:241], v48 offset:0
    ds_read_b64_tr_b16 v[242:243], v48 offset:512
    ds_read_b64_tr_b16 v[244:245], v48 offset:8192
    ds_read_b64_tr_b16 v[246:247], v48 offset:8704
    ds_read_b64_tr_b16 v[248:249], v48 offset:8
    ds_read_b64_tr_b16 v[250:251], v48 offset:520
    ds_read_b64_tr_b16 v[252:253], v48 offset:8200
    ds_read_b64_tr_b16 v[254:255], v48 offset:8712
    s_waitcnt lgkmcnt(0)
    s_barrier
    ds_write_b128 v33, v[112:115] offset:49152
    ds_write_b128 v33, v[116:119] offset:50176
    ds_write_b128 v33, v[120:123] offset:51200
    ds_write_b128 v33, v[124:127] offset:52224
    s_waitcnt lgkmcnt(0)
    s_branch mega_kernel_rf_iw1
mega_kernel_rf_iw:
    buffer_load_dword v58, off, s[12:15], 0 offset:204 sc1
    s_waitcnt vmcnt(0)
mega_kernel_rf_iw1:
    v_and_b32 v50, 0xffff, v58
    v_readfirstlane_b32 s60, v58
    v_cmp_ne_u32 vcc, s100, v50
    s_cbranch_vccnz mega_kernel_rf_iw
    s_lshr_b32 s60, s60, 15
    s_cmp_gt_u32 s60, s100
    s_cselect_b32 s60, 8192, 0
    s_bfe_u32 s22, s31, 0x10001
    s_lshl_b32 s22, s22, 12
    s_add_u32 s22, s22, s60
    s_lshl_b32 s23, s20, 10
    s_add_u32 s22, s22, s23
    s_add_u32 s38, s38, s22
    s_add_u32 s37, s37, s22
    s_xor_b32 s40, s38, 4096
    s_xor_b32 s39, s37, 4096
    s_xor_b32 s36, s35, 16384
    s_mov_b32 s21, 0
    s_cmp_eq_u32 s30, 0
    s_mov_b32 s22, 0x33003300
    s_cselect_b32 s16, 0x00330033, s22
    s_mov_b32 s17, s16
    s_cselect_b32 s18, -1, 0
    s_not_b32 s19, s18
    s_lshl_b32 s22, s31, 13
    s_lshl_b32 s23, s20, 11
    s_add_u32 s22, s22, s23
    s_add_u32 s43, s22, 16777216
    s_add_u32 s44, s22, 33554432
    s_lshl_b32 s45, s31, 13
    s_add_u32 s45, s45, 178257920
    s_mul_i32 s48, s20, 3072
    s_add_u32 m0, s48, 140288
    s_mov_b32 s41, 1
    s_mov_b32 s42, 1
    v_mov_b32 v0, v34
    v_bfrev_b32 v12, 1
    v_bfrev_b32 v3, 1
    v_cndmask_b32 v10, v3, v10, s[16:17]
    v_cndmask_b32 v9, v3, v9, s[26:27]
    s_sub_u32 s45, s45, 0
    s_lshl_b32 s51, s30, 11
    s_add_u32 s51, s51, s45
    s_mov_b32 s50, 0
    s_cmp_lg_u32 s20, 3
    s_cbranch_scc1 mega_kernel_rf_kv0
    v_readlane_b32 s50, v57, 0
    v_readlane_b32 s22, v57, 2
    v_readlane_b32 s23, v57, 1
    v_readlane_b32 s24, v57, 3
    s_nop 3
    s_min_u32 s50, s50, s22
    s_min_u32 s23, s23, s24
    s_lshl_b32 s50, s50, 1
    s_lshl_b32 s23, s23, 1
    s_add_u32 s23, s23, 1
    s_min_u32 s50, s50, s23
mega_kernel_rf_kvb0:
    s_add_u32 s22, s21, 1
    s_min_u32 s22, s22, 63
    s_cmp_gt_u32 s50, s22
    s_cbranch_scc1 mega_kernel_rf_kvd0
    buffer_load_dword v48, v7, s[4:7], 0 offen sc1
    s_waitcnt vmcnt(0)
    v_readlane_b32 s50, v48, 0
    v_readlane_b32 s22, v48, 2
    v_readlane_b32 s23, v48, 1
    v_readlane_b32 s24, v48, 3
    s_nop 3
    s_min_u32 s50, s50, s22
    s_min_u32 s23, s23, s24
    s_lshl_b32 s50, s50, 1
    s_lshl_b32 s23, s23, 1
    s_add_u32 s23, s23, 1
    s_min_u32 s50, s50, s23
    s_branch mega_kernel_rf_kvb0
mega_kernel_rf_kvd0:
mega_kernel_rf_kv0:
    s_barrier
    s_cmp_eq_u32 s20, 1
    s_cbranch_scc1 mega_kernel_rf_w1_entry
    s_cmp_eq_u32 s20, 2
    s_cbranch_scc1 mega_kernel_rf_w2_entry
    s_cmp_eq_u32 s20, 3
    s_cbranch_scc1 mega_kernel_rf_w3_entry
mega_kernel_rf_w0_entry:
    v_mfma_f32_32x32x8_bf16 v[96:111], v[14:15], v[14:15], 0
    v_mfma_f32_16x16x16_bf16 v[112:115], v[14:15], v[14:15], 0
    v_mfma_f32_16x16x16_bf16 v[116:119], v[14:15], v[14:15], 0
    ds_read_b128 v[64:67], v1 offset:0
    ds_read_b128 v[68:71], v1 offset:1024
    ds_read_b128 v[72:75], v1 offset:2048
    ds_read_b128 v[76:79], v1 offset:3072
    ds_read_b128 v[80:83], v1 offset:16384
    ds_read_b128 v[84:87], v1 offset:17408
    ds_read_b128 v[88:91], v1 offset:18432
    ds_read_b128 v[92:95], v1 offset:19456
    buffer_load_dwordx4 v[120:123], v1, s[4:7], s44 offen
    buffer_load_dwordx4 v[124:127], v1, s[4:7], s44 offen offset:1024
    s_add_u32 s44, s44, 262144
mega_kernel_rf_w0_loop:
    s_add_u32 s22, s35, 0
    s_waitcnt vmcnt(0)
    buffer_load_dwordx4 v[32:35], v1, s[4:7], s22 offen sc1
    buffer_load_dwordx4 v[36:39], v1, s[4:7], s22 offen offset:1024 sc1
mega_kernel_rf_w0_pa:
    s_waitcnt vmcnt(1)
    ds_write_b128 v6, v[32:35] offset:0
    s_waitcnt vmcnt(0)
    ds_write_b128 v6, v[36:39] offset:1024
    v_max3_u32 v3, v32, v34, v36
    v_max_u32 v3, v3, v38
    v_cmp_eq_u32 vcc, -1, v3
    v_smfmac_f32_16x16x64_bf16 v[96:99], v[32:35], a[0:7], v2
    buffer_load_dwordx4 v[32:35], v1, s[4:7], s22 offen sc1
    v_smfmac_f32_16x16x64_bf16 v[100:103], v[32:35], a[8:15], v2
    buffer_load_dwordx4 v[36:39], v1, s[4:7], s22 offen offset:1024 sc1
    v_smfmac_f32_16x16x64_bf16 v[104:107], v[32:35], a[128:135], v2
    s_cbranch_vccnz mega_kernel_rf_w0_pafail
    s_waitcnt lgkmcnt(0)
    s_barrier
    ds_read_b128 v[40:43], v6 offset:2048
    ds_read_b128 v[44:47], v6 offset:3072
    v_smfmac_f32_16x16x64_bf16 v[108:111], v[32:35], a[136:143], v2
    ds_read_b128 v[48:51], v6 offset:4096
    v_smfmac_f32_16x16x64_bf16 v[96:99], v[36:39], a[16:23], v2
    ds_read_b128 v[52:55], v6 offset:5120
    v_smfmac_f32_16x16x64_bf16 v[100:103], v[36:39], a[24:31], v2
    ds_read_b128 v[56:59], v6 offset:6144
    v_smfmac_f32_16x16x64_bf16 v[104:107], v[36:39], a[144:151], v2
    ds_read_b128 v[60:63], v6 offset:7168
    v_smfmac_f32_16x16x64_bf16 v[108:111], v[36:39], a[152:159], v2
    buffer_load_dwordx4 v1, s[4:7], s43 offen lds
    s_waitcnt lgkmcnt(5)
    v_smfmac_f32_16x16x64_bf16 v[96:99], v[40:43], a[32:39], v2
    v_smfmac_f32_16x16x64_bf16 v[104:107], v[40:43], a[160:167], v2
    s_waitcnt lgkmcnt(4)
    v_smfmac_f32_16x16x64_bf16 v[96:99], v[44:47], a[48:55], v2
    v_smfmac_f32_16x16x64_bf16 v[104:107], v[44:47], a[176:183], v2
    buffer_load_dwordx4 v1, s[4:7], s43 offen offset:1024 lds
    s_waitcnt lgkmcnt(3)
    v_smfmac_f32_16x16x64_bf16 v[96:99], v[48:51], a[64:71], v2
    v_smfmac_f32_16x16x64_bf16 v[104:107], v[48:51], a[192:199], v2
    s_waitcnt lgkmcnt(2)
    v_smfmac_f32_16x16x64_bf16 v[96:99], v[52:55], a[80:87], v2
    v_smfmac_f32_16x16x64_bf16 v[104:107], v[52:55], a[208:215], v2
    v_mov_b32 v4, s21
    buffer_store_dword v4, v7, s[4:7], 0 offen sc1
    s_waitcnt lgkmcnt(1)
    v_smfmac_f32_16x16x64_bf16 v[96:99], v[56:59], a[96:103], v2
    v_smfmac_f32_16x16x64_bf16 v[104:107], v[56:59], a[224:231], v2
    s_waitcnt lgkmcnt(0)
    v_smfmac_f32_16x16x64_bf16 v[96:99], v[60:63], a[112:119], v2
    v_smfmac_f32_16x16x64_bf16 v[104:107], v[60:63], a[240:247], v2
    v_smfmac_f32_16x16x64_bf16 v[100:103], v[40:43], a[40:47], v2
    s_nop 2
    v_smfmac_f32_16x16x64_bf16 v[100:103], v[44:47], a[56:63], v2
    s_nop 2
    v_smfmac_f32_16x16x64_bf16 v[100:103], v[48:51], a[72:79], v2
    v_add_f32 v96, v96, v98
    v_add_f32 v97, v97, v99
    v_smfmac_f32_16x16x64_bf16 v[100:103], v[52:55], a[88:95], v2
    v_add_f32 v104, v104, v106
    v_add_f32 v105, v105, v107
    v_smfmac_f32_16x16x64_bf16 v[100:103], v[56:59], a[104:111], v2
    v_cvt_pk_bf16_f32 v96, v96, v97
    v_cvt_pk_bf16_f32 v97, v104, v105
    v_smfmac_f32_16x16x64_bf16 v[100:103], v[60:63], a[120:127], v2
    v_and_or_b32 v96, v96, -2, s41
    buffer_store_dwordx2 v[96:97], v11, s[4:7], s37 offen sc1
    v_smfmac_f32_16x16x64_bf16 v[108:111], v[40:43], a[168:175], v2
    v_smfmac_f32_16x16x64_bf16 v[108:111], v[44:47], a[184:191], v2
    v_smfmac_f32_16x16x64_bf16 v[108:111], v[48:51], a[200:207], v2
    v_smfmac_f32_16x16x64_bf16 v[108:111], v[52:55], a[216:223], v2
    v_smfmac_f32_16x16x64_bf16 v[108:111], v[56:59], a[232:239], v2
    s_nop 2
    v_add_f32 v100, v100, v102
    v_smfmac_f32_16x16x64_bf16 v[108:111], v[60:63], a[248:255], v2
    v_add_f32 v101, v101, v103
    v_cvt_pk_bf16_f32 v98, v100, v101
    v_and_or_b32 v98, v98, -2, s41
    s_nop 4
    v_pk_add_f32 v[108:109], v[108:109], v[110:111]
    v_cvt_pk_bf16_f32 v99, v108, v109
    buffer_store_dwordx2 v[98:99], v11, s[4:7], s37 offen offset:512 sc1
    v_smfmac_f32_16x16x64_bf16 v[112:115], v[32:35], v[64:71], v2
    ds_read_b128 v[64:67], v1 offset:32768
    ds_read_b128 v[68:71], v1 offset:33792
    v_smfmac_f32_16x16x64_bf16 v[116:119], v[32:35], v[72:79], v2
    ds_read_b128 v[72:75], v1 offset:34816
    ds_read_b128 v[76:79], v1 offset:35840
    v_smfmac_f32_16x16x64_bf16 v[112:115], v[36:39], v[80:87], v2
    ds_read_b128 v[80:83], v1 offset:49152
    ds_read_b128 v[84:87], v1 offset:50176
    v_smfmac_f32_16x16x64_bf16 v[116:119], v[36:39], v[88:95], v2
    ds_read_b128 v[88:91], v1 offset:51200
    ds_read_b128 v[92:95], v1 offset:52224
    v_smfmac_f32_16x16x64_bf16 v[112:115], v[52:55], v[208:215], v2
    v_smfmac_f32_16x16x64_bf16 v[116:119], v[52:55], v[216:223], v2
    v_smfmac_f32_16x16x64_bf16 v[112:115], v[56:59], v[224:231], v2
    s_waitcnt lgkmcnt(6)
    v_smfmac_f32_16x16x64_bf16 v[112:115], v[40:43], v[64:71], v2
    ds_read_b128 v[64:67], v5 offset:0
    ds_read_b128 v[68:71], v5 offset:1024
    s_waitcnt lgkmcnt(6)
    v_smfmac_f32_16x16x64_bf16 v[116:119], v[40:43], v[72:79], v2
    ds_read_b128 v[72:75], v5 offset:2048
    ds_read_b128 v[76:79], v5 offset:3072
    v_smfmac_f32_16x16x64_bf16 v[116:119], v[56:59], v[232:239], v2
    v_smfmac_f32_16x16x64_bf16 v[112:115], v[60:63], v[240:247], v2
    v_smfmac_f32_16x16x64_bf16 v[116:119], v[60:63], v[248:255], v2
    s_waitcnt lgkmcnt(6)
    v_smfmac_f32_16x16x64_bf16 v[112:115], v[44:47], v[80:87], v2
    s_waitcnt lgkmcnt(4)
    v_smfmac_f32_16x16x64_bf16 v[116:119], v[44:47], v[88:95], v2
    s_waitcnt lgkmcnt(2)
    v_smfmac_f32_16x16x64_bf16 v[112:115], v[48:51], v[64:71], v2
    s_waitcnt lgkmcnt(0)
    v_smfmac_f32_16x16x64_bf16 v[116:119], v[48:51], v[72:79], v2
    v_mfma_f32_16x16x16_bf16 v[100:103], v[96:97], v[16:17], 0
    v_mfma_f32_16x16x16_bf16 v[104:107], v[98:99], v[16:17], 0
    s_nop 4
    v_add_f32 v112, v112, v114
    v_add_f32 v113, v113, v115
    v_add_f32 v114, v116, v118
    v_add_f32 v115, v117, v119
    v_cvt_pk_bf16_f32 v18, v112, v113
    v_cvt_pk_bf16_f32 v19, v114, v115
    v_and_or_b32 v18, v18, -2, s41
    v_mov_b32 v112, v18
    v_mov_b32 v114, v19
    v_mov_b32 v92, v28
    v_mov_b32 v93, 0
    s_waitcnt vmcnt(3)
    s_barrier
    ds_read_b128 v[32:35], v6 offset:9216
    ds_read_b128 v[36:39], v6 offset:10240
    ds_read_b128 v[40:43], v6 offset:12288
    ds_read_b128 v[44:47], v6 offset:13312
    buffer_load_dwordx2 v[108:109], v11, s[4:7], s38 offen sc1
    ds_read_b128 v[48:51], v6 offset:15360
    ds_read_b128 v[52:55], v6 offset:16384
    ds_read_b128 v[56:59], v6 offset:18432
    ds_read_b128 v[60:63], v6 offset:19456
    buffer_load_dwordx2 v[110:111], v11, s[4:7], s38 offen offset:512 sc1
    s_barrier
    buffer_store_dwordx2 v[18:19], v11, s[4:7], s39 offen sc1
    s_nop 15
    s_nop 15
    buffer_load_dwordx2 v[20:21], v11, s[4:7], s38 offen sc1
    buffer_load_dwordx2 v[22:23], v11, s[4:7], s38 offen offset:512 sc1
    s_waitcnt vmcnt(4)
    v_mfma_f32_16x16x16_bf16 v[80:83], v[108:109], v[16:17], v[100:103]
    v_and_b32 v3, 1, v108
    v_cmp_ne_u32 vcc, s41, v3
    s_nop 5
    v_cvt_pk_bf16_f32 v64, v80, v81
    v_cvt_pk_bf16_f32 v65, v82, v83
    s_cbranch_vccnz mega_kernel_rf_w0_xslow
    s_waitcnt vmcnt(3)
    v_mfma_f32_16x16x16_bf16 v[84:87], v[110:111], v[16:17], v[104:107]
    v_and_b32 v3, 1, v110
    v_cmp_ne_u32 vcc, s41, v3
    s_nop 5
    v_cvt_pk_bf16_f32 v66, v84, v85
    v_cvt_pk_bf16_f32 v67, v86, v87
    ds_write_b128 v6, v[64:67] offset:8192
    s_cbranch_vccnz mega_kernel_rf_w0_xslow
mega_kernel_rf_w0_xok:
    s_cmp_eq_u32 s21, 63
    s_cbranch_scc1 mega_kernel_rf_w0_last
    buffer_load_dwordx2 v[116:117], v11, s[4:7], s40 offen sc1
    s_waitcnt lgkmcnt(1)
    v_mfma_f32_16x16x32_bf16 v[80:83], v[32:35], v[64:67], 0
    s_waitcnt lgkmcnt(0)
    s_barrier
    ds_read_b128 v[68:71], v6 offset:11264
    ds_read_b128 v[72:75], v6 offset:14336
    ds_read_b128 v[76:79], v6 offset:17408
    v_mfma_f32_16x16x32_bf16 v[84:87], v[36:39], v[64:67], 0
    v_mfma_f32_16x16x32_bf16 v[88:91], v[64:67], v[64:67], 0
    buffer_load_dwordx2 v[20:21], v11, s[4:7], s40 offen sc1
    s_waitcnt lgkmcnt(2)
    v_mfma_f32_16x16x32_bf16 v[80:83], v[40:43], v[68:71], v[80:83]
    buffer_store_dwordx4 v[64:67], v10, s[4:7], s45 offen offset:0 sc1
    s_waitcnt lgkmcnt(1)
    v_mfma_f32_16x16x32_bf16 v[80:83], v[48:51], v[72:75], v[80:83]
    s_waitcnt lgkmcnt(0)
    v_mfma_f32_16x16x32_bf16 v[80:83], v[56:59], v[76:79], v[80:83]
    v_mfma_f32_16x16x32_bf16 v[84:87], v[44:47], v[68:71], v[84:87]
    v_mfma_f32_16x16x32_bf16 v[84:87], v[52:55], v[72:75], v[84:87]
    buffer_store_dwordx2 v[18:19], v11, s[4:7], s51 offen offset:2048 sc1
    v_mfma_f32_16x16x32_bf16 v[84:87], v[60:63], v[76:79], v[84:87]
    v_mfma_f32_16x16x32_bf16 v[88:91], v[68:71], v[68:71], v[88:91]
    v_mfma_f32_16x16x32_bf16 v[88:91], v[72:75], v[72:75], v[88:91]
    v_mfma_f32_16x16x32_bf16 v[88:91], v[76:79], v[76:79], v[88:91]
    v_mfma_f32_32x32x4_2b_bf16 v[32:63], v[14:15], v[14:15], 0
    s_nop 0
    v_max3_f32 v4, v80, v81, v82
    s_nop 1
    v_max3_f32 v4, v4, v83, v84
    v_max3_f32 v4, v4, v85, v86
    v_max_f32 v4, v4, v87
    v_max3_f32 v90, v4, v88, v89
    v_max3_f32 v4, v4, v88, v89
    s_nop 1
    v_permlane16_swap_b32 v4, v90
    v_max_f32 v4, v4, v90
    v_max_f32 v90, v4, v90
    s_nop 1
    v_permlane32_swap_b32 v4, v90
    v_max_f32 v4, v4, v90
    v_mul_f32 v4, s34, v4
    v_pk_fma_f32 v[80:81], v[80:81], s[34:35], v[4:5] op_sel_hi:[1,0,0] neg_lo:[0,0,1] neg_hi:[0,0,1]
    v_pk_fma_f32 v[82:83], v[82:83], s[34:35], v[4:5] op_sel_hi:[1,0,0] neg_lo:[0,0,1] neg_hi:[0,0,1]
    v_pk_fma_f32 v[84:85], v[84:85], s[34:35], v[4:5] op_sel_hi:[1,0,0] neg_lo:[0,0,1] neg_hi:[0,0,1]
    v_pk_fma_f32 v[86:87], v[86:87], s[34:35], v[4:5] op_sel_hi:[1,0,0] neg_lo:[0,0,1] neg_hi:[0,0,1]
    v_pk_fma_f32 v[88:89], v[88:89], s[34:35], v[4:5] op_sel_hi:[1,0,0] neg_lo:[0,0,1] neg_hi:[0,0,1]
    v_exp_f32 v80, v80
    v_exp_f32 v81, v81
    v_exp_f32 v82, v82
    v_cvt_pk_bf16_f32 v68, v80, v81
    v_exp_f32 v83, v83
    v_exp_f32 v84, v84
    v_cvt_pk_bf16_f32 v69, v82, v83
    v_exp_f32 v85, v85
    v_exp_f32 v86, v86
    v_cvt_pk_bf16_f32 v70, v84, v85
    v_exp_f32 v87, v87
    v_exp_f32 v88, v88
    v_cvt_pk_bf16_f32 v71, v86, v87
    v_exp_f32 v89, v89
    s_waitcnt vmcnt(3)
    v_mfma_f32_16x16x32_bf16 v[76:79], v[28:31], v[68:71], 0
    v_and_b32 v3, 1, v116
    v_cvt_pk_bf16_f32 v72, v88, v89
    v_mfma_f32_16x16x32_bf16 v[100:103], v[120:123], v[68:71], 0
    v_cmp_ne_u32 vcc, s41, v3
    v_cvt_pk_bf16_f32 v73, v88, v89
    v_mfma_f32_16x16x32_bf16 v[104:107], v[124:127], v[68:71], 0
    v_mov_b32 v113, v116
    v_mov_b32 v115, v117
    v_mfma_f32_16x16x16_bf16 v[76:79], v[92:93], v[72:73], v[76:79]
    s_cbranch_vccnz mega_kernel_rf_w0_pv0
mega_kernel_rf_w0_pv2:
    v_mfma_f32_16x16x16_bf16 v[100:103], v[112:113], v[72:73], v[100:103]
    v_mfma_f32_16x16x16_bf16 v[104:107], v[114:115], v[72:73], v[104:107]
    buffer_load_dwordx4 v[120:123], v1, s[4:7], s44 offen
    buffer_load_dwordx4 v[124:127], v1, s[4:7], s44 offen offset:1024
    s_nop 2
    v_rcp_f32 v76, v76
    s_mov_b64 exec, s[28:29]
    v_pk_mul_f32 v[100:101], v[100:101], v[76:77] op_sel_hi:[1,0]
    v_pk_mul_f32 v[102:103], v[102:103], v[76:77] op_sel_hi:[1,0]
    v_pk_mul_f32 v[104:105], v[104:105], v[76:77] op_sel_hi:[1,0]
    v_pk_mul_f32 v[106:107], v[106:107], v[76:77] op_sel_hi:[1,0]
    v_cvt_pk_bf16_f32 v84, v100, v101
    v_cvt_pk_bf16_f32 v85, v102, v103
    v_cvt_pk_bf16_f32 v86, v104, v105
    v_cvt_pk_bf16_f32 v87, v106, v107
    ds_write_b128 v6, v[84:87] offset:20448
    s_mov_b64 exec, -1
    ds_read_b128 v[88:91], v5 offset:16384
    ds_read_b128 v[92:95], v5 offset:17408
    ds_read_b128 v[112:115], v5 offset:18432
    ds_read_b128 v[116:119], v5 offset:19456
    ds_read_b128 v[96:99], v5 offset:32768
    ds_read_b128 v[100:103], v5 offset:33792
    s_waitcnt lgkmcnt(6)
    s_barrier
    ds_read_b128 v[68:71], v6 offset:20480
    ds_read_b128 v[72:75], v6 offset:21504
    ds_read_b128 v[104:107], v5 offset:34816
    ds_read_b128 v[108:111], v5 offset:35840
    ds_read_b128 v[80:83], v5 offset:49152
    ds_read_b128 v[84:87], v5 offset:50176
    s_waitcnt lgkmcnt(5)
    v_smfmac_f32_16x16x64_bf16 v[32:35], v[68:71], v[128:135], v2
    s_add_u32 s21, s21, 1
    s_xor_b32 s38, s38, 1048576
    s_xor_b32 s37, s37, 1048576
    s_waitcnt lgkmcnt(4)
    v_smfmac_f32_16x16x64_bf16 v[32:35], v[72:75], v[136:143], v2
    s_xor_b32 s40, s40, 1048576
    s_xor_b32 s39, s39, 1048576
    s_lshr_b32 s41, s21, 1
    v_smfmac_f32_16x16x64_bf16 v[36:39], v[68:71], v[144:151], v2
    s_and_b32 s41, s41, 1
    s_xor_b32 s41, s41, 1
    s_xor_b32 s35, s35, 16384
    v_smfmac_f32_16x16x64_bf16 v[36:39], v[72:75], v[152:159], v2
    v_add_f32 v32, v32, v34
    s_xor_b32 s36, s36, 16384
    s_add_u32 s43, s43, 262144
    s_add_u32 s44, s44, 262144
    v_smfmac_f32_16x16x64_bf16 v[40:43], v[68:71], v[160:167], v2
    v_add_f32 v33, v33, v35
    v_smfmac_f32_16x16x64_bf16 v[40:43], v[72:75], v[168:175], v2
    v_cvt_pk_bf16_f32 v32, v32, v33
    v_smfmac_f32_16x16x64_bf16 v[44:47], v[68:71], v[176:183], v2
    v_and_or_b32 v32, v32, -2, s42
    v_smfmac_f32_16x16x64_bf16 v[44:47], v[72:75], v[184:191], v2
    v_add_f32 v36, v36, v38
    v_smfmac_f32_16x16x64_bf16 v[48:51], v[68:71], v[192:199], v2
    v_add_f32 v37, v37, v39
    v_smfmac_f32_16x16x64_bf16 v[48:51], v[72:75], v[200:207], v2
    v_cvt_pk_bf16_f32 v33, v36, v37
    s_waitcnt lgkmcnt(0)
    v_smfmac_f32_16x16x64_bf16 v[52:55], v[68:71], v[88:95], v2
    ds_read_b128 v[88:91], v5 offset:51200
    ds_read_b128 v[92:95], v5 offset:52224
    v_smfmac_f32_16x16x64_bf16 v[52:55], v[72:75], v[112:119], v2
    v_add_f32 v40, v40, v42
    v_smfmac_f32_16x16x64_bf16 v[56:59], v[68:71], v[96:103], v2
    v_add_f32 v41, v41, v43
    v_smfmac_f32_16x16x64_bf16 v[56:59], v[72:75], v[104:111], v2
    v_cvt_pk_bf16_f32 v34, v40, v41
    v_smfmac_f32_16x16x64_bf16 v[60:63], v[68:71], v[80:87], v2
    v_add_f32 v44, v44, v46
    s_waitcnt lgkmcnt(0)
    v_smfmac_f32_16x16x64_bf16 v[60:63], v[72:75], v[88:95], v2
    v_add_f32 v45, v45, v47
    v_cvt_pk_bf16_f32 v35, v44, v45
    buffer_store_dwordx4 v[32:35], v8, s[4:7], s46 offen
    v_pk_add_f32 v[48:49], v[48:49], v[50:51]
    v_cvt_pk_bf16_f32 v48, v48, v49
    v_and_or_b32 v48, v48, -2, s42
    v_pk_add_f32 v[52:53], v[52:53], v[54:55]
    v_cvt_pk_bf16_f32 v49, v52, v53
    v_pk_add_f32 v[56:57], v[56:57], v[58:59]
    v_cvt_pk_bf16_f32 v50, v56, v57
    v_pk_add_f32 v[60:61], v[60:61], v[62:63]
    v_cvt_pk_bf16_f32 v51, v60, v61
    buffer_store_dwordx4 v[48:51], v8, s[4:7], s61 offen
    s_add_u32 s45, s45, 262144
    s_add_u32 s51, s51, 262144
    v_mfma_f32_32x32x8_bf16 v[96:111], v[14:15], v[14:15], 0
    v_mfma_f32_16x16x16_bf16 v[112:115], v[14:15], v[14:15], 0
    v_mfma_f32_16x16x16_bf16 v[116:119], v[14:15], v[14:15], 0
    ds_read_b128 v[64:67], v1 offset:0
    ds_read_b128 v[68:71], v1 offset:1024
    ds_read_b128 v[72:75], v1 offset:2048
    ds_read_b128 v[76:79], v1 offset:3072
    ds_read_b128 v[80:83], v1 offset:16384
    ds_read_b128 v[84:87], v1 offset:17408
    ds_read_b128 v[88:91], v1 offset:18432
    ds_read_b128 v[92:95], v1 offset:19456
    v_mov_b32 v58, -1
    v_mov_b32 v59, -1
    s_waitcnt vmcnt(0)
mega_kernel_rf_w0_pc:
    buffer_load_dword v36, v13, s[4:7], s25 offen offset:0 sc1
    buffer_load_dword v37, v13, s[4:7], s25 offen offset:256 sc1
    buffer_load_dword v38, v13, s[4:7], s25 offen offset:512 sc1
    buffer_load_dword v39, v13, s[4:7], s25 offen offset:768 sc1
    buffer_load_dword v40, v13, s[4:7], s25 offen offset:1024 sc1
    buffer_load_dword v41, v13, s[4:7], s25 offen offset:1280 sc1
    buffer_load_dword v42, v13, s[4:7], s25 offen offset:1536 sc1
    buffer_load_dword v43, v13, s[4:7], s25 offen offset:1792 sc1
    s_waitcnt vmcnt(4)
    v_mfma_f32_16x16x32_bf16 v[52:55], v[36:39], v[24:27], 0
    v_bitop3_b32 v3, s42, v36, v37 bitop3:0x7e
    v_bitop3_b32 v4, s42, v38, v39 bitop3:0x7e
    s_waitcnt vmcnt(2)
    v_or_b32 v3, v3, v4
    v_bitop3_b32 v4, s42, v40, v41 bitop3:0x7e
    s_waitcnt vmcnt(0)
    v_mfma_f32_16x16x32_bf16 v[52:55], v[40:43], v[24:27], v[52:55]
    v_bitop3_b32 v56, s42, v42, v43 bitop3:0x7e
    v_or3_b32 v3, v3, v4, v56
    v_and_b32 v3, v0, v3
    v_cmp_ne_u32 vcc, 0, v3
    s_nop 3
    v_cvt_pk_bf16_f32 v56, v52, v53
    v_cvt_pk_bf16_f32 v57, v54, v55
    v_min_u32 v56, -2, v56
    s_cbranch_vccnz mega_kernel_rf_w0_pc
    s_mov_b64 exec, s[26:27]
    buffer_store_dwordx2 v[56:57], v9, s[4:7], s35 offen offset:0
    buffer_store_dwordx2 v[58:59], v9, s[4:7], s36 offen offset:0
    s_mov_b64 exec, -1
    s_xor_b32 s42, s42, 1
    s_branch mega_kernel_rf_w0_loop
mega_kernel_rf_w0_last:
    buffer_store_dwordx4 v[64:67], v10, s[4:7], s45 offen offset:0 sc1
    buffer_store_dwordx2 v[18:19], v11, s[4:7], s51 offen offset:2048 sc1
    s_branch mega_kernel_rf_end
mega_kernel_rf_w0_pafail:
    s_nop 7
    v_mov_b32 v96, 0
    v_mov_b32 v97, 0
    v_mov_b32 v98, 0
    v_mov_b32 v99, 0
    v_mov_b32 v100, 0
    v_mov_b32 v101, 0
    v_mov_b32 v102, 0
    v_mov_b32 v103, 0
    v_mov_b32 v104, 0
    v_mov_b32 v105, 0
    v_mov_b32 v106, 0
    v_mov_b32 v107, 0
    s_branch mega_kernel_rf_w0_pa
mega_kernel_rf_w0_xslow:
    buffer_load_dwordx2 v[108:109], v11, s[4:7], s38 offen sc1
    buffer_load_dwordx2 v[110:111], v11, s[4:7], s38 offen offset:512 sc1
    s_waitcnt vmcnt(2)
    v_bitop3_b32 v3, s41, v20, v22 bitop3:0x7e
    v_mfma_f32_16x16x16_bf16 v[80:83], v[20:21], v[16:17], v[100:103]
    v_and_b32 v3, 1, v3
    v_mfma_f32_16x16x16_bf16 v[84:87], v[22:23], v[16:17], v[104:107]
    v_cmp_ne_u32 vcc, 0, v3
    s_cbranch_vccz mega_kernel_rf_w0_xgot
    buffer_load_dwordx2 v[20:21], v11, s[4:7], s38 offen sc1
    buffer_load_dwordx2 v[22:23], v11, s[4:7], s38 offen offset:512 sc1
    s_waitcnt vmcnt(2)
    v_bitop3_b32 v3, s41, v108, v110 bitop3:0x7e
    v_mfma_f32_16x16x16_bf16 v[80:83], v[108:109], v[16:17], v[100:103]
    v_and_b32 v3, 1, v3
    v_mfma_f32_16x16x16_bf16 v[84:87], v[110:111], v[16:17], v[104:107]
    v_cmp_ne_u32 vcc, 0, v3
    s_cbranch_vccz mega_kernel_rf_w0_xgot
    s_branch mega_kernel_rf_w0_xslow
mega_kernel_rf_w0_xgot:
    s_nop 3
    v_cvt_pk_bf16_f32 v64, v80, v81
    v_cvt_pk_bf16_f32 v65, v82, v83
    v_cvt_pk_bf16_f32 v66, v84, v85
    v_cvt_pk_bf16_f32 v67, v86, v87
    ds_write_b128 v6, v[64:67] offset:8192
    s_branch mega_kernel_rf_w0_xok
mega_kernel_rf_w0_pv0:
    s_waitcnt vmcnt(2)
    s_branch mega_kernel_rf_w0_pv1
mega_kernel_rf_w0_pv:
    buffer_load_dwordx2 v[20:21], v11, s[4:7], s40 offen sc1
    s_waitcnt vmcnt(0)
mega_kernel_rf_w0_pv1:
    v_and_b32 v3, 1, v20
    v_cmp_ne_u32 vcc, s41, v3
    v_mov_b32 v113, v20
    v_mov_b32 v115, v21
    s_cbranch_vccnz mega_kernel_rf_w0_pv
    s_branch mega_kernel_rf_w0_pv2
mega_kernel_rf_w1_entry:
    v_mfma_f32_32x32x8_bf16 v[96:111], v[14:15], v[14:15], 0
    v_mfma_f32_16x16x16_bf16 v[112:115], v[14:15], v[14:15], 0
    v_mfma_f32_16x16x16_bf16 v[116:119], v[14:15], v[14:15], 0
    ds_read_b128 v[64:67], v1 offset:4096
    ds_read_b128 v[68:71], v1 offset:5120
    ds_read_b128 v[72:75], v1 offset:6144
    ds_read_b128 v[76:79], v1 offset:7168
    ds_read_b128 v[80:83], v1 offset:20480
    ds_read_b128 v[84:87], v1 offset:21504
    ds_read_b128 v[88:91], v1 offset:22528
    ds_read_b128 v[92:95], v1 offset:23552
    buffer_load_dwordx4 v[120:123], v1, s[4:7], s44 offen
    buffer_load_dwordx4 v[124:127], v1, s[4:7], s44 offen offset:1024
    s_add_u32 s44, s44, 262144
mega_kernel_rf_w1_loop:
    s_add_u32 s22, s35, 2048
    s_waitcnt vmcnt(0)
    buffer_load_dwordx4 v[40:43], v1, s[4:7], s22 offen sc1
    buffer_load_dwordx4 v[44:47], v1, s[4:7], s22 offen offset:1024 sc1
mega_kernel_rf_w1_pa:
    s_waitcnt vmcnt(1)
    ds_write_b128 v6, v[40:43] offset:2048
    s_waitcnt vmcnt(0)
    ds_write_b128 v6, v[44:47] offset:3072
    v_max3_u32 v3, v40, v42, v44
    v_max_u32 v3, v3, v46
    v_cmp_eq_u32 vcc, -1, v3
    v_smfmac_f32_16x16x64_bf16 v[96:99], v[40:43], a[32:39], v2
    buffer_load_dwordx4 v[40:43], v1, s[4:7], s22 offen sc1
    v_smfmac_f32_16x16x64_bf16 v[100:103], v[40:43], a[40:47], v2
    buffer_load_dwordx4 v[44:47], v1, s[4:7], s22 offen offset:1024 sc1
    v_smfmac_f32_16x16x64_bf16 v[104:107], v[40:43], a[160:167], v2
    s_cbranch_vccnz mega_kernel_rf_w1_pafail
    s_waitcnt lgkmcnt(0)
    s_barrier
    ds_read_b128 v[48:51], v6 offset:4096
    ds_read_b128 v[52:55], v6 offset:5120
    v_smfmac_f32_16x16x64_bf16 v[108:111], v[40:43], a[168:175], v2
    ds_read_b128 v[56:59], v6 offset:6144
    v_smfmac_f32_16x16x64_bf16 v[96:99], v[44:47], a[48:55], v2
    ds_read_b128 v[60:63], v6 offset:7168
    v_smfmac_f32_16x16x64_bf16 v[100:103], v[44:47], a[56:63], v2
    ds_read_b128 v[32:35], v6 offset:0
    v_smfmac_f32_16x16x64_bf16 v[104:107], v[44:47], a[176:183], v2
    ds_read_b128 v[36:39], v6 offset:1024
    v_smfmac_f32_16x16x64_bf16 v[108:111], v[44:47], a[184:191], v2
    s_waitcnt lgkmcnt(5)
    v_smfmac_f32_16x16x64_bf16 v[96:99], v[48:51], a[64:71], v2
    buffer_load_dwordx4 v1, s[4:7], s43 offen lds
    v_smfmac_f32_16x16x64_bf16 v[104:107], v[48:51], a[192:199], v2
    s_waitcnt lgkmcnt(4)
    v_smfmac_f32_16x16x64_bf16 v[96:99], v[52:55], a[80:87], v2
    v_smfmac_f32_16x16x64_bf16 v[104:107], v[52:55], a[208:215], v2
    s_waitcnt lgkmcnt(3)
    v_smfmac_f32_16x16x64_bf16 v[96:99], v[56:59], a[96:103], v2
    buffer_load_dwordx4 v1, s[4:7], s43 offen offset:1024 lds
    v_smfmac_f32_16x16x64_bf16 v[104:107], v[56:59], a[224:231], v2
    s_waitcnt lgkmcnt(2)
    v_smfmac_f32_16x16x64_bf16 v[96:99], v[60:63], a[112:119], v2
    v_smfmac_f32_16x16x64_bf16 v[104:107], v[60:63], a[240:247], v2
    s_waitcnt lgkmcnt(1)
    v_smfmac_f32_16x16x64_bf16 v[96:99], v[32:35], a[0:7], v2
    v_smfmac_f32_16x16x64_bf16 v[104:107], v[32:35], a[128:135], v2
    s_waitcnt lgkmcnt(0)
    v_smfmac_f32_16x16x64_bf16 v[96:99], v[36:39], a[16:23], v2
    v_smfmac_f32_16x16x64_bf16 v[104:107], v[36:39], a[144:151], v2
    v_smfmac_f32_16x16x64_bf16 v[100:103], v[48:51], a[72:79], v2
    s_nop 2
    v_smfmac_f32_16x16x64_bf16 v[100:103], v[52:55], a[88:95], v2
    s_nop 2
    v_smfmac_f32_16x16x64_bf16 v[100:103], v[56:59], a[104:111], v2
    v_add_f32 v96, v96, v98
    v_add_f32 v97, v97, v99
    v_smfmac_f32_16x16x64_bf16 v[100:103], v[60:63], a[120:127], v2
    v_add_f32 v104, v104, v106
    v_add_f32 v105, v105, v107
    v_smfmac_f32_16x16x64_bf16 v[100:103], v[32:35], a[8:15], v2
    v_cvt_pk_bf16_f32 v96, v96, v97
    v_cvt_pk_bf16_f32 v97, v104, v105
    v_smfmac_f32_16x16x64_bf16 v[100:103], v[36:39], a[24:31], v2
    v_and_or_b32 v96, v96, -2, s41
    buffer_store_dwordx2 v[96:97], v11, s[4:7], s37 offen sc1
    v_smfmac_f32_16x16x64_bf16 v[108:111], v[48:51], a[200:207], v2
    v_smfmac_f32_16x16x64_bf16 v[108:111], v[52:55], a[216:223], v2
    v_smfmac_f32_16x16x64_bf16 v[108:111], v[56:59], a[232:239], v2
    v_smfmac_f32_16x16x64_bf16 v[108:111], v[60:63], a[248:255], v2
    v_smfmac_f32_16x16x64_bf16 v[108:111], v[32:35], a[136:143], v2
    s_nop 2
    v_add_f32 v100, v100, v102
    v_smfmac_f32_16x16x64_bf16 v[108:111], v[36:39], a[152:159], v2
    v_add_f32 v101, v101, v103
    v_cvt_pk_bf16_f32 v98, v100, v101
    v_and_or_b32 v98, v98, -2, s41
    s_nop 4
    v_pk_add_f32 v[108:109], v[108:109], v[110:111]
    v_cvt_pk_bf16_f32 v99, v108, v109
    buffer_store_dwordx2 v[98:99], v11, s[4:7], s37 offen offset:512 sc1
    v_smfmac_f32_16x16x64_bf16 v[112:115], v[32:35], v[64:71], v2
    ds_read_b128 v[64:67], v1 offset:36864
    ds_read_b128 v[68:71], v1 offset:37888
    v_smfmac_f32_16x16x64_bf16 v[116:119], v[32:35], v[72:79], v2
    ds_read_b128 v[72:75], v1 offset:38912
    ds_read_b128 v[76:79], v1 offset:39936
    v_smfmac_f32_16x16x64_bf16 v[112:115], v[36:39], v[80:87], v2
    ds_read_b128 v[80:83], v1 offset:53248
    ds_read_b128 v[84:87], v1 offset:54272
    v_smfmac_f32_16x16x64_bf16 v[116:119], v[36:39], v[88:95], v2
    ds_read_b128 v[88:91], v1 offset:55296
    ds_read_b128 v[92:95], v1 offset:56320
    v_smfmac_f32_16x16x64_bf16 v[112:115], v[52:55], v[208:215], v2
    v_smfmac_f32_16x16x64_bf16 v[116:119], v[52:55], v[216:223], v2
    v_smfmac_f32_16x16x64_bf16 v[112:115], v[56:59], v[224:231], v2
    s_waitcnt lgkmcnt(6)
    v_smfmac_f32_16x16x64_bf16 v[112:115], v[40:43], v[64:71], v2
    ds_read_b128 v[64:67], v5 offset:4096
    ds_read_b128 v[68:71], v5 offset:5120
    s_waitcnt lgkmcnt(6)
    v_smfmac_f32_16x16x64_bf16 v[116:119], v[40:43], v[72:79], v2
    ds_read_b128 v[72:75], v5 offset:6144
    ds_read_b128 v[76:79], v5 offset:7168
    v_smfmac_f32_16x16x64_bf16 v[116:119], v[56:59], v[232:239], v2
    v_smfmac_f32_16x16x64_bf16 v[112:115], v[60:63], v[240:247], v2
    v_smfmac_f32_16x16x64_bf16 v[116:119], v[60:63], v[248:255], v2
    s_waitcnt lgkmcnt(6)
    v_smfmac_f32_16x16x64_bf16 v[112:115], v[44:47], v[80:87], v2
    s_waitcnt lgkmcnt(4)
    v_smfmac_f32_16x16x64_bf16 v[116:119], v[44:47], v[88:95], v2
    s_waitcnt lgkmcnt(2)
    v_smfmac_f32_16x16x64_bf16 v[112:115], v[48:51], v[64:71], v2
    s_waitcnt lgkmcnt(0)
    v_smfmac_f32_16x16x64_bf16 v[116:119], v[48:51], v[72:79], v2
    v_mfma_f32_16x16x16_bf16 v[100:103], v[96:97], v[16:17], 0
    v_mfma_f32_16x16x16_bf16 v[104:107], v[98:99], v[16:17], 0
    s_nop 4
    v_add_f32 v112, v112, v114
    v_add_f32 v113, v113, v115
    v_add_f32 v114, v116, v118
    v_add_f32 v115, v117, v119
    v_cvt_pk_bf16_f32 v18, v112, v113
    v_cvt_pk_bf16_f32 v19, v114, v115
    v_and_or_b32 v18, v18, -2, s41
    v_mov_b32 v112, v18
    v_mov_b32 v114, v19
    v_mov_b32 v92, v28
    v_mov_b32 v93, 0
    s_waitcnt vmcnt(2)
    s_barrier
    ds_read_b128 v[32:35], v6 offset:12288
    ds_read_b128 v[36:39], v6 offset:13312
    ds_read_b128 v[40:43], v6 offset:9216
    ds_read_b128 v[44:47], v6 offset:10240
    buffer_load_dwordx2 v[108:109], v11, s[4:7], s38 offen sc1
    ds_read_b128 v[48:51], v6 offset:18432
    ds_read_b128 v[52:55], v6 offset:19456
    ds_read_b128 v[56:59], v6 offset:15360
    ds_read_b128 v[60:63], v6 offset:16384
    buffer_load_dwordx2 v[110:111], v11, s[4:7], s38 offen offset:512 sc1
    s_barrier
    buffer_store_dwordx2 v[18:19], v11, s[4:7], s39 offen sc1
    s_nop 15
    s_nop 15
    buffer_load_dwordx2 v[20:21], v11, s[4:7], s38 offen sc1
    buffer_load_dwordx2 v[22:23], v11, s[4:7], s38 offen offset:512 sc1
    s_waitcnt vmcnt(4)
    v_mfma_f32_16x16x16_bf16 v[80:83], v[108:109], v[16:17], v[100:103]
    v_and_b32 v3, 1, v108
    v_cmp_ne_u32 vcc, s41, v3
    s_nop 5
    v_cvt_pk_bf16_f32 v64, v80, v81
    v_cvt_pk_bf16_f32 v65, v82, v83
    s_cbranch_vccnz mega_kernel_rf_w1_xslow
    s_waitcnt vmcnt(3)
    v_mfma_f32_16x16x16_bf16 v[84:87], v[110:111], v[16:17], v[104:107]
    v_and_b32 v3, 1, v110
    v_cmp_ne_u32 vcc, s41, v3
    s_nop 5
    v_cvt_pk_bf16_f32 v66, v84, v85
    v_cvt_pk_bf16_f32 v67, v86, v87
    ds_write_b128 v6, v[64:67] offset:11264
    s_cbranch_vccnz mega_kernel_rf_w1_xslow
mega_kernel_rf_w1_xok:
    s_cmp_eq_u32 s21, 63
    s_cbranch_scc1 mega_kernel_rf_w1_last
    buffer_load_dwordx2 v[116:117], v11, s[4:7], s40 offen sc1
    s_waitcnt lgkmcnt(1)
    v_mfma_f32_16x16x32_bf16 v[80:83], v[32:35], v[64:67], 0
    s_waitcnt lgkmcnt(0)
    s_barrier
    ds_read_b128 v[68:71], v6 offset:8192
    ds_read_b128 v[72:75], v6 offset:17408
    ds_read_b128 v[76:79], v6 offset:14336
    v_mfma_f32_16x16x32_bf16 v[84:87], v[36:39], v[64:67], 0
    v_mfma_f32_16x16x32_bf16 v[88:91], v[64:67], v[64:67], 0
    buffer_load_dwordx2 v[20:21], v11, s[4:7], s40 offen sc1
    s_waitcnt lgkmcnt(2)
    v_mfma_f32_16x16x32_bf16 v[80:83], v[40:43], v[68:71], v[80:83]
    s_waitcnt lgkmcnt(1)
    v_mfma_f32_16x16x32_bf16 v[80:83], v[48:51], v[72:75], v[80:83]
    buffer_store_dwordx4 v[64:67], v10, s[4:7], s45 offen offset:64 sc1
    s_waitcnt lgkmcnt(0)
    v_mfma_f32_16x16x32_bf16 v[80:83], v[56:59], v[76:79], v[80:83]
    v_mfma_f32_16x16x32_bf16 v[84:87], v[44:47], v[68:71], v[84:87]
    v_mfma_f32_16x16x32_bf16 v[84:87], v[52:55], v[72:75], v[84:87]
    v_mfma_f32_16x16x32_bf16 v[84:87], v[60:63], v[76:79], v[84:87]
    buffer_store_dwordx2 v[18:19], v11, s[4:7], s51 offen offset:2560 sc1
    v_mfma_f32_16x16x32_bf16 v[88:91], v[68:71], v[68:71], v[88:91]
    v_mfma_f32_16x16x32_bf16 v[88:91], v[72:75], v[72:75], v[88:91]
    v_mfma_f32_16x16x32_bf16 v[88:91], v[76:79], v[76:79], v[88:91]
    v_mfma_f32_32x32x4_2b_bf16 v[32:63], v[14:15], v[14:15], 0
    s_nop 0
    v_max3_f32 v4, v80, v81, v82
    s_nop 1
    v_max3_f32 v4, v4, v83, v84
    v_max3_f32 v4, v4, v85, v86
    v_max_f32 v4, v4, v87
    v_max3_f32 v90, v4, v88, v89
    v_max3_f32 v4, v4, v88, v89
    s_nop 1
    v_permlane16_swap_b32 v4, v90
    v_max_f32 v4, v4, v90
    v_max_f32 v90, v4, v90
    s_nop 1
    v_permlane32_swap_b32 v4, v90
    v_max_f32 v4, v4, v90
    v_mul_f32 v4, s34, v4
    v_pk_fma_f32 v[80:81], v[80:81], s[34:35], v[4:5] op_sel_hi:[1,0,0] neg_lo:[0,0,1] neg_hi:[0,0,1]
    v_pk_fma_f32 v[82:83], v[82:83], s[34:35], v[4:5] op_sel_hi:[1,0,0] neg_lo:[0,0,1] neg_hi:[0,0,1]
    v_pk_fma_f32 v[84:85], v[84:85], s[34:35], v[4:5] op_sel_hi:[1,0,0] neg_lo:[0,0,1] neg_hi:[0,0,1]
    v_pk_fma_f32 v[86:87], v[86:87], s[34:35], v[4:5] op_sel_hi:[1,0,0] neg_lo:[0,0,1] neg_hi:[0,0,1]
    v_pk_fma_f32 v[88:89], v[88:89], s[34:35], v[4:5] op_sel_hi:[1,0,0] neg_lo:[0,0,1] neg_hi:[0,0,1]
    v_exp_f32 v80, v80
    v_exp_f32 v81, v81
    v_exp_f32 v82, v82
    v_cvt_pk_bf16_f32 v68, v80, v81
    v_exp_f32 v83, v83
    v_exp_f32 v84, v84
    v_cvt_pk_bf16_f32 v69, v82, v83
    v_exp_f32 v85, v85
    v_exp_f32 v86, v86
    v_cvt_pk_bf16_f32 v70, v84, v85
    v_exp_f32 v87, v87
    v_exp_f32 v88, v88
    v_cvt_pk_bf16_f32 v71, v86, v87
    v_exp_f32 v89, v89
    s_waitcnt vmcnt(3)
    v_mfma_f32_16x16x32_bf16 v[76:79], v[28:31], v[68:71], 0
    v_and_b32 v3, 1, v116
    v_cvt_pk_bf16_f32 v72, v88, v89
    v_mfma_f32_16x16x32_bf16 v[100:103], v[120:123], v[68:71], 0
    v_cmp_ne_u32 vcc, s41, v3
    v_cvt_pk_bf16_f32 v73, v88, v89
    v_mfma_f32_16x16x32_bf16 v[104:107], v[124:127], v[68:71], 0
    v_mov_b32 v113, v116
    v_mov_b32 v115, v117
    v_mfma_f32_16x16x16_bf16 v[76:79], v[92:93], v[72:73], v[76:79]
    s_cbranch_vccnz mega_kernel_rf_w1_pv0
mega_kernel_rf_w1_pv2:
    v_mfma_f32_16x16x16_bf16 v[100:103], v[112:113], v[72:73], v[100:103]
    v_mfma_f32_16x16x16_bf16 v[104:107], v[114:115], v[72:73], v[104:107]
    buffer_load_dwordx4 v[120:123], v1, s[4:7], s44 offen
    buffer_load_dwordx4 v[124:127], v1, s[4:7], s44 offen offset:1024
    s_nop 2
    v_rcp_f32 v76, v76
    s_mov_b64 exec, s[28:29]
    v_pk_mul_f32 v[100:101], v[100:101], v[76:77] op_sel_hi:[1,0]
    v_pk_mul_f32 v[102:103], v[102:103], v[76:77] op_sel_hi:[1,0]
    v_pk_mul_f32 v[104:105], v[104:105], v[76:77] op_sel_hi:[1,0]
    v_pk_mul_f32 v[106:107], v[106:107], v[76:77] op_sel_hi:[1,0]
    v_cvt_pk_bf16_f32 v84, v100, v101
    v_cvt_pk_bf16_f32 v85, v102, v103
    v_cvt_pk_bf16_f32 v86, v104, v105
    v_cvt_pk_bf16_f32 v87, v106, v107
    ds_write_b128 v6, v[84:87] offset:20480
    s_mov_b64 exec, -1
    ds_read_b128 v[88:91], v5 offset:20480
    ds_read_b128 v[92:95], v5 offset:21504
    ds_read_b128 v[112:115], v5 offset:22528
    ds_read_b128 v[116:119], v5 offset:23552
    ds_read_b128 v[96:99], v5 offset:36864
    ds_read_b128 v[100:103], v5 offset:37888
    s_waitcnt lgkmcnt(6)
    s_barrier
    ds_read_b128 v[68:71], v6 offset:20480
    ds_read_b128 v[72:75], v6 offset:21504
    ds_read_b128 v[104:107], v5 offset:38912
    ds_read_b128 v[108:111], v5 offset:39936
    ds_read_b128 v[80:83], v5 offset:53248
    ds_read_b128 v[84:87], v5 offset:54272
    s_waitcnt lgkmcnt(5)
    v_smfmac_f32_16x16x64_bf16 v[32:35], v[68:71], v[128:135], v2
    s_add_u32 s21, s21, 1
    s_xor_b32 s38, s38, 1048576
    s_xor_b32 s37, s37, 1048576
    s_waitcnt lgkmcnt(4)
    v_smfmac_f32_16x16x64_bf16 v[32:35], v[72:75], v[136:143], v2
    s_xor_b32 s40, s40, 1048576
    s_xor_b32 s39, s39, 1048576
    s_lshr_b32 s41, s21, 1
    v_smfmac_f32_16x16x64_bf16 v[36:39], v[68:71], v[144:151], v2
    s_and_b32 s41, s41, 1
    s_xor_b32 s41, s41, 1
    s_xor_b32 s35, s35, 16384
    v_smfmac_f32_16x16x64_bf16 v[36:39], v[72:75], v[152:159], v2
    v_add_f32 v32, v32, v34
    s_xor_b32 s36, s36, 16384
    s_add_u32 s43, s43, 262144
    s_add_u32 s44, s44, 262144
    v_smfmac_f32_16x16x64_bf16 v[40:43], v[68:71], v[160:167], v2
    v_add_f32 v33, v33, v35
    v_smfmac_f32_16x16x64_bf16 v[40:43], v[72:75], v[168:175], v2
    v_cvt_pk_bf16_f32 v32, v32, v33
    v_smfmac_f32_16x16x64_bf16 v[44:47], v[68:71], v[176:183], v2
    v_and_or_b32 v32, v32, -2, s42
    v_smfmac_f32_16x16x64_bf16 v[44:47], v[72:75], v[184:191], v2
    v_add_f32 v36, v36, v38
    v_smfmac_f32_16x16x64_bf16 v[48:51], v[68:71], v[192:199], v2
    v_add_f32 v37, v37, v39
    v_smfmac_f32_16x16x64_bf16 v[48:51], v[72:75], v[200:207], v2
    v_cvt_pk_bf16_f32 v33, v36, v37
    s_waitcnt lgkmcnt(0)
    v_smfmac_f32_16x16x64_bf16 v[52:55], v[68:71], v[88:95], v2
    ds_read_b128 v[88:91], v5 offset:55296
    ds_read_b128 v[92:95], v5 offset:56320
    v_smfmac_f32_16x16x64_bf16 v[52:55], v[72:75], v[112:119], v2
    v_add_f32 v40, v40, v42
    v_smfmac_f32_16x16x64_bf16 v[56:59], v[68:71], v[96:103], v2
    v_add_f32 v41, v41, v43
    v_smfmac_f32_16x16x64_bf16 v[56:59], v[72:75], v[104:111], v2
    v_cvt_pk_bf16_f32 v34, v40, v41
    v_smfmac_f32_16x16x64_bf16 v[60:63], v[68:71], v[80:87], v2
    v_add_f32 v44, v44, v46
    s_waitcnt lgkmcnt(0)
    v_smfmac_f32_16x16x64_bf16 v[60:63], v[72:75], v[88:95], v2
    v_add_f32 v45, v45, v47
    v_cvt_pk_bf16_f32 v35, v44, v45
    buffer_store_dwordx4 v[32:35], v8, s[4:7], s46 offen
    v_pk_add_f32 v[48:49], v[48:49], v[50:51]
    v_cvt_pk_bf16_f32 v48, v48, v49
    v_and_or_b32 v48, v48, -2, s42
    v_pk_add_f32 v[52:53], v[52:53], v[54:55]
    v_cvt_pk_bf16_f32 v49, v52, v53
    v_pk_add_f32 v[56:57], v[56:57], v[58:59]
    v_cvt_pk_bf16_f32 v50, v56, v57
    v_pk_add_f32 v[60:61], v[60:61], v[62:63]
    v_cvt_pk_bf16_f32 v51, v60, v61
    buffer_store_dwordx4 v[48:51], v8, s[4:7], s61 offen
    s_add_u32 s45, s45, 262144
    s_add_u32 s51, s51, 262144
    v_mfma_f32_32x32x8_bf16 v[96:111], v[14:15], v[14:15], 0
    v_mfma_f32_16x16x16_bf16 v[112:115], v[14:15], v[14:15], 0
    v_mfma_f32_16x16x16_bf16 v[116:119], v[14:15], v[14:15], 0
    ds_read_b128 v[64:67], v1 offset:4096
    ds_read_b128 v[68:71], v1 offset:5120
    ds_read_b128 v[72:75], v1 offset:6144
    ds_read_b128 v[76:79], v1 offset:7168
    ds_read_b128 v[80:83], v1 offset:20480
    ds_read_b128 v[84:87], v1 offset:21504
    ds_read_b128 v[88:91], v1 offset:22528
    ds_read_b128 v[92:95], v1 offset:23552
    v_mov_b32 v58, -1
    v_mov_b32 v59, -1
    s_waitcnt vmcnt(0)
mega_kernel_rf_w1_pc:
    buffer_load_dword v36, v13, s[4:7], s25 offen offset:0 sc1
    buffer_load_dword v37, v13, s[4:7], s25 offen offset:256 sc1
    buffer_load_dword v38, v13, s[4:7], s25 offen offset:512 sc1
    buffer_load_dword v39, v13, s[4:7], s25 offen offset:768 sc1
    buffer_load_dword v40, v13, s[4:7], s25 offen offset:1024 sc1
    buffer_load_dword v41, v13, s[4:7], s25 offen offset:1280 sc1
    buffer_load_dword v42, v13, s[4:7], s25 offen offset:1536 sc1
    buffer_load_dword v43, v13, s[4:7], s25 offen offset:1792 sc1
    s_waitcnt vmcnt(4)
    v_mfma_f32_16x16x32_bf16 v[52:55], v[36:39], v[24:27], 0
    v_bitop3_b32 v3, s42, v36, v37 bitop3:0x7e
    v_bitop3_b32 v4, s42, v38, v39 bitop3:0x7e
    s_waitcnt vmcnt(2)
    v_or_b32 v3, v3, v4
    v_bitop3_b32 v4, s42, v40, v41 bitop3:0x7e
    s_waitcnt vmcnt(0)
    v_mfma_f32_16x16x32_bf16 v[52:55], v[40:43], v[24:27], v[52:55]
    v_bitop3_b32 v56, s42, v42, v43 bitop3:0x7e
    v_or3_b32 v3, v3, v4, v56
    v_and_b32 v3, v0, v3
    v_cmp_ne_u32 vcc, 0, v3
    s_nop 3
    v_cvt_pk_bf16_f32 v56, v52, v53
    v_cvt_pk_bf16_f32 v57, v54, v55
    v_min_u32 v56, -2, v56
    s_cbranch_vccnz mega_kernel_rf_w1_pc
    s_mov_b64 exec, s[26:27]
    buffer_store_dwordx2 v[56:57], v9, s[4:7], s35 offen offset:256
    buffer_store_dwordx2 v[58:59], v9, s[4:7], s36 offen offset:256
    s_mov_b64 exec, -1
    s_xor_b32 s42, s42, 1
    s_branch mega_kernel_rf_w1_loop
mega_kernel_rf_w1_last:
    buffer_store_dwordx4 v[64:67], v10, s[4:7], s45 offen offset:64 sc1
    buffer_store_dwordx2 v[18:19], v11, s[4:7], s51 offen offset:2560 sc1
    s_branch mega_kernel_rf_end
mega_kernel_rf_w1_pafail:
    s_nop 7
    v_mov_b32 v96, 0
    v_mov_b32 v97, 0
    v_mov_b32 v98, 0
    v_mov_b32 v99, 0
    v_mov_b32 v100, 0
    v_mov_b32 v101, 0
    v_mov_b32 v102, 0
    v_mov_b32 v103, 0
    v_mov_b32 v104, 0
    v_mov_b32 v105, 0
    v_mov_b32 v106, 0
    v_mov_b32 v107, 0
    s_branch mega_kernel_rf_w1_pa
mega_kernel_rf_w1_xslow:
    buffer_load_dwordx2 v[108:109], v11, s[4:7], s38 offen sc1
    buffer_load_dwordx2 v[110:111], v11, s[4:7], s38 offen offset:512 sc1
    s_waitcnt vmcnt(2)
    v_bitop3_b32 v3, s41, v20, v22 bitop3:0x7e
    v_mfma_f32_16x16x16_bf16 v[80:83], v[20:21], v[16:17], v[100:103]
    v_and_b32 v3, 1, v3
    v_mfma_f32_16x16x16_bf16 v[84:87], v[22:23], v[16:17], v[104:107]
    v_cmp_ne_u32 vcc, 0, v3
    s_cbranch_vccz mega_kernel_rf_w1_xgot
    buffer_load_dwordx2 v[20:21], v11, s[4:7], s38 offen sc1
    buffer_load_dwordx2 v[22:23], v11, s[4:7], s38 offen offset:512 sc1
    s_waitcnt vmcnt(2)
    v_bitop3_b32 v3, s41, v108, v110 bitop3:0x7e
    v_mfma_f32_16x16x16_bf16 v[80:83], v[108:109], v[16:17], v[100:103]
    v_and_b32 v3, 1, v3
    v_mfma_f32_16x16x16_bf16 v[84:87], v[110:111], v[16:17], v[104:107]
    v_cmp_ne_u32 vcc, 0, v3
    s_cbranch_vccz mega_kernel_rf_w1_xgot
    s_branch mega_kernel_rf_w1_xslow
mega_kernel_rf_w1_xgot:
    s_nop 3
    v_cvt_pk_bf16_f32 v64, v80, v81
    v_cvt_pk_bf16_f32 v65, v82, v83
    v_cvt_pk_bf16_f32 v66, v84, v85
    v_cvt_pk_bf16_f32 v67, v86, v87
    ds_write_b128 v6, v[64:67] offset:11264
    s_branch mega_kernel_rf_w1_xok
mega_kernel_rf_w1_pv0:
    s_waitcnt vmcnt(2)
    s_branch mega_kernel_rf_w1_pv1
mega_kernel_rf_w1_pv:
    buffer_load_dwordx2 v[20:21], v11, s[4:7], s40 offen sc1
    s_waitcnt vmcnt(0)
mega_kernel_rf_w1_pv1:
    v_and_b32 v3, 1, v20
    v_cmp_ne_u32 vcc, s41, v3
    v_mov_b32 v113, v20
    v_mov_b32 v115, v21
    s_cbranch_vccnz mega_kernel_rf_w1_pv
    s_branch mega_kernel_rf_w1_pv2
mega_kernel_rf_w2_entry:
    v_mfma_f32_32x32x8_bf16 v[96:111], v[14:15], v[14:15], 0
    v_mfma_f32_16x16x16_bf16 v[112:115], v[14:15], v[14:15], 0
    v_mfma_f32_16x16x16_bf16 v[116:119], v[14:15], v[14:15], 0
    ds_read_b128 v[64:67], v1 offset:8192
    ds_read_b128 v[68:71], v1 offset:9216
    ds_read_b128 v[72:75], v1 offset:10240
    ds_read_b128 v[76:79], v1 offset:11264
    ds_read_b128 v[80:83], v1 offset:24576
    ds_read_b128 v[84:87], v1 offset:25600
    ds_read_b128 v[88:91], v1 offset:26624
    ds_read_b128 v[92:95], v1 offset:27648
    buffer_load_dwordx4 v[120:123], v1, s[4:7], s44 offen
    buffer_load_dwordx4 v[124:127], v1, s[4:7], s44 offen offset:1024
    s_add_u32 s44, s44, 262144
mega_kernel_rf_w2_loop:
    s_add_u32 s22, s35, 4096
    s_waitcnt vmcnt(0)
    buffer_load_dwordx4 v[48:51], v1, s[4:7], s22 offen sc1
    buffer_load_dwordx4 v[52:55], v1, s[4:7], s22 offen offset:1024 sc1
mega_kernel_rf_w2_pa:
    s_waitcnt vmcnt(1)
    ds_write_b128 v6, v[48:51] offset:4096
    s_waitcnt vmcnt(0)
    ds_write_b128 v6, v[52:55] offset:5120
    v_max3_u32 v3, v48, v50, v52
    v_max_u32 v3, v3, v54
    v_cmp_eq_u32 vcc, -1, v3
    v_smfmac_f32_16x16x64_bf16 v[96:99], v[48:51], a[64:71], v2
    buffer_load_dwordx4 v[48:51], v1, s[4:7], s22 offen sc1
    v_smfmac_f32_16x16x64_bf16 v[100:103], v[48:51], a[72:79], v2
    buffer_load_dwordx4 v[52:55], v1, s[4:7], s22 offen offset:1024 sc1
    v_smfmac_f32_16x16x64_bf16 v[104:107], v[48:51], a[192:199], v2
    s_cbranch_vccnz mega_kernel_rf_w2_pafail
    s_waitcnt lgkmcnt(0)
    s_barrier
    ds_read_b128 v[56:59], v6 offset:6144
    ds_read_b128 v[60:63], v6 offset:7168
    v_smfmac_f32_16x16x64_bf16 v[108:111], v[48:51], a[200:207], v2
    ds_read_b128 v[32:35], v6 offset:0
    v_smfmac_f32_16x16x64_bf16 v[96:99], v[52:55], a[80:87], v2
    ds_read_b128 v[36:39], v6 offset:1024
    v_smfmac_f32_16x16x64_bf16 v[100:103], v[52:55], a[88:95], v2
    ds_read_b128 v[40:43], v6 offset:2048
    v_smfmac_f32_16x16x64_bf16 v[104:107], v[52:55], a[208:215], v2
    ds_read_b128 v[44:47], v6 offset:3072
    v_smfmac_f32_16x16x64_bf16 v[108:111], v[52:55], a[216:223], v2
    s_waitcnt lgkmcnt(5)
    v_smfmac_f32_16x16x64_bf16 v[96:99], v[56:59], a[96:103], v2
    v_smfmac_f32_16x16x64_bf16 v[104:107], v[56:59], a[224:231], v2
    buffer_load_dwordx4 v1, s[4:7], s43 offen lds
    s_waitcnt lgkmcnt(4)
    v_smfmac_f32_16x16x64_bf16 v[96:99], v[60:63], a[112:119], v2
    v_smfmac_f32_16x16x64_bf16 v[104:107], v[60:63], a[240:247], v2
    s_waitcnt lgkmcnt(3)
    v_smfmac_f32_16x16x64_bf16 v[96:99], v[32:35], a[0:7], v2
    v_smfmac_f32_16x16x64_bf16 v[104:107], v[32:35], a[128:135], v2
    buffer_load_dwordx4 v1, s[4:7], s43 offen offset:1024 lds
    s_waitcnt lgkmcnt(2)
    v_smfmac_f32_16x16x64_bf16 v[96:99], v[36:39], a[16:23], v2
    v_smfmac_f32_16x16x64_bf16 v[104:107], v[36:39], a[144:151], v2
    s_waitcnt lgkmcnt(1)
    v_smfmac_f32_16x16x64_bf16 v[96:99], v[40:43], a[32:39], v2
    v_smfmac_f32_16x16x64_bf16 v[104:107], v[40:43], a[160:167], v2
    s_waitcnt lgkmcnt(0)
    v_smfmac_f32_16x16x64_bf16 v[96:99], v[44:47], a[48:55], v2
    v_smfmac_f32_16x16x64_bf16 v[104:107], v[44:47], a[176:183], v2
    v_smfmac_f32_16x16x64_bf16 v[100:103], v[56:59], a[104:111], v2
    s_nop 2
    v_smfmac_f32_16x16x64_bf16 v[100:103], v[60:63], a[120:127], v2
    s_nop 2
    v_smfmac_f32_16x16x64_bf16 v[100:103], v[32:35], a[8:15], v2
    v_add_f32 v96, v96, v98
    v_add_f32 v97, v97, v99
    v_smfmac_f32_16x16x64_bf16 v[100:103], v[36:39], a[24:31], v2
    v_add_f32 v104, v104, v106
    v_add_f32 v105, v105, v107
    v_smfmac_f32_16x16x64_bf16 v[100:103], v[40:43], a[40:47], v2
    v_cvt_pk_bf16_f32 v96, v96, v97
    v_cvt_pk_bf16_f32 v97, v104, v105
    v_smfmac_f32_16x16x64_bf16 v[100:103], v[44:47], a[56:63], v2
    v_and_or_b32 v96, v96, -2, s41
    buffer_store_dwordx2 v[96:97], v11, s[4:7], s37 offen sc1
    v_smfmac_f32_16x16x64_bf16 v[108:111], v[56:59], a[232:239], v2
    v_smfmac_f32_16x16x64_bf16 v[108:111], v[60:63], a[248:255], v2
    v_smfmac_f32_16x16x64_bf16 v[108:111], v[32:35], a[136:143], v2
    v_smfmac_f32_16x16x64_bf16 v[108:111], v[36:39], a[152:159], v2
    v_smfmac_f32_16x16x64_bf16 v[108:111], v[40:43], a[168:175], v2
    s_nop 2
    v_add_f32 v100, v100, v102
    v_smfmac_f32_16x16x64_bf16 v[108:111], v[44:47], a[184:191], v2
    v_add_f32 v101, v101, v103
    v_cvt_pk_bf16_f32 v98, v100, v101
    v_and_or_b32 v98, v98, -2, s41
    s_nop 4
    v_pk_add_f32 v[108:109], v[108:109], v[110:111]
    v_cvt_pk_bf16_f32 v99, v108, v109
    buffer_store_dwordx2 v[98:99], v11, s[4:7], s37 offen offset:512 sc1
    v_smfmac_f32_16x16x64_bf16 v[112:115], v[32:35], v[64:71], v2
    ds_read_b128 v[64:67], v1 offset:40960
    ds_read_b128 v[68:71], v1 offset:41984
    v_smfmac_f32_16x16x64_bf16 v[116:119], v[32:35], v[72:79], v2
    ds_read_b128 v[72:75], v1 offset:43008
    ds_read_b128 v[76:79], v1 offset:44032
    v_smfmac_f32_16x16x64_bf16 v[112:115], v[36:39], v[80:87], v2
    ds_read_b128 v[80:83], v1 offset:57344
    ds_read_b128 v[84:87], v1 offset:58368
    v_smfmac_f32_16x16x64_bf16 v[116:119], v[36:39], v[88:95], v2
    ds_read_b128 v[88:91], v1 offset:59392
    ds_read_b128 v[92:95], v1 offset:60416
    v_smfmac_f32_16x16x64_bf16 v[112:115], v[52:55], v[208:215], v2
    v_smfmac_f32_16x16x64_bf16 v[116:119], v[52:55], v[216:223], v2
    v_smfmac_f32_16x16x64_bf16 v[112:115], v[56:59], v[224:231], v2
    s_waitcnt lgkmcnt(6)
    v_smfmac_f32_16x16x64_bf16 v[112:115], v[40:43], v[64:71], v2
    ds_read_b128 v[64:67], v5 offset:8192
    ds_read_b128 v[68:71], v5 offset:9216
    s_waitcnt lgkmcnt(6)
    v_smfmac_f32_16x16x64_bf16 v[116:119], v[40:43], v[72:79], v2
    ds_read_b128 v[72:75], v5 offset:10240
    ds_read_b128 v[76:79], v5 offset:11264
    v_smfmac_f32_16x16x64_bf16 v[116:119], v[56:59], v[232:239], v2
    v_smfmac_f32_16x16x64_bf16 v[112:115], v[60:63], v[240:247], v2
    v_smfmac_f32_16x16x64_bf16 v[116:119], v[60:63], v[248:255], v2
    s_waitcnt lgkmcnt(6)
    v_smfmac_f32_16x16x64_bf16 v[112:115], v[44:47], v[80:87], v2
    s_waitcnt lgkmcnt(4)
    v_smfmac_f32_16x16x64_bf16 v[116:119], v[44:47], v[88:95], v2
    s_waitcnt lgkmcnt(2)
    v_smfmac_f32_16x16x64_bf16 v[112:115], v[48:51], v[64:71], v2
    s_waitcnt lgkmcnt(0)
    v_smfmac_f32_16x16x64_bf16 v[116:119], v[48:51], v[72:79], v2
    v_mfma_f32_16x16x16_bf16 v[100:103], v[96:97], v[16:17], 0
    v_mfma_f32_16x16x16_bf16 v[104:107], v[98:99], v[16:17], 0
    s_nop 4
    v_add_f32 v112, v112, v114
    v_add_f32 v113, v113, v115
    v_add_f32 v114, v116, v118
    v_add_f32 v115, v117, v119
    v_cvt_pk_bf16_f32 v18, v112, v113
    v_cvt_pk_bf16_f32 v19, v114, v115
    v_and_or_b32 v18, v18, -2, s41
    v_mov_b32 v112, v18
    v_mov_b32 v114, v19
    v_mov_b32 v92, v28
    v_mov_b32 v93, 0
    s_waitcnt vmcnt(2)
    s_barrier
    ds_read_b128 v[32:35], v6 offset:15360
    ds_read_b128 v[36:39], v6 offset:16384
    ds_read_b128 v[40:43], v6 offset:18432
    ds_read_b128 v[44:47], v6 offset:19456
    buffer_load_dwordx2 v[108:109], v11, s[4:7], s38 offen sc1
    ds_read_b128 v[48:51], v6 offset:9216
    ds_read_b128 v[52:55], v6 offset:10240
    ds_read_b128 v[56:59], v6 offset:12288
    ds_read_b128 v[60:63], v6 offset:13312
    buffer_load_dwordx2 v[110:111], v11, s[4:7], s38 offen offset:512 sc1
    s_barrier
    buffer_store_dwordx2 v[18:19], v11, s[4:7], s39 offen sc1
    s_nop 15
    s_nop 15
    buffer_load_dwordx2 v[20:21], v11, s[4:7], s38 offen sc1
    buffer_load_dwordx2 v[22:23], v11, s[4:7], s38 offen offset:512 sc1
    s_waitcnt vmcnt(4)
    v_mfma_f32_16x16x16_bf16 v[80:83], v[108:109], v[16:17], v[100:103]
    v_and_b32 v3, 1, v108
    v_cmp_ne_u32 vcc, s41, v3
    s_nop 5
    v_cvt_pk_bf16_f32 v64, v80, v81
    v_cvt_pk_bf16_f32 v65, v82, v83
    s_cbranch_vccnz mega_kernel_rf_w2_xslow
    s_waitcnt vmcnt(3)
    v_mfma_f32_16x16x16_bf16 v[84:87], v[110:111], v[16:17], v[104:107]
    v_and_b32 v3, 1, v110
    v_cmp_ne_u32 vcc, s41, v3
    s_nop 5
    v_cvt_pk_bf16_f32 v66, v84, v85
    v_cvt_pk_bf16_f32 v67, v86, v87
    ds_write_b128 v6, v[64:67] offset:14336
    s_cbranch_vccnz mega_kernel_rf_w2_xslow
mega_kernel_rf_w2_xok:
    s_cmp_eq_u32 s21, 63
    s_cbranch_scc1 mega_kernel_rf_w2_last
    buffer_load_dwordx2 v[116:117], v11, s[4:7], s40 offen sc1
    s_waitcnt lgkmcnt(1)
    v_mfma_f32_16x16x32_bf16 v[80:83], v[32:35], v[64:67], 0
    s_waitcnt lgkmcnt(0)
    s_barrier
    ds_read_b128 v[68:71], v6 offset:17408
    ds_read_b128 v[72:75], v6 offset:8192
    ds_read_b128 v[76:79], v6 offset:11264
    v_mfma_f32_16x16x32_bf16 v[84:87], v[36:39], v[64:67], 0
    v_mfma_f32_16x16x32_bf16 v[88:91], v[64:67], v[64:67], 0
    buffer_load_dwordx2 v[20:21], v11, s[4:7], s40 offen sc1
    s_waitcnt lgkmcnt(2)
    v_mfma_f32_16x16x32_bf16 v[80:83], v[40:43], v[68:71], v[80:83]
    s_waitcnt lgkmcnt(1)
    v_mfma_f32_16x16x32_bf16 v[80:83], v[48:51], v[72:75], v[80:83]
    s_waitcnt lgkmcnt(0)
    v_mfma_f32_16x16x32_bf16 v[80:83], v[56:59], v[76:79], v[80:83]
    buffer_store_dwordx4 v[64:67], v10, s[4:7], s45 offen offset:128 sc1
    v_mfma_f32_16x16x32_bf16 v[84:87], v[44:47], v[68:71], v[84:87]
    v_mfma_f32_16x16x32_bf16 v[84:87], v[52:55], v[72:75], v[84:87]
    v_mfma_f32_16x16x32_bf16 v[84:87], v[60:63], v[76:79], v[84:87]
    v_mfma_f32_16x16x32_bf16 v[88:91], v[68:71], v[68:71], v[88:91]
    buffer_store_dwordx2 v[18:19], v11, s[4:7], s51 offen offset:3072 sc1
    v_mfma_f32_16x16x32_bf16 v[88:91], v[72:75], v[72:75], v[88:91]
    v_mfma_f32_16x16x32_bf16 v[88:91], v[76:79], v[76:79], v[88:91]
    v_mfma_f32_32x32x4_2b_bf16 v[32:63], v[14:15], v[14:15], 0
    s_nop 0
    v_max3_f32 v4, v80, v81, v82
    s_nop 1
    v_max3_f32 v4, v4, v83, v84
    v_max3_f32 v4, v4, v85, v86
    v_max_f32 v4, v4, v87
    v_max3_f32 v90, v4, v88, v89
    v_max3_f32 v4, v4, v88, v89
    s_nop 1
    v_permlane16_swap_b32 v4, v90
    v_max_f32 v4, v4, v90
    v_max_f32 v90, v4, v90
    s_nop 1
    v_permlane32_swap_b32 v4, v90
    v_max_f32 v4, v4, v90
    v_mul_f32 v4, s34, v4
    v_pk_fma_f32 v[80:81], v[80:81], s[34:35], v[4:5] op_sel_hi:[1,0,0] neg_lo:[0,0,1] neg_hi:[0,0,1]
    v_pk_fma_f32 v[82:83], v[82:83], s[34:35], v[4:5] op_sel_hi:[1,0,0] neg_lo:[0,0,1] neg_hi:[0,0,1]
    v_pk_fma_f32 v[84:85], v[84:85], s[34:35], v[4:5] op_sel_hi:[1,0,0] neg_lo:[0,0,1] neg_hi:[0,0,1]
    v_pk_fma_f32 v[86:87], v[86:87], s[34:35], v[4:5] op_sel_hi:[1,0,0] neg_lo:[0,0,1] neg_hi:[0,0,1]
    v_pk_fma_f32 v[88:89], v[88:89], s[34:35], v[4:5] op_sel_hi:[1,0,0] neg_lo:[0,0,1] neg_hi:[0,0,1]
    v_exp_f32 v80, v80
    v_exp_f32 v81, v81
    v_exp_f32 v82, v82
    v_cvt_pk_bf16_f32 v68, v80, v81
    v_exp_f32 v83, v83
    v_exp_f32 v84, v84
    v_cvt_pk_bf16_f32 v69, v82, v83
    v_exp_f32 v85, v85
    v_exp_f32 v86, v86
    v_cvt_pk_bf16_f32 v70, v84, v85
    v_exp_f32 v87, v87
    v_exp_f32 v88, v88
    v_cvt_pk_bf16_f32 v71, v86, v87
    v_exp_f32 v89, v89
    s_waitcnt vmcnt(3)
    v_mfma_f32_16x16x32_bf16 v[76:79], v[28:31], v[68:71], 0
    v_and_b32 v3, 1, v116
    v_cvt_pk_bf16_f32 v72, v88, v89
    v_mfma_f32_16x16x32_bf16 v[100:103], v[120:123], v[68:71], 0
    v_cmp_ne_u32 vcc, s41, v3
    v_cvt_pk_bf16_f32 v73, v88, v89
    v_mfma_f32_16x16x32_bf16 v[104:107], v[124:127], v[68:71], 0
    v_mov_b32 v113, v116
    v_mov_b32 v115, v117
    v_mfma_f32_16x16x16_bf16 v[76:79], v[92:93], v[72:73], v[76:79]
    s_cbranch_vccnz mega_kernel_rf_w2_pv0
mega_kernel_rf_w2_pv2:
    v_mfma_f32_16x16x16_bf16 v[100:103], v[112:113], v[72:73], v[100:103]
    v_mfma_f32_16x16x16_bf16 v[104:107], v[114:115], v[72:73], v[104:107]
    buffer_load_dwordx4 v[120:123], v1, s[4:7], s44 offen
    buffer_load_dwordx4 v[124:127], v1, s[4:7], s44 offen offset:1024
    s_nop 2
    v_rcp_f32 v76, v76
    s_mov_b64 exec, s[28:29]
    v_pk_mul_f32 v[100:101], v[100:101], v[76:77] op_sel_hi:[1,0]
    v_pk_mul_f32 v[102:103], v[102:103], v[76:77] op_sel_hi:[1,0]
    v_pk_mul_f32 v[104:105], v[104:105], v[76:77] op_sel_hi:[1,0]
    v_pk_mul_f32 v[106:107], v[106:107], v[76:77] op_sel_hi:[1,0]
    v_cvt_pk_bf16_f32 v84, v100, v101
    v_cvt_pk_bf16_f32 v85, v102, v103
    v_cvt_pk_bf16_f32 v86, v104, v105
    v_cvt_pk_bf16_f32 v87, v106, v107
    ds_write_b128 v6, v[84:87] offset:21472
    s_mov_b64 exec, -1
    ds_read_b128 v[88:91], v5 offset:24576
    ds_read_b128 v[92:95], v5 offset:25600
    ds_read_b128 v[112:115], v5 offset:26624
    ds_read_b128 v[116:119], v5 offset:27648
    ds_read_b128 v[96:99], v5 offset:40960
    ds_read_b128 v[100:103], v5 offset:41984
    s_waitcnt lgkmcnt(6)
    s_barrier
    ds_read_b128 v[68:71], v6 offset:20480
    ds_read_b128 v[72:75], v6 offset:21504
    ds_read_b128 v[104:107], v5 offset:43008
    ds_read_b128 v[108:111], v5 offset:44032
    ds_read_b128 v[80:83], v5 offset:57344
    ds_read_b128 v[84:87], v5 offset:58368
    s_waitcnt lgkmcnt(5)
    v_smfmac_f32_16x16x64_bf16 v[32:35], v[68:71], v[128:135], v2
    s_add_u32 s21, s21, 1
    s_xor_b32 s38, s38, 1048576
    s_xor_b32 s37, s37, 1048576
    s_waitcnt lgkmcnt(4)
    v_smfmac_f32_16x16x64_bf16 v[32:35], v[72:75], v[136:143], v2
    s_xor_b32 s40, s40, 1048576
    s_xor_b32 s39, s39, 1048576
    s_lshr_b32 s41, s21, 1
    v_smfmac_f32_16x16x64_bf16 v[36:39], v[68:71], v[144:151], v2
    s_and_b32 s41, s41, 1
    s_xor_b32 s41, s41, 1
    s_xor_b32 s35, s35, 16384
    v_smfmac_f32_16x16x64_bf16 v[36:39], v[72:75], v[152:159], v2
    v_add_f32 v32, v32, v34
    s_xor_b32 s36, s36, 16384
    s_add_u32 s43, s43, 262144
    s_add_u32 s44, s44, 262144
    v_smfmac_f32_16x16x64_bf16 v[40:43], v[68:71], v[160:167], v2
    v_add_f32 v33, v33, v35
    v_smfmac_f32_16x16x64_bf16 v[40:43], v[72:75], v[168:175], v2
    v_cvt_pk_bf16_f32 v32, v32, v33
    v_smfmac_f32_16x16x64_bf16 v[44:47], v[68:71], v[176:183], v2
    v_and_or_b32 v32, v32, -2, s42
    v_smfmac_f32_16x16x64_bf16 v[44:47], v[72:75], v[184:191], v2
    v_add_f32 v36, v36, v38
    v_smfmac_f32_16x16x64_bf16 v[48:51], v[68:71], v[192:199], v2
    v_add_f32 v37, v37, v39
    v_smfmac_f32_16x16x64_bf16 v[48:51], v[72:75], v[200:207], v2
    v_cvt_pk_bf16_f32 v33, v36, v37
    s_waitcnt lgkmcnt(0)
    v_smfmac_f32_16x16x64_bf16 v[52:55], v[68:71], v[88:95], v2
    ds_read_b128 v[88:91], v5 offset:59392
    ds_read_b128 v[92:95], v5 offset:60416
    v_smfmac_f32_16x16x64_bf16 v[52:55], v[72:75], v[112:119], v2
    v_add_f32 v40, v40, v42
    v_smfmac_f32_16x16x64_bf16 v[56:59], v[68:71], v[96:103], v2
    v_add_f32 v41, v41, v43
    v_smfmac_f32_16x16x64_bf16 v[56:59], v[72:75], v[104:111], v2
    v_cvt_pk_bf16_f32 v34, v40, v41
    v_smfmac_f32_16x16x64_bf16 v[60:63], v[68:71], v[80:87], v2
    v_add_f32 v44, v44, v46
    s_waitcnt lgkmcnt(0)
    v_smfmac_f32_16x16x64_bf16 v[60:63], v[72:75], v[88:95], v2
    v_add_f32 v45, v45, v47
    v_cvt_pk_bf16_f32 v35, v44, v45
    buffer_store_dwordx4 v[32:35], v8, s[4:7], s46 offen
    v_pk_add_f32 v[48:49], v[48:49], v[50:51]
    v_cvt_pk_bf16_f32 v48, v48, v49
    v_and_or_b32 v48, v48, -2, s42
    v_pk_add_f32 v[52:53], v[52:53], v[54:55]
    v_cvt_pk_bf16_f32 v49, v52, v53
    v_pk_add_f32 v[56:57], v[56:57], v[58:59]
    v_cvt_pk_bf16_f32 v50, v56, v57
    v_pk_add_f32 v[60:61], v[60:61], v[62:63]
    v_cvt_pk_bf16_f32 v51, v60, v61
    buffer_store_dwordx4 v[48:51], v8, s[4:7], s61 offen
    s_add_u32 s45, s45, 262144
    s_add_u32 s51, s51, 262144
    v_mfma_f32_32x32x8_bf16 v[96:111], v[14:15], v[14:15], 0
    v_mfma_f32_16x16x16_bf16 v[112:115], v[14:15], v[14:15], 0
    v_mfma_f32_16x16x16_bf16 v[116:119], v[14:15], v[14:15], 0
    ds_read_b128 v[64:67], v1 offset:8192
    ds_read_b128 v[68:71], v1 offset:9216
    ds_read_b128 v[72:75], v1 offset:10240
    ds_read_b128 v[76:79], v1 offset:11264
    ds_read_b128 v[80:83], v1 offset:24576
    ds_read_b128 v[84:87], v1 offset:25600
    ds_read_b128 v[88:91], v1 offset:26624
    ds_read_b128 v[92:95], v1 offset:27648
    v_mov_b32 v58, -1
    v_mov_b32 v59, -1
    s_waitcnt vmcnt(0)
mega_kernel_rf_w2_pc:
    buffer_load_dword v36, v13, s[4:7], s25 offen offset:0 sc1
    buffer_load_dword v37, v13, s[4:7], s25 offen offset:256 sc1
    buffer_load_dword v38, v13, s[4:7], s25 offen offset:512 sc1
    buffer_load_dword v39, v13, s[4:7], s25 offen offset:768 sc1
    buffer_load_dword v40, v13, s[4:7], s25 offen offset:1024 sc1
    buffer_load_dword v41, v13, s[4:7], s25 offen offset:1280 sc1
    buffer_load_dword v42, v13, s[4:7], s25 offen offset:1536 sc1
    buffer_load_dword v43, v13, s[4:7], s25 offen offset:1792 sc1
    s_waitcnt vmcnt(4)
    v_mfma_f32_16x16x32_bf16 v[52:55], v[36:39], v[24:27], 0
    v_bitop3_b32 v3, s42, v36, v37 bitop3:0x7e
    v_bitop3_b32 v4, s42, v38, v39 bitop3:0x7e
    s_waitcnt vmcnt(2)
    v_or_b32 v3, v3, v4
    v_bitop3_b32 v4, s42, v40, v41 bitop3:0x7e
    s_waitcnt vmcnt(0)
    v_mfma_f32_16x16x32_bf16 v[52:55], v[40:43], v[24:27], v[52:55]
    v_bitop3_b32 v56, s42, v42, v43 bitop3:0x7e
    v_or3_b32 v3, v3, v4, v56
    v_and_b32 v3, v0, v3
    v_cmp_ne_u32 vcc, 0, v3
    s_nop 3
    v_cvt_pk_bf16_f32 v56, v52, v53
    v_cvt_pk_bf16_f32 v57, v54, v55
    v_min_u32 v56, -2, v56
    s_cbranch_vccnz mega_kernel_rf_w2_pc
    s_mov_b64 exec, s[26:27]
    buffer_store_dwordx2 v[56:57], v9, s[4:7], s35 offen offset:512
    buffer_store_dwordx2 v[58:59], v9, s[4:7], s36 offen offset:512
    s_mov_b64 exec, -1
    s_xor_b32 s42, s42, 1
    s_branch mega_kernel_rf_w2_loop
mega_kernel_rf_w2_last:
    buffer_store_dwordx4 v[64:67], v10, s[4:7], s45 offen offset:128 sc1
    buffer_store_dwordx2 v[18:19], v11, s[4:7], s51 offen offset:3072 sc1
    s_branch mega_kernel_rf_end
mega_kernel_rf_w2_pafail:
    s_nop 7
    v_mov_b32 v96, 0
    v_mov_b32 v97, 0
    v_mov_b32 v98, 0
    v_mov_b32 v99, 0
    v_mov_b32 v100, 0
    v_mov_b32 v101, 0
    v_mov_b32 v102, 0
    v_mov_b32 v103, 0
    v_mov_b32 v104, 0
    v_mov_b32 v105, 0
    v_mov_b32 v106, 0
    v_mov_b32 v107, 0
    s_branch mega_kernel_rf_w2_pa
mega_kernel_rf_w2_xslow:
    buffer_load_dwordx2 v[108:109], v11, s[4:7], s38 offen sc1
    buffer_load_dwordx2 v[110:111], v11, s[4:7], s38 offen offset:512 sc1
    s_waitcnt vmcnt(2)
    v_bitop3_b32 v3, s41, v20, v22 bitop3:0x7e
    v_mfma_f32_16x16x16_bf16 v[80:83], v[20:21], v[16:17], v[100:103]
    v_and_b32 v3, 1, v3
    v_mfma_f32_16x16x16_bf16 v[84:87], v[22:23], v[16:17], v[104:107]
    v_cmp_ne_u32 vcc, 0, v3
    s_cbranch_vccz mega_kernel_rf_w2_xgot
    buffer_load_dwordx2 v[20:21], v11, s[4:7], s38 offen sc1
    buffer_load_dwordx2 v[22:23], v11, s[4:7], s38 offen offset:512 sc1
    s_waitcnt vmcnt(2)
    v_bitop3_b32 v3, s41, v108, v110 bitop3:0x7e
    v_mfma_f32_16x16x16_bf16 v[80:83], v[108:109], v[16:17], v[100:103]
    v_and_b32 v3, 1, v3
    v_mfma_f32_16x16x16_bf16 v[84:87], v[110:111], v[16:17], v[104:107]
    v_cmp_ne_u32 vcc, 0, v3
    s_cbranch_vccz mega_kernel_rf_w2_xgot
    s_branch mega_kernel_rf_w2_xslow
mega_kernel_rf_w2_xgot:
    s_nop 3
    v_cvt_pk_bf16_f32 v64, v80, v81
    v_cvt_pk_bf16_f32 v65, v82, v83
    v_cvt_pk_bf16_f32 v66, v84, v85
    v_cvt_pk_bf16_f32 v67, v86, v87
    ds_write_b128 v6, v[64:67] offset:14336
    s_branch mega_kernel_rf_w2_xok
mega_kernel_rf_w2_pv0:
    s_waitcnt vmcnt(2)
    s_branch mega_kernel_rf_w2_pv1
mega_kernel_rf_w2_pv:
    buffer_load_dwordx2 v[20:21], v11, s[4:7], s40 offen sc1
    s_waitcnt vmcnt(0)
mega_kernel_rf_w2_pv1:
    v_and_b32 v3, 1, v20
    v_cmp_ne_u32 vcc, s41, v3
    v_mov_b32 v113, v20
    v_mov_b32 v115, v21
    s_cbranch_vccnz mega_kernel_rf_w2_pv
    s_branch mega_kernel_rf_w2_pv2
mega_kernel_rf_w3_entry:
    v_mfma_f32_32x32x8_bf16 v[96:111], v[14:15], v[14:15], 0
    v_mfma_f32_16x16x16_bf16 v[112:115], v[14:15], v[14:15], 0
    v_mfma_f32_16x16x16_bf16 v[116:119], v[14:15], v[14:15], 0
    ds_read_b128 v[64:67], v1 offset:12288
    ds_read_b128 v[68:71], v1 offset:13312
    ds_read_b128 v[72:75], v1 offset:14336
    ds_read_b128 v[76:79], v1 offset:15360
    ds_read_b128 v[80:83], v1 offset:28672
    ds_read_b128 v[84:87], v1 offset:29696
    ds_read_b128 v[88:91], v1 offset:30720
    ds_read_b128 v[92:95], v1 offset:31744
    buffer_load_dwordx4 v[120:123], v1, s[4:7], s44 offen
    buffer_load_dwordx4 v[124:127], v1, s[4:7], s44 offen offset:1024
    s_add_u32 s44, s44, 262144
mega_kernel_rf_w3_loop:
    s_add_u32 s22, s35, 6144
    s_waitcnt vmcnt(0)
    buffer_load_dwordx4 v[56:59], v1, s[4:7], s22 offen sc1
    buffer_load_dwordx4 v[60:63], v1, s[4:7], s22 offen offset:1024 sc1
mega_kernel_rf_w3_pa:
    s_waitcnt vmcnt(1)
    ds_write_b128 v6, v[56:59] offset:6144
    s_waitcnt vmcnt(0)
    ds_write_b128 v6, v[60:63] offset:7168
    v_max3_u32 v3, v56, v58, v60
    v_max_u32 v3, v3, v62
    v_cmp_eq_u32 vcc, -1, v3
    v_smfmac_f32_16x16x64_bf16 v[96:99], v[56:59], a[96:103], v2
    buffer_load_dwordx4 v[56:59], v1, s[4:7], s22 offen sc1
    v_smfmac_f32_16x16x64_bf16 v[100:103], v[56:59], a[104:111], v2
    buffer_load_dwordx4 v[60:63], v1, s[4:7], s22 offen offset:1024 sc1
    v_smfmac_f32_16x16x64_bf16 v[104:107], v[56:59], a[224:231], v2
    s_cbranch_vccnz mega_kernel_rf_w3_pafail
    s_waitcnt lgkmcnt(0)
    s_barrier
    ds_read_b128 v[32:35], v6 offset:0
    ds_read_b128 v[36:39], v6 offset:1024
    v_smfmac_f32_16x16x64_bf16 v[108:111], v[56:59], a[232:239], v2
    ds_read_b128 v[40:43], v6 offset:2048
    v_smfmac_f32_16x16x64_bf16 v[96:99], v[60:63], a[112:119], v2
    ds_read_b128 v[44:47], v6 offset:3072
    v_smfmac_f32_16x16x64_bf16 v[100:103], v[60:63], a[120:127], v2
    ds_read_b128 v[48:51], v6 offset:4096
    v_smfmac_f32_16x16x64_bf16 v[104:107], v[60:63], a[240:247], v2
    ds_read_b128 v[52:55], v6 offset:5120
    v_smfmac_f32_16x16x64_bf16 v[108:111], v[60:63], a[248:255], v2
    s_waitcnt lgkmcnt(5)
    v_smfmac_f32_16x16x64_bf16 v[96:99], v[32:35], a[0:7], v2
    v_smfmac_f32_16x16x64_bf16 v[104:107], v[32:35], a[128:135], v2
    s_waitcnt lgkmcnt(4)
    v_smfmac_f32_16x16x64_bf16 v[96:99], v[36:39], a[16:23], v2
    buffer_load_dwordx4 v1, s[4:7], s43 offen lds
    v_smfmac_f32_16x16x64_bf16 v[104:107], v[36:39], a[144:151], v2
    s_waitcnt lgkmcnt(3)
    v_smfmac_f32_16x16x64_bf16 v[96:99], v[40:43], a[32:39], v2
    v_smfmac_f32_16x16x64_bf16 v[104:107], v[40:43], a[160:167], v2
    s_waitcnt lgkmcnt(2)
    v_smfmac_f32_16x16x64_bf16 v[96:99], v[44:47], a[48:55], v2
    buffer_load_dwordx4 v1, s[4:7], s43 offen offset:1024 lds
    v_smfmac_f32_16x16x64_bf16 v[104:107], v[44:47], a[176:183], v2
    s_waitcnt lgkmcnt(1)
    v_smfmac_f32_16x16x64_bf16 v[96:99], v[48:51], a[64:71], v2
    v_smfmac_f32_16x16x64_bf16 v[104:107], v[48:51], a[192:199], v2
    s_waitcnt lgkmcnt(0)
    v_smfmac_f32_16x16x64_bf16 v[96:99], v[52:55], a[80:87], v2
    buffer_load_dword v12, v7, s[4:7], 0 offen sc1
    v_smfmac_f32_16x16x64_bf16 v[104:107], v[52:55], a[208:215], v2
    v_smfmac_f32_16x16x64_bf16 v[100:103], v[32:35], a[8:15], v2
    s_nop 2
    v_smfmac_f32_16x16x64_bf16 v[100:103], v[36:39], a[24:31], v2
    s_nop 2
    v_smfmac_f32_16x16x64_bf16 v[100:103], v[40:43], a[40:47], v2
    v_add_f32 v96, v96, v98
    v_add_f32 v97, v97, v99
    v_smfmac_f32_16x16x64_bf16 v[100:103], v[44:47], a[56:63], v2
    v_add_f32 v104, v104, v106
    v_add_f32 v105, v105, v107
    v_smfmac_f32_16x16x64_bf16 v[100:103], v[48:51], a[72:79], v2
    v_cvt_pk_bf16_f32 v96, v96, v97
    v_cvt_pk_bf16_f32 v97, v104, v105
    v_smfmac_f32_16x16x64_bf16 v[100:103], v[52:55], a[88:95], v2
    v_and_or_b32 v96, v96, -2, s41
    buffer_store_dwordx2 v[96:97], v11, s[4:7], s37 offen sc1
    v_smfmac_f32_16x16x64_bf16 v[108:111], v[32:35], a[136:143], v2
    v_smfmac_f32_16x16x64_bf16 v[108:111], v[36:39], a[152:159], v2
    v_smfmac_f32_16x16x64_bf16 v[108:111], v[40:43], a[168:175], v2
    v_smfmac_f32_16x16x64_bf16 v[108:111], v[44:47], a[184:191], v2
    v_smfmac_f32_16x16x64_bf16 v[108:111], v[48:51], a[200:207], v2
    s_nop 2
    v_add_f32 v100, v100, v102
    v_smfmac_f32_16x16x64_bf16 v[108:111], v[52:55], a[216:223], v2
    v_add_f32 v101, v101, v103
    v_cvt_pk_bf16_f32 v98, v100, v101
    v_and_or_b32 v98, v98, -2, s41
    s_nop 4
    v_pk_add_f32 v[108:109], v[108:109], v[110:111]
    v_cvt_pk_bf16_f32 v99, v108, v109
    buffer_store_dwordx2 v[98:99], v11, s[4:7], s37 offen offset:512 sc1
    v_smfmac_f32_16x16x64_bf16 v[112:115], v[32:35], v[64:71], v2
    ds_read_b128 v[64:67], v1 offset:45056
    ds_read_b128 v[68:71], v1 offset:46080
    v_smfmac_f32_16x16x64_bf16 v[116:119], v[32:35], v[72:79], v2
    ds_read_b128 v[72:75], v1 offset:47104
    ds_read_b128 v[76:79], v1 offset:48128
    v_smfmac_f32_16x16x64_bf16 v[112:115], v[36:39], v[80:87], v2
    ds_read_b128 v[80:83], v1 offset:61440
    ds_read_b128 v[84:87], v1 offset:62464
    v_smfmac_f32_16x16x64_bf16 v[116:119], v[36:39], v[88:95], v2
    ds_read_b128 v[88:91], v1 offset:63488
    ds_read_b128 v[92:95], v1 offset:64512
    v_smfmac_f32_16x16x64_bf16 v[112:115], v[52:55], v[208:215], v2
    v_smfmac_f32_16x16x64_bf16 v[116:119], v[52:55], v[216:223], v2
    v_smfmac_f32_16x16x64_bf16 v[112:115], v[56:59], v[224:231], v2
    s_waitcnt lgkmcnt(6)
    v_smfmac_f32_16x16x64_bf16 v[112:115], v[40:43], v[64:71], v2
    ds_read_b128 v[64:67], v5 offset:12288
    ds_read_b128 v[68:71], v5 offset:13312
    s_waitcnt lgkmcnt(6)
    v_smfmac_f32_16x16x64_bf16 v[116:119], v[40:43], v[72:79], v2
    ds_read_b128 v[72:75], v5 offset:14336
    ds_read_b128 v[76:79], v5 offset:15360
    v_smfmac_f32_16x16x64_bf16 v[116:119], v[56:59], v[232:239], v2
    v_smfmac_f32_16x16x64_bf16 v[112:115], v[60:63], v[240:247], v2
    v_smfmac_f32_16x16x64_bf16 v[116:119], v[60:63], v[248:255], v2
    s_waitcnt lgkmcnt(6)
    v_smfmac_f32_16x16x64_bf16 v[112:115], v[44:47], v[80:87], v2
    s_waitcnt lgkmcnt(4)
    v_smfmac_f32_16x16x64_bf16 v[116:119], v[44:47], v[88:95], v2
    s_waitcnt lgkmcnt(2)
    v_smfmac_f32_16x16x64_bf16 v[112:115], v[48:51], v[64:71], v2
    s_waitcnt lgkmcnt(0)
    v_smfmac_f32_16x16x64_bf16 v[116:119], v[48:51], v[72:79], v2
    v_mfma_f32_16x16x16_bf16 v[100:103], v[96:97], v[16:17], 0
    v_mfma_f32_16x16x16_bf16 v[104:107], v[98:99], v[16:17], 0
    s_nop 4
    v_add_f32 v112, v112, v114
    v_add_f32 v113, v113, v115
    v_add_f32 v114, v116, v118
    v_add_f32 v115, v117, v119
    v_cvt_pk_bf16_f32 v18, v112, v113
    v_cvt_pk_bf16_f32 v19, v114, v115
    v_and_or_b32 v18, v18, -2, s41
    v_mov_b32 v112, v18
    v_mov_b32 v114, v19
    v_mov_b32 v92, v28
    v_mov_b32 v93, 0
    s_waitcnt vmcnt(3)
    s_barrier
    ds_read_b128 v[32:35], v6 offset:18432
    ds_read_b128 v[36:39], v6 offset:19456
    ds_read_b128 v[40:43], v6 offset:15360
    ds_read_b128 v[44:47], v6 offset:16384
    buffer_load_dwordx2 v[108:109], v11, s[4:7], s38 offen sc1
    ds_read_b128 v[48:51], v6 offset:12288
    ds_read_b128 v[52:55], v6 offset:13312
    ds_read_b128 v[56:59], v6 offset:9216
    ds_read_b128 v[60:63], v6 offset:10240
    buffer_load_dwordx2 v[110:111], v11, s[4:7], s38 offen offset:512 sc1
    s_barrier
    buffer_store_dwordx2 v[18:19], v11, s[4:7], s39 offen sc1
    s_nop 15
    s_nop 15
    buffer_load_dwordx2 v[20:21], v11, s[4:7], s38 offen sc1
    buffer_load_dwordx2 v[22:23], v11, s[4:7], s38 offen offset:512 sc1
    s_waitcnt vmcnt(4)
    v_mfma_f32_16x16x16_bf16 v[80:83], v[108:109], v[16:17], v[100:103]
    v_and_b32 v3, 1, v108
    v_cmp_ne_u32 vcc, s41, v3
    s_nop 5
    v_cvt_pk_bf16_f32 v64, v80, v81
    v_cvt_pk_bf16_f32 v65, v82, v83
    s_cbranch_vccnz mega_kernel_rf_w3_xslow
    s_waitcnt vmcnt(3)
    v_mfma_f32_16x16x16_bf16 v[84:87], v[110:111], v[16:17], v[104:107]
    v_and_b32 v3, 1, v110
    v_cmp_ne_u32 vcc, s41, v3
    s_nop 5
    v_cvt_pk_bf16_f32 v66, v84, v85
    v_cvt_pk_bf16_f32 v67, v86, v87
    ds_write_b128 v6, v[64:67] offset:17408
    s_cbranch_vccnz mega_kernel_rf_w3_xslow
mega_kernel_rf_w3_xok:
    s_cmp_eq_u32 s21, 63
    s_cbranch_scc1 mega_kernel_rf_w3_last
    buffer_load_dwordx2 v[116:117], v11, s[4:7], s40 offen sc1
    s_waitcnt lgkmcnt(1)
    v_mfma_f32_16x16x32_bf16 v[80:83], v[32:35], v[64:67], 0
    s_waitcnt lgkmcnt(0)
    s_barrier
    ds_read_b128 v[68:71], v6 offset:14336
    ds_read_b128 v[72:75], v6 offset:11264
    ds_read_b128 v[76:79], v6 offset:8192
    v_mfma_f32_16x16x32_bf16 v[84:87], v[36:39], v[64:67], 0
    v_mfma_f32_16x16x32_bf16 v[88:91], v[64:67], v[64:67], 0
    buffer_load_dwordx2 v[20:21], v11, s[4:7], s40 offen sc1
    s_waitcnt lgkmcnt(2)
    v_mfma_f32_16x16x32_bf16 v[80:83], v[40:43], v[68:71], v[80:83]
    s_waitcnt lgkmcnt(1)
    v_mfma_f32_16x16x32_bf16 v[80:83], v[48:51], v[72:75], v[80:83]
    s_waitcnt lgkmcnt(0)
    v_mfma_f32_16x16x32_bf16 v[80:83], v[56:59], v[76:79], v[80:83]
    v_mfma_f32_16x16x32_bf16 v[84:87], v[44:47], v[68:71], v[84:87]
    buffer_store_dwordx4 v[64:67], v10, s[4:7], s45 offen offset:192 sc1
    v_mfma_f32_16x16x32_bf16 v[84:87], v[52:55], v[72:75], v[84:87]
    v_mfma_f32_16x16x32_bf16 v[84:87], v[60:63], v[76:79], v[84:87]
    v_mfma_f32_16x16x32_bf16 v[88:91], v[68:71], v[68:71], v[88:91]
    v_mfma_f32_16x16x32_bf16 v[88:91], v[72:75], v[72:75], v[88:91]
    buffer_store_dwordx2 v[18:19], v11, s[4:7], s51 offen offset:3584 sc1
    v_mfma_f32_16x16x32_bf16 v[88:91], v[76:79], v[76:79], v[88:91]
    v_mfma_f32_32x32x4_2b_bf16 v[32:63], v[14:15], v[14:15], 0
    s_nop 0
    v_max3_f32 v4, v80, v81, v82
    s_nop 1
    v_max3_f32 v4, v4, v83, v84
    v_max3_f32 v4, v4, v85, v86
    v_max_f32 v4, v4, v87
    v_max3_f32 v90, v4, v88, v89
    v_max3_f32 v4, v4, v88, v89
    s_nop 1
    v_permlane16_swap_b32 v4, v90
    v_max_f32 v4, v4, v90
    v_max_f32 v90, v4, v90
    s_nop 1
    v_permlane32_swap_b32 v4, v90
    v_max_f32 v4, v4, v90
    v_mul_f32 v4, s34, v4
    v_pk_fma_f32 v[80:81], v[80:81], s[34:35], v[4:5] op_sel_hi:[1,0,0] neg_lo:[0,0,1] neg_hi:[0,0,1]
    v_pk_fma_f32 v[82:83], v[82:83], s[34:35], v[4:5] op_sel_hi:[1,0,0] neg_lo:[0,0,1] neg_hi:[0,0,1]
    v_pk_fma_f32 v[84:85], v[84:85], s[34:35], v[4:5] op_sel_hi:[1,0,0] neg_lo:[0,0,1] neg_hi:[0,0,1]
    v_pk_fma_f32 v[86:87], v[86:87], s[34:35], v[4:5] op_sel_hi:[1,0,0] neg_lo:[0,0,1] neg_hi:[0,0,1]
    v_pk_fma_f32 v[88:89], v[88:89], s[34:35], v[4:5] op_sel_hi:[1,0,0] neg_lo:[0,0,1] neg_hi:[0,0,1]
    v_exp_f32 v80, v80
    v_exp_f32 v81, v81
    v_exp_f32 v82, v82
    v_cvt_pk_bf16_f32 v68, v80, v81
    v_exp_f32 v83, v83
    v_exp_f32 v84, v84
    v_cvt_pk_bf16_f32 v69, v82, v83
    v_exp_f32 v85, v85
    v_exp_f32 v86, v86
    v_cvt_pk_bf16_f32 v70, v84, v85
    v_exp_f32 v87, v87
    v_exp_f32 v88, v88
    v_cvt_pk_bf16_f32 v71, v86, v87
    v_exp_f32 v89, v89
    s_waitcnt vmcnt(3)
    v_mfma_f32_16x16x32_bf16 v[76:79], v[28:31], v[68:71], 0
    v_and_b32 v3, 1, v116
    v_cvt_pk_bf16_f32 v72, v88, v89
    v_mfma_f32_16x16x32_bf16 v[100:103], v[120:123], v[68:71], 0
    v_cmp_ne_u32 vcc, s41, v3
    v_cvt_pk_bf16_f32 v73, v88, v89
    v_mfma_f32_16x16x32_bf16 v[104:107], v[124:127], v[68:71], 0
    v_mov_b32 v113, v116
    v_mov_b32 v115, v117
    v_mfma_f32_16x16x16_bf16 v[76:79], v[92:93], v[72:73], v[76:79]
    s_cbranch_vccnz mega_kernel_rf_w3_pv0
mega_kernel_rf_w3_pv2:
    v_mfma_f32_16x16x16_bf16 v[100:103], v[112:113], v[72:73], v[100:103]
    v_mfma_f32_16x16x16_bf16 v[104:107], v[114:115], v[72:73], v[104:107]
    buffer_load_dwordx4 v[120:123], v1, s[4:7], s44 offen
    buffer_load_dwordx4 v[124:127], v1, s[4:7], s44 offen offset:1024
    s_nop 2
    v_rcp_f32 v76, v76
    s_mov_b64 exec, s[28:29]
    v_pk_mul_f32 v[100:101], v[100:101], v[76:77] op_sel_hi:[1,0]
    v_pk_mul_f32 v[102:103], v[102:103], v[76:77] op_sel_hi:[1,0]
    v_pk_mul_f32 v[104:105], v[104:105], v[76:77] op_sel_hi:[1,0]
    v_pk_mul_f32 v[106:107], v[106:107], v[76:77] op_sel_hi:[1,0]
    v_cvt_pk_bf16_f32 v84, v100, v101
    v_cvt_pk_bf16_f32 v85, v102, v103
    v_cvt_pk_bf16_f32 v86, v104, v105
    v_cvt_pk_bf16_f32 v87, v106, v107
    ds_write_b128 v6, v[84:87] offset:21504
    s_mov_b64 exec, -1
    ds_read_b128 v[88:91], v5 offset:28672
    ds_read_b128 v[92:95], v5 offset:29696
    ds_read_b128 v[112:115], v5 offset:30720
    ds_read_b128 v[116:119], v5 offset:31744
    ds_read_b128 v[96:99], v5 offset:45056
    ds_read_b128 v[100:103], v5 offset:46080
    s_waitcnt lgkmcnt(6)
    s_barrier
    ds_read_b128 v[68:71], v6 offset:20480
    ds_read_b128 v[72:75], v6 offset:21504
    ds_read_b128 v[104:107], v5 offset:47104
    ds_read_b128 v[108:111], v5 offset:48128
    ds_read_b128 v[80:83], v5 offset:61440
    ds_read_b128 v[84:87], v5 offset:62464
    s_waitcnt lgkmcnt(5)
    v_smfmac_f32_16x16x64_bf16 v[32:35], v[68:71], v[128:135], v2
    s_add_u32 s21, s21, 1
    s_xor_b32 s38, s38, 1048576
    s_xor_b32 s37, s37, 1048576
    s_waitcnt lgkmcnt(4)
    v_smfmac_f32_16x16x64_bf16 v[32:35], v[72:75], v[136:143], v2
    s_xor_b32 s40, s40, 1048576
    s_xor_b32 s39, s39, 1048576
    s_lshr_b32 s41, s21, 1
    v_smfmac_f32_16x16x64_bf16 v[36:39], v[68:71], v[144:151], v2
    s_and_b32 s41, s41, 1
    s_xor_b32 s41, s41, 1
    s_xor_b32 s35, s35, 16384
    v_smfmac_f32_16x16x64_bf16 v[36:39], v[72:75], v[152:159], v2
    v_add_f32 v32, v32, v34
    s_xor_b32 s36, s36, 16384
    s_add_u32 s43, s43, 262144
    s_add_u32 s44, s44, 262144
    v_smfmac_f32_16x16x64_bf16 v[40:43], v[68:71], v[160:167], v2
    v_add_f32 v33, v33, v35
    v_smfmac_f32_16x16x64_bf16 v[40:43], v[72:75], v[168:175], v2
    v_cvt_pk_bf16_f32 v32, v32, v33
    v_smfmac_f32_16x16x64_bf16 v[44:47], v[68:71], v[176:183], v2
    v_and_or_b32 v32, v32, -2, s42
    v_smfmac_f32_16x16x64_bf16 v[44:47], v[72:75], v[184:191], v2
    v_add_f32 v36, v36, v38
    v_smfmac_f32_16x16x64_bf16 v[48:51], v[68:71], v[192:199], v2
    v_add_f32 v37, v37, v39
    v_smfmac_f32_16x16x64_bf16 v[48:51], v[72:75], v[200:207], v2
    v_cvt_pk_bf16_f32 v33, v36, v37
    s_waitcnt lgkmcnt(0)
    v_smfmac_f32_16x16x64_bf16 v[52:55], v[68:71], v[88:95], v2
    ds_read_b128 v[88:91], v5 offset:63488
    ds_read_b128 v[92:95], v5 offset:64512
    v_smfmac_f32_16x16x64_bf16 v[52:55], v[72:75], v[112:119], v2
    v_add_f32 v40, v40, v42
    v_smfmac_f32_16x16x64_bf16 v[56:59], v[68:71], v[96:103], v2
    v_add_f32 v41, v41, v43
    v_smfmac_f32_16x16x64_bf16 v[56:59], v[72:75], v[104:111], v2
    v_cvt_pk_bf16_f32 v34, v40, v41
    v_smfmac_f32_16x16x64_bf16 v[60:63], v[68:71], v[80:87], v2
    v_add_f32 v44, v44, v46
    s_waitcnt lgkmcnt(0)
    v_smfmac_f32_16x16x64_bf16 v[60:63], v[72:75], v[88:95], v2
    v_add_f32 v45, v45, v47
    v_cvt_pk_bf16_f32 v35, v44, v45
    buffer_store_dwordx4 v[32:35], v8, s[4:7], s46 offen
    v_pk_add_f32 v[48:49], v[48:49], v[50:51]
    v_cvt_pk_bf16_f32 v48, v48, v49
    v_and_or_b32 v48, v48, -2, s42
    v_pk_add_f32 v[52:53], v[52:53], v[54:55]
    v_cvt_pk_bf16_f32 v49, v52, v53
    v_pk_add_f32 v[56:57], v[56:57], v[58:59]
    v_cvt_pk_bf16_f32 v50, v56, v57
    v_pk_add_f32 v[60:61], v[60:61], v[62:63]
    v_cvt_pk_bf16_f32 v51, v60, v61
    buffer_store_dwordx4 v[48:51], v8, s[4:7], s61 offen
    s_add_u32 s45, s45, 262144
    s_add_u32 s51, s51, 262144
    v_mfma_f32_32x32x8_bf16 v[96:111], v[14:15], v[14:15], 0
    v_mfma_f32_16x16x16_bf16 v[112:115], v[14:15], v[14:15], 0
    v_mfma_f32_16x16x16_bf16 v[116:119], v[14:15], v[14:15], 0
    ds_read_b128 v[64:67], v1 offset:12288
    ds_read_b128 v[68:71], v1 offset:13312
    ds_read_b128 v[72:75], v1 offset:14336
    ds_read_b128 v[76:79], v1 offset:15360
    ds_read_b128 v[80:83], v1 offset:28672
    ds_read_b128 v[84:87], v1 offset:29696
    ds_read_b128 v[88:91], v1 offset:30720
    ds_read_b128 v[92:95], v1 offset:31744
    s_add_u32 s22, s21, 2
    s_cmp_gt_u32 s50, s22
    s_cbranch_scc1 mega_kernel_rf_w3_kvs
    v_readlane_b32 s50, v12, 0
    v_readlane_b32 s22, v12, 2
    v_readlane_b32 s23, v12, 1
    v_readlane_b32 s24, v12, 3
    s_nop 3
    s_min_u32 s50, s50, s22
    s_min_u32 s23, s23, s24
    s_lshl_b32 s50, s50, 1
    s_lshl_b32 s23, s23, 1
    s_add_u32 s23, s23, 1
    s_min_u32 s50, s50, s23
mega_kernel_rf_kvb1:
    s_add_u32 s22, s21, 1
    s_min_u32 s22, s22, 63
    s_cmp_gt_u32 s50, s22
    s_cbranch_scc1 mega_kernel_rf_kvd1
    buffer_load_dword v12, v7, s[4:7], 0 offen sc1
    s_waitcnt vmcnt(0)
    v_readlane_b32 s50, v12, 0
    v_readlane_b32 s22, v12, 2
    v_readlane_b32 s23, v12, 1
    v_readlane_b32 s24, v12, 3
    s_nop 3
    s_min_u32 s50, s50, s22
    s_min_u32 s23, s23, s24
    s_lshl_b32 s50, s50, 1
    s_lshl_b32 s23, s23, 1
    s_add_u32 s23, s23, 1
    s_min_u32 s50, s50, s23
    s_branch mega_kernel_rf_kvb1
mega_kernel_rf_kvd1:
mega_kernel_rf_w3_kvs:
    v_mov_b32 v58, -1
    v_mov_b32 v59, -1
    s_waitcnt vmcnt(0)
mega_kernel_rf_w3_pc:
    buffer_load_dword v36, v13, s[4:7], s25 offen offset:0 sc1
    buffer_load_dword v37, v13, s[4:7], s25 offen offset:256 sc1
    buffer_load_dword v38, v13, s[4:7], s25 offen offset:512 sc1
    buffer_load_dword v39, v13, s[4:7], s25 offen offset:768 sc1
    buffer_load_dword v40, v13, s[4:7], s25 offen offset:1024 sc1
    buffer_load_dword v41, v13, s[4:7], s25 offen offset:1280 sc1
    buffer_load_dword v42, v13, s[4:7], s25 offen offset:1536 sc1
    buffer_load_dword v43, v13, s[4:7], s25 offen offset:1792 sc1
    s_waitcnt vmcnt(4)
    v_mfma_f32_16x16x32_bf16 v[52:55], v[36:39], v[24:27], 0
    v_bitop3_b32 v3, s42, v36, v37 bitop3:0x7e
    v_bitop3_b32 v4, s42, v38, v39 bitop3:0x7e
    s_waitcnt vmcnt(2)
    v_or_b32 v3, v3, v4
    v_bitop3_b32 v4, s42, v40, v41 bitop3:0x7e
    s_waitcnt vmcnt(0)
    v_mfma_f32_16x16x32_bf16 v[52:55], v[40:43], v[24:27], v[52:55]
    v_bitop3_b32 v56, s42, v42, v43 bitop3:0x7e
    v_or3_b32 v3, v3, v4, v56
    v_and_b32 v3, v0, v3
    v_cmp_ne_u32 vcc, 0, v3
    s_nop 3
    v_cvt_pk_bf16_f32 v56, v52, v53
    v_cvt_pk_bf16_f32 v57, v54, v55
    v_min_u32 v56, -2, v56
    s_cbranch_vccnz mega_kernel_rf_w3_pc
    s_mov_b64 exec, s[26:27]
    buffer_store_dwordx2 v[56:57], v9, s[4:7], s35 offen offset:768
    buffer_store_dwordx2 v[58:59], v9, s[4:7], s36 offen offset:768
    s_mov_b64 exec, -1
    s_xor_b32 s42, s42, 1
    s_branch mega_kernel_rf_w3_loop
mega_kernel_rf_w3_last:
    buffer_store_dwordx4 v[64:67], v10, s[4:7], s45 offen offset:192 sc1
    buffer_store_dwordx2 v[18:19], v11, s[4:7], s51 offen offset:3584 sc1
    s_branch mega_kernel_rf_end
mega_kernel_rf_w3_pafail:
    s_nop 7
    v_mov_b32 v96, 0
    v_mov_b32 v97, 0
    v_mov_b32 v98, 0
    v_mov_b32 v99, 0
    v_mov_b32 v100, 0
    v_mov_b32 v101, 0
    v_mov_b32 v102, 0
    v_mov_b32 v103, 0
    v_mov_b32 v104, 0
    v_mov_b32 v105, 0
    v_mov_b32 v106, 0
    v_mov_b32 v107, 0
    s_branch mega_kernel_rf_w3_pa
mega_kernel_rf_w3_xslow:
    buffer_load_dwordx2 v[108:109], v11, s[4:7], s38 offen sc1
    buffer_load_dwordx2 v[110:111], v11, s[4:7], s38 offen offset:512 sc1
    s_waitcnt vmcnt(2)
    v_bitop3_b32 v3, s41, v20, v22 bitop3:0x7e
    v_mfma_f32_16x16x16_bf16 v[80:83], v[20:21], v[16:17], v[100:103]
    v_and_b32 v3, 1, v3
    v_mfma_f32_16x16x16_bf16 v[84:87], v[22:23], v[16:17], v[104:107]
    v_cmp_ne_u32 vcc, 0, v3
    s_cbranch_vccz mega_kernel_rf_w3_xgot
    buffer_load_dwordx2 v[20:21], v11, s[4:7], s38 offen sc1
    buffer_load_dwordx2 v[22:23], v11, s[4:7], s38 offen offset:512 sc1
    s_waitcnt vmcnt(2)
    v_bitop3_b32 v3, s41, v108, v110 bitop3:0x7e
    v_mfma_f32_16x16x16_bf16 v[80:83], v[108:109], v[16:17], v[100:103]
    v_and_b32 v3, 1, v3
    v_mfma_f32_16x16x16_bf16 v[84:87], v[110:111], v[16:17], v[104:107]
    v_cmp_ne_u32 vcc, 0, v3
    s_cbranch_vccz mega_kernel_rf_w3_xgot
    s_branch mega_kernel_rf_w3_xslow
mega_kernel_rf_w3_xgot:
    s_nop 3
    v_cvt_pk_bf16_f32 v64, v80, v81
    v_cvt_pk_bf16_f32 v65, v82, v83
    v_cvt_pk_bf16_f32 v66, v84, v85
    v_cvt_pk_bf16_f32 v67, v86, v87
    ds_write_b128 v6, v[64:67] offset:17408
    s_branch mega_kernel_rf_w3_xok
mega_kernel_rf_w3_pv0:
    s_waitcnt vmcnt(2)
    s_branch mega_kernel_rf_w3_pv1
mega_kernel_rf_w3_pv:
    buffer_load_dwordx2 v[20:21], v11, s[4:7], s40 offen sc1
    s_waitcnt vmcnt(0)
mega_kernel_rf_w3_pv1:
    v_and_b32 v3, 1, v20
    v_cmp_ne_u32 vcc, s41, v3
    v_mov_b32 v113, v20
    v_mov_b32 v115, v21
    s_cbranch_vccnz mega_kernel_rf_w3_pv
    s_branch mega_kernel_rf_w3_pv2
mega_kernel_rf_end:
    s_mov_b64 exec, -1
    v_mov_b32 v3, 64
    s_waitcnt vmcnt(0)
    s_barrier
    s_cmp_lg_u32 s20, 0
    s_cbranch_scc1 mega_kernel_rf_end2
    buffer_store_dword v3, v7, s[4:7], 0 offen sc1
mega_kernel_rf_end2:
    s_waitcnt vmcnt(0)
    s_endpgm
mega_kernel_recs:
    s_load_dwordx2 s[4:5], s[0:1], 96
    s_load_dwordx2 s[12:13], s[0:1], 88
    s_load_dwordx2 s[50:51], s[0:1], 16
    s_load_dwordx2 s[52:53], s[0:1], 24
    s_load_dwordx2 s[54:55], s[0:1], 32
    s_load_dwordx2 s[56:57], s[0:1], 40
    s_load_dwordx2 s[58:59], s[0:1], 8
    v_lshrrev_b32 v3, 6, v0
    v_and_b32 v40, 63, v0
    v_readfirstlane_b32 s20, v3
    v_lshrrev_b32 v41, 4, v40
    v_and_b32 v42, 15, v40
    v_lshlrev_b32 v1, 4, v40
    s_mov_b32 s49, 0
    s_waitcnt lgkmcnt(0)
    s_mov_b32 s6, 268435456
    s_mov_b32 s7, 0x00020000
    s_mov_b32 s14, 256
    s_mov_b32 s15, 0x00020000
    s_mov_b32 s10, 8388608
    s_mov_b32 s11, 0x00020000
    s_mov_b32 s26, 0x00030003
    s_mov_b32 s27, 0x00030003
    s_mov_b32 s28, 0xcccccccc
    s_mov_b32 s29, 0xcccccccc
    s_mov_b32 s32, 0x33333333
    s_mov_b32 s33, 0x33333333
    s_mov_b32 s34, 0x3e0293ee
    s_lshl_b32 s22, s20, 2
    v_xor_b32 v3, s22, v42
    v_lshlrev_b32 v3, 4, v3
    v_lshl_add_u32 v4, v41, 4, s20
    v_lshl_add_u32 v44, v4, 13, v3
    s_lshl_b32 s22, s30, 22
    s_lshl_b32 s23, s31, 8
    s_add_u32 s22, s22, s23
    v_add_u32 v44, s22, v44
    s_lshr_b32 s22, s20, 1
    s_lshl_b32 s22, s22, 5
    s_and_b32 s23, s20, 1
    s_lshl_b32 s23, s23, 2
    s_add_u32 s22, s22, s23
    s_lshl_b32 s23, s31, 7
    s_add_u32 s22, s22, s23
    v_add_u32 v4, s22, v41
    v_lshl_add_u32 v45, v4, 11, v3
    s_lshl_b32 s22, s30, 10
    v_add_u32 v45, s22, v45
    s_lshl_b32 s48, s20, 10
    s_mov_b32 s8, s50
    s_mov_b32 s9, s51
    s_add_u32 m0, s48, 0
    s_mov_b32 s22, 0
    buffer_load_dwordx4 v44, s[8:11], s22 offen  lds
    s_add_u32 m0, s48, 4096
    s_mov_b32 s22, 32768
    buffer_load_dwordx4 v44, s[8:11], s22 offen  lds
    s_add_u32 m0, s48, 8192
    s_mov_b32 s22, 65536
    buffer_load_dwordx4 v44, s[8:11], s22 offen  lds
    s_add_u32 m0, s48, 12288
    s_mov_b32 s22, 98304
    buffer_load_dwordx4 v44, s[8:11], s22 offen  lds
    s_add_u32 m0, s48, 16384
    s_mov_b32 s22, 524288
    buffer_load_dwordx4 v44, s[8:11], s22 offen  lds
    s_add_u32 m0, s48, 20480
    s_mov_b32 s22, 557056
    buffer_load_dwordx4 v44, s[8:11], s22 offen  lds
    s_add_u32 m0, s48, 24576
    s_mov_b32 s22, 589824
    buffer_load_dwordx4 v44, s[8:11], s22 offen  lds
    s_add_u32 m0, s48, 28672
    s_mov_b32 s22, 622592
    buffer_load_dwordx4 v44, s[8:11], s22 offen  lds
    s_add_u32 m0, s48, 32768
    s_mov_b32 s22, 1048576
    buffer_load_dwordx4 v44, s[8:11], s22 offen  lds
    s_add_u32 m0, s48, 36864
    s_mov_b32 s22, 1081344
    buffer_load_dwordx4 v44, s[8:11], s22 offen  lds
    s_add_u32 m0, s48, 40960
    s_mov_b32 s22, 1114112
    buffer_load_dwordx4 v44, s[8:11], s22 offen  lds
    s_add_u32 m0, s48, 45056
    s_mov_b32 s22, 1146880
    buffer_load_dwordx4 v44, s[8:11], s22 offen  lds
    s_add_u32 m0, s48, 49152
    s_mov_b32 s22, 1572864
    buffer_load_dwordx4 v44, s[8:11], s22 offen  lds
    s_add_u32 m0, s48, 53248
    s_mov_b32 s22, 1605632
    buffer_load_dwordx4 v44, s[8:11], s22 offen  lds
    s_add_u32 m0, s48, 57344
    s_mov_b32 s22, 1638400
    buffer_load_dwordx4 v44, s[8:11], s22 offen  lds
    s_add_u32 m0, s48, 61440
    s_mov_b32 s22, 1671168
    buffer_load_dwordx4 v44, s[8:11], s22 offen  lds
    s_add_u32 m0, s48, 65536
    s_mov_b32 s22, 2097152
    buffer_load_dwordx4 v44, s[8:11], s22 offen  lds
    s_add_u32 m0, s48, 69632
    s_mov_b32 s22, 2129920
    buffer_load_dwordx4 v44, s[8:11], s22 offen  lds
    s_add_u32 m0, s48, 73728
    s_mov_b32 s22, 2162688
    buffer_load_dwordx4 v44, s[8:11], s22 offen  lds
    s_add_u32 m0, s48, 77824
    s_mov_b32 s22, 2195456
    buffer_load_dwordx4 v44, s[8:11], s22 offen  lds
    s_add_u32 m0, s48, 81920
    s_mov_b32 s22, 2621440
    buffer_load_dwordx4 v44, s[8:11], s22 offen  lds
    s_add_u32 m0, s48, 86016
    s_mov_b32 s22, 2654208
    buffer_load_dwordx4 v44, s[8:11], s22 offen  lds
    s_add_u32 m0, s48, 90112
    s_mov_b32 s22, 2686976
    buffer_load_dwordx4 v44, s[8:11], s22 offen  lds
    s_add_u32 m0, s48, 94208
    s_mov_b32 s22, 2719744
    buffer_load_dwordx4 v44, s[8:11], s22 offen  lds
    s_add_u32 m0, s48, 98304
    s_mov_b32 s22, 3145728
    buffer_load_dwordx4 v44, s[8:11], s22 offen  lds
    s_add_u32 m0, s48, 102400
    s_mov_b32 s22, 3178496
    buffer_load_dwordx4 v44, s[8:11], s22 offen  lds
    s_add_u32 m0, s48, 106496
    s_mov_b32 s22, 3211264
    buffer_load_dwordx4 v44, s[8:11], s22 offen  lds
    s_add_u32 m0, s48, 110592
    s_mov_b32 s22, 3244032
    buffer_load_dwordx4 v44, s[8:11], s22 offen  lds
    s_add_u32 m0, s48, 114688
    s_mov_b32 s22, 3670016
    buffer_load_dwordx4 v44, s[8:11], s22 offen  lds
    s_add_u32 m0, s48, 118784
    s_mov_b32 s22, 3702784
    buffer_load_dwordx4 v44, s[8:11], s22 offen  lds
    s_add_u32 m0, s48, 122880
    s_mov_b32 s22, 3735552
    buffer_load_dwordx4 v44, s[8:11], s22 offen  lds
    s_add_u32 m0, s48, 126976
    s_mov_b32 s22, 3768320
    buffer_load_dwordx4 v44, s[8:11], s22 offen  lds
    s_lshl_b32 s22, s30, 5
    s_add_u32 s22, s22, s31
    s_lshl_b32 s38, s22, 14
    s_xor_b32 s22, s22, 32
    s_lshl_b32 s37, s22, 14
    s_add_u32 s38, s38, 67108864
    s_add_u32 s37, s37, 67108864
    s_lshl_b32 s46, s30, 19
    s_add_u32 s46, s46, 70254592
    s_mul_i32 s22, s31, 8448
    s_add_u32 s47, s46, s22
    s_mul_i32 s22, s20, 67584
    s_add_u32 s46, s46, s22
    s_lshl_b32 s22, s31, 6
    s_add_u32 s46, s46, s22
    s_add_u32 s61, s46, 33792
    s_mul_i32 s22, s20, 2048
    s_add_u32 s25, s47, s22
    s_lshl_b32 s35, s30, 13
    s_add_u32 s35, s35, 69206016
    v_lshrrev_b32 v53, 2, v42
    v_lshlrev_b32 v53, 1, v53
    v_and_b32 v54, 1, v42
    v_add_u32 v55, v53, v54
    v_mov_b32 v14, 0
    v_mov_b32 v15, 0
    v_mov_b32 v2, 0x4444
    v_mov_b32 v3, 0xeeee
    v_cndmask_b32 v2, v2, v3, s[28:29]
    s_lshl_b32 s22, s20, 12
    v_add_u32 v32, s22, v1
    v_add_u32 v33, 0x10000, v32
    v_add_u32 v5, 0x10000, v1
    v_add_u32 v6, 131072, v1
    v_and_b32 v3, 3, v42
    v_bfe_u32 v43, v40, 1, 1
    v_lshlrev_b32 v7, 13, v43
    v_and_b32 v43, 1, v40
    v_lshl_add_u32 v7, v43, 7, v7
    s_lshl_b32 s22, s31, 8
    s_add_u32 s23, s22, 71311360
    v_add_u32 v7, s23, v7
    s_cmp_lg_u32 s20, 0
    s_cbranch_scc1 mega_kernel_rs_flk
    s_lshl_b32 s23, s30, 7
    s_add_u32 s22, s22, s23
    s_add_u32 s22, s22, 71327744
    v_bfrev_b32 v7, 1
    v_writelane_b32 v7, s22, 0
mega_kernel_rs_flk:
    v_lshlrev_b32 v11, 3, v40
    v_lshlrev_b32 v10, 8, v55
    v_lshl_add_u32 v10, v41, 4, v10
    v_mul_u32_u24 v8, 8448, v41
    v_lshl_add_u32 v8, v3, 4, v8
    v_lshrrev_b32 v4, 2, v42
    v_mul_u32_u24 v4, 2048, v4
    v_add_u32 v8, v4, v8
    v_lshrrev_b32 v9, 1, v41
    v_lshlrev_b32 v9, 5, v9
    v_and_b32 v4, 1, v42
    v_lshl_add_u32 v9, v4, 4, v9
    v_and_b32 v4, 1, v41
    v_lshl_add_u32 v9, v4, 3, v9
    s_lshr_b32 s22, s31, 2
    s_lshl_b32 s22, s22, 10
    s_and_b32 s23, s31, 3
    s_lshl_b32 s23, s23, 6
    s_add_u32 s22, s22, s23
    v_add_u32 v9, s22, v9
    v_lshrrev_b32 v4, 2, v42
    v_lshlrev_b32 v12, 8, v4
    v_lshl_add_u32 v12, v41, 6, v12
    v_lshl_add_u32 v12, v3, 4, v12
    v_lshlrev_b32 v13, 6, v41
    v_lshl_add_u32 v13, v42, 2, v13
    v_cmp_eq_u32 vcc, 0, v3
    v_mov_b32 v28, 0x3f803f80
    v_mov_b32 v29, 0x3f803f80
    v_cndmask_b32 v34, 0, 1, vcc
    v_mov_b32 v30, 0x3f803f80
    v_mov_b32 v31, 0x3f803f80
    v_and_b32 v49, 1, v42
    v_lshlrev_b32 v49, 4, v49
    v_mov_b32 v50, 0x3f80
    v_lshlrev_b32 v50, v49, v50
    v_lshrrev_b32 v51, 2, v42
    v_cmp_eq_u32 vcc, v51, v41
    v_mov_b32 v24, v50
    v_cndmask_b32 v52, 0, v50, s[28:29]
    v_cndmask_b32 v53, 0, v50, s[32:33]
    v_cndmask_b32 v16, 0, v52, vcc
    v_cndmask_b32 v17, 0, v53, vcc
    v_mov_b32 v25, v50
    v_mov_b32 v26, v50
    v_mov_b32 v27, v50
    v_bfe_u32 v60, v40, 3, 1
    v_bfe_u32 v49, v40, 2, 1
    v_and_b32 v50, 1, v41
    v_lshrrev_b32 v51, 1, v41
    v_lshlrev_b32 v52, 3, v60
    v_lshl_add_u32 v52, v50, 2, v52
    v_lshl_add_u32 v53, v51, 4, v52
    v_add_u32 v53, v53, v49
    v_and_b32 v54, 3, v40
    s_lshl_b32 s22, s20, 2
    v_add_u32 v55, s22, v54
    v_xor_b32 v55, v55, v52
    v_lshlrev_b32 v55, 4, v55
    v_lshl_add_u32 v46, v53, 8, v55
    v_lshlrev_b32 v55, 4, v52
    v_lshl_add_u32 v55, v54, 3, v55
    v_lshl_add_u32 v47, v53, 8, v55
    s_waitcnt vmcnt(28)
    s_barrier
    v_add_u32 v48, 0, v46
    ds_read_b64_tr_b16 a[0:1], v48 offset:0
    ds_read_b64_tr_b16 a[2:3], v48 offset:512
    ds_read_b64_tr_b16 a[4:5], v48 offset:8192
    ds_read_b64_tr_b16 a[6:7], v48 offset:8704
    ds_read_b64_tr_b16 a[8:9], v48 offset:8
    ds_read_b64_tr_b16 a[10:11], v48 offset:520
    ds_read_b64_tr_b16 a[12:13], v48 offset:8200
    ds_read_b64_tr_b16 a[14:15], v48 offset:8712
    s_waitcnt lgkmcnt(0)
    s_barrier
    s_mov_b32 s8, s52
    s_mov_b32 s9, s53
    s_add_u32 m0, s48, 0
    s_mov_b32 s22, 0
    buffer_load_dwordx4 v44, s[8:11], s22 offen  lds
    s_add_u32 m0, s48, 4096
    s_mov_b32 s22, 32768
    buffer_load_dwordx4 v44, s[8:11], s22 offen  lds
    s_add_u32 m0, s48, 8192
    s_mov_b32 s22, 65536
    buffer_load_dwordx4 v44, s[8:11], s22 offen  lds
    s_add_u32 m0, s48, 12288
    s_mov_b32 s22, 98304
    buffer_load_dwordx4 v44, s[8:11], s22 offen  lds
    s_waitcnt vmcnt(28)
    s_barrier
    v_add_u32 v48, 16384, v46
    ds_read_b64_tr_b16 a[16:17], v48 offset:0
    ds_read_b64_tr_b16 a[18:19], v48 offset:512
    ds_read_b64_tr_b16 a[20:21], v48 offset:8192
    ds_read_b64_tr_b16 a[22:23], v48 offset:8704
    ds_read_b64_tr_b16 a[24:25], v48 offset:8
    ds_read_b64_tr_b16 a[26:27], v48 offset:520
    ds_read_b64_tr_b16 a[28:29], v48 offset:8200
    ds_read_b64_tr_b16 a[30:31], v48 offset:8712
    s_waitcnt lgkmcnt(0)
    s_barrier
    s_add_u32 m0, s48, 16384
    s_mov_b32 s22, 524288
    buffer_load_dwordx4 v44, s[8:11], s22 offen  lds
    s_add_u32 m0, s48, 20480
    s_mov_b32 s22, 557056
    buffer_load_dwordx4 v44, s[8:11], s22 offen  lds
    s_add_u32 m0, s48, 24576
    s_mov_b32 s22, 589824
    buffer_load_dwordx4 v44, s[8:11], s22 offen  lds
    s_add_u32 m0, s48, 28672
    s_mov_b32 s22, 622592
    buffer_load_dwordx4 v44, s[8:11], s22 offen  lds
    s_waitcnt vmcnt(28)
    s_barrier
    v_add_u32 v48, 32768, v46
    ds_read_b64_tr_b16 a[32:33], v48 offset:0
    ds_read_b64_tr_b16 a[34:35], v48 offset:512
    ds_read_b64_tr_b16 a[36:37], v48 offset:8192
    ds_read_b64_tr_b16 a[38:39], v48 offset:8704
    ds_read_b64_tr_b16 a[40:41], v48 offset:8
    ds_read_b64_tr_b16 a[42:43], v48 offset:520
    ds_read_b64_tr_b16 a[44:45], v48 offset:8200
    ds_read_b64_tr_b16 a[46:47], v48 offset:8712
    s_waitcnt lgkmcnt(0)
    s_barrier
    s_add_u32 m0, s48, 32768
    s_mov_b32 s22, 1048576
    buffer_load_dwordx4 v44, s[8:11], s22 offen  lds
    s_add_u32 m0, s48, 36864
    s_mov_b32 s22, 1081344
    buffer_load_dwordx4 v44, s[8:11], s22 offen  lds
    s_add_u32 m0, s48, 40960
    s_mov_b32 s22, 1114112
    buffer_load_dwordx4 v44, s[8:11], s22 offen  lds
    s_add_u32 m0, s48, 45056
    s_mov_b32 s22, 1146880
    buffer_load_dwordx4 v44, s[8:11], s22 offen  lds
    s_waitcnt vmcnt(28)
    s_barrier
    v_add_u32 v48, 49152, v46
    ds_read_b64_tr_b16 a[48:49], v48 offset:0
    ds_read_b64_tr_b16 a[50:51], v48 offset:512
    ds_read_b64_tr_b16 a[52:53], v48 offset:8192
    ds_read_b64_tr_b16 a[54:55], v48 offset:8704
    ds_read_b64_tr_b16 a[56:57], v48 offset:8
    ds_read_b64_tr_b16 a[58:59], v48 offset:520
    ds_read_b64_tr_b16 a[60:61], v48 offset:8200
    ds_read_b64_tr_b16 a[62:63], v48 offset:8712
    s_waitcnt lgkmcnt(0)
    s_barrier
    s_add_u32 m0, s48, 49152
    s_mov_b32 s22, 1572864
    buffer_load_dwordx4 v44, s[8:11], s22 offen  lds
    s_add_u32 m0, s48, 53248
    s_mov_b32 s22, 1605632
    buffer_load_dwordx4 v44, s[8:11], s22 offen  lds
    s_add_u32 m0, s48, 57344
    s_mov_b32 s22, 1638400
    buffer_load_dwordx4 v44, s[8:11], s22 offen  lds
    s_add_u32 m0, s48, 61440
    s_mov_b32 s22, 1671168
    buffer_load_dwordx4 v44, s[8:11], s22 offen  lds
    s_waitcnt vmcnt(28)
    s_barrier
    v_add_u32 v48, 65536, v46
    ds_read_b64_tr_b16 a[64:65], v48 offset:0
    ds_read_b64_tr_b16 a[66:67], v48 offset:512
    ds_read_b64_tr_b16 a[68:69], v48 offset:8192
    ds_read_b64_tr_b16 a[70:71], v48 offset:8704
    ds_read_b64_tr_b16 a[72:73], v48 offset:8
    ds_read_b64_tr_b16 a[74:75], v48 offset:520
    ds_read_b64_tr_b16 a[76:77], v48 offset:8200
    ds_read_b64_tr_b16 a[78:79], v48 offset:8712
    s_waitcnt lgkmcnt(0)
    s_barrier
    s_add_u32 m0, s48, 65536
    s_mov_b32 s22, 2097152
    buffer_load_dwordx4 v44, s[8:11], s22 offen  lds
    s_add_u32 m0, s48, 69632
    s_mov_b32 s22, 2129920
    buffer_load_dwordx4 v44, s[8:11], s22 offen  lds
    s_add_u32 m0, s48, 73728
    s_mov_b32 s22, 2162688
    buffer_load_dwordx4 v44, s[8:11], s22 offen  lds
    s_add_u32 m0, s48, 77824
    s_mov_b32 s22, 2195456
    buffer_load_dwordx4 v44, s[8:11], s22 offen  lds
    s_waitcnt vmcnt(28)
    s_barrier
    v_add_u32 v48, 81920, v46
    ds_read_b64_tr_b16 a[80:81], v48 offset:0
    ds_read_b64_tr_b16 a[82:83], v48 offset:512
    ds_read_b64_tr_b16 a[84:85], v48 offset:8192
    ds_read_b64_tr_b16 a[86:87], v48 offset:8704
    ds_read_b64_tr_b16 a[88:89], v48 offset:8
    ds_read_b64_tr_b16 a[90:91], v48 offset:520
    ds_read_b64_tr_b16 a[92:93], v48 offset:8200
    ds_read_b64_tr_b16 a[94:95], v48 offset:8712
    s_waitcnt lgkmcnt(0)
    s_barrier
    s_add_u32 m0, s48, 81920
    s_mov_b32 s22, 2621440
    buffer_load_dwordx4 v44, s[8:11], s22 offen  lds
    s_add_u32 m0, s48, 86016
    s_mov_b32 s22, 2654208
    buffer_load_dwordx4 v44, s[8:11], s22 offen  lds
    s_add_u32 m0, s48, 90112
    s_mov_b32 s22, 2686976
    buffer_load_dwordx4 v44, s[8:11], s22 offen  lds
    s_add_u32 m0, s48, 94208
    s_mov_b32 s22, 2719744
    buffer_load_dwordx4 v44, s[8:11], s22 offen  lds
    s_waitcnt vmcnt(28)
    s_barrier
    v_add_u32 v48, 98304, v46
    ds_read_b64_tr_b16 a[96:97], v48 offset:0
    ds_read_b64_tr_b16 a[98:99], v48 offset:512
    ds_read_b64_tr_b16 a[100:101], v48 offset:8192
    ds_read_b64_tr_b16 a[102:103], v48 offset:8704
    ds_read_b64_tr_b16 a[104:105], v48 offset:8
    ds_read_b64_tr_b16 a[106:107], v48 offset:520
    ds_read_b64_tr_b16 a[108:109], v48 offset:8200
    ds_read_b64_tr_b16 a[110:111], v48 offset:8712
    s_waitcnt lgkmcnt(0)
    s_barrier
    s_add_u32 m0, s48, 98304
    s_mov_b32 s22, 3145728
    buffer_load_dwordx4 v44, s[8:11], s22 offen  lds
    s_add_u32 m0, s48, 102400
    s_mov_b32 s22, 3178496
    buffer_load_dwordx4 v44, s[8:11], s22 offen  lds
    s_add_u32 m0, s48, 106496
    s_mov_b32 s22, 3211264
    buffer_load_dwordx4 v44, s[8:11], s22 offen  lds
    s_add_u32 m0, s48, 110592
    s_mov_b32 s22, 3244032
    buffer_load_dwordx4 v44, s[8:11], s22 offen  lds
    s_waitcnt vmcnt(28)
    s_barrier
    v_add_u32 v48, 114688, v46
    ds_read_b64_tr_b16 a[112:113], v48 offset:0
    ds_read_b64_tr_b16 a[114:115], v48 offset:512
    ds_read_b64_tr_b16 a[116:117], v48 offset:8192
    ds_read_b64_tr_b16 a[118:119], v48 offset:8704
    ds_read_b64_tr_b16 a[120:121], v48 offset:8
    ds_read_b64_tr_b16 a[122:123], v48 offset:520
    ds_read_b64_tr_b16 a[124:125], v48 offset:8200
    ds_read_b64_tr_b16 a[126:127], v48 offset:8712
    s_waitcnt lgkmcnt(0)
    s_barrier
    s_add_u32 m0, s48, 114688
    s_mov_b32 s22, 3670016
    buffer_load_dwordx4 v44, s[8:11], s22 offen  lds
    s_add_u32 m0, s48, 118784
    s_mov_b32 s22, 3702784
    buffer_load_dwordx4 v44, s[8:11], s22 offen  lds
    s_add_u32 m0, s48, 122880
    s_mov_b32 s22, 3735552
    buffer_load_dwordx4 v44, s[8:11], s22 offen  lds
    s_add_u32 m0, s48, 126976
    s_mov_b32 s22, 3768320
    buffer_load_dwordx4 v44, s[8:11], s22 offen  lds
    s_waitcnt vmcnt(28)
    s_barrier
    v_add_u32 v48, 0, v46
    ds_read_b64_tr_b16 a[128:129], v48 offset:0
    ds_read_b64_tr_b16 a[130:131], v48 offset:512
    ds_read_b64_tr_b16 a[132:133], v48 offset:8192
    ds_read_b64_tr_b16 a[134:135], v48 offset:8704
    ds_read_b64_tr_b16 a[136:137], v48 offset:8
    ds_read_b64_tr_b16 a[138:139], v48 offset:520
    ds_read_b64_tr_b16 a[140:141], v48 offset:8200
    ds_read_b64_tr_b16 a[142:143], v48 offset:8712
    s_waitcnt lgkmcnt(0)
    s_barrier
    s_mov_b32 s8, s56
    s_mov_b32 s9, s57
    s_add_u32 m0, s48, 0
    s_mov_b32 s22, 0
    buffer_load_dwordx4 v45, s[8:11], s22 offen  lds
    s_add_u32 m0, s48, 4096
    s_mov_b32 s22, 16384
    buffer_load_dwordx4 v45, s[8:11], s22 offen  lds
    s_add_u32 m0, s48, 8192
    s_mov_b32 s22, 32768
    buffer_load_dwordx4 v45, s[8:11], s22 offen  lds
    s_add_u32 m0, s48, 12288
    s_mov_b32 s22, 49152
    buffer_load_dwordx4 v45, s[8:11], s22 offen  lds
    s_waitcnt vmcnt(28)
    s_barrier
    v_add_u32 v48, 16384, v46
    ds_read_b64_tr_b16 a[144:145], v48 offset:0
    ds_read_b64_tr_b16 a[146:147], v48 offset:512
    ds_read_b64_tr_b16 a[148:149], v48 offset:8192
    ds_read_b64_tr_b16 a[150:151], v48 offset:8704
    ds_read_b64_tr_b16 a[152:153], v48 offset:8
    ds_read_b64_tr_b16 a[154:155], v48 offset:520
    ds_read_b64_tr_b16 a[156:157], v48 offset:8200
    ds_read_b64_tr_b16 a[158:159], v48 offset:8712
    s_waitcnt lgkmcnt(0)
    s_barrier
    s_add_u32 m0, s48, 16384
    s_mov_b32 s22, 256
    buffer_load_dwordx4 v45, s[8:11], s22 offen  lds
    s_add_u32 m0, s48, 20480
    s_mov_b32 s22, 16640
    buffer_load_dwordx4 v45, s[8:11], s22 offen  lds
    s_add_u32 m0, s48, 24576
    s_mov_b32 s22, 33024
    buffer_load_dwordx4 v45, s[8:11], s22 offen  lds
    s_add_u32 m0, s48, 28672
    s_mov_b32 s22, 49408
    buffer_load_dwordx4 v45, s[8:11], s22 offen  lds
    s_waitcnt vmcnt(28)
    s_barrier
    v_add_u32 v48, 32768, v46
    ds_read_b64_tr_b16 a[160:161], v48 offset:0
    ds_read_b64_tr_b16 a[162:163], v48 offset:512
    ds_read_b64_tr_b16 a[164:165], v48 offset:8192
    ds_read_b64_tr_b16 a[166:167], v48 offset:8704
    ds_read_b64_tr_b16 a[168:169], v48 offset:8
    ds_read_b64_tr_b16 a[170:171], v48 offset:520
    ds_read_b64_tr_b16 a[172:173], v48 offset:8200
    ds_read_b64_tr_b16 a[174:175], v48 offset:8712
    s_waitcnt lgkmcnt(0)
    s_barrier
    s_add_u32 m0, s48, 32768
    s_mov_b32 s22, 512
    buffer_load_dwordx4 v45, s[8:11], s22 offen  lds
    s_add_u32 m0, s48, 36864
    s_mov_b32 s22, 16896
    buffer_load_dwordx4 v45, s[8:11], s22 offen  lds
    s_add_u32 m0, s48, 40960
    s_mov_b32 s22, 33280
    buffer_load_dwordx4 v45, s[8:11], s22 offen  lds
    s_add_u32 m0, s48, 45056
    s_mov_b32 s22, 49664
    buffer_load_dwordx4 v45, s[8:11], s22 offen  lds
    s_waitcnt vmcnt(28)
    s_barrier
    v_add_u32 v48, 49152, v46
    ds_read_b64_tr_b16 a[176:177], v48 offset:0
    ds_read_b64_tr_b16 a[178:179], v48 offset:512
    ds_read_b64_tr_b16 a[180:181], v48 offset:8192
    ds_read_b64_tr_b16 a[182:183], v48 offset:8704
    ds_read_b64_tr_b16 a[184:185], v48 offset:8
    ds_read_b64_tr_b16 a[186:187], v48 offset:520
    ds_read_b64_tr_b16 a[188:189], v48 offset:8200
    ds_read_b64_tr_b16 a[190:191], v48 offset:8712
    s_waitcnt lgkmcnt(0)
    s_barrier
    s_add_u32 m0, s48, 49152
    s_mov_b32 s22, 768
    buffer_load_dwordx4 v45, s[8:11], s22 offen  lds
    s_add_u32 m0, s48, 53248
    s_mov_b32 s22, 17152
    buffer_load_dwordx4 v45, s[8:11], s22 offen  lds
    s_add_u32 m0, s48, 57344
    s_mov_b32 s22, 33536
    buffer_load_dwordx4 v45, s[8:11], s22 offen  lds
    s_add_u32 m0, s48, 61440
    s_mov_b32 s22, 49920
    buffer_load_dwordx4 v45, s[8:11], s22 offen  lds
    s_waitcnt vmcnt(28)
    s_barrier
    v_add_u32 v48, 65536, v46
    ds_read_b64_tr_b16 a[192:193], v48 offset:0
    ds_read_b64_tr_b16 a[194:195], v48 offset:512
    ds_read_b64_tr_b16 a[196:197], v48 offset:8192
    ds_read_b64_tr_b16 a[198:199], v48 offset:8704
    ds_read_b64_tr_b16 a[200:201], v48 offset:8
    ds_read_b64_tr_b16 a[202:203], v48 offset:520
    ds_read_b64_tr_b16 a[204:205], v48 offset:8200
    ds_read_b64_tr_b16 a[206:207], v48 offset:8712
    s_waitcnt lgkmcnt(0)
    s_barrier
    s_add_u32 m0, s48, 65536
    s_mov_b32 s22, 131072
    buffer_load_dwordx4 v45, s[8:11], s22 offen  lds
    s_add_u32 m0, s48, 69632
    s_mov_b32 s22, 147456
    buffer_load_dwordx4 v45, s[8:11], s22 offen  lds
    s_add_u32 m0, s48, 73728
    s_mov_b32 s22, 163840
    buffer_load_dwordx4 v45, s[8:11], s22 offen  lds
    s_add_u32 m0, s48, 77824
    s_mov_b32 s22, 180224
    buffer_load_dwordx4 v45, s[8:11], s22 offen  lds
    s_waitcnt vmcnt(28)
    s_barrier
    v_add_u32 v48, 81920, v46
    ds_read_b64_tr_b16 a[208:209], v48 offset:0
    ds_read_b64_tr_b16 a[210:211], v48 offset:512
    ds_read_b64_tr_b16 a[212:213], v48 offset:8192
    ds_read_b64_tr_b16 a[214:215], v48 offset:8704
    ds_read_b64_tr_b16 a[216:217], v48 offset:8
    ds_read_b64_tr_b16 a[218:219], v48 offset:520
    ds_read_b64_tr_b16 a[220:221], v48 offset:8200
    ds_read_b64_tr_b16 a[222:223], v48 offset:8712
    s_waitcnt lgkmcnt(0)
    s_barrier
    s_add_u32 m0, s48, 81920
    s_mov_b32 s22, 131328
    buffer_load_dwordx4 v45, s[8:11], s22 offen  lds
    s_add_u32 m0, s48, 86016
    s_mov_b32 s22, 147712
    buffer_load_dwordx4 v45, s[8:11], s22 offen  lds
    s_add_u32 m0, s48, 90112
    s_mov_b32 s22, 164096
    buffer_load_dwordx4 v45, s[8:11], s22 offen  lds
    s_add_u32 m0, s48, 94208
    s_mov_b32 s22, 180480
    buffer_load_dwordx4 v45, s[8:11], s22 offen  lds
    s_waitcnt vmcnt(28)
    s_barrier
    v_add_u32 v48, 98304, v46
    ds_read_b64_tr_b16 a[224:225], v48 offset:0
    ds_read_b64_tr_b16 a[226:227], v48 offset:512
    ds_read_b64_tr_b16 a[228:229], v48 offset:8192
    ds_read_b64_tr_b16 a[230:231], v48 offset:8704
    ds_read_b64_tr_b16 a[232:233], v48 offset:8
    ds_read_b64_tr_b16 a[234:235], v48 offset:520
    ds_read_b64_tr_b16 a[236:237], v48 offset:8200
    ds_read_b64_tr_b16 a[238:239], v48 offset:8712
    s_waitcnt lgkmcnt(0)
    s_barrier
    s_add_u32 m0, s48, 98304
    s_mov_b32 s22, 131584
    buffer_load_dwordx4 v45, s[8:11], s22 offen  lds
    s_add_u32 m0, s48, 102400
    s_mov_b32 s22, 147968
    buffer_load_dwordx4 v45, s[8:11], s22 offen  lds
    s_add_u32 m0, s48, 106496
    s_mov_b32 s22, 164352
    buffer_load_dwordx4 v45, s[8:11], s22 offen  lds
    s_add_u32 m0, s48, 110592
    s_mov_b32 s22, 180736
    buffer_load_dwordx4 v45, s[8:11], s22 offen  lds
    s_waitcnt vmcnt(28)
    s_barrier
    v_add_u32 v48, 114688, v46
    ds_read_b64_tr_b16 a[240:241], v48 offset:0
    ds_read_b64_tr_b16 a[242:243], v48 offset:512
    ds_read_b64_tr_b16 a[244:245], v48 offset:8192
    ds_read_b64_tr_b16 a[246:247], v48 offset:8704
    ds_read_b64_tr_b16 a[248:249], v48 offset:8
    ds_read_b64_tr_b16 a[250:251], v48 offset:520
    ds_read_b64_tr_b16 a[252:253], v48 offset:8200
    ds_read_b64_tr_b16 a[254:255], v48 offset:8712
    s_waitcnt lgkmcnt(0)
    s_barrier
    s_add_u32 m0, s48, 114688
    s_mov_b32 s22, 131840
    buffer_load_dwordx4 v45, s[8:11], s22 offen  lds
    s_add_u32 m0, s48, 118784
    s_mov_b32 s22, 148224
    buffer_load_dwordx4 v45, s[8:11], s22 offen  lds
    s_add_u32 m0, s48, 122880
    s_mov_b32 s22, 164608
    buffer_load_dwordx4 v45, s[8:11], s22 offen  lds
    s_add_u32 m0, s48, 126976
    s_mov_b32 s22, 180992
    buffer_load_dwordx4 v45, s[8:11], s22 offen  lds
    s_waitcnt vmcnt(28)
    s_barrier
    s_cmp_lg_u32 s20, 0
    s_cbranch_scc1 mega_kernel_rs_wo0
    v_xor_b32 v48, 0, v47
    v_add_u32 v48, 0, v48
    ds_read_b64_tr_b16 v[128:129], v48 offset:0
    ds_read_b64_tr_b16 v[130:131], v48 offset:512
    ds_read_b64_tr_b16 v[132:133], v48 offset:8192
    ds_read_b64_tr_b16 v[134:135], v48 offset:8704
    ds_read_b64_tr_b16 v[144:145], v48 offset:32
    ds_read_b64_tr_b16 v[146:147], v48 offset:544
    ds_read_b64_tr_b16 v[148:149], v48 offset:8224
    ds_read_b64_tr_b16 v[150:151], v48 offset:8736
    s_waitcnt lgkmcnt(0)
    v_xor_b32 v48, 64, v47
    v_add_u32 v48, 0, v48
    ds_read_b64_tr_b16 v[160:161], v48 offset:0
    ds_read_b64_tr_b16 v[162:163], v48 offset:512
    ds_read_b64_tr_b16 v[164:165], v48 offset:8192
    ds_read_b64_tr_b16 v[166:167], v48 offset:8704
    ds_read_b64_tr_b16 v[176:177], v48 offset:32
    ds_read_b64_tr_b16 v[178:179], v48 offset:544
    ds_read_b64_tr_b16 v[180:181], v48 offset:8224
    ds_read_b64_tr_b16 v[182:183], v48 offset:8736
    s_waitcnt lgkmcnt(0)
    v_xor_b32 v48, 128, v47
    v_add_u32 v48, 0, v48
    ds_read_b64_tr_b16 v[192:193], v48 offset:0
    ds_read_b64_tr_b16 v[194:195], v48 offset:512
    ds_read_b64_tr_b16 v[196:197], v48 offset:8192
    ds_read_b64_tr_b16 v[198:199], v48 offset:8704
    ds_read_b64_tr_b16 v[80:81], v48 offset:32
    ds_read_b64_tr_b16 v[82:83], v48 offset:544
    ds_read_b64_tr_b16 v[84:85], v48 offset:8224
    ds_read_b64_tr_b16 v[86:87], v48 offset:8736
    s_waitcnt lgkmcnt(0)
    v_xor_b32 v48, 192, v47
    v_add_u32 v48, 0, v48
    ds_read_b64_tr_b16 v[96:97], v48 offset:0
    ds_read_b64_tr_b16 v[98:99], v48 offset:512
    ds_read_b64_tr_b16 v[100:101], v48 offset:8192
    ds_read_b64_tr_b16 v[102:103], v48 offset:8704
    ds_read_b64_tr_b16 v[112:113], v48 offset:32
    ds_read_b64_tr_b16 v[114:115], v48 offset:544
    ds_read_b64_tr_b16 v[116:117], v48 offset:8224
    ds_read_b64_tr_b16 v[118:119], v48 offset:8736
    s_waitcnt lgkmcnt(0)
mega_kernel_rs_wo0:
    s_barrier
    s_mov_b32 s8, s54
    s_mov_b32 s9, s55
    s_add_u32 m0, s48, 0
    s_mov_b32 s22, 0
    buffer_load_dwordx4 v44, s[8:11], s22 offen  lds
    s_add_u32 m0, s48, 4096
    s_mov_b32 s22, 32768
    buffer_load_dwordx4 v44, s[8:11], s22 offen  lds
    s_add_u32 m0, s48, 8192
    s_mov_b32 s22, 65536
    buffer_load_dwordx4 v44, s[8:11], s22 offen  lds
    s_add_u32 m0, s48, 12288
    s_mov_b32 s22, 98304
    buffer_load_dwordx4 v44, s[8:11], s22 offen  lds
    s_waitcnt vmcnt(28)
    s_barrier
    s_cmp_lg_u32 s20, 1
    s_cbranch_scc1 mega_kernel_rs_wo1
    v_xor_b32 v48, 0, v47
    v_add_u32 v48, 16384, v48
    ds_read_b64_tr_b16 v[128:129], v48 offset:0
    ds_read_b64_tr_b16 v[130:131], v48 offset:512
    ds_read_b64_tr_b16 v[132:133], v48 offset:8192
    ds_read_b64_tr_b16 v[134:135], v48 offset:8704
    ds_read_b64_tr_b16 v[144:145], v48 offset:32
    ds_read_b64_tr_b16 v[146:147], v48 offset:544
    ds_read_b64_tr_b16 v[148:149], v48 offset:8224
    ds_read_b64_tr_b16 v[150:151], v48 offset:8736
    s_waitcnt lgkmcnt(0)
    v_xor_b32 v48, 64, v47
    v_add_u32 v48, 16384, v48
    ds_read_b64_tr_b16 v[160:161], v48 offset:0
    ds_read_b64_tr_b16 v[162:163], v48 offset:512
    ds_read_b64_tr_b16 v[164:165], v48 offset:8192
    ds_read_b64_tr_b16 v[166:167], v48 offset:8704
    ds_read_b64_tr_b16 v[176:177], v48 offset:32
    ds_read_b64_tr_b16 v[178:179], v48 offset:544
    ds_read_b64_tr_b16 v[180:181], v48 offset:8224
    ds_read_b64_tr_b16 v[182:183], v48 offset:8736
    s_waitcnt lgkmcnt(0)
    v_xor_b32 v48, 128, v47
    v_add_u32 v48, 16384, v48
    ds_read_b64_tr_b16 v[192:193], v48 offset:0
    ds_read_b64_tr_b16 v[194:195], v48 offset:512
    ds_read_b64_tr_b16 v[196:197], v48 offset:8192
    ds_read_b64_tr_b16 v[198:199], v48 offset:8704
    ds_read_b64_tr_b16 v[80:81], v48 offset:32
    ds_read_b64_tr_b16 v[82:83], v48 offset:544
    ds_read_b64_tr_b16 v[84:85], v48 offset:8224
    ds_read_b64_tr_b16 v[86:87], v48 offset:8736
    s_waitcnt lgkmcnt(0)
    v_xor_b32 v48, 192, v47
    v_add_u32 v48, 16384, v48
    ds_read_b64_tr_b16 v[96:97], v48 offset:0
    ds_read_b64_tr_b16 v[98:99], v48 offset:512
    ds_read_b64_tr_b16 v[100:101], v48 offset:8192
    ds_read_b64_tr_b16 v[102:103], v48 offset:8704
    ds_read_b64_tr_b16 v[112:113], v48 offset:32
    ds_read_b64_tr_b16 v[114:115], v48 offset:544
    ds_read_b64_tr_b16 v[116:117], v48 offset:8224
    ds_read_b64_tr_b16 v[118:119], v48 offset:8736
    s_waitcnt lgkmcnt(0)
mega_kernel_rs_wo1:
    s_barrier
    s_add_u32 m0, s48, 16384
    s_mov_b32 s22, 524288
    buffer_load_dwordx4 v44, s[8:11], s22 offen  lds
    s_add_u32 m0, s48, 20480
    s_mov_b32 s22, 557056
    buffer_load_dwordx4 v44, s[8:11], s22 offen  lds
    s_add_u32 m0, s48, 24576
    s_mov_b32 s22, 589824
    buffer_load_dwordx4 v44, s[8:11], s22 offen  lds
    s_add_u32 m0, s48, 28672
    s_mov_b32 s22, 622592
    buffer_load_dwordx4 v44, s[8:11], s22 offen  lds
    s_waitcnt vmcnt(28)
    s_barrier
    s_cmp_lg_u32 s20, 2
    s_cbranch_scc1 mega_kernel_rs_wo2
    v_xor_b32 v48, 0, v47
    v_add_u32 v48, 32768, v48
    ds_read_b64_tr_b16 v[128:129], v48 offset:0
    ds_read_b64_tr_b16 v[130:131], v48 offset:512
    ds_read_b64_tr_b16 v[132:133], v48 offset:8192
    ds_read_b64_tr_b16 v[134:135], v48 offset:8704
    ds_read_b64_tr_b16 v[144:145], v48 offset:32
    ds_read_b64_tr_b16 v[146:147], v48 offset:544
    ds_read_b64_tr_b16 v[148:149], v48 offset:8224
    ds_read_b64_tr_b16 v[150:151], v48 offset:8736
    s_waitcnt lgkmcnt(0)
    v_xor_b32 v48, 64, v47
    v_add_u32 v48, 32768, v48
    ds_read_b64_tr_b16 v[160:161], v48 offset:0
    ds_read_b64_tr_b16 v[162:163], v48 offset:512
    ds_read_b64_tr_b16 v[164:165], v48 offset:8192
    ds_read_b64_tr_b16 v[166:167], v48 offset:8704
    ds_read_b64_tr_b16 v[176:177], v48 offset:32
    ds_read_b64_tr_b16 v[178:179], v48 offset:544
    ds_read_b64_tr_b16 v[180:181], v48 offset:8224
    ds_read_b64_tr_b16 v[182:183], v48 offset:8736
    s_waitcnt lgkmcnt(0)
    v_xor_b32 v48, 128, v47
    v_add_u32 v48, 32768, v48
    ds_read_b64_tr_b16 v[192:193], v48 offset:0
    ds_read_b64_tr_b16 v[194:195], v48 offset:512
    ds_read_b64_tr_b16 v[196:197], v48 offset:8192
    ds_read_b64_tr_b16 v[198:199], v48 offset:8704
    ds_read_b64_tr_b16 v[80:81], v48 offset:32
    ds_read_b64_tr_b16 v[82:83], v48 offset:544
    ds_read_b64_tr_b16 v[84:85], v48 offset:8224
    ds_read_b64_tr_b16 v[86:87], v48 offset:8736
    s_waitcnt lgkmcnt(0)
    v_xor_b32 v48, 192, v47
    v_add_u32 v48, 32768, v48
    ds_read_b64_tr_b16 v[96:97], v48 offset:0
    ds_read_b64_tr_b16 v[98:99], v48 offset:512
    ds_read_b64_tr_b16 v[100:101], v48 offset:8192
    ds_read_b64_tr_b16 v[102:103], v48 offset:8704
    ds_read_b64_tr_b16 v[112:113], v48 offset:32
    ds_read_b64_tr_b16 v[114:115], v48 offset:544
    ds_read_b64_tr_b16 v[116:117], v48 offset:8224
    ds_read_b64_tr_b16 v[118:119], v48 offset:8736
    s_waitcnt lgkmcnt(0)
mega_kernel_rs_wo2:
    s_barrier
    s_add_u32 m0, s48, 32768
    s_mov_b32 s22, 1048576
    buffer_load_dwordx4 v44, s[8:11], s22 offen  lds
    s_add_u32 m0, s48, 36864
    s_mov_b32 s22, 1081344
    buffer_load_dwordx4 v44, s[8:11], s22 offen  lds
    s_add_u32 m0, s48, 40960
    s_mov_b32 s22, 1114112
    buffer_load_dwordx4 v44, s[8:11], s22 offen  lds
    s_add_u32 m0, s48, 45056
    s_mov_b32 s22, 1146880
    buffer_load_dwordx4 v44, s[8:11], s22 offen  lds
    s_waitcnt vmcnt(28)
    s_barrier
    s_cmp_lg_u32 s20, 3
    s_cbranch_scc1 mega_kernel_rs_wo3
    v_xor_b32 v48, 0, v47
    v_add_u32 v48, 49152, v48
    ds_read_b64_tr_b16 v[128:129], v48 offset:0
    ds_read_b64_tr_b16 v[130:131], v48 offset:512
    ds_read_b64_tr_b16 v[132:133], v48 offset:8192
    ds_read_b64_tr_b16 v[134:135], v48 offset:8704
    ds_read_b64_tr_b16 v[144:145], v48 offset:32
    ds_read_b64_tr_b16 v[146:147], v48 offset:544
    ds_read_b64_tr_b16 v[148:149], v48 offset:8224
    ds_read_b64_tr_b16 v[150:151], v48 offset:8736
    s_waitcnt lgkmcnt(0)
    v_xor_b32 v48, 64, v47
    v_add_u32 v48, 49152, v48
    ds_read_b64_tr_b16 v[160:161], v48 offset:0
    ds_read_b64_tr_b16 v[162:163], v48 offset:512
    ds_read_b64_tr_b16 v[164:165], v48 offset:8192
    ds_read_b64_tr_b16 v[166:167], v48 offset:8704
    ds_read_b64_tr_b16 v[176:177], v48 offset:32
    ds_read_b64_tr_b16 v[178:179], v48 offset:544
    ds_read_b64_tr_b16 v[180:181], v48 offset:8224
    ds_read_b64_tr_b16 v[182:183], v48 offset:8736
    s_waitcnt lgkmcnt(0)
    v_xor_b32 v48, 128, v47
    v_add_u32 v48, 49152, v48
    ds_read_b64_tr_b16 v[192:193], v48 offset:0
    ds_read_b64_tr_b16 v[194:195], v48 offset:512
    ds_read_b64_tr_b16 v[196:197], v48 offset:8192
    ds_read_b64_tr_b16 v[198:199], v48 offset:8704
    ds_read_b64_tr_b16 v[80:81], v48 offset:32
    ds_read_b64_tr_b16 v[82:83], v48 offset:544
    ds_read_b64_tr_b16 v[84:85], v48 offset:8224
    ds_read_b64_tr_b16 v[86:87], v48 offset:8736
    s_waitcnt lgkmcnt(0)
    v_xor_b32 v48, 192, v47
    v_add_u32 v48, 49152, v48
    ds_read_b64_tr_b16 v[96:97], v48 offset:0
    ds_read_b64_tr_b16 v[98:99], v48 offset:512
    ds_read_b64_tr_b16 v[100:101], v48 offset:8192
    ds_read_b64_tr_b16 v[102:103], v48 offset:8704
    ds_read_b64_tr_b16 v[112:113], v48 offset:32
    ds_read_b64_tr_b16 v[114:115], v48 offset:544
    ds_read_b64_tr_b16 v[116:117], v48 offset:8224
    ds_read_b64_tr_b16 v[118:119], v48 offset:8736
    s_waitcnt lgkmcnt(0)
mega_kernel_rs_wo3:
    s_barrier
    s_add_u32 m0, s48, 49152
    s_mov_b32 s22, 1572864
    buffer_load_dwordx4 v44, s[8:11], s22 offen  lds
    s_add_u32 m0, s48, 53248
    s_mov_b32 s22, 1605632
    buffer_load_dwordx4 v44, s[8:11], s22 offen  lds
    s_add_u32 m0, s48, 57344
    s_mov_b32 s22, 1638400
    buffer_load_dwordx4 v44, s[8:11], s22 offen  lds
    s_add_u32 m0, s48, 61440
    s_mov_b32 s22, 1671168
    buffer_load_dwordx4 v44, s[8:11], s22 offen  lds
    s_waitcnt vmcnt(28)
    s_barrier
    s_cmp_lg_u32 s20, 0
    s_cbranch_scc1 mega_kernel_rs_wo4
    v_xor_b32 v48, 0, v47
    v_add_u32 v48, 65536, v48
    ds_read_b64_tr_b16 v[136:137], v48 offset:0
    ds_read_b64_tr_b16 v[138:139], v48 offset:512
    ds_read_b64_tr_b16 v[140:141], v48 offset:8192
    ds_read_b64_tr_b16 v[142:143], v48 offset:8704
    ds_read_b64_tr_b16 v[152:153], v48 offset:32
    ds_read_b64_tr_b16 v[154:155], v48 offset:544
    ds_read_b64_tr_b16 v[156:157], v48 offset:8224
    ds_read_b64_tr_b16 v[158:159], v48 offset:8736
    s_waitcnt lgkmcnt(0)
    v_xor_b32 v48, 64, v47
    v_add_u32 v48, 65536, v48
    ds_read_b64_tr_b16 v[168:169], v48 offset:0
    ds_read_b64_tr_b16 v[170:171], v48 offset:512
    ds_read_b64_tr_b16 v[172:173], v48 offset:8192
    ds_read_b64_tr_b16 v[174:175], v48 offset:8704
    ds_read_b64_tr_b16 v[184:185], v48 offset:32
    ds_read_b64_tr_b16 v[186:187], v48 offset:544
    ds_read_b64_tr_b16 v[188:189], v48 offset:8224
    ds_read_b64_tr_b16 v[190:191], v48 offset:8736
    s_waitcnt lgkmcnt(0)
    v_xor_b32 v48, 128, v47
    v_add_u32 v48, 65536, v48
    ds_read_b64_tr_b16 v[200:201], v48 offset:0
    ds_read_b64_tr_b16 v[202:203], v48 offset:512
    ds_read_b64_tr_b16 v[204:205], v48 offset:8192
    ds_read_b64_tr_b16 v[206:207], v48 offset:8704
    ds_read_b64_tr_b16 v[88:89], v48 offset:32
    ds_read_b64_tr_b16 v[90:91], v48 offset:544
    ds_read_b64_tr_b16 v[92:93], v48 offset:8224
    ds_read_b64_tr_b16 v[94:95], v48 offset:8736
    s_waitcnt lgkmcnt(0)
    v_xor_b32 v48, 192, v47
    v_add_u32 v48, 65536, v48
    ds_read_b64_tr_b16 v[104:105], v48 offset:0
    ds_read_b64_tr_b16 v[106:107], v48 offset:512
    ds_read_b64_tr_b16 v[108:109], v48 offset:8192
    ds_read_b64_tr_b16 v[110:111], v48 offset:8704
    ds_read_b64_tr_b16 v[120:121], v48 offset:32
    ds_read_b64_tr_b16 v[122:123], v48 offset:544
    ds_read_b64_tr_b16 v[124:125], v48 offset:8224
    ds_read_b64_tr_b16 v[126:127], v48 offset:8736
    s_waitcnt lgkmcnt(0)
mega_kernel_rs_wo4:
    s_barrier
    s_add_u32 m0, s48, 65536
    s_mov_b32 s22, 2097152
    buffer_load_dwordx4 v44, s[8:11], s22 offen  lds
    s_add_u32 m0, s48, 69632
    s_mov_b32 s22, 2129920
    buffer_load_dwordx4 v44, s[8:11], s22 offen  lds
    s_add_u32 m0, s48, 73728
    s_mov_b32 s22, 2162688
    buffer_load_dwordx4 v44, s[8:11], s22 offen  lds
    s_add_u32 m0, s48, 77824
    s_mov_b32 s22, 2195456
    buffer_load_dwordx4 v44, s[8:11], s22 offen  lds
    s_waitcnt vmcnt(28)
    s_barrier
    s_cmp_lg_u32 s20, 1
    s_cbranch_scc1 mega_kernel_rs_wo5
    v_xor_b32 v48, 0, v47
    v_add_u32 v48, 81920, v48
    ds_read_b64_tr_b16 v[136:137], v48 offset:0
    ds_read_b64_tr_b16 v[138:139], v48 offset:512
    ds_read_b64_tr_b16 v[140:141], v48 offset:8192
    ds_read_b64_tr_b16 v[142:143], v48 offset:8704
    ds_read_b64_tr_b16 v[152:153], v48 offset:32
    ds_read_b64_tr_b16 v[154:155], v48 offset:544
    ds_read_b64_tr_b16 v[156:157], v48 offset:8224
    ds_read_b64_tr_b16 v[158:159], v48 offset:8736
    s_waitcnt lgkmcnt(0)
    v_xor_b32 v48, 64, v47
    v_add_u32 v48, 81920, v48
    ds_read_b64_tr_b16 v[168:169], v48 offset:0
    ds_read_b64_tr_b16 v[170:171], v48 offset:512
    ds_read_b64_tr_b16 v[172:173], v48 offset:8192
    ds_read_b64_tr_b16 v[174:175], v48 offset:8704
    ds_read_b64_tr_b16 v[184:185], v48 offset:32
    ds_read_b64_tr_b16 v[186:187], v48 offset:544
    ds_read_b64_tr_b16 v[188:189], v48 offset:8224
    ds_read_b64_tr_b16 v[190:191], v48 offset:8736
    s_waitcnt lgkmcnt(0)
    v_xor_b32 v48, 128, v47
    v_add_u32 v48, 81920, v48
    ds_read_b64_tr_b16 v[200:201], v48 offset:0
    ds_read_b64_tr_b16 v[202:203], v48 offset:512
    ds_read_b64_tr_b16 v[204:205], v48 offset:8192
    ds_read_b64_tr_b16 v[206:207], v48 offset:8704
    ds_read_b64_tr_b16 v[88:89], v48 offset:32
    ds_read_b64_tr_b16 v[90:91], v48 offset:544
    ds_read_b64_tr_b16 v[92:93], v48 offset:8224
    ds_read_b64_tr_b16 v[94:95], v48 offset:8736
    s_waitcnt lgkmcnt(0)
    v_xor_b32 v48, 192, v47
    v_add_u32 v48, 81920, v48
    ds_read_b64_tr_b16 v[104:105], v48 offset:0
    ds_read_b64_tr_b16 v[106:107], v48 offset:512
    ds_read_b64_tr_b16 v[108:109], v48 offset:8192
    ds_read_b64_tr_b16 v[110:111], v48 offset:8704
    ds_read_b64_tr_b16 v[120:121], v48 offset:32
    ds_read_b64_tr_b16 v[122:123], v48 offset:544
    ds_read_b64_tr_b16 v[124:125], v48 offset:8224
    ds_read_b64_tr_b16 v[126:127], v48 offset:8736
    s_waitcnt lgkmcnt(0)
mega_kernel_rs_wo5:
    s_barrier
    s_add_u32 m0, s48, 81920
    s_mov_b32 s22, 2621440
    buffer_load_dwordx4 v44, s[8:11], s22 offen  lds
    s_add_u32 m0, s48, 86016
    s_mov_b32 s22, 2654208
    buffer_load_dwordx4 v44, s[8:11], s22 offen  lds
    s_add_u32 m0, s48, 90112
    s_mov_b32 s22, 2686976
    buffer_load_dwordx4 v44, s[8:11], s22 offen  lds
    s_add_u32 m0, s48, 94208
    s_mov_b32 s22, 2719744
    buffer_load_dwordx4 v44, s[8:11], s22 offen  lds
    s_waitcnt vmcnt(28)
    s_barrier
    s_cmp_lg_u32 s20, 2
    s_cbranch_scc1 mega_kernel_rs_wo6
    v_xor_b32 v48, 0, v47
    v_add_u32 v48, 98304, v48
    ds_read_b64_tr_b16 v[136:137], v48 offset:0
    ds_read_b64_tr_b16 v[138:139], v48 offset:512
    ds_read_b64_tr_b16 v[140:141], v48 offset:8192
    ds_read_b64_tr_b16 v[142:143], v48 offset:8704
    ds_read_b64_tr_b16 v[152:153], v48 offset:32
    ds_read_b64_tr_b16 v[154:155], v48 offset:544
    ds_read_b64_tr_b16 v[156:157], v48 offset:8224
    ds_read_b64_tr_b16 v[158:159], v48 offset:8736
    s_waitcnt lgkmcnt(0)
    v_xor_b32 v48, 64, v47
    v_add_u32 v48, 98304, v48
    ds_read_b64_tr_b16 v[168:169], v48 offset:0
    ds_read_b64_tr_b16 v[170:171], v48 offset:512
    ds_read_b64_tr_b16 v[172:173], v48 offset:8192
    ds_read_b64_tr_b16 v[174:175], v48 offset:8704
    ds_read_b64_tr_b16 v[184:185], v48 offset:32
    ds_read_b64_tr_b16 v[186:187], v48 offset:544
    ds_read_b64_tr_b16 v[188:189], v48 offset:8224
    ds_read_b64_tr_b16 v[190:191], v48 offset:8736
    s_waitcnt lgkmcnt(0)
    v_xor_b32 v48, 128, v47
    v_add_u32 v48, 98304, v48
    ds_read_b64_tr_b16 v[200:201], v48 offset:0
    ds_read_b64_tr_b16 v[202:203], v48 offset:512
    ds_read_b64_tr_b16 v[204:205], v48 offset:8192
    ds_read_b64_tr_b16 v[206:207], v48 offset:8704
    ds_read_b64_tr_b16 v[88:89], v48 offset:32
    ds_read_b64_tr_b16 v[90:91], v48 offset:544
    ds_read_b64_tr_b16 v[92:93], v48 offset:8224
    ds_read_b64_tr_b16 v[94:95], v48 offset:8736
    s_waitcnt lgkmcnt(0)
    v_xor_b32 v48, 192, v47
    v_add_u32 v48, 98304, v48
    ds_read_b64_tr_b16 v[104:105], v48 offset:0
    ds_read_b64_tr_b16 v[106:107], v48 offset:512
    ds_read_b64_tr_b16 v[108:109], v48 offset:8192
    ds_read_b64_tr_b16 v[110:111], v48 offset:8704
    ds_read_b64_tr_b16 v[120:121], v48 offset:32
    ds_read_b64_tr_b16 v[122:123], v48 offset:544
    ds_read_b64_tr_b16 v[124:125], v48 offset:8224
    ds_read_b64_tr_b16 v[126:127], v48 offset:8736
    s_waitcnt lgkmcnt(0)
mega_kernel_rs_wo6:
    s_barrier
    s_add_u32 m0, s48, 98304
    s_mov_b32 s22, 3145728
    buffer_load_dwordx4 v44, s[8:11], s22 offen  lds
    s_add_u32 m0, s48, 102400
    s_mov_b32 s22, 3178496
    buffer_load_dwordx4 v44, s[8:11], s22 offen  lds
    s_add_u32 m0, s48, 106496
    s_mov_b32 s22, 3211264
    buffer_load_dwordx4 v44, s[8:11], s22 offen  lds
    s_add_u32 m0, s48, 110592
    s_mov_b32 s22, 3244032
    buffer_load_dwordx4 v44, s[8:11], s22 offen  lds
    s_waitcnt vmcnt(28)
    s_barrier
    s_cmp_lg_u32 s20, 3
    s_cbranch_scc1 mega_kernel_rs_wo7
    v_xor_b32 v48, 0, v47
    v_add_u32 v48, 114688, v48
    ds_read_b64_tr_b16 v[136:137], v48 offset:0
    ds_read_b64_tr_b16 v[138:139], v48 offset:512
    ds_read_b64_tr_b16 v[140:141], v48 offset:8192
    ds_read_b64_tr_b16 v[142:143], v48 offset:8704
    ds_read_b64_tr_b16 v[152:153], v48 offset:32
    ds_read_b64_tr_b16 v[154:155], v48 offset:544
    ds_read_b64_tr_b16 v[156:157], v48 offset:8224
    ds_read_b64_tr_b16 v[158:159], v48 offset:8736
    s_waitcnt lgkmcnt(0)
    v_xor_b32 v48, 64, v47
    v_add_u32 v48, 114688, v48
    ds_read_b64_tr_b16 v[168:169], v48 offset:0
    ds_read_b64_tr_b16 v[170:171], v48 offset:512
    ds_read_b64_tr_b16 v[172:173], v48 offset:8192
    ds_read_b64_tr_b16 v[174:175], v48 offset:8704
    ds_read_b64_tr_b16 v[184:185], v48 offset:32
    ds_read_b64_tr_b16 v[186:187], v48 offset:544
    ds_read_b64_tr_b16 v[188:189], v48 offset:8224
    ds_read_b64_tr_b16 v[190:191], v48 offset:8736
    s_waitcnt lgkmcnt(0)
    v_xor_b32 v48, 128, v47
    v_add_u32 v48, 114688, v48
    ds_read_b64_tr_b16 v[200:201], v48 offset:0
    ds_read_b64_tr_b16 v[202:203], v48 offset:512
    ds_read_b64_tr_b16 v[204:205], v48 offset:8192
    ds_read_b64_tr_b16 v[206:207], v48 offset:8704
    ds_read_b64_tr_b16 v[88:89], v48 offset:32
    ds_read_b64_tr_b16 v[90:91], v48 offset:544
    ds_read_b64_tr_b16 v[92:93], v48 offset:8224
    ds_read_b64_tr_b16 v[94:95], v48 offset:8736
    s_waitcnt lgkmcnt(0)
    v_xor_b32 v48, 192, v47
    v_add_u32 v48, 114688, v48
    ds_read_b64_tr_b16 v[104:105], v48 offset:0
    ds_read_b64_tr_b16 v[106:107], v48 offset:512
    ds_read_b64_tr_b16 v[108:109], v48 offset:8192
    ds_read_b64_tr_b16 v[110:111], v48 offset:8704
    ds_read_b64_tr_b16 v[120:121], v48 offset:32
    ds_read_b64_tr_b16 v[122:123], v48 offset:544
    ds_read_b64_tr_b16 v[124:125], v48 offset:8224
    ds_read_b64_tr_b16 v[126:127], v48 offset:8736
    s_waitcnt lgkmcnt(0)
mega_kernel_rs_wo7:
    s_barrier
    s_add_u32 m0, s48, 114688
    s_mov_b32 s22, 3670016
    buffer_load_dwordx4 v44, s[8:11], s22 offen  lds
    s_add_u32 m0, s48, 118784
    s_mov_b32 s22, 3702784
    buffer_load_dwordx4 v44, s[8:11], s22 offen  lds
    s_add_u32 m0, s48, 122880
    s_mov_b32 s22, 3735552
    buffer_load_dwordx4 v44, s[8:11], s22 offen  lds
    s_add_u32 m0, s48, 126976
    s_mov_b32 s22, 3768320
    buffer_load_dwordx4 v44, s[8:11], s22 offen  lds
    s_waitcnt vmcnt(28)
    s_barrier
    v_add_u32 v48, 0, v46
    ds_read_b64_tr_b16 v[64:65], v48 offset:0
    ds_read_b64_tr_b16 v[66:67], v48 offset:512
    ds_read_b64_tr_b16 v[68:69], v48 offset:8192
    ds_read_b64_tr_b16 v[70:71], v48 offset:8704
    ds_read_b64_tr_b16 v[72:73], v48 offset:8
    ds_read_b64_tr_b16 v[74:75], v48 offset:520
    ds_read_b64_tr_b16 v[76:77], v48 offset:8200
    ds_read_b64_tr_b16 v[78:79], v48 offset:8712
    s_waitcnt lgkmcnt(0)
    s_barrier
    ds_write_b128 v32, v[64:67] offset:0
    ds_write_b128 v32, v[68:71] offset:1024
    ds_write_b128 v32, v[72:75] offset:2048
    ds_write_b128 v32, v[76:79] offset:3072
    s_waitcnt lgkmcnt(0)
    s_waitcnt vmcnt(24)
    s_barrier
    v_add_u32 v48, 16384, v46
    ds_read_b64_tr_b16 v[64:65], v48 offset:0
    ds_read_b64_tr_b16 v[66:67], v48 offset:512
    ds_read_b64_tr_b16 v[68:69], v48 offset:8192
    ds_read_b64_tr_b16 v[70:71], v48 offset:8704
    ds_read_b64_tr_b16 v[72:73], v48 offset:8
    ds_read_b64_tr_b16 v[74:75], v48 offset:520
    ds_read_b64_tr_b16 v[76:77], v48 offset:8200
    ds_read_b64_tr_b16 v[78:79], v48 offset:8712
    s_waitcnt lgkmcnt(0)
    s_barrier
    ds_write_b128 v32, v[64:67] offset:16384
    ds_write_b128 v32, v[68:71] offset:17408
    ds_write_b128 v32, v[72:75] offset:18432
    ds_write_b128 v32, v[76:79] offset:19456
    s_waitcnt lgkmcnt(0)
    s_waitcnt vmcnt(20)
    s_barrier
    s_getpc_b64 s[16:17]
mega_kernel_rs_pc0:
    s_add_u32 s16, s16, mega_kernel_rs_w0_entry - mega_kernel_rs_pc0
    s_addc_u32 s17, s17, 0
    v_lshlrev_b32 v49, 7, v0
    v_min_u32 v49, mega_kernel_rs_end - mega_kernel_rs_w0_entry, v49
    global_load_dword v50, v49, s[16:17]
    v_lshlrev_b32 v49, 7, v40
    s_xor_b32 s23, s35, 16384
    s_cmp_eq_u32 s20, 1
    s_cselect_b32 s22, s35, s47
    s_cmp_eq_u32 s20, 2
    s_cselect_b32 s22, s23, s22
    s_lshl_b32 s23, s31, 13
    s_add_u32 s23, s23, 178257920
    s_cmp_eq_u32 s20, 3
    s_cselect_b32 s22, s23, s22
    buffer_load_dword v51, v49, s[4:7], s22 offen sc1
    v_lshlrev_b32 v49, 13, v0
    v_and_b32 v49, 0x1fffff, v49
    s_mov_b32 s22, 67108864
    buffer_load_dword v52, v49, s[4:7], s22 offen sc1
    buffer_load_dword v57, v7, s[4:7], 0 offen sc1
    v_add_u32 v48, 32768, v46
    ds_read_b64_tr_b16 v[64:65], v48 offset:0
    ds_read_b64_tr_b16 v[66:67], v48 offset:512
    ds_read_b64_tr_b16 v[68:69], v48 offset:8192
    ds_read_b64_tr_b16 v[70:71], v48 offset:8704
    ds_read_b64_tr_b16 v[72:73], v48 offset:8
    ds_read_b64_tr_b16 v[74:75], v48 offset:520
    ds_read_b64_tr_b16 v[76:77], v48 offset:8200
    ds_read_b64_tr_b16 v[78:79], v48 offset:8712
    s_waitcnt lgkmcnt(0)
    s_barrier
    ds_write_b128 v32, v[64:67] offset:32768
    ds_write_b128 v32, v[68:71] offset:33792
    ds_write_b128 v32, v[72:75] offset:34816
    ds_write_b128 v32, v[76:79] offset:35840
    s_waitcnt lgkmcnt(0)
    s_waitcnt vmcnt(16)
    s_barrier
    v_add_u32 v48, 49152, v46
    ds_read_b64_tr_b16 v[64:65], v48 offset:0
    ds_read_b64_tr_b16 v[66:67], v48 offset:512
    ds_read_b64_tr_b16 v[68:69], v48 offset:8192
    ds_read_b64_tr_b16 v[70:71], v48 offset:8704
    ds_read_b64_tr_b16 v[72:73], v48 offset:8
    ds_read_b64_tr_b16 v[74:75], v48 offset:520
    ds_read_b64_tr_b16 v[76:77], v48 offset:8200
    ds_read_b64_tr_b16 v[78:79], v48 offset:8712
    s_waitcnt lgkmcnt(0)
    s_barrier
    ds_write_b128 v32, v[64:67] offset:49152
    ds_write_b128 v32, v[68:71] offset:50176
    ds_write_b128 v32, v[72:75] offset:51200
    ds_write_b128 v32, v[76:79] offset:52224
    s_waitcnt lgkmcnt(0)
    s_waitcnt vmcnt(12)
    s_barrier
    v_add_u32 v48, 65536, v46
    ds_read_b64_tr_b16 v[64:65], v48 offset:0
    ds_read_b64_tr_b16 v[66:67], v48 offset:512
    ds_read_b64_tr_b16 v[68:69], v48 offset:8192
    ds_read_b64_tr_b16 v[70:71], v48 offset:8704
    ds_read_b64_tr_b16 v[72:73], v48 offset:8
    ds_read_b64_tr_b16 v[74:75], v48 offset:520
    ds_read_b64_tr_b16 v[76:77], v48 offset:8200
    ds_read_b64_tr_b16 v[78:79], v48 offset:8712
    s_waitcnt lgkmcnt(0)
    s_barrier
    ds_write_b128 v33, v[64:67] offset:0
    ds_write_b128 v33, v[68:71] offset:1024
    ds_write_b128 v33, v[72:75] offset:2048
    ds_write_b128 v33, v[76:79] offset:3072
    s_waitcnt lgkmcnt(0)
    s_waitcnt vmcnt(8)
    s_barrier
    v_add_u32 v48, 81920, v46
    ds_read_b64_tr_b16 v[208:209], v48 offset:0
    ds_read_b64_tr_b16 v[210:211], v48 offset:512
    ds_read_b64_tr_b16 v[212:213], v48 offset:8192
    ds_read_b64_tr_b16 v[214:215], v48 offset:8704
    ds_read_b64_tr_b16 v[216:217], v48 offset:8
    ds_read_b64_tr_b16 v[218:219], v48 offset:520
    ds_read_b64_tr_b16 v[220:221], v48 offset:8200
    ds_read_b64_tr_b16 v[222:223], v48 offset:8712
    s_waitcnt lgkmcnt(0)
    s_barrier
    ds_write_b128 v33, v[80:83] offset:16384
    ds_write_b128 v33, v[84:87] offset:17408
    ds_write_b128 v33, v[88:91] offset:18432
    ds_write_b128 v33, v[92:95] offset:19456
    s_waitcnt lgkmcnt(0)
    s_waitcnt vmcnt(4)
    s_barrier
    v_add_u32 v48, 98304, v46
    ds_read_b64_tr_b16 v[224:225], v48 offset:0
    ds_read_b64_tr_b16 v[226:227], v48 offset:512
    ds_read_b64_tr_b16 v[228:229], v48 offset:8192
    ds_read_b64_tr_b16 v[230:231], v48 offset:8704
    ds_read_b64_tr_b16 v[232:233], v48 offset:8
    ds_read_b64_tr_b16 v[234:235], v48 offset:520
    ds_read_b64_tr_b16 v[236:237], v48 offset:8200
    ds_read_b64_tr_b16 v[238:239], v48 offset:8712
    s_waitcnt lgkmcnt(0)
    s_barrier
    ds_write_b128 v33, v[96:99] offset:32768
    ds_write_b128 v33, v[100:103] offset:33792
    ds_write_b128 v33, v[104:107] offset:34816
    ds_write_b128 v33, v[108:111] offset:35840
    s_waitcnt lgkmcnt(0)
    s_waitcnt vmcnt(0)
    s_barrier
    v_add_u32 v48, 114688, v46
    ds_read_b64_tr_b16 v[240:241], v48 offset:0
    ds_read_b64_tr_b16 v[242:243], v48 offset:512
    ds_read_b64_tr_b16 v[244:245], v48 offset:8192
    ds_read_b64_tr_b16 v[246:247], v48 offset:8704
    ds_read_b64_tr_b16 v[248:249], v48 offset:8
    ds_read_b64_tr_b16 v[250:251], v48 offset:520
    ds_read_b64_tr_b16 v[252:253], v48 offset:8200
    ds_read_b64_tr_b16 v[254:255], v48 offset:8712
    s_waitcnt lgkmcnt(0)
    s_barrier
    ds_write_b128 v33, v[112:115] offset:49152
    ds_write_b128 v33, v[116:119] offset:50176
    ds_write_b128 v33, v[120:123] offset:51200
    ds_write_b128 v33, v[124:127] offset:52224
    s_waitcnt lgkmcnt(0)
mega_kernel_rs_iw:
    buffer_load_dword v58, off, s[12:15], 0 offset:204 sc1
    s_waitcnt vmcnt(0)
mega_kernel_rs_iw1:
    v_and_b32 v50, 0xffff, v58
    v_readfirstlane_b32 s60, v58
    v_cmp_ne_u32 vcc, s100, v50
    s_cbranch_vccnz mega_kernel_rs_iw
    s_lshr_b32 s60, s60, 15
    s_cmp_gt_u32 s60, s100
    s_cselect_b32 s60, 8192, 0
    s_bfe_u32 s22, s31, 0x10001
    s_lshl_b32 s22, s22, 12
    s_add_u32 s22, s22, s60
    s_lshl_b32 s23, s20, 10
    s_add_u32 s22, s22, s23
    s_add_u32 s38, s38, s22
    s_add_u32 s37, s37, s22
    s_xor_b32 s40, s38, 4096
    s_xor_b32 s39, s37, 4096
    s_xor_b32 s36, s35, 16384
    s_mov_b32 s21, 0
    s_cmp_eq_u32 s30, 0
    s_mov_b32 s22, 0x33003300
    s_cselect_b32 s16, 0x00330033, s22
    s_mov_b32 s17, s16
    s_cselect_b32 s18, -1, 0
    s_not_b32 s19, s18
    s_lshl_b32 s22, s31, 13
    s_lshl_b32 s23, s20, 11
    s_add_u32 s22, s22, s23
    s_add_u32 s43, s22, 16777216
    s_add_u32 s44, s22, 33554432
    s_lshl_b32 s45, s31, 13
    s_add_u32 s45, s45, 178257920
    s_mul_i32 s48, s20, 3072
    s_add_u32 m0, s48, 140288
    s_mov_b32 s41, 1
    s_mov_b32 s42, 1
    v_mov_b32 v0, v34
    v_bfrev_b32 v12, 1
    v_bfrev_b32 v3, 1
    v_cndmask_b32 v10, v3, v10, s[16:17]
    v_cndmask_b32 v9, v3, v9, s[26:27]
    s_sub_u32 s45, s45, 0
    s_lshl_b32 s51, s30, 11
    s_add_u32 s51, s51, s45
    s_mov_b32 s50, 0
    s_cmp_lg_u32 s20, 3
    s_cbranch_scc1 mega_kernel_rs_kv0
    v_readlane_b32 s50, v57, 0
    v_readlane_b32 s22, v57, 2
    v_readlane_b32 s23, v57, 1
    v_readlane_b32 s24, v57, 3
    s_nop 3
    s_min_u32 s50, s50, s22
    s_min_u32 s23, s23, s24
    s_lshl_b32 s50, s50, 1
    s_lshl_b32 s23, s23, 1
    s_add_u32 s23, s23, 1
    s_min_u32 s50, s50, s23
mega_kernel_rs_kvb0:
    s_add_u32 s22, s21, 1
    s_min_u32 s22, s22, 63
    s_cmp_gt_u32 s50, s22
    s_cbranch_scc1 mega_kernel_rs_kvd0
    buffer_load_dword v48, v7, s[4:7], 0 offen sc1
    s_waitcnt vmcnt(0)
    v_readlane_b32 s50, v48, 0
    v_readlane_b32 s22, v48, 2
    v_readlane_b32 s23, v48, 1
    v_readlane_b32 s24, v48, 3
    s_nop 3
    s_min_u32 s50, s50, s22
    s_min_u32 s23, s23, s24
    s_lshl_b32 s50, s50, 1
    s_lshl_b32 s23, s23, 1
    s_add_u32 s23, s23, 1
    s_min_u32 s50, s50, s23
    s_branch mega_kernel_rs_kvb0
mega_kernel_rs_kvd0:
mega_kernel_rs_kv0:
    s_barrier
    s_cmp_eq_u32 s20, 1
    s_cbranch_scc1 mega_kernel_rs_w1_entry
    s_cmp_eq_u32 s20, 2
    s_cbranch_scc1 mega_kernel_rs_w2_entry
    s_cmp_eq_u32 s20, 3
    s_cbranch_scc1 mega_kernel_rs_w3_entry
mega_kernel_rs_w0_entry:
    v_mfma_f32_32x32x8_bf16 v[96:111], v[14:15], v[14:15], 0
    v_mfma_f32_16x16x16_bf16 v[112:115], v[14:15], v[14:15], 0
    v_mfma_f32_16x16x16_bf16 v[116:119], v[14:15], v[14:15], 0
    ds_read_b128 v[64:67], v1 offset:0
    ds_read_b128 v[68:71], v1 offset:1024
    ds_read_b128 v[72:75], v1 offset:2048
    ds_read_b128 v[76:79], v1 offset:3072
    ds_read_b128 v[80:83], v1 offset:16384
    ds_read_b128 v[84:87], v1 offset:17408
    ds_read_b128 v[88:91], v1 offset:18432
    ds_read_b128 v[92:95], v1 offset:19456
    buffer_load_dwordx4 v[120:123], v1, s[4:7], s44 offen
    buffer_load_dwordx4 v[124:127], v1, s[4:7], s44 offen offset:1024
    s_add_u32 s44, s44, 262144
mega_kernel_rs_w0_loop:
    s_add_u32 s22, s35, 0
    s_waitcnt vmcnt(0)
    buffer_load_dwordx4 v[32:35], v1, s[4:7], s22 offen sc1
    buffer_load_dwordx4 v[36:39], v1, s[4:7], s22 offen offset:1024 sc1
mega_kernel_rs_w0_pa:
    s_waitcnt vmcnt(1)
    ds_write_b128 v6, v[32:35] offset:0
    s_waitcnt vmcnt(0)
    ds_write_b128 v6, v[36:39] offset:1024
    v_max3_u32 v3, v32, v34, v36
    v_max_u32 v3, v3, v38
    v_cmp_eq_u32 vcc, -1, v3
    v_smfmac_f32_16x16x64_bf16 v[96:99], v[32:35], a[0:7], v2
    buffer_load_dwordx4 v[32:35], v1, s[4:7], s22 offen sc1
    v_smfmac_f32_16x16x64_bf16 v[100:103], v[32:35], a[8:15], v2
    buffer_load_dwordx4 v[36:39], v1, s[4:7], s22 offen offset:1024 sc1
    v_smfmac_f32_16x16x64_bf16 v[104:107], v[32:35], a[128:135], v2
    s_cbranch_vccnz mega_kernel_rs_w0_pafail
    s_waitcnt lgkmcnt(0)
    s_barrier
    ds_read_b128 v[40:43], v6 offset:2048
    ds_read_b128 v[44:47], v6 offset:3072
    v_smfmac_f32_16x16x64_bf16 v[108:111], v[32:35], a[136:143], v2
    ds_read_b128 v[48:51], v6 offset:4096
    v_smfmac_f32_16x16x64_bf16 v[96:99], v[36:39], a[16:23], v2
    ds_read_b128 v[52:55], v6 offset:5120
    v_smfmac_f32_16x16x64_bf16 v[100:103], v[36:39], a[24:31], v2
    ds_read_b128 v[56:59], v6 offset:6144
    v_smfmac_f32_16x16x64_bf16 v[104:107], v[36:39], a[144:151], v2
    ds_read_b128 v[60:63], v6 offset:7168
    v_smfmac_f32_16x16x64_bf16 v[108:111], v[36:39], a[152:159], v2
    buffer_load_dwordx4 v1, s[4:7], s43 offen lds
    s_waitcnt lgkmcnt(5)
    v_smfmac_f32_16x16x64_bf16 v[96:99], v[40:43], a[32:39], v2
    v_smfmac_f32_16x16x64_bf16 v[104:107], v[40:43], a[160:167], v2
    s_waitcnt lgkmcnt(4)
    v_smfmac_f32_16x16x64_bf16 v[96:99], v[44:47], a[48:55], v2
    v_smfmac_f32_16x16x64_bf16 v[104:107], v[44:47], a[176:183], v2
    buffer_load_dwordx4 v1, s[4:7], s43 offen offset:1024 lds
    s_waitcnt lgkmcnt(3)
    v_smfmac_f32_16x16x64_bf16 v[96:99], v[48:51], a[64:71], v2
    v_smfmac_f32_16x16x64_bf16 v[104:107], v[48:51], a[192:199], v2
    s_waitcnt lgkmcnt(2)
    v_smfmac_f32_16x16x64_bf16 v[96:99], v[52:55], a[80:87], v2
    v_smfmac_f32_16x16x64_bf16 v[104:107], v[52:55], a[208:215], v2
    v_mov_b32 v4, s21
    buffer_store_dword v4, v7, s[4:7], 0 offen sc1
    s_waitcnt lgkmcnt(1)
    v_smfmac_f32_16x16x64_bf16 v[96:99], v[56:59], a[96:103], v2
    v_smfmac_f32_16x16x64_bf16 v[104:107], v[56:59], a[224:231], v2
    s_waitcnt lgkmcnt(0)
    v_smfmac_f32_16x16x64_bf16 v[96:99], v[60:63], a[112:119], v2
    v_smfmac_f32_16x16x64_bf16 v[104:107], v[60:63], a[240:247], v2
    v_smfmac_f32_16x16x64_bf16 v[100:103], v[40:43], a[40:47], v2
    s_nop 2
    v_smfmac_f32_16x16x64_bf16 v[100:103], v[44:47], a[56:63], v2
    s_nop 2
    v_smfmac_f32_16x16x64_bf16 v[100:103], v[48:51], a[72:79], v2
    v_add_f32 v96, v96, v98
    v_add_f32 v97, v97, v99
    v_smfmac_f32_16x16x64_bf16 v[100:103], v[52:55], a[88:95], v2
    v_add_f32 v104, v104, v106
    v_add_f32 v105, v105, v107
    v_smfmac_f32_16x16x64_bf16 v[100:103], v[56:59], a[104:111], v2
    v_cvt_pk_bf16_f32 v96, v96, v97
    v_cvt_pk_bf16_f32 v97, v104, v105
    v_smfmac_f32_16x16x64_bf16 v[100:103], v[60:63], a[120:127], v2
    v_and_or_b32 v96, v96, -2, s41
    buffer_store_dwordx2 v[96:97], v11, s[4:7], s37 offen sc1
    v_smfmac_f32_16x16x64_bf16 v[108:111], v[40:43], a[168:175], v2
    v_smfmac_f32_16x16x64_bf16 v[108:111], v[44:47], a[184:191], v2
    v_smfmac_f32_16x16x64_bf16 v[108:111], v[48:51], a[200:207], v2
    v_smfmac_f32_16x16x64_bf16 v[108:111], v[52:55], a[216:223], v2
    v_smfmac_f32_16x16x64_bf16 v[108:111], v[56:59], a[232:239], v2
    s_nop 2
    v_add_f32 v100, v100, v102
    v_smfmac_f32_16x16x64_bf16 v[108:111], v[60:63], a[248:255], v2
    v_add_f32 v101, v101, v103
    v_cvt_pk_bf16_f32 v98, v100, v101
    v_and_or_b32 v98, v98, -2, s41
    s_nop 4
    v_pk_add_f32 v[108:109], v[108:109], v[110:111]
    v_cvt_pk_bf16_f32 v99, v108, v109
    buffer_store_dwordx2 v[98:99], v11, s[4:7], s37 offen offset:512 sc1
    v_smfmac_f32_16x16x64_bf16 v[112:115], v[32:35], v[64:71], v2
    ds_read_b128 v[64:67], v1 offset:32768
    ds_read_b128 v[68:71], v1 offset:33792
    v_smfmac_f32_16x16x64_bf16 v[116:119], v[32:35], v[72:79], v2
    ds_read_b128 v[72:75], v1 offset:34816
    ds_read_b128 v[76:79], v1 offset:35840
    v_smfmac_f32_16x16x64_bf16 v[112:115], v[36:39], v[80:87], v2
    ds_read_b128 v[80:83], v1 offset:49152
    ds_read_b128 v[84:87], v1 offset:50176
    v_smfmac_f32_16x16x64_bf16 v[116:119], v[36:39], v[88:95], v2
    ds_read_b128 v[88:91], v1 offset:51200
    ds_read_b128 v[92:95], v1 offset:52224
    v_smfmac_f32_16x16x64_bf16 v[112:115], v[52:55], v[208:215], v2
    v_smfmac_f32_16x16x64_bf16 v[116:119], v[52:55], v[216:223], v2
    v_smfmac_f32_16x16x64_bf16 v[112:115], v[56:59], v[224:231], v2
    s_waitcnt lgkmcnt(6)
    v_smfmac_f32_16x16x64_bf16 v[112:115], v[40:43], v[64:71], v2
    ds_read_b128 v[64:67], v5 offset:0
    ds_read_b128 v[68:71], v5 offset:1024
    s_waitcnt lgkmcnt(6)
    v_smfmac_f32_16x16x64_bf16 v[116:119], v[40:43], v[72:79], v2
    ds_read_b128 v[72:75], v5 offset:2048
    ds_read_b128 v[76:79], v5 offset:3072
    v_smfmac_f32_16x16x64_bf16 v[116:119], v[56:59], v[232:239], v2
    v_smfmac_f32_16x16x64_bf16 v[112:115], v[60:63], v[240:247], v2
    v_smfmac_f32_16x16x64_bf16 v[116:119], v[60:63], v[248:255], v2
    s_waitcnt lgkmcnt(6)
    v_smfmac_f32_16x16x64_bf16 v[112:115], v[44:47], v[80:87], v2
    s_waitcnt lgkmcnt(4)
    v_smfmac_f32_16x16x64_bf16 v[116:119], v[44:47], v[88:95], v2
    s_waitcnt lgkmcnt(2)
    v_smfmac_f32_16x16x64_bf16 v[112:115], v[48:51], v[64:71], v2
    s_waitcnt lgkmcnt(0)
    v_smfmac_f32_16x16x64_bf16 v[116:119], v[48:51], v[72:79], v2
    v_mfma_f32_16x16x16_bf16 v[100:103], v[96:97], v[16:17], 0
    v_mfma_f32_16x16x16_bf16 v[104:107], v[98:99], v[16:17], 0
    s_nop 4
    v_add_f32 v112, v112, v114
    v_add_f32 v113, v113, v115
    v_add_f32 v114, v116, v118
    v_add_f32 v115, v117, v119
    v_cvt_pk_bf16_f32 v18, v112, v113
    v_cvt_pk_bf16_f32 v19, v114, v115
    v_and_or_b32 v18, v18, -2, s41
    v_mov_b32 v112, v18
    v_mov_b32 v114, v19
    v_mov_b32 v92, v28
    v_mov_b32 v93, 0
    s_waitcnt vmcnt(3)
    s_barrier
    ds_read_b128 v[32:35], v6 offset:9216
    ds_read_b128 v[36:39], v6 offset:10240
    ds_read_b128 v[40:43], v6 offset:12288
    ds_read_b128 v[44:47], v6 offset:13312
    buffer_load_dwordx2 v[108:109], v11, s[4:7], s38 offen sc1
    ds_read_b128 v[48:51], v6 offset:15360
    ds_read_b128 v[52:55], v6 offset:16384
    ds_read_b128 v[56:59], v6 offset:18432
    ds_read_b128 v[60:63], v6 offset:19456
    buffer_load_dwordx2 v[110:111], v11, s[4:7], s38 offen offset:512 sc1
    s_barrier
    buffer_store_dwordx2 v[18:19], v11, s[4:7], s39 offen sc1
    s_nop 15
    s_nop 15
    buffer_load_dwordx2 v[20:21], v11, s[4:7], s38 offen sc1
    buffer_load_dwordx2 v[22:23], v11, s[4:7], s38 offen offset:512 sc1
    s_waitcnt vmcnt(4)
    v_mfma_f32_16x16x16_bf16 v[80:83], v[108:109], v[16:17], v[100:103]
    v_and_b32 v3, 1, v108
    v_cmp_ne_u32 vcc, s41, v3
    s_nop 5
    v_cvt_pk_bf16_f32 v64, v80, v81
    v_cvt_pk_bf16_f32 v65, v82, v83
    s_cbranch_vccnz mega_kernel_rs_w0_xslow
    s_waitcnt vmcnt(3)
    v_mfma_f32_16x16x16_bf16 v[84:87], v[110:111], v[16:17], v[104:107]
    v_and_b32 v3, 1, v110
    v_cmp_ne_u32 vcc, s41, v3
    s_nop 5
    v_cvt_pk_bf16_f32 v66, v84, v85
    v_cvt_pk_bf16_f32 v67, v86, v87
    ds_write_b128 v6, v[64:67] offset:8192
    s_cbranch_vccnz mega_kernel_rs_w0_xslow
mega_kernel_rs_w0_xok:
    s_cmp_eq_u32 s21, 63
    s_cbranch_scc1 mega_kernel_rs_w0_last
    buffer_load_dwordx2 v[116:117], v11, s[4:7], s40 offen sc1
    s_waitcnt lgkmcnt(1)
    v_mfma_f32_16x16x32_bf16 v[80:83], v[32:35], v[64:67], 0
    s_waitcnt lgkmcnt(0)
    s_barrier
    ds_read_b128 v[68:71], v6 offset:11264
    ds_read_b128 v[72:75], v6 offset:14336
    ds_read_b128 v[76:79], v6 offset:17408
    v_mfma_f32_16x16x32_bf16 v[84:87], v[36:39], v[64:67], 0
    v_mfma_f32_16x16x32_bf16 v[88:91], v[64:67], v[64:67], 0
    buffer_load_dwordx2 v[20:21], v11, s[4:7], s40 offen sc1
    s_waitcnt lgkmcnt(2)
    v_mfma_f32_16x16x32_bf16 v[80:83], v[40:43], v[68:71], v[80:83]
    buffer_store_dwordx4 v[64:67], v10, s[4:7], s45 offen offset:0 sc1
    s_waitcnt lgkmcnt(1)
    v_mfma_f32_16x16x32_bf16 v[80:83], v[48:51], v[72:75], v[80:83]
    s_waitcnt lgkmcnt(0)
    v_mfma_f32_16x16x32_bf16 v[80:83], v[56:59], v[76:79], v[80:83]
    v_mfma_f32_16x16x32_bf16 v[84:87], v[44:47], v[68:71], v[84:87]
    v_mfma_f32_16x16x32_bf16 v[84:87], v[52:55], v[72:75], v[84:87]
    buffer_store_dwordx2 v[18:19], v11, s[4:7], s51 offen offset:2048 sc1
    v_mfma_f32_16x16x32_bf16 v[84:87], v[60:63], v[76:79], v[84:87]
    v_mfma_f32_16x16x32_bf16 v[88:91], v[68:71], v[68:71], v[88:91]
    v_mfma_f32_16x16x32_bf16 v[88:91], v[72:75], v[72:75], v[88:91]
    v_mfma_f32_16x16x32_bf16 v[88:91], v[76:79], v[76:79], v[88:91]
    v_mfma_f32_32x32x4_2b_bf16 v[32:63], v[14:15], v[14:15], 0
    s_nop 0
    v_max3_f32 v4, v80, v81, v82
    s_nop 1
    v_max3_f32 v4, v4, v83, v84
    v_max3_f32 v4, v4, v85, v86
    v_max_f32 v4, v4, v87
    v_max3_f32 v90, v4, v88, v89
    v_max3_f32 v4, v4, v88, v89
    s_nop 1
    v_permlane16_swap_b32 v4, v90
    v_max_f32 v4, v4, v90
    v_max_f32 v90, v4, v90
    s_nop 1
    v_permlane32_swap_b32 v4, v90
    v_max_f32 v4, v4, v90
    v_mul_f32 v4, s34, v4
    v_pk_fma_f32 v[80:81], v[80:81], s[34:35], v[4:5] op_sel_hi:[1,0,0] neg_lo:[0,0,1] neg_hi:[0,0,1]
    v_pk_fma_f32 v[82:83], v[82:83], s[34:35], v[4:5] op_sel_hi:[1,0,0] neg_lo:[0,0,1] neg_hi:[0,0,1]
    v_pk_fma_f32 v[84:85], v[84:85], s[34:35], v[4:5] op_sel_hi:[1,0,0] neg_lo:[0,0,1] neg_hi:[0,0,1]
    v_pk_fma_f32 v[86:87], v[86:87], s[34:35], v[4:5] op_sel_hi:[1,0,0] neg_lo:[0,0,1] neg_hi:[0,0,1]
    v_pk_fma_f32 v[88:89], v[88:89], s[34:35], v[4:5] op_sel_hi:[1,0,0] neg_lo:[0,0,1] neg_hi:[0,0,1]
    v_exp_f32 v80, v80
    v_exp_f32 v81, v81
    v_exp_f32 v82, v82
    v_cvt_pk_bf16_f32 v68, v80, v81
    v_exp_f32 v83, v83
    v_exp_f32 v84, v84
    v_cvt_pk_bf16_f32 v69, v82, v83
    v_exp_f32 v85, v85
    v_exp_f32 v86, v86
    v_cvt_pk_bf16_f32 v70, v84, v85
    v_exp_f32 v87, v87
    v_exp_f32 v88, v88
    v_cvt_pk_bf16_f32 v71, v86, v87
    v_exp_f32 v89, v89
    s_waitcnt vmcnt(3)
    v_mfma_f32_16x16x32_bf16 v[76:79], v[28:31], v[68:71], 0
    v_and_b32 v3, 1, v116
    v_cvt_pk_bf16_f32 v72, v88, v89
    v_mfma_f32_16x16x32_bf16 v[100:103], v[120:123], v[68:71], 0
    v_cmp_ne_u32 vcc, s41, v3
    v_cvt_pk_bf16_f32 v73, v88, v89
    v_mfma_f32_16x16x32_bf16 v[104:107], v[124:127], v[68:71], 0
    v_mov_b32 v113, v116
    v_mov_b32 v115, v117
    v_mfma_f32_16x16x16_bf16 v[76:79], v[92:93], v[72:73], v[76:79]
    s_cbranch_vccnz mega_kernel_rs_w0_pv0
mega_kernel_rs_w0_pv2:
    v_mfma_f32_16x16x16_bf16 v[100:103], v[112:113], v[72:73], v[100:103]
    v_mfma_f32_16x16x16_bf16 v[104:107], v[114:115], v[72:73], v[104:107]
    buffer_load_dwordx4 v[120:123], v1, s[4:7], s44 offen
    buffer_load_dwordx4 v[124:127], v1, s[4:7], s44 offen offset:1024
    s_nop 2
    v_rcp_f32 v76, v76
    s_mov_b64 exec, s[28:29]
    v_pk_mul_f32 v[100:101], v[100:101], v[76:77] op_sel_hi:[1,0]
    v_pk_mul_f32 v[102:103], v[102:103], v[76:77] op_sel_hi:[1,0]
    v_pk_mul_f32 v[104:105], v[104:105], v[76:77] op_sel_hi:[1,0]
    v_pk_mul_f32 v[106:107], v[106:107], v[76:77] op_sel_hi:[1,0]
    v_cvt_pk_bf16_f32 v84, v100, v101
    v_cvt_pk_bf16_f32 v85, v102, v103
    v_cvt_pk_bf16_f32 v86, v104, v105
    v_cvt_pk_bf16_f32 v87, v106, v107
    ds_write_b128 v6, v[84:87] offset:20448
    s_mov_b64 exec, -1
    ds_read_b128 v[88:91], v5 offset:16384
    ds_read_b128 v[92:95], v5 offset:17408
    ds_read_b128 v[112:115], v5 offset:18432
    ds_read_b128 v[116:119], v5 offset:19456
    ds_read_b128 v[96:99], v5 offset:32768
    ds_read_b128 v[100:103], v5 offset:33792
    s_waitcnt lgkmcnt(6)
    s_barrier
    ds_read_b128 v[68:71], v6 offset:20480
    ds_read_b128 v[72:75], v6 offset:21504
    ds_read_b128 v[104:107], v5 offset:34816
    ds_read_b128 v[108:111], v5 offset:35840
    ds_read_b128 v[80:83], v5 offset:49152
    ds_read_b128 v[84:87], v5 offset:50176
    s_waitcnt lgkmcnt(5)
    v_smfmac_f32_16x16x64_bf16 v[32:35], v[68:71], v[128:135], v2
    s_add_u32 s21, s21, 1
    s_xor_b32 s38, s38, 1048576
    s_xor_b32 s37, s37, 1048576
    s_waitcnt lgkmcnt(4)
    v_smfmac_f32_16x16x64_bf16 v[32:35], v[72:75], v[136:143], v2
    s_xor_b32 s40, s40, 1048576
    s_xor_b32 s39, s39, 1048576
    s_lshr_b32 s41, s21, 1
    v_smfmac_f32_16x16x64_bf16 v[36:39], v[68:71], v[144:151], v2
    s_and_b32 s41, s41, 1
    s_xor_b32 s41, s41, 1
    s_xor_b32 s35, s35, 16384
    v_smfmac_f32_16x16x64_bf16 v[36:39], v[72:75], v[152:159], v2
    v_add_f32 v32, v32, v34
    s_xor_b32 s36, s36, 16384
    s_add_u32 s43, s43, 262144
    s_add_u32 s44, s44, 262144
    v_smfmac_f32_16x16x64_bf16 v[40:43], v[68:71], v[160:167], v2
    v_add_f32 v33, v33, v35
    v_smfmac_f32_16x16x64_bf16 v[40:43], v[72:75], v[168:175], v2
    v_cvt_pk_bf16_f32 v32, v32, v33
    v_smfmac_f32_16x16x64_bf16 v[44:47], v[68:71], v[176:183], v2
    v_and_or_b32 v32, v32, -2, s42
    v_smfmac_f32_16x16x64_bf16 v[44:47], v[72:75], v[184:191], v2
    v_add_f32 v36, v36, v38
    v_smfmac_f32_16x16x64_bf16 v[48:51], v[68:71], v[192:199], v2
    v_add_f32 v37, v37, v39
    v_smfmac_f32_16x16x64_bf16 v[48:51], v[72:75], v[200:207], v2
    v_cvt_pk_bf16_f32 v33, v36, v37
    s_waitcnt lgkmcnt(0)
    v_smfmac_f32_16x16x64_bf16 v[52:55], v[68:71], v[88:95], v2
    ds_read_b128 v[88:91], v5 offset:51200
    ds_read_b128 v[92:95], v5 offset:52224
    v_smfmac_f32_16x16x64_bf16 v[52:55], v[72:75], v[112:119], v2
    v_add_f32 v40, v40, v42
    v_smfmac_f32_16x16x64_bf16 v[56:59], v[68:71], v[96:103], v2
    v_add_f32 v41, v41, v43
    v_smfmac_f32_16x16x64_bf16 v[56:59], v[72:75], v[104:111], v2
    v_cvt_pk_bf16_f32 v34, v40, v41
    v_smfmac_f32_16x16x64_bf16 v[60:63], v[68:71], v[80:87], v2
    v_add_f32 v44, v44, v46
    s_waitcnt lgkmcnt(0)
    v_smfmac_f32_16x16x64_bf16 v[60:63], v[72:75], v[88:95], v2
    v_add_f32 v45, v45, v47
    v_cvt_pk_bf16_f32 v35, v44, v45
    buffer_store_dwordx4 v[32:35], v8, s[4:7], s46 offen sc1
    v_pk_add_f32 v[48:49], v[48:49], v[50:51]
    v_cvt_pk_bf16_f32 v48, v48, v49
    v_and_or_b32 v48, v48, -2, s42
    v_pk_add_f32 v[52:53], v[52:53], v[54:55]
    v_cvt_pk_bf16_f32 v49, v52, v53
    v_pk_add_f32 v[56:57], v[56:57], v[58:59]
    v_cvt_pk_bf16_f32 v50, v56, v57
    v_pk_add_f32 v[60:61], v[60:61], v[62:63]
    v_cvt_pk_bf16_f32 v51, v60, v61
    buffer_store_dwordx4 v[48:51], v8, s[4:7], s61 offen sc1
    s_add_u32 s45, s45, 262144
    s_add_u32 s51, s51, 262144
    v_mfma_f32_32x32x8_bf16 v[96:111], v[14:15], v[14:15], 0
    v_mfma_f32_16x16x16_bf16 v[112:115], v[14:15], v[14:15], 0
    v_mfma_f32_16x16x16_bf16 v[116:119], v[14:15], v[14:15], 0
    ds_read_b128 v[64:67], v1 offset:0
    ds_read_b128 v[68:71], v1 offset:1024
    ds_read_b128 v[72:75], v1 offset:2048
    ds_read_b128 v[76:79], v1 offset:3072
    ds_read_b128 v[80:83], v1 offset:16384
    ds_read_b128 v[84:87], v1 offset:17408
    ds_read_b128 v[88:91], v1 offset:18432
    ds_read_b128 v[92:95], v1 offset:19456
    v_mov_b32 v58, -1
    v_mov_b32 v59, -1
    s_waitcnt vmcnt(0)
mega_kernel_rs_w0_pc:
    buffer_load_dword v36, v13, s[4:7], s25 offen offset:0 sc1
    buffer_load_dword v37, v13, s[4:7], s25 offen offset:256 sc1
    buffer_load_dword v38, v13, s[4:7], s25 offen offset:512 sc1
    buffer_load_dword v39, v13, s[4:7], s25 offen offset:768 sc1
    buffer_load_dword v40, v13, s[4:7], s25 offen offset:1024 sc1
    buffer_load_dword v41, v13, s[4:7], s25 offen offset:1280 sc1
    buffer_load_dword v42, v13, s[4:7], s25 offen offset:1536 sc1
    buffer_load_dword v43, v13, s[4:7], s25 offen offset:1792 sc1
    s_waitcnt vmcnt(4)
    v_mfma_f32_16x16x32_bf16 v[52:55], v[36:39], v[24:27], 0
    v_bitop3_b32 v3, s42, v36, v37 bitop3:0x7e
    v_bitop3_b32 v4, s42, v38, v39 bitop3:0x7e
    s_waitcnt vmcnt(2)
    v_or_b32 v3, v3, v4
    v_bitop3_b32 v4, s42, v40, v41 bitop3:0x7e
    s_waitcnt vmcnt(0)
    v_mfma_f32_16x16x32_bf16 v[52:55], v[40:43], v[24:27], v[52:55]
    v_bitop3_b32 v56, s42, v42, v43 bitop3:0x7e
    v_or3_b32 v3, v3, v4, v56
    v_and_b32 v3, v0, v3
    v_cmp_ne_u32 vcc, 0, v3
    s_nop 3
    v_cvt_pk_bf16_f32 v56, v52, v53
    v_cvt_pk_bf16_f32 v57, v54, v55
    v_min_u32 v56, -2, v56
    s_cbranch_vccnz mega_kernel_rs_w0_pc
    s_mov_b64 exec, s[26:27]
    buffer_store_dwordx2 v[56:57], v9, s[4:7], s35 offen offset:0 sc1
    buffer_store_dwordx2 v[58:59], v9, s[4:7], s36 offen offset:0 sc1
    s_mov_b64 exec, -1
    s_xor_b32 s42, s42, 1
    s_branch mega_kernel_rs_w0_loop
mega_kernel_rs_w0_last:
    buffer_store_dwordx4 v[64:67], v10, s[4:7], s45 offen offset:0 sc1
    buffer_store_dwordx2 v[18:19], v11, s[4:7], s51 offen offset:2048 sc1
    s_branch mega_kernel_rs_end
mega_kernel_rs_w0_pafail:
    s_nop 7
    v_mov_b32 v96, 0
    v_mov_b32 v97, 0
    v_mov_b32 v98, 0
    v_mov_b32 v99, 0
    v_mov_b32 v100, 0
    v_mov_b32 v101, 0
    v_mov_b32 v102, 0
    v_mov_b32 v103, 0
    v_mov_b32 v104, 0
    v_mov_b32 v105, 0
    v_mov_b32 v106, 0
    v_mov_b32 v107, 0
    s_branch mega_kernel_rs_w0_pa
mega_kernel_rs_w0_xslow:
    buffer_load_dwordx2 v[108:109], v11, s[4:7], s38 offen sc1
    buffer_load_dwordx2 v[110:111], v11, s[4:7], s38 offen offset:512 sc1
    s_waitcnt vmcnt(2)
    v_bitop3_b32 v3, s41, v20, v22 bitop3:0x7e
    v_mfma_f32_16x16x16_bf16 v[80:83], v[20:21], v[16:17], v[100:103]
    v_and_b32 v3, 1, v3
    v_mfma_f32_16x16x16_bf16 v[84:87], v[22:23], v[16:17], v[104:107]
    v_cmp_ne_u32 vcc, 0, v3
    s_cbranch_vccz mega_kernel_rs_w0_xgot
    buffer_load_dwordx2 v[20:21], v11, s[4:7], s38 offen sc1
    buffer_load_dwordx2 v[22:23], v11, s[4:7], s38 offen offset:512 sc1
    s_waitcnt vmcnt(2)
    v_bitop3_b32 v3, s41, v108, v110 bitop3:0x7e
    v_mfma_f32_16x16x16_bf16 v[80:83], v[108:109], v[16:17], v[100:103]
    v_and_b32 v3, 1, v3
    v_mfma_f32_16x16x16_bf16 v[84:87], v[110:111], v[16:17], v[104:107]
    v_cmp_ne_u32 vcc, 0, v3
    s_cbranch_vccz mega_kernel_rs_w0_xgot
    s_branch mega_kernel_rs_w0_xslow
mega_kernel_rs_w0_xgot:
    s_nop 3
    v_cvt_pk_bf16_f32 v64, v80, v81
    v_cvt_pk_bf16_f32 v65, v82, v83
    v_cvt_pk_bf16_f32 v66, v84, v85
    v_cvt_pk_bf16_f32 v67, v86, v87
    ds_write_b128 v6, v[64:67] offset:8192
    s_branch mega_kernel_rs_w0_xok
mega_kernel_rs_w0_pv0:
    s_waitcnt vmcnt(2)
    s_branch mega_kernel_rs_w0_pv1
mega_kernel_rs_w0_pv:
    buffer_load_dwordx2 v[20:21], v11, s[4:7], s40 offen sc1
    s_waitcnt vmcnt(0)
mega_kernel_rs_w0_pv1:
    v_and_b32 v3, 1, v20
    v_cmp_ne_u32 vcc, s41, v3
    v_mov_b32 v113, v20
    v_mov_b32 v115, v21
    s_cbranch_vccnz mega_kernel_rs_w0_pv
    s_branch mega_kernel_rs_w0_pv2
mega_kernel_rs_w1_entry:
    v_mfma_f32_32x32x8_bf16 v[96:111], v[14:15], v[14:15], 0
    v_mfma_f32_16x16x16_bf16 v[112:115], v[14:15], v[14:15], 0
    v_mfma_f32_16x16x16_bf16 v[116:119], v[14:15], v[14:15], 0
    ds_read_b128 v[64:67], v1 offset:4096
    ds_read_b128 v[68:71], v1 offset:5120
    ds_read_b128 v[72:75], v1 offset:6144
    ds_read_b128 v[76:79], v1 offset:7168
    ds_read_b128 v[80:83], v1 offset:20480
    ds_read_b128 v[84:87], v1 offset:21504
    ds_read_b128 v[88:91], v1 offset:22528
    ds_read_b128 v[92:95], v1 offset:23552
    buffer_load_dwordx4 v[120:123], v1, s[4:7], s44 offen
    buffer_load_dwordx4 v[124:127], v1, s[4:7], s44 offen offset:1024
    s_add_u32 s44, s44, 262144
mega_kernel_rs_w1_loop:
    s_add_u32 s22, s35, 2048
    s_waitcnt vmcnt(0)
    buffer_load_dwordx4 v[40:43], v1, s[4:7], s22 offen sc1
    buffer_load_dwordx4 v[44:47], v1, s[4:7], s22 offen offset:1024 sc1
mega_kernel_rs_w1_pa:
    s_waitcnt vmcnt(1)
    ds_write_b128 v6, v[40:43] offset:2048
    s_waitcnt vmcnt(0)
    ds_write_b128 v6, v[44:47] offset:3072
    v_max3_u32 v3, v40, v42, v44
    v_max_u32 v3, v3, v46
    v_cmp_eq_u32 vcc, -1, v3
    v_smfmac_f32_16x16x64_bf16 v[96:99], v[40:43], a[32:39], v2
    buffer_load_dwordx4 v[40:43], v1, s[4:7], s22 offen sc1
    v_smfmac_f32_16x16x64_bf16 v[100:103], v[40:43], a[40:47], v2
    buffer_load_dwordx4 v[44:47], v1, s[4:7], s22 offen offset:1024 sc1
    v_smfmac_f32_16x16x64_bf16 v[104:107], v[40:43], a[160:167], v2
    s_cbranch_vccnz mega_kernel_rs_w1_pafail
    s_waitcnt lgkmcnt(0)
    s_barrier
    ds_read_b128 v[48:51], v6 offset:4096
    ds_read_b128 v[52:55], v6 offset:5120
    v_smfmac_f32_16x16x64_bf16 v[108:111], v[40:43], a[168:175], v2
    ds_read_b128 v[56:59], v6 offset:6144
    v_smfmac_f32_16x16x64_bf16 v[96:99], v[44:47], a[48:55], v2
    ds_read_b128 v[60:63], v6 offset:7168
    v_smfmac_f32_16x16x64_bf16 v[100:103], v[44:47], a[56:63], v2
    ds_read_b128 v[32:35], v6 offset:0
    v_smfmac_f32_16x16x64_bf16 v[104:107], v[44:47], a[176:183], v2
    ds_read_b128 v[36:39], v6 offset:1024
    v_smfmac_f32_16x16x64_bf16 v[108:111], v[44:47], a[184:191], v2
    s_waitcnt lgkmcnt(5)
    v_smfmac_f32_16x16x64_bf16 v[96:99], v[48:51], a[64:71], v2
    buffer_load_dwordx4 v1, s[4:7], s43 offen lds
    v_smfmac_f32_16x16x64_bf16 v[104:107], v[48:51], a[192:199], v2
    s_waitcnt lgkmcnt(4)
    v_smfmac_f32_16x16x64_bf16 v[96:99], v[52:55], a[80:87], v2
    v_smfmac_f32_16x16x64_bf16 v[104:107], v[52:55], a[208:215], v2
    s_waitcnt lgkmcnt(3)
    v_smfmac_f32_16x16x64_bf16 v[96:99], v[56:59], a[96:103], v2
    buffer_load_dwordx4 v1, s[4:7], s43 offen offset:1024 lds
    v_smfmac_f32_16x16x64_bf16 v[104:107], v[56:59], a[224:231], v2
    s_waitcnt lgkmcnt(2)
    v_smfmac_f32_16x16x64_bf16 v[96:99], v[60:63], a[112:119], v2
    v_smfmac_f32_16x16x64_bf16 v[104:107], v[60:63], a[240:247], v2
    s_waitcnt lgkmcnt(1)
    v_smfmac_f32_16x16x64_bf16 v[96:99], v[32:35], a[0:7], v2
    v_smfmac_f32_16x16x64_bf16 v[104:107], v[32:35], a[128:135], v2
    s_waitcnt lgkmcnt(0)
    v_smfmac_f32_16x16x64_bf16 v[96:99], v[36:39], a[16:23], v2
    v_smfmac_f32_16x16x64_bf16 v[104:107], v[36:39], a[144:151], v2
    v_smfmac_f32_16x16x64_bf16 v[100:103], v[48:51], a[72:79], v2
    s_nop 2
    v_smfmac_f32_16x16x64_bf16 v[100:103], v[52:55], a[88:95], v2
    s_nop 2
    v_smfmac_f32_16x16x64_bf16 v[100:103], v[56:59], a[104:111], v2
    v_add_f32 v96, v96, v98
    v_add_f32 v97, v97, v99
    v_smfmac_f32_16x16x64_bf16 v[100:103], v[60:63], a[120:127], v2
    v_add_f32 v104, v104, v106
    v_add_f32 v105, v105, v107
    v_smfmac_f32_16x16x64_bf16 v[100:103], v[32:35], a[8:15], v2
    v_cvt_pk_bf16_f32 v96, v96, v97
    v_cvt_pk_bf16_f32 v97, v104, v105
    v_smfmac_f32_16x16x64_bf16 v[100:103], v[36:39], a[24:31], v2
    v_and_or_b32 v96, v96, -2, s41
    buffer_store_dwordx2 v[96:97], v11, s[4:7], s37 offen sc1
    v_smfmac_f32_16x16x64_bf16 v[108:111], v[48:51], a[200:207], v2
    v_smfmac_f32_16x16x64_bf16 v[108:111], v[52:55], a[216:223], v2
    v_smfmac_f32_16x16x64_bf16 v[108:111], v[56:59], a[232:239], v2
    v_smfmac_f32_16x16x64_bf16 v[108:111], v[60:63], a[248:255], v2
    v_smfmac_f32_16x16x64_bf16 v[108:111], v[32:35], a[136:143], v2
    s_nop 2
    v_add_f32 v100, v100, v102
    v_smfmac_f32_16x16x64_bf16 v[108:111], v[36:39], a[152:159], v2
    v_add_f32 v101, v101, v103
    v_cvt_pk_bf16_f32 v98, v100, v101
    v_and_or_b32 v98, v98, -2, s41
    s_nop 4
    v_pk_add_f32 v[108:109], v[108:109], v[110:111]
    v_cvt_pk_bf16_f32 v99, v108, v109
    buffer_store_dwordx2 v[98:99], v11, s[4:7], s37 offen offset:512 sc1
    v_smfmac_f32_16x16x64_bf16 v[112:115], v[32:35], v[64:71], v2
    ds_read_b128 v[64:67], v1 offset:36864
    ds_read_b128 v[68:71], v1 offset:37888
    v_smfmac_f32_16x16x64_bf16 v[116:119], v[32:35], v[72:79], v2
    ds_read_b128 v[72:75], v1 offset:38912
    ds_read_b128 v[76:79], v1 offset:39936
    v_smfmac_f32_16x16x64_bf16 v[112:115], v[36:39], v[80:87], v2
    ds_read_b128 v[80:83], v1 offset:53248
    ds_read_b128 v[84:87], v1 offset:54272
    v_smfmac_f32_16x16x64_bf16 v[116:119], v[36:39], v[88:95], v2
    ds_read_b128 v[88:91], v1 offset:55296
    ds_read_b128 v[92:95], v1 offset:56320
    v_smfmac_f32_16x16x64_bf16 v[112:115], v[52:55], v[208:215], v2
    v_smfmac_f32_16x16x64_bf16 v[116:119], v[52:55], v[216:223], v2
    v_smfmac_f32_16x16x64_bf16 v[112:115], v[56:59], v[224:231], v2
    s_waitcnt lgkmcnt(6)
    v_smfmac_f32_16x16x64_bf16 v[112:115], v[40:43], v[64:71], v2
    ds_read_b128 v[64:67], v5 offset:4096
    ds_read_b128 v[68:71], v5 offset:5120
    s_waitcnt lgkmcnt(6)
    v_smfmac_f32_16x16x64_bf16 v[116:119], v[40:43], v[72:79], v2
    ds_read_b128 v[72:75], v5 offset:6144
    ds_read_b128 v[76:79], v5 offset:7168
    v_smfmac_f32_16x16x64_bf16 v[116:119], v[56:59], v[232:239], v2
    v_smfmac_f32_16x16x64_bf16 v[112:115], v[60:63], v[240:247], v2
    v_smfmac_f32_16x16x64_bf16 v[116:119], v[60:63], v[248:255], v2
    s_waitcnt lgkmcnt(6)
    v_smfmac_f32_16x16x64_bf16 v[112:115], v[44:47], v[80:87], v2
    s_waitcnt lgkmcnt(4)
    v_smfmac_f32_16x16x64_bf16 v[116:119], v[44:47], v[88:95], v2
    s_waitcnt lgkmcnt(2)
    v_smfmac_f32_16x16x64_bf16 v[112:115], v[48:51], v[64:71], v2
    s_waitcnt lgkmcnt(0)
    v_smfmac_f32_16x16x64_bf16 v[116:119], v[48:51], v[72:79], v2
    v_mfma_f32_16x16x16_bf16 v[100:103], v[96:97], v[16:17], 0
    v_mfma_f32_16x16x16_bf16 v[104:107], v[98:99], v[16:17], 0
    s_nop 4
    v_add_f32 v112, v112, v114
    v_add_f32 v113, v113, v115
    v_add_f32 v114, v116, v118
    v_add_f32 v115, v117, v119
    v_cvt_pk_bf16_f32 v18, v112, v113
    v_cvt_pk_bf16_f32 v19, v114, v115
    v_and_or_b32 v18, v18, -2, s41
    v_mov_b32 v112, v18
    v_mov_b32 v114, v19
    v_mov_b32 v92, v28
    v_mov_b32 v93, 0
    s_waitcnt vmcnt(2)
    s_barrier
    ds_read_b128 v[32:35], v6 offset:12288
    ds_read_b128 v[36:39], v6 offset:13312
    ds_read_b128 v[40:43], v6 offset:9216
    ds_read_b128 v[44:47], v6 offset:10240
    buffer_load_dwordx2 v[108:109], v11, s[4:7], s38 offen sc1
    ds_read_b128 v[48:51], v6 offset:18432
    ds_read_b128 v[52:55], v6 offset:19456
    ds_read_b128 v[56:59], v6 offset:15360
    ds_read_b128 v[60:63], v6 offset:16384
    buffer_load_dwordx2 v[110:111], v11, s[4:7], s38 offen offset:512 sc1
    s_barrier
    buffer_store_dwordx2 v[18:19], v11, s[4:7], s39 offen sc1
    s_nop 15
    s_nop 15
    buffer_load_dwordx2 v[20:21], v11, s[4:7], s38 offen sc1
    buffer_load_dwordx2 v[22:23], v11, s[4:7], s38 offen offset:512 sc1
    s_waitcnt vmcnt(4)
    v_mfma_f32_16x16x16_bf16 v[80:83], v[108:109], v[16:17], v[100:103]
    v_and_b32 v3, 1, v108
    v_cmp_ne_u32 vcc, s41, v3
    s_nop 5
    v_cvt_pk_bf16_f32 v64, v80, v81
    v_cvt_pk_bf16_f32 v65, v82, v83
    s_cbranch_vccnz mega_kernel_rs_w1_xslow
    s_waitcnt vmcnt(3)
    v_mfma_f32_16x16x16_bf16 v[84:87], v[110:111], v[16:17], v[104:107]
    v_and_b32 v3, 1, v110
    v_cmp_ne_u32 vcc, s41, v3
    s_nop 5
    v_cvt_pk_bf16_f32 v66, v84, v85
    v_cvt_pk_bf16_f32 v67, v86, v87
    ds_write_b128 v6, v[64:67] offset:11264
    s_cbranch_vccnz mega_kernel_rs_w1_xslow
mega_kernel_rs_w1_xok:
    s_cmp_eq_u32 s21, 63
    s_cbranch_scc1 mega_kernel_rs_w1_last
    buffer_load_dwordx2 v[116:117], v11, s[4:7], s40 offen sc1
    s_waitcnt lgkmcnt(1)
    v_mfma_f32_16x16x32_bf16 v[80:83], v[32:35], v[64:67], 0
    s_waitcnt lgkmcnt(0)
    s_barrier
    ds_read_b128 v[68:71], v6 offset:8192
    ds_read_b128 v[72:75], v6 offset:17408
    ds_read_b128 v[76:79], v6 offset:14336
    v_mfma_f32_16x16x32_bf16 v[84:87], v[36:39], v[64:67], 0
    v_mfma_f32_16x16x32_bf16 v[88:91], v[64:67], v[64:67], 0
    buffer_load_dwordx2 v[20:21], v11, s[4:7], s40 offen sc1
    s_waitcnt lgkmcnt(2)
    v_mfma_f32_16x16x32_bf16 v[80:83], v[40:43], v[68:71], v[80:83]
    s_waitcnt lgkmcnt(1)
    v_mfma_f32_16x16x32_bf16 v[80:83], v[48:51], v[72:75], v[80:83]
    buffer_store_dwordx4 v[64:67], v10, s[4:7], s45 offen offset:64 sc1
    s_waitcnt lgkmcnt(0)
    v_mfma_f32_16x16x32_bf16 v[80:83], v[56:59], v[76:79], v[80:83]
    v_mfma_f32_16x16x32_bf16 v[84:87], v[44:47], v[68:71], v[84:87]
    v_mfma_f32_16x16x32_bf16 v[84:87], v[52:55], v[72:75], v[84:87]
    v_mfma_f32_16x16x32_bf16 v[84:87], v[60:63], v[76:79], v[84:87]
    buffer_store_dwordx2 v[18:19], v11, s[4:7], s51 offen offset:2560 sc1
    v_mfma_f32_16x16x32_bf16 v[88:91], v[68:71], v[68:71], v[88:91]
    v_mfma_f32_16x16x32_bf16 v[88:91], v[72:75], v[72:75], v[88:91]
    v_mfma_f32_16x16x32_bf16 v[88:91], v[76:79], v[76:79], v[88:91]
    v_mfma_f32_32x32x4_2b_bf16 v[32:63], v[14:15], v[14:15], 0
    s_nop 0
    v_max3_f32 v4, v80, v81, v82
    s_nop 1
    v_max3_f32 v4, v4, v83, v84
    v_max3_f32 v4, v4, v85, v86
    v_max_f32 v4, v4, v87
    v_max3_f32 v90, v4, v88, v89
    v_max3_f32 v4, v4, v88, v89
    s_nop 1
    v_permlane16_swap_b32 v4, v90
    v_max_f32 v4, v4, v90
    v_max_f32 v90, v4, v90
    s_nop 1
    v_permlane32_swap_b32 v4, v90
    v_max_f32 v4, v4, v90
    v_mul_f32 v4, s34, v4
    v_pk_fma_f32 v[80:81], v[80:81], s[34:35], v[4:5] op_sel_hi:[1,0,0] neg_lo:[0,0,1] neg_hi:[0,0,1]
    v_pk_fma_f32 v[82:83], v[82:83], s[34:35], v[4:5] op_sel_hi:[1,0,0] neg_lo:[0,0,1] neg_hi:[0,0,1]
    v_pk_fma_f32 v[84:85], v[84:85], s[34:35], v[4:5] op_sel_hi:[1,0,0] neg_lo:[0,0,1] neg_hi:[0,0,1]
    v_pk_fma_f32 v[86:87], v[86:87], s[34:35], v[4:5] op_sel_hi:[1,0,0] neg_lo:[0,0,1] neg_hi:[0,0,1]
    v_pk_fma_f32 v[88:89], v[88:89], s[34:35], v[4:5] op_sel_hi:[1,0,0] neg_lo:[0,0,1] neg_hi:[0,0,1]
    v_exp_f32 v80, v80
    v_exp_f32 v81, v81
    v_exp_f32 v82, v82
    v_cvt_pk_bf16_f32 v68, v80, v81
    v_exp_f32 v83, v83
    v_exp_f32 v84, v84
    v_cvt_pk_bf16_f32 v69, v82, v83
    v_exp_f32 v85, v85
    v_exp_f32 v86, v86
    v_cvt_pk_bf16_f32 v70, v84, v85
    v_exp_f32 v87, v87
    v_exp_f32 v88, v88
    v_cvt_pk_bf16_f32 v71, v86, v87
    v_exp_f32 v89, v89
    s_waitcnt vmcnt(3)
    v_mfma_f32_16x16x32_bf16 v[76:79], v[28:31], v[68:71], 0
    v_and_b32 v3, 1, v116
    v_cvt_pk_bf16_f32 v72, v88, v89
    v_mfma_f32_16x16x32_bf16 v[100:103], v[120:123], v[68:71], 0
    v_cmp_ne_u32 vcc, s41, v3
    v_cvt_pk_bf16_f32 v73, v88, v89
    v_mfma_f32_16x16x32_bf16 v[104:107], v[124:127], v[68:71], 0
    v_mov_b32 v113, v116
    v_mov_b32 v115, v117
    v_mfma_f32_16x16x16_bf16 v[76:79], v[92:93], v[72:73], v[76:79]
    s_cbranch_vccnz mega_kernel_rs_w1_pv0
mega_kernel_rs_w1_pv2:
    v_mfma_f32_16x16x16_bf16 v[100:103], v[112:113], v[72:73], v[100:103]
    v_mfma_f32_16x16x16_bf16 v[104:107], v[114:115], v[72:73], v[104:107]
    buffer_load_dwordx4 v[120:123], v1, s[4:7], s44 offen
    buffer_load_dwordx4 v[124:127], v1, s[4:7], s44 offen offset:1024
    s_nop 2
    v_rcp_f32 v76, v76
    s_mov_b64 exec, s[28:29]
    v_pk_mul_f32 v[100:101], v[100:101], v[76:77] op_sel_hi:[1,0]
    v_pk_mul_f32 v[102:103], v[102:103], v[76:77] op_sel_hi:[1,0]
    v_pk_mul_f32 v[104:105], v[104:105], v[76:77] op_sel_hi:[1,0]
    v_pk_mul_f32 v[106:107], v[106:107], v[76:77] op_sel_hi:[1,0]
    v_cvt_pk_bf16_f32 v84, v100, v101
    v_cvt_pk_bf16_f32 v85, v102, v103
    v_cvt_pk_bf16_f32 v86, v104, v105
    v_cvt_pk_bf16_f32 v87, v106, v107
    ds_write_b128 v6, v[84:87] offset:20480
    s_mov_b64 exec, -1
    ds_read_b128 v[88:91], v5 offset:20480
    ds_read_b128 v[92:95], v5 offset:21504
    ds_read_b128 v[112:115], v5 offset:22528
    ds_read_b128 v[116:119], v5 offset:23552
    ds_read_b128 v[96:99], v5 offset:36864
    ds_read_b128 v[100:103], v5 offset:37888
    s_waitcnt lgkmcnt(6)
    s_barrier
    ds_read_b128 v[68:71], v6 offset:20480
    ds_read_b128 v[72:75], v6 offset:21504
    ds_read_b128 v[104:107], v5 offset:38912
    ds_read_b128 v[108:111], v5 offset:39936
    ds_read_b128 v[80:83], v5 offset:53248
    ds_read_b128 v[84:87], v5 offset:54272
    s_waitcnt lgkmcnt(5)
    v_smfmac_f32_16x16x64_bf16 v[32:35], v[68:71], v[128:135], v2
    s_add_u32 s21, s21, 1
    s_xor_b32 s38, s38, 1048576
    s_xor_b32 s37, s37, 1048576
    s_waitcnt lgkmcnt(4)
    v_smfmac_f32_16x16x64_bf16 v[32:35], v[72:75], v[136:143], v2
    s_xor_b32 s40, s40, 1048576
    s_xor_b32 s39, s39, 1048576
    s_lshr_b32 s41, s21, 1
    v_smfmac_f32_16x16x64_bf16 v[36:39], v[68:71], v[144:151], v2
    s_and_b32 s41, s41, 1
    s_xor_b32 s41, s41, 1
    s_xor_b32 s35, s35, 16384
    v_smfmac_f32_16x16x64_bf16 v[36:39], v[72:75], v[152:159], v2
    v_add_f32 v32, v32, v34
    s_xor_b32 s36, s36, 16384
    s_add_u32 s43, s43, 262144
    s_add_u32 s44, s44, 262144
    v_smfmac_f32_16x16x64_bf16 v[40:43], v[68:71], v[160:167], v2
    v_add_f32 v33, v33, v35
    v_smfmac_f32_16x16x64_bf16 v[40:43], v[72:75], v[168:175], v2
    v_cvt_pk_bf16_f32 v32, v32, v33
    v_smfmac_f32_16x16x64_bf16 v[44:47], v[68:71], v[176:183], v2
    v_and_or_b32 v32, v32, -2, s42
    v_smfmac_f32_16x16x64_bf16 v[44:47], v[72:75], v[184:191], v2
    v_add_f32 v36, v36, v38
    v_smfmac_f32_16x16x64_bf16 v[48:51], v[68:71], v[192:199], v2
    v_add_f32 v37, v37, v39
    v_smfmac_f32_16x16x64_bf16 v[48:51], v[72:75], v[200:207], v2
    v_cvt_pk_bf16_f32 v33, v36, v37
    s_waitcnt lgkmcnt(0)
    v_smfmac_f32_16x16x64_bf16 v[52:55], v[68:71], v[88:95], v2
    ds_read_b128 v[88:91], v5 offset:55296
    ds_read_b128 v[92:95], v5 offset:56320
    v_smfmac_f32_16x16x64_bf16 v[52:55], v[72:75], v[112:119], v2
    v_add_f32 v40, v40, v42
    v_smfmac_f32_16x16x64_bf16 v[56:59], v[68:71], v[96:103], v2
    v_add_f32 v41, v41, v43
    v_smfmac_f32_16x16x64_bf16 v[56:59], v[72:75], v[104:111], v2
    v_cvt_pk_bf16_f32 v34, v40, v41
    v_smfmac_f32_16x16x64_bf16 v[60:63], v[68:71], v[80:87], v2
    v_add_f32 v44, v44, v46
    s_waitcnt lgkmcnt(0)
    v_smfmac_f32_16x16x64_bf16 v[60:63], v[72:75], v[88:95], v2
    v_add_f32 v45, v45, v47
    v_cvt_pk_bf16_f32 v35, v44, v45
    buffer_store_dwordx4 v[32:35], v8, s[4:7], s46 offen sc1
    v_pk_add_f32 v[48:49], v[48:49], v[50:51]
    v_cvt_pk_bf16_f32 v48, v48, v49
    v_and_or_b32 v48, v48, -2, s42
    v_pk_add_f32 v[52:53], v[52:53], v[54:55]
    v_cvt_pk_bf16_f32 v49, v52, v53
    v_pk_add_f32 v[56:57], v[56:57], v[58:59]
    v_cvt_pk_bf16_f32 v50, v56, v57
    v_pk_add_f32 v[60:61], v[60:61], v[62:63]
    v_cvt_pk_bf16_f32 v51, v60, v61
    buffer_store_dwordx4 v[48:51], v8, s[4:7], s61 offen sc1
    s_add_u32 s45, s45, 262144
    s_add_u32 s51, s51, 262144
    v_mfma_f32_32x32x8_bf16 v[96:111], v[14:15], v[14:15], 0
    v_mfma_f32_16x16x16_bf16 v[112:115], v[14:15], v[14:15], 0
    v_mfma_f32_16x16x16_bf16 v[116:119], v[14:15], v[14:15], 0
    ds_read_b128 v[64:67], v1 offset:4096
    ds_read_b128 v[68:71], v1 offset:5120
    ds_read_b128 v[72:75], v1 offset:6144
    ds_read_b128 v[76:79], v1 offset:7168
    ds_read_b128 v[80:83], v1 offset:20480
    ds_read_b128 v[84:87], v1 offset:21504
    ds_read_b128 v[88:91], v1 offset:22528
    ds_read_b128 v[92:95], v1 offset:23552
    v_mov_b32 v58, -1
    v_mov_b32 v59, -1
    s_waitcnt vmcnt(0)
mega_kernel_rs_w1_pc:
    buffer_load_dword v36, v13, s[4:7], s25 offen offset:0 sc1
    buffer_load_dword v37, v13, s[4:7], s25 offen offset:256 sc1
    buffer_load_dword v38, v13, s[4:7], s25 offen offset:512 sc1
    buffer_load_dword v39, v13, s[4:7], s25 offen offset:768 sc1
    buffer_load_dword v40, v13, s[4:7], s25 offen offset:1024 sc1
    buffer_load_dword v41, v13, s[4:7], s25 offen offset:1280 sc1
    buffer_load_dword v42, v13, s[4:7], s25 offen offset:1536 sc1
    buffer_load_dword v43, v13, s[4:7], s25 offen offset:1792 sc1
    s_waitcnt vmcnt(4)
    v_mfma_f32_16x16x32_bf16 v[52:55], v[36:39], v[24:27], 0
    v_bitop3_b32 v3, s42, v36, v37 bitop3:0x7e
    v_bitop3_b32 v4, s42, v38, v39 bitop3:0x7e
    s_waitcnt vmcnt(2)
    v_or_b32 v3, v3, v4
    v_bitop3_b32 v4, s42, v40, v41 bitop3:0x7e
    s_waitcnt vmcnt(0)
    v_mfma_f32_16x16x32_bf16 v[52:55], v[40:43], v[24:27], v[52:55]
    v_bitop3_b32 v56, s42, v42, v43 bitop3:0x7e
    v_or3_b32 v3, v3, v4, v56
    v_and_b32 v3, v0, v3
    v_cmp_ne_u32 vcc, 0, v3
    s_nop 3
    v_cvt_pk_bf16_f32 v56, v52, v53
    v_cvt_pk_bf16_f32 v57, v54, v55
    v_min_u32 v56, -2, v56
    s_cbranch_vccnz mega_kernel_rs_w1_pc
    s_mov_b64 exec, s[26:27]
    buffer_store_dwordx2 v[56:57], v9, s[4:7], s35 offen offset:256 sc1
    buffer_store_dwordx2 v[58:59], v9, s[4:7], s36 offen offset:256 sc1
    s_mov_b64 exec, -1
    s_xor_b32 s42, s42, 1
    s_branch mega_kernel_rs_w1_loop
mega_kernel_rs_w1_last:
    buffer_store_dwordx4 v[64:67], v10, s[4:7], s45 offen offset:64 sc1
    buffer_store_dwordx2 v[18:19], v11, s[4:7], s51 offen offset:2560 sc1
    s_branch mega_kernel_rs_end
mega_kernel_rs_w1_pafail:
    s_nop 7
    v_mov_b32 v96, 0
    v_mov_b32 v97, 0
    v_mov_b32 v98, 0
    v_mov_b32 v99, 0
    v_mov_b32 v100, 0
    v_mov_b32 v101, 0
    v_mov_b32 v102, 0
    v_mov_b32 v103, 0
    v_mov_b32 v104, 0
    v_mov_b32 v105, 0
    v_mov_b32 v106, 0
    v_mov_b32 v107, 0
    s_branch mega_kernel_rs_w1_pa
mega_kernel_rs_w1_xslow:
    buffer_load_dwordx2 v[108:109], v11, s[4:7], s38 offen sc1
    buffer_load_dwordx2 v[110:111], v11, s[4:7], s38 offen offset:512 sc1
    s_waitcnt vmcnt(2)
    v_bitop3_b32 v3, s41, v20, v22 bitop3:0x7e
    v_mfma_f32_16x16x16_bf16 v[80:83], v[20:21], v[16:17], v[100:103]
    v_and_b32 v3, 1, v3
    v_mfma_f32_16x16x16_bf16 v[84:87], v[22:23], v[16:17], v[104:107]
    v_cmp_ne_u32 vcc, 0, v3
    s_cbranch_vccz mega_kernel_rs_w1_xgot
    buffer_load_dwordx2 v[20:21], v11, s[4:7], s38 offen sc1
    buffer_load_dwordx2 v[22:23], v11, s[4:7], s38 offen offset:512 sc1
    s_waitcnt vmcnt(2)
    v_bitop3_b32 v3, s41, v108, v110 bitop3:0x7e
    v_mfma_f32_16x16x16_bf16 v[80:83], v[108:109], v[16:17], v[100:103]
    v_and_b32 v3, 1, v3
    v_mfma_f32_16x16x16_bf16 v[84:87], v[110:111], v[16:17], v[104:107]
    v_cmp_ne_u32 vcc, 0, v3
    s_cbranch_vccz mega_kernel_rs_w1_xgot
    s_branch mega_kernel_rs_w1_xslow
mega_kernel_rs_w1_xgot:
    s_nop 3
    v_cvt_pk_bf16_f32 v64, v80, v81
    v_cvt_pk_bf16_f32 v65, v82, v83
    v_cvt_pk_bf16_f32 v66, v84, v85
    v_cvt_pk_bf16_f32 v67, v86, v87
    ds_write_b128 v6, v[64:67] offset:11264
    s_branch mega_kernel_rs_w1_xok
mega_kernel_rs_w1_pv0:
    s_waitcnt vmcnt(2)
    s_branch mega_kernel_rs_w1_pv1
mega_kernel_rs_w1_pv:
    buffer_load_dwordx2 v[20:21], v11, s[4:7], s40 offen sc1
    s_waitcnt vmcnt(0)
mega_kernel_rs_w1_pv1:
    v_and_b32 v3, 1, v20
    v_cmp_ne_u32 vcc, s41, v3
    v_mov_b32 v113, v20
    v_mov_b32 v115, v21
    s_cbranch_vccnz mega_kernel_rs_w1_pv
    s_branch mega_kernel_rs_w1_pv2
mega_kernel_rs_w2_entry:
    v_mfma_f32_32x32x8_bf16 v[96:111], v[14:15], v[14:15], 0
    v_mfma_f32_16x16x16_bf16 v[112:115], v[14:15], v[14:15], 0
    v_mfma_f32_16x16x16_bf16 v[116:119], v[14:15], v[14:15], 0
    ds_read_b128 v[64:67], v1 offset:8192
    ds_read_b128 v[68:71], v1 offset:9216
    ds_read_b128 v[72:75], v1 offset:10240
    ds_read_b128 v[76:79], v1 offset:11264
    ds_read_b128 v[80:83], v1 offset:24576
    ds_read_b128 v[84:87], v1 offset:25600
    ds_read_b128 v[88:91], v1 offset:26624
    ds_read_b128 v[92:95], v1 offset:27648
    buffer_load_dwordx4 v[120:123], v1, s[4:7], s44 offen
    buffer_load_dwordx4 v[124:127], v1, s[4:7], s44 offen offset:1024
    s_add_u32 s44, s44, 262144
mega_kernel_rs_w2_loop:
    s_add_u32 s22, s35, 4096
    s_waitcnt vmcnt(0)
    buffer_load_dwordx4 v[48:51], v1, s[4:7], s22 offen sc1
    buffer_load_dwordx4 v[52:55], v1, s[4:7], s22 offen offset:1024 sc1
mega_kernel_rs_w2_pa:
    s_waitcnt vmcnt(1)
    ds_write_b128 v6, v[48:51] offset:4096
    s_waitcnt vmcnt(0)
    ds_write_b128 v6, v[52:55] offset:5120
    v_max3_u32 v3, v48, v50, v52
    v_max_u32 v3, v3, v54
    v_cmp_eq_u32 vcc, -1, v3
    v_smfmac_f32_16x16x64_bf16 v[96:99], v[48:51], a[64:71], v2
    buffer_load_dwordx4 v[48:51], v1, s[4:7], s22 offen sc1
    v_smfmac_f32_16x16x64_bf16 v[100:103], v[48:51], a[72:79], v2
    buffer_load_dwordx4 v[52:55], v1, s[4:7], s22 offen offset:1024 sc1
    v_smfmac_f32_16x16x64_bf16 v[104:107], v[48:51], a[192:199], v2
    s_cbranch_vccnz mega_kernel_rs_w2_pafail
    s_waitcnt lgkmcnt(0)
    s_barrier
    ds_read_b128 v[56:59], v6 offset:6144
    ds_read_b128 v[60:63], v6 offset:7168
    v_smfmac_f32_16x16x64_bf16 v[108:111], v[48:51], a[200:207], v2
    ds_read_b128 v[32:35], v6 offset:0
    v_smfmac_f32_16x16x64_bf16 v[96:99], v[52:55], a[80:87], v2
    ds_read_b128 v[36:39], v6 offset:1024
    v_smfmac_f32_16x16x64_bf16 v[100:103], v[52:55], a[88:95], v2
    ds_read_b128 v[40:43], v6 offset:2048
    v_smfmac_f32_16x16x64_bf16 v[104:107], v[52:55], a[208:215], v2
    ds_read_b128 v[44:47], v6 offset:3072
    v_smfmac_f32_16x16x64_bf16 v[108:111], v[52:55], a[216:223], v2
    s_waitcnt lgkmcnt(5)
    v_smfmac_f32_16x16x64_bf16 v[96:99], v[56:59], a[96:103], v2
    v_smfmac_f32_16x16x64_bf16 v[104:107], v[56:59], a[224:231], v2
    buffer_load_dwordx4 v1, s[4:7], s43 offen lds
    s_waitcnt lgkmcnt(4)
    v_smfmac_f32_16x16x64_bf16 v[96:99], v[60:63], a[112:119], v2
    v_smfmac_f32_16x16x64_bf16 v[104:107], v[60:63], a[240:247], v2
    s_waitcnt lgkmcnt(3)
    v_smfmac_f32_16x16x64_bf16 v[96:99], v[32:35], a[0:7], v2
    v_smfmac_f32_16x16x64_bf16 v[104:107], v[32:35], a[128:135], v2
    buffer_load_dwordx4 v1, s[4:7], s43 offen offset:1024 lds
    s_waitcnt lgkmcnt(2)
    v_smfmac_f32_16x16x64_bf16 v[96:99], v[36:39], a[16:23], v2
    v_smfmac_f32_16x16x64_bf16 v[104:107], v[36:39], a[144:151], v2
    s_waitcnt lgkmcnt(1)
    v_smfmac_f32_16x16x64_bf16 v[96:99], v[40:43], a[32:39], v2
    v_smfmac_f32_16x16x64_bf16 v[104:107], v[40:43], a[160:167], v2
    s_waitcnt lgkmcnt(0)
    v_smfmac_f32_16x16x64_bf16 v[96:99], v[44:47], a[48:55], v2
    v_smfmac_f32_16x16x64_bf16 v[104:107], v[44:47], a[176:183], v2
    v_smfmac_f32_16x16x64_bf16 v[100:103], v[56:59], a[104:111], v2
    s_nop 2
    v_smfmac_f32_16x16x64_bf16 v[100:103], v[60:63], a[120:127], v2
    s_nop 2
    v_smfmac_f32_16x16x64_bf16 v[100:103], v[32:35], a[8:15], v2
    v_add_f32 v96, v96, v98
    v_add_f32 v97, v97, v99
    v_smfmac_f32_16x16x64_bf16 v[100:103], v[36:39], a[24:31], v2
    v_add_f32 v104, v104, v106
    v_add_f32 v105, v105, v107
    v_smfmac_f32_16x16x64_bf16 v[100:103], v[40:43], a[40:47], v2
    v_cvt_pk_bf16_f32 v96, v96, v97
    v_cvt_pk_bf16_f32 v97, v104, v105
    v_smfmac_f32_16x16x64_bf16 v[100:103], v[44:47], a[56:63], v2
    v_and_or_b32 v96, v96, -2, s41
    buffer_store_dwordx2 v[96:97], v11, s[4:7], s37 offen sc1
    v_smfmac_f32_16x16x64_bf16 v[108:111], v[56:59], a[232:239], v2
    v_smfmac_f32_16x16x64_bf16 v[108:111], v[60:63], a[248:255], v2
    v_smfmac_f32_16x16x64_bf16 v[108:111], v[32:35], a[136:143], v2
    v_smfmac_f32_16x16x64_bf16 v[108:111], v[36:39], a[152:159], v2
    v_smfmac_f32_16x16x64_bf16 v[108:111], v[40:43], a[168:175], v2
    s_nop 2
    v_add_f32 v100, v100, v102
    v_smfmac_f32_16x16x64_bf16 v[108:111], v[44:47], a[184:191], v2
    v_add_f32 v101, v101, v103
    v_cvt_pk_bf16_f32 v98, v100, v101
    v_and_or_b32 v98, v98, -2, s41
    s_nop 4
    v_pk_add_f32 v[108:109], v[108:109], v[110:111]
    v_cvt_pk_bf16_f32 v99, v108, v109
    buffer_store_dwordx2 v[98:99], v11, s[4:7], s37 offen offset:512 sc1
    v_smfmac_f32_16x16x64_bf16 v[112:115], v[32:35], v[64:71], v2
    ds_read_b128 v[64:67], v1 offset:40960
    ds_read_b128 v[68:71], v1 offset:41984
    v_smfmac_f32_16x16x64_bf16 v[116:119], v[32:35], v[72:79], v2
    ds_read_b128 v[72:75], v1 offset:43008
    ds_read_b128 v[76:79], v1 offset:44032
    v_smfmac_f32_16x16x64_bf16 v[112:115], v[36:39], v[80:87], v2
    ds_read_b128 v[80:83], v1 offset:57344
    ds_read_b128 v[84:87], v1 offset:58368
    v_smfmac_f32_16x16x64_bf16 v[116:119], v[36:39], v[88:95], v2
    ds_read_b128 v[88:91], v1 offset:59392
    ds_read_b128 v[92:95], v1 offset:60416
    v_smfmac_f32_16x16x64_bf16 v[112:115], v[52:55], v[208:215], v2
    v_smfmac_f32_16x16x64_bf16 v[116:119], v[52:55], v[216:223], v2
    v_smfmac_f32_16x16x64_bf16 v[112:115], v[56:59], v[224:231], v2
    s_waitcnt lgkmcnt(6)
    v_smfmac_f32_16x16x64_bf16 v[112:115], v[40:43], v[64:71], v2
    ds_read_b128 v[64:67], v5 offset:8192
    ds_read_b128 v[68:71], v5 offset:9216
    s_waitcnt lgkmcnt(6)
    v_smfmac_f32_16x16x64_bf16 v[116:119], v[40:43], v[72:79], v2
    ds_read_b128 v[72:75], v5 offset:10240
    ds_read_b128 v[76:79], v5 offset:11264
    v_smfmac_f32_16x16x64_bf16 v[116:119], v[56:59], v[232:239], v2
    v_smfmac_f32_16x16x64_bf16 v[112:115], v[60:63], v[240:247], v2
    v_smfmac_f32_16x16x64_bf16 v[116:119], v[60:63], v[248:255], v2
    s_waitcnt lgkmcnt(6)
    v_smfmac_f32_16x16x64_bf16 v[112:115], v[44:47], v[80:87], v2
    s_waitcnt lgkmcnt(4)
    v_smfmac_f32_16x16x64_bf16 v[116:119], v[44:47], v[88:95], v2
    s_waitcnt lgkmcnt(2)
    v_smfmac_f32_16x16x64_bf16 v[112:115], v[48:51], v[64:71], v2
    s_waitcnt lgkmcnt(0)
    v_smfmac_f32_16x16x64_bf16 v[116:119], v[48:51], v[72:79], v2
    v_mfma_f32_16x16x16_bf16 v[100:103], v[96:97], v[16:17], 0
    v_mfma_f32_16x16x16_bf16 v[104:107], v[98:99], v[16:17], 0
    s_nop 4
    v_add_f32 v112, v112, v114
    v_add_f32 v113, v113, v115
    v_add_f32 v114, v116, v118
    v_add_f32 v115, v117, v119
    v_cvt_pk_bf16_f32 v18, v112, v113
    v_cvt_pk_bf16_f32 v19, v114, v115
    v_and_or_b32 v18, v18, -2, s41
    v_mov_b32 v112, v18
    v_mov_b32 v114, v19
    v_mov_b32 v92, v28
    v_mov_b32 v93, 0
    s_waitcnt vmcnt(2)
    s_barrier
    ds_read_b128 v[32:35], v6 offset:15360
    ds_read_b128 v[36:39], v6 offset:16384
    ds_read_b128 v[40:43], v6 offset:18432
    ds_read_b128 v[44:47], v6 offset:19456
    buffer_load_dwordx2 v[108:109], v11, s[4:7], s38 offen sc1
    ds_read_b128 v[48:51], v6 offset:9216
    ds_read_b128 v[52:55], v6 offset:10240
    ds_read_b128 v[56:59], v6 offset:12288
    ds_read_b128 v[60:63], v6 offset:13312
    buffer_load_dwordx2 v[110:111], v11, s[4:7], s38 offen offset:512 sc1
    s_barrier
    buffer_store_dwordx2 v[18:19], v11, s[4:7], s39 offen sc1
    s_nop 15
    s_nop 15
    buffer_load_dwordx2 v[20:21], v11, s[4:7], s38 offen sc1
    buffer_load_dwordx2 v[22:23], v11, s[4:7], s38 offen offset:512 sc1
    s_waitcnt vmcnt(4)
    v_mfma_f32_16x16x16_bf16 v[80:83], v[108:109], v[16:17], v[100:103]
    v_and_b32 v3, 1, v108
    v_cmp_ne_u32 vcc, s41, v3
    s_nop 5
    v_cvt_pk_bf16_f32 v64, v80, v81
    v_cvt_pk_bf16_f32 v65, v82, v83
    s_cbranch_vccnz mega_kernel_rs_w2_xslow
    s_waitcnt vmcnt(3)
    v_mfma_f32_16x16x16_bf16 v[84:87], v[110:111], v[16:17], v[104:107]
    v_and_b32 v3, 1, v110
    v_cmp_ne_u32 vcc, s41, v3
    s_nop 5
    v_cvt_pk_bf16_f32 v66, v84, v85
    v_cvt_pk_bf16_f32 v67, v86, v87
    ds_write_b128 v6, v[64:67] offset:14336
    s_cbranch_vccnz mega_kernel_rs_w2_xslow
mega_kernel_rs_w2_xok:
    s_cmp_eq_u32 s21, 63
    s_cbranch_scc1 mega_kernel_rs_w2_last
    buffer_load_dwordx2 v[116:117], v11, s[4:7], s40 offen sc1
    s_waitcnt lgkmcnt(1)
    v_mfma_f32_16x16x32_bf16 v[80:83], v[32:35], v[64:67], 0
    s_waitcnt lgkmcnt(0)
    s_barrier
    ds_read_b128 v[68:71], v6 offset:17408
    ds_read_b128 v[72:75], v6 offset:8192
    ds_read_b128 v[76:79], v6 offset:11264
    v_mfma_f32_16x16x32_bf16 v[84:87], v[36:39], v[64:67], 0
    v_mfma_f32_16x16x32_bf16 v[88:91], v[64:67], v[64:67], 0
    buffer_load_dwordx2 v[20:21], v11, s[4:7], s40 offen sc1
    s_waitcnt lgkmcnt(2)
    v_mfma_f32_16x16x32_bf16 v[80:83], v[40:43], v[68:71], v[80:83]
    s_waitcnt lgkmcnt(1)
    v_mfma_f32_16x16x32_bf16 v[80:83], v[48:51], v[72:75], v[80:83]
    s_waitcnt lgkmcnt(0)
    v_mfma_f32_16x16x32_bf16 v[80:83], v[56:59], v[76:79], v[80:83]
    buffer_store_dwordx4 v[64:67], v10, s[4:7], s45 offen offset:128 sc1
    v_mfma_f32_16x16x32_bf16 v[84:87], v[44:47], v[68:71], v[84:87]
    v_mfma_f32_16x16x32_bf16 v[84:87], v[52:55], v[72:75], v[84:87]
    v_mfma_f32_16x16x32_bf16 v[84:87], v[60:63], v[76:79], v[84:87]
    v_mfma_f32_16x16x32_bf16 v[88:91], v[68:71], v[68:71], v[88:91]
    buffer_store_dwordx2 v[18:19], v11, s[4:7], s51 offen offset:3072 sc1
    v_mfma_f32_16x16x32_bf16 v[88:91], v[72:75], v[72:75], v[88:91]
    v_mfma_f32_16x16x32_bf16 v[88:91], v[76:79], v[76:79], v[88:91]
    v_mfma_f32_32x32x4_2b_bf16 v[32:63], v[14:15], v[14:15], 0
    s_nop 0
    v_max3_f32 v4, v80, v81, v82
    s_nop 1
    v_max3_f32 v4, v4, v83, v84
    v_max3_f32 v4, v4, v85, v86
    v_max_f32 v4, v4, v87
    v_max3_f32 v90, v4, v88, v89
    v_max3_f32 v4, v4, v88, v89
    s_nop 1
    v_permlane16_swap_b32 v4, v90
    v_max_f32 v4, v4, v90
    v_max_f32 v90, v4, v90
    s_nop 1
    v_permlane32_swap_b32 v4, v90
    v_max_f32 v4, v4, v90
    v_mul_f32 v4, s34, v4
    v_pk_fma_f32 v[80:81], v[80:81], s[34:35], v[4:5] op_sel_hi:[1,0,0] neg_lo:[0,0,1] neg_hi:[0,0,1]
    v_pk_fma_f32 v[82:83], v[82:83], s[34:35], v[4:5] op_sel_hi:[1,0,0] neg_lo:[0,0,1] neg_hi:[0,0,1]
    v_pk_fma_f32 v[84:85], v[84:85], s[34:35], v[4:5] op_sel_hi:[1,0,0] neg_lo:[0,0,1] neg_hi:[0,0,1]
    v_pk_fma_f32 v[86:87], v[86:87], s[34:35], v[4:5] op_sel_hi:[1,0,0] neg_lo:[0,0,1] neg_hi:[0,0,1]
    v_pk_fma_f32 v[88:89], v[88:89], s[34:35], v[4:5] op_sel_hi:[1,0,0] neg_lo:[0,0,1] neg_hi:[0,0,1]
    v_exp_f32 v80, v80
    v_exp_f32 v81, v81
    v_exp_f32 v82, v82
    v_cvt_pk_bf16_f32 v68, v80, v81
    v_exp_f32 v83, v83
    v_exp_f32 v84, v84
    v_cvt_pk_bf16_f32 v69, v82, v83
    v_exp_f32 v85, v85
    v_exp_f32 v86, v86
    v_cvt_pk_bf16_f32 v70, v84, v85
    v_exp_f32 v87, v87
    v_exp_f32 v88, v88
    v_cvt_pk_bf16_f32 v71, v86, v87
    v_exp_f32 v89, v89
    s_waitcnt vmcnt(3)
    v_mfma_f32_16x16x32_bf16 v[76:79], v[28:31], v[68:71], 0
    v_and_b32 v3, 1, v116
    v_cvt_pk_bf16_f32 v72, v88, v89
    v_mfma_f32_16x16x32_bf16 v[100:103], v[120:123], v[68:71], 0
    v_cmp_ne_u32 vcc, s41, v3
    v_cvt_pk_bf16_f32 v73, v88, v89
    v_mfma_f32_16x16x32_bf16 v[104:107], v[124:127], v[68:71], 0
    v_mov_b32 v113, v116
    v_mov_b32 v115, v117
    v_mfma_f32_16x16x16_bf16 v[76:79], v[92:93], v[72:73], v[76:79]
    s_cbranch_vccnz mega_kernel_rs_w2_pv0
mega_kernel_rs_w2_pv2:
    v_mfma_f32_16x16x16_bf16 v[100:103], v[112:113], v[72:73], v[100:103]
    v_mfma_f32_16x16x16_bf16 v[104:107], v[114:115], v[72:73], v[104:107]
    buffer_load_dwordx4 v[120:123], v1, s[4:7], s44 offen
    buffer_load_dwordx4 v[124:127], v1, s[4:7], s44 offen offset:1024
    s_nop 2
    v_rcp_f32 v76, v76
    s_mov_b64 exec, s[28:29]
    v_pk_mul_f32 v[100:101], v[100:101], v[76:77] op_sel_hi:[1,0]
    v_pk_mul_f32 v[102:103], v[102:103], v[76:77] op_sel_hi:[1,0]
    v_pk_mul_f32 v[104:105], v[104:105], v[76:77] op_sel_hi:[1,0]
    v_pk_mul_f32 v[106:107], v[106:107], v[76:77] op_sel_hi:[1,0]
    v_cvt_pk_bf16_f32 v84, v100, v101
    v_cvt_pk_bf16_f32 v85, v102, v103
    v_cvt_pk_bf16_f32 v86, v104, v105
    v_cvt_pk_bf16_f32 v87, v106, v107
    ds_write_b128 v6, v[84:87] offset:21472
    s_mov_b64 exec, -1
    ds_read_b128 v[88:91], v5 offset:24576
    ds_read_b128 v[92:95], v5 offset:25600
    ds_read_b128 v[112:115], v5 offset:26624
    ds_read_b128 v[116:119], v5 offset:27648
    ds_read_b128 v[96:99], v5 offset:40960
    ds_read_b128 v[100:103], v5 offset:41984
    s_waitcnt lgkmcnt(6)
    s_barrier
    ds_read_b128 v[68:71], v6 offset:20480
    ds_read_b128 v[72:75], v6 offset:21504
    ds_read_b128 v[104:107], v5 offset:43008
    ds_read_b128 v[108:111], v5 offset:44032
    ds_read_b128 v[80:83], v5 offset:57344
    ds_read_b128 v[84:87], v5 offset:58368
    s_waitcnt lgkmcnt(5)
    v_smfmac_f32_16x16x64_bf16 v[32:35], v[68:71], v[128:135], v2
    s_add_u32 s21, s21, 1
    s_xor_b32 s38, s38, 1048576
    s_xor_b32 s37, s37, 1048576
    s_waitcnt lgkmcnt(4)
    v_smfmac_f32_16x16x64_bf16 v[32:35], v[72:75], v[136:143], v2
    s_xor_b32 s40, s40, 1048576
    s_xor_b32 s39, s39, 1048576
    s_lshr_b32 s41, s21, 1
    v_smfmac_f32_16x16x64_bf16 v[36:39], v[68:71], v[144:151], v2
    s_and_b32 s41, s41, 1
    s_xor_b32 s41, s41, 1
    s_xor_b32 s35, s35, 16384
    v_smfmac_f32_16x16x64_bf16 v[36:39], v[72:75], v[152:159], v2
    v_add_f32 v32, v32, v34
    s_xor_b32 s36, s36, 16384
    s_add_u32 s43, s43, 262144
    s_add_u32 s44, s44, 262144
    v_smfmac_f32_16x16x64_bf16 v[40:43], v[68:71], v[160:167], v2
    v_add_f32 v33, v33, v35
    v_smfmac_f32_16x16x64_bf16 v[40:43], v[72:75], v[168:175], v2
    v_cvt_pk_bf16_f32 v32, v32, v33
    v_smfmac_f32_16x16x64_bf16 v[44:47], v[68:71], v[176:183], v2
    v_and_or_b32 v32, v32, -2, s42
    v_smfmac_f32_16x16x64_bf16 v[44:47], v[72:75], v[184:191], v2
    v_add_f32 v36, v36, v38
    v_smfmac_f32_16x16x64_bf16 v[48:51], v[68:71], v[192:199], v2
    v_add_f32 v37, v37, v39
    v_smfmac_f32_16x16x64_bf16 v[48:51], v[72:75], v[200:207], v2
    v_cvt_pk_bf16_f32 v33, v36, v37
    s_waitcnt lgkmcnt(0)
    v_smfmac_f32_16x16x64_bf16 v[52:55], v[68:71], v[88:95], v2
    ds_read_b128 v[88:91], v5 offset:59392
    ds_read_b128 v[92:95], v5 offset:60416
    v_smfmac_f32_16x16x64_bf16 v[52:55], v[72:75], v[112:119], v2
    v_add_f32 v40, v40, v42
    v_smfmac_f32_16x16x64_bf16 v[56:59], v[68:71], v[96:103], v2
    v_add_f32 v41, v41, v43
    v_smfmac_f32_16x16x64_bf16 v[56:59], v[72:75], v[104:111], v2
    v_cvt_pk_bf16_f32 v34, v40, v41
    v_smfmac_f32_16x16x64_bf16 v[60:63], v[68:71], v[80:87], v2
    v_add_f32 v44, v44, v46
    s_waitcnt lgkmcnt(0)
    v_smfmac_f32_16x16x64_bf16 v[60:63], v[72:75], v[88:95], v2
    v_add_f32 v45, v45, v47
    v_cvt_pk_bf16_f32 v35, v44, v45
    buffer_store_dwordx4 v[32:35], v8, s[4:7], s46 offen sc1
    v_pk_add_f32 v[48:49], v[48:49], v[50:51]
    v_cvt_pk_bf16_f32 v48, v48, v49
    v_and_or_b32 v48, v48, -2, s42
    v_pk_add_f32 v[52:53], v[52:53], v[54:55]
    v_cvt_pk_bf16_f32 v49, v52, v53
    v_pk_add_f32 v[56:57], v[56:57], v[58:59]
    v_cvt_pk_bf16_f32 v50, v56, v57
    v_pk_add_f32 v[60:61], v[60:61], v[62:63]
    v_cvt_pk_bf16_f32 v51, v60, v61
    buffer_store_dwordx4 v[48:51], v8, s[4:7], s61 offen sc1
    s_add_u32 s45, s45, 262144
    s_add_u32 s51, s51, 262144
    v_mfma_f32_32x32x8_bf16 v[96:111], v[14:15], v[14:15], 0
    v_mfma_f32_16x16x16_bf16 v[112:115], v[14:15], v[14:15], 0
    v_mfma_f32_16x16x16_bf16 v[116:119], v[14:15], v[14:15], 0
    ds_read_b128 v[64:67], v1 offset:8192
    ds_read_b128 v[68:71], v1 offset:9216
    ds_read_b128 v[72:75], v1 offset:10240
    ds_read_b128 v[76:79], v1 offset:11264
    ds_read_b128 v[80:83], v1 offset:24576
    ds_read_b128 v[84:87], v1 offset:25600
    ds_read_b128 v[88:91], v1 offset:26624
    ds_read_b128 v[92:95], v1 offset:27648
    v_mov_b32 v58, -1
    v_mov_b32 v59, -1
    s_waitcnt vmcnt(0)
mega_kernel_rs_w2_pc:
    buffer_load_dword v36, v13, s[4:7], s25 offen offset:0 sc1
    buffer_load_dword v37, v13, s[4:7], s25 offen offset:256 sc1
    buffer_load_dword v38, v13, s[4:7], s25 offen offset:512 sc1
    buffer_load_dword v39, v13, s[4:7], s25 offen offset:768 sc1
    buffer_load_dword v40, v13, s[4:7], s25 offen offset:1024 sc1
    buffer_load_dword v41, v13, s[4:7], s25 offen offset:1280 sc1
    buffer_load_dword v42, v13, s[4:7], s25 offen offset:1536 sc1
    buffer_load_dword v43, v13, s[4:7], s25 offen offset:1792 sc1
    s_waitcnt vmcnt(4)
    v_mfma_f32_16x16x32_bf16 v[52:55], v[36:39], v[24:27], 0
    v_bitop3_b32 v3, s42, v36, v37 bitop3:0x7e
    v_bitop3_b32 v4, s42, v38, v39 bitop3:0x7e
    s_waitcnt vmcnt(2)
    v_or_b32 v3, v3, v4
    v_bitop3_b32 v4, s42, v40, v41 bitop3:0x7e
    s_waitcnt vmcnt(0)
    v_mfma_f32_16x16x32_bf16 v[52:55], v[40:43], v[24:27], v[52:55]
    v_bitop3_b32 v56, s42, v42, v43 bitop3:0x7e
    v_or3_b32 v3, v3, v4, v56
    v_and_b32 v3, v0, v3
    v_cmp_ne_u32 vcc, 0, v3
    s_nop 3
    v_cvt_pk_bf16_f32 v56, v52, v53
    v_cvt_pk_bf16_f32 v57, v54, v55
    v_min_u32 v56, -2, v56
    s_cbranch_vccnz mega_kernel_rs_w2_pc
    s_mov_b64 exec, s[26:27]
    buffer_store_dwordx2 v[56:57], v9, s[4:7], s35 offen offset:512 sc1
    buffer_store_dwordx2 v[58:59], v9, s[4:7], s36 offen offset:512 sc1
    s_mov_b64 exec, -1
    s_xor_b32 s42, s42, 1
    s_branch mega_kernel_rs_w2_loop
mega_kernel_rs_w2_last:
    buffer_store_dwordx4 v[64:67], v10, s[4:7], s45 offen offset:128 sc1
    buffer_store_dwordx2 v[18:19], v11, s[4:7], s51 offen offset:3072 sc1
    s_branch mega_kernel_rs_end
mega_kernel_rs_w2_pafail:
    s_nop 7
    v_mov_b32 v96, 0
    v_mov_b32 v97, 0
    v_mov_b32 v98, 0
    v_mov_b32 v99, 0
    v_mov_b32 v100, 0
    v_mov_b32 v101, 0
    v_mov_b32 v102, 0
    v_mov_b32 v103, 0
    v_mov_b32 v104, 0
    v_mov_b32 v105, 0
    v_mov_b32 v106, 0
    v_mov_b32 v107, 0
    s_branch mega_kernel_rs_w2_pa
mega_kernel_rs_w2_xslow:
    buffer_load_dwordx2 v[108:109], v11, s[4:7], s38 offen sc1
    buffer_load_dwordx2 v[110:111], v11, s[4:7], s38 offen offset:512 sc1
    s_waitcnt vmcnt(2)
    v_bitop3_b32 v3, s41, v20, v22 bitop3:0x7e
    v_mfma_f32_16x16x16_bf16 v[80:83], v[20:21], v[16:17], v[100:103]
    v_and_b32 v3, 1, v3
    v_mfma_f32_16x16x16_bf16 v[84:87], v[22:23], v[16:17], v[104:107]
    v_cmp_ne_u32 vcc, 0, v3
    s_cbranch_vccz mega_kernel_rs_w2_xgot
    buffer_load_dwordx2 v[20:21], v11, s[4:7], s38 offen sc1
    buffer_load_dwordx2 v[22:23], v11, s[4:7], s38 offen offset:512 sc1
    s_waitcnt vmcnt(2)
    v_bitop3_b32 v3, s41, v108, v110 bitop3:0x7e
    v_mfma_f32_16x16x16_bf16 v[80:83], v[108:109], v[16:17], v[100:103]
    v_and_b32 v3, 1, v3
    v_mfma_f32_16x16x16_bf16 v[84:87], v[110:111], v[16:17], v[104:107]
    v_cmp_ne_u32 vcc, 0, v3
    s_cbranch_vccz mega_kernel_rs_w2_xgot
    s_branch mega_kernel_rs_w2_xslow
mega_kernel_rs_w2_xgot:
    s_nop 3
    v_cvt_pk_bf16_f32 v64, v80, v81
    v_cvt_pk_bf16_f32 v65, v82, v83
    v_cvt_pk_bf16_f32 v66, v84, v85
    v_cvt_pk_bf16_f32 v67, v86, v87
    ds_write_b128 v6, v[64:67] offset:14336
    s_branch mega_kernel_rs_w2_xok
mega_kernel_rs_w2_pv0:
    s_waitcnt vmcnt(2)
    s_branch mega_kernel_rs_w2_pv1
mega_kernel_rs_w2_pv:
    buffer_load_dwordx2 v[20:21], v11, s[4:7], s40 offen sc1
    s_waitcnt vmcnt(0)
mega_kernel_rs_w2_pv1:
    v_and_b32 v3, 1, v20
    v_cmp_ne_u32 vcc, s41, v3
    v_mov_b32 v113, v20
    v_mov_b32 v115, v21
    s_cbranch_vccnz mega_kernel_rs_w2_pv
    s_branch mega_kernel_rs_w2_pv2
mega_kernel_rs_w3_entry:
    v_mfma_f32_32x32x8_bf16 v[96:111], v[14:15], v[14:15], 0
    v_mfma_f32_16x16x16_bf16 v[112:115], v[14:15], v[14:15], 0
    v_mfma_f32_16x16x16_bf16 v[116:119], v[14:15], v[14:15], 0
    ds_read_b128 v[64:67], v1 offset:12288
    ds_read_b128 v[68:71], v1 offset:13312
    ds_read_b128 v[72:75], v1 offset:14336
    ds_read_b128 v[76:79], v1 offset:15360
    ds_read_b128 v[80:83], v1 offset:28672
    ds_read_b128 v[84:87], v1 offset:29696
    ds_read_b128 v[88:91], v1 offset:30720
    ds_read_b128 v[92:95], v1 offset:31744
    buffer_load_dwordx4 v[120:123], v1, s[4:7], s44 offen
    buffer_load_dwordx4 v[124:127], v1, s[4:7], s44 offen offset:1024
    s_add_u32 s44, s44, 262144
mega_kernel_rs_w3_loop:
    s_add_u32 s22, s35, 6144
    s_waitcnt vmcnt(0)
    buffer_load_dwordx4 v[56:59], v1, s[4:7], s22 offen sc1
    buffer_load_dwordx4 v[60:63], v1, s[4:7], s22 offen offset:1024 sc1
mega_kernel_rs_w3_pa:
    s_waitcnt vmcnt(1)
    ds_write_b128 v6, v[56:59] offset:6144
    s_waitcnt vmcnt(0)
    ds_write_b128 v6, v[60:63] offset:7168
    v_max3_u32 v3, v56, v58, v60
    v_max_u32 v3, v3, v62
    v_cmp_eq_u32 vcc, -1, v3
    v_smfmac_f32_16x16x64_bf16 v[96:99], v[56:59], a[96:103], v2
    buffer_load_dwordx4 v[56:59], v1, s[4:7], s22 offen sc1
    v_smfmac_f32_16x16x64_bf16 v[100:103], v[56:59], a[104:111], v2
    buffer_load_dwordx4 v[60:63], v1, s[4:7], s22 offen offset:1024 sc1
    v_smfmac_f32_16x16x64_bf16 v[104:107], v[56:59], a[224:231], v2
    s_cbranch_vccnz mega_kernel_rs_w3_pafail
    s_waitcnt lgkmcnt(0)
    s_barrier
    ds_read_b128 v[32:35], v6 offset:0
    ds_read_b128 v[36:39], v6 offset:1024
    v_smfmac_f32_16x16x64_bf16 v[108:111], v[56:59], a[232:239], v2
    ds_read_b128 v[40:43], v6 offset:2048
    v_smfmac_f32_16x16x64_bf16 v[96:99], v[60:63], a[112:119], v2
    ds_read_b128 v[44:47], v6 offset:3072
    v_smfmac_f32_16x16x64_bf16 v[100:103], v[60:63], a[120:127], v2
    ds_read_b128 v[48:51], v6 offset:4096
    v_smfmac_f32_16x16x64_bf16 v[104:107], v[60:63], a[240:247], v2
    ds_read_b128 v[52:55], v6 offset:5120
    v_smfmac_f32_16x16x64_bf16 v[108:111], v[60:63], a[248:255], v2
    s_waitcnt lgkmcnt(5)
    v_smfmac_f32_16x16x64_bf16 v[96:99], v[32:35], a[0:7], v2
    v_smfmac_f32_16x16x64_bf16 v[104:107], v[32:35], a[128:135], v2
    s_waitcnt lgkmcnt(4)
    v_smfmac_f32_16x16x64_bf16 v[96:99], v[36:39], a[16:23], v2
    buffer_load_dwordx4 v1, s[4:7], s43 offen lds
    v_smfmac_f32_16x16x64_bf16 v[104:107], v[36:39], a[144:151], v2
    s_waitcnt lgkmcnt(3)
    v_smfmac_f32_16x16x64_bf16 v[96:99], v[40:43], a[32:39], v2
    v_smfmac_f32_16x16x64_bf16 v[104:107], v[40:43], a[160:167], v2
    s_waitcnt lgkmcnt(2)
    v_smfmac_f32_16x16x64_bf16 v[96:99], v[44:47], a[48:55], v2
    buffer_load_dwordx4 v1, s[4:7], s43 offen offset:1024 lds
    v_smfmac_f32_16x16x64_bf16 v[104:107], v[44:47], a[176:183], v2
    s_waitcnt lgkmcnt(1)
    v_smfmac_f32_16x16x64_bf16 v[96:99], v[48:51], a[64:71], v2
    v_smfmac_f32_16x16x64_bf16 v[104:107], v[48:51], a[192:199], v2
    s_waitcnt lgkmcnt(0)
    v_smfmac_f32_16x16x64_bf16 v[96:99], v[52:55], a[80:87], v2
    buffer_load_dword v12, v7, s[4:7], 0 offen sc1
    v_smfmac_f32_16x16x64_bf16 v[104:107], v[52:55], a[208:215], v2
    v_smfmac_f32_16x16x64_bf16 v[100:103], v[32:35], a[8:15], v2
    s_nop 2
    v_smfmac_f32_16x16x64_bf16 v[100:103], v[36:39], a[24:31], v2
    s_nop 2
    v_smfmac_f32_16x16x64_bf16 v[100:103], v[40:43], a[40:47], v2
    v_add_f32 v96, v96, v98
    v_add_f32 v97, v97, v99
    v_smfmac_f32_16x16x64_bf16 v[100:103], v[44:47], a[56:63], v2
    v_add_f32 v104, v104, v106
    v_add_f32 v105, v105, v107
    v_smfmac_f32_16x16x64_bf16 v[100:103], v[48:51], a[72:79], v2
    v_cvt_pk_bf16_f32 v96, v96, v97
    v_cvt_pk_bf16_f32 v97, v104, v105
    v_smfmac_f32_16x16x64_bf16 v[100:103], v[52:55], a[88:95], v2
    v_and_or_b32 v96, v96, -2, s41
    buffer_store_dwordx2 v[96:97], v11, s[4:7], s37 offen sc1
    v_smfmac_f32_16x16x64_bf16 v[108:111], v[32:35], a[136:143], v2
    v_smfmac_f32_16x16x64_bf16 v[108:111], v[36:39], a[152:159], v2
    v_smfmac_f32_16x16x64_bf16 v[108:111], v[40:43], a[168:175], v2
    v_smfmac_f32_16x16x64_bf16 v[108:111], v[44:47], a[184:191], v2
    v_smfmac_f32_16x16x64_bf16 v[108:111], v[48:51], a[200:207], v2
    s_nop 2
    v_add_f32 v100, v100, v102
    v_smfmac_f32_16x16x64_bf16 v[108:111], v[52:55], a[216:223], v2
    v_add_f32 v101, v101, v103
    v_cvt_pk_bf16_f32 v98, v100, v101
    v_and_or_b32 v98, v98, -2, s41
    s_nop 4
    v_pk_add_f32 v[108:109], v[108:109], v[110:111]
    v_cvt_pk_bf16_f32 v99, v108, v109
    buffer_store_dwordx2 v[98:99], v11, s[4:7], s37 offen offset:512 sc1
    v_smfmac_f32_16x16x64_bf16 v[112:115], v[32:35], v[64:71], v2
    ds_read_b128 v[64:67], v1 offset:45056
    ds_read_b128 v[68:71], v1 offset:46080
    v_smfmac_f32_16x16x64_bf16 v[116:119], v[32:35], v[72:79], v2
    ds_read_b128 v[72:75], v1 offset:47104
    ds_read_b128 v[76:79], v1 offset:48128
    v_smfmac_f32_16x16x64_bf16 v[112:115], v[36:39], v[80:87], v2
    ds_read_b128 v[80:83], v1 offset:61440
    ds_read_b128 v[84:87], v1 offset:62464
    v_smfmac_f32_16x16x64_bf16 v[116:119], v[36:39], v[88:95], v2
    ds_read_b128 v[88:91], v1 offset:63488
    ds_read_b128 v[92:95], v1 offset:64512
    v_smfmac_f32_16x16x64_bf16 v[112:115], v[52:55], v[208:215], v2
    v_smfmac_f32_16x16x64_bf16 v[116:119], v[52:55], v[216:223], v2
    v_smfmac_f32_16x16x64_bf16 v[112:115], v[56:59], v[224:231], v2
    s_waitcnt lgkmcnt(6)
    v_smfmac_f32_16x16x64_bf16 v[112:115], v[40:43], v[64:71], v2
    ds_read_b128 v[64:67], v5 offset:12288
    ds_read_b128 v[68:71], v5 offset:13312
    s_waitcnt lgkmcnt(6)
    v_smfmac_f32_16x16x64_bf16 v[116:119], v[40:43], v[72:79], v2
    ds_read_b128 v[72:75], v5 offset:14336
    ds_read_b128 v[76:79], v5 offset:15360
    v_smfmac_f32_16x16x64_bf16 v[116:119], v[56:59], v[232:239], v2
    v_smfmac_f32_16x16x64_bf16 v[112:115], v[60:63], v[240:247], v2
    v_smfmac_f32_16x16x64_bf16 v[116:119], v[60:63], v[248:255], v2
    s_waitcnt lgkmcnt(6)
    v_smfmac_f32_16x16x64_bf16 v[112:115], v[44:47], v[80:87], v2
    s_waitcnt lgkmcnt(4)
    v_smfmac_f32_16x16x64_bf16 v[116:119], v[44:47], v[88:95], v2
    s_waitcnt lgkmcnt(2)
    v_smfmac_f32_16x16x64_bf16 v[112:115], v[48:51], v[64:71], v2
    s_waitcnt lgkmcnt(0)
    v_smfmac_f32_16x16x64_bf16 v[116:119], v[48:51], v[72:79], v2
    v_mfma_f32_16x16x16_bf16 v[100:103], v[96:97], v[16:17], 0
    v_mfma_f32_16x16x16_bf16 v[104:107], v[98:99], v[16:17], 0
    s_nop 4
    v_add_f32 v112, v112, v114
    v_add_f32 v113, v113, v115
    v_add_f32 v114, v116, v118
    v_add_f32 v115, v117, v119
    v_cvt_pk_bf16_f32 v18, v112, v113
    v_cvt_pk_bf16_f32 v19, v114, v115
    v_and_or_b32 v18, v18, -2, s41
    v_mov_b32 v112, v18
    v_mov_b32 v114, v19
    v_mov_b32 v92, v28
    v_mov_b32 v93, 0
    s_waitcnt vmcnt(3)
    s_barrier
    ds_read_b128 v[32:35], v6 offset:18432
    ds_read_b128 v[36:39], v6 offset:19456
    ds_read_b128 v[40:43], v6 offset:15360
    ds_read_b128 v[44:47], v6 offset:16384
    buffer_load_dwordx2 v[108:109], v11, s[4:7], s38 offen sc1
    ds_read_b128 v[48:51], v6 offset:12288
    ds_read_b128 v[52:55], v6 offset:13312
    ds_read_b128 v[56:59], v6 offset:9216
    ds_read_b128 v[60:63], v6 offset:10240
    buffer_load_dwordx2 v[110:111], v11, s[4:7], s38 offen offset:512 sc1
    s_barrier
    buffer_store_dwordx2 v[18:19], v11, s[4:7], s39 offen sc1
    s_nop 15
    s_nop 15
    buffer_load_dwordx2 v[20:21], v11, s[4:7], s38 offen sc1
    buffer_load_dwordx2 v[22:23], v11, s[4:7], s38 offen offset:512 sc1
    s_waitcnt vmcnt(4)
    v_mfma_f32_16x16x16_bf16 v[80:83], v[108:109], v[16:17], v[100:103]
    v_and_b32 v3, 1, v108
    v_cmp_ne_u32 vcc, s41, v3
    s_nop 5
    v_cvt_pk_bf16_f32 v64, v80, v81
    v_cvt_pk_bf16_f32 v65, v82, v83
    s_cbranch_vccnz mega_kernel_rs_w3_xslow
    s_waitcnt vmcnt(3)
    v_mfma_f32_16x16x16_bf16 v[84:87], v[110:111], v[16:17], v[104:107]
    v_and_b32 v3, 1, v110
    v_cmp_ne_u32 vcc, s41, v3
    s_nop 5
    v_cvt_pk_bf16_f32 v66, v84, v85
    v_cvt_pk_bf16_f32 v67, v86, v87
    ds_write_b128 v6, v[64:67] offset:17408
    s_cbranch_vccnz mega_kernel_rs_w3_xslow
mega_kernel_rs_w3_xok:
    s_cmp_eq_u32 s21, 63
    s_cbranch_scc1 mega_kernel_rs_w3_last
    buffer_load_dwordx2 v[116:117], v11, s[4:7], s40 offen sc1
    s_waitcnt lgkmcnt(1)
    v_mfma_f32_16x16x32_bf16 v[80:83], v[32:35], v[64:67], 0
    s_waitcnt lgkmcnt(0)
    s_barrier
    ds_read_b128 v[68:71], v6 offset:14336
    ds_read_b128 v[72:75], v6 offset:11264
    ds_read_b128 v[76:79], v6 offset:8192
    v_mfma_f32_16x16x32_bf16 v[84:87], v[36:39], v[64:67], 0
    v_mfma_f32_16x16x32_bf16 v[88:91], v[64:67], v[64:67], 0
    buffer_load_dwordx2 v[20:21], v11, s[4:7], s40 offen sc1
    s_waitcnt lgkmcnt(2)
    v_mfma_f32_16x16x32_bf16 v[80:83], v[40:43], v[68:71], v[80:83]
    s_waitcnt lgkmcnt(1)
    v_mfma_f32_16x16x32_bf16 v[80:83], v[48:51], v[72:75], v[80:83]
    s_waitcnt lgkmcnt(0)
    v_mfma_f32_16x16x32_bf16 v[80:83], v[56:59], v[76:79], v[80:83]
    v_mfma_f32_16x16x32_bf16 v[84:87], v[44:47], v[68:71], v[84:87]
    buffer_store_dwordx4 v[64:67], v10, s[4:7], s45 offen offset:192 sc1
    v_mfma_f32_16x16x32_bf16 v[84:87], v[52:55], v[72:75], v[84:87]
    v_mfma_f32_16x16x32_bf16 v[84:87], v[60:63], v[76:79], v[84:87]
    v_mfma_f32_16x16x32_bf16 v[88:91], v[68:71], v[68:71], v[88:91]
    v_mfma_f32_16x16x32_bf16 v[88:91], v[72:75], v[72:75], v[88:91]
    buffer_store_dwordx2 v[18:19], v11, s[4:7], s51 offen offset:3584 sc1
    v_mfma_f32_16x16x32_bf16 v[88:91], v[76:79], v[76:79], v[88:91]
    v_mfma_f32_32x32x4_2b_bf16 v[32:63], v[14:15], v[14:15], 0
    s_nop 0
    v_max3_f32 v4, v80, v81, v82
    s_nop 1
    v_max3_f32 v4, v4, v83, v84
    v_max3_f32 v4, v4, v85, v86
    v_max_f32 v4, v4, v87
    v_max3_f32 v90, v4, v88, v89
    v_max3_f32 v4, v4, v88, v89
    s_nop 1
    v_permlane16_swap_b32 v4, v90
    v_max_f32 v4, v4, v90
    v_max_f32 v90, v4, v90
    s_nop 1
    v_permlane32_swap_b32 v4, v90
    v_max_f32 v4, v4, v90
    v_mul_f32 v4, s34, v4
    v_pk_fma_f32 v[80:81], v[80:81], s[34:35], v[4:5] op_sel_hi:[1,0,0] neg_lo:[0,0,1] neg_hi:[0,0,1]
    v_pk_fma_f32 v[82:83], v[82:83], s[34:35], v[4:5] op_sel_hi:[1,0,0] neg_lo:[0,0,1] neg_hi:[0,0,1]
    v_pk_fma_f32 v[84:85], v[84:85], s[34:35], v[4:5] op_sel_hi:[1,0,0] neg_lo:[0,0,1] neg_hi:[0,0,1]
    v_pk_fma_f32 v[86:87], v[86:87], s[34:35], v[4:5] op_sel_hi:[1,0,0] neg_lo:[0,0,1] neg_hi:[0,0,1]
    v_pk_fma_f32 v[88:89], v[88:89], s[34:35], v[4:5] op_sel_hi:[1,0,0] neg_lo:[0,0,1] neg_hi:[0,0,1]
    v_exp_f32 v80, v80
    v_exp_f32 v81, v81
    v_exp_f32 v82, v82
    v_cvt_pk_bf16_f32 v68, v80, v81
    v_exp_f32 v83, v83
    v_exp_f32 v84, v84
    v_cvt_pk_bf16_f32 v69, v82, v83
    v_exp_f32 v85, v85
    v_exp_f32 v86, v86
    v_cvt_pk_bf16_f32 v70, v84, v85
    v_exp_f32 v87, v87
    v_exp_f32 v88, v88
    v_cvt_pk_bf16_f32 v71, v86, v87
    v_exp_f32 v89, v89
    s_waitcnt vmcnt(3)
    v_mfma_f32_16x16x32_bf16 v[76:79], v[28:31], v[68:71], 0
    v_and_b32 v3, 1, v116
    v_cvt_pk_bf16_f32 v72, v88, v89
    v_mfma_f32_16x16x32_bf16 v[100:103], v[120:123], v[68:71], 0
    v_cmp_ne_u32 vcc, s41, v3
    v_cvt_pk_bf16_f32 v73, v88, v89
    v_mfma_f32_16x16x32_bf16 v[104:107], v[124:127], v[68:71], 0
    v_mov_b32 v113, v116
    v_mov_b32 v115, v117
    v_mfma_f32_16x16x16_bf16 v[76:79], v[92:93], v[72:73], v[76:79]
    s_cbranch_vccnz mega_kernel_rs_w3_pv0
mega_kernel_rs_w3_pv2:
    v_mfma_f32_16x16x16_bf16 v[100:103], v[112:113], v[72:73], v[100:103]
    v_mfma_f32_16x16x16_bf16 v[104:107], v[114:115], v[72:73], v[104:107]
    buffer_load_dwordx4 v[120:123], v1, s[4:7], s44 offen
    buffer_load_dwordx4 v[124:127], v1, s[4:7], s44 offen offset:1024
    s_nop 2
    v_rcp_f32 v76, v76
    s_mov_b64 exec, s[28:29]
    v_pk_mul_f32 v[100:101], v[100:101], v[76:77] op_sel_hi:[1,0]
    v_pk_mul_f32 v[102:103], v[102:103], v[76:77] op_sel_hi:[1,0]
    v_pk_mul_f32 v[104:105], v[104:105], v[76:77] op_sel_hi:[1,0]
    v_pk_mul_f32 v[106:107], v[106:107], v[76:77] op_sel_hi:[1,0]
    v_cvt_pk_bf16_f32 v84, v100, v101
    v_cvt_pk_bf16_f32 v85, v102, v103
    v_cvt_pk_bf16_f32 v86, v104, v105
    v_cvt_pk_bf16_f32 v87, v106, v107
    ds_write_b128 v6, v[84:87] offset:21504
    s_mov_b64 exec, -1
    ds_read_b128 v[88:91], v5 offset:28672
    ds_read_b128 v[92:95], v5 offset:29696
    ds_read_b128 v[112:115], v5 offset:30720
    ds_read_b128 v[116:119], v5 offset:31744
    ds_read_b128 v[96:99], v5 offset:45056
    ds_read_b128 v[100:103], v5 offset:46080
    s_waitcnt lgkmcnt(6)
    s_barrier
    ds_read_b128 v[68:71], v6 offset:20480
    ds_read_b128 v[72:75], v6 offset:21504
    ds_read_b128 v[104:107], v5 offset:47104
    ds_read_b128 v[108:111], v5 offset:48128
    ds_read_b128 v[80:83], v5 offset:61440
    ds_read_b128 v[84:87], v5 offset:62464
    s_waitcnt lgkmcnt(5)
    v_smfmac_f32_16x16x64_bf16 v[32:35], v[68:71], v[128:135], v2
    s_add_u32 s21, s21, 1
    s_xor_b32 s38, s38, 1048576
    s_xor_b32 s37, s37, 1048576
    s_waitcnt lgkmcnt(4)
    v_smfmac_f32_16x16x64_bf16 v[32:35], v[72:75], v[136:143], v2
    s_xor_b32 s40, s40, 1048576
    s_xor_b32 s39, s39, 1048576
    s_lshr_b32 s41, s21, 1
    v_smfmac_f32_16x16x64_bf16 v[36:39], v[68:71], v[144:151], v2
    s_and_b32 s41, s41, 1
    s_xor_b32 s41, s41, 1
    s_xor_b32 s35, s35, 16384
    v_smfmac_f32_16x16x64_bf16 v[36:39], v[72:75], v[152:159], v2
    v_add_f32 v32, v32, v34
    s_xor_b32 s36, s36, 16384
    s_add_u32 s43, s43, 262144
    s_add_u32 s44, s44, 262144
    v_smfmac_f32_16x16x64_bf16 v[40:43], v[68:71], v[160:167], v2
    v_add_f32 v33, v33, v35
    v_smfmac_f32_16x16x64_bf16 v[40:43], v[72:75], v[168:175], v2
    v_cvt_pk_bf16_f32 v32, v32, v33
    v_smfmac_f32_16x16x64_bf16 v[44:47], v[68:71], v[176:183], v2
    v_and_or_b32 v32, v32, -2, s42
    v_smfmac_f32_16x16x64_bf16 v[44:47], v[72:75], v[184:191], v2
    v_add_f32 v36, v36, v38
    v_smfmac_f32_16x16x64_bf16 v[48:51], v[68:71], v[192:199], v2
    v_add_f32 v37, v37, v39
    v_smfmac_f32_16x16x64_bf16 v[48:51], v[72:75], v[200:207], v2
    v_cvt_pk_bf16_f32 v33, v36, v37
    s_waitcnt lgkmcnt(0)
    v_smfmac_f32_16x16x64_bf16 v[52:55], v[68:71], v[88:95], v2
    ds_read_b128 v[88:91], v5 offset:63488
    ds_read_b128 v[92:95], v5 offset:64512
    v_smfmac_f32_16x16x64_bf16 v[52:55], v[72:75], v[112:119], v2
    v_add_f32 v40, v40, v42
    v_smfmac_f32_16x16x64_bf16 v[56:59], v[68:71], v[96:103], v2
    v_add_f32 v41, v41, v43
    v_smfmac_f32_16x16x64_bf16 v[56:59], v[72:75], v[104:111], v2
    v_cvt_pk_bf16_f32 v34, v40, v41
    v_smfmac_f32_16x16x64_bf16 v[60:63], v[68:71], v[80:87], v2
    v_add_f32 v44, v44, v46
    s_waitcnt lgkmcnt(0)
    v_smfmac_f32_16x16x64_bf16 v[60:63], v[72:75], v[88:95], v2
    v_add_f32 v45, v45, v47
    v_cvt_pk_bf16_f32 v35, v44, v45
    buffer_store_dwordx4 v[32:35], v8, s[4:7], s46 offen sc1
    v_pk_add_f32 v[48:49], v[48:49], v[50:51]
    v_cvt_pk_bf16_f32 v48, v48, v49
    v_and_or_b32 v48, v48, -2, s42
    v_pk_add_f32 v[52:53], v[52:53], v[54:55]
    v_cvt_pk_bf16_f32 v49, v52, v53
    v_pk_add_f32 v[56:57], v[56:57], v[58:59]
    v_cvt_pk_bf16_f32 v50, v56, v57
    v_pk_add_f32 v[60:61], v[60:61], v[62:63]
    v_cvt_pk_bf16_f32 v51, v60, v61
    buffer_store_dwordx4 v[48:51], v8, s[4:7], s61 offen sc1
    s_add_u32 s45, s45, 262144
    s_add_u32 s51, s51, 262144
    v_mfma_f32_32x32x8_bf16 v[96:111], v[14:15], v[14:15], 0
    v_mfma_f32_16x16x16_bf16 v[112:115], v[14:15], v[14:15], 0
    v_mfma_f32_16x16x16_bf16 v[116:119], v[14:15], v[14:15], 0
    ds_read_b128 v[64:67], v1 offset:12288
    ds_read_b128 v[68:71], v1 offset:13312
    ds_read_b128 v[72:75], v1 offset:14336
    ds_read_b128 v[76:79], v1 offset:15360
    ds_read_b128 v[80:83], v1 offset:28672
    ds_read_b128 v[84:87], v1 offset:29696
    ds_read_b128 v[88:91], v1 offset:30720
    ds_read_b128 v[92:95], v1 offset:31744
    s_add_u32 s22, s21, 2
    s_cmp_gt_u32 s50, s22
    s_cbranch_scc1 mega_kernel_rs_w3_kvs
    v_readlane_b32 s50, v12, 0
    v_readlane_b32 s22, v12, 2
    v_readlane_b32 s23, v12, 1
    v_readlane_b32 s24, v12, 3
    s_nop 3
    s_min_u32 s50, s50, s22
    s_min_u32 s23, s23, s24
    s_lshl_b32 s50, s50, 1
    s_lshl_b32 s23, s23, 1
    s_add_u32 s23, s23, 1
    s_min_u32 s50, s50, s23
mega_kernel_rs_kvb1:
    s_add_u32 s22, s21, 1
    s_min_u32 s22, s22, 63
    s_cmp_gt_u32 s50, s22
    s_cbranch_scc1 mega_kernel_rs_kvd1
    buffer_load_dword v12, v7, s[4:7], 0 offen sc1
    s_waitcnt vmcnt(0)
    v_readlane_b32 s50, v12, 0
    v_readlane_b32 s22, v12, 2
    v_readlane_b32 s23, v12, 1
    v_readlane_b32 s24, v12, 3
    s_nop 3
    s_min_u32 s50, s50, s22
    s_min_u32 s23, s23, s24
    s_lshl_b32 s50, s50, 1
    s_lshl_b32 s23, s23, 1
    s_add_u32 s23, s23, 1
    s_min_u32 s50, s50, s23
    s_branch mega_kernel_rs_kvb1
mega_kernel_rs_kvd1:
mega_kernel_rs_w3_kvs:
    v_mov_b32 v58, -1
    v_mov_b32 v59, -1
    s_waitcnt vmcnt(0)
mega_kernel_rs_w3_pc:
    buffer_load_dword v36, v13, s[4:7], s25 offen offset:0 sc1
    buffer_load_dword v37, v13, s[4:7], s25 offen offset:256 sc1
    buffer_load_dword v38, v13, s[4:7], s25 offen offset:512 sc1
    buffer_load_dword v39, v13, s[4:7], s25 offen offset:768 sc1
    buffer_load_dword v40, v13, s[4:7], s25 offen offset:1024 sc1
    buffer_load_dword v41, v13, s[4:7], s25 offen offset:1280 sc1
    buffer_load_dword v42, v13, s[4:7], s25 offen offset:1536 sc1
    buffer_load_dword v43, v13, s[4:7], s25 offen offset:1792 sc1
    s_waitcnt vmcnt(4)
    v_mfma_f32_16x16x32_bf16 v[52:55], v[36:39], v[24:27], 0
    v_bitop3_b32 v3, s42, v36, v37 bitop3:0x7e
    v_bitop3_b32 v4, s42, v38, v39 bitop3:0x7e
    s_waitcnt vmcnt(2)
    v_or_b32 v3, v3, v4
    v_bitop3_b32 v4, s42, v40, v41 bitop3:0x7e
    s_waitcnt vmcnt(0)
    v_mfma_f32_16x16x32_bf16 v[52:55], v[40:43], v[24:27], v[52:55]
    v_bitop3_b32 v56, s42, v42, v43 bitop3:0x7e
    v_or3_b32 v3, v3, v4, v56
    v_and_b32 v3, v0, v3
    v_cmp_ne_u32 vcc, 0, v3
    s_nop 3
    v_cvt_pk_bf16_f32 v56, v52, v53
    v_cvt_pk_bf16_f32 v57, v54, v55
    v_min_u32 v56, -2, v56
    s_cbranch_vccnz mega_kernel_rs_w3_pc
    s_mov_b64 exec, s[26:27]
    buffer_store_dwordx2 v[56:57], v9, s[4:7], s35 offen offset:768 sc1
    buffer_store_dwordx2 v[58:59], v9, s[4:7], s36 offen offset:768 sc1
    s_mov_b64 exec, -1
    s_xor_b32 s42, s42, 1
    s_branch mega_kernel_rs_w3_loop
mega_kernel_rs_w3_last:
    buffer_store_dwordx4 v[64:67], v10, s[4:7], s45 offen offset:192 sc1
    buffer_store_dwordx2 v[18:19], v11, s[4:7], s51 offen offset:3584 sc1
    s_branch mega_kernel_rs_end
mega_kernel_rs_w3_pafail:
    s_nop 7
    v_mov_b32 v96, 0
    v_mov_b32 v97, 0
    v_mov_b32 v98, 0
    v_mov_b32 v99, 0
    v_mov_b32 v100, 0
    v_mov_b32 v101, 0
    v_mov_b32 v102, 0
    v_mov_b32 v103, 0
    v_mov_b32 v104, 0
    v_mov_b32 v105, 0
    v_mov_b32 v106, 0
    v_mov_b32 v107, 0
    s_branch mega_kernel_rs_w3_pa
mega_kernel_rs_w3_xslow:
    buffer_load_dwordx2 v[108:109], v11, s[4:7], s38 offen sc1
    buffer_load_dwordx2 v[110:111], v11, s[4:7], s38 offen offset:512 sc1
    s_waitcnt vmcnt(2)
    v_bitop3_b32 v3, s41, v20, v22 bitop3:0x7e
    v_mfma_f32_16x16x16_bf16 v[80:83], v[20:21], v[16:17], v[100:103]
    v_and_b32 v3, 1, v3
    v_mfma_f32_16x16x16_bf16 v[84:87], v[22:23], v[16:17], v[104:107]
    v_cmp_ne_u32 vcc, 0, v3
    s_cbranch_vccz mega_kernel_rs_w3_xgot
    buffer_load_dwordx2 v[20:21], v11, s[4:7], s38 offen sc1
    buffer_load_dwordx2 v[22:23], v11, s[4:7], s38 offen offset:512 sc1
    s_waitcnt vmcnt(2)
    v_bitop3_b32 v3, s41, v108, v110 bitop3:0x7e
    v_mfma_f32_16x16x16_bf16 v[80:83], v[108:109], v[16:17], v[100:103]
    v_and_b32 v3, 1, v3
    v_mfma_f32_16x16x16_bf16 v[84:87], v[110:111], v[16:17], v[104:107]
    v_cmp_ne_u32 vcc, 0, v3
    s_cbranch_vccz mega_kernel_rs_w3_xgot
    s_branch mega_kernel_rs_w3_xslow
mega_kernel_rs_w3_xgot:
    s_nop 3
    v_cvt_pk_bf16_f32 v64, v80, v81
    v_cvt_pk_bf16_f32 v65, v82, v83
    v_cvt_pk_bf16_f32 v66, v84, v85
    v_cvt_pk_bf16_f32 v67, v86, v87
    ds_write_b128 v6, v[64:67] offset:17408
    s_branch mega_kernel_rs_w3_xok
mega_kernel_rs_w3_pv0:
    s_waitcnt vmcnt(2)
    s_branch mega_kernel_rs_w3_pv1
mega_kernel_rs_w3_pv:
    buffer_load_dwordx2 v[20:21], v11, s[4:7], s40 offen sc1
    s_waitcnt vmcnt(0)
mega_kernel_rs_w3_pv1:
    v_and_b32 v3, 1, v20
    v_cmp_ne_u32 vcc, s41, v3
    v_mov_b32 v113, v20
    v_mov_b32 v115, v21
    s_cbranch_vccnz mega_kernel_rs_w3_pv
    s_branch mega_kernel_rs_w3_pv2
mega_kernel_rs_end:
    s_mov_b64 exec, -1
    v_mov_b32 v3, 64
    s_waitcnt vmcnt(0)
    s_barrier
    s_cmp_lg_u32 s20, 0
    s_cbranch_scc1 mega_kernel_rs_end2
    buffer_store_dword v3, v7, s[4:7], 0 offen sc1
mega_kernel_rs_end2:
    s_waitcnt vmcnt(0)
    s_endpgm
mega_kernel_bulk:
    s_load_dwordx2 s[8:9], s[0:1], 0
    s_load_dwordx2 s[40:41], s[0:1], 16
    s_load_dwordx2 s[42:43], s[0:1], 24
    s_load_dwordx2 s[44:45], s[0:1], 32
    v_lshrrev_b32 v2, 6, v0
    v_and_b32 v1, 63, v0
    v_readfirstlane_b32 s16, v2
    s_lshr_b32 s17, s92, 6
    s_bfe_u32 s18, s92, 0x50001
    s_and_b32 s19, s92, 1
    s_waitcnt lgkmcnt(0)
    s_mov_b32 s10, 4194304
    s_mov_b32 s11, 0x00020000
    s_cmp_eq_u32 s17, 1
    s_cselect_b32 s12, s42, s40
    s_cselect_b32 s13, s43, s41
    s_cmp_eq_u32 s17, 2
    s_cselect_b32 s12, s44, s12
    s_cselect_b32 s13, s45, s13
    s_mov_b32 s14, 8388608
    s_mov_b32 s15, 0x00020000
    v_lshrrev_b32 v2, 4, v1
    v_and_b32 v3, 15, v1
    v_lshlrev_b32 v4, 2, v2
    v_xor_b32 v4, v4, v3
    v_lshlrev_b32 v4, 4, v4
    s_lshl_b32 s20, s16, 5
    v_add_u32 v11, s20, v2
    v_lshl_add_u32 v11, v11, 13, v4
    s_lshl_b32 s20, s18, 8
    v_add_u32 v11, s20, v11
    s_lshl_b32 s22, s16, 13
    s_lshl_b32 s27, s19, 23
    s_and_b32 s27, s27, 4194304
    s_add_u32 m0, s22, 0
    s_xor_b32 s20, s27, 0
    buffer_load_dwordx4 v11, s[12:15], s20 offen lds
    s_add_u32 m0, s22, 1024
    s_xor_b32 s20, s27, 32768
    buffer_load_dwordx4 v11, s[12:15], s20 offen lds
    s_add_u32 m0, s22, 2048
    s_xor_b32 s20, s27, 65536
    buffer_load_dwordx4 v11, s[12:15], s20 offen lds
    s_add_u32 m0, s22, 3072
    s_xor_b32 s20, s27, 98304
    buffer_load_dwordx4 v11, s[12:15], s20 offen lds
    s_add_u32 m0, s22, 4096
    s_xor_b32 s20, s27, 131072
    buffer_load_dwordx4 v11, s[12:15], s20 offen lds
    s_add_u32 m0, s22, 5120
    s_xor_b32 s20, s27, 163840
    buffer_load_dwordx4 v11, s[12:15], s20 offen lds
    s_add_u32 m0, s22, 6144
    s_xor_b32 s20, s27, 196608
    buffer_load_dwordx4 v11, s[12:15], s20 offen lds
    s_add_u32 m0, s22, 7168
    s_xor_b32 s20, s27, 229376
    buffer_load_dwordx4 v11, s[12:15], s20 offen lds
    s_add_u32 m0, s22, 32768
    s_xor_b32 s20, s27, 1048576
    buffer_load_dwordx4 v11, s[12:15], s20 offen lds
    s_add_u32 m0, s22, 33792
    s_xor_b32 s20, s27, 1081344
    buffer_load_dwordx4 v11, s[12:15], s20 offen lds
    s_add_u32 m0, s22, 34816
    s_xor_b32 s20, s27, 1114112
    buffer_load_dwordx4 v11, s[12:15], s20 offen lds
    s_add_u32 m0, s22, 35840
    s_xor_b32 s20, s27, 1146880
    buffer_load_dwordx4 v11, s[12:15], s20 offen lds
    s_add_u32 m0, s22, 36864
    s_xor_b32 s20, s27, 1179648
    buffer_load_dwordx4 v11, s[12:15], s20 offen lds
    s_add_u32 m0, s22, 37888
    s_xor_b32 s20, s27, 1212416
    buffer_load_dwordx4 v11, s[12:15], s20 offen lds
    s_add_u32 m0, s22, 38912
    s_xor_b32 s20, s27, 1245184
    buffer_load_dwordx4 v11, s[12:15], s20 offen lds
    s_add_u32 m0, s22, 39936
    s_xor_b32 s20, s27, 1277952
    buffer_load_dwordx4 v11, s[12:15], s20 offen lds
    s_add_u32 m0, s22, 65536
    s_xor_b32 s20, s27, 2097152
    buffer_load_dwordx4 v11, s[12:15], s20 offen lds
    s_add_u32 m0, s22, 66560
    s_xor_b32 s20, s27, 2129920
    buffer_load_dwordx4 v11, s[12:15], s20 offen lds
    s_add_u32 m0, s22, 67584
    s_xor_b32 s20, s27, 2162688
    buffer_load_dwordx4 v11, s[12:15], s20 offen lds
    s_add_u32 m0, s22, 68608
    s_xor_b32 s20, s27, 2195456
    buffer_load_dwordx4 v11, s[12:15], s20 offen lds
    s_add_u32 m0, s22, 69632
    s_xor_b32 s20, s27, 2228224
    buffer_load_dwordx4 v11, s[12:15], s20 offen lds
    s_add_u32 m0, s22, 70656
    s_xor_b32 s20, s27, 2260992
    buffer_load_dwordx4 v11, s[12:15], s20 offen lds
    s_add_u32 m0, s22, 71680
    s_xor_b32 s20, s27, 2293760
    buffer_load_dwordx4 v11, s[12:15], s20 offen lds
    s_add_u32 m0, s22, 72704
    s_xor_b32 s20, s27, 2326528
    buffer_load_dwordx4 v11, s[12:15], s20 offen lds
    s_add_u32 m0, s22, 98304
    s_xor_b32 s20, s27, 3145728
    buffer_load_dwordx4 v11, s[12:15], s20 offen lds
    s_add_u32 m0, s22, 99328
    s_xor_b32 s20, s27, 3178496
    buffer_load_dwordx4 v11, s[12:15], s20 offen lds
    s_add_u32 m0, s22, 100352
    s_xor_b32 s20, s27, 3211264
    buffer_load_dwordx4 v11, s[12:15], s20 offen lds
    s_add_u32 m0, s22, 101376
    s_xor_b32 s20, s27, 3244032
    buffer_load_dwordx4 v11, s[12:15], s20 offen lds
    s_add_u32 m0, s22, 102400
    s_xor_b32 s20, s27, 3276800
    buffer_load_dwordx4 v11, s[12:15], s20 offen lds
    s_add_u32 m0, s22, 103424
    s_xor_b32 s20, s27, 3309568
    buffer_load_dwordx4 v11, s[12:15], s20 offen lds
    s_add_u32 m0, s22, 104448
    s_xor_b32 s20, s27, 3342336
    buffer_load_dwordx4 v11, s[12:15], s20 offen lds
    s_add_u32 m0, s22, 105472
    s_xor_b32 s20, s27, 3375104
    buffer_load_dwordx4 v11, s[12:15], s20 offen lds
    v_and_b32 v3, 3, v1
    v_bfe_u32 v4, v1, 4, 1
    v_lshl_add_u32 v13, v3, 1, v4
    v_and_b32 v14, 1, v3
    v_lshlrev_b32 v14, 1, v14
    v_lshrrev_b32 v15, 1, v3
    v_add_u32 v14, v14, v15
    v_lshl_add_u32 v14, v4, 2, v14
    s_cmp_eq_u32 s17, 2
    s_cselect_b64 vcc, -1, 0
    v_cndmask_b32 v13, v14, v13, vcc
    v_bfe_u32 v14, v1, 2, 2
    v_xor_b32 v15, s16, v14
    v_lshlrev_b32 v15, 6, v15
    v_lshl_add_u32 v15, v13, 3, v15
    v_lshrrev_b32 v13, 5, v1
    v_lshl_add_u32 v13, v13, 3, v14
    v_lshl_add_u32 v12, v13, 8, v15
    v_and_b32 v3, 15, v1
    s_lshl_b32 s20, s16, 3
    v_add_u32 v13, s20, v2
    v_add_u32 v13, 0, v13
    v_and_b32 v14, 15, v13
    v_xor_b32 v14, v14, v3
    v_lshlrev_b32 v14, 4, v14
    v_lshl_add_u32 v6, v13, 11, v14
    v_add_u32 v13, s20, v2
    v_add_u32 v13, 4, v13
    v_and_b32 v14, 15, v13
    v_xor_b32 v14, v14, v3
    v_lshlrev_b32 v14, 4, v14
    v_lshl_add_u32 v7, v13, 11, v14
    v_and_b32 v13, 31, v1
    v_lshrrev_b32 v14, 5, v1
    v_xor_b32 v14, v14, v3
    v_lshlrev_b32 v14, 4, v14
    v_lshl_add_u32 v13, v13, 8, v14
    v_xor_b32 v16, 0, v13
    v_add_u32 v24, 0x10000, v16
    v_xor_b32 v17, 32, v13
    v_add_u32 v25, 0x10000, v17
    v_xor_b32 v18, 64, v13
    v_add_u32 v26, 0x10000, v18
    v_xor_b32 v19, 96, v13
    v_add_u32 v27, 0x10000, v19
    v_xor_b32 v20, 128, v13
    v_add_u32 v28, 0x10000, v20
    v_xor_b32 v21, 160, v13
    v_add_u32 v29, 0x10000, v21
    v_xor_b32 v22, 192, v13
    v_add_u32 v30, 0x10000, v22
    v_xor_b32 v23, 224, v13
    v_add_u32 v31, 0x10000, v23
    v_bfe_u32 v13, v1, 4, 1
    v_lshlrev_b32 v8, 10, v13
    v_lshrrev_b32 v13, 5, v1
    v_lshl_add_u32 v8, v13, 8, v8
    v_lshl_add_u32 v8, v3, 4, v8
    v_bfrev_b32 v13, 1
    s_lshl_b32 s20, s92, 7
    s_add_u32 s20, s20, 71303168
    v_mov_b32 v14, s20
    v_cmp_eq_u32 vcc, 0, v0
    s_lshl_b32 s24, s17, 24
    s_lshl_b32 s20, s19, 18
    v_cndmask_b32 v9, v13, v14, vcc
    s_add_u32 s24, s24, s20
    s_lshl_b32 s20, s18, 13
    s_add_u32 s24, s24, s20
    s_lshl_b32 s20, s16, 11
    s_add_u32 s24, s24, s20
    s_add_u32 s24, s24, 0
    s_lshl_b32 s23, s19, 16
    s_lshr_b32 s20, s27, 12
    s_add_u32 s23, s23, s20
    v_mov_b32 v10, 0
    s_lshl_b32 s21, s16, 11
    s_waitcnt vmcnt(24)
    s_barrier
    v_add_u32 v13, 0, v12
    ds_read_b64_tr_b16 a[0:1], v13 offset:0
    ds_read_b64_tr_b16 a[2:3], v13 offset:1024
    ds_read_b64_tr_b16 a[4:5], v13 offset:4096
    ds_read_b64_tr_b16 a[6:7], v13 offset:5120
    ds_read_b64_tr_b16 a[8:9], v13 offset:8192
    ds_read_b64_tr_b16 a[10:11], v13 offset:9216
    ds_read_b64_tr_b16 a[12:13], v13 offset:12288
    ds_read_b64_tr_b16 a[14:15], v13 offset:13312
    s_waitcnt lgkmcnt(0)
    ds_read_b64_tr_b16 a[16:17], v13 offset:16384
    ds_read_b64_tr_b16 a[18:19], v13 offset:17408
    ds_read_b64_tr_b16 a[20:21], v13 offset:20480
    ds_read_b64_tr_b16 a[22:23], v13 offset:21504
    ds_read_b64_tr_b16 a[24:25], v13 offset:24576
    ds_read_b64_tr_b16 a[26:27], v13 offset:25600
    ds_read_b64_tr_b16 a[28:29], v13 offset:28672
    ds_read_b64_tr_b16 a[30:31], v13 offset:29696
    s_waitcnt lgkmcnt(0)
    s_barrier
    s_add_u32 m0, s22, 0
    s_xor_b32 s20, s27, 4194304
    buffer_load_dwordx4 v11, s[12:15], s20 offen lds
    s_add_u32 m0, s22, 1024
    s_xor_b32 s20, s27, 4227072
    buffer_load_dwordx4 v11, s[12:15], s20 offen lds
    s_add_u32 m0, s22, 2048
    s_xor_b32 s20, s27, 4259840
    buffer_load_dwordx4 v11, s[12:15], s20 offen lds
    s_add_u32 m0, s22, 3072
    s_xor_b32 s20, s27, 4292608
    buffer_load_dwordx4 v11, s[12:15], s20 offen lds
    s_add_u32 m0, s22, 4096
    s_xor_b32 s20, s27, 4325376
    buffer_load_dwordx4 v11, s[12:15], s20 offen lds
    s_add_u32 m0, s22, 5120
    s_xor_b32 s20, s27, 4358144
    buffer_load_dwordx4 v11, s[12:15], s20 offen lds
    s_add_u32 m0, s22, 6144
    s_xor_b32 s20, s27, 4390912
    buffer_load_dwordx4 v11, s[12:15], s20 offen lds
    s_add_u32 m0, s22, 7168
    s_xor_b32 s20, s27, 4423680
    buffer_load_dwordx4 v11, s[12:15], s20 offen lds
    s_waitcnt vmcnt(24)
    s_barrier
    v_add_u32 v13, 32768, v12
    ds_read_b64_tr_b16 a[32:33], v13 offset:0
    ds_read_b64_tr_b16 a[34:35], v13 offset:1024
    ds_read_b64_tr_b16 a[36:37], v13 offset:4096
    ds_read_b64_tr_b16 a[38:39], v13 offset:5120
    ds_read_b64_tr_b16 a[40:41], v13 offset:8192
    ds_read_b64_tr_b16 a[42:43], v13 offset:9216
    ds_read_b64_tr_b16 a[44:45], v13 offset:12288
    ds_read_b64_tr_b16 a[46:47], v13 offset:13312
    s_waitcnt lgkmcnt(0)
    ds_read_b64_tr_b16 a[48:49], v13 offset:16384
    ds_read_b64_tr_b16 a[50:51], v13 offset:17408
    ds_read_b64_tr_b16 a[52:53], v13 offset:20480
    ds_read_b64_tr_b16 a[54:55], v13 offset:21504
    ds_read_b64_tr_b16 a[56:57], v13 offset:24576
    ds_read_b64_tr_b16 a[58:59], v13 offset:25600
    ds_read_b64_tr_b16 a[60:61], v13 offset:28672
    ds_read_b64_tr_b16 a[62:63], v13 offset:29696
    s_waitcnt lgkmcnt(0)
    s_barrier
    s_add_u32 m0, s22, 32768
    s_xor_b32 s20, s27, 5242880
    buffer_load_dwordx4 v11, s[12:15], s20 offen lds
    s_add_u32 m0, s22, 33792
    s_xor_b32 s20, s27, 5275648
    buffer_load_dwordx4 v11, s[12:15], s20 offen lds
    s_add_u32 m0, s22, 34816
    s_xor_b32 s20, s27, 5308416
    buffer_load_dwordx4 v11, s[12:15], s20 offen lds
    s_add_u32 m0, s22, 35840
    s_xor_b32 s20, s27, 5341184
    buffer_load_dwordx4 v11, s[12:15], s20 offen lds
    s_add_u32 m0, s22, 36864
    s_xor_b32 s20, s27, 5373952
    buffer_load_dwordx4 v11, s[12:15], s20 offen lds
    s_add_u32 m0, s22, 37888
    s_xor_b32 s20, s27, 5406720
    buffer_load_dwordx4 v11, s[12:15], s20 offen lds
    s_add_u32 m0, s22, 38912
    s_xor_b32 s20, s27, 5439488
    buffer_load_dwordx4 v11, s[12:15], s20 offen lds
    s_add_u32 m0, s22, 39936
    s_xor_b32 s20, s27, 5472256
    buffer_load_dwordx4 v11, s[12:15], s20 offen lds
    s_waitcnt vmcnt(24)
    s_barrier
    v_add_u32 v13, 65536, v12
    ds_read_b64_tr_b16 a[64:65], v13 offset:0
    ds_read_b64_tr_b16 a[66:67], v13 offset:1024
    ds_read_b64_tr_b16 a[68:69], v13 offset:4096
    ds_read_b64_tr_b16 a[70:71], v13 offset:5120
    ds_read_b64_tr_b16 a[72:73], v13 offset:8192
    ds_read_b64_tr_b16 a[74:75], v13 offset:9216
    ds_read_b64_tr_b16 a[76:77], v13 offset:12288
    ds_read_b64_tr_b16 a[78:79], v13 offset:13312
    s_waitcnt lgkmcnt(0)
    ds_read_b64_tr_b16 a[80:81], v13 offset:16384
    ds_read_b64_tr_b16 a[82:83], v13 offset:17408
    ds_read_b64_tr_b16 a[84:85], v13 offset:20480
    ds_read_b64_tr_b16 a[86:87], v13 offset:21504
    ds_read_b64_tr_b16 a[88:89], v13 offset:24576
    ds_read_b64_tr_b16 a[90:91], v13 offset:25600
    ds_read_b64_tr_b16 a[92:93], v13 offset:28672
    ds_read_b64_tr_b16 a[94:95], v13 offset:29696
    s_waitcnt lgkmcnt(0)
    s_barrier
    s_add_u32 m0, s22, 65536
    s_xor_b32 s20, s27, 6291456
    buffer_load_dwordx4 v11, s[12:15], s20 offen lds
    s_add_u32 m0, s22, 66560
    s_xor_b32 s20, s27, 6324224
    buffer_load_dwordx4 v11, s[12:15], s20 offen lds
    s_add_u32 m0, s22, 67584
    s_xor_b32 s20, s27, 6356992
    buffer_load_dwordx4 v11, s[12:15], s20 offen lds
    s_add_u32 m0, s22, 68608
    s_xor_b32 s20, s27, 6389760
    buffer_load_dwordx4 v11, s[12:15], s20 offen lds
    s_add_u32 m0, s22, 69632
    s_xor_b32 s20, s27, 6422528
    buffer_load_dwordx4 v11, s[12:15], s20 offen lds
    s_add_u32 m0, s22, 70656
    s_xor_b32 s20, s27, 6455296
    buffer_load_dwordx4 v11, s[12:15], s20 offen lds
    s_add_u32 m0, s22, 71680
    s_xor_b32 s20, s27, 6488064
    buffer_load_dwordx4 v11, s[12:15], s20 offen lds
    s_add_u32 m0, s22, 72704
    s_xor_b32 s20, s27, 6520832
    buffer_load_dwordx4 v11, s[12:15], s20 offen lds
    s_waitcnt vmcnt(24)
    s_barrier
    v_and_b32 v254, 7, v0
    v_lshlrev_b32 v254, 5, v254
    buffer_load_dword v252, v254, s[88:91], 0 offen sc1
    v_add_u32 v13, 98304, v12
    ds_read_b64_tr_b16 a[96:97], v13 offset:0
    ds_read_b64_tr_b16 a[98:99], v13 offset:1024
    ds_read_b64_tr_b16 a[100:101], v13 offset:4096
    ds_read_b64_tr_b16 a[102:103], v13 offset:5120
    ds_read_b64_tr_b16 a[104:105], v13 offset:8192
    ds_read_b64_tr_b16 a[106:107], v13 offset:9216
    ds_read_b64_tr_b16 a[108:109], v13 offset:12288
    ds_read_b64_tr_b16 a[110:111], v13 offset:13312
    s_waitcnt lgkmcnt(0)
    ds_read_b64_tr_b16 a[112:113], v13 offset:16384
    ds_read_b64_tr_b16 a[114:115], v13 offset:17408
    ds_read_b64_tr_b16 a[116:117], v13 offset:20480
    ds_read_b64_tr_b16 a[118:119], v13 offset:21504
    ds_read_b64_tr_b16 a[120:121], v13 offset:24576
    ds_read_b64_tr_b16 a[122:123], v13 offset:25600
    ds_read_b64_tr_b16 a[124:125], v13 offset:28672
    ds_read_b64_tr_b16 a[126:127], v13 offset:29696
    s_waitcnt lgkmcnt(0)
    s_barrier
    s_add_u32 m0, s22, 98304
    s_xor_b32 s20, s27, 7340032
    buffer_load_dwordx4 v11, s[12:15], s20 offen lds
    s_add_u32 m0, s22, 99328
    s_xor_b32 s20, s27, 7372800
    buffer_load_dwordx4 v11, s[12:15], s20 offen lds
    s_add_u32 m0, s22, 100352
    s_xor_b32 s20, s27, 7405568
    buffer_load_dwordx4 v11, s[12:15], s20 offen lds
    s_add_u32 m0, s22, 101376
    s_xor_b32 s20, s27, 7438336
    buffer_load_dwordx4 v11, s[12:15], s20 offen lds
    s_add_u32 m0, s22, 102400
    s_xor_b32 s20, s27, 7471104
    buffer_load_dwordx4 v11, s[12:15], s20 offen lds
    s_add_u32 m0, s22, 103424
    s_xor_b32 s20, s27, 7503872
    buffer_load_dwordx4 v11, s[12:15], s20 offen lds
    s_add_u32 m0, s22, 104448
    s_xor_b32 s20, s27, 7536640
    buffer_load_dwordx4 v11, s[12:15], s20 offen lds
    s_add_u32 m0, s22, 105472
    s_xor_b32 s20, s27, 7569408
    buffer_load_dwordx4 v11, s[12:15], s20 offen lds
    s_waitcnt vmcnt(24)
    s_barrier
    v_add_u32 v13, 0, v12
    ds_read_b64_tr_b16 a[128:129], v13 offset:0
    ds_read_b64_tr_b16 a[130:131], v13 offset:1024
    ds_read_b64_tr_b16 a[132:133], v13 offset:4096
    ds_read_b64_tr_b16 a[134:135], v13 offset:5120
    ds_read_b64_tr_b16 a[136:137], v13 offset:8192
    ds_read_b64_tr_b16 a[138:139], v13 offset:9216
    ds_read_b64_tr_b16 a[140:141], v13 offset:12288
    ds_read_b64_tr_b16 a[142:143], v13 offset:13312
    s_waitcnt lgkmcnt(0)
    ds_read_b64_tr_b16 a[144:145], v13 offset:16384
    ds_read_b64_tr_b16 a[146:147], v13 offset:17408
    ds_read_b64_tr_b16 a[148:149], v13 offset:20480
    ds_read_b64_tr_b16 a[150:151], v13 offset:21504
    ds_read_b64_tr_b16 a[152:153], v13 offset:24576
    ds_read_b64_tr_b16 a[154:155], v13 offset:25600
    ds_read_b64_tr_b16 a[156:157], v13 offset:28672
    ds_read_b64_tr_b16 a[158:159], v13 offset:29696
    s_waitcnt lgkmcnt(0)
    s_barrier
    s_add_u32 m0, s21, 0
    s_xor_b32 s20, s23, 0
    buffer_load_dwordx4 v6, s[8:11], s20 offen lds
    s_add_u32 m0, s21, 1024
    s_xor_b32 s20, s23, 0
    buffer_load_dwordx4 v7, s[8:11], s20 offen lds
    s_add_u32 m0, s21, 8192
    s_xor_b32 s20, s23, 256
    buffer_load_dwordx4 v6, s[8:11], s20 offen lds
    s_add_u32 m0, s21, 9216
    s_xor_b32 s20, s23, 256
    buffer_load_dwordx4 v7, s[8:11], s20 offen lds
    s_add_u32 m0, s21, 16384
    s_xor_b32 s20, s23, 512
    buffer_load_dwordx4 v6, s[8:11], s20 offen lds
    s_add_u32 m0, s21, 17408
    s_xor_b32 s20, s23, 512
    buffer_load_dwordx4 v7, s[8:11], s20 offen lds
    s_add_u32 m0, s21, 24576
    s_xor_b32 s20, s23, 768
    buffer_load_dwordx4 v6, s[8:11], s20 offen lds
    s_add_u32 m0, s21, 25600
    s_xor_b32 s20, s23, 768
    buffer_load_dwordx4 v7, s[8:11], s20 offen lds
    s_waitcnt vmcnt(24)
    s_barrier
    v_add_u32 v13, 32768, v12
    ds_read_b64_tr_b16 a[160:161], v13 offset:0
    ds_read_b64_tr_b16 a[162:163], v13 offset:1024
    ds_read_b64_tr_b16 a[164:165], v13 offset:4096
    ds_read_b64_tr_b16 a[166:167], v13 offset:5120
    ds_read_b64_tr_b16 a[168:169], v13 offset:8192
    ds_read_b64_tr_b16 a[170:171], v13 offset:9216
    ds_read_b64_tr_b16 a[172:173], v13 offset:12288
    ds_read_b64_tr_b16 a[174:175], v13 offset:13312
    s_waitcnt lgkmcnt(0)
    ds_read_b64_tr_b16 a[176:177], v13 offset:16384
    ds_read_b64_tr_b16 a[178:179], v13 offset:17408
    ds_read_b64_tr_b16 a[180:181], v13 offset:20480
    ds_read_b64_tr_b16 a[182:183], v13 offset:21504
    ds_read_b64_tr_b16 a[184:185], v13 offset:24576
    ds_read_b64_tr_b16 a[186:187], v13 offset:25600
    ds_read_b64_tr_b16 a[188:189], v13 offset:28672
    ds_read_b64_tr_b16 a[190:191], v13 offset:29696
    s_waitcnt lgkmcnt(0)
    s_barrier
    s_add_u32 m0, s21, 32768
    s_xor_b32 s20, s23, 1024
    buffer_load_dwordx4 v6, s[8:11], s20 offen lds
    s_add_u32 m0, s21, 33792
    s_xor_b32 s20, s23, 1024
    buffer_load_dwordx4 v7, s[8:11], s20 offen lds
    s_add_u32 m0, s21, 40960
    s_xor_b32 s20, s23, 1280
    buffer_load_dwordx4 v6, s[8:11], s20 offen lds
    s_add_u32 m0, s21, 41984
    s_xor_b32 s20, s23, 1280
    buffer_load_dwordx4 v7, s[8:11], s20 offen lds
    s_add_u32 m0, s21, 49152
    s_xor_b32 s20, s23, 1536
    buffer_load_dwordx4 v6, s[8:11], s20 offen lds
    s_add_u32 m0, s21, 50176
    s_xor_b32 s20, s23, 1536
    buffer_load_dwordx4 v7, s[8:11], s20 offen lds
    s_add_u32 m0, s21, 57344
    s_xor_b32 s20, s23, 1792
    buffer_load_dwordx4 v6, s[8:11], s20 offen lds
    s_add_u32 m0, s21, 58368
    s_xor_b32 s20, s23, 1792
    buffer_load_dwordx4 v7, s[8:11], s20 offen lds
    s_waitcnt vmcnt(24)
    s_barrier
    v_add_u32 v13, 65536, v12
    ds_read_b64_tr_b16 a[192:193], v13 offset:0
    ds_read_b64_tr_b16 a[194:195], v13 offset:1024
    ds_read_b64_tr_b16 a[196:197], v13 offset:4096
    ds_read_b64_tr_b16 a[198:199], v13 offset:5120
    ds_read_b64_tr_b16 a[200:201], v13 offset:8192
    ds_read_b64_tr_b16 a[202:203], v13 offset:9216
    ds_read_b64_tr_b16 a[204:205], v13 offset:12288
    ds_read_b64_tr_b16 a[206:207], v13 offset:13312
    s_waitcnt lgkmcnt(0)
    ds_read_b64_tr_b16 a[208:209], v13 offset:16384
    ds_read_b64_tr_b16 a[210:211], v13 offset:17408
    ds_read_b64_tr_b16 a[212:213], v13 offset:20480
    ds_read_b64_tr_b16 a[214:215], v13 offset:21504
    ds_read_b64_tr_b16 a[216:217], v13 offset:24576
    ds_read_b64_tr_b16 a[218:219], v13 offset:25600
    ds_read_b64_tr_b16 a[220:221], v13 offset:28672
    ds_read_b64_tr_b16 a[222:223], v13 offset:29696
    s_waitcnt lgkmcnt(0)
    s_barrier
    s_add_u32 s23, s23, 131072
    s_add_u32 m0, s21, 65536
    s_xor_b32 s20, s23, 0
    buffer_load_dwordx4 v6, s[8:11], s20 offen lds
    s_add_u32 m0, s21, 66560
    s_xor_b32 s20, s23, 0
    buffer_load_dwordx4 v7, s[8:11], s20 offen lds
    s_add_u32 m0, s21, 73728
    s_xor_b32 s20, s23, 256
    buffer_load_dwordx4 v6, s[8:11], s20 offen lds
    s_add_u32 m0, s21, 74752
    s_xor_b32 s20, s23, 256
    buffer_load_dwordx4 v7, s[8:11], s20 offen lds
    s_add_u32 m0, s21, 81920
    s_xor_b32 s20, s23, 512
    buffer_load_dwordx4 v6, s[8:11], s20 offen lds
    s_add_u32 m0, s21, 82944
    s_xor_b32 s20, s23, 512
    buffer_load_dwordx4 v7, s[8:11], s20 offen lds
    s_add_u32 m0, s21, 90112
    s_xor_b32 s20, s23, 768
    buffer_load_dwordx4 v6, s[8:11], s20 offen lds
    s_add_u32 m0, s21, 91136
    s_xor_b32 s20, s23, 768
    buffer_load_dwordx4 v7, s[8:11], s20 offen lds
    s_waitcnt vmcnt(24)
    s_barrier
    s_cmp_lg_u32 s97, 0
    s_cbranch_scc1 mega_kernel_h2_2_ok
mega_kernel_h2_2_ev:
    v_cmp_ne_u32 vcc, 32, v252
    s_cbranch_vccz mega_kernel_h2_2_ok
    s_mov_b32 s78, 0
    v_readlane_b32 s81, v252, 0
    s_nop 3
    s_add_u32 s78, s78, s81
    v_readlane_b32 s81, v252, 1
    s_nop 3
    s_add_u32 s78, s78, s81
    v_readlane_b32 s81, v252, 2
    s_nop 3
    s_add_u32 s78, s78, s81
    v_readlane_b32 s81, v252, 3
    s_nop 3
    s_add_u32 s78, s78, s81
    v_readlane_b32 s81, v252, 4
    s_nop 3
    s_add_u32 s78, s78, s81
    v_readlane_b32 s81, v252, 5
    s_nop 3
    s_add_u32 s78, s78, s81
    v_readlane_b32 s81, v252, 6
    s_nop 3
    s_add_u32 s78, s78, s81
    v_readlane_b32 s81, v252, 7
    s_nop 3
    s_add_u32 s78, s78, s81
    s_cmp_eq_u32 s78, 256
    s_cbranch_scc1 mega_kernel_redo
    buffer_load_dword v252, v254, s[88:91], 0 offen sc1
    s_waitcnt vmcnt(0)
    s_branch mega_kernel_h2_2_ev
mega_kernel_h2_2_ok:
    v_add_u32 v13, 98304, v12
    ds_read_b64_tr_b16 a[224:225], v13 offset:0
    ds_read_b64_tr_b16 a[226:227], v13 offset:1024
    ds_read_b64_tr_b16 a[228:229], v13 offset:4096
    ds_read_b64_tr_b16 a[230:231], v13 offset:5120
    ds_read_b64_tr_b16 a[232:233], v13 offset:8192
    ds_read_b64_tr_b16 a[234:235], v13 offset:9216
    ds_read_b64_tr_b16 a[236:237], v13 offset:12288
    ds_read_b64_tr_b16 a[238:239], v13 offset:13312
    s_waitcnt lgkmcnt(0)
    ds_read_b64_tr_b16 a[240:241], v13 offset:16384
    ds_read_b64_tr_b16 a[242:243], v13 offset:17408
    ds_read_b64_tr_b16 a[244:245], v13 offset:20480
    ds_read_b64_tr_b16 a[246:247], v13 offset:21504
    ds_read_b64_tr_b16 a[248:249], v13 offset:24576
    ds_read_b64_tr_b16 a[250:251], v13 offset:25600
    ds_read_b64_tr_b16 a[252:253], v13 offset:28672
    ds_read_b64_tr_b16 a[254:255], v13 offset:29696
    s_waitcnt lgkmcnt(0)
    s_barrier
    s_waitcnt vmcnt(16)
    s_barrier
    s_cmp_eq_u32 s17, 2
    s_cbranch_scc1 mega_kernel_q_v
    ds_read_b128 v[32:35], v16 offset:0
    ds_read_b128 v[36:39], v17 offset:0
    ds_read_b128 v[40:43], v18 offset:0
    ds_read_b128 v[44:47], v19 offset:0
    ds_read_b128 v[48:51], v20 offset:0
    ds_read_b128 v[52:55], v21 offset:0
    s_mov_b32 s25, 0
mega_kernel_q_qk_loop:
    s_waitcnt lgkmcnt(5)
    v_mfma_f32_32x32x16_bf16 v[64:79], a[0:3], v[32:35], 0
    ds_read_b128 v[56:59], v22 offset:0
    s_waitcnt lgkmcnt(5)
    v_mfma_f32_32x32x16_bf16 v[64:79], a[4:7], v[36:39], v[64:79]
    ds_read_b128 v[60:63], v23 offset:0
    s_waitcnt lgkmcnt(5)
    v_mfma_f32_32x32x16_bf16 v[64:79], a[8:11], v[40:43], v[64:79]
    ds_read_b128 v[32:35], v16 offset:8192
    s_cmp_eq_u32 s25, 0
    s_cbranch_scc1 mega_kernel_q_qk_sk2
    s_add_u32 m0, s21, 74752
    s_xor_b32 s20, s23, 256
    buffer_load_dwordx4 v7, s[8:11], s20 offen lds
mega_kernel_q_qk_sk2:
    s_waitcnt lgkmcnt(5)
    v_mfma_f32_32x32x16_bf16 v[64:79], a[12:15], v[44:47], v[64:79]
    ds_read_b128 v[36:39], v17 offset:8192
    s_waitcnt lgkmcnt(5)
    v_mfma_f32_32x32x16_bf16 v[64:79], a[16:19], v[48:51], v[64:79]
    ds_read_b128 v[40:43], v18 offset:8192
    s_waitcnt lgkmcnt(5)
    v_mfma_f32_32x32x16_bf16 v[64:79], a[20:23], v[52:55], v[64:79]
    ds_read_b128 v[44:47], v19 offset:8192
    s_cmp_eq_u32 s25, 0
    s_cbranch_scc1 mega_kernel_q_qk_sk5
    s_add_u32 m0, s21, 81920
    s_xor_b32 s20, s23, 512
    buffer_load_dwordx4 v6, s[8:11], s20 offen lds
mega_kernel_q_qk_sk5:
    s_waitcnt lgkmcnt(5)
    v_mfma_f32_32x32x16_bf16 v[64:79], a[24:27], v[56:59], v[64:79]
    ds_read_b128 v[48:51], v20 offset:8192
    s_waitcnt lgkmcnt(5)
    v_mfma_f32_32x32x16_bf16 v[64:79], a[28:31], v[60:63], v[64:79]
    ds_read_b128 v[52:55], v21 offset:8192
    s_waitcnt lgkmcnt(5)
    v_mfma_f32_32x32x16_bf16 v[64:79], a[32:35], v[32:35], v[64:79]
    ds_read_b128 v[56:59], v22 offset:8192
    s_cmp_eq_u32 s25, 0
    s_cbranch_scc1 mega_kernel_q_qk_sk8
    s_add_u32 m0, s21, 82944
    s_xor_b32 s20, s23, 512
    buffer_load_dwordx4 v7, s[8:11], s20 offen lds
mega_kernel_q_qk_sk8:
    s_waitcnt lgkmcnt(5)
    v_mfma_f32_32x32x16_bf16 v[64:79], a[36:39], v[36:39], v[64:79]
    ds_read_b128 v[60:63], v23 offset:8192
    s_waitcnt lgkmcnt(5)
    v_mfma_f32_32x32x16_bf16 v[64:79], a[40:43], v[40:43], v[64:79]
    ds_read_b128 v[32:35], v16 offset:16384
    s_waitcnt lgkmcnt(5)
    v_mfma_f32_32x32x16_bf16 v[64:79], a[44:47], v[44:47], v[64:79]
    ds_read_b128 v[36:39], v17 offset:16384
    s_cmp_eq_u32 s25, 0
    s_cbranch_scc1 mega_kernel_q_qk_sk11
    s_add_u32 m0, s21, 90112
    s_xor_b32 s20, s23, 768
    buffer_load_dwordx4 v6, s[8:11], s20 offen lds
mega_kernel_q_qk_sk11:
    s_waitcnt lgkmcnt(5)
    v_mfma_f32_32x32x16_bf16 v[64:79], a[48:51], v[48:51], v[64:79]
    ds_read_b128 v[40:43], v18 offset:16384
    s_waitcnt lgkmcnt(5)
    v_mfma_f32_32x32x16_bf16 v[64:79], a[52:55], v[52:55], v[64:79]
    ds_read_b128 v[44:47], v19 offset:16384
    s_waitcnt lgkmcnt(5)
    v_mfma_f32_32x32x16_bf16 v[64:79], a[56:59], v[56:59], v[64:79]
    ds_read_b128 v[48:51], v20 offset:16384
    s_cmp_eq_u32 s25, 0
    s_cbranch_scc1 mega_kernel_q_qk_sk14
    s_add_u32 m0, s21, 91136
    s_xor_b32 s20, s23, 768
    buffer_load_dwordx4 v7, s[8:11], s20 offen lds
mega_kernel_q_qk_sk14:
    s_waitcnt lgkmcnt(5)
    v_mfma_f32_32x32x16_bf16 v[64:79], a[60:63], v[60:63], v[64:79]
    ds_read_b128 v[52:55], v21 offset:16384
    s_waitcnt lgkmcnt(5)
    v_mfma_f32_32x32x16_bf16 v[64:79], a[64:67], v[32:35], v[64:79]
    ds_read_b128 v[56:59], v22 offset:16384
    s_cmp_eq_u32 s25, 0
    s_cbranch_scc1 mega_kernel_q_qk_ne0
    v_cvt_pk_bf16_f32 v96, v80, v81
    v_cvt_pk_bf16_f32 v97, v82, v83
    v_cvt_pk_bf16_f32 v98, v84, v85
    v_cvt_pk_bf16_f32 v99, v86, v87
    buffer_store_dwordx4 v[96:99], v8, s[84:87], s24 offen offset:0 sc1
mega_kernel_q_qk_ne0:
    s_waitcnt lgkmcnt(5)
    v_mfma_f32_32x32x16_bf16 v[64:79], a[68:71], v[36:39], v[64:79]
    ds_read_b128 v[60:63], v23 offset:16384
    s_waitcnt lgkmcnt(5)
    v_mfma_f32_32x32x16_bf16 v[64:79], a[72:75], v[40:43], v[64:79]
    ds_read_b128 v[32:35], v16 offset:24576
    s_cmp_eq_u32 s25, 0
    s_cbranch_scc1 mega_kernel_q_qk_ne1
    v_cvt_pk_bf16_f32 v100, v88, v89
    v_cvt_pk_bf16_f32 v101, v90, v91
    v_cvt_pk_bf16_f32 v102, v92, v93
    v_cvt_pk_bf16_f32 v103, v94, v95
    buffer_store_dwordx4 v[100:103], v8, s[84:87], s24 offen offset:512 sc1
    s_add_u32 s24, s24, 524288
mega_kernel_q_qk_ne1:
    s_waitcnt lgkmcnt(5)
    v_mfma_f32_32x32x16_bf16 v[64:79], a[76:79], v[44:47], v[64:79]
    ds_read_b128 v[36:39], v17 offset:24576
    s_waitcnt lgkmcnt(5)
    v_mfma_f32_32x32x16_bf16 v[64:79], a[80:83], v[48:51], v[64:79]
    ds_read_b128 v[40:43], v18 offset:24576
    s_waitcnt lgkmcnt(5)
    v_mfma_f32_32x32x16_bf16 v[64:79], a[84:87], v[52:55], v[64:79]
    ds_read_b128 v[44:47], v19 offset:24576
    s_waitcnt lgkmcnt(5)
    v_mfma_f32_32x32x16_bf16 v[64:79], a[88:91], v[56:59], v[64:79]
    ds_read_b128 v[48:51], v20 offset:24576
    s_waitcnt lgkmcnt(5)
    v_mfma_f32_32x32x16_bf16 v[64:79], a[92:95], v[60:63], v[64:79]
    ds_read_b128 v[52:55], v21 offset:24576
    s_waitcnt vmcnt(8)
    s_barrier
    s_waitcnt lgkmcnt(5)
    v_mfma_f32_32x32x16_bf16 v[64:79], a[96:99], v[32:35], v[64:79]
    ds_read_b128 v[56:59], v22 offset:24576
    s_waitcnt lgkmcnt(5)
    v_mfma_f32_32x32x16_bf16 v[64:79], a[100:103], v[36:39], v[64:79]
    ds_read_b128 v[60:63], v23 offset:24576
    s_add_u32 m0, s21, 98304
    s_xor_b32 s20, s23, 1024
    buffer_load_dwordx4 v6, s[8:11], s20 offen lds
    s_waitcnt lgkmcnt(5)
    v_mfma_f32_32x32x16_bf16 v[64:79], a[104:107], v[40:43], v[64:79]
    ds_read_b128 v[32:35], v16 offset:32768
    s_waitcnt lgkmcnt(5)
    v_mfma_f32_32x32x16_bf16 v[64:79], a[108:111], v[44:47], v[64:79]
    ds_read_b128 v[36:39], v17 offset:32768
    s_waitcnt lgkmcnt(5)
    v_mfma_f32_32x32x16_bf16 v[64:79], a[112:115], v[48:51], v[64:79]
    ds_read_b128 v[40:43], v18 offset:32768
    s_add_u32 m0, s21, 99328
    s_xor_b32 s20, s23, 1024
    buffer_load_dwordx4 v7, s[8:11], s20 offen lds
    s_waitcnt lgkmcnt(5)
    v_mfma_f32_32x32x16_bf16 v[64:79], a[116:119], v[52:55], v[64:79]
    ds_read_b128 v[44:47], v19 offset:32768
    s_waitcnt lgkmcnt(5)
    v_mfma_f32_32x32x16_bf16 v[64:79], a[120:123], v[56:59], v[64:79]
    ds_read_b128 v[48:51], v20 offset:32768
    s_waitcnt lgkmcnt(5)
    v_mfma_f32_32x32x16_bf16 v[64:79], a[124:127], v[60:63], v[64:79]
    ds_read_b128 v[52:55], v21 offset:32768
    s_add_u32 m0, s21, 106496
    s_xor_b32 s20, s23, 1280
    buffer_load_dwordx4 v6, s[8:11], s20 offen lds
    s_waitcnt lgkmcnt(5)
    v_mfma_f32_32x32x16_bf16 v[64:79], a[128:131], v[32:35], v[64:79]
    ds_read_b128 v[56:59], v22 offset:32768
    s_waitcnt lgkmcnt(5)
    v_mfma_f32_32x32x16_bf16 v[64:79], a[132:135], v[36:39], v[64:79]
    ds_read_b128 v[60:63], v23 offset:32768
    s_waitcnt lgkmcnt(5)
    v_mfma_f32_32x32x16_bf16 v[64:79], a[136:139], v[40:43], v[64:79]
    ds_read_b128 v[32:35], v16 offset:40960
    s_add_u32 m0, s21, 107520
    s_xor_b32 s20, s23, 1280
    buffer_load_dwordx4 v7, s[8:11], s20 offen lds
    s_waitcnt lgkmcnt(5)
    v_mfma_f32_32x32x16_bf16 v[64:79], a[140:143], v[44:47], v[64:79]
    ds_read_b128 v[36:39], v17 offset:40960
    s_waitcnt lgkmcnt(5)
    v_mfma_f32_32x32x16_bf16 v[64:79], a[144:147], v[48:51], v[64:79]
    ds_read_b128 v[40:43], v18 offset:40960
    s_waitcnt lgkmcnt(5)
    v_mfma_f32_32x32x16_bf16 v[64:79], a[148:151], v[52:55], v[64:79]
    ds_read_b128 v[44:47], v19 offset:40960
    s_add_u32 m0, s21, 114688
    s_xor_b32 s20, s23, 1536
    buffer_load_dwordx4 v6, s[8:11], s20 offen lds
    s_waitcnt lgkmcnt(5)
    v_mfma_f32_32x32x16_bf16 v[64:79], a[152:155], v[56:59], v[64:79]
    ds_read_b128 v[48:51], v20 offset:40960
    s_waitcnt lgkmcnt(5)
    v_mfma_f32_32x32x16_bf16 v[64:79], a[156:159], v[60:63], v[64:79]
    ds_read_b128 v[52:55], v21 offset:40960
    s_waitcnt lgkmcnt(5)
    v_mfma_f32_32x32x16_bf16 v[64:79], a[160:163], v[32:35], v[64:79]
    ds_read_b128 v[56:59], v22 offset:40960
    s_add_u32 m0, s21, 115712
    s_xor_b32 s20, s23, 1536
    buffer_load_dwordx4 v7, s[8:11], s20 offen lds
    s_waitcnt lgkmcnt(5)
    v_mfma_f32_32x32x16_bf16 v[64:79], a[164:167], v[36:39], v[64:79]
    ds_read_b128 v[60:63], v23 offset:40960
    s_waitcnt lgkmcnt(5)
    v_mfma_f32_32x32x16_bf16 v[64:79], a[168:171], v[40:43], v[64:79]
    ds_read_b128 v[32:35], v16 offset:49152
    s_waitcnt lgkmcnt(5)
    v_mfma_f32_32x32x16_bf16 v[64:79], a[172:175], v[44:47], v[64:79]
    ds_read_b128 v[36:39], v17 offset:49152
    s_add_u32 m0, s21, 122880
    s_xor_b32 s20, s23, 1792
    buffer_load_dwordx4 v6, s[8:11], s20 offen lds
    s_waitcnt lgkmcnt(5)
    v_mfma_f32_32x32x16_bf16 v[64:79], a[176:179], v[48:51], v[64:79]
    ds_read_b128 v[40:43], v18 offset:49152
    s_waitcnt lgkmcnt(5)
    v_mfma_f32_32x32x16_bf16 v[64:79], a[180:183], v[52:55], v[64:79]
    ds_read_b128 v[44:47], v19 offset:49152
    s_waitcnt lgkmcnt(5)
    v_mfma_f32_32x32x16_bf16 v[64:79], a[184:187], v[56:59], v[64:79]
    ds_read_b128 v[48:51], v20 offset:49152
    s_add_u32 m0, s21, 123904
    s_xor_b32 s20, s23, 1792
    buffer_load_dwordx4 v7, s[8:11], s20 offen lds
    s_waitcnt lgkmcnt(5)
    v_mfma_f32_32x32x16_bf16 v[64:79], a[188:191], v[60:63], v[64:79]
    ds_read_b128 v[52:55], v21 offset:49152
    s_waitcnt lgkmcnt(5)
    v_mfma_f32_32x32x16_bf16 v[64:79], a[192:195], v[32:35], v[64:79]
    ds_read_b128 v[56:59], v22 offset:49152
    s_waitcnt lgkmcnt(5)
    v_mfma_f32_32x32x16_bf16 v[64:79], a[196:199], v[36:39], v[64:79]
    ds_read_b128 v[60:63], v23 offset:49152
    s_waitcnt lgkmcnt(5)
    v_mfma_f32_32x32x16_bf16 v[64:79], a[200:203], v[40:43], v[64:79]
    ds_read_b128 v[32:35], v16 offset:57344
    s_waitcnt lgkmcnt(5)
    v_mfma_f32_32x32x16_bf16 v[64:79], a[204:207], v[44:47], v[64:79]
    ds_read_b128 v[36:39], v17 offset:57344
    s_waitcnt lgkmcnt(5)
    v_mfma_f32_32x32x16_bf16 v[64:79], a[208:211], v[48:51], v[64:79]
    ds_read_b128 v[40:43], v18 offset:57344
    s_waitcnt lgkmcnt(5)
    v_mfma_f32_32x32x16_bf16 v[64:79], a[212:215], v[52:55], v[64:79]
    ds_read_b128 v[44:47], v19 offset:57344
    s_waitcnt lgkmcnt(5)
    v_mfma_f32_32x32x16_bf16 v[64:79], a[216:219], v[56:59], v[64:79]
    ds_read_b128 v[48:51], v20 offset:57344
    s_waitcnt lgkmcnt(5)
    v_mfma_f32_32x32x16_bf16 v[64:79], a[220:223], v[60:63], v[64:79]
    ds_read_b128 v[52:55], v21 offset:57344
    s_waitcnt vmcnt(8)
    s_barrier
    s_waitcnt lgkmcnt(5)
    v_mfma_f32_32x32x16_bf16 v[64:79], a[224:227], v[32:35], v[64:79]
    ds_read_b128 v[56:59], v22 offset:57344
    s_waitcnt lgkmcnt(5)
    v_mfma_f32_32x32x16_bf16 v[64:79], a[228:231], v[36:39], v[64:79]
    ds_read_b128 v[60:63], v23 offset:57344
    s_add_u32 s23, s23, 131072
    s_add_u32 m0, s21, 0
    s_xor_b32 s20, s23, 0
    buffer_load_dwordx4 v6, s[8:11], s20 offen lds
    s_waitcnt lgkmcnt(5)
    v_mfma_f32_32x32x16_bf16 v[64:79], a[232:235], v[40:43], v[64:79]
    ds_read_b128 v[32:35], v24 offset:0
    s_cmp_eq_u32 s25, 0
    s_cbranch_scc1 mega_kernel_q_qk_nf
    v_add_u32 v10, 1, v10
    buffer_store_dword v10, v9, s[84:87], 0 offen sc1
mega_kernel_q_qk_nf:
    s_waitcnt lgkmcnt(5)
    v_mfma_f32_32x32x16_bf16 v[64:79], a[236:239], v[44:47], v[64:79]
    ds_read_b128 v[36:39], v25 offset:0
    s_waitcnt lgkmcnt(5)
    v_mfma_f32_32x32x16_bf16 v[64:79], a[240:243], v[48:51], v[64:79]
    ds_read_b128 v[40:43], v26 offset:0
    s_add_u32 m0, s21, 1024
    s_xor_b32 s20, s23, 0
    buffer_load_dwordx4 v7, s[8:11], s20 offen lds
    s_waitcnt lgkmcnt(5)
    v_mfma_f32_32x32x16_bf16 v[64:79], a[244:247], v[52:55], v[64:79]
    ds_read_b128 v[44:47], v27 offset:0
    s_waitcnt lgkmcnt(5)
    v_mfma_f32_32x32x16_bf16 v[64:79], a[248:251], v[56:59], v[64:79]
    ds_read_b128 v[48:51], v28 offset:0
    s_waitcnt lgkmcnt(5)
    v_mfma_f32_32x32x16_bf16 v[64:79], a[252:255], v[60:63], v[64:79]
    ds_read_b128 v[52:55], v29 offset:0
    s_add_u32 m0, s21, 8192
    s_xor_b32 s20, s23, 256
    buffer_load_dwordx4 v6, s[8:11], s20 offen lds
    s_waitcnt lgkmcnt(5)
    v_mfma_f32_32x32x16_bf16 v[80:95], a[0:3], v[32:35], 0
    ds_read_b128 v[56:59], v30 offset:0
    s_waitcnt lgkmcnt(5)
    v_mfma_f32_32x32x16_bf16 v[80:95], a[4:7], v[36:39], v[80:95]
    ds_read_b128 v[60:63], v31 offset:0
    s_waitcnt lgkmcnt(5)
    v_mfma_f32_32x32x16_bf16 v[80:95], a[8:11], v[40:43], v[80:95]
    ds_read_b128 v[32:35], v24 offset:8192
    s_add_u32 m0, s21, 9216
    s_xor_b32 s20, s23, 256
    buffer_load_dwordx4 v7, s[8:11], s20 offen lds
    s_waitcnt lgkmcnt(5)
    v_mfma_f32_32x32x16_bf16 v[80:95], a[12:15], v[44:47], v[80:95]
    ds_read_b128 v[36:39], v25 offset:8192
    s_waitcnt lgkmcnt(5)
    v_mfma_f32_32x32x16_bf16 v[80:95], a[16:19], v[48:51], v[80:95]
    ds_read_b128 v[40:43], v26 offset:8192
    s_waitcnt lgkmcnt(5)
    v_mfma_f32_32x32x16_bf16 v[80:95], a[20:23], v[52:55], v[80:95]
    ds_read_b128 v[44:47], v27 offset:8192
    s_add_u32 m0, s21, 16384
    s_xor_b32 s20, s23, 512
    buffer_load_dwordx4 v6, s[8:11], s20 offen lds
    s_waitcnt lgkmcnt(5)
    v_mfma_f32_32x32x16_bf16 v[80:95], a[24:27], v[56:59], v[80:95]
    ds_read_b128 v[48:51], v28 offset:8192
    s_waitcnt lgkmcnt(5)
    v_mfma_f32_32x32x16_bf16 v[80:95], a[28:31], v[60:63], v[80:95]
    ds_read_b128 v[52:55], v29 offset:8192
    s_waitcnt lgkmcnt(5)
    v_mfma_f32_32x32x16_bf16 v[80:95], a[32:35], v[32:35], v[80:95]
    ds_read_b128 v[56:59], v30 offset:8192
    s_add_u32 m0, s21, 17408
    s_xor_b32 s20, s23, 512
    buffer_load_dwordx4 v7, s[8:11], s20 offen lds
    s_waitcnt lgkmcnt(5)
    v_mfma_f32_32x32x16_bf16 v[80:95], a[36:39], v[36:39], v[80:95]
    ds_read_b128 v[60:63], v31 offset:8192
    s_waitcnt lgkmcnt(5)
    v_mfma_f32_32x32x16_bf16 v[80:95], a[40:43], v[40:43], v[80:95]
    ds_read_b128 v[32:35], v24 offset:16384
    s_waitcnt lgkmcnt(5)
    v_mfma_f32_32x32x16_bf16 v[80:95], a[44:47], v[44:47], v[80:95]
    ds_read_b128 v[36:39], v25 offset:16384
    s_add_u32 m0, s21, 24576
    s_xor_b32 s20, s23, 768
    buffer_load_dwordx4 v6, s[8:11], s20 offen lds
    s_waitcnt lgkmcnt(5)
    v_mfma_f32_32x32x16_bf16 v[80:95], a[48:51], v[48:51], v[80:95]
    ds_read_b128 v[40:43], v26 offset:16384
    s_waitcnt lgkmcnt(5)
    v_mfma_f32_32x32x16_bf16 v[80:95], a[52:55], v[52:55], v[80:95]
    ds_read_b128 v[44:47], v27 offset:16384
    s_waitcnt lgkmcnt(5)
    v_mfma_f32_32x32x16_bf16 v[80:95], a[56:59], v[56:59], v[80:95]
    ds_read_b128 v[48:51], v28 offset:16384
    s_add_u32 m0, s21, 25600
    s_xor_b32 s20, s23, 768
    buffer_load_dwordx4 v7, s[8:11], s20 offen lds
    s_waitcnt lgkmcnt(5)
    v_mfma_f32_32x32x16_bf16 v[80:95], a[60:63], v[60:63], v[80:95]
    ds_read_b128 v[52:55], v29 offset:16384
    s_waitcnt lgkmcnt(5)
    v_mfma_f32_32x32x16_bf16 v[80:95], a[64:67], v[32:35], v[80:95]
    ds_read_b128 v[56:59], v30 offset:16384
    v_cvt_pk_bf16_f32 v96, v64, v65
    v_cvt_pk_bf16_f32 v97, v66, v67
    v_cvt_pk_bf16_f32 v98, v68, v69
    v_cvt_pk_bf16_f32 v99, v70, v71
    buffer_store_dwordx4 v[96:99], v8, s[84:87], s24 offen offset:0 sc1
    s_waitcnt lgkmcnt(5)
    v_mfma_f32_32x32x16_bf16 v[80:95], a[68:71], v[36:39], v[80:95]
    ds_read_b128 v[60:63], v31 offset:16384
    s_waitcnt lgkmcnt(5)
    v_mfma_f32_32x32x16_bf16 v[80:95], a[72:75], v[40:43], v[80:95]
    ds_read_b128 v[32:35], v24 offset:24576
    v_cvt_pk_bf16_f32 v100, v72, v73
    v_cvt_pk_bf16_f32 v101, v74, v75
    v_cvt_pk_bf16_f32 v102, v76, v77
    v_cvt_pk_bf16_f32 v103, v78, v79
    buffer_store_dwordx4 v[100:103], v8, s[84:87], s24 offen offset:512 sc1
    s_add_u32 s24, s24, 524288
    s_waitcnt lgkmcnt(5)
    v_mfma_f32_32x32x16_bf16 v[80:95], a[76:79], v[44:47], v[80:95]
    ds_read_b128 v[36:39], v25 offset:24576
    s_waitcnt lgkmcnt(5)
    v_mfma_f32_32x32x16_bf16 v[80:95], a[80:83], v[48:51], v[80:95]
    ds_read_b128 v[40:43], v26 offset:24576
    s_waitcnt lgkmcnt(5)
    v_mfma_f32_32x32x16_bf16 v[80:95], a[84:87], v[52:55], v[80:95]
    ds_read_b128 v[44:47], v27 offset:24576
    s_waitcnt lgkmcnt(5)
    v_mfma_f32_32x32x16_bf16 v[80:95], a[88:91], v[56:59], v[80:95]
    ds_read_b128 v[48:51], v28 offset:24576
    s_waitcnt lgkmcnt(5)
    v_mfma_f32_32x32x16_bf16 v[80:95], a[92:95], v[60:63], v[80:95]
    ds_read_b128 v[52:55], v29 offset:24576
    s_waitcnt vmcnt(8)
    s_barrier
    s_waitcnt lgkmcnt(5)
    v_mfma_f32_32x32x16_bf16 v[80:95], a[96:99], v[32:35], v[80:95]
    ds_read_b128 v[56:59], v30 offset:24576
    s_waitcnt lgkmcnt(5)
    v_mfma_f32_32x32x16_bf16 v[80:95], a[100:103], v[36:39], v[80:95]
    ds_read_b128 v[60:63], v31 offset:24576
    s_add_u32 m0, s21, 32768
    s_xor_b32 s20, s23, 1024
    buffer_load_dwordx4 v6, s[8:11], s20 offen lds
    s_waitcnt lgkmcnt(5)
    v_mfma_f32_32x32x16_bf16 v[80:95], a[104:107], v[40:43], v[80:95]
    ds_read_b128 v[32:35], v24 offset:32768
    s_waitcnt lgkmcnt(5)
    v_mfma_f32_32x32x16_bf16 v[80:95], a[108:111], v[44:47], v[80:95]
    ds_read_b128 v[36:39], v25 offset:32768
    s_waitcnt lgkmcnt(5)
    v_mfma_f32_32x32x16_bf16 v[80:95], a[112:115], v[48:51], v[80:95]
    ds_read_b128 v[40:43], v26 offset:32768
    s_add_u32 m0, s21, 33792
    s_xor_b32 s20, s23, 1024
    buffer_load_dwordx4 v7, s[8:11], s20 offen lds
    s_waitcnt lgkmcnt(5)
    v_mfma_f32_32x32x16_bf16 v[80:95], a[116:119], v[52:55], v[80:95]
    ds_read_b128 v[44:47], v27 offset:32768
    s_waitcnt lgkmcnt(5)
    v_mfma_f32_32x32x16_bf16 v[80:95], a[120:123], v[56:59], v[80:95]
    ds_read_b128 v[48:51], v28 offset:32768
    s_waitcnt lgkmcnt(5)
    v_mfma_f32_32x32x16_bf16 v[80:95], a[124:127], v[60:63], v[80:95]
    ds_read_b128 v[52:55], v29 offset:32768
    s_add_u32 m0, s21, 40960
    s_xor_b32 s20, s23, 1280
    buffer_load_dwordx4 v6, s[8:11], s20 offen lds
    s_waitcnt lgkmcnt(5)
    v_mfma_f32_32x32x16_bf16 v[80:95], a[128:131], v[32:35], v[80:95]
    ds_read_b128 v[56:59], v30 offset:32768
    s_waitcnt lgkmcnt(5)
    v_mfma_f32_32x32x16_bf16 v[80:95], a[132:135], v[36:39], v[80:95]
    ds_read_b128 v[60:63], v31 offset:32768
    s_waitcnt lgkmcnt(5)
    v_mfma_f32_32x32x16_bf16 v[80:95], a[136:139], v[40:43], v[80:95]
    ds_read_b128 v[32:35], v24 offset:40960
    s_add_u32 m0, s21, 41984
    s_xor_b32 s20, s23, 1280
    buffer_load_dwordx4 v7, s[8:11], s20 offen lds
    s_waitcnt lgkmcnt(5)
    v_mfma_f32_32x32x16_bf16 v[80:95], a[140:143], v[44:47], v[80:95]
    ds_read_b128 v[36:39], v25 offset:40960
    s_waitcnt lgkmcnt(5)
    v_mfma_f32_32x32x16_bf16 v[80:95], a[144:147], v[48:51], v[80:95]
    ds_read_b128 v[40:43], v26 offset:40960
    s_waitcnt lgkmcnt(5)
    v_mfma_f32_32x32x16_bf16 v[80:95], a[148:151], v[52:55], v[80:95]
    ds_read_b128 v[44:47], v27 offset:40960
    s_add_u32 m0, s21, 49152
    s_xor_b32 s20, s23, 1536
    buffer_load_dwordx4 v6, s[8:11], s20 offen lds
    s_waitcnt lgkmcnt(5)
    v_mfma_f32_32x32x16_bf16 v[80:95], a[152:155], v[56:59], v[80:95]
    ds_read_b128 v[48:51], v28 offset:40960
    s_waitcnt lgkmcnt(5)
    v_mfma_f32_32x32x16_bf16 v[80:95], a[156:159], v[60:63], v[80:95]
    ds_read_b128 v[52:55], v29 offset:40960
    s_waitcnt lgkmcnt(5)
    v_mfma_f32_32x32x16_bf16 v[80:95], a[160:163], v[32:35], v[80:95]
    ds_read_b128 v[56:59], v30 offset:40960
    s_add_u32 m0, s21, 50176
    s_xor_b32 s20, s23, 1536
    buffer_load_dwordx4 v7, s[8:11], s20 offen lds
    s_waitcnt lgkmcnt(5)
    v_mfma_f32_32x32x16_bf16 v[80:95], a[164:167], v[36:39], v[80:95]
    ds_read_b128 v[60:63], v31 offset:40960
    s_waitcnt lgkmcnt(5)
    v_mfma_f32_32x32x16_bf16 v[80:95], a[168:171], v[40:43], v[80:95]
    ds_read_b128 v[32:35], v24 offset:49152
    s_waitcnt lgkmcnt(5)
    v_mfma_f32_32x32x16_bf16 v[80:95], a[172:175], v[44:47], v[80:95]
    ds_read_b128 v[36:39], v25 offset:49152
    s_add_u32 m0, s21, 57344
    s_xor_b32 s20, s23, 1792
    buffer_load_dwordx4 v6, s[8:11], s20 offen lds
    s_waitcnt lgkmcnt(5)
    v_mfma_f32_32x32x16_bf16 v[80:95], a[176:179], v[48:51], v[80:95]
    ds_read_b128 v[40:43], v26 offset:49152
    s_waitcnt lgkmcnt(5)
    v_mfma_f32_32x32x16_bf16 v[80:95], a[180:183], v[52:55], v[80:95]
    ds_read_b128 v[44:47], v27 offset:49152
    s_waitcnt lgkmcnt(5)
    v_mfma_f32_32x32x16_bf16 v[80:95], a[184:187], v[56:59], v[80:95]
    ds_read_b128 v[48:51], v28 offset:49152
    s_add_u32 m0, s21, 58368
    s_xor_b32 s20, s23, 1792
    buffer_load_dwordx4 v7, s[8:11], s20 offen lds
    s_waitcnt lgkmcnt(5)
    v_mfma_f32_32x32x16_bf16 v[80:95], a[188:191], v[60:63], v[80:95]
    ds_read_b128 v[52:55], v29 offset:49152
    s_waitcnt lgkmcnt(5)
    v_mfma_f32_32x32x16_bf16 v[80:95], a[192:195], v[32:35], v[80:95]
    ds_read_b128 v[56:59], v30 offset:49152
    s_waitcnt lgkmcnt(5)
    v_mfma_f32_32x32x16_bf16 v[80:95], a[196:199], v[36:39], v[80:95]
    ds_read_b128 v[60:63], v31 offset:49152
    s_waitcnt lgkmcnt(5)
    v_mfma_f32_32x32x16_bf16 v[80:95], a[200:203], v[40:43], v[80:95]
    ds_read_b128 v[32:35], v24 offset:57344
    s_waitcnt lgkmcnt(5)
    v_mfma_f32_32x32x16_bf16 v[80:95], a[204:207], v[44:47], v[80:95]
    ds_read_b128 v[36:39], v25 offset:57344
    s_waitcnt lgkmcnt(5)
    v_mfma_f32_32x32x16_bf16 v[80:95], a[208:211], v[48:51], v[80:95]
    ds_read_b128 v[40:43], v26 offset:57344
    s_waitcnt lgkmcnt(5)
    v_mfma_f32_32x32x16_bf16 v[80:95], a[212:215], v[52:55], v[80:95]
    ds_read_b128 v[44:47], v27 offset:57344
    s_waitcnt lgkmcnt(5)
    v_mfma_f32_32x32x16_bf16 v[80:95], a[216:219], v[56:59], v[80:95]
    ds_read_b128 v[48:51], v28 offset:57344
    s_waitcnt lgkmcnt(5)
    v_mfma_f32_32x32x16_bf16 v[80:95], a[220:223], v[60:63], v[80:95]
    ds_read_b128 v[52:55], v29 offset:57344
    s_waitcnt vmcnt(8)
    s_barrier
    s_waitcnt lgkmcnt(5)
    v_mfma_f32_32x32x16_bf16 v[80:95], a[224:227], v[32:35], v[80:95]
    ds_read_b128 v[56:59], v30 offset:57344
    s_waitcnt lgkmcnt(5)
    v_mfma_f32_32x32x16_bf16 v[80:95], a[228:231], v[36:39], v[80:95]
    ds_read_b128 v[60:63], v31 offset:57344
    s_add_u32 s23, s23, 131072
    s_add_u32 m0, s21, 65536
    s_xor_b32 s20, s23, 0
    buffer_load_dwordx4 v6, s[8:11], s20 offen lds
    s_waitcnt lgkmcnt(5)
    v_mfma_f32_32x32x16_bf16 v[80:95], a[232:235], v[40:43], v[80:95]
    ds_read_b128 v[32:35], v16 offset:0
    v_add_u32 v10, 1, v10
    buffer_store_dword v10, v9, s[84:87], 0 offen sc1
    s_waitcnt lgkmcnt(5)
    v_mfma_f32_32x32x16_bf16 v[80:95], a[236:239], v[44:47], v[80:95]
    ds_read_b128 v[36:39], v17 offset:0
    s_waitcnt lgkmcnt(5)
    v_mfma_f32_32x32x16_bf16 v[80:95], a[240:243], v[48:51], v[80:95]
    ds_read_b128 v[40:43], v18 offset:0
    s_add_u32 m0, s21, 66560
    s_xor_b32 s20, s23, 0
    buffer_load_dwordx4 v7, s[8:11], s20 offen lds
    s_waitcnt lgkmcnt(5)
    v_mfma_f32_32x32x16_bf16 v[80:95], a[244:247], v[52:55], v[80:95]
    ds_read_b128 v[44:47], v19 offset:0
    s_waitcnt lgkmcnt(5)
    v_mfma_f32_32x32x16_bf16 v[80:95], a[248:251], v[56:59], v[80:95]
    ds_read_b128 v[48:51], v20 offset:0
    s_waitcnt lgkmcnt(5)
    v_mfma_f32_32x32x16_bf16 v[80:95], a[252:255], v[60:63], v[80:95]
    ds_read_b128 v[52:55], v21 offset:0
    s_add_u32 m0, s21, 73728
    s_xor_b32 s20, s23, 256
    buffer_load_dwordx4 v6, s[8:11], s20 offen lds
    s_add_u32 s25, s25, 1
    s_cmp_lt_u32 s25, 16
    s_cbranch_scc1 mega_kernel_q_qk_loop
    s_nop 11
    v_cvt_pk_bf16_f32 v96, v80, v81
    v_cvt_pk_bf16_f32 v97, v82, v83
    v_cvt_pk_bf16_f32 v98, v84, v85
    v_cvt_pk_bf16_f32 v99, v86, v87
    buffer_store_dwordx4 v[96:99], v8, s[84:87], s24 offen offset:0 sc1
    v_cvt_pk_bf16_f32 v100, v88, v89
    v_cvt_pk_bf16_f32 v101, v90, v91
    v_cvt_pk_bf16_f32 v102, v92, v93
    v_cvt_pk_bf16_f32 v103, v94, v95
    buffer_store_dwordx4 v[100:103], v8, s[84:87], s24 offen offset:512 sc1
    s_add_u32 s24, s24, 524288
    s_waitcnt vmcnt(0) lgkmcnt(0)
    s_barrier
    v_add_u32 v10, 1, v10
    buffer_store_dword v10, v9, s[84:87], 0 offen sc1
    s_branch mega_kernel_q_done
mega_kernel_q_v:
    ds_read_b128 v[32:35], v16 offset:0
    ds_read_b128 v[36:39], v17 offset:0
    ds_read_b128 v[40:43], v18 offset:0
    ds_read_b128 v[44:47], v19 offset:0
    ds_read_b128 v[48:51], v20 offset:0
    ds_read_b128 v[52:55], v21 offset:0
    s_mov_b32 s25, 0
mega_kernel_q_v_loop:
    s_waitcnt lgkmcnt(5)
    v_mfma_f32_32x32x16_bf16 v[64:79], v[32:35], a[0:3], 0
    ds_read_b128 v[56:59], v22 offset:0
    s_waitcnt lgkmcnt(5)
    v_mfma_f32_32x32x16_bf16 v[64:79], v[36:39], a[4:7], v[64:79]
    ds_read_b128 v[60:63], v23 offset:0
    s_waitcnt lgkmcnt(5)
    v_mfma_f32_32x32x16_bf16 v[64:79], v[40:43], a[8:11], v[64:79]
    ds_read_b128 v[32:35], v16 offset:8192
    s_cmp_eq_u32 s25, 0
    s_cbranch_scc1 mega_kernel_q_v_sk2
    s_add_u32 m0, s21, 74752
    s_xor_b32 s20, s23, 256
    buffer_load_dwordx4 v7, s[8:11], s20 offen lds
mega_kernel_q_v_sk2:
    s_waitcnt lgkmcnt(5)
    v_mfma_f32_32x32x16_bf16 v[64:79], v[44:47], a[12:15], v[64:79]
    ds_read_b128 v[36:39], v17 offset:8192
    s_waitcnt lgkmcnt(5)
    v_mfma_f32_32x32x16_bf16 v[64:79], v[48:51], a[16:19], v[64:79]
    ds_read_b128 v[40:43], v18 offset:8192
    s_waitcnt lgkmcnt(5)
    v_mfma_f32_32x32x16_bf16 v[64:79], v[52:55], a[20:23], v[64:79]
    ds_read_b128 v[44:47], v19 offset:8192
    s_cmp_eq_u32 s25, 0
    s_cbranch_scc1 mega_kernel_q_v_sk5
    s_add_u32 m0, s21, 81920
    s_xor_b32 s20, s23, 512
    buffer_load_dwordx4 v6, s[8:11], s20 offen lds
mega_kernel_q_v_sk5:
    s_waitcnt lgkmcnt(5)
    v_mfma_f32_32x32x16_bf16 v[64:79], v[56:59], a[24:27], v[64:79]
    ds_read_b128 v[48:51], v20 offset:8192
    s_waitcnt lgkmcnt(5)
    v_mfma_f32_32x32x16_bf16 v[64:79], v[60:63], a[28:31], v[64:79]
    ds_read_b128 v[52:55], v21 offset:8192
    s_waitcnt lgkmcnt(5)
    v_mfma_f32_32x32x16_bf16 v[64:79], v[32:35], a[32:35], v[64:79]
    ds_read_b128 v[56:59], v22 offset:8192
    s_cmp_eq_u32 s25, 0
    s_cbranch_scc1 mega_kernel_q_v_sk8
    s_add_u32 m0, s21, 82944
    s_xor_b32 s20, s23, 512
    buffer_load_dwordx4 v7, s[8:11], s20 offen lds
mega_kernel_q_v_sk8:
    s_waitcnt lgkmcnt(5)
    v_mfma_f32_32x32x16_bf16 v[64:79], v[36:39], a[36:39], v[64:79]
    ds_read_b128 v[60:63], v23 offset:8192
    s_waitcnt lgkmcnt(5)
    v_mfma_f32_32x32x16_bf16 v[64:79], v[40:43], a[40:43], v[64:79]
    ds_read_b128 v[32:35], v16 offset:16384
    s_waitcnt lgkmcnt(5)
    v_mfma_f32_32x32x16_bf16 v[64:79], v[44:47], a[44:47], v[64:79]
    ds_read_b128 v[36:39], v17 offset:16384
    s_cmp_eq_u32 s25, 0
    s_cbranch_scc1 mega_kernel_q_v_sk11
    s_add_u32 m0, s21, 90112
    s_xor_b32 s20, s23, 768
    buffer_load_dwordx4 v6, s[8:11], s20 offen lds
mega_kernel_q_v_sk11:
    s_waitcnt lgkmcnt(5)
    v_mfma_f32_32x32x16_bf16 v[64:79], v[48:51], a[48:51], v[64:79]
    ds_read_b128 v[40:43], v18 offset:16384
    s_waitcnt lgkmcnt(5)
    v_mfma_f32_32x32x16_bf16 v[64:79], v[52:55], a[52:55], v[64:79]
    ds_read_b128 v[44:47], v19 offset:16384
    s_waitcnt lgkmcnt(5)
    v_mfma_f32_32x32x16_bf16 v[64:79], v[56:59], a[56:59], v[64:79]
    ds_read_b128 v[48:51], v20 offset:16384
    s_cmp_eq_u32 s25, 0
    s_cbranch_scc1 mega_kernel_q_v_sk14
    s_add_u32 m0, s21, 91136
    s_xor_b32 s20, s23, 768
    buffer_load_dwordx4 v7, s[8:11], s20 offen lds
mega_kernel_q_v_sk14:
    s_waitcnt lgkmcnt(5)
    v_mfma_f32_32x32x16_bf16 v[64:79], v[60:63], a[60:63], v[64:79]
    ds_read_b128 v[52:55], v21 offset:16384
    s_waitcnt lgkmcnt(5)
    v_mfma_f32_32x32x16_bf16 v[64:79], v[32:35], a[64:67], v[64:79]
    ds_read_b128 v[56:59], v22 offset:16384
    s_cmp_eq_u32 s25, 0
    s_cbranch_scc1 mega_kernel_q_v_ne0
    v_cvt_pk_bf16_f32 v96, v80, v81
    v_cvt_pk_bf16_f32 v97, v82, v83
    v_cvt_pk_bf16_f32 v98, v88, v89
    v_cvt_pk_bf16_f32 v99, v90, v91
    buffer_store_dwordx4 v[96:99], v8, s[84:87], s24 offen offset:0 sc1
mega_kernel_q_v_ne0:
    s_waitcnt lgkmcnt(5)
    v_mfma_f32_32x32x16_bf16 v[64:79], v[36:39], a[68:71], v[64:79]
    ds_read_b128 v[60:63], v23 offset:16384
    s_waitcnt lgkmcnt(5)
    v_mfma_f32_32x32x16_bf16 v[64:79], v[40:43], a[72:75], v[64:79]
    ds_read_b128 v[32:35], v16 offset:24576
    s_cmp_eq_u32 s25, 0
    s_cbranch_scc1 mega_kernel_q_v_ne1
    v_cvt_pk_bf16_f32 v100, v84, v85
    v_cvt_pk_bf16_f32 v101, v86, v87
    v_cvt_pk_bf16_f32 v102, v92, v93
    v_cvt_pk_bf16_f32 v103, v94, v95
    buffer_store_dwordx4 v[100:103], v8, s[84:87], s24 offen offset:512 sc1
    s_add_u32 s24, s24, 524288
mega_kernel_q_v_ne1:
    s_waitcnt lgkmcnt(5)
    v_mfma_f32_32x32x16_bf16 v[64:79], v[44:47], a[76:79], v[64:79]
    ds_read_b128 v[36:39], v17 offset:24576
    s_waitcnt lgkmcnt(5)
    v_mfma_f32_32x32x16_bf16 v[64:79], v[48:51], a[80:83], v[64:79]
    ds_read_b128 v[40:43], v18 offset:24576
    s_waitcnt lgkmcnt(5)
    v_mfma_f32_32x32x16_bf16 v[64:79], v[52:55], a[84:87], v[64:79]
    ds_read_b128 v[44:47], v19 offset:24576
    s_waitcnt lgkmcnt(5)
    v_mfma_f32_32x32x16_bf16 v[64:79], v[56:59], a[88:91], v[64:79]
    ds_read_b128 v[48:51], v20 offset:24576
    s_waitcnt lgkmcnt(5)
    v_mfma_f32_32x32x16_bf16 v[64:79], v[60:63], a[92:95], v[64:79]
    ds_read_b128 v[52:55], v21 offset:24576
    s_waitcnt vmcnt(8)
    s_barrier
    s_waitcnt lgkmcnt(5)
    v_mfma_f32_32x32x16_bf16 v[64:79], v[32:35], a[96:99], v[64:79]
    ds_read_b128 v[56:59], v22 offset:24576
    s_waitcnt lgkmcnt(5)
    v_mfma_f32_32x32x16_bf16 v[64:79], v[36:39], a[100:103], v[64:79]
    ds_read_b128 v[60:63], v23 offset:24576
    s_add_u32 m0, s21, 98304
    s_xor_b32 s20, s23, 1024
    buffer_load_dwordx4 v6, s[8:11], s20 offen lds
    s_waitcnt lgkmcnt(5)
    v_mfma_f32_32x32x16_bf16 v[64:79], v[40:43], a[104:107], v[64:79]
    ds_read_b128 v[32:35], v16 offset:32768
    s_waitcnt lgkmcnt(5)
    v_mfma_f32_32x32x16_bf16 v[64:79], v[44:47], a[108:111], v[64:79]
    ds_read_b128 v[36:39], v17 offset:32768
    s_waitcnt lgkmcnt(5)
    v_mfma_f32_32x32x16_bf16 v[64:79], v[48:51], a[112:115], v[64:79]
    ds_read_b128 v[40:43], v18 offset:32768
    s_add_u32 m0, s21, 99328
    s_xor_b32 s20, s23, 1024
    buffer_load_dwordx4 v7, s[8:11], s20 offen lds
    s_waitcnt lgkmcnt(5)
    v_mfma_f32_32x32x16_bf16 v[64:79], v[52:55], a[116:119], v[64:79]
    ds_read_b128 v[44:47], v19 offset:32768
    s_waitcnt lgkmcnt(5)
    v_mfma_f32_32x32x16_bf16 v[64:79], v[56:59], a[120:123], v[64:79]
    ds_read_b128 v[48:51], v20 offset:32768
    s_waitcnt lgkmcnt(5)
    v_mfma_f32_32x32x16_bf16 v[64:79], v[60:63], a[124:127], v[64:79]
    ds_read_b128 v[52:55], v21 offset:32768
    s_add_u32 m0, s21, 106496
    s_xor_b32 s20, s23, 1280
    buffer_load_dwordx4 v6, s[8:11], s20 offen lds
    s_waitcnt lgkmcnt(5)
    v_mfma_f32_32x32x16_bf16 v[64:79], v[32:35], a[128:131], v[64:79]
    ds_read_b128 v[56:59], v22 offset:32768
    s_waitcnt lgkmcnt(5)
    v_mfma_f32_32x32x16_bf16 v[64:79], v[36:39], a[132:135], v[64:79]
    ds_read_b128 v[60:63], v23 offset:32768
    s_waitcnt lgkmcnt(5)
    v_mfma_f32_32x32x16_bf16 v[64:79], v[40:43], a[136:139], v[64:79]
    ds_read_b128 v[32:35], v16 offset:40960
    s_add_u32 m0, s21, 107520
    s_xor_b32 s20, s23, 1280
    buffer_load_dwordx4 v7, s[8:11], s20 offen lds
    s_waitcnt lgkmcnt(5)
    v_mfma_f32_32x32x16_bf16 v[64:79], v[44:47], a[140:143], v[64:79]
    ds_read_b128 v[36:39], v17 offset:40960
    s_waitcnt lgkmcnt(5)
    v_mfma_f32_32x32x16_bf16 v[64:79], v[48:51], a[144:147], v[64:79]
    ds_read_b128 v[40:43], v18 offset:40960
    s_waitcnt lgkmcnt(5)
    v_mfma_f32_32x32x16_bf16 v[64:79], v[52:55], a[148:151], v[64:79]
    ds_read_b128 v[44:47], v19 offset:40960
    s_add_u32 m0, s21, 114688
    s_xor_b32 s20, s23, 1536
    buffer_load_dwordx4 v6, s[8:11], s20 offen lds
    s_waitcnt lgkmcnt(5)
    v_mfma_f32_32x32x16_bf16 v[64:79], v[56:59], a[152:155], v[64:79]
    ds_read_b128 v[48:51], v20 offset:40960
    s_waitcnt lgkmcnt(5)
    v_mfma_f32_32x32x16_bf16 v[64:79], v[60:63], a[156:159], v[64:79]
    ds_read_b128 v[52:55], v21 offset:40960
    s_waitcnt lgkmcnt(5)
    v_mfma_f32_32x32x16_bf16 v[64:79], v[32:35], a[160:163], v[64:79]
    ds_read_b128 v[56:59], v22 offset:40960
    s_add_u32 m0, s21, 115712
    s_xor_b32 s20, s23, 1536
    buffer_load_dwordx4 v7, s[8:11], s20 offen lds
    s_waitcnt lgkmcnt(5)
    v_mfma_f32_32x32x16_bf16 v[64:79], v[36:39], a[164:167], v[64:79]
    ds_read_b128 v[60:63], v23 offset:40960
    s_waitcnt lgkmcnt(5)
    v_mfma_f32_32x32x16_bf16 v[64:79], v[40:43], a[168:171], v[64:79]
    ds_read_b128 v[32:35], v16 offset:49152
    s_waitcnt lgkmcnt(5)
    v_mfma_f32_32x32x16_bf16 v[64:79], v[44:47], a[172:175], v[64:79]
    ds_read_b128 v[36:39], v17 offset:49152
    s_add_u32 m0, s21, 122880
    s_xor_b32 s20, s23, 1792
    buffer_load_dwordx4 v6, s[8:11], s20 offen lds
    s_waitcnt lgkmcnt(5)
    v_mfma_f32_32x32x16_bf16 v[64:79], v[48:51], a[176:179], v[64:79]
    ds_read_b128 v[40:43], v18 offset:49152
    s_waitcnt lgkmcnt(5)
    v_mfma_f32_32x32x16_bf16 v[64:79], v[52:55], a[180:183], v[64:79]
    ds_read_b128 v[44:47], v19 offset:49152
    s_waitcnt lgkmcnt(5)
    v_mfma_f32_32x32x16_bf16 v[64:79], v[56:59], a[184:187], v[64:79]
    ds_read_b128 v[48:51], v20 offset:49152
    s_add_u32 m0, s21, 123904
    s_xor_b32 s20, s23, 1792
    buffer_load_dwordx4 v7, s[8:11], s20 offen lds
    s_waitcnt lgkmcnt(5)
    v_mfma_f32_32x32x16_bf16 v[64:79], v[60:63], a[188:191], v[64:79]
    ds_read_b128 v[52:55], v21 offset:49152
    s_waitcnt lgkmcnt(5)
    v_mfma_f32_32x32x16_bf16 v[64:79], v[32:35], a[192:195], v[64:79]
    ds_read_b128 v[56:59], v22 offset:49152
    s_waitcnt lgkmcnt(5)
    v_mfma_f32_32x32x16_bf16 v[64:79], v[36:39], a[196:199], v[64:79]
    ds_read_b128 v[60:63], v23 offset:49152
    s_waitcnt lgkmcnt(5)
    v_mfma_f32_32x32x16_bf16 v[64:79], v[40:43], a[200:203], v[64:79]
    ds_read_b128 v[32:35], v16 offset:57344
    s_waitcnt lgkmcnt(5)
    v_mfma_f32_32x32x16_bf16 v[64:79], v[44:47], a[204:207], v[64:79]
    ds_read_b128 v[36:39], v17 offset:57344
    s_waitcnt lgkmcnt(5)
    v_mfma_f32_32x32x16_bf16 v[64:79], v[48:51], a[208:211], v[64:79]
    ds_read_b128 v[40:43], v18 offset:57344
    s_waitcnt lgkmcnt(5)
    v_mfma_f32_32x32x16_bf16 v[64:79], v[52:55], a[212:215], v[64:79]
    ds_read_b128 v[44:47], v19 offset:57344
    s_waitcnt lgkmcnt(5)
    v_mfma_f32_32x32x16_bf16 v[64:79], v[56:59], a[216:219], v[64:79]
    ds_read_b128 v[48:51], v20 offset:57344
    s_waitcnt lgkmcnt(5)
    v_mfma_f32_32x32x16_bf16 v[64:79], v[60:63], a[220:223], v[64:79]
    ds_read_b128 v[52:55], v21 offset:57344
    s_waitcnt vmcnt(8)
    s_barrier
    s_waitcnt lgkmcnt(5)
    v_mfma_f32_32x32x16_bf16 v[64:79], v[32:35], a[224:227], v[64:79]
    ds_read_b128 v[56:59], v22 offset:57344
    s_waitcnt lgkmcnt(5)
    v_mfma_f32_32x32x16_bf16 v[64:79], v[36:39], a[228:231], v[64:79]
    ds_read_b128 v[60:63], v23 offset:57344
    s_add_u32 s23, s23, 131072
    s_add_u32 m0, s21, 0
    s_xor_b32 s20, s23, 0
    buffer_load_dwordx4 v6, s[8:11], s20 offen lds
    s_waitcnt lgkmcnt(5)
    v_mfma_f32_32x32x16_bf16 v[64:79], v[40:43], a[232:235], v[64:79]
    ds_read_b128 v[32:35], v24 offset:0
    s_cmp_eq_u32 s25, 0
    s_cbranch_scc1 mega_kernel_q_v_nf
    v_add_u32 v10, 1, v10
    buffer_store_dword v10, v9, s[84:87], 0 offen sc1
mega_kernel_q_v_nf:
    s_waitcnt lgkmcnt(5)
    v_mfma_f32_32x32x16_bf16 v[64:79], v[44:47], a[236:239], v[64:79]
    ds_read_b128 v[36:39], v25 offset:0
    s_waitcnt lgkmcnt(5)
    v_mfma_f32_32x32x16_bf16 v[64:79], v[48:51], a[240:243], v[64:79]
    ds_read_b128 v[40:43], v26 offset:0
    s_add_u32 m0, s21, 1024
    s_xor_b32 s20, s23, 0
    buffer_load_dwordx4 v7, s[8:11], s20 offen lds
    s_waitcnt lgkmcnt(5)
    v_mfma_f32_32x32x16_bf16 v[64:79], v[52:55], a[244:247], v[64:79]
    ds_read_b128 v[44:47], v27 offset:0
    s_waitcnt lgkmcnt(5)
    v_mfma_f32_32x32x16_bf16 v[64:79], v[56:59], a[248:251], v[64:79]
    ds_read_b128 v[48:51], v28 offset:0
    s_waitcnt lgkmcnt(5)
    v_mfma_f32_32x32x16_bf16 v[64:79], v[60:63], a[252:255], v[64:79]
    ds_read_b128 v[52:55], v29 offset:0
    s_add_u32 m0, s21, 8192
    s_xor_b32 s20, s23, 256
    buffer_load_dwordx4 v6, s[8:11], s20 offen lds
    s_waitcnt lgkmcnt(5)
    v_mfma_f32_32x32x16_bf16 v[80:95], v[32:35], a[0:3], 0
    ds_read_b128 v[56:59], v30 offset:0
    s_waitcnt lgkmcnt(5)
    v_mfma_f32_32x32x16_bf16 v[80:95], v[36:39], a[4:7], v[80:95]
    ds_read_b128 v[60:63], v31 offset:0
    s_waitcnt lgkmcnt(5)
    v_mfma_f32_32x32x16_bf16 v[80:95], v[40:43], a[8:11], v[80:95]
    ds_read_b128 v[32:35], v24 offset:8192
    s_add_u32 m0, s21, 9216
    s_xor_b32 s20, s23, 256
    buffer_load_dwordx4 v7, s[8:11], s20 offen lds
    s_waitcnt lgkmcnt(5)
    v_mfma_f32_32x32x16_bf16 v[80:95], v[44:47], a[12:15], v[80:95]
    ds_read_b128 v[36:39], v25 offset:8192
    s_waitcnt lgkmcnt(5)
    v_mfma_f32_32x32x16_bf16 v[80:95], v[48:51], a[16:19], v[80:95]
    ds_read_b128 v[40:43], v26 offset:8192
    s_waitcnt lgkmcnt(5)
    v_mfma_f32_32x32x16_bf16 v[80:95], v[52:55], a[20:23], v[80:95]
    ds_read_b128 v[44:47], v27 offset:8192
    s_add_u32 m0, s21, 16384
    s_xor_b32 s20, s23, 512
    buffer_load_dwordx4 v6, s[8:11], s20 offen lds
    s_waitcnt lgkmcnt(5)
    v_mfma_f32_32x32x16_bf16 v[80:95], v[56:59], a[24:27], v[80:95]
    ds_read_b128 v[48:51], v28 offset:8192
    s_waitcnt lgkmcnt(5)
    v_mfma_f32_32x32x16_bf16 v[80:95], v[60:63], a[28:31], v[80:95]
    ds_read_b128 v[52:55], v29 offset:8192
    s_waitcnt lgkmcnt(5)
    v_mfma_f32_32x32x16_bf16 v[80:95], v[32:35], a[32:35], v[80:95]
    ds_read_b128 v[56:59], v30 offset:8192
    s_add_u32 m0, s21, 17408
    s_xor_b32 s20, s23, 512
    buffer_load_dwordx4 v7, s[8:11], s20 offen lds
    s_waitcnt lgkmcnt(5)
    v_mfma_f32_32x32x16_bf16 v[80:95], v[36:39], a[36:39], v[80:95]
    ds_read_b128 v[60:63], v31 offset:8192
    s_waitcnt lgkmcnt(5)
    v_mfma_f32_32x32x16_bf16 v[80:95], v[40:43], a[40:43], v[80:95]
    ds_read_b128 v[32:35], v24 offset:16384
    s_waitcnt lgkmcnt(5)
    v_mfma_f32_32x32x16_bf16 v[80:95], v[44:47], a[44:47], v[80:95]
    ds_read_b128 v[36:39], v25 offset:16384
    s_add_u32 m0, s21, 24576
    s_xor_b32 s20, s23, 768
    buffer_load_dwordx4 v6, s[8:11], s20 offen lds
    s_waitcnt lgkmcnt(5)
    v_mfma_f32_32x32x16_bf16 v[80:95], v[48:51], a[48:51], v[80:95]
    ds_read_b128 v[40:43], v26 offset:16384
    s_waitcnt lgkmcnt(5)
    v_mfma_f32_32x32x16_bf16 v[80:95], v[52:55], a[52:55], v[80:95]
    ds_read_b128 v[44:47], v27 offset:16384
    s_waitcnt lgkmcnt(5)
    v_mfma_f32_32x32x16_bf16 v[80:95], v[56:59], a[56:59], v[80:95]
    ds_read_b128 v[48:51], v28 offset:16384
    s_add_u32 m0, s21, 25600
    s_xor_b32 s20, s23, 768
    buffer_load_dwordx4 v7, s[8:11], s20 offen lds
    s_waitcnt lgkmcnt(5)
    v_mfma_f32_32x32x16_bf16 v[80:95], v[60:63], a[60:63], v[80:95]
    ds_read_b128 v[52:55], v29 offset:16384
    s_waitcnt lgkmcnt(5)
    v_mfma_f32_32x32x16_bf16 v[80:95], v[32:35], a[64:67], v[80:95]
    ds_read_b128 v[56:59], v30 offset:16384
    v_cvt_pk_bf16_f32 v96, v64, v65
    v_cvt_pk_bf16_f32 v97, v66, v67
    v_cvt_pk_bf16_f32 v98, v72, v73
    v_cvt_pk_bf16_f32 v99, v74, v75
    buffer_store_dwordx4 v[96:99], v8, s[84:87], s24 offen offset:0 sc1
    s_waitcnt lgkmcnt(5)
    v_mfma_f32_32x32x16_bf16 v[80:95], v[36:39], a[68:71], v[80:95]
    ds_read_b128 v[60:63], v31 offset:16384
    s_waitcnt lgkmcnt(5)
    v_mfma_f32_32x32x16_bf16 v[80:95], v[40:43], a[72:75], v[80:95]
    ds_read_b128 v[32:35], v24 offset:24576
    v_cvt_pk_bf16_f32 v100, v68, v69
    v_cvt_pk_bf16_f32 v101, v70, v71
    v_cvt_pk_bf16_f32 v102, v76, v77
    v_cvt_pk_bf16_f32 v103, v78, v79
    buffer_store_dwordx4 v[100:103], v8, s[84:87], s24 offen offset:512 sc1
    s_add_u32 s24, s24, 524288
    s_waitcnt lgkmcnt(5)
    v_mfma_f32_32x32x16_bf16 v[80:95], v[44:47], a[76:79], v[80:95]
    ds_read_b128 v[36:39], v25 offset:24576
    s_waitcnt lgkmcnt(5)
    v_mfma_f32_32x32x16_bf16 v[80:95], v[48:51], a[80:83], v[80:95]
    ds_read_b128 v[40:43], v26 offset:24576
    s_waitcnt lgkmcnt(5)
    v_mfma_f32_32x32x16_bf16 v[80:95], v[52:55], a[84:87], v[80:95]
    ds_read_b128 v[44:47], v27 offset:24576
    s_waitcnt lgkmcnt(5)
    v_mfma_f32_32x32x16_bf16 v[80:95], v[56:59], a[88:91], v[80:95]
    ds_read_b128 v[48:51], v28 offset:24576
    s_waitcnt lgkmcnt(5)
    v_mfma_f32_32x32x16_bf16 v[80:95], v[60:63], a[92:95], v[80:95]
    ds_read_b128 v[52:55], v29 offset:24576
    s_waitcnt vmcnt(8)
    s_barrier
    s_waitcnt lgkmcnt(5)
    v_mfma_f32_32x32x16_bf16 v[80:95], v[32:35], a[96:99], v[80:95]
    ds_read_b128 v[56:59], v30 offset:24576
    s_waitcnt lgkmcnt(5)
    v_mfma_f32_32x32x16_bf16 v[80:95], v[36:39], a[100:103], v[80:95]
    ds_read_b128 v[60:63], v31 offset:24576
    s_add_u32 m0, s21, 32768
    s_xor_b32 s20, s23, 1024
    buffer_load_dwordx4 v6, s[8:11], s20 offen lds
    s_waitcnt lgkmcnt(5)
    v_mfma_f32_32x32x16_bf16 v[80:95], v[40:43], a[104:107], v[80:95]
    ds_read_b128 v[32:35], v24 offset:32768
    s_waitcnt lgkmcnt(5)
    v_mfma_f32_32x32x16_bf16 v[80:95], v[44:47], a[108:111], v[80:95]
    ds_read_b128 v[36:39], v25 offset:32768
    s_waitcnt lgkmcnt(5)
    v_mfma_f32_32x32x16_bf16 v[80:95], v[48:51], a[112:115], v[80:95]
    ds_read_b128 v[40:43], v26 offset:32768
    s_add_u32 m0, s21, 33792
    s_xor_b32 s20, s23, 1024
    buffer_load_dwordx4 v7, s[8:11], s20 offen lds
    s_waitcnt lgkmcnt(5)
    v_mfma_f32_32x32x16_bf16 v[80:95], v[52:55], a[116:119], v[80:95]
    ds_read_b128 v[44:47], v27 offset:32768
    s_waitcnt lgkmcnt(5)
    v_mfma_f32_32x32x16_bf16 v[80:95], v[56:59], a[120:123], v[80:95]
    ds_read_b128 v[48:51], v28 offset:32768
    s_waitcnt lgkmcnt(5)
    v_mfma_f32_32x32x16_bf16 v[80:95], v[60:63], a[124:127], v[80:95]
    ds_read_b128 v[52:55], v29 offset:32768
    s_add_u32 m0, s21, 40960
    s_xor_b32 s20, s23, 1280
    buffer_load_dwordx4 v6, s[8:11], s20 offen lds
    s_waitcnt lgkmcnt(5)
    v_mfma_f32_32x32x16_bf16 v[80:95], v[32:35], a[128:131], v[80:95]
    ds_read_b128 v[56:59], v30 offset:32768
    s_waitcnt lgkmcnt(5)
    v_mfma_f32_32x32x16_bf16 v[80:95], v[36:39], a[132:135], v[80:95]
    ds_read_b128 v[60:63], v31 offset:32768
    s_waitcnt lgkmcnt(5)
    v_mfma_f32_32x32x16_bf16 v[80:95], v[40:43], a[136:139], v[80:95]
    ds_read_b128 v[32:35], v24 offset:40960
    s_add_u32 m0, s21, 41984
    s_xor_b32 s20, s23, 1280
    buffer_load_dwordx4 v7, s[8:11], s20 offen lds
    s_waitcnt lgkmcnt(5)
    v_mfma_f32_32x32x16_bf16 v[80:95], v[44:47], a[140:143], v[80:95]
    ds_read_b128 v[36:39], v25 offset:40960
    s_waitcnt lgkmcnt(5)
    v_mfma_f32_32x32x16_bf16 v[80:95], v[48:51], a[144:147], v[80:95]
    ds_read_b128 v[40:43], v26 offset:40960
    s_waitcnt lgkmcnt(5)
    v_mfma_f32_32x32x16_bf16 v[80:95], v[52:55], a[148:151], v[80:95]
    ds_read_b128 v[44:47], v27 offset:40960
    s_add_u32 m0, s21, 49152
    s_xor_b32 s20, s23, 1536
    buffer_load_dwordx4 v6, s[8:11], s20 offen lds
    s_waitcnt lgkmcnt(5)
    v_mfma_f32_32x32x16_bf16 v[80:95], v[56:59], a[152:155], v[80:95]
    ds_read_b128 v[48:51], v28 offset:40960
    s_waitcnt lgkmcnt(5)
    v_mfma_f32_32x32x16_bf16 v[80:95], v[60:63], a[156:159], v[80:95]
    ds_read_b128 v[52:55], v29 offset:40960
    s_waitcnt lgkmcnt(5)
    v_mfma_f32_32x32x16_bf16 v[80:95], v[32:35], a[160:163], v[80:95]
    ds_read_b128 v[56:59], v30 offset:40960
    s_add_u32 m0, s21, 50176
    s_xor_b32 s20, s23, 1536
    buffer_load_dwordx4 v7, s[8:11], s20 offen lds
    s_waitcnt lgkmcnt(5)
    v_mfma_f32_32x32x16_bf16 v[80:95], v[36:39], a[164:167], v[80:95]
    ds_read_b128 v[60:63], v31 offset:40960
    s_waitcnt lgkmcnt(5)
    v_mfma_f32_32x32x16_bf16 v[80:95], v[40:43], a[168:171], v[80:95]
    ds_read_b128 v[32:35], v24 offset:49152
    s_waitcnt lgkmcnt(5)
    v_mfma_f32_32x32x16_bf16 v[80:95], v[44:47], a[172:175], v[80:95]
    ds_read_b128 v[36:39], v25 offset:49152
    s_add_u32 m0, s21, 57344
    s_xor_b32 s20, s23, 1792
    buffer_load_dwordx4 v6, s[8:11], s20 offen lds
    s_waitcnt lgkmcnt(5)
    v_mfma_f32_32x32x16_bf16 v[80:95], v[48:51], a[176:179], v[80:95]
    ds_read_b128 v[40:43], v26 offset:49152
    s_waitcnt lgkmcnt(5)
    v_mfma_f32_32x32x16_bf16 v[80:95], v[52:55], a[180:183], v[80:95]
    ds_read_b128 v[44:47], v27 offset:49152
    s_waitcnt lgkmcnt(5)
    v_mfma_f32_32x32x16_bf16 v[80:95], v[56:59], a[184:187], v[80:95]
    ds_read_b128 v[48:51], v28 offset:49152
    s_add_u32 m0, s21, 58368
    s_xor_b32 s20, s23, 1792
    buffer_load_dwordx4 v7, s[8:11], s20 offen lds
    s_waitcnt lgkmcnt(5)
    v_mfma_f32_32x32x16_bf16 v[80:95], v[60:63], a[188:191], v[80:95]
    ds_read_b128 v[52:55], v29 offset:49152
    s_waitcnt lgkmcnt(5)
    v_mfma_f32_32x32x16_bf16 v[80:95], v[32:35], a[192:195], v[80:95]
    ds_read_b128 v[56:59], v30 offset:49152
    s_waitcnt lgkmcnt(5)
    v_mfma_f32_32x32x16_bf16 v[80:95], v[36:39], a[196:199], v[80:95]
    ds_read_b128 v[60:63], v31 offset:49152
    s_waitcnt lgkmcnt(5)
    v_mfma_f32_32x32x16_bf16 v[80:95], v[40:43], a[200:203], v[80:95]
    ds_read_b128 v[32:35], v24 offset:57344
    s_waitcnt lgkmcnt(5)
    v_mfma_f32_32x32x16_bf16 v[80:95], v[44:47], a[204:207], v[80:95]
    ds_read_b128 v[36:39], v25 offset:57344
    s_waitcnt lgkmcnt(5)
    v_mfma_f32_32x32x16_bf16 v[80:95], v[48:51], a[208:211], v[80:95]
    ds_read_b128 v[40:43], v26 offset:57344
    s_waitcnt lgkmcnt(5)
    v_mfma_f32_32x32x16_bf16 v[80:95], v[52:55], a[212:215], v[80:95]
    ds_read_b128 v[44:47], v27 offset:57344
    s_waitcnt lgkmcnt(5)
    v_mfma_f32_32x32x16_bf16 v[80:95], v[56:59], a[216:219], v[80:95]
    ds_read_b128 v[48:51], v28 offset:57344
    s_waitcnt lgkmcnt(5)
    v_mfma_f32_32x32x16_bf16 v[80:95], v[60:63], a[220:223], v[80:95]
    ds_read_b128 v[52:55], v29 offset:57344
    s_waitcnt vmcnt(8)
    s_barrier
    s_waitcnt lgkmcnt(5)
    v_mfma_f32_32x32x16_bf16 v[80:95], v[32:35], a[224:227], v[80:95]
    ds_read_b128 v[56:59], v30 offset:57344
    s_waitcnt lgkmcnt(5)
    v_mfma_f32_32x32x16_bf16 v[80:95], v[36:39], a[228:231], v[80:95]
    ds_read_b128 v[60:63], v31 offset:57344
    s_add_u32 s23, s23, 131072
    s_add_u32 m0, s21, 65536
    s_xor_b32 s20, s23, 0
    buffer_load_dwordx4 v6, s[8:11], s20 offen lds
    s_waitcnt lgkmcnt(5)
    v_mfma_f32_32x32x16_bf16 v[80:95], v[40:43], a[232:235], v[80:95]
    ds_read_b128 v[32:35], v16 offset:0
    v_add_u32 v10, 1, v10
    buffer_store_dword v10, v9, s[84:87], 0 offen sc1
    s_waitcnt lgkmcnt(5)
    v_mfma_f32_32x32x16_bf16 v[80:95], v[44:47], a[236:239], v[80:95]
    ds_read_b128 v[36:39], v17 offset:0
    s_waitcnt lgkmcnt(5)
    v_mfma_f32_32x32x16_bf16 v[80:95], v[48:51], a[240:243], v[80:95]
    ds_read_b128 v[40:43], v18 offset:0
    s_add_u32 m0, s21, 66560
    s_xor_b32 s20, s23, 0
    buffer_load_dwordx4 v7, s[8:11], s20 offen lds
    s_waitcnt lgkmcnt(5)
    v_mfma_f32_32x32x16_bf16 v[80:95], v[52:55], a[244:247], v[80:95]
    ds_read_b128 v[44:47], v19 offset:0
    s_waitcnt lgkmcnt(5)
    v_mfma_f32_32x32x16_bf16 v[80:95], v[56:59], a[248:251], v[80:95]
    ds_read_b128 v[48:51], v20 offset:0
    s_waitcnt lgkmcnt(5)
    v_mfma_f32_32x32x16_bf16 v[80:95], v[60:63], a[252:255], v[80:95]
    ds_read_b128 v[52:55], v21 offset:0
    s_add_u32 m0, s21, 73728
    s_xor_b32 s20, s23, 256
    buffer_load_dwordx4 v6, s[8:11], s20 offen lds
    s_add_u32 s25, s25, 1
    s_cmp_lt_u32 s25, 16
    s_cbranch_scc1 mega_kernel_q_v_loop
    s_nop 11
    v_cvt_pk_bf16_f32 v96, v80, v81
    v_cvt_pk_bf16_f32 v97, v82, v83
    v_cvt_pk_bf16_f32 v98, v88, v89
    v_cvt_pk_bf16_f32 v99, v90, v91
    buffer_store_dwordx4 v[96:99], v8, s[84:87], s24 offen offset:0 sc1
    v_cvt_pk_bf16_f32 v100, v84, v85
    v_cvt_pk_bf16_f32 v101, v86, v87
    v_cvt_pk_bf16_f32 v102, v92, v93
    v_cvt_pk_bf16_f32 v103, v94, v95
    buffer_store_dwordx4 v[100:103], v8, s[84:87], s24 offen offset:512 sc1
    s_add_u32 s24, s24, 524288
    s_waitcnt vmcnt(0) lgkmcnt(0)
    s_barrier
    v_add_u32 v10, 1, v10
    buffer_store_dword v10, v9, s[84:87], 0 offen sc1
mega_kernel_q_done:
    s_load_dwordx2 s[52:53], s[0:1], 40
    v_and_b32 v202, 63, v0
    s_and_b32 s58, s92, 31
    v_lshrrev_b32 v200, 2, v202
    v_lshlrev_b32 v200, 11, v200
    v_and_b32 v203, 3, v202
    v_lshl_add_u32 v200, v203, 4, v200
    s_lshl_b32 s56, s98, 21
    s_lshl_b32 s57, s58, 6
    s_add_u32 s56, s56, s57
    v_add_u32 v200, s56, v200
    s_lshl_b32 s56, s98, 14
    s_add_u32 s56, s56, 81920
    s_lshr_b32 s57, s58, 1
    s_lshl_b32 s57, s57, 12
    v_lshrrev_b32 v201, 5, v202
    v_bfe_u32 v204, v202, 2, 2
    v_lshl_add_u32 v201, v201, 3, v204
    v_lshlrev_b32 v201, 6, v201
    v_bfe_u32 v204, v202, 4, 1
    v_lshl_add_u32 v201, v204, 5, v201
    v_lshl_add_u32 v201, v203, 3, v201
    v_add_u32 v201, s56, v201
    s_waitcnt lgkmcnt(0)
    s_mov_b32 s54, 8388608
    s_mov_b32 s55, 0x00020000
    s_add_u32 m0, s56, 0
    s_add_u32 s58, s57, 0
    s_and_b32 s58, s58, 0xffff
    s_lshl_b32 s58, s58, 5
    buffer_load_dwordx4 v200, s[52:55], s58 offen lds
    s_add_u32 m0, s56, 1024
    s_add_u32 s58, s57, 1024
    s_and_b32 s58, s58, 0xffff
    s_lshl_b32 s58, s58, 5
    buffer_load_dwordx4 v200, s[52:55], s58 offen lds
    s_add_u32 m0, s56, 2048
    s_add_u32 s58, s57, 2048
    s_and_b32 s58, s58, 0xffff
    s_lshl_b32 s58, s58, 5
    buffer_load_dwordx4 v200, s[52:55], s58 offen lds
    s_add_u32 m0, s56, 3072
    s_add_u32 s58, s57, 3072
    s_and_b32 s58, s58, 0xffff
    s_lshl_b32 s58, s58, 5
    buffer_load_dwordx4 v200, s[52:55], s58 offen lds
    s_add_u32 m0, s56, 4096
    s_add_u32 s58, s57, 4096
    s_and_b32 s58, s58, 0xffff
    s_lshl_b32 s58, s58, 5
    buffer_load_dwordx4 v200, s[52:55], s58 offen lds
    s_add_u32 m0, s56, 5120
    s_add_u32 s58, s57, 5120
    s_and_b32 s58, s58, 0xffff
    s_lshl_b32 s58, s58, 5
    buffer_load_dwordx4 v200, s[52:55], s58 offen lds
    s_add_u32 m0, s56, 6144
    s_add_u32 s58, s57, 6144
    s_and_b32 s58, s58, 0xffff
    s_lshl_b32 s58, s58, 5
    buffer_load_dwordx4 v200, s[52:55], s58 offen lds
    s_add_u32 m0, s56, 7168
    s_add_u32 s58, s57, 7168
    s_and_b32 s58, s58, 0xffff
    s_lshl_b32 s58, s58, 5
    buffer_load_dwordx4 v200, s[52:55], s58 offen lds
    s_add_u32 m0, s56, 8192
    s_add_u32 s58, s57, 8192
    s_and_b32 s58, s58, 0xffff
    s_lshl_b32 s58, s58, 5
    buffer_load_dwordx4 v200, s[52:55], s58 offen lds
    s_add_u32 m0, s56, 9216
    s_add_u32 s58, s57, 9216
    s_and_b32 s58, s58, 0xffff
    s_lshl_b32 s58, s58, 5
    buffer_load_dwordx4 v200, s[52:55], s58 offen lds
    s_add_u32 m0, s56, 10240
    s_add_u32 s58, s57, 10240
    s_and_b32 s58, s58, 0xffff
    s_lshl_b32 s58, s58, 5
    buffer_load_dwordx4 v200, s[52:55], s58 offen lds
    s_add_u32 m0, s56, 11264
    s_add_u32 s58, s57, 11264
    s_and_b32 s58, s58, 0xffff
    s_lshl_b32 s58, s58, 5
    buffer_load_dwordx4 v200, s[52:55], s58 offen lds
    s_add_u32 m0, s56, 12288
    s_add_u32 s58, s57, 12288
    s_and_b32 s58, s58, 0xffff
    s_lshl_b32 s58, s58, 5
    buffer_load_dwordx4 v200, s[52:55], s58 offen lds
    s_add_u32 m0, s56, 13312
    s_add_u32 s58, s57, 13312
    s_and_b32 s58, s58, 0xffff
    s_lshl_b32 s58, s58, 5
    buffer_load_dwordx4 v200, s[52:55], s58 offen lds
    s_add_u32 m0, s56, 14336
    s_add_u32 s58, s57, 14336
    s_and_b32 s58, s58, 0xffff
    s_lshl_b32 s58, s58, 5
    buffer_load_dwordx4 v200, s[52:55], s58 offen lds
    s_add_u32 m0, s56, 15360
    s_add_u32 s58, s57, 15360
    s_and_b32 s58, s58, 0xffff
    s_lshl_b32 s58, s58, 5
    buffer_load_dwordx4 v200, s[52:55], s58 offen lds
    s_cmp_lt_u32 s92, 128
    s_cbranch_scc1 mega_kernel_f1
    s_sub_u32 s99, s92, 128
mega_kernel_f0l:
    s_barrier
    s_load_dwordx2 s[4:5], s[0:1], 64
    s_load_dwordx2 s[8:9], s[0:1], 72
    s_load_dwordx2 s[12:13], s[0:1], 96
    s_and_b32 s16, s99, 31
    s_lshr_b32 s17, s99, 5
    v_and_b32 v1, 63, v0
    v_lshrrev_b32 v2, 6, v0
    s_waitcnt lgkmcnt(0)
    s_mov_b32 s6, 2101248
    s_mov_b32 s7, 0x00020000
    s_mov_b32 s10, 2101248
    s_mov_b32 s11, 0x00020000
    s_add_u32 s12, s12, 121634816
    s_addc_u32 s13, s13, 0
    s_mov_b32 s14, 4202496
    s_mov_b32 s15, 0x00020000
    s_lshl_b32 s18, s16, 6
    v_add_u32 v3, s18, v2
    s_movk_i32 s19, 1026
    v_mul_lo_u32 v3, v3, s19
    s_lshl_b32 s18, s17, 7
    v_add_u32 v3, s18, v3
    v_lshl_add_u32 v3, v1, 1, v3
    s_mov_b32 s18, 0
    buffer_load_ushort v16, v3, s[4:7], s18 offen
    buffer_load_ushort v32, v3, s[8:11], s18 offen
    s_mov_b32 s18, 4104
    buffer_load_ushort v17, v3, s[4:7], s18 offen
    buffer_load_ushort v33, v3, s[8:11], s18 offen
    s_mov_b32 s18, 8208
    buffer_load_ushort v18, v3, s[4:7], s18 offen
    buffer_load_ushort v34, v3, s[8:11], s18 offen
    s_mov_b32 s18, 12312
    buffer_load_ushort v19, v3, s[4:7], s18 offen
    buffer_load_ushort v35, v3, s[8:11], s18 offen
    s_mov_b32 s18, 16416
    buffer_load_ushort v20, v3, s[4:7], s18 offen
    buffer_load_ushort v36, v3, s[8:11], s18 offen
    s_mov_b32 s18, 20520
    buffer_load_ushort v21, v3, s[4:7], s18 offen
    buffer_load_ushort v37, v3, s[8:11], s18 offen
    s_mov_b32 s18, 24624
    buffer_load_ushort v22, v3, s[4:7], s18 offen
    buffer_load_ushort v38, v3, s[8:11], s18 offen
    s_mov_b32 s18, 28728
    buffer_load_ushort v23, v3, s[4:7], s18 offen
    buffer_load_ushort v39, v3, s[8:11], s18 offen
    s_mov_b32 s18, 32832
    buffer_load_ushort v24, v3, s[4:7], s18 offen
    buffer_load_ushort v40, v3, s[8:11], s18 offen
    s_mov_b32 s18, 36936
    buffer_load_ushort v25, v3, s[4:7], s18 offen
    buffer_load_ushort v41, v3, s[8:11], s18 offen
    s_mov_b32 s18, 41040
    buffer_load_ushort v26, v3, s[4:7], s18 offen
    buffer_load_ushort v42, v3, s[8:11], s18 offen
    s_mov_b32 s18, 45144
    buffer_load_ushort v27, v3, s[4:7], s18 offen
    buffer_load_ushort v43, v3, s[8:11], s18 offen
    s_mov_b32 s18, 49248
    buffer_load_ushort v28, v3, s[4:7], s18 offen
    buffer_load_ushort v44, v3, s[8:11], s18 offen
    s_mov_b32 s18, 53352
    buffer_load_ushort v29, v3, s[4:7], s18 offen
    buffer_load_ushort v45, v3, s[8:11], s18 offen
    s_mov_b32 s18, 57456
    buffer_load_ushort v30, v3, s[4:7], s18 offen
    buffer_load_ushort v46, v3, s[8:11], s18 offen
    s_mov_b32 s18, 61560
    buffer_load_ushort v31, v3, s[4:7], s18 offen
    buffer_load_ushort v47, v3, s[8:11], s18 offen
    v_mul_u32_u24 v4, 65, v1
    v_add_u32 v4, v4, v2
    v_lshlrev_b32 v4, 2, v4
    s_waitcnt vmcnt(0)
    v_lshl_or_b32 v16, v32, 16, v16
    ds_write_b32 v4, v16 offset:0
    v_lshl_or_b32 v17, v33, 16, v17
    ds_write_b32 v4, v17 offset:16
    v_lshl_or_b32 v18, v34, 16, v18
    ds_write_b32 v4, v18 offset:32
    v_lshl_or_b32 v19, v35, 16, v19
    ds_write_b32 v4, v19 offset:48
    v_lshl_or_b32 v20, v36, 16, v20
    ds_write_b32 v4, v20 offset:64
    v_lshl_or_b32 v21, v37, 16, v21
    ds_write_b32 v4, v21 offset:80
    v_lshl_or_b32 v22, v38, 16, v22
    ds_write_b32 v4, v22 offset:96
    v_lshl_or_b32 v23, v39, 16, v23
    ds_write_b32 v4, v23 offset:112
    v_lshl_or_b32 v24, v40, 16, v24
    ds_write_b32 v4, v24 offset:128
    v_lshl_or_b32 v25, v41, 16, v25
    ds_write_b32 v4, v25 offset:144
    v_lshl_or_b32 v26, v42, 16, v26
    ds_write_b32 v4, v26 offset:160
    v_lshl_or_b32 v27, v43, 16, v27
    ds_write_b32 v4, v27 offset:176
    v_lshl_or_b32 v28, v44, 16, v28
    ds_write_b32 v4, v28 offset:192
    v_lshl_or_b32 v29, v45, 16, v29
    ds_write_b32 v4, v29 offset:208
    v_lshl_or_b32 v30, v46, 16, v30
    ds_write_b32 v4, v30 offset:224
    v_lshl_or_b32 v31, v47, 16, v31
    ds_write_b32 v4, v31 offset:240
    v_lshrrev_b32 v7, 4, v0
    v_and_b32 v8, 15, v0
    v_mul_u32_u24 v5, 65, v7
    v_lshl_add_u32 v5, v8, 2, v5
    v_lshlrev_b32 v5, 2, v5
    s_waitcnt lgkmcnt(0)
    s_barrier
    ds_read_b32 v16, v5 offset:0
    ds_read_b32 v17, v5 offset:4
    ds_read_b32 v18, v5 offset:8
    ds_read_b32 v19, v5 offset:12
    ds_read_b32 v20, v5 offset:4160
    ds_read_b32 v21, v5 offset:4164
    ds_read_b32 v22, v5 offset:4168
    ds_read_b32 v23, v5 offset:4172
    ds_read_b32 v24, v5 offset:8320
    ds_read_b32 v25, v5 offset:8324
    ds_read_b32 v26, v5 offset:8328
    ds_read_b32 v27, v5 offset:8332
    ds_read_b32 v28, v5 offset:12480
    ds_read_b32 v29, v5 offset:12484
    ds_read_b32 v30, v5 offset:12488
    ds_read_b32 v31, v5 offset:12492
    s_lshl_b32 s18, s17, 6
    v_add_u32 v6, s18, v7
    v_lshlrev_b32 v6, 13, v6
    s_lshl_b32 s18, s16, 8
    v_add_u32 v6, s18, v6
    v_lshl_add_u32 v6, v8, 4, v6
    s_waitcnt lgkmcnt(0)
    s_mov_b32 s18, 0
    buffer_store_dwordx4 v[16:19], v6, s[12:15], s18 offen sc1
    s_mov_b32 s18, 131072
    buffer_store_dwordx4 v[20:23], v6, s[12:15], s18 offen sc1
    s_mov_b32 s18, 262144
    buffer_store_dwordx4 v[24:27], v6, s[12:15], s18 offen sc1
    s_mov_b32 s18, 393216
    buffer_store_dwordx4 v[28:31], v6, s[12:15], s18 offen sc1
    s_add_u32 s99, s99, 64
    s_cmp_lt_u32 s99, 288
    s_cbranch_scc1 mega_kernel_f0l
    s_branch mega_kernel_f1d
mega_kernel_f1:
    s_barrier
    s_load_dwordx2 s[4:5], s[0:1], 56
    s_load_dwordx2 s[8:9], s[0:1], 96
    v_and_b32 v1, 31, v0
    v_lshrrev_b32 v2, 5, v0
    v_cvt_f32_u32 v3, v1
    s_waitcnt lgkmcnt(0)
    s_mov_b32 s6, 4194304
    s_mov_b32 s7, 0x00020000
    s_mov_b32 s10, 268435456
    s_mov_b32 s11, 0x00020000
    s_lshl_b32 s12, s92, 15
    v_lshlrev_b32 v6, 12, v2
    v_lshl_add_u32 v6, v1, 1, v6
    buffer_load_ushort v16, v6, s[4:7], s12 offen offset:0
    buffer_load_ushort v48, v6, s[4:7], s12 offen offset:2048
    buffer_load_ushort v17, v6, s[4:7], s12 offen offset:64
    buffer_load_ushort v49, v6, s[4:7], s12 offen offset:2112
    buffer_load_ushort v18, v6, s[4:7], s12 offen offset:128
    buffer_load_ushort v50, v6, s[4:7], s12 offen offset:2176
    buffer_load_ushort v19, v6, s[4:7], s12 offen offset:192
    buffer_load_ushort v51, v6, s[4:7], s12 offen offset:2240
    buffer_load_ushort v20, v6, s[4:7], s12 offen offset:256
    buffer_load_ushort v52, v6, s[4:7], s12 offen offset:2304
    buffer_load_ushort v21, v6, s[4:7], s12 offen offset:320
    buffer_load_ushort v53, v6, s[4:7], s12 offen offset:2368
    buffer_load_ushort v22, v6, s[4:7], s12 offen offset:384
    buffer_load_ushort v54, v6, s[4:7], s12 offen offset:2432
    buffer_load_ushort v23, v6, s[4:7], s12 offen offset:448
    buffer_load_ushort v55, v6, s[4:7], s12 offen offset:2496
    buffer_load_ushort v24, v6, s[4:7], s12 offen offset:512
    buffer_load_ushort v56, v6, s[4:7], s12 offen offset:2560
    buffer_load_ushort v25, v6, s[4:7], s12 offen offset:576
    buffer_load_ushort v57, v6, s[4:7], s12 offen offset:2624
    buffer_load_ushort v26, v6, s[4:7], s12 offen offset:640
    buffer_load_ushort v58, v6, s[4:7], s12 offen offset:2688
    buffer_load_ushort v27, v6, s[4:7], s12 offen offset:704
    buffer_load_ushort v59, v6, s[4:7], s12 offen offset:2752
    buffer_load_ushort v28, v6, s[4:7], s12 offen offset:768
    buffer_load_ushort v60, v6, s[4:7], s12 offen offset:2816
    buffer_load_ushort v29, v6, s[4:7], s12 offen offset:832
    buffer_load_ushort v61, v6, s[4:7], s12 offen offset:2880
    buffer_load_ushort v30, v6, s[4:7], s12 offen offset:896
    buffer_load_ushort v62, v6, s[4:7], s12 offen offset:2944
    buffer_load_ushort v31, v6, s[4:7], s12 offen offset:960
    buffer_load_ushort v63, v6, s[4:7], s12 offen offset:3008
    buffer_load_ushort v32, v6, s[4:7], s12 offen offset:1024
    buffer_load_ushort v64, v6, s[4:7], s12 offen offset:3072
    buffer_load_ushort v33, v6, s[4:7], s12 offen offset:1088
    buffer_load_ushort v65, v6, s[4:7], s12 offen offset:3136
    buffer_load_ushort v34, v6, s[4:7], s12 offen offset:1152
    buffer_load_ushort v66, v6, s[4:7], s12 offen offset:3200
    buffer_load_ushort v35, v6, s[4:7], s12 offen offset:1216
    buffer_load_ushort v67, v6, s[4:7], s12 offen offset:3264
    buffer_load_ushort v36, v6, s[4:7], s12 offen offset:1280
    buffer_load_ushort v68, v6, s[4:7], s12 offen offset:3328
    buffer_load_ushort v37, v6, s[4:7], s12 offen offset:1344
    buffer_load_ushort v69, v6, s[4:7], s12 offen offset:3392
    buffer_load_ushort v38, v6, s[4:7], s12 offen offset:1408
    buffer_load_ushort v70, v6, s[4:7], s12 offen offset:3456
    buffer_load_ushort v39, v6, s[4:7], s12 offen offset:1472
    buffer_load_ushort v71, v6, s[4:7], s12 offen offset:3520
    buffer_load_ushort v40, v6, s[4:7], s12 offen offset:1536
    buffer_load_ushort v72, v6, s[4:7], s12 offen offset:3584
    buffer_load_ushort v41, v6, s[4:7], s12 offen offset:1600
    buffer_load_ushort v73, v6, s[4:7], s12 offen offset:3648
    buffer_load_ushort v42, v6, s[4:7], s12 offen offset:1664
    buffer_load_ushort v74, v6, s[4:7], s12 offen offset:3712
    buffer_load_ushort v43, v6, s[4:7], s12 offen offset:1728
    buffer_load_ushort v75, v6, s[4:7], s12 offen offset:3776
    buffer_load_ushort v44, v6, s[4:7], s12 offen offset:1792
    buffer_load_ushort v76, v6, s[4:7], s12 offen offset:3840
    buffer_load_ushort v45, v6, s[4:7], s12 offen offset:1856
    buffer_load_ushort v77, v6, s[4:7], s12 offen offset:3904
    buffer_load_ushort v46, v6, s[4:7], s12 offen offset:1920
    buffer_load_ushort v78, v6, s[4:7], s12 offen offset:3968
    buffer_load_ushort v47, v6, s[4:7], s12 offen offset:1984
    buffer_load_ushort v79, v6, s[4:7], s12 offen offset:4032
    s_movk_i32 s13, 8448
    v_mul_lo_u32 v7, v2, s13
    v_lshl_add_u32 v4, v1, 3, v7
    s_movk_i32 s13, 264
    v_mul_lo_u32 v5, v1, s13
    v_add_u32 v5, v5, v7
    s_waitcnt vmcnt(0)
    v_lshlrev_b32 v16, 16, v16
    v_lshlrev_b32 v48, 16, v48
    v_lshlrev_b32 v17, 16, v17
    v_lshlrev_b32 v49, 16, v49
    v_lshlrev_b32 v18, 16, v18
    v_lshlrev_b32 v50, 16, v50
    v_lshlrev_b32 v19, 16, v19
    v_lshlrev_b32 v51, 16, v51
    v_lshlrev_b32 v20, 16, v20
    v_lshlrev_b32 v52, 16, v52
    v_lshlrev_b32 v21, 16, v21
    v_lshlrev_b32 v53, 16, v53
    v_lshlrev_b32 v22, 16, v22
    v_lshlrev_b32 v54, 16, v54
    v_lshlrev_b32 v23, 16, v23
    v_lshlrev_b32 v55, 16, v55
    v_lshlrev_b32 v24, 16, v24
    v_lshlrev_b32 v56, 16, v56
    v_lshlrev_b32 v25, 16, v25
    v_lshlrev_b32 v57, 16, v57
    v_lshlrev_b32 v26, 16, v26
    v_lshlrev_b32 v58, 16, v58
    v_lshlrev_b32 v27, 16, v27
    v_lshlrev_b32 v59, 16, v59
    v_lshlrev_b32 v28, 16, v28
    v_lshlrev_b32 v60, 16, v60
    v_lshlrev_b32 v29, 16, v29
    v_lshlrev_b32 v61, 16, v61
    v_lshlrev_b32 v30, 16, v30
    v_lshlrev_b32 v62, 16, v62
    v_lshlrev_b32 v31, 16, v31
    v_lshlrev_b32 v63, 16, v63
    v_lshlrev_b32 v32, 16, v32
    v_lshlrev_b32 v64, 16, v64
    v_lshlrev_b32 v33, 16, v33
    v_lshlrev_b32 v65, 16, v65
    v_lshlrev_b32 v34, 16, v34
    v_lshlrev_b32 v66, 16, v66
    v_lshlrev_b32 v35, 16, v35
    v_lshlrev_b32 v67, 16, v67
    v_lshlrev_b32 v36, 16, v36
    v_lshlrev_b32 v68, 16, v68
    v_lshlrev_b32 v37, 16, v37
    v_lshlrev_b32 v69, 16, v69
    v_lshlrev_b32 v38, 16, v38
    v_lshlrev_b32 v70, 16, v70
    v_lshlrev_b32 v39, 16, v39
    v_lshlrev_b32 v71, 16, v71
    v_lshlrev_b32 v40, 16, v40
    v_lshlrev_b32 v72, 16, v72
    v_lshlrev_b32 v41, 16, v41
    v_lshlrev_b32 v73, 16, v73
    v_lshlrev_b32 v42, 16, v42
    v_lshlrev_b32 v74, 16, v74
    v_lshlrev_b32 v43, 16, v43
    v_lshlrev_b32 v75, 16, v75
    v_lshlrev_b32 v44, 16, v44
    v_lshlrev_b32 v76, 16, v76
    v_lshlrev_b32 v45, 16, v45
    v_lshlrev_b32 v77, 16, v77
    v_lshlrev_b32 v46, 16, v46
    v_lshlrev_b32 v78, 16, v78
    v_lshlrev_b32 v47, 16, v47
    v_lshlrev_b32 v79, 16, v79
    v_sub_f32 v80, v16, v32
    v_sub_f32 v81, v48, v64
    v_add_f32 v16, v16, v32
    v_add_f32 v48, v48, v64
    v_sub_f32 v32, v17, v33
    v_sub_f32 v64, v49, v65
    v_add_f32 v17, v17, v33
    v_add_f32 v49, v49, v65
    v_mul_f32 v33, 0x3f7b14be, v32
    v_mul_f32 v65, 0xbe47c5c2, v32
    v_fmac_f32 v33, 0x3e47c5c2, v64
    v_fmac_f32 v65, 0x3f7b14be, v64
    v_sub_f32 v32, v18, v34
    v_sub_f32 v64, v50, v66
    v_add_f32 v18, v18, v34
    v_add_f32 v50, v50, v66
    v_mul_f32 v34, 0x3f6c835e, v32
    v_mul_f32 v66, 0xbec3ef15, v32
    v_fmac_f32 v34, 0x3ec3ef15, v64
    v_fmac_f32 v66, 0x3f6c835e, v64
    v_sub_f32 v32, v19, v35
    v_sub_f32 v64, v51, v67
    v_add_f32 v19, v19, v35
    v_add_f32 v51, v51, v67
    v_mul_f32 v35, 0x3f54db31, v32
    v_mul_f32 v67, 0xbf0e39da, v32
    v_fmac_f32 v35, 0x3f0e39da, v64
    v_fmac_f32 v67, 0x3f54db31, v64
    v_sub_f32 v32, v20, v36
    v_sub_f32 v64, v52, v68
    v_add_f32 v20, v20, v36
    v_add_f32 v52, v52, v68
    v_mul_f32 v36, 0x3f3504f3, v32
    v_mul_f32 v68, 0xbf3504f3, v32
    v_fmac_f32 v36, 0x3f3504f3, v64
    v_fmac_f32 v68, 0x3f3504f3, v64
    v_sub_f32 v32, v21, v37
    v_sub_f32 v64, v53, v69
    v_add_f32 v21, v21, v37
    v_add_f32 v53, v53, v69
    v_mul_f32 v37, 0x3f0e39da, v32
    v_mul_f32 v69, 0xbf54db31, v32
    v_fmac_f32 v37, 0x3f54db31, v64
    v_fmac_f32 v69, 0x3f0e39da, v64
    v_sub_f32 v32, v22, v38
    v_sub_f32 v64, v54, v70
    v_add_f32 v22, v22, v38
    v_add_f32 v54, v54, v70
    v_mul_f32 v38, 0x3ec3ef15, v32
    v_mul_f32 v70, 0xbf6c835e, v32
    v_fmac_f32 v38, 0x3f6c835e, v64
    v_fmac_f32 v70, 0x3ec3ef15, v64
    v_sub_f32 v32, v23, v39
    v_sub_f32 v64, v55, v71
    v_add_f32 v23, v23, v39
    v_add_f32 v55, v55, v71
    v_mul_f32 v39, 0x3e47c5c2, v32
    v_mul_f32 v71, 0xbf7b14be, v32
    v_fmac_f32 v39, 0x3f7b14be, v64
    v_fmac_f32 v71, 0x3e47c5c2, v64
    v_sub_f32 v32, v56, v72
    v_sub_f32 v64, v40, v24
    v_add_f32 v24, v24, v40
    v_add_f32 v56, v56, v72
    v_sub_f32 v40, v25, v41
    v_sub_f32 v72, v57, v73
    v_add_f32 v25, v25, v41
    v_add_f32 v57, v57, v73
    v_mul_f32 v41, 0xbe47c5c2, v40
    v_mul_f32 v73, 0xbf7b14be, v40
    v_fmac_f32 v41, 0x3f7b14be, v72
    v_fmac_f32 v73, 0xbe47c5c2, v72
    v_sub_f32 v40, v26, v42
    v_sub_f32 v72, v58, v74
    v_add_f32 v26, v26, v42
    v_add_f32 v58, v58, v74
    v_mul_f32 v42, 0xbec3ef15, v40
    v_mul_f32 v74, 0xbf6c835e, v40
    v_fmac_f32 v42, 0x3f6c835e, v72
    v_fmac_f32 v74, 0xbec3ef15, v72
    v_sub_f32 v40, v27, v43
    v_sub_f32 v72, v59, v75
    v_add_f32 v27, v27, v43
    v_add_f32 v59, v59, v75
    v_mul_f32 v43, 0xbf0e39da, v40
    v_mul_f32 v75, 0xbf54db31, v40
    v_fmac_f32 v43, 0x3f54db31, v72
    v_fmac_f32 v75, 0xbf0e39da, v72
    v_sub_f32 v40, v28, v44
    v_sub_f32 v72, v60, v76
    v_add_f32 v28, v28, v44
    v_add_f32 v60, v60, v76
    v_mul_f32 v44, 0xbf3504f3, v40
    v_mul_f32 v76, 0xbf3504f3, v40
    v_fmac_f32 v44, 0x3f3504f3, v72
    v_fmac_f32 v76, 0xbf3504f3, v72
    v_sub_f32 v40, v29, v45
    v_sub_f32 v72, v61, v77
    v_add_f32 v29, v29, v45
    v_add_f32 v61, v61, v77
    v_mul_f32 v45, 0xbf54db31, v40
    v_mul_f32 v77, 0xbf0e39da, v40
    v_fmac_f32 v45, 0x3f0e39da, v72
    v_fmac_f32 v77, 0xbf54db31, v72
    v_sub_f32 v40, v30, v46
    v_sub_f32 v72, v62, v78
    v_add_f32 v30, v30, v46
    v_add_f32 v62, v62, v78
    v_mul_f32 v46, 0xbf6c835e, v40
    v_mul_f32 v78, 0xbec3ef15, v40
    v_fmac_f32 v46, 0x3ec3ef15, v72
    v_fmac_f32 v78, 0xbf6c835e, v72
    v_sub_f32 v40, v31, v47
    v_sub_f32 v72, v63, v79
    v_add_f32 v31, v31, v47
    v_add_f32 v63, v63, v79
    v_mul_f32 v47, 0xbf7b14be, v40
    v_mul_f32 v79, 0xbe47c5c2, v40
    v_fmac_f32 v47, 0x3e47c5c2, v72
    v_fmac_f32 v79, 0xbf7b14be, v72
    v_sub_f32 v40, v16, v24
    v_sub_f32 v72, v48, v56
    v_add_f32 v16, v16, v24
    v_add_f32 v48, v48, v56
    v_sub_f32 v24, v17, v25
    v_sub_f32 v56, v49, v57
    v_add_f32 v17, v17, v25
    v_add_f32 v49, v49, v57
    v_mul_f32 v25, 0x3f6c835e, v24
    v_mul_f32 v57, 0xbec3ef15, v24
    v_fmac_f32 v25, 0x3ec3ef15, v56
    v_fmac_f32 v57, 0x3f6c835e, v56
    v_sub_f32 v24, v18, v26
    v_sub_f32 v56, v50, v58
    v_add_f32 v18, v18, v26
    v_add_f32 v50, v50, v58
    v_mul_f32 v26, 0x3f3504f3, v24
    v_mul_f32 v58, 0xbf3504f3, v24
    v_fmac_f32 v26, 0x3f3504f3, v56
    v_fmac_f32 v58, 0x3f3504f3, v56
    v_sub_f32 v24, v19, v27
    v_sub_f32 v56, v51, v59
    v_add_f32 v19, v19, v27
    v_add_f32 v51, v51, v59
    v_mul_f32 v27, 0x3ec3ef15, v24
    v_mul_f32 v59, 0xbf6c835e, v24
    v_fmac_f32 v27, 0x3f6c835e, v56
    v_fmac_f32 v59, 0x3ec3ef15, v56
    v_sub_f32 v24, v52, v60
    v_sub_f32 v56, v28, v20
    v_add_f32 v20, v20, v28
    v_add_f32 v52, v52, v60
    v_sub_f32 v28, v21, v29
    v_sub_f32 v60, v53, v61
    v_add_f32 v21, v21, v29
    v_add_f32 v53, v53, v61
    v_mul_f32 v29, 0xbec3ef15, v28
    v_mul_f32 v61, 0xbf6c835e, v28
    v_fmac_f32 v29, 0x3f6c835e, v60
    v_fmac_f32 v61, 0xbec3ef15, v60
    v_sub_f32 v28, v22, v30
    v_sub_f32 v60, v54, v62
    v_add_f32 v22, v22, v30
    v_add_f32 v54, v54, v62
    v_mul_f32 v30, 0xbf3504f3, v28
    v_mul_f32 v62, 0xbf3504f3, v28
    v_fmac_f32 v30, 0x3f3504f3, v60
    v_fmac_f32 v62, 0xbf3504f3, v60
    v_sub_f32 v28, v23, v31
    v_sub_f32 v60, v55, v63
    v_add_f32 v23, v23, v31
    v_add_f32 v55, v55, v63
    v_mul_f32 v31, 0xbf6c835e, v28
    v_mul_f32 v63, 0xbec3ef15, v28
    v_fmac_f32 v31, 0x3ec3ef15, v60
    v_fmac_f32 v63, 0xbf6c835e, v60
    v_sub_f32 v28, v80, v32
    v_sub_f32 v60, v81, v64
    v_add_f32 v80, v80, v32
    v_add_f32 v81, v81, v64
    v_sub_f32 v32, v33, v41
    v_sub_f32 v64, v65, v73
    v_add_f32 v33, v33, v41
    v_add_f32 v65, v65, v73
    v_mul_f32 v41, 0x3f6c835e, v32
    v_mul_f32 v73, 0xbec3ef15, v32
    v_fmac_f32 v41, 0x3ec3ef15, v64
    v_fmac_f32 v73, 0x3f6c835e, v64
    v_sub_f32 v32, v34, v42
    v_sub_f32 v64, v66, v74
    v_add_f32 v34, v34, v42
    v_add_f32 v66, v66, v74
    v_mul_f32 v42, 0x3f3504f3, v32
    v_mul_f32 v74, 0xbf3504f3, v32
    v_fmac_f32 v42, 0x3f3504f3, v64
    v_fmac_f32 v74, 0x3f3504f3, v64
    v_sub_f32 v32, v35, v43
    v_sub_f32 v64, v67, v75
    v_add_f32 v35, v35, v43
    v_add_f32 v67, v67, v75
    v_mul_f32 v43, 0x3ec3ef15, v32
    v_mul_f32 v75, 0xbf6c835e, v32
    v_fmac_f32 v43, 0x3f6c835e, v64
    v_fmac_f32 v75, 0x3ec3ef15, v64
    v_sub_f32 v32, v68, v76
    v_sub_f32 v64, v44, v36
    v_add_f32 v36, v36, v44
    v_add_f32 v68, v68, v76
    v_sub_f32 v44, v37, v45
    v_sub_f32 v76, v69, v77
    v_add_f32 v37, v37, v45
    v_add_f32 v69, v69, v77
    v_mul_f32 v45, 0xbec3ef15, v44
    v_mul_f32 v77, 0xbf6c835e, v44
    v_fmac_f32 v45, 0x3f6c835e, v76
    v_fmac_f32 v77, 0xbec3ef15, v76
    v_sub_f32 v44, v38, v46
    v_sub_f32 v76, v70, v78
    v_add_f32 v38, v38, v46
    v_add_f32 v70, v70, v78
    v_mul_f32 v46, 0xbf3504f3, v44
    v_mul_f32 v78, 0xbf3504f3, v44
    v_fmac_f32 v46, 0x3f3504f3, v76
    v_fmac_f32 v78, 0xbf3504f3, v76
    v_sub_f32 v44, v39, v47
    v_sub_f32 v76, v71, v79
    v_add_f32 v39, v39, v47
    v_add_f32 v71, v71, v79
    v_mul_f32 v47, 0xbf6c835e, v44
    v_mul_f32 v79, 0xbec3ef15, v44
    v_fmac_f32 v47, 0x3ec3ef15, v76
    v_fmac_f32 v79, 0xbf6c835e, v76
    v_sub_f32 v44, v16, v20
    v_sub_f32 v76, v48, v52
    v_add_f32 v16, v16, v20
    v_add_f32 v48, v48, v52
    v_sub_f32 v20, v17, v21
    v_sub_f32 v52, v49, v53
    v_add_f32 v17, v17, v21
    v_add_f32 v49, v49, v53
    v_mul_f32 v21, 0x3f3504f3, v20
    v_mul_f32 v53, 0xbf3504f3, v20
    v_fmac_f32 v21, 0x3f3504f3, v52
    v_fmac_f32 v53, 0x3f3504f3, v52
    v_sub_f32 v20, v50, v54
    v_sub_f32 v52, v22, v18
    v_add_f32 v18, v18, v22
    v_add_f32 v50, v50, v54
    v_sub_f32 v22, v19, v23
    v_sub_f32 v54, v51, v55
    v_add_f32 v19, v19, v23
    v_add_f32 v51, v51, v55
    v_mul_f32 v23, 0xbf3504f3, v22
    v_mul_f32 v55, 0xbf3504f3, v22
    v_fmac_f32 v23, 0x3f3504f3, v54
    v_fmac_f32 v55, 0xbf3504f3, v54
    v_sub_f32 v22, v40, v24
    v_sub_f32 v54, v72, v56
    v_add_f32 v40, v40, v24
    v_add_f32 v72, v72, v56
    v_sub_f32 v24, v25, v29
    v_sub_f32 v56, v57, v61
    v_add_f32 v25, v25, v29
    v_add_f32 v57, v57, v61
    v_mul_f32 v29, 0x3f3504f3, v24
    v_mul_f32 v61, 0xbf3504f3, v24
    v_fmac_f32 v29, 0x3f3504f3, v56
    v_fmac_f32 v61, 0x3f3504f3, v56
    v_sub_f32 v24, v58, v62
    v_sub_f32 v56, v30, v26
    v_add_f32 v26, v26, v30
    v_add_f32 v58, v58, v62
    v_sub_f32 v30, v27, v31
    v_sub_f32 v62, v59, v63
    v_add_f32 v27, v27, v31
    v_add_f32 v59, v59, v63
    v_mul_f32 v31, 0xbf3504f3, v30
    v_mul_f32 v63, 0xbf3504f3, v30
    v_fmac_f32 v31, 0x3f3504f3, v62
    v_fmac_f32 v63, 0xbf3504f3, v62
    v_sub_f32 v30, v80, v36
    v_sub_f32 v62, v81, v68
    v_add_f32 v80, v80, v36
    v_add_f32 v81, v81, v68
    v_sub_f32 v36, v33, v37
    v_sub_f32 v68, v65, v69
    v_add_f32 v33, v33, v37
    v_add_f32 v65, v65, v69
    v_mul_f32 v37, 0x3f3504f3, v36
    v_mul_f32 v69, 0xbf3504f3, v36
    v_fmac_f32 v37, 0x3f3504f3, v68
    v_fmac_f32 v69, 0x3f3504f3, v68
    v_sub_f32 v36, v66, v70
    v_sub_f32 v68, v38, v34
    v_add_f32 v34, v34, v38
    v_add_f32 v66, v66, v70
    v_sub_f32 v38, v35, v39
    v_sub_f32 v70, v67, v71
    v_add_f32 v35, v35, v39
    v_add_f32 v67, v67, v71
    v_mul_f32 v39, 0xbf3504f3, v38
    v_mul_f32 v71, 0xbf3504f3, v38
    v_fmac_f32 v39, 0x3f3504f3, v70
    v_fmac_f32 v71, 0xbf3504f3, v70
    v_sub_f32 v38, v28, v32
    v_sub_f32 v70, v60, v64
    v_add_f32 v28, v28, v32
    v_add_f32 v60, v60, v64
    v_sub_f32 v32, v41, v45
    v_sub_f32 v64, v73, v77
    v_add_f32 v41, v41, v45
    v_add_f32 v73, v73, v77
    v_mul_f32 v45, 0x3f3504f3, v32
    v_mul_f32 v77, 0xbf3504f3, v32
    v_fmac_f32 v45, 0x3f3504f3, v64
    v_fmac_f32 v77, 0x3f3504f3, v64
    v_sub_f32 v32, v74, v78
    v_sub_f32 v64, v46, v42
    v_add_f32 v42, v42, v46
    v_add_f32 v74, v74, v78
    v_sub_f32 v46, v43, v47
    v_sub_f32 v78, v75, v79
    v_add_f32 v43, v43, v47
    v_add_f32 v75, v75, v79
    v_mul_f32 v47, 0xbf3504f3, v46
    v_mul_f32 v79, 0xbf3504f3, v46
    v_fmac_f32 v47, 0x3f3504f3, v78
    v_fmac_f32 v79, 0xbf3504f3, v78
    v_sub_f32 v46, v16, v18
    v_sub_f32 v78, v48, v50
    v_add_f32 v16, v16, v18
    v_add_f32 v48, v48, v50
    v_sub_f32 v18, v49, v51
    v_sub_f32 v50, v19, v17
    v_add_f32 v17, v17, v19
    v_add_f32 v49, v49, v51
    v_sub_f32 v19, v44, v20
    v_sub_f32 v51, v76, v52
    v_add_f32 v44, v44, v20
    v_add_f32 v76, v76, v52
    v_sub_f32 v20, v53, v55
    v_sub_f32 v52, v23, v21
    v_add_f32 v21, v21, v23
    v_add_f32 v53, v53, v55
    v_sub_f32 v23, v40, v26
    v_sub_f32 v55, v72, v58
    v_add_f32 v40, v40, v26
    v_add_f32 v72, v72, v58
    v_sub_f32 v26, v57, v59
    v_sub_f32 v58, v27, v25
    v_add_f32 v25, v25, v27
    v_add_f32 v57, v57, v59
    v_sub_f32 v27, v22, v24
    v_sub_f32 v59, v54, v56
    v_add_f32 v22, v22, v24
    v_add_f32 v54, v54, v56
    v_sub_f32 v24, v61, v63
    v_sub_f32 v56, v31, v29
    v_add_f32 v29, v29, v31
    v_add_f32 v61, v61, v63
    v_sub_f32 v31, v80, v34
    v_sub_f32 v63, v81, v66
    v_add_f32 v80, v80, v34
    v_add_f32 v81, v81, v66
    v_sub_f32 v34, v65, v67
    v_sub_f32 v66, v35, v33
    v_add_f32 v33, v33, v35
    v_add_f32 v65, v65, v67
    v_sub_f32 v35, v30, v36
    v_sub_f32 v67, v62, v68
    v_add_f32 v30, v30, v36
    v_add_f32 v62, v62, v68
    v_sub_f32 v36, v69, v71
    v_sub_f32 v68, v39, v37
    v_add_f32 v37, v37, v39
    v_add_f32 v69, v69, v71
    v_sub_f32 v39, v28, v42
    v_sub_f32 v71, v60, v74
    v_add_f32 v28, v28, v42
    v_add_f32 v60, v60, v74
    v_sub_f32 v42, v73, v75
    v_sub_f32 v74, v43, v41
    v_add_f32 v41, v41, v43
    v_add_f32 v73, v73, v75
    v_sub_f32 v43, v38, v32
    v_sub_f32 v75, v70, v64
    v_add_f32 v38, v38, v32
    v_add_f32 v70, v70, v64
    v_sub_f32 v32, v77, v79
    v_sub_f32 v64, v47, v45
    v_add_f32 v45, v45, v47
    v_add_f32 v77, v77, v79
    v_sub_f32 v47, v16, v17
    v_sub_f32 v79, v48, v49
    v_add_f32 v16, v16, v17
    v_add_f32 v48, v48, v49
    v_sub_f32 v17, v46, v18
    v_sub_f32 v49, v78, v50
    v_add_f32 v46, v46, v18
    v_add_f32 v78, v78, v50
    v_sub_f32 v18, v44, v21
    v_sub_f32 v50, v76, v53
    v_add_f32 v44, v44, v21
    v_add_f32 v76, v76, v53
    v_sub_f32 v21, v19, v20
    v_sub_f32 v53, v51, v52
    v_add_f32 v19, v19, v20
    v_add_f32 v51, v51, v52
    v_sub_f32 v20, v40, v25
    v_sub_f32 v52, v72, v57
    v_add_f32 v40, v40, v25
    v_add_f32 v72, v72, v57
    v_sub_f32 v25, v23, v26
    v_sub_f32 v57, v55, v58
    v_add_f32 v23, v23, v26
    v_add_f32 v55, v55, v58
    v_sub_f32 v26, v22, v29
    v_sub_f32 v58, v54, v61
    v_add_f32 v22, v22, v29
    v_add_f32 v54, v54, v61
    v_sub_f32 v29, v27, v24
    v_sub_f32 v61, v59, v56
    v_add_f32 v27, v27, v24
    v_add_f32 v59, v59, v56
    v_sub_f32 v24, v80, v33
    v_sub_f32 v56, v81, v65
    v_add_f32 v80, v80, v33
    v_add_f32 v81, v81, v65
    v_sub_f32 v33, v31, v34
    v_sub_f32 v65, v63, v66
    v_add_f32 v31, v31, v34
    v_add_f32 v63, v63, v66
    v_sub_f32 v34, v30, v37
    v_sub_f32 v66, v62, v69
    v_add_f32 v30, v30, v37
    v_add_f32 v62, v62, v69
    v_sub_f32 v37, v35, v36
    v_sub_f32 v69, v67, v68
    v_add_f32 v35, v35, v36
    v_add_f32 v67, v67, v68
    v_sub_f32 v36, v28, v41
    v_sub_f32 v68, v60, v73
    v_add_f32 v28, v28, v41
    v_add_f32 v60, v60, v73
    v_sub_f32 v41, v39, v42
    v_sub_f32 v73, v71, v74
    v_add_f32 v39, v39, v42
    v_add_f32 v71, v71, v74
    v_sub_f32 v42, v38, v45
    v_sub_f32 v74, v70, v77
    v_add_f32 v38, v38, v45
    v_add_f32 v70, v70, v77
    v_sub_f32 v45, v43, v32
    v_sub_f32 v77, v75, v64
    v_add_f32 v43, v43, v32
    v_add_f32 v75, v75, v64
    v_mul_f32 v32, 0xba800000, v3
    v_cos_f32 v64, v32
    v_sin_f32 v82, v32
    s_nop 0
    v_mul_f32 v83, v80, v64
    v_fma_f32 v83, -v81, v82, v83
    v_mul_f32 v81, v81, v64
    v_fmac_f32 v81, v80, v82
    v_mul_f32 v32, 0xbb000000, v3
    v_cos_f32 v64, v32
    v_sin_f32 v82, v32
    s_nop 0
    v_mul_f32 v80, v40, v64
    v_fma_f32 v80, -v72, v82, v80
    v_mul_f32 v72, v72, v64
    v_fmac_f32 v72, v40, v82
    v_mul_f32 v32, 0xbb400000, v3
    v_cos_f32 v64, v32
    v_sin_f32 v82, v32
    s_nop 0
    v_mul_f32 v40, v28, v64
    v_fma_f32 v40, -v60, v82, v40
    v_mul_f32 v60, v60, v64
    v_fmac_f32 v60, v28, v82
    v_mul_f32 v32, 0xbb800000, v3
    v_cos_f32 v64, v32
    v_sin_f32 v82, v32
    s_nop 0
    v_mul_f32 v28, v44, v64
    v_fma_f32 v28, -v76, v82, v28
    v_mul_f32 v76, v76, v64
    v_fmac_f32 v76, v44, v82
    v_mul_f32 v32, 0xbba00000, v3
    v_cos_f32 v64, v32
    v_sin_f32 v82, v32
    s_nop 0
    v_mul_f32 v44, v30, v64
    v_fma_f32 v44, -v62, v82, v44
    v_mul_f32 v62, v62, v64
    v_fmac_f32 v62, v30, v82
    v_mul_f32 v32, 0xbbc00000, v3
    v_cos_f32 v64, v32
    v_sin_f32 v82, v32
    s_nop 0
    v_mul_f32 v30, v22, v64
    v_fma_f32 v30, -v54, v82, v30
    v_mul_f32 v54, v54, v64
    v_fmac_f32 v54, v22, v82
    v_mul_f32 v32, 0xbbe00000, v3
    v_cos_f32 v64, v32
    v_sin_f32 v82, v32
    s_nop 0
    v_mul_f32 v22, v38, v64
    v_fma_f32 v22, -v70, v82, v22
    v_mul_f32 v70, v70, v64
    v_fmac_f32 v70, v38, v82
    v_mul_f32 v32, 0xbc000000, v3
    v_cos_f32 v64, v32
    v_sin_f32 v82, v32
    s_nop 0
    v_mul_f32 v38, v46, v64
    v_fma_f32 v38, -v78, v82, v38
    v_mul_f32 v78, v78, v64
    v_fmac_f32 v78, v46, v82
    v_mul_f32 v32, 0xbc100000, v3
    v_cos_f32 v64, v32
    v_sin_f32 v82, v32
    s_nop 0
    v_mul_f32 v46, v31, v64
    v_fma_f32 v46, -v63, v82, v46
    v_mul_f32 v63, v63, v64
    v_fmac_f32 v63, v31, v82
    v_mul_f32 v32, 0xbc200000, v3
    v_cos_f32 v64, v32
    v_sin_f32 v82, v32
    s_nop 0
    v_mul_f32 v31, v23, v64
    v_fma_f32 v31, -v55, v82, v31
    v_mul_f32 v55, v55, v64
    v_fmac_f32 v55, v23, v82
    v_mul_f32 v32, 0xbc300000, v3
    v_cos_f32 v64, v32
    v_sin_f32 v82, v32
    s_nop 0
    v_mul_f32 v23, v39, v64
    v_fma_f32 v23, -v71, v82, v23
    v_mul_f32 v71, v71, v64
    v_fmac_f32 v71, v39, v82
    v_mul_f32 v32, 0xbc400000, v3
    v_cos_f32 v64, v32
    v_sin_f32 v82, v32
    s_nop 0
    v_mul_f32 v39, v19, v64
    v_fma_f32 v39, -v51, v82, v39
    v_mul_f32 v51, v51, v64
    v_fmac_f32 v51, v19, v82
    v_mul_f32 v32, 0xbc500000, v3
    v_cos_f32 v64, v32
    v_sin_f32 v82, v32
    s_nop 0
    v_mul_f32 v19, v35, v64
    v_fma_f32 v19, -v67, v82, v19
    v_mul_f32 v67, v67, v64
    v_fmac_f32 v67, v35, v82
    v_mul_f32 v32, 0xbc600000, v3
    v_cos_f32 v64, v32
    v_sin_f32 v82, v32
    s_nop 0
    v_mul_f32 v35, v27, v64
    v_fma_f32 v35, -v59, v82, v35
    v_mul_f32 v59, v59, v64
    v_fmac_f32 v59, v27, v82
    v_mul_f32 v32, 0xbc700000, v3
    v_cos_f32 v64, v32
    v_sin_f32 v82, v32
    s_nop 0
    v_mul_f32 v27, v43, v64
    v_fma_f32 v27, -v75, v82, v27
    v_mul_f32 v75, v75, v64
    v_fmac_f32 v75, v43, v82
    v_mul_f32 v32, 0xbc800000, v3
    v_cos_f32 v64, v32
    v_sin_f32 v82, v32
    s_nop 0
    v_mul_f32 v43, v47, v64
    v_fma_f32 v43, -v79, v82, v43
    v_mul_f32 v79, v79, v64
    v_fmac_f32 v79, v47, v82
    v_mul_f32 v32, 0xbc880000, v3
    v_cos_f32 v64, v32
    v_sin_f32 v82, v32
    s_nop 0
    v_mul_f32 v47, v24, v64
    v_fma_f32 v47, -v56, v82, v47
    v_mul_f32 v56, v56, v64
    v_fmac_f32 v56, v24, v82
    v_mul_f32 v32, 0xbc900000, v3
    v_cos_f32 v64, v32
    v_sin_f32 v82, v32
    s_nop 0
    v_mul_f32 v24, v20, v64
    v_fma_f32 v24, -v52, v82, v24
    v_mul_f32 v52, v52, v64
    v_fmac_f32 v52, v20, v82
    v_mul_f32 v32, 0xbc980000, v3
    v_cos_f32 v64, v32
    v_sin_f32 v82, v32
    s_nop 0
    v_mul_f32 v20, v36, v64
    v_fma_f32 v20, -v68, v82, v20
    v_mul_f32 v68, v68, v64
    v_fmac_f32 v68, v36, v82
    v_mul_f32 v32, 0xbca00000, v3
    v_cos_f32 v64, v32
    v_sin_f32 v82, v32
    s_nop 0
    v_mul_f32 v36, v18, v64
    v_fma_f32 v36, -v50, v82, v36
    v_mul_f32 v50, v50, v64
    v_fmac_f32 v50, v18, v82
    v_mul_f32 v32, 0xbca80000, v3
    v_cos_f32 v64, v32
    v_sin_f32 v82, v32
    s_nop 0
    v_mul_f32 v18, v34, v64
    v_fma_f32 v18, -v66, v82, v18
    v_mul_f32 v66, v66, v64
    v_fmac_f32 v66, v34, v82
    v_mul_f32 v32, 0xbcb00000, v3
    v_cos_f32 v64, v32
    v_sin_f32 v82, v32
    s_nop 0
    v_mul_f32 v34, v26, v64
    v_fma_f32 v34, -v58, v82, v34
    v_mul_f32 v58, v58, v64
    v_fmac_f32 v58, v26, v82
    v_mul_f32 v32, 0xbcb80000, v3
    v_cos_f32 v64, v32
    v_sin_f32 v82, v32
    s_nop 0
    v_mul_f32 v26, v42, v64
    v_fma_f32 v26, -v74, v82, v26
    v_mul_f32 v74, v74, v64
    v_fmac_f32 v74, v42, v82
    v_mul_f32 v32, 0xbcc00000, v3
    v_cos_f32 v64, v32
    v_sin_f32 v82, v32
    s_nop 0
    v_mul_f32 v42, v17, v64
    v_fma_f32 v42, -v49, v82, v42
    v_mul_f32 v49, v49, v64
    v_fmac_f32 v49, v17, v82
    v_mul_f32 v32, 0xbcc80000, v3
    v_cos_f32 v64, v32
    v_sin_f32 v82, v32
    s_nop 0
    v_mul_f32 v17, v33, v64
    v_fma_f32 v17, -v65, v82, v17
    v_mul_f32 v65, v65, v64
    v_fmac_f32 v65, v33, v82
    v_mul_f32 v32, 0xbcd00000, v3
    v_cos_f32 v64, v32
    v_sin_f32 v82, v32
    s_nop 0
    v_mul_f32 v33, v25, v64
    v_fma_f32 v33, -v57, v82, v33
    v_mul_f32 v57, v57, v64
    v_fmac_f32 v57, v25, v82
    v_mul_f32 v32, 0xbcd80000, v3
    v_cos_f32 v64, v32
    v_sin_f32 v82, v32
    s_nop 0
    v_mul_f32 v25, v41, v64
    v_fma_f32 v25, -v73, v82, v25
    v_mul_f32 v73, v73, v64
    v_fmac_f32 v73, v41, v82
    v_mul_f32 v32, 0xbce00000, v3
    v_cos_f32 v64, v32
    v_sin_f32 v82, v32
    s_nop 0
    v_mul_f32 v41, v21, v64
    v_fma_f32 v41, -v53, v82, v41
    v_mul_f32 v53, v53, v64
    v_fmac_f32 v53, v21, v82
    v_mul_f32 v32, 0xbce80000, v3
    v_cos_f32 v64, v32
    v_sin_f32 v82, v32
    s_nop 0
    v_mul_f32 v21, v37, v64
    v_fma_f32 v21, -v69, v82, v21
    v_mul_f32 v69, v69, v64
    v_fmac_f32 v69, v37, v82
    v_mul_f32 v32, 0xbcf00000, v3
    v_cos_f32 v64, v32
    v_sin_f32 v82, v32
    s_nop 0
    v_mul_f32 v37, v29, v64
    v_fma_f32 v37, -v61, v82, v37
    v_mul_f32 v61, v61, v64
    v_fmac_f32 v61, v29, v82
    v_mul_f32 v32, 0xbcf80000, v3
    v_cos_f32 v64, v32
    v_sin_f32 v82, v32
    s_nop 0
    v_mul_f32 v29, v45, v64
    v_fma_f32 v29, -v77, v82, v29
    v_mul_f32 v77, v77, v64
    v_fmac_f32 v77, v45, v82
    ds_write_b32 v4, v16 offset:0
    ds_write_b32 v4, v48 offset:4
    ds_write_b32 v4, v83 offset:264
    ds_write_b32 v4, v81 offset:268
    ds_write_b32 v4, v80 offset:528
    ds_write_b32 v4, v72 offset:532
    ds_write_b32 v4, v40 offset:792
    ds_write_b32 v4, v60 offset:796
    ds_write_b32 v4, v28 offset:1056
    ds_write_b32 v4, v76 offset:1060
    ds_write_b32 v4, v44 offset:1320
    ds_write_b32 v4, v62 offset:1324
    ds_write_b32 v4, v30 offset:1584
    ds_write_b32 v4, v54 offset:1588
    ds_write_b32 v4, v22 offset:1848
    ds_write_b32 v4, v70 offset:1852
    ds_write_b32 v4, v38 offset:2112
    ds_write_b32 v4, v78 offset:2116
    ds_write_b32 v4, v46 offset:2376
    ds_write_b32 v4, v63 offset:2380
    ds_write_b32 v4, v31 offset:2640
    ds_write_b32 v4, v55 offset:2644
    ds_write_b32 v4, v23 offset:2904
    ds_write_b32 v4, v71 offset:2908
    ds_write_b32 v4, v39 offset:3168
    ds_write_b32 v4, v51 offset:3172
    ds_write_b32 v4, v19 offset:3432
    ds_write_b32 v4, v67 offset:3436
    ds_write_b32 v4, v35 offset:3696
    ds_write_b32 v4, v59 offset:3700
    ds_write_b32 v4, v27 offset:3960
    ds_write_b32 v4, v75 offset:3964
    ds_write_b32 v4, v43 offset:4224
    ds_write_b32 v4, v79 offset:4228
    ds_write_b32 v4, v47 offset:4488
    ds_write_b32 v4, v56 offset:4492
    ds_write_b32 v4, v24 offset:4752
    ds_write_b32 v4, v52 offset:4756
    ds_write_b32 v4, v20 offset:5016
    ds_write_b32 v4, v68 offset:5020
    ds_write_b32 v4, v36 offset:5280
    ds_write_b32 v4, v50 offset:5284
    ds_write_b32 v4, v18 offset:5544
    ds_write_b32 v4, v66 offset:5548
    ds_write_b32 v4, v34 offset:5808
    ds_write_b32 v4, v58 offset:5812
    ds_write_b32 v4, v26 offset:6072
    ds_write_b32 v4, v74 offset:6076
    ds_write_b32 v4, v42 offset:6336
    ds_write_b32 v4, v49 offset:6340
    ds_write_b32 v4, v17 offset:6600
    ds_write_b32 v4, v65 offset:6604
    ds_write_b32 v4, v33 offset:6864
    ds_write_b32 v4, v57 offset:6868
    ds_write_b32 v4, v25 offset:7128
    ds_write_b32 v4, v73 offset:7132
    ds_write_b32 v4, v41 offset:7392
    ds_write_b32 v4, v53 offset:7396
    ds_write_b32 v4, v21 offset:7656
    ds_write_b32 v4, v69 offset:7660
    ds_write_b32 v4, v37 offset:7920
    ds_write_b32 v4, v61 offset:7924
    ds_write_b32 v4, v29 offset:8184
    ds_write_b32 v4, v77 offset:8188
    s_waitcnt lgkmcnt(0)
    ds_read_b32 v16, v5 offset:0
    ds_read_b32 v48, v5 offset:4
    ds_read_b32 v83, v5 offset:8
    ds_read_b32 v81, v5 offset:12
    ds_read_b32 v80, v5 offset:16
    ds_read_b32 v72, v5 offset:20
    ds_read_b32 v40, v5 offset:24
    ds_read_b32 v60, v5 offset:28
    ds_read_b32 v28, v5 offset:32
    ds_read_b32 v76, v5 offset:36
    ds_read_b32 v44, v5 offset:40
    ds_read_b32 v62, v5 offset:44
    ds_read_b32 v30, v5 offset:48
    ds_read_b32 v54, v5 offset:52
    s_waitcnt lgkmcnt(0)
    ds_read_b32 v22, v5 offset:56
    ds_read_b32 v70, v5 offset:60
    ds_read_b32 v38, v5 offset:64
    ds_read_b32 v78, v5 offset:68
    ds_read_b32 v46, v5 offset:72
    ds_read_b32 v63, v5 offset:76
    ds_read_b32 v31, v5 offset:80
    ds_read_b32 v55, v5 offset:84
    ds_read_b32 v23, v5 offset:88
    ds_read_b32 v71, v5 offset:92
    ds_read_b32 v39, v5 offset:96
    ds_read_b32 v51, v5 offset:100
    ds_read_b32 v19, v5 offset:104
    ds_read_b32 v67, v5 offset:108
    s_waitcnt lgkmcnt(0)
    ds_read_b32 v35, v5 offset:112
    ds_read_b32 v59, v5 offset:116
    ds_read_b32 v27, v5 offset:120
    ds_read_b32 v75, v5 offset:124
    ds_read_b32 v43, v5 offset:128
    ds_read_b32 v79, v5 offset:132
    ds_read_b32 v47, v5 offset:136
    ds_read_b32 v56, v5 offset:140
    ds_read_b32 v24, v5 offset:144
    ds_read_b32 v52, v5 offset:148
    ds_read_b32 v20, v5 offset:152
    ds_read_b32 v68, v5 offset:156
    ds_read_b32 v36, v5 offset:160
    ds_read_b32 v50, v5 offset:164
    s_waitcnt lgkmcnt(0)
    ds_read_b32 v18, v5 offset:168
    ds_read_b32 v66, v5 offset:172
    ds_read_b32 v34, v5 offset:176
    ds_read_b32 v58, v5 offset:180
    ds_read_b32 v26, v5 offset:184
    ds_read_b32 v74, v5 offset:188
    ds_read_b32 v42, v5 offset:192
    ds_read_b32 v49, v5 offset:196
    ds_read_b32 v17, v5 offset:200
    ds_read_b32 v65, v5 offset:204
    ds_read_b32 v33, v5 offset:208
    ds_read_b32 v57, v5 offset:212
    ds_read_b32 v25, v5 offset:216
    ds_read_b32 v73, v5 offset:220
    s_waitcnt lgkmcnt(0)
    ds_read_b32 v41, v5 offset:224
    ds_read_b32 v53, v5 offset:228
    ds_read_b32 v21, v5 offset:232
    ds_read_b32 v69, v5 offset:236
    ds_read_b32 v37, v5 offset:240
    ds_read_b32 v61, v5 offset:244
    ds_read_b32 v29, v5 offset:248
    ds_read_b32 v77, v5 offset:252
    s_waitcnt lgkmcnt(0)
    v_sub_f32 v32, v16, v43
    v_sub_f32 v64, v48, v79
    v_add_f32 v16, v16, v43
    v_add_f32 v48, v48, v79
    v_sub_f32 v43, v83, v47
    v_sub_f32 v79, v81, v56
    v_add_f32 v83, v83, v47
    v_add_f32 v81, v81, v56
    v_mul_f32 v47, 0x3f7b14be, v43
    v_mul_f32 v56, 0xbe47c5c2, v43
    v_fmac_f32 v47, 0x3e47c5c2, v79
    v_fmac_f32 v56, 0x3f7b14be, v79
    v_sub_f32 v43, v80, v24
    v_sub_f32 v79, v72, v52
    v_add_f32 v80, v80, v24
    v_add_f32 v72, v72, v52
    v_mul_f32 v24, 0x3f6c835e, v43
    v_mul_f32 v52, 0xbec3ef15, v43
    v_fmac_f32 v24, 0x3ec3ef15, v79
    v_fmac_f32 v52, 0x3f6c835e, v79
    v_sub_f32 v43, v40, v20
    v_sub_f32 v79, v60, v68
    v_add_f32 v40, v40, v20
    v_add_f32 v60, v60, v68
    v_mul_f32 v20, 0x3f54db31, v43
    v_mul_f32 v68, 0xbf0e39da, v43
    v_fmac_f32 v20, 0x3f0e39da, v79
    v_fmac_f32 v68, 0x3f54db31, v79
    v_sub_f32 v43, v28, v36
    v_sub_f32 v79, v76, v50
    v_add_f32 v28, v28, v36
    v_add_f32 v76, v76, v50
    v_mul_f32 v36, 0x3f3504f3, v43
    v_mul_f32 v50, 0xbf3504f3, v43
    v_fmac_f32 v36, 0x3f3504f3, v79
    v_fmac_f32 v50, 0x3f3504f3, v79
    v_sub_f32 v43, v44, v18
    v_sub_f32 v79, v62, v66
    v_add_f32 v44, v44, v18
    v_add_f32 v62, v62, v66
    v_mul_f32 v18, 0x3f0e39da, v43
    v_mul_f32 v66, 0xbf54db31, v43
    v_fmac_f32 v18, 0x3f54db31, v79
    v_fmac_f32 v66, 0x3f0e39da, v79
    v_sub_f32 v43, v30, v34
    v_sub_f32 v79, v54, v58
    v_add_f32 v30, v30, v34
    v_add_f32 v54, v54, v58
    v_mul_f32 v34, 0x3ec3ef15, v43
    v_mul_f32 v58, 0xbf6c835e, v43
    v_fmac_f32 v34, 0x3f6c835e, v79
    v_fmac_f32 v58, 0x3ec3ef15, v79
    v_sub_f32 v43, v22, v26
    v_sub_f32 v79, v70, v74
    v_add_f32 v22, v22, v26
    v_add_f32 v70, v70, v74
    v_mul_f32 v26, 0x3e47c5c2, v43
    v_mul_f32 v74, 0xbf7b14be, v43
    v_fmac_f32 v26, 0x3f7b14be, v79
    v_fmac_f32 v74, 0x3e47c5c2, v79
    v_sub_f32 v43, v78, v49
    v_sub_f32 v79, v42, v38
    v_add_f32 v38, v38, v42
    v_add_f32 v78, v78, v49
    v_sub_f32 v42, v46, v17
    v_sub_f32 v49, v63, v65
    v_add_f32 v46, v46, v17
    v_add_f32 v63, v63, v65
    v_mul_f32 v17, 0xbe47c5c2, v42
    v_mul_f32 v65, 0xbf7b14be, v42
    v_fmac_f32 v17, 0x3f7b14be, v49
    v_fmac_f32 v65, 0xbe47c5c2, v49
    v_sub_f32 v42, v31, v33
    v_sub_f32 v49, v55, v57
    v_add_f32 v31, v31, v33
    v_add_f32 v55, v55, v57
    v_mul_f32 v33, 0xbec3ef15, v42
    v_mul_f32 v57, 0xbf6c835e, v42
    v_fmac_f32 v33, 0x3f6c835e, v49
    v_fmac_f32 v57, 0xbec3ef15, v49
    v_sub_f32 v42, v23, v25
    v_sub_f32 v49, v71, v73
    v_add_f32 v23, v23, v25
    v_add_f32 v71, v71, v73
    v_mul_f32 v25, 0xbf0e39da, v42
    v_mul_f32 v73, 0xbf54db31, v42
    v_fmac_f32 v25, 0x3f54db31, v49
    v_fmac_f32 v73, 0xbf0e39da, v49
    v_sub_f32 v42, v39, v41
    v_sub_f32 v49, v51, v53
    v_add_f32 v39, v39, v41
    v_add_f32 v51, v51, v53
    v_mul_f32 v41, 0xbf3504f3, v42
    v_mul_f32 v53, 0xbf3504f3, v42
    v_fmac_f32 v41, 0x3f3504f3, v49
    v_fmac_f32 v53, 0xbf3504f3, v49
    v_sub_f32 v42, v19, v21
    v_sub_f32 v49, v67, v69
    v_add_f32 v19, v19, v21
    v_add_f32 v67, v67, v69
    v_mul_f32 v21, 0xbf54db31, v42
    v_mul_f32 v69, 0xbf0e39da, v42
    v_fmac_f32 v21, 0x3f0e39da, v49
    v_fmac_f32 v69, 0xbf54db31, v49
    v_sub_f32 v42, v35, v37
    v_sub_f32 v49, v59, v61
    v_add_f32 v35, v35, v37
    v_add_f32 v59, v59, v61
    v_mul_f32 v37, 0xbf6c835e, v42
    v_mul_f32 v61, 0xbec3ef15, v42
    v_fmac_f32 v37, 0x3ec3ef15, v49
    v_fmac_f32 v61, 0xbf6c835e, v49
    v_sub_f32 v42, v27, v29
    v_sub_f32 v49, v75, v77
    v_add_f32 v27, v27, v29
    v_add_f32 v75, v75, v77
    v_mul_f32 v29, 0xbf7b14be, v42
    v_mul_f32 v77, 0xbe47c5c2, v42
    v_fmac_f32 v29, 0x3e47c5c2, v49
    v_fmac_f32 v77, 0xbf7b14be, v49
    v_sub_f32 v42, v16, v38
    v_sub_f32 v49, v48, v78
    v_add_f32 v16, v16, v38
    v_add_f32 v48, v48, v78
    v_sub_f32 v38, v83, v46
    v_sub_f32 v78, v81, v63
    v_add_f32 v83, v83, v46
    v_add_f32 v81, v81, v63
    v_mul_f32 v46, 0x3f6c835e, v38
    v_mul_f32 v63, 0xbec3ef15, v38
    v_fmac_f32 v46, 0x3ec3ef15, v78
    v_fmac_f32 v63, 0x3f6c835e, v78
    v_sub_f32 v38, v80, v31
    v_sub_f32 v78, v72, v55
    v_add_f32 v80, v80, v31
    v_add_f32 v72, v72, v55
    v_mul_f32 v31, 0x3f3504f3, v38
    v_mul_f32 v55, 0xbf3504f3, v38
    v_fmac_f32 v31, 0x3f3504f3, v78
    v_fmac_f32 v55, 0x3f3504f3, v78
    v_sub_f32 v38, v40, v23
    v_sub_f32 v78, v60, v71
    v_add_f32 v40, v40, v23
    v_add_f32 v60, v60, v71
    v_mul_f32 v23, 0x3ec3ef15, v38
    v_mul_f32 v71, 0xbf6c835e, v38
    v_fmac_f32 v23, 0x3f6c835e, v78
    v_fmac_f32 v71, 0x3ec3ef15, v78
    v_sub_f32 v38, v76, v51
    v_sub_f32 v78, v39, v28
    v_add_f32 v28, v28, v39
    v_add_f32 v76, v76, v51
    v_sub_f32 v39, v44, v19
    v_sub_f32 v51, v62, v67
    v_add_f32 v44, v44, v19
    v_add_f32 v62, v62, v67
    v_mul_f32 v19, 0xbec3ef15, v39
    v_mul_f32 v67, 0xbf6c835e, v39
    v_fmac_f32 v19, 0x3f6c835e, v51
    v_fmac_f32 v67, 0xbec3ef15, v51
    v_sub_f32 v39, v30, v35
    v_sub_f32 v51, v54, v59
    v_add_f32 v30, v30, v35
    v_add_f32 v54, v54, v59
    v_mul_f32 v35, 0xbf3504f3, v39
    v_mul_f32 v59, 0xbf3504f3, v39
    v_fmac_f32 v35, 0x3f3504f3, v51
    v_fmac_f32 v59, 0xbf3504f3, v51
    v_sub_f32 v39, v22, v27
    v_sub_f32 v51, v70, v75
    v_add_f32 v22, v22, v27
    v_add_f32 v70, v70, v75
    v_mul_f32 v27, 0xbf6c835e, v39
    v_mul_f32 v75, 0xbec3ef15, v39
    v_fmac_f32 v27, 0x3ec3ef15, v51
    v_fmac_f32 v75, 0xbf6c835e, v51
    v_sub_f32 v39, v32, v43
    v_sub_f32 v51, v64, v79
    v_add_f32 v32, v32, v43
    v_add_f32 v64, v64, v79
    v_sub_f32 v43, v47, v17
    v_sub_f32 v79, v56, v65
    v_add_f32 v47, v47, v17
    v_add_f32 v56, v56, v65
    v_mul_f32 v17, 0x3f6c835e, v43
    v_mul_f32 v65, 0xbec3ef15, v43
    v_fmac_f32 v17, 0x3ec3ef15, v79
    v_fmac_f32 v65, 0x3f6c835e, v79
    v_sub_f32 v43, v24, v33
    v_sub_f32 v79, v52, v57
    v_add_f32 v24, v24, v33
    v_add_f32 v52, v52, v57
    v_mul_f32 v33, 0x3f3504f3, v43
    v_mul_f32 v57, 0xbf3504f3, v43
    v_fmac_f32 v33, 0x3f3504f3, v79
    v_fmac_f32 v57, 0x3f3504f3, v79
    v_sub_f32 v43, v20, v25
    v_sub_f32 v79, v68, v73
    v_add_f32 v20, v20, v25
    v_add_f32 v68, v68, v73
    v_mul_f32 v25, 0x3ec3ef15, v43
    v_mul_f32 v73, 0xbf6c835e, v43
    v_fmac_f32 v25, 0x3f6c835e, v79
    v_fmac_f32 v73, 0x3ec3ef15, v79
    v_sub_f32 v43, v50, v53
    v_sub_f32 v79, v41, v36
    v_add_f32 v36, v36, v41
    v_add_f32 v50, v50, v53
    v_sub_f32 v41, v18, v21
    v_sub_f32 v53, v66, v69
    v_add_f32 v18, v18, v21
    v_add_f32 v66, v66, v69
    v_mul_f32 v21, 0xbec3ef15, v41
    v_mul_f32 v69, 0xbf6c835e, v41
    v_fmac_f32 v21, 0x3f6c835e, v53
    v_fmac_f32 v69, 0xbec3ef15, v53
    v_sub_f32 v41, v34, v37
    v_sub_f32 v53, v58, v61
    v_add_f32 v34, v34, v37
    v_add_f32 v58, v58, v61
    v_mul_f32 v37, 0xbf3504f3, v41
    v_mul_f32 v61, 0xbf3504f3, v41
    v_fmac_f32 v37, 0x3f3504f3, v53
    v_fmac_f32 v61, 0xbf3504f3, v53
    v_sub_f32 v41, v26, v29
    v_sub_f32 v53, v74, v77
    v_add_f32 v26, v26, v29
    v_add_f32 v74, v74, v77
    v_mul_f32 v29, 0xbf6c835e, v41
    v_mul_f32 v77, 0xbec3ef15, v41
    v_fmac_f32 v29, 0x3ec3ef15, v53
    v_fmac_f32 v77, 0xbf6c835e, v53
    v_sub_f32 v41, v16, v28
    v_sub_f32 v53, v48, v76
    v_add_f32 v16, v16, v28
    v_add_f32 v48, v48, v76
    v_sub_f32 v28, v83, v44
    v_sub_f32 v76, v81, v62
    v_add_f32 v83, v83, v44
    v_add_f32 v81, v81, v62
    v_mul_f32 v44, 0x3f3504f3, v28
    v_mul_f32 v62, 0xbf3504f3, v28
    v_fmac_f32 v44, 0x3f3504f3, v76
    v_fmac_f32 v62, 0x3f3504f3, v76
    v_sub_f32 v28, v72, v54
    v_sub_f32 v76, v30, v80
    v_add_f32 v80, v80, v30
    v_add_f32 v72, v72, v54
    v_sub_f32 v30, v40, v22
    v_sub_f32 v54, v60, v70
    v_add_f32 v40, v40, v22
    v_add_f32 v60, v60, v70
    v_mul_f32 v22, 0xbf3504f3, v30
    v_mul_f32 v70, 0xbf3504f3, v30
    v_fmac_f32 v22, 0x3f3504f3, v54
    v_fmac_f32 v70, 0xbf3504f3, v54
    v_sub_f32 v30, v42, v38
    v_sub_f32 v54, v49, v78
    v_add_f32 v42, v42, v38
    v_add_f32 v49, v49, v78
    v_sub_f32 v38, v46, v19
    v_sub_f32 v78, v63, v67
    v_add_f32 v46, v46, v19
    v_add_f32 v63, v63, v67
    v_mul_f32 v19, 0x3f3504f3, v38
    v_mul_f32 v67, 0xbf3504f3, v38
    v_fmac_f32 v19, 0x3f3504f3, v78
    v_fmac_f32 v67, 0x3f3504f3, v78
    v_sub_f32 v38, v55, v59
    v_sub_f32 v78, v35, v31
    v_add_f32 v31, v31, v35
    v_add_f32 v55, v55, v59
    v_sub_f32 v35, v23, v27
    v_sub_f32 v59, v71, v75
    v_add_f32 v23, v23, v27
    v_add_f32 v71, v71, v75
    v_mul_f32 v27, 0xbf3504f3, v35
    v_mul_f32 v75, 0xbf3504f3, v35
    v_fmac_f32 v27, 0x3f3504f3, v59
    v_fmac_f32 v75, 0xbf3504f3, v59
    v_sub_f32 v35, v32, v36
    v_sub_f32 v59, v64, v50
    v_add_f32 v32, v32, v36
    v_add_f32 v64, v64, v50
    v_sub_f32 v36, v47, v18
    v_sub_f32 v50, v56, v66
    v_add_f32 v47, v47, v18
    v_add_f32 v56, v56, v66
    v_mul_f32 v18, 0x3f3504f3, v36
    v_mul_f32 v66, 0xbf3504f3, v36
    v_fmac_f32 v18, 0x3f3504f3, v50
    v_fmac_f32 v66, 0x3f3504f3, v50
    v_sub_f32 v36, v52, v58
    v_sub_f32 v50, v34, v24
    v_add_f32 v24, v24, v34
    v_add_f32 v52, v52, v58
    v_sub_f32 v34, v20, v26
    v_sub_f32 v58, v68, v74
    v_add_f32 v20, v20, v26
    v_add_f32 v68, v68, v74
    v_mul_f32 v26, 0xbf3504f3, v34
    v_mul_f32 v74, 0xbf3504f3, v34
    v_fmac_f32 v26, 0x3f3504f3, v58
    v_fmac_f32 v74, 0xbf3504f3, v58
    v_sub_f32 v34, v39, v43
    v_sub_f32 v58, v51, v79
    v_add_f32 v39, v39, v43
    v_add_f32 v51, v51, v79
    v_sub_f32 v43, v17, v21
    v_sub_f32 v79, v65, v69
    v_add_f32 v17, v17, v21
    v_add_f32 v65, v65, v69
    v_mul_f32 v21, 0x3f3504f3, v43
    v_mul_f32 v69, 0xbf3504f3, v43
    v_fmac_f32 v21, 0x3f3504f3, v79
    v_fmac_f32 v69, 0x3f3504f3, v79
    v_sub_f32 v43, v57, v61
    v_sub_f32 v79, v37, v33
    v_add_f32 v33, v33, v37
    v_add_f32 v57, v57, v61
    v_sub_f32 v37, v25, v29
    v_sub_f32 v61, v73, v77
    v_add_f32 v25, v25, v29
    v_add_f32 v73, v73, v77
    v_mul_f32 v29, 0xbf3504f3, v37
    v_mul_f32 v77, 0xbf3504f3, v37
    v_fmac_f32 v29, 0x3f3504f3, v61
    v_fmac_f32 v77, 0xbf3504f3, v61
    v_sub_f32 v37, v16, v80
    v_sub_f32 v61, v48, v72
    v_add_f32 v16, v16, v80
    v_add_f32 v48, v48, v72
    v_sub_f32 v80, v81, v60
    v_sub_f32 v72, v40, v83
    v_add_f32 v83, v83, v40
    v_add_f32 v81, v81, v60
    v_sub_f32 v40, v41, v28
    v_sub_f32 v60, v53, v76
    v_add_f32 v41, v41, v28
    v_add_f32 v53, v53, v76
    v_sub_f32 v28, v62, v70
    v_sub_f32 v76, v22, v44
    v_add_f32 v44, v44, v22
    v_add_f32 v62, v62, v70
    v_sub_f32 v22, v42, v31
    v_sub_f32 v70, v49, v55
    v_add_f32 v42, v42, v31
    v_add_f32 v49, v49, v55
    v_sub_f32 v31, v63, v71
    v_sub_f32 v55, v23, v46
    v_add_f32 v46, v46, v23
    v_add_f32 v63, v63, v71
    v_sub_f32 v23, v30, v38
    v_sub_f32 v71, v54, v78
    v_add_f32 v30, v30, v38
    v_add_f32 v54, v54, v78
    v_sub_f32 v38, v67, v75
    v_sub_f32 v78, v27, v19
    v_add_f32 v19, v19, v27
    v_add_f32 v67, v67, v75
    v_sub_f32 v27, v32, v24
    v_sub_f32 v75, v64, v52
    v_add_f32 v32, v32, v24
    v_add_f32 v64, v64, v52
    v_sub_f32 v24, v56, v68
    v_sub_f32 v52, v20, v47
    v_add_f32 v47, v47, v20
    v_add_f32 v56, v56, v68
    v_sub_f32 v20, v35, v36
    v_sub_f32 v68, v59, v50
    v_add_f32 v35, v35, v36
    v_add_f32 v59, v59, v50
    v_sub_f32 v36, v66, v74
    v_sub_f32 v50, v26, v18
    v_add_f32 v18, v18, v26
    v_add_f32 v66, v66, v74
    v_sub_f32 v26, v39, v33
    v_sub_f32 v74, v51, v57
    v_add_f32 v39, v39, v33
    v_add_f32 v51, v51, v57
    v_sub_f32 v33, v65, v73
    v_sub_f32 v57, v25, v17
    v_add_f32 v17, v17, v25
    v_add_f32 v65, v65, v73
    v_sub_f32 v25, v34, v43
    v_sub_f32 v73, v58, v79
    v_add_f32 v34, v34, v43
    v_add_f32 v58, v58, v79
    v_sub_f32 v43, v69, v77
    v_sub_f32 v79, v29, v21
    v_add_f32 v21, v21, v29
    v_add_f32 v69, v69, v77
    v_sub_f32 v29, v16, v83
    v_sub_f32 v77, v48, v81
    v_add_f32 v16, v16, v83
    v_add_f32 v48, v48, v81
    v_sub_f32 v83, v37, v80
    v_sub_f32 v81, v61, v72
    v_add_f32 v37, v37, v80
    v_add_f32 v61, v61, v72
    v_sub_f32 v80, v41, v44
    v_sub_f32 v72, v53, v62
    v_add_f32 v41, v41, v44
    v_add_f32 v53, v53, v62
    v_sub_f32 v44, v40, v28
    v_sub_f32 v62, v60, v76
    v_add_f32 v40, v40, v28
    v_add_f32 v60, v60, v76
    v_sub_f32 v28, v42, v46
    v_sub_f32 v76, v49, v63
    v_add_f32 v42, v42, v46
    v_add_f32 v49, v49, v63
    v_sub_f32 v46, v22, v31
    v_sub_f32 v63, v70, v55
    v_add_f32 v22, v22, v31
    v_add_f32 v70, v70, v55
    v_sub_f32 v31, v30, v19
    v_sub_f32 v55, v54, v67
    v_add_f32 v30, v30, v19
    v_add_f32 v54, v54, v67
    v_sub_f32 v19, v23, v38
    v_sub_f32 v67, v71, v78
    v_add_f32 v23, v23, v38
    v_add_f32 v71, v71, v78
    v_sub_f32 v38, v32, v47
    v_sub_f32 v78, v64, v56
    v_add_f32 v32, v32, v47
    v_add_f32 v64, v64, v56
    v_sub_f32 v47, v27, v24
    v_sub_f32 v56, v75, v52
    v_add_f32 v27, v27, v24
    v_add_f32 v75, v75, v52
    v_sub_f32 v24, v35, v18
    v_sub_f32 v52, v59, v66
    v_add_f32 v35, v35, v18
    v_add_f32 v59, v59, v66
    v_sub_f32 v18, v20, v36
    v_sub_f32 v66, v68, v50
    v_add_f32 v20, v20, v36
    v_add_f32 v68, v68, v50
    v_sub_f32 v36, v39, v17
    v_sub_f32 v50, v51, v65
    v_add_f32 v39, v39, v17
    v_add_f32 v51, v51, v65
    v_sub_f32 v17, v26, v33
    v_sub_f32 v65, v74, v57
    v_add_f32 v26, v26, v33
    v_add_f32 v74, v74, v57
    v_sub_f32 v33, v34, v21
    v_sub_f32 v57, v58, v69
    v_add_f32 v34, v34, v21
    v_add_f32 v58, v58, v69
    v_sub_f32 v21, v25, v43
    v_sub_f32 v69, v73, v79
    v_add_f32 v25, v25, v43
    v_add_f32 v73, v73, v79
    ds_write_b32 v4, v16 offset:0
    ds_write_b32 v4, v48 offset:4
    ds_write_b32 v4, v32 offset:256
    ds_write_b32 v4, v64 offset:260
    ds_write_b32 v4, v42 offset:512
    ds_write_b32 v4, v49 offset:516
    ds_write_b32 v4, v39 offset:768
    ds_write_b32 v4, v51 offset:772
    ds_write_b32 v4, v41 offset:1024
    ds_write_b32 v4, v53 offset:1028
    ds_write_b32 v4, v35 offset:1280
    ds_write_b32 v4, v59 offset:1284
    ds_write_b32 v4, v30 offset:1536
    ds_write_b32 v4, v54 offset:1540
    ds_write_b32 v4, v34 offset:1792
    ds_write_b32 v4, v58 offset:1796
    ds_write_b32 v4, v37 offset:2048
    ds_write_b32 v4, v61 offset:2052
    ds_write_b32 v4, v27 offset:2304
    ds_write_b32 v4, v75 offset:2308
    ds_write_b32 v4, v22 offset:2560
    ds_write_b32 v4, v70 offset:2564
    ds_write_b32 v4, v26 offset:2816
    ds_write_b32 v4, v74 offset:2820
    ds_write_b32 v4, v40 offset:3072
    ds_write_b32 v4, v60 offset:3076
    ds_write_b32 v4, v20 offset:3328
    ds_write_b32 v4, v68 offset:3332
    ds_write_b32 v4, v23 offset:3584
    ds_write_b32 v4, v71 offset:3588
    ds_write_b32 v4, v25 offset:3840
    ds_write_b32 v4, v73 offset:3844
    ds_write_b32 v4, v29 offset:4096
    ds_write_b32 v4, v77 offset:4100
    ds_write_b32 v4, v38 offset:4352
    ds_write_b32 v4, v78 offset:4356
    ds_write_b32 v4, v28 offset:4608
    ds_write_b32 v4, v76 offset:4612
    ds_write_b32 v4, v36 offset:4864
    ds_write_b32 v4, v50 offset:4868
    ds_write_b32 v4, v80 offset:5120
    ds_write_b32 v4, v72 offset:5124
    ds_write_b32 v4, v24 offset:5376
    ds_write_b32 v4, v52 offset:5380
    ds_write_b32 v4, v31 offset:5632
    ds_write_b32 v4, v55 offset:5636
    ds_write_b32 v4, v33 offset:5888
    ds_write_b32 v4, v57 offset:5892
    ds_write_b32 v4, v83 offset:6144
    ds_write_b32 v4, v81 offset:6148
    ds_write_b32 v4, v47 offset:6400
    ds_write_b32 v4, v56 offset:6404
    ds_write_b32 v4, v46 offset:6656
    ds_write_b32 v4, v63 offset:6660
    ds_write_b32 v4, v17 offset:6912
    ds_write_b32 v4, v65 offset:6916
    ds_write_b32 v4, v44 offset:7168
    ds_write_b32 v4, v62 offset:7172
    ds_write_b32 v4, v18 offset:7424
    ds_write_b32 v4, v66 offset:7428
    ds_write_b32 v4, v19 offset:7680
    ds_write_b32 v4, v67 offset:7684
    ds_write_b32 v4, v21 offset:7936
    ds_write_b32 v4, v69 offset:7940
    s_waitcnt lgkmcnt(0)
    s_barrier
    v_and_b32 v6, 7, v0
    v_lshrrev_b32 v7, 3, v0
    s_movk_i32 s13, 8448
    v_mul_lo_u32 v8, v6, s13
    v_lshl_add_u32 v4, v7, 3, v8
    v_lshlrev_b32 v5, 14, v7
    v_lshl_add_u32 v5, v6, 4, v5
    s_lshl_b32 s12, s92, 7
    s_add_u32 s12, s12, 96468992
    v_sub_u32 v6, 1024, v7
    v_and_b32 v6, 1023, v6
    v_lshl_add_u32 v6, v6, 3, v8
    ds_read_b64 v[16:17], v4 offset:0
    ds_read_b64 v[18:19], v6
    s_waitcnt lgkmcnt(0)
    v_add_f32 v20, v16, v18
    v_sub_f32 v21, v17, v19
    v_add_f32 v22, v17, v19
    v_sub_f32 v23, v18, v16
    s_mov_b32 s13, s12
    s_add_u32 s13, s12, 0
    buffer_store_dwordx4 v[20:23], v5, s[8:11], s13 offen sc1
    s_nop 1
    v_sub_u32 v6, 992, v7
    v_and_b32 v6, 1023, v6
    v_lshl_add_u32 v6, v6, 3, v8
    ds_read_b64 v[16:17], v4 offset:256
    ds_read_b64 v[18:19], v6
    s_waitcnt lgkmcnt(0)
    v_add_f32 v20, v16, v18
    v_sub_f32 v21, v17, v19
    v_add_f32 v22, v17, v19
    v_sub_f32 v23, v18, v16
    s_mov_b32 s13, s12
    s_add_u32 s13, s12, 524288
    buffer_store_dwordx4 v[20:23], v5, s[8:11], s13 offen sc1
    s_nop 1
    v_sub_u32 v6, 960, v7
    v_and_b32 v6, 1023, v6
    v_lshl_add_u32 v6, v6, 3, v8
    ds_read_b64 v[16:17], v4 offset:512
    ds_read_b64 v[18:19], v6
    s_waitcnt lgkmcnt(0)
    v_add_f32 v20, v16, v18
    v_sub_f32 v21, v17, v19
    v_add_f32 v22, v17, v19
    v_sub_f32 v23, v18, v16
    s_mov_b32 s13, s12
    s_add_u32 s13, s12, 1048576
    buffer_store_dwordx4 v[20:23], v5, s[8:11], s13 offen sc1
    s_nop 1
    v_sub_u32 v6, 928, v7
    v_and_b32 v6, 1023, v6
    v_lshl_add_u32 v6, v6, 3, v8
    ds_read_b64 v[16:17], v4 offset:768
    ds_read_b64 v[18:19], v6
    s_waitcnt lgkmcnt(0)
    v_add_f32 v20, v16, v18
    v_sub_f32 v21, v17, v19
    v_add_f32 v22, v17, v19
    v_sub_f32 v23, v18, v16
    s_mov_b32 s13, s12
    s_add_u32 s13, s12, 1572864
    buffer_store_dwordx4 v[20:23], v5, s[8:11], s13 offen sc1
    s_nop 1
    v_sub_u32 v6, 896, v7
    v_and_b32 v6, 1023, v6
    v_lshl_add_u32 v6, v6, 3, v8
    ds_read_b64 v[16:17], v4 offset:1024
    ds_read_b64 v[18:19], v6
    s_waitcnt lgkmcnt(0)
    v_add_f32 v20, v16, v18
    v_sub_f32 v21, v17, v19
    v_add_f32 v22, v17, v19
    v_sub_f32 v23, v18, v16
    s_mov_b32 s13, s12
    s_add_u32 s13, s12, 2097152
    buffer_store_dwordx4 v[20:23], v5, s[8:11], s13 offen sc1
    s_nop 1
    v_sub_u32 v6, 864, v7
    v_and_b32 v6, 1023, v6
    v_lshl_add_u32 v6, v6, 3, v8
    ds_read_b64 v[16:17], v4 offset:1280
    ds_read_b64 v[18:19], v6
    s_waitcnt lgkmcnt(0)
    v_add_f32 v20, v16, v18
    v_sub_f32 v21, v17, v19
    v_add_f32 v22, v17, v19
    v_sub_f32 v23, v18, v16
    s_mov_b32 s13, s12
    s_add_u32 s13, s12, 2621440
    buffer_store_dwordx4 v[20:23], v5, s[8:11], s13 offen sc1
    s_nop 1
    v_sub_u32 v6, 832, v7
    v_and_b32 v6, 1023, v6
    v_lshl_add_u32 v6, v6, 3, v8
    ds_read_b64 v[16:17], v4 offset:1536
    ds_read_b64 v[18:19], v6
    s_waitcnt lgkmcnt(0)
    v_add_f32 v20, v16, v18
    v_sub_f32 v21, v17, v19
    v_add_f32 v22, v17, v19
    v_sub_f32 v23, v18, v16
    s_mov_b32 s13, s12
    s_add_u32 s13, s12, 3145728
    buffer_store_dwordx4 v[20:23], v5, s[8:11], s13 offen sc1
    s_nop 1
    v_sub_u32 v6, 800, v7
    v_and_b32 v6, 1023, v6
    v_lshl_add_u32 v6, v6, 3, v8
    ds_read_b64 v[16:17], v4 offset:1792
    ds_read_b64 v[18:19], v6
    s_waitcnt lgkmcnt(0)
    v_add_f32 v20, v16, v18
    v_sub_f32 v21, v17, v19
    v_add_f32 v22, v17, v19
    v_sub_f32 v23, v18, v16
    s_mov_b32 s13, s12
    s_add_u32 s13, s12, 3670016
    buffer_store_dwordx4 v[20:23], v5, s[8:11], s13 offen sc1
    s_nop 1
    v_sub_u32 v6, 768, v7
    v_and_b32 v6, 1023, v6
    v_lshl_add_u32 v6, v6, 3, v8
    ds_read_b64 v[16:17], v4 offset:2048
    ds_read_b64 v[18:19], v6
    s_waitcnt lgkmcnt(0)
    v_add_f32 v20, v16, v18
    v_sub_f32 v21, v17, v19
    v_add_f32 v22, v17, v19
    v_sub_f32 v23, v18, v16
    s_mov_b32 s13, s12
    s_add_u32 s13, s12, 4194304
    buffer_store_dwordx4 v[20:23], v5, s[8:11], s13 offen sc1
    s_nop 1
    v_sub_u32 v6, 736, v7
    v_and_b32 v6, 1023, v6
    v_lshl_add_u32 v6, v6, 3, v8
    ds_read_b64 v[16:17], v4 offset:2304
    ds_read_b64 v[18:19], v6
    s_waitcnt lgkmcnt(0)
    v_add_f32 v20, v16, v18
    v_sub_f32 v21, v17, v19
    v_add_f32 v22, v17, v19
    v_sub_f32 v23, v18, v16
    s_mov_b32 s13, s12
    s_add_u32 s13, s12, 4718592
    buffer_store_dwordx4 v[20:23], v5, s[8:11], s13 offen sc1
    s_nop 1
    v_sub_u32 v6, 704, v7
    v_and_b32 v6, 1023, v6
    v_lshl_add_u32 v6, v6, 3, v8
    ds_read_b64 v[16:17], v4 offset:2560
    ds_read_b64 v[18:19], v6
    s_waitcnt lgkmcnt(0)
    v_add_f32 v20, v16, v18
    v_sub_f32 v21, v17, v19
    v_add_f32 v22, v17, v19
    v_sub_f32 v23, v18, v16
    s_mov_b32 s13, s12
    s_add_u32 s13, s12, 5242880
    buffer_store_dwordx4 v[20:23], v5, s[8:11], s13 offen sc1
    s_nop 1
    v_sub_u32 v6, 672, v7
    v_and_b32 v6, 1023, v6
    v_lshl_add_u32 v6, v6, 3, v8
    ds_read_b64 v[16:17], v4 offset:2816
    ds_read_b64 v[18:19], v6
    s_waitcnt lgkmcnt(0)
    v_add_f32 v20, v16, v18
    v_sub_f32 v21, v17, v19
    v_add_f32 v22, v17, v19
    v_sub_f32 v23, v18, v16
    s_mov_b32 s13, s12
    s_add_u32 s13, s12, 5767168
    buffer_store_dwordx4 v[20:23], v5, s[8:11], s13 offen sc1
    s_nop 1
    v_sub_u32 v6, 640, v7
    v_and_b32 v6, 1023, v6
    v_lshl_add_u32 v6, v6, 3, v8
    ds_read_b64 v[16:17], v4 offset:3072
    ds_read_b64 v[18:19], v6
    s_waitcnt lgkmcnt(0)
    v_add_f32 v20, v16, v18
    v_sub_f32 v21, v17, v19
    v_add_f32 v22, v17, v19
    v_sub_f32 v23, v18, v16
    s_mov_b32 s13, s12
    s_add_u32 s13, s12, 6291456
    buffer_store_dwordx4 v[20:23], v5, s[8:11], s13 offen sc1
    s_nop 1
    v_sub_u32 v6, 608, v7
    v_and_b32 v6, 1023, v6
    v_lshl_add_u32 v6, v6, 3, v8
    ds_read_b64 v[16:17], v4 offset:3328
    ds_read_b64 v[18:19], v6
    s_waitcnt lgkmcnt(0)
    v_add_f32 v20, v16, v18
    v_sub_f32 v21, v17, v19
    v_add_f32 v22, v17, v19
    v_sub_f32 v23, v18, v16
    s_mov_b32 s13, s12
    s_add_u32 s13, s12, 6815744
    buffer_store_dwordx4 v[20:23], v5, s[8:11], s13 offen sc1
    s_nop 1
    v_sub_u32 v6, 576, v7
    v_and_b32 v6, 1023, v6
    v_lshl_add_u32 v6, v6, 3, v8
    ds_read_b64 v[16:17], v4 offset:3584
    ds_read_b64 v[18:19], v6
    s_waitcnt lgkmcnt(0)
    v_add_f32 v20, v16, v18
    v_sub_f32 v21, v17, v19
    v_add_f32 v22, v17, v19
    v_sub_f32 v23, v18, v16
    s_mov_b32 s13, s12
    s_add_u32 s13, s12, 7340032
    buffer_store_dwordx4 v[20:23], v5, s[8:11], s13 offen sc1
    s_nop 1
    v_sub_u32 v6, 544, v7
    v_and_b32 v6, 1023, v6
    v_lshl_add_u32 v6, v6, 3, v8
    ds_read_b64 v[16:17], v4 offset:3840
    ds_read_b64 v[18:19], v6
    s_waitcnt lgkmcnt(0)
    v_add_f32 v20, v16, v18
    v_sub_f32 v21, v17, v19
    v_add_f32 v22, v17, v19
    v_sub_f32 v23, v18, v16
    s_mov_b32 s13, s12
    s_add_u32 s13, s12, 7864320
    buffer_store_dwordx4 v[20:23], v5, s[8:11], s13 offen sc1
    s_nop 1
    v_sub_u32 v6, 512, v7
    v_and_b32 v6, 1023, v6
    v_lshl_add_u32 v6, v6, 3, v8
    ds_read_b64 v[16:17], v4 offset:4096
    ds_read_b64 v[18:19], v6
    s_waitcnt lgkmcnt(0)
    v_add_f32 v20, v16, v18
    v_sub_f32 v21, v17, v19
    v_add_f32 v22, v17, v19
    v_sub_f32 v23, v18, v16
    s_mov_b32 s13, s12
    v_cmp_eq_u32 vcc, 0, v7
    s_and_saveexec_b64 s[14:15], vcc
    s_add_u32 s13, s12, 8388608
    buffer_store_dwordx4 v[20:23], v5, s[8:11], s13 offen sc1
    s_nop 1
    s_mov_b64 exec, -1
mega_kernel_f1d:
    s_waitcnt vmcnt(0)
    s_barrier
    v_mov_b32 v2, 1
    v_cmp_eq_u32 vcc, 0, v0
    s_and_saveexec_b64 s[80:81], vcc
    s_cbranch_execz mega_kernel_sg72_2
    buffer_atomic_add v2, off, s[88:91], 0 offset:72 sc1
mega_kernel_sg72_2:
    s_mov_b64 exec, s[80:81]
    s_waitcnt vmcnt(0)
    ds_read_b64_tr_b16 a[0:1], v201 offset:0
    ds_read_b64_tr_b16 a[2:3], v201 offset:256
    ds_read_b64_tr_b16 a[4:5], v201 offset:1024
    ds_read_b64_tr_b16 a[6:7], v201 offset:1280
    ds_read_b64_tr_b16 a[8:9], v201 offset:2048
    ds_read_b64_tr_b16 a[10:11], v201 offset:2304
    ds_read_b64_tr_b16 a[12:13], v201 offset:3072
    ds_read_b64_tr_b16 a[14:15], v201 offset:3328
    s_waitcnt lgkmcnt(0)
    ds_read_b64_tr_b16 a[16:17], v201 offset:4096
    ds_read_b64_tr_b16 a[18:19], v201 offset:4352
    ds_read_b64_tr_b16 a[20:21], v201 offset:5120
    ds_read_b64_tr_b16 a[22:23], v201 offset:5376
    ds_read_b64_tr_b16 a[24:25], v201 offset:6144
    ds_read_b64_tr_b16 a[26:27], v201 offset:6400
    ds_read_b64_tr_b16 a[28:29], v201 offset:7168
    ds_read_b64_tr_b16 a[30:31], v201 offset:7424
    s_waitcnt lgkmcnt(0)
    ds_read_b64_tr_b16 a[32:33], v201 offset:8192
    ds_read_b64_tr_b16 a[34:35], v201 offset:8448
    ds_read_b64_tr_b16 a[36:37], v201 offset:9216
    ds_read_b64_tr_b16 a[38:39], v201 offset:9472
    ds_read_b64_tr_b16 a[40:41], v201 offset:10240
    ds_read_b64_tr_b16 a[42:43], v201 offset:10496
    ds_read_b64_tr_b16 a[44:45], v201 offset:11264
    ds_read_b64_tr_b16 a[46:47], v201 offset:11520
    s_waitcnt lgkmcnt(0)
    ds_read_b64_tr_b16 a[48:49], v201 offset:12288
    ds_read_b64_tr_b16 a[50:51], v201 offset:12544
    ds_read_b64_tr_b16 a[52:53], v201 offset:13312
    ds_read_b64_tr_b16 a[54:55], v201 offset:13568
    ds_read_b64_tr_b16 a[56:57], v201 offset:14336
    ds_read_b64_tr_b16 a[58:59], v201 offset:14592
    ds_read_b64_tr_b16 a[60:61], v201 offset:15360
    ds_read_b64_tr_b16 a[62:63], v201 offset:15616
    s_waitcnt lgkmcnt(0)
    s_add_u32 m0, s56, 0
    s_add_u32 s58, s57, 16384
    s_and_b32 s58, s58, 0xffff
    s_lshl_b32 s58, s58, 5
    buffer_load_dwordx4 v200, s[52:55], s58 offen lds
    s_add_u32 m0, s56, 1024
    s_add_u32 s58, s57, 17408
    s_and_b32 s58, s58, 0xffff
    s_lshl_b32 s58, s58, 5
    buffer_load_dwordx4 v200, s[52:55], s58 offen lds
    s_add_u32 m0, s56, 2048
    s_add_u32 s58, s57, 18432
    s_and_b32 s58, s58, 0xffff
    s_lshl_b32 s58, s58, 5
    buffer_load_dwordx4 v200, s[52:55], s58 offen lds
    s_add_u32 m0, s56, 3072
    s_add_u32 s58, s57, 19456
    s_and_b32 s58, s58, 0xffff
    s_lshl_b32 s58, s58, 5
    buffer_load_dwordx4 v200, s[52:55], s58 offen lds
    s_add_u32 m0, s56, 4096
    s_add_u32 s58, s57, 20480
    s_and_b32 s58, s58, 0xffff
    s_lshl_b32 s58, s58, 5
    buffer_load_dwordx4 v200, s[52:55], s58 offen lds
    s_add_u32 m0, s56, 5120
    s_add_u32 s58, s57, 21504
    s_and_b32 s58, s58, 0xffff
    s_lshl_b32 s58, s58, 5
    buffer_load_dwordx4 v200, s[52:55], s58 offen lds
    s_add_u32 m0, s56, 6144
    s_add_u32 s58, s57, 22528
    s_and_b32 s58, s58, 0xffff
    s_lshl_b32 s58, s58, 5
    buffer_load_dwordx4 v200, s[52:55], s58 offen lds
    s_add_u32 m0, s56, 7168
    s_add_u32 s58, s57, 23552
    s_and_b32 s58, s58, 0xffff
    s_lshl_b32 s58, s58, 5
    buffer_load_dwordx4 v200, s[52:55], s58 offen lds
    s_add_u32 m0, s56, 8192
    s_add_u32 s58, s57, 24576
    s_and_b32 s58, s58, 0xffff
    s_lshl_b32 s58, s58, 5
    buffer_load_dwordx4 v200, s[52:55], s58 offen lds
    s_add_u32 m0, s56, 9216
    s_add_u32 s58, s57, 25600
    s_and_b32 s58, s58, 0xffff
    s_lshl_b32 s58, s58, 5
    buffer_load_dwordx4 v200, s[52:55], s58 offen lds
    s_add_u32 m0, s56, 10240
    s_add_u32 s58, s57, 26624
    s_and_b32 s58, s58, 0xffff
    s_lshl_b32 s58, s58, 5
    buffer_load_dwordx4 v200, s[52:55], s58 offen lds
    s_add_u32 m0, s56, 11264
    s_add_u32 s58, s57, 27648
    s_and_b32 s58, s58, 0xffff
    s_lshl_b32 s58, s58, 5
    buffer_load_dwordx4 v200, s[52:55], s58 offen lds
    s_add_u32 m0, s56, 12288
    s_add_u32 s58, s57, 28672
    s_and_b32 s58, s58, 0xffff
    s_lshl_b32 s58, s58, 5
    buffer_load_dwordx4 v200, s[52:55], s58 offen lds
    s_add_u32 m0, s56, 13312
    s_add_u32 s58, s57, 29696
    s_and_b32 s58, s58, 0xffff
    s_lshl_b32 s58, s58, 5
    buffer_load_dwordx4 v200, s[52:55], s58 offen lds
    s_add_u32 m0, s56, 14336
    s_add_u32 s58, s57, 30720
    s_and_b32 s58, s58, 0xffff
    s_lshl_b32 s58, s58, 5
    buffer_load_dwordx4 v200, s[52:55], s58 offen lds
    s_add_u32 m0, s56, 15360
    s_add_u32 s58, s57, 31744
    s_and_b32 s58, s58, 0xffff
    s_lshl_b32 s58, s58, 5
    buffer_load_dwordx4 v200, s[52:55], s58 offen lds
    s_cmp_ge_u32 s92, 128
    s_cbranch_scc1 mega_kernel_xo
mega_kernel_wf1:
    s_sleep 8
    buffer_load_dword v2, off, s[88:91], 0 offset:72 sc1
    s_waitcnt vmcnt(0)
    v_cmp_ne_u32 vcc, 192, v2
    s_cbranch_vccnz mega_kernel_wf1
    s_mov_b32 s99, s92
    s_barrier
mega_kernel_f2_in:
    s_load_dwordx2 s[8:9], s[0:1], 96
    v_lshrrev_b32 v5, 6, v0
    v_and_b32 v1, 63, v0
    v_readfirstlane_b32 s12, v5
    s_lshl_b32 s13, s99, 2
    s_add_u32 s13, s13, s12
    s_cmp_ge_u32 s13, 513
    s_cbranch_scc1 mega_kernel_f2_end
    v_cvt_f32_u32 v2, v1
    s_waitcnt lgkmcnt(0)
    s_mov_b32 s10, 268435456
    s_mov_b32 s11, 0x00020000
    s_lshl_b32 s14, s13, 14
    s_add_u32 s15, s14, 96468992
    v_lshlrev_b32 v5, 3, v1
    s_add_u32 s16, s15, 0
    buffer_load_dwordx2 v[16:17], v5, s[8:11], s16 offen
    s_add_u32 s16, s15, 512
    buffer_load_dwordx2 v[18:19], v5, s[8:11], s16 offen
    s_add_u32 s16, s15, 1024
    buffer_load_dwordx2 v[20:21], v5, s[8:11], s16 offen
    s_add_u32 s16, s15, 1536
    buffer_load_dwordx2 v[22:23], v5, s[8:11], s16 offen
    s_add_u32 s16, s15, 2048
    buffer_load_dwordx2 v[24:25], v5, s[8:11], s16 offen
    s_add_u32 s16, s15, 2560
    buffer_load_dwordx2 v[26:27], v5, s[8:11], s16 offen
    s_add_u32 s16, s15, 3072
    buffer_load_dwordx2 v[28:29], v5, s[8:11], s16 offen
    s_add_u32 s16, s15, 3584
    buffer_load_dwordx2 v[30:31], v5, s[8:11], s16 offen
    s_add_u32 s16, s15, 4096
    buffer_load_dwordx2 v[32:33], v5, s[8:11], s16 offen
    s_add_u32 s16, s15, 4608
    buffer_load_dwordx2 v[34:35], v5, s[8:11], s16 offen
    s_add_u32 s16, s15, 5120
    buffer_load_dwordx2 v[36:37], v5, s[8:11], s16 offen
    s_add_u32 s16, s15, 5632
    buffer_load_dwordx2 v[38:39], v5, s[8:11], s16 offen
    s_add_u32 s16, s15, 6144
    buffer_load_dwordx2 v[40:41], v5, s[8:11], s16 offen
    s_add_u32 s16, s15, 6656
    buffer_load_dwordx2 v[42:43], v5, s[8:11], s16 offen
    s_add_u32 s16, s15, 7168
    buffer_load_dwordx2 v[44:45], v5, s[8:11], s16 offen
    s_add_u32 s16, s15, 7680
    buffer_load_dwordx2 v[46:47], v5, s[8:11], s16 offen
    s_add_u32 s16, s15, 8192
    buffer_load_dwordx2 v[48:49], v5, s[8:11], s16 offen
    s_add_u32 s16, s15, 8704
    buffer_load_dwordx2 v[50:51], v5, s[8:11], s16 offen
    s_add_u32 s16, s15, 9216
    buffer_load_dwordx2 v[52:53], v5, s[8:11], s16 offen
    s_add_u32 s16, s15, 9728
    buffer_load_dwordx2 v[54:55], v5, s[8:11], s16 offen
    s_add_u32 s16, s15, 10240
    buffer_load_dwordx2 v[56:57], v5, s[8:11], s16 offen
    s_add_u32 s16, s15, 10752
    buffer_load_dwordx2 v[58:59], v5, s[8:11], s16 offen
    s_add_u32 s16, s15, 11264
    buffer_load_dwordx2 v[60:61], v5, s[8:11], s16 offen
    s_add_u32 s16, s15, 11776
    buffer_load_dwordx2 v[62:63], v5, s[8:11], s16 offen
    s_add_u32 s16, s15, 12288
    buffer_load_dwordx2 v[64:65], v5, s[8:11], s16 offen
    s_add_u32 s16, s15, 12800
    buffer_load_dwordx2 v[66:67], v5, s[8:11], s16 offen
    s_add_u32 s16, s15, 13312
    buffer_load_dwordx2 v[68:69], v5, s[8:11], s16 offen
    s_add_u32 s16, s15, 13824
    buffer_load_dwordx2 v[70:71], v5, s[8:11], s16 offen
    s_add_u32 s16, s15, 14336
    buffer_load_dwordx2 v[72:73], v5, s[8:11], s16 offen
    s_add_u32 s16, s15, 14848
    buffer_load_dwordx2 v[74:75], v5, s[8:11], s16 offen
    s_add_u32 s16, s15, 15360
    buffer_load_dwordx2 v[76:77], v5, s[8:11], s16 offen
    s_add_u32 s16, s15, 15872
    buffer_load_dwordx2 v[78:79], v5, s[8:11], s16 offen
    s_mul_i32 s17, s12, 16896
    v_lshlrev_b32 v3, 3, v1
    v_add_u32 v3, s17, v3
    v_and_b32 v7, 1, v1
    v_lshrrev_b32 v6, 1, v1
    v_cvt_f32_u32 v8, v6
    v_cvt_f32_u32 v10, v7
    s_movk_i32 s18, 528
    v_mul_lo_u32 v4, v6, s18
    v_lshl_add_u32 v4, v7, 3, v4
    v_add_u32 v4, s17, v4
    v_mov_b32 v9, 1.0
    v_fma_f32 v9, v10, -2.0, v9
    v_lshlrev_b32 v5, 12, v7
    v_lshl_add_u32 v11, v6, 2, v5
    s_lshl_b32 s19, s13, 13
    s_add_u32 s19, s19, 121634816
    s_waitcnt vmcnt(0)
    v_sub_f32 v80, v16, v48
    v_sub_f32 v81, v17, v49
    v_add_f32 v16, v16, v48
    v_add_f32 v17, v17, v49
    v_sub_f32 v48, v18, v50
    v_sub_f32 v49, v19, v51
    v_add_f32 v18, v18, v50
    v_add_f32 v19, v19, v51
    v_mul_f32 v50, 0x3f7b14be, v48
    v_mul_f32 v51, 0xbe47c5c2, v48
    v_fmac_f32 v50, 0x3e47c5c2, v49
    v_fmac_f32 v51, 0x3f7b14be, v49
    v_sub_f32 v48, v20, v52
    v_sub_f32 v49, v21, v53
    v_add_f32 v20, v20, v52
    v_add_f32 v21, v21, v53
    v_mul_f32 v52, 0x3f6c835e, v48
    v_mul_f32 v53, 0xbec3ef15, v48
    v_fmac_f32 v52, 0x3ec3ef15, v49
    v_fmac_f32 v53, 0x3f6c835e, v49
    v_sub_f32 v48, v22, v54
    v_sub_f32 v49, v23, v55
    v_add_f32 v22, v22, v54
    v_add_f32 v23, v23, v55
    v_mul_f32 v54, 0x3f54db31, v48
    v_mul_f32 v55, 0xbf0e39da, v48
    v_fmac_f32 v54, 0x3f0e39da, v49
    v_fmac_f32 v55, 0x3f54db31, v49
    v_sub_f32 v48, v24, v56
    v_sub_f32 v49, v25, v57
    v_add_f32 v24, v24, v56
    v_add_f32 v25, v25, v57
    v_mul_f32 v56, 0x3f3504f3, v48
    v_mul_f32 v57, 0xbf3504f3, v48
    v_fmac_f32 v56, 0x3f3504f3, v49
    v_fmac_f32 v57, 0x3f3504f3, v49
    v_sub_f32 v48, v26, v58
    v_sub_f32 v49, v27, v59
    v_add_f32 v26, v26, v58
    v_add_f32 v27, v27, v59
    v_mul_f32 v58, 0x3f0e39da, v48
    v_mul_f32 v59, 0xbf54db31, v48
    v_fmac_f32 v58, 0x3f54db31, v49
    v_fmac_f32 v59, 0x3f0e39da, v49
    v_sub_f32 v48, v28, v60
    v_sub_f32 v49, v29, v61
    v_add_f32 v28, v28, v60
    v_add_f32 v29, v29, v61
    v_mul_f32 v60, 0x3ec3ef15, v48
    v_mul_f32 v61, 0xbf6c835e, v48
    v_fmac_f32 v60, 0x3f6c835e, v49
    v_fmac_f32 v61, 0x3ec3ef15, v49
    v_sub_f32 v48, v30, v62
    v_sub_f32 v49, v31, v63
    v_add_f32 v30, v30, v62
    v_add_f32 v31, v31, v63
    v_mul_f32 v62, 0x3e47c5c2, v48
    v_mul_f32 v63, 0xbf7b14be, v48
    v_fmac_f32 v62, 0x3f7b14be, v49
    v_fmac_f32 v63, 0x3e47c5c2, v49
    v_sub_f32 v48, v33, v65
    v_sub_f32 v49, v64, v32
    v_add_f32 v32, v32, v64
    v_add_f32 v33, v33, v65
    v_sub_f32 v64, v34, v66
    v_sub_f32 v65, v35, v67
    v_add_f32 v34, v34, v66
    v_add_f32 v35, v35, v67
    v_mul_f32 v66, 0xbe47c5c2, v64
    v_mul_f32 v67, 0xbf7b14be, v64
    v_fmac_f32 v66, 0x3f7b14be, v65
    v_fmac_f32 v67, 0xbe47c5c2, v65
    v_sub_f32 v64, v36, v68
    v_sub_f32 v65, v37, v69
    v_add_f32 v36, v36, v68
    v_add_f32 v37, v37, v69
    v_mul_f32 v68, 0xbec3ef15, v64
    v_mul_f32 v69, 0xbf6c835e, v64
    v_fmac_f32 v68, 0x3f6c835e, v65
    v_fmac_f32 v69, 0xbec3ef15, v65
    v_sub_f32 v64, v38, v70
    v_sub_f32 v65, v39, v71
    v_add_f32 v38, v38, v70
    v_add_f32 v39, v39, v71
    v_mul_f32 v70, 0xbf0e39da, v64
    v_mul_f32 v71, 0xbf54db31, v64
    v_fmac_f32 v70, 0x3f54db31, v65
    v_fmac_f32 v71, 0xbf0e39da, v65
    v_sub_f32 v64, v40, v72
    v_sub_f32 v65, v41, v73
    v_add_f32 v40, v40, v72
    v_add_f32 v41, v41, v73
    v_mul_f32 v72, 0xbf3504f3, v64
    v_mul_f32 v73, 0xbf3504f3, v64
    v_fmac_f32 v72, 0x3f3504f3, v65
    v_fmac_f32 v73, 0xbf3504f3, v65
    v_sub_f32 v64, v42, v74
    v_sub_f32 v65, v43, v75
    v_add_f32 v42, v42, v74
    v_add_f32 v43, v43, v75
    v_mul_f32 v74, 0xbf54db31, v64
    v_mul_f32 v75, 0xbf0e39da, v64
    v_fmac_f32 v74, 0x3f0e39da, v65
    v_fmac_f32 v75, 0xbf54db31, v65
    v_sub_f32 v64, v44, v76
    v_sub_f32 v65, v45, v77
    v_add_f32 v44, v44, v76
    v_add_f32 v45, v45, v77
    v_mul_f32 v76, 0xbf6c835e, v64
    v_mul_f32 v77, 0xbec3ef15, v64
    v_fmac_f32 v76, 0x3ec3ef15, v65
    v_fmac_f32 v77, 0xbf6c835e, v65
    v_sub_f32 v64, v46, v78
    v_sub_f32 v65, v47, v79
    v_add_f32 v46, v46, v78
    v_add_f32 v47, v47, v79
    v_mul_f32 v78, 0xbf7b14be, v64
    v_mul_f32 v79, 0xbe47c5c2, v64
    v_fmac_f32 v78, 0x3e47c5c2, v65
    v_fmac_f32 v79, 0xbf7b14be, v65
    v_sub_f32 v64, v16, v32
    v_sub_f32 v65, v17, v33
    v_add_f32 v16, v16, v32
    v_add_f32 v17, v17, v33
    v_sub_f32 v32, v18, v34
    v_sub_f32 v33, v19, v35
    v_add_f32 v18, v18, v34
    v_add_f32 v19, v19, v35
    v_mul_f32 v34, 0x3f6c835e, v32
    v_mul_f32 v35, 0xbec3ef15, v32
    v_fmac_f32 v34, 0x3ec3ef15, v33
    v_fmac_f32 v35, 0x3f6c835e, v33
    v_sub_f32 v32, v20, v36
    v_sub_f32 v33, v21, v37
    v_add_f32 v20, v20, v36
    v_add_f32 v21, v21, v37
    v_mul_f32 v36, 0x3f3504f3, v32
    v_mul_f32 v37, 0xbf3504f3, v32
    v_fmac_f32 v36, 0x3f3504f3, v33
    v_fmac_f32 v37, 0x3f3504f3, v33
    v_sub_f32 v32, v22, v38
    v_sub_f32 v33, v23, v39
    v_add_f32 v22, v22, v38
    v_add_f32 v23, v23, v39
    v_mul_f32 v38, 0x3ec3ef15, v32
    v_mul_f32 v39, 0xbf6c835e, v32
    v_fmac_f32 v38, 0x3f6c835e, v33
    v_fmac_f32 v39, 0x3ec3ef15, v33
    v_sub_f32 v32, v25, v41
    v_sub_f32 v33, v40, v24
    v_add_f32 v24, v24, v40
    v_add_f32 v25, v25, v41
    v_sub_f32 v40, v26, v42
    v_sub_f32 v41, v27, v43
    v_add_f32 v26, v26, v42
    v_add_f32 v27, v27, v43
    v_mul_f32 v42, 0xbec3ef15, v40
    v_mul_f32 v43, 0xbf6c835e, v40
    v_fmac_f32 v42, 0x3f6c835e, v41
    v_fmac_f32 v43, 0xbec3ef15, v41
    v_sub_f32 v40, v28, v44
    v_sub_f32 v41, v29, v45
    v_add_f32 v28, v28, v44
    v_add_f32 v29, v29, v45
    v_mul_f32 v44, 0xbf3504f3, v40
    v_mul_f32 v45, 0xbf3504f3, v40
    v_fmac_f32 v44, 0x3f3504f3, v41
    v_fmac_f32 v45, 0xbf3504f3, v41
    v_sub_f32 v40, v30, v46
    v_sub_f32 v41, v31, v47
    v_add_f32 v30, v30, v46
    v_add_f32 v31, v31, v47
    v_mul_f32 v46, 0xbf6c835e, v40
    v_mul_f32 v47, 0xbec3ef15, v40
    v_fmac_f32 v46, 0x3ec3ef15, v41
    v_fmac_f32 v47, 0xbf6c835e, v41
    v_sub_f32 v40, v80, v48
    v_sub_f32 v41, v81, v49
    v_add_f32 v80, v80, v48
    v_add_f32 v81, v81, v49
    v_sub_f32 v48, v50, v66
    v_sub_f32 v49, v51, v67
    v_add_f32 v50, v50, v66
    v_add_f32 v51, v51, v67
    v_mul_f32 v66, 0x3f6c835e, v48
    v_mul_f32 v67, 0xbec3ef15, v48
    v_fmac_f32 v66, 0x3ec3ef15, v49
    v_fmac_f32 v67, 0x3f6c835e, v49
    v_sub_f32 v48, v52, v68
    v_sub_f32 v49, v53, v69
    v_add_f32 v52, v52, v68
    v_add_f32 v53, v53, v69
    v_mul_f32 v68, 0x3f3504f3, v48
    v_mul_f32 v69, 0xbf3504f3, v48
    v_fmac_f32 v68, 0x3f3504f3, v49
    v_fmac_f32 v69, 0x3f3504f3, v49
    v_sub_f32 v48, v54, v70
    v_sub_f32 v49, v55, v71
    v_add_f32 v54, v54, v70
    v_add_f32 v55, v55, v71
    v_mul_f32 v70, 0x3ec3ef15, v48
    v_mul_f32 v71, 0xbf6c835e, v48
    v_fmac_f32 v70, 0x3f6c835e, v49
    v_fmac_f32 v71, 0x3ec3ef15, v49
    v_sub_f32 v48, v57, v73
    v_sub_f32 v49, v72, v56
    v_add_f32 v56, v56, v72
    v_add_f32 v57, v57, v73
    v_sub_f32 v72, v58, v74
    v_sub_f32 v73, v59, v75
    v_add_f32 v58, v58, v74
    v_add_f32 v59, v59, v75
    v_mul_f32 v74, 0xbec3ef15, v72
    v_mul_f32 v75, 0xbf6c835e, v72
    v_fmac_f32 v74, 0x3f6c835e, v73
    v_fmac_f32 v75, 0xbec3ef15, v73
    v_sub_f32 v72, v60, v76
    v_sub_f32 v73, v61, v77
    v_add_f32 v60, v60, v76
    v_add_f32 v61, v61, v77
    v_mul_f32 v76, 0xbf3504f3, v72
    v_mul_f32 v77, 0xbf3504f3, v72
    v_fmac_f32 v76, 0x3f3504f3, v73
    v_fmac_f32 v77, 0xbf3504f3, v73
    v_sub_f32 v72, v62, v78
    v_sub_f32 v73, v63, v79
    v_add_f32 v62, v62, v78
    v_add_f32 v63, v63, v79
    v_mul_f32 v78, 0xbf6c835e, v72
    v_mul_f32 v79, 0xbec3ef15, v72
    v_fmac_f32 v78, 0x3ec3ef15, v73
    v_fmac_f32 v79, 0xbf6c835e, v73
    v_sub_f32 v72, v16, v24
    v_sub_f32 v73, v17, v25
    v_add_f32 v16, v16, v24
    v_add_f32 v17, v17, v25
    v_sub_f32 v24, v18, v26
    v_sub_f32 v25, v19, v27
    v_add_f32 v18, v18, v26
    v_add_f32 v19, v19, v27
    v_mul_f32 v26, 0x3f3504f3, v24
    v_mul_f32 v27, 0xbf3504f3, v24
    v_fmac_f32 v26, 0x3f3504f3, v25
    v_fmac_f32 v27, 0x3f3504f3, v25
    v_sub_f32 v24, v21, v29
    v_sub_f32 v25, v28, v20
    v_add_f32 v20, v20, v28
    v_add_f32 v21, v21, v29
    v_sub_f32 v28, v22, v30
    v_sub_f32 v29, v23, v31
    v_add_f32 v22, v22, v30
    v_add_f32 v23, v23, v31
    v_mul_f32 v30, 0xbf3504f3, v28
    v_mul_f32 v31, 0xbf3504f3, v28
    v_fmac_f32 v30, 0x3f3504f3, v29
    v_fmac_f32 v31, 0xbf3504f3, v29
    v_sub_f32 v28, v64, v32
    v_sub_f32 v29, v65, v33
    v_add_f32 v64, v64, v32
    v_add_f32 v65, v65, v33
    v_sub_f32 v32, v34, v42
    v_sub_f32 v33, v35, v43
    v_add_f32 v34, v34, v42
    v_add_f32 v35, v35, v43
    v_mul_f32 v42, 0x3f3504f3, v32
    v_mul_f32 v43, 0xbf3504f3, v32
    v_fmac_f32 v42, 0x3f3504f3, v33
    v_fmac_f32 v43, 0x3f3504f3, v33
    v_sub_f32 v32, v37, v45
    v_sub_f32 v33, v44, v36
    v_add_f32 v36, v36, v44
    v_add_f32 v37, v37, v45
    v_sub_f32 v44, v38, v46
    v_sub_f32 v45, v39, v47
    v_add_f32 v38, v38, v46
    v_add_f32 v39, v39, v47
    v_mul_f32 v46, 0xbf3504f3, v44
    v_mul_f32 v47, 0xbf3504f3, v44
    v_fmac_f32 v46, 0x3f3504f3, v45
    v_fmac_f32 v47, 0xbf3504f3, v45
    v_sub_f32 v44, v80, v56
    v_sub_f32 v45, v81, v57
    v_add_f32 v80, v80, v56
    v_add_f32 v81, v81, v57
    v_sub_f32 v56, v50, v58
    v_sub_f32 v57, v51, v59
    v_add_f32 v50, v50, v58
    v_add_f32 v51, v51, v59
    v_mul_f32 v58, 0x3f3504f3, v56
    v_mul_f32 v59, 0xbf3504f3, v56
    v_fmac_f32 v58, 0x3f3504f3, v57
    v_fmac_f32 v59, 0x3f3504f3, v57
    v_sub_f32 v56, v53, v61
    v_sub_f32 v57, v60, v52
    v_add_f32 v52, v52, v60
    v_add_f32 v53, v53, v61
    v_sub_f32 v60, v54, v62
    v_sub_f32 v61, v55, v63
    v_add_f32 v54, v54, v62
    v_add_f32 v55, v55, v63
    v_mul_f32 v62, 0xbf3504f3, v60
    v_mul_f32 v63, 0xbf3504f3, v60
    v_fmac_f32 v62, 0x3f3504f3, v61
    v_fmac_f32 v63, 0xbf3504f3, v61
    v_sub_f32 v60, v40, v48
    v_sub_f32 v61, v41, v49
    v_add_f32 v40, v40, v48
    v_add_f32 v41, v41, v49
    v_sub_f32 v48, v66, v74
    v_sub_f32 v49, v67, v75
    v_add_f32 v66, v66, v74
    v_add_f32 v67, v67, v75
    v_mul_f32 v74, 0x3f3504f3, v48
    v_mul_f32 v75, 0xbf3504f3, v48
    v_fmac_f32 v74, 0x3f3504f3, v49
    v_fmac_f32 v75, 0x3f3504f3, v49
    v_sub_f32 v48, v69, v77
    v_sub_f32 v49, v76, v68
    v_add_f32 v68, v68, v76
    v_add_f32 v69, v69, v77
    v_sub_f32 v76, v70, v78
    v_sub_f32 v77, v71, v79
    v_add_f32 v70, v70, v78
    v_add_f32 v71, v71, v79
    v_mul_f32 v78, 0xbf3504f3, v76
    v_mul_f32 v79, 0xbf3504f3, v76
    v_fmac_f32 v78, 0x3f3504f3, v77
    v_fmac_f32 v79, 0xbf3504f3, v77
    v_sub_f32 v76, v16, v20
    v_sub_f32 v77, v17, v21
    v_add_f32 v16, v16, v20
    v_add_f32 v17, v17, v21
    v_sub_f32 v20, v19, v23
    v_sub_f32 v21, v22, v18
    v_add_f32 v18, v18, v22
    v_add_f32 v19, v19, v23
    v_sub_f32 v22, v72, v24
    v_sub_f32 v23, v73, v25
    v_add_f32 v72, v72, v24
    v_add_f32 v73, v73, v25
    v_sub_f32 v24, v27, v31
    v_sub_f32 v25, v30, v26
    v_add_f32 v26, v26, v30
    v_add_f32 v27, v27, v31
    v_sub_f32 v30, v64, v36
    v_sub_f32 v31, v65, v37
    v_add_f32 v64, v64, v36
    v_add_f32 v65, v65, v37
    v_sub_f32 v36, v35, v39
    v_sub_f32 v37, v38, v34
    v_add_f32 v34, v34, v38
    v_add_f32 v35, v35, v39
    v_sub_f32 v38, v28, v32
    v_sub_f32 v39, v29, v33
    v_add_f32 v28, v28, v32
    v_add_f32 v29, v29, v33
    v_sub_f32 v32, v43, v47
    v_sub_f32 v33, v46, v42
    v_add_f32 v42, v42, v46
    v_add_f32 v43, v43, v47
    v_sub_f32 v46, v80, v52
    v_sub_f32 v47, v81, v53
    v_add_f32 v80, v80, v52
    v_add_f32 v81, v81, v53
    v_sub_f32 v52, v51, v55
    v_sub_f32 v53, v54, v50
    v_add_f32 v50, v50, v54
    v_add_f32 v51, v51, v55
    v_sub_f32 v54, v44, v56
    v_sub_f32 v55, v45, v57
    v_add_f32 v44, v44, v56
    v_add_f32 v45, v45, v57
    v_sub_f32 v56, v59, v63
    v_sub_f32 v57, v62, v58
    v_add_f32 v58, v58, v62
    v_add_f32 v59, v59, v63
    v_sub_f32 v62, v40, v68
    v_sub_f32 v63, v41, v69
    v_add_f32 v40, v40, v68
    v_add_f32 v41, v41, v69
    v_sub_f32 v68, v67, v71
    v_sub_f32 v69, v70, v66
    v_add_f32 v66, v66, v70
    v_add_f32 v67, v67, v71
    v_sub_f32 v70, v60, v48
    v_sub_f32 v71, v61, v49
    v_add_f32 v60, v60, v48
    v_add_f32 v61, v61, v49
    v_sub_f32 v48, v75, v79
    v_sub_f32 v49, v78, v74
    v_add_f32 v74, v74, v78
    v_add_f32 v75, v75, v79
    v_sub_f32 v78, v16, v18
    v_sub_f32 v79, v17, v19
    v_add_f32 v16, v16, v18
    v_add_f32 v17, v17, v19
    v_sub_f32 v18, v76, v20
    v_sub_f32 v19, v77, v21
    v_add_f32 v76, v76, v20
    v_add_f32 v77, v77, v21
    v_sub_f32 v20, v72, v26
    v_sub_f32 v21, v73, v27
    v_add_f32 v72, v72, v26
    v_add_f32 v73, v73, v27
    v_sub_f32 v26, v22, v24
    v_sub_f32 v27, v23, v25
    v_add_f32 v22, v22, v24
    v_add_f32 v23, v23, v25
    v_sub_f32 v24, v64, v34
    v_sub_f32 v25, v65, v35
    v_add_f32 v64, v64, v34
    v_add_f32 v65, v65, v35
    v_sub_f32 v34, v30, v36
    v_sub_f32 v35, v31, v37
    v_add_f32 v30, v30, v36
    v_add_f32 v31, v31, v37
    v_sub_f32 v36, v28, v42
    v_sub_f32 v37, v29, v43
    v_add_f32 v28, v28, v42
    v_add_f32 v29, v29, v43
    v_sub_f32 v42, v38, v32
    v_sub_f32 v43, v39, v33
    v_add_f32 v38, v38, v32
    v_add_f32 v39, v39, v33
    v_sub_f32 v32, v80, v50
    v_sub_f32 v33, v81, v51
    v_add_f32 v80, v80, v50
    v_add_f32 v81, v81, v51
    v_sub_f32 v50, v46, v52
    v_sub_f32 v51, v47, v53
    v_add_f32 v46, v46, v52
    v_add_f32 v47, v47, v53
    v_sub_f32 v52, v44, v58
    v_sub_f32 v53, v45, v59
    v_add_f32 v44, v44, v58
    v_add_f32 v45, v45, v59
    v_sub_f32 v58, v54, v56
    v_sub_f32 v59, v55, v57
    v_add_f32 v54, v54, v56
    v_add_f32 v55, v55, v57
    v_sub_f32 v56, v40, v66
    v_sub_f32 v57, v41, v67
    v_add_f32 v40, v40, v66
    v_add_f32 v41, v41, v67
    v_sub_f32 v66, v62, v68
    v_sub_f32 v67, v63, v69
    v_add_f32 v62, v62, v68
    v_add_f32 v63, v63, v69
    v_sub_f32 v68, v60, v74
    v_sub_f32 v69, v61, v75
    v_add_f32 v60, v60, v74
    v_add_f32 v61, v61, v75
    v_sub_f32 v74, v70, v48
    v_sub_f32 v75, v71, v49
    v_add_f32 v70, v70, v48
    v_add_f32 v71, v71, v49
    v_mul_f32 v48, 0xba000000, v2
    v_cos_f32 v49, v48
    v_sin_f32 v82, v48
    s_nop 0
    v_mul_f32 v83, v80, v49
    v_fma_f32 v83, -v81, v82, v83
    v_mul_f32 v81, v81, v49
    v_fmac_f32 v81, v80, v82
    v_mul_f32 v48, 0xba800000, v2
    v_cos_f32 v49, v48
    v_sin_f32 v82, v48
    s_nop 0
    v_mul_f32 v80, v64, v49
    v_fma_f32 v80, -v65, v82, v80
    v_mul_f32 v65, v65, v49
    v_fmac_f32 v65, v64, v82
    v_mul_f32 v48, 0xbac00000, v2
    v_cos_f32 v49, v48
    v_sin_f32 v82, v48
    s_nop 0
    v_mul_f32 v64, v40, v49
    v_fma_f32 v64, -v41, v82, v64
    v_mul_f32 v41, v41, v49
    v_fmac_f32 v41, v40, v82
    v_mul_f32 v48, 0xbb000000, v2
    v_cos_f32 v49, v48
    v_sin_f32 v82, v48
    s_nop 0
    v_mul_f32 v40, v72, v49
    v_fma_f32 v40, -v73, v82, v40
    v_mul_f32 v73, v73, v49
    v_fmac_f32 v73, v72, v82
    v_mul_f32 v48, 0xbb200000, v2
    v_cos_f32 v49, v48
    v_sin_f32 v82, v48
    s_nop 0
    v_mul_f32 v72, v44, v49
    v_fma_f32 v72, -v45, v82, v72
    v_mul_f32 v45, v45, v49
    v_fmac_f32 v45, v44, v82
    v_mul_f32 v48, 0xbb400000, v2
    v_cos_f32 v49, v48
    v_sin_f32 v82, v48
    s_nop 0
    v_mul_f32 v44, v28, v49
    v_fma_f32 v44, -v29, v82, v44
    v_mul_f32 v29, v29, v49
    v_fmac_f32 v29, v28, v82
    v_mul_f32 v48, 0xbb600000, v2
    v_cos_f32 v49, v48
    v_sin_f32 v82, v48
    s_nop 0
    v_mul_f32 v28, v60, v49
    v_fma_f32 v28, -v61, v82, v28
    v_mul_f32 v61, v61, v49
    v_fmac_f32 v61, v60, v82
    v_mul_f32 v48, 0xbb800000, v2
    v_cos_f32 v49, v48
    v_sin_f32 v82, v48
    s_nop 0
    v_mul_f32 v60, v76, v49
    v_fma_f32 v60, -v77, v82, v60
    v_mul_f32 v77, v77, v49
    v_fmac_f32 v77, v76, v82
    v_mul_f32 v48, 0xbb900000, v2
    v_cos_f32 v49, v48
    v_sin_f32 v82, v48
    s_nop 0
    v_mul_f32 v76, v46, v49
    v_fma_f32 v76, -v47, v82, v76
    v_mul_f32 v47, v47, v49
    v_fmac_f32 v47, v46, v82
    v_mul_f32 v48, 0xbba00000, v2
    v_cos_f32 v49, v48
    v_sin_f32 v82, v48
    s_nop 0
    v_mul_f32 v46, v30, v49
    v_fma_f32 v46, -v31, v82, v46
    v_mul_f32 v31, v31, v49
    v_fmac_f32 v31, v30, v82
    v_mul_f32 v48, 0xbbb00000, v2
    v_cos_f32 v49, v48
    v_sin_f32 v82, v48
    s_nop 0
    v_mul_f32 v30, v62, v49
    v_fma_f32 v30, -v63, v82, v30
    v_mul_f32 v63, v63, v49
    v_fmac_f32 v63, v62, v82
    v_mul_f32 v48, 0xbbc00000, v2
    v_cos_f32 v49, v48
    v_sin_f32 v82, v48
    s_nop 0
    v_mul_f32 v62, v22, v49
    v_fma_f32 v62, -v23, v82, v62
    v_mul_f32 v23, v23, v49
    v_fmac_f32 v23, v22, v82
    v_mul_f32 v48, 0xbbd00000, v2
    v_cos_f32 v49, v48
    v_sin_f32 v82, v48
    s_nop 0
    v_mul_f32 v22, v54, v49
    v_fma_f32 v22, -v55, v82, v22
    v_mul_f32 v55, v55, v49
    v_fmac_f32 v55, v54, v82
    v_mul_f32 v48, 0xbbe00000, v2
    v_cos_f32 v49, v48
    v_sin_f32 v82, v48
    s_nop 0
    v_mul_f32 v54, v38, v49
    v_fma_f32 v54, -v39, v82, v54
    v_mul_f32 v39, v39, v49
    v_fmac_f32 v39, v38, v82
    v_mul_f32 v48, 0xbbf00000, v2
    v_cos_f32 v49, v48
    v_sin_f32 v82, v48
    s_nop 0
    v_mul_f32 v38, v70, v49
    v_fma_f32 v38, -v71, v82, v38
    v_mul_f32 v71, v71, v49
    v_fmac_f32 v71, v70, v82
    v_mul_f32 v48, 0xbc000000, v2
    v_cos_f32 v49, v48
    v_sin_f32 v82, v48
    s_nop 0
    v_mul_f32 v70, v78, v49
    v_fma_f32 v70, -v79, v82, v70
    v_mul_f32 v79, v79, v49
    v_fmac_f32 v79, v78, v82
    v_mul_f32 v48, 0xbc080000, v2
    v_cos_f32 v49, v48
    v_sin_f32 v82, v48
    s_nop 0
    v_mul_f32 v78, v32, v49
    v_fma_f32 v78, -v33, v82, v78
    v_mul_f32 v33, v33, v49
    v_fmac_f32 v33, v32, v82
    v_mul_f32 v48, 0xbc100000, v2
    v_cos_f32 v49, v48
    v_sin_f32 v82, v48
    s_nop 0
    v_mul_f32 v32, v24, v49
    v_fma_f32 v32, -v25, v82, v32
    v_mul_f32 v25, v25, v49
    v_fmac_f32 v25, v24, v82
    v_mul_f32 v48, 0xbc180000, v2
    v_cos_f32 v49, v48
    v_sin_f32 v82, v48
    s_nop 0
    v_mul_f32 v24, v56, v49
    v_fma_f32 v24, -v57, v82, v24
    v_mul_f32 v57, v57, v49
    v_fmac_f32 v57, v56, v82
    v_mul_f32 v48, 0xbc200000, v2
    v_cos_f32 v49, v48
    v_sin_f32 v82, v48
    s_nop 0
    v_mul_f32 v56, v20, v49
    v_fma_f32 v56, -v21, v82, v56
    v_mul_f32 v21, v21, v49
    v_fmac_f32 v21, v20, v82
    v_mul_f32 v48, 0xbc280000, v2
    v_cos_f32 v49, v48
    v_sin_f32 v82, v48
    s_nop 0
    v_mul_f32 v20, v52, v49
    v_fma_f32 v20, -v53, v82, v20
    v_mul_f32 v53, v53, v49
    v_fmac_f32 v53, v52, v82
    v_mul_f32 v48, 0xbc300000, v2
    v_cos_f32 v49, v48
    v_sin_f32 v82, v48
    s_nop 0
    v_mul_f32 v52, v36, v49
    v_fma_f32 v52, -v37, v82, v52
    v_mul_f32 v37, v37, v49
    v_fmac_f32 v37, v36, v82
    v_mul_f32 v48, 0xbc380000, v2
    v_cos_f32 v49, v48
    v_sin_f32 v82, v48
    s_nop 0
    v_mul_f32 v36, v68, v49
    v_fma_f32 v36, -v69, v82, v36
    v_mul_f32 v69, v69, v49
    v_fmac_f32 v69, v68, v82
    v_mul_f32 v48, 0xbc400000, v2
    v_cos_f32 v49, v48
    v_sin_f32 v82, v48
    s_nop 0
    v_mul_f32 v68, v18, v49
    v_fma_f32 v68, -v19, v82, v68
    v_mul_f32 v19, v19, v49
    v_fmac_f32 v19, v18, v82
    v_mul_f32 v48, 0xbc480000, v2
    v_cos_f32 v49, v48
    v_sin_f32 v82, v48
    s_nop 0
    v_mul_f32 v18, v50, v49
    v_fma_f32 v18, -v51, v82, v18
    v_mul_f32 v51, v51, v49
    v_fmac_f32 v51, v50, v82
    v_mul_f32 v48, 0xbc500000, v2
    v_cos_f32 v49, v48
    v_sin_f32 v82, v48
    s_nop 0
    v_mul_f32 v50, v34, v49
    v_fma_f32 v50, -v35, v82, v50
    v_mul_f32 v35, v35, v49
    v_fmac_f32 v35, v34, v82
    v_mul_f32 v48, 0xbc580000, v2
    v_cos_f32 v49, v48
    v_sin_f32 v82, v48
    s_nop 0
    v_mul_f32 v34, v66, v49
    v_fma_f32 v34, -v67, v82, v34
    v_mul_f32 v67, v67, v49
    v_fmac_f32 v67, v66, v82
    v_mul_f32 v48, 0xbc600000, v2
    v_cos_f32 v49, v48
    v_sin_f32 v82, v48
    s_nop 0
    v_mul_f32 v66, v26, v49
    v_fma_f32 v66, -v27, v82, v66
    v_mul_f32 v27, v27, v49
    v_fmac_f32 v27, v26, v82
    v_mul_f32 v48, 0xbc680000, v2
    v_cos_f32 v49, v48
    v_sin_f32 v82, v48
    s_nop 0
    v_mul_f32 v26, v58, v49
    v_fma_f32 v26, -v59, v82, v26
    v_mul_f32 v59, v59, v49
    v_fmac_f32 v59, v58, v82
    v_mul_f32 v48, 0xbc700000, v2
    v_cos_f32 v49, v48
    v_sin_f32 v82, v48
    s_nop 0
    v_mul_f32 v58, v42, v49
    v_fma_f32 v58, -v43, v82, v58
    v_mul_f32 v43, v43, v49
    v_fmac_f32 v43, v42, v82
    v_mul_f32 v48, 0xbc780000, v2
    v_cos_f32 v49, v48
    v_sin_f32 v82, v48
    s_nop 0
    v_mul_f32 v42, v74, v49
    v_fma_f32 v42, -v75, v82, v42
    v_mul_f32 v75, v75, v49
    v_fmac_f32 v75, v74, v82
    ds_write_b32 v3, v16 offset:0
    ds_write_b32 v3, v17 offset:4
    ds_write_b32 v3, v83 offset:528
    ds_write_b32 v3, v81 offset:532
    ds_write_b32 v3, v80 offset:1056
    ds_write_b32 v3, v65 offset:1060
    ds_write_b32 v3, v64 offset:1584
    ds_write_b32 v3, v41 offset:1588
    ds_write_b32 v3, v40 offset:2112
    ds_write_b32 v3, v73 offset:2116
    ds_write_b32 v3, v72 offset:2640
    ds_write_b32 v3, v45 offset:2644
    ds_write_b32 v3, v44 offset:3168
    ds_write_b32 v3, v29 offset:3172
    ds_write_b32 v3, v28 offset:3696
    ds_write_b32 v3, v61 offset:3700
    ds_write_b32 v3, v60 offset:4224
    ds_write_b32 v3, v77 offset:4228
    ds_write_b32 v3, v76 offset:4752
    ds_write_b32 v3, v47 offset:4756
    ds_write_b32 v3, v46 offset:5280
    ds_write_b32 v3, v31 offset:5284
    ds_write_b32 v3, v30 offset:5808
    ds_write_b32 v3, v63 offset:5812
    ds_write_b32 v3, v62 offset:6336
    ds_write_b32 v3, v23 offset:6340
    ds_write_b32 v3, v22 offset:6864
    ds_write_b32 v3, v55 offset:6868
    ds_write_b32 v3, v54 offset:7392
    ds_write_b32 v3, v39 offset:7396
    ds_write_b32 v3, v38 offset:7920
    ds_write_b32 v3, v71 offset:7924
    ds_write_b32 v3, v70 offset:8448
    ds_write_b32 v3, v79 offset:8452
    ds_write_b32 v3, v78 offset:8976
    ds_write_b32 v3, v33 offset:8980
    ds_write_b32 v3, v32 offset:9504
    ds_write_b32 v3, v25 offset:9508
    ds_write_b32 v3, v24 offset:10032
    ds_write_b32 v3, v57 offset:10036
    ds_write_b32 v3, v56 offset:10560
    ds_write_b32 v3, v21 offset:10564
    ds_write_b32 v3, v20 offset:11088
    ds_write_b32 v3, v53 offset:11092
    ds_write_b32 v3, v52 offset:11616
    ds_write_b32 v3, v37 offset:11620
    ds_write_b32 v3, v36 offset:12144
    ds_write_b32 v3, v69 offset:12148
    ds_write_b32 v3, v68 offset:12672
    ds_write_b32 v3, v19 offset:12676
    ds_write_b32 v3, v18 offset:13200
    ds_write_b32 v3, v51 offset:13204
    ds_write_b32 v3, v50 offset:13728
    ds_write_b32 v3, v35 offset:13732
    ds_write_b32 v3, v34 offset:14256
    ds_write_b32 v3, v67 offset:14260
    ds_write_b32 v3, v66 offset:14784
    ds_write_b32 v3, v27 offset:14788
    ds_write_b32 v3, v26 offset:15312
    ds_write_b32 v3, v59 offset:15316
    ds_write_b32 v3, v58 offset:15840
    ds_write_b32 v3, v43 offset:15844
    ds_write_b32 v3, v42 offset:16368
    ds_write_b32 v3, v75 offset:16372
    s_waitcnt lgkmcnt(0)
    ds_read_b32 v16, v4 offset:0
    ds_read_b32 v17, v4 offset:4
    ds_read_b32 v83, v4 offset:16
    ds_read_b32 v81, v4 offset:20
    ds_read_b32 v80, v4 offset:32
    ds_read_b32 v65, v4 offset:36
    ds_read_b32 v64, v4 offset:48
    ds_read_b32 v41, v4 offset:52
    ds_read_b32 v40, v4 offset:64
    ds_read_b32 v73, v4 offset:68
    ds_read_b32 v72, v4 offset:80
    ds_read_b32 v45, v4 offset:84
    ds_read_b32 v44, v4 offset:96
    ds_read_b32 v29, v4 offset:100
    s_waitcnt lgkmcnt(0)
    ds_read_b32 v28, v4 offset:112
    ds_read_b32 v61, v4 offset:116
    ds_read_b32 v60, v4 offset:128
    ds_read_b32 v77, v4 offset:132
    ds_read_b32 v76, v4 offset:144
    ds_read_b32 v47, v4 offset:148
    ds_read_b32 v46, v4 offset:160
    ds_read_b32 v31, v4 offset:164
    ds_read_b32 v30, v4 offset:176
    ds_read_b32 v63, v4 offset:180
    ds_read_b32 v62, v4 offset:192
    ds_read_b32 v23, v4 offset:196
    ds_read_b32 v22, v4 offset:208
    ds_read_b32 v55, v4 offset:212
    s_waitcnt lgkmcnt(0)
    ds_read_b32 v54, v4 offset:224
    ds_read_b32 v39, v4 offset:228
    ds_read_b32 v38, v4 offset:240
    ds_read_b32 v71, v4 offset:244
    ds_read_b32 v70, v4 offset:256
    ds_read_b32 v79, v4 offset:260
    ds_read_b32 v78, v4 offset:272
    ds_read_b32 v33, v4 offset:276
    ds_read_b32 v32, v4 offset:288
    ds_read_b32 v25, v4 offset:292
    ds_read_b32 v24, v4 offset:304
    ds_read_b32 v57, v4 offset:308
    ds_read_b32 v56, v4 offset:320
    ds_read_b32 v21, v4 offset:324
    s_waitcnt lgkmcnt(0)
    ds_read_b32 v20, v4 offset:336
    ds_read_b32 v53, v4 offset:340
    ds_read_b32 v52, v4 offset:352
    ds_read_b32 v37, v4 offset:356
    ds_read_b32 v36, v4 offset:368
    ds_read_b32 v69, v4 offset:372
    ds_read_b32 v68, v4 offset:384
    ds_read_b32 v19, v4 offset:388
    ds_read_b32 v18, v4 offset:400
    ds_read_b32 v51, v4 offset:404
    ds_read_b32 v50, v4 offset:416
    ds_read_b32 v35, v4 offset:420
    ds_read_b32 v34, v4 offset:432
    ds_read_b32 v67, v4 offset:436
    s_waitcnt lgkmcnt(0)
    ds_read_b32 v66, v4 offset:448
    ds_read_b32 v27, v4 offset:452
    ds_read_b32 v26, v4 offset:464
    ds_read_b32 v59, v4 offset:468
    ds_read_b32 v58, v4 offset:480
    ds_read_b32 v43, v4 offset:484
    ds_read_b32 v42, v4 offset:496
    ds_read_b32 v75, v4 offset:500
    s_waitcnt lgkmcnt(0)
    buffer_load_dword v88, v11, s[8:11], s19 offen offset:0
    buffer_load_dword v89, v11, s[8:11], s19 offen offset:128
    buffer_load_dword v90, v11, s[8:11], s19 offen offset:256
    buffer_load_dword v91, v11, s[8:11], s19 offen offset:384
    buffer_load_dword v92, v11, s[8:11], s19 offen offset:512
    buffer_load_dword v93, v11, s[8:11], s19 offen offset:640
    buffer_load_dword v94, v11, s[8:11], s19 offen offset:768
    buffer_load_dword v95, v11, s[8:11], s19 offen offset:896
    buffer_load_dword v96, v11, s[8:11], s19 offen offset:1024
    buffer_load_dword v97, v11, s[8:11], s19 offen offset:1152
    buffer_load_dword v98, v11, s[8:11], s19 offen offset:1280
    buffer_load_dword v99, v11, s[8:11], s19 offen offset:1408
    buffer_load_dword v100, v11, s[8:11], s19 offen offset:1536
    buffer_load_dword v101, v11, s[8:11], s19 offen offset:1664
    buffer_load_dword v102, v11, s[8:11], s19 offen offset:1792
    buffer_load_dword v103, v11, s[8:11], s19 offen offset:1920
    buffer_load_dword v104, v11, s[8:11], s19 offen offset:2048
    buffer_load_dword v105, v11, s[8:11], s19 offen offset:2176
    buffer_load_dword v106, v11, s[8:11], s19 offen offset:2304
    buffer_load_dword v107, v11, s[8:11], s19 offen offset:2432
    buffer_load_dword v108, v11, s[8:11], s19 offen offset:2560
    buffer_load_dword v109, v11, s[8:11], s19 offen offset:2688
    buffer_load_dword v110, v11, s[8:11], s19 offen offset:2816
    buffer_load_dword v111, v11, s[8:11], s19 offen offset:2944
    buffer_load_dword v112, v11, s[8:11], s19 offen offset:3072
    buffer_load_dword v113, v11, s[8:11], s19 offen offset:3200
    buffer_load_dword v114, v11, s[8:11], s19 offen offset:3328
    buffer_load_dword v115, v11, s[8:11], s19 offen offset:3456
    buffer_load_dword v116, v11, s[8:11], s19 offen offset:3584
    buffer_load_dword v117, v11, s[8:11], s19 offen offset:3712
    buffer_load_dword v118, v11, s[8:11], s19 offen offset:3840
    buffer_load_dword v119, v11, s[8:11], s19 offen offset:3968
    v_sub_f32 v48, v16, v70
    v_sub_f32 v49, v17, v79
    v_add_f32 v16, v16, v70
    v_add_f32 v17, v17, v79
    v_sub_f32 v70, v83, v78
    v_sub_f32 v79, v81, v33
    v_add_f32 v83, v83, v78
    v_add_f32 v81, v81, v33
    v_mul_f32 v78, 0x3f7b14be, v70
    v_mul_f32 v33, 0xbe47c5c2, v70
    v_fmac_f32 v78, 0x3e47c5c2, v79
    v_fmac_f32 v33, 0x3f7b14be, v79
    v_sub_f32 v70, v80, v32
    v_sub_f32 v79, v65, v25
    v_add_f32 v80, v80, v32
    v_add_f32 v65, v65, v25
    v_mul_f32 v32, 0x3f6c835e, v70
    v_mul_f32 v25, 0xbec3ef15, v70
    v_fmac_f32 v32, 0x3ec3ef15, v79
    v_fmac_f32 v25, 0x3f6c835e, v79
    v_sub_f32 v70, v64, v24
    v_sub_f32 v79, v41, v57
    v_add_f32 v64, v64, v24
    v_add_f32 v41, v41, v57
    v_mul_f32 v24, 0x3f54db31, v70
    v_mul_f32 v57, 0xbf0e39da, v70
    v_fmac_f32 v24, 0x3f0e39da, v79
    v_fmac_f32 v57, 0x3f54db31, v79
    v_sub_f32 v70, v40, v56
    v_sub_f32 v79, v73, v21
    v_add_f32 v40, v40, v56
    v_add_f32 v73, v73, v21
    v_mul_f32 v56, 0x3f3504f3, v70
    v_mul_f32 v21, 0xbf3504f3, v70
    v_fmac_f32 v56, 0x3f3504f3, v79
    v_fmac_f32 v21, 0x3f3504f3, v79
    v_sub_f32 v70, v72, v20
    v_sub_f32 v79, v45, v53
    v_add_f32 v72, v72, v20
    v_add_f32 v45, v45, v53
    v_mul_f32 v20, 0x3f0e39da, v70
    v_mul_f32 v53, 0xbf54db31, v70
    v_fmac_f32 v20, 0x3f54db31, v79
    v_fmac_f32 v53, 0x3f0e39da, v79
    v_sub_f32 v70, v44, v52
    v_sub_f32 v79, v29, v37
    v_add_f32 v44, v44, v52
    v_add_f32 v29, v29, v37
    v_mul_f32 v52, 0x3ec3ef15, v70
    v_mul_f32 v37, 0xbf6c835e, v70
    v_fmac_f32 v52, 0x3f6c835e, v79
    v_fmac_f32 v37, 0x3ec3ef15, v79
    v_sub_f32 v70, v28, v36
    v_sub_f32 v79, v61, v69
    v_add_f32 v28, v28, v36
    v_add_f32 v61, v61, v69
    v_mul_f32 v36, 0x3e47c5c2, v70
    v_mul_f32 v69, 0xbf7b14be, v70
    v_fmac_f32 v36, 0x3f7b14be, v79
    v_fmac_f32 v69, 0x3e47c5c2, v79
    v_sub_f32 v70, v77, v19
    v_sub_f32 v79, v68, v60
    v_add_f32 v60, v60, v68
    v_add_f32 v77, v77, v19
    v_sub_f32 v68, v76, v18
    v_sub_f32 v19, v47, v51
    v_add_f32 v76, v76, v18
    v_add_f32 v47, v47, v51
    v_mul_f32 v18, 0xbe47c5c2, v68
    v_mul_f32 v51, 0xbf7b14be, v68
    v_fmac_f32 v18, 0x3f7b14be, v19
    v_fmac_f32 v51, 0xbe47c5c2, v19
    v_sub_f32 v68, v46, v50
    v_sub_f32 v19, v31, v35
    v_add_f32 v46, v46, v50
    v_add_f32 v31, v31, v35
    v_mul_f32 v50, 0xbec3ef15, v68
    v_mul_f32 v35, 0xbf6c835e, v68
    v_fmac_f32 v50, 0x3f6c835e, v19
    v_fmac_f32 v35, 0xbec3ef15, v19
    v_sub_f32 v68, v30, v34
    v_sub_f32 v19, v63, v67
    v_add_f32 v30, v30, v34
    v_add_f32 v63, v63, v67
    v_mul_f32 v34, 0xbf0e39da, v68
    v_mul_f32 v67, 0xbf54db31, v68
    v_fmac_f32 v34, 0x3f54db31, v19
    v_fmac_f32 v67, 0xbf0e39da, v19
    v_sub_f32 v68, v62, v66
    v_sub_f32 v19, v23, v27
    v_add_f32 v62, v62, v66
    v_add_f32 v23, v23, v27
    v_mul_f32 v66, 0xbf3504f3, v68
    v_mul_f32 v27, 0xbf3504f3, v68
    v_fmac_f32 v66, 0x3f3504f3, v19
    v_fmac_f32 v27, 0xbf3504f3, v19
    v_sub_f32 v68, v22, v26
    v_sub_f32 v19, v55, v59
    v_add_f32 v22, v22, v26
    v_add_f32 v55, v55, v59
    v_mul_f32 v26, 0xbf54db31, v68
    v_mul_f32 v59, 0xbf0e39da, v68
    v_fmac_f32 v26, 0x3f0e39da, v19
    v_fmac_f32 v59, 0xbf54db31, v19
    v_sub_f32 v68, v54, v58
    v_sub_f32 v19, v39, v43
    v_add_f32 v54, v54, v58
    v_add_f32 v39, v39, v43
    v_mul_f32 v58, 0xbf6c835e, v68
    v_mul_f32 v43, 0xbec3ef15, v68
    v_fmac_f32 v58, 0x3ec3ef15, v19
    v_fmac_f32 v43, 0xbf6c835e, v19
    v_sub_f32 v68, v38, v42
    v_sub_f32 v19, v71, v75
    v_add_f32 v38, v38, v42
    v_add_f32 v71, v71, v75
    v_mul_f32 v42, 0xbf7b14be, v68
    v_mul_f32 v75, 0xbe47c5c2, v68
    v_fmac_f32 v42, 0x3e47c5c2, v19
    v_fmac_f32 v75, 0xbf7b14be, v19
    v_sub_f32 v68, v16, v60
    v_sub_f32 v19, v17, v77
    v_add_f32 v16, v16, v60
    v_add_f32 v17, v17, v77
    v_sub_f32 v60, v83, v76
    v_sub_f32 v77, v81, v47
    v_add_f32 v83, v83, v76
    v_add_f32 v81, v81, v47
    v_mul_f32 v76, 0x3f6c835e, v60
    v_mul_f32 v47, 0xbec3ef15, v60
    v_fmac_f32 v76, 0x3ec3ef15, v77
    v_fmac_f32 v47, 0x3f6c835e, v77
    v_sub_f32 v60, v80, v46
    v_sub_f32 v77, v65, v31
    v_add_f32 v80, v80, v46
    v_add_f32 v65, v65, v31
    v_mul_f32 v46, 0x3f3504f3, v60
    v_mul_f32 v31, 0xbf3504f3, v60
    v_fmac_f32 v46, 0x3f3504f3, v77
    v_fmac_f32 v31, 0x3f3504f3, v77
    v_sub_f32 v60, v64, v30
    v_sub_f32 v77, v41, v63
    v_add_f32 v64, v64, v30
    v_add_f32 v41, v41, v63
    v_mul_f32 v30, 0x3ec3ef15, v60
    v_mul_f32 v63, 0xbf6c835e, v60
    v_fmac_f32 v30, 0x3f6c835e, v77
    v_fmac_f32 v63, 0x3ec3ef15, v77
    v_sub_f32 v60, v73, v23
    v_sub_f32 v77, v62, v40
    v_add_f32 v40, v40, v62
    v_add_f32 v73, v73, v23
    v_sub_f32 v62, v72, v22
    v_sub_f32 v23, v45, v55
    v_add_f32 v72, v72, v22
    v_add_f32 v45, v45, v55
    v_mul_f32 v22, 0xbec3ef15, v62
    v_mul_f32 v55, 0xbf6c835e, v62
    v_fmac_f32 v22, 0x3f6c835e, v23
    v_fmac_f32 v55, 0xbec3ef15, v23
    v_sub_f32 v62, v44, v54
    v_sub_f32 v23, v29, v39
    v_add_f32 v44, v44, v54
    v_add_f32 v29, v29, v39
    v_mul_f32 v54, 0xbf3504f3, v62
    v_mul_f32 v39, 0xbf3504f3, v62
    v_fmac_f32 v54, 0x3f3504f3, v23
    v_fmac_f32 v39, 0xbf3504f3, v23
    v_sub_f32 v62, v28, v38
    v_sub_f32 v23, v61, v71
    v_add_f32 v28, v28, v38
    v_add_f32 v61, v61, v71
    v_mul_f32 v38, 0xbf6c835e, v62
    v_mul_f32 v71, 0xbec3ef15, v62
    v_fmac_f32 v38, 0x3ec3ef15, v23
    v_fmac_f32 v71, 0xbf6c835e, v23
    v_sub_f32 v62, v48, v70
    v_sub_f32 v23, v49, v79
    v_add_f32 v48, v48, v70
    v_add_f32 v49, v49, v79
    v_sub_f32 v70, v78, v18
    v_sub_f32 v79, v33, v51
    v_add_f32 v78, v78, v18
    v_add_f32 v33, v33, v51
    v_mul_f32 v18, 0x3f6c835e, v70
    v_mul_f32 v51, 0xbec3ef15, v70
    v_fmac_f32 v18, 0x3ec3ef15, v79
    v_fmac_f32 v51, 0x3f6c835e, v79
    v_sub_f32 v70, v32, v50
    v_sub_f32 v79, v25, v35
    v_add_f32 v32, v32, v50
    v_add_f32 v25, v25, v35
    v_mul_f32 v50, 0x3f3504f3, v70
    v_mul_f32 v35, 0xbf3504f3, v70
    v_fmac_f32 v50, 0x3f3504f3, v79
    v_fmac_f32 v35, 0x3f3504f3, v79
    v_sub_f32 v70, v24, v34
    v_sub_f32 v79, v57, v67
    v_add_f32 v24, v24, v34
    v_add_f32 v57, v57, v67
    v_mul_f32 v34, 0x3ec3ef15, v70
    v_mul_f32 v67, 0xbf6c835e, v70
    v_fmac_f32 v34, 0x3f6c835e, v79
    v_fmac_f32 v67, 0x3ec3ef15, v79
    v_sub_f32 v70, v21, v27
    v_sub_f32 v79, v66, v56
    v_add_f32 v56, v56, v66
    v_add_f32 v21, v21, v27
    v_sub_f32 v66, v20, v26
    v_sub_f32 v27, v53, v59
    v_add_f32 v20, v20, v26
    v_add_f32 v53, v53, v59
    v_mul_f32 v26, 0xbec3ef15, v66
    v_mul_f32 v59, 0xbf6c835e, v66
    v_fmac_f32 v26, 0x3f6c835e, v27
    v_fmac_f32 v59, 0xbec3ef15, v27
    v_sub_f32 v66, v52, v58
    v_sub_f32 v27, v37, v43
    v_add_f32 v52, v52, v58
    v_add_f32 v37, v37, v43
    v_mul_f32 v58, 0xbf3504f3, v66
    v_mul_f32 v43, 0xbf3504f3, v66
    v_fmac_f32 v58, 0x3f3504f3, v27
    v_fmac_f32 v43, 0xbf3504f3, v27
    v_sub_f32 v66, v36, v42
    v_sub_f32 v27, v69, v75
    v_add_f32 v36, v36, v42
    v_add_f32 v69, v69, v75
    v_mul_f32 v42, 0xbf6c835e, v66
    v_mul_f32 v75, 0xbec3ef15, v66
    v_fmac_f32 v42, 0x3ec3ef15, v27
    v_fmac_f32 v75, 0xbf6c835e, v27
    v_sub_f32 v66, v16, v40
    v_sub_f32 v27, v17, v73
    v_add_f32 v16, v16, v40
    v_add_f32 v17, v17, v73
    v_sub_f32 v40, v83, v72
    v_sub_f32 v73, v81, v45
    v_add_f32 v83, v83, v72
    v_add_f32 v81, v81, v45
    v_mul_f32 v72, 0x3f3504f3, v40
    v_mul_f32 v45, 0xbf3504f3, v40
    v_fmac_f32 v72, 0x3f3504f3, v73
    v_fmac_f32 v45, 0x3f3504f3, v73
    v_sub_f32 v40, v65, v29
    v_sub_f32 v73, v44, v80
    v_add_f32 v80, v80, v44
    v_add_f32 v65, v65, v29
    v_sub_f32 v44, v64, v28
    v_sub_f32 v29, v41, v61
    v_add_f32 v64, v64, v28
    v_add_f32 v41, v41, v61
    v_mul_f32 v28, 0xbf3504f3, v44
    v_mul_f32 v61, 0xbf3504f3, v44
    v_fmac_f32 v28, 0x3f3504f3, v29
    v_fmac_f32 v61, 0xbf3504f3, v29
    v_sub_f32 v44, v68, v60
    v_sub_f32 v29, v19, v77
    v_add_f32 v68, v68, v60
    v_add_f32 v19, v19, v77
    v_sub_f32 v60, v76, v22
    v_sub_f32 v77, v47, v55
    v_add_f32 v76, v76, v22
    v_add_f32 v47, v47, v55
    v_mul_f32 v22, 0x3f3504f3, v60
    v_mul_f32 v55, 0xbf3504f3, v60
    v_fmac_f32 v22, 0x3f3504f3, v77
    v_fmac_f32 v55, 0x3f3504f3, v77
    v_sub_f32 v60, v31, v39
    v_sub_f32 v77, v54, v46
    v_add_f32 v46, v46, v54
    v_add_f32 v31, v31, v39
    v_sub_f32 v54, v30, v38
    v_sub_f32 v39, v63, v71
    v_add_f32 v30, v30, v38
    v_add_f32 v63, v63, v71
    v_mul_f32 v38, 0xbf3504f3, v54
    v_mul_f32 v71, 0xbf3504f3, v54
    v_fmac_f32 v38, 0x3f3504f3, v39
    v_fmac_f32 v71, 0xbf3504f3, v39
    v_sub_f32 v54, v48, v56
    v_sub_f32 v39, v49, v21
    v_add_f32 v48, v48, v56
    v_add_f32 v49, v49, v21
    v_sub_f32 v56, v78, v20
    v_sub_f32 v21, v33, v53
    v_add_f32 v78, v78, v20
    v_add_f32 v33, v33, v53
    v_mul_f32 v20, 0x3f3504f3, v56
    v_mul_f32 v53, 0xbf3504f3, v56
    v_fmac_f32 v20, 0x3f3504f3, v21
    v_fmac_f32 v53, 0x3f3504f3, v21
    v_sub_f32 v56, v25, v37
    v_sub_f32 v21, v52, v32
    v_add_f32 v32, v32, v52
    v_add_f32 v25, v25, v37
    v_sub_f32 v52, v24, v36
    v_sub_f32 v37, v57, v69
    v_add_f32 v24, v24, v36
    v_add_f32 v57, v57, v69
    v_mul_f32 v36, 0xbf3504f3, v52
    v_mul_f32 v69, 0xbf3504f3, v52
    v_fmac_f32 v36, 0x3f3504f3, v37
    v_fmac_f32 v69, 0xbf3504f3, v37
    v_sub_f32 v52, v62, v70
    v_sub_f32 v37, v23, v79
    v_add_f32 v62, v62, v70
    v_add_f32 v23, v23, v79
    v_sub_f32 v70, v18, v26
    v_sub_f32 v79, v51, v59
    v_add_f32 v18, v18, v26
    v_add_f32 v51, v51, v59
    v_mul_f32 v26, 0x3f3504f3, v70
    v_mul_f32 v59, 0xbf3504f3, v70
    v_fmac_f32 v26, 0x3f3504f3, v79
    v_fmac_f32 v59, 0x3f3504f3, v79
    v_sub_f32 v70, v35, v43
    v_sub_f32 v79, v58, v50
    v_add_f32 v50, v50, v58
    v_add_f32 v35, v35, v43
    v_sub_f32 v58, v34, v42
    v_sub_f32 v43, v67, v75
    v_add_f32 v34, v34, v42
    v_add_f32 v67, v67, v75
    v_mul_f32 v42, 0xbf3504f3, v58
    v_mul_f32 v75, 0xbf3504f3, v58
    v_fmac_f32 v42, 0x3f3504f3, v43
    v_fmac_f32 v75, 0xbf3504f3, v43
    v_sub_f32 v58, v16, v80
    v_sub_f32 v43, v17, v65
    v_add_f32 v16, v16, v80
    v_add_f32 v17, v17, v65
    v_sub_f32 v80, v81, v41
    v_sub_f32 v65, v64, v83
    v_add_f32 v83, v83, v64
    v_add_f32 v81, v81, v41
    v_sub_f32 v64, v66, v40
    v_sub_f32 v41, v27, v73
    v_add_f32 v66, v66, v40
    v_add_f32 v27, v27, v73
    v_sub_f32 v40, v45, v61
    v_sub_f32 v73, v28, v72
    v_add_f32 v72, v72, v28
    v_add_f32 v45, v45, v61
    v_sub_f32 v28, v68, v46
    v_sub_f32 v61, v19, v31
    v_add_f32 v68, v68, v46
    v_add_f32 v19, v19, v31
    v_sub_f32 v46, v47, v63
    v_sub_f32 v31, v30, v76
    v_add_f32 v76, v76, v30
    v_add_f32 v47, v47, v63
    v_sub_f32 v30, v44, v60
    v_sub_f32 v63, v29, v77
    v_add_f32 v44, v44, v60
    v_add_f32 v29, v29, v77
    v_sub_f32 v60, v55, v71
    v_sub_f32 v77, v38, v22
    v_add_f32 v22, v22, v38
    v_add_f32 v55, v55, v71
    v_sub_f32 v38, v48, v32
    v_sub_f32 v71, v49, v25
    v_add_f32 v48, v48, v32
    v_add_f32 v49, v49, v25
    v_sub_f32 v32, v33, v57
    v_sub_f32 v25, v24, v78
    v_add_f32 v78, v78, v24
    v_add_f32 v33, v33, v57
    v_sub_f32 v24, v54, v56
    v_sub_f32 v57, v39, v21
    v_add_f32 v54, v54, v56
    v_add_f32 v39, v39, v21
    v_sub_f32 v56, v53, v69
    v_sub_f32 v21, v36, v20
    v_add_f32 v20, v20, v36
    v_add_f32 v53, v53, v69
    v_sub_f32 v36, v62, v50
    v_sub_f32 v69, v23, v35
    v_add_f32 v62, v62, v50
    v_add_f32 v23, v23, v35
    v_sub_f32 v50, v51, v67
    v_sub_f32 v35, v34, v18
    v_add_f32 v18, v18, v34
    v_add_f32 v51, v51, v67
    v_sub_f32 v34, v52, v70
    v_sub_f32 v67, v37, v79
    v_add_f32 v52, v52, v70
    v_add_f32 v37, v37, v79
    v_sub_f32 v70, v59, v75
    v_sub_f32 v79, v42, v26
    v_add_f32 v26, v26, v42
    v_add_f32 v59, v59, v75
    v_sub_f32 v42, v16, v83
    v_sub_f32 v75, v17, v81
    v_add_f32 v16, v16, v83
    v_add_f32 v17, v17, v81
    v_sub_f32 v83, v58, v80
    v_sub_f32 v81, v43, v65
    v_add_f32 v58, v58, v80
    v_add_f32 v43, v43, v65
    v_sub_f32 v80, v66, v72
    v_sub_f32 v65, v27, v45
    v_add_f32 v66, v66, v72
    v_add_f32 v27, v27, v45
    v_sub_f32 v72, v64, v40
    v_sub_f32 v45, v41, v73
    v_add_f32 v64, v64, v40
    v_add_f32 v41, v41, v73
    v_sub_f32 v40, v68, v76
    v_sub_f32 v73, v19, v47
    v_add_f32 v68, v68, v76
    v_add_f32 v19, v19, v47
    v_sub_f32 v76, v28, v46
    v_sub_f32 v47, v61, v31
    v_add_f32 v28, v28, v46
    v_add_f32 v61, v61, v31
    v_sub_f32 v46, v44, v22
    v_sub_f32 v31, v29, v55
    v_add_f32 v44, v44, v22
    v_add_f32 v29, v29, v55
    v_sub_f32 v22, v30, v60
    v_sub_f32 v55, v63, v77
    v_add_f32 v30, v30, v60
    v_add_f32 v63, v63, v77
    v_sub_f32 v60, v48, v78
    v_sub_f32 v77, v49, v33
    v_add_f32 v48, v48, v78
    v_add_f32 v49, v49, v33
    v_sub_f32 v78, v38, v32
    v_sub_f32 v33, v71, v25
    v_add_f32 v38, v38, v32
    v_add_f32 v71, v71, v25
    v_sub_f32 v32, v54, v20
    v_sub_f32 v25, v39, v53
    v_add_f32 v54, v54, v20
    v_add_f32 v39, v39, v53
    v_sub_f32 v20, v24, v56
    v_sub_f32 v53, v57, v21
    v_add_f32 v24, v24, v56
    v_add_f32 v57, v57, v21
    v_sub_f32 v56, v62, v18
    v_sub_f32 v21, v23, v51
    v_add_f32 v62, v62, v18
    v_add_f32 v23, v23, v51
    v_sub_f32 v18, v36, v50
    v_sub_f32 v51, v69, v35
    v_add_f32 v36, v36, v50
    v_add_f32 v69, v69, v35
    v_sub_f32 v50, v52, v26
    v_sub_f32 v35, v37, v59
    v_add_f32 v52, v52, v26
    v_add_f32 v37, v37, v59
    v_sub_f32 v26, v34, v70
    v_sub_f32 v59, v67, v79
    v_add_f32 v34, v34, v70
    v_add_f32 v67, v67, v79
    v_mul_f32 v70, 0xbc800000, v10
    v_cos_f32 v79, v70
    v_sin_f32 v82, v70
    s_nop 0
    v_mul_f32 v74, v48, v79
    v_fma_f32 v74, -v49, v82, v74
    v_mul_f32 v49, v49, v79
    v_fmac_f32 v49, v48, v82
    v_mul_f32 v70, 0xbd000000, v10
    v_cos_f32 v79, v70
    v_sin_f32 v82, v70
    s_nop 0
    v_mul_f32 v48, v68, v79
    v_fma_f32 v48, -v19, v82, v48
    v_mul_f32 v19, v19, v79
    v_fmac_f32 v19, v68, v82
    v_mul_f32 v70, 0xbd400000, v10
    v_cos_f32 v79, v70
    v_sin_f32 v82, v70
    s_nop 0
    v_mul_f32 v68, v62, v79
    v_fma_f32 v68, -v23, v82, v68
    v_mul_f32 v23, v23, v79
    v_fmac_f32 v23, v62, v82
    v_mul_f32 v70, 0xbd800000, v10
    v_cos_f32 v79, v70
    v_sin_f32 v82, v70
    s_nop 0
    v_mul_f32 v62, v66, v79
    v_fma_f32 v62, -v27, v82, v62
    v_mul_f32 v27, v27, v79
    v_fmac_f32 v27, v66, v82
    v_mul_f32 v70, 0xbda00000, v10
    v_cos_f32 v79, v70
    v_sin_f32 v82, v70
    s_nop 0
    v_mul_f32 v66, v54, v79
    v_fma_f32 v66, -v39, v82, v66
    v_mul_f32 v39, v39, v79
    v_fmac_f32 v39, v54, v82
    v_mul_f32 v70, 0xbdc00000, v10
    v_cos_f32 v79, v70
    v_sin_f32 v82, v70
    s_nop 0
    v_mul_f32 v54, v44, v79
    v_fma_f32 v54, -v29, v82, v54
    v_mul_f32 v29, v29, v79
    v_fmac_f32 v29, v44, v82
    v_mul_f32 v70, 0xbde00000, v10
    v_cos_f32 v79, v70
    v_sin_f32 v82, v70
    s_nop 0
    v_mul_f32 v44, v52, v79
    v_fma_f32 v44, -v37, v82, v44
    v_mul_f32 v37, v37, v79
    v_fmac_f32 v37, v52, v82
    v_mul_f32 v70, 0xbe000000, v10
    v_cos_f32 v79, v70
    v_sin_f32 v82, v70
    s_nop 0
    v_mul_f32 v52, v58, v79
    v_fma_f32 v52, -v43, v82, v52
    v_mul_f32 v43, v43, v79
    v_fmac_f32 v43, v58, v82
    v_mul_f32 v70, 0xbe100000, v10
    v_cos_f32 v79, v70
    v_sin_f32 v82, v70
    s_nop 0
    v_mul_f32 v58, v38, v79
    v_fma_f32 v58, -v71, v82, v58
    v_mul_f32 v71, v71, v79
    v_fmac_f32 v71, v38, v82
    v_mul_f32 v70, 0xbe200000, v10
    v_cos_f32 v79, v70
    v_sin_f32 v82, v70
    s_nop 0
    v_mul_f32 v38, v28, v79
    v_fma_f32 v38, -v61, v82, v38
    v_mul_f32 v61, v61, v79
    v_fmac_f32 v61, v28, v82
    v_mul_f32 v70, 0xbe300000, v10
    v_cos_f32 v79, v70
    v_sin_f32 v82, v70
    s_nop 0
    v_mul_f32 v28, v36, v79
    v_fma_f32 v28, -v69, v82, v28
    v_mul_f32 v69, v69, v79
    v_fmac_f32 v69, v36, v82
    v_mul_f32 v70, 0xbe400000, v10
    v_cos_f32 v79, v70
    v_sin_f32 v82, v70
    s_nop 0
    v_mul_f32 v36, v64, v79
    v_fma_f32 v36, -v41, v82, v36
    v_mul_f32 v41, v41, v79
    v_fmac_f32 v41, v64, v82
    v_mul_f32 v70, 0xbe500000, v10
    v_cos_f32 v79, v70
    v_sin_f32 v82, v70
    s_nop 0
    v_mul_f32 v64, v24, v79
    v_fma_f32 v64, -v57, v82, v64
    v_mul_f32 v57, v57, v79
    v_fmac_f32 v57, v24, v82
    v_mul_f32 v70, 0xbe600000, v10
    v_cos_f32 v79, v70
    v_sin_f32 v82, v70
    s_nop 0
    v_mul_f32 v24, v30, v79
    v_fma_f32 v24, -v63, v82, v24
    v_mul_f32 v63, v63, v79
    v_fmac_f32 v63, v30, v82
    v_mul_f32 v70, 0xbe700000, v10
    v_cos_f32 v79, v70
    v_sin_f32 v82, v70
    s_nop 0
    v_mul_f32 v30, v34, v79
    v_fma_f32 v30, -v67, v82, v30
    v_mul_f32 v67, v67, v79
    v_fmac_f32 v67, v34, v82
    v_mul_f32 v70, 0xbe800000, v10
    v_cos_f32 v79, v70
    v_sin_f32 v82, v70
    s_nop 0
    v_mul_f32 v34, v42, v79
    v_fma_f32 v34, -v75, v82, v34
    v_mul_f32 v75, v75, v79
    v_fmac_f32 v75, v42, v82
    v_mul_f32 v70, 0xbe880000, v10
    v_cos_f32 v79, v70
    v_sin_f32 v82, v70
    s_nop 0
    v_mul_f32 v42, v60, v79
    v_fma_f32 v42, -v77, v82, v42
    v_mul_f32 v77, v77, v79
    v_fmac_f32 v77, v60, v82
    v_mul_f32 v70, 0xbe900000, v10
    v_cos_f32 v79, v70
    v_sin_f32 v82, v70
    s_nop 0
    v_mul_f32 v60, v40, v79
    v_fma_f32 v60, -v73, v82, v60
    v_mul_f32 v73, v73, v79
    v_fmac_f32 v73, v40, v82
    v_mul_f32 v70, 0xbe980000, v10
    v_cos_f32 v79, v70
    v_sin_f32 v82, v70
    s_nop 0
    v_mul_f32 v40, v56, v79
    v_fma_f32 v40, -v21, v82, v40
    v_mul_f32 v21, v21, v79
    v_fmac_f32 v21, v56, v82
    v_mul_f32 v70, 0xbea00000, v10
    v_cos_f32 v79, v70
    v_sin_f32 v82, v70
    s_nop 0
    v_mul_f32 v56, v80, v79
    v_fma_f32 v56, -v65, v82, v56
    v_mul_f32 v65, v65, v79
    v_fmac_f32 v65, v80, v82
    v_mul_f32 v70, 0xbea80000, v10
    v_cos_f32 v79, v70
    v_sin_f32 v82, v70
    s_nop 0
    v_mul_f32 v80, v32, v79
    v_fma_f32 v80, -v25, v82, v80
    v_mul_f32 v25, v25, v79
    v_fmac_f32 v25, v32, v82
    v_mul_f32 v70, 0xbeb00000, v10
    v_cos_f32 v79, v70
    v_sin_f32 v82, v70
    s_nop 0
    v_mul_f32 v32, v46, v79
    v_fma_f32 v32, -v31, v82, v32
    v_mul_f32 v31, v31, v79
    v_fmac_f32 v31, v46, v82
    v_mul_f32 v70, 0xbeb80000, v10
    v_cos_f32 v79, v70
    v_sin_f32 v82, v70
    s_nop 0
    v_mul_f32 v46, v50, v79
    v_fma_f32 v46, -v35, v82, v46
    v_mul_f32 v35, v35, v79
    v_fmac_f32 v35, v50, v82
    v_mul_f32 v70, 0xbec00000, v10
    v_cos_f32 v79, v70
    v_sin_f32 v82, v70
    s_nop 0
    v_mul_f32 v50, v83, v79
    v_fma_f32 v50, -v81, v82, v50
    v_mul_f32 v81, v81, v79
    v_fmac_f32 v81, v83, v82
    v_mul_f32 v70, 0xbec80000, v10
    v_cos_f32 v79, v70
    v_sin_f32 v82, v70
    s_nop 0
    v_mul_f32 v83, v78, v79
    v_fma_f32 v83, -v33, v82, v83
    v_mul_f32 v33, v33, v79
    v_fmac_f32 v33, v78, v82
    v_mul_f32 v70, 0xbed00000, v10
    v_cos_f32 v79, v70
    v_sin_f32 v82, v70
    s_nop 0
    v_mul_f32 v78, v76, v79
    v_fma_f32 v78, -v47, v82, v78
    v_mul_f32 v47, v47, v79
    v_fmac_f32 v47, v76, v82
    v_mul_f32 v70, 0xbed80000, v10
    v_cos_f32 v79, v70
    v_sin_f32 v82, v70
    s_nop 0
    v_mul_f32 v76, v18, v79
    v_fma_f32 v76, -v51, v82, v76
    v_mul_f32 v51, v51, v79
    v_fmac_f32 v51, v18, v82
    v_mul_f32 v70, 0xbee00000, v10
    v_cos_f32 v79, v70
    v_sin_f32 v82, v70
    s_nop 0
    v_mul_f32 v18, v72, v79
    v_fma_f32 v18, -v45, v82, v18
    v_mul_f32 v45, v45, v79
    v_fmac_f32 v45, v72, v82
    v_mul_f32 v70, 0xbee80000, v10
    v_cos_f32 v79, v70
    v_sin_f32 v82, v70
    s_nop 0
    v_mul_f32 v72, v20, v79
    v_fma_f32 v72, -v53, v82, v72
    v_mul_f32 v53, v53, v79
    v_fmac_f32 v53, v20, v82
    v_mul_f32 v70, 0xbef00000, v10
    v_cos_f32 v79, v70
    v_sin_f32 v82, v70
    s_nop 0
    v_mul_f32 v20, v22, v79
    v_fma_f32 v20, -v55, v82, v20
    v_mul_f32 v55, v55, v79
    v_fmac_f32 v55, v22, v82
    v_mul_f32 v70, 0xbef80000, v10
    v_cos_f32 v79, v70
    v_sin_f32 v82, v70
    s_nop 0
    v_mul_f32 v22, v26, v79
    v_fma_f32 v22, -v59, v82, v22
    v_mul_f32 v59, v59, v79
    v_fmac_f32 v59, v26, v82
    s_nop 1
    v_mov_b32_dpp v70, v16 quad_perm:[1,0,3,2] row_mask:0xf bank_mask:0xf
    v_fma_f32 v16, v16, v9, v70
    v_mov_b32_dpp v70, v17 quad_perm:[1,0,3,2] row_mask:0xf bank_mask:0xf
    v_fma_f32 v17, v17, v9, v70
    v_mov_b32_dpp v70, v74 quad_perm:[1,0,3,2] row_mask:0xf bank_mask:0xf
    v_fma_f32 v74, v74, v9, v70
    v_mov_b32_dpp v70, v49 quad_perm:[1,0,3,2] row_mask:0xf bank_mask:0xf
    v_fma_f32 v49, v49, v9, v70
    v_mov_b32_dpp v70, v48 quad_perm:[1,0,3,2] row_mask:0xf bank_mask:0xf
    v_fma_f32 v48, v48, v9, v70
    v_mov_b32_dpp v70, v19 quad_perm:[1,0,3,2] row_mask:0xf bank_mask:0xf
    v_fma_f32 v19, v19, v9, v70
    v_mov_b32_dpp v70, v68 quad_perm:[1,0,3,2] row_mask:0xf bank_mask:0xf
    v_fma_f32 v68, v68, v9, v70
    v_mov_b32_dpp v70, v23 quad_perm:[1,0,3,2] row_mask:0xf bank_mask:0xf
    v_fma_f32 v23, v23, v9, v70
    v_mov_b32_dpp v70, v62 quad_perm:[1,0,3,2] row_mask:0xf bank_mask:0xf
    v_fma_f32 v62, v62, v9, v70
    v_mov_b32_dpp v70, v27 quad_perm:[1,0,3,2] row_mask:0xf bank_mask:0xf
    v_fma_f32 v27, v27, v9, v70
    v_mov_b32_dpp v70, v66 quad_perm:[1,0,3,2] row_mask:0xf bank_mask:0xf
    v_fma_f32 v66, v66, v9, v70
    v_mov_b32_dpp v70, v39 quad_perm:[1,0,3,2] row_mask:0xf bank_mask:0xf
    v_fma_f32 v39, v39, v9, v70
    v_mov_b32_dpp v70, v54 quad_perm:[1,0,3,2] row_mask:0xf bank_mask:0xf
    v_fma_f32 v54, v54, v9, v70
    v_mov_b32_dpp v70, v29 quad_perm:[1,0,3,2] row_mask:0xf bank_mask:0xf
    v_fma_f32 v29, v29, v9, v70
    v_mov_b32_dpp v70, v44 quad_perm:[1,0,3,2] row_mask:0xf bank_mask:0xf
    v_fma_f32 v44, v44, v9, v70
    v_mov_b32_dpp v70, v37 quad_perm:[1,0,3,2] row_mask:0xf bank_mask:0xf
    v_fma_f32 v37, v37, v9, v70
    v_mov_b32_dpp v70, v52 quad_perm:[1,0,3,2] row_mask:0xf bank_mask:0xf
    v_fma_f32 v52, v52, v9, v70
    v_mov_b32_dpp v70, v43 quad_perm:[1,0,3,2] row_mask:0xf bank_mask:0xf
    v_fma_f32 v43, v43, v9, v70
    v_mov_b32_dpp v70, v58 quad_perm:[1,0,3,2] row_mask:0xf bank_mask:0xf
    v_fma_f32 v58, v58, v9, v70
    v_mov_b32_dpp v70, v71 quad_perm:[1,0,3,2] row_mask:0xf bank_mask:0xf
    v_fma_f32 v71, v71, v9, v70
    v_mov_b32_dpp v70, v38 quad_perm:[1,0,3,2] row_mask:0xf bank_mask:0xf
    v_fma_f32 v38, v38, v9, v70
    v_mov_b32_dpp v70, v61 quad_perm:[1,0,3,2] row_mask:0xf bank_mask:0xf
    v_fma_f32 v61, v61, v9, v70
    v_mov_b32_dpp v70, v28 quad_perm:[1,0,3,2] row_mask:0xf bank_mask:0xf
    v_fma_f32 v28, v28, v9, v70
    v_mov_b32_dpp v70, v69 quad_perm:[1,0,3,2] row_mask:0xf bank_mask:0xf
    v_fma_f32 v69, v69, v9, v70
    v_mov_b32_dpp v70, v36 quad_perm:[1,0,3,2] row_mask:0xf bank_mask:0xf
    v_fma_f32 v36, v36, v9, v70
    v_mov_b32_dpp v70, v41 quad_perm:[1,0,3,2] row_mask:0xf bank_mask:0xf
    v_fma_f32 v41, v41, v9, v70
    v_mov_b32_dpp v70, v64 quad_perm:[1,0,3,2] row_mask:0xf bank_mask:0xf
    v_fma_f32 v64, v64, v9, v70
    v_mov_b32_dpp v70, v57 quad_perm:[1,0,3,2] row_mask:0xf bank_mask:0xf
    v_fma_f32 v57, v57, v9, v70
    v_mov_b32_dpp v70, v24 quad_perm:[1,0,3,2] row_mask:0xf bank_mask:0xf
    v_fma_f32 v24, v24, v9, v70
    v_mov_b32_dpp v70, v63 quad_perm:[1,0,3,2] row_mask:0xf bank_mask:0xf
    v_fma_f32 v63, v63, v9, v70
    v_mov_b32_dpp v70, v30 quad_perm:[1,0,3,2] row_mask:0xf bank_mask:0xf
    v_fma_f32 v30, v30, v9, v70
    v_mov_b32_dpp v70, v67 quad_perm:[1,0,3,2] row_mask:0xf bank_mask:0xf
    v_fma_f32 v67, v67, v9, v70
    v_mov_b32_dpp v70, v34 quad_perm:[1,0,3,2] row_mask:0xf bank_mask:0xf
    v_fma_f32 v34, v34, v9, v70
    v_mov_b32_dpp v70, v75 quad_perm:[1,0,3,2] row_mask:0xf bank_mask:0xf
    v_fma_f32 v75, v75, v9, v70
    v_mov_b32_dpp v70, v42 quad_perm:[1,0,3,2] row_mask:0xf bank_mask:0xf
    v_fma_f32 v42, v42, v9, v70
    v_mov_b32_dpp v70, v77 quad_perm:[1,0,3,2] row_mask:0xf bank_mask:0xf
    v_fma_f32 v77, v77, v9, v70
    v_mov_b32_dpp v70, v60 quad_perm:[1,0,3,2] row_mask:0xf bank_mask:0xf
    v_fma_f32 v60, v60, v9, v70
    v_mov_b32_dpp v70, v73 quad_perm:[1,0,3,2] row_mask:0xf bank_mask:0xf
    v_fma_f32 v73, v73, v9, v70
    v_mov_b32_dpp v70, v40 quad_perm:[1,0,3,2] row_mask:0xf bank_mask:0xf
    v_fma_f32 v40, v40, v9, v70
    v_mov_b32_dpp v70, v21 quad_perm:[1,0,3,2] row_mask:0xf bank_mask:0xf
    v_fma_f32 v21, v21, v9, v70
    v_mov_b32_dpp v70, v56 quad_perm:[1,0,3,2] row_mask:0xf bank_mask:0xf
    v_fma_f32 v56, v56, v9, v70
    v_mov_b32_dpp v70, v65 quad_perm:[1,0,3,2] row_mask:0xf bank_mask:0xf
    v_fma_f32 v65, v65, v9, v70
    v_mov_b32_dpp v70, v80 quad_perm:[1,0,3,2] row_mask:0xf bank_mask:0xf
    v_fma_f32 v80, v80, v9, v70
    v_mov_b32_dpp v70, v25 quad_perm:[1,0,3,2] row_mask:0xf bank_mask:0xf
    v_fma_f32 v25, v25, v9, v70
    v_mov_b32_dpp v70, v32 quad_perm:[1,0,3,2] row_mask:0xf bank_mask:0xf
    v_fma_f32 v32, v32, v9, v70
    v_mov_b32_dpp v70, v31 quad_perm:[1,0,3,2] row_mask:0xf bank_mask:0xf
    v_fma_f32 v31, v31, v9, v70
    v_mov_b32_dpp v70, v46 quad_perm:[1,0,3,2] row_mask:0xf bank_mask:0xf
    v_fma_f32 v46, v46, v9, v70
    v_mov_b32_dpp v70, v35 quad_perm:[1,0,3,2] row_mask:0xf bank_mask:0xf
    v_fma_f32 v35, v35, v9, v70
    v_mov_b32_dpp v70, v50 quad_perm:[1,0,3,2] row_mask:0xf bank_mask:0xf
    v_fma_f32 v50, v50, v9, v70
    v_mov_b32_dpp v70, v81 quad_perm:[1,0,3,2] row_mask:0xf bank_mask:0xf
    v_fma_f32 v81, v81, v9, v70
    v_mov_b32_dpp v70, v83 quad_perm:[1,0,3,2] row_mask:0xf bank_mask:0xf
    v_fma_f32 v83, v83, v9, v70
    v_mov_b32_dpp v70, v33 quad_perm:[1,0,3,2] row_mask:0xf bank_mask:0xf
    v_fma_f32 v33, v33, v9, v70
    v_mov_b32_dpp v70, v78 quad_perm:[1,0,3,2] row_mask:0xf bank_mask:0xf
    v_fma_f32 v78, v78, v9, v70
    v_mov_b32_dpp v70, v47 quad_perm:[1,0,3,2] row_mask:0xf bank_mask:0xf
    v_fma_f32 v47, v47, v9, v70
    v_mov_b32_dpp v70, v76 quad_perm:[1,0,3,2] row_mask:0xf bank_mask:0xf
    v_fma_f32 v76, v76, v9, v70
    v_mov_b32_dpp v70, v51 quad_perm:[1,0,3,2] row_mask:0xf bank_mask:0xf
    v_fma_f32 v51, v51, v9, v70
    v_mov_b32_dpp v70, v18 quad_perm:[1,0,3,2] row_mask:0xf bank_mask:0xf
    v_fma_f32 v18, v18, v9, v70
    v_mov_b32_dpp v70, v45 quad_perm:[1,0,3,2] row_mask:0xf bank_mask:0xf
    v_fma_f32 v45, v45, v9, v70
    v_mov_b32_dpp v70, v72 quad_perm:[1,0,3,2] row_mask:0xf bank_mask:0xf
    v_fma_f32 v72, v72, v9, v70
    v_mov_b32_dpp v70, v53 quad_perm:[1,0,3,2] row_mask:0xf bank_mask:0xf
    v_fma_f32 v53, v53, v9, v70
    v_mov_b32_dpp v70, v20 quad_perm:[1,0,3,2] row_mask:0xf bank_mask:0xf
    v_fma_f32 v20, v20, v9, v70
    v_mov_b32_dpp v70, v55 quad_perm:[1,0,3,2] row_mask:0xf bank_mask:0xf
    v_fma_f32 v55, v55, v9, v70
    v_mov_b32_dpp v70, v22 quad_perm:[1,0,3,2] row_mask:0xf bank_mask:0xf
    v_fma_f32 v22, v22, v9, v70
    v_mov_b32_dpp v70, v59 quad_perm:[1,0,3,2] row_mask:0xf bank_mask:0xf
    v_fma_f32 v59, v59, v9, v70
    s_waitcnt vmcnt(0)
    s_mov_b32 s20, 0x34800000
    v_lshlrev_b32 v70, 16, v88
    v_and_b32 v79, 0xffff0000, v88
    v_mul_f32 v70, s20, v70
    v_mul_f32 v79, s20, v79
    v_mul_f32 v82, v16, v70
    v_fma_f32 v82, -v17, v79, v82
    v_mul_f32 v17, v17, v70
    v_fmac_f32 v17, v16, v79
    v_lshlrev_b32 v70, 16, v89
    v_and_b32 v79, 0xffff0000, v89
    v_mul_f32 v70, s20, v70
    v_mul_f32 v79, s20, v79
    v_mul_f32 v16, v74, v70
    v_fma_f32 v16, -v49, v79, v16
    v_mul_f32 v49, v49, v70
    v_fmac_f32 v49, v74, v79
    v_lshlrev_b32 v70, 16, v90
    v_and_b32 v79, 0xffff0000, v90
    v_mul_f32 v70, s20, v70
    v_mul_f32 v79, s20, v79
    v_mul_f32 v74, v48, v70
    v_fma_f32 v74, -v19, v79, v74
    v_mul_f32 v19, v19, v70
    v_fmac_f32 v19, v48, v79
    v_lshlrev_b32 v70, 16, v91
    v_and_b32 v79, 0xffff0000, v91
    v_mul_f32 v70, s20, v70
    v_mul_f32 v79, s20, v79
    v_mul_f32 v48, v68, v70
    v_fma_f32 v48, -v23, v79, v48
    v_mul_f32 v23, v23, v70
    v_fmac_f32 v23, v68, v79
    v_lshlrev_b32 v70, 16, v92
    v_and_b32 v79, 0xffff0000, v92
    v_mul_f32 v70, s20, v70
    v_mul_f32 v79, s20, v79
    v_mul_f32 v68, v62, v70
    v_fma_f32 v68, -v27, v79, v68
    v_mul_f32 v27, v27, v70
    v_fmac_f32 v27, v62, v79
    v_lshlrev_b32 v70, 16, v93
    v_and_b32 v79, 0xffff0000, v93
    v_mul_f32 v70, s20, v70
    v_mul_f32 v79, s20, v79
    v_mul_f32 v62, v66, v70
    v_fma_f32 v62, -v39, v79, v62
    v_mul_f32 v39, v39, v70
    v_fmac_f32 v39, v66, v79
    v_lshlrev_b32 v70, 16, v94
    v_and_b32 v79, 0xffff0000, v94
    v_mul_f32 v70, s20, v70
    v_mul_f32 v79, s20, v79
    v_mul_f32 v66, v54, v70
    v_fma_f32 v66, -v29, v79, v66
    v_mul_f32 v29, v29, v70
    v_fmac_f32 v29, v54, v79
    v_lshlrev_b32 v70, 16, v95
    v_and_b32 v79, 0xffff0000, v95
    v_mul_f32 v70, s20, v70
    v_mul_f32 v79, s20, v79
    v_mul_f32 v54, v44, v70
    v_fma_f32 v54, -v37, v79, v54
    v_mul_f32 v37, v37, v70
    v_fmac_f32 v37, v44, v79
    v_lshlrev_b32 v70, 16, v96
    v_and_b32 v79, 0xffff0000, v96
    v_mul_f32 v70, s20, v70
    v_mul_f32 v79, s20, v79
    v_mul_f32 v44, v52, v70
    v_fma_f32 v44, -v43, v79, v44
    v_mul_f32 v43, v43, v70
    v_fmac_f32 v43, v52, v79
    v_lshlrev_b32 v70, 16, v97
    v_and_b32 v79, 0xffff0000, v97
    v_mul_f32 v70, s20, v70
    v_mul_f32 v79, s20, v79
    v_mul_f32 v52, v58, v70
    v_fma_f32 v52, -v71, v79, v52
    v_mul_f32 v71, v71, v70
    v_fmac_f32 v71, v58, v79
    v_lshlrev_b32 v70, 16, v98
    v_and_b32 v79, 0xffff0000, v98
    v_mul_f32 v70, s20, v70
    v_mul_f32 v79, s20, v79
    v_mul_f32 v58, v38, v70
    v_fma_f32 v58, -v61, v79, v58
    v_mul_f32 v61, v61, v70
    v_fmac_f32 v61, v38, v79
    v_lshlrev_b32 v70, 16, v99
    v_and_b32 v79, 0xffff0000, v99
    v_mul_f32 v70, s20, v70
    v_mul_f32 v79, s20, v79
    v_mul_f32 v38, v28, v70
    v_fma_f32 v38, -v69, v79, v38
    v_mul_f32 v69, v69, v70
    v_fmac_f32 v69, v28, v79
    v_lshlrev_b32 v70, 16, v100
    v_and_b32 v79, 0xffff0000, v100
    v_mul_f32 v70, s20, v70
    v_mul_f32 v79, s20, v79
    v_mul_f32 v28, v36, v70
    v_fma_f32 v28, -v41, v79, v28
    v_mul_f32 v41, v41, v70
    v_fmac_f32 v41, v36, v79
    v_lshlrev_b32 v70, 16, v101
    v_and_b32 v79, 0xffff0000, v101
    v_mul_f32 v70, s20, v70
    v_mul_f32 v79, s20, v79
    v_mul_f32 v36, v64, v70
    v_fma_f32 v36, -v57, v79, v36
    v_mul_f32 v57, v57, v70
    v_fmac_f32 v57, v64, v79
    v_lshlrev_b32 v70, 16, v102
    v_and_b32 v79, 0xffff0000, v102
    v_mul_f32 v70, s20, v70
    v_mul_f32 v79, s20, v79
    v_mul_f32 v64, v24, v70
    v_fma_f32 v64, -v63, v79, v64
    v_mul_f32 v63, v63, v70
    v_fmac_f32 v63, v24, v79
    v_lshlrev_b32 v70, 16, v103
    v_and_b32 v79, 0xffff0000, v103
    v_mul_f32 v70, s20, v70
    v_mul_f32 v79, s20, v79
    v_mul_f32 v24, v30, v70
    v_fma_f32 v24, -v67, v79, v24
    v_mul_f32 v67, v67, v70
    v_fmac_f32 v67, v30, v79
    v_lshlrev_b32 v70, 16, v104
    v_and_b32 v79, 0xffff0000, v104
    v_mul_f32 v70, s20, v70
    v_mul_f32 v79, s20, v79
    v_mul_f32 v30, v34, v70
    v_fma_f32 v30, -v75, v79, v30
    v_mul_f32 v75, v75, v70
    v_fmac_f32 v75, v34, v79
    v_lshlrev_b32 v70, 16, v105
    v_and_b32 v79, 0xffff0000, v105
    v_mul_f32 v70, s20, v70
    v_mul_f32 v79, s20, v79
    v_mul_f32 v34, v42, v70
    v_fma_f32 v34, -v77, v79, v34
    v_mul_f32 v77, v77, v70
    v_fmac_f32 v77, v42, v79
    v_lshlrev_b32 v70, 16, v106
    v_and_b32 v79, 0xffff0000, v106
    v_mul_f32 v70, s20, v70
    v_mul_f32 v79, s20, v79
    v_mul_f32 v42, v60, v70
    v_fma_f32 v42, -v73, v79, v42
    v_mul_f32 v73, v73, v70
    v_fmac_f32 v73, v60, v79
    v_lshlrev_b32 v70, 16, v107
    v_and_b32 v79, 0xffff0000, v107
    v_mul_f32 v70, s20, v70
    v_mul_f32 v79, s20, v79
    v_mul_f32 v60, v40, v70
    v_fma_f32 v60, -v21, v79, v60
    v_mul_f32 v21, v21, v70
    v_fmac_f32 v21, v40, v79
    v_lshlrev_b32 v70, 16, v108
    v_and_b32 v79, 0xffff0000, v108
    v_mul_f32 v70, s20, v70
    v_mul_f32 v79, s20, v79
    v_mul_f32 v40, v56, v70
    v_fma_f32 v40, -v65, v79, v40
    v_mul_f32 v65, v65, v70
    v_fmac_f32 v65, v56, v79
    v_lshlrev_b32 v70, 16, v109
    v_and_b32 v79, 0xffff0000, v109
    v_mul_f32 v70, s20, v70
    v_mul_f32 v79, s20, v79
    v_mul_f32 v56, v80, v70
    v_fma_f32 v56, -v25, v79, v56
    v_mul_f32 v25, v25, v70
    v_fmac_f32 v25, v80, v79
    v_lshlrev_b32 v70, 16, v110
    v_and_b32 v79, 0xffff0000, v110
    v_mul_f32 v70, s20, v70
    v_mul_f32 v79, s20, v79
    v_mul_f32 v80, v32, v70
    v_fma_f32 v80, -v31, v79, v80
    v_mul_f32 v31, v31, v70
    v_fmac_f32 v31, v32, v79
    v_lshlrev_b32 v70, 16, v111
    v_and_b32 v79, 0xffff0000, v111
    v_mul_f32 v70, s20, v70
    v_mul_f32 v79, s20, v79
    v_mul_f32 v32, v46, v70
    v_fma_f32 v32, -v35, v79, v32
    v_mul_f32 v35, v35, v70
    v_fmac_f32 v35, v46, v79
    v_lshlrev_b32 v70, 16, v112
    v_and_b32 v79, 0xffff0000, v112
    v_mul_f32 v70, s20, v70
    v_mul_f32 v79, s20, v79
    v_mul_f32 v46, v50, v70
    v_fma_f32 v46, -v81, v79, v46
    v_mul_f32 v81, v81, v70
    v_fmac_f32 v81, v50, v79
    v_lshlrev_b32 v70, 16, v113
    v_and_b32 v79, 0xffff0000, v113
    v_mul_f32 v70, s20, v70
    v_mul_f32 v79, s20, v79
    v_mul_f32 v50, v83, v70
    v_fma_f32 v50, -v33, v79, v50
    v_mul_f32 v33, v33, v70
    v_fmac_f32 v33, v83, v79
    v_lshlrev_b32 v70, 16, v114
    v_and_b32 v79, 0xffff0000, v114
    v_mul_f32 v70, s20, v70
    v_mul_f32 v79, s20, v79
    v_mul_f32 v83, v78, v70
    v_fma_f32 v83, -v47, v79, v83
    v_mul_f32 v47, v47, v70
    v_fmac_f32 v47, v78, v79
    v_lshlrev_b32 v70, 16, v115
    v_and_b32 v79, 0xffff0000, v115
    v_mul_f32 v70, s20, v70
    v_mul_f32 v79, s20, v79
    v_mul_f32 v78, v76, v70
    v_fma_f32 v78, -v51, v79, v78
    v_mul_f32 v51, v51, v70
    v_fmac_f32 v51, v76, v79
    v_lshlrev_b32 v70, 16, v116
    v_and_b32 v79, 0xffff0000, v116
    v_mul_f32 v70, s20, v70
    v_mul_f32 v79, s20, v79
    v_mul_f32 v76, v18, v70
    v_fma_f32 v76, -v45, v79, v76
    v_mul_f32 v45, v45, v70
    v_fmac_f32 v45, v18, v79
    v_lshlrev_b32 v70, 16, v117
    v_and_b32 v79, 0xffff0000, v117
    v_mul_f32 v70, s20, v70
    v_mul_f32 v79, s20, v79
    v_mul_f32 v18, v72, v70
    v_fma_f32 v18, -v53, v79, v18
    v_mul_f32 v53, v53, v70
    v_fmac_f32 v53, v72, v79
    v_lshlrev_b32 v70, 16, v118
    v_and_b32 v79, 0xffff0000, v118
    v_mul_f32 v70, s20, v70
    v_mul_f32 v79, s20, v79
    v_mul_f32 v72, v20, v70
    v_fma_f32 v72, -v55, v79, v72
    v_mul_f32 v55, v55, v70
    v_fmac_f32 v55, v20, v79
    v_lshlrev_b32 v70, 16, v119
    v_and_b32 v79, 0xffff0000, v119
    v_mul_f32 v70, s20, v70
    v_mul_f32 v79, s20, v79
    v_mul_f32 v20, v22, v70
    v_fma_f32 v20, -v59, v79, v20
    v_mul_f32 v59, v59, v70
    v_fmac_f32 v59, v22, v79
    s_waitcnt vmcnt(0)
    ds_read_b64_tr_b16 a[64:65], v201 offset:0
    ds_read_b64_tr_b16 a[66:67], v201 offset:256
    ds_read_b64_tr_b16 a[68:69], v201 offset:1024
    ds_read_b64_tr_b16 a[70:71], v201 offset:1280
    ds_read_b64_tr_b16 a[72:73], v201 offset:2048
    ds_read_b64_tr_b16 a[74:75], v201 offset:2304
    ds_read_b64_tr_b16 a[76:77], v201 offset:3072
    ds_read_b64_tr_b16 a[78:79], v201 offset:3328
    s_waitcnt lgkmcnt(0)
    ds_read_b64_tr_b16 a[80:81], v201 offset:4096
    ds_read_b64_tr_b16 a[82:83], v201 offset:4352
    ds_read_b64_tr_b16 a[84:85], v201 offset:5120
    ds_read_b64_tr_b16 a[86:87], v201 offset:5376
    ds_read_b64_tr_b16 a[88:89], v201 offset:6144
    ds_read_b64_tr_b16 a[90:91], v201 offset:6400
    ds_read_b64_tr_b16 a[92:93], v201 offset:7168
    ds_read_b64_tr_b16 a[94:95], v201 offset:7424
    s_waitcnt lgkmcnt(0)
    ds_read_b64_tr_b16 a[96:97], v201 offset:8192
    ds_read_b64_tr_b16 a[98:99], v201 offset:8448
    ds_read_b64_tr_b16 a[100:101], v201 offset:9216
    ds_read_b64_tr_b16 a[102:103], v201 offset:9472
    ds_read_b64_tr_b16 a[104:105], v201 offset:10240
    ds_read_b64_tr_b16 a[106:107], v201 offset:10496
    ds_read_b64_tr_b16 a[108:109], v201 offset:11264
    ds_read_b64_tr_b16 a[110:111], v201 offset:11520
    s_waitcnt lgkmcnt(0)
    ds_read_b64_tr_b16 a[112:113], v201 offset:12288
    ds_read_b64_tr_b16 a[114:115], v201 offset:12544
    ds_read_b64_tr_b16 a[116:117], v201 offset:13312
    ds_read_b64_tr_b16 a[118:119], v201 offset:13568
    ds_read_b64_tr_b16 a[120:121], v201 offset:14336
    ds_read_b64_tr_b16 a[122:123], v201 offset:14592
    ds_read_b64_tr_b16 a[124:125], v201 offset:15360
    ds_read_b64_tr_b16 a[126:127], v201 offset:15616
    s_waitcnt lgkmcnt(0)
    s_add_u32 m0, s56, 0
    s_add_u32 s58, s57, 32768
    s_and_b32 s58, s58, 0xffff
    s_lshl_b32 s58, s58, 5
    buffer_load_dwordx4 v200, s[52:55], s58 offen lds
    s_add_u32 m0, s56, 1024
    s_add_u32 s58, s57, 33792
    s_and_b32 s58, s58, 0xffff
    s_lshl_b32 s58, s58, 5
    buffer_load_dwordx4 v200, s[52:55], s58 offen lds
    s_add_u32 m0, s56, 2048
    s_add_u32 s58, s57, 34816
    s_and_b32 s58, s58, 0xffff
    s_lshl_b32 s58, s58, 5
    buffer_load_dwordx4 v200, s[52:55], s58 offen lds
    s_add_u32 m0, s56, 3072
    s_add_u32 s58, s57, 35840
    s_and_b32 s58, s58, 0xffff
    s_lshl_b32 s58, s58, 5
    buffer_load_dwordx4 v200, s[52:55], s58 offen lds
    s_add_u32 m0, s56, 4096
    s_add_u32 s58, s57, 36864
    s_and_b32 s58, s58, 0xffff
    s_lshl_b32 s58, s58, 5
    buffer_load_dwordx4 v200, s[52:55], s58 offen lds
    s_add_u32 m0, s56, 5120
    s_add_u32 s58, s57, 37888
    s_and_b32 s58, s58, 0xffff
    s_lshl_b32 s58, s58, 5
    buffer_load_dwordx4 v200, s[52:55], s58 offen lds
    s_add_u32 m0, s56, 6144
    s_add_u32 s58, s57, 38912
    s_and_b32 s58, s58, 0xffff
    s_lshl_b32 s58, s58, 5
    buffer_load_dwordx4 v200, s[52:55], s58 offen lds
    s_add_u32 m0, s56, 7168
    s_add_u32 s58, s57, 39936
    s_and_b32 s58, s58, 0xffff
    s_lshl_b32 s58, s58, 5
    buffer_load_dwordx4 v200, s[52:55], s58 offen lds
    s_add_u32 m0, s56, 8192
    s_add_u32 s58, s57, 40960
    s_and_b32 s58, s58, 0xffff
    s_lshl_b32 s58, s58, 5
    buffer_load_dwordx4 v200, s[52:55], s58 offen lds
    s_add_u32 m0, s56, 9216
    s_add_u32 s58, s57, 41984
    s_and_b32 s58, s58, 0xffff
    s_lshl_b32 s58, s58, 5
    buffer_load_dwordx4 v200, s[52:55], s58 offen lds
    s_add_u32 m0, s56, 10240
    s_add_u32 s58, s57, 43008
    s_and_b32 s58, s58, 0xffff
    s_lshl_b32 s58, s58, 5
    buffer_load_dwordx4 v200, s[52:55], s58 offen lds
    s_add_u32 m0, s56, 11264
    s_add_u32 s58, s57, 44032
    s_and_b32 s58, s58, 0xffff
    s_lshl_b32 s58, s58, 5
    buffer_load_dwordx4 v200, s[52:55], s58 offen lds
    s_add_u32 m0, s56, 12288
    s_add_u32 s58, s57, 45056
    s_and_b32 s58, s58, 0xffff
    s_lshl_b32 s58, s58, 5
    buffer_load_dwordx4 v200, s[52:55], s58 offen lds
    s_add_u32 m0, s56, 13312
    s_add_u32 s58, s57, 46080
    s_and_b32 s58, s58, 0xffff
    s_lshl_b32 s58, s58, 5
    buffer_load_dwordx4 v200, s[52:55], s58 offen lds
    s_add_u32 m0, s56, 14336
    s_add_u32 s58, s57, 47104
    s_and_b32 s58, s58, 0xffff
    s_lshl_b32 s58, s58, 5
    buffer_load_dwordx4 v200, s[52:55], s58 offen lds
    s_add_u32 m0, s56, 15360
    s_add_u32 s58, s57, 48128
    s_and_b32 s58, s58, 0xffff
    s_lshl_b32 s58, s58, 5
    buffer_load_dwordx4 v200, s[52:55], s58 offen lds
    s_nop 1
    v_mov_b32_dpp v70, v82 quad_perm:[1,0,3,2] row_mask:0xf bank_mask:0xf
    v_fma_f32 v82, v82, v9, v70
    v_mov_b32_dpp v70, v17 quad_perm:[1,0,3,2] row_mask:0xf bank_mask:0xf
    v_fma_f32 v17, v17, v9, v70
    v_mov_b32_dpp v70, v16 quad_perm:[1,0,3,2] row_mask:0xf bank_mask:0xf
    v_fma_f32 v16, v16, v9, v70
    v_mov_b32_dpp v70, v49 quad_perm:[1,0,3,2] row_mask:0xf bank_mask:0xf
    v_fma_f32 v49, v49, v9, v70
    v_mov_b32_dpp v70, v74 quad_perm:[1,0,3,2] row_mask:0xf bank_mask:0xf
    v_fma_f32 v74, v74, v9, v70
    v_mov_b32_dpp v70, v19 quad_perm:[1,0,3,2] row_mask:0xf bank_mask:0xf
    v_fma_f32 v19, v19, v9, v70
    v_mov_b32_dpp v70, v48 quad_perm:[1,0,3,2] row_mask:0xf bank_mask:0xf
    v_fma_f32 v48, v48, v9, v70
    v_mov_b32_dpp v70, v23 quad_perm:[1,0,3,2] row_mask:0xf bank_mask:0xf
    v_fma_f32 v23, v23, v9, v70
    v_mov_b32_dpp v70, v68 quad_perm:[1,0,3,2] row_mask:0xf bank_mask:0xf
    v_fma_f32 v68, v68, v9, v70
    v_mov_b32_dpp v70, v27 quad_perm:[1,0,3,2] row_mask:0xf bank_mask:0xf
    v_fma_f32 v27, v27, v9, v70
    v_mov_b32_dpp v70, v62 quad_perm:[1,0,3,2] row_mask:0xf bank_mask:0xf
    v_fma_f32 v62, v62, v9, v70
    v_mov_b32_dpp v70, v39 quad_perm:[1,0,3,2] row_mask:0xf bank_mask:0xf
    v_fma_f32 v39, v39, v9, v70
    v_mov_b32_dpp v70, v66 quad_perm:[1,0,3,2] row_mask:0xf bank_mask:0xf
    v_fma_f32 v66, v66, v9, v70
    v_mov_b32_dpp v70, v29 quad_perm:[1,0,3,2] row_mask:0xf bank_mask:0xf
    v_fma_f32 v29, v29, v9, v70
    v_mov_b32_dpp v70, v54 quad_perm:[1,0,3,2] row_mask:0xf bank_mask:0xf
    v_fma_f32 v54, v54, v9, v70
    v_mov_b32_dpp v70, v37 quad_perm:[1,0,3,2] row_mask:0xf bank_mask:0xf
    v_fma_f32 v37, v37, v9, v70
    v_mov_b32_dpp v70, v44 quad_perm:[1,0,3,2] row_mask:0xf bank_mask:0xf
    v_fma_f32 v44, v44, v9, v70
    v_mov_b32_dpp v70, v43 quad_perm:[1,0,3,2] row_mask:0xf bank_mask:0xf
    v_fma_f32 v43, v43, v9, v70
    v_mov_b32_dpp v70, v52 quad_perm:[1,0,3,2] row_mask:0xf bank_mask:0xf
    v_fma_f32 v52, v52, v9, v70
    v_mov_b32_dpp v70, v71 quad_perm:[1,0,3,2] row_mask:0xf bank_mask:0xf
    v_fma_f32 v71, v71, v9, v70
    v_mov_b32_dpp v70, v58 quad_perm:[1,0,3,2] row_mask:0xf bank_mask:0xf
    v_fma_f32 v58, v58, v9, v70
    v_mov_b32_dpp v70, v61 quad_perm:[1,0,3,2] row_mask:0xf bank_mask:0xf
    v_fma_f32 v61, v61, v9, v70
    v_mov_b32_dpp v70, v38 quad_perm:[1,0,3,2] row_mask:0xf bank_mask:0xf
    v_fma_f32 v38, v38, v9, v70
    v_mov_b32_dpp v70, v69 quad_perm:[1,0,3,2] row_mask:0xf bank_mask:0xf
    v_fma_f32 v69, v69, v9, v70
    v_mov_b32_dpp v70, v28 quad_perm:[1,0,3,2] row_mask:0xf bank_mask:0xf
    v_fma_f32 v28, v28, v9, v70
    v_mov_b32_dpp v70, v41 quad_perm:[1,0,3,2] row_mask:0xf bank_mask:0xf
    v_fma_f32 v41, v41, v9, v70
    v_mov_b32_dpp v70, v36 quad_perm:[1,0,3,2] row_mask:0xf bank_mask:0xf
    v_fma_f32 v36, v36, v9, v70
    v_mov_b32_dpp v70, v57 quad_perm:[1,0,3,2] row_mask:0xf bank_mask:0xf
    v_fma_f32 v57, v57, v9, v70
    v_mov_b32_dpp v70, v64 quad_perm:[1,0,3,2] row_mask:0xf bank_mask:0xf
    v_fma_f32 v64, v64, v9, v70
    v_mov_b32_dpp v70, v63 quad_perm:[1,0,3,2] row_mask:0xf bank_mask:0xf
    v_fma_f32 v63, v63, v9, v70
    v_mov_b32_dpp v70, v24 quad_perm:[1,0,3,2] row_mask:0xf bank_mask:0xf
    v_fma_f32 v24, v24, v9, v70
    v_mov_b32_dpp v70, v67 quad_perm:[1,0,3,2] row_mask:0xf bank_mask:0xf
    v_fma_f32 v67, v67, v9, v70
    v_mov_b32_dpp v70, v30 quad_perm:[1,0,3,2] row_mask:0xf bank_mask:0xf
    v_fma_f32 v30, v30, v9, v70
    v_mov_b32_dpp v70, v75 quad_perm:[1,0,3,2] row_mask:0xf bank_mask:0xf
    v_fma_f32 v75, v75, v9, v70
    v_mov_b32_dpp v70, v34 quad_perm:[1,0,3,2] row_mask:0xf bank_mask:0xf
    v_fma_f32 v34, v34, v9, v70
    v_mov_b32_dpp v70, v77 quad_perm:[1,0,3,2] row_mask:0xf bank_mask:0xf
    v_fma_f32 v77, v77, v9, v70
    v_mov_b32_dpp v70, v42 quad_perm:[1,0,3,2] row_mask:0xf bank_mask:0xf
    v_fma_f32 v42, v42, v9, v70
    v_mov_b32_dpp v70, v73 quad_perm:[1,0,3,2] row_mask:0xf bank_mask:0xf
    v_fma_f32 v73, v73, v9, v70
    v_mov_b32_dpp v70, v60 quad_perm:[1,0,3,2] row_mask:0xf bank_mask:0xf
    v_fma_f32 v60, v60, v9, v70
    v_mov_b32_dpp v70, v21 quad_perm:[1,0,3,2] row_mask:0xf bank_mask:0xf
    v_fma_f32 v21, v21, v9, v70
    v_mov_b32_dpp v70, v40 quad_perm:[1,0,3,2] row_mask:0xf bank_mask:0xf
    v_fma_f32 v40, v40, v9, v70
    v_mov_b32_dpp v70, v65 quad_perm:[1,0,3,2] row_mask:0xf bank_mask:0xf
    v_fma_f32 v65, v65, v9, v70
    v_mov_b32_dpp v70, v56 quad_perm:[1,0,3,2] row_mask:0xf bank_mask:0xf
    v_fma_f32 v56, v56, v9, v70
    v_mov_b32_dpp v70, v25 quad_perm:[1,0,3,2] row_mask:0xf bank_mask:0xf
    v_fma_f32 v25, v25, v9, v70
    v_mov_b32_dpp v70, v80 quad_perm:[1,0,3,2] row_mask:0xf bank_mask:0xf
    v_fma_f32 v80, v80, v9, v70
    v_mov_b32_dpp v70, v31 quad_perm:[1,0,3,2] row_mask:0xf bank_mask:0xf
    v_fma_f32 v31, v31, v9, v70
    v_mov_b32_dpp v70, v32 quad_perm:[1,0,3,2] row_mask:0xf bank_mask:0xf
    v_fma_f32 v32, v32, v9, v70
    v_mov_b32_dpp v70, v35 quad_perm:[1,0,3,2] row_mask:0xf bank_mask:0xf
    v_fma_f32 v35, v35, v9, v70
    v_mov_b32_dpp v70, v46 quad_perm:[1,0,3,2] row_mask:0xf bank_mask:0xf
    v_fma_f32 v46, v46, v9, v70
    v_mov_b32_dpp v70, v81 quad_perm:[1,0,3,2] row_mask:0xf bank_mask:0xf
    v_fma_f32 v81, v81, v9, v70
    v_mov_b32_dpp v70, v50 quad_perm:[1,0,3,2] row_mask:0xf bank_mask:0xf
    v_fma_f32 v50, v50, v9, v70
    v_mov_b32_dpp v70, v33 quad_perm:[1,0,3,2] row_mask:0xf bank_mask:0xf
    v_fma_f32 v33, v33, v9, v70
    v_mov_b32_dpp v70, v83 quad_perm:[1,0,3,2] row_mask:0xf bank_mask:0xf
    v_fma_f32 v83, v83, v9, v70
    v_mov_b32_dpp v70, v47 quad_perm:[1,0,3,2] row_mask:0xf bank_mask:0xf
    v_fma_f32 v47, v47, v9, v70
    v_mov_b32_dpp v70, v78 quad_perm:[1,0,3,2] row_mask:0xf bank_mask:0xf
    v_fma_f32 v78, v78, v9, v70
    v_mov_b32_dpp v70, v51 quad_perm:[1,0,3,2] row_mask:0xf bank_mask:0xf
    v_fma_f32 v51, v51, v9, v70
    v_mov_b32_dpp v70, v76 quad_perm:[1,0,3,2] row_mask:0xf bank_mask:0xf
    v_fma_f32 v76, v76, v9, v70
    v_mov_b32_dpp v70, v45 quad_perm:[1,0,3,2] row_mask:0xf bank_mask:0xf
    v_fma_f32 v45, v45, v9, v70
    v_mov_b32_dpp v70, v18 quad_perm:[1,0,3,2] row_mask:0xf bank_mask:0xf
    v_fma_f32 v18, v18, v9, v70
    v_mov_b32_dpp v70, v53 quad_perm:[1,0,3,2] row_mask:0xf bank_mask:0xf
    v_fma_f32 v53, v53, v9, v70
    v_mov_b32_dpp v70, v72 quad_perm:[1,0,3,2] row_mask:0xf bank_mask:0xf
    v_fma_f32 v72, v72, v9, v70
    v_mov_b32_dpp v70, v55 quad_perm:[1,0,3,2] row_mask:0xf bank_mask:0xf
    v_fma_f32 v55, v55, v9, v70
    v_mov_b32_dpp v70, v20 quad_perm:[1,0,3,2] row_mask:0xf bank_mask:0xf
    v_fma_f32 v20, v20, v9, v70
    v_mov_b32_dpp v70, v59 quad_perm:[1,0,3,2] row_mask:0xf bank_mask:0xf
    v_fma_f32 v59, v59, v9, v70
    v_mul_f32 v70, 0x3c800000, v10
    v_cos_f32 v79, v70
    v_sin_f32 v22, v70
    s_nop 0
    v_mul_f32 v26, v16, v79
    v_fma_f32 v26, -v49, v22, v26
    v_mul_f32 v49, v49, v79
    v_fmac_f32 v49, v16, v22
    v_mul_f32 v70, 0x3d000000, v10
    v_cos_f32 v79, v70
    v_sin_f32 v22, v70
    s_nop 0
    v_mul_f32 v16, v74, v79
    v_fma_f32 v16, -v19, v22, v16
    v_mul_f32 v19, v19, v79
    v_fmac_f32 v19, v74, v22
    v_mul_f32 v70, 0x3d400000, v10
    v_cos_f32 v79, v70
    v_sin_f32 v22, v70
    s_nop 0
    v_mul_f32 v74, v48, v79
    v_fma_f32 v74, -v23, v22, v74
    v_mul_f32 v23, v23, v79
    v_fmac_f32 v23, v48, v22
    v_mul_f32 v70, 0x3d800000, v10
    v_cos_f32 v79, v70
    v_sin_f32 v22, v70
    s_nop 0
    v_mul_f32 v48, v68, v79
    v_fma_f32 v48, -v27, v22, v48
    v_mul_f32 v27, v27, v79
    v_fmac_f32 v27, v68, v22
    v_mul_f32 v70, 0x3da00000, v10
    v_cos_f32 v79, v70
    v_sin_f32 v22, v70
    s_nop 0
    v_mul_f32 v68, v62, v79
    v_fma_f32 v68, -v39, v22, v68
    v_mul_f32 v39, v39, v79
    v_fmac_f32 v39, v62, v22
    v_mul_f32 v70, 0x3dc00000, v10
    v_cos_f32 v79, v70
    v_sin_f32 v22, v70
    s_nop 0
    v_mul_f32 v62, v66, v79
    v_fma_f32 v62, -v29, v22, v62
    v_mul_f32 v29, v29, v79
    v_fmac_f32 v29, v66, v22
    v_mul_f32 v70, 0x3de00000, v10
    v_cos_f32 v79, v70
    v_sin_f32 v22, v70
    s_nop 0
    v_mul_f32 v66, v54, v79
    v_fma_f32 v66, -v37, v22, v66
    v_mul_f32 v37, v37, v79
    v_fmac_f32 v37, v54, v22
    v_mul_f32 v70, 0x3e000000, v10
    v_cos_f32 v79, v70
    v_sin_f32 v22, v70
    s_nop 0
    v_mul_f32 v54, v44, v79
    v_fma_f32 v54, -v43, v22, v54
    v_mul_f32 v43, v43, v79
    v_fmac_f32 v43, v44, v22
    v_mul_f32 v70, 0x3e100000, v10
    v_cos_f32 v79, v70
    v_sin_f32 v22, v70
    s_nop 0
    v_mul_f32 v44, v52, v79
    v_fma_f32 v44, -v71, v22, v44
    v_mul_f32 v71, v71, v79
    v_fmac_f32 v71, v52, v22
    v_mul_f32 v70, 0x3e200000, v10
    v_cos_f32 v79, v70
    v_sin_f32 v22, v70
    s_nop 0
    v_mul_f32 v52, v58, v79
    v_fma_f32 v52, -v61, v22, v52
    v_mul_f32 v61, v61, v79
    v_fmac_f32 v61, v58, v22
    v_mul_f32 v70, 0x3e300000, v10
    v_cos_f32 v79, v70
    v_sin_f32 v22, v70
    s_nop 0
    v_mul_f32 v58, v38, v79
    v_fma_f32 v58, -v69, v22, v58
    v_mul_f32 v69, v69, v79
    v_fmac_f32 v69, v38, v22
    v_mul_f32 v70, 0x3e400000, v10
    v_cos_f32 v79, v70
    v_sin_f32 v22, v70
    s_nop 0
    v_mul_f32 v38, v28, v79
    v_fma_f32 v38, -v41, v22, v38
    v_mul_f32 v41, v41, v79
    v_fmac_f32 v41, v28, v22
    v_mul_f32 v70, 0x3e500000, v10
    v_cos_f32 v79, v70
    v_sin_f32 v22, v70
    s_nop 0
    v_mul_f32 v28, v36, v79
    v_fma_f32 v28, -v57, v22, v28
    v_mul_f32 v57, v57, v79
    v_fmac_f32 v57, v36, v22
    v_mul_f32 v70, 0x3e600000, v10
    v_cos_f32 v79, v70
    v_sin_f32 v22, v70
    s_nop 0
    v_mul_f32 v36, v64, v79
    v_fma_f32 v36, -v63, v22, v36
    v_mul_f32 v63, v63, v79
    v_fmac_f32 v63, v64, v22
    v_mul_f32 v70, 0x3e700000, v10
    v_cos_f32 v79, v70
    v_sin_f32 v22, v70
    s_nop 0
    v_mul_f32 v64, v24, v79
    v_fma_f32 v64, -v67, v22, v64
    v_mul_f32 v67, v67, v79
    v_fmac_f32 v67, v24, v22
    v_mul_f32 v70, 0x3e800000, v10
    v_cos_f32 v79, v70
    v_sin_f32 v22, v70
    s_nop 0
    v_mul_f32 v24, v30, v79
    v_fma_f32 v24, -v75, v22, v24
    v_mul_f32 v75, v75, v79
    v_fmac_f32 v75, v30, v22
    v_mul_f32 v70, 0x3e880000, v10
    v_cos_f32 v79, v70
    v_sin_f32 v22, v70
    s_nop 0
    v_mul_f32 v30, v34, v79
    v_fma_f32 v30, -v77, v22, v30
    v_mul_f32 v77, v77, v79
    v_fmac_f32 v77, v34, v22
    v_mul_f32 v70, 0x3e900000, v10
    v_cos_f32 v79, v70
    v_sin_f32 v22, v70
    s_nop 0
    v_mul_f32 v34, v42, v79
    v_fma_f32 v34, -v73, v22, v34
    v_mul_f32 v73, v73, v79
    v_fmac_f32 v73, v42, v22
    v_mul_f32 v70, 0x3e980000, v10
    v_cos_f32 v79, v70
    v_sin_f32 v22, v70
    s_nop 0
    v_mul_f32 v42, v60, v79
    v_fma_f32 v42, -v21, v22, v42
    v_mul_f32 v21, v21, v79
    v_fmac_f32 v21, v60, v22
    v_mul_f32 v70, 0x3ea00000, v10
    v_cos_f32 v79, v70
    v_sin_f32 v22, v70
    s_nop 0
    v_mul_f32 v60, v40, v79
    v_fma_f32 v60, -v65, v22, v60
    v_mul_f32 v65, v65, v79
    v_fmac_f32 v65, v40, v22
    v_mul_f32 v70, 0x3ea80000, v10
    v_cos_f32 v79, v70
    v_sin_f32 v22, v70
    s_nop 0
    v_mul_f32 v40, v56, v79
    v_fma_f32 v40, -v25, v22, v40
    v_mul_f32 v25, v25, v79
    v_fmac_f32 v25, v56, v22
    v_mul_f32 v70, 0x3eb00000, v10
    v_cos_f32 v79, v70
    v_sin_f32 v22, v70
    s_nop 0
    v_mul_f32 v56, v80, v79
    v_fma_f32 v56, -v31, v22, v56
    v_mul_f32 v31, v31, v79
    v_fmac_f32 v31, v80, v22
    v_mul_f32 v70, 0x3eb80000, v10
    v_cos_f32 v79, v70
    v_sin_f32 v22, v70
    s_nop 0
    v_mul_f32 v80, v32, v79
    v_fma_f32 v80, -v35, v22, v80
    v_mul_f32 v35, v35, v79
    v_fmac_f32 v35, v32, v22
    v_mul_f32 v70, 0x3ec00000, v10
    v_cos_f32 v79, v70
    v_sin_f32 v22, v70
    s_nop 0
    v_mul_f32 v32, v46, v79
    v_fma_f32 v32, -v81, v22, v32
    v_mul_f32 v81, v81, v79
    v_fmac_f32 v81, v46, v22
    v_mul_f32 v70, 0x3ec80000, v10
    v_cos_f32 v79, v70
    v_sin_f32 v22, v70
    s_nop 0
    v_mul_f32 v46, v50, v79
    v_fma_f32 v46, -v33, v22, v46
    v_mul_f32 v33, v33, v79
    v_fmac_f32 v33, v50, v22
    v_mul_f32 v70, 0x3ed00000, v10
    v_cos_f32 v79, v70
    v_sin_f32 v22, v70
    s_nop 0
    v_mul_f32 v50, v83, v79
    v_fma_f32 v50, -v47, v22, v50
    v_mul_f32 v47, v47, v79
    v_fmac_f32 v47, v83, v22
    v_mul_f32 v70, 0x3ed80000, v10
    v_cos_f32 v79, v70
    v_sin_f32 v22, v70
    s_nop 0
    v_mul_f32 v83, v78, v79
    v_fma_f32 v83, -v51, v22, v83
    v_mul_f32 v51, v51, v79
    v_fmac_f32 v51, v78, v22
    v_mul_f32 v70, 0x3ee00000, v10
    v_cos_f32 v79, v70
    v_sin_f32 v22, v70
    s_nop 0
    v_mul_f32 v78, v76, v79
    v_fma_f32 v78, -v45, v22, v78
    v_mul_f32 v45, v45, v79
    v_fmac_f32 v45, v76, v22
    v_mul_f32 v70, 0x3ee80000, v10
    v_cos_f32 v79, v70
    v_sin_f32 v22, v70
    s_nop 0
    v_mul_f32 v76, v18, v79
    v_fma_f32 v76, -v53, v22, v76
    v_mul_f32 v53, v53, v79
    v_fmac_f32 v53, v18, v22
    v_mul_f32 v70, 0x3ef00000, v10
    v_cos_f32 v79, v70
    v_sin_f32 v22, v70
    s_nop 0
    v_mul_f32 v18, v72, v79
    v_fma_f32 v18, -v55, v22, v18
    v_mul_f32 v55, v55, v79
    v_fmac_f32 v55, v72, v22
    v_mul_f32 v70, 0x3ef80000, v10
    v_cos_f32 v79, v70
    v_sin_f32 v22, v70
    s_nop 0
    v_mul_f32 v72, v20, v79
    v_fma_f32 v72, -v59, v22, v72
    v_mul_f32 v59, v59, v79
    v_fmac_f32 v59, v20, v22
    v_sub_f32 v70, v82, v24
    v_sub_f32 v79, v17, v75
    v_add_f32 v82, v82, v24
    v_add_f32 v17, v17, v75
    v_sub_f32 v24, v26, v30
    v_sub_f32 v75, v49, v77
    v_add_f32 v26, v26, v30
    v_add_f32 v49, v49, v77
    v_mul_f32 v30, 0x3f7b14be, v24
    v_mul_f32 v77, 0x3e47c5c2, v24
    v_fmac_f32 v30, 0xbe47c5c2, v75
    v_fmac_f32 v77, 0x3f7b14be, v75
    v_sub_f32 v24, v16, v34
    v_sub_f32 v75, v19, v73
    v_add_f32 v16, v16, v34
    v_add_f32 v19, v19, v73
    v_mul_f32 v34, 0x3f6c835e, v24
    v_mul_f32 v73, 0x3ec3ef15, v24
    v_fmac_f32 v34, 0xbec3ef15, v75
    v_fmac_f32 v73, 0x3f6c835e, v75
    v_sub_f32 v24, v74, v42
    v_sub_f32 v75, v23, v21
    v_add_f32 v74, v74, v42
    v_add_f32 v23, v23, v21
    v_mul_f32 v42, 0x3f54db31, v24
    v_mul_f32 v21, 0x3f0e39da, v24
    v_fmac_f32 v42, 0xbf0e39da, v75
    v_fmac_f32 v21, 0x3f54db31, v75
    v_sub_f32 v24, v48, v60
    v_sub_f32 v75, v27, v65
    v_add_f32 v48, v48, v60
    v_add_f32 v27, v27, v65
    v_mul_f32 v60, 0x3f3504f3, v24
    v_mul_f32 v65, 0x3f3504f3, v24
    v_fmac_f32 v60, 0xbf3504f3, v75
    v_fmac_f32 v65, 0x3f3504f3, v75
    v_sub_f32 v24, v68, v40
    v_sub_f32 v75, v39, v25
    v_add_f32 v68, v68, v40
    v_add_f32 v39, v39, v25
    v_mul_f32 v40, 0x3f0e39da, v24
    v_mul_f32 v25, 0x3f54db31, v24
    v_fmac_f32 v40, 0xbf54db31, v75
    v_fmac_f32 v25, 0x3f0e39da, v75
    v_sub_f32 v24, v62, v56
    v_sub_f32 v75, v29, v31
    v_add_f32 v62, v62, v56
    v_add_f32 v29, v29, v31
    v_mul_f32 v56, 0x3ec3ef15, v24
    v_mul_f32 v31, 0x3f6c835e, v24
    v_fmac_f32 v56, 0xbf6c835e, v75
    v_fmac_f32 v31, 0x3ec3ef15, v75
    v_sub_f32 v24, v66, v80
    v_sub_f32 v75, v37, v35
    v_add_f32 v66, v66, v80
    v_add_f32 v37, v37, v35
    v_mul_f32 v80, 0x3e47c5c2, v24
    v_mul_f32 v35, 0x3f7b14be, v24
    v_fmac_f32 v80, 0xbf7b14be, v75
    v_fmac_f32 v35, 0x3e47c5c2, v75
    v_sub_f32 v24, v81, v43
    v_sub_f32 v75, v54, v32
    v_add_f32 v54, v54, v32
    v_add_f32 v43, v43, v81
    v_sub_f32 v32, v44, v46
    v_sub_f32 v81, v71, v33
    v_add_f32 v44, v44, v46
    v_add_f32 v71, v71, v33
    v_mul_f32 v46, 0xbe47c5c2, v32
    v_mul_f32 v33, 0x3f7b14be, v32
    v_fmac_f32 v46, 0xbf7b14be, v81
    v_fmac_f32 v33, 0xbe47c5c2, v81
    v_sub_f32 v32, v52, v50
    v_sub_f32 v81, v61, v47
    v_add_f32 v52, v52, v50
    v_add_f32 v61, v61, v47
    v_mul_f32 v50, 0xbec3ef15, v32
    v_mul_f32 v47, 0x3f6c835e, v32
    v_fmac_f32 v50, 0xbf6c835e, v81
    v_fmac_f32 v47, 0xbec3ef15, v81
    v_sub_f32 v32, v58, v83
    v_sub_f32 v81, v69, v51
    v_add_f32 v58, v58, v83
    v_add_f32 v69, v69, v51
    v_mul_f32 v83, 0xbf0e39da, v32
    v_mul_f32 v51, 0x3f54db31, v32
    v_fmac_f32 v83, 0xbf54db31, v81
    v_fmac_f32 v51, 0xbf0e39da, v81
    v_sub_f32 v32, v38, v78
    v_sub_f32 v81, v41, v45
    v_add_f32 v38, v38, v78
    v_add_f32 v41, v41, v45
    v_mul_f32 v78, 0xbf3504f3, v32
    v_mul_f32 v45, 0x3f3504f3, v32
    v_fmac_f32 v78, 0xbf3504f3, v81
    v_fmac_f32 v45, 0xbf3504f3, v81
    v_sub_f32 v32, v28, v76
    v_sub_f32 v81, v57, v53
    v_add_f32 v28, v28, v76
    v_add_f32 v57, v57, v53
    v_mul_f32 v76, 0xbf54db31, v32
    v_mul_f32 v53, 0x3f0e39da, v32
    v_fmac_f32 v76, 0xbf0e39da, v81
    v_fmac_f32 v53, 0xbf54db31, v81
    v_sub_f32 v32, v36, v18
    v_sub_f32 v81, v63, v55
    v_add_f32 v36, v36, v18
    v_add_f32 v63, v63, v55
    v_mul_f32 v18, 0xbf6c835e, v32
    v_mul_f32 v55, 0x3ec3ef15, v32
    v_fmac_f32 v18, 0xbec3ef15, v81
    v_fmac_f32 v55, 0xbf6c835e, v81
    v_sub_f32 v32, v64, v72
    v_sub_f32 v81, v67, v59
    v_add_f32 v64, v64, v72
    v_add_f32 v67, v67, v59
    v_mul_f32 v72, 0xbf7b14be, v32
    v_mul_f32 v59, 0x3e47c5c2, v32
    v_fmac_f32 v72, 0xbe47c5c2, v81
    v_fmac_f32 v59, 0xbf7b14be, v81
    v_sub_f32 v32, v82, v54
    v_sub_f32 v81, v17, v43
    v_add_f32 v82, v82, v54
    v_add_f32 v17, v17, v43
    v_sub_f32 v54, v26, v44
    v_sub_f32 v43, v49, v71
    v_add_f32 v26, v26, v44
    v_add_f32 v49, v49, v71
    v_mul_f32 v44, 0x3f6c835e, v54
    v_mul_f32 v71, 0x3ec3ef15, v54
    v_fmac_f32 v44, 0xbec3ef15, v43
    v_fmac_f32 v71, 0x3f6c835e, v43
    v_sub_f32 v54, v16, v52
    v_sub_f32 v43, v19, v61
    v_add_f32 v16, v16, v52
    v_add_f32 v19, v19, v61
    v_mul_f32 v52, 0x3f3504f3, v54
    v_mul_f32 v61, 0x3f3504f3, v54
    v_fmac_f32 v52, 0xbf3504f3, v43
    v_fmac_f32 v61, 0x3f3504f3, v43
    v_sub_f32 v54, v74, v58
    v_sub_f32 v43, v23, v69
    v_add_f32 v74, v74, v58
    v_add_f32 v23, v23, v69
    v_mul_f32 v58, 0x3ec3ef15, v54
    v_mul_f32 v69, 0x3f6c835e, v54
    v_fmac_f32 v58, 0xbf6c835e, v43
    v_fmac_f32 v69, 0x3ec3ef15, v43
    v_sub_f32 v54, v41, v27
    v_sub_f32 v43, v48, v38
    v_add_f32 v48, v48, v38
    v_add_f32 v27, v27, v41
    v_sub_f32 v38, v68, v28
    v_sub_f32 v41, v39, v57
    v_add_f32 v68, v68, v28
    v_add_f32 v39, v39, v57
    v_mul_f32 v28, 0xbec3ef15, v38
    v_mul_f32 v57, 0x3f6c835e, v38
    v_fmac_f32 v28, 0xbf6c835e, v41
    v_fmac_f32 v57, 0xbec3ef15, v41
    v_sub_f32 v38, v62, v36
    v_sub_f32 v41, v29, v63
    v_add_f32 v62, v62, v36
    v_add_f32 v29, v29, v63
    v_mul_f32 v36, 0xbf3504f3, v38
    v_mul_f32 v63, 0x3f3504f3, v38
    v_fmac_f32 v36, 0xbf3504f3, v41
    v_fmac_f32 v63, 0xbf3504f3, v41
    v_sub_f32 v38, v66, v64
    v_sub_f32 v41, v37, v67
    v_add_f32 v66, v66, v64
    v_add_f32 v37, v37, v67
    v_mul_f32 v64, 0xbf6c835e, v38
    v_mul_f32 v67, 0x3ec3ef15, v38
    v_fmac_f32 v64, 0xbec3ef15, v41
    v_fmac_f32 v67, 0xbf6c835e, v41
    v_sub_f32 v38, v70, v24
    v_sub_f32 v41, v79, v75
    v_add_f32 v70, v70, v24
    v_add_f32 v79, v79, v75
    v_sub_f32 v24, v30, v46
    v_sub_f32 v75, v77, v33
    v_add_f32 v30, v30, v46
    v_add_f32 v77, v77, v33
    v_mul_f32 v46, 0x3f6c835e, v24
    v_mul_f32 v33, 0x3ec3ef15, v24
    v_fmac_f32 v46, 0xbec3ef15, v75
    v_fmac_f32 v33, 0x3f6c835e, v75
    v_sub_f32 v24, v34, v50
    v_sub_f32 v75, v73, v47
    v_add_f32 v34, v34, v50
    v_add_f32 v73, v73, v47
    v_mul_f32 v50, 0x3f3504f3, v24
    v_mul_f32 v47, 0x3f3504f3, v24
    v_fmac_f32 v50, 0xbf3504f3, v75
    v_fmac_f32 v47, 0x3f3504f3, v75
    v_sub_f32 v24, v42, v83
    v_sub_f32 v75, v21, v51
    v_add_f32 v42, v42, v83
    v_add_f32 v21, v21, v51
    v_mul_f32 v83, 0x3ec3ef15, v24
    v_mul_f32 v51, 0x3f6c835e, v24
    v_fmac_f32 v83, 0xbf6c835e, v75
    v_fmac_f32 v51, 0x3ec3ef15, v75
    v_sub_f32 v24, v45, v65
    v_sub_f32 v75, v60, v78
    v_add_f32 v60, v60, v78
    v_add_f32 v65, v65, v45
    v_sub_f32 v78, v40, v76
    v_sub_f32 v45, v25, v53
    v_add_f32 v40, v40, v76
    v_add_f32 v25, v25, v53
    v_mul_f32 v76, 0xbec3ef15, v78
    v_mul_f32 v53, 0x3f6c835e, v78
    v_fmac_f32 v76, 0xbf6c835e, v45
    v_fmac_f32 v53, 0xbec3ef15, v45
    v_sub_f32 v78, v56, v18
    v_sub_f32 v45, v31, v55
    v_add_f32 v56, v56, v18
    v_add_f32 v31, v31, v55
    v_mul_f32 v18, 0xbf3504f3, v78
    v_mul_f32 v55, 0x3f3504f3, v78
    v_fmac_f32 v18, 0xbf3504f3, v45
    v_fmac_f32 v55, 0xbf3504f3, v45
    v_sub_f32 v78, v80, v72
    v_sub_f32 v45, v35, v59
    v_add_f32 v80, v80, v72
    v_add_f32 v35, v35, v59
    v_mul_f32 v72, 0xbf6c835e, v78
    v_mul_f32 v59, 0x3ec3ef15, v78
    v_fmac_f32 v72, 0xbec3ef15, v45
    v_fmac_f32 v59, 0xbf6c835e, v45
    v_sub_f32 v78, v82, v48
    v_sub_f32 v45, v17, v27
    v_add_f32 v82, v82, v48
    v_add_f32 v17, v17, v27
    v_sub_f32 v48, v26, v68
    v_sub_f32 v27, v49, v39
    v_add_f32 v26, v26, v68
    v_add_f32 v49, v49, v39
    v_mul_f32 v68, 0x3f3504f3, v48
    v_mul_f32 v39, 0x3f3504f3, v48
    v_fmac_f32 v68, 0xbf3504f3, v27
    v_fmac_f32 v39, 0x3f3504f3, v27
    v_sub_f32 v48, v29, v19
    v_sub_f32 v27, v16, v62
    v_add_f32 v16, v16, v62
    v_add_f32 v19, v19, v29
    v_sub_f32 v62, v74, v66
    v_sub_f32 v29, v23, v37
    v_add_f32 v74, v74, v66
    v_add_f32 v23, v23, v37
    v_mul_f32 v66, 0xbf3504f3, v62
    v_mul_f32 v37, 0x3f3504f3, v62
    v_fmac_f32 v66, 0xbf3504f3, v29
    v_fmac_f32 v37, 0xbf3504f3, v29
    v_sub_f32 v62, v32, v54
    v_sub_f32 v29, v81, v43
    v_add_f32 v32, v32, v54
    v_add_f32 v81, v81, v43
    v_sub_f32 v54, v44, v28
    v_sub_f32 v43, v71, v57
    v_add_f32 v44, v44, v28
    v_add_f32 v71, v71, v57
    v_mul_f32 v28, 0x3f3504f3, v54
    v_mul_f32 v57, 0x3f3504f3, v54
    v_fmac_f32 v28, 0xbf3504f3, v43
    v_fmac_f32 v57, 0x3f3504f3, v43
    v_sub_f32 v54, v63, v61
    v_sub_f32 v43, v52, v36
    v_add_f32 v52, v52, v36
    v_add_f32 v61, v61, v63
    v_sub_f32 v36, v58, v64
    v_sub_f32 v63, v69, v67
    v_add_f32 v58, v58, v64
    v_add_f32 v69, v69, v67
    v_mul_f32 v64, 0xbf3504f3, v36
    v_mul_f32 v67, 0x3f3504f3, v36
    v_fmac_f32 v64, 0xbf3504f3, v63
    v_fmac_f32 v67, 0xbf3504f3, v63
    v_sub_f32 v36, v70, v60
    v_sub_f32 v63, v79, v65
    v_add_f32 v70, v70, v60
    v_add_f32 v79, v79, v65
    v_sub_f32 v60, v30, v40
    v_sub_f32 v65, v77, v25
    v_add_f32 v30, v30, v40
    v_add_f32 v77, v77, v25
    v_mul_f32 v40, 0x3f3504f3, v60
    v_mul_f32 v25, 0x3f3504f3, v60
    v_fmac_f32 v40, 0xbf3504f3, v65
    v_fmac_f32 v25, 0x3f3504f3, v65
    v_sub_f32 v60, v31, v73
    v_sub_f32 v65, v34, v56
    v_add_f32 v34, v34, v56
    v_add_f32 v73, v73, v31
    v_sub_f32 v56, v42, v80
    v_sub_f32 v31, v21, v35
    v_add_f32 v42, v42, v80
    v_add_f32 v21, v21, v35
    v_mul_f32 v80, 0xbf3504f3, v56
    v_mul_f32 v35, 0x3f3504f3, v56
    v_fmac_f32 v80, 0xbf3504f3, v31
    v_fmac_f32 v35, 0xbf3504f3, v31
    v_sub_f32 v56, v38, v24
    v_sub_f32 v31, v41, v75
    v_add_f32 v38, v38, v24
    v_add_f32 v41, v41, v75
    v_sub_f32 v24, v46, v76
    v_sub_f32 v75, v33, v53
    v_add_f32 v46, v46, v76
    v_add_f32 v33, v33, v53
    v_mul_f32 v76, 0x3f3504f3, v24
    v_mul_f32 v53, 0x3f3504f3, v24
    v_fmac_f32 v76, 0xbf3504f3, v75
    v_fmac_f32 v53, 0x3f3504f3, v75
    v_sub_f32 v24, v55, v47
    v_sub_f32 v75, v50, v18
    v_add_f32 v50, v50, v18
    v_add_f32 v47, v47, v55
    v_sub_f32 v18, v83, v72
    v_sub_f32 v55, v51, v59
    v_add_f32 v83, v83, v72
    v_add_f32 v51, v51, v59
    v_mul_f32 v72, 0xbf3504f3, v18
    v_mul_f32 v59, 0x3f3504f3, v18
    v_fmac_f32 v72, 0xbf3504f3, v55
    v_fmac_f32 v59, 0xbf3504f3, v55
    v_sub_f32 v18, v82, v16
    v_sub_f32 v55, v17, v19
    v_add_f32 v82, v82, v16
    v_add_f32 v17, v17, v19
    v_sub_f32 v16, v23, v49
    v_sub_f32 v19, v26, v74
    v_add_f32 v26, v26, v74
    v_add_f32 v49, v49, v23
    v_sub_f32 v74, v78, v48
    v_sub_f32 v23, v45, v27
    v_add_f32 v78, v78, v48
    v_add_f32 v45, v45, v27
    v_sub_f32 v48, v37, v39
    v_sub_f32 v27, v68, v66
    v_add_f32 v68, v68, v66
    v_add_f32 v39, v39, v37
    v_sub_f32 v66, v32, v52
    v_sub_f32 v37, v81, v61
    v_add_f32 v32, v32, v52
    v_add_f32 v81, v81, v61
    v_sub_f32 v52, v69, v71
    v_sub_f32 v61, v44, v58
    v_add_f32 v44, v44, v58
    v_add_f32 v71, v71, v69
    v_sub_f32 v58, v62, v54
    v_sub_f32 v69, v29, v43
    v_add_f32 v62, v62, v54
    v_add_f32 v29, v29, v43
    v_sub_f32 v54, v67, v57
    v_sub_f32 v43, v28, v64
    v_add_f32 v28, v28, v64
    v_add_f32 v57, v57, v67
    v_sub_f32 v64, v70, v34
    v_sub_f32 v67, v79, v73
    v_add_f32 v70, v70, v34
    v_add_f32 v79, v79, v73
    v_sub_f32 v34, v21, v77
    v_sub_f32 v73, v30, v42
    v_add_f32 v30, v30, v42
    v_add_f32 v77, v77, v21
    v_sub_f32 v42, v36, v60
    v_sub_f32 v21, v63, v65
    v_add_f32 v36, v36, v60
    v_add_f32 v63, v63, v65
    v_sub_f32 v60, v35, v25
    v_sub_f32 v65, v40, v80
    v_add_f32 v40, v40, v80
    v_add_f32 v25, v25, v35
    v_sub_f32 v80, v38, v50
    v_sub_f32 v35, v41, v47
    v_add_f32 v38, v38, v50
    v_add_f32 v41, v41, v47
    v_sub_f32 v50, v51, v33
    v_sub_f32 v47, v46, v83
    v_add_f32 v46, v46, v83
    v_add_f32 v33, v33, v51
    v_sub_f32 v83, v56, v24
    v_sub_f32 v51, v31, v75
    v_add_f32 v56, v56, v24
    v_add_f32 v31, v31, v75
    v_sub_f32 v24, v59, v53
    v_sub_f32 v75, v76, v72
    v_add_f32 v76, v76, v72
    v_add_f32 v53, v53, v59
    v_sub_f32 v72, v82, v26
    v_sub_f32 v59, v17, v49
    v_add_f32 v82, v82, v26
    v_add_f32 v17, v17, v49
    v_sub_f32 v26, v18, v16
    v_sub_f32 v49, v55, v19
    v_add_f32 v18, v18, v16
    v_add_f32 v55, v55, v19
    v_sub_f32 v16, v78, v68
    v_sub_f32 v19, v45, v39
    v_add_f32 v78, v78, v68
    v_add_f32 v45, v45, v39
    v_sub_f32 v68, v74, v48
    v_sub_f32 v39, v23, v27
    v_add_f32 v74, v74, v48
    v_add_f32 v23, v23, v27
    v_sub_f32 v48, v32, v44
    v_sub_f32 v27, v81, v71
    v_add_f32 v32, v32, v44
    v_add_f32 v81, v81, v71
    v_sub_f32 v44, v66, v52
    v_sub_f32 v71, v37, v61
    v_add_f32 v66, v66, v52
    v_add_f32 v37, v37, v61
    v_sub_f32 v52, v62, v28
    v_sub_f32 v61, v29, v57
    v_add_f32 v62, v62, v28
    v_add_f32 v29, v29, v57
    v_sub_f32 v28, v58, v54
    v_sub_f32 v57, v69, v43
    v_add_f32 v58, v58, v54
    v_add_f32 v69, v69, v43
    v_sub_f32 v54, v70, v30
    v_sub_f32 v43, v79, v77
    v_add_f32 v70, v70, v30
    v_add_f32 v79, v79, v77
    v_sub_f32 v30, v64, v34
    v_sub_f32 v77, v67, v73
    v_add_f32 v64, v64, v34
    v_add_f32 v67, v67, v73
    v_sub_f32 v34, v36, v40
    v_sub_f32 v73, v63, v25
    v_add_f32 v36, v36, v40
    v_add_f32 v63, v63, v25
    v_sub_f32 v40, v42, v60
    v_sub_f32 v25, v21, v65
    v_add_f32 v42, v42, v60
    v_add_f32 v21, v21, v65
    v_sub_f32 v60, v38, v46
    v_sub_f32 v65, v41, v33
    v_add_f32 v38, v38, v46
    v_add_f32 v41, v41, v33
    v_sub_f32 v46, v80, v50
    v_sub_f32 v33, v35, v47
    v_add_f32 v80, v80, v50
    v_add_f32 v35, v35, v47
    v_sub_f32 v50, v56, v76
    v_sub_f32 v47, v31, v53
    v_add_f32 v56, v56, v76
    v_add_f32 v31, v31, v53
    v_sub_f32 v76, v83, v24
    v_sub_f32 v53, v51, v75
    v_add_f32 v83, v83, v24
    v_add_f32 v51, v51, v75
    v_mul_f32 v12, v10, v8
    v_mul_f32 v12, 0x3a000000, v12
    v_mov_b32 v24, v12
    v_fmac_f32 v24, 0x00000000, v8
    v_cos_f32 v75, v24
    v_sin_f32 v22, v24
    s_nop 0
    v_mul_f32 v20, v82, v75
    v_fma_f32 v20, -v17, v22, v20
    v_mul_f32 v17, v17, v75
    v_fmac_f32 v17, v82, v22
    v_mov_b32 v24, v12
    v_fmac_f32 v24, 0x3a800000, v8
    v_cos_f32 v75, v24
    v_sin_f32 v22, v24
    s_nop 0
    v_mul_f32 v82, v70, v75
    v_fma_f32 v82, -v79, v22, v82
    v_mul_f32 v79, v79, v75
    v_fmac_f32 v79, v70, v22
    v_mov_b32 v24, v12
    v_fmac_f32 v24, 0x3b000000, v8
    v_cos_f32 v75, v24
    v_sin_f32 v22, v24
    s_nop 0
    v_mul_f32 v70, v32, v75
    v_fma_f32 v70, -v81, v22, v70
    v_mul_f32 v81, v81, v75
    v_fmac_f32 v81, v32, v22
    v_mov_b32 v24, v12
    v_fmac_f32 v24, 0x3b400000, v8
    v_cos_f32 v75, v24
    v_sin_f32 v22, v24
    s_nop 0
    v_mul_f32 v32, v38, v75
    v_fma_f32 v32, -v41, v22, v32
    v_mul_f32 v41, v41, v75
    v_fmac_f32 v41, v38, v22
    v_mov_b32 v24, v12
    v_fmac_f32 v24, 0x3b800000, v8
    v_cos_f32 v75, v24
    v_sin_f32 v22, v24
    s_nop 0
    v_mul_f32 v38, v78, v75
    v_fma_f32 v38, -v45, v22, v38
    v_mul_f32 v45, v45, v75
    v_fmac_f32 v45, v78, v22
    v_mov_b32 v24, v12
    v_fmac_f32 v24, 0x3ba00000, v8
    v_cos_f32 v75, v24
    v_sin_f32 v22, v24
    s_nop 0
    v_mul_f32 v78, v36, v75
    v_fma_f32 v78, -v63, v22, v78
    v_mul_f32 v63, v63, v75
    v_fmac_f32 v63, v36, v22
    v_mov_b32 v24, v12
    v_fmac_f32 v24, 0x3bc00000, v8
    v_cos_f32 v75, v24
    v_sin_f32 v22, v24
    s_nop 0
    v_mul_f32 v36, v62, v75
    v_fma_f32 v36, -v29, v22, v36
    v_mul_f32 v29, v29, v75
    v_fmac_f32 v29, v62, v22
    v_mov_b32 v24, v12
    v_fmac_f32 v24, 0x3be00000, v8
    v_cos_f32 v75, v24
    v_sin_f32 v22, v24
    s_nop 0
    v_mul_f32 v62, v56, v75
    v_fma_f32 v62, -v31, v22, v62
    v_mul_f32 v31, v31, v75
    v_fmac_f32 v31, v56, v22
    v_mov_b32 v24, v12
    v_fmac_f32 v24, 0x3c000000, v8
    v_cos_f32 v75, v24
    v_sin_f32 v22, v24
    s_nop 0
    v_mul_f32 v56, v18, v75
    v_fma_f32 v56, -v55, v22, v56
    v_mul_f32 v55, v55, v75
    v_fmac_f32 v55, v18, v22
    v_mov_b32 v24, v12
    v_fmac_f32 v24, 0x3c100000, v8
    v_cos_f32 v75, v24
    v_sin_f32 v22, v24
    s_nop 0
    v_mul_f32 v18, v64, v75
    v_fma_f32 v18, -v67, v22, v18
    v_mul_f32 v67, v67, v75
    v_fmac_f32 v67, v64, v22
    v_mov_b32 v24, v12
    v_fmac_f32 v24, 0x3c200000, v8
    v_cos_f32 v75, v24
    v_sin_f32 v22, v24
    s_nop 0
    v_mul_f32 v64, v66, v75
    v_fma_f32 v64, -v37, v22, v64
    v_mul_f32 v37, v37, v75
    v_fmac_f32 v37, v66, v22
    v_mov_b32 v24, v12
    v_fmac_f32 v24, 0x3c300000, v8
    v_cos_f32 v75, v24
    v_sin_f32 v22, v24
    s_nop 0
    v_mul_f32 v66, v80, v75
    v_fma_f32 v66, -v35, v22, v66
    v_mul_f32 v35, v35, v75
    v_fmac_f32 v35, v80, v22
    v_mov_b32 v24, v12
    v_fmac_f32 v24, 0x3c400000, v8
    v_cos_f32 v75, v24
    v_sin_f32 v22, v24
    s_nop 0
    v_mul_f32 v80, v74, v75
    v_fma_f32 v80, -v23, v22, v80
    v_mul_f32 v23, v23, v75
    v_fmac_f32 v23, v74, v22
    v_mov_b32 v24, v12
    v_fmac_f32 v24, 0x3c500000, v8
    v_cos_f32 v75, v24
    v_sin_f32 v22, v24
    s_nop 0
    v_mul_f32 v74, v42, v75
    v_fma_f32 v74, -v21, v22, v74
    v_mul_f32 v21, v21, v75
    v_fmac_f32 v21, v42, v22
    v_mov_b32 v24, v12
    v_fmac_f32 v24, 0x3c600000, v8
    v_cos_f32 v75, v24
    v_sin_f32 v22, v24
    s_nop 0
    v_mul_f32 v42, v58, v75
    v_fma_f32 v42, -v69, v22, v42
    v_mul_f32 v69, v69, v75
    v_fmac_f32 v69, v58, v22
    v_mov_b32 v24, v12
    v_fmac_f32 v24, 0x3c700000, v8
    v_cos_f32 v75, v24
    v_sin_f32 v22, v24
    s_nop 0
    v_mul_f32 v58, v83, v75
    v_fma_f32 v58, -v51, v22, v58
    v_mul_f32 v51, v51, v75
    v_fmac_f32 v51, v83, v22
    v_mov_b32 v24, v12
    v_fmac_f32 v24, 0x3c800000, v8
    v_cos_f32 v75, v24
    v_sin_f32 v22, v24
    s_nop 0
    v_mul_f32 v83, v72, v75
    v_fma_f32 v83, -v59, v22, v83
    v_mul_f32 v59, v59, v75
    v_fmac_f32 v59, v72, v22
    v_mov_b32 v24, v12
    v_fmac_f32 v24, 0x3c880000, v8
    v_cos_f32 v75, v24
    v_sin_f32 v22, v24
    s_nop 0
    v_mul_f32 v72, v54, v75
    v_fma_f32 v72, -v43, v22, v72
    v_mul_f32 v43, v43, v75
    v_fmac_f32 v43, v54, v22
    v_mov_b32 v24, v12
    v_fmac_f32 v24, 0x3c900000, v8
    v_cos_f32 v75, v24
    v_sin_f32 v22, v24
    s_nop 0
    v_mul_f32 v54, v48, v75
    v_fma_f32 v54, -v27, v22, v54
    v_mul_f32 v27, v27, v75
    v_fmac_f32 v27, v48, v22
    v_mov_b32 v24, v12
    v_fmac_f32 v24, 0x3c980000, v8
    v_cos_f32 v75, v24
    v_sin_f32 v22, v24
    s_nop 0
    v_mul_f32 v48, v60, v75
    v_fma_f32 v48, -v65, v22, v48
    v_mul_f32 v65, v65, v75
    v_fmac_f32 v65, v60, v22
    v_mov_b32 v24, v12
    v_fmac_f32 v24, 0x3ca00000, v8
    v_cos_f32 v75, v24
    v_sin_f32 v22, v24
    s_nop 0
    v_mul_f32 v60, v16, v75
    v_fma_f32 v60, -v19, v22, v60
    v_mul_f32 v19, v19, v75
    v_fmac_f32 v19, v16, v22
    v_mov_b32 v24, v12
    v_fmac_f32 v24, 0x3ca80000, v8
    v_cos_f32 v75, v24
    v_sin_f32 v22, v24
    s_nop 0
    v_mul_f32 v16, v34, v75
    v_fma_f32 v16, -v73, v22, v16
    v_mul_f32 v73, v73, v75
    v_fmac_f32 v73, v34, v22
    v_mov_b32 v24, v12
    v_fmac_f32 v24, 0x3cb00000, v8
    v_cos_f32 v75, v24
    v_sin_f32 v22, v24
    s_nop 0
    v_mul_f32 v34, v52, v75
    v_fma_f32 v34, -v61, v22, v34
    v_mul_f32 v61, v61, v75
    v_fmac_f32 v61, v52, v22
    v_mov_b32 v24, v12
    v_fmac_f32 v24, 0x3cb80000, v8
    v_cos_f32 v75, v24
    v_sin_f32 v22, v24
    s_nop 0
    v_mul_f32 v52, v50, v75
    v_fma_f32 v52, -v47, v22, v52
    v_mul_f32 v47, v47, v75
    v_fmac_f32 v47, v50, v22
    v_mov_b32 v24, v12
    v_fmac_f32 v24, 0x3cc00000, v8
    v_cos_f32 v75, v24
    v_sin_f32 v22, v24
    s_nop 0
    v_mul_f32 v50, v26, v75
    v_fma_f32 v50, -v49, v22, v50
    v_mul_f32 v49, v49, v75
    v_fmac_f32 v49, v26, v22
    v_mov_b32 v24, v12
    v_fmac_f32 v24, 0x3cc80000, v8
    v_cos_f32 v75, v24
    v_sin_f32 v22, v24
    s_nop 0
    v_mul_f32 v26, v30, v75
    v_fma_f32 v26, -v77, v22, v26
    v_mul_f32 v77, v77, v75
    v_fmac_f32 v77, v30, v22
    v_mov_b32 v24, v12
    v_fmac_f32 v24, 0x3cd00000, v8
    v_cos_f32 v75, v24
    v_sin_f32 v22, v24
    s_nop 0
    v_mul_f32 v30, v44, v75
    v_fma_f32 v30, -v71, v22, v30
    v_mul_f32 v71, v71, v75
    v_fmac_f32 v71, v44, v22
    v_mov_b32 v24, v12
    v_fmac_f32 v24, 0x3cd80000, v8
    v_cos_f32 v75, v24
    v_sin_f32 v22, v24
    s_nop 0
    v_mul_f32 v44, v46, v75
    v_fma_f32 v44, -v33, v22, v44
    v_mul_f32 v33, v33, v75
    v_fmac_f32 v33, v46, v22
    v_mov_b32 v24, v12
    v_fmac_f32 v24, 0x3ce00000, v8
    v_cos_f32 v75, v24
    v_sin_f32 v22, v24
    s_nop 0
    v_mul_f32 v46, v68, v75
    v_fma_f32 v46, -v39, v22, v46
    v_mul_f32 v39, v39, v75
    v_fmac_f32 v39, v68, v22
    v_mov_b32 v24, v12
    v_fmac_f32 v24, 0x3ce80000, v8
    v_cos_f32 v75, v24
    v_sin_f32 v22, v24
    s_nop 0
    v_mul_f32 v68, v40, v75
    v_fma_f32 v68, -v25, v22, v68
    v_mul_f32 v25, v25, v75
    v_fmac_f32 v25, v40, v22
    v_mov_b32 v24, v12
    v_fmac_f32 v24, 0x3cf00000, v8
    v_cos_f32 v75, v24
    v_sin_f32 v22, v24
    s_nop 0
    v_mul_f32 v40, v28, v75
    v_fma_f32 v40, -v57, v22, v40
    v_mul_f32 v57, v57, v75
    v_fmac_f32 v57, v28, v22
    v_mov_b32 v24, v12
    v_fmac_f32 v24, 0x3cf80000, v8
    v_cos_f32 v75, v24
    v_sin_f32 v22, v24
    s_nop 0
    v_mul_f32 v28, v76, v75
    v_fma_f32 v28, -v53, v22, v28
    v_mul_f32 v53, v53, v75
    v_fmac_f32 v53, v76, v22
    ds_write_b32 v4, v20 offset:0
    ds_write_b32 v4, v17 offset:4
    ds_write_b32 v4, v82 offset:16
    ds_write_b32 v4, v79 offset:20
    ds_write_b32 v4, v70 offset:32
    ds_write_b32 v4, v81 offset:36
    ds_write_b32 v4, v32 offset:48
    ds_write_b32 v4, v41 offset:52
    ds_write_b32 v4, v38 offset:64
    ds_write_b32 v4, v45 offset:68
    ds_write_b32 v4, v78 offset:80
    ds_write_b32 v4, v63 offset:84
    ds_write_b32 v4, v36 offset:96
    ds_write_b32 v4, v29 offset:100
    ds_write_b32 v4, v62 offset:112
    ds_write_b32 v4, v31 offset:116
    ds_write_b32 v4, v56 offset:128
    ds_write_b32 v4, v55 offset:132
    ds_write_b32 v4, v18 offset:144
    ds_write_b32 v4, v67 offset:148
    ds_write_b32 v4, v64 offset:160
    ds_write_b32 v4, v37 offset:164
    ds_write_b32 v4, v66 offset:176
    ds_write_b32 v4, v35 offset:180
    ds_write_b32 v4, v80 offset:192
    ds_write_b32 v4, v23 offset:196
    ds_write_b32 v4, v74 offset:208
    ds_write_b32 v4, v21 offset:212
    ds_write_b32 v4, v42 offset:224
    ds_write_b32 v4, v69 offset:228
    ds_write_b32 v4, v58 offset:240
    ds_write_b32 v4, v51 offset:244
    ds_write_b32 v4, v83 offset:256
    ds_write_b32 v4, v59 offset:260
    ds_write_b32 v4, v72 offset:272
    ds_write_b32 v4, v43 offset:276
    ds_write_b32 v4, v54 offset:288
    ds_write_b32 v4, v27 offset:292
    ds_write_b32 v4, v48 offset:304
    ds_write_b32 v4, v65 offset:308
    ds_write_b32 v4, v60 offset:320
    ds_write_b32 v4, v19 offset:324
    ds_write_b32 v4, v16 offset:336
    ds_write_b32 v4, v73 offset:340
    ds_write_b32 v4, v34 offset:352
    ds_write_b32 v4, v61 offset:356
    ds_write_b32 v4, v52 offset:368
    ds_write_b32 v4, v47 offset:372
    ds_write_b32 v4, v50 offset:384
    ds_write_b32 v4, v49 offset:388
    ds_write_b32 v4, v26 offset:400
    ds_write_b32 v4, v77 offset:404
    ds_write_b32 v4, v30 offset:416
    ds_write_b32 v4, v71 offset:420
    ds_write_b32 v4, v44 offset:432
    ds_write_b32 v4, v33 offset:436
    ds_write_b32 v4, v46 offset:448
    ds_write_b32 v4, v39 offset:452
    ds_write_b32 v4, v68 offset:464
    ds_write_b32 v4, v25 offset:468
    ds_write_b32 v4, v40 offset:480
    ds_write_b32 v4, v57 offset:484
    ds_write_b32 v4, v28 offset:496
    ds_write_b32 v4, v53 offset:500
    s_waitcnt lgkmcnt(0)
    ds_read_b32 v20, v3 offset:0
    ds_read_b32 v17, v3 offset:4
    ds_read_b32 v82, v3 offset:528
    ds_read_b32 v79, v3 offset:532
    ds_read_b32 v70, v3 offset:1056
    ds_read_b32 v81, v3 offset:1060
    ds_read_b32 v32, v3 offset:1584
    ds_read_b32 v41, v3 offset:1588
    ds_read_b32 v38, v3 offset:2112
    ds_read_b32 v45, v3 offset:2116
    ds_read_b32 v78, v3 offset:2640
    ds_read_b32 v63, v3 offset:2644
    ds_read_b32 v36, v3 offset:3168
    ds_read_b32 v29, v3 offset:3172
    s_waitcnt lgkmcnt(0)
    ds_read_b32 v62, v3 offset:3696
    ds_read_b32 v31, v3 offset:3700
    ds_read_b32 v56, v3 offset:4224
    ds_read_b32 v55, v3 offset:4228
    ds_read_b32 v18, v3 offset:4752
    ds_read_b32 v67, v3 offset:4756
    ds_read_b32 v64, v3 offset:5280
    ds_read_b32 v37, v3 offset:5284
    ds_read_b32 v66, v3 offset:5808
    ds_read_b32 v35, v3 offset:5812
    ds_read_b32 v80, v3 offset:6336
    ds_read_b32 v23, v3 offset:6340
    ds_read_b32 v74, v3 offset:6864
    ds_read_b32 v21, v3 offset:6868
    s_waitcnt lgkmcnt(0)
    ds_read_b32 v42, v3 offset:7392
    ds_read_b32 v69, v3 offset:7396
    ds_read_b32 v58, v3 offset:7920
    ds_read_b32 v51, v3 offset:7924
    ds_read_b32 v83, v3 offset:8448
    ds_read_b32 v59, v3 offset:8452
    ds_read_b32 v72, v3 offset:8976
    ds_read_b32 v43, v3 offset:8980
    ds_read_b32 v54, v3 offset:9504
    ds_read_b32 v27, v3 offset:9508
    ds_read_b32 v48, v3 offset:10032
    ds_read_b32 v65, v3 offset:10036
    ds_read_b32 v60, v3 offset:10560
    ds_read_b32 v19, v3 offset:10564
    s_waitcnt lgkmcnt(0)
    ds_read_b32 v16, v3 offset:11088
    ds_read_b32 v73, v3 offset:11092
    ds_read_b32 v34, v3 offset:11616
    ds_read_b32 v61, v3 offset:11620
    ds_read_b32 v52, v3 offset:12144
    ds_read_b32 v47, v3 offset:12148
    ds_read_b32 v50, v3 offset:12672
    ds_read_b32 v49, v3 offset:12676
    ds_read_b32 v26, v3 offset:13200
    ds_read_b32 v77, v3 offset:13204
    ds_read_b32 v30, v3 offset:13728
    ds_read_b32 v71, v3 offset:13732
    ds_read_b32 v44, v3 offset:14256
    ds_read_b32 v33, v3 offset:14260
    s_waitcnt lgkmcnt(0)
    ds_read_b32 v46, v3 offset:14784
    ds_read_b32 v39, v3 offset:14788
    ds_read_b32 v68, v3 offset:15312
    ds_read_b32 v25, v3 offset:15316
    ds_read_b32 v40, v3 offset:15840
    ds_read_b32 v57, v3 offset:15844
    ds_read_b32 v28, v3 offset:16368
    ds_read_b32 v53, v3 offset:16372
    s_waitcnt lgkmcnt(0)
    v_sub_f32 v24, v20, v83
    v_sub_f32 v75, v17, v59
    v_add_f32 v20, v20, v83
    v_add_f32 v17, v17, v59
    v_sub_f32 v83, v82, v72
    v_sub_f32 v59, v79, v43
    v_add_f32 v82, v82, v72
    v_add_f32 v79, v79, v43
    v_mul_f32 v72, 0x3f7b14be, v83
    v_mul_f32 v43, 0x3e47c5c2, v83
    v_fmac_f32 v72, 0xbe47c5c2, v59
    v_fmac_f32 v43, 0x3f7b14be, v59
    v_sub_f32 v83, v70, v54
    v_sub_f32 v59, v81, v27
    v_add_f32 v70, v70, v54
    v_add_f32 v81, v81, v27
    v_mul_f32 v54, 0x3f6c835e, v83
    v_mul_f32 v27, 0x3ec3ef15, v83
    v_fmac_f32 v54, 0xbec3ef15, v59
    v_fmac_f32 v27, 0x3f6c835e, v59
    v_sub_f32 v83, v32, v48
    v_sub_f32 v59, v41, v65
    v_add_f32 v32, v32, v48
    v_add_f32 v41, v41, v65
    v_mul_f32 v48, 0x3f54db31, v83
    v_mul_f32 v65, 0x3f0e39da, v83
    v_fmac_f32 v48, 0xbf0e39da, v59
    v_fmac_f32 v65, 0x3f54db31, v59
    v_sub_f32 v83, v38, v60
    v_sub_f32 v59, v45, v19
    v_add_f32 v38, v38, v60
    v_add_f32 v45, v45, v19
    v_mul_f32 v60, 0x3f3504f3, v83
    v_mul_f32 v19, 0x3f3504f3, v83
    v_fmac_f32 v60, 0xbf3504f3, v59
    v_fmac_f32 v19, 0x3f3504f3, v59
    v_sub_f32 v83, v78, v16
    v_sub_f32 v59, v63, v73
    v_add_f32 v78, v78, v16
    v_add_f32 v63, v63, v73
    v_mul_f32 v16, 0x3f0e39da, v83
    v_mul_f32 v73, 0x3f54db31, v83
    v_fmac_f32 v16, 0xbf54db31, v59
    v_fmac_f32 v73, 0x3f0e39da, v59
    v_sub_f32 v83, v36, v34
    v_sub_f32 v59, v29, v61
    v_add_f32 v36, v36, v34
    v_add_f32 v29, v29, v61
    v_mul_f32 v34, 0x3ec3ef15, v83
    v_mul_f32 v61, 0x3f6c835e, v83
    v_fmac_f32 v34, 0xbf6c835e, v59
    v_fmac_f32 v61, 0x3ec3ef15, v59
    v_sub_f32 v83, v62, v52
    v_sub_f32 v59, v31, v47
    v_add_f32 v62, v62, v52
    v_add_f32 v31, v31, v47
    v_mul_f32 v52, 0x3e47c5c2, v83
    v_mul_f32 v47, 0x3f7b14be, v83
    v_fmac_f32 v52, 0xbf7b14be, v59
    v_fmac_f32 v47, 0x3e47c5c2, v59
    v_sub_f32 v83, v49, v55
    v_sub_f32 v59, v56, v50
    v_add_f32 v56, v56, v50
    v_add_f32 v55, v55, v49
    v_sub_f32 v50, v18, v26
    v_sub_f32 v49, v67, v77
    v_add_f32 v18, v18, v26
    v_add_f32 v67, v67, v77
    v_mul_f32 v26, 0xbe47c5c2, v50
    v_mul_f32 v77, 0x3f7b14be, v50
    v_fmac_f32 v26, 0xbf7b14be, v49
    v_fmac_f32 v77, 0xbe47c5c2, v49
    v_sub_f32 v50, v64, v30
    v_sub_f32 v49, v37, v71
    v_add_f32 v64, v64, v30
    v_add_f32 v37, v37, v71
    v_mul_f32 v30, 0xbec3ef15, v50
    v_mul_f32 v71, 0x3f6c835e, v50
    v_fmac_f32 v30, 0xbf6c835e, v49
    v_fmac_f32 v71, 0xbec3ef15, v49
    v_sub_f32 v50, v66, v44
    v_sub_f32 v49, v35, v33
    v_add_f32 v66, v66, v44
    v_add_f32 v35, v35, v33
    v_mul_f32 v44, 0xbf0e39da, v50
    v_mul_f32 v33, 0x3f54db31, v50
    v_fmac_f32 v44, 0xbf54db31, v49
    v_fmac_f32 v33, 0xbf0e39da, v49
    v_sub_f32 v50, v80, v46
    v_sub_f32 v49, v23, v39
    v_add_f32 v80, v80, v46
    v_add_f32 v23, v23, v39
    v_mul_f32 v46, 0xbf3504f3, v50
    v_mul_f32 v39, 0x3f3504f3, v50
    v_fmac_f32 v46, 0xbf3504f3, v49
    v_fmac_f32 v39, 0xbf3504f3, v49
    v_sub_f32 v50, v74, v68
    v_sub_f32 v49, v21, v25
    v_add_f32 v74, v74, v68
    v_add_f32 v21, v21, v25
    v_mul_f32 v68, 0xbf54db31, v50
    v_mul_f32 v25, 0x3f0e39da, v50
    v_fmac_f32 v68, 0xbf0e39da, v49
    v_fmac_f32 v25, 0xbf54db31, v49
    v_sub_f32 v50, v42, v40
    v_sub_f32 v49, v69, v57
    v_add_f32 v42, v42, v40
    v_add_f32 v69, v69, v57
    v_mul_f32 v40, 0xbf6c835e, v50
    v_mul_f32 v57, 0x3ec3ef15, v50
    v_fmac_f32 v40, 0xbec3ef15, v49
    v_fmac_f32 v57, 0xbf6c835e, v49
    v_sub_f32 v50, v58, v28
    v_sub_f32 v49, v51, v53
    v_add_f32 v58, v58, v28
    v_add_f32 v51, v51, v53
    v_mul_f32 v28, 0xbf7b14be, v50
    v_mul_f32 v53, 0x3e47c5c2, v50
    v_fmac_f32 v28, 0xbe47c5c2, v49
    v_fmac_f32 v53, 0xbf7b14be, v49
    v_sub_f32 v50, v20, v56
    v_sub_f32 v49, v17, v55
    v_add_f32 v20, v20, v56
    v_add_f32 v17, v17, v55
    v_sub_f32 v56, v82, v18
    v_sub_f32 v55, v79, v67
    v_add_f32 v82, v82, v18
    v_add_f32 v79, v79, v67
    v_mul_f32 v18, 0x3f6c835e, v56
    v_mul_f32 v67, 0x3ec3ef15, v56
    v_fmac_f32 v18, 0xbec3ef15, v55
    v_fmac_f32 v67, 0x3f6c835e, v55
    v_sub_f32 v56, v70, v64
    v_sub_f32 v55, v81, v37
    v_add_f32 v70, v70, v64
    v_add_f32 v81, v81, v37
    v_mul_f32 v64, 0x3f3504f3, v56
    v_mul_f32 v37, 0x3f3504f3, v56
    v_fmac_f32 v64, 0xbf3504f3, v55
    v_fmac_f32 v37, 0x3f3504f3, v55
    v_sub_f32 v56, v32, v66
    v_sub_f32 v55, v41, v35
    v_add_f32 v32, v32, v66
    v_add_f32 v41, v41, v35
    v_mul_f32 v66, 0x3ec3ef15, v56
    v_mul_f32 v35, 0x3f6c835e, v56
    v_fmac_f32 v66, 0xbf6c835e, v55
    v_fmac_f32 v35, 0x3ec3ef15, v55
    v_sub_f32 v56, v23, v45
    v_sub_f32 v55, v38, v80
    v_add_f32 v38, v38, v80
    v_add_f32 v45, v45, v23
    v_sub_f32 v80, v78, v74
    v_sub_f32 v23, v63, v21
    v_add_f32 v78, v78, v74
    v_add_f32 v63, v63, v21
    v_mul_f32 v74, 0xbec3ef15, v80
    v_mul_f32 v21, 0x3f6c835e, v80
    v_fmac_f32 v74, 0xbf6c835e, v23
    v_fmac_f32 v21, 0xbec3ef15, v23
    v_sub_f32 v80, v36, v42
    v_sub_f32 v23, v29, v69
    v_add_f32 v36, v36, v42
    v_add_f32 v29, v29, v69
    v_mul_f32 v42, 0xbf3504f3, v80
    v_mul_f32 v69, 0x3f3504f3, v80
    v_fmac_f32 v42, 0xbf3504f3, v23
    v_fmac_f32 v69, 0xbf3504f3, v23
    v_sub_f32 v80, v62, v58
    v_sub_f32 v23, v31, v51
    v_add_f32 v62, v62, v58
    v_add_f32 v31, v31, v51
    v_mul_f32 v58, 0xbf6c835e, v80
    v_mul_f32 v51, 0x3ec3ef15, v80
    v_fmac_f32 v58, 0xbec3ef15, v23
    v_fmac_f32 v51, 0xbf6c835e, v23
    v_sub_f32 v80, v24, v83
    v_sub_f32 v23, v75, v59
    v_add_f32 v24, v24, v83
    v_add_f32 v75, v75, v59
    v_sub_f32 v83, v72, v26
    v_sub_f32 v59, v43, v77
    v_add_f32 v72, v72, v26
    v_add_f32 v43, v43, v77
    v_mul_f32 v26, 0x3f6c835e, v83
    v_mul_f32 v77, 0x3ec3ef15, v83
    v_fmac_f32 v26, 0xbec3ef15, v59
    v_fmac_f32 v77, 0x3f6c835e, v59
    v_sub_f32 v83, v54, v30
    v_sub_f32 v59, v27, v71
    v_add_f32 v54, v54, v30
    v_add_f32 v27, v27, v71
    v_mul_f32 v30, 0x3f3504f3, v83
    v_mul_f32 v71, 0x3f3504f3, v83
    v_fmac_f32 v30, 0xbf3504f3, v59
    v_fmac_f32 v71, 0x3f3504f3, v59
    v_sub_f32 v83, v48, v44
    v_sub_f32 v59, v65, v33
    v_add_f32 v48, v48, v44
    v_add_f32 v65, v65, v33
    v_mul_f32 v44, 0x3ec3ef15, v83
    v_mul_f32 v33, 0x3f6c835e, v83
    v_fmac_f32 v44, 0xbf6c835e, v59
    v_fmac_f32 v33, 0x3ec3ef15, v59
    v_sub_f32 v83, v39, v19
    v_sub_f32 v59, v60, v46
    v_add_f32 v60, v60, v46
    v_add_f32 v19, v19, v39
    v_sub_f32 v46, v16, v68
    v_sub_f32 v39, v73, v25
    v_add_f32 v16, v16, v68
    v_add_f32 v73, v73, v25
    v_mul_f32 v68, 0xbec3ef15, v46
    v_mul_f32 v25, 0x3f6c835e, v46
    v_fmac_f32 v68, 0xbf6c835e, v39
    v_fmac_f32 v25, 0xbec3ef15, v39
    v_sub_f32 v46, v34, v40
    v_sub_f32 v39, v61, v57
    v_add_f32 v34, v34, v40
    v_add_f32 v61, v61, v57
    v_mul_f32 v40, 0xbf3504f3, v46
    v_mul_f32 v57, 0x3f3504f3, v46
    v_fmac_f32 v40, 0xbf3504f3, v39
    v_fmac_f32 v57, 0xbf3504f3, v39
    v_sub_f32 v46, v52, v28
    v_sub_f32 v39, v47, v53
    v_add_f32 v52, v52, v28
    v_add_f32 v47, v47, v53
    v_mul_f32 v28, 0xbf6c835e, v46
    v_mul_f32 v53, 0x3ec3ef15, v46
    v_fmac_f32 v28, 0xbec3ef15, v39
    v_fmac_f32 v53, 0xbf6c835e, v39
    v_sub_f32 v46, v20, v38
    v_sub_f32 v39, v17, v45
    v_add_f32 v20, v20, v38
    v_add_f32 v17, v17, v45
    v_sub_f32 v38, v82, v78
    v_sub_f32 v45, v79, v63
    v_add_f32 v82, v82, v78
    v_add_f32 v79, v79, v63
    v_mul_f32 v78, 0x3f3504f3, v38
    v_mul_f32 v63, 0x3f3504f3, v38
    v_fmac_f32 v78, 0xbf3504f3, v45
    v_fmac_f32 v63, 0x3f3504f3, v45
    v_sub_f32 v38, v29, v81
    v_sub_f32 v45, v70, v36
    v_add_f32 v70, v70, v36
    v_add_f32 v81, v81, v29
    v_sub_f32 v36, v32, v62
    v_sub_f32 v29, v41, v31
    v_add_f32 v32, v32, v62
    v_add_f32 v41, v41, v31
    v_mul_f32 v62, 0xbf3504f3, v36
    v_mul_f32 v31, 0x3f3504f3, v36
    v_fmac_f32 v62, 0xbf3504f3, v29
    v_fmac_f32 v31, 0xbf3504f3, v29
    v_sub_f32 v36, v50, v56
    v_sub_f32 v29, v49, v55
    v_add_f32 v50, v50, v56
    v_add_f32 v49, v49, v55
    v_sub_f32 v56, v18, v74
    v_sub_f32 v55, v67, v21
    v_add_f32 v18, v18, v74
    v_add_f32 v67, v67, v21
    v_mul_f32 v74, 0x3f3504f3, v56
    v_mul_f32 v21, 0x3f3504f3, v56
    v_fmac_f32 v74, 0xbf3504f3, v55
    v_fmac_f32 v21, 0x3f3504f3, v55
    v_sub_f32 v56, v69, v37
    v_sub_f32 v55, v64, v42
    v_add_f32 v64, v64, v42
    v_add_f32 v37, v37, v69
    v_sub_f32 v42, v66, v58
    v_sub_f32 v69, v35, v51
    v_add_f32 v66, v66, v58
    v_add_f32 v35, v35, v51
    v_mul_f32 v58, 0xbf3504f3, v42
    v_mul_f32 v51, 0x3f3504f3, v42
    v_fmac_f32 v58, 0xbf3504f3, v69
    v_fmac_f32 v51, 0xbf3504f3, v69
    v_sub_f32 v42, v24, v60
    v_sub_f32 v69, v75, v19
    v_add_f32 v24, v24, v60
    v_add_f32 v75, v75, v19
    v_sub_f32 v60, v72, v16
    v_sub_f32 v19, v43, v73
    v_add_f32 v72, v72, v16
    v_add_f32 v43, v43, v73
    v_mul_f32 v16, 0x3f3504f3, v60
    v_mul_f32 v73, 0x3f3504f3, v60
    v_fmac_f32 v16, 0xbf3504f3, v19
    v_fmac_f32 v73, 0x3f3504f3, v19
    v_sub_f32 v60, v61, v27
    v_sub_f32 v19, v54, v34
    v_add_f32 v54, v54, v34
    v_add_f32 v27, v27, v61
    v_sub_f32 v34, v48, v52
    v_sub_f32 v61, v65, v47
    v_add_f32 v48, v48, v52
    v_add_f32 v65, v65, v47
    v_mul_f32 v52, 0xbf3504f3, v34
    v_mul_f32 v47, 0x3f3504f3, v34
    v_fmac_f32 v52, 0xbf3504f3, v61
    v_fmac_f32 v47, 0xbf3504f3, v61
    v_sub_f32 v34, v80, v83
    v_sub_f32 v61, v23, v59
    v_add_f32 v80, v80, v83
    v_add_f32 v23, v23, v59
    v_sub_f32 v83, v26, v68
    v_sub_f32 v59, v77, v25
    v_add_f32 v26, v26, v68
    v_add_f32 v77, v77, v25
    v_mul_f32 v68, 0x3f3504f3, v83
    v_mul_f32 v25, 0x3f3504f3, v83
    v_fmac_f32 v68, 0xbf3504f3, v59
    v_fmac_f32 v25, 0x3f3504f3, v59
    v_sub_f32 v83, v57, v71
    v_sub_f32 v59, v30, v40
    v_add_f32 v30, v30, v40
    v_add_f32 v71, v71, v57
    v_sub_f32 v40, v44, v28
    v_sub_f32 v57, v33, v53
    v_add_f32 v44, v44, v28
    v_add_f32 v33, v33, v53
    v_mul_f32 v28, 0xbf3504f3, v40
    v_mul_f32 v53, 0x3f3504f3, v40
    v_fmac_f32 v28, 0xbf3504f3, v57
    v_fmac_f32 v53, 0xbf3504f3, v57
    v_sub_f32 v40, v20, v70
    v_sub_f32 v57, v17, v81
    v_add_f32 v20, v20, v70
    v_add_f32 v17, v17, v81
    v_sub_f32 v70, v41, v79
    v_sub_f32 v81, v82, v32
    v_add_f32 v82, v82, v32
    v_add_f32 v79, v79, v41
    v_sub_f32 v32, v46, v38
    v_sub_f32 v41, v39, v45
    v_add_f32 v46, v46, v38
    v_add_f32 v39, v39, v45
    v_sub_f32 v38, v31, v63
    v_sub_f32 v45, v78, v62
    v_add_f32 v78, v78, v62
    v_add_f32 v63, v63, v31
    v_sub_f32 v62, v50, v64
    v_sub_f32 v31, v49, v37
    v_add_f32 v50, v50, v64
    v_add_f32 v49, v49, v37
    v_sub_f32 v64, v35, v67
    v_sub_f32 v37, v18, v66
    v_add_f32 v18, v18, v66
    v_add_f32 v67, v67, v35
    v_sub_f32 v66, v36, v56
    v_sub_f32 v35, v29, v55
    v_add_f32 v36, v36, v56
    v_add_f32 v29, v29, v55
    v_sub_f32 v56, v51, v21
    v_sub_f32 v55, v74, v58
    v_add_f32 v74, v74, v58
    v_add_f32 v21, v21, v51
    v_sub_f32 v58, v24, v54
    v_sub_f32 v51, v75, v27
    v_add_f32 v24, v24, v54
    v_add_f32 v75, v75, v27
    v_sub_f32 v54, v65, v43
    v_sub_f32 v27, v72, v48
    v_add_f32 v72, v72, v48
    v_add_f32 v43, v43, v65
    v_sub_f32 v48, v42, v60
    v_sub_f32 v65, v69, v19
    v_add_f32 v42, v42, v60
    v_add_f32 v69, v69, v19
    v_sub_f32 v60, v47, v73
    v_sub_f32 v19, v16, v52
    v_add_f32 v16, v16, v52
    v_add_f32 v73, v73, v47
    v_sub_f32 v52, v80, v30
    v_sub_f32 v47, v23, v71
    v_add_f32 v80, v80, v30
    v_add_f32 v23, v23, v71
    v_sub_f32 v30, v33, v77
    v_sub_f32 v71, v26, v44
    v_add_f32 v26, v26, v44
    v_add_f32 v77, v77, v33
    v_sub_f32 v44, v34, v83
    v_sub_f32 v33, v61, v59
    v_add_f32 v34, v34, v83
    v_add_f32 v61, v61, v59
    v_sub_f32 v83, v53, v25
    v_sub_f32 v59, v68, v28
    v_add_f32 v68, v68, v28
    v_add_f32 v25, v25, v53
    v_sub_f32 v28, v20, v82
    v_sub_f32 v53, v17, v79
    v_add_f32 v20, v20, v82
    v_add_f32 v17, v17, v79
    v_sub_f32 v82, v40, v70
    v_sub_f32 v79, v57, v81
    v_add_f32 v40, v40, v70
    v_add_f32 v57, v57, v81
    v_sub_f32 v70, v46, v78
    v_sub_f32 v81, v39, v63
    v_add_f32 v46, v46, v78
    v_add_f32 v39, v39, v63
    v_sub_f32 v78, v32, v38
    v_sub_f32 v63, v41, v45
    v_add_f32 v32, v32, v38
    v_add_f32 v41, v41, v45
    v_sub_f32 v38, v50, v18
    v_sub_f32 v45, v49, v67
    v_add_f32 v50, v50, v18
    v_add_f32 v49, v49, v67
    v_sub_f32 v18, v62, v64
    v_sub_f32 v67, v31, v37
    v_add_f32 v62, v62, v64
    v_add_f32 v31, v31, v37
    v_sub_f32 v64, v36, v74
    v_sub_f32 v37, v29, v21
    v_add_f32 v36, v36, v74
    v_add_f32 v29, v29, v21
    v_sub_f32 v74, v66, v56
    v_sub_f32 v21, v35, v55
    v_add_f32 v66, v66, v56
    v_add_f32 v35, v35, v55
    v_sub_f32 v56, v24, v72
    v_sub_f32 v55, v75, v43
    v_add_f32 v24, v24, v72
    v_add_f32 v75, v75, v43
    v_sub_f32 v72, v58, v54
    v_sub_f32 v43, v51, v27
    v_add_f32 v58, v58, v54
    v_add_f32 v51, v51, v27
    v_sub_f32 v54, v42, v16
    v_sub_f32 v27, v69, v73
    v_add_f32 v42, v42, v16
    v_add_f32 v69, v69, v73
    v_sub_f32 v16, v48, v60
    v_sub_f32 v73, v65, v19
    v_add_f32 v48, v48, v60
    v_add_f32 v65, v65, v19
    v_sub_f32 v60, v80, v26
    v_sub_f32 v19, v23, v77
    v_add_f32 v80, v80, v26
    v_add_f32 v23, v23, v77
    v_sub_f32 v26, v52, v30
    v_sub_f32 v77, v47, v71
    v_add_f32 v52, v52, v30
    v_add_f32 v47, v47, v71
    v_sub_f32 v30, v34, v68
    v_sub_f32 v71, v61, v25
    v_add_f32 v34, v34, v68
    v_add_f32 v61, v61, v25
    v_sub_f32 v68, v44, v83
    v_sub_f32 v25, v33, v59
    v_add_f32 v44, v44, v83
    v_add_f32 v33, v33, v59
    s_add_u32 s15, s14, 109051904
    v_lshlrev_b32 v5, 3, v1
    s_add_u32 s16, s15, 0
    v_mov_b32 v88, v20
    v_mov_b32 v89, v17
    buffer_store_dwordx2 v[88:89], v5, s[8:11], s16 offen sc1
    s_add_u32 s16, s15, 512
    v_mov_b32 v90, v24
    v_mov_b32 v91, v75
    buffer_store_dwordx2 v[90:91], v5, s[8:11], s16 offen sc1
    s_add_u32 s16, s15, 1024
    v_mov_b32 v92, v50
    v_mov_b32 v93, v49
    buffer_store_dwordx2 v[92:93], v5, s[8:11], s16 offen sc1
    s_add_u32 s16, s15, 1536
    v_mov_b32 v94, v80
    v_mov_b32 v95, v23
    buffer_store_dwordx2 v[94:95], v5, s[8:11], s16 offen sc1
    s_add_u32 s16, s15, 2048
    v_mov_b32 v96, v46
    v_mov_b32 v97, v39
    buffer_store_dwordx2 v[96:97], v5, s[8:11], s16 offen sc1
    s_add_u32 s16, s15, 2560
    v_mov_b32 v98, v42
    v_mov_b32 v99, v69
    buffer_store_dwordx2 v[98:99], v5, s[8:11], s16 offen sc1
    s_add_u32 s16, s15, 3072
    v_mov_b32 v100, v36
    v_mov_b32 v101, v29
    buffer_store_dwordx2 v[100:101], v5, s[8:11], s16 offen sc1
    s_add_u32 s16, s15, 3584
    v_mov_b32 v102, v34
    v_mov_b32 v103, v61
    buffer_store_dwordx2 v[102:103], v5, s[8:11], s16 offen sc1
    s_add_u32 s16, s15, 4096
    v_mov_b32 v88, v40
    v_mov_b32 v89, v57
    buffer_store_dwordx2 v[88:89], v5, s[8:11], s16 offen sc1
    s_add_u32 s16, s15, 4608
    v_mov_b32 v90, v58
    v_mov_b32 v91, v51
    buffer_store_dwordx2 v[90:91], v5, s[8:11], s16 offen sc1
    s_add_u32 s16, s15, 5120
    v_mov_b32 v92, v62
    v_mov_b32 v93, v31
    buffer_store_dwordx2 v[92:93], v5, s[8:11], s16 offen sc1
    s_add_u32 s16, s15, 5632
    v_mov_b32 v94, v52
    v_mov_b32 v95, v47
    buffer_store_dwordx2 v[94:95], v5, s[8:11], s16 offen sc1
    s_add_u32 s16, s15, 6144
    v_mov_b32 v96, v32
    v_mov_b32 v97, v41
    buffer_store_dwordx2 v[96:97], v5, s[8:11], s16 offen sc1
    s_add_u32 s16, s15, 6656
    v_mov_b32 v98, v48
    v_mov_b32 v99, v65
    buffer_store_dwordx2 v[98:99], v5, s[8:11], s16 offen sc1
    s_add_u32 s16, s15, 7168
    v_mov_b32 v100, v66
    v_mov_b32 v101, v35
    buffer_store_dwordx2 v[100:101], v5, s[8:11], s16 offen sc1
    s_add_u32 s16, s15, 7680
    v_mov_b32 v102, v44
    v_mov_b32 v103, v33
    buffer_store_dwordx2 v[102:103], v5, s[8:11], s16 offen sc1
    s_add_u32 s16, s15, 8192
    v_mov_b32 v88, v28
    v_mov_b32 v89, v53
    buffer_store_dwordx2 v[88:89], v5, s[8:11], s16 offen sc1
    s_add_u32 s16, s15, 8704
    v_mov_b32 v90, v56
    v_mov_b32 v91, v55
    buffer_store_dwordx2 v[90:91], v5, s[8:11], s16 offen sc1
    s_add_u32 s16, s15, 9216
    v_mov_b32 v92, v38
    v_mov_b32 v93, v45
    buffer_store_dwordx2 v[92:93], v5, s[8:11], s16 offen sc1
    s_add_u32 s16, s15, 9728
    v_mov_b32 v94, v60
    v_mov_b32 v95, v19
    buffer_store_dwordx2 v[94:95], v5, s[8:11], s16 offen sc1
    s_add_u32 s16, s15, 10240
    v_mov_b32 v96, v70
    v_mov_b32 v97, v81
    buffer_store_dwordx2 v[96:97], v5, s[8:11], s16 offen sc1
    s_add_u32 s16, s15, 10752
    v_mov_b32 v98, v54
    v_mov_b32 v99, v27
    buffer_store_dwordx2 v[98:99], v5, s[8:11], s16 offen sc1
    s_add_u32 s16, s15, 11264
    v_mov_b32 v100, v64
    v_mov_b32 v101, v37
    buffer_store_dwordx2 v[100:101], v5, s[8:11], s16 offen sc1
    s_add_u32 s16, s15, 11776
    v_mov_b32 v102, v30
    v_mov_b32 v103, v71
    buffer_store_dwordx2 v[102:103], v5, s[8:11], s16 offen sc1
    s_add_u32 s16, s15, 12288
    v_mov_b32 v88, v82
    v_mov_b32 v89, v79
    buffer_store_dwordx2 v[88:89], v5, s[8:11], s16 offen sc1
    s_add_u32 s16, s15, 12800
    v_mov_b32 v90, v72
    v_mov_b32 v91, v43
    buffer_store_dwordx2 v[90:91], v5, s[8:11], s16 offen sc1
    s_add_u32 s16, s15, 13312
    v_mov_b32 v92, v18
    v_mov_b32 v93, v67
    buffer_store_dwordx2 v[92:93], v5, s[8:11], s16 offen sc1
    s_add_u32 s16, s15, 13824
    v_mov_b32 v94, v26
    v_mov_b32 v95, v77
    buffer_store_dwordx2 v[94:95], v5, s[8:11], s16 offen sc1
    s_add_u32 s16, s15, 14336
    v_mov_b32 v96, v78
    v_mov_b32 v97, v63
    buffer_store_dwordx2 v[96:97], v5, s[8:11], s16 offen sc1
    s_add_u32 s16, s15, 14848
    v_mov_b32 v98, v16
    v_mov_b32 v99, v73
    buffer_store_dwordx2 v[98:99], v5, s[8:11], s16 offen sc1
    s_add_u32 s16, s15, 15360
    v_mov_b32 v100, v74
    v_mov_b32 v101, v21
    buffer_store_dwordx2 v[100:101], v5, s[8:11], s16 offen sc1
    s_add_u32 s16, s15, 15872
    v_mov_b32 v102, v68
    v_mov_b32 v103, v25
    buffer_store_dwordx2 v[102:103], v5, s[8:11], s16 offen sc1
mega_kernel_f2_end:
    s_cmp_eq_u32 s99, 128
    s_cbranch_scc1 mega_kernel_f2ret
    s_waitcnt vmcnt(0)
    s_barrier
    v_mov_b32 v2, 1
    v_cmp_eq_u32 vcc, 0, v0
    s_and_saveexec_b64 s[80:81], vcc
    s_cbranch_execz mega_kernel_sg136_3
    buffer_atomic_add v2, off, s[88:91], 0 offset:136 sc1
mega_kernel_sg136_3:
    s_mov_b64 exec, s[80:81]
    s_waitcnt vmcnt(0)
    ds_read_b64_tr_b16 a[128:129], v201 offset:0
    ds_read_b64_tr_b16 a[130:131], v201 offset:256
    ds_read_b64_tr_b16 a[132:133], v201 offset:1024
    ds_read_b64_tr_b16 a[134:135], v201 offset:1280
    ds_read_b64_tr_b16 a[136:137], v201 offset:2048
    ds_read_b64_tr_b16 a[138:139], v201 offset:2304
    ds_read_b64_tr_b16 a[140:141], v201 offset:3072
    ds_read_b64_tr_b16 a[142:143], v201 offset:3328
    s_waitcnt lgkmcnt(0)
    ds_read_b64_tr_b16 a[144:145], v201 offset:4096
    ds_read_b64_tr_b16 a[146:147], v201 offset:4352
    ds_read_b64_tr_b16 a[148:149], v201 offset:5120
    ds_read_b64_tr_b16 a[150:151], v201 offset:5376
    ds_read_b64_tr_b16 a[152:153], v201 offset:6144
    ds_read_b64_tr_b16 a[154:155], v201 offset:6400
    ds_read_b64_tr_b16 a[156:157], v201 offset:7168
    ds_read_b64_tr_b16 a[158:159], v201 offset:7424
    s_waitcnt lgkmcnt(0)
    ds_read_b64_tr_b16 a[160:161], v201 offset:8192
    ds_read_b64_tr_b16 a[162:163], v201 offset:8448
    ds_read_b64_tr_b16 a[164:165], v201 offset:9216
    ds_read_b64_tr_b16 a[166:167], v201 offset:9472
    ds_read_b64_tr_b16 a[168:169], v201 offset:10240
    ds_read_b64_tr_b16 a[170:171], v201 offset:10496
    ds_read_b64_tr_b16 a[172:173], v201 offset:11264
    ds_read_b64_tr_b16 a[174:175], v201 offset:11520
    s_waitcnt lgkmcnt(0)
    ds_read_b64_tr_b16 a[176:177], v201 offset:12288
    ds_read_b64_tr_b16 a[178:179], v201 offset:12544
    ds_read_b64_tr_b16 a[180:181], v201 offset:13312
    ds_read_b64_tr_b16 a[182:183], v201 offset:13568
    ds_read_b64_tr_b16 a[184:185], v201 offset:14336
    ds_read_b64_tr_b16 a[186:187], v201 offset:14592
    ds_read_b64_tr_b16 a[188:189], v201 offset:15360
    ds_read_b64_tr_b16 a[190:191], v201 offset:15616
    s_waitcnt lgkmcnt(0)
    s_add_u32 m0, s56, 0
    s_add_u32 s58, s57, 49152
    s_and_b32 s58, s58, 0xffff
    s_lshl_b32 s58, s58, 5
    buffer_load_dwordx4 v200, s[52:55], s58 offen lds
    s_add_u32 m0, s56, 1024
    s_add_u32 s58, s57, 50176
    s_and_b32 s58, s58, 0xffff
    s_lshl_b32 s58, s58, 5
    buffer_load_dwordx4 v200, s[52:55], s58 offen lds
    s_add_u32 m0, s56, 2048
    s_add_u32 s58, s57, 51200
    s_and_b32 s58, s58, 0xffff
    s_lshl_b32 s58, s58, 5
    buffer_load_dwordx4 v200, s[52:55], s58 offen lds
    s_add_u32 m0, s56, 3072
    s_add_u32 s58, s57, 52224
    s_and_b32 s58, s58, 0xffff
    s_lshl_b32 s58, s58, 5
    buffer_load_dwordx4 v200, s[52:55], s58 offen lds
    s_add_u32 m0, s56, 4096
    s_add_u32 s58, s57, 53248
    s_and_b32 s58, s58, 0xffff
    s_lshl_b32 s58, s58, 5
    buffer_load_dwordx4 v200, s[52:55], s58 offen lds
    s_add_u32 m0, s56, 5120
    s_add_u32 s58, s57, 54272
    s_and_b32 s58, s58, 0xffff
    s_lshl_b32 s58, s58, 5
    buffer_load_dwordx4 v200, s[52:55], s58 offen lds
    s_add_u32 m0, s56, 6144
    s_add_u32 s58, s57, 55296
    s_and_b32 s58, s58, 0xffff
    s_lshl_b32 s58, s58, 5
    buffer_load_dwordx4 v200, s[52:55], s58 offen lds
    s_add_u32 m0, s56, 7168
    s_add_u32 s58, s57, 56320
    s_and_b32 s58, s58, 0xffff
    s_lshl_b32 s58, s58, 5
    buffer_load_dwordx4 v200, s[52:55], s58 offen lds
    s_add_u32 m0, s56, 8192
    s_add_u32 s58, s57, 57344
    s_and_b32 s58, s58, 0xffff
    s_lshl_b32 s58, s58, 5
    buffer_load_dwordx4 v200, s[52:55], s58 offen lds
    s_add_u32 m0, s56, 9216
    s_add_u32 s58, s57, 58368
    s_and_b32 s58, s58, 0xffff
    s_lshl_b32 s58, s58, 5
    buffer_load_dwordx4 v200, s[52:55], s58 offen lds
    s_add_u32 m0, s56, 10240
    s_add_u32 s58, s57, 59392
    s_and_b32 s58, s58, 0xffff
    s_lshl_b32 s58, s58, 5
    buffer_load_dwordx4 v200, s[52:55], s58 offen lds
    s_add_u32 m0, s56, 11264
    s_add_u32 s58, s57, 60416
    s_and_b32 s58, s58, 0xffff
    s_lshl_b32 s58, s58, 5
    buffer_load_dwordx4 v200, s[52:55], s58 offen lds
    s_add_u32 m0, s56, 12288
    s_add_u32 s58, s57, 61440
    s_and_b32 s58, s58, 0xffff
    s_lshl_b32 s58, s58, 5
    buffer_load_dwordx4 v200, s[52:55], s58 offen lds
    s_add_u32 m0, s56, 13312
    s_add_u32 s58, s57, 62464
    s_and_b32 s58, s58, 0xffff
    s_lshl_b32 s58, s58, 5
    buffer_load_dwordx4 v200, s[52:55], s58 offen lds
    s_add_u32 m0, s56, 14336
    s_add_u32 s58, s57, 63488
    s_and_b32 s58, s58, 0xffff
    s_lshl_b32 s58, s58, 5
    buffer_load_dwordx4 v200, s[52:55], s58 offen lds
    s_add_u32 m0, s56, 15360
    s_add_u32 s58, s57, 64512
    s_and_b32 s58, s58, 0xffff
    s_lshl_b32 s58, s58, 5
    buffer_load_dwordx4 v200, s[52:55], s58 offen lds
mega_kernel_wf2:
    s_sleep 8
    buffer_load_dword v2, off, s[88:91], 0 offset:136 sc1
    s_waitcnt vmcnt(0)
    v_cmp_ne_u32 vcc, 129, v2
    s_cbranch_vccnz mega_kernel_wf2
    s_barrier
    s_load_dwordx2 s[4:5], s[0:1], 80
    s_load_dwordx2 s[8:9], s[0:1], 96
    v_and_b32 v6, 7, v0
    v_lshrrev_b32 v7, 3, v0
    s_movk_i32 s13, 8448
    v_mul_lo_u32 v8, v6, s13
    v_lshl_add_u32 v4, v7, 3, v8
    v_lshlrev_b32 v5, 14, v7
    v_lshl_add_u32 v5, v6, 4, v5
    s_lshl_b32 s12, s92, 7
    s_add_u32 s12, s12, 109051904
    s_waitcnt lgkmcnt(0)
    s_mov_b32 s6, 8388608
    s_mov_b32 s7, 0x00020000
    s_mov_b32 s10, 268435456
    s_mov_b32 s11, 0x00020000
    s_add_u32 s13, s12, 0
    buffer_load_dwordx4 v[16:19], v5, s[8:11], s13 offen
    s_add_u32 s13, s12, 524288
    buffer_load_dwordx4 v[20:23], v5, s[8:11], s13 offen
    s_add_u32 s13, s12, 1048576
    buffer_load_dwordx4 v[24:27], v5, s[8:11], s13 offen
    s_add_u32 s13, s12, 1572864
    buffer_load_dwordx4 v[28:31], v5, s[8:11], s13 offen
    s_add_u32 s13, s12, 2097152
    buffer_load_dwordx4 v[32:35], v5, s[8:11], s13 offen
    s_add_u32 s13, s12, 2621440
    buffer_load_dwordx4 v[36:39], v5, s[8:11], s13 offen
    s_add_u32 s13, s12, 3145728
    buffer_load_dwordx4 v[40:43], v5, s[8:11], s13 offen
    s_add_u32 s13, s12, 3670016
    buffer_load_dwordx4 v[44:47], v5, s[8:11], s13 offen
    s_add_u32 s13, s12, 4194304
    buffer_load_dwordx4 v[48:51], v5, s[8:11], s13 offen
    s_add_u32 s13, s12, 4718592
    buffer_load_dwordx4 v[52:55], v5, s[8:11], s13 offen
    s_add_u32 s13, s12, 5242880
    buffer_load_dwordx4 v[56:59], v5, s[8:11], s13 offen
    s_add_u32 s13, s12, 5767168
    buffer_load_dwordx4 v[60:63], v5, s[8:11], s13 offen
    s_add_u32 s13, s12, 6291456
    buffer_load_dwordx4 v[64:67], v5, s[8:11], s13 offen
    s_add_u32 s13, s12, 6815744
    buffer_load_dwordx4 v[68:71], v5, s[8:11], s13 offen
    s_add_u32 s13, s12, 7340032
    buffer_load_dwordx4 v[72:75], v5, s[8:11], s13 offen
    s_add_u32 s13, s12, 7864320
    buffer_load_dwordx4 v[76:79], v5, s[8:11], s13 offen
    s_add_u32 s13, s12, 8388608
    buffer_load_dwordx4 v[80:83], v5, s[8:11], s13 offen
    s_waitcnt vmcnt(0)
    v_cmp_eq_u32 vcc, 0, v7
    s_nop 1
    v_mov_b32 v9, 0
    v_cndmask_b32 v17, v17, v9, vcc
    v_cndmask_b32 v19, v19, v9, vcc
    v_cndmask_b32 v81, v81, v9, vcc
    v_cndmask_b32 v83, v83, v9, vcc
    v_sub_u32 v6, 1024, v7
    v_and_b32 v6, 1023, v6
    v_lshl_add_u32 v6, v6, 3, v8
    v_sub_f32 v10, v16, v19
    v_add_f32 v11, v17, v18
    v_add_f32 v12, v16, v19
    v_sub_f32 v13, v18, v17
    ds_write_b64 v4, v[10:11] offset:0
    ds_write_b64 v6, v[12:13]
    v_sub_u32 v6, 992, v7
    v_and_b32 v6, 1023, v6
    v_lshl_add_u32 v6, v6, 3, v8
    v_sub_f32 v10, v20, v23
    v_add_f32 v11, v21, v22
    v_add_f32 v12, v20, v23
    v_sub_f32 v13, v22, v21
    ds_write_b64 v4, v[10:11] offset:256
    ds_write_b64 v6, v[12:13]
    v_sub_u32 v6, 960, v7
    v_and_b32 v6, 1023, v6
    v_lshl_add_u32 v6, v6, 3, v8
    v_sub_f32 v10, v24, v27
    v_add_f32 v11, v25, v26
    v_add_f32 v12, v24, v27
    v_sub_f32 v13, v26, v25
    ds_write_b64 v4, v[10:11] offset:512
    ds_write_b64 v6, v[12:13]
    v_sub_u32 v6, 928, v7
    v_and_b32 v6, 1023, v6
    v_lshl_add_u32 v6, v6, 3, v8
    v_sub_f32 v10, v28, v31
    v_add_f32 v11, v29, v30
    v_add_f32 v12, v28, v31
    v_sub_f32 v13, v30, v29
    ds_write_b64 v4, v[10:11] offset:768
    ds_write_b64 v6, v[12:13]
    v_sub_u32 v6, 896, v7
    v_and_b32 v6, 1023, v6
    v_lshl_add_u32 v6, v6, 3, v8
    v_sub_f32 v10, v32, v35
    v_add_f32 v11, v33, v34
    v_add_f32 v12, v32, v35
    v_sub_f32 v13, v34, v33
    ds_write_b64 v4, v[10:11] offset:1024
    ds_write_b64 v6, v[12:13]
    v_sub_u32 v6, 864, v7
    v_and_b32 v6, 1023, v6
    v_lshl_add_u32 v6, v6, 3, v8
    v_sub_f32 v10, v36, v39
    v_add_f32 v11, v37, v38
    v_add_f32 v12, v36, v39
    v_sub_f32 v13, v38, v37
    ds_write_b64 v4, v[10:11] offset:1280
    ds_write_b64 v6, v[12:13]
    v_sub_u32 v6, 832, v7
    v_and_b32 v6, 1023, v6
    v_lshl_add_u32 v6, v6, 3, v8
    v_sub_f32 v10, v40, v43
    v_add_f32 v11, v41, v42
    v_add_f32 v12, v40, v43
    v_sub_f32 v13, v42, v41
    ds_write_b64 v4, v[10:11] offset:1536
    ds_write_b64 v6, v[12:13]
    v_sub_u32 v6, 800, v7
    v_and_b32 v6, 1023, v6
    v_lshl_add_u32 v6, v6, 3, v8
    v_sub_f32 v10, v44, v47
    v_add_f32 v11, v45, v46
    v_add_f32 v12, v44, v47
    v_sub_f32 v13, v46, v45
    ds_write_b64 v4, v[10:11] offset:1792
    ds_write_b64 v6, v[12:13]
    v_sub_u32 v6, 768, v7
    v_and_b32 v6, 1023, v6
    v_lshl_add_u32 v6, v6, 3, v8
    v_sub_f32 v10, v48, v51
    v_add_f32 v11, v49, v50
    v_add_f32 v12, v48, v51
    v_sub_f32 v13, v50, v49
    ds_write_b64 v4, v[10:11] offset:2048
    ds_write_b64 v6, v[12:13]
    v_sub_u32 v6, 736, v7
    v_and_b32 v6, 1023, v6
    v_lshl_add_u32 v6, v6, 3, v8
    v_sub_f32 v10, v52, v55
    v_add_f32 v11, v53, v54
    v_add_f32 v12, v52, v55
    v_sub_f32 v13, v54, v53
    ds_write_b64 v4, v[10:11] offset:2304
    ds_write_b64 v6, v[12:13]
    v_sub_u32 v6, 704, v7
    v_and_b32 v6, 1023, v6
    v_lshl_add_u32 v6, v6, 3, v8
    v_sub_f32 v10, v56, v59
    v_add_f32 v11, v57, v58
    v_add_f32 v12, v56, v59
    v_sub_f32 v13, v58, v57
    ds_write_b64 v4, v[10:11] offset:2560
    ds_write_b64 v6, v[12:13]
    v_sub_u32 v6, 672, v7
    v_and_b32 v6, 1023, v6
    v_lshl_add_u32 v6, v6, 3, v8
    v_sub_f32 v10, v60, v63
    v_add_f32 v11, v61, v62
    v_add_f32 v12, v60, v63
    v_sub_f32 v13, v62, v61
    ds_write_b64 v4, v[10:11] offset:2816
    ds_write_b64 v6, v[12:13]
    v_sub_u32 v6, 640, v7
    v_and_b32 v6, 1023, v6
    v_lshl_add_u32 v6, v6, 3, v8
    v_sub_f32 v10, v64, v67
    v_add_f32 v11, v65, v66
    v_add_f32 v12, v64, v67
    v_sub_f32 v13, v66, v65
    ds_write_b64 v4, v[10:11] offset:3072
    ds_write_b64 v6, v[12:13]
    v_sub_u32 v6, 608, v7
    v_and_b32 v6, 1023, v6
    v_lshl_add_u32 v6, v6, 3, v8
    v_sub_f32 v10, v68, v71
    v_add_f32 v11, v69, v70
    v_add_f32 v12, v68, v71
    v_sub_f32 v13, v70, v69
    ds_write_b64 v4, v[10:11] offset:3328
    ds_write_b64 v6, v[12:13]
    v_sub_u32 v6, 576, v7
    v_and_b32 v6, 1023, v6
    v_lshl_add_u32 v6, v6, 3, v8
    v_sub_f32 v10, v72, v75
    v_add_f32 v11, v73, v74
    v_add_f32 v12, v72, v75
    v_sub_f32 v13, v74, v73
    ds_write_b64 v4, v[10:11] offset:3584
    ds_write_b64 v6, v[12:13]
    v_sub_u32 v6, 544, v7
    v_and_b32 v6, 1023, v6
    v_lshl_add_u32 v6, v6, 3, v8
    v_sub_f32 v10, v76, v79
    v_add_f32 v11, v77, v78
    v_add_f32 v12, v76, v79
    v_sub_f32 v13, v78, v77
    ds_write_b64 v4, v[10:11] offset:3840
    ds_write_b64 v6, v[12:13]
    s_and_saveexec_b64 s[14:15], vcc
    v_sub_u32 v6, 512, v7
    v_and_b32 v6, 1023, v6
    v_lshl_add_u32 v6, v6, 3, v8
    v_sub_f32 v10, v80, v83
    v_add_f32 v11, v81, v82
    v_add_f32 v12, v80, v83
    v_sub_f32 v13, v82, v81
    ds_write_b64 v4, v[10:11] offset:4096
    ds_write_b64 v6, v[12:13]
    s_mov_b64 exec, s[14:15]
    s_waitcnt lgkmcnt(0)
    s_barrier
    v_and_b32 v1, 31, v0
    v_lshrrev_b32 v2, 5, v0
    v_cvt_f32_u32 v3, v1
    s_movk_i32 s13, 8448
    v_mul_lo_u32 v7, v2, s13
    v_lshl_add_u32 v4, v1, 3, v7
    s_movk_i32 s13, 264
    v_mul_lo_u32 v5, v1, s13
    v_add_u32 v5, v5, v7
    ds_read_b32 v16, v4 offset:0
    ds_read_b32 v48, v4 offset:4
    ds_read_b32 v17, v4 offset:256
    ds_read_b32 v49, v4 offset:260
    ds_read_b32 v18, v4 offset:512
    ds_read_b32 v50, v4 offset:516
    ds_read_b32 v19, v4 offset:768
    ds_read_b32 v51, v4 offset:772
    ds_read_b32 v20, v4 offset:1024
    ds_read_b32 v52, v4 offset:1028
    ds_read_b32 v21, v4 offset:1280
    ds_read_b32 v53, v4 offset:1284
    ds_read_b32 v22, v4 offset:1536
    ds_read_b32 v54, v4 offset:1540
    s_waitcnt lgkmcnt(0)
    ds_read_b32 v23, v4 offset:1792
    ds_read_b32 v55, v4 offset:1796
    ds_read_b32 v24, v4 offset:2048
    ds_read_b32 v56, v4 offset:2052
    ds_read_b32 v25, v4 offset:2304
    ds_read_b32 v57, v4 offset:2308
    ds_read_b32 v26, v4 offset:2560
    ds_read_b32 v58, v4 offset:2564
    ds_read_b32 v27, v4 offset:2816
    ds_read_b32 v59, v4 offset:2820
    ds_read_b32 v28, v4 offset:3072
    ds_read_b32 v60, v4 offset:3076
    ds_read_b32 v29, v4 offset:3328
    ds_read_b32 v61, v4 offset:3332
    s_waitcnt lgkmcnt(0)
    ds_read_b32 v30, v4 offset:3584
    ds_read_b32 v62, v4 offset:3588
    ds_read_b32 v31, v4 offset:3840
    ds_read_b32 v63, v4 offset:3844
    ds_read_b32 v32, v4 offset:4096
    ds_read_b32 v64, v4 offset:4100
    ds_read_b32 v33, v4 offset:4352
    ds_read_b32 v65, v4 offset:4356
    ds_read_b32 v34, v4 offset:4608
    ds_read_b32 v66, v4 offset:4612
    ds_read_b32 v35, v4 offset:4864
    ds_read_b32 v67, v4 offset:4868
    ds_read_b32 v36, v4 offset:5120
    ds_read_b32 v68, v4 offset:5124
    s_waitcnt lgkmcnt(0)
    ds_read_b32 v37, v4 offset:5376
    ds_read_b32 v69, v4 offset:5380
    ds_read_b32 v38, v4 offset:5632
    ds_read_b32 v70, v4 offset:5636
    ds_read_b32 v39, v4 offset:5888
    ds_read_b32 v71, v4 offset:5892
    ds_read_b32 v40, v4 offset:6144
    ds_read_b32 v72, v4 offset:6148
    ds_read_b32 v41, v4 offset:6400
    ds_read_b32 v73, v4 offset:6404
    ds_read_b32 v42, v4 offset:6656
    ds_read_b32 v74, v4 offset:6660
    ds_read_b32 v43, v4 offset:6912
    ds_read_b32 v75, v4 offset:6916
    s_waitcnt lgkmcnt(0)
    ds_read_b32 v44, v4 offset:7168
    ds_read_b32 v76, v4 offset:7172
    ds_read_b32 v45, v4 offset:7424
    ds_read_b32 v77, v4 offset:7428
    ds_read_b32 v46, v4 offset:7680
    ds_read_b32 v78, v4 offset:7684
    ds_read_b32 v47, v4 offset:7936
    ds_read_b32 v79, v4 offset:7940
    s_waitcnt lgkmcnt(0)
    v_sub_f32 v80, v16, v32
    v_sub_f32 v81, v48, v64
    v_add_f32 v16, v16, v32
    v_add_f32 v48, v48, v64
    v_sub_f32 v32, v17, v33
    v_sub_f32 v64, v49, v65
    v_add_f32 v17, v17, v33
    v_add_f32 v49, v49, v65
    v_mul_f32 v33, 0x3f7b14be, v32
    v_mul_f32 v65, 0x3e47c5c2, v32
    v_fmac_f32 v33, 0xbe47c5c2, v64
    v_fmac_f32 v65, 0x3f7b14be, v64
    v_sub_f32 v32, v18, v34
    v_sub_f32 v64, v50, v66
    v_add_f32 v18, v18, v34
    v_add_f32 v50, v50, v66
    v_mul_f32 v34, 0x3f6c835e, v32
    v_mul_f32 v66, 0x3ec3ef15, v32
    v_fmac_f32 v34, 0xbec3ef15, v64
    v_fmac_f32 v66, 0x3f6c835e, v64
    v_sub_f32 v32, v19, v35
    v_sub_f32 v64, v51, v67
    v_add_f32 v19, v19, v35
    v_add_f32 v51, v51, v67
    v_mul_f32 v35, 0x3f54db31, v32
    v_mul_f32 v67, 0x3f0e39da, v32
    v_fmac_f32 v35, 0xbf0e39da, v64
    v_fmac_f32 v67, 0x3f54db31, v64
    v_sub_f32 v32, v20, v36
    v_sub_f32 v64, v52, v68
    v_add_f32 v20, v20, v36
    v_add_f32 v52, v52, v68
    v_mul_f32 v36, 0x3f3504f3, v32
    v_mul_f32 v68, 0x3f3504f3, v32
    v_fmac_f32 v36, 0xbf3504f3, v64
    v_fmac_f32 v68, 0x3f3504f3, v64
    v_sub_f32 v32, v21, v37
    v_sub_f32 v64, v53, v69
    v_add_f32 v21, v21, v37
    v_add_f32 v53, v53, v69
    v_mul_f32 v37, 0x3f0e39da, v32
    v_mul_f32 v69, 0x3f54db31, v32
    v_fmac_f32 v37, 0xbf54db31, v64
    v_fmac_f32 v69, 0x3f0e39da, v64
    v_sub_f32 v32, v22, v38
    v_sub_f32 v64, v54, v70
    v_add_f32 v22, v22, v38
    v_add_f32 v54, v54, v70
    v_mul_f32 v38, 0x3ec3ef15, v32
    v_mul_f32 v70, 0x3f6c835e, v32
    v_fmac_f32 v38, 0xbf6c835e, v64
    v_fmac_f32 v70, 0x3ec3ef15, v64
    v_sub_f32 v32, v23, v39
    v_sub_f32 v64, v55, v71
    v_add_f32 v23, v23, v39
    v_add_f32 v55, v55, v71
    v_mul_f32 v39, 0x3e47c5c2, v32
    v_mul_f32 v71, 0x3f7b14be, v32
    v_fmac_f32 v39, 0xbf7b14be, v64
    v_fmac_f32 v71, 0x3e47c5c2, v64
    v_sub_f32 v32, v72, v56
    v_sub_f32 v64, v24, v40
    v_add_f32 v24, v24, v40
    v_add_f32 v56, v56, v72
    v_sub_f32 v40, v25, v41
    v_sub_f32 v72, v57, v73
    v_add_f32 v25, v25, v41
    v_add_f32 v57, v57, v73
    v_mul_f32 v41, 0xbe47c5c2, v40
    v_mul_f32 v73, 0x3f7b14be, v40
    v_fmac_f32 v41, 0xbf7b14be, v72
    v_fmac_f32 v73, 0xbe47c5c2, v72
    v_sub_f32 v40, v26, v42
    v_sub_f32 v72, v58, v74
    v_add_f32 v26, v26, v42
    v_add_f32 v58, v58, v74
    v_mul_f32 v42, 0xbec3ef15, v40
    v_mul_f32 v74, 0x3f6c835e, v40
    v_fmac_f32 v42, 0xbf6c835e, v72
    v_fmac_f32 v74, 0xbec3ef15, v72
    v_sub_f32 v40, v27, v43
    v_sub_f32 v72, v59, v75
    v_add_f32 v27, v27, v43
    v_add_f32 v59, v59, v75
    v_mul_f32 v43, 0xbf0e39da, v40
    v_mul_f32 v75, 0x3f54db31, v40
    v_fmac_f32 v43, 0xbf54db31, v72
    v_fmac_f32 v75, 0xbf0e39da, v72
    v_sub_f32 v40, v28, v44
    v_sub_f32 v72, v60, v76
    v_add_f32 v28, v28, v44
    v_add_f32 v60, v60, v76
    v_mul_f32 v44, 0xbf3504f3, v40
    v_mul_f32 v76, 0x3f3504f3, v40
    v_fmac_f32 v44, 0xbf3504f3, v72
    v_fmac_f32 v76, 0xbf3504f3, v72
    v_sub_f32 v40, v29, v45
    v_sub_f32 v72, v61, v77
    v_add_f32 v29, v29, v45
    v_add_f32 v61, v61, v77
    v_mul_f32 v45, 0xbf54db31, v40
    v_mul_f32 v77, 0x3f0e39da, v40
    v_fmac_f32 v45, 0xbf0e39da, v72
    v_fmac_f32 v77, 0xbf54db31, v72
    v_sub_f32 v40, v30, v46
    v_sub_f32 v72, v62, v78
    v_add_f32 v30, v30, v46
    v_add_f32 v62, v62, v78
    v_mul_f32 v46, 0xbf6c835e, v40
    v_mul_f32 v78, 0x3ec3ef15, v40
    v_fmac_f32 v46, 0xbec3ef15, v72
    v_fmac_f32 v78, 0xbf6c835e, v72
    v_sub_f32 v40, v31, v47
    v_sub_f32 v72, v63, v79
    v_add_f32 v31, v31, v47
    v_add_f32 v63, v63, v79
    v_mul_f32 v47, 0xbf7b14be, v40
    v_mul_f32 v79, 0x3e47c5c2, v40
    v_fmac_f32 v47, 0xbe47c5c2, v72
    v_fmac_f32 v79, 0xbf7b14be, v72
    v_sub_f32 v40, v16, v24
    v_sub_f32 v72, v48, v56
    v_add_f32 v16, v16, v24
    v_add_f32 v48, v48, v56
    v_sub_f32 v24, v17, v25
    v_sub_f32 v56, v49, v57
    v_add_f32 v17, v17, v25
    v_add_f32 v49, v49, v57
    v_mul_f32 v25, 0x3f6c835e, v24
    v_mul_f32 v57, 0x3ec3ef15, v24
    v_fmac_f32 v25, 0xbec3ef15, v56
    v_fmac_f32 v57, 0x3f6c835e, v56
    v_sub_f32 v24, v18, v26
    v_sub_f32 v56, v50, v58
    v_add_f32 v18, v18, v26
    v_add_f32 v50, v50, v58
    v_mul_f32 v26, 0x3f3504f3, v24
    v_mul_f32 v58, 0x3f3504f3, v24
    v_fmac_f32 v26, 0xbf3504f3, v56
    v_fmac_f32 v58, 0x3f3504f3, v56
    v_sub_f32 v24, v19, v27
    v_sub_f32 v56, v51, v59
    v_add_f32 v19, v19, v27
    v_add_f32 v51, v51, v59
    v_mul_f32 v27, 0x3ec3ef15, v24
    v_mul_f32 v59, 0x3f6c835e, v24
    v_fmac_f32 v27, 0xbf6c835e, v56
    v_fmac_f32 v59, 0x3ec3ef15, v56
    v_sub_f32 v24, v60, v52
    v_sub_f32 v56, v20, v28
    v_add_f32 v20, v20, v28
    v_add_f32 v52, v52, v60
    v_sub_f32 v28, v21, v29
    v_sub_f32 v60, v53, v61
    v_add_f32 v21, v21, v29
    v_add_f32 v53, v53, v61
    v_mul_f32 v29, 0xbec3ef15, v28
    v_mul_f32 v61, 0x3f6c835e, v28
    v_fmac_f32 v29, 0xbf6c835e, v60
    v_fmac_f32 v61, 0xbec3ef15, v60
    v_sub_f32 v28, v22, v30
    v_sub_f32 v60, v54, v62
    v_add_f32 v22, v22, v30
    v_add_f32 v54, v54, v62
    v_mul_f32 v30, 0xbf3504f3, v28
    v_mul_f32 v62, 0x3f3504f3, v28
    v_fmac_f32 v30, 0xbf3504f3, v60
    v_fmac_f32 v62, 0xbf3504f3, v60
    v_sub_f32 v28, v23, v31
    v_sub_f32 v60, v55, v63
    v_add_f32 v23, v23, v31
    v_add_f32 v55, v55, v63
    v_mul_f32 v31, 0xbf6c835e, v28
    v_mul_f32 v63, 0x3ec3ef15, v28
    v_fmac_f32 v31, 0xbec3ef15, v60
    v_fmac_f32 v63, 0xbf6c835e, v60
    v_sub_f32 v28, v80, v32
    v_sub_f32 v60, v81, v64
    v_add_f32 v80, v80, v32
    v_add_f32 v81, v81, v64
    v_sub_f32 v32, v33, v41
    v_sub_f32 v64, v65, v73
    v_add_f32 v33, v33, v41
    v_add_f32 v65, v65, v73
    v_mul_f32 v41, 0x3f6c835e, v32
    v_mul_f32 v73, 0x3ec3ef15, v32
    v_fmac_f32 v41, 0xbec3ef15, v64
    v_fmac_f32 v73, 0x3f6c835e, v64
    v_sub_f32 v32, v34, v42
    v_sub_f32 v64, v66, v74
    v_add_f32 v34, v34, v42
    v_add_f32 v66, v66, v74
    v_mul_f32 v42, 0x3f3504f3, v32
    v_mul_f32 v74, 0x3f3504f3, v32
    v_fmac_f32 v42, 0xbf3504f3, v64
    v_fmac_f32 v74, 0x3f3504f3, v64
    v_sub_f32 v32, v35, v43
    v_sub_f32 v64, v67, v75
    v_add_f32 v35, v35, v43
    v_add_f32 v67, v67, v75
    v_mul_f32 v43, 0x3ec3ef15, v32
    v_mul_f32 v75, 0x3f6c835e, v32
    v_fmac_f32 v43, 0xbf6c835e, v64
    v_fmac_f32 v75, 0x3ec3ef15, v64
    v_sub_f32 v32, v76, v68
    v_sub_f32 v64, v36, v44
    v_add_f32 v36, v36, v44
    v_add_f32 v68, v68, v76
    v_sub_f32 v44, v37, v45
    v_sub_f32 v76, v69, v77
    v_add_f32 v37, v37, v45
    v_add_f32 v69, v69, v77
    v_mul_f32 v45, 0xbec3ef15, v44
    v_mul_f32 v77, 0x3f6c835e, v44
    v_fmac_f32 v45, 0xbf6c835e, v76
    v_fmac_f32 v77, 0xbec3ef15, v76
    v_sub_f32 v44, v38, v46
    v_sub_f32 v76, v70, v78
    v_add_f32 v38, v38, v46
    v_add_f32 v70, v70, v78
    v_mul_f32 v46, 0xbf3504f3, v44
    v_mul_f32 v78, 0x3f3504f3, v44
    v_fmac_f32 v46, 0xbf3504f3, v76
    v_fmac_f32 v78, 0xbf3504f3, v76
    v_sub_f32 v44, v39, v47
    v_sub_f32 v76, v71, v79
    v_add_f32 v39, v39, v47
    v_add_f32 v71, v71, v79
    v_mul_f32 v47, 0xbf6c835e, v44
    v_mul_f32 v79, 0x3ec3ef15, v44
    v_fmac_f32 v47, 0xbec3ef15, v76
    v_fmac_f32 v79, 0xbf6c835e, v76
    v_sub_f32 v44, v16, v20
    v_sub_f32 v76, v48, v52
    v_add_f32 v16, v16, v20
    v_add_f32 v48, v48, v52
    v_sub_f32 v20, v17, v21
    v_sub_f32 v52, v49, v53
    v_add_f32 v17, v17, v21
    v_add_f32 v49, v49, v53
    v_mul_f32 v21, 0x3f3504f3, v20
    v_mul_f32 v53, 0x3f3504f3, v20
    v_fmac_f32 v21, 0xbf3504f3, v52
    v_fmac_f32 v53, 0x3f3504f3, v52
    v_sub_f32 v20, v54, v50
    v_sub_f32 v52, v18, v22
    v_add_f32 v18, v18, v22
    v_add_f32 v50, v50, v54
    v_sub_f32 v22, v19, v23
    v_sub_f32 v54, v51, v55
    v_add_f32 v19, v19, v23
    v_add_f32 v51, v51, v55
    v_mul_f32 v23, 0xbf3504f3, v22
    v_mul_f32 v55, 0x3f3504f3, v22
    v_fmac_f32 v23, 0xbf3504f3, v54
    v_fmac_f32 v55, 0xbf3504f3, v54
    v_sub_f32 v22, v40, v24
    v_sub_f32 v54, v72, v56
    v_add_f32 v40, v40, v24
    v_add_f32 v72, v72, v56
    v_sub_f32 v24, v25, v29
    v_sub_f32 v56, v57, v61
    v_add_f32 v25, v25, v29
    v_add_f32 v57, v57, v61
    v_mul_f32 v29, 0x3f3504f3, v24
    v_mul_f32 v61, 0x3f3504f3, v24
    v_fmac_f32 v29, 0xbf3504f3, v56
    v_fmac_f32 v61, 0x3f3504f3, v56
    v_sub_f32 v24, v62, v58
    v_sub_f32 v56, v26, v30
    v_add_f32 v26, v26, v30
    v_add_f32 v58, v58, v62
    v_sub_f32 v30, v27, v31
    v_sub_f32 v62, v59, v63
    v_add_f32 v27, v27, v31
    v_add_f32 v59, v59, v63
    v_mul_f32 v31, 0xbf3504f3, v30
    v_mul_f32 v63, 0x3f3504f3, v30
    v_fmac_f32 v31, 0xbf3504f3, v62
    v_fmac_f32 v63, 0xbf3504f3, v62
    v_sub_f32 v30, v80, v36
    v_sub_f32 v62, v81, v68
    v_add_f32 v80, v80, v36
    v_add_f32 v81, v81, v68
    v_sub_f32 v36, v33, v37
    v_sub_f32 v68, v65, v69
    v_add_f32 v33, v33, v37
    v_add_f32 v65, v65, v69
    v_mul_f32 v37, 0x3f3504f3, v36
    v_mul_f32 v69, 0x3f3504f3, v36
    v_fmac_f32 v37, 0xbf3504f3, v68
    v_fmac_f32 v69, 0x3f3504f3, v68
    v_sub_f32 v36, v70, v66
    v_sub_f32 v68, v34, v38
    v_add_f32 v34, v34, v38
    v_add_f32 v66, v66, v70
    v_sub_f32 v38, v35, v39
    v_sub_f32 v70, v67, v71
    v_add_f32 v35, v35, v39
    v_add_f32 v67, v67, v71
    v_mul_f32 v39, 0xbf3504f3, v38
    v_mul_f32 v71, 0x3f3504f3, v38
    v_fmac_f32 v39, 0xbf3504f3, v70
    v_fmac_f32 v71, 0xbf3504f3, v70
    v_sub_f32 v38, v28, v32
    v_sub_f32 v70, v60, v64
    v_add_f32 v28, v28, v32
    v_add_f32 v60, v60, v64
    v_sub_f32 v32, v41, v45
    v_sub_f32 v64, v73, v77
    v_add_f32 v41, v41, v45
    v_add_f32 v73, v73, v77
    v_mul_f32 v45, 0x3f3504f3, v32
    v_mul_f32 v77, 0x3f3504f3, v32
    v_fmac_f32 v45, 0xbf3504f3, v64
    v_fmac_f32 v77, 0x3f3504f3, v64
    v_sub_f32 v32, v78, v74
    v_sub_f32 v64, v42, v46
    v_add_f32 v42, v42, v46
    v_add_f32 v74, v74, v78
    v_sub_f32 v46, v43, v47
    v_sub_f32 v78, v75, v79
    v_add_f32 v43, v43, v47
    v_add_f32 v75, v75, v79
    v_mul_f32 v47, 0xbf3504f3, v46
    v_mul_f32 v79, 0x3f3504f3, v46
    v_fmac_f32 v47, 0xbf3504f3, v78
    v_fmac_f32 v79, 0xbf3504f3, v78
    v_sub_f32 v46, v16, v18
    v_sub_f32 v78, v48, v50
    v_add_f32 v16, v16, v18
    v_add_f32 v48, v48, v50
    v_sub_f32 v18, v51, v49
    v_sub_f32 v50, v17, v19
    v_add_f32 v17, v17, v19
    v_add_f32 v49, v49, v51
    v_sub_f32 v19, v44, v20
    v_sub_f32 v51, v76, v52
    v_add_f32 v44, v44, v20
    v_add_f32 v76, v76, v52
    v_sub_f32 v20, v55, v53
    v_sub_f32 v52, v21, v23
    v_add_f32 v21, v21, v23
    v_add_f32 v53, v53, v55
    v_sub_f32 v23, v40, v26
    v_sub_f32 v55, v72, v58
    v_add_f32 v40, v40, v26
    v_add_f32 v72, v72, v58
    v_sub_f32 v26, v59, v57
    v_sub_f32 v58, v25, v27
    v_add_f32 v25, v25, v27
    v_add_f32 v57, v57, v59
    v_sub_f32 v27, v22, v24
    v_sub_f32 v59, v54, v56
    v_add_f32 v22, v22, v24
    v_add_f32 v54, v54, v56
    v_sub_f32 v24, v63, v61
    v_sub_f32 v56, v29, v31
    v_add_f32 v29, v29, v31
    v_add_f32 v61, v61, v63
    v_sub_f32 v31, v80, v34
    v_sub_f32 v63, v81, v66
    v_add_f32 v80, v80, v34
    v_add_f32 v81, v81, v66
    v_sub_f32 v34, v67, v65
    v_sub_f32 v66, v33, v35
    v_add_f32 v33, v33, v35
    v_add_f32 v65, v65, v67
    v_sub_f32 v35, v30, v36
    v_sub_f32 v67, v62, v68
    v_add_f32 v30, v30, v36
    v_add_f32 v62, v62, v68
    v_sub_f32 v36, v71, v69
    v_sub_f32 v68, v37, v39
    v_add_f32 v37, v37, v39
    v_add_f32 v69, v69, v71
    v_sub_f32 v39, v28, v42
    v_sub_f32 v71, v60, v74
    v_add_f32 v28, v28, v42
    v_add_f32 v60, v60, v74
    v_sub_f32 v42, v75, v73
    v_sub_f32 v74, v41, v43
    v_add_f32 v41, v41, v43
    v_add_f32 v73, v73, v75
    v_sub_f32 v43, v38, v32
    v_sub_f32 v75, v70, v64
    v_add_f32 v38, v38, v32
    v_add_f32 v70, v70, v64
    v_sub_f32 v32, v79, v77
    v_sub_f32 v64, v45, v47
    v_add_f32 v45, v45, v47
    v_add_f32 v77, v77, v79
    v_sub_f32 v47, v16, v17
    v_sub_f32 v79, v48, v49
    v_add_f32 v16, v16, v17
    v_add_f32 v48, v48, v49
    v_sub_f32 v17, v46, v18
    v_sub_f32 v49, v78, v50
    v_add_f32 v46, v46, v18
    v_add_f32 v78, v78, v50
    v_sub_f32 v18, v44, v21
    v_sub_f32 v50, v76, v53
    v_add_f32 v44, v44, v21
    v_add_f32 v76, v76, v53
    v_sub_f32 v21, v19, v20
    v_sub_f32 v53, v51, v52
    v_add_f32 v19, v19, v20
    v_add_f32 v51, v51, v52
    v_sub_f32 v20, v40, v25
    v_sub_f32 v52, v72, v57
    v_add_f32 v40, v40, v25
    v_add_f32 v72, v72, v57
    v_sub_f32 v25, v23, v26
    v_sub_f32 v57, v55, v58
    v_add_f32 v23, v23, v26
    v_add_f32 v55, v55, v58
    v_sub_f32 v26, v22, v29
    v_sub_f32 v58, v54, v61
    v_add_f32 v22, v22, v29
    v_add_f32 v54, v54, v61
    v_sub_f32 v29, v27, v24
    v_sub_f32 v61, v59, v56
    v_add_f32 v27, v27, v24
    v_add_f32 v59, v59, v56
    v_sub_f32 v24, v80, v33
    v_sub_f32 v56, v81, v65
    v_add_f32 v80, v80, v33
    v_add_f32 v81, v81, v65
    v_sub_f32 v33, v31, v34
    v_sub_f32 v65, v63, v66
    v_add_f32 v31, v31, v34
    v_add_f32 v63, v63, v66
    v_sub_f32 v34, v30, v37
    v_sub_f32 v66, v62, v69
    v_add_f32 v30, v30, v37
    v_add_f32 v62, v62, v69
    v_sub_f32 v37, v35, v36
    v_sub_f32 v69, v67, v68
    v_add_f32 v35, v35, v36
    v_add_f32 v67, v67, v68
    v_sub_f32 v36, v28, v41
    v_sub_f32 v68, v60, v73
    v_add_f32 v28, v28, v41
    v_add_f32 v60, v60, v73
    v_sub_f32 v41, v39, v42
    v_sub_f32 v73, v71, v74
    v_add_f32 v39, v39, v42
    v_add_f32 v71, v71, v74
    v_sub_f32 v42, v38, v45
    v_sub_f32 v74, v70, v77
    v_add_f32 v38, v38, v45
    v_add_f32 v70, v70, v77
    v_sub_f32 v45, v43, v32
    v_sub_f32 v77, v75, v64
    v_add_f32 v43, v43, v32
    v_add_f32 v75, v75, v64
    v_mul_f32 v32, 0x3a800000, v3
    v_cos_f32 v64, v32
    v_sin_f32 v82, v32
    s_nop 0
    v_mul_f32 v83, v80, v64
    v_fma_f32 v83, -v81, v82, v83
    v_mul_f32 v81, v81, v64
    v_fmac_f32 v81, v80, v82
    v_mul_f32 v32, 0x3b000000, v3
    v_cos_f32 v64, v32
    v_sin_f32 v82, v32
    s_nop 0
    v_mul_f32 v80, v40, v64
    v_fma_f32 v80, -v72, v82, v80
    v_mul_f32 v72, v72, v64
    v_fmac_f32 v72, v40, v82
    v_mul_f32 v32, 0x3b400000, v3
    v_cos_f32 v64, v32
    v_sin_f32 v82, v32
    s_nop 0
    v_mul_f32 v40, v28, v64
    v_fma_f32 v40, -v60, v82, v40
    v_mul_f32 v60, v60, v64
    v_fmac_f32 v60, v28, v82
    v_mul_f32 v32, 0x3b800000, v3
    v_cos_f32 v64, v32
    v_sin_f32 v82, v32
    s_nop 0
    v_mul_f32 v28, v44, v64
    v_fma_f32 v28, -v76, v82, v28
    v_mul_f32 v76, v76, v64
    v_fmac_f32 v76, v44, v82
    v_mul_f32 v32, 0x3ba00000, v3
    v_cos_f32 v64, v32
    v_sin_f32 v82, v32
    s_nop 0
    v_mul_f32 v44, v30, v64
    v_fma_f32 v44, -v62, v82, v44
    v_mul_f32 v62, v62, v64
    v_fmac_f32 v62, v30, v82
    v_mul_f32 v32, 0x3bc00000, v3
    v_cos_f32 v64, v32
    v_sin_f32 v82, v32
    s_nop 0
    v_mul_f32 v30, v22, v64
    v_fma_f32 v30, -v54, v82, v30
    v_mul_f32 v54, v54, v64
    v_fmac_f32 v54, v22, v82
    v_mul_f32 v32, 0x3be00000, v3
    v_cos_f32 v64, v32
    v_sin_f32 v82, v32
    s_nop 0
    v_mul_f32 v22, v38, v64
    v_fma_f32 v22, -v70, v82, v22
    v_mul_f32 v70, v70, v64
    v_fmac_f32 v70, v38, v82
    v_mul_f32 v32, 0x3c000000, v3
    v_cos_f32 v64, v32
    v_sin_f32 v82, v32
    s_nop 0
    v_mul_f32 v38, v46, v64
    v_fma_f32 v38, -v78, v82, v38
    v_mul_f32 v78, v78, v64
    v_fmac_f32 v78, v46, v82
    v_mul_f32 v32, 0x3c100000, v3
    v_cos_f32 v64, v32
    v_sin_f32 v82, v32
    s_nop 0
    v_mul_f32 v46, v31, v64
    v_fma_f32 v46, -v63, v82, v46
    v_mul_f32 v63, v63, v64
    v_fmac_f32 v63, v31, v82
    v_mul_f32 v32, 0x3c200000, v3
    v_cos_f32 v64, v32
    v_sin_f32 v82, v32
    s_nop 0
    v_mul_f32 v31, v23, v64
    v_fma_f32 v31, -v55, v82, v31
    v_mul_f32 v55, v55, v64
    v_fmac_f32 v55, v23, v82
    v_mul_f32 v32, 0x3c300000, v3
    v_cos_f32 v64, v32
    v_sin_f32 v82, v32
    s_nop 0
    v_mul_f32 v23, v39, v64
    v_fma_f32 v23, -v71, v82, v23
    v_mul_f32 v71, v71, v64
    v_fmac_f32 v71, v39, v82
    v_mul_f32 v32, 0x3c400000, v3
    v_cos_f32 v64, v32
    v_sin_f32 v82, v32
    s_nop 0
    v_mul_f32 v39, v19, v64
    v_fma_f32 v39, -v51, v82, v39
    v_mul_f32 v51, v51, v64
    v_fmac_f32 v51, v19, v82
    v_mul_f32 v32, 0x3c500000, v3
    v_cos_f32 v64, v32
    v_sin_f32 v82, v32
    s_nop 0
    v_mul_f32 v19, v35, v64
    v_fma_f32 v19, -v67, v82, v19
    v_mul_f32 v67, v67, v64
    v_fmac_f32 v67, v35, v82
    v_mul_f32 v32, 0x3c600000, v3
    v_cos_f32 v64, v32
    v_sin_f32 v82, v32
    s_nop 0
    v_mul_f32 v35, v27, v64
    v_fma_f32 v35, -v59, v82, v35
    v_mul_f32 v59, v59, v64
    v_fmac_f32 v59, v27, v82
    v_mul_f32 v32, 0x3c700000, v3
    v_cos_f32 v64, v32
    v_sin_f32 v82, v32
    s_nop 0
    v_mul_f32 v27, v43, v64
    v_fma_f32 v27, -v75, v82, v27
    v_mul_f32 v75, v75, v64
    v_fmac_f32 v75, v43, v82
    v_mul_f32 v32, 0x3c800000, v3
    v_cos_f32 v64, v32
    v_sin_f32 v82, v32
    s_nop 0
    v_mul_f32 v43, v47, v64
    v_fma_f32 v43, -v79, v82, v43
    v_mul_f32 v79, v79, v64
    v_fmac_f32 v79, v47, v82
    v_mul_f32 v32, 0x3c880000, v3
    v_cos_f32 v64, v32
    v_sin_f32 v82, v32
    s_nop 0
    v_mul_f32 v47, v24, v64
    v_fma_f32 v47, -v56, v82, v47
    v_mul_f32 v56, v56, v64
    v_fmac_f32 v56, v24, v82
    v_mul_f32 v32, 0x3c900000, v3
    v_cos_f32 v64, v32
    v_sin_f32 v82, v32
    s_nop 0
    v_mul_f32 v24, v20, v64
    v_fma_f32 v24, -v52, v82, v24
    v_mul_f32 v52, v52, v64
    v_fmac_f32 v52, v20, v82
    v_mul_f32 v32, 0x3c980000, v3
    v_cos_f32 v64, v32
    v_sin_f32 v82, v32
    s_nop 0
    v_mul_f32 v20, v36, v64
    v_fma_f32 v20, -v68, v82, v20
    v_mul_f32 v68, v68, v64
    v_fmac_f32 v68, v36, v82
    v_mul_f32 v32, 0x3ca00000, v3
    v_cos_f32 v64, v32
    v_sin_f32 v82, v32
    s_nop 0
    v_mul_f32 v36, v18, v64
    v_fma_f32 v36, -v50, v82, v36
    v_mul_f32 v50, v50, v64
    v_fmac_f32 v50, v18, v82
    v_mul_f32 v32, 0x3ca80000, v3
    v_cos_f32 v64, v32
    v_sin_f32 v82, v32
    s_nop 0
    v_mul_f32 v18, v34, v64
    v_fma_f32 v18, -v66, v82, v18
    v_mul_f32 v66, v66, v64
    v_fmac_f32 v66, v34, v82
    v_mul_f32 v32, 0x3cb00000, v3
    v_cos_f32 v64, v32
    v_sin_f32 v82, v32
    s_nop 0
    v_mul_f32 v34, v26, v64
    v_fma_f32 v34, -v58, v82, v34
    v_mul_f32 v58, v58, v64
    v_fmac_f32 v58, v26, v82
    v_mul_f32 v32, 0x3cb80000, v3
    v_cos_f32 v64, v32
    v_sin_f32 v82, v32
    s_nop 0
    v_mul_f32 v26, v42, v64
    v_fma_f32 v26, -v74, v82, v26
    v_mul_f32 v74, v74, v64
    v_fmac_f32 v74, v42, v82
    v_mul_f32 v32, 0x3cc00000, v3
    v_cos_f32 v64, v32
    v_sin_f32 v82, v32
    s_nop 0
    v_mul_f32 v42, v17, v64
    v_fma_f32 v42, -v49, v82, v42
    v_mul_f32 v49, v49, v64
    v_fmac_f32 v49, v17, v82
    v_mul_f32 v32, 0x3cc80000, v3
    v_cos_f32 v64, v32
    v_sin_f32 v82, v32
    s_nop 0
    v_mul_f32 v17, v33, v64
    v_fma_f32 v17, -v65, v82, v17
    v_mul_f32 v65, v65, v64
    v_fmac_f32 v65, v33, v82
    v_mul_f32 v32, 0x3cd00000, v3
    v_cos_f32 v64, v32
    v_sin_f32 v82, v32
    s_nop 0
    v_mul_f32 v33, v25, v64
    v_fma_f32 v33, -v57, v82, v33
    v_mul_f32 v57, v57, v64
    v_fmac_f32 v57, v25, v82
    v_mul_f32 v32, 0x3cd80000, v3
    v_cos_f32 v64, v32
    v_sin_f32 v82, v32
    s_nop 0
    v_mul_f32 v25, v41, v64
    v_fma_f32 v25, -v73, v82, v25
    v_mul_f32 v73, v73, v64
    v_fmac_f32 v73, v41, v82
    v_mul_f32 v32, 0x3ce00000, v3
    v_cos_f32 v64, v32
    v_sin_f32 v82, v32
    s_nop 0
    v_mul_f32 v41, v21, v64
    v_fma_f32 v41, -v53, v82, v41
    v_mul_f32 v53, v53, v64
    v_fmac_f32 v53, v21, v82
    v_mul_f32 v32, 0x3ce80000, v3
    v_cos_f32 v64, v32
    v_sin_f32 v82, v32
    s_nop 0
    v_mul_f32 v21, v37, v64
    v_fma_f32 v21, -v69, v82, v21
    v_mul_f32 v69, v69, v64
    v_fmac_f32 v69, v37, v82
    v_mul_f32 v32, 0x3cf00000, v3
    v_cos_f32 v64, v32
    v_sin_f32 v82, v32
    s_nop 0
    v_mul_f32 v37, v29, v64
    v_fma_f32 v37, -v61, v82, v37
    v_mul_f32 v61, v61, v64
    v_fmac_f32 v61, v29, v82
    v_mul_f32 v32, 0x3cf80000, v3
    v_cos_f32 v64, v32
    v_sin_f32 v82, v32
    s_nop 0
    v_mul_f32 v29, v45, v64
    v_fma_f32 v29, -v77, v82, v29
    v_mul_f32 v77, v77, v64
    v_fmac_f32 v77, v45, v82
    ds_write_b32 v4, v16 offset:0
    ds_write_b32 v4, v48 offset:4
    ds_write_b32 v4, v83 offset:264
    ds_write_b32 v4, v81 offset:268
    ds_write_b32 v4, v80 offset:528
    ds_write_b32 v4, v72 offset:532
    ds_write_b32 v4, v40 offset:792
    ds_write_b32 v4, v60 offset:796
    ds_write_b32 v4, v28 offset:1056
    ds_write_b32 v4, v76 offset:1060
    ds_write_b32 v4, v44 offset:1320
    ds_write_b32 v4, v62 offset:1324
    ds_write_b32 v4, v30 offset:1584
    ds_write_b32 v4, v54 offset:1588
    ds_write_b32 v4, v22 offset:1848
    ds_write_b32 v4, v70 offset:1852
    ds_write_b32 v4, v38 offset:2112
    ds_write_b32 v4, v78 offset:2116
    ds_write_b32 v4, v46 offset:2376
    ds_write_b32 v4, v63 offset:2380
    ds_write_b32 v4, v31 offset:2640
    ds_write_b32 v4, v55 offset:2644
    ds_write_b32 v4, v23 offset:2904
    ds_write_b32 v4, v71 offset:2908
    ds_write_b32 v4, v39 offset:3168
    ds_write_b32 v4, v51 offset:3172
    ds_write_b32 v4, v19 offset:3432
    ds_write_b32 v4, v67 offset:3436
    ds_write_b32 v4, v35 offset:3696
    ds_write_b32 v4, v59 offset:3700
    ds_write_b32 v4, v27 offset:3960
    ds_write_b32 v4, v75 offset:3964
    ds_write_b32 v4, v43 offset:4224
    ds_write_b32 v4, v79 offset:4228
    ds_write_b32 v4, v47 offset:4488
    ds_write_b32 v4, v56 offset:4492
    ds_write_b32 v4, v24 offset:4752
    ds_write_b32 v4, v52 offset:4756
    ds_write_b32 v4, v20 offset:5016
    ds_write_b32 v4, v68 offset:5020
    ds_write_b32 v4, v36 offset:5280
    ds_write_b32 v4, v50 offset:5284
    ds_write_b32 v4, v18 offset:5544
    ds_write_b32 v4, v66 offset:5548
    ds_write_b32 v4, v34 offset:5808
    ds_write_b32 v4, v58 offset:5812
    ds_write_b32 v4, v26 offset:6072
    ds_write_b32 v4, v74 offset:6076
    ds_write_b32 v4, v42 offset:6336
    ds_write_b32 v4, v49 offset:6340
    ds_write_b32 v4, v17 offset:6600
    ds_write_b32 v4, v65 offset:6604
    ds_write_b32 v4, v33 offset:6864
    ds_write_b32 v4, v57 offset:6868
    ds_write_b32 v4, v25 offset:7128
    ds_write_b32 v4, v73 offset:7132
    ds_write_b32 v4, v41 offset:7392
    ds_write_b32 v4, v53 offset:7396
    ds_write_b32 v4, v21 offset:7656
    ds_write_b32 v4, v69 offset:7660
    ds_write_b32 v4, v37 offset:7920
    ds_write_b32 v4, v61 offset:7924
    ds_write_b32 v4, v29 offset:8184
    ds_write_b32 v4, v77 offset:8188
    s_waitcnt lgkmcnt(0)
    ds_read_b32 v16, v5 offset:0
    ds_read_b32 v48, v5 offset:4
    ds_read_b32 v83, v5 offset:8
    ds_read_b32 v81, v5 offset:12
    ds_read_b32 v80, v5 offset:16
    ds_read_b32 v72, v5 offset:20
    ds_read_b32 v40, v5 offset:24
    ds_read_b32 v60, v5 offset:28
    ds_read_b32 v28, v5 offset:32
    ds_read_b32 v76, v5 offset:36
    ds_read_b32 v44, v5 offset:40
    ds_read_b32 v62, v5 offset:44
    ds_read_b32 v30, v5 offset:48
    ds_read_b32 v54, v5 offset:52
    s_waitcnt lgkmcnt(0)
    ds_read_b32 v22, v5 offset:56
    ds_read_b32 v70, v5 offset:60
    ds_read_b32 v38, v5 offset:64
    ds_read_b32 v78, v5 offset:68
    ds_read_b32 v46, v5 offset:72
    ds_read_b32 v63, v5 offset:76
    ds_read_b32 v31, v5 offset:80
    ds_read_b32 v55, v5 offset:84
    ds_read_b32 v23, v5 offset:88
    ds_read_b32 v71, v5 offset:92
    ds_read_b32 v39, v5 offset:96
    ds_read_b32 v51, v5 offset:100
    ds_read_b32 v19, v5 offset:104
    ds_read_b32 v67, v5 offset:108
    s_waitcnt lgkmcnt(0)
    ds_read_b32 v35, v5 offset:112
    ds_read_b32 v59, v5 offset:116
    ds_read_b32 v27, v5 offset:120
    ds_read_b32 v75, v5 offset:124
    ds_read_b32 v43, v5 offset:128
    ds_read_b32 v79, v5 offset:132
    ds_read_b32 v47, v5 offset:136
    ds_read_b32 v56, v5 offset:140
    ds_read_b32 v24, v5 offset:144
    ds_read_b32 v52, v5 offset:148
    ds_read_b32 v20, v5 offset:152
    ds_read_b32 v68, v5 offset:156
    ds_read_b32 v36, v5 offset:160
    ds_read_b32 v50, v5 offset:164
    s_waitcnt lgkmcnt(0)
    ds_read_b32 v18, v5 offset:168
    ds_read_b32 v66, v5 offset:172
    ds_read_b32 v34, v5 offset:176
    ds_read_b32 v58, v5 offset:180
    ds_read_b32 v26, v5 offset:184
    ds_read_b32 v74, v5 offset:188
    ds_read_b32 v42, v5 offset:192
    ds_read_b32 v49, v5 offset:196
    ds_read_b32 v17, v5 offset:200
    ds_read_b32 v65, v5 offset:204
    ds_read_b32 v33, v5 offset:208
    ds_read_b32 v57, v5 offset:212
    ds_read_b32 v25, v5 offset:216
    ds_read_b32 v73, v5 offset:220
    s_waitcnt lgkmcnt(0)
    ds_read_b32 v41, v5 offset:224
    ds_read_b32 v53, v5 offset:228
    ds_read_b32 v21, v5 offset:232
    ds_read_b32 v69, v5 offset:236
    ds_read_b32 v37, v5 offset:240
    ds_read_b32 v61, v5 offset:244
    ds_read_b32 v29, v5 offset:248
    ds_read_b32 v77, v5 offset:252
    s_waitcnt lgkmcnt(0)
    v_sub_f32 v32, v16, v43
    v_sub_f32 v64, v48, v79
    v_add_f32 v16, v16, v43
    v_add_f32 v48, v48, v79
    v_sub_f32 v43, v83, v47
    v_sub_f32 v79, v81, v56
    v_add_f32 v83, v83, v47
    v_add_f32 v81, v81, v56
    v_mul_f32 v47, 0x3f7b14be, v43
    v_mul_f32 v56, 0x3e47c5c2, v43
    v_fmac_f32 v47, 0xbe47c5c2, v79
    v_fmac_f32 v56, 0x3f7b14be, v79
    v_sub_f32 v43, v80, v24
    v_sub_f32 v79, v72, v52
    v_add_f32 v80, v80, v24
    v_add_f32 v72, v72, v52
    v_mul_f32 v24, 0x3f6c835e, v43
    v_mul_f32 v52, 0x3ec3ef15, v43
    v_fmac_f32 v24, 0xbec3ef15, v79
    v_fmac_f32 v52, 0x3f6c835e, v79
    v_sub_f32 v43, v40, v20
    v_sub_f32 v79, v60, v68
    v_add_f32 v40, v40, v20
    v_add_f32 v60, v60, v68
    v_mul_f32 v20, 0x3f54db31, v43
    v_mul_f32 v68, 0x3f0e39da, v43
    v_fmac_f32 v20, 0xbf0e39da, v79
    v_fmac_f32 v68, 0x3f54db31, v79
    v_sub_f32 v43, v28, v36
    v_sub_f32 v79, v76, v50
    v_add_f32 v28, v28, v36
    v_add_f32 v76, v76, v50
    v_mul_f32 v36, 0x3f3504f3, v43
    v_mul_f32 v50, 0x3f3504f3, v43
    v_fmac_f32 v36, 0xbf3504f3, v79
    v_fmac_f32 v50, 0x3f3504f3, v79
    v_sub_f32 v43, v44, v18
    v_sub_f32 v79, v62, v66
    v_add_f32 v44, v44, v18
    v_add_f32 v62, v62, v66
    v_mul_f32 v18, 0x3f0e39da, v43
    v_mul_f32 v66, 0x3f54db31, v43
    v_fmac_f32 v18, 0xbf54db31, v79
    v_fmac_f32 v66, 0x3f0e39da, v79
    v_sub_f32 v43, v30, v34
    v_sub_f32 v79, v54, v58
    v_add_f32 v30, v30, v34
    v_add_f32 v54, v54, v58
    v_mul_f32 v34, 0x3ec3ef15, v43
    v_mul_f32 v58, 0x3f6c835e, v43
    v_fmac_f32 v34, 0xbf6c835e, v79
    v_fmac_f32 v58, 0x3ec3ef15, v79
    v_sub_f32 v43, v22, v26
    v_sub_f32 v79, v70, v74
    v_add_f32 v22, v22, v26
    v_add_f32 v70, v70, v74
    v_mul_f32 v26, 0x3e47c5c2, v43
    v_mul_f32 v74, 0x3f7b14be, v43
    v_fmac_f32 v26, 0xbf7b14be, v79
    v_fmac_f32 v74, 0x3e47c5c2, v79
    v_sub_f32 v43, v49, v78
    v_sub_f32 v79, v38, v42
    v_add_f32 v38, v38, v42
    v_add_f32 v78, v78, v49
    v_sub_f32 v42, v46, v17
    v_sub_f32 v49, v63, v65
    v_add_f32 v46, v46, v17
    v_add_f32 v63, v63, v65
    v_mul_f32 v17, 0xbe47c5c2, v42
    v_mul_f32 v65, 0x3f7b14be, v42
    v_fmac_f32 v17, 0xbf7b14be, v49
    v_fmac_f32 v65, 0xbe47c5c2, v49
    v_sub_f32 v42, v31, v33
    v_sub_f32 v49, v55, v57
    v_add_f32 v31, v31, v33
    v_add_f32 v55, v55, v57
    v_mul_f32 v33, 0xbec3ef15, v42
    v_mul_f32 v57, 0x3f6c835e, v42
    v_fmac_f32 v33, 0xbf6c835e, v49
    v_fmac_f32 v57, 0xbec3ef15, v49
    v_sub_f32 v42, v23, v25
    v_sub_f32 v49, v71, v73
    v_add_f32 v23, v23, v25
    v_add_f32 v71, v71, v73
    v_mul_f32 v25, 0xbf0e39da, v42
    v_mul_f32 v73, 0x3f54db31, v42
    v_fmac_f32 v25, 0xbf54db31, v49
    v_fmac_f32 v73, 0xbf0e39da, v49
    v_sub_f32 v42, v39, v41
    v_sub_f32 v49, v51, v53
    v_add_f32 v39, v39, v41
    v_add_f32 v51, v51, v53
    v_mul_f32 v41, 0xbf3504f3, v42
    v_mul_f32 v53, 0x3f3504f3, v42
    v_fmac_f32 v41, 0xbf3504f3, v49
    v_fmac_f32 v53, 0xbf3504f3, v49
    v_sub_f32 v42, v19, v21
    v_sub_f32 v49, v67, v69
    v_add_f32 v19, v19, v21
    v_add_f32 v67, v67, v69
    v_mul_f32 v21, 0xbf54db31, v42
    v_mul_f32 v69, 0x3f0e39da, v42
    v_fmac_f32 v21, 0xbf0e39da, v49
    v_fmac_f32 v69, 0xbf54db31, v49
    v_sub_f32 v42, v35, v37
    v_sub_f32 v49, v59, v61
    v_add_f32 v35, v35, v37
    v_add_f32 v59, v59, v61
    v_mul_f32 v37, 0xbf6c835e, v42
    v_mul_f32 v61, 0x3ec3ef15, v42
    v_fmac_f32 v37, 0xbec3ef15, v49
    v_fmac_f32 v61, 0xbf6c835e, v49
    v_sub_f32 v42, v27, v29
    v_sub_f32 v49, v75, v77
    v_add_f32 v27, v27, v29
    v_add_f32 v75, v75, v77
    v_mul_f32 v29, 0xbf7b14be, v42
    v_mul_f32 v77, 0x3e47c5c2, v42
    v_fmac_f32 v29, 0xbe47c5c2, v49
    v_fmac_f32 v77, 0xbf7b14be, v49
    v_sub_f32 v42, v16, v38
    v_sub_f32 v49, v48, v78
    v_add_f32 v16, v16, v38
    v_add_f32 v48, v48, v78
    v_sub_f32 v38, v83, v46
    v_sub_f32 v78, v81, v63
    v_add_f32 v83, v83, v46
    v_add_f32 v81, v81, v63
    v_mul_f32 v46, 0x3f6c835e, v38
    v_mul_f32 v63, 0x3ec3ef15, v38
    v_fmac_f32 v46, 0xbec3ef15, v78
    v_fmac_f32 v63, 0x3f6c835e, v78
    v_sub_f32 v38, v80, v31
    v_sub_f32 v78, v72, v55
    v_add_f32 v80, v80, v31
    v_add_f32 v72, v72, v55
    v_mul_f32 v31, 0x3f3504f3, v38
    v_mul_f32 v55, 0x3f3504f3, v38
    v_fmac_f32 v31, 0xbf3504f3, v78
    v_fmac_f32 v55, 0x3f3504f3, v78
    v_sub_f32 v38, v40, v23
    v_sub_f32 v78, v60, v71
    v_add_f32 v40, v40, v23
    v_add_f32 v60, v60, v71
    v_mul_f32 v23, 0x3ec3ef15, v38
    v_mul_f32 v71, 0x3f6c835e, v38
    v_fmac_f32 v23, 0xbf6c835e, v78
    v_fmac_f32 v71, 0x3ec3ef15, v78
    v_sub_f32 v38, v51, v76
    v_sub_f32 v78, v28, v39
    v_add_f32 v28, v28, v39
    v_add_f32 v76, v76, v51
    v_sub_f32 v39, v44, v19
    v_sub_f32 v51, v62, v67
    v_add_f32 v44, v44, v19
    v_add_f32 v62, v62, v67
    v_mul_f32 v19, 0xbec3ef15, v39
    v_mul_f32 v67, 0x3f6c835e, v39
    v_fmac_f32 v19, 0xbf6c835e, v51
    v_fmac_f32 v67, 0xbec3ef15, v51
    v_sub_f32 v39, v30, v35
    v_sub_f32 v51, v54, v59
    v_add_f32 v30, v30, v35
    v_add_f32 v54, v54, v59
    v_mul_f32 v35, 0xbf3504f3, v39
    v_mul_f32 v59, 0x3f3504f3, v39
    v_fmac_f32 v35, 0xbf3504f3, v51
    v_fmac_f32 v59, 0xbf3504f3, v51
    v_sub_f32 v39, v22, v27
    v_sub_f32 v51, v70, v75
    v_add_f32 v22, v22, v27
    v_add_f32 v70, v70, v75
    v_mul_f32 v27, 0xbf6c835e, v39
    v_mul_f32 v75, 0x3ec3ef15, v39
    v_fmac_f32 v27, 0xbec3ef15, v51
    v_fmac_f32 v75, 0xbf6c835e, v51
    v_sub_f32 v39, v32, v43
    v_sub_f32 v51, v64, v79
    v_add_f32 v32, v32, v43
    v_add_f32 v64, v64, v79
    v_sub_f32 v43, v47, v17
    v_sub_f32 v79, v56, v65
    v_add_f32 v47, v47, v17
    v_add_f32 v56, v56, v65
    v_mul_f32 v17, 0x3f6c835e, v43
    v_mul_f32 v65, 0x3ec3ef15, v43
    v_fmac_f32 v17, 0xbec3ef15, v79
    v_fmac_f32 v65, 0x3f6c835e, v79
    v_sub_f32 v43, v24, v33
    v_sub_f32 v79, v52, v57
    v_add_f32 v24, v24, v33
    v_add_f32 v52, v52, v57
    v_mul_f32 v33, 0x3f3504f3, v43
    v_mul_f32 v57, 0x3f3504f3, v43
    v_fmac_f32 v33, 0xbf3504f3, v79
    v_fmac_f32 v57, 0x3f3504f3, v79
    v_sub_f32 v43, v20, v25
    v_sub_f32 v79, v68, v73
    v_add_f32 v20, v20, v25
    v_add_f32 v68, v68, v73
    v_mul_f32 v25, 0x3ec3ef15, v43
    v_mul_f32 v73, 0x3f6c835e, v43
    v_fmac_f32 v25, 0xbf6c835e, v79
    v_fmac_f32 v73, 0x3ec3ef15, v79
    v_sub_f32 v43, v53, v50
    v_sub_f32 v79, v36, v41
    v_add_f32 v36, v36, v41
    v_add_f32 v50, v50, v53
    v_sub_f32 v41, v18, v21
    v_sub_f32 v53, v66, v69
    v_add_f32 v18, v18, v21
    v_add_f32 v66, v66, v69
    v_mul_f32 v21, 0xbec3ef15, v41
    v_mul_f32 v69, 0x3f6c835e, v41
    v_fmac_f32 v21, 0xbf6c835e, v53
    v_fmac_f32 v69, 0xbec3ef15, v53
    v_sub_f32 v41, v34, v37
    v_sub_f32 v53, v58, v61
    v_add_f32 v34, v34, v37
    v_add_f32 v58, v58, v61
    v_mul_f32 v37, 0xbf3504f3, v41
    v_mul_f32 v61, 0x3f3504f3, v41
    v_fmac_f32 v37, 0xbf3504f3, v53
    v_fmac_f32 v61, 0xbf3504f3, v53
    v_sub_f32 v41, v26, v29
    v_sub_f32 v53, v74, v77
    v_add_f32 v26, v26, v29
    v_add_f32 v74, v74, v77
    v_mul_f32 v29, 0xbf6c835e, v41
    v_mul_f32 v77, 0x3ec3ef15, v41
    v_fmac_f32 v29, 0xbec3ef15, v53
    v_fmac_f32 v77, 0xbf6c835e, v53
    v_sub_f32 v41, v16, v28
    v_sub_f32 v53, v48, v76
    v_add_f32 v16, v16, v28
    v_add_f32 v48, v48, v76
    v_sub_f32 v28, v83, v44
    v_sub_f32 v76, v81, v62
    v_add_f32 v83, v83, v44
    v_add_f32 v81, v81, v62
    v_mul_f32 v44, 0x3f3504f3, v28
    v_mul_f32 v62, 0x3f3504f3, v28
    v_fmac_f32 v44, 0xbf3504f3, v76
    v_fmac_f32 v62, 0x3f3504f3, v76
    v_sub_f32 v28, v54, v72
    v_sub_f32 v76, v80, v30
    v_add_f32 v80, v80, v30
    v_add_f32 v72, v72, v54
    v_sub_f32 v30, v40, v22
    v_sub_f32 v54, v60, v70
    v_add_f32 v40, v40, v22
    v_add_f32 v60, v60, v70
    v_mul_f32 v22, 0xbf3504f3, v30
    v_mul_f32 v70, 0x3f3504f3, v30
    v_fmac_f32 v22, 0xbf3504f3, v54
    v_fmac_f32 v70, 0xbf3504f3, v54
    v_sub_f32 v30, v42, v38
    v_sub_f32 v54, v49, v78
    v_add_f32 v42, v42, v38
    v_add_f32 v49, v49, v78
    v_sub_f32 v38, v46, v19
    v_sub_f32 v78, v63, v67
    v_add_f32 v46, v46, v19
    v_add_f32 v63, v63, v67
    v_mul_f32 v19, 0x3f3504f3, v38
    v_mul_f32 v67, 0x3f3504f3, v38
    v_fmac_f32 v19, 0xbf3504f3, v78
    v_fmac_f32 v67, 0x3f3504f3, v78
    v_sub_f32 v38, v59, v55
    v_sub_f32 v78, v31, v35
    v_add_f32 v31, v31, v35
    v_add_f32 v55, v55, v59
    v_sub_f32 v35, v23, v27
    v_sub_f32 v59, v71, v75
    v_add_f32 v23, v23, v27
    v_add_f32 v71, v71, v75
    v_mul_f32 v27, 0xbf3504f3, v35
    v_mul_f32 v75, 0x3f3504f3, v35
    v_fmac_f32 v27, 0xbf3504f3, v59
    v_fmac_f32 v75, 0xbf3504f3, v59
    v_sub_f32 v35, v32, v36
    v_sub_f32 v59, v64, v50
    v_add_f32 v32, v32, v36
    v_add_f32 v64, v64, v50
    v_sub_f32 v36, v47, v18
    v_sub_f32 v50, v56, v66
    v_add_f32 v47, v47, v18
    v_add_f32 v56, v56, v66
    v_mul_f32 v18, 0x3f3504f3, v36
    v_mul_f32 v66, 0x3f3504f3, v36
    v_fmac_f32 v18, 0xbf3504f3, v50
    v_fmac_f32 v66, 0x3f3504f3, v50
    v_sub_f32 v36, v58, v52
    v_sub_f32 v50, v24, v34
    v_add_f32 v24, v24, v34
    v_add_f32 v52, v52, v58
    v_sub_f32 v34, v20, v26
    v_sub_f32 v58, v68, v74
    v_add_f32 v20, v20, v26
    v_add_f32 v68, v68, v74
    v_mul_f32 v26, 0xbf3504f3, v34
    v_mul_f32 v74, 0x3f3504f3, v34
    v_fmac_f32 v26, 0xbf3504f3, v58
    v_fmac_f32 v74, 0xbf3504f3, v58
    v_sub_f32 v34, v39, v43
    v_sub_f32 v58, v51, v79
    v_add_f32 v39, v39, v43
    v_add_f32 v51, v51, v79
    v_sub_f32 v43, v17, v21
    v_sub_f32 v79, v65, v69
    v_add_f32 v17, v17, v21
    v_add_f32 v65, v65, v69
    v_mul_f32 v21, 0x3f3504f3, v43
    v_mul_f32 v69, 0x3f3504f3, v43
    v_fmac_f32 v21, 0xbf3504f3, v79
    v_fmac_f32 v69, 0x3f3504f3, v79
    v_sub_f32 v43, v61, v57
    v_sub_f32 v79, v33, v37
    v_add_f32 v33, v33, v37
    v_add_f32 v57, v57, v61
    v_sub_f32 v37, v25, v29
    v_sub_f32 v61, v73, v77
    v_add_f32 v25, v25, v29
    v_add_f32 v73, v73, v77
    v_mul_f32 v29, 0xbf3504f3, v37
    v_mul_f32 v77, 0x3f3504f3, v37
    v_fmac_f32 v29, 0xbf3504f3, v61
    v_fmac_f32 v77, 0xbf3504f3, v61
    v_sub_f32 v37, v16, v80
    v_sub_f32 v61, v48, v72
    v_add_f32 v16, v16, v80
    v_add_f32 v48, v48, v72
    v_sub_f32 v80, v60, v81
    v_sub_f32 v72, v83, v40
    v_add_f32 v83, v83, v40
    v_add_f32 v81, v81, v60
    v_sub_f32 v40, v41, v28
    v_sub_f32 v60, v53, v76
    v_add_f32 v41, v41, v28
    v_add_f32 v53, v53, v76
    v_sub_f32 v28, v70, v62
    v_sub_f32 v76, v44, v22
    v_add_f32 v44, v44, v22
    v_add_f32 v62, v62, v70
    v_sub_f32 v22, v42, v31
    v_sub_f32 v70, v49, v55
    v_add_f32 v42, v42, v31
    v_add_f32 v49, v49, v55
    v_sub_f32 v31, v71, v63
    v_sub_f32 v55, v46, v23
    v_add_f32 v46, v46, v23
    v_add_f32 v63, v63, v71
    v_sub_f32 v23, v30, v38
    v_sub_f32 v71, v54, v78
    v_add_f32 v30, v30, v38
    v_add_f32 v54, v54, v78
    v_sub_f32 v38, v75, v67
    v_sub_f32 v78, v19, v27
    v_add_f32 v19, v19, v27
    v_add_f32 v67, v67, v75
    v_sub_f32 v27, v32, v24
    v_sub_f32 v75, v64, v52
    v_add_f32 v32, v32, v24
    v_add_f32 v64, v64, v52
    v_sub_f32 v24, v68, v56
    v_sub_f32 v52, v47, v20
    v_add_f32 v47, v47, v20
    v_add_f32 v56, v56, v68
    v_sub_f32 v20, v35, v36
    v_sub_f32 v68, v59, v50
    v_add_f32 v35, v35, v36
    v_add_f32 v59, v59, v50
    v_sub_f32 v36, v74, v66
    v_sub_f32 v50, v18, v26
    v_add_f32 v18, v18, v26
    v_add_f32 v66, v66, v74
    v_sub_f32 v26, v39, v33
    v_sub_f32 v74, v51, v57
    v_add_f32 v39, v39, v33
    v_add_f32 v51, v51, v57
    v_sub_f32 v33, v73, v65
    v_sub_f32 v57, v17, v25
    v_add_f32 v17, v17, v25
    v_add_f32 v65, v65, v73
    v_sub_f32 v25, v34, v43
    v_sub_f32 v73, v58, v79
    v_add_f32 v34, v34, v43
    v_add_f32 v58, v58, v79
    v_sub_f32 v43, v77, v69
    v_sub_f32 v79, v21, v29
    v_add_f32 v21, v21, v29
    v_add_f32 v69, v69, v77
    v_sub_f32 v29, v16, v83
    v_sub_f32 v77, v48, v81
    v_add_f32 v16, v16, v83
    v_add_f32 v48, v48, v81
    v_sub_f32 v83, v37, v80
    v_sub_f32 v81, v61, v72
    v_add_f32 v37, v37, v80
    v_add_f32 v61, v61, v72
    v_sub_f32 v80, v41, v44
    v_sub_f32 v72, v53, v62
    v_add_f32 v41, v41, v44
    v_add_f32 v53, v53, v62
    v_sub_f32 v44, v40, v28
    v_sub_f32 v62, v60, v76
    v_add_f32 v40, v40, v28
    v_add_f32 v60, v60, v76
    v_sub_f32 v28, v42, v46
    v_sub_f32 v76, v49, v63
    v_add_f32 v42, v42, v46
    v_add_f32 v49, v49, v63
    v_sub_f32 v46, v22, v31
    v_sub_f32 v63, v70, v55
    v_add_f32 v22, v22, v31
    v_add_f32 v70, v70, v55
    v_sub_f32 v31, v30, v19
    v_sub_f32 v55, v54, v67
    v_add_f32 v30, v30, v19
    v_add_f32 v54, v54, v67
    v_sub_f32 v19, v23, v38
    v_sub_f32 v67, v71, v78
    v_add_f32 v23, v23, v38
    v_add_f32 v71, v71, v78
    v_sub_f32 v38, v32, v47
    v_sub_f32 v78, v64, v56
    v_add_f32 v32, v32, v47
    v_add_f32 v64, v64, v56
    v_sub_f32 v47, v27, v24
    v_sub_f32 v56, v75, v52
    v_add_f32 v27, v27, v24
    v_add_f32 v75, v75, v52
    v_sub_f32 v24, v35, v18
    v_sub_f32 v52, v59, v66
    v_add_f32 v35, v35, v18
    v_add_f32 v59, v59, v66
    v_sub_f32 v18, v20, v36
    v_sub_f32 v66, v68, v50
    v_add_f32 v20, v20, v36
    v_add_f32 v68, v68, v50
    v_sub_f32 v36, v39, v17
    v_sub_f32 v50, v51, v65
    v_add_f32 v39, v39, v17
    v_add_f32 v51, v51, v65
    v_sub_f32 v17, v26, v33
    v_sub_f32 v65, v74, v57
    v_add_f32 v26, v26, v33
    v_add_f32 v74, v74, v57
    v_sub_f32 v33, v34, v21
    v_sub_f32 v57, v58, v69
    v_add_f32 v34, v34, v21
    v_add_f32 v58, v58, v69
    v_sub_f32 v21, v25, v43
    v_sub_f32 v69, v73, v79
    v_add_f32 v25, v25, v43
    v_add_f32 v73, v73, v79
    v_lshl_add_u32 v6, v1, 2, v7
    ds_write_b32 v6, v16 offset:0
    ds_write_b32 v6, v48 offset:4096
    ds_write_b32 v6, v32 offset:128
    ds_write_b32 v6, v64 offset:4224
    ds_write_b32 v6, v42 offset:256
    ds_write_b32 v6, v49 offset:4352
    ds_write_b32 v6, v39 offset:384
    ds_write_b32 v6, v51 offset:4480
    ds_write_b32 v6, v41 offset:512
    ds_write_b32 v6, v53 offset:4608
    ds_write_b32 v6, v35 offset:640
    ds_write_b32 v6, v59 offset:4736
    ds_write_b32 v6, v30 offset:768
    ds_write_b32 v6, v54 offset:4864
    ds_write_b32 v6, v34 offset:896
    ds_write_b32 v6, v58 offset:4992
    ds_write_b32 v6, v37 offset:1024
    ds_write_b32 v6, v61 offset:5120
    ds_write_b32 v6, v27 offset:1152
    ds_write_b32 v6, v75 offset:5248
    ds_write_b32 v6, v22 offset:1280
    ds_write_b32 v6, v70 offset:5376
    ds_write_b32 v6, v26 offset:1408
    ds_write_b32 v6, v74 offset:5504
    ds_write_b32 v6, v40 offset:1536
    ds_write_b32 v6, v60 offset:5632
    ds_write_b32 v6, v20 offset:1664
    ds_write_b32 v6, v68 offset:5760
    ds_write_b32 v6, v23 offset:1792
    ds_write_b32 v6, v71 offset:5888
    ds_write_b32 v6, v25 offset:1920
    ds_write_b32 v6, v73 offset:6016
    ds_write_b32 v6, v29 offset:2048
    ds_write_b32 v6, v77 offset:6144
    ds_write_b32 v6, v38 offset:2176
    ds_write_b32 v6, v78 offset:6272
    ds_write_b32 v6, v28 offset:2304
    ds_write_b32 v6, v76 offset:6400
    ds_write_b32 v6, v36 offset:2432
    ds_write_b32 v6, v50 offset:6528
    ds_write_b32 v6, v80 offset:2560
    ds_write_b32 v6, v72 offset:6656
    ds_write_b32 v6, v24 offset:2688
    ds_write_b32 v6, v52 offset:6784
    ds_write_b32 v6, v31 offset:2816
    ds_write_b32 v6, v55 offset:6912
    ds_write_b32 v6, v33 offset:2944
    ds_write_b32 v6, v57 offset:7040
    ds_write_b32 v6, v83 offset:3072
    ds_write_b32 v6, v81 offset:7168
    ds_write_b32 v6, v47 offset:3200
    ds_write_b32 v6, v56 offset:7296
    ds_write_b32 v6, v46 offset:3328
    ds_write_b32 v6, v63 offset:7424
    ds_write_b32 v6, v17 offset:3456
    ds_write_b32 v6, v65 offset:7552
    ds_write_b32 v6, v44 offset:3584
    ds_write_b32 v6, v62 offset:7680
    ds_write_b32 v6, v18 offset:3712
    ds_write_b32 v6, v66 offset:7808
    ds_write_b32 v6, v19 offset:3840
    ds_write_b32 v6, v67 offset:7936
    ds_write_b32 v6, v21 offset:3968
    ds_write_b32 v6, v69 offset:8064
    s_waitcnt lgkmcnt(0)
    s_barrier
    v_and_b32 v6, 127, v0
    v_lshrrev_b32 v7, 7, v0
    v_lshlrev_b32 v8, 5, v6
    v_lshl_add_u32 v8, v7, 12, v8
    v_lshlrev_b32 v5, 4, v6
    v_lshl_add_u32 v5, v7, 12, v5
    v_add_u32 v5, 2048, v5
    s_lshl_b32 s12, s92, 16
    ds_read_b128 v[16:19], v8 offset:0
    ds_read_b128 v[20:23], v8 offset:16
    s_waitcnt lgkmcnt(0)
    v_cvt_pk_bf16_f32 v24, v16, v17
    v_cvt_pk_bf16_f32 v25, v18, v19
    v_cvt_pk_bf16_f32 v26, v20, v21
    v_cvt_pk_bf16_f32 v27, v22, v23
    s_add_u32 s13, s12, 0
    buffer_store_dwordx4 v[24:27], v5, s[4:7], s13 offen
    s_nop 1
    ds_read_b128 v[16:19], v8 offset:8448
    ds_read_b128 v[20:23], v8 offset:8464
    s_waitcnt lgkmcnt(0)
    v_cvt_pk_bf16_f32 v24, v16, v17
    v_cvt_pk_bf16_f32 v25, v18, v19
    v_cvt_pk_bf16_f32 v26, v20, v21
    v_cvt_pk_bf16_f32 v27, v22, v23
    s_add_u32 s13, s12, 8192
    buffer_store_dwordx4 v[24:27], v5, s[4:7], s13 offen
    s_nop 1
    ds_read_b128 v[16:19], v8 offset:16896
    ds_read_b128 v[20:23], v8 offset:16912
    s_waitcnt lgkmcnt(0)
    v_cvt_pk_bf16_f32 v24, v16, v17
    v_cvt_pk_bf16_f32 v25, v18, v19
    v_cvt_pk_bf16_f32 v26, v20, v21
    v_cvt_pk_bf16_f32 v27, v22, v23
    s_add_u32 s13, s12, 16384
    buffer_store_dwordx4 v[24:27], v5, s[4:7], s13 offen
    s_nop 1
    ds_read_b128 v[16:19], v8 offset:25344
    ds_read_b128 v[20:23], v8 offset:25360
    s_waitcnt lgkmcnt(0)
    v_cvt_pk_bf16_f32 v24, v16, v17
    v_cvt_pk_bf16_f32 v25, v18, v19
    v_cvt_pk_bf16_f32 v26, v20, v21
    v_cvt_pk_bf16_f32 v27, v22, v23
    s_add_u32 s13, s12, 24576
    buffer_store_dwordx4 v[24:27], v5, s[4:7], s13 offen
    s_nop 1
    ds_read_b128 v[16:19], v8 offset:33792
    ds_read_b128 v[20:23], v8 offset:33808
    s_waitcnt lgkmcnt(0)
    v_cvt_pk_bf16_f32 v24, v16, v17
    v_cvt_pk_bf16_f32 v25, v18, v19
    v_cvt_pk_bf16_f32 v26, v20, v21
    v_cvt_pk_bf16_f32 v27, v22, v23
    s_add_u32 s13, s12, 32768
    buffer_store_dwordx4 v[24:27], v5, s[4:7], s13 offen
    s_nop 1
    ds_read_b128 v[16:19], v8 offset:42240
    ds_read_b128 v[20:23], v8 offset:42256
    s_waitcnt lgkmcnt(0)
    v_cvt_pk_bf16_f32 v24, v16, v17
    v_cvt_pk_bf16_f32 v25, v18, v19
    v_cvt_pk_bf16_f32 v26, v20, v21
    v_cvt_pk_bf16_f32 v27, v22, v23
    s_add_u32 s13, s12, 40960
    buffer_store_dwordx4 v[24:27], v5, s[4:7], s13 offen
    s_nop 1
    ds_read_b128 v[16:19], v8 offset:50688
    ds_read_b128 v[20:23], v8 offset:50704
    s_waitcnt lgkmcnt(0)
    v_cvt_pk_bf16_f32 v24, v16, v17
    v_cvt_pk_bf16_f32 v25, v18, v19
    v_cvt_pk_bf16_f32 v26, v20, v21
    v_cvt_pk_bf16_f32 v27, v22, v23
    s_add_u32 s13, s12, 49152
    buffer_store_dwordx4 v[24:27], v5, s[4:7], s13 offen
    s_nop 1
    ds_read_b128 v[16:19], v8 offset:59136
    ds_read_b128 v[20:23], v8 offset:59152
    s_waitcnt lgkmcnt(0)
    v_cvt_pk_bf16_f32 v24, v16, v17
    v_cvt_pk_bf16_f32 v25, v18, v19
    v_cvt_pk_bf16_f32 v26, v20, v21
    v_cvt_pk_bf16_f32 v27, v22, v23
    s_add_u32 s13, s12, 57344
    buffer_store_dwordx4 v[24:27], v5, s[4:7], s13 offen
    s_nop 1
    s_branch mega_kernel_xo4
mega_kernel_xo:
    s_cmp_lg_u32 s92, 128
    s_cbranch_scc1 mega_kernel_xo2
    s_cmp_lg_u32 s98, 0
    s_cbranch_scc1 mega_kernel_xo2
mega_kernel_wf1b:
    s_sleep 8
    buffer_load_dword v2, off, s[88:91], 0 offset:72 sc1
    s_waitcnt vmcnt(0)
    v_cmp_ne_u32 vcc, 192, v2
    s_cbranch_vccnz mega_kernel_wf1b
    s_mov_b32 s99, 128
    s_branch mega_kernel_f2_in
mega_kernel_f2ret:
    s_waitcnt vmcnt(0)
    v_mov_b32 v2, 1
    s_mov_b64 exec, 1
    buffer_atomic_add v2, off, s[88:91], 0 offset:136 sc1
    s_mov_b64 exec, -1
    s_branch mega_kernel_xo3
mega_kernel_xo2:
    s_waitcnt vmcnt(0)
    ds_read_b64_tr_b16 a[64:65], v201 offset:0
    ds_read_b64_tr_b16 a[66:67], v201 offset:256
    ds_read_b64_tr_b16 a[68:69], v201 offset:1024
    ds_read_b64_tr_b16 a[70:71], v201 offset:1280
    ds_read_b64_tr_b16 a[72:73], v201 offset:2048
    ds_read_b64_tr_b16 a[74:75], v201 offset:2304
    ds_read_b64_tr_b16 a[76:77], v201 offset:3072
    ds_read_b64_tr_b16 a[78:79], v201 offset:3328
    s_waitcnt lgkmcnt(0)
    ds_read_b64_tr_b16 a[80:81], v201 offset:4096
    ds_read_b64_tr_b16 a[82:83], v201 offset:4352
    ds_read_b64_tr_b16 a[84:85], v201 offset:5120
    ds_read_b64_tr_b16 a[86:87], v201 offset:5376
    ds_read_b64_tr_b16 a[88:89], v201 offset:6144
    ds_read_b64_tr_b16 a[90:91], v201 offset:6400
    ds_read_b64_tr_b16 a[92:93], v201 offset:7168
    ds_read_b64_tr_b16 a[94:95], v201 offset:7424
    s_waitcnt lgkmcnt(0)
    ds_read_b64_tr_b16 a[96:97], v201 offset:8192
    ds_read_b64_tr_b16 a[98:99], v201 offset:8448
    ds_read_b64_tr_b16 a[100:101], v201 offset:9216
    ds_read_b64_tr_b16 a[102:103], v201 offset:9472
    ds_read_b64_tr_b16 a[104:105], v201 offset:10240
    ds_read_b64_tr_b16 a[106:107], v201 offset:10496
    ds_read_b64_tr_b16 a[108:109], v201 offset:11264
    ds_read_b64_tr_b16 a[110:111], v201 offset:11520
    s_waitcnt lgkmcnt(0)
    ds_read_b64_tr_b16 a[112:113], v201 offset:12288
    ds_read_b64_tr_b16 a[114:115], v201 offset:12544
    ds_read_b64_tr_b16 a[116:117], v201 offset:13312
    ds_read_b64_tr_b16 a[118:119], v201 offset:13568
    ds_read_b64_tr_b16 a[120:121], v201 offset:14336
    ds_read_b64_tr_b16 a[122:123], v201 offset:14592
    ds_read_b64_tr_b16 a[124:125], v201 offset:15360
    ds_read_b64_tr_b16 a[126:127], v201 offset:15616
    s_waitcnt lgkmcnt(0)
    s_add_u32 m0, s56, 0
    s_add_u32 s58, s57, 32768
    s_and_b32 s58, s58, 0xffff
    s_lshl_b32 s58, s58, 5
    buffer_load_dwordx4 v200, s[52:55], s58 offen lds
    s_add_u32 m0, s56, 1024
    s_add_u32 s58, s57, 33792
    s_and_b32 s58, s58, 0xffff
    s_lshl_b32 s58, s58, 5
    buffer_load_dwordx4 v200, s[52:55], s58 offen lds
    s_add_u32 m0, s56, 2048
    s_add_u32 s58, s57, 34816
    s_and_b32 s58, s58, 0xffff
    s_lshl_b32 s58, s58, 5
    buffer_load_dwordx4 v200, s[52:55], s58 offen lds
    s_add_u32 m0, s56, 3072
    s_add_u32 s58, s57, 35840
    s_and_b32 s58, s58, 0xffff
    s_lshl_b32 s58, s58, 5
    buffer_load_dwordx4 v200, s[52:55], s58 offen lds
    s_add_u32 m0, s56, 4096
    s_add_u32 s58, s57, 36864
    s_and_b32 s58, s58, 0xffff
    s_lshl_b32 s58, s58, 5
    buffer_load_dwordx4 v200, s[52:55], s58 offen lds
    s_add_u32 m0, s56, 5120
    s_add_u32 s58, s57, 37888
    s_and_b32 s58, s58, 0xffff
    s_lshl_b32 s58, s58, 5
    buffer_load_dwordx4 v200, s[52:55], s58 offen lds
    s_add_u32 m0, s56, 6144
    s_add_u32 s58, s57, 38912
    s_and_b32 s58, s58, 0xffff
    s_lshl_b32 s58, s58, 5
    buffer_load_dwordx4 v200, s[52:55], s58 offen lds
    s_add_u32 m0, s56, 7168
    s_add_u32 s58, s57, 39936
    s_and_b32 s58, s58, 0xffff
    s_lshl_b32 s58, s58, 5
    buffer_load_dwordx4 v200, s[52:55], s58 offen lds
    s_add_u32 m0, s56, 8192
    s_add_u32 s58, s57, 40960
    s_and_b32 s58, s58, 0xffff
    s_lshl_b32 s58, s58, 5
    buffer_load_dwordx4 v200, s[52:55], s58 offen lds
    s_add_u32 m0, s56, 9216
    s_add_u32 s58, s57, 41984
    s_and_b32 s58, s58, 0xffff
    s_lshl_b32 s58, s58, 5
    buffer_load_dwordx4 v200, s[52:55], s58 offen lds
    s_add_u32 m0, s56, 10240
    s_add_u32 s58, s57, 43008
    s_and_b32 s58, s58, 0xffff
    s_lshl_b32 s58, s58, 5
    buffer_load_dwordx4 v200, s[52:55], s58 offen lds
    s_add_u32 m0, s56, 11264
    s_add_u32 s58, s57, 44032
    s_and_b32 s58, s58, 0xffff
    s_lshl_b32 s58, s58, 5
    buffer_load_dwordx4 v200, s[52:55], s58 offen lds
    s_add_u32 m0, s56, 12288
    s_add_u32 s58, s57, 45056
    s_and_b32 s58, s58, 0xffff
    s_lshl_b32 s58, s58, 5
    buffer_load_dwordx4 v200, s[52:55], s58 offen lds
    s_add_u32 m0, s56, 13312
    s_add_u32 s58, s57, 46080
    s_and_b32 s58, s58, 0xffff
    s_lshl_b32 s58, s58, 5
    buffer_load_dwordx4 v200, s[52:55], s58 offen lds
    s_add_u32 m0, s56, 14336
    s_add_u32 s58, s57, 47104
    s_and_b32 s58, s58, 0xffff
    s_lshl_b32 s58, s58, 5
    buffer_load_dwordx4 v200, s[52:55], s58 offen lds
    s_add_u32 m0, s56, 15360
    s_add_u32 s58, s57, 48128
    s_and_b32 s58, s58, 0xffff
    s_lshl_b32 s58, s58, 5
    buffer_load_dwordx4 v200, s[52:55], s58 offen lds
mega_kernel_xo3:
    s_waitcnt vmcnt(0)
    ds_read_b64_tr_b16 a[128:129], v201 offset:0
    ds_read_b64_tr_b16 a[130:131], v201 offset:256
    ds_read_b64_tr_b16 a[132:133], v201 offset:1024
    ds_read_b64_tr_b16 a[134:135], v201 offset:1280
    ds_read_b64_tr_b16 a[136:137], v201 offset:2048
    ds_read_b64_tr_b16 a[138:139], v201 offset:2304
    ds_read_b64_tr_b16 a[140:141], v201 offset:3072
    ds_read_b64_tr_b16 a[142:143], v201 offset:3328
    s_waitcnt lgkmcnt(0)
    ds_read_b64_tr_b16 a[144:145], v201 offset:4096
    ds_read_b64_tr_b16 a[146:147], v201 offset:4352
    ds_read_b64_tr_b16 a[148:149], v201 offset:5120
    ds_read_b64_tr_b16 a[150:151], v201 offset:5376
    ds_read_b64_tr_b16 a[152:153], v201 offset:6144
    ds_read_b64_tr_b16 a[154:155], v201 offset:6400
    ds_read_b64_tr_b16 a[156:157], v201 offset:7168
    ds_read_b64_tr_b16 a[158:159], v201 offset:7424
    s_waitcnt lgkmcnt(0)
    ds_read_b64_tr_b16 a[160:161], v201 offset:8192
    ds_read_b64_tr_b16 a[162:163], v201 offset:8448
    ds_read_b64_tr_b16 a[164:165], v201 offset:9216
    ds_read_b64_tr_b16 a[166:167], v201 offset:9472
    ds_read_b64_tr_b16 a[168:169], v201 offset:10240
    ds_read_b64_tr_b16 a[170:171], v201 offset:10496
    ds_read_b64_tr_b16 a[172:173], v201 offset:11264
    ds_read_b64_tr_b16 a[174:175], v201 offset:11520
    s_waitcnt lgkmcnt(0)
    ds_read_b64_tr_b16 a[176:177], v201 offset:12288
    ds_read_b64_tr_b16 a[178:179], v201 offset:12544
    ds_read_b64_tr_b16 a[180:181], v201 offset:13312
    ds_read_b64_tr_b16 a[182:183], v201 offset:13568
    ds_read_b64_tr_b16 a[184:185], v201 offset:14336
    ds_read_b64_tr_b16 a[186:187], v201 offset:14592
    ds_read_b64_tr_b16 a[188:189], v201 offset:15360
    ds_read_b64_tr_b16 a[190:191], v201 offset:15616
    s_waitcnt lgkmcnt(0)
    s_add_u32 m0, s56, 0
    s_add_u32 s58, s57, 49152
    s_and_b32 s58, s58, 0xffff
    s_lshl_b32 s58, s58, 5
    buffer_load_dwordx4 v200, s[52:55], s58 offen lds
    s_add_u32 m0, s56, 1024
    s_add_u32 s58, s57, 50176
    s_and_b32 s58, s58, 0xffff
    s_lshl_b32 s58, s58, 5
    buffer_load_dwordx4 v200, s[52:55], s58 offen lds
    s_add_u32 m0, s56, 2048
    s_add_u32 s58, s57, 51200
    s_and_b32 s58, s58, 0xffff
    s_lshl_b32 s58, s58, 5
    buffer_load_dwordx4 v200, s[52:55], s58 offen lds
    s_add_u32 m0, s56, 3072
    s_add_u32 s58, s57, 52224
    s_and_b32 s58, s58, 0xffff
    s_lshl_b32 s58, s58, 5
    buffer_load_dwordx4 v200, s[52:55], s58 offen lds
    s_add_u32 m0, s56, 4096
    s_add_u32 s58, s57, 53248
    s_and_b32 s58, s58, 0xffff
    s_lshl_b32 s58, s58, 5
    buffer_load_dwordx4 v200, s[52:55], s58 offen lds
    s_add_u32 m0, s56, 5120
    s_add_u32 s58, s57, 54272
    s_and_b32 s58, s58, 0xffff
    s_lshl_b32 s58, s58, 5
    buffer_load_dwordx4 v200, s[52:55], s58 offen lds
    s_add_u32 m0, s56, 6144
    s_add_u32 s58, s57, 55296
    s_and_b32 s58, s58, 0xffff
    s_lshl_b32 s58, s58, 5
    buffer_load_dwordx4 v200, s[52:55], s58 offen lds
    s_add_u32 m0, s56, 7168
    s_add_u32 s58, s57, 56320
    s_and_b32 s58, s58, 0xffff
    s_lshl_b32 s58, s58, 5
    buffer_load_dwordx4 v200, s[52:55], s58 offen lds
    s_add_u32 m0, s56, 8192
    s_add_u32 s58, s57, 57344
    s_and_b32 s58, s58, 0xffff
    s_lshl_b32 s58, s58, 5
    buffer_load_dwordx4 v200, s[52:55], s58 offen lds
    s_add_u32 m0, s56, 9216
    s_add_u32 s58, s57, 58368
    s_and_b32 s58, s58, 0xffff
    s_lshl_b32 s58, s58, 5
    buffer_load_dwordx4 v200, s[52:55], s58 offen lds
    s_add_u32 m0, s56, 10240
    s_add_u32 s58, s57, 59392
    s_and_b32 s58, s58, 0xffff
    s_lshl_b32 s58, s58, 5
    buffer_load_dwordx4 v200, s[52:55], s58 offen lds
    s_add_u32 m0, s56, 11264
    s_add_u32 s58, s57, 60416
    s_and_b32 s58, s58, 0xffff
    s_lshl_b32 s58, s58, 5
    buffer_load_dwordx4 v200, s[52:55], s58 offen lds
    s_add_u32 m0, s56, 12288
    s_add_u32 s58, s57, 61440
    s_and_b32 s58, s58, 0xffff
    s_lshl_b32 s58, s58, 5
    buffer_load_dwordx4 v200, s[52:55], s58 offen lds
    s_add_u32 m0, s56, 13312
    s_add_u32 s58, s57, 62464
    s_and_b32 s58, s58, 0xffff
    s_lshl_b32 s58, s58, 5
    buffer_load_dwordx4 v200, s[52:55], s58 offen lds
    s_add_u32 m0, s56, 14336
    s_add_u32 s58, s57, 63488
    s_and_b32 s58, s58, 0xffff
    s_lshl_b32 s58, s58, 5
    buffer_load_dwordx4 v200, s[52:55], s58 offen lds
    s_add_u32 m0, s56, 15360
    s_add_u32 s58, s57, 64512
    s_and_b32 s58, s58, 0xffff
    s_lshl_b32 s58, s58, 5
    buffer_load_dwordx4 v200, s[52:55], s58 offen lds
mega_kernel_xo4:
    s_waitcnt vmcnt(0)
    ds_read_b64_tr_b16 a[192:193], v201 offset:0
    ds_read_b64_tr_b16 a[194:195], v201 offset:256
    ds_read_b64_tr_b16 a[196:197], v201 offset:1024
    ds_read_b64_tr_b16 a[198:199], v201 offset:1280
    ds_read_b64_tr_b16 a[200:201], v201 offset:2048
    ds_read_b64_tr_b16 a[202:203], v201 offset:2304
    ds_read_b64_tr_b16 a[204:205], v201 offset:3072
    ds_read_b64_tr_b16 a[206:207], v201 offset:3328
    s_waitcnt lgkmcnt(0)
    ds_read_b64_tr_b16 a[208:209], v201 offset:4096
    ds_read_b64_tr_b16 a[210:211], v201 offset:4352
    ds_read_b64_tr_b16 a[212:213], v201 offset:5120
    ds_read_b64_tr_b16 a[214:215], v201 offset:5376
    ds_read_b64_tr_b16 a[216:217], v201 offset:6144
    ds_read_b64_tr_b16 a[218:219], v201 offset:6400
    ds_read_b64_tr_b16 a[220:221], v201 offset:7168
    ds_read_b64_tr_b16 a[222:223], v201 offset:7424
    s_waitcnt lgkmcnt(0)
    ds_read_b64_tr_b16 a[224:225], v201 offset:8192
    ds_read_b64_tr_b16 a[226:227], v201 offset:8448
    ds_read_b64_tr_b16 a[228:229], v201 offset:9216
    ds_read_b64_tr_b16 a[230:231], v201 offset:9472
    ds_read_b64_tr_b16 a[232:233], v201 offset:10240
    ds_read_b64_tr_b16 a[234:235], v201 offset:10496
    ds_read_b64_tr_b16 a[236:237], v201 offset:11264
    ds_read_b64_tr_b16 a[238:239], v201 offset:11520
    s_waitcnt lgkmcnt(0)
    ds_read_b64_tr_b16 a[240:241], v201 offset:12288
    ds_read_b64_tr_b16 a[242:243], v201 offset:12544
    ds_read_b64_tr_b16 a[244:245], v201 offset:13312
    ds_read_b64_tr_b16 a[246:247], v201 offset:13568
    ds_read_b64_tr_b16 a[248:249], v201 offset:14336
    ds_read_b64_tr_b16 a[250:251], v201 offset:14592
    ds_read_b64_tr_b16 a[252:253], v201 offset:15360
    ds_read_b64_tr_b16 a[254:255], v201 offset:15616
    s_waitcnt lgkmcnt(0)
    s_load_dwordx2 s[8:9], s[0:1], 40
    s_load_dwordx2 s[12:13], s[0:1], 80
    v_lshrrev_b32 v3, 6, v0
    v_and_b32 v1, 63, v0
    v_readfirstlane_b32 s16, v3
    s_lshr_b32 s17, s92, 5
    s_and_b32 s18, s92, 31
    v_lshlrev_b32 v2, 4, v1
    s_waitcnt lgkmcnt(0)
    s_mov_b32 s10, 8388608
    s_mov_b32 s11, 0x00020000
    s_mov_b32 s14, 8388608
    s_mov_b32 s15, 0x00020000
    s_mov_b32 s24, 0x3e0293ee
    s_lshr_b32 s50, s18, 1
    s_lshl_b32 s50, s50, 12
    s_lshl_b32 s47, s17, 2
    s_add_u32 s20, s47, s16
    s_lshl_b32 s20, s20, 18
    s_lshl_b32 s21, s18, 13
    s_add_u32 s20, s20, s21
    s_add_u32 s20, s20, 50331648
    v_lshlrev_b32 v26, 7, v1
    buffer_load_dword v28, v26, s[84:87], s20 offen sc1
    v_and_b32 v4, 15, v1
    v_lshrrev_b32 v5, 4, v1
    v_lshrrev_b32 v3, 2, v4
    v_lshlrev_b32 v3, 1, v3
    v_and_b32 v26, 1, v4
    v_add_u32 v3, v3, v26
    v_lshlrev_b32 v6, 8, v3
    v_lshl_add_u32 v6, v5, 4, v6
    s_lshr_b32 s20, s16, 1
    s_lshl_b32 s20, s20, 10
    s_add_u32 s20, s20, 2048
    v_lshlrev_b32 v7, 3, v1
    v_add_u32 v7, s20, v7
    v_lshlrev_b32 v8, 9, v5
    v_lshl_add_u32 v8, v4, 4, v8
    s_lshr_b32 s20, s16, 1
    s_lshl_b32 s20, s20, 12
    s_and_b32 s21, s16, 1
    s_lshl_b32 s21, s21, 8
    s_add_u32 s20, s20, s21
    v_add_u32 v8, s20, v8
    v_lshlrev_b32 v19, 4, v4
    v_and_b32 v26, 1, v5
    v_lshl_add_u32 v19, v26, 10, v19
    v_lshrrev_b32 v26, 1, v5
    v_lshl_add_u32 v19, v26, 9, v19
    s_and_b32 s20, s17, 1
    s_lshl_b32 s20, s20, 8
    v_add_u32 v19, s20, v19
    v_lshlrev_b32 v26, 2, v5
    v_sub_u32 v9, v4, v26
    s_lshr_b32 s21, s21, 4
    v_add_u32 v9, s21, v9
    v_add_u32 v10, -16, v9
    v_mov_b32 v11, 0xff7fffff
    v_mov_b32 v20, 0x3f803f80
    v_mov_b32 v21, 0x3f803f80
    v_mov_b32 v22, 0x3f803f80
    v_mov_b32 v23, 0x3f803f80
    v_bfe_u32 v26, v1, 1, 2
    v_min_u32 v26, 2, v26
    s_lshl_b32 s20, s18, 8
    s_add_u32 s20, s20, 71303168
    v_lshlrev_b32 v12, 13, v26
    v_and_b32 v26, 1, v1
    v_lshl_add_u32 v12, v26, 7, v12
    v_add_u32 v12, s20, v12
    v_and_b32 v26, 1, v1
    v_lshlrev_b32 v13, 7, v26
    s_add_u32 s20, s20, 24576
    v_add_u32 v13, s20, v13
    v_and_b32 v26, 7, v1
    s_lshl_b32 s20, s17, 5
    s_lshl_b32 s21, s16, 3
    s_add_u32 s20, s20, s21
    v_add_u32 v26, s20, v26
    v_lshlrev_b32 v14, 7, v26
    v_add_u32 v14, 71335936, v14
    v_bfrev_b32 v26, 1
    s_lshl_b32 s20, s92, 7
    s_add_u32 s20, s20, 71335936
    v_mov_b32 v27, s20
    v_cmp_eq_u32 vcc, 0, v0
    s_lshl_b32 s20, s16, 12
    v_add_u32 v17, s20, v2
    v_cndmask_b32 v15, v26, v27, vcc
    v_lshrrev_b32 v26, 3, v0
    v_and_b32 v27, 1, v0
    v_lshl_add_u32 v27, v27, 5, v26
    v_lshlrev_b32 v16, 4, v27
    v_bfe_u32 v27, v0, 1, 2
    v_lshl_add_u32 v16, v27, 10, v16
    v_lshlrev_b32 v18, 12, v26
    v_and_b32 v27, 7, v0
    v_lshl_add_u32 v18, v27, 3, v18
    s_lshl_b32 s20, s18, 6
    v_add_u32 v18, s20, v18
    s_barrier
    s_add_u32 s22, s17, 4
    s_sub_u32 s20, s17, 4
    s_cmp_ge_u32 s17, 4
    s_cselect_b32 s22, s20, s22
mega_kernel_x_gp:
    buffer_load_dword v3, v12, s[84:87], 0 offen sc1
    s_waitcnt vmcnt(0)
    v_cmp_ne_u32 vcc, 32, v3
    s_cbranch_vccz mega_kernel_x_gk
    s_sleep 8
    s_branch mega_kernel_x_gp
mega_kernel_x_gk:
    s_mov_b32 s46, 0
    s_lshl_b32 s27, s22, 18
    s_lshl_b32 s20, s18, 13
    s_add_u32 s27, s27, s20
    s_add_u32 s29, s27, 178257920
    s_and_b32 s20, s16, 1
    s_lshl_b32 s20, s20, 10
    s_add_u32 s26, s27, s20
    s_add_u32 s26, s26, 0
    s_lshr_b32 s20, s16, 1
    s_lshl_b32 s20, s20, 12
    s_add_u32 s28, s27, s20
    s_add_u32 s28, s28, 33554432
    s_add_u32 s27, s27, 16777216
    s_add_u32 s48, s26, 4096
    s_add_u32 s49, s27, 4096
mega_kernel_x_ldq:
    buffer_load_dwordx4 v[24:27], v2, s[84:87], s26 offen offset:0
    buffer_load_dwordx4 v[28:31], v2, s[84:87], s26 offen offset:2048
    buffer_load_dwordx4 v[32:35], v2, s[84:87], s48 offen offset:0
    buffer_load_dwordx4 v[36:39], v2, s[84:87], s48 offen offset:2048
    buffer_load_dwordx4 v[40:43], v2, s[84:87], s27 offen offset:0
    buffer_load_dwordx4 v[44:47], v2, s[84:87], s27 offen offset:1024
    buffer_load_dwordx4 v[48:51], v2, s[84:87], s27 offen offset:2048
    buffer_load_dwordx4 v[52:55], v2, s[84:87], s27 offen offset:3072
    buffer_load_dwordx4 v[56:59], v2, s[84:87], s49 offen offset:0
    buffer_load_dwordx4 v[60:63], v2, s[84:87], s49 offen offset:1024
    buffer_load_dwordx4 v[64:67], v2, s[84:87], s49 offen offset:2048
    buffer_load_dwordx4 v[68:71], v2, s[84:87], s49 offen offset:3072
    buffer_load_dwordx4 v[72:75], v2, s[84:87], s28 offen offset:0
    buffer_load_dwordx4 v[76:79], v2, s[84:87], s28 offen offset:1024
    buffer_load_dwordx4 v[80:83], v2, s[84:87], s28 offen offset:2048
    buffer_load_dwordx4 v[84:87], v2, s[84:87], s28 offen offset:3072
mega_kernel_x_att:
    s_waitcnt vmcnt(0)
    v_mfma_f32_16x16x32_bf16 v[112:115], v[40:43], v[24:27], 0
    v_mfma_f32_16x16x32_bf16 v[116:119], v[44:47], v[24:27], 0
    v_mfma_f32_16x16x32_bf16 v[112:115], v[48:51], v[28:31], v[112:115]
    v_mfma_f32_16x16x32_bf16 v[116:119], v[52:55], v[28:31], v[116:119]
    v_mfma_f32_16x16x32_bf16 v[112:115], v[56:59], v[32:35], v[112:115]
    v_mfma_f32_16x16x32_bf16 v[116:119], v[60:63], v[32:35], v[116:119]
    v_mfma_f32_16x16x32_bf16 v[112:115], v[64:67], v[36:39], v[112:115]
    v_mfma_f32_16x16x32_bf16 v[116:119], v[68:71], v[36:39], v[116:119]
    s_lshl_b32 s41, s47, 18
    s_add_u32 s41, s41, 50331648
    s_lshl_b32 s20, s18, 13
    s_add_u32 s40, s41, s20
    s_lshl_b32 s20, s16, 16
    s_add_u32 s41, s41, s20
    s_lshl_b32 s42, s22, 17
    v_mov_b32 v130, v20
    v_mov_b32 v131, 0
    v_cmp_gt_i32 vcc, 0, v9
    s_nop 1
    v_cndmask_b32 v112, v112, v11, vcc
    v_cmp_gt_i32 vcc, 1, v9
    s_nop 1
    v_cndmask_b32 v113, v113, v11, vcc
    v_cmp_gt_i32 vcc, 2, v9
    s_nop 1
    v_cndmask_b32 v114, v114, v11, vcc
    v_cmp_gt_i32 vcc, 3, v9
    s_nop 1
    v_cndmask_b32 v115, v115, v11, vcc
    v_cmp_gt_i32 vcc, 0, v10
    s_nop 1
    v_cndmask_b32 v116, v116, v11, vcc
    v_cmp_gt_i32 vcc, 1, v10
    s_nop 1
    v_cndmask_b32 v117, v117, v11, vcc
    v_cmp_gt_i32 vcc, 2, v10
    s_nop 1
    v_cndmask_b32 v118, v118, v11, vcc
    v_cmp_gt_i32 vcc, 3, v10
    s_nop 1
    v_cndmask_b32 v119, v119, v11, vcc
    s_cmp_eq_u32 s46, 1
    s_cbranch_scc1 mega_kernel_x_rd
mega_kernel_x_rp:
    buffer_load_dword v3, v13, s[84:87], 0 offen sc1
    s_waitcnt vmcnt(0)
    v_cmp_ge_u32 vcc, s22, v3
    s_cbranch_vccz mega_kernel_x_rk
    s_sleep 2
    s_branch mega_kernel_x_rp
mega_kernel_x_rk:
    buffer_load_dwordx4 v[88:91], v6, s[84:87], s29 offen offset:0 sc1
    buffer_load_dwordx4 v[92:95], v6, s[84:87], s29 offen offset:64 sc1
    buffer_load_dwordx4 v[96:99], v6, s[84:87], s29 offen offset:128 sc1
    buffer_load_dwordx4 v[100:103], v6, s[84:87], s29 offen offset:192 sc1
    buffer_load_dwordx2 v[104:105], v7, s[84:87], s29 offen offset:0 sc1
    buffer_load_dwordx2 v[106:107], v7, s[84:87], s29 offen offset:2048 sc1
    buffer_load_dwordx2 v[108:109], v7, s[84:87], s29 offen offset:512 sc1
    buffer_load_dwordx2 v[110:111], v7, s[84:87], s29 offen offset:2560 sc1
mega_kernel_x_rd:
    s_waitcnt vmcnt(7)
    v_mfma_f32_16x16x32_bf16 v[120:123], v[88:91], v[24:27], 0
    s_waitcnt vmcnt(6)
    v_mfma_f32_16x16x32_bf16 v[120:123], v[92:95], v[28:31], v[120:123]
    s_waitcnt vmcnt(5)
    v_mfma_f32_16x16x32_bf16 v[120:123], v[96:99], v[32:35], v[120:123]
    s_waitcnt vmcnt(4)
    v_mfma_f32_16x16x32_bf16 v[120:123], v[100:103], v[36:39], v[120:123]
    v_max3_f32 v4, v112, v113, v114
    v_max3_f32 v4, v4, v115, v116
    v_max3_f32 v4, v4, v117, v118
    s_waitcnt vmcnt(0)
    v_swap_b32 v105, v106
    v_swap_b32 v109, v110
    s_nop 1
    v_max3_f32 v4, v4, v119, v120
    v_max_f32 v3, v4, v121
    v_max_f32 v4, v4, v121
    s_nop 1
    v_permlane16_swap_b32 v4, v3
    v_max_f32 v4, v4, v3
    v_max_f32 v3, v4, v3
    s_nop 1
    v_permlane32_swap_b32 v4, v3
    v_max_f32 v4, v4, v3
    v_mul_f32 v4, s24, v4
    v_fma_f32 v112, v112, s24, -v4
    v_fma_f32 v113, v113, s24, -v4
    v_fma_f32 v114, v114, s24, -v4
    v_fma_f32 v115, v115, s24, -v4
    v_fma_f32 v116, v116, s24, -v4
    v_fma_f32 v117, v117, s24, -v4
    v_fma_f32 v118, v118, s24, -v4
    v_fma_f32 v119, v119, s24, -v4
    v_fma_f32 v120, v120, s24, -v4
    v_fma_f32 v121, v121, s24, -v4
    v_exp_f32 v112, v112
    v_exp_f32 v113, v113
    v_exp_f32 v114, v114
    v_exp_f32 v115, v115
    v_exp_f32 v116, v116
    v_exp_f32 v117, v117
    v_exp_f32 v118, v118
    v_exp_f32 v119, v119
    v_exp_f32 v120, v120
    v_exp_f32 v121, v121
    s_nop 0
    v_cvt_pk_bf16_f32 v124, v112, v113
    v_cvt_pk_bf16_f32 v125, v114, v115
    v_cvt_pk_bf16_f32 v126, v116, v117
    v_cvt_pk_bf16_f32 v127, v118, v119
    v_cvt_pk_bf16_f32 v128, v120, v121
    v_mov_b32 v129, v128
    s_nop 1
    v_mfma_f32_16x16x32_bf16 v[132:135], v[20:23], v[124:127], 0
    v_mfma_f32_16x16x32_bf16 v[88:91], v[72:75], v[124:127], 0
    v_mfma_f32_16x16x32_bf16 v[92:95], v[76:79], v[124:127], 0
    v_mfma_f32_16x16x32_bf16 v[96:99], v[80:83], v[124:127], 0
    v_mfma_f32_16x16x32_bf16 v[100:103], v[84:87], v[124:127], 0
    s_nop 1
    v_mfma_f32_16x16x16_bf16 v[132:135], v[130:131], v[128:129], v[132:135]
    v_mfma_f32_16x16x16_bf16 v[88:91], v[104:105], v[128:129], v[88:91]
    v_mfma_f32_16x16x16_bf16 v[92:95], v[106:107], v[128:129], v[92:95]
    v_mfma_f32_16x16x16_bf16 v[96:99], v[108:109], v[128:129], v[96:99]
    v_mfma_f32_16x16x16_bf16 v[100:103], v[110:111], v[128:129], v[100:103]
    s_nop 3
    v_rcp_f32 v132, v132
    s_nop 2
    v_pk_mul_f32 v[88:89], v[88:89], v[132:133] op_sel_hi:[1,0]
    v_pk_mul_f32 v[90:91], v[90:91], v[132:133] op_sel_hi:[1,0]
    v_pk_mul_f32 v[92:93], v[92:93], v[132:133] op_sel_hi:[1,0]
    v_pk_mul_f32 v[94:95], v[94:95], v[132:133] op_sel_hi:[1,0]
    v_pk_mul_f32 v[96:97], v[96:97], v[132:133] op_sel_hi:[1,0]
    v_pk_mul_f32 v[98:99], v[98:99], v[132:133] op_sel_hi:[1,0]
    v_pk_mul_f32 v[100:101], v[100:101], v[132:133] op_sel_hi:[1,0]
    v_pk_mul_f32 v[102:103], v[102:103], v[132:133] op_sel_hi:[1,0]
    v_cvt_pk_bf16_f32 v112, v88, v89
    v_cvt_pk_bf16_f32 v113, v90, v91
    v_cvt_pk_bf16_f32 v114, v92, v93
    v_cvt_pk_bf16_f32 v115, v94, v95
    v_cvt_pk_bf16_f32 v116, v96, v97
    v_cvt_pk_bf16_f32 v117, v98, v99
    v_cvt_pk_bf16_f32 v118, v100, v101
    v_cvt_pk_bf16_f32 v119, v102, v103
    s_add_u32 s43, s22, 1
    v_mov_b32 v4, s43
    s_cmp_eq_u32 s96, 1
    s_cbranch_scc1 mega_kernel_x_of
    buffer_store_dwordx4 v[112:115], v8, s[84:87], s40 offen sc1
    buffer_store_dwordx4 v[116:119], v8, s[84:87], s40 offen offset:2048 sc1
    s_waitcnt vmcnt(0)
    s_barrier
    buffer_store_dword v4, v15, s[84:87], 0 offen sc1
    s_branch mega_kernel_x_od
mega_kernel_x_of:
    buffer_store_dwordx4 v[112:115], v8, s[84:87], s40 offen
    buffer_store_dwordx4 v[116:119], v8, s[84:87], s40 offen offset:2048
    s_waitcnt vmcnt(0)
    s_barrier
    buffer_store_dword v4, v15, s[84:87], 0 offen
mega_kernel_x_od:
    s_mov_b32 s45, s22
    s_add_u32 s20, s47, 1
    s_and_b32 s20, s20, 3
    s_andn2_b32 s47, s47, 3
    s_or_b32 s47, s47, s20
    s_add_u32 s20, s22, 2
    s_add_u32 s21, s17, 4
    s_cmp_lt_u32 s20, 4
    s_cselect_b32 s20, s20, s21
    s_add_u32 s21, s22, 6
    s_cmp_lt_u32 s22, 4
    s_cselect_b32 s22, s20, s21
    s_lshr_b32 s20, s17, 1
    s_add_u32 s20, s20, 58
    s_cmp_ge_u32 s22, 58
    s_cselect_b32 s22, s20, s22
    s_add_u32 s20, s45, 3
    s_cmp_ge_u32 s45, 58
    s_cselect_b32 s22, s20, s22
    s_lshl_b32 s27, s22, 18
    s_lshl_b32 s20, s18, 13
    s_add_u32 s27, s27, s20
    s_add_u32 s29, s27, 178257920
    s_and_b32 s20, s16, 1
    s_lshl_b32 s20, s20, 10
    s_add_u32 s26, s27, s20
    s_add_u32 s26, s26, 0
    s_lshr_b32 s20, s16, 1
    s_lshl_b32 s20, s20, 12
    s_add_u32 s28, s27, s20
    s_add_u32 s28, s28, 33554432
    s_add_u32 s27, s27, 16777216
    s_add_u32 s48, s26, 4096
    s_add_u32 s49, s27, 4096
mega_kernel_x_xp:
    buffer_load_dword v3, v14, s[84:87], 0 offen sc1
    s_waitcnt vmcnt(0)
    v_cmp_ge_u32 vcc, s45, v3
    s_cbranch_vccnz mega_kernel_x_xp
    s_cmp_ge_u32 s45, 58
    s_cbranch_scc1 mega_kernel_x_half
    s_add_u32 s20, s50, 0
    s_and_b32 s20, s20, 0xffff
    s_add_u32 s20, s20, s41
    buffer_load_dwordx4 v[136:139], v2, s[84:87], s20 offen offset:0 sc1
    buffer_load_dwordx4 v[140:143], v2, s[84:87], s20 offen offset:1024 sc1
    buffer_load_dwordx4 v[144:147], v2, s[84:87], s20 offen offset:2048 sc1
    buffer_load_dwordx4 v[148:151], v2, s[84:87], s20 offen offset:3072 sc1
    s_add_u32 s20, s50, 4096
    s_and_b32 s20, s20, 0xffff
    s_add_u32 s20, s20, s41
    buffer_load_dwordx4 v[152:155], v2, s[84:87], s20 offen offset:0 sc1
    buffer_load_dwordx4 v[156:159], v2, s[84:87], s20 offen offset:1024 sc1
    buffer_load_dwordx4 v[160:163], v2, s[84:87], s20 offen offset:2048 sc1
    buffer_load_dwordx4 v[164:167], v2, s[84:87], s20 offen offset:3072 sc1
    s_add_u32 s20, s50, 8192
    s_and_b32 s20, s20, 0xffff
    s_add_u32 s20, s20, s41
    buffer_load_dwordx4 v[168:171], v2, s[84:87], s20 offen offset:0 sc1
    buffer_load_dwordx4 v[172:175], v2, s[84:87], s20 offen offset:1024 sc1
    buffer_load_dwordx4 v[176:179], v2, s[84:87], s20 offen offset:2048 sc1
    buffer_load_dwordx4 v[180:183], v2, s[84:87], s20 offen offset:3072 sc1
    buffer_load_dword v5, v13, s[84:87], 0 offen sc1
    s_waitcnt vmcnt(12)
    v_mfma_f32_32x32x16_bf16 v[112:127], a[0:3], v[136:139], 0
    s_add_u32 s20, s50, 12288
    s_and_b32 s20, s20, 0xffff
    s_add_u32 s20, s20, s41
    buffer_load_dwordx4 v[184:187], v2, s[84:87], s20 offen offset:0 sc1
    s_waitcnt vmcnt(12)
    v_mfma_f32_32x32x16_bf16 v[112:127], a[4:7], v[140:143], v[112:127]
    buffer_load_dwordx4 v[188:191], v2, s[84:87], s20 offen offset:1024 sc1
    s_waitcnt vmcnt(12)
    v_mfma_f32_32x32x16_bf16 v[112:127], a[8:11], v[144:147], v[112:127]
    buffer_load_dwordx4 v[192:195], v2, s[84:87], s20 offen offset:2048 sc1
    s_waitcnt vmcnt(12)
    v_mfma_f32_32x32x16_bf16 v[112:127], a[12:15], v[148:151], v[112:127]
    buffer_load_dwordx4 v[196:199], v2, s[84:87], s20 offen offset:3072 sc1
    s_waitcnt vmcnt(12)
    v_mfma_f32_32x32x16_bf16 v[112:127], a[16:19], v[152:155], v[112:127]
    s_add_u32 s20, s50, 16384
    s_and_b32 s20, s20, 0xffff
    s_add_u32 s20, s20, s41
    buffer_load_dwordx4 v[200:203], v2, s[84:87], s20 offen offset:0 sc1
    s_waitcnt vmcnt(12)
    v_mfma_f32_32x32x16_bf16 v[112:127], a[20:23], v[156:159], v[112:127]
    buffer_load_dwordx4 v[204:207], v2, s[84:87], s20 offen offset:1024 sc1
    s_waitcnt vmcnt(12)
    v_mfma_f32_32x32x16_bf16 v[112:127], a[24:27], v[160:163], v[112:127]
    buffer_load_dwordx4 v[208:211], v2, s[84:87], s20 offen offset:2048 sc1
    s_waitcnt vmcnt(12)
    v_mfma_f32_32x32x16_bf16 v[112:127], a[28:31], v[164:167], v[112:127]
    buffer_load_dwordx4 v[212:215], v2, s[84:87], s20 offen offset:3072 sc1
    s_waitcnt vmcnt(12)
    v_mfma_f32_32x32x16_bf16 v[112:127], a[32:35], v[168:171], v[112:127]
    s_add_u32 s20, s50, 20480
    s_and_b32 s20, s20, 0xffff
    s_add_u32 s20, s20, s41
    buffer_load_dwordx4 v[216:219], v2, s[84:87], s20 offen offset:0 sc1
    s_waitcnt vmcnt(12)
    v_mfma_f32_32x32x16_bf16 v[112:127], a[36:39], v[172:175], v[112:127]
    buffer_load_dwordx4 v[220:223], v2, s[84:87], s20 offen offset:1024 sc1
    s_waitcnt vmcnt(12)
    v_mfma_f32_32x32x16_bf16 v[112:127], a[40:43], v[176:179], v[112:127]
    buffer_load_dwordx4 v[224:227], v2, s[84:87], s20 offen offset:2048 sc1
    s_waitcnt vmcnt(12)
    v_mfma_f32_32x32x16_bf16 v[112:127], a[44:47], v[180:183], v[112:127]
    buffer_load_dwordx4 v[228:231], v2, s[84:87], s20 offen offset:3072 sc1
    s_waitcnt vmcnt(11)
    v_mfma_f32_32x32x16_bf16 v[112:127], a[48:51], v[184:187], v[112:127]
    s_add_u32 s20, s50, 24576
    s_and_b32 s20, s20, 0xffff
    s_add_u32 s20, s20, s41
    buffer_load_dwordx4 v[232:235], v2, s[84:87], s20 offen offset:0 sc1
    v_cmp_ge_u32 vcc, s22, v5
    s_waitcnt vmcnt(11)
    v_mfma_f32_32x32x16_bf16 v[112:127], a[52:55], v[188:191], v[112:127]
    buffer_load_dwordx4 v[236:239], v2, s[84:87], s20 offen offset:1024 sc1
    s_cmp_eq_u64 vcc, 0
    s_cselect_b32 s46, 1, 0
    s_waitcnt vmcnt(11)
    v_mfma_f32_32x32x16_bf16 v[112:127], a[56:59], v[192:195], v[112:127]
    buffer_load_dwordx4 v[240:243], v2, s[84:87], s20 offen offset:2048 sc1
    s_waitcnt vmcnt(11)
    v_mfma_f32_32x32x16_bf16 v[112:127], a[60:63], v[196:199], v[112:127]
    buffer_load_dwordx4 v[244:247], v2, s[84:87], s20 offen offset:3072 sc1
    s_waitcnt vmcnt(11)
    v_mfma_f32_32x32x16_bf16 v[112:127], a[64:67], v[200:203], v[112:127]
    s_add_u32 s20, s50, 28672
    s_and_b32 s20, s20, 0xffff
    s_add_u32 s20, s20, s41
    buffer_load_dwordx4 v[248:251], v2, s[84:87], s20 offen offset:0 sc1
    s_waitcnt vmcnt(11)
    v_mfma_f32_32x32x16_bf16 v[112:127], a[68:71], v[204:207], v[112:127]
    buffer_load_dwordx4 v[252:255], v2, s[84:87], s20 offen offset:1024 sc1
    s_waitcnt vmcnt(11)
    v_mfma_f32_32x32x16_bf16 v[112:127], a[72:75], v[208:211], v[112:127]
    buffer_load_dwordx4 v[136:139], v2, s[84:87], s20 offen offset:2048 sc1
    s_waitcnt vmcnt(11)
    v_mfma_f32_32x32x16_bf16 v[112:127], a[76:79], v[212:215], v[112:127]
    buffer_load_dwordx4 v[140:143], v2, s[84:87], s20 offen offset:3072 sc1
    s_waitcnt vmcnt(11)
    v_mfma_f32_32x32x16_bf16 v[112:127], a[80:83], v[216:219], v[112:127]
    s_add_u32 s20, s50, 32768
    s_and_b32 s20, s20, 0xffff
    s_add_u32 s20, s20, s41
    buffer_load_dwordx4 v[144:147], v2, s[84:87], s20 offen offset:0 sc1
    s_waitcnt vmcnt(11)
    v_mfma_f32_32x32x16_bf16 v[112:127], a[84:87], v[220:223], v[112:127]
    buffer_load_dwordx4 v[148:151], v2, s[84:87], s20 offen offset:1024 sc1
    s_waitcnt vmcnt(11)
    v_mfma_f32_32x32x16_bf16 v[112:127], a[88:91], v[224:227], v[112:127]
    buffer_load_dwordx4 v[152:155], v2, s[84:87], s20 offen offset:2048 sc1
    s_waitcnt vmcnt(11)
    v_mfma_f32_32x32x16_bf16 v[112:127], a[92:95], v[228:231], v[112:127]
    buffer_load_dwordx4 v[156:159], v2, s[84:87], s20 offen offset:3072 sc1
    s_waitcnt vmcnt(11)
    v_mfma_f32_32x32x16_bf16 v[112:127], a[96:99], v[232:235], v[112:127]
    s_add_u32 s20, s50, 36864
    s_and_b32 s20, s20, 0xffff
    s_add_u32 s20, s20, s41
    buffer_load_dwordx4 v[160:163], v2, s[84:87], s20 offen offset:0 sc1
    s_waitcnt vmcnt(11)
    v_mfma_f32_32x32x16_bf16 v[112:127], a[100:103], v[236:239], v[112:127]
    buffer_load_dwordx4 v[164:167], v2, s[84:87], s20 offen offset:1024 sc1
    s_waitcnt vmcnt(11)
    v_mfma_f32_32x32x16_bf16 v[112:127], a[104:107], v[240:243], v[112:127]
    buffer_load_dwordx4 v[168:171], v2, s[84:87], s20 offen offset:2048 sc1
    s_waitcnt vmcnt(11)
    v_mfma_f32_32x32x16_bf16 v[112:127], a[108:111], v[244:247], v[112:127]
    buffer_load_dwordx4 v[172:175], v2, s[84:87], s20 offen offset:3072 sc1
    s_waitcnt vmcnt(11)
    v_mfma_f32_32x32x16_bf16 v[112:127], a[112:115], v[248:251], v[112:127]
    s_add_u32 s20, s50, 40960
    s_and_b32 s20, s20, 0xffff
    s_add_u32 s20, s20, s41
    buffer_load_dwordx4 v[176:179], v2, s[84:87], s20 offen offset:0 sc1
    s_waitcnt vmcnt(11)
    v_mfma_f32_32x32x16_bf16 v[112:127], a[116:119], v[252:255], v[112:127]
    buffer_load_dwordx4 v[180:183], v2, s[84:87], s20 offen offset:1024 sc1
    s_waitcnt vmcnt(11)
    v_mfma_f32_32x32x16_bf16 v[112:127], a[120:123], v[136:139], v[112:127]
    buffer_load_dwordx4 v[184:187], v2, s[84:87], s20 offen offset:2048 sc1
    s_waitcnt vmcnt(11)
    v_mfma_f32_32x32x16_bf16 v[112:127], a[124:127], v[140:143], v[112:127]
    buffer_load_dwordx4 v[188:191], v2, s[84:87], s20 offen offset:3072 sc1
    s_waitcnt vmcnt(11)
    v_mfma_f32_32x32x16_bf16 v[112:127], a[128:131], v[144:147], v[112:127]
    s_add_u32 s20, s50, 45056
    s_and_b32 s20, s20, 0xffff
    s_add_u32 s20, s20, s41
    buffer_load_dwordx4 v[192:195], v2, s[84:87], s20 offen offset:0 sc1
    s_waitcnt vmcnt(11)
    v_mfma_f32_32x32x16_bf16 v[112:127], a[132:135], v[148:151], v[112:127]
    buffer_load_dwordx4 v[196:199], v2, s[84:87], s20 offen offset:1024 sc1
    s_waitcnt vmcnt(11)
    v_mfma_f32_32x32x16_bf16 v[112:127], a[136:139], v[152:155], v[112:127]
    buffer_load_dwordx4 v[200:203], v2, s[84:87], s20 offen offset:2048 sc1
    s_waitcnt vmcnt(11)
    v_mfma_f32_32x32x16_bf16 v[112:127], a[140:143], v[156:159], v[112:127]
    buffer_load_dwordx4 v[204:207], v2, s[84:87], s20 offen offset:3072 sc1
    s_waitcnt vmcnt(11)
    v_mfma_f32_32x32x16_bf16 v[112:127], a[144:147], v[160:163], v[112:127]
    s_add_u32 s20, s50, 49152
    s_and_b32 s20, s20, 0xffff
    s_add_u32 s20, s20, s41
    buffer_load_dwordx4 v[208:211], v2, s[84:87], s20 offen offset:0 sc1
    s_waitcnt vmcnt(11)
    v_mfma_f32_32x32x16_bf16 v[112:127], a[148:151], v[164:167], v[112:127]
    buffer_load_dwordx4 v[212:215], v2, s[84:87], s20 offen offset:1024 sc1
    s_waitcnt vmcnt(11)
    v_mfma_f32_32x32x16_bf16 v[112:127], a[152:155], v[168:171], v[112:127]
    buffer_load_dwordx4 v[216:219], v2, s[84:87], s20 offen offset:2048 sc1
    s_waitcnt vmcnt(11)
    v_mfma_f32_32x32x16_bf16 v[112:127], a[156:159], v[172:175], v[112:127]
    buffer_load_dwordx4 v[220:223], v2, s[84:87], s20 offen offset:3072 sc1
    s_waitcnt vmcnt(11)
    v_mfma_f32_32x32x16_bf16 v[112:127], a[160:163], v[176:179], v[112:127]
    s_add_u32 s20, s50, 53248
    s_and_b32 s20, s20, 0xffff
    s_add_u32 s20, s20, s41
    buffer_load_dwordx4 v[224:227], v2, s[84:87], s20 offen offset:0 sc1
    s_waitcnt vmcnt(11)
    v_mfma_f32_32x32x16_bf16 v[112:127], a[164:167], v[180:183], v[112:127]
    buffer_load_dwordx4 v[228:231], v2, s[84:87], s20 offen offset:1024 sc1
    s_waitcnt vmcnt(11)
    v_mfma_f32_32x32x16_bf16 v[112:127], a[168:171], v[184:187], v[112:127]
    buffer_load_dwordx4 v[232:235], v2, s[84:87], s20 offen offset:2048 sc1
    s_waitcnt vmcnt(11)
    v_mfma_f32_32x32x16_bf16 v[112:127], a[172:175], v[188:191], v[112:127]
    buffer_load_dwordx4 v[236:239], v2, s[84:87], s20 offen offset:3072 sc1
    s_waitcnt vmcnt(11)
    v_mfma_f32_32x32x16_bf16 v[112:127], a[176:179], v[192:195], v[112:127]
    s_add_u32 s20, s50, 57344
    s_and_b32 s20, s20, 0xffff
    s_add_u32 s20, s20, s41
    buffer_load_dwordx4 v[240:243], v2, s[84:87], s20 offen offset:0 sc1
    s_waitcnt vmcnt(11)
    v_mfma_f32_32x32x16_bf16 v[112:127], a[180:183], v[196:199], v[112:127]
    buffer_load_dwordx4 v[244:247], v2, s[84:87], s20 offen offset:1024 sc1
    s_waitcnt vmcnt(11)
    v_mfma_f32_32x32x16_bf16 v[112:127], a[184:187], v[200:203], v[112:127]
    buffer_load_dwordx4 v[248:251], v2, s[84:87], s20 offen offset:2048 sc1
    s_waitcnt vmcnt(11)
    v_mfma_f32_32x32x16_bf16 v[112:127], a[188:191], v[204:207], v[112:127]
    buffer_load_dwordx4 v[252:255], v2, s[84:87], s20 offen offset:3072 sc1
    s_waitcnt vmcnt(11)
    v_mfma_f32_32x32x16_bf16 v[112:127], a[192:195], v[208:211], v[112:127]
    s_add_u32 s20, s50, 61440
    s_and_b32 s20, s20, 0xffff
    s_add_u32 s20, s20, s41
    buffer_load_dwordx4 v[136:139], v2, s[84:87], s20 offen offset:0 sc1
    s_waitcnt vmcnt(11)
    v_mfma_f32_32x32x16_bf16 v[112:127], a[196:199], v[212:215], v[112:127]
    buffer_load_dwordx4 v[140:143], v2, s[84:87], s20 offen offset:1024 sc1
    s_waitcnt vmcnt(11)
    v_mfma_f32_32x32x16_bf16 v[112:127], a[200:203], v[216:219], v[112:127]
    buffer_load_dwordx4 v[144:147], v2, s[84:87], s20 offen offset:2048 sc1
    s_waitcnt vmcnt(11)
    v_mfma_f32_32x32x16_bf16 v[112:127], a[204:207], v[220:223], v[112:127]
    buffer_load_dwordx4 v[148:151], v2, s[84:87], s20 offen offset:3072 sc1
    s_cmp_eq_u32 s46, 1
    s_cbranch_scc1 mega_kernel_x_pfx
    s_waitcnt vmcnt(11)
    v_mfma_f32_32x32x16_bf16 v[112:127], a[208:211], v[224:227], v[112:127]
    s_waitcnt vmcnt(10)
    v_mfma_f32_32x32x16_bf16 v[112:127], a[212:215], v[228:231], v[112:127]
    s_waitcnt vmcnt(9)
    v_mfma_f32_32x32x16_bf16 v[112:127], a[216:219], v[232:235], v[112:127]
    s_waitcnt vmcnt(8)
    v_mfma_f32_32x32x16_bf16 v[112:127], a[220:223], v[236:239], v[112:127]
    s_waitcnt vmcnt(7)
    v_mfma_f32_32x32x16_bf16 v[112:127], a[224:227], v[240:243], v[112:127]
    s_waitcnt vmcnt(6)
    v_mfma_f32_32x32x16_bf16 v[112:127], a[228:231], v[244:247], v[112:127]
    s_waitcnt vmcnt(5)
    v_mfma_f32_32x32x16_bf16 v[112:127], a[232:235], v[248:251], v[112:127]
    s_waitcnt vmcnt(4)
    v_mfma_f32_32x32x16_bf16 v[112:127], a[236:239], v[252:255], v[112:127]
    s_waitcnt vmcnt(3)
    v_mfma_f32_32x32x16_bf16 v[112:127], a[240:243], v[136:139], v[112:127]
    s_waitcnt vmcnt(2)
    v_mfma_f32_32x32x16_bf16 v[112:127], a[244:247], v[140:143], v[112:127]
    s_waitcnt vmcnt(1)
    v_mfma_f32_32x32x16_bf16 v[112:127], a[248:251], v[144:147], v[112:127]
    s_waitcnt vmcnt(0)
    v_mfma_f32_32x32x16_bf16 v[112:127], a[252:255], v[148:151], v[112:127]
    s_branch mega_kernel_x_pfd
mega_kernel_x_pfx:
    s_waitcnt vmcnt(11)
    v_mfma_f32_32x32x16_bf16 v[112:127], a[208:211], v[224:227], v[112:127]
    buffer_load_dwordx4 v[24:27], v2, s[84:87], s26 offen offset:0
    buffer_load_dwordx4 v[28:31], v2, s[84:87], s26 offen offset:2048
    s_waitcnt vmcnt(12)
    v_mfma_f32_32x32x16_bf16 v[112:127], a[212:215], v[228:231], v[112:127]
    buffer_load_dwordx4 v[32:35], v2, s[84:87], s48 offen offset:0
    buffer_load_dwordx4 v[36:39], v2, s[84:87], s48 offen offset:2048
    s_waitcnt vmcnt(13)
    v_mfma_f32_32x32x16_bf16 v[112:127], a[216:219], v[232:235], v[112:127]
    buffer_load_dwordx4 v[40:43], v2, s[84:87], s27 offen offset:0
    buffer_load_dwordx4 v[44:47], v2, s[84:87], s27 offen offset:1024
    s_waitcnt vmcnt(14)
    v_mfma_f32_32x32x16_bf16 v[112:127], a[220:223], v[236:239], v[112:127]
    buffer_load_dwordx4 v[48:51], v2, s[84:87], s27 offen offset:2048
    buffer_load_dwordx4 v[52:55], v2, s[84:87], s27 offen offset:3072
    s_waitcnt vmcnt(15)
    v_mfma_f32_32x32x16_bf16 v[112:127], a[224:227], v[240:243], v[112:127]
    buffer_load_dwordx4 v[56:59], v2, s[84:87], s49 offen offset:0
    buffer_load_dwordx4 v[60:63], v2, s[84:87], s49 offen offset:1024
    s_waitcnt vmcnt(16)
    v_mfma_f32_32x32x16_bf16 v[112:127], a[228:231], v[244:247], v[112:127]
    buffer_load_dwordx4 v[64:67], v2, s[84:87], s49 offen offset:2048
    buffer_load_dwordx4 v[68:71], v2, s[84:87], s49 offen offset:3072
    s_waitcnt vmcnt(17)
    v_mfma_f32_32x32x16_bf16 v[112:127], a[232:235], v[248:251], v[112:127]
    buffer_load_dwordx4 v[72:75], v2, s[84:87], s28 offen offset:0
    buffer_load_dwordx4 v[76:79], v2, s[84:87], s28 offen offset:1024
    s_waitcnt vmcnt(18)
    v_mfma_f32_32x32x16_bf16 v[112:127], a[236:239], v[252:255], v[112:127]
    buffer_load_dwordx4 v[80:83], v2, s[84:87], s28 offen offset:2048
    buffer_load_dwordx4 v[84:87], v2, s[84:87], s28 offen offset:3072
    s_waitcnt vmcnt(19)
    v_mfma_f32_32x32x16_bf16 v[112:127], a[240:243], v[136:139], v[112:127]
    buffer_load_dwordx4 v[88:91], v6, s[84:87], s29 offen offset:0 sc1
    buffer_load_dwordx4 v[92:95], v6, s[84:87], s29 offen offset:64 sc1
    s_waitcnt vmcnt(20)
    v_mfma_f32_32x32x16_bf16 v[112:127], a[244:247], v[140:143], v[112:127]
    buffer_load_dwordx4 v[96:99], v6, s[84:87], s29 offen offset:128 sc1
    buffer_load_dwordx4 v[100:103], v6, s[84:87], s29 offen offset:192 sc1
    s_waitcnt vmcnt(21)
    v_mfma_f32_32x32x16_bf16 v[112:127], a[248:251], v[144:147], v[112:127]
    buffer_load_dwordx2 v[104:105], v7, s[84:87], s29 offen offset:0 sc1
    buffer_load_dwordx2 v[106:107], v7, s[84:87], s29 offen offset:2048 sc1
    s_waitcnt vmcnt(22)
    v_mfma_f32_32x32x16_bf16 v[112:127], a[252:255], v[148:151], v[112:127]
    buffer_load_dwordx2 v[108:109], v7, s[84:87], s29 offen offset:512 sc1
    buffer_load_dwordx2 v[110:111], v7, s[84:87], s29 offen offset:2560 sc1
mega_kernel_x_pfd:
    s_nop 11
    ds_write_b128 v17, v[112:115] offset:0
    ds_write_b128 v17, v[116:119] offset:1024
    ds_write_b128 v17, v[120:123] offset:2048
    ds_write_b128 v17, v[124:127] offset:3072
    s_waitcnt lgkmcnt(0)
    s_barrier
    ds_read_b128 v[112:115], v16 offset:0
    ds_read_b128 v[116:119], v16 offset:4096
    ds_read_b128 v[120:123], v16 offset:8192
    ds_read_b128 v[124:127], v16 offset:12288
    s_waitcnt lgkmcnt(0)
    v_pk_add_f32 v[112:113], v[112:113], v[116:117]
    v_pk_add_f32 v[114:115], v[114:115], v[118:119]
    v_pk_add_f32 v[120:121], v[120:121], v[124:125]
    v_pk_add_f32 v[122:123], v[122:123], v[126:127]
    v_pk_add_f32 v[112:113], v[112:113], v[120:121]
    v_pk_add_f32 v[114:115], v[114:115], v[122:123]
    v_cvt_pk_bf16_f32 v132, v112, v113
    v_cvt_pk_bf16_f32 v133, v114, v115
    buffer_store_dwordx2 v[132:133], v18, s[12:15], s42 offen
    s_branch mega_kernel_x_nxt
mega_kernel_x_half:
    s_add_u32 s20, s50, 0
    s_and_b32 s20, s20, 0xffff
    s_add_u32 s20, s20, s41
    buffer_load_dwordx4 v[136:139], v19, s[84:87], s20 offen offset:0 sc1
    buffer_load_dwordx4 v[140:143], v19, s[84:87], s20 offen offset:2048 sc1
    s_add_u32 s20, s50, 4096
    s_and_b32 s20, s20, 0xffff
    s_add_u32 s20, s20, s41
    buffer_load_dwordx4 v[144:147], v19, s[84:87], s20 offen offset:0 sc1
    buffer_load_dwordx4 v[148:151], v19, s[84:87], s20 offen offset:2048 sc1
    s_add_u32 s20, s50, 8192
    s_and_b32 s20, s20, 0xffff
    s_add_u32 s20, s20, s41
    buffer_load_dwordx4 v[152:155], v19, s[84:87], s20 offen offset:0 sc1
    buffer_load_dwordx4 v[156:159], v19, s[84:87], s20 offen offset:2048 sc1
    s_add_u32 s20, s50, 12288
    s_and_b32 s20, s20, 0xffff
    s_add_u32 s20, s20, s41
    buffer_load_dwordx4 v[160:163], v19, s[84:87], s20 offen offset:0 sc1
    buffer_load_dwordx4 v[164:167], v19, s[84:87], s20 offen offset:2048 sc1
    s_add_u32 s20, s50, 16384
    s_and_b32 s20, s20, 0xffff
    s_add_u32 s20, s20, s41
    buffer_load_dwordx4 v[168:171], v19, s[84:87], s20 offen offset:0 sc1
    buffer_load_dwordx4 v[172:175], v19, s[84:87], s20 offen offset:2048 sc1
    s_add_u32 s20, s50, 20480
    s_and_b32 s20, s20, 0xffff
    s_add_u32 s20, s20, s41
    buffer_load_dwordx4 v[176:179], v19, s[84:87], s20 offen offset:0 sc1
    buffer_load_dwordx4 v[180:183], v19, s[84:87], s20 offen offset:2048 sc1
    s_mov_b32 s46, 0
    s_waitcnt vmcnt(11)
    v_mfma_f32_32x32x16_bf16 v[112:127], a[0:3], v[136:139], 0
    v_mfma_f32_32x32x16_bf16 v[88:103], a[4:7], v[136:139], 0
    s_add_u32 s20, s50, 24576
    s_and_b32 s20, s20, 0xffff
    s_add_u32 s20, s20, s41
    buffer_load_dwordx4 v[184:187], v19, s[84:87], s20 offen offset:0 sc1
    s_waitcnt vmcnt(11)
    v_mfma_f32_32x32x16_bf16 v[112:127], a[8:11], v[140:143], v[112:127]
    v_mfma_f32_32x32x16_bf16 v[88:103], a[12:15], v[140:143], v[88:103]
    buffer_load_dwordx4 v[188:191], v19, s[84:87], s20 offen offset:2048 sc1
    s_waitcnt vmcnt(11)
    v_mfma_f32_32x32x16_bf16 v[112:127], a[16:19], v[144:147], v[112:127]
    v_mfma_f32_32x32x16_bf16 v[88:103], a[20:23], v[144:147], v[88:103]
    s_add_u32 s20, s50, 28672
    s_and_b32 s20, s20, 0xffff
    s_add_u32 s20, s20, s41
    buffer_load_dwordx4 v[192:195], v19, s[84:87], s20 offen offset:0 sc1
    s_waitcnt vmcnt(11)
    v_mfma_f32_32x32x16_bf16 v[112:127], a[24:27], v[148:151], v[112:127]
    v_mfma_f32_32x32x16_bf16 v[88:103], a[28:31], v[148:151], v[88:103]
    buffer_load_dwordx4 v[196:199], v19, s[84:87], s20 offen offset:2048 sc1
    s_waitcnt vmcnt(11)
    v_mfma_f32_32x32x16_bf16 v[112:127], a[32:35], v[152:155], v[112:127]
    v_mfma_f32_32x32x16_bf16 v[88:103], a[36:39], v[152:155], v[88:103]
    s_add_u32 s20, s50, 32768
    s_and_b32 s20, s20, 0xffff
    s_add_u32 s20, s20, s41
    buffer_load_dwordx4 v[200:203], v19, s[84:87], s20 offen offset:0 sc1
    s_waitcnt vmcnt(11)
    v_mfma_f32_32x32x16_bf16 v[112:127], a[40:43], v[156:159], v[112:127]
    v_mfma_f32_32x32x16_bf16 v[88:103], a[44:47], v[156:159], v[88:103]
    buffer_load_dwordx4 v[204:207], v19, s[84:87], s20 offen offset:2048 sc1
    s_waitcnt vmcnt(11)
    v_mfma_f32_32x32x16_bf16 v[112:127], a[48:51], v[160:163], v[112:127]
    v_mfma_f32_32x32x16_bf16 v[88:103], a[52:55], v[160:163], v[88:103]
    s_add_u32 s20, s50, 36864
    s_and_b32 s20, s20, 0xffff
    s_add_u32 s20, s20, s41
    buffer_load_dwordx4 v[208:211], v19, s[84:87], s20 offen offset:0 sc1
    s_waitcnt vmcnt(11)
    v_mfma_f32_32x32x16_bf16 v[112:127], a[56:59], v[164:167], v[112:127]
    v_mfma_f32_32x32x16_bf16 v[88:103], a[60:63], v[164:167], v[88:103]
    buffer_load_dwordx4 v[212:215], v19, s[84:87], s20 offen offset:2048 sc1
    s_waitcnt vmcnt(11)
    v_mfma_f32_32x32x16_bf16 v[112:127], a[64:67], v[168:171], v[112:127]
    v_mfma_f32_32x32x16_bf16 v[88:103], a[68:71], v[168:171], v[88:103]
    s_add_u32 s20, s50, 40960
    s_and_b32 s20, s20, 0xffff
    s_add_u32 s20, s20, s41
    buffer_load_dwordx4 v[216:219], v19, s[84:87], s20 offen offset:0 sc1
    s_waitcnt vmcnt(11)
    v_mfma_f32_32x32x16_bf16 v[112:127], a[72:75], v[172:175], v[112:127]
    v_mfma_f32_32x32x16_bf16 v[88:103], a[76:79], v[172:175], v[88:103]
    buffer_load_dwordx4 v[220:223], v19, s[84:87], s20 offen offset:2048 sc1
    s_waitcnt vmcnt(11)
    v_mfma_f32_32x32x16_bf16 v[112:127], a[80:83], v[176:179], v[112:127]
    v_mfma_f32_32x32x16_bf16 v[88:103], a[84:87], v[176:179], v[88:103]
    s_add_u32 s20, s50, 45056
    s_and_b32 s20, s20, 0xffff
    s_add_u32 s20, s20, s41
    buffer_load_dwordx4 v[224:227], v19, s[84:87], s20 offen offset:0 sc1
    s_waitcnt vmcnt(11)
    v_mfma_f32_32x32x16_bf16 v[112:127], a[88:91], v[180:183], v[112:127]
    v_mfma_f32_32x32x16_bf16 v[88:103], a[92:95], v[180:183], v[88:103]
    buffer_load_dwordx4 v[228:231], v19, s[84:87], s20 offen offset:2048 sc1
    s_waitcnt vmcnt(11)
    v_mfma_f32_32x32x16_bf16 v[112:127], a[96:99], v[184:187], v[112:127]
    v_mfma_f32_32x32x16_bf16 v[88:103], a[100:103], v[184:187], v[88:103]
    s_add_u32 s20, s50, 49152
    s_and_b32 s20, s20, 0xffff
    s_add_u32 s20, s20, s41
    buffer_load_dwordx4 v[232:235], v19, s[84:87], s20 offen offset:0 sc1
    s_waitcnt vmcnt(11)
    v_mfma_f32_32x32x16_bf16 v[112:127], a[104:107], v[188:191], v[112:127]
    v_mfma_f32_32x32x16_bf16 v[88:103], a[108:111], v[188:191], v[88:103]
    buffer_load_dwordx4 v[236:239], v19, s[84:87], s20 offen offset:2048 sc1
    s_waitcnt vmcnt(11)
    v_mfma_f32_32x32x16_bf16 v[112:127], a[112:115], v[192:195], v[112:127]
    v_mfma_f32_32x32x16_bf16 v[88:103], a[116:119], v[192:195], v[88:103]
    s_add_u32 s20, s50, 53248
    s_and_b32 s20, s20, 0xffff
    s_add_u32 s20, s20, s41
    buffer_load_dwordx4 v[240:243], v19, s[84:87], s20 offen offset:0 sc1
    s_waitcnt vmcnt(11)
    v_mfma_f32_32x32x16_bf16 v[112:127], a[120:123], v[196:199], v[112:127]
    v_mfma_f32_32x32x16_bf16 v[88:103], a[124:127], v[196:199], v[88:103]
    buffer_load_dwordx4 v[244:247], v19, s[84:87], s20 offen offset:2048 sc1
    s_waitcnt vmcnt(11)
    v_mfma_f32_32x32x16_bf16 v[112:127], a[128:131], v[200:203], v[112:127]
    v_mfma_f32_32x32x16_bf16 v[88:103], a[132:135], v[200:203], v[88:103]
    s_add_u32 s20, s50, 57344
    s_and_b32 s20, s20, 0xffff
    s_add_u32 s20, s20, s41
    buffer_load_dwordx4 v[248:251], v19, s[84:87], s20 offen offset:0 sc1
    s_waitcnt vmcnt(11)
    v_mfma_f32_32x32x16_bf16 v[112:127], a[136:139], v[204:207], v[112:127]
    v_mfma_f32_32x32x16_bf16 v[88:103], a[140:143], v[204:207], v[88:103]
    buffer_load_dwordx4 v[252:255], v19, s[84:87], s20 offen offset:2048 sc1
    s_waitcnt vmcnt(11)
    v_mfma_f32_32x32x16_bf16 v[112:127], a[144:147], v[208:211], v[112:127]
    v_mfma_f32_32x32x16_bf16 v[88:103], a[148:151], v[208:211], v[88:103]
    s_add_u32 s20, s50, 61440
    s_and_b32 s20, s20, 0xffff
    s_add_u32 s20, s20, s41
    buffer_load_dwordx4 v[136:139], v19, s[84:87], s20 offen offset:0 sc1
    s_waitcnt vmcnt(11)
    v_mfma_f32_32x32x16_bf16 v[112:127], a[152:155], v[212:215], v[112:127]
    v_mfma_f32_32x32x16_bf16 v[88:103], a[156:159], v[212:215], v[88:103]
    buffer_load_dwordx4 v[140:143], v19, s[84:87], s20 offen offset:2048 sc1
    s_waitcnt vmcnt(11)
    v_mfma_f32_32x32x16_bf16 v[112:127], a[160:163], v[216:219], v[112:127]
    v_mfma_f32_32x32x16_bf16 v[88:103], a[164:167], v[216:219], v[88:103]
    s_waitcnt vmcnt(10)
    v_mfma_f32_32x32x16_bf16 v[112:127], a[168:171], v[220:223], v[112:127]
    v_mfma_f32_32x32x16_bf16 v[88:103], a[172:175], v[220:223], v[88:103]
    s_waitcnt vmcnt(9)
    v_mfma_f32_32x32x16_bf16 v[112:127], a[176:179], v[224:227], v[112:127]
    v_mfma_f32_32x32x16_bf16 v[88:103], a[180:183], v[224:227], v[88:103]
    s_waitcnt vmcnt(8)
    v_mfma_f32_32x32x16_bf16 v[112:127], a[184:187], v[228:231], v[112:127]
    v_mfma_f32_32x32x16_bf16 v[88:103], a[188:191], v[228:231], v[88:103]
    s_waitcnt vmcnt(7)
    v_mfma_f32_32x32x16_bf16 v[112:127], a[192:195], v[232:235], v[112:127]
    v_mfma_f32_32x32x16_bf16 v[88:103], a[196:199], v[232:235], v[88:103]
    s_waitcnt vmcnt(6)
    v_mfma_f32_32x32x16_bf16 v[112:127], a[200:203], v[236:239], v[112:127]
    v_mfma_f32_32x32x16_bf16 v[88:103], a[204:207], v[236:239], v[88:103]
    s_waitcnt vmcnt(5)
    v_mfma_f32_32x32x16_bf16 v[112:127], a[208:211], v[240:243], v[112:127]
    v_mfma_f32_32x32x16_bf16 v[88:103], a[212:215], v[240:243], v[88:103]
    s_waitcnt vmcnt(4)
    v_mfma_f32_32x32x16_bf16 v[112:127], a[216:219], v[244:247], v[112:127]
    v_mfma_f32_32x32x16_bf16 v[88:103], a[220:223], v[244:247], v[88:103]
    s_waitcnt vmcnt(3)
    v_mfma_f32_32x32x16_bf16 v[112:127], a[224:227], v[248:251], v[112:127]
    v_mfma_f32_32x32x16_bf16 v[88:103], a[228:231], v[248:251], v[88:103]
    s_waitcnt vmcnt(2)
    v_mfma_f32_32x32x16_bf16 v[112:127], a[232:235], v[252:255], v[112:127]
    v_mfma_f32_32x32x16_bf16 v[88:103], a[236:239], v[252:255], v[88:103]
    s_waitcnt vmcnt(1)
    v_mfma_f32_32x32x16_bf16 v[112:127], a[240:243], v[136:139], v[112:127]
    v_mfma_f32_32x32x16_bf16 v[88:103], a[244:247], v[136:139], v[88:103]
    s_waitcnt vmcnt(0)
    v_mfma_f32_32x32x16_bf16 v[112:127], a[248:251], v[140:143], v[112:127]
    v_mfma_f32_32x32x16_bf16 v[88:103], a[252:255], v[140:143], v[88:103]
    s_mov_b32 vcc_lo, 0xffff0000
    s_mov_b32 vcc_hi, 0xffff0000
    s_nop 9
    v_cndmask_b32 v112, v112, v88, vcc
    v_cndmask_b32 v113, v113, v89, vcc
    v_cndmask_b32 v114, v114, v90, vcc
    v_cndmask_b32 v115, v115, v91, vcc
    v_cndmask_b32 v116, v116, v92, vcc
    v_cndmask_b32 v117, v117, v93, vcc
    v_cndmask_b32 v118, v118, v94, vcc
    v_cndmask_b32 v119, v119, v95, vcc
    v_cndmask_b32 v120, v120, v96, vcc
    v_cndmask_b32 v121, v121, v97, vcc
    v_cndmask_b32 v122, v122, v98, vcc
    v_cndmask_b32 v123, v123, v99, vcc
    v_cndmask_b32 v124, v124, v100, vcc
    v_cndmask_b32 v125, v125, v101, vcc
    v_cndmask_b32 v126, v126, v102, vcc
    v_cndmask_b32 v127, v127, v103, vcc
    ds_write_b128 v17, v[112:115] offset:0
    ds_write_b128 v17, v[116:119] offset:1024
    ds_write_b128 v17, v[120:123] offset:2048
    ds_write_b128 v17, v[124:127] offset:3072
    s_waitcnt lgkmcnt(0)
    s_barrier
    s_cmp_ge_u32 s16, 2
    s_cbranch_scc1 mega_kernel_x_nxt
    ds_read_b128 v[112:115], v16 offset:0
    ds_read_b128 v[88:91], v16 offset:256
    ds_read_b128 v[116:119], v16 offset:4096
    ds_read_b128 v[92:95], v16 offset:4352
    ds_read_b128 v[120:123], v16 offset:8192
    ds_read_b128 v[96:99], v16 offset:8448
    ds_read_b128 v[124:127], v16 offset:12288
    ds_read_b128 v[100:103], v16 offset:12544
    s_and_b32 s20, s17, 1
    s_lshl_b32 s20, s20, 16
    s_add_u32 s42, s42, s20
    s_waitcnt lgkmcnt(0)
    v_pk_add_f32 v[112:113], v[112:113], v[88:89]
    v_pk_add_f32 v[114:115], v[114:115], v[90:91]
    v_pk_add_f32 v[116:117], v[116:117], v[92:93]
    v_pk_add_f32 v[118:119], v[118:119], v[94:95]
    v_pk_add_f32 v[120:121], v[120:121], v[96:97]
    v_pk_add_f32 v[122:123], v[122:123], v[98:99]
    v_pk_add_f32 v[124:125], v[124:125], v[100:101]
    v_pk_add_f32 v[126:127], v[126:127], v[102:103]
    v_pk_add_f32 v[112:113], v[112:113], v[116:117]
    v_pk_add_f32 v[114:115], v[114:115], v[118:119]
    v_pk_add_f32 v[120:121], v[120:121], v[124:125]
    v_pk_add_f32 v[122:123], v[122:123], v[126:127]
    v_pk_add_f32 v[112:113], v[112:113], v[120:121]
    v_pk_add_f32 v[114:115], v[114:115], v[122:123]
    v_cvt_pk_bf16_f32 v132, v112, v113
    v_cvt_pk_bf16_f32 v133, v114, v115
    buffer_store_dwordx2 v[132:133], v18, s[12:15], s42 offen
mega_kernel_x_nxt:
    s_cmp_eq_u32 s46, 1
    s_cbranch_scc1 mega_kernel_x_att
    s_cmp_lt_u32 s22, 64
    s_cbranch_scc1 mega_kernel_x_ldq
    s_endpgm
.section .rodata,"a"
.p2align 6
.amdhsa_kernel mega_kernel
  .amdhsa_next_free_vgpr 512
  .amdhsa_next_free_sgpr 102
  .amdhsa_accum_offset 256
  .amdhsa_group_segment_fixed_size 0
  .amdhsa_kernarg_size 104
  .amdhsa_user_sgpr_count 2
  .amdhsa_user_sgpr_kernarg_segment_ptr 1
  .amdhsa_system_sgpr_workgroup_id_x 1
.end_amdhsa_kernel
```

```asm
; @launch kernel=mega_kernel grid=(256,1,1) block=(256,1,1) lds=161792
.amdgcn_target "amdgcn-amd-amdhsa--gfx950"
.text
.globl mega_kernel
.p2align 8
.type mega_kernel,@function
mega_kernel:
    s_cmp_ge_u32 s2, 256
    s_cbranch_scc1 mega_kernel_exit
    s_load_dwordx2 s[84:85], s[0:1], 96
    s_load_dwordx2 s[88:89], s[0:1], 88
    s_getreg_b32 s93, hwreg(HW_REG_XCC_ID)
    s_and_b32 s93, s93, 7
    s_lshl_b32 s93, s93, 2
    s_lshr_b32 s93, 0x76543210, s93
    s_and_b32 s93, s93, 7
    v_lshrrev_b32 v1, 6, v0
    v_mov_b32 v4, 0
    v_readfirstlane_b32 s80, v1
    v_mov_b32 v5, 0
    v_mov_b32 v6, 0
    v_mov_b32 v7, 0
    s_mov_b32 s83, 0
    s_lshl_b32 s101, s2, 2
    s_add_u32 s101, s101, s80
    s_lshl_b32 s101, s101, 8
    s_add_u32 s101, s101, 230686720
    s_waitcnt lgkmcnt(0)
    s_mov_b32 s86, 268435456
    s_mov_b32 s87, 0x00020000
    s_mov_b32 s90, 256
    s_mov_b32 s91, 0x00020000
    s_mov_b32 s98, s80
    s_cmp_lg_u32 s80, 0
    s_cbranch_scc1 mega_kernel_st0
    v_mov_b32 v10, 1
    s_lshl_b32 s81, s93, 5
    s_mov_b64 exec, 1
    buffer_atomic_add v10, off, s[88:91], s81 offset:4 sc0
    s_lshl_b32 s81, s2, 7
    s_add_u32 s81, s81, 71303168
    s_mov_b64 exec, 3
    v_lshlrev_b32 v1, 15, v0
    buffer_store_dword v4, v1, s[84:87], s81 offen sc1
    s_mov_b64 exec, -1
mega_kernel_st0:
    s_load_dwordx2 s[72:73], s[0:1], 8
    v_mov_b32 v4, 0
    v_mov_b32 v5, 0
    v_mov_b32 v6, 0
    v_mov_b32 v7, 0
    v_lshlrev_b32 v1, 4, v0
    s_lshl_b32 s81, s2, 13
    s_add_u32 s81, s81, 67108864
    s_add_u32 s79, s81, 4096
    buffer_store_dwordx4 v[4:7], v1, s[84:87], s81 offen sc1
    buffer_store_dwordx4 v[4:7], v1, s[84:87], s79 offen sc1
    s_lshl_b32 s81, s2, 12
    s_add_u32 s81, s81, 70254592
    buffer_store_dwordx4 v[4:7], v1, s[84:87], s81 offen sc1
    s_cmp_ge_u32 s2, 64
    s_cbranch_scc1 mega_kernel_gi
    v_bfe_u32 v2, v0, 3, 1
    v_lshlrev_b32 v2, 11, v2
    v_and_b32 v3, 3, v0
    v_lshl_add_u32 v2, v3, 5, v2
    v_bfe_u32 v3, v0, 4, 3
    v_lshl_add_u32 v2, v3, 2, v2
    v_bfe_u32 v3, v0, 2, 1
    v_lshl_add_u32 v2, v3, 1, v2
    s_lshr_b32 s81, s2, 2
    s_lshl_b32 s81, s81, 7
    s_and_b32 s79, s2, 3
    s_lshl_b32 s79, s79, 12
    s_add_u32 s81, s81, s79
    s_waitcnt lgkmcnt(0)
    s_mov_b32 s74, 16384
    s_mov_b32 s75, 0x00020000
    buffer_load_ushort v8, v2, s[72:75], s81 offen
    v_mov_b32 v9, -1
    v_and_b32 v1, 31, v0
    v_lshlrev_b32 v1, 1, v1
    v_bfe_u32 v3, v0, 5, 2
    v_lshl_add_u32 v1, v3, 8, v1
    v_lshrrev_b32 v3, 7, v0
    v_lshl_add_u32 v1, v3, 14, v1
    v_cmp_gt_u32 vcc, 128, v0
    s_lshr_b32 s81, s2, 2
    s_lshl_b32 s81, s81, 10
    s_and_b32 s79, s2, 3
    s_lshl_b32 s79, s79, 6
    s_add_u32 s81, s81, s79
    s_add_u32 s81, s81, 69206016
    s_waitcnt vmcnt(0)
    v_min_u32 v8, 0xfffe, v8
    v_cndmask_b32 v8, v9, v8, vcc
    buffer_store_short v8, v1, s[84:87], s81 offen sc1
mega_kernel_gi:
    s_waitcnt lgkmcnt(0)
    s_cmp_lg_u32 s80, 0
    s_cbranch_scc1 mega_kernel_st1
    s_mov_b64 exec, 1
    s_waitcnt vmcnt(4)
    ds_write_b32 v4, v10
    s_mov_b64 exec, -1
    s_waitcnt lgkmcnt(0)
mega_kernel_st1:
    s_barrier
    ds_read_b32 v2, v4
    s_waitcnt lgkmcnt(0)
    v_readfirstlane_b32 s94, v2
    s_barrier
    s_sub_u32 s81, s93, 2
    s_cmp_ge_u32 s81, 2
    s_cbranch_scc1 mega_kernel_nopr
    s_cmp_lg_u32 s80, 0
    s_cbranch_scc1 mega_kernel_prd
    v_lshlrev_b32 v1, 4, v0
    s_and_b32 s81, s2, 127
    s_lshl_b32 s81, s81, 14
    s_add_u32 s81, s81, 67108864
    s_add_u32 s77, s81, 8192
    buffer_store_dwordx4 v[4:7], v1, s[84:87], s81 offen sc1
    buffer_store_dwordx4 v[4:7], v1, s[84:87], s77 offen sc1
    s_waitcnt vmcnt(0)
    s_memtime s[70:71]
    buffer_store_dwordx4 v[4:7], v1, s[84:87], s81 offen sc1
    s_waitcnt vmcnt(0)
    s_memtime s[72:73]
    buffer_store_dwordx4 v[4:7], v1, s[84:87], s77 offen sc1
    s_waitcnt vmcnt(0)
    buffer_store_dwordx4 v[4:7], v1, s[84:87], s77 offen sc1
    s_waitcnt vmcnt(0)
    s_memtime s[74:75]
    buffer_store_dwordx4 v[4:7], v1, s[84:87], s81 offen sc1
    s_waitcnt vmcnt(0)
    s_memtime s[76:77]
    s_waitcnt lgkmcnt(0)
    s_sub_u32 s76, s76, s74
    s_sub_u32 s74, s74, s72
    s_sub_u32 s72, s72, s70
    s_add_u32 s72, s72, s76
    s_cmp_lt_u32 s74, s72
    s_cselect_b32 s81, 0x10001, 1
    v_mov_b32 v8, s81
    s_mov_b64 exec, 1
    buffer_atomic_add v8, off, s[88:91], 0 offset:204 sc1
    s_mov_b64 exec, -1
mega_kernel_prd:
    s_barrier
mega_kernel_nopr:
    s_mov_b32 s97, 0
    s_mov_b32 s100, 64
mega_kernel_fast:
    s_mov_b32 s96, 1
    s_mov_b32 s30, s93
    s_and_b32 s31, s94, 31
    s_cmp_lt_u32 s93, 2
    s_cbranch_scc1 mega_kernel_recf
    s_sub_u32 s92, s93, 2
    s_lshl_b32 s92, s92, 5
    s_add_u32 s92, s92, s31
    s_branch mega_kernel_bulk
mega_kernel_redo:
    s_waitcnt vmcnt(0) lgkmcnt(0)
    s_barrier
    v_readlane_b32 s100, v252, 2
    v_readlane_b32 s81, v252, 3
    s_mov_b32 s97, 1
    s_nop 2
    s_add_u32 s100, s100, s81
    s_mov_b32 s95, s94
    v_readlane_b32 s81, v252, 0
    s_cmp_gt_u32 s93, 0
    s_nop 2
    s_cselect_b32 s81, s81, 0
    s_add_u32 s95, s95, s81
    v_readlane_b32 s81, v252, 1
    s_cmp_gt_u32 s93, 1
    s_nop 2
    s_cselect_b32 s81, s81, 0
    s_add_u32 s95, s95, s81
    v_readlane_b32 s81, v252, 2
    s_cmp_gt_u32 s93, 2
    s_nop 2
    s_cselect_b32 s81, s81, 0
    s_add_u32 s95, s95, s81
    v_readlane_b32 s81, v252, 3
    s_cmp_gt_u32 s93, 3
    s_nop 2
    s_cselect_b32 s81, s81, 0
    s_add_u32 s95, s95, s81
    v_readlane_b32 s81, v252, 4
    s_cmp_gt_u32 s93, 4
    s_nop 2
    s_cselect_b32 s81, s81, 0
    s_add_u32 s95, s95, s81
    v_readlane_b32 s81, v252, 5
    s_cmp_gt_u32 s93, 5
    s_nop 2
    s_cselect_b32 s81, s81, 0
    s_add_u32 s95, s95, s81
    v_readlane_b32 s81, v252, 6
    s_cmp_gt_u32 s93, 6
    s_nop 2
    s_cselect_b32 s81, s81, 0
    s_add_u32 s95, s95, s81
mega_kernel_slow:
    s_mov_b32 s96, 0
    s_lshr_b32 s30, s95, 5
    s_and_b32 s31, s95, 31
    s_cmp_lt_u32 s95, 64
    s_cbranch_scc1 mega_kernel_recs
    s_sub_u32 s92, s95, 64
    s_branch mega_kernel_bulk
mega_kernel_exit:
    s_endpgm
mega_kernel_recf:
    s_load_dwordx2 s[4:5], s[0:1], 96
    s_load_dwordx2 s[12:13], s[0:1], 88
    s_load_dwordx2 s[50:51], s[0:1], 16
    s_load_dwordx2 s[52:53], s[0:1], 24
    s_load_dwordx2 s[54:55], s[0:1], 32
    s_load_dwordx2 s[56:57], s[0:1], 40
    s_load_dwordx2 s[58:59], s[0:1], 8
    v_lshrrev_b32 v3, 6, v0
    v_and_b32 v40, 63, v0
    v_readfirstlane_b32 s20, v3
    v_lshrrev_b32 v41, 4, v40
    v_and_b32 v42, 15, v40
    v_lshlrev_b32 v1, 4, v40
    s_mov_b32 s49, 0
    s_waitcnt lgkmcnt(0)
    s_mov_b32 s6, 268435456
    s_mov_b32 s7, 0x00020000
    s_mov_b32 s14, 256
    s_mov_b32 s15, 0x00020000
    s_mov_b32 s10, 8388608
    s_mov_b32 s11, 0x00020000
    s_mov_b32 s26, 0x00030003
    s_mov_b32 s27, 0x00030003
    s_mov_b32 s28, 0xcccccccc
    s_mov_b32 s29, 0xcccccccc
    s_mov_b32 s32, 0x33333333
    s_mov_b32 s33, 0x33333333
    s_mov_b32 s34, 0x3e0293ee
    s_lshl_b32 s22, s20, 2
    v_xor_b32 v3, s22, v42
    v_lshlrev_b32 v3, 4, v3
    v_lshl_add_u32 v4, v41, 4, s20
    v_lshl_add_u32 v44, v4, 13, v3
    s_lshl_b32 s22, s30, 22
    s_lshl_b32 s23, s31, 8
    s_add_u32 s22, s22, s23
    v_add_u32 v44, s22, v44
    s_lshr_b32 s22, s20, 1
    s_lshl_b32 s22, s22, 5
    s_and_b32 s23, s20, 1
    s_lshl_b32 s23, s23, 2
    s_add_u32 s22, s22, s23
    s_lshl_b32 s23, s31, 7
    s_add_u32 s22, s22, s23
    v_add_u32 v4, s22, v41
    v_lshl_add_u32 v45, v4, 11, v3
    s_lshl_b32 s22, s30, 10
    v_add_u32 v45, s22, v45
    s_lshl_b32 s48, s20, 10
    s_mov_b32 s8, s50
    s_mov_b32 s9, s51
    s_add_u32 m0, s48, 0
    s_mov_b32 s22, 0
    buffer_load_dwordx4 v44, s[8:11], s22 offen  lds
    s_add_u32 m0, s48, 4096
    s_mov_b32 s22, 32768
    buffer_load_dwordx4 v44, s[8:11], s22 offen  lds
    s_add_u32 m0, s48, 8192
    s_mov_b32 s22, 65536
    buffer_load_dwordx4 v44, s[8:11], s22 offen  lds
    s_add_u32 m0, s48, 12288
    s_mov_b32 s22, 98304
    buffer_load_dwordx4 v44, s[8:11], s22 offen  lds
    s_add_u32 m0, s48, 16384
    s_mov_b32 s22, 524288
    buffer_load_dwordx4 v44, s[8:11], s22 offen  lds
    s_add_u32 m0, s48, 20480
    s_mov_b32 s22, 557056
    buffer_load_dwordx4 v44, s[8:11], s22 offen  lds
    s_add_u32 m0, s48, 24576
    s_mov_b32 s22, 589824
    buffer_load_dwordx4 v44, s[8:11], s22 offen  lds
    s_add_u32 m0, s48, 28672
    s_mov_b32 s22, 622592
    buffer_load_dwordx4 v44, s[8:11], s22 offen  lds
    s_add_u32 m0, s48, 32768
    s_mov_b32 s22, 1048576
    buffer_load_dwordx4 v44, s[8:11], s22 offen  lds
    s_add_u32 m0, s48, 36864
    s_mov_b32 s22, 1081344
    buffer_load_dwordx4 v44, s[8:11], s22 offen  lds
    s_add_u32 m0, s48, 40960
    s_mov_b32 s22, 1114112
    buffer_load_dwordx4 v44, s[8:11], s22 offen  lds
    s_add_u32 m0, s48, 45056
    s_mov_b32 s22, 1146880
    buffer_load_dwordx4 v44, s[8:11], s22 offen  lds
    s_waitcnt vmcnt(12)
    s_barrier
    s_or_b32 s81, s97, s98
    s_cmp_lg_u32 s81, 0
    s_cbranch_scc1 mega_kernel_h0_1
    s_lshl_b32 s81, s93, 5
    v_mov_b32 v250, 1
    s_mov_b64 exec, 1
    buffer_atomic_add v250, off, s[88:91], s81 sc1
    s_mov_b64 exec, -1
mega_kernel_h0_1:
    s_add_u32 m0, s48, 49152
    s_mov_b32 s22, 1572864
    buffer_load_dwordx4 v44, s[8:11], s22 offen  lds
    s_add_u32 m0, s48, 53248
    s_mov_b32 s22, 1605632
    buffer_load_dwordx4 v44, s[8:11], s22 offen  lds
    s_add_u32 m0, s48, 57344
    s_mov_b32 s22, 1638400
    buffer_load_dwordx4 v44, s[8:11], s22 offen  lds
    s_add_u32 m0, s48, 61440
    s_mov_b32 s22, 1671168
    buffer_load_dwordx4 v44, s[8:11], s22 offen  lds
    s_add_u32 m0, s48, 65536
    s_mov_b32 s22, 2097152
    buffer_load_dwordx4 v44, s[8:11], s22 offen  lds
    s_add_u32 m0, s48, 69632
    s_mov_b32 s22, 2129920
    buffer_load_dwordx4 v44, s[8:11], s22 offen  lds
    s_add_u32 m0, s48, 73728
    s_mov_b32 s22, 2162688
    buffer_load_dwordx4 v44, s[8:11], s22 offen  lds
    s_add_u32 m0, s48, 77824
    s_mov_b32 s22, 2195456
    buffer_load_dwordx4 v44, s[8:11], s22 offen  lds
    s_add_u32 m0, s48, 81920
    s_mov_b32 s22, 2621440
    buffer_load_dwordx4 v44, s[8:11], s22 offen  lds
    s_add_u32 m0, s48, 86016
    s_mov_b32 s22, 2654208
    buffer_load_dwordx4 v44, s[8:11], s22 offen  lds
    s_add_u32 m0, s48, 90112
    s_mov_b32 s22, 2686976
    buffer_load_dwordx4 v44, s[8:11], s22 offen  lds
    s_add_u32 m0, s48, 94208
    s_mov_b32 s22, 2719744
    buffer_load_dwordx4 v44, s[8:11], s22 offen  lds
    s_add_u32 m0, s48, 98304
    s_mov_b32 s22, 3145728
    buffer_load_dwordx4 v44, s[8:11], s22 offen  lds
    s_add_u32 m0, s48, 102400
    s_mov_b32 s22, 3178496
    buffer_load_dwordx4 v44, s[8:11], s22 offen  lds
    s_add_u32 m0, s48, 106496
    s_mov_b32 s22, 3211264
    buffer_load_dwordx4 v44, s[8:11], s22 offen  lds
    s_add_u32 m0, s48, 110592
    s_mov_b32 s22, 3244032
    buffer_load_dwordx4 v44, s[8:11], s22 offen  lds
    s_add_u32 m0, s48, 114688
    s_mov_b32 s22, 3670016
    buffer_load_dwordx4 v44, s[8:11], s22 offen  lds
    s_add_u32 m0, s48, 118784
    s_mov_b32 s22, 3702784
    buffer_load_dwordx4 v44, s[8:11], s22 offen  lds
    s_add_u32 m0, s48, 122880
    s_mov_b32 s22, 3735552
    buffer_load_dwordx4 v44, s[8:11], s22 offen  lds
    s_add_u32 m0, s48, 126976
    s_mov_b32 s22, 3768320
    buffer_load_dwordx4 v44, s[8:11], s22 offen  lds
    s_lshl_b32 s22, s30, 5
    s_add_u32 s22, s22, s31
    s_lshl_b32 s38, s22, 14
    s_xor_b32 s22, s22, 32
    s_lshl_b32 s37, s22, 14
    s_add_u32 s38, s38, 67108864
    s_add_u32 s37, s37, 67108864
    s_lshl_b32 s46, s30, 19
    s_add_u32 s46, s46, 70254592
    s_mul_i32 s22, s31, 8448
    s_add_u32 s47, s46, s22
    s_mul_i32 s22, s20, 67584
    s_add_u32 s46, s46, s22
    s_lshl_b32 s22, s31, 6
    s_add_u32 s46, s46, s22
    s_add_u32 s61, s46, 33792
    s_mul_i32 s22, s20, 2048
    s_add_u32 s25, s47, s22
    s_lshl_b32 s35, s30, 13
    s_add_u32 s35, s35, 69206016
    v_lshrrev_b32 v53, 2, v42
    v_lshlrev_b32 v53, 1, v53
    v_and_b32 v54, 1, v42
    v_add_u32 v55, v53, v54
    v_mov_b32 v14, 0
    v_mov_b32 v15, 0
    v_mov_b32 v2, 0x4444
    v_mov_b32 v3, 0xeeee
    v_cndmask_b32 v2, v2, v3, s[28:29]
    s_lshl_b32 s22, s20, 12
    v_add_u32 v32, s22, v1
    v_add_u32 v33, 0x10000, v32
    v_add_u32 v5, 0x10000, v1
    v_add_u32 v6, 131072, v1
    v_and_b32 v3, 3, v42
    v_bfe_u32 v43, v40, 1, 1
    v_lshlrev_b32 v7, 13, v43
    v_and_b32 v43, 1, v40
    v_lshl_add_u32 v7, v43, 7, v7
    s_lshl_b32 s22, s31, 8
    s_add_u32 s23, s22, 71311360
    v_add_u32 v7, s23, v7
    s_cmp_lg_u32 s20, 0
    s_cbranch_scc1 mega_kernel_rf_flk
    s_lshl_b32 s23, s30, 7
    s_add_u32 s22, s22, s23
    s_add_u32 s22, s22, 71327744
    v_bfrev_b32 v7, 1
    v_writelane_b32 v7, s22, 0
mega_kernel_rf_flk:
    v_lshlrev_b32 v11, 3, v40
    v_lshlrev_b32 v10, 8, v55
    v_lshl_add_u32 v10, v41, 4, v10
    v_mul_u32_u24 v8, 8448, v41
    v_lshl_add_u32 v8, v3, 4, v8
    v_lshrrev_b32 v4, 2, v42
    v_mul_u32_u24 v4, 2048, v4
    v_add_u32 v8, v4, v8
    v_lshrrev_b32 v9, 1, v41
    v_lshlrev_b32 v9, 5, v9
    v_and_b32 v4, 1, v42
    v_lshl_add_u32 v9, v4, 4, v9
    v_and_b32 v4, 1, v41
    v_lshl_add_u32 v9, v4, 3, v9
    s_lshr_b32 s22, s31, 2
    s_lshl_b32 s22, s22, 10
    s_and_b32 s23, s31, 3
    s_lshl_b32 s23, s23, 6
    s_add_u32 s22, s22, s23
    v_add_u32 v9, s22, v9
    v_lshrrev_b32 v4, 2, v42
    v_lshlrev_b32 v12, 8, v4
    v_lshl_add_u32 v12, v41, 6, v12
    v_lshl_add_u32 v12, v3, 4, v12
    v_lshlrev_b32 v13, 6, v41
    v_lshl_add_u32 v13, v42, 2, v13
    v_cmp_eq_u32 vcc, 0, v3
    v_mov_b32 v28, 0x3f803f80
    v_mov_b32 v29, 0x3f803f80
    v_cndmask_b32 v34, 0, 1, vcc
    v_mov_b32 v30, 0x3f803f80
    v_mov_b32 v31, 0x3f803f80
    v_and_b32 v49, 1, v42
    v_lshlrev_b32 v49, 4, v49
    v_mov_b32 v50, 0x3f80
    v_lshlrev_b32 v50, v49, v50
    v_lshrrev_b32 v51, 2, v42
    v_cmp_eq_u32 vcc, v51, v41
    v_mov_b32 v24, v50
    v_cndmask_b32 v52, 0, v50, s[28:29]
    v_cndmask_b32 v53, 0, v50, s[32:33]
    v_cndmask_b32 v16, 0, v52, vcc
    v_cndmask_b32 v17, 0, v53, vcc
    v_mov_b32 v25, v50
    v_mov_b32 v26, v50
    v_mov_b32 v27, v50
    v_bfe_u32 v60, v40, 3, 1
    v_bfe_u32 v49, v40, 2, 1
    v_and_b32 v50, 1, v41
    v_lshrrev_b32 v51, 1, v41
    v_lshlrev_b32 v52, 3, v60
    v_lshl_add_u32 v52, v50, 2, v52
    v_lshl_add_u32 v53, v51, 4, v52
    v_add_u32 v53, v53, v49
    v_and_b32 v54, 3, v40
    s_lshl_b32 s22, s20, 2
    v_add_u32 v55, s22, v54
    v_xor_b32 v55, v55, v52
    v_lshlrev_b32 v55, 4, v55
    v_lshl_add_u32 v46, v53, 8, v55
    v_lshlrev_b32 v55, 4, v52
    v_lshl_add_u32 v55, v54, 3, v55
    v_lshl_add_u32 v47, v53, 8, v55
    s_waitcnt vmcnt(28)
    s_barrier
    v_add_u32 v48, 0, v46
    ds_read_b64_tr_b16 a[0:1], v48 offset:0
    ds_read_b64_tr_b16 a[2:3], v48 offset:512
    ds_read_b64_tr_b16 a[4:5], v48 offset:8192
    ds_read_b64_tr_b16 a[6:7], v48 offset:8704
    ds_read_b64_tr_b16 a[8:9], v48 offset:8
    ds_read_b64_tr_b16 a[10:11], v48 offset:520
    ds_read_b64_tr_b16 a[12:13], v48 offset:8200
    ds_read_b64_tr_b16 a[14:15], v48 offset:8712
    s_waitcnt lgkmcnt(0)
    s_barrier
    s_mov_b32 s8, s52
    s_mov_b32 s9, s53
    s_add_u32 m0, s48, 0
    s_mov_b32 s22, 0
    buffer_load_dwordx4 v44, s[8:11], s22 offen  lds
    s_add_u32 m0, s48, 4096
    s_mov_b32 s22, 32768
    buffer_load_dwordx4 v44, s[8:11], s22 offen  lds
    s_add_u32 m0, s48, 8192
    s_mov_b32 s22, 65536
    buffer_load_dwordx4 v44, s[8:11], s22 offen  lds
    s_add_u32 m0, s48, 12288
    s_mov_b32 s22, 98304
    buffer_load_dwordx4 v44, s[8:11], s22 offen  lds
    s_waitcnt vmcnt(28)
    s_barrier
    v_add_u32 v48, 16384, v46
    ds_read_b64_tr_b16 a[16:17], v48 offset:0
    ds_read_b64_tr_b16 a[18:19], v48 offset:512
    ds_read_b64_tr_b16 a[20:21], v48 offset:8192
    ds_read_b64_tr_b16 a[22:23], v48 offset:8704
    ds_read_b64_tr_b16 a[24:25], v48 offset:8
    ds_read_b64_tr_b16 a[26:27], v48 offset:520
    ds_read_b64_tr_b16 a[28:29], v48 offset:8200
    ds_read_b64_tr_b16 a[30:31], v48 offset:8712
    s_waitcnt lgkmcnt(0)
    s_barrier
    s_add_u32 m0, s48, 16384
    s_mov_b32 s22, 524288
    buffer_load_dwordx4 v44, s[8:11], s22 offen  lds
    s_add_u32 m0, s48, 20480
    s_mov_b32 s22, 557056
    buffer_load_dwordx4 v44, s[8:11], s22 offen  lds
    s_add_u32 m0, s48, 24576
    s_mov_b32 s22, 589824
    buffer_load_dwordx4 v44, s[8:11], s22 offen  lds
    s_add_u32 m0, s48, 28672
    s_mov_b32 s22, 622592
    buffer_load_dwordx4 v44, s[8:11], s22 offen  lds
    s_waitcnt vmcnt(28)
    s_barrier
    v_add_u32 v48, 32768, v46
    ds_read_b64_tr_b16 a[32:33], v48 offset:0
    ds_read_b64_tr_b16 a[34:35], v48 offset:512
    ds_read_b64_tr_b16 a[36:37], v48 offset:8192
    ds_read_b64_tr_b16 a[38:39], v48 offset:8704
    ds_read_b64_tr_b16 a[40:41], v48 offset:8
    ds_read_b64_tr_b16 a[42:43], v48 offset:520
    ds_read_b64_tr_b16 a[44:45], v48 offset:8200
    ds_read_b64_tr_b16 a[46:47], v48 offset:8712
    s_waitcnt lgkmcnt(0)
    s_barrier
    s_add_u32 m0, s48, 32768
    s_mov_b32 s22, 1048576
    buffer_load_dwordx4 v44, s[8:11], s22 offen  lds
    s_add_u32 m0, s48, 36864
    s_mov_b32 s22, 1081344
    buffer_load_dwordx4 v44, s[8:11], s22 offen  lds
    s_add_u32 m0, s48, 40960
    s_mov_b32 s22, 1114112
    buffer_load_dwordx4 v44, s[8:11], s22 offen  lds
    s_add_u32 m0, s48, 45056
    s_mov_b32 s22, 1146880
    buffer_load_dwordx4 v44, s[8:11], s22 offen  lds
    s_waitcnt vmcnt(28)
    s_barrier
    v_add_u32 v48, 49152, v46
    ds_read_b64_tr_b16 a[48:49], v48 offset:0
    ds_read_b64_tr_b16 a[50:51], v48 offset:512
    ds_read_b64_tr_b16 a[52:53], v48 offset:8192
    ds_read_b64_tr_b16 a[54:55], v48 offset:8704
    ds_read_b64_tr_b16 a[56:57], v48 offset:8
    ds_read_b64_tr_b16 a[58:59], v48 offset:520
    ds_read_b64_tr_b16 a[60:61], v48 offset:8200
    ds_read_b64_tr_b16 a[62:63], v48 offset:8712
    s_waitcnt lgkmcnt(0)
    s_barrier
    s_add_u32 m0, s48, 49152
    s_mov_b32 s22, 1572864
    buffer_load_dwordx4 v44, s[8:11], s22 offen  lds
    s_add_u32 m0, s48, 53248
    s_mov_b32 s22, 1605632
    buffer_load_dwordx4 v44, s[8:11], s22 offen  lds
    s_add_u32 m0, s48, 57344
    s_mov_b32 s22, 1638400
    buffer_load_dwordx4 v44, s[8:11], s22 offen  lds
    s_add_u32 m0, s48, 61440
    s_mov_b32 s22, 1671168
    buffer_load_dwordx4 v44, s[8:11], s22 offen  lds
    s_waitcnt vmcnt(28)
    s_barrier
    v_add_u32 v48, 65536, v46
    ds_read_b64_tr_b16 a[64:65], v48 offset:0
    ds_read_b64_tr_b16 a[66:67], v48 offset:512
    ds_read_b64_tr_b16 a[68:69], v48 offset:8192
    ds_read_b64_tr_b16 a[70:71], v48 offset:8704
    ds_read_b64_tr_b16 a[72:73], v48 offset:8
    ds_read_b64_tr_b16 a[74:75], v48 offset:520
    ds_read_b64_tr_b16 a[76:77], v48 offset:8200
    ds_read_b64_tr_b16 a[78:79], v48 offset:8712
    s_waitcnt lgkmcnt(0)
    s_barrier
    s_add_u32 m0, s48, 65536
    s_mov_b32 s22, 2097152
    buffer_load_dwordx4 v44, s[8:11], s22 offen  lds
    s_add_u32 m0, s48, 69632
    s_mov_b32 s22, 2129920
    buffer_load_dwordx4 v44, s[8:11], s22 offen  lds
    s_add_u32 m0, s48, 73728
    s_mov_b32 s22, 2162688
    buffer_load_dwordx4 v44, s[8:11], s22 offen  lds
    s_add_u32 m0, s48, 77824
    s_mov_b32 s22, 2195456
    buffer_load_dwordx4 v44, s[8:11], s22 offen  lds
    s_waitcnt vmcnt(28)
    s_barrier
    v_add_u32 v48, 81920, v46
    ds_read_b64_tr_b16 a[80:81], v48 offset:0
    ds_read_b64_tr_b16 a[82:83], v48 offset:512
    ds_read_b64_tr_b16 a[84:85], v48 offset:8192
    ds_read_b64_tr_b16 a[86:87], v48 offset:8704
    ds_read_b64_tr_b16 a[88:89], v48 offset:8
    ds_read_b64_tr_b16 a[90:91], v48 offset:520
    ds_read_b64_tr_b16 a[92:93], v48 offset:8200
    ds_read_b64_tr_b16 a[94:95], v48 offset:8712
    s_waitcnt lgkmcnt(0)
    s_barrier
    s_add_u32 m0, s48, 81920
    s_mov_b32 s22, 2621440
    buffer_load_dwordx4 v44, s[8:11], s22 offen  lds
    s_add_u32 m0, s48, 86016
    s_mov_b32 s22, 2654208
    buffer_load_dwordx4 v44, s[8:11], s22 offen  lds
    s_add_u32 m0, s48, 90112
    s_mov_b32 s22, 2686976
    buffer_load_dwordx4 v44, s[8:11], s22 offen  lds
    s_add_u32 m0, s48, 94208
    s_mov_b32 s22, 2719744
    buffer_load_dwordx4 v44, s[8:11], s22 offen  lds
    s_waitcnt vmcnt(28)
    s_barrier
    v_add_u32 v48, 98304, v46
    ds_read_b64_tr_b16 a[96:97], v48 offset:0
    ds_read_b64_tr_b16 a[98:99], v48 offset:512
    ds_read_b64_tr_b16 a[100:101], v48 offset:8192
    ds_read_b64_tr_b16 a[102:103], v48 offset:8704
    ds_read_b64_tr_b16 a[104:105], v48 offset:8
    ds_read_b64_tr_b16 a[106:107], v48 offset:520
    ds_read_b64_tr_b16 a[108:109], v48 offset:8200
    ds_read_b64_tr_b16 a[110:111], v48 offset:8712
    s_waitcnt lgkmcnt(0)
    s_barrier
    s_add_u32 m0, s48, 98304
    s_mov_b32 s22, 3145728
    buffer_load_dwordx4 v44, s[8:11], s22 offen  lds
    s_add_u32 m0, s48, 102400
    s_mov_b32 s22, 3178496
    buffer_load_dwordx4 v44, s[8:11], s22 offen  lds
    s_add_u32 m0, s48, 106496
    s_mov_b32 s22, 3211264
    buffer_load_dwordx4 v44, s[8:11], s22 offen  lds
    s_add_u32 m0, s48, 110592
    s_mov_b32 s22, 3244032
    buffer_load_dwordx4 v44, s[8:11], s22 offen  lds
    s_waitcnt vmcnt(28)
    s_barrier
    v_add_u32 v48, 114688, v46
    ds_read_b64_tr_b16 a[112:113], v48 offset:0
    ds_read_b64_tr_b16 a[114:115], v48 offset:512
    ds_read_b64_tr_b16 a[116:117], v48 offset:8192
    ds_read_b64_tr_b16 a[118:119], v48 offset:8704
    ds_read_b64_tr_b16 a[120:121], v48 offset:8
    ds_read_b64_tr_b16 a[122:123], v48 offset:520
    ds_read_b64_tr_b16 a[124:125], v48 offset:8200
    ds_read_b64_tr_b16 a[126:127], v48 offset:8712
    s_waitcnt lgkmcnt(0)
    s_barrier
    s_add_u32 m0, s48, 114688
    s_mov_b32 s22, 3670016
    buffer_load_dwordx4 v44, s[8:11], s22 offen  lds
    s_add_u32 m0, s48, 118784
    s_mov_b32 s22, 3702784
    buffer_load_dwordx4 v44, s[8:11], s22 offen  lds
    s_add_u32 m0, s48, 122880
    s_mov_b32 s22, 3735552
    buffer_load_dwordx4 v44, s[8:11], s22 offen  lds
    s_add_u32 m0, s48, 126976
    s_mov_b32 s22, 3768320
    buffer_load_dwordx4 v44, s[8:11], s22 offen  lds
    s_waitcnt vmcnt(28)
    s_barrier
    v_add_u32 v48, 0, v46
    ds_read_b64_tr_b16 a[128:129], v48 offset:0
    ds_read_b64_tr_b16 a[130:131], v48 offset:512
    ds_read_b64_tr_b16 a[132:133], v48 offset:8192
    ds_read_b64_tr_b16 a[134:135], v48 offset:8704
    ds_read_b64_tr_b16 a[136:137], v48 offset:8
    ds_read_b64_tr_b16 a[138:139], v48 offset:520
    ds_read_b64_tr_b16 a[140:141], v48 offset:8200
    ds_read_b64_tr_b16 a[142:143], v48 offset:8712
    s_waitcnt lgkmcnt(0)
    s_barrier
    s_mov_b32 s8, s56
    s_mov_b32 s9, s57
    s_add_u32 m0, s48, 0
    s_mov_b32 s22, 0
    buffer_load_dwordx4 v45, s[8:11], s22 offen  lds
    s_add_u32 m0, s48, 4096
    s_mov_b32 s22, 16384
    buffer_load_dwordx4 v45, s[8:11], s22 offen  lds
    s_add_u32 m0, s48, 8192
    s_mov_b32 s22, 32768
    buffer_load_dwordx4 v45, s[8:11], s22 offen  lds
    s_add_u32 m0, s48, 12288
    s_mov_b32 s22, 49152
    buffer_load_dwordx4 v45, s[8:11], s22 offen  lds
    s_waitcnt vmcnt(28)
    s_barrier
    v_add_u32 v48, 16384, v46
    ds_read_b64_tr_b16 a[144:145], v48 offset:0
    ds_read_b64_tr_b16 a[146:147], v48 offset:512
    ds_read_b64_tr_b16 a[148:149], v48 offset:8192
    ds_read_b64_tr_b16 a[150:151], v48 offset:8704
    ds_read_b64_tr_b16 a[152:153], v48 offset:8
    ds_read_b64_tr_b16 a[154:155], v48 offset:520
    ds_read_b64_tr_b16 a[156:157], v48 offset:8200
    ds_read_b64_tr_b16 a[158:159], v48 offset:8712
    s_waitcnt lgkmcnt(0)
    s_barrier
    s_add_u32 m0, s48, 16384
    s_mov_b32 s22, 256
    buffer_load_dwordx4 v45, s[8:11], s22 offen  lds
    s_add_u32 m0, s48, 20480
    s_mov_b32 s22, 16640
    buffer_load_dwordx4 v45, s[8:11], s22 offen  lds
    s_add_u32 m0, s48, 24576
    s_mov_b32 s22, 33024
    buffer_load_dwordx4 v45, s[8:11], s22 offen  lds
    s_add_u32 m0, s48, 28672
    s_mov_b32 s22, 49408
    buffer_load_dwordx4 v45, s[8:11], s22 offen  lds
    s_waitcnt vmcnt(28)
    s_barrier
    v_add_u32 v48, 32768, v46
    ds_read_b64_tr_b16 a[160:161], v48 offset:0
    ds_read_b64_tr_b16 a[162:163], v48 offset:512
    ds_read_b64_tr_b16 a[164:165], v48 offset:8192
    ds_read_b64_tr_b16 a[166:167], v48 offset:8704
    ds_read_b64_tr_b16 a[168:169], v48 offset:8
    ds_read_b64_tr_b16 a[170:171], v48 offset:520
    ds_read_b64_tr_b16 a[172:173], v48 offset:8200
    ds_read_b64_tr_b16 a[174:175], v48 offset:8712
    s_waitcnt lgkmcnt(0)
    s_barrier
    s_add_u32 m0, s48, 32768
    s_mov_b32 s22, 512
    buffer_load_dwordx4 v45, s[8:11], s22 offen  lds
    s_add_u32 m0, s48, 36864
    s_mov_b32 s22, 16896
    buffer_load_dwordx4 v45, s[8:11], s22 offen  lds
    s_add_u32 m0, s48, 40960
    s_mov_b32 s22, 33280
    buffer_load_dwordx4 v45, s[8:11], s22 offen  lds
    s_add_u32 m0, s48, 45056
    s_mov_b32 s22, 49664
    buffer_load_dwordx4 v45, s[8:11], s22 offen  lds
    s_waitcnt vmcnt(28)
    s_barrier
    v_add_u32 v48, 49152, v46
    ds_read_b64_tr_b16 a[176:177], v48 offset:0
    ds_read_b64_tr_b16 a[178:179], v48 offset:512
    ds_read_b64_tr_b16 a[180:181], v48 offset:8192
    ds_read_b64_tr_b16 a[182:183], v48 offset:8704
    ds_read_b64_tr_b16 a[184:185], v48 offset:8
    ds_read_b64_tr_b16 a[186:187], v48 offset:520
    ds_read_b64_tr_b16 a[188:189], v48 offset:8200
    ds_read_b64_tr_b16 a[190:191], v48 offset:8712
    s_waitcnt lgkmcnt(0)
    s_barrier
    s_add_u32 m0, s48, 49152
    s_mov_b32 s22, 768
    buffer_load_dwordx4 v45, s[8:11], s22 offen  lds
    s_add_u32 m0, s48, 53248
    s_mov_b32 s22, 17152
    buffer_load_dwordx4 v45, s[8:11], s22 offen  lds
    s_add_u32 m0, s48, 57344
    s_mov_b32 s22, 33536
    buffer_load_dwordx4 v45, s[8:11], s22 offen  lds
    s_add_u32 m0, s48, 61440
    s_mov_b32 s22, 49920
    buffer_load_dwordx4 v45, s[8:11], s22 offen  lds
    s_waitcnt vmcnt(28)
    s_barrier
    v_and_b32 v254, 7, v0
    v_lshlrev_b32 v254, 5, v254
    buffer_load_dword v252, v254, s[88:91], 0 offen sc1
    buffer_load_dword v58, off, s[12:15], 0 offset:204 sc1
    v_add_u32 v48, 65536, v46
    ds_read_b64_tr_b16 a[192:193], v48 offset:0
    ds_read_b64_tr_b16 a[194:195], v48 offset:512
    ds_read_b64_tr_b16 a[196:197], v48 offset:8192
    ds_read_b64_tr_b16 a[198:199], v48 offset:8704
    ds_read_b64_tr_b16 a[200:201], v48 offset:8
    ds_read_b64_tr_b16 a[202:203], v48 offset:520
    ds_read_b64_tr_b16 a[204:205], v48 offset:8200
    ds_read_b64_tr_b16 a[206:207], v48 offset:8712
    s_waitcnt lgkmcnt(0)
    s_barrier
    s_add_u32 m0, s48, 65536
    s_mov_b32 s22, 131072
    buffer_load_dwordx4 v45, s[8:11], s22 offen  lds
    s_add_u32 m0, s48, 69632
    s_mov_b32 s22, 147456
    buffer_load_dwordx4 v45, s[8:11], s22 offen  lds
    s_add_u32 m0, s48, 73728
    s_mov_b32 s22, 163840
    buffer_load_dwordx4 v45, s[8:11], s22 offen  lds
    s_add_u32 m0, s48, 77824
    s_mov_b32 s22, 180224
    buffer_load_dwordx4 v45, s[8:11], s22 offen  lds
    s_waitcnt vmcnt(28)
    s_barrier
    v_add_u32 v48, 81920, v46
    ds_read_b64_tr_b16 a[208:209], v48 offset:0
    ds_read_b64_tr_b16 a[210:211], v48 offset:512
    ds_read_b64_tr_b16 a[212:213], v48 offset:8192
    ds_read_b64_tr_b16 a[214:215], v48 offset:8704
    ds_read_b64_tr_b16 a[216:217], v48 offset:8
    ds_read_b64_tr_b16 a[218:219], v48 offset:520
    ds_read_b64_tr_b16 a[220:221], v48 offset:8200
    ds_read_b64_tr_b16 a[222:223], v48 offset:8712
    s_waitcnt lgkmcnt(0)
    s_barrier
    s_add_u32 m0, s48, 81920
    s_mov_b32 s22, 131328
    buffer_load_dwordx4 v45, s[8:11], s22 offen  lds
    s_add_u32 m0, s48, 86016
    s_mov_b32 s22, 147712
    buffer_load_dwordx4 v45, s[8:11], s22 offen  lds
    s_add_u32 m0, s48, 90112
    s_mov_b32 s22, 164096
    buffer_load_dwordx4 v45, s[8:11], s22 offen  lds
    s_add_u32 m0, s48, 94208
    s_mov_b32 s22, 180480
    buffer_load_dwordx4 v45, s[8:11], s22 offen  lds
    s_waitcnt vmcnt(28)
    s_barrier
    v_add_u32 v48, 98304, v46
    ds_read_b64_tr_b16 a[224:225], v48 offset:0
    ds_read_b64_tr_b16 a[226:227], v48 offset:512
    ds_read_b64_tr_b16 a[228:229], v48 offset:8192
    ds_read_b64_tr_b16 a[230:231], v48 offset:8704
    ds_read_b64_tr_b16 a[232:233], v48 offset:8
    ds_read_b64_tr_b16 a[234:235], v48 offset:520
    ds_read_b64_tr_b16 a[236:237], v48 offset:8200
    ds_read_b64_tr_b16 a[238:239], v48 offset:8712
    s_waitcnt lgkmcnt(0)
    s_barrier
    s_add_u32 m0, s48, 98304
    s_mov_b32 s22, 131584
    buffer_load_dwordx4 v45, s[8:11], s22 offen  lds
    s_add_u32 m0, s48, 102400
    s_mov_b32 s22, 147968
    buffer_load_dwordx4 v45, s[8:11], s22 offen  lds
    s_add_u32 m0, s48, 106496
    s_mov_b32 s22, 164352
    buffer_load_dwordx4 v45, s[8:11], s22 offen  lds
    s_add_u32 m0, s48, 110592
    s_mov_b32 s22, 180736
    buffer_load_dwordx4 v45, s[8:11], s22 offen  lds
    s_waitcnt vmcnt(28)
    s_barrier
    v_add_u32 v48, 114688, v46
    ds_read_b64_tr_b16 a[240:241], v48 offset:0
    ds_read_b64_tr_b16 a[242:243], v48 offset:512
    ds_read_b64_tr_b16 a[244:245], v48 offset:8192
    ds_read_b64_tr_b16 a[246:247], v48 offset:8704
    ds_read_b64_tr_b16 a[248:249], v48 offset:8
    ds_read_b64_tr_b16 a[250:251], v48 offset:520
    ds_read_b64_tr_b16 a[252:253], v48 offset:8200
    ds_read_b64_tr_b16 a[254:255], v48 offset:8712
    s_waitcnt lgkmcnt(0)
    s_barrier
    s_add_u32 m0, s48, 114688
    s_mov_b32 s22, 131840
    buffer_load_dwordx4 v45, s[8:11], s22 offen  lds
    s_add_u32 m0, s48, 118784
    s_mov_b32 s22, 148224
    buffer_load_dwordx4 v45, s[8:11], s22 offen  lds
    s_add_u32 m0, s48, 122880
    s_mov_b32 s22, 164608
    buffer_load_dwordx4 v45, s[8:11], s22 offen  lds
    s_add_u32 m0, s48, 126976
    s_mov_b32 s22, 180992
    buffer_load_dwordx4 v45, s[8:11], s22 offen  lds
    s_waitcnt vmcnt(28)
    s_barrier
    s_cmp_lg_u32 s20, 0
    s_cbranch_scc1 mega_kernel_rf_wo0
    v_xor_b32 v48, 0, v47
    v_add_u32 v48, 0, v48
    ds_read_b64_tr_b16 v[128:129], v48 offset:0
    ds_read_b64_tr_b16 v[130:131], v48 offset:512
    ds_read_b64_tr_b16 v[132:133], v48 offset:8192
    ds_read_b64_tr_b16 v[134:135], v48 offset:8704
    ds_read_b64_tr_b16 v[144:145], v48 offset:32
    ds_read_b64_tr_b16 v[146:147], v48 offset:544
    ds_read_b64_tr_b16 v[148:149], v48 offset:8224
    ds_read_b64_tr_b16 v[150:151], v48 offset:8736
    s_waitcnt lgkmcnt(0)
    v_xor_b32 v48, 64, v47
    v_add_u32 v48, 0, v48
    ds_read_b64_tr_b16 v[160:161], v48 offset:0
    ds_read_b64_tr_b16 v[162:163], v48 offset:512
    ds_read_b64_tr_b16 v[164:165], v48 offset:8192
    ds_read_b64_tr_b16 v[166:167], v48 offset:8704
    ds_read_b64_tr_b16 v[176:177], v48 offset:32
    ds_read_b64_tr_b16 v[178:179], v48 offset:544
    ds_read_b64_tr_b16 v[180:181], v48 offset:8224
    ds_read_b64_tr_b16 v[182:183], v48 offset:8736
    s_waitcnt lgkmcnt(0)
    v_xor_b32 v48, 128, v47
    v_add_u32 v48, 0, v48
    ds_read_b64_tr_b16 v[192:193], v48 offset:0
    ds_read_b64_tr_b16 v[194:195], v48 offset:512
    ds_read_b64_tr_b16 v[196:197], v48 offset:8192
    ds_read_b64_tr_b16 v[198:199], v48 offset:8704
    ds_read_b64_tr_b16 v[208:209], v48 offset:32
    ds_read_b64_tr_b16 v[210:211], v48 offset:544
    ds_read_b64_tr_b16 v[212:213], v48 offset:8224
    ds_read_b64_tr_b16 v[214:215], v48 offset:8736
    s_waitcnt lgkmcnt(0)
    v_xor_b32 v48, 192, v47
    v_add_u32 v48, 0, v48
    ds_read_b64_tr_b16 v[224:225], v48 offset:0
    ds_read_b64_tr_b16 v[226:227], v48 offset:512
    ds_read_b64_tr_b16 v[228:229], v48 offset:8192
    ds_read_b64_tr_b16 v[230:231], v48 offset:8704
    ds_read_b64_tr_b16 v[240:241], v48 offset:32
    ds_read_b64_tr_b16 v[242:243], v48 offset:544
    ds_read_b64_tr_b16 v[244:245], v48 offset:8224
    ds_read_b64_tr_b16 v[246:247], v48 offset:8736
    s_waitcnt lgkmcnt(0)
mega_kernel_rf_wo0:
    s_barrier
    s_mov_b32 s8, s54
    s_mov_b32 s9, s55
    s_add_u32 m0, s48, 0
    s_mov_b32 s22, 0
    buffer_load_dwordx4 v44, s[8:11], s22 offen  lds
    s_add_u32 m0, s48, 4096
    s_mov_b32 s22, 32768
    buffer_load_dwordx4 v44, s[8:11], s22 offen  lds
    s_add_u32 m0, s48, 8192
    s_mov_b32 s22, 65536
    buffer_load_dwordx4 v44, s[8:11], s22 offen  lds
    s_add_u32 m0, s48, 12288
    s_mov_b32 s22, 98304
    buffer_load_dwordx4 v44, s[8:11], s22 offen  lds
    s_waitcnt vmcnt(28)
    s_barrier
    s_cmp_lg_u32 s20, 1
    s_cbranch_scc1 mega_kernel_rf_wo1
    v_xor_b32 v48, 0, v47
    v_add_u32 v48, 16384, v48
    ds_read_b64_tr_b16 v[128:129], v48 offset:0
    ds_read_b64_tr_b16 v[130:131], v48 offset:512
    ds_read_b64_tr_b16 v[132:133], v48 offset:8192
    ds_read_b64_tr_b16 v[134:135], v48 offset:8704
    ds_read_b64_tr_b16 v[144:145], v48 offset:32
    ds_read_b64_tr_b16 v[146:147], v48 offset:544
    ds_read_b64_tr_b16 v[148:149], v48 offset:8224
    ds_read_b64_tr_b16 v[150:151], v48 offset:8736
    s_waitcnt lgkmcnt(0)
    v_xor_b32 v48, 64, v47
    v_add_u32 v48, 16384, v48
    ds_read_b64_tr_b16 v[160:161], v48 offset:0
    ds_read_b64_tr_b16 v[162:163], v48 offset:512
    ds_read_b64_tr_b16 v[164:165], v48 offset:8192
    ds_read_b64_tr_b16 v[166:167], v48 offset:8704
    ds_read_b64_tr_b16 v[176:177], v48 offset:32
    ds_read_b64_tr_b16 v[178:179], v48 offset:544
    ds_read_b64_tr_b16 v[180:181], v48 offset:8224
    ds_read_b64_tr_b16 v[182:183], v48 offset:8736
    s_waitcnt lgkmcnt(0)
    v_xor_b32 v48, 128, v47
    v_add_u32 v48, 16384, v48
    ds_read_b64_tr_b16 v[192:193], v48 offset:0
    ds_read_b64_tr_b16 v[194:195], v48 offset:512
    ds_read_b64_tr_b16 v[196:197], v48 offset:8192
    ds_read_b64_tr_b16 v[198:199], v48 offset:8704
    ds_read_b64_tr_b16 v[208:209], v48 offset:32
    ds_read_b64_tr_b16 v[210:211], v48 offset:544
    ds_read_b64_tr_b16 v[212:213], v48 offset:8224
    ds_read_b64_tr_b16 v[214:215], v48 offset:8736
    s_waitcnt lgkmcnt(0)
    v_xor_b32 v48, 192, v47
    v_add_u32 v48, 16384, v48
    ds_read_b64_tr_b16 v[224:225], v48 offset:0
    ds_read_b64_tr_b16 v[226:227], v48 offset:512
    ds_read_b64_tr_b16 v[228:229], v48 offset:8192
    ds_read_b64_tr_b16 v[230:231], v48 offset:8704
    ds_read_b64_tr_b16 v[240:241], v48 offset:32
    ds_read_b64_tr_b16 v[242:243], v48 offset:544
    ds_read_b64_tr_b16 v[244:245], v48 offset:8224
    ds_read_b64_tr_b16 v[246:247], v48 offset:8736
    s_waitcnt lgkmcnt(0)
mega_kernel_rf_wo1:
    s_barrier
    s_add_u32 m0, s48, 16384
    s_mov_b32 s22, 524288
    buffer_load_dwordx4 v44, s[8:11], s22 offen  lds
    s_add_u32 m0, s48, 20480
    s_mov_b32 s22, 557056
    buffer_load_dwordx4 v44, s[8:11], s22 offen  lds
    s_add_u32 m0, s48, 24576
    s_mov_b32 s22, 589824
    buffer_load_dwordx4 v44, s[8:11], s22 offen  lds
    s_add_u32 m0, s48, 28672
    s_mov_b32 s22, 622592
    buffer_load_dwordx4 v44, s[8:11], s22 offen  lds
    s_waitcnt vmcnt(28)
    s_barrier
    s_cmp_lg_u32 s20, 2
    s_cbranch_scc1 mega_kernel_rf_wo2
    v_xor_b32 v48, 0, v47
    v_add_u32 v48, 32768, v48
    ds_read_b64_tr_b16 v[128:129], v48 offset:0
    ds_read_b64_tr_b16 v[130:131], v48 offset:512
    ds_read_b64_tr_b16 v[132:133], v48 offset:8192
    ds_read_b64_tr_b16 v[134:135], v48 offset:8704
    ds_read_b64_tr_b16 v[144:145], v48 offset:32
    ds_read_b64_tr_b16 v[146:147], v48 offset:544
    ds_read_b64_tr_b16 v[148:149], v48 offset:8224
    ds_read_b64_tr_b16 v[150:151], v48 offset:8736
    s_waitcnt lgkmcnt(0)
    v_xor_b32 v48, 64, v47
    v_add_u32 v48, 32768, v48
    ds_read_b64_tr_b16 v[160:161], v48 offset:0
    ds_read_b64_tr_b16 v[162:163], v48 offset:512
    ds_read_b64_tr_b16 v[164:165], v48 offset:8192
    ds_read_b64_tr_b16 v[166:167], v48 offset:8704
    ds_read_b64_tr_b16 v[176:177], v48 offset:32
    ds_read_b64_tr_b16 v[178:179], v48 offset:544
    ds_read_b64_tr_b16 v[180:181], v48 offset:8224
    ds_read_b64_tr_b16 v[182:183], v48 offset:8736
    s_waitcnt lgkmcnt(0)
    v_xor_b32 v48, 128, v47
    v_add_u32 v48, 32768, v48
    ds_read_b64_tr_b16 v[192:193], v48 offset:0
    ds_read_b64_tr_b16 v[194:195], v48 offset:512
    ds_read_b64_tr_b16 v[196:197], v48 offset:8192
    ds_read_b64_tr_b16 v[198:199], v48 offset:8704
    ds_read_b64_tr_b16 v[208:209], v48 offset:32
    ds_read_b64_tr_b16 v[210:211], v48 offset:544
    ds_read_b64_tr_b16 v[212:213], v48 offset:8224
    ds_read_b64_tr_b16 v[214:215], v48 offset:8736
    s_waitcnt lgkmcnt(0)
    v_xor_b32 v48, 192, v47
    v_add_u32 v48, 32768, v48
    ds_read_b64_tr_b16 v[224:225], v48 offset:0
    ds_read_b64_tr_b16 v[226:227], v48 offset:512
    ds_read_b64_tr_b16 v[228:229], v48 offset:8192
    ds_read_b64_tr_b16 v[230:231], v48 offset:8704
    ds_read_b64_tr_b16 v[240:241], v48 offset:32
    ds_read_b64_tr_b16 v[242:243], v48 offset:544
    ds_read_b64_tr_b16 v[244:245], v48 offset:8224
    ds_read_b64_tr_b16 v[246:247], v48 offset:8736
    s_waitcnt lgkmcnt(0)
mega_kernel_rf_wo2:
    s_barrier
    s_add_u32 m0, s48, 32768
    s_mov_b32 s22, 1048576
    buffer_load_dwordx4 v44, s[8:11], s22 offen  lds
    s_add_u32 m0, s48, 36864
    s_mov_b32 s22, 1081344
    buffer_load_dwordx4 v44, s[8:11], s22 offen  lds
    s_add_u32 m0, s48, 40960
    s_mov_b32 s22, 1114112
    buffer_load_dwordx4 v44, s[8:11], s22 offen  lds
    s_add_u32 m0, s48, 45056
    s_mov_b32 s22, 1146880
    buffer_load_dwordx4 v44, s[8:11], s22 offen  lds
    s_waitcnt vmcnt(28)
    s_barrier
    s_cmp_lg_u32 s20, 3
    s_cbranch_scc1 mega_kernel_rf_wo3
    v_xor_b32 v48, 0, v47
    v_add_u32 v48, 49152, v48
    ds_read_b64_tr_b16 v[128:129], v48 offset:0
    ds_read_b64_tr_b16 v[130:131], v48 offset:512
    ds_read_b64_tr_b16 v[132:133], v48 offset:8192
    ds_read_b64_tr_b16 v[134:135], v48 offset:8704
    ds_read_b64_tr_b16 v[144:145], v48 offset:32
    ds_read_b64_tr_b16 v[146:147], v48 offset:544
    ds_read_b64_tr_b16 v[148:149], v48 offset:8224
    ds_read_b64_tr_b16 v[150:151], v48 offset:8736
    s_waitcnt lgkmcnt(0)
    v_xor_b32 v48, 64, v47
    v_add_u32 v48, 49152, v48
    ds_read_b64_tr_b16 v[160:161], v48 offset:0
    ds_read_b64_tr_b16 v[162:163], v48 offset:512
    ds_read_b64_tr_b16 v[164:165], v48 offset:8192
    ds_read_b64_tr_b16 v[166:167], v48 offset:8704
    ds_read_b64_tr_b16 v[176:177], v48 offset:32
    ds_read_b64_tr_b16 v[178:179], v48 offset:544
    ds_read_b64_tr_b16 v[180:181], v48 offset:8224
    ds_read_b64_tr_b16 v[182:183], v48 offset:8736
    s_waitcnt lgkmcnt(0)
    v_xor_b32 v48, 128, v47
    v_add_u32 v48, 49152, v48
    ds_read_b64_tr_b16 v[192:193], v48 offset:0
    ds_read_b64_tr_b16 v[194:195], v48 offset:512
    ds_read_b64_tr_b16 v[196:197], v48 offset:8192
    ds_read_b64_tr_b16 v[198:199], v48 offset:8704
    ds_read_b64_tr_b16 v[208:209], v48 offset:32
    ds_read_b64_tr_b16 v[210:211], v48 offset:544
    ds_read_b64_tr_b16 v[212:213], v48 offset:8224
    ds_read_b64_tr_b16 v[214:215], v48 offset:8736
    s_waitcnt lgkmcnt(0)
    v_xor_b32 v48, 192, v47
    v_add_u32 v48, 49152, v48
    ds_read_b64_tr_b16 v[224:225], v48 offset:0
    ds_read_b64_tr_b16 v[226:227], v48 offset:512
    ds_read_b64_tr_b16 v[228:229], v48 offset:8192
    ds_read_b64_tr_b16 v[230:231], v48 offset:8704
    ds_read_b64_tr_b16 v[240:241], v48 offset:32
    ds_read_b64_tr_b16 v[242:243], v48 offset:544
    ds_read_b64_tr_b16 v[244:245], v48 offset:8224
    ds_read_b64_tr_b16 v[246:247], v48 offset:8736
    s_waitcnt lgkmcnt(0)
mega_kernel_rf_wo3:
    s_barrier
    s_add_u32 m0, s48, 49152
    s_mov_b32 s22, 1572864
    buffer_load_dwordx4 v44, s[8:11], s22 offen  lds
    s_add_u32 m0, s48, 53248
    s_mov_b32 s22, 1605632
    buffer_load_dwordx4 v44, s[8:11], s22 offen  lds
    s_add_u32 m0, s48, 57344
    s_mov_b32 s22, 1638400
    buffer_load_dwordx4 v44, s[8:11], s22 offen  lds
    s_add_u32 m0, s48, 61440
    s_mov_b32 s22, 1671168
    buffer_load_dwordx4 v44, s[8:11], s22 offen  lds
    s_waitcnt vmcnt(28)
    s_barrier
    s_cmp_lg_u32 s20, 0
    s_cbranch_scc1 mega_kernel_rf_wo4
    v_xor_b32 v48, 0, v47
    v_add_u32 v48, 65536, v48
    ds_read_b64_tr_b16 v[136:137], v48 offset:0
    ds_read_b64_tr_b16 v[138:139], v48 offset:512
    ds_read_b64_tr_b16 v[140:141], v48 offset:8192
    ds_read_b64_tr_b16 v[142:143], v48 offset:8704
    ds_read_b64_tr_b16 v[152:153], v48 offset:32
    ds_read_b64_tr_b16 v[154:155], v48 offset:544
    ds_read_b64_tr_b16 v[156:157], v48 offset:8224
    ds_read_b64_tr_b16 v[158:159], v48 offset:8736
    s_waitcnt lgkmcnt(0)
    v_xor_b32 v48, 64, v47
    v_add_u32 v48, 65536, v48
    ds_read_b64_tr_b16 v[168:169], v48 offset:0
    ds_read_b64_tr_b16 v[170:171], v48 offset:512
    ds_read_b64_tr_b16 v[172:173], v48 offset:8192
    ds_read_b64_tr_b16 v[174:175], v48 offset:8704
    ds_read_b64_tr_b16 v[184:185], v48 offset:32
    ds_read_b64_tr_b16 v[186:187], v48 offset:544
    ds_read_b64_tr_b16 v[188:189], v48 offset:8224
    ds_read_b64_tr_b16 v[190:191], v48 offset:8736
    s_waitcnt lgkmcnt(0)
    v_xor_b32 v48, 128, v47
    v_add_u32 v48, 65536, v48
    ds_read_b64_tr_b16 v[200:201], v48 offset:0
    ds_read_b64_tr_b16 v[202:203], v48 offset:512
    ds_read_b64_tr_b16 v[204:205], v48 offset:8192
    ds_read_b64_tr_b16 v[206:207], v48 offset:8704
    ds_read_b64_tr_b16 v[216:217], v48 offset:32
    ds_read_b64_tr_b16 v[218:219], v48 offset:544
    ds_read_b64_tr_b16 v[220:221], v48 offset:8224
    ds_read_b64_tr_b16 v[222:223], v48 offset:8736
    s_waitcnt lgkmcnt(0)
    v_xor_b32 v48, 192, v47
    v_add_u32 v48, 65536, v48
    ds_read_b64_tr_b16 v[232:233], v48 offset:0
    ds_read_b64_tr_b16 v[234:235], v48 offset:512
    ds_read_b64_tr_b16 v[236:237], v48 offset:8192
    ds_read_b64_tr_b16 v[238:239], v48 offset:8704
    ds_read_b64_tr_b16 v[248:249], v48 offset:32
    ds_read_b64_tr_b16 v[250:251], v48 offset:544
    ds_read_b64_tr_b16 v[252:253], v48 offset:8224
    ds_read_b64_tr_b16 v[254:255], v48 offset:8736
    s_waitcnt lgkmcnt(0)
mega_kernel_rf_wo4:
    s_barrier
    s_add_u32 m0, s48, 65536
    s_mov_b32 s22, 2097152
    buffer_load_dwordx4 v44, s[8:11], s22 offen  lds
    s_add_u32 m0, s48, 69632
    s_mov_b32 s22, 2129920
    buffer_load_dwordx4 v44, s[8:11], s22 offen  lds
    s_add_u32 m0, s48, 73728
    s_mov_b32 s22, 2162688
    buffer_load_dwordx4 v44, s[8:11], s22 offen  lds
    s_add_u32 m0, s48, 77824
    s_mov_b32 s22, 2195456
    buffer_load_dwordx4 v44, s[8:11], s22 offen  lds
    s_waitcnt vmcnt(28)
    s_barrier
    s_cmp_lg_u32 s20, 1
    s_cbranch_scc1 mega_kernel_rf_wo5
    v_xor_b32 v48, 0, v47
    v_add_u32 v48, 81920, v48
    ds_read_b64_tr_b16 v[136:137], v48 offset:0
    ds_read_b64_tr_b16 v[138:139], v48 offset:512
    ds_read_b64_tr_b16 v[140:141], v48 offset:8192
    ds_read_b64_tr_b16 v[142:143], v48 offset:8704
    ds_read_b64_tr_b16 v[152:153], v48 offset:32
    ds_read_b64_tr_b16 v[154:155], v48 offset:544
    ds_read_b64_tr_b16 v[156:157], v48 offset:8224
    ds_read_b64_tr_b16 v[158:159], v48 offset:8736
    s_waitcnt lgkmcnt(0)
    v_xor_b32 v48, 64, v47
    v_add_u32 v48, 81920, v48
    ds_read_b64_tr_b16 v[168:169], v48 offset:0
    ds_read_b64_tr_b16 v[170:171], v48 offset:512
    ds_read_b64_tr_b16 v[172:173], v48 offset:8192
    ds_read_b64_tr_b16 v[174:175], v48 offset:8704
    ds_read_b64_tr_b16 v[184:185], v48 offset:32
    ds_read_b64_tr_b16 v[186:187], v48 offset:544
    ds_read_b64_tr_b16 v[188:189], v48 offset:8224
    ds_read_b64_tr_b16 v[190:191], v48 offset:8736
    s_waitcnt lgkmcnt(0)
    v_xor_b32 v48, 128, v47
    v_add_u32 v48, 81920, v48
    ds_read_b64_tr_b16 v[200:201], v48 offset:0
    ds_read_b64_tr_b16 v[202:203], v48 offset:512
    ds_read_b64_tr_b16 v[204:205], v48 offset:8192
    ds_read_b64_tr_b16 v[206:207], v48 offset:8704
    ds_read_b64_tr_b16 v[216:217], v48 offset:32
    ds_read_b64_tr_b16 v[218:219], v48 offset:544
    ds_read_b64_tr_b16 v[220:221], v48 offset:8224
    ds_read_b64_tr_b16 v[222:223], v48 offset:8736
    s_waitcnt lgkmcnt(0)
    v_xor_b32 v48, 192, v47
    v_add_u32 v48, 81920, v48
    ds_read_b64_tr_b16 v[232:233], v48 offset:0
    ds_read_b64_tr_b16 v[234:235], v48 offset:512
    ds_read_b64_tr_b16 v[236:237], v48 offset:8192
    ds_read_b64_tr_b16 v[238:239], v48 offset:8704
    ds_read_b64_tr_b16 v[248:249], v48 offset:32
    ds_read_b64_tr_b16 v[250:251], v48 offset:544
    ds_read_b64_tr_b16 v[252:253], v48 offset:8224
    ds_read_b64_tr_b16 v[254:255], v48 offset:8736
    s_waitcnt lgkmcnt(0)
mega_kernel_rf_wo5:
    s_barrier
    s_add_u32 m0, s48, 81920
    s_mov_b32 s22, 2621440
    buffer_load_dwordx4 v44, s[8:11], s22 offen  lds
    s_add_u32 m0, s48, 86016
    s_mov_b32 s22, 2654208
    buffer_load_dwordx4 v44, s[8:11], s22 offen  lds
    s_add_u32 m0, s48, 90112
    s_mov_b32 s22, 2686976
    buffer_load_dwordx4 v44, s[8:11], s22 offen  lds
    s_add_u32 m0, s48, 94208
    s_mov_b32 s22, 2719744
    buffer_load_dwordx4 v44, s[8:11], s22 offen  lds
    s_waitcnt vmcnt(28)
    s_barrier
    s_cmp_lg_u32 s97, 0
    s_cbranch_scc1 mega_kernel_h2_2_ok
mega_kernel_h2_2_ev:
    v_cmp_ne_u32 vcc, 32, v252
    s_cbranch_vccz mega_kernel_h2_2_ok
    s_mov_b32 s78, 0
    v_readlane_b32 s81, v252, 0
    s_nop 3
    s_add_u32 s78, s78, s81
    v_readlane_b32 s81, v252, 1
    s_nop 3
    s_add_u32 s78, s78, s81
    v_readlane_b32 s81, v252, 2
    s_nop 3
    s_add_u32 s78, s78, s81
    v_readlane_b32 s81, v252, 3
    s_nop 3
    s_add_u32 s78, s78, s81
    v_readlane_b32 s81, v252, 4
    s_nop 3
    s_add_u32 s78, s78, s81
    v_readlane_b32 s81, v252, 5
    s_nop 3
    s_add_u32 s78, s78, s81
    v_readlane_b32 s81, v252, 6
    s_nop 3
    s_add_u32 s78, s78, s81
    v_readlane_b32 s81, v252, 7
    s_nop 3
    s_add_u32 s78, s78, s81
    s_cmp_eq_u32 s78, 256
    s_cbranch_scc1 mega_kernel_redo
    buffer_load_dword v252, v254, s[88:91], 0 offen sc1
    s_waitcnt vmcnt(0)
    s_branch mega_kernel_h2_2_ev
mega_kernel_h2_2_ok:
    s_cmp_lg_u32 s20, 2
    s_cbranch_scc1 mega_kernel_rf_wo6
    v_xor_b32 v48, 0, v47
    v_add_u32 v48, 98304, v48
    ds_read_b64_tr_b16 v[136:137], v48 offset:0
    ds_read_b64_tr_b16 v[138:139], v48 offset:512
    ds_read_b64_tr_b16 v[140:141], v48 offset:8192
    ds_read_b64_tr_b16 v[142:143], v48 offset:8704
    ds_read_b64_tr_b16 v[152:153], v48 offset:32
    ds_read_b64_tr_b16 v[154:155], v48 offset:544
    ds_read_b64_tr_b16 v[156:157], v48 offset:8224
    ds_read_b64_tr_b16 v[158:159], v48 offset:8736
    s_waitcnt lgkmcnt(0)
    v_xor_b32 v48, 64, v47
    v_add_u32 v48, 98304, v48
    ds_read_b64_tr_b16 v[168:169], v48 offset:0
    ds_read_b64_tr_b16 v[170:171], v48 offset:512
    ds_read_b64_tr_b16 v[172:173], v48 offset:8192
    ds_read_b64_tr_b16 v[174:175], v48 offset:8704
    ds_read_b64_tr_b16 v[184:185], v48 offset:32
    ds_read_b64_tr_b16 v[186:187], v48 offset:544
    ds_read_b64_tr_b16 v[188:189], v48 offset:8224
    ds_read_b64_tr_b16 v[190:191], v48 offset:8736
    s_waitcnt lgkmcnt(0)
    v_xor_b32 v48, 128, v47
    v_add_u32 v48, 98304, v48
    ds_read_b64_tr_b16 v[200:201], v48 offset:0
    ds_read_b64_tr_b16 v[202:203], v48 offset:512
    ds_read_b64_tr_b16 v[204:205], v48 offset:8192
    ds_read_b64_tr_b16 v[206:207], v48 offset:8704
    ds_read_b64_tr_b16 v[216:217], v48 offset:32
    ds_read_b64_tr_b16 v[218:219], v48 offset:544
    ds_read_b64_tr_b16 v[220:221], v48 offset:8224
    ds_read_b64_tr_b16 v[222:223], v48 offset:8736
    s_waitcnt lgkmcnt(0)
    v_xor_b32 v48, 192, v47
    v_add_u32 v48, 98304, v48
    ds_read_b64_tr_b16 v[232:233], v48 offset:0
    ds_read_b64_tr_b16 v[234:235], v48 offset:512
    ds_read_b64_tr_b16 v[236:237], v48 offset:8192
    ds_read_b64_tr_b16 v[238:239], v48 offset:8704
    ds_read_b64_tr_b16 v[248:249], v48 offset:32
    ds_read_b64_tr_b16 v[250:251], v48 offset:544
    ds_read_b64_tr_b16 v[252:253], v48 offset:8224
    ds_read_b64_tr_b16 v[254:255], v48 offset:8736
    s_waitcnt lgkmcnt(0)
mega_kernel_rf_wo6:
    s_barrier
    s_add_u32 m0, s48, 98304
    s_mov_b32 s22, 3145728
    buffer_load_dwordx4 v44, s[8:11], s22 offen  lds
    s_add_u32 m0, s48, 102400
    s_mov_b32 s22, 3178496
    buffer_load_dwordx4 v44, s[8:11], s22 offen  lds
    s_add_u32 m0, s48, 106496
    s_mov_b32 s22, 3211264
    buffer_load_dwordx4 v44, s[8:11], s22 offen  lds
    s_add_u32 m0, s48, 110592
    s_mov_b32 s22, 3244032
    buffer_load_dwordx4 v44, s[8:11], s22 offen  lds
    s_waitcnt vmcnt(28)
    s_barrier
    s_cmp_lg_u32 s20, 3
    s_cbranch_scc1 mega_kernel_rf_wo7
    v_xor_b32 v48, 0, v47
    v_add_u32 v48, 114688, v48
    ds_read_b64_tr_b16 v[136:137], v48 offset:0
    ds_read_b64_tr_b16 v[138:139], v48 offset:512
    ds_read_b64_tr_b16 v[140:141], v48 offset:8192
    ds_read_b64_tr_b16 v[142:143], v48 offset:8704
    ds_read_b64_tr_b16 v[152:153], v48 offset:32
    ds_read_b64_tr_b16 v[154:155], v48 offset:544
    ds_read_b64_tr_b16 v[156:157], v48 offset:8224
    ds_read_b64_tr_b16 v[158:159], v48 offset:8736
    s_waitcnt lgkmcnt(0)
    v_xor_b32 v48, 64, v47
    v_add_u32 v48, 114688, v48
    ds_read_b64_tr_b16 v[168:169], v48 offset:0
    ds_read_b64_tr_b16 v[170:171], v48 offset:512
    ds_read_b64_tr_b16 v[172:173], v48 offset:8192
    ds_read_b64_tr_b16 v[174:175], v48 offset:8704
    ds_read_b64_tr_b16 v[184:185], v48 offset:32
    ds_read_b64_tr_b16 v[186:187], v48 offset:544
    ds_read_b64_tr_b16 v[188:189], v48 offset:8224
    ds_read_b64_tr_b16 v[190:191], v48 offset:8736
    s_waitcnt lgkmcnt(0)
    v_xor_b32 v48, 128, v47
    v_add_u32 v48, 114688, v48
    ds_read_b64_tr_b16 v[200:201], v48 offset:0
    ds_read_b64_tr_b16 v[202:203], v48 offset:512
    ds_read_b64_tr_b16 v[204:205], v48 offset:8192
    ds_read_b64_tr_b16 v[206:207], v48 offset:8704
    ds_read_b64_tr_b16 v[216:217], v48 offset:32
    ds_read_b64_tr_b16 v[218:219], v48 offset:544
    ds_read_b64_tr_b16 v[220:221], v48 offset:8224
    ds_read_b64_tr_b16 v[222:223], v48 offset:8736
    s_waitcnt lgkmcnt(0)
    v_xor_b32 v48, 192, v47
    v_add_u32 v48, 114688, v48
    ds_read_b64_tr_b16 v[232:233], v48 offset:0
    ds_read_b64_tr_b16 v[234:235], v48 offset:512
    ds_read_b64_tr_b16 v[236:237], v48 offset:8192
    ds_read_b64_tr_b16 v[238:239], v48 offset:8704
    ds_read_b64_tr_b16 v[248:249], v48 offset:32
    ds_read_b64_tr_b16 v[250:251], v48 offset:544
    ds_read_b64_tr_b16 v[252:253], v48 offset:8224
    ds_read_b64_tr_b16 v[254:255], v48 offset:8736
    s_waitcnt lgkmcnt(0)
mega_kernel_rf_wo7:
    s_barrier
    s_add_u32 m0, s48, 114688
    s_mov_b32 s22, 3670016
    buffer_load_dwordx4 v44, s[8:11], s22 offen  lds
    s_add_u32 m0, s48, 118784
    s_mov_b32 s22, 3702784
    buffer_load_dwordx4 v44, s[8:11], s22 offen  lds
    s_add_u32 m0, s48, 122880
    s_mov_b32 s22, 3735552
    buffer_load_dwordx4 v44, s[8:11], s22 offen  lds
    s_add_u32 m0, s48, 126976
    s_mov_b32 s22, 3768320
    buffer_load_dwordx4 v44, s[8:11], s22 offen  lds
    s_waitcnt vmcnt(28)
    s_barrier
    v_add_u32 v48, 0, v46
    ds_read_b64_tr_b16 v[64:65], v48 offset:0
    ds_read_b64_tr_b16 v[66:67], v48 offset:512
    ds_read_b64_tr_b16 v[68:69], v48 offset:8192
    ds_read_b64_tr_b16 v[70:71], v48 offset:8704
    ds_read_b64_tr_b16 v[72:73], v48 offset:8
    ds_read_b64_tr_b16 v[74:75], v48 offset:520
    ds_read_b64_tr_b16 v[76:77], v48 offset:8200
    ds_read_b64_tr_b16 v[78:79], v48 offset:8712
    s_waitcnt lgkmcnt(0)
    s_barrier
    ds_write_b128 v32, v[64:67] offset:0
    ds_write_b128 v32, v[68:71] offset:1024
    ds_write_b128 v32, v[72:75] offset:2048
    ds_write_b128 v32, v[76:79] offset:3072
    s_waitcnt lgkmcnt(0)
    s_waitcnt vmcnt(24)
    s_barrier
    v_add_u32 v48, 16384, v46
    ds_read_b64_tr_b16 v[64:65], v48 offset:0
    ds_read_b64_tr_b16 v[66:67], v48 offset:512
    ds_read_b64_tr_b16 v[68:69], v48 offset:8192
    ds_read_b64_tr_b16 v[70:71], v48 offset:8704
    ds_read_b64_tr_b16 v[72:73], v48 offset:8
    ds_read_b64_tr_b16 v[74:75], v48 offset:520
    ds_read_b64_tr_b16 v[76:77], v48 offset:8200
    ds_read_b64_tr_b16 v[78:79], v48 offset:8712
    s_waitcnt lgkmcnt(0)
    s_barrier
    ds_write_b128 v32, v[64:67] offset:16384
    ds_write_b128 v32, v[68:71] offset:17408
    ds_write_b128 v32, v[72:75] offset:18432
    ds_write_b128 v32, v[76:79] offset:19456
    s_waitcnt lgkmcnt(0)
    s_waitcnt vmcnt(20)
    s_barrier
    s_getpc_b64 s[16:17]
mega_kernel_rf_pc0:
    s_add_u32 s16, s16, mega_kernel_rf_w0_entry - mega_kernel_rf_pc0
    s_addc_u32 s17, s17, 0
    v_lshlrev_b32 v49, 7, v0
    v_min_u32 v49, mega_kernel_rf_end - mega_kernel_rf_w0_entry, v49
    global_load_dword v50, v49, s[16:17]
    v_lshlrev_b32 v49, 7, v40
    s_xor_b32 s23, s35, 16384
    s_cmp_eq_u32 s20, 1
    s_cselect_b32 s22, s35, s47
    s_cmp_eq_u32 s20, 2
    s_cselect_b32 s22, s23, s22
    s_lshl_b32 s23, s31, 13
    s_add_u32 s23, s23, 178257920
    s_cmp_eq_u32 s20, 3
    s_cselect_b32 s22, s23, s22
    buffer_load_dword v51, v49, s[4:7], s22 offen sc1
    v_lshlrev_b32 v49, 13, v0
    v_and_b32 v49, 0x1fffff, v49
    s_mov_b32 s22, 67108864
    buffer_load_dword v52, v49, s[4:7], s22 offen sc1
    buffer_load_dword v57, v7, s[4:7], 0 offen sc1
    v_add_u32 v48, 32768, v46
    ds_read_b64_tr_b16 v[64:65], v48 offset:0
    ds_read_b64_tr_b16 v[66:67], v48 offset:512
    ds_read_b64_tr_b16 v[68:69], v48 offset:8192
    ds_read_b64_tr_b16 v[70:71], v48 offset:8704
    ds_read_b64_tr_b16 v[72:73], v48 offset:8
    ds_read_b64_tr_b16 v[74:75], v48 offset:520
    ds_read_b64_tr_b16 v[76:77], v48 offset:8200
    ds_read_b64_tr_b16 v[78:79], v48 offset:8712
    s_waitcnt lgkmcnt(0)
    s_barrier
    ds_write_b128 v32, v[64:67] offset:32768
    ds_write_b128 v32, v[68:71] offset:33792
    ds_write_b128 v32, v[72:75] offset:34816
    ds_write_b128 v32, v[76:79] offset:35840
    s_waitcnt lgkmcnt(0)
    s_waitcnt vmcnt(16)
    s_barrier
    v_add_u32 v48, 49152, v46
    ds_read_b64_tr_b16 v[64:65], v48 offset:0
    ds_read_b64_tr_b16 v[66:67], v48 offset:512
    ds_read_b64_tr_b16 v[68:69], v48 offset:8192
    ds_read_b64_tr_b16 v[70:71], v48 offset:8704
    ds_read_b64_tr_b16 v[72:73], v48 offset:8
    ds_read_b64_tr_b16 v[74:75], v48 offset:520
    ds_read_b64_tr_b16 v[76:77], v48 offset:8200
    ds_read_b64_tr_b16 v[78:79], v48 offset:8712
    s_waitcnt lgkmcnt(0)
    s_barrier
    ds_write_b128 v32, v[64:67] offset:49152
    ds_write_b128 v32, v[68:71] offset:50176
    ds_write_b128 v32, v[72:75] offset:51200
    ds_write_b128 v32, v[76:79] offset:52224
    s_waitcnt lgkmcnt(0)
    s_waitcnt vmcnt(12)
    s_barrier
    v_add_u32 v48, 65536, v46
    ds_read_b64_tr_b16 v[64:65], v48 offset:0
    ds_read_b64_tr_b16 v[66:67], v48 offset:512
    ds_read_b64_tr_b16 v[68:69], v48 offset:8192
    ds_read_b64_tr_b16 v[70:71], v48 offset:8704
    ds_read_b64_tr_b16 v[72:73], v48 offset:8
    ds_read_b64_tr_b16 v[74:75], v48 offset:520
    ds_read_b64_tr_b16 v[76:77], v48 offset:8200
    ds_read_b64_tr_b16 v[78:79], v48 offset:8712
    s_waitcnt lgkmcnt(0)
    s_barrier
    ds_write_b128 v33, v[64:67] offset:0
    ds_write_b128 v33, v[68:71] offset:1024
    ds_write_b128 v33, v[72:75] offset:2048
    ds_write_b128 v33, v[76:79] offset:3072
    s_waitcnt lgkmcnt(0)
    s_waitcnt vmcnt(8)
    s_barrier
    v_add_u32 v48, 81920, v46
    ds_read_b64_tr_b16 v[64:65], v48 offset:0
    ds_read_b64_tr_b16 v[66:67], v48 offset:512
    ds_read_b64_tr_b16 v[68:69], v48 offset:8192
    ds_read_b64_tr_b16 v[70:71], v48 offset:8704
    ds_read_b64_tr_b16 v[72:73], v48 offset:8
    ds_read_b64_tr_b16 v[74:75], v48 offset:520
    ds_read_b64_tr_b16 v[76:77], v48 offset:8200
    ds_read_b64_tr_b16 v[78:79], v48 offset:8712
    s_waitcnt lgkmcnt(0)
    s_barrier
    ds_write_b128 v33, v[64:67] offset:16384
    ds_write_b128 v33, v[68:71] offset:17408
    ds_write_b128 v33, v[72:75] offset:18432
    ds_write_b128 v33, v[76:79] offset:19456
    s_waitcnt lgkmcnt(0)
    s_waitcnt vmcnt(4)
    s_barrier
    v_add_u32 v48, 98304, v46
    ds_read_b64_tr_b16 v[64:65], v48 offset:0
    ds_read_b64_tr_b16 v[66:67], v48 offset:512
    ds_read_b64_tr_b16 v[68:69], v48 offset:8192
    ds_read_b64_tr_b16 v[70:71], v48 offset:8704
    ds_read_b64_tr_b16 v[72:73], v48 offset:8
    ds_read_b64_tr_b16 v[74:75], v48 offset:520
    ds_read_b64_tr_b16 v[76:77], v48 offset:8200
    ds_read_b64_tr_b16 v[78:79], v48 offset:8712
    s_waitcnt lgkmcnt(0)
    s_barrier
    ds_write_b128 v33, v[64:67] offset:32768
    ds_write_b128 v33, v[68:71] offset:33792
    ds_write_b128 v33, v[72:75] offset:34816
    ds_write_b128 v33, v[76:79] offset:35840
    s_waitcnt lgkmcnt(0)
    s_waitcnt vmcnt(0)
    s_barrier
    v_add_u32 v48, 114688, v46
    ds_read_b64_tr_b16 v[64:65], v48 offset:0
    ds_read_b64_tr_b16 v[66:67], v48 offset:512
    ds_read_b64_tr_b16 v[68:69], v48 offset:8192
    ds_read_b64_tr_b16 v[70:71], v48 offset:8704
    ds_read_b64_tr_b16 v[72:73], v48 offset:8
    ds_read_b64_tr_b16 v[74:75], v48 offset:520
    ds_read_b64_tr_b16 v[76:77], v48 offset:8200
    ds_read_b64_tr_b16 v[78:79], v48 offset:8712
    s_waitcnt lgkmcnt(0)
    s_barrier
    ds_write_b128 v33, v[64:67] offset:49152
    ds_write_b128 v33, v[68:71] offset:50176
    ds_write_b128 v33, v[72:75] offset:51200
    ds_write_b128 v33, v[76:79] offset:52224
    s_waitcnt lgkmcnt(0)
    s_branch mega_kernel_rf_iw1
mega_kernel_rf_iw:
    buffer_load_dword v58, off, s[12:15], 0 offset:204 sc1
    s_waitcnt vmcnt(0)
mega_kernel_rf_iw1:
    v_and_b32 v50, 0xffff, v58
    v_readfirstlane_b32 s60, v58
    v_cmp_ne_u32 vcc, s100, v50
    s_cbranch_vccnz mega_kernel_rf_iw
    s_lshr_b32 s60, s60, 15
    s_cmp_gt_u32 s60, s100
    s_cselect_b32 s60, 8192, 0
    s_bfe_u32 s22, s31, 0x10001
    s_lshl_b32 s22, s22, 12
    s_add_u32 s22, s22, s60
    s_lshl_b32 s23, s20, 10
    s_add_u32 s22, s22, s23
    s_add_u32 s38, s38, s22
    s_add_u32 s37, s37, s22
    s_xor_b32 s40, s38, 4096
    s_xor_b32 s39, s37, 4096
    s_xor_b32 s36, s35, 16384
    s_mov_b32 s21, 0
    s_cmp_eq_u32 s30, 0
    s_mov_b32 s22, 0x33003300
    s_cselect_b32 s16, 0x00330033, s22
    s_mov_b32 s17, s16
    s_cselect_b32 s18, -1, 0
    s_not_b32 s19, s18
    s_lshl_b32 s22, s31, 13
    s_lshl_b32 s23, s20, 11
    s_add_u32 s22, s22, s23
    s_add_u32 s43, s22, 16777216
    s_add_u32 s44, s22, 33554432
    s_lshl_b32 s45, s31, 13
    s_add_u32 s45, s45, 178257920
    s_mul_i32 s48, s20, 5120
    s_add_u32 m0, s48, 140288
    s_mov_b32 s41, 1
    s_mov_b32 s42, 1
    v_mov_b32 v0, v34
    v_bfrev_b32 v12, 1
    v_bfrev_b32 v3, 1
    v_cndmask_b32 v10, v3, v10, s[16:17]
    v_cndmask_b32 v9, v3, v9, s[26:27]
    s_sub_u32 s45, s45, 0
    s_lshl_b32 s51, s30, 11
    s_add_u32 s51, s51, s45
    s_mov_b32 s50, 0
    s_cmp_lg_u32 s20, 3
    s_cbranch_scc1 mega_kernel_rf_kv0
    v_readlane_b32 s50, v57, 0
    v_readlane_b32 s22, v57, 2
    v_readlane_b32 s23, v57, 1
    v_readlane_b32 s24, v57, 3
    s_nop 3
    s_min_u32 s50, s50, s22
    s_min_u32 s23, s23, s24
    s_lshl_b32 s50, s50, 1
    s_lshl_b32 s23, s23, 1
    s_add_u32 s23, s23, 1
    s_min_u32 s50, s50, s23
mega_kernel_rf_kvb0:
    s_add_u32 s22, s21, 1
    s_min_u32 s22, s22, 63
    s_cmp_gt_u32 s50, s22
    s_cbranch_scc1 mega_kernel_rf_kvd0
    buffer_load_dword v48, v7, s[4:7], 0 offen sc1
    s_waitcnt vmcnt(0)
    v_readlane_b32 s50, v48, 0
    v_readlane_b32 s22, v48, 2
    v_readlane_b32 s23, v48, 1
    v_readlane_b32 s24, v48, 3
    s_nop 3
    s_min_u32 s50, s50, s22
    s_min_u32 s23, s23, s24
    s_lshl_b32 s50, s50, 1
    s_lshl_b32 s23, s23, 1
    s_add_u32 s23, s23, 1
    s_min_u32 s50, s50, s23
    s_branch mega_kernel_rf_kvb0
mega_kernel_rf_kvd0:
mega_kernel_rf_kv0:
    s_barrier
    s_cmp_eq_u32 s20, 1
    s_cbranch_scc1 mega_kernel_rf_w1_entry
    s_cmp_eq_u32 s20, 2
    s_cbranch_scc1 mega_kernel_rf_w2_entry
    s_cmp_eq_u32 s20, 3
    s_cbranch_scc1 mega_kernel_rf_w3_entry
mega_kernel_rf_w0_entry:
    v_mfma_f32_32x32x8_bf16 v[96:111], v[14:15], v[14:15], 0
    v_mfma_f32_16x16x16_bf16 v[112:115], v[14:15], v[14:15], 0
    v_mfma_f32_16x16x16_bf16 v[116:119], v[14:15], v[14:15], 0
    ds_read_b128 v[64:67], v1 offset:0
    ds_read_b128 v[68:71], v1 offset:1024
    ds_read_b128 v[72:75], v1 offset:2048
    ds_read_b128 v[76:79], v1 offset:3072
    ds_read_b128 v[80:83], v1 offset:16384
    ds_read_b128 v[84:87], v1 offset:17408
    ds_read_b128 v[88:91], v1 offset:18432
    ds_read_b128 v[92:95], v1 offset:19456
    buffer_load_dwordx4 v[120:123], v1, s[4:7], s44 offen
    buffer_load_dwordx4 v[124:127], v1, s[4:7], s44 offen offset:1024
    s_add_u32 s44, s44, 262144
mega_kernel_rf_w0_loop:
    s_add_u32 s22, s35, 0
    s_waitcnt vmcnt(0)
    buffer_load_dwordx4 v[32:35], v1, s[4:7], s22 offen sc1
    buffer_load_dwordx4 v[36:39], v1, s[4:7], s22 offen offset:1024 sc1
mega_kernel_rf_w0_pa:
    s_waitcnt vmcnt(1)
    ds_write_b128 v6, v[32:35] offset:0
    s_waitcnt vmcnt(0)
    ds_write_b128 v6, v[36:39] offset:1024
    v_max3_u32 v3, v32, v34, v36
    v_max_u32 v3, v3, v38
    v_cmp_eq_u32 vcc, -1, v3
    v_smfmac_f32_16x16x64_bf16 v[96:99], v[32:35], a[0:7], v2
    buffer_load_dwordx4 v[32:35], v1, s[4:7], s22 offen sc1
    v_smfmac_f32_16x16x64_bf16 v[100:103], v[32:35], a[8:15], v2
    buffer_load_dwordx4 v[36:39], v1, s[4:7], s22 offen offset:1024 sc1
    v_smfmac_f32_16x16x64_bf16 v[104:107], v[32:35], a[128:135], v2
    s_cbranch_vccnz mega_kernel_rf_w0_pafail
    s_waitcnt lgkmcnt(0)
    s_barrier
    ds_read_b128 v[40:43], v6 offset:2048
    ds_read_b128 v[44:47], v6 offset:3072
    v_smfmac_f32_16x16x64_bf16 v[108:111], v[32:35], a[136:143], v2
    ds_read_b128 v[48:51], v6 offset:4096
    v_smfmac_f32_16x16x64_bf16 v[96:99], v[36:39], a[16:23], v2
    ds_read_b128 v[52:55], v6 offset:5120
    v_smfmac_f32_16x16x64_bf16 v[100:103], v[36:39], a[24:31], v2
    ds_read_b128 v[56:59], v6 offset:6144
    v_smfmac_f32_16x16x64_bf16 v[104:107], v[36:39], a[144:151], v2
    ds_read_b128 v[60:63], v6 offset:7168
    v_smfmac_f32_16x16x64_bf16 v[108:111], v[36:39], a[152:159], v2
    buffer_load_dwordx4 v1, s[4:7], s43 offen lds
    s_waitcnt lgkmcnt(5)
    v_smfmac_f32_16x16x64_bf16 v[96:99], v[40:43], a[32:39], v2
    v_smfmac_f32_16x16x64_bf16 v[104:107], v[40:43], a[160:167], v2
    s_waitcnt lgkmcnt(4)
    v_smfmac_f32_16x16x64_bf16 v[96:99], v[44:47], a[48:55], v2
    v_smfmac_f32_16x16x64_bf16 v[104:107], v[44:47], a[176:183], v2
    buffer_load_dwordx4 v1, s[4:7], s43 offen offset:1024 lds
    s_waitcnt lgkmcnt(3)
    v_smfmac_f32_16x16x64_bf16 v[96:99], v[48:51], a[64:71], v2
    v_smfmac_f32_16x16x64_bf16 v[104:107], v[48:51], a[192:199], v2
    s_waitcnt lgkmcnt(2)
    v_smfmac_f32_16x16x64_bf16 v[96:99], v[52:55], a[80:87], v2
    v_smfmac_f32_16x16x64_bf16 v[104:107], v[52:55], a[208:215], v2
    v_mov_b32 v4, s21
    buffer_store_dword v4, v7, s[4:7], 0 offen sc1
    s_waitcnt lgkmcnt(1)
    v_smfmac_f32_16x16x64_bf16 v[96:99], v[56:59], a[96:103], v2
    v_smfmac_f32_16x16x64_bf16 v[104:107], v[56:59], a[224:231], v2
    s_waitcnt lgkmcnt(0)
    v_smfmac_f32_16x16x64_bf16 v[96:99], v[60:63], a[112:119], v2
    v_smfmac_f32_16x16x64_bf16 v[104:107], v[60:63], a[240:247], v2
    v_smfmac_f32_16x16x64_bf16 v[100:103], v[40:43], a[40:47], v2
    s_nop 2
    v_smfmac_f32_16x16x64_bf16 v[100:103], v[44:47], a[56:63], v2
    s_nop 1
    v_add_f32 v96, v96, v98
    v_smfmac_f32_16x16x64_bf16 v[100:103], v[48:51], a[72:79], v2
    v_add_f32 v97, v97, v99
    v_add_f32 v104, v104, v106
    v_smfmac_f32_16x16x64_bf16 v[100:103], v[52:55], a[88:95], v2
    v_add_f32 v105, v105, v107
    v_cvt_pk_bf16_f32 v96, v96, v97
    v_smfmac_f32_16x16x64_bf16 v[100:103], v[56:59], a[104:111], v2
    v_cvt_pk_bf16_f32 v97, v104, v105
    v_and_or_b32 v96, v96, -2, s41
    v_smfmac_f32_16x16x64_bf16 v[100:103], v[60:63], a[120:127], v2
    buffer_store_dwordx2 v[96:97], v11, s[4:7], s37 offen sc1
    v_smfmac_f32_16x16x64_bf16 v[108:111], v[40:43], a[168:175], v2
    v_smfmac_f32_16x16x64_bf16 v[108:111], v[44:47], a[184:191], v2
    v_smfmac_f32_16x16x64_bf16 v[108:111], v[48:51], a[200:207], v2
    v_smfmac_f32_16x16x64_bf16 v[108:111], v[52:55], a[216:223], v2
    v_smfmac_f32_16x16x64_bf16 v[108:111], v[56:59], a[232:239], v2
    s_nop 2
    v_add_f32 v100, v100, v102
    v_smfmac_f32_16x16x64_bf16 v[108:111], v[60:63], a[248:255], v2
    v_add_f32 v101, v101, v103
    v_cvt_pk_bf16_f32 v98, v100, v101
    v_and_or_b32 v98, v98, -2, s41
    s_nop 4
    v_pk_add_f32 v[108:109], v[108:109], v[110:111]
    v_cvt_pk_bf16_f32 v99, v108, v109
    buffer_store_dwordx2 v[98:99], v11, s[4:7], s37 offen offset:512 sc1
    v_smfmac_f32_16x16x64_bf16 v[112:115], v[32:35], v[64:71], v2
    ds_read_b128 v[64:67], v1 offset:32768
    ds_read_b128 v[68:71], v1 offset:33792
    v_smfmac_f32_16x16x64_bf16 v[116:119], v[32:35], v[72:79], v2
    ds_read_b128 v[72:75], v1 offset:34816
    ds_read_b128 v[76:79], v1 offset:35840
    v_smfmac_f32_16x16x64_bf16 v[112:115], v[36:39], v[80:87], v2
    ds_read_b128 v[80:83], v1 offset:49152
    ds_read_b128 v[84:87], v1 offset:50176
    v_smfmac_f32_16x16x64_bf16 v[116:119], v[36:39], v[88:95], v2
    ds_read_b128 v[88:91], v1 offset:51200
    ds_read_b128 v[92:95], v1 offset:52224
    s_waitcnt lgkmcnt(6)
    v_smfmac_f32_16x16x64_bf16 v[112:115], v[40:43], v[64:71], v2
    ds_read_b128 v[64:67], v5 offset:0
    ds_read_b128 v[68:71], v5 offset:1024
    s_waitcnt lgkmcnt(6)
    v_smfmac_f32_16x16x64_bf16 v[116:119], v[40:43], v[72:79], v2
    ds_read_b128 v[72:75], v5 offset:2048
    ds_read_b128 v[76:79], v5 offset:3072
    s_waitcnt lgkmcnt(6)
    v_smfmac_f32_16x16x64_bf16 v[112:115], v[44:47], v[80:87], v2
    ds_read_b128 v[80:83], v5 offset:16384
    ds_read_b128 v[84:87], v5 offset:17408
    s_waitcnt lgkmcnt(6)
    v_smfmac_f32_16x16x64_bf16 v[116:119], v[44:47], v[88:95], v2
    ds_read_b128 v[88:91], v5 offset:18432
    ds_read_b128 v[92:95], v5 offset:19456
    s_waitcnt lgkmcnt(6)
    v_smfmac_f32_16x16x64_bf16 v[112:115], v[48:51], v[64:71], v2
    ds_read_b128 v[64:67], v5 offset:32768
    ds_read_b128 v[68:71], v5 offset:33792
    s_waitcnt lgkmcnt(6)
    v_smfmac_f32_16x16x64_bf16 v[116:119], v[48:51], v[72:79], v2
    ds_read_b128 v[72:75], v5 offset:34816
    ds_read_b128 v[76:79], v5 offset:35840
    s_waitcnt lgkmcnt(6)
    v_smfmac_f32_16x16x64_bf16 v[112:115], v[52:55], v[80:87], v2
    ds_read_b128 v[80:83], v5 offset:49152
    ds_read_b128 v[84:87], v5 offset:50176
    s_waitcnt lgkmcnt(6)
    v_smfmac_f32_16x16x64_bf16 v[116:119], v[52:55], v[88:95], v2
    ds_read_b128 v[88:91], v5 offset:51200
    ds_read_b128 v[92:95], v5 offset:52224
    s_waitcnt lgkmcnt(6)
    v_smfmac_f32_16x16x64_bf16 v[112:115], v[56:59], v[64:71], v2
    s_waitcnt lgkmcnt(4)
    v_smfmac_f32_16x16x64_bf16 v[116:119], v[56:59], v[72:79], v2
    s_waitcnt lgkmcnt(2)
    v_smfmac_f32_16x16x64_bf16 v[112:115], v[60:63], v[80:87], v2
    s_waitcnt lgkmcnt(0)
    v_smfmac_f32_16x16x64_bf16 v[116:119], v[60:63], v[88:95], v2
    buffer_load_dwordx2 v[108:109], v11, s[4:7], s38 offen sc1
    v_mfma_f32_16x16x16_bf16 v[100:103], v[96:97], v[16:17], 0
    v_mfma_f32_16x16x16_bf16 v[104:107], v[98:99], v[16:17], 0
    s_nop 4
    v_add_f32 v112, v112, v114
    v_add_f32 v113, v113, v115
    v_add_f32 v114, v116, v118
    v_add_f32 v115, v117, v119
    v_cvt_pk_bf16_f32 v18, v112, v113
    v_cvt_pk_bf16_f32 v19, v114, v115
    v_and_or_b32 v18, v18, -2, s41
    buffer_load_dwordx2 v[110:111], v11, s[4:7], s38 offen offset:512 sc1
    s_barrier
    buffer_store_dwordx2 v[18:19], v11, s[4:7], s39 offen sc1
    v_mov_b32 v112, v18
    v_mov_b32 v114, v19
    v_mov_b32 v92, v28
    v_mov_b32 v93, 0
    s_waitcnt vmcnt(6)
    s_barrier
    ds_read_b128 v[32:35], v6 offset:9216
    ds_read_b128 v[36:39], v6 offset:10240
    ds_read_b128 v[40:43], v6 offset:14336
    ds_read_b128 v[44:47], v6 offset:15360
    ds_read_b128 v[48:51], v6 offset:19456
    ds_read_b128 v[52:55], v6 offset:20480
    ds_read_b128 v[56:59], v6 offset:24576
    ds_read_b128 v[60:63], v6 offset:25600
    buffer_load_dwordx2 v[20:21], v11, s[4:7], s38 offen sc1
    buffer_load_dwordx2 v[22:23], v11, s[4:7], s38 offen offset:512 sc1
    s_waitcnt vmcnt(4)
    v_mfma_f32_16x16x16_bf16 v[80:83], v[108:109], v[16:17], v[100:103]
    v_and_b32 v3, 1, v108
    v_cmp_ne_u32 vcc, s41, v3
    s_nop 5
    v_cvt_pk_bf16_f32 v64, v80, v81
    v_cvt_pk_bf16_f32 v65, v82, v83
    s_cbranch_vccnz mega_kernel_rf_w0_xslow
    s_waitcnt vmcnt(3)
    v_mfma_f32_16x16x16_bf16 v[84:87], v[110:111], v[16:17], v[104:107]
    v_and_b32 v3, 1, v110
    v_cmp_ne_u32 vcc, s41, v3
    s_nop 5
    v_cvt_pk_bf16_f32 v66, v84, v85
    v_cvt_pk_bf16_f32 v67, v86, v87
    ds_write_b128 v6, v[64:67] offset:8192
    s_cbranch_vccnz mega_kernel_rf_w0_xslow
mega_kernel_rf_w0_xok:
    s_cmp_eq_u32 s21, 63
    s_cbranch_scc1 mega_kernel_rf_w0_last
    buffer_load_dwordx2 v[116:117], v11, s[4:7], s40 offen sc1
    s_waitcnt lgkmcnt(1)
    v_mfma_f32_16x16x32_bf16 v[80:83], v[32:35], v[64:67], 0
    s_waitcnt lgkmcnt(0)
    s_barrier
    ds_read_b128 v[68:71], v6 offset:13312
    ds_read_b128 v[72:75], v6 offset:18432
    ds_read_b128 v[76:79], v6 offset:23552
    v_mfma_f32_16x16x32_bf16 v[84:87], v[36:39], v[64:67], 0
    v_mfma_f32_16x16x32_bf16 v[88:91], v[64:67], v[64:67], 0
    buffer_load_dwordx2 v[20:21], v11, s[4:7], s40 offen sc1
    s_waitcnt lgkmcnt(2)
    v_mfma_f32_16x16x32_bf16 v[80:83], v[40:43], v[68:71], v[80:83]
    buffer_store_dwordx4 v[64:67], v10, s[4:7], s45 offen offset:0 sc1
    s_waitcnt lgkmcnt(1)
    v_mfma_f32_16x16x32_bf16 v[80:83], v[48:51], v[72:75], v[80:83]
    s_waitcnt lgkmcnt(0)
    v_mfma_f32_16x16x32_bf16 v[80:83], v[56:59], v[76:79], v[80:83]
    v_mfma_f32_16x16x32_bf16 v[84:87], v[44:47], v[68:71], v[84:87]
    v_mfma_f32_16x16x32_bf16 v[84:87], v[52:55], v[72:75], v[84:87]
    buffer_store_dwordx2 v[18:19], v11, s[4:7], s51 offen offset:2048 sc1
    v_mfma_f32_16x16x32_bf16 v[84:87], v[60:63], v[76:79], v[84:87]
    v_mfma_f32_16x16x32_bf16 v[88:91], v[68:71], v[68:71], v[88:91]
    v_mfma_f32_16x16x32_bf16 v[88:91], v[72:75], v[72:75], v[88:91]
    v_mfma_f32_16x16x32_bf16 v[88:91], v[76:79], v[76:79], v[88:91]
    v_mfma_f32_32x32x4_2b_bf16 v[32:63], v[14:15], v[14:15], 0
    s_nop 0
    v_max3_f32 v4, v80, v81, v82
    s_nop 1
    v_max3_f32 v4, v4, v83, v84
    v_max3_f32 v4, v4, v85, v86
    v_max_f32 v4, v4, v87
    v_max3_f32 v90, v4, v88, v89
    v_max3_f32 v4, v4, v88, v89
    s_nop 1
    v_permlane16_swap_b32 v4, v90
    v_max_f32 v4, v4, v90
    v_max_f32 v90, v4, v90
    s_nop 1
    v_permlane32_swap_b32 v4, v90
    v_max_f32 v4, v4, v90
    v_mul_f32 v4, s34, v4
    v_pk_fma_f32 v[80:81], v[80:81], s[34:35], v[4:5] op_sel_hi:[1,0,0] neg_lo:[0,0,1] neg_hi:[0,0,1]
    v_pk_fma_f32 v[82:83], v[82:83], s[34:35], v[4:5] op_sel_hi:[1,0,0] neg_lo:[0,0,1] neg_hi:[0,0,1]
    v_pk_fma_f32 v[84:85], v[84:85], s[34:35], v[4:5] op_sel_hi:[1,0,0] neg_lo:[0,0,1] neg_hi:[0,0,1]
    v_pk_fma_f32 v[86:87], v[86:87], s[34:35], v[4:5] op_sel_hi:[1,0,0] neg_lo:[0,0,1] neg_hi:[0,0,1]
    v_pk_fma_f32 v[88:89], v[88:89], s[34:35], v[4:5] op_sel_hi:[1,0,0] neg_lo:[0,0,1] neg_hi:[0,0,1]
    v_exp_f32 v80, v80
    v_exp_f32 v81, v81
    v_exp_f32 v82, v82
    v_cvt_pk_bf16_f32 v68, v80, v81
    v_exp_f32 v83, v83
    v_exp_f32 v84, v84
    v_cvt_pk_bf16_f32 v69, v82, v83
    v_exp_f32 v85, v85
    v_exp_f32 v86, v86
    v_cvt_pk_bf16_f32 v70, v84, v85
    v_exp_f32 v87, v87
    v_exp_f32 v88, v88
    v_cvt_pk_bf16_f32 v71, v86, v87
    v_exp_f32 v89, v89
    s_waitcnt vmcnt(3)
    v_mfma_f32_16x16x32_bf16 v[76:79], v[28:31], v[68:71], 0
    v_and_b32 v3, 1, v116
    v_cvt_pk_bf16_f32 v72, v88, v89
    v_mfma_f32_16x16x32_bf16 v[100:103], v[120:123], v[68:71], 0
    v_cmp_ne_u32 vcc, s41, v3
    v_cvt_pk_bf16_f32 v73, v88, v89
    v_mfma_f32_16x16x32_bf16 v[104:107], v[124:127], v[68:71], 0
    v_mov_b32 v113, v116
    v_mov_b32 v115, v117
    v_mfma_f32_16x16x16_bf16 v[76:79], v[92:93], v[72:73], v[76:79]
    s_cbranch_vccnz mega_kernel_rf_w0_pv0
mega_kernel_rf_w0_pv2:
    v_mfma_f32_16x16x16_bf16 v[100:103], v[112:113], v[72:73], v[100:103]
    v_mfma_f32_16x16x16_bf16 v[104:107], v[114:115], v[72:73], v[104:107]
    buffer_load_dwordx4 v[120:123], v1, s[4:7], s44 offen
    buffer_load_dwordx4 v[124:127], v1, s[4:7], s44 offen offset:1024
    s_nop 2
    v_rcp_f32 v76, v76
    s_mov_b64 exec, s[28:29]
    v_pk_mul_f32 v[100:101], v[100:101], v[76:77] op_sel_hi:[1,0]
    v_pk_mul_f32 v[102:103], v[102:103], v[76:77] op_sel_hi:[1,0]
    v_pk_mul_f32 v[104:105], v[104:105], v[76:77] op_sel_hi:[1,0]
    v_pk_mul_f32 v[106:107], v[106:107], v[76:77] op_sel_hi:[1,0]
    v_cvt_pk_bf16_f32 v84, v100, v101
    v_cvt_pk_bf16_f32 v85, v102, v103
    v_cvt_pk_bf16_f32 v86, v104, v105
    v_cvt_pk_bf16_f32 v87, v106, v107
    ds_write_b128 v6, v[84:87] offset:28640
    s_mov_b64 exec, -1
    s_waitcnt lgkmcnt(0)
    s_barrier
    ds_read_b128 v[68:71], v6 offset:28672
    ds_read_b128 v[72:75], v6 offset:29696
    s_waitcnt lgkmcnt(1)
    v_smfmac_f32_16x16x64_bf16 v[32:35], v[68:71], v[128:135], v2
    s_add_u32 s21, s21, 1
    s_xor_b32 s38, s38, 1048576
    s_xor_b32 s37, s37, 1048576
    s_waitcnt lgkmcnt(0)
    v_smfmac_f32_16x16x64_bf16 v[32:35], v[72:75], v[136:143], v2
    s_xor_b32 s40, s40, 1048576
    s_xor_b32 s39, s39, 1048576
    s_lshr_b32 s41, s21, 1
    v_smfmac_f32_16x16x64_bf16 v[36:39], v[68:71], v[144:151], v2
    s_and_b32 s41, s41, 1
    s_xor_b32 s41, s41, 1
    s_xor_b32 s35, s35, 16384
    v_smfmac_f32_16x16x64_bf16 v[36:39], v[72:75], v[152:159], v2
    v_add_f32 v32, v32, v34
    s_xor_b32 s36, s36, 16384
    s_add_u32 s43, s43, 262144
    s_add_u32 s44, s44, 262144
    v_smfmac_f32_16x16x64_bf16 v[40:43], v[68:71], v[160:167], v2
    v_add_f32 v33, v33, v35
    v_smfmac_f32_16x16x64_bf16 v[40:43], v[72:75], v[168:175], v2
    v_cvt_pk_bf16_f32 v32, v32, v33
    v_smfmac_f32_16x16x64_bf16 v[44:47], v[68:71], v[176:183], v2
    v_and_or_b32 v32, v32, -2, s42
    v_smfmac_f32_16x16x64_bf16 v[44:47], v[72:75], v[184:191], v2
    v_add_f32 v36, v36, v38
    v_smfmac_f32_16x16x64_bf16 v[48:51], v[68:71], v[192:199], v2
    v_add_f32 v37, v37, v39
    v_smfmac_f32_16x16x64_bf16 v[48:51], v[72:75], v[200:207], v2
    v_cvt_pk_bf16_f32 v33, v36, v37
    v_smfmac_f32_16x16x64_bf16 v[52:55], v[68:71], v[208:215], v2
    v_add_f32 v40, v40, v42
    v_smfmac_f32_16x16x64_bf16 v[52:55], v[72:75], v[216:223], v2
    v_add_f32 v41, v41, v43
    v_smfmac_f32_16x16x64_bf16 v[56:59], v[68:71], v[224:231], v2
    v_cvt_pk_bf16_f32 v34, v40, v41
    v_smfmac_f32_16x16x64_bf16 v[56:59], v[72:75], v[232:239], v2
    v_add_f32 v44, v44, v46
    v_smfmac_f32_16x16x64_bf16 v[60:63], v[68:71], v[240:247], v2
    v_add_f32 v45, v45, v47
    v_smfmac_f32_16x16x64_bf16 v[60:63], v[72:75], v[248:255], v2
    v_cvt_pk_bf16_f32 v35, v44, v45
    buffer_store_dwordx4 v[32:35], v8, s[4:7], s46 offen
    v_pk_add_f32 v[48:49], v[48:49], v[50:51]
    v_cvt_pk_bf16_f32 v48, v48, v49
    v_and_or_b32 v48, v48, -2, s42
    v_pk_add_f32 v[52:53], v[52:53], v[54:55]
    v_cvt_pk_bf16_f32 v49, v52, v53
    v_pk_add_f32 v[56:57], v[56:57], v[58:59]
    v_cvt_pk_bf16_f32 v50, v56, v57
    v_pk_add_f32 v[60:61], v[60:61], v[62:63]
    v_cvt_pk_bf16_f32 v51, v60, v61
    buffer_store_dwordx4 v[48:51], v8, s[4:7], s61 offen
    s_add_u32 s45, s45, 262144
    s_add_u32 s51, s51, 262144
    v_mfma_f32_32x32x8_bf16 v[96:111], v[14:15], v[14:15], 0
    v_mfma_f32_16x16x16_bf16 v[112:115], v[14:15], v[14:15], 0
    v_mfma_f32_16x16x16_bf16 v[116:119], v[14:15], v[14:15], 0
    ds_read_b128 v[64:67], v1 offset:0
    ds_read_b128 v[68:71], v1 offset:1024
    ds_read_b128 v[72:75], v1 offset:2048
    ds_read_b128 v[76:79], v1 offset:3072
    ds_read_b128 v[80:83], v1 offset:16384
    ds_read_b128 v[84:87], v1 offset:17408
    ds_read_b128 v[88:91], v1 offset:18432
    ds_read_b128 v[92:95], v1 offset:19456
    v_mov_b32 v58, -1
    v_mov_b32 v59, -1
    s_waitcnt vmcnt(0)
mega_kernel_rf_w0_pc:
    buffer_load_dword v36, v13, s[4:7], s25 offen offset:0 sc1
    buffer_load_dword v37, v13, s[4:7], s25 offen offset:256 sc1
    buffer_load_dword v38, v13, s[4:7], s25 offen offset:512 sc1
    buffer_load_dword v39, v13, s[4:7], s25 offen offset:768 sc1
    buffer_load_dword v40, v13, s[4:7], s25 offen offset:1024 sc1
    buffer_load_dword v41, v13, s[4:7], s25 offen offset:1280 sc1
    buffer_load_dword v42, v13, s[4:7], s25 offen offset:1536 sc1
    buffer_load_dword v43, v13, s[4:7], s25 offen offset:1792 sc1
    s_waitcnt vmcnt(4)
    v_mfma_f32_16x16x32_bf16 v[52:55], v[36:39], v[24:27], 0
    v_bitop3_b32 v3, s42, v36, v37 bitop3:0x7e
    v_bitop3_b32 v4, s42, v38, v39 bitop3:0x7e
    s_waitcnt vmcnt(2)
    v_or_b32 v3, v3, v4
    v_bitop3_b32 v4, s42, v40, v41 bitop3:0x7e
    s_waitcnt vmcnt(0)
    v_mfma_f32_16x16x32_bf16 v[52:55], v[40:43], v[24:27], v[52:55]
    v_bitop3_b32 v56, s42, v42, v43 bitop3:0x7e
    v_or3_b32 v3, v3, v4, v56
    v_and_b32 v3, v0, v3
    v_cmp_ne_u32 vcc, 0, v3
    s_nop 3
    v_cvt_pk_bf16_f32 v56, v52, v53
    v_cvt_pk_bf16_f32 v57, v54, v55
    v_min_u32 v56, -2, v56
    s_cbranch_vccnz mega_kernel_rf_w0_pc
    s_mov_b64 exec, s[26:27]
    buffer_store_dwordx2 v[56:57], v9, s[4:7], s35 offen offset:0
    buffer_store_dwordx2 v[58:59], v9, s[4:7], s36 offen offset:0
    s_mov_b64 exec, -1
    s_xor_b32 s42, s42, 1
    s_branch mega_kernel_rf_w0_loop
mega_kernel_rf_w0_last:
    buffer_store_dwordx4 v[64:67], v10, s[4:7], s45 offen offset:0 sc1
    buffer_store_dwordx2 v[18:19], v11, s[4:7], s51 offen offset:2048 sc1
    s_branch mega_kernel_rf_end
mega_kernel_rf_w0_pafail:
    s_nop 7
    v_mov_b32 v96, 0
    v_mov_b32 v97, 0
    v_mov_b32 v98, 0
    v_mov_b32 v99, 0
    v_mov_b32 v100, 0
    v_mov_b32 v101, 0
    v_mov_b32 v102, 0
    v_mov_b32 v103, 0
    v_mov_b32 v104, 0
    v_mov_b32 v105, 0
    v_mov_b32 v106, 0
    v_mov_b32 v107, 0
    s_branch mega_kernel_rf_w0_pa
mega_kernel_rf_w0_xslow:
    buffer_load_dwordx2 v[108:109], v11, s[4:7], s38 offen sc1
    buffer_load_dwordx2 v[110:111], v11, s[4:7], s38 offen offset:512 sc1
    s_waitcnt vmcnt(2)
    v_bitop3_b32 v3, s41, v20, v22 bitop3:0x7e
    v_mfma_f32_16x16x16_bf16 v[80:83], v[20:21], v[16:17], v[100:103]
    v_and_b32 v3, 1, v3
    v_mfma_f32_16x16x16_bf16 v[84:87], v[22:23], v[16:17], v[104:107]
    v_cmp_ne_u32 vcc, 0, v3
    s_cbranch_vccz mega_kernel_rf_w0_xgot
    buffer_load_dwordx2 v[20:21], v11, s[4:7], s38 offen sc1
    buffer_load_dwordx2 v[22:23], v11, s[4:7], s38 offen offset:512 sc1
    s_waitcnt vmcnt(2)
    v_bitop3_b32 v3, s41, v108, v110 bitop3:0x7e
    v_mfma_f32_16x16x16_bf16 v[80:83], v[108:109], v[16:17], v[100:103]
    v_and_b32 v3, 1, v3
    v_mfma_f32_16x16x16_bf16 v[84:87], v[110:111], v[16:17], v[104:107]
    v_cmp_ne_u32 vcc, 0, v3
    s_cbranch_vccz mega_kernel_rf_w0_xgot
    s_branch mega_kernel_rf_w0_xslow
mega_kernel_rf_w0_xgot:
    s_nop 3
    v_cvt_pk_bf16_f32 v64, v80, v81
    v_cvt_pk_bf16_f32 v65, v82, v83
    v_cvt_pk_bf16_f32 v66, v84, v85
    v_cvt_pk_bf16_f32 v67, v86, v87
    ds_write_b128 v6, v[64:67] offset:8192
    s_branch mega_kernel_rf_w0_xok
mega_kernel_rf_w0_pv0:
    s_waitcnt vmcnt(2)
    s_branch mega_kernel_rf_w0_pv1
mega_kernel_rf_w0_pv:
    buffer_load_dwordx2 v[20:21], v11, s[4:7], s40 offen sc1
    s_waitcnt vmcnt(0)
mega_kernel_rf_w0_pv1:
    v_and_b32 v3, 1, v20
    v_cmp_ne_u32 vcc, s41, v3
    v_mov_b32 v113, v20
    v_mov_b32 v115, v21
    s_cbranch_vccnz mega_kernel_rf_w0_pv
    s_branch mega_kernel_rf_w0_pv2
mega_kernel_rf_w1_entry:
    v_mfma_f32_32x32x8_bf16 v[96:111], v[14:15], v[14:15], 0
    v_mfma_f32_16x16x16_bf16 v[112:115], v[14:15], v[14:15], 0
    v_mfma_f32_16x16x16_bf16 v[116:119], v[14:15], v[14:15], 0
    ds_read_b128 v[64:67], v1 offset:4096
    ds_read_b128 v[68:71], v1 offset:5120
    ds_read_b128 v[72:75], v1 offset:6144
    ds_read_b128 v[76:79], v1 offset:7168
    ds_read_b128 v[80:83], v1 offset:20480
    ds_read_b128 v[84:87], v1 offset:21504
    ds_read_b128 v[88:91], v1 offset:22528
    ds_read_b128 v[92:95], v1 offset:23552
    buffer_load_dwordx4 v[120:123], v1, s[4:7], s44 offen
    buffer_load_dwordx4 v[124:127], v1, s[4:7], s44 offen offset:1024
    s_add_u32 s44, s44, 262144
mega_kernel_rf_w1_loop:
    s_add_u32 s22, s35, 2048
    s_waitcnt vmcnt(0)
    buffer_load_dwordx4 v[40:43], v1, s[4:7], s22 offen sc1
    buffer_load_dwordx4 v[44:47], v1, s[4:7], s22 offen offset:1024 sc1
mega_kernel_rf_w1_pa:
    s_waitcnt vmcnt(1)
    ds_write_b128 v6, v[40:43] offset:2048
    s_waitcnt vmcnt(0)
    ds_write_b128 v6, v[44:47] offset:3072
    v_max3_u32 v3, v40, v42, v44
    v_max_u32 v3, v3, v46
    v_cmp_eq_u32 vcc, -1, v3
    v_smfmac_f32_16x16x64_bf16 v[96:99], v[40:43], a[32:39], v2
    buffer_load_dwordx4 v[40:43], v1, s[4:7], s22 offen sc1
    v_smfmac_f32_16x16x64_bf16 v[100:103], v[40:43], a[40:47], v2
    buffer_load_dwordx4 v[44:47], v1, s[4:7], s22 offen offset:1024 sc1
    v_smfmac_f32_16x16x64_bf16 v[104:107], v[40:43], a[160:167], v2
    s_cbranch_vccnz mega_kernel_rf_w1_pafail
    s_waitcnt lgkmcnt(0)
    s_barrier
    ds_read_b128 v[48:51], v6 offset:4096
    ds_read_b128 v[52:55], v6 offset:5120
    v_smfmac_f32_16x16x64_bf16 v[108:111], v[40:43], a[168:175], v2
    ds_read_b128 v[56:59], v6 offset:6144
    v_smfmac_f32_16x16x64_bf16 v[96:99], v[44:47], a[48:55], v2
    ds_read_b128 v[60:63], v6 offset:7168
    v_smfmac_f32_16x16x64_bf16 v[100:103], v[44:47], a[56:63], v2
    ds_read_b128 v[32:35], v6 offset:0
    v_smfmac_f32_16x16x64_bf16 v[104:107], v[44:47], a[176:183], v2
    ds_read_b128 v[36:39], v6 offset:1024
    v_smfmac_f32_16x16x64_bf16 v[108:111], v[44:47], a[184:191], v2
    s_waitcnt lgkmcnt(5)
    v_smfmac_f32_16x16x64_bf16 v[96:99], v[48:51], a[64:71], v2
    buffer_load_dwordx4 v1, s[4:7], s43 offen lds
    v_smfmac_f32_16x16x64_bf16 v[104:107], v[48:51], a[192:199], v2
    s_waitcnt lgkmcnt(4)
    v_smfmac_f32_16x16x64_bf16 v[96:99], v[52:55], a[80:87], v2
    v_smfmac_f32_16x16x64_bf16 v[104:107], v[52:55], a[208:215], v2
    s_waitcnt lgkmcnt(3)
    v_smfmac_f32_16x16x64_bf16 v[96:99], v[56:59], a[96:103], v2
    buffer_load_dwordx4 v1, s[4:7], s43 offen offset:1024 lds
    v_smfmac_f32_16x16x64_bf16 v[104:107], v[56:59], a[224:231], v2
    s_waitcnt lgkmcnt(2)
    v_smfmac_f32_16x16x64_bf16 v[96:99], v[60:63], a[112:119], v2
    v_smfmac_f32_16x16x64_bf16 v[104:107], v[60:63], a[240:247], v2
    s_waitcnt lgkmcnt(1)
    v_smfmac_f32_16x16x64_bf16 v[96:99], v[32:35], a[0:7], v2
    v_smfmac_f32_16x16x64_bf16 v[104:107], v[32:35], a[128:135], v2
    s_waitcnt lgkmcnt(0)
    v_smfmac_f32_16x16x64_bf16 v[96:99], v[36:39], a[16:23], v2
    v_smfmac_f32_16x16x64_bf16 v[104:107], v[36:39], a[144:151], v2
    v_smfmac_f32_16x16x64_bf16 v[100:103], v[48:51], a[72:79], v2
    s_nop 2
    v_smfmac_f32_16x16x64_bf16 v[100:103], v[52:55], a[88:95], v2
    s_nop 1
    v_add_f32 v96, v96, v98
    v_smfmac_f32_16x16x64_bf16 v[100:103], v[56:59], a[104:111], v2
    v_add_f32 v97, v97, v99
    v_add_f32 v104, v104, v106
    v_smfmac_f32_16x16x64_bf16 v[100:103], v[60:63], a[120:127], v2
    v_add_f32 v105, v105, v107
    v_cvt_pk_bf16_f32 v96, v96, v97
    v_smfmac_f32_16x16x64_bf16 v[100:103], v[32:35], a[8:15], v2
    v_cvt_pk_bf16_f32 v97, v104, v105
    v_and_or_b32 v96, v96, -2, s41
    v_smfmac_f32_16x16x64_bf16 v[100:103], v[36:39], a[24:31], v2
    buffer_store_dwordx2 v[96:97], v11, s[4:7], s37 offen sc1
    v_smfmac_f32_16x16x64_bf16 v[108:111], v[48:51], a[200:207], v2
    v_smfmac_f32_16x16x64_bf16 v[108:111], v[52:55], a[216:223], v2
    v_smfmac_f32_16x16x64_bf16 v[108:111], v[56:59], a[232:239], v2
    v_smfmac_f32_16x16x64_bf16 v[108:111], v[60:63], a[248:255], v2
    v_smfmac_f32_16x16x64_bf16 v[108:111], v[32:35], a[136:143], v2
    s_nop 2
    v_add_f32 v100, v100, v102
    v_smfmac_f32_16x16x64_bf16 v[108:111], v[36:39], a[152:159], v2
    v_add_f32 v101, v101, v103
    v_cvt_pk_bf16_f32 v98, v100, v101
    v_and_or_b32 v98, v98, -2, s41
    s_nop 4
    v_pk_add_f32 v[108:109], v[108:109], v[110:111]
    v_cvt_pk_bf16_f32 v99, v108, v109
    buffer_store_dwordx2 v[98:99], v11, s[4:7], s37 offen offset:512 sc1
    v_smfmac_f32_16x16x64_bf16 v[112:115], v[32:35], v[64:71], v2
    ds_read_b128 v[64:67], v1 offset:36864
    ds_read_b128 v[68:71], v1 offset:37888
    v_smfmac_f32_16x16x64_bf16 v[116:119], v[32:35], v[72:79], v2
    ds_read_b128 v[72:75], v1 offset:38912
    ds_read_b128 v[76:79], v1 offset:39936
    v_smfmac_f32_16x16x64_bf16 v[112:115], v[36:39], v[80:87], v2
    ds_read_b128 v[80:83], v1 offset:53248
    ds_read_b128 v[84:87], v1 offset:54272
    v_smfmac_f32_16x16x64_bf16 v[116:119], v[36:39], v[88:95], v2
    ds_read_b128 v[88:91], v1 offset:55296
    ds_read_b128 v[92:95], v1 offset:56320
    s_waitcnt lgkmcnt(6)
    v_smfmac_f32_16x16x64_bf16 v[112:115], v[40:43], v[64:71], v2
    ds_read_b128 v[64:67], v5 offset:4096
    ds_read_b128 v[68:71], v5 offset:5120
    s_waitcnt lgkmcnt(6)
    v_smfmac_f32_16x16x64_bf16 v[116:119], v[40:43], v[72:79], v2
    ds_read_b128 v[72:75], v5 offset:6144
    ds_read_b128 v[76:79], v5 offset:7168
    s_waitcnt lgkmcnt(6)
    v_smfmac_f32_16x16x64_bf16 v[112:115], v[44:47], v[80:87], v2
    ds_read_b128 v[80:83], v5 offset:20480
    ds_read_b128 v[84:87], v5 offset:21504
    s_waitcnt lgkmcnt(6)
    v_smfmac_f32_16x16x64_bf16 v[116:119], v[44:47], v[88:95], v2
    ds_read_b128 v[88:91], v5 offset:22528
    ds_read_b128 v[92:95], v5 offset:23552
    s_waitcnt lgkmcnt(6)
    v_smfmac_f32_16x16x64_bf16 v[112:115], v[48:51], v[64:71], v2
    ds_read_b128 v[64:67], v5 offset:36864
    ds_read_b128 v[68:71], v5 offset:37888
    s_waitcnt lgkmcnt(6)
    v_smfmac_f32_16x16x64_bf16 v[116:119], v[48:51], v[72:79], v2
    ds_read_b128 v[72:75], v5 offset:38912
    ds_read_b128 v[76:79], v5 offset:39936
    s_waitcnt lgkmcnt(6)
    v_smfmac_f32_16x16x64_bf16 v[112:115], v[52:55], v[80:87], v2
    ds_read_b128 v[80:83], v5 offset:53248
    ds_read_b128 v[84:87], v5 offset:54272
    s_waitcnt lgkmcnt(6)
    v_smfmac_f32_16x16x64_bf16 v[116:119], v[52:55], v[88:95], v2
    ds_read_b128 v[88:91], v5 offset:55296
    ds_read_b128 v[92:95], v5 offset:56320
    s_waitcnt lgkmcnt(6)
    v_smfmac_f32_16x16x64_bf16 v[112:115], v[56:59], v[64:71], v2
    s_waitcnt lgkmcnt(4)
    v_smfmac_f32_16x16x64_bf16 v[116:119], v[56:59], v[72:79], v2
    s_waitcnt lgkmcnt(2)
    v_smfmac_f32_16x16x64_bf16 v[112:115], v[60:63], v[80:87], v2
    s_waitcnt lgkmcnt(0)
    v_smfmac_f32_16x16x64_bf16 v[116:119], v[60:63], v[88:95], v2
    buffer_load_dwordx2 v[108:109], v11, s[4:7], s38 offen sc1
    v_mfma_f32_16x16x16_bf16 v[100:103], v[96:97], v[16:17], 0
    v_mfma_f32_16x16x16_bf16 v[104:107], v[98:99], v[16:17], 0
    s_nop 4
    v_add_f32 v112, v112, v114
    v_add_f32 v113, v113, v115
    v_add_f32 v114, v116, v118
    v_add_f32 v115, v117, v119
    v_cvt_pk_bf16_f32 v18, v112, v113
    v_cvt_pk_bf16_f32 v19, v114, v115
    v_and_or_b32 v18, v18, -2, s41
    buffer_load_dwordx2 v[110:111], v11, s[4:7], s38 offen offset:512 sc1
    s_barrier
    buffer_store_dwordx2 v[18:19], v11, s[4:7], s39 offen sc1
    v_mov_b32 v112, v18
    v_mov_b32 v114, v19
    v_mov_b32 v92, v28
    v_mov_b32 v93, 0
    s_waitcnt vmcnt(5)
    s_barrier
    ds_read_b128 v[32:35], v6 offset:14336
    ds_read_b128 v[36:39], v6 offset:15360
    ds_read_b128 v[40:43], v6 offset:9216
    ds_read_b128 v[44:47], v6 offset:10240
    ds_read_b128 v[48:51], v6 offset:24576
    ds_read_b128 v[52:55], v6 offset:25600
    ds_read_b128 v[56:59], v6 offset:19456
    ds_read_b128 v[60:63], v6 offset:20480
    buffer_load_dwordx2 v[20:21], v11, s[4:7], s38 offen sc1
    buffer_load_dwordx2 v[22:23], v11, s[4:7], s38 offen offset:512 sc1
    s_waitcnt vmcnt(4)
    v_mfma_f32_16x16x16_bf16 v[80:83], v[108:109], v[16:17], v[100:103]
    v_and_b32 v3, 1, v108
    v_cmp_ne_u32 vcc, s41, v3
    s_nop 5
    v_cvt_pk_bf16_f32 v64, v80, v81
    v_cvt_pk_bf16_f32 v65, v82, v83
    s_cbranch_vccnz mega_kernel_rf_w1_xslow
    s_waitcnt vmcnt(3)
    v_mfma_f32_16x16x16_bf16 v[84:87], v[110:111], v[16:17], v[104:107]
    v_and_b32 v3, 1, v110
    v_cmp_ne_u32 vcc, s41, v3
    s_nop 5
    v_cvt_pk_bf16_f32 v66, v84, v85
    v_cvt_pk_bf16_f32 v67, v86, v87
    ds_write_b128 v6, v[64:67] offset:13312
    s_cbranch_vccnz mega_kernel_rf_w1_xslow
mega_kernel_rf_w1_xok:
    s_cmp_eq_u32 s21, 63
    s_cbranch_scc1 mega_kernel_rf_w1_last
    buffer_load_dwordx2 v[116:117], v11, s[4:7], s40 offen sc1
    s_waitcnt lgkmcnt(1)
    v_mfma_f32_16x16x32_bf16 v[80:83], v[32:35], v[64:67], 0
    s_waitcnt lgkmcnt(0)
    s_barrier
    ds_read_b128 v[68:71], v6 offset:8192
    ds_read_b128 v[72:75], v6 offset:23552
    ds_read_b128 v[76:79], v6 offset:18432
    v_mfma_f32_16x16x32_bf16 v[84:87], v[36:39], v[64:67], 0
    v_mfma_f32_16x16x32_bf16 v[88:91], v[64:67], v[64:67], 0
    buffer_load_dwordx2 v[20:21], v11, s[4:7], s40 offen sc1
    s_waitcnt lgkmcnt(2)
    v_mfma_f32_16x16x32_bf16 v[80:83], v[40:43], v[68:71], v[80:83]
    s_waitcnt lgkmcnt(1)
    v_mfma_f32_16x16x32_bf16 v[80:83], v[48:51], v[72:75], v[80:83]
    buffer_store_dwordx4 v[64:67], v10, s[4:7], s45 offen offset:64 sc1
    s_waitcnt lgkmcnt(0)
    v_mfma_f32_16x16x32_bf16 v[80:83], v[56:59], v[76:79], v[80:83]
    v_mfma_f32_16x16x32_bf16 v[84:87], v[44:47], v[68:71], v[84:87]
    v_mfma_f32_16x16x32_bf16 v[84:87], v[52:55], v[72:75], v[84:87]
    v_mfma_f32_16x16x32_bf16 v[84:87], v[60:63], v[76:79], v[84:87]
    buffer_store_dwordx2 v[18:19], v11, s[4:7], s51 offen offset:2560 sc1
    v_mfma_f32_16x16x32_bf16 v[88:91], v[68:71], v[68:71], v[88:91]
    v_mfma_f32_16x16x32_bf16 v[88:91], v[72:75], v[72:75], v[88:91]
    v_mfma_f32_16x16x32_bf16 v[88:91], v[76:79], v[76:79], v[88:91]
    v_mfma_f32_32x32x4_2b_bf16 v[32:63], v[14:15], v[14:15], 0
    s_nop 0
    v_max3_f32 v4, v80, v81, v82
    s_nop 1
    v_max3_f32 v4, v4, v83, v84
    v_max3_f32 v4, v4, v85, v86
    v_max_f32 v4, v4, v87
    v_max3_f32 v90, v4, v88, v89
    v_max3_f32 v4, v4, v88, v89
    s_nop 1
    v_permlane16_swap_b32 v4, v90
    v_max_f32 v4, v4, v90
    v_max_f32 v90, v4, v90
    s_nop 1
    v_permlane32_swap_b32 v4, v90
    v_max_f32 v4, v4, v90
    v_mul_f32 v4, s34, v4
    v_pk_fma_f32 v[80:81], v[80:81], s[34:35], v[4:5] op_sel_hi:[1,0,0] neg_lo:[0,0,1] neg_hi:[0,0,1]
    v_pk_fma_f32 v[82:83], v[82:83], s[34:35], v[4:5] op_sel_hi:[1,0,0] neg_lo:[0,0,1] neg_hi:[0,0,1]
    v_pk_fma_f32 v[84:85], v[84:85], s[34:35], v[4:5] op_sel_hi:[1,0,0] neg_lo:[0,0,1] neg_hi:[0,0,1]
    v_pk_fma_f32 v[86:87], v[86:87], s[34:35], v[4:5] op_sel_hi:[1,0,0] neg_lo:[0,0,1] neg_hi:[0,0,1]
    v_pk_fma_f32 v[88:89], v[88:89], s[34:35], v[4:5] op_sel_hi:[1,0,0] neg_lo:[0,0,1] neg_hi:[0,0,1]
    v_exp_f32 v80, v80
    v_exp_f32 v81, v81
    v_exp_f32 v82, v82
    v_cvt_pk_bf16_f32 v68, v80, v81
    v_exp_f32 v83, v83
    v_exp_f32 v84, v84
    v_cvt_pk_bf16_f32 v69, v82, v83
    v_exp_f32 v85, v85
    v_exp_f32 v86, v86
    v_cvt_pk_bf16_f32 v70, v84, v85
    v_exp_f32 v87, v87
    v_exp_f32 v88, v88
    v_cvt_pk_bf16_f32 v71, v86, v87
    v_exp_f32 v89, v89
    s_waitcnt vmcnt(3)
    v_mfma_f32_16x16x32_bf16 v[76:79], v[28:31], v[68:71], 0
    v_and_b32 v3, 1, v116
    v_cvt_pk_bf16_f32 v72, v88, v89
    v_mfma_f32_16x16x32_bf16 v[100:103], v[120:123], v[68:71], 0
    v_cmp_ne_u32 vcc, s41, v3
    v_cvt_pk_bf16_f32 v73, v88, v89
    v_mfma_f32_16x16x32_bf16 v[104:107], v[124:127], v[68:71], 0
    v_mov_b32 v113, v116
    v_mov_b32 v115, v117
    v_mfma_f32_16x16x16_bf16 v[76:79], v[92:93], v[72:73], v[76:79]
    s_cbranch_vccnz mega_kernel_rf_w1_pv0
mega_kernel_rf_w1_pv2:
    v_mfma_f32_16x16x16_bf16 v[100:103], v[112:113], v[72:73], v[100:103]
    v_mfma_f32_16x16x16_bf16 v[104:107], v[114:115], v[72:73], v[104:107]
    buffer_load_dwordx4 v[120:123], v1, s[4:7], s44 offen
    buffer_load_dwordx4 v[124:127], v1, s[4:7], s44 offen offset:1024
    s_nop 2
    v_rcp_f32 v76, v76
    s_mov_b64 exec, s[28:29]
    v_pk_mul_f32 v[100:101], v[100:101], v[76:77] op_sel_hi:[1,0]
    v_pk_mul_f32 v[102:103], v[102:103], v[76:77] op_sel_hi:[1,0]
    v_pk_mul_f32 v[104:105], v[104:105], v[76:77] op_sel_hi:[1,0]
    v_pk_mul_f32 v[106:107], v[106:107], v[76:77] op_sel_hi:[1,0]
    v_cvt_pk_bf16_f32 v84, v100, v101
    v_cvt_pk_bf16_f32 v85, v102, v103
    v_cvt_pk_bf16_f32 v86, v104, v105
    v_cvt_pk_bf16_f32 v87, v106, v107
    ds_write_b128 v6, v[84:87] offset:28672
    s_mov_b64 exec, -1
    s_waitcnt lgkmcnt(0)
    s_barrier
    ds_read_b128 v[68:71], v6 offset:28672
    ds_read_b128 v[72:75], v6 offset:29696
    s_waitcnt lgkmcnt(1)
    v_smfmac_f32_16x16x64_bf16 v[32:35], v[68:71], v[128:135], v2
    s_add_u32 s21, s21, 1
    s_xor_b32 s38, s38, 1048576
    s_xor_b32 s37, s37, 1048576
    s_waitcnt lgkmcnt(0)
    v_smfmac_f32_16x16x64_bf16 v[32:35], v[72:75], v[136:143], v2
    s_xor_b32 s40, s40, 1048576
    s_xor_b32 s39, s39, 1048576
    s_lshr_b32 s41, s21, 1
    v_smfmac_f32_16x16x64_bf16 v[36:39], v[68:71], v[144:151], v2
    s_and_b32 s41, s41, 1
    s_xor_b32 s41, s41, 1
    s_xor_b32 s35, s35, 16384
    v_smfmac_f32_16x16x64_bf16 v[36:39], v[72:75], v[152:159], v2
    v_add_f32 v32, v32, v34
    s_xor_b32 s36, s36, 16384
    s_add_u32 s43, s43, 262144
    s_add_u32 s44, s44, 262144
    v_smfmac_f32_16x16x64_bf16 v[40:43], v[68:71], v[160:167], v2
    v_add_f32 v33, v33, v35
    v_smfmac_f32_16x16x64_bf16 v[40:43], v[72:75], v[168:175], v2
    v_cvt_pk_bf16_f32 v32, v32, v33
    v_smfmac_f32_16x16x64_bf16 v[44:47], v[68:71], v[176:183], v2
    v_and_or_b32 v32, v32, -2, s42
    v_smfmac_f32_16x16x64_bf16 v[44:47], v[72:75], v[184:191], v2
    v_add_f32 v36, v36, v38
    v_smfmac_f32_16x16x64_bf16 v[48:51], v[68:71], v[192:199], v2
    v_add_f32 v37, v37, v39
    v_smfmac_f32_16x16x64_bf16 v[48:51], v[72:75], v[200:207], v2
    v_cvt_pk_bf16_f32 v33, v36, v37
    v_smfmac_f32_16x16x64_bf16 v[52:55], v[68:71], v[208:215], v2
    v_add_f32 v40, v40, v42
    v_smfmac_f32_16x16x64_bf16 v[52:55], v[72:75], v[216:223], v2
    v_add_f32 v41, v41, v43
    v_smfmac_f32_16x16x64_bf16 v[56:59], v[68:71], v[224:231], v2
    v_cvt_pk_bf16_f32 v34, v40, v41
    v_smfmac_f32_16x16x64_bf16 v[56:59], v[72:75], v[232:239], v2
    v_add_f32 v44, v44, v46
    v_smfmac_f32_16x16x64_bf16 v[60:63], v[68:71], v[240:247], v2
    v_add_f32 v45, v45, v47
    v_smfmac_f32_16x16x64_bf16 v[60:63], v[72:75], v[248:255], v2
    v_cvt_pk_bf16_f32 v35, v44, v45
    buffer_store_dwordx4 v[32:35], v8, s[4:7], s46 offen
    v_pk_add_f32 v[48:49], v[48:49], v[50:51]
    v_cvt_pk_bf16_f32 v48, v48, v49
    v_and_or_b32 v48, v48, -2, s42
    v_pk_add_f32 v[52:53], v[52:53], v[54:55]
    v_cvt_pk_bf16_f32 v49, v52, v53
    v_pk_add_f32 v[56:57], v[56:57], v[58:59]
    v_cvt_pk_bf16_f32 v50, v56, v57
    v_pk_add_f32 v[60:61], v[60:61], v[62:63]
    v_cvt_pk_bf16_f32 v51, v60, v61
    buffer_store_dwordx4 v[48:51], v8, s[4:7], s61 offen
    s_add_u32 s45, s45, 262144
    s_add_u32 s51, s51, 262144
    v_mfma_f32_32x32x8_bf16 v[96:111], v[14:15], v[14:15], 0
    v_mfma_f32_16x16x16_bf16 v[112:115], v[14:15], v[14:15], 0
    v_mfma_f32_16x16x16_bf16 v[116:119], v[14:15], v[14:15], 0
    ds_read_b128 v[64:67], v1 offset:4096
    ds_read_b128 v[68:71], v1 offset:5120
    ds_read_b128 v[72:75], v1 offset:6144
    ds_read_b128 v[76:79], v1 offset:7168
    ds_read_b128 v[80:83], v1 offset:20480
    ds_read_b128 v[84:87], v1 offset:21504
    ds_read_b128 v[88:91], v1 offset:22528
    ds_read_b128 v[92:95], v1 offset:23552
    v_mov_b32 v58, -1
    v_mov_b32 v59, -1
    s_waitcnt vmcnt(0)
mega_kernel_rf_w1_pc:
    buffer_load_dword v36, v13, s[4:7], s25 offen offset:0 sc1
    buffer_load_dword v37, v13, s[4:7], s25 offen offset:256 sc1
    buffer_load_dword v38, v13, s[4:7], s25 offen offset:512 sc1
    buffer_load_dword v39, v13, s[4:7], s25 offen offset:768 sc1
    buffer_load_dword v40, v13, s[4:7], s25 offen offset:1024 sc1
    buffer_load_dword v41, v13, s[4:7], s25 offen offset:1280 sc1
    buffer_load_dword v42, v13, s[4:7], s25 offen offset:1536 sc1
    buffer_load_dword v43, v13, s[4:7], s25 offen offset:1792 sc1
    s_waitcnt vmcnt(4)
    v_mfma_f32_16x16x32_bf16 v[52:55], v[36:39], v[24:27], 0
    v_bitop3_b32 v3, s42, v36, v37 bitop3:0x7e
    v_bitop3_b32 v4, s42, v38, v39 bitop3:0x7e
    s_waitcnt vmcnt(2)
    v_or_b32 v3, v3, v4
    v_bitop3_b32 v4, s42, v40, v41 bitop3:0x7e
    s_waitcnt vmcnt(0)
    v_mfma_f32_16x16x32_bf16 v[52:55], v[40:43], v[24:27], v[52:55]
    v_bitop3_b32 v56, s42, v42, v43 bitop3:0x7e
    v_or3_b32 v3, v3, v4, v56
    v_and_b32 v3, v0, v3
    v_cmp_ne_u32 vcc, 0, v3
    s_nop 3
    v_cvt_pk_bf16_f32 v56, v52, v53
    v_cvt_pk_bf16_f32 v57, v54, v55
    v_min_u32 v56, -2, v56
    s_cbranch_vccnz mega_kernel_rf_w1_pc
    s_mov_b64 exec, s[26:27]
    buffer_store_dwordx2 v[56:57], v9, s[4:7], s35 offen offset:256
    buffer_store_dwordx2 v[58:59], v9, s[4:7], s36 offen offset:256
    s_mov_b64 exec, -1
    s_xor_b32 s42, s42, 1
    s_branch mega_kernel_rf_w1_loop
mega_kernel_rf_w1_last:
    buffer_store_dwordx4 v[64:67], v10, s[4:7], s45 offen offset:64 sc1
    buffer_store_dwordx2 v[18:19], v11, s[4:7], s51 offen offset:2560 sc1
    s_branch mega_kernel_rf_end
mega_kernel_rf_w1_pafail:
    s_nop 7
    v_mov_b32 v96, 0
    v_mov_b32 v97, 0
    v_mov_b32 v98, 0
    v_mov_b32 v99, 0
    v_mov_b32 v100, 0
    v_mov_b32 v101, 0
    v_mov_b32 v102, 0
    v_mov_b32 v103, 0
    v_mov_b32 v104, 0
    v_mov_b32 v105, 0
    v_mov_b32 v106, 0
    v_mov_b32 v107, 0
    s_branch mega_kernel_rf_w1_pa
mega_kernel_rf_w1_xslow:
    buffer_load_dwordx2 v[108:109], v11, s[4:7], s38 offen sc1
    buffer_load_dwordx2 v[110:111], v11, s[4:7], s38 offen offset:512 sc1
    s_waitcnt vmcnt(2)
    v_bitop3_b32 v3, s41, v20, v22 bitop3:0x7e
    v_mfma_f32_16x16x16_bf16 v[80:83], v[20:21], v[16:17], v[100:103]
    v_and_b32 v3, 1, v3
    v_mfma_f32_16x16x16_bf16 v[84:87], v[22:23], v[16:17], v[104:107]
    v_cmp_ne_u32 vcc, 0, v3
    s_cbranch_vccz mega_kernel_rf_w1_xgot
    buffer_load_dwordx2 v[20:21], v11, s[4:7], s38 offen sc1
    buffer_load_dwordx2 v[22:23], v11, s[4:7], s38 offen offset:512 sc1
    s_waitcnt vmcnt(2)
    v_bitop3_b32 v3, s41, v108, v110 bitop3:0x7e
    v_mfma_f32_16x16x16_bf16 v[80:83], v[108:109], v[16:17], v[100:103]
    v_and_b32 v3, 1, v3
    v_mfma_f32_16x16x16_bf16 v[84:87], v[110:111], v[16:17], v[104:107]
    v_cmp_ne_u32 vcc, 0, v3
    s_cbranch_vccz mega_kernel_rf_w1_xgot
    s_branch mega_kernel_rf_w1_xslow
mega_kernel_rf_w1_xgot:
    s_nop 3
    v_cvt_pk_bf16_f32 v64, v80, v81
    v_cvt_pk_bf16_f32 v65, v82, v83
    v_cvt_pk_bf16_f32 v66, v84, v85
    v_cvt_pk_bf16_f32 v67, v86, v87
    ds_write_b128 v6, v[64:67] offset:13312
    s_branch mega_kernel_rf_w1_xok
mega_kernel_rf_w1_pv0:
    s_waitcnt vmcnt(2)
    s_branch mega_kernel_rf_w1_pv1
mega_kernel_rf_w1_pv:
    buffer_load_dwordx2 v[20:21], v11, s[4:7], s40 offen sc1
    s_waitcnt vmcnt(0)
mega_kernel_rf_w1_pv1:
    v_and_b32 v3, 1, v20
    v_cmp_ne_u32 vcc, s41, v3
    v_mov_b32 v113, v20
    v_mov_b32 v115, v21
    s_cbranch_vccnz mega_kernel_rf_w1_pv
    s_branch mega_kernel_rf_w1_pv2
mega_kernel_rf_w2_entry:
    v_mfma_f32_32x32x8_bf16 v[96:111], v[14:15], v[14:15], 0
    v_mfma_f32_16x16x16_bf16 v[112:115], v[14:15], v[14:15], 0
    v_mfma_f32_16x16x16_bf16 v[116:119], v[14:15], v[14:15], 0
    ds_read_b128 v[64:67], v1 offset:8192
    ds_read_b128 v[68:71], v1 offset:9216
    ds_read_b128 v[72:75], v1 offset:10240
    ds_read_b128 v[76:79], v1 offset:11264
    ds_read_b128 v[80:83], v1 offset:24576
    ds_read_b128 v[84:87], v1 offset:25600
    ds_read_b128 v[88:91], v1 offset:26624
    ds_read_b128 v[92:95], v1 offset:27648
    buffer_load_dwordx4 v[120:123], v1, s[4:7], s44 offen
    buffer_load_dwordx4 v[124:127], v1, s[4:7], s44 offen offset:1024
    s_add_u32 s44, s44, 262144
mega_kernel_rf_w2_loop:
    s_add_u32 s22, s35, 4096
    s_waitcnt vmcnt(0)
    buffer_load_dwordx4 v[48:51], v1, s[4:7], s22 offen sc1
    buffer_load_dwordx4 v[52:55], v1, s[4:7], s22 offen offset:1024 sc1
mega_kernel_rf_w2_pa:
    s_waitcnt vmcnt(1)
    ds_write_b128 v6, v[48:51] offset:4096
    s_waitcnt vmcnt(0)
    ds_write_b128 v6, v[52:55] offset:5120
    v_max3_u32 v3, v48, v50, v52
    v_max_u32 v3, v3, v54
    v_cmp_eq_u32 vcc, -1, v3
    v_smfmac_f32_16x16x64_bf16 v[96:99], v[48:51], a[64:71], v2
    buffer_load_dwordx4 v[48:51], v1, s[4:7], s22 offen sc1
    v_smfmac_f32_16x16x64_bf16 v[100:103], v[48:51], a[72:79], v2
    buffer_load_dwordx4 v[52:55], v1, s[4:7], s22 offen offset:1024 sc1
    v_smfmac_f32_16x16x64_bf16 v[104:107], v[48:51], a[192:199], v2
    s_cbranch_vccnz mega_kernel_rf_w2_pafail
    s_waitcnt lgkmcnt(0)
    s_barrier
    ds_read_b128 v[56:59], v6 offset:6144
    ds_read_b128 v[60:63], v6 offset:7168
    v_smfmac_f32_16x16x64_bf16 v[108:111], v[48:51], a[200:207], v2
    ds_read_b128 v[32:35], v6 offset:0
    v_smfmac_f32_16x16x64_bf16 v[96:99], v[52:55], a[80:87], v2
    ds_read_b128 v[36:39], v6 offset:1024
    v_smfmac_f32_16x16x64_bf16 v[100:103], v[52:55], a[88:95], v2
    ds_read_b128 v[40:43], v6 offset:2048
    v_smfmac_f32_16x16x64_bf16 v[104:107], v[52:55], a[208:215], v2
    ds_read_b128 v[44:47], v6 offset:3072
    v_smfmac_f32_16x16x64_bf16 v[108:111], v[52:55], a[216:223], v2
    s_waitcnt lgkmcnt(5)
    v_smfmac_f32_16x16x64_bf16 v[96:99], v[56:59], a[96:103], v2
    v_smfmac_f32_16x16x64_bf16 v[104:107], v[56:59], a[224:231], v2
    buffer_load_dwordx4 v1, s[4:7], s43 offen lds
    s_waitcnt lgkmcnt(4)
    v_smfmac_f32_16x16x64_bf16 v[96:99], v[60:63], a[112:119], v2
    v_smfmac_f32_16x16x64_bf16 v[104:107], v[60:63], a[240:247], v2
    s_waitcnt lgkmcnt(3)
    v_smfmac_f32_16x16x64_bf16 v[96:99], v[32:35], a[0:7], v2
    v_smfmac_f32_16x16x64_bf16 v[104:107], v[32:35], a[128:135], v2
    buffer_load_dwordx4 v1, s[4:7], s43 offen offset:1024 lds
    s_waitcnt lgkmcnt(2)
    v_smfmac_f32_16x16x64_bf16 v[96:99], v[36:39], a[16:23], v2
    v_smfmac_f32_16x16x64_bf16 v[104:107], v[36:39], a[144:151], v2
    s_waitcnt lgkmcnt(1)
    v_smfmac_f32_16x16x64_bf16 v[96:99], v[40:43], a[32:39], v2
    v_smfmac_f32_16x16x64_bf16 v[104:107], v[40:43], a[160:167], v2
    s_waitcnt lgkmcnt(0)
    v_smfmac_f32_16x16x64_bf16 v[96:99], v[44:47], a[48:55], v2
    v_smfmac_f32_16x16x64_bf16 v[104:107], v[44:47], a[176:183], v2
    v_smfmac_f32_16x16x64_bf16 v[100:103], v[56:59], a[104:111], v2
    s_nop 2
    v_smfmac_f32_16x16x64_bf16 v[100:103], v[60:63], a[120:127], v2
    s_nop 1
    v_add_f32 v96, v96, v98
    v_smfmac_f32_16x16x64_bf16 v[100:103], v[32:35], a[8:15], v2
    v_add_f32 v97, v97, v99
    v_add_f32 v104, v104, v106
    v_smfmac_f32_16x16x64_bf16 v[100:103], v[36:39], a[24:31], v2
    v_add_f32 v105, v105, v107
    v_cvt_pk_bf16_f32 v96, v96, v97
    v_smfmac_f32_16x16x64_bf16 v[100:103], v[40:43], a[40:47], v2
    v_cvt_pk_bf16_f32 v97, v104, v105
    v_and_or_b32 v96, v96, -2, s41
    v_smfmac_f32_16x16x64_bf16 v[100:103], v[44:47], a[56:63], v2
    buffer_store_dwordx2 v[96:97], v11, s[4:7], s37 offen sc1
    v_smfmac_f32_16x16x64_bf16 v[108:111], v[56:59], a[232:239], v2
    v_smfmac_f32_16x16x64_bf16 v[108:111], v[60:63], a[248:255], v2
    v_smfmac_f32_16x16x64_bf16 v[108:111], v[32:35], a[136:143], v2
    v_smfmac_f32_16x16x64_bf16 v[108:111], v[36:39], a[152:159], v2
    v_smfmac_f32_16x16x64_bf16 v[108:111], v[40:43], a[168:175], v2
    s_nop 2
    v_add_f32 v100, v100, v102
    v_smfmac_f32_16x16x64_bf16 v[108:111], v[44:47], a[184:191], v2
    v_add_f32 v101, v101, v103
    v_cvt_pk_bf16_f32 v98, v100, v101
    v_and_or_b32 v98, v98, -2, s41
    s_nop 4
    v_pk_add_f32 v[108:109], v[108:109], v[110:111]
    v_cvt_pk_bf16_f32 v99, v108, v109
    buffer_store_dwordx2 v[98:99], v11, s[4:7], s37 offen offset:512 sc1
    v_smfmac_f32_16x16x64_bf16 v[112:115], v[32:35], v[64:71], v2
    ds_read_b128 v[64:67], v1 offset:40960
    ds_read_b128 v[68:71], v1 offset:41984
    v_smfmac_f32_16x16x64_bf16 v[116:119], v[32:35], v[72:79], v2
    ds_read_b128 v[72:75], v1 offset:43008
    ds_read_b128 v[76:79], v1 offset:44032
    v_smfmac_f32_16x16x64_bf16 v[112:115], v[36:39], v[80:87], v2
    ds_read_b128 v[80:83], v1 offset:57344
    ds_read_b128 v[84:87], v1 offset:58368
    v_smfmac_f32_16x16x64_bf16 v[116:119], v[36:39], v[88:95], v2
    ds_read_b128 v[88:91], v1 offset:59392
    ds_read_b128 v[92:95], v1 offset:60416
    s_waitcnt lgkmcnt(6)
    v_smfmac_f32_16x16x64_bf16 v[112:115], v[40:43], v[64:71], v2
    ds_read_b128 v[64:67], v5 offset:8192
    ds_read_b128 v[68:71], v5 offset:9216
    s_waitcnt lgkmcnt(6)
    v_smfmac_f32_16x16x64_bf16 v[116:119], v[40:43], v[72:79], v2
    ds_read_b128 v[72:75], v5 offset:10240
    ds_read_b128 v[76:79], v5 offset:11264
    s_waitcnt lgkmcnt(6)
    v_smfmac_f32_16x16x64_bf16 v[112:115], v[44:47], v[80:87], v2
    ds_read_b128 v[80:83], v5 offset:24576
    ds_read_b128 v[84:87], v5 offset:25600
    s_waitcnt lgkmcnt(6)
    v_smfmac_f32_16x16x64_bf16 v[116:119], v[44:47], v[88:95], v2
    ds_read_b128 v[88:91], v5 offset:26624
    ds_read_b128 v[92:95], v5 offset:27648
    s_waitcnt lgkmcnt(6)
    v_smfmac_f32_16x16x64_bf16 v[112:115], v[48:51], v[64:71], v2
    ds_read_b128 v[64:67], v5 offset:40960
    ds_read_b128 v[68:71], v5 offset:41984
    s_waitcnt lgkmcnt(6)
    v_smfmac_f32_16x16x64_bf16 v[116:119], v[48:51], v[72:79], v2
    ds_read_b128 v[72:75], v5 offset:43008
    ds_read_b128 v[76:79], v5 offset:44032
    s_waitcnt lgkmcnt(6)
    v_smfmac_f32_16x16x64_bf16 v[112:115], v[52:55], v[80:87], v2
    ds_read_b128 v[80:83], v5 offset:57344
    ds_read_b128 v[84:87], v5 offset:58368
    s_waitcnt lgkmcnt(6)
    v_smfmac_f32_16x16x64_bf16 v[116:119], v[52:55], v[88:95], v2
    ds_read_b128 v[88:91], v5 offset:59392
    ds_read_b128 v[92:95], v5 offset:60416
    s_waitcnt lgkmcnt(6)
    v_smfmac_f32_16x16x64_bf16 v[112:115], v[56:59], v[64:71], v2
    s_waitcnt lgkmcnt(4)
    v_smfmac_f32_16x16x64_bf16 v[116:119], v[56:59], v[72:79], v2
    s_waitcnt lgkmcnt(2)
    v_smfmac_f32_16x16x64_bf16 v[112:115], v[60:63], v[80:87], v2
    s_waitcnt lgkmcnt(0)
    v_smfmac_f32_16x16x64_bf16 v[116:119], v[60:63], v[88:95], v2
    buffer_load_dwordx2 v[108:109], v11, s[4:7], s38 offen sc1
    v_mfma_f32_16x16x16_bf16 v[100:103], v[96:97], v[16:17], 0
    v_mfma_f32_16x16x16_bf16 v[104:107], v[98:99], v[16:17], 0
    s_nop 4
    v_add_f32 v112, v112, v114
    v_add_f32 v113, v113, v115
    v_add_f32 v114, v116, v118
    v_add_f32 v115, v117, v119
    v_cvt_pk_bf16_f32 v18, v112, v113
    v_cvt_pk_bf16_f32 v19, v114, v115
    v_and_or_b32 v18, v18, -2, s41
    buffer_load_dwordx2 v[110:111], v11, s[4:7], s38 offen offset:512 sc1
    s_barrier
    buffer_store_dwordx2 v[18:19], v11, s[4:7], s39 offen sc1
    v_mov_b32 v112, v18
    v_mov_b32 v114, v19
    v_mov_b32 v92, v28
    v_mov_b32 v93, 0
    s_waitcnt vmcnt(5)
    s_barrier
    ds_read_b128 v[32:35], v6 offset:19456
    ds_read_b128 v[36:39], v6 offset:20480
    ds_read_b128 v[40:43], v6 offset:24576
    ds_read_b128 v[44:47], v6 offset:25600
    ds_read_b128 v[48:51], v6 offset:9216
    ds_read_b128 v[52:55], v6 offset:10240
    ds_read_b128 v[56:59], v6 offset:14336
    ds_read_b128 v[60:63], v6 offset:15360
    buffer_load_dwordx2 v[20:21], v11, s[4:7], s38 offen sc1
    buffer_load_dwordx2 v[22:23], v11, s[4:7], s38 offen offset:512 sc1
    s_waitcnt vmcnt(4)
    v_mfma_f32_16x16x16_bf16 v[80:83], v[108:109], v[16:17], v[100:103]
    v_and_b32 v3, 1, v108
    v_cmp_ne_u32 vcc, s41, v3
    s_nop 5
    v_cvt_pk_bf16_f32 v64, v80, v81
    v_cvt_pk_bf16_f32 v65, v82, v83
    s_cbranch_vccnz mega_kernel_rf_w2_xslow
    s_waitcnt vmcnt(3)
    v_mfma_f32_16x16x16_bf16 v[84:87], v[110:111], v[16:17], v[104:107]
    v_and_b32 v3, 1, v110
    v_cmp_ne_u32 vcc, s41, v3
    s_nop 5
    v_cvt_pk_bf16_f32 v66, v84, v85
    v_cvt_pk_bf16_f32 v67, v86, v87
    ds_write_b128 v6, v[64:67] offset:18432
    s_cbranch_vccnz mega_kernel_rf_w2_xslow
mega_kernel_rf_w2_xok:
    s_cmp_eq_u32 s21, 63
    s_cbranch_scc1 mega_kernel_rf_w2_last
    buffer_load_dwordx2 v[116:117], v11, s[4:7], s40 offen sc1
    s_waitcnt lgkmcnt(1)
    v_mfma_f32_16x16x32_bf16 v[80:83], v[32:35], v[64:67], 0
    s_waitcnt lgkmcnt(0)
    s_barrier
    ds_read_b128 v[68:71], v6 offset:23552
    ds_read_b128 v[72:75], v6 offset:8192
    ds_read_b128 v[76:79], v6 offset:13312
    v_mfma_f32_16x16x32_bf16 v[84:87], v[36:39], v[64:67], 0
    v_mfma_f32_16x16x32_bf16 v[88:91], v[64:67], v[64:67], 0
    buffer_load_dwordx2 v[20:21], v11, s[4:7], s40 offen sc1
    s_waitcnt lgkmcnt(2)
    v_mfma_f32_16x16x32_bf16 v[80:83], v[40:43], v[68:71], v[80:83]
    s_waitcnt lgkmcnt(1)
    v_mfma_f32_16x16x32_bf16 v[80:83], v[48:51], v[72:75], v[80:83]
    s_waitcnt lgkmcnt(0)
    v_mfma_f32_16x16x32_bf16 v[80:83], v[56:59], v[76:79], v[80:83]
    buffer_store_dwordx4 v[64:67], v10, s[4:7], s45 offen offset:128 sc1
    v_mfma_f32_16x16x32_bf16 v[84:87], v[44:47], v[68:71], v[84:87]
    v_mfma_f32_16x16x32_bf16 v[84:87], v[52:55], v[72:75], v[84:87]
    v_mfma_f32_16x16x32_bf16 v[84:87], v[60:63], v[76:79], v[84:87]
    v_mfma_f32_16x16x32_bf16 v[88:91], v[68:71], v[68:71], v[88:91]
    buffer_store_dwordx2 v[18:19], v11, s[4:7], s51 offen offset:3072 sc1
    v_mfma_f32_16x16x32_bf16 v[88:91], v[72:75], v[72:75], v[88:91]
    v_mfma_f32_16x16x32_bf16 v[88:91], v[76:79], v[76:79], v[88:91]
    v_mfma_f32_32x32x4_2b_bf16 v[32:63], v[14:15], v[14:15], 0
    s_nop 0
    v_max3_f32 v4, v80, v81, v82
    s_nop 1
    v_max3_f32 v4, v4, v83, v84
    v_max3_f32 v4, v4, v85, v86
    v_max_f32 v4, v4, v87
    v_max3_f32 v90, v4, v88, v89
    v_max3_f32 v4, v4, v88, v89
    s_nop 1
    v_permlane16_swap_b32 v4, v90
    v_max_f32 v4, v4, v90
    v_max_f32 v90, v4, v90
    s_nop 1
    v_permlane32_swap_b32 v4, v90
    v_max_f32 v4, v4, v90
    v_mul_f32 v4, s34, v4
    v_pk_fma_f32 v[80:81], v[80:81], s[34:35], v[4:5] op_sel_hi:[1,0,0] neg_lo:[0,0,1] neg_hi:[0,0,1]
    v_pk_fma_f32 v[82:83], v[82:83], s[34:35], v[4:5] op_sel_hi:[1,0,0] neg_lo:[0,0,1] neg_hi:[0,0,1]
    v_pk_fma_f32 v[84:85], v[84:85], s[34:35], v[4:5] op_sel_hi:[1,0,0] neg_lo:[0,0,1] neg_hi:[0,0,1]
    v_pk_fma_f32 v[86:87], v[86:87], s[34:35], v[4:5] op_sel_hi:[1,0,0] neg_lo:[0,0,1] neg_hi:[0,0,1]
    v_pk_fma_f32 v[88:89], v[88:89], s[34:35], v[4:5] op_sel_hi:[1,0,0] neg_lo:[0,0,1] neg_hi:[0,0,1]
    v_exp_f32 v80, v80
    v_exp_f32 v81, v81
    v_exp_f32 v82, v82
    v_cvt_pk_bf16_f32 v68, v80, v81
    v_exp_f32 v83, v83
    v_exp_f32 v84, v84
    v_cvt_pk_bf16_f32 v69, v82, v83
    v_exp_f32 v85, v85
    v_exp_f32 v86, v86
    v_cvt_pk_bf16_f32 v70, v84, v85
    v_exp_f32 v87, v87
    v_exp_f32 v88, v88
    v_cvt_pk_bf16_f32 v71, v86, v87
    v_exp_f32 v89, v89
    s_waitcnt vmcnt(3)
    v_mfma_f32_16x16x32_bf16 v[76:79], v[28:31], v[68:71], 0
    v_and_b32 v3, 1, v116
    v_cvt_pk_bf16_f32 v72, v88, v89
    v_mfma_f32_16x16x32_bf16 v[100:103], v[120:123], v[68:71], 0
    v_cmp_ne_u32 vcc, s41, v3
    v_cvt_pk_bf16_f32 v73, v88, v89
    v_mfma_f32_16x16x32_bf16 v[104:107], v[124:127], v[68:71], 0
    v_mov_b32 v113, v116
    v_mov_b32 v115, v117
    v_mfma_f32_16x16x16_bf16 v[76:79], v[92:93], v[72:73], v[76:79]
    s_cbranch_vccnz mega_kernel_rf_w2_pv0
mega_kernel_rf_w2_pv2:
    v_mfma_f32_16x16x16_bf16 v[100:103], v[112:113], v[72:73], v[100:103]
    v_mfma_f32_16x16x16_bf16 v[104:107], v[114:115], v[72:73], v[104:107]
    buffer_load_dwordx4 v[120:123], v1, s[4:7], s44 offen
    buffer_load_dwordx4 v[124:127], v1, s[4:7], s44 offen offset:1024
    s_nop 2
    v_rcp_f32 v76, v76
    s_mov_b64 exec, s[28:29]
    v_pk_mul_f32 v[100:101], v[100:101], v[76:77] op_sel_hi:[1,0]
    v_pk_mul_f32 v[102:103], v[102:103], v[76:77] op_sel_hi:[1,0]
    v_pk_mul_f32 v[104:105], v[104:105], v[76:77] op_sel_hi:[1,0]
    v_pk_mul_f32 v[106:107], v[106:107], v[76:77] op_sel_hi:[1,0]
    v_cvt_pk_bf16_f32 v84, v100, v101
    v_cvt_pk_bf16_f32 v85, v102, v103
    v_cvt_pk_bf16_f32 v86, v104, v105
    v_cvt_pk_bf16_f32 v87, v106, v107
    ds_write_b128 v6, v[84:87] offset:29664
    s_mov_b64 exec, -1
    s_waitcnt lgkmcnt(0)
    s_barrier
    ds_read_b128 v[68:71], v6 offset:28672
    ds_read_b128 v[72:75], v6 offset:29696
    s_waitcnt lgkmcnt(1)
    v_smfmac_f32_16x16x64_bf16 v[32:35], v[68:71], v[128:135], v2
    s_add_u32 s21, s21, 1
    s_xor_b32 s38, s38, 1048576
    s_xor_b32 s37, s37, 1048576
    s_waitcnt lgkmcnt(0)
    v_smfmac_f32_16x16x64_bf16 v[32:35], v[72:75], v[136:143], v2
    s_xor_b32 s40, s40, 1048576
    s_xor_b32 s39, s39, 1048576
    s_lshr_b32 s41, s21, 1
    v_smfmac_f32_16x16x64_bf16 v[36:39], v[68:71], v[144:151], v2
    s_and_b32 s41, s41, 1
    s_xor_b32 s41, s41, 1
    s_xor_b32 s35, s35, 16384
    v_smfmac_f32_16x16x64_bf16 v[36:39], v[72:75], v[152:159], v2
    v_add_f32 v32, v32, v34
    s_xor_b32 s36, s36, 16384
    s_add_u32 s43, s43, 262144
    s_add_u32 s44, s44, 262144
    v_smfmac_f32_16x16x64_bf16 v[40:43], v[68:71], v[160:167], v2
    v_add_f32 v33, v33, v35
    v_smfmac_f32_16x16x64_bf16 v[40:43], v[72:75], v[168:175], v2
    v_cvt_pk_bf16_f32 v32, v32, v33
    v_smfmac_f32_16x16x64_bf16 v[44:47], v[68:71], v[176:183], v2
    v_and_or_b32 v32, v32, -2, s42
    v_smfmac_f32_16x16x64_bf16 v[44:47], v[72:75], v[184:191], v2
    v_add_f32 v36, v36, v38
    v_smfmac_f32_16x16x64_bf16 v[48:51], v[68:71], v[192:199], v2
    v_add_f32 v37, v37, v39
    v_smfmac_f32_16x16x64_bf16 v[48:51], v[72:75], v[200:207], v2
    v_cvt_pk_bf16_f32 v33, v36, v37
    v_smfmac_f32_16x16x64_bf16 v[52:55], v[68:71], v[208:215], v2
    v_add_f32 v40, v40, v42
    v_smfmac_f32_16x16x64_bf16 v[52:55], v[72:75], v[216:223], v2
    v_add_f32 v41, v41, v43
    v_smfmac_f32_16x16x64_bf16 v[56:59], v[68:71], v[224:231], v2
    v_cvt_pk_bf16_f32 v34, v40, v41
    v_smfmac_f32_16x16x64_bf16 v[56:59], v[72:75], v[232:239], v2
    v_add_f32 v44, v44, v46
    v_smfmac_f32_16x16x64_bf16 v[60:63], v[68:71], v[240:247], v2
    v_add_f32 v45, v45, v47
    v_smfmac_f32_16x16x64_bf16 v[60:63], v[72:75], v[248:255], v2
    v_cvt_pk_bf16_f32 v35, v44, v45
    buffer_store_dwordx4 v[32:35], v8, s[4:7], s46 offen
    v_pk_add_f32 v[48:49], v[48:49], v[50:51]
    v_cvt_pk_bf16_f32 v48, v48, v49
    v_and_or_b32 v48, v48, -2, s42
    v_pk_add_f32 v[52:53], v[52:53], v[54:55]
    v_cvt_pk_bf16_f32 v49, v52, v53
    v_pk_add_f32 v[56:57], v[56:57], v[58:59]
    v_cvt_pk_bf16_f32 v50, v56, v57
    v_pk_add_f32 v[60:61], v[60:61], v[62:63]
    v_cvt_pk_bf16_f32 v51, v60, v61
    buffer_store_dwordx4 v[48:51], v8, s[4:7], s61 offen
    s_add_u32 s45, s45, 262144
    s_add_u32 s51, s51, 262144
    v_mfma_f32_32x32x8_bf16 v[96:111], v[14:15], v[14:15], 0
    v_mfma_f32_16x16x16_bf16 v[112:115], v[14:15], v[14:15], 0
    v_mfma_f32_16x16x16_bf16 v[116:119], v[14:15], v[14:15], 0
    ds_read_b128 v[64:67], v1 offset:8192
    ds_read_b128 v[68:71], v1 offset:9216
    ds_read_b128 v[72:75], v1 offset:10240
    ds_read_b128 v[76:79], v1 offset:11264
    ds_read_b128 v[80:83], v1 offset:24576
    ds_read_b128 v[84:87], v1 offset:25600
    ds_read_b128 v[88:91], v1 offset:26624
    ds_read_b128 v[92:95], v1 offset:27648
    v_mov_b32 v58, -1
    v_mov_b32 v59, -1
    s_waitcnt vmcnt(0)
mega_kernel_rf_w2_pc:
    buffer_load_dword v36, v13, s[4:7], s25 offen offset:0 sc1
    buffer_load_dword v37, v13, s[4:7], s25 offen offset:256 sc1
    buffer_load_dword v38, v13, s[4:7], s25 offen offset:512 sc1
    buffer_load_dword v39, v13, s[4:7], s25 offen offset:768 sc1
    buffer_load_dword v40, v13, s[4:7], s25 offen offset:1024 sc1
    buffer_load_dword v41, v13, s[4:7], s25 offen offset:1280 sc1
    buffer_load_dword v42, v13, s[4:7], s25 offen offset:1536 sc1
    buffer_load_dword v43, v13, s[4:7], s25 offen offset:1792 sc1
    s_waitcnt vmcnt(4)
    v_mfma_f32_16x16x32_bf16 v[52:55], v[36:39], v[24:27], 0
    v_bitop3_b32 v3, s42, v36, v37 bitop3:0x7e
    v_bitop3_b32 v4, s42, v38, v39 bitop3:0x7e
    s_waitcnt vmcnt(2)
    v_or_b32 v3, v3, v4
    v_bitop3_b32 v4, s42, v40, v41 bitop3:0x7e
    s_waitcnt vmcnt(0)
    v_mfma_f32_16x16x32_bf16 v[52:55], v[40:43], v[24:27], v[52:55]
    v_bitop3_b32 v56, s42, v42, v43 bitop3:0x7e
    v_or3_b32 v3, v3, v4, v56
    v_and_b32 v3, v0, v3
    v_cmp_ne_u32 vcc, 0, v3
    s_nop 3
    v_cvt_pk_bf16_f32 v56, v52, v53
    v_cvt_pk_bf16_f32 v57, v54, v55
    v_min_u32 v56, -2, v56
    s_cbranch_vccnz mega_kernel_rf_w2_pc
    s_mov_b64 exec, s[26:27]
    buffer_store_dwordx2 v[56:57], v9, s[4:7], s35 offen offset:512
    buffer_store_dwordx2 v[58:59], v9, s[4:7], s36 offen offset:512
    s_mov_b64 exec, -1
    s_xor_b32 s42, s42, 1
    s_branch mega_kernel_rf_w2_loop
mega_kernel_rf_w2_last:
    buffer_store_dwordx4 v[64:67], v10, s[4:7], s45 offen offset:128 sc1
    buffer_store_dwordx2 v[18:19], v11, s[4:7], s51 offen offset:3072 sc1
    s_branch mega_kernel_rf_end
mega_kernel_rf_w2_pafail:
    s_nop 7
    v_mov_b32 v96, 0
    v_mov_b32 v97, 0
    v_mov_b32 v98, 0
    v_mov_b32 v99, 0
    v_mov_b32 v100, 0
    v_mov_b32 v101, 0
    v_mov_b32 v102, 0
    v_mov_b32 v103, 0
    v_mov_b32 v104, 0
    v_mov_b32 v105, 0
    v_mov_b32 v106, 0
    v_mov_b32 v107, 0
    s_branch mega_kernel_rf_w2_pa
mega_kernel_rf_w2_xslow:
    buffer_load_dwordx2 v[108:109], v11, s[4:7], s38 offen sc1
    buffer_load_dwordx2 v[110:111], v11, s[4:7], s38 offen offset:512 sc1
    s_waitcnt vmcnt(2)
    v_bitop3_b32 v3, s41, v20, v22 bitop3:0x7e
    v_mfma_f32_16x16x16_bf16 v[80:83], v[20:21], v[16:17], v[100:103]
    v_and_b32 v3, 1, v3
    v_mfma_f32_16x16x16_bf16 v[84:87], v[22:23], v[16:17], v[104:107]
    v_cmp_ne_u32 vcc, 0, v3
    s_cbranch_vccz mega_kernel_rf_w2_xgot
    buffer_load_dwordx2 v[20:21], v11, s[4:7], s38 offen sc1
    buffer_load_dwordx2 v[22:23], v11, s[4:7], s38 offen offset:512 sc1
    s_waitcnt vmcnt(2)
    v_bitop3_b32 v3, s41, v108, v110 bitop3:0x7e
    v_mfma_f32_16x16x16_bf16 v[80:83], v[108:109], v[16:17], v[100:103]
    v_and_b32 v3, 1, v3
    v_mfma_f32_16x16x16_bf16 v[84:87], v[110:111], v[16:17], v[104:107]
    v_cmp_ne_u32 vcc, 0, v3
    s_cbranch_vccz mega_kernel_rf_w2_xgot
    s_branch mega_kernel_rf_w2_xslow
mega_kernel_rf_w2_xgot:
    s_nop 3
    v_cvt_pk_bf16_f32 v64, v80, v81
    v_cvt_pk_bf16_f32 v65, v82, v83
    v_cvt_pk_bf16_f32 v66, v84, v85
    v_cvt_pk_bf16_f32 v67, v86, v87
    ds_write_b128 v6, v[64:67] offset:18432
    s_branch mega_kernel_rf_w2_xok
mega_kernel_rf_w2_pv0:
    s_waitcnt vmcnt(2)
    s_branch mega_kernel_rf_w2_pv1
mega_kernel_rf_w2_pv:
    buffer_load_dwordx2 v[20:21], v11, s[4:7], s40 offen sc1
    s_waitcnt vmcnt(0)
mega_kernel_rf_w2_pv1:
    v_and_b32 v3, 1, v20
    v_cmp_ne_u32 vcc, s41, v3
    v_mov_b32 v113, v20
    v_mov_b32 v115, v21
    s_cbranch_vccnz mega_kernel_rf_w2_pv
    s_branch mega_kernel_rf_w2_pv2
mega_kernel_rf_w3_entry:
    v_mfma_f32_32x32x8_bf16 v[96:111], v[14:15], v[14:15], 0
    v_mfma_f32_16x16x16_bf16 v[112:115], v[14:15], v[14:15], 0
    v_mfma_f32_16x16x16_bf16 v[116:119], v[14:15], v[14:15], 0
    ds_read_b128 v[64:67], v1 offset:12288
    ds_read_b128 v[68:71], v1 offset:13312
    ds_read_b128 v[72:75], v1 offset:14336
    ds_read_b128 v[76:79], v1 offset:15360
    ds_read_b128 v[80:83], v1 offset:28672
    ds_read_b128 v[84:87], v1 offset:29696
    ds_read_b128 v[88:91], v1 offset:30720
    ds_read_b128 v[92:95], v1 offset:31744
    buffer_load_dwordx4 v[120:123], v1, s[4:7], s44 offen
    buffer_load_dwordx4 v[124:127], v1, s[4:7], s44 offen offset:1024
    s_add_u32 s44, s44, 262144
mega_kernel_rf_w3_loop:
    s_add_u32 s22, s35, 6144
    s_waitcnt vmcnt(0)
    buffer_load_dwordx4 v[56:59], v1, s[4:7], s22 offen sc1
    buffer_load_dwordx4 v[60:63], v1, s[4:7], s22 offen offset:1024 sc1
mega_kernel_rf_w3_pa:
    s_waitcnt vmcnt(1)
    ds_write_b128 v6, v[56:59] offset:6144
    s_waitcnt vmcnt(0)
    ds_write_b128 v6, v[60:63] offset:7168
    v_max3_u32 v3, v56, v58, v60
    v_max_u32 v3, v3, v62
    v_cmp_eq_u32 vcc, -1, v3
    v_smfmac_f32_16x16x64_bf16 v[96:99], v[56:59], a[96:103], v2
    buffer_load_dwordx4 v[56:59], v1, s[4:7], s22 offen sc1
    v_smfmac_f32_16x16x64_bf16 v[100:103], v[56:59], a[104:111], v2
    buffer_load_dwordx4 v[60:63], v1, s[4:7], s22 offen offset:1024 sc1
    v_smfmac_f32_16x16x64_bf16 v[104:107], v[56:59], a[224:231], v2
    s_cbranch_vccnz mega_kernel_rf_w3_pafail
    s_waitcnt lgkmcnt(0)
    s_barrier
    ds_read_b128 v[32:35], v6 offset:0
    ds_read_b128 v[36:39], v6 offset:1024
    v_smfmac_f32_16x16x64_bf16 v[108:111], v[56:59], a[232:239], v2
    ds_read_b128 v[40:43], v6 offset:2048
    v_smfmac_f32_16x16x64_bf16 v[96:99], v[60:63], a[112:119], v2
    ds_read_b128 v[44:47], v6 offset:3072
    v_smfmac_f32_16x16x64_bf16 v[100:103], v[60:63], a[120:127], v2
    ds_read_b128 v[48:51], v6 offset:4096
    v_smfmac_f32_16x16x64_bf16 v[104:107], v[60:63], a[240:247], v2
    ds_read_b128 v[52:55], v6 offset:5120
    v_smfmac_f32_16x16x64_bf16 v[108:111], v[60:63], a[248:255], v2
    s_waitcnt lgkmcnt(5)
    v_smfmac_f32_16x16x64_bf16 v[96:99], v[32:35], a[0:7], v2
    v_smfmac_f32_16x16x64_bf16 v[104:107], v[32:35], a[128:135], v2
    s_waitcnt lgkmcnt(4)
    v_smfmac_f32_16x16x64_bf16 v[96:99], v[36:39], a[16:23], v2
    buffer_load_dwordx4 v1, s[4:7], s43 offen lds
    v_smfmac_f32_16x16x64_bf16 v[104:107], v[36:39], a[144:151], v2
    s_waitcnt lgkmcnt(3)
    v_smfmac_f32_16x16x64_bf16 v[96:99], v[40:43], a[32:39], v2
    v_smfmac_f32_16x16x64_bf16 v[104:107], v[40:43], a[160:167], v2
    s_waitcnt lgkmcnt(2)
    v_smfmac_f32_16x16x64_bf16 v[96:99], v[44:47], a[48:55], v2
    buffer_load_dwordx4 v1, s[4:7], s43 offen offset:1024 lds
    v_smfmac_f32_16x16x64_bf16 v[104:107], v[44:47], a[176:183], v2
    s_waitcnt lgkmcnt(1)
    v_smfmac_f32_16x16x64_bf16 v[96:99], v[48:51], a[64:71], v2
    v_smfmac_f32_16x16x64_bf16 v[104:107], v[48:51], a[192:199], v2
    s_waitcnt lgkmcnt(0)
    v_smfmac_f32_16x16x64_bf16 v[96:99], v[52:55], a[80:87], v2
    buffer_load_dword v12, v7, s[4:7], 0 offen sc1
    v_smfmac_f32_16x16x64_bf16 v[104:107], v[52:55], a[208:215], v2
    v_smfmac_f32_16x16x64_bf16 v[100:103], v[32:35], a[8:15], v2
    s_nop 2
    v_smfmac_f32_16x16x64_bf16 v[100:103], v[36:39], a[24:31], v2
    s_nop 1
    v_add_f32 v96, v96, v98
    v_smfmac_f32_16x16x64_bf16 v[100:103], v[40:43], a[40:47], v2
    v_add_f32 v97, v97, v99
    v_add_f32 v104, v104, v106
    v_smfmac_f32_16x16x64_bf16 v[100:103], v[44:47], a[56:63], v2
    v_add_f32 v105, v105, v107
    v_cvt_pk_bf16_f32 v96, v96, v97
    v_smfmac_f32_16x16x64_bf16 v[100:103], v[48:51], a[72:79], v2
    v_cvt_pk_bf16_f32 v97, v104, v105
    v_and_or_b32 v96, v96, -2, s41
    v_smfmac_f32_16x16x64_bf16 v[100:103], v[52:55], a[88:95], v2
    buffer_store_dwordx2 v[96:97], v11, s[4:7], s37 offen sc1
    v_smfmac_f32_16x16x64_bf16 v[108:111], v[32:35], a[136:143], v2
    v_smfmac_f32_16x16x64_bf16 v[108:111], v[36:39], a[152:159], v2
    v_smfmac_f32_16x16x64_bf16 v[108:111], v[40:43], a[168:175], v2
    v_smfmac_f32_16x16x64_bf16 v[108:111], v[44:47], a[184:191], v2
    v_smfmac_f32_16x16x64_bf16 v[108:111], v[48:51], a[200:207], v2
    s_nop 2
    v_add_f32 v100, v100, v102
    v_smfmac_f32_16x16x64_bf16 v[108:111], v[52:55], a[216:223], v2
    v_add_f32 v101, v101, v103
    v_cvt_pk_bf16_f32 v98, v100, v101
    v_and_or_b32 v98, v98, -2, s41
    s_nop 4
    v_pk_add_f32 v[108:109], v[108:109], v[110:111]
    v_cvt_pk_bf16_f32 v99, v108, v109
    buffer_store_dwordx2 v[98:99], v11, s[4:7], s37 offen offset:512 sc1
    v_smfmac_f32_16x16x64_bf16 v[112:115], v[32:35], v[64:71], v2
    ds_read_b128 v[64:67], v1 offset:45056
    ds_read_b128 v[68:71], v1 offset:46080
    v_smfmac_f32_16x16x64_bf16 v[116:119], v[32:35], v[72:79], v2
    ds_read_b128 v[72:75], v1 offset:47104
    ds_read_b128 v[76:79], v1 offset:48128
    v_smfmac_f32_16x16x64_bf16 v[112:115], v[36:39], v[80:87], v2
    ds_read_b128 v[80:83], v1 offset:61440
    ds_read_b128 v[84:87], v1 offset:62464
    v_smfmac_f32_16x16x64_bf16 v[116:119], v[36:39], v[88:95], v2
    ds_read_b128 v[88:91], v1 offset:63488
    ds_read_b128 v[92:95], v1 offset:64512
    s_waitcnt lgkmcnt(6)
    v_smfmac_f32_16x16x64_bf16 v[112:115], v[40:43], v[64:71], v2
    ds_read_b128 v[64:67], v5 offset:12288
    ds_read_b128 v[68:71], v5 offset:13312
    s_waitcnt lgkmcnt(6)
    v_smfmac_f32_16x16x64_bf16 v[116:119], v[40:43], v[72:79], v2
    ds_read_b128 v[72:75], v5 offset:14336
    ds_read_b128 v[76:79], v5 offset:15360
    s_waitcnt lgkmcnt(6)
    v_smfmac_f32_16x16x64_bf16 v[112:115], v[44:47], v[80:87], v2
    ds_read_b128 v[80:83], v5 offset:28672
    ds_read_b128 v[84:87], v5 offset:29696
    s_waitcnt lgkmcnt(6)
    v_smfmac_f32_16x16x64_bf16 v[116:119], v[44:47], v[88:95], v2
    ds_read_b128 v[88:91], v5 offset:30720
    ds_read_b128 v[92:95], v5 offset:31744
    s_waitcnt lgkmcnt(6)
    v_smfmac_f32_16x16x64_bf16 v[112:115], v[48:51], v[64:71], v2
    ds_read_b128 v[64:67], v5 offset:45056
    ds_read_b128 v[68:71], v5 offset:46080
    s_waitcnt lgkmcnt(6)
    v_smfmac_f32_16x16x64_bf16 v[116:119], v[48:51], v[72:79], v2
    ds_read_b128 v[72:75], v5 offset:47104
    ds_read_b128 v[76:79], v5 offset:48128
    s_waitcnt lgkmcnt(6)
    v_smfmac_f32_16x16x64_bf16 v[112:115], v[52:55], v[80:87], v2
    ds_read_b128 v[80:83], v5 offset:61440
    ds_read_b128 v[84:87], v5 offset:62464
    s_waitcnt lgkmcnt(6)
    v_smfmac_f32_16x16x64_bf16 v[116:119], v[52:55], v[88:95], v2
    ds_read_b128 v[88:91], v5 offset:63488
    ds_read_b128 v[92:95], v5 offset:64512
    s_waitcnt lgkmcnt(6)
    v_smfmac_f32_16x16x64_bf16 v[112:115], v[56:59], v[64:71], v2
    s_waitcnt lgkmcnt(4)
    v_smfmac_f32_16x16x64_bf16 v[116:119], v[56:59], v[72:79], v2
    s_waitcnt lgkmcnt(2)
    v_smfmac_f32_16x16x64_bf16 v[112:115], v[60:63], v[80:87], v2
    s_waitcnt lgkmcnt(0)
    v_smfmac_f32_16x16x64_bf16 v[116:119], v[60:63], v[88:95], v2
    buffer_load_dwordx2 v[108:109], v11, s[4:7], s38 offen sc1
    v_mfma_f32_16x16x16_bf16 v[100:103], v[96:97], v[16:17], 0
    v_mfma_f32_16x16x16_bf16 v[104:107], v[98:99], v[16:17], 0
    s_nop 4
    v_add_f32 v112, v112, v114
    v_add_f32 v113, v113, v115
    v_add_f32 v114, v116, v118
    v_add_f32 v115, v117, v119
    v_cvt_pk_bf16_f32 v18, v112, v113
    v_cvt_pk_bf16_f32 v19, v114, v115
    v_and_or_b32 v18, v18, -2, s41
    buffer_load_dwordx2 v[110:111], v11, s[4:7], s38 offen offset:512 sc1
    s_barrier
    buffer_store_dwordx2 v[18:19], v11, s[4:7], s39 offen sc1
    v_mov_b32 v112, v18
    v_mov_b32 v114, v19
    v_mov_b32 v92, v28
    v_mov_b32 v93, 0
    s_waitcnt vmcnt(6)
    s_barrier
    ds_read_b128 v[32:35], v6 offset:24576
    ds_read_b128 v[36:39], v6 offset:25600
    ds_read_b128 v[40:43], v6 offset:19456
    ds_read_b128 v[44:47], v6 offset:20480
    ds_read_b128 v[48:51], v6 offset:14336
    ds_read_b128 v[52:55], v6 offset:15360
    ds_read_b128 v[56:59], v6 offset:9216
    ds_read_b128 v[60:63], v6 offset:10240
    buffer_load_dwordx2 v[20:21], v11, s[4:7], s38 offen sc1
    buffer_load_dwordx2 v[22:23], v11, s[4:7], s38 offen offset:512 sc1
    s_waitcnt vmcnt(4)
    v_mfma_f32_16x16x16_bf16 v[80:83], v[108:109], v[16:17], v[100:103]
    v_and_b32 v3, 1, v108
    v_cmp_ne_u32 vcc, s41, v3
    s_nop 5
    v_cvt_pk_bf16_f32 v64, v80, v81
    v_cvt_pk_bf16_f32 v65, v82, v83
    s_cbranch_vccnz mega_kernel_rf_w3_xslow
    s_waitcnt vmcnt(3)
    v_mfma_f32_16x16x16_bf16 v[84:87], v[110:111], v[16:17], v[104:107]
    v_and_b32 v3, 1, v110
    v_cmp_ne_u32 vcc, s41, v3
    s_nop 5
    v_cvt_pk_bf16_f32 v66, v84, v85
    v_cvt_pk_bf16_f32 v67, v86, v87
    ds_write_b128 v6, v[64:67] offset:23552
    s_cbranch_vccnz mega_kernel_rf_w3_xslow
mega_kernel_rf_w3_xok:
    s_cmp_eq_u32 s21, 63
    s_cbranch_scc1 mega_kernel_rf_w3_last
    buffer_load_dwordx2 v[116:117], v11, s[4:7], s40 offen sc1
    s_waitcnt lgkmcnt(1)
    v_mfma_f32_16x16x32_bf16 v[80:83], v[32:35], v[64:67], 0
    s_waitcnt lgkmcnt(0)
    s_barrier
    ds_read_b128 v[68:71], v6 offset:18432
    ds_read_b128 v[72:75], v6 offset:13312
    ds_read_b128 v[76:79], v6 offset:8192
    v_mfma_f32_16x16x32_bf16 v[84:87], v[36:39], v[64:67], 0
    v_mfma_f32_16x16x32_bf16 v[88:91], v[64:67], v[64:67], 0
    buffer_load_dwordx2 v[20:21], v11, s[4:7], s40 offen sc1
    s_waitcnt lgkmcnt(2)
    v_mfma_f32_16x16x32_bf16 v[80:83], v[40:43], v[68:71], v[80:83]
    s_waitcnt lgkmcnt(1)
    v_mfma_f32_16x16x32_bf16 v[80:83], v[48:51], v[72:75], v[80:83]
    s_waitcnt lgkmcnt(0)
    v_mfma_f32_16x16x32_bf16 v[80:83], v[56:59], v[76:79], v[80:83]
    v_mfma_f32_16x16x32_bf16 v[84:87], v[44:47], v[68:71], v[84:87]
    buffer_store_dwordx4 v[64:67], v10, s[4:7], s45 offen offset:192 sc1
    v_mfma_f32_16x16x32_bf16 v[84:87], v[52:55], v[72:75], v[84:87]
    v_mfma_f32_16x16x32_bf16 v[84:87], v[60:63], v[76:79], v[84:87]
    v_mfma_f32_16x16x32_bf16 v[88:91], v[68:71], v[68:71], v[88:91]
    v_mfma_f32_16x16x32_bf16 v[88:91], v[72:75], v[72:75], v[88:91]
    buffer_store_dwordx2 v[18:19], v11, s[4:7], s51 offen offset:3584 sc1
    v_mfma_f32_16x16x32_bf16 v[88:91], v[76:79], v[76:79], v[88:91]
    v_mfma_f32_32x32x4_2b_bf16 v[32:63], v[14:15], v[14:15], 0
    s_nop 0
    v_max3_f32 v4, v80, v81, v82
    s_nop 1
    v_max3_f32 v4, v4, v83, v84
    v_max3_f32 v4, v4, v85, v86
    v_max_f32 v4, v4, v87
    v_max3_f32 v90, v4, v88, v89
    v_max3_f32 v4, v4, v88, v89
    s_nop 1
    v_permlane16_swap_b32 v4, v90
    v_max_f32 v4, v4, v90
    v_max_f32 v90, v4, v90
    s_nop 1
    v_permlane32_swap_b32 v4, v90
    v_max_f32 v4, v4, v90
    v_mul_f32 v4, s34, v4
    v_pk_fma_f32 v[80:81], v[80:81], s[34:35], v[4:5] op_sel_hi:[1,0,0] neg_lo:[0,0,1] neg_hi:[0,0,1]
    v_pk_fma_f32 v[82:83], v[82:83], s[34:35], v[4:5] op_sel_hi:[1,0,0] neg_lo:[0,0,1] neg_hi:[0,0,1]
    v_pk_fma_f32 v[84:85], v[84:85], s[34:35], v[4:5] op_sel_hi:[1,0,0] neg_lo:[0,0,1] neg_hi:[0,0,1]
    v_pk_fma_f32 v[86:87], v[86:87], s[34:35], v[4:5] op_sel_hi:[1,0,0] neg_lo:[0,0,1] neg_hi:[0,0,1]
    v_pk_fma_f32 v[88:89], v[88:89], s[34:35], v[4:5] op_sel_hi:[1,0,0] neg_lo:[0,0,1] neg_hi:[0,0,1]
    v_exp_f32 v80, v80
    v_exp_f32 v81, v81
    v_exp_f32 v82, v82
    v_cvt_pk_bf16_f32 v68, v80, v81
    v_exp_f32 v83, v83
    v_exp_f32 v84, v84
    v_cvt_pk_bf16_f32 v69, v82, v83
    v_exp_f32 v85, v85
    v_exp_f32 v86, v86
    v_cvt_pk_bf16_f32 v70, v84, v85
    v_exp_f32 v87, v87
    v_exp_f32 v88, v88
    v_cvt_pk_bf16_f32 v71, v86, v87
    v_exp_f32 v89, v89
    s_waitcnt vmcnt(3)
    v_mfma_f32_16x16x32_bf16 v[76:79], v[28:31], v[68:71], 0
    v_and_b32 v3, 1, v116
    v_cvt_pk_bf16_f32 v72, v88, v89
    v_mfma_f32_16x16x32_bf16 v[100:103], v[120:123], v[68:71], 0
    v_cmp_ne_u32 vcc, s41, v3
    v_cvt_pk_bf16_f32 v73, v88, v89
    v_mfma_f32_16x16x32_bf16 v[104:107], v[124:127], v[68:71], 0
    v_mov_b32 v113, v116
    v_mov_b32 v115, v117
    v_mfma_f32_16x16x16_bf16 v[76:79], v[92:93], v[72:73], v[76:79]
    s_cbranch_vccnz mega_kernel_rf_w3_pv0
mega_kernel_rf_w3_pv2:
    v_mfma_f32_16x16x16_bf16 v[100:103], v[112:113], v[72:73], v[100:103]
    v_mfma_f32_16x16x16_bf16 v[104:107], v[114:115], v[72:73], v[104:107]
    buffer_load_dwordx4 v[120:123], v1, s[4:7], s44 offen
    buffer_load_dwordx4 v[124:127], v1, s[4:7], s44 offen offset:1024
    s_nop 2
    v_rcp_f32 v76, v76
    s_mov_b64 exec, s[28:29]
    v_pk_mul_f32 v[100:101], v[100:101], v[76:77] op_sel_hi:[1,0]
    v_pk_mul_f32 v[102:103], v[102:103], v[76:77] op_sel_hi:[1,0]
    v_pk_mul_f32 v[104:105], v[104:105], v[76:77] op_sel_hi:[1,0]
    v_pk_mul_f32 v[106:107], v[106:107], v[76:77] op_sel_hi:[1,0]
    v_cvt_pk_bf16_f32 v84, v100, v101
    v_cvt_pk_bf16_f32 v85, v102, v103
    v_cvt_pk_bf16_f32 v86, v104, v105
    v_cvt_pk_bf16_f32 v87, v106, v107
    ds_write_b128 v6, v[84:87] offset:29696
    s_mov_b64 exec, -1
    s_waitcnt lgkmcnt(0)
    s_barrier
    ds_read_b128 v[68:71], v6 offset:28672
    ds_read_b128 v[72:75], v6 offset:29696
    s_waitcnt lgkmcnt(1)
    v_smfmac_f32_16x16x64_bf16 v[32:35], v[68:71], v[128:135], v2
    s_add_u32 s21, s21, 1
    s_xor_b32 s38, s38, 1048576
    s_xor_b32 s37, s37, 1048576
    s_waitcnt lgkmcnt(0)
    v_smfmac_f32_16x16x64_bf16 v[32:35], v[72:75], v[136:143], v2
    s_xor_b32 s40, s40, 1048576
    s_xor_b32 s39, s39, 1048576
    s_lshr_b32 s41, s21, 1
    v_smfmac_f32_16x16x64_bf16 v[36:39], v[68:71], v[144:151], v2
    s_and_b32 s41, s41, 1
    s_xor_b32 s41, s41, 1
    s_xor_b32 s35, s35, 16384
    v_smfmac_f32_16x16x64_bf16 v[36:39], v[72:75], v[152:159], v2
    v_add_f32 v32, v32, v34
    s_xor_b32 s36, s36, 16384
    s_add_u32 s43, s43, 262144
    s_add_u32 s44, s44, 262144
    v_smfmac_f32_16x16x64_bf16 v[40:43], v[68:71], v[160:167], v2
    v_add_f32 v33, v33, v35
    v_smfmac_f32_16x16x64_bf16 v[40:43], v[72:75], v[168:175], v2
    v_cvt_pk_bf16_f32 v32, v32, v33
    v_smfmac_f32_16x16x64_bf16 v[44:47], v[68:71], v[176:183], v2
    v_and_or_b32 v32, v32, -2, s42
    v_smfmac_f32_16x16x64_bf16 v[44:47], v[72:75], v[184:191], v2
    v_add_f32 v36, v36, v38
    v_smfmac_f32_16x16x64_bf16 v[48:51], v[68:71], v[192:199], v2
    v_add_f32 v37, v37, v39
    v_smfmac_f32_16x16x64_bf16 v[48:51], v[72:75], v[200:207], v2
    v_cvt_pk_bf16_f32 v33, v36, v37
    v_smfmac_f32_16x16x64_bf16 v[52:55], v[68:71], v[208:215], v2
    v_add_f32 v40, v40, v42
    v_smfmac_f32_16x16x64_bf16 v[52:55], v[72:75], v[216:223], v2
    v_add_f32 v41, v41, v43
    v_smfmac_f32_16x16x64_bf16 v[56:59], v[68:71], v[224:231], v2
    v_cvt_pk_bf16_f32 v34, v40, v41
    v_smfmac_f32_16x16x64_bf16 v[56:59], v[72:75], v[232:239], v2
    v_add_f32 v44, v44, v46
    v_smfmac_f32_16x16x64_bf16 v[60:63], v[68:71], v[240:247], v2
    v_add_f32 v45, v45, v47
    v_smfmac_f32_16x16x64_bf16 v[60:63], v[72:75], v[248:255], v2
    v_cvt_pk_bf16_f32 v35, v44, v45
    buffer_store_dwordx4 v[32:35], v8, s[4:7], s46 offen
    v_pk_add_f32 v[48:49], v[48:49], v[50:51]
    v_cvt_pk_bf16_f32 v48, v48, v49
    v_and_or_b32 v48, v48, -2, s42
    v_pk_add_f32 v[52:53], v[52:53], v[54:55]
    v_cvt_pk_bf16_f32 v49, v52, v53
    v_pk_add_f32 v[56:57], v[56:57], v[58:59]
    v_cvt_pk_bf16_f32 v50, v56, v57
    v_pk_add_f32 v[60:61], v[60:61], v[62:63]
    v_cvt_pk_bf16_f32 v51, v60, v61
    buffer_store_dwordx4 v[48:51], v8, s[4:7], s61 offen
    s_add_u32 s45, s45, 262144
    s_add_u32 s51, s51, 262144
    v_mfma_f32_32x32x8_bf16 v[96:111], v[14:15], v[14:15], 0
    v_mfma_f32_16x16x16_bf16 v[112:115], v[14:15], v[14:15], 0
    v_mfma_f32_16x16x16_bf16 v[116:119], v[14:15], v[14:15], 0
    ds_read_b128 v[64:67], v1 offset:12288
    ds_read_b128 v[68:71], v1 offset:13312
    ds_read_b128 v[72:75], v1 offset:14336
    ds_read_b128 v[76:79], v1 offset:15360
    ds_read_b128 v[80:83], v1 offset:28672
    ds_read_b128 v[84:87], v1 offset:29696
    ds_read_b128 v[88:91], v1 offset:30720
    ds_read_b128 v[92:95], v1 offset:31744
    s_add_u32 s22, s21, 2
    s_cmp_gt_u32 s50, s22
    s_cbranch_scc1 mega_kernel_rf_w3_kvs
    v_readlane_b32 s50, v12, 0
    v_readlane_b32 s22, v12, 2
    v_readlane_b32 s23, v12, 1
    v_readlane_b32 s24, v12, 3
    s_nop 3
    s_min_u32 s50, s50, s22
    s_min_u32 s23, s23, s24
    s_lshl_b32 s50, s50, 1
    s_lshl_b32 s23, s23, 1
    s_add_u32 s23, s23, 1
    s_min_u32 s50, s50, s23
mega_kernel_rf_kvb1:
    s_add_u32 s22, s21, 1
    s_min_u32 s22, s22, 63
    s_cmp_gt_u32 s50, s22
    s_cbranch_scc1 mega_kernel_rf_kvd1
    buffer_load_dword v12, v7, s[4:7], 0 offen sc1
    s_waitcnt vmcnt(0)
    v_readlane_b32 s50, v12, 0
    v_readlane_b32 s22, v12, 2
    v_readlane_b32 s23, v12, 1
    v_readlane_b32 s24, v12, 3
    s_nop 3
    s_min_u32 s50, s50, s22
    s_min_u32 s23, s23, s24
    s_lshl_b32 s50, s50, 1
    s_lshl_b32 s23, s23, 1
    s_add_u32 s23, s23, 1
    s_min_u32 s50, s50, s23
    s_branch mega_kernel_rf_kvb1
mega_kernel_rf_kvd1:
mega_kernel_rf_w3_kvs:
    v_mov_b32 v58, -1
    v_mov_b32 v59, -1
    s_waitcnt vmcnt(0)
mega_kernel_rf_w3_pc:
    buffer_load_dword v36, v13, s[4:7], s25 offen offset:0 sc1
    buffer_load_dword v37, v13, s[4:7], s25 offen offset:256 sc1
    buffer_load_dword v38, v13, s[4:7], s25 offen offset:512 sc1
    buffer_load_dword v39, v13, s[4:7], s25 offen offset:768 sc1
    buffer_load_dword v40, v13, s[4:7], s25 offen offset:1024 sc1
    buffer_load_dword v41, v13, s[4:7], s25 offen offset:1280 sc1
    buffer_load_dword v42, v13, s[4:7], s25 offen offset:1536 sc1
    buffer_load_dword v43, v13, s[4:7], s25 offen offset:1792 sc1
    s_waitcnt vmcnt(4)
    v_mfma_f32_16x16x32_bf16 v[52:55], v[36:39], v[24:27], 0
    v_bitop3_b32 v3, s42, v36, v37 bitop3:0x7e
    v_bitop3_b32 v4, s42, v38, v39 bitop3:0x7e
    s_waitcnt vmcnt(2)
    v_or_b32 v3, v3, v4
    v_bitop3_b32 v4, s42, v40, v41 bitop3:0x7e
    s_waitcnt vmcnt(0)
    v_mfma_f32_16x16x32_bf16 v[52:55], v[40:43], v[24:27], v[52:55]
    v_bitop3_b32 v56, s42, v42, v43 bitop3:0x7e
    v_or3_b32 v3, v3, v4, v56
    v_and_b32 v3, v0, v3
    v_cmp_ne_u32 vcc, 0, v3
    s_nop 3
    v_cvt_pk_bf16_f32 v56, v52, v53
    v_cvt_pk_bf16_f32 v57, v54, v55
    v_min_u32 v56, -2, v56
    s_cbranch_vccnz mega_kernel_rf_w3_pc
    s_mov_b64 exec, s[26:27]
    buffer_store_dwordx2 v[56:57], v9, s[4:7], s35 offen offset:768
    buffer_store_dwordx2 v[58:59], v9, s[4:7], s36 offen offset:768
    s_mov_b64 exec, -1
    s_xor_b32 s42, s42, 1
    s_branch mega_kernel_rf_w3_loop
mega_kernel_rf_w3_last:
    buffer_store_dwordx4 v[64:67], v10, s[4:7], s45 offen offset:192 sc1
    buffer_store_dwordx2 v[18:19], v11, s[4:7], s51 offen offset:3584 sc1
    s_branch mega_kernel_rf_end
mega_kernel_rf_w3_pafail:
    s_nop 7
    v_mov_b32 v96, 0
    v_mov_b32 v97, 0
    v_mov_b32 v98, 0
    v_mov_b32 v99, 0
    v_mov_b32 v100, 0
    v_mov_b32 v101, 0
    v_mov_b32 v102, 0
    v_mov_b32 v103, 0
    v_mov_b32 v104, 0
    v_mov_b32 v105, 0
    v_mov_b32 v106, 0
    v_mov_b32 v107, 0
    s_branch mega_kernel_rf_w3_pa
mega_kernel_rf_w3_xslow:
    buffer_load_dwordx2 v[108:109], v11, s[4:7], s38 offen sc1
    buffer_load_dwordx2 v[110:111], v11, s[4:7], s38 offen offset:512 sc1
    s_waitcnt vmcnt(2)
    v_bitop3_b32 v3, s41, v20, v22 bitop3:0x7e
    v_mfma_f32_16x16x16_bf16 v[80:83], v[20:21], v[16:17], v[100:103]
    v_and_b32 v3, 1, v3
    v_mfma_f32_16x16x16_bf16 v[84:87], v[22:23], v[16:17], v[104:107]
    v_cmp_ne_u32 vcc, 0, v3
    s_cbranch_vccz mega_kernel_rf_w3_xgot
    buffer_load_dwordx2 v[20:21], v11, s[4:7], s38 offen sc1
    buffer_load_dwordx2 v[22:23], v11, s[4:7], s38 offen offset:512 sc1
    s_waitcnt vmcnt(2)
    v_bitop3_b32 v3, s41, v108, v110 bitop3:0x7e
    v_mfma_f32_16x16x16_bf16 v[80:83], v[108:109], v[16:17], v[100:103]
    v_and_b32 v3, 1, v3
    v_mfma_f32_16x16x16_bf16 v[84:87], v[110:111], v[16:17], v[104:107]
    v_cmp_ne_u32 vcc, 0, v3
    s_cbranch_vccz mega_kernel_rf_w3_xgot
    s_branch mega_kernel_rf_w3_xslow
mega_kernel_rf_w3_xgot:
    s_nop 3
    v_cvt_pk_bf16_f32 v64, v80, v81
    v_cvt_pk_bf16_f32 v65, v82, v83
    v_cvt_pk_bf16_f32 v66, v84, v85
    v_cvt_pk_bf16_f32 v67, v86, v87
    ds_write_b128 v6, v[64:67] offset:23552
    s_branch mega_kernel_rf_w3_xok
mega_kernel_rf_w3_pv0:
    s_waitcnt vmcnt(2)
    s_branch mega_kernel_rf_w3_pv1
mega_kernel_rf_w3_pv:
    buffer_load_dwordx2 v[20:21], v11, s[4:7], s40 offen sc1
    s_waitcnt vmcnt(0)
mega_kernel_rf_w3_pv1:
    v_and_b32 v3, 1, v20
    v_cmp_ne_u32 vcc, s41, v3
    v_mov_b32 v113, v20
    v_mov_b32 v115, v21
    s_cbranch_vccnz mega_kernel_rf_w3_pv
    s_branch mega_kernel_rf_w3_pv2
mega_kernel_rf_end:
    s_mov_b64 exec, -1
    v_mov_b32 v3, 64
    s_waitcnt vmcnt(0)
    s_barrier
    s_cmp_lg_u32 s20, 0
    s_cbranch_scc1 mega_kernel_rf_end2
    buffer_store_dword v3, v7, s[4:7], 0 offen sc1
mega_kernel_rf_end2:
    s_waitcnt vmcnt(0)
    s_endpgm
mega_kernel_recs:
    s_load_dwordx2 s[4:5], s[0:1], 96
    s_load_dwordx2 s[12:13], s[0:1], 88
    s_load_dwordx2 s[50:51], s[0:1], 16
    s_load_dwordx2 s[52:53], s[0:1], 24
    s_load_dwordx2 s[54:55], s[0:1], 32
    s_load_dwordx2 s[56:57], s[0:1], 40
    s_load_dwordx2 s[58:59], s[0:1], 8
    v_lshrrev_b32 v3, 6, v0
    v_and_b32 v40, 63, v0
    v_readfirstlane_b32 s20, v3
    v_lshrrev_b32 v41, 4, v40
    v_and_b32 v42, 15, v40
    v_lshlrev_b32 v1, 4, v40
    s_mov_b32 s49, 0
    s_waitcnt lgkmcnt(0)
    s_mov_b32 s6, 268435456
    s_mov_b32 s7, 0x00020000
    s_mov_b32 s14, 256
    s_mov_b32 s15, 0x00020000
    s_mov_b32 s10, 8388608
    s_mov_b32 s11, 0x00020000
    s_mov_b32 s26, 0x00030003
    s_mov_b32 s27, 0x00030003
    s_mov_b32 s28, 0xcccccccc
    s_mov_b32 s29, 0xcccccccc
    s_mov_b32 s32, 0x33333333
    s_mov_b32 s33, 0x33333333
    s_mov_b32 s34, 0x3e0293ee
    s_lshl_b32 s22, s20, 2
    v_xor_b32 v3, s22, v42
    v_lshlrev_b32 v3, 4, v3
    v_lshl_add_u32 v4, v41, 4, s20
    v_lshl_add_u32 v44, v4, 13, v3
    s_lshl_b32 s22, s30, 22
    s_lshl_b32 s23, s31, 8
    s_add_u32 s22, s22, s23
    v_add_u32 v44, s22, v44
    s_lshr_b32 s22, s20, 1
    s_lshl_b32 s22, s22, 5
    s_and_b32 s23, s20, 1
    s_lshl_b32 s23, s23, 2
    s_add_u32 s22, s22, s23
    s_lshl_b32 s23, s31, 7
    s_add_u32 s22, s22, s23
    v_add_u32 v4, s22, v41
    v_lshl_add_u32 v45, v4, 11, v3
    s_lshl_b32 s22, s30, 10
    v_add_u32 v45, s22, v45
    s_lshl_b32 s48, s20, 10
    s_mov_b32 s8, s50
    s_mov_b32 s9, s51
    s_add_u32 m0, s48, 0
    s_mov_b32 s22, 0
    buffer_load_dwordx4 v44, s[8:11], s22 offen  lds
    s_add_u32 m0, s48, 4096
    s_mov_b32 s22, 32768
    buffer_load_dwordx4 v44, s[8:11], s22 offen  lds
    s_add_u32 m0, s48, 8192
    s_mov_b32 s22, 65536
    buffer_load_dwordx4 v44, s[8:11], s22 offen  lds
    s_add_u32 m0, s48, 12288
    s_mov_b32 s22, 98304
    buffer_load_dwordx4 v44, s[8:11], s22 offen  lds
    s_add_u32 m0, s48, 16384
    s_mov_b32 s22, 524288
    buffer_load_dwordx4 v44, s[8:11], s22 offen  lds
    s_add_u32 m0, s48, 20480
    s_mov_b32 s22, 557056
    buffer_load_dwordx4 v44, s[8:11], s22 offen  lds
    s_add_u32 m0, s48, 24576
    s_mov_b32 s22, 589824
    buffer_load_dwordx4 v44, s[8:11], s22 offen  lds
    s_add_u32 m0, s48, 28672
    s_mov_b32 s22, 622592
    buffer_load_dwordx4 v44, s[8:11], s22 offen  lds
    s_add_u32 m0, s48, 32768
    s_mov_b32 s22, 1048576
    buffer_load_dwordx4 v44, s[8:11], s22 offen  lds
    s_add_u32 m0, s48, 36864
    s_mov_b32 s22, 1081344
    buffer_load_dwordx4 v44, s[8:11], s22 offen  lds
    s_add_u32 m0, s48, 40960
    s_mov_b32 s22, 1114112
    buffer_load_dwordx4 v44, s[8:11], s22 offen  lds
    s_add_u32 m0, s48, 45056
    s_mov_b32 s22, 1146880
    buffer_load_dwordx4 v44, s[8:11], s22 offen  lds
    s_add_u32 m0, s48, 49152
    s_mov_b32 s22, 1572864
    buffer_load_dwordx4 v44, s[8:11], s22 offen  lds
    s_add_u32 m0, s48, 53248
    s_mov_b32 s22, 1605632
    buffer_load_dwordx4 v44, s[8:11], s22 offen  lds
    s_add_u32 m0, s48, 57344
    s_mov_b32 s22, 1638400
    buffer_load_dwordx4 v44, s[8:11], s22 offen  lds
    s_add_u32 m0, s48, 61440
    s_mov_b32 s22, 1671168
    buffer_load_dwordx4 v44, s[8:11], s22 offen  lds
    s_add_u32 m0, s48, 65536
    s_mov_b32 s22, 2097152
    buffer_load_dwordx4 v44, s[8:11], s22 offen  lds
    s_add_u32 m0, s48, 69632
    s_mov_b32 s22, 2129920
    buffer_load_dwordx4 v44, s[8:11], s22 offen  lds
    s_add_u32 m0, s48, 73728
    s_mov_b32 s22, 2162688
    buffer_load_dwordx4 v44, s[8:11], s22 offen  lds
    s_add_u32 m0, s48, 77824
    s_mov_b32 s22, 2195456
    buffer_load_dwordx4 v44, s[8:11], s22 offen  lds
    s_add_u32 m0, s48, 81920
    s_mov_b32 s22, 2621440
    buffer_load_dwordx4 v44, s[8:11], s22 offen  lds
    s_add_u32 m0, s48, 86016
    s_mov_b32 s22, 2654208
    buffer_load_dwordx4 v44, s[8:11], s22 offen  lds
    s_add_u32 m0, s48, 90112
    s_mov_b32 s22, 2686976
    buffer_load_dwordx4 v44, s[8:11], s22 offen  lds
    s_add_u32 m0, s48, 94208
    s_mov_b32 s22, 2719744
    buffer_load_dwordx4 v44, s[8:11], s22 offen  lds
    s_add_u32 m0, s48, 98304
    s_mov_b32 s22, 3145728
    buffer_load_dwordx4 v44, s[8:11], s22 offen  lds
    s_add_u32 m0, s48, 102400
    s_mov_b32 s22, 3178496
    buffer_load_dwordx4 v44, s[8:11], s22 offen  lds
    s_add_u32 m0, s48, 106496
    s_mov_b32 s22, 3211264
    buffer_load_dwordx4 v44, s[8:11], s22 offen  lds
    s_add_u32 m0, s48, 110592
    s_mov_b32 s22, 3244032
    buffer_load_dwordx4 v44, s[8:11], s22 offen  lds
    s_add_u32 m0, s48, 114688
    s_mov_b32 s22, 3670016
    buffer_load_dwordx4 v44, s[8:11], s22 offen  lds
    s_add_u32 m0, s48, 118784
    s_mov_b32 s22, 3702784
    buffer_load_dwordx4 v44, s[8:11], s22 offen  lds
    s_add_u32 m0, s48, 122880
    s_mov_b32 s22, 3735552
    buffer_load_dwordx4 v44, s[8:11], s22 offen  lds
    s_add_u32 m0, s48, 126976
    s_mov_b32 s22, 3768320
    buffer_load_dwordx4 v44, s[8:11], s22 offen  lds
    s_lshl_b32 s22, s30, 5
    s_add_u32 s22, s22, s31
    s_lshl_b32 s38, s22, 14
    s_xor_b32 s22, s22, 32
    s_lshl_b32 s37, s22, 14
    s_add_u32 s38, s38, 67108864
    s_add_u32 s37, s37, 67108864
    s_lshl_b32 s46, s30, 19
    s_add_u32 s46, s46, 70254592
    s_mul_i32 s22, s31, 8448
    s_add_u32 s47, s46, s22
    s_mul_i32 s22, s20, 67584
    s_add_u32 s46, s46, s22
    s_lshl_b32 s22, s31, 6
    s_add_u32 s46, s46, s22
    s_add_u32 s61, s46, 33792
    s_mul_i32 s22, s20, 2048
    s_add_u32 s25, s47, s22
    s_lshl_b32 s35, s30, 13
    s_add_u32 s35, s35, 69206016
    v_lshrrev_b32 v53, 2, v42
    v_lshlrev_b32 v53, 1, v53
    v_and_b32 v54, 1, v42
    v_add_u32 v55, v53, v54
    v_mov_b32 v14, 0
    v_mov_b32 v15, 0
    v_mov_b32 v2, 0x4444
    v_mov_b32 v3, 0xeeee
    v_cndmask_b32 v2, v2, v3, s[28:29]
    s_lshl_b32 s22, s20, 12
    v_add_u32 v32, s22, v1
    v_add_u32 v33, 0x10000, v32
    v_add_u32 v5, 0x10000, v1
    v_add_u32 v6, 131072, v1
    v_and_b32 v3, 3, v42
    v_bfe_u32 v43, v40, 1, 1
    v_lshlrev_b32 v7, 13, v43
    v_and_b32 v43, 1, v40
    v_lshl_add_u32 v7, v43, 7, v7
    s_lshl_b32 s22, s31, 8
    s_add_u32 s23, s22, 71311360
    v_add_u32 v7, s23, v7
    s_cmp_lg_u32 s20, 0
    s_cbranch_scc1 mega_kernel_rs_flk
    s_lshl_b32 s23, s30, 7
    s_add_u32 s22, s22, s23
    s_add_u32 s22, s22, 71327744
    v_bfrev_b32 v7, 1
    v_writelane_b32 v7, s22, 0
mega_kernel_rs_flk:
    v_lshlrev_b32 v11, 3, v40
    v_lshlrev_b32 v10, 8, v55
    v_lshl_add_u32 v10, v41, 4, v10
    v_mul_u32_u24 v8, 8448, v41
    v_lshl_add_u32 v8, v3, 4, v8
    v_lshrrev_b32 v4, 2, v42
    v_mul_u32_u24 v4, 2048, v4
    v_add_u32 v8, v4, v8
    v_lshrrev_b32 v9, 1, v41
    v_lshlrev_b32 v9, 5, v9
    v_and_b32 v4, 1, v42
    v_lshl_add_u32 v9, v4, 4, v9
    v_and_b32 v4, 1, v41
    v_lshl_add_u32 v9, v4, 3, v9
    s_lshr_b32 s22, s31, 2
    s_lshl_b32 s22, s22, 10
    s_and_b32 s23, s31, 3
    s_lshl_b32 s23, s23, 6
    s_add_u32 s22, s22, s23
    v_add_u32 v9, s22, v9
    v_lshrrev_b32 v4, 2, v42
    v_lshlrev_b32 v12, 8, v4
    v_lshl_add_u32 v12, v41, 6, v12
    v_lshl_add_u32 v12, v3, 4, v12
    v_lshlrev_b32 v13, 6, v41
    v_lshl_add_u32 v13, v42, 2, v13
    v_cmp_eq_u32 vcc, 0, v3
    v_mov_b32 v28, 0x3f803f80
    v_mov_b32 v29, 0x3f803f80
    v_cndmask_b32 v34, 0, 1, vcc
    v_mov_b32 v30, 0x3f803f80
    v_mov_b32 v31, 0x3f803f80
    v_and_b32 v49, 1, v42
    v_lshlrev_b32 v49, 4, v49
    v_mov_b32 v50, 0x3f80
    v_lshlrev_b32 v50, v49, v50
    v_lshrrev_b32 v51, 2, v42
    v_cmp_eq_u32 vcc, v51, v41
    v_mov_b32 v24, v50
    v_cndmask_b32 v52, 0, v50, s[28:29]
    v_cndmask_b32 v53, 0, v50, s[32:33]
    v_cndmask_b32 v16, 0, v52, vcc
    v_cndmask_b32 v17, 0, v53, vcc
    v_mov_b32 v25, v50
    v_mov_b32 v26, v50
    v_mov_b32 v27, v50
    v_bfe_u32 v60, v40, 3, 1
    v_bfe_u32 v49, v40, 2, 1
    v_and_b32 v50, 1, v41
    v_lshrrev_b32 v51, 1, v41
    v_lshlrev_b32 v52, 3, v60
    v_lshl_add_u32 v52, v50, 2, v52
    v_lshl_add_u32 v53, v51, 4, v52
    v_add_u32 v53, v53, v49
    v_and_b32 v54, 3, v40
    s_lshl_b32 s22, s20, 2
    v_add_u32 v55, s22, v54
    v_xor_b32 v55, v55, v52
    v_lshlrev_b32 v55, 4, v55
    v_lshl_add_u32 v46, v53, 8, v55
    v_lshlrev_b32 v55, 4, v52
    v_lshl_add_u32 v55, v54, 3, v55
    v_lshl_add_u32 v47, v53, 8, v55
    s_waitcnt vmcnt(28)
    s_barrier
    v_add_u32 v48, 0, v46
    ds_read_b64_tr_b16 a[0:1], v48 offset:0
    ds_read_b64_tr_b16 a[2:3], v48 offset:512
    ds_read_b64_tr_b16 a[4:5], v48 offset:8192
    ds_read_b64_tr_b16 a[6:7], v48 offset:8704
    ds_read_b64_tr_b16 a[8:9], v48 offset:8
    ds_read_b64_tr_b16 a[10:11], v48 offset:520
    ds_read_b64_tr_b16 a[12:13], v48 offset:8200
    ds_read_b64_tr_b16 a[14:15], v48 offset:8712
    s_waitcnt lgkmcnt(0)
    s_barrier
    s_mov_b32 s8, s52
    s_mov_b32 s9, s53
    s_add_u32 m0, s48, 0
    s_mov_b32 s22, 0
    buffer_load_dwordx4 v44, s[8:11], s22 offen  lds
    s_add_u32 m0, s48, 4096
    s_mov_b32 s22, 32768
    buffer_load_dwordx4 v44, s[8:11], s22 offen  lds
    s_add_u32 m0, s48, 8192
    s_mov_b32 s22, 65536
    buffer_load_dwordx4 v44, s[8:11], s22 offen  lds
    s_add_u32 m0, s48, 12288
    s_mov_b32 s22, 98304
    buffer_load_dwordx4 v44, s[8:11], s22 offen  lds
    s_waitcnt vmcnt(28)
    s_barrier
    v_add_u32 v48, 16384, v46
    ds_read_b64_tr_b16 a[16:17], v48 offset:0
    ds_read_b64_tr_b16 a[18:19], v48 offset:512
    ds_read_b64_tr_b16 a[20:21], v48 offset:8192
    ds_read_b64_tr_b16 a[22:23], v48 offset:8704
    ds_read_b64_tr_b16 a[24:25], v48 offset:8
    ds_read_b64_tr_b16 a[26:27], v48 offset:520
    ds_read_b64_tr_b16 a[28:29], v48 offset:8200
    ds_read_b64_tr_b16 a[30:31], v48 offset:8712
    s_waitcnt lgkmcnt(0)
    s_barrier
    s_add_u32 m0, s48, 16384
    s_mov_b32 s22, 524288
    buffer_load_dwordx4 v44, s[8:11], s22 offen  lds
    s_add_u32 m0, s48, 20480
    s_mov_b32 s22, 557056
    buffer_load_dwordx4 v44, s[8:11], s22 offen  lds
    s_add_u32 m0, s48, 24576
    s_mov_b32 s22, 589824
    buffer_load_dwordx4 v44, s[8:11], s22 offen  lds
    s_add_u32 m0, s48, 28672
    s_mov_b32 s22, 622592
    buffer_load_dwordx4 v44, s[8:11], s22 offen  lds
    s_waitcnt vmcnt(28)
    s_barrier
    v_add_u32 v48, 32768, v46
    ds_read_b64_tr_b16 a[32:33], v48 offset:0
    ds_read_b64_tr_b16 a[34:35], v48 offset:512
    ds_read_b64_tr_b16 a[36:37], v48 offset:8192
    ds_read_b64_tr_b16 a[38:39], v48 offset:8704
    ds_read_b64_tr_b16 a[40:41], v48 offset:8
    ds_read_b64_tr_b16 a[42:43], v48 offset:520
    ds_read_b64_tr_b16 a[44:45], v48 offset:8200
    ds_read_b64_tr_b16 a[46:47], v48 offset:8712
    s_waitcnt lgkmcnt(0)
    s_barrier
    s_add_u32 m0, s48, 32768
    s_mov_b32 s22, 1048576
    buffer_load_dwordx4 v44, s[8:11], s22 offen  lds
    s_add_u32 m0, s48, 36864
    s_mov_b32 s22, 1081344
    buffer_load_dwordx4 v44, s[8:11], s22 offen  lds
    s_add_u32 m0, s48, 40960
    s_mov_b32 s22, 1114112
    buffer_load_dwordx4 v44, s[8:11], s22 offen  lds
    s_add_u32 m0, s48, 45056
    s_mov_b32 s22, 1146880
    buffer_load_dwordx4 v44, s[8:11], s22 offen  lds
    s_waitcnt vmcnt(28)
    s_barrier
    v_add_u32 v48, 49152, v46
    ds_read_b64_tr_b16 a[48:49], v48 offset:0
    ds_read_b64_tr_b16 a[50:51], v48 offset:512
    ds_read_b64_tr_b16 a[52:53], v48 offset:8192
    ds_read_b64_tr_b16 a[54:55], v48 offset:8704
    ds_read_b64_tr_b16 a[56:57], v48 offset:8
    ds_read_b64_tr_b16 a[58:59], v48 offset:520
    ds_read_b64_tr_b16 a[60:61], v48 offset:8200
    ds_read_b64_tr_b16 a[62:63], v48 offset:8712
    s_waitcnt lgkmcnt(0)
    s_barrier
    s_add_u32 m0, s48, 49152
    s_mov_b32 s22, 1572864
    buffer_load_dwordx4 v44, s[8:11], s22 offen  lds
    s_add_u32 m0, s48, 53248
    s_mov_b32 s22, 1605632
    buffer_load_dwordx4 v44, s[8:11], s22 offen  lds
    s_add_u32 m0, s48, 57344
    s_mov_b32 s22, 1638400
    buffer_load_dwordx4 v44, s[8:11], s22 offen  lds
    s_add_u32 m0, s48, 61440
    s_mov_b32 s22, 1671168
    buffer_load_dwordx4 v44, s[8:11], s22 offen  lds
    s_waitcnt vmcnt(28)
    s_barrier
    v_add_u32 v48, 65536, v46
    ds_read_b64_tr_b16 a[64:65], v48 offset:0
    ds_read_b64_tr_b16 a[66:67], v48 offset:512
    ds_read_b64_tr_b16 a[68:69], v48 offset:8192
    ds_read_b64_tr_b16 a[70:71], v48 offset:8704
    ds_read_b64_tr_b16 a[72:73], v48 offset:8
    ds_read_b64_tr_b16 a[74:75], v48 offset:520
    ds_read_b64_tr_b16 a[76:77], v48 offset:8200
    ds_read_b64_tr_b16 a[78:79], v48 offset:8712
    s_waitcnt lgkmcnt(0)
    s_barrier
    s_add_u32 m0, s48, 65536
    s_mov_b32 s22, 2097152
    buffer_load_dwordx4 v44, s[8:11], s22 offen  lds
    s_add_u32 m0, s48, 69632
    s_mov_b32 s22, 2129920
    buffer_load_dwordx4 v44, s[8:11], s22 offen  lds
    s_add_u32 m0, s48, 73728
    s_mov_b32 s22, 2162688
    buffer_load_dwordx4 v44, s[8:11], s22 offen  lds
    s_add_u32 m0, s48, 77824
    s_mov_b32 s22, 2195456
    buffer_load_dwordx4 v44, s[8:11], s22 offen  lds
    s_waitcnt vmcnt(28)
    s_barrier
    v_add_u32 v48, 81920, v46
    ds_read_b64_tr_b16 a[80:81], v48 offset:0
    ds_read_b64_tr_b16 a[82:83], v48 offset:512
    ds_read_b64_tr_b16 a[84:85], v48 offset:8192
    ds_read_b64_tr_b16 a[86:87], v48 offset:8704
    ds_read_b64_tr_b16 a[88:89], v48 offset:8
    ds_read_b64_tr_b16 a[90:91], v48 offset:520
    ds_read_b64_tr_b16 a[92:93], v48 offset:8200
    ds_read_b64_tr_b16 a[94:95], v48 offset:8712
    s_waitcnt lgkmcnt(0)
    s_barrier
    s_add_u32 m0, s48, 81920
    s_mov_b32 s22, 2621440
    buffer_load_dwordx4 v44, s[8:11], s22 offen  lds
    s_add_u32 m0, s48, 86016
    s_mov_b32 s22, 2654208
    buffer_load_dwordx4 v44, s[8:11], s22 offen  lds
    s_add_u32 m0, s48, 90112
    s_mov_b32 s22, 2686976
    buffer_load_dwordx4 v44, s[8:11], s22 offen  lds
    s_add_u32 m0, s48, 94208
    s_mov_b32 s22, 2719744
    buffer_load_dwordx4 v44, s[8:11], s22 offen  lds
    s_waitcnt vmcnt(28)
    s_barrier
    v_add_u32 v48, 98304, v46
    ds_read_b64_tr_b16 a[96:97], v48 offset:0
    ds_read_b64_tr_b16 a[98:99], v48 offset:512
    ds_read_b64_tr_b16 a[100:101], v48 offset:8192
    ds_read_b64_tr_b16 a[102:103], v48 offset:8704
    ds_read_b64_tr_b16 a[104:105], v48 offset:8
    ds_read_b64_tr_b16 a[106:107], v48 offset:520
    ds_read_b64_tr_b16 a[108:109], v48 offset:8200
    ds_read_b64_tr_b16 a[110:111], v48 offset:8712
    s_waitcnt lgkmcnt(0)
    s_barrier
    s_add_u32 m0, s48, 98304
    s_mov_b32 s22, 3145728
    buffer_load_dwordx4 v44, s[8:11], s22 offen  lds
    s_add_u32 m0, s48, 102400
    s_mov_b32 s22, 3178496
    buffer_load_dwordx4 v44, s[8:11], s22 offen  lds
    s_add_u32 m0, s48, 106496
    s_mov_b32 s22, 3211264
    buffer_load_dwordx4 v44, s[8:11], s22 offen  lds
    s_add_u32 m0, s48, 110592
    s_mov_b32 s22, 3244032
    buffer_load_dwordx4 v44, s[8:11], s22 offen  lds
    s_waitcnt vmcnt(28)
    s_barrier
    v_add_u32 v48, 114688, v46
    ds_read_b64_tr_b16 a[112:113], v48 offset:0
    ds_read_b64_tr_b16 a[114:115], v48 offset:512
    ds_read_b64_tr_b16 a[116:117], v48 offset:8192
    ds_read_b64_tr_b16 a[118:119], v48 offset:8704
    ds_read_b64_tr_b16 a[120:121], v48 offset:8
    ds_read_b64_tr_b16 a[122:123], v48 offset:520
    ds_read_b64_tr_b16 a[124:125], v48 offset:8200
    ds_read_b64_tr_b16 a[126:127], v48 offset:8712
    s_waitcnt lgkmcnt(0)
    s_barrier
    s_add_u32 m0, s48, 114688
    s_mov_b32 s22, 3670016
    buffer_load_dwordx4 v44, s[8:11], s22 offen  lds
    s_add_u32 m0, s48, 118784
    s_mov_b32 s22, 3702784
    buffer_load_dwordx4 v44, s[8:11], s22 offen  lds
    s_add_u32 m0, s48, 122880
    s_mov_b32 s22, 3735552
    buffer_load_dwordx4 v44, s[8:11], s22 offen  lds
    s_add_u32 m0, s48, 126976
    s_mov_b32 s22, 3768320
    buffer_load_dwordx4 v44, s[8:11], s22 offen  lds
    s_waitcnt vmcnt(28)
    s_barrier
    v_add_u32 v48, 0, v46
    ds_read_b64_tr_b16 a[128:129], v48 offset:0
    ds_read_b64_tr_b16 a[130:131], v48 offset:512
    ds_read_b64_tr_b16 a[132:133], v48 offset:8192
    ds_read_b64_tr_b16 a[134:135], v48 offset:8704
    ds_read_b64_tr_b16 a[136:137], v48 offset:8
    ds_read_b64_tr_b16 a[138:139], v48 offset:520
    ds_read_b64_tr_b16 a[140:141], v48 offset:8200
    ds_read_b64_tr_b16 a[142:143], v48 offset:8712
    s_waitcnt lgkmcnt(0)
    s_barrier
    s_mov_b32 s8, s56
    s_mov_b32 s9, s57
    s_add_u32 m0, s48, 0
    s_mov_b32 s22, 0
    buffer_load_dwordx4 v45, s[8:11], s22 offen  lds
    s_add_u32 m0, s48, 4096
    s_mov_b32 s22, 16384
    buffer_load_dwordx4 v45, s[8:11], s22 offen  lds
    s_add_u32 m0, s48, 8192
    s_mov_b32 s22, 32768
    buffer_load_dwordx4 v45, s[8:11], s22 offen  lds
    s_add_u32 m0, s48, 12288
    s_mov_b32 s22, 49152
    buffer_load_dwordx4 v45, s[8:11], s22 offen  lds
    s_waitcnt vmcnt(28)
    s_barrier
    v_add_u32 v48, 16384, v46
    ds_read_b64_tr_b16 a[144:145], v48 offset:0
    ds_read_b64_tr_b16 a[146:147], v48 offset:512
    ds_read_b64_tr_b16 a[148:149], v48 offset:8192
    ds_read_b64_tr_b16 a[150:151], v48 offset:8704
    ds_read_b64_tr_b16 a[152:153], v48 offset:8
    ds_read_b64_tr_b16 a[154:155], v48 offset:520
    ds_read_b64_tr_b16 a[156:157], v48 offset:8200
    ds_read_b64_tr_b16 a[158:159], v48 offset:8712
    s_waitcnt lgkmcnt(0)
    s_barrier
    s_add_u32 m0, s48, 16384
    s_mov_b32 s22, 256
    buffer_load_dwordx4 v45, s[8:11], s22 offen  lds
    s_add_u32 m0, s48, 20480
    s_mov_b32 s22, 16640
    buffer_load_dwordx4 v45, s[8:11], s22 offen  lds
    s_add_u32 m0, s48, 24576
    s_mov_b32 s22, 33024
    buffer_load_dwordx4 v45, s[8:11], s22 offen  lds
    s_add_u32 m0, s48, 28672
    s_mov_b32 s22, 49408
    buffer_load_dwordx4 v45, s[8:11], s22 offen  lds
    s_waitcnt vmcnt(28)
    s_barrier
    v_add_u32 v48, 32768, v46
    ds_read_b64_tr_b16 a[160:161], v48 offset:0
    ds_read_b64_tr_b16 a[162:163], v48 offset:512
    ds_read_b64_tr_b16 a[164:165], v48 offset:8192
    ds_read_b64_tr_b16 a[166:167], v48 offset:8704
    ds_read_b64_tr_b16 a[168:169], v48 offset:8
    ds_read_b64_tr_b16 a[170:171], v48 offset:520
    ds_read_b64_tr_b16 a[172:173], v48 offset:8200
    ds_read_b64_tr_b16 a[174:175], v48 offset:8712
    s_waitcnt lgkmcnt(0)
    s_barrier
    s_add_u32 m0, s48, 32768
    s_mov_b32 s22, 512
    buffer_load_dwordx4 v45, s[8:11], s22 offen  lds
    s_add_u32 m0, s48, 36864
    s_mov_b32 s22, 16896
    buffer_load_dwordx4 v45, s[8:11], s22 offen  lds
    s_add_u32 m0, s48, 40960
    s_mov_b32 s22, 33280
    buffer_load_dwordx4 v45, s[8:11], s22 offen  lds
    s_add_u32 m0, s48, 45056
    s_mov_b32 s22, 49664
    buffer_load_dwordx4 v45, s[8:11], s22 offen  lds
    s_waitcnt vmcnt(28)
    s_barrier
    v_add_u32 v48, 49152, v46
    ds_read_b64_tr_b16 a[176:177], v48 offset:0
    ds_read_b64_tr_b16 a[178:179], v48 offset:512
    ds_read_b64_tr_b16 a[180:181], v48 offset:8192
    ds_read_b64_tr_b16 a[182:183], v48 offset:8704
    ds_read_b64_tr_b16 a[184:185], v48 offset:8
    ds_read_b64_tr_b16 a[186:187], v48 offset:520
    ds_read_b64_tr_b16 a[188:189], v48 offset:8200
    ds_read_b64_tr_b16 a[190:191], v48 offset:8712
    s_waitcnt lgkmcnt(0)
    s_barrier
    s_add_u32 m0, s48, 49152
    s_mov_b32 s22, 768
    buffer_load_dwordx4 v45, s[8:11], s22 offen  lds
    s_add_u32 m0, s48, 53248
    s_mov_b32 s22, 17152
    buffer_load_dwordx4 v45, s[8:11], s22 offen  lds
    s_add_u32 m0, s48, 57344
    s_mov_b32 s22, 33536
    buffer_load_dwordx4 v45, s[8:11], s22 offen  lds
    s_add_u32 m0, s48, 61440
    s_mov_b32 s22, 49920
    buffer_load_dwordx4 v45, s[8:11], s22 offen  lds
    s_waitcnt vmcnt(28)
    s_barrier
    v_add_u32 v48, 65536, v46
    ds_read_b64_tr_b16 a[192:193], v48 offset:0
    ds_read_b64_tr_b16 a[194:195], v48 offset:512
    ds_read_b64_tr_b16 a[196:197], v48 offset:8192
    ds_read_b64_tr_b16 a[198:199], v48 offset:8704
    ds_read_b64_tr_b16 a[200:201], v48 offset:8
    ds_read_b64_tr_b16 a[202:203], v48 offset:520
    ds_read_b64_tr_b16 a[204:205], v48 offset:8200
    ds_read_b64_tr_b16 a[206:207], v48 offset:8712
    s_waitcnt lgkmcnt(0)
    s_barrier
    s_add_u32 m0, s48, 65536
    s_mov_b32 s22, 131072
    buffer_load_dwordx4 v45, s[8:11], s22 offen  lds
    s_add_u32 m0, s48, 69632
    s_mov_b32 s22, 147456
    buffer_load_dwordx4 v45, s[8:11], s22 offen  lds
    s_add_u32 m0, s48, 73728
    s_mov_b32 s22, 163840
    buffer_load_dwordx4 v45, s[8:11], s22 offen  lds
    s_add_u32 m0, s48, 77824
    s_mov_b32 s22, 180224
    buffer_load_dwordx4 v45, s[8:11], s22 offen  lds
    s_waitcnt vmcnt(28)
    s_barrier
    v_add_u32 v48, 81920, v46
    ds_read_b64_tr_b16 a[208:209], v48 offset:0
    ds_read_b64_tr_b16 a[210:211], v48 offset:512
    ds_read_b64_tr_b16 a[212:213], v48 offset:8192
    ds_read_b64_tr_b16 a[214:215], v48 offset:8704
    ds_read_b64_tr_b16 a[216:217], v48 offset:8
    ds_read_b64_tr_b16 a[218:219], v48 offset:520
    ds_read_b64_tr_b16 a[220:221], v48 offset:8200
    ds_read_b64_tr_b16 a[222:223], v48 offset:8712
    s_waitcnt lgkmcnt(0)
    s_barrier
    s_add_u32 m0, s48, 81920
    s_mov_b32 s22, 131328
    buffer_load_dwordx4 v45, s[8:11], s22 offen  lds
    s_add_u32 m0, s48, 86016
    s_mov_b32 s22, 147712
    buffer_load_dwordx4 v45, s[8:11], s22 offen  lds
    s_add_u32 m0, s48, 90112
    s_mov_b32 s22, 164096
    buffer_load_dwordx4 v45, s[8:11], s22 offen  lds
    s_add_u32 m0, s48, 94208
    s_mov_b32 s22, 180480
    buffer_load_dwordx4 v45, s[8:11], s22 offen  lds
    s_waitcnt vmcnt(28)
    s_barrier
    v_add_u32 v48, 98304, v46
    ds_read_b64_tr_b16 a[224:225], v48 offset:0
    ds_read_b64_tr_b16 a[226:227], v48 offset:512
    ds_read_b64_tr_b16 a[228:229], v48 offset:8192
    ds_read_b64_tr_b16 a[230:231], v48 offset:8704
    ds_read_b64_tr_b16 a[232:233], v48 offset:8
    ds_read_b64_tr_b16 a[234:235], v48 offset:520
    ds_read_b64_tr_b16 a[236:237], v48 offset:8200
    ds_read_b64_tr_b16 a[238:239], v48 offset:8712
    s_waitcnt lgkmcnt(0)
    s_barrier
    s_add_u32 m0, s48, 98304
    s_mov_b32 s22, 131584
    buffer_load_dwordx4 v45, s[8:11], s22 offen  lds
    s_add_u32 m0, s48, 102400
    s_mov_b32 s22, 147968
    buffer_load_dwordx4 v45, s[8:11], s22 offen  lds
    s_add_u32 m0, s48, 106496
    s_mov_b32 s22, 164352
    buffer_load_dwordx4 v45, s[8:11], s22 offen  lds
    s_add_u32 m0, s48, 110592
    s_mov_b32 s22, 180736
    buffer_load_dwordx4 v45, s[8:11], s22 offen  lds
    s_waitcnt vmcnt(28)
    s_barrier
    v_add_u32 v48, 114688, v46
    ds_read_b64_tr_b16 a[240:241], v48 offset:0
    ds_read_b64_tr_b16 a[242:243], v48 offset:512
    ds_read_b64_tr_b16 a[244:245], v48 offset:8192
    ds_read_b64_tr_b16 a[246:247], v48 offset:8704
    ds_read_b64_tr_b16 a[248:249], v48 offset:8
    ds_read_b64_tr_b16 a[250:251], v48 offset:520
    ds_read_b64_tr_b16 a[252:253], v48 offset:8200
    ds_read_b64_tr_b16 a[254:255], v48 offset:8712
    s_waitcnt lgkmcnt(0)
    s_barrier
    s_add_u32 m0, s48, 114688
    s_mov_b32 s22, 131840
    buffer_load_dwordx4 v45, s[8:11], s22 offen  lds
    s_add_u32 m0, s48, 118784
    s_mov_b32 s22, 148224
    buffer_load_dwordx4 v45, s[8:11], s22 offen  lds
    s_add_u32 m0, s48, 122880
    s_mov_b32 s22, 164608
    buffer_load_dwordx4 v45, s[8:11], s22 offen  lds
    s_add_u32 m0, s48, 126976
    s_mov_b32 s22, 180992
    buffer_load_dwordx4 v45, s[8:11], s22 offen  lds
    s_waitcnt vmcnt(28)
    s_barrier
    s_cmp_lg_u32 s20, 0
    s_cbranch_scc1 mega_kernel_rs_wo0
    v_xor_b32 v48, 0, v47
    v_add_u32 v48, 0, v48
    ds_read_b64_tr_b16 v[128:129], v48 offset:0
    ds_read_b64_tr_b16 v[130:131], v48 offset:512
    ds_read_b64_tr_b16 v[132:133], v48 offset:8192
    ds_read_b64_tr_b16 v[134:135], v48 offset:8704
    ds_read_b64_tr_b16 v[144:145], v48 offset:32
    ds_read_b64_tr_b16 v[146:147], v48 offset:544
    ds_read_b64_tr_b16 v[148:149], v48 offset:8224
    ds_read_b64_tr_b16 v[150:151], v48 offset:8736
    s_waitcnt lgkmcnt(0)
    v_xor_b32 v48, 64, v47
    v_add_u32 v48, 0, v48
    ds_read_b64_tr_b16 v[160:161], v48 offset:0
    ds_read_b64_tr_b16 v[162:163], v48 offset:512
    ds_read_b64_tr_b16 v[164:165], v48 offset:8192
    ds_read_b64_tr_b16 v[166:167], v48 offset:8704
    ds_read_b64_tr_b16 v[176:177], v48 offset:32
    ds_read_b64_tr_b16 v[178:179], v48 offset:544
    ds_read_b64_tr_b16 v[180:181], v48 offset:8224
    ds_read_b64_tr_b16 v[182:183], v48 offset:8736
    s_waitcnt lgkmcnt(0)
    v_xor_b32 v48, 128, v47
    v_add_u32 v48, 0, v48
    ds_read_b64_tr_b16 v[192:193], v48 offset:0
    ds_read_b64_tr_b16 v[194:195], v48 offset:512
    ds_read_b64_tr_b16 v[196:197], v48 offset:8192
    ds_read_b64_tr_b16 v[198:199], v48 offset:8704
    ds_read_b64_tr_b16 v[208:209], v48 offset:32
    ds_read_b64_tr_b16 v[210:211], v48 offset:544
    ds_read_b64_tr_b16 v[212:213], v48 offset:8224
    ds_read_b64_tr_b16 v[214:215], v48 offset:8736
    s_waitcnt lgkmcnt(0)
    v_xor_b32 v48, 192, v47
    v_add_u32 v48, 0, v48
    ds_read_b64_tr_b16 v[224:225], v48 offset:0
    ds_read_b64_tr_b16 v[226:227], v48 offset:512
    ds_read_b64_tr_b16 v[228:229], v48 offset:8192
    ds_read_b64_tr_b16 v[230:231], v48 offset:8704
    ds_read_b64_tr_b16 v[240:241], v48 offset:32
    ds_read_b64_tr_b16 v[242:243], v48 offset:544
    ds_read_b64_tr_b16 v[244:245], v48 offset:8224
    ds_read_b64_tr_b16 v[246:247], v48 offset:8736
    s_waitcnt lgkmcnt(0)
mega_kernel_rs_wo0:
    s_barrier
    s_mov_b32 s8, s54
    s_mov_b32 s9, s55
    s_add_u32 m0, s48, 0
    s_mov_b32 s22, 0
    buffer_load_dwordx4 v44, s[8:11], s22 offen  lds
    s_add_u32 m0, s48, 4096
    s_mov_b32 s22, 32768
    buffer_load_dwordx4 v44, s[8:11], s22 offen  lds
    s_add_u32 m0, s48, 8192
    s_mov_b32 s22, 65536
    buffer_load_dwordx4 v44, s[8:11], s22 offen  lds
    s_add_u32 m0, s48, 12288
    s_mov_b32 s22, 98304
    buffer_load_dwordx4 v44, s[8:11], s22 offen  lds
    s_waitcnt vmcnt(28)
    s_barrier
    s_cmp_lg_u32 s20, 1
    s_cbranch_scc1 mega_kernel_rs_wo1
    v_xor_b32 v48, 0, v47
    v_add_u32 v48, 16384, v48
    ds_read_b64_tr_b16 v[128:129], v48 offset:0
    ds_read_b64_tr_b16 v[130:131], v48 offset:512
    ds_read_b64_tr_b16 v[132:133], v48 offset:8192
    ds_read_b64_tr_b16 v[134:135], v48 offset:8704
    ds_read_b64_tr_b16 v[144:145], v48 offset:32
    ds_read_b64_tr_b16 v[146:147], v48 offset:544
    ds_read_b64_tr_b16 v[148:149], v48 offset:8224
    ds_read_b64_tr_b16 v[150:151], v48 offset:8736
    s_waitcnt lgkmcnt(0)
    v_xor_b32 v48, 64, v47
    v_add_u32 v48, 16384, v48
    ds_read_b64_tr_b16 v[160:161], v48 offset:0
    ds_read_b64_tr_b16 v[162:163], v48 offset:512
    ds_read_b64_tr_b16 v[164:165], v48 offset:8192
    ds_read_b64_tr_b16 v[166:167], v48 offset:8704
    ds_read_b64_tr_b16 v[176:177], v48 offset:32
    ds_read_b64_tr_b16 v[178:179], v48 offset:544
    ds_read_b64_tr_b16 v[180:181], v48 offset:8224
    ds_read_b64_tr_b16 v[182:183], v48 offset:8736
    s_waitcnt lgkmcnt(0)
    v_xor_b32 v48, 128, v47
    v_add_u32 v48, 16384, v48
    ds_read_b64_tr_b16 v[192:193], v48 offset:0
    ds_read_b64_tr_b16 v[194:195], v48 offset:512
    ds_read_b64_tr_b16 v[196:197], v48 offset:8192
    ds_read_b64_tr_b16 v[198:199], v48 offset:8704
    ds_read_b64_tr_b16 v[208:209], v48 offset:32
    ds_read_b64_tr_b16 v[210:211], v48 offset:544
    ds_read_b64_tr_b16 v[212:213], v48 offset:8224
    ds_read_b64_tr_b16 v[214:215], v48 offset:8736
    s_waitcnt lgkmcnt(0)
    v_xor_b32 v48, 192, v47
    v_add_u32 v48, 16384, v48
    ds_read_b64_tr_b16 v[224:225], v48 offset:0
    ds_read_b64_tr_b16 v[226:227], v48 offset:512
    ds_read_b64_tr_b16 v[228:229], v48 offset:8192
    ds_read_b64_tr_b16 v[230:231], v48 offset:8704
    ds_read_b64_tr_b16 v[240:241], v48 offset:32
    ds_read_b64_tr_b16 v[242:243], v48 offset:544
    ds_read_b64_tr_b16 v[244:245], v48 offset:8224
    ds_read_b64_tr_b16 v[246:247], v48 offset:8736
    s_waitcnt lgkmcnt(0)
mega_kernel_rs_wo1:
    s_barrier
    s_add_u32 m0, s48, 16384
    s_mov_b32 s22, 524288
    buffer_load_dwordx4 v44, s[8:11], s22 offen  lds
    s_add_u32 m0, s48, 20480
    s_mov_b32 s22, 557056
    buffer_load_dwordx4 v44, s[8:11], s22 offen  lds
    s_add_u32 m0, s48, 24576
    s_mov_b32 s22, 589824
    buffer_load_dwordx4 v44, s[8:11], s22 offen  lds
    s_add_u32 m0, s48, 28672
    s_mov_b32 s22, 622592
    buffer_load_dwordx4 v44, s[8:11], s22 offen  lds
    s_waitcnt vmcnt(28)
    s_barrier
    s_cmp_lg_u32 s20, 2
    s_cbranch_scc1 mega_kernel_rs_wo2
    v_xor_b32 v48, 0, v47
    v_add_u32 v48, 32768, v48
    ds_read_b64_tr_b16 v[128:129], v48 offset:0
    ds_read_b64_tr_b16 v[130:131], v48 offset:512
    ds_read_b64_tr_b16 v[132:133], v48 offset:8192
    ds_read_b64_tr_b16 v[134:135], v48 offset:8704
    ds_read_b64_tr_b16 v[144:145], v48 offset:32
    ds_read_b64_tr_b16 v[146:147], v48 offset:544
    ds_read_b64_tr_b16 v[148:149], v48 offset:8224
    ds_read_b64_tr_b16 v[150:151], v48 offset:8736
    s_waitcnt lgkmcnt(0)
    v_xor_b32 v48, 64, v47
    v_add_u32 v48, 32768, v48
    ds_read_b64_tr_b16 v[160:161], v48 offset:0
    ds_read_b64_tr_b16 v[162:163], v48 offset:512
    ds_read_b64_tr_b16 v[164:165], v48 offset:8192
    ds_read_b64_tr_b16 v[166:167], v48 offset:8704
    ds_read_b64_tr_b16 v[176:177], v48 offset:32
    ds_read_b64_tr_b16 v[178:179], v48 offset:544
    ds_read_b64_tr_b16 v[180:181], v48 offset:8224
    ds_read_b64_tr_b16 v[182:183], v48 offset:8736
    s_waitcnt lgkmcnt(0)
    v_xor_b32 v48, 128, v47
    v_add_u32 v48, 32768, v48
    ds_read_b64_tr_b16 v[192:193], v48 offset:0
    ds_read_b64_tr_b16 v[194:195], v48 offset:512
    ds_read_b64_tr_b16 v[196:197], v48 offset:8192
    ds_read_b64_tr_b16 v[198:199], v48 offset:8704
    ds_read_b64_tr_b16 v[208:209], v48 offset:32
    ds_read_b64_tr_b16 v[210:211], v48 offset:544
    ds_read_b64_tr_b16 v[212:213], v48 offset:8224
    ds_read_b64_tr_b16 v[214:215], v48 offset:8736
    s_waitcnt lgkmcnt(0)
    v_xor_b32 v48, 192, v47
    v_add_u32 v48, 32768, v48
    ds_read_b64_tr_b16 v[224:225], v48 offset:0
    ds_read_b64_tr_b16 v[226:227], v48 offset:512
    ds_read_b64_tr_b16 v[228:229], v48 offset:8192
    ds_read_b64_tr_b16 v[230:231], v48 offset:8704
    ds_read_b64_tr_b16 v[240:241], v48 offset:32
    ds_read_b64_tr_b16 v[242:243], v48 offset:544
    ds_read_b64_tr_b16 v[244:245], v48 offset:8224
    ds_read_b64_tr_b16 v[246:247], v48 offset:8736
    s_waitcnt lgkmcnt(0)
mega_kernel_rs_wo2:
    s_barrier
    s_add_u32 m0, s48, 32768
    s_mov_b32 s22, 1048576
    buffer_load_dwordx4 v44, s[8:11], s22 offen  lds
    s_add_u32 m0, s48, 36864
    s_mov_b32 s22, 1081344
    buffer_load_dwordx4 v44, s[8:11], s22 offen  lds
    s_add_u32 m0, s48, 40960
    s_mov_b32 s22, 1114112
    buffer_load_dwordx4 v44, s[8:11], s22 offen  lds
    s_add_u32 m0, s48, 45056
    s_mov_b32 s22, 1146880
    buffer_load_dwordx4 v44, s[8:11], s22 offen  lds
    s_waitcnt vmcnt(28)
    s_barrier
    s_cmp_lg_u32 s20, 3
    s_cbranch_scc1 mega_kernel_rs_wo3
    v_xor_b32 v48, 0, v47
    v_add_u32 v48, 49152, v48
    ds_read_b64_tr_b16 v[128:129], v48 offset:0
    ds_read_b64_tr_b16 v[130:131], v48 offset:512
    ds_read_b64_tr_b16 v[132:133], v48 offset:8192
    ds_read_b64_tr_b16 v[134:135], v48 offset:8704
    ds_read_b64_tr_b16 v[144:145], v48 offset:32
    ds_read_b64_tr_b16 v[146:147], v48 offset:544
    ds_read_b64_tr_b16 v[148:149], v48 offset:8224
    ds_read_b64_tr_b16 v[150:151], v48 offset:8736
    s_waitcnt lgkmcnt(0)
    v_xor_b32 v48, 64, v47
    v_add_u32 v48, 49152, v48
    ds_read_b64_tr_b16 v[160:161], v48 offset:0
    ds_read_b64_tr_b16 v[162:163], v48 offset:512
    ds_read_b64_tr_b16 v[164:165], v48 offset:8192
    ds_read_b64_tr_b16 v[166:167], v48 offset:8704
    ds_read_b64_tr_b16 v[176:177], v48 offset:32
    ds_read_b64_tr_b16 v[178:179], v48 offset:544
    ds_read_b64_tr_b16 v[180:181], v48 offset:8224
    ds_read_b64_tr_b16 v[182:183], v48 offset:8736
    s_waitcnt lgkmcnt(0)
    v_xor_b32 v48, 128, v47
    v_add_u32 v48, 49152, v48
    ds_read_b64_tr_b16 v[192:193], v48 offset:0
    ds_read_b64_tr_b16 v[194:195], v48 offset:512
    ds_read_b64_tr_b16 v[196:197], v48 offset:8192
    ds_read_b64_tr_b16 v[198:199], v48 offset:8704
    ds_read_b64_tr_b16 v[208:209], v48 offset:32
    ds_read_b64_tr_b16 v[210:211], v48 offset:544
    ds_read_b64_tr_b16 v[212:213], v48 offset:8224
    ds_read_b64_tr_b16 v[214:215], v48 offset:8736
    s_waitcnt lgkmcnt(0)
    v_xor_b32 v48, 192, v47
    v_add_u32 v48, 49152, v48
    ds_read_b64_tr_b16 v[224:225], v48 offset:0
    ds_read_b64_tr_b16 v[226:227], v48 offset:512
    ds_read_b64_tr_b16 v[228:229], v48 offset:8192
    ds_read_b64_tr_b16 v[230:231], v48 offset:8704
    ds_read_b64_tr_b16 v[240:241], v48 offset:32
    ds_read_b64_tr_b16 v[242:243], v48 offset:544
    ds_read_b64_tr_b16 v[244:245], v48 offset:8224
    ds_read_b64_tr_b16 v[246:247], v48 offset:8736
    s_waitcnt lgkmcnt(0)
mega_kernel_rs_wo3:
    s_barrier
    s_add_u32 m0, s48, 49152
    s_mov_b32 s22, 1572864
    buffer_load_dwordx4 v44, s[8:11], s22 offen  lds
    s_add_u32 m0, s48, 53248
    s_mov_b32 s22, 1605632
    buffer_load_dwordx4 v44, s[8:11], s22 offen  lds
    s_add_u32 m0, s48, 57344
    s_mov_b32 s22, 1638400
    buffer_load_dwordx4 v44, s[8:11], s22 offen  lds
    s_add_u32 m0, s48, 61440
    s_mov_b32 s22, 1671168
    buffer_load_dwordx4 v44, s[8:11], s22 offen  lds
    s_waitcnt vmcnt(28)
    s_barrier
    s_cmp_lg_u32 s20, 0
    s_cbranch_scc1 mega_kernel_rs_wo4
    v_xor_b32 v48, 0, v47
    v_add_u32 v48, 65536, v48
    ds_read_b64_tr_b16 v[136:137], v48 offset:0
    ds_read_b64_tr_b16 v[138:139], v48 offset:512
    ds_read_b64_tr_b16 v[140:141], v48 offset:8192
    ds_read_b64_tr_b16 v[142:143], v48 offset:8704
    ds_read_b64_tr_b16 v[152:153], v48 offset:32
    ds_read_b64_tr_b16 v[154:155], v48 offset:544
    ds_read_b64_tr_b16 v[156:157], v48 offset:8224
    ds_read_b64_tr_b16 v[158:159], v48 offset:8736
    s_waitcnt lgkmcnt(0)
    v_xor_b32 v48, 64, v47
    v_add_u32 v48, 65536, v48
    ds_read_b64_tr_b16 v[168:169], v48 offset:0
    ds_read_b64_tr_b16 v[170:171], v48 offset:512
    ds_read_b64_tr_b16 v[172:173], v48 offset:8192
    ds_read_b64_tr_b16 v[174:175], v48 offset:8704
    ds_read_b64_tr_b16 v[184:185], v48 offset:32
    ds_read_b64_tr_b16 v[186:187], v48 offset:544
    ds_read_b64_tr_b16 v[188:189], v48 offset:8224
    ds_read_b64_tr_b16 v[190:191], v48 offset:8736
    s_waitcnt lgkmcnt(0)
    v_xor_b32 v48, 128, v47
    v_add_u32 v48, 65536, v48
    ds_read_b64_tr_b16 v[200:201], v48 offset:0
    ds_read_b64_tr_b16 v[202:203], v48 offset:512
    ds_read_b64_tr_b16 v[204:205], v48 offset:8192
    ds_read_b64_tr_b16 v[206:207], v48 offset:8704
    ds_read_b64_tr_b16 v[216:217], v48 offset:32
    ds_read_b64_tr_b16 v[218:219], v48 offset:544
    ds_read_b64_tr_b16 v[220:221], v48 offset:8224
    ds_read_b64_tr_b16 v[222:223], v48 offset:8736
    s_waitcnt lgkmcnt(0)
    v_xor_b32 v48, 192, v47
    v_add_u32 v48, 65536, v48
    ds_read_b64_tr_b16 v[232:233], v48 offset:0
    ds_read_b64_tr_b16 v[234:235], v48 offset:512
    ds_read_b64_tr_b16 v[236:237], v48 offset:8192
    ds_read_b64_tr_b16 v[238:239], v48 offset:8704
    ds_read_b64_tr_b16 v[248:249], v48 offset:32
    ds_read_b64_tr_b16 v[250:251], v48 offset:544
    ds_read_b64_tr_b16 v[252:253], v48 offset:8224
    ds_read_b64_tr_b16 v[254:255], v48 offset:8736
    s_waitcnt lgkmcnt(0)
mega_kernel_rs_wo4:
    s_barrier
    s_add_u32 m0, s48, 65536
    s_mov_b32 s22, 2097152
    buffer_load_dwordx4 v44, s[8:11], s22 offen  lds
    s_add_u32 m0, s48, 69632
    s_mov_b32 s22, 2129920
    buffer_load_dwordx4 v44, s[8:11], s22 offen  lds
    s_add_u32 m0, s48, 73728
    s_mov_b32 s22, 2162688
    buffer_load_dwordx4 v44, s[8:11], s22 offen  lds
    s_add_u32 m0, s48, 77824
    s_mov_b32 s22, 2195456
    buffer_load_dwordx4 v44, s[8:11], s22 offen  lds
    s_waitcnt vmcnt(28)
    s_barrier
    s_cmp_lg_u32 s20, 1
    s_cbranch_scc1 mega_kernel_rs_wo5
    v_xor_b32 v48, 0, v47
    v_add_u32 v48, 81920, v48
    ds_read_b64_tr_b16 v[136:137], v48 offset:0
    ds_read_b64_tr_b16 v[138:139], v48 offset:512
    ds_read_b64_tr_b16 v[140:141], v48 offset:8192
    ds_read_b64_tr_b16 v[142:143], v48 offset:8704
    ds_read_b64_tr_b16 v[152:153], v48 offset:32
    ds_read_b64_tr_b16 v[154:155], v48 offset:544
    ds_read_b64_tr_b16 v[156:157], v48 offset:8224
    ds_read_b64_tr_b16 v[158:159], v48 offset:8736
    s_waitcnt lgkmcnt(0)
    v_xor_b32 v48, 64, v47
    v_add_u32 v48, 81920, v48
    ds_read_b64_tr_b16 v[168:169], v48 offset:0
    ds_read_b64_tr_b16 v[170:171], v48 offset:512
    ds_read_b64_tr_b16 v[172:173], v48 offset:8192
    ds_read_b64_tr_b16 v[174:175], v48 offset:8704
    ds_read_b64_tr_b16 v[184:185], v48 offset:32
    ds_read_b64_tr_b16 v[186:187], v48 offset:544
    ds_read_b64_tr_b16 v[188:189], v48 offset:8224
    ds_read_b64_tr_b16 v[190:191], v48 offset:8736
    s_waitcnt lgkmcnt(0)
    v_xor_b32 v48, 128, v47
    v_add_u32 v48, 81920, v48
    ds_read_b64_tr_b16 v[200:201], v48 offset:0
    ds_read_b64_tr_b16 v[202:203], v48 offset:512
    ds_read_b64_tr_b16 v[204:205], v48 offset:8192
    ds_read_b64_tr_b16 v[206:207], v48 offset:8704
    ds_read_b64_tr_b16 v[216:217], v48 offset:32
    ds_read_b64_tr_b16 v[218:219], v48 offset:544
    ds_read_b64_tr_b16 v[220:221], v48 offset:8224
    ds_read_b64_tr_b16 v[222:223], v48 offset:8736
    s_waitcnt lgkmcnt(0)
    v_xor_b32 v48, 192, v47
    v_add_u32 v48, 81920, v48
    ds_read_b64_tr_b16 v[232:233], v48 offset:0
    ds_read_b64_tr_b16 v[234:235], v48 offset:512
    ds_read_b64_tr_b16 v[236:237], v48 offset:8192
    ds_read_b64_tr_b16 v[238:239], v48 offset:8704
    ds_read_b64_tr_b16 v[248:249], v48 offset:32
    ds_read_b64_tr_b16 v[250:251], v48 offset:544
    ds_read_b64_tr_b16 v[252:253], v48 offset:8224
    ds_read_b64_tr_b16 v[254:255], v48 offset:8736
    s_waitcnt lgkmcnt(0)
mega_kernel_rs_wo5:
    s_barrier
    s_add_u32 m0, s48, 81920
    s_mov_b32 s22, 2621440
    buffer_load_dwordx4 v44, s[8:11], s22 offen  lds
    s_add_u32 m0, s48, 86016
    s_mov_b32 s22, 2654208
    buffer_load_dwordx4 v44, s[8:11], s22 offen  lds
    s_add_u32 m0, s48, 90112
    s_mov_b32 s22, 2686976
    buffer_load_dwordx4 v44, s[8:11], s22 offen  lds
    s_add_u32 m0, s48, 94208
    s_mov_b32 s22, 2719744
    buffer_load_dwordx4 v44, s[8:11], s22 offen  lds
    s_waitcnt vmcnt(28)
    s_barrier
    s_cmp_lg_u32 s20, 2
    s_cbranch_scc1 mega_kernel_rs_wo6
    v_xor_b32 v48, 0, v47
    v_add_u32 v48, 98304, v48
    ds_read_b64_tr_b16 v[136:137], v48 offset:0
    ds_read_b64_tr_b16 v[138:139], v48 offset:512
    ds_read_b64_tr_b16 v[140:141], v48 offset:8192
    ds_read_b64_tr_b16 v[142:143], v48 offset:8704
    ds_read_b64_tr_b16 v[152:153], v48 offset:32
    ds_read_b64_tr_b16 v[154:155], v48 offset:544
    ds_read_b64_tr_b16 v[156:157], v48 offset:8224
    ds_read_b64_tr_b16 v[158:159], v48 offset:8736
    s_waitcnt lgkmcnt(0)
    v_xor_b32 v48, 64, v47
    v_add_u32 v48, 98304, v48
    ds_read_b64_tr_b16 v[168:169], v48 offset:0
    ds_read_b64_tr_b16 v[170:171], v48 offset:512
    ds_read_b64_tr_b16 v[172:173], v48 offset:8192
    ds_read_b64_tr_b16 v[174:175], v48 offset:8704
    ds_read_b64_tr_b16 v[184:185], v48 offset:32
    ds_read_b64_tr_b16 v[186:187], v48 offset:544
    ds_read_b64_tr_b16 v[188:189], v48 offset:8224
    ds_read_b64_tr_b16 v[190:191], v48 offset:8736
    s_waitcnt lgkmcnt(0)
    v_xor_b32 v48, 128, v47
    v_add_u32 v48, 98304, v48
    ds_read_b64_tr_b16 v[200:201], v48 offset:0
    ds_read_b64_tr_b16 v[202:203], v48 offset:512
    ds_read_b64_tr_b16 v[204:205], v48 offset:8192
    ds_read_b64_tr_b16 v[206:207], v48 offset:8704
    ds_read_b64_tr_b16 v[216:217], v48 offset:32
    ds_read_b64_tr_b16 v[218:219], v48 offset:544
    ds_read_b64_tr_b16 v[220:221], v48 offset:8224
    ds_read_b64_tr_b16 v[222:223], v48 offset:8736
    s_waitcnt lgkmcnt(0)
    v_xor_b32 v48, 192, v47
    v_add_u32 v48, 98304, v48
    ds_read_b64_tr_b16 v[232:233], v48 offset:0
    ds_read_b64_tr_b16 v[234:235], v48 offset:512
    ds_read_b64_tr_b16 v[236:237], v48 offset:8192
    ds_read_b64_tr_b16 v[238:239], v48 offset:8704
    ds_read_b64_tr_b16 v[248:249], v48 offset:32
    ds_read_b64_tr_b16 v[250:251], v48 offset:544
    ds_read_b64_tr_b16 v[252:253], v48 offset:8224
    ds_read_b64_tr_b16 v[254:255], v48 offset:8736
    s_waitcnt lgkmcnt(0)
mega_kernel_rs_wo6:
    s_barrier
    s_add_u32 m0, s48, 98304
    s_mov_b32 s22, 3145728
    buffer_load_dwordx4 v44, s[8:11], s22 offen  lds
    s_add_u32 m0, s48, 102400
    s_mov_b32 s22, 3178496
    buffer_load_dwordx4 v44, s[8:11], s22 offen  lds
    s_add_u32 m0, s48, 106496
    s_mov_b32 s22, 3211264
    buffer_load_dwordx4 v44, s[8:11], s22 offen  lds
    s_add_u32 m0, s48, 110592
    s_mov_b32 s22, 3244032
    buffer_load_dwordx4 v44, s[8:11], s22 offen  lds
    s_waitcnt vmcnt(28)
    s_barrier
    s_cmp_lg_u32 s20, 3
    s_cbranch_scc1 mega_kernel_rs_wo7
    v_xor_b32 v48, 0, v47
    v_add_u32 v48, 114688, v48
    ds_read_b64_tr_b16 v[136:137], v48 offset:0
    ds_read_b64_tr_b16 v[138:139], v48 offset:512
    ds_read_b64_tr_b16 v[140:141], v48 offset:8192
    ds_read_b64_tr_b16 v[142:143], v48 offset:8704
    ds_read_b64_tr_b16 v[152:153], v48 offset:32
    ds_read_b64_tr_b16 v[154:155], v48 offset:544
    ds_read_b64_tr_b16 v[156:157], v48 offset:8224
    ds_read_b64_tr_b16 v[158:159], v48 offset:8736
    s_waitcnt lgkmcnt(0)
    v_xor_b32 v48, 64, v47
    v_add_u32 v48, 114688, v48
    ds_read_b64_tr_b16 v[168:169], v48 offset:0
    ds_read_b64_tr_b16 v[170:171], v48 offset:512
    ds_read_b64_tr_b16 v[172:173], v48 offset:8192
    ds_read_b64_tr_b16 v[174:175], v48 offset:8704
    ds_read_b64_tr_b16 v[184:185], v48 offset:32
    ds_read_b64_tr_b16 v[186:187], v48 offset:544
    ds_read_b64_tr_b16 v[188:189], v48 offset:8224
    ds_read_b64_tr_b16 v[190:191], v48 offset:8736
    s_waitcnt lgkmcnt(0)
    v_xor_b32 v48, 128, v47
    v_add_u32 v48, 114688, v48
    ds_read_b64_tr_b16 v[200:201], v48 offset:0
    ds_read_b64_tr_b16 v[202:203], v48 offset:512
    ds_read_b64_tr_b16 v[204:205], v48 offset:8192
    ds_read_b64_tr_b16 v[206:207], v48 offset:8704
    ds_read_b64_tr_b16 v[216:217], v48 offset:32
    ds_read_b64_tr_b16 v[218:219], v48 offset:544
    ds_read_b64_tr_b16 v[220:221], v48 offset:8224
    ds_read_b64_tr_b16 v[222:223], v48 offset:8736
    s_waitcnt lgkmcnt(0)
    v_xor_b32 v48, 192, v47
    v_add_u32 v48, 114688, v48
    ds_read_b64_tr_b16 v[232:233], v48 offset:0
    ds_read_b64_tr_b16 v[234:235], v48 offset:512
    ds_read_b64_tr_b16 v[236:237], v48 offset:8192
    ds_read_b64_tr_b16 v[238:239], v48 offset:8704
    ds_read_b64_tr_b16 v[248:249], v48 offset:32
    ds_read_b64_tr_b16 v[250:251], v48 offset:544
    ds_read_b64_tr_b16 v[252:253], v48 offset:8224
    ds_read_b64_tr_b16 v[254:255], v48 offset:8736
    s_waitcnt lgkmcnt(0)
mega_kernel_rs_wo7:
    s_barrier
    s_add_u32 m0, s48, 114688
    s_mov_b32 s22, 3670016
    buffer_load_dwordx4 v44, s[8:11], s22 offen  lds
    s_add_u32 m0, s48, 118784
    s_mov_b32 s22, 3702784
    buffer_load_dwordx4 v44, s[8:11], s22 offen  lds
    s_add_u32 m0, s48, 122880
    s_mov_b32 s22, 3735552
    buffer_load_dwordx4 v44, s[8:11], s22 offen  lds
    s_add_u32 m0, s48, 126976
    s_mov_b32 s22, 3768320
    buffer_load_dwordx4 v44, s[8:11], s22 offen  lds
    s_waitcnt vmcnt(28)
    s_barrier
    v_add_u32 v48, 0, v46
    ds_read_b64_tr_b16 v[64:65], v48 offset:0
    ds_read_b64_tr_b16 v[66:67], v48 offset:512
    ds_read_b64_tr_b16 v[68:69], v48 offset:8192
    ds_read_b64_tr_b16 v[70:71], v48 offset:8704
    ds_read_b64_tr_b16 v[72:73], v48 offset:8
    ds_read_b64_tr_b16 v[74:75], v48 offset:520
    ds_read_b64_tr_b16 v[76:77], v48 offset:8200
    ds_read_b64_tr_b16 v[78:79], v48 offset:8712
    s_waitcnt lgkmcnt(0)
    s_barrier
    ds_write_b128 v32, v[64:67] offset:0
    ds_write_b128 v32, v[68:71] offset:1024
    ds_write_b128 v32, v[72:75] offset:2048
    ds_write_b128 v32, v[76:79] offset:3072
    s_waitcnt lgkmcnt(0)
    s_waitcnt vmcnt(24)
    s_barrier
    v_add_u32 v48, 16384, v46
    ds_read_b64_tr_b16 v[64:65], v48 offset:0
    ds_read_b64_tr_b16 v[66:67], v48 offset:512
    ds_read_b64_tr_b16 v[68:69], v48 offset:8192
    ds_read_b64_tr_b16 v[70:71], v48 offset:8704
    ds_read_b64_tr_b16 v[72:73], v48 offset:8
    ds_read_b64_tr_b16 v[74:75], v48 offset:520
    ds_read_b64_tr_b16 v[76:77], v48 offset:8200
    ds_read_b64_tr_b16 v[78:79], v48 offset:8712
    s_waitcnt lgkmcnt(0)
    s_barrier
    ds_write_b128 v32, v[64:67] offset:16384
    ds_write_b128 v32, v[68:71] offset:17408
    ds_write_b128 v32, v[72:75] offset:18432
    ds_write_b128 v32, v[76:79] offset:19456
    s_waitcnt lgkmcnt(0)
    s_waitcnt vmcnt(20)
    s_barrier
    s_getpc_b64 s[16:17]
mega_kernel_rs_pc0:
    s_add_u32 s16, s16, mega_kernel_rs_w0_entry - mega_kernel_rs_pc0
    s_addc_u32 s17, s17, 0
    v_lshlrev_b32 v49, 7, v0
    v_min_u32 v49, mega_kernel_rs_end - mega_kernel_rs_w0_entry, v49
    global_load_dword v50, v49, s[16:17]
    v_lshlrev_b32 v49, 7, v40
    s_xor_b32 s23, s35, 16384
    s_cmp_eq_u32 s20, 1
    s_cselect_b32 s22, s35, s47
    s_cmp_eq_u32 s20, 2
    s_cselect_b32 s22, s23, s22
    s_lshl_b32 s23, s31, 13
    s_add_u32 s23, s23, 178257920
    s_cmp_eq_u32 s20, 3
    s_cselect_b32 s22, s23, s22
    buffer_load_dword v51, v49, s[4:7], s22 offen sc1
    v_lshlrev_b32 v49, 13, v0
    v_and_b32 v49, 0x1fffff, v49
    s_mov_b32 s22, 67108864
    buffer_load_dword v52, v49, s[4:7], s22 offen sc1
    buffer_load_dword v57, v7, s[4:7], 0 offen sc1
    v_add_u32 v48, 32768, v46
    ds_read_b64_tr_b16 v[64:65], v48 offset:0
    ds_read_b64_tr_b16 v[66:67], v48 offset:512
    ds_read_b64_tr_b16 v[68:69], v48 offset:8192
    ds_read_b64_tr_b16 v[70:71], v48 offset:8704
    ds_read_b64_tr_b16 v[72:73], v48 offset:8
    ds_read_b64_tr_b16 v[74:75], v48 offset:520
    ds_read_b64_tr_b16 v[76:77], v48 offset:8200
    ds_read_b64_tr_b16 v[78:79], v48 offset:8712
    s_waitcnt lgkmcnt(0)
    s_barrier
    ds_write_b128 v32, v[64:67] offset:32768
    ds_write_b128 v32, v[68:71] offset:33792
    ds_write_b128 v32, v[72:75] offset:34816
    ds_write_b128 v32, v[76:79] offset:35840
    s_waitcnt lgkmcnt(0)
    s_waitcnt vmcnt(16)
    s_barrier
    v_add_u32 v48, 49152, v46
    ds_read_b64_tr_b16 v[64:65], v48 offset:0
    ds_read_b64_tr_b16 v[66:67], v48 offset:512
    ds_read_b64_tr_b16 v[68:69], v48 offset:8192
    ds_read_b64_tr_b16 v[70:71], v48 offset:8704
    ds_read_b64_tr_b16 v[72:73], v48 offset:8
    ds_read_b64_tr_b16 v[74:75], v48 offset:520
    ds_read_b64_tr_b16 v[76:77], v48 offset:8200
    ds_read_b64_tr_b16 v[78:79], v48 offset:8712
    s_waitcnt lgkmcnt(0)
    s_barrier
    ds_write_b128 v32, v[64:67] offset:49152
    ds_write_b128 v32, v[68:71] offset:50176
    ds_write_b128 v32, v[72:75] offset:51200
    ds_write_b128 v32, v[76:79] offset:52224
    s_waitcnt lgkmcnt(0)
    s_waitcnt vmcnt(12)
    s_barrier
    v_add_u32 v48, 65536, v46
    ds_read_b64_tr_b16 v[64:65], v48 offset:0
    ds_read_b64_tr_b16 v[66:67], v48 offset:512
    ds_read_b64_tr_b16 v[68:69], v48 offset:8192
    ds_read_b64_tr_b16 v[70:71], v48 offset:8704
    ds_read_b64_tr_b16 v[72:73], v48 offset:8
    ds_read_b64_tr_b16 v[74:75], v48 offset:520
    ds_read_b64_tr_b16 v[76:77], v48 offset:8200
    ds_read_b64_tr_b16 v[78:79], v48 offset:8712
    s_waitcnt lgkmcnt(0)
    s_barrier
    ds_write_b128 v33, v[64:67] offset:0
    ds_write_b128 v33, v[68:71] offset:1024
    ds_write_b128 v33, v[72:75] offset:2048
    ds_write_b128 v33, v[76:79] offset:3072
    s_waitcnt lgkmcnt(0)
    s_waitcnt vmcnt(8)
    s_barrier
    v_add_u32 v48, 81920, v46
    ds_read_b64_tr_b16 v[64:65], v48 offset:0
    ds_read_b64_tr_b16 v[66:67], v48 offset:512
    ds_read_b64_tr_b16 v[68:69], v48 offset:8192
    ds_read_b64_tr_b16 v[70:71], v48 offset:8704
    ds_read_b64_tr_b16 v[72:73], v48 offset:8
    ds_read_b64_tr_b16 v[74:75], v48 offset:520
    ds_read_b64_tr_b16 v[76:77], v48 offset:8200
    ds_read_b64_tr_b16 v[78:79], v48 offset:8712
    s_waitcnt lgkmcnt(0)
    s_barrier
    ds_write_b128 v33, v[64:67] offset:16384
    ds_write_b128 v33, v[68:71] offset:17408
    ds_write_b128 v33, v[72:75] offset:18432
    ds_write_b128 v33, v[76:79] offset:19456
    s_waitcnt lgkmcnt(0)
    s_waitcnt vmcnt(4)
    s_barrier
    v_add_u32 v48, 98304, v46
    ds_read_b64_tr_b16 v[64:65], v48 offset:0
    ds_read_b64_tr_b16 v[66:67], v48 offset:512
    ds_read_b64_tr_b16 v[68:69], v48 offset:8192
    ds_read_b64_tr_b16 v[70:71], v48 offset:8704
    ds_read_b64_tr_b16 v[72:73], v48 offset:8
    ds_read_b64_tr_b16 v[74:75], v48 offset:520
    ds_read_b64_tr_b16 v[76:77], v48 offset:8200
    ds_read_b64_tr_b16 v[78:79], v48 offset:8712
    s_waitcnt lgkmcnt(0)
    s_barrier
    ds_write_b128 v33, v[64:67] offset:32768
    ds_write_b128 v33, v[68:71] offset:33792
    ds_write_b128 v33, v[72:75] offset:34816
    ds_write_b128 v33, v[76:79] offset:35840
    s_waitcnt lgkmcnt(0)
    s_waitcnt vmcnt(0)
    s_barrier
    v_add_u32 v48, 114688, v46
    ds_read_b64_tr_b16 v[64:65], v48 offset:0
    ds_read_b64_tr_b16 v[66:67], v48 offset:512
    ds_read_b64_tr_b16 v[68:69], v48 offset:8192
    ds_read_b64_tr_b16 v[70:71], v48 offset:8704
    ds_read_b64_tr_b16 v[72:73], v48 offset:8
    ds_read_b64_tr_b16 v[74:75], v48 offset:520
    ds_read_b64_tr_b16 v[76:77], v48 offset:8200
    ds_read_b64_tr_b16 v[78:79], v48 offset:8712
    s_waitcnt lgkmcnt(0)
    s_barrier
    ds_write_b128 v33, v[64:67] offset:49152
    ds_write_b128 v33, v[68:71] offset:50176
    ds_write_b128 v33, v[72:75] offset:51200
    ds_write_b128 v33, v[76:79] offset:52224
    s_waitcnt lgkmcnt(0)
mega_kernel_rs_iw:
    buffer_load_dword v58, off, s[12:15], 0 offset:204 sc1
    s_waitcnt vmcnt(0)
mega_kernel_rs_iw1:
    v_and_b32 v50, 0xffff, v58
    v_readfirstlane_b32 s60, v58
    v_cmp_ne_u32 vcc, s100, v50
    s_cbranch_vccnz mega_kernel_rs_iw
    s_lshr_b32 s60, s60, 15
    s_cmp_gt_u32 s60, s100
    s_cselect_b32 s60, 8192, 0
    s_bfe_u32 s22, s31, 0x10001
    s_lshl_b32 s22, s22, 12
    s_add_u32 s22, s22, s60
    s_lshl_b32 s23, s20, 10
    s_add_u32 s22, s22, s23
    s_add_u32 s38, s38, s22
    s_add_u32 s37, s37, s22
    s_xor_b32 s40, s38, 4096
    s_xor_b32 s39, s37, 4096
    s_xor_b32 s36, s35, 16384
    s_mov_b32 s21, 0
    s_cmp_eq_u32 s30, 0
    s_mov_b32 s22, 0x33003300
    s_cselect_b32 s16, 0x00330033, s22
    s_mov_b32 s17, s16
    s_cselect_b32 s18, -1, 0
    s_not_b32 s19, s18
    s_lshl_b32 s22, s31, 13
    s_lshl_b32 s23, s20, 11
    s_add_u32 s22, s22, s23
    s_add_u32 s43, s22, 16777216
    s_add_u32 s44, s22, 33554432
    s_lshl_b32 s45, s31, 13
    s_add_u32 s45, s45, 178257920
    s_mul_i32 s48, s20, 5120
    s_add_u32 m0, s48, 140288
    s_mov_b32 s41, 1
    s_mov_b32 s42, 1
    v_mov_b32 v0, v34
    v_bfrev_b32 v12, 1
    v_bfrev_b32 v3, 1
    v_cndmask_b32 v10, v3, v10, s[16:17]
    v_cndmask_b32 v9, v3, v9, s[26:27]
    s_sub_u32 s45, s45, 0
    s_lshl_b32 s51, s30, 11
    s_add_u32 s51, s51, s45
    s_mov_b32 s50, 0
    s_cmp_lg_u32 s20, 3
    s_cbranch_scc1 mega_kernel_rs_kv0
    v_readlane_b32 s50, v57, 0
    v_readlane_b32 s22, v57, 2
    v_readlane_b32 s23, v57, 1
    v_readlane_b32 s24, v57, 3
    s_nop 3
    s_min_u32 s50, s50, s22
    s_min_u32 s23, s23, s24
    s_lshl_b32 s50, s50, 1
    s_lshl_b32 s23, s23, 1
    s_add_u32 s23, s23, 1
    s_min_u32 s50, s50, s23
mega_kernel_rs_kvb0:
    s_add_u32 s22, s21, 1
    s_min_u32 s22, s22, 63
    s_cmp_gt_u32 s50, s22
    s_cbranch_scc1 mega_kernel_rs_kvd0
    buffer_load_dword v48, v7, s[4:7], 0 offen sc1
    s_waitcnt vmcnt(0)
    v_readlane_b32 s50, v48, 0
    v_readlane_b32 s22, v48, 2
    v_readlane_b32 s23, v48, 1
    v_readlane_b32 s24, v48, 3
    s_nop 3
    s_min_u32 s50, s50, s22
    s_min_u32 s23, s23, s24
    s_lshl_b32 s50, s50, 1
    s_lshl_b32 s23, s23, 1
    s_add_u32 s23, s23, 1
    s_min_u32 s50, s50, s23
    s_branch mega_kernel_rs_kvb0
mega_kernel_rs_kvd0:
mega_kernel_rs_kv0:
    s_barrier
    s_cmp_eq_u32 s20, 1
    s_cbranch_scc1 mega_kernel_rs_w1_entry
    s_cmp_eq_u32 s20, 2
    s_cbranch_scc1 mega_kernel_rs_w2_entry
    s_cmp_eq_u32 s20, 3
    s_cbranch_scc1 mega_kernel_rs_w3_entry
mega_kernel_rs_w0_entry:
    v_mfma_f32_32x32x8_bf16 v[96:111], v[14:15], v[14:15], 0
    v_mfma_f32_16x16x16_bf16 v[112:115], v[14:15], v[14:15], 0
    v_mfma_f32_16x16x16_bf16 v[116:119], v[14:15], v[14:15], 0
    ds_read_b128 v[64:67], v1 offset:0
    ds_read_b128 v[68:71], v1 offset:1024
    ds_read_b128 v[72:75], v1 offset:2048
    ds_read_b128 v[76:79], v1 offset:3072
    ds_read_b128 v[80:83], v1 offset:16384
    ds_read_b128 v[84:87], v1 offset:17408
    ds_read_b128 v[88:91], v1 offset:18432
    ds_read_b128 v[92:95], v1 offset:19456
    buffer_load_dwordx4 v[120:123], v1, s[4:7], s44 offen
    buffer_load_dwordx4 v[124:127], v1, s[4:7], s44 offen offset:1024
    s_add_u32 s44, s44, 262144
mega_kernel_rs_w0_loop:
    s_add_u32 s22, s35, 0
    s_waitcnt vmcnt(0)
    buffer_load_dwordx4 v[32:35], v1, s[4:7], s22 offen sc1
    buffer_load_dwordx4 v[36:39], v1, s[4:7], s22 offen offset:1024 sc1
mega_kernel_rs_w0_pa:
    s_waitcnt vmcnt(1)
    ds_write_b128 v6, v[32:35] offset:0
    s_waitcnt vmcnt(0)
    ds_write_b128 v6, v[36:39] offset:1024
    v_max3_u32 v3, v32, v34, v36
    v_max_u32 v3, v3, v38
    v_cmp_eq_u32 vcc, -1, v3
    v_smfmac_f32_16x16x64_bf16 v[96:99], v[32:35], a[0:7], v2
    buffer_load_dwordx4 v[32:35], v1, s[4:7], s22 offen sc1
    v_smfmac_f32_16x16x64_bf16 v[100:103], v[32:35], a[8:15], v2
    buffer_load_dwordx4 v[36:39], v1, s[4:7], s22 offen offset:1024 sc1
    v_smfmac_f32_16x16x64_bf16 v[104:107], v[32:35], a[128:135], v2
    s_cbranch_vccnz mega_kernel_rs_w0_pafail
    s_waitcnt lgkmcnt(0)
    s_barrier
    ds_read_b128 v[40:43], v6 offset:2048
    ds_read_b128 v[44:47], v6 offset:3072
    v_smfmac_f32_16x16x64_bf16 v[108:111], v[32:35], a[136:143], v2
    ds_read_b128 v[48:51], v6 offset:4096
    v_smfmac_f32_16x16x64_bf16 v[96:99], v[36:39], a[16:23], v2
    ds_read_b128 v[52:55], v6 offset:5120
    v_smfmac_f32_16x16x64_bf16 v[100:103], v[36:39], a[24:31], v2
    ds_read_b128 v[56:59], v6 offset:6144
    v_smfmac_f32_16x16x64_bf16 v[104:107], v[36:39], a[144:151], v2
    ds_read_b128 v[60:63], v6 offset:7168
    v_smfmac_f32_16x16x64_bf16 v[108:111], v[36:39], a[152:159], v2
    buffer_load_dwordx4 v1, s[4:7], s43 offen lds
    s_waitcnt lgkmcnt(5)
    v_smfmac_f32_16x16x64_bf16 v[96:99], v[40:43], a[32:39], v2
    v_smfmac_f32_16x16x64_bf16 v[104:107], v[40:43], a[160:167], v2
    s_waitcnt lgkmcnt(4)
    v_smfmac_f32_16x16x64_bf16 v[96:99], v[44:47], a[48:55], v2
    v_smfmac_f32_16x16x64_bf16 v[104:107], v[44:47], a[176:183], v2
    buffer_load_dwordx4 v1, s[4:7], s43 offen offset:1024 lds
    s_waitcnt lgkmcnt(3)
    v_smfmac_f32_16x16x64_bf16 v[96:99], v[48:51], a[64:71], v2
    v_smfmac_f32_16x16x64_bf16 v[104:107], v[48:51], a[192:199], v2
    s_waitcnt lgkmcnt(2)
    v_smfmac_f32_16x16x64_bf16 v[96:99], v[52:55], a[80:87], v2
    v_smfmac_f32_16x16x64_bf16 v[104:107], v[52:55], a[208:215], v2
    v_mov_b32 v4, s21
    buffer_store_dword v4, v7, s[4:7], 0 offen sc1
    s_waitcnt lgkmcnt(1)
    v_smfmac_f32_16x16x64_bf16 v[96:99], v[56:59], a[96:103], v2
    v_smfmac_f32_16x16x64_bf16 v[104:107], v[56:59], a[224:231], v2
    s_waitcnt lgkmcnt(0)
    v_smfmac_f32_16x16x64_bf16 v[96:99], v[60:63], a[112:119], v2
    v_smfmac_f32_16x16x64_bf16 v[104:107], v[60:63], a[240:247], v2
    v_smfmac_f32_16x16x64_bf16 v[100:103], v[40:43], a[40:47], v2
    s_nop 2
    v_smfmac_f32_16x16x64_bf16 v[100:103], v[44:47], a[56:63], v2
    s_nop 1
    v_add_f32 v96, v96, v98
    v_smfmac_f32_16x16x64_bf16 v[100:103], v[48:51], a[72:79], v2
    v_add_f32 v97, v97, v99
    v_add_f32 v104, v104, v106
    v_smfmac_f32_16x16x64_bf16 v[100:103], v[52:55], a[88:95], v2
    v_add_f32 v105, v105, v107
    v_cvt_pk_bf16_f32 v96, v96, v97
    v_smfmac_f32_16x16x64_bf16 v[100:103], v[56:59], a[104:111], v2
    v_cvt_pk_bf16_f32 v97, v104, v105
    v_and_or_b32 v96, v96, -2, s41
    v_smfmac_f32_16x16x64_bf16 v[100:103], v[60:63], a[120:127], v2
    buffer_store_dwordx2 v[96:97], v11, s[4:7], s37 offen sc1
    v_smfmac_f32_16x16x64_bf16 v[108:111], v[40:43], a[168:175], v2
    v_smfmac_f32_16x16x64_bf16 v[108:111], v[44:47], a[184:191], v2
    v_smfmac_f32_16x16x64_bf16 v[108:111], v[48:51], a[200:207], v2
    v_smfmac_f32_16x16x64_bf16 v[108:111], v[52:55], a[216:223], v2
    v_smfmac_f32_16x16x64_bf16 v[108:111], v[56:59], a[232:239], v2
    s_nop 2
    v_add_f32 v100, v100, v102
    v_smfmac_f32_16x16x64_bf16 v[108:111], v[60:63], a[248:255], v2
    v_add_f32 v101, v101, v103
    v_cvt_pk_bf16_f32 v98, v100, v101
    v_and_or_b32 v98, v98, -2, s41
    s_nop 4
    v_pk_add_f32 v[108:109], v[108:109], v[110:111]
    v_cvt_pk_bf16_f32 v99, v108, v109
    buffer_store_dwordx2 v[98:99], v11, s[4:7], s37 offen offset:512 sc1
    v_smfmac_f32_16x16x64_bf16 v[112:115], v[32:35], v[64:71], v2
    ds_read_b128 v[64:67], v1 offset:32768
    ds_read_b128 v[68:71], v1 offset:33792
    v_smfmac_f32_16x16x64_bf16 v[116:119], v[32:35], v[72:79], v2
    ds_read_b128 v[72:75], v1 offset:34816
    ds_read_b128 v[76:79], v1 offset:35840
    v_smfmac_f32_16x16x64_bf16 v[112:115], v[36:39], v[80:87], v2
    ds_read_b128 v[80:83], v1 offset:49152
    ds_read_b128 v[84:87], v1 offset:50176
    v_smfmac_f32_16x16x64_bf16 v[116:119], v[36:39], v[88:95], v2
    ds_read_b128 v[88:91], v1 offset:51200
    ds_read_b128 v[92:95], v1 offset:52224
    s_waitcnt lgkmcnt(6)
    v_smfmac_f32_16x16x64_bf16 v[112:115], v[40:43], v[64:71], v2
    ds_read_b128 v[64:67], v5 offset:0
    ds_read_b128 v[68:71], v5 offset:1024
    s_waitcnt lgkmcnt(6)
    v_smfmac_f32_16x16x64_bf16 v[116:119], v[40:43], v[72:79], v2
    ds_read_b128 v[72:75], v5 offset:2048
    ds_read_b128 v[76:79], v5 offset:3072
    s_waitcnt lgkmcnt(6)
    v_smfmac_f32_16x16x64_bf16 v[112:115], v[44:47], v[80:87], v2
    ds_read_b128 v[80:83], v5 offset:16384
    ds_read_b128 v[84:87], v5 offset:17408
    s_waitcnt lgkmcnt(6)
    v_smfmac_f32_16x16x64_bf16 v[116:119], v[44:47], v[88:95], v2
    ds_read_b128 v[88:91], v5 offset:18432
    ds_read_b128 v[92:95], v5 offset:19456
    s_waitcnt lgkmcnt(6)
    v_smfmac_f32_16x16x64_bf16 v[112:115], v[48:51], v[64:71], v2
    ds_read_b128 v[64:67], v5 offset:32768
    ds_read_b128 v[68:71], v5 offset:33792
    s_waitcnt lgkmcnt(6)
    v_smfmac_f32_16x16x64_bf16 v[116:119], v[48:51], v[72:79], v2
    ds_read_b128 v[72:75], v5 offset:34816
    ds_read_b128 v[76:79], v5 offset:35840
    s_waitcnt lgkmcnt(6)
    v_smfmac_f32_16x16x64_bf16 v[112:115], v[52:55], v[80:87], v2
    ds_read_b128 v[80:83], v5 offset:49152
    ds_read_b128 v[84:87], v5 offset:50176
    s_waitcnt lgkmcnt(6)
    v_smfmac_f32_16x16x64_bf16 v[116:119], v[52:55], v[88:95], v2
    ds_read_b128 v[88:91], v5 offset:51200
    ds_read_b128 v[92:95], v5 offset:52224
    s_waitcnt lgkmcnt(6)
    v_smfmac_f32_16x16x64_bf16 v[112:115], v[56:59], v[64:71], v2
    s_waitcnt lgkmcnt(4)
    v_smfmac_f32_16x16x64_bf16 v[116:119], v[56:59], v[72:79], v2
    s_waitcnt lgkmcnt(2)
    v_smfmac_f32_16x16x64_bf16 v[112:115], v[60:63], v[80:87], v2
    s_waitcnt lgkmcnt(0)
    v_smfmac_f32_16x16x64_bf16 v[116:119], v[60:63], v[88:95], v2
    buffer_load_dwordx2 v[108:109], v11, s[4:7], s38 offen sc1
    v_mfma_f32_16x16x16_bf16 v[100:103], v[96:97], v[16:17], 0
    v_mfma_f32_16x16x16_bf16 v[104:107], v[98:99], v[16:17], 0
    s_nop 4
    v_add_f32 v112, v112, v114
    v_add_f32 v113, v113, v115
    v_add_f32 v114, v116, v118
    v_add_f32 v115, v117, v119
    v_cvt_pk_bf16_f32 v18, v112, v113
    v_cvt_pk_bf16_f32 v19, v114, v115
    v_and_or_b32 v18, v18, -2, s41
    buffer_load_dwordx2 v[110:111], v11, s[4:7], s38 offen offset:512 sc1
    s_barrier
    buffer_store_dwordx2 v[18:19], v11, s[4:7], s39 offen sc1
    v_mov_b32 v112, v18
    v_mov_b32 v114, v19
    v_mov_b32 v92, v28
    v_mov_b32 v93, 0
    s_waitcnt vmcnt(6)
    s_barrier
    ds_read_b128 v[32:35], v6 offset:9216
    ds_read_b128 v[36:39], v6 offset:10240
    ds_read_b128 v[40:43], v6 offset:14336
    ds_read_b128 v[44:47], v6 offset:15360
    ds_read_b128 v[48:51], v6 offset:19456
    ds_read_b128 v[52:55], v6 offset:20480
    ds_read_b128 v[56:59], v6 offset:24576
    ds_read_b128 v[60:63], v6 offset:25600
    buffer_load_dwordx2 v[20:21], v11, s[4:7], s38 offen sc1
    buffer_load_dwordx2 v[22:23], v11, s[4:7], s38 offen offset:512 sc1
    s_waitcnt vmcnt(4)
    v_mfma_f32_16x16x16_bf16 v[80:83], v[108:109], v[16:17], v[100:103]
    v_and_b32 v3, 1, v108
    v_cmp_ne_u32 vcc, s41, v3
    s_nop 5
    v_cvt_pk_bf16_f32 v64, v80, v81
    v_cvt_pk_bf16_f32 v65, v82, v83
    s_cbranch_vccnz mega_kernel_rs_w0_xslow
    s_waitcnt vmcnt(3)
    v_mfma_f32_16x16x16_bf16 v[84:87], v[110:111], v[16:17], v[104:107]
    v_and_b32 v3, 1, v110
    v_cmp_ne_u32 vcc, s41, v3
    s_nop 5
    v_cvt_pk_bf16_f32 v66, v84, v85
    v_cvt_pk_bf16_f32 v67, v86, v87
    ds_write_b128 v6, v[64:67] offset:8192
    s_cbranch_vccnz mega_kernel_rs_w0_xslow
mega_kernel_rs_w0_xok:
    s_cmp_eq_u32 s21, 63
    s_cbranch_scc1 mega_kernel_rs_w0_last
    buffer_load_dwordx2 v[116:117], v11, s[4:7], s40 offen sc1
    s_waitcnt lgkmcnt(1)
    v_mfma_f32_16x16x32_bf16 v[80:83], v[32:35], v[64:67], 0
    s_waitcnt lgkmcnt(0)
    s_barrier
    ds_read_b128 v[68:71], v6 offset:13312
    ds_read_b128 v[72:75], v6 offset:18432
    ds_read_b128 v[76:79], v6 offset:23552
    v_mfma_f32_16x16x32_bf16 v[84:87], v[36:39], v[64:67], 0
    v_mfma_f32_16x16x32_bf16 v[88:91], v[64:67], v[64:67], 0
    buffer_load_dwordx2 v[20:21], v11, s[4:7], s40 offen sc1
    s_waitcnt lgkmcnt(2)
    v_mfma_f32_16x16x32_bf16 v[80:83], v[40:43], v[68:71], v[80:83]
    buffer_store_dwordx4 v[64:67], v10, s[4:7], s45 offen offset:0 sc1
    s_waitcnt lgkmcnt(1)
    v_mfma_f32_16x16x32_bf16 v[80:83], v[48:51], v[72:75], v[80:83]
    s_waitcnt lgkmcnt(0)
    v_mfma_f32_16x16x32_bf16 v[80:83], v[56:59], v[76:79], v[80:83]
    v_mfma_f32_16x16x32_bf16 v[84:87], v[44:47], v[68:71], v[84:87]
    v_mfma_f32_16x16x32_bf16 v[84:87], v[52:55], v[72:75], v[84:87]
    buffer_store_dwordx2 v[18:19], v11, s[4:7], s51 offen offset:2048 sc1
    v_mfma_f32_16x16x32_bf16 v[84:87], v[60:63], v[76:79], v[84:87]
    v_mfma_f32_16x16x32_bf16 v[88:91], v[68:71], v[68:71], v[88:91]
    v_mfma_f32_16x16x32_bf16 v[88:91], v[72:75], v[72:75], v[88:91]
    v_mfma_f32_16x16x32_bf16 v[88:91], v[76:79], v[76:79], v[88:91]
    v_mfma_f32_32x32x4_2b_bf16 v[32:63], v[14:15], v[14:15], 0
    s_nop 0
    v_max3_f32 v4, v80, v81, v82
    s_nop 1
    v_max3_f32 v4, v4, v83, v84
    v_max3_f32 v4, v4, v85, v86
    v_max_f32 v4, v4, v87
    v_max3_f32 v90, v4, v88, v89
    v_max3_f32 v4, v4, v88, v89
    s_nop 1
    v_permlane16_swap_b32 v4, v90
    v_max_f32 v4, v4, v90
    v_max_f32 v90, v4, v90
    s_nop 1
    v_permlane32_swap_b32 v4, v90
    v_max_f32 v4, v4, v90
    v_mul_f32 v4, s34, v4
    v_pk_fma_f32 v[80:81], v[80:81], s[34:35], v[4:5] op_sel_hi:[1,0,0] neg_lo:[0,0,1] neg_hi:[0,0,1]
    v_pk_fma_f32 v[82:83], v[82:83], s[34:35], v[4:5] op_sel_hi:[1,0,0] neg_lo:[0,0,1] neg_hi:[0,0,1]
    v_pk_fma_f32 v[84:85], v[84:85], s[34:35], v[4:5] op_sel_hi:[1,0,0] neg_lo:[0,0,1] neg_hi:[0,0,1]
    v_pk_fma_f32 v[86:87], v[86:87], s[34:35], v[4:5] op_sel_hi:[1,0,0] neg_lo:[0,0,1] neg_hi:[0,0,1]
    v_pk_fma_f32 v[88:89], v[88:89], s[34:35], v[4:5] op_sel_hi:[1,0,0] neg_lo:[0,0,1] neg_hi:[0,0,1]
    v_exp_f32 v80, v80
    v_exp_f32 v81, v81
    v_exp_f32 v82, v82
    v_cvt_pk_bf16_f32 v68, v80, v81
    v_exp_f32 v83, v83
    v_exp_f32 v84, v84
    v_cvt_pk_bf16_f32 v69, v82, v83
    v_exp_f32 v85, v85
    v_exp_f32 v86, v86
    v_cvt_pk_bf16_f32 v70, v84, v85
    v_exp_f32 v87, v87
    v_exp_f32 v88, v88
    v_cvt_pk_bf16_f32 v71, v86, v87
    v_exp_f32 v89, v89
    s_waitcnt vmcnt(3)
    v_mfma_f32_16x16x32_bf16 v[76:79], v[28:31], v[68:71], 0
    v_and_b32 v3, 1, v116
    v_cvt_pk_bf16_f32 v72, v88, v89
    v_mfma_f32_16x16x32_bf16 v[100:103], v[120:123], v[68:71], 0
    v_cmp_ne_u32 vcc, s41, v3
    v_cvt_pk_bf16_f32 v73, v88, v89
    v_mfma_f32_16x16x32_bf16 v[104:107], v[124:127], v[68:71], 0
    v_mov_b32 v113, v116
    v_mov_b32 v115, v117
    v_mfma_f32_16x16x16_bf16 v[76:79], v[92:93], v[72:73], v[76:79]
    s_cbranch_vccnz mega_kernel_rs_w0_pv0
mega_kernel_rs_w0_pv2:
    v_mfma_f32_16x16x16_bf16 v[100:103], v[112:113], v[72:73], v[100:103]
    v_mfma_f32_16x16x16_bf16 v[104:107], v[114:115], v[72:73], v[104:107]
    buffer_load_dwordx4 v[120:123], v1, s[4:7], s44 offen
    buffer_load_dwordx4 v[124:127], v1, s[4:7], s44 offen offset:1024
    s_nop 2
    v_rcp_f32 v76, v76
    s_mov_b64 exec, s[28:29]
    v_pk_mul_f32 v[100:101], v[100:101], v[76:77] op_sel_hi:[1,0]
    v_pk_mul_f32 v[102:103], v[102:103], v[76:77] op_sel_hi:[1,0]
    v_pk_mul_f32 v[104:105], v[104:105], v[76:77] op_sel_hi:[1,0]
    v_pk_mul_f32 v[106:107], v[106:107], v[76:77] op_sel_hi:[1,0]
    v_cvt_pk_bf16_f32 v84, v100, v101
    v_cvt_pk_bf16_f32 v85, v102, v103
    v_cvt_pk_bf16_f32 v86, v104, v105
    v_cvt_pk_bf16_f32 v87, v106, v107
    ds_write_b128 v6, v[84:87] offset:28640
    s_mov_b64 exec, -1
    s_waitcnt lgkmcnt(0)
    s_barrier
    ds_read_b128 v[68:71], v6 offset:28672
    ds_read_b128 v[72:75], v6 offset:29696
    s_waitcnt lgkmcnt(1)
    v_smfmac_f32_16x16x64_bf16 v[32:35], v[68:71], v[128:135], v2
    s_add_u32 s21, s21, 1
    s_xor_b32 s38, s38, 1048576
    s_xor_b32 s37, s37, 1048576
    s_waitcnt lgkmcnt(0)
    v_smfmac_f32_16x16x64_bf16 v[32:35], v[72:75], v[136:143], v2
    s_xor_b32 s40, s40, 1048576
    s_xor_b32 s39, s39, 1048576
    s_lshr_b32 s41, s21, 1
    v_smfmac_f32_16x16x64_bf16 v[36:39], v[68:71], v[144:151], v2
    s_and_b32 s41, s41, 1
    s_xor_b32 s41, s41, 1
    s_xor_b32 s35, s35, 16384
    v_smfmac_f32_16x16x64_bf16 v[36:39], v[72:75], v[152:159], v2
    v_add_f32 v32, v32, v34
    s_xor_b32 s36, s36, 16384
    s_add_u32 s43, s43, 262144
    s_add_u32 s44, s44, 262144
    v_smfmac_f32_16x16x64_bf16 v[40:43], v[68:71], v[160:167], v2
    v_add_f32 v33, v33, v35
    v_smfmac_f32_16x16x64_bf16 v[40:43], v[72:75], v[168:175], v2
    v_cvt_pk_bf16_f32 v32, v32, v33
    v_smfmac_f32_16x16x64_bf16 v[44:47], v[68:71], v[176:183], v2
    v_and_or_b32 v32, v32, -2, s42
    v_smfmac_f32_16x16x64_bf16 v[44:47], v[72:75], v[184:191], v2
    v_add_f32 v36, v36, v38
    v_smfmac_f32_16x16x64_bf16 v[48:51], v[68:71], v[192:199], v2
    v_add_f32 v37, v37, v39
    v_smfmac_f32_16x16x64_bf16 v[48:51], v[72:75], v[200:207], v2
    v_cvt_pk_bf16_f32 v33, v36, v37
    v_smfmac_f32_16x16x64_bf16 v[52:55], v[68:71], v[208:215], v2
    v_add_f32 v40, v40, v42
    v_smfmac_f32_16x16x64_bf16 v[52:55], v[72:75], v[216:223], v2
    v_add_f32 v41, v41, v43
    v_smfmac_f32_16x16x64_bf16 v[56:59], v[68:71], v[224:231], v2
    v_cvt_pk_bf16_f32 v34, v40, v41
    v_smfmac_f32_16x16x64_bf16 v[56:59], v[72:75], v[232:239], v2
    v_add_f32 v44, v44, v46
    v_smfmac_f32_16x16x64_bf16 v[60:63], v[68:71], v[240:247], v2
    v_add_f32 v45, v45, v47
    v_smfmac_f32_16x16x64_bf16 v[60:63], v[72:75], v[248:255], v2
    v_cvt_pk_bf16_f32 v35, v44, v45
    buffer_store_dwordx4 v[32:35], v8, s[4:7], s46 offen sc1
    v_pk_add_f32 v[48:49], v[48:49], v[50:51]
    v_cvt_pk_bf16_f32 v48, v48, v49
    v_and_or_b32 v48, v48, -2, s42
    v_pk_add_f32 v[52:53], v[52:53], v[54:55]
    v_cvt_pk_bf16_f32 v49, v52, v53
    v_pk_add_f32 v[56:57], v[56:57], v[58:59]
    v_cvt_pk_bf16_f32 v50, v56, v57
    v_pk_add_f32 v[60:61], v[60:61], v[62:63]
    v_cvt_pk_bf16_f32 v51, v60, v61
    buffer_store_dwordx4 v[48:51], v8, s[4:7], s61 offen sc1
    s_add_u32 s45, s45, 262144
    s_add_u32 s51, s51, 262144
    v_mfma_f32_32x32x8_bf16 v[96:111], v[14:15], v[14:15], 0
    v_mfma_f32_16x16x16_bf16 v[112:115], v[14:15], v[14:15], 0
    v_mfma_f32_16x16x16_bf16 v[116:119], v[14:15], v[14:15], 0
    ds_read_b128 v[64:67], v1 offset:0
    ds_read_b128 v[68:71], v1 offset:1024
    ds_read_b128 v[72:75], v1 offset:2048
    ds_read_b128 v[76:79], v1 offset:3072
    ds_read_b128 v[80:83], v1 offset:16384
    ds_read_b128 v[84:87], v1 offset:17408
    ds_read_b128 v[88:91], v1 offset:18432
    ds_read_b128 v[92:95], v1 offset:19456
    v_mov_b32 v58, -1
    v_mov_b32 v59, -1
    s_waitcnt vmcnt(0)
mega_kernel_rs_w0_pc:
    buffer_load_dword v36, v13, s[4:7], s25 offen offset:0 sc1
    buffer_load_dword v37, v13, s[4:7], s25 offen offset:256 sc1
    buffer_load_dword v38, v13, s[4:7], s25 offen offset:512 sc1
    buffer_load_dword v39, v13, s[4:7], s25 offen offset:768 sc1
    buffer_load_dword v40, v13, s[4:7], s25 offen offset:1024 sc1
    buffer_load_dword v41, v13, s[4:7], s25 offen offset:1280 sc1
    buffer_load_dword v42, v13, s[4:7], s25 offen offset:1536 sc1
    buffer_load_dword v43, v13, s[4:7], s25 offen offset:1792 sc1
    s_waitcnt vmcnt(4)
    v_mfma_f32_16x16x32_bf16 v[52:55], v[36:39], v[24:27], 0
    v_bitop3_b32 v3, s42, v36, v37 bitop3:0x7e
    v_bitop3_b32 v4, s42, v38, v39 bitop3:0x7e
    s_waitcnt vmcnt(2)
    v_or_b32 v3, v3, v4
    v_bitop3_b32 v4, s42, v40, v41 bitop3:0x7e
    s_waitcnt vmcnt(0)
    v_mfma_f32_16x16x32_bf16 v[52:55], v[40:43], v[24:27], v[52:55]
    v_bitop3_b32 v56, s42, v42, v43 bitop3:0x7e
    v_or3_b32 v3, v3, v4, v56
    v_and_b32 v3, v0, v3
    v_cmp_ne_u32 vcc, 0, v3
    s_nop 3
    v_cvt_pk_bf16_f32 v56, v52, v53
    v_cvt_pk_bf16_f32 v57, v54, v55
    v_min_u32 v56, -2, v56
    s_cbranch_vccnz mega_kernel_rs_w0_pc
    s_mov_b64 exec, s[26:27]
    buffer_store_dwordx2 v[56:57], v9, s[4:7], s35 offen offset:0 sc1
    buffer_store_dwordx2 v[58:59], v9, s[4:7], s36 offen offset:0 sc1
    s_mov_b64 exec, -1
    s_xor_b32 s42, s42, 1
    s_branch mega_kernel_rs_w0_loop
mega_kernel_rs_w0_last:
    buffer_store_dwordx4 v[64:67], v10, s[4:7], s45 offen offset:0 sc1
    buffer_store_dwordx2 v[18:19], v11, s[4:7], s51 offen offset:2048 sc1
    s_branch mega_kernel_rs_end
mega_kernel_rs_w0_pafail:
    s_nop 7
    v_mov_b32 v96, 0
    v_mov_b32 v97, 0
    v_mov_b32 v98, 0
    v_mov_b32 v99, 0
    v_mov_b32 v100, 0
    v_mov_b32 v101, 0
    v_mov_b32 v102, 0
    v_mov_b32 v103, 0
    v_mov_b32 v104, 0
    v_mov_b32 v105, 0
    v_mov_b32 v106, 0
    v_mov_b32 v107, 0
    s_branch mega_kernel_rs_w0_pa
mega_kernel_rs_w0_xslow:
    buffer_load_dwordx2 v[108:109], v11, s[4:7], s38 offen sc1
    buffer_load_dwordx2 v[110:111], v11, s[4:7], s38 offen offset:512 sc1
    s_waitcnt vmcnt(2)
    v_bitop3_b32 v3, s41, v20, v22 bitop3:0x7e
    v_mfma_f32_16x16x16_bf16 v[80:83], v[20:21], v[16:17], v[100:103]
    v_and_b32 v3, 1, v3
    v_mfma_f32_16x16x16_bf16 v[84:87], v[22:23], v[16:17], v[104:107]
    v_cmp_ne_u32 vcc, 0, v3
    s_cbranch_vccz mega_kernel_rs_w0_xgot
    buffer_load_dwordx2 v[20:21], v11, s[4:7], s38 offen sc1
    buffer_load_dwordx2 v[22:23], v11, s[4:7], s38 offen offset:512 sc1
    s_waitcnt vmcnt(2)
    v_bitop3_b32 v3, s41, v108, v110 bitop3:0x7e
    v_mfma_f32_16x16x16_bf16 v[80:83], v[108:109], v[16:17], v[100:103]
    v_and_b32 v3, 1, v3
    v_mfma_f32_16x16x16_bf16 v[84:87], v[110:111], v[16:17], v[104:107]
    v_cmp_ne_u32 vcc, 0, v3
    s_cbranch_vccz mega_kernel_rs_w0_xgot
    s_branch mega_kernel_rs_w0_xslow
mega_kernel_rs_w0_xgot:
    s_nop 3
    v_cvt_pk_bf16_f32 v64, v80, v81
    v_cvt_pk_bf16_f32 v65, v82, v83
    v_cvt_pk_bf16_f32 v66, v84, v85
    v_cvt_pk_bf16_f32 v67, v86, v87
    ds_write_b128 v6, v[64:67] offset:8192
    s_branch mega_kernel_rs_w0_xok
mega_kernel_rs_w0_pv0:
    s_waitcnt vmcnt(2)
    s_branch mega_kernel_rs_w0_pv1
mega_kernel_rs_w0_pv:
    buffer_load_dwordx2 v[20:21], v11, s[4:7], s40 offen sc1
    s_waitcnt vmcnt(0)
mega_kernel_rs_w0_pv1:
    v_and_b32 v3, 1, v20
    v_cmp_ne_u32 vcc, s41, v3
    v_mov_b32 v113, v20
    v_mov_b32 v115, v21
    s_cbranch_vccnz mega_kernel_rs_w0_pv
    s_branch mega_kernel_rs_w0_pv2
mega_kernel_rs_w1_entry:
    v_mfma_f32_32x32x8_bf16 v[96:111], v[14:15], v[14:15], 0
    v_mfma_f32_16x16x16_bf16 v[112:115], v[14:15], v[14:15], 0
    v_mfma_f32_16x16x16_bf16 v[116:119], v[14:15], v[14:15], 0
    ds_read_b128 v[64:67], v1 offset:4096
    ds_read_b128 v[68:71], v1 offset:5120
    ds_read_b128 v[72:75], v1 offset:6144
    ds_read_b128 v[76:79], v1 offset:7168
    ds_read_b128 v[80:83], v1 offset:20480
    ds_read_b128 v[84:87], v1 offset:21504
    ds_read_b128 v[88:91], v1 offset:22528
    ds_read_b128 v[92:95], v1 offset:23552
    buffer_load_dwordx4 v[120:123], v1, s[4:7], s44 offen
    buffer_load_dwordx4 v[124:127], v1, s[4:7], s44 offen offset:1024
    s_add_u32 s44, s44, 262144
mega_kernel_rs_w1_loop:
    s_add_u32 s22, s35, 2048
    s_waitcnt vmcnt(0)
    buffer_load_dwordx4 v[40:43], v1, s[4:7], s22 offen sc1
    buffer_load_dwordx4 v[44:47], v1, s[4:7], s22 offen offset:1024 sc1
mega_kernel_rs_w1_pa:
    s_waitcnt vmcnt(1)
    ds_write_b128 v6, v[40:43] offset:2048
    s_waitcnt vmcnt(0)
    ds_write_b128 v6, v[44:47] offset:3072
    v_max3_u32 v3, v40, v42, v44
    v_max_u32 v3, v3, v46
    v_cmp_eq_u32 vcc, -1, v3
    v_smfmac_f32_16x16x64_bf16 v[96:99], v[40:43], a[32:39], v2
    buffer_load_dwordx4 v[40:43], v1, s[4:7], s22 offen sc1
    v_smfmac_f32_16x16x64_bf16 v[100:103], v[40:43], a[40:47], v2
    buffer_load_dwordx4 v[44:47], v1, s[4:7], s22 offen offset:1024 sc1
    v_smfmac_f32_16x16x64_bf16 v[104:107], v[40:43], a[160:167], v2
    s_cbranch_vccnz mega_kernel_rs_w1_pafail
    s_waitcnt lgkmcnt(0)
    s_barrier
    ds_read_b128 v[48:51], v6 offset:4096
    ds_read_b128 v[52:55], v6 offset:5120
    v_smfmac_f32_16x16x64_bf16 v[108:111], v[40:43], a[168:175], v2
    ds_read_b128 v[56:59], v6 offset:6144
    v_smfmac_f32_16x16x64_bf16 v[96:99], v[44:47], a[48:55], v2
    ds_read_b128 v[60:63], v6 offset:7168
    v_smfmac_f32_16x16x64_bf16 v[100:103], v[44:47], a[56:63], v2
    ds_read_b128 v[32:35], v6 offset:0
    v_smfmac_f32_16x16x64_bf16 v[104:107], v[44:47], a[176:183], v2
    ds_read_b128 v[36:39], v6 offset:1024
    v_smfmac_f32_16x16x64_bf16 v[108:111], v[44:47], a[184:191], v2
    s_waitcnt lgkmcnt(5)
    v_smfmac_f32_16x16x64_bf16 v[96:99], v[48:51], a[64:71], v2
    buffer_load_dwordx4 v1, s[4:7], s43 offen lds
    v_smfmac_f32_16x16x64_bf16 v[104:107], v[48:51], a[192:199], v2
    s_waitcnt lgkmcnt(4)
    v_smfmac_f32_16x16x64_bf16 v[96:99], v[52:55], a[80:87], v2
    v_smfmac_f32_16x16x64_bf16 v[104:107], v[52:55], a[208:215], v2
    s_waitcnt lgkmcnt(3)
    v_smfmac_f32_16x16x64_bf16 v[96:99], v[56:59], a[96:103], v2
    buffer_load_dwordx4 v1, s[4:7], s43 offen offset:1024 lds
    v_smfmac_f32_16x16x64_bf16 v[104:107], v[56:59], a[224:231], v2
    s_waitcnt lgkmcnt(2)
    v_smfmac_f32_16x16x64_bf16 v[96:99], v[60:63], a[112:119], v2
    v_smfmac_f32_16x16x64_bf16 v[104:107], v[60:63], a[240:247], v2
    s_waitcnt lgkmcnt(1)
    v_smfmac_f32_16x16x64_bf16 v[96:99], v[32:35], a[0:7], v2
    v_smfmac_f32_16x16x64_bf16 v[104:107], v[32:35], a[128:135], v2
    s_waitcnt lgkmcnt(0)
    v_smfmac_f32_16x16x64_bf16 v[96:99], v[36:39], a[16:23], v2
    v_smfmac_f32_16x16x64_bf16 v[104:107], v[36:39], a[144:151], v2
    v_smfmac_f32_16x16x64_bf16 v[100:103], v[48:51], a[72:79], v2
    s_nop 2
    v_smfmac_f32_16x16x64_bf16 v[100:103], v[52:55], a[88:95], v2
    s_nop 1
    v_add_f32 v96, v96, v98
    v_smfmac_f32_16x16x64_bf16 v[100:103], v[56:59], a[104:111], v2
    v_add_f32 v97, v97, v99
    v_add_f32 v104, v104, v106
    v_smfmac_f32_16x16x64_bf16 v[100:103], v[60:63], a[120:127], v2
    v_add_f32 v105, v105, v107
    v_cvt_pk_bf16_f32 v96, v96, v97
    v_smfmac_f32_16x16x64_bf16 v[100:103], v[32:35], a[8:15], v2
    v_cvt_pk_bf16_f32 v97, v104, v105
    v_and_or_b32 v96, v96, -2, s41
    v_smfmac_f32_16x16x64_bf16 v[100:103], v[36:39], a[24:31], v2
    buffer_store_dwordx2 v[96:97], v11, s[4:7], s37 offen sc1
    v_smfmac_f32_16x16x64_bf16 v[108:111], v[48:51], a[200:207], v2
    v_smfmac_f32_16x16x64_bf16 v[108:111], v[52:55], a[216:223], v2
    v_smfmac_f32_16x16x64_bf16 v[108:111], v[56:59], a[232:239], v2
    v_smfmac_f32_16x16x64_bf16 v[108:111], v[60:63], a[248:255], v2
    v_smfmac_f32_16x16x64_bf16 v[108:111], v[32:35], a[136:143], v2
    s_nop 2
    v_add_f32 v100, v100, v102
    v_smfmac_f32_16x16x64_bf16 v[108:111], v[36:39], a[152:159], v2
    v_add_f32 v101, v101, v103
    v_cvt_pk_bf16_f32 v98, v100, v101
    v_and_or_b32 v98, v98, -2, s41
    s_nop 4
    v_pk_add_f32 v[108:109], v[108:109], v[110:111]
    v_cvt_pk_bf16_f32 v99, v108, v109
    buffer_store_dwordx2 v[98:99], v11, s[4:7], s37 offen offset:512 sc1
    v_smfmac_f32_16x16x64_bf16 v[112:115], v[32:35], v[64:71], v2
    ds_read_b128 v[64:67], v1 offset:36864
    ds_read_b128 v[68:71], v1 offset:37888
    v_smfmac_f32_16x16x64_bf16 v[116:119], v[32:35], v[72:79], v2
    ds_read_b128 v[72:75], v1 offset:38912
    ds_read_b128 v[76:79], v1 offset:39936
    v_smfmac_f32_16x16x64_bf16 v[112:115], v[36:39], v[80:87], v2
    ds_read_b128 v[80:83], v1 offset:53248
    ds_read_b128 v[84:87], v1 offset:54272
    v_smfmac_f32_16x16x64_bf16 v[116:119], v[36:39], v[88:95], v2
    ds_read_b128 v[88:91], v1 offset:55296
    ds_read_b128 v[92:95], v1 offset:56320
    s_waitcnt lgkmcnt(6)
    v_smfmac_f32_16x16x64_bf16 v[112:115], v[40:43], v[64:71], v2
    ds_read_b128 v[64:67], v5 offset:4096
    ds_read_b128 v[68:71], v5 offset:5120
    s_waitcnt lgkmcnt(6)
    v_smfmac_f32_16x16x64_bf16 v[116:119], v[40:43], v[72:79], v2
    ds_read_b128 v[72:75], v5 offset:6144
    ds_read_b128 v[76:79], v5 offset:7168
    s_waitcnt lgkmcnt(6)
    v_smfmac_f32_16x16x64_bf16 v[112:115], v[44:47], v[80:87], v2
    ds_read_b128 v[80:83], v5 offset:20480
    ds_read_b128 v[84:87], v5 offset:21504
    s_waitcnt lgkmcnt(6)
    v_smfmac_f32_16x16x64_bf16 v[116:119], v[44:47], v[88:95], v2
    ds_read_b128 v[88:91], v5 offset:22528
    ds_read_b128 v[92:95], v5 offset:23552
    s_waitcnt lgkmcnt(6)
    v_smfmac_f32_16x16x64_bf16 v[112:115], v[48:51], v[64:71], v2
    ds_read_b128 v[64:67], v5 offset:36864
    ds_read_b128 v[68:71], v5 offset:37888
    s_waitcnt lgkmcnt(6)
    v_smfmac_f32_16x16x64_bf16 v[116:119], v[48:51], v[72:79], v2
    ds_read_b128 v[72:75], v5 offset:38912
    ds_read_b128 v[76:79], v5 offset:39936
    s_waitcnt lgkmcnt(6)
    v_smfmac_f32_16x16x64_bf16 v[112:115], v[52:55], v[80:87], v2
    ds_read_b128 v[80:83], v5 offset:53248
    ds_read_b128 v[84:87], v5 offset:54272
    s_waitcnt lgkmcnt(6)
    v_smfmac_f32_16x16x64_bf16 v[116:119], v[52:55], v[88:95], v2
    ds_read_b128 v[88:91], v5 offset:55296
    ds_read_b128 v[92:95], v5 offset:56320
    s_waitcnt lgkmcnt(6)
    v_smfmac_f32_16x16x64_bf16 v[112:115], v[56:59], v[64:71], v2
    s_waitcnt lgkmcnt(4)
    v_smfmac_f32_16x16x64_bf16 v[116:119], v[56:59], v[72:79], v2
    s_waitcnt lgkmcnt(2)
    v_smfmac_f32_16x16x64_bf16 v[112:115], v[60:63], v[80:87], v2
    s_waitcnt lgkmcnt(0)
    v_smfmac_f32_16x16x64_bf16 v[116:119], v[60:63], v[88:95], v2
    buffer_load_dwordx2 v[108:109], v11, s[4:7], s38 offen sc1
    v_mfma_f32_16x16x16_bf16 v[100:103], v[96:97], v[16:17], 0
    v_mfma_f32_16x16x16_bf16 v[104:107], v[98:99], v[16:17], 0
    s_nop 4
    v_add_f32 v112, v112, v114
    v_add_f32 v113, v113, v115
    v_add_f32 v114, v116, v118
    v_add_f32 v115, v117, v119
    v_cvt_pk_bf16_f32 v18, v112, v113
    v_cvt_pk_bf16_f32 v19, v114, v115
    v_and_or_b32 v18, v18, -2, s41
    buffer_load_dwordx2 v[110:111], v11, s[4:7], s38 offen offset:512 sc1
    s_barrier
    buffer_store_dwordx2 v[18:19], v11, s[4:7], s39 offen sc1
    v_mov_b32 v112, v18
    v_mov_b32 v114, v19
    v_mov_b32 v92, v28
    v_mov_b32 v93, 0
    s_waitcnt vmcnt(5)
    s_barrier
    ds_read_b128 v[32:35], v6 offset:14336
    ds_read_b128 v[36:39], v6 offset:15360
    ds_read_b128 v[40:43], v6 offset:9216
    ds_read_b128 v[44:47], v6 offset:10240
    ds_read_b128 v[48:51], v6 offset:24576
    ds_read_b128 v[52:55], v6 offset:25600
    ds_read_b128 v[56:59], v6 offset:19456
    ds_read_b128 v[60:63], v6 offset:20480
    buffer_load_dwordx2 v[20:21], v11, s[4:7], s38 offen sc1
    buffer_load_dwordx2 v[22:23], v11, s[4:7], s38 offen offset:512 sc1
    s_waitcnt vmcnt(4)
    v_mfma_f32_16x16x16_bf16 v[80:83], v[108:109], v[16:17], v[100:103]
    v_and_b32 v3, 1, v108
    v_cmp_ne_u32 vcc, s41, v3
    s_nop 5
    v_cvt_pk_bf16_f32 v64, v80, v81
    v_cvt_pk_bf16_f32 v65, v82, v83
    s_cbranch_vccnz mega_kernel_rs_w1_xslow
    s_waitcnt vmcnt(3)
    v_mfma_f32_16x16x16_bf16 v[84:87], v[110:111], v[16:17], v[104:107]
    v_and_b32 v3, 1, v110
    v_cmp_ne_u32 vcc, s41, v3
    s_nop 5
    v_cvt_pk_bf16_f32 v66, v84, v85
    v_cvt_pk_bf16_f32 v67, v86, v87
    ds_write_b128 v6, v[64:67] offset:13312
    s_cbranch_vccnz mega_kernel_rs_w1_xslow
mega_kernel_rs_w1_xok:
    s_cmp_eq_u32 s21, 63
    s_cbranch_scc1 mega_kernel_rs_w1_last
    buffer_load_dwordx2 v[116:117], v11, s[4:7], s40 offen sc1
    s_waitcnt lgkmcnt(1)
    v_mfma_f32_16x16x32_bf16 v[80:83], v[32:35], v[64:67], 0
    s_waitcnt lgkmcnt(0)
    s_barrier
    ds_read_b128 v[68:71], v6 offset:8192
    ds_read_b128 v[72:75], v6 offset:23552
    ds_read_b128 v[76:79], v6 offset:18432
    v_mfma_f32_16x16x32_bf16 v[84:87], v[36:39], v[64:67], 0
    v_mfma_f32_16x16x32_bf16 v[88:91], v[64:67], v[64:67], 0
    buffer_load_dwordx2 v[20:21], v11, s[4:7], s40 offen sc1
    s_waitcnt lgkmcnt(2)
    v_mfma_f32_16x16x32_bf16 v[80:83], v[40:43], v[68:71], v[80:83]
    s_waitcnt lgkmcnt(1)
    v_mfma_f32_16x16x32_bf16 v[80:83], v[48:51], v[72:75], v[80:83]
    buffer_store_dwordx4 v[64:67], v10, s[4:7], s45 offen offset:64 sc1
    s_waitcnt lgkmcnt(0)
    v_mfma_f32_16x16x32_bf16 v[80:83], v[56:59], v[76:79], v[80:83]
    v_mfma_f32_16x16x32_bf16 v[84:87], v[44:47], v[68:71], v[84:87]
    v_mfma_f32_16x16x32_bf16 v[84:87], v[52:55], v[72:75], v[84:87]
    v_mfma_f32_16x16x32_bf16 v[84:87], v[60:63], v[76:79], v[84:87]
    buffer_store_dwordx2 v[18:19], v11, s[4:7], s51 offen offset:2560 sc1
    v_mfma_f32_16x16x32_bf16 v[88:91], v[68:71], v[68:71], v[88:91]
    v_mfma_f32_16x16x32_bf16 v[88:91], v[72:75], v[72:75], v[88:91]
    v_mfma_f32_16x16x32_bf16 v[88:91], v[76:79], v[76:79], v[88:91]
    v_mfma_f32_32x32x4_2b_bf16 v[32:63], v[14:15], v[14:15], 0
    s_nop 0
    v_max3_f32 v4, v80, v81, v82
    s_nop 1
    v_max3_f32 v4, v4, v83, v84
    v_max3_f32 v4, v4, v85, v86
    v_max_f32 v4, v4, v87
    v_max3_f32 v90, v4, v88, v89
    v_max3_f32 v4, v4, v88, v89
    s_nop 1
    v_permlane16_swap_b32 v4, v90
    v_max_f32 v4, v4, v90
    v_max_f32 v90, v4, v90
    s_nop 1
    v_permlane32_swap_b32 v4, v90
    v_max_f32 v4, v4, v90
    v_mul_f32 v4, s34, v4
    v_pk_fma_f32 v[80:81], v[80:81], s[34:35], v[4:5] op_sel_hi:[1,0,0] neg_lo:[0,0,1] neg_hi:[0,0,1]
    v_pk_fma_f32 v[82:83], v[82:83], s[34:35], v[4:5] op_sel_hi:[1,0,0] neg_lo:[0,0,1] neg_hi:[0,0,1]
    v_pk_fma_f32 v[84:85], v[84:85], s[34:35], v[4:5] op_sel_hi:[1,0,0] neg_lo:[0,0,1] neg_hi:[0,0,1]
    v_pk_fma_f32 v[86:87], v[86:87], s[34:35], v[4:5] op_sel_hi:[1,0,0] neg_lo:[0,0,1] neg_hi:[0,0,1]
    v_pk_fma_f32 v[88:89], v[88:89], s[34:35], v[4:5] op_sel_hi:[1,0,0] neg_lo:[0,0,1] neg_hi:[0,0,1]
    v_exp_f32 v80, v80
    v_exp_f32 v81, v81
    v_exp_f32 v82, v82
    v_cvt_pk_bf16_f32 v68, v80, v81
    v_exp_f32 v83, v83
    v_exp_f32 v84, v84
    v_cvt_pk_bf16_f32 v69, v82, v83
    v_exp_f32 v85, v85
    v_exp_f32 v86, v86
    v_cvt_pk_bf16_f32 v70, v84, v85
    v_exp_f32 v87, v87
    v_exp_f32 v88, v88
    v_cvt_pk_bf16_f32 v71, v86, v87
    v_exp_f32 v89, v89
    s_waitcnt vmcnt(3)
    v_mfma_f32_16x16x32_bf16 v[76:79], v[28:31], v[68:71], 0
    v_and_b32 v3, 1, v116
    v_cvt_pk_bf16_f32 v72, v88, v89
    v_mfma_f32_16x16x32_bf16 v[100:103], v[120:123], v[68:71], 0
    v_cmp_ne_u32 vcc, s41, v3
    v_cvt_pk_bf16_f32 v73, v88, v89
    v_mfma_f32_16x16x32_bf16 v[104:107], v[124:127], v[68:71], 0
    v_mov_b32 v113, v116
    v_mov_b32 v115, v117
    v_mfma_f32_16x16x16_bf16 v[76:79], v[92:93], v[72:73], v[76:79]
    s_cbranch_vccnz mega_kernel_rs_w1_pv0
mega_kernel_rs_w1_pv2:
    v_mfma_f32_16x16x16_bf16 v[100:103], v[112:113], v[72:73], v[100:103]
    v_mfma_f32_16x16x16_bf16 v[104:107], v[114:115], v[72:73], v[104:107]
    buffer_load_dwordx4 v[120:123], v1, s[4:7], s44 offen
    buffer_load_dwordx4 v[124:127], v1, s[4:7], s44 offen offset:1024
    s_nop 2
    v_rcp_f32 v76, v76
    s_mov_b64 exec, s[28:29]
    v_pk_mul_f32 v[100:101], v[100:101], v[76:77] op_sel_hi:[1,0]
    v_pk_mul_f32 v[102:103], v[102:103], v[76:77] op_sel_hi:[1,0]
    v_pk_mul_f32 v[104:105], v[104:105], v[76:77] op_sel_hi:[1,0]
    v_pk_mul_f32 v[106:107], v[106:107], v[76:77] op_sel_hi:[1,0]
    v_cvt_pk_bf16_f32 v84, v100, v101
    v_cvt_pk_bf16_f32 v85, v102, v103
    v_cvt_pk_bf16_f32 v86, v104, v105
    v_cvt_pk_bf16_f32 v87, v106, v107
    ds_write_b128 v6, v[84:87] offset:28672
    s_mov_b64 exec, -1
    s_waitcnt lgkmcnt(0)
    s_barrier
    ds_read_b128 v[68:71], v6 offset:28672
    ds_read_b128 v[72:75], v6 offset:29696
    s_waitcnt lgkmcnt(1)
    v_smfmac_f32_16x16x64_bf16 v[32:35], v[68:71], v[128:135], v2
    s_add_u32 s21, s21, 1
    s_xor_b32 s38, s38, 1048576
    s_xor_b32 s37, s37, 1048576
    s_waitcnt lgkmcnt(0)
    v_smfmac_f32_16x16x64_bf16 v[32:35], v[72:75], v[136:143], v2
    s_xor_b32 s40, s40, 1048576
    s_xor_b32 s39, s39, 1048576
    s_lshr_b32 s41, s21, 1
    v_smfmac_f32_16x16x64_bf16 v[36:39], v[68:71], v[144:151], v2
    s_and_b32 s41, s41, 1
    s_xor_b32 s41, s41, 1
    s_xor_b32 s35, s35, 16384
    v_smfmac_f32_16x16x64_bf16 v[36:39], v[72:75], v[152:159], v2
    v_add_f32 v32, v32, v34
    s_xor_b32 s36, s36, 16384
    s_add_u32 s43, s43, 262144
    s_add_u32 s44, s44, 262144
    v_smfmac_f32_16x16x64_bf16 v[40:43], v[68:71], v[160:167], v2
    v_add_f32 v33, v33, v35
    v_smfmac_f32_16x16x64_bf16 v[40:43], v[72:75], v[168:175], v2
    v_cvt_pk_bf16_f32 v32, v32, v33
    v_smfmac_f32_16x16x64_bf16 v[44:47], v[68:71], v[176:183], v2
    v_and_or_b32 v32, v32, -2, s42
    v_smfmac_f32_16x16x64_bf16 v[44:47], v[72:75], v[184:191], v2
    v_add_f32 v36, v36, v38
    v_smfmac_f32_16x16x64_bf16 v[48:51], v[68:71], v[192:199], v2
    v_add_f32 v37, v37, v39
    v_smfmac_f32_16x16x64_bf16 v[48:51], v[72:75], v[200:207], v2
    v_cvt_pk_bf16_f32 v33, v36, v37
    v_smfmac_f32_16x16x64_bf16 v[52:55], v[68:71], v[208:215], v2
    v_add_f32 v40, v40, v42
    v_smfmac_f32_16x16x64_bf16 v[52:55], v[72:75], v[216:223], v2
    v_add_f32 v41, v41, v43
    v_smfmac_f32_16x16x64_bf16 v[56:59], v[68:71], v[224:231], v2
    v_cvt_pk_bf16_f32 v34, v40, v41
    v_smfmac_f32_16x16x64_bf16 v[56:59], v[72:75], v[232:239], v2
    v_add_f32 v44, v44, v46
    v_smfmac_f32_16x16x64_bf16 v[60:63], v[68:71], v[240:247], v2
    v_add_f32 v45, v45, v47
    v_smfmac_f32_16x16x64_bf16 v[60:63], v[72:75], v[248:255], v2
    v_cvt_pk_bf16_f32 v35, v44, v45
    buffer_store_dwordx4 v[32:35], v8, s[4:7], s46 offen sc1
    v_pk_add_f32 v[48:49], v[48:49], v[50:51]
    v_cvt_pk_bf16_f32 v48, v48, v49
    v_and_or_b32 v48, v48, -2, s42
    v_pk_add_f32 v[52:53], v[52:53], v[54:55]
    v_cvt_pk_bf16_f32 v49, v52, v53
    v_pk_add_f32 v[56:57], v[56:57], v[58:59]
    v_cvt_pk_bf16_f32 v50, v56, v57
    v_pk_add_f32 v[60:61], v[60:61], v[62:63]
    v_cvt_pk_bf16_f32 v51, v60, v61
    buffer_store_dwordx4 v[48:51], v8, s[4:7], s61 offen sc1
    s_add_u32 s45, s45, 262144
    s_add_u32 s51, s51, 262144
    v_mfma_f32_32x32x8_bf16 v[96:111], v[14:15], v[14:15], 0
    v_mfma_f32_16x16x16_bf16 v[112:115], v[14:15], v[14:15], 0
    v_mfma_f32_16x16x16_bf16 v[116:119], v[14:15], v[14:15], 0
    ds_read_b128 v[64:67], v1 offset:4096
    ds_read_b128 v[68:71], v1 offset:5120
    ds_read_b128 v[72:75], v1 offset:6144
    ds_read_b128 v[76:79], v1 offset:7168
    ds_read_b128 v[80:83], v1 offset:20480
    ds_read_b128 v[84:87], v1 offset:21504
    ds_read_b128 v[88:91], v1 offset:22528
    ds_read_b128 v[92:95], v1 offset:23552
    v_mov_b32 v58, -1
    v_mov_b32 v59, -1
    s_waitcnt vmcnt(0)
mega_kernel_rs_w1_pc:
    buffer_load_dword v36, v13, s[4:7], s25 offen offset:0 sc1
    buffer_load_dword v37, v13, s[4:7], s25 offen offset:256 sc1
    buffer_load_dword v38, v13, s[4:7], s25 offen offset:512 sc1
    buffer_load_dword v39, v13, s[4:7], s25 offen offset:768 sc1
    buffer_load_dword v40, v13, s[4:7], s25 offen offset:1024 sc1
    buffer_load_dword v41, v13, s[4:7], s25 offen offset:1280 sc1
    buffer_load_dword v42, v13, s[4:7], s25 offen offset:1536 sc1
    buffer_load_dword v43, v13, s[4:7], s25 offen offset:1792 sc1
    s_waitcnt vmcnt(4)
    v_mfma_f32_16x16x32_bf16 v[52:55], v[36:39], v[24:27], 0
    v_bitop3_b32 v3, s42, v36, v37 bitop3:0x7e
    v_bitop3_b32 v4, s42, v38, v39 bitop3:0x7e
    s_waitcnt vmcnt(2)
    v_or_b32 v3, v3, v4
    v_bitop3_b32 v4, s42, v40, v41 bitop3:0x7e
    s_waitcnt vmcnt(0)
    v_mfma_f32_16x16x32_bf16 v[52:55], v[40:43], v[24:27], v[52:55]
    v_bitop3_b32 v56, s42, v42, v43 bitop3:0x7e
    v_or3_b32 v3, v3, v4, v56
    v_and_b32 v3, v0, v3
    v_cmp_ne_u32 vcc, 0, v3
    s_nop 3
    v_cvt_pk_bf16_f32 v56, v52, v53
    v_cvt_pk_bf16_f32 v57, v54, v55
    v_min_u32 v56, -2, v56
    s_cbranch_vccnz mega_kernel_rs_w1_pc
    s_mov_b64 exec, s[26:27]
    buffer_store_dwordx2 v[56:57], v9, s[4:7], s35 offen offset:256 sc1
    buffer_store_dwordx2 v[58:59], v9, s[4:7], s36 offen offset:256 sc1
    s_mov_b64 exec, -1
    s_xor_b32 s42, s42, 1
    s_branch mega_kernel_rs_w1_loop
mega_kernel_rs_w1_last:
    buffer_store_dwordx4 v[64:67], v10, s[4:7], s45 offen offset:64 sc1
    buffer_store_dwordx2 v[18:19], v11, s[4:7], s51 offen offset:2560 sc1
    s_branch mega_kernel_rs_end
mega_kernel_rs_w1_pafail:
    s_nop 7
    v_mov_b32 v96, 0
    v_mov_b32 v97, 0
    v_mov_b32 v98, 0
    v_mov_b32 v99, 0
    v_mov_b32 v100, 0
    v_mov_b32 v101, 0
    v_mov_b32 v102, 0
    v_mov_b32 v103, 0
    v_mov_b32 v104, 0
    v_mov_b32 v105, 0
    v_mov_b32 v106, 0
    v_mov_b32 v107, 0
    s_branch mega_kernel_rs_w1_pa
mega_kernel_rs_w1_xslow:
    buffer_load_dwordx2 v[108:109], v11, s[4:7], s38 offen sc1
    buffer_load_dwordx2 v[110:111], v11, s[4:7], s38 offen offset:512 sc1
    s_waitcnt vmcnt(2)
    v_bitop3_b32 v3, s41, v20, v22 bitop3:0x7e
    v_mfma_f32_16x16x16_bf16 v[80:83], v[20:21], v[16:17], v[100:103]
    v_and_b32 v3, 1, v3
    v_mfma_f32_16x16x16_bf16 v[84:87], v[22:23], v[16:17], v[104:107]
    v_cmp_ne_u32 vcc, 0, v3
    s_cbranch_vccz mega_kernel_rs_w1_xgot
    buffer_load_dwordx2 v[20:21], v11, s[4:7], s38 offen sc1
    buffer_load_dwordx2 v[22:23], v11, s[4:7], s38 offen offset:512 sc1
    s_waitcnt vmcnt(2)
    v_bitop3_b32 v3, s41, v108, v110 bitop3:0x7e
    v_mfma_f32_16x16x16_bf16 v[80:83], v[108:109], v[16:17], v[100:103]
    v_and_b32 v3, 1, v3
    v_mfma_f32_16x16x16_bf16 v[84:87], v[110:111], v[16:17], v[104:107]
    v_cmp_ne_u32 vcc, 0, v3
    s_cbranch_vccz mega_kernel_rs_w1_xgot
    s_branch mega_kernel_rs_w1_xslow
mega_kernel_rs_w1_xgot:
    s_nop 3
    v_cvt_pk_bf16_f32 v64, v80, v81
    v_cvt_pk_bf16_f32 v65, v82, v83
    v_cvt_pk_bf16_f32 v66, v84, v85
    v_cvt_pk_bf16_f32 v67, v86, v87
    ds_write_b128 v6, v[64:67] offset:13312
    s_branch mega_kernel_rs_w1_xok
mega_kernel_rs_w1_pv0:
    s_waitcnt vmcnt(2)
    s_branch mega_kernel_rs_w1_pv1
mega_kernel_rs_w1_pv:
    buffer_load_dwordx2 v[20:21], v11, s[4:7], s40 offen sc1
    s_waitcnt vmcnt(0)
mega_kernel_rs_w1_pv1:
    v_and_b32 v3, 1, v20
    v_cmp_ne_u32 vcc, s41, v3
    v_mov_b32 v113, v20
    v_mov_b32 v115, v21
    s_cbranch_vccnz mega_kernel_rs_w1_pv
    s_branch mega_kernel_rs_w1_pv2
mega_kernel_rs_w2_entry:
    v_mfma_f32_32x32x8_bf16 v[96:111], v[14:15], v[14:15], 0
    v_mfma_f32_16x16x16_bf16 v[112:115], v[14:15], v[14:15], 0
    v_mfma_f32_16x16x16_bf16 v[116:119], v[14:15], v[14:15], 0
    ds_read_b128 v[64:67], v1 offset:8192
    ds_read_b128 v[68:71], v1 offset:9216
    ds_read_b128 v[72:75], v1 offset:10240
    ds_read_b128 v[76:79], v1 offset:11264
    ds_read_b128 v[80:83], v1 offset:24576
    ds_read_b128 v[84:87], v1 offset:25600
    ds_read_b128 v[88:91], v1 offset:26624
    ds_read_b128 v[92:95], v1 offset:27648
    buffer_load_dwordx4 v[120:123], v1, s[4:7], s44 offen
    buffer_load_dwordx4 v[124:127], v1, s[4:7], s44 offen offset:1024
    s_add_u32 s44, s44, 262144
mega_kernel_rs_w2_loop:
    s_add_u32 s22, s35, 4096
    s_waitcnt vmcnt(0)
    buffer_load_dwordx4 v[48:51], v1, s[4:7], s22 offen sc1
    buffer_load_dwordx4 v[52:55], v1, s[4:7], s22 offen offset:1024 sc1
mega_kernel_rs_w2_pa:
    s_waitcnt vmcnt(1)
    ds_write_b128 v6, v[48:51] offset:4096
    s_waitcnt vmcnt(0)
    ds_write_b128 v6, v[52:55] offset:5120
    v_max3_u32 v3, v48, v50, v52
    v_max_u32 v3, v3, v54
    v_cmp_eq_u32 vcc, -1, v3
    v_smfmac_f32_16x16x64_bf16 v[96:99], v[48:51], a[64:71], v2
    buffer_load_dwordx4 v[48:51], v1, s[4:7], s22 offen sc1
    v_smfmac_f32_16x16x64_bf16 v[100:103], v[48:51], a[72:79], v2
    buffer_load_dwordx4 v[52:55], v1, s[4:7], s22 offen offset:1024 sc1
    v_smfmac_f32_16x16x64_bf16 v[104:107], v[48:51], a[192:199], v2
    s_cbranch_vccnz mega_kernel_rs_w2_pafail
    s_waitcnt lgkmcnt(0)
    s_barrier
    ds_read_b128 v[56:59], v6 offset:6144
    ds_read_b128 v[60:63], v6 offset:7168
    v_smfmac_f32_16x16x64_bf16 v[108:111], v[48:51], a[200:207], v2
    ds_read_b128 v[32:35], v6 offset:0
    v_smfmac_f32_16x16x64_bf16 v[96:99], v[52:55], a[80:87], v2
    ds_read_b128 v[36:39], v6 offset:1024
    v_smfmac_f32_16x16x64_bf16 v[100:103], v[52:55], a[88:95], v2
    ds_read_b128 v[40:43], v6 offset:2048
    v_smfmac_f32_16x16x64_bf16 v[104:107], v[52:55], a[208:215], v2
    ds_read_b128 v[44:47], v6 offset:3072
    v_smfmac_f32_16x16x64_bf16 v[108:111], v[52:55], a[216:223], v2
    s_waitcnt lgkmcnt(5)
    v_smfmac_f32_16x16x64_bf16 v[96:99], v[56:59], a[96:103], v2
    v_smfmac_f32_16x16x64_bf16 v[104:107], v[56:59], a[224:231], v2
    buffer_load_dwordx4 v1, s[4:7], s43 offen lds
    s_waitcnt lgkmcnt(4)
    v_smfmac_f32_16x16x64_bf16 v[96:99], v[60:63], a[112:119], v2
    v_smfmac_f32_16x16x64_bf16 v[104:107], v[60:63], a[240:247], v2
    s_waitcnt lgkmcnt(3)
    v_smfmac_f32_16x16x64_bf16 v[96:99], v[32:35], a[0:7], v2
    v_smfmac_f32_16x16x64_bf16 v[104:107], v[32:35], a[128:135], v2
    buffer_load_dwordx4 v1, s[4:7], s43 offen offset:1024 lds
    s_waitcnt lgkmcnt(2)
    v_smfmac_f32_16x16x64_bf16 v[96:99], v[36:39], a[16:23], v2
    v_smfmac_f32_16x16x64_bf16 v[104:107], v[36:39], a[144:151], v2
    s_waitcnt lgkmcnt(1)
    v_smfmac_f32_16x16x64_bf16 v[96:99], v[40:43], a[32:39], v2
    v_smfmac_f32_16x16x64_bf16 v[104:107], v[40:43], a[160:167], v2
    s_waitcnt lgkmcnt(0)
    v_smfmac_f32_16x16x64_bf16 v[96:99], v[44:47], a[48:55], v2
    v_smfmac_f32_16x16x64_bf16 v[104:107], v[44:47], a[176:183], v2
    v_smfmac_f32_16x16x64_bf16 v[100:103], v[56:59], a[104:111], v2
    s_nop 2
    v_smfmac_f32_16x16x64_bf16 v[100:103], v[60:63], a[120:127], v2
    s_nop 1
    v_add_f32 v96, v96, v98
    v_smfmac_f32_16x16x64_bf16 v[100:103], v[32:35], a[8:15], v2
    v_add_f32 v97, v97, v99
    v_add_f32 v104, v104, v106
    v_smfmac_f32_16x16x64_bf16 v[100:103], v[36:39], a[24:31], v2
    v_add_f32 v105, v105, v107
    v_cvt_pk_bf16_f32 v96, v96, v97
    v_smfmac_f32_16x16x64_bf16 v[100:103], v[40:43], a[40:47], v2
    v_cvt_pk_bf16_f32 v97, v104, v105
    v_and_or_b32 v96, v96, -2, s41
    v_smfmac_f32_16x16x64_bf16 v[100:103], v[44:47], a[56:63], v2
    buffer_store_dwordx2 v[96:97], v11, s[4:7], s37 offen sc1
    v_smfmac_f32_16x16x64_bf16 v[108:111], v[56:59], a[232:239], v2
    v_smfmac_f32_16x16x64_bf16 v[108:111], v[60:63], a[248:255], v2
    v_smfmac_f32_16x16x64_bf16 v[108:111], v[32:35], a[136:143], v2
    v_smfmac_f32_16x16x64_bf16 v[108:111], v[36:39], a[152:159], v2
    v_smfmac_f32_16x16x64_bf16 v[108:111], v[40:43], a[168:175], v2
    s_nop 2
    v_add_f32 v100, v100, v102
    v_smfmac_f32_16x16x64_bf16 v[108:111], v[44:47], a[184:191], v2
    v_add_f32 v101, v101, v103
    v_cvt_pk_bf16_f32 v98, v100, v101
    v_and_or_b32 v98, v98, -2, s41
    s_nop 4
    v_pk_add_f32 v[108:109], v[108:109], v[110:111]
    v_cvt_pk_bf16_f32 v99, v108, v109
    buffer_store_dwordx2 v[98:99], v11, s[4:7], s37 offen offset:512 sc1
    v_smfmac_f32_16x16x64_bf16 v[112:115], v[32:35], v[64:71], v2
    ds_read_b128 v[64:67], v1 offset:40960
    ds_read_b128 v[68:71], v1 offset:41984
    v_smfmac_f32_16x16x64_bf16 v[116:119], v[32:35], v[72:79], v2
    ds_read_b128 v[72:75], v1 offset:43008
    ds_read_b128 v[76:79], v1 offset:44032
    v_smfmac_f32_16x16x64_bf16 v[112:115], v[36:39], v[80:87], v2
    ds_read_b128 v[80:83], v1 offset:57344
    ds_read_b128 v[84:87], v1 offset:58368
    v_smfmac_f32_16x16x64_bf16 v[116:119], v[36:39], v[88:95], v2
    ds_read_b128 v[88:91], v1 offset:59392
    ds_read_b128 v[92:95], v1 offset:60416
    s_waitcnt lgkmcnt(6)
    v_smfmac_f32_16x16x64_bf16 v[112:115], v[40:43], v[64:71], v2
    ds_read_b128 v[64:67], v5 offset:8192
    ds_read_b128 v[68:71], v5 offset:9216
    s_waitcnt lgkmcnt(6)
    v_smfmac_f32_16x16x64_bf16 v[116:119], v[40:43], v[72:79], v2
    ds_read_b128 v[72:75], v5 offset:10240
    ds_read_b128 v[76:79], v5 offset:11264
    s_waitcnt lgkmcnt(6)
    v_smfmac_f32_16x16x64_bf16 v[112:115], v[44:47], v[80:87], v2
    ds_read_b128 v[80:83], v5 offset:24576
    ds_read_b128 v[84:87], v5 offset:25600
    s_waitcnt lgkmcnt(6)
    v_smfmac_f32_16x16x64_bf16 v[116:119], v[44:47], v[88:95], v2
    ds_read_b128 v[88:91], v5 offset:26624
    ds_read_b128 v[92:95], v5 offset:27648
    s_waitcnt lgkmcnt(6)
    v_smfmac_f32_16x16x64_bf16 v[112:115], v[48:51], v[64:71], v2
    ds_read_b128 v[64:67], v5 offset:40960
    ds_read_b128 v[68:71], v5 offset:41984
    s_waitcnt lgkmcnt(6)
    v_smfmac_f32_16x16x64_bf16 v[116:119], v[48:51], v[72:79], v2
    ds_read_b128 v[72:75], v5 offset:43008
    ds_read_b128 v[76:79], v5 offset:44032
    s_waitcnt lgkmcnt(6)
    v_smfmac_f32_16x16x64_bf16 v[112:115], v[52:55], v[80:87], v2
    ds_read_b128 v[80:83], v5 offset:57344
    ds_read_b128 v[84:87], v5 offset:58368
    s_waitcnt lgkmcnt(6)
    v_smfmac_f32_16x16x64_bf16 v[116:119], v[52:55], v[88:95], v2
    ds_read_b128 v[88:91], v5 offset:59392
    ds_read_b128 v[92:95], v5 offset:60416
    s_waitcnt lgkmcnt(6)
    v_smfmac_f32_16x16x64_bf16 v[112:115], v[56:59], v[64:71], v2
    s_waitcnt lgkmcnt(4)
    v_smfmac_f32_16x16x64_bf16 v[116:119], v[56:59], v[72:79], v2
    s_waitcnt lgkmcnt(2)
    v_smfmac_f32_16x16x64_bf16 v[112:115], v[60:63], v[80:87], v2
    s_waitcnt lgkmcnt(0)
    v_smfmac_f32_16x16x64_bf16 v[116:119], v[60:63], v[88:95], v2
    buffer_load_dwordx2 v[108:109], v11, s[4:7], s38 offen sc1
    v_mfma_f32_16x16x16_bf16 v[100:103], v[96:97], v[16:17], 0
    v_mfma_f32_16x16x16_bf16 v[104:107], v[98:99], v[16:17], 0
    s_nop 4
    v_add_f32 v112, v112, v114
    v_add_f32 v113, v113, v115
    v_add_f32 v114, v116, v118
    v_add_f32 v115, v117, v119
    v_cvt_pk_bf16_f32 v18, v112, v113
    v_cvt_pk_bf16_f32 v19, v114, v115
    v_and_or_b32 v18, v18, -2, s41
    buffer_load_dwordx2 v[110:111], v11, s[4:7], s38 offen offset:512 sc1
    s_barrier
    buffer_store_dwordx2 v[18:19], v11, s[4:7], s39 offen sc1
    v_mov_b32 v112, v18
    v_mov_b32 v114, v19
    v_mov_b32 v92, v28
    v_mov_b32 v93, 0
    s_waitcnt vmcnt(5)
    s_barrier
    ds_read_b128 v[32:35], v6 offset:19456
    ds_read_b128 v[36:39], v6 offset:20480
    ds_read_b128 v[40:43], v6 offset:24576
    ds_read_b128 v[44:47], v6 offset:25600
    ds_read_b128 v[48:51], v6 offset:9216
    ds_read_b128 v[52:55], v6 offset:10240
    ds_read_b128 v[56:59], v6 offset:14336
    ds_read_b128 v[60:63], v6 offset:15360
    buffer_load_dwordx2 v[20:21], v11, s[4:7], s38 offen sc1
    buffer_load_dwordx2 v[22:23], v11, s[4:7], s38 offen offset:512 sc1
    s_waitcnt vmcnt(4)
    v_mfma_f32_16x16x16_bf16 v[80:83], v[108:109], v[16:17], v[100:103]
    v_and_b32 v3, 1, v108
    v_cmp_ne_u32 vcc, s41, v3
    s_nop 5
    v_cvt_pk_bf16_f32 v64, v80, v81
    v_cvt_pk_bf16_f32 v65, v82, v83
    s_cbranch_vccnz mega_kernel_rs_w2_xslow
    s_waitcnt vmcnt(3)
    v_mfma_f32_16x16x16_bf16 v[84:87], v[110:111], v[16:17], v[104:107]
    v_and_b32 v3, 1, v110
    v_cmp_ne_u32 vcc, s41, v3
    s_nop 5
    v_cvt_pk_bf16_f32 v66, v84, v85
    v_cvt_pk_bf16_f32 v67, v86, v87
    ds_write_b128 v6, v[64:67] offset:18432
    s_cbranch_vccnz mega_kernel_rs_w2_xslow
mega_kernel_rs_w2_xok:
    s_cmp_eq_u32 s21, 63
    s_cbranch_scc1 mega_kernel_rs_w2_last
    buffer_load_dwordx2 v[116:117], v11, s[4:7], s40 offen sc1
    s_waitcnt lgkmcnt(1)
    v_mfma_f32_16x16x32_bf16 v[80:83], v[32:35], v[64:67], 0
    s_waitcnt lgkmcnt(0)
    s_barrier
    ds_read_b128 v[68:71], v6 offset:23552
    ds_read_b128 v[72:75], v6 offset:8192
    ds_read_b128 v[76:79], v6 offset:13312
    v_mfma_f32_16x16x32_bf16 v[84:87], v[36:39], v[64:67], 0
    v_mfma_f32_16x16x32_bf16 v[88:91], v[64:67], v[64:67], 0
    buffer_load_dwordx2 v[20:21], v11, s[4:7], s40 offen sc1
    s_waitcnt lgkmcnt(2)
    v_mfma_f32_16x16x32_bf16 v[80:83], v[40:43], v[68:71], v[80:83]
    s_waitcnt lgkmcnt(1)
    v_mfma_f32_16x16x32_bf16 v[80:83], v[48:51], v[72:75], v[80:83]
    s_waitcnt lgkmcnt(0)
    v_mfma_f32_16x16x32_bf16 v[80:83], v[56:59], v[76:79], v[80:83]
    buffer_store_dwordx4 v[64:67], v10, s[4:7], s45 offen offset:128 sc1
    v_mfma_f32_16x16x32_bf16 v[84:87], v[44:47], v[68:71], v[84:87]
    v_mfma_f32_16x16x32_bf16 v[84:87], v[52:55], v[72:75], v[84:87]
    v_mfma_f32_16x16x32_bf16 v[84:87], v[60:63], v[76:79], v[84:87]
    v_mfma_f32_16x16x32_bf16 v[88:91], v[68:71], v[68:71], v[88:91]
    buffer_store_dwordx2 v[18:19], v11, s[4:7], s51 offen offset:3072 sc1
    v_mfma_f32_16x16x32_bf16 v[88:91], v[72:75], v[72:75], v[88:91]
    v_mfma_f32_16x16x32_bf16 v[88:91], v[76:79], v[76:79], v[88:91]
    v_mfma_f32_32x32x4_2b_bf16 v[32:63], v[14:15], v[14:15], 0
    s_nop 0
    v_max3_f32 v4, v80, v81, v82
    s_nop 1
    v_max3_f32 v4, v4, v83, v84
    v_max3_f32 v4, v4, v85, v86
    v_max_f32 v4, v4, v87
    v_max3_f32 v90, v4, v88, v89
    v_max3_f32 v4, v4, v88, v89
    s_nop 1
    v_permlane16_swap_b32 v4, v90
    v_max_f32 v4, v4, v90
    v_max_f32 v90, v4, v90
    s_nop 1
    v_permlane32_swap_b32 v4, v90
    v_max_f32 v4, v4, v90
    v_mul_f32 v4, s34, v4
    v_pk_fma_f32 v[80:81], v[80:81], s[34:35], v[4:5] op_sel_hi:[1,0,0] neg_lo:[0,0,1] neg_hi:[0,0,1]
    v_pk_fma_f32 v[82:83], v[82:83], s[34:35], v[4:5] op_sel_hi:[1,0,0] neg_lo:[0,0,1] neg_hi:[0,0,1]
    v_pk_fma_f32 v[84:85], v[84:85], s[34:35], v[4:5] op_sel_hi:[1,0,0] neg_lo:[0,0,1] neg_hi:[0,0,1]
    v_pk_fma_f32 v[86:87], v[86:87], s[34:35], v[4:5] op_sel_hi:[1,0,0] neg_lo:[0,0,1] neg_hi:[0,0,1]
    v_pk_fma_f32 v[88:89], v[88:89], s[34:35], v[4:5] op_sel_hi:[1,0,0] neg_lo:[0,0,1] neg_hi:[0,0,1]
    v_exp_f32 v80, v80
    v_exp_f32 v81, v81
    v_exp_f32 v82, v82
    v_cvt_pk_bf16_f32 v68, v80, v81
    v_exp_f32 v83, v83
    v_exp_f32 v84, v84
    v_cvt_pk_bf16_f32 v69, v82, v83
    v_exp_f32 v85, v85
    v_exp_f32 v86, v86
    v_cvt_pk_bf16_f32 v70, v84, v85
    v_exp_f32 v87, v87
    v_exp_f32 v88, v88
    v_cvt_pk_bf16_f32 v71, v86, v87
    v_exp_f32 v89, v89
    s_waitcnt vmcnt(3)
    v_mfma_f32_16x16x32_bf16 v[76:79], v[28:31], v[68:71], 0
    v_and_b32 v3, 1, v116
    v_cvt_pk_bf16_f32 v72, v88, v89
    v_mfma_f32_16x16x32_bf16 v[100:103], v[120:123], v[68:71], 0
    v_cmp_ne_u32 vcc, s41, v3
    v_cvt_pk_bf16_f32 v73, v88, v89
    v_mfma_f32_16x16x32_bf16 v[104:107], v[124:127], v[68:71], 0
    v_mov_b32 v113, v116
    v_mov_b32 v115, v117
    v_mfma_f32_16x16x16_bf16 v[76:79], v[92:93], v[72:73], v[76:79]
    s_cbranch_vccnz mega_kernel_rs_w2_pv0
mega_kernel_rs_w2_pv2:
    v_mfma_f32_16x16x16_bf16 v[100:103], v[112:113], v[72:73], v[100:103]
    v_mfma_f32_16x16x16_bf16 v[104:107], v[114:115], v[72:73], v[104:107]
    buffer_load_dwordx4 v[120:123], v1, s[4:7], s44 offen
    buffer_load_dwordx4 v[124:127], v1, s[4:7], s44 offen offset:1024
    s_nop 2
    v_rcp_f32 v76, v76
    s_mov_b64 exec, s[28:29]
    v_pk_mul_f32 v[100:101], v[100:101], v[76:77] op_sel_hi:[1,0]
    v_pk_mul_f32 v[102:103], v[102:103], v[76:77] op_sel_hi:[1,0]
    v_pk_mul_f32 v[104:105], v[104:105], v[76:77] op_sel_hi:[1,0]
    v_pk_mul_f32 v[106:107], v[106:107], v[76:77] op_sel_hi:[1,0]
    v_cvt_pk_bf16_f32 v84, v100, v101
    v_cvt_pk_bf16_f32 v85, v102, v103
    v_cvt_pk_bf16_f32 v86, v104, v105
    v_cvt_pk_bf16_f32 v87, v106, v107
    ds_write_b128 v6, v[84:87] offset:29664
    s_mov_b64 exec, -1
    s_waitcnt lgkmcnt(0)
    s_barrier
    ds_read_b128 v[68:71], v6 offset:28672
    ds_read_b128 v[72:75], v6 offset:29696
    s_waitcnt lgkmcnt(1)
    v_smfmac_f32_16x16x64_bf16 v[32:35], v[68:71], v[128:135], v2
    s_add_u32 s21, s21, 1
    s_xor_b32 s38, s38, 1048576
    s_xor_b32 s37, s37, 1048576
    s_waitcnt lgkmcnt(0)
    v_smfmac_f32_16x16x64_bf16 v[32:35], v[72:75], v[136:143], v2
    s_xor_b32 s40, s40, 1048576
    s_xor_b32 s39, s39, 1048576
    s_lshr_b32 s41, s21, 1
    v_smfmac_f32_16x16x64_bf16 v[36:39], v[68:71], v[144:151], v2
    s_and_b32 s41, s41, 1
    s_xor_b32 s41, s41, 1
    s_xor_b32 s35, s35, 16384
    v_smfmac_f32_16x16x64_bf16 v[36:39], v[72:75], v[152:159], v2
    v_add_f32 v32, v32, v34
    s_xor_b32 s36, s36, 16384
    s_add_u32 s43, s43, 262144
    s_add_u32 s44, s44, 262144
    v_smfmac_f32_16x16x64_bf16 v[40:43], v[68:71], v[160:167], v2
    v_add_f32 v33, v33, v35
    v_smfmac_f32_16x16x64_bf16 v[40:43], v[72:75], v[168:175], v2
    v_cvt_pk_bf16_f32 v32, v32, v33
    v_smfmac_f32_16x16x64_bf16 v[44:47], v[68:71], v[176:183], v2
    v_and_or_b32 v32, v32, -2, s42
    v_smfmac_f32_16x16x64_bf16 v[44:47], v[72:75], v[184:191], v2
    v_add_f32 v36, v36, v38
    v_smfmac_f32_16x16x64_bf16 v[48:51], v[68:71], v[192:199], v2
    v_add_f32 v37, v37, v39
    v_smfmac_f32_16x16x64_bf16 v[48:51], v[72:75], v[200:207], v2
    v_cvt_pk_bf16_f32 v33, v36, v37
    v_smfmac_f32_16x16x64_bf16 v[52:55], v[68:71], v[208:215], v2
    v_add_f32 v40, v40, v42
    v_smfmac_f32_16x16x64_bf16 v[52:55], v[72:75], v[216:223], v2
    v_add_f32 v41, v41, v43
    v_smfmac_f32_16x16x64_bf16 v[56:59], v[68:71], v[224:231], v2
    v_cvt_pk_bf16_f32 v34, v40, v41
    v_smfmac_f32_16x16x64_bf16 v[56:59], v[72:75], v[232:239], v2
    v_add_f32 v44, v44, v46
    v_smfmac_f32_16x16x64_bf16 v[60:63], v[68:71], v[240:247], v2
    v_add_f32 v45, v45, v47
    v_smfmac_f32_16x16x64_bf16 v[60:63], v[72:75], v[248:255], v2
    v_cvt_pk_bf16_f32 v35, v44, v45
    buffer_store_dwordx4 v[32:35], v8, s[4:7], s46 offen sc1
    v_pk_add_f32 v[48:49], v[48:49], v[50:51]
    v_cvt_pk_bf16_f32 v48, v48, v49
    v_and_or_b32 v48, v48, -2, s42
    v_pk_add_f32 v[52:53], v[52:53], v[54:55]
    v_cvt_pk_bf16_f32 v49, v52, v53
    v_pk_add_f32 v[56:57], v[56:57], v[58:59]
    v_cvt_pk_bf16_f32 v50, v56, v57
    v_pk_add_f32 v[60:61], v[60:61], v[62:63]
    v_cvt_pk_bf16_f32 v51, v60, v61
    buffer_store_dwordx4 v[48:51], v8, s[4:7], s61 offen sc1
    s_add_u32 s45, s45, 262144
    s_add_u32 s51, s51, 262144
    v_mfma_f32_32x32x8_bf16 v[96:111], v[14:15], v[14:15], 0
    v_mfma_f32_16x16x16_bf16 v[112:115], v[14:15], v[14:15], 0
    v_mfma_f32_16x16x16_bf16 v[116:119], v[14:15], v[14:15], 0
    ds_read_b128 v[64:67], v1 offset:8192
    ds_read_b128 v[68:71], v1 offset:9216
    ds_read_b128 v[72:75], v1 offset:10240
    ds_read_b128 v[76:79], v1 offset:11264
    ds_read_b128 v[80:83], v1 offset:24576
    ds_read_b128 v[84:87], v1 offset:25600
    ds_read_b128 v[88:91], v1 offset:26624
    ds_read_b128 v[92:95], v1 offset:27648
    v_mov_b32 v58, -1
    v_mov_b32 v59, -1
    s_waitcnt vmcnt(0)
mega_kernel_rs_w2_pc:
    buffer_load_dword v36, v13, s[4:7], s25 offen offset:0 sc1
    buffer_load_dword v37, v13, s[4:7], s25 offen offset:256 sc1
    buffer_load_dword v38, v13, s[4:7], s25 offen offset:512 sc1
    buffer_load_dword v39, v13, s[4:7], s25 offen offset:768 sc1
    buffer_load_dword v40, v13, s[4:7], s25 offen offset:1024 sc1
    buffer_load_dword v41, v13, s[4:7], s25 offen offset:1280 sc1
    buffer_load_dword v42, v13, s[4:7], s25 offen offset:1536 sc1
    buffer_load_dword v43, v13, s[4:7], s25 offen offset:1792 sc1
    s_waitcnt vmcnt(4)
    v_mfma_f32_16x16x32_bf16 v[52:55], v[36:39], v[24:27], 0
    v_bitop3_b32 v3, s42, v36, v37 bitop3:0x7e
    v_bitop3_b32 v4, s42, v38, v39 bitop3:0x7e
    s_waitcnt vmcnt(2)
    v_or_b32 v3, v3, v4
    v_bitop3_b32 v4, s42, v40, v41 bitop3:0x7e
    s_waitcnt vmcnt(0)
    v_mfma_f32_16x16x32_bf16 v[52:55], v[40:43], v[24:27], v[52:55]
    v_bitop3_b32 v56, s42, v42, v43 bitop3:0x7e
    v_or3_b32 v3, v3, v4, v56
    v_and_b32 v3, v0, v3
    v_cmp_ne_u32 vcc, 0, v3
    s_nop 3
    v_cvt_pk_bf16_f32 v56, v52, v53
    v_cvt_pk_bf16_f32 v57, v54, v55
    v_min_u32 v56, -2, v56
    s_cbranch_vccnz mega_kernel_rs_w2_pc
    s_mov_b64 exec, s[26:27]
    buffer_store_dwordx2 v[56:57], v9, s[4:7], s35 offen offset:512 sc1
    buffer_store_dwordx2 v[58:59], v9, s[4:7], s36 offen offset:512 sc1
    s_mov_b64 exec, -1
    s_xor_b32 s42, s42, 1
    s_branch mega_kernel_rs_w2_loop
mega_kernel_rs_w2_last:
    buffer_store_dwordx4 v[64:67], v10, s[4:7], s45 offen offset:128 sc1
    buffer_store_dwordx2 v[18:19], v11, s[4:7], s51 offen offset:3072 sc1
    s_branch mega_kernel_rs_end
mega_kernel_rs_w2_pafail:
    s_nop 7
    v_mov_b32 v96, 0
    v_mov_b32 v97, 0
    v_mov_b32 v98, 0
    v_mov_b32 v99, 0
    v_mov_b32 v100, 0
    v_mov_b32 v101, 0
    v_mov_b32 v102, 0
    v_mov_b32 v103, 0
    v_mov_b32 v104, 0
    v_mov_b32 v105, 0
    v_mov_b32 v106, 0
    v_mov_b32 v107, 0
    s_branch mega_kernel_rs_w2_pa
mega_kernel_rs_w2_xslow:
    buffer_load_dwordx2 v[108:109], v11, s[4:7], s38 offen sc1
    buffer_load_dwordx2 v[110:111], v11, s[4:7], s38 offen offset:512 sc1
    s_waitcnt vmcnt(2)
    v_bitop3_b32 v3, s41, v20, v22 bitop3:0x7e
    v_mfma_f32_16x16x16_bf16 v[80:83], v[20:21], v[16:17], v[100:103]
    v_and_b32 v3, 1, v3
    v_mfma_f32_16x16x16_bf16 v[84:87], v[22:23], v[16:17], v[104:107]
    v_cmp_ne_u32 vcc, 0, v3
    s_cbranch_vccz mega_kernel_rs_w2_xgot
    buffer_load_dwordx2 v[20:21], v11, s[4:7], s38 offen sc1
    buffer_load_dwordx2 v[22:23], v11, s[4:7], s38 offen offset:512 sc1
    s_waitcnt vmcnt(2)
    v_bitop3_b32 v3, s41, v108, v110 bitop3:0x7e
    v_mfma_f32_16x16x16_bf16 v[80:83], v[108:109], v[16:17], v[100:103]
    v_and_b32 v3, 1, v3
    v_mfma_f32_16x16x16_bf16 v[84:87], v[110:111], v[16:17], v[104:107]
    v_cmp_ne_u32 vcc, 0, v3
    s_cbranch_vccz mega_kernel_rs_w2_xgot
    s_branch mega_kernel_rs_w2_xslow
mega_kernel_rs_w2_xgot:
    s_nop 3
    v_cvt_pk_bf16_f32 v64, v80, v81
    v_cvt_pk_bf16_f32 v65, v82, v83
    v_cvt_pk_bf16_f32 v66, v84, v85
    v_cvt_pk_bf16_f32 v67, v86, v87
    ds_write_b128 v6, v[64:67] offset:18432
    s_branch mega_kernel_rs_w2_xok
mega_kernel_rs_w2_pv0:
    s_waitcnt vmcnt(2)
    s_branch mega_kernel_rs_w2_pv1
mega_kernel_rs_w2_pv:
    buffer_load_dwordx2 v[20:21], v11, s[4:7], s40 offen sc1
    s_waitcnt vmcnt(0)
mega_kernel_rs_w2_pv1:
    v_and_b32 v3, 1, v20
    v_cmp_ne_u32 vcc, s41, v3
    v_mov_b32 v113, v20
    v_mov_b32 v115, v21
    s_cbranch_vccnz mega_kernel_rs_w2_pv
    s_branch mega_kernel_rs_w2_pv2
mega_kernel_rs_w3_entry:
    v_mfma_f32_32x32x8_bf16 v[96:111], v[14:15], v[14:15], 0
    v_mfma_f32_16x16x16_bf16 v[112:115], v[14:15], v[14:15], 0
    v_mfma_f32_16x16x16_bf16 v[116:119], v[14:15], v[14:15], 0
    ds_read_b128 v[64:67], v1 offset:12288
    ds_read_b128 v[68:71], v1 offset:13312
    ds_read_b128 v[72:75], v1 offset:14336
    ds_read_b128 v[76:79], v1 offset:15360
    ds_read_b128 v[80:83], v1 offset:28672
    ds_read_b128 v[84:87], v1 offset:29696
    ds_read_b128 v[88:91], v1 offset:30720
    ds_read_b128 v[92:95], v1 offset:31744
    buffer_load_dwordx4 v[120:123], v1, s[4:7], s44 offen
    buffer_load_dwordx4 v[124:127], v1, s[4:7], s44 offen offset:1024
    s_add_u32 s44, s44, 262144
mega_kernel_rs_w3_loop:
    s_add_u32 s22, s35, 6144
    s_waitcnt vmcnt(0)
    buffer_load_dwordx4 v[56:59], v1, s[4:7], s22 offen sc1
    buffer_load_dwordx4 v[60:63], v1, s[4:7], s22 offen offset:1024 sc1
mega_kernel_rs_w3_pa:
    s_waitcnt vmcnt(1)
    ds_write_b128 v6, v[56:59] offset:6144
    s_waitcnt vmcnt(0)
    ds_write_b128 v6, v[60:63] offset:7168
    v_max3_u32 v3, v56, v58, v60
    v_max_u32 v3, v3, v62
    v_cmp_eq_u32 vcc, -1, v3
    v_smfmac_f32_16x16x64_bf16 v[96:99], v[56:59], a[96:103], v2
    buffer_load_dwordx4 v[56:59], v1, s[4:7], s22 offen sc1
    v_smfmac_f32_16x16x64_bf16 v[100:103], v[56:59], a[104:111], v2
    buffer_load_dwordx4 v[60:63], v1, s[4:7], s22 offen offset:1024 sc1
    v_smfmac_f32_16x16x64_bf16 v[104:107], v[56:59], a[224:231], v2
    s_cbranch_vccnz mega_kernel_rs_w3_pafail
    s_waitcnt lgkmcnt(0)
    s_barrier
    ds_read_b128 v[32:35], v6 offset:0
    ds_read_b128 v[36:39], v6 offset:1024
    v_smfmac_f32_16x16x64_bf16 v[108:111], v[56:59], a[232:239], v2
    ds_read_b128 v[40:43], v6 offset:2048
    v_smfmac_f32_16x16x64_bf16 v[96:99], v[60:63], a[112:119], v2
    ds_read_b128 v[44:47], v6 offset:3072
    v_smfmac_f32_16x16x64_bf16 v[100:103], v[60:63], a[120:127], v2
    ds_read_b128 v[48:51], v6 offset:4096
    v_smfmac_f32_16x16x64_bf16 v[104:107], v[60:63], a[240:247], v2
    ds_read_b128 v[52:55], v6 offset:5120
    v_smfmac_f32_16x16x64_bf16 v[108:111], v[60:63], a[248:255], v2
    s_waitcnt lgkmcnt(5)
    v_smfmac_f32_16x16x64_bf16 v[96:99], v[32:35], a[0:7], v2
    v_smfmac_f32_16x16x64_bf16 v[104:107], v[32:35], a[128:135], v2
    s_waitcnt lgkmcnt(4)
    v_smfmac_f32_16x16x64_bf16 v[96:99], v[36:39], a[16:23], v2
    buffer_load_dwordx4 v1, s[4:7], s43 offen lds
    v_smfmac_f32_16x16x64_bf16 v[104:107], v[36:39], a[144:151], v2
    s_waitcnt lgkmcnt(3)
    v_smfmac_f32_16x16x64_bf16 v[96:99], v[40:43], a[32:39], v2
    v_smfmac_f32_16x16x64_bf16 v[104:107], v[40:43], a[160:167], v2
    s_waitcnt lgkmcnt(2)
    v_smfmac_f32_16x16x64_bf16 v[96:99], v[44:47], a[48:55], v2
    buffer_load_dwordx4 v1, s[4:7], s43 offen offset:1024 lds
    v_smfmac_f32_16x16x64_bf16 v[104:107], v[44:47], a[176:183], v2
    s_waitcnt lgkmcnt(1)
    v_smfmac_f32_16x16x64_bf16 v[96:99], v[48:51], a[64:71], v2
    v_smfmac_f32_16x16x64_bf16 v[104:107], v[48:51], a[192:199], v2
    s_waitcnt lgkmcnt(0)
    v_smfmac_f32_16x16x64_bf16 v[96:99], v[52:55], a[80:87], v2
    buffer_load_dword v12, v7, s[4:7], 0 offen sc1
    v_smfmac_f32_16x16x64_bf16 v[104:107], v[52:55], a[208:215], v2
    v_smfmac_f32_16x16x64_bf16 v[100:103], v[32:35], a[8:15], v2
    s_nop 2
    v_smfmac_f32_16x16x64_bf16 v[100:103], v[36:39], a[24:31], v2
    s_nop 1
    v_add_f32 v96, v96, v98
    v_smfmac_f32_16x16x64_bf16 v[100:103], v[40:43], a[40:47], v2
    v_add_f32 v97, v97, v99
    v_add_f32 v104, v104, v106
    v_smfmac_f32_16x16x64_bf16 v[100:103], v[44:47], a[56:63], v2
    v_add_f32 v105, v105, v107
    v_cvt_pk_bf16_f32 v96, v96, v97
    v_smfmac_f32_16x16x64_bf16 v[100:103], v[48:51], a[72:79], v2
    v_cvt_pk_bf16_f32 v97, v104, v105
    v_and_or_b32 v96, v96, -2, s41
    v_smfmac_f32_16x16x64_bf16 v[100:103], v[52:55], a[88:95], v2
    buffer_store_dwordx2 v[96:97], v11, s[4:7], s37 offen sc1
    v_smfmac_f32_16x16x64_bf16 v[108:111], v[32:35], a[136:143], v2
    v_smfmac_f32_16x16x64_bf16 v[108:111], v[36:39], a[152:159], v2
    v_smfmac_f32_16x16x64_bf16 v[108:111], v[40:43], a[168:175], v2
    v_smfmac_f32_16x16x64_bf16 v[108:111], v[44:47], a[184:191], v2
    v_smfmac_f32_16x16x64_bf16 v[108:111], v[48:51], a[200:207], v2
    s_nop 2
    v_add_f32 v100, v100, v102
    v_smfmac_f32_16x16x64_bf16 v[108:111], v[52:55], a[216:223], v2
    v_add_f32 v101, v101, v103
    v_cvt_pk_bf16_f32 v98, v100, v101
    v_and_or_b32 v98, v98, -2, s41
    s_nop 4
    v_pk_add_f32 v[108:109], v[108:109], v[110:111]
    v_cvt_pk_bf16_f32 v99, v108, v109
    buffer_store_dwordx2 v[98:99], v11, s[4:7], s37 offen offset:512 sc1
    v_smfmac_f32_16x16x64_bf16 v[112:115], v[32:35], v[64:71], v2
    ds_read_b128 v[64:67], v1 offset:45056
    ds_read_b128 v[68:71], v1 offset:46080
    v_smfmac_f32_16x16x64_bf16 v[116:119], v[32:35], v[72:79], v2
    ds_read_b128 v[72:75], v1 offset:47104
    ds_read_b128 v[76:79], v1 offset:48128
    v_smfmac_f32_16x16x64_bf16 v[112:115], v[36:39], v[80:87], v2
    ds_read_b128 v[80:83], v1 offset:61440
    ds_read_b128 v[84:87], v1 offset:62464
    v_smfmac_f32_16x16x64_bf16 v[116:119], v[36:39], v[88:95], v2
    ds_read_b128 v[88:91], v1 offset:63488
    ds_read_b128 v[92:95], v1 offset:64512
    s_waitcnt lgkmcnt(6)
    v_smfmac_f32_16x16x64_bf16 v[112:115], v[40:43], v[64:71], v2
    ds_read_b128 v[64:67], v5 offset:12288
    ds_read_b128 v[68:71], v5 offset:13312
    s_waitcnt lgkmcnt(6)
    v_smfmac_f32_16x16x64_bf16 v[116:119], v[40:43], v[72:79], v2
    ds_read_b128 v[72:75], v5 offset:14336
    ds_read_b128 v[76:79], v5 offset:15360
    s_waitcnt lgkmcnt(6)
    v_smfmac_f32_16x16x64_bf16 v[112:115], v[44:47], v[80:87], v2
    ds_read_b128 v[80:83], v5 offset:28672
    ds_read_b128 v[84:87], v5 offset:29696
    s_waitcnt lgkmcnt(6)
    v_smfmac_f32_16x16x64_bf16 v[116:119], v[44:47], v[88:95], v2
    ds_read_b128 v[88:91], v5 offset:30720
    ds_read_b128 v[92:95], v5 offset:31744
    s_waitcnt lgkmcnt(6)
    v_smfmac_f32_16x16x64_bf16 v[112:115], v[48:51], v[64:71], v2
    ds_read_b128 v[64:67], v5 offset:45056
    ds_read_b128 v[68:71], v5 offset:46080
    s_waitcnt lgkmcnt(6)
    v_smfmac_f32_16x16x64_bf16 v[116:119], v[48:51], v[72:79], v2
    ds_read_b128 v[72:75], v5 offset:47104
    ds_read_b128 v[76:79], v5 offset:48128
    s_waitcnt lgkmcnt(6)
    v_smfmac_f32_16x16x64_bf16 v[112:115], v[52:55], v[80:87], v2
    ds_read_b128 v[80:83], v5 offset:61440
    ds_read_b128 v[84:87], v5 offset:62464
    s_waitcnt lgkmcnt(6)
    v_smfmac_f32_16x16x64_bf16 v[116:119], v[52:55], v[88:95], v2
    ds_read_b128 v[88:91], v5 offset:63488
    ds_read_b128 v[92:95], v5 offset:64512
    s_waitcnt lgkmcnt(6)
    v_smfmac_f32_16x16x64_bf16 v[112:115], v[56:59], v[64:71], v2
    s_waitcnt lgkmcnt(4)
    v_smfmac_f32_16x16x64_bf16 v[116:119], v[56:59], v[72:79], v2
    s_waitcnt lgkmcnt(2)
    v_smfmac_f32_16x16x64_bf16 v[112:115], v[60:63], v[80:87], v2
    s_waitcnt lgkmcnt(0)
    v_smfmac_f32_16x16x64_bf16 v[116:119], v[60:63], v[88:95], v2
    buffer_load_dwordx2 v[108:109], v11, s[4:7], s38 offen sc1
    v_mfma_f32_16x16x16_bf16 v[100:103], v[96:97], v[16:17], 0
    v_mfma_f32_16x16x16_bf16 v[104:107], v[98:99], v[16:17], 0
    s_nop 4
    v_add_f32 v112, v112, v114
    v_add_f32 v113, v113, v115
    v_add_f32 v114, v116, v118
    v_add_f32 v115, v117, v119
    v_cvt_pk_bf16_f32 v18, v112, v113
    v_cvt_pk_bf16_f32 v19, v114, v115
    v_and_or_b32 v18, v18, -2, s41
    buffer_load_dwordx2 v[110:111], v11, s[4:7], s38 offen offset:512 sc1
    s_barrier
    buffer_store_dwordx2 v[18:19], v11, s[4:7], s39 offen sc1
    v_mov_b32 v112, v18
    v_mov_b32 v114, v19
    v_mov_b32 v92, v28
    v_mov_b32 v93, 0
    s_waitcnt vmcnt(6)
    s_barrier
    ds_read_b128 v[32:35], v6 offset:24576
    ds_read_b128 v[36:39], v6 offset:25600
    ds_read_b128 v[40:43], v6 offset:19456
    ds_read_b128 v[44:47], v6 offset:20480
    ds_read_b128 v[48:51], v6 offset:14336
    ds_read_b128 v[52:55], v6 offset:15360
    ds_read_b128 v[56:59], v6 offset:9216
    ds_read_b128 v[60:63], v6 offset:10240
    buffer_load_dwordx2 v[20:21], v11, s[4:7], s38 offen sc1
    buffer_load_dwordx2 v[22:23], v11, s[4:7], s38 offen offset:512 sc1
    s_waitcnt vmcnt(4)
    v_mfma_f32_16x16x16_bf16 v[80:83], v[108:109], v[16:17], v[100:103]
    v_and_b32 v3, 1, v108
    v_cmp_ne_u32 vcc, s41, v3
    s_nop 5
    v_cvt_pk_bf16_f32 v64, v80, v81
    v_cvt_pk_bf16_f32 v65, v82, v83
    s_cbranch_vccnz mega_kernel_rs_w3_xslow
    s_waitcnt vmcnt(3)
    v_mfma_f32_16x16x16_bf16 v[84:87], v[110:111], v[16:17], v[104:107]
    v_and_b32 v3, 1, v110
    v_cmp_ne_u32 vcc, s41, v3
    s_nop 5
    v_cvt_pk_bf16_f32 v66, v84, v85
    v_cvt_pk_bf16_f32 v67, v86, v87
    ds_write_b128 v6, v[64:67] offset:23552
    s_cbranch_vccnz mega_kernel_rs_w3_xslow
mega_kernel_rs_w3_xok:
    s_cmp_eq_u32 s21, 63
    s_cbranch_scc1 mega_kernel_rs_w3_last
    buffer_load_dwordx2 v[116:117], v11, s[4:7], s40 offen sc1
    s_waitcnt lgkmcnt(1)
    v_mfma_f32_16x16x32_bf16 v[80:83], v[32:35], v[64:67], 0
    s_waitcnt lgkmcnt(0)
    s_barrier
    ds_read_b128 v[68:71], v6 offset:18432
    ds_read_b128 v[72:75], v6 offset:13312
    ds_read_b128 v[76:79], v6 offset:8192
    v_mfma_f32_16x16x32_bf16 v[84:87], v[36:39], v[64:67], 0
    v_mfma_f32_16x16x32_bf16 v[88:91], v[64:67], v[64:67], 0
    buffer_load_dwordx2 v[20:21], v11, s[4:7], s40 offen sc1
    s_waitcnt lgkmcnt(2)
    v_mfma_f32_16x16x32_bf16 v[80:83], v[40:43], v[68:71], v[80:83]
    s_waitcnt lgkmcnt(1)
    v_mfma_f32_16x16x32_bf16 v[80:83], v[48:51], v[72:75], v[80:83]
    s_waitcnt lgkmcnt(0)
    v_mfma_f32_16x16x32_bf16 v[80:83], v[56:59], v[76:79], v[80:83]
    v_mfma_f32_16x16x32_bf16 v[84:87], v[44:47], v[68:71], v[84:87]
    buffer_store_dwordx4 v[64:67], v10, s[4:7], s45 offen offset:192 sc1
    v_mfma_f32_16x16x32_bf16 v[84:87], v[52:55], v[72:75], v[84:87]
    v_mfma_f32_16x16x32_bf16 v[84:87], v[60:63], v[76:79], v[84:87]
    v_mfma_f32_16x16x32_bf16 v[88:91], v[68:71], v[68:71], v[88:91]
    v_mfma_f32_16x16x32_bf16 v[88:91], v[72:75], v[72:75], v[88:91]
    buffer_store_dwordx2 v[18:19], v11, s[4:7], s51 offen offset:3584 sc1
    v_mfma_f32_16x16x32_bf16 v[88:91], v[76:79], v[76:79], v[88:91]
    v_mfma_f32_32x32x4_2b_bf16 v[32:63], v[14:15], v[14:15], 0
    s_nop 0
    v_max3_f32 v4, v80, v81, v82
    s_nop 1
    v_max3_f32 v4, v4, v83, v84
    v_max3_f32 v4, v4, v85, v86
    v_max_f32 v4, v4, v87
    v_max3_f32 v90, v4, v88, v89
    v_max3_f32 v4, v4, v88, v89
    s_nop 1
    v_permlane16_swap_b32 v4, v90
    v_max_f32 v4, v4, v90
    v_max_f32 v90, v4, v90
    s_nop 1
    v_permlane32_swap_b32 v4, v90
    v_max_f32 v4, v4, v90
    v_mul_f32 v4, s34, v4
    v_pk_fma_f32 v[80:81], v[80:81], s[34:35], v[4:5] op_sel_hi:[1,0,0] neg_lo:[0,0,1] neg_hi:[0,0,1]
    v_pk_fma_f32 v[82:83], v[82:83], s[34:35], v[4:5] op_sel_hi:[1,0,0] neg_lo:[0,0,1] neg_hi:[0,0,1]
    v_pk_fma_f32 v[84:85], v[84:85], s[34:35], v[4:5] op_sel_hi:[1,0,0] neg_lo:[0,0,1] neg_hi:[0,0,1]
    v_pk_fma_f32 v[86:87], v[86:87], s[34:35], v[4:5] op_sel_hi:[1,0,0] neg_lo:[0,0,1] neg_hi:[0,0,1]
    v_pk_fma_f32 v[88:89], v[88:89], s[34:35], v[4:5] op_sel_hi:[1,0,0] neg_lo:[0,0,1] neg_hi:[0,0,1]
    v_exp_f32 v80, v80
    v_exp_f32 v81, v81
    v_exp_f32 v82, v82
    v_cvt_pk_bf16_f32 v68, v80, v81
    v_exp_f32 v83, v83
    v_exp_f32 v84, v84
    v_cvt_pk_bf16_f32 v69, v82, v83
    v_exp_f32 v85, v85
    v_exp_f32 v86, v86
    v_cvt_pk_bf16_f32 v70, v84, v85
    v_exp_f32 v87, v87
    v_exp_f32 v88, v88
    v_cvt_pk_bf16_f32 v71, v86, v87
    v_exp_f32 v89, v89
    s_waitcnt vmcnt(3)
    v_mfma_f32_16x16x32_bf16 v[76:79], v[28:31], v[68:71], 0
    v_and_b32 v3, 1, v116
    v_cvt_pk_bf16_f32 v72, v88, v89
    v_mfma_f32_16x16x32_bf16 v[100:103], v[120:123], v[68:71], 0
    v_cmp_ne_u32 vcc, s41, v3
    v_cvt_pk_bf16_f32 v73, v88, v89
    v_mfma_f32_16x16x32_bf16 v[104:107], v[124:127], v[68:71], 0
    v_mov_b32 v113, v116
    v_mov_b32 v115, v117
    v_mfma_f32_16x16x16_bf16 v[76:79], v[92:93], v[72:73], v[76:79]
    s_cbranch_vccnz mega_kernel_rs_w3_pv0
mega_kernel_rs_w3_pv2:
    v_mfma_f32_16x16x16_bf16 v[100:103], v[112:113], v[72:73], v[100:103]
    v_mfma_f32_16x16x16_bf16 v[104:107], v[114:115], v[72:73], v[104:107]
    buffer_load_dwordx4 v[120:123], v1, s[4:7], s44 offen
    buffer_load_dwordx4 v[124:127], v1, s[4:7], s44 offen offset:1024
    s_nop 2
    v_rcp_f32 v76, v76
    s_mov_b64 exec, s[28:29]
    v_pk_mul_f32 v[100:101], v[100:101], v[76:77] op_sel_hi:[1,0]
    v_pk_mul_f32 v[102:103], v[102:103], v[76:77] op_sel_hi:[1,0]
    v_pk_mul_f32 v[104:105], v[104:105], v[76:77] op_sel_hi:[1,0]
    v_pk_mul_f32 v[106:107], v[106:107], v[76:77] op_sel_hi:[1,0]
    v_cvt_pk_bf16_f32 v84, v100, v101
    v_cvt_pk_bf16_f32 v85, v102, v103
    v_cvt_pk_bf16_f32 v86, v104, v105
    v_cvt_pk_bf16_f32 v87, v106, v107
    ds_write_b128 v6, v[84:87] offset:29696
    s_mov_b64 exec, -1
    s_waitcnt lgkmcnt(0)
    s_barrier
    ds_read_b128 v[68:71], v6 offset:28672
    ds_read_b128 v[72:75], v6 offset:29696
    s_waitcnt lgkmcnt(1)
    v_smfmac_f32_16x16x64_bf16 v[32:35], v[68:71], v[128:135], v2
    s_add_u32 s21, s21, 1
    s_xor_b32 s38, s38, 1048576
    s_xor_b32 s37, s37, 1048576
    s_waitcnt lgkmcnt(0)
    v_smfmac_f32_16x16x64_bf16 v[32:35], v[72:75], v[136:143], v2
    s_xor_b32 s40, s40, 1048576
    s_xor_b32 s39, s39, 1048576
    s_lshr_b32 s41, s21, 1
    v_smfmac_f32_16x16x64_bf16 v[36:39], v[68:71], v[144:151], v2
    s_and_b32 s41, s41, 1
    s_xor_b32 s41, s41, 1
    s_xor_b32 s35, s35, 16384
    v_smfmac_f32_16x16x64_bf16 v[36:39], v[72:75], v[152:159], v2
    v_add_f32 v32, v32, v34
    s_xor_b32 s36, s36, 16384
    s_add_u32 s43, s43, 262144
    s_add_u32 s44, s44, 262144
    v_smfmac_f32_16x16x64_bf16 v[40:43], v[68:71], v[160:167], v2
    v_add_f32 v33, v33, v35
    v_smfmac_f32_16x16x64_bf16 v[40:43], v[72:75], v[168:175], v2
    v_cvt_pk_bf16_f32 v32, v32, v33
    v_smfmac_f32_16x16x64_bf16 v[44:47], v[68:71], v[176:183], v2
    v_and_or_b32 v32, v32, -2, s42
    v_smfmac_f32_16x16x64_bf16 v[44:47], v[72:75], v[184:191], v2
    v_add_f32 v36, v36, v38
    v_smfmac_f32_16x16x64_bf16 v[48:51], v[68:71], v[192:199], v2
    v_add_f32 v37, v37, v39
    v_smfmac_f32_16x16x64_bf16 v[48:51], v[72:75], v[200:207], v2
    v_cvt_pk_bf16_f32 v33, v36, v37
    v_smfmac_f32_16x16x64_bf16 v[52:55], v[68:71], v[208:215], v2
    v_add_f32 v40, v40, v42
    v_smfmac_f32_16x16x64_bf16 v[52:55], v[72:75], v[216:223], v2
    v_add_f32 v41, v41, v43
    v_smfmac_f32_16x16x64_bf16 v[56:59], v[68:71], v[224:231], v2
    v_cvt_pk_bf16_f32 v34, v40, v41
    v_smfmac_f32_16x16x64_bf16 v[56:59], v[72:75], v[232:239], v2
    v_add_f32 v44, v44, v46
    v_smfmac_f32_16x16x64_bf16 v[60:63], v[68:71], v[240:247], v2
    v_add_f32 v45, v45, v47
    v_smfmac_f32_16x16x64_bf16 v[60:63], v[72:75], v[248:255], v2
    v_cvt_pk_bf16_f32 v35, v44, v45
    buffer_store_dwordx4 v[32:35], v8, s[4:7], s46 offen sc1
    v_pk_add_f32 v[48:49], v[48:49], v[50:51]
    v_cvt_pk_bf16_f32 v48, v48, v49
    v_and_or_b32 v48, v48, -2, s42
    v_pk_add_f32 v[52:53], v[52:53], v[54:55]
    v_cvt_pk_bf16_f32 v49, v52, v53
    v_pk_add_f32 v[56:57], v[56:57], v[58:59]
    v_cvt_pk_bf16_f32 v50, v56, v57
    v_pk_add_f32 v[60:61], v[60:61], v[62:63]
    v_cvt_pk_bf16_f32 v51, v60, v61
    buffer_store_dwordx4 v[48:51], v8, s[4:7], s61 offen sc1
    s_add_u32 s45, s45, 262144
    s_add_u32 s51, s51, 262144
    v_mfma_f32_32x32x8_bf16 v[96:111], v[14:15], v[14:15], 0
    v_mfma_f32_16x16x16_bf16 v[112:115], v[14:15], v[14:15], 0
    v_mfma_f32_16x16x16_bf16 v[116:119], v[14:15], v[14:15], 0
    ds_read_b128 v[64:67], v1 offset:12288
    ds_read_b128 v[68:71], v1 offset:13312
    ds_read_b128 v[72:75], v1 offset:14336
    ds_read_b128 v[76:79], v1 offset:15360
    ds_read_b128 v[80:83], v1 offset:28672
    ds_read_b128 v[84:87], v1 offset:29696
    ds_read_b128 v[88:91], v1 offset:30720
    ds_read_b128 v[92:95], v1 offset:31744
    s_add_u32 s22, s21, 2
    s_cmp_gt_u32 s50, s22
    s_cbranch_scc1 mega_kernel_rs_w3_kvs
    v_readlane_b32 s50, v12, 0
    v_readlane_b32 s22, v12, 2
    v_readlane_b32 s23, v12, 1
    v_readlane_b32 s24, v12, 3
    s_nop 3
    s_min_u32 s50, s50, s22
    s_min_u32 s23, s23, s24
    s_lshl_b32 s50, s50, 1
    s_lshl_b32 s23, s23, 1
    s_add_u32 s23, s23, 1
    s_min_u32 s50, s50, s23
mega_kernel_rs_kvb1:
    s_add_u32 s22, s21, 1
    s_min_u32 s22, s22, 63
    s_cmp_gt_u32 s50, s22
    s_cbranch_scc1 mega_kernel_rs_kvd1
    buffer_load_dword v12, v7, s[4:7], 0 offen sc1
    s_waitcnt vmcnt(0)
    v_readlane_b32 s50, v12, 0
    v_readlane_b32 s22, v12, 2
    v_readlane_b32 s23, v12, 1
    v_readlane_b32 s24, v12, 3
    s_nop 3
    s_min_u32 s50, s50, s22
    s_min_u32 s23, s23, s24
    s_lshl_b32 s50, s50, 1
    s_lshl_b32 s23, s23, 1
    s_add_u32 s23, s23, 1
    s_min_u32 s50, s50, s23
    s_branch mega_kernel_rs_kvb1
mega_kernel_rs_kvd1:
mega_kernel_rs_w3_kvs:
    v_mov_b32 v58, -1
    v_mov_b32 v59, -1
    s_waitcnt vmcnt(0)
mega_kernel_rs_w3_pc:
    buffer_load_dword v36, v13, s[4:7], s25 offen offset:0 sc1
    buffer_load_dword v37, v13, s[4:7], s25 offen offset:256 sc1
    buffer_load_dword v38, v13, s[4:7], s25 offen offset:512 sc1
    buffer_load_dword v39, v13, s[4:7], s25 offen offset:768 sc1
    buffer_load_dword v40, v13, s[4:7], s25 offen offset:1024 sc1
    buffer_load_dword v41, v13, s[4:7], s25 offen offset:1280 sc1
    buffer_load_dword v42, v13, s[4:7], s25 offen offset:1536 sc1
    buffer_load_dword v43, v13, s[4:7], s25 offen offset:1792 sc1
    s_waitcnt vmcnt(4)
    v_mfma_f32_16x16x32_bf16 v[52:55], v[36:39], v[24:27], 0
    v_bitop3_b32 v3, s42, v36, v37 bitop3:0x7e
    v_bitop3_b32 v4, s42, v38, v39 bitop3:0x7e
    s_waitcnt vmcnt(2)
    v_or_b32 v3, v3, v4
    v_bitop3_b32 v4, s42, v40, v41 bitop3:0x7e
    s_waitcnt vmcnt(0)
    v_mfma_f32_16x16x32_bf16 v[52:55], v[40:43], v[24:27], v[52:55]
    v_bitop3_b32 v56, s42, v42, v43 bitop3:0x7e
    v_or3_b32 v3, v3, v4, v56
    v_and_b32 v3, v0, v3
    v_cmp_ne_u32 vcc, 0, v3
    s_nop 3
    v_cvt_pk_bf16_f32 v56, v52, v53
    v_cvt_pk_bf16_f32 v57, v54, v55
    v_min_u32 v56, -2, v56
    s_cbranch_vccnz mega_kernel_rs_w3_pc
    s_mov_b64 exec, s[26:27]
    buffer_store_dwordx2 v[56:57], v9, s[4:7], s35 offen offset:768 sc1
    buffer_store_dwordx2 v[58:59], v9, s[4:7], s36 offen offset:768 sc1
    s_mov_b64 exec, -1
    s_xor_b32 s42, s42, 1
    s_branch mega_kernel_rs_w3_loop
mega_kernel_rs_w3_last:
    buffer_store_dwordx4 v[64:67], v10, s[4:7], s45 offen offset:192 sc1
    buffer_store_dwordx2 v[18:19], v11, s[4:7], s51 offen offset:3584 sc1
    s_branch mega_kernel_rs_end
mega_kernel_rs_w3_pafail:
    s_nop 7
    v_mov_b32 v96, 0
    v_mov_b32 v97, 0
    v_mov_b32 v98, 0
    v_mov_b32 v99, 0
    v_mov_b32 v100, 0
    v_mov_b32 v101, 0
    v_mov_b32 v102, 0
    v_mov_b32 v103, 0
    v_mov_b32 v104, 0
    v_mov_b32 v105, 0
    v_mov_b32 v106, 0
    v_mov_b32 v107, 0
    s_branch mega_kernel_rs_w3_pa
mega_kernel_rs_w3_xslow:
    buffer_load_dwordx2 v[108:109], v11, s[4:7], s38 offen sc1
    buffer_load_dwordx2 v[110:111], v11, s[4:7], s38 offen offset:512 sc1
    s_waitcnt vmcnt(2)
    v_bitop3_b32 v3, s41, v20, v22 bitop3:0x7e
    v_mfma_f32_16x16x16_bf16 v[80:83], v[20:21], v[16:17], v[100:103]
    v_and_b32 v3, 1, v3
    v_mfma_f32_16x16x16_bf16 v[84:87], v[22:23], v[16:17], v[104:107]
    v_cmp_ne_u32 vcc, 0, v3
    s_cbranch_vccz mega_kernel_rs_w3_xgot
    buffer_load_dwordx2 v[20:21], v11, s[4:7], s38 offen sc1
    buffer_load_dwordx2 v[22:23], v11, s[4:7], s38 offen offset:512 sc1
    s_waitcnt vmcnt(2)
    v_bitop3_b32 v3, s41, v108, v110 bitop3:0x7e
    v_mfma_f32_16x16x16_bf16 v[80:83], v[108:109], v[16:17], v[100:103]
    v_and_b32 v3, 1, v3
    v_mfma_f32_16x16x16_bf16 v[84:87], v[110:111], v[16:17], v[104:107]
    v_cmp_ne_u32 vcc, 0, v3
    s_cbranch_vccz mega_kernel_rs_w3_xgot
    s_branch mega_kernel_rs_w3_xslow
mega_kernel_rs_w3_xgot:
    s_nop 3
    v_cvt_pk_bf16_f32 v64, v80, v81
    v_cvt_pk_bf16_f32 v65, v82, v83
    v_cvt_pk_bf16_f32 v66, v84, v85
    v_cvt_pk_bf16_f32 v67, v86, v87
    ds_write_b128 v6, v[64:67] offset:23552
    s_branch mega_kernel_rs_w3_xok
mega_kernel_rs_w3_pv0:
    s_waitcnt vmcnt(2)
    s_branch mega_kernel_rs_w3_pv1
mega_kernel_rs_w3_pv:
    buffer_load_dwordx2 v[20:21], v11, s[4:7], s40 offen sc1
    s_waitcnt vmcnt(0)
mega_kernel_rs_w3_pv1:
    v_and_b32 v3, 1, v20
    v_cmp_ne_u32 vcc, s41, v3
    v_mov_b32 v113, v20
    v_mov_b32 v115, v21
    s_cbranch_vccnz mega_kernel_rs_w3_pv
    s_branch mega_kernel_rs_w3_pv2
mega_kernel_rs_end:
    s_mov_b64 exec, -1
    v_mov_b32 v3, 64
    s_waitcnt vmcnt(0)
    s_barrier
    s_cmp_lg_u32 s20, 0
    s_cbranch_scc1 mega_kernel_rs_end2
    buffer_store_dword v3, v7, s[4:7], 0 offen sc1
mega_kernel_rs_end2:
    s_waitcnt vmcnt(0)
    s_endpgm
mega_kernel_bulk:
    s_load_dwordx2 s[8:9], s[0:1], 0
    s_load_dwordx2 s[40:41], s[0:1], 16
    s_load_dwordx2 s[42:43], s[0:1], 24
    s_load_dwordx2 s[44:45], s[0:1], 32
    v_lshrrev_b32 v2, 6, v0
    v_and_b32 v1, 63, v0
    v_readfirstlane_b32 s16, v2
    s_lshr_b32 s17, s92, 6
    s_bfe_u32 s18, s92, 0x50001
    s_and_b32 s19, s92, 1
    s_waitcnt lgkmcnt(0)
    s_mov_b32 s10, 4194304
    s_mov_b32 s11, 0x00020000
    s_cmp_eq_u32 s17, 1
    s_cselect_b32 s12, s42, s40
    s_cselect_b32 s13, s43, s41
    s_cmp_eq_u32 s17, 2
    s_cselect_b32 s12, s44, s12
    s_cselect_b32 s13, s45, s13
    s_mov_b32 s14, 8388608
    s_mov_b32 s15, 0x00020000
    v_lshrrev_b32 v2, 4, v1
    v_and_b32 v3, 15, v1
    v_lshlrev_b32 v4, 2, v2
    v_xor_b32 v4, v4, v3
    v_lshlrev_b32 v4, 4, v4
    s_lshl_b32 s20, s16, 5
    v_add_u32 v11, s20, v2
    v_lshl_add_u32 v11, v11, 13, v4
    s_lshl_b32 s20, s18, 8
    v_add_u32 v11, s20, v11
    s_lshl_b32 s22, s16, 13
    s_lshl_b32 s27, s19, 23
    s_and_b32 s27, s27, 4194304
    s_add_u32 m0, s22, 0
    s_xor_b32 s20, s27, 0
    buffer_load_dwordx4 v11, s[12:15], s20 offen lds
    s_add_u32 m0, s22, 1024
    s_xor_b32 s20, s27, 32768
    buffer_load_dwordx4 v11, s[12:15], s20 offen lds
    s_add_u32 m0, s22, 2048
    s_xor_b32 s20, s27, 65536
    buffer_load_dwordx4 v11, s[12:15], s20 offen lds
    s_add_u32 m0, s22, 3072
    s_xor_b32 s20, s27, 98304
    buffer_load_dwordx4 v11, s[12:15], s20 offen lds
    s_add_u32 m0, s22, 4096
    s_xor_b32 s20, s27, 131072
    buffer_load_dwordx4 v11, s[12:15], s20 offen lds
    s_add_u32 m0, s22, 5120
    s_xor_b32 s20, s27, 163840
    buffer_load_dwordx4 v11, s[12:15], s20 offen lds
    s_add_u32 m0, s22, 6144
    s_xor_b32 s20, s27, 196608
    buffer_load_dwordx4 v11, s[12:15], s20 offen lds
    s_add_u32 m0, s22, 7168
    s_xor_b32 s20, s27, 229376
    buffer_load_dwordx4 v11, s[12:15], s20 offen lds
    s_waitcnt vmcnt(8)
    s_barrier
    s_or_b32 s81, s97, s98
    s_cmp_lg_u32 s81, 0
    s_cbranch_scc1 mega_kernel_h0_3
    s_lshl_b32 s81, s93, 5
    v_mov_b32 v250, 1
    s_mov_b64 exec, 1
    buffer_atomic_add v250, off, s[88:91], s81 sc1
    s_mov_b64 exec, -1
mega_kernel_h0_3:
    s_add_u32 m0, s22, 32768
    s_xor_b32 s20, s27, 1048576
    buffer_load_dwordx4 v11, s[12:15], s20 offen lds
    s_add_u32 m0, s22, 33792
    s_xor_b32 s20, s27, 1081344
    buffer_load_dwordx4 v11, s[12:15], s20 offen lds
    s_add_u32 m0, s22, 34816
    s_xor_b32 s20, s27, 1114112
    buffer_load_dwordx4 v11, s[12:15], s20 offen lds
    s_add_u32 m0, s22, 35840
    s_xor_b32 s20, s27, 1146880
    buffer_load_dwordx4 v11, s[12:15], s20 offen lds
    s_add_u32 m0, s22, 36864
    s_xor_b32 s20, s27, 1179648
    buffer_load_dwordx4 v11, s[12:15], s20 offen lds
    s_add_u32 m0, s22, 37888
    s_xor_b32 s20, s27, 1212416
    buffer_load_dwordx4 v11, s[12:15], s20 offen lds
    s_add_u32 m0, s22, 38912
    s_xor_b32 s20, s27, 1245184
    buffer_load_dwordx4 v11, s[12:15], s20 offen lds
    s_add_u32 m0, s22, 39936
    s_xor_b32 s20, s27, 1277952
    buffer_load_dwordx4 v11, s[12:15], s20 offen lds
    s_add_u32 m0, s22, 65536
    s_xor_b32 s20, s27, 2097152
    buffer_load_dwordx4 v11, s[12:15], s20 offen lds
    s_add_u32 m0, s22, 66560
    s_xor_b32 s20, s27, 2129920
    buffer_load_dwordx4 v11, s[12:15], s20 offen lds
    s_add_u32 m0, s22, 67584
    s_xor_b32 s20, s27, 2162688
    buffer_load_dwordx4 v11, s[12:15], s20 offen lds
    s_add_u32 m0, s22, 68608
    s_xor_b32 s20, s27, 2195456
    buffer_load_dwordx4 v11, s[12:15], s20 offen lds
    s_add_u32 m0, s22, 69632
    s_xor_b32 s20, s27, 2228224
    buffer_load_dwordx4 v11, s[12:15], s20 offen lds
    s_add_u32 m0, s22, 70656
    s_xor_b32 s20, s27, 2260992
    buffer_load_dwordx4 v11, s[12:15], s20 offen lds
    s_add_u32 m0, s22, 71680
    s_xor_b32 s20, s27, 2293760
    buffer_load_dwordx4 v11, s[12:15], s20 offen lds
    s_add_u32 m0, s22, 72704
    s_xor_b32 s20, s27, 2326528
    buffer_load_dwordx4 v11, s[12:15], s20 offen lds
    s_add_u32 m0, s22, 98304
    s_xor_b32 s20, s27, 3145728
    buffer_load_dwordx4 v11, s[12:15], s20 offen lds
    s_add_u32 m0, s22, 99328
    s_xor_b32 s20, s27, 3178496
    buffer_load_dwordx4 v11, s[12:15], s20 offen lds
    s_add_u32 m0, s22, 100352
    s_xor_b32 s20, s27, 3211264
    buffer_load_dwordx4 v11, s[12:15], s20 offen lds
    s_add_u32 m0, s22, 101376
    s_xor_b32 s20, s27, 3244032
    buffer_load_dwordx4 v11, s[12:15], s20 offen lds
    s_add_u32 m0, s22, 102400
    s_xor_b32 s20, s27, 3276800
    buffer_load_dwordx4 v11, s[12:15], s20 offen lds
    s_add_u32 m0, s22, 103424
    s_xor_b32 s20, s27, 3309568
    buffer_load_dwordx4 v11, s[12:15], s20 offen lds
    s_add_u32 m0, s22, 104448
    s_xor_b32 s20, s27, 3342336
    buffer_load_dwordx4 v11, s[12:15], s20 offen lds
    s_add_u32 m0, s22, 105472
    s_xor_b32 s20, s27, 3375104
    buffer_load_dwordx4 v11, s[12:15], s20 offen lds
    v_and_b32 v3, 3, v1
    v_bfe_u32 v4, v1, 4, 1
    v_lshl_add_u32 v13, v3, 1, v4
    v_and_b32 v14, 1, v3
    v_lshlrev_b32 v14, 1, v14
    v_lshrrev_b32 v15, 1, v3
    v_add_u32 v14, v14, v15
    v_lshl_add_u32 v14, v4, 2, v14
    s_cmp_eq_u32 s17, 2
    s_cselect_b64 vcc, -1, 0
    v_cndmask_b32 v13, v14, v13, vcc
    v_bfe_u32 v14, v1, 2, 2
    v_xor_b32 v15, s16, v14
    v_lshlrev_b32 v15, 6, v15
    v_lshl_add_u32 v15, v13, 3, v15
    v_lshrrev_b32 v13, 5, v1
    v_lshl_add_u32 v13, v13, 3, v14
    v_lshl_add_u32 v12, v13, 8, v15
    v_and_b32 v3, 15, v1
    s_lshl_b32 s20, s16, 3
    v_add_u32 v13, s20, v2
    v_add_u32 v13, 0, v13
    v_and_b32 v14, 15, v13
    v_xor_b32 v14, v14, v3
    v_lshlrev_b32 v14, 4, v14
    v_lshl_add_u32 v6, v13, 11, v14
    v_add_u32 v13, s20, v2
    v_add_u32 v13, 4, v13
    v_and_b32 v14, 15, v13
    v_xor_b32 v14, v14, v3
    v_lshlrev_b32 v14, 4, v14
    v_lshl_add_u32 v7, v13, 11, v14
    v_and_b32 v13, 31, v1
    v_lshrrev_b32 v14, 5, v1
    v_xor_b32 v14, v14, v3
    v_lshlrev_b32 v14, 4, v14
    v_lshl_add_u32 v13, v13, 8, v14
    v_xor_b32 v16, 0, v13
    v_add_u32 v24, 0x10000, v16
    v_xor_b32 v17, 32, v13
    v_add_u32 v25, 0x10000, v17
    v_xor_b32 v18, 64, v13
    v_add_u32 v26, 0x10000, v18
    v_xor_b32 v19, 96, v13
    v_add_u32 v27, 0x10000, v19
    v_xor_b32 v20, 128, v13
    v_add_u32 v28, 0x10000, v20
    v_xor_b32 v21, 160, v13
    v_add_u32 v29, 0x10000, v21
    v_xor_b32 v22, 192, v13
    v_add_u32 v30, 0x10000, v22
    v_xor_b32 v23, 224, v13
    v_add_u32 v31, 0x10000, v23
    v_bfe_u32 v13, v1, 4, 1
    v_lshlrev_b32 v8, 10, v13
    v_lshrrev_b32 v13, 5, v1
    v_lshl_add_u32 v8, v13, 8, v8
    v_lshl_add_u32 v8, v3, 4, v8
    v_bfrev_b32 v13, 1
    s_lshl_b32 s20, s92, 7
    s_add_u32 s20, s20, 71303168
    v_mov_b32 v14, s20
    v_cmp_eq_u32 vcc, 0, v0
    s_lshl_b32 s24, s17, 24
    s_lshl_b32 s20, s19, 18
    v_cndmask_b32 v9, v13, v14, vcc
    s_add_u32 s24, s24, s20
    s_lshl_b32 s20, s18, 13
    s_add_u32 s24, s24, s20
    s_lshl_b32 s20, s16, 11
    s_add_u32 s24, s24, s20
    s_add_u32 s24, s24, 0
    s_lshl_b32 s23, s19, 16
    s_lshr_b32 s20, s27, 12
    s_add_u32 s23, s23, s20
    v_mov_b32 v10, 0
    s_lshl_b32 s21, s16, 11
    s_waitcnt vmcnt(24)
    s_barrier
    v_add_u32 v13, 0, v12
    ds_read_b64_tr_b16 a[0:1], v13 offset:0
    ds_read_b64_tr_b16 a[2:3], v13 offset:1024
    ds_read_b64_tr_b16 a[4:5], v13 offset:4096
    ds_read_b64_tr_b16 a[6:7], v13 offset:5120
    ds_read_b64_tr_b16 a[8:9], v13 offset:8192
    ds_read_b64_tr_b16 a[10:11], v13 offset:9216
    ds_read_b64_tr_b16 a[12:13], v13 offset:12288
    ds_read_b64_tr_b16 a[14:15], v13 offset:13312
    s_waitcnt lgkmcnt(0)
    ds_read_b64_tr_b16 a[16:17], v13 offset:16384
    ds_read_b64_tr_b16 a[18:19], v13 offset:17408
    ds_read_b64_tr_b16 a[20:21], v13 offset:20480
    ds_read_b64_tr_b16 a[22:23], v13 offset:21504
    ds_read_b64_tr_b16 a[24:25], v13 offset:24576
    ds_read_b64_tr_b16 a[26:27], v13 offset:25600
    ds_read_b64_tr_b16 a[28:29], v13 offset:28672
    ds_read_b64_tr_b16 a[30:31], v13 offset:29696
    s_waitcnt lgkmcnt(0)
    s_barrier
    s_add_u32 m0, s22, 0
    s_xor_b32 s20, s27, 4194304
    buffer_load_dwordx4 v11, s[12:15], s20 offen lds
    s_add_u32 m0, s22, 1024
    s_xor_b32 s20, s27, 4227072
    buffer_load_dwordx4 v11, s[12:15], s20 offen lds
    s_add_u32 m0, s22, 2048
    s_xor_b32 s20, s27, 4259840
    buffer_load_dwordx4 v11, s[12:15], s20 offen lds
    s_add_u32 m0, s22, 3072
    s_xor_b32 s20, s27, 4292608
    buffer_load_dwordx4 v11, s[12:15], s20 offen lds
    s_add_u32 m0, s22, 4096
    s_xor_b32 s20, s27, 4325376
    buffer_load_dwordx4 v11, s[12:15], s20 offen lds
    s_add_u32 m0, s22, 5120
    s_xor_b32 s20, s27, 4358144
    buffer_load_dwordx4 v11, s[12:15], s20 offen lds
    s_add_u32 m0, s22, 6144
    s_xor_b32 s20, s27, 4390912
    buffer_load_dwordx4 v11, s[12:15], s20 offen lds
    s_add_u32 m0, s22, 7168
    s_xor_b32 s20, s27, 4423680
    buffer_load_dwordx4 v11, s[12:15], s20 offen lds
    s_waitcnt vmcnt(24)
    s_barrier
    v_add_u32 v13, 32768, v12
    ds_read_b64_tr_b16 a[32:33], v13 offset:0
    ds_read_b64_tr_b16 a[34:35], v13 offset:1024
    ds_read_b64_tr_b16 a[36:37], v13 offset:4096
    ds_read_b64_tr_b16 a[38:39], v13 offset:5120
    ds_read_b64_tr_b16 a[40:41], v13 offset:8192
    ds_read_b64_tr_b16 a[42:43], v13 offset:9216
    ds_read_b64_tr_b16 a[44:45], v13 offset:12288
    ds_read_b64_tr_b16 a[46:47], v13 offset:13312
    s_waitcnt lgkmcnt(0)
    ds_read_b64_tr_b16 a[48:49], v13 offset:16384
    ds_read_b64_tr_b16 a[50:51], v13 offset:17408
    ds_read_b64_tr_b16 a[52:53], v13 offset:20480
    ds_read_b64_tr_b16 a[54:55], v13 offset:21504
    ds_read_b64_tr_b16 a[56:57], v13 offset:24576
    ds_read_b64_tr_b16 a[58:59], v13 offset:25600
    ds_read_b64_tr_b16 a[60:61], v13 offset:28672
    ds_read_b64_tr_b16 a[62:63], v13 offset:29696
    s_waitcnt lgkmcnt(0)
    s_barrier
    s_add_u32 m0, s22, 32768
    s_xor_b32 s20, s27, 5242880
    buffer_load_dwordx4 v11, s[12:15], s20 offen lds
    s_add_u32 m0, s22, 33792
    s_xor_b32 s20, s27, 5275648
    buffer_load_dwordx4 v11, s[12:15], s20 offen lds
    s_add_u32 m0, s22, 34816
    s_xor_b32 s20, s27, 5308416
    buffer_load_dwordx4 v11, s[12:15], s20 offen lds
    s_add_u32 m0, s22, 35840
    s_xor_b32 s20, s27, 5341184
    buffer_load_dwordx4 v11, s[12:15], s20 offen lds
    s_add_u32 m0, s22, 36864
    s_xor_b32 s20, s27, 5373952
    buffer_load_dwordx4 v11, s[12:15], s20 offen lds
    s_add_u32 m0, s22, 37888
    s_xor_b32 s20, s27, 5406720
    buffer_load_dwordx4 v11, s[12:15], s20 offen lds
    s_add_u32 m0, s22, 38912
    s_xor_b32 s20, s27, 5439488
    buffer_load_dwordx4 v11, s[12:15], s20 offen lds
    s_add_u32 m0, s22, 39936
    s_xor_b32 s20, s27, 5472256
    buffer_load_dwordx4 v11, s[12:15], s20 offen lds
    s_waitcnt vmcnt(24)
    s_barrier
    v_add_u32 v13, 65536, v12
    ds_read_b64_tr_b16 a[64:65], v13 offset:0
    ds_read_b64_tr_b16 a[66:67], v13 offset:1024
    ds_read_b64_tr_b16 a[68:69], v13 offset:4096
    ds_read_b64_tr_b16 a[70:71], v13 offset:5120
    ds_read_b64_tr_b16 a[72:73], v13 offset:8192
    ds_read_b64_tr_b16 a[74:75], v13 offset:9216
    ds_read_b64_tr_b16 a[76:77], v13 offset:12288
    ds_read_b64_tr_b16 a[78:79], v13 offset:13312
    s_waitcnt lgkmcnt(0)
    ds_read_b64_tr_b16 a[80:81], v13 offset:16384
    ds_read_b64_tr_b16 a[82:83], v13 offset:17408
    ds_read_b64_tr_b16 a[84:85], v13 offset:20480
    ds_read_b64_tr_b16 a[86:87], v13 offset:21504
    ds_read_b64_tr_b16 a[88:89], v13 offset:24576
    ds_read_b64_tr_b16 a[90:91], v13 offset:25600
    ds_read_b64_tr_b16 a[92:93], v13 offset:28672
    ds_read_b64_tr_b16 a[94:95], v13 offset:29696
    s_waitcnt lgkmcnt(0)
    s_barrier
    s_add_u32 m0, s22, 65536
    s_xor_b32 s20, s27, 6291456
    buffer_load_dwordx4 v11, s[12:15], s20 offen lds
    s_add_u32 m0, s22, 66560
    s_xor_b32 s20, s27, 6324224
    buffer_load_dwordx4 v11, s[12:15], s20 offen lds
    s_add_u32 m0, s22, 67584
    s_xor_b32 s20, s27, 6356992
    buffer_load_dwordx4 v11, s[12:15], s20 offen lds
    s_add_u32 m0, s22, 68608
    s_xor_b32 s20, s27, 6389760
    buffer_load_dwordx4 v11, s[12:15], s20 offen lds
    s_add_u32 m0, s22, 69632
    s_xor_b32 s20, s27, 6422528
    buffer_load_dwordx4 v11, s[12:15], s20 offen lds
    s_add_u32 m0, s22, 70656
    s_xor_b32 s20, s27, 6455296
    buffer_load_dwordx4 v11, s[12:15], s20 offen lds
    s_add_u32 m0, s22, 71680
    s_xor_b32 s20, s27, 6488064
    buffer_load_dwordx4 v11, s[12:15], s20 offen lds
    s_add_u32 m0, s22, 72704
    s_xor_b32 s20, s27, 6520832
    buffer_load_dwordx4 v11, s[12:15], s20 offen lds
    s_waitcnt vmcnt(24)
    s_barrier
    v_and_b32 v254, 7, v0
    v_lshlrev_b32 v254, 5, v254
    buffer_load_dword v252, v254, s[88:91], 0 offen sc1
    v_add_u32 v13, 98304, v12
    ds_read_b64_tr_b16 a[96:97], v13 offset:0
    ds_read_b64_tr_b16 a[98:99], v13 offset:1024
    ds_read_b64_tr_b16 a[100:101], v13 offset:4096
    ds_read_b64_tr_b16 a[102:103], v13 offset:5120
    ds_read_b64_tr_b16 a[104:105], v13 offset:8192
    ds_read_b64_tr_b16 a[106:107], v13 offset:9216
    ds_read_b64_tr_b16 a[108:109], v13 offset:12288
    ds_read_b64_tr_b16 a[110:111], v13 offset:13312
    s_waitcnt lgkmcnt(0)
    ds_read_b64_tr_b16 a[112:113], v13 offset:16384
    ds_read_b64_tr_b16 a[114:115], v13 offset:17408
    ds_read_b64_tr_b16 a[116:117], v13 offset:20480
    ds_read_b64_tr_b16 a[118:119], v13 offset:21504
    ds_read_b64_tr_b16 a[120:121], v13 offset:24576
    ds_read_b64_tr_b16 a[122:123], v13 offset:25600
    ds_read_b64_tr_b16 a[124:125], v13 offset:28672
    ds_read_b64_tr_b16 a[126:127], v13 offset:29696
    s_waitcnt lgkmcnt(0)
    s_barrier
    s_add_u32 m0, s22, 98304
    s_xor_b32 s20, s27, 7340032
    buffer_load_dwordx4 v11, s[12:15], s20 offen lds
    s_add_u32 m0, s22, 99328
    s_xor_b32 s20, s27, 7372800
    buffer_load_dwordx4 v11, s[12:15], s20 offen lds
    s_add_u32 m0, s22, 100352
    s_xor_b32 s20, s27, 7405568
    buffer_load_dwordx4 v11, s[12:15], s20 offen lds
    s_add_u32 m0, s22, 101376
    s_xor_b32 s20, s27, 7438336
    buffer_load_dwordx4 v11, s[12:15], s20 offen lds
    s_add_u32 m0, s22, 102400
    s_xor_b32 s20, s27, 7471104
    buffer_load_dwordx4 v11, s[12:15], s20 offen lds
    s_add_u32 m0, s22, 103424
    s_xor_b32 s20, s27, 7503872
    buffer_load_dwordx4 v11, s[12:15], s20 offen lds
    s_add_u32 m0, s22, 104448
    s_xor_b32 s20, s27, 7536640
    buffer_load_dwordx4 v11, s[12:15], s20 offen lds
    s_add_u32 m0, s22, 105472
    s_xor_b32 s20, s27, 7569408
    buffer_load_dwordx4 v11, s[12:15], s20 offen lds
    s_waitcnt vmcnt(24)
    s_barrier
    v_add_u32 v13, 0, v12
    ds_read_b64_tr_b16 a[128:129], v13 offset:0
    ds_read_b64_tr_b16 a[130:131], v13 offset:1024
    ds_read_b64_tr_b16 a[132:133], v13 offset:4096
    ds_read_b64_tr_b16 a[134:135], v13 offset:5120
    ds_read_b64_tr_b16 a[136:137], v13 offset:8192
    ds_read_b64_tr_b16 a[138:139], v13 offset:9216
    ds_read_b64_tr_b16 a[140:141], v13 offset:12288
    ds_read_b64_tr_b16 a[142:143], v13 offset:13312
    s_waitcnt lgkmcnt(0)
    ds_read_b64_tr_b16 a[144:145], v13 offset:16384
    ds_read_b64_tr_b16 a[146:147], v13 offset:17408
    ds_read_b64_tr_b16 a[148:149], v13 offset:20480
    ds_read_b64_tr_b16 a[150:151], v13 offset:21504
    ds_read_b64_tr_b16 a[152:153], v13 offset:24576
    ds_read_b64_tr_b16 a[154:155], v13 offset:25600
    ds_read_b64_tr_b16 a[156:157], v13 offset:28672
    ds_read_b64_tr_b16 a[158:159], v13 offset:29696
    s_waitcnt lgkmcnt(0)
    s_barrier
    s_add_u32 m0, s21, 0
    s_xor_b32 s20, s23, 0
    buffer_load_dwordx4 v6, s[8:11], s20 offen lds
    s_add_u32 m0, s21, 1024
    s_xor_b32 s20, s23, 0
    buffer_load_dwordx4 v7, s[8:11], s20 offen lds
    s_add_u32 m0, s21, 8192
    s_xor_b32 s20, s23, 256
    buffer_load_dwordx4 v6, s[8:11], s20 offen lds
    s_add_u32 m0, s21, 9216
    s_xor_b32 s20, s23, 256
    buffer_load_dwordx4 v7, s[8:11], s20 offen lds
    s_add_u32 m0, s21, 16384
    s_xor_b32 s20, s23, 512
    buffer_load_dwordx4 v6, s[8:11], s20 offen lds
    s_add_u32 m0, s21, 17408
    s_xor_b32 s20, s23, 512
    buffer_load_dwordx4 v7, s[8:11], s20 offen lds
    s_add_u32 m0, s21, 24576
    s_xor_b32 s20, s23, 768
    buffer_load_dwordx4 v6, s[8:11], s20 offen lds
    s_add_u32 m0, s21, 25600
    s_xor_b32 s20, s23, 768
    buffer_load_dwordx4 v7, s[8:11], s20 offen lds
    s_waitcnt vmcnt(24)
    s_barrier
    v_add_u32 v13, 32768, v12
    ds_read_b64_tr_b16 a[160:161], v13 offset:0
    ds_read_b64_tr_b16 a[162:163], v13 offset:1024
    ds_read_b64_tr_b16 a[164:165], v13 offset:4096
    ds_read_b64_tr_b16 a[166:167], v13 offset:5120
    ds_read_b64_tr_b16 a[168:169], v13 offset:8192
    ds_read_b64_tr_b16 a[170:171], v13 offset:9216
    ds_read_b64_tr_b16 a[172:173], v13 offset:12288
    ds_read_b64_tr_b16 a[174:175], v13 offset:13312
    s_waitcnt lgkmcnt(0)
    ds_read_b64_tr_b16 a[176:177], v13 offset:16384
    ds_read_b64_tr_b16 a[178:179], v13 offset:17408
    ds_read_b64_tr_b16 a[180:181], v13 offset:20480
    ds_read_b64_tr_b16 a[182:183], v13 offset:21504
    ds_read_b64_tr_b16 a[184:185], v13 offset:24576
    ds_read_b64_tr_b16 a[186:187], v13 offset:25600
    ds_read_b64_tr_b16 a[188:189], v13 offset:28672
    ds_read_b64_tr_b16 a[190:191], v13 offset:29696
    s_waitcnt lgkmcnt(0)
    s_barrier
    s_add_u32 m0, s21, 32768
    s_xor_b32 s20, s23, 1024
    buffer_load_dwordx4 v6, s[8:11], s20 offen lds
    s_add_u32 m0, s21, 33792
    s_xor_b32 s20, s23, 1024
    buffer_load_dwordx4 v7, s[8:11], s20 offen lds
    s_add_u32 m0, s21, 40960
    s_xor_b32 s20, s23, 1280
    buffer_load_dwordx4 v6, s[8:11], s20 offen lds
    s_add_u32 m0, s21, 41984
    s_xor_b32 s20, s23, 1280
    buffer_load_dwordx4 v7, s[8:11], s20 offen lds
    s_add_u32 m0, s21, 49152
    s_xor_b32 s20, s23, 1536
    buffer_load_dwordx4 v6, s[8:11], s20 offen lds
    s_add_u32 m0, s21, 50176
    s_xor_b32 s20, s23, 1536
    buffer_load_dwordx4 v7, s[8:11], s20 offen lds
    s_add_u32 m0, s21, 57344
    s_xor_b32 s20, s23, 1792
    buffer_load_dwordx4 v6, s[8:11], s20 offen lds
    s_add_u32 m0, s21, 58368
    s_xor_b32 s20, s23, 1792
    buffer_load_dwordx4 v7, s[8:11], s20 offen lds
    s_waitcnt vmcnt(24)
    s_barrier
    v_add_u32 v13, 65536, v12
    ds_read_b64_tr_b16 a[192:193], v13 offset:0
    ds_read_b64_tr_b16 a[194:195], v13 offset:1024
    ds_read_b64_tr_b16 a[196:197], v13 offset:4096
    ds_read_b64_tr_b16 a[198:199], v13 offset:5120
    ds_read_b64_tr_b16 a[200:201], v13 offset:8192
    ds_read_b64_tr_b16 a[202:203], v13 offset:9216
    ds_read_b64_tr_b16 a[204:205], v13 offset:12288
    ds_read_b64_tr_b16 a[206:207], v13 offset:13312
    s_waitcnt lgkmcnt(0)
    ds_read_b64_tr_b16 a[208:209], v13 offset:16384
    ds_read_b64_tr_b16 a[210:211], v13 offset:17408
    ds_read_b64_tr_b16 a[212:213], v13 offset:20480
    ds_read_b64_tr_b16 a[214:215], v13 offset:21504
    ds_read_b64_tr_b16 a[216:217], v13 offset:24576
    ds_read_b64_tr_b16 a[218:219], v13 offset:25600
    ds_read_b64_tr_b16 a[220:221], v13 offset:28672
    ds_read_b64_tr_b16 a[222:223], v13 offset:29696
    s_waitcnt lgkmcnt(0)
    s_barrier
    s_add_u32 s23, s23, 131072
    s_add_u32 m0, s21, 65536
    s_xor_b32 s20, s23, 0
    buffer_load_dwordx4 v6, s[8:11], s20 offen lds
    s_add_u32 m0, s21, 66560
    s_xor_b32 s20, s23, 0
    buffer_load_dwordx4 v7, s[8:11], s20 offen lds
    s_add_u32 m0, s21, 73728
    s_xor_b32 s20, s23, 256
    buffer_load_dwordx4 v6, s[8:11], s20 offen lds
    s_add_u32 m0, s21, 74752
    s_xor_b32 s20, s23, 256
    buffer_load_dwordx4 v7, s[8:11], s20 offen lds
    s_add_u32 m0, s21, 81920
    s_xor_b32 s20, s23, 512
    buffer_load_dwordx4 v6, s[8:11], s20 offen lds
    s_add_u32 m0, s21, 82944
    s_xor_b32 s20, s23, 512
    buffer_load_dwordx4 v7, s[8:11], s20 offen lds
    s_add_u32 m0, s21, 90112
    s_xor_b32 s20, s23, 768
    buffer_load_dwordx4 v6, s[8:11], s20 offen lds
    s_add_u32 m0, s21, 91136
    s_xor_b32 s20, s23, 768
    buffer_load_dwordx4 v7, s[8:11], s20 offen lds
    s_waitcnt vmcnt(24)
    s_barrier
    s_cmp_lg_u32 s97, 0
    s_cbranch_scc1 mega_kernel_h2_4_ok
mega_kernel_h2_4_ev:
    v_cmp_ne_u32 vcc, 32, v252
    s_cbranch_vccz mega_kernel_h2_4_ok
    s_mov_b32 s78, 0
    v_readlane_b32 s81, v252, 0
    s_nop 3
    s_add_u32 s78, s78, s81
    v_readlane_b32 s81, v252, 1
    s_nop 3
    s_add_u32 s78, s78, s81
    v_readlane_b32 s81, v252, 2
    s_nop 3
    s_add_u32 s78, s78, s81
    v_readlane_b32 s81, v252, 3
    s_nop 3
    s_add_u32 s78, s78, s81
    v_readlane_b32 s81, v252, 4
    s_nop 3
    s_add_u32 s78, s78, s81
    v_readlane_b32 s81, v252, 5
    s_nop 3
    s_add_u32 s78, s78, s81
    v_readlane_b32 s81, v252, 6
    s_nop 3
    s_add_u32 s78, s78, s81
    v_readlane_b32 s81, v252, 7
    s_nop 3
    s_add_u32 s78, s78, s81
    s_cmp_eq_u32 s78, 256
    s_cbranch_scc1 mega_kernel_redo
    buffer_load_dword v252, v254, s[88:91], 0 offen sc1
    s_waitcnt vmcnt(0)
    s_branch mega_kernel_h2_4_ev
mega_kernel_h2_4_ok:
    v_add_u32 v13, 98304, v12
    ds_read_b64_tr_b16 a[224:225], v13 offset:0
    ds_read_b64_tr_b16 a[226:227], v13 offset:1024
    ds_read_b64_tr_b16 a[228:229], v13 offset:4096
    ds_read_b64_tr_b16 a[230:231], v13 offset:5120
    ds_read_b64_tr_b16 a[232:233], v13 offset:8192
    ds_read_b64_tr_b16 a[234:235], v13 offset:9216
    ds_read_b64_tr_b16 a[236:237], v13 offset:12288
    ds_read_b64_tr_b16 a[238:239], v13 offset:13312
    s_waitcnt lgkmcnt(0)
    ds_read_b64_tr_b16 a[240:241], v13 offset:16384
    ds_read_b64_tr_b16 a[242:243], v13 offset:17408
    ds_read_b64_tr_b16 a[244:245], v13 offset:20480
    ds_read_b64_tr_b16 a[246:247], v13 offset:21504
    ds_read_b64_tr_b16 a[248:249], v13 offset:24576
    ds_read_b64_tr_b16 a[250:251], v13 offset:25600
    ds_read_b64_tr_b16 a[252:253], v13 offset:28672
    ds_read_b64_tr_b16 a[254:255], v13 offset:29696
    s_waitcnt lgkmcnt(0)
    s_barrier
    s_waitcnt vmcnt(16)
    s_barrier
    s_cmp_eq_u32 s17, 2
    s_cbranch_scc1 mega_kernel_q_v
    ds_read_b128 v[32:35], v16 offset:0
    ds_read_b128 v[36:39], v17 offset:0
    ds_read_b128 v[40:43], v18 offset:0
    ds_read_b128 v[44:47], v19 offset:0
    ds_read_b128 v[48:51], v20 offset:0
    ds_read_b128 v[52:55], v21 offset:0
    s_mov_b32 s25, 0
mega_kernel_q_qk_loop:
    s_waitcnt lgkmcnt(5)
    v_mfma_f32_32x32x16_bf16 v[64:79], a[0:3], v[32:35], 0
    ds_read_b128 v[56:59], v22 offset:0
    s_waitcnt lgkmcnt(5)
    v_mfma_f32_32x32x16_bf16 v[64:79], a[4:7], v[36:39], v[64:79]
    ds_read_b128 v[60:63], v23 offset:0
    s_waitcnt lgkmcnt(5)
    v_mfma_f32_32x32x16_bf16 v[64:79], a[8:11], v[40:43], v[64:79]
    ds_read_b128 v[32:35], v16 offset:8192
    s_cmp_eq_u32 s25, 0
    s_cbranch_scc1 mega_kernel_q_qk_sk2
    s_add_u32 m0, s21, 74752
    s_xor_b32 s20, s23, 256
    buffer_load_dwordx4 v7, s[8:11], s20 offen lds
mega_kernel_q_qk_sk2:
    s_waitcnt lgkmcnt(5)
    v_mfma_f32_32x32x16_bf16 v[64:79], a[12:15], v[44:47], v[64:79]
    ds_read_b128 v[36:39], v17 offset:8192
    s_waitcnt lgkmcnt(5)
    v_mfma_f32_32x32x16_bf16 v[64:79], a[16:19], v[48:51], v[64:79]
    ds_read_b128 v[40:43], v18 offset:8192
    s_waitcnt lgkmcnt(5)
    v_mfma_f32_32x32x16_bf16 v[64:79], a[20:23], v[52:55], v[64:79]
    ds_read_b128 v[44:47], v19 offset:8192
    s_cmp_eq_u32 s25, 0
    s_cbranch_scc1 mega_kernel_q_qk_sk5
    s_add_u32 m0, s21, 81920
    s_xor_b32 s20, s23, 512
    buffer_load_dwordx4 v6, s[8:11], s20 offen lds
mega_kernel_q_qk_sk5:
    s_waitcnt lgkmcnt(5)
    v_mfma_f32_32x32x16_bf16 v[64:79], a[24:27], v[56:59], v[64:79]
    ds_read_b128 v[48:51], v20 offset:8192
    s_waitcnt lgkmcnt(5)
    v_mfma_f32_32x32x16_bf16 v[64:79], a[28:31], v[60:63], v[64:79]
    ds_read_b128 v[52:55], v21 offset:8192
    s_waitcnt lgkmcnt(5)
    v_mfma_f32_32x32x16_bf16 v[64:79], a[32:35], v[32:35], v[64:79]
    ds_read_b128 v[56:59], v22 offset:8192
    s_cmp_eq_u32 s25, 0
    s_cbranch_scc1 mega_kernel_q_qk_sk8
    s_add_u32 m0, s21, 82944
    s_xor_b32 s20, s23, 512
    buffer_load_dwordx4 v7, s[8:11], s20 offen lds
mega_kernel_q_qk_sk8:
    s_waitcnt lgkmcnt(5)
    v_mfma_f32_32x32x16_bf16 v[64:79], a[36:39], v[36:39], v[64:79]
    ds_read_b128 v[60:63], v23 offset:8192
    s_waitcnt lgkmcnt(5)
    v_mfma_f32_32x32x16_bf16 v[64:79], a[40:43], v[40:43], v[64:79]
    ds_read_b128 v[32:35], v16 offset:16384
    s_waitcnt lgkmcnt(5)
    v_mfma_f32_32x32x16_bf16 v[64:79], a[44:47], v[44:47], v[64:79]
    ds_read_b128 v[36:39], v17 offset:16384
    s_cmp_eq_u32 s25, 0
    s_cbranch_scc1 mega_kernel_q_qk_sk11
    s_add_u32 m0, s21, 90112
    s_xor_b32 s20, s23, 768
    buffer_load_dwordx4 v6, s[8:11], s20 offen lds
mega_kernel_q_qk_sk11:
    s_waitcnt lgkmcnt(5)
    v_mfma_f32_32x32x16_bf16 v[64:79], a[48:51], v[48:51], v[64:79]
    ds_read_b128 v[40:43], v18 offset:16384
    s_waitcnt lgkmcnt(5)
    v_mfma_f32_32x32x16_bf16 v[64:79], a[52:55], v[52:55], v[64:79]
    ds_read_b128 v[44:47], v19 offset:16384
    s_waitcnt lgkmcnt(5)
    v_mfma_f32_32x32x16_bf16 v[64:79], a[56:59], v[56:59], v[64:79]
    ds_read_b128 v[48:51], v20 offset:16384
    s_cmp_eq_u32 s25, 0
    s_cbranch_scc1 mega_kernel_q_qk_sk14
    s_add_u32 m0, s21, 91136
    s_xor_b32 s20, s23, 768
    buffer_load_dwordx4 v7, s[8:11], s20 offen lds
mega_kernel_q_qk_sk14:
    s_waitcnt lgkmcnt(5)
    v_mfma_f32_32x32x16_bf16 v[64:79], a[60:63], v[60:63], v[64:79]
    ds_read_b128 v[52:55], v21 offset:16384
    s_waitcnt lgkmcnt(5)
    v_mfma_f32_32x32x16_bf16 v[64:79], a[64:67], v[32:35], v[64:79]
    ds_read_b128 v[56:59], v22 offset:16384
    s_cmp_eq_u32 s25, 0
    s_cbranch_scc1 mega_kernel_q_qk_ne0
    v_cvt_pk_bf16_f32 v96, v80, v81
    v_cvt_pk_bf16_f32 v97, v82, v83
    v_cvt_pk_bf16_f32 v98, v84, v85
    v_cvt_pk_bf16_f32 v99, v86, v87
    buffer_store_dwordx4 v[96:99], v8, s[84:87], s24 offen offset:0 sc1
mega_kernel_q_qk_ne0:
    s_waitcnt lgkmcnt(5)
    v_mfma_f32_32x32x16_bf16 v[64:79], a[68:71], v[36:39], v[64:79]
    ds_read_b128 v[60:63], v23 offset:16384
    s_waitcnt lgkmcnt(5)
    v_mfma_f32_32x32x16_bf16 v[64:79], a[72:75], v[40:43], v[64:79]
    ds_read_b128 v[32:35], v16 offset:24576
    s_cmp_eq_u32 s25, 0
    s_cbranch_scc1 mega_kernel_q_qk_ne1
    v_cvt_pk_bf16_f32 v100, v88, v89
    v_cvt_pk_bf16_f32 v101, v90, v91
    v_cvt_pk_bf16_f32 v102, v92, v93
    v_cvt_pk_bf16_f32 v103, v94, v95
    buffer_store_dwordx4 v[100:103], v8, s[84:87], s24 offen offset:512 sc1
    s_add_u32 s24, s24, 524288
mega_kernel_q_qk_ne1:
    s_waitcnt lgkmcnt(5)
    v_mfma_f32_32x32x16_bf16 v[64:79], a[76:79], v[44:47], v[64:79]
    ds_read_b128 v[36:39], v17 offset:24576
    s_waitcnt lgkmcnt(5)
    v_mfma_f32_32x32x16_bf16 v[64:79], a[80:83], v[48:51], v[64:79]
    ds_read_b128 v[40:43], v18 offset:24576
    s_waitcnt lgkmcnt(5)
    v_mfma_f32_32x32x16_bf16 v[64:79], a[84:87], v[52:55], v[64:79]
    ds_read_b128 v[44:47], v19 offset:24576
    s_waitcnt lgkmcnt(5)
    v_mfma_f32_32x32x16_bf16 v[64:79], a[88:91], v[56:59], v[64:79]
    ds_read_b128 v[48:51], v20 offset:24576
    s_waitcnt lgkmcnt(5)
    v_mfma_f32_32x32x16_bf16 v[64:79], a[92:95], v[60:63], v[64:79]
    ds_read_b128 v[52:55], v21 offset:24576
    s_waitcnt vmcnt(8)
    s_barrier
    s_waitcnt lgkmcnt(5)
    v_mfma_f32_32x32x16_bf16 v[64:79], a[96:99], v[32:35], v[64:79]
    ds_read_b128 v[56:59], v22 offset:24576
    s_waitcnt lgkmcnt(5)
    v_mfma_f32_32x32x16_bf16 v[64:79], a[100:103], v[36:39], v[64:79]
    ds_read_b128 v[60:63], v23 offset:24576
    s_add_u32 m0, s21, 98304
    s_xor_b32 s20, s23, 1024
    buffer_load_dwordx4 v6, s[8:11], s20 offen lds
    s_waitcnt lgkmcnt(5)
    v_mfma_f32_32x32x16_bf16 v[64:79], a[104:107], v[40:43], v[64:79]
    ds_read_b128 v[32:35], v16 offset:32768
    s_waitcnt lgkmcnt(5)
    v_mfma_f32_32x32x16_bf16 v[64:79], a[108:111], v[44:47], v[64:79]
    ds_read_b128 v[36:39], v17 offset:32768
    s_waitcnt lgkmcnt(5)
    v_mfma_f32_32x32x16_bf16 v[64:79], a[112:115], v[48:51], v[64:79]
    ds_read_b128 v[40:43], v18 offset:32768
    s_add_u32 m0, s21, 99328
    s_xor_b32 s20, s23, 1024
    buffer_load_dwordx4 v7, s[8:11], s20 offen lds
    s_waitcnt lgkmcnt(5)
    v_mfma_f32_32x32x16_bf16 v[64:79], a[116:119], v[52:55], v[64:79]
    ds_read_b128 v[44:47], v19 offset:32768
    s_waitcnt lgkmcnt(5)
    v_mfma_f32_32x32x16_bf16 v[64:79], a[120:123], v[56:59], v[64:79]
    ds_read_b128 v[48:51], v20 offset:32768
    s_waitcnt lgkmcnt(5)
    v_mfma_f32_32x32x16_bf16 v[64:79], a[124:127], v[60:63], v[64:79]
    ds_read_b128 v[52:55], v21 offset:32768
    s_add_u32 m0, s21, 106496
    s_xor_b32 s20, s23, 1280
    buffer_load_dwordx4 v6, s[8:11], s20 offen lds
    s_waitcnt lgkmcnt(5)
    v_mfma_f32_32x32x16_bf16 v[64:79], a[128:131], v[32:35], v[64:79]
    ds_read_b128 v[56:59], v22 offset:32768
    s_waitcnt lgkmcnt(5)
    v_mfma_f32_32x32x16_bf16 v[64:79], a[132:135], v[36:39], v[64:79]
    ds_read_b128 v[60:63], v23 offset:32768
    s_waitcnt lgkmcnt(5)
    v_mfma_f32_32x32x16_bf16 v[64:79], a[136:139], v[40:43], v[64:79]
    ds_read_b128 v[32:35], v16 offset:40960
    s_add_u32 m0, s21, 107520
    s_xor_b32 s20, s23, 1280
    buffer_load_dwordx4 v7, s[8:11], s20 offen lds
    s_waitcnt lgkmcnt(5)
    v_mfma_f32_32x32x16_bf16 v[64:79], a[140:143], v[44:47], v[64:79]
    ds_read_b128 v[36:39], v17 offset:40960
    s_waitcnt lgkmcnt(5)
    v_mfma_f32_32x32x16_bf16 v[64:79], a[144:147], v[48:51], v[64:79]
    ds_read_b128 v[40:43], v18 offset:40960
    s_waitcnt lgkmcnt(5)
    v_mfma_f32_32x32x16_bf16 v[64:79], a[148:151], v[52:55], v[64:79]
    ds_read_b128 v[44:47], v19 offset:40960
    s_add_u32 m0, s21, 114688
    s_xor_b32 s20, s23, 1536
    buffer_load_dwordx4 v6, s[8:11], s20 offen lds
    s_waitcnt lgkmcnt(5)
    v_mfma_f32_32x32x16_bf16 v[64:79], a[152:155], v[56:59], v[64:79]
    ds_read_b128 v[48:51], v20 offset:40960
    s_waitcnt lgkmcnt(5)
    v_mfma_f32_32x32x16_bf16 v[64:79], a[156:159], v[60:63], v[64:79]
    ds_read_b128 v[52:55], v21 offset:40960
    s_waitcnt lgkmcnt(5)
    v_mfma_f32_32x32x16_bf16 v[64:79], a[160:163], v[32:35], v[64:79]
    ds_read_b128 v[56:59], v22 offset:40960
    s_add_u32 m0, s21, 115712
    s_xor_b32 s20, s23, 1536
    buffer_load_dwordx4 v7, s[8:11], s20 offen lds
    s_waitcnt lgkmcnt(5)
    v_mfma_f32_32x32x16_bf16 v[64:79], a[164:167], v[36:39], v[64:79]
    ds_read_b128 v[60:63], v23 offset:40960
    s_waitcnt lgkmcnt(5)
    v_mfma_f32_32x32x16_bf16 v[64:79], a[168:171], v[40:43], v[64:79]
    ds_read_b128 v[32:35], v16 offset:49152
    s_waitcnt lgkmcnt(5)
    v_mfma_f32_32x32x16_bf16 v[64:79], a[172:175], v[44:47], v[64:79]
    ds_read_b128 v[36:39], v17 offset:49152
    s_add_u32 m0, s21, 122880
    s_xor_b32 s20, s23, 1792
    buffer_load_dwordx4 v6, s[8:11], s20 offen lds
    s_waitcnt lgkmcnt(5)
    v_mfma_f32_32x32x16_bf16 v[64:79], a[176:179], v[48:51], v[64:79]
    ds_read_b128 v[40:43], v18 offset:49152
    s_waitcnt lgkmcnt(5)
    v_mfma_f32_32x32x16_bf16 v[64:79], a[180:183], v[52:55], v[64:79]
    ds_read_b128 v[44:47], v19 offset:49152
    s_waitcnt lgkmcnt(5)
    v_mfma_f32_32x32x16_bf16 v[64:79], a[184:187], v[56:59], v[64:79]
    ds_read_b128 v[48:51], v20 offset:49152
    s_add_u32 m0, s21, 123904
    s_xor_b32 s20, s23, 1792
    buffer_load_dwordx4 v7, s[8:11], s20 offen lds
    s_waitcnt lgkmcnt(5)
    v_mfma_f32_32x32x16_bf16 v[64:79], a[188:191], v[60:63], v[64:79]
    ds_read_b128 v[52:55], v21 offset:49152
    s_waitcnt lgkmcnt(5)
    v_mfma_f32_32x32x16_bf16 v[64:79], a[192:195], v[32:35], v[64:79]
    ds_read_b128 v[56:59], v22 offset:49152
    s_waitcnt lgkmcnt(5)
    v_mfma_f32_32x32x16_bf16 v[64:79], a[196:199], v[36:39], v[64:79]
    ds_read_b128 v[60:63], v23 offset:49152
    s_waitcnt lgkmcnt(5)
    v_mfma_f32_32x32x16_bf16 v[64:79], a[200:203], v[40:43], v[64:79]
    ds_read_b128 v[32:35], v16 offset:57344
    s_waitcnt lgkmcnt(5)
    v_mfma_f32_32x32x16_bf16 v[64:79], a[204:207], v[44:47], v[64:79]
    ds_read_b128 v[36:39], v17 offset:57344
    s_waitcnt lgkmcnt(5)
    v_mfma_f32_32x32x16_bf16 v[64:79], a[208:211], v[48:51], v[64:79]
    ds_read_b128 v[40:43], v18 offset:57344
    s_waitcnt lgkmcnt(5)
    v_mfma_f32_32x32x16_bf16 v[64:79], a[212:215], v[52:55], v[64:79]
    ds_read_b128 v[44:47], v19 offset:57344
    s_waitcnt lgkmcnt(5)
    v_mfma_f32_32x32x16_bf16 v[64:79], a[216:219], v[56:59], v[64:79]
    ds_read_b128 v[48:51], v20 offset:57344
    s_waitcnt lgkmcnt(5)
    v_mfma_f32_32x32x16_bf16 v[64:79], a[220:223], v[60:63], v[64:79]
    ds_read_b128 v[52:55], v21 offset:57344
    s_waitcnt vmcnt(8)
    s_barrier
    s_waitcnt lgkmcnt(5)
    v_mfma_f32_32x32x16_bf16 v[64:79], a[224:227], v[32:35], v[64:79]
    ds_read_b128 v[56:59], v22 offset:57344
    s_waitcnt lgkmcnt(5)
    v_mfma_f32_32x32x16_bf16 v[64:79], a[228:231], v[36:39], v[64:79]
    ds_read_b128 v[60:63], v23 offset:57344
    s_add_u32 s23, s23, 131072
    s_add_u32 m0, s21, 0
    s_xor_b32 s20, s23, 0
    buffer_load_dwordx4 v6, s[8:11], s20 offen lds
    s_waitcnt lgkmcnt(5)
    v_mfma_f32_32x32x16_bf16 v[64:79], a[232:235], v[40:43], v[64:79]
    ds_read_b128 v[32:35], v24 offset:0
    s_cmp_eq_u32 s25, 0
    s_cbranch_scc1 mega_kernel_q_qk_nf
    v_add_u32 v10, 1, v10
    buffer_store_dword v10, v9, s[84:87], 0 offen sc1
mega_kernel_q_qk_nf:
    s_waitcnt lgkmcnt(5)
    v_mfma_f32_32x32x16_bf16 v[64:79], a[236:239], v[44:47], v[64:79]
    ds_read_b128 v[36:39], v25 offset:0
    s_waitcnt lgkmcnt(5)
    v_mfma_f32_32x32x16_bf16 v[64:79], a[240:243], v[48:51], v[64:79]
    ds_read_b128 v[40:43], v26 offset:0
    s_add_u32 m0, s21, 1024
    s_xor_b32 s20, s23, 0
    buffer_load_dwordx4 v7, s[8:11], s20 offen lds
    s_waitcnt lgkmcnt(5)
    v_mfma_f32_32x32x16_bf16 v[64:79], a[244:247], v[52:55], v[64:79]
    ds_read_b128 v[44:47], v27 offset:0
    s_waitcnt lgkmcnt(5)
    v_mfma_f32_32x32x16_bf16 v[64:79], a[248:251], v[56:59], v[64:79]
    ds_read_b128 v[48:51], v28 offset:0
    s_waitcnt lgkmcnt(5)
    v_mfma_f32_32x32x16_bf16 v[64:79], a[252:255], v[60:63], v[64:79]
    ds_read_b128 v[52:55], v29 offset:0
    s_add_u32 m0, s21, 8192
    s_xor_b32 s20, s23, 256
    buffer_load_dwordx4 v6, s[8:11], s20 offen lds
    s_waitcnt lgkmcnt(5)
    v_mfma_f32_32x32x16_bf16 v[80:95], a[0:3], v[32:35], 0
    ds_read_b128 v[56:59], v30 offset:0
    s_waitcnt lgkmcnt(5)
    v_mfma_f32_32x32x16_bf16 v[80:95], a[4:7], v[36:39], v[80:95]
    ds_read_b128 v[60:63], v31 offset:0
    s_waitcnt lgkmcnt(5)
    v_mfma_f32_32x32x16_bf16 v[80:95], a[8:11], v[40:43], v[80:95]
    ds_read_b128 v[32:35], v24 offset:8192
    s_add_u32 m0, s21, 9216
    s_xor_b32 s20, s23, 256
    buffer_load_dwordx4 v7, s[8:11], s20 offen lds
    s_waitcnt lgkmcnt(5)
    v_mfma_f32_32x32x16_bf16 v[80:95], a[12:15], v[44:47], v[80:95]
    ds_read_b128 v[36:39], v25 offset:8192
    s_waitcnt lgkmcnt(5)
    v_mfma_f32_32x32x16_bf16 v[80:95], a[16:19], v[48:51], v[80:95]
    ds_read_b128 v[40:43], v26 offset:8192
    s_waitcnt lgkmcnt(5)
    v_mfma_f32_32x32x16_bf16 v[80:95], a[20:23], v[52:55], v[80:95]
    ds_read_b128 v[44:47], v27 offset:8192
    s_add_u32 m0, s21, 16384
    s_xor_b32 s20, s23, 512
    buffer_load_dwordx4 v6, s[8:11], s20 offen lds
    s_waitcnt lgkmcnt(5)
    v_mfma_f32_32x32x16_bf16 v[80:95], a[24:27], v[56:59], v[80:95]
    ds_read_b128 v[48:51], v28 offset:8192
    s_waitcnt lgkmcnt(5)
    v_mfma_f32_32x32x16_bf16 v[80:95], a[28:31], v[60:63], v[80:95]
    ds_read_b128 v[52:55], v29 offset:8192
    s_waitcnt lgkmcnt(5)
    v_mfma_f32_32x32x16_bf16 v[80:95], a[32:35], v[32:35], v[80:95]
    ds_read_b128 v[56:59], v30 offset:8192
    s_add_u32 m0, s21, 17408
    s_xor_b32 s20, s23, 512
    buffer_load_dwordx4 v7, s[8:11], s20 offen lds
    s_waitcnt lgkmcnt(5)
    v_mfma_f32_32x32x16_bf16 v[80:95], a[36:39], v[36:39], v[80:95]
    ds_read_b128 v[60:63], v31 offset:8192
    s_waitcnt lgkmcnt(5)
    v_mfma_f32_32x32x16_bf16 v[80:95], a[40:43], v[40:43], v[80:95]
    ds_read_b128 v[32:35], v24 offset:16384
    s_waitcnt lgkmcnt(5)
    v_mfma_f32_32x32x16_bf16 v[80:95], a[44:47], v[44:47], v[80:95]
    ds_read_b128 v[36:39], v25 offset:16384
    s_add_u32 m0, s21, 24576
    s_xor_b32 s20, s23, 768
    buffer_load_dwordx4 v6, s[8:11], s20 offen lds
    s_waitcnt lgkmcnt(5)
    v_mfma_f32_32x32x16_bf16 v[80:95], a[48:51], v[48:51], v[80:95]
    ds_read_b128 v[40:43], v26 offset:16384
    s_waitcnt lgkmcnt(5)
    v_mfma_f32_32x32x16_bf16 v[80:95], a[52:55], v[52:55], v[80:95]
    ds_read_b128 v[44:47], v27 offset:16384
    s_waitcnt lgkmcnt(5)
    v_mfma_f32_32x32x16_bf16 v[80:95], a[56:59], v[56:59], v[80:95]
    ds_read_b128 v[48:51], v28 offset:16384
    s_add_u32 m0, s21, 25600
    s_xor_b32 s20, s23, 768
    buffer_load_dwordx4 v7, s[8:11], s20 offen lds
    s_waitcnt lgkmcnt(5)
    v_mfma_f32_32x32x16_bf16 v[80:95], a[60:63], v[60:63], v[80:95]
    ds_read_b128 v[52:55], v29 offset:16384
    s_waitcnt lgkmcnt(5)
    v_mfma_f32_32x32x16_bf16 v[80:95], a[64:67], v[32:35], v[80:95]
    ds_read_b128 v[56:59], v30 offset:16384
    v_cvt_pk_bf16_f32 v96, v64, v65
    v_cvt_pk_bf16_f32 v97, v66, v67
    v_cvt_pk_bf16_f32 v98, v68, v69
    v_cvt_pk_bf16_f32 v99, v70, v71
    buffer_store_dwordx4 v[96:99], v8, s[84:87], s24 offen offset:0 sc1
    s_waitcnt lgkmcnt(5)
    v_mfma_f32_32x32x16_bf16 v[80:95], a[68:71], v[36:39], v[80:95]
    ds_read_b128 v[60:63], v31 offset:16384
    s_waitcnt lgkmcnt(5)
    v_mfma_f32_32x32x16_bf16 v[80:95], a[72:75], v[40:43], v[80:95]
    ds_read_b128 v[32:35], v24 offset:24576
    v_cvt_pk_bf16_f32 v100, v72, v73
    v_cvt_pk_bf16_f32 v101, v74, v75
    v_cvt_pk_bf16_f32 v102, v76, v77
    v_cvt_pk_bf16_f32 v103, v78, v79
    buffer_store_dwordx4 v[100:103], v8, s[84:87], s24 offen offset:512 sc1
    s_add_u32 s24, s24, 524288
    s_waitcnt lgkmcnt(5)
    v_mfma_f32_32x32x16_bf16 v[80:95], a[76:79], v[44:47], v[80:95]
    ds_read_b128 v[36:39], v25 offset:24576
    s_waitcnt lgkmcnt(5)
    v_mfma_f32_32x32x16_bf16 v[80:95], a[80:83], v[48:51], v[80:95]
    ds_read_b128 v[40:43], v26 offset:24576
    s_waitcnt lgkmcnt(5)
    v_mfma_f32_32x32x16_bf16 v[80:95], a[84:87], v[52:55], v[80:95]
    ds_read_b128 v[44:47], v27 offset:24576
    s_waitcnt lgkmcnt(5)
    v_mfma_f32_32x32x16_bf16 v[80:95], a[88:91], v[56:59], v[80:95]
    ds_read_b128 v[48:51], v28 offset:24576
    s_waitcnt lgkmcnt(5)
    v_mfma_f32_32x32x16_bf16 v[80:95], a[92:95], v[60:63], v[80:95]
    ds_read_b128 v[52:55], v29 offset:24576
    s_waitcnt vmcnt(8)
    s_barrier
    s_waitcnt lgkmcnt(5)
    v_mfma_f32_32x32x16_bf16 v[80:95], a[96:99], v[32:35], v[80:95]
    ds_read_b128 v[56:59], v30 offset:24576
    s_waitcnt lgkmcnt(5)
    v_mfma_f32_32x32x16_bf16 v[80:95], a[100:103], v[36:39], v[80:95]
    ds_read_b128 v[60:63], v31 offset:24576
    s_add_u32 m0, s21, 32768
    s_xor_b32 s20, s23, 1024
    buffer_load_dwordx4 v6, s[8:11], s20 offen lds
    s_waitcnt lgkmcnt(5)
    v_mfma_f32_32x32x16_bf16 v[80:95], a[104:107], v[40:43], v[80:95]
    ds_read_b128 v[32:35], v24 offset:32768
    s_waitcnt lgkmcnt(5)
    v_mfma_f32_32x32x16_bf16 v[80:95], a[108:111], v[44:47], v[80:95]
    ds_read_b128 v[36:39], v25 offset:32768
    s_waitcnt lgkmcnt(5)
    v_mfma_f32_32x32x16_bf16 v[80:95], a[112:115], v[48:51], v[80:95]
    ds_read_b128 v[40:43], v26 offset:32768
    s_add_u32 m0, s21, 33792
    s_xor_b32 s20, s23, 1024
    buffer_load_dwordx4 v7, s[8:11], s20 offen lds
    s_waitcnt lgkmcnt(5)
    v_mfma_f32_32x32x16_bf16 v[80:95], a[116:119], v[52:55], v[80:95]
    ds_read_b128 v[44:47], v27 offset:32768
    s_waitcnt lgkmcnt(5)
    v_mfma_f32_32x32x16_bf16 v[80:95], a[120:123], v[56:59], v[80:95]
    ds_read_b128 v[48:51], v28 offset:32768
    s_waitcnt lgkmcnt(5)
    v_mfma_f32_32x32x16_bf16 v[80:95], a[124:127], v[60:63], v[80:95]
    ds_read_b128 v[52:55], v29 offset:32768
    s_add_u32 m0, s21, 40960
    s_xor_b32 s20, s23, 1280
    buffer_load_dwordx4 v6, s[8:11], s20 offen lds
    s_waitcnt lgkmcnt(5)
    v_mfma_f32_32x32x16_bf16 v[80:95], a[128:131], v[32:35], v[80:95]
    ds_read_b128 v[56:59], v30 offset:32768
    s_waitcnt lgkmcnt(5)
    v_mfma_f32_32x32x16_bf16 v[80:95], a[132:135], v[36:39], v[80:95]
    ds_read_b128 v[60:63], v31 offset:32768
    s_waitcnt lgkmcnt(5)
    v_mfma_f32_32x32x16_bf16 v[80:95], a[136:139], v[40:43], v[80:95]
    ds_read_b128 v[32:35], v24 offset:40960
    s_add_u32 m0, s21, 41984
    s_xor_b32 s20, s23, 1280
    buffer_load_dwordx4 v7, s[8:11], s20 offen lds
    s_waitcnt lgkmcnt(5)
    v_mfma_f32_32x32x16_bf16 v[80:95], a[140:143], v[44:47], v[80:95]
    ds_read_b128 v[36:39], v25 offset:40960
    s_waitcnt lgkmcnt(5)
    v_mfma_f32_32x32x16_bf16 v[80:95], a[144:147], v[48:51], v[80:95]
    ds_read_b128 v[40:43], v26 offset:40960
    s_waitcnt lgkmcnt(5)
    v_mfma_f32_32x32x16_bf16 v[80:95], a[148:151], v[52:55], v[80:95]
    ds_read_b128 v[44:47], v27 offset:40960
    s_add_u32 m0, s21, 49152
    s_xor_b32 s20, s23, 1536
    buffer_load_dwordx4 v6, s[8:11], s20 offen lds
    s_waitcnt lgkmcnt(5)
    v_mfma_f32_32x32x16_bf16 v[80:95], a[152:155], v[56:59], v[80:95]
    ds_read_b128 v[48:51], v28 offset:40960
    s_waitcnt lgkmcnt(5)
    v_mfma_f32_32x32x16_bf16 v[80:95], a[156:159], v[60:63], v[80:95]
    ds_read_b128 v[52:55], v29 offset:40960
    s_waitcnt lgkmcnt(5)
    v_mfma_f32_32x32x16_bf16 v[80:95], a[160:163], v[32:35], v[80:95]
    ds_read_b128 v[56:59], v30 offset:40960
    s_add_u32 m0, s21, 50176
    s_xor_b32 s20, s23, 1536
    buffer_load_dwordx4 v7, s[8:11], s20 offen lds
    s_waitcnt lgkmcnt(5)
    v_mfma_f32_32x32x16_bf16 v[80:95], a[164:167], v[36:39], v[80:95]
    ds_read_b128 v[60:63], v31 offset:40960
    s_waitcnt lgkmcnt(5)
    v_mfma_f32_32x32x16_bf16 v[80:95], a[168:171], v[40:43], v[80:95]
    ds_read_b128 v[32:35], v24 offset:49152
    s_waitcnt lgkmcnt(5)
    v_mfma_f32_32x32x16_bf16 v[80:95], a[172:175], v[44:47], v[80:95]
    ds_read_b128 v[36:39], v25 offset:49152
    s_add_u32 m0, s21, 57344
    s_xor_b32 s20, s23, 1792
    buffer_load_dwordx4 v6, s[8:11], s20 offen lds
    s_waitcnt lgkmcnt(5)
    v_mfma_f32_32x32x16_bf16 v[80:95], a[176:179], v[48:51], v[80:95]
    ds_read_b128 v[40:43], v26 offset:49152
    s_waitcnt lgkmcnt(5)
    v_mfma_f32_32x32x16_bf16 v[80:95], a[180:183], v[52:55], v[80:95]
    ds_read_b128 v[44:47], v27 offset:49152
    s_waitcnt lgkmcnt(5)
    v_mfma_f32_32x32x16_bf16 v[80:95], a[184:187], v[56:59], v[80:95]
    ds_read_b128 v[48:51], v28 offset:49152
    s_add_u32 m0, s21, 58368
    s_xor_b32 s20, s23, 1792
    buffer_load_dwordx4 v7, s[8:11], s20 offen lds
    s_waitcnt lgkmcnt(5)
    v_mfma_f32_32x32x16_bf16 v[80:95], a[188:191], v[60:63], v[80:95]
    ds_read_b128 v[52:55], v29 offset:49152
    s_waitcnt lgkmcnt(5)
    v_mfma_f32_32x32x16_bf16 v[80:95], a[192:195], v[32:35], v[80:95]
    ds_read_b128 v[56:59], v30 offset:49152
    s_waitcnt lgkmcnt(5)
    v_mfma_f32_32x32x16_bf16 v[80:95], a[196:199], v[36:39], v[80:95]
    ds_read_b128 v[60:63], v31 offset:49152
    s_waitcnt lgkmcnt(5)
    v_mfma_f32_32x32x16_bf16 v[80:95], a[200:203], v[40:43], v[80:95]
    ds_read_b128 v[32:35], v24 offset:57344
    s_waitcnt lgkmcnt(5)
    v_mfma_f32_32x32x16_bf16 v[80:95], a[204:207], v[44:47], v[80:95]
    ds_read_b128 v[36:39], v25 offset:57344
    s_waitcnt lgkmcnt(5)
    v_mfma_f32_32x32x16_bf16 v[80:95], a[208:211], v[48:51], v[80:95]
    ds_read_b128 v[40:43], v26 offset:57344
    s_waitcnt lgkmcnt(5)
    v_mfma_f32_32x32x16_bf16 v[80:95], a[212:215], v[52:55], v[80:95]
    ds_read_b128 v[44:47], v27 offset:57344
    s_waitcnt lgkmcnt(5)
    v_mfma_f32_32x32x16_bf16 v[80:95], a[216:219], v[56:59], v[80:95]
    ds_read_b128 v[48:51], v28 offset:57344
    s_waitcnt lgkmcnt(5)
    v_mfma_f32_32x32x16_bf16 v[80:95], a[220:223], v[60:63], v[80:95]
    ds_read_b128 v[52:55], v29 offset:57344
    s_waitcnt vmcnt(8)
    s_barrier
    s_waitcnt lgkmcnt(5)
    v_mfma_f32_32x32x16_bf16 v[80:95], a[224:227], v[32:35], v[80:95]
    ds_read_b128 v[56:59], v30 offset:57344
    s_waitcnt lgkmcnt(5)
    v_mfma_f32_32x32x16_bf16 v[80:95], a[228:231], v[36:39], v[80:95]
    ds_read_b128 v[60:63], v31 offset:57344
    s_add_u32 s23, s23, 131072
    s_add_u32 m0, s21, 65536
    s_xor_b32 s20, s23, 0
    buffer_load_dwordx4 v6, s[8:11], s20 offen lds
    s_waitcnt lgkmcnt(5)
    v_mfma_f32_32x32x16_bf16 v[80:95], a[232:235], v[40:43], v[80:95]
    ds_read_b128 v[32:35], v16 offset:0
    v_add_u32 v10, 1, v10
    buffer_store_dword v10, v9, s[84:87], 0 offen sc1
    s_waitcnt lgkmcnt(5)
    v_mfma_f32_32x32x16_bf16 v[80:95], a[236:239], v[44:47], v[80:95]
    ds_read_b128 v[36:39], v17 offset:0
    s_waitcnt lgkmcnt(5)
    v_mfma_f32_32x32x16_bf16 v[80:95], a[240:243], v[48:51], v[80:95]
    ds_read_b128 v[40:43], v18 offset:0
    s_add_u32 m0, s21, 66560
    s_xor_b32 s20, s23, 0
    buffer_load_dwordx4 v7, s[8:11], s20 offen lds
    s_waitcnt lgkmcnt(5)
    v_mfma_f32_32x32x16_bf16 v[80:95], a[244:247], v[52:55], v[80:95]
    ds_read_b128 v[44:47], v19 offset:0
    s_waitcnt lgkmcnt(5)
    v_mfma_f32_32x32x16_bf16 v[80:95], a[248:251], v[56:59], v[80:95]
    ds_read_b128 v[48:51], v20 offset:0
    s_waitcnt lgkmcnt(5)
    v_mfma_f32_32x32x16_bf16 v[80:95], a[252:255], v[60:63], v[80:95]
    ds_read_b128 v[52:55], v21 offset:0
    s_add_u32 m0, s21, 73728
    s_xor_b32 s20, s23, 256
    buffer_load_dwordx4 v6, s[8:11], s20 offen lds
    s_add_u32 s25, s25, 1
    s_cmp_lt_u32 s25, 16
    s_cbranch_scc1 mega_kernel_q_qk_loop
    s_nop 11
    v_cvt_pk_bf16_f32 v96, v80, v81
    v_cvt_pk_bf16_f32 v97, v82, v83
    v_cvt_pk_bf16_f32 v98, v84, v85
    v_cvt_pk_bf16_f32 v99, v86, v87
    buffer_store_dwordx4 v[96:99], v8, s[84:87], s24 offen offset:0 sc1
    v_cvt_pk_bf16_f32 v100, v88, v89
    v_cvt_pk_bf16_f32 v101, v90, v91
    v_cvt_pk_bf16_f32 v102, v92, v93
    v_cvt_pk_bf16_f32 v103, v94, v95
    buffer_store_dwordx4 v[100:103], v8, s[84:87], s24 offen offset:512 sc1
    s_add_u32 s24, s24, 524288
    s_waitcnt vmcnt(0) lgkmcnt(0)
    s_barrier
    v_add_u32 v10, 1, v10
    buffer_store_dword v10, v9, s[84:87], 0 offen sc1
    s_branch mega_kernel_q_done
mega_kernel_q_v:
    ds_read_b128 v[32:35], v16 offset:0
    ds_read_b128 v[36:39], v17 offset:0
    ds_read_b128 v[40:43], v18 offset:0
    ds_read_b128 v[44:47], v19 offset:0
    ds_read_b128 v[48:51], v20 offset:0
    ds_read_b128 v[52:55], v21 offset:0
    s_mov_b32 s25, 0
mega_kernel_q_v_loop:
    s_waitcnt lgkmcnt(5)
    v_mfma_f32_32x32x16_bf16 v[64:79], v[32:35], a[0:3], 0
    ds_read_b128 v[56:59], v22 offset:0
    s_waitcnt lgkmcnt(5)
    v_mfma_f32_32x32x16_bf16 v[64:79], v[36:39], a[4:7], v[64:79]
    ds_read_b128 v[60:63], v23 offset:0
    s_waitcnt lgkmcnt(5)
    v_mfma_f32_32x32x16_bf16 v[64:79], v[40:43], a[8:11], v[64:79]
    ds_read_b128 v[32:35], v16 offset:8192
    s_cmp_eq_u32 s25, 0
    s_cbranch_scc1 mega_kernel_q_v_sk2
    s_add_u32 m0, s21, 74752
    s_xor_b32 s20, s23, 256
    buffer_load_dwordx4 v7, s[8:11], s20 offen lds
mega_kernel_q_v_sk2:
    s_waitcnt lgkmcnt(5)
    v_mfma_f32_32x32x16_bf16 v[64:79], v[44:47], a[12:15], v[64:79]
    ds_read_b128 v[36:39], v17 offset:8192
    s_waitcnt lgkmcnt(5)
    v_mfma_f32_32x32x16_bf16 v[64:79], v[48:51], a[16:19], v[64:79]
    ds_read_b128 v[40:43], v18 offset:8192
    s_waitcnt lgkmcnt(5)
    v_mfma_f32_32x32x16_bf16 v[64:79], v[52:55], a[20:23], v[64:79]
    ds_read_b128 v[44:47], v19 offset:8192
    s_cmp_eq_u32 s25, 0
    s_cbranch_scc1 mega_kernel_q_v_sk5
    s_add_u32 m0, s21, 81920
    s_xor_b32 s20, s23, 512
    buffer_load_dwordx4 v6, s[8:11], s20 offen lds
mega_kernel_q_v_sk5:
    s_waitcnt lgkmcnt(5)
    v_mfma_f32_32x32x16_bf16 v[64:79], v[56:59], a[24:27], v[64:79]
    ds_read_b128 v[48:51], v20 offset:8192
    s_waitcnt lgkmcnt(5)
    v_mfma_f32_32x32x16_bf16 v[64:79], v[60:63], a[28:31], v[64:79]
    ds_read_b128 v[52:55], v21 offset:8192
    s_waitcnt lgkmcnt(5)
    v_mfma_f32_32x32x16_bf16 v[64:79], v[32:35], a[32:35], v[64:79]
    ds_read_b128 v[56:59], v22 offset:8192
    s_cmp_eq_u32 s25, 0
    s_cbranch_scc1 mega_kernel_q_v_sk8
    s_add_u32 m0, s21, 82944
    s_xor_b32 s20, s23, 512
    buffer_load_dwordx4 v7, s[8:11], s20 offen lds
mega_kernel_q_v_sk8:
    s_waitcnt lgkmcnt(5)
    v_mfma_f32_32x32x16_bf16 v[64:79], v[36:39], a[36:39], v[64:79]
    ds_read_b128 v[60:63], v23 offset:8192
    s_waitcnt lgkmcnt(5)
    v_mfma_f32_32x32x16_bf16 v[64:79], v[40:43], a[40:43], v[64:79]
    ds_read_b128 v[32:35], v16 offset:16384
    s_waitcnt lgkmcnt(5)
    v_mfma_f32_32x32x16_bf16 v[64:79], v[44:47], a[44:47], v[64:79]
    ds_read_b128 v[36:39], v17 offset:16384
    s_cmp_eq_u32 s25, 0
    s_cbranch_scc1 mega_kernel_q_v_sk11
    s_add_u32 m0, s21, 90112
    s_xor_b32 s20, s23, 768
    buffer_load_dwordx4 v6, s[8:11], s20 offen lds
mega_kernel_q_v_sk11:
    s_waitcnt lgkmcnt(5)
    v_mfma_f32_32x32x16_bf16 v[64:79], v[48:51], a[48:51], v[64:79]
    ds_read_b128 v[40:43], v18 offset:16384
    s_waitcnt lgkmcnt(5)
    v_mfma_f32_32x32x16_bf16 v[64:79], v[52:55], a[52:55], v[64:79]
    ds_read_b128 v[44:47], v19 offset:16384
    s_waitcnt lgkmcnt(5)
    v_mfma_f32_32x32x16_bf16 v[64:79], v[56:59], a[56:59], v[64:79]
    ds_read_b128 v[48:51], v20 offset:16384
    s_cmp_eq_u32 s25, 0
    s_cbranch_scc1 mega_kernel_q_v_sk14
    s_add_u32 m0, s21, 91136
    s_xor_b32 s20, s23, 768
    buffer_load_dwordx4 v7, s[8:11], s20 offen lds
mega_kernel_q_v_sk14:
    s_waitcnt lgkmcnt(5)
    v_mfma_f32_32x32x16_bf16 v[64:79], v[60:63], a[60:63], v[64:79]
    ds_read_b128 v[52:55], v21 offset:16384
    s_waitcnt lgkmcnt(5)
    v_mfma_f32_32x32x16_bf16 v[64:79], v[32:35], a[64:67], v[64:79]
    ds_read_b128 v[56:59], v22 offset:16384
    s_cmp_eq_u32 s25, 0
    s_cbranch_scc1 mega_kernel_q_v_ne0
    v_cvt_pk_bf16_f32 v96, v80, v81
    v_cvt_pk_bf16_f32 v97, v82, v83
    v_cvt_pk_bf16_f32 v98, v88, v89
    v_cvt_pk_bf16_f32 v99, v90, v91
    buffer_store_dwordx4 v[96:99], v8, s[84:87], s24 offen offset:0 sc1
mega_kernel_q_v_ne0:
    s_waitcnt lgkmcnt(5)
    v_mfma_f32_32x32x16_bf16 v[64:79], v[36:39], a[68:71], v[64:79]
    ds_read_b128 v[60:63], v23 offset:16384
    s_waitcnt lgkmcnt(5)
    v_mfma_f32_32x32x16_bf16 v[64:79], v[40:43], a[72:75], v[64:79]
    ds_read_b128 v[32:35], v16 offset:24576
    s_cmp_eq_u32 s25, 0
    s_cbranch_scc1 mega_kernel_q_v_ne1
    v_cvt_pk_bf16_f32 v100, v84, v85
    v_cvt_pk_bf16_f32 v101, v86, v87
    v_cvt_pk_bf16_f32 v102, v92, v93
    v_cvt_pk_bf16_f32 v103, v94, v95
    buffer_store_dwordx4 v[100:103], v8, s[84:87], s24 offen offset:512 sc1
    s_add_u32 s24, s24, 524288
mega_kernel_q_v_ne1:
    s_waitcnt lgkmcnt(5)
    v_mfma_f32_32x32x16_bf16 v[64:79], v[44:47], a[76:79], v[64:79]
    ds_read_b128 v[36:39], v17 offset:24576
    s_waitcnt lgkmcnt(5)
    v_mfma_f32_32x32x16_bf16 v[64:79], v[48:51], a[80:83], v[64:79]
    ds_read_b128 v[40:43], v18 offset:24576
    s_waitcnt lgkmcnt(5)
    v_mfma_f32_32x32x16_bf16 v[64:79], v[52:55], a[84:87], v[64:79]
    ds_read_b128 v[44:47], v19 offset:24576
    s_waitcnt lgkmcnt(5)
    v_mfma_f32_32x32x16_bf16 v[64:79], v[56:59], a[88:91], v[64:79]
    ds_read_b128 v[48:51], v20 offset:24576
    s_waitcnt lgkmcnt(5)
    v_mfma_f32_32x32x16_bf16 v[64:79], v[60:63], a[92:95], v[64:79]
    ds_read_b128 v[52:55], v21 offset:24576
    s_waitcnt vmcnt(8)
    s_barrier
    s_waitcnt lgkmcnt(5)
    v_mfma_f32_32x32x16_bf16 v[64:79], v[32:35], a[96:99], v[64:79]
    ds_read_b128 v[56:59], v22 offset:24576
    s_waitcnt lgkmcnt(5)
    v_mfma_f32_32x32x16_bf16 v[64:79], v[36:39], a[100:103], v[64:79]
    ds_read_b128 v[60:63], v23 offset:24576
    s_add_u32 m0, s21, 98304
    s_xor_b32 s20, s23, 1024
    buffer_load_dwordx4 v6, s[8:11], s20 offen lds
    s_waitcnt lgkmcnt(5)
    v_mfma_f32_32x32x16_bf16 v[64:79], v[40:43], a[104:107], v[64:79]
    ds_read_b128 v[32:35], v16 offset:32768
    s_waitcnt lgkmcnt(5)
    v_mfma_f32_32x32x16_bf16 v[64:79], v[44:47], a[108:111], v[64:79]
    ds_read_b128 v[36:39], v17 offset:32768
    s_waitcnt lgkmcnt(5)
    v_mfma_f32_32x32x16_bf16 v[64:79], v[48:51], a[112:115], v[64:79]
    ds_read_b128 v[40:43], v18 offset:32768
    s_add_u32 m0, s21, 99328
    s_xor_b32 s20, s23, 1024
    buffer_load_dwordx4 v7, s[8:11], s20 offen lds
    s_waitcnt lgkmcnt(5)
    v_mfma_f32_32x32x16_bf16 v[64:79], v[52:55], a[116:119], v[64:79]
    ds_read_b128 v[44:47], v19 offset:32768
    s_waitcnt lgkmcnt(5)
    v_mfma_f32_32x32x16_bf16 v[64:79], v[56:59], a[120:123], v[64:79]
    ds_read_b128 v[48:51], v20 offset:32768
    s_waitcnt lgkmcnt(5)
    v_mfma_f32_32x32x16_bf16 v[64:79], v[60:63], a[124:127], v[64:79]
    ds_read_b128 v[52:55], v21 offset:32768
    s_add_u32 m0, s21, 106496
    s_xor_b32 s20, s23, 1280
    buffer_load_dwordx4 v6, s[8:11], s20 offen lds
    s_waitcnt lgkmcnt(5)
    v_mfma_f32_32x32x16_bf16 v[64:79], v[32:35], a[128:131], v[64:79]
    ds_read_b128 v[56:59], v22 offset:32768
    s_waitcnt lgkmcnt(5)
    v_mfma_f32_32x32x16_bf16 v[64:79], v[36:39], a[132:135], v[64:79]
    ds_read_b128 v[60:63], v23 offset:32768
    s_waitcnt lgkmcnt(5)
    v_mfma_f32_32x32x16_bf16 v[64:79], v[40:43], a[136:139], v[64:79]
    ds_read_b128 v[32:35], v16 offset:40960
    s_add_u32 m0, s21, 107520
    s_xor_b32 s20, s23, 1280
    buffer_load_dwordx4 v7, s[8:11], s20 offen lds
    s_waitcnt lgkmcnt(5)
    v_mfma_f32_32x32x16_bf16 v[64:79], v[44:47], a[140:143], v[64:79]
    ds_read_b128 v[36:39], v17 offset:40960
    s_waitcnt lgkmcnt(5)
    v_mfma_f32_32x32x16_bf16 v[64:79], v[48:51], a[144:147], v[64:79]
    ds_read_b128 v[40:43], v18 offset:40960
    s_waitcnt lgkmcnt(5)
    v_mfma_f32_32x32x16_bf16 v[64:79], v[52:55], a[148:151], v[64:79]
    ds_read_b128 v[44:47], v19 offset:40960
    s_add_u32 m0, s21, 114688
    s_xor_b32 s20, s23, 1536
    buffer_load_dwordx4 v6, s[8:11], s20 offen lds
    s_waitcnt lgkmcnt(5)
    v_mfma_f32_32x32x16_bf16 v[64:79], v[56:59], a[152:155], v[64:79]
    ds_read_b128 v[48:51], v20 offset:40960
    s_waitcnt lgkmcnt(5)
    v_mfma_f32_32x32x16_bf16 v[64:79], v[60:63], a[156:159], v[64:79]
    ds_read_b128 v[52:55], v21 offset:40960
    s_waitcnt lgkmcnt(5)
    v_mfma_f32_32x32x16_bf16 v[64:79], v[32:35], a[160:163], v[64:79]
    ds_read_b128 v[56:59], v22 offset:40960
    s_add_u32 m0, s21, 115712
    s_xor_b32 s20, s23, 1536
    buffer_load_dwordx4 v7, s[8:11], s20 offen lds
    s_waitcnt lgkmcnt(5)
    v_mfma_f32_32x32x16_bf16 v[64:79], v[36:39], a[164:167], v[64:79]
    ds_read_b128 v[60:63], v23 offset:40960
    s_waitcnt lgkmcnt(5)
    v_mfma_f32_32x32x16_bf16 v[64:79], v[40:43], a[168:171], v[64:79]
    ds_read_b128 v[32:35], v16 offset:49152
    s_waitcnt lgkmcnt(5)
    v_mfma_f32_32x32x16_bf16 v[64:79], v[44:47], a[172:175], v[64:79]
    ds_read_b128 v[36:39], v17 offset:49152
    s_add_u32 m0, s21, 122880
    s_xor_b32 s20, s23, 1792
    buffer_load_dwordx4 v6, s[8:11], s20 offen lds
    s_waitcnt lgkmcnt(5)
    v_mfma_f32_32x32x16_bf16 v[64:79], v[48:51], a[176:179], v[64:79]
    ds_read_b128 v[40:43], v18 offset:49152
    s_waitcnt lgkmcnt(5)
    v_mfma_f32_32x32x16_bf16 v[64:79], v[52:55], a[180:183], v[64:79]
    ds_read_b128 v[44:47], v19 offset:49152
    s_waitcnt lgkmcnt(5)
    v_mfma_f32_32x32x16_bf16 v[64:79], v[56:59], a[184:187], v[64:79]
    ds_read_b128 v[48:51], v20 offset:49152
    s_add_u32 m0, s21, 123904
    s_xor_b32 s20, s23, 1792
    buffer_load_dwordx4 v7, s[8:11], s20 offen lds
    s_waitcnt lgkmcnt(5)
    v_mfma_f32_32x32x16_bf16 v[64:79], v[60:63], a[188:191], v[64:79]
    ds_read_b128 v[52:55], v21 offset:49152
    s_waitcnt lgkmcnt(5)
    v_mfma_f32_32x32x16_bf16 v[64:79], v[32:35], a[192:195], v[64:79]
    ds_read_b128 v[56:59], v22 offset:49152
    s_waitcnt lgkmcnt(5)
    v_mfma_f32_32x32x16_bf16 v[64:79], v[36:39], a[196:199], v[64:79]
    ds_read_b128 v[60:63], v23 offset:49152
    s_waitcnt lgkmcnt(5)
    v_mfma_f32_32x32x16_bf16 v[64:79], v[40:43], a[200:203], v[64:79]
    ds_read_b128 v[32:35], v16 offset:57344
    s_waitcnt lgkmcnt(5)
    v_mfma_f32_32x32x16_bf16 v[64:79], v[44:47], a[204:207], v[64:79]
    ds_read_b128 v[36:39], v17 offset:57344
    s_waitcnt lgkmcnt(5)
    v_mfma_f32_32x32x16_bf16 v[64:79], v[48:51], a[208:211], v[64:79]
    ds_read_b128 v[40:43], v18 offset:57344
    s_waitcnt lgkmcnt(5)
    v_mfma_f32_32x32x16_bf16 v[64:79], v[52:55], a[212:215], v[64:79]
    ds_read_b128 v[44:47], v19 offset:57344
    s_waitcnt lgkmcnt(5)
    v_mfma_f32_32x32x16_bf16 v[64:79], v[56:59], a[216:219], v[64:79]
    ds_read_b128 v[48:51], v20 offset:57344
    s_waitcnt lgkmcnt(5)
    v_mfma_f32_32x32x16_bf16 v[64:79], v[60:63], a[220:223], v[64:79]
    ds_read_b128 v[52:55], v21 offset:57344
    s_waitcnt vmcnt(8)
    s_barrier
    s_waitcnt lgkmcnt(5)
    v_mfma_f32_32x32x16_bf16 v[64:79], v[32:35], a[224:227], v[64:79]
    ds_read_b128 v[56:59], v22 offset:57344
    s_waitcnt lgkmcnt(5)
    v_mfma_f32_32x32x16_bf16 v[64:79], v[36:39], a[228:231], v[64:79]
    ds_read_b128 v[60:63], v23 offset:57344
    s_add_u32 s23, s23, 131072
    s_add_u32 m0, s21, 0
    s_xor_b32 s20, s23, 0
    buffer_load_dwordx4 v6, s[8:11], s20 offen lds
    s_waitcnt lgkmcnt(5)
    v_mfma_f32_32x32x16_bf16 v[64:79], v[40:43], a[232:235], v[64:79]
    ds_read_b128 v[32:35], v24 offset:0
    s_cmp_eq_u32 s25, 0
    s_cbranch_scc1 mega_kernel_q_v_nf
    v_add_u32 v10, 1, v10
    buffer_store_dword v10, v9, s[84:87], 0 offen sc1
mega_kernel_q_v_nf:
    s_waitcnt lgkmcnt(5)
    v_mfma_f32_32x32x16_bf16 v[64:79], v[44:47], a[236:239], v[64:79]
    ds_read_b128 v[36:39], v25 offset:0
    s_waitcnt lgkmcnt(5)
    v_mfma_f32_32x32x16_bf16 v[64:79], v[48:51], a[240:243], v[64:79]
    ds_read_b128 v[40:43], v26 offset:0
    s_add_u32 m0, s21, 1024
    s_xor_b32 s20, s23, 0
    buffer_load_dwordx4 v7, s[8:11], s20 offen lds
    s_waitcnt lgkmcnt(5)
    v_mfma_f32_32x32x16_bf16 v[64:79], v[52:55], a[244:247], v[64:79]
    ds_read_b128 v[44:47], v27 offset:0
    s_waitcnt lgkmcnt(5)
    v_mfma_f32_32x32x16_bf16 v[64:79], v[56:59], a[248:251], v[64:79]
    ds_read_b128 v[48:51], v28 offset:0
    s_waitcnt lgkmcnt(5)
    v_mfma_f32_32x32x16_bf16 v[64:79], v[60:63], a[252:255], v[64:79]
    ds_read_b128 v[52:55], v29 offset:0
    s_add_u32 m0, s21, 8192
    s_xor_b32 s20, s23, 256
    buffer_load_dwordx4 v6, s[8:11], s20 offen lds
    s_waitcnt lgkmcnt(5)
    v_mfma_f32_32x32x16_bf16 v[80:95], v[32:35], a[0:3], 0
    ds_read_b128 v[56:59], v30 offset:0
    s_waitcnt lgkmcnt(5)
    v_mfma_f32_32x32x16_bf16 v[80:95], v[36:39], a[4:7], v[80:95]
    ds_read_b128 v[60:63], v31 offset:0
    s_waitcnt lgkmcnt(5)
    v_mfma_f32_32x32x16_bf16 v[80:95], v[40:43], a[8:11], v[80:95]
    ds_read_b128 v[32:35], v24 offset:8192
    s_add_u32 m0, s21, 9216
    s_xor_b32 s20, s23, 256
    buffer_load_dwordx4 v7, s[8:11], s20 offen lds
    s_waitcnt lgkmcnt(5)
    v_mfma_f32_32x32x16_bf16 v[80:95], v[44:47], a[12:15], v[80:95]
    ds_read_b128 v[36:39], v25 offset:8192
    s_waitcnt lgkmcnt(5)
    v_mfma_f32_32x32x16_bf16 v[80:95], v[48:51], a[16:19], v[80:95]
    ds_read_b128 v[40:43], v26 offset:8192
    s_waitcnt lgkmcnt(5)
    v_mfma_f32_32x32x16_bf16 v[80:95], v[52:55], a[20:23], v[80:95]
    ds_read_b128 v[44:47], v27 offset:8192
    s_add_u32 m0, s21, 16384
    s_xor_b32 s20, s23, 512
    buffer_load_dwordx4 v6, s[8:11], s20 offen lds
    s_waitcnt lgkmcnt(5)
    v_mfma_f32_32x32x16_bf16 v[80:95], v[56:59], a[24:27], v[80:95]
    ds_read_b128 v[48:51], v28 offset:8192
    s_waitcnt lgkmcnt(5)
    v_mfma_f32_32x32x16_bf16 v[80:95], v[60:63], a[28:31], v[80:95]
    ds_read_b128 v[52:55], v29 offset:8192
    s_waitcnt lgkmcnt(5)
    v_mfma_f32_32x32x16_bf16 v[80:95], v[32:35], a[32:35], v[80:95]
    ds_read_b128 v[56:59], v30 offset:8192
    s_add_u32 m0, s21, 17408
    s_xor_b32 s20, s23, 512
    buffer_load_dwordx4 v7, s[8:11], s20 offen lds
    s_waitcnt lgkmcnt(5)
    v_mfma_f32_32x32x16_bf16 v[80:95], v[36:39], a[36:39], v[80:95]
    ds_read_b128 v[60:63], v31 offset:8192
    s_waitcnt lgkmcnt(5)
    v_mfma_f32_32x32x16_bf16 v[80:95], v[40:43], a[40:43], v[80:95]
    ds_read_b128 v[32:35], v24 offset:16384
    s_waitcnt lgkmcnt(5)
    v_mfma_f32_32x32x16_bf16 v[80:95], v[44:47], a[44:47], v[80:95]
    ds_read_b128 v[36:39], v25 offset:16384
    s_add_u32 m0, s21, 24576
    s_xor_b32 s20, s23, 768
    buffer_load_dwordx4 v6, s[8:11], s20 offen lds
    s_waitcnt lgkmcnt(5)
    v_mfma_f32_32x32x16_bf16 v[80:95], v[48:51], a[48:51], v[80:95]
    ds_read_b128 v[40:43], v26 offset:16384
    s_waitcnt lgkmcnt(5)
    v_mfma_f32_32x32x16_bf16 v[80:95], v[52:55], a[52:55], v[80:95]
    ds_read_b128 v[44:47], v27 offset:16384
    s_waitcnt lgkmcnt(5)
    v_mfma_f32_32x32x16_bf16 v[80:95], v[56:59], a[56:59], v[80:95]
    ds_read_b128 v[48:51], v28 offset:16384
    s_add_u32 m0, s21, 25600
    s_xor_b32 s20, s23, 768
    buffer_load_dwordx4 v7, s[8:11], s20 offen lds
    s_waitcnt lgkmcnt(5)
    v_mfma_f32_32x32x16_bf16 v[80:95], v[60:63], a[60:63], v[80:95]
    ds_read_b128 v[52:55], v29 offset:16384
    s_waitcnt lgkmcnt(5)
    v_mfma_f32_32x32x16_bf16 v[80:95], v[32:35], a[64:67], v[80:95]
    ds_read_b128 v[56:59], v30 offset:16384
    v_cvt_pk_bf16_f32 v96, v64, v65
    v_cvt_pk_bf16_f32 v97, v66, v67
    v_cvt_pk_bf16_f32 v98, v72, v73
    v_cvt_pk_bf16_f32 v99, v74, v75
    buffer_store_dwordx4 v[96:99], v8, s[84:87], s24 offen offset:0 sc1
    s_waitcnt lgkmcnt(5)
    v_mfma_f32_32x32x16_bf16 v[80:95], v[36:39], a[68:71], v[80:95]
    ds_read_b128 v[60:63], v31 offset:16384
    s_waitcnt lgkmcnt(5)
    v_mfma_f32_32x32x16_bf16 v[80:95], v[40:43], a[72:75], v[80:95]
    ds_read_b128 v[32:35], v24 offset:24576
    v_cvt_pk_bf16_f32 v100, v68, v69
    v_cvt_pk_bf16_f32 v101, v70, v71
    v_cvt_pk_bf16_f32 v102, v76, v77
    v_cvt_pk_bf16_f32 v103, v78, v79
    buffer_store_dwordx4 v[100:103], v8, s[84:87], s24 offen offset:512 sc1
    s_add_u32 s24, s24, 524288
    s_waitcnt lgkmcnt(5)
    v_mfma_f32_32x32x16_bf16 v[80:95], v[44:47], a[76:79], v[80:95]
    ds_read_b128 v[36:39], v25 offset:24576
    s_waitcnt lgkmcnt(5)
    v_mfma_f32_32x32x16_bf16 v[80:95], v[48:51], a[80:83], v[80:95]
    ds_read_b128 v[40:43], v26 offset:24576
    s_waitcnt lgkmcnt(5)
    v_mfma_f32_32x32x16_bf16 v[80:95], v[52:55], a[84:87], v[80:95]
    ds_read_b128 v[44:47], v27 offset:24576
    s_waitcnt lgkmcnt(5)
    v_mfma_f32_32x32x16_bf16 v[80:95], v[56:59], a[88:91], v[80:95]
    ds_read_b128 v[48:51], v28 offset:24576
    s_waitcnt lgkmcnt(5)
    v_mfma_f32_32x32x16_bf16 v[80:95], v[60:63], a[92:95], v[80:95]
    ds_read_b128 v[52:55], v29 offset:24576
    s_waitcnt vmcnt(8)
    s_barrier
    s_waitcnt lgkmcnt(5)
    v_mfma_f32_32x32x16_bf16 v[80:95], v[32:35], a[96:99], v[80:95]
    ds_read_b128 v[56:59], v30 offset:24576
    s_waitcnt lgkmcnt(5)
    v_mfma_f32_32x32x16_bf16 v[80:95], v[36:39], a[100:103], v[80:95]
    ds_read_b128 v[60:63], v31 offset:24576
    s_add_u32 m0, s21, 32768
    s_xor_b32 s20, s23, 1024
    buffer_load_dwordx4 v6, s[8:11], s20 offen lds
    s_waitcnt lgkmcnt(5)
    v_mfma_f32_32x32x16_bf16 v[80:95], v[40:43], a[104:107], v[80:95]
    ds_read_b128 v[32:35], v24 offset:32768
    s_waitcnt lgkmcnt(5)
    v_mfma_f32_32x32x16_bf16 v[80:95], v[44:47], a[108:111], v[80:95]
    ds_read_b128 v[36:39], v25 offset:32768
    s_waitcnt lgkmcnt(5)
    v_mfma_f32_32x32x16_bf16 v[80:95], v[48:51], a[112:115], v[80:95]
    ds_read_b128 v[40:43], v26 offset:32768
    s_add_u32 m0, s21, 33792
    s_xor_b32 s20, s23, 1024
    buffer_load_dwordx4 v7, s[8:11], s20 offen lds
    s_waitcnt lgkmcnt(5)
    v_mfma_f32_32x32x16_bf16 v[80:95], v[52:55], a[116:119], v[80:95]
    ds_read_b128 v[44:47], v27 offset:32768
    s_waitcnt lgkmcnt(5)
    v_mfma_f32_32x32x16_bf16 v[80:95], v[56:59], a[120:123], v[80:95]
    ds_read_b128 v[48:51], v28 offset:32768
    s_waitcnt lgkmcnt(5)
    v_mfma_f32_32x32x16_bf16 v[80:95], v[60:63], a[124:127], v[80:95]
    ds_read_b128 v[52:55], v29 offset:32768
    s_add_u32 m0, s21, 40960
    s_xor_b32 s20, s23, 1280
    buffer_load_dwordx4 v6, s[8:11], s20 offen lds
    s_waitcnt lgkmcnt(5)
    v_mfma_f32_32x32x16_bf16 v[80:95], v[32:35], a[128:131], v[80:95]
    ds_read_b128 v[56:59], v30 offset:32768
    s_waitcnt lgkmcnt(5)
    v_mfma_f32_32x32x16_bf16 v[80:95], v[36:39], a[132:135], v[80:95]
    ds_read_b128 v[60:63], v31 offset:32768
    s_waitcnt lgkmcnt(5)
    v_mfma_f32_32x32x16_bf16 v[80:95], v[40:43], a[136:139], v[80:95]
    ds_read_b128 v[32:35], v24 offset:40960
    s_add_u32 m0, s21, 41984
    s_xor_b32 s20, s23, 1280
    buffer_load_dwordx4 v7, s[8:11], s20 offen lds
    s_waitcnt lgkmcnt(5)
    v_mfma_f32_32x32x16_bf16 v[80:95], v[44:47], a[140:143], v[80:95]
    ds_read_b128 v[36:39], v25 offset:40960
    s_waitcnt lgkmcnt(5)
    v_mfma_f32_32x32x16_bf16 v[80:95], v[48:51], a[144:147], v[80:95]
    ds_read_b128 v[40:43], v26 offset:40960
    s_waitcnt lgkmcnt(5)
    v_mfma_f32_32x32x16_bf16 v[80:95], v[52:55], a[148:151], v[80:95]
    ds_read_b128 v[44:47], v27 offset:40960
    s_add_u32 m0, s21, 49152
    s_xor_b32 s20, s23, 1536
    buffer_load_dwordx4 v6, s[8:11], s20 offen lds
    s_waitcnt lgkmcnt(5)
    v_mfma_f32_32x32x16_bf16 v[80:95], v[56:59], a[152:155], v[80:95]
    ds_read_b128 v[48:51], v28 offset:40960
    s_waitcnt lgkmcnt(5)
    v_mfma_f32_32x32x16_bf16 v[80:95], v[60:63], a[156:159], v[80:95]
    ds_read_b128 v[52:55], v29 offset:40960
    s_waitcnt lgkmcnt(5)
    v_mfma_f32_32x32x16_bf16 v[80:95], v[32:35], a[160:163], v[80:95]
    ds_read_b128 v[56:59], v30 offset:40960
    s_add_u32 m0, s21, 50176
    s_xor_b32 s20, s23, 1536
    buffer_load_dwordx4 v7, s[8:11], s20 offen lds
    s_waitcnt lgkmcnt(5)
    v_mfma_f32_32x32x16_bf16 v[80:95], v[36:39], a[164:167], v[80:95]
    ds_read_b128 v[60:63], v31 offset:40960
    s_waitcnt lgkmcnt(5)
    v_mfma_f32_32x32x16_bf16 v[80:95], v[40:43], a[168:171], v[80:95]
    ds_read_b128 v[32:35], v24 offset:49152
    s_waitcnt lgkmcnt(5)
    v_mfma_f32_32x32x16_bf16 v[80:95], v[44:47], a[172:175], v[80:95]
    ds_read_b128 v[36:39], v25 offset:49152
    s_add_u32 m0, s21, 57344
    s_xor_b32 s20, s23, 1792
    buffer_load_dwordx4 v6, s[8:11], s20 offen lds
    s_waitcnt lgkmcnt(5)
    v_mfma_f32_32x32x16_bf16 v[80:95], v[48:51], a[176:179], v[80:95]
    ds_read_b128 v[40:43], v26 offset:49152
    s_waitcnt lgkmcnt(5)
    v_mfma_f32_32x32x16_bf16 v[80:95], v[52:55], a[180:183], v[80:95]
    ds_read_b128 v[44:47], v27 offset:49152
    s_waitcnt lgkmcnt(5)
    v_mfma_f32_32x32x16_bf16 v[80:95], v[56:59], a[184:187], v[80:95]
    ds_read_b128 v[48:51], v28 offset:49152
    s_add_u32 m0, s21, 58368
    s_xor_b32 s20, s23, 1792
    buffer_load_dwordx4 v7, s[8:11], s20 offen lds
    s_waitcnt lgkmcnt(5)
    v_mfma_f32_32x32x16_bf16 v[80:95], v[60:63], a[188:191], v[80:95]
    ds_read_b128 v[52:55], v29 offset:49152
    s_waitcnt lgkmcnt(5)
    v_mfma_f32_32x32x16_bf16 v[80:95], v[32:35], a[192:195], v[80:95]
    ds_read_b128 v[56:59], v30 offset:49152
    s_waitcnt lgkmcnt(5)
    v_mfma_f32_32x32x16_bf16 v[80:95], v[36:39], a[196:199], v[80:95]
    ds_read_b128 v[60:63], v31 offset:49152
    s_waitcnt lgkmcnt(5)
    v_mfma_f32_32x32x16_bf16 v[80:95], v[40:43], a[200:203], v[80:95]
    ds_read_b128 v[32:35], v24 offset:57344
    s_waitcnt lgkmcnt(5)
    v_mfma_f32_32x32x16_bf16 v[80:95], v[44:47], a[204:207], v[80:95]
    ds_read_b128 v[36:39], v25 offset:57344
    s_waitcnt lgkmcnt(5)
    v_mfma_f32_32x32x16_bf16 v[80:95], v[48:51], a[208:211], v[80:95]
    ds_read_b128 v[40:43], v26 offset:57344
    s_waitcnt lgkmcnt(5)
    v_mfma_f32_32x32x16_bf16 v[80:95], v[52:55], a[212:215], v[80:95]
    ds_read_b128 v[44:47], v27 offset:57344
    s_waitcnt lgkmcnt(5)
    v_mfma_f32_32x32x16_bf16 v[80:95], v[56:59], a[216:219], v[80:95]
    ds_read_b128 v[48:51], v28 offset:57344
    s_waitcnt lgkmcnt(5)
    v_mfma_f32_32x32x16_bf16 v[80:95], v[60:63], a[220:223], v[80:95]
    ds_read_b128 v[52:55], v29 offset:57344
    s_waitcnt vmcnt(8)
    s_barrier
    s_waitcnt lgkmcnt(5)
    v_mfma_f32_32x32x16_bf16 v[80:95], v[32:35], a[224:227], v[80:95]
    ds_read_b128 v[56:59], v30 offset:57344
    s_waitcnt lgkmcnt(5)
    v_mfma_f32_32x32x16_bf16 v[80:95], v[36:39], a[228:231], v[80:95]
    ds_read_b128 v[60:63], v31 offset:57344
    s_add_u32 s23, s23, 131072
    s_add_u32 m0, s21, 65536
    s_xor_b32 s20, s23, 0
    buffer_load_dwordx4 v6, s[8:11], s20 offen lds
    s_waitcnt lgkmcnt(5)
    v_mfma_f32_32x32x16_bf16 v[80:95], v[40:43], a[232:235], v[80:95]
    ds_read_b128 v[32:35], v16 offset:0
    v_add_u32 v10, 1, v10
    buffer_store_dword v10, v9, s[84:87], 0 offen sc1
    s_waitcnt lgkmcnt(5)
    v_mfma_f32_32x32x16_bf16 v[80:95], v[44:47], a[236:239], v[80:95]
    ds_read_b128 v[36:39], v17 offset:0
    s_waitcnt lgkmcnt(5)
    v_mfma_f32_32x32x16_bf16 v[80:95], v[48:51], a[240:243], v[80:95]
    ds_read_b128 v[40:43], v18 offset:0
    s_add_u32 m0, s21, 66560
    s_xor_b32 s20, s23, 0
    buffer_load_dwordx4 v7, s[8:11], s20 offen lds
    s_waitcnt lgkmcnt(5)
    v_mfma_f32_32x32x16_bf16 v[80:95], v[52:55], a[244:247], v[80:95]
    ds_read_b128 v[44:47], v19 offset:0
    s_waitcnt lgkmcnt(5)
    v_mfma_f32_32x32x16_bf16 v[80:95], v[56:59], a[248:251], v[80:95]
    ds_read_b128 v[48:51], v20 offset:0
    s_waitcnt lgkmcnt(5)
    v_mfma_f32_32x32x16_bf16 v[80:95], v[60:63], a[252:255], v[80:95]
    ds_read_b128 v[52:55], v21 offset:0
    s_add_u32 m0, s21, 73728
    s_xor_b32 s20, s23, 256
    buffer_load_dwordx4 v6, s[8:11], s20 offen lds
    s_add_u32 s25, s25, 1
    s_cmp_lt_u32 s25, 16
    s_cbranch_scc1 mega_kernel_q_v_loop
    s_nop 11
    v_cvt_pk_bf16_f32 v96, v80, v81
    v_cvt_pk_bf16_f32 v97, v82, v83
    v_cvt_pk_bf16_f32 v98, v88, v89
    v_cvt_pk_bf16_f32 v99, v90, v91
    buffer_store_dwordx4 v[96:99], v8, s[84:87], s24 offen offset:0 sc1
    v_cvt_pk_bf16_f32 v100, v84, v85
    v_cvt_pk_bf16_f32 v101, v86, v87
    v_cvt_pk_bf16_f32 v102, v92, v93
    v_cvt_pk_bf16_f32 v103, v94, v95
    buffer_store_dwordx4 v[100:103], v8, s[84:87], s24 offen offset:512 sc1
    s_add_u32 s24, s24, 524288
    s_waitcnt vmcnt(0) lgkmcnt(0)
    s_barrier
    v_add_u32 v10, 1, v10
    buffer_store_dword v10, v9, s[84:87], 0 offen sc1
mega_kernel_q_done:
    s_load_dwordx2 s[52:53], s[0:1], 40
    v_and_b32 v202, 63, v0
    s_and_b32 s58, s92, 31
    v_lshrrev_b32 v200, 2, v202
    v_lshlrev_b32 v200, 11, v200
    v_and_b32 v203, 3, v202
    v_lshl_add_u32 v200, v203, 4, v200
    s_lshl_b32 s56, s98, 21
    s_lshl_b32 s57, s58, 6
    s_add_u32 s56, s56, s57
    v_add_u32 v200, s56, v200
    s_lshl_b32 s56, s98, 14
    s_add_u32 s56, s56, 81920
    s_lshr_b32 s57, s58, 1
    s_lshl_b32 s57, s57, 12
    v_lshrrev_b32 v201, 5, v202
    v_bfe_u32 v204, v202, 2, 2
    v_lshl_add_u32 v201, v201, 3, v204
    v_lshlrev_b32 v201, 6, v201
    v_bfe_u32 v204, v202, 4, 1
    v_lshl_add_u32 v201, v204, 5, v201
    v_lshl_add_u32 v201, v203, 3, v201
    v_add_u32 v201, s56, v201
    s_waitcnt lgkmcnt(0)
    s_mov_b32 s54, 8388608
    s_mov_b32 s55, 0x00020000
    s_add_u32 m0, s56, 0
    s_add_u32 s58, s57, 0
    s_and_b32 s58, s58, 0xffff
    s_lshl_b32 s58, s58, 5
    buffer_load_dwordx4 v200, s[52:55], s58 offen lds
    s_add_u32 m0, s56, 1024
    s_add_u32 s58, s57, 1024
    s_and_b32 s58, s58, 0xffff
    s_lshl_b32 s58, s58, 5
    buffer_load_dwordx4 v200, s[52:55], s58 offen lds
    s_add_u32 m0, s56, 2048
    s_add_u32 s58, s57, 2048
    s_and_b32 s58, s58, 0xffff
    s_lshl_b32 s58, s58, 5
    buffer_load_dwordx4 v200, s[52:55], s58 offen lds
    s_add_u32 m0, s56, 3072
    s_add_u32 s58, s57, 3072
    s_and_b32 s58, s58, 0xffff
    s_lshl_b32 s58, s58, 5
    buffer_load_dwordx4 v200, s[52:55], s58 offen lds
    s_add_u32 m0, s56, 4096
    s_add_u32 s58, s57, 4096
    s_and_b32 s58, s58, 0xffff
    s_lshl_b32 s58, s58, 5
    buffer_load_dwordx4 v200, s[52:55], s58 offen lds
    s_add_u32 m0, s56, 5120
    s_add_u32 s58, s57, 5120
    s_and_b32 s58, s58, 0xffff
    s_lshl_b32 s58, s58, 5
    buffer_load_dwordx4 v200, s[52:55], s58 offen lds
    s_add_u32 m0, s56, 6144
    s_add_u32 s58, s57, 6144
    s_and_b32 s58, s58, 0xffff
    s_lshl_b32 s58, s58, 5
    buffer_load_dwordx4 v200, s[52:55], s58 offen lds
    s_add_u32 m0, s56, 7168
    s_add_u32 s58, s57, 7168
    s_and_b32 s58, s58, 0xffff
    s_lshl_b32 s58, s58, 5
    buffer_load_dwordx4 v200, s[52:55], s58 offen lds
    s_add_u32 m0, s56, 8192
    s_add_u32 s58, s57, 8192
    s_and_b32 s58, s58, 0xffff
    s_lshl_b32 s58, s58, 5
    buffer_load_dwordx4 v200, s[52:55], s58 offen lds
    s_add_u32 m0, s56, 9216
    s_add_u32 s58, s57, 9216
    s_and_b32 s58, s58, 0xffff
    s_lshl_b32 s58, s58, 5
    buffer_load_dwordx4 v200, s[52:55], s58 offen lds
    s_add_u32 m0, s56, 10240
    s_add_u32 s58, s57, 10240
    s_and_b32 s58, s58, 0xffff
    s_lshl_b32 s58, s58, 5
    buffer_load_dwordx4 v200, s[52:55], s58 offen lds
    s_add_u32 m0, s56, 11264
    s_add_u32 s58, s57, 11264
    s_and_b32 s58, s58, 0xffff
    s_lshl_b32 s58, s58, 5
    buffer_load_dwordx4 v200, s[52:55], s58 offen lds
    s_add_u32 m0, s56, 12288
    s_add_u32 s58, s57, 12288
    s_and_b32 s58, s58, 0xffff
    s_lshl_b32 s58, s58, 5
    buffer_load_dwordx4 v200, s[52:55], s58 offen lds
    s_add_u32 m0, s56, 13312
    s_add_u32 s58, s57, 13312
    s_and_b32 s58, s58, 0xffff
    s_lshl_b32 s58, s58, 5
    buffer_load_dwordx4 v200, s[52:55], s58 offen lds
    s_add_u32 m0, s56, 14336
    s_add_u32 s58, s57, 14336
    s_and_b32 s58, s58, 0xffff
    s_lshl_b32 s58, s58, 5
    buffer_load_dwordx4 v200, s[52:55], s58 offen lds
    s_add_u32 m0, s56, 15360
    s_add_u32 s58, s57, 15360
    s_and_b32 s58, s58, 0xffff
    s_lshl_b32 s58, s58, 5
    buffer_load_dwordx4 v200, s[52:55], s58 offen lds
    s_cmp_lt_u32 s92, 128
    s_cbranch_scc1 mega_kernel_f1
    s_sub_u32 s99, s92, 128
mega_kernel_f0l:
    s_barrier
    s_load_dwordx2 s[4:5], s[0:1], 64
    s_load_dwordx2 s[8:9], s[0:1], 72
    s_load_dwordx2 s[12:13], s[0:1], 96
    s_and_b32 s16, s99, 31
    s_lshr_b32 s17, s99, 5
    v_and_b32 v1, 63, v0
    v_lshrrev_b32 v2, 6, v0
    s_waitcnt lgkmcnt(0)
    s_mov_b32 s6, 2101248
    s_mov_b32 s7, 0x00020000
    s_mov_b32 s10, 2101248
    s_mov_b32 s11, 0x00020000
    s_add_u32 s12, s12, 121634816
    s_addc_u32 s13, s13, 0
    s_mov_b32 s14, 4202496
    s_mov_b32 s15, 0x00020000
    s_lshl_b32 s18, s16, 6
    v_add_u32 v3, s18, v2
    s_movk_i32 s19, 1026
    v_mul_lo_u32 v3, v3, s19
    s_lshl_b32 s18, s17, 7
    v_add_u32 v3, s18, v3
    v_lshl_add_u32 v3, v1, 1, v3
    s_mov_b32 s18, 0
    buffer_load_ushort v16, v3, s[4:7], s18 offen
    buffer_load_ushort v32, v3, s[8:11], s18 offen
    s_mov_b32 s18, 4104
    buffer_load_ushort v17, v3, s[4:7], s18 offen
    buffer_load_ushort v33, v3, s[8:11], s18 offen
    s_mov_b32 s18, 8208
    buffer_load_ushort v18, v3, s[4:7], s18 offen
    buffer_load_ushort v34, v3, s[8:11], s18 offen
    s_mov_b32 s18, 12312
    buffer_load_ushort v19, v3, s[4:7], s18 offen
    buffer_load_ushort v35, v3, s[8:11], s18 offen
    s_mov_b32 s18, 16416
    buffer_load_ushort v20, v3, s[4:7], s18 offen
    buffer_load_ushort v36, v3, s[8:11], s18 offen
    s_mov_b32 s18, 20520
    buffer_load_ushort v21, v3, s[4:7], s18 offen
    buffer_load_ushort v37, v3, s[8:11], s18 offen
    s_mov_b32 s18, 24624
    buffer_load_ushort v22, v3, s[4:7], s18 offen
    buffer_load_ushort v38, v3, s[8:11], s18 offen
    s_mov_b32 s18, 28728
    buffer_load_ushort v23, v3, s[4:7], s18 offen
    buffer_load_ushort v39, v3, s[8:11], s18 offen
    s_mov_b32 s18, 32832
    buffer_load_ushort v24, v3, s[4:7], s18 offen
    buffer_load_ushort v40, v3, s[8:11], s18 offen
    s_mov_b32 s18, 36936
    buffer_load_ushort v25, v3, s[4:7], s18 offen
    buffer_load_ushort v41, v3, s[8:11], s18 offen
    s_mov_b32 s18, 41040
    buffer_load_ushort v26, v3, s[4:7], s18 offen
    buffer_load_ushort v42, v3, s[8:11], s18 offen
    s_mov_b32 s18, 45144
    buffer_load_ushort v27, v3, s[4:7], s18 offen
    buffer_load_ushort v43, v3, s[8:11], s18 offen
    s_mov_b32 s18, 49248
    buffer_load_ushort v28, v3, s[4:7], s18 offen
    buffer_load_ushort v44, v3, s[8:11], s18 offen
    s_mov_b32 s18, 53352
    buffer_load_ushort v29, v3, s[4:7], s18 offen
    buffer_load_ushort v45, v3, s[8:11], s18 offen
    s_mov_b32 s18, 57456
    buffer_load_ushort v30, v3, s[4:7], s18 offen
    buffer_load_ushort v46, v3, s[8:11], s18 offen
    s_mov_b32 s18, 61560
    buffer_load_ushort v31, v3, s[4:7], s18 offen
    buffer_load_ushort v47, v3, s[8:11], s18 offen
    v_mul_u32_u24 v4, 65, v1
    v_add_u32 v4, v4, v2
    v_lshlrev_b32 v4, 2, v4
    s_waitcnt vmcnt(0)
    v_lshl_or_b32 v16, v32, 16, v16
    ds_write_b32 v4, v16 offset:0
    v_lshl_or_b32 v17, v33, 16, v17
    ds_write_b32 v4, v17 offset:16
    v_lshl_or_b32 v18, v34, 16, v18
    ds_write_b32 v4, v18 offset:32
    v_lshl_or_b32 v19, v35, 16, v19
    ds_write_b32 v4, v19 offset:48
    v_lshl_or_b32 v20, v36, 16, v20
    ds_write_b32 v4, v20 offset:64
    v_lshl_or_b32 v21, v37, 16, v21
    ds_write_b32 v4, v21 offset:80
    v_lshl_or_b32 v22, v38, 16, v22
    ds_write_b32 v4, v22 offset:96
    v_lshl_or_b32 v23, v39, 16, v23
    ds_write_b32 v4, v23 offset:112
    v_lshl_or_b32 v24, v40, 16, v24
    ds_write_b32 v4, v24 offset:128
    v_lshl_or_b32 v25, v41, 16, v25
    ds_write_b32 v4, v25 offset:144
    v_lshl_or_b32 v26, v42, 16, v26
    ds_write_b32 v4, v26 offset:160
    v_lshl_or_b32 v27, v43, 16, v27
    ds_write_b32 v4, v27 offset:176
    v_lshl_or_b32 v28, v44, 16, v28
    ds_write_b32 v4, v28 offset:192
    v_lshl_or_b32 v29, v45, 16, v29
    ds_write_b32 v4, v29 offset:208
    v_lshl_or_b32 v30, v46, 16, v30
    ds_write_b32 v4, v30 offset:224
    v_lshl_or_b32 v31, v47, 16, v31
    ds_write_b32 v4, v31 offset:240
    v_lshrrev_b32 v7, 4, v0
    v_and_b32 v8, 15, v0
    v_mul_u32_u24 v5, 65, v7
    v_lshl_add_u32 v5, v8, 2, v5
    v_lshlrev_b32 v5, 2, v5
    s_waitcnt lgkmcnt(0)
    s_barrier
    ds_read_b32 v16, v5 offset:0
    ds_read_b32 v17, v5 offset:4
    ds_read_b32 v18, v5 offset:8
    ds_read_b32 v19, v5 offset:12
    ds_read_b32 v20, v5 offset:4160
    ds_read_b32 v21, v5 offset:4164
    ds_read_b32 v22, v5 offset:4168
    ds_read_b32 v23, v5 offset:4172
    ds_read_b32 v24, v5 offset:8320
    ds_read_b32 v25, v5 offset:8324
    ds_read_b32 v26, v5 offset:8328
    ds_read_b32 v27, v5 offset:8332
    ds_read_b32 v28, v5 offset:12480
    ds_read_b32 v29, v5 offset:12484
    ds_read_b32 v30, v5 offset:12488
    ds_read_b32 v31, v5 offset:12492
    s_lshl_b32 s18, s17, 6
    v_add_u32 v6, s18, v7
    v_lshlrev_b32 v6, 13, v6
    s_lshl_b32 s18, s16, 8
    v_add_u32 v6, s18, v6
    v_lshl_add_u32 v6, v8, 4, v6
    s_waitcnt lgkmcnt(0)
    s_mov_b32 s18, 0
    buffer_store_dwordx4 v[16:19], v6, s[12:15], s18 offen sc1
    s_mov_b32 s18, 131072
    buffer_store_dwordx4 v[20:23], v6, s[12:15], s18 offen sc1
    s_mov_b32 s18, 262144
    buffer_store_dwordx4 v[24:27], v6, s[12:15], s18 offen sc1
    s_mov_b32 s18, 393216
    buffer_store_dwordx4 v[28:31], v6, s[12:15], s18 offen sc1
    s_add_u32 s99, s99, 64
    s_cmp_lt_u32 s99, 288
    s_cbranch_scc1 mega_kernel_f0l
    s_branch mega_kernel_f1d
mega_kernel_f1:
    s_barrier
    s_load_dwordx2 s[4:5], s[0:1], 56
    s_load_dwordx2 s[8:9], s[0:1], 96
    v_and_b32 v1, 31, v0
    v_lshrrev_b32 v2, 5, v0
    v_cvt_f32_u32 v3, v1
    s_waitcnt lgkmcnt(0)
    s_mov_b32 s6, 4194304
    s_mov_b32 s7, 0x00020000
    s_mov_b32 s10, 268435456
    s_mov_b32 s11, 0x00020000
    s_lshl_b32 s12, s92, 15
    v_lshlrev_b32 v6, 12, v2
    v_lshl_add_u32 v6, v1, 1, v6
    buffer_load_ushort v16, v6, s[4:7], s12 offen offset:0
    buffer_load_ushort v48, v6, s[4:7], s12 offen offset:2048
    buffer_load_ushort v17, v6, s[4:7], s12 offen offset:64
    buffer_load_ushort v49, v6, s[4:7], s12 offen offset:2112
    buffer_load_ushort v18, v6, s[4:7], s12 offen offset:128
    buffer_load_ushort v50, v6, s[4:7], s12 offen offset:2176
    buffer_load_ushort v19, v6, s[4:7], s12 offen offset:192
    buffer_load_ushort v51, v6, s[4:7], s12 offen offset:2240
    buffer_load_ushort v20, v6, s[4:7], s12 offen offset:256
    buffer_load_ushort v52, v6, s[4:7], s12 offen offset:2304
    buffer_load_ushort v21, v6, s[4:7], s12 offen offset:320
    buffer_load_ushort v53, v6, s[4:7], s12 offen offset:2368
    buffer_load_ushort v22, v6, s[4:7], s12 offen offset:384
    buffer_load_ushort v54, v6, s[4:7], s12 offen offset:2432
    buffer_load_ushort v23, v6, s[4:7], s12 offen offset:448
    buffer_load_ushort v55, v6, s[4:7], s12 offen offset:2496
    buffer_load_ushort v24, v6, s[4:7], s12 offen offset:512
    buffer_load_ushort v56, v6, s[4:7], s12 offen offset:2560
    buffer_load_ushort v25, v6, s[4:7], s12 offen offset:576
    buffer_load_ushort v57, v6, s[4:7], s12 offen offset:2624
    buffer_load_ushort v26, v6, s[4:7], s12 offen offset:640
    buffer_load_ushort v58, v6, s[4:7], s12 offen offset:2688
    buffer_load_ushort v27, v6, s[4:7], s12 offen offset:704
    buffer_load_ushort v59, v6, s[4:7], s12 offen offset:2752
    buffer_load_ushort v28, v6, s[4:7], s12 offen offset:768
    buffer_load_ushort v60, v6, s[4:7], s12 offen offset:2816
    buffer_load_ushort v29, v6, s[4:7], s12 offen offset:832
    buffer_load_ushort v61, v6, s[4:7], s12 offen offset:2880
    buffer_load_ushort v30, v6, s[4:7], s12 offen offset:896
    buffer_load_ushort v62, v6, s[4:7], s12 offen offset:2944
    buffer_load_ushort v31, v6, s[4:7], s12 offen offset:960
    buffer_load_ushort v63, v6, s[4:7], s12 offen offset:3008
    buffer_load_ushort v32, v6, s[4:7], s12 offen offset:1024
    buffer_load_ushort v64, v6, s[4:7], s12 offen offset:3072
    buffer_load_ushort v33, v6, s[4:7], s12 offen offset:1088
    buffer_load_ushort v65, v6, s[4:7], s12 offen offset:3136
    buffer_load_ushort v34, v6, s[4:7], s12 offen offset:1152
    buffer_load_ushort v66, v6, s[4:7], s12 offen offset:3200
    buffer_load_ushort v35, v6, s[4:7], s12 offen offset:1216
    buffer_load_ushort v67, v6, s[4:7], s12 offen offset:3264
    buffer_load_ushort v36, v6, s[4:7], s12 offen offset:1280
    buffer_load_ushort v68, v6, s[4:7], s12 offen offset:3328
    buffer_load_ushort v37, v6, s[4:7], s12 offen offset:1344
    buffer_load_ushort v69, v6, s[4:7], s12 offen offset:3392
    buffer_load_ushort v38, v6, s[4:7], s12 offen offset:1408
    buffer_load_ushort v70, v6, s[4:7], s12 offen offset:3456
    buffer_load_ushort v39, v6, s[4:7], s12 offen offset:1472
    buffer_load_ushort v71, v6, s[4:7], s12 offen offset:3520
    buffer_load_ushort v40, v6, s[4:7], s12 offen offset:1536
    buffer_load_ushort v72, v6, s[4:7], s12 offen offset:3584
    buffer_load_ushort v41, v6, s[4:7], s12 offen offset:1600
    buffer_load_ushort v73, v6, s[4:7], s12 offen offset:3648
    buffer_load_ushort v42, v6, s[4:7], s12 offen offset:1664
    buffer_load_ushort v74, v6, s[4:7], s12 offen offset:3712
    buffer_load_ushort v43, v6, s[4:7], s12 offen offset:1728
    buffer_load_ushort v75, v6, s[4:7], s12 offen offset:3776
    buffer_load_ushort v44, v6, s[4:7], s12 offen offset:1792
    buffer_load_ushort v76, v6, s[4:7], s12 offen offset:3840
    buffer_load_ushort v45, v6, s[4:7], s12 offen offset:1856
    buffer_load_ushort v77, v6, s[4:7], s12 offen offset:3904
    buffer_load_ushort v46, v6, s[4:7], s12 offen offset:1920
    buffer_load_ushort v78, v6, s[4:7], s12 offen offset:3968
    buffer_load_ushort v47, v6, s[4:7], s12 offen offset:1984
    buffer_load_ushort v79, v6, s[4:7], s12 offen offset:4032
    s_movk_i32 s13, 8448
    v_mul_lo_u32 v7, v2, s13
    v_lshl_add_u32 v4, v1, 3, v7
    s_movk_i32 s13, 264
    v_mul_lo_u32 v5, v1, s13
    v_add_u32 v5, v5, v7
    s_waitcnt vmcnt(0)
    v_lshlrev_b32 v16, 16, v16
    v_lshlrev_b32 v48, 16, v48
    v_lshlrev_b32 v17, 16, v17
    v_lshlrev_b32 v49, 16, v49
    v_lshlrev_b32 v18, 16, v18
    v_lshlrev_b32 v50, 16, v50
    v_lshlrev_b32 v19, 16, v19
    v_lshlrev_b32 v51, 16, v51
    v_lshlrev_b32 v20, 16, v20
    v_lshlrev_b32 v52, 16, v52
    v_lshlrev_b32 v21, 16, v21
    v_lshlrev_b32 v53, 16, v53
    v_lshlrev_b32 v22, 16, v22
    v_lshlrev_b32 v54, 16, v54
    v_lshlrev_b32 v23, 16, v23
    v_lshlrev_b32 v55, 16, v55
    v_lshlrev_b32 v24, 16, v24
    v_lshlrev_b32 v56, 16, v56
    v_lshlrev_b32 v25, 16, v25
    v_lshlrev_b32 v57, 16, v57
    v_lshlrev_b32 v26, 16, v26
    v_lshlrev_b32 v58, 16, v58
    v_lshlrev_b32 v27, 16, v27
    v_lshlrev_b32 v59, 16, v59
    v_lshlrev_b32 v28, 16, v28
    v_lshlrev_b32 v60, 16, v60
    v_lshlrev_b32 v29, 16, v29
    v_lshlrev_b32 v61, 16, v61
    v_lshlrev_b32 v30, 16, v30
    v_lshlrev_b32 v62, 16, v62
    v_lshlrev_b32 v31, 16, v31
    v_lshlrev_b32 v63, 16, v63
    v_lshlrev_b32 v32, 16, v32
    v_lshlrev_b32 v64, 16, v64
    v_lshlrev_b32 v33, 16, v33
    v_lshlrev_b32 v65, 16, v65
    v_lshlrev_b32 v34, 16, v34
    v_lshlrev_b32 v66, 16, v66
    v_lshlrev_b32 v35, 16, v35
    v_lshlrev_b32 v67, 16, v67
    v_lshlrev_b32 v36, 16, v36
    v_lshlrev_b32 v68, 16, v68
    v_lshlrev_b32 v37, 16, v37
    v_lshlrev_b32 v69, 16, v69
    v_lshlrev_b32 v38, 16, v38
    v_lshlrev_b32 v70, 16, v70
    v_lshlrev_b32 v39, 16, v39
    v_lshlrev_b32 v71, 16, v71
    v_lshlrev_b32 v40, 16, v40
    v_lshlrev_b32 v72, 16, v72
    v_lshlrev_b32 v41, 16, v41
    v_lshlrev_b32 v73, 16, v73
    v_lshlrev_b32 v42, 16, v42
    v_lshlrev_b32 v74, 16, v74
    v_lshlrev_b32 v43, 16, v43
    v_lshlrev_b32 v75, 16, v75
    v_lshlrev_b32 v44, 16, v44
    v_lshlrev_b32 v76, 16, v76
    v_lshlrev_b32 v45, 16, v45
    v_lshlrev_b32 v77, 16, v77
    v_lshlrev_b32 v46, 16, v46
    v_lshlrev_b32 v78, 16, v78
    v_lshlrev_b32 v47, 16, v47
    v_lshlrev_b32 v79, 16, v79
    v_sub_f32 v80, v16, v32
    v_sub_f32 v81, v48, v64
    v_add_f32 v16, v16, v32
    v_add_f32 v48, v48, v64
    v_sub_f32 v32, v17, v33
    v_sub_f32 v64, v49, v65
    v_add_f32 v17, v17, v33
    v_add_f32 v49, v49, v65
    v_mul_f32 v33, 0x3f7b14be, v32
    v_mul_f32 v65, 0xbe47c5c2, v32
    v_fmac_f32 v33, 0x3e47c5c2, v64
    v_fmac_f32 v65, 0x3f7b14be, v64
    v_sub_f32 v32, v18, v34
    v_sub_f32 v64, v50, v66
    v_add_f32 v18, v18, v34
    v_add_f32 v50, v50, v66
    v_mul_f32 v34, 0x3f6c835e, v32
    v_mul_f32 v66, 0xbec3ef15, v32
    v_fmac_f32 v34, 0x3ec3ef15, v64
    v_fmac_f32 v66, 0x3f6c835e, v64
    v_sub_f32 v32, v19, v35
    v_sub_f32 v64, v51, v67
    v_add_f32 v19, v19, v35
    v_add_f32 v51, v51, v67
    v_mul_f32 v35, 0x3f54db31, v32
    v_mul_f32 v67, 0xbf0e39da, v32
    v_fmac_f32 v35, 0x3f0e39da, v64
    v_fmac_f32 v67, 0x3f54db31, v64
    v_sub_f32 v32, v20, v36
    v_sub_f32 v64, v52, v68
    v_add_f32 v20, v20, v36
    v_add_f32 v52, v52, v68
    v_mul_f32 v36, 0x3f3504f3, v32
    v_mul_f32 v68, 0xbf3504f3, v32
    v_fmac_f32 v36, 0x3f3504f3, v64
    v_fmac_f32 v68, 0x3f3504f3, v64
    v_sub_f32 v32, v21, v37
    v_sub_f32 v64, v53, v69
    v_add_f32 v21, v21, v37
    v_add_f32 v53, v53, v69
    v_mul_f32 v37, 0x3f0e39da, v32
    v_mul_f32 v69, 0xbf54db31, v32
    v_fmac_f32 v37, 0x3f54db31, v64
    v_fmac_f32 v69, 0x3f0e39da, v64
    v_sub_f32 v32, v22, v38
    v_sub_f32 v64, v54, v70
    v_add_f32 v22, v22, v38
    v_add_f32 v54, v54, v70
    v_mul_f32 v38, 0x3ec3ef15, v32
    v_mul_f32 v70, 0xbf6c835e, v32
    v_fmac_f32 v38, 0x3f6c835e, v64
    v_fmac_f32 v70, 0x3ec3ef15, v64
    v_sub_f32 v32, v23, v39
    v_sub_f32 v64, v55, v71
    v_add_f32 v23, v23, v39
    v_add_f32 v55, v55, v71
    v_mul_f32 v39, 0x3e47c5c2, v32
    v_mul_f32 v71, 0xbf7b14be, v32
    v_fmac_f32 v39, 0x3f7b14be, v64
    v_fmac_f32 v71, 0x3e47c5c2, v64
    v_sub_f32 v32, v56, v72
    v_sub_f32 v64, v40, v24
    v_add_f32 v24, v24, v40
    v_add_f32 v56, v56, v72
    v_sub_f32 v40, v25, v41
    v_sub_f32 v72, v57, v73
    v_add_f32 v25, v25, v41
    v_add_f32 v57, v57, v73
    v_mul_f32 v41, 0xbe47c5c2, v40
    v_mul_f32 v73, 0xbf7b14be, v40
    v_fmac_f32 v41, 0x3f7b14be, v72
    v_fmac_f32 v73, 0xbe47c5c2, v72
    v_sub_f32 v40, v26, v42
    v_sub_f32 v72, v58, v74
    v_add_f32 v26, v26, v42
    v_add_f32 v58, v58, v74
    v_mul_f32 v42, 0xbec3ef15, v40
    v_mul_f32 v74, 0xbf6c835e, v40
    v_fmac_f32 v42, 0x3f6c835e, v72
    v_fmac_f32 v74, 0xbec3ef15, v72
    v_sub_f32 v40, v27, v43
    v_sub_f32 v72, v59, v75
    v_add_f32 v27, v27, v43
    v_add_f32 v59, v59, v75
    v_mul_f32 v43, 0xbf0e39da, v40
    v_mul_f32 v75, 0xbf54db31, v40
    v_fmac_f32 v43, 0x3f54db31, v72
    v_fmac_f32 v75, 0xbf0e39da, v72
    v_sub_f32 v40, v28, v44
    v_sub_f32 v72, v60, v76
    v_add_f32 v28, v28, v44
    v_add_f32 v60, v60, v76
    v_mul_f32 v44, 0xbf3504f3, v40
    v_mul_f32 v76, 0xbf3504f3, v40
    v_fmac_f32 v44, 0x3f3504f3, v72
    v_fmac_f32 v76, 0xbf3504f3, v72
    v_sub_f32 v40, v29, v45
    v_sub_f32 v72, v61, v77
    v_add_f32 v29, v29, v45
    v_add_f32 v61, v61, v77
    v_mul_f32 v45, 0xbf54db31, v40
    v_mul_f32 v77, 0xbf0e39da, v40
    v_fmac_f32 v45, 0x3f0e39da, v72
    v_fmac_f32 v77, 0xbf54db31, v72
    v_sub_f32 v40, v30, v46
    v_sub_f32 v72, v62, v78
    v_add_f32 v30, v30, v46
    v_add_f32 v62, v62, v78
    v_mul_f32 v46, 0xbf6c835e, v40
    v_mul_f32 v78, 0xbec3ef15, v40
    v_fmac_f32 v46, 0x3ec3ef15, v72
    v_fmac_f32 v78, 0xbf6c835e, v72
    v_sub_f32 v40, v31, v47
    v_sub_f32 v72, v63, v79
    v_add_f32 v31, v31, v47
    v_add_f32 v63, v63, v79
    v_mul_f32 v47, 0xbf7b14be, v40
    v_mul_f32 v79, 0xbe47c5c2, v40
    v_fmac_f32 v47, 0x3e47c5c2, v72
    v_fmac_f32 v79, 0xbf7b14be, v72
    v_sub_f32 v40, v16, v24
    v_sub_f32 v72, v48, v56
    v_add_f32 v16, v16, v24
    v_add_f32 v48, v48, v56
    v_sub_f32 v24, v17, v25
    v_sub_f32 v56, v49, v57
    v_add_f32 v17, v17, v25
    v_add_f32 v49, v49, v57
    v_mul_f32 v25, 0x3f6c835e, v24
    v_mul_f32 v57, 0xbec3ef15, v24
    v_fmac_f32 v25, 0x3ec3ef15, v56
    v_fmac_f32 v57, 0x3f6c835e, v56
    v_sub_f32 v24, v18, v26
    v_sub_f32 v56, v50, v58
    v_add_f32 v18, v18, v26
    v_add_f32 v50, v50, v58
    v_mul_f32 v26, 0x3f3504f3, v24
    v_mul_f32 v58, 0xbf3504f3, v24
    v_fmac_f32 v26, 0x3f3504f3, v56
    v_fmac_f32 v58, 0x3f3504f3, v56
    v_sub_f32 v24, v19, v27
    v_sub_f32 v56, v51, v59
    v_add_f32 v19, v19, v27
    v_add_f32 v51, v51, v59
    v_mul_f32 v27, 0x3ec3ef15, v24
    v_mul_f32 v59, 0xbf6c835e, v24
    v_fmac_f32 v27, 0x3f6c835e, v56
    v_fmac_f32 v59, 0x3ec3ef15, v56
    v_sub_f32 v24, v52, v60
    v_sub_f32 v56, v28, v20
    v_add_f32 v20, v20, v28
    v_add_f32 v52, v52, v60
    v_sub_f32 v28, v21, v29
    v_sub_f32 v60, v53, v61
    v_add_f32 v21, v21, v29
    v_add_f32 v53, v53, v61
    v_mul_f32 v29, 0xbec3ef15, v28
    v_mul_f32 v61, 0xbf6c835e, v28
    v_fmac_f32 v29, 0x3f6c835e, v60
    v_fmac_f32 v61, 0xbec3ef15, v60
    v_sub_f32 v28, v22, v30
    v_sub_f32 v60, v54, v62
    v_add_f32 v22, v22, v30
    v_add_f32 v54, v54, v62
    v_mul_f32 v30, 0xbf3504f3, v28
    v_mul_f32 v62, 0xbf3504f3, v28
    v_fmac_f32 v30, 0x3f3504f3, v60
    v_fmac_f32 v62, 0xbf3504f3, v60
    v_sub_f32 v28, v23, v31
    v_sub_f32 v60, v55, v63
    v_add_f32 v23, v23, v31
    v_add_f32 v55, v55, v63
    v_mul_f32 v31, 0xbf6c835e, v28
    v_mul_f32 v63, 0xbec3ef15, v28
    v_fmac_f32 v31, 0x3ec3ef15, v60
    v_fmac_f32 v63, 0xbf6c835e, v60
    v_sub_f32 v28, v80, v32
    v_sub_f32 v60, v81, v64
    v_add_f32 v80, v80, v32
    v_add_f32 v81, v81, v64
    v_sub_f32 v32, v33, v41
    v_sub_f32 v64, v65, v73
    v_add_f32 v33, v33, v41
    v_add_f32 v65, v65, v73
    v_mul_f32 v41, 0x3f6c835e, v32
    v_mul_f32 v73, 0xbec3ef15, v32
    v_fmac_f32 v41, 0x3ec3ef15, v64
    v_fmac_f32 v73, 0x3f6c835e, v64
    v_sub_f32 v32, v34, v42
    v_sub_f32 v64, v66, v74
    v_add_f32 v34, v34, v42
    v_add_f32 v66, v66, v74
    v_mul_f32 v42, 0x3f3504f3, v32
    v_mul_f32 v74, 0xbf3504f3, v32
    v_fmac_f32 v42, 0x3f3504f3, v64
    v_fmac_f32 v74, 0x3f3504f3, v64
    v_sub_f32 v32, v35, v43
    v_sub_f32 v64, v67, v75
    v_add_f32 v35, v35, v43
    v_add_f32 v67, v67, v75
    v_mul_f32 v43, 0x3ec3ef15, v32
    v_mul_f32 v75, 0xbf6c835e, v32
    v_fmac_f32 v43, 0x3f6c835e, v64
    v_fmac_f32 v75, 0x3ec3ef15, v64
    v_sub_f32 v32, v68, v76
    v_sub_f32 v64, v44, v36
    v_add_f32 v36, v36, v44
    v_add_f32 v68, v68, v76
    v_sub_f32 v44, v37, v45
    v_sub_f32 v76, v69, v77
    v_add_f32 v37, v37, v45
    v_add_f32 v69, v69, v77
    v_mul_f32 v45, 0xbec3ef15, v44
    v_mul_f32 v77, 0xbf6c835e, v44
    v_fmac_f32 v45, 0x3f6c835e, v76
    v_fmac_f32 v77, 0xbec3ef15, v76
    v_sub_f32 v44, v38, v46
    v_sub_f32 v76, v70, v78
    v_add_f32 v38, v38, v46
    v_add_f32 v70, v70, v78
    v_mul_f32 v46, 0xbf3504f3, v44
    v_mul_f32 v78, 0xbf3504f3, v44
    v_fmac_f32 v46, 0x3f3504f3, v76
    v_fmac_f32 v78, 0xbf3504f3, v76
    v_sub_f32 v44, v39, v47
    v_sub_f32 v76, v71, v79
    v_add_f32 v39, v39, v47
    v_add_f32 v71, v71, v79
    v_mul_f32 v47, 0xbf6c835e, v44
    v_mul_f32 v79, 0xbec3ef15, v44
    v_fmac_f32 v47, 0x3ec3ef15, v76
    v_fmac_f32 v79, 0xbf6c835e, v76
    v_sub_f32 v44, v16, v20
    v_sub_f32 v76, v48, v52
    v_add_f32 v16, v16, v20
    v_add_f32 v48, v48, v52
    v_sub_f32 v20, v17, v21
    v_sub_f32 v52, v49, v53
    v_add_f32 v17, v17, v21
    v_add_f32 v49, v49, v53
    v_mul_f32 v21, 0x3f3504f3, v20
    v_mul_f32 v53, 0xbf3504f3, v20
    v_fmac_f32 v21, 0x3f3504f3, v52
    v_fmac_f32 v53, 0x3f3504f3, v52
    v_sub_f32 v20, v50, v54
    v_sub_f32 v52, v22, v18
    v_add_f32 v18, v18, v22
    v_add_f32 v50, v50, v54
    v_sub_f32 v22, v19, v23
    v_sub_f32 v54, v51, v55
    v_add_f32 v19, v19, v23
    v_add_f32 v51, v51, v55
    v_mul_f32 v23, 0xbf3504f3, v22
    v_mul_f32 v55, 0xbf3504f3, v22
    v_fmac_f32 v23, 0x3f3504f3, v54
    v_fmac_f32 v55, 0xbf3504f3, v54
    v_sub_f32 v22, v40, v24
    v_sub_f32 v54, v72, v56
    v_add_f32 v40, v40, v24
    v_add_f32 v72, v72, v56
    v_sub_f32 v24, v25, v29
    v_sub_f32 v56, v57, v61
    v_add_f32 v25, v25, v29
    v_add_f32 v57, v57, v61
    v_mul_f32 v29, 0x3f3504f3, v24
    v_mul_f32 v61, 0xbf3504f3, v24
    v_fmac_f32 v29, 0x3f3504f3, v56
    v_fmac_f32 v61, 0x3f3504f3, v56
    v_sub_f32 v24, v58, v62
    v_sub_f32 v56, v30, v26
    v_add_f32 v26, v26, v30
    v_add_f32 v58, v58, v62
    v_sub_f32 v30, v27, v31
    v_sub_f32 v62, v59, v63
    v_add_f32 v27, v27, v31
    v_add_f32 v59, v59, v63
    v_mul_f32 v31, 0xbf3504f3, v30
    v_mul_f32 v63, 0xbf3504f3, v30
    v_fmac_f32 v31, 0x3f3504f3, v62
    v_fmac_f32 v63, 0xbf3504f3, v62
    v_sub_f32 v30, v80, v36
    v_sub_f32 v62, v81, v68
    v_add_f32 v80, v80, v36
    v_add_f32 v81, v81, v68
    v_sub_f32 v36, v33, v37
    v_sub_f32 v68, v65, v69
    v_add_f32 v33, v33, v37
    v_add_f32 v65, v65, v69
    v_mul_f32 v37, 0x3f3504f3, v36
    v_mul_f32 v69, 0xbf3504f3, v36
    v_fmac_f32 v37, 0x3f3504f3, v68
    v_fmac_f32 v69, 0x3f3504f3, v68
    v_sub_f32 v36, v66, v70
    v_sub_f32 v68, v38, v34
    v_add_f32 v34, v34, v38
    v_add_f32 v66, v66, v70
    v_sub_f32 v38, v35, v39
    v_sub_f32 v70, v67, v71
    v_add_f32 v35, v35, v39
    v_add_f32 v67, v67, v71
    v_mul_f32 v39, 0xbf3504f3, v38
    v_mul_f32 v71, 0xbf3504f3, v38
    v_fmac_f32 v39, 0x3f3504f3, v70
    v_fmac_f32 v71, 0xbf3504f3, v70
    v_sub_f32 v38, v28, v32
    v_sub_f32 v70, v60, v64
    v_add_f32 v28, v28, v32
    v_add_f32 v60, v60, v64
    v_sub_f32 v32, v41, v45
    v_sub_f32 v64, v73, v77
    v_add_f32 v41, v41, v45
    v_add_f32 v73, v73, v77
    v_mul_f32 v45, 0x3f3504f3, v32
    v_mul_f32 v77, 0xbf3504f3, v32
    v_fmac_f32 v45, 0x3f3504f3, v64
    v_fmac_f32 v77, 0x3f3504f3, v64
    v_sub_f32 v32, v74, v78
    v_sub_f32 v64, v46, v42
    v_add_f32 v42, v42, v46
    v_add_f32 v74, v74, v78
    v_sub_f32 v46, v43, v47
    v_sub_f32 v78, v75, v79
    v_add_f32 v43, v43, v47
    v_add_f32 v75, v75, v79
    v_mul_f32 v47, 0xbf3504f3, v46
    v_mul_f32 v79, 0xbf3504f3, v46
    v_fmac_f32 v47, 0x3f3504f3, v78
    v_fmac_f32 v79, 0xbf3504f3, v78
    v_sub_f32 v46, v16, v18
    v_sub_f32 v78, v48, v50
    v_add_f32 v16, v16, v18
    v_add_f32 v48, v48, v50
    v_sub_f32 v18, v49, v51
    v_sub_f32 v50, v19, v17
    v_add_f32 v17, v17, v19
    v_add_f32 v49, v49, v51
    v_sub_f32 v19, v44, v20
    v_sub_f32 v51, v76, v52
    v_add_f32 v44, v44, v20
    v_add_f32 v76, v76, v52
    v_sub_f32 v20, v53, v55
    v_sub_f32 v52, v23, v21
    v_add_f32 v21, v21, v23
    v_add_f32 v53, v53, v55
    v_sub_f32 v23, v40, v26
    v_sub_f32 v55, v72, v58
    v_add_f32 v40, v40, v26
    v_add_f32 v72, v72, v58
    v_sub_f32 v26, v57, v59
    v_sub_f32 v58, v27, v25
    v_add_f32 v25, v25, v27
    v_add_f32 v57, v57, v59
    v_sub_f32 v27, v22, v24
    v_sub_f32 v59, v54, v56
    v_add_f32 v22, v22, v24
    v_add_f32 v54, v54, v56
    v_sub_f32 v24, v61, v63
    v_sub_f32 v56, v31, v29
    v_add_f32 v29, v29, v31
    v_add_f32 v61, v61, v63
    v_sub_f32 v31, v80, v34
    v_sub_f32 v63, v81, v66
    v_add_f32 v80, v80, v34
    v_add_f32 v81, v81, v66
    v_sub_f32 v34, v65, v67
    v_sub_f32 v66, v35, v33
    v_add_f32 v33, v33, v35
    v_add_f32 v65, v65, v67
    v_sub_f32 v35, v30, v36
    v_sub_f32 v67, v62, v68
    v_add_f32 v30, v30, v36
    v_add_f32 v62, v62, v68
    v_sub_f32 v36, v69, v71
    v_sub_f32 v68, v39, v37
    v_add_f32 v37, v37, v39
    v_add_f32 v69, v69, v71
    v_sub_f32 v39, v28, v42
    v_sub_f32 v71, v60, v74
    v_add_f32 v28, v28, v42
    v_add_f32 v60, v60, v74
    v_sub_f32 v42, v73, v75
    v_sub_f32 v74, v43, v41
    v_add_f32 v41, v41, v43
    v_add_f32 v73, v73, v75
    v_sub_f32 v43, v38, v32
    v_sub_f32 v75, v70, v64
    v_add_f32 v38, v38, v32
    v_add_f32 v70, v70, v64
    v_sub_f32 v32, v77, v79
    v_sub_f32 v64, v47, v45
    v_add_f32 v45, v45, v47
    v_add_f32 v77, v77, v79
    v_sub_f32 v47, v16, v17
    v_sub_f32 v79, v48, v49
    v_add_f32 v16, v16, v17
    v_add_f32 v48, v48, v49
    v_sub_f32 v17, v46, v18
    v_sub_f32 v49, v78, v50
    v_add_f32 v46, v46, v18
    v_add_f32 v78, v78, v50
    v_sub_f32 v18, v44, v21
    v_sub_f32 v50, v76, v53
    v_add_f32 v44, v44, v21
    v_add_f32 v76, v76, v53
    v_sub_f32 v21, v19, v20
    v_sub_f32 v53, v51, v52
    v_add_f32 v19, v19, v20
    v_add_f32 v51, v51, v52
    v_sub_f32 v20, v40, v25
    v_sub_f32 v52, v72, v57
    v_add_f32 v40, v40, v25
    v_add_f32 v72, v72, v57
    v_sub_f32 v25, v23, v26
    v_sub_f32 v57, v55, v58
    v_add_f32 v23, v23, v26
    v_add_f32 v55, v55, v58
    v_sub_f32 v26, v22, v29
    v_sub_f32 v58, v54, v61
    v_add_f32 v22, v22, v29
    v_add_f32 v54, v54, v61
    v_sub_f32 v29, v27, v24
    v_sub_f32 v61, v59, v56
    v_add_f32 v27, v27, v24
    v_add_f32 v59, v59, v56
    v_sub_f32 v24, v80, v33
    v_sub_f32 v56, v81, v65
    v_add_f32 v80, v80, v33
    v_add_f32 v81, v81, v65
    v_sub_f32 v33, v31, v34
    v_sub_f32 v65, v63, v66
    v_add_f32 v31, v31, v34
    v_add_f32 v63, v63, v66
    v_sub_f32 v34, v30, v37
    v_sub_f32 v66, v62, v69
    v_add_f32 v30, v30, v37
    v_add_f32 v62, v62, v69
    v_sub_f32 v37, v35, v36
    v_sub_f32 v69, v67, v68
    v_add_f32 v35, v35, v36
    v_add_f32 v67, v67, v68
    v_sub_f32 v36, v28, v41
    v_sub_f32 v68, v60, v73
    v_add_f32 v28, v28, v41
    v_add_f32 v60, v60, v73
    v_sub_f32 v41, v39, v42
    v_sub_f32 v73, v71, v74
    v_add_f32 v39, v39, v42
    v_add_f32 v71, v71, v74
    v_sub_f32 v42, v38, v45
    v_sub_f32 v74, v70, v77
    v_add_f32 v38, v38, v45
    v_add_f32 v70, v70, v77
    v_sub_f32 v45, v43, v32
    v_sub_f32 v77, v75, v64
    v_add_f32 v43, v43, v32
    v_add_f32 v75, v75, v64
    v_mul_f32 v32, 0xba800000, v3
    v_cos_f32 v64, v32
    v_sin_f32 v82, v32
    s_nop 0
    v_mul_f32 v83, v80, v64
    v_fma_f32 v83, -v81, v82, v83
    v_mul_f32 v81, v81, v64
    v_fmac_f32 v81, v80, v82
    v_mul_f32 v32, 0xbb000000, v3
    v_cos_f32 v64, v32
    v_sin_f32 v82, v32
    s_nop 0
    v_mul_f32 v80, v40, v64
    v_fma_f32 v80, -v72, v82, v80
    v_mul_f32 v72, v72, v64
    v_fmac_f32 v72, v40, v82
    v_mul_f32 v32, 0xbb400000, v3
    v_cos_f32 v64, v32
    v_sin_f32 v82, v32
    s_nop 0
    v_mul_f32 v40, v28, v64
    v_fma_f32 v40, -v60, v82, v40
    v_mul_f32 v60, v60, v64
    v_fmac_f32 v60, v28, v82
    v_mul_f32 v32, 0xbb800000, v3
    v_cos_f32 v64, v32
    v_sin_f32 v82, v32
    s_nop 0
    v_mul_f32 v28, v44, v64
    v_fma_f32 v28, -v76, v82, v28
    v_mul_f32 v76, v76, v64
    v_fmac_f32 v76, v44, v82
    v_mul_f32 v32, 0xbba00000, v3
    v_cos_f32 v64, v32
    v_sin_f32 v82, v32
    s_nop 0
    v_mul_f32 v44, v30, v64
    v_fma_f32 v44, -v62, v82, v44
    v_mul_f32 v62, v62, v64
    v_fmac_f32 v62, v30, v82
    v_mul_f32 v32, 0xbbc00000, v3
    v_cos_f32 v64, v32
    v_sin_f32 v82, v32
    s_nop 0
    v_mul_f32 v30, v22, v64
    v_fma_f32 v30, -v54, v82, v30
    v_mul_f32 v54, v54, v64
    v_fmac_f32 v54, v22, v82
    v_mul_f32 v32, 0xbbe00000, v3
    v_cos_f32 v64, v32
    v_sin_f32 v82, v32
    s_nop 0
    v_mul_f32 v22, v38, v64
    v_fma_f32 v22, -v70, v82, v22
    v_mul_f32 v70, v70, v64
    v_fmac_f32 v70, v38, v82
    v_mul_f32 v32, 0xbc000000, v3
    v_cos_f32 v64, v32
    v_sin_f32 v82, v32
    s_nop 0
    v_mul_f32 v38, v46, v64
    v_fma_f32 v38, -v78, v82, v38
    v_mul_f32 v78, v78, v64
    v_fmac_f32 v78, v46, v82
    v_mul_f32 v32, 0xbc100000, v3
    v_cos_f32 v64, v32
    v_sin_f32 v82, v32
    s_nop 0
    v_mul_f32 v46, v31, v64
    v_fma_f32 v46, -v63, v82, v46
    v_mul_f32 v63, v63, v64
    v_fmac_f32 v63, v31, v82
    v_mul_f32 v32, 0xbc200000, v3
    v_cos_f32 v64, v32
    v_sin_f32 v82, v32
    s_nop 0
    v_mul_f32 v31, v23, v64
    v_fma_f32 v31, -v55, v82, v31
    v_mul_f32 v55, v55, v64
    v_fmac_f32 v55, v23, v82
    v_mul_f32 v32, 0xbc300000, v3
    v_cos_f32 v64, v32
    v_sin_f32 v82, v32
    s_nop 0
    v_mul_f32 v23, v39, v64
    v_fma_f32 v23, -v71, v82, v23
    v_mul_f32 v71, v71, v64
    v_fmac_f32 v71, v39, v82
    v_mul_f32 v32, 0xbc400000, v3
    v_cos_f32 v64, v32
    v_sin_f32 v82, v32
    s_nop 0
    v_mul_f32 v39, v19, v64
    v_fma_f32 v39, -v51, v82, v39
    v_mul_f32 v51, v51, v64
    v_fmac_f32 v51, v19, v82
    v_mul_f32 v32, 0xbc500000, v3
    v_cos_f32 v64, v32
    v_sin_f32 v82, v32
    s_nop 0
    v_mul_f32 v19, v35, v64
    v_fma_f32 v19, -v67, v82, v19
    v_mul_f32 v67, v67, v64
    v_fmac_f32 v67, v35, v82
    v_mul_f32 v32, 0xbc600000, v3
    v_cos_f32 v64, v32
    v_sin_f32 v82, v32
    s_nop 0
    v_mul_f32 v35, v27, v64
    v_fma_f32 v35, -v59, v82, v35
    v_mul_f32 v59, v59, v64
    v_fmac_f32 v59, v27, v82
    v_mul_f32 v32, 0xbc700000, v3
    v_cos_f32 v64, v32
    v_sin_f32 v82, v32
    s_nop 0
    v_mul_f32 v27, v43, v64
    v_fma_f32 v27, -v75, v82, v27
    v_mul_f32 v75, v75, v64
    v_fmac_f32 v75, v43, v82
    v_mul_f32 v32, 0xbc800000, v3
    v_cos_f32 v64, v32
    v_sin_f32 v82, v32
    s_nop 0
    v_mul_f32 v43, v47, v64
    v_fma_f32 v43, -v79, v82, v43
    v_mul_f32 v79, v79, v64
    v_fmac_f32 v79, v47, v82
    v_mul_f32 v32, 0xbc880000, v3
    v_cos_f32 v64, v32
    v_sin_f32 v82, v32
    s_nop 0
    v_mul_f32 v47, v24, v64
    v_fma_f32 v47, -v56, v82, v47
    v_mul_f32 v56, v56, v64
    v_fmac_f32 v56, v24, v82
    v_mul_f32 v32, 0xbc900000, v3
    v_cos_f32 v64, v32
    v_sin_f32 v82, v32
    s_nop 0
    v_mul_f32 v24, v20, v64
    v_fma_f32 v24, -v52, v82, v24
    v_mul_f32 v52, v52, v64
    v_fmac_f32 v52, v20, v82
    v_mul_f32 v32, 0xbc980000, v3
    v_cos_f32 v64, v32
    v_sin_f32 v82, v32
    s_nop 0
    v_mul_f32 v20, v36, v64
    v_fma_f32 v20, -v68, v82, v20
    v_mul_f32 v68, v68, v64
    v_fmac_f32 v68, v36, v82
    v_mul_f32 v32, 0xbca00000, v3
    v_cos_f32 v64, v32
    v_sin_f32 v82, v32
    s_nop 0
    v_mul_f32 v36, v18, v64
    v_fma_f32 v36, -v50, v82, v36
    v_mul_f32 v50, v50, v64
    v_fmac_f32 v50, v18, v82
    v_mul_f32 v32, 0xbca80000, v3
    v_cos_f32 v64, v32
    v_sin_f32 v82, v32
    s_nop 0
    v_mul_f32 v18, v34, v64
    v_fma_f32 v18, -v66, v82, v18
    v_mul_f32 v66, v66, v64
    v_fmac_f32 v66, v34, v82
    v_mul_f32 v32, 0xbcb00000, v3
    v_cos_f32 v64, v32
    v_sin_f32 v82, v32
    s_nop 0
    v_mul_f32 v34, v26, v64
    v_fma_f32 v34, -v58, v82, v34
    v_mul_f32 v58, v58, v64
    v_fmac_f32 v58, v26, v82
    v_mul_f32 v32, 0xbcb80000, v3
    v_cos_f32 v64, v32
    v_sin_f32 v82, v32
    s_nop 0
    v_mul_f32 v26, v42, v64
    v_fma_f32 v26, -v74, v82, v26
    v_mul_f32 v74, v74, v64
    v_fmac_f32 v74, v42, v82
    v_mul_f32 v32, 0xbcc00000, v3
    v_cos_f32 v64, v32
    v_sin_f32 v82, v32
    s_nop 0
    v_mul_f32 v42, v17, v64
    v_fma_f32 v42, -v49, v82, v42
    v_mul_f32 v49, v49, v64
    v_fmac_f32 v49, v17, v82
    v_mul_f32 v32, 0xbcc80000, v3
    v_cos_f32 v64, v32
    v_sin_f32 v82, v32
    s_nop 0
    v_mul_f32 v17, v33, v64
    v_fma_f32 v17, -v65, v82, v17
    v_mul_f32 v65, v65, v64
    v_fmac_f32 v65, v33, v82
    v_mul_f32 v32, 0xbcd00000, v3
    v_cos_f32 v64, v32
    v_sin_f32 v82, v32
    s_nop 0
    v_mul_f32 v33, v25, v64
    v_fma_f32 v33, -v57, v82, v33
    v_mul_f32 v57, v57, v64
    v_fmac_f32 v57, v25, v82
    v_mul_f32 v32, 0xbcd80000, v3
    v_cos_f32 v64, v32
    v_sin_f32 v82, v32
    s_nop 0
    v_mul_f32 v25, v41, v64
    v_fma_f32 v25, -v73, v82, v25
    v_mul_f32 v73, v73, v64
    v_fmac_f32 v73, v41, v82
    v_mul_f32 v32, 0xbce00000, v3
    v_cos_f32 v64, v32
    v_sin_f32 v82, v32
    s_nop 0
    v_mul_f32 v41, v21, v64
    v_fma_f32 v41, -v53, v82, v41
    v_mul_f32 v53, v53, v64
    v_fmac_f32 v53, v21, v82
    v_mul_f32 v32, 0xbce80000, v3
    v_cos_f32 v64, v32
    v_sin_f32 v82, v32
    s_nop 0
    v_mul_f32 v21, v37, v64
    v_fma_f32 v21, -v69, v82, v21
    v_mul_f32 v69, v69, v64
    v_fmac_f32 v69, v37, v82
    v_mul_f32 v32, 0xbcf00000, v3
    v_cos_f32 v64, v32
    v_sin_f32 v82, v32
    s_nop 0
    v_mul_f32 v37, v29, v64
    v_fma_f32 v37, -v61, v82, v37
    v_mul_f32 v61, v61, v64
    v_fmac_f32 v61, v29, v82
    v_mul_f32 v32, 0xbcf80000, v3
    v_cos_f32 v64, v32
    v_sin_f32 v82, v32
    s_nop 0
    v_mul_f32 v29, v45, v64
    v_fma_f32 v29, -v77, v82, v29
    v_mul_f32 v77, v77, v64
    v_fmac_f32 v77, v45, v82
    ds_write_b32 v4, v16 offset:0
    ds_write_b32 v4, v48 offset:4
    ds_write_b32 v4, v83 offset:264
    ds_write_b32 v4, v81 offset:268
    ds_write_b32 v4, v80 offset:528
    ds_write_b32 v4, v72 offset:532
    ds_write_b32 v4, v40 offset:792
    ds_write_b32 v4, v60 offset:796
    ds_write_b32 v4, v28 offset:1056
    ds_write_b32 v4, v76 offset:1060
    ds_write_b32 v4, v44 offset:1320
    ds_write_b32 v4, v62 offset:1324
    ds_write_b32 v4, v30 offset:1584
    ds_write_b32 v4, v54 offset:1588
    ds_write_b32 v4, v22 offset:1848
    ds_write_b32 v4, v70 offset:1852
    ds_write_b32 v4, v38 offset:2112
    ds_write_b32 v4, v78 offset:2116
    ds_write_b32 v4, v46 offset:2376
    ds_write_b32 v4, v63 offset:2380
    ds_write_b32 v4, v31 offset:2640
    ds_write_b32 v4, v55 offset:2644
    ds_write_b32 v4, v23 offset:2904
    ds_write_b32 v4, v71 offset:2908
    ds_write_b32 v4, v39 offset:3168
    ds_write_b32 v4, v51 offset:3172
    ds_write_b32 v4, v19 offset:3432
    ds_write_b32 v4, v67 offset:3436
    ds_write_b32 v4, v35 offset:3696
    ds_write_b32 v4, v59 offset:3700
    ds_write_b32 v4, v27 offset:3960
    ds_write_b32 v4, v75 offset:3964
    ds_write_b32 v4, v43 offset:4224
    ds_write_b32 v4, v79 offset:4228
    ds_write_b32 v4, v47 offset:4488
    ds_write_b32 v4, v56 offset:4492
    ds_write_b32 v4, v24 offset:4752
    ds_write_b32 v4, v52 offset:4756
    ds_write_b32 v4, v20 offset:5016
    ds_write_b32 v4, v68 offset:5020
    ds_write_b32 v4, v36 offset:5280
    ds_write_b32 v4, v50 offset:5284
    ds_write_b32 v4, v18 offset:5544
    ds_write_b32 v4, v66 offset:5548
    ds_write_b32 v4, v34 offset:5808
    ds_write_b32 v4, v58 offset:5812
    ds_write_b32 v4, v26 offset:6072
    ds_write_b32 v4, v74 offset:6076
    ds_write_b32 v4, v42 offset:6336
    ds_write_b32 v4, v49 offset:6340
    ds_write_b32 v4, v17 offset:6600
    ds_write_b32 v4, v65 offset:6604
    ds_write_b32 v4, v33 offset:6864
    ds_write_b32 v4, v57 offset:6868
    ds_write_b32 v4, v25 offset:7128
    ds_write_b32 v4, v73 offset:7132
    ds_write_b32 v4, v41 offset:7392
    ds_write_b32 v4, v53 offset:7396
    ds_write_b32 v4, v21 offset:7656
    ds_write_b32 v4, v69 offset:7660
    ds_write_b32 v4, v37 offset:7920
    ds_write_b32 v4, v61 offset:7924
    ds_write_b32 v4, v29 offset:8184
    ds_write_b32 v4, v77 offset:8188
    s_waitcnt lgkmcnt(0)
    ds_read_b32 v16, v5 offset:0
    ds_read_b32 v48, v5 offset:4
    ds_read_b32 v83, v5 offset:8
    ds_read_b32 v81, v5 offset:12
    ds_read_b32 v80, v5 offset:16
    ds_read_b32 v72, v5 offset:20
    ds_read_b32 v40, v5 offset:24
    ds_read_b32 v60, v5 offset:28
    ds_read_b32 v28, v5 offset:32
    ds_read_b32 v76, v5 offset:36
    ds_read_b32 v44, v5 offset:40
    ds_read_b32 v62, v5 offset:44
    ds_read_b32 v30, v5 offset:48
    ds_read_b32 v54, v5 offset:52
    s_waitcnt lgkmcnt(0)
    ds_read_b32 v22, v5 offset:56
    ds_read_b32 v70, v5 offset:60
    ds_read_b32 v38, v5 offset:64
    ds_read_b32 v78, v5 offset:68
    ds_read_b32 v46, v5 offset:72
    ds_read_b32 v63, v5 offset:76
    ds_read_b32 v31, v5 offset:80
    ds_read_b32 v55, v5 offset:84
    ds_read_b32 v23, v5 offset:88
    ds_read_b32 v71, v5 offset:92
    ds_read_b32 v39, v5 offset:96
    ds_read_b32 v51, v5 offset:100
    ds_read_b32 v19, v5 offset:104
    ds_read_b32 v67, v5 offset:108
    s_waitcnt lgkmcnt(0)
    ds_read_b32 v35, v5 offset:112
    ds_read_b32 v59, v5 offset:116
    ds_read_b32 v27, v5 offset:120
    ds_read_b32 v75, v5 offset:124
    ds_read_b32 v43, v5 offset:128
    ds_read_b32 v79, v5 offset:132
    ds_read_b32 v47, v5 offset:136
    ds_read_b32 v56, v5 offset:140
    ds_read_b32 v24, v5 offset:144
    ds_read_b32 v52, v5 offset:148
    ds_read_b32 v20, v5 offset:152
    ds_read_b32 v68, v5 offset:156
    ds_read_b32 v36, v5 offset:160
    ds_read_b32 v50, v5 offset:164
    s_waitcnt lgkmcnt(0)
    ds_read_b32 v18, v5 offset:168
    ds_read_b32 v66, v5 offset:172
    ds_read_b32 v34, v5 offset:176
    ds_read_b32 v58, v5 offset:180
    ds_read_b32 v26, v5 offset:184
    ds_read_b32 v74, v5 offset:188
    ds_read_b32 v42, v5 offset:192
    ds_read_b32 v49, v5 offset:196
    ds_read_b32 v17, v5 offset:200
    ds_read_b32 v65, v5 offset:204
    ds_read_b32 v33, v5 offset:208
    ds_read_b32 v57, v5 offset:212
    ds_read_b32 v25, v5 offset:216
    ds_read_b32 v73, v5 offset:220
    s_waitcnt lgkmcnt(0)
    ds_read_b32 v41, v5 offset:224
    ds_read_b32 v53, v5 offset:228
    ds_read_b32 v21, v5 offset:232
    ds_read_b32 v69, v5 offset:236
    ds_read_b32 v37, v5 offset:240
    ds_read_b32 v61, v5 offset:244
    ds_read_b32 v29, v5 offset:248
    ds_read_b32 v77, v5 offset:252
    s_waitcnt lgkmcnt(0)
    v_sub_f32 v32, v16, v43
    v_sub_f32 v64, v48, v79
    v_add_f32 v16, v16, v43
    v_add_f32 v48, v48, v79
    v_sub_f32 v43, v83, v47
    v_sub_f32 v79, v81, v56
    v_add_f32 v83, v83, v47
    v_add_f32 v81, v81, v56
    v_mul_f32 v47, 0x3f7b14be, v43
    v_mul_f32 v56, 0xbe47c5c2, v43
    v_fmac_f32 v47, 0x3e47c5c2, v79
    v_fmac_f32 v56, 0x3f7b14be, v79
    v_sub_f32 v43, v80, v24
    v_sub_f32 v79, v72, v52
    v_add_f32 v80, v80, v24
    v_add_f32 v72, v72, v52
    v_mul_f32 v24, 0x3f6c835e, v43
    v_mul_f32 v52, 0xbec3ef15, v43
    v_fmac_f32 v24, 0x3ec3ef15, v79
    v_fmac_f32 v52, 0x3f6c835e, v79
    v_sub_f32 v43, v40, v20
    v_sub_f32 v79, v60, v68
    v_add_f32 v40, v40, v20
    v_add_f32 v60, v60, v68
    v_mul_f32 v20, 0x3f54db31, v43
    v_mul_f32 v68, 0xbf0e39da, v43
    v_fmac_f32 v20, 0x3f0e39da, v79
    v_fmac_f32 v68, 0x3f54db31, v79
    v_sub_f32 v43, v28, v36
    v_sub_f32 v79, v76, v50
    v_add_f32 v28, v28, v36
    v_add_f32 v76, v76, v50
    v_mul_f32 v36, 0x3f3504f3, v43
    v_mul_f32 v50, 0xbf3504f3, v43
    v_fmac_f32 v36, 0x3f3504f3, v79
    v_fmac_f32 v50, 0x3f3504f3, v79
    v_sub_f32 v43, v44, v18
    v_sub_f32 v79, v62, v66
    v_add_f32 v44, v44, v18
    v_add_f32 v62, v62, v66
    v_mul_f32 v18, 0x3f0e39da, v43
    v_mul_f32 v66, 0xbf54db31, v43
    v_fmac_f32 v18, 0x3f54db31, v79
    v_fmac_f32 v66, 0x3f0e39da, v79
    v_sub_f32 v43, v30, v34
    v_sub_f32 v79, v54, v58
    v_add_f32 v30, v30, v34
    v_add_f32 v54, v54, v58
    v_mul_f32 v34, 0x3ec3ef15, v43
    v_mul_f32 v58, 0xbf6c835e, v43
    v_fmac_f32 v34, 0x3f6c835e, v79
    v_fmac_f32 v58, 0x3ec3ef15, v79
    v_sub_f32 v43, v22, v26
    v_sub_f32 v79, v70, v74
    v_add_f32 v22, v22, v26
    v_add_f32 v70, v70, v74
    v_mul_f32 v26, 0x3e47c5c2, v43
    v_mul_f32 v74, 0xbf7b14be, v43
    v_fmac_f32 v26, 0x3f7b14be, v79
    v_fmac_f32 v74, 0x3e47c5c2, v79
    v_sub_f32 v43, v78, v49
    v_sub_f32 v79, v42, v38
    v_add_f32 v38, v38, v42
    v_add_f32 v78, v78, v49
    v_sub_f32 v42, v46, v17
    v_sub_f32 v49, v63, v65
    v_add_f32 v46, v46, v17
    v_add_f32 v63, v63, v65
    v_mul_f32 v17, 0xbe47c5c2, v42
    v_mul_f32 v65, 0xbf7b14be, v42
    v_fmac_f32 v17, 0x3f7b14be, v49
    v_fmac_f32 v65, 0xbe47c5c2, v49
    v_sub_f32 v42, v31, v33
    v_sub_f32 v49, v55, v57
    v_add_f32 v31, v31, v33
    v_add_f32 v55, v55, v57
    v_mul_f32 v33, 0xbec3ef15, v42
    v_mul_f32 v57, 0xbf6c835e, v42
    v_fmac_f32 v33, 0x3f6c835e, v49
    v_fmac_f32 v57, 0xbec3ef15, v49
    v_sub_f32 v42, v23, v25
    v_sub_f32 v49, v71, v73
    v_add_f32 v23, v23, v25
    v_add_f32 v71, v71, v73
    v_mul_f32 v25, 0xbf0e39da, v42
    v_mul_f32 v73, 0xbf54db31, v42
    v_fmac_f32 v25, 0x3f54db31, v49
    v_fmac_f32 v73, 0xbf0e39da, v49
    v_sub_f32 v42, v39, v41
    v_sub_f32 v49, v51, v53
    v_add_f32 v39, v39, v41
    v_add_f32 v51, v51, v53
    v_mul_f32 v41, 0xbf3504f3, v42
    v_mul_f32 v53, 0xbf3504f3, v42
    v_fmac_f32 v41, 0x3f3504f3, v49
    v_fmac_f32 v53, 0xbf3504f3, v49
    v_sub_f32 v42, v19, v21
    v_sub_f32 v49, v67, v69
    v_add_f32 v19, v19, v21
    v_add_f32 v67, v67, v69
    v_mul_f32 v21, 0xbf54db31, v42
    v_mul_f32 v69, 0xbf0e39da, v42
    v_fmac_f32 v21, 0x3f0e39da, v49
    v_fmac_f32 v69, 0xbf54db31, v49
    v_sub_f32 v42, v35, v37
    v_sub_f32 v49, v59, v61
    v_add_f32 v35, v35, v37
    v_add_f32 v59, v59, v61
    v_mul_f32 v37, 0xbf6c835e, v42
    v_mul_f32 v61, 0xbec3ef15, v42
    v_fmac_f32 v37, 0x3ec3ef15, v49
    v_fmac_f32 v61, 0xbf6c835e, v49
    v_sub_f32 v42, v27, v29
    v_sub_f32 v49, v75, v77
    v_add_f32 v27, v27, v29
    v_add_f32 v75, v75, v77
    v_mul_f32 v29, 0xbf7b14be, v42
    v_mul_f32 v77, 0xbe47c5c2, v42
    v_fmac_f32 v29, 0x3e47c5c2, v49
    v_fmac_f32 v77, 0xbf7b14be, v49
    v_sub_f32 v42, v16, v38
    v_sub_f32 v49, v48, v78
    v_add_f32 v16, v16, v38
    v_add_f32 v48, v48, v78
    v_sub_f32 v38, v83, v46
    v_sub_f32 v78, v81, v63
    v_add_f32 v83, v83, v46
    v_add_f32 v81, v81, v63
    v_mul_f32 v46, 0x3f6c835e, v38
    v_mul_f32 v63, 0xbec3ef15, v38
    v_fmac_f32 v46, 0x3ec3ef15, v78
    v_fmac_f32 v63, 0x3f6c835e, v78
    v_sub_f32 v38, v80, v31
    v_sub_f32 v78, v72, v55
    v_add_f32 v80, v80, v31
    v_add_f32 v72, v72, v55
    v_mul_f32 v31, 0x3f3504f3, v38
    v_mul_f32 v55, 0xbf3504f3, v38
    v_fmac_f32 v31, 0x3f3504f3, v78
    v_fmac_f32 v55, 0x3f3504f3, v78
    v_sub_f32 v38, v40, v23
    v_sub_f32 v78, v60, v71
    v_add_f32 v40, v40, v23
    v_add_f32 v60, v60, v71
    v_mul_f32 v23, 0x3ec3ef15, v38
    v_mul_f32 v71, 0xbf6c835e, v38
    v_fmac_f32 v23, 0x3f6c835e, v78
    v_fmac_f32 v71, 0x3ec3ef15, v78
    v_sub_f32 v38, v76, v51
    v_sub_f32 v78, v39, v28
    v_add_f32 v28, v28, v39
    v_add_f32 v76, v76, v51
    v_sub_f32 v39, v44, v19
    v_sub_f32 v51, v62, v67
    v_add_f32 v44, v44, v19
    v_add_f32 v62, v62, v67
    v_mul_f32 v19, 0xbec3ef15, v39
    v_mul_f32 v67, 0xbf6c835e, v39
    v_fmac_f32 v19, 0x3f6c835e, v51
    v_fmac_f32 v67, 0xbec3ef15, v51
    v_sub_f32 v39, v30, v35
    v_sub_f32 v51, v54, v59
    v_add_f32 v30, v30, v35
    v_add_f32 v54, v54, v59
    v_mul_f32 v35, 0xbf3504f3, v39
    v_mul_f32 v59, 0xbf3504f3, v39
    v_fmac_f32 v35, 0x3f3504f3, v51
    v_fmac_f32 v59, 0xbf3504f3, v51
    v_sub_f32 v39, v22, v27
    v_sub_f32 v51, v70, v75
    v_add_f32 v22, v22, v27
    v_add_f32 v70, v70, v75
    v_mul_f32 v27, 0xbf6c835e, v39
    v_mul_f32 v75, 0xbec3ef15, v39
    v_fmac_f32 v27, 0x3ec3ef15, v51
    v_fmac_f32 v75, 0xbf6c835e, v51
    v_sub_f32 v39, v32, v43
    v_sub_f32 v51, v64, v79
    v_add_f32 v32, v32, v43
    v_add_f32 v64, v64, v79
    v_sub_f32 v43, v47, v17
    v_sub_f32 v79, v56, v65
    v_add_f32 v47, v47, v17
    v_add_f32 v56, v56, v65
    v_mul_f32 v17, 0x3f6c835e, v43
    v_mul_f32 v65, 0xbec3ef15, v43
    v_fmac_f32 v17, 0x3ec3ef15, v79
    v_fmac_f32 v65, 0x3f6c835e, v79
    v_sub_f32 v43, v24, v33
    v_sub_f32 v79, v52, v57
    v_add_f32 v24, v24, v33
    v_add_f32 v52, v52, v57
    v_mul_f32 v33, 0x3f3504f3, v43
    v_mul_f32 v57, 0xbf3504f3, v43
    v_fmac_f32 v33, 0x3f3504f3, v79
    v_fmac_f32 v57, 0x3f3504f3, v79
    v_sub_f32 v43, v20, v25
    v_sub_f32 v79, v68, v73
    v_add_f32 v20, v20, v25
    v_add_f32 v68, v68, v73
    v_mul_f32 v25, 0x3ec3ef15, v43
    v_mul_f32 v73, 0xbf6c835e, v43
    v_fmac_f32 v25, 0x3f6c835e, v79
    v_fmac_f32 v73, 0x3ec3ef15, v79
    v_sub_f32 v43, v50, v53
    v_sub_f32 v79, v41, v36
    v_add_f32 v36, v36, v41
    v_add_f32 v50, v50, v53
    v_sub_f32 v41, v18, v21
    v_sub_f32 v53, v66, v69
    v_add_f32 v18, v18, v21
    v_add_f32 v66, v66, v69
    v_mul_f32 v21, 0xbec3ef15, v41
    v_mul_f32 v69, 0xbf6c835e, v41
    v_fmac_f32 v21, 0x3f6c835e, v53
    v_fmac_f32 v69, 0xbec3ef15, v53
    v_sub_f32 v41, v34, v37
    v_sub_f32 v53, v58, v61
    v_add_f32 v34, v34, v37
    v_add_f32 v58, v58, v61
    v_mul_f32 v37, 0xbf3504f3, v41
    v_mul_f32 v61, 0xbf3504f3, v41
    v_fmac_f32 v37, 0x3f3504f3, v53
    v_fmac_f32 v61, 0xbf3504f3, v53
    v_sub_f32 v41, v26, v29
    v_sub_f32 v53, v74, v77
    v_add_f32 v26, v26, v29
    v_add_f32 v74, v74, v77
    v_mul_f32 v29, 0xbf6c835e, v41
    v_mul_f32 v77, 0xbec3ef15, v41
    v_fmac_f32 v29, 0x3ec3ef15, v53
    v_fmac_f32 v77, 0xbf6c835e, v53
    v_sub_f32 v41, v16, v28
    v_sub_f32 v53, v48, v76
    v_add_f32 v16, v16, v28
    v_add_f32 v48, v48, v76
    v_sub_f32 v28, v83, v44
    v_sub_f32 v76, v81, v62
    v_add_f32 v83, v83, v44
    v_add_f32 v81, v81, v62
    v_mul_f32 v44, 0x3f3504f3, v28
    v_mul_f32 v62, 0xbf3504f3, v28
    v_fmac_f32 v44, 0x3f3504f3, v76
    v_fmac_f32 v62, 0x3f3504f3, v76
    v_sub_f32 v28, v72, v54
    v_sub_f32 v76, v30, v80
    v_add_f32 v80, v80, v30
    v_add_f32 v72, v72, v54
    v_sub_f32 v30, v40, v22
    v_sub_f32 v54, v60, v70
    v_add_f32 v40, v40, v22
    v_add_f32 v60, v60, v70
    v_mul_f32 v22, 0xbf3504f3, v30
    v_mul_f32 v70, 0xbf3504f3, v30
    v_fmac_f32 v22, 0x3f3504f3, v54
    v_fmac_f32 v70, 0xbf3504f3, v54
    v_sub_f32 v30, v42, v38
    v_sub_f32 v54, v49, v78
    v_add_f32 v42, v42, v38
    v_add_f32 v49, v49, v78
    v_sub_f32 v38, v46, v19
    v_sub_f32 v78, v63, v67
    v_add_f32 v46, v46, v19
    v_add_f32 v63, v63, v67
    v_mul_f32 v19, 0x3f3504f3, v38
    v_mul_f32 v67, 0xbf3504f3, v38
    v_fmac_f32 v19, 0x3f3504f3, v78
    v_fmac_f32 v67, 0x3f3504f3, v78
    v_sub_f32 v38, v55, v59
    v_sub_f32 v78, v35, v31
    v_add_f32 v31, v31, v35
    v_add_f32 v55, v55, v59
    v_sub_f32 v35, v23, v27
    v_sub_f32 v59, v71, v75
    v_add_f32 v23, v23, v27
    v_add_f32 v71, v71, v75
    v_mul_f32 v27, 0xbf3504f3, v35
    v_mul_f32 v75, 0xbf3504f3, v35
    v_fmac_f32 v27, 0x3f3504f3, v59
    v_fmac_f32 v75, 0xbf3504f3, v59
    v_sub_f32 v35, v32, v36
    v_sub_f32 v59, v64, v50
    v_add_f32 v32, v32, v36
    v_add_f32 v64, v64, v50
    v_sub_f32 v36, v47, v18
    v_sub_f32 v50, v56, v66
    v_add_f32 v47, v47, v18
    v_add_f32 v56, v56, v66
    v_mul_f32 v18, 0x3f3504f3, v36
    v_mul_f32 v66, 0xbf3504f3, v36
    v_fmac_f32 v18, 0x3f3504f3, v50
    v_fmac_f32 v66, 0x3f3504f3, v50
    v_sub_f32 v36, v52, v58
    v_sub_f32 v50, v34, v24
    v_add_f32 v24, v24, v34
    v_add_f32 v52, v52, v58
    v_sub_f32 v34, v20, v26
    v_sub_f32 v58, v68, v74
    v_add_f32 v20, v20, v26
    v_add_f32 v68, v68, v74
    v_mul_f32 v26, 0xbf3504f3, v34
    v_mul_f32 v74, 0xbf3504f3, v34
    v_fmac_f32 v26, 0x3f3504f3, v58
    v_fmac_f32 v74, 0xbf3504f3, v58
    v_sub_f32 v34, v39, v43
    v_sub_f32 v58, v51, v79
    v_add_f32 v39, v39, v43
    v_add_f32 v51, v51, v79
    v_sub_f32 v43, v17, v21
    v_sub_f32 v79, v65, v69
    v_add_f32 v17, v17, v21
    v_add_f32 v65, v65, v69
    v_mul_f32 v21, 0x3f3504f3, v43
    v_mul_f32 v69, 0xbf3504f3, v43
    v_fmac_f32 v21, 0x3f3504f3, v79
    v_fmac_f32 v69, 0x3f3504f3, v79
    v_sub_f32 v43, v57, v61
    v_sub_f32 v79, v37, v33
    v_add_f32 v33, v33, v37
    v_add_f32 v57, v57, v61
    v_sub_f32 v37, v25, v29
    v_sub_f32 v61, v73, v77
    v_add_f32 v25, v25, v29
    v_add_f32 v73, v73, v77
    v_mul_f32 v29, 0xbf3504f3, v37
    v_mul_f32 v77, 0xbf3504f3, v37
    v_fmac_f32 v29, 0x3f3504f3, v61
    v_fmac_f32 v77, 0xbf3504f3, v61
    v_sub_f32 v37, v16, v80
    v_sub_f32 v61, v48, v72
    v_add_f32 v16, v16, v80
    v_add_f32 v48, v48, v72
    v_sub_f32 v80, v81, v60
    v_sub_f32 v72, v40, v83
    v_add_f32 v83, v83, v40
    v_add_f32 v81, v81, v60
    v_sub_f32 v40, v41, v28
    v_sub_f32 v60, v53, v76
    v_add_f32 v41, v41, v28
    v_add_f32 v53, v53, v76
    v_sub_f32 v28, v62, v70
    v_sub_f32 v76, v22, v44
    v_add_f32 v44, v44, v22
    v_add_f32 v62, v62, v70
    v_sub_f32 v22, v42, v31
    v_sub_f32 v70, v49, v55
    v_add_f32 v42, v42, v31
    v_add_f32 v49, v49, v55
    v_sub_f32 v31, v63, v71
    v_sub_f32 v55, v23, v46
    v_add_f32 v46, v46, v23
    v_add_f32 v63, v63, v71
    v_sub_f32 v23, v30, v38
    v_sub_f32 v71, v54, v78
    v_add_f32 v30, v30, v38
    v_add_f32 v54, v54, v78
    v_sub_f32 v38, v67, v75
    v_sub_f32 v78, v27, v19
    v_add_f32 v19, v19, v27
    v_add_f32 v67, v67, v75
    v_sub_f32 v27, v32, v24
    v_sub_f32 v75, v64, v52
    v_add_f32 v32, v32, v24
    v_add_f32 v64, v64, v52
    v_sub_f32 v24, v56, v68
    v_sub_f32 v52, v20, v47
    v_add_f32 v47, v47, v20
    v_add_f32 v56, v56, v68
    v_sub_f32 v20, v35, v36
    v_sub_f32 v68, v59, v50
    v_add_f32 v35, v35, v36
    v_add_f32 v59, v59, v50
    v_sub_f32 v36, v66, v74
    v_sub_f32 v50, v26, v18
    v_add_f32 v18, v18, v26
    v_add_f32 v66, v66, v74
    v_sub_f32 v26, v39, v33
    v_sub_f32 v74, v51, v57
    v_add_f32 v39, v39, v33
    v_add_f32 v51, v51, v57
    v_sub_f32 v33, v65, v73
    v_sub_f32 v57, v25, v17
    v_add_f32 v17, v17, v25
    v_add_f32 v65, v65, v73
    v_sub_f32 v25, v34, v43
    v_sub_f32 v73, v58, v79
    v_add_f32 v34, v34, v43
    v_add_f32 v58, v58, v79
    v_sub_f32 v43, v69, v77
    v_sub_f32 v79, v29, v21
    v_add_f32 v21, v21, v29
    v_add_f32 v69, v69, v77
    v_sub_f32 v29, v16, v83
    v_sub_f32 v77, v48, v81
    v_add_f32 v16, v16, v83
    v_add_f32 v48, v48, v81
    v_sub_f32 v83, v37, v80
    v_sub_f32 v81, v61, v72
    v_add_f32 v37, v37, v80
    v_add_f32 v61, v61, v72
    v_sub_f32 v80, v41, v44
    v_sub_f32 v72, v53, v62
    v_add_f32 v41, v41, v44
    v_add_f32 v53, v53, v62
    v_sub_f32 v44, v40, v28
    v_sub_f32 v62, v60, v76
    v_add_f32 v40, v40, v28
    v_add_f32 v60, v60, v76
    v_sub_f32 v28, v42, v46
    v_sub_f32 v76, v49, v63
    v_add_f32 v42, v42, v46
    v_add_f32 v49, v49, v63
    v_sub_f32 v46, v22, v31
    v_sub_f32 v63, v70, v55
    v_add_f32 v22, v22, v31
    v_add_f32 v70, v70, v55
    v_sub_f32 v31, v30, v19
    v_sub_f32 v55, v54, v67
    v_add_f32 v30, v30, v19
    v_add_f32 v54, v54, v67
    v_sub_f32 v19, v23, v38
    v_sub_f32 v67, v71, v78
    v_add_f32 v23, v23, v38
    v_add_f32 v71, v71, v78
    v_sub_f32 v38, v32, v47
    v_sub_f32 v78, v64, v56
    v_add_f32 v32, v32, v47
    v_add_f32 v64, v64, v56
    v_sub_f32 v47, v27, v24
    v_sub_f32 v56, v75, v52
    v_add_f32 v27, v27, v24
    v_add_f32 v75, v75, v52
    v_sub_f32 v24, v35, v18
    v_sub_f32 v52, v59, v66
    v_add_f32 v35, v35, v18
    v_add_f32 v59, v59, v66
    v_sub_f32 v18, v20, v36
    v_sub_f32 v66, v68, v50
    v_add_f32 v20, v20, v36
    v_add_f32 v68, v68, v50
    v_sub_f32 v36, v39, v17
    v_sub_f32 v50, v51, v65
    v_add_f32 v39, v39, v17
    v_add_f32 v51, v51, v65
    v_sub_f32 v17, v26, v33
    v_sub_f32 v65, v74, v57
    v_add_f32 v26, v26, v33
    v_add_f32 v74, v74, v57
    v_sub_f32 v33, v34, v21
    v_sub_f32 v57, v58, v69
    v_add_f32 v34, v34, v21
    v_add_f32 v58, v58, v69
    v_sub_f32 v21, v25, v43
    v_sub_f32 v69, v73, v79
    v_add_f32 v25, v25, v43
    v_add_f32 v73, v73, v79
    ds_write_b32 v4, v16 offset:0
    ds_write_b32 v4, v48 offset:4
    ds_write_b32 v4, v32 offset:256
    ds_write_b32 v4, v64 offset:260
    ds_write_b32 v4, v42 offset:512
    ds_write_b32 v4, v49 offset:516
    ds_write_b32 v4, v39 offset:768
    ds_write_b32 v4, v51 offset:772
    ds_write_b32 v4, v41 offset:1024
    ds_write_b32 v4, v53 offset:1028
    ds_write_b32 v4, v35 offset:1280
    ds_write_b32 v4, v59 offset:1284
    ds_write_b32 v4, v30 offset:1536
    ds_write_b32 v4, v54 offset:1540
    ds_write_b32 v4, v34 offset:1792
    ds_write_b32 v4, v58 offset:1796
    ds_write_b32 v4, v37 offset:2048
    ds_write_b32 v4, v61 offset:2052
    ds_write_b32 v4, v27 offset:2304
    ds_write_b32 v4, v75 offset:2308
    ds_write_b32 v4, v22 offset:2560
    ds_write_b32 v4, v70 offset:2564
    ds_write_b32 v4, v26 offset:2816
    ds_write_b32 v4, v74 offset:2820
    ds_write_b32 v4, v40 offset:3072
    ds_write_b32 v4, v60 offset:3076
    ds_write_b32 v4, v20 offset:3328
    ds_write_b32 v4, v68 offset:3332
    ds_write_b32 v4, v23 offset:3584
    ds_write_b32 v4, v71 offset:3588
    ds_write_b32 v4, v25 offset:3840
    ds_write_b32 v4, v73 offset:3844
    ds_write_b32 v4, v29 offset:4096
    ds_write_b32 v4, v77 offset:4100
    ds_write_b32 v4, v38 offset:4352
    ds_write_b32 v4, v78 offset:4356
    ds_write_b32 v4, v28 offset:4608
    ds_write_b32 v4, v76 offset:4612
    ds_write_b32 v4, v36 offset:4864
    ds_write_b32 v4, v50 offset:4868
    ds_write_b32 v4, v80 offset:5120
    ds_write_b32 v4, v72 offset:5124
    ds_write_b32 v4, v24 offset:5376
    ds_write_b32 v4, v52 offset:5380
    ds_write_b32 v4, v31 offset:5632
    ds_write_b32 v4, v55 offset:5636
    ds_write_b32 v4, v33 offset:5888
    ds_write_b32 v4, v57 offset:5892
    ds_write_b32 v4, v83 offset:6144
    ds_write_b32 v4, v81 offset:6148
    ds_write_b32 v4, v47 offset:6400
    ds_write_b32 v4, v56 offset:6404
    ds_write_b32 v4, v46 offset:6656
    ds_write_b32 v4, v63 offset:6660
    ds_write_b32 v4, v17 offset:6912
    ds_write_b32 v4, v65 offset:6916
    ds_write_b32 v4, v44 offset:7168
    ds_write_b32 v4, v62 offset:7172
    ds_write_b32 v4, v18 offset:7424
    ds_write_b32 v4, v66 offset:7428
    ds_write_b32 v4, v19 offset:7680
    ds_write_b32 v4, v67 offset:7684
    ds_write_b32 v4, v21 offset:7936
    ds_write_b32 v4, v69 offset:7940
    s_waitcnt lgkmcnt(0)
    s_barrier
    v_and_b32 v6, 7, v0
    v_lshrrev_b32 v7, 3, v0
    s_movk_i32 s13, 8448
    v_mul_lo_u32 v8, v6, s13
    v_lshl_add_u32 v4, v7, 3, v8
    v_lshlrev_b32 v5, 14, v7
    v_lshl_add_u32 v5, v6, 4, v5
    s_lshl_b32 s12, s92, 7
    s_add_u32 s12, s12, 96468992
    v_sub_u32 v6, 1024, v7
    v_and_b32 v6, 1023, v6
    v_lshl_add_u32 v6, v6, 3, v8
    ds_read_b64 v[16:17], v4 offset:0
    ds_read_b64 v[18:19], v6
    s_waitcnt lgkmcnt(0)
    v_add_f32 v20, v16, v18
    v_sub_f32 v21, v17, v19
    v_add_f32 v22, v17, v19
    v_sub_f32 v23, v18, v16
    s_mov_b32 s13, s12
    s_add_u32 s13, s12, 0
    buffer_store_dwordx4 v[20:23], v5, s[8:11], s13 offen sc1
    s_nop 1
    v_sub_u32 v6, 992, v7
    v_and_b32 v6, 1023, v6
    v_lshl_add_u32 v6, v6, 3, v8
    ds_read_b64 v[16:17], v4 offset:256
    ds_read_b64 v[18:19], v6
    s_waitcnt lgkmcnt(0)
    v_add_f32 v20, v16, v18
    v_sub_f32 v21, v17, v19
    v_add_f32 v22, v17, v19
    v_sub_f32 v23, v18, v16
    s_mov_b32 s13, s12
    s_add_u32 s13, s12, 524288
    buffer_store_dwordx4 v[20:23], v5, s[8:11], s13 offen sc1
    s_nop 1
    v_sub_u32 v6, 960, v7
    v_and_b32 v6, 1023, v6
    v_lshl_add_u32 v6, v6, 3, v8
    ds_read_b64 v[16:17], v4 offset:512
    ds_read_b64 v[18:19], v6
    s_waitcnt lgkmcnt(0)
    v_add_f32 v20, v16, v18
    v_sub_f32 v21, v17, v19
    v_add_f32 v22, v17, v19
    v_sub_f32 v23, v18, v16
    s_mov_b32 s13, s12
    s_add_u32 s13, s12, 1048576
    buffer_store_dwordx4 v[20:23], v5, s[8:11], s13 offen sc1
    s_nop 1
    v_sub_u32 v6, 928, v7
    v_and_b32 v6, 1023, v6
    v_lshl_add_u32 v6, v6, 3, v8
    ds_read_b64 v[16:17], v4 offset:768
    ds_read_b64 v[18:19], v6
    s_waitcnt lgkmcnt(0)
    v_add_f32 v20, v16, v18
    v_sub_f32 v21, v17, v19
    v_add_f32 v22, v17, v19
    v_sub_f32 v23, v18, v16
    s_mov_b32 s13, s12
    s_add_u32 s13, s12, 1572864
    buffer_store_dwordx4 v[20:23], v5, s[8:11], s13 offen sc1
    s_nop 1
    v_sub_u32 v6, 896, v7
    v_and_b32 v6, 1023, v6
    v_lshl_add_u32 v6, v6, 3, v8
    ds_read_b64 v[16:17], v4 offset:1024
    ds_read_b64 v[18:19], v6
    s_waitcnt lgkmcnt(0)
    v_add_f32 v20, v16, v18
    v_sub_f32 v21, v17, v19
    v_add_f32 v22, v17, v19
    v_sub_f32 v23, v18, v16
    s_mov_b32 s13, s12
    s_add_u32 s13, s12, 2097152
    buffer_store_dwordx4 v[20:23], v5, s[8:11], s13 offen sc1
    s_nop 1
    v_sub_u32 v6, 864, v7
    v_and_b32 v6, 1023, v6
    v_lshl_add_u32 v6, v6, 3, v8
    ds_read_b64 v[16:17], v4 offset:1280
    ds_read_b64 v[18:19], v6
    s_waitcnt lgkmcnt(0)
    v_add_f32 v20, v16, v18
    v_sub_f32 v21, v17, v19
    v_add_f32 v22, v17, v19
    v_sub_f32 v23, v18, v16
    s_mov_b32 s13, s12
    s_add_u32 s13, s12, 2621440
    buffer_store_dwordx4 v[20:23], v5, s[8:11], s13 offen sc1
    s_nop 1
    v_sub_u32 v6, 832, v7
    v_and_b32 v6, 1023, v6
    v_lshl_add_u32 v6, v6, 3, v8
    ds_read_b64 v[16:17], v4 offset:1536
    ds_read_b64 v[18:19], v6
    s_waitcnt lgkmcnt(0)
    v_add_f32 v20, v16, v18
    v_sub_f32 v21, v17, v19
    v_add_f32 v22, v17, v19
    v_sub_f32 v23, v18, v16
    s_mov_b32 s13, s12
    s_add_u32 s13, s12, 3145728
    buffer_store_dwordx4 v[20:23], v5, s[8:11], s13 offen sc1
    s_nop 1
    v_sub_u32 v6, 800, v7
    v_and_b32 v6, 1023, v6
    v_lshl_add_u32 v6, v6, 3, v8
    ds_read_b64 v[16:17], v4 offset:1792
    ds_read_b64 v[18:19], v6
    s_waitcnt lgkmcnt(0)
    v_add_f32 v20, v16, v18
    v_sub_f32 v21, v17, v19
    v_add_f32 v22, v17, v19
    v_sub_f32 v23, v18, v16
    s_mov_b32 s13, s12
    s_add_u32 s13, s12, 3670016
    buffer_store_dwordx4 v[20:23], v5, s[8:11], s13 offen sc1
    s_nop 1
    v_sub_u32 v6, 768, v7
    v_and_b32 v6, 1023, v6
    v_lshl_add_u32 v6, v6, 3, v8
    ds_read_b64 v[16:17], v4 offset:2048
    ds_read_b64 v[18:19], v6
    s_waitcnt lgkmcnt(0)
    v_add_f32 v20, v16, v18
    v_sub_f32 v21, v17, v19
    v_add_f32 v22, v17, v19
    v_sub_f32 v23, v18, v16
    s_mov_b32 s13, s12
    s_add_u32 s13, s12, 4194304
    buffer_store_dwordx4 v[20:23], v5, s[8:11], s13 offen sc1
    s_nop 1
    v_sub_u32 v6, 736, v7
    v_and_b32 v6, 1023, v6
    v_lshl_add_u32 v6, v6, 3, v8
    ds_read_b64 v[16:17], v4 offset:2304
    ds_read_b64 v[18:19], v6
    s_waitcnt lgkmcnt(0)
    v_add_f32 v20, v16, v18
    v_sub_f32 v21, v17, v19
    v_add_f32 v22, v17, v19
    v_sub_f32 v23, v18, v16
    s_mov_b32 s13, s12
    s_add_u32 s13, s12, 4718592
    buffer_store_dwordx4 v[20:23], v5, s[8:11], s13 offen sc1
    s_nop 1
    v_sub_u32 v6, 704, v7
    v_and_b32 v6, 1023, v6
    v_lshl_add_u32 v6, v6, 3, v8
    ds_read_b64 v[16:17], v4 offset:2560
    ds_read_b64 v[18:19], v6
    s_waitcnt lgkmcnt(0)
    v_add_f32 v20, v16, v18
    v_sub_f32 v21, v17, v19
    v_add_f32 v22, v17, v19
    v_sub_f32 v23, v18, v16
    s_mov_b32 s13, s12
    s_add_u32 s13, s12, 5242880
    buffer_store_dwordx4 v[20:23], v5, s[8:11], s13 offen sc1
    s_nop 1
    v_sub_u32 v6, 672, v7
    v_and_b32 v6, 1023, v6
    v_lshl_add_u32 v6, v6, 3, v8
    ds_read_b64 v[16:17], v4 offset:2816
    ds_read_b64 v[18:19], v6
    s_waitcnt lgkmcnt(0)
    v_add_f32 v20, v16, v18
    v_sub_f32 v21, v17, v19
    v_add_f32 v22, v17, v19
    v_sub_f32 v23, v18, v16
    s_mov_b32 s13, s12
    s_add_u32 s13, s12, 5767168
    buffer_store_dwordx4 v[20:23], v5, s[8:11], s13 offen sc1
    s_nop 1
    v_sub_u32 v6, 640, v7
    v_and_b32 v6, 1023, v6
    v_lshl_add_u32 v6, v6, 3, v8
    ds_read_b64 v[16:17], v4 offset:3072
    ds_read_b64 v[18:19], v6
    s_waitcnt lgkmcnt(0)
    v_add_f32 v20, v16, v18
    v_sub_f32 v21, v17, v19
    v_add_f32 v22, v17, v19
    v_sub_f32 v23, v18, v16
    s_mov_b32 s13, s12
    s_add_u32 s13, s12, 6291456
    buffer_store_dwordx4 v[20:23], v5, s[8:11], s13 offen sc1
    s_nop 1
    v_sub_u32 v6, 608, v7
    v_and_b32 v6, 1023, v6
    v_lshl_add_u32 v6, v6, 3, v8
    ds_read_b64 v[16:17], v4 offset:3328
    ds_read_b64 v[18:19], v6
    s_waitcnt lgkmcnt(0)
    v_add_f32 v20, v16, v18
    v_sub_f32 v21, v17, v19
    v_add_f32 v22, v17, v19
    v_sub_f32 v23, v18, v16
    s_mov_b32 s13, s12
    s_add_u32 s13, s12, 6815744
    buffer_store_dwordx4 v[20:23], v5, s[8:11], s13 offen sc1
    s_nop 1
    v_sub_u32 v6, 576, v7
    v_and_b32 v6, 1023, v6
    v_lshl_add_u32 v6, v6, 3, v8
    ds_read_b64 v[16:17], v4 offset:3584
    ds_read_b64 v[18:19], v6
    s_waitcnt lgkmcnt(0)
    v_add_f32 v20, v16, v18
    v_sub_f32 v21, v17, v19
    v_add_f32 v22, v17, v19
    v_sub_f32 v23, v18, v16
    s_mov_b32 s13, s12
    s_add_u32 s13, s12, 7340032
    buffer_store_dwordx4 v[20:23], v5, s[8:11], s13 offen sc1
    s_nop 1
    v_sub_u32 v6, 544, v7
    v_and_b32 v6, 1023, v6
    v_lshl_add_u32 v6, v6, 3, v8
    ds_read_b64 v[16:17], v4 offset:3840
    ds_read_b64 v[18:19], v6
    s_waitcnt lgkmcnt(0)
    v_add_f32 v20, v16, v18
    v_sub_f32 v21, v17, v19
    v_add_f32 v22, v17, v19
    v_sub_f32 v23, v18, v16
    s_mov_b32 s13, s12
    s_add_u32 s13, s12, 7864320
    buffer_store_dwordx4 v[20:23], v5, s[8:11], s13 offen sc1
    s_nop 1
    v_sub_u32 v6, 512, v7
    v_and_b32 v6, 1023, v6
    v_lshl_add_u32 v6, v6, 3, v8
    ds_read_b64 v[16:17], v4 offset:4096
    ds_read_b64 v[18:19], v6
    s_waitcnt lgkmcnt(0)
    v_add_f32 v20, v16, v18
    v_sub_f32 v21, v17, v19
    v_add_f32 v22, v17, v19
    v_sub_f32 v23, v18, v16
    s_mov_b32 s13, s12
    v_cmp_eq_u32 vcc, 0, v7
    s_and_saveexec_b64 s[14:15], vcc
    s_add_u32 s13, s12, 8388608
    buffer_store_dwordx4 v[20:23], v5, s[8:11], s13 offen sc1
    s_nop 1
    s_mov_b64 exec, -1
mega_kernel_f1d:
    s_waitcnt vmcnt(0)
    s_barrier
    v_mov_b32 v2, 1
    v_cmp_eq_u32 vcc, 0, v0
    s_and_saveexec_b64 s[80:81], vcc
    s_cbranch_execz mega_kernel_sg72_4
    buffer_atomic_add v2, off, s[88:91], 0 offset:72 sc1
mega_kernel_sg72_4:
    s_mov_b64 exec, s[80:81]
    s_waitcnt vmcnt(0)
    ds_read_b64_tr_b16 a[0:1], v201 offset:0
    ds_read_b64_tr_b16 a[2:3], v201 offset:256
    ds_read_b64_tr_b16 a[4:5], v201 offset:1024
    ds_read_b64_tr_b16 a[6:7], v201 offset:1280
    ds_read_b64_tr_b16 a[8:9], v201 offset:2048
    ds_read_b64_tr_b16 a[10:11], v201 offset:2304
    ds_read_b64_tr_b16 a[12:13], v201 offset:3072
    ds_read_b64_tr_b16 a[14:15], v201 offset:3328
    s_waitcnt lgkmcnt(0)
    ds_read_b64_tr_b16 a[16:17], v201 offset:4096
    ds_read_b64_tr_b16 a[18:19], v201 offset:4352
    ds_read_b64_tr_b16 a[20:21], v201 offset:5120
    ds_read_b64_tr_b16 a[22:23], v201 offset:5376
    ds_read_b64_tr_b16 a[24:25], v201 offset:6144
    ds_read_b64_tr_b16 a[26:27], v201 offset:6400
    ds_read_b64_tr_b16 a[28:29], v201 offset:7168
    ds_read_b64_tr_b16 a[30:31], v201 offset:7424
    s_waitcnt lgkmcnt(0)
    ds_read_b64_tr_b16 a[32:33], v201 offset:8192
    ds_read_b64_tr_b16 a[34:35], v201 offset:8448
    ds_read_b64_tr_b16 a[36:37], v201 offset:9216
    ds_read_b64_tr_b16 a[38:39], v201 offset:9472
    ds_read_b64_tr_b16 a[40:41], v201 offset:10240
    ds_read_b64_tr_b16 a[42:43], v201 offset:10496
    ds_read_b64_tr_b16 a[44:45], v201 offset:11264
    ds_read_b64_tr_b16 a[46:47], v201 offset:11520
    s_waitcnt lgkmcnt(0)
    ds_read_b64_tr_b16 a[48:49], v201 offset:12288
    ds_read_b64_tr_b16 a[50:51], v201 offset:12544
    ds_read_b64_tr_b16 a[52:53], v201 offset:13312
    ds_read_b64_tr_b16 a[54:55], v201 offset:13568
    ds_read_b64_tr_b16 a[56:57], v201 offset:14336
    ds_read_b64_tr_b16 a[58:59], v201 offset:14592
    ds_read_b64_tr_b16 a[60:61], v201 offset:15360
    ds_read_b64_tr_b16 a[62:63], v201 offset:15616
    s_waitcnt lgkmcnt(0)
    s_add_u32 m0, s56, 0
    s_add_u32 s58, s57, 16384
    s_and_b32 s58, s58, 0xffff
    s_lshl_b32 s58, s58, 5
    buffer_load_dwordx4 v200, s[52:55], s58 offen lds
    s_add_u32 m0, s56, 1024
    s_add_u32 s58, s57, 17408
    s_and_b32 s58, s58, 0xffff
    s_lshl_b32 s58, s58, 5
    buffer_load_dwordx4 v200, s[52:55], s58 offen lds
    s_add_u32 m0, s56, 2048
    s_add_u32 s58, s57, 18432
    s_and_b32 s58, s58, 0xffff
    s_lshl_b32 s58, s58, 5
    buffer_load_dwordx4 v200, s[52:55], s58 offen lds
    s_add_u32 m0, s56, 3072
    s_add_u32 s58, s57, 19456
    s_and_b32 s58, s58, 0xffff
    s_lshl_b32 s58, s58, 5
    buffer_load_dwordx4 v200, s[52:55], s58 offen lds
    s_add_u32 m0, s56, 4096
    s_add_u32 s58, s57, 20480
    s_and_b32 s58, s58, 0xffff
    s_lshl_b32 s58, s58, 5
    buffer_load_dwordx4 v200, s[52:55], s58 offen lds
    s_add_u32 m0, s56, 5120
    s_add_u32 s58, s57, 21504
    s_and_b32 s58, s58, 0xffff
    s_lshl_b32 s58, s58, 5
    buffer_load_dwordx4 v200, s[52:55], s58 offen lds
    s_add_u32 m0, s56, 6144
    s_add_u32 s58, s57, 22528
    s_and_b32 s58, s58, 0xffff
    s_lshl_b32 s58, s58, 5
    buffer_load_dwordx4 v200, s[52:55], s58 offen lds
    s_add_u32 m0, s56, 7168
    s_add_u32 s58, s57, 23552
    s_and_b32 s58, s58, 0xffff
    s_lshl_b32 s58, s58, 5
    buffer_load_dwordx4 v200, s[52:55], s58 offen lds
    s_add_u32 m0, s56, 8192
    s_add_u32 s58, s57, 24576
    s_and_b32 s58, s58, 0xffff
    s_lshl_b32 s58, s58, 5
    buffer_load_dwordx4 v200, s[52:55], s58 offen lds
    s_add_u32 m0, s56, 9216
    s_add_u32 s58, s57, 25600
    s_and_b32 s58, s58, 0xffff
    s_lshl_b32 s58, s58, 5
    buffer_load_dwordx4 v200, s[52:55], s58 offen lds
    s_add_u32 m0, s56, 10240
    s_add_u32 s58, s57, 26624
    s_and_b32 s58, s58, 0xffff
    s_lshl_b32 s58, s58, 5
    buffer_load_dwordx4 v200, s[52:55], s58 offen lds
    s_add_u32 m0, s56, 11264
    s_add_u32 s58, s57, 27648
    s_and_b32 s58, s58, 0xffff
    s_lshl_b32 s58, s58, 5
    buffer_load_dwordx4 v200, s[52:55], s58 offen lds
    s_add_u32 m0, s56, 12288
    s_add_u32 s58, s57, 28672
    s_and_b32 s58, s58, 0xffff
    s_lshl_b32 s58, s58, 5
    buffer_load_dwordx4 v200, s[52:55], s58 offen lds
    s_add_u32 m0, s56, 13312
    s_add_u32 s58, s57, 29696
    s_and_b32 s58, s58, 0xffff
    s_lshl_b32 s58, s58, 5
    buffer_load_dwordx4 v200, s[52:55], s58 offen lds
    s_add_u32 m0, s56, 14336
    s_add_u32 s58, s57, 30720
    s_and_b32 s58, s58, 0xffff
    s_lshl_b32 s58, s58, 5
    buffer_load_dwordx4 v200, s[52:55], s58 offen lds
    s_add_u32 m0, s56, 15360
    s_add_u32 s58, s57, 31744
    s_and_b32 s58, s58, 0xffff
    s_lshl_b32 s58, s58, 5
    buffer_load_dwordx4 v200, s[52:55], s58 offen lds
    s_cmp_ge_u32 s92, 128
    s_cbranch_scc1 mega_kernel_xo
mega_kernel_wf1:
    s_sleep 8
    buffer_load_dword v2, off, s[88:91], 0 offset:72 sc1
    s_waitcnt vmcnt(0)
    v_cmp_ne_u32 vcc, 192, v2
    s_cbranch_vccnz mega_kernel_wf1
    s_mov_b32 s99, s92
    s_barrier
mega_kernel_f2_in:
    s_load_dwordx2 s[8:9], s[0:1], 96
    v_lshrrev_b32 v5, 6, v0
    v_and_b32 v1, 63, v0
    v_readfirstlane_b32 s12, v5
    s_lshl_b32 s13, s99, 2
    s_add_u32 s13, s13, s12
    s_cmp_ge_u32 s13, 513
    s_cbranch_scc1 mega_kernel_f2_end
    v_cvt_f32_u32 v2, v1
    s_waitcnt lgkmcnt(0)
    s_mov_b32 s10, 268435456
    s_mov_b32 s11, 0x00020000
    s_lshl_b32 s14, s13, 14
    s_add_u32 s15, s14, 96468992
    v_lshlrev_b32 v5, 3, v1
    s_add_u32 s16, s15, 0
    buffer_load_dwordx2 v[16:17], v5, s[8:11], s16 offen
    s_add_u32 s16, s15, 512
    buffer_load_dwordx2 v[18:19], v5, s[8:11], s16 offen
    s_add_u32 s16, s15, 1024
    buffer_load_dwordx2 v[20:21], v5, s[8:11], s16 offen
    s_add_u32 s16, s15, 1536
    buffer_load_dwordx2 v[22:23], v5, s[8:11], s16 offen
    s_add_u32 s16, s15, 2048
    buffer_load_dwordx2 v[24:25], v5, s[8:11], s16 offen
    s_add_u32 s16, s15, 2560
    buffer_load_dwordx2 v[26:27], v5, s[8:11], s16 offen
    s_add_u32 s16, s15, 3072
    buffer_load_dwordx2 v[28:29], v5, s[8:11], s16 offen
    s_add_u32 s16, s15, 3584
    buffer_load_dwordx2 v[30:31], v5, s[8:11], s16 offen
    s_add_u32 s16, s15, 4096
    buffer_load_dwordx2 v[32:33], v5, s[8:11], s16 offen
    s_add_u32 s16, s15, 4608
    buffer_load_dwordx2 v[34:35], v5, s[8:11], s16 offen
    s_add_u32 s16, s15, 5120
    buffer_load_dwordx2 v[36:37], v5, s[8:11], s16 offen
    s_add_u32 s16, s15, 5632
    buffer_load_dwordx2 v[38:39], v5, s[8:11], s16 offen
    s_add_u32 s16, s15, 6144
    buffer_load_dwordx2 v[40:41], v5, s[8:11], s16 offen
    s_add_u32 s16, s15, 6656
    buffer_load_dwordx2 v[42:43], v5, s[8:11], s16 offen
    s_add_u32 s16, s15, 7168
    buffer_load_dwordx2 v[44:45], v5, s[8:11], s16 offen
    s_add_u32 s16, s15, 7680
    buffer_load_dwordx2 v[46:47], v5, s[8:11], s16 offen
    s_add_u32 s16, s15, 8192
    buffer_load_dwordx2 v[48:49], v5, s[8:11], s16 offen
    s_add_u32 s16, s15, 8704
    buffer_load_dwordx2 v[50:51], v5, s[8:11], s16 offen
    s_add_u32 s16, s15, 9216
    buffer_load_dwordx2 v[52:53], v5, s[8:11], s16 offen
    s_add_u32 s16, s15, 9728
    buffer_load_dwordx2 v[54:55], v5, s[8:11], s16 offen
    s_add_u32 s16, s15, 10240
    buffer_load_dwordx2 v[56:57], v5, s[8:11], s16 offen
    s_add_u32 s16, s15, 10752
    buffer_load_dwordx2 v[58:59], v5, s[8:11], s16 offen
    s_add_u32 s16, s15, 11264
    buffer_load_dwordx2 v[60:61], v5, s[8:11], s16 offen
    s_add_u32 s16, s15, 11776
    buffer_load_dwordx2 v[62:63], v5, s[8:11], s16 offen
    s_add_u32 s16, s15, 12288
    buffer_load_dwordx2 v[64:65], v5, s[8:11], s16 offen
    s_add_u32 s16, s15, 12800
    buffer_load_dwordx2 v[66:67], v5, s[8:11], s16 offen
    s_add_u32 s16, s15, 13312
    buffer_load_dwordx2 v[68:69], v5, s[8:11], s16 offen
    s_add_u32 s16, s15, 13824
    buffer_load_dwordx2 v[70:71], v5, s[8:11], s16 offen
    s_add_u32 s16, s15, 14336
    buffer_load_dwordx2 v[72:73], v5, s[8:11], s16 offen
    s_add_u32 s16, s15, 14848
    buffer_load_dwordx2 v[74:75], v5, s[8:11], s16 offen
    s_add_u32 s16, s15, 15360
    buffer_load_dwordx2 v[76:77], v5, s[8:11], s16 offen
    s_add_u32 s16, s15, 15872
    buffer_load_dwordx2 v[78:79], v5, s[8:11], s16 offen
    s_mul_i32 s17, s12, 16896
    v_lshlrev_b32 v3, 3, v1
    v_add_u32 v3, s17, v3
    v_and_b32 v7, 1, v1
    v_lshrrev_b32 v6, 1, v1
    v_cvt_f32_u32 v8, v6
    v_cvt_f32_u32 v10, v7
    s_movk_i32 s18, 528
    v_mul_lo_u32 v4, v6, s18
    v_lshl_add_u32 v4, v7, 3, v4
    v_add_u32 v4, s17, v4
    v_mov_b32 v9, 1.0
    v_fma_f32 v9, v10, -2.0, v9
    v_lshlrev_b32 v5, 12, v7
    v_lshl_add_u32 v11, v6, 2, v5
    s_lshl_b32 s19, s13, 13
    s_add_u32 s19, s19, 121634816
    s_waitcnt vmcnt(0)
    v_sub_f32 v80, v16, v48
    v_sub_f32 v81, v17, v49
    v_add_f32 v16, v16, v48
    v_add_f32 v17, v17, v49
    v_sub_f32 v48, v18, v50
    v_sub_f32 v49, v19, v51
    v_add_f32 v18, v18, v50
    v_add_f32 v19, v19, v51
    v_mul_f32 v50, 0x3f7b14be, v48
    v_mul_f32 v51, 0xbe47c5c2, v48
    v_fmac_f32 v50, 0x3e47c5c2, v49
    v_fmac_f32 v51, 0x3f7b14be, v49
    v_sub_f32 v48, v20, v52
    v_sub_f32 v49, v21, v53
    v_add_f32 v20, v20, v52
    v_add_f32 v21, v21, v53
    v_mul_f32 v52, 0x3f6c835e, v48
    v_mul_f32 v53, 0xbec3ef15, v48
    v_fmac_f32 v52, 0x3ec3ef15, v49
    v_fmac_f32 v53, 0x3f6c835e, v49
    v_sub_f32 v48, v22, v54
    v_sub_f32 v49, v23, v55
    v_add_f32 v22, v22, v54
    v_add_f32 v23, v23, v55
    v_mul_f32 v54, 0x3f54db31, v48
    v_mul_f32 v55, 0xbf0e39da, v48
    v_fmac_f32 v54, 0x3f0e39da, v49
    v_fmac_f32 v55, 0x3f54db31, v49
    v_sub_f32 v48, v24, v56
    v_sub_f32 v49, v25, v57
    v_add_f32 v24, v24, v56
    v_add_f32 v25, v25, v57
    v_mul_f32 v56, 0x3f3504f3, v48
    v_mul_f32 v57, 0xbf3504f3, v48
    v_fmac_f32 v56, 0x3f3504f3, v49
    v_fmac_f32 v57, 0x3f3504f3, v49
    v_sub_f32 v48, v26, v58
    v_sub_f32 v49, v27, v59
    v_add_f32 v26, v26, v58
    v_add_f32 v27, v27, v59
    v_mul_f32 v58, 0x3f0e39da, v48
    v_mul_f32 v59, 0xbf54db31, v48
    v_fmac_f32 v58, 0x3f54db31, v49
    v_fmac_f32 v59, 0x3f0e39da, v49
    v_sub_f32 v48, v28, v60
    v_sub_f32 v49, v29, v61
    v_add_f32 v28, v28, v60
    v_add_f32 v29, v29, v61
    v_mul_f32 v60, 0x3ec3ef15, v48
    v_mul_f32 v61, 0xbf6c835e, v48
    v_fmac_f32 v60, 0x3f6c835e, v49
    v_fmac_f32 v61, 0x3ec3ef15, v49
    v_sub_f32 v48, v30, v62
    v_sub_f32 v49, v31, v63
    v_add_f32 v30, v30, v62
    v_add_f32 v31, v31, v63
    v_mul_f32 v62, 0x3e47c5c2, v48
    v_mul_f32 v63, 0xbf7b14be, v48
    v_fmac_f32 v62, 0x3f7b14be, v49
    v_fmac_f32 v63, 0x3e47c5c2, v49
    v_sub_f32 v48, v33, v65
    v_sub_f32 v49, v64, v32
    v_add_f32 v32, v32, v64
    v_add_f32 v33, v33, v65
    v_sub_f32 v64, v34, v66
    v_sub_f32 v65, v35, v67
    v_add_f32 v34, v34, v66
    v_add_f32 v35, v35, v67
    v_mul_f32 v66, 0xbe47c5c2, v64
    v_mul_f32 v67, 0xbf7b14be, v64
    v_fmac_f32 v66, 0x3f7b14be, v65
    v_fmac_f32 v67, 0xbe47c5c2, v65
    v_sub_f32 v64, v36, v68
    v_sub_f32 v65, v37, v69
    v_add_f32 v36, v36, v68
    v_add_f32 v37, v37, v69
    v_mul_f32 v68, 0xbec3ef15, v64
    v_mul_f32 v69, 0xbf6c835e, v64
    v_fmac_f32 v68, 0x3f6c835e, v65
    v_fmac_f32 v69, 0xbec3ef15, v65
    v_sub_f32 v64, v38, v70
    v_sub_f32 v65, v39, v71
    v_add_f32 v38, v38, v70
    v_add_f32 v39, v39, v71
    v_mul_f32 v70, 0xbf0e39da, v64
    v_mul_f32 v71, 0xbf54db31, v64
    v_fmac_f32 v70, 0x3f54db31, v65
    v_fmac_f32 v71, 0xbf0e39da, v65
    v_sub_f32 v64, v40, v72
    v_sub_f32 v65, v41, v73
    v_add_f32 v40, v40, v72
    v_add_f32 v41, v41, v73
    v_mul_f32 v72, 0xbf3504f3, v64
    v_mul_f32 v73, 0xbf3504f3, v64
    v_fmac_f32 v72, 0x3f3504f3, v65
    v_fmac_f32 v73, 0xbf3504f3, v65
    v_sub_f32 v64, v42, v74
    v_sub_f32 v65, v43, v75
    v_add_f32 v42, v42, v74
    v_add_f32 v43, v43, v75
    v_mul_f32 v74, 0xbf54db31, v64
    v_mul_f32 v75, 0xbf0e39da, v64
    v_fmac_f32 v74, 0x3f0e39da, v65
    v_fmac_f32 v75, 0xbf54db31, v65
    v_sub_f32 v64, v44, v76
    v_sub_f32 v65, v45, v77
    v_add_f32 v44, v44, v76
    v_add_f32 v45, v45, v77
    v_mul_f32 v76, 0xbf6c835e, v64
    v_mul_f32 v77, 0xbec3ef15, v64
    v_fmac_f32 v76, 0x3ec3ef15, v65
    v_fmac_f32 v77, 0xbf6c835e, v65
    v_sub_f32 v64, v46, v78
    v_sub_f32 v65, v47, v79
    v_add_f32 v46, v46, v78
    v_add_f32 v47, v47, v79
    v_mul_f32 v78, 0xbf7b14be, v64
    v_mul_f32 v79, 0xbe47c5c2, v64
    v_fmac_f32 v78, 0x3e47c5c2, v65
    v_fmac_f32 v79, 0xbf7b14be, v65
    v_sub_f32 v64, v16, v32
    v_sub_f32 v65, v17, v33
    v_add_f32 v16, v16, v32
    v_add_f32 v17, v17, v33
    v_sub_f32 v32, v18, v34
    v_sub_f32 v33, v19, v35
    v_add_f32 v18, v18, v34
    v_add_f32 v19, v19, v35
    v_mul_f32 v34, 0x3f6c835e, v32
    v_mul_f32 v35, 0xbec3ef15, v32
    v_fmac_f32 v34, 0x3ec3ef15, v33
    v_fmac_f32 v35, 0x3f6c835e, v33
    v_sub_f32 v32, v20, v36
    v_sub_f32 v33, v21, v37
    v_add_f32 v20, v20, v36
    v_add_f32 v21, v21, v37
    v_mul_f32 v36, 0x3f3504f3, v32
    v_mul_f32 v37, 0xbf3504f3, v32
    v_fmac_f32 v36, 0x3f3504f3, v33
    v_fmac_f32 v37, 0x3f3504f3, v33
    v_sub_f32 v32, v22, v38
    v_sub_f32 v33, v23, v39
    v_add_f32 v22, v22, v38
    v_add_f32 v23, v23, v39
    v_mul_f32 v38, 0x3ec3ef15, v32
    v_mul_f32 v39, 0xbf6c835e, v32
    v_fmac_f32 v38, 0x3f6c835e, v33
    v_fmac_f32 v39, 0x3ec3ef15, v33
    v_sub_f32 v32, v25, v41
    v_sub_f32 v33, v40, v24
    v_add_f32 v24, v24, v40
    v_add_f32 v25, v25, v41
    v_sub_f32 v40, v26, v42
    v_sub_f32 v41, v27, v43
    v_add_f32 v26, v26, v42
    v_add_f32 v27, v27, v43
    v_mul_f32 v42, 0xbec3ef15, v40
    v_mul_f32 v43, 0xbf6c835e, v40
    v_fmac_f32 v42, 0x3f6c835e, v41
    v_fmac_f32 v43, 0xbec3ef15, v41
    v_sub_f32 v40, v28, v44
    v_sub_f32 v41, v29, v45
    v_add_f32 v28, v28, v44
    v_add_f32 v29, v29, v45
    v_mul_f32 v44, 0xbf3504f3, v40
    v_mul_f32 v45, 0xbf3504f3, v40
    v_fmac_f32 v44, 0x3f3504f3, v41
    v_fmac_f32 v45, 0xbf3504f3, v41
    v_sub_f32 v40, v30, v46
    v_sub_f32 v41, v31, v47
    v_add_f32 v30, v30, v46
    v_add_f32 v31, v31, v47
    v_mul_f32 v46, 0xbf6c835e, v40
    v_mul_f32 v47, 0xbec3ef15, v40
    v_fmac_f32 v46, 0x3ec3ef15, v41
    v_fmac_f32 v47, 0xbf6c835e, v41
    v_sub_f32 v40, v80, v48
    v_sub_f32 v41, v81, v49
    v_add_f32 v80, v80, v48
    v_add_f32 v81, v81, v49
    v_sub_f32 v48, v50, v66
    v_sub_f32 v49, v51, v67
    v_add_f32 v50, v50, v66
    v_add_f32 v51, v51, v67
    v_mul_f32 v66, 0x3f6c835e, v48
    v_mul_f32 v67, 0xbec3ef15, v48
    v_fmac_f32 v66, 0x3ec3ef15, v49
    v_fmac_f32 v67, 0x3f6c835e, v49
    v_sub_f32 v48, v52, v68
    v_sub_f32 v49, v53, v69
    v_add_f32 v52, v52, v68
    v_add_f32 v53, v53, v69
    v_mul_f32 v68, 0x3f3504f3, v48
    v_mul_f32 v69, 0xbf3504f3, v48
    v_fmac_f32 v68, 0x3f3504f3, v49
    v_fmac_f32 v69, 0x3f3504f3, v49
    v_sub_f32 v48, v54, v70
    v_sub_f32 v49, v55, v71
    v_add_f32 v54, v54, v70
    v_add_f32 v55, v55, v71
    v_mul_f32 v70, 0x3ec3ef15, v48
    v_mul_f32 v71, 0xbf6c835e, v48
    v_fmac_f32 v70, 0x3f6c835e, v49
    v_fmac_f32 v71, 0x3ec3ef15, v49
    v_sub_f32 v48, v57, v73
    v_sub_f32 v49, v72, v56
    v_add_f32 v56, v56, v72
    v_add_f32 v57, v57, v73
    v_sub_f32 v72, v58, v74
    v_sub_f32 v73, v59, v75
    v_add_f32 v58, v58, v74
    v_add_f32 v59, v59, v75
    v_mul_f32 v74, 0xbec3ef15, v72
    v_mul_f32 v75, 0xbf6c835e, v72
    v_fmac_f32 v74, 0x3f6c835e, v73
    v_fmac_f32 v75, 0xbec3ef15, v73
    v_sub_f32 v72, v60, v76
    v_sub_f32 v73, v61, v77
    v_add_f32 v60, v60, v76
    v_add_f32 v61, v61, v77
    v_mul_f32 v76, 0xbf3504f3, v72
    v_mul_f32 v77, 0xbf3504f3, v72
    v_fmac_f32 v76, 0x3f3504f3, v73
    v_fmac_f32 v77, 0xbf3504f3, v73
    v_sub_f32 v72, v62, v78
    v_sub_f32 v73, v63, v79
    v_add_f32 v62, v62, v78
    v_add_f32 v63, v63, v79
    v_mul_f32 v78, 0xbf6c835e, v72
    v_mul_f32 v79, 0xbec3ef15, v72
    v_fmac_f32 v78, 0x3ec3ef15, v73
    v_fmac_f32 v79, 0xbf6c835e, v73
    v_sub_f32 v72, v16, v24
    v_sub_f32 v73, v17, v25
    v_add_f32 v16, v16, v24
    v_add_f32 v17, v17, v25
    v_sub_f32 v24, v18, v26
    v_sub_f32 v25, v19, v27
    v_add_f32 v18, v18, v26
    v_add_f32 v19, v19, v27
    v_mul_f32 v26, 0x3f3504f3, v24
    v_mul_f32 v27, 0xbf3504f3, v24
    v_fmac_f32 v26, 0x3f3504f3, v25
    v_fmac_f32 v27, 0x3f3504f3, v25
    v_sub_f32 v24, v21, v29
    v_sub_f32 v25, v28, v20
    v_add_f32 v20, v20, v28
    v_add_f32 v21, v21, v29
    v_sub_f32 v28, v22, v30
    v_sub_f32 v29, v23, v31
    v_add_f32 v22, v22, v30
    v_add_f32 v23, v23, v31
    v_mul_f32 v30, 0xbf3504f3, v28
    v_mul_f32 v31, 0xbf3504f3, v28
    v_fmac_f32 v30, 0x3f3504f3, v29
    v_fmac_f32 v31, 0xbf3504f3, v29
    v_sub_f32 v28, v64, v32
    v_sub_f32 v29, v65, v33
    v_add_f32 v64, v64, v32
    v_add_f32 v65, v65, v33
    v_sub_f32 v32, v34, v42
    v_sub_f32 v33, v35, v43
    v_add_f32 v34, v34, v42
    v_add_f32 v35, v35, v43
    v_mul_f32 v42, 0x3f3504f3, v32
    v_mul_f32 v43, 0xbf3504f3, v32
    v_fmac_f32 v42, 0x3f3504f3, v33
    v_fmac_f32 v43, 0x3f3504f3, v33
    v_sub_f32 v32, v37, v45
    v_sub_f32 v33, v44, v36
    v_add_f32 v36, v36, v44
    v_add_f32 v37, v37, v45
    v_sub_f32 v44, v38, v46
    v_sub_f32 v45, v39, v47
    v_add_f32 v38, v38, v46
    v_add_f32 v39, v39, v47
    v_mul_f32 v46, 0xbf3504f3, v44
    v_mul_f32 v47, 0xbf3504f3, v44
    v_fmac_f32 v46, 0x3f3504f3, v45
    v_fmac_f32 v47, 0xbf3504f3, v45
    v_sub_f32 v44, v80, v56
    v_sub_f32 v45, v81, v57
    v_add_f32 v80, v80, v56
    v_add_f32 v81, v81, v57
    v_sub_f32 v56, v50, v58
    v_sub_f32 v57, v51, v59
    v_add_f32 v50, v50, v58
    v_add_f32 v51, v51, v59
    v_mul_f32 v58, 0x3f3504f3, v56
    v_mul_f32 v59, 0xbf3504f3, v56
    v_fmac_f32 v58, 0x3f3504f3, v57
    v_fmac_f32 v59, 0x3f3504f3, v57
    v_sub_f32 v56, v53, v61
    v_sub_f32 v57, v60, v52
    v_add_f32 v52, v52, v60
    v_add_f32 v53, v53, v61
    v_sub_f32 v60, v54, v62
    v_sub_f32 v61, v55, v63
    v_add_f32 v54, v54, v62
    v_add_f32 v55, v55, v63
    v_mul_f32 v62, 0xbf3504f3, v60
    v_mul_f32 v63, 0xbf3504f3, v60
    v_fmac_f32 v62, 0x3f3504f3, v61
    v_fmac_f32 v63, 0xbf3504f3, v61
    v_sub_f32 v60, v40, v48
    v_sub_f32 v61, v41, v49
    v_add_f32 v40, v40, v48
    v_add_f32 v41, v41, v49
    v_sub_f32 v48, v66, v74
    v_sub_f32 v49, v67, v75
    v_add_f32 v66, v66, v74
    v_add_f32 v67, v67, v75
    v_mul_f32 v74, 0x3f3504f3, v48
    v_mul_f32 v75, 0xbf3504f3, v48
    v_fmac_f32 v74, 0x3f3504f3, v49
    v_fmac_f32 v75, 0x3f3504f3, v49
    v_sub_f32 v48, v69, v77
    v_sub_f32 v49, v76, v68
    v_add_f32 v68, v68, v76
    v_add_f32 v69, v69, v77
    v_sub_f32 v76, v70, v78
    v_sub_f32 v77, v71, v79
    v_add_f32 v70, v70, v78
    v_add_f32 v71, v71, v79
    v_mul_f32 v78, 0xbf3504f3, v76
    v_mul_f32 v79, 0xbf3504f3, v76
    v_fmac_f32 v78, 0x3f3504f3, v77
    v_fmac_f32 v79, 0xbf3504f3, v77
    v_sub_f32 v76, v16, v20
    v_sub_f32 v77, v17, v21
    v_add_f32 v16, v16, v20
    v_add_f32 v17, v17, v21
    v_sub_f32 v20, v19, v23
    v_sub_f32 v21, v22, v18
    v_add_f32 v18, v18, v22
    v_add_f32 v19, v19, v23
    v_sub_f32 v22, v72, v24
    v_sub_f32 v23, v73, v25
    v_add_f32 v72, v72, v24
    v_add_f32 v73, v73, v25
    v_sub_f32 v24, v27, v31
    v_sub_f32 v25, v30, v26
    v_add_f32 v26, v26, v30
    v_add_f32 v27, v27, v31
    v_sub_f32 v30, v64, v36
    v_sub_f32 v31, v65, v37
    v_add_f32 v64, v64, v36
    v_add_f32 v65, v65, v37
    v_sub_f32 v36, v35, v39
    v_sub_f32 v37, v38, v34
    v_add_f32 v34, v34, v38
    v_add_f32 v35, v35, v39
    v_sub_f32 v38, v28, v32
    v_sub_f32 v39, v29, v33
    v_add_f32 v28, v28, v32
    v_add_f32 v29, v29, v33
    v_sub_f32 v32, v43, v47
    v_sub_f32 v33, v46, v42
    v_add_f32 v42, v42, v46
    v_add_f32 v43, v43, v47
    v_sub_f32 v46, v80, v52
    v_sub_f32 v47, v81, v53
    v_add_f32 v80, v80, v52
    v_add_f32 v81, v81, v53
    v_sub_f32 v52, v51, v55
    v_sub_f32 v53, v54, v50
    v_add_f32 v50, v50, v54
    v_add_f32 v51, v51, v55
    v_sub_f32 v54, v44, v56
    v_sub_f32 v55, v45, v57
    v_add_f32 v44, v44, v56
    v_add_f32 v45, v45, v57
    v_sub_f32 v56, v59, v63
    v_sub_f32 v57, v62, v58
    v_add_f32 v58, v58, v62
    v_add_f32 v59, v59, v63
    v_sub_f32 v62, v40, v68
    v_sub_f32 v63, v41, v69
    v_add_f32 v40, v40, v68
    v_add_f32 v41, v41, v69
    v_sub_f32 v68, v67, v71
    v_sub_f32 v69, v70, v66
    v_add_f32 v66, v66, v70
    v_add_f32 v67, v67, v71
    v_sub_f32 v70, v60, v48
    v_sub_f32 v71, v61, v49
    v_add_f32 v60, v60, v48
    v_add_f32 v61, v61, v49
    v_sub_f32 v48, v75, v79
    v_sub_f32 v49, v78, v74
    v_add_f32 v74, v74, v78
    v_add_f32 v75, v75, v79
    v_sub_f32 v78, v16, v18
    v_sub_f32 v79, v17, v19
    v_add_f32 v16, v16, v18
    v_add_f32 v17, v17, v19
    v_sub_f32 v18, v76, v20
    v_sub_f32 v19, v77, v21
    v_add_f32 v76, v76, v20
    v_add_f32 v77, v77, v21
    v_sub_f32 v20, v72, v26
    v_sub_f32 v21, v73, v27
    v_add_f32 v72, v72, v26
    v_add_f32 v73, v73, v27
    v_sub_f32 v26, v22, v24
    v_sub_f32 v27, v23, v25
    v_add_f32 v22, v22, v24
    v_add_f32 v23, v23, v25
    v_sub_f32 v24, v64, v34
    v_sub_f32 v25, v65, v35
    v_add_f32 v64, v64, v34
    v_add_f32 v65, v65, v35
    v_sub_f32 v34, v30, v36
    v_sub_f32 v35, v31, v37
    v_add_f32 v30, v30, v36
    v_add_f32 v31, v31, v37
    v_sub_f32 v36, v28, v42
    v_sub_f32 v37, v29, v43
    v_add_f32 v28, v28, v42
    v_add_f32 v29, v29, v43
    v_sub_f32 v42, v38, v32
    v_sub_f32 v43, v39, v33
    v_add_f32 v38, v38, v32
    v_add_f32 v39, v39, v33
    v_sub_f32 v32, v80, v50
    v_sub_f32 v33, v81, v51
    v_add_f32 v80, v80, v50
    v_add_f32 v81, v81, v51
    v_sub_f32 v50, v46, v52
    v_sub_f32 v51, v47, v53
    v_add_f32 v46, v46, v52
    v_add_f32 v47, v47, v53
    v_sub_f32 v52, v44, v58
    v_sub_f32 v53, v45, v59
    v_add_f32 v44, v44, v58
    v_add_f32 v45, v45, v59
    v_sub_f32 v58, v54, v56
    v_sub_f32 v59, v55, v57
    v_add_f32 v54, v54, v56
    v_add_f32 v55, v55, v57
    v_sub_f32 v56, v40, v66
    v_sub_f32 v57, v41, v67
    v_add_f32 v40, v40, v66
    v_add_f32 v41, v41, v67
    v_sub_f32 v66, v62, v68
    v_sub_f32 v67, v63, v69
    v_add_f32 v62, v62, v68
    v_add_f32 v63, v63, v69
    v_sub_f32 v68, v60, v74
    v_sub_f32 v69, v61, v75
    v_add_f32 v60, v60, v74
    v_add_f32 v61, v61, v75
    v_sub_f32 v74, v70, v48
    v_sub_f32 v75, v71, v49
    v_add_f32 v70, v70, v48
    v_add_f32 v71, v71, v49
    v_mul_f32 v48, 0xba000000, v2
    v_cos_f32 v49, v48
    v_sin_f32 v82, v48
    s_nop 0
    v_mul_f32 v83, v80, v49
    v_fma_f32 v83, -v81, v82, v83
    v_mul_f32 v81, v81, v49
    v_fmac_f32 v81, v80, v82
    v_mul_f32 v48, 0xba800000, v2
    v_cos_f32 v49, v48
    v_sin_f32 v82, v48
    s_nop 0
    v_mul_f32 v80, v64, v49
    v_fma_f32 v80, -v65, v82, v80
    v_mul_f32 v65, v65, v49
    v_fmac_f32 v65, v64, v82
    v_mul_f32 v48, 0xbac00000, v2
    v_cos_f32 v49, v48
    v_sin_f32 v82, v48
    s_nop 0
    v_mul_f32 v64, v40, v49
    v_fma_f32 v64, -v41, v82, v64
    v_mul_f32 v41, v41, v49
    v_fmac_f32 v41, v40, v82
    v_mul_f32 v48, 0xbb000000, v2
    v_cos_f32 v49, v48
    v_sin_f32 v82, v48
    s_nop 0
    v_mul_f32 v40, v72, v49
    v_fma_f32 v40, -v73, v82, v40
    v_mul_f32 v73, v73, v49
    v_fmac_f32 v73, v72, v82
    v_mul_f32 v48, 0xbb200000, v2
    v_cos_f32 v49, v48
    v_sin_f32 v82, v48
    s_nop 0
    v_mul_f32 v72, v44, v49
    v_fma_f32 v72, -v45, v82, v72
    v_mul_f32 v45, v45, v49
    v_fmac_f32 v45, v44, v82
    v_mul_f32 v48, 0xbb400000, v2
    v_cos_f32 v49, v48
    v_sin_f32 v82, v48
    s_nop 0
    v_mul_f32 v44, v28, v49
    v_fma_f32 v44, -v29, v82, v44
    v_mul_f32 v29, v29, v49
    v_fmac_f32 v29, v28, v82
    v_mul_f32 v48, 0xbb600000, v2
    v_cos_f32 v49, v48
    v_sin_f32 v82, v48
    s_nop 0
    v_mul_f32 v28, v60, v49
    v_fma_f32 v28, -v61, v82, v28
    v_mul_f32 v61, v61, v49
    v_fmac_f32 v61, v60, v82
    v_mul_f32 v48, 0xbb800000, v2
    v_cos_f32 v49, v48
    v_sin_f32 v82, v48
    s_nop 0
    v_mul_f32 v60, v76, v49
    v_fma_f32 v60, -v77, v82, v60
    v_mul_f32 v77, v77, v49
    v_fmac_f32 v77, v76, v82
    v_mul_f32 v48, 0xbb900000, v2
    v_cos_f32 v49, v48
    v_sin_f32 v82, v48
    s_nop 0
    v_mul_f32 v76, v46, v49
    v_fma_f32 v76, -v47, v82, v76
    v_mul_f32 v47, v47, v49
    v_fmac_f32 v47, v46, v82
    v_mul_f32 v48, 0xbba00000, v2
    v_cos_f32 v49, v48
    v_sin_f32 v82, v48
    s_nop 0
    v_mul_f32 v46, v30, v49
    v_fma_f32 v46, -v31, v82, v46
    v_mul_f32 v31, v31, v49
    v_fmac_f32 v31, v30, v82
    v_mul_f32 v48, 0xbbb00000, v2
    v_cos_f32 v49, v48
    v_sin_f32 v82, v48
    s_nop 0
    v_mul_f32 v30, v62, v49
    v_fma_f32 v30, -v63, v82, v30
    v_mul_f32 v63, v63, v49
    v_fmac_f32 v63, v62, v82
    v_mul_f32 v48, 0xbbc00000, v2
    v_cos_f32 v49, v48
    v_sin_f32 v82, v48
    s_nop 0
    v_mul_f32 v62, v22, v49
    v_fma_f32 v62, -v23, v82, v62
    v_mul_f32 v23, v23, v49
    v_fmac_f32 v23, v22, v82
    v_mul_f32 v48, 0xbbd00000, v2
    v_cos_f32 v49, v48
    v_sin_f32 v82, v48
    s_nop 0
    v_mul_f32 v22, v54, v49
    v_fma_f32 v22, -v55, v82, v22
    v_mul_f32 v55, v55, v49
    v_fmac_f32 v55, v54, v82
    v_mul_f32 v48, 0xbbe00000, v2
    v_cos_f32 v49, v48
    v_sin_f32 v82, v48
    s_nop 0
    v_mul_f32 v54, v38, v49
    v_fma_f32 v54, -v39, v82, v54
    v_mul_f32 v39, v39, v49
    v_fmac_f32 v39, v38, v82
    v_mul_f32 v48, 0xbbf00000, v2
    v_cos_f32 v49, v48
    v_sin_f32 v82, v48
    s_nop 0
    v_mul_f32 v38, v70, v49
    v_fma_f32 v38, -v71, v82, v38
    v_mul_f32 v71, v71, v49
    v_fmac_f32 v71, v70, v82
    v_mul_f32 v48, 0xbc000000, v2
    v_cos_f32 v49, v48
    v_sin_f32 v82, v48
    s_nop 0
    v_mul_f32 v70, v78, v49
    v_fma_f32 v70, -v79, v82, v70
    v_mul_f32 v79, v79, v49
    v_fmac_f32 v79, v78, v82
    v_mul_f32 v48, 0xbc080000, v2
    v_cos_f32 v49, v48
    v_sin_f32 v82, v48
    s_nop 0
    v_mul_f32 v78, v32, v49
    v_fma_f32 v78, -v33, v82, v78
    v_mul_f32 v33, v33, v49
    v_fmac_f32 v33, v32, v82
    v_mul_f32 v48, 0xbc100000, v2
    v_cos_f32 v49, v48
    v_sin_f32 v82, v48
    s_nop 0
    v_mul_f32 v32, v24, v49
    v_fma_f32 v32, -v25, v82, v32
    v_mul_f32 v25, v25, v49
    v_fmac_f32 v25, v24, v82
    v_mul_f32 v48, 0xbc180000, v2
    v_cos_f32 v49, v48
    v_sin_f32 v82, v48
    s_nop 0
    v_mul_f32 v24, v56, v49
    v_fma_f32 v24, -v57, v82, v24
    v_mul_f32 v57, v57, v49
    v_fmac_f32 v57, v56, v82
    v_mul_f32 v48, 0xbc200000, v2
    v_cos_f32 v49, v48
    v_sin_f32 v82, v48
    s_nop 0
    v_mul_f32 v56, v20, v49
    v_fma_f32 v56, -v21, v82, v56
    v_mul_f32 v21, v21, v49
    v_fmac_f32 v21, v20, v82
    v_mul_f32 v48, 0xbc280000, v2
    v_cos_f32 v49, v48
    v_sin_f32 v82, v48
    s_nop 0
    v_mul_f32 v20, v52, v49
    v_fma_f32 v20, -v53, v82, v20
    v_mul_f32 v53, v53, v49
    v_fmac_f32 v53, v52, v82
    v_mul_f32 v48, 0xbc300000, v2
    v_cos_f32 v49, v48
    v_sin_f32 v82, v48
    s_nop 0
    v_mul_f32 v52, v36, v49
    v_fma_f32 v52, -v37, v82, v52
    v_mul_f32 v37, v37, v49
    v_fmac_f32 v37, v36, v82
    v_mul_f32 v48, 0xbc380000, v2
    v_cos_f32 v49, v48
    v_sin_f32 v82, v48
    s_nop 0
    v_mul_f32 v36, v68, v49
    v_fma_f32 v36, -v69, v82, v36
    v_mul_f32 v69, v69, v49
    v_fmac_f32 v69, v68, v82
    v_mul_f32 v48, 0xbc400000, v2
    v_cos_f32 v49, v48
    v_sin_f32 v82, v48
    s_nop 0
    v_mul_f32 v68, v18, v49
    v_fma_f32 v68, -v19, v82, v68
    v_mul_f32 v19, v19, v49
    v_fmac_f32 v19, v18, v82
    v_mul_f32 v48, 0xbc480000, v2
    v_cos_f32 v49, v48
    v_sin_f32 v82, v48
    s_nop 0
    v_mul_f32 v18, v50, v49
    v_fma_f32 v18, -v51, v82, v18
    v_mul_f32 v51, v51, v49
    v_fmac_f32 v51, v50, v82
    v_mul_f32 v48, 0xbc500000, v2
    v_cos_f32 v49, v48
    v_sin_f32 v82, v48
    s_nop 0
    v_mul_f32 v50, v34, v49
    v_fma_f32 v50, -v35, v82, v50
    v_mul_f32 v35, v35, v49
    v_fmac_f32 v35, v34, v82
    v_mul_f32 v48, 0xbc580000, v2
    v_cos_f32 v49, v48
    v_sin_f32 v82, v48
    s_nop 0
    v_mul_f32 v34, v66, v49
    v_fma_f32 v34, -v67, v82, v34
    v_mul_f32 v67, v67, v49
    v_fmac_f32 v67, v66, v82
    v_mul_f32 v48, 0xbc600000, v2
    v_cos_f32 v49, v48
    v_sin_f32 v82, v48
    s_nop 0
    v_mul_f32 v66, v26, v49
    v_fma_f32 v66, -v27, v82, v66
    v_mul_f32 v27, v27, v49
    v_fmac_f32 v27, v26, v82
    v_mul_f32 v48, 0xbc680000, v2
    v_cos_f32 v49, v48
    v_sin_f32 v82, v48
    s_nop 0
    v_mul_f32 v26, v58, v49
    v_fma_f32 v26, -v59, v82, v26
    v_mul_f32 v59, v59, v49
    v_fmac_f32 v59, v58, v82
    v_mul_f32 v48, 0xbc700000, v2
    v_cos_f32 v49, v48
    v_sin_f32 v82, v48
    s_nop 0
    v_mul_f32 v58, v42, v49
    v_fma_f32 v58, -v43, v82, v58
    v_mul_f32 v43, v43, v49
    v_fmac_f32 v43, v42, v82
    v_mul_f32 v48, 0xbc780000, v2
    v_cos_f32 v49, v48
    v_sin_f32 v82, v48
    s_nop 0
    v_mul_f32 v42, v74, v49
    v_fma_f32 v42, -v75, v82, v42
    v_mul_f32 v75, v75, v49
    v_fmac_f32 v75, v74, v82
    ds_write_b32 v3, v16 offset:0
    ds_write_b32 v3, v17 offset:4
    ds_write_b32 v3, v83 offset:528
    ds_write_b32 v3, v81 offset:532
    ds_write_b32 v3, v80 offset:1056
    ds_write_b32 v3, v65 offset:1060
    ds_write_b32 v3, v64 offset:1584
    ds_write_b32 v3, v41 offset:1588
    ds_write_b32 v3, v40 offset:2112
    ds_write_b32 v3, v73 offset:2116
    ds_write_b32 v3, v72 offset:2640
    ds_write_b32 v3, v45 offset:2644
    ds_write_b32 v3, v44 offset:3168
    ds_write_b32 v3, v29 offset:3172
    ds_write_b32 v3, v28 offset:3696
    ds_write_b32 v3, v61 offset:3700
    ds_write_b32 v3, v60 offset:4224
    ds_write_b32 v3, v77 offset:4228
    ds_write_b32 v3, v76 offset:4752
    ds_write_b32 v3, v47 offset:4756
    ds_write_b32 v3, v46 offset:5280
    ds_write_b32 v3, v31 offset:5284
    ds_write_b32 v3, v30 offset:5808
    ds_write_b32 v3, v63 offset:5812
    ds_write_b32 v3, v62 offset:6336
    ds_write_b32 v3, v23 offset:6340
    ds_write_b32 v3, v22 offset:6864
    ds_write_b32 v3, v55 offset:6868
    ds_write_b32 v3, v54 offset:7392
    ds_write_b32 v3, v39 offset:7396
    ds_write_b32 v3, v38 offset:7920
    ds_write_b32 v3, v71 offset:7924
    ds_write_b32 v3, v70 offset:8448
    ds_write_b32 v3, v79 offset:8452
    ds_write_b32 v3, v78 offset:8976
    ds_write_b32 v3, v33 offset:8980
    ds_write_b32 v3, v32 offset:9504
    ds_write_b32 v3, v25 offset:9508
    ds_write_b32 v3, v24 offset:10032
    ds_write_b32 v3, v57 offset:10036
    ds_write_b32 v3, v56 offset:10560
    ds_write_b32 v3, v21 offset:10564
    ds_write_b32 v3, v20 offset:11088
    ds_write_b32 v3, v53 offset:11092
    ds_write_b32 v3, v52 offset:11616
    ds_write_b32 v3, v37 offset:11620
    ds_write_b32 v3, v36 offset:12144
    ds_write_b32 v3, v69 offset:12148
    ds_write_b32 v3, v68 offset:12672
    ds_write_b32 v3, v19 offset:12676
    ds_write_b32 v3, v18 offset:13200
    ds_write_b32 v3, v51 offset:13204
    ds_write_b32 v3, v50 offset:13728
    ds_write_b32 v3, v35 offset:13732
    ds_write_b32 v3, v34 offset:14256
    ds_write_b32 v3, v67 offset:14260
    ds_write_b32 v3, v66 offset:14784
    ds_write_b32 v3, v27 offset:14788
    ds_write_b32 v3, v26 offset:15312
    ds_write_b32 v3, v59 offset:15316
    ds_write_b32 v3, v58 offset:15840
    ds_write_b32 v3, v43 offset:15844
    ds_write_b32 v3, v42 offset:16368
    ds_write_b32 v3, v75 offset:16372
    s_waitcnt lgkmcnt(0)
    ds_read_b32 v16, v4 offset:0
    ds_read_b32 v17, v4 offset:4
    ds_read_b32 v83, v4 offset:16
    ds_read_b32 v81, v4 offset:20
    ds_read_b32 v80, v4 offset:32
    ds_read_b32 v65, v4 offset:36
    ds_read_b32 v64, v4 offset:48
    ds_read_b32 v41, v4 offset:52
    ds_read_b32 v40, v4 offset:64
    ds_read_b32 v73, v4 offset:68
    ds_read_b32 v72, v4 offset:80
    ds_read_b32 v45, v4 offset:84
    ds_read_b32 v44, v4 offset:96
    ds_read_b32 v29, v4 offset:100
    s_waitcnt lgkmcnt(0)
    ds_read_b32 v28, v4 offset:112
    ds_read_b32 v61, v4 offset:116
    ds_read_b32 v60, v4 offset:128
    ds_read_b32 v77, v4 offset:132
    ds_read_b32 v76, v4 offset:144
    ds_read_b32 v47, v4 offset:148
    ds_read_b32 v46, v4 offset:160
    ds_read_b32 v31, v4 offset:164
    ds_read_b32 v30, v4 offset:176
    ds_read_b32 v63, v4 offset:180
    ds_read_b32 v62, v4 offset:192
    ds_read_b32 v23, v4 offset:196
    ds_read_b32 v22, v4 offset:208
    ds_read_b32 v55, v4 offset:212
    s_waitcnt lgkmcnt(0)
    ds_read_b32 v54, v4 offset:224
    ds_read_b32 v39, v4 offset:228
    ds_read_b32 v38, v4 offset:240
    ds_read_b32 v71, v4 offset:244
    ds_read_b32 v70, v4 offset:256
    ds_read_b32 v79, v4 offset:260
    ds_read_b32 v78, v4 offset:272
    ds_read_b32 v33, v4 offset:276
    ds_read_b32 v32, v4 offset:288
    ds_read_b32 v25, v4 offset:292
    ds_read_b32 v24, v4 offset:304
    ds_read_b32 v57, v4 offset:308
    ds_read_b32 v56, v4 offset:320
    ds_read_b32 v21, v4 offset:324
    s_waitcnt lgkmcnt(0)
    ds_read_b32 v20, v4 offset:336
    ds_read_b32 v53, v4 offset:340
    ds_read_b32 v52, v4 offset:352
    ds_read_b32 v37, v4 offset:356
    ds_read_b32 v36, v4 offset:368
    ds_read_b32 v69, v4 offset:372
    ds_read_b32 v68, v4 offset:384
    ds_read_b32 v19, v4 offset:388
    ds_read_b32 v18, v4 offset:400
    ds_read_b32 v51, v4 offset:404
    ds_read_b32 v50, v4 offset:416
    ds_read_b32 v35, v4 offset:420
    ds_read_b32 v34, v4 offset:432
    ds_read_b32 v67, v4 offset:436
    s_waitcnt lgkmcnt(0)
    ds_read_b32 v66, v4 offset:448
    ds_read_b32 v27, v4 offset:452
    ds_read_b32 v26, v4 offset:464
    ds_read_b32 v59, v4 offset:468
    ds_read_b32 v58, v4 offset:480
    ds_read_b32 v43, v4 offset:484
    ds_read_b32 v42, v4 offset:496
    ds_read_b32 v75, v4 offset:500
    s_waitcnt lgkmcnt(0)
    buffer_load_dword v88, v11, s[8:11], s19 offen offset:0
    buffer_load_dword v89, v11, s[8:11], s19 offen offset:128
    buffer_load_dword v90, v11, s[8:11], s19 offen offset:256
    buffer_load_dword v91, v11, s[8:11], s19 offen offset:384
    buffer_load_dword v92, v11, s[8:11], s19 offen offset:512
    buffer_load_dword v93, v11, s[8:11], s19 offen offset:640
    buffer_load_dword v94, v11, s[8:11], s19 offen offset:768
    buffer_load_dword v95, v11, s[8:11], s19 offen offset:896
    buffer_load_dword v96, v11, s[8:11], s19 offen offset:1024
    buffer_load_dword v97, v11, s[8:11], s19 offen offset:1152
    buffer_load_dword v98, v11, s[8:11], s19 offen offset:1280
    buffer_load_dword v99, v11, s[8:11], s19 offen offset:1408
    buffer_load_dword v100, v11, s[8:11], s19 offen offset:1536
    buffer_load_dword v101, v11, s[8:11], s19 offen offset:1664
    buffer_load_dword v102, v11, s[8:11], s19 offen offset:1792
    buffer_load_dword v103, v11, s[8:11], s19 offen offset:1920
    buffer_load_dword v104, v11, s[8:11], s19 offen offset:2048
    buffer_load_dword v105, v11, s[8:11], s19 offen offset:2176
    buffer_load_dword v106, v11, s[8:11], s19 offen offset:2304
    buffer_load_dword v107, v11, s[8:11], s19 offen offset:2432
    buffer_load_dword v108, v11, s[8:11], s19 offen offset:2560
    buffer_load_dword v109, v11, s[8:11], s19 offen offset:2688
    buffer_load_dword v110, v11, s[8:11], s19 offen offset:2816
    buffer_load_dword v111, v11, s[8:11], s19 offen offset:2944
    buffer_load_dword v112, v11, s[8:11], s19 offen offset:3072
    buffer_load_dword v113, v11, s[8:11], s19 offen offset:3200
    buffer_load_dword v114, v11, s[8:11], s19 offen offset:3328
    buffer_load_dword v115, v11, s[8:11], s19 offen offset:3456
    buffer_load_dword v116, v11, s[8:11], s19 offen offset:3584
    buffer_load_dword v117, v11, s[8:11], s19 offen offset:3712
    buffer_load_dword v118, v11, s[8:11], s19 offen offset:3840
    buffer_load_dword v119, v11, s[8:11], s19 offen offset:3968
    v_sub_f32 v48, v16, v70
    v_sub_f32 v49, v17, v79
    v_add_f32 v16, v16, v70
    v_add_f32 v17, v17, v79
    v_sub_f32 v70, v83, v78
    v_sub_f32 v79, v81, v33
    v_add_f32 v83, v83, v78
    v_add_f32 v81, v81, v33
    v_mul_f32 v78, 0x3f7b14be, v70
    v_mul_f32 v33, 0xbe47c5c2, v70
    v_fmac_f32 v78, 0x3e47c5c2, v79
    v_fmac_f32 v33, 0x3f7b14be, v79
    v_sub_f32 v70, v80, v32
    v_sub_f32 v79, v65, v25
    v_add_f32 v80, v80, v32
    v_add_f32 v65, v65, v25
    v_mul_f32 v32, 0x3f6c835e, v70
    v_mul_f32 v25, 0xbec3ef15, v70
    v_fmac_f32 v32, 0x3ec3ef15, v79
    v_fmac_f32 v25, 0x3f6c835e, v79
    v_sub_f32 v70, v64, v24
    v_sub_f32 v79, v41, v57
    v_add_f32 v64, v64, v24
    v_add_f32 v41, v41, v57
    v_mul_f32 v24, 0x3f54db31, v70
    v_mul_f32 v57, 0xbf0e39da, v70
    v_fmac_f32 v24, 0x3f0e39da, v79
    v_fmac_f32 v57, 0x3f54db31, v79
    v_sub_f32 v70, v40, v56
    v_sub_f32 v79, v73, v21
    v_add_f32 v40, v40, v56
    v_add_f32 v73, v73, v21
    v_mul_f32 v56, 0x3f3504f3, v70
    v_mul_f32 v21, 0xbf3504f3, v70
    v_fmac_f32 v56, 0x3f3504f3, v79
    v_fmac_f32 v21, 0x3f3504f3, v79
    v_sub_f32 v70, v72, v20
    v_sub_f32 v79, v45, v53
    v_add_f32 v72, v72, v20
    v_add_f32 v45, v45, v53
    v_mul_f32 v20, 0x3f0e39da, v70
    v_mul_f32 v53, 0xbf54db31, v70
    v_fmac_f32 v20, 0x3f54db31, v79
    v_fmac_f32 v53, 0x3f0e39da, v79
    v_sub_f32 v70, v44, v52
    v_sub_f32 v79, v29, v37
    v_add_f32 v44, v44, v52
    v_add_f32 v29, v29, v37
    v_mul_f32 v52, 0x3ec3ef15, v70
    v_mul_f32 v37, 0xbf6c835e, v70
    v_fmac_f32 v52, 0x3f6c835e, v79
    v_fmac_f32 v37, 0x3ec3ef15, v79
    v_sub_f32 v70, v28, v36
    v_sub_f32 v79, v61, v69
    v_add_f32 v28, v28, v36
    v_add_f32 v61, v61, v69
    v_mul_f32 v36, 0x3e47c5c2, v70
    v_mul_f32 v69, 0xbf7b14be, v70
    v_fmac_f32 v36, 0x3f7b14be, v79
    v_fmac_f32 v69, 0x3e47c5c2, v79
    v_sub_f32 v70, v77, v19
    v_sub_f32 v79, v68, v60
    v_add_f32 v60, v60, v68
    v_add_f32 v77, v77, v19
    v_sub_f32 v68, v76, v18
    v_sub_f32 v19, v47, v51
    v_add_f32 v76, v76, v18
    v_add_f32 v47, v47, v51
    v_mul_f32 v18, 0xbe47c5c2, v68
    v_mul_f32 v51, 0xbf7b14be, v68
    v_fmac_f32 v18, 0x3f7b14be, v19
    v_fmac_f32 v51, 0xbe47c5c2, v19
    v_sub_f32 v68, v46, v50
    v_sub_f32 v19, v31, v35
    v_add_f32 v46, v46, v50
    v_add_f32 v31, v31, v35
    v_mul_f32 v50, 0xbec3ef15, v68
    v_mul_f32 v35, 0xbf6c835e, v68
    v_fmac_f32 v50, 0x3f6c835e, v19
    v_fmac_f32 v35, 0xbec3ef15, v19
    v_sub_f32 v68, v30, v34
    v_sub_f32 v19, v63, v67
    v_add_f32 v30, v30, v34
    v_add_f32 v63, v63, v67
    v_mul_f32 v34, 0xbf0e39da, v68
    v_mul_f32 v67, 0xbf54db31, v68
    v_fmac_f32 v34, 0x3f54db31, v19
    v_fmac_f32 v67, 0xbf0e39da, v19
    v_sub_f32 v68, v62, v66
    v_sub_f32 v19, v23, v27
    v_add_f32 v62, v62, v66
    v_add_f32 v23, v23, v27
    v_mul_f32 v66, 0xbf3504f3, v68
    v_mul_f32 v27, 0xbf3504f3, v68
    v_fmac_f32 v66, 0x3f3504f3, v19
    v_fmac_f32 v27, 0xbf3504f3, v19
    v_sub_f32 v68, v22, v26
    v_sub_f32 v19, v55, v59
    v_add_f32 v22, v22, v26
    v_add_f32 v55, v55, v59
    v_mul_f32 v26, 0xbf54db31, v68
    v_mul_f32 v59, 0xbf0e39da, v68
    v_fmac_f32 v26, 0x3f0e39da, v19
    v_fmac_f32 v59, 0xbf54db31, v19
    v_sub_f32 v68, v54, v58
    v_sub_f32 v19, v39, v43
    v_add_f32 v54, v54, v58
    v_add_f32 v39, v39, v43
    v_mul_f32 v58, 0xbf6c835e, v68
    v_mul_f32 v43, 0xbec3ef15, v68
    v_fmac_f32 v58, 0x3ec3ef15, v19
    v_fmac_f32 v43, 0xbf6c835e, v19
    v_sub_f32 v68, v38, v42
    v_sub_f32 v19, v71, v75
    v_add_f32 v38, v38, v42
    v_add_f32 v71, v71, v75
    v_mul_f32 v42, 0xbf7b14be, v68
    v_mul_f32 v75, 0xbe47c5c2, v68
    v_fmac_f32 v42, 0x3e47c5c2, v19
    v_fmac_f32 v75, 0xbf7b14be, v19
    v_sub_f32 v68, v16, v60
    v_sub_f32 v19, v17, v77
    v_add_f32 v16, v16, v60
    v_add_f32 v17, v17, v77
    v_sub_f32 v60, v83, v76
    v_sub_f32 v77, v81, v47
    v_add_f32 v83, v83, v76
    v_add_f32 v81, v81, v47
    v_mul_f32 v76, 0x3f6c835e, v60
    v_mul_f32 v47, 0xbec3ef15, v60
    v_fmac_f32 v76, 0x3ec3ef15, v77
    v_fmac_f32 v47, 0x3f6c835e, v77
    v_sub_f32 v60, v80, v46
    v_sub_f32 v77, v65, v31
    v_add_f32 v80, v80, v46
    v_add_f32 v65, v65, v31
    v_mul_f32 v46, 0x3f3504f3, v60
    v_mul_f32 v31, 0xbf3504f3, v60
    v_fmac_f32 v46, 0x3f3504f3, v77
    v_fmac_f32 v31, 0x3f3504f3, v77
    v_sub_f32 v60, v64, v30
    v_sub_f32 v77, v41, v63
    v_add_f32 v64, v64, v30
    v_add_f32 v41, v41, v63
    v_mul_f32 v30, 0x3ec3ef15, v60
    v_mul_f32 v63, 0xbf6c835e, v60
    v_fmac_f32 v30, 0x3f6c835e, v77
    v_fmac_f32 v63, 0x3ec3ef15, v77
    v_sub_f32 v60, v73, v23
    v_sub_f32 v77, v62, v40
    v_add_f32 v40, v40, v62
    v_add_f32 v73, v73, v23
    v_sub_f32 v62, v72, v22
    v_sub_f32 v23, v45, v55
    v_add_f32 v72, v72, v22
    v_add_f32 v45, v45, v55
    v_mul_f32 v22, 0xbec3ef15, v62
    v_mul_f32 v55, 0xbf6c835e, v62
    v_fmac_f32 v22, 0x3f6c835e, v23
    v_fmac_f32 v55, 0xbec3ef15, v23
    v_sub_f32 v62, v44, v54
    v_sub_f32 v23, v29, v39
    v_add_f32 v44, v44, v54
    v_add_f32 v29, v29, v39
    v_mul_f32 v54, 0xbf3504f3, v62
    v_mul_f32 v39, 0xbf3504f3, v62
    v_fmac_f32 v54, 0x3f3504f3, v23
    v_fmac_f32 v39, 0xbf3504f3, v23
    v_sub_f32 v62, v28, v38
    v_sub_f32 v23, v61, v71
    v_add_f32 v28, v28, v38
    v_add_f32 v61, v61, v71
    v_mul_f32 v38, 0xbf6c835e, v62
    v_mul_f32 v71, 0xbec3ef15, v62
    v_fmac_f32 v38, 0x3ec3ef15, v23
    v_fmac_f32 v71, 0xbf6c835e, v23
    v_sub_f32 v62, v48, v70
    v_sub_f32 v23, v49, v79
    v_add_f32 v48, v48, v70
    v_add_f32 v49, v49, v79
    v_sub_f32 v70, v78, v18
    v_sub_f32 v79, v33, v51
    v_add_f32 v78, v78, v18
    v_add_f32 v33, v33, v51
    v_mul_f32 v18, 0x3f6c835e, v70
    v_mul_f32 v51, 0xbec3ef15, v70
    v_fmac_f32 v18, 0x3ec3ef15, v79
    v_fmac_f32 v51, 0x3f6c835e, v79
    v_sub_f32 v70, v32, v50
    v_sub_f32 v79, v25, v35
    v_add_f32 v32, v32, v50
    v_add_f32 v25, v25, v35
    v_mul_f32 v50, 0x3f3504f3, v70
    v_mul_f32 v35, 0xbf3504f3, v70
    v_fmac_f32 v50, 0x3f3504f3, v79
    v_fmac_f32 v35, 0x3f3504f3, v79
    v_sub_f32 v70, v24, v34
    v_sub_f32 v79, v57, v67
    v_add_f32 v24, v24, v34
    v_add_f32 v57, v57, v67
    v_mul_f32 v34, 0x3ec3ef15, v70
    v_mul_f32 v67, 0xbf6c835e, v70
    v_fmac_f32 v34, 0x3f6c835e, v79
    v_fmac_f32 v67, 0x3ec3ef15, v79
    v_sub_f32 v70, v21, v27
    v_sub_f32 v79, v66, v56
    v_add_f32 v56, v56, v66
    v_add_f32 v21, v21, v27
    v_sub_f32 v66, v20, v26
    v_sub_f32 v27, v53, v59
    v_add_f32 v20, v20, v26
    v_add_f32 v53, v53, v59
    v_mul_f32 v26, 0xbec3ef15, v66
    v_mul_f32 v59, 0xbf6c835e, v66
    v_fmac_f32 v26, 0x3f6c835e, v27
    v_fmac_f32 v59, 0xbec3ef15, v27
    v_sub_f32 v66, v52, v58
    v_sub_f32 v27, v37, v43
    v_add_f32 v52, v52, v58
    v_add_f32 v37, v37, v43
    v_mul_f32 v58, 0xbf3504f3, v66
    v_mul_f32 v43, 0xbf3504f3, v66
    v_fmac_f32 v58, 0x3f3504f3, v27
    v_fmac_f32 v43, 0xbf3504f3, v27
    v_sub_f32 v66, v36, v42
    v_sub_f32 v27, v69, v75
    v_add_f32 v36, v36, v42
    v_add_f32 v69, v69, v75
    v_mul_f32 v42, 0xbf6c835e, v66
    v_mul_f32 v75, 0xbec3ef15, v66
    v_fmac_f32 v42, 0x3ec3ef15, v27
    v_fmac_f32 v75, 0xbf6c835e, v27
    v_sub_f32 v66, v16, v40
    v_sub_f32 v27, v17, v73
    v_add_f32 v16, v16, v40
    v_add_f32 v17, v17, v73
    v_sub_f32 v40, v83, v72
    v_sub_f32 v73, v81, v45
    v_add_f32 v83, v83, v72
    v_add_f32 v81, v81, v45
    v_mul_f32 v72, 0x3f3504f3, v40
    v_mul_f32 v45, 0xbf3504f3, v40
    v_fmac_f32 v72, 0x3f3504f3, v73
    v_fmac_f32 v45, 0x3f3504f3, v73
    v_sub_f32 v40, v65, v29
    v_sub_f32 v73, v44, v80
    v_add_f32 v80, v80, v44
    v_add_f32 v65, v65, v29
    v_sub_f32 v44, v64, v28
    v_sub_f32 v29, v41, v61
    v_add_f32 v64, v64, v28
    v_add_f32 v41, v41, v61
    v_mul_f32 v28, 0xbf3504f3, v44
    v_mul_f32 v61, 0xbf3504f3, v44
    v_fmac_f32 v28, 0x3f3504f3, v29
    v_fmac_f32 v61, 0xbf3504f3, v29
    v_sub_f32 v44, v68, v60
    v_sub_f32 v29, v19, v77
    v_add_f32 v68, v68, v60
    v_add_f32 v19, v19, v77
    v_sub_f32 v60, v76, v22
    v_sub_f32 v77, v47, v55
    v_add_f32 v76, v76, v22
    v_add_f32 v47, v47, v55
    v_mul_f32 v22, 0x3f3504f3, v60
    v_mul_f32 v55, 0xbf3504f3, v60
    v_fmac_f32 v22, 0x3f3504f3, v77
    v_fmac_f32 v55, 0x3f3504f3, v77
    v_sub_f32 v60, v31, v39
    v_sub_f32 v77, v54, v46
    v_add_f32 v46, v46, v54
    v_add_f32 v31, v31, v39
    v_sub_f32 v54, v30, v38
    v_sub_f32 v39, v63, v71
    v_add_f32 v30, v30, v38
    v_add_f32 v63, v63, v71
    v_mul_f32 v38, 0xbf3504f3, v54
    v_mul_f32 v71, 0xbf3504f3, v54
    v_fmac_f32 v38, 0x3f3504f3, v39
    v_fmac_f32 v71, 0xbf3504f3, v39
    v_sub_f32 v54, v48, v56
    v_sub_f32 v39, v49, v21
    v_add_f32 v48, v48, v56
    v_add_f32 v49, v49, v21
    v_sub_f32 v56, v78, v20
    v_sub_f32 v21, v33, v53
    v_add_f32 v78, v78, v20
    v_add_f32 v33, v33, v53
    v_mul_f32 v20, 0x3f3504f3, v56
    v_mul_f32 v53, 0xbf3504f3, v56
    v_fmac_f32 v20, 0x3f3504f3, v21
    v_fmac_f32 v53, 0x3f3504f3, v21
    v_sub_f32 v56, v25, v37
    v_sub_f32 v21, v52, v32
    v_add_f32 v32, v32, v52
    v_add_f32 v25, v25, v37
    v_sub_f32 v52, v24, v36
    v_sub_f32 v37, v57, v69
    v_add_f32 v24, v24, v36
    v_add_f32 v57, v57, v69
    v_mul_f32 v36, 0xbf3504f3, v52
    v_mul_f32 v69, 0xbf3504f3, v52
    v_fmac_f32 v36, 0x3f3504f3, v37
    v_fmac_f32 v69, 0xbf3504f3, v37
    v_sub_f32 v52, v62, v70
    v_sub_f32 v37, v23, v79
    v_add_f32 v62, v62, v70
    v_add_f32 v23, v23, v79
    v_sub_f32 v70, v18, v26
    v_sub_f32 v79, v51, v59
    v_add_f32 v18, v18, v26
    v_add_f32 v51, v51, v59
    v_mul_f32 v26, 0x3f3504f3, v70
    v_mul_f32 v59, 0xbf3504f3, v70
    v_fmac_f32 v26, 0x3f3504f3, v79
    v_fmac_f32 v59, 0x3f3504f3, v79
    v_sub_f32 v70, v35, v43
    v_sub_f32 v79, v58, v50
    v_add_f32 v50, v50, v58
    v_add_f32 v35, v35, v43
    v_sub_f32 v58, v34, v42
    v_sub_f32 v43, v67, v75
    v_add_f32 v34, v34, v42
    v_add_f32 v67, v67, v75
    v_mul_f32 v42, 0xbf3504f3, v58
    v_mul_f32 v75, 0xbf3504f3, v58
    v_fmac_f32 v42, 0x3f3504f3, v43
    v_fmac_f32 v75, 0xbf3504f3, v43
    v_sub_f32 v58, v16, v80
    v_sub_f32 v43, v17, v65
    v_add_f32 v16, v16, v80
    v_add_f32 v17, v17, v65
    v_sub_f32 v80, v81, v41
    v_sub_f32 v65, v64, v83
    v_add_f32 v83, v83, v64
    v_add_f32 v81, v81, v41
    v_sub_f32 v64, v66, v40
    v_sub_f32 v41, v27, v73
    v_add_f32 v66, v66, v40
    v_add_f32 v27, v27, v73
    v_sub_f32 v40, v45, v61
    v_sub_f32 v73, v28, v72
    v_add_f32 v72, v72, v28
    v_add_f32 v45, v45, v61
    v_sub_f32 v28, v68, v46
    v_sub_f32 v61, v19, v31
    v_add_f32 v68, v68, v46
    v_add_f32 v19, v19, v31
    v_sub_f32 v46, v47, v63
    v_sub_f32 v31, v30, v76
    v_add_f32 v76, v76, v30
    v_add_f32 v47, v47, v63
    v_sub_f32 v30, v44, v60
    v_sub_f32 v63, v29, v77
    v_add_f32 v44, v44, v60
    v_add_f32 v29, v29, v77
    v_sub_f32 v60, v55, v71
    v_sub_f32 v77, v38, v22
    v_add_f32 v22, v22, v38
    v_add_f32 v55, v55, v71
    v_sub_f32 v38, v48, v32
    v_sub_f32 v71, v49, v25
    v_add_f32 v48, v48, v32
    v_add_f32 v49, v49, v25
    v_sub_f32 v32, v33, v57
    v_sub_f32 v25, v24, v78
    v_add_f32 v78, v78, v24
    v_add_f32 v33, v33, v57
    v_sub_f32 v24, v54, v56
    v_sub_f32 v57, v39, v21
    v_add_f32 v54, v54, v56
    v_add_f32 v39, v39, v21
    v_sub_f32 v56, v53, v69
    v_sub_f32 v21, v36, v20
    v_add_f32 v20, v20, v36
    v_add_f32 v53, v53, v69
    v_sub_f32 v36, v62, v50
    v_sub_f32 v69, v23, v35
    v_add_f32 v62, v62, v50
    v_add_f32 v23, v23, v35
    v_sub_f32 v50, v51, v67
    v_sub_f32 v35, v34, v18
    v_add_f32 v18, v18, v34
    v_add_f32 v51, v51, v67
    v_sub_f32 v34, v52, v70
    v_sub_f32 v67, v37, v79
    v_add_f32 v52, v52, v70
    v_add_f32 v37, v37, v79
    v_sub_f32 v70, v59, v75
    v_sub_f32 v79, v42, v26
    v_add_f32 v26, v26, v42
    v_add_f32 v59, v59, v75
    v_sub_f32 v42, v16, v83
    v_sub_f32 v75, v17, v81
    v_add_f32 v16, v16, v83
    v_add_f32 v17, v17, v81
    v_sub_f32 v83, v58, v80
    v_sub_f32 v81, v43, v65
    v_add_f32 v58, v58, v80
    v_add_f32 v43, v43, v65
    v_sub_f32 v80, v66, v72
    v_sub_f32 v65, v27, v45
    v_add_f32 v66, v66, v72
    v_add_f32 v27, v27, v45
    v_sub_f32 v72, v64, v40
    v_sub_f32 v45, v41, v73
    v_add_f32 v64, v64, v40
    v_add_f32 v41, v41, v73
    v_sub_f32 v40, v68, v76
    v_sub_f32 v73, v19, v47
    v_add_f32 v68, v68, v76
    v_add_f32 v19, v19, v47
    v_sub_f32 v76, v28, v46
    v_sub_f32 v47, v61, v31
    v_add_f32 v28, v28, v46
    v_add_f32 v61, v61, v31
    v_sub_f32 v46, v44, v22
    v_sub_f32 v31, v29, v55
    v_add_f32 v44, v44, v22
    v_add_f32 v29, v29, v55
    v_sub_f32 v22, v30, v60
    v_sub_f32 v55, v63, v77
    v_add_f32 v30, v30, v60
    v_add_f32 v63, v63, v77
    v_sub_f32 v60, v48, v78
    v_sub_f32 v77, v49, v33
    v_add_f32 v48, v48, v78
    v_add_f32 v49, v49, v33
    v_sub_f32 v78, v38, v32
    v_sub_f32 v33, v71, v25
    v_add_f32 v38, v38, v32
    v_add_f32 v71, v71, v25
    v_sub_f32 v32, v54, v20
    v_sub_f32 v25, v39, v53
    v_add_f32 v54, v54, v20
    v_add_f32 v39, v39, v53
    v_sub_f32 v20, v24, v56
    v_sub_f32 v53, v57, v21
    v_add_f32 v24, v24, v56
    v_add_f32 v57, v57, v21
    v_sub_f32 v56, v62, v18
    v_sub_f32 v21, v23, v51
    v_add_f32 v62, v62, v18
    v_add_f32 v23, v23, v51
    v_sub_f32 v18, v36, v50
    v_sub_f32 v51, v69, v35
    v_add_f32 v36, v36, v50
    v_add_f32 v69, v69, v35
    v_sub_f32 v50, v52, v26
    v_sub_f32 v35, v37, v59
    v_add_f32 v52, v52, v26
    v_add_f32 v37, v37, v59
    v_sub_f32 v26, v34, v70
    v_sub_f32 v59, v67, v79
    v_add_f32 v34, v34, v70
    v_add_f32 v67, v67, v79
    v_mul_f32 v70, 0xbc800000, v10
    v_cos_f32 v79, v70
    v_sin_f32 v82, v70
    s_nop 0
    v_mul_f32 v74, v48, v79
    v_fma_f32 v74, -v49, v82, v74
    v_mul_f32 v49, v49, v79
    v_fmac_f32 v49, v48, v82
    v_mul_f32 v70, 0xbd000000, v10
    v_cos_f32 v79, v70
    v_sin_f32 v82, v70
    s_nop 0
    v_mul_f32 v48, v68, v79
    v_fma_f32 v48, -v19, v82, v48
    v_mul_f32 v19, v19, v79
    v_fmac_f32 v19, v68, v82
    v_mul_f32 v70, 0xbd400000, v10
    v_cos_f32 v79, v70
    v_sin_f32 v82, v70
    s_nop 0
    v_mul_f32 v68, v62, v79
    v_fma_f32 v68, -v23, v82, v68
    v_mul_f32 v23, v23, v79
    v_fmac_f32 v23, v62, v82
    v_mul_f32 v70, 0xbd800000, v10
    v_cos_f32 v79, v70
    v_sin_f32 v82, v70
    s_nop 0
    v_mul_f32 v62, v66, v79
    v_fma_f32 v62, -v27, v82, v62
    v_mul_f32 v27, v27, v79
    v_fmac_f32 v27, v66, v82
    v_mul_f32 v70, 0xbda00000, v10
    v_cos_f32 v79, v70
    v_sin_f32 v82, v70
    s_nop 0
    v_mul_f32 v66, v54, v79
    v_fma_f32 v66, -v39, v82, v66
    v_mul_f32 v39, v39, v79
    v_fmac_f32 v39, v54, v82
    v_mul_f32 v70, 0xbdc00000, v10
    v_cos_f32 v79, v70
    v_sin_f32 v82, v70
    s_nop 0
    v_mul_f32 v54, v44, v79
    v_fma_f32 v54, -v29, v82, v54
    v_mul_f32 v29, v29, v79
    v_fmac_f32 v29, v44, v82
    v_mul_f32 v70, 0xbde00000, v10
    v_cos_f32 v79, v70
    v_sin_f32 v82, v70
    s_nop 0
    v_mul_f32 v44, v52, v79
    v_fma_f32 v44, -v37, v82, v44
    v_mul_f32 v37, v37, v79
    v_fmac_f32 v37, v52, v82
    v_mul_f32 v70, 0xbe000000, v10
    v_cos_f32 v79, v70
    v_sin_f32 v82, v70
    s_nop 0
    v_mul_f32 v52, v58, v79
    v_fma_f32 v52, -v43, v82, v52
    v_mul_f32 v43, v43, v79
    v_fmac_f32 v43, v58, v82
    v_mul_f32 v70, 0xbe100000, v10
    v_cos_f32 v79, v70
    v_sin_f32 v82, v70
    s_nop 0
    v_mul_f32 v58, v38, v79
    v_fma_f32 v58, -v71, v82, v58
    v_mul_f32 v71, v71, v79
    v_fmac_f32 v71, v38, v82
    v_mul_f32 v70, 0xbe200000, v10
    v_cos_f32 v79, v70
    v_sin_f32 v82, v70
    s_nop 0
    v_mul_f32 v38, v28, v79
    v_fma_f32 v38, -v61, v82, v38
    v_mul_f32 v61, v61, v79
    v_fmac_f32 v61, v28, v82
    v_mul_f32 v70, 0xbe300000, v10
    v_cos_f32 v79, v70
    v_sin_f32 v82, v70
    s_nop 0
    v_mul_f32 v28, v36, v79
    v_fma_f32 v28, -v69, v82, v28
    v_mul_f32 v69, v69, v79
    v_fmac_f32 v69, v36, v82
    v_mul_f32 v70, 0xbe400000, v10
    v_cos_f32 v79, v70
    v_sin_f32 v82, v70
    s_nop 0
    v_mul_f32 v36, v64, v79
    v_fma_f32 v36, -v41, v82, v36
    v_mul_f32 v41, v41, v79
    v_fmac_f32 v41, v64, v82
    v_mul_f32 v70, 0xbe500000, v10
    v_cos_f32 v79, v70
    v_sin_f32 v82, v70
    s_nop 0
    v_mul_f32 v64, v24, v79
    v_fma_f32 v64, -v57, v82, v64
    v_mul_f32 v57, v57, v79
    v_fmac_f32 v57, v24, v82
    v_mul_f32 v70, 0xbe600000, v10
    v_cos_f32 v79, v70
    v_sin_f32 v82, v70
    s_nop 0
    v_mul_f32 v24, v30, v79
    v_fma_f32 v24, -v63, v82, v24
    v_mul_f32 v63, v63, v79
    v_fmac_f32 v63, v30, v82
    v_mul_f32 v70, 0xbe700000, v10
    v_cos_f32 v79, v70
    v_sin_f32 v82, v70
    s_nop 0
    v_mul_f32 v30, v34, v79
    v_fma_f32 v30, -v67, v82, v30
    v_mul_f32 v67, v67, v79
    v_fmac_f32 v67, v34, v82
    v_mul_f32 v70, 0xbe800000, v10
    v_cos_f32 v79, v70
    v_sin_f32 v82, v70
    s_nop 0
    v_mul_f32 v34, v42, v79
    v_fma_f32 v34, -v75, v82, v34
    v_mul_f32 v75, v75, v79
    v_fmac_f32 v75, v42, v82
    v_mul_f32 v70, 0xbe880000, v10
    v_cos_f32 v79, v70
    v_sin_f32 v82, v70
    s_nop 0
    v_mul_f32 v42, v60, v79
    v_fma_f32 v42, -v77, v82, v42
    v_mul_f32 v77, v77, v79
    v_fmac_f32 v77, v60, v82
    v_mul_f32 v70, 0xbe900000, v10
    v_cos_f32 v79, v70
    v_sin_f32 v82, v70
    s_nop 0
    v_mul_f32 v60, v40, v79
    v_fma_f32 v60, -v73, v82, v60
    v_mul_f32 v73, v73, v79
    v_fmac_f32 v73, v40, v82
    v_mul_f32 v70, 0xbe980000, v10
    v_cos_f32 v79, v70
    v_sin_f32 v82, v70
    s_nop 0
    v_mul_f32 v40, v56, v79
    v_fma_f32 v40, -v21, v82, v40
    v_mul_f32 v21, v21, v79
    v_fmac_f32 v21, v56, v82
    v_mul_f32 v70, 0xbea00000, v10
    v_cos_f32 v79, v70
    v_sin_f32 v82, v70
    s_nop 0
    v_mul_f32 v56, v80, v79
    v_fma_f32 v56, -v65, v82, v56
    v_mul_f32 v65, v65, v79
    v_fmac_f32 v65, v80, v82
    v_mul_f32 v70, 0xbea80000, v10
    v_cos_f32 v79, v70
    v_sin_f32 v82, v70
    s_nop 0
    v_mul_f32 v80, v32, v79
    v_fma_f32 v80, -v25, v82, v80
    v_mul_f32 v25, v25, v79
    v_fmac_f32 v25, v32, v82
    v_mul_f32 v70, 0xbeb00000, v10
    v_cos_f32 v79, v70
    v_sin_f32 v82, v70
    s_nop 0
    v_mul_f32 v32, v46, v79
    v_fma_f32 v32, -v31, v82, v32
    v_mul_f32 v31, v31, v79
    v_fmac_f32 v31, v46, v82
    v_mul_f32 v70, 0xbeb80000, v10
    v_cos_f32 v79, v70
    v_sin_f32 v82, v70
    s_nop 0
    v_mul_f32 v46, v50, v79
    v_fma_f32 v46, -v35, v82, v46
    v_mul_f32 v35, v35, v79
    v_fmac_f32 v35, v50, v82
    v_mul_f32 v70, 0xbec00000, v10
    v_cos_f32 v79, v70
    v_sin_f32 v82, v70
    s_nop 0
    v_mul_f32 v50, v83, v79
    v_fma_f32 v50, -v81, v82, v50
    v_mul_f32 v81, v81, v79
    v_fmac_f32 v81, v83, v82
    v_mul_f32 v70, 0xbec80000, v10
    v_cos_f32 v79, v70
    v_sin_f32 v82, v70
    s_nop 0
    v_mul_f32 v83, v78, v79
    v_fma_f32 v83, -v33, v82, v83
    v_mul_f32 v33, v33, v79
    v_fmac_f32 v33, v78, v82
    v_mul_f32 v70, 0xbed00000, v10
    v_cos_f32 v79, v70
    v_sin_f32 v82, v70
    s_nop 0
    v_mul_f32 v78, v76, v79
    v_fma_f32 v78, -v47, v82, v78
    v_mul_f32 v47, v47, v79
    v_fmac_f32 v47, v76, v82
    v_mul_f32 v70, 0xbed80000, v10
    v_cos_f32 v79, v70
    v_sin_f32 v82, v70
    s_nop 0
    v_mul_f32 v76, v18, v79
    v_fma_f32 v76, -v51, v82, v76
    v_mul_f32 v51, v51, v79
    v_fmac_f32 v51, v18, v82
    v_mul_f32 v70, 0xbee00000, v10
    v_cos_f32 v79, v70
    v_sin_f32 v82, v70
    s_nop 0
    v_mul_f32 v18, v72, v79
    v_fma_f32 v18, -v45, v82, v18
    v_mul_f32 v45, v45, v79
    v_fmac_f32 v45, v72, v82
    v_mul_f32 v70, 0xbee80000, v10
    v_cos_f32 v79, v70
    v_sin_f32 v82, v70
    s_nop 0
    v_mul_f32 v72, v20, v79
    v_fma_f32 v72, -v53, v82, v72
    v_mul_f32 v53, v53, v79
    v_fmac_f32 v53, v20, v82
    v_mul_f32 v70, 0xbef00000, v10
    v_cos_f32 v79, v70
    v_sin_f32 v82, v70
    s_nop 0
    v_mul_f32 v20, v22, v79
    v_fma_f32 v20, -v55, v82, v20
    v_mul_f32 v55, v55, v79
    v_fmac_f32 v55, v22, v82
    v_mul_f32 v70, 0xbef80000, v10
    v_cos_f32 v79, v70
    v_sin_f32 v82, v70
    s_nop 0
    v_mul_f32 v22, v26, v79
    v_fma_f32 v22, -v59, v82, v22
    v_mul_f32 v59, v59, v79
    v_fmac_f32 v59, v26, v82
    s_nop 1
    v_mov_b32_dpp v70, v16 quad_perm:[1,0,3,2] row_mask:0xf bank_mask:0xf
    v_fma_f32 v16, v16, v9, v70
    v_mov_b32_dpp v70, v17 quad_perm:[1,0,3,2] row_mask:0xf bank_mask:0xf
    v_fma_f32 v17, v17, v9, v70
    v_mov_b32_dpp v70, v74 quad_perm:[1,0,3,2] row_mask:0xf bank_mask:0xf
    v_fma_f32 v74, v74, v9, v70
    v_mov_b32_dpp v70, v49 quad_perm:[1,0,3,2] row_mask:0xf bank_mask:0xf
    v_fma_f32 v49, v49, v9, v70
    v_mov_b32_dpp v70, v48 quad_perm:[1,0,3,2] row_mask:0xf bank_mask:0xf
    v_fma_f32 v48, v48, v9, v70
    v_mov_b32_dpp v70, v19 quad_perm:[1,0,3,2] row_mask:0xf bank_mask:0xf
    v_fma_f32 v19, v19, v9, v70
    v_mov_b32_dpp v70, v68 quad_perm:[1,0,3,2] row_mask:0xf bank_mask:0xf
    v_fma_f32 v68, v68, v9, v70
    v_mov_b32_dpp v70, v23 quad_perm:[1,0,3,2] row_mask:0xf bank_mask:0xf
    v_fma_f32 v23, v23, v9, v70
    v_mov_b32_dpp v70, v62 quad_perm:[1,0,3,2] row_mask:0xf bank_mask:0xf
    v_fma_f32 v62, v62, v9, v70
    v_mov_b32_dpp v70, v27 quad_perm:[1,0,3,2] row_mask:0xf bank_mask:0xf
    v_fma_f32 v27, v27, v9, v70
    v_mov_b32_dpp v70, v66 quad_perm:[1,0,3,2] row_mask:0xf bank_mask:0xf
    v_fma_f32 v66, v66, v9, v70
    v_mov_b32_dpp v70, v39 quad_perm:[1,0,3,2] row_mask:0xf bank_mask:0xf
    v_fma_f32 v39, v39, v9, v70
    v_mov_b32_dpp v70, v54 quad_perm:[1,0,3,2] row_mask:0xf bank_mask:0xf
    v_fma_f32 v54, v54, v9, v70
    v_mov_b32_dpp v70, v29 quad_perm:[1,0,3,2] row_mask:0xf bank_mask:0xf
    v_fma_f32 v29, v29, v9, v70
    v_mov_b32_dpp v70, v44 quad_perm:[1,0,3,2] row_mask:0xf bank_mask:0xf
    v_fma_f32 v44, v44, v9, v70
    v_mov_b32_dpp v70, v37 quad_perm:[1,0,3,2] row_mask:0xf bank_mask:0xf
    v_fma_f32 v37, v37, v9, v70
    v_mov_b32_dpp v70, v52 quad_perm:[1,0,3,2] row_mask:0xf bank_mask:0xf
    v_fma_f32 v52, v52, v9, v70
    v_mov_b32_dpp v70, v43 quad_perm:[1,0,3,2] row_mask:0xf bank_mask:0xf
    v_fma_f32 v43, v43, v9, v70
    v_mov_b32_dpp v70, v58 quad_perm:[1,0,3,2] row_mask:0xf bank_mask:0xf
    v_fma_f32 v58, v58, v9, v70
    v_mov_b32_dpp v70, v71 quad_perm:[1,0,3,2] row_mask:0xf bank_mask:0xf
    v_fma_f32 v71, v71, v9, v70
    v_mov_b32_dpp v70, v38 quad_perm:[1,0,3,2] row_mask:0xf bank_mask:0xf
    v_fma_f32 v38, v38, v9, v70
    v_mov_b32_dpp v70, v61 quad_perm:[1,0,3,2] row_mask:0xf bank_mask:0xf
    v_fma_f32 v61, v61, v9, v70
    v_mov_b32_dpp v70, v28 quad_perm:[1,0,3,2] row_mask:0xf bank_mask:0xf
    v_fma_f32 v28, v28, v9, v70
    v_mov_b32_dpp v70, v69 quad_perm:[1,0,3,2] row_mask:0xf bank_mask:0xf
    v_fma_f32 v69, v69, v9, v70
    v_mov_b32_dpp v70, v36 quad_perm:[1,0,3,2] row_mask:0xf bank_mask:0xf
    v_fma_f32 v36, v36, v9, v70
    v_mov_b32_dpp v70, v41 quad_perm:[1,0,3,2] row_mask:0xf bank_mask:0xf
    v_fma_f32 v41, v41, v9, v70
    v_mov_b32_dpp v70, v64 quad_perm:[1,0,3,2] row_mask:0xf bank_mask:0xf
    v_fma_f32 v64, v64, v9, v70
    v_mov_b32_dpp v70, v57 quad_perm:[1,0,3,2] row_mask:0xf bank_mask:0xf
    v_fma_f32 v57, v57, v9, v70
    v_mov_b32_dpp v70, v24 quad_perm:[1,0,3,2] row_mask:0xf bank_mask:0xf
    v_fma_f32 v24, v24, v9, v70
    v_mov_b32_dpp v70, v63 quad_perm:[1,0,3,2] row_mask:0xf bank_mask:0xf
    v_fma_f32 v63, v63, v9, v70
    v_mov_b32_dpp v70, v30 quad_perm:[1,0,3,2] row_mask:0xf bank_mask:0xf
    v_fma_f32 v30, v30, v9, v70
    v_mov_b32_dpp v70, v67 quad_perm:[1,0,3,2] row_mask:0xf bank_mask:0xf
    v_fma_f32 v67, v67, v9, v70
    v_mov_b32_dpp v70, v34 quad_perm:[1,0,3,2] row_mask:0xf bank_mask:0xf
    v_fma_f32 v34, v34, v9, v70
    v_mov_b32_dpp v70, v75 quad_perm:[1,0,3,2] row_mask:0xf bank_mask:0xf
    v_fma_f32 v75, v75, v9, v70
    v_mov_b32_dpp v70, v42 quad_perm:[1,0,3,2] row_mask:0xf bank_mask:0xf
    v_fma_f32 v42, v42, v9, v70
    v_mov_b32_dpp v70, v77 quad_perm:[1,0,3,2] row_mask:0xf bank_mask:0xf
    v_fma_f32 v77, v77, v9, v70
    v_mov_b32_dpp v70, v60 quad_perm:[1,0,3,2] row_mask:0xf bank_mask:0xf
    v_fma_f32 v60, v60, v9, v70
    v_mov_b32_dpp v70, v73 quad_perm:[1,0,3,2] row_mask:0xf bank_mask:0xf
    v_fma_f32 v73, v73, v9, v70
    v_mov_b32_dpp v70, v40 quad_perm:[1,0,3,2] row_mask:0xf bank_mask:0xf
    v_fma_f32 v40, v40, v9, v70
    v_mov_b32_dpp v70, v21 quad_perm:[1,0,3,2] row_mask:0xf bank_mask:0xf
    v_fma_f32 v21, v21, v9, v70
    v_mov_b32_dpp v70, v56 quad_perm:[1,0,3,2] row_mask:0xf bank_mask:0xf
    v_fma_f32 v56, v56, v9, v70
    v_mov_b32_dpp v70, v65 quad_perm:[1,0,3,2] row_mask:0xf bank_mask:0xf
    v_fma_f32 v65, v65, v9, v70
    v_mov_b32_dpp v70, v80 quad_perm:[1,0,3,2] row_mask:0xf bank_mask:0xf
    v_fma_f32 v80, v80, v9, v70
    v_mov_b32_dpp v70, v25 quad_perm:[1,0,3,2] row_mask:0xf bank_mask:0xf
    v_fma_f32 v25, v25, v9, v70
    v_mov_b32_dpp v70, v32 quad_perm:[1,0,3,2] row_mask:0xf bank_mask:0xf
    v_fma_f32 v32, v32, v9, v70
    v_mov_b32_dpp v70, v31 quad_perm:[1,0,3,2] row_mask:0xf bank_mask:0xf
    v_fma_f32 v31, v31, v9, v70
    v_mov_b32_dpp v70, v46 quad_perm:[1,0,3,2] row_mask:0xf bank_mask:0xf
    v_fma_f32 v46, v46, v9, v70
    v_mov_b32_dpp v70, v35 quad_perm:[1,0,3,2] row_mask:0xf bank_mask:0xf
    v_fma_f32 v35, v35, v9, v70
    v_mov_b32_dpp v70, v50 quad_perm:[1,0,3,2] row_mask:0xf bank_mask:0xf
    v_fma_f32 v50, v50, v9, v70
    v_mov_b32_dpp v70, v81 quad_perm:[1,0,3,2] row_mask:0xf bank_mask:0xf
    v_fma_f32 v81, v81, v9, v70
    v_mov_b32_dpp v70, v83 quad_perm:[1,0,3,2] row_mask:0xf bank_mask:0xf
    v_fma_f32 v83, v83, v9, v70
    v_mov_b32_dpp v70, v33 quad_perm:[1,0,3,2] row_mask:0xf bank_mask:0xf
    v_fma_f32 v33, v33, v9, v70
    v_mov_b32_dpp v70, v78 quad_perm:[1,0,3,2] row_mask:0xf bank_mask:0xf
    v_fma_f32 v78, v78, v9, v70
    v_mov_b32_dpp v70, v47 quad_perm:[1,0,3,2] row_mask:0xf bank_mask:0xf
    v_fma_f32 v47, v47, v9, v70
    v_mov_b32_dpp v70, v76 quad_perm:[1,0,3,2] row_mask:0xf bank_mask:0xf
    v_fma_f32 v76, v76, v9, v70
    v_mov_b32_dpp v70, v51 quad_perm:[1,0,3,2] row_mask:0xf bank_mask:0xf
    v_fma_f32 v51, v51, v9, v70
    v_mov_b32_dpp v70, v18 quad_perm:[1,0,3,2] row_mask:0xf bank_mask:0xf
    v_fma_f32 v18, v18, v9, v70
    v_mov_b32_dpp v70, v45 quad_perm:[1,0,3,2] row_mask:0xf bank_mask:0xf
    v_fma_f32 v45, v45, v9, v70
    v_mov_b32_dpp v70, v72 quad_perm:[1,0,3,2] row_mask:0xf bank_mask:0xf
    v_fma_f32 v72, v72, v9, v70
    v_mov_b32_dpp v70, v53 quad_perm:[1,0,3,2] row_mask:0xf bank_mask:0xf
    v_fma_f32 v53, v53, v9, v70
    v_mov_b32_dpp v70, v20 quad_perm:[1,0,3,2] row_mask:0xf bank_mask:0xf
    v_fma_f32 v20, v20, v9, v70
    v_mov_b32_dpp v70, v55 quad_perm:[1,0,3,2] row_mask:0xf bank_mask:0xf
    v_fma_f32 v55, v55, v9, v70
    v_mov_b32_dpp v70, v22 quad_perm:[1,0,3,2] row_mask:0xf bank_mask:0xf
    v_fma_f32 v22, v22, v9, v70
    v_mov_b32_dpp v70, v59 quad_perm:[1,0,3,2] row_mask:0xf bank_mask:0xf
    v_fma_f32 v59, v59, v9, v70
    s_waitcnt vmcnt(0)
    s_mov_b32 s20, 0x34800000
    v_lshlrev_b32 v70, 16, v88
    v_and_b32 v79, 0xffff0000, v88
    v_mul_f32 v70, s20, v70
    v_mul_f32 v79, s20, v79
    v_mul_f32 v82, v16, v70
    v_fma_f32 v82, -v17, v79, v82
    v_mul_f32 v17, v17, v70
    v_fmac_f32 v17, v16, v79
    v_lshlrev_b32 v70, 16, v89
    v_and_b32 v79, 0xffff0000, v89
    v_mul_f32 v70, s20, v70
    v_mul_f32 v79, s20, v79
    v_mul_f32 v16, v74, v70
    v_fma_f32 v16, -v49, v79, v16
    v_mul_f32 v49, v49, v70
    v_fmac_f32 v49, v74, v79
    v_lshlrev_b32 v70, 16, v90
    v_and_b32 v79, 0xffff0000, v90
    v_mul_f32 v70, s20, v70
    v_mul_f32 v79, s20, v79
    v_mul_f32 v74, v48, v70
    v_fma_f32 v74, -v19, v79, v74
    v_mul_f32 v19, v19, v70
    v_fmac_f32 v19, v48, v79
    v_lshlrev_b32 v70, 16, v91
    v_and_b32 v79, 0xffff0000, v91
    v_mul_f32 v70, s20, v70
    v_mul_f32 v79, s20, v79
    v_mul_f32 v48, v68, v70
    v_fma_f32 v48, -v23, v79, v48
    v_mul_f32 v23, v23, v70
    v_fmac_f32 v23, v68, v79
    v_lshlrev_b32 v70, 16, v92
    v_and_b32 v79, 0xffff0000, v92
    v_mul_f32 v70, s20, v70
    v_mul_f32 v79, s20, v79
    v_mul_f32 v68, v62, v70
    v_fma_f32 v68, -v27, v79, v68
    v_mul_f32 v27, v27, v70
    v_fmac_f32 v27, v62, v79
    v_lshlrev_b32 v70, 16, v93
    v_and_b32 v79, 0xffff0000, v93
    v_mul_f32 v70, s20, v70
    v_mul_f32 v79, s20, v79
    v_mul_f32 v62, v66, v70
    v_fma_f32 v62, -v39, v79, v62
    v_mul_f32 v39, v39, v70
    v_fmac_f32 v39, v66, v79
    v_lshlrev_b32 v70, 16, v94
    v_and_b32 v79, 0xffff0000, v94
    v_mul_f32 v70, s20, v70
    v_mul_f32 v79, s20, v79
    v_mul_f32 v66, v54, v70
    v_fma_f32 v66, -v29, v79, v66
    v_mul_f32 v29, v29, v70
    v_fmac_f32 v29, v54, v79
    v_lshlrev_b32 v70, 16, v95
    v_and_b32 v79, 0xffff0000, v95
    v_mul_f32 v70, s20, v70
    v_mul_f32 v79, s20, v79
    v_mul_f32 v54, v44, v70
    v_fma_f32 v54, -v37, v79, v54
    v_mul_f32 v37, v37, v70
    v_fmac_f32 v37, v44, v79
    v_lshlrev_b32 v70, 16, v96
    v_and_b32 v79, 0xffff0000, v96
    v_mul_f32 v70, s20, v70
    v_mul_f32 v79, s20, v79
    v_mul_f32 v44, v52, v70
    v_fma_f32 v44, -v43, v79, v44
    v_mul_f32 v43, v43, v70
    v_fmac_f32 v43, v52, v79
    v_lshlrev_b32 v70, 16, v97
    v_and_b32 v79, 0xffff0000, v97
    v_mul_f32 v70, s20, v70
    v_mul_f32 v79, s20, v79
    v_mul_f32 v52, v58, v70
    v_fma_f32 v52, -v71, v79, v52
    v_mul_f32 v71, v71, v70
    v_fmac_f32 v71, v58, v79
    v_lshlrev_b32 v70, 16, v98
    v_and_b32 v79, 0xffff0000, v98
    v_mul_f32 v70, s20, v70
    v_mul_f32 v79, s20, v79
    v_mul_f32 v58, v38, v70
    v_fma_f32 v58, -v61, v79, v58
    v_mul_f32 v61, v61, v70
    v_fmac_f32 v61, v38, v79
    v_lshlrev_b32 v70, 16, v99
    v_and_b32 v79, 0xffff0000, v99
    v_mul_f32 v70, s20, v70
    v_mul_f32 v79, s20, v79
    v_mul_f32 v38, v28, v70
    v_fma_f32 v38, -v69, v79, v38
    v_mul_f32 v69, v69, v70
    v_fmac_f32 v69, v28, v79
    v_lshlrev_b32 v70, 16, v100
    v_and_b32 v79, 0xffff0000, v100
    v_mul_f32 v70, s20, v70
    v_mul_f32 v79, s20, v79
    v_mul_f32 v28, v36, v70
    v_fma_f32 v28, -v41, v79, v28
    v_mul_f32 v41, v41, v70
    v_fmac_f32 v41, v36, v79
    v_lshlrev_b32 v70, 16, v101
    v_and_b32 v79, 0xffff0000, v101
    v_mul_f32 v70, s20, v70
    v_mul_f32 v79, s20, v79
    v_mul_f32 v36, v64, v70
    v_fma_f32 v36, -v57, v79, v36
    v_mul_f32 v57, v57, v70
    v_fmac_f32 v57, v64, v79
    v_lshlrev_b32 v70, 16, v102
    v_and_b32 v79, 0xffff0000, v102
    v_mul_f32 v70, s20, v70
    v_mul_f32 v79, s20, v79
    v_mul_f32 v64, v24, v70
    v_fma_f32 v64, -v63, v79, v64
    v_mul_f32 v63, v63, v70
    v_fmac_f32 v63, v24, v79
    v_lshlrev_b32 v70, 16, v103
    v_and_b32 v79, 0xffff0000, v103
    v_mul_f32 v70, s20, v70
    v_mul_f32 v79, s20, v79
    v_mul_f32 v24, v30, v70
    v_fma_f32 v24, -v67, v79, v24
    v_mul_f32 v67, v67, v70
    v_fmac_f32 v67, v30, v79
    v_lshlrev_b32 v70, 16, v104
    v_and_b32 v79, 0xffff0000, v104
    v_mul_f32 v70, s20, v70
    v_mul_f32 v79, s20, v79
    v_mul_f32 v30, v34, v70
    v_fma_f32 v30, -v75, v79, v30
    v_mul_f32 v75, v75, v70
    v_fmac_f32 v75, v34, v79
    v_lshlrev_b32 v70, 16, v105
    v_and_b32 v79, 0xffff0000, v105
    v_mul_f32 v70, s20, v70
    v_mul_f32 v79, s20, v79
    v_mul_f32 v34, v42, v70
    v_fma_f32 v34, -v77, v79, v34
    v_mul_f32 v77, v77, v70
    v_fmac_f32 v77, v42, v79
    v_lshlrev_b32 v70, 16, v106
    v_and_b32 v79, 0xffff0000, v106
    v_mul_f32 v70, s20, v70
    v_mul_f32 v79, s20, v79
    v_mul_f32 v42, v60, v70
    v_fma_f32 v42, -v73, v79, v42
    v_mul_f32 v73, v73, v70
    v_fmac_f32 v73, v60, v79
    v_lshlrev_b32 v70, 16, v107
    v_and_b32 v79, 0xffff0000, v107
    v_mul_f32 v70, s20, v70
    v_mul_f32 v79, s20, v79
    v_mul_f32 v60, v40, v70
    v_fma_f32 v60, -v21, v79, v60
    v_mul_f32 v21, v21, v70
    v_fmac_f32 v21, v40, v79
    v_lshlrev_b32 v70, 16, v108
    v_and_b32 v79, 0xffff0000, v108
    v_mul_f32 v70, s20, v70
    v_mul_f32 v79, s20, v79
    v_mul_f32 v40, v56, v70
    v_fma_f32 v40, -v65, v79, v40
    v_mul_f32 v65, v65, v70
    v_fmac_f32 v65, v56, v79
    v_lshlrev_b32 v70, 16, v109
    v_and_b32 v79, 0xffff0000, v109
    v_mul_f32 v70, s20, v70
    v_mul_f32 v79, s20, v79
    v_mul_f32 v56, v80, v70
    v_fma_f32 v56, -v25, v79, v56
    v_mul_f32 v25, v25, v70
    v_fmac_f32 v25, v80, v79
    v_lshlrev_b32 v70, 16, v110
    v_and_b32 v79, 0xffff0000, v110
    v_mul_f32 v70, s20, v70
    v_mul_f32 v79, s20, v79
    v_mul_f32 v80, v32, v70
    v_fma_f32 v80, -v31, v79, v80
    v_mul_f32 v31, v31, v70
    v_fmac_f32 v31, v32, v79
    v_lshlrev_b32 v70, 16, v111
    v_and_b32 v79, 0xffff0000, v111
    v_mul_f32 v70, s20, v70
    v_mul_f32 v79, s20, v79
    v_mul_f32 v32, v46, v70
    v_fma_f32 v32, -v35, v79, v32
    v_mul_f32 v35, v35, v70
    v_fmac_f32 v35, v46, v79
    v_lshlrev_b32 v70, 16, v112
    v_and_b32 v79, 0xffff0000, v112
    v_mul_f32 v70, s20, v70
    v_mul_f32 v79, s20, v79
    v_mul_f32 v46, v50, v70
    v_fma_f32 v46, -v81, v79, v46
    v_mul_f32 v81, v81, v70
    v_fmac_f32 v81, v50, v79
    v_lshlrev_b32 v70, 16, v113
    v_and_b32 v79, 0xffff0000, v113
    v_mul_f32 v70, s20, v70
    v_mul_f32 v79, s20, v79
    v_mul_f32 v50, v83, v70
    v_fma_f32 v50, -v33, v79, v50
    v_mul_f32 v33, v33, v70
    v_fmac_f32 v33, v83, v79
    v_lshlrev_b32 v70, 16, v114
    v_and_b32 v79, 0xffff0000, v114
    v_mul_f32 v70, s20, v70
    v_mul_f32 v79, s20, v79
    v_mul_f32 v83, v78, v70
    v_fma_f32 v83, -v47, v79, v83
    v_mul_f32 v47, v47, v70
    v_fmac_f32 v47, v78, v79
    v_lshlrev_b32 v70, 16, v115
    v_and_b32 v79, 0xffff0000, v115
    v_mul_f32 v70, s20, v70
    v_mul_f32 v79, s20, v79
    v_mul_f32 v78, v76, v70
    v_fma_f32 v78, -v51, v79, v78
    v_mul_f32 v51, v51, v70
    v_fmac_f32 v51, v76, v79
    v_lshlrev_b32 v70, 16, v116
    v_and_b32 v79, 0xffff0000, v116
    v_mul_f32 v70, s20, v70
    v_mul_f32 v79, s20, v79
    v_mul_f32 v76, v18, v70
    v_fma_f32 v76, -v45, v79, v76
    v_mul_f32 v45, v45, v70
    v_fmac_f32 v45, v18, v79
    v_lshlrev_b32 v70, 16, v117
    v_and_b32 v79, 0xffff0000, v117
    v_mul_f32 v70, s20, v70
    v_mul_f32 v79, s20, v79
    v_mul_f32 v18, v72, v70
    v_fma_f32 v18, -v53, v79, v18
    v_mul_f32 v53, v53, v70
    v_fmac_f32 v53, v72, v79
    v_lshlrev_b32 v70, 16, v118
    v_and_b32 v79, 0xffff0000, v118
    v_mul_f32 v70, s20, v70
    v_mul_f32 v79, s20, v79
    v_mul_f32 v72, v20, v70
    v_fma_f32 v72, -v55, v79, v72
    v_mul_f32 v55, v55, v70
    v_fmac_f32 v55, v20, v79
    v_lshlrev_b32 v70, 16, v119
    v_and_b32 v79, 0xffff0000, v119
    v_mul_f32 v70, s20, v70
    v_mul_f32 v79, s20, v79
    v_mul_f32 v20, v22, v70
    v_fma_f32 v20, -v59, v79, v20
    v_mul_f32 v59, v59, v70
    v_fmac_f32 v59, v22, v79
    s_waitcnt vmcnt(0)
    ds_read_b64_tr_b16 a[64:65], v201 offset:0
    ds_read_b64_tr_b16 a[66:67], v201 offset:256
    ds_read_b64_tr_b16 a[68:69], v201 offset:1024
    ds_read_b64_tr_b16 a[70:71], v201 offset:1280
    ds_read_b64_tr_b16 a[72:73], v201 offset:2048
    ds_read_b64_tr_b16 a[74:75], v201 offset:2304
    ds_read_b64_tr_b16 a[76:77], v201 offset:3072
    ds_read_b64_tr_b16 a[78:79], v201 offset:3328
    s_waitcnt lgkmcnt(0)
    ds_read_b64_tr_b16 a[80:81], v201 offset:4096
    ds_read_b64_tr_b16 a[82:83], v201 offset:4352
    ds_read_b64_tr_b16 a[84:85], v201 offset:5120
    ds_read_b64_tr_b16 a[86:87], v201 offset:5376
    ds_read_b64_tr_b16 a[88:89], v201 offset:6144
    ds_read_b64_tr_b16 a[90:91], v201 offset:6400
    ds_read_b64_tr_b16 a[92:93], v201 offset:7168
    ds_read_b64_tr_b16 a[94:95], v201 offset:7424
    s_waitcnt lgkmcnt(0)
    ds_read_b64_tr_b16 a[96:97], v201 offset:8192
    ds_read_b64_tr_b16 a[98:99], v201 offset:8448
    ds_read_b64_tr_b16 a[100:101], v201 offset:9216
    ds_read_b64_tr_b16 a[102:103], v201 offset:9472
    ds_read_b64_tr_b16 a[104:105], v201 offset:10240
    ds_read_b64_tr_b16 a[106:107], v201 offset:10496
    ds_read_b64_tr_b16 a[108:109], v201 offset:11264
    ds_read_b64_tr_b16 a[110:111], v201 offset:11520
    s_waitcnt lgkmcnt(0)
    ds_read_b64_tr_b16 a[112:113], v201 offset:12288
    ds_read_b64_tr_b16 a[114:115], v201 offset:12544
    ds_read_b64_tr_b16 a[116:117], v201 offset:13312
    ds_read_b64_tr_b16 a[118:119], v201 offset:13568
    ds_read_b64_tr_b16 a[120:121], v201 offset:14336
    ds_read_b64_tr_b16 a[122:123], v201 offset:14592
    ds_read_b64_tr_b16 a[124:125], v201 offset:15360
    ds_read_b64_tr_b16 a[126:127], v201 offset:15616
    s_waitcnt lgkmcnt(0)
    s_add_u32 m0, s56, 0
    s_add_u32 s58, s57, 32768
    s_and_b32 s58, s58, 0xffff
    s_lshl_b32 s58, s58, 5
    buffer_load_dwordx4 v200, s[52:55], s58 offen lds
    s_add_u32 m0, s56, 1024
    s_add_u32 s58, s57, 33792
    s_and_b32 s58, s58, 0xffff
    s_lshl_b32 s58, s58, 5
    buffer_load_dwordx4 v200, s[52:55], s58 offen lds
    s_add_u32 m0, s56, 2048
    s_add_u32 s58, s57, 34816
    s_and_b32 s58, s58, 0xffff
    s_lshl_b32 s58, s58, 5
    buffer_load_dwordx4 v200, s[52:55], s58 offen lds
    s_add_u32 m0, s56, 3072
    s_add_u32 s58, s57, 35840
    s_and_b32 s58, s58, 0xffff
    s_lshl_b32 s58, s58, 5
    buffer_load_dwordx4 v200, s[52:55], s58 offen lds
    s_add_u32 m0, s56, 4096
    s_add_u32 s58, s57, 36864
    s_and_b32 s58, s58, 0xffff
    s_lshl_b32 s58, s58, 5
    buffer_load_dwordx4 v200, s[52:55], s58 offen lds
    s_add_u32 m0, s56, 5120
    s_add_u32 s58, s57, 37888
    s_and_b32 s58, s58, 0xffff
    s_lshl_b32 s58, s58, 5
    buffer_load_dwordx4 v200, s[52:55], s58 offen lds
    s_add_u32 m0, s56, 6144
    s_add_u32 s58, s57, 38912
    s_and_b32 s58, s58, 0xffff
    s_lshl_b32 s58, s58, 5
    buffer_load_dwordx4 v200, s[52:55], s58 offen lds
    s_add_u32 m0, s56, 7168
    s_add_u32 s58, s57, 39936
    s_and_b32 s58, s58, 0xffff
    s_lshl_b32 s58, s58, 5
    buffer_load_dwordx4 v200, s[52:55], s58 offen lds
    s_add_u32 m0, s56, 8192
    s_add_u32 s58, s57, 40960
    s_and_b32 s58, s58, 0xffff
    s_lshl_b32 s58, s58, 5
    buffer_load_dwordx4 v200, s[52:55], s58 offen lds
    s_add_u32 m0, s56, 9216
    s_add_u32 s58, s57, 41984
    s_and_b32 s58, s58, 0xffff
    s_lshl_b32 s58, s58, 5
    buffer_load_dwordx4 v200, s[52:55], s58 offen lds
    s_add_u32 m0, s56, 10240
    s_add_u32 s58, s57, 43008
    s_and_b32 s58, s58, 0xffff
    s_lshl_b32 s58, s58, 5
    buffer_load_dwordx4 v200, s[52:55], s58 offen lds
    s_add_u32 m0, s56, 11264
    s_add_u32 s58, s57, 44032
    s_and_b32 s58, s58, 0xffff
    s_lshl_b32 s58, s58, 5
    buffer_load_dwordx4 v200, s[52:55], s58 offen lds
    s_add_u32 m0, s56, 12288
    s_add_u32 s58, s57, 45056
    s_and_b32 s58, s58, 0xffff
    s_lshl_b32 s58, s58, 5
    buffer_load_dwordx4 v200, s[52:55], s58 offen lds
    s_add_u32 m0, s56, 13312
    s_add_u32 s58, s57, 46080
    s_and_b32 s58, s58, 0xffff
    s_lshl_b32 s58, s58, 5
    buffer_load_dwordx4 v200, s[52:55], s58 offen lds
    s_add_u32 m0, s56, 14336
    s_add_u32 s58, s57, 47104
    s_and_b32 s58, s58, 0xffff
    s_lshl_b32 s58, s58, 5
    buffer_load_dwordx4 v200, s[52:55], s58 offen lds
    s_add_u32 m0, s56, 15360
    s_add_u32 s58, s57, 48128
    s_and_b32 s58, s58, 0xffff
    s_lshl_b32 s58, s58, 5
    buffer_load_dwordx4 v200, s[52:55], s58 offen lds
    s_nop 1
    v_mov_b32_dpp v70, v82 quad_perm:[1,0,3,2] row_mask:0xf bank_mask:0xf
    v_fma_f32 v82, v82, v9, v70
    v_mov_b32_dpp v70, v17 quad_perm:[1,0,3,2] row_mask:0xf bank_mask:0xf
    v_fma_f32 v17, v17, v9, v70
    v_mov_b32_dpp v70, v16 quad_perm:[1,0,3,2] row_mask:0xf bank_mask:0xf
    v_fma_f32 v16, v16, v9, v70
    v_mov_b32_dpp v70, v49 quad_perm:[1,0,3,2] row_mask:0xf bank_mask:0xf
    v_fma_f32 v49, v49, v9, v70
    v_mov_b32_dpp v70, v74 quad_perm:[1,0,3,2] row_mask:0xf bank_mask:0xf
    v_fma_f32 v74, v74, v9, v70
    v_mov_b32_dpp v70, v19 quad_perm:[1,0,3,2] row_mask:0xf bank_mask:0xf
    v_fma_f32 v19, v19, v9, v70
    v_mov_b32_dpp v70, v48 quad_perm:[1,0,3,2] row_mask:0xf bank_mask:0xf
    v_fma_f32 v48, v48, v9, v70
    v_mov_b32_dpp v70, v23 quad_perm:[1,0,3,2] row_mask:0xf bank_mask:0xf
    v_fma_f32 v23, v23, v9, v70
    v_mov_b32_dpp v70, v68 quad_perm:[1,0,3,2] row_mask:0xf bank_mask:0xf
    v_fma_f32 v68, v68, v9, v70
    v_mov_b32_dpp v70, v27 quad_perm:[1,0,3,2] row_mask:0xf bank_mask:0xf
    v_fma_f32 v27, v27, v9, v70
    v_mov_b32_dpp v70, v62 quad_perm:[1,0,3,2] row_mask:0xf bank_mask:0xf
    v_fma_f32 v62, v62, v9, v70
    v_mov_b32_dpp v70, v39 quad_perm:[1,0,3,2] row_mask:0xf bank_mask:0xf
    v_fma_f32 v39, v39, v9, v70
    v_mov_b32_dpp v70, v66 quad_perm:[1,0,3,2] row_mask:0xf bank_mask:0xf
    v_fma_f32 v66, v66, v9, v70
    v_mov_b32_dpp v70, v29 quad_perm:[1,0,3,2] row_mask:0xf bank_mask:0xf
    v_fma_f32 v29, v29, v9, v70
    v_mov_b32_dpp v70, v54 quad_perm:[1,0,3,2] row_mask:0xf bank_mask:0xf
    v_fma_f32 v54, v54, v9, v70
    v_mov_b32_dpp v70, v37 quad_perm:[1,0,3,2] row_mask:0xf bank_mask:0xf
    v_fma_f32 v37, v37, v9, v70
    v_mov_b32_dpp v70, v44 quad_perm:[1,0,3,2] row_mask:0xf bank_mask:0xf
    v_fma_f32 v44, v44, v9, v70
    v_mov_b32_dpp v70, v43 quad_perm:[1,0,3,2] row_mask:0xf bank_mask:0xf
    v_fma_f32 v43, v43, v9, v70
    v_mov_b32_dpp v70, v52 quad_perm:[1,0,3,2] row_mask:0xf bank_mask:0xf
    v_fma_f32 v52, v52, v9, v70
    v_mov_b32_dpp v70, v71 quad_perm:[1,0,3,2] row_mask:0xf bank_mask:0xf
    v_fma_f32 v71, v71, v9, v70
    v_mov_b32_dpp v70, v58 quad_perm:[1,0,3,2] row_mask:0xf bank_mask:0xf
    v_fma_f32 v58, v58, v9, v70
    v_mov_b32_dpp v70, v61 quad_perm:[1,0,3,2] row_mask:0xf bank_mask:0xf
    v_fma_f32 v61, v61, v9, v70
    v_mov_b32_dpp v70, v38 quad_perm:[1,0,3,2] row_mask:0xf bank_mask:0xf
    v_fma_f32 v38, v38, v9, v70
    v_mov_b32_dpp v70, v69 quad_perm:[1,0,3,2] row_mask:0xf bank_mask:0xf
    v_fma_f32 v69, v69, v9, v70
    v_mov_b32_dpp v70, v28 quad_perm:[1,0,3,2] row_mask:0xf bank_mask:0xf
    v_fma_f32 v28, v28, v9, v70
    v_mov_b32_dpp v70, v41 quad_perm:[1,0,3,2] row_mask:0xf bank_mask:0xf
    v_fma_f32 v41, v41, v9, v70
    v_mov_b32_dpp v70, v36 quad_perm:[1,0,3,2] row_mask:0xf bank_mask:0xf
    v_fma_f32 v36, v36, v9, v70
    v_mov_b32_dpp v70, v57 quad_perm:[1,0,3,2] row_mask:0xf bank_mask:0xf
    v_fma_f32 v57, v57, v9, v70
    v_mov_b32_dpp v70, v64 quad_perm:[1,0,3,2] row_mask:0xf bank_mask:0xf
    v_fma_f32 v64, v64, v9, v70
    v_mov_b32_dpp v70, v63 quad_perm:[1,0,3,2] row_mask:0xf bank_mask:0xf
    v_fma_f32 v63, v63, v9, v70
    v_mov_b32_dpp v70, v24 quad_perm:[1,0,3,2] row_mask:0xf bank_mask:0xf
    v_fma_f32 v24, v24, v9, v70
    v_mov_b32_dpp v70, v67 quad_perm:[1,0,3,2] row_mask:0xf bank_mask:0xf
    v_fma_f32 v67, v67, v9, v70
    v_mov_b32_dpp v70, v30 quad_perm:[1,0,3,2] row_mask:0xf bank_mask:0xf
    v_fma_f32 v30, v30, v9, v70
    v_mov_b32_dpp v70, v75 quad_perm:[1,0,3,2] row_mask:0xf bank_mask:0xf
    v_fma_f32 v75, v75, v9, v70
    v_mov_b32_dpp v70, v34 quad_perm:[1,0,3,2] row_mask:0xf bank_mask:0xf
    v_fma_f32 v34, v34, v9, v70
    v_mov_b32_dpp v70, v77 quad_perm:[1,0,3,2] row_mask:0xf bank_mask:0xf
    v_fma_f32 v77, v77, v9, v70
    v_mov_b32_dpp v70, v42 quad_perm:[1,0,3,2] row_mask:0xf bank_mask:0xf
    v_fma_f32 v42, v42, v9, v70
    v_mov_b32_dpp v70, v73 quad_perm:[1,0,3,2] row_mask:0xf bank_mask:0xf
    v_fma_f32 v73, v73, v9, v70
    v_mov_b32_dpp v70, v60 quad_perm:[1,0,3,2] row_mask:0xf bank_mask:0xf
    v_fma_f32 v60, v60, v9, v70
    v_mov_b32_dpp v70, v21 quad_perm:[1,0,3,2] row_mask:0xf bank_mask:0xf
    v_fma_f32 v21, v21, v9, v70
    v_mov_b32_dpp v70, v40 quad_perm:[1,0,3,2] row_mask:0xf bank_mask:0xf
    v_fma_f32 v40, v40, v9, v70
    v_mov_b32_dpp v70, v65 quad_perm:[1,0,3,2] row_mask:0xf bank_mask:0xf
    v_fma_f32 v65, v65, v9, v70
    v_mov_b32_dpp v70, v56 quad_perm:[1,0,3,2] row_mask:0xf bank_mask:0xf
    v_fma_f32 v56, v56, v9, v70
    v_mov_b32_dpp v70, v25 quad_perm:[1,0,3,2] row_mask:0xf bank_mask:0xf
    v_fma_f32 v25, v25, v9, v70
    v_mov_b32_dpp v70, v80 quad_perm:[1,0,3,2] row_mask:0xf bank_mask:0xf
    v_fma_f32 v80, v80, v9, v70
    v_mov_b32_dpp v70, v31 quad_perm:[1,0,3,2] row_mask:0xf bank_mask:0xf
    v_fma_f32 v31, v31, v9, v70
    v_mov_b32_dpp v70, v32 quad_perm:[1,0,3,2] row_mask:0xf bank_mask:0xf
    v_fma_f32 v32, v32, v9, v70
    v_mov_b32_dpp v70, v35 quad_perm:[1,0,3,2] row_mask:0xf bank_mask:0xf
    v_fma_f32 v35, v35, v9, v70
    v_mov_b32_dpp v70, v46 quad_perm:[1,0,3,2] row_mask:0xf bank_mask:0xf
    v_fma_f32 v46, v46, v9, v70
    v_mov_b32_dpp v70, v81 quad_perm:[1,0,3,2] row_mask:0xf bank_mask:0xf
    v_fma_f32 v81, v81, v9, v70
    v_mov_b32_dpp v70, v50 quad_perm:[1,0,3,2] row_mask:0xf bank_mask:0xf
    v_fma_f32 v50, v50, v9, v70
    v_mov_b32_dpp v70, v33 quad_perm:[1,0,3,2] row_mask:0xf bank_mask:0xf
    v_fma_f32 v33, v33, v9, v70
    v_mov_b32_dpp v70, v83 quad_perm:[1,0,3,2] row_mask:0xf bank_mask:0xf
    v_fma_f32 v83, v83, v9, v70
    v_mov_b32_dpp v70, v47 quad_perm:[1,0,3,2] row_mask:0xf bank_mask:0xf
    v_fma_f32 v47, v47, v9, v70
    v_mov_b32_dpp v70, v78 quad_perm:[1,0,3,2] row_mask:0xf bank_mask:0xf
    v_fma_f32 v78, v78, v9, v70
    v_mov_b32_dpp v70, v51 quad_perm:[1,0,3,2] row_mask:0xf bank_mask:0xf
    v_fma_f32 v51, v51, v9, v70
    v_mov_b32_dpp v70, v76 quad_perm:[1,0,3,2] row_mask:0xf bank_mask:0xf
    v_fma_f32 v76, v76, v9, v70
    v_mov_b32_dpp v70, v45 quad_perm:[1,0,3,2] row_mask:0xf bank_mask:0xf
    v_fma_f32 v45, v45, v9, v70
    v_mov_b32_dpp v70, v18 quad_perm:[1,0,3,2] row_mask:0xf bank_mask:0xf
    v_fma_f32 v18, v18, v9, v70
    v_mov_b32_dpp v70, v53 quad_perm:[1,0,3,2] row_mask:0xf bank_mask:0xf
    v_fma_f32 v53, v53, v9, v70
    v_mov_b32_dpp v70, v72 quad_perm:[1,0,3,2] row_mask:0xf bank_mask:0xf
    v_fma_f32 v72, v72, v9, v70
    v_mov_b32_dpp v70, v55 quad_perm:[1,0,3,2] row_mask:0xf bank_mask:0xf
    v_fma_f32 v55, v55, v9, v70
    v_mov_b32_dpp v70, v20 quad_perm:[1,0,3,2] row_mask:0xf bank_mask:0xf
    v_fma_f32 v20, v20, v9, v70
    v_mov_b32_dpp v70, v59 quad_perm:[1,0,3,2] row_mask:0xf bank_mask:0xf
    v_fma_f32 v59, v59, v9, v70
    v_mul_f32 v70, 0x3c800000, v10
    v_cos_f32 v79, v70
    v_sin_f32 v22, v70
    s_nop 0
    v_mul_f32 v26, v16, v79
    v_fma_f32 v26, -v49, v22, v26
    v_mul_f32 v49, v49, v79
    v_fmac_f32 v49, v16, v22
    v_mul_f32 v70, 0x3d000000, v10
    v_cos_f32 v79, v70
    v_sin_f32 v22, v70
    s_nop 0
    v_mul_f32 v16, v74, v79
    v_fma_f32 v16, -v19, v22, v16
    v_mul_f32 v19, v19, v79
    v_fmac_f32 v19, v74, v22
    v_mul_f32 v70, 0x3d400000, v10
    v_cos_f32 v79, v70
    v_sin_f32 v22, v70
    s_nop 0
    v_mul_f32 v74, v48, v79
    v_fma_f32 v74, -v23, v22, v74
    v_mul_f32 v23, v23, v79
    v_fmac_f32 v23, v48, v22
    v_mul_f32 v70, 0x3d800000, v10
    v_cos_f32 v79, v70
    v_sin_f32 v22, v70
    s_nop 0
    v_mul_f32 v48, v68, v79
    v_fma_f32 v48, -v27, v22, v48
    v_mul_f32 v27, v27, v79
    v_fmac_f32 v27, v68, v22
    v_mul_f32 v70, 0x3da00000, v10
    v_cos_f32 v79, v70
    v_sin_f32 v22, v70
    s_nop 0
    v_mul_f32 v68, v62, v79
    v_fma_f32 v68, -v39, v22, v68
    v_mul_f32 v39, v39, v79
    v_fmac_f32 v39, v62, v22
    v_mul_f32 v70, 0x3dc00000, v10
    v_cos_f32 v79, v70
    v_sin_f32 v22, v70
    s_nop 0
    v_mul_f32 v62, v66, v79
    v_fma_f32 v62, -v29, v22, v62
    v_mul_f32 v29, v29, v79
    v_fmac_f32 v29, v66, v22
    v_mul_f32 v70, 0x3de00000, v10
    v_cos_f32 v79, v70
    v_sin_f32 v22, v70
    s_nop 0
    v_mul_f32 v66, v54, v79
    v_fma_f32 v66, -v37, v22, v66
    v_mul_f32 v37, v37, v79
    v_fmac_f32 v37, v54, v22
    v_mul_f32 v70, 0x3e000000, v10
    v_cos_f32 v79, v70
    v_sin_f32 v22, v70
    s_nop 0
    v_mul_f32 v54, v44, v79
    v_fma_f32 v54, -v43, v22, v54
    v_mul_f32 v43, v43, v79
    v_fmac_f32 v43, v44, v22
    v_mul_f32 v70, 0x3e100000, v10
    v_cos_f32 v79, v70
    v_sin_f32 v22, v70
    s_nop 0
    v_mul_f32 v44, v52, v79
    v_fma_f32 v44, -v71, v22, v44
    v_mul_f32 v71, v71, v79
    v_fmac_f32 v71, v52, v22
    v_mul_f32 v70, 0x3e200000, v10
    v_cos_f32 v79, v70
    v_sin_f32 v22, v70
    s_nop 0
    v_mul_f32 v52, v58, v79
    v_fma_f32 v52, -v61, v22, v52
    v_mul_f32 v61, v61, v79
    v_fmac_f32 v61, v58, v22
    v_mul_f32 v70, 0x3e300000, v10
    v_cos_f32 v79, v70
    v_sin_f32 v22, v70
    s_nop 0
    v_mul_f32 v58, v38, v79
    v_fma_f32 v58, -v69, v22, v58
    v_mul_f32 v69, v69, v79
    v_fmac_f32 v69, v38, v22
    v_mul_f32 v70, 0x3e400000, v10
    v_cos_f32 v79, v70
    v_sin_f32 v22, v70
    s_nop 0
    v_mul_f32 v38, v28, v79
    v_fma_f32 v38, -v41, v22, v38
    v_mul_f32 v41, v41, v79
    v_fmac_f32 v41, v28, v22
    v_mul_f32 v70, 0x3e500000, v10
    v_cos_f32 v79, v70
    v_sin_f32 v22, v70
    s_nop 0
    v_mul_f32 v28, v36, v79
    v_fma_f32 v28, -v57, v22, v28
    v_mul_f32 v57, v57, v79
    v_fmac_f32 v57, v36, v22
    v_mul_f32 v70, 0x3e600000, v10
    v_cos_f32 v79, v70
    v_sin_f32 v22, v70
    s_nop 0
    v_mul_f32 v36, v64, v79
    v_fma_f32 v36, -v63, v22, v36
    v_mul_f32 v63, v63, v79
    v_fmac_f32 v63, v64, v22
    v_mul_f32 v70, 0x3e700000, v10
    v_cos_f32 v79, v70
    v_sin_f32 v22, v70
    s_nop 0
    v_mul_f32 v64, v24, v79
    v_fma_f32 v64, -v67, v22, v64
    v_mul_f32 v67, v67, v79
    v_fmac_f32 v67, v24, v22
    v_mul_f32 v70, 0x3e800000, v10
    v_cos_f32 v79, v70
    v_sin_f32 v22, v70
    s_nop 0
    v_mul_f32 v24, v30, v79
    v_fma_f32 v24, -v75, v22, v24
    v_mul_f32 v75, v75, v79
    v_fmac_f32 v75, v30, v22
    v_mul_f32 v70, 0x3e880000, v10
    v_cos_f32 v79, v70
    v_sin_f32 v22, v70
    s_nop 0
    v_mul_f32 v30, v34, v79
    v_fma_f32 v30, -v77, v22, v30
    v_mul_f32 v77, v77, v79
    v_fmac_f32 v77, v34, v22
    v_mul_f32 v70, 0x3e900000, v10
    v_cos_f32 v79, v70
    v_sin_f32 v22, v70
    s_nop 0
    v_mul_f32 v34, v42, v79
    v_fma_f32 v34, -v73, v22, v34
    v_mul_f32 v73, v73, v79
    v_fmac_f32 v73, v42, v22
    v_mul_f32 v70, 0x3e980000, v10
    v_cos_f32 v79, v70
    v_sin_f32 v22, v70
    s_nop 0
    v_mul_f32 v42, v60, v79
    v_fma_f32 v42, -v21, v22, v42
    v_mul_f32 v21, v21, v79
    v_fmac_f32 v21, v60, v22
    v_mul_f32 v70, 0x3ea00000, v10
    v_cos_f32 v79, v70
    v_sin_f32 v22, v70
    s_nop 0
    v_mul_f32 v60, v40, v79
    v_fma_f32 v60, -v65, v22, v60
    v_mul_f32 v65, v65, v79
    v_fmac_f32 v65, v40, v22
    v_mul_f32 v70, 0x3ea80000, v10
    v_cos_f32 v79, v70
    v_sin_f32 v22, v70
    s_nop 0
    v_mul_f32 v40, v56, v79
    v_fma_f32 v40, -v25, v22, v40
    v_mul_f32 v25, v25, v79
    v_fmac_f32 v25, v56, v22
    v_mul_f32 v70, 0x3eb00000, v10
    v_cos_f32 v79, v70
    v_sin_f32 v22, v70
    s_nop 0
    v_mul_f32 v56, v80, v79
    v_fma_f32 v56, -v31, v22, v56
    v_mul_f32 v31, v31, v79
    v_fmac_f32 v31, v80, v22
    v_mul_f32 v70, 0x3eb80000, v10
    v_cos_f32 v79, v70
    v_sin_f32 v22, v70
    s_nop 0
    v_mul_f32 v80, v32, v79
    v_fma_f32 v80, -v35, v22, v80
    v_mul_f32 v35, v35, v79
    v_fmac_f32 v35, v32, v22
    v_mul_f32 v70, 0x3ec00000, v10
    v_cos_f32 v79, v70
    v_sin_f32 v22, v70
    s_nop 0
    v_mul_f32 v32, v46, v79
    v_fma_f32 v32, -v81, v22, v32
    v_mul_f32 v81, v81, v79
    v_fmac_f32 v81, v46, v22
    v_mul_f32 v70, 0x3ec80000, v10
    v_cos_f32 v79, v70
    v_sin_f32 v22, v70
    s_nop 0
    v_mul_f32 v46, v50, v79
    v_fma_f32 v46, -v33, v22, v46
    v_mul_f32 v33, v33, v79
    v_fmac_f32 v33, v50, v22
    v_mul_f32 v70, 0x3ed00000, v10
    v_cos_f32 v79, v70
    v_sin_f32 v22, v70
    s_nop 0
    v_mul_f32 v50, v83, v79
    v_fma_f32 v50, -v47, v22, v50
    v_mul_f32 v47, v47, v79
    v_fmac_f32 v47, v83, v22
    v_mul_f32 v70, 0x3ed80000, v10
    v_cos_f32 v79, v70
    v_sin_f32 v22, v70
    s_nop 0
    v_mul_f32 v83, v78, v79
    v_fma_f32 v83, -v51, v22, v83
    v_mul_f32 v51, v51, v79
    v_fmac_f32 v51, v78, v22
    v_mul_f32 v70, 0x3ee00000, v10
    v_cos_f32 v79, v70
    v_sin_f32 v22, v70
    s_nop 0
    v_mul_f32 v78, v76, v79
    v_fma_f32 v78, -v45, v22, v78
    v_mul_f32 v45, v45, v79
    v_fmac_f32 v45, v76, v22
    v_mul_f32 v70, 0x3ee80000, v10
    v_cos_f32 v79, v70
    v_sin_f32 v22, v70
    s_nop 0
    v_mul_f32 v76, v18, v79
    v_fma_f32 v76, -v53, v22, v76
    v_mul_f32 v53, v53, v79
    v_fmac_f32 v53, v18, v22
    v_mul_f32 v70, 0x3ef00000, v10
    v_cos_f32 v79, v70
    v_sin_f32 v22, v70
    s_nop 0
    v_mul_f32 v18, v72, v79
    v_fma_f32 v18, -v55, v22, v18
    v_mul_f32 v55, v55, v79
    v_fmac_f32 v55, v72, v22
    v_mul_f32 v70, 0x3ef80000, v10
    v_cos_f32 v79, v70
    v_sin_f32 v22, v70
    s_nop 0
    v_mul_f32 v72, v20, v79
    v_fma_f32 v72, -v59, v22, v72
    v_mul_f32 v59, v59, v79
    v_fmac_f32 v59, v20, v22
    v_sub_f32 v70, v82, v24
    v_sub_f32 v79, v17, v75
    v_add_f32 v82, v82, v24
    v_add_f32 v17, v17, v75
    v_sub_f32 v24, v26, v30
    v_sub_f32 v75, v49, v77
    v_add_f32 v26, v26, v30
    v_add_f32 v49, v49, v77
    v_mul_f32 v30, 0x3f7b14be, v24
    v_mul_f32 v77, 0x3e47c5c2, v24
    v_fmac_f32 v30, 0xbe47c5c2, v75
    v_fmac_f32 v77, 0x3f7b14be, v75
    v_sub_f32 v24, v16, v34
    v_sub_f32 v75, v19, v73
    v_add_f32 v16, v16, v34
    v_add_f32 v19, v19, v73
    v_mul_f32 v34, 0x3f6c835e, v24
    v_mul_f32 v73, 0x3ec3ef15, v24
    v_fmac_f32 v34, 0xbec3ef15, v75
    v_fmac_f32 v73, 0x3f6c835e, v75
    v_sub_f32 v24, v74, v42
    v_sub_f32 v75, v23, v21
    v_add_f32 v74, v74, v42
    v_add_f32 v23, v23, v21
    v_mul_f32 v42, 0x3f54db31, v24
    v_mul_f32 v21, 0x3f0e39da, v24
    v_fmac_f32 v42, 0xbf0e39da, v75
    v_fmac_f32 v21, 0x3f54db31, v75
    v_sub_f32 v24, v48, v60
    v_sub_f32 v75, v27, v65
    v_add_f32 v48, v48, v60
    v_add_f32 v27, v27, v65
    v_mul_f32 v60, 0x3f3504f3, v24
    v_mul_f32 v65, 0x3f3504f3, v24
    v_fmac_f32 v60, 0xbf3504f3, v75
    v_fmac_f32 v65, 0x3f3504f3, v75
    v_sub_f32 v24, v68, v40
    v_sub_f32 v75, v39, v25
    v_add_f32 v68, v68, v40
    v_add_f32 v39, v39, v25
    v_mul_f32 v40, 0x3f0e39da, v24
    v_mul_f32 v25, 0x3f54db31, v24
    v_fmac_f32 v40, 0xbf54db31, v75
    v_fmac_f32 v25, 0x3f0e39da, v75
    v_sub_f32 v24, v62, v56
    v_sub_f32 v75, v29, v31
    v_add_f32 v62, v62, v56
    v_add_f32 v29, v29, v31
    v_mul_f32 v56, 0x3ec3ef15, v24
    v_mul_f32 v31, 0x3f6c835e, v24
    v_fmac_f32 v56, 0xbf6c835e, v75
    v_fmac_f32 v31, 0x3ec3ef15, v75
    v_sub_f32 v24, v66, v80
    v_sub_f32 v75, v37, v35
    v_add_f32 v66, v66, v80
    v_add_f32 v37, v37, v35
    v_mul_f32 v80, 0x3e47c5c2, v24
    v_mul_f32 v35, 0x3f7b14be, v24
    v_fmac_f32 v80, 0xbf7b14be, v75
    v_fmac_f32 v35, 0x3e47c5c2, v75
    v_sub_f32 v24, v81, v43
    v_sub_f32 v75, v54, v32
    v_add_f32 v54, v54, v32
    v_add_f32 v43, v43, v81
    v_sub_f32 v32, v44, v46
    v_sub_f32 v81, v71, v33
    v_add_f32 v44, v44, v46
    v_add_f32 v71, v71, v33
    v_mul_f32 v46, 0xbe47c5c2, v32
    v_mul_f32 v33, 0x3f7b14be, v32
    v_fmac_f32 v46, 0xbf7b14be, v81
    v_fmac_f32 v33, 0xbe47c5c2, v81
    v_sub_f32 v32, v52, v50
    v_sub_f32 v81, v61, v47
    v_add_f32 v52, v52, v50
    v_add_f32 v61, v61, v47
    v_mul_f32 v50, 0xbec3ef15, v32
    v_mul_f32 v47, 0x3f6c835e, v32
    v_fmac_f32 v50, 0xbf6c835e, v81
    v_fmac_f32 v47, 0xbec3ef15, v81
    v_sub_f32 v32, v58, v83
    v_sub_f32 v81, v69, v51
    v_add_f32 v58, v58, v83
    v_add_f32 v69, v69, v51
    v_mul_f32 v83, 0xbf0e39da, v32
    v_mul_f32 v51, 0x3f54db31, v32
    v_fmac_f32 v83, 0xbf54db31, v81
    v_fmac_f32 v51, 0xbf0e39da, v81
    v_sub_f32 v32, v38, v78
    v_sub_f32 v81, v41, v45
    v_add_f32 v38, v38, v78
    v_add_f32 v41, v41, v45
    v_mul_f32 v78, 0xbf3504f3, v32
    v_mul_f32 v45, 0x3f3504f3, v32
    v_fmac_f32 v78, 0xbf3504f3, v81
    v_fmac_f32 v45, 0xbf3504f3, v81
    v_sub_f32 v32, v28, v76
    v_sub_f32 v81, v57, v53
    v_add_f32 v28, v28, v76
    v_add_f32 v57, v57, v53
    v_mul_f32 v76, 0xbf54db31, v32
    v_mul_f32 v53, 0x3f0e39da, v32
    v_fmac_f32 v76, 0xbf0e39da, v81
    v_fmac_f32 v53, 0xbf54db31, v81
    v_sub_f32 v32, v36, v18
    v_sub_f32 v81, v63, v55
    v_add_f32 v36, v36, v18
    v_add_f32 v63, v63, v55
    v_mul_f32 v18, 0xbf6c835e, v32
    v_mul_f32 v55, 0x3ec3ef15, v32
    v_fmac_f32 v18, 0xbec3ef15, v81
    v_fmac_f32 v55, 0xbf6c835e, v81
    v_sub_f32 v32, v64, v72
    v_sub_f32 v81, v67, v59
    v_add_f32 v64, v64, v72
    v_add_f32 v67, v67, v59
    v_mul_f32 v72, 0xbf7b14be, v32
    v_mul_f32 v59, 0x3e47c5c2, v32
    v_fmac_f32 v72, 0xbe47c5c2, v81
    v_fmac_f32 v59, 0xbf7b14be, v81
    v_sub_f32 v32, v82, v54
    v_sub_f32 v81, v17, v43
    v_add_f32 v82, v82, v54
    v_add_f32 v17, v17, v43
    v_sub_f32 v54, v26, v44
    v_sub_f32 v43, v49, v71
    v_add_f32 v26, v26, v44
    v_add_f32 v49, v49, v71
    v_mul_f32 v44, 0x3f6c835e, v54
    v_mul_f32 v71, 0x3ec3ef15, v54
    v_fmac_f32 v44, 0xbec3ef15, v43
    v_fmac_f32 v71, 0x3f6c835e, v43
    v_sub_f32 v54, v16, v52
    v_sub_f32 v43, v19, v61
    v_add_f32 v16, v16, v52
    v_add_f32 v19, v19, v61
    v_mul_f32 v52, 0x3f3504f3, v54
    v_mul_f32 v61, 0x3f3504f3, v54
    v_fmac_f32 v52, 0xbf3504f3, v43
    v_fmac_f32 v61, 0x3f3504f3, v43
    v_sub_f32 v54, v74, v58
    v_sub_f32 v43, v23, v69
    v_add_f32 v74, v74, v58
    v_add_f32 v23, v23, v69
    v_mul_f32 v58, 0x3ec3ef15, v54
    v_mul_f32 v69, 0x3f6c835e, v54
    v_fmac_f32 v58, 0xbf6c835e, v43
    v_fmac_f32 v69, 0x3ec3ef15, v43
    v_sub_f32 v54, v41, v27
    v_sub_f32 v43, v48, v38
    v_add_f32 v48, v48, v38
    v_add_f32 v27, v27, v41
    v_sub_f32 v38, v68, v28
    v_sub_f32 v41, v39, v57
    v_add_f32 v68, v68, v28
    v_add_f32 v39, v39, v57
    v_mul_f32 v28, 0xbec3ef15, v38
    v_mul_f32 v57, 0x3f6c835e, v38
    v_fmac_f32 v28, 0xbf6c835e, v41
    v_fmac_f32 v57, 0xbec3ef15, v41
    v_sub_f32 v38, v62, v36
    v_sub_f32 v41, v29, v63
    v_add_f32 v62, v62, v36
    v_add_f32 v29, v29, v63
    v_mul_f32 v36, 0xbf3504f3, v38
    v_mul_f32 v63, 0x3f3504f3, v38
    v_fmac_f32 v36, 0xbf3504f3, v41
    v_fmac_f32 v63, 0xbf3504f3, v41
    v_sub_f32 v38, v66, v64
    v_sub_f32 v41, v37, v67
    v_add_f32 v66, v66, v64
    v_add_f32 v37, v37, v67
    v_mul_f32 v64, 0xbf6c835e, v38
    v_mul_f32 v67, 0x3ec3ef15, v38
    v_fmac_f32 v64, 0xbec3ef15, v41
    v_fmac_f32 v67, 0xbf6c835e, v41
    v_sub_f32 v38, v70, v24
    v_sub_f32 v41, v79, v75
    v_add_f32 v70, v70, v24
    v_add_f32 v79, v79, v75
    v_sub_f32 v24, v30, v46
    v_sub_f32 v75, v77, v33
    v_add_f32 v30, v30, v46
    v_add_f32 v77, v77, v33
    v_mul_f32 v46, 0x3f6c835e, v24
    v_mul_f32 v33, 0x3ec3ef15, v24
    v_fmac_f32 v46, 0xbec3ef15, v75
    v_fmac_f32 v33, 0x3f6c835e, v75
    v_sub_f32 v24, v34, v50
    v_sub_f32 v75, v73, v47
    v_add_f32 v34, v34, v50
    v_add_f32 v73, v73, v47
    v_mul_f32 v50, 0x3f3504f3, v24
    v_mul_f32 v47, 0x3f3504f3, v24
    v_fmac_f32 v50, 0xbf3504f3, v75
    v_fmac_f32 v47, 0x3f3504f3, v75
    v_sub_f32 v24, v42, v83
    v_sub_f32 v75, v21, v51
    v_add_f32 v42, v42, v83
    v_add_f32 v21, v21, v51
    v_mul_f32 v83, 0x3ec3ef15, v24
    v_mul_f32 v51, 0x3f6c835e, v24
    v_fmac_f32 v83, 0xbf6c835e, v75
    v_fmac_f32 v51, 0x3ec3ef15, v75
    v_sub_f32 v24, v45, v65
    v_sub_f32 v75, v60, v78
    v_add_f32 v60, v60, v78
    v_add_f32 v65, v65, v45
    v_sub_f32 v78, v40, v76
    v_sub_f32 v45, v25, v53
    v_add_f32 v40, v40, v76
    v_add_f32 v25, v25, v53
    v_mul_f32 v76, 0xbec3ef15, v78
    v_mul_f32 v53, 0x3f6c835e, v78
    v_fmac_f32 v76, 0xbf6c835e, v45
    v_fmac_f32 v53, 0xbec3ef15, v45
    v_sub_f32 v78, v56, v18
    v_sub_f32 v45, v31, v55
    v_add_f32 v56, v56, v18
    v_add_f32 v31, v31, v55
    v_mul_f32 v18, 0xbf3504f3, v78
    v_mul_f32 v55, 0x3f3504f3, v78
    v_fmac_f32 v18, 0xbf3504f3, v45
    v_fmac_f32 v55, 0xbf3504f3, v45
    v_sub_f32 v78, v80, v72
    v_sub_f32 v45, v35, v59
    v_add_f32 v80, v80, v72
    v_add_f32 v35, v35, v59
    v_mul_f32 v72, 0xbf6c835e, v78
    v_mul_f32 v59, 0x3ec3ef15, v78
    v_fmac_f32 v72, 0xbec3ef15, v45
    v_fmac_f32 v59, 0xbf6c835e, v45
    v_sub_f32 v78, v82, v48
    v_sub_f32 v45, v17, v27
    v_add_f32 v82, v82, v48
    v_add_f32 v17, v17, v27
    v_sub_f32 v48, v26, v68
    v_sub_f32 v27, v49, v39
    v_add_f32 v26, v26, v68
    v_add_f32 v49, v49, v39
    v_mul_f32 v68, 0x3f3504f3, v48
    v_mul_f32 v39, 0x3f3504f3, v48
    v_fmac_f32 v68, 0xbf3504f3, v27
    v_fmac_f32 v39, 0x3f3504f3, v27
    v_sub_f32 v48, v29, v19
    v_sub_f32 v27, v16, v62
    v_add_f32 v16, v16, v62
    v_add_f32 v19, v19, v29
    v_sub_f32 v62, v74, v66
    v_sub_f32 v29, v23, v37
    v_add_f32 v74, v74, v66
    v_add_f32 v23, v23, v37
    v_mul_f32 v66, 0xbf3504f3, v62
    v_mul_f32 v37, 0x3f3504f3, v62
    v_fmac_f32 v66, 0xbf3504f3, v29
    v_fmac_f32 v37, 0xbf3504f3, v29
    v_sub_f32 v62, v32, v54
    v_sub_f32 v29, v81, v43
    v_add_f32 v32, v32, v54
    v_add_f32 v81, v81, v43
    v_sub_f32 v54, v44, v28
    v_sub_f32 v43, v71, v57
    v_add_f32 v44, v44, v28
    v_add_f32 v71, v71, v57
    v_mul_f32 v28, 0x3f3504f3, v54
    v_mul_f32 v57, 0x3f3504f3, v54
    v_fmac_f32 v28, 0xbf3504f3, v43
    v_fmac_f32 v57, 0x3f3504f3, v43
    v_sub_f32 v54, v63, v61
    v_sub_f32 v43, v52, v36
    v_add_f32 v52, v52, v36
    v_add_f32 v61, v61, v63
    v_sub_f32 v36, v58, v64
    v_sub_f32 v63, v69, v67
    v_add_f32 v58, v58, v64
    v_add_f32 v69, v69, v67
    v_mul_f32 v64, 0xbf3504f3, v36
    v_mul_f32 v67, 0x3f3504f3, v36
    v_fmac_f32 v64, 0xbf3504f3, v63
    v_fmac_f32 v67, 0xbf3504f3, v63
    v_sub_f32 v36, v70, v60
    v_sub_f32 v63, v79, v65
    v_add_f32 v70, v70, v60
    v_add_f32 v79, v79, v65
    v_sub_f32 v60, v30, v40
    v_sub_f32 v65, v77, v25
    v_add_f32 v30, v30, v40
    v_add_f32 v77, v77, v25
    v_mul_f32 v40, 0x3f3504f3, v60
    v_mul_f32 v25, 0x3f3504f3, v60
    v_fmac_f32 v40, 0xbf3504f3, v65
    v_fmac_f32 v25, 0x3f3504f3, v65
    v_sub_f32 v60, v31, v73
    v_sub_f32 v65, v34, v56
    v_add_f32 v34, v34, v56
    v_add_f32 v73, v73, v31
    v_sub_f32 v56, v42, v80
    v_sub_f32 v31, v21, v35
    v_add_f32 v42, v42, v80
    v_add_f32 v21, v21, v35
    v_mul_f32 v80, 0xbf3504f3, v56
    v_mul_f32 v35, 0x3f3504f3, v56
    v_fmac_f32 v80, 0xbf3504f3, v31
    v_fmac_f32 v35, 0xbf3504f3, v31
    v_sub_f32 v56, v38, v24
    v_sub_f32 v31, v41, v75
    v_add_f32 v38, v38, v24
    v_add_f32 v41, v41, v75
    v_sub_f32 v24, v46, v76
    v_sub_f32 v75, v33, v53
    v_add_f32 v46, v46, v76
    v_add_f32 v33, v33, v53
    v_mul_f32 v76, 0x3f3504f3, v24
    v_mul_f32 v53, 0x3f3504f3, v24
    v_fmac_f32 v76, 0xbf3504f3, v75
    v_fmac_f32 v53, 0x3f3504f3, v75
    v_sub_f32 v24, v55, v47
    v_sub_f32 v75, v50, v18
    v_add_f32 v50, v50, v18
    v_add_f32 v47, v47, v55
    v_sub_f32 v18, v83, v72
    v_sub_f32 v55, v51, v59
    v_add_f32 v83, v83, v72
    v_add_f32 v51, v51, v59
    v_mul_f32 v72, 0xbf3504f3, v18
    v_mul_f32 v59, 0x3f3504f3, v18
    v_fmac_f32 v72, 0xbf3504f3, v55
    v_fmac_f32 v59, 0xbf3504f3, v55
    v_sub_f32 v18, v82, v16
    v_sub_f32 v55, v17, v19
    v_add_f32 v82, v82, v16
    v_add_f32 v17, v17, v19
    v_sub_f32 v16, v23, v49
    v_sub_f32 v19, v26, v74
    v_add_f32 v26, v26, v74
    v_add_f32 v49, v49, v23
    v_sub_f32 v74, v78, v48
    v_sub_f32 v23, v45, v27
    v_add_f32 v78, v78, v48
    v_add_f32 v45, v45, v27
    v_sub_f32 v48, v37, v39
    v_sub_f32 v27, v68, v66
    v_add_f32 v68, v68, v66
    v_add_f32 v39, v39, v37
    v_sub_f32 v66, v32, v52
    v_sub_f32 v37, v81, v61
    v_add_f32 v32, v32, v52
    v_add_f32 v81, v81, v61
    v_sub_f32 v52, v69, v71
    v_sub_f32 v61, v44, v58
    v_add_f32 v44, v44, v58
    v_add_f32 v71, v71, v69
    v_sub_f32 v58, v62, v54
    v_sub_f32 v69, v29, v43
    v_add_f32 v62, v62, v54
    v_add_f32 v29, v29, v43
    v_sub_f32 v54, v67, v57
    v_sub_f32 v43, v28, v64
    v_add_f32 v28, v28, v64
    v_add_f32 v57, v57, v67
    v_sub_f32 v64, v70, v34
    v_sub_f32 v67, v79, v73
    v_add_f32 v70, v70, v34
    v_add_f32 v79, v79, v73
    v_sub_f32 v34, v21, v77
    v_sub_f32 v73, v30, v42
    v_add_f32 v30, v30, v42
    v_add_f32 v77, v77, v21
    v_sub_f32 v42, v36, v60
    v_sub_f32 v21, v63, v65
    v_add_f32 v36, v36, v60
    v_add_f32 v63, v63, v65
    v_sub_f32 v60, v35, v25
    v_sub_f32 v65, v40, v80
    v_add_f32 v40, v40, v80
    v_add_f32 v25, v25, v35
    v_sub_f32 v80, v38, v50
    v_sub_f32 v35, v41, v47
    v_add_f32 v38, v38, v50
    v_add_f32 v41, v41, v47
    v_sub_f32 v50, v51, v33
    v_sub_f32 v47, v46, v83
    v_add_f32 v46, v46, v83
    v_add_f32 v33, v33, v51
    v_sub_f32 v83, v56, v24
    v_sub_f32 v51, v31, v75
    v_add_f32 v56, v56, v24
    v_add_f32 v31, v31, v75
    v_sub_f32 v24, v59, v53
    v_sub_f32 v75, v76, v72
    v_add_f32 v76, v76, v72
    v_add_f32 v53, v53, v59
    v_sub_f32 v72, v82, v26
    v_sub_f32 v59, v17, v49
    v_add_f32 v82, v82, v26
    v_add_f32 v17, v17, v49
    v_sub_f32 v26, v18, v16
    v_sub_f32 v49, v55, v19
    v_add_f32 v18, v18, v16
    v_add_f32 v55, v55, v19
    v_sub_f32 v16, v78, v68
    v_sub_f32 v19, v45, v39
    v_add_f32 v78, v78, v68
    v_add_f32 v45, v45, v39
    v_sub_f32 v68, v74, v48
    v_sub_f32 v39, v23, v27
    v_add_f32 v74, v74, v48
    v_add_f32 v23, v23, v27
    v_sub_f32 v48, v32, v44
    v_sub_f32 v27, v81, v71
    v_add_f32 v32, v32, v44
    v_add_f32 v81, v81, v71
    v_sub_f32 v44, v66, v52
    v_sub_f32 v71, v37, v61
    v_add_f32 v66, v66, v52
    v_add_f32 v37, v37, v61
    v_sub_f32 v52, v62, v28
    v_sub_f32 v61, v29, v57
    v_add_f32 v62, v62, v28
    v_add_f32 v29, v29, v57
    v_sub_f32 v28, v58, v54
    v_sub_f32 v57, v69, v43
    v_add_f32 v58, v58, v54
    v_add_f32 v69, v69, v43
    v_sub_f32 v54, v70, v30
    v_sub_f32 v43, v79, v77
    v_add_f32 v70, v70, v30
    v_add_f32 v79, v79, v77
    v_sub_f32 v30, v64, v34
    v_sub_f32 v77, v67, v73
    v_add_f32 v64, v64, v34
    v_add_f32 v67, v67, v73
    v_sub_f32 v34, v36, v40
    v_sub_f32 v73, v63, v25
    v_add_f32 v36, v36, v40
    v_add_f32 v63, v63, v25
    v_sub_f32 v40, v42, v60
    v_sub_f32 v25, v21, v65
    v_add_f32 v42, v42, v60
    v_add_f32 v21, v21, v65
    v_sub_f32 v60, v38, v46
    v_sub_f32 v65, v41, v33
    v_add_f32 v38, v38, v46
    v_add_f32 v41, v41, v33
    v_sub_f32 v46, v80, v50
    v_sub_f32 v33, v35, v47
    v_add_f32 v80, v80, v50
    v_add_f32 v35, v35, v47
    v_sub_f32 v50, v56, v76
    v_sub_f32 v47, v31, v53
    v_add_f32 v56, v56, v76
    v_add_f32 v31, v31, v53
    v_sub_f32 v76, v83, v24
    v_sub_f32 v53, v51, v75
    v_add_f32 v83, v83, v24
    v_add_f32 v51, v51, v75
    v_mul_f32 v12, v10, v8
    v_mul_f32 v12, 0x3a000000, v12
    v_mov_b32 v24, v12
    v_fmac_f32 v24, 0x00000000, v8
    v_cos_f32 v75, v24
    v_sin_f32 v22, v24
    s_nop 0
    v_mul_f32 v20, v82, v75
    v_fma_f32 v20, -v17, v22, v20
    v_mul_f32 v17, v17, v75
    v_fmac_f32 v17, v82, v22
    v_mov_b32 v24, v12
    v_fmac_f32 v24, 0x3a800000, v8
    v_cos_f32 v75, v24
    v_sin_f32 v22, v24
    s_nop 0
    v_mul_f32 v82, v70, v75
    v_fma_f32 v82, -v79, v22, v82
    v_mul_f32 v79, v79, v75
    v_fmac_f32 v79, v70, v22
    v_mov_b32 v24, v12
    v_fmac_f32 v24, 0x3b000000, v8
    v_cos_f32 v75, v24
    v_sin_f32 v22, v24
    s_nop 0
    v_mul_f32 v70, v32, v75
    v_fma_f32 v70, -v81, v22, v70
    v_mul_f32 v81, v81, v75
    v_fmac_f32 v81, v32, v22
    v_mov_b32 v24, v12
    v_fmac_f32 v24, 0x3b400000, v8
    v_cos_f32 v75, v24
    v_sin_f32 v22, v24
    s_nop 0
    v_mul_f32 v32, v38, v75
    v_fma_f32 v32, -v41, v22, v32
    v_mul_f32 v41, v41, v75
    v_fmac_f32 v41, v38, v22
    v_mov_b32 v24, v12
    v_fmac_f32 v24, 0x3b800000, v8
    v_cos_f32 v75, v24
    v_sin_f32 v22, v24
    s_nop 0
    v_mul_f32 v38, v78, v75
    v_fma_f32 v38, -v45, v22, v38
    v_mul_f32 v45, v45, v75
    v_fmac_f32 v45, v78, v22
    v_mov_b32 v24, v12
    v_fmac_f32 v24, 0x3ba00000, v8
    v_cos_f32 v75, v24
    v_sin_f32 v22, v24
    s_nop 0
    v_mul_f32 v78, v36, v75
    v_fma_f32 v78, -v63, v22, v78
    v_mul_f32 v63, v63, v75
    v_fmac_f32 v63, v36, v22
    v_mov_b32 v24, v12
    v_fmac_f32 v24, 0x3bc00000, v8
    v_cos_f32 v75, v24
    v_sin_f32 v22, v24
    s_nop 0
    v_mul_f32 v36, v62, v75
    v_fma_f32 v36, -v29, v22, v36
    v_mul_f32 v29, v29, v75
    v_fmac_f32 v29, v62, v22
    v_mov_b32 v24, v12
    v_fmac_f32 v24, 0x3be00000, v8
    v_cos_f32 v75, v24
    v_sin_f32 v22, v24
    s_nop 0
    v_mul_f32 v62, v56, v75
    v_fma_f32 v62, -v31, v22, v62
    v_mul_f32 v31, v31, v75
    v_fmac_f32 v31, v56, v22
    v_mov_b32 v24, v12
    v_fmac_f32 v24, 0x3c000000, v8
    v_cos_f32 v75, v24
    v_sin_f32 v22, v24
    s_nop 0
    v_mul_f32 v56, v18, v75
    v_fma_f32 v56, -v55, v22, v56
    v_mul_f32 v55, v55, v75
    v_fmac_f32 v55, v18, v22
    v_mov_b32 v24, v12
    v_fmac_f32 v24, 0x3c100000, v8
    v_cos_f32 v75, v24
    v_sin_f32 v22, v24
    s_nop 0
    v_mul_f32 v18, v64, v75
    v_fma_f32 v18, -v67, v22, v18
    v_mul_f32 v67, v67, v75
    v_fmac_f32 v67, v64, v22
    v_mov_b32 v24, v12
    v_fmac_f32 v24, 0x3c200000, v8
    v_cos_f32 v75, v24
    v_sin_f32 v22, v24
    s_nop 0
    v_mul_f32 v64, v66, v75
    v_fma_f32 v64, -v37, v22, v64
    v_mul_f32 v37, v37, v75
    v_fmac_f32 v37, v66, v22
    v_mov_b32 v24, v12
    v_fmac_f32 v24, 0x3c300000, v8
    v_cos_f32 v75, v24
    v_sin_f32 v22, v24
    s_nop 0
    v_mul_f32 v66, v80, v75
    v_fma_f32 v66, -v35, v22, v66
    v_mul_f32 v35, v35, v75
    v_fmac_f32 v35, v80, v22
    v_mov_b32 v24, v12
    v_fmac_f32 v24, 0x3c400000, v8
    v_cos_f32 v75, v24
    v_sin_f32 v22, v24
    s_nop 0
    v_mul_f32 v80, v74, v75
    v_fma_f32 v80, -v23, v22, v80
    v_mul_f32 v23, v23, v75
    v_fmac_f32 v23, v74, v22
    v_mov_b32 v24, v12
    v_fmac_f32 v24, 0x3c500000, v8
    v_cos_f32 v75, v24
    v_sin_f32 v22, v24
    s_nop 0
    v_mul_f32 v74, v42, v75
    v_fma_f32 v74, -v21, v22, v74
    v_mul_f32 v21, v21, v75
    v_fmac_f32 v21, v42, v22
    v_mov_b32 v24, v12
    v_fmac_f32 v24, 0x3c600000, v8
    v_cos_f32 v75, v24
    v_sin_f32 v22, v24
    s_nop 0
    v_mul_f32 v42, v58, v75
    v_fma_f32 v42, -v69, v22, v42
    v_mul_f32 v69, v69, v75
    v_fmac_f32 v69, v58, v22
    v_mov_b32 v24, v12
    v_fmac_f32 v24, 0x3c700000, v8
    v_cos_f32 v75, v24
    v_sin_f32 v22, v24
    s_nop 0
    v_mul_f32 v58, v83, v75
    v_fma_f32 v58, -v51, v22, v58
    v_mul_f32 v51, v51, v75
    v_fmac_f32 v51, v83, v22
    v_mov_b32 v24, v12
    v_fmac_f32 v24, 0x3c800000, v8
    v_cos_f32 v75, v24
    v_sin_f32 v22, v24
    s_nop 0
    v_mul_f32 v83, v72, v75
    v_fma_f32 v83, -v59, v22, v83
    v_mul_f32 v59, v59, v75
    v_fmac_f32 v59, v72, v22
    v_mov_b32 v24, v12
    v_fmac_f32 v24, 0x3c880000, v8
    v_cos_f32 v75, v24
    v_sin_f32 v22, v24
    s_nop 0
    v_mul_f32 v72, v54, v75
    v_fma_f32 v72, -v43, v22, v72
    v_mul_f32 v43, v43, v75
    v_fmac_f32 v43, v54, v22
    v_mov_b32 v24, v12
    v_fmac_f32 v24, 0x3c900000, v8
    v_cos_f32 v75, v24
    v_sin_f32 v22, v24
    s_nop 0
    v_mul_f32 v54, v48, v75
    v_fma_f32 v54, -v27, v22, v54
    v_mul_f32 v27, v27, v75
    v_fmac_f32 v27, v48, v22
    v_mov_b32 v24, v12
    v_fmac_f32 v24, 0x3c980000, v8
    v_cos_f32 v75, v24
    v_sin_f32 v22, v24
    s_nop 0
    v_mul_f32 v48, v60, v75
    v_fma_f32 v48, -v65, v22, v48
    v_mul_f32 v65, v65, v75
    v_fmac_f32 v65, v60, v22
    v_mov_b32 v24, v12
    v_fmac_f32 v24, 0x3ca00000, v8
    v_cos_f32 v75, v24
    v_sin_f32 v22, v24
    s_nop 0
    v_mul_f32 v60, v16, v75
    v_fma_f32 v60, -v19, v22, v60
    v_mul_f32 v19, v19, v75
    v_fmac_f32 v19, v16, v22
    v_mov_b32 v24, v12
    v_fmac_f32 v24, 0x3ca80000, v8
    v_cos_f32 v75, v24
    v_sin_f32 v22, v24
    s_nop 0
    v_mul_f32 v16, v34, v75
    v_fma_f32 v16, -v73, v22, v16
    v_mul_f32 v73, v73, v75
    v_fmac_f32 v73, v34, v22
    v_mov_b32 v24, v12
    v_fmac_f32 v24, 0x3cb00000, v8
    v_cos_f32 v75, v24
    v_sin_f32 v22, v24
    s_nop 0
    v_mul_f32 v34, v52, v75
    v_fma_f32 v34, -v61, v22, v34
    v_mul_f32 v61, v61, v75
    v_fmac_f32 v61, v52, v22
    v_mov_b32 v24, v12
    v_fmac_f32 v24, 0x3cb80000, v8
    v_cos_f32 v75, v24
    v_sin_f32 v22, v24
    s_nop 0
    v_mul_f32 v52, v50, v75
    v_fma_f32 v52, -v47, v22, v52
    v_mul_f32 v47, v47, v75
    v_fmac_f32 v47, v50, v22
    v_mov_b32 v24, v12
    v_fmac_f32 v24, 0x3cc00000, v8
    v_cos_f32 v75, v24
    v_sin_f32 v22, v24
    s_nop 0
    v_mul_f32 v50, v26, v75
    v_fma_f32 v50, -v49, v22, v50
    v_mul_f32 v49, v49, v75
    v_fmac_f32 v49, v26, v22
    v_mov_b32 v24, v12
    v_fmac_f32 v24, 0x3cc80000, v8
    v_cos_f32 v75, v24
    v_sin_f32 v22, v24
    s_nop 0
    v_mul_f32 v26, v30, v75
    v_fma_f32 v26, -v77, v22, v26
    v_mul_f32 v77, v77, v75
    v_fmac_f32 v77, v30, v22
    v_mov_b32 v24, v12
    v_fmac_f32 v24, 0x3cd00000, v8
    v_cos_f32 v75, v24
    v_sin_f32 v22, v24
    s_nop 0
    v_mul_f32 v30, v44, v75
    v_fma_f32 v30, -v71, v22, v30
    v_mul_f32 v71, v71, v75
    v_fmac_f32 v71, v44, v22
    v_mov_b32 v24, v12
    v_fmac_f32 v24, 0x3cd80000, v8
    v_cos_f32 v75, v24
    v_sin_f32 v22, v24
    s_nop 0
    v_mul_f32 v44, v46, v75
    v_fma_f32 v44, -v33, v22, v44
    v_mul_f32 v33, v33, v75
    v_fmac_f32 v33, v46, v22
    v_mov_b32 v24, v12
    v_fmac_f32 v24, 0x3ce00000, v8
    v_cos_f32 v75, v24
    v_sin_f32 v22, v24
    s_nop 0
    v_mul_f32 v46, v68, v75
    v_fma_f32 v46, -v39, v22, v46
    v_mul_f32 v39, v39, v75
    v_fmac_f32 v39, v68, v22
    v_mov_b32 v24, v12
    v_fmac_f32 v24, 0x3ce80000, v8
    v_cos_f32 v75, v24
    v_sin_f32 v22, v24
    s_nop 0
    v_mul_f32 v68, v40, v75
    v_fma_f32 v68, -v25, v22, v68
    v_mul_f32 v25, v25, v75
    v_fmac_f32 v25, v40, v22
    v_mov_b32 v24, v12
    v_fmac_f32 v24, 0x3cf00000, v8
    v_cos_f32 v75, v24
    v_sin_f32 v22, v24
    s_nop 0
    v_mul_f32 v40, v28, v75
    v_fma_f32 v40, -v57, v22, v40
    v_mul_f32 v57, v57, v75
    v_fmac_f32 v57, v28, v22
    v_mov_b32 v24, v12
    v_fmac_f32 v24, 0x3cf80000, v8
    v_cos_f32 v75, v24
    v_sin_f32 v22, v24
    s_nop 0
    v_mul_f32 v28, v76, v75
    v_fma_f32 v28, -v53, v22, v28
    v_mul_f32 v53, v53, v75
    v_fmac_f32 v53, v76, v22
    ds_write_b32 v4, v20 offset:0
    ds_write_b32 v4, v17 offset:4
    ds_write_b32 v4, v82 offset:16
    ds_write_b32 v4, v79 offset:20
    ds_write_b32 v4, v70 offset:32
    ds_write_b32 v4, v81 offset:36
    ds_write_b32 v4, v32 offset:48
    ds_write_b32 v4, v41 offset:52
    ds_write_b32 v4, v38 offset:64
    ds_write_b32 v4, v45 offset:68
    ds_write_b32 v4, v78 offset:80
    ds_write_b32 v4, v63 offset:84
    ds_write_b32 v4, v36 offset:96
    ds_write_b32 v4, v29 offset:100
    ds_write_b32 v4, v62 offset:112
    ds_write_b32 v4, v31 offset:116
    ds_write_b32 v4, v56 offset:128
    ds_write_b32 v4, v55 offset:132
    ds_write_b32 v4, v18 offset:144
    ds_write_b32 v4, v67 offset:148
    ds_write_b32 v4, v64 offset:160
    ds_write_b32 v4, v37 offset:164
    ds_write_b32 v4, v66 offset:176
    ds_write_b32 v4, v35 offset:180
    ds_write_b32 v4, v80 offset:192
    ds_write_b32 v4, v23 offset:196
    ds_write_b32 v4, v74 offset:208
    ds_write_b32 v4, v21 offset:212
    ds_write_b32 v4, v42 offset:224
    ds_write_b32 v4, v69 offset:228
    ds_write_b32 v4, v58 offset:240
    ds_write_b32 v4, v51 offset:244
    ds_write_b32 v4, v83 offset:256
    ds_write_b32 v4, v59 offset:260
    ds_write_b32 v4, v72 offset:272
    ds_write_b32 v4, v43 offset:276
    ds_write_b32 v4, v54 offset:288
    ds_write_b32 v4, v27 offset:292
    ds_write_b32 v4, v48 offset:304
    ds_write_b32 v4, v65 offset:308
    ds_write_b32 v4, v60 offset:320
    ds_write_b32 v4, v19 offset:324
    ds_write_b32 v4, v16 offset:336
    ds_write_b32 v4, v73 offset:340
    ds_write_b32 v4, v34 offset:352
    ds_write_b32 v4, v61 offset:356
    ds_write_b32 v4, v52 offset:368
    ds_write_b32 v4, v47 offset:372
    ds_write_b32 v4, v50 offset:384
    ds_write_b32 v4, v49 offset:388
    ds_write_b32 v4, v26 offset:400
    ds_write_b32 v4, v77 offset:404
    ds_write_b32 v4, v30 offset:416
    ds_write_b32 v4, v71 offset:420
    ds_write_b32 v4, v44 offset:432
    ds_write_b32 v4, v33 offset:436
    ds_write_b32 v4, v46 offset:448
    ds_write_b32 v4, v39 offset:452
    ds_write_b32 v4, v68 offset:464
    ds_write_b32 v4, v25 offset:468
    ds_write_b32 v4, v40 offset:480
    ds_write_b32 v4, v57 offset:484
    ds_write_b32 v4, v28 offset:496
    ds_write_b32 v4, v53 offset:500
    s_waitcnt lgkmcnt(0)
    ds_read_b32 v20, v3 offset:0
    ds_read_b32 v17, v3 offset:4
    ds_read_b32 v82, v3 offset:528
    ds_read_b32 v79, v3 offset:532
    ds_read_b32 v70, v3 offset:1056
    ds_read_b32 v81, v3 offset:1060
    ds_read_b32 v32, v3 offset:1584
    ds_read_b32 v41, v3 offset:1588
    ds_read_b32 v38, v3 offset:2112
    ds_read_b32 v45, v3 offset:2116
    ds_read_b32 v78, v3 offset:2640
    ds_read_b32 v63, v3 offset:2644
    ds_read_b32 v36, v3 offset:3168
    ds_read_b32 v29, v3 offset:3172
    s_waitcnt lgkmcnt(0)
    ds_read_b32 v62, v3 offset:3696
    ds_read_b32 v31, v3 offset:3700
    ds_read_b32 v56, v3 offset:4224
    ds_read_b32 v55, v3 offset:4228
    ds_read_b32 v18, v3 offset:4752
    ds_read_b32 v67, v3 offset:4756
    ds_read_b32 v64, v3 offset:5280
    ds_read_b32 v37, v3 offset:5284
    ds_read_b32 v66, v3 offset:5808
    ds_read_b32 v35, v3 offset:5812
    ds_read_b32 v80, v3 offset:6336
    ds_read_b32 v23, v3 offset:6340
    ds_read_b32 v74, v3 offset:6864
    ds_read_b32 v21, v3 offset:6868
    s_waitcnt lgkmcnt(0)
    ds_read_b32 v42, v3 offset:7392
    ds_read_b32 v69, v3 offset:7396
    ds_read_b32 v58, v3 offset:7920
    ds_read_b32 v51, v3 offset:7924
    ds_read_b32 v83, v3 offset:8448
    ds_read_b32 v59, v3 offset:8452
    ds_read_b32 v72, v3 offset:8976
    ds_read_b32 v43, v3 offset:8980
    ds_read_b32 v54, v3 offset:9504
    ds_read_b32 v27, v3 offset:9508
    ds_read_b32 v48, v3 offset:10032
    ds_read_b32 v65, v3 offset:10036
    ds_read_b32 v60, v3 offset:10560
    ds_read_b32 v19, v3 offset:10564
    s_waitcnt lgkmcnt(0)
    ds_read_b32 v16, v3 offset:11088
    ds_read_b32 v73, v3 offset:11092
    ds_read_b32 v34, v3 offset:11616
    ds_read_b32 v61, v3 offset:11620
    ds_read_b32 v52, v3 offset:12144
    ds_read_b32 v47, v3 offset:12148
    ds_read_b32 v50, v3 offset:12672
    ds_read_b32 v49, v3 offset:12676
    ds_read_b32 v26, v3 offset:13200
    ds_read_b32 v77, v3 offset:13204
    ds_read_b32 v30, v3 offset:13728
    ds_read_b32 v71, v3 offset:13732
    ds_read_b32 v44, v3 offset:14256
    ds_read_b32 v33, v3 offset:14260
    s_waitcnt lgkmcnt(0)
    ds_read_b32 v46, v3 offset:14784
    ds_read_b32 v39, v3 offset:14788
    ds_read_b32 v68, v3 offset:15312
    ds_read_b32 v25, v3 offset:15316
    ds_read_b32 v40, v3 offset:15840
    ds_read_b32 v57, v3 offset:15844
    ds_read_b32 v28, v3 offset:16368
    ds_read_b32 v53, v3 offset:16372
    s_waitcnt lgkmcnt(0)
    v_sub_f32 v24, v20, v83
    v_sub_f32 v75, v17, v59
    v_add_f32 v20, v20, v83
    v_add_f32 v17, v17, v59
    v_sub_f32 v83, v82, v72
    v_sub_f32 v59, v79, v43
    v_add_f32 v82, v82, v72
    v_add_f32 v79, v79, v43
    v_mul_f32 v72, 0x3f7b14be, v83
    v_mul_f32 v43, 0x3e47c5c2, v83
    v_fmac_f32 v72, 0xbe47c5c2, v59
    v_fmac_f32 v43, 0x3f7b14be, v59
    v_sub_f32 v83, v70, v54
    v_sub_f32 v59, v81, v27
    v_add_f32 v70, v70, v54
    v_add_f32 v81, v81, v27
    v_mul_f32 v54, 0x3f6c835e, v83
    v_mul_f32 v27, 0x3ec3ef15, v83
    v_fmac_f32 v54, 0xbec3ef15, v59
    v_fmac_f32 v27, 0x3f6c835e, v59
    v_sub_f32 v83, v32, v48
    v_sub_f32 v59, v41, v65
    v_add_f32 v32, v32, v48
    v_add_f32 v41, v41, v65
    v_mul_f32 v48, 0x3f54db31, v83
    v_mul_f32 v65, 0x3f0e39da, v83
    v_fmac_f32 v48, 0xbf0e39da, v59
    v_fmac_f32 v65, 0x3f54db31, v59
    v_sub_f32 v83, v38, v60
    v_sub_f32 v59, v45, v19
    v_add_f32 v38, v38, v60
    v_add_f32 v45, v45, v19
    v_mul_f32 v60, 0x3f3504f3, v83
    v_mul_f32 v19, 0x3f3504f3, v83
    v_fmac_f32 v60, 0xbf3504f3, v59
    v_fmac_f32 v19, 0x3f3504f3, v59
    v_sub_f32 v83, v78, v16
    v_sub_f32 v59, v63, v73
    v_add_f32 v78, v78, v16
    v_add_f32 v63, v63, v73
    v_mul_f32 v16, 0x3f0e39da, v83
    v_mul_f32 v73, 0x3f54db31, v83
    v_fmac_f32 v16, 0xbf54db31, v59
    v_fmac_f32 v73, 0x3f0e39da, v59
    v_sub_f32 v83, v36, v34
    v_sub_f32 v59, v29, v61
    v_add_f32 v36, v36, v34
    v_add_f32 v29, v29, v61
    v_mul_f32 v34, 0x3ec3ef15, v83
    v_mul_f32 v61, 0x3f6c835e, v83
    v_fmac_f32 v34, 0xbf6c835e, v59
    v_fmac_f32 v61, 0x3ec3ef15, v59
    v_sub_f32 v83, v62, v52
    v_sub_f32 v59, v31, v47
    v_add_f32 v62, v62, v52
    v_add_f32 v31, v31, v47
    v_mul_f32 v52, 0x3e47c5c2, v83
    v_mul_f32 v47, 0x3f7b14be, v83
    v_fmac_f32 v52, 0xbf7b14be, v59
    v_fmac_f32 v47, 0x3e47c5c2, v59
    v_sub_f32 v83, v49, v55
    v_sub_f32 v59, v56, v50
    v_add_f32 v56, v56, v50
    v_add_f32 v55, v55, v49
    v_sub_f32 v50, v18, v26
    v_sub_f32 v49, v67, v77
    v_add_f32 v18, v18, v26
    v_add_f32 v67, v67, v77
    v_mul_f32 v26, 0xbe47c5c2, v50
    v_mul_f32 v77, 0x3f7b14be, v50
    v_fmac_f32 v26, 0xbf7b14be, v49
    v_fmac_f32 v77, 0xbe47c5c2, v49
    v_sub_f32 v50, v64, v30
    v_sub_f32 v49, v37, v71
    v_add_f32 v64, v64, v30
    v_add_f32 v37, v37, v71
    v_mul_f32 v30, 0xbec3ef15, v50
    v_mul_f32 v71, 0x3f6c835e, v50
    v_fmac_f32 v30, 0xbf6c835e, v49
    v_fmac_f32 v71, 0xbec3ef15, v49
    v_sub_f32 v50, v66, v44
    v_sub_f32 v49, v35, v33
    v_add_f32 v66, v66, v44
    v_add_f32 v35, v35, v33
    v_mul_f32 v44, 0xbf0e39da, v50
    v_mul_f32 v33, 0x3f54db31, v50
    v_fmac_f32 v44, 0xbf54db31, v49
    v_fmac_f32 v33, 0xbf0e39da, v49
    v_sub_f32 v50, v80, v46
    v_sub_f32 v49, v23, v39
    v_add_f32 v80, v80, v46
    v_add_f32 v23, v23, v39
    v_mul_f32 v46, 0xbf3504f3, v50
    v_mul_f32 v39, 0x3f3504f3, v50
    v_fmac_f32 v46, 0xbf3504f3, v49
    v_fmac_f32 v39, 0xbf3504f3, v49
    v_sub_f32 v50, v74, v68
    v_sub_f32 v49, v21, v25
    v_add_f32 v74, v74, v68
    v_add_f32 v21, v21, v25
    v_mul_f32 v68, 0xbf54db31, v50
    v_mul_f32 v25, 0x3f0e39da, v50
    v_fmac_f32 v68, 0xbf0e39da, v49
    v_fmac_f32 v25, 0xbf54db31, v49
    v_sub_f32 v50, v42, v40
    v_sub_f32 v49, v69, v57
    v_add_f32 v42, v42, v40
    v_add_f32 v69, v69, v57
    v_mul_f32 v40, 0xbf6c835e, v50
    v_mul_f32 v57, 0x3ec3ef15, v50
    v_fmac_f32 v40, 0xbec3ef15, v49
    v_fmac_f32 v57, 0xbf6c835e, v49
    v_sub_f32 v50, v58, v28
    v_sub_f32 v49, v51, v53
    v_add_f32 v58, v58, v28
    v_add_f32 v51, v51, v53
    v_mul_f32 v28, 0xbf7b14be, v50
    v_mul_f32 v53, 0x3e47c5c2, v50
    v_fmac_f32 v28, 0xbe47c5c2, v49
    v_fmac_f32 v53, 0xbf7b14be, v49
    v_sub_f32 v50, v20, v56
    v_sub_f32 v49, v17, v55
    v_add_f32 v20, v20, v56
    v_add_f32 v17, v17, v55
    v_sub_f32 v56, v82, v18
    v_sub_f32 v55, v79, v67
    v_add_f32 v82, v82, v18
    v_add_f32 v79, v79, v67
    v_mul_f32 v18, 0x3f6c835e, v56
    v_mul_f32 v67, 0x3ec3ef15, v56
    v_fmac_f32 v18, 0xbec3ef15, v55
    v_fmac_f32 v67, 0x3f6c835e, v55
    v_sub_f32 v56, v70, v64
    v_sub_f32 v55, v81, v37
    v_add_f32 v70, v70, v64
    v_add_f32 v81, v81, v37
    v_mul_f32 v64, 0x3f3504f3, v56
    v_mul_f32 v37, 0x3f3504f3, v56
    v_fmac_f32 v64, 0xbf3504f3, v55
    v_fmac_f32 v37, 0x3f3504f3, v55
    v_sub_f32 v56, v32, v66
    v_sub_f32 v55, v41, v35
    v_add_f32 v32, v32, v66
    v_add_f32 v41, v41, v35
    v_mul_f32 v66, 0x3ec3ef15, v56
    v_mul_f32 v35, 0x3f6c835e, v56
    v_fmac_f32 v66, 0xbf6c835e, v55
    v_fmac_f32 v35, 0x3ec3ef15, v55
    v_sub_f32 v56, v23, v45
    v_sub_f32 v55, v38, v80
    v_add_f32 v38, v38, v80
    v_add_f32 v45, v45, v23
    v_sub_f32 v80, v78, v74
    v_sub_f32 v23, v63, v21
    v_add_f32 v78, v78, v74
    v_add_f32 v63, v63, v21
    v_mul_f32 v74, 0xbec3ef15, v80
    v_mul_f32 v21, 0x3f6c835e, v80
    v_fmac_f32 v74, 0xbf6c835e, v23
    v_fmac_f32 v21, 0xbec3ef15, v23
    v_sub_f32 v80, v36, v42
    v_sub_f32 v23, v29, v69
    v_add_f32 v36, v36, v42
    v_add_f32 v29, v29, v69
    v_mul_f32 v42, 0xbf3504f3, v80
    v_mul_f32 v69, 0x3f3504f3, v80
    v_fmac_f32 v42, 0xbf3504f3, v23
    v_fmac_f32 v69, 0xbf3504f3, v23
    v_sub_f32 v80, v62, v58
    v_sub_f32 v23, v31, v51
    v_add_f32 v62, v62, v58
    v_add_f32 v31, v31, v51
    v_mul_f32 v58, 0xbf6c835e, v80
    v_mul_f32 v51, 0x3ec3ef15, v80
    v_fmac_f32 v58, 0xbec3ef15, v23
    v_fmac_f32 v51, 0xbf6c835e, v23
    v_sub_f32 v80, v24, v83
    v_sub_f32 v23, v75, v59
    v_add_f32 v24, v24, v83
    v_add_f32 v75, v75, v59
    v_sub_f32 v83, v72, v26
    v_sub_f32 v59, v43, v77
    v_add_f32 v72, v72, v26
    v_add_f32 v43, v43, v77
    v_mul_f32 v26, 0x3f6c835e, v83
    v_mul_f32 v77, 0x3ec3ef15, v83
    v_fmac_f32 v26, 0xbec3ef15, v59
    v_fmac_f32 v77, 0x3f6c835e, v59
    v_sub_f32 v83, v54, v30
    v_sub_f32 v59, v27, v71
    v_add_f32 v54, v54, v30
    v_add_f32 v27, v27, v71
    v_mul_f32 v30, 0x3f3504f3, v83
    v_mul_f32 v71, 0x3f3504f3, v83
    v_fmac_f32 v30, 0xbf3504f3, v59
    v_fmac_f32 v71, 0x3f3504f3, v59
    v_sub_f32 v83, v48, v44
    v_sub_f32 v59, v65, v33
    v_add_f32 v48, v48, v44
    v_add_f32 v65, v65, v33
    v_mul_f32 v44, 0x3ec3ef15, v83
    v_mul_f32 v33, 0x3f6c835e, v83
    v_fmac_f32 v44, 0xbf6c835e, v59
    v_fmac_f32 v33, 0x3ec3ef15, v59
    v_sub_f32 v83, v39, v19
    v_sub_f32 v59, v60, v46
    v_add_f32 v60, v60, v46
    v_add_f32 v19, v19, v39
    v_sub_f32 v46, v16, v68
    v_sub_f32 v39, v73, v25
    v_add_f32 v16, v16, v68
    v_add_f32 v73, v73, v25
    v_mul_f32 v68, 0xbec3ef15, v46
    v_mul_f32 v25, 0x3f6c835e, v46
    v_fmac_f32 v68, 0xbf6c835e, v39
    v_fmac_f32 v25, 0xbec3ef15, v39
    v_sub_f32 v46, v34, v40
    v_sub_f32 v39, v61, v57
    v_add_f32 v34, v34, v40
    v_add_f32 v61, v61, v57
    v_mul_f32 v40, 0xbf3504f3, v46
    v_mul_f32 v57, 0x3f3504f3, v46
    v_fmac_f32 v40, 0xbf3504f3, v39
    v_fmac_f32 v57, 0xbf3504f3, v39
    v_sub_f32 v46, v52, v28
    v_sub_f32 v39, v47, v53
    v_add_f32 v52, v52, v28
    v_add_f32 v47, v47, v53
    v_mul_f32 v28, 0xbf6c835e, v46
    v_mul_f32 v53, 0x3ec3ef15, v46
    v_fmac_f32 v28, 0xbec3ef15, v39
    v_fmac_f32 v53, 0xbf6c835e, v39
    v_sub_f32 v46, v20, v38
    v_sub_f32 v39, v17, v45
    v_add_f32 v20, v20, v38
    v_add_f32 v17, v17, v45
    v_sub_f32 v38, v82, v78
    v_sub_f32 v45, v79, v63
    v_add_f32 v82, v82, v78
    v_add_f32 v79, v79, v63
    v_mul_f32 v78, 0x3f3504f3, v38
    v_mul_f32 v63, 0x3f3504f3, v38
    v_fmac_f32 v78, 0xbf3504f3, v45
    v_fmac_f32 v63, 0x3f3504f3, v45
    v_sub_f32 v38, v29, v81
    v_sub_f32 v45, v70, v36
    v_add_f32 v70, v70, v36
    v_add_f32 v81, v81, v29
    v_sub_f32 v36, v32, v62
    v_sub_f32 v29, v41, v31
    v_add_f32 v32, v32, v62
    v_add_f32 v41, v41, v31
    v_mul_f32 v62, 0xbf3504f3, v36
    v_mul_f32 v31, 0x3f3504f3, v36
    v_fmac_f32 v62, 0xbf3504f3, v29
    v_fmac_f32 v31, 0xbf3504f3, v29
    v_sub_f32 v36, v50, v56
    v_sub_f32 v29, v49, v55
    v_add_f32 v50, v50, v56
    v_add_f32 v49, v49, v55
    v_sub_f32 v56, v18, v74
    v_sub_f32 v55, v67, v21
    v_add_f32 v18, v18, v74
    v_add_f32 v67, v67, v21
    v_mul_f32 v74, 0x3f3504f3, v56
    v_mul_f32 v21, 0x3f3504f3, v56
    v_fmac_f32 v74, 0xbf3504f3, v55
    v_fmac_f32 v21, 0x3f3504f3, v55
    v_sub_f32 v56, v69, v37
    v_sub_f32 v55, v64, v42
    v_add_f32 v64, v64, v42
    v_add_f32 v37, v37, v69
    v_sub_f32 v42, v66, v58
    v_sub_f32 v69, v35, v51
    v_add_f32 v66, v66, v58
    v_add_f32 v35, v35, v51
    v_mul_f32 v58, 0xbf3504f3, v42
    v_mul_f32 v51, 0x3f3504f3, v42
    v_fmac_f32 v58, 0xbf3504f3, v69
    v_fmac_f32 v51, 0xbf3504f3, v69
    v_sub_f32 v42, v24, v60
    v_sub_f32 v69, v75, v19
    v_add_f32 v24, v24, v60
    v_add_f32 v75, v75, v19
    v_sub_f32 v60, v72, v16
    v_sub_f32 v19, v43, v73
    v_add_f32 v72, v72, v16
    v_add_f32 v43, v43, v73
    v_mul_f32 v16, 0x3f3504f3, v60
    v_mul_f32 v73, 0x3f3504f3, v60
    v_fmac_f32 v16, 0xbf3504f3, v19
    v_fmac_f32 v73, 0x3f3504f3, v19
    v_sub_f32 v60, v61, v27
    v_sub_f32 v19, v54, v34
    v_add_f32 v54, v54, v34
    v_add_f32 v27, v27, v61
    v_sub_f32 v34, v48, v52
    v_sub_f32 v61, v65, v47
    v_add_f32 v48, v48, v52
    v_add_f32 v65, v65, v47
    v_mul_f32 v52, 0xbf3504f3, v34
    v_mul_f32 v47, 0x3f3504f3, v34
    v_fmac_f32 v52, 0xbf3504f3, v61
    v_fmac_f32 v47, 0xbf3504f3, v61
    v_sub_f32 v34, v80, v83
    v_sub_f32 v61, v23, v59
    v_add_f32 v80, v80, v83
    v_add_f32 v23, v23, v59
    v_sub_f32 v83, v26, v68
    v_sub_f32 v59, v77, v25
    v_add_f32 v26, v26, v68
    v_add_f32 v77, v77, v25
    v_mul_f32 v68, 0x3f3504f3, v83
    v_mul_f32 v25, 0x3f3504f3, v83
    v_fmac_f32 v68, 0xbf3504f3, v59
    v_fmac_f32 v25, 0x3f3504f3, v59
    v_sub_f32 v83, v57, v71
    v_sub_f32 v59, v30, v40
    v_add_f32 v30, v30, v40
    v_add_f32 v71, v71, v57
    v_sub_f32 v40, v44, v28
    v_sub_f32 v57, v33, v53
    v_add_f32 v44, v44, v28
    v_add_f32 v33, v33, v53
    v_mul_f32 v28, 0xbf3504f3, v40
    v_mul_f32 v53, 0x3f3504f3, v40
    v_fmac_f32 v28, 0xbf3504f3, v57
    v_fmac_f32 v53, 0xbf3504f3, v57
    v_sub_f32 v40, v20, v70
    v_sub_f32 v57, v17, v81
    v_add_f32 v20, v20, v70
    v_add_f32 v17, v17, v81
    v_sub_f32 v70, v41, v79
    v_sub_f32 v81, v82, v32
    v_add_f32 v82, v82, v32
    v_add_f32 v79, v79, v41
    v_sub_f32 v32, v46, v38
    v_sub_f32 v41, v39, v45
    v_add_f32 v46, v46, v38
    v_add_f32 v39, v39, v45
    v_sub_f32 v38, v31, v63
    v_sub_f32 v45, v78, v62
    v_add_f32 v78, v78, v62
    v_add_f32 v63, v63, v31
    v_sub_f32 v62, v50, v64
    v_sub_f32 v31, v49, v37
    v_add_f32 v50, v50, v64
    v_add_f32 v49, v49, v37
    v_sub_f32 v64, v35, v67
    v_sub_f32 v37, v18, v66
    v_add_f32 v18, v18, v66
    v_add_f32 v67, v67, v35
    v_sub_f32 v66, v36, v56
    v_sub_f32 v35, v29, v55
    v_add_f32 v36, v36, v56
    v_add_f32 v29, v29, v55
    v_sub_f32 v56, v51, v21
    v_sub_f32 v55, v74, v58
    v_add_f32 v74, v74, v58
    v_add_f32 v21, v21, v51
    v_sub_f32 v58, v24, v54
    v_sub_f32 v51, v75, v27
    v_add_f32 v24, v24, v54
    v_add_f32 v75, v75, v27
    v_sub_f32 v54, v65, v43
    v_sub_f32 v27, v72, v48
    v_add_f32 v72, v72, v48
    v_add_f32 v43, v43, v65
    v_sub_f32 v48, v42, v60
    v_sub_f32 v65, v69, v19
    v_add_f32 v42, v42, v60
    v_add_f32 v69, v69, v19
    v_sub_f32 v60, v47, v73
    v_sub_f32 v19, v16, v52
    v_add_f32 v16, v16, v52
    v_add_f32 v73, v73, v47
    v_sub_f32 v52, v80, v30
    v_sub_f32 v47, v23, v71
    v_add_f32 v80, v80, v30
    v_add_f32 v23, v23, v71
    v_sub_f32 v30, v33, v77
    v_sub_f32 v71, v26, v44
    v_add_f32 v26, v26, v44
    v_add_f32 v77, v77, v33
    v_sub_f32 v44, v34, v83
    v_sub_f32 v33, v61, v59
    v_add_f32 v34, v34, v83
    v_add_f32 v61, v61, v59
    v_sub_f32 v83, v53, v25
    v_sub_f32 v59, v68, v28
    v_add_f32 v68, v68, v28
    v_add_f32 v25, v25, v53
    v_sub_f32 v28, v20, v82
    v_sub_f32 v53, v17, v79
    v_add_f32 v20, v20, v82
    v_add_f32 v17, v17, v79
    v_sub_f32 v82, v40, v70
    v_sub_f32 v79, v57, v81
    v_add_f32 v40, v40, v70
    v_add_f32 v57, v57, v81
    v_sub_f32 v70, v46, v78
    v_sub_f32 v81, v39, v63
    v_add_f32 v46, v46, v78
    v_add_f32 v39, v39, v63
    v_sub_f32 v78, v32, v38
    v_sub_f32 v63, v41, v45
    v_add_f32 v32, v32, v38
    v_add_f32 v41, v41, v45
    v_sub_f32 v38, v50, v18
    v_sub_f32 v45, v49, v67
    v_add_f32 v50, v50, v18
    v_add_f32 v49, v49, v67
    v_sub_f32 v18, v62, v64
    v_sub_f32 v67, v31, v37
    v_add_f32 v62, v62, v64
    v_add_f32 v31, v31, v37
    v_sub_f32 v64, v36, v74
    v_sub_f32 v37, v29, v21
    v_add_f32 v36, v36, v74
    v_add_f32 v29, v29, v21
    v_sub_f32 v74, v66, v56
    v_sub_f32 v21, v35, v55
    v_add_f32 v66, v66, v56
    v_add_f32 v35, v35, v55
    v_sub_f32 v56, v24, v72
    v_sub_f32 v55, v75, v43
    v_add_f32 v24, v24, v72
    v_add_f32 v75, v75, v43
    v_sub_f32 v72, v58, v54
    v_sub_f32 v43, v51, v27
    v_add_f32 v58, v58, v54
    v_add_f32 v51, v51, v27
    v_sub_f32 v54, v42, v16
    v_sub_f32 v27, v69, v73
    v_add_f32 v42, v42, v16
    v_add_f32 v69, v69, v73
    v_sub_f32 v16, v48, v60
    v_sub_f32 v73, v65, v19
    v_add_f32 v48, v48, v60
    v_add_f32 v65, v65, v19
    v_sub_f32 v60, v80, v26
    v_sub_f32 v19, v23, v77
    v_add_f32 v80, v80, v26
    v_add_f32 v23, v23, v77
    v_sub_f32 v26, v52, v30
    v_sub_f32 v77, v47, v71
    v_add_f32 v52, v52, v30
    v_add_f32 v47, v47, v71
    v_sub_f32 v30, v34, v68
    v_sub_f32 v71, v61, v25
    v_add_f32 v34, v34, v68
    v_add_f32 v61, v61, v25
    v_sub_f32 v68, v44, v83
    v_sub_f32 v25, v33, v59
    v_add_f32 v44, v44, v83
    v_add_f32 v33, v33, v59
    s_add_u32 s15, s14, 109051904
    v_lshlrev_b32 v5, 3, v1
    s_add_u32 s16, s15, 0
    v_mov_b32 v88, v20
    v_mov_b32 v89, v17
    buffer_store_dwordx2 v[88:89], v5, s[8:11], s16 offen sc1
    s_add_u32 s16, s15, 512
    v_mov_b32 v90, v24
    v_mov_b32 v91, v75
    buffer_store_dwordx2 v[90:91], v5, s[8:11], s16 offen sc1
    s_add_u32 s16, s15, 1024
    v_mov_b32 v92, v50
    v_mov_b32 v93, v49
    buffer_store_dwordx2 v[92:93], v5, s[8:11], s16 offen sc1
    s_add_u32 s16, s15, 1536
    v_mov_b32 v94, v80
    v_mov_b32 v95, v23
    buffer_store_dwordx2 v[94:95], v5, s[8:11], s16 offen sc1
    s_add_u32 s16, s15, 2048
    v_mov_b32 v96, v46
    v_mov_b32 v97, v39
    buffer_store_dwordx2 v[96:97], v5, s[8:11], s16 offen sc1
    s_add_u32 s16, s15, 2560
    v_mov_b32 v98, v42
    v_mov_b32 v99, v69
    buffer_store_dwordx2 v[98:99], v5, s[8:11], s16 offen sc1
    s_add_u32 s16, s15, 3072
    v_mov_b32 v100, v36
    v_mov_b32 v101, v29
    buffer_store_dwordx2 v[100:101], v5, s[8:11], s16 offen sc1
    s_add_u32 s16, s15, 3584
    v_mov_b32 v102, v34
    v_mov_b32 v103, v61
    buffer_store_dwordx2 v[102:103], v5, s[8:11], s16 offen sc1
    s_add_u32 s16, s15, 4096
    v_mov_b32 v88, v40
    v_mov_b32 v89, v57
    buffer_store_dwordx2 v[88:89], v5, s[8:11], s16 offen sc1
    s_add_u32 s16, s15, 4608
    v_mov_b32 v90, v58
    v_mov_b32 v91, v51
    buffer_store_dwordx2 v[90:91], v5, s[8:11], s16 offen sc1
    s_add_u32 s16, s15, 5120
    v_mov_b32 v92, v62
    v_mov_b32 v93, v31
    buffer_store_dwordx2 v[92:93], v5, s[8:11], s16 offen sc1
    s_add_u32 s16, s15, 5632
    v_mov_b32 v94, v52
    v_mov_b32 v95, v47
    buffer_store_dwordx2 v[94:95], v5, s[8:11], s16 offen sc1
    s_add_u32 s16, s15, 6144
    v_mov_b32 v96, v32
    v_mov_b32 v97, v41
    buffer_store_dwordx2 v[96:97], v5, s[8:11], s16 offen sc1
    s_add_u32 s16, s15, 6656
    v_mov_b32 v98, v48
    v_mov_b32 v99, v65
    buffer_store_dwordx2 v[98:99], v5, s[8:11], s16 offen sc1
    s_add_u32 s16, s15, 7168
    v_mov_b32 v100, v66
    v_mov_b32 v101, v35
    buffer_store_dwordx2 v[100:101], v5, s[8:11], s16 offen sc1
    s_add_u32 s16, s15, 7680
    v_mov_b32 v102, v44
    v_mov_b32 v103, v33
    buffer_store_dwordx2 v[102:103], v5, s[8:11], s16 offen sc1
    s_add_u32 s16, s15, 8192
    v_mov_b32 v88, v28
    v_mov_b32 v89, v53
    buffer_store_dwordx2 v[88:89], v5, s[8:11], s16 offen sc1
    s_add_u32 s16, s15, 8704
    v_mov_b32 v90, v56
    v_mov_b32 v91, v55
    buffer_store_dwordx2 v[90:91], v5, s[8:11], s16 offen sc1
    s_add_u32 s16, s15, 9216
    v_mov_b32 v92, v38
    v_mov_b32 v93, v45
    buffer_store_dwordx2 v[92:93], v5, s[8:11], s16 offen sc1
    s_add_u32 s16, s15, 9728
    v_mov_b32 v94, v60
    v_mov_b32 v95, v19
    buffer_store_dwordx2 v[94:95], v5, s[8:11], s16 offen sc1
    s_add_u32 s16, s15, 10240
    v_mov_b32 v96, v70
    v_mov_b32 v97, v81
    buffer_store_dwordx2 v[96:97], v5, s[8:11], s16 offen sc1
    s_add_u32 s16, s15, 10752
    v_mov_b32 v98, v54
    v_mov_b32 v99, v27
    buffer_store_dwordx2 v[98:99], v5, s[8:11], s16 offen sc1
    s_add_u32 s16, s15, 11264
    v_mov_b32 v100, v64
    v_mov_b32 v101, v37
    buffer_store_dwordx2 v[100:101], v5, s[8:11], s16 offen sc1
    s_add_u32 s16, s15, 11776
    v_mov_b32 v102, v30
    v_mov_b32 v103, v71
    buffer_store_dwordx2 v[102:103], v5, s[8:11], s16 offen sc1
    s_add_u32 s16, s15, 12288
    v_mov_b32 v88, v82
    v_mov_b32 v89, v79
    buffer_store_dwordx2 v[88:89], v5, s[8:11], s16 offen sc1
    s_add_u32 s16, s15, 12800
    v_mov_b32 v90, v72
    v_mov_b32 v91, v43
    buffer_store_dwordx2 v[90:91], v5, s[8:11], s16 offen sc1
    s_add_u32 s16, s15, 13312
    v_mov_b32 v92, v18
    v_mov_b32 v93, v67
    buffer_store_dwordx2 v[92:93], v5, s[8:11], s16 offen sc1
    s_add_u32 s16, s15, 13824
    v_mov_b32 v94, v26
    v_mov_b32 v95, v77
    buffer_store_dwordx2 v[94:95], v5, s[8:11], s16 offen sc1
    s_add_u32 s16, s15, 14336
    v_mov_b32 v96, v78
    v_mov_b32 v97, v63
    buffer_store_dwordx2 v[96:97], v5, s[8:11], s16 offen sc1
    s_add_u32 s16, s15, 14848
    v_mov_b32 v98, v16
    v_mov_b32 v99, v73
    buffer_store_dwordx2 v[98:99], v5, s[8:11], s16 offen sc1
    s_add_u32 s16, s15, 15360
    v_mov_b32 v100, v74
    v_mov_b32 v101, v21
    buffer_store_dwordx2 v[100:101], v5, s[8:11], s16 offen sc1
    s_add_u32 s16, s15, 15872
    v_mov_b32 v102, v68
    v_mov_b32 v103, v25
    buffer_store_dwordx2 v[102:103], v5, s[8:11], s16 offen sc1
mega_kernel_f2_end:
    s_cmp_eq_u32 s99, 128
    s_cbranch_scc1 mega_kernel_f2ret
    s_waitcnt vmcnt(0)
    s_barrier
    v_mov_b32 v2, 1
    v_cmp_eq_u32 vcc, 0, v0
    s_and_saveexec_b64 s[80:81], vcc
    s_cbranch_execz mega_kernel_sg136_5
    buffer_atomic_add v2, off, s[88:91], 0 offset:136 sc1
mega_kernel_sg136_5:
    s_mov_b64 exec, s[80:81]
    s_waitcnt vmcnt(0)
    ds_read_b64_tr_b16 a[128:129], v201 offset:0
    ds_read_b64_tr_b16 a[130:131], v201 offset:256
    ds_read_b64_tr_b16 a[132:133], v201 offset:1024
    ds_read_b64_tr_b16 a[134:135], v201 offset:1280
    ds_read_b64_tr_b16 a[136:137], v201 offset:2048
    ds_read_b64_tr_b16 a[138:139], v201 offset:2304
    ds_read_b64_tr_b16 a[140:141], v201 offset:3072
    ds_read_b64_tr_b16 a[142:143], v201 offset:3328
    s_waitcnt lgkmcnt(0)
    ds_read_b64_tr_b16 a[144:145], v201 offset:4096
    ds_read_b64_tr_b16 a[146:147], v201 offset:4352
    ds_read_b64_tr_b16 a[148:149], v201 offset:5120
    ds_read_b64_tr_b16 a[150:151], v201 offset:5376
    ds_read_b64_tr_b16 a[152:153], v201 offset:6144
    ds_read_b64_tr_b16 a[154:155], v201 offset:6400
    ds_read_b64_tr_b16 a[156:157], v201 offset:7168
    ds_read_b64_tr_b16 a[158:159], v201 offset:7424
    s_waitcnt lgkmcnt(0)
    ds_read_b64_tr_b16 a[160:161], v201 offset:8192
    ds_read_b64_tr_b16 a[162:163], v201 offset:8448
    ds_read_b64_tr_b16 a[164:165], v201 offset:9216
    ds_read_b64_tr_b16 a[166:167], v201 offset:9472
    ds_read_b64_tr_b16 a[168:169], v201 offset:10240
    ds_read_b64_tr_b16 a[170:171], v201 offset:10496
    ds_read_b64_tr_b16 a[172:173], v201 offset:11264
    ds_read_b64_tr_b16 a[174:175], v201 offset:11520
    s_waitcnt lgkmcnt(0)
    ds_read_b64_tr_b16 a[176:177], v201 offset:12288
    ds_read_b64_tr_b16 a[178:179], v201 offset:12544
    ds_read_b64_tr_b16 a[180:181], v201 offset:13312
    ds_read_b64_tr_b16 a[182:183], v201 offset:13568
    ds_read_b64_tr_b16 a[184:185], v201 offset:14336
    ds_read_b64_tr_b16 a[186:187], v201 offset:14592
    ds_read_b64_tr_b16 a[188:189], v201 offset:15360
    ds_read_b64_tr_b16 a[190:191], v201 offset:15616
    s_waitcnt lgkmcnt(0)
    s_add_u32 m0, s56, 0
    s_add_u32 s58, s57, 49152
    s_and_b32 s58, s58, 0xffff
    s_lshl_b32 s58, s58, 5
    buffer_load_dwordx4 v200, s[52:55], s58 offen lds
    s_add_u32 m0, s56, 1024
    s_add_u32 s58, s57, 50176
    s_and_b32 s58, s58, 0xffff
    s_lshl_b32 s58, s58, 5
    buffer_load_dwordx4 v200, s[52:55], s58 offen lds
    s_add_u32 m0, s56, 2048
    s_add_u32 s58, s57, 51200
    s_and_b32 s58, s58, 0xffff
    s_lshl_b32 s58, s58, 5
    buffer_load_dwordx4 v200, s[52:55], s58 offen lds
    s_add_u32 m0, s56, 3072
    s_add_u32 s58, s57, 52224
    s_and_b32 s58, s58, 0xffff
    s_lshl_b32 s58, s58, 5
    buffer_load_dwordx4 v200, s[52:55], s58 offen lds
    s_add_u32 m0, s56, 4096
    s_add_u32 s58, s57, 53248
    s_and_b32 s58, s58, 0xffff
    s_lshl_b32 s58, s58, 5
    buffer_load_dwordx4 v200, s[52:55], s58 offen lds
    s_add_u32 m0, s56, 5120
    s_add_u32 s58, s57, 54272
    s_and_b32 s58, s58, 0xffff
    s_lshl_b32 s58, s58, 5
    buffer_load_dwordx4 v200, s[52:55], s58 offen lds
    s_add_u32 m0, s56, 6144
    s_add_u32 s58, s57, 55296
    s_and_b32 s58, s58, 0xffff
    s_lshl_b32 s58, s58, 5
    buffer_load_dwordx4 v200, s[52:55], s58 offen lds
    s_add_u32 m0, s56, 7168
    s_add_u32 s58, s57, 56320
    s_and_b32 s58, s58, 0xffff
    s_lshl_b32 s58, s58, 5
    buffer_load_dwordx4 v200, s[52:55], s58 offen lds
    s_add_u32 m0, s56, 8192
    s_add_u32 s58, s57, 57344
    s_and_b32 s58, s58, 0xffff
    s_lshl_b32 s58, s58, 5
    buffer_load_dwordx4 v200, s[52:55], s58 offen lds
    s_add_u32 m0, s56, 9216
    s_add_u32 s58, s57, 58368
    s_and_b32 s58, s58, 0xffff
    s_lshl_b32 s58, s58, 5
    buffer_load_dwordx4 v200, s[52:55], s58 offen lds
    s_add_u32 m0, s56, 10240
    s_add_u32 s58, s57, 59392
    s_and_b32 s58, s58, 0xffff
    s_lshl_b32 s58, s58, 5
    buffer_load_dwordx4 v200, s[52:55], s58 offen lds
    s_add_u32 m0, s56, 11264
    s_add_u32 s58, s57, 60416
    s_and_b32 s58, s58, 0xffff
    s_lshl_b32 s58, s58, 5
    buffer_load_dwordx4 v200, s[52:55], s58 offen lds
    s_add_u32 m0, s56, 12288
    s_add_u32 s58, s57, 61440
    s_and_b32 s58, s58, 0xffff
    s_lshl_b32 s58, s58, 5
    buffer_load_dwordx4 v200, s[52:55], s58 offen lds
    s_add_u32 m0, s56, 13312
    s_add_u32 s58, s57, 62464
    s_and_b32 s58, s58, 0xffff
    s_lshl_b32 s58, s58, 5
    buffer_load_dwordx4 v200, s[52:55], s58 offen lds
    s_add_u32 m0, s56, 14336
    s_add_u32 s58, s57, 63488
    s_and_b32 s58, s58, 0xffff
    s_lshl_b32 s58, s58, 5
    buffer_load_dwordx4 v200, s[52:55], s58 offen lds
    s_add_u32 m0, s56, 15360
    s_add_u32 s58, s57, 64512
    s_and_b32 s58, s58, 0xffff
    s_lshl_b32 s58, s58, 5
    buffer_load_dwordx4 v200, s[52:55], s58 offen lds
mega_kernel_wf2:
    s_sleep 8
    buffer_load_dword v2, off, s[88:91], 0 offset:136 sc1
    s_waitcnt vmcnt(0)
    v_cmp_ne_u32 vcc, 129, v2
    s_cbranch_vccnz mega_kernel_wf2
    s_barrier
    s_load_dwordx2 s[4:5], s[0:1], 80
    s_load_dwordx2 s[8:9], s[0:1], 96
    v_and_b32 v6, 7, v0
    v_lshrrev_b32 v7, 3, v0
    s_movk_i32 s13, 8448
    v_mul_lo_u32 v8, v6, s13
    v_lshl_add_u32 v4, v7, 3, v8
    v_lshlrev_b32 v5, 14, v7
    v_lshl_add_u32 v5, v6, 4, v5
    s_lshl_b32 s12, s92, 7
    s_add_u32 s12, s12, 109051904
    s_waitcnt lgkmcnt(0)
    s_mov_b32 s6, 8388608
    s_mov_b32 s7, 0x00020000
    s_mov_b32 s10, 268435456
    s_mov_b32 s11, 0x00020000
    s_add_u32 s13, s12, 0
    buffer_load_dwordx4 v[16:19], v5, s[8:11], s13 offen
    s_add_u32 s13, s12, 524288
    buffer_load_dwordx4 v[20:23], v5, s[8:11], s13 offen
    s_add_u32 s13, s12, 1048576
    buffer_load_dwordx4 v[24:27], v5, s[8:11], s13 offen
    s_add_u32 s13, s12, 1572864
    buffer_load_dwordx4 v[28:31], v5, s[8:11], s13 offen
    s_add_u32 s13, s12, 2097152
    buffer_load_dwordx4 v[32:35], v5, s[8:11], s13 offen
    s_add_u32 s13, s12, 2621440
    buffer_load_dwordx4 v[36:39], v5, s[8:11], s13 offen
    s_add_u32 s13, s12, 3145728
    buffer_load_dwordx4 v[40:43], v5, s[8:11], s13 offen
    s_add_u32 s13, s12, 3670016
    buffer_load_dwordx4 v[44:47], v5, s[8:11], s13 offen
    s_add_u32 s13, s12, 4194304
    buffer_load_dwordx4 v[48:51], v5, s[8:11], s13 offen
    s_add_u32 s13, s12, 4718592
    buffer_load_dwordx4 v[52:55], v5, s[8:11], s13 offen
    s_add_u32 s13, s12, 5242880
    buffer_load_dwordx4 v[56:59], v5, s[8:11], s13 offen
    s_add_u32 s13, s12, 5767168
    buffer_load_dwordx4 v[60:63], v5, s[8:11], s13 offen
    s_add_u32 s13, s12, 6291456
    buffer_load_dwordx4 v[64:67], v5, s[8:11], s13 offen
    s_add_u32 s13, s12, 6815744
    buffer_load_dwordx4 v[68:71], v5, s[8:11], s13 offen
    s_add_u32 s13, s12, 7340032
    buffer_load_dwordx4 v[72:75], v5, s[8:11], s13 offen
    s_add_u32 s13, s12, 7864320
    buffer_load_dwordx4 v[76:79], v5, s[8:11], s13 offen
    s_add_u32 s13, s12, 8388608
    buffer_load_dwordx4 v[80:83], v5, s[8:11], s13 offen
    s_waitcnt vmcnt(0)
    v_cmp_eq_u32 vcc, 0, v7
    s_nop 1
    v_mov_b32 v9, 0
    v_cndmask_b32 v17, v17, v9, vcc
    v_cndmask_b32 v19, v19, v9, vcc
    v_cndmask_b32 v81, v81, v9, vcc
    v_cndmask_b32 v83, v83, v9, vcc
    v_sub_u32 v6, 1024, v7
    v_and_b32 v6, 1023, v6
    v_lshl_add_u32 v6, v6, 3, v8
    v_sub_f32 v10, v16, v19
    v_add_f32 v11, v17, v18
    v_add_f32 v12, v16, v19
    v_sub_f32 v13, v18, v17
    ds_write_b64 v4, v[10:11] offset:0
    ds_write_b64 v6, v[12:13]
    v_sub_u32 v6, 992, v7
    v_and_b32 v6, 1023, v6
    v_lshl_add_u32 v6, v6, 3, v8
    v_sub_f32 v10, v20, v23
    v_add_f32 v11, v21, v22
    v_add_f32 v12, v20, v23
    v_sub_f32 v13, v22, v21
    ds_write_b64 v4, v[10:11] offset:256
    ds_write_b64 v6, v[12:13]
    v_sub_u32 v6, 960, v7
    v_and_b32 v6, 1023, v6
    v_lshl_add_u32 v6, v6, 3, v8
    v_sub_f32 v10, v24, v27
    v_add_f32 v11, v25, v26
    v_add_f32 v12, v24, v27
    v_sub_f32 v13, v26, v25
    ds_write_b64 v4, v[10:11] offset:512
    ds_write_b64 v6, v[12:13]
    v_sub_u32 v6, 928, v7
    v_and_b32 v6, 1023, v6
    v_lshl_add_u32 v6, v6, 3, v8
    v_sub_f32 v10, v28, v31
    v_add_f32 v11, v29, v30
    v_add_f32 v12, v28, v31
    v_sub_f32 v13, v30, v29
    ds_write_b64 v4, v[10:11] offset:768
    ds_write_b64 v6, v[12:13]
    v_sub_u32 v6, 896, v7
    v_and_b32 v6, 1023, v6
    v_lshl_add_u32 v6, v6, 3, v8
    v_sub_f32 v10, v32, v35
    v_add_f32 v11, v33, v34
    v_add_f32 v12, v32, v35
    v_sub_f32 v13, v34, v33
    ds_write_b64 v4, v[10:11] offset:1024
    ds_write_b64 v6, v[12:13]
    v_sub_u32 v6, 864, v7
    v_and_b32 v6, 1023, v6
    v_lshl_add_u32 v6, v6, 3, v8
    v_sub_f32 v10, v36, v39
    v_add_f32 v11, v37, v38
    v_add_f32 v12, v36, v39
    v_sub_f32 v13, v38, v37
    ds_write_b64 v4, v[10:11] offset:1280
    ds_write_b64 v6, v[12:13]
    v_sub_u32 v6, 832, v7
    v_and_b32 v6, 1023, v6
    v_lshl_add_u32 v6, v6, 3, v8
    v_sub_f32 v10, v40, v43
    v_add_f32 v11, v41, v42
    v_add_f32 v12, v40, v43
    v_sub_f32 v13, v42, v41
    ds_write_b64 v4, v[10:11] offset:1536
    ds_write_b64 v6, v[12:13]
    v_sub_u32 v6, 800, v7
    v_and_b32 v6, 1023, v6
    v_lshl_add_u32 v6, v6, 3, v8
    v_sub_f32 v10, v44, v47
    v_add_f32 v11, v45, v46
    v_add_f32 v12, v44, v47
    v_sub_f32 v13, v46, v45
    ds_write_b64 v4, v[10:11] offset:1792
    ds_write_b64 v6, v[12:13]
    v_sub_u32 v6, 768, v7
    v_and_b32 v6, 1023, v6
    v_lshl_add_u32 v6, v6, 3, v8
    v_sub_f32 v10, v48, v51
    v_add_f32 v11, v49, v50
    v_add_f32 v12, v48, v51
    v_sub_f32 v13, v50, v49
    ds_write_b64 v4, v[10:11] offset:2048
    ds_write_b64 v6, v[12:13]
    v_sub_u32 v6, 736, v7
    v_and_b32 v6, 1023, v6
    v_lshl_add_u32 v6, v6, 3, v8
    v_sub_f32 v10, v52, v55
    v_add_f32 v11, v53, v54
    v_add_f32 v12, v52, v55
    v_sub_f32 v13, v54, v53
    ds_write_b64 v4, v[10:11] offset:2304
    ds_write_b64 v6, v[12:13]
    v_sub_u32 v6, 704, v7
    v_and_b32 v6, 1023, v6
    v_lshl_add_u32 v6, v6, 3, v8
    v_sub_f32 v10, v56, v59
    v_add_f32 v11, v57, v58
    v_add_f32 v12, v56, v59
    v_sub_f32 v13, v58, v57
    ds_write_b64 v4, v[10:11] offset:2560
    ds_write_b64 v6, v[12:13]
    v_sub_u32 v6, 672, v7
    v_and_b32 v6, 1023, v6
    v_lshl_add_u32 v6, v6, 3, v8
    v_sub_f32 v10, v60, v63
    v_add_f32 v11, v61, v62
    v_add_f32 v12, v60, v63
    v_sub_f32 v13, v62, v61
    ds_write_b64 v4, v[10:11] offset:2816
    ds_write_b64 v6, v[12:13]
    v_sub_u32 v6, 640, v7
    v_and_b32 v6, 1023, v6
    v_lshl_add_u32 v6, v6, 3, v8
    v_sub_f32 v10, v64, v67
    v_add_f32 v11, v65, v66
    v_add_f32 v12, v64, v67
    v_sub_f32 v13, v66, v65
    ds_write_b64 v4, v[10:11] offset:3072
    ds_write_b64 v6, v[12:13]
    v_sub_u32 v6, 608, v7
    v_and_b32 v6, 1023, v6
    v_lshl_add_u32 v6, v6, 3, v8
    v_sub_f32 v10, v68, v71
    v_add_f32 v11, v69, v70
    v_add_f32 v12, v68, v71
    v_sub_f32 v13, v70, v69
    ds_write_b64 v4, v[10:11] offset:3328
    ds_write_b64 v6, v[12:13]
    v_sub_u32 v6, 576, v7
    v_and_b32 v6, 1023, v6
    v_lshl_add_u32 v6, v6, 3, v8
    v_sub_f32 v10, v72, v75
    v_add_f32 v11, v73, v74
    v_add_f32 v12, v72, v75
    v_sub_f32 v13, v74, v73
    ds_write_b64 v4, v[10:11] offset:3584
    ds_write_b64 v6, v[12:13]
    v_sub_u32 v6, 544, v7
    v_and_b32 v6, 1023, v6
    v_lshl_add_u32 v6, v6, 3, v8
    v_sub_f32 v10, v76, v79
    v_add_f32 v11, v77, v78
    v_add_f32 v12, v76, v79
    v_sub_f32 v13, v78, v77
    ds_write_b64 v4, v[10:11] offset:3840
    ds_write_b64 v6, v[12:13]
    s_and_saveexec_b64 s[14:15], vcc
    v_sub_u32 v6, 512, v7
    v_and_b32 v6, 1023, v6
    v_lshl_add_u32 v6, v6, 3, v8
    v_sub_f32 v10, v80, v83
    v_add_f32 v11, v81, v82
    v_add_f32 v12, v80, v83
    v_sub_f32 v13, v82, v81
    ds_write_b64 v4, v[10:11] offset:4096
    ds_write_b64 v6, v[12:13]
    s_mov_b64 exec, s[14:15]
    s_waitcnt lgkmcnt(0)
    s_barrier
    v_and_b32 v1, 31, v0
    v_lshrrev_b32 v2, 5, v0
    v_cvt_f32_u32 v3, v1
    s_movk_i32 s13, 8448
    v_mul_lo_u32 v7, v2, s13
    v_lshl_add_u32 v4, v1, 3, v7
    s_movk_i32 s13, 264
    v_mul_lo_u32 v5, v1, s13
    v_add_u32 v5, v5, v7
    ds_read_b32 v16, v4 offset:0
    ds_read_b32 v48, v4 offset:4
    ds_read_b32 v17, v4 offset:256
    ds_read_b32 v49, v4 offset:260
    ds_read_b32 v18, v4 offset:512
    ds_read_b32 v50, v4 offset:516
    ds_read_b32 v19, v4 offset:768
    ds_read_b32 v51, v4 offset:772
    ds_read_b32 v20, v4 offset:1024
    ds_read_b32 v52, v4 offset:1028
    ds_read_b32 v21, v4 offset:1280
    ds_read_b32 v53, v4 offset:1284
    ds_read_b32 v22, v4 offset:1536
    ds_read_b32 v54, v4 offset:1540
    s_waitcnt lgkmcnt(0)
    ds_read_b32 v23, v4 offset:1792
    ds_read_b32 v55, v4 offset:1796
    ds_read_b32 v24, v4 offset:2048
    ds_read_b32 v56, v4 offset:2052
    ds_read_b32 v25, v4 offset:2304
    ds_read_b32 v57, v4 offset:2308
    ds_read_b32 v26, v4 offset:2560
    ds_read_b32 v58, v4 offset:2564
    ds_read_b32 v27, v4 offset:2816
    ds_read_b32 v59, v4 offset:2820
    ds_read_b32 v28, v4 offset:3072
    ds_read_b32 v60, v4 offset:3076
    ds_read_b32 v29, v4 offset:3328
    ds_read_b32 v61, v4 offset:3332
    s_waitcnt lgkmcnt(0)
    ds_read_b32 v30, v4 offset:3584
    ds_read_b32 v62, v4 offset:3588
    ds_read_b32 v31, v4 offset:3840
    ds_read_b32 v63, v4 offset:3844
    ds_read_b32 v32, v4 offset:4096
    ds_read_b32 v64, v4 offset:4100
    ds_read_b32 v33, v4 offset:4352
    ds_read_b32 v65, v4 offset:4356
    ds_read_b32 v34, v4 offset:4608
    ds_read_b32 v66, v4 offset:4612
    ds_read_b32 v35, v4 offset:4864
    ds_read_b32 v67, v4 offset:4868
    ds_read_b32 v36, v4 offset:5120
    ds_read_b32 v68, v4 offset:5124
    s_waitcnt lgkmcnt(0)
    ds_read_b32 v37, v4 offset:5376
    ds_read_b32 v69, v4 offset:5380
    ds_read_b32 v38, v4 offset:5632
    ds_read_b32 v70, v4 offset:5636
    ds_read_b32 v39, v4 offset:5888
    ds_read_b32 v71, v4 offset:5892
    ds_read_b32 v40, v4 offset:6144
    ds_read_b32 v72, v4 offset:6148
    ds_read_b32 v41, v4 offset:6400
    ds_read_b32 v73, v4 offset:6404
    ds_read_b32 v42, v4 offset:6656
    ds_read_b32 v74, v4 offset:6660
    ds_read_b32 v43, v4 offset:6912
    ds_read_b32 v75, v4 offset:6916
    s_waitcnt lgkmcnt(0)
    ds_read_b32 v44, v4 offset:7168
    ds_read_b32 v76, v4 offset:7172
    ds_read_b32 v45, v4 offset:7424
    ds_read_b32 v77, v4 offset:7428
    ds_read_b32 v46, v4 offset:7680
    ds_read_b32 v78, v4 offset:7684
    ds_read_b32 v47, v4 offset:7936
    ds_read_b32 v79, v4 offset:7940
    s_waitcnt lgkmcnt(0)
    v_sub_f32 v80, v16, v32
    v_sub_f32 v81, v48, v64
    v_add_f32 v16, v16, v32
    v_add_f32 v48, v48, v64
    v_sub_f32 v32, v17, v33
    v_sub_f32 v64, v49, v65
    v_add_f32 v17, v17, v33
    v_add_f32 v49, v49, v65
    v_mul_f32 v33, 0x3f7b14be, v32
    v_mul_f32 v65, 0x3e47c5c2, v32
    v_fmac_f32 v33, 0xbe47c5c2, v64
    v_fmac_f32 v65, 0x3f7b14be, v64
    v_sub_f32 v32, v18, v34
    v_sub_f32 v64, v50, v66
    v_add_f32 v18, v18, v34
    v_add_f32 v50, v50, v66
    v_mul_f32 v34, 0x3f6c835e, v32
    v_mul_f32 v66, 0x3ec3ef15, v32
    v_fmac_f32 v34, 0xbec3ef15, v64
    v_fmac_f32 v66, 0x3f6c835e, v64
    v_sub_f32 v32, v19, v35
    v_sub_f32 v64, v51, v67
    v_add_f32 v19, v19, v35
    v_add_f32 v51, v51, v67
    v_mul_f32 v35, 0x3f54db31, v32
    v_mul_f32 v67, 0x3f0e39da, v32
    v_fmac_f32 v35, 0xbf0e39da, v64
    v_fmac_f32 v67, 0x3f54db31, v64
    v_sub_f32 v32, v20, v36
    v_sub_f32 v64, v52, v68
    v_add_f32 v20, v20, v36
    v_add_f32 v52, v52, v68
    v_mul_f32 v36, 0x3f3504f3, v32
    v_mul_f32 v68, 0x3f3504f3, v32
    v_fmac_f32 v36, 0xbf3504f3, v64
    v_fmac_f32 v68, 0x3f3504f3, v64
    v_sub_f32 v32, v21, v37
    v_sub_f32 v64, v53, v69
    v_add_f32 v21, v21, v37
    v_add_f32 v53, v53, v69
    v_mul_f32 v37, 0x3f0e39da, v32
    v_mul_f32 v69, 0x3f54db31, v32
    v_fmac_f32 v37, 0xbf54db31, v64
    v_fmac_f32 v69, 0x3f0e39da, v64
    v_sub_f32 v32, v22, v38
    v_sub_f32 v64, v54, v70
    v_add_f32 v22, v22, v38
    v_add_f32 v54, v54, v70
    v_mul_f32 v38, 0x3ec3ef15, v32
    v_mul_f32 v70, 0x3f6c835e, v32
    v_fmac_f32 v38, 0xbf6c835e, v64
    v_fmac_f32 v70, 0x3ec3ef15, v64
    v_sub_f32 v32, v23, v39
    v_sub_f32 v64, v55, v71
    v_add_f32 v23, v23, v39
    v_add_f32 v55, v55, v71
    v_mul_f32 v39, 0x3e47c5c2, v32
    v_mul_f32 v71, 0x3f7b14be, v32
    v_fmac_f32 v39, 0xbf7b14be, v64
    v_fmac_f32 v71, 0x3e47c5c2, v64
    v_sub_f32 v32, v72, v56
    v_sub_f32 v64, v24, v40
    v_add_f32 v24, v24, v40
    v_add_f32 v56, v56, v72
    v_sub_f32 v40, v25, v41
    v_sub_f32 v72, v57, v73
    v_add_f32 v25, v25, v41
    v_add_f32 v57, v57, v73
    v_mul_f32 v41, 0xbe47c5c2, v40
    v_mul_f32 v73, 0x3f7b14be, v40
    v_fmac_f32 v41, 0xbf7b14be, v72
    v_fmac_f32 v73, 0xbe47c5c2, v72
    v_sub_f32 v40, v26, v42
    v_sub_f32 v72, v58, v74
    v_add_f32 v26, v26, v42
    v_add_f32 v58, v58, v74
    v_mul_f32 v42, 0xbec3ef15, v40
    v_mul_f32 v74, 0x3f6c835e, v40
    v_fmac_f32 v42, 0xbf6c835e, v72
    v_fmac_f32 v74, 0xbec3ef15, v72
    v_sub_f32 v40, v27, v43
    v_sub_f32 v72, v59, v75
    v_add_f32 v27, v27, v43
    v_add_f32 v59, v59, v75
    v_mul_f32 v43, 0xbf0e39da, v40
    v_mul_f32 v75, 0x3f54db31, v40
    v_fmac_f32 v43, 0xbf54db31, v72
    v_fmac_f32 v75, 0xbf0e39da, v72
    v_sub_f32 v40, v28, v44
    v_sub_f32 v72, v60, v76
    v_add_f32 v28, v28, v44
    v_add_f32 v60, v60, v76
    v_mul_f32 v44, 0xbf3504f3, v40
    v_mul_f32 v76, 0x3f3504f3, v40
    v_fmac_f32 v44, 0xbf3504f3, v72
    v_fmac_f32 v76, 0xbf3504f3, v72
    v_sub_f32 v40, v29, v45
    v_sub_f32 v72, v61, v77
    v_add_f32 v29, v29, v45
    v_add_f32 v61, v61, v77
    v_mul_f32 v45, 0xbf54db31, v40
    v_mul_f32 v77, 0x3f0e39da, v40
    v_fmac_f32 v45, 0xbf0e39da, v72
    v_fmac_f32 v77, 0xbf54db31, v72
    v_sub_f32 v40, v30, v46
    v_sub_f32 v72, v62, v78
    v_add_f32 v30, v30, v46
    v_add_f32 v62, v62, v78
    v_mul_f32 v46, 0xbf6c835e, v40
    v_mul_f32 v78, 0x3ec3ef15, v40
    v_fmac_f32 v46, 0xbec3ef15, v72
    v_fmac_f32 v78, 0xbf6c835e, v72
    v_sub_f32 v40, v31, v47
    v_sub_f32 v72, v63, v79
    v_add_f32 v31, v31, v47
    v_add_f32 v63, v63, v79
    v_mul_f32 v47, 0xbf7b14be, v40
    v_mul_f32 v79, 0x3e47c5c2, v40
    v_fmac_f32 v47, 0xbe47c5c2, v72
    v_fmac_f32 v79, 0xbf7b14be, v72
    v_sub_f32 v40, v16, v24
    v_sub_f32 v72, v48, v56
    v_add_f32 v16, v16, v24
    v_add_f32 v48, v48, v56
    v_sub_f32 v24, v17, v25
    v_sub_f32 v56, v49, v57
    v_add_f32 v17, v17, v25
    v_add_f32 v49, v49, v57
    v_mul_f32 v25, 0x3f6c835e, v24
    v_mul_f32 v57, 0x3ec3ef15, v24
    v_fmac_f32 v25, 0xbec3ef15, v56
    v_fmac_f32 v57, 0x3f6c835e, v56
    v_sub_f32 v24, v18, v26
    v_sub_f32 v56, v50, v58
    v_add_f32 v18, v18, v26
    v_add_f32 v50, v50, v58
    v_mul_f32 v26, 0x3f3504f3, v24
    v_mul_f32 v58, 0x3f3504f3, v24
    v_fmac_f32 v26, 0xbf3504f3, v56
    v_fmac_f32 v58, 0x3f3504f3, v56
    v_sub_f32 v24, v19, v27
    v_sub_f32 v56, v51, v59
    v_add_f32 v19, v19, v27
    v_add_f32 v51, v51, v59
    v_mul_f32 v27, 0x3ec3ef15, v24
    v_mul_f32 v59, 0x3f6c835e, v24
    v_fmac_f32 v27, 0xbf6c835e, v56
    v_fmac_f32 v59, 0x3ec3ef15, v56
    v_sub_f32 v24, v60, v52
    v_sub_f32 v56, v20, v28
    v_add_f32 v20, v20, v28
    v_add_f32 v52, v52, v60
    v_sub_f32 v28, v21, v29
    v_sub_f32 v60, v53, v61
    v_add_f32 v21, v21, v29
    v_add_f32 v53, v53, v61
    v_mul_f32 v29, 0xbec3ef15, v28
    v_mul_f32 v61, 0x3f6c835e, v28
    v_fmac_f32 v29, 0xbf6c835e, v60
    v_fmac_f32 v61, 0xbec3ef15, v60
    v_sub_f32 v28, v22, v30
    v_sub_f32 v60, v54, v62
    v_add_f32 v22, v22, v30
    v_add_f32 v54, v54, v62
    v_mul_f32 v30, 0xbf3504f3, v28
    v_mul_f32 v62, 0x3f3504f3, v28
    v_fmac_f32 v30, 0xbf3504f3, v60
    v_fmac_f32 v62, 0xbf3504f3, v60
    v_sub_f32 v28, v23, v31
    v_sub_f32 v60, v55, v63
    v_add_f32 v23, v23, v31
    v_add_f32 v55, v55, v63
    v_mul_f32 v31, 0xbf6c835e, v28
    v_mul_f32 v63, 0x3ec3ef15, v28
    v_fmac_f32 v31, 0xbec3ef15, v60
    v_fmac_f32 v63, 0xbf6c835e, v60
    v_sub_f32 v28, v80, v32
    v_sub_f32 v60, v81, v64
    v_add_f32 v80, v80, v32
    v_add_f32 v81, v81, v64
    v_sub_f32 v32, v33, v41
    v_sub_f32 v64, v65, v73
    v_add_f32 v33, v33, v41
    v_add_f32 v65, v65, v73
    v_mul_f32 v41, 0x3f6c835e, v32
    v_mul_f32 v73, 0x3ec3ef15, v32
    v_fmac_f32 v41, 0xbec3ef15, v64
    v_fmac_f32 v73, 0x3f6c835e, v64
    v_sub_f32 v32, v34, v42
    v_sub_f32 v64, v66, v74
    v_add_f32 v34, v34, v42
    v_add_f32 v66, v66, v74
    v_mul_f32 v42, 0x3f3504f3, v32
    v_mul_f32 v74, 0x3f3504f3, v32
    v_fmac_f32 v42, 0xbf3504f3, v64
    v_fmac_f32 v74, 0x3f3504f3, v64
    v_sub_f32 v32, v35, v43
    v_sub_f32 v64, v67, v75
    v_add_f32 v35, v35, v43
    v_add_f32 v67, v67, v75
    v_mul_f32 v43, 0x3ec3ef15, v32
    v_mul_f32 v75, 0x3f6c835e, v32
    v_fmac_f32 v43, 0xbf6c835e, v64
    v_fmac_f32 v75, 0x3ec3ef15, v64
    v_sub_f32 v32, v76, v68
    v_sub_f32 v64, v36, v44
    v_add_f32 v36, v36, v44
    v_add_f32 v68, v68, v76
    v_sub_f32 v44, v37, v45
    v_sub_f32 v76, v69, v77
    v_add_f32 v37, v37, v45
    v_add_f32 v69, v69, v77
    v_mul_f32 v45, 0xbec3ef15, v44
    v_mul_f32 v77, 0x3f6c835e, v44
    v_fmac_f32 v45, 0xbf6c835e, v76
    v_fmac_f32 v77, 0xbec3ef15, v76
    v_sub_f32 v44, v38, v46
    v_sub_f32 v76, v70, v78
    v_add_f32 v38, v38, v46
    v_add_f32 v70, v70, v78
    v_mul_f32 v46, 0xbf3504f3, v44
    v_mul_f32 v78, 0x3f3504f3, v44
    v_fmac_f32 v46, 0xbf3504f3, v76
    v_fmac_f32 v78, 0xbf3504f3, v76
    v_sub_f32 v44, v39, v47
    v_sub_f32 v76, v71, v79
    v_add_f32 v39, v39, v47
    v_add_f32 v71, v71, v79
    v_mul_f32 v47, 0xbf6c835e, v44
    v_mul_f32 v79, 0x3ec3ef15, v44
    v_fmac_f32 v47, 0xbec3ef15, v76
    v_fmac_f32 v79, 0xbf6c835e, v76
    v_sub_f32 v44, v16, v20
    v_sub_f32 v76, v48, v52
    v_add_f32 v16, v16, v20
    v_add_f32 v48, v48, v52
    v_sub_f32 v20, v17, v21
    v_sub_f32 v52, v49, v53
    v_add_f32 v17, v17, v21
    v_add_f32 v49, v49, v53
    v_mul_f32 v21, 0x3f3504f3, v20
    v_mul_f32 v53, 0x3f3504f3, v20
    v_fmac_f32 v21, 0xbf3504f3, v52
    v_fmac_f32 v53, 0x3f3504f3, v52
    v_sub_f32 v20, v54, v50
    v_sub_f32 v52, v18, v22
    v_add_f32 v18, v18, v22
    v_add_f32 v50, v50, v54
    v_sub_f32 v22, v19, v23
    v_sub_f32 v54, v51, v55
    v_add_f32 v19, v19, v23
    v_add_f32 v51, v51, v55
    v_mul_f32 v23, 0xbf3504f3, v22
    v_mul_f32 v55, 0x3f3504f3, v22
    v_fmac_f32 v23, 0xbf3504f3, v54
    v_fmac_f32 v55, 0xbf3504f3, v54
    v_sub_f32 v22, v40, v24
    v_sub_f32 v54, v72, v56
    v_add_f32 v40, v40, v24
    v_add_f32 v72, v72, v56
    v_sub_f32 v24, v25, v29
    v_sub_f32 v56, v57, v61
    v_add_f32 v25, v25, v29
    v_add_f32 v57, v57, v61
    v_mul_f32 v29, 0x3f3504f3, v24
    v_mul_f32 v61, 0x3f3504f3, v24
    v_fmac_f32 v29, 0xbf3504f3, v56
    v_fmac_f32 v61, 0x3f3504f3, v56
    v_sub_f32 v24, v62, v58
    v_sub_f32 v56, v26, v30
    v_add_f32 v26, v26, v30
    v_add_f32 v58, v58, v62
    v_sub_f32 v30, v27, v31
    v_sub_f32 v62, v59, v63
    v_add_f32 v27, v27, v31
    v_add_f32 v59, v59, v63
    v_mul_f32 v31, 0xbf3504f3, v30
    v_mul_f32 v63, 0x3f3504f3, v30
    v_fmac_f32 v31, 0xbf3504f3, v62
    v_fmac_f32 v63, 0xbf3504f3, v62
    v_sub_f32 v30, v80, v36
    v_sub_f32 v62, v81, v68
    v_add_f32 v80, v80, v36
    v_add_f32 v81, v81, v68
    v_sub_f32 v36, v33, v37
    v_sub_f32 v68, v65, v69
    v_add_f32 v33, v33, v37
    v_add_f32 v65, v65, v69
    v_mul_f32 v37, 0x3f3504f3, v36
    v_mul_f32 v69, 0x3f3504f3, v36
    v_fmac_f32 v37, 0xbf3504f3, v68
    v_fmac_f32 v69, 0x3f3504f3, v68
    v_sub_f32 v36, v70, v66
    v_sub_f32 v68, v34, v38
    v_add_f32 v34, v34, v38
    v_add_f32 v66, v66, v70
    v_sub_f32 v38, v35, v39
    v_sub_f32 v70, v67, v71
    v_add_f32 v35, v35, v39
    v_add_f32 v67, v67, v71
    v_mul_f32 v39, 0xbf3504f3, v38
    v_mul_f32 v71, 0x3f3504f3, v38
    v_fmac_f32 v39, 0xbf3504f3, v70
    v_fmac_f32 v71, 0xbf3504f3, v70
    v_sub_f32 v38, v28, v32
    v_sub_f32 v70, v60, v64
    v_add_f32 v28, v28, v32
    v_add_f32 v60, v60, v64
    v_sub_f32 v32, v41, v45
    v_sub_f32 v64, v73, v77
    v_add_f32 v41, v41, v45
    v_add_f32 v73, v73, v77
    v_mul_f32 v45, 0x3f3504f3, v32
    v_mul_f32 v77, 0x3f3504f3, v32
    v_fmac_f32 v45, 0xbf3504f3, v64
    v_fmac_f32 v77, 0x3f3504f3, v64
    v_sub_f32 v32, v78, v74
    v_sub_f32 v64, v42, v46
    v_add_f32 v42, v42, v46
    v_add_f32 v74, v74, v78
    v_sub_f32 v46, v43, v47
    v_sub_f32 v78, v75, v79
    v_add_f32 v43, v43, v47
    v_add_f32 v75, v75, v79
    v_mul_f32 v47, 0xbf3504f3, v46
    v_mul_f32 v79, 0x3f3504f3, v46
    v_fmac_f32 v47, 0xbf3504f3, v78
    v_fmac_f32 v79, 0xbf3504f3, v78
    v_sub_f32 v46, v16, v18
    v_sub_f32 v78, v48, v50
    v_add_f32 v16, v16, v18
    v_add_f32 v48, v48, v50
    v_sub_f32 v18, v51, v49
    v_sub_f32 v50, v17, v19
    v_add_f32 v17, v17, v19
    v_add_f32 v49, v49, v51
    v_sub_f32 v19, v44, v20
    v_sub_f32 v51, v76, v52
    v_add_f32 v44, v44, v20
    v_add_f32 v76, v76, v52
    v_sub_f32 v20, v55, v53
    v_sub_f32 v52, v21, v23
    v_add_f32 v21, v21, v23
    v_add_f32 v53, v53, v55
    v_sub_f32 v23, v40, v26
    v_sub_f32 v55, v72, v58
    v_add_f32 v40, v40, v26
    v_add_f32 v72, v72, v58
    v_sub_f32 v26, v59, v57
    v_sub_f32 v58, v25, v27
    v_add_f32 v25, v25, v27
    v_add_f32 v57, v57, v59
    v_sub_f32 v27, v22, v24
    v_sub_f32 v59, v54, v56
    v_add_f32 v22, v22, v24
    v_add_f32 v54, v54, v56
    v_sub_f32 v24, v63, v61
    v_sub_f32 v56, v29, v31
    v_add_f32 v29, v29, v31
    v_add_f32 v61, v61, v63
    v_sub_f32 v31, v80, v34
    v_sub_f32 v63, v81, v66
    v_add_f32 v80, v80, v34
    v_add_f32 v81, v81, v66
    v_sub_f32 v34, v67, v65
    v_sub_f32 v66, v33, v35
    v_add_f32 v33, v33, v35
    v_add_f32 v65, v65, v67
    v_sub_f32 v35, v30, v36
    v_sub_f32 v67, v62, v68
    v_add_f32 v30, v30, v36
    v_add_f32 v62, v62, v68
    v_sub_f32 v36, v71, v69
    v_sub_f32 v68, v37, v39
    v_add_f32 v37, v37, v39
    v_add_f32 v69, v69, v71
    v_sub_f32 v39, v28, v42
    v_sub_f32 v71, v60, v74
    v_add_f32 v28, v28, v42
    v_add_f32 v60, v60, v74
    v_sub_f32 v42, v75, v73
    v_sub_f32 v74, v41, v43
    v_add_f32 v41, v41, v43
    v_add_f32 v73, v73, v75
    v_sub_f32 v43, v38, v32
    v_sub_f32 v75, v70, v64
    v_add_f32 v38, v38, v32
    v_add_f32 v70, v70, v64
    v_sub_f32 v32, v79, v77
    v_sub_f32 v64, v45, v47
    v_add_f32 v45, v45, v47
    v_add_f32 v77, v77, v79
    v_sub_f32 v47, v16, v17
    v_sub_f32 v79, v48, v49
    v_add_f32 v16, v16, v17
    v_add_f32 v48, v48, v49
    v_sub_f32 v17, v46, v18
    v_sub_f32 v49, v78, v50
    v_add_f32 v46, v46, v18
    v_add_f32 v78, v78, v50
    v_sub_f32 v18, v44, v21
    v_sub_f32 v50, v76, v53
    v_add_f32 v44, v44, v21
    v_add_f32 v76, v76, v53
    v_sub_f32 v21, v19, v20
    v_sub_f32 v53, v51, v52
    v_add_f32 v19, v19, v20
    v_add_f32 v51, v51, v52
    v_sub_f32 v20, v40, v25
    v_sub_f32 v52, v72, v57
    v_add_f32 v40, v40, v25
    v_add_f32 v72, v72, v57
    v_sub_f32 v25, v23, v26
    v_sub_f32 v57, v55, v58
    v_add_f32 v23, v23, v26
    v_add_f32 v55, v55, v58
    v_sub_f32 v26, v22, v29
    v_sub_f32 v58, v54, v61
    v_add_f32 v22, v22, v29
    v_add_f32 v54, v54, v61
    v_sub_f32 v29, v27, v24
    v_sub_f32 v61, v59, v56
    v_add_f32 v27, v27, v24
    v_add_f32 v59, v59, v56
    v_sub_f32 v24, v80, v33
    v_sub_f32 v56, v81, v65
    v_add_f32 v80, v80, v33
    v_add_f32 v81, v81, v65
    v_sub_f32 v33, v31, v34
    v_sub_f32 v65, v63, v66
    v_add_f32 v31, v31, v34
    v_add_f32 v63, v63, v66
    v_sub_f32 v34, v30, v37
    v_sub_f32 v66, v62, v69
    v_add_f32 v30, v30, v37
    v_add_f32 v62, v62, v69
    v_sub_f32 v37, v35, v36
    v_sub_f32 v69, v67, v68
    v_add_f32 v35, v35, v36
    v_add_f32 v67, v67, v68
    v_sub_f32 v36, v28, v41
    v_sub_f32 v68, v60, v73
    v_add_f32 v28, v28, v41
    v_add_f32 v60, v60, v73
    v_sub_f32 v41, v39, v42
    v_sub_f32 v73, v71, v74
    v_add_f32 v39, v39, v42
    v_add_f32 v71, v71, v74
    v_sub_f32 v42, v38, v45
    v_sub_f32 v74, v70, v77
    v_add_f32 v38, v38, v45
    v_add_f32 v70, v70, v77
    v_sub_f32 v45, v43, v32
    v_sub_f32 v77, v75, v64
    v_add_f32 v43, v43, v32
    v_add_f32 v75, v75, v64
    v_mul_f32 v32, 0x3a800000, v3
    v_cos_f32 v64, v32
    v_sin_f32 v82, v32
    s_nop 0
    v_mul_f32 v83, v80, v64
    v_fma_f32 v83, -v81, v82, v83
    v_mul_f32 v81, v81, v64
    v_fmac_f32 v81, v80, v82
    v_mul_f32 v32, 0x3b000000, v3
    v_cos_f32 v64, v32
    v_sin_f32 v82, v32
    s_nop 0
    v_mul_f32 v80, v40, v64
    v_fma_f32 v80, -v72, v82, v80
    v_mul_f32 v72, v72, v64
    v_fmac_f32 v72, v40, v82
    v_mul_f32 v32, 0x3b400000, v3
    v_cos_f32 v64, v32
    v_sin_f32 v82, v32
    s_nop 0
    v_mul_f32 v40, v28, v64
    v_fma_f32 v40, -v60, v82, v40
    v_mul_f32 v60, v60, v64
    v_fmac_f32 v60, v28, v82
    v_mul_f32 v32, 0x3b800000, v3
    v_cos_f32 v64, v32
    v_sin_f32 v82, v32
    s_nop 0
    v_mul_f32 v28, v44, v64
    v_fma_f32 v28, -v76, v82, v28
    v_mul_f32 v76, v76, v64
    v_fmac_f32 v76, v44, v82
    v_mul_f32 v32, 0x3ba00000, v3
    v_cos_f32 v64, v32
    v_sin_f32 v82, v32
    s_nop 0
    v_mul_f32 v44, v30, v64
    v_fma_f32 v44, -v62, v82, v44
    v_mul_f32 v62, v62, v64
    v_fmac_f32 v62, v30, v82
    v_mul_f32 v32, 0x3bc00000, v3
    v_cos_f32 v64, v32
    v_sin_f32 v82, v32
    s_nop 0
    v_mul_f32 v30, v22, v64
    v_fma_f32 v30, -v54, v82, v30
    v_mul_f32 v54, v54, v64
    v_fmac_f32 v54, v22, v82
    v_mul_f32 v32, 0x3be00000, v3
    v_cos_f32 v64, v32
    v_sin_f32 v82, v32
    s_nop 0
    v_mul_f32 v22, v38, v64
    v_fma_f32 v22, -v70, v82, v22
    v_mul_f32 v70, v70, v64
    v_fmac_f32 v70, v38, v82
    v_mul_f32 v32, 0x3c000000, v3
    v_cos_f32 v64, v32
    v_sin_f32 v82, v32
    s_nop 0
    v_mul_f32 v38, v46, v64
    v_fma_f32 v38, -v78, v82, v38
    v_mul_f32 v78, v78, v64
    v_fmac_f32 v78, v46, v82
    v_mul_f32 v32, 0x3c100000, v3
    v_cos_f32 v64, v32
    v_sin_f32 v82, v32
    s_nop 0
    v_mul_f32 v46, v31, v64
    v_fma_f32 v46, -v63, v82, v46
    v_mul_f32 v63, v63, v64
    v_fmac_f32 v63, v31, v82
    v_mul_f32 v32, 0x3c200000, v3
    v_cos_f32 v64, v32
    v_sin_f32 v82, v32
    s_nop 0
    v_mul_f32 v31, v23, v64
    v_fma_f32 v31, -v55, v82, v31
    v_mul_f32 v55, v55, v64
    v_fmac_f32 v55, v23, v82
    v_mul_f32 v32, 0x3c300000, v3
    v_cos_f32 v64, v32
    v_sin_f32 v82, v32
    s_nop 0
    v_mul_f32 v23, v39, v64
    v_fma_f32 v23, -v71, v82, v23
    v_mul_f32 v71, v71, v64
    v_fmac_f32 v71, v39, v82
    v_mul_f32 v32, 0x3c400000, v3
    v_cos_f32 v64, v32
    v_sin_f32 v82, v32
    s_nop 0
    v_mul_f32 v39, v19, v64
    v_fma_f32 v39, -v51, v82, v39
    v_mul_f32 v51, v51, v64
    v_fmac_f32 v51, v19, v82
    v_mul_f32 v32, 0x3c500000, v3
    v_cos_f32 v64, v32
    v_sin_f32 v82, v32
    s_nop 0
    v_mul_f32 v19, v35, v64
    v_fma_f32 v19, -v67, v82, v19
    v_mul_f32 v67, v67, v64
    v_fmac_f32 v67, v35, v82
    v_mul_f32 v32, 0x3c600000, v3
    v_cos_f32 v64, v32
    v_sin_f32 v82, v32
    s_nop 0
    v_mul_f32 v35, v27, v64
    v_fma_f32 v35, -v59, v82, v35
    v_mul_f32 v59, v59, v64
    v_fmac_f32 v59, v27, v82
    v_mul_f32 v32, 0x3c700000, v3
    v_cos_f32 v64, v32
    v_sin_f32 v82, v32
    s_nop 0
    v_mul_f32 v27, v43, v64
    v_fma_f32 v27, -v75, v82, v27
    v_mul_f32 v75, v75, v64
    v_fmac_f32 v75, v43, v82
    v_mul_f32 v32, 0x3c800000, v3
    v_cos_f32 v64, v32
    v_sin_f32 v82, v32
    s_nop 0
    v_mul_f32 v43, v47, v64
    v_fma_f32 v43, -v79, v82, v43
    v_mul_f32 v79, v79, v64
    v_fmac_f32 v79, v47, v82
    v_mul_f32 v32, 0x3c880000, v3
    v_cos_f32 v64, v32
    v_sin_f32 v82, v32
    s_nop 0
    v_mul_f32 v47, v24, v64
    v_fma_f32 v47, -v56, v82, v47
    v_mul_f32 v56, v56, v64
    v_fmac_f32 v56, v24, v82
    v_mul_f32 v32, 0x3c900000, v3
    v_cos_f32 v64, v32
    v_sin_f32 v82, v32
    s_nop 0
    v_mul_f32 v24, v20, v64
    v_fma_f32 v24, -v52, v82, v24
    v_mul_f32 v52, v52, v64
    v_fmac_f32 v52, v20, v82
    v_mul_f32 v32, 0x3c980000, v3
    v_cos_f32 v64, v32
    v_sin_f32 v82, v32
    s_nop 0
    v_mul_f32 v20, v36, v64
    v_fma_f32 v20, -v68, v82, v20
    v_mul_f32 v68, v68, v64
    v_fmac_f32 v68, v36, v82
    v_mul_f32 v32, 0x3ca00000, v3
    v_cos_f32 v64, v32
    v_sin_f32 v82, v32
    s_nop 0
    v_mul_f32 v36, v18, v64
    v_fma_f32 v36, -v50, v82, v36
    v_mul_f32 v50, v50, v64
    v_fmac_f32 v50, v18, v82
    v_mul_f32 v32, 0x3ca80000, v3
    v_cos_f32 v64, v32
    v_sin_f32 v82, v32
    s_nop 0
    v_mul_f32 v18, v34, v64
    v_fma_f32 v18, -v66, v82, v18
    v_mul_f32 v66, v66, v64
    v_fmac_f32 v66, v34, v82
    v_mul_f32 v32, 0x3cb00000, v3
    v_cos_f32 v64, v32
    v_sin_f32 v82, v32
    s_nop 0
    v_mul_f32 v34, v26, v64
    v_fma_f32 v34, -v58, v82, v34
    v_mul_f32 v58, v58, v64
    v_fmac_f32 v58, v26, v82
    v_mul_f32 v32, 0x3cb80000, v3
    v_cos_f32 v64, v32
    v_sin_f32 v82, v32
    s_nop 0
    v_mul_f32 v26, v42, v64
    v_fma_f32 v26, -v74, v82, v26
    v_mul_f32 v74, v74, v64
    v_fmac_f32 v74, v42, v82
    v_mul_f32 v32, 0x3cc00000, v3
    v_cos_f32 v64, v32
    v_sin_f32 v82, v32
    s_nop 0
    v_mul_f32 v42, v17, v64
    v_fma_f32 v42, -v49, v82, v42
    v_mul_f32 v49, v49, v64
    v_fmac_f32 v49, v17, v82
    v_mul_f32 v32, 0x3cc80000, v3
    v_cos_f32 v64, v32
    v_sin_f32 v82, v32
    s_nop 0
    v_mul_f32 v17, v33, v64
    v_fma_f32 v17, -v65, v82, v17
    v_mul_f32 v65, v65, v64
    v_fmac_f32 v65, v33, v82
    v_mul_f32 v32, 0x3cd00000, v3
    v_cos_f32 v64, v32
    v_sin_f32 v82, v32
    s_nop 0
    v_mul_f32 v33, v25, v64
    v_fma_f32 v33, -v57, v82, v33
    v_mul_f32 v57, v57, v64
    v_fmac_f32 v57, v25, v82
    v_mul_f32 v32, 0x3cd80000, v3
    v_cos_f32 v64, v32
    v_sin_f32 v82, v32
    s_nop 0
    v_mul_f32 v25, v41, v64
    v_fma_f32 v25, -v73, v82, v25
    v_mul_f32 v73, v73, v64
    v_fmac_f32 v73, v41, v82
    v_mul_f32 v32, 0x3ce00000, v3
    v_cos_f32 v64, v32
    v_sin_f32 v82, v32
    s_nop 0
    v_mul_f32 v41, v21, v64
    v_fma_f32 v41, -v53, v82, v41
    v_mul_f32 v53, v53, v64
    v_fmac_f32 v53, v21, v82
    v_mul_f32 v32, 0x3ce80000, v3
    v_cos_f32 v64, v32
    v_sin_f32 v82, v32
    s_nop 0
    v_mul_f32 v21, v37, v64
    v_fma_f32 v21, -v69, v82, v21
    v_mul_f32 v69, v69, v64
    v_fmac_f32 v69, v37, v82
    v_mul_f32 v32, 0x3cf00000, v3
    v_cos_f32 v64, v32
    v_sin_f32 v82, v32
    s_nop 0
    v_mul_f32 v37, v29, v64
    v_fma_f32 v37, -v61, v82, v37
    v_mul_f32 v61, v61, v64
    v_fmac_f32 v61, v29, v82
    v_mul_f32 v32, 0x3cf80000, v3
    v_cos_f32 v64, v32
    v_sin_f32 v82, v32
    s_nop 0
    v_mul_f32 v29, v45, v64
    v_fma_f32 v29, -v77, v82, v29
    v_mul_f32 v77, v77, v64
    v_fmac_f32 v77, v45, v82
    ds_write_b32 v4, v16 offset:0
    ds_write_b32 v4, v48 offset:4
    ds_write_b32 v4, v83 offset:264
    ds_write_b32 v4, v81 offset:268
    ds_write_b32 v4, v80 offset:528
    ds_write_b32 v4, v72 offset:532
    ds_write_b32 v4, v40 offset:792
    ds_write_b32 v4, v60 offset:796
    ds_write_b32 v4, v28 offset:1056
    ds_write_b32 v4, v76 offset:1060
    ds_write_b32 v4, v44 offset:1320
    ds_write_b32 v4, v62 offset:1324
    ds_write_b32 v4, v30 offset:1584
    ds_write_b32 v4, v54 offset:1588
    ds_write_b32 v4, v22 offset:1848
    ds_write_b32 v4, v70 offset:1852
    ds_write_b32 v4, v38 offset:2112
    ds_write_b32 v4, v78 offset:2116
    ds_write_b32 v4, v46 offset:2376
    ds_write_b32 v4, v63 offset:2380
    ds_write_b32 v4, v31 offset:2640
    ds_write_b32 v4, v55 offset:2644
    ds_write_b32 v4, v23 offset:2904
    ds_write_b32 v4, v71 offset:2908
    ds_write_b32 v4, v39 offset:3168
    ds_write_b32 v4, v51 offset:3172
    ds_write_b32 v4, v19 offset:3432
    ds_write_b32 v4, v67 offset:3436
    ds_write_b32 v4, v35 offset:3696
    ds_write_b32 v4, v59 offset:3700
    ds_write_b32 v4, v27 offset:3960
    ds_write_b32 v4, v75 offset:3964
    ds_write_b32 v4, v43 offset:4224
    ds_write_b32 v4, v79 offset:4228
    ds_write_b32 v4, v47 offset:4488
    ds_write_b32 v4, v56 offset:4492
    ds_write_b32 v4, v24 offset:4752
    ds_write_b32 v4, v52 offset:4756
    ds_write_b32 v4, v20 offset:5016
    ds_write_b32 v4, v68 offset:5020
    ds_write_b32 v4, v36 offset:5280
    ds_write_b32 v4, v50 offset:5284
    ds_write_b32 v4, v18 offset:5544
    ds_write_b32 v4, v66 offset:5548
    ds_write_b32 v4, v34 offset:5808
    ds_write_b32 v4, v58 offset:5812
    ds_write_b32 v4, v26 offset:6072
    ds_write_b32 v4, v74 offset:6076
    ds_write_b32 v4, v42 offset:6336
    ds_write_b32 v4, v49 offset:6340
    ds_write_b32 v4, v17 offset:6600
    ds_write_b32 v4, v65 offset:6604
    ds_write_b32 v4, v33 offset:6864
    ds_write_b32 v4, v57 offset:6868
    ds_write_b32 v4, v25 offset:7128
    ds_write_b32 v4, v73 offset:7132
    ds_write_b32 v4, v41 offset:7392
    ds_write_b32 v4, v53 offset:7396
    ds_write_b32 v4, v21 offset:7656
    ds_write_b32 v4, v69 offset:7660
    ds_write_b32 v4, v37 offset:7920
    ds_write_b32 v4, v61 offset:7924
    ds_write_b32 v4, v29 offset:8184
    ds_write_b32 v4, v77 offset:8188
    s_waitcnt lgkmcnt(0)
    ds_read_b32 v16, v5 offset:0
    ds_read_b32 v48, v5 offset:4
    ds_read_b32 v83, v5 offset:8
    ds_read_b32 v81, v5 offset:12
    ds_read_b32 v80, v5 offset:16
    ds_read_b32 v72, v5 offset:20
    ds_read_b32 v40, v5 offset:24
    ds_read_b32 v60, v5 offset:28
    ds_read_b32 v28, v5 offset:32
    ds_read_b32 v76, v5 offset:36
    ds_read_b32 v44, v5 offset:40
    ds_read_b32 v62, v5 offset:44
    ds_read_b32 v30, v5 offset:48
    ds_read_b32 v54, v5 offset:52
    s_waitcnt lgkmcnt(0)
    ds_read_b32 v22, v5 offset:56
    ds_read_b32 v70, v5 offset:60
    ds_read_b32 v38, v5 offset:64
    ds_read_b32 v78, v5 offset:68
    ds_read_b32 v46, v5 offset:72
    ds_read_b32 v63, v5 offset:76
    ds_read_b32 v31, v5 offset:80
    ds_read_b32 v55, v5 offset:84
    ds_read_b32 v23, v5 offset:88
    ds_read_b32 v71, v5 offset:92
    ds_read_b32 v39, v5 offset:96
    ds_read_b32 v51, v5 offset:100
    ds_read_b32 v19, v5 offset:104
    ds_read_b32 v67, v5 offset:108
    s_waitcnt lgkmcnt(0)
    ds_read_b32 v35, v5 offset:112
    ds_read_b32 v59, v5 offset:116
    ds_read_b32 v27, v5 offset:120
    ds_read_b32 v75, v5 offset:124
    ds_read_b32 v43, v5 offset:128
    ds_read_b32 v79, v5 offset:132
    ds_read_b32 v47, v5 offset:136
    ds_read_b32 v56, v5 offset:140
    ds_read_b32 v24, v5 offset:144
    ds_read_b32 v52, v5 offset:148
    ds_read_b32 v20, v5 offset:152
    ds_read_b32 v68, v5 offset:156
    ds_read_b32 v36, v5 offset:160
    ds_read_b32 v50, v5 offset:164
    s_waitcnt lgkmcnt(0)
    ds_read_b32 v18, v5 offset:168
    ds_read_b32 v66, v5 offset:172
    ds_read_b32 v34, v5 offset:176
    ds_read_b32 v58, v5 offset:180
    ds_read_b32 v26, v5 offset:184
    ds_read_b32 v74, v5 offset:188
    ds_read_b32 v42, v5 offset:192
    ds_read_b32 v49, v5 offset:196
    ds_read_b32 v17, v5 offset:200
    ds_read_b32 v65, v5 offset:204
    ds_read_b32 v33, v5 offset:208
    ds_read_b32 v57, v5 offset:212
    ds_read_b32 v25, v5 offset:216
    ds_read_b32 v73, v5 offset:220
    s_waitcnt lgkmcnt(0)
    ds_read_b32 v41, v5 offset:224
    ds_read_b32 v53, v5 offset:228
    ds_read_b32 v21, v5 offset:232
    ds_read_b32 v69, v5 offset:236
    ds_read_b32 v37, v5 offset:240
    ds_read_b32 v61, v5 offset:244
    ds_read_b32 v29, v5 offset:248
    ds_read_b32 v77, v5 offset:252
    s_waitcnt lgkmcnt(0)
    v_sub_f32 v32, v16, v43
    v_sub_f32 v64, v48, v79
    v_add_f32 v16, v16, v43
    v_add_f32 v48, v48, v79
    v_sub_f32 v43, v83, v47
    v_sub_f32 v79, v81, v56
    v_add_f32 v83, v83, v47
    v_add_f32 v81, v81, v56
    v_mul_f32 v47, 0x3f7b14be, v43
    v_mul_f32 v56, 0x3e47c5c2, v43
    v_fmac_f32 v47, 0xbe47c5c2, v79
    v_fmac_f32 v56, 0x3f7b14be, v79
    v_sub_f32 v43, v80, v24
    v_sub_f32 v79, v72, v52
    v_add_f32 v80, v80, v24
    v_add_f32 v72, v72, v52
    v_mul_f32 v24, 0x3f6c835e, v43
    v_mul_f32 v52, 0x3ec3ef15, v43
    v_fmac_f32 v24, 0xbec3ef15, v79
    v_fmac_f32 v52, 0x3f6c835e, v79
    v_sub_f32 v43, v40, v20
    v_sub_f32 v79, v60, v68
    v_add_f32 v40, v40, v20
    v_add_f32 v60, v60, v68
    v_mul_f32 v20, 0x3f54db31, v43
    v_mul_f32 v68, 0x3f0e39da, v43
    v_fmac_f32 v20, 0xbf0e39da, v79
    v_fmac_f32 v68, 0x3f54db31, v79
    v_sub_f32 v43, v28, v36
    v_sub_f32 v79, v76, v50
    v_add_f32 v28, v28, v36
    v_add_f32 v76, v76, v50
    v_mul_f32 v36, 0x3f3504f3, v43
    v_mul_f32 v50, 0x3f3504f3, v43
    v_fmac_f32 v36, 0xbf3504f3, v79
    v_fmac_f32 v50, 0x3f3504f3, v79
    v_sub_f32 v43, v44, v18
    v_sub_f32 v79, v62, v66
    v_add_f32 v44, v44, v18
    v_add_f32 v62, v62, v66
    v_mul_f32 v18, 0x3f0e39da, v43
    v_mul_f32 v66, 0x3f54db31, v43
    v_fmac_f32 v18, 0xbf54db31, v79
    v_fmac_f32 v66, 0x3f0e39da, v79
    v_sub_f32 v43, v30, v34
    v_sub_f32 v79, v54, v58
    v_add_f32 v30, v30, v34
    v_add_f32 v54, v54, v58
    v_mul_f32 v34, 0x3ec3ef15, v43
    v_mul_f32 v58, 0x3f6c835e, v43
    v_fmac_f32 v34, 0xbf6c835e, v79
    v_fmac_f32 v58, 0x3ec3ef15, v79
    v_sub_f32 v43, v22, v26
    v_sub_f32 v79, v70, v74
    v_add_f32 v22, v22, v26
    v_add_f32 v70, v70, v74
    v_mul_f32 v26, 0x3e47c5c2, v43
    v_mul_f32 v74, 0x3f7b14be, v43
    v_fmac_f32 v26, 0xbf7b14be, v79
    v_fmac_f32 v74, 0x3e47c5c2, v79
    v_sub_f32 v43, v49, v78
    v_sub_f32 v79, v38, v42
    v_add_f32 v38, v38, v42
    v_add_f32 v78, v78, v49
    v_sub_f32 v42, v46, v17
    v_sub_f32 v49, v63, v65
    v_add_f32 v46, v46, v17
    v_add_f32 v63, v63, v65
    v_mul_f32 v17, 0xbe47c5c2, v42
    v_mul_f32 v65, 0x3f7b14be, v42
    v_fmac_f32 v17, 0xbf7b14be, v49
    v_fmac_f32 v65, 0xbe47c5c2, v49
    v_sub_f32 v42, v31, v33
    v_sub_f32 v49, v55, v57
    v_add_f32 v31, v31, v33
    v_add_f32 v55, v55, v57
    v_mul_f32 v33, 0xbec3ef15, v42
    v_mul_f32 v57, 0x3f6c835e, v42
    v_fmac_f32 v33, 0xbf6c835e, v49
    v_fmac_f32 v57, 0xbec3ef15, v49
    v_sub_f32 v42, v23, v25
    v_sub_f32 v49, v71, v73
    v_add_f32 v23, v23, v25
    v_add_f32 v71, v71, v73
    v_mul_f32 v25, 0xbf0e39da, v42
    v_mul_f32 v73, 0x3f54db31, v42
    v_fmac_f32 v25, 0xbf54db31, v49
    v_fmac_f32 v73, 0xbf0e39da, v49
    v_sub_f32 v42, v39, v41
    v_sub_f32 v49, v51, v53
    v_add_f32 v39, v39, v41
    v_add_f32 v51, v51, v53
    v_mul_f32 v41, 0xbf3504f3, v42
    v_mul_f32 v53, 0x3f3504f3, v42
    v_fmac_f32 v41, 0xbf3504f3, v49
    v_fmac_f32 v53, 0xbf3504f3, v49
    v_sub_f32 v42, v19, v21
    v_sub_f32 v49, v67, v69
    v_add_f32 v19, v19, v21
    v_add_f32 v67, v67, v69
    v_mul_f32 v21, 0xbf54db31, v42
    v_mul_f32 v69, 0x3f0e39da, v42
    v_fmac_f32 v21, 0xbf0e39da, v49
    v_fmac_f32 v69, 0xbf54db31, v49
    v_sub_f32 v42, v35, v37
    v_sub_f32 v49, v59, v61
    v_add_f32 v35, v35, v37
    v_add_f32 v59, v59, v61
    v_mul_f32 v37, 0xbf6c835e, v42
    v_mul_f32 v61, 0x3ec3ef15, v42
    v_fmac_f32 v37, 0xbec3ef15, v49
    v_fmac_f32 v61, 0xbf6c835e, v49
    v_sub_f32 v42, v27, v29
    v_sub_f32 v49, v75, v77
    v_add_f32 v27, v27, v29
    v_add_f32 v75, v75, v77
    v_mul_f32 v29, 0xbf7b14be, v42
    v_mul_f32 v77, 0x3e47c5c2, v42
    v_fmac_f32 v29, 0xbe47c5c2, v49
    v_fmac_f32 v77, 0xbf7b14be, v49
    v_sub_f32 v42, v16, v38
    v_sub_f32 v49, v48, v78
    v_add_f32 v16, v16, v38
    v_add_f32 v48, v48, v78
    v_sub_f32 v38, v83, v46
    v_sub_f32 v78, v81, v63
    v_add_f32 v83, v83, v46
    v_add_f32 v81, v81, v63
    v_mul_f32 v46, 0x3f6c835e, v38
    v_mul_f32 v63, 0x3ec3ef15, v38
    v_fmac_f32 v46, 0xbec3ef15, v78
    v_fmac_f32 v63, 0x3f6c835e, v78
    v_sub_f32 v38, v80, v31
    v_sub_f32 v78, v72, v55
    v_add_f32 v80, v80, v31
    v_add_f32 v72, v72, v55
    v_mul_f32 v31, 0x3f3504f3, v38
    v_mul_f32 v55, 0x3f3504f3, v38
    v_fmac_f32 v31, 0xbf3504f3, v78
    v_fmac_f32 v55, 0x3f3504f3, v78
    v_sub_f32 v38, v40, v23
    v_sub_f32 v78, v60, v71
    v_add_f32 v40, v40, v23
    v_add_f32 v60, v60, v71
    v_mul_f32 v23, 0x3ec3ef15, v38
    v_mul_f32 v71, 0x3f6c835e, v38
    v_fmac_f32 v23, 0xbf6c835e, v78
    v_fmac_f32 v71, 0x3ec3ef15, v78
    v_sub_f32 v38, v51, v76
    v_sub_f32 v78, v28, v39
    v_add_f32 v28, v28, v39
    v_add_f32 v76, v76, v51
    v_sub_f32 v39, v44, v19
    v_sub_f32 v51, v62, v67
    v_add_f32 v44, v44, v19
    v_add_f32 v62, v62, v67
    v_mul_f32 v19, 0xbec3ef15, v39
    v_mul_f32 v67, 0x3f6c835e, v39
    v_fmac_f32 v19, 0xbf6c835e, v51
    v_fmac_f32 v67, 0xbec3ef15, v51
    v_sub_f32 v39, v30, v35
    v_sub_f32 v51, v54, v59
    v_add_f32 v30, v30, v35
    v_add_f32 v54, v54, v59
    v_mul_f32 v35, 0xbf3504f3, v39
    v_mul_f32 v59, 0x3f3504f3, v39
    v_fmac_f32 v35, 0xbf3504f3, v51
    v_fmac_f32 v59, 0xbf3504f3, v51
    v_sub_f32 v39, v22, v27
    v_sub_f32 v51, v70, v75
    v_add_f32 v22, v22, v27
    v_add_f32 v70, v70, v75
    v_mul_f32 v27, 0xbf6c835e, v39
    v_mul_f32 v75, 0x3ec3ef15, v39
    v_fmac_f32 v27, 0xbec3ef15, v51
    v_fmac_f32 v75, 0xbf6c835e, v51
    v_sub_f32 v39, v32, v43
    v_sub_f32 v51, v64, v79
    v_add_f32 v32, v32, v43
    v_add_f32 v64, v64, v79
    v_sub_f32 v43, v47, v17
    v_sub_f32 v79, v56, v65
    v_add_f32 v47, v47, v17
    v_add_f32 v56, v56, v65
    v_mul_f32 v17, 0x3f6c835e, v43
    v_mul_f32 v65, 0x3ec3ef15, v43
    v_fmac_f32 v17, 0xbec3ef15, v79
    v_fmac_f32 v65, 0x3f6c835e, v79
    v_sub_f32 v43, v24, v33
    v_sub_f32 v79, v52, v57
    v_add_f32 v24, v24, v33
    v_add_f32 v52, v52, v57
    v_mul_f32 v33, 0x3f3504f3, v43
    v_mul_f32 v57, 0x3f3504f3, v43
    v_fmac_f32 v33, 0xbf3504f3, v79
    v_fmac_f32 v57, 0x3f3504f3, v79
    v_sub_f32 v43, v20, v25
    v_sub_f32 v79, v68, v73
    v_add_f32 v20, v20, v25
    v_add_f32 v68, v68, v73
    v_mul_f32 v25, 0x3ec3ef15, v43
    v_mul_f32 v73, 0x3f6c835e, v43
    v_fmac_f32 v25, 0xbf6c835e, v79
    v_fmac_f32 v73, 0x3ec3ef15, v79
    v_sub_f32 v43, v53, v50
    v_sub_f32 v79, v36, v41
    v_add_f32 v36, v36, v41
    v_add_f32 v50, v50, v53
    v_sub_f32 v41, v18, v21
    v_sub_f32 v53, v66, v69
    v_add_f32 v18, v18, v21
    v_add_f32 v66, v66, v69
    v_mul_f32 v21, 0xbec3ef15, v41
    v_mul_f32 v69, 0x3f6c835e, v41
    v_fmac_f32 v21, 0xbf6c835e, v53
    v_fmac_f32 v69, 0xbec3ef15, v53
    v_sub_f32 v41, v34, v37
    v_sub_f32 v53, v58, v61
    v_add_f32 v34, v34, v37
    v_add_f32 v58, v58, v61
    v_mul_f32 v37, 0xbf3504f3, v41
    v_mul_f32 v61, 0x3f3504f3, v41
    v_fmac_f32 v37, 0xbf3504f3, v53
    v_fmac_f32 v61, 0xbf3504f3, v53
    v_sub_f32 v41, v26, v29
    v_sub_f32 v53, v74, v77
    v_add_f32 v26, v26, v29
    v_add_f32 v74, v74, v77
    v_mul_f32 v29, 0xbf6c835e, v41
    v_mul_f32 v77, 0x3ec3ef15, v41
    v_fmac_f32 v29, 0xbec3ef15, v53
    v_fmac_f32 v77, 0xbf6c835e, v53
    v_sub_f32 v41, v16, v28
    v_sub_f32 v53, v48, v76
    v_add_f32 v16, v16, v28
    v_add_f32 v48, v48, v76
    v_sub_f32 v28, v83, v44
    v_sub_f32 v76, v81, v62
    v_add_f32 v83, v83, v44
    v_add_f32 v81, v81, v62
    v_mul_f32 v44, 0x3f3504f3, v28
    v_mul_f32 v62, 0x3f3504f3, v28
    v_fmac_f32 v44, 0xbf3504f3, v76
    v_fmac_f32 v62, 0x3f3504f3, v76
    v_sub_f32 v28, v54, v72
    v_sub_f32 v76, v80, v30
    v_add_f32 v80, v80, v30
    v_add_f32 v72, v72, v54
    v_sub_f32 v30, v40, v22
    v_sub_f32 v54, v60, v70
    v_add_f32 v40, v40, v22
    v_add_f32 v60, v60, v70
    v_mul_f32 v22, 0xbf3504f3, v30
    v_mul_f32 v70, 0x3f3504f3, v30
    v_fmac_f32 v22, 0xbf3504f3, v54
    v_fmac_f32 v70, 0xbf3504f3, v54
    v_sub_f32 v30, v42, v38
    v_sub_f32 v54, v49, v78
    v_add_f32 v42, v42, v38
    v_add_f32 v49, v49, v78
    v_sub_f32 v38, v46, v19
    v_sub_f32 v78, v63, v67
    v_add_f32 v46, v46, v19
    v_add_f32 v63, v63, v67
    v_mul_f32 v19, 0x3f3504f3, v38
    v_mul_f32 v67, 0x3f3504f3, v38
    v_fmac_f32 v19, 0xbf3504f3, v78
    v_fmac_f32 v67, 0x3f3504f3, v78
    v_sub_f32 v38, v59, v55
    v_sub_f32 v78, v31, v35
    v_add_f32 v31, v31, v35
    v_add_f32 v55, v55, v59
    v_sub_f32 v35, v23, v27
    v_sub_f32 v59, v71, v75
    v_add_f32 v23, v23, v27
    v_add_f32 v71, v71, v75
    v_mul_f32 v27, 0xbf3504f3, v35
    v_mul_f32 v75, 0x3f3504f3, v35
    v_fmac_f32 v27, 0xbf3504f3, v59
    v_fmac_f32 v75, 0xbf3504f3, v59
    v_sub_f32 v35, v32, v36
    v_sub_f32 v59, v64, v50
    v_add_f32 v32, v32, v36
    v_add_f32 v64, v64, v50
    v_sub_f32 v36, v47, v18
    v_sub_f32 v50, v56, v66
    v_add_f32 v47, v47, v18
    v_add_f32 v56, v56, v66
    v_mul_f32 v18, 0x3f3504f3, v36
    v_mul_f32 v66, 0x3f3504f3, v36
    v_fmac_f32 v18, 0xbf3504f3, v50
    v_fmac_f32 v66, 0x3f3504f3, v50
    v_sub_f32 v36, v58, v52
    v_sub_f32 v50, v24, v34
    v_add_f32 v24, v24, v34
    v_add_f32 v52, v52, v58
    v_sub_f32 v34, v20, v26
    v_sub_f32 v58, v68, v74
    v_add_f32 v20, v20, v26
    v_add_f32 v68, v68, v74
    v_mul_f32 v26, 0xbf3504f3, v34
    v_mul_f32 v74, 0x3f3504f3, v34
    v_fmac_f32 v26, 0xbf3504f3, v58
    v_fmac_f32 v74, 0xbf3504f3, v58
    v_sub_f32 v34, v39, v43
    v_sub_f32 v58, v51, v79
    v_add_f32 v39, v39, v43
    v_add_f32 v51, v51, v79
    v_sub_f32 v43, v17, v21
    v_sub_f32 v79, v65, v69
    v_add_f32 v17, v17, v21
    v_add_f32 v65, v65, v69
    v_mul_f32 v21, 0x3f3504f3, v43
    v_mul_f32 v69, 0x3f3504f3, v43
    v_fmac_f32 v21, 0xbf3504f3, v79
    v_fmac_f32 v69, 0x3f3504f3, v79
    v_sub_f32 v43, v61, v57
    v_sub_f32 v79, v33, v37
    v_add_f32 v33, v33, v37
    v_add_f32 v57, v57, v61
    v_sub_f32 v37, v25, v29
    v_sub_f32 v61, v73, v77
    v_add_f32 v25, v25, v29
    v_add_f32 v73, v73, v77
    v_mul_f32 v29, 0xbf3504f3, v37
    v_mul_f32 v77, 0x3f3504f3, v37
    v_fmac_f32 v29, 0xbf3504f3, v61
    v_fmac_f32 v77, 0xbf3504f3, v61
    v_sub_f32 v37, v16, v80
    v_sub_f32 v61, v48, v72
    v_add_f32 v16, v16, v80
    v_add_f32 v48, v48, v72
    v_sub_f32 v80, v60, v81
    v_sub_f32 v72, v83, v40
    v_add_f32 v83, v83, v40
    v_add_f32 v81, v81, v60
    v_sub_f32 v40, v41, v28
    v_sub_f32 v60, v53, v76
    v_add_f32 v41, v41, v28
    v_add_f32 v53, v53, v76
    v_sub_f32 v28, v70, v62
    v_sub_f32 v76, v44, v22
    v_add_f32 v44, v44, v22
    v_add_f32 v62, v62, v70
    v_sub_f32 v22, v42, v31
    v_sub_f32 v70, v49, v55
    v_add_f32 v42, v42, v31
    v_add_f32 v49, v49, v55
    v_sub_f32 v31, v71, v63
    v_sub_f32 v55, v46, v23
    v_add_f32 v46, v46, v23
    v_add_f32 v63, v63, v71
    v_sub_f32 v23, v30, v38
    v_sub_f32 v71, v54, v78
    v_add_f32 v30, v30, v38
    v_add_f32 v54, v54, v78
    v_sub_f32 v38, v75, v67
    v_sub_f32 v78, v19, v27
    v_add_f32 v19, v19, v27
    v_add_f32 v67, v67, v75
    v_sub_f32 v27, v32, v24
    v_sub_f32 v75, v64, v52
    v_add_f32 v32, v32, v24
    v_add_f32 v64, v64, v52
    v_sub_f32 v24, v68, v56
    v_sub_f32 v52, v47, v20
    v_add_f32 v47, v47, v20
    v_add_f32 v56, v56, v68
    v_sub_f32 v20, v35, v36
    v_sub_f32 v68, v59, v50
    v_add_f32 v35, v35, v36
    v_add_f32 v59, v59, v50
    v_sub_f32 v36, v74, v66
    v_sub_f32 v50, v18, v26
    v_add_f32 v18, v18, v26
    v_add_f32 v66, v66, v74
    v_sub_f32 v26, v39, v33
    v_sub_f32 v74, v51, v57
    v_add_f32 v39, v39, v33
    v_add_f32 v51, v51, v57
    v_sub_f32 v33, v73, v65
    v_sub_f32 v57, v17, v25
    v_add_f32 v17, v17, v25
    v_add_f32 v65, v65, v73
    v_sub_f32 v25, v34, v43
    v_sub_f32 v73, v58, v79
    v_add_f32 v34, v34, v43
    v_add_f32 v58, v58, v79
    v_sub_f32 v43, v77, v69
    v_sub_f32 v79, v21, v29
    v_add_f32 v21, v21, v29
    v_add_f32 v69, v69, v77
    v_sub_f32 v29, v16, v83
    v_sub_f32 v77, v48, v81
    v_add_f32 v16, v16, v83
    v_add_f32 v48, v48, v81
    v_sub_f32 v83, v37, v80
    v_sub_f32 v81, v61, v72
    v_add_f32 v37, v37, v80
    v_add_f32 v61, v61, v72
    v_sub_f32 v80, v41, v44
    v_sub_f32 v72, v53, v62
    v_add_f32 v41, v41, v44
    v_add_f32 v53, v53, v62
    v_sub_f32 v44, v40, v28
    v_sub_f32 v62, v60, v76
    v_add_f32 v40, v40, v28
    v_add_f32 v60, v60, v76
    v_sub_f32 v28, v42, v46
    v_sub_f32 v76, v49, v63
    v_add_f32 v42, v42, v46
    v_add_f32 v49, v49, v63
    v_sub_f32 v46, v22, v31
    v_sub_f32 v63, v70, v55
    v_add_f32 v22, v22, v31
    v_add_f32 v70, v70, v55
    v_sub_f32 v31, v30, v19
    v_sub_f32 v55, v54, v67
    v_add_f32 v30, v30, v19
    v_add_f32 v54, v54, v67
    v_sub_f32 v19, v23, v38
    v_sub_f32 v67, v71, v78
    v_add_f32 v23, v23, v38
    v_add_f32 v71, v71, v78
    v_sub_f32 v38, v32, v47
    v_sub_f32 v78, v64, v56
    v_add_f32 v32, v32, v47
    v_add_f32 v64, v64, v56
    v_sub_f32 v47, v27, v24
    v_sub_f32 v56, v75, v52
    v_add_f32 v27, v27, v24
    v_add_f32 v75, v75, v52
    v_sub_f32 v24, v35, v18
    v_sub_f32 v52, v59, v66
    v_add_f32 v35, v35, v18
    v_add_f32 v59, v59, v66
    v_sub_f32 v18, v20, v36
    v_sub_f32 v66, v68, v50
    v_add_f32 v20, v20, v36
    v_add_f32 v68, v68, v50
    v_sub_f32 v36, v39, v17
    v_sub_f32 v50, v51, v65
    v_add_f32 v39, v39, v17
    v_add_f32 v51, v51, v65
    v_sub_f32 v17, v26, v33
    v_sub_f32 v65, v74, v57
    v_add_f32 v26, v26, v33
    v_add_f32 v74, v74, v57
    v_sub_f32 v33, v34, v21
    v_sub_f32 v57, v58, v69
    v_add_f32 v34, v34, v21
    v_add_f32 v58, v58, v69
    v_sub_f32 v21, v25, v43
    v_sub_f32 v69, v73, v79
    v_add_f32 v25, v25, v43
    v_add_f32 v73, v73, v79
    v_lshl_add_u32 v6, v1, 2, v7
    ds_write_b32 v6, v16 offset:0
    ds_write_b32 v6, v48 offset:4096
    ds_write_b32 v6, v32 offset:128
    ds_write_b32 v6, v64 offset:4224
    ds_write_b32 v6, v42 offset:256
    ds_write_b32 v6, v49 offset:4352
    ds_write_b32 v6, v39 offset:384
    ds_write_b32 v6, v51 offset:4480
    ds_write_b32 v6, v41 offset:512
    ds_write_b32 v6, v53 offset:4608
    ds_write_b32 v6, v35 offset:640
    ds_write_b32 v6, v59 offset:4736
    ds_write_b32 v6, v30 offset:768
    ds_write_b32 v6, v54 offset:4864
    ds_write_b32 v6, v34 offset:896
    ds_write_b32 v6, v58 offset:4992
    ds_write_b32 v6, v37 offset:1024
    ds_write_b32 v6, v61 offset:5120
    ds_write_b32 v6, v27 offset:1152
    ds_write_b32 v6, v75 offset:5248
    ds_write_b32 v6, v22 offset:1280
    ds_write_b32 v6, v70 offset:5376
    ds_write_b32 v6, v26 offset:1408
    ds_write_b32 v6, v74 offset:5504
    ds_write_b32 v6, v40 offset:1536
    ds_write_b32 v6, v60 offset:5632
    ds_write_b32 v6, v20 offset:1664
    ds_write_b32 v6, v68 offset:5760
    ds_write_b32 v6, v23 offset:1792
    ds_write_b32 v6, v71 offset:5888
    ds_write_b32 v6, v25 offset:1920
    ds_write_b32 v6, v73 offset:6016
    ds_write_b32 v6, v29 offset:2048
    ds_write_b32 v6, v77 offset:6144
    ds_write_b32 v6, v38 offset:2176
    ds_write_b32 v6, v78 offset:6272
    ds_write_b32 v6, v28 offset:2304
    ds_write_b32 v6, v76 offset:6400
    ds_write_b32 v6, v36 offset:2432
    ds_write_b32 v6, v50 offset:6528
    ds_write_b32 v6, v80 offset:2560
    ds_write_b32 v6, v72 offset:6656
    ds_write_b32 v6, v24 offset:2688
    ds_write_b32 v6, v52 offset:6784
    ds_write_b32 v6, v31 offset:2816
    ds_write_b32 v6, v55 offset:6912
    ds_write_b32 v6, v33 offset:2944
    ds_write_b32 v6, v57 offset:7040
    ds_write_b32 v6, v83 offset:3072
    ds_write_b32 v6, v81 offset:7168
    ds_write_b32 v6, v47 offset:3200
    ds_write_b32 v6, v56 offset:7296
    ds_write_b32 v6, v46 offset:3328
    ds_write_b32 v6, v63 offset:7424
    ds_write_b32 v6, v17 offset:3456
    ds_write_b32 v6, v65 offset:7552
    ds_write_b32 v6, v44 offset:3584
    ds_write_b32 v6, v62 offset:7680
    ds_write_b32 v6, v18 offset:3712
    ds_write_b32 v6, v66 offset:7808
    ds_write_b32 v6, v19 offset:3840
    ds_write_b32 v6, v67 offset:7936
    ds_write_b32 v6, v21 offset:3968
    ds_write_b32 v6, v69 offset:8064
    s_waitcnt lgkmcnt(0)
    s_barrier
    v_and_b32 v6, 127, v0
    v_lshrrev_b32 v7, 7, v0
    v_lshlrev_b32 v8, 5, v6
    v_lshl_add_u32 v8, v7, 12, v8
    v_lshlrev_b32 v5, 4, v6
    v_lshl_add_u32 v5, v7, 12, v5
    v_add_u32 v5, 2048, v5
    s_lshl_b32 s12, s92, 16
    ds_read_b128 v[16:19], v8 offset:0
    ds_read_b128 v[20:23], v8 offset:16
    s_waitcnt lgkmcnt(0)
    v_cvt_pk_bf16_f32 v24, v16, v17
    v_cvt_pk_bf16_f32 v25, v18, v19
    v_cvt_pk_bf16_f32 v26, v20, v21
    v_cvt_pk_bf16_f32 v27, v22, v23
    s_add_u32 s13, s12, 0
    buffer_store_dwordx4 v[24:27], v5, s[4:7], s13 offen
    s_nop 1
    ds_read_b128 v[16:19], v8 offset:8448
    ds_read_b128 v[20:23], v8 offset:8464
    s_waitcnt lgkmcnt(0)
    v_cvt_pk_bf16_f32 v24, v16, v17
    v_cvt_pk_bf16_f32 v25, v18, v19
    v_cvt_pk_bf16_f32 v26, v20, v21
    v_cvt_pk_bf16_f32 v27, v22, v23
    s_add_u32 s13, s12, 8192
    buffer_store_dwordx4 v[24:27], v5, s[4:7], s13 offen
    s_nop 1
    ds_read_b128 v[16:19], v8 offset:16896
    ds_read_b128 v[20:23], v8 offset:16912
    s_waitcnt lgkmcnt(0)
    v_cvt_pk_bf16_f32 v24, v16, v17
    v_cvt_pk_bf16_f32 v25, v18, v19
    v_cvt_pk_bf16_f32 v26, v20, v21
    v_cvt_pk_bf16_f32 v27, v22, v23
    s_add_u32 s13, s12, 16384
    buffer_store_dwordx4 v[24:27], v5, s[4:7], s13 offen
    s_nop 1
    ds_read_b128 v[16:19], v8 offset:25344
    ds_read_b128 v[20:23], v8 offset:25360
    s_waitcnt lgkmcnt(0)
    v_cvt_pk_bf16_f32 v24, v16, v17
    v_cvt_pk_bf16_f32 v25, v18, v19
    v_cvt_pk_bf16_f32 v26, v20, v21
    v_cvt_pk_bf16_f32 v27, v22, v23
    s_add_u32 s13, s12, 24576
    buffer_store_dwordx4 v[24:27], v5, s[4:7], s13 offen
    s_nop 1
    ds_read_b128 v[16:19], v8 offset:33792
    ds_read_b128 v[20:23], v8 offset:33808
    s_waitcnt lgkmcnt(0)
    v_cvt_pk_bf16_f32 v24, v16, v17
    v_cvt_pk_bf16_f32 v25, v18, v19
    v_cvt_pk_bf16_f32 v26, v20, v21
    v_cvt_pk_bf16_f32 v27, v22, v23
    s_add_u32 s13, s12, 32768
    buffer_store_dwordx4 v[24:27], v5, s[4:7], s13 offen
    s_nop 1
    ds_read_b128 v[16:19], v8 offset:42240
    ds_read_b128 v[20:23], v8 offset:42256
    s_waitcnt lgkmcnt(0)
    v_cvt_pk_bf16_f32 v24, v16, v17
    v_cvt_pk_bf16_f32 v25, v18, v19
    v_cvt_pk_bf16_f32 v26, v20, v21
    v_cvt_pk_bf16_f32 v27, v22, v23
    s_add_u32 s13, s12, 40960
    buffer_store_dwordx4 v[24:27], v5, s[4:7], s13 offen
    s_nop 1
    ds_read_b128 v[16:19], v8 offset:50688
    ds_read_b128 v[20:23], v8 offset:50704
    s_waitcnt lgkmcnt(0)
    v_cvt_pk_bf16_f32 v24, v16, v17
    v_cvt_pk_bf16_f32 v25, v18, v19
    v_cvt_pk_bf16_f32 v26, v20, v21
    v_cvt_pk_bf16_f32 v27, v22, v23
    s_add_u32 s13, s12, 49152
    buffer_store_dwordx4 v[24:27], v5, s[4:7], s13 offen
    s_nop 1
    ds_read_b128 v[16:19], v8 offset:59136
    ds_read_b128 v[20:23], v8 offset:59152
    s_waitcnt lgkmcnt(0)
    v_cvt_pk_bf16_f32 v24, v16, v17
    v_cvt_pk_bf16_f32 v25, v18, v19
    v_cvt_pk_bf16_f32 v26, v20, v21
    v_cvt_pk_bf16_f32 v27, v22, v23
    s_add_u32 s13, s12, 57344
    buffer_store_dwordx4 v[24:27], v5, s[4:7], s13 offen
    s_nop 1
    s_branch mega_kernel_xo4
mega_kernel_xo:
    s_cmp_lg_u32 s92, 128
    s_cbranch_scc1 mega_kernel_xo2
    s_cmp_lg_u32 s98, 0
    s_cbranch_scc1 mega_kernel_xo2
mega_kernel_wf1b:
    s_sleep 8
    buffer_load_dword v2, off, s[88:91], 0 offset:72 sc1
    s_waitcnt vmcnt(0)
    v_cmp_ne_u32 vcc, 192, v2
    s_cbranch_vccnz mega_kernel_wf1b
    s_mov_b32 s99, 128
    s_branch mega_kernel_f2_in
mega_kernel_f2ret:
    s_waitcnt vmcnt(0)
    v_mov_b32 v2, 1
    s_mov_b64 exec, 1
    buffer_atomic_add v2, off, s[88:91], 0 offset:136 sc1
    s_mov_b64 exec, -1
    s_branch mega_kernel_xo3
mega_kernel_xo2:
    s_waitcnt vmcnt(0)
    ds_read_b64_tr_b16 a[64:65], v201 offset:0
    ds_read_b64_tr_b16 a[66:67], v201 offset:256
    ds_read_b64_tr_b16 a[68:69], v201 offset:1024
    ds_read_b64_tr_b16 a[70:71], v201 offset:1280
    ds_read_b64_tr_b16 a[72:73], v201 offset:2048
    ds_read_b64_tr_b16 a[74:75], v201 offset:2304
    ds_read_b64_tr_b16 a[76:77], v201 offset:3072
    ds_read_b64_tr_b16 a[78:79], v201 offset:3328
    s_waitcnt lgkmcnt(0)
    ds_read_b64_tr_b16 a[80:81], v201 offset:4096
    ds_read_b64_tr_b16 a[82:83], v201 offset:4352
    ds_read_b64_tr_b16 a[84:85], v201 offset:5120
    ds_read_b64_tr_b16 a[86:87], v201 offset:5376
    ds_read_b64_tr_b16 a[88:89], v201 offset:6144
    ds_read_b64_tr_b16 a[90:91], v201 offset:6400
    ds_read_b64_tr_b16 a[92:93], v201 offset:7168
    ds_read_b64_tr_b16 a[94:95], v201 offset:7424
    s_waitcnt lgkmcnt(0)
    ds_read_b64_tr_b16 a[96:97], v201 offset:8192
    ds_read_b64_tr_b16 a[98:99], v201 offset:8448
    ds_read_b64_tr_b16 a[100:101], v201 offset:9216
    ds_read_b64_tr_b16 a[102:103], v201 offset:9472
    ds_read_b64_tr_b16 a[104:105], v201 offset:10240
    ds_read_b64_tr_b16 a[106:107], v201 offset:10496
    ds_read_b64_tr_b16 a[108:109], v201 offset:11264
    ds_read_b64_tr_b16 a[110:111], v201 offset:11520
    s_waitcnt lgkmcnt(0)
    ds_read_b64_tr_b16 a[112:113], v201 offset:12288
    ds_read_b64_tr_b16 a[114:115], v201 offset:12544
    ds_read_b64_tr_b16 a[116:117], v201 offset:13312
    ds_read_b64_tr_b16 a[118:119], v201 offset:13568
    ds_read_b64_tr_b16 a[120:121], v201 offset:14336
    ds_read_b64_tr_b16 a[122:123], v201 offset:14592
    ds_read_b64_tr_b16 a[124:125], v201 offset:15360
    ds_read_b64_tr_b16 a[126:127], v201 offset:15616
    s_waitcnt lgkmcnt(0)
    s_add_u32 m0, s56, 0
    s_add_u32 s58, s57, 32768
    s_and_b32 s58, s58, 0xffff
    s_lshl_b32 s58, s58, 5
    buffer_load_dwordx4 v200, s[52:55], s58 offen lds
    s_add_u32 m0, s56, 1024
    s_add_u32 s58, s57, 33792
    s_and_b32 s58, s58, 0xffff
    s_lshl_b32 s58, s58, 5
    buffer_load_dwordx4 v200, s[52:55], s58 offen lds
    s_add_u32 m0, s56, 2048
    s_add_u32 s58, s57, 34816
    s_and_b32 s58, s58, 0xffff
    s_lshl_b32 s58, s58, 5
    buffer_load_dwordx4 v200, s[52:55], s58 offen lds
    s_add_u32 m0, s56, 3072
    s_add_u32 s58, s57, 35840
    s_and_b32 s58, s58, 0xffff
    s_lshl_b32 s58, s58, 5
    buffer_load_dwordx4 v200, s[52:55], s58 offen lds
    s_add_u32 m0, s56, 4096
    s_add_u32 s58, s57, 36864
    s_and_b32 s58, s58, 0xffff
    s_lshl_b32 s58, s58, 5
    buffer_load_dwordx4 v200, s[52:55], s58 offen lds
    s_add_u32 m0, s56, 5120
    s_add_u32 s58, s57, 37888
    s_and_b32 s58, s58, 0xffff
    s_lshl_b32 s58, s58, 5
    buffer_load_dwordx4 v200, s[52:55], s58 offen lds
    s_add_u32 m0, s56, 6144
    s_add_u32 s58, s57, 38912
    s_and_b32 s58, s58, 0xffff
    s_lshl_b32 s58, s58, 5
    buffer_load_dwordx4 v200, s[52:55], s58 offen lds
    s_add_u32 m0, s56, 7168
    s_add_u32 s58, s57, 39936
    s_and_b32 s58, s58, 0xffff
    s_lshl_b32 s58, s58, 5
    buffer_load_dwordx4 v200, s[52:55], s58 offen lds
    s_add_u32 m0, s56, 8192
    s_add_u32 s58, s57, 40960
    s_and_b32 s58, s58, 0xffff
    s_lshl_b32 s58, s58, 5
    buffer_load_dwordx4 v200, s[52:55], s58 offen lds
    s_add_u32 m0, s56, 9216
    s_add_u32 s58, s57, 41984
    s_and_b32 s58, s58, 0xffff
    s_lshl_b32 s58, s58, 5
    buffer_load_dwordx4 v200, s[52:55], s58 offen lds
    s_add_u32 m0, s56, 10240
    s_add_u32 s58, s57, 43008
    s_and_b32 s58, s58, 0xffff
    s_lshl_b32 s58, s58, 5
    buffer_load_dwordx4 v200, s[52:55], s58 offen lds
    s_add_u32 m0, s56, 11264
    s_add_u32 s58, s57, 44032
    s_and_b32 s58, s58, 0xffff
    s_lshl_b32 s58, s58, 5
    buffer_load_dwordx4 v200, s[52:55], s58 offen lds
    s_add_u32 m0, s56, 12288
    s_add_u32 s58, s57, 45056
    s_and_b32 s58, s58, 0xffff
    s_lshl_b32 s58, s58, 5
    buffer_load_dwordx4 v200, s[52:55], s58 offen lds
    s_add_u32 m0, s56, 13312
    s_add_u32 s58, s57, 46080
    s_and_b32 s58, s58, 0xffff
    s_lshl_b32 s58, s58, 5
    buffer_load_dwordx4 v200, s[52:55], s58 offen lds
    s_add_u32 m0, s56, 14336
    s_add_u32 s58, s57, 47104
    s_and_b32 s58, s58, 0xffff
    s_lshl_b32 s58, s58, 5
    buffer_load_dwordx4 v200, s[52:55], s58 offen lds
    s_add_u32 m0, s56, 15360
    s_add_u32 s58, s57, 48128
    s_and_b32 s58, s58, 0xffff
    s_lshl_b32 s58, s58, 5
    buffer_load_dwordx4 v200, s[52:55], s58 offen lds
mega_kernel_xo3:
    s_waitcnt vmcnt(0)
    ds_read_b64_tr_b16 a[128:129], v201 offset:0
    ds_read_b64_tr_b16 a[130:131], v201 offset:256
    ds_read_b64_tr_b16 a[132:133], v201 offset:1024
    ds_read_b64_tr_b16 a[134:135], v201 offset:1280
    ds_read_b64_tr_b16 a[136:137], v201 offset:2048
    ds_read_b64_tr_b16 a[138:139], v201 offset:2304
    ds_read_b64_tr_b16 a[140:141], v201 offset:3072
    ds_read_b64_tr_b16 a[142:143], v201 offset:3328
    s_waitcnt lgkmcnt(0)
    ds_read_b64_tr_b16 a[144:145], v201 offset:4096
    ds_read_b64_tr_b16 a[146:147], v201 offset:4352
    ds_read_b64_tr_b16 a[148:149], v201 offset:5120
    ds_read_b64_tr_b16 a[150:151], v201 offset:5376
    ds_read_b64_tr_b16 a[152:153], v201 offset:6144
    ds_read_b64_tr_b16 a[154:155], v201 offset:6400
    ds_read_b64_tr_b16 a[156:157], v201 offset:7168
    ds_read_b64_tr_b16 a[158:159], v201 offset:7424
    s_waitcnt lgkmcnt(0)
    ds_read_b64_tr_b16 a[160:161], v201 offset:8192
    ds_read_b64_tr_b16 a[162:163], v201 offset:8448
    ds_read_b64_tr_b16 a[164:165], v201 offset:9216
    ds_read_b64_tr_b16 a[166:167], v201 offset:9472
    ds_read_b64_tr_b16 a[168:169], v201 offset:10240
    ds_read_b64_tr_b16 a[170:171], v201 offset:10496
    ds_read_b64_tr_b16 a[172:173], v201 offset:11264
    ds_read_b64_tr_b16 a[174:175], v201 offset:11520
    s_waitcnt lgkmcnt(0)
    ds_read_b64_tr_b16 a[176:177], v201 offset:12288
    ds_read_b64_tr_b16 a[178:179], v201 offset:12544
    ds_read_b64_tr_b16 a[180:181], v201 offset:13312
    ds_read_b64_tr_b16 a[182:183], v201 offset:13568
    ds_read_b64_tr_b16 a[184:185], v201 offset:14336
    ds_read_b64_tr_b16 a[186:187], v201 offset:14592
    ds_read_b64_tr_b16 a[188:189], v201 offset:15360
    ds_read_b64_tr_b16 a[190:191], v201 offset:15616
    s_waitcnt lgkmcnt(0)
    s_add_u32 m0, s56, 0
    s_add_u32 s58, s57, 49152
    s_and_b32 s58, s58, 0xffff
    s_lshl_b32 s58, s58, 5
    buffer_load_dwordx4 v200, s[52:55], s58 offen lds
    s_add_u32 m0, s56, 1024
    s_add_u32 s58, s57, 50176
    s_and_b32 s58, s58, 0xffff
    s_lshl_b32 s58, s58, 5
    buffer_load_dwordx4 v200, s[52:55], s58 offen lds
    s_add_u32 m0, s56, 2048
    s_add_u32 s58, s57, 51200
    s_and_b32 s58, s58, 0xffff
    s_lshl_b32 s58, s58, 5
    buffer_load_dwordx4 v200, s[52:55], s58 offen lds
    s_add_u32 m0, s56, 3072
    s_add_u32 s58, s57, 52224
    s_and_b32 s58, s58, 0xffff
    s_lshl_b32 s58, s58, 5
    buffer_load_dwordx4 v200, s[52:55], s58 offen lds
    s_add_u32 m0, s56, 4096
    s_add_u32 s58, s57, 53248
    s_and_b32 s58, s58, 0xffff
    s_lshl_b32 s58, s58, 5
    buffer_load_dwordx4 v200, s[52:55], s58 offen lds
    s_add_u32 m0, s56, 5120
    s_add_u32 s58, s57, 54272
    s_and_b32 s58, s58, 0xffff
    s_lshl_b32 s58, s58, 5
    buffer_load_dwordx4 v200, s[52:55], s58 offen lds
    s_add_u32 m0, s56, 6144
    s_add_u32 s58, s57, 55296
    s_and_b32 s58, s58, 0xffff
    s_lshl_b32 s58, s58, 5
    buffer_load_dwordx4 v200, s[52:55], s58 offen lds
    s_add_u32 m0, s56, 7168
    s_add_u32 s58, s57, 56320
    s_and_b32 s58, s58, 0xffff
    s_lshl_b32 s58, s58, 5
    buffer_load_dwordx4 v200, s[52:55], s58 offen lds
    s_add_u32 m0, s56, 8192
    s_add_u32 s58, s57, 57344
    s_and_b32 s58, s58, 0xffff
    s_lshl_b32 s58, s58, 5
    buffer_load_dwordx4 v200, s[52:55], s58 offen lds
    s_add_u32 m0, s56, 9216
    s_add_u32 s58, s57, 58368
    s_and_b32 s58, s58, 0xffff
    s_lshl_b32 s58, s58, 5
    buffer_load_dwordx4 v200, s[52:55], s58 offen lds
    s_add_u32 m0, s56, 10240
    s_add_u32 s58, s57, 59392
    s_and_b32 s58, s58, 0xffff
    s_lshl_b32 s58, s58, 5
    buffer_load_dwordx4 v200, s[52:55], s58 offen lds
    s_add_u32 m0, s56, 11264
    s_add_u32 s58, s57, 60416
    s_and_b32 s58, s58, 0xffff
    s_lshl_b32 s58, s58, 5
    buffer_load_dwordx4 v200, s[52:55], s58 offen lds
    s_add_u32 m0, s56, 12288
    s_add_u32 s58, s57, 61440
    s_and_b32 s58, s58, 0xffff
    s_lshl_b32 s58, s58, 5
    buffer_load_dwordx4 v200, s[52:55], s58 offen lds
    s_add_u32 m0, s56, 13312
    s_add_u32 s58, s57, 62464
    s_and_b32 s58, s58, 0xffff
    s_lshl_b32 s58, s58, 5
    buffer_load_dwordx4 v200, s[52:55], s58 offen lds
    s_add_u32 m0, s56, 14336
    s_add_u32 s58, s57, 63488
    s_and_b32 s58, s58, 0xffff
    s_lshl_b32 s58, s58, 5
    buffer_load_dwordx4 v200, s[52:55], s58 offen lds
    s_add_u32 m0, s56, 15360
    s_add_u32 s58, s57, 64512
    s_and_b32 s58, s58, 0xffff
    s_lshl_b32 s58, s58, 5
    buffer_load_dwordx4 v200, s[52:55], s58 offen lds
mega_kernel_xo4:
    s_waitcnt vmcnt(0)
    ds_read_b64_tr_b16 a[192:193], v201 offset:0
    ds_read_b64_tr_b16 a[194:195], v201 offset:256
    ds_read_b64_tr_b16 a[196:197], v201 offset:1024
    ds_read_b64_tr_b16 a[198:199], v201 offset:1280
    ds_read_b64_tr_b16 a[200:201], v201 offset:2048
    ds_read_b64_tr_b16 a[202:203], v201 offset:2304
    ds_read_b64_tr_b16 a[204:205], v201 offset:3072
    ds_read_b64_tr_b16 a[206:207], v201 offset:3328
    s_waitcnt lgkmcnt(0)
    ds_read_b64_tr_b16 a[208:209], v201 offset:4096
    ds_read_b64_tr_b16 a[210:211], v201 offset:4352
    ds_read_b64_tr_b16 a[212:213], v201 offset:5120
    ds_read_b64_tr_b16 a[214:215], v201 offset:5376
    ds_read_b64_tr_b16 a[216:217], v201 offset:6144
    ds_read_b64_tr_b16 a[218:219], v201 offset:6400
    ds_read_b64_tr_b16 a[220:221], v201 offset:7168
    ds_read_b64_tr_b16 a[222:223], v201 offset:7424
    s_waitcnt lgkmcnt(0)
    ds_read_b64_tr_b16 a[224:225], v201 offset:8192
    ds_read_b64_tr_b16 a[226:227], v201 offset:8448
    ds_read_b64_tr_b16 a[228:229], v201 offset:9216
    ds_read_b64_tr_b16 a[230:231], v201 offset:9472
    ds_read_b64_tr_b16 a[232:233], v201 offset:10240
    ds_read_b64_tr_b16 a[234:235], v201 offset:10496
    ds_read_b64_tr_b16 a[236:237], v201 offset:11264
    ds_read_b64_tr_b16 a[238:239], v201 offset:11520
    s_waitcnt lgkmcnt(0)
    ds_read_b64_tr_b16 a[240:241], v201 offset:12288
    ds_read_b64_tr_b16 a[242:243], v201 offset:12544
    ds_read_b64_tr_b16 a[244:245], v201 offset:13312
    ds_read_b64_tr_b16 a[246:247], v201 offset:13568
    ds_read_b64_tr_b16 a[248:249], v201 offset:14336
    ds_read_b64_tr_b16 a[250:251], v201 offset:14592
    ds_read_b64_tr_b16 a[252:253], v201 offset:15360
    ds_read_b64_tr_b16 a[254:255], v201 offset:15616
    s_waitcnt lgkmcnt(0)
    s_load_dwordx2 s[8:9], s[0:1], 40
    s_load_dwordx2 s[12:13], s[0:1], 80
    v_lshrrev_b32 v3, 6, v0
    v_and_b32 v1, 63, v0
    v_readfirstlane_b32 s16, v3
    s_lshr_b32 s17, s92, 5
    s_and_b32 s18, s92, 31
    v_lshlrev_b32 v2, 4, v1
    s_waitcnt lgkmcnt(0)
    s_mov_b32 s10, 8388608
    s_mov_b32 s11, 0x00020000
    s_mov_b32 s14, 8388608
    s_mov_b32 s15, 0x00020000
    s_mov_b32 s24, 0x3e0293ee
    s_lshr_b32 s50, s18, 1
    s_lshl_b32 s50, s50, 12
    s_lshl_b32 s47, s17, 2
    s_add_u32 s20, s47, s16
    s_lshl_b32 s20, s20, 18
    s_lshl_b32 s21, s18, 13
    s_add_u32 s20, s20, s21
    s_add_u32 s20, s20, 50331648
    v_lshlrev_b32 v26, 7, v1
    buffer_load_dword v28, v26, s[84:87], s20 offen sc1
    v_and_b32 v4, 15, v1
    v_lshrrev_b32 v5, 4, v1
    v_lshrrev_b32 v3, 2, v4
    v_lshlrev_b32 v3, 1, v3
    v_and_b32 v26, 1, v4
    v_add_u32 v3, v3, v26
    v_lshlrev_b32 v6, 8, v3
    v_lshl_add_u32 v6, v5, 4, v6
    s_lshr_b32 s20, s16, 1
    s_lshl_b32 s20, s20, 10
    s_add_u32 s20, s20, 2048
    v_lshlrev_b32 v7, 3, v1
    v_add_u32 v7, s20, v7
    v_lshlrev_b32 v8, 9, v5
    v_lshl_add_u32 v8, v4, 4, v8
    s_lshr_b32 s20, s16, 1
    s_lshl_b32 s20, s20, 12
    s_and_b32 s21, s16, 1
    s_lshl_b32 s21, s21, 8
    s_add_u32 s20, s20, s21
    v_add_u32 v8, s20, v8
    v_lshlrev_b32 v19, 4, v4
    v_and_b32 v26, 1, v5
    v_lshl_add_u32 v19, v26, 10, v19
    v_lshrrev_b32 v26, 1, v5
    v_lshl_add_u32 v19, v26, 9, v19
    s_and_b32 s20, s17, 1
    s_lshl_b32 s20, s20, 8
    v_add_u32 v19, s20, v19
    v_lshlrev_b32 v26, 2, v5
    v_sub_u32 v9, v4, v26
    s_lshr_b32 s21, s21, 4
    v_add_u32 v9, s21, v9
    v_add_u32 v10, -16, v9
    v_mov_b32 v11, 0xff7fffff
    v_mov_b32 v20, 0x3f803f80
    v_mov_b32 v21, 0x3f803f80
    v_mov_b32 v22, 0x3f803f80
    v_mov_b32 v23, 0x3f803f80
    v_bfe_u32 v26, v1, 1, 2
    v_min_u32 v26, 2, v26
    s_lshl_b32 s20, s18, 8
    s_add_u32 s20, s20, 71303168
    v_lshlrev_b32 v12, 13, v26
    v_and_b32 v26, 1, v1
    v_lshl_add_u32 v12, v26, 7, v12
    v_add_u32 v12, s20, v12
    v_and_b32 v26, 1, v1
    v_lshlrev_b32 v13, 7, v26
    s_add_u32 s20, s20, 24576
    v_add_u32 v13, s20, v13
    v_and_b32 v26, 7, v1
    s_lshl_b32 s20, s17, 5
    s_lshl_b32 s21, s16, 3
    s_add_u32 s20, s20, s21
    v_add_u32 v26, s20, v26
    v_lshlrev_b32 v14, 7, v26
    v_add_u32 v14, 71335936, v14
    v_bfrev_b32 v26, 1
    s_lshl_b32 s20, s92, 7
    s_add_u32 s20, s20, 71335936
    v_mov_b32 v27, s20
    v_cmp_eq_u32 vcc, 0, v0
    s_lshl_b32 s20, s16, 12
    v_add_u32 v17, s20, v2
    v_cndmask_b32 v15, v26, v27, vcc
    v_lshrrev_b32 v26, 3, v0
    v_and_b32 v27, 1, v0
    v_lshl_add_u32 v27, v27, 5, v26
    v_lshlrev_b32 v16, 4, v27
    v_bfe_u32 v27, v0, 1, 2
    v_lshl_add_u32 v16, v27, 10, v16
    v_lshlrev_b32 v18, 12, v26
    v_and_b32 v27, 7, v0
    v_lshl_add_u32 v18, v27, 3, v18
    s_lshl_b32 s20, s18, 6
    v_add_u32 v18, s20, v18
    s_barrier
    s_add_u32 s22, s17, 4
    s_sub_u32 s20, s17, 4
    s_cmp_ge_u32 s17, 4
    s_cselect_b32 s22, s20, s22
mega_kernel_x_gp:
    buffer_load_dword v3, v12, s[84:87], 0 offen sc1
    s_waitcnt vmcnt(0)
    v_cmp_ne_u32 vcc, 32, v3
    s_cbranch_vccz mega_kernel_x_gk
    s_sleep 8
    s_branch mega_kernel_x_gp
mega_kernel_x_gk:
    s_mov_b32 s46, 0
    s_lshl_b32 s27, s22, 18
    s_lshl_b32 s20, s18, 13
    s_add_u32 s27, s27, s20
    s_add_u32 s29, s27, 178257920
    s_and_b32 s20, s16, 1
    s_lshl_b32 s20, s20, 10
    s_add_u32 s26, s27, s20
    s_add_u32 s26, s26, 0
    s_lshr_b32 s20, s16, 1
    s_lshl_b32 s20, s20, 12
    s_add_u32 s28, s27, s20
    s_add_u32 s28, s28, 33554432
    s_add_u32 s27, s27, 16777216
    s_add_u32 s48, s26, 4096
    s_add_u32 s49, s27, 4096
mega_kernel_x_ldq:
    buffer_load_dwordx4 v[24:27], v2, s[84:87], s26 offen offset:0
    buffer_load_dwordx4 v[28:31], v2, s[84:87], s26 offen offset:2048
    buffer_load_dwordx4 v[32:35], v2, s[84:87], s48 offen offset:0
    buffer_load_dwordx4 v[36:39], v2, s[84:87], s48 offen offset:2048
    buffer_load_dwordx4 v[40:43], v2, s[84:87], s27 offen offset:0
    buffer_load_dwordx4 v[44:47], v2, s[84:87], s27 offen offset:1024
    buffer_load_dwordx4 v[48:51], v2, s[84:87], s27 offen offset:2048
    buffer_load_dwordx4 v[52:55], v2, s[84:87], s27 offen offset:3072
    buffer_load_dwordx4 v[56:59], v2, s[84:87], s49 offen offset:0
    buffer_load_dwordx4 v[60:63], v2, s[84:87], s49 offen offset:1024
    buffer_load_dwordx4 v[64:67], v2, s[84:87], s49 offen offset:2048
    buffer_load_dwordx4 v[68:71], v2, s[84:87], s49 offen offset:3072
    buffer_load_dwordx4 v[72:75], v2, s[84:87], s28 offen offset:0
    buffer_load_dwordx4 v[76:79], v2, s[84:87], s28 offen offset:1024
    buffer_load_dwordx4 v[80:83], v2, s[84:87], s28 offen offset:2048
    buffer_load_dwordx4 v[84:87], v2, s[84:87], s28 offen offset:3072
mega_kernel_x_att:
    s_waitcnt vmcnt(0)
    v_mfma_f32_16x16x32_bf16 v[112:115], v[40:43], v[24:27], 0
    v_mfma_f32_16x16x32_bf16 v[116:119], v[44:47], v[24:27], 0
    v_mfma_f32_16x16x32_bf16 v[112:115], v[48:51], v[28:31], v[112:115]
    v_mfma_f32_16x16x32_bf16 v[116:119], v[52:55], v[28:31], v[116:119]
    v_mfma_f32_16x16x32_bf16 v[112:115], v[56:59], v[32:35], v[112:115]
    v_mfma_f32_16x16x32_bf16 v[116:119], v[60:63], v[32:35], v[116:119]
    v_mfma_f32_16x16x32_bf16 v[112:115], v[64:67], v[36:39], v[112:115]
    v_mfma_f32_16x16x32_bf16 v[116:119], v[68:71], v[36:39], v[116:119]
    s_lshl_b32 s41, s47, 18
    s_add_u32 s41, s41, 50331648
    s_lshl_b32 s20, s18, 13
    s_add_u32 s40, s41, s20
    s_lshl_b32 s20, s16, 16
    s_add_u32 s41, s41, s20
    s_lshl_b32 s42, s22, 17
    v_mov_b32 v130, v20
    v_mov_b32 v131, 0
    v_cmp_gt_i32 vcc, 0, v9
    s_nop 1
    v_cndmask_b32 v112, v112, v11, vcc
    v_cmp_gt_i32 vcc, 1, v9
    s_nop 1
    v_cndmask_b32 v113, v113, v11, vcc
    v_cmp_gt_i32 vcc, 2, v9
    s_nop 1
    v_cndmask_b32 v114, v114, v11, vcc
    v_cmp_gt_i32 vcc, 3, v9
    s_nop 1
    v_cndmask_b32 v115, v115, v11, vcc
    v_cmp_gt_i32 vcc, 0, v10
    s_nop 1
    v_cndmask_b32 v116, v116, v11, vcc
    v_cmp_gt_i32 vcc, 1, v10
    s_nop 1
    v_cndmask_b32 v117, v117, v11, vcc
    v_cmp_gt_i32 vcc, 2, v10
    s_nop 1
    v_cndmask_b32 v118, v118, v11, vcc
    v_cmp_gt_i32 vcc, 3, v10
    s_nop 1
    v_cndmask_b32 v119, v119, v11, vcc
    s_cmp_eq_u32 s46, 1
    s_cbranch_scc1 mega_kernel_x_rd
mega_kernel_x_rp:
    buffer_load_dword v3, v13, s[84:87], 0 offen sc1
    s_waitcnt vmcnt(0)
    v_cmp_ge_u32 vcc, s22, v3
    s_cbranch_vccz mega_kernel_x_rk
    s_sleep 2
    s_branch mega_kernel_x_rp
mega_kernel_x_rk:
    buffer_load_dwordx4 v[88:91], v6, s[84:87], s29 offen offset:0 sc1
    buffer_load_dwordx4 v[92:95], v6, s[84:87], s29 offen offset:64 sc1
    buffer_load_dwordx4 v[96:99], v6, s[84:87], s29 offen offset:128 sc1
    buffer_load_dwordx4 v[100:103], v6, s[84:87], s29 offen offset:192 sc1
    buffer_load_dwordx2 v[104:105], v7, s[84:87], s29 offen offset:0 sc1
    buffer_load_dwordx2 v[106:107], v7, s[84:87], s29 offen offset:2048 sc1
    buffer_load_dwordx2 v[108:109], v7, s[84:87], s29 offen offset:512 sc1
    buffer_load_dwordx2 v[110:111], v7, s[84:87], s29 offen offset:2560 sc1
mega_kernel_x_rd:
    s_waitcnt vmcnt(7)
    v_mfma_f32_16x16x32_bf16 v[120:123], v[88:91], v[24:27], 0
    s_waitcnt vmcnt(6)
    v_mfma_f32_16x16x32_bf16 v[120:123], v[92:95], v[28:31], v[120:123]
    s_waitcnt vmcnt(5)
    v_mfma_f32_16x16x32_bf16 v[120:123], v[96:99], v[32:35], v[120:123]
    s_waitcnt vmcnt(4)
    v_mfma_f32_16x16x32_bf16 v[120:123], v[100:103], v[36:39], v[120:123]
    v_max3_f32 v4, v112, v113, v114
    v_max3_f32 v4, v4, v115, v116
    v_max3_f32 v4, v4, v117, v118
    s_waitcnt vmcnt(0)
    v_swap_b32 v105, v106
    v_swap_b32 v109, v110
    s_nop 1
    v_max3_f32 v4, v4, v119, v120
    v_max_f32 v3, v4, v121
    v_max_f32 v4, v4, v121
    s_nop 1
    v_permlane16_swap_b32 v4, v3
    v_max_f32 v4, v4, v3
    v_max_f32 v3, v4, v3
    s_nop 1
    v_permlane32_swap_b32 v4, v3
    v_max_f32 v4, v4, v3
    v_mul_f32 v4, s24, v4
    v_fma_f32 v112, v112, s24, -v4
    v_fma_f32 v113, v113, s24, -v4
    v_fma_f32 v114, v114, s24, -v4
    v_fma_f32 v115, v115, s24, -v4
    v_fma_f32 v116, v116, s24, -v4
    v_fma_f32 v117, v117, s24, -v4
    v_fma_f32 v118, v118, s24, -v4
    v_fma_f32 v119, v119, s24, -v4
    v_fma_f32 v120, v120, s24, -v4
    v_fma_f32 v121, v121, s24, -v4
    v_exp_f32 v112, v112
    v_exp_f32 v113, v113
    v_exp_f32 v114, v114
    v_exp_f32 v115, v115
    v_exp_f32 v116, v116
    v_exp_f32 v117, v117
    v_exp_f32 v118, v118
    v_exp_f32 v119, v119
    v_exp_f32 v120, v120
    v_exp_f32 v121, v121
    s_nop 0
    v_cvt_pk_bf16_f32 v124, v112, v113
    v_cvt_pk_bf16_f32 v125, v114, v115
    v_cvt_pk_bf16_f32 v126, v116, v117
    v_cvt_pk_bf16_f32 v127, v118, v119
    v_cvt_pk_bf16_f32 v128, v120, v121
    v_mov_b32 v129, v128
    s_nop 1
    v_mfma_f32_16x16x32_bf16 v[132:135], v[20:23], v[124:127], 0
    v_mfma_f32_16x16x32_bf16 v[88:91], v[72:75], v[124:127], 0
    v_mfma_f32_16x16x32_bf16 v[92:95], v[76:79], v[124:127], 0
    v_mfma_f32_16x16x32_bf16 v[96:99], v[80:83], v[124:127], 0
    v_mfma_f32_16x16x32_bf16 v[100:103], v[84:87], v[124:127], 0
    s_nop 1
    v_mfma_f32_16x16x16_bf16 v[132:135], v[130:131], v[128:129], v[132:135]
    v_mfma_f32_16x16x16_bf16 v[88:91], v[104:105], v[128:129], v[88:91]
    v_mfma_f32_16x16x16_bf16 v[92:95], v[106:107], v[128:129], v[92:95]
    v_mfma_f32_16x16x16_bf16 v[96:99], v[108:109], v[128:129], v[96:99]
    v_mfma_f32_16x16x16_bf16 v[100:103], v[110:111], v[128:129], v[100:103]
    s_nop 3
    v_rcp_f32 v132, v132
    s_nop 2
    v_pk_mul_f32 v[88:89], v[88:89], v[132:133] op_sel_hi:[1,0]
    v_pk_mul_f32 v[90:91], v[90:91], v[132:133] op_sel_hi:[1,0]
    v_pk_mul_f32 v[92:93], v[92:93], v[132:133] op_sel_hi:[1,0]
    v_pk_mul_f32 v[94:95], v[94:95], v[132:133] op_sel_hi:[1,0]
    v_pk_mul_f32 v[96:97], v[96:97], v[132:133] op_sel_hi:[1,0]
    v_pk_mul_f32 v[98:99], v[98:99], v[132:133] op_sel_hi:[1,0]
    v_pk_mul_f32 v[100:101], v[100:101], v[132:133] op_sel_hi:[1,0]
    v_pk_mul_f32 v[102:103], v[102:103], v[132:133] op_sel_hi:[1,0]
    v_cvt_pk_bf16_f32 v112, v88, v89
    v_cvt_pk_bf16_f32 v113, v90, v91
    v_cvt_pk_bf16_f32 v114, v92, v93
    v_cvt_pk_bf16_f32 v115, v94, v95
    v_cvt_pk_bf16_f32 v116, v96, v97
    v_cvt_pk_bf16_f32 v117, v98, v99
    v_cvt_pk_bf16_f32 v118, v100, v101
    v_cvt_pk_bf16_f32 v119, v102, v103
    s_add_u32 s43, s22, 1
    v_mov_b32 v4, s43
    s_cmp_eq_u32 s96, 1
    s_cbranch_scc1 mega_kernel_x_of
    buffer_store_dwordx4 v[112:115], v8, s[84:87], s40 offen sc1
    buffer_store_dwordx4 v[116:119], v8, s[84:87], s40 offen offset:2048 sc1
    s_waitcnt vmcnt(0)
    s_barrier
    buffer_store_dword v4, v15, s[84:87], 0 offen sc1
    s_branch mega_kernel_x_od
mega_kernel_x_of:
    buffer_store_dwordx4 v[112:115], v8, s[84:87], s40 offen
    buffer_store_dwordx4 v[116:119], v8, s[84:87], s40 offen offset:2048
    s_waitcnt vmcnt(0)
    s_barrier
    buffer_store_dword v4, v15, s[84:87], 0 offen
mega_kernel_x_od:
    s_mov_b32 s45, s22
    s_add_u32 s20, s47, 1
    s_and_b32 s20, s20, 3
    s_andn2_b32 s47, s47, 3
    s_or_b32 s47, s47, s20
    s_add_u32 s20, s22, 2
    s_add_u32 s21, s17, 4
    s_cmp_lt_u32 s20, 4
    s_cselect_b32 s20, s20, s21
    s_add_u32 s21, s22, 6
    s_cmp_lt_u32 s22, 4
    s_cselect_b32 s22, s20, s21
    s_lshr_b32 s20, s17, 1
    s_add_u32 s20, s20, 58
    s_cmp_ge_u32 s22, 58
    s_cselect_b32 s22, s20, s22
    s_add_u32 s20, s45, 3
    s_cmp_ge_u32 s45, 58
    s_cselect_b32 s22, s20, s22
    s_lshl_b32 s27, s22, 18
    s_lshl_b32 s20, s18, 13
    s_add_u32 s27, s27, s20
    s_add_u32 s29, s27, 178257920
    s_and_b32 s20, s16, 1
    s_lshl_b32 s20, s20, 10
    s_add_u32 s26, s27, s20
    s_add_u32 s26, s26, 0
    s_lshr_b32 s20, s16, 1
    s_lshl_b32 s20, s20, 12
    s_add_u32 s28, s27, s20
    s_add_u32 s28, s28, 33554432
    s_add_u32 s27, s27, 16777216
    s_add_u32 s48, s26, 4096
    s_add_u32 s49, s27, 4096
mega_kernel_x_xp:
    buffer_load_dword v3, v14, s[84:87], 0 offen sc1
    s_waitcnt vmcnt(0)
    v_cmp_ge_u32 vcc, s45, v3
    s_cbranch_vccnz mega_kernel_x_xp
    s_cmp_ge_u32 s45, 58
    s_cbranch_scc1 mega_kernel_x_half
    s_add_u32 s20, s50, 0
    s_and_b32 s20, s20, 0xffff
    s_add_u32 s20, s20, s41
    buffer_load_dwordx4 v[136:139], v2, s[84:87], s20 offen offset:0 sc1
    buffer_load_dwordx4 v[140:143], v2, s[84:87], s20 offen offset:1024 sc1
    buffer_load_dwordx4 v[144:147], v2, s[84:87], s20 offen offset:2048 sc1
    buffer_load_dwordx4 v[148:151], v2, s[84:87], s20 offen offset:3072 sc1
    s_add_u32 s20, s50, 4096
    s_and_b32 s20, s20, 0xffff
    s_add_u32 s20, s20, s41
    buffer_load_dwordx4 v[152:155], v2, s[84:87], s20 offen offset:0 sc1
    buffer_load_dwordx4 v[156:159], v2, s[84:87], s20 offen offset:1024 sc1
    buffer_load_dwordx4 v[160:163], v2, s[84:87], s20 offen offset:2048 sc1
    buffer_load_dwordx4 v[164:167], v2, s[84:87], s20 offen offset:3072 sc1
    s_add_u32 s20, s50, 8192
    s_and_b32 s20, s20, 0xffff
    s_add_u32 s20, s20, s41
    buffer_load_dwordx4 v[168:171], v2, s[84:87], s20 offen offset:0 sc1
    buffer_load_dwordx4 v[172:175], v2, s[84:87], s20 offen offset:1024 sc1
    buffer_load_dwordx4 v[176:179], v2, s[84:87], s20 offen offset:2048 sc1
    buffer_load_dwordx4 v[180:183], v2, s[84:87], s20 offen offset:3072 sc1
    buffer_load_dword v5, v13, s[84:87], 0 offen sc1
    s_waitcnt vmcnt(12)
    v_mfma_f32_32x32x16_bf16 v[112:127], a[0:3], v[136:139], 0
    s_add_u32 s20, s50, 12288
    s_and_b32 s20, s20, 0xffff
    s_add_u32 s20, s20, s41
    buffer_load_dwordx4 v[184:187], v2, s[84:87], s20 offen offset:0 sc1
    s_waitcnt vmcnt(12)
    v_mfma_f32_32x32x16_bf16 v[112:127], a[4:7], v[140:143], v[112:127]
    buffer_load_dwordx4 v[188:191], v2, s[84:87], s20 offen offset:1024 sc1
    s_waitcnt vmcnt(12)
    v_mfma_f32_32x32x16_bf16 v[112:127], a[8:11], v[144:147], v[112:127]
    buffer_load_dwordx4 v[192:195], v2, s[84:87], s20 offen offset:2048 sc1
    s_waitcnt vmcnt(12)
    v_mfma_f32_32x32x16_bf16 v[112:127], a[12:15], v[148:151], v[112:127]
    buffer_load_dwordx4 v[196:199], v2, s[84:87], s20 offen offset:3072 sc1
    s_waitcnt vmcnt(12)
    v_mfma_f32_32x32x16_bf16 v[112:127], a[16:19], v[152:155], v[112:127]
    s_add_u32 s20, s50, 16384
    s_and_b32 s20, s20, 0xffff
    s_add_u32 s20, s20, s41
    buffer_load_dwordx4 v[200:203], v2, s[84:87], s20 offen offset:0 sc1
    s_waitcnt vmcnt(12)
    v_mfma_f32_32x32x16_bf16 v[112:127], a[20:23], v[156:159], v[112:127]
    buffer_load_dwordx4 v[204:207], v2, s[84:87], s20 offen offset:1024 sc1
    s_waitcnt vmcnt(12)
    v_mfma_f32_32x32x16_bf16 v[112:127], a[24:27], v[160:163], v[112:127]
    buffer_load_dwordx4 v[208:211], v2, s[84:87], s20 offen offset:2048 sc1
    s_waitcnt vmcnt(12)
    v_mfma_f32_32x32x16_bf16 v[112:127], a[28:31], v[164:167], v[112:127]
    buffer_load_dwordx4 v[212:215], v2, s[84:87], s20 offen offset:3072 sc1
    s_waitcnt vmcnt(12)
    v_mfma_f32_32x32x16_bf16 v[112:127], a[32:35], v[168:171], v[112:127]
    s_add_u32 s20, s50, 20480
    s_and_b32 s20, s20, 0xffff
    s_add_u32 s20, s20, s41
    buffer_load_dwordx4 v[216:219], v2, s[84:87], s20 offen offset:0 sc1
    s_waitcnt vmcnt(12)
    v_mfma_f32_32x32x16_bf16 v[112:127], a[36:39], v[172:175], v[112:127]
    buffer_load_dwordx4 v[220:223], v2, s[84:87], s20 offen offset:1024 sc1
    s_waitcnt vmcnt(12)
    v_mfma_f32_32x32x16_bf16 v[112:127], a[40:43], v[176:179], v[112:127]
    buffer_load_dwordx4 v[224:227], v2, s[84:87], s20 offen offset:2048 sc1
    s_waitcnt vmcnt(12)
    v_mfma_f32_32x32x16_bf16 v[112:127], a[44:47], v[180:183], v[112:127]
    buffer_load_dwordx4 v[228:231], v2, s[84:87], s20 offen offset:3072 sc1
    s_waitcnt vmcnt(11)
    v_mfma_f32_32x32x16_bf16 v[112:127], a[48:51], v[184:187], v[112:127]
    s_add_u32 s20, s50, 24576
    s_and_b32 s20, s20, 0xffff
    s_add_u32 s20, s20, s41
    buffer_load_dwordx4 v[232:235], v2, s[84:87], s20 offen offset:0 sc1
    v_cmp_ge_u32 vcc, s22, v5
    s_waitcnt vmcnt(11)
    v_mfma_f32_32x32x16_bf16 v[112:127], a[52:55], v[188:191], v[112:127]
    buffer_load_dwordx4 v[236:239], v2, s[84:87], s20 offen offset:1024 sc1
    s_cmp_eq_u64 vcc, 0
    s_cselect_b32 s46, 1, 0
    s_waitcnt vmcnt(11)
    v_mfma_f32_32x32x16_bf16 v[112:127], a[56:59], v[192:195], v[112:127]
    buffer_load_dwordx4 v[240:243], v2, s[84:87], s20 offen offset:2048 sc1
    s_waitcnt vmcnt(11)
    v_mfma_f32_32x32x16_bf16 v[112:127], a[60:63], v[196:199], v[112:127]
    buffer_load_dwordx4 v[244:247], v2, s[84:87], s20 offen offset:3072 sc1
    s_waitcnt vmcnt(11)
    v_mfma_f32_32x32x16_bf16 v[112:127], a[64:67], v[200:203], v[112:127]
    s_add_u32 s20, s50, 28672
    s_and_b32 s20, s20, 0xffff
    s_add_u32 s20, s20, s41
    buffer_load_dwordx4 v[248:251], v2, s[84:87], s20 offen offset:0 sc1
    s_waitcnt vmcnt(11)
    v_mfma_f32_32x32x16_bf16 v[112:127], a[68:71], v[204:207], v[112:127]
    buffer_load_dwordx4 v[252:255], v2, s[84:87], s20 offen offset:1024 sc1
    s_waitcnt vmcnt(11)
    v_mfma_f32_32x32x16_bf16 v[112:127], a[72:75], v[208:211], v[112:127]
    buffer_load_dwordx4 v[136:139], v2, s[84:87], s20 offen offset:2048 sc1
    s_waitcnt vmcnt(11)
    v_mfma_f32_32x32x16_bf16 v[112:127], a[76:79], v[212:215], v[112:127]
    buffer_load_dwordx4 v[140:143], v2, s[84:87], s20 offen offset:3072 sc1
    s_waitcnt vmcnt(11)
    v_mfma_f32_32x32x16_bf16 v[112:127], a[80:83], v[216:219], v[112:127]
    s_add_u32 s20, s50, 32768
    s_and_b32 s20, s20, 0xffff
    s_add_u32 s20, s20, s41
    buffer_load_dwordx4 v[144:147], v2, s[84:87], s20 offen offset:0 sc1
    s_waitcnt vmcnt(11)
    v_mfma_f32_32x32x16_bf16 v[112:127], a[84:87], v[220:223], v[112:127]
    buffer_load_dwordx4 v[148:151], v2, s[84:87], s20 offen offset:1024 sc1
    s_waitcnt vmcnt(11)
    v_mfma_f32_32x32x16_bf16 v[112:127], a[88:91], v[224:227], v[112:127]
    buffer_load_dwordx4 v[152:155], v2, s[84:87], s20 offen offset:2048 sc1
    s_waitcnt vmcnt(11)
    v_mfma_f32_32x32x16_bf16 v[112:127], a[92:95], v[228:231], v[112:127]
    buffer_load_dwordx4 v[156:159], v2, s[84:87], s20 offen offset:3072 sc1
    s_waitcnt vmcnt(11)
    v_mfma_f32_32x32x16_bf16 v[112:127], a[96:99], v[232:235], v[112:127]
    s_add_u32 s20, s50, 36864
    s_and_b32 s20, s20, 0xffff
    s_add_u32 s20, s20, s41
    buffer_load_dwordx4 v[160:163], v2, s[84:87], s20 offen offset:0 sc1
    s_waitcnt vmcnt(11)
    v_mfma_f32_32x32x16_bf16 v[112:127], a[100:103], v[236:239], v[112:127]
    buffer_load_dwordx4 v[164:167], v2, s[84:87], s20 offen offset:1024 sc1
    s_waitcnt vmcnt(11)
    v_mfma_f32_32x32x16_bf16 v[112:127], a[104:107], v[240:243], v[112:127]
    buffer_load_dwordx4 v[168:171], v2, s[84:87], s20 offen offset:2048 sc1
    s_waitcnt vmcnt(11)
    v_mfma_f32_32x32x16_bf16 v[112:127], a[108:111], v[244:247], v[112:127]
    buffer_load_dwordx4 v[172:175], v2, s[84:87], s20 offen offset:3072 sc1
    s_waitcnt vmcnt(11)
    v_mfma_f32_32x32x16_bf16 v[112:127], a[112:115], v[248:251], v[112:127]
    s_add_u32 s20, s50, 40960
    s_and_b32 s20, s20, 0xffff
    s_add_u32 s20, s20, s41
    buffer_load_dwordx4 v[176:179], v2, s[84:87], s20 offen offset:0 sc1
    s_waitcnt vmcnt(11)
    v_mfma_f32_32x32x16_bf16 v[112:127], a[116:119], v[252:255], v[112:127]
    buffer_load_dwordx4 v[180:183], v2, s[84:87], s20 offen offset:1024 sc1
    s_waitcnt vmcnt(11)
    v_mfma_f32_32x32x16_bf16 v[112:127], a[120:123], v[136:139], v[112:127]
    buffer_load_dwordx4 v[184:187], v2, s[84:87], s20 offen offset:2048 sc1
    s_waitcnt vmcnt(11)
    v_mfma_f32_32x32x16_bf16 v[112:127], a[124:127], v[140:143], v[112:127]
    buffer_load_dwordx4 v[188:191], v2, s[84:87], s20 offen offset:3072 sc1
    s_waitcnt vmcnt(11)
    v_mfma_f32_32x32x16_bf16 v[112:127], a[128:131], v[144:147], v[112:127]
    s_add_u32 s20, s50, 45056
    s_and_b32 s20, s20, 0xffff
    s_add_u32 s20, s20, s41
    buffer_load_dwordx4 v[192:195], v2, s[84:87], s20 offen offset:0 sc1
    s_waitcnt vmcnt(11)
    v_mfma_f32_32x32x16_bf16 v[112:127], a[132:135], v[148:151], v[112:127]
    buffer_load_dwordx4 v[196:199], v2, s[84:87], s20 offen offset:1024 sc1
    s_waitcnt vmcnt(11)
    v_mfma_f32_32x32x16_bf16 v[112:127], a[136:139], v[152:155], v[112:127]
    buffer_load_dwordx4 v[200:203], v2, s[84:87], s20 offen offset:2048 sc1
    s_waitcnt vmcnt(11)
    v_mfma_f32_32x32x16_bf16 v[112:127], a[140:143], v[156:159], v[112:127]
    buffer_load_dwordx4 v[204:207], v2, s[84:87], s20 offen offset:3072 sc1
    s_waitcnt vmcnt(11)
    v_mfma_f32_32x32x16_bf16 v[112:127], a[144:147], v[160:163], v[112:127]
    s_add_u32 s20, s50, 49152
    s_and_b32 s20, s20, 0xffff
    s_add_u32 s20, s20, s41
    buffer_load_dwordx4 v[208:211], v2, s[84:87], s20 offen offset:0 sc1
    s_waitcnt vmcnt(11)
    v_mfma_f32_32x32x16_bf16 v[112:127], a[148:151], v[164:167], v[112:127]
    buffer_load_dwordx4 v[212:215], v2, s[84:87], s20 offen offset:1024 sc1
    s_waitcnt vmcnt(11)
    v_mfma_f32_32x32x16_bf16 v[112:127], a[152:155], v[168:171], v[112:127]
    buffer_load_dwordx4 v[216:219], v2, s[84:87], s20 offen offset:2048 sc1
    s_waitcnt vmcnt(11)
    v_mfma_f32_32x32x16_bf16 v[112:127], a[156:159], v[172:175], v[112:127]
    buffer_load_dwordx4 v[220:223], v2, s[84:87], s20 offen offset:3072 sc1
    s_waitcnt vmcnt(11)
    v_mfma_f32_32x32x16_bf16 v[112:127], a[160:163], v[176:179], v[112:127]
    s_add_u32 s20, s50, 53248
    s_and_b32 s20, s20, 0xffff
    s_add_u32 s20, s20, s41
    buffer_load_dwordx4 v[224:227], v2, s[84:87], s20 offen offset:0 sc1
    s_waitcnt vmcnt(11)
    v_mfma_f32_32x32x16_bf16 v[112:127], a[164:167], v[180:183], v[112:127]
    buffer_load_dwordx4 v[228:231], v2, s[84:87], s20 offen offset:1024 sc1
    s_waitcnt vmcnt(11)
    v_mfma_f32_32x32x16_bf16 v[112:127], a[168:171], v[184:187], v[112:127]
    buffer_load_dwordx4 v[232:235], v2, s[84:87], s20 offen offset:2048 sc1
    s_waitcnt vmcnt(11)
    v_mfma_f32_32x32x16_bf16 v[112:127], a[172:175], v[188:191], v[112:127]
    buffer_load_dwordx4 v[236:239], v2, s[84:87], s20 offen offset:3072 sc1
    s_waitcnt vmcnt(11)
    v_mfma_f32_32x32x16_bf16 v[112:127], a[176:179], v[192:195], v[112:127]
    s_add_u32 s20, s50, 57344
    s_and_b32 s20, s20, 0xffff
    s_add_u32 s20, s20, s41
    buffer_load_dwordx4 v[240:243], v2, s[84:87], s20 offen offset:0 sc1
    s_waitcnt vmcnt(11)
    v_mfma_f32_32x32x16_bf16 v[112:127], a[180:183], v[196:199], v[112:127]
    buffer_load_dwordx4 v[244:247], v2, s[84:87], s20 offen offset:1024 sc1
    s_waitcnt vmcnt(11)
    v_mfma_f32_32x32x16_bf16 v[112:127], a[184:187], v[200:203], v[112:127]
    buffer_load_dwordx4 v[248:251], v2, s[84:87], s20 offen offset:2048 sc1
    s_waitcnt vmcnt(11)
    v_mfma_f32_32x32x16_bf16 v[112:127], a[188:191], v[204:207], v[112:127]
    buffer_load_dwordx4 v[252:255], v2, s[84:87], s20 offen offset:3072 sc1
    s_waitcnt vmcnt(11)
    v_mfma_f32_32x32x16_bf16 v[112:127], a[192:195], v[208:211], v[112:127]
    s_add_u32 s20, s50, 61440
    s_and_b32 s20, s20, 0xffff
    s_add_u32 s20, s20, s41
    buffer_load_dwordx4 v[136:139], v2, s[84:87], s20 offen offset:0 sc1
    s_waitcnt vmcnt(11)
    v_mfma_f32_32x32x16_bf16 v[112:127], a[196:199], v[212:215], v[112:127]
    buffer_load_dwordx4 v[140:143], v2, s[84:87], s20 offen offset:1024 sc1
    s_waitcnt vmcnt(11)
    v_mfma_f32_32x32x16_bf16 v[112:127], a[200:203], v[216:219], v[112:127]
    buffer_load_dwordx4 v[144:147], v2, s[84:87], s20 offen offset:2048 sc1
    s_waitcnt vmcnt(11)
    v_mfma_f32_32x32x16_bf16 v[112:127], a[204:207], v[220:223], v[112:127]
    buffer_load_dwordx4 v[148:151], v2, s[84:87], s20 offen offset:3072 sc1
    s_cmp_eq_u32 s46, 1
    s_cbranch_scc1 mega_kernel_x_pfx
    s_waitcnt vmcnt(11)
    v_mfma_f32_32x32x16_bf16 v[112:127], a[208:211], v[224:227], v[112:127]
    s_waitcnt vmcnt(10)
    v_mfma_f32_32x32x16_bf16 v[112:127], a[212:215], v[228:231], v[112:127]
    s_waitcnt vmcnt(9)
    v_mfma_f32_32x32x16_bf16 v[112:127], a[216:219], v[232:235], v[112:127]
    s_waitcnt vmcnt(8)
    v_mfma_f32_32x32x16_bf16 v[112:127], a[220:223], v[236:239], v[112:127]
    s_waitcnt vmcnt(7)
    v_mfma_f32_32x32x16_bf16 v[112:127], a[224:227], v[240:243], v[112:127]
    s_waitcnt vmcnt(6)
    v_mfma_f32_32x32x16_bf16 v[112:127], a[228:231], v[244:247], v[112:127]
    s_waitcnt vmcnt(5)
    v_mfma_f32_32x32x16_bf16 v[112:127], a[232:235], v[248:251], v[112:127]
    s_waitcnt vmcnt(4)
    v_mfma_f32_32x32x16_bf16 v[112:127], a[236:239], v[252:255], v[112:127]
    s_waitcnt vmcnt(3)
    v_mfma_f32_32x32x16_bf16 v[112:127], a[240:243], v[136:139], v[112:127]
    s_waitcnt vmcnt(2)
    v_mfma_f32_32x32x16_bf16 v[112:127], a[244:247], v[140:143], v[112:127]
    s_waitcnt vmcnt(1)
    v_mfma_f32_32x32x16_bf16 v[112:127], a[248:251], v[144:147], v[112:127]
    s_waitcnt vmcnt(0)
    v_mfma_f32_32x32x16_bf16 v[112:127], a[252:255], v[148:151], v[112:127]
    s_branch mega_kernel_x_pfd
mega_kernel_x_pfx:
    s_waitcnt vmcnt(11)
    v_mfma_f32_32x32x16_bf16 v[112:127], a[208:211], v[224:227], v[112:127]
    buffer_load_dwordx4 v[24:27], v2, s[84:87], s26 offen offset:0
    buffer_load_dwordx4 v[28:31], v2, s[84:87], s26 offen offset:2048
    s_waitcnt vmcnt(12)
    v_mfma_f32_32x32x16_bf16 v[112:127], a[212:215], v[228:231], v[112:127]
    buffer_load_dwordx4 v[32:35], v2, s[84:87], s48 offen offset:0
    buffer_load_dwordx4 v[36:39], v2, s[84:87], s48 offen offset:2048
    s_waitcnt vmcnt(13)
    v_mfma_f32_32x32x16_bf16 v[112:127], a[216:219], v[232:235], v[112:127]
    buffer_load_dwordx4 v[40:43], v2, s[84:87], s27 offen offset:0
    buffer_load_dwordx4 v[44:47], v2, s[84:87], s27 offen offset:1024
    s_waitcnt vmcnt(14)
    v_mfma_f32_32x32x16_bf16 v[112:127], a[220:223], v[236:239], v[112:127]
    buffer_load_dwordx4 v[48:51], v2, s[84:87], s27 offen offset:2048
    buffer_load_dwordx4 v[52:55], v2, s[84:87], s27 offen offset:3072
    s_waitcnt vmcnt(15)
    v_mfma_f32_32x32x16_bf16 v[112:127], a[224:227], v[240:243], v[112:127]
    buffer_load_dwordx4 v[56:59], v2, s[84:87], s49 offen offset:0
    buffer_load_dwordx4 v[60:63], v2, s[84:87], s49 offen offset:1024
    s_waitcnt vmcnt(16)
    v_mfma_f32_32x32x16_bf16 v[112:127], a[228:231], v[244:247], v[112:127]
    buffer_load_dwordx4 v[64:67], v2, s[84:87], s49 offen offset:2048
    buffer_load_dwordx4 v[68:71], v2, s[84:87], s49 offen offset:3072
    s_waitcnt vmcnt(17)
    v_mfma_f32_32x32x16_bf16 v[112:127], a[232:235], v[248:251], v[112:127]
    buffer_load_dwordx4 v[72:75], v2, s[84:87], s28 offen offset:0
    buffer_load_dwordx4 v[76:79], v2, s[84:87], s28 offen offset:1024
    s_waitcnt vmcnt(18)
    v_mfma_f32_32x32x16_bf16 v[112:127], a[236:239], v[252:255], v[112:127]
    buffer_load_dwordx4 v[80:83], v2, s[84:87], s28 offen offset:2048
    buffer_load_dwordx4 v[84:87], v2, s[84:87], s28 offen offset:3072
    s_waitcnt vmcnt(19)
    v_mfma_f32_32x32x16_bf16 v[112:127], a[240:243], v[136:139], v[112:127]
    buffer_load_dwordx4 v[88:91], v6, s[84:87], s29 offen offset:0 sc1
    buffer_load_dwordx4 v[92:95], v6, s[84:87], s29 offen offset:64 sc1
    s_waitcnt vmcnt(20)
    v_mfma_f32_32x32x16_bf16 v[112:127], a[244:247], v[140:143], v[112:127]
    buffer_load_dwordx4 v[96:99], v6, s[84:87], s29 offen offset:128 sc1
    buffer_load_dwordx4 v[100:103], v6, s[84:87], s29 offen offset:192 sc1
    s_waitcnt vmcnt(21)
    v_mfma_f32_32x32x16_bf16 v[112:127], a[248:251], v[144:147], v[112:127]
    buffer_load_dwordx2 v[104:105], v7, s[84:87], s29 offen offset:0 sc1
    buffer_load_dwordx2 v[106:107], v7, s[84:87], s29 offen offset:2048 sc1
    s_waitcnt vmcnt(22)
    v_mfma_f32_32x32x16_bf16 v[112:127], a[252:255], v[148:151], v[112:127]
    buffer_load_dwordx2 v[108:109], v7, s[84:87], s29 offen offset:512 sc1
    buffer_load_dwordx2 v[110:111], v7, s[84:87], s29 offen offset:2560 sc1
mega_kernel_x_pfd:
    s_nop 11
    ds_write_b128 v17, v[112:115] offset:0
    ds_write_b128 v17, v[116:119] offset:1024
    ds_write_b128 v17, v[120:123] offset:2048
    ds_write_b128 v17, v[124:127] offset:3072
    s_waitcnt lgkmcnt(0)
    s_barrier
    ds_read_b128 v[112:115], v16 offset:0
    ds_read_b128 v[116:119], v16 offset:4096
    ds_read_b128 v[120:123], v16 offset:8192
    ds_read_b128 v[124:127], v16 offset:12288
    s_waitcnt lgkmcnt(0)
    v_pk_add_f32 v[112:113], v[112:113], v[116:117]
    v_pk_add_f32 v[114:115], v[114:115], v[118:119]
    v_pk_add_f32 v[120:121], v[120:121], v[124:125]
    v_pk_add_f32 v[122:123], v[122:123], v[126:127]
    v_pk_add_f32 v[112:113], v[112:113], v[120:121]
    v_pk_add_f32 v[114:115], v[114:115], v[122:123]
    v_cvt_pk_bf16_f32 v132, v112, v113
    v_cvt_pk_bf16_f32 v133, v114, v115
    buffer_store_dwordx2 v[132:133], v18, s[12:15], s42 offen
    s_branch mega_kernel_x_nxt
mega_kernel_x_half:
    s_add_u32 s20, s50, 0
    s_and_b32 s20, s20, 0xffff
    s_add_u32 s20, s20, s41
    buffer_load_dwordx4 v[136:139], v19, s[84:87], s20 offen offset:0 sc1
    buffer_load_dwordx4 v[140:143], v19, s[84:87], s20 offen offset:2048 sc1
    s_add_u32 s20, s50, 4096
    s_and_b32 s20, s20, 0xffff
    s_add_u32 s20, s20, s41
    buffer_load_dwordx4 v[144:147], v19, s[84:87], s20 offen offset:0 sc1
    buffer_load_dwordx4 v[148:151], v19, s[84:87], s20 offen offset:2048 sc1
    s_add_u32 s20, s50, 8192
    s_and_b32 s20, s20, 0xffff
    s_add_u32 s20, s20, s41
    buffer_load_dwordx4 v[152:155], v19, s[84:87], s20 offen offset:0 sc1
    buffer_load_dwordx4 v[156:159], v19, s[84:87], s20 offen offset:2048 sc1
    s_add_u32 s20, s50, 12288
    s_and_b32 s20, s20, 0xffff
    s_add_u32 s20, s20, s41
    buffer_load_dwordx4 v[160:163], v19, s[84:87], s20 offen offset:0 sc1
    buffer_load_dwordx4 v[164:167], v19, s[84:87], s20 offen offset:2048 sc1
    s_add_u32 s20, s50, 16384
    s_and_b32 s20, s20, 0xffff
    s_add_u32 s20, s20, s41
    buffer_load_dwordx4 v[168:171], v19, s[84:87], s20 offen offset:0 sc1
    buffer_load_dwordx4 v[172:175], v19, s[84:87], s20 offen offset:2048 sc1
    s_add_u32 s20, s50, 20480
    s_and_b32 s20, s20, 0xffff
    s_add_u32 s20, s20, s41
    buffer_load_dwordx4 v[176:179], v19, s[84:87], s20 offen offset:0 sc1
    buffer_load_dwordx4 v[180:183], v19, s[84:87], s20 offen offset:2048 sc1
    s_mov_b32 s46, 0
    s_waitcnt vmcnt(11)
    v_mfma_f32_32x32x16_bf16 v[112:127], a[0:3], v[136:139], 0
    v_mfma_f32_32x32x16_bf16 v[88:103], a[4:7], v[136:139], 0
    s_add_u32 s20, s50, 24576
    s_and_b32 s20, s20, 0xffff
    s_add_u32 s20, s20, s41
    buffer_load_dwordx4 v[184:187], v19, s[84:87], s20 offen offset:0 sc1
    s_waitcnt vmcnt(11)
    v_mfma_f32_32x32x16_bf16 v[112:127], a[8:11], v[140:143], v[112:127]
    v_mfma_f32_32x32x16_bf16 v[88:103], a[12:15], v[140:143], v[88:103]
    buffer_load_dwordx4 v[188:191], v19, s[84:87], s20 offen offset:2048 sc1
    s_waitcnt vmcnt(11)
    v_mfma_f32_32x32x16_bf16 v[112:127], a[16:19], v[144:147], v[112:127]
    v_mfma_f32_32x32x16_bf16 v[88:103], a[20:23], v[144:147], v[88:103]
    s_add_u32 s20, s50, 28672
    s_and_b32 s20, s20, 0xffff
    s_add_u32 s20, s20, s41
    buffer_load_dwordx4 v[192:195], v19, s[84:87], s20 offen offset:0 sc1
    s_waitcnt vmcnt(11)
    v_mfma_f32_32x32x16_bf16 v[112:127], a[24:27], v[148:151], v[112:127]
    v_mfma_f32_32x32x16_bf16 v[88:103], a[28:31], v[148:151], v[88:103]
    buffer_load_dwordx4 v[196:199], v19, s[84:87], s20 offen offset:2048 sc1
    s_waitcnt vmcnt(11)
    v_mfma_f32_32x32x16_bf16 v[112:127], a[32:35], v[152:155], v[112:127]
    v_mfma_f32_32x32x16_bf16 v[88:103], a[36:39], v[152:155], v[88:103]
    s_add_u32 s20, s50, 32768
    s_and_b32 s20, s20, 0xffff
    s_add_u32 s20, s20, s41
    buffer_load_dwordx4 v[200:203], v19, s[84:87], s20 offen offset:0 sc1
    s_waitcnt vmcnt(11)
    v_mfma_f32_32x32x16_bf16 v[112:127], a[40:43], v[156:159], v[112:127]
    v_mfma_f32_32x32x16_bf16 v[88:103], a[44:47], v[156:159], v[88:103]
    buffer_load_dwordx4 v[204:207], v19, s[84:87], s20 offen offset:2048 sc1
    s_waitcnt vmcnt(11)
    v_mfma_f32_32x32x16_bf16 v[112:127], a[48:51], v[160:163], v[112:127]
    v_mfma_f32_32x32x16_bf16 v[88:103], a[52:55], v[160:163], v[88:103]
    s_add_u32 s20, s50, 36864
    s_and_b32 s20, s20, 0xffff
    s_add_u32 s20, s20, s41
    buffer_load_dwordx4 v[208:211], v19, s[84:87], s20 offen offset:0 sc1
    s_waitcnt vmcnt(11)
    v_mfma_f32_32x32x16_bf16 v[112:127], a[56:59], v[164:167], v[112:127]
    v_mfma_f32_32x32x16_bf16 v[88:103], a[60:63], v[164:167], v[88:103]
    buffer_load_dwordx4 v[212:215], v19, s[84:87], s20 offen offset:2048 sc1
    s_waitcnt vmcnt(11)
    v_mfma_f32_32x32x16_bf16 v[112:127], a[64:67], v[168:171], v[112:127]
    v_mfma_f32_32x32x16_bf16 v[88:103], a[68:71], v[168:171], v[88:103]
    s_add_u32 s20, s50, 40960
    s_and_b32 s20, s20, 0xffff
    s_add_u32 s20, s20, s41
    buffer_load_dwordx4 v[216:219], v19, s[84:87], s20 offen offset:0 sc1
    s_waitcnt vmcnt(11)
    v_mfma_f32_32x32x16_bf16 v[112:127], a[72:75], v[172:175], v[112:127]
    v_mfma_f32_32x32x16_bf16 v[88:103], a[76:79], v[172:175], v[88:103]
    buffer_load_dwordx4 v[220:223], v19, s[84:87], s20 offen offset:2048 sc1
    s_waitcnt vmcnt(11)
    v_mfma_f32_32x32x16_bf16 v[112:127], a[80:83], v[176:179], v[112:127]
    v_mfma_f32_32x32x16_bf16 v[88:103], a[84:87], v[176:179], v[88:103]
    s_add_u32 s20, s50, 45056
    s_and_b32 s20, s20, 0xffff
    s_add_u32 s20, s20, s41
    buffer_load_dwordx4 v[224:227], v19, s[84:87], s20 offen offset:0 sc1
    s_waitcnt vmcnt(11)
    v_mfma_f32_32x32x16_bf16 v[112:127], a[88:91], v[180:183], v[112:127]
    v_mfma_f32_32x32x16_bf16 v[88:103], a[92:95], v[180:183], v[88:103]
    buffer_load_dwordx4 v[228:231], v19, s[84:87], s20 offen offset:2048 sc1
    s_waitcnt vmcnt(11)
    v_mfma_f32_32x32x16_bf16 v[112:127], a[96:99], v[184:187], v[112:127]
    v_mfma_f32_32x32x16_bf16 v[88:103], a[100:103], v[184:187], v[88:103]
    s_add_u32 s20, s50, 49152
    s_and_b32 s20, s20, 0xffff
    s_add_u32 s20, s20, s41
    buffer_load_dwordx4 v[232:235], v19, s[84:87], s20 offen offset:0 sc1
    s_waitcnt vmcnt(11)
    v_mfma_f32_32x32x16_bf16 v[112:127], a[104:107], v[188:191], v[112:127]
    v_mfma_f32_32x32x16_bf16 v[88:103], a[108:111], v[188:191], v[88:103]
    buffer_load_dwordx4 v[236:239], v19, s[84:87], s20 offen offset:2048 sc1
    s_waitcnt vmcnt(11)
    v_mfma_f32_32x32x16_bf16 v[112:127], a[112:115], v[192:195], v[112:127]
    v_mfma_f32_32x32x16_bf16 v[88:103], a[116:119], v[192:195], v[88:103]
    s_add_u32 s20, s50, 53248
    s_and_b32 s20, s20, 0xffff
    s_add_u32 s20, s20, s41
    buffer_load_dwordx4 v[240:243], v19, s[84:87], s20 offen offset:0 sc1
    s_waitcnt vmcnt(11)
    v_mfma_f32_32x32x16_bf16 v[112:127], a[120:123], v[196:199], v[112:127]
    v_mfma_f32_32x32x16_bf16 v[88:103], a[124:127], v[196:199], v[88:103]
    buffer_load_dwordx4 v[244:247], v19, s[84:87], s20 offen offset:2048 sc1
    s_waitcnt vmcnt(11)
    v_mfma_f32_32x32x16_bf16 v[112:127], a[128:131], v[200:203], v[112:127]
    v_mfma_f32_32x32x16_bf16 v[88:103], a[132:135], v[200:203], v[88:103]
    s_add_u32 s20, s50, 57344
    s_and_b32 s20, s20, 0xffff
    s_add_u32 s20, s20, s41
    buffer_load_dwordx4 v[248:251], v19, s[84:87], s20 offen offset:0 sc1
    s_waitcnt vmcnt(11)
    v_mfma_f32_32x32x16_bf16 v[112:127], a[136:139], v[204:207], v[112:127]
    v_mfma_f32_32x32x16_bf16 v[88:103], a[140:143], v[204:207], v[88:103]
    buffer_load_dwordx4 v[252:255], v19, s[84:87], s20 offen offset:2048 sc1
    s_waitcnt vmcnt(11)
    v_mfma_f32_32x32x16_bf16 v[112:127], a[144:147], v[208:211], v[112:127]
    v_mfma_f32_32x32x16_bf16 v[88:103], a[148:151], v[208:211], v[88:103]
    s_add_u32 s20, s50, 61440
    s_and_b32 s20, s20, 0xffff
    s_add_u32 s20, s20, s41
    buffer_load_dwordx4 v[136:139], v19, s[84:87], s20 offen offset:0 sc1
    s_waitcnt vmcnt(11)
    v_mfma_f32_32x32x16_bf16 v[112:127], a[152:155], v[212:215], v[112:127]
    v_mfma_f32_32x32x16_bf16 v[88:103], a[156:159], v[212:215], v[88:103]
    buffer_load_dwordx4 v[140:143], v19, s[84:87], s20 offen offset:2048 sc1
    s_waitcnt vmcnt(11)
    v_mfma_f32_32x32x16_bf16 v[112:127], a[160:163], v[216:219], v[112:127]
    v_mfma_f32_32x32x16_bf16 v[88:103], a[164:167], v[216:219], v[88:103]
    s_waitcnt vmcnt(10)
    v_mfma_f32_32x32x16_bf16 v[112:127], a[168:171], v[220:223], v[112:127]
    v_mfma_f32_32x32x16_bf16 v[88:103], a[172:175], v[220:223], v[88:103]
    s_waitcnt vmcnt(9)
    v_mfma_f32_32x32x16_bf16 v[112:127], a[176:179], v[224:227], v[112:127]
    v_mfma_f32_32x32x16_bf16 v[88:103], a[180:183], v[224:227], v[88:103]
    s_waitcnt vmcnt(8)
    v_mfma_f32_32x32x16_bf16 v[112:127], a[184:187], v[228:231], v[112:127]
    v_mfma_f32_32x32x16_bf16 v[88:103], a[188:191], v[228:231], v[88:103]
    s_waitcnt vmcnt(7)
    v_mfma_f32_32x32x16_bf16 v[112:127], a[192:195], v[232:235], v[112:127]
    v_mfma_f32_32x32x16_bf16 v[88:103], a[196:199], v[232:235], v[88:103]
    s_waitcnt vmcnt(6)
    v_mfma_f32_32x32x16_bf16 v[112:127], a[200:203], v[236:239], v[112:127]
    v_mfma_f32_32x32x16_bf16 v[88:103], a[204:207], v[236:239], v[88:103]
    s_waitcnt vmcnt(5)
    v_mfma_f32_32x32x16_bf16 v[112:127], a[208:211], v[240:243], v[112:127]
    v_mfma_f32_32x32x16_bf16 v[88:103], a[212:215], v[240:243], v[88:103]
    s_waitcnt vmcnt(4)
    v_mfma_f32_32x32x16_bf16 v[112:127], a[216:219], v[244:247], v[112:127]
    v_mfma_f32_32x32x16_bf16 v[88:103], a[220:223], v[244:247], v[88:103]
    s_waitcnt vmcnt(3)
    v_mfma_f32_32x32x16_bf16 v[112:127], a[224:227], v[248:251], v[112:127]
    v_mfma_f32_32x32x16_bf16 v[88:103], a[228:231], v[248:251], v[88:103]
    s_waitcnt vmcnt(2)
    v_mfma_f32_32x32x16_bf16 v[112:127], a[232:235], v[252:255], v[112:127]
    v_mfma_f32_32x32x16_bf16 v[88:103], a[236:239], v[252:255], v[88:103]
    s_waitcnt vmcnt(1)
    v_mfma_f32_32x32x16_bf16 v[112:127], a[240:243], v[136:139], v[112:127]
    v_mfma_f32_32x32x16_bf16 v[88:103], a[244:247], v[136:139], v[88:103]
    s_waitcnt vmcnt(0)
    v_mfma_f32_32x32x16_bf16 v[112:127], a[248:251], v[140:143], v[112:127]
    v_mfma_f32_32x32x16_bf16 v[88:103], a[252:255], v[140:143], v[88:103]
    s_mov_b32 vcc_lo, 0xffff0000
    s_mov_b32 vcc_hi, 0xffff0000
    s_nop 9
    v_cndmask_b32 v112, v112, v88, vcc
    v_cndmask_b32 v113, v113, v89, vcc
    v_cndmask_b32 v114, v114, v90, vcc
    v_cndmask_b32 v115, v115, v91, vcc
    v_cndmask_b32 v116, v116, v92, vcc
    v_cndmask_b32 v117, v117, v93, vcc
    v_cndmask_b32 v118, v118, v94, vcc
    v_cndmask_b32 v119, v119, v95, vcc
    v_cndmask_b32 v120, v120, v96, vcc
    v_cndmask_b32 v121, v121, v97, vcc
    v_cndmask_b32 v122, v122, v98, vcc
    v_cndmask_b32 v123, v123, v99, vcc
    v_cndmask_b32 v124, v124, v100, vcc
    v_cndmask_b32 v125, v125, v101, vcc
    v_cndmask_b32 v126, v126, v102, vcc
    v_cndmask_b32 v127, v127, v103, vcc
    ds_write_b128 v17, v[112:115] offset:0
    ds_write_b128 v17, v[116:119] offset:1024
    ds_write_b128 v17, v[120:123] offset:2048
    ds_write_b128 v17, v[124:127] offset:3072
    s_waitcnt lgkmcnt(0)
    s_barrier
    s_cmp_ge_u32 s16, 2
    s_cbranch_scc1 mega_kernel_x_nxt
    ds_read_b128 v[112:115], v16 offset:0
    ds_read_b128 v[88:91], v16 offset:256
    ds_read_b128 v[116:119], v16 offset:4096
    ds_read_b128 v[92:95], v16 offset:4352
    ds_read_b128 v[120:123], v16 offset:8192
    ds_read_b128 v[96:99], v16 offset:8448
    ds_read_b128 v[124:127], v16 offset:12288
    ds_read_b128 v[100:103], v16 offset:12544
    s_and_b32 s20, s17, 1
    s_lshl_b32 s20, s20, 16
    s_add_u32 s42, s42, s20
    s_waitcnt lgkmcnt(0)
    v_pk_add_f32 v[112:113], v[112:113], v[88:89]
    v_pk_add_f32 v[114:115], v[114:115], v[90:91]
    v_pk_add_f32 v[116:117], v[116:117], v[92:93]
    v_pk_add_f32 v[118:119], v[118:119], v[94:95]
    v_pk_add_f32 v[120:121], v[120:121], v[96:97]
    v_pk_add_f32 v[122:123], v[122:123], v[98:99]
    v_pk_add_f32 v[124:125], v[124:125], v[100:101]
    v_pk_add_f32 v[126:127], v[126:127], v[102:103]
    v_pk_add_f32 v[112:113], v[112:113], v[116:117]
    v_pk_add_f32 v[114:115], v[114:115], v[118:119]
    v_pk_add_f32 v[120:121], v[120:121], v[124:125]
    v_pk_add_f32 v[122:123], v[122:123], v[126:127]
    v_pk_add_f32 v[112:113], v[112:113], v[120:121]
    v_pk_add_f32 v[114:115], v[114:115], v[122:123]
    v_cvt_pk_bf16_f32 v132, v112, v113
    v_cvt_pk_bf16_f32 v133, v114, v115
    buffer_store_dwordx2 v[132:133], v18, s[12:15], s42 offen
mega_kernel_x_nxt:
    s_cmp_eq_u32 s46, 1
    s_cbranch_scc1 mega_kernel_x_att
    s_cmp_lt_u32 s22, 64
    s_cbranch_scc1 mega_kernel_x_ldq
    s_endpgm
.section .rodata,"a"
.p2align 6
.amdhsa_kernel mega_kernel
  .amdhsa_next_free_vgpr 512
  .amdhsa_next_free_sgpr 102
  .amdhsa_accum_offset 256
  .amdhsa_group_segment_fixed_size 0
  .amdhsa_kernarg_size 104
  .amdhsa_user_sgpr_count 2
  .amdhsa_user_sgpr_kernarg_segment_ptr 1
  .amdhsa_system_sgpr_workgroup_id_x 1
.end_amdhsa_kernel
```

```asm
; @launch kernel=mega_kernel grid=(256,1,1) block=(256,1,1) lds=161792
.amdgcn_target "amdgcn-amd-amdhsa--gfx950"
.text
.globl mega_kernel
.p2align 8
.type mega_kernel,@function
mega_kernel:
    s_cmp_ge_u32 s2, 256
    s_cbranch_scc1 mega_kernel_exit
    s_load_dwordx2 s[84:85], s[0:1], 96
    s_load_dwordx2 s[88:89], s[0:1], 88
    s_getreg_b32 s93, hwreg(HW_REG_XCC_ID)
    s_and_b32 s93, s93, 7
    s_lshl_b32 s93, s93, 2
    s_lshr_b32 s93, 0x76543210, s93
    s_and_b32 s93, s93, 7
    v_lshrrev_b32 v1, 6, v0
    v_mov_b32 v4, 0
    v_readfirstlane_b32 s80, v1
    v_mov_b32 v5, 0
    v_mov_b32 v6, 0
    v_mov_b32 v7, 0
    s_mov_b32 s83, 0
    s_lshl_b32 s101, s2, 2
    s_add_u32 s101, s101, s80
    s_lshl_b32 s101, s101, 8
    s_add_u32 s101, s101, 230686720
    s_waitcnt lgkmcnt(0)
    s_mov_b32 s86, 268435456
    s_mov_b32 s87, 0x00020000
    s_mov_b32 s90, 256
    s_mov_b32 s91, 0x00020000
    s_mov_b32 s98, s80
    s_cmp_lg_u32 s80, 0
    s_cbranch_scc1 mega_kernel_st0
    v_mov_b32 v10, 1
    s_lshl_b32 s81, s93, 5
    s_mov_b64 exec, 1
    buffer_atomic_add v10, off, s[88:91], s81 offset:4 sc0
    s_lshl_b32 s81, s2, 7
    s_add_u32 s81, s81, 71303168
    s_mov_b64 exec, 3
    v_lshlrev_b32 v1, 15, v0
    buffer_store_dword v4, v1, s[84:87], s81 offen sc1
    s_mov_b64 exec, -1
mega_kernel_st0:
    s_load_dwordx2 s[72:73], s[0:1], 8
    v_mov_b32 v4, 0
    v_mov_b32 v5, 0
    v_mov_b32 v6, 0
    v_mov_b32 v7, 0
    v_lshlrev_b32 v1, 4, v0
    s_lshl_b32 s81, s2, 13
    s_add_u32 s81, s81, 67108864
    s_add_u32 s79, s81, 4096
    buffer_store_dwordx4 v[4:7], v1, s[84:87], s81 offen sc1
    buffer_store_dwordx4 v[4:7], v1, s[84:87], s79 offen sc1
    s_lshl_b32 s81, s2, 12
    s_add_u32 s81, s81, 70254592
    buffer_store_dwordx4 v[4:7], v1, s[84:87], s81 offen sc1
    s_cmp_ge_u32 s2, 64
    s_cbranch_scc1 mega_kernel_gi
    v_bfe_u32 v2, v0, 3, 1
    v_lshlrev_b32 v2, 11, v2
    v_and_b32 v3, 3, v0
    v_lshl_add_u32 v2, v3, 5, v2
    v_bfe_u32 v3, v0, 4, 3
    v_lshl_add_u32 v2, v3, 2, v2
    v_bfe_u32 v3, v0, 2, 1
    v_lshl_add_u32 v2, v3, 1, v2
    s_lshr_b32 s81, s2, 2
    s_lshl_b32 s81, s81, 7
    s_and_b32 s79, s2, 3
    s_lshl_b32 s79, s79, 12
    s_add_u32 s81, s81, s79
    s_waitcnt lgkmcnt(0)
    s_mov_b32 s74, 16384
    s_mov_b32 s75, 0x00020000
    buffer_load_ushort v8, v2, s[72:75], s81 offen
    v_mov_b32 v9, -1
    v_and_b32 v1, 31, v0
    v_lshlrev_b32 v1, 1, v1
    v_bfe_u32 v3, v0, 5, 2
    v_lshl_add_u32 v1, v3, 8, v1
    v_lshrrev_b32 v3, 7, v0
    v_lshl_add_u32 v1, v3, 14, v1
    v_cmp_gt_u32 vcc, 128, v0
    s_lshr_b32 s81, s2, 2
    s_lshl_b32 s81, s81, 10
    s_and_b32 s79, s2, 3
    s_lshl_b32 s79, s79, 6
    s_add_u32 s81, s81, s79
    s_add_u32 s81, s81, 69206016
    s_waitcnt vmcnt(0)
    v_min_u32 v8, 0xfffe, v8
    v_cndmask_b32 v8, v9, v8, vcc
    buffer_store_short v8, v1, s[84:87], s81 offen sc1
mega_kernel_gi:
    s_waitcnt lgkmcnt(0)
    s_cmp_lg_u32 s80, 0
    s_cbranch_scc1 mega_kernel_st1
    s_mov_b64 exec, 1
    s_waitcnt vmcnt(4)
    ds_write_b32 v4, v10
    s_mov_b64 exec, -1
    s_waitcnt lgkmcnt(0)
mega_kernel_st1:
    s_barrier
    ds_read_b32 v2, v4
    s_waitcnt lgkmcnt(0)
    v_readfirstlane_b32 s94, v2
    s_barrier
    s_sub_u32 s81, s93, 2
    s_cmp_ge_u32 s81, 2
    s_cbranch_scc1 mega_kernel_nopr
    s_cmp_lg_u32 s80, 0
    s_cbranch_scc1 mega_kernel_prd
    v_lshlrev_b32 v1, 4, v0
    s_and_b32 s81, s2, 127
    s_lshl_b32 s81, s81, 14
    s_add_u32 s81, s81, 67108864
    s_add_u32 s77, s81, 8192
    buffer_store_dwordx4 v[4:7], v1, s[84:87], s81 offen sc1
    buffer_store_dwordx4 v[4:7], v1, s[84:87], s77 offen sc1
    s_waitcnt vmcnt(0)
    s_memtime s[70:71]
    buffer_store_dwordx4 v[4:7], v1, s[84:87], s81 offen sc1
    s_waitcnt vmcnt(0)
    s_memtime s[72:73]
    buffer_store_dwordx4 v[4:7], v1, s[84:87], s77 offen sc1
    s_waitcnt vmcnt(0)
    buffer_store_dwordx4 v[4:7], v1, s[84:87], s77 offen sc1
    s_waitcnt vmcnt(0)
    s_memtime s[74:75]
    buffer_store_dwordx4 v[4:7], v1, s[84:87], s81 offen sc1
    s_waitcnt vmcnt(0)
    s_memtime s[76:77]
    s_waitcnt lgkmcnt(0)
    s_sub_u32 s76, s76, s74
    s_sub_u32 s74, s74, s72
    s_sub_u32 s72, s72, s70
    s_add_u32 s72, s72, s76
    s_cmp_lt_u32 s74, s72
    s_cselect_b32 s81, 0x10001, 1
    v_mov_b32 v8, s81
    s_mov_b64 exec, 1
    buffer_atomic_add v8, off, s[88:91], 0 offset:204 sc1
    s_mov_b64 exec, -1
mega_kernel_prd:
    s_barrier
mega_kernel_nopr:
    s_mov_b32 s97, 0
    s_mov_b32 s100, 64
mega_kernel_fast:
    s_mov_b32 s96, 1
    s_mov_b32 s30, s93
    s_and_b32 s31, s94, 31
    s_cmp_lt_u32 s93, 2
    s_cbranch_scc1 mega_kernel_recf
    s_sub_u32 s92, s93, 2
    s_lshl_b32 s92, s92, 5
    s_add_u32 s92, s92, s31
    s_branch mega_kernel_bulk
mega_kernel_redo:
    s_waitcnt vmcnt(0) lgkmcnt(0)
    s_barrier
    v_readlane_b32 s100, v36, 2
    v_readlane_b32 s81, v36, 3
    s_mov_b32 s97, 1
    s_nop 2
    s_add_u32 s100, s100, s81
    s_mov_b32 s95, s94
    v_readlane_b32 s81, v36, 0
    s_cmp_gt_u32 s93, 0
    s_nop 2
    s_cselect_b32 s81, s81, 0
    s_add_u32 s95, s95, s81
    v_readlane_b32 s81, v36, 1
    s_cmp_gt_u32 s93, 1
    s_nop 2
    s_cselect_b32 s81, s81, 0
    s_add_u32 s95, s95, s81
    v_readlane_b32 s81, v36, 2
    s_cmp_gt_u32 s93, 2
    s_nop 2
    s_cselect_b32 s81, s81, 0
    s_add_u32 s95, s95, s81
    v_readlane_b32 s81, v36, 3
    s_cmp_gt_u32 s93, 3
    s_nop 2
    s_cselect_b32 s81, s81, 0
    s_add_u32 s95, s95, s81
    v_readlane_b32 s81, v36, 4
    s_cmp_gt_u32 s93, 4
    s_nop 2
    s_cselect_b32 s81, s81, 0
    s_add_u32 s95, s95, s81
    v_readlane_b32 s81, v36, 5
    s_cmp_gt_u32 s93, 5
    s_nop 2
    s_cselect_b32 s81, s81, 0
    s_add_u32 s95, s95, s81
    v_readlane_b32 s81, v36, 6
    s_cmp_gt_u32 s93, 6
    s_nop 2
    s_cselect_b32 s81, s81, 0
    s_add_u32 s95, s95, s81
mega_kernel_slow:
    s_mov_b32 s96, 0
    s_lshr_b32 s30, s95, 5
    s_and_b32 s31, s95, 31
    s_cmp_lt_u32 s95, 64
    s_cbranch_scc1 mega_kernel_recs
    s_sub_u32 s92, s95, 64
    s_branch mega_kernel_bulk
mega_kernel_exit:
    s_endpgm
mega_kernel_recf:
    s_load_dwordx2 s[4:5], s[0:1], 96
    s_load_dwordx2 s[12:13], s[0:1], 88
    s_load_dwordx2 s[50:51], s[0:1], 16
    s_load_dwordx2 s[52:53], s[0:1], 24
    s_load_dwordx2 s[54:55], s[0:1], 32
    s_load_dwordx2 s[56:57], s[0:1], 40
    s_load_dwordx2 s[58:59], s[0:1], 8
    v_lshrrev_b32 v3, 6, v0
    v_and_b32 v40, 63, v0
    v_readfirstlane_b32 s20, v3
    v_lshrrev_b32 v41, 4, v40
    v_and_b32 v42, 15, v40
    v_lshlrev_b32 v1, 4, v40
    s_mov_b32 s49, 0
    s_waitcnt lgkmcnt(0)
    s_mov_b32 s6, 268435456
    s_mov_b32 s7, 0x00020000
    s_mov_b32 s14, 256
    s_mov_b32 s15, 0x00020000
    s_mov_b32 s10, 8388608
    s_mov_b32 s11, 0x00020000
    s_mov_b32 s26, 0x00030003
    s_mov_b32 s27, 0x00030003
    s_mov_b32 s28, 0xcccccccc
    s_mov_b32 s29, 0xcccccccc
    s_mov_b32 s32, 0x33333333
    s_mov_b32 s33, 0x33333333
    s_mov_b32 s34, 0x3e0293ee
    s_lshl_b32 s22, s20, 2
    v_xor_b32 v3, s22, v42
    v_lshlrev_b32 v3, 4, v3
    v_lshl_add_u32 v4, v41, 4, s20
    v_lshl_add_u32 v44, v4, 13, v3
    s_lshl_b32 s22, s30, 22
    s_lshl_b32 s23, s31, 8
    s_add_u32 s22, s22, s23
    v_add_u32 v44, s22, v44
    s_lshr_b32 s22, s20, 1
    s_lshl_b32 s22, s22, 5
    s_and_b32 s23, s20, 1
    s_lshl_b32 s23, s23, 2
    s_add_u32 s22, s22, s23
    s_lshl_b32 s23, s31, 7
    s_add_u32 s22, s22, s23
    v_add_u32 v4, s22, v41
    v_lshl_add_u32 v45, v4, 11, v3
    s_lshl_b32 s22, s30, 10
    v_add_u32 v45, s22, v45
    s_lshl_b32 s48, s20, 10
    s_mov_b32 s8, s50
    s_mov_b32 s9, s51
    s_add_u32 m0, s48, 0
    s_mov_b32 s22, 0
    buffer_load_dwordx4 v44, s[8:11], s22 offen  lds
    s_add_u32 m0, s48, 4096
    s_mov_b32 s22, 32768
    buffer_load_dwordx4 v44, s[8:11], s22 offen  lds
    s_add_u32 m0, s48, 8192
    s_mov_b32 s22, 65536
    buffer_load_dwordx4 v44, s[8:11], s22 offen  lds
    s_add_u32 m0, s48, 12288
    s_mov_b32 s22, 98304
    buffer_load_dwordx4 v44, s[8:11], s22 offen  lds
    s_add_u32 m0, s48, 16384
    s_mov_b32 s22, 524288
    buffer_load_dwordx4 v44, s[8:11], s22 offen  lds
    s_add_u32 m0, s48, 20480
    s_mov_b32 s22, 557056
    buffer_load_dwordx4 v44, s[8:11], s22 offen  lds
    s_add_u32 m0, s48, 24576
    s_mov_b32 s22, 589824
    buffer_load_dwordx4 v44, s[8:11], s22 offen  lds
    s_add_u32 m0, s48, 28672
    s_mov_b32 s22, 622592
    buffer_load_dwordx4 v44, s[8:11], s22 offen  lds
    s_add_u32 m0, s48, 32768
    s_mov_b32 s22, 1048576
    buffer_load_dwordx4 v44, s[8:11], s22 offen  lds
    s_add_u32 m0, s48, 36864
    s_mov_b32 s22, 1081344
    buffer_load_dwordx4 v44, s[8:11], s22 offen  lds
    s_add_u32 m0, s48, 40960
    s_mov_b32 s22, 1114112
    buffer_load_dwordx4 v44, s[8:11], s22 offen  lds
    s_add_u32 m0, s48, 45056
    s_mov_b32 s22, 1146880
    buffer_load_dwordx4 v44, s[8:11], s22 offen  lds
    s_waitcnt vmcnt(12)
    s_barrier
    s_or_b32 s81, s97, s98
    s_cmp_lg_u32 s81, 0
    s_cbranch_scc1 mega_kernel_h0_1
    s_lshl_b32 s81, s93, 5
    v_mov_b32 v38, 1
    s_mov_b64 exec, 1
    buffer_atomic_add v38, off, s[88:91], s81 sc1
    s_mov_b64 exec, -1
mega_kernel_h0_1:
    s_add_u32 m0, s48, 49152
    s_mov_b32 s22, 1572864
    buffer_load_dwordx4 v44, s[8:11], s22 offen  lds
    s_add_u32 m0, s48, 53248
    s_mov_b32 s22, 1605632
    buffer_load_dwordx4 v44, s[8:11], s22 offen  lds
    s_add_u32 m0, s48, 57344
    s_mov_b32 s22, 1638400
    buffer_load_dwordx4 v44, s[8:11], s22 offen  lds
    s_add_u32 m0, s48, 61440
    s_mov_b32 s22, 1671168
    buffer_load_dwordx4 v44, s[8:11], s22 offen  lds
    s_add_u32 m0, s48, 65536
    s_mov_b32 s22, 2097152
    buffer_load_dwordx4 v44, s[8:11], s22 offen  lds
    s_add_u32 m0, s48, 69632
    s_mov_b32 s22, 2129920
    buffer_load_dwordx4 v44, s[8:11], s22 offen  lds
    s_add_u32 m0, s48, 73728
    s_mov_b32 s22, 2162688
    buffer_load_dwordx4 v44, s[8:11], s22 offen  lds
    s_add_u32 m0, s48, 77824
    s_mov_b32 s22, 2195456
    buffer_load_dwordx4 v44, s[8:11], s22 offen  lds
    s_add_u32 m0, s48, 81920
    s_mov_b32 s22, 2621440
    buffer_load_dwordx4 v44, s[8:11], s22 offen  lds
    s_add_u32 m0, s48, 86016
    s_mov_b32 s22, 2654208
    buffer_load_dwordx4 v44, s[8:11], s22 offen  lds
    s_add_u32 m0, s48, 90112
    s_mov_b32 s22, 2686976
    buffer_load_dwordx4 v44, s[8:11], s22 offen  lds
    s_add_u32 m0, s48, 94208
    s_mov_b32 s22, 2719744
    buffer_load_dwordx4 v44, s[8:11], s22 offen  lds
    s_add_u32 m0, s48, 98304
    s_mov_b32 s22, 3145728
    buffer_load_dwordx4 v44, s[8:11], s22 offen  lds
    s_add_u32 m0, s48, 102400
    s_mov_b32 s22, 3178496
    buffer_load_dwordx4 v44, s[8:11], s22 offen  lds
    s_add_u32 m0, s48, 106496
    s_mov_b32 s22, 3211264
    buffer_load_dwordx4 v44, s[8:11], s22 offen  lds
    s_add_u32 m0, s48, 110592
    s_mov_b32 s22, 3244032
    buffer_load_dwordx4 v44, s[8:11], s22 offen  lds
    s_add_u32 m0, s48, 114688
    s_mov_b32 s22, 3670016
    buffer_load_dwordx4 v44, s[8:11], s22 offen  lds
    s_add_u32 m0, s48, 118784
    s_mov_b32 s22, 3702784
    buffer_load_dwordx4 v44, s[8:11], s22 offen  lds
    s_add_u32 m0, s48, 122880
    s_mov_b32 s22, 3735552
    buffer_load_dwordx4 v44, s[8:11], s22 offen  lds
    s_add_u32 m0, s48, 126976
    s_mov_b32 s22, 3768320
    buffer_load_dwordx4 v44, s[8:11], s22 offen  lds
    s_lshl_b32 s22, s30, 5
    s_add_u32 s22, s22, s31
    s_lshl_b32 s38, s22, 14
    s_xor_b32 s22, s22, 32
    s_lshl_b32 s37, s22, 14
    s_add_u32 s38, s38, 67108864
    s_add_u32 s37, s37, 67108864
    s_lshl_b32 s46, s30, 19
    s_add_u32 s46, s46, 70254592
    s_mul_i32 s22, s31, 8448
    s_add_u32 s47, s46, s22
    s_mul_i32 s22, s20, 67584
    s_add_u32 s46, s46, s22
    s_lshl_b32 s22, s31, 6
    s_add_u32 s46, s46, s22
    s_add_u32 s61, s46, 33792
    s_mul_i32 s22, s20, 2048
    s_add_u32 s25, s47, s22
    s_lshl_b32 s35, s30, 13
    s_add_u32 s35, s35, 69206016
    v_lshrrev_b32 v53, 2, v42
    v_lshlrev_b32 v53, 1, v53
    v_and_b32 v54, 1, v42
    v_add_u32 v55, v53, v54
    v_mov_b32 v14, 0
    v_mov_b32 v15, 0
    v_mov_b32 v2, 0x4444
    v_mov_b32 v3, 0xeeee
    v_cndmask_b32 v2, v2, v3, s[28:29]
    s_lshl_b32 s22, s20, 12
    v_add_u32 v32, s22, v1
    v_add_u32 v33, 0x10000, v32
    v_add_u32 v5, 0x10000, v1
    v_add_u32 v6, 131072, v1
    v_and_b32 v3, 3, v42
    v_bfe_u32 v43, v40, 1, 1
    v_lshlrev_b32 v7, 13, v43
    v_and_b32 v43, 1, v40
    v_lshl_add_u32 v7, v43, 7, v7
    s_lshl_b32 s22, s31, 8
    s_add_u32 s23, s22, 71311360
    v_add_u32 v7, s23, v7
    s_cmp_lg_u32 s20, 0
    s_cbranch_scc1 mega_kernel_rf_flk
    s_lshl_b32 s23, s30, 7
    s_add_u32 s22, s22, s23
    s_add_u32 s22, s22, 71327744
    v_bfrev_b32 v7, 1
    v_writelane_b32 v7, s22, 0
mega_kernel_rf_flk:
    v_lshlrev_b32 v11, 3, v40
    v_lshlrev_b32 v10, 8, v55
    v_lshl_add_u32 v10, v41, 4, v10
    v_mul_u32_u24 v8, 8448, v41
    v_lshl_add_u32 v8, v3, 4, v8
    v_lshrrev_b32 v4, 2, v42
    v_mul_u32_u24 v4, 2048, v4
    v_add_u32 v8, v4, v8
    v_lshrrev_b32 v9, 1, v41
    v_lshlrev_b32 v9, 5, v9
    v_and_b32 v4, 1, v42
    v_lshl_add_u32 v9, v4, 4, v9
    v_and_b32 v4, 1, v41
    v_lshl_add_u32 v9, v4, 3, v9
    s_lshr_b32 s22, s31, 2
    s_lshl_b32 s22, s22, 10
    s_and_b32 s23, s31, 3
    s_lshl_b32 s23, s23, 6
    s_add_u32 s22, s22, s23
    v_add_u32 v9, s22, v9
    v_lshrrev_b32 v4, 2, v42
    v_lshlrev_b32 v12, 8, v4
    v_lshl_add_u32 v12, v41, 6, v12
    v_lshl_add_u32 v12, v3, 4, v12
    v_lshlrev_b32 v13, 6, v41
    v_lshl_add_u32 v13, v42, 2, v13
    v_cmp_eq_u32 vcc, 0, v3
    v_mov_b32 v28, 0x3f803f80
    v_mov_b32 v29, 0x3f803f80
    v_cndmask_b32 v34, 0, 1, vcc
    v_mov_b32 v30, 0x3f803f80
    v_mov_b32 v31, 0x3f803f80
    v_and_b32 v49, 1, v42
    v_lshlrev_b32 v49, 4, v49
    v_mov_b32 v50, 0x3f80
    v_lshlrev_b32 v50, v49, v50
    v_lshrrev_b32 v51, 2, v42
    v_cmp_eq_u32 vcc, v51, v41
    v_mov_b32 v24, v50
    v_cndmask_b32 v52, 0, v50, s[28:29]
    v_cndmask_b32 v53, 0, v50, s[32:33]
    v_cndmask_b32 v16, 0, v52, vcc
    v_cndmask_b32 v17, 0, v53, vcc
    v_mov_b32 v25, v50
    v_mov_b32 v26, v50
    v_mov_b32 v27, v50
    v_bfe_u32 v60, v40, 3, 1
    v_bfe_u32 v49, v40, 2, 1
    v_and_b32 v50, 1, v41
    v_lshrrev_b32 v51, 1, v41
    v_lshlrev_b32 v52, 3, v60
    v_lshl_add_u32 v52, v50, 2, v52
    v_lshl_add_u32 v53, v51, 4, v52
    v_add_u32 v53, v53, v49
    v_and_b32 v54, 3, v40
    s_lshl_b32 s22, s20, 2
    v_add_u32 v55, s22, v54
    v_xor_b32 v55, v55, v52
    v_lshlrev_b32 v55, 4, v55
    v_lshl_add_u32 v46, v53, 8, v55
    v_lshlrev_b32 v55, 4, v52
    v_lshl_add_u32 v55, v54, 3, v55
    v_lshl_add_u32 v47, v53, 8, v55
    s_waitcnt vmcnt(28)
    s_barrier
    v_add_u32 v48, 0, v46
    ds_read_b64_tr_b16 a[0:1], v48 offset:0
    ds_read_b64_tr_b16 a[2:3], v48 offset:512
    ds_read_b64_tr_b16 a[4:5], v48 offset:8192
    ds_read_b64_tr_b16 a[6:7], v48 offset:8704
    ds_read_b64_tr_b16 a[8:9], v48 offset:8
    ds_read_b64_tr_b16 a[10:11], v48 offset:520
    ds_read_b64_tr_b16 a[12:13], v48 offset:8200
    ds_read_b64_tr_b16 a[14:15], v48 offset:8712
    s_waitcnt lgkmcnt(0)
    s_barrier
    s_mov_b32 s8, s52
    s_mov_b32 s9, s53
    s_add_u32 m0, s48, 0
    s_mov_b32 s22, 0
    buffer_load_dwordx4 v44, s[8:11], s22 offen  lds
    s_add_u32 m0, s48, 4096
    s_mov_b32 s22, 32768
    buffer_load_dwordx4 v44, s[8:11], s22 offen  lds
    s_add_u32 m0, s48, 8192
    s_mov_b32 s22, 65536
    buffer_load_dwordx4 v44, s[8:11], s22 offen  lds
    s_add_u32 m0, s48, 12288
    s_mov_b32 s22, 98304
    buffer_load_dwordx4 v44, s[8:11], s22 offen  lds
    s_waitcnt vmcnt(28)
    s_barrier
    v_add_u32 v48, 16384, v46
    ds_read_b64_tr_b16 a[16:17], v48 offset:0
    ds_read_b64_tr_b16 a[18:19], v48 offset:512
    ds_read_b64_tr_b16 a[20:21], v48 offset:8192
    ds_read_b64_tr_b16 a[22:23], v48 offset:8704
    ds_read_b64_tr_b16 a[24:25], v48 offset:8
    ds_read_b64_tr_b16 a[26:27], v48 offset:520
    ds_read_b64_tr_b16 a[28:29], v48 offset:8200
    ds_read_b64_tr_b16 a[30:31], v48 offset:8712
    s_waitcnt lgkmcnt(0)
    s_barrier
    s_add_u32 m0, s48, 16384
    s_mov_b32 s22, 524288
    buffer_load_dwordx4 v44, s[8:11], s22 offen  lds
    s_add_u32 m0, s48, 20480
    s_mov_b32 s22, 557056
    buffer_load_dwordx4 v44, s[8:11], s22 offen  lds
    s_add_u32 m0, s48, 24576
    s_mov_b32 s22, 589824
    buffer_load_dwordx4 v44, s[8:11], s22 offen  lds
    s_add_u32 m0, s48, 28672
    s_mov_b32 s22, 622592
    buffer_load_dwordx4 v44, s[8:11], s22 offen  lds
    s_waitcnt vmcnt(28)
    s_barrier
    v_add_u32 v48, 32768, v46
    ds_read_b64_tr_b16 a[32:33], v48 offset:0
    ds_read_b64_tr_b16 a[34:35], v48 offset:512
    ds_read_b64_tr_b16 a[36:37], v48 offset:8192
    ds_read_b64_tr_b16 a[38:39], v48 offset:8704
    ds_read_b64_tr_b16 a[40:41], v48 offset:8
    ds_read_b64_tr_b16 a[42:43], v48 offset:520
    ds_read_b64_tr_b16 a[44:45], v48 offset:8200
    ds_read_b64_tr_b16 a[46:47], v48 offset:8712
    s_waitcnt lgkmcnt(0)
    s_barrier
    s_add_u32 m0, s48, 32768
    s_mov_b32 s22, 1048576
    buffer_load_dwordx4 v44, s[8:11], s22 offen  lds
    s_add_u32 m0, s48, 36864
    s_mov_b32 s22, 1081344
    buffer_load_dwordx4 v44, s[8:11], s22 offen  lds
    s_add_u32 m0, s48, 40960
    s_mov_b32 s22, 1114112
    buffer_load_dwordx4 v44, s[8:11], s22 offen  lds
    s_add_u32 m0, s48, 45056
    s_mov_b32 s22, 1146880
    buffer_load_dwordx4 v44, s[8:11], s22 offen  lds
    s_waitcnt vmcnt(28)
    s_barrier
    v_add_u32 v48, 49152, v46
    ds_read_b64_tr_b16 a[48:49], v48 offset:0
    ds_read_b64_tr_b16 a[50:51], v48 offset:512
    ds_read_b64_tr_b16 a[52:53], v48 offset:8192
    ds_read_b64_tr_b16 a[54:55], v48 offset:8704
    ds_read_b64_tr_b16 a[56:57], v48 offset:8
    ds_read_b64_tr_b16 a[58:59], v48 offset:520
    ds_read_b64_tr_b16 a[60:61], v48 offset:8200
    ds_read_b64_tr_b16 a[62:63], v48 offset:8712
    s_waitcnt lgkmcnt(0)
    s_barrier
    s_add_u32 m0, s48, 49152
    s_mov_b32 s22, 1572864
    buffer_load_dwordx4 v44, s[8:11], s22 offen  lds
    s_add_u32 m0, s48, 53248
    s_mov_b32 s22, 1605632
    buffer_load_dwordx4 v44, s[8:11], s22 offen  lds
    s_add_u32 m0, s48, 57344
    s_mov_b32 s22, 1638400
    buffer_load_dwordx4 v44, s[8:11], s22 offen  lds
    s_add_u32 m0, s48, 61440
    s_mov_b32 s22, 1671168
    buffer_load_dwordx4 v44, s[8:11], s22 offen  lds
    s_waitcnt vmcnt(28)
    s_barrier
    v_add_u32 v48, 65536, v46
    ds_read_b64_tr_b16 a[64:65], v48 offset:0
    ds_read_b64_tr_b16 a[66:67], v48 offset:512
    ds_read_b64_tr_b16 a[68:69], v48 offset:8192
    ds_read_b64_tr_b16 a[70:71], v48 offset:8704
    ds_read_b64_tr_b16 a[72:73], v48 offset:8
    ds_read_b64_tr_b16 a[74:75], v48 offset:520
    ds_read_b64_tr_b16 a[76:77], v48 offset:8200
    ds_read_b64_tr_b16 a[78:79], v48 offset:8712
    s_waitcnt lgkmcnt(0)
    s_barrier
    s_add_u32 m0, s48, 65536
    s_mov_b32 s22, 2097152
    buffer_load_dwordx4 v44, s[8:11], s22 offen  lds
    s_add_u32 m0, s48, 69632
    s_mov_b32 s22, 2129920
    buffer_load_dwordx4 v44, s[8:11], s22 offen  lds
    s_add_u32 m0, s48, 73728
    s_mov_b32 s22, 2162688
    buffer_load_dwordx4 v44, s[8:11], s22 offen  lds
    s_add_u32 m0, s48, 77824
    s_mov_b32 s22, 2195456
    buffer_load_dwordx4 v44, s[8:11], s22 offen  lds
    s_waitcnt vmcnt(28)
    s_barrier
    v_add_u32 v48, 81920, v46
    ds_read_b64_tr_b16 a[80:81], v48 offset:0
    ds_read_b64_tr_b16 a[82:83], v48 offset:512
    ds_read_b64_tr_b16 a[84:85], v48 offset:8192
    ds_read_b64_tr_b16 a[86:87], v48 offset:8704
    ds_read_b64_tr_b16 a[88:89], v48 offset:8
    ds_read_b64_tr_b16 a[90:91], v48 offset:520
    ds_read_b64_tr_b16 a[92:93], v48 offset:8200
    ds_read_b64_tr_b16 a[94:95], v48 offset:8712
    s_waitcnt lgkmcnt(0)
    s_barrier
    s_add_u32 m0, s48, 81920
    s_mov_b32 s22, 2621440
    buffer_load_dwordx4 v44, s[8:11], s22 offen  lds
    s_add_u32 m0, s48, 86016
    s_mov_b32 s22, 2654208
    buffer_load_dwordx4 v44, s[8:11], s22 offen  lds
    s_add_u32 m0, s48, 90112
    s_mov_b32 s22, 2686976
    buffer_load_dwordx4 v44, s[8:11], s22 offen  lds
    s_add_u32 m0, s48, 94208
    s_mov_b32 s22, 2719744
    buffer_load_dwordx4 v44, s[8:11], s22 offen  lds
    s_waitcnt vmcnt(28)
    s_barrier
    v_add_u32 v48, 98304, v46
    ds_read_b64_tr_b16 a[96:97], v48 offset:0
    ds_read_b64_tr_b16 a[98:99], v48 offset:512
    ds_read_b64_tr_b16 a[100:101], v48 offset:8192
    ds_read_b64_tr_b16 a[102:103], v48 offset:8704
    ds_read_b64_tr_b16 a[104:105], v48 offset:8
    ds_read_b64_tr_b16 a[106:107], v48 offset:520
    ds_read_b64_tr_b16 a[108:109], v48 offset:8200
    ds_read_b64_tr_b16 a[110:111], v48 offset:8712
    s_waitcnt lgkmcnt(0)
    s_barrier
    s_add_u32 m0, s48, 98304
    s_mov_b32 s22, 3145728
    buffer_load_dwordx4 v44, s[8:11], s22 offen  lds
    s_add_u32 m0, s48, 102400
    s_mov_b32 s22, 3178496
    buffer_load_dwordx4 v44, s[8:11], s22 offen  lds
    s_add_u32 m0, s48, 106496
    s_mov_b32 s22, 3211264
    buffer_load_dwordx4 v44, s[8:11], s22 offen  lds
    s_add_u32 m0, s48, 110592
    s_mov_b32 s22, 3244032
    buffer_load_dwordx4 v44, s[8:11], s22 offen  lds
    s_waitcnt vmcnt(28)
    s_barrier
    v_add_u32 v48, 114688, v46
    ds_read_b64_tr_b16 a[112:113], v48 offset:0
    ds_read_b64_tr_b16 a[114:115], v48 offset:512
    ds_read_b64_tr_b16 a[116:117], v48 offset:8192
    ds_read_b64_tr_b16 a[118:119], v48 offset:8704
    ds_read_b64_tr_b16 a[120:121], v48 offset:8
    ds_read_b64_tr_b16 a[122:123], v48 offset:520
    ds_read_b64_tr_b16 a[124:125], v48 offset:8200
    ds_read_b64_tr_b16 a[126:127], v48 offset:8712
    s_waitcnt lgkmcnt(0)
    s_barrier
    s_add_u32 m0, s48, 114688
    s_mov_b32 s22, 3670016
    buffer_load_dwordx4 v44, s[8:11], s22 offen  lds
    s_add_u32 m0, s48, 118784
    s_mov_b32 s22, 3702784
    buffer_load_dwordx4 v44, s[8:11], s22 offen  lds
    s_add_u32 m0, s48, 122880
    s_mov_b32 s22, 3735552
    buffer_load_dwordx4 v44, s[8:11], s22 offen  lds
    s_add_u32 m0, s48, 126976
    s_mov_b32 s22, 3768320
    buffer_load_dwordx4 v44, s[8:11], s22 offen  lds
    s_waitcnt vmcnt(28)
    s_barrier
    v_add_u32 v48, 0, v46
    ds_read_b64_tr_b16 a[128:129], v48 offset:0
    ds_read_b64_tr_b16 a[130:131], v48 offset:512
    ds_read_b64_tr_b16 a[132:133], v48 offset:8192
    ds_read_b64_tr_b16 a[134:135], v48 offset:8704
    ds_read_b64_tr_b16 a[136:137], v48 offset:8
    ds_read_b64_tr_b16 a[138:139], v48 offset:520
    ds_read_b64_tr_b16 a[140:141], v48 offset:8200
    ds_read_b64_tr_b16 a[142:143], v48 offset:8712
    s_waitcnt lgkmcnt(0)
    s_barrier
    s_mov_b32 s8, s56
    s_mov_b32 s9, s57
    s_add_u32 m0, s48, 0
    s_mov_b32 s22, 0
    buffer_load_dwordx4 v45, s[8:11], s22 offen  lds
    s_add_u32 m0, s48, 4096
    s_mov_b32 s22, 16384
    buffer_load_dwordx4 v45, s[8:11], s22 offen  lds
    s_add_u32 m0, s48, 8192
    s_mov_b32 s22, 32768
    buffer_load_dwordx4 v45, s[8:11], s22 offen  lds
    s_add_u32 m0, s48, 12288
    s_mov_b32 s22, 49152
    buffer_load_dwordx4 v45, s[8:11], s22 offen  lds
    s_waitcnt vmcnt(28)
    s_barrier
    v_add_u32 v48, 16384, v46
    ds_read_b64_tr_b16 a[144:145], v48 offset:0
    ds_read_b64_tr_b16 a[146:147], v48 offset:512
    ds_read_b64_tr_b16 a[148:149], v48 offset:8192
    ds_read_b64_tr_b16 a[150:151], v48 offset:8704
    ds_read_b64_tr_b16 a[152:153], v48 offset:8
    ds_read_b64_tr_b16 a[154:155], v48 offset:520
    ds_read_b64_tr_b16 a[156:157], v48 offset:8200
    ds_read_b64_tr_b16 a[158:159], v48 offset:8712
    s_waitcnt lgkmcnt(0)
    s_barrier
    s_add_u32 m0, s48, 16384
    s_mov_b32 s22, 256
    buffer_load_dwordx4 v45, s[8:11], s22 offen  lds
    s_add_u32 m0, s48, 20480
    s_mov_b32 s22, 16640
    buffer_load_dwordx4 v45, s[8:11], s22 offen  lds
    s_add_u32 m0, s48, 24576
    s_mov_b32 s22, 33024
    buffer_load_dwordx4 v45, s[8:11], s22 offen  lds
    s_add_u32 m0, s48, 28672
    s_mov_b32 s22, 49408
    buffer_load_dwordx4 v45, s[8:11], s22 offen  lds
    s_waitcnt vmcnt(28)
    s_barrier
    v_add_u32 v48, 32768, v46
    ds_read_b64_tr_b16 a[160:161], v48 offset:0
    ds_read_b64_tr_b16 a[162:163], v48 offset:512
    ds_read_b64_tr_b16 a[164:165], v48 offset:8192
    ds_read_b64_tr_b16 a[166:167], v48 offset:8704
    ds_read_b64_tr_b16 a[168:169], v48 offset:8
    ds_read_b64_tr_b16 a[170:171], v48 offset:520
    ds_read_b64_tr_b16 a[172:173], v48 offset:8200
    ds_read_b64_tr_b16 a[174:175], v48 offset:8712
    s_waitcnt lgkmcnt(0)
    s_barrier
    s_add_u32 m0, s48, 32768
    s_mov_b32 s22, 512
    buffer_load_dwordx4 v45, s[8:11], s22 offen  lds
    s_add_u32 m0, s48, 36864
    s_mov_b32 s22, 16896
    buffer_load_dwordx4 v45, s[8:11], s22 offen  lds
    s_add_u32 m0, s48, 40960
    s_mov_b32 s22, 33280
    buffer_load_dwordx4 v45, s[8:11], s22 offen  lds
    s_add_u32 m0, s48, 45056
    s_mov_b32 s22, 49664
    buffer_load_dwordx4 v45, s[8:11], s22 offen  lds
    s_waitcnt vmcnt(28)
    s_barrier
    v_add_u32 v48, 49152, v46
    ds_read_b64_tr_b16 a[176:177], v48 offset:0
    ds_read_b64_tr_b16 a[178:179], v48 offset:512
    ds_read_b64_tr_b16 a[180:181], v48 offset:8192
    ds_read_b64_tr_b16 a[182:183], v48 offset:8704
    ds_read_b64_tr_b16 a[184:185], v48 offset:8
    ds_read_b64_tr_b16 a[186:187], v48 offset:520
    ds_read_b64_tr_b16 a[188:189], v48 offset:8200
    ds_read_b64_tr_b16 a[190:191], v48 offset:8712
    s_waitcnt lgkmcnt(0)
    s_barrier
    s_add_u32 m0, s48, 49152
    s_mov_b32 s22, 768
    buffer_load_dwordx4 v45, s[8:11], s22 offen  lds
    s_add_u32 m0, s48, 53248
    s_mov_b32 s22, 17152
    buffer_load_dwordx4 v45, s[8:11], s22 offen  lds
    s_add_u32 m0, s48, 57344
    s_mov_b32 s22, 33536
    buffer_load_dwordx4 v45, s[8:11], s22 offen  lds
    s_add_u32 m0, s48, 61440
    s_mov_b32 s22, 49920
    buffer_load_dwordx4 v45, s[8:11], s22 offen  lds
    s_waitcnt vmcnt(28)
    s_barrier
    v_and_b32 v37, 7, v0
    v_lshlrev_b32 v37, 5, v37
    buffer_load_dword v36, v37, s[88:91], 0 offen sc1
    buffer_load_dword v58, off, s[12:15], 0 offset:204 sc1
    v_add_u32 v48, 65536, v46
    ds_read_b64_tr_b16 a[192:193], v48 offset:0
    ds_read_b64_tr_b16 a[194:195], v48 offset:512
    ds_read_b64_tr_b16 a[196:197], v48 offset:8192
    ds_read_b64_tr_b16 a[198:199], v48 offset:8704
    ds_read_b64_tr_b16 a[200:201], v48 offset:8
    ds_read_b64_tr_b16 a[202:203], v48 offset:520
    ds_read_b64_tr_b16 a[204:205], v48 offset:8200
    ds_read_b64_tr_b16 a[206:207], v48 offset:8712
    s_waitcnt lgkmcnt(0)
    s_barrier
    s_add_u32 m0, s48, 65536
    s_mov_b32 s22, 131072
    buffer_load_dwordx4 v45, s[8:11], s22 offen  lds
    s_add_u32 m0, s48, 69632
    s_mov_b32 s22, 147456
    buffer_load_dwordx4 v45, s[8:11], s22 offen  lds
    s_add_u32 m0, s48, 73728
    s_mov_b32 s22, 163840
    buffer_load_dwordx4 v45, s[8:11], s22 offen  lds
    s_add_u32 m0, s48, 77824
    s_mov_b32 s22, 180224
    buffer_load_dwordx4 v45, s[8:11], s22 offen  lds
    s_waitcnt vmcnt(28)
    s_barrier
    v_add_u32 v48, 81920, v46
    ds_read_b64_tr_b16 a[208:209], v48 offset:0
    ds_read_b64_tr_b16 a[210:211], v48 offset:512
    ds_read_b64_tr_b16 a[212:213], v48 offset:8192
    ds_read_b64_tr_b16 a[214:215], v48 offset:8704
    ds_read_b64_tr_b16 a[216:217], v48 offset:8
    ds_read_b64_tr_b16 a[218:219], v48 offset:520
    ds_read_b64_tr_b16 a[220:221], v48 offset:8200
    ds_read_b64_tr_b16 a[222:223], v48 offset:8712
    s_waitcnt lgkmcnt(0)
    s_barrier
    s_add_u32 m0, s48, 81920
    s_mov_b32 s22, 131328
    buffer_load_dwordx4 v45, s[8:11], s22 offen  lds
    s_add_u32 m0, s48, 86016
    s_mov_b32 s22, 147712
    buffer_load_dwordx4 v45, s[8:11], s22 offen  lds
    s_add_u32 m0, s48, 90112
    s_mov_b32 s22, 164096
    buffer_load_dwordx4 v45, s[8:11], s22 offen  lds
    s_add_u32 m0, s48, 94208
    s_mov_b32 s22, 180480
    buffer_load_dwordx4 v45, s[8:11], s22 offen  lds
    s_waitcnt vmcnt(28)
    s_barrier
    v_add_u32 v48, 98304, v46
    ds_read_b64_tr_b16 a[224:225], v48 offset:0
    ds_read_b64_tr_b16 a[226:227], v48 offset:512
    ds_read_b64_tr_b16 a[228:229], v48 offset:8192
    ds_read_b64_tr_b16 a[230:231], v48 offset:8704
    ds_read_b64_tr_b16 a[232:233], v48 offset:8
    ds_read_b64_tr_b16 a[234:235], v48 offset:520
    ds_read_b64_tr_b16 a[236:237], v48 offset:8200
    ds_read_b64_tr_b16 a[238:239], v48 offset:8712
    s_waitcnt lgkmcnt(0)
    s_barrier
    s_add_u32 m0, s48, 98304
    s_mov_b32 s22, 131584
    buffer_load_dwordx4 v45, s[8:11], s22 offen  lds
    s_add_u32 m0, s48, 102400
    s_mov_b32 s22, 147968
    buffer_load_dwordx4 v45, s[8:11], s22 offen  lds
    s_add_u32 m0, s48, 106496
    s_mov_b32 s22, 164352
    buffer_load_dwordx4 v45, s[8:11], s22 offen  lds
    s_add_u32 m0, s48, 110592
    s_mov_b32 s22, 180736
    buffer_load_dwordx4 v45, s[8:11], s22 offen  lds
    s_waitcnt vmcnt(28)
    s_barrier
    v_add_u32 v48, 114688, v46
    ds_read_b64_tr_b16 a[240:241], v48 offset:0
    ds_read_b64_tr_b16 a[242:243], v48 offset:512
    ds_read_b64_tr_b16 a[244:245], v48 offset:8192
    ds_read_b64_tr_b16 a[246:247], v48 offset:8704
    ds_read_b64_tr_b16 a[248:249], v48 offset:8
    ds_read_b64_tr_b16 a[250:251], v48 offset:520
    ds_read_b64_tr_b16 a[252:253], v48 offset:8200
    ds_read_b64_tr_b16 a[254:255], v48 offset:8712
    s_waitcnt lgkmcnt(0)
    s_barrier
    s_add_u32 m0, s48, 114688
    s_mov_b32 s22, 131840
    buffer_load_dwordx4 v45, s[8:11], s22 offen  lds
    s_add_u32 m0, s48, 118784
    s_mov_b32 s22, 148224
    buffer_load_dwordx4 v45, s[8:11], s22 offen  lds
    s_add_u32 m0, s48, 122880
    s_mov_b32 s22, 164608
    buffer_load_dwordx4 v45, s[8:11], s22 offen  lds
    s_add_u32 m0, s48, 126976
    s_mov_b32 s22, 180992
    buffer_load_dwordx4 v45, s[8:11], s22 offen  lds
    s_waitcnt vmcnt(28)
    s_barrier
    s_cmp_lg_u32 s20, 0
    s_cbranch_scc1 mega_kernel_rf_wo0
    v_xor_b32 v48, 0, v47
    v_add_u32 v48, 0, v48
    ds_read_b64_tr_b16 v[128:129], v48 offset:0
    ds_read_b64_tr_b16 v[130:131], v48 offset:512
    ds_read_b64_tr_b16 v[132:133], v48 offset:8192
    ds_read_b64_tr_b16 v[134:135], v48 offset:8704
    ds_read_b64_tr_b16 v[144:145], v48 offset:32
    ds_read_b64_tr_b16 v[146:147], v48 offset:544
    ds_read_b64_tr_b16 v[148:149], v48 offset:8224
    ds_read_b64_tr_b16 v[150:151], v48 offset:8736
    s_waitcnt lgkmcnt(0)
    v_xor_b32 v48, 64, v47
    v_add_u32 v48, 0, v48
    ds_read_b64_tr_b16 v[160:161], v48 offset:0
    ds_read_b64_tr_b16 v[162:163], v48 offset:512
    ds_read_b64_tr_b16 v[164:165], v48 offset:8192
    ds_read_b64_tr_b16 v[166:167], v48 offset:8704
    ds_read_b64_tr_b16 v[176:177], v48 offset:32
    ds_read_b64_tr_b16 v[178:179], v48 offset:544
    ds_read_b64_tr_b16 v[180:181], v48 offset:8224
    ds_read_b64_tr_b16 v[182:183], v48 offset:8736
    s_waitcnt lgkmcnt(0)
    v_xor_b32 v48, 128, v47
    v_add_u32 v48, 0, v48
    ds_read_b64_tr_b16 v[192:193], v48 offset:0
    ds_read_b64_tr_b16 v[194:195], v48 offset:512
    ds_read_b64_tr_b16 v[196:197], v48 offset:8192
    ds_read_b64_tr_b16 v[198:199], v48 offset:8704
    ds_read_b64_tr_b16 v[208:209], v48 offset:32
    ds_read_b64_tr_b16 v[210:211], v48 offset:544
    ds_read_b64_tr_b16 v[212:213], v48 offset:8224
    ds_read_b64_tr_b16 v[214:215], v48 offset:8736
    s_waitcnt lgkmcnt(0)
    v_xor_b32 v48, 192, v47
    v_add_u32 v48, 0, v48
    ds_read_b64_tr_b16 v[224:225], v48 offset:0
    ds_read_b64_tr_b16 v[226:227], v48 offset:512
    ds_read_b64_tr_b16 v[228:229], v48 offset:8192
    ds_read_b64_tr_b16 v[230:231], v48 offset:8704
    ds_read_b64_tr_b16 v[240:241], v48 offset:32
    ds_read_b64_tr_b16 v[242:243], v48 offset:544
    ds_read_b64_tr_b16 v[244:245], v48 offset:8224
    ds_read_b64_tr_b16 v[246:247], v48 offset:8736
    s_waitcnt lgkmcnt(0)
mega_kernel_rf_wo0:
    s_barrier
    s_mov_b32 s8, s54
    s_mov_b32 s9, s55
    s_add_u32 m0, s48, 0
    s_mov_b32 s22, 0
    buffer_load_dwordx4 v44, s[8:11], s22 offen  lds
    s_add_u32 m0, s48, 4096
    s_mov_b32 s22, 32768
    buffer_load_dwordx4 v44, s[8:11], s22 offen  lds
    s_add_u32 m0, s48, 8192
    s_mov_b32 s22, 65536
    buffer_load_dwordx4 v44, s[8:11], s22 offen  lds
    s_add_u32 m0, s48, 12288
    s_mov_b32 s22, 98304
    buffer_load_dwordx4 v44, s[8:11], s22 offen  lds
    s_waitcnt vmcnt(28)
    s_barrier
    s_cmp_lg_u32 s20, 1
    s_cbranch_scc1 mega_kernel_rf_wo1
    v_xor_b32 v48, 0, v47
    v_add_u32 v48, 16384, v48
    ds_read_b64_tr_b16 v[128:129], v48 offset:0
    ds_read_b64_tr_b16 v[130:131], v48 offset:512
    ds_read_b64_tr_b16 v[132:133], v48 offset:8192
    ds_read_b64_tr_b16 v[134:135], v48 offset:8704
    ds_read_b64_tr_b16 v[144:145], v48 offset:32
    ds_read_b64_tr_b16 v[146:147], v48 offset:544
    ds_read_b64_tr_b16 v[148:149], v48 offset:8224
    ds_read_b64_tr_b16 v[150:151], v48 offset:8736
    s_waitcnt lgkmcnt(0)
    v_xor_b32 v48, 64, v47
    v_add_u32 v48, 16384, v48
    ds_read_b64_tr_b16 v[160:161], v48 offset:0
    ds_read_b64_tr_b16 v[162:163], v48 offset:512
    ds_read_b64_tr_b16 v[164:165], v48 offset:8192
    ds_read_b64_tr_b16 v[166:167], v48 offset:8704
    ds_read_b64_tr_b16 v[176:177], v48 offset:32
    ds_read_b64_tr_b16 v[178:179], v48 offset:544
    ds_read_b64_tr_b16 v[180:181], v48 offset:8224
    ds_read_b64_tr_b16 v[182:183], v48 offset:8736
    s_waitcnt lgkmcnt(0)
    v_xor_b32 v48, 128, v47
    v_add_u32 v48, 16384, v48
    ds_read_b64_tr_b16 v[192:193], v48 offset:0
    ds_read_b64_tr_b16 v[194:195], v48 offset:512
    ds_read_b64_tr_b16 v[196:197], v48 offset:8192
    ds_read_b64_tr_b16 v[198:199], v48 offset:8704
    ds_read_b64_tr_b16 v[208:209], v48 offset:32
    ds_read_b64_tr_b16 v[210:211], v48 offset:544
    ds_read_b64_tr_b16 v[212:213], v48 offset:8224
    ds_read_b64_tr_b16 v[214:215], v48 offset:8736
    s_waitcnt lgkmcnt(0)
    v_xor_b32 v48, 192, v47
    v_add_u32 v48, 16384, v48
    ds_read_b64_tr_b16 v[224:225], v48 offset:0
    ds_read_b64_tr_b16 v[226:227], v48 offset:512
    ds_read_b64_tr_b16 v[228:229], v48 offset:8192
    ds_read_b64_tr_b16 v[230:231], v48 offset:8704
    ds_read_b64_tr_b16 v[240:241], v48 offset:32
    ds_read_b64_tr_b16 v[242:243], v48 offset:544
    ds_read_b64_tr_b16 v[244:245], v48 offset:8224
    ds_read_b64_tr_b16 v[246:247], v48 offset:8736
    s_waitcnt lgkmcnt(0)
mega_kernel_rf_wo1:
    s_barrier
    s_add_u32 m0, s48, 16384
    s_mov_b32 s22, 524288
    buffer_load_dwordx4 v44, s[8:11], s22 offen  lds
    s_add_u32 m0, s48, 20480
    s_mov_b32 s22, 557056
    buffer_load_dwordx4 v44, s[8:11], s22 offen  lds
    s_add_u32 m0, s48, 24576
    s_mov_b32 s22, 589824
    buffer_load_dwordx4 v44, s[8:11], s22 offen  lds
    s_add_u32 m0, s48, 28672
    s_mov_b32 s22, 622592
    buffer_load_dwordx4 v44, s[8:11], s22 offen  lds
    s_waitcnt vmcnt(28)
    s_barrier
    s_cmp_lg_u32 s20, 2
    s_cbranch_scc1 mega_kernel_rf_wo2
    v_xor_b32 v48, 0, v47
    v_add_u32 v48, 32768, v48
    ds_read_b64_tr_b16 v[128:129], v48 offset:0
    ds_read_b64_tr_b16 v[130:131], v48 offset:512
    ds_read_b64_tr_b16 v[132:133], v48 offset:8192
    ds_read_b64_tr_b16 v[134:135], v48 offset:8704
    ds_read_b64_tr_b16 v[144:145], v48 offset:32
    ds_read_b64_tr_b16 v[146:147], v48 offset:544
    ds_read_b64_tr_b16 v[148:149], v48 offset:8224
    ds_read_b64_tr_b16 v[150:151], v48 offset:8736
    s_waitcnt lgkmcnt(0)
    v_xor_b32 v48, 64, v47
    v_add_u32 v48, 32768, v48
    ds_read_b64_tr_b16 v[160:161], v48 offset:0
    ds_read_b64_tr_b16 v[162:163], v48 offset:512
    ds_read_b64_tr_b16 v[164:165], v48 offset:8192
    ds_read_b64_tr_b16 v[166:167], v48 offset:8704
    ds_read_b64_tr_b16 v[176:177], v48 offset:32
    ds_read_b64_tr_b16 v[178:179], v48 offset:544
    ds_read_b64_tr_b16 v[180:181], v48 offset:8224
    ds_read_b64_tr_b16 v[182:183], v48 offset:8736
    s_waitcnt lgkmcnt(0)
    v_xor_b32 v48, 128, v47
    v_add_u32 v48, 32768, v48
    ds_read_b64_tr_b16 v[192:193], v48 offset:0
    ds_read_b64_tr_b16 v[194:195], v48 offset:512
    ds_read_b64_tr_b16 v[196:197], v48 offset:8192
    ds_read_b64_tr_b16 v[198:199], v48 offset:8704
    ds_read_b64_tr_b16 v[208:209], v48 offset:32
    ds_read_b64_tr_b16 v[210:211], v48 offset:544
    ds_read_b64_tr_b16 v[212:213], v48 offset:8224
    ds_read_b64_tr_b16 v[214:215], v48 offset:8736
    s_waitcnt lgkmcnt(0)
    v_xor_b32 v48, 192, v47
    v_add_u32 v48, 32768, v48
    ds_read_b64_tr_b16 v[224:225], v48 offset:0
    ds_read_b64_tr_b16 v[226:227], v48 offset:512
    ds_read_b64_tr_b16 v[228:229], v48 offset:8192
    ds_read_b64_tr_b16 v[230:231], v48 offset:8704
    ds_read_b64_tr_b16 v[240:241], v48 offset:32
    ds_read_b64_tr_b16 v[242:243], v48 offset:544
    ds_read_b64_tr_b16 v[244:245], v48 offset:8224
    ds_read_b64_tr_b16 v[246:247], v48 offset:8736
    s_waitcnt lgkmcnt(0)
mega_kernel_rf_wo2:
    s_barrier
    s_add_u32 m0, s48, 32768
    s_mov_b32 s22, 1048576
    buffer_load_dwordx4 v44, s[8:11], s22 offen  lds
    s_add_u32 m0, s48, 36864
    s_mov_b32 s22, 1081344
    buffer_load_dwordx4 v44, s[8:11], s22 offen  lds
    s_add_u32 m0, s48, 40960
    s_mov_b32 s22, 1114112
    buffer_load_dwordx4 v44, s[8:11], s22 offen  lds
    s_add_u32 m0, s48, 45056
    s_mov_b32 s22, 1146880
    buffer_load_dwordx4 v44, s[8:11], s22 offen  lds
    s_waitcnt vmcnt(28)
    s_barrier
    s_cmp_lg_u32 s20, 3
    s_cbranch_scc1 mega_kernel_rf_wo3
    v_xor_b32 v48, 0, v47
    v_add_u32 v48, 49152, v48
    ds_read_b64_tr_b16 v[128:129], v48 offset:0
    ds_read_b64_tr_b16 v[130:131], v48 offset:512
    ds_read_b64_tr_b16 v[132:133], v48 offset:8192
    ds_read_b64_tr_b16 v[134:135], v48 offset:8704
    ds_read_b64_tr_b16 v[144:145], v48 offset:32
    ds_read_b64_tr_b16 v[146:147], v48 offset:544
    ds_read_b64_tr_b16 v[148:149], v48 offset:8224
    ds_read_b64_tr_b16 v[150:151], v48 offset:8736
    s_waitcnt lgkmcnt(0)
    v_xor_b32 v48, 64, v47
    v_add_u32 v48, 49152, v48
    ds_read_b64_tr_b16 v[160:161], v48 offset:0
    ds_read_b64_tr_b16 v[162:163], v48 offset:512
    ds_read_b64_tr_b16 v[164:165], v48 offset:8192
    ds_read_b64_tr_b16 v[166:167], v48 offset:8704
    ds_read_b64_tr_b16 v[176:177], v48 offset:32
    ds_read_b64_tr_b16 v[178:179], v48 offset:544
    ds_read_b64_tr_b16 v[180:181], v48 offset:8224
    ds_read_b64_tr_b16 v[182:183], v48 offset:8736
    s_waitcnt lgkmcnt(0)
    v_xor_b32 v48, 128, v47
    v_add_u32 v48, 49152, v48
    ds_read_b64_tr_b16 v[192:193], v48 offset:0
    ds_read_b64_tr_b16 v[194:195], v48 offset:512
    ds_read_b64_tr_b16 v[196:197], v48 offset:8192
    ds_read_b64_tr_b16 v[198:199], v48 offset:8704
    ds_read_b64_tr_b16 v[208:209], v48 offset:32
    ds_read_b64_tr_b16 v[210:211], v48 offset:544
    ds_read_b64_tr_b16 v[212:213], v48 offset:8224
    ds_read_b64_tr_b16 v[214:215], v48 offset:8736
    s_waitcnt lgkmcnt(0)
    v_xor_b32 v48, 192, v47
    v_add_u32 v48, 49152, v48
    ds_read_b64_tr_b16 v[224:225], v48 offset:0
    ds_read_b64_tr_b16 v[226:227], v48 offset:512
    ds_read_b64_tr_b16 v[228:229], v48 offset:8192
    ds_read_b64_tr_b16 v[230:231], v48 offset:8704
    ds_read_b64_tr_b16 v[240:241], v48 offset:32
    ds_read_b64_tr_b16 v[242:243], v48 offset:544
    ds_read_b64_tr_b16 v[244:245], v48 offset:8224
    ds_read_b64_tr_b16 v[246:247], v48 offset:8736
    s_waitcnt lgkmcnt(0)
mega_kernel_rf_wo3:
    s_barrier
    s_add_u32 m0, s48, 49152
    s_mov_b32 s22, 1572864
    buffer_load_dwordx4 v44, s[8:11], s22 offen  lds
    s_add_u32 m0, s48, 53248
    s_mov_b32 s22, 1605632
    buffer_load_dwordx4 v44, s[8:11], s22 offen  lds
    s_add_u32 m0, s48, 57344
    s_mov_b32 s22, 1638400
    buffer_load_dwordx4 v44, s[8:11], s22 offen  lds
    s_add_u32 m0, s48, 61440
    s_mov_b32 s22, 1671168
    buffer_load_dwordx4 v44, s[8:11], s22 offen  lds
    s_waitcnt vmcnt(28)
    s_barrier
    s_cmp_lg_u32 s20, 0
    s_cbranch_scc1 mega_kernel_rf_wo4
    v_xor_b32 v48, 0, v47
    v_add_u32 v48, 65536, v48
    ds_read_b64_tr_b16 v[136:137], v48 offset:0
    ds_read_b64_tr_b16 v[138:139], v48 offset:512
    ds_read_b64_tr_b16 v[140:141], v48 offset:8192
    ds_read_b64_tr_b16 v[142:143], v48 offset:8704
    ds_read_b64_tr_b16 v[152:153], v48 offset:32
    ds_read_b64_tr_b16 v[154:155], v48 offset:544
    ds_read_b64_tr_b16 v[156:157], v48 offset:8224
    ds_read_b64_tr_b16 v[158:159], v48 offset:8736
    s_waitcnt lgkmcnt(0)
    v_xor_b32 v48, 64, v47
    v_add_u32 v48, 65536, v48
    ds_read_b64_tr_b16 v[168:169], v48 offset:0
    ds_read_b64_tr_b16 v[170:171], v48 offset:512
    ds_read_b64_tr_b16 v[172:173], v48 offset:8192
    ds_read_b64_tr_b16 v[174:175], v48 offset:8704
    ds_read_b64_tr_b16 v[184:185], v48 offset:32
    ds_read_b64_tr_b16 v[186:187], v48 offset:544
    ds_read_b64_tr_b16 v[188:189], v48 offset:8224
    ds_read_b64_tr_b16 v[190:191], v48 offset:8736
    s_waitcnt lgkmcnt(0)
    v_xor_b32 v48, 128, v47
    v_add_u32 v48, 65536, v48
    ds_read_b64_tr_b16 v[200:201], v48 offset:0
    ds_read_b64_tr_b16 v[202:203], v48 offset:512
    ds_read_b64_tr_b16 v[204:205], v48 offset:8192
    ds_read_b64_tr_b16 v[206:207], v48 offset:8704
    ds_read_b64_tr_b16 v[216:217], v48 offset:32
    ds_read_b64_tr_b16 v[218:219], v48 offset:544
    ds_read_b64_tr_b16 v[220:221], v48 offset:8224
    ds_read_b64_tr_b16 v[222:223], v48 offset:8736
    s_waitcnt lgkmcnt(0)
    v_xor_b32 v48, 192, v47
    v_add_u32 v48, 65536, v48
    ds_read_b64_tr_b16 v[232:233], v48 offset:0
    ds_read_b64_tr_b16 v[234:235], v48 offset:512
    ds_read_b64_tr_b16 v[236:237], v48 offset:8192
    ds_read_b64_tr_b16 v[238:239], v48 offset:8704
    ds_read_b64_tr_b16 v[248:249], v48 offset:32
    ds_read_b64_tr_b16 v[250:251], v48 offset:544
    ds_read_b64_tr_b16 v[252:253], v48 offset:8224
    ds_read_b64_tr_b16 v[254:255], v48 offset:8736
    s_waitcnt lgkmcnt(0)
mega_kernel_rf_wo4:
    s_barrier
    s_add_u32 m0, s48, 65536
    s_mov_b32 s22, 2097152
    buffer_load_dwordx4 v44, s[8:11], s22 offen  lds
    s_add_u32 m0, s48, 69632
    s_mov_b32 s22, 2129920
    buffer_load_dwordx4 v44, s[8:11], s22 offen  lds
    s_add_u32 m0, s48, 73728
    s_mov_b32 s22, 2162688
    buffer_load_dwordx4 v44, s[8:11], s22 offen  lds
    s_add_u32 m0, s48, 77824
    s_mov_b32 s22, 2195456
    buffer_load_dwordx4 v44, s[8:11], s22 offen  lds
    s_waitcnt vmcnt(28)
    s_barrier
    s_cmp_lg_u32 s20, 1
    s_cbranch_scc1 mega_kernel_rf_wo5
    v_xor_b32 v48, 0, v47
    v_add_u32 v48, 81920, v48
    ds_read_b64_tr_b16 v[136:137], v48 offset:0
    ds_read_b64_tr_b16 v[138:139], v48 offset:512
    ds_read_b64_tr_b16 v[140:141], v48 offset:8192
    ds_read_b64_tr_b16 v[142:143], v48 offset:8704
    ds_read_b64_tr_b16 v[152:153], v48 offset:32
    ds_read_b64_tr_b16 v[154:155], v48 offset:544
    ds_read_b64_tr_b16 v[156:157], v48 offset:8224
    ds_read_b64_tr_b16 v[158:159], v48 offset:8736
    s_waitcnt lgkmcnt(0)
    v_xor_b32 v48, 64, v47
    v_add_u32 v48, 81920, v48
    ds_read_b64_tr_b16 v[168:169], v48 offset:0
    ds_read_b64_tr_b16 v[170:171], v48 offset:512
    ds_read_b64_tr_b16 v[172:173], v48 offset:8192
    ds_read_b64_tr_b16 v[174:175], v48 offset:8704
    ds_read_b64_tr_b16 v[184:185], v48 offset:32
    ds_read_b64_tr_b16 v[186:187], v48 offset:544
    ds_read_b64_tr_b16 v[188:189], v48 offset:8224
    ds_read_b64_tr_b16 v[190:191], v48 offset:8736
    s_waitcnt lgkmcnt(0)
    v_xor_b32 v48, 128, v47
    v_add_u32 v48, 81920, v48
    ds_read_b64_tr_b16 v[200:201], v48 offset:0
    ds_read_b64_tr_b16 v[202:203], v48 offset:512
    ds_read_b64_tr_b16 v[204:205], v48 offset:8192
    ds_read_b64_tr_b16 v[206:207], v48 offset:8704
    ds_read_b64_tr_b16 v[216:217], v48 offset:32
    ds_read_b64_tr_b16 v[218:219], v48 offset:544
    ds_read_b64_tr_b16 v[220:221], v48 offset:8224
    ds_read_b64_tr_b16 v[222:223], v48 offset:8736
    s_waitcnt lgkmcnt(0)
    v_xor_b32 v48, 192, v47
    v_add_u32 v48, 81920, v48
    ds_read_b64_tr_b16 v[232:233], v48 offset:0
    ds_read_b64_tr_b16 v[234:235], v48 offset:512
    ds_read_b64_tr_b16 v[236:237], v48 offset:8192
    ds_read_b64_tr_b16 v[238:239], v48 offset:8704
    ds_read_b64_tr_b16 v[248:249], v48 offset:32
    ds_read_b64_tr_b16 v[250:251], v48 offset:544
    ds_read_b64_tr_b16 v[252:253], v48 offset:8224
    ds_read_b64_tr_b16 v[254:255], v48 offset:8736
    s_waitcnt lgkmcnt(0)
mega_kernel_rf_wo5:
    s_barrier
    s_add_u32 m0, s48, 81920
    s_mov_b32 s22, 2621440
    buffer_load_dwordx4 v44, s[8:11], s22 offen  lds
    s_add_u32 m0, s48, 86016
    s_mov_b32 s22, 2654208
    buffer_load_dwordx4 v44, s[8:11], s22 offen  lds
    s_add_u32 m0, s48, 90112
    s_mov_b32 s22, 2686976
    buffer_load_dwordx4 v44, s[8:11], s22 offen  lds
    s_add_u32 m0, s48, 94208
    s_mov_b32 s22, 2719744
    buffer_load_dwordx4 v44, s[8:11], s22 offen  lds
    s_waitcnt vmcnt(28)
    s_barrier
    s_cmp_lg_u32 s97, 0
    s_cbranch_scc1 mega_kernel_h2_2_ok
mega_kernel_h2_2_ev:
    v_cmp_ne_u32 vcc, 32, v36
    s_cbranch_vccz mega_kernel_h2_2_ok
    s_mov_b32 s78, 0
    v_readlane_b32 s81, v36, 0
    s_nop 3
    s_add_u32 s78, s78, s81
    v_readlane_b32 s81, v36, 1
    s_nop 3
    s_add_u32 s78, s78, s81
    v_readlane_b32 s81, v36, 2
    s_nop 3
    s_add_u32 s78, s78, s81
    v_readlane_b32 s81, v36, 3
    s_nop 3
    s_add_u32 s78, s78, s81
    v_readlane_b32 s81, v36, 4
    s_nop 3
    s_add_u32 s78, s78, s81
    v_readlane_b32 s81, v36, 5
    s_nop 3
    s_add_u32 s78, s78, s81
    v_readlane_b32 s81, v36, 6
    s_nop 3
    s_add_u32 s78, s78, s81
    v_readlane_b32 s81, v36, 7
    s_nop 3
    s_add_u32 s78, s78, s81
    s_cmp_eq_u32 s78, 256
    s_cbranch_scc1 mega_kernel_redo
    buffer_load_dword v36, v37, s[88:91], 0 offen sc1
    s_waitcnt vmcnt(0)
    s_branch mega_kernel_h2_2_ev
mega_kernel_h2_2_ok:
    s_cmp_lg_u32 s20, 2
    s_cbranch_scc1 mega_kernel_rf_wo6
    v_xor_b32 v48, 0, v47
    v_add_u32 v48, 98304, v48
    ds_read_b64_tr_b16 v[136:137], v48 offset:0
    ds_read_b64_tr_b16 v[138:139], v48 offset:512
    ds_read_b64_tr_b16 v[140:141], v48 offset:8192
    ds_read_b64_tr_b16 v[142:143], v48 offset:8704
    ds_read_b64_tr_b16 v[152:153], v48 offset:32
    ds_read_b64_tr_b16 v[154:155], v48 offset:544
    ds_read_b64_tr_b16 v[156:157], v48 offset:8224
    ds_read_b64_tr_b16 v[158:159], v48 offset:8736
    s_waitcnt lgkmcnt(0)
    v_xor_b32 v48, 64, v47
    v_add_u32 v48, 98304, v48
    ds_read_b64_tr_b16 v[168:169], v48 offset:0
    ds_read_b64_tr_b16 v[170:171], v48 offset:512
    ds_read_b64_tr_b16 v[172:173], v48 offset:8192
    ds_read_b64_tr_b16 v[174:175], v48 offset:8704
    ds_read_b64_tr_b16 v[184:185], v48 offset:32
    ds_read_b64_tr_b16 v[186:187], v48 offset:544
    ds_read_b64_tr_b16 v[188:189], v48 offset:8224
    ds_read_b64_tr_b16 v[190:191], v48 offset:8736
    s_waitcnt lgkmcnt(0)
    v_xor_b32 v48, 128, v47
    v_add_u32 v48, 98304, v48
    ds_read_b64_tr_b16 v[200:201], v48 offset:0
    ds_read_b64_tr_b16 v[202:203], v48 offset:512
    ds_read_b64_tr_b16 v[204:205], v48 offset:8192
    ds_read_b64_tr_b16 v[206:207], v48 offset:8704
    ds_read_b64_tr_b16 v[216:217], v48 offset:32
    ds_read_b64_tr_b16 v[218:219], v48 offset:544
    ds_read_b64_tr_b16 v[220:221], v48 offset:8224
    ds_read_b64_tr_b16 v[222:223], v48 offset:8736
    s_waitcnt lgkmcnt(0)
    v_xor_b32 v48, 192, v47
    v_add_u32 v48, 98304, v48
    ds_read_b64_tr_b16 v[232:233], v48 offset:0
    ds_read_b64_tr_b16 v[234:235], v48 offset:512
    ds_read_b64_tr_b16 v[236:237], v48 offset:8192
    ds_read_b64_tr_b16 v[238:239], v48 offset:8704
    ds_read_b64_tr_b16 v[248:249], v48 offset:32
    ds_read_b64_tr_b16 v[250:251], v48 offset:544
    ds_read_b64_tr_b16 v[252:253], v48 offset:8224
    ds_read_b64_tr_b16 v[254:255], v48 offset:8736
    s_waitcnt lgkmcnt(0)
mega_kernel_rf_wo6:
    s_barrier
    s_add_u32 m0, s48, 98304
    s_mov_b32 s22, 3145728
    buffer_load_dwordx4 v44, s[8:11], s22 offen  lds
    s_add_u32 m0, s48, 102400
    s_mov_b32 s22, 3178496
    buffer_load_dwordx4 v44, s[8:11], s22 offen  lds
    s_add_u32 m0, s48, 106496
    s_mov_b32 s22, 3211264
    buffer_load_dwordx4 v44, s[8:11], s22 offen  lds
    s_add_u32 m0, s48, 110592
    s_mov_b32 s22, 3244032
    buffer_load_dwordx4 v44, s[8:11], s22 offen  lds
    s_waitcnt vmcnt(28)
    s_barrier
    s_cmp_lg_u32 s20, 3
    s_cbranch_scc1 mega_kernel_rf_wo7
    v_xor_b32 v48, 0, v47
    v_add_u32 v48, 114688, v48
    ds_read_b64_tr_b16 v[136:137], v48 offset:0
    ds_read_b64_tr_b16 v[138:139], v48 offset:512
    ds_read_b64_tr_b16 v[140:141], v48 offset:8192
    ds_read_b64_tr_b16 v[142:143], v48 offset:8704
    ds_read_b64_tr_b16 v[152:153], v48 offset:32
    ds_read_b64_tr_b16 v[154:155], v48 offset:544
    ds_read_b64_tr_b16 v[156:157], v48 offset:8224
    ds_read_b64_tr_b16 v[158:159], v48 offset:8736
    s_waitcnt lgkmcnt(0)
    v_xor_b32 v48, 64, v47
    v_add_u32 v48, 114688, v48
    ds_read_b64_tr_b16 v[168:169], v48 offset:0
    ds_read_b64_tr_b16 v[170:171], v48 offset:512
    ds_read_b64_tr_b16 v[172:173], v48 offset:8192
    ds_read_b64_tr_b16 v[174:175], v48 offset:8704
    ds_read_b64_tr_b16 v[184:185], v48 offset:32
    ds_read_b64_tr_b16 v[186:187], v48 offset:544
    ds_read_b64_tr_b16 v[188:189], v48 offset:8224
    ds_read_b64_tr_b16 v[190:191], v48 offset:8736
    s_waitcnt lgkmcnt(0)
    v_xor_b32 v48, 128, v47
    v_add_u32 v48, 114688, v48
    ds_read_b64_tr_b16 v[200:201], v48 offset:0
    ds_read_b64_tr_b16 v[202:203], v48 offset:512
    ds_read_b64_tr_b16 v[204:205], v48 offset:8192
    ds_read_b64_tr_b16 v[206:207], v48 offset:8704
    ds_read_b64_tr_b16 v[216:217], v48 offset:32
    ds_read_b64_tr_b16 v[218:219], v48 offset:544
    ds_read_b64_tr_b16 v[220:221], v48 offset:8224
    ds_read_b64_tr_b16 v[222:223], v48 offset:8736
    s_waitcnt lgkmcnt(0)
    v_xor_b32 v48, 192, v47
    v_add_u32 v48, 114688, v48
    ds_read_b64_tr_b16 v[232:233], v48 offset:0
    ds_read_b64_tr_b16 v[234:235], v48 offset:512
    ds_read_b64_tr_b16 v[236:237], v48 offset:8192
    ds_read_b64_tr_b16 v[238:239], v48 offset:8704
    ds_read_b64_tr_b16 v[248:249], v48 offset:32
    ds_read_b64_tr_b16 v[250:251], v48 offset:544
    ds_read_b64_tr_b16 v[252:253], v48 offset:8224
    ds_read_b64_tr_b16 v[254:255], v48 offset:8736
    s_waitcnt lgkmcnt(0)
mega_kernel_rf_wo7:
    s_barrier
    s_add_u32 m0, s48, 114688
    s_mov_b32 s22, 3670016
    buffer_load_dwordx4 v44, s[8:11], s22 offen  lds
    s_add_u32 m0, s48, 118784
    s_mov_b32 s22, 3702784
    buffer_load_dwordx4 v44, s[8:11], s22 offen  lds
    s_add_u32 m0, s48, 122880
    s_mov_b32 s22, 3735552
    buffer_load_dwordx4 v44, s[8:11], s22 offen  lds
    s_add_u32 m0, s48, 126976
    s_mov_b32 s22, 3768320
    buffer_load_dwordx4 v44, s[8:11], s22 offen  lds
    s_waitcnt vmcnt(28)
    s_barrier
    v_add_u32 v48, 0, v46
    ds_read_b64_tr_b16 v[64:65], v48 offset:0
    ds_read_b64_tr_b16 v[66:67], v48 offset:512
    ds_read_b64_tr_b16 v[68:69], v48 offset:8192
    ds_read_b64_tr_b16 v[70:71], v48 offset:8704
    ds_read_b64_tr_b16 v[72:73], v48 offset:8
    ds_read_b64_tr_b16 v[74:75], v48 offset:520
    ds_read_b64_tr_b16 v[76:77], v48 offset:8200
    ds_read_b64_tr_b16 v[78:79], v48 offset:8712
    s_waitcnt lgkmcnt(0)
    s_barrier
    ds_write_b128 v32, v[64:67] offset:0
    ds_write_b128 v32, v[68:71] offset:1024
    ds_write_b128 v32, v[72:75] offset:2048
    ds_write_b128 v32, v[76:79] offset:3072
    s_waitcnt lgkmcnt(0)
    s_waitcnt vmcnt(24)
    s_barrier
    v_add_u32 v48, 16384, v46
    ds_read_b64_tr_b16 v[64:65], v48 offset:0
    ds_read_b64_tr_b16 v[66:67], v48 offset:512
    ds_read_b64_tr_b16 v[68:69], v48 offset:8192
    ds_read_b64_tr_b16 v[70:71], v48 offset:8704
    ds_read_b64_tr_b16 v[72:73], v48 offset:8
    ds_read_b64_tr_b16 v[74:75], v48 offset:520
    ds_read_b64_tr_b16 v[76:77], v48 offset:8200
    ds_read_b64_tr_b16 v[78:79], v48 offset:8712
    s_waitcnt lgkmcnt(0)
    s_barrier
    ds_write_b128 v32, v[64:67] offset:16384
    ds_write_b128 v32, v[68:71] offset:17408
    ds_write_b128 v32, v[72:75] offset:18432
    ds_write_b128 v32, v[76:79] offset:19456
    s_waitcnt lgkmcnt(0)
    s_waitcnt vmcnt(20)
    s_barrier
    s_getpc_b64 s[16:17]
mega_kernel_rf_pc0:
    s_add_u32 s16, s16, mega_kernel_rf_w0_entry - mega_kernel_rf_pc0
    s_addc_u32 s17, s17, 0
    v_lshlrev_b32 v49, 7, v0
    v_min_u32 v49, mega_kernel_rf_end - mega_kernel_rf_w0_entry, v49
    global_load_dword v50, v49, s[16:17]
    v_lshlrev_b32 v49, 7, v40
    s_xor_b32 s23, s35, 16384
    s_cmp_eq_u32 s20, 1
    s_cselect_b32 s22, s35, s47
    s_cmp_eq_u32 s20, 2
    s_cselect_b32 s22, s23, s22
    s_lshl_b32 s23, s31, 13
    s_add_u32 s23, s23, 178257920
    s_cmp_eq_u32 s20, 3
    s_cselect_b32 s22, s23, s22
    buffer_load_dword v51, v49, s[4:7], s22 offen sc1
    v_lshlrev_b32 v49, 13, v0
    v_and_b32 v49, 0x1fffff, v49
    s_mov_b32 s22, 67108864
    buffer_load_dword v52, v49, s[4:7], s22 offen sc1
    buffer_load_dword v57, v7, s[4:7], 0 offen sc1
    v_add_u32 v48, 32768, v46
    ds_read_b64_tr_b16 v[64:65], v48 offset:0
    ds_read_b64_tr_b16 v[66:67], v48 offset:512
    ds_read_b64_tr_b16 v[68:69], v48 offset:8192
    ds_read_b64_tr_b16 v[70:71], v48 offset:8704
    ds_read_b64_tr_b16 v[72:73], v48 offset:8
    ds_read_b64_tr_b16 v[74:75], v48 offset:520
    ds_read_b64_tr_b16 v[76:77], v48 offset:8200
    ds_read_b64_tr_b16 v[78:79], v48 offset:8712
    s_waitcnt lgkmcnt(0)
    s_barrier
    ds_write_b128 v32, v[64:67] offset:32768
    ds_write_b128 v32, v[68:71] offset:33792
    ds_write_b128 v32, v[72:75] offset:34816
    ds_write_b128 v32, v[76:79] offset:35840
    s_waitcnt lgkmcnt(0)
    s_waitcnt vmcnt(16)
    s_barrier
    v_add_u32 v48, 49152, v46
    ds_read_b64_tr_b16 v[64:65], v48 offset:0
    ds_read_b64_tr_b16 v[66:67], v48 offset:512
    ds_read_b64_tr_b16 v[68:69], v48 offset:8192
    ds_read_b64_tr_b16 v[70:71], v48 offset:8704
    ds_read_b64_tr_b16 v[72:73], v48 offset:8
    ds_read_b64_tr_b16 v[74:75], v48 offset:520
    ds_read_b64_tr_b16 v[76:77], v48 offset:8200
    ds_read_b64_tr_b16 v[78:79], v48 offset:8712
    s_waitcnt lgkmcnt(0)
    s_barrier
    ds_write_b128 v32, v[64:67] offset:49152
    ds_write_b128 v32, v[68:71] offset:50176
    ds_write_b128 v32, v[72:75] offset:51200
    ds_write_b128 v32, v[76:79] offset:52224
    s_waitcnt lgkmcnt(0)
    s_waitcnt vmcnt(12)
    s_barrier
    v_add_u32 v48, 65536, v46
    ds_read_b64_tr_b16 v[64:65], v48 offset:0
    ds_read_b64_tr_b16 v[66:67], v48 offset:512
    ds_read_b64_tr_b16 v[68:69], v48 offset:8192
    ds_read_b64_tr_b16 v[70:71], v48 offset:8704
    ds_read_b64_tr_b16 v[72:73], v48 offset:8
    ds_read_b64_tr_b16 v[74:75], v48 offset:520
    ds_read_b64_tr_b16 v[76:77], v48 offset:8200
    ds_read_b64_tr_b16 v[78:79], v48 offset:8712
    s_waitcnt lgkmcnt(0)
    s_barrier
    ds_write_b128 v33, v[64:67] offset:0
    ds_write_b128 v33, v[68:71] offset:1024
    ds_write_b128 v33, v[72:75] offset:2048
    ds_write_b128 v33, v[76:79] offset:3072
    s_waitcnt lgkmcnt(0)
    s_waitcnt vmcnt(8)
    s_barrier
    v_add_u32 v48, 81920, v46
    ds_read_b64_tr_b16 v[64:65], v48 offset:0
    ds_read_b64_tr_b16 v[66:67], v48 offset:512
    ds_read_b64_tr_b16 v[68:69], v48 offset:8192
    ds_read_b64_tr_b16 v[70:71], v48 offset:8704
    ds_read_b64_tr_b16 v[72:73], v48 offset:8
    ds_read_b64_tr_b16 v[74:75], v48 offset:520
    ds_read_b64_tr_b16 v[76:77], v48 offset:8200
    ds_read_b64_tr_b16 v[78:79], v48 offset:8712
    s_waitcnt lgkmcnt(0)
    s_barrier
    ds_write_b128 v33, v[64:67] offset:16384
    ds_write_b128 v33, v[68:71] offset:17408
    ds_write_b128 v33, v[72:75] offset:18432
    ds_write_b128 v33, v[76:79] offset:19456
    s_waitcnt lgkmcnt(0)
    s_waitcnt vmcnt(4)
    s_barrier
    v_add_u32 v48, 98304, v46
    ds_read_b64_tr_b16 v[64:65], v48 offset:0
    ds_read_b64_tr_b16 v[66:67], v48 offset:512
    ds_read_b64_tr_b16 v[68:69], v48 offset:8192
    ds_read_b64_tr_b16 v[70:71], v48 offset:8704
    ds_read_b64_tr_b16 v[72:73], v48 offset:8
    ds_read_b64_tr_b16 v[74:75], v48 offset:520
    ds_read_b64_tr_b16 v[76:77], v48 offset:8200
    ds_read_b64_tr_b16 v[78:79], v48 offset:8712
    s_waitcnt lgkmcnt(0)
    s_barrier
    ds_write_b128 v33, v[64:67] offset:32768
    ds_write_b128 v33, v[68:71] offset:33792
    ds_write_b128 v33, v[72:75] offset:34816
    ds_write_b128 v33, v[76:79] offset:35840
    s_waitcnt lgkmcnt(0)
    s_waitcnt vmcnt(0)
    s_barrier
    v_add_u32 v48, 114688, v46
    ds_read_b64_tr_b16 v[64:65], v48 offset:0
    ds_read_b64_tr_b16 v[66:67], v48 offset:512
    ds_read_b64_tr_b16 v[68:69], v48 offset:8192
    ds_read_b64_tr_b16 v[70:71], v48 offset:8704
    ds_read_b64_tr_b16 v[72:73], v48 offset:8
    ds_read_b64_tr_b16 v[74:75], v48 offset:520
    ds_read_b64_tr_b16 v[76:77], v48 offset:8200
    ds_read_b64_tr_b16 v[78:79], v48 offset:8712
    s_waitcnt lgkmcnt(0)
    s_barrier
    ds_write_b128 v33, v[64:67] offset:49152
    ds_write_b128 v33, v[68:71] offset:50176
    ds_write_b128 v33, v[72:75] offset:51200
    ds_write_b128 v33, v[76:79] offset:52224
    s_waitcnt lgkmcnt(0)
    s_branch mega_kernel_rf_iw1
mega_kernel_rf_iw:
    buffer_load_dword v58, off, s[12:15], 0 offset:204 sc1
    s_waitcnt vmcnt(0)
mega_kernel_rf_iw1:
    v_and_b32 v50, 0xffff, v58
    v_readfirstlane_b32 s60, v58
    v_cmp_ne_u32 vcc, s100, v50
    s_cbranch_vccnz mega_kernel_rf_iw
    s_lshr_b32 s60, s60, 15
    s_cmp_gt_u32 s60, s100
    s_cselect_b32 s60, 8192, 0
    s_bfe_u32 s22, s31, 0x10001
    s_lshl_b32 s22, s22, 12
    s_add_u32 s22, s22, s60
    s_lshl_b32 s23, s20, 10
    s_add_u32 s22, s22, s23
    s_add_u32 s38, s38, s22
    s_add_u32 s37, s37, s22
    s_xor_b32 s40, s38, 4096
    s_xor_b32 s39, s37, 4096
    s_xor_b32 s36, s35, 16384
    s_mov_b32 s21, 0
    s_cmp_eq_u32 s30, 0
    s_mov_b32 s22, 0x33003300
    s_cselect_b32 s16, 0x00330033, s22
    s_mov_b32 s17, s16
    s_cselect_b32 s18, -1, 0
    s_not_b32 s19, s18
    s_lshl_b32 s22, s31, 13
    s_lshl_b32 s23, s20, 11
    s_add_u32 s22, s22, s23
    s_add_u32 s43, s22, 16777216
    s_add_u32 s44, s22, 33554432
    s_lshl_b32 s45, s31, 13
    s_add_u32 s45, s45, 178257920
    s_mul_i32 s48, s20, 5120
    s_add_u32 m0, s48, 140288
    s_mov_b32 s41, 1
    s_mov_b32 s42, 1
    v_mov_b32 v0, v34
    v_bfrev_b32 v12, 1
    v_bfrev_b32 v3, 1
    v_cndmask_b32 v10, v3, v10, s[16:17]
    v_cndmask_b32 v9, v3, v9, s[26:27]
    s_sub_u32 s45, s45, 0
    s_lshl_b32 s51, s30, 11
    s_add_u32 s51, s51, s45
    s_mov_b32 s50, 0
    s_cmp_lg_u32 s20, 3
    s_cbranch_scc1 mega_kernel_rf_kv0
    v_readlane_b32 s50, v57, 0
    v_readlane_b32 s22, v57, 2
    v_readlane_b32 s23, v57, 1
    v_readlane_b32 s24, v57, 3
    s_nop 3
    s_min_u32 s50, s50, s22
    s_min_u32 s23, s23, s24
    s_lshl_b32 s50, s50, 1
    s_lshl_b32 s23, s23, 1
    s_add_u32 s23, s23, 1
    s_min_u32 s50, s50, s23
mega_kernel_rf_kvb0:
    s_add_u32 s22, s21, 1
    s_min_u32 s22, s22, 63
    s_cmp_gt_u32 s50, s22
    s_cbranch_scc1 mega_kernel_rf_kvd0
    buffer_load_dword v48, v7, s[4:7], 0 offen sc1
    s_waitcnt vmcnt(0)
    v_readlane_b32 s50, v48, 0
    v_readlane_b32 s22, v48, 2
    v_readlane_b32 s23, v48, 1
    v_readlane_b32 s24, v48, 3
    s_nop 3
    s_min_u32 s50, s50, s22
    s_min_u32 s23, s23, s24
    s_lshl_b32 s50, s50, 1
    s_lshl_b32 s23, s23, 1
    s_add_u32 s23, s23, 1
    s_min_u32 s50, s50, s23
    s_branch mega_kernel_rf_kvb0
mega_kernel_rf_kvd0:
mega_kernel_rf_kv0:
    s_barrier
    s_cmp_eq_u32 s20, 1
    s_cbranch_scc1 mega_kernel_rf_w1_entry
    s_cmp_eq_u32 s20, 2
    s_cbranch_scc1 mega_kernel_rf_w2_entry
    s_cmp_eq_u32 s20, 3
    s_cbranch_scc1 mega_kernel_rf_w3_entry
mega_kernel_rf_w0_entry:
    v_mfma_f32_32x32x8_bf16 v[96:111], v[14:15], v[14:15], 0
    v_mfma_f32_16x16x16_bf16 v[112:115], v[14:15], v[14:15], 0
    v_mfma_f32_16x16x16_bf16 v[116:119], v[14:15], v[14:15], 0
    ds_read_b128 v[64:67], v1 offset:0
    ds_read_b128 v[68:71], v1 offset:1024
    ds_read_b128 v[72:75], v1 offset:2048
    ds_read_b128 v[76:79], v1 offset:3072
    ds_read_b128 v[80:83], v1 offset:16384
    ds_read_b128 v[84:87], v1 offset:17408
    ds_read_b128 v[88:91], v1 offset:18432
    ds_read_b128 v[92:95], v1 offset:19456
    buffer_load_dwordx4 v[120:123], v1, s[4:7], s44 offen
    buffer_load_dwordx4 v[124:127], v1, s[4:7], s44 offen offset:1024
    s_add_u32 s44, s44, 262144
mega_kernel_rf_w0_loop:
    s_add_u32 s22, s35, 0
    s_waitcnt vmcnt(0)
    buffer_load_dwordx4 v[32:35], v1, s[4:7], s22 offen sc1
    buffer_load_dwordx4 v[36:39], v1, s[4:7], s22 offen offset:1024 sc1
mega_kernel_rf_w0_pa:
    s_waitcnt vmcnt(1)
    ds_write_b128 v6, v[32:35] offset:0
    s_waitcnt vmcnt(0)
    ds_write_b128 v6, v[36:39] offset:1024
    v_max3_u32 v3, v32, v34, v36
    v_max_u32 v3, v3, v38
    v_cmp_eq_u32 vcc, -1, v3
    v_smfmac_f32_16x16x64_bf16 v[96:99], v[32:35], a[0:7], v2
    buffer_load_dwordx4 v[32:35], v1, s[4:7], s22 offen sc1
    v_smfmac_f32_16x16x64_bf16 v[100:103], v[32:35], a[8:15], v2
    buffer_load_dwordx4 v[36:39], v1, s[4:7], s22 offen offset:1024 sc1
    v_smfmac_f32_16x16x64_bf16 v[104:107], v[32:35], a[128:135], v2
    s_cbranch_vccnz mega_kernel_rf_w0_pafail
    s_waitcnt lgkmcnt(0)
    s_barrier
    ds_read_b128 v[40:43], v6 offset:2048
    ds_read_b128 v[44:47], v6 offset:3072
    v_smfmac_f32_16x16x64_bf16 v[108:111], v[32:35], a[136:143], v2
    ds_read_b128 v[48:51], v6 offset:4096
    v_smfmac_f32_16x16x64_bf16 v[96:99], v[36:39], a[16:23], v2
    ds_read_b128 v[52:55], v6 offset:5120
    v_smfmac_f32_16x16x64_bf16 v[100:103], v[36:39], a[24:31], v2
    ds_read_b128 v[56:59], v6 offset:6144
    v_smfmac_f32_16x16x64_bf16 v[104:107], v[36:39], a[144:151], v2
    ds_read_b128 v[60:63], v6 offset:7168
    v_smfmac_f32_16x16x64_bf16 v[108:111], v[36:39], a[152:159], v2
    buffer_load_dwordx4 v1, s[4:7], s43 offen lds
    s_waitcnt lgkmcnt(5)
    v_smfmac_f32_16x16x64_bf16 v[96:99], v[40:43], a[32:39], v2
    v_smfmac_f32_16x16x64_bf16 v[104:107], v[40:43], a[160:167], v2
    s_waitcnt lgkmcnt(4)
    v_smfmac_f32_16x16x64_bf16 v[96:99], v[44:47], a[48:55], v2
    v_smfmac_f32_16x16x64_bf16 v[104:107], v[44:47], a[176:183], v2
    buffer_load_dwordx4 v1, s[4:7], s43 offen offset:1024 lds
    s_waitcnt lgkmcnt(3)
    v_smfmac_f32_16x16x64_bf16 v[96:99], v[48:51], a[64:71], v2
    v_smfmac_f32_16x16x64_bf16 v[104:107], v[48:51], a[192:199], v2
    s_waitcnt lgkmcnt(2)
    v_smfmac_f32_16x16x64_bf16 v[96:99], v[52:55], a[80:87], v2
    v_smfmac_f32_16x16x64_bf16 v[104:107], v[52:55], a[208:215], v2
    v_mov_b32 v4, s21
    buffer_store_dword v4, v7, s[4:7], 0 offen sc1
    s_waitcnt lgkmcnt(1)
    v_smfmac_f32_16x16x64_bf16 v[96:99], v[56:59], a[96:103], v2
    v_smfmac_f32_16x16x64_bf16 v[104:107], v[56:59], a[224:231], v2
    s_waitcnt lgkmcnt(0)
    v_smfmac_f32_16x16x64_bf16 v[96:99], v[60:63], a[112:119], v2
    v_smfmac_f32_16x16x64_bf16 v[104:107], v[60:63], a[240:247], v2
    v_smfmac_f32_16x16x64_bf16 v[100:103], v[40:43], a[40:47], v2
    s_nop 2
    v_smfmac_f32_16x16x64_bf16 v[100:103], v[44:47], a[56:63], v2
    s_nop 1
    v_add_f32 v96, v96, v98
    v_smfmac_f32_16x16x64_bf16 v[100:103], v[48:51], a[72:79], v2
    v_add_f32 v97, v97, v99
    v_add_f32 v104, v104, v106
    v_smfmac_f32_16x16x64_bf16 v[100:103], v[52:55], a[88:95], v2
    v_add_f32 v105, v105, v107
    v_cvt_pk_bf16_f32 v96, v96, v97
    v_smfmac_f32_16x16x64_bf16 v[100:103], v[56:59], a[104:111], v2
    v_cvt_pk_bf16_f32 v97, v104, v105
    v_and_or_b32 v96, v96, -2, s41
    v_smfmac_f32_16x16x64_bf16 v[100:103], v[60:63], a[120:127], v2
    buffer_store_dwordx2 v[96:97], v11, s[4:7], s37 offen sc1
    v_smfmac_f32_16x16x64_bf16 v[108:111], v[40:43], a[168:175], v2
    v_smfmac_f32_16x16x64_bf16 v[108:111], v[44:47], a[184:191], v2
    v_smfmac_f32_16x16x64_bf16 v[108:111], v[48:51], a[200:207], v2
    v_smfmac_f32_16x16x64_bf16 v[108:111], v[52:55], a[216:223], v2
    v_smfmac_f32_16x16x64_bf16 v[108:111], v[56:59], a[232:239], v2
    s_nop 2
    v_add_f32 v100, v100, v102
    v_smfmac_f32_16x16x64_bf16 v[108:111], v[60:63], a[248:255], v2
    v_add_f32 v101, v101, v103
    v_cvt_pk_bf16_f32 v98, v100, v101
    v_and_or_b32 v98, v98, -2, s41
    s_nop 4
    v_pk_add_f32 v[108:109], v[108:109], v[110:111]
    v_cvt_pk_bf16_f32 v99, v108, v109
    buffer_store_dwordx2 v[98:99], v11, s[4:7], s37 offen offset:512 sc1
    v_smfmac_f32_16x16x64_bf16 v[112:115], v[32:35], v[64:71], v2
    ds_read_b128 v[64:67], v1 offset:32768
    ds_read_b128 v[68:71], v1 offset:33792
    v_smfmac_f32_16x16x64_bf16 v[116:119], v[32:35], v[72:79], v2
    ds_read_b128 v[72:75], v1 offset:34816
    ds_read_b128 v[76:79], v1 offset:35840
    v_smfmac_f32_16x16x64_bf16 v[112:115], v[36:39], v[80:87], v2
    ds_read_b128 v[80:83], v1 offset:49152
    ds_read_b128 v[84:87], v1 offset:50176
    v_smfmac_f32_16x16x64_bf16 v[116:119], v[36:39], v[88:95], v2
    ds_read_b128 v[88:91], v1 offset:51200
    ds_read_b128 v[92:95], v1 offset:52224
    s_waitcnt lgkmcnt(6)
    v_smfmac_f32_16x16x64_bf16 v[112:115], v[40:43], v[64:71], v2
    ds_read_b128 v[64:67], v5 offset:0
    ds_read_b128 v[68:71], v5 offset:1024
    s_waitcnt lgkmcnt(6)
    v_smfmac_f32_16x16x64_bf16 v[116:119], v[40:43], v[72:79], v2
    ds_read_b128 v[72:75], v5 offset:2048
    ds_read_b128 v[76:79], v5 offset:3072
    s_waitcnt lgkmcnt(6)
    v_smfmac_f32_16x16x64_bf16 v[112:115], v[44:47], v[80:87], v2
    ds_read_b128 v[80:83], v5 offset:16384
    ds_read_b128 v[84:87], v5 offset:17408
    s_waitcnt lgkmcnt(6)
    v_smfmac_f32_16x16x64_bf16 v[116:119], v[44:47], v[88:95], v2
    ds_read_b128 v[88:91], v5 offset:18432
    ds_read_b128 v[92:95], v5 offset:19456
    s_waitcnt lgkmcnt(6)
    v_smfmac_f32_16x16x64_bf16 v[112:115], v[48:51], v[64:71], v2
    ds_read_b128 v[64:67], v5 offset:32768
    ds_read_b128 v[68:71], v5 offset:33792
    s_waitcnt lgkmcnt(6)
    v_smfmac_f32_16x16x64_bf16 v[116:119], v[48:51], v[72:79], v2
    ds_read_b128 v[72:75], v5 offset:34816
    ds_read_b128 v[76:79], v5 offset:35840
    s_waitcnt lgkmcnt(6)
    v_smfmac_f32_16x16x64_bf16 v[112:115], v[52:55], v[80:87], v2
    ds_read_b128 v[80:83], v5 offset:49152
    ds_read_b128 v[84:87], v5 offset:50176
    s_waitcnt lgkmcnt(6)
    v_smfmac_f32_16x16x64_bf16 v[116:119], v[52:55], v[88:95], v2
    ds_read_b128 v[88:91], v5 offset:51200
    ds_read_b128 v[92:95], v5 offset:52224
    s_waitcnt lgkmcnt(6)
    v_smfmac_f32_16x16x64_bf16 v[112:115], v[56:59], v[64:71], v2
    s_waitcnt lgkmcnt(4)
    v_smfmac_f32_16x16x64_bf16 v[116:119], v[56:59], v[72:79], v2
    s_waitcnt lgkmcnt(2)
    v_smfmac_f32_16x16x64_bf16 v[112:115], v[60:63], v[80:87], v2
    s_waitcnt lgkmcnt(0)
    v_smfmac_f32_16x16x64_bf16 v[116:119], v[60:63], v[88:95], v2
    buffer_load_dwordx2 v[108:109], v11, s[4:7], s38 offen sc1
    v_mfma_f32_16x16x16_bf16 v[100:103], v[96:97], v[16:17], 0
    v_mfma_f32_16x16x16_bf16 v[104:107], v[98:99], v[16:17], 0
    s_nop 4
    v_add_f32 v112, v112, v114
    v_add_f32 v113, v113, v115
    v_add_f32 v114, v116, v118
    v_add_f32 v115, v117, v119
    v_cvt_pk_bf16_f32 v18, v112, v113
    v_cvt_pk_bf16_f32 v19, v114, v115
    v_and_or_b32 v18, v18, -2, s41
    buffer_load_dwordx2 v[110:111], v11, s[4:7], s38 offen offset:512 sc1
    s_barrier
    buffer_store_dwordx2 v[18:19], v11, s[4:7], s39 offen sc1
    v_mov_b32 v112, v18
    v_mov_b32 v114, v19
    v_mov_b32 v92, v28
    v_mov_b32 v93, 0
    s_waitcnt vmcnt(6)
    s_barrier
    ds_read_b128 v[32:35], v6 offset:9216
    ds_read_b128 v[36:39], v6 offset:10240
    ds_read_b128 v[40:43], v6 offset:14336
    ds_read_b128 v[44:47], v6 offset:15360
    ds_read_b128 v[48:51], v6 offset:19456
    ds_read_b128 v[52:55], v6 offset:20480
    ds_read_b128 v[56:59], v6 offset:24576
    ds_read_b128 v[60:63], v6 offset:25600
    buffer_load_dwordx2 v[20:21], v11, s[4:7], s38 offen sc1
    buffer_load_dwordx2 v[22:23], v11, s[4:7], s38 offen offset:512 sc1
    s_waitcnt vmcnt(4)
    v_mfma_f32_16x16x16_bf16 v[80:83], v[108:109], v[16:17], v[100:103]
    v_and_b32 v3, 1, v108
    v_cmp_ne_u32 vcc, s41, v3
    s_nop 5
    v_cvt_pk_bf16_f32 v64, v80, v81
    v_cvt_pk_bf16_f32 v65, v82, v83
    s_cbranch_vccnz mega_kernel_rf_w0_xslow
    s_waitcnt vmcnt(3)
    v_mfma_f32_16x16x16_bf16 v[84:87], v[110:111], v[16:17], v[104:107]
    v_and_b32 v3, 1, v110
    v_cmp_ne_u32 vcc, s41, v3
    s_nop 5
    v_cvt_pk_bf16_f32 v66, v84, v85
    v_cvt_pk_bf16_f32 v67, v86, v87
    ds_write_b128 v6, v[64:67] offset:8192
    s_cbranch_vccnz mega_kernel_rf_w0_xslow
mega_kernel_rf_w0_xok:
    s_cmp_eq_u32 s21, 63
    s_cbranch_scc1 mega_kernel_rf_w0_last
    buffer_load_dwordx2 v[116:117], v11, s[4:7], s40 offen sc1
    s_waitcnt lgkmcnt(1)
    v_mfma_f32_16x16x32_bf16 v[80:83], v[32:35], v[64:67], 0
    s_waitcnt lgkmcnt(0)
    s_barrier
    ds_read_b128 v[68:71], v6 offset:13312
    ds_read_b128 v[72:75], v6 offset:18432
    ds_read_b128 v[76:79], v6 offset:23552
    v_mfma_f32_16x16x32_bf16 v[84:87], v[36:39], v[64:67], 0
    v_mfma_f32_16x16x32_bf16 v[88:91], v[64:67], v[64:67], 0
    buffer_load_dwordx2 v[20:21], v11, s[4:7], s40 offen sc1
    s_waitcnt lgkmcnt(2)
    v_mfma_f32_16x16x32_bf16 v[80:83], v[40:43], v[68:71], v[80:83]
    buffer_store_dwordx4 v[64:67], v10, s[4:7], s45 offen offset:0 sc1
    s_waitcnt lgkmcnt(1)
    v_mfma_f32_16x16x32_bf16 v[80:83], v[48:51], v[72:75], v[80:83]
    s_waitcnt lgkmcnt(0)
    v_mfma_f32_16x16x32_bf16 v[80:83], v[56:59], v[76:79], v[80:83]
    v_mfma_f32_16x16x32_bf16 v[84:87], v[44:47], v[68:71], v[84:87]
    v_mfma_f32_16x16x32_bf16 v[84:87], v[52:55], v[72:75], v[84:87]
    buffer_store_dwordx2 v[18:19], v11, s[4:7], s51 offen offset:2048 sc1
    v_mfma_f32_16x16x32_bf16 v[84:87], v[60:63], v[76:79], v[84:87]
    v_mfma_f32_16x16x32_bf16 v[88:91], v[68:71], v[68:71], v[88:91]
    v_mfma_f32_16x16x32_bf16 v[88:91], v[72:75], v[72:75], v[88:91]
    v_mfma_f32_16x16x32_bf16 v[88:91], v[76:79], v[76:79], v[88:91]
    v_mfma_f32_32x32x4_2b_bf16 v[32:63], v[14:15], v[14:15], 0
    s_nop 0
    v_max3_f32 v4, v80, v81, v82
    s_nop 1
    v_max3_f32 v4, v4, v83, v84
    v_max3_f32 v4, v4, v85, v86
    v_max_f32 v4, v4, v87
    v_max3_f32 v90, v4, v88, v89
    v_max3_f32 v4, v4, v88, v89
    s_nop 1
    v_permlane16_swap_b32 v4, v90
    v_max_f32 v4, v4, v90
    v_max_f32 v90, v4, v90
    s_nop 1
    v_permlane32_swap_b32 v4, v90
    v_max_f32 v4, v4, v90
    v_mul_f32 v4, s34, v4
    v_pk_fma_f32 v[80:81], v[80:81], s[34:35], v[4:5] op_sel_hi:[1,0,0] neg_lo:[0,0,1] neg_hi:[0,0,1]
    v_pk_fma_f32 v[82:83], v[82:83], s[34:35], v[4:5] op_sel_hi:[1,0,0] neg_lo:[0,0,1] neg_hi:[0,0,1]
    v_pk_fma_f32 v[84:85], v[84:85], s[34:35], v[4:5] op_sel_hi:[1,0,0] neg_lo:[0,0,1] neg_hi:[0,0,1]
    v_pk_fma_f32 v[86:87], v[86:87], s[34:35], v[4:5] op_sel_hi:[1,0,0] neg_lo:[0,0,1] neg_hi:[0,0,1]
    v_pk_fma_f32 v[88:89], v[88:89], s[34:35], v[4:5] op_sel_hi:[1,0,0] neg_lo:[0,0,1] neg_hi:[0,0,1]
    v_exp_f32 v80, v80
    v_exp_f32 v81, v81
    v_exp_f32 v82, v82
    v_cvt_pk_bf16_f32 v68, v80, v81
    v_exp_f32 v83, v83
    v_exp_f32 v84, v84
    v_cvt_pk_bf16_f32 v69, v82, v83
    v_exp_f32 v85, v85
    v_exp_f32 v86, v86
    v_cvt_pk_bf16_f32 v70, v84, v85
    v_exp_f32 v87, v87
    v_exp_f32 v88, v88
    v_cvt_pk_bf16_f32 v71, v86, v87
    v_exp_f32 v89, v89
    s_waitcnt vmcnt(3)
    v_mfma_f32_16x16x32_bf16 v[76:79], v[28:31], v[68:71], 0
    v_and_b32 v3, 1, v116
    v_cvt_pk_bf16_f32 v72, v88, v89
    v_mfma_f32_16x16x32_bf16 v[100:103], v[120:123], v[68:71], 0
    v_cmp_ne_u32 vcc, s41, v3
    v_cvt_pk_bf16_f32 v73, v88, v89
    v_mfma_f32_16x16x32_bf16 v[104:107], v[124:127], v[68:71], 0
    v_mov_b32 v113, v116
    v_mov_b32 v115, v117
    v_mfma_f32_16x16x16_bf16 v[76:79], v[92:93], v[72:73], v[76:79]
    s_cbranch_vccnz mega_kernel_rf_w0_pv0
mega_kernel_rf_w0_pv2:
    v_mfma_f32_16x16x16_bf16 v[100:103], v[112:113], v[72:73], v[100:103]
    v_mfma_f32_16x16x16_bf16 v[104:107], v[114:115], v[72:73], v[104:107]
    buffer_load_dwordx4 v[120:123], v1, s[4:7], s44 offen
    buffer_load_dwordx4 v[124:127], v1, s[4:7], s44 offen offset:1024
    s_nop 2
    v_rcp_f32 v76, v76
    s_mov_b64 exec, s[28:29]
    v_pk_mul_f32 v[100:101], v[100:101], v[76:77] op_sel_hi:[1,0]
    v_pk_mul_f32 v[102:103], v[102:103], v[76:77] op_sel_hi:[1,0]
    v_pk_mul_f32 v[104:105], v[104:105], v[76:77] op_sel_hi:[1,0]
    v_pk_mul_f32 v[106:107], v[106:107], v[76:77] op_sel_hi:[1,0]
    v_cvt_pk_bf16_f32 v84, v100, v101
    v_cvt_pk_bf16_f32 v85, v102, v103
    v_cvt_pk_bf16_f32 v86, v104, v105
    v_cvt_pk_bf16_f32 v87, v106, v107
    ds_write_b128 v6, v[84:87] offset:28640
    s_mov_b64 exec, -1
    s_waitcnt lgkmcnt(0)
    s_barrier
    ds_read_b128 v[68:71], v6 offset:28672
    ds_read_b128 v[72:75], v6 offset:29696
    s_waitcnt lgkmcnt(1)
    v_smfmac_f32_16x16x64_bf16 v[32:35], v[68:71], v[128:135], v2
    s_add_u32 s21, s21, 1
    s_xor_b32 s38, s38, 1048576
    s_xor_b32 s37, s37, 1048576
    s_waitcnt lgkmcnt(0)
    v_smfmac_f32_16x16x64_bf16 v[32:35], v[72:75], v[136:143], v2
    s_xor_b32 s40, s40, 1048576
    s_xor_b32 s39, s39, 1048576
    s_lshr_b32 s41, s21, 1
    v_smfmac_f32_16x16x64_bf16 v[36:39], v[68:71], v[144:151], v2
    s_and_b32 s41, s41, 1
    s_xor_b32 s41, s41, 1
    s_xor_b32 s35, s35, 16384
    v_smfmac_f32_16x16x64_bf16 v[36:39], v[72:75], v[152:159], v2
    v_add_f32 v32, v32, v34
    s_xor_b32 s36, s36, 16384
    s_add_u32 s43, s43, 262144
    s_add_u32 s44, s44, 262144
    v_smfmac_f32_16x16x64_bf16 v[40:43], v[68:71], v[160:167], v2
    v_add_f32 v33, v33, v35
    v_smfmac_f32_16x16x64_bf16 v[40:43], v[72:75], v[168:175], v2
    v_cvt_pk_bf16_f32 v32, v32, v33
    v_smfmac_f32_16x16x64_bf16 v[44:47], v[68:71], v[176:183], v2
    v_and_or_b32 v32, v32, -2, s42
    v_smfmac_f32_16x16x64_bf16 v[44:47], v[72:75], v[184:191], v2
    v_add_f32 v36, v36, v38
    v_smfmac_f32_16x16x64_bf16 v[48:51], v[68:71], v[192:199], v2
    v_add_f32 v37, v37, v39
    v_smfmac_f32_16x16x64_bf16 v[48:51], v[72:75], v[200:207], v2
    v_cvt_pk_bf16_f32 v33, v36, v37
    v_smfmac_f32_16x16x64_bf16 v[52:55], v[68:71], v[208:215], v2
    v_add_f32 v40, v40, v42
    v_smfmac_f32_16x16x64_bf16 v[52:55], v[72:75], v[216:223], v2
    v_add_f32 v41, v41, v43
    v_smfmac_f32_16x16x64_bf16 v[56:59], v[68:71], v[224:231], v2
    v_cvt_pk_bf16_f32 v34, v40, v41
    v_smfmac_f32_16x16x64_bf16 v[56:59], v[72:75], v[232:239], v2
    v_add_f32 v44, v44, v46
    v_smfmac_f32_16x16x64_bf16 v[60:63], v[68:71], v[240:247], v2
    v_add_f32 v45, v45, v47
    v_smfmac_f32_16x16x64_bf16 v[60:63], v[72:75], v[248:255], v2
    v_cvt_pk_bf16_f32 v35, v44, v45
    buffer_store_dwordx4 v[32:35], v8, s[4:7], s46 offen
    v_pk_add_f32 v[48:49], v[48:49], v[50:51]
    v_cvt_pk_bf16_f32 v48, v48, v49
    v_and_or_b32 v48, v48, -2, s42
    v_pk_add_f32 v[52:53], v[52:53], v[54:55]
    v_cvt_pk_bf16_f32 v49, v52, v53
    v_pk_add_f32 v[56:57], v[56:57], v[58:59]
    v_cvt_pk_bf16_f32 v50, v56, v57
    v_pk_add_f32 v[60:61], v[60:61], v[62:63]
    v_cvt_pk_bf16_f32 v51, v60, v61
    buffer_store_dwordx4 v[48:51], v8, s[4:7], s61 offen
    s_add_u32 s45, s45, 262144
    s_add_u32 s51, s51, 262144
    v_mfma_f32_32x32x8_bf16 v[96:111], v[14:15], v[14:15], 0
    v_mfma_f32_16x16x16_bf16 v[112:115], v[14:15], v[14:15], 0
    v_mfma_f32_16x16x16_bf16 v[116:119], v[14:15], v[14:15], 0
    ds_read_b128 v[64:67], v1 offset:0
    ds_read_b128 v[68:71], v1 offset:1024
    ds_read_b128 v[72:75], v1 offset:2048
    ds_read_b128 v[76:79], v1 offset:3072
    ds_read_b128 v[80:83], v1 offset:16384
    ds_read_b128 v[84:87], v1 offset:17408
    ds_read_b128 v[88:91], v1 offset:18432
    ds_read_b128 v[92:95], v1 offset:19456
    v_mov_b32 v58, -1
    v_mov_b32 v59, -1
    s_waitcnt vmcnt(0)
mega_kernel_rf_w0_pc:
    buffer_load_dword v36, v13, s[4:7], s25 offen offset:0 sc1
    buffer_load_dword v37, v13, s[4:7], s25 offen offset:256 sc1
    buffer_load_dword v38, v13, s[4:7], s25 offen offset:512 sc1
    buffer_load_dword v39, v13, s[4:7], s25 offen offset:768 sc1
    buffer_load_dword v40, v13, s[4:7], s25 offen offset:1024 sc1
    buffer_load_dword v41, v13, s[4:7], s25 offen offset:1280 sc1
    buffer_load_dword v42, v13, s[4:7], s25 offen offset:1536 sc1
    buffer_load_dword v43, v13, s[4:7], s25 offen offset:1792 sc1
    s_waitcnt vmcnt(4)
    v_mfma_f32_16x16x32_bf16 v[52:55], v[36:39], v[24:27], 0
    v_bitop3_b32 v3, s42, v36, v37 bitop3:0x7e
    v_bitop3_b32 v4, s42, v38, v39 bitop3:0x7e
    s_waitcnt vmcnt(2)
    v_or_b32 v3, v3, v4
    v_bitop3_b32 v4, s42, v40, v41 bitop3:0x7e
    s_waitcnt vmcnt(0)
    v_mfma_f32_16x16x32_bf16 v[52:55], v[40:43], v[24:27], v[52:55]
    v_bitop3_b32 v56, s42, v42, v43 bitop3:0x7e
    v_or3_b32 v3, v3, v4, v56
    v_and_b32 v3, v0, v3
    v_cmp_ne_u32 vcc, 0, v3
    s_nop 3
    v_cvt_pk_bf16_f32 v56, v52, v53
    v_cvt_pk_bf16_f32 v57, v54, v55
    v_min_u32 v56, -2, v56
    s_cbranch_vccnz mega_kernel_rf_w0_pc
    s_mov_b64 exec, s[26:27]
    buffer_store_dwordx2 v[56:57], v9, s[4:7], s35 offen offset:0
    buffer_store_dwordx2 v[58:59], v9, s[4:7], s36 offen offset:0
    s_mov_b64 exec, -1
    s_xor_b32 s42, s42, 1
    s_branch mega_kernel_rf_w0_loop
mega_kernel_rf_w0_last:
    buffer_store_dwordx4 v[64:67], v10, s[4:7], s45 offen offset:0 sc1
    buffer_store_dwordx2 v[18:19], v11, s[4:7], s51 offen offset:2048 sc1
    s_branch mega_kernel_rf_end
mega_kernel_rf_w0_pafail:
    s_nop 7
    v_mov_b32 v96, 0
    v_mov_b32 v97, 0
    v_mov_b32 v98, 0
    v_mov_b32 v99, 0
    v_mov_b32 v100, 0
    v_mov_b32 v101, 0
    v_mov_b32 v102, 0
    v_mov_b32 v103, 0
    v_mov_b32 v104, 0
    v_mov_b32 v105, 0
    v_mov_b32 v106, 0
    v_mov_b32 v107, 0
    s_branch mega_kernel_rf_w0_pa
mega_kernel_rf_w0_xslow:
    buffer_load_dwordx2 v[108:109], v11, s[4:7], s38 offen sc1
    buffer_load_dwordx2 v[110:111], v11, s[4:7], s38 offen offset:512 sc1
    s_waitcnt vmcnt(2)
    v_bitop3_b32 v3, s41, v20, v22 bitop3:0x7e
    v_mfma_f32_16x16x16_bf16 v[80:83], v[20:21], v[16:17], v[100:103]
    v_and_b32 v3, 1, v3
    v_mfma_f32_16x16x16_bf16 v[84:87], v[22:23], v[16:17], v[104:107]
    v_cmp_ne_u32 vcc, 0, v3
    s_cbranch_vccz mega_kernel_rf_w0_xgot
    buffer_load_dwordx2 v[20:21], v11, s[4:7], s38 offen sc1
    buffer_load_dwordx2 v[22:23], v11, s[4:7], s38 offen offset:512 sc1
    s_waitcnt vmcnt(2)
    v_bitop3_b32 v3, s41, v108, v110 bitop3:0x7e
    v_mfma_f32_16x16x16_bf16 v[80:83], v[108:109], v[16:17], v[100:103]
    v_and_b32 v3, 1, v3
    v_mfma_f32_16x16x16_bf16 v[84:87], v[110:111], v[16:17], v[104:107]
    v_cmp_ne_u32 vcc, 0, v3
    s_cbranch_vccz mega_kernel_rf_w0_xgot
    s_branch mega_kernel_rf_w0_xslow
mega_kernel_rf_w0_xgot:
    s_nop 3
    v_cvt_pk_bf16_f32 v64, v80, v81
    v_cvt_pk_bf16_f32 v65, v82, v83
    v_cvt_pk_bf16_f32 v66, v84, v85
    v_cvt_pk_bf16_f32 v67, v86, v87
    ds_write_b128 v6, v[64:67] offset:8192
    s_branch mega_kernel_rf_w0_xok
mega_kernel_rf_w0_pv0:
    s_waitcnt vmcnt(2)
    s_branch mega_kernel_rf_w0_pv1
mega_kernel_rf_w0_pv:
    buffer_load_dwordx2 v[20:21], v11, s[4:7], s40 offen sc1
    s_waitcnt vmcnt(0)
mega_kernel_rf_w0_pv1:
    v_and_b32 v3, 1, v20
    v_cmp_ne_u32 vcc, s41, v3
    v_mov_b32 v113, v20
    v_mov_b32 v115, v21
    s_cbranch_vccnz mega_kernel_rf_w0_pv
    s_branch mega_kernel_rf_w0_pv2
mega_kernel_rf_w1_entry:
    v_mfma_f32_32x32x8_bf16 v[96:111], v[14:15], v[14:15], 0
    v_mfma_f32_16x16x16_bf16 v[112:115], v[14:15], v[14:15], 0
    v_mfma_f32_16x16x16_bf16 v[116:119], v[14:15], v[14:15], 0
    ds_read_b128 v[64:67], v1 offset:4096
    ds_read_b128 v[68:71], v1 offset:5120
    ds_read_b128 v[72:75], v1 offset:6144
    ds_read_b128 v[76:79], v1 offset:7168
    ds_read_b128 v[80:83], v1 offset:20480
    ds_read_b128 v[84:87], v1 offset:21504
    ds_read_b128 v[88:91], v1 offset:22528
    ds_read_b128 v[92:95], v1 offset:23552
    buffer_load_dwordx4 v[120:123], v1, s[4:7], s44 offen
    buffer_load_dwordx4 v[124:127], v1, s[4:7], s44 offen offset:1024
    s_add_u32 s44, s44, 262144
mega_kernel_rf_w1_loop:
    s_add_u32 s22, s35, 2048
    s_waitcnt vmcnt(0)
    buffer_load_dwordx4 v[40:43], v1, s[4:7], s22 offen sc1
    buffer_load_dwordx4 v[44:47], v1, s[4:7], s22 offen offset:1024 sc1
mega_kernel_rf_w1_pa:
    s_waitcnt vmcnt(1)
    ds_write_b128 v6, v[40:43] offset:2048
    s_waitcnt vmcnt(0)
    ds_write_b128 v6, v[44:47] offset:3072
    v_max3_u32 v3, v40, v42, v44
    v_max_u32 v3, v3, v46
    v_cmp_eq_u32 vcc, -1, v3
    v_smfmac_f32_16x16x64_bf16 v[96:99], v[40:43], a[32:39], v2
    buffer_load_dwordx4 v[40:43], v1, s[4:7], s22 offen sc1
    v_smfmac_f32_16x16x64_bf16 v[100:103], v[40:43], a[40:47], v2
    buffer_load_dwordx4 v[44:47], v1, s[4:7], s22 offen offset:1024 sc1
    v_smfmac_f32_16x16x64_bf16 v[104:107], v[40:43], a[160:167], v2
    s_cbranch_vccnz mega_kernel_rf_w1_pafail
    s_waitcnt lgkmcnt(0)
    s_barrier
    ds_read_b128 v[48:51], v6 offset:4096
    ds_read_b128 v[52:55], v6 offset:5120
    v_smfmac_f32_16x16x64_bf16 v[108:111], v[40:43], a[168:175], v2
    ds_read_b128 v[56:59], v6 offset:6144
    v_smfmac_f32_16x16x64_bf16 v[96:99], v[44:47], a[48:55], v2
    ds_read_b128 v[60:63], v6 offset:7168
    v_smfmac_f32_16x16x64_bf16 v[100:103], v[44:47], a[56:63], v2
    ds_read_b128 v[32:35], v6 offset:0
    v_smfmac_f32_16x16x64_bf16 v[104:107], v[44:47], a[176:183], v2
    ds_read_b128 v[36:39], v6 offset:1024
    v_smfmac_f32_16x16x64_bf16 v[108:111], v[44:47], a[184:191], v2
    s_waitcnt lgkmcnt(5)
    v_smfmac_f32_16x16x64_bf16 v[96:99], v[48:51], a[64:71], v2
    buffer_load_dwordx4 v1, s[4:7], s43 offen lds
    v_smfmac_f32_16x16x64_bf16 v[104:107], v[48:51], a[192:199], v2
    s_waitcnt lgkmcnt(4)
    v_smfmac_f32_16x16x64_bf16 v[96:99], v[52:55], a[80:87], v2
    v_smfmac_f32_16x16x64_bf16 v[104:107], v[52:55], a[208:215], v2
    s_waitcnt lgkmcnt(3)
    v_smfmac_f32_16x16x64_bf16 v[96:99], v[56:59], a[96:103], v2
    buffer_load_dwordx4 v1, s[4:7], s43 offen offset:1024 lds
    v_smfmac_f32_16x16x64_bf16 v[104:107], v[56:59], a[224:231], v2
    s_waitcnt lgkmcnt(2)
    v_smfmac_f32_16x16x64_bf16 v[96:99], v[60:63], a[112:119], v2
    v_smfmac_f32_16x16x64_bf16 v[104:107], v[60:63], a[240:247], v2
    s_waitcnt lgkmcnt(1)
    v_smfmac_f32_16x16x64_bf16 v[96:99], v[32:35], a[0:7], v2
    v_smfmac_f32_16x16x64_bf16 v[104:107], v[32:35], a[128:135], v2
    s_waitcnt lgkmcnt(0)
    v_smfmac_f32_16x16x64_bf16 v[96:99], v[36:39], a[16:23], v2
    v_smfmac_f32_16x16x64_bf16 v[104:107], v[36:39], a[144:151], v2
    v_smfmac_f32_16x16x64_bf16 v[100:103], v[48:51], a[72:79], v2
    s_nop 2
    v_smfmac_f32_16x16x64_bf16 v[100:103], v[52:55], a[88:95], v2
    s_nop 1
    v_add_f32 v96, v96, v98
    v_smfmac_f32_16x16x64_bf16 v[100:103], v[56:59], a[104:111], v2
    v_add_f32 v97, v97, v99
    v_add_f32 v104, v104, v106
    v_smfmac_f32_16x16x64_bf16 v[100:103], v[60:63], a[120:127], v2
    v_add_f32 v105, v105, v107
    v_cvt_pk_bf16_f32 v96, v96, v97
    v_smfmac_f32_16x16x64_bf16 v[100:103], v[32:35], a[8:15], v2
    v_cvt_pk_bf16_f32 v97, v104, v105
    v_and_or_b32 v96, v96, -2, s41
    v_smfmac_f32_16x16x64_bf16 v[100:103], v[36:39], a[24:31], v2
    buffer_store_dwordx2 v[96:97], v11, s[4:7], s37 offen sc1
    v_smfmac_f32_16x16x64_bf16 v[108:111], v[48:51], a[200:207], v2
    v_smfmac_f32_16x16x64_bf16 v[108:111], v[52:55], a[216:223], v2
    v_smfmac_f32_16x16x64_bf16 v[108:111], v[56:59], a[232:239], v2
    v_smfmac_f32_16x16x64_bf16 v[108:111], v[60:63], a[248:255], v2
    v_smfmac_f32_16x16x64_bf16 v[108:111], v[32:35], a[136:143], v2
    s_nop 2
    v_add_f32 v100, v100, v102
    v_smfmac_f32_16x16x64_bf16 v[108:111], v[36:39], a[152:159], v2
    v_add_f32 v101, v101, v103
    v_cvt_pk_bf16_f32 v98, v100, v101
    v_and_or_b32 v98, v98, -2, s41
    s_nop 4
    v_pk_add_f32 v[108:109], v[108:109], v[110:111]
    v_cvt_pk_bf16_f32 v99, v108, v109
    buffer_store_dwordx2 v[98:99], v11, s[4:7], s37 offen offset:512 sc1
    v_smfmac_f32_16x16x64_bf16 v[112:115], v[32:35], v[64:71], v2
    ds_read_b128 v[64:67], v1 offset:36864
    ds_read_b128 v[68:71], v1 offset:37888
    v_smfmac_f32_16x16x64_bf16 v[116:119], v[32:35], v[72:79], v2
    ds_read_b128 v[72:75], v1 offset:38912
    ds_read_b128 v[76:79], v1 offset:39936
    v_smfmac_f32_16x16x64_bf16 v[112:115], v[36:39], v[80:87], v2
    ds_read_b128 v[80:83], v1 offset:53248
    ds_read_b128 v[84:87], v1 offset:54272
    v_smfmac_f32_16x16x64_bf16 v[116:119], v[36:39], v[88:95], v2
    ds_read_b128 v[88:91], v1 offset:55296
    ds_read_b128 v[92:95], v1 offset:56320
    s_waitcnt lgkmcnt(6)
    v_smfmac_f32_16x16x64_bf16 v[112:115], v[40:43], v[64:71], v2
    ds_read_b128 v[64:67], v5 offset:4096
    ds_read_b128 v[68:71], v5 offset:5120
    s_waitcnt lgkmcnt(6)
    v_smfmac_f32_16x16x64_bf16 v[116:119], v[40:43], v[72:79], v2
    ds_read_b128 v[72:75], v5 offset:6144
    ds_read_b128 v[76:79], v5 offset:7168
    s_waitcnt lgkmcnt(6)
    v_smfmac_f32_16x16x64_bf16 v[112:115], v[44:47], v[80:87], v2
    ds_read_b128 v[80:83], v5 offset:20480
    ds_read_b128 v[84:87], v5 offset:21504
    s_waitcnt lgkmcnt(6)
    v_smfmac_f32_16x16x64_bf16 v[116:119], v[44:47], v[88:95], v2
    ds_read_b128 v[88:91], v5 offset:22528
    ds_read_b128 v[92:95], v5 offset:23552
    s_waitcnt lgkmcnt(6)
    v_smfmac_f32_16x16x64_bf16 v[112:115], v[48:51], v[64:71], v2
    ds_read_b128 v[64:67], v5 offset:36864
    ds_read_b128 v[68:71], v5 offset:37888
    s_waitcnt lgkmcnt(6)
    v_smfmac_f32_16x16x64_bf16 v[116:119], v[48:51], v[72:79], v2
    ds_read_b128 v[72:75], v5 offset:38912
    ds_read_b128 v[76:79], v5 offset:39936
    s_waitcnt lgkmcnt(6)
    v_smfmac_f32_16x16x64_bf16 v[112:115], v[52:55], v[80:87], v2
    ds_read_b128 v[80:83], v5 offset:53248
    ds_read_b128 v[84:87], v5 offset:54272
    s_waitcnt lgkmcnt(6)
    v_smfmac_f32_16x16x64_bf16 v[116:119], v[52:55], v[88:95], v2
    ds_read_b128 v[88:91], v5 offset:55296
    ds_read_b128 v[92:95], v5 offset:56320
    s_waitcnt lgkmcnt(6)
    v_smfmac_f32_16x16x64_bf16 v[112:115], v[56:59], v[64:71], v2
    s_waitcnt lgkmcnt(4)
    v_smfmac_f32_16x16x64_bf16 v[116:119], v[56:59], v[72:79], v2
    s_waitcnt lgkmcnt(2)
    v_smfmac_f32_16x16x64_bf16 v[112:115], v[60:63], v[80:87], v2
    s_waitcnt lgkmcnt(0)
    v_smfmac_f32_16x16x64_bf16 v[116:119], v[60:63], v[88:95], v2
    buffer_load_dwordx2 v[108:109], v11, s[4:7], s38 offen sc1
    v_mfma_f32_16x16x16_bf16 v[100:103], v[96:97], v[16:17], 0
    v_mfma_f32_16x16x16_bf16 v[104:107], v[98:99], v[16:17], 0
    s_nop 4
    v_add_f32 v112, v112, v114
    v_add_f32 v113, v113, v115
    v_add_f32 v114, v116, v118
    v_add_f32 v115, v117, v119
    v_cvt_pk_bf16_f32 v18, v112, v113
    v_cvt_pk_bf16_f32 v19, v114, v115
    v_and_or_b32 v18, v18, -2, s41
    buffer_load_dwordx2 v[110:111], v11, s[4:7], s38 offen offset:512 sc1
    s_barrier
    buffer_store_dwordx2 v[18:19], v11, s[4:7], s39 offen sc1
    v_mov_b32 v112, v18
    v_mov_b32 v114, v19
    v_mov_b32 v92, v28
    v_mov_b32 v93, 0
    s_waitcnt vmcnt(5)
    s_barrier
    ds_read_b128 v[32:35], v6 offset:14336
    ds_read_b128 v[36:39], v6 offset:15360
    ds_read_b128 v[40:43], v6 offset:9216
    ds_read_b128 v[44:47], v6 offset:10240
    ds_read_b128 v[48:51], v6 offset:24576
    ds_read_b128 v[52:55], v6 offset:25600
    ds_read_b128 v[56:59], v6 offset:19456
    ds_read_b128 v[60:63], v6 offset:20480
    buffer_load_dwordx2 v[20:21], v11, s[4:7], s38 offen sc1
    buffer_load_dwordx2 v[22:23], v11, s[4:7], s38 offen offset:512 sc1
    s_waitcnt vmcnt(4)
    v_mfma_f32_16x16x16_bf16 v[80:83], v[108:109], v[16:17], v[100:103]
    v_and_b32 v3, 1, v108
    v_cmp_ne_u32 vcc, s41, v3
    s_nop 5
    v_cvt_pk_bf16_f32 v64, v80, v81
    v_cvt_pk_bf16_f32 v65, v82, v83
    s_cbranch_vccnz mega_kernel_rf_w1_xslow
    s_waitcnt vmcnt(3)
    v_mfma_f32_16x16x16_bf16 v[84:87], v[110:111], v[16:17], v[104:107]
    v_and_b32 v3, 1, v110
    v_cmp_ne_u32 vcc, s41, v3
    s_nop 5
    v_cvt_pk_bf16_f32 v66, v84, v85
    v_cvt_pk_bf16_f32 v67, v86, v87
    ds_write_b128 v6, v[64:67] offset:13312
    s_cbranch_vccnz mega_kernel_rf_w1_xslow
mega_kernel_rf_w1_xok:
    s_cmp_eq_u32 s21, 63
    s_cbranch_scc1 mega_kernel_rf_w1_last
    buffer_load_dwordx2 v[116:117], v11, s[4:7], s40 offen sc1
    s_waitcnt lgkmcnt(1)
    v_mfma_f32_16x16x32_bf16 v[80:83], v[32:35], v[64:67], 0
    s_waitcnt lgkmcnt(0)
    s_barrier
    ds_read_b128 v[68:71], v6 offset:8192
    ds_read_b128 v[72:75], v6 offset:23552
    ds_read_b128 v[76:79], v6 offset:18432
    v_mfma_f32_16x16x32_bf16 v[84:87], v[36:39], v[64:67], 0
    v_mfma_f32_16x16x32_bf16 v[88:91], v[64:67], v[64:67], 0
    buffer_load_dwordx2 v[20:21], v11, s[4:7], s40 offen sc1
    s_waitcnt lgkmcnt(2)
    v_mfma_f32_16x16x32_bf16 v[80:83], v[40:43], v[68:71], v[80:83]
    s_waitcnt lgkmcnt(1)
    v_mfma_f32_16x16x32_bf16 v[80:83], v[48:51], v[72:75], v[80:83]
    buffer_store_dwordx4 v[64:67], v10, s[4:7], s45 offen offset:64 sc1
    s_waitcnt lgkmcnt(0)
    v_mfma_f32_16x16x32_bf16 v[80:83], v[56:59], v[76:79], v[80:83]
    v_mfma_f32_16x16x32_bf16 v[84:87], v[44:47], v[68:71], v[84:87]
    v_mfma_f32_16x16x32_bf16 v[84:87], v[52:55], v[72:75], v[84:87]
    v_mfma_f32_16x16x32_bf16 v[84:87], v[60:63], v[76:79], v[84:87]
    buffer_store_dwordx2 v[18:19], v11, s[4:7], s51 offen offset:2560 sc1
    v_mfma_f32_16x16x32_bf16 v[88:91], v[68:71], v[68:71], v[88:91]
    v_mfma_f32_16x16x32_bf16 v[88:91], v[72:75], v[72:75], v[88:91]
    v_mfma_f32_16x16x32_bf16 v[88:91], v[76:79], v[76:79], v[88:91]
    v_mfma_f32_32x32x4_2b_bf16 v[32:63], v[14:15], v[14:15], 0
    s_nop 0
    v_max3_f32 v4, v80, v81, v82
    s_nop 1
    v_max3_f32 v4, v4, v83, v84
    v_max3_f32 v4, v4, v85, v86
    v_max_f32 v4, v4, v87
    v_max3_f32 v90, v4, v88, v89
    v_max3_f32 v4, v4, v88, v89
    s_nop 1
    v_permlane16_swap_b32 v4, v90
    v_max_f32 v4, v4, v90
    v_max_f32 v90, v4, v90
    s_nop 1
    v_permlane32_swap_b32 v4, v90
    v_max_f32 v4, v4, v90
    v_mul_f32 v4, s34, v4
    v_pk_fma_f32 v[80:81], v[80:81], s[34:35], v[4:5] op_sel_hi:[1,0,0] neg_lo:[0,0,1] neg_hi:[0,0,1]
    v_pk_fma_f32 v[82:83], v[82:83], s[34:35], v[4:5] op_sel_hi:[1,0,0] neg_lo:[0,0,1] neg_hi:[0,0,1]
    v_pk_fma_f32 v[84:85], v[84:85], s[34:35], v[4:5] op_sel_hi:[1,0,0] neg_lo:[0,0,1] neg_hi:[0,0,1]
    v_pk_fma_f32 v[86:87], v[86:87], s[34:35], v[4:5] op_sel_hi:[1,0,0] neg_lo:[0,0,1] neg_hi:[0,0,1]
    v_pk_fma_f32 v[88:89], v[88:89], s[34:35], v[4:5] op_sel_hi:[1,0,0] neg_lo:[0,0,1] neg_hi:[0,0,1]
    v_exp_f32 v80, v80
    v_exp_f32 v81, v81
    v_exp_f32 v82, v82
    v_cvt_pk_bf16_f32 v68, v80, v81
    v_exp_f32 v83, v83
    v_exp_f32 v84, v84
    v_cvt_pk_bf16_f32 v69, v82, v83
    v_exp_f32 v85, v85
    v_exp_f32 v86, v86
    v_cvt_pk_bf16_f32 v70, v84, v85
    v_exp_f32 v87, v87
    v_exp_f32 v88, v88
    v_cvt_pk_bf16_f32 v71, v86, v87
    v_exp_f32 v89, v89
    s_waitcnt vmcnt(3)
    v_mfma_f32_16x16x32_bf16 v[76:79], v[28:31], v[68:71], 0
    v_and_b32 v3, 1, v116
    v_cvt_pk_bf16_f32 v72, v88, v89
    v_mfma_f32_16x16x32_bf16 v[100:103], v[120:123], v[68:71], 0
    v_cmp_ne_u32 vcc, s41, v3
    v_cvt_pk_bf16_f32 v73, v88, v89
    v_mfma_f32_16x16x32_bf16 v[104:107], v[124:127], v[68:71], 0
    v_mov_b32 v113, v116
    v_mov_b32 v115, v117
    v_mfma_f32_16x16x16_bf16 v[76:79], v[92:93], v[72:73], v[76:79]
    s_cbranch_vccnz mega_kernel_rf_w1_pv0
mega_kernel_rf_w1_pv2:
    v_mfma_f32_16x16x16_bf16 v[100:103], v[112:113], v[72:73], v[100:103]
    v_mfma_f32_16x16x16_bf16 v[104:107], v[114:115], v[72:73], v[104:107]
    buffer_load_dwordx4 v[120:123], v1, s[4:7], s44 offen
    buffer_load_dwordx4 v[124:127], v1, s[4:7], s44 offen offset:1024
    s_nop 2
    v_rcp_f32 v76, v76
    s_mov_b64 exec, s[28:29]
    v_pk_mul_f32 v[100:101], v[100:101], v[76:77] op_sel_hi:[1,0]
    v_pk_mul_f32 v[102:103], v[102:103], v[76:77] op_sel_hi:[1,0]
    v_pk_mul_f32 v[104:105], v[104:105], v[76:77] op_sel_hi:[1,0]
    v_pk_mul_f32 v[106:107], v[106:107], v[76:77] op_sel_hi:[1,0]
    v_cvt_pk_bf16_f32 v84, v100, v101
    v_cvt_pk_bf16_f32 v85, v102, v103
    v_cvt_pk_bf16_f32 v86, v104, v105
    v_cvt_pk_bf16_f32 v87, v106, v107
    ds_write_b128 v6, v[84:87] offset:28672
    s_mov_b64 exec, -1
    s_waitcnt lgkmcnt(0)
    s_barrier
    ds_read_b128 v[68:71], v6 offset:28672
    ds_read_b128 v[72:75], v6 offset:29696
    s_waitcnt lgkmcnt(1)
    v_smfmac_f32_16x16x64_bf16 v[32:35], v[68:71], v[128:135], v2
    s_add_u32 s21, s21, 1
    s_xor_b32 s38, s38, 1048576
    s_xor_b32 s37, s37, 1048576
    s_waitcnt lgkmcnt(0)
    v_smfmac_f32_16x16x64_bf16 v[32:35], v[72:75], v[136:143], v2
    s_xor_b32 s40, s40, 1048576
    s_xor_b32 s39, s39, 1048576
    s_lshr_b32 s41, s21, 1
    v_smfmac_f32_16x16x64_bf16 v[36:39], v[68:71], v[144:151], v2
    s_and_b32 s41, s41, 1
    s_xor_b32 s41, s41, 1
    s_xor_b32 s35, s35, 16384
    v_smfmac_f32_16x16x64_bf16 v[36:39], v[72:75], v[152:159], v2
    v_add_f32 v32, v32, v34
    s_xor_b32 s36, s36, 16384
    s_add_u32 s43, s43, 262144
    s_add_u32 s44, s44, 262144
    v_smfmac_f32_16x16x64_bf16 v[40:43], v[68:71], v[160:167], v2
    v_add_f32 v33, v33, v35
    v_smfmac_f32_16x16x64_bf16 v[40:43], v[72:75], v[168:175], v2
    v_cvt_pk_bf16_f32 v32, v32, v33
    v_smfmac_f32_16x16x64_bf16 v[44:47], v[68:71], v[176:183], v2
    v_and_or_b32 v32, v32, -2, s42
    v_smfmac_f32_16x16x64_bf16 v[44:47], v[72:75], v[184:191], v2
    v_add_f32 v36, v36, v38
    v_smfmac_f32_16x16x64_bf16 v[48:51], v[68:71], v[192:199], v2
    v_add_f32 v37, v37, v39
    v_smfmac_f32_16x16x64_bf16 v[48:51], v[72:75], v[200:207], v2
    v_cvt_pk_bf16_f32 v33, v36, v37
    v_smfmac_f32_16x16x64_bf16 v[52:55], v[68:71], v[208:215], v2
    v_add_f32 v40, v40, v42
    v_smfmac_f32_16x16x64_bf16 v[52:55], v[72:75], v[216:223], v2
    v_add_f32 v41, v41, v43
    v_smfmac_f32_16x16x64_bf16 v[56:59], v[68:71], v[224:231], v2
    v_cvt_pk_bf16_f32 v34, v40, v41
    v_smfmac_f32_16x16x64_bf16 v[56:59], v[72:75], v[232:239], v2
    v_add_f32 v44, v44, v46
    v_smfmac_f32_16x16x64_bf16 v[60:63], v[68:71], v[240:247], v2
    v_add_f32 v45, v45, v47
    v_smfmac_f32_16x16x64_bf16 v[60:63], v[72:75], v[248:255], v2
    v_cvt_pk_bf16_f32 v35, v44, v45
    buffer_store_dwordx4 v[32:35], v8, s[4:7], s46 offen
    v_pk_add_f32 v[48:49], v[48:49], v[50:51]
    v_cvt_pk_bf16_f32 v48, v48, v49
    v_and_or_b32 v48, v48, -2, s42
    v_pk_add_f32 v[52:53], v[52:53], v[54:55]
    v_cvt_pk_bf16_f32 v49, v52, v53
    v_pk_add_f32 v[56:57], v[56:57], v[58:59]
    v_cvt_pk_bf16_f32 v50, v56, v57
    v_pk_add_f32 v[60:61], v[60:61], v[62:63]
    v_cvt_pk_bf16_f32 v51, v60, v61
    buffer_store_dwordx4 v[48:51], v8, s[4:7], s61 offen
    s_add_u32 s45, s45, 262144
    s_add_u32 s51, s51, 262144
    v_mfma_f32_32x32x8_bf16 v[96:111], v[14:15], v[14:15], 0
    v_mfma_f32_16x16x16_bf16 v[112:115], v[14:15], v[14:15], 0
    v_mfma_f32_16x16x16_bf16 v[116:119], v[14:15], v[14:15], 0
    ds_read_b128 v[64:67], v1 offset:4096
    ds_read_b128 v[68:71], v1 offset:5120
    ds_read_b128 v[72:75], v1 offset:6144
    ds_read_b128 v[76:79], v1 offset:7168
    ds_read_b128 v[80:83], v1 offset:20480
    ds_read_b128 v[84:87], v1 offset:21504
    ds_read_b128 v[88:91], v1 offset:22528
    ds_read_b128 v[92:95], v1 offset:23552
    v_mov_b32 v58, -1
    v_mov_b32 v59, -1
    s_waitcnt vmcnt(0)
mega_kernel_rf_w1_pc:
    buffer_load_dword v36, v13, s[4:7], s25 offen offset:0 sc1
    buffer_load_dword v37, v13, s[4:7], s25 offen offset:256 sc1
    buffer_load_dword v38, v13, s[4:7], s25 offen offset:512 sc1
    buffer_load_dword v39, v13, s[4:7], s25 offen offset:768 sc1
    buffer_load_dword v40, v13, s[4:7], s25 offen offset:1024 sc1
    buffer_load_dword v41, v13, s[4:7], s25 offen offset:1280 sc1
    buffer_load_dword v42, v13, s[4:7], s25 offen offset:1536 sc1
    buffer_load_dword v43, v13, s[4:7], s25 offen offset:1792 sc1
    s_waitcnt vmcnt(4)
    v_mfma_f32_16x16x32_bf16 v[52:55], v[36:39], v[24:27], 0
    v_bitop3_b32 v3, s42, v36, v37 bitop3:0x7e
    v_bitop3_b32 v4, s42, v38, v39 bitop3:0x7e
    s_waitcnt vmcnt(2)
    v_or_b32 v3, v3, v4
    v_bitop3_b32 v4, s42, v40, v41 bitop3:0x7e
    s_waitcnt vmcnt(0)
    v_mfma_f32_16x16x32_bf16 v[52:55], v[40:43], v[24:27], v[52:55]
    v_bitop3_b32 v56, s42, v42, v43 bitop3:0x7e
    v_or3_b32 v3, v3, v4, v56
    v_and_b32 v3, v0, v3
    v_cmp_ne_u32 vcc, 0, v3
    s_nop 3
    v_cvt_pk_bf16_f32 v56, v52, v53
    v_cvt_pk_bf16_f32 v57, v54, v55
    v_min_u32 v56, -2, v56
    s_cbranch_vccnz mega_kernel_rf_w1_pc
    s_mov_b64 exec, s[26:27]
    buffer_store_dwordx2 v[56:57], v9, s[4:7], s35 offen offset:256
    buffer_store_dwordx2 v[58:59], v9, s[4:7], s36 offen offset:256
    s_mov_b64 exec, -1
    s_xor_b32 s42, s42, 1
    s_branch mega_kernel_rf_w1_loop
mega_kernel_rf_w1_last:
    buffer_store_dwordx4 v[64:67], v10, s[4:7], s45 offen offset:64 sc1
    buffer_store_dwordx2 v[18:19], v11, s[4:7], s51 offen offset:2560 sc1
    s_branch mega_kernel_rf_end
mega_kernel_rf_w1_pafail:
    s_nop 7
    v_mov_b32 v96, 0
    v_mov_b32 v97, 0
    v_mov_b32 v98, 0
    v_mov_b32 v99, 0
    v_mov_b32 v100, 0
    v_mov_b32 v101, 0
    v_mov_b32 v102, 0
    v_mov_b32 v103, 0
    v_mov_b32 v104, 0
    v_mov_b32 v105, 0
    v_mov_b32 v106, 0
    v_mov_b32 v107, 0
    s_branch mega_kernel_rf_w1_pa
mega_kernel_rf_w1_xslow:
    buffer_load_dwordx2 v[108:109], v11, s[4:7], s38 offen sc1
    buffer_load_dwordx2 v[110:111], v11, s[4:7], s38 offen offset:512 sc1
    s_waitcnt vmcnt(2)
    v_bitop3_b32 v3, s41, v20, v22 bitop3:0x7e
    v_mfma_f32_16x16x16_bf16 v[80:83], v[20:21], v[16:17], v[100:103]
    v_and_b32 v3, 1, v3
    v_mfma_f32_16x16x16_bf16 v[84:87], v[22:23], v[16:17], v[104:107]
    v_cmp_ne_u32 vcc, 0, v3
    s_cbranch_vccz mega_kernel_rf_w1_xgot
    buffer_load_dwordx2 v[20:21], v11, s[4:7], s38 offen sc1
    buffer_load_dwordx2 v[22:23], v11, s[4:7], s38 offen offset:512 sc1
    s_waitcnt vmcnt(2)
    v_bitop3_b32 v3, s41, v108, v110 bitop3:0x7e
    v_mfma_f32_16x16x16_bf16 v[80:83], v[108:109], v[16:17], v[100:103]
    v_and_b32 v3, 1, v3
    v_mfma_f32_16x16x16_bf16 v[84:87], v[110:111], v[16:17], v[104:107]
    v_cmp_ne_u32 vcc, 0, v3
    s_cbranch_vccz mega_kernel_rf_w1_xgot
    s_branch mega_kernel_rf_w1_xslow
mega_kernel_rf_w1_xgot:
    s_nop 3
    v_cvt_pk_bf16_f32 v64, v80, v81
    v_cvt_pk_bf16_f32 v65, v82, v83
    v_cvt_pk_bf16_f32 v66, v84, v85
    v_cvt_pk_bf16_f32 v67, v86, v87
    ds_write_b128 v6, v[64:67] offset:13312
    s_branch mega_kernel_rf_w1_xok
mega_kernel_rf_w1_pv0:
    s_waitcnt vmcnt(2)
    s_branch mega_kernel_rf_w1_pv1
mega_kernel_rf_w1_pv:
    buffer_load_dwordx2 v[20:21], v11, s[4:7], s40 offen sc1
    s_waitcnt vmcnt(0)
mega_kernel_rf_w1_pv1:
    v_and_b32 v3, 1, v20
    v_cmp_ne_u32 vcc, s41, v3
    v_mov_b32 v113, v20
    v_mov_b32 v115, v21
    s_cbranch_vccnz mega_kernel_rf_w1_pv
    s_branch mega_kernel_rf_w1_pv2
mega_kernel_rf_w2_entry:
    v_mfma_f32_32x32x8_bf16 v[96:111], v[14:15], v[14:15], 0
    v_mfma_f32_16x16x16_bf16 v[112:115], v[14:15], v[14:15], 0
    v_mfma_f32_16x16x16_bf16 v[116:119], v[14:15], v[14:15], 0
    ds_read_b128 v[64:67], v1 offset:8192
    ds_read_b128 v[68:71], v1 offset:9216
    ds_read_b128 v[72:75], v1 offset:10240
    ds_read_b128 v[76:79], v1 offset:11264
    ds_read_b128 v[80:83], v1 offset:24576
    ds_read_b128 v[84:87], v1 offset:25600
    ds_read_b128 v[88:91], v1 offset:26624
    ds_read_b128 v[92:95], v1 offset:27648
    buffer_load_dwordx4 v[120:123], v1, s[4:7], s44 offen
    buffer_load_dwordx4 v[124:127], v1, s[4:7], s44 offen offset:1024
    s_add_u32 s44, s44, 262144
mega_kernel_rf_w2_loop:
    s_add_u32 s22, s35, 4096
    s_waitcnt vmcnt(0)
    buffer_load_dwordx4 v[48:51], v1, s[4:7], s22 offen sc1
    buffer_load_dwordx4 v[52:55], v1, s[4:7], s22 offen offset:1024 sc1
mega_kernel_rf_w2_pa:
    s_waitcnt vmcnt(1)
    ds_write_b128 v6, v[48:51] offset:4096
    s_waitcnt vmcnt(0)
    ds_write_b128 v6, v[52:55] offset:5120
    v_max3_u32 v3, v48, v50, v52
    v_max_u32 v3, v3, v54
    v_cmp_eq_u32 vcc, -1, v3
    v_smfmac_f32_16x16x64_bf16 v[96:99], v[48:51], a[64:71], v2
    buffer_load_dwordx4 v[48:51], v1, s[4:7], s22 offen sc1
    v_smfmac_f32_16x16x64_bf16 v[100:103], v[48:51], a[72:79], v2
    buffer_load_dwordx4 v[52:55], v1, s[4:7], s22 offen offset:1024 sc1
    v_smfmac_f32_16x16x64_bf16 v[104:107], v[48:51], a[192:199], v2
    s_cbranch_vccnz mega_kernel_rf_w2_pafail
    s_waitcnt lgkmcnt(0)
    s_barrier
    ds_read_b128 v[56:59], v6 offset:6144
    ds_read_b128 v[60:63], v6 offset:7168
    v_smfmac_f32_16x16x64_bf16 v[108:111], v[48:51], a[200:207], v2
    ds_read_b128 v[32:35], v6 offset:0
    v_smfmac_f32_16x16x64_bf16 v[96:99], v[52:55], a[80:87], v2
    ds_read_b128 v[36:39], v6 offset:1024
    v_smfmac_f32_16x16x64_bf16 v[100:103], v[52:55], a[88:95], v2
    ds_read_b128 v[40:43], v6 offset:2048
    v_smfmac_f32_16x16x64_bf16 v[104:107], v[52:55], a[208:215], v2
    ds_read_b128 v[44:47], v6 offset:3072
    v_smfmac_f32_16x16x64_bf16 v[108:111], v[52:55], a[216:223], v2
    s_waitcnt lgkmcnt(5)
    v_smfmac_f32_16x16x64_bf16 v[96:99], v[56:59], a[96:103], v2
    v_smfmac_f32_16x16x64_bf16 v[104:107], v[56:59], a[224:231], v2
    buffer_load_dwordx4 v1, s[4:7], s43 offen lds
    s_waitcnt lgkmcnt(4)
    v_smfmac_f32_16x16x64_bf16 v[96:99], v[60:63], a[112:119], v2
    v_smfmac_f32_16x16x64_bf16 v[104:107], v[60:63], a[240:247], v2
    s_waitcnt lgkmcnt(3)
    v_smfmac_f32_16x16x64_bf16 v[96:99], v[32:35], a[0:7], v2
    v_smfmac_f32_16x16x64_bf16 v[104:107], v[32:35], a[128:135], v2
    buffer_load_dwordx4 v1, s[4:7], s43 offen offset:1024 lds
    s_waitcnt lgkmcnt(2)
    v_smfmac_f32_16x16x64_bf16 v[96:99], v[36:39], a[16:23], v2
    v_smfmac_f32_16x16x64_bf16 v[104:107], v[36:39], a[144:151], v2
    s_waitcnt lgkmcnt(1)
    v_smfmac_f32_16x16x64_bf16 v[96:99], v[40:43], a[32:39], v2
    v_smfmac_f32_16x16x64_bf16 v[104:107], v[40:43], a[160:167], v2
    s_waitcnt lgkmcnt(0)
    v_smfmac_f32_16x16x64_bf16 v[96:99], v[44:47], a[48:55], v2
    v_smfmac_f32_16x16x64_bf16 v[104:107], v[44:47], a[176:183], v2
    v_smfmac_f32_16x16x64_bf16 v[100:103], v[56:59], a[104:111], v2
    s_nop 2
    v_smfmac_f32_16x16x64_bf16 v[100:103], v[60:63], a[120:127], v2
    s_nop 1
    v_add_f32 v96, v96, v98
    v_smfmac_f32_16x16x64_bf16 v[100:103], v[32:35], a[8:15], v2
    v_add_f32 v97, v97, v99
    v_add_f32 v104, v104, v106
    v_smfmac_f32_16x16x64_bf16 v[100:103], v[36:39], a[24:31], v2
    v_add_f32 v105, v105, v107
    v_cvt_pk_bf16_f32 v96, v96, v97
    v_smfmac_f32_16x16x64_bf16 v[100:103], v[40:43], a[40:47], v2
    v_cvt_pk_bf16_f32 v97, v104, v105
    v_and_or_b32 v96, v96, -2, s41
    v_smfmac_f32_16x16x64_bf16 v[100:103], v[44:47], a[56:63], v2
    buffer_store_dwordx2 v[96:97], v11, s[4:7], s37 offen sc1
    v_smfmac_f32_16x16x64_bf16 v[108:111], v[56:59], a[232:239], v2
    v_smfmac_f32_16x16x64_bf16 v[108:111], v[60:63], a[248:255], v2
    v_smfmac_f32_16x16x64_bf16 v[108:111], v[32:35], a[136:143], v2
    v_smfmac_f32_16x16x64_bf16 v[108:111], v[36:39], a[152:159], v2
    v_smfmac_f32_16x16x64_bf16 v[108:111], v[40:43], a[168:175], v2
    s_nop 2
    v_add_f32 v100, v100, v102
    v_smfmac_f32_16x16x64_bf16 v[108:111], v[44:47], a[184:191], v2
    v_add_f32 v101, v101, v103
    v_cvt_pk_bf16_f32 v98, v100, v101
    v_and_or_b32 v98, v98, -2, s41
    s_nop 4
    v_pk_add_f32 v[108:109], v[108:109], v[110:111]
    v_cvt_pk_bf16_f32 v99, v108, v109
    buffer_store_dwordx2 v[98:99], v11, s[4:7], s37 offen offset:512 sc1
    v_smfmac_f32_16x16x64_bf16 v[112:115], v[32:35], v[64:71], v2
    ds_read_b128 v[64:67], v1 offset:40960
    ds_read_b128 v[68:71], v1 offset:41984
    v_smfmac_f32_16x16x64_bf16 v[116:119], v[32:35], v[72:79], v2
    ds_read_b128 v[72:75], v1 offset:43008
    ds_read_b128 v[76:79], v1 offset:44032
    v_smfmac_f32_16x16x64_bf16 v[112:115], v[36:39], v[80:87], v2
    ds_read_b128 v[80:83], v1 offset:57344
    ds_read_b128 v[84:87], v1 offset:58368
    v_smfmac_f32_16x16x64_bf16 v[116:119], v[36:39], v[88:95], v2
    ds_read_b128 v[88:91], v1 offset:59392
    ds_read_b128 v[92:95], v1 offset:60416
    s_waitcnt lgkmcnt(6)
    v_smfmac_f32_16x16x64_bf16 v[112:115], v[40:43], v[64:71], v2
    ds_read_b128 v[64:67], v5 offset:8192
    ds_read_b128 v[68:71], v5 offset:9216
    s_waitcnt lgkmcnt(6)
    v_smfmac_f32_16x16x64_bf16 v[116:119], v[40:43], v[72:79], v2
    ds_read_b128 v[72:75], v5 offset:10240
    ds_read_b128 v[76:79], v5 offset:11264
    s_waitcnt lgkmcnt(6)
    v_smfmac_f32_16x16x64_bf16 v[112:115], v[44:47], v[80:87], v2
    ds_read_b128 v[80:83], v5 offset:24576
    ds_read_b128 v[84:87], v5 offset:25600
    s_waitcnt lgkmcnt(6)
    v_smfmac_f32_16x16x64_bf16 v[116:119], v[44:47], v[88:95], v2
    ds_read_b128 v[88:91], v5 offset:26624
    ds_read_b128 v[92:95], v5 offset:27648
    s_waitcnt lgkmcnt(6)
    v_smfmac_f32_16x16x64_bf16 v[112:115], v[48:51], v[64:71], v2
    ds_read_b128 v[64:67], v5 offset:40960
    ds_read_b128 v[68:71], v5 offset:41984
    s_waitcnt lgkmcnt(6)
    v_smfmac_f32_16x16x64_bf16 v[116:119], v[48:51], v[72:79], v2
    ds_read_b128 v[72:75], v5 offset:43008
    ds_read_b128 v[76:79], v5 offset:44032
    s_waitcnt lgkmcnt(6)
    v_smfmac_f32_16x16x64_bf16 v[112:115], v[52:55], v[80:87], v2
    ds_read_b128 v[80:83], v5 offset:57344
    ds_read_b128 v[84:87], v5 offset:58368
    s_waitcnt lgkmcnt(6)
    v_smfmac_f32_16x16x64_bf16 v[116:119], v[52:55], v[88:95], v2
    ds_read_b128 v[88:91], v5 offset:59392
    ds_read_b128 v[92:95], v5 offset:60416
    s_waitcnt lgkmcnt(6)
    v_smfmac_f32_16x16x64_bf16 v[112:115], v[56:59], v[64:71], v2
    s_waitcnt lgkmcnt(4)
    v_smfmac_f32_16x16x64_bf16 v[116:119], v[56:59], v[72:79], v2
    s_waitcnt lgkmcnt(2)
    v_smfmac_f32_16x16x64_bf16 v[112:115], v[60:63], v[80:87], v2
    s_waitcnt lgkmcnt(0)
    v_smfmac_f32_16x16x64_bf16 v[116:119], v[60:63], v[88:95], v2
    buffer_load_dwordx2 v[108:109], v11, s[4:7], s38 offen sc1
    v_mfma_f32_16x16x16_bf16 v[100:103], v[96:97], v[16:17], 0
    v_mfma_f32_16x16x16_bf16 v[104:107], v[98:99], v[16:17], 0
    s_nop 4
    v_add_f32 v112, v112, v114
    v_add_f32 v113, v113, v115
    v_add_f32 v114, v116, v118
    v_add_f32 v115, v117, v119
    v_cvt_pk_bf16_f32 v18, v112, v113
    v_cvt_pk_bf16_f32 v19, v114, v115
    v_and_or_b32 v18, v18, -2, s41
    buffer_load_dwordx2 v[110:111], v11, s[4:7], s38 offen offset:512 sc1
    s_barrier
    buffer_store_dwordx2 v[18:19], v11, s[4:7], s39 offen sc1
    v_mov_b32 v112, v18
    v_mov_b32 v114, v19
    v_mov_b32 v92, v28
    v_mov_b32 v93, 0
    s_waitcnt vmcnt(5)
    s_barrier
    ds_read_b128 v[32:35], v6 offset:19456
    ds_read_b128 v[36:39], v6 offset:20480
    ds_read_b128 v[40:43], v6 offset:24576
    ds_read_b128 v[44:47], v6 offset:25600
    ds_read_b128 v[48:51], v6 offset:9216
    ds_read_b128 v[52:55], v6 offset:10240
    ds_read_b128 v[56:59], v6 offset:14336
    ds_read_b128 v[60:63], v6 offset:15360
    buffer_load_dwordx2 v[20:21], v11, s[4:7], s38 offen sc1
    buffer_load_dwordx2 v[22:23], v11, s[4:7], s38 offen offset:512 sc1
    s_waitcnt vmcnt(4)
    v_mfma_f32_16x16x16_bf16 v[80:83], v[108:109], v[16:17], v[100:103]
    v_and_b32 v3, 1, v108
    v_cmp_ne_u32 vcc, s41, v3
    s_nop 5
    v_cvt_pk_bf16_f32 v64, v80, v81
    v_cvt_pk_bf16_f32 v65, v82, v83
    s_cbranch_vccnz mega_kernel_rf_w2_xslow
    s_waitcnt vmcnt(3)
    v_mfma_f32_16x16x16_bf16 v[84:87], v[110:111], v[16:17], v[104:107]
    v_and_b32 v3, 1, v110
    v_cmp_ne_u32 vcc, s41, v3
    s_nop 5
    v_cvt_pk_bf16_f32 v66, v84, v85
    v_cvt_pk_bf16_f32 v67, v86, v87
    ds_write_b128 v6, v[64:67] offset:18432
    s_cbranch_vccnz mega_kernel_rf_w2_xslow
mega_kernel_rf_w2_xok:
    s_cmp_eq_u32 s21, 63
    s_cbranch_scc1 mega_kernel_rf_w2_last
    buffer_load_dwordx2 v[116:117], v11, s[4:7], s40 offen sc1
    s_waitcnt lgkmcnt(1)
    v_mfma_f32_16x16x32_bf16 v[80:83], v[32:35], v[64:67], 0
    s_waitcnt lgkmcnt(0)
    s_barrier
    ds_read_b128 v[68:71], v6 offset:23552
    ds_read_b128 v[72:75], v6 offset:8192
    ds_read_b128 v[76:79], v6 offset:13312
    v_mfma_f32_16x16x32_bf16 v[84:87], v[36:39], v[64:67], 0
    v_mfma_f32_16x16x32_bf16 v[88:91], v[64:67], v[64:67], 0
    buffer_load_dwordx2 v[20:21], v11, s[4:7], s40 offen sc1
    s_waitcnt lgkmcnt(2)
    v_mfma_f32_16x16x32_bf16 v[80:83], v[40:43], v[68:71], v[80:83]
    s_waitcnt lgkmcnt(1)
    v_mfma_f32_16x16x32_bf16 v[80:83], v[48:51], v[72:75], v[80:83]
    s_waitcnt lgkmcnt(0)
    v_mfma_f32_16x16x32_bf16 v[80:83], v[56:59], v[76:79], v[80:83]
    buffer_store_dwordx4 v[64:67], v10, s[4:7], s45 offen offset:128 sc1
    v_mfma_f32_16x16x32_bf16 v[84:87], v[44:47], v[68:71], v[84:87]
    v_mfma_f32_16x16x32_bf16 v[84:87], v[52:55], v[72:75], v[84:87]
    v_mfma_f32_16x16x32_bf16 v[84:87], v[60:63], v[76:79], v[84:87]
    v_mfma_f32_16x16x32_bf16 v[88:91], v[68:71], v[68:71], v[88:91]
    buffer_store_dwordx2 v[18:19], v11, s[4:7], s51 offen offset:3072 sc1
    v_mfma_f32_16x16x32_bf16 v[88:91], v[72:75], v[72:75], v[88:91]
    v_mfma_f32_16x16x32_bf16 v[88:91], v[76:79], v[76:79], v[88:91]
    v_mfma_f32_32x32x4_2b_bf16 v[32:63], v[14:15], v[14:15], 0
    s_nop 0
    v_max3_f32 v4, v80, v81, v82
    s_nop 1
    v_max3_f32 v4, v4, v83, v84
    v_max3_f32 v4, v4, v85, v86
    v_max_f32 v4, v4, v87
    v_max3_f32 v90, v4, v88, v89
    v_max3_f32 v4, v4, v88, v89
    s_nop 1
    v_permlane16_swap_b32 v4, v90
    v_max_f32 v4, v4, v90
    v_max_f32 v90, v4, v90
    s_nop 1
    v_permlane32_swap_b32 v4, v90
    v_max_f32 v4, v4, v90
    v_mul_f32 v4, s34, v4
    v_pk_fma_f32 v[80:81], v[80:81], s[34:35], v[4:5] op_sel_hi:[1,0,0] neg_lo:[0,0,1] neg_hi:[0,0,1]
    v_pk_fma_f32 v[82:83], v[82:83], s[34:35], v[4:5] op_sel_hi:[1,0,0] neg_lo:[0,0,1] neg_hi:[0,0,1]
    v_pk_fma_f32 v[84:85], v[84:85], s[34:35], v[4:5] op_sel_hi:[1,0,0] neg_lo:[0,0,1] neg_hi:[0,0,1]
    v_pk_fma_f32 v[86:87], v[86:87], s[34:35], v[4:5] op_sel_hi:[1,0,0] neg_lo:[0,0,1] neg_hi:[0,0,1]
    v_pk_fma_f32 v[88:89], v[88:89], s[34:35], v[4:5] op_sel_hi:[1,0,0] neg_lo:[0,0,1] neg_hi:[0,0,1]
    v_exp_f32 v80, v80
    v_exp_f32 v81, v81
    v_exp_f32 v82, v82
    v_cvt_pk_bf16_f32 v68, v80, v81
    v_exp_f32 v83, v83
    v_exp_f32 v84, v84
    v_cvt_pk_bf16_f32 v69, v82, v83
    v_exp_f32 v85, v85
    v_exp_f32 v86, v86
    v_cvt_pk_bf16_f32 v70, v84, v85
    v_exp_f32 v87, v87
    v_exp_f32 v88, v88
    v_cvt_pk_bf16_f32 v71, v86, v87
    v_exp_f32 v89, v89
    s_waitcnt vmcnt(3)
    v_mfma_f32_16x16x32_bf16 v[76:79], v[28:31], v[68:71], 0
    v_and_b32 v3, 1, v116
    v_cvt_pk_bf16_f32 v72, v88, v89
    v_mfma_f32_16x16x32_bf16 v[100:103], v[120:123], v[68:71], 0
    v_cmp_ne_u32 vcc, s41, v3
    v_cvt_pk_bf16_f32 v73, v88, v89
    v_mfma_f32_16x16x32_bf16 v[104:107], v[124:127], v[68:71], 0
    v_mov_b32 v113, v116
    v_mov_b32 v115, v117
    v_mfma_f32_16x16x16_bf16 v[76:79], v[92:93], v[72:73], v[76:79]
    s_cbranch_vccnz mega_kernel_rf_w2_pv0
mega_kernel_rf_w2_pv2:
    v_mfma_f32_16x16x16_bf16 v[100:103], v[112:113], v[72:73], v[100:103]
    v_mfma_f32_16x16x16_bf16 v[104:107], v[114:115], v[72:73], v[104:107]
    buffer_load_dwordx4 v[120:123], v1, s[4:7], s44 offen
    buffer_load_dwordx4 v[124:127], v1, s[4:7], s44 offen offset:1024
    s_nop 2
    v_rcp_f32 v76, v76
    s_mov_b64 exec, s[28:29]
    v_pk_mul_f32 v[100:101], v[100:101], v[76:77] op_sel_hi:[1,0]
    v_pk_mul_f32 v[102:103], v[102:103], v[76:77] op_sel_hi:[1,0]
    v_pk_mul_f32 v[104:105], v[104:105], v[76:77] op_sel_hi:[1,0]
    v_pk_mul_f32 v[106:107], v[106:107], v[76:77] op_sel_hi:[1,0]
    v_cvt_pk_bf16_f32 v84, v100, v101
    v_cvt_pk_bf16_f32 v85, v102, v103
    v_cvt_pk_bf16_f32 v86, v104, v105
    v_cvt_pk_bf16_f32 v87, v106, v107
    ds_write_b128 v6, v[84:87] offset:29664
    s_mov_b64 exec, -1
    s_waitcnt lgkmcnt(0)
    s_barrier
    ds_read_b128 v[68:71], v6 offset:28672
    ds_read_b128 v[72:75], v6 offset:29696
    s_waitcnt lgkmcnt(1)
    v_smfmac_f32_16x16x64_bf16 v[32:35], v[68:71], v[128:135], v2
    s_add_u32 s21, s21, 1
    s_xor_b32 s38, s38, 1048576
    s_xor_b32 s37, s37, 1048576
    s_waitcnt lgkmcnt(0)
    v_smfmac_f32_16x16x64_bf16 v[32:35], v[72:75], v[136:143], v2
    s_xor_b32 s40, s40, 1048576
    s_xor_b32 s39, s39, 1048576
    s_lshr_b32 s41, s21, 1
    v_smfmac_f32_16x16x64_bf16 v[36:39], v[68:71], v[144:151], v2
    s_and_b32 s41, s41, 1
    s_xor_b32 s41, s41, 1
    s_xor_b32 s35, s35, 16384
    v_smfmac_f32_16x16x64_bf16 v[36:39], v[72:75], v[152:159], v2
    v_add_f32 v32, v32, v34
    s_xor_b32 s36, s36, 16384
    s_add_u32 s43, s43, 262144
    s_add_u32 s44, s44, 262144
    v_smfmac_f32_16x16x64_bf16 v[40:43], v[68:71], v[160:167], v2
    v_add_f32 v33, v33, v35
    v_smfmac_f32_16x16x64_bf16 v[40:43], v[72:75], v[168:175], v2
    v_cvt_pk_bf16_f32 v32, v32, v33
    v_smfmac_f32_16x16x64_bf16 v[44:47], v[68:71], v[176:183], v2
    v_and_or_b32 v32, v32, -2, s42
    v_smfmac_f32_16x16x64_bf16 v[44:47], v[72:75], v[184:191], v2
    v_add_f32 v36, v36, v38
    v_smfmac_f32_16x16x64_bf16 v[48:51], v[68:71], v[192:199], v2
    v_add_f32 v37, v37, v39
    v_smfmac_f32_16x16x64_bf16 v[48:51], v[72:75], v[200:207], v2
    v_cvt_pk_bf16_f32 v33, v36, v37
    v_smfmac_f32_16x16x64_bf16 v[52:55], v[68:71], v[208:215], v2
    v_add_f32 v40, v40, v42
    v_smfmac_f32_16x16x64_bf16 v[52:55], v[72:75], v[216:223], v2
    v_add_f32 v41, v41, v43
    v_smfmac_f32_16x16x64_bf16 v[56:59], v[68:71], v[224:231], v2
    v_cvt_pk_bf16_f32 v34, v40, v41
    v_smfmac_f32_16x16x64_bf16 v[56:59], v[72:75], v[232:239], v2
    v_add_f32 v44, v44, v46
    v_smfmac_f32_16x16x64_bf16 v[60:63], v[68:71], v[240:247], v2
    v_add_f32 v45, v45, v47
    v_smfmac_f32_16x16x64_bf16 v[60:63], v[72:75], v[248:255], v2
    v_cvt_pk_bf16_f32 v35, v44, v45
    buffer_store_dwordx4 v[32:35], v8, s[4:7], s46 offen
    v_pk_add_f32 v[48:49], v[48:49], v[50:51]
    v_cvt_pk_bf16_f32 v48, v48, v49
    v_and_or_b32 v48, v48, -2, s42
    v_pk_add_f32 v[52:53], v[52:53], v[54:55]
    v_cvt_pk_bf16_f32 v49, v52, v53
    v_pk_add_f32 v[56:57], v[56:57], v[58:59]
    v_cvt_pk_bf16_f32 v50, v56, v57
    v_pk_add_f32 v[60:61], v[60:61], v[62:63]
    v_cvt_pk_bf16_f32 v51, v60, v61
    buffer_store_dwordx4 v[48:51], v8, s[4:7], s61 offen
    s_add_u32 s45, s45, 262144
    s_add_u32 s51, s51, 262144
    v_mfma_f32_32x32x8_bf16 v[96:111], v[14:15], v[14:15], 0
    v_mfma_f32_16x16x16_bf16 v[112:115], v[14:15], v[14:15], 0
    v_mfma_f32_16x16x16_bf16 v[116:119], v[14:15], v[14:15], 0
    ds_read_b128 v[64:67], v1 offset:8192
    ds_read_b128 v[68:71], v1 offset:9216
    ds_read_b128 v[72:75], v1 offset:10240
    ds_read_b128 v[76:79], v1 offset:11264
    ds_read_b128 v[80:83], v1 offset:24576
    ds_read_b128 v[84:87], v1 offset:25600
    ds_read_b128 v[88:91], v1 offset:26624
    ds_read_b128 v[92:95], v1 offset:27648
    v_mov_b32 v58, -1
    v_mov_b32 v59, -1
    s_waitcnt vmcnt(0)
mega_kernel_rf_w2_pc:
    buffer_load_dword v36, v13, s[4:7], s25 offen offset:0 sc1
    buffer_load_dword v37, v13, s[4:7], s25 offen offset:256 sc1
    buffer_load_dword v38, v13, s[4:7], s25 offen offset:512 sc1
    buffer_load_dword v39, v13, s[4:7], s25 offen offset:768 sc1
    buffer_load_dword v40, v13, s[4:7], s25 offen offset:1024 sc1
    buffer_load_dword v41, v13, s[4:7], s25 offen offset:1280 sc1
    buffer_load_dword v42, v13, s[4:7], s25 offen offset:1536 sc1
    buffer_load_dword v43, v13, s[4:7], s25 offen offset:1792 sc1
    s_waitcnt vmcnt(4)
    v_mfma_f32_16x16x32_bf16 v[52:55], v[36:39], v[24:27], 0
    v_bitop3_b32 v3, s42, v36, v37 bitop3:0x7e
    v_bitop3_b32 v4, s42, v38, v39 bitop3:0x7e
    s_waitcnt vmcnt(2)
    v_or_b32 v3, v3, v4
    v_bitop3_b32 v4, s42, v40, v41 bitop3:0x7e
    s_waitcnt vmcnt(0)
    v_mfma_f32_16x16x32_bf16 v[52:55], v[40:43], v[24:27], v[52:55]
    v_bitop3_b32 v56, s42, v42, v43 bitop3:0x7e
    v_or3_b32 v3, v3, v4, v56
    v_and_b32 v3, v0, v3
    v_cmp_ne_u32 vcc, 0, v3
    s_nop 3
    v_cvt_pk_bf16_f32 v56, v52, v53
    v_cvt_pk_bf16_f32 v57, v54, v55
    v_min_u32 v56, -2, v56
    s_cbranch_vccnz mega_kernel_rf_w2_pc
    s_mov_b64 exec, s[26:27]
    buffer_store_dwordx2 v[56:57], v9, s[4:7], s35 offen offset:512
    buffer_store_dwordx2 v[58:59], v9, s[4:7], s36 offen offset:512
    s_mov_b64 exec, -1
    s_xor_b32 s42, s42, 1
    s_branch mega_kernel_rf_w2_loop
mega_kernel_rf_w2_last:
    buffer_store_dwordx4 v[64:67], v10, s[4:7], s45 offen offset:128 sc1
    buffer_store_dwordx2 v[18:19], v11, s[4:7], s51 offen offset:3072 sc1
    s_branch mega_kernel_rf_end
mega_kernel_rf_w2_pafail:
    s_nop 7
    v_mov_b32 v96, 0
    v_mov_b32 v97, 0
    v_mov_b32 v98, 0
    v_mov_b32 v99, 0
    v_mov_b32 v100, 0
    v_mov_b32 v101, 0
    v_mov_b32 v102, 0
    v_mov_b32 v103, 0
    v_mov_b32 v104, 0
    v_mov_b32 v105, 0
    v_mov_b32 v106, 0
    v_mov_b32 v107, 0
    s_branch mega_kernel_rf_w2_pa
mega_kernel_rf_w2_xslow:
    buffer_load_dwordx2 v[108:109], v11, s[4:7], s38 offen sc1
    buffer_load_dwordx2 v[110:111], v11, s[4:7], s38 offen offset:512 sc1
    s_waitcnt vmcnt(2)
    v_bitop3_b32 v3, s41, v20, v22 bitop3:0x7e
    v_mfma_f32_16x16x16_bf16 v[80:83], v[20:21], v[16:17], v[100:103]
    v_and_b32 v3, 1, v3
    v_mfma_f32_16x16x16_bf16 v[84:87], v[22:23], v[16:17], v[104:107]
    v_cmp_ne_u32 vcc, 0, v3
    s_cbranch_vccz mega_kernel_rf_w2_xgot
    buffer_load_dwordx2 v[20:21], v11, s[4:7], s38 offen sc1
    buffer_load_dwordx2 v[22:23], v11, s[4:7], s38 offen offset:512 sc1
    s_waitcnt vmcnt(2)
    v_bitop3_b32 v3, s41, v108, v110 bitop3:0x7e
    v_mfma_f32_16x16x16_bf16 v[80:83], v[108:109], v[16:17], v[100:103]
    v_and_b32 v3, 1, v3
    v_mfma_f32_16x16x16_bf16 v[84:87], v[110:111], v[16:17], v[104:107]
    v_cmp_ne_u32 vcc, 0, v3
    s_cbranch_vccz mega_kernel_rf_w2_xgot
    s_branch mega_kernel_rf_w2_xslow
mega_kernel_rf_w2_xgot:
    s_nop 3
    v_cvt_pk_bf16_f32 v64, v80, v81
    v_cvt_pk_bf16_f32 v65, v82, v83
    v_cvt_pk_bf16_f32 v66, v84, v85
    v_cvt_pk_bf16_f32 v67, v86, v87
    ds_write_b128 v6, v[64:67] offset:18432
    s_branch mega_kernel_rf_w2_xok
mega_kernel_rf_w2_pv0:
    s_waitcnt vmcnt(2)
    s_branch mega_kernel_rf_w2_pv1
mega_kernel_rf_w2_pv:
    buffer_load_dwordx2 v[20:21], v11, s[4:7], s40 offen sc1
    s_waitcnt vmcnt(0)
mega_kernel_rf_w2_pv1:
    v_and_b32 v3, 1, v20
    v_cmp_ne_u32 vcc, s41, v3
    v_mov_b32 v113, v20
    v_mov_b32 v115, v21
    s_cbranch_vccnz mega_kernel_rf_w2_pv
    s_branch mega_kernel_rf_w2_pv2
mega_kernel_rf_w3_entry:
    v_mfma_f32_32x32x8_bf16 v[96:111], v[14:15], v[14:15], 0
    v_mfma_f32_16x16x16_bf16 v[112:115], v[14:15], v[14:15], 0
    v_mfma_f32_16x16x16_bf16 v[116:119], v[14:15], v[14:15], 0
    ds_read_b128 v[64:67], v1 offset:12288
    ds_read_b128 v[68:71], v1 offset:13312
    ds_read_b128 v[72:75], v1 offset:14336
    ds_read_b128 v[76:79], v1 offset:15360
    ds_read_b128 v[80:83], v1 offset:28672
    ds_read_b128 v[84:87], v1 offset:29696
    ds_read_b128 v[88:91], v1 offset:30720
    ds_read_b128 v[92:95], v1 offset:31744
    buffer_load_dwordx4 v[120:123], v1, s[4:7], s44 offen
    buffer_load_dwordx4 v[124:127], v1, s[4:7], s44 offen offset:1024
    s_add_u32 s44, s44, 262144
mega_kernel_rf_w3_loop:
    s_add_u32 s22, s35, 6144
    s_waitcnt vmcnt(0)
    buffer_load_dwordx4 v[56:59], v1, s[4:7], s22 offen sc1
    buffer_load_dwordx4 v[60:63], v1, s[4:7], s22 offen offset:1024 sc1
mega_kernel_rf_w3_pa:
    s_waitcnt vmcnt(1)
    ds_write_b128 v6, v[56:59] offset:6144
    s_waitcnt vmcnt(0)
    ds_write_b128 v6, v[60:63] offset:7168
    v_max3_u32 v3, v56, v58, v60
    v_max_u32 v3, v3, v62
    v_cmp_eq_u32 vcc, -1, v3
    v_smfmac_f32_16x16x64_bf16 v[96:99], v[56:59], a[96:103], v2
    buffer_load_dwordx4 v[56:59], v1, s[4:7], s22 offen sc1
    v_smfmac_f32_16x16x64_bf16 v[100:103], v[56:59], a[104:111], v2
    buffer_load_dwordx4 v[60:63], v1, s[4:7], s22 offen offset:1024 sc1
    v_smfmac_f32_16x16x64_bf16 v[104:107], v[56:59], a[224:231], v2
    s_cbranch_vccnz mega_kernel_rf_w3_pafail
    s_waitcnt lgkmcnt(0)
    s_barrier
    ds_read_b128 v[32:35], v6 offset:0
    ds_read_b128 v[36:39], v6 offset:1024
    v_smfmac_f32_16x16x64_bf16 v[108:111], v[56:59], a[232:239], v2
    ds_read_b128 v[40:43], v6 offset:2048
    v_smfmac_f32_16x16x64_bf16 v[96:99], v[60:63], a[112:119], v2
    ds_read_b128 v[44:47], v6 offset:3072
    v_smfmac_f32_16x16x64_bf16 v[100:103], v[60:63], a[120:127], v2
    ds_read_b128 v[48:51], v6 offset:4096
    v_smfmac_f32_16x16x64_bf16 v[104:107], v[60:63], a[240:247], v2
    ds_read_b128 v[52:55], v6 offset:5120
    v_smfmac_f32_16x16x64_bf16 v[108:111], v[60:63], a[248:255], v2
    s_waitcnt lgkmcnt(5)
    v_smfmac_f32_16x16x64_bf16 v[96:99], v[32:35], a[0:7], v2
    v_smfmac_f32_16x16x64_bf16 v[104:107], v[32:35], a[128:135], v2
    s_waitcnt lgkmcnt(4)
    v_smfmac_f32_16x16x64_bf16 v[96:99], v[36:39], a[16:23], v2
    buffer_load_dwordx4 v1, s[4:7], s43 offen lds
    v_smfmac_f32_16x16x64_bf16 v[104:107], v[36:39], a[144:151], v2
    s_waitcnt lgkmcnt(3)
    v_smfmac_f32_16x16x64_bf16 v[96:99], v[40:43], a[32:39], v2
    v_smfmac_f32_16x16x64_bf16 v[104:107], v[40:43], a[160:167], v2
    s_waitcnt lgkmcnt(2)
    v_smfmac_f32_16x16x64_bf16 v[96:99], v[44:47], a[48:55], v2
    buffer_load_dwordx4 v1, s[4:7], s43 offen offset:1024 lds
    v_smfmac_f32_16x16x64_bf16 v[104:107], v[44:47], a[176:183], v2
    s_waitcnt lgkmcnt(1)
    v_smfmac_f32_16x16x64_bf16 v[96:99], v[48:51], a[64:71], v2
    v_smfmac_f32_16x16x64_bf16 v[104:107], v[48:51], a[192:199], v2
    s_waitcnt lgkmcnt(0)
    v_smfmac_f32_16x16x64_bf16 v[96:99], v[52:55], a[80:87], v2
    buffer_load_dword v12, v7, s[4:7], 0 offen sc1
    v_smfmac_f32_16x16x64_bf16 v[104:107], v[52:55], a[208:215], v2
    v_smfmac_f32_16x16x64_bf16 v[100:103], v[32:35], a[8:15], v2
    s_nop 2
    v_smfmac_f32_16x16x64_bf16 v[100:103], v[36:39], a[24:31], v2
    s_nop 1
    v_add_f32 v96, v96, v98
    v_smfmac_f32_16x16x64_bf16 v[100:103], v[40:43], a[40:47], v2
    v_add_f32 v97, v97, v99
    v_add_f32 v104, v104, v106
    v_smfmac_f32_16x16x64_bf16 v[100:103], v[44:47], a[56:63], v2
    v_add_f32 v105, v105, v107
    v_cvt_pk_bf16_f32 v96, v96, v97
    v_smfmac_f32_16x16x64_bf16 v[100:103], v[48:51], a[72:79], v2
    v_cvt_pk_bf16_f32 v97, v104, v105
    v_and_or_b32 v96, v96, -2, s41
    v_smfmac_f32_16x16x64_bf16 v[100:103], v[52:55], a[88:95], v2
    buffer_store_dwordx2 v[96:97], v11, s[4:7], s37 offen sc1
    v_smfmac_f32_16x16x64_bf16 v[108:111], v[32:35], a[136:143], v2
    v_smfmac_f32_16x16x64_bf16 v[108:111], v[36:39], a[152:159], v2
    v_smfmac_f32_16x16x64_bf16 v[108:111], v[40:43], a[168:175], v2
    v_smfmac_f32_16x16x64_bf16 v[108:111], v[44:47], a[184:191], v2
    v_smfmac_f32_16x16x64_bf16 v[108:111], v[48:51], a[200:207], v2
    s_nop 2
    v_add_f32 v100, v100, v102
    v_smfmac_f32_16x16x64_bf16 v[108:111], v[52:55], a[216:223], v2
    v_add_f32 v101, v101, v103
    v_cvt_pk_bf16_f32 v98, v100, v101
    v_and_or_b32 v98, v98, -2, s41
    s_nop 4
    v_pk_add_f32 v[108:109], v[108:109], v[110:111]
    v_cvt_pk_bf16_f32 v99, v108, v109
    buffer_store_dwordx2 v[98:99], v11, s[4:7], s37 offen offset:512 sc1
    v_smfmac_f32_16x16x64_bf16 v[112:115], v[32:35], v[64:71], v2
    ds_read_b128 v[64:67], v1 offset:45056
    ds_read_b128 v[68:71], v1 offset:46080
    v_smfmac_f32_16x16x64_bf16 v[116:119], v[32:35], v[72:79], v2
    ds_read_b128 v[72:75], v1 offset:47104
    ds_read_b128 v[76:79], v1 offset:48128
    v_smfmac_f32_16x16x64_bf16 v[112:115], v[36:39], v[80:87], v2
    ds_read_b128 v[80:83], v1 offset:61440
    ds_read_b128 v[84:87], v1 offset:62464
    v_smfmac_f32_16x16x64_bf16 v[116:119], v[36:39], v[88:95], v2
    ds_read_b128 v[88:91], v1 offset:63488
    ds_read_b128 v[92:95], v1 offset:64512
    s_waitcnt lgkmcnt(6)
    v_smfmac_f32_16x16x64_bf16 v[112:115], v[40:43], v[64:71], v2
    ds_read_b128 v[64:67], v5 offset:12288
    ds_read_b128 v[68:71], v5 offset:13312
    s_waitcnt lgkmcnt(6)
    v_smfmac_f32_16x16x64_bf16 v[116:119], v[40:43], v[72:79], v2
    ds_read_b128 v[72:75], v5 offset:14336
    ds_read_b128 v[76:79], v5 offset:15360
    s_waitcnt lgkmcnt(6)
    v_smfmac_f32_16x16x64_bf16 v[112:115], v[44:47], v[80:87], v2
    ds_read_b128 v[80:83], v5 offset:28672
    ds_read_b128 v[84:87], v5 offset:29696
    s_waitcnt lgkmcnt(6)
    v_smfmac_f32_16x16x64_bf16 v[116:119], v[44:47], v[88:95], v2
    ds_read_b128 v[88:91], v5 offset:30720
    ds_read_b128 v[92:95], v5 offset:31744
    s_waitcnt lgkmcnt(6)
    v_smfmac_f32_16x16x64_bf16 v[112:115], v[48:51], v[64:71], v2
    ds_read_b128 v[64:67], v5 offset:45056
    ds_read_b128 v[68:71], v5 offset:46080
    s_waitcnt lgkmcnt(6)
    v_smfmac_f32_16x16x64_bf16 v[116:119], v[48:51], v[72:79], v2
    ds_read_b128 v[72:75], v5 offset:47104
    ds_read_b128 v[76:79], v5 offset:48128
    s_waitcnt lgkmcnt(6)
    v_smfmac_f32_16x16x64_bf16 v[112:115], v[52:55], v[80:87], v2
    ds_read_b128 v[80:83], v5 offset:61440
    ds_read_b128 v[84:87], v5 offset:62464
    s_waitcnt lgkmcnt(6)
    v_smfmac_f32_16x16x64_bf16 v[116:119], v[52:55], v[88:95], v2
    ds_read_b128 v[88:91], v5 offset:63488
    ds_read_b128 v[92:95], v5 offset:64512
    s_waitcnt lgkmcnt(6)
    v_smfmac_f32_16x16x64_bf16 v[112:115], v[56:59], v[64:71], v2
    s_waitcnt lgkmcnt(4)
    v_smfmac_f32_16x16x64_bf16 v[116:119], v[56:59], v[72:79], v2
    s_waitcnt lgkmcnt(2)
    v_smfmac_f32_16x16x64_bf16 v[112:115], v[60:63], v[80:87], v2
    s_waitcnt lgkmcnt(0)
    v_smfmac_f32_16x16x64_bf16 v[116:119], v[60:63], v[88:95], v2
    buffer_load_dwordx2 v[108:109], v11, s[4:7], s38 offen sc1
    v_mfma_f32_16x16x16_bf16 v[100:103], v[96:97], v[16:17], 0
    v_mfma_f32_16x16x16_bf16 v[104:107], v[98:99], v[16:17], 0
    s_nop 4
    v_add_f32 v112, v112, v114
    v_add_f32 v113, v113, v115
    v_add_f32 v114, v116, v118
    v_add_f32 v115, v117, v119
    v_cvt_pk_bf16_f32 v18, v112, v113
    v_cvt_pk_bf16_f32 v19, v114, v115
    v_and_or_b32 v18, v18, -2, s41
    buffer_load_dwordx2 v[110:111], v11, s[4:7], s38 offen offset:512 sc1
    s_barrier
    buffer_store_dwordx2 v[18:19], v11, s[4:7], s39 offen sc1
    v_mov_b32 v112, v18
    v_mov_b32 v114, v19
    v_mov_b32 v92, v28
    v_mov_b32 v93, 0
    s_waitcnt vmcnt(6)
    s_barrier
    ds_read_b128 v[32:35], v6 offset:24576
    ds_read_b128 v[36:39], v6 offset:25600
    ds_read_b128 v[40:43], v6 offset:19456
    ds_read_b128 v[44:47], v6 offset:20480
    ds_read_b128 v[48:51], v6 offset:14336
    ds_read_b128 v[52:55], v6 offset:15360
    ds_read_b128 v[56:59], v6 offset:9216
    ds_read_b128 v[60:63], v6 offset:10240
    buffer_load_dwordx2 v[20:21], v11, s[4:7], s38 offen sc1
    buffer_load_dwordx2 v[22:23], v11, s[4:7], s38 offen offset:512 sc1
    s_waitcnt vmcnt(4)
    v_mfma_f32_16x16x16_bf16 v[80:83], v[108:109], v[16:17], v[100:103]
    v_and_b32 v3, 1, v108
    v_cmp_ne_u32 vcc, s41, v3
    s_nop 5
    v_cvt_pk_bf16_f32 v64, v80, v81
    v_cvt_pk_bf16_f32 v65, v82, v83
    s_cbranch_vccnz mega_kernel_rf_w3_xslow
    s_waitcnt vmcnt(3)
    v_mfma_f32_16x16x16_bf16 v[84:87], v[110:111], v[16:17], v[104:107]
    v_and_b32 v3, 1, v110
    v_cmp_ne_u32 vcc, s41, v3
    s_nop 5
    v_cvt_pk_bf16_f32 v66, v84, v85
    v_cvt_pk_bf16_f32 v67, v86, v87
    ds_write_b128 v6, v[64:67] offset:23552
    s_cbranch_vccnz mega_kernel_rf_w3_xslow
mega_kernel_rf_w3_xok:
    s_cmp_eq_u32 s21, 63
    s_cbranch_scc1 mega_kernel_rf_w3_last
    buffer_load_dwordx2 v[116:117], v11, s[4:7], s40 offen sc1
    s_waitcnt lgkmcnt(1)
    v_mfma_f32_16x16x32_bf16 v[80:83], v[32:35], v[64:67], 0
    s_waitcnt lgkmcnt(0)
    s_barrier
    ds_read_b128 v[68:71], v6 offset:18432
    ds_read_b128 v[72:75], v6 offset:13312
    ds_read_b128 v[76:79], v6 offset:8192
    v_mfma_f32_16x16x32_bf16 v[84:87], v[36:39], v[64:67], 0
    v_mfma_f32_16x16x32_bf16 v[88:91], v[64:67], v[64:67], 0
    buffer_load_dwordx2 v[20:21], v11, s[4:7], s40 offen sc1
    s_waitcnt lgkmcnt(2)
    v_mfma_f32_16x16x32_bf16 v[80:83], v[40:43], v[68:71], v[80:83]
    s_waitcnt lgkmcnt(1)
    v_mfma_f32_16x16x32_bf16 v[80:83], v[48:51], v[72:75], v[80:83]
    s_waitcnt lgkmcnt(0)
    v_mfma_f32_16x16x32_bf16 v[80:83], v[56:59], v[76:79], v[80:83]
    v_mfma_f32_16x16x32_bf16 v[84:87], v[44:47], v[68:71], v[84:87]
    buffer_store_dwordx4 v[64:67], v10, s[4:7], s45 offen offset:192 sc1
    v_mfma_f32_16x16x32_bf16 v[84:87], v[52:55], v[72:75], v[84:87]
    v_mfma_f32_16x16x32_bf16 v[84:87], v[60:63], v[76:79], v[84:87]
    v_mfma_f32_16x16x32_bf16 v[88:91], v[68:71], v[68:71], v[88:91]
    v_mfma_f32_16x16x32_bf16 v[88:91], v[72:75], v[72:75], v[88:91]
    buffer_store_dwordx2 v[18:19], v11, s[4:7], s51 offen offset:3584 sc1
    v_mfma_f32_16x16x32_bf16 v[88:91], v[76:79], v[76:79], v[88:91]
    v_mfma_f32_32x32x4_2b_bf16 v[32:63], v[14:15], v[14:15], 0
    s_nop 0
    v_max3_f32 v4, v80, v81, v82
    s_nop 1
    v_max3_f32 v4, v4, v83, v84
    v_max3_f32 v4, v4, v85, v86
    v_max_f32 v4, v4, v87
    v_max3_f32 v90, v4, v88, v89
    v_max3_f32 v4, v4, v88, v89
    s_nop 1
    v_permlane16_swap_b32 v4, v90
    v_max_f32 v4, v4, v90
    v_max_f32 v90, v4, v90
    s_nop 1
    v_permlane32_swap_b32 v4, v90
    v_max_f32 v4, v4, v90
    v_mul_f32 v4, s34, v4
    v_pk_fma_f32 v[80:81], v[80:81], s[34:35], v[4:5] op_sel_hi:[1,0,0] neg_lo:[0,0,1] neg_hi:[0,0,1]
    v_pk_fma_f32 v[82:83], v[82:83], s[34:35], v[4:5] op_sel_hi:[1,0,0] neg_lo:[0,0,1] neg_hi:[0,0,1]
    v_pk_fma_f32 v[84:85], v[84:85], s[34:35], v[4:5] op_sel_hi:[1,0,0] neg_lo:[0,0,1] neg_hi:[0,0,1]
    v_pk_fma_f32 v[86:87], v[86:87], s[34:35], v[4:5] op_sel_hi:[1,0,0] neg_lo:[0,0,1] neg_hi:[0,0,1]
    v_pk_fma_f32 v[88:89], v[88:89], s[34:35], v[4:5] op_sel_hi:[1,0,0] neg_lo:[0,0,1] neg_hi:[0,0,1]
    v_exp_f32 v80, v80
    v_exp_f32 v81, v81
    v_exp_f32 v82, v82
    v_cvt_pk_bf16_f32 v68, v80, v81
    v_exp_f32 v83, v83
    v_exp_f32 v84, v84
    v_cvt_pk_bf16_f32 v69, v82, v83
    v_exp_f32 v85, v85
    v_exp_f32 v86, v86
    v_cvt_pk_bf16_f32 v70, v84, v85
    v_exp_f32 v87, v87
    v_exp_f32 v88, v88
    v_cvt_pk_bf16_f32 v71, v86, v87
    v_exp_f32 v89, v89
    s_waitcnt vmcnt(3)
    v_mfma_f32_16x16x32_bf16 v[76:79], v[28:31], v[68:71], 0
    v_and_b32 v3, 1, v116
    v_cvt_pk_bf16_f32 v72, v88, v89
    v_mfma_f32_16x16x32_bf16 v[100:103], v[120:123], v[68:71], 0
    v_cmp_ne_u32 vcc, s41, v3
    v_cvt_pk_bf16_f32 v73, v88, v89
    v_mfma_f32_16x16x32_bf16 v[104:107], v[124:127], v[68:71], 0
    v_mov_b32 v113, v116
    v_mov_b32 v115, v117
    v_mfma_f32_16x16x16_bf16 v[76:79], v[92:93], v[72:73], v[76:79]
    s_cbranch_vccnz mega_kernel_rf_w3_pv0
mega_kernel_rf_w3_pv2:
    v_mfma_f32_16x16x16_bf16 v[100:103], v[112:113], v[72:73], v[100:103]
    v_mfma_f32_16x16x16_bf16 v[104:107], v[114:115], v[72:73], v[104:107]
    buffer_load_dwordx4 v[120:123], v1, s[4:7], s44 offen
    buffer_load_dwordx4 v[124:127], v1, s[4:7], s44 offen offset:1024
    s_nop 2
    v_rcp_f32 v76, v76
    s_mov_b64 exec, s[28:29]
    v_pk_mul_f32 v[100:101], v[100:101], v[76:77] op_sel_hi:[1,0]
    v_pk_mul_f32 v[102:103], v[102:103], v[76:77] op_sel_hi:[1,0]
    v_pk_mul_f32 v[104:105], v[104:105], v[76:77] op_sel_hi:[1,0]
    v_pk_mul_f32 v[106:107], v[106:107], v[76:77] op_sel_hi:[1,0]
    v_cvt_pk_bf16_f32 v84, v100, v101
    v_cvt_pk_bf16_f32 v85, v102, v103
    v_cvt_pk_bf16_f32 v86, v104, v105
    v_cvt_pk_bf16_f32 v87, v106, v107
    ds_write_b128 v6, v[84:87] offset:29696
    s_mov_b64 exec, -1
    s_waitcnt lgkmcnt(0)
    s_barrier
    ds_read_b128 v[68:71], v6 offset:28672
    ds_read_b128 v[72:75], v6 offset:29696
    s_waitcnt lgkmcnt(1)
    v_smfmac_f32_16x16x64_bf16 v[32:35], v[68:71], v[128:135], v2
    s_add_u32 s21, s21, 1
    s_xor_b32 s38, s38, 1048576
    s_xor_b32 s37, s37, 1048576
    s_waitcnt lgkmcnt(0)
    v_smfmac_f32_16x16x64_bf16 v[32:35], v[72:75], v[136:143], v2
    s_xor_b32 s40, s40, 1048576
    s_xor_b32 s39, s39, 1048576
    s_lshr_b32 s41, s21, 1
    v_smfmac_f32_16x16x64_bf16 v[36:39], v[68:71], v[144:151], v2
    s_and_b32 s41, s41, 1
    s_xor_b32 s41, s41, 1
    s_xor_b32 s35, s35, 16384
    v_smfmac_f32_16x16x64_bf16 v[36:39], v[72:75], v[152:159], v2
    v_add_f32 v32, v32, v34
    s_xor_b32 s36, s36, 16384
    s_add_u32 s43, s43, 262144
    s_add_u32 s44, s44, 262144
    v_smfmac_f32_16x16x64_bf16 v[40:43], v[68:71], v[160:167], v2
    v_add_f32 v33, v33, v35
    v_smfmac_f32_16x16x64_bf16 v[40:43], v[72:75], v[168:175], v2
    v_cvt_pk_bf16_f32 v32, v32, v33
    v_smfmac_f32_16x16x64_bf16 v[44:47], v[68:71], v[176:183], v2
    v_and_or_b32 v32, v32, -2, s42
    v_smfmac_f32_16x16x64_bf16 v[44:47], v[72:75], v[184:191], v2
    v_add_f32 v36, v36, v38
    v_smfmac_f32_16x16x64_bf16 v[48:51], v[68:71], v[192:199], v2
    v_add_f32 v37, v37, v39
    v_smfmac_f32_16x16x64_bf16 v[48:51], v[72:75], v[200:207], v2
    v_cvt_pk_bf16_f32 v33, v36, v37
    v_smfmac_f32_16x16x64_bf16 v[52:55], v[68:71], v[208:215], v2
    v_add_f32 v40, v40, v42
    v_smfmac_f32_16x16x64_bf16 v[52:55], v[72:75], v[216:223], v2
    v_add_f32 v41, v41, v43
    v_smfmac_f32_16x16x64_bf16 v[56:59], v[68:71], v[224:231], v2
    v_cvt_pk_bf16_f32 v34, v40, v41
    v_smfmac_f32_16x16x64_bf16 v[56:59], v[72:75], v[232:239], v2
    v_add_f32 v44, v44, v46
    v_smfmac_f32_16x16x64_bf16 v[60:63], v[68:71], v[240:247], v2
    v_add_f32 v45, v45, v47
    v_smfmac_f32_16x16x64_bf16 v[60:63], v[72:75], v[248:255], v2
    v_cvt_pk_bf16_f32 v35, v44, v45
    buffer_store_dwordx4 v[32:35], v8, s[4:7], s46 offen
    v_pk_add_f32 v[48:49], v[48:49], v[50:51]
    v_cvt_pk_bf16_f32 v48, v48, v49
    v_and_or_b32 v48, v48, -2, s42
    v_pk_add_f32 v[52:53], v[52:53], v[54:55]
    v_cvt_pk_bf16_f32 v49, v52, v53
    v_pk_add_f32 v[56:57], v[56:57], v[58:59]
    v_cvt_pk_bf16_f32 v50, v56, v57
    v_pk_add_f32 v[60:61], v[60:61], v[62:63]
    v_cvt_pk_bf16_f32 v51, v60, v61
    buffer_store_dwordx4 v[48:51], v8, s[4:7], s61 offen
    s_add_u32 s45, s45, 262144
    s_add_u32 s51, s51, 262144
    v_mfma_f32_32x32x8_bf16 v[96:111], v[14:15], v[14:15], 0
    v_mfma_f32_16x16x16_bf16 v[112:115], v[14:15], v[14:15], 0
    v_mfma_f32_16x16x16_bf16 v[116:119], v[14:15], v[14:15], 0
    ds_read_b128 v[64:67], v1 offset:12288
    ds_read_b128 v[68:71], v1 offset:13312
    ds_read_b128 v[72:75], v1 offset:14336
    ds_read_b128 v[76:79], v1 offset:15360
    ds_read_b128 v[80:83], v1 offset:28672
    ds_read_b128 v[84:87], v1 offset:29696
    ds_read_b128 v[88:91], v1 offset:30720
    ds_read_b128 v[92:95], v1 offset:31744
    s_add_u32 s22, s21, 2
    s_cmp_gt_u32 s50, s22
    s_cbranch_scc1 mega_kernel_rf_w3_kvs
    v_readlane_b32 s50, v12, 0
    v_readlane_b32 s22, v12, 2
    v_readlane_b32 s23, v12, 1
    v_readlane_b32 s24, v12, 3
    s_nop 3
    s_min_u32 s50, s50, s22
    s_min_u32 s23, s23, s24
    s_lshl_b32 s50, s50, 1
    s_lshl_b32 s23, s23, 1
    s_add_u32 s23, s23, 1
    s_min_u32 s50, s50, s23
mega_kernel_rf_kvb1:
    s_add_u32 s22, s21, 1
    s_min_u32 s22, s22, 63
    s_cmp_gt_u32 s50, s22
    s_cbranch_scc1 mega_kernel_rf_kvd1
    buffer_load_dword v12, v7, s[4:7], 0 offen sc1
    s_waitcnt vmcnt(0)
    v_readlane_b32 s50, v12, 0
    v_readlane_b32 s22, v12, 2
    v_readlane_b32 s23, v12, 1
    v_readlane_b32 s24, v12, 3
    s_nop 3
    s_min_u32 s50, s50, s22
    s_min_u32 s23, s23, s24
    s_lshl_b32 s50, s50, 1
    s_lshl_b32 s23, s23, 1
    s_add_u32 s23, s23, 1
    s_min_u32 s50, s50, s23
    s_branch mega_kernel_rf_kvb1
mega_kernel_rf_kvd1:
mega_kernel_rf_w3_kvs:
    v_mov_b32 v58, -1
    v_mov_b32 v59, -1
    s_waitcnt vmcnt(0)
mega_kernel_rf_w3_pc:
    buffer_load_dword v36, v13, s[4:7], s25 offen offset:0 sc1
    buffer_load_dword v37, v13, s[4:7], s25 offen offset:256 sc1
    buffer_load_dword v38, v13, s[4:7], s25 offen offset:512 sc1
    buffer_load_dword v39, v13, s[4:7], s25 offen offset:768 sc1
    buffer_load_dword v40, v13, s[4:7], s25 offen offset:1024 sc1
    buffer_load_dword v41, v13, s[4:7], s25 offen offset:1280 sc1
    buffer_load_dword v42, v13, s[4:7], s25 offen offset:1536 sc1
    buffer_load_dword v43, v13, s[4:7], s25 offen offset:1792 sc1
    s_waitcnt vmcnt(4)
    v_mfma_f32_16x16x32_bf16 v[52:55], v[36:39], v[24:27], 0
    v_bitop3_b32 v3, s42, v36, v37 bitop3:0x7e
    v_bitop3_b32 v4, s42, v38, v39 bitop3:0x7e
    s_waitcnt vmcnt(2)
    v_or_b32 v3, v3, v4
    v_bitop3_b32 v4, s42, v40, v41 bitop3:0x7e
    s_waitcnt vmcnt(0)
    v_mfma_f32_16x16x32_bf16 v[52:55], v[40:43], v[24:27], v[52:55]
    v_bitop3_b32 v56, s42, v42, v43 bitop3:0x7e
    v_or3_b32 v3, v3, v4, v56
    v_and_b32 v3, v0, v3
    v_cmp_ne_u32 vcc, 0, v3
    s_nop 3
    v_cvt_pk_bf16_f32 v56, v52, v53
    v_cvt_pk_bf16_f32 v57, v54, v55
    v_min_u32 v56, -2, v56
    s_cbranch_vccnz mega_kernel_rf_w3_pc
    s_mov_b64 exec, s[26:27]
    buffer_store_dwordx2 v[56:57], v9, s[4:7], s35 offen offset:768
    buffer_store_dwordx2 v[58:59], v9, s[4:7], s36 offen offset:768
    s_mov_b64 exec, -1
    s_xor_b32 s42, s42, 1
    s_branch mega_kernel_rf_w3_loop
mega_kernel_rf_w3_last:
    buffer_store_dwordx4 v[64:67], v10, s[4:7], s45 offen offset:192 sc1
    buffer_store_dwordx2 v[18:19], v11, s[4:7], s51 offen offset:3584 sc1
    s_branch mega_kernel_rf_end
mega_kernel_rf_w3_pafail:
    s_nop 7
    v_mov_b32 v96, 0
    v_mov_b32 v97, 0
    v_mov_b32 v98, 0
    v_mov_b32 v99, 0
    v_mov_b32 v100, 0
    v_mov_b32 v101, 0
    v_mov_b32 v102, 0
    v_mov_b32 v103, 0
    v_mov_b32 v104, 0
    v_mov_b32 v105, 0
    v_mov_b32 v106, 0
    v_mov_b32 v107, 0
    s_branch mega_kernel_rf_w3_pa
mega_kernel_rf_w3_xslow:
    buffer_load_dwordx2 v[108:109], v11, s[4:7], s38 offen sc1
    buffer_load_dwordx2 v[110:111], v11, s[4:7], s38 offen offset:512 sc1
    s_waitcnt vmcnt(2)
    v_bitop3_b32 v3, s41, v20, v22 bitop3:0x7e
    v_mfma_f32_16x16x16_bf16 v[80:83], v[20:21], v[16:17], v[100:103]
    v_and_b32 v3, 1, v3
    v_mfma_f32_16x16x16_bf16 v[84:87], v[22:23], v[16:17], v[104:107]
    v_cmp_ne_u32 vcc, 0, v3
    s_cbranch_vccz mega_kernel_rf_w3_xgot
    buffer_load_dwordx2 v[20:21], v11, s[4:7], s38 offen sc1
    buffer_load_dwordx2 v[22:23], v11, s[4:7], s38 offen offset:512 sc1
    s_waitcnt vmcnt(2)
    v_bitop3_b32 v3, s41, v108, v110 bitop3:0x7e
    v_mfma_f32_16x16x16_bf16 v[80:83], v[108:109], v[16:17], v[100:103]
    v_and_b32 v3, 1, v3
    v_mfma_f32_16x16x16_bf16 v[84:87], v[110:111], v[16:17], v[104:107]
    v_cmp_ne_u32 vcc, 0, v3
    s_cbranch_vccz mega_kernel_rf_w3_xgot
    s_branch mega_kernel_rf_w3_xslow
mega_kernel_rf_w3_xgot:
    s_nop 3
    v_cvt_pk_bf16_f32 v64, v80, v81
    v_cvt_pk_bf16_f32 v65, v82, v83
    v_cvt_pk_bf16_f32 v66, v84, v85
    v_cvt_pk_bf16_f32 v67, v86, v87
    ds_write_b128 v6, v[64:67] offset:23552
    s_branch mega_kernel_rf_w3_xok
mega_kernel_rf_w3_pv0:
    s_waitcnt vmcnt(2)
    s_branch mega_kernel_rf_w3_pv1
mega_kernel_rf_w3_pv:
    buffer_load_dwordx2 v[20:21], v11, s[4:7], s40 offen sc1
    s_waitcnt vmcnt(0)
mega_kernel_rf_w3_pv1:
    v_and_b32 v3, 1, v20
    v_cmp_ne_u32 vcc, s41, v3
    v_mov_b32 v113, v20
    v_mov_b32 v115, v21
    s_cbranch_vccnz mega_kernel_rf_w3_pv
    s_branch mega_kernel_rf_w3_pv2
mega_kernel_rf_end:
    s_mov_b64 exec, -1
    v_mov_b32 v3, 64
    s_waitcnt vmcnt(0)
    s_barrier
    s_cmp_lg_u32 s20, 0
    s_cbranch_scc1 mega_kernel_rf_end2
    buffer_store_dword v3, v7, s[4:7], 0 offen sc1
mega_kernel_rf_end2:
    s_waitcnt vmcnt(0)
    s_endpgm
mega_kernel_recs:
    s_load_dwordx2 s[4:5], s[0:1], 96
    s_load_dwordx2 s[12:13], s[0:1], 88
    s_load_dwordx2 s[50:51], s[0:1], 16
    s_load_dwordx2 s[52:53], s[0:1], 24
    s_load_dwordx2 s[54:55], s[0:1], 32
    s_load_dwordx2 s[56:57], s[0:1], 40
    s_load_dwordx2 s[58:59], s[0:1], 8
    v_lshrrev_b32 v3, 6, v0
    v_and_b32 v40, 63, v0
    v_readfirstlane_b32 s20, v3
    v_lshrrev_b32 v41, 4, v40
    v_and_b32 v42, 15, v40
    v_lshlrev_b32 v1, 4, v40
    s_mov_b32 s49, 0
    s_waitcnt lgkmcnt(0)
    s_mov_b32 s6, 268435456
    s_mov_b32 s7, 0x00020000
    s_mov_b32 s14, 256
    s_mov_b32 s15, 0x00020000
    s_mov_b32 s10, 8388608
    s_mov_b32 s11, 0x00020000
    s_mov_b32 s26, 0x00030003
    s_mov_b32 s27, 0x00030003
    s_mov_b32 s28, 0xcccccccc
    s_mov_b32 s29, 0xcccccccc
    s_mov_b32 s32, 0x33333333
    s_mov_b32 s33, 0x33333333
    s_mov_b32 s34, 0x3e0293ee
    s_lshl_b32 s22, s20, 2
    v_xor_b32 v3, s22, v42
    v_lshlrev_b32 v3, 4, v3
    v_lshl_add_u32 v4, v41, 4, s20
    v_lshl_add_u32 v44, v4, 13, v3
    s_lshl_b32 s22, s30, 22
    s_lshl_b32 s23, s31, 8
    s_add_u32 s22, s22, s23
    v_add_u32 v44, s22, v44
    s_lshr_b32 s22, s20, 1
    s_lshl_b32 s22, s22, 5
    s_and_b32 s23, s20, 1
    s_lshl_b32 s23, s23, 2
    s_add_u32 s22, s22, s23
    s_lshl_b32 s23, s31, 7
    s_add_u32 s22, s22, s23
    v_add_u32 v4, s22, v41
    v_lshl_add_u32 v45, v4, 11, v3
    s_lshl_b32 s22, s30, 10
    v_add_u32 v45, s22, v45
    s_lshl_b32 s48, s20, 10
    s_mov_b32 s8, s50
    s_mov_b32 s9, s51
    s_add_u32 m0, s48, 0
    s_mov_b32 s22, 0
    buffer_load_dwordx4 v44, s[8:11], s22 offen  lds
    s_add_u32 m0, s48, 4096
    s_mov_b32 s22, 32768
    buffer_load_dwordx4 v44, s[8:11], s22 offen  lds
    s_add_u32 m0, s48, 8192
    s_mov_b32 s22, 65536
    buffer_load_dwordx4 v44, s[8:11], s22 offen  lds
    s_add_u32 m0, s48, 12288
    s_mov_b32 s22, 98304
    buffer_load_dwordx4 v44, s[8:11], s22 offen  lds
    s_add_u32 m0, s48, 16384
    s_mov_b32 s22, 524288
    buffer_load_dwordx4 v44, s[8:11], s22 offen  lds
    s_add_u32 m0, s48, 20480
    s_mov_b32 s22, 557056
    buffer_load_dwordx4 v44, s[8:11], s22 offen  lds
    s_add_u32 m0, s48, 24576
    s_mov_b32 s22, 589824
    buffer_load_dwordx4 v44, s[8:11], s22 offen  lds
    s_add_u32 m0, s48, 28672
    s_mov_b32 s22, 622592
    buffer_load_dwordx4 v44, s[8:11], s22 offen  lds
    s_add_u32 m0, s48, 32768
    s_mov_b32 s22, 1048576
    buffer_load_dwordx4 v44, s[8:11], s22 offen  lds
    s_add_u32 m0, s48, 36864
    s_mov_b32 s22, 1081344
    buffer_load_dwordx4 v44, s[8:11], s22 offen  lds
    s_add_u32 m0, s48, 40960
    s_mov_b32 s22, 1114112
    buffer_load_dwordx4 v44, s[8:11], s22 offen  lds
    s_add_u32 m0, s48, 45056
    s_mov_b32 s22, 1146880
    buffer_load_dwordx4 v44, s[8:11], s22 offen  lds
    s_add_u32 m0, s48, 49152
    s_mov_b32 s22, 1572864
    buffer_load_dwordx4 v44, s[8:11], s22 offen  lds
    s_add_u32 m0, s48, 53248
    s_mov_b32 s22, 1605632
    buffer_load_dwordx4 v44, s[8:11], s22 offen  lds
    s_add_u32 m0, s48, 57344
    s_mov_b32 s22, 1638400
    buffer_load_dwordx4 v44, s[8:11], s22 offen  lds
    s_add_u32 m0, s48, 61440
    s_mov_b32 s22, 1671168
    buffer_load_dwordx4 v44, s[8:11], s22 offen  lds
    s_add_u32 m0, s48, 65536
    s_mov_b32 s22, 2097152
    buffer_load_dwordx4 v44, s[8:11], s22 offen  lds
    s_add_u32 m0, s48, 69632
    s_mov_b32 s22, 2129920
    buffer_load_dwordx4 v44, s[8:11], s22 offen  lds
    s_add_u32 m0, s48, 73728
    s_mov_b32 s22, 2162688
    buffer_load_dwordx4 v44, s[8:11], s22 offen  lds
    s_add_u32 m0, s48, 77824
    s_mov_b32 s22, 2195456
    buffer_load_dwordx4 v44, s[8:11], s22 offen  lds
    s_add_u32 m0, s48, 81920
    s_mov_b32 s22, 2621440
    buffer_load_dwordx4 v44, s[8:11], s22 offen  lds
    s_add_u32 m0, s48, 86016
    s_mov_b32 s22, 2654208
    buffer_load_dwordx4 v44, s[8:11], s22 offen  lds
    s_add_u32 m0, s48, 90112
    s_mov_b32 s22, 2686976
    buffer_load_dwordx4 v44, s[8:11], s22 offen  lds
    s_add_u32 m0, s48, 94208
    s_mov_b32 s22, 2719744
    buffer_load_dwordx4 v44, s[8:11], s22 offen  lds
    s_add_u32 m0, s48, 98304
    s_mov_b32 s22, 3145728
    buffer_load_dwordx4 v44, s[8:11], s22 offen  lds
    s_add_u32 m0, s48, 102400
    s_mov_b32 s22, 3178496
    buffer_load_dwordx4 v44, s[8:11], s22 offen  lds
    s_add_u32 m0, s48, 106496
    s_mov_b32 s22, 3211264
    buffer_load_dwordx4 v44, s[8:11], s22 offen  lds
    s_add_u32 m0, s48, 110592
    s_mov_b32 s22, 3244032
    buffer_load_dwordx4 v44, s[8:11], s22 offen  lds
    s_add_u32 m0, s48, 114688
    s_mov_b32 s22, 3670016
    buffer_load_dwordx4 v44, s[8:11], s22 offen  lds
    s_add_u32 m0, s48, 118784
    s_mov_b32 s22, 3702784
    buffer_load_dwordx4 v44, s[8:11], s22 offen  lds
    s_add_u32 m0, s48, 122880
    s_mov_b32 s22, 3735552
    buffer_load_dwordx4 v44, s[8:11], s22 offen  lds
    s_add_u32 m0, s48, 126976
    s_mov_b32 s22, 3768320
    buffer_load_dwordx4 v44, s[8:11], s22 offen  lds
    s_lshl_b32 s22, s30, 5
    s_add_u32 s22, s22, s31
    s_lshl_b32 s38, s22, 14
    s_xor_b32 s22, s22, 32
    s_lshl_b32 s37, s22, 14
    s_add_u32 s38, s38, 67108864
    s_add_u32 s37, s37, 67108864
    s_lshl_b32 s46, s30, 19
    s_add_u32 s46, s46, 70254592
    s_mul_i32 s22, s31, 8448
    s_add_u32 s47, s46, s22
    s_mul_i32 s22, s20, 67584
    s_add_u32 s46, s46, s22
    s_lshl_b32 s22, s31, 6
    s_add_u32 s46, s46, s22
    s_add_u32 s61, s46, 33792
    s_mul_i32 s22, s20, 2048
    s_add_u32 s25, s47, s22
    s_lshl_b32 s35, s30, 13
    s_add_u32 s35, s35, 69206016
    v_lshrrev_b32 v53, 2, v42
    v_lshlrev_b32 v53, 1, v53
    v_and_b32 v54, 1, v42
    v_add_u32 v55, v53, v54
    v_mov_b32 v14, 0
    v_mov_b32 v15, 0
    v_mov_b32 v2, 0x4444
    v_mov_b32 v3, 0xeeee
    v_cndmask_b32 v2, v2, v3, s[28:29]
    s_lshl_b32 s22, s20, 12
    v_add_u32 v32, s22, v1
    v_add_u32 v33, 0x10000, v32
    v_add_u32 v5, 0x10000, v1
    v_add_u32 v6, 131072, v1
    v_and_b32 v3, 3, v42
    v_bfe_u32 v43, v40, 1, 1
    v_lshlrev_b32 v7, 13, v43
    v_and_b32 v43, 1, v40
    v_lshl_add_u32 v7, v43, 7, v7
    s_lshl_b32 s22, s31, 8
    s_add_u32 s23, s22, 71311360
    v_add_u32 v7, s23, v7
    s_cmp_lg_u32 s20, 0
    s_cbranch_scc1 mega_kernel_rs_flk
    s_lshl_b32 s23, s30, 7
    s_add_u32 s22, s22, s23
    s_add_u32 s22, s22, 71327744
    v_bfrev_b32 v7, 1
    v_writelane_b32 v7, s22, 0
mega_kernel_rs_flk:
    v_lshlrev_b32 v11, 3, v40
    v_lshlrev_b32 v10, 8, v55
    v_lshl_add_u32 v10, v41, 4, v10
    v_mul_u32_u24 v8, 8448, v41
    v_lshl_add_u32 v8, v3, 4, v8
    v_lshrrev_b32 v4, 2, v42
    v_mul_u32_u24 v4, 2048, v4
    v_add_u32 v8, v4, v8
    v_lshrrev_b32 v9, 1, v41
    v_lshlrev_b32 v9, 5, v9
    v_and_b32 v4, 1, v42
    v_lshl_add_u32 v9, v4, 4, v9
    v_and_b32 v4, 1, v41
    v_lshl_add_u32 v9, v4, 3, v9
    s_lshr_b32 s22, s31, 2
    s_lshl_b32 s22, s22, 10
    s_and_b32 s23, s31, 3
    s_lshl_b32 s23, s23, 6
    s_add_u32 s22, s22, s23
    v_add_u32 v9, s22, v9
    v_lshrrev_b32 v4, 2, v42
    v_lshlrev_b32 v12, 8, v4
    v_lshl_add_u32 v12, v41, 6, v12
    v_lshl_add_u32 v12, v3, 4, v12
    v_lshlrev_b32 v13, 6, v41
    v_lshl_add_u32 v13, v42, 2, v13
    v_cmp_eq_u32 vcc, 0, v3
    v_mov_b32 v28, 0x3f803f80
    v_mov_b32 v29, 0x3f803f80
    v_cndmask_b32 v34, 0, 1, vcc
    v_mov_b32 v30, 0x3f803f80
    v_mov_b32 v31, 0x3f803f80
    v_and_b32 v49, 1, v42
    v_lshlrev_b32 v49, 4, v49
    v_mov_b32 v50, 0x3f80
    v_lshlrev_b32 v50, v49, v50
    v_lshrrev_b32 v51, 2, v42
    v_cmp_eq_u32 vcc, v51, v41
    v_mov_b32 v24, v50
    v_cndmask_b32 v52, 0, v50, s[28:29]
    v_cndmask_b32 v53, 0, v50, s[32:33]
    v_cndmask_b32 v16, 0, v52, vcc
    v_cndmask_b32 v17, 0, v53, vcc
    v_mov_b32 v25, v50
    v_mov_b32 v26, v50
    v_mov_b32 v27, v50
    v_bfe_u32 v60, v40, 3, 1
    v_bfe_u32 v49, v40, 2, 1
    v_and_b32 v50, 1, v41
    v_lshrrev_b32 v51, 1, v41
    v_lshlrev_b32 v52, 3, v60
    v_lshl_add_u32 v52, v50, 2, v52
    v_lshl_add_u32 v53, v51, 4, v52
    v_add_u32 v53, v53, v49
    v_and_b32 v54, 3, v40
    s_lshl_b32 s22, s20, 2
    v_add_u32 v55, s22, v54
    v_xor_b32 v55, v55, v52
    v_lshlrev_b32 v55, 4, v55
    v_lshl_add_u32 v46, v53, 8, v55
    v_lshlrev_b32 v55, 4, v52
    v_lshl_add_u32 v55, v54, 3, v55
    v_lshl_add_u32 v47, v53, 8, v55
    s_waitcnt vmcnt(28)
    s_barrier
    v_add_u32 v48, 0, v46
    ds_read_b64_tr_b16 a[0:1], v48 offset:0
    ds_read_b64_tr_b16 a[2:3], v48 offset:512
    ds_read_b64_tr_b16 a[4:5], v48 offset:8192
    ds_read_b64_tr_b16 a[6:7], v48 offset:8704
    ds_read_b64_tr_b16 a[8:9], v48 offset:8
    ds_read_b64_tr_b16 a[10:11], v48 offset:520
    ds_read_b64_tr_b16 a[12:13], v48 offset:8200
    ds_read_b64_tr_b16 a[14:15], v48 offset:8712
    s_waitcnt lgkmcnt(0)
    s_barrier
    s_mov_b32 s8, s52
    s_mov_b32 s9, s53
    s_add_u32 m0, s48, 0
    s_mov_b32 s22, 0
    buffer_load_dwordx4 v44, s[8:11], s22 offen  lds
    s_add_u32 m0, s48, 4096
    s_mov_b32 s22, 32768
    buffer_load_dwordx4 v44, s[8:11], s22 offen  lds
    s_add_u32 m0, s48, 8192
    s_mov_b32 s22, 65536
    buffer_load_dwordx4 v44, s[8:11], s22 offen  lds
    s_add_u32 m0, s48, 12288
    s_mov_b32 s22, 98304
    buffer_load_dwordx4 v44, s[8:11], s22 offen  lds
    s_waitcnt vmcnt(28)
    s_barrier
    v_add_u32 v48, 16384, v46
    ds_read_b64_tr_b16 a[16:17], v48 offset:0
    ds_read_b64_tr_b16 a[18:19], v48 offset:512
    ds_read_b64_tr_b16 a[20:21], v48 offset:8192
    ds_read_b64_tr_b16 a[22:23], v48 offset:8704
    ds_read_b64_tr_b16 a[24:25], v48 offset:8
    ds_read_b64_tr_b16 a[26:27], v48 offset:520
    ds_read_b64_tr_b16 a[28:29], v48 offset:8200
    ds_read_b64_tr_b16 a[30:31], v48 offset:8712
    s_waitcnt lgkmcnt(0)
    s_barrier
    s_add_u32 m0, s48, 16384
    s_mov_b32 s22, 524288
    buffer_load_dwordx4 v44, s[8:11], s22 offen  lds
    s_add_u32 m0, s48, 20480
    s_mov_b32 s22, 557056
    buffer_load_dwordx4 v44, s[8:11], s22 offen  lds
    s_add_u32 m0, s48, 24576
    s_mov_b32 s22, 589824
    buffer_load_dwordx4 v44, s[8:11], s22 offen  lds
    s_add_u32 m0, s48, 28672
    s_mov_b32 s22, 622592
    buffer_load_dwordx4 v44, s[8:11], s22 offen  lds
    s_waitcnt vmcnt(28)
    s_barrier
    v_add_u32 v48, 32768, v46
    ds_read_b64_tr_b16 a[32:33], v48 offset:0
    ds_read_b64_tr_b16 a[34:35], v48 offset:512
    ds_read_b64_tr_b16 a[36:37], v48 offset:8192
    ds_read_b64_tr_b16 a[38:39], v48 offset:8704
    ds_read_b64_tr_b16 a[40:41], v48 offset:8
    ds_read_b64_tr_b16 a[42:43], v48 offset:520
    ds_read_b64_tr_b16 a[44:45], v48 offset:8200
    ds_read_b64_tr_b16 a[46:47], v48 offset:8712
    s_waitcnt lgkmcnt(0)
    s_barrier
    s_add_u32 m0, s48, 32768
    s_mov_b32 s22, 1048576
    buffer_load_dwordx4 v44, s[8:11], s22 offen  lds
    s_add_u32 m0, s48, 36864
    s_mov_b32 s22, 1081344
    buffer_load_dwordx4 v44, s[8:11], s22 offen  lds
    s_add_u32 m0, s48, 40960
    s_mov_b32 s22, 1114112
    buffer_load_dwordx4 v44, s[8:11], s22 offen  lds
    s_add_u32 m0, s48, 45056
    s_mov_b32 s22, 1146880
    buffer_load_dwordx4 v44, s[8:11], s22 offen  lds
    s_waitcnt vmcnt(28)
    s_barrier
    v_add_u32 v48, 49152, v46
    ds_read_b64_tr_b16 a[48:49], v48 offset:0
    ds_read_b64_tr_b16 a[50:51], v48 offset:512
    ds_read_b64_tr_b16 a[52:53], v48 offset:8192
    ds_read_b64_tr_b16 a[54:55], v48 offset:8704
    ds_read_b64_tr_b16 a[56:57], v48 offset:8
    ds_read_b64_tr_b16 a[58:59], v48 offset:520
    ds_read_b64_tr_b16 a[60:61], v48 offset:8200
    ds_read_b64_tr_b16 a[62:63], v48 offset:8712
    s_waitcnt lgkmcnt(0)
    s_barrier
    s_add_u32 m0, s48, 49152
    s_mov_b32 s22, 1572864
    buffer_load_dwordx4 v44, s[8:11], s22 offen  lds
    s_add_u32 m0, s48, 53248
    s_mov_b32 s22, 1605632
    buffer_load_dwordx4 v44, s[8:11], s22 offen  lds
    s_add_u32 m0, s48, 57344
    s_mov_b32 s22, 1638400
    buffer_load_dwordx4 v44, s[8:11], s22 offen  lds
    s_add_u32 m0, s48, 61440
    s_mov_b32 s22, 1671168
    buffer_load_dwordx4 v44, s[8:11], s22 offen  lds
    s_waitcnt vmcnt(28)
    s_barrier
    v_add_u32 v48, 65536, v46
    ds_read_b64_tr_b16 a[64:65], v48 offset:0
    ds_read_b64_tr_b16 a[66:67], v48 offset:512
    ds_read_b64_tr_b16 a[68:69], v48 offset:8192
    ds_read_b64_tr_b16 a[70:71], v48 offset:8704
    ds_read_b64_tr_b16 a[72:73], v48 offset:8
    ds_read_b64_tr_b16 a[74:75], v48 offset:520
    ds_read_b64_tr_b16 a[76:77], v48 offset:8200
    ds_read_b64_tr_b16 a[78:79], v48 offset:8712
    s_waitcnt lgkmcnt(0)
    s_barrier
    s_add_u32 m0, s48, 65536
    s_mov_b32 s22, 2097152
    buffer_load_dwordx4 v44, s[8:11], s22 offen  lds
    s_add_u32 m0, s48, 69632
    s_mov_b32 s22, 2129920
    buffer_load_dwordx4 v44, s[8:11], s22 offen  lds
    s_add_u32 m0, s48, 73728
    s_mov_b32 s22, 2162688
    buffer_load_dwordx4 v44, s[8:11], s22 offen  lds
    s_add_u32 m0, s48, 77824
    s_mov_b32 s22, 2195456
    buffer_load_dwordx4 v44, s[8:11], s22 offen  lds
    s_waitcnt vmcnt(28)
    s_barrier
    v_add_u32 v48, 81920, v46
    ds_read_b64_tr_b16 a[80:81], v48 offset:0
    ds_read_b64_tr_b16 a[82:83], v48 offset:512
    ds_read_b64_tr_b16 a[84:85], v48 offset:8192
    ds_read_b64_tr_b16 a[86:87], v48 offset:8704
    ds_read_b64_tr_b16 a[88:89], v48 offset:8
    ds_read_b64_tr_b16 a[90:91], v48 offset:520
    ds_read_b64_tr_b16 a[92:93], v48 offset:8200
    ds_read_b64_tr_b16 a[94:95], v48 offset:8712
    s_waitcnt lgkmcnt(0)
    s_barrier
    s_add_u32 m0, s48, 81920
    s_mov_b32 s22, 2621440
    buffer_load_dwordx4 v44, s[8:11], s22 offen  lds
    s_add_u32 m0, s48, 86016
    s_mov_b32 s22, 2654208
    buffer_load_dwordx4 v44, s[8:11], s22 offen  lds
    s_add_u32 m0, s48, 90112
    s_mov_b32 s22, 2686976
    buffer_load_dwordx4 v44, s[8:11], s22 offen  lds
    s_add_u32 m0, s48, 94208
    s_mov_b32 s22, 2719744
    buffer_load_dwordx4 v44, s[8:11], s22 offen  lds
    s_waitcnt vmcnt(28)
    s_barrier
    v_add_u32 v48, 98304, v46
    ds_read_b64_tr_b16 a[96:97], v48 offset:0
    ds_read_b64_tr_b16 a[98:99], v48 offset:512
    ds_read_b64_tr_b16 a[100:101], v48 offset:8192
    ds_read_b64_tr_b16 a[102:103], v48 offset:8704
    ds_read_b64_tr_b16 a[104:105], v48 offset:8
    ds_read_b64_tr_b16 a[106:107], v48 offset:520
    ds_read_b64_tr_b16 a[108:109], v48 offset:8200
    ds_read_b64_tr_b16 a[110:111], v48 offset:8712
    s_waitcnt lgkmcnt(0)
    s_barrier
    s_add_u32 m0, s48, 98304
    s_mov_b32 s22, 3145728
    buffer_load_dwordx4 v44, s[8:11], s22 offen  lds
    s_add_u32 m0, s48, 102400
    s_mov_b32 s22, 3178496
    buffer_load_dwordx4 v44, s[8:11], s22 offen  lds
    s_add_u32 m0, s48, 106496
    s_mov_b32 s22, 3211264
    buffer_load_dwordx4 v44, s[8:11], s22 offen  lds
    s_add_u32 m0, s48, 110592
    s_mov_b32 s22, 3244032
    buffer_load_dwordx4 v44, s[8:11], s22 offen  lds
    s_waitcnt vmcnt(28)
    s_barrier
    v_add_u32 v48, 114688, v46
    ds_read_b64_tr_b16 a[112:113], v48 offset:0
    ds_read_b64_tr_b16 a[114:115], v48 offset:512
    ds_read_b64_tr_b16 a[116:117], v48 offset:8192
    ds_read_b64_tr_b16 a[118:119], v48 offset:8704
    ds_read_b64_tr_b16 a[120:121], v48 offset:8
    ds_read_b64_tr_b16 a[122:123], v48 offset:520
    ds_read_b64_tr_b16 a[124:125], v48 offset:8200
    ds_read_b64_tr_b16 a[126:127], v48 offset:8712
    s_waitcnt lgkmcnt(0)
    s_barrier
    s_add_u32 m0, s48, 114688
    s_mov_b32 s22, 3670016
    buffer_load_dwordx4 v44, s[8:11], s22 offen  lds
    s_add_u32 m0, s48, 118784
    s_mov_b32 s22, 3702784
    buffer_load_dwordx4 v44, s[8:11], s22 offen  lds
    s_add_u32 m0, s48, 122880
    s_mov_b32 s22, 3735552
    buffer_load_dwordx4 v44, s[8:11], s22 offen  lds
    s_add_u32 m0, s48, 126976
    s_mov_b32 s22, 3768320
    buffer_load_dwordx4 v44, s[8:11], s22 offen  lds
    s_waitcnt vmcnt(28)
    s_barrier
    v_add_u32 v48, 0, v46
    ds_read_b64_tr_b16 a[128:129], v48 offset:0
    ds_read_b64_tr_b16 a[130:131], v48 offset:512
    ds_read_b64_tr_b16 a[132:133], v48 offset:8192
    ds_read_b64_tr_b16 a[134:135], v48 offset:8704
    ds_read_b64_tr_b16 a[136:137], v48 offset:8
    ds_read_b64_tr_b16 a[138:139], v48 offset:520
    ds_read_b64_tr_b16 a[140:141], v48 offset:8200
    ds_read_b64_tr_b16 a[142:143], v48 offset:8712
    s_waitcnt lgkmcnt(0)
    s_barrier
    s_mov_b32 s8, s56
    s_mov_b32 s9, s57
    s_add_u32 m0, s48, 0
    s_mov_b32 s22, 0
    buffer_load_dwordx4 v45, s[8:11], s22 offen  lds
    s_add_u32 m0, s48, 4096
    s_mov_b32 s22, 16384
    buffer_load_dwordx4 v45, s[8:11], s22 offen  lds
    s_add_u32 m0, s48, 8192
    s_mov_b32 s22, 32768
    buffer_load_dwordx4 v45, s[8:11], s22 offen  lds
    s_add_u32 m0, s48, 12288
    s_mov_b32 s22, 49152
    buffer_load_dwordx4 v45, s[8:11], s22 offen  lds
    s_waitcnt vmcnt(28)
    s_barrier
    v_add_u32 v48, 16384, v46
    ds_read_b64_tr_b16 a[144:145], v48 offset:0
    ds_read_b64_tr_b16 a[146:147], v48 offset:512
    ds_read_b64_tr_b16 a[148:149], v48 offset:8192
    ds_read_b64_tr_b16 a[150:151], v48 offset:8704
    ds_read_b64_tr_b16 a[152:153], v48 offset:8
    ds_read_b64_tr_b16 a[154:155], v48 offset:520
    ds_read_b64_tr_b16 a[156:157], v48 offset:8200
    ds_read_b64_tr_b16 a[158:159], v48 offset:8712
    s_waitcnt lgkmcnt(0)
    s_barrier
    s_add_u32 m0, s48, 16384
    s_mov_b32 s22, 256
    buffer_load_dwordx4 v45, s[8:11], s22 offen  lds
    s_add_u32 m0, s48, 20480
    s_mov_b32 s22, 16640
    buffer_load_dwordx4 v45, s[8:11], s22 offen  lds
    s_add_u32 m0, s48, 24576
    s_mov_b32 s22, 33024
    buffer_load_dwordx4 v45, s[8:11], s22 offen  lds
    s_add_u32 m0, s48, 28672
    s_mov_b32 s22, 49408
    buffer_load_dwordx4 v45, s[8:11], s22 offen  lds
    s_waitcnt vmcnt(28)
    s_barrier
    v_add_u32 v48, 32768, v46
    ds_read_b64_tr_b16 a[160:161], v48 offset:0
    ds_read_b64_tr_b16 a[162:163], v48 offset:512
    ds_read_b64_tr_b16 a[164:165], v48 offset:8192
    ds_read_b64_tr_b16 a[166:167], v48 offset:8704
    ds_read_b64_tr_b16 a[168:169], v48 offset:8
    ds_read_b64_tr_b16 a[170:171], v48 offset:520
    ds_read_b64_tr_b16 a[172:173], v48 offset:8200
    ds_read_b64_tr_b16 a[174:175], v48 offset:8712
    s_waitcnt lgkmcnt(0)
    s_barrier
    s_add_u32 m0, s48, 32768
    s_mov_b32 s22, 512
    buffer_load_dwordx4 v45, s[8:11], s22 offen  lds
    s_add_u32 m0, s48, 36864
    s_mov_b32 s22, 16896
    buffer_load_dwordx4 v45, s[8:11], s22 offen  lds
    s_add_u32 m0, s48, 40960
    s_mov_b32 s22, 33280
    buffer_load_dwordx4 v45, s[8:11], s22 offen  lds
    s_add_u32 m0, s48, 45056
    s_mov_b32 s22, 49664
    buffer_load_dwordx4 v45, s[8:11], s22 offen  lds
    s_waitcnt vmcnt(28)
    s_barrier
    v_add_u32 v48, 49152, v46
    ds_read_b64_tr_b16 a[176:177], v48 offset:0
    ds_read_b64_tr_b16 a[178:179], v48 offset:512
    ds_read_b64_tr_b16 a[180:181], v48 offset:8192
    ds_read_b64_tr_b16 a[182:183], v48 offset:8704
    ds_read_b64_tr_b16 a[184:185], v48 offset:8
    ds_read_b64_tr_b16 a[186:187], v48 offset:520
    ds_read_b64_tr_b16 a[188:189], v48 offset:8200
    ds_read_b64_tr_b16 a[190:191], v48 offset:8712
    s_waitcnt lgkmcnt(0)
    s_barrier
    s_add_u32 m0, s48, 49152
    s_mov_b32 s22, 768
    buffer_load_dwordx4 v45, s[8:11], s22 offen  lds
    s_add_u32 m0, s48, 53248
    s_mov_b32 s22, 17152
    buffer_load_dwordx4 v45, s[8:11], s22 offen  lds
    s_add_u32 m0, s48, 57344
    s_mov_b32 s22, 33536
    buffer_load_dwordx4 v45, s[8:11], s22 offen  lds
    s_add_u32 m0, s48, 61440
    s_mov_b32 s22, 49920
    buffer_load_dwordx4 v45, s[8:11], s22 offen  lds
    s_waitcnt vmcnt(28)
    s_barrier
    v_add_u32 v48, 65536, v46
    ds_read_b64_tr_b16 a[192:193], v48 offset:0
    ds_read_b64_tr_b16 a[194:195], v48 offset:512
    ds_read_b64_tr_b16 a[196:197], v48 offset:8192
    ds_read_b64_tr_b16 a[198:199], v48 offset:8704
    ds_read_b64_tr_b16 a[200:201], v48 offset:8
    ds_read_b64_tr_b16 a[202:203], v48 offset:520
    ds_read_b64_tr_b16 a[204:205], v48 offset:8200
    ds_read_b64_tr_b16 a[206:207], v48 offset:8712
    s_waitcnt lgkmcnt(0)
    s_barrier
    s_add_u32 m0, s48, 65536
    s_mov_b32 s22, 131072
    buffer_load_dwordx4 v45, s[8:11], s22 offen  lds
    s_add_u32 m0, s48, 69632
    s_mov_b32 s22, 147456
    buffer_load_dwordx4 v45, s[8:11], s22 offen  lds
    s_add_u32 m0, s48, 73728
    s_mov_b32 s22, 163840
    buffer_load_dwordx4 v45, s[8:11], s22 offen  lds
    s_add_u32 m0, s48, 77824
    s_mov_b32 s22, 180224
    buffer_load_dwordx4 v45, s[8:11], s22 offen  lds
    s_waitcnt vmcnt(28)
    s_barrier
    v_add_u32 v48, 81920, v46
    ds_read_b64_tr_b16 a[208:209], v48 offset:0
    ds_read_b64_tr_b16 a[210:211], v48 offset:512
    ds_read_b64_tr_b16 a[212:213], v48 offset:8192
    ds_read_b64_tr_b16 a[214:215], v48 offset:8704
    ds_read_b64_tr_b16 a[216:217], v48 offset:8
    ds_read_b64_tr_b16 a[218:219], v48 offset:520
    ds_read_b64_tr_b16 a[220:221], v48 offset:8200
    ds_read_b64_tr_b16 a[222:223], v48 offset:8712
    s_waitcnt lgkmcnt(0)
    s_barrier
    s_add_u32 m0, s48, 81920
    s_mov_b32 s22, 131328
    buffer_load_dwordx4 v45, s[8:11], s22 offen  lds
    s_add_u32 m0, s48, 86016
    s_mov_b32 s22, 147712
    buffer_load_dwordx4 v45, s[8:11], s22 offen  lds
    s_add_u32 m0, s48, 90112
    s_mov_b32 s22, 164096
    buffer_load_dwordx4 v45, s[8:11], s22 offen  lds
    s_add_u32 m0, s48, 94208
    s_mov_b32 s22, 180480
    buffer_load_dwordx4 v45, s[8:11], s22 offen  lds
    s_waitcnt vmcnt(28)
    s_barrier
    v_add_u32 v48, 98304, v46
    ds_read_b64_tr_b16 a[224:225], v48 offset:0
    ds_read_b64_tr_b16 a[226:227], v48 offset:512
    ds_read_b64_tr_b16 a[228:229], v48 offset:8192
    ds_read_b64_tr_b16 a[230:231], v48 offset:8704
    ds_read_b64_tr_b16 a[232:233], v48 offset:8
    ds_read_b64_tr_b16 a[234:235], v48 offset:520
    ds_read_b64_tr_b16 a[236:237], v48 offset:8200
    ds_read_b64_tr_b16 a[238:239], v48 offset:8712
    s_waitcnt lgkmcnt(0)
    s_barrier
    s_add_u32 m0, s48, 98304
    s_mov_b32 s22, 131584
    buffer_load_dwordx4 v45, s[8:11], s22 offen  lds
    s_add_u32 m0, s48, 102400
    s_mov_b32 s22, 147968
    buffer_load_dwordx4 v45, s[8:11], s22 offen  lds
    s_add_u32 m0, s48, 106496
    s_mov_b32 s22, 164352
    buffer_load_dwordx4 v45, s[8:11], s22 offen  lds
    s_add_u32 m0, s48, 110592
    s_mov_b32 s22, 180736
    buffer_load_dwordx4 v45, s[8:11], s22 offen  lds
    s_waitcnt vmcnt(28)
    s_barrier
    v_add_u32 v48, 114688, v46
    ds_read_b64_tr_b16 a[240:241], v48 offset:0
    ds_read_b64_tr_b16 a[242:243], v48 offset:512
    ds_read_b64_tr_b16 a[244:245], v48 offset:8192
    ds_read_b64_tr_b16 a[246:247], v48 offset:8704
    ds_read_b64_tr_b16 a[248:249], v48 offset:8
    ds_read_b64_tr_b16 a[250:251], v48 offset:520
    ds_read_b64_tr_b16 a[252:253], v48 offset:8200
    ds_read_b64_tr_b16 a[254:255], v48 offset:8712
    s_waitcnt lgkmcnt(0)
    s_barrier
    s_add_u32 m0, s48, 114688
    s_mov_b32 s22, 131840
    buffer_load_dwordx4 v45, s[8:11], s22 offen  lds
    s_add_u32 m0, s48, 118784
    s_mov_b32 s22, 148224
    buffer_load_dwordx4 v45, s[8:11], s22 offen  lds
    s_add_u32 m0, s48, 122880
    s_mov_b32 s22, 164608
    buffer_load_dwordx4 v45, s[8:11], s22 offen  lds
    s_add_u32 m0, s48, 126976
    s_mov_b32 s22, 180992
    buffer_load_dwordx4 v45, s[8:11], s22 offen  lds
    s_waitcnt vmcnt(28)
    s_barrier
    s_cmp_lg_u32 s20, 0
    s_cbranch_scc1 mega_kernel_rs_wo0
    v_xor_b32 v48, 0, v47
    v_add_u32 v48, 0, v48
    ds_read_b64_tr_b16 v[128:129], v48 offset:0
    ds_read_b64_tr_b16 v[130:131], v48 offset:512
    ds_read_b64_tr_b16 v[132:133], v48 offset:8192
    ds_read_b64_tr_b16 v[134:135], v48 offset:8704
    ds_read_b64_tr_b16 v[144:145], v48 offset:32
    ds_read_b64_tr_b16 v[146:147], v48 offset:544
    ds_read_b64_tr_b16 v[148:149], v48 offset:8224
    ds_read_b64_tr_b16 v[150:151], v48 offset:8736
    s_waitcnt lgkmcnt(0)
    v_xor_b32 v48, 64, v47
    v_add_u32 v48, 0, v48
    ds_read_b64_tr_b16 v[160:161], v48 offset:0
    ds_read_b64_tr_b16 v[162:163], v48 offset:512
    ds_read_b64_tr_b16 v[164:165], v48 offset:8192
    ds_read_b64_tr_b16 v[166:167], v48 offset:8704
    ds_read_b64_tr_b16 v[176:177], v48 offset:32
    ds_read_b64_tr_b16 v[178:179], v48 offset:544
    ds_read_b64_tr_b16 v[180:181], v48 offset:8224
    ds_read_b64_tr_b16 v[182:183], v48 offset:8736
    s_waitcnt lgkmcnt(0)
    v_xor_b32 v48, 128, v47
    v_add_u32 v48, 0, v48
    ds_read_b64_tr_b16 v[192:193], v48 offset:0
    ds_read_b64_tr_b16 v[194:195], v48 offset:512
    ds_read_b64_tr_b16 v[196:197], v48 offset:8192
    ds_read_b64_tr_b16 v[198:199], v48 offset:8704
    ds_read_b64_tr_b16 v[208:209], v48 offset:32
    ds_read_b64_tr_b16 v[210:211], v48 offset:544
    ds_read_b64_tr_b16 v[212:213], v48 offset:8224
    ds_read_b64_tr_b16 v[214:215], v48 offset:8736
    s_waitcnt lgkmcnt(0)
    v_xor_b32 v48, 192, v47
    v_add_u32 v48, 0, v48
    ds_read_b64_tr_b16 v[224:225], v48 offset:0
    ds_read_b64_tr_b16 v[226:227], v48 offset:512
    ds_read_b64_tr_b16 v[228:229], v48 offset:8192
    ds_read_b64_tr_b16 v[230:231], v48 offset:8704
    ds_read_b64_tr_b16 v[240:241], v48 offset:32
    ds_read_b64_tr_b16 v[242:243], v48 offset:544
    ds_read_b64_tr_b16 v[244:245], v48 offset:8224
    ds_read_b64_tr_b16 v[246:247], v48 offset:8736
    s_waitcnt lgkmcnt(0)
mega_kernel_rs_wo0:
    s_barrier
    s_mov_b32 s8, s54
    s_mov_b32 s9, s55
    s_add_u32 m0, s48, 0
    s_mov_b32 s22, 0
    buffer_load_dwordx4 v44, s[8:11], s22 offen  lds
    s_add_u32 m0, s48, 4096
    s_mov_b32 s22, 32768
    buffer_load_dwordx4 v44, s[8:11], s22 offen  lds
    s_add_u32 m0, s48, 8192
    s_mov_b32 s22, 65536
    buffer_load_dwordx4 v44, s[8:11], s22 offen  lds
    s_add_u32 m0, s48, 12288
    s_mov_b32 s22, 98304
    buffer_load_dwordx4 v44, s[8:11], s22 offen  lds
    s_waitcnt vmcnt(28)
    s_barrier
    s_cmp_lg_u32 s20, 1
    s_cbranch_scc1 mega_kernel_rs_wo1
    v_xor_b32 v48, 0, v47
    v_add_u32 v48, 16384, v48
    ds_read_b64_tr_b16 v[128:129], v48 offset:0
    ds_read_b64_tr_b16 v[130:131], v48 offset:512
    ds_read_b64_tr_b16 v[132:133], v48 offset:8192
    ds_read_b64_tr_b16 v[134:135], v48 offset:8704
    ds_read_b64_tr_b16 v[144:145], v48 offset:32
    ds_read_b64_tr_b16 v[146:147], v48 offset:544
    ds_read_b64_tr_b16 v[148:149], v48 offset:8224
    ds_read_b64_tr_b16 v[150:151], v48 offset:8736
    s_waitcnt lgkmcnt(0)
    v_xor_b32 v48, 64, v47
    v_add_u32 v48, 16384, v48
    ds_read_b64_tr_b16 v[160:161], v48 offset:0
    ds_read_b64_tr_b16 v[162:163], v48 offset:512
    ds_read_b64_tr_b16 v[164:165], v48 offset:8192
    ds_read_b64_tr_b16 v[166:167], v48 offset:8704
    ds_read_b64_tr_b16 v[176:177], v48 offset:32
    ds_read_b64_tr_b16 v[178:179], v48 offset:544
    ds_read_b64_tr_b16 v[180:181], v48 offset:8224
    ds_read_b64_tr_b16 v[182:183], v48 offset:8736
    s_waitcnt lgkmcnt(0)
    v_xor_b32 v48, 128, v47
    v_add_u32 v48, 16384, v48
    ds_read_b64_tr_b16 v[192:193], v48 offset:0
    ds_read_b64_tr_b16 v[194:195], v48 offset:512
    ds_read_b64_tr_b16 v[196:197], v48 offset:8192
    ds_read_b64_tr_b16 v[198:199], v48 offset:8704
    ds_read_b64_tr_b16 v[208:209], v48 offset:32
    ds_read_b64_tr_b16 v[210:211], v48 offset:544
    ds_read_b64_tr_b16 v[212:213], v48 offset:8224
    ds_read_b64_tr_b16 v[214:215], v48 offset:8736
    s_waitcnt lgkmcnt(0)
    v_xor_b32 v48, 192, v47
    v_add_u32 v48, 16384, v48
    ds_read_b64_tr_b16 v[224:225], v48 offset:0
    ds_read_b64_tr_b16 v[226:227], v48 offset:512
    ds_read_b64_tr_b16 v[228:229], v48 offset:8192
    ds_read_b64_tr_b16 v[230:231], v48 offset:8704
    ds_read_b64_tr_b16 v[240:241], v48 offset:32
    ds_read_b64_tr_b16 v[242:243], v48 offset:544
    ds_read_b64_tr_b16 v[244:245], v48 offset:8224
    ds_read_b64_tr_b16 v[246:247], v48 offset:8736
    s_waitcnt lgkmcnt(0)
mega_kernel_rs_wo1:
    s_barrier
    s_add_u32 m0, s48, 16384
    s_mov_b32 s22, 524288
    buffer_load_dwordx4 v44, s[8:11], s22 offen  lds
    s_add_u32 m0, s48, 20480
    s_mov_b32 s22, 557056
    buffer_load_dwordx4 v44, s[8:11], s22 offen  lds
    s_add_u32 m0, s48, 24576
    s_mov_b32 s22, 589824
    buffer_load_dwordx4 v44, s[8:11], s22 offen  lds
    s_add_u32 m0, s48, 28672
    s_mov_b32 s22, 622592
    buffer_load_dwordx4 v44, s[8:11], s22 offen  lds
    s_waitcnt vmcnt(28)
    s_barrier
    s_cmp_lg_u32 s20, 2
    s_cbranch_scc1 mega_kernel_rs_wo2
    v_xor_b32 v48, 0, v47
    v_add_u32 v48, 32768, v48
    ds_read_b64_tr_b16 v[128:129], v48 offset:0
    ds_read_b64_tr_b16 v[130:131], v48 offset:512
    ds_read_b64_tr_b16 v[132:133], v48 offset:8192
    ds_read_b64_tr_b16 v[134:135], v48 offset:8704
    ds_read_b64_tr_b16 v[144:145], v48 offset:32
    ds_read_b64_tr_b16 v[146:147], v48 offset:544
    ds_read_b64_tr_b16 v[148:149], v48 offset:8224
    ds_read_b64_tr_b16 v[150:151], v48 offset:8736
    s_waitcnt lgkmcnt(0)
    v_xor_b32 v48, 64, v47
    v_add_u32 v48, 32768, v48
    ds_read_b64_tr_b16 v[160:161], v48 offset:0
    ds_read_b64_tr_b16 v[162:163], v48 offset:512
    ds_read_b64_tr_b16 v[164:165], v48 offset:8192
    ds_read_b64_tr_b16 v[166:167], v48 offset:8704
    ds_read_b64_tr_b16 v[176:177], v48 offset:32
    ds_read_b64_tr_b16 v[178:179], v48 offset:544
    ds_read_b64_tr_b16 v[180:181], v48 offset:8224
    ds_read_b64_tr_b16 v[182:183], v48 offset:8736
    s_waitcnt lgkmcnt(0)
    v_xor_b32 v48, 128, v47
    v_add_u32 v48, 32768, v48
    ds_read_b64_tr_b16 v[192:193], v48 offset:0
    ds_read_b64_tr_b16 v[194:195], v48 offset:512
    ds_read_b64_tr_b16 v[196:197], v48 offset:8192
    ds_read_b64_tr_b16 v[198:199], v48 offset:8704
    ds_read_b64_tr_b16 v[208:209], v48 offset:32
    ds_read_b64_tr_b16 v[210:211], v48 offset:544
    ds_read_b64_tr_b16 v[212:213], v48 offset:8224
    ds_read_b64_tr_b16 v[214:215], v48 offset:8736
    s_waitcnt lgkmcnt(0)
    v_xor_b32 v48, 192, v47
    v_add_u32 v48, 32768, v48
    ds_read_b64_tr_b16 v[224:225], v48 offset:0
    ds_read_b64_tr_b16 v[226:227], v48 offset:512
    ds_read_b64_tr_b16 v[228:229], v48 offset:8192
    ds_read_b64_tr_b16 v[230:231], v48 offset:8704
    ds_read_b64_tr_b16 v[240:241], v48 offset:32
    ds_read_b64_tr_b16 v[242:243], v48 offset:544
    ds_read_b64_tr_b16 v[244:245], v48 offset:8224
    ds_read_b64_tr_b16 v[246:247], v48 offset:8736
    s_waitcnt lgkmcnt(0)
mega_kernel_rs_wo2:
    s_barrier
    s_add_u32 m0, s48, 32768
    s_mov_b32 s22, 1048576
    buffer_load_dwordx4 v44, s[8:11], s22 offen  lds
    s_add_u32 m0, s48, 36864
    s_mov_b32 s22, 1081344
    buffer_load_dwordx4 v44, s[8:11], s22 offen  lds
    s_add_u32 m0, s48, 40960
    s_mov_b32 s22, 1114112
    buffer_load_dwordx4 v44, s[8:11], s22 offen  lds
    s_add_u32 m0, s48, 45056
    s_mov_b32 s22, 1146880
    buffer_load_dwordx4 v44, s[8:11], s22 offen  lds
    s_waitcnt vmcnt(28)
    s_barrier
    s_cmp_lg_u32 s20, 3
    s_cbranch_scc1 mega_kernel_rs_wo3
    v_xor_b32 v48, 0, v47
    v_add_u32 v48, 49152, v48
    ds_read_b64_tr_b16 v[128:129], v48 offset:0
    ds_read_b64_tr_b16 v[130:131], v48 offset:512
    ds_read_b64_tr_b16 v[132:133], v48 offset:8192
    ds_read_b64_tr_b16 v[134:135], v48 offset:8704
    ds_read_b64_tr_b16 v[144:145], v48 offset:32
    ds_read_b64_tr_b16 v[146:147], v48 offset:544
    ds_read_b64_tr_b16 v[148:149], v48 offset:8224
    ds_read_b64_tr_b16 v[150:151], v48 offset:8736
    s_waitcnt lgkmcnt(0)
    v_xor_b32 v48, 64, v47
    v_add_u32 v48, 49152, v48
    ds_read_b64_tr_b16 v[160:161], v48 offset:0
    ds_read_b64_tr_b16 v[162:163], v48 offset:512
    ds_read_b64_tr_b16 v[164:165], v48 offset:8192
    ds_read_b64_tr_b16 v[166:167], v48 offset:8704
    ds_read_b64_tr_b16 v[176:177], v48 offset:32
    ds_read_b64_tr_b16 v[178:179], v48 offset:544
    ds_read_b64_tr_b16 v[180:181], v48 offset:8224
    ds_read_b64_tr_b16 v[182:183], v48 offset:8736
    s_waitcnt lgkmcnt(0)
    v_xor_b32 v48, 128, v47
    v_add_u32 v48, 49152, v48
    ds_read_b64_tr_b16 v[192:193], v48 offset:0
    ds_read_b64_tr_b16 v[194:195], v48 offset:512
    ds_read_b64_tr_b16 v[196:197], v48 offset:8192
    ds_read_b64_tr_b16 v[198:199], v48 offset:8704
    ds_read_b64_tr_b16 v[208:209], v48 offset:32
    ds_read_b64_tr_b16 v[210:211], v48 offset:544
    ds_read_b64_tr_b16 v[212:213], v48 offset:8224
    ds_read_b64_tr_b16 v[214:215], v48 offset:8736
    s_waitcnt lgkmcnt(0)
    v_xor_b32 v48, 192, v47
    v_add_u32 v48, 49152, v48
    ds_read_b64_tr_b16 v[224:225], v48 offset:0
    ds_read_b64_tr_b16 v[226:227], v48 offset:512
    ds_read_b64_tr_b16 v[228:229], v48 offset:8192
    ds_read_b64_tr_b16 v[230:231], v48 offset:8704
    ds_read_b64_tr_b16 v[240:241], v48 offset:32
    ds_read_b64_tr_b16 v[242:243], v48 offset:544
    ds_read_b64_tr_b16 v[244:245], v48 offset:8224
    ds_read_b64_tr_b16 v[246:247], v48 offset:8736
    s_waitcnt lgkmcnt(0)
mega_kernel_rs_wo3:
    s_barrier
    s_add_u32 m0, s48, 49152
    s_mov_b32 s22, 1572864
    buffer_load_dwordx4 v44, s[8:11], s22 offen  lds
    s_add_u32 m0, s48, 53248
    s_mov_b32 s22, 1605632
    buffer_load_dwordx4 v44, s[8:11], s22 offen  lds
    s_add_u32 m0, s48, 57344
    s_mov_b32 s22, 1638400
    buffer_load_dwordx4 v44, s[8:11], s22 offen  lds
    s_add_u32 m0, s48, 61440
    s_mov_b32 s22, 1671168
    buffer_load_dwordx4 v44, s[8:11], s22 offen  lds
    s_waitcnt vmcnt(28)
    s_barrier
    s_cmp_lg_u32 s20, 0
    s_cbranch_scc1 mega_kernel_rs_wo4
    v_xor_b32 v48, 0, v47
    v_add_u32 v48, 65536, v48
    ds_read_b64_tr_b16 v[136:137], v48 offset:0
    ds_read_b64_tr_b16 v[138:139], v48 offset:512
    ds_read_b64_tr_b16 v[140:141], v48 offset:8192
    ds_read_b64_tr_b16 v[142:143], v48 offset:8704
    ds_read_b64_tr_b16 v[152:153], v48 offset:32
    ds_read_b64_tr_b16 v[154:155], v48 offset:544
    ds_read_b64_tr_b16 v[156:157], v48 offset:8224
    ds_read_b64_tr_b16 v[158:159], v48 offset:8736
    s_waitcnt lgkmcnt(0)
    v_xor_b32 v48, 64, v47
    v_add_u32 v48, 65536, v48
    ds_read_b64_tr_b16 v[168:169], v48 offset:0
    ds_read_b64_tr_b16 v[170:171], v48 offset:512
    ds_read_b64_tr_b16 v[172:173], v48 offset:8192
    ds_read_b64_tr_b16 v[174:175], v48 offset:8704
    ds_read_b64_tr_b16 v[184:185], v48 offset:32
    ds_read_b64_tr_b16 v[186:187], v48 offset:544
    ds_read_b64_tr_b16 v[188:189], v48 offset:8224
    ds_read_b64_tr_b16 v[190:191], v48 offset:8736
    s_waitcnt lgkmcnt(0)
    v_xor_b32 v48, 128, v47
    v_add_u32 v48, 65536, v48
    ds_read_b64_tr_b16 v[200:201], v48 offset:0
    ds_read_b64_tr_b16 v[202:203], v48 offset:512
    ds_read_b64_tr_b16 v[204:205], v48 offset:8192
    ds_read_b64_tr_b16 v[206:207], v48 offset:8704
    ds_read_b64_tr_b16 v[216:217], v48 offset:32
    ds_read_b64_tr_b16 v[218:219], v48 offset:544
    ds_read_b64_tr_b16 v[220:221], v48 offset:8224
    ds_read_b64_tr_b16 v[222:223], v48 offset:8736
    s_waitcnt lgkmcnt(0)
    v_xor_b32 v48, 192, v47
    v_add_u32 v48, 65536, v48
    ds_read_b64_tr_b16 v[232:233], v48 offset:0
    ds_read_b64_tr_b16 v[234:235], v48 offset:512
    ds_read_b64_tr_b16 v[236:237], v48 offset:8192
    ds_read_b64_tr_b16 v[238:239], v48 offset:8704
    ds_read_b64_tr_b16 v[248:249], v48 offset:32
    ds_read_b64_tr_b16 v[250:251], v48 offset:544
    ds_read_b64_tr_b16 v[252:253], v48 offset:8224
    ds_read_b64_tr_b16 v[254:255], v48 offset:8736
    s_waitcnt lgkmcnt(0)
mega_kernel_rs_wo4:
    s_barrier
    s_add_u32 m0, s48, 65536
    s_mov_b32 s22, 2097152
    buffer_load_dwordx4 v44, s[8:11], s22 offen  lds
    s_add_u32 m0, s48, 69632
    s_mov_b32 s22, 2129920
    buffer_load_dwordx4 v44, s[8:11], s22 offen  lds
    s_add_u32 m0, s48, 73728
    s_mov_b32 s22, 2162688
    buffer_load_dwordx4 v44, s[8:11], s22 offen  lds
    s_add_u32 m0, s48, 77824
    s_mov_b32 s22, 2195456
    buffer_load_dwordx4 v44, s[8:11], s22 offen  lds
    s_waitcnt vmcnt(28)
    s_barrier
    s_cmp_lg_u32 s20, 1
    s_cbranch_scc1 mega_kernel_rs_wo5
    v_xor_b32 v48, 0, v47
    v_add_u32 v48, 81920, v48
    ds_read_b64_tr_b16 v[136:137], v48 offset:0
    ds_read_b64_tr_b16 v[138:139], v48 offset:512
    ds_read_b64_tr_b16 v[140:141], v48 offset:8192
    ds_read_b64_tr_b16 v[142:143], v48 offset:8704
    ds_read_b64_tr_b16 v[152:153], v48 offset:32
    ds_read_b64_tr_b16 v[154:155], v48 offset:544
    ds_read_b64_tr_b16 v[156:157], v48 offset:8224
    ds_read_b64_tr_b16 v[158:159], v48 offset:8736
    s_waitcnt lgkmcnt(0)
    v_xor_b32 v48, 64, v47
    v_add_u32 v48, 81920, v48
    ds_read_b64_tr_b16 v[168:169], v48 offset:0
    ds_read_b64_tr_b16 v[170:171], v48 offset:512
    ds_read_b64_tr_b16 v[172:173], v48 offset:8192
    ds_read_b64_tr_b16 v[174:175], v48 offset:8704
    ds_read_b64_tr_b16 v[184:185], v48 offset:32
    ds_read_b64_tr_b16 v[186:187], v48 offset:544
    ds_read_b64_tr_b16 v[188:189], v48 offset:8224
    ds_read_b64_tr_b16 v[190:191], v48 offset:8736
    s_waitcnt lgkmcnt(0)
    v_xor_b32 v48, 128, v47
    v_add_u32 v48, 81920, v48
    ds_read_b64_tr_b16 v[200:201], v48 offset:0
    ds_read_b64_tr_b16 v[202:203], v48 offset:512
    ds_read_b64_tr_b16 v[204:205], v48 offset:8192
    ds_read_b64_tr_b16 v[206:207], v48 offset:8704
    ds_read_b64_tr_b16 v[216:217], v48 offset:32
    ds_read_b64_tr_b16 v[218:219], v48 offset:544
    ds_read_b64_tr_b16 v[220:221], v48 offset:8224
    ds_read_b64_tr_b16 v[222:223], v48 offset:8736
    s_waitcnt lgkmcnt(0)
    v_xor_b32 v48, 192, v47
    v_add_u32 v48, 81920, v48
    ds_read_b64_tr_b16 v[232:233], v48 offset:0
    ds_read_b64_tr_b16 v[234:235], v48 offset:512
    ds_read_b64_tr_b16 v[236:237], v48 offset:8192
    ds_read_b64_tr_b16 v[238:239], v48 offset:8704
    ds_read_b64_tr_b16 v[248:249], v48 offset:32
    ds_read_b64_tr_b16 v[250:251], v48 offset:544
    ds_read_b64_tr_b16 v[252:253], v48 offset:8224
    ds_read_b64_tr_b16 v[254:255], v48 offset:8736
    s_waitcnt lgkmcnt(0)
mega_kernel_rs_wo5:
    s_barrier
    s_add_u32 m0, s48, 81920
    s_mov_b32 s22, 2621440
    buffer_load_dwordx4 v44, s[8:11], s22 offen  lds
    s_add_u32 m0, s48, 86016
    s_mov_b32 s22, 2654208
    buffer_load_dwordx4 v44, s[8:11], s22 offen  lds
    s_add_u32 m0, s48, 90112
    s_mov_b32 s22, 2686976
    buffer_load_dwordx4 v44, s[8:11], s22 offen  lds
    s_add_u32 m0, s48, 94208
    s_mov_b32 s22, 2719744
    buffer_load_dwordx4 v44, s[8:11], s22 offen  lds
    s_waitcnt vmcnt(28)
    s_barrier
    s_cmp_lg_u32 s20, 2
    s_cbranch_scc1 mega_kernel_rs_wo6
    v_xor_b32 v48, 0, v47
    v_add_u32 v48, 98304, v48
    ds_read_b64_tr_b16 v[136:137], v48 offset:0
    ds_read_b64_tr_b16 v[138:139], v48 offset:512
    ds_read_b64_tr_b16 v[140:141], v48 offset:8192
    ds_read_b64_tr_b16 v[142:143], v48 offset:8704
    ds_read_b64_tr_b16 v[152:153], v48 offset:32
    ds_read_b64_tr_b16 v[154:155], v48 offset:544
    ds_read_b64_tr_b16 v[156:157], v48 offset:8224
    ds_read_b64_tr_b16 v[158:159], v48 offset:8736
    s_waitcnt lgkmcnt(0)
    v_xor_b32 v48, 64, v47
    v_add_u32 v48, 98304, v48
    ds_read_b64_tr_b16 v[168:169], v48 offset:0
    ds_read_b64_tr_b16 v[170:171], v48 offset:512
    ds_read_b64_tr_b16 v[172:173], v48 offset:8192
    ds_read_b64_tr_b16 v[174:175], v48 offset:8704
    ds_read_b64_tr_b16 v[184:185], v48 offset:32
    ds_read_b64_tr_b16 v[186:187], v48 offset:544
    ds_read_b64_tr_b16 v[188:189], v48 offset:8224
    ds_read_b64_tr_b16 v[190:191], v48 offset:8736
    s_waitcnt lgkmcnt(0)
    v_xor_b32 v48, 128, v47
    v_add_u32 v48, 98304, v48
    ds_read_b64_tr_b16 v[200:201], v48 offset:0
    ds_read_b64_tr_b16 v[202:203], v48 offset:512
    ds_read_b64_tr_b16 v[204:205], v48 offset:8192
    ds_read_b64_tr_b16 v[206:207], v48 offset:8704
    ds_read_b64_tr_b16 v[216:217], v48 offset:32
    ds_read_b64_tr_b16 v[218:219], v48 offset:544
    ds_read_b64_tr_b16 v[220:221], v48 offset:8224
    ds_read_b64_tr_b16 v[222:223], v48 offset:8736
    s_waitcnt lgkmcnt(0)
    v_xor_b32 v48, 192, v47
    v_add_u32 v48, 98304, v48
    ds_read_b64_tr_b16 v[232:233], v48 offset:0
    ds_read_b64_tr_b16 v[234:235], v48 offset:512
    ds_read_b64_tr_b16 v[236:237], v48 offset:8192
    ds_read_b64_tr_b16 v[238:239], v48 offset:8704
    ds_read_b64_tr_b16 v[248:249], v48 offset:32
    ds_read_b64_tr_b16 v[250:251], v48 offset:544
    ds_read_b64_tr_b16 v[252:253], v48 offset:8224
    ds_read_b64_tr_b16 v[254:255], v48 offset:8736
    s_waitcnt lgkmcnt(0)
mega_kernel_rs_wo6:
    s_barrier
    s_add_u32 m0, s48, 98304
    s_mov_b32 s22, 3145728
    buffer_load_dwordx4 v44, s[8:11], s22 offen  lds
    s_add_u32 m0, s48, 102400
    s_mov_b32 s22, 3178496
    buffer_load_dwordx4 v44, s[8:11], s22 offen  lds
    s_add_u32 m0, s48, 106496
    s_mov_b32 s22, 3211264
    buffer_load_dwordx4 v44, s[8:11], s22 offen  lds
    s_add_u32 m0, s48, 110592
    s_mov_b32 s22, 3244032
    buffer_load_dwordx4 v44, s[8:11], s22 offen  lds
    s_waitcnt vmcnt(28)
    s_barrier
    s_cmp_lg_u32 s20, 3
    s_cbranch_scc1 mega_kernel_rs_wo7
    v_xor_b32 v48, 0, v47
    v_add_u32 v48, 114688, v48
    ds_read_b64_tr_b16 v[136:137], v48 offset:0
    ds_read_b64_tr_b16 v[138:139], v48 offset:512
    ds_read_b64_tr_b16 v[140:141], v48 offset:8192
    ds_read_b64_tr_b16 v[142:143], v48 offset:8704
    ds_read_b64_tr_b16 v[152:153], v48 offset:32
    ds_read_b64_tr_b16 v[154:155], v48 offset:544
    ds_read_b64_tr_b16 v[156:157], v48 offset:8224
    ds_read_b64_tr_b16 v[158:159], v48 offset:8736
    s_waitcnt lgkmcnt(0)
    v_xor_b32 v48, 64, v47
    v_add_u32 v48, 114688, v48
    ds_read_b64_tr_b16 v[168:169], v48 offset:0
    ds_read_b64_tr_b16 v[170:171], v48 offset:512
    ds_read_b64_tr_b16 v[172:173], v48 offset:8192
    ds_read_b64_tr_b16 v[174:175], v48 offset:8704
    ds_read_b64_tr_b16 v[184:185], v48 offset:32
    ds_read_b64_tr_b16 v[186:187], v48 offset:544
    ds_read_b64_tr_b16 v[188:189], v48 offset:8224
    ds_read_b64_tr_b16 v[190:191], v48 offset:8736
    s_waitcnt lgkmcnt(0)
    v_xor_b32 v48, 128, v47
    v_add_u32 v48, 114688, v48
    ds_read_b64_tr_b16 v[200:201], v48 offset:0
    ds_read_b64_tr_b16 v[202:203], v48 offset:512
    ds_read_b64_tr_b16 v[204:205], v48 offset:8192
    ds_read_b64_tr_b16 v[206:207], v48 offset:8704
    ds_read_b64_tr_b16 v[216:217], v48 offset:32
    ds_read_b64_tr_b16 v[218:219], v48 offset:544
    ds_read_b64_tr_b16 v[220:221], v48 offset:8224
    ds_read_b64_tr_b16 v[222:223], v48 offset:8736
    s_waitcnt lgkmcnt(0)
    v_xor_b32 v48, 192, v47
    v_add_u32 v48, 114688, v48
    ds_read_b64_tr_b16 v[232:233], v48 offset:0
    ds_read_b64_tr_b16 v[234:235], v48 offset:512
    ds_read_b64_tr_b16 v[236:237], v48 offset:8192
    ds_read_b64_tr_b16 v[238:239], v48 offset:8704
    ds_read_b64_tr_b16 v[248:249], v48 offset:32
    ds_read_b64_tr_b16 v[250:251], v48 offset:544
    ds_read_b64_tr_b16 v[252:253], v48 offset:8224
    ds_read_b64_tr_b16 v[254:255], v48 offset:8736
    s_waitcnt lgkmcnt(0)
mega_kernel_rs_wo7:
    s_barrier
    s_add_u32 m0, s48, 114688
    s_mov_b32 s22, 3670016
    buffer_load_dwordx4 v44, s[8:11], s22 offen  lds
    s_add_u32 m0, s48, 118784
    s_mov_b32 s22, 3702784
    buffer_load_dwordx4 v44, s[8:11], s22 offen  lds
    s_add_u32 m0, s48, 122880
    s_mov_b32 s22, 3735552
    buffer_load_dwordx4 v44, s[8:11], s22 offen  lds
    s_add_u32 m0, s48, 126976
    s_mov_b32 s22, 3768320
    buffer_load_dwordx4 v44, s[8:11], s22 offen  lds
    s_waitcnt vmcnt(28)
    s_barrier
    v_add_u32 v48, 0, v46
    ds_read_b64_tr_b16 v[64:65], v48 offset:0
    ds_read_b64_tr_b16 v[66:67], v48 offset:512
    ds_read_b64_tr_b16 v[68:69], v48 offset:8192
    ds_read_b64_tr_b16 v[70:71], v48 offset:8704
    ds_read_b64_tr_b16 v[72:73], v48 offset:8
    ds_read_b64_tr_b16 v[74:75], v48 offset:520
    ds_read_b64_tr_b16 v[76:77], v48 offset:8200
    ds_read_b64_tr_b16 v[78:79], v48 offset:8712
    s_waitcnt lgkmcnt(0)
    s_barrier
    ds_write_b128 v32, v[64:67] offset:0
    ds_write_b128 v32, v[68:71] offset:1024
    ds_write_b128 v32, v[72:75] offset:2048
    ds_write_b128 v32, v[76:79] offset:3072
    s_waitcnt lgkmcnt(0)
    s_waitcnt vmcnt(24)
    s_barrier
    v_add_u32 v48, 16384, v46
    ds_read_b64_tr_b16 v[64:65], v48 offset:0
    ds_read_b64_tr_b16 v[66:67], v48 offset:512
    ds_read_b64_tr_b16 v[68:69], v48 offset:8192
    ds_read_b64_tr_b16 v[70:71], v48 offset:8704
    ds_read_b64_tr_b16 v[72:73], v48 offset:8
    ds_read_b64_tr_b16 v[74:75], v48 offset:520
    ds_read_b64_tr_b16 v[76:77], v48 offset:8200
    ds_read_b64_tr_b16 v[78:79], v48 offset:8712
    s_waitcnt lgkmcnt(0)
    s_barrier
    ds_write_b128 v32, v[64:67] offset:16384
    ds_write_b128 v32, v[68:71] offset:17408
    ds_write_b128 v32, v[72:75] offset:18432
    ds_write_b128 v32, v[76:79] offset:19456
    s_waitcnt lgkmcnt(0)
    s_waitcnt vmcnt(20)
    s_barrier
    s_getpc_b64 s[16:17]
mega_kernel_rs_pc0:
    s_add_u32 s16, s16, mega_kernel_rs_w0_entry - mega_kernel_rs_pc0
    s_addc_u32 s17, s17, 0
    v_lshlrev_b32 v49, 7, v0
    v_min_u32 v49, mega_kernel_rs_end - mega_kernel_rs_w0_entry, v49
    global_load_dword v50, v49, s[16:17]
    v_lshlrev_b32 v49, 7, v40
    s_xor_b32 s23, s35, 16384
    s_cmp_eq_u32 s20, 1
    s_cselect_b32 s22, s35, s47
    s_cmp_eq_u32 s20, 2
    s_cselect_b32 s22, s23, s22
    s_lshl_b32 s23, s31, 13
    s_add_u32 s23, s23, 178257920
    s_cmp_eq_u32 s20, 3
    s_cselect_b32 s22, s23, s22
    buffer_load_dword v51, v49, s[4:7], s22 offen sc1
    v_lshlrev_b32 v49, 13, v0
    v_and_b32 v49, 0x1fffff, v49
    s_mov_b32 s22, 67108864
    buffer_load_dword v52, v49, s[4:7], s22 offen sc1
    buffer_load_dword v57, v7, s[4:7], 0 offen sc1
    v_add_u32 v48, 32768, v46
    ds_read_b64_tr_b16 v[64:65], v48 offset:0
    ds_read_b64_tr_b16 v[66:67], v48 offset:512
    ds_read_b64_tr_b16 v[68:69], v48 offset:8192
    ds_read_b64_tr_b16 v[70:71], v48 offset:8704
    ds_read_b64_tr_b16 v[72:73], v48 offset:8
    ds_read_b64_tr_b16 v[74:75], v48 offset:520
    ds_read_b64_tr_b16 v[76:77], v48 offset:8200
    ds_read_b64_tr_b16 v[78:79], v48 offset:8712
    s_waitcnt lgkmcnt(0)
    s_barrier
    ds_write_b128 v32, v[64:67] offset:32768
    ds_write_b128 v32, v[68:71] offset:33792
    ds_write_b128 v32, v[72:75] offset:34816
    ds_write_b128 v32, v[76:79] offset:35840
    s_waitcnt lgkmcnt(0)
    s_waitcnt vmcnt(16)
    s_barrier
    v_add_u32 v48, 49152, v46
    ds_read_b64_tr_b16 v[64:65], v48 offset:0
    ds_read_b64_tr_b16 v[66:67], v48 offset:512
    ds_read_b64_tr_b16 v[68:69], v48 offset:8192
    ds_read_b64_tr_b16 v[70:71], v48 offset:8704
    ds_read_b64_tr_b16 v[72:73], v48 offset:8
    ds_read_b64_tr_b16 v[74:75], v48 offset:520
    ds_read_b64_tr_b16 v[76:77], v48 offset:8200
    ds_read_b64_tr_b16 v[78:79], v48 offset:8712
    s_waitcnt lgkmcnt(0)
    s_barrier
    ds_write_b128 v32, v[64:67] offset:49152
    ds_write_b128 v32, v[68:71] offset:50176
    ds_write_b128 v32, v[72:75] offset:51200
    ds_write_b128 v32, v[76:79] offset:52224
    s_waitcnt lgkmcnt(0)
    s_waitcnt vmcnt(12)
    s_barrier
    v_add_u32 v48, 65536, v46
    ds_read_b64_tr_b16 v[64:65], v48 offset:0
    ds_read_b64_tr_b16 v[66:67], v48 offset:512
    ds_read_b64_tr_b16 v[68:69], v48 offset:8192
    ds_read_b64_tr_b16 v[70:71], v48 offset:8704
    ds_read_b64_tr_b16 v[72:73], v48 offset:8
    ds_read_b64_tr_b16 v[74:75], v48 offset:520
    ds_read_b64_tr_b16 v[76:77], v48 offset:8200
    ds_read_b64_tr_b16 v[78:79], v48 offset:8712
    s_waitcnt lgkmcnt(0)
    s_barrier
    ds_write_b128 v33, v[64:67] offset:0
    ds_write_b128 v33, v[68:71] offset:1024
    ds_write_b128 v33, v[72:75] offset:2048
    ds_write_b128 v33, v[76:79] offset:3072
    s_waitcnt lgkmcnt(0)
    s_waitcnt vmcnt(8)
    s_barrier
    v_add_u32 v48, 81920, v46
    ds_read_b64_tr_b16 v[64:65], v48 offset:0
    ds_read_b64_tr_b16 v[66:67], v48 offset:512
    ds_read_b64_tr_b16 v[68:69], v48 offset:8192
    ds_read_b64_tr_b16 v[70:71], v48 offset:8704
    ds_read_b64_tr_b16 v[72:73], v48 offset:8
    ds_read_b64_tr_b16 v[74:75], v48 offset:520
    ds_read_b64_tr_b16 v[76:77], v48 offset:8200
    ds_read_b64_tr_b16 v[78:79], v48 offset:8712
    s_waitcnt lgkmcnt(0)
    s_barrier
    ds_write_b128 v33, v[64:67] offset:16384
    ds_write_b128 v33, v[68:71] offset:17408
    ds_write_b128 v33, v[72:75] offset:18432
    ds_write_b128 v33, v[76:79] offset:19456
    s_waitcnt lgkmcnt(0)
    s_waitcnt vmcnt(4)
    s_barrier
    v_add_u32 v48, 98304, v46
    ds_read_b64_tr_b16 v[64:65], v48 offset:0
    ds_read_b64_tr_b16 v[66:67], v48 offset:512
    ds_read_b64_tr_b16 v[68:69], v48 offset:8192
    ds_read_b64_tr_b16 v[70:71], v48 offset:8704
    ds_read_b64_tr_b16 v[72:73], v48 offset:8
    ds_read_b64_tr_b16 v[74:75], v48 offset:520
    ds_read_b64_tr_b16 v[76:77], v48 offset:8200
    ds_read_b64_tr_b16 v[78:79], v48 offset:8712
    s_waitcnt lgkmcnt(0)
    s_barrier
    ds_write_b128 v33, v[64:67] offset:32768
    ds_write_b128 v33, v[68:71] offset:33792
    ds_write_b128 v33, v[72:75] offset:34816
    ds_write_b128 v33, v[76:79] offset:35840
    s_waitcnt lgkmcnt(0)
    s_waitcnt vmcnt(0)
    s_barrier
    v_add_u32 v48, 114688, v46
    ds_read_b64_tr_b16 v[64:65], v48 offset:0
    ds_read_b64_tr_b16 v[66:67], v48 offset:512
    ds_read_b64_tr_b16 v[68:69], v48 offset:8192
    ds_read_b64_tr_b16 v[70:71], v48 offset:8704
    ds_read_b64_tr_b16 v[72:73], v48 offset:8
    ds_read_b64_tr_b16 v[74:75], v48 offset:520
    ds_read_b64_tr_b16 v[76:77], v48 offset:8200
    ds_read_b64_tr_b16 v[78:79], v48 offset:8712
    s_waitcnt lgkmcnt(0)
    s_barrier
    ds_write_b128 v33, v[64:67] offset:49152
    ds_write_b128 v33, v[68:71] offset:50176
    ds_write_b128 v33, v[72:75] offset:51200
    ds_write_b128 v33, v[76:79] offset:52224
    s_waitcnt lgkmcnt(0)
mega_kernel_rs_iw:
    buffer_load_dword v58, off, s[12:15], 0 offset:204 sc1
    s_waitcnt vmcnt(0)
mega_kernel_rs_iw1:
    v_and_b32 v50, 0xffff, v58
    v_readfirstlane_b32 s60, v58
    v_cmp_ne_u32 vcc, s100, v50
    s_cbranch_vccnz mega_kernel_rs_iw
    s_lshr_b32 s60, s60, 15
    s_cmp_gt_u32 s60, s100
    s_cselect_b32 s60, 8192, 0
    s_bfe_u32 s22, s31, 0x10001
    s_lshl_b32 s22, s22, 12
    s_add_u32 s22, s22, s60
    s_lshl_b32 s23, s20, 10
    s_add_u32 s22, s22, s23
    s_add_u32 s38, s38, s22
    s_add_u32 s37, s37, s22
    s_xor_b32 s40, s38, 4096
    s_xor_b32 s39, s37, 4096
    s_xor_b32 s36, s35, 16384
    s_mov_b32 s21, 0
    s_cmp_eq_u32 s30, 0
    s_mov_b32 s22, 0x33003300
    s_cselect_b32 s16, 0x00330033, s22
    s_mov_b32 s17, s16
    s_cselect_b32 s18, -1, 0
    s_not_b32 s19, s18
    s_lshl_b32 s22, s31, 13
    s_lshl_b32 s23, s20, 11
    s_add_u32 s22, s22, s23
    s_add_u32 s43, s22, 16777216
    s_add_u32 s44, s22, 33554432
    s_lshl_b32 s45, s31, 13
    s_add_u32 s45, s45, 178257920
    s_mul_i32 s48, s20, 5120
    s_add_u32 m0, s48, 140288
    s_mov_b32 s41, 1
    s_mov_b32 s42, 1
    v_mov_b32 v0, v34
    v_bfrev_b32 v12, 1
    v_bfrev_b32 v3, 1
    v_cndmask_b32 v10, v3, v10, s[16:17]
    v_cndmask_b32 v9, v3, v9, s[26:27]
    s_sub_u32 s45, s45, 0
    s_lshl_b32 s51, s30, 11
    s_add_u32 s51, s51, s45
    s_mov_b32 s50, 0
    s_cmp_lg_u32 s20, 3
    s_cbranch_scc1 mega_kernel_rs_kv0
    v_readlane_b32 s50, v57, 0
    v_readlane_b32 s22, v57, 2
    v_readlane_b32 s23, v57, 1
    v_readlane_b32 s24, v57, 3
    s_nop 3
    s_min_u32 s50, s50, s22
    s_min_u32 s23, s23, s24
    s_lshl_b32 s50, s50, 1
    s_lshl_b32 s23, s23, 1
    s_add_u32 s23, s23, 1
    s_min_u32 s50, s50, s23
mega_kernel_rs_kvb0:
    s_add_u32 s22, s21, 1
    s_min_u32 s22, s22, 63
    s_cmp_gt_u32 s50, s22
    s_cbranch_scc1 mega_kernel_rs_kvd0
    buffer_load_dword v48, v7, s[4:7], 0 offen sc1
    s_waitcnt vmcnt(0)
    v_readlane_b32 s50, v48, 0
    v_readlane_b32 s22, v48, 2
    v_readlane_b32 s23, v48, 1
    v_readlane_b32 s24, v48, 3
    s_nop 3
    s_min_u32 s50, s50, s22
    s_min_u32 s23, s23, s24
    s_lshl_b32 s50, s50, 1
    s_lshl_b32 s23, s23, 1
    s_add_u32 s23, s23, 1
    s_min_u32 s50, s50, s23
    s_branch mega_kernel_rs_kvb0
mega_kernel_rs_kvd0:
mega_kernel_rs_kv0:
    s_barrier
    s_cmp_eq_u32 s20, 1
    s_cbranch_scc1 mega_kernel_rs_w1_entry
    s_cmp_eq_u32 s20, 2
    s_cbranch_scc1 mega_kernel_rs_w2_entry
    s_cmp_eq_u32 s20, 3
    s_cbranch_scc1 mega_kernel_rs_w3_entry
mega_kernel_rs_w0_entry:
    v_mfma_f32_32x32x8_bf16 v[96:111], v[14:15], v[14:15], 0
    v_mfma_f32_16x16x16_bf16 v[112:115], v[14:15], v[14:15], 0
    v_mfma_f32_16x16x16_bf16 v[116:119], v[14:15], v[14:15], 0
    ds_read_b128 v[64:67], v1 offset:0
    ds_read_b128 v[68:71], v1 offset:1024
    ds_read_b128 v[72:75], v1 offset:2048
    ds_read_b128 v[76:79], v1 offset:3072
    ds_read_b128 v[80:83], v1 offset:16384
    ds_read_b128 v[84:87], v1 offset:17408
    ds_read_b128 v[88:91], v1 offset:18432
    ds_read_b128 v[92:95], v1 offset:19456
    buffer_load_dwordx4 v[120:123], v1, s[4:7], s44 offen
    buffer_load_dwordx4 v[124:127], v1, s[4:7], s44 offen offset:1024
    s_add_u32 s44, s44, 262144
mega_kernel_rs_w0_loop:
    s_add_u32 s22, s35, 0
    s_waitcnt vmcnt(0)
    buffer_load_dwordx4 v[32:35], v1, s[4:7], s22 offen sc1
    buffer_load_dwordx4 v[36:39], v1, s[4:7], s22 offen offset:1024 sc1
mega_kernel_rs_w0_pa:
    s_waitcnt vmcnt(1)
    ds_write_b128 v6, v[32:35] offset:0
    s_waitcnt vmcnt(0)
    ds_write_b128 v6, v[36:39] offset:1024
    v_max3_u32 v3, v32, v34, v36
    v_max_u32 v3, v3, v38
    v_cmp_eq_u32 vcc, -1, v3
    v_smfmac_f32_16x16x64_bf16 v[96:99], v[32:35], a[0:7], v2
    buffer_load_dwordx4 v[32:35], v1, s[4:7], s22 offen sc1
    v_smfmac_f32_16x16x64_bf16 v[100:103], v[32:35], a[8:15], v2
    buffer_load_dwordx4 v[36:39], v1, s[4:7], s22 offen offset:1024 sc1
    v_smfmac_f32_16x16x64_bf16 v[104:107], v[32:35], a[128:135], v2
    s_cbranch_vccnz mega_kernel_rs_w0_pafail
    s_waitcnt lgkmcnt(0)
    s_barrier
    ds_read_b128 v[40:43], v6 offset:2048
    ds_read_b128 v[44:47], v6 offset:3072
    v_smfmac_f32_16x16x64_bf16 v[108:111], v[32:35], a[136:143], v2
    ds_read_b128 v[48:51], v6 offset:4096
    v_smfmac_f32_16x16x64_bf16 v[96:99], v[36:39], a[16:23], v2
    ds_read_b128 v[52:55], v6 offset:5120
    v_smfmac_f32_16x16x64_bf16 v[100:103], v[36:39], a[24:31], v2
    ds_read_b128 v[56:59], v6 offset:6144
    v_smfmac_f32_16x16x64_bf16 v[104:107], v[36:39], a[144:151], v2
    ds_read_b128 v[60:63], v6 offset:7168
    v_smfmac_f32_16x16x64_bf16 v[108:111], v[36:39], a[152:159], v2
    buffer_load_dwordx4 v1, s[4:7], s43 offen lds
    s_waitcnt lgkmcnt(5)
    v_smfmac_f32_16x16x64_bf16 v[96:99], v[40:43], a[32:39], v2
    v_smfmac_f32_16x16x64_bf16 v[104:107], v[40:43], a[160:167], v2
    s_waitcnt lgkmcnt(4)
    v_smfmac_f32_16x16x64_bf16 v[96:99], v[44:47], a[48:55], v2
    v_smfmac_f32_16x16x64_bf16 v[104:107], v[44:47], a[176:183], v2
    buffer_load_dwordx4 v1, s[4:7], s43 offen offset:1024 lds
    s_waitcnt lgkmcnt(3)
    v_smfmac_f32_16x16x64_bf16 v[96:99], v[48:51], a[64:71], v2
    v_smfmac_f32_16x16x64_bf16 v[104:107], v[48:51], a[192:199], v2
    s_waitcnt lgkmcnt(2)
    v_smfmac_f32_16x16x64_bf16 v[96:99], v[52:55], a[80:87], v2
    v_smfmac_f32_16x16x64_bf16 v[104:107], v[52:55], a[208:215], v2
    v_mov_b32 v4, s21
    buffer_store_dword v4, v7, s[4:7], 0 offen sc1
    s_waitcnt lgkmcnt(1)
    v_smfmac_f32_16x16x64_bf16 v[96:99], v[56:59], a[96:103], v2
    v_smfmac_f32_16x16x64_bf16 v[104:107], v[56:59], a[224:231], v2
    s_waitcnt lgkmcnt(0)
    v_smfmac_f32_16x16x64_bf16 v[96:99], v[60:63], a[112:119], v2
    v_smfmac_f32_16x16x64_bf16 v[104:107], v[60:63], a[240:247], v2
    v_smfmac_f32_16x16x64_bf16 v[100:103], v[40:43], a[40:47], v2
    s_nop 2
    v_smfmac_f32_16x16x64_bf16 v[100:103], v[44:47], a[56:63], v2
    s_nop 1
    v_add_f32 v96, v96, v98
    v_smfmac_f32_16x16x64_bf16 v[100:103], v[48:51], a[72:79], v2
    v_add_f32 v97, v97, v99
    v_add_f32 v104, v104, v106
    v_smfmac_f32_16x16x64_bf16 v[100:103], v[52:55], a[88:95], v2
    v_add_f32 v105, v105, v107
    v_cvt_pk_bf16_f32 v96, v96, v97
    v_smfmac_f32_16x16x64_bf16 v[100:103], v[56:59], a[104:111], v2
    v_cvt_pk_bf16_f32 v97, v104, v105
    v_and_or_b32 v96, v96, -2, s41
    v_smfmac_f32_16x16x64_bf16 v[100:103], v[60:63], a[120:127], v2
    buffer_store_dwordx2 v[96:97], v11, s[4:7], s37 offen sc1
    v_smfmac_f32_16x16x64_bf16 v[108:111], v[40:43], a[168:175], v2
    v_smfmac_f32_16x16x64_bf16 v[108:111], v[44:47], a[184:191], v2
    v_smfmac_f32_16x16x64_bf16 v[108:111], v[48:51], a[200:207], v2
    v_smfmac_f32_16x16x64_bf16 v[108:111], v[52:55], a[216:223], v2
    v_smfmac_f32_16x16x64_bf16 v[108:111], v[56:59], a[232:239], v2
    s_nop 2
    v_add_f32 v100, v100, v102
    v_smfmac_f32_16x16x64_bf16 v[108:111], v[60:63], a[248:255], v2
    v_add_f32 v101, v101, v103
    v_cvt_pk_bf16_f32 v98, v100, v101
    v_and_or_b32 v98, v98, -2, s41
    s_nop 4
    v_pk_add_f32 v[108:109], v[108:109], v[110:111]
    v_cvt_pk_bf16_f32 v99, v108, v109
    buffer_store_dwordx2 v[98:99], v11, s[4:7], s37 offen offset:512 sc1
    v_smfmac_f32_16x16x64_bf16 v[112:115], v[32:35], v[64:71], v2
    ds_read_b128 v[64:67], v1 offset:32768
    ds_read_b128 v[68:71], v1 offset:33792
    v_smfmac_f32_16x16x64_bf16 v[116:119], v[32:35], v[72:79], v2
    ds_read_b128 v[72:75], v1 offset:34816
    ds_read_b128 v[76:79], v1 offset:35840
    v_smfmac_f32_16x16x64_bf16 v[112:115], v[36:39], v[80:87], v2
    ds_read_b128 v[80:83], v1 offset:49152
    ds_read_b128 v[84:87], v1 offset:50176
    v_smfmac_f32_16x16x64_bf16 v[116:119], v[36:39], v[88:95], v2
    ds_read_b128 v[88:91], v1 offset:51200
    ds_read_b128 v[92:95], v1 offset:52224
    s_waitcnt lgkmcnt(6)
    v_smfmac_f32_16x16x64_bf16 v[112:115], v[40:43], v[64:71], v2
    ds_read_b128 v[64:67], v5 offset:0
    ds_read_b128 v[68:71], v5 offset:1024
    s_waitcnt lgkmcnt(6)
    v_smfmac_f32_16x16x64_bf16 v[116:119], v[40:43], v[72:79], v2
    ds_read_b128 v[72:75], v5 offset:2048
    ds_read_b128 v[76:79], v5 offset:3072
    s_waitcnt lgkmcnt(6)
    v_smfmac_f32_16x16x64_bf16 v[112:115], v[44:47], v[80:87], v2
    ds_read_b128 v[80:83], v5 offset:16384
    ds_read_b128 v[84:87], v5 offset:17408
    s_waitcnt lgkmcnt(6)
    v_smfmac_f32_16x16x64_bf16 v[116:119], v[44:47], v[88:95], v2
    ds_read_b128 v[88:91], v5 offset:18432
    ds_read_b128 v[92:95], v5 offset:19456
    s_waitcnt lgkmcnt(6)
    v_smfmac_f32_16x16x64_bf16 v[112:115], v[48:51], v[64:71], v2
    ds_read_b128 v[64:67], v5 offset:32768
    ds_read_b128 v[68:71], v5 offset:33792
    s_waitcnt lgkmcnt(6)
    v_smfmac_f32_16x16x64_bf16 v[116:119], v[48:51], v[72:79], v2
    ds_read_b128 v[72:75], v5 offset:34816
    ds_read_b128 v[76:79], v5 offset:35840
    s_waitcnt lgkmcnt(6)
    v_smfmac_f32_16x16x64_bf16 v[112:115], v[52:55], v[80:87], v2
    ds_read_b128 v[80:83], v5 offset:49152
    ds_read_b128 v[84:87], v5 offset:50176
    s_waitcnt lgkmcnt(6)
    v_smfmac_f32_16x16x64_bf16 v[116:119], v[52:55], v[88:95], v2
    ds_read_b128 v[88:91], v5 offset:51200
    ds_read_b128 v[92:95], v5 offset:52224
    s_waitcnt lgkmcnt(6)
    v_smfmac_f32_16x16x64_bf16 v[112:115], v[56:59], v[64:71], v2
    s_waitcnt lgkmcnt(4)
    v_smfmac_f32_16x16x64_bf16 v[116:119], v[56:59], v[72:79], v2
    s_waitcnt lgkmcnt(2)
    v_smfmac_f32_16x16x64_bf16 v[112:115], v[60:63], v[80:87], v2
    s_waitcnt lgkmcnt(0)
    v_smfmac_f32_16x16x64_bf16 v[116:119], v[60:63], v[88:95], v2
    buffer_load_dwordx2 v[108:109], v11, s[4:7], s38 offen sc1
    v_mfma_f32_16x16x16_bf16 v[100:103], v[96:97], v[16:17], 0
    v_mfma_f32_16x16x16_bf16 v[104:107], v[98:99], v[16:17], 0
    s_nop 4
    v_add_f32 v112, v112, v114
    v_add_f32 v113, v113, v115
    v_add_f32 v114, v116, v118
    v_add_f32 v115, v117, v119
    v_cvt_pk_bf16_f32 v18, v112, v113
    v_cvt_pk_bf16_f32 v19, v114, v115
    v_and_or_b32 v18, v18, -2, s41
    buffer_load_dwordx2 v[110:111], v11, s[4:7], s38 offen offset:512 sc1
    s_barrier
    buffer_store_dwordx2 v[18:19], v11, s[4:7], s39 offen sc1
    v_mov_b32 v112, v18
    v_mov_b32 v114, v19
    v_mov_b32 v92, v28
    v_mov_b32 v93, 0
    s_waitcnt vmcnt(6)
    s_barrier
    ds_read_b128 v[32:35], v6 offset:9216
    ds_read_b128 v[36:39], v6 offset:10240
    ds_read_b128 v[40:43], v6 offset:14336
    ds_read_b128 v[44:47], v6 offset:15360
    ds_read_b128 v[48:51], v6 offset:19456
    ds_read_b128 v[52:55], v6 offset:20480
    ds_read_b128 v[56:59], v6 offset:24576
    ds_read_b128 v[60:63], v6 offset:25600
    buffer_load_dwordx2 v[20:21], v11, s[4:7], s38 offen sc1
    buffer_load_dwordx2 v[22:23], v11, s[4:7], s38 offen offset:512 sc1
    s_waitcnt vmcnt(4)
    v_mfma_f32_16x16x16_bf16 v[80:83], v[108:109], v[16:17], v[100:103]
    v_and_b32 v3, 1, v108
    v_cmp_ne_u32 vcc, s41, v3
    s_nop 5
    v_cvt_pk_bf16_f32 v64, v80, v81
    v_cvt_pk_bf16_f32 v65, v82, v83
    s_cbranch_vccnz mega_kernel_rs_w0_xslow
    s_waitcnt vmcnt(3)
    v_mfma_f32_16x16x16_bf16 v[84:87], v[110:111], v[16:17], v[104:107]
    v_and_b32 v3, 1, v110
    v_cmp_ne_u32 vcc, s41, v3
    s_nop 5
    v_cvt_pk_bf16_f32 v66, v84, v85
    v_cvt_pk_bf16_f32 v67, v86, v87
    ds_write_b128 v6, v[64:67] offset:8192
    s_cbranch_vccnz mega_kernel_rs_w0_xslow
mega_kernel_rs_w0_xok:
    s_cmp_eq_u32 s21, 63
    s_cbranch_scc1 mega_kernel_rs_w0_last
    buffer_load_dwordx2 v[116:117], v11, s[4:7], s40 offen sc1
    s_waitcnt lgkmcnt(1)
    v_mfma_f32_16x16x32_bf16 v[80:83], v[32:35], v[64:67], 0
    s_waitcnt lgkmcnt(0)
    s_barrier
    ds_read_b128 v[68:71], v6 offset:13312
    ds_read_b128 v[72:75], v6 offset:18432
    ds_read_b128 v[76:79], v6 offset:23552
    v_mfma_f32_16x16x32_bf16 v[84:87], v[36:39], v[64:67], 0
    v_mfma_f32_16x16x32_bf16 v[88:91], v[64:67], v[64:67], 0
    buffer_load_dwordx2 v[20:21], v11, s[4:7], s40 offen sc1
    s_waitcnt lgkmcnt(2)
    v_mfma_f32_16x16x32_bf16 v[80:83], v[40:43], v[68:71], v[80:83]
    buffer_store_dwordx4 v[64:67], v10, s[4:7], s45 offen offset:0 sc1
    s_waitcnt lgkmcnt(1)
    v_mfma_f32_16x16x32_bf16 v[80:83], v[48:51], v[72:75], v[80:83]
    s_waitcnt lgkmcnt(0)
    v_mfma_f32_16x16x32_bf16 v[80:83], v[56:59], v[76:79], v[80:83]
    v_mfma_f32_16x16x32_bf16 v[84:87], v[44:47], v[68:71], v[84:87]
    v_mfma_f32_16x16x32_bf16 v[84:87], v[52:55], v[72:75], v[84:87]
    buffer_store_dwordx2 v[18:19], v11, s[4:7], s51 offen offset:2048 sc1
    v_mfma_f32_16x16x32_bf16 v[84:87], v[60:63], v[76:79], v[84:87]
    v_mfma_f32_16x16x32_bf16 v[88:91], v[68:71], v[68:71], v[88:91]
    v_mfma_f32_16x16x32_bf16 v[88:91], v[72:75], v[72:75], v[88:91]
    v_mfma_f32_16x16x32_bf16 v[88:91], v[76:79], v[76:79], v[88:91]
    v_mfma_f32_32x32x4_2b_bf16 v[32:63], v[14:15], v[14:15], 0
    s_nop 0
    v_max3_f32 v4, v80, v81, v82
    s_nop 1
    v_max3_f32 v4, v4, v83, v84
    v_max3_f32 v4, v4, v85, v86
    v_max_f32 v4, v4, v87
    v_max3_f32 v90, v4, v88, v89
    v_max3_f32 v4, v4, v88, v89
    s_nop 1
    v_permlane16_swap_b32 v4, v90
    v_max_f32 v4, v4, v90
    v_max_f32 v90, v4, v90
    s_nop 1
    v_permlane32_swap_b32 v4, v90
    v_max_f32 v4, v4, v90
    v_mul_f32 v4, s34, v4
    v_pk_fma_f32 v[80:81], v[80:81], s[34:35], v[4:5] op_sel_hi:[1,0,0] neg_lo:[0,0,1] neg_hi:[0,0,1]
    v_pk_fma_f32 v[82:83], v[82:83], s[34:35], v[4:5] op_sel_hi:[1,0,0] neg_lo:[0,0,1] neg_hi:[0,0,1]
    v_pk_fma_f32 v[84:85], v[84:85], s[34:35], v[4:5] op_sel_hi:[1,0,0] neg_lo:[0,0,1] neg_hi:[0,0,1]
    v_pk_fma_f32 v[86:87], v[86:87], s[34:35], v[4:5] op_sel_hi:[1,0,0] neg_lo:[0,0,1] neg_hi:[0,0,1]
    v_pk_fma_f32 v[88:89], v[88:89], s[34:35], v[4:5] op_sel_hi:[1,0,0] neg_lo:[0,0,1] neg_hi:[0,0,1]
    v_exp_f32 v80, v80
    v_exp_f32 v81, v81
    v_exp_f32 v82, v82
    v_cvt_pk_bf16_f32 v68, v80, v81
    v_exp_f32 v83, v83
    v_exp_f32 v84, v84
    v_cvt_pk_bf16_f32 v69, v82, v83
    v_exp_f32 v85, v85
    v_exp_f32 v86, v86
    v_cvt_pk_bf16_f32 v70, v84, v85
    v_exp_f32 v87, v87
    v_exp_f32 v88, v88
    v_cvt_pk_bf16_f32 v71, v86, v87
    v_exp_f32 v89, v89
    s_waitcnt vmcnt(3)
    v_mfma_f32_16x16x32_bf16 v[76:79], v[28:31], v[68:71], 0
    v_and_b32 v3, 1, v116
    v_cvt_pk_bf16_f32 v72, v88, v89
    v_mfma_f32_16x16x32_bf16 v[100:103], v[120:123], v[68:71], 0
    v_cmp_ne_u32 vcc, s41, v3
    v_cvt_pk_bf16_f32 v73, v88, v89
    v_mfma_f32_16x16x32_bf16 v[104:107], v[124:127], v[68:71], 0
    v_mov_b32 v113, v116
    v_mov_b32 v115, v117
    v_mfma_f32_16x16x16_bf16 v[76:79], v[92:93], v[72:73], v[76:79]
    s_cbranch_vccnz mega_kernel_rs_w0_pv0
mega_kernel_rs_w0_pv2:
    v_mfma_f32_16x16x16_bf16 v[100:103], v[112:113], v[72:73], v[100:103]
    v_mfma_f32_16x16x16_bf16 v[104:107], v[114:115], v[72:73], v[104:107]
    buffer_load_dwordx4 v[120:123], v1, s[4:7], s44 offen
    buffer_load_dwordx4 v[124:127], v1, s[4:7], s44 offen offset:1024
    s_nop 2
    v_rcp_f32 v76, v76
    s_mov_b64 exec, s[28:29]
    v_pk_mul_f32 v[100:101], v[100:101], v[76:77] op_sel_hi:[1,0]
    v_pk_mul_f32 v[102:103], v[102:103], v[76:77] op_sel_hi:[1,0]
    v_pk_mul_f32 v[104:105], v[104:105], v[76:77] op_sel_hi:[1,0]
    v_pk_mul_f32 v[106:107], v[106:107], v[76:77] op_sel_hi:[1,0]
    v_cvt_pk_bf16_f32 v84, v100, v101
    v_cvt_pk_bf16_f32 v85, v102, v103
    v_cvt_pk_bf16_f32 v86, v104, v105
    v_cvt_pk_bf16_f32 v87, v106, v107
    ds_write_b128 v6, v[84:87] offset:28640
    s_mov_b64 exec, -1
    s_waitcnt lgkmcnt(0)
    s_barrier
    ds_read_b128 v[68:71], v6 offset:28672
    ds_read_b128 v[72:75], v6 offset:29696
    s_waitcnt lgkmcnt(1)
    v_smfmac_f32_16x16x64_bf16 v[32:35], v[68:71], v[128:135], v2
    s_add_u32 s21, s21, 1
    s_xor_b32 s38, s38, 1048576
    s_xor_b32 s37, s37, 1048576
    s_waitcnt lgkmcnt(0)
    v_smfmac_f32_16x16x64_bf16 v[32:35], v[72:75], v[136:143], v2
    s_xor_b32 s40, s40, 1048576
    s_xor_b32 s39, s39, 1048576
    s_lshr_b32 s41, s21, 1
    v_smfmac_f32_16x16x64_bf16 v[36:39], v[68:71], v[144:151], v2
    s_and_b32 s41, s41, 1
    s_xor_b32 s41, s41, 1
    s_xor_b32 s35, s35, 16384
    v_smfmac_f32_16x16x64_bf16 v[36:39], v[72:75], v[152:159], v2
    v_add_f32 v32, v32, v34
    s_xor_b32 s36, s36, 16384
    s_add_u32 s43, s43, 262144
    s_add_u32 s44, s44, 262144
    v_smfmac_f32_16x16x64_bf16 v[40:43], v[68:71], v[160:167], v2
    v_add_f32 v33, v33, v35
    v_smfmac_f32_16x16x64_bf16 v[40:43], v[72:75], v[168:175], v2
    v_cvt_pk_bf16_f32 v32, v32, v33
    v_smfmac_f32_16x16x64_bf16 v[44:47], v[68:71], v[176:183], v2
    v_and_or_b32 v32, v32, -2, s42
    v_smfmac_f32_16x16x64_bf16 v[44:47], v[72:75], v[184:191], v2
    v_add_f32 v36, v36, v38
    v_smfmac_f32_16x16x64_bf16 v[48:51], v[68:71], v[192:199], v2
    v_add_f32 v37, v37, v39
    v_smfmac_f32_16x16x64_bf16 v[48:51], v[72:75], v[200:207], v2
    v_cvt_pk_bf16_f32 v33, v36, v37
    v_smfmac_f32_16x16x64_bf16 v[52:55], v[68:71], v[208:215], v2
    v_add_f32 v40, v40, v42
    v_smfmac_f32_16x16x64_bf16 v[52:55], v[72:75], v[216:223], v2
    v_add_f32 v41, v41, v43
    v_smfmac_f32_16x16x64_bf16 v[56:59], v[68:71], v[224:231], v2
    v_cvt_pk_bf16_f32 v34, v40, v41
    v_smfmac_f32_16x16x64_bf16 v[56:59], v[72:75], v[232:239], v2
    v_add_f32 v44, v44, v46
    v_smfmac_f32_16x16x64_bf16 v[60:63], v[68:71], v[240:247], v2
    v_add_f32 v45, v45, v47
    v_smfmac_f32_16x16x64_bf16 v[60:63], v[72:75], v[248:255], v2
    v_cvt_pk_bf16_f32 v35, v44, v45
    buffer_store_dwordx4 v[32:35], v8, s[4:7], s46 offen sc1
    v_pk_add_f32 v[48:49], v[48:49], v[50:51]
    v_cvt_pk_bf16_f32 v48, v48, v49
    v_and_or_b32 v48, v48, -2, s42
    v_pk_add_f32 v[52:53], v[52:53], v[54:55]
    v_cvt_pk_bf16_f32 v49, v52, v53
    v_pk_add_f32 v[56:57], v[56:57], v[58:59]
    v_cvt_pk_bf16_f32 v50, v56, v57
    v_pk_add_f32 v[60:61], v[60:61], v[62:63]
    v_cvt_pk_bf16_f32 v51, v60, v61
    buffer_store_dwordx4 v[48:51], v8, s[4:7], s61 offen sc1
    s_add_u32 s45, s45, 262144
    s_add_u32 s51, s51, 262144
    v_mfma_f32_32x32x8_bf16 v[96:111], v[14:15], v[14:15], 0
    v_mfma_f32_16x16x16_bf16 v[112:115], v[14:15], v[14:15], 0
    v_mfma_f32_16x16x16_bf16 v[116:119], v[14:15], v[14:15], 0
    ds_read_b128 v[64:67], v1 offset:0
    ds_read_b128 v[68:71], v1 offset:1024
    ds_read_b128 v[72:75], v1 offset:2048
    ds_read_b128 v[76:79], v1 offset:3072
    ds_read_b128 v[80:83], v1 offset:16384
    ds_read_b128 v[84:87], v1 offset:17408
    ds_read_b128 v[88:91], v1 offset:18432
    ds_read_b128 v[92:95], v1 offset:19456
    v_mov_b32 v58, -1
    v_mov_b32 v59, -1
    s_waitcnt vmcnt(0)
mega_kernel_rs_w0_pc:
    buffer_load_dword v36, v13, s[4:7], s25 offen offset:0 sc1
    buffer_load_dword v37, v13, s[4:7], s25 offen offset:256 sc1
    buffer_load_dword v38, v13, s[4:7], s25 offen offset:512 sc1
    buffer_load_dword v39, v13, s[4:7], s25 offen offset:768 sc1
    buffer_load_dword v40, v13, s[4:7], s25 offen offset:1024 sc1
    buffer_load_dword v41, v13, s[4:7], s25 offen offset:1280 sc1
    buffer_load_dword v42, v13, s[4:7], s25 offen offset:1536 sc1
    buffer_load_dword v43, v13, s[4:7], s25 offen offset:1792 sc1
    s_waitcnt vmcnt(4)
    v_mfma_f32_16x16x32_bf16 v[52:55], v[36:39], v[24:27], 0
    v_bitop3_b32 v3, s42, v36, v37 bitop3:0x7e
    v_bitop3_b32 v4, s42, v38, v39 bitop3:0x7e
    s_waitcnt vmcnt(2)
    v_or_b32 v3, v3, v4
    v_bitop3_b32 v4, s42, v40, v41 bitop3:0x7e
    s_waitcnt vmcnt(0)
    v_mfma_f32_16x16x32_bf16 v[52:55], v[40:43], v[24:27], v[52:55]
    v_bitop3_b32 v56, s42, v42, v43 bitop3:0x7e
    v_or3_b32 v3, v3, v4, v56
    v_and_b32 v3, v0, v3
    v_cmp_ne_u32 vcc, 0, v3
    s_nop 3
    v_cvt_pk_bf16_f32 v56, v52, v53
    v_cvt_pk_bf16_f32 v57, v54, v55
    v_min_u32 v56, -2, v56
    s_cbranch_vccnz mega_kernel_rs_w0_pc
    s_mov_b64 exec, s[26:27]
    buffer_store_dwordx2 v[56:57], v9, s[4:7], s35 offen offset:0 sc1
    buffer_store_dwordx2 v[58:59], v9, s[4:7], s36 offen offset:0 sc1
    s_mov_b64 exec, -1
    s_xor_b32 s42, s42, 1
    s_branch mega_kernel_rs_w0_loop
mega_kernel_rs_w0_last:
    buffer_store_dwordx4 v[64:67], v10, s[4:7], s45 offen offset:0 sc1
    buffer_store_dwordx2 v[18:19], v11, s[4:7], s51 offen offset:2048 sc1
    s_branch mega_kernel_rs_end
mega_kernel_rs_w0_pafail:
    s_nop 7
    v_mov_b32 v96, 0
    v_mov_b32 v97, 0
    v_mov_b32 v98, 0
    v_mov_b32 v99, 0
    v_mov_b32 v100, 0
    v_mov_b32 v101, 0
    v_mov_b32 v102, 0
    v_mov_b32 v103, 0
    v_mov_b32 v104, 0
    v_mov_b32 v105, 0
    v_mov_b32 v106, 0
    v_mov_b32 v107, 0
    s_branch mega_kernel_rs_w0_pa
mega_kernel_rs_w0_xslow:
    buffer_load_dwordx2 v[108:109], v11, s[4:7], s38 offen sc1
    buffer_load_dwordx2 v[110:111], v11, s[4:7], s38 offen offset:512 sc1
    s_waitcnt vmcnt(2)
    v_bitop3_b32 v3, s41, v20, v22 bitop3:0x7e
    v_mfma_f32_16x16x16_bf16 v[80:83], v[20:21], v[16:17], v[100:103]
    v_and_b32 v3, 1, v3
    v_mfma_f32_16x16x16_bf16 v[84:87], v[22:23], v[16:17], v[104:107]
    v_cmp_ne_u32 vcc, 0, v3
    s_cbranch_vccz mega_kernel_rs_w0_xgot
    buffer_load_dwordx2 v[20:21], v11, s[4:7], s38 offen sc1
    buffer_load_dwordx2 v[22:23], v11, s[4:7], s38 offen offset:512 sc1
    s_waitcnt vmcnt(2)
    v_bitop3_b32 v3, s41, v108, v110 bitop3:0x7e
    v_mfma_f32_16x16x16_bf16 v[80:83], v[108:109], v[16:17], v[100:103]
    v_and_b32 v3, 1, v3
    v_mfma_f32_16x16x16_bf16 v[84:87], v[110:111], v[16:17], v[104:107]
    v_cmp_ne_u32 vcc, 0, v3
    s_cbranch_vccz mega_kernel_rs_w0_xgot
    s_branch mega_kernel_rs_w0_xslow
mega_kernel_rs_w0_xgot:
    s_nop 3
    v_cvt_pk_bf16_f32 v64, v80, v81
    v_cvt_pk_bf16_f32 v65, v82, v83
    v_cvt_pk_bf16_f32 v66, v84, v85
    v_cvt_pk_bf16_f32 v67, v86, v87
    ds_write_b128 v6, v[64:67] offset:8192
    s_branch mega_kernel_rs_w0_xok
mega_kernel_rs_w0_pv0:
    s_waitcnt vmcnt(2)
    s_branch mega_kernel_rs_w0_pv1
mega_kernel_rs_w0_pv:
    buffer_load_dwordx2 v[20:21], v11, s[4:7], s40 offen sc1
    s_waitcnt vmcnt(0)
mega_kernel_rs_w0_pv1:
    v_and_b32 v3, 1, v20
    v_cmp_ne_u32 vcc, s41, v3
    v_mov_b32 v113, v20
    v_mov_b32 v115, v21
    s_cbranch_vccnz mega_kernel_rs_w0_pv
    s_branch mega_kernel_rs_w0_pv2
mega_kernel_rs_w1_entry:
    v_mfma_f32_32x32x8_bf16 v[96:111], v[14:15], v[14:15], 0
    v_mfma_f32_16x16x16_bf16 v[112:115], v[14:15], v[14:15], 0
    v_mfma_f32_16x16x16_bf16 v[116:119], v[14:15], v[14:15], 0
    ds_read_b128 v[64:67], v1 offset:4096
    ds_read_b128 v[68:71], v1 offset:5120
    ds_read_b128 v[72:75], v1 offset:6144
    ds_read_b128 v[76:79], v1 offset:7168
    ds_read_b128 v[80:83], v1 offset:20480
    ds_read_b128 v[84:87], v1 offset:21504
    ds_read_b128 v[88:91], v1 offset:22528
    ds_read_b128 v[92:95], v1 offset:23552
    buffer_load_dwordx4 v[120:123], v1, s[4:7], s44 offen
    buffer_load_dwordx4 v[124:127], v1, s[4:7], s44 offen offset:1024
    s_add_u32 s44, s44, 262144
mega_kernel_rs_w1_loop:
    s_add_u32 s22, s35, 2048
    s_waitcnt vmcnt(0)
    buffer_load_dwordx4 v[40:43], v1, s[4:7], s22 offen sc1
    buffer_load_dwordx4 v[44:47], v1, s[4:7], s22 offen offset:1024 sc1
mega_kernel_rs_w1_pa:
    s_waitcnt vmcnt(1)
    ds_write_b128 v6, v[40:43] offset:2048
    s_waitcnt vmcnt(0)
    ds_write_b128 v6, v[44:47] offset:3072
    v_max3_u32 v3, v40, v42, v44
    v_max_u32 v3, v3, v46
    v_cmp_eq_u32 vcc, -1, v3
    v_smfmac_f32_16x16x64_bf16 v[96:99], v[40:43], a[32:39], v2
    buffer_load_dwordx4 v[40:43], v1, s[4:7], s22 offen sc1
    v_smfmac_f32_16x16x64_bf16 v[100:103], v[40:43], a[40:47], v2
    buffer_load_dwordx4 v[44:47], v1, s[4:7], s22 offen offset:1024 sc1
    v_smfmac_f32_16x16x64_bf16 v[104:107], v[40:43], a[160:167], v2
    s_cbranch_vccnz mega_kernel_rs_w1_pafail
    s_waitcnt lgkmcnt(0)
    s_barrier
    ds_read_b128 v[48:51], v6 offset:4096
    ds_read_b128 v[52:55], v6 offset:5120
    v_smfmac_f32_16x16x64_bf16 v[108:111], v[40:43], a[168:175], v2
    ds_read_b128 v[56:59], v6 offset:6144
    v_smfmac_f32_16x16x64_bf16 v[96:99], v[44:47], a[48:55], v2
    ds_read_b128 v[60:63], v6 offset:7168
    v_smfmac_f32_16x16x64_bf16 v[100:103], v[44:47], a[56:63], v2
    ds_read_b128 v[32:35], v6 offset:0
    v_smfmac_f32_16x16x64_bf16 v[104:107], v[44:47], a[176:183], v2
    ds_read_b128 v[36:39], v6 offset:1024
    v_smfmac_f32_16x16x64_bf16 v[108:111], v[44:47], a[184:191], v2
    s_waitcnt lgkmcnt(5)
    v_smfmac_f32_16x16x64_bf16 v[96:99], v[48:51], a[64:71], v2
    buffer_load_dwordx4 v1, s[4:7], s43 offen lds
    v_smfmac_f32_16x16x64_bf16 v[104:107], v[48:51], a[192:199], v2
    s_waitcnt lgkmcnt(4)
    v_smfmac_f32_16x16x64_bf16 v[96:99], v[52:55], a[80:87], v2
    v_smfmac_f32_16x16x64_bf16 v[104:107], v[52:55], a[208:215], v2
    s_waitcnt lgkmcnt(3)
    v_smfmac_f32_16x16x64_bf16 v[96:99], v[56:59], a[96:103], v2
    buffer_load_dwordx4 v1, s[4:7], s43 offen offset:1024 lds
    v_smfmac_f32_16x16x64_bf16 v[104:107], v[56:59], a[224:231], v2
    s_waitcnt lgkmcnt(2)
    v_smfmac_f32_16x16x64_bf16 v[96:99], v[60:63], a[112:119], v2
    v_smfmac_f32_16x16x64_bf16 v[104:107], v[60:63], a[240:247], v2
    s_waitcnt lgkmcnt(1)
    v_smfmac_f32_16x16x64_bf16 v[96:99], v[32:35], a[0:7], v2
    v_smfmac_f32_16x16x64_bf16 v[104:107], v[32:35], a[128:135], v2
    s_waitcnt lgkmcnt(0)
    v_smfmac_f32_16x16x64_bf16 v[96:99], v[36:39], a[16:23], v2
    v_smfmac_f32_16x16x64_bf16 v[104:107], v[36:39], a[144:151], v2
    v_smfmac_f32_16x16x64_bf16 v[100:103], v[48:51], a[72:79], v2
    s_nop 2
    v_smfmac_f32_16x16x64_bf16 v[100:103], v[52:55], a[88:95], v2
    s_nop 1
    v_add_f32 v96, v96, v98
    v_smfmac_f32_16x16x64_bf16 v[100:103], v[56:59], a[104:111], v2
    v_add_f32 v97, v97, v99
    v_add_f32 v104, v104, v106
    v_smfmac_f32_16x16x64_bf16 v[100:103], v[60:63], a[120:127], v2
    v_add_f32 v105, v105, v107
    v_cvt_pk_bf16_f32 v96, v96, v97
    v_smfmac_f32_16x16x64_bf16 v[100:103], v[32:35], a[8:15], v2
    v_cvt_pk_bf16_f32 v97, v104, v105
    v_and_or_b32 v96, v96, -2, s41
    v_smfmac_f32_16x16x64_bf16 v[100:103], v[36:39], a[24:31], v2
    buffer_store_dwordx2 v[96:97], v11, s[4:7], s37 offen sc1
    v_smfmac_f32_16x16x64_bf16 v[108:111], v[48:51], a[200:207], v2
    v_smfmac_f32_16x16x64_bf16 v[108:111], v[52:55], a[216:223], v2
    v_smfmac_f32_16x16x64_bf16 v[108:111], v[56:59], a[232:239], v2
    v_smfmac_f32_16x16x64_bf16 v[108:111], v[60:63], a[248:255], v2
    v_smfmac_f32_16x16x64_bf16 v[108:111], v[32:35], a[136:143], v2
    s_nop 2
    v_add_f32 v100, v100, v102
    v_smfmac_f32_16x16x64_bf16 v[108:111], v[36:39], a[152:159], v2
    v_add_f32 v101, v101, v103
    v_cvt_pk_bf16_f32 v98, v100, v101
    v_and_or_b32 v98, v98, -2, s41
    s_nop 4
    v_pk_add_f32 v[108:109], v[108:109], v[110:111]
    v_cvt_pk_bf16_f32 v99, v108, v109
    buffer_store_dwordx2 v[98:99], v11, s[4:7], s37 offen offset:512 sc1
    v_smfmac_f32_16x16x64_bf16 v[112:115], v[32:35], v[64:71], v2
    ds_read_b128 v[64:67], v1 offset:36864
    ds_read_b128 v[68:71], v1 offset:37888
    v_smfmac_f32_16x16x64_bf16 v[116:119], v[32:35], v[72:79], v2
    ds_read_b128 v[72:75], v1 offset:38912
    ds_read_b128 v[76:79], v1 offset:39936
    v_smfmac_f32_16x16x64_bf16 v[112:115], v[36:39], v[80:87], v2
    ds_read_b128 v[80:83], v1 offset:53248
    ds_read_b128 v[84:87], v1 offset:54272
    v_smfmac_f32_16x16x64_bf16 v[116:119], v[36:39], v[88:95], v2
    ds_read_b128 v[88:91], v1 offset:55296
    ds_read_b128 v[92:95], v1 offset:56320
    s_waitcnt lgkmcnt(6)
    v_smfmac_f32_16x16x64_bf16 v[112:115], v[40:43], v[64:71], v2
    ds_read_b128 v[64:67], v5 offset:4096
    ds_read_b128 v[68:71], v5 offset:5120
    s_waitcnt lgkmcnt(6)
    v_smfmac_f32_16x16x64_bf16 v[116:119], v[40:43], v[72:79], v2
    ds_read_b128 v[72:75], v5 offset:6144
    ds_read_b128 v[76:79], v5 offset:7168
    s_waitcnt lgkmcnt(6)
    v_smfmac_f32_16x16x64_bf16 v[112:115], v[44:47], v[80:87], v2
    ds_read_b128 v[80:83], v5 offset:20480
    ds_read_b128 v[84:87], v5 offset:21504
    s_waitcnt lgkmcnt(6)
    v_smfmac_f32_16x16x64_bf16 v[116:119], v[44:47], v[88:95], v2
    ds_read_b128 v[88:91], v5 offset:22528
    ds_read_b128 v[92:95], v5 offset:23552
    s_waitcnt lgkmcnt(6)
    v_smfmac_f32_16x16x64_bf16 v[112:115], v[48:51], v[64:71], v2
    ds_read_b128 v[64:67], v5 offset:36864
    ds_read_b128 v[68:71], v5 offset:37888
    s_waitcnt lgkmcnt(6)
    v_smfmac_f32_16x16x64_bf16 v[116:119], v[48:51], v[72:79], v2
    ds_read_b128 v[72:75], v5 offset:38912
    ds_read_b128 v[76:79], v5 offset:39936
    s_waitcnt lgkmcnt(6)
    v_smfmac_f32_16x16x64_bf16 v[112:115], v[52:55], v[80:87], v2
    ds_read_b128 v[80:83], v5 offset:53248
    ds_read_b128 v[84:87], v5 offset:54272
    s_waitcnt lgkmcnt(6)
    v_smfmac_f32_16x16x64_bf16 v[116:119], v[52:55], v[88:95], v2
    ds_read_b128 v[88:91], v5 offset:55296
    ds_read_b128 v[92:95], v5 offset:56320
    s_waitcnt lgkmcnt(6)
    v_smfmac_f32_16x16x64_bf16 v[112:115], v[56:59], v[64:71], v2
    s_waitcnt lgkmcnt(4)
    v_smfmac_f32_16x16x64_bf16 v[116:119], v[56:59], v[72:79], v2
    s_waitcnt lgkmcnt(2)
    v_smfmac_f32_16x16x64_bf16 v[112:115], v[60:63], v[80:87], v2
    s_waitcnt lgkmcnt(0)
    v_smfmac_f32_16x16x64_bf16 v[116:119], v[60:63], v[88:95], v2
    buffer_load_dwordx2 v[108:109], v11, s[4:7], s38 offen sc1
    v_mfma_f32_16x16x16_bf16 v[100:103], v[96:97], v[16:17], 0
    v_mfma_f32_16x16x16_bf16 v[104:107], v[98:99], v[16:17], 0
    s_nop 4
    v_add_f32 v112, v112, v114
    v_add_f32 v113, v113, v115
    v_add_f32 v114, v116, v118
    v_add_f32 v115, v117, v119
    v_cvt_pk_bf16_f32 v18, v112, v113
    v_cvt_pk_bf16_f32 v19, v114, v115
    v_and_or_b32 v18, v18, -2, s41
    buffer_load_dwordx2 v[110:111], v11, s[4:7], s38 offen offset:512 sc1
    s_barrier
    buffer_store_dwordx2 v[18:19], v11, s[4:7], s39 offen sc1
    v_mov_b32 v112, v18
    v_mov_b32 v114, v19
    v_mov_b32 v92, v28
    v_mov_b32 v93, 0
    s_waitcnt vmcnt(5)
    s_barrier
    ds_read_b128 v[32:35], v6 offset:14336
    ds_read_b128 v[36:39], v6 offset:15360
    ds_read_b128 v[40:43], v6 offset:9216
    ds_read_b128 v[44:47], v6 offset:10240
    ds_read_b128 v[48:51], v6 offset:24576
    ds_read_b128 v[52:55], v6 offset:25600
    ds_read_b128 v[56:59], v6 offset:19456
    ds_read_b128 v[60:63], v6 offset:20480
    buffer_load_dwordx2 v[20:21], v11, s[4:7], s38 offen sc1
    buffer_load_dwordx2 v[22:23], v11, s[4:7], s38 offen offset:512 sc1
    s_waitcnt vmcnt(4)
    v_mfma_f32_16x16x16_bf16 v[80:83], v[108:109], v[16:17], v[100:103]
    v_and_b32 v3, 1, v108
    v_cmp_ne_u32 vcc, s41, v3
    s_nop 5
    v_cvt_pk_bf16_f32 v64, v80, v81
    v_cvt_pk_bf16_f32 v65, v82, v83
    s_cbranch_vccnz mega_kernel_rs_w1_xslow
    s_waitcnt vmcnt(3)
    v_mfma_f32_16x16x16_bf16 v[84:87], v[110:111], v[16:17], v[104:107]
    v_and_b32 v3, 1, v110
    v_cmp_ne_u32 vcc, s41, v3
    s_nop 5
    v_cvt_pk_bf16_f32 v66, v84, v85
    v_cvt_pk_bf16_f32 v67, v86, v87
    ds_write_b128 v6, v[64:67] offset:13312
    s_cbranch_vccnz mega_kernel_rs_w1_xslow
mega_kernel_rs_w1_xok:
    s_cmp_eq_u32 s21, 63
    s_cbranch_scc1 mega_kernel_rs_w1_last
    buffer_load_dwordx2 v[116:117], v11, s[4:7], s40 offen sc1
    s_waitcnt lgkmcnt(1)
    v_mfma_f32_16x16x32_bf16 v[80:83], v[32:35], v[64:67], 0
    s_waitcnt lgkmcnt(0)
    s_barrier
    ds_read_b128 v[68:71], v6 offset:8192
    ds_read_b128 v[72:75], v6 offset:23552
    ds_read_b128 v[76:79], v6 offset:18432
    v_mfma_f32_16x16x32_bf16 v[84:87], v[36:39], v[64:67], 0
    v_mfma_f32_16x16x32_bf16 v[88:91], v[64:67], v[64:67], 0
    buffer_load_dwordx2 v[20:21], v11, s[4:7], s40 offen sc1
    s_waitcnt lgkmcnt(2)
    v_mfma_f32_16x16x32_bf16 v[80:83], v[40:43], v[68:71], v[80:83]
    s_waitcnt lgkmcnt(1)
    v_mfma_f32_16x16x32_bf16 v[80:83], v[48:51], v[72:75], v[80:83]
    buffer_store_dwordx4 v[64:67], v10, s[4:7], s45 offen offset:64 sc1
    s_waitcnt lgkmcnt(0)
    v_mfma_f32_16x16x32_bf16 v[80:83], v[56:59], v[76:79], v[80:83]
    v_mfma_f32_16x16x32_bf16 v[84:87], v[44:47], v[68:71], v[84:87]
    v_mfma_f32_16x16x32_bf16 v[84:87], v[52:55], v[72:75], v[84:87]
    v_mfma_f32_16x16x32_bf16 v[84:87], v[60:63], v[76:79], v[84:87]
    buffer_store_dwordx2 v[18:19], v11, s[4:7], s51 offen offset:2560 sc1
    v_mfma_f32_16x16x32_bf16 v[88:91], v[68:71], v[68:71], v[88:91]
    v_mfma_f32_16x16x32_bf16 v[88:91], v[72:75], v[72:75], v[88:91]
    v_mfma_f32_16x16x32_bf16 v[88:91], v[76:79], v[76:79], v[88:91]
    v_mfma_f32_32x32x4_2b_bf16 v[32:63], v[14:15], v[14:15], 0
    s_nop 0
    v_max3_f32 v4, v80, v81, v82
    s_nop 1
    v_max3_f32 v4, v4, v83, v84
    v_max3_f32 v4, v4, v85, v86
    v_max_f32 v4, v4, v87
    v_max3_f32 v90, v4, v88, v89
    v_max3_f32 v4, v4, v88, v89
    s_nop 1
    v_permlane16_swap_b32 v4, v90
    v_max_f32 v4, v4, v90
    v_max_f32 v90, v4, v90
    s_nop 1
    v_permlane32_swap_b32 v4, v90
    v_max_f32 v4, v4, v90
    v_mul_f32 v4, s34, v4
    v_pk_fma_f32 v[80:81], v[80:81], s[34:35], v[4:5] op_sel_hi:[1,0,0] neg_lo:[0,0,1] neg_hi:[0,0,1]
    v_pk_fma_f32 v[82:83], v[82:83], s[34:35], v[4:5] op_sel_hi:[1,0,0] neg_lo:[0,0,1] neg_hi:[0,0,1]
    v_pk_fma_f32 v[84:85], v[84:85], s[34:35], v[4:5] op_sel_hi:[1,0,0] neg_lo:[0,0,1] neg_hi:[0,0,1]
    v_pk_fma_f32 v[86:87], v[86:87], s[34:35], v[4:5] op_sel_hi:[1,0,0] neg_lo:[0,0,1] neg_hi:[0,0,1]
    v_pk_fma_f32 v[88:89], v[88:89], s[34:35], v[4:5] op_sel_hi:[1,0,0] neg_lo:[0,0,1] neg_hi:[0,0,1]
    v_exp_f32 v80, v80
    v_exp_f32 v81, v81
    v_exp_f32 v82, v82
    v_cvt_pk_bf16_f32 v68, v80, v81
    v_exp_f32 v83, v83
    v_exp_f32 v84, v84
    v_cvt_pk_bf16_f32 v69, v82, v83
    v_exp_f32 v85, v85
    v_exp_f32 v86, v86
    v_cvt_pk_bf16_f32 v70, v84, v85
    v_exp_f32 v87, v87
    v_exp_f32 v88, v88
    v_cvt_pk_bf16_f32 v71, v86, v87
    v_exp_f32 v89, v89
    s_waitcnt vmcnt(3)
    v_mfma_f32_16x16x32_bf16 v[76:79], v[28:31], v[68:71], 0
    v_and_b32 v3, 1, v116
    v_cvt_pk_bf16_f32 v72, v88, v89
    v_mfma_f32_16x16x32_bf16 v[100:103], v[120:123], v[68:71], 0
    v_cmp_ne_u32 vcc, s41, v3
    v_cvt_pk_bf16_f32 v73, v88, v89
    v_mfma_f32_16x16x32_bf16 v[104:107], v[124:127], v[68:71], 0
    v_mov_b32 v113, v116
    v_mov_b32 v115, v117
    v_mfma_f32_16x16x16_bf16 v[76:79], v[92:93], v[72:73], v[76:79]
    s_cbranch_vccnz mega_kernel_rs_w1_pv0
mega_kernel_rs_w1_pv2:
    v_mfma_f32_16x16x16_bf16 v[100:103], v[112:113], v[72:73], v[100:103]
    v_mfma_f32_16x16x16_bf16 v[104:107], v[114:115], v[72:73], v[104:107]
    buffer_load_dwordx4 v[120:123], v1, s[4:7], s44 offen
    buffer_load_dwordx4 v[124:127], v1, s[4:7], s44 offen offset:1024
    s_nop 2
    v_rcp_f32 v76, v76
    s_mov_b64 exec, s[28:29]
    v_pk_mul_f32 v[100:101], v[100:101], v[76:77] op_sel_hi:[1,0]
    v_pk_mul_f32 v[102:103], v[102:103], v[76:77] op_sel_hi:[1,0]
    v_pk_mul_f32 v[104:105], v[104:105], v[76:77] op_sel_hi:[1,0]
    v_pk_mul_f32 v[106:107], v[106:107], v[76:77] op_sel_hi:[1,0]
    v_cvt_pk_bf16_f32 v84, v100, v101
    v_cvt_pk_bf16_f32 v85, v102, v103
    v_cvt_pk_bf16_f32 v86, v104, v105
    v_cvt_pk_bf16_f32 v87, v106, v107
    ds_write_b128 v6, v[84:87] offset:28672
    s_mov_b64 exec, -1
    s_waitcnt lgkmcnt(0)
    s_barrier
    ds_read_b128 v[68:71], v6 offset:28672
    ds_read_b128 v[72:75], v6 offset:29696
    s_waitcnt lgkmcnt(1)
    v_smfmac_f32_16x16x64_bf16 v[32:35], v[68:71], v[128:135], v2
    s_add_u32 s21, s21, 1
    s_xor_b32 s38, s38, 1048576
    s_xor_b32 s37, s37, 1048576
    s_waitcnt lgkmcnt(0)
    v_smfmac_f32_16x16x64_bf16 v[32:35], v[72:75], v[136:143], v2
    s_xor_b32 s40, s40, 1048576
    s_xor_b32 s39, s39, 1048576
    s_lshr_b32 s41, s21, 1
    v_smfmac_f32_16x16x64_bf16 v[36:39], v[68:71], v[144:151], v2
    s_and_b32 s41, s41, 1
    s_xor_b32 s41, s41, 1
    s_xor_b32 s35, s35, 16384
    v_smfmac_f32_16x16x64_bf16 v[36:39], v[72:75], v[152:159], v2
    v_add_f32 v32, v32, v34
    s_xor_b32 s36, s36, 16384
    s_add_u32 s43, s43, 262144
    s_add_u32 s44, s44, 262144
    v_smfmac_f32_16x16x64_bf16 v[40:43], v[68:71], v[160:167], v2
    v_add_f32 v33, v33, v35
    v_smfmac_f32_16x16x64_bf16 v[40:43], v[72:75], v[168:175], v2
    v_cvt_pk_bf16_f32 v32, v32, v33
    v_smfmac_f32_16x16x64_bf16 v[44:47], v[68:71], v[176:183], v2
    v_and_or_b32 v32, v32, -2, s42
    v_smfmac_f32_16x16x64_bf16 v[44:47], v[72:75], v[184:191], v2
    v_add_f32 v36, v36, v38
    v_smfmac_f32_16x16x64_bf16 v[48:51], v[68:71], v[192:199], v2
    v_add_f32 v37, v37, v39
    v_smfmac_f32_16x16x64_bf16 v[48:51], v[72:75], v[200:207], v2
    v_cvt_pk_bf16_f32 v33, v36, v37
    v_smfmac_f32_16x16x64_bf16 v[52:55], v[68:71], v[208:215], v2
    v_add_f32 v40, v40, v42
    v_smfmac_f32_16x16x64_bf16 v[52:55], v[72:75], v[216:223], v2
    v_add_f32 v41, v41, v43
    v_smfmac_f32_16x16x64_bf16 v[56:59], v[68:71], v[224:231], v2
    v_cvt_pk_bf16_f32 v34, v40, v41
    v_smfmac_f32_16x16x64_bf16 v[56:59], v[72:75], v[232:239], v2
    v_add_f32 v44, v44, v46
    v_smfmac_f32_16x16x64_bf16 v[60:63], v[68:71], v[240:247], v2
    v_add_f32 v45, v45, v47
    v_smfmac_f32_16x16x64_bf16 v[60:63], v[72:75], v[248:255], v2
    v_cvt_pk_bf16_f32 v35, v44, v45
    buffer_store_dwordx4 v[32:35], v8, s[4:7], s46 offen sc1
    v_pk_add_f32 v[48:49], v[48:49], v[50:51]
    v_cvt_pk_bf16_f32 v48, v48, v49
    v_and_or_b32 v48, v48, -2, s42
    v_pk_add_f32 v[52:53], v[52:53], v[54:55]
    v_cvt_pk_bf16_f32 v49, v52, v53
    v_pk_add_f32 v[56:57], v[56:57], v[58:59]
    v_cvt_pk_bf16_f32 v50, v56, v57
    v_pk_add_f32 v[60:61], v[60:61], v[62:63]
    v_cvt_pk_bf16_f32 v51, v60, v61
    buffer_store_dwordx4 v[48:51], v8, s[4:7], s61 offen sc1
    s_add_u32 s45, s45, 262144
    s_add_u32 s51, s51, 262144
    v_mfma_f32_32x32x8_bf16 v[96:111], v[14:15], v[14:15], 0
    v_mfma_f32_16x16x16_bf16 v[112:115], v[14:15], v[14:15], 0
    v_mfma_f32_16x16x16_bf16 v[116:119], v[14:15], v[14:15], 0
    ds_read_b128 v[64:67], v1 offset:4096
    ds_read_b128 v[68:71], v1 offset:5120
    ds_read_b128 v[72:75], v1 offset:6144
    ds_read_b128 v[76:79], v1 offset:7168
    ds_read_b128 v[80:83], v1 offset:20480
    ds_read_b128 v[84:87], v1 offset:21504
    ds_read_b128 v[88:91], v1 offset:22528
    ds_read_b128 v[92:95], v1 offset:23552
    v_mov_b32 v58, -1
    v_mov_b32 v59, -1
    s_waitcnt vmcnt(0)
mega_kernel_rs_w1_pc:
    buffer_load_dword v36, v13, s[4:7], s25 offen offset:0 sc1
    buffer_load_dword v37, v13, s[4:7], s25 offen offset:256 sc1
    buffer_load_dword v38, v13, s[4:7], s25 offen offset:512 sc1
    buffer_load_dword v39, v13, s[4:7], s25 offen offset:768 sc1
    buffer_load_dword v40, v13, s[4:7], s25 offen offset:1024 sc1
    buffer_load_dword v41, v13, s[4:7], s25 offen offset:1280 sc1
    buffer_load_dword v42, v13, s[4:7], s25 offen offset:1536 sc1
    buffer_load_dword v43, v13, s[4:7], s25 offen offset:1792 sc1
    s_waitcnt vmcnt(4)
    v_mfma_f32_16x16x32_bf16 v[52:55], v[36:39], v[24:27], 0
    v_bitop3_b32 v3, s42, v36, v37 bitop3:0x7e
    v_bitop3_b32 v4, s42, v38, v39 bitop3:0x7e
    s_waitcnt vmcnt(2)
    v_or_b32 v3, v3, v4
    v_bitop3_b32 v4, s42, v40, v41 bitop3:0x7e
    s_waitcnt vmcnt(0)
    v_mfma_f32_16x16x32_bf16 v[52:55], v[40:43], v[24:27], v[52:55]
    v_bitop3_b32 v56, s42, v42, v43 bitop3:0x7e
    v_or3_b32 v3, v3, v4, v56
    v_and_b32 v3, v0, v3
    v_cmp_ne_u32 vcc, 0, v3
    s_nop 3
    v_cvt_pk_bf16_f32 v56, v52, v53
    v_cvt_pk_bf16_f32 v57, v54, v55
    v_min_u32 v56, -2, v56
    s_cbranch_vccnz mega_kernel_rs_w1_pc
    s_mov_b64 exec, s[26:27]
    buffer_store_dwordx2 v[56:57], v9, s[4:7], s35 offen offset:256 sc1
    buffer_store_dwordx2 v[58:59], v9, s[4:7], s36 offen offset:256 sc1
    s_mov_b64 exec, -1
    s_xor_b32 s42, s42, 1
    s_branch mega_kernel_rs_w1_loop
mega_kernel_rs_w1_last:
    buffer_store_dwordx4 v[64:67], v10, s[4:7], s45 offen offset:64 sc1
    buffer_store_dwordx2 v[18:19], v11, s[4:7], s51 offen offset:2560 sc1
    s_branch mega_kernel_rs_end
mega_kernel_rs_w1_pafail:
    s_nop 7
    v_mov_b32 v96, 0
    v_mov_b32 v97, 0
    v_mov_b32 v98, 0
    v_mov_b32 v99, 0
    v_mov_b32 v100, 0
    v_mov_b32 v101, 0
    v_mov_b32 v102, 0
    v_mov_b32 v103, 0
    v_mov_b32 v104, 0
    v_mov_b32 v105, 0
    v_mov_b32 v106, 0
    v_mov_b32 v107, 0
    s_branch mega_kernel_rs_w1_pa
mega_kernel_rs_w1_xslow:
    buffer_load_dwordx2 v[108:109], v11, s[4:7], s38 offen sc1
    buffer_load_dwordx2 v[110:111], v11, s[4:7], s38 offen offset:512 sc1
    s_waitcnt vmcnt(2)
    v_bitop3_b32 v3, s41, v20, v22 bitop3:0x7e
    v_mfma_f32_16x16x16_bf16 v[80:83], v[20:21], v[16:17], v[100:103]
    v_and_b32 v3, 1, v3
    v_mfma_f32_16x16x16_bf16 v[84:87], v[22:23], v[16:17], v[104:107]
    v_cmp_ne_u32 vcc, 0, v3
    s_cbranch_vccz mega_kernel_rs_w1_xgot
    buffer_load_dwordx2 v[20:21], v11, s[4:7], s38 offen sc1
    buffer_load_dwordx2 v[22:23], v11, s[4:7], s38 offen offset:512 sc1
    s_waitcnt vmcnt(2)
    v_bitop3_b32 v3, s41, v108, v110 bitop3:0x7e
    v_mfma_f32_16x16x16_bf16 v[80:83], v[108:109], v[16:17], v[100:103]
    v_and_b32 v3, 1, v3
    v_mfma_f32_16x16x16_bf16 v[84:87], v[110:111], v[16:17], v[104:107]
    v_cmp_ne_u32 vcc, 0, v3
    s_cbranch_vccz mega_kernel_rs_w1_xgot
    s_branch mega_kernel_rs_w1_xslow
mega_kernel_rs_w1_xgot:
    s_nop 3
    v_cvt_pk_bf16_f32 v64, v80, v81
    v_cvt_pk_bf16_f32 v65, v82, v83
    v_cvt_pk_bf16_f32 v66, v84, v85
    v_cvt_pk_bf16_f32 v67, v86, v87
    ds_write_b128 v6, v[64:67] offset:13312
    s_branch mega_kernel_rs_w1_xok
mega_kernel_rs_w1_pv0:
    s_waitcnt vmcnt(2)
    s_branch mega_kernel_rs_w1_pv1
mega_kernel_rs_w1_pv:
    buffer_load_dwordx2 v[20:21], v11, s[4:7], s40 offen sc1
    s_waitcnt vmcnt(0)
mega_kernel_rs_w1_pv1:
    v_and_b32 v3, 1, v20
    v_cmp_ne_u32 vcc, s41, v3
    v_mov_b32 v113, v20
    v_mov_b32 v115, v21
    s_cbranch_vccnz mega_kernel_rs_w1_pv
    s_branch mega_kernel_rs_w1_pv2
mega_kernel_rs_w2_entry:
    v_mfma_f32_32x32x8_bf16 v[96:111], v[14:15], v[14:15], 0
    v_mfma_f32_16x16x16_bf16 v[112:115], v[14:15], v[14:15], 0
    v_mfma_f32_16x16x16_bf16 v[116:119], v[14:15], v[14:15], 0
    ds_read_b128 v[64:67], v1 offset:8192
    ds_read_b128 v[68:71], v1 offset:9216
    ds_read_b128 v[72:75], v1 offset:10240
    ds_read_b128 v[76:79], v1 offset:11264
    ds_read_b128 v[80:83], v1 offset:24576
    ds_read_b128 v[84:87], v1 offset:25600
    ds_read_b128 v[88:91], v1 offset:26624
    ds_read_b128 v[92:95], v1 offset:27648
    buffer_load_dwordx4 v[120:123], v1, s[4:7], s44 offen
    buffer_load_dwordx4 v[124:127], v1, s[4:7], s44 offen offset:1024
    s_add_u32 s44, s44, 262144
mega_kernel_rs_w2_loop:
    s_add_u32 s22, s35, 4096
    s_waitcnt vmcnt(0)
    buffer_load_dwordx4 v[48:51], v1, s[4:7], s22 offen sc1
    buffer_load_dwordx4 v[52:55], v1, s[4:7], s22 offen offset:1024 sc1
mega_kernel_rs_w2_pa:
    s_waitcnt vmcnt(1)
    ds_write_b128 v6, v[48:51] offset:4096
    s_waitcnt vmcnt(0)
    ds_write_b128 v6, v[52:55] offset:5120
    v_max3_u32 v3, v48, v50, v52
    v_max_u32 v3, v3, v54
    v_cmp_eq_u32 vcc, -1, v3
    v_smfmac_f32_16x16x64_bf16 v[96:99], v[48:51], a[64:71], v2
    buffer_load_dwordx4 v[48:51], v1, s[4:7], s22 offen sc1
    v_smfmac_f32_16x16x64_bf16 v[100:103], v[48:51], a[72:79], v2
    buffer_load_dwordx4 v[52:55], v1, s[4:7], s22 offen offset:1024 sc1
    v_smfmac_f32_16x16x64_bf16 v[104:107], v[48:51], a[192:199], v2
    s_cbranch_vccnz mega_kernel_rs_w2_pafail
    s_waitcnt lgkmcnt(0)
    s_barrier
    ds_read_b128 v[56:59], v6 offset:6144
    ds_read_b128 v[60:63], v6 offset:7168
    v_smfmac_f32_16x16x64_bf16 v[108:111], v[48:51], a[200:207], v2
    ds_read_b128 v[32:35], v6 offset:0
    v_smfmac_f32_16x16x64_bf16 v[96:99], v[52:55], a[80:87], v2
    ds_read_b128 v[36:39], v6 offset:1024
    v_smfmac_f32_16x16x64_bf16 v[100:103], v[52:55], a[88:95], v2
    ds_read_b128 v[40:43], v6 offset:2048
    v_smfmac_f32_16x16x64_bf16 v[104:107], v[52:55], a[208:215], v2
    ds_read_b128 v[44:47], v6 offset:3072
    v_smfmac_f32_16x16x64_bf16 v[108:111], v[52:55], a[216:223], v2
    s_waitcnt lgkmcnt(5)
    v_smfmac_f32_16x16x64_bf16 v[96:99], v[56:59], a[96:103], v2
    v_smfmac_f32_16x16x64_bf16 v[104:107], v[56:59], a[224:231], v2
    buffer_load_dwordx4 v1, s[4:7], s43 offen lds
    s_waitcnt lgkmcnt(4)
    v_smfmac_f32_16x16x64_bf16 v[96:99], v[60:63], a[112:119], v2
    v_smfmac_f32_16x16x64_bf16 v[104:107], v[60:63], a[240:247], v2
    s_waitcnt lgkmcnt(3)
    v_smfmac_f32_16x16x64_bf16 v[96:99], v[32:35], a[0:7], v2
    v_smfmac_f32_16x16x64_bf16 v[104:107], v[32:35], a[128:135], v2
    buffer_load_dwordx4 v1, s[4:7], s43 offen offset:1024 lds
    s_waitcnt lgkmcnt(2)
    v_smfmac_f32_16x16x64_bf16 v[96:99], v[36:39], a[16:23], v2
    v_smfmac_f32_16x16x64_bf16 v[104:107], v[36:39], a[144:151], v2
    s_waitcnt lgkmcnt(1)
    v_smfmac_f32_16x16x64_bf16 v[96:99], v[40:43], a[32:39], v2
    v_smfmac_f32_16x16x64_bf16 v[104:107], v[40:43], a[160:167], v2
    s_waitcnt lgkmcnt(0)
    v_smfmac_f32_16x16x64_bf16 v[96:99], v[44:47], a[48:55], v2
    v_smfmac_f32_16x16x64_bf16 v[104:107], v[44:47], a[176:183], v2
    v_smfmac_f32_16x16x64_bf16 v[100:103], v[56:59], a[104:111], v2
    s_nop 2
    v_smfmac_f32_16x16x64_bf16 v[100:103], v[60:63], a[120:127], v2
    s_nop 1
    v_add_f32 v96, v96, v98
    v_smfmac_f32_16x16x64_bf16 v[100:103], v[32:35], a[8:15], v2
    v_add_f32 v97, v97, v99
    v_add_f32 v104, v104, v106
    v_smfmac_f32_16x16x64_bf16 v[100:103], v[36:39], a[24:31], v2
    v_add_f32 v105, v105, v107
    v_cvt_pk_bf16_f32 v96, v96, v97
    v_smfmac_f32_16x16x64_bf16 v[100:103], v[40:43], a[40:47], v2
    v_cvt_pk_bf16_f32 v97, v104, v105
    v_and_or_b32 v96, v96, -2, s41
    v_smfmac_f32_16x16x64_bf16 v[100:103], v[44:47], a[56:63], v2
    buffer_store_dwordx2 v[96:97], v11, s[4:7], s37 offen sc1
    v_smfmac_f32_16x16x64_bf16 v[108:111], v[56:59], a[232:239], v2
    v_smfmac_f32_16x16x64_bf16 v[108:111], v[60:63], a[248:255], v2
    v_smfmac_f32_16x16x64_bf16 v[108:111], v[32:35], a[136:143], v2
    v_smfmac_f32_16x16x64_bf16 v[108:111], v[36:39], a[152:159], v2
    v_smfmac_f32_16x16x64_bf16 v[108:111], v[40:43], a[168:175], v2
    s_nop 2
    v_add_f32 v100, v100, v102
    v_smfmac_f32_16x16x64_bf16 v[108:111], v[44:47], a[184:191], v2
    v_add_f32 v101, v101, v103
    v_cvt_pk_bf16_f32 v98, v100, v101
    v_and_or_b32 v98, v98, -2, s41
    s_nop 4
    v_pk_add_f32 v[108:109], v[108:109], v[110:111]
    v_cvt_pk_bf16_f32 v99, v108, v109
    buffer_store_dwordx2 v[98:99], v11, s[4:7], s37 offen offset:512 sc1
    v_smfmac_f32_16x16x64_bf16 v[112:115], v[32:35], v[64:71], v2
    ds_read_b128 v[64:67], v1 offset:40960
    ds_read_b128 v[68:71], v1 offset:41984
    v_smfmac_f32_16x16x64_bf16 v[116:119], v[32:35], v[72:79], v2
    ds_read_b128 v[72:75], v1 offset:43008
    ds_read_b128 v[76:79], v1 offset:44032
    v_smfmac_f32_16x16x64_bf16 v[112:115], v[36:39], v[80:87], v2
    ds_read_b128 v[80:83], v1 offset:57344
    ds_read_b128 v[84:87], v1 offset:58368
    v_smfmac_f32_16x16x64_bf16 v[116:119], v[36:39], v[88:95], v2
    ds_read_b128 v[88:91], v1 offset:59392
    ds_read_b128 v[92:95], v1 offset:60416
    s_waitcnt lgkmcnt(6)
    v_smfmac_f32_16x16x64_bf16 v[112:115], v[40:43], v[64:71], v2
    ds_read_b128 v[64:67], v5 offset:8192
    ds_read_b128 v[68:71], v5 offset:9216
    s_waitcnt lgkmcnt(6)
    v_smfmac_f32_16x16x64_bf16 v[116:119], v[40:43], v[72:79], v2
    ds_read_b128 v[72:75], v5 offset:10240
    ds_read_b128 v[76:79], v5 offset:11264
    s_waitcnt lgkmcnt(6)
    v_smfmac_f32_16x16x64_bf16 v[112:115], v[44:47], v[80:87], v2
    ds_read_b128 v[80:83], v5 offset:24576
    ds_read_b128 v[84:87], v5 offset:25600
    s_waitcnt lgkmcnt(6)
    v_smfmac_f32_16x16x64_bf16 v[116:119], v[44:47], v[88:95], v2
    ds_read_b128 v[88:91], v5 offset:26624
    ds_read_b128 v[92:95], v5 offset:27648
    s_waitcnt lgkmcnt(6)
    v_smfmac_f32_16x16x64_bf16 v[112:115], v[48:51], v[64:71], v2
    ds_read_b128 v[64:67], v5 offset:40960
    ds_read_b128 v[68:71], v5 offset:41984
    s_waitcnt lgkmcnt(6)
    v_smfmac_f32_16x16x64_bf16 v[116:119], v[48:51], v[72:79], v2
    ds_read_b128 v[72:75], v5 offset:43008
    ds_read_b128 v[76:79], v5 offset:44032
    s_waitcnt lgkmcnt(6)
    v_smfmac_f32_16x16x64_bf16 v[112:115], v[52:55], v[80:87], v2
    ds_read_b128 v[80:83], v5 offset:57344
    ds_read_b128 v[84:87], v5 offset:58368
    s_waitcnt lgkmcnt(6)
    v_smfmac_f32_16x16x64_bf16 v[116:119], v[52:55], v[88:95], v2
    ds_read_b128 v[88:91], v5 offset:59392
    ds_read_b128 v[92:95], v5 offset:60416
    s_waitcnt lgkmcnt(6)
    v_smfmac_f32_16x16x64_bf16 v[112:115], v[56:59], v[64:71], v2
    s_waitcnt lgkmcnt(4)
    v_smfmac_f32_16x16x64_bf16 v[116:119], v[56:59], v[72:79], v2
    s_waitcnt lgkmcnt(2)
    v_smfmac_f32_16x16x64_bf16 v[112:115], v[60:63], v[80:87], v2
    s_waitcnt lgkmcnt(0)
    v_smfmac_f32_16x16x64_bf16 v[116:119], v[60:63], v[88:95], v2
    buffer_load_dwordx2 v[108:109], v11, s[4:7], s38 offen sc1
    v_mfma_f32_16x16x16_bf16 v[100:103], v[96:97], v[16:17], 0
    v_mfma_f32_16x16x16_bf16 v[104:107], v[98:99], v[16:17], 0
    s_nop 4
    v_add_f32 v112, v112, v114
    v_add_f32 v113, v113, v115
    v_add_f32 v114, v116, v118
    v_add_f32 v115, v117, v119
    v_cvt_pk_bf16_f32 v18, v112, v113
    v_cvt_pk_bf16_f32 v19, v114, v115
    v_and_or_b32 v18, v18, -2, s41
    buffer_load_dwordx2 v[110:111], v11, s[4:7], s38 offen offset:512 sc1
    s_barrier
    buffer_store_dwordx2 v[18:19], v11, s[4:7], s39 offen sc1
    v_mov_b32 v112, v18
    v_mov_b32 v114, v19
    v_mov_b32 v92, v28
    v_mov_b32 v93, 0
    s_waitcnt vmcnt(5)
    s_barrier
    ds_read_b128 v[32:35], v6 offset:19456
    ds_read_b128 v[36:39], v6 offset:20480
    ds_read_b128 v[40:43], v6 offset:24576
    ds_read_b128 v[44:47], v6 offset:25600
    ds_read_b128 v[48:51], v6 offset:9216
    ds_read_b128 v[52:55], v6 offset:10240
    ds_read_b128 v[56:59], v6 offset:14336
    ds_read_b128 v[60:63], v6 offset:15360
    buffer_load_dwordx2 v[20:21], v11, s[4:7], s38 offen sc1
    buffer_load_dwordx2 v[22:23], v11, s[4:7], s38 offen offset:512 sc1
    s_waitcnt vmcnt(4)
    v_mfma_f32_16x16x16_bf16 v[80:83], v[108:109], v[16:17], v[100:103]
    v_and_b32 v3, 1, v108
    v_cmp_ne_u32 vcc, s41, v3
    s_nop 5
    v_cvt_pk_bf16_f32 v64, v80, v81
    v_cvt_pk_bf16_f32 v65, v82, v83
    s_cbranch_vccnz mega_kernel_rs_w2_xslow
    s_waitcnt vmcnt(3)
    v_mfma_f32_16x16x16_bf16 v[84:87], v[110:111], v[16:17], v[104:107]
    v_and_b32 v3, 1, v110
    v_cmp_ne_u32 vcc, s41, v3
    s_nop 5
    v_cvt_pk_bf16_f32 v66, v84, v85
    v_cvt_pk_bf16_f32 v67, v86, v87
    ds_write_b128 v6, v[64:67] offset:18432
    s_cbranch_vccnz mega_kernel_rs_w2_xslow
mega_kernel_rs_w2_xok:
    s_cmp_eq_u32 s21, 63
    s_cbranch_scc1 mega_kernel_rs_w2_last
    buffer_load_dwordx2 v[116:117], v11, s[4:7], s40 offen sc1
    s_waitcnt lgkmcnt(1)
    v_mfma_f32_16x16x32_bf16 v[80:83], v[32:35], v[64:67], 0
    s_waitcnt lgkmcnt(0)
    s_barrier
    ds_read_b128 v[68:71], v6 offset:23552
    ds_read_b128 v[72:75], v6 offset:8192
    ds_read_b128 v[76:79], v6 offset:13312
    v_mfma_f32_16x16x32_bf16 v[84:87], v[36:39], v[64:67], 0
    v_mfma_f32_16x16x32_bf16 v[88:91], v[64:67], v[64:67], 0
    buffer_load_dwordx2 v[20:21], v11, s[4:7], s40 offen sc1
    s_waitcnt lgkmcnt(2)
    v_mfma_f32_16x16x32_bf16 v[80:83], v[40:43], v[68:71], v[80:83]
    s_waitcnt lgkmcnt(1)
    v_mfma_f32_16x16x32_bf16 v[80:83], v[48:51], v[72:75], v[80:83]
    s_waitcnt lgkmcnt(0)
    v_mfma_f32_16x16x32_bf16 v[80:83], v[56:59], v[76:79], v[80:83]
    buffer_store_dwordx4 v[64:67], v10, s[4:7], s45 offen offset:128 sc1
    v_mfma_f32_16x16x32_bf16 v[84:87], v[44:47], v[68:71], v[84:87]
    v_mfma_f32_16x16x32_bf16 v[84:87], v[52:55], v[72:75], v[84:87]
    v_mfma_f32_16x16x32_bf16 v[84:87], v[60:63], v[76:79], v[84:87]
    v_mfma_f32_16x16x32_bf16 v[88:91], v[68:71], v[68:71], v[88:91]
    buffer_store_dwordx2 v[18:19], v11, s[4:7], s51 offen offset:3072 sc1
    v_mfma_f32_16x16x32_bf16 v[88:91], v[72:75], v[72:75], v[88:91]
    v_mfma_f32_16x16x32_bf16 v[88:91], v[76:79], v[76:79], v[88:91]
    v_mfma_f32_32x32x4_2b_bf16 v[32:63], v[14:15], v[14:15], 0
    s_nop 0
    v_max3_f32 v4, v80, v81, v82
    s_nop 1
    v_max3_f32 v4, v4, v83, v84
    v_max3_f32 v4, v4, v85, v86
    v_max_f32 v4, v4, v87
    v_max3_f32 v90, v4, v88, v89
    v_max3_f32 v4, v4, v88, v89
    s_nop 1
    v_permlane16_swap_b32 v4, v90
    v_max_f32 v4, v4, v90
    v_max_f32 v90, v4, v90
    s_nop 1
    v_permlane32_swap_b32 v4, v90
    v_max_f32 v4, v4, v90
    v_mul_f32 v4, s34, v4
    v_pk_fma_f32 v[80:81], v[80:81], s[34:35], v[4:5] op_sel_hi:[1,0,0] neg_lo:[0,0,1] neg_hi:[0,0,1]
    v_pk_fma_f32 v[82:83], v[82:83], s[34:35], v[4:5] op_sel_hi:[1,0,0] neg_lo:[0,0,1] neg_hi:[0,0,1]
    v_pk_fma_f32 v[84:85], v[84:85], s[34:35], v[4:5] op_sel_hi:[1,0,0] neg_lo:[0,0,1] neg_hi:[0,0,1]
    v_pk_fma_f32 v[86:87], v[86:87], s[34:35], v[4:5] op_sel_hi:[1,0,0] neg_lo:[0,0,1] neg_hi:[0,0,1]
    v_pk_fma_f32 v[88:89], v[88:89], s[34:35], v[4:5] op_sel_hi:[1,0,0] neg_lo:[0,0,1] neg_hi:[0,0,1]
    v_exp_f32 v80, v80
    v_exp_f32 v81, v81
    v_exp_f32 v82, v82
    v_cvt_pk_bf16_f32 v68, v80, v81
    v_exp_f32 v83, v83
    v_exp_f32 v84, v84
    v_cvt_pk_bf16_f32 v69, v82, v83
    v_exp_f32 v85, v85
    v_exp_f32 v86, v86
    v_cvt_pk_bf16_f32 v70, v84, v85
    v_exp_f32 v87, v87
    v_exp_f32 v88, v88
    v_cvt_pk_bf16_f32 v71, v86, v87
    v_exp_f32 v89, v89
    s_waitcnt vmcnt(3)
    v_mfma_f32_16x16x32_bf16 v[76:79], v[28:31], v[68:71], 0
    v_and_b32 v3, 1, v116
    v_cvt_pk_bf16_f32 v72, v88, v89
    v_mfma_f32_16x16x32_bf16 v[100:103], v[120:123], v[68:71], 0
    v_cmp_ne_u32 vcc, s41, v3
    v_cvt_pk_bf16_f32 v73, v88, v89
    v_mfma_f32_16x16x32_bf16 v[104:107], v[124:127], v[68:71], 0
    v_mov_b32 v113, v116
    v_mov_b32 v115, v117
    v_mfma_f32_16x16x16_bf16 v[76:79], v[92:93], v[72:73], v[76:79]
    s_cbranch_vccnz mega_kernel_rs_w2_pv0
mega_kernel_rs_w2_pv2:
    v_mfma_f32_16x16x16_bf16 v[100:103], v[112:113], v[72:73], v[100:103]
    v_mfma_f32_16x16x16_bf16 v[104:107], v[114:115], v[72:73], v[104:107]
    buffer_load_dwordx4 v[120:123], v1, s[4:7], s44 offen
    buffer_load_dwordx4 v[124:127], v1, s[4:7], s44 offen offset:1024
    s_nop 2
    v_rcp_f32 v76, v76
    s_mov_b64 exec, s[28:29]
    v_pk_mul_f32 v[100:101], v[100:101], v[76:77] op_sel_hi:[1,0]
    v_pk_mul_f32 v[102:103], v[102:103], v[76:77] op_sel_hi:[1,0]
    v_pk_mul_f32 v[104:105], v[104:105], v[76:77] op_sel_hi:[1,0]
    v_pk_mul_f32 v[106:107], v[106:107], v[76:77] op_sel_hi:[1,0]
    v_cvt_pk_bf16_f32 v84, v100, v101
    v_cvt_pk_bf16_f32 v85, v102, v103
    v_cvt_pk_bf16_f32 v86, v104, v105
    v_cvt_pk_bf16_f32 v87, v106, v107
    ds_write_b128 v6, v[84:87] offset:29664
    s_mov_b64 exec, -1
    s_waitcnt lgkmcnt(0)
    s_barrier
    ds_read_b128 v[68:71], v6 offset:28672
    ds_read_b128 v[72:75], v6 offset:29696
    s_waitcnt lgkmcnt(1)
    v_smfmac_f32_16x16x64_bf16 v[32:35], v[68:71], v[128:135], v2
    s_add_u32 s21, s21, 1
    s_xor_b32 s38, s38, 1048576
    s_xor_b32 s37, s37, 1048576
    s_waitcnt lgkmcnt(0)
    v_smfmac_f32_16x16x64_bf16 v[32:35], v[72:75], v[136:143], v2
    s_xor_b32 s40, s40, 1048576
    s_xor_b32 s39, s39, 1048576
    s_lshr_b32 s41, s21, 1
    v_smfmac_f32_16x16x64_bf16 v[36:39], v[68:71], v[144:151], v2
    s_and_b32 s41, s41, 1
    s_xor_b32 s41, s41, 1
    s_xor_b32 s35, s35, 16384
    v_smfmac_f32_16x16x64_bf16 v[36:39], v[72:75], v[152:159], v2
    v_add_f32 v32, v32, v34
    s_xor_b32 s36, s36, 16384
    s_add_u32 s43, s43, 262144
    s_add_u32 s44, s44, 262144
    v_smfmac_f32_16x16x64_bf16 v[40:43], v[68:71], v[160:167], v2
    v_add_f32 v33, v33, v35
    v_smfmac_f32_16x16x64_bf16 v[40:43], v[72:75], v[168:175], v2
    v_cvt_pk_bf16_f32 v32, v32, v33
    v_smfmac_f32_16x16x64_bf16 v[44:47], v[68:71], v[176:183], v2
    v_and_or_b32 v32, v32, -2, s42
    v_smfmac_f32_16x16x64_bf16 v[44:47], v[72:75], v[184:191], v2
    v_add_f32 v36, v36, v38
    v_smfmac_f32_16x16x64_bf16 v[48:51], v[68:71], v[192:199], v2
    v_add_f32 v37, v37, v39
    v_smfmac_f32_16x16x64_bf16 v[48:51], v[72:75], v[200:207], v2
    v_cvt_pk_bf16_f32 v33, v36, v37
    v_smfmac_f32_16x16x64_bf16 v[52:55], v[68:71], v[208:215], v2
    v_add_f32 v40, v40, v42
    v_smfmac_f32_16x16x64_bf16 v[52:55], v[72:75], v[216:223], v2
    v_add_f32 v41, v41, v43
    v_smfmac_f32_16x16x64_bf16 v[56:59], v[68:71], v[224:231], v2
    v_cvt_pk_bf16_f32 v34, v40, v41
    v_smfmac_f32_16x16x64_bf16 v[56:59], v[72:75], v[232:239], v2
    v_add_f32 v44, v44, v46
    v_smfmac_f32_16x16x64_bf16 v[60:63], v[68:71], v[240:247], v2
    v_add_f32 v45, v45, v47
    v_smfmac_f32_16x16x64_bf16 v[60:63], v[72:75], v[248:255], v2
    v_cvt_pk_bf16_f32 v35, v44, v45
    buffer_store_dwordx4 v[32:35], v8, s[4:7], s46 offen sc1
    v_pk_add_f32 v[48:49], v[48:49], v[50:51]
    v_cvt_pk_bf16_f32 v48, v48, v49
    v_and_or_b32 v48, v48, -2, s42
    v_pk_add_f32 v[52:53], v[52:53], v[54:55]
    v_cvt_pk_bf16_f32 v49, v52, v53
    v_pk_add_f32 v[56:57], v[56:57], v[58:59]
    v_cvt_pk_bf16_f32 v50, v56, v57
    v_pk_add_f32 v[60:61], v[60:61], v[62:63]
    v_cvt_pk_bf16_f32 v51, v60, v61
    buffer_store_dwordx4 v[48:51], v8, s[4:7], s61 offen sc1
    s_add_u32 s45, s45, 262144
    s_add_u32 s51, s51, 262144
    v_mfma_f32_32x32x8_bf16 v[96:111], v[14:15], v[14:15], 0
    v_mfma_f32_16x16x16_bf16 v[112:115], v[14:15], v[14:15], 0
    v_mfma_f32_16x16x16_bf16 v[116:119], v[14:15], v[14:15], 0
    ds_read_b128 v[64:67], v1 offset:8192
    ds_read_b128 v[68:71], v1 offset:9216
    ds_read_b128 v[72:75], v1 offset:10240
    ds_read_b128 v[76:79], v1 offset:11264
    ds_read_b128 v[80:83], v1 offset:24576
    ds_read_b128 v[84:87], v1 offset:25600
    ds_read_b128 v[88:91], v1 offset:26624
    ds_read_b128 v[92:95], v1 offset:27648
    v_mov_b32 v58, -1
    v_mov_b32 v59, -1
    s_waitcnt vmcnt(0)
mega_kernel_rs_w2_pc:
    buffer_load_dword v36, v13, s[4:7], s25 offen offset:0 sc1
    buffer_load_dword v37, v13, s[4:7], s25 offen offset:256 sc1
    buffer_load_dword v38, v13, s[4:7], s25 offen offset:512 sc1
    buffer_load_dword v39, v13, s[4:7], s25 offen offset:768 sc1
    buffer_load_dword v40, v13, s[4:7], s25 offen offset:1024 sc1
    buffer_load_dword v41, v13, s[4:7], s25 offen offset:1280 sc1
    buffer_load_dword v42, v13, s[4:7], s25 offen offset:1536 sc1
    buffer_load_dword v43, v13, s[4:7], s25 offen offset:1792 sc1
    s_waitcnt vmcnt(4)
    v_mfma_f32_16x16x32_bf16 v[52:55], v[36:39], v[24:27], 0
    v_bitop3_b32 v3, s42, v36, v37 bitop3:0x7e
    v_bitop3_b32 v4, s42, v38, v39 bitop3:0x7e
    s_waitcnt vmcnt(2)
    v_or_b32 v3, v3, v4
    v_bitop3_b32 v4, s42, v40, v41 bitop3:0x7e
    s_waitcnt vmcnt(0)
    v_mfma_f32_16x16x32_bf16 v[52:55], v[40:43], v[24:27], v[52:55]
    v_bitop3_b32 v56, s42, v42, v43 bitop3:0x7e
    v_or3_b32 v3, v3, v4, v56
    v_and_b32 v3, v0, v3
    v_cmp_ne_u32 vcc, 0, v3
    s_nop 3
    v_cvt_pk_bf16_f32 v56, v52, v53
    v_cvt_pk_bf16_f32 v57, v54, v55
    v_min_u32 v56, -2, v56
    s_cbranch_vccnz mega_kernel_rs_w2_pc
    s_mov_b64 exec, s[26:27]
    buffer_store_dwordx2 v[56:57], v9, s[4:7], s35 offen offset:512 sc1
    buffer_store_dwordx2 v[58:59], v9, s[4:7], s36 offen offset:512 sc1
    s_mov_b64 exec, -1
    s_xor_b32 s42, s42, 1
    s_branch mega_kernel_rs_w2_loop
mega_kernel_rs_w2_last:
    buffer_store_dwordx4 v[64:67], v10, s[4:7], s45 offen offset:128 sc1
    buffer_store_dwordx2 v[18:19], v11, s[4:7], s51 offen offset:3072 sc1
    s_branch mega_kernel_rs_end
mega_kernel_rs_w2_pafail:
    s_nop 7
    v_mov_b32 v96, 0
    v_mov_b32 v97, 0
    v_mov_b32 v98, 0
    v_mov_b32 v99, 0
    v_mov_b32 v100, 0
    v_mov_b32 v101, 0
    v_mov_b32 v102, 0
    v_mov_b32 v103, 0
    v_mov_b32 v104, 0
    v_mov_b32 v105, 0
    v_mov_b32 v106, 0
    v_mov_b32 v107, 0
    s_branch mega_kernel_rs_w2_pa
mega_kernel_rs_w2_xslow:
    buffer_load_dwordx2 v[108:109], v11, s[4:7], s38 offen sc1
    buffer_load_dwordx2 v[110:111], v11, s[4:7], s38 offen offset:512 sc1
    s_waitcnt vmcnt(2)
    v_bitop3_b32 v3, s41, v20, v22 bitop3:0x7e
    v_mfma_f32_16x16x16_bf16 v[80:83], v[20:21], v[16:17], v[100:103]
    v_and_b32 v3, 1, v3
    v_mfma_f32_16x16x16_bf16 v[84:87], v[22:23], v[16:17], v[104:107]
    v_cmp_ne_u32 vcc, 0, v3
    s_cbranch_vccz mega_kernel_rs_w2_xgot
    buffer_load_dwordx2 v[20:21], v11, s[4:7], s38 offen sc1
    buffer_load_dwordx2 v[22:23], v11, s[4:7], s38 offen offset:512 sc1
    s_waitcnt vmcnt(2)
    v_bitop3_b32 v3, s41, v108, v110 bitop3:0x7e
    v_mfma_f32_16x16x16_bf16 v[80:83], v[108:109], v[16:17], v[100:103]
    v_and_b32 v3, 1, v3
    v_mfma_f32_16x16x16_bf16 v[84:87], v[110:111], v[16:17], v[104:107]
    v_cmp_ne_u32 vcc, 0, v3
    s_cbranch_vccz mega_kernel_rs_w2_xgot
    s_branch mega_kernel_rs_w2_xslow
mega_kernel_rs_w2_xgot:
    s_nop 3
    v_cvt_pk_bf16_f32 v64, v80, v81
    v_cvt_pk_bf16_f32 v65, v82, v83
    v_cvt_pk_bf16_f32 v66, v84, v85
    v_cvt_pk_bf16_f32 v67, v86, v87
    ds_write_b128 v6, v[64:67] offset:18432
    s_branch mega_kernel_rs_w2_xok
mega_kernel_rs_w2_pv0:
    s_waitcnt vmcnt(2)
    s_branch mega_kernel_rs_w2_pv1
mega_kernel_rs_w2_pv:
    buffer_load_dwordx2 v[20:21], v11, s[4:7], s40 offen sc1
    s_waitcnt vmcnt(0)
mega_kernel_rs_w2_pv1:
    v_and_b32 v3, 1, v20
    v_cmp_ne_u32 vcc, s41, v3
    v_mov_b32 v113, v20
    v_mov_b32 v115, v21
    s_cbranch_vccnz mega_kernel_rs_w2_pv
    s_branch mega_kernel_rs_w2_pv2
mega_kernel_rs_w3_entry:
    v_mfma_f32_32x32x8_bf16 v[96:111], v[14:15], v[14:15], 0
    v_mfma_f32_16x16x16_bf16 v[112:115], v[14:15], v[14:15], 0
    v_mfma_f32_16x16x16_bf16 v[116:119], v[14:15], v[14:15], 0
    ds_read_b128 v[64:67], v1 offset:12288
    ds_read_b128 v[68:71], v1 offset:13312
    ds_read_b128 v[72:75], v1 offset:14336
    ds_read_b128 v[76:79], v1 offset:15360
    ds_read_b128 v[80:83], v1 offset:28672
    ds_read_b128 v[84:87], v1 offset:29696
    ds_read_b128 v[88:91], v1 offset:30720
    ds_read_b128 v[92:95], v1 offset:31744
    buffer_load_dwordx4 v[120:123], v1, s[4:7], s44 offen
    buffer_load_dwordx4 v[124:127], v1, s[4:7], s44 offen offset:1024
    s_add_u32 s44, s44, 262144
mega_kernel_rs_w3_loop:
    s_add_u32 s22, s35, 6144
    s_waitcnt vmcnt(0)
    buffer_load_dwordx4 v[56:59], v1, s[4:7], s22 offen sc1
    buffer_load_dwordx4 v[60:63], v1, s[4:7], s22 offen offset:1024 sc1
mega_kernel_rs_w3_pa:
    s_waitcnt vmcnt(1)
    ds_write_b128 v6, v[56:59] offset:6144
    s_waitcnt vmcnt(0)
    ds_write_b128 v6, v[60:63] offset:7168
    v_max3_u32 v3, v56, v58, v60
    v_max_u32 v3, v3, v62
    v_cmp_eq_u32 vcc, -1, v3
    v_smfmac_f32_16x16x64_bf16 v[96:99], v[56:59], a[96:103], v2
    buffer_load_dwordx4 v[56:59], v1, s[4:7], s22 offen sc1
    v_smfmac_f32_16x16x64_bf16 v[100:103], v[56:59], a[104:111], v2
    buffer_load_dwordx4 v[60:63], v1, s[4:7], s22 offen offset:1024 sc1
    v_smfmac_f32_16x16x64_bf16 v[104:107], v[56:59], a[224:231], v2
    s_cbranch_vccnz mega_kernel_rs_w3_pafail
    s_waitcnt lgkmcnt(0)
    s_barrier
    ds_read_b128 v[32:35], v6 offset:0
    ds_read_b128 v[36:39], v6 offset:1024
    v_smfmac_f32_16x16x64_bf16 v[108:111], v[56:59], a[232:239], v2
    ds_read_b128 v[40:43], v6 offset:2048
    v_smfmac_f32_16x16x64_bf16 v[96:99], v[60:63], a[112:119], v2
    ds_read_b128 v[44:47], v6 offset:3072
    v_smfmac_f32_16x16x64_bf16 v[100:103], v[60:63], a[120:127], v2
    ds_read_b128 v[48:51], v6 offset:4096
    v_smfmac_f32_16x16x64_bf16 v[104:107], v[60:63], a[240:247], v2
    ds_read_b128 v[52:55], v6 offset:5120
    v_smfmac_f32_16x16x64_bf16 v[108:111], v[60:63], a[248:255], v2
    s_waitcnt lgkmcnt(5)
    v_smfmac_f32_16x16x64_bf16 v[96:99], v[32:35], a[0:7], v2
    v_smfmac_f32_16x16x64_bf16 v[104:107], v[32:35], a[128:135], v2
    s_waitcnt lgkmcnt(4)
    v_smfmac_f32_16x16x64_bf16 v[96:99], v[36:39], a[16:23], v2
    buffer_load_dwordx4 v1, s[4:7], s43 offen lds
    v_smfmac_f32_16x16x64_bf16 v[104:107], v[36:39], a[144:151], v2
    s_waitcnt lgkmcnt(3)
    v_smfmac_f32_16x16x64_bf16 v[96:99], v[40:43], a[32:39], v2
    v_smfmac_f32_16x16x64_bf16 v[104:107], v[40:43], a[160:167], v2
    s_waitcnt lgkmcnt(2)
    v_smfmac_f32_16x16x64_bf16 v[96:99], v[44:47], a[48:55], v2
    buffer_load_dwordx4 v1, s[4:7], s43 offen offset:1024 lds
    v_smfmac_f32_16x16x64_bf16 v[104:107], v[44:47], a[176:183], v2
    s_waitcnt lgkmcnt(1)
    v_smfmac_f32_16x16x64_bf16 v[96:99], v[48:51], a[64:71], v2
    v_smfmac_f32_16x16x64_bf16 v[104:107], v[48:51], a[192:199], v2
    s_waitcnt lgkmcnt(0)
    v_smfmac_f32_16x16x64_bf16 v[96:99], v[52:55], a[80:87], v2
    buffer_load_dword v12, v7, s[4:7], 0 offen sc1
    v_smfmac_f32_16x16x64_bf16 v[104:107], v[52:55], a[208:215], v2
    v_smfmac_f32_16x16x64_bf16 v[100:103], v[32:35], a[8:15], v2
    s_nop 2
    v_smfmac_f32_16x16x64_bf16 v[100:103], v[36:39], a[24:31], v2
    s_nop 1
    v_add_f32 v96, v96, v98
    v_smfmac_f32_16x16x64_bf16 v[100:103], v[40:43], a[40:47], v2
    v_add_f32 v97, v97, v99
    v_add_f32 v104, v104, v106
    v_smfmac_f32_16x16x64_bf16 v[100:103], v[44:47], a[56:63], v2
    v_add_f32 v105, v105, v107
    v_cvt_pk_bf16_f32 v96, v96, v97
    v_smfmac_f32_16x16x64_bf16 v[100:103], v[48:51], a[72:79], v2
    v_cvt_pk_bf16_f32 v97, v104, v105
    v_and_or_b32 v96, v96, -2, s41
    v_smfmac_f32_16x16x64_bf16 v[100:103], v[52:55], a[88:95], v2
    buffer_store_dwordx2 v[96:97], v11, s[4:7], s37 offen sc1
    v_smfmac_f32_16x16x64_bf16 v[108:111], v[32:35], a[136:143], v2
    v_smfmac_f32_16x16x64_bf16 v[108:111], v[36:39], a[152:159], v2
    v_smfmac_f32_16x16x64_bf16 v[108:111], v[40:43], a[168:175], v2
    v_smfmac_f32_16x16x64_bf16 v[108:111], v[44:47], a[184:191], v2
    v_smfmac_f32_16x16x64_bf16 v[108:111], v[48:51], a[200:207], v2
    s_nop 2
    v_add_f32 v100, v100, v102
    v_smfmac_f32_16x16x64_bf16 v[108:111], v[52:55], a[216:223], v2
    v_add_f32 v101, v101, v103
    v_cvt_pk_bf16_f32 v98, v100, v101
    v_and_or_b32 v98, v98, -2, s41
    s_nop 4
    v_pk_add_f32 v[108:109], v[108:109], v[110:111]
    v_cvt_pk_bf16_f32 v99, v108, v109
    buffer_store_dwordx2 v[98:99], v11, s[4:7], s37 offen offset:512 sc1
    v_smfmac_f32_16x16x64_bf16 v[112:115], v[32:35], v[64:71], v2
    ds_read_b128 v[64:67], v1 offset:45056
    ds_read_b128 v[68:71], v1 offset:46080
    v_smfmac_f32_16x16x64_bf16 v[116:119], v[32:35], v[72:79], v2
    ds_read_b128 v[72:75], v1 offset:47104
    ds_read_b128 v[76:79], v1 offset:48128
    v_smfmac_f32_16x16x64_bf16 v[112:115], v[36:39], v[80:87], v2
    ds_read_b128 v[80:83], v1 offset:61440
    ds_read_b128 v[84:87], v1 offset:62464
    v_smfmac_f32_16x16x64_bf16 v[116:119], v[36:39], v[88:95], v2
    ds_read_b128 v[88:91], v1 offset:63488
    ds_read_b128 v[92:95], v1 offset:64512
    s_waitcnt lgkmcnt(6)
    v_smfmac_f32_16x16x64_bf16 v[112:115], v[40:43], v[64:71], v2
    ds_read_b128 v[64:67], v5 offset:12288
    ds_read_b128 v[68:71], v5 offset:13312
    s_waitcnt lgkmcnt(6)
    v_smfmac_f32_16x16x64_bf16 v[116:119], v[40:43], v[72:79], v2
    ds_read_b128 v[72:75], v5 offset:14336
    ds_read_b128 v[76:79], v5 offset:15360
    s_waitcnt lgkmcnt(6)
    v_smfmac_f32_16x16x64_bf16 v[112:115], v[44:47], v[80:87], v2
    ds_read_b128 v[80:83], v5 offset:28672
    ds_read_b128 v[84:87], v5 offset:29696
    s_waitcnt lgkmcnt(6)
    v_smfmac_f32_16x16x64_bf16 v[116:119], v[44:47], v[88:95], v2
    ds_read_b128 v[88:91], v5 offset:30720
    ds_read_b128 v[92:95], v5 offset:31744
    s_waitcnt lgkmcnt(6)
    v_smfmac_f32_16x16x64_bf16 v[112:115], v[48:51], v[64:71], v2
    ds_read_b128 v[64:67], v5 offset:45056
    ds_read_b128 v[68:71], v5 offset:46080
    s_waitcnt lgkmcnt(6)
    v_smfmac_f32_16x16x64_bf16 v[116:119], v[48:51], v[72:79], v2
    ds_read_b128 v[72:75], v5 offset:47104
    ds_read_b128 v[76:79], v5 offset:48128
    s_waitcnt lgkmcnt(6)
    v_smfmac_f32_16x16x64_bf16 v[112:115], v[52:55], v[80:87], v2
    ds_read_b128 v[80:83], v5 offset:61440
    ds_read_b128 v[84:87], v5 offset:62464
    s_waitcnt lgkmcnt(6)
    v_smfmac_f32_16x16x64_bf16 v[116:119], v[52:55], v[88:95], v2
    ds_read_b128 v[88:91], v5 offset:63488
    ds_read_b128 v[92:95], v5 offset:64512
    s_waitcnt lgkmcnt(6)
    v_smfmac_f32_16x16x64_bf16 v[112:115], v[56:59], v[64:71], v2
    s_waitcnt lgkmcnt(4)
    v_smfmac_f32_16x16x64_bf16 v[116:119], v[56:59], v[72:79], v2
    s_waitcnt lgkmcnt(2)
    v_smfmac_f32_16x16x64_bf16 v[112:115], v[60:63], v[80:87], v2
    s_waitcnt lgkmcnt(0)
    v_smfmac_f32_16x16x64_bf16 v[116:119], v[60:63], v[88:95], v2
    buffer_load_dwordx2 v[108:109], v11, s[4:7], s38 offen sc1
    v_mfma_f32_16x16x16_bf16 v[100:103], v[96:97], v[16:17], 0
    v_mfma_f32_16x16x16_bf16 v[104:107], v[98:99], v[16:17], 0
    s_nop 4
    v_add_f32 v112, v112, v114
    v_add_f32 v113, v113, v115
    v_add_f32 v114, v116, v118
    v_add_f32 v115, v117, v119
    v_cvt_pk_bf16_f32 v18, v112, v113
    v_cvt_pk_bf16_f32 v19, v114, v115
    v_and_or_b32 v18, v18, -2, s41
    buffer_load_dwordx2 v[110:111], v11, s[4:7], s38 offen offset:512 sc1
    s_barrier
    buffer_store_dwordx2 v[18:19], v11, s[4:7], s39 offen sc1
    v_mov_b32 v112, v18
    v_mov_b32 v114, v19
    v_mov_b32 v92, v28
    v_mov_b32 v93, 0
    s_waitcnt vmcnt(6)
    s_barrier
    ds_read_b128 v[32:35], v6 offset:24576
    ds_read_b128 v[36:39], v6 offset:25600
    ds_read_b128 v[40:43], v6 offset:19456
    ds_read_b128 v[44:47], v6 offset:20480
    ds_read_b128 v[48:51], v6 offset:14336
    ds_read_b128 v[52:55], v6 offset:15360
    ds_read_b128 v[56:59], v6 offset:9216
    ds_read_b128 v[60:63], v6 offset:10240
    buffer_load_dwordx2 v[20:21], v11, s[4:7], s38 offen sc1
    buffer_load_dwordx2 v[22:23], v11, s[4:7], s38 offen offset:512 sc1
    s_waitcnt vmcnt(4)
    v_mfma_f32_16x16x16_bf16 v[80:83], v[108:109], v[16:17], v[100:103]
    v_and_b32 v3, 1, v108
    v_cmp_ne_u32 vcc, s41, v3
    s_nop 5
    v_cvt_pk_bf16_f32 v64, v80, v81
    v_cvt_pk_bf16_f32 v65, v82, v83
    s_cbranch_vccnz mega_kernel_rs_w3_xslow
    s_waitcnt vmcnt(3)
    v_mfma_f32_16x16x16_bf16 v[84:87], v[110:111], v[16:17], v[104:107]
    v_and_b32 v3, 1, v110
    v_cmp_ne_u32 vcc, s41, v3
    s_nop 5
    v_cvt_pk_bf16_f32 v66, v84, v85
    v_cvt_pk_bf16_f32 v67, v86, v87
    ds_write_b128 v6, v[64:67] offset:23552
    s_cbranch_vccnz mega_kernel_rs_w3_xslow
mega_kernel_rs_w3_xok:
    s_cmp_eq_u32 s21, 63
    s_cbranch_scc1 mega_kernel_rs_w3_last
    buffer_load_dwordx2 v[116:117], v11, s[4:7], s40 offen sc1
    s_waitcnt lgkmcnt(1)
    v_mfma_f32_16x16x32_bf16 v[80:83], v[32:35], v[64:67], 0
    s_waitcnt lgkmcnt(0)
    s_barrier
    ds_read_b128 v[68:71], v6 offset:18432
    ds_read_b128 v[72:75], v6 offset:13312
    ds_read_b128 v[76:79], v6 offset:8192
    v_mfma_f32_16x16x32_bf16 v[84:87], v[36:39], v[64:67], 0
    v_mfma_f32_16x16x32_bf16 v[88:91], v[64:67], v[64:67], 0
    buffer_load_dwordx2 v[20:21], v11, s[4:7], s40 offen sc1
    s_waitcnt lgkmcnt(2)
    v_mfma_f32_16x16x32_bf16 v[80:83], v[40:43], v[68:71], v[80:83]
    s_waitcnt lgkmcnt(1)
    v_mfma_f32_16x16x32_bf16 v[80:83], v[48:51], v[72:75], v[80:83]
    s_waitcnt lgkmcnt(0)
    v_mfma_f32_16x16x32_bf16 v[80:83], v[56:59], v[76:79], v[80:83]
    v_mfma_f32_16x16x32_bf16 v[84:87], v[44:47], v[68:71], v[84:87]
    buffer_store_dwordx4 v[64:67], v10, s[4:7], s45 offen offset:192 sc1
    v_mfma_f32_16x16x32_bf16 v[84:87], v[52:55], v[72:75], v[84:87]
    v_mfma_f32_16x16x32_bf16 v[84:87], v[60:63], v[76:79], v[84:87]
    v_mfma_f32_16x16x32_bf16 v[88:91], v[68:71], v[68:71], v[88:91]
    v_mfma_f32_16x16x32_bf16 v[88:91], v[72:75], v[72:75], v[88:91]
    buffer_store_dwordx2 v[18:19], v11, s[4:7], s51 offen offset:3584 sc1
    v_mfma_f32_16x16x32_bf16 v[88:91], v[76:79], v[76:79], v[88:91]
    v_mfma_f32_32x32x4_2b_bf16 v[32:63], v[14:15], v[14:15], 0
    s_nop 0
    v_max3_f32 v4, v80, v81, v82
    s_nop 1
    v_max3_f32 v4, v4, v83, v84
    v_max3_f32 v4, v4, v85, v86
    v_max_f32 v4, v4, v87
    v_max3_f32 v90, v4, v88, v89
    v_max3_f32 v4, v4, v88, v89
    s_nop 1
    v_permlane16_swap_b32 v4, v90
    v_max_f32 v4, v4, v90
    v_max_f32 v90, v4, v90
    s_nop 1
    v_permlane32_swap_b32 v4, v90
    v_max_f32 v4, v4, v90
    v_mul_f32 v4, s34, v4
    v_pk_fma_f32 v[80:81], v[80:81], s[34:35], v[4:5] op_sel_hi:[1,0,0] neg_lo:[0,0,1] neg_hi:[0,0,1]
    v_pk_fma_f32 v[82:83], v[82:83], s[34:35], v[4:5] op_sel_hi:[1,0,0] neg_lo:[0,0,1] neg_hi:[0,0,1]
    v_pk_fma_f32 v[84:85], v[84:85], s[34:35], v[4:5] op_sel_hi:[1,0,0] neg_lo:[0,0,1] neg_hi:[0,0,1]
    v_pk_fma_f32 v[86:87], v[86:87], s[34:35], v[4:5] op_sel_hi:[1,0,0] neg_lo:[0,0,1] neg_hi:[0,0,1]
    v_pk_fma_f32 v[88:89], v[88:89], s[34:35], v[4:5] op_sel_hi:[1,0,0] neg_lo:[0,0,1] neg_hi:[0,0,1]
    v_exp_f32 v80, v80
    v_exp_f32 v81, v81
    v_exp_f32 v82, v82
    v_cvt_pk_bf16_f32 v68, v80, v81
    v_exp_f32 v83, v83
    v_exp_f32 v84, v84
    v_cvt_pk_bf16_f32 v69, v82, v83
    v_exp_f32 v85, v85
    v_exp_f32 v86, v86
    v_cvt_pk_bf16_f32 v70, v84, v85
    v_exp_f32 v87, v87
    v_exp_f32 v88, v88
    v_cvt_pk_bf16_f32 v71, v86, v87
    v_exp_f32 v89, v89
    s_waitcnt vmcnt(3)
    v_mfma_f32_16x16x32_bf16 v[76:79], v[28:31], v[68:71], 0
    v_and_b32 v3, 1, v116
    v_cvt_pk_bf16_f32 v72, v88, v89
    v_mfma_f32_16x16x32_bf16 v[100:103], v[120:123], v[68:71], 0
    v_cmp_ne_u32 vcc, s41, v3
    v_cvt_pk_bf16_f32 v73, v88, v89
    v_mfma_f32_16x16x32_bf16 v[104:107], v[124:127], v[68:71], 0
    v_mov_b32 v113, v116
    v_mov_b32 v115, v117
    v_mfma_f32_16x16x16_bf16 v[76:79], v[92:93], v[72:73], v[76:79]
    s_cbranch_vccnz mega_kernel_rs_w3_pv0
mega_kernel_rs_w3_pv2:
    v_mfma_f32_16x16x16_bf16 v[100:103], v[112:113], v[72:73], v[100:103]
    v_mfma_f32_16x16x16_bf16 v[104:107], v[114:115], v[72:73], v[104:107]
    buffer_load_dwordx4 v[120:123], v1, s[4:7], s44 offen
    buffer_load_dwordx4 v[124:127], v1, s[4:7], s44 offen offset:1024
    s_nop 2
    v_rcp_f32 v76, v76
    s_mov_b64 exec, s[28:29]
    v_pk_mul_f32 v[100:101], v[100:101], v[76:77] op_sel_hi:[1,0]
    v_pk_mul_f32 v[102:103], v[102:103], v[76:77] op_sel_hi:[1,0]
    v_pk_mul_f32 v[104:105], v[104:105], v[76:77] op_sel_hi:[1,0]
    v_pk_mul_f32 v[106:107], v[106:107], v[76:77] op_sel_hi:[1,0]
    v_cvt_pk_bf16_f32 v84, v100, v101
    v_cvt_pk_bf16_f32 v85, v102, v103
    v_cvt_pk_bf16_f32 v86, v104, v105
    v_cvt_pk_bf16_f32 v87, v106, v107
    ds_write_b128 v6, v[84:87] offset:29696
    s_mov_b64 exec, -1
    s_waitcnt lgkmcnt(0)
    s_barrier
    ds_read_b128 v[68:71], v6 offset:28672
    ds_read_b128 v[72:75], v6 offset:29696
    s_waitcnt lgkmcnt(1)
    v_smfmac_f32_16x16x64_bf16 v[32:35], v[68:71], v[128:135], v2
    s_add_u32 s21, s21, 1
    s_xor_b32 s38, s38, 1048576
    s_xor_b32 s37, s37, 1048576
    s_waitcnt lgkmcnt(0)
    v_smfmac_f32_16x16x64_bf16 v[32:35], v[72:75], v[136:143], v2
    s_xor_b32 s40, s40, 1048576
    s_xor_b32 s39, s39, 1048576
    s_lshr_b32 s41, s21, 1
    v_smfmac_f32_16x16x64_bf16 v[36:39], v[68:71], v[144:151], v2
    s_and_b32 s41, s41, 1
    s_xor_b32 s41, s41, 1
    s_xor_b32 s35, s35, 16384
    v_smfmac_f32_16x16x64_bf16 v[36:39], v[72:75], v[152:159], v2
    v_add_f32 v32, v32, v34
    s_xor_b32 s36, s36, 16384
    s_add_u32 s43, s43, 262144
    s_add_u32 s44, s44, 262144
    v_smfmac_f32_16x16x64_bf16 v[40:43], v[68:71], v[160:167], v2
    v_add_f32 v33, v33, v35
    v_smfmac_f32_16x16x64_bf16 v[40:43], v[72:75], v[168:175], v2
    v_cvt_pk_bf16_f32 v32, v32, v33
    v_smfmac_f32_16x16x64_bf16 v[44:47], v[68:71], v[176:183], v2
    v_and_or_b32 v32, v32, -2, s42
    v_smfmac_f32_16x16x64_bf16 v[44:47], v[72:75], v[184:191], v2
    v_add_f32 v36, v36, v38
    v_smfmac_f32_16x16x64_bf16 v[48:51], v[68:71], v[192:199], v2
    v_add_f32 v37, v37, v39
    v_smfmac_f32_16x16x64_bf16 v[48:51], v[72:75], v[200:207], v2
    v_cvt_pk_bf16_f32 v33, v36, v37
    v_smfmac_f32_16x16x64_bf16 v[52:55], v[68:71], v[208:215], v2
    v_add_f32 v40, v40, v42
    v_smfmac_f32_16x16x64_bf16 v[52:55], v[72:75], v[216:223], v2
    v_add_f32 v41, v41, v43
    v_smfmac_f32_16x16x64_bf16 v[56:59], v[68:71], v[224:231], v2
    v_cvt_pk_bf16_f32 v34, v40, v41
    v_smfmac_f32_16x16x64_bf16 v[56:59], v[72:75], v[232:239], v2
    v_add_f32 v44, v44, v46
    v_smfmac_f32_16x16x64_bf16 v[60:63], v[68:71], v[240:247], v2
    v_add_f32 v45, v45, v47
    v_smfmac_f32_16x16x64_bf16 v[60:63], v[72:75], v[248:255], v2
    v_cvt_pk_bf16_f32 v35, v44, v45
    buffer_store_dwordx4 v[32:35], v8, s[4:7], s46 offen sc1
    v_pk_add_f32 v[48:49], v[48:49], v[50:51]
    v_cvt_pk_bf16_f32 v48, v48, v49
    v_and_or_b32 v48, v48, -2, s42
    v_pk_add_f32 v[52:53], v[52:53], v[54:55]
    v_cvt_pk_bf16_f32 v49, v52, v53
    v_pk_add_f32 v[56:57], v[56:57], v[58:59]
    v_cvt_pk_bf16_f32 v50, v56, v57
    v_pk_add_f32 v[60:61], v[60:61], v[62:63]
    v_cvt_pk_bf16_f32 v51, v60, v61
    buffer_store_dwordx4 v[48:51], v8, s[4:7], s61 offen sc1
    s_add_u32 s45, s45, 262144
    s_add_u32 s51, s51, 262144
    v_mfma_f32_32x32x8_bf16 v[96:111], v[14:15], v[14:15], 0
    v_mfma_f32_16x16x16_bf16 v[112:115], v[14:15], v[14:15], 0
    v_mfma_f32_16x16x16_bf16 v[116:119], v[14:15], v[14:15], 0
    ds_read_b128 v[64:67], v1 offset:12288
    ds_read_b128 v[68:71], v1 offset:13312
    ds_read_b128 v[72:75], v1 offset:14336
    ds_read_b128 v[76:79], v1 offset:15360
    ds_read_b128 v[80:83], v1 offset:28672
    ds_read_b128 v[84:87], v1 offset:29696
    ds_read_b128 v[88:91], v1 offset:30720
    ds_read_b128 v[92:95], v1 offset:31744
    s_add_u32 s22, s21, 2
    s_cmp_gt_u32 s50, s22
    s_cbranch_scc1 mega_kernel_rs_w3_kvs
    v_readlane_b32 s50, v12, 0
    v_readlane_b32 s22, v12, 2
    v_readlane_b32 s23, v12, 1
    v_readlane_b32 s24, v12, 3
    s_nop 3
    s_min_u32 s50, s50, s22
    s_min_u32 s23, s23, s24
    s_lshl_b32 s50, s50, 1
    s_lshl_b32 s23, s23, 1
    s_add_u32 s23, s23, 1
    s_min_u32 s50, s50, s23
mega_kernel_rs_kvb1:
    s_add_u32 s22, s21, 1
    s_min_u32 s22, s22, 63
    s_cmp_gt_u32 s50, s22
    s_cbranch_scc1 mega_kernel_rs_kvd1
    buffer_load_dword v12, v7, s[4:7], 0 offen sc1
    s_waitcnt vmcnt(0)
    v_readlane_b32 s50, v12, 0
    v_readlane_b32 s22, v12, 2
    v_readlane_b32 s23, v12, 1
    v_readlane_b32 s24, v12, 3
    s_nop 3
    s_min_u32 s50, s50, s22
    s_min_u32 s23, s23, s24
    s_lshl_b32 s50, s50, 1
    s_lshl_b32 s23, s23, 1
    s_add_u32 s23, s23, 1
    s_min_u32 s50, s50, s23
    s_branch mega_kernel_rs_kvb1
mega_kernel_rs_kvd1:
mega_kernel_rs_w3_kvs:
    v_mov_b32 v58, -1
    v_mov_b32 v59, -1
    s_waitcnt vmcnt(0)
mega_kernel_rs_w3_pc:
    buffer_load_dword v36, v13, s[4:7], s25 offen offset:0 sc1
    buffer_load_dword v37, v13, s[4:7], s25 offen offset:256 sc1
    buffer_load_dword v38, v13, s[4:7], s25 offen offset:512 sc1
    buffer_load_dword v39, v13, s[4:7], s25 offen offset:768 sc1
    buffer_load_dword v40, v13, s[4:7], s25 offen offset:1024 sc1
    buffer_load_dword v41, v13, s[4:7], s25 offen offset:1280 sc1
    buffer_load_dword v42, v13, s[4:7], s25 offen offset:1536 sc1
    buffer_load_dword v43, v13, s[4:7], s25 offen offset:1792 sc1
    s_waitcnt vmcnt(4)
    v_mfma_f32_16x16x32_bf16 v[52:55], v[36:39], v[24:27], 0
    v_bitop3_b32 v3, s42, v36, v37 bitop3:0x7e
    v_bitop3_b32 v4, s42, v38, v39 bitop3:0x7e
    s_waitcnt vmcnt(2)
    v_or_b32 v3, v3, v4
    v_bitop3_b32 v4, s42, v40, v41 bitop3:0x7e
    s_waitcnt vmcnt(0)
    v_mfma_f32_16x16x32_bf16 v[52:55], v[40:43], v[24:27], v[52:55]
    v_bitop3_b32 v56, s42, v42, v43 bitop3:0x7e
    v_or3_b32 v3, v3, v4, v56
    v_and_b32 v3, v0, v3
    v_cmp_ne_u32 vcc, 0, v3
    s_nop 3
    v_cvt_pk_bf16_f32 v56, v52, v53
    v_cvt_pk_bf16_f32 v57, v54, v55
    v_min_u32 v56, -2, v56
    s_cbranch_vccnz mega_kernel_rs_w3_pc
    s_mov_b64 exec, s[26:27]
    buffer_store_dwordx2 v[56:57], v9, s[4:7], s35 offen offset:768 sc1
    buffer_store_dwordx2 v[58:59], v9, s[4:7], s36 offen offset:768 sc1
    s_mov_b64 exec, -1
    s_xor_b32 s42, s42, 1
    s_branch mega_kernel_rs_w3_loop
mega_kernel_rs_w3_last:
    buffer_store_dwordx4 v[64:67], v10, s[4:7], s45 offen offset:192 sc1
    buffer_store_dwordx2 v[18:19], v11, s[4:7], s51 offen offset:3584 sc1
    s_branch mega_kernel_rs_end
mega_kernel_rs_w3_pafail:
    s_nop 7
    v_mov_b32 v96, 0
    v_mov_b32 v97, 0
    v_mov_b32 v98, 0
    v_mov_b32 v99, 0
    v_mov_b32 v100, 0
    v_mov_b32 v101, 0
    v_mov_b32 v102, 0
    v_mov_b32 v103, 0
    v_mov_b32 v104, 0
    v_mov_b32 v105, 0
    v_mov_b32 v106, 0
    v_mov_b32 v107, 0
    s_branch mega_kernel_rs_w3_pa
mega_kernel_rs_w3_xslow:
    buffer_load_dwordx2 v[108:109], v11, s[4:7], s38 offen sc1
    buffer_load_dwordx2 v[110:111], v11, s[4:7], s38 offen offset:512 sc1
    s_waitcnt vmcnt(2)
    v_bitop3_b32 v3, s41, v20, v22 bitop3:0x7e
    v_mfma_f32_16x16x16_bf16 v[80:83], v[20:21], v[16:17], v[100:103]
    v_and_b32 v3, 1, v3
    v_mfma_f32_16x16x16_bf16 v[84:87], v[22:23], v[16:17], v[104:107]
    v_cmp_ne_u32 vcc, 0, v3
    s_cbranch_vccz mega_kernel_rs_w3_xgot
    buffer_load_dwordx2 v[20:21], v11, s[4:7], s38 offen sc1
    buffer_load_dwordx2 v[22:23], v11, s[4:7], s38 offen offset:512 sc1
    s_waitcnt vmcnt(2)
    v_bitop3_b32 v3, s41, v108, v110 bitop3:0x7e
    v_mfma_f32_16x16x16_bf16 v[80:83], v[108:109], v[16:17], v[100:103]
    v_and_b32 v3, 1, v3
    v_mfma_f32_16x16x16_bf16 v[84:87], v[110:111], v[16:17], v[104:107]
    v_cmp_ne_u32 vcc, 0, v3
    s_cbranch_vccz mega_kernel_rs_w3_xgot
    s_branch mega_kernel_rs_w3_xslow
mega_kernel_rs_w3_xgot:
    s_nop 3
    v_cvt_pk_bf16_f32 v64, v80, v81
    v_cvt_pk_bf16_f32 v65, v82, v83
    v_cvt_pk_bf16_f32 v66, v84, v85
    v_cvt_pk_bf16_f32 v67, v86, v87
    ds_write_b128 v6, v[64:67] offset:23552
    s_branch mega_kernel_rs_w3_xok
mega_kernel_rs_w3_pv0:
    s_waitcnt vmcnt(2)
    s_branch mega_kernel_rs_w3_pv1
mega_kernel_rs_w3_pv:
    buffer_load_dwordx2 v[20:21], v11, s[4:7], s40 offen sc1
    s_waitcnt vmcnt(0)
mega_kernel_rs_w3_pv1:
    v_and_b32 v3, 1, v20
    v_cmp_ne_u32 vcc, s41, v3
    v_mov_b32 v113, v20
    v_mov_b32 v115, v21
    s_cbranch_vccnz mega_kernel_rs_w3_pv
    s_branch mega_kernel_rs_w3_pv2
mega_kernel_rs_end:
    s_mov_b64 exec, -1
    v_mov_b32 v3, 64
    s_waitcnt vmcnt(0)
    s_barrier
    s_cmp_lg_u32 s20, 0
    s_cbranch_scc1 mega_kernel_rs_end2
    buffer_store_dword v3, v7, s[4:7], 0 offen sc1
mega_kernel_rs_end2:
    s_waitcnt vmcnt(0)
    s_endpgm
mega_kernel_bulk:
    s_load_dwordx2 s[8:9], s[0:1], 0
    s_load_dwordx2 s[40:41], s[0:1], 16
    s_load_dwordx2 s[42:43], s[0:1], 24
    s_load_dwordx2 s[44:45], s[0:1], 32
    v_lshrrev_b32 v2, 6, v0
    v_and_b32 v1, 63, v0
    v_readfirstlane_b32 s16, v2
    s_lshr_b32 s17, s92, 6
    s_bfe_u32 s18, s92, 0x50001
    s_and_b32 s19, s92, 1
    s_waitcnt lgkmcnt(0)
    s_mov_b32 s10, 4194304
    s_mov_b32 s11, 0x00020000
    s_cmp_eq_u32 s17, 1
    s_cselect_b32 s12, s42, s40
    s_cselect_b32 s13, s43, s41
    s_cmp_eq_u32 s17, 2
    s_cselect_b32 s12, s44, s12
    s_cselect_b32 s13, s45, s13
    s_mov_b32 s14, 8388608
    s_mov_b32 s15, 0x00020000
    v_lshrrev_b32 v2, 4, v1
    v_and_b32 v3, 15, v1
    v_lshlrev_b32 v4, 2, v2
    v_xor_b32 v4, v4, v3
    v_lshlrev_b32 v4, 4, v4
    s_lshl_b32 s20, s16, 5
    v_add_u32 v11, s20, v2
    v_lshl_add_u32 v11, v11, 13, v4
    s_lshl_b32 s20, s18, 8
    v_add_u32 v11, s20, v11
    s_lshl_b32 s22, s16, 13
    s_lshl_b32 s27, s19, 23
    s_and_b32 s27, s27, 4194304
    s_add_u32 m0, s22, 0
    s_xor_b32 s20, s27, 0
    buffer_load_dwordx4 v11, s[12:15], s20 offen lds
    s_add_u32 m0, s22, 1024
    s_xor_b32 s20, s27, 32768
    buffer_load_dwordx4 v11, s[12:15], s20 offen lds
    s_add_u32 m0, s22, 2048
    s_xor_b32 s20, s27, 65536
    buffer_load_dwordx4 v11, s[12:15], s20 offen lds
    s_add_u32 m0, s22, 3072
    s_xor_b32 s20, s27, 98304
    buffer_load_dwordx4 v11, s[12:15], s20 offen lds
    s_add_u32 m0, s22, 4096
    s_xor_b32 s20, s27, 131072
    buffer_load_dwordx4 v11, s[12:15], s20 offen lds
    s_add_u32 m0, s22, 5120
    s_xor_b32 s20, s27, 163840
    buffer_load_dwordx4 v11, s[12:15], s20 offen lds
    s_add_u32 m0, s22, 6144
    s_xor_b32 s20, s27, 196608
    buffer_load_dwordx4 v11, s[12:15], s20 offen lds
    s_add_u32 m0, s22, 7168
    s_xor_b32 s20, s27, 229376
    buffer_load_dwordx4 v11, s[12:15], s20 offen lds
    s_waitcnt vmcnt(8)
    s_barrier
    s_or_b32 s81, s97, s98
    s_cmp_lg_u32 s81, 0
    s_cbranch_scc1 mega_kernel_h0_3
    s_lshl_b32 s81, s93, 5
    v_mov_b32 v38, 1
    s_mov_b64 exec, 1
    buffer_atomic_add v38, off, s[88:91], s81 sc1
    s_mov_b64 exec, -1
mega_kernel_h0_3:
    s_add_u32 m0, s22, 32768
    s_xor_b32 s20, s27, 1048576
    buffer_load_dwordx4 v11, s[12:15], s20 offen lds
    s_add_u32 m0, s22, 33792
    s_xor_b32 s20, s27, 1081344
    buffer_load_dwordx4 v11, s[12:15], s20 offen lds
    s_add_u32 m0, s22, 34816
    s_xor_b32 s20, s27, 1114112
    buffer_load_dwordx4 v11, s[12:15], s20 offen lds
    s_add_u32 m0, s22, 35840
    s_xor_b32 s20, s27, 1146880
    buffer_load_dwordx4 v11, s[12:15], s20 offen lds
    s_add_u32 m0, s22, 36864
    s_xor_b32 s20, s27, 1179648
    buffer_load_dwordx4 v11, s[12:15], s20 offen lds
    s_add_u32 m0, s22, 37888
    s_xor_b32 s20, s27, 1212416
    buffer_load_dwordx4 v11, s[12:15], s20 offen lds
    s_add_u32 m0, s22, 38912
    s_xor_b32 s20, s27, 1245184
    buffer_load_dwordx4 v11, s[12:15], s20 offen lds
    s_add_u32 m0, s22, 39936
    s_xor_b32 s20, s27, 1277952
    buffer_load_dwordx4 v11, s[12:15], s20 offen lds
    s_add_u32 m0, s22, 65536
    s_xor_b32 s20, s27, 2097152
    buffer_load_dwordx4 v11, s[12:15], s20 offen lds
    s_add_u32 m0, s22, 66560
    s_xor_b32 s20, s27, 2129920
    buffer_load_dwordx4 v11, s[12:15], s20 offen lds
    s_add_u32 m0, s22, 67584
    s_xor_b32 s20, s27, 2162688
    buffer_load_dwordx4 v11, s[12:15], s20 offen lds
    s_add_u32 m0, s22, 68608
    s_xor_b32 s20, s27, 2195456
    buffer_load_dwordx4 v11, s[12:15], s20 offen lds
    s_add_u32 m0, s22, 69632
    s_xor_b32 s20, s27, 2228224
    buffer_load_dwordx4 v11, s[12:15], s20 offen lds
    s_add_u32 m0, s22, 70656
    s_xor_b32 s20, s27, 2260992
    buffer_load_dwordx4 v11, s[12:15], s20 offen lds
    s_add_u32 m0, s22, 71680
    s_xor_b32 s20, s27, 2293760
    buffer_load_dwordx4 v11, s[12:15], s20 offen lds
    s_add_u32 m0, s22, 72704
    s_xor_b32 s20, s27, 2326528
    buffer_load_dwordx4 v11, s[12:15], s20 offen lds
    s_add_u32 m0, s22, 98304
    s_xor_b32 s20, s27, 3145728
    buffer_load_dwordx4 v11, s[12:15], s20 offen lds
    s_add_u32 m0, s22, 99328
    s_xor_b32 s20, s27, 3178496
    buffer_load_dwordx4 v11, s[12:15], s20 offen lds
    s_add_u32 m0, s22, 100352
    s_xor_b32 s20, s27, 3211264
    buffer_load_dwordx4 v11, s[12:15], s20 offen lds
    s_add_u32 m0, s22, 101376
    s_xor_b32 s20, s27, 3244032
    buffer_load_dwordx4 v11, s[12:15], s20 offen lds
    s_add_u32 m0, s22, 102400
    s_xor_b32 s20, s27, 3276800
    buffer_load_dwordx4 v11, s[12:15], s20 offen lds
    s_add_u32 m0, s22, 103424
    s_xor_b32 s20, s27, 3309568
    buffer_load_dwordx4 v11, s[12:15], s20 offen lds
    s_add_u32 m0, s22, 104448
    s_xor_b32 s20, s27, 3342336
    buffer_load_dwordx4 v11, s[12:15], s20 offen lds
    s_add_u32 m0, s22, 105472
    s_xor_b32 s20, s27, 3375104
    buffer_load_dwordx4 v11, s[12:15], s20 offen lds
    v_and_b32 v3, 3, v1
    v_bfe_u32 v4, v1, 4, 1
    v_lshl_add_u32 v13, v3, 1, v4
    v_and_b32 v14, 1, v3
    v_lshlrev_b32 v14, 1, v14
    v_lshrrev_b32 v15, 1, v3
    v_add_u32 v14, v14, v15
    v_lshl_add_u32 v14, v4, 2, v14
    s_cmp_eq_u32 s17, 2
    s_cselect_b64 vcc, -1, 0
    v_cndmask_b32 v13, v14, v13, vcc
    v_bfe_u32 v14, v1, 2, 2
    v_xor_b32 v15, s16, v14
    v_lshlrev_b32 v15, 6, v15
    v_lshl_add_u32 v15, v13, 3, v15
    v_lshrrev_b32 v13, 5, v1
    v_lshl_add_u32 v13, v13, 3, v14
    v_lshl_add_u32 v12, v13, 8, v15
    v_and_b32 v3, 15, v1
    s_lshl_b32 s20, s16, 3
    v_add_u32 v13, s20, v2
    v_add_u32 v13, 0, v13
    v_and_b32 v14, 15, v13
    v_xor_b32 v14, v14, v3
    v_lshlrev_b32 v14, 4, v14
    v_lshl_add_u32 v6, v13, 11, v14
    v_add_u32 v13, s20, v2
    v_add_u32 v13, 4, v13
    v_and_b32 v14, 15, v13
    v_xor_b32 v14, v14, v3
    v_lshlrev_b32 v14, 4, v14
    v_lshl_add_u32 v7, v13, 11, v14
    v_and_b32 v13, 31, v1
    v_lshrrev_b32 v14, 5, v1
    v_xor_b32 v14, v14, v3
    v_lshlrev_b32 v14, 4, v14
    v_lshl_add_u32 v13, v13, 8, v14
    v_xor_b32 v16, 0, v13
    v_add_u32 v24, 0x10000, v16
    v_xor_b32 v17, 32, v13
    v_add_u32 v25, 0x10000, v17
    v_xor_b32 v18, 64, v13
    v_add_u32 v26, 0x10000, v18
    v_xor_b32 v19, 96, v13
    v_add_u32 v27, 0x10000, v19
    v_xor_b32 v20, 128, v13
    v_add_u32 v28, 0x10000, v20
    v_xor_b32 v21, 160, v13
    v_add_u32 v29, 0x10000, v21
    v_xor_b32 v22, 192, v13
    v_add_u32 v30, 0x10000, v22
    v_xor_b32 v23, 224, v13
    v_add_u32 v31, 0x10000, v23
    v_bfe_u32 v13, v1, 4, 1
    v_lshlrev_b32 v8, 10, v13
    v_lshrrev_b32 v13, 5, v1
    v_lshl_add_u32 v8, v13, 8, v8
    v_lshl_add_u32 v8, v3, 4, v8
    v_bfrev_b32 v13, 1
    s_lshl_b32 s20, s92, 7
    s_add_u32 s20, s20, 71303168
    v_mov_b32 v14, s20
    v_cmp_eq_u32 vcc, 0, v0
    s_lshl_b32 s24, s17, 24
    s_lshl_b32 s20, s19, 18
    v_cndmask_b32 v9, v13, v14, vcc
    s_add_u32 s24, s24, s20
    s_lshl_b32 s20, s18, 13
    s_add_u32 s24, s24, s20
    s_lshl_b32 s20, s16, 11
    s_add_u32 s24, s24, s20
    s_add_u32 s24, s24, 0
    s_lshl_b32 s23, s19, 16
    s_lshr_b32 s20, s27, 12
    s_add_u32 s23, s23, s20
    v_mov_b32 v10, 0
    s_lshl_b32 s21, s16, 11
    s_waitcnt vmcnt(24)
    s_barrier
    v_add_u32 v13, 0, v12
    ds_read_b64_tr_b16 a[0:1], v13 offset:0
    ds_read_b64_tr_b16 a[2:3], v13 offset:1024
    ds_read_b64_tr_b16 a[4:5], v13 offset:4096
    ds_read_b64_tr_b16 a[6:7], v13 offset:5120
    ds_read_b64_tr_b16 a[8:9], v13 offset:8192
    ds_read_b64_tr_b16 a[10:11], v13 offset:9216
    ds_read_b64_tr_b16 a[12:13], v13 offset:12288
    ds_read_b64_tr_b16 a[14:15], v13 offset:13312
    s_waitcnt lgkmcnt(0)
    ds_read_b64_tr_b16 a[16:17], v13 offset:16384
    ds_read_b64_tr_b16 a[18:19], v13 offset:17408
    ds_read_b64_tr_b16 a[20:21], v13 offset:20480
    ds_read_b64_tr_b16 a[22:23], v13 offset:21504
    ds_read_b64_tr_b16 a[24:25], v13 offset:24576
    ds_read_b64_tr_b16 a[26:27], v13 offset:25600
    ds_read_b64_tr_b16 a[28:29], v13 offset:28672
    ds_read_b64_tr_b16 a[30:31], v13 offset:29696
    s_waitcnt lgkmcnt(0)
    s_barrier
    s_add_u32 m0, s22, 0
    s_xor_b32 s20, s27, 4194304
    buffer_load_dwordx4 v11, s[12:15], s20 offen lds
    s_add_u32 m0, s22, 1024
    s_xor_b32 s20, s27, 4227072
    buffer_load_dwordx4 v11, s[12:15], s20 offen lds
    s_add_u32 m0, s22, 2048
    s_xor_b32 s20, s27, 4259840
    buffer_load_dwordx4 v11, s[12:15], s20 offen lds
    s_add_u32 m0, s22, 3072
    s_xor_b32 s20, s27, 4292608
    buffer_load_dwordx4 v11, s[12:15], s20 offen lds
    s_add_u32 m0, s22, 4096
    s_xor_b32 s20, s27, 4325376
    buffer_load_dwordx4 v11, s[12:15], s20 offen lds
    s_add_u32 m0, s22, 5120
    s_xor_b32 s20, s27, 4358144
    buffer_load_dwordx4 v11, s[12:15], s20 offen lds
    s_add_u32 m0, s22, 6144
    s_xor_b32 s20, s27, 4390912
    buffer_load_dwordx4 v11, s[12:15], s20 offen lds
    s_add_u32 m0, s22, 7168
    s_xor_b32 s20, s27, 4423680
    buffer_load_dwordx4 v11, s[12:15], s20 offen lds
    s_waitcnt vmcnt(24)
    s_barrier
    v_add_u32 v13, 32768, v12
    ds_read_b64_tr_b16 a[32:33], v13 offset:0
    ds_read_b64_tr_b16 a[34:35], v13 offset:1024
    ds_read_b64_tr_b16 a[36:37], v13 offset:4096
    ds_read_b64_tr_b16 a[38:39], v13 offset:5120
    ds_read_b64_tr_b16 a[40:41], v13 offset:8192
    ds_read_b64_tr_b16 a[42:43], v13 offset:9216
    ds_read_b64_tr_b16 a[44:45], v13 offset:12288
    ds_read_b64_tr_b16 a[46:47], v13 offset:13312
    s_waitcnt lgkmcnt(0)
    ds_read_b64_tr_b16 a[48:49], v13 offset:16384
    ds_read_b64_tr_b16 a[50:51], v13 offset:17408
    ds_read_b64_tr_b16 a[52:53], v13 offset:20480
    ds_read_b64_tr_b16 a[54:55], v13 offset:21504
    ds_read_b64_tr_b16 a[56:57], v13 offset:24576
    ds_read_b64_tr_b16 a[58:59], v13 offset:25600
    ds_read_b64_tr_b16 a[60:61], v13 offset:28672
    ds_read_b64_tr_b16 a[62:63], v13 offset:29696
    s_waitcnt lgkmcnt(0)
    s_barrier
    s_add_u32 m0, s22, 32768
    s_xor_b32 s20, s27, 5242880
    buffer_load_dwordx4 v11, s[12:15], s20 offen lds
    s_add_u32 m0, s22, 33792
    s_xor_b32 s20, s27, 5275648
    buffer_load_dwordx4 v11, s[12:15], s20 offen lds
    s_add_u32 m0, s22, 34816
    s_xor_b32 s20, s27, 5308416
    buffer_load_dwordx4 v11, s[12:15], s20 offen lds
    s_add_u32 m0, s22, 35840
    s_xor_b32 s20, s27, 5341184
    buffer_load_dwordx4 v11, s[12:15], s20 offen lds
    s_add_u32 m0, s22, 36864
    s_xor_b32 s20, s27, 5373952
    buffer_load_dwordx4 v11, s[12:15], s20 offen lds
    s_add_u32 m0, s22, 37888
    s_xor_b32 s20, s27, 5406720
    buffer_load_dwordx4 v11, s[12:15], s20 offen lds
    s_add_u32 m0, s22, 38912
    s_xor_b32 s20, s27, 5439488
    buffer_load_dwordx4 v11, s[12:15], s20 offen lds
    s_add_u32 m0, s22, 39936
    s_xor_b32 s20, s27, 5472256
    buffer_load_dwordx4 v11, s[12:15], s20 offen lds
    s_waitcnt vmcnt(24)
    s_barrier
    v_add_u32 v13, 65536, v12
    ds_read_b64_tr_b16 a[64:65], v13 offset:0
    ds_read_b64_tr_b16 a[66:67], v13 offset:1024
    ds_read_b64_tr_b16 a[68:69], v13 offset:4096
    ds_read_b64_tr_b16 a[70:71], v13 offset:5120
    ds_read_b64_tr_b16 a[72:73], v13 offset:8192
    ds_read_b64_tr_b16 a[74:75], v13 offset:9216
    ds_read_b64_tr_b16 a[76:77], v13 offset:12288
    ds_read_b64_tr_b16 a[78:79], v13 offset:13312
    s_waitcnt lgkmcnt(0)
    ds_read_b64_tr_b16 a[80:81], v13 offset:16384
    ds_read_b64_tr_b16 a[82:83], v13 offset:17408
    ds_read_b64_tr_b16 a[84:85], v13 offset:20480
    ds_read_b64_tr_b16 a[86:87], v13 offset:21504
    ds_read_b64_tr_b16 a[88:89], v13 offset:24576
    ds_read_b64_tr_b16 a[90:91], v13 offset:25600
    ds_read_b64_tr_b16 a[92:93], v13 offset:28672
    ds_read_b64_tr_b16 a[94:95], v13 offset:29696
    s_waitcnt lgkmcnt(0)
    s_barrier
    s_add_u32 m0, s22, 65536
    s_xor_b32 s20, s27, 6291456
    buffer_load_dwordx4 v11, s[12:15], s20 offen lds
    s_add_u32 m0, s22, 66560
    s_xor_b32 s20, s27, 6324224
    buffer_load_dwordx4 v11, s[12:15], s20 offen lds
    s_add_u32 m0, s22, 67584
    s_xor_b32 s20, s27, 6356992
    buffer_load_dwordx4 v11, s[12:15], s20 offen lds
    s_add_u32 m0, s22, 68608
    s_xor_b32 s20, s27, 6389760
    buffer_load_dwordx4 v11, s[12:15], s20 offen lds
    s_add_u32 m0, s22, 69632
    s_xor_b32 s20, s27, 6422528
    buffer_load_dwordx4 v11, s[12:15], s20 offen lds
    s_add_u32 m0, s22, 70656
    s_xor_b32 s20, s27, 6455296
    buffer_load_dwordx4 v11, s[12:15], s20 offen lds
    s_add_u32 m0, s22, 71680
    s_xor_b32 s20, s27, 6488064
    buffer_load_dwordx4 v11, s[12:15], s20 offen lds
    s_add_u32 m0, s22, 72704
    s_xor_b32 s20, s27, 6520832
    buffer_load_dwordx4 v11, s[12:15], s20 offen lds
    s_waitcnt vmcnt(24)
    s_barrier
    v_and_b32 v37, 7, v0
    v_lshlrev_b32 v37, 5, v37
    buffer_load_dword v36, v37, s[88:91], 0 offen sc1
    v_add_u32 v13, 98304, v12
    ds_read_b64_tr_b16 a[96:97], v13 offset:0
    ds_read_b64_tr_b16 a[98:99], v13 offset:1024
    ds_read_b64_tr_b16 a[100:101], v13 offset:4096
    ds_read_b64_tr_b16 a[102:103], v13 offset:5120
    ds_read_b64_tr_b16 a[104:105], v13 offset:8192
    ds_read_b64_tr_b16 a[106:107], v13 offset:9216
    ds_read_b64_tr_b16 a[108:109], v13 offset:12288
    ds_read_b64_tr_b16 a[110:111], v13 offset:13312
    s_waitcnt lgkmcnt(0)
    ds_read_b64_tr_b16 a[112:113], v13 offset:16384
    ds_read_b64_tr_b16 a[114:115], v13 offset:17408
    ds_read_b64_tr_b16 a[116:117], v13 offset:20480
    ds_read_b64_tr_b16 a[118:119], v13 offset:21504
    ds_read_b64_tr_b16 a[120:121], v13 offset:24576
    ds_read_b64_tr_b16 a[122:123], v13 offset:25600
    ds_read_b64_tr_b16 a[124:125], v13 offset:28672
    ds_read_b64_tr_b16 a[126:127], v13 offset:29696
    s_waitcnt lgkmcnt(0)
    s_barrier
    s_add_u32 m0, s22, 98304
    s_xor_b32 s20, s27, 7340032
    buffer_load_dwordx4 v11, s[12:15], s20 offen lds
    s_add_u32 m0, s22, 99328
    s_xor_b32 s20, s27, 7372800
    buffer_load_dwordx4 v11, s[12:15], s20 offen lds
    s_add_u32 m0, s22, 100352
    s_xor_b32 s20, s27, 7405568
    buffer_load_dwordx4 v11, s[12:15], s20 offen lds
    s_add_u32 m0, s22, 101376
    s_xor_b32 s20, s27, 7438336
    buffer_load_dwordx4 v11, s[12:15], s20 offen lds
    s_add_u32 m0, s22, 102400
    s_xor_b32 s20, s27, 7471104
    buffer_load_dwordx4 v11, s[12:15], s20 offen lds
    s_add_u32 m0, s22, 103424
    s_xor_b32 s20, s27, 7503872
    buffer_load_dwordx4 v11, s[12:15], s20 offen lds
    s_add_u32 m0, s22, 104448
    s_xor_b32 s20, s27, 7536640
    buffer_load_dwordx4 v11, s[12:15], s20 offen lds
    s_add_u32 m0, s22, 105472
    s_xor_b32 s20, s27, 7569408
    buffer_load_dwordx4 v11, s[12:15], s20 offen lds
    s_waitcnt vmcnt(24)
    s_barrier
    v_add_u32 v13, 0, v12
    ds_read_b64_tr_b16 a[128:129], v13 offset:0
    ds_read_b64_tr_b16 a[130:131], v13 offset:1024
    ds_read_b64_tr_b16 a[132:133], v13 offset:4096
    ds_read_b64_tr_b16 a[134:135], v13 offset:5120
    ds_read_b64_tr_b16 a[136:137], v13 offset:8192
    ds_read_b64_tr_b16 a[138:139], v13 offset:9216
    ds_read_b64_tr_b16 a[140:141], v13 offset:12288
    ds_read_b64_tr_b16 a[142:143], v13 offset:13312
    s_waitcnt lgkmcnt(0)
    ds_read_b64_tr_b16 a[144:145], v13 offset:16384
    ds_read_b64_tr_b16 a[146:147], v13 offset:17408
    ds_read_b64_tr_b16 a[148:149], v13 offset:20480
    ds_read_b64_tr_b16 a[150:151], v13 offset:21504
    ds_read_b64_tr_b16 a[152:153], v13 offset:24576
    ds_read_b64_tr_b16 a[154:155], v13 offset:25600
    ds_read_b64_tr_b16 a[156:157], v13 offset:28672
    ds_read_b64_tr_b16 a[158:159], v13 offset:29696
    s_waitcnt lgkmcnt(0)
    s_barrier
    s_add_u32 m0, s21, 0
    s_xor_b32 s20, s23, 0
    buffer_load_dwordx4 v6, s[8:11], s20 offen lds
    s_add_u32 m0, s21, 1024
    s_xor_b32 s20, s23, 0
    buffer_load_dwordx4 v7, s[8:11], s20 offen lds
    s_add_u32 m0, s21, 8192
    s_xor_b32 s20, s23, 256
    buffer_load_dwordx4 v6, s[8:11], s20 offen lds
    s_add_u32 m0, s21, 9216
    s_xor_b32 s20, s23, 256
    buffer_load_dwordx4 v7, s[8:11], s20 offen lds
    s_add_u32 m0, s21, 16384
    s_xor_b32 s20, s23, 512
    buffer_load_dwordx4 v6, s[8:11], s20 offen lds
    s_add_u32 m0, s21, 17408
    s_xor_b32 s20, s23, 512
    buffer_load_dwordx4 v7, s[8:11], s20 offen lds
    s_add_u32 m0, s21, 24576
    s_xor_b32 s20, s23, 768
    buffer_load_dwordx4 v6, s[8:11], s20 offen lds
    s_add_u32 m0, s21, 25600
    s_xor_b32 s20, s23, 768
    buffer_load_dwordx4 v7, s[8:11], s20 offen lds
    s_waitcnt vmcnt(24)
    s_barrier
    v_add_u32 v13, 32768, v12
    ds_read_b64_tr_b16 a[160:161], v13 offset:0
    ds_read_b64_tr_b16 a[162:163], v13 offset:1024
    ds_read_b64_tr_b16 a[164:165], v13 offset:4096
    ds_read_b64_tr_b16 a[166:167], v13 offset:5120
    ds_read_b64_tr_b16 a[168:169], v13 offset:8192
    ds_read_b64_tr_b16 a[170:171], v13 offset:9216
    ds_read_b64_tr_b16 a[172:173], v13 offset:12288
    ds_read_b64_tr_b16 a[174:175], v13 offset:13312
    s_waitcnt lgkmcnt(0)
    ds_read_b64_tr_b16 a[176:177], v13 offset:16384
    ds_read_b64_tr_b16 a[178:179], v13 offset:17408
    ds_read_b64_tr_b16 a[180:181], v13 offset:20480
    ds_read_b64_tr_b16 a[182:183], v13 offset:21504
    ds_read_b64_tr_b16 a[184:185], v13 offset:24576
    ds_read_b64_tr_b16 a[186:187], v13 offset:25600
    ds_read_b64_tr_b16 a[188:189], v13 offset:28672
    ds_read_b64_tr_b16 a[190:191], v13 offset:29696
    s_waitcnt lgkmcnt(0)
    s_barrier
    s_add_u32 m0, s21, 32768
    s_xor_b32 s20, s23, 1024
    buffer_load_dwordx4 v6, s[8:11], s20 offen lds
    s_add_u32 m0, s21, 33792
    s_xor_b32 s20, s23, 1024
    buffer_load_dwordx4 v7, s[8:11], s20 offen lds
    s_add_u32 m0, s21, 40960
    s_xor_b32 s20, s23, 1280
    buffer_load_dwordx4 v6, s[8:11], s20 offen lds
    s_add_u32 m0, s21, 41984
    s_xor_b32 s20, s23, 1280
    buffer_load_dwordx4 v7, s[8:11], s20 offen lds
    s_add_u32 m0, s21, 49152
    s_xor_b32 s20, s23, 1536
    buffer_load_dwordx4 v6, s[8:11], s20 offen lds
    s_add_u32 m0, s21, 50176
    s_xor_b32 s20, s23, 1536
    buffer_load_dwordx4 v7, s[8:11], s20 offen lds
    s_add_u32 m0, s21, 57344
    s_xor_b32 s20, s23, 1792
    buffer_load_dwordx4 v6, s[8:11], s20 offen lds
    s_add_u32 m0, s21, 58368
    s_xor_b32 s20, s23, 1792
    buffer_load_dwordx4 v7, s[8:11], s20 offen lds
    s_waitcnt vmcnt(24)
    s_barrier
    v_add_u32 v13, 65536, v12
    ds_read_b64_tr_b16 a[192:193], v13 offset:0
    ds_read_b64_tr_b16 a[194:195], v13 offset:1024
    ds_read_b64_tr_b16 a[196:197], v13 offset:4096
    ds_read_b64_tr_b16 a[198:199], v13 offset:5120
    ds_read_b64_tr_b16 a[200:201], v13 offset:8192
    ds_read_b64_tr_b16 a[202:203], v13 offset:9216
    ds_read_b64_tr_b16 a[204:205], v13 offset:12288
    ds_read_b64_tr_b16 a[206:207], v13 offset:13312
    s_waitcnt lgkmcnt(0)
    ds_read_b64_tr_b16 a[208:209], v13 offset:16384
    ds_read_b64_tr_b16 a[210:211], v13 offset:17408
    ds_read_b64_tr_b16 a[212:213], v13 offset:20480
    ds_read_b64_tr_b16 a[214:215], v13 offset:21504
    ds_read_b64_tr_b16 a[216:217], v13 offset:24576
    ds_read_b64_tr_b16 a[218:219], v13 offset:25600
    ds_read_b64_tr_b16 a[220:221], v13 offset:28672
    ds_read_b64_tr_b16 a[222:223], v13 offset:29696
    s_waitcnt lgkmcnt(0)
    s_barrier
    s_add_u32 s23, s23, 131072
    s_add_u32 m0, s21, 65536
    s_xor_b32 s20, s23, 0
    buffer_load_dwordx4 v6, s[8:11], s20 offen lds
    s_add_u32 m0, s21, 66560
    s_xor_b32 s20, s23, 0
    buffer_load_dwordx4 v7, s[8:11], s20 offen lds
    s_add_u32 m0, s21, 73728
    s_xor_b32 s20, s23, 256
    buffer_load_dwordx4 v6, s[8:11], s20 offen lds
    s_add_u32 m0, s21, 74752
    s_xor_b32 s20, s23, 256
    buffer_load_dwordx4 v7, s[8:11], s20 offen lds
    s_add_u32 m0, s21, 81920
    s_xor_b32 s20, s23, 512
    buffer_load_dwordx4 v6, s[8:11], s20 offen lds
    s_add_u32 m0, s21, 82944
    s_xor_b32 s20, s23, 512
    buffer_load_dwordx4 v7, s[8:11], s20 offen lds
    s_add_u32 m0, s21, 90112
    s_xor_b32 s20, s23, 768
    buffer_load_dwordx4 v6, s[8:11], s20 offen lds
    s_add_u32 m0, s21, 91136
    s_xor_b32 s20, s23, 768
    buffer_load_dwordx4 v7, s[8:11], s20 offen lds
    s_waitcnt vmcnt(24)
    s_barrier
    s_cmp_lg_u32 s97, 0
    s_cbranch_scc1 mega_kernel_h2_4_ok
mega_kernel_h2_4_ev:
    v_cmp_ne_u32 vcc, 32, v36
    s_cbranch_vccz mega_kernel_h2_4_ok
    s_mov_b32 s78, 0
    v_readlane_b32 s81, v36, 0
    s_nop 3
    s_add_u32 s78, s78, s81
    v_readlane_b32 s81, v36, 1
    s_nop 3
    s_add_u32 s78, s78, s81
    v_readlane_b32 s81, v36, 2
    s_nop 3
    s_add_u32 s78, s78, s81
    v_readlane_b32 s81, v36, 3
    s_nop 3
    s_add_u32 s78, s78, s81
    v_readlane_b32 s81, v36, 4
    s_nop 3
    s_add_u32 s78, s78, s81
    v_readlane_b32 s81, v36, 5
    s_nop 3
    s_add_u32 s78, s78, s81
    v_readlane_b32 s81, v36, 6
    s_nop 3
    s_add_u32 s78, s78, s81
    v_readlane_b32 s81, v36, 7
    s_nop 3
    s_add_u32 s78, s78, s81
    s_cmp_eq_u32 s78, 256
    s_cbranch_scc1 mega_kernel_redo
    buffer_load_dword v36, v37, s[88:91], 0 offen sc1
    s_waitcnt vmcnt(0)
    s_branch mega_kernel_h2_4_ev
mega_kernel_h2_4_ok:
    v_add_u32 v13, 98304, v12
    ds_read_b64_tr_b16 a[224:225], v13 offset:0
    ds_read_b64_tr_b16 a[226:227], v13 offset:1024
    ds_read_b64_tr_b16 a[228:229], v13 offset:4096
    ds_read_b64_tr_b16 a[230:231], v13 offset:5120
    ds_read_b64_tr_b16 a[232:233], v13 offset:8192
    ds_read_b64_tr_b16 a[234:235], v13 offset:9216
    ds_read_b64_tr_b16 a[236:237], v13 offset:12288
    ds_read_b64_tr_b16 a[238:239], v13 offset:13312
    s_waitcnt lgkmcnt(0)
    ds_read_b64_tr_b16 a[240:241], v13 offset:16384
    ds_read_b64_tr_b16 a[242:243], v13 offset:17408
    ds_read_b64_tr_b16 a[244:245], v13 offset:20480
    ds_read_b64_tr_b16 a[246:247], v13 offset:21504
    ds_read_b64_tr_b16 a[248:249], v13 offset:24576
    ds_read_b64_tr_b16 a[250:251], v13 offset:25600
    ds_read_b64_tr_b16 a[252:253], v13 offset:28672
    ds_read_b64_tr_b16 a[254:255], v13 offset:29696
    s_waitcnt lgkmcnt(0)
    s_barrier
    s_waitcnt vmcnt(16)
    s_barrier
    s_cmp_eq_u32 s17, 2
    s_cbranch_scc1 mega_kernel_q_v
    ds_read_b128 v[32:35], v16 offset:0
    ds_read_b128 v[36:39], v17 offset:0
    ds_read_b128 v[40:43], v18 offset:0
    ds_read_b128 v[44:47], v19 offset:0
    ds_read_b128 v[48:51], v20 offset:0
    ds_read_b128 v[52:55], v21 offset:0
    s_mov_b32 s25, 0
mega_kernel_q_qk_loop:
    s_waitcnt lgkmcnt(5)
    v_mfma_f32_32x32x16_bf16 v[64:79], a[0:3], v[32:35], 0
    ds_read_b128 v[56:59], v22 offset:0
    s_waitcnt lgkmcnt(5)
    v_mfma_f32_32x32x16_bf16 v[64:79], a[4:7], v[36:39], v[64:79]
    ds_read_b128 v[60:63], v23 offset:0
    s_waitcnt lgkmcnt(5)
    v_mfma_f32_32x32x16_bf16 v[64:79], a[8:11], v[40:43], v[64:79]
    ds_read_b128 v[32:35], v16 offset:8192
    s_cmp_eq_u32 s25, 0
    s_cbranch_scc1 mega_kernel_q_qk_sk2
    s_add_u32 m0, s21, 74752
    s_xor_b32 s20, s23, 256
    buffer_load_dwordx4 v7, s[8:11], s20 offen lds
mega_kernel_q_qk_sk2:
    s_waitcnt lgkmcnt(5)
    v_mfma_f32_32x32x16_bf16 v[64:79], a[12:15], v[44:47], v[64:79]
    ds_read_b128 v[36:39], v17 offset:8192
    s_waitcnt lgkmcnt(5)
    v_mfma_f32_32x32x16_bf16 v[64:79], a[16:19], v[48:51], v[64:79]
    ds_read_b128 v[40:43], v18 offset:8192
    s_waitcnt lgkmcnt(5)
    v_mfma_f32_32x32x16_bf16 v[64:79], a[20:23], v[52:55], v[64:79]
    ds_read_b128 v[44:47], v19 offset:8192
    s_cmp_eq_u32 s25, 0
    s_cbranch_scc1 mega_kernel_q_qk_sk5
    s_add_u32 m0, s21, 81920
    s_xor_b32 s20, s23, 512
    buffer_load_dwordx4 v6, s[8:11], s20 offen lds
mega_kernel_q_qk_sk5:
    s_waitcnt lgkmcnt(5)
    v_mfma_f32_32x32x16_bf16 v[64:79], a[24:27], v[56:59], v[64:79]
    ds_read_b128 v[48:51], v20 offset:8192
    s_waitcnt lgkmcnt(5)
    v_mfma_f32_32x32x16_bf16 v[64:79], a[28:31], v[60:63], v[64:79]
    ds_read_b128 v[52:55], v21 offset:8192
    s_waitcnt lgkmcnt(5)
    v_mfma_f32_32x32x16_bf16 v[64:79], a[32:35], v[32:35], v[64:79]
    ds_read_b128 v[56:59], v22 offset:8192
    s_cmp_eq_u32 s25, 0
    s_cbranch_scc1 mega_kernel_q_qk_sk8
    s_add_u32 m0, s21, 82944
    s_xor_b32 s20, s23, 512
    buffer_load_dwordx4 v7, s[8:11], s20 offen lds
mega_kernel_q_qk_sk8:
    s_waitcnt lgkmcnt(5)
    v_mfma_f32_32x32x16_bf16 v[64:79], a[36:39], v[36:39], v[64:79]
    ds_read_b128 v[60:63], v23 offset:8192
    s_waitcnt lgkmcnt(5)
    v_mfma_f32_32x32x16_bf16 v[64:79], a[40:43], v[40:43], v[64:79]
    ds_read_b128 v[32:35], v16 offset:16384
    s_waitcnt lgkmcnt(5)
    v_mfma_f32_32x32x16_bf16 v[64:79], a[44:47], v[44:47], v[64:79]
    ds_read_b128 v[36:39], v17 offset:16384
    s_cmp_eq_u32 s25, 0
    s_cbranch_scc1 mega_kernel_q_qk_sk11
    s_add_u32 m0, s21, 90112
    s_xor_b32 s20, s23, 768
    buffer_load_dwordx4 v6, s[8:11], s20 offen lds
mega_kernel_q_qk_sk11:
    s_waitcnt lgkmcnt(5)
    v_mfma_f32_32x32x16_bf16 v[64:79], a[48:51], v[48:51], v[64:79]
    ds_read_b128 v[40:43], v18 offset:16384
    s_waitcnt lgkmcnt(5)
    v_mfma_f32_32x32x16_bf16 v[64:79], a[52:55], v[52:55], v[64:79]
    ds_read_b128 v[44:47], v19 offset:16384
    s_waitcnt lgkmcnt(5)
    v_mfma_f32_32x32x16_bf16 v[64:79], a[56:59], v[56:59], v[64:79]
    ds_read_b128 v[48:51], v20 offset:16384
    s_cmp_eq_u32 s25, 0
    s_cbranch_scc1 mega_kernel_q_qk_sk14
    s_add_u32 m0, s21, 91136
    s_xor_b32 s20, s23, 768
    buffer_load_dwordx4 v7, s[8:11], s20 offen lds
mega_kernel_q_qk_sk14:
    s_waitcnt lgkmcnt(5)
    v_mfma_f32_32x32x16_bf16 v[64:79], a[60:63], v[60:63], v[64:79]
    ds_read_b128 v[52:55], v21 offset:16384
    s_waitcnt lgkmcnt(5)
    v_mfma_f32_32x32x16_bf16 v[64:79], a[64:67], v[32:35], v[64:79]
    ds_read_b128 v[56:59], v22 offset:16384
    s_cmp_eq_u32 s25, 0
    s_cbranch_scc1 mega_kernel_q_qk_ne0
    v_cvt_pk_bf16_f32 v96, v80, v81
    v_cvt_pk_bf16_f32 v97, v82, v83
    v_cvt_pk_bf16_f32 v98, v84, v85
    v_cvt_pk_bf16_f32 v99, v86, v87
    buffer_store_dwordx4 v[96:99], v8, s[84:87], s24 offen offset:0 sc1
mega_kernel_q_qk_ne0:
    s_waitcnt lgkmcnt(5)
    v_mfma_f32_32x32x16_bf16 v[64:79], a[68:71], v[36:39], v[64:79]
    ds_read_b128 v[60:63], v23 offset:16384
    s_waitcnt lgkmcnt(5)
    v_mfma_f32_32x32x16_bf16 v[64:79], a[72:75], v[40:43], v[64:79]
    ds_read_b128 v[32:35], v16 offset:24576
    s_cmp_eq_u32 s25, 0
    s_cbranch_scc1 mega_kernel_q_qk_ne1
    v_cvt_pk_bf16_f32 v100, v88, v89
    v_cvt_pk_bf16_f32 v101, v90, v91
    v_cvt_pk_bf16_f32 v102, v92, v93
    v_cvt_pk_bf16_f32 v103, v94, v95
    buffer_store_dwordx4 v[100:103], v8, s[84:87], s24 offen offset:512 sc1
    s_add_u32 s24, s24, 524288
mega_kernel_q_qk_ne1:
    s_waitcnt lgkmcnt(5)
    v_mfma_f32_32x32x16_bf16 v[64:79], a[76:79], v[44:47], v[64:79]
    ds_read_b128 v[36:39], v17 offset:24576
    s_waitcnt lgkmcnt(5)
    v_mfma_f32_32x32x16_bf16 v[64:79], a[80:83], v[48:51], v[64:79]
    ds_read_b128 v[40:43], v18 offset:24576
    s_waitcnt lgkmcnt(5)
    v_mfma_f32_32x32x16_bf16 v[64:79], a[84:87], v[52:55], v[64:79]
    ds_read_b128 v[44:47], v19 offset:24576
    s_waitcnt lgkmcnt(5)
    v_mfma_f32_32x32x16_bf16 v[64:79], a[88:91], v[56:59], v[64:79]
    ds_read_b128 v[48:51], v20 offset:24576
    s_waitcnt lgkmcnt(5)
    v_mfma_f32_32x32x16_bf16 v[64:79], a[92:95], v[60:63], v[64:79]
    ds_read_b128 v[52:55], v21 offset:24576
    s_waitcnt vmcnt(8)
    s_barrier
    s_waitcnt lgkmcnt(5)
    v_mfma_f32_32x32x16_bf16 v[64:79], a[96:99], v[32:35], v[64:79]
    ds_read_b128 v[56:59], v22 offset:24576
    s_waitcnt lgkmcnt(5)
    v_mfma_f32_32x32x16_bf16 v[64:79], a[100:103], v[36:39], v[64:79]
    ds_read_b128 v[60:63], v23 offset:24576
    s_add_u32 m0, s21, 98304
    s_xor_b32 s20, s23, 1024
    buffer_load_dwordx4 v6, s[8:11], s20 offen lds
    s_waitcnt lgkmcnt(5)
    v_mfma_f32_32x32x16_bf16 v[64:79], a[104:107], v[40:43], v[64:79]
    ds_read_b128 v[32:35], v16 offset:32768
    s_waitcnt lgkmcnt(5)
    v_mfma_f32_32x32x16_bf16 v[64:79], a[108:111], v[44:47], v[64:79]
    ds_read_b128 v[36:39], v17 offset:32768
    s_waitcnt lgkmcnt(5)
    v_mfma_f32_32x32x16_bf16 v[64:79], a[112:115], v[48:51], v[64:79]
    ds_read_b128 v[40:43], v18 offset:32768
    s_add_u32 m0, s21, 99328
    s_xor_b32 s20, s23, 1024
    buffer_load_dwordx4 v7, s[8:11], s20 offen lds
    s_waitcnt lgkmcnt(5)
    v_mfma_f32_32x32x16_bf16 v[64:79], a[116:119], v[52:55], v[64:79]
    ds_read_b128 v[44:47], v19 offset:32768
    s_waitcnt lgkmcnt(5)
    v_mfma_f32_32x32x16_bf16 v[64:79], a[120:123], v[56:59], v[64:79]
    ds_read_b128 v[48:51], v20 offset:32768
    s_waitcnt lgkmcnt(5)
    v_mfma_f32_32x32x16_bf16 v[64:79], a[124:127], v[60:63], v[64:79]
    ds_read_b128 v[52:55], v21 offset:32768
    s_add_u32 m0, s21, 106496
    s_xor_b32 s20, s23, 1280
    buffer_load_dwordx4 v6, s[8:11], s20 offen lds
    s_waitcnt lgkmcnt(5)
    v_mfma_f32_32x32x16_bf16 v[64:79], a[128:131], v[32:35], v[64:79]
    ds_read_b128 v[56:59], v22 offset:32768
    s_waitcnt lgkmcnt(5)
    v_mfma_f32_32x32x16_bf16 v[64:79], a[132:135], v[36:39], v[64:79]
    ds_read_b128 v[60:63], v23 offset:32768
    s_waitcnt lgkmcnt(5)
    v_mfma_f32_32x32x16_bf16 v[64:79], a[136:139], v[40:43], v[64:79]
    ds_read_b128 v[32:35], v16 offset:40960
    s_add_u32 m0, s21, 107520
    s_xor_b32 s20, s23, 1280
    buffer_load_dwordx4 v7, s[8:11], s20 offen lds
    s_waitcnt lgkmcnt(5)
    v_mfma_f32_32x32x16_bf16 v[64:79], a[140:143], v[44:47], v[64:79]
    ds_read_b128 v[36:39], v17 offset:40960
    s_waitcnt lgkmcnt(5)
    v_mfma_f32_32x32x16_bf16 v[64:79], a[144:147], v[48:51], v[64:79]
    ds_read_b128 v[40:43], v18 offset:40960
    s_waitcnt lgkmcnt(5)
    v_mfma_f32_32x32x16_bf16 v[64:79], a[148:151], v[52:55], v[64:79]
    ds_read_b128 v[44:47], v19 offset:40960
    s_add_u32 m0, s21, 114688
    s_xor_b32 s20, s23, 1536
    buffer_load_dwordx4 v6, s[8:11], s20 offen lds
    s_waitcnt lgkmcnt(5)
    v_mfma_f32_32x32x16_bf16 v[64:79], a[152:155], v[56:59], v[64:79]
    ds_read_b128 v[48:51], v20 offset:40960
    s_waitcnt lgkmcnt(5)
    v_mfma_f32_32x32x16_bf16 v[64:79], a[156:159], v[60:63], v[64:79]
    ds_read_b128 v[52:55], v21 offset:40960
    s_waitcnt lgkmcnt(5)
    v_mfma_f32_32x32x16_bf16 v[64:79], a[160:163], v[32:35], v[64:79]
    ds_read_b128 v[56:59], v22 offset:40960
    s_add_u32 m0, s21, 115712
    s_xor_b32 s20, s23, 1536
    buffer_load_dwordx4 v7, s[8:11], s20 offen lds
    s_waitcnt lgkmcnt(5)
    v_mfma_f32_32x32x16_bf16 v[64:79], a[164:167], v[36:39], v[64:79]
    ds_read_b128 v[60:63], v23 offset:40960
    s_waitcnt lgkmcnt(5)
    v_mfma_f32_32x32x16_bf16 v[64:79], a[168:171], v[40:43], v[64:79]
    ds_read_b128 v[32:35], v16 offset:49152
    s_waitcnt lgkmcnt(5)
    v_mfma_f32_32x32x16_bf16 v[64:79], a[172:175], v[44:47], v[64:79]
    ds_read_b128 v[36:39], v17 offset:49152
    s_add_u32 m0, s21, 122880
    s_xor_b32 s20, s23, 1792
    buffer_load_dwordx4 v6, s[8:11], s20 offen lds
    s_waitcnt lgkmcnt(5)
    v_mfma_f32_32x32x16_bf16 v[64:79], a[176:179], v[48:51], v[64:79]
    ds_read_b128 v[40:43], v18 offset:49152
    s_waitcnt lgkmcnt(5)
    v_mfma_f32_32x32x16_bf16 v[64:79], a[180:183], v[52:55], v[64:79]
    ds_read_b128 v[44:47], v19 offset:49152
    s_waitcnt lgkmcnt(5)
    v_mfma_f32_32x32x16_bf16 v[64:79], a[184:187], v[56:59], v[64:79]
    ds_read_b128 v[48:51], v20 offset:49152
    s_add_u32 m0, s21, 123904
    s_xor_b32 s20, s23, 1792
    buffer_load_dwordx4 v7, s[8:11], s20 offen lds
    s_waitcnt lgkmcnt(5)
    v_mfma_f32_32x32x16_bf16 v[64:79], a[188:191], v[60:63], v[64:79]
    ds_read_b128 v[52:55], v21 offset:49152
    s_waitcnt lgkmcnt(5)
    v_mfma_f32_32x32x16_bf16 v[64:79], a[192:195], v[32:35], v[64:79]
    ds_read_b128 v[56:59], v22 offset:49152
    s_waitcnt lgkmcnt(5)
    v_mfma_f32_32x32x16_bf16 v[64:79], a[196:199], v[36:39], v[64:79]
    ds_read_b128 v[60:63], v23 offset:49152
    s_waitcnt lgkmcnt(5)
    v_mfma_f32_32x32x16_bf16 v[64:79], a[200:203], v[40:43], v[64:79]
    ds_read_b128 v[32:35], v16 offset:57344
    s_waitcnt lgkmcnt(5)
    v_mfma_f32_32x32x16_bf16 v[64:79], a[204:207], v[44:47], v[64:79]
    ds_read_b128 v[36:39], v17 offset:57344
    s_waitcnt lgkmcnt(5)
    v_mfma_f32_32x32x16_bf16 v[64:79], a[208:211], v[48:51], v[64:79]
    ds_read_b128 v[40:43], v18 offset:57344
    s_waitcnt lgkmcnt(5)
    v_mfma_f32_32x32x16_bf16 v[64:79], a[212:215], v[52:55], v[64:79]
    ds_read_b128 v[44:47], v19 offset:57344
    s_waitcnt lgkmcnt(5)
    v_mfma_f32_32x32x16_bf16 v[64:79], a[216:219], v[56:59], v[64:79]
    ds_read_b128 v[48:51], v20 offset:57344
    s_waitcnt lgkmcnt(5)
    v_mfma_f32_32x32x16_bf16 v[64:79], a[220:223], v[60:63], v[64:79]
    ds_read_b128 v[52:55], v21 offset:57344
    s_waitcnt vmcnt(8)
    s_barrier
    s_waitcnt lgkmcnt(5)
    v_mfma_f32_32x32x16_bf16 v[64:79], a[224:227], v[32:35], v[64:79]
    ds_read_b128 v[56:59], v22 offset:57344
    s_waitcnt lgkmcnt(5)
    v_mfma_f32_32x32x16_bf16 v[64:79], a[228:231], v[36:39], v[64:79]
    ds_read_b128 v[60:63], v23 offset:57344
    s_add_u32 s23, s23, 131072
    s_add_u32 m0, s21, 0
    s_xor_b32 s20, s23, 0
    buffer_load_dwordx4 v6, s[8:11], s20 offen lds
    s_waitcnt lgkmcnt(5)
    v_mfma_f32_32x32x16_bf16 v[64:79], a[232:235], v[40:43], v[64:79]
    ds_read_b128 v[32:35], v24 offset:0
    s_cmp_eq_u32 s25, 0
    s_cbranch_scc1 mega_kernel_q_qk_nf
    v_add_u32 v10, 1, v10
    buffer_store_dword v10, v9, s[84:87], 0 offen sc1
mega_kernel_q_qk_nf:
    s_waitcnt lgkmcnt(5)
    v_mfma_f32_32x32x16_bf16 v[64:79], a[236:239], v[44:47], v[64:79]
    ds_read_b128 v[36:39], v25 offset:0
    s_waitcnt lgkmcnt(5)
    v_mfma_f32_32x32x16_bf16 v[64:79], a[240:243], v[48:51], v[64:79]
    ds_read_b128 v[40:43], v26 offset:0
    s_add_u32 m0, s21, 1024
    s_xor_b32 s20, s23, 0
    buffer_load_dwordx4 v7, s[8:11], s20 offen lds
    s_waitcnt lgkmcnt(5)
    v_mfma_f32_32x32x16_bf16 v[64:79], a[244:247], v[52:55], v[64:79]
    ds_read_b128 v[44:47], v27 offset:0
    s_waitcnt lgkmcnt(5)
    v_mfma_f32_32x32x16_bf16 v[64:79], a[248:251], v[56:59], v[64:79]
    ds_read_b128 v[48:51], v28 offset:0
    s_waitcnt lgkmcnt(5)
    v_mfma_f32_32x32x16_bf16 v[64:79], a[252:255], v[60:63], v[64:79]
    ds_read_b128 v[52:55], v29 offset:0
    s_add_u32 m0, s21, 8192
    s_xor_b32 s20, s23, 256
    buffer_load_dwordx4 v6, s[8:11], s20 offen lds
    s_waitcnt lgkmcnt(5)
    v_mfma_f32_32x32x16_bf16 v[80:95], a[0:3], v[32:35], 0
    ds_read_b128 v[56:59], v30 offset:0
    s_waitcnt lgkmcnt(5)
    v_mfma_f32_32x32x16_bf16 v[80:95], a[4:7], v[36:39], v[80:95]
    ds_read_b128 v[60:63], v31 offset:0
    s_waitcnt lgkmcnt(5)
    v_mfma_f32_32x32x16_bf16 v[80:95], a[8:11], v[40:43], v[80:95]
    ds_read_b128 v[32:35], v24 offset:8192
    s_add_u32 m0, s21, 9216
    s_xor_b32 s20, s23, 256
    buffer_load_dwordx4 v7, s[8:11], s20 offen lds
    s_waitcnt lgkmcnt(5)
    v_mfma_f32_32x32x16_bf16 v[80:95], a[12:15], v[44:47], v[80:95]
    ds_read_b128 v[36:39], v25 offset:8192
    s_waitcnt lgkmcnt(5)
    v_mfma_f32_32x32x16_bf16 v[80:95], a[16:19], v[48:51], v[80:95]
    ds_read_b128 v[40:43], v26 offset:8192
    s_waitcnt lgkmcnt(5)
    v_mfma_f32_32x32x16_bf16 v[80:95], a[20:23], v[52:55], v[80:95]
    ds_read_b128 v[44:47], v27 offset:8192
    s_add_u32 m0, s21, 16384
    s_xor_b32 s20, s23, 512
    buffer_load_dwordx4 v6, s[8:11], s20 offen lds
    s_waitcnt lgkmcnt(5)
    v_mfma_f32_32x32x16_bf16 v[80:95], a[24:27], v[56:59], v[80:95]
    ds_read_b128 v[48:51], v28 offset:8192
    s_waitcnt lgkmcnt(5)
    v_mfma_f32_32x32x16_bf16 v[80:95], a[28:31], v[60:63], v[80:95]
    ds_read_b128 v[52:55], v29 offset:8192
    s_waitcnt lgkmcnt(5)
    v_mfma_f32_32x32x16_bf16 v[80:95], a[32:35], v[32:35], v[80:95]
    ds_read_b128 v[56:59], v30 offset:8192
    s_add_u32 m0, s21, 17408
    s_xor_b32 s20, s23, 512
    buffer_load_dwordx4 v7, s[8:11], s20 offen lds
    s_waitcnt lgkmcnt(5)
    v_mfma_f32_32x32x16_bf16 v[80:95], a[36:39], v[36:39], v[80:95]
    ds_read_b128 v[60:63], v31 offset:8192
    s_waitcnt lgkmcnt(5)
    v_mfma_f32_32x32x16_bf16 v[80:95], a[40:43], v[40:43], v[80:95]
    ds_read_b128 v[32:35], v24 offset:16384
    s_waitcnt lgkmcnt(5)
    v_mfma_f32_32x32x16_bf16 v[80:95], a[44:47], v[44:47], v[80:95]
    ds_read_b128 v[36:39], v25 offset:16384
    s_add_u32 m0, s21, 24576
    s_xor_b32 s20, s23, 768
    buffer_load_dwordx4 v6, s[8:11], s20 offen lds
    s_waitcnt lgkmcnt(5)
    v_mfma_f32_32x32x16_bf16 v[80:95], a[48:51], v[48:51], v[80:95]
    ds_read_b128 v[40:43], v26 offset:16384
    s_waitcnt lgkmcnt(5)
    v_mfma_f32_32x32x16_bf16 v[80:95], a[52:55], v[52:55], v[80:95]
    ds_read_b128 v[44:47], v27 offset:16384
    s_waitcnt lgkmcnt(5)
    v_mfma_f32_32x32x16_bf16 v[80:95], a[56:59], v[56:59], v[80:95]
    ds_read_b128 v[48:51], v28 offset:16384
    s_add_u32 m0, s21, 25600
    s_xor_b32 s20, s23, 768
    buffer_load_dwordx4 v7, s[8:11], s20 offen lds
    s_waitcnt lgkmcnt(5)
    v_mfma_f32_32x32x16_bf16 v[80:95], a[60:63], v[60:63], v[80:95]
    ds_read_b128 v[52:55], v29 offset:16384
    s_waitcnt lgkmcnt(5)
    v_mfma_f32_32x32x16_bf16 v[80:95], a[64:67], v[32:35], v[80:95]
    ds_read_b128 v[56:59], v30 offset:16384
    v_cvt_pk_bf16_f32 v96, v64, v65
    v_cvt_pk_bf16_f32 v97, v66, v67
    v_cvt_pk_bf16_f32 v98, v68, v69
    v_cvt_pk_bf16_f32 v99, v70, v71
    buffer_store_dwordx4 v[96:99], v8, s[84:87], s24 offen offset:0 sc1
    s_waitcnt lgkmcnt(5)
    v_mfma_f32_32x32x16_bf16 v[80:95], a[68:71], v[36:39], v[80:95]
    ds_read_b128 v[60:63], v31 offset:16384
    s_waitcnt lgkmcnt(5)
    v_mfma_f32_32x32x16_bf16 v[80:95], a[72:75], v[40:43], v[80:95]
    ds_read_b128 v[32:35], v24 offset:24576
    v_cvt_pk_bf16_f32 v100, v72, v73
    v_cvt_pk_bf16_f32 v101, v74, v75
    v_cvt_pk_bf16_f32 v102, v76, v77
    v_cvt_pk_bf16_f32 v103, v78, v79
    buffer_store_dwordx4 v[100:103], v8, s[84:87], s24 offen offset:512 sc1
    s_add_u32 s24, s24, 524288
    s_waitcnt lgkmcnt(5)
    v_mfma_f32_32x32x16_bf16 v[80:95], a[76:79], v[44:47], v[80:95]
    ds_read_b128 v[36:39], v25 offset:24576
    s_waitcnt lgkmcnt(5)
    v_mfma_f32_32x32x16_bf16 v[80:95], a[80:83], v[48:51], v[80:95]
    ds_read_b128 v[40:43], v26 offset:24576
    s_waitcnt lgkmcnt(5)
    v_mfma_f32_32x32x16_bf16 v[80:95], a[84:87], v[52:55], v[80:95]
    ds_read_b128 v[44:47], v27 offset:24576
    s_waitcnt lgkmcnt(5)
    v_mfma_f32_32x32x16_bf16 v[80:95], a[88:91], v[56:59], v[80:95]
    ds_read_b128 v[48:51], v28 offset:24576
    s_waitcnt lgkmcnt(5)
    v_mfma_f32_32x32x16_bf16 v[80:95], a[92:95], v[60:63], v[80:95]
    ds_read_b128 v[52:55], v29 offset:24576
    s_waitcnt vmcnt(8)
    s_barrier
    s_waitcnt lgkmcnt(5)
    v_mfma_f32_32x32x16_bf16 v[80:95], a[96:99], v[32:35], v[80:95]
    ds_read_b128 v[56:59], v30 offset:24576
    s_waitcnt lgkmcnt(5)
    v_mfma_f32_32x32x16_bf16 v[80:95], a[100:103], v[36:39], v[80:95]
    ds_read_b128 v[60:63], v31 offset:24576
    s_add_u32 m0, s21, 32768
    s_xor_b32 s20, s23, 1024
    buffer_load_dwordx4 v6, s[8:11], s20 offen lds
    s_waitcnt lgkmcnt(5)
    v_mfma_f32_32x32x16_bf16 v[80:95], a[104:107], v[40:43], v[80:95]
    ds_read_b128 v[32:35], v24 offset:32768
    s_waitcnt lgkmcnt(5)
    v_mfma_f32_32x32x16_bf16 v[80:95], a[108:111], v[44:47], v[80:95]
    ds_read_b128 v[36:39], v25 offset:32768
    s_waitcnt lgkmcnt(5)
    v_mfma_f32_32x32x16_bf16 v[80:95], a[112:115], v[48:51], v[80:95]
    ds_read_b128 v[40:43], v26 offset:32768
    s_add_u32 m0, s21, 33792
    s_xor_b32 s20, s23, 1024
    buffer_load_dwordx4 v7, s[8:11], s20 offen lds
    s_waitcnt lgkmcnt(5)
    v_mfma_f32_32x32x16_bf16 v[80:95], a[116:119], v[52:55], v[80:95]
    ds_read_b128 v[44:47], v27 offset:32768
    s_waitcnt lgkmcnt(5)
    v_mfma_f32_32x32x16_bf16 v[80:95], a[120:123], v[56:59], v[80:95]
    ds_read_b128 v[48:51], v28 offset:32768
    s_waitcnt lgkmcnt(5)
    v_mfma_f32_32x32x16_bf16 v[80:95], a[124:127], v[60:63], v[80:95]
    ds_read_b128 v[52:55], v29 offset:32768
    s_add_u32 m0, s21, 40960
    s_xor_b32 s20, s23, 1280
    buffer_load_dwordx4 v6, s[8:11], s20 offen lds
    s_waitcnt lgkmcnt(5)
    v_mfma_f32_32x32x16_bf16 v[80:95], a[128:131], v[32:35], v[80:95]
    ds_read_b128 v[56:59], v30 offset:32768
    s_waitcnt lgkmcnt(5)
    v_mfma_f32_32x32x16_bf16 v[80:95], a[132:135], v[36:39], v[80:95]
    ds_read_b128 v[60:63], v31 offset:32768
    s_waitcnt lgkmcnt(5)
    v_mfma_f32_32x32x16_bf16 v[80:95], a[136:139], v[40:43], v[80:95]
    ds_read_b128 v[32:35], v24 offset:40960
    s_add_u32 m0, s21, 41984
    s_xor_b32 s20, s23, 1280
    buffer_load_dwordx4 v7, s[8:11], s20 offen lds
    s_waitcnt lgkmcnt(5)
    v_mfma_f32_32x32x16_bf16 v[80:95], a[140:143], v[44:47], v[80:95]
    ds_read_b128 v[36:39], v25 offset:40960
    s_waitcnt lgkmcnt(5)
    v_mfma_f32_32x32x16_bf16 v[80:95], a[144:147], v[48:51], v[80:95]
    ds_read_b128 v[40:43], v26 offset:40960
    s_waitcnt lgkmcnt(5)
    v_mfma_f32_32x32x16_bf16 v[80:95], a[148:151], v[52:55], v[80:95]
    ds_read_b128 v[44:47], v27 offset:40960
    s_add_u32 m0, s21, 49152
    s_xor_b32 s20, s23, 1536
    buffer_load_dwordx4 v6, s[8:11], s20 offen lds
    s_waitcnt lgkmcnt(5)
    v_mfma_f32_32x32x16_bf16 v[80:95], a[152:155], v[56:59], v[80:95]
    ds_read_b128 v[48:51], v28 offset:40960
    s_waitcnt lgkmcnt(5)
    v_mfma_f32_32x32x16_bf16 v[80:95], a[156:159], v[60:63], v[80:95]
    ds_read_b128 v[52:55], v29 offset:40960
    s_waitcnt lgkmcnt(5)
    v_mfma_f32_32x32x16_bf16 v[80:95], a[160:163], v[32:35], v[80:95]
    ds_read_b128 v[56:59], v30 offset:40960
    s_add_u32 m0, s21, 50176
    s_xor_b32 s20, s23, 1536
    buffer_load_dwordx4 v7, s[8:11], s20 offen lds
    s_waitcnt lgkmcnt(5)
    v_mfma_f32_32x32x16_bf16 v[80:95], a[164:167], v[36:39], v[80:95]
    ds_read_b128 v[60:63], v31 offset:40960
    s_waitcnt lgkmcnt(5)
    v_mfma_f32_32x32x16_bf16 v[80:95], a[168:171], v[40:43], v[80:95]
    ds_read_b128 v[32:35], v24 offset:49152
    s_waitcnt lgkmcnt(5)
    v_mfma_f32_32x32x16_bf16 v[80:95], a[172:175], v[44:47], v[80:95]
    ds_read_b128 v[36:39], v25 offset:49152
    s_add_u32 m0, s21, 57344
    s_xor_b32 s20, s23, 1792
    buffer_load_dwordx4 v6, s[8:11], s20 offen lds
    s_waitcnt lgkmcnt(5)
    v_mfma_f32_32x32x16_bf16 v[80:95], a[176:179], v[48:51], v[80:95]
    ds_read_b128 v[40:43], v26 offset:49152
    s_waitcnt lgkmcnt(5)
    v_mfma_f32_32x32x16_bf16 v[80:95], a[180:183], v[52:55], v[80:95]
    ds_read_b128 v[44:47], v27 offset:49152
    s_waitcnt lgkmcnt(5)
    v_mfma_f32_32x32x16_bf16 v[80:95], a[184:187], v[56:59], v[80:95]
    ds_read_b128 v[48:51], v28 offset:49152
    s_add_u32 m0, s21, 58368
    s_xor_b32 s20, s23, 1792
    buffer_load_dwordx4 v7, s[8:11], s20 offen lds
    s_waitcnt lgkmcnt(5)
    v_mfma_f32_32x32x16_bf16 v[80:95], a[188:191], v[60:63], v[80:95]
    ds_read_b128 v[52:55], v29 offset:49152
    s_waitcnt lgkmcnt(5)
    v_mfma_f32_32x32x16_bf16 v[80:95], a[192:195], v[32:35], v[80:95]
    ds_read_b128 v[56:59], v30 offset:49152
    s_waitcnt lgkmcnt(5)
    v_mfma_f32_32x32x16_bf16 v[80:95], a[196:199], v[36:39], v[80:95]
    ds_read_b128 v[60:63], v31 offset:49152
    s_waitcnt lgkmcnt(5)
    v_mfma_f32_32x32x16_bf16 v[80:95], a[200:203], v[40:43], v[80:95]
    ds_read_b128 v[32:35], v24 offset:57344
    s_waitcnt lgkmcnt(5)
    v_mfma_f32_32x32x16_bf16 v[80:95], a[204:207], v[44:47], v[80:95]
    ds_read_b128 v[36:39], v25 offset:57344
    s_waitcnt lgkmcnt(5)
    v_mfma_f32_32x32x16_bf16 v[80:95], a[208:211], v[48:51], v[80:95]
    ds_read_b128 v[40:43], v26 offset:57344
    s_waitcnt lgkmcnt(5)
    v_mfma_f32_32x32x16_bf16 v[80:95], a[212:215], v[52:55], v[80:95]
    ds_read_b128 v[44:47], v27 offset:57344
    s_waitcnt lgkmcnt(5)
    v_mfma_f32_32x32x16_bf16 v[80:95], a[216:219], v[56:59], v[80:95]
    ds_read_b128 v[48:51], v28 offset:57344
    s_waitcnt lgkmcnt(5)
    v_mfma_f32_32x32x16_bf16 v[80:95], a[220:223], v[60:63], v[80:95]
    ds_read_b128 v[52:55], v29 offset:57344
    s_waitcnt vmcnt(8)
    s_barrier
    s_waitcnt lgkmcnt(5)
    v_mfma_f32_32x32x16_bf16 v[80:95], a[224:227], v[32:35], v[80:95]
    ds_read_b128 v[56:59], v30 offset:57344
    s_waitcnt lgkmcnt(5)
    v_mfma_f32_32x32x16_bf16 v[80:95], a[228:231], v[36:39], v[80:95]
    ds_read_b128 v[60:63], v31 offset:57344
    s_add_u32 s23, s23, 131072
    s_add_u32 m0, s21, 65536
    s_xor_b32 s20, s23, 0
    buffer_load_dwordx4 v6, s[8:11], s20 offen lds
    s_waitcnt lgkmcnt(5)
    v_mfma_f32_32x32x16_bf16 v[80:95], a[232:235], v[40:43], v[80:95]
    ds_read_b128 v[32:35], v16 offset:0
    v_add_u32 v10, 1, v10
    buffer_store_dword v10, v9, s[84:87], 0 offen sc1
    s_waitcnt lgkmcnt(5)
    v_mfma_f32_32x32x16_bf16 v[80:95], a[236:239], v[44:47], v[80:95]
    ds_read_b128 v[36:39], v17 offset:0
    s_waitcnt lgkmcnt(5)
    v_mfma_f32_32x32x16_bf16 v[80:95], a[240:243], v[48:51], v[80:95]
    ds_read_b128 v[40:43], v18 offset:0
    s_add_u32 m0, s21, 66560
    s_xor_b32 s20, s23, 0
    buffer_load_dwordx4 v7, s[8:11], s20 offen lds
    s_waitcnt lgkmcnt(5)
    v_mfma_f32_32x32x16_bf16 v[80:95], a[244:247], v[52:55], v[80:95]
    ds_read_b128 v[44:47], v19 offset:0
    s_waitcnt lgkmcnt(5)
    v_mfma_f32_32x32x16_bf16 v[80:95], a[248:251], v[56:59], v[80:95]
    ds_read_b128 v[48:51], v20 offset:0
    s_waitcnt lgkmcnt(5)
    v_mfma_f32_32x32x16_bf16 v[80:95], a[252:255], v[60:63], v[80:95]
    ds_read_b128 v[52:55], v21 offset:0
    s_add_u32 m0, s21, 73728
    s_xor_b32 s20, s23, 256
    buffer_load_dwordx4 v6, s[8:11], s20 offen lds
    s_add_u32 s25, s25, 1
    s_cmp_lt_u32 s25, 16
    s_cbranch_scc1 mega_kernel_q_qk_loop
    s_nop 11
    v_cvt_pk_bf16_f32 v96, v80, v81
    v_cvt_pk_bf16_f32 v97, v82, v83
    v_cvt_pk_bf16_f32 v98, v84, v85
    v_cvt_pk_bf16_f32 v99, v86, v87
    buffer_store_dwordx4 v[96:99], v8, s[84:87], s24 offen offset:0 sc1
    v_cvt_pk_bf16_f32 v100, v88, v89
    v_cvt_pk_bf16_f32 v101, v90, v91
    v_cvt_pk_bf16_f32 v102, v92, v93
    v_cvt_pk_bf16_f32 v103, v94, v95
    buffer_store_dwordx4 v[100:103], v8, s[84:87], s24 offen offset:512 sc1
    s_add_u32 s24, s24, 524288
    s_waitcnt vmcnt(0) lgkmcnt(0)
    s_barrier
    v_add_u32 v10, 1, v10
    buffer_store_dword v10, v9, s[84:87], 0 offen sc1
    s_branch mega_kernel_q_done
mega_kernel_q_v:
    ds_read_b128 v[32:35], v16 offset:0
    ds_read_b128 v[36:39], v17 offset:0
    ds_read_b128 v[40:43], v18 offset:0
    ds_read_b128 v[44:47], v19 offset:0
    ds_read_b128 v[48:51], v20 offset:0
    ds_read_b128 v[52:55], v21 offset:0
    s_mov_b32 s25, 0
mega_kernel_q_v_loop:
    s_waitcnt lgkmcnt(5)
    v_mfma_f32_32x32x16_bf16 v[64:79], v[32:35], a[0:3], 0
    ds_read_b128 v[56:59], v22 offset:0
    s_waitcnt lgkmcnt(5)
    v_mfma_f32_32x32x16_bf16 v[64:79], v[36:39], a[4:7], v[64:79]
    ds_read_b128 v[60:63], v23 offset:0
    s_waitcnt lgkmcnt(5)
    v_mfma_f32_32x32x16_bf16 v[64:79], v[40:43], a[8:11], v[64:79]
    ds_read_b128 v[32:35], v16 offset:8192
    s_cmp_eq_u32 s25, 0
    s_cbranch_scc1 mega_kernel_q_v_sk2
    s_add_u32 m0, s21, 74752
    s_xor_b32 s20, s23, 256
    buffer_load_dwordx4 v7, s[8:11], s20 offen lds
mega_kernel_q_v_sk2:
    s_waitcnt lgkmcnt(5)
    v_mfma_f32_32x32x16_bf16 v[64:79], v[44:47], a[12:15], v[64:79]
    ds_read_b128 v[36:39], v17 offset:8192
    s_waitcnt lgkmcnt(5)
    v_mfma_f32_32x32x16_bf16 v[64:79], v[48:51], a[16:19], v[64:79]
    ds_read_b128 v[40:43], v18 offset:8192
    s_waitcnt lgkmcnt(5)
    v_mfma_f32_32x32x16_bf16 v[64:79], v[52:55], a[20:23], v[64:79]
    ds_read_b128 v[44:47], v19 offset:8192
    s_cmp_eq_u32 s25, 0
    s_cbranch_scc1 mega_kernel_q_v_sk5
    s_add_u32 m0, s21, 81920
    s_xor_b32 s20, s23, 512
    buffer_load_dwordx4 v6, s[8:11], s20 offen lds
mega_kernel_q_v_sk5:
    s_waitcnt lgkmcnt(5)
    v_mfma_f32_32x32x16_bf16 v[64:79], v[56:59], a[24:27], v[64:79]
    ds_read_b128 v[48:51], v20 offset:8192
    s_waitcnt lgkmcnt(5)
    v_mfma_f32_32x32x16_bf16 v[64:79], v[60:63], a[28:31], v[64:79]
    ds_read_b128 v[52:55], v21 offset:8192
    s_waitcnt lgkmcnt(5)
    v_mfma_f32_32x32x16_bf16 v[64:79], v[32:35], a[32:35], v[64:79]
    ds_read_b128 v[56:59], v22 offset:8192
    s_cmp_eq_u32 s25, 0
    s_cbranch_scc1 mega_kernel_q_v_sk8
    s_add_u32 m0, s21, 82944
    s_xor_b32 s20, s23, 512
    buffer_load_dwordx4 v7, s[8:11], s20 offen lds
mega_kernel_q_v_sk8:
    s_waitcnt lgkmcnt(5)
    v_mfma_f32_32x32x16_bf16 v[64:79], v[36:39], a[36:39], v[64:79]
    ds_read_b128 v[60:63], v23 offset:8192
    s_waitcnt lgkmcnt(5)
    v_mfma_f32_32x32x16_bf16 v[64:79], v[40:43], a[40:43], v[64:79]
    ds_read_b128 v[32:35], v16 offset:16384
    s_waitcnt lgkmcnt(5)
    v_mfma_f32_32x32x16_bf16 v[64:79], v[44:47], a[44:47], v[64:79]
    ds_read_b128 v[36:39], v17 offset:16384
    s_cmp_eq_u32 s25, 0
    s_cbranch_scc1 mega_kernel_q_v_sk11
    s_add_u32 m0, s21, 90112
    s_xor_b32 s20, s23, 768
    buffer_load_dwordx4 v6, s[8:11], s20 offen lds
mega_kernel_q_v_sk11:
    s_waitcnt lgkmcnt(5)
    v_mfma_f32_32x32x16_bf16 v[64:79], v[48:51], a[48:51], v[64:79]
    ds_read_b128 v[40:43], v18 offset:16384
    s_waitcnt lgkmcnt(5)
    v_mfma_f32_32x32x16_bf16 v[64:79], v[52:55], a[52:55], v[64:79]
    ds_read_b128 v[44:47], v19 offset:16384
    s_waitcnt lgkmcnt(5)
    v_mfma_f32_32x32x16_bf16 v[64:79], v[56:59], a[56:59], v[64:79]
    ds_read_b128 v[48:51], v20 offset:16384
    s_cmp_eq_u32 s25, 0
    s_cbranch_scc1 mega_kernel_q_v_sk14
    s_add_u32 m0, s21, 91136
    s_xor_b32 s20, s23, 768
    buffer_load_dwordx4 v7, s[8:11], s20 offen lds
mega_kernel_q_v_sk14:
    s_waitcnt lgkmcnt(5)
    v_mfma_f32_32x32x16_bf16 v[64:79], v[60:63], a[60:63], v[64:79]
    ds_read_b128 v[52:55], v21 offset:16384
    s_waitcnt lgkmcnt(5)
    v_mfma_f32_32x32x16_bf16 v[64:79], v[32:35], a[64:67], v[64:79]
    ds_read_b128 v[56:59], v22 offset:16384
    s_cmp_eq_u32 s25, 0
    s_cbranch_scc1 mega_kernel_q_v_ne0
    v_cvt_pk_bf16_f32 v96, v80, v81
    v_cvt_pk_bf16_f32 v97, v82, v83
    v_cvt_pk_bf16_f32 v98, v88, v89
    v_cvt_pk_bf16_f32 v99, v90, v91
    buffer_store_dwordx4 v[96:99], v8, s[84:87], s24 offen offset:0 sc1
mega_kernel_q_v_ne0:
    s_waitcnt lgkmcnt(5)
    v_mfma_f32_32x32x16_bf16 v[64:79], v[36:39], a[68:71], v[64:79]
    ds_read_b128 v[60:63], v23 offset:16384
    s_waitcnt lgkmcnt(5)
    v_mfma_f32_32x32x16_bf16 v[64:79], v[40:43], a[72:75], v[64:79]
    ds_read_b128 v[32:35], v16 offset:24576
    s_cmp_eq_u32 s25, 0
    s_cbranch_scc1 mega_kernel_q_v_ne1
    v_cvt_pk_bf16_f32 v100, v84, v85
    v_cvt_pk_bf16_f32 v101, v86, v87
    v_cvt_pk_bf16_f32 v102, v92, v93
    v_cvt_pk_bf16_f32 v103, v94, v95
    buffer_store_dwordx4 v[100:103], v8, s[84:87], s24 offen offset:512 sc1
    s_add_u32 s24, s24, 524288
mega_kernel_q_v_ne1:
    s_waitcnt lgkmcnt(5)
    v_mfma_f32_32x32x16_bf16 v[64:79], v[44:47], a[76:79], v[64:79]
    ds_read_b128 v[36:39], v17 offset:24576
    s_waitcnt lgkmcnt(5)
    v_mfma_f32_32x32x16_bf16 v[64:79], v[48:51], a[80:83], v[64:79]
    ds_read_b128 v[40:43], v18 offset:24576
    s_waitcnt lgkmcnt(5)
    v_mfma_f32_32x32x16_bf16 v[64:79], v[52:55], a[84:87], v[64:79]
    ds_read_b128 v[44:47], v19 offset:24576
    s_waitcnt lgkmcnt(5)
    v_mfma_f32_32x32x16_bf16 v[64:79], v[56:59], a[88:91], v[64:79]
    ds_read_b128 v[48:51], v20 offset:24576
    s_waitcnt lgkmcnt(5)
    v_mfma_f32_32x32x16_bf16 v[64:79], v[60:63], a[92:95], v[64:79]
    ds_read_b128 v[52:55], v21 offset:24576
    s_waitcnt vmcnt(8)
    s_barrier
    s_waitcnt lgkmcnt(5)
    v_mfma_f32_32x32x16_bf16 v[64:79], v[32:35], a[96:99], v[64:79]
    ds_read_b128 v[56:59], v22 offset:24576
    s_waitcnt lgkmcnt(5)
    v_mfma_f32_32x32x16_bf16 v[64:79], v[36:39], a[100:103], v[64:79]
    ds_read_b128 v[60:63], v23 offset:24576
    s_add_u32 m0, s21, 98304
    s_xor_b32 s20, s23, 1024
    buffer_load_dwordx4 v6, s[8:11], s20 offen lds
    s_waitcnt lgkmcnt(5)
    v_mfma_f32_32x32x16_bf16 v[64:79], v[40:43], a[104:107], v[64:79]
    ds_read_b128 v[32:35], v16 offset:32768
    s_waitcnt lgkmcnt(5)
    v_mfma_f32_32x32x16_bf16 v[64:79], v[44:47], a[108:111], v[64:79]
    ds_read_b128 v[36:39], v17 offset:32768
    s_waitcnt lgkmcnt(5)
    v_mfma_f32_32x32x16_bf16 v[64:79], v[48:51], a[112:115], v[64:79]
    ds_read_b128 v[40:43], v18 offset:32768
    s_add_u32 m0, s21, 99328
    s_xor_b32 s20, s23, 1024
    buffer_load_dwordx4 v7, s[8:11], s20 offen lds
    s_waitcnt lgkmcnt(5)
    v_mfma_f32_32x32x16_bf16 v[64:79], v[52:55], a[116:119], v[64:79]
    ds_read_b128 v[44:47], v19 offset:32768
    s_waitcnt lgkmcnt(5)
    v_mfma_f32_32x32x16_bf16 v[64:79], v[56:59], a[120:123], v[64:79]
    ds_read_b128 v[48:51], v20 offset:32768
    s_waitcnt lgkmcnt(5)
    v_mfma_f32_32x32x16_bf16 v[64:79], v[60:63], a[124:127], v[64:79]
    ds_read_b128 v[52:55], v21 offset:32768
    s_add_u32 m0, s21, 106496
    s_xor_b32 s20, s23, 1280
    buffer_load_dwordx4 v6, s[8:11], s20 offen lds
    s_waitcnt lgkmcnt(5)
    v_mfma_f32_32x32x16_bf16 v[64:79], v[32:35], a[128:131], v[64:79]
    ds_read_b128 v[56:59], v22 offset:32768
    s_waitcnt lgkmcnt(5)
    v_mfma_f32_32x32x16_bf16 v[64:79], v[36:39], a[132:135], v[64:79]
    ds_read_b128 v[60:63], v23 offset:32768
    s_waitcnt lgkmcnt(5)
    v_mfma_f32_32x32x16_bf16 v[64:79], v[40:43], a[136:139], v[64:79]
    ds_read_b128 v[32:35], v16 offset:40960
    s_add_u32 m0, s21, 107520
    s_xor_b32 s20, s23, 1280
    buffer_load_dwordx4 v7, s[8:11], s20 offen lds
    s_waitcnt lgkmcnt(5)
    v_mfma_f32_32x32x16_bf16 v[64:79], v[44:47], a[140:143], v[64:79]
    ds_read_b128 v[36:39], v17 offset:40960
    s_waitcnt lgkmcnt(5)
    v_mfma_f32_32x32x16_bf16 v[64:79], v[48:51], a[144:147], v[64:79]
    ds_read_b128 v[40:43], v18 offset:40960
    s_waitcnt lgkmcnt(5)
    v_mfma_f32_32x32x16_bf16 v[64:79], v[52:55], a[148:151], v[64:79]
    ds_read_b128 v[44:47], v19 offset:40960
    s_add_u32 m0, s21, 114688
    s_xor_b32 s20, s23, 1536
    buffer_load_dwordx4 v6, s[8:11], s20 offen lds
    s_waitcnt lgkmcnt(5)
    v_mfma_f32_32x32x16_bf16 v[64:79], v[56:59], a[152:155], v[64:79]
    ds_read_b128 v[48:51], v20 offset:40960
    s_waitcnt lgkmcnt(5)
    v_mfma_f32_32x32x16_bf16 v[64:79], v[60:63], a[156:159], v[64:79]
    ds_read_b128 v[52:55], v21 offset:40960
    s_waitcnt lgkmcnt(5)
    v_mfma_f32_32x32x16_bf16 v[64:79], v[32:35], a[160:163], v[64:79]
    ds_read_b128 v[56:59], v22 offset:40960
    s_add_u32 m0, s21, 115712
    s_xor_b32 s20, s23, 1536
    buffer_load_dwordx4 v7, s[8:11], s20 offen lds
    s_waitcnt lgkmcnt(5)
    v_mfma_f32_32x32x16_bf16 v[64:79], v[36:39], a[164:167], v[64:79]
    ds_read_b128 v[60:63], v23 offset:40960
    s_waitcnt lgkmcnt(5)
    v_mfma_f32_32x32x16_bf16 v[64:79], v[40:43], a[168:171], v[64:79]
    ds_read_b128 v[32:35], v16 offset:49152
    s_waitcnt lgkmcnt(5)
    v_mfma_f32_32x32x16_bf16 v[64:79], v[44:47], a[172:175], v[64:79]
    ds_read_b128 v[36:39], v17 offset:49152
    s_add_u32 m0, s21, 122880
    s_xor_b32 s20, s23, 1792
    buffer_load_dwordx4 v6, s[8:11], s20 offen lds
    s_waitcnt lgkmcnt(5)
    v_mfma_f32_32x32x16_bf16 v[64:79], v[48:51], a[176:179], v[64:79]
    ds_read_b128 v[40:43], v18 offset:49152
    s_waitcnt lgkmcnt(5)
    v_mfma_f32_32x32x16_bf16 v[64:79], v[52:55], a[180:183], v[64:79]
    ds_read_b128 v[44:47], v19 offset:49152
    s_waitcnt lgkmcnt(5)
    v_mfma_f32_32x32x16_bf16 v[64:79], v[56:59], a[184:187], v[64:79]
    ds_read_b128 v[48:51], v20 offset:49152
    s_add_u32 m0, s21, 123904
    s_xor_b32 s20, s23, 1792
    buffer_load_dwordx4 v7, s[8:11], s20 offen lds
    s_waitcnt lgkmcnt(5)
    v_mfma_f32_32x32x16_bf16 v[64:79], v[60:63], a[188:191], v[64:79]
    ds_read_b128 v[52:55], v21 offset:49152
    s_waitcnt lgkmcnt(5)
    v_mfma_f32_32x32x16_bf16 v[64:79], v[32:35], a[192:195], v[64:79]
    ds_read_b128 v[56:59], v22 offset:49152
    s_waitcnt lgkmcnt(5)
    v_mfma_f32_32x32x16_bf16 v[64:79], v[36:39], a[196:199], v[64:79]
    ds_read_b128 v[60:63], v23 offset:49152
    s_waitcnt lgkmcnt(5)
    v_mfma_f32_32x32x16_bf16 v[64:79], v[40:43], a[200:203], v[64:79]
    ds_read_b128 v[32:35], v16 offset:57344
    s_waitcnt lgkmcnt(5)
    v_mfma_f32_32x32x16_bf16 v[64:79], v[44:47], a[204:207], v[64:79]
    ds_read_b128 v[36:39], v17 offset:57344
    s_waitcnt lgkmcnt(5)
    v_mfma_f32_32x32x16_bf16 v[64:79], v[48:51], a[208:211], v[64:79]
    ds_read_b128 v[40:43], v18 offset:57344
    s_waitcnt lgkmcnt(5)
    v_mfma_f32_32x32x16_bf16 v[64:79], v[52:55], a[212:215], v[64:79]
    ds_read_b128 v[44:47], v19 offset:57344
    s_waitcnt lgkmcnt(5)
    v_mfma_f32_32x32x16_bf16 v[64:79], v[56:59], a[216:219], v[64:79]
    ds_read_b128 v[48:51], v20 offset:57344
    s_waitcnt lgkmcnt(5)
    v_mfma_f32_32x32x16_bf16 v[64:79], v[60:63], a[220:223], v[64:79]
    ds_read_b128 v[52:55], v21 offset:57344
    s_waitcnt vmcnt(8)
    s_barrier
    s_waitcnt lgkmcnt(5)
    v_mfma_f32_32x32x16_bf16 v[64:79], v[32:35], a[224:227], v[64:79]
    ds_read_b128 v[56:59], v22 offset:57344
    s_waitcnt lgkmcnt(5)
    v_mfma_f32_32x32x16_bf16 v[64:79], v[36:39], a[228:231], v[64:79]
    ds_read_b128 v[60:63], v23 offset:57344
    s_add_u32 s23, s23, 131072
    s_add_u32 m0, s21, 0
    s_xor_b32 s20, s23, 0
    buffer_load_dwordx4 v6, s[8:11], s20 offen lds
    s_waitcnt lgkmcnt(5)
    v_mfma_f32_32x32x16_bf16 v[64:79], v[40:43], a[232:235], v[64:79]
    ds_read_b128 v[32:35], v24 offset:0
    s_cmp_eq_u32 s25, 0
    s_cbranch_scc1 mega_kernel_q_v_nf
    v_add_u32 v10, 1, v10
    buffer_store_dword v10, v9, s[84:87], 0 offen sc1
mega_kernel_q_v_nf:
    s_waitcnt lgkmcnt(5)
    v_mfma_f32_32x32x16_bf16 v[64:79], v[44:47], a[236:239], v[64:79]
    ds_read_b128 v[36:39], v25 offset:0
    s_waitcnt lgkmcnt(5)
    v_mfma_f32_32x32x16_bf16 v[64:79], v[48:51], a[240:243], v[64:79]
    ds_read_b128 v[40:43], v26 offset:0
    s_add_u32 m0, s21, 1024
    s_xor_b32 s20, s23, 0
    buffer_load_dwordx4 v7, s[8:11], s20 offen lds
    s_waitcnt lgkmcnt(5)
    v_mfma_f32_32x32x16_bf16 v[64:79], v[52:55], a[244:247], v[64:79]
    ds_read_b128 v[44:47], v27 offset:0
    s_waitcnt lgkmcnt(5)
    v_mfma_f32_32x32x16_bf16 v[64:79], v[56:59], a[248:251], v[64:79]
    ds_read_b128 v[48:51], v28 offset:0
    s_waitcnt lgkmcnt(5)
    v_mfma_f32_32x32x16_bf16 v[64:79], v[60:63], a[252:255], v[64:79]
    ds_read_b128 v[52:55], v29 offset:0
    s_add_u32 m0, s21, 8192
    s_xor_b32 s20, s23, 256
    buffer_load_dwordx4 v6, s[8:11], s20 offen lds
    s_waitcnt lgkmcnt(5)
    v_mfma_f32_32x32x16_bf16 v[80:95], v[32:35], a[0:3], 0
    ds_read_b128 v[56:59], v30 offset:0
    s_waitcnt lgkmcnt(5)
    v_mfma_f32_32x32x16_bf16 v[80:95], v[36:39], a[4:7], v[80:95]
    ds_read_b128 v[60:63], v31 offset:0
    s_waitcnt lgkmcnt(5)
    v_mfma_f32_32x32x16_bf16 v[80:95], v[40:43], a[8:11], v[80:95]
    ds_read_b128 v[32:35], v24 offset:8192
    s_add_u32 m0, s21, 9216
    s_xor_b32 s20, s23, 256
    buffer_load_dwordx4 v7, s[8:11], s20 offen lds
    s_waitcnt lgkmcnt(5)
    v_mfma_f32_32x32x16_bf16 v[80:95], v[44:47], a[12:15], v[80:95]
    ds_read_b128 v[36:39], v25 offset:8192
    s_waitcnt lgkmcnt(5)
    v_mfma_f32_32x32x16_bf16 v[80:95], v[48:51], a[16:19], v[80:95]
    ds_read_b128 v[40:43], v26 offset:8192
    s_waitcnt lgkmcnt(5)
    v_mfma_f32_32x32x16_bf16 v[80:95], v[52:55], a[20:23], v[80:95]
    ds_read_b128 v[44:47], v27 offset:8192
    s_add_u32 m0, s21, 16384
    s_xor_b32 s20, s23, 512
    buffer_load_dwordx4 v6, s[8:11], s20 offen lds
    s_waitcnt lgkmcnt(5)
    v_mfma_f32_32x32x16_bf16 v[80:95], v[56:59], a[24:27], v[80:95]
    ds_read_b128 v[48:51], v28 offset:8192
    s_waitcnt lgkmcnt(5)
    v_mfma_f32_32x32x16_bf16 v[80:95], v[60:63], a[28:31], v[80:95]
    ds_read_b128 v[52:55], v29 offset:8192
    s_waitcnt lgkmcnt(5)
    v_mfma_f32_32x32x16_bf16 v[80:95], v[32:35], a[32:35], v[80:95]
    ds_read_b128 v[56:59], v30 offset:8192
    s_add_u32 m0, s21, 17408
    s_xor_b32 s20, s23, 512
    buffer_load_dwordx4 v7, s[8:11], s20 offen lds
    s_waitcnt lgkmcnt(5)
    v_mfma_f32_32x32x16_bf16 v[80:95], v[36:39], a[36:39], v[80:95]
    ds_read_b128 v[60:63], v31 offset:8192
    s_waitcnt lgkmcnt(5)
    v_mfma_f32_32x32x16_bf16 v[80:95], v[40:43], a[40:43], v[80:95]
    ds_read_b128 v[32:35], v24 offset:16384
    s_waitcnt lgkmcnt(5)
    v_mfma_f32_32x32x16_bf16 v[80:95], v[44:47], a[44:47], v[80:95]
    ds_read_b128 v[36:39], v25 offset:16384
    s_add_u32 m0, s21, 24576
    s_xor_b32 s20, s23, 768
    buffer_load_dwordx4 v6, s[8:11], s20 offen lds
    s_waitcnt lgkmcnt(5)
    v_mfma_f32_32x32x16_bf16 v[80:95], v[48:51], a[48:51], v[80:95]
    ds_read_b128 v[40:43], v26 offset:16384
    s_waitcnt lgkmcnt(5)
    v_mfma_f32_32x32x16_bf16 v[80:95], v[52:55], a[52:55], v[80:95]
    ds_read_b128 v[44:47], v27 offset:16384
    s_waitcnt lgkmcnt(5)
    v_mfma_f32_32x32x16_bf16 v[80:95], v[56:59], a[56:59], v[80:95]
    ds_read_b128 v[48:51], v28 offset:16384
    s_add_u32 m0, s21, 25600
    s_xor_b32 s20, s23, 768
    buffer_load_dwordx4 v7, s[8:11], s20 offen lds
    s_waitcnt lgkmcnt(5)
    v_mfma_f32_32x32x16_bf16 v[80:95], v[60:63], a[60:63], v[80:95]
    ds_read_b128 v[52:55], v29 offset:16384
    s_waitcnt lgkmcnt(5)
    v_mfma_f32_32x32x16_bf16 v[80:95], v[32:35], a[64:67], v[80:95]
    ds_read_b128 v[56:59], v30 offset:16384
    v_cvt_pk_bf16_f32 v96, v64, v65
    v_cvt_pk_bf16_f32 v97, v66, v67
    v_cvt_pk_bf16_f32 v98, v72, v73
    v_cvt_pk_bf16_f32 v99, v74, v75
    buffer_store_dwordx4 v[96:99], v8, s[84:87], s24 offen offset:0 sc1
    s_waitcnt lgkmcnt(5)
    v_mfma_f32_32x32x16_bf16 v[80:95], v[36:39], a[68:71], v[80:95]
    ds_read_b128 v[60:63], v31 offset:16384
    s_waitcnt lgkmcnt(5)
    v_mfma_f32_32x32x16_bf16 v[80:95], v[40:43], a[72:75], v[80:95]
    ds_read_b128 v[32:35], v24 offset:24576
    v_cvt_pk_bf16_f32 v100, v68, v69
    v_cvt_pk_bf16_f32 v101, v70, v71
    v_cvt_pk_bf16_f32 v102, v76, v77
    v_cvt_pk_bf16_f32 v103, v78, v79
    buffer_store_dwordx4 v[100:103], v8, s[84:87], s24 offen offset:512 sc1
    s_add_u32 s24, s24, 524288
    s_waitcnt lgkmcnt(5)
    v_mfma_f32_32x32x16_bf16 v[80:95], v[44:47], a[76:79], v[80:95]
    ds_read_b128 v[36:39], v25 offset:24576
    s_waitcnt lgkmcnt(5)
    v_mfma_f32_32x32x16_bf16 v[80:95], v[48:51], a[80:83], v[80:95]
    ds_read_b128 v[40:43], v26 offset:24576
    s_waitcnt lgkmcnt(5)
    v_mfma_f32_32x32x16_bf16 v[80:95], v[52:55], a[84:87], v[80:95]
    ds_read_b128 v[44:47], v27 offset:24576
    s_waitcnt lgkmcnt(5)
    v_mfma_f32_32x32x16_bf16 v[80:95], v[56:59], a[88:91], v[80:95]
    ds_read_b128 v[48:51], v28 offset:24576
    s_waitcnt lgkmcnt(5)
    v_mfma_f32_32x32x16_bf16 v[80:95], v[60:63], a[92:95], v[80:95]
    ds_read_b128 v[52:55], v29 offset:24576
    s_waitcnt vmcnt(8)
    s_barrier
    s_waitcnt lgkmcnt(5)
    v_mfma_f32_32x32x16_bf16 v[80:95], v[32:35], a[96:99], v[80:95]
    ds_read_b128 v[56:59], v30 offset:24576
    s_waitcnt lgkmcnt(5)
    v_mfma_f32_32x32x16_bf16 v[80:95], v[36:39], a[100:103], v[80:95]
    ds_read_b128 v[60:63], v31 offset:24576
    s_add_u32 m0, s21, 32768
    s_xor_b32 s20, s23, 1024
    buffer_load_dwordx4 v6, s[8:11], s20 offen lds
    s_waitcnt lgkmcnt(5)
    v_mfma_f32_32x32x16_bf16 v[80:95], v[40:43], a[104:107], v[80:95]
    ds_read_b128 v[32:35], v24 offset:32768
    s_waitcnt lgkmcnt(5)
    v_mfma_f32_32x32x16_bf16 v[80:95], v[44:47], a[108:111], v[80:95]
    ds_read_b128 v[36:39], v25 offset:32768
    s_waitcnt lgkmcnt(5)
    v_mfma_f32_32x32x16_bf16 v[80:95], v[48:51], a[112:115], v[80:95]
    ds_read_b128 v[40:43], v26 offset:32768
    s_add_u32 m0, s21, 33792
    s_xor_b32 s20, s23, 1024
    buffer_load_dwordx4 v7, s[8:11], s20 offen lds
    s_waitcnt lgkmcnt(5)
    v_mfma_f32_32x32x16_bf16 v[80:95], v[52:55], a[116:119], v[80:95]
    ds_read_b128 v[44:47], v27 offset:32768
    s_waitcnt lgkmcnt(5)
    v_mfma_f32_32x32x16_bf16 v[80:95], v[56:59], a[120:123], v[80:95]
    ds_read_b128 v[48:51], v28 offset:32768
    s_waitcnt lgkmcnt(5)
    v_mfma_f32_32x32x16_bf16 v[80:95], v[60:63], a[124:127], v[80:95]
    ds_read_b128 v[52:55], v29 offset:32768
    s_add_u32 m0, s21, 40960
    s_xor_b32 s20, s23, 1280
    buffer_load_dwordx4 v6, s[8:11], s20 offen lds
    s_waitcnt lgkmcnt(5)
    v_mfma_f32_32x32x16_bf16 v[80:95], v[32:35], a[128:131], v[80:95]
    ds_read_b128 v[56:59], v30 offset:32768
    s_waitcnt lgkmcnt(5)
    v_mfma_f32_32x32x16_bf16 v[80:95], v[36:39], a[132:135], v[80:95]
    ds_read_b128 v[60:63], v31 offset:32768
    s_waitcnt lgkmcnt(5)
    v_mfma_f32_32x32x16_bf16 v[80:95], v[40:43], a[136:139], v[80:95]
    ds_read_b128 v[32:35], v24 offset:40960
    s_add_u32 m0, s21, 41984
    s_xor_b32 s20, s23, 1280
    buffer_load_dwordx4 v7, s[8:11], s20 offen lds
    s_waitcnt lgkmcnt(5)
    v_mfma_f32_32x32x16_bf16 v[80:95], v[44:47], a[140:143], v[80:95]
    ds_read_b128 v[36:39], v25 offset:40960
    s_waitcnt lgkmcnt(5)
    v_mfma_f32_32x32x16_bf16 v[80:95], v[48:51], a[144:147], v[80:95]
    ds_read_b128 v[40:43], v26 offset:40960
    s_waitcnt lgkmcnt(5)
    v_mfma_f32_32x32x16_bf16 v[80:95], v[52:55], a[148:151], v[80:95]
    ds_read_b128 v[44:47], v27 offset:40960
    s_add_u32 m0, s21, 49152
    s_xor_b32 s20, s23, 1536
    buffer_load_dwordx4 v6, s[8:11], s20 offen lds
    s_waitcnt lgkmcnt(5)
    v_mfma_f32_32x32x16_bf16 v[80:95], v[56:59], a[152:155], v[80:95]
    ds_read_b128 v[48:51], v28 offset:40960
    s_waitcnt lgkmcnt(5)
    v_mfma_f32_32x32x16_bf16 v[80:95], v[60:63], a[156:159], v[80:95]
    ds_read_b128 v[52:55], v29 offset:40960
    s_waitcnt lgkmcnt(5)
    v_mfma_f32_32x32x16_bf16 v[80:95], v[32:35], a[160:163], v[80:95]
    ds_read_b128 v[56:59], v30 offset:40960
    s_add_u32 m0, s21, 50176
    s_xor_b32 s20, s23, 1536
    buffer_load_dwordx4 v7, s[8:11], s20 offen lds
    s_waitcnt lgkmcnt(5)
    v_mfma_f32_32x32x16_bf16 v[80:95], v[36:39], a[164:167], v[80:95]
    ds_read_b128 v[60:63], v31 offset:40960
    s_waitcnt lgkmcnt(5)
    v_mfma_f32_32x32x16_bf16 v[80:95], v[40:43], a[168:171], v[80:95]
    ds_read_b128 v[32:35], v24 offset:49152
    s_waitcnt lgkmcnt(5)
    v_mfma_f32_32x32x16_bf16 v[80:95], v[44:47], a[172:175], v[80:95]
    ds_read_b128 v[36:39], v25 offset:49152
    s_add_u32 m0, s21, 57344
    s_xor_b32 s20, s23, 1792
    buffer_load_dwordx4 v6, s[8:11], s20 offen lds
    s_waitcnt lgkmcnt(5)
    v_mfma_f32_32x32x16_bf16 v[80:95], v[48:51], a[176:179], v[80:95]
    ds_read_b128 v[40:43], v26 offset:49152
    s_waitcnt lgkmcnt(5)
    v_mfma_f32_32x32x16_bf16 v[80:95], v[52:55], a[180:183], v[80:95]
    ds_read_b128 v[44:47], v27 offset:49152
    s_waitcnt lgkmcnt(5)
    v_mfma_f32_32x32x16_bf16 v[80:95], v[56:59], a[184:187], v[80:95]
    ds_read_b128 v[48:51], v28 offset:49152
    s_add_u32 m0, s21, 58368
    s_xor_b32 s20, s23, 1792
    buffer_load_dwordx4 v7, s[8:11], s20 offen lds
    s_waitcnt lgkmcnt(5)
    v_mfma_f32_32x32x16_bf16 v[80:95], v[60:63], a[188:191], v[80:95]
    ds_read_b128 v[52:55], v29 offset:49152
    s_waitcnt lgkmcnt(5)
    v_mfma_f32_32x32x16_bf16 v[80:95], v[32:35], a[192:195], v[80:95]
    ds_read_b128 v[56:59], v30 offset:49152
    s_waitcnt lgkmcnt(5)
    v_mfma_f32_32x32x16_bf16 v[80:95], v[36:39], a[196:199], v[80:95]
    ds_read_b128 v[60:63], v31 offset:49152
    s_waitcnt lgkmcnt(5)
    v_mfma_f32_32x32x16_bf16 v[80:95], v[40:43], a[200:203], v[80:95]
    ds_read_b128 v[32:35], v24 offset:57344
    s_waitcnt lgkmcnt(5)
    v_mfma_f32_32x32x16_bf16 v[80:95], v[44:47], a[204:207], v[80:95]
    ds_read_b128 v[36:39], v25 offset:57344
    s_waitcnt lgkmcnt(5)
    v_mfma_f32_32x32x16_bf16 v[80:95], v[48:51], a[208:211], v[80:95]
    ds_read_b128 v[40:43], v26 offset:57344
    s_waitcnt lgkmcnt(5)
    v_mfma_f32_32x32x16_bf16 v[80:95], v[52:55], a[212:215], v[80:95]
    ds_read_b128 v[44:47], v27 offset:57344
    s_waitcnt lgkmcnt(5)
    v_mfma_f32_32x32x16_bf16 v[80:95], v[56:59], a[216:219], v[80:95]
    ds_read_b128 v[48:51], v28 offset:57344
    s_waitcnt lgkmcnt(5)
    v_mfma_f32_32x32x16_bf16 v[80:95], v[60:63], a[220:223], v[80:95]
    ds_read_b128 v[52:55], v29 offset:57344
    s_waitcnt vmcnt(8)
    s_barrier
    s_waitcnt lgkmcnt(5)
    v_mfma_f32_32x32x16_bf16 v[80:95], v[32:35], a[224:227], v[80:95]
    ds_read_b128 v[56:59], v30 offset:57344
    s_waitcnt lgkmcnt(5)
    v_mfma_f32_32x32x16_bf16 v[80:95], v[36:39], a[228:231], v[80:95]
    ds_read_b128 v[60:63], v31 offset:57344
    s_add_u32 s23, s23, 131072
    s_add_u32 m0, s21, 65536
    s_xor_b32 s20, s23, 0
    buffer_load_dwordx4 v6, s[8:11], s20 offen lds
    s_waitcnt lgkmcnt(5)
    v_mfma_f32_32x32x16_bf16 v[80:95], v[40:43], a[232:235], v[80:95]
    ds_read_b128 v[32:35], v16 offset:0
    v_add_u32 v10, 1, v10
    buffer_store_dword v10, v9, s[84:87], 0 offen sc1
    s_waitcnt lgkmcnt(5)
    v_mfma_f32_32x32x16_bf16 v[80:95], v[44:47], a[236:239], v[80:95]
    ds_read_b128 v[36:39], v17 offset:0
    s_waitcnt lgkmcnt(5)
    v_mfma_f32_32x32x16_bf16 v[80:95], v[48:51], a[240:243], v[80:95]
    ds_read_b128 v[40:43], v18 offset:0
    s_add_u32 m0, s21, 66560
    s_xor_b32 s20, s23, 0
    buffer_load_dwordx4 v7, s[8:11], s20 offen lds
    s_waitcnt lgkmcnt(5)
    v_mfma_f32_32x32x16_bf16 v[80:95], v[52:55], a[244:247], v[80:95]
    ds_read_b128 v[44:47], v19 offset:0
    s_waitcnt lgkmcnt(5)
    v_mfma_f32_32x32x16_bf16 v[80:95], v[56:59], a[248:251], v[80:95]
    ds_read_b128 v[48:51], v20 offset:0
    s_waitcnt lgkmcnt(5)
    v_mfma_f32_32x32x16_bf16 v[80:95], v[60:63], a[252:255], v[80:95]
    ds_read_b128 v[52:55], v21 offset:0
    s_add_u32 m0, s21, 73728
    s_xor_b32 s20, s23, 256
    buffer_load_dwordx4 v6, s[8:11], s20 offen lds
    s_add_u32 s25, s25, 1
    s_cmp_lt_u32 s25, 16
    s_cbranch_scc1 mega_kernel_q_v_loop
    s_nop 11
    v_cvt_pk_bf16_f32 v96, v80, v81
    v_cvt_pk_bf16_f32 v97, v82, v83
    v_cvt_pk_bf16_f32 v98, v88, v89
    v_cvt_pk_bf16_f32 v99, v90, v91
    buffer_store_dwordx4 v[96:99], v8, s[84:87], s24 offen offset:0 sc1
    v_cvt_pk_bf16_f32 v100, v84, v85
    v_cvt_pk_bf16_f32 v101, v86, v87
    v_cvt_pk_bf16_f32 v102, v92, v93
    v_cvt_pk_bf16_f32 v103, v94, v95
    buffer_store_dwordx4 v[100:103], v8, s[84:87], s24 offen offset:512 sc1
    s_add_u32 s24, s24, 524288
    s_waitcnt vmcnt(0) lgkmcnt(0)
    s_barrier
    v_add_u32 v10, 1, v10
    buffer_store_dword v10, v9, s[84:87], 0 offen sc1
mega_kernel_q_done:
    s_load_dwordx2 s[52:53], s[0:1], 40
    v_and_b32 v202, 63, v0
    s_and_b32 s58, s92, 31
    v_lshrrev_b32 v200, 2, v202
    v_lshlrev_b32 v200, 11, v200
    v_and_b32 v203, 3, v202
    v_lshl_add_u32 v200, v203, 4, v200
    s_lshl_b32 s56, s98, 21
    s_lshl_b32 s57, s58, 6
    s_add_u32 s56, s56, s57
    v_add_u32 v200, s56, v200
    s_lshl_b32 s56, s98, 14
    s_add_u32 s56, s56, 81920
    s_lshr_b32 s57, s58, 1
    s_lshl_b32 s57, s57, 12
    v_lshrrev_b32 v201, 5, v202
    v_bfe_u32 v204, v202, 2, 2
    v_lshl_add_u32 v201, v201, 3, v204
    v_lshlrev_b32 v201, 6, v201
    v_bfe_u32 v204, v202, 4, 1
    v_lshl_add_u32 v201, v204, 5, v201
    v_lshl_add_u32 v201, v203, 3, v201
    v_add_u32 v201, s56, v201
    s_waitcnt lgkmcnt(0)
    s_mov_b32 s54, 8388608
    s_mov_b32 s55, 0x00020000
    s_add_u32 m0, s56, 0
    s_add_u32 s58, s57, 0
    s_and_b32 s58, s58, 0xffff
    s_lshl_b32 s58, s58, 5
    buffer_load_dwordx4 v200, s[52:55], s58 offen lds
    s_add_u32 m0, s56, 1024
    s_add_u32 s58, s57, 1024
    s_and_b32 s58, s58, 0xffff
    s_lshl_b32 s58, s58, 5
    buffer_load_dwordx4 v200, s[52:55], s58 offen lds
    s_add_u32 m0, s56, 2048
    s_add_u32 s58, s57, 2048
    s_and_b32 s58, s58, 0xffff
    s_lshl_b32 s58, s58, 5
    buffer_load_dwordx4 v200, s[52:55], s58 offen lds
    s_add_u32 m0, s56, 3072
    s_add_u32 s58, s57, 3072
    s_and_b32 s58, s58, 0xffff
    s_lshl_b32 s58, s58, 5
    buffer_load_dwordx4 v200, s[52:55], s58 offen lds
    s_add_u32 m0, s56, 4096
    s_add_u32 s58, s57, 4096
    s_and_b32 s58, s58, 0xffff
    s_lshl_b32 s58, s58, 5
    buffer_load_dwordx4 v200, s[52:55], s58 offen lds
    s_add_u32 m0, s56, 5120
    s_add_u32 s58, s57, 5120
    s_and_b32 s58, s58, 0xffff
    s_lshl_b32 s58, s58, 5
    buffer_load_dwordx4 v200, s[52:55], s58 offen lds
    s_add_u32 m0, s56, 6144
    s_add_u32 s58, s57, 6144
    s_and_b32 s58, s58, 0xffff
    s_lshl_b32 s58, s58, 5
    buffer_load_dwordx4 v200, s[52:55], s58 offen lds
    s_add_u32 m0, s56, 7168
    s_add_u32 s58, s57, 7168
    s_and_b32 s58, s58, 0xffff
    s_lshl_b32 s58, s58, 5
    buffer_load_dwordx4 v200, s[52:55], s58 offen lds
    s_add_u32 m0, s56, 8192
    s_add_u32 s58, s57, 8192
    s_and_b32 s58, s58, 0xffff
    s_lshl_b32 s58, s58, 5
    buffer_load_dwordx4 v200, s[52:55], s58 offen lds
    s_add_u32 m0, s56, 9216
    s_add_u32 s58, s57, 9216
    s_and_b32 s58, s58, 0xffff
    s_lshl_b32 s58, s58, 5
    buffer_load_dwordx4 v200, s[52:55], s58 offen lds
    s_add_u32 m0, s56, 10240
    s_add_u32 s58, s57, 10240
    s_and_b32 s58, s58, 0xffff
    s_lshl_b32 s58, s58, 5
    buffer_load_dwordx4 v200, s[52:55], s58 offen lds
    s_add_u32 m0, s56, 11264
    s_add_u32 s58, s57, 11264
    s_and_b32 s58, s58, 0xffff
    s_lshl_b32 s58, s58, 5
    buffer_load_dwordx4 v200, s[52:55], s58 offen lds
    s_add_u32 m0, s56, 12288
    s_add_u32 s58, s57, 12288
    s_and_b32 s58, s58, 0xffff
    s_lshl_b32 s58, s58, 5
    buffer_load_dwordx4 v200, s[52:55], s58 offen lds
    s_add_u32 m0, s56, 13312
    s_add_u32 s58, s57, 13312
    s_and_b32 s58, s58, 0xffff
    s_lshl_b32 s58, s58, 5
    buffer_load_dwordx4 v200, s[52:55], s58 offen lds
    s_add_u32 m0, s56, 14336
    s_add_u32 s58, s57, 14336
    s_and_b32 s58, s58, 0xffff
    s_lshl_b32 s58, s58, 5
    buffer_load_dwordx4 v200, s[52:55], s58 offen lds
    s_add_u32 m0, s56, 15360
    s_add_u32 s58, s57, 15360
    s_and_b32 s58, s58, 0xffff
    s_lshl_b32 s58, s58, 5
    buffer_load_dwordx4 v200, s[52:55], s58 offen lds
    s_cmp_lt_u32 s92, 128
    s_cbranch_scc1 mega_kernel_f1
    s_sub_u32 s99, s92, 128
mega_kernel_f0l:
    s_barrier
    s_load_dwordx2 s[4:5], s[0:1], 64
    s_load_dwordx2 s[8:9], s[0:1], 72
    s_load_dwordx2 s[12:13], s[0:1], 96
    s_and_b32 s16, s99, 31
    s_lshr_b32 s17, s99, 5
    v_and_b32 v1, 63, v0
    v_lshrrev_b32 v2, 6, v0
    s_waitcnt lgkmcnt(0)
    s_mov_b32 s6, 2101248
    s_mov_b32 s7, 0x00020000
    s_mov_b32 s10, 2101248
    s_mov_b32 s11, 0x00020000
    s_add_u32 s12, s12, 121634816
    s_addc_u32 s13, s13, 0
    s_mov_b32 s14, 4202496
    s_mov_b32 s15, 0x00020000
    s_lshl_b32 s18, s16, 6
    v_add_u32 v3, s18, v2
    s_movk_i32 s19, 1026
    v_mul_lo_u32 v3, v3, s19
    s_lshl_b32 s18, s17, 7
    v_add_u32 v3, s18, v3
    v_lshl_add_u32 v3, v1, 1, v3
    s_mov_b32 s18, 0
    buffer_load_ushort v16, v3, s[4:7], s18 offen
    buffer_load_ushort v32, v3, s[8:11], s18 offen
    s_mov_b32 s18, 4104
    buffer_load_ushort v17, v3, s[4:7], s18 offen
    buffer_load_ushort v33, v3, s[8:11], s18 offen
    s_mov_b32 s18, 8208
    buffer_load_ushort v18, v3, s[4:7], s18 offen
    buffer_load_ushort v34, v3, s[8:11], s18 offen
    s_mov_b32 s18, 12312
    buffer_load_ushort v19, v3, s[4:7], s18 offen
    buffer_load_ushort v35, v3, s[8:11], s18 offen
    s_mov_b32 s18, 16416
    buffer_load_ushort v20, v3, s[4:7], s18 offen
    buffer_load_ushort v36, v3, s[8:11], s18 offen
    s_mov_b32 s18, 20520
    buffer_load_ushort v21, v3, s[4:7], s18 offen
    buffer_load_ushort v37, v3, s[8:11], s18 offen
    s_mov_b32 s18, 24624
    buffer_load_ushort v22, v3, s[4:7], s18 offen
    buffer_load_ushort v38, v3, s[8:11], s18 offen
    s_mov_b32 s18, 28728
    buffer_load_ushort v23, v3, s[4:7], s18 offen
    buffer_load_ushort v39, v3, s[8:11], s18 offen
    s_mov_b32 s18, 32832
    buffer_load_ushort v24, v3, s[4:7], s18 offen
    buffer_load_ushort v40, v3, s[8:11], s18 offen
    s_mov_b32 s18, 36936
    buffer_load_ushort v25, v3, s[4:7], s18 offen
    buffer_load_ushort v41, v3, s[8:11], s18 offen
    s_mov_b32 s18, 41040
    buffer_load_ushort v26, v3, s[4:7], s18 offen
    buffer_load_ushort v42, v3, s[8:11], s18 offen
    s_mov_b32 s18, 45144
    buffer_load_ushort v27, v3, s[4:7], s18 offen
    buffer_load_ushort v43, v3, s[8:11], s18 offen
    s_mov_b32 s18, 49248
    buffer_load_ushort v28, v3, s[4:7], s18 offen
    buffer_load_ushort v44, v3, s[8:11], s18 offen
    s_mov_b32 s18, 53352
    buffer_load_ushort v29, v3, s[4:7], s18 offen
    buffer_load_ushort v45, v3, s[8:11], s18 offen
    s_mov_b32 s18, 57456
    buffer_load_ushort v30, v3, s[4:7], s18 offen
    buffer_load_ushort v46, v3, s[8:11], s18 offen
    s_mov_b32 s18, 61560
    buffer_load_ushort v31, v3, s[4:7], s18 offen
    buffer_load_ushort v47, v3, s[8:11], s18 offen
    v_mul_u32_u24 v4, 65, v1
    v_add_u32 v4, v4, v2
    v_lshlrev_b32 v4, 2, v4
    s_waitcnt vmcnt(0)
    v_lshl_or_b32 v16, v32, 16, v16
    ds_write_b32 v4, v16 offset:0
    v_lshl_or_b32 v17, v33, 16, v17
    ds_write_b32 v4, v17 offset:16
    v_lshl_or_b32 v18, v34, 16, v18
    ds_write_b32 v4, v18 offset:32
    v_lshl_or_b32 v19, v35, 16, v19
    ds_write_b32 v4, v19 offset:48
    v_lshl_or_b32 v20, v36, 16, v20
    ds_write_b32 v4, v20 offset:64
    v_lshl_or_b32 v21, v37, 16, v21
    ds_write_b32 v4, v21 offset:80
    v_lshl_or_b32 v22, v38, 16, v22
    ds_write_b32 v4, v22 offset:96
    v_lshl_or_b32 v23, v39, 16, v23
    ds_write_b32 v4, v23 offset:112
    v_lshl_or_b32 v24, v40, 16, v24
    ds_write_b32 v4, v24 offset:128
    v_lshl_or_b32 v25, v41, 16, v25
    ds_write_b32 v4, v25 offset:144
    v_lshl_or_b32 v26, v42, 16, v26
    ds_write_b32 v4, v26 offset:160
    v_lshl_or_b32 v27, v43, 16, v27
    ds_write_b32 v4, v27 offset:176
    v_lshl_or_b32 v28, v44, 16, v28
    ds_write_b32 v4, v28 offset:192
    v_lshl_or_b32 v29, v45, 16, v29
    ds_write_b32 v4, v29 offset:208
    v_lshl_or_b32 v30, v46, 16, v30
    ds_write_b32 v4, v30 offset:224
    v_lshl_or_b32 v31, v47, 16, v31
    ds_write_b32 v4, v31 offset:240
    v_lshrrev_b32 v7, 4, v0
    v_and_b32 v8, 15, v0
    v_mul_u32_u24 v5, 65, v7
    v_lshl_add_u32 v5, v8, 2, v5
    v_lshlrev_b32 v5, 2, v5
    s_waitcnt lgkmcnt(0)
    s_barrier
    ds_read_b32 v16, v5 offset:0
    ds_read_b32 v17, v5 offset:4
    ds_read_b32 v18, v5 offset:8
    ds_read_b32 v19, v5 offset:12
    ds_read_b32 v20, v5 offset:4160
    ds_read_b32 v21, v5 offset:4164
    ds_read_b32 v22, v5 offset:4168
    ds_read_b32 v23, v5 offset:4172
    ds_read_b32 v24, v5 offset:8320
    ds_read_b32 v25, v5 offset:8324
    ds_read_b32 v26, v5 offset:8328
    ds_read_b32 v27, v5 offset:8332
    ds_read_b32 v28, v5 offset:12480
    ds_read_b32 v29, v5 offset:12484
    ds_read_b32 v30, v5 offset:12488
    ds_read_b32 v31, v5 offset:12492
    s_lshl_b32 s18, s17, 6
    v_add_u32 v6, s18, v7
    v_lshlrev_b32 v6, 13, v6
    s_lshl_b32 s18, s16, 8
    v_add_u32 v6, s18, v6
    v_lshl_add_u32 v6, v8, 4, v6
    s_waitcnt lgkmcnt(0)
    s_mov_b32 s18, 0
    buffer_store_dwordx4 v[16:19], v6, s[12:15], s18 offen sc1
    s_mov_b32 s18, 131072
    buffer_store_dwordx4 v[20:23], v6, s[12:15], s18 offen sc1
    s_mov_b32 s18, 262144
    buffer_store_dwordx4 v[24:27], v6, s[12:15], s18 offen sc1
    s_mov_b32 s18, 393216
    buffer_store_dwordx4 v[28:31], v6, s[12:15], s18 offen sc1
    s_add_u32 s99, s99, 64
    s_cmp_lt_u32 s99, 288
    s_cbranch_scc1 mega_kernel_f0l
    s_branch mega_kernel_f1d
mega_kernel_f1:
    s_barrier
    s_load_dwordx2 s[4:5], s[0:1], 56
    s_load_dwordx2 s[8:9], s[0:1], 96
    v_and_b32 v1, 31, v0
    v_lshrrev_b32 v2, 5, v0
    v_cvt_f32_u32 v3, v1
    s_waitcnt lgkmcnt(0)
    s_mov_b32 s6, 4194304
    s_mov_b32 s7, 0x00020000
    s_mov_b32 s10, 268435456
    s_mov_b32 s11, 0x00020000
    s_lshl_b32 s12, s92, 15
    v_lshlrev_b32 v6, 12, v2
    v_lshl_add_u32 v6, v1, 1, v6
    buffer_load_ushort v16, v6, s[4:7], s12 offen offset:0
    buffer_load_ushort v48, v6, s[4:7], s12 offen offset:2048
    buffer_load_ushort v17, v6, s[4:7], s12 offen offset:64
    buffer_load_ushort v49, v6, s[4:7], s12 offen offset:2112
    buffer_load_ushort v18, v6, s[4:7], s12 offen offset:128
    buffer_load_ushort v50, v6, s[4:7], s12 offen offset:2176
    buffer_load_ushort v19, v6, s[4:7], s12 offen offset:192
    buffer_load_ushort v51, v6, s[4:7], s12 offen offset:2240
    buffer_load_ushort v20, v6, s[4:7], s12 offen offset:256
    buffer_load_ushort v52, v6, s[4:7], s12 offen offset:2304
    buffer_load_ushort v21, v6, s[4:7], s12 offen offset:320
    buffer_load_ushort v53, v6, s[4:7], s12 offen offset:2368
    buffer_load_ushort v22, v6, s[4:7], s12 offen offset:384
    buffer_load_ushort v54, v6, s[4:7], s12 offen offset:2432
    buffer_load_ushort v23, v6, s[4:7], s12 offen offset:448
    buffer_load_ushort v55, v6, s[4:7], s12 offen offset:2496
    buffer_load_ushort v24, v6, s[4:7], s12 offen offset:512
    buffer_load_ushort v56, v6, s[4:7], s12 offen offset:2560
    buffer_load_ushort v25, v6, s[4:7], s12 offen offset:576
    buffer_load_ushort v57, v6, s[4:7], s12 offen offset:2624
    buffer_load_ushort v26, v6, s[4:7], s12 offen offset:640
    buffer_load_ushort v58, v6, s[4:7], s12 offen offset:2688
    buffer_load_ushort v27, v6, s[4:7], s12 offen offset:704
    buffer_load_ushort v59, v6, s[4:7], s12 offen offset:2752
    buffer_load_ushort v28, v6, s[4:7], s12 offen offset:768
    buffer_load_ushort v60, v6, s[4:7], s12 offen offset:2816
    buffer_load_ushort v29, v6, s[4:7], s12 offen offset:832
    buffer_load_ushort v61, v6, s[4:7], s12 offen offset:2880
    buffer_load_ushort v30, v6, s[4:7], s12 offen offset:896
    buffer_load_ushort v62, v6, s[4:7], s12 offen offset:2944
    buffer_load_ushort v31, v6, s[4:7], s12 offen offset:960
    buffer_load_ushort v63, v6, s[4:7], s12 offen offset:3008
    buffer_load_ushort v32, v6, s[4:7], s12 offen offset:1024
    buffer_load_ushort v64, v6, s[4:7], s12 offen offset:3072
    buffer_load_ushort v33, v6, s[4:7], s12 offen offset:1088
    buffer_load_ushort v65, v6, s[4:7], s12 offen offset:3136
    buffer_load_ushort v34, v6, s[4:7], s12 offen offset:1152
    buffer_load_ushort v66, v6, s[4:7], s12 offen offset:3200
    buffer_load_ushort v35, v6, s[4:7], s12 offen offset:1216
    buffer_load_ushort v67, v6, s[4:7], s12 offen offset:3264
    buffer_load_ushort v36, v6, s[4:7], s12 offen offset:1280
    buffer_load_ushort v68, v6, s[4:7], s12 offen offset:3328
    buffer_load_ushort v37, v6, s[4:7], s12 offen offset:1344
    buffer_load_ushort v69, v6, s[4:7], s12 offen offset:3392
    buffer_load_ushort v38, v6, s[4:7], s12 offen offset:1408
    buffer_load_ushort v70, v6, s[4:7], s12 offen offset:3456
    buffer_load_ushort v39, v6, s[4:7], s12 offen offset:1472
    buffer_load_ushort v71, v6, s[4:7], s12 offen offset:3520
    buffer_load_ushort v40, v6, s[4:7], s12 offen offset:1536
    buffer_load_ushort v72, v6, s[4:7], s12 offen offset:3584
    buffer_load_ushort v41, v6, s[4:7], s12 offen offset:1600
    buffer_load_ushort v73, v6, s[4:7], s12 offen offset:3648
    buffer_load_ushort v42, v6, s[4:7], s12 offen offset:1664
    buffer_load_ushort v74, v6, s[4:7], s12 offen offset:3712
    buffer_load_ushort v43, v6, s[4:7], s12 offen offset:1728
    buffer_load_ushort v75, v6, s[4:7], s12 offen offset:3776
    buffer_load_ushort v44, v6, s[4:7], s12 offen offset:1792
    buffer_load_ushort v76, v6, s[4:7], s12 offen offset:3840
    buffer_load_ushort v45, v6, s[4:7], s12 offen offset:1856
    buffer_load_ushort v77, v6, s[4:7], s12 offen offset:3904
    buffer_load_ushort v46, v6, s[4:7], s12 offen offset:1920
    buffer_load_ushort v78, v6, s[4:7], s12 offen offset:3968
    buffer_load_ushort v47, v6, s[4:7], s12 offen offset:1984
    buffer_load_ushort v79, v6, s[4:7], s12 offen offset:4032
    s_movk_i32 s13, 8448
    v_mul_lo_u32 v7, v2, s13
    v_lshl_add_u32 v4, v1, 3, v7
    s_movk_i32 s13, 264
    v_mul_lo_u32 v5, v1, s13
    v_add_u32 v5, v5, v7
    s_waitcnt vmcnt(0)
    v_lshlrev_b32 v16, 16, v16
    v_lshlrev_b32 v48, 16, v48
    v_lshlrev_b32 v17, 16, v17
    v_lshlrev_b32 v49, 16, v49
    v_lshlrev_b32 v18, 16, v18
    v_lshlrev_b32 v50, 16, v50
    v_lshlrev_b32 v19, 16, v19
    v_lshlrev_b32 v51, 16, v51
    v_lshlrev_b32 v20, 16, v20
    v_lshlrev_b32 v52, 16, v52
    v_lshlrev_b32 v21, 16, v21
    v_lshlrev_b32 v53, 16, v53
    v_lshlrev_b32 v22, 16, v22
    v_lshlrev_b32 v54, 16, v54
    v_lshlrev_b32 v23, 16, v23
    v_lshlrev_b32 v55, 16, v55
    v_lshlrev_b32 v24, 16, v24
    v_lshlrev_b32 v56, 16, v56
    v_lshlrev_b32 v25, 16, v25
    v_lshlrev_b32 v57, 16, v57
    v_lshlrev_b32 v26, 16, v26
    v_lshlrev_b32 v58, 16, v58
    v_lshlrev_b32 v27, 16, v27
    v_lshlrev_b32 v59, 16, v59
    v_lshlrev_b32 v28, 16, v28
    v_lshlrev_b32 v60, 16, v60
    v_lshlrev_b32 v29, 16, v29
    v_lshlrev_b32 v61, 16, v61
    v_lshlrev_b32 v30, 16, v30
    v_lshlrev_b32 v62, 16, v62
    v_lshlrev_b32 v31, 16, v31
    v_lshlrev_b32 v63, 16, v63
    v_lshlrev_b32 v32, 16, v32
    v_lshlrev_b32 v64, 16, v64
    v_lshlrev_b32 v33, 16, v33
    v_lshlrev_b32 v65, 16, v65
    v_lshlrev_b32 v34, 16, v34
    v_lshlrev_b32 v66, 16, v66
    v_lshlrev_b32 v35, 16, v35
    v_lshlrev_b32 v67, 16, v67
    v_lshlrev_b32 v36, 16, v36
    v_lshlrev_b32 v68, 16, v68
    v_lshlrev_b32 v37, 16, v37
    v_lshlrev_b32 v69, 16, v69
    v_lshlrev_b32 v38, 16, v38
    v_lshlrev_b32 v70, 16, v70
    v_lshlrev_b32 v39, 16, v39
    v_lshlrev_b32 v71, 16, v71
    v_lshlrev_b32 v40, 16, v40
    v_lshlrev_b32 v72, 16, v72
    v_lshlrev_b32 v41, 16, v41
    v_lshlrev_b32 v73, 16, v73
    v_lshlrev_b32 v42, 16, v42
    v_lshlrev_b32 v74, 16, v74
    v_lshlrev_b32 v43, 16, v43
    v_lshlrev_b32 v75, 16, v75
    v_lshlrev_b32 v44, 16, v44
    v_lshlrev_b32 v76, 16, v76
    v_lshlrev_b32 v45, 16, v45
    v_lshlrev_b32 v77, 16, v77
    v_lshlrev_b32 v46, 16, v46
    v_lshlrev_b32 v78, 16, v78
    v_lshlrev_b32 v47, 16, v47
    v_lshlrev_b32 v79, 16, v79
    v_sub_f32 v80, v16, v32
    v_sub_f32 v81, v48, v64
    v_add_f32 v16, v16, v32
    v_add_f32 v48, v48, v64
    v_sub_f32 v32, v17, v33
    v_sub_f32 v64, v49, v65
    v_add_f32 v17, v17, v33
    v_add_f32 v49, v49, v65
    v_mul_f32 v33, 0x3f7b14be, v32
    v_mul_f32 v65, 0xbe47c5c2, v32
    v_fmac_f32 v33, 0x3e47c5c2, v64
    v_fmac_f32 v65, 0x3f7b14be, v64
    v_sub_f32 v32, v18, v34
    v_sub_f32 v64, v50, v66
    v_add_f32 v18, v18, v34
    v_add_f32 v50, v50, v66
    v_mul_f32 v34, 0x3f6c835e, v32
    v_mul_f32 v66, 0xbec3ef15, v32
    v_fmac_f32 v34, 0x3ec3ef15, v64
    v_fmac_f32 v66, 0x3f6c835e, v64
    v_sub_f32 v32, v19, v35
    v_sub_f32 v64, v51, v67
    v_add_f32 v19, v19, v35
    v_add_f32 v51, v51, v67
    v_mul_f32 v35, 0x3f54db31, v32
    v_mul_f32 v67, 0xbf0e39da, v32
    v_fmac_f32 v35, 0x3f0e39da, v64
    v_fmac_f32 v67, 0x3f54db31, v64
    v_sub_f32 v32, v20, v36
    v_sub_f32 v64, v52, v68
    v_add_f32 v20, v20, v36
    v_add_f32 v52, v52, v68
    v_mul_f32 v36, 0x3f3504f3, v32
    v_mul_f32 v68, 0xbf3504f3, v32
    v_fmac_f32 v36, 0x3f3504f3, v64
    v_fmac_f32 v68, 0x3f3504f3, v64
    v_sub_f32 v32, v21, v37
    v_sub_f32 v64, v53, v69
    v_add_f32 v21, v21, v37
    v_add_f32 v53, v53, v69
    v_mul_f32 v37, 0x3f0e39da, v32
    v_mul_f32 v69, 0xbf54db31, v32
    v_fmac_f32 v37, 0x3f54db31, v64
    v_fmac_f32 v69, 0x3f0e39da, v64
    v_sub_f32 v32, v22, v38
    v_sub_f32 v64, v54, v70
    v_add_f32 v22, v22, v38
    v_add_f32 v54, v54, v70
    v_mul_f32 v38, 0x3ec3ef15, v32
    v_mul_f32 v70, 0xbf6c835e, v32
    v_fmac_f32 v38, 0x3f6c835e, v64
    v_fmac_f32 v70, 0x3ec3ef15, v64
    v_sub_f32 v32, v23, v39
    v_sub_f32 v64, v55, v71
    v_add_f32 v23, v23, v39
    v_add_f32 v55, v55, v71
    v_mul_f32 v39, 0x3e47c5c2, v32
    v_mul_f32 v71, 0xbf7b14be, v32
    v_fmac_f32 v39, 0x3f7b14be, v64
    v_fmac_f32 v71, 0x3e47c5c2, v64
    v_sub_f32 v32, v56, v72
    v_sub_f32 v64, v40, v24
    v_add_f32 v24, v24, v40
    v_add_f32 v56, v56, v72
    v_sub_f32 v40, v25, v41
    v_sub_f32 v72, v57, v73
    v_add_f32 v25, v25, v41
    v_add_f32 v57, v57, v73
    v_mul_f32 v41, 0xbe47c5c2, v40
    v_mul_f32 v73, 0xbf7b14be, v40
    v_fmac_f32 v41, 0x3f7b14be, v72
    v_fmac_f32 v73, 0xbe47c5c2, v72
    v_sub_f32 v40, v26, v42
    v_sub_f32 v72, v58, v74
    v_add_f32 v26, v26, v42
    v_add_f32 v58, v58, v74
    v_mul_f32 v42, 0xbec3ef15, v40
    v_mul_f32 v74, 0xbf6c835e, v40
    v_fmac_f32 v42, 0x3f6c835e, v72
    v_fmac_f32 v74, 0xbec3ef15, v72
    v_sub_f32 v40, v27, v43
    v_sub_f32 v72, v59, v75
    v_add_f32 v27, v27, v43
    v_add_f32 v59, v59, v75
    v_mul_f32 v43, 0xbf0e39da, v40
    v_mul_f32 v75, 0xbf54db31, v40
    v_fmac_f32 v43, 0x3f54db31, v72
    v_fmac_f32 v75, 0xbf0e39da, v72
    v_sub_f32 v40, v28, v44
    v_sub_f32 v72, v60, v76
    v_add_f32 v28, v28, v44
    v_add_f32 v60, v60, v76
    v_mul_f32 v44, 0xbf3504f3, v40
    v_mul_f32 v76, 0xbf3504f3, v40
    v_fmac_f32 v44, 0x3f3504f3, v72
    v_fmac_f32 v76, 0xbf3504f3, v72
    v_sub_f32 v40, v29, v45
    v_sub_f32 v72, v61, v77
    v_add_f32 v29, v29, v45
    v_add_f32 v61, v61, v77
    v_mul_f32 v45, 0xbf54db31, v40
    v_mul_f32 v77, 0xbf0e39da, v40
    v_fmac_f32 v45, 0x3f0e39da, v72
    v_fmac_f32 v77, 0xbf54db31, v72
    v_sub_f32 v40, v30, v46
    v_sub_f32 v72, v62, v78
    v_add_f32 v30, v30, v46
    v_add_f32 v62, v62, v78
    v_mul_f32 v46, 0xbf6c835e, v40
    v_mul_f32 v78, 0xbec3ef15, v40
    v_fmac_f32 v46, 0x3ec3ef15, v72
    v_fmac_f32 v78, 0xbf6c835e, v72
    v_sub_f32 v40, v31, v47
    v_sub_f32 v72, v63, v79
    v_add_f32 v31, v31, v47
    v_add_f32 v63, v63, v79
    v_mul_f32 v47, 0xbf7b14be, v40
    v_mul_f32 v79, 0xbe47c5c2, v40
    v_fmac_f32 v47, 0x3e47c5c2, v72
    v_fmac_f32 v79, 0xbf7b14be, v72
    v_sub_f32 v40, v16, v24
    v_sub_f32 v72, v48, v56
    v_add_f32 v16, v16, v24
    v_add_f32 v48, v48, v56
    v_sub_f32 v24, v17, v25
    v_sub_f32 v56, v49, v57
    v_add_f32 v17, v17, v25
    v_add_f32 v49, v49, v57
    v_mul_f32 v25, 0x3f6c835e, v24
    v_mul_f32 v57, 0xbec3ef15, v24
    v_fmac_f32 v25, 0x3ec3ef15, v56
    v_fmac_f32 v57, 0x3f6c835e, v56
    v_sub_f32 v24, v18, v26
    v_sub_f32 v56, v50, v58
    v_add_f32 v18, v18, v26
    v_add_f32 v50, v50, v58
    v_mul_f32 v26, 0x3f3504f3, v24
    v_mul_f32 v58, 0xbf3504f3, v24
    v_fmac_f32 v26, 0x3f3504f3, v56
    v_fmac_f32 v58, 0x3f3504f3, v56
    v_sub_f32 v24, v19, v27
    v_sub_f32 v56, v51, v59
    v_add_f32 v19, v19, v27
    v_add_f32 v51, v51, v59
    v_mul_f32 v27, 0x3ec3ef15, v24
    v_mul_f32 v59, 0xbf6c835e, v24
    v_fmac_f32 v27, 0x3f6c835e, v56
    v_fmac_f32 v59, 0x3ec3ef15, v56
    v_sub_f32 v24, v52, v60
    v_sub_f32 v56, v28, v20
    v_add_f32 v20, v20, v28
    v_add_f32 v52, v52, v60
    v_sub_f32 v28, v21, v29
    v_sub_f32 v60, v53, v61
    v_add_f32 v21, v21, v29
    v_add_f32 v53, v53, v61
    v_mul_f32 v29, 0xbec3ef15, v28
    v_mul_f32 v61, 0xbf6c835e, v28
    v_fmac_f32 v29, 0x3f6c835e, v60
    v_fmac_f32 v61, 0xbec3ef15, v60
    v_sub_f32 v28, v22, v30
    v_sub_f32 v60, v54, v62
    v_add_f32 v22, v22, v30
    v_add_f32 v54, v54, v62
    v_mul_f32 v30, 0xbf3504f3, v28
    v_mul_f32 v62, 0xbf3504f3, v28
    v_fmac_f32 v30, 0x3f3504f3, v60
    v_fmac_f32 v62, 0xbf3504f3, v60
    v_sub_f32 v28, v23, v31
    v_sub_f32 v60, v55, v63
    v_add_f32 v23, v23, v31
    v_add_f32 v55, v55, v63
    v_mul_f32 v31, 0xbf6c835e, v28
    v_mul_f32 v63, 0xbec3ef15, v28
    v_fmac_f32 v31, 0x3ec3ef15, v60
    v_fmac_f32 v63, 0xbf6c835e, v60
    v_sub_f32 v28, v80, v32
    v_sub_f32 v60, v81, v64
    v_add_f32 v80, v80, v32
    v_add_f32 v81, v81, v64
    v_sub_f32 v32, v33, v41
    v_sub_f32 v64, v65, v73
    v_add_f32 v33, v33, v41
    v_add_f32 v65, v65, v73
    v_mul_f32 v41, 0x3f6c835e, v32
    v_mul_f32 v73, 0xbec3ef15, v32
    v_fmac_f32 v41, 0x3ec3ef15, v64
    v_fmac_f32 v73, 0x3f6c835e, v64
    v_sub_f32 v32, v34, v42
    v_sub_f32 v64, v66, v74
    v_add_f32 v34, v34, v42
    v_add_f32 v66, v66, v74
    v_mul_f32 v42, 0x3f3504f3, v32
    v_mul_f32 v74, 0xbf3504f3, v32
    v_fmac_f32 v42, 0x3f3504f3, v64
    v_fmac_f32 v74, 0x3f3504f3, v64
    v_sub_f32 v32, v35, v43
    v_sub_f32 v64, v67, v75
    v_add_f32 v35, v35, v43
    v_add_f32 v67, v67, v75
    v_mul_f32 v43, 0x3ec3ef15, v32
    v_mul_f32 v75, 0xbf6c835e, v32
    v_fmac_f32 v43, 0x3f6c835e, v64
    v_fmac_f32 v75, 0x3ec3ef15, v64
    v_sub_f32 v32, v68, v76
    v_sub_f32 v64, v44, v36
    v_add_f32 v36, v36, v44
    v_add_f32 v68, v68, v76
    v_sub_f32 v44, v37, v45
    v_sub_f32 v76, v69, v77
    v_add_f32 v37, v37, v45
    v_add_f32 v69, v69, v77
    v_mul_f32 v45, 0xbec3ef15, v44
    v_mul_f32 v77, 0xbf6c835e, v44
    v_fmac_f32 v45, 0x3f6c835e, v76
    v_fmac_f32 v77, 0xbec3ef15, v76
    v_sub_f32 v44, v38, v46
    v_sub_f32 v76, v70, v78
    v_add_f32 v38, v38, v46
    v_add_f32 v70, v70, v78
    v_mul_f32 v46, 0xbf3504f3, v44
    v_mul_f32 v78, 0xbf3504f3, v44
    v_fmac_f32 v46, 0x3f3504f3, v76
    v_fmac_f32 v78, 0xbf3504f3, v76
    v_sub_f32 v44, v39, v47
    v_sub_f32 v76, v71, v79
    v_add_f32 v39, v39, v47
    v_add_f32 v71, v71, v79
    v_mul_f32 v47, 0xbf6c835e, v44
    v_mul_f32 v79, 0xbec3ef15, v44
    v_fmac_f32 v47, 0x3ec3ef15, v76
    v_fmac_f32 v79, 0xbf6c835e, v76
    v_sub_f32 v44, v16, v20
    v_sub_f32 v76, v48, v52
    v_add_f32 v16, v16, v20
    v_add_f32 v48, v48, v52
    v_sub_f32 v20, v17, v21
    v_sub_f32 v52, v49, v53
    v_add_f32 v17, v17, v21
    v_add_f32 v49, v49, v53
    v_mul_f32 v21, 0x3f3504f3, v20
    v_mul_f32 v53, 0xbf3504f3, v20
    v_fmac_f32 v21, 0x3f3504f3, v52
    v_fmac_f32 v53, 0x3f3504f3, v52
    v_sub_f32 v20, v50, v54
    v_sub_f32 v52, v22, v18
    v_add_f32 v18, v18, v22
    v_add_f32 v50, v50, v54
    v_sub_f32 v22, v19, v23
    v_sub_f32 v54, v51, v55
    v_add_f32 v19, v19, v23
    v_add_f32 v51, v51, v55
    v_mul_f32 v23, 0xbf3504f3, v22
    v_mul_f32 v55, 0xbf3504f3, v22
    v_fmac_f32 v23, 0x3f3504f3, v54
    v_fmac_f32 v55, 0xbf3504f3, v54
    v_sub_f32 v22, v40, v24
    v_sub_f32 v54, v72, v56
    v_add_f32 v40, v40, v24
    v_add_f32 v72, v72, v56
    v_sub_f32 v24, v25, v29
    v_sub_f32 v56, v57, v61
    v_add_f32 v25, v25, v29
    v_add_f32 v57, v57, v61
    v_mul_f32 v29, 0x3f3504f3, v24
    v_mul_f32 v61, 0xbf3504f3, v24
    v_fmac_f32 v29, 0x3f3504f3, v56
    v_fmac_f32 v61, 0x3f3504f3, v56
    v_sub_f32 v24, v58, v62
    v_sub_f32 v56, v30, v26
    v_add_f32 v26, v26, v30
    v_add_f32 v58, v58, v62
    v_sub_f32 v30, v27, v31
    v_sub_f32 v62, v59, v63
    v_add_f32 v27, v27, v31
    v_add_f32 v59, v59, v63
    v_mul_f32 v31, 0xbf3504f3, v30
    v_mul_f32 v63, 0xbf3504f3, v30
    v_fmac_f32 v31, 0x3f3504f3, v62
    v_fmac_f32 v63, 0xbf3504f3, v62
    v_sub_f32 v30, v80, v36
    v_sub_f32 v62, v81, v68
    v_add_f32 v80, v80, v36
    v_add_f32 v81, v81, v68
    v_sub_f32 v36, v33, v37
    v_sub_f32 v68, v65, v69
    v_add_f32 v33, v33, v37
    v_add_f32 v65, v65, v69
    v_mul_f32 v37, 0x3f3504f3, v36
    v_mul_f32 v69, 0xbf3504f3, v36
    v_fmac_f32 v37, 0x3f3504f3, v68
    v_fmac_f32 v69, 0x3f3504f3, v68
    v_sub_f32 v36, v66, v70
    v_sub_f32 v68, v38, v34
    v_add_f32 v34, v34, v38
    v_add_f32 v66, v66, v70
    v_sub_f32 v38, v35, v39
    v_sub_f32 v70, v67, v71
    v_add_f32 v35, v35, v39
    v_add_f32 v67, v67, v71
    v_mul_f32 v39, 0xbf3504f3, v38
    v_mul_f32 v71, 0xbf3504f3, v38
    v_fmac_f32 v39, 0x3f3504f3, v70
    v_fmac_f32 v71, 0xbf3504f3, v70
    v_sub_f32 v38, v28, v32
    v_sub_f32 v70, v60, v64
    v_add_f32 v28, v28, v32
    v_add_f32 v60, v60, v64
    v_sub_f32 v32, v41, v45
    v_sub_f32 v64, v73, v77
    v_add_f32 v41, v41, v45
    v_add_f32 v73, v73, v77
    v_mul_f32 v45, 0x3f3504f3, v32
    v_mul_f32 v77, 0xbf3504f3, v32
    v_fmac_f32 v45, 0x3f3504f3, v64
    v_fmac_f32 v77, 0x3f3504f3, v64
    v_sub_f32 v32, v74, v78
    v_sub_f32 v64, v46, v42
    v_add_f32 v42, v42, v46
    v_add_f32 v74, v74, v78
    v_sub_f32 v46, v43, v47
    v_sub_f32 v78, v75, v79
    v_add_f32 v43, v43, v47
    v_add_f32 v75, v75, v79
    v_mul_f32 v47, 0xbf3504f3, v46
    v_mul_f32 v79, 0xbf3504f3, v46
    v_fmac_f32 v47, 0x3f3504f3, v78
    v_fmac_f32 v79, 0xbf3504f3, v78
    v_sub_f32 v46, v16, v18
    v_sub_f32 v78, v48, v50
    v_add_f32 v16, v16, v18
    v_add_f32 v48, v48, v50
    v_sub_f32 v18, v49, v51
    v_sub_f32 v50, v19, v17
    v_add_f32 v17, v17, v19
    v_add_f32 v49, v49, v51
    v_sub_f32 v19, v44, v20
    v_sub_f32 v51, v76, v52
    v_add_f32 v44, v44, v20
    v_add_f32 v76, v76, v52
    v_sub_f32 v20, v53, v55
    v_sub_f32 v52, v23, v21
    v_add_f32 v21, v21, v23
    v_add_f32 v53, v53, v55
    v_sub_f32 v23, v40, v26
    v_sub_f32 v55, v72, v58
    v_add_f32 v40, v40, v26
    v_add_f32 v72, v72, v58
    v_sub_f32 v26, v57, v59
    v_sub_f32 v58, v27, v25
    v_add_f32 v25, v25, v27
    v_add_f32 v57, v57, v59
    v_sub_f32 v27, v22, v24
    v_sub_f32 v59, v54, v56
    v_add_f32 v22, v22, v24
    v_add_f32 v54, v54, v56
    v_sub_f32 v24, v61, v63
    v_sub_f32 v56, v31, v29
    v_add_f32 v29, v29, v31
    v_add_f32 v61, v61, v63
    v_sub_f32 v31, v80, v34
    v_sub_f32 v63, v81, v66
    v_add_f32 v80, v80, v34
    v_add_f32 v81, v81, v66
    v_sub_f32 v34, v65, v67
    v_sub_f32 v66, v35, v33
    v_add_f32 v33, v33, v35
    v_add_f32 v65, v65, v67
    v_sub_f32 v35, v30, v36
    v_sub_f32 v67, v62, v68
    v_add_f32 v30, v30, v36
    v_add_f32 v62, v62, v68
    v_sub_f32 v36, v69, v71
    v_sub_f32 v68, v39, v37
    v_add_f32 v37, v37, v39
    v_add_f32 v69, v69, v71
    v_sub_f32 v39, v28, v42
    v_sub_f32 v71, v60, v74
    v_add_f32 v28, v28, v42
    v_add_f32 v60, v60, v74
    v_sub_f32 v42, v73, v75
    v_sub_f32 v74, v43, v41
    v_add_f32 v41, v41, v43
    v_add_f32 v73, v73, v75
    v_sub_f32 v43, v38, v32
    v_sub_f32 v75, v70, v64
    v_add_f32 v38, v38, v32
    v_add_f32 v70, v70, v64
    v_sub_f32 v32, v77, v79
    v_sub_f32 v64, v47, v45
    v_add_f32 v45, v45, v47
    v_add_f32 v77, v77, v79
    v_sub_f32 v47, v16, v17
    v_sub_f32 v79, v48, v49
    v_add_f32 v16, v16, v17
    v_add_f32 v48, v48, v49
    v_sub_f32 v17, v46, v18
    v_sub_f32 v49, v78, v50
    v_add_f32 v46, v46, v18
    v_add_f32 v78, v78, v50
    v_sub_f32 v18, v44, v21
    v_sub_f32 v50, v76, v53
    v_add_f32 v44, v44, v21
    v_add_f32 v76, v76, v53
    v_sub_f32 v21, v19, v20
    v_sub_f32 v53, v51, v52
    v_add_f32 v19, v19, v20
    v_add_f32 v51, v51, v52
    v_sub_f32 v20, v40, v25
    v_sub_f32 v52, v72, v57
    v_add_f32 v40, v40, v25
    v_add_f32 v72, v72, v57
    v_sub_f32 v25, v23, v26
    v_sub_f32 v57, v55, v58
    v_add_f32 v23, v23, v26
    v_add_f32 v55, v55, v58
    v_sub_f32 v26, v22, v29
    v_sub_f32 v58, v54, v61
    v_add_f32 v22, v22, v29
    v_add_f32 v54, v54, v61
    v_sub_f32 v29, v27, v24
    v_sub_f32 v61, v59, v56
    v_add_f32 v27, v27, v24
    v_add_f32 v59, v59, v56
    v_sub_f32 v24, v80, v33
    v_sub_f32 v56, v81, v65
    v_add_f32 v80, v80, v33
    v_add_f32 v81, v81, v65
    v_sub_f32 v33, v31, v34
    v_sub_f32 v65, v63, v66
    v_add_f32 v31, v31, v34
    v_add_f32 v63, v63, v66
    v_sub_f32 v34, v30, v37
    v_sub_f32 v66, v62, v69
    v_add_f32 v30, v30, v37
    v_add_f32 v62, v62, v69
    v_sub_f32 v37, v35, v36
    v_sub_f32 v69, v67, v68
    v_add_f32 v35, v35, v36
    v_add_f32 v67, v67, v68
    v_sub_f32 v36, v28, v41
    v_sub_f32 v68, v60, v73
    v_add_f32 v28, v28, v41
    v_add_f32 v60, v60, v73
    v_sub_f32 v41, v39, v42
    v_sub_f32 v73, v71, v74
    v_add_f32 v39, v39, v42
    v_add_f32 v71, v71, v74
    v_sub_f32 v42, v38, v45
    v_sub_f32 v74, v70, v77
    v_add_f32 v38, v38, v45
    v_add_f32 v70, v70, v77
    v_sub_f32 v45, v43, v32
    v_sub_f32 v77, v75, v64
    v_add_f32 v43, v43, v32
    v_add_f32 v75, v75, v64
    v_mul_f32 v32, 0xba800000, v3
    v_cos_f32 v64, v32
    v_sin_f32 v82, v32
    s_nop 0
    v_mul_f32 v83, v80, v64
    v_fma_f32 v83, -v81, v82, v83
    v_mul_f32 v81, v81, v64
    v_fmac_f32 v81, v80, v82
    v_mul_f32 v32, 0xbb000000, v3
    v_cos_f32 v64, v32
    v_sin_f32 v82, v32
    s_nop 0
    v_mul_f32 v80, v40, v64
    v_fma_f32 v80, -v72, v82, v80
    v_mul_f32 v72, v72, v64
    v_fmac_f32 v72, v40, v82
    v_mul_f32 v32, 0xbb400000, v3
    v_cos_f32 v64, v32
    v_sin_f32 v82, v32
    s_nop 0
    v_mul_f32 v40, v28, v64
    v_fma_f32 v40, -v60, v82, v40
    v_mul_f32 v60, v60, v64
    v_fmac_f32 v60, v28, v82
    v_mul_f32 v32, 0xbb800000, v3
    v_cos_f32 v64, v32
    v_sin_f32 v82, v32
    s_nop 0
    v_mul_f32 v28, v44, v64
    v_fma_f32 v28, -v76, v82, v28
    v_mul_f32 v76, v76, v64
    v_fmac_f32 v76, v44, v82
    v_mul_f32 v32, 0xbba00000, v3
    v_cos_f32 v64, v32
    v_sin_f32 v82, v32
    s_nop 0
    v_mul_f32 v44, v30, v64
    v_fma_f32 v44, -v62, v82, v44
    v_mul_f32 v62, v62, v64
    v_fmac_f32 v62, v30, v82
    v_mul_f32 v32, 0xbbc00000, v3
    v_cos_f32 v64, v32
    v_sin_f32 v82, v32
    s_nop 0
    v_mul_f32 v30, v22, v64
    v_fma_f32 v30, -v54, v82, v30
    v_mul_f32 v54, v54, v64
    v_fmac_f32 v54, v22, v82
    v_mul_f32 v32, 0xbbe00000, v3
    v_cos_f32 v64, v32
    v_sin_f32 v82, v32
    s_nop 0
    v_mul_f32 v22, v38, v64
    v_fma_f32 v22, -v70, v82, v22
    v_mul_f32 v70, v70, v64
    v_fmac_f32 v70, v38, v82
    v_mul_f32 v32, 0xbc000000, v3
    v_cos_f32 v64, v32
    v_sin_f32 v82, v32
    s_nop 0
    v_mul_f32 v38, v46, v64
    v_fma_f32 v38, -v78, v82, v38
    v_mul_f32 v78, v78, v64
    v_fmac_f32 v78, v46, v82
    v_mul_f32 v32, 0xbc100000, v3
    v_cos_f32 v64, v32
    v_sin_f32 v82, v32
    s_nop 0
    v_mul_f32 v46, v31, v64
    v_fma_f32 v46, -v63, v82, v46
    v_mul_f32 v63, v63, v64
    v_fmac_f32 v63, v31, v82
    v_mul_f32 v32, 0xbc200000, v3
    v_cos_f32 v64, v32
    v_sin_f32 v82, v32
    s_nop 0
    v_mul_f32 v31, v23, v64
    v_fma_f32 v31, -v55, v82, v31
    v_mul_f32 v55, v55, v64
    v_fmac_f32 v55, v23, v82
    v_mul_f32 v32, 0xbc300000, v3
    v_cos_f32 v64, v32
    v_sin_f32 v82, v32
    s_nop 0
    v_mul_f32 v23, v39, v64
    v_fma_f32 v23, -v71, v82, v23
    v_mul_f32 v71, v71, v64
    v_fmac_f32 v71, v39, v82
    v_mul_f32 v32, 0xbc400000, v3
    v_cos_f32 v64, v32
    v_sin_f32 v82, v32
    s_nop 0
    v_mul_f32 v39, v19, v64
    v_fma_f32 v39, -v51, v82, v39
    v_mul_f32 v51, v51, v64
    v_fmac_f32 v51, v19, v82
    v_mul_f32 v32, 0xbc500000, v3
    v_cos_f32 v64, v32
    v_sin_f32 v82, v32
    s_nop 0
    v_mul_f32 v19, v35, v64
    v_fma_f32 v19, -v67, v82, v19
    v_mul_f32 v67, v67, v64
    v_fmac_f32 v67, v35, v82
    v_mul_f32 v32, 0xbc600000, v3
    v_cos_f32 v64, v32
    v_sin_f32 v82, v32
    s_nop 0
    v_mul_f32 v35, v27, v64
    v_fma_f32 v35, -v59, v82, v35
    v_mul_f32 v59, v59, v64
    v_fmac_f32 v59, v27, v82
    v_mul_f32 v32, 0xbc700000, v3
    v_cos_f32 v64, v32
    v_sin_f32 v82, v32
    s_nop 0
    v_mul_f32 v27, v43, v64
    v_fma_f32 v27, -v75, v82, v27
    v_mul_f32 v75, v75, v64
    v_fmac_f32 v75, v43, v82
    v_mul_f32 v32, 0xbc800000, v3
    v_cos_f32 v64, v32
    v_sin_f32 v82, v32
    s_nop 0
    v_mul_f32 v43, v47, v64
    v_fma_f32 v43, -v79, v82, v43
    v_mul_f32 v79, v79, v64
    v_fmac_f32 v79, v47, v82
    v_mul_f32 v32, 0xbc880000, v3
    v_cos_f32 v64, v32
    v_sin_f32 v82, v32
    s_nop 0
    v_mul_f32 v47, v24, v64
    v_fma_f32 v47, -v56, v82, v47
    v_mul_f32 v56, v56, v64
    v_fmac_f32 v56, v24, v82
    v_mul_f32 v32, 0xbc900000, v3
    v_cos_f32 v64, v32
    v_sin_f32 v82, v32
    s_nop 0
    v_mul_f32 v24, v20, v64
    v_fma_f32 v24, -v52, v82, v24
    v_mul_f32 v52, v52, v64
    v_fmac_f32 v52, v20, v82
    v_mul_f32 v32, 0xbc980000, v3
    v_cos_f32 v64, v32
    v_sin_f32 v82, v32
    s_nop 0
    v_mul_f32 v20, v36, v64
    v_fma_f32 v20, -v68, v82, v20
    v_mul_f32 v68, v68, v64
    v_fmac_f32 v68, v36, v82
    v_mul_f32 v32, 0xbca00000, v3
    v_cos_f32 v64, v32
    v_sin_f32 v82, v32
    s_nop 0
    v_mul_f32 v36, v18, v64
    v_fma_f32 v36, -v50, v82, v36
    v_mul_f32 v50, v50, v64
    v_fmac_f32 v50, v18, v82
    v_mul_f32 v32, 0xbca80000, v3
    v_cos_f32 v64, v32
    v_sin_f32 v82, v32
    s_nop 0
    v_mul_f32 v18, v34, v64
    v_fma_f32 v18, -v66, v82, v18
    v_mul_f32 v66, v66, v64
    v_fmac_f32 v66, v34, v82
    v_mul_f32 v32, 0xbcb00000, v3
    v_cos_f32 v64, v32
    v_sin_f32 v82, v32
    s_nop 0
    v_mul_f32 v34, v26, v64
    v_fma_f32 v34, -v58, v82, v34
    v_mul_f32 v58, v58, v64
    v_fmac_f32 v58, v26, v82
    v_mul_f32 v32, 0xbcb80000, v3
    v_cos_f32 v64, v32
    v_sin_f32 v82, v32
    s_nop 0
    v_mul_f32 v26, v42, v64
    v_fma_f32 v26, -v74, v82, v26
    v_mul_f32 v74, v74, v64
    v_fmac_f32 v74, v42, v82
    v_mul_f32 v32, 0xbcc00000, v3
    v_cos_f32 v64, v32
    v_sin_f32 v82, v32
    s_nop 0
    v_mul_f32 v42, v17, v64
    v_fma_f32 v42, -v49, v82, v42
    v_mul_f32 v49, v49, v64
    v_fmac_f32 v49, v17, v82
    v_mul_f32 v32, 0xbcc80000, v3
    v_cos_f32 v64, v32
    v_sin_f32 v82, v32
    s_nop 0
    v_mul_f32 v17, v33, v64
    v_fma_f32 v17, -v65, v82, v17
    v_mul_f32 v65, v65, v64
    v_fmac_f32 v65, v33, v82
    v_mul_f32 v32, 0xbcd00000, v3
    v_cos_f32 v64, v32
    v_sin_f32 v82, v32
    s_nop 0
    v_mul_f32 v33, v25, v64
    v_fma_f32 v33, -v57, v82, v33
    v_mul_f32 v57, v57, v64
    v_fmac_f32 v57, v25, v82
    v_mul_f32 v32, 0xbcd80000, v3
    v_cos_f32 v64, v32
    v_sin_f32 v82, v32
    s_nop 0
    v_mul_f32 v25, v41, v64
    v_fma_f32 v25, -v73, v82, v25
    v_mul_f32 v73, v73, v64
    v_fmac_f32 v73, v41, v82
    v_mul_f32 v32, 0xbce00000, v3
    v_cos_f32 v64, v32
    v_sin_f32 v82, v32
    s_nop 0
    v_mul_f32 v41, v21, v64
    v_fma_f32 v41, -v53, v82, v41
    v_mul_f32 v53, v53, v64
    v_fmac_f32 v53, v21, v82
    v_mul_f32 v32, 0xbce80000, v3
    v_cos_f32 v64, v32
    v_sin_f32 v82, v32
    s_nop 0
    v_mul_f32 v21, v37, v64
    v_fma_f32 v21, -v69, v82, v21
    v_mul_f32 v69, v69, v64
    v_fmac_f32 v69, v37, v82
    v_mul_f32 v32, 0xbcf00000, v3
    v_cos_f32 v64, v32
    v_sin_f32 v82, v32
    s_nop 0
    v_mul_f32 v37, v29, v64
    v_fma_f32 v37, -v61, v82, v37
    v_mul_f32 v61, v61, v64
    v_fmac_f32 v61, v29, v82
    v_mul_f32 v32, 0xbcf80000, v3
    v_cos_f32 v64, v32
    v_sin_f32 v82, v32
    s_nop 0
    v_mul_f32 v29, v45, v64
    v_fma_f32 v29, -v77, v82, v29
    v_mul_f32 v77, v77, v64
    v_fmac_f32 v77, v45, v82
    ds_write_b32 v4, v16 offset:0
    ds_write_b32 v4, v48 offset:4
    ds_write_b32 v4, v83 offset:264
    ds_write_b32 v4, v81 offset:268
    ds_write_b32 v4, v80 offset:528
    ds_write_b32 v4, v72 offset:532
    ds_write_b32 v4, v40 offset:792
    ds_write_b32 v4, v60 offset:796
    ds_write_b32 v4, v28 offset:1056
    ds_write_b32 v4, v76 offset:1060
    ds_write_b32 v4, v44 offset:1320
    ds_write_b32 v4, v62 offset:1324
    ds_write_b32 v4, v30 offset:1584
    ds_write_b32 v4, v54 offset:1588
    ds_write_b32 v4, v22 offset:1848
    ds_write_b32 v4, v70 offset:1852
    ds_write_b32 v4, v38 offset:2112
    ds_write_b32 v4, v78 offset:2116
    ds_write_b32 v4, v46 offset:2376
    ds_write_b32 v4, v63 offset:2380
    ds_write_b32 v4, v31 offset:2640
    ds_write_b32 v4, v55 offset:2644
    ds_write_b32 v4, v23 offset:2904
    ds_write_b32 v4, v71 offset:2908
    ds_write_b32 v4, v39 offset:3168
    ds_write_b32 v4, v51 offset:3172
    ds_write_b32 v4, v19 offset:3432
    ds_write_b32 v4, v67 offset:3436
    ds_write_b32 v4, v35 offset:3696
    ds_write_b32 v4, v59 offset:3700
    ds_write_b32 v4, v27 offset:3960
    ds_write_b32 v4, v75 offset:3964
    ds_write_b32 v4, v43 offset:4224
    ds_write_b32 v4, v79 offset:4228
    ds_write_b32 v4, v47 offset:4488
    ds_write_b32 v4, v56 offset:4492
    ds_write_b32 v4, v24 offset:4752
    ds_write_b32 v4, v52 offset:4756
    ds_write_b32 v4, v20 offset:5016
    ds_write_b32 v4, v68 offset:5020
    ds_write_b32 v4, v36 offset:5280
    ds_write_b32 v4, v50 offset:5284
    ds_write_b32 v4, v18 offset:5544
    ds_write_b32 v4, v66 offset:5548
    ds_write_b32 v4, v34 offset:5808
    ds_write_b32 v4, v58 offset:5812
    ds_write_b32 v4, v26 offset:6072
    ds_write_b32 v4, v74 offset:6076
    ds_write_b32 v4, v42 offset:6336
    ds_write_b32 v4, v49 offset:6340
    ds_write_b32 v4, v17 offset:6600
    ds_write_b32 v4, v65 offset:6604
    ds_write_b32 v4, v33 offset:6864
    ds_write_b32 v4, v57 offset:6868
    ds_write_b32 v4, v25 offset:7128
    ds_write_b32 v4, v73 offset:7132
    ds_write_b32 v4, v41 offset:7392
    ds_write_b32 v4, v53 offset:7396
    ds_write_b32 v4, v21 offset:7656
    ds_write_b32 v4, v69 offset:7660
    ds_write_b32 v4, v37 offset:7920
    ds_write_b32 v4, v61 offset:7924
    ds_write_b32 v4, v29 offset:8184
    ds_write_b32 v4, v77 offset:8188
    s_waitcnt lgkmcnt(0)
    ds_read_b32 v16, v5 offset:0
    ds_read_b32 v48, v5 offset:4
    ds_read_b32 v83, v5 offset:8
    ds_read_b32 v81, v5 offset:12
    ds_read_b32 v80, v5 offset:16
    ds_read_b32 v72, v5 offset:20
    ds_read_b32 v40, v5 offset:24
    ds_read_b32 v60, v5 offset:28
    ds_read_b32 v28, v5 offset:32
    ds_read_b32 v76, v5 offset:36
    ds_read_b32 v44, v5 offset:40
    ds_read_b32 v62, v5 offset:44
    ds_read_b32 v30, v5 offset:48
    ds_read_b32 v54, v5 offset:52
    s_waitcnt lgkmcnt(0)
    ds_read_b32 v22, v5 offset:56
    ds_read_b32 v70, v5 offset:60
    ds_read_b32 v38, v5 offset:64
    ds_read_b32 v78, v5 offset:68
    ds_read_b32 v46, v5 offset:72
    ds_read_b32 v63, v5 offset:76
    ds_read_b32 v31, v5 offset:80
    ds_read_b32 v55, v5 offset:84
    ds_read_b32 v23, v5 offset:88
    ds_read_b32 v71, v5 offset:92
    ds_read_b32 v39, v5 offset:96
    ds_read_b32 v51, v5 offset:100
    ds_read_b32 v19, v5 offset:104
    ds_read_b32 v67, v5 offset:108
    s_waitcnt lgkmcnt(0)
    ds_read_b32 v35, v5 offset:112
    ds_read_b32 v59, v5 offset:116
    ds_read_b32 v27, v5 offset:120
    ds_read_b32 v75, v5 offset:124
    ds_read_b32 v43, v5 offset:128
    ds_read_b32 v79, v5 offset:132
    ds_read_b32 v47, v5 offset:136
    ds_read_b32 v56, v5 offset:140
    ds_read_b32 v24, v5 offset:144
    ds_read_b32 v52, v5 offset:148
    ds_read_b32 v20, v5 offset:152
    ds_read_b32 v68, v5 offset:156
    ds_read_b32 v36, v5 offset:160
    ds_read_b32 v50, v5 offset:164
    s_waitcnt lgkmcnt(0)
    ds_read_b32 v18, v5 offset:168
    ds_read_b32 v66, v5 offset:172
    ds_read_b32 v34, v5 offset:176
    ds_read_b32 v58, v5 offset:180
    ds_read_b32 v26, v5 offset:184
    ds_read_b32 v74, v5 offset:188
    ds_read_b32 v42, v5 offset:192
    ds_read_b32 v49, v5 offset:196
    ds_read_b32 v17, v5 offset:200
    ds_read_b32 v65, v5 offset:204
    ds_read_b32 v33, v5 offset:208
    ds_read_b32 v57, v5 offset:212
    ds_read_b32 v25, v5 offset:216
    ds_read_b32 v73, v5 offset:220
    s_waitcnt lgkmcnt(0)
    ds_read_b32 v41, v5 offset:224
    ds_read_b32 v53, v5 offset:228
    ds_read_b32 v21, v5 offset:232
    ds_read_b32 v69, v5 offset:236
    ds_read_b32 v37, v5 offset:240
    ds_read_b32 v61, v5 offset:244
    ds_read_b32 v29, v5 offset:248
    ds_read_b32 v77, v5 offset:252
    s_waitcnt lgkmcnt(0)
    v_sub_f32 v32, v16, v43
    v_sub_f32 v64, v48, v79
    v_add_f32 v16, v16, v43
    v_add_f32 v48, v48, v79
    v_sub_f32 v43, v83, v47
    v_sub_f32 v79, v81, v56
    v_add_f32 v83, v83, v47
    v_add_f32 v81, v81, v56
    v_mul_f32 v47, 0x3f7b14be, v43
    v_mul_f32 v56, 0xbe47c5c2, v43
    v_fmac_f32 v47, 0x3e47c5c2, v79
    v_fmac_f32 v56, 0x3f7b14be, v79
    v_sub_f32 v43, v80, v24
    v_sub_f32 v79, v72, v52
    v_add_f32 v80, v80, v24
    v_add_f32 v72, v72, v52
    v_mul_f32 v24, 0x3f6c835e, v43
    v_mul_f32 v52, 0xbec3ef15, v43
    v_fmac_f32 v24, 0x3ec3ef15, v79
    v_fmac_f32 v52, 0x3f6c835e, v79
    v_sub_f32 v43, v40, v20
    v_sub_f32 v79, v60, v68
    v_add_f32 v40, v40, v20
    v_add_f32 v60, v60, v68
    v_mul_f32 v20, 0x3f54db31, v43
    v_mul_f32 v68, 0xbf0e39da, v43
    v_fmac_f32 v20, 0x3f0e39da, v79
    v_fmac_f32 v68, 0x3f54db31, v79
    v_sub_f32 v43, v28, v36
    v_sub_f32 v79, v76, v50
    v_add_f32 v28, v28, v36
    v_add_f32 v76, v76, v50
    v_mul_f32 v36, 0x3f3504f3, v43
    v_mul_f32 v50, 0xbf3504f3, v43
    v_fmac_f32 v36, 0x3f3504f3, v79
    v_fmac_f32 v50, 0x3f3504f3, v79
    v_sub_f32 v43, v44, v18
    v_sub_f32 v79, v62, v66
    v_add_f32 v44, v44, v18
    v_add_f32 v62, v62, v66
    v_mul_f32 v18, 0x3f0e39da, v43
    v_mul_f32 v66, 0xbf54db31, v43
    v_fmac_f32 v18, 0x3f54db31, v79
    v_fmac_f32 v66, 0x3f0e39da, v79
    v_sub_f32 v43, v30, v34
    v_sub_f32 v79, v54, v58
    v_add_f32 v30, v30, v34
    v_add_f32 v54, v54, v58
    v_mul_f32 v34, 0x3ec3ef15, v43
    v_mul_f32 v58, 0xbf6c835e, v43
    v_fmac_f32 v34, 0x3f6c835e, v79
    v_fmac_f32 v58, 0x3ec3ef15, v79
    v_sub_f32 v43, v22, v26
    v_sub_f32 v79, v70, v74
    v_add_f32 v22, v22, v26
    v_add_f32 v70, v70, v74
    v_mul_f32 v26, 0x3e47c5c2, v43
    v_mul_f32 v74, 0xbf7b14be, v43
    v_fmac_f32 v26, 0x3f7b14be, v79
    v_fmac_f32 v74, 0x3e47c5c2, v79
    v_sub_f32 v43, v78, v49
    v_sub_f32 v79, v42, v38
    v_add_f32 v38, v38, v42
    v_add_f32 v78, v78, v49
    v_sub_f32 v42, v46, v17
    v_sub_f32 v49, v63, v65
    v_add_f32 v46, v46, v17
    v_add_f32 v63, v63, v65
    v_mul_f32 v17, 0xbe47c5c2, v42
    v_mul_f32 v65, 0xbf7b14be, v42
    v_fmac_f32 v17, 0x3f7b14be, v49
    v_fmac_f32 v65, 0xbe47c5c2, v49
    v_sub_f32 v42, v31, v33
    v_sub_f32 v49, v55, v57
    v_add_f32 v31, v31, v33
    v_add_f32 v55, v55, v57
    v_mul_f32 v33, 0xbec3ef15, v42
    v_mul_f32 v57, 0xbf6c835e, v42
    v_fmac_f32 v33, 0x3f6c835e, v49
    v_fmac_f32 v57, 0xbec3ef15, v49
    v_sub_f32 v42, v23, v25
    v_sub_f32 v49, v71, v73
    v_add_f32 v23, v23, v25
    v_add_f32 v71, v71, v73
    v_mul_f32 v25, 0xbf0e39da, v42
    v_mul_f32 v73, 0xbf54db31, v42
    v_fmac_f32 v25, 0x3f54db31, v49
    v_fmac_f32 v73, 0xbf0e39da, v49
    v_sub_f32 v42, v39, v41
    v_sub_f32 v49, v51, v53
    v_add_f32 v39, v39, v41
    v_add_f32 v51, v51, v53
    v_mul_f32 v41, 0xbf3504f3, v42
    v_mul_f32 v53, 0xbf3504f3, v42
    v_fmac_f32 v41, 0x3f3504f3, v49
    v_fmac_f32 v53, 0xbf3504f3, v49
    v_sub_f32 v42, v19, v21
    v_sub_f32 v49, v67, v69
    v_add_f32 v19, v19, v21
    v_add_f32 v67, v67, v69
    v_mul_f32 v21, 0xbf54db31, v42
    v_mul_f32 v69, 0xbf0e39da, v42
    v_fmac_f32 v21, 0x3f0e39da, v49
    v_fmac_f32 v69, 0xbf54db31, v49
    v_sub_f32 v42, v35, v37
    v_sub_f32 v49, v59, v61
    v_add_f32 v35, v35, v37
    v_add_f32 v59, v59, v61
    v_mul_f32 v37, 0xbf6c835e, v42
    v_mul_f32 v61, 0xbec3ef15, v42
    v_fmac_f32 v37, 0x3ec3ef15, v49
    v_fmac_f32 v61, 0xbf6c835e, v49
    v_sub_f32 v42, v27, v29
    v_sub_f32 v49, v75, v77
    v_add_f32 v27, v27, v29
    v_add_f32 v75, v75, v77
    v_mul_f32 v29, 0xbf7b14be, v42
    v_mul_f32 v77, 0xbe47c5c2, v42
    v_fmac_f32 v29, 0x3e47c5c2, v49
    v_fmac_f32 v77, 0xbf7b14be, v49
    v_sub_f32 v42, v16, v38
    v_sub_f32 v49, v48, v78
    v_add_f32 v16, v16, v38
    v_add_f32 v48, v48, v78
    v_sub_f32 v38, v83, v46
    v_sub_f32 v78, v81, v63
    v_add_f32 v83, v83, v46
    v_add_f32 v81, v81, v63
    v_mul_f32 v46, 0x3f6c835e, v38
    v_mul_f32 v63, 0xbec3ef15, v38
    v_fmac_f32 v46, 0x3ec3ef15, v78
    v_fmac_f32 v63, 0x3f6c835e, v78
    v_sub_f32 v38, v80, v31
    v_sub_f32 v78, v72, v55
    v_add_f32 v80, v80, v31
    v_add_f32 v72, v72, v55
    v_mul_f32 v31, 0x3f3504f3, v38
    v_mul_f32 v55, 0xbf3504f3, v38
    v_fmac_f32 v31, 0x3f3504f3, v78
    v_fmac_f32 v55, 0x3f3504f3, v78
    v_sub_f32 v38, v40, v23
    v_sub_f32 v78, v60, v71
    v_add_f32 v40, v40, v23
    v_add_f32 v60, v60, v71
    v_mul_f32 v23, 0x3ec3ef15, v38
    v_mul_f32 v71, 0xbf6c835e, v38
    v_fmac_f32 v23, 0x3f6c835e, v78
    v_fmac_f32 v71, 0x3ec3ef15, v78
    v_sub_f32 v38, v76, v51
    v_sub_f32 v78, v39, v28
    v_add_f32 v28, v28, v39
    v_add_f32 v76, v76, v51
    v_sub_f32 v39, v44, v19
    v_sub_f32 v51, v62, v67
    v_add_f32 v44, v44, v19
    v_add_f32 v62, v62, v67
    v_mul_f32 v19, 0xbec3ef15, v39
    v_mul_f32 v67, 0xbf6c835e, v39
    v_fmac_f32 v19, 0x3f6c835e, v51
    v_fmac_f32 v67, 0xbec3ef15, v51
    v_sub_f32 v39, v30, v35
    v_sub_f32 v51, v54, v59
    v_add_f32 v30, v30, v35
    v_add_f32 v54, v54, v59
    v_mul_f32 v35, 0xbf3504f3, v39
    v_mul_f32 v59, 0xbf3504f3, v39
    v_fmac_f32 v35, 0x3f3504f3, v51
    v_fmac_f32 v59, 0xbf3504f3, v51
    v_sub_f32 v39, v22, v27
    v_sub_f32 v51, v70, v75
    v_add_f32 v22, v22, v27
    v_add_f32 v70, v70, v75
    v_mul_f32 v27, 0xbf6c835e, v39
    v_mul_f32 v75, 0xbec3ef15, v39
    v_fmac_f32 v27, 0x3ec3ef15, v51
    v_fmac_f32 v75, 0xbf6c835e, v51
    v_sub_f32 v39, v32, v43
    v_sub_f32 v51, v64, v79
    v_add_f32 v32, v32, v43
    v_add_f32 v64, v64, v79
    v_sub_f32 v43, v47, v17
    v_sub_f32 v79, v56, v65
    v_add_f32 v47, v47, v17
    v_add_f32 v56, v56, v65
    v_mul_f32 v17, 0x3f6c835e, v43
    v_mul_f32 v65, 0xbec3ef15, v43
    v_fmac_f32 v17, 0x3ec3ef15, v79
    v_fmac_f32 v65, 0x3f6c835e, v79
    v_sub_f32 v43, v24, v33
    v_sub_f32 v79, v52, v57
    v_add_f32 v24, v24, v33
    v_add_f32 v52, v52, v57
    v_mul_f32 v33, 0x3f3504f3, v43
    v_mul_f32 v57, 0xbf3504f3, v43
    v_fmac_f32 v33, 0x3f3504f3, v79
    v_fmac_f32 v57, 0x3f3504f3, v79
    v_sub_f32 v43, v20, v25
    v_sub_f32 v79, v68, v73
    v_add_f32 v20, v20, v25
    v_add_f32 v68, v68, v73
    v_mul_f32 v25, 0x3ec3ef15, v43
    v_mul_f32 v73, 0xbf6c835e, v43
    v_fmac_f32 v25, 0x3f6c835e, v79
    v_fmac_f32 v73, 0x3ec3ef15, v79
    v_sub_f32 v43, v50, v53
    v_sub_f32 v79, v41, v36
    v_add_f32 v36, v36, v41
    v_add_f32 v50, v50, v53
    v_sub_f32 v41, v18, v21
    v_sub_f32 v53, v66, v69
    v_add_f32 v18, v18, v21
    v_add_f32 v66, v66, v69
    v_mul_f32 v21, 0xbec3ef15, v41
    v_mul_f32 v69, 0xbf6c835e, v41
    v_fmac_f32 v21, 0x3f6c835e, v53
    v_fmac_f32 v69, 0xbec3ef15, v53
    v_sub_f32 v41, v34, v37
    v_sub_f32 v53, v58, v61
    v_add_f32 v34, v34, v37
    v_add_f32 v58, v58, v61
    v_mul_f32 v37, 0xbf3504f3, v41
    v_mul_f32 v61, 0xbf3504f3, v41
    v_fmac_f32 v37, 0x3f3504f3, v53
    v_fmac_f32 v61, 0xbf3504f3, v53
    v_sub_f32 v41, v26, v29
    v_sub_f32 v53, v74, v77
    v_add_f32 v26, v26, v29
    v_add_f32 v74, v74, v77
    v_mul_f32 v29, 0xbf6c835e, v41
    v_mul_f32 v77, 0xbec3ef15, v41
    v_fmac_f32 v29, 0x3ec3ef15, v53
    v_fmac_f32 v77, 0xbf6c835e, v53
    v_sub_f32 v41, v16, v28
    v_sub_f32 v53, v48, v76
    v_add_f32 v16, v16, v28
    v_add_f32 v48, v48, v76
    v_sub_f32 v28, v83, v44
    v_sub_f32 v76, v81, v62
    v_add_f32 v83, v83, v44
    v_add_f32 v81, v81, v62
    v_mul_f32 v44, 0x3f3504f3, v28
    v_mul_f32 v62, 0xbf3504f3, v28
    v_fmac_f32 v44, 0x3f3504f3, v76
    v_fmac_f32 v62, 0x3f3504f3, v76
    v_sub_f32 v28, v72, v54
    v_sub_f32 v76, v30, v80
    v_add_f32 v80, v80, v30
    v_add_f32 v72, v72, v54
    v_sub_f32 v30, v40, v22
    v_sub_f32 v54, v60, v70
    v_add_f32 v40, v40, v22
    v_add_f32 v60, v60, v70
    v_mul_f32 v22, 0xbf3504f3, v30
    v_mul_f32 v70, 0xbf3504f3, v30
    v_fmac_f32 v22, 0x3f3504f3, v54
    v_fmac_f32 v70, 0xbf3504f3, v54
    v_sub_f32 v30, v42, v38
    v_sub_f32 v54, v49, v78
    v_add_f32 v42, v42, v38
    v_add_f32 v49, v49, v78
    v_sub_f32 v38, v46, v19
    v_sub_f32 v78, v63, v67
    v_add_f32 v46, v46, v19
    v_add_f32 v63, v63, v67
    v_mul_f32 v19, 0x3f3504f3, v38
    v_mul_f32 v67, 0xbf3504f3, v38
    v_fmac_f32 v19, 0x3f3504f3, v78
    v_fmac_f32 v67, 0x3f3504f3, v78
    v_sub_f32 v38, v55, v59
    v_sub_f32 v78, v35, v31
    v_add_f32 v31, v31, v35
    v_add_f32 v55, v55, v59
    v_sub_f32 v35, v23, v27
    v_sub_f32 v59, v71, v75
    v_add_f32 v23, v23, v27
    v_add_f32 v71, v71, v75
    v_mul_f32 v27, 0xbf3504f3, v35
    v_mul_f32 v75, 0xbf3504f3, v35
    v_fmac_f32 v27, 0x3f3504f3, v59
    v_fmac_f32 v75, 0xbf3504f3, v59
    v_sub_f32 v35, v32, v36
    v_sub_f32 v59, v64, v50
    v_add_f32 v32, v32, v36
    v_add_f32 v64, v64, v50
    v_sub_f32 v36, v47, v18
    v_sub_f32 v50, v56, v66
    v_add_f32 v47, v47, v18
    v_add_f32 v56, v56, v66
    v_mul_f32 v18, 0x3f3504f3, v36
    v_mul_f32 v66, 0xbf3504f3, v36
    v_fmac_f32 v18, 0x3f3504f3, v50
    v_fmac_f32 v66, 0x3f3504f3, v50
    v_sub_f32 v36, v52, v58
    v_sub_f32 v50, v34, v24
    v_add_f32 v24, v24, v34
    v_add_f32 v52, v52, v58
    v_sub_f32 v34, v20, v26
    v_sub_f32 v58, v68, v74
    v_add_f32 v20, v20, v26
    v_add_f32 v68, v68, v74
    v_mul_f32 v26, 0xbf3504f3, v34
    v_mul_f32 v74, 0xbf3504f3, v34
    v_fmac_f32 v26, 0x3f3504f3, v58
    v_fmac_f32 v74, 0xbf3504f3, v58
    v_sub_f32 v34, v39, v43
    v_sub_f32 v58, v51, v79
    v_add_f32 v39, v39, v43
    v_add_f32 v51, v51, v79
    v_sub_f32 v43, v17, v21
    v_sub_f32 v79, v65, v69
    v_add_f32 v17, v17, v21
    v_add_f32 v65, v65, v69
    v_mul_f32 v21, 0x3f3504f3, v43
    v_mul_f32 v69, 0xbf3504f3, v43
    v_fmac_f32 v21, 0x3f3504f3, v79
    v_fmac_f32 v69, 0x3f3504f3, v79
    v_sub_f32 v43, v57, v61
    v_sub_f32 v79, v37, v33
    v_add_f32 v33, v33, v37
    v_add_f32 v57, v57, v61
    v_sub_f32 v37, v25, v29
    v_sub_f32 v61, v73, v77
    v_add_f32 v25, v25, v29
    v_add_f32 v73, v73, v77
    v_mul_f32 v29, 0xbf3504f3, v37
    v_mul_f32 v77, 0xbf3504f3, v37
    v_fmac_f32 v29, 0x3f3504f3, v61
    v_fmac_f32 v77, 0xbf3504f3, v61
    v_sub_f32 v37, v16, v80
    v_sub_f32 v61, v48, v72
    v_add_f32 v16, v16, v80
    v_add_f32 v48, v48, v72
    v_sub_f32 v80, v81, v60
    v_sub_f32 v72, v40, v83
    v_add_f32 v83, v83, v40
    v_add_f32 v81, v81, v60
    v_sub_f32 v40, v41, v28
    v_sub_f32 v60, v53, v76
    v_add_f32 v41, v41, v28
    v_add_f32 v53, v53, v76
    v_sub_f32 v28, v62, v70
    v_sub_f32 v76, v22, v44
    v_add_f32 v44, v44, v22
    v_add_f32 v62, v62, v70
    v_sub_f32 v22, v42, v31
    v_sub_f32 v70, v49, v55
    v_add_f32 v42, v42, v31
    v_add_f32 v49, v49, v55
    v_sub_f32 v31, v63, v71
    v_sub_f32 v55, v23, v46
    v_add_f32 v46, v46, v23
    v_add_f32 v63, v63, v71
    v_sub_f32 v23, v30, v38
    v_sub_f32 v71, v54, v78
    v_add_f32 v30, v30, v38
    v_add_f32 v54, v54, v78
    v_sub_f32 v38, v67, v75
    v_sub_f32 v78, v27, v19
    v_add_f32 v19, v19, v27
    v_add_f32 v67, v67, v75
    v_sub_f32 v27, v32, v24
    v_sub_f32 v75, v64, v52
    v_add_f32 v32, v32, v24
    v_add_f32 v64, v64, v52
    v_sub_f32 v24, v56, v68
    v_sub_f32 v52, v20, v47
    v_add_f32 v47, v47, v20
    v_add_f32 v56, v56, v68
    v_sub_f32 v20, v35, v36
    v_sub_f32 v68, v59, v50
    v_add_f32 v35, v35, v36
    v_add_f32 v59, v59, v50
    v_sub_f32 v36, v66, v74
    v_sub_f32 v50, v26, v18
    v_add_f32 v18, v18, v26
    v_add_f32 v66, v66, v74
    v_sub_f32 v26, v39, v33
    v_sub_f32 v74, v51, v57
    v_add_f32 v39, v39, v33
    v_add_f32 v51, v51, v57
    v_sub_f32 v33, v65, v73
    v_sub_f32 v57, v25, v17
    v_add_f32 v17, v17, v25
    v_add_f32 v65, v65, v73
    v_sub_f32 v25, v34, v43
    v_sub_f32 v73, v58, v79
    v_add_f32 v34, v34, v43
    v_add_f32 v58, v58, v79
    v_sub_f32 v43, v69, v77
    v_sub_f32 v79, v29, v21
    v_add_f32 v21, v21, v29
    v_add_f32 v69, v69, v77
    v_sub_f32 v29, v16, v83
    v_sub_f32 v77, v48, v81
    v_add_f32 v16, v16, v83
    v_add_f32 v48, v48, v81
    v_sub_f32 v83, v37, v80
    v_sub_f32 v81, v61, v72
    v_add_f32 v37, v37, v80
    v_add_f32 v61, v61, v72
    v_sub_f32 v80, v41, v44
    v_sub_f32 v72, v53, v62
    v_add_f32 v41, v41, v44
    v_add_f32 v53, v53, v62
    v_sub_f32 v44, v40, v28
    v_sub_f32 v62, v60, v76
    v_add_f32 v40, v40, v28
    v_add_f32 v60, v60, v76
    v_sub_f32 v28, v42, v46
    v_sub_f32 v76, v49, v63
    v_add_f32 v42, v42, v46
    v_add_f32 v49, v49, v63
    v_sub_f32 v46, v22, v31
    v_sub_f32 v63, v70, v55
    v_add_f32 v22, v22, v31
    v_add_f32 v70, v70, v55
    v_sub_f32 v31, v30, v19
    v_sub_f32 v55, v54, v67
    v_add_f32 v30, v30, v19
    v_add_f32 v54, v54, v67
    v_sub_f32 v19, v23, v38
    v_sub_f32 v67, v71, v78
    v_add_f32 v23, v23, v38
    v_add_f32 v71, v71, v78
    v_sub_f32 v38, v32, v47
    v_sub_f32 v78, v64, v56
    v_add_f32 v32, v32, v47
    v_add_f32 v64, v64, v56
    v_sub_f32 v47, v27, v24
    v_sub_f32 v56, v75, v52
    v_add_f32 v27, v27, v24
    v_add_f32 v75, v75, v52
    v_sub_f32 v24, v35, v18
    v_sub_f32 v52, v59, v66
    v_add_f32 v35, v35, v18
    v_add_f32 v59, v59, v66
    v_sub_f32 v18, v20, v36
    v_sub_f32 v66, v68, v50
    v_add_f32 v20, v20, v36
    v_add_f32 v68, v68, v50
    v_sub_f32 v36, v39, v17
    v_sub_f32 v50, v51, v65
    v_add_f32 v39, v39, v17
    v_add_f32 v51, v51, v65
    v_sub_f32 v17, v26, v33
    v_sub_f32 v65, v74, v57
    v_add_f32 v26, v26, v33
    v_add_f32 v74, v74, v57
    v_sub_f32 v33, v34, v21
    v_sub_f32 v57, v58, v69
    v_add_f32 v34, v34, v21
    v_add_f32 v58, v58, v69
    v_sub_f32 v21, v25, v43
    v_sub_f32 v69, v73, v79
    v_add_f32 v25, v25, v43
    v_add_f32 v73, v73, v79
    ds_write_b32 v4, v16 offset:0
    ds_write_b32 v4, v48 offset:4
    ds_write_b32 v4, v32 offset:256
    ds_write_b32 v4, v64 offset:260
    ds_write_b32 v4, v42 offset:512
    ds_write_b32 v4, v49 offset:516
    ds_write_b32 v4, v39 offset:768
    ds_write_b32 v4, v51 offset:772
    ds_write_b32 v4, v41 offset:1024
    ds_write_b32 v4, v53 offset:1028
    ds_write_b32 v4, v35 offset:1280
    ds_write_b32 v4, v59 offset:1284
    ds_write_b32 v4, v30 offset:1536
    ds_write_b32 v4, v54 offset:1540
    ds_write_b32 v4, v34 offset:1792
    ds_write_b32 v4, v58 offset:1796
    ds_write_b32 v4, v37 offset:2048
    ds_write_b32 v4, v61 offset:2052
    ds_write_b32 v4, v27 offset:2304
    ds_write_b32 v4, v75 offset:2308
    ds_write_b32 v4, v22 offset:2560
    ds_write_b32 v4, v70 offset:2564
    ds_write_b32 v4, v26 offset:2816
    ds_write_b32 v4, v74 offset:2820
    ds_write_b32 v4, v40 offset:3072
    ds_write_b32 v4, v60 offset:3076
    ds_write_b32 v4, v20 offset:3328
    ds_write_b32 v4, v68 offset:3332
    ds_write_b32 v4, v23 offset:3584
    ds_write_b32 v4, v71 offset:3588
    ds_write_b32 v4, v25 offset:3840
    ds_write_b32 v4, v73 offset:3844
    ds_write_b32 v4, v29 offset:4096
    ds_write_b32 v4, v77 offset:4100
    ds_write_b32 v4, v38 offset:4352
    ds_write_b32 v4, v78 offset:4356
    ds_write_b32 v4, v28 offset:4608
    ds_write_b32 v4, v76 offset:4612
    ds_write_b32 v4, v36 offset:4864
    ds_write_b32 v4, v50 offset:4868
    ds_write_b32 v4, v80 offset:5120
    ds_write_b32 v4, v72 offset:5124
    ds_write_b32 v4, v24 offset:5376
    ds_write_b32 v4, v52 offset:5380
    ds_write_b32 v4, v31 offset:5632
    ds_write_b32 v4, v55 offset:5636
    ds_write_b32 v4, v33 offset:5888
    ds_write_b32 v4, v57 offset:5892
    ds_write_b32 v4, v83 offset:6144
    ds_write_b32 v4, v81 offset:6148
    ds_write_b32 v4, v47 offset:6400
    ds_write_b32 v4, v56 offset:6404
    ds_write_b32 v4, v46 offset:6656
    ds_write_b32 v4, v63 offset:6660
    ds_write_b32 v4, v17 offset:6912
    ds_write_b32 v4, v65 offset:6916
    ds_write_b32 v4, v44 offset:7168
    ds_write_b32 v4, v62 offset:7172
    ds_write_b32 v4, v18 offset:7424
    ds_write_b32 v4, v66 offset:7428
    ds_write_b32 v4, v19 offset:7680
    ds_write_b32 v4, v67 offset:7684
    ds_write_b32 v4, v21 offset:7936
    ds_write_b32 v4, v69 offset:7940
    s_waitcnt lgkmcnt(0)
    s_barrier
    v_and_b32 v6, 7, v0
    v_lshrrev_b32 v7, 3, v0
    s_movk_i32 s13, 8448
    v_mul_lo_u32 v8, v6, s13
    v_lshl_add_u32 v4, v7, 3, v8
    v_lshlrev_b32 v5, 14, v7
    v_lshl_add_u32 v5, v6, 4, v5
    s_lshl_b32 s12, s92, 7
    s_add_u32 s12, s12, 96468992
    v_sub_u32 v6, 1024, v7
    v_and_b32 v6, 1023, v6
    v_lshl_add_u32 v6, v6, 3, v8
    ds_read_b64 v[16:17], v4 offset:0
    ds_read_b64 v[18:19], v6
    s_waitcnt lgkmcnt(0)
    v_add_f32 v20, v16, v18
    v_sub_f32 v21, v17, v19
    v_add_f32 v22, v17, v19
    v_sub_f32 v23, v18, v16
    s_mov_b32 s13, s12
    s_add_u32 s13, s12, 0
    buffer_store_dwordx4 v[20:23], v5, s[8:11], s13 offen sc1
    s_nop 1
    v_sub_u32 v6, 992, v7
    v_and_b32 v6, 1023, v6
    v_lshl_add_u32 v6, v6, 3, v8
    ds_read_b64 v[16:17], v4 offset:256
    ds_read_b64 v[18:19], v6
    s_waitcnt lgkmcnt(0)
    v_add_f32 v20, v16, v18
    v_sub_f32 v21, v17, v19
    v_add_f32 v22, v17, v19
    v_sub_f32 v23, v18, v16
    s_mov_b32 s13, s12
    s_add_u32 s13, s12, 524288
    buffer_store_dwordx4 v[20:23], v5, s[8:11], s13 offen sc1
    s_nop 1
    v_sub_u32 v6, 960, v7
    v_and_b32 v6, 1023, v6
    v_lshl_add_u32 v6, v6, 3, v8
    ds_read_b64 v[16:17], v4 offset:512
    ds_read_b64 v[18:19], v6
    s_waitcnt lgkmcnt(0)
    v_add_f32 v20, v16, v18
    v_sub_f32 v21, v17, v19
    v_add_f32 v22, v17, v19
    v_sub_f32 v23, v18, v16
    s_mov_b32 s13, s12
    s_add_u32 s13, s12, 1048576
    buffer_store_dwordx4 v[20:23], v5, s[8:11], s13 offen sc1
    s_nop 1
    v_sub_u32 v6, 928, v7
    v_and_b32 v6, 1023, v6
    v_lshl_add_u32 v6, v6, 3, v8
    ds_read_b64 v[16:17], v4 offset:768
    ds_read_b64 v[18:19], v6
    s_waitcnt lgkmcnt(0)
    v_add_f32 v20, v16, v18
    v_sub_f32 v21, v17, v19
    v_add_f32 v22, v17, v19
    v_sub_f32 v23, v18, v16
    s_mov_b32 s13, s12
    s_add_u32 s13, s12, 1572864
    buffer_store_dwordx4 v[20:23], v5, s[8:11], s13 offen sc1
    s_nop 1
    v_sub_u32 v6, 896, v7
    v_and_b32 v6, 1023, v6
    v_lshl_add_u32 v6, v6, 3, v8
    ds_read_b64 v[16:17], v4 offset:1024
    ds_read_b64 v[18:19], v6
    s_waitcnt lgkmcnt(0)
    v_add_f32 v20, v16, v18
    v_sub_f32 v21, v17, v19
    v_add_f32 v22, v17, v19
    v_sub_f32 v23, v18, v16
    s_mov_b32 s13, s12
    s_add_u32 s13, s12, 2097152
    buffer_store_dwordx4 v[20:23], v5, s[8:11], s13 offen sc1
    s_nop 1
    v_sub_u32 v6, 864, v7
    v_and_b32 v6, 1023, v6
    v_lshl_add_u32 v6, v6, 3, v8
    ds_read_b64 v[16:17], v4 offset:1280
    ds_read_b64 v[18:19], v6
    s_waitcnt lgkmcnt(0)
    v_add_f32 v20, v16, v18
    v_sub_f32 v21, v17, v19
    v_add_f32 v22, v17, v19
    v_sub_f32 v23, v18, v16
    s_mov_b32 s13, s12
    s_add_u32 s13, s12, 2621440
    buffer_store_dwordx4 v[20:23], v5, s[8:11], s13 offen sc1
    s_nop 1
    v_sub_u32 v6, 832, v7
    v_and_b32 v6, 1023, v6
    v_lshl_add_u32 v6, v6, 3, v8
    ds_read_b64 v[16:17], v4 offset:1536
    ds_read_b64 v[18:19], v6
    s_waitcnt lgkmcnt(0)
    v_add_f32 v20, v16, v18
    v_sub_f32 v21, v17, v19
    v_add_f32 v22, v17, v19
    v_sub_f32 v23, v18, v16
    s_mov_b32 s13, s12
    s_add_u32 s13, s12, 3145728
    buffer_store_dwordx4 v[20:23], v5, s[8:11], s13 offen sc1
    s_nop 1
    v_sub_u32 v6, 800, v7
    v_and_b32 v6, 1023, v6
    v_lshl_add_u32 v6, v6, 3, v8
    ds_read_b64 v[16:17], v4 offset:1792
    ds_read_b64 v[18:19], v6
    s_waitcnt lgkmcnt(0)
    v_add_f32 v20, v16, v18
    v_sub_f32 v21, v17, v19
    v_add_f32 v22, v17, v19
    v_sub_f32 v23, v18, v16
    s_mov_b32 s13, s12
    s_add_u32 s13, s12, 3670016
    buffer_store_dwordx4 v[20:23], v5, s[8:11], s13 offen sc1
    s_nop 1
    v_sub_u32 v6, 768, v7
    v_and_b32 v6, 1023, v6
    v_lshl_add_u32 v6, v6, 3, v8
    ds_read_b64 v[16:17], v4 offset:2048
    ds_read_b64 v[18:19], v6
    s_waitcnt lgkmcnt(0)
    v_add_f32 v20, v16, v18
    v_sub_f32 v21, v17, v19
    v_add_f32 v22, v17, v19
    v_sub_f32 v23, v18, v16
    s_mov_b32 s13, s12
    s_add_u32 s13, s12, 4194304
    buffer_store_dwordx4 v[20:23], v5, s[8:11], s13 offen sc1
    s_nop 1
    v_sub_u32 v6, 736, v7
    v_and_b32 v6, 1023, v6
    v_lshl_add_u32 v6, v6, 3, v8
    ds_read_b64 v[16:17], v4 offset:2304
    ds_read_b64 v[18:19], v6
    s_waitcnt lgkmcnt(0)
    v_add_f32 v20, v16, v18
    v_sub_f32 v21, v17, v19
    v_add_f32 v22, v17, v19
    v_sub_f32 v23, v18, v16
    s_mov_b32 s13, s12
    s_add_u32 s13, s12, 4718592
    buffer_store_dwordx4 v[20:23], v5, s[8:11], s13 offen sc1
    s_nop 1
    v_sub_u32 v6, 704, v7
    v_and_b32 v6, 1023, v6
    v_lshl_add_u32 v6, v6, 3, v8
    ds_read_b64 v[16:17], v4 offset:2560
    ds_read_b64 v[18:19], v6
    s_waitcnt lgkmcnt(0)
    v_add_f32 v20, v16, v18
    v_sub_f32 v21, v17, v19
    v_add_f32 v22, v17, v19
    v_sub_f32 v23, v18, v16
    s_mov_b32 s13, s12
    s_add_u32 s13, s12, 5242880
    buffer_store_dwordx4 v[20:23], v5, s[8:11], s13 offen sc1
    s_nop 1
    v_sub_u32 v6, 672, v7
    v_and_b32 v6, 1023, v6
    v_lshl_add_u32 v6, v6, 3, v8
    ds_read_b64 v[16:17], v4 offset:2816
    ds_read_b64 v[18:19], v6
    s_waitcnt lgkmcnt(0)
    v_add_f32 v20, v16, v18
    v_sub_f32 v21, v17, v19
    v_add_f32 v22, v17, v19
    v_sub_f32 v23, v18, v16
    s_mov_b32 s13, s12
    s_add_u32 s13, s12, 5767168
    buffer_store_dwordx4 v[20:23], v5, s[8:11], s13 offen sc1
    s_nop 1
    v_sub_u32 v6, 640, v7
    v_and_b32 v6, 1023, v6
    v_lshl_add_u32 v6, v6, 3, v8
    ds_read_b64 v[16:17], v4 offset:3072
    ds_read_b64 v[18:19], v6
    s_waitcnt lgkmcnt(0)
    v_add_f32 v20, v16, v18
    v_sub_f32 v21, v17, v19
    v_add_f32 v22, v17, v19
    v_sub_f32 v23, v18, v16
    s_mov_b32 s13, s12
    s_add_u32 s13, s12, 6291456
    buffer_store_dwordx4 v[20:23], v5, s[8:11], s13 offen sc1
    s_nop 1
    v_sub_u32 v6, 608, v7
    v_and_b32 v6, 1023, v6
    v_lshl_add_u32 v6, v6, 3, v8
    ds_read_b64 v[16:17], v4 offset:3328
    ds_read_b64 v[18:19], v6
    s_waitcnt lgkmcnt(0)
    v_add_f32 v20, v16, v18
    v_sub_f32 v21, v17, v19
    v_add_f32 v22, v17, v19
    v_sub_f32 v23, v18, v16
    s_mov_b32 s13, s12
    s_add_u32 s13, s12, 6815744
    buffer_store_dwordx4 v[20:23], v5, s[8:11], s13 offen sc1
    s_nop 1
    v_sub_u32 v6, 576, v7
    v_and_b32 v6, 1023, v6
    v_lshl_add_u32 v6, v6, 3, v8
    ds_read_b64 v[16:17], v4 offset:3584
    ds_read_b64 v[18:19], v6
    s_waitcnt lgkmcnt(0)
    v_add_f32 v20, v16, v18
    v_sub_f32 v21, v17, v19
    v_add_f32 v22, v17, v19
    v_sub_f32 v23, v18, v16
    s_mov_b32 s13, s12
    s_add_u32 s13, s12, 7340032
    buffer_store_dwordx4 v[20:23], v5, s[8:11], s13 offen sc1
    s_nop 1
    v_sub_u32 v6, 544, v7
    v_and_b32 v6, 1023, v6
    v_lshl_add_u32 v6, v6, 3, v8
    ds_read_b64 v[16:17], v4 offset:3840
    ds_read_b64 v[18:19], v6
    s_waitcnt lgkmcnt(0)
    v_add_f32 v20, v16, v18
    v_sub_f32 v21, v17, v19
    v_add_f32 v22, v17, v19
    v_sub_f32 v23, v18, v16
    s_mov_b32 s13, s12
    s_add_u32 s13, s12, 7864320
    buffer_store_dwordx4 v[20:23], v5, s[8:11], s13 offen sc1
    s_nop 1
    v_sub_u32 v6, 512, v7
    v_and_b32 v6, 1023, v6
    v_lshl_add_u32 v6, v6, 3, v8
    ds_read_b64 v[16:17], v4 offset:4096
    ds_read_b64 v[18:19], v6
    s_waitcnt lgkmcnt(0)
    v_add_f32 v20, v16, v18
    v_sub_f32 v21, v17, v19
    v_add_f32 v22, v17, v19
    v_sub_f32 v23, v18, v16
    s_mov_b32 s13, s12
    v_cmp_eq_u32 vcc, 0, v7
    s_and_saveexec_b64 s[14:15], vcc
    s_add_u32 s13, s12, 8388608
    buffer_store_dwordx4 v[20:23], v5, s[8:11], s13 offen sc1
    s_nop 1
    s_mov_b64 exec, -1
mega_kernel_f1d:
    s_waitcnt vmcnt(0)
    s_barrier
    v_mov_b32 v2, 1
    v_cmp_eq_u32 vcc, 0, v0
    s_and_saveexec_b64 s[80:81], vcc
    s_cbranch_execz mega_kernel_sg72_4
    buffer_atomic_add v2, off, s[88:91], 0 offset:72 sc1
mega_kernel_sg72_4:
    s_mov_b64 exec, s[80:81]
    s_waitcnt vmcnt(0)
    ds_read_b64_tr_b16 a[0:1], v201 offset:0
    ds_read_b64_tr_b16 a[2:3], v201 offset:256
    ds_read_b64_tr_b16 a[4:5], v201 offset:1024
    ds_read_b64_tr_b16 a[6:7], v201 offset:1280
    ds_read_b64_tr_b16 a[8:9], v201 offset:2048
    ds_read_b64_tr_b16 a[10:11], v201 offset:2304
    ds_read_b64_tr_b16 a[12:13], v201 offset:3072
    ds_read_b64_tr_b16 a[14:15], v201 offset:3328
    s_waitcnt lgkmcnt(0)
    ds_read_b64_tr_b16 a[16:17], v201 offset:4096
    ds_read_b64_tr_b16 a[18:19], v201 offset:4352
    ds_read_b64_tr_b16 a[20:21], v201 offset:5120
    ds_read_b64_tr_b16 a[22:23], v201 offset:5376
    ds_read_b64_tr_b16 a[24:25], v201 offset:6144
    ds_read_b64_tr_b16 a[26:27], v201 offset:6400
    ds_read_b64_tr_b16 a[28:29], v201 offset:7168
    ds_read_b64_tr_b16 a[30:31], v201 offset:7424
    s_waitcnt lgkmcnt(0)
    ds_read_b64_tr_b16 a[32:33], v201 offset:8192
    ds_read_b64_tr_b16 a[34:35], v201 offset:8448
    ds_read_b64_tr_b16 a[36:37], v201 offset:9216
    ds_read_b64_tr_b16 a[38:39], v201 offset:9472
    ds_read_b64_tr_b16 a[40:41], v201 offset:10240
    ds_read_b64_tr_b16 a[42:43], v201 offset:10496
    ds_read_b64_tr_b16 a[44:45], v201 offset:11264
    ds_read_b64_tr_b16 a[46:47], v201 offset:11520
    s_waitcnt lgkmcnt(0)
    ds_read_b64_tr_b16 a[48:49], v201 offset:12288
    ds_read_b64_tr_b16 a[50:51], v201 offset:12544
    ds_read_b64_tr_b16 a[52:53], v201 offset:13312
    ds_read_b64_tr_b16 a[54:55], v201 offset:13568
    ds_read_b64_tr_b16 a[56:57], v201 offset:14336
    ds_read_b64_tr_b16 a[58:59], v201 offset:14592
    ds_read_b64_tr_b16 a[60:61], v201 offset:15360
    ds_read_b64_tr_b16 a[62:63], v201 offset:15616
    s_waitcnt lgkmcnt(0)
    s_add_u32 m0, s56, 0
    s_add_u32 s58, s57, 16384
    s_and_b32 s58, s58, 0xffff
    s_lshl_b32 s58, s58, 5
    buffer_load_dwordx4 v200, s[52:55], s58 offen lds
    s_add_u32 m0, s56, 1024
    s_add_u32 s58, s57, 17408
    s_and_b32 s58, s58, 0xffff
    s_lshl_b32 s58, s58, 5
    buffer_load_dwordx4 v200, s[52:55], s58 offen lds
    s_add_u32 m0, s56, 2048
    s_add_u32 s58, s57, 18432
    s_and_b32 s58, s58, 0xffff
    s_lshl_b32 s58, s58, 5
    buffer_load_dwordx4 v200, s[52:55], s58 offen lds
    s_add_u32 m0, s56, 3072
    s_add_u32 s58, s57, 19456
    s_and_b32 s58, s58, 0xffff
    s_lshl_b32 s58, s58, 5
    buffer_load_dwordx4 v200, s[52:55], s58 offen lds
    s_add_u32 m0, s56, 4096
    s_add_u32 s58, s57, 20480
    s_and_b32 s58, s58, 0xffff
    s_lshl_b32 s58, s58, 5
    buffer_load_dwordx4 v200, s[52:55], s58 offen lds
    s_add_u32 m0, s56, 5120
    s_add_u32 s58, s57, 21504
    s_and_b32 s58, s58, 0xffff
    s_lshl_b32 s58, s58, 5
    buffer_load_dwordx4 v200, s[52:55], s58 offen lds
    s_add_u32 m0, s56, 6144
    s_add_u32 s58, s57, 22528
    s_and_b32 s58, s58, 0xffff
    s_lshl_b32 s58, s58, 5
    buffer_load_dwordx4 v200, s[52:55], s58 offen lds
    s_add_u32 m0, s56, 7168
    s_add_u32 s58, s57, 23552
    s_and_b32 s58, s58, 0xffff
    s_lshl_b32 s58, s58, 5
    buffer_load_dwordx4 v200, s[52:55], s58 offen lds
    s_add_u32 m0, s56, 8192
    s_add_u32 s58, s57, 24576
    s_and_b32 s58, s58, 0xffff
    s_lshl_b32 s58, s58, 5
    buffer_load_dwordx4 v200, s[52:55], s58 offen lds
    s_add_u32 m0, s56, 9216
    s_add_u32 s58, s57, 25600
    s_and_b32 s58, s58, 0xffff
    s_lshl_b32 s58, s58, 5
    buffer_load_dwordx4 v200, s[52:55], s58 offen lds
    s_add_u32 m0, s56, 10240
    s_add_u32 s58, s57, 26624
    s_and_b32 s58, s58, 0xffff
    s_lshl_b32 s58, s58, 5
    buffer_load_dwordx4 v200, s[52:55], s58 offen lds
    s_add_u32 m0, s56, 11264
    s_add_u32 s58, s57, 27648
    s_and_b32 s58, s58, 0xffff
    s_lshl_b32 s58, s58, 5
    buffer_load_dwordx4 v200, s[52:55], s58 offen lds
    s_add_u32 m0, s56, 12288
    s_add_u32 s58, s57, 28672
    s_and_b32 s58, s58, 0xffff
    s_lshl_b32 s58, s58, 5
    buffer_load_dwordx4 v200, s[52:55], s58 offen lds
    s_add_u32 m0, s56, 13312
    s_add_u32 s58, s57, 29696
    s_and_b32 s58, s58, 0xffff
    s_lshl_b32 s58, s58, 5
    buffer_load_dwordx4 v200, s[52:55], s58 offen lds
    s_add_u32 m0, s56, 14336
    s_add_u32 s58, s57, 30720
    s_and_b32 s58, s58, 0xffff
    s_lshl_b32 s58, s58, 5
    buffer_load_dwordx4 v200, s[52:55], s58 offen lds
    s_add_u32 m0, s56, 15360
    s_add_u32 s58, s57, 31744
    s_and_b32 s58, s58, 0xffff
    s_lshl_b32 s58, s58, 5
    buffer_load_dwordx4 v200, s[52:55], s58 offen lds
    s_cmp_ge_u32 s92, 128
    s_cbranch_scc1 mega_kernel_xo
mega_kernel_wf1:
    s_sleep 8
    buffer_load_dword v2, off, s[88:91], 0 offset:72 sc1
    s_waitcnt vmcnt(0)
    v_cmp_ne_u32 vcc, 192, v2
    s_cbranch_vccnz mega_kernel_wf1
    s_mov_b32 s99, s92
    s_barrier
mega_kernel_f2_in:
    s_load_dwordx2 s[8:9], s[0:1], 96
    v_lshrrev_b32 v5, 6, v0
    v_and_b32 v1, 63, v0
    v_readfirstlane_b32 s12, v5
    s_lshl_b32 s13, s99, 2
    s_add_u32 s13, s13, s12
    s_cmp_ge_u32 s13, 513
    s_cbranch_scc1 mega_kernel_f2_end
    v_cvt_f32_u32 v2, v1
    s_waitcnt lgkmcnt(0)
    s_mov_b32 s10, 268435456
    s_mov_b32 s11, 0x00020000
    s_lshl_b32 s14, s13, 14
    s_add_u32 s15, s14, 96468992
    v_lshlrev_b32 v5, 3, v1
    s_add_u32 s16, s15, 0
    buffer_load_dwordx2 v[16:17], v5, s[8:11], s16 offen
    s_add_u32 s16, s15, 512
    buffer_load_dwordx2 v[18:19], v5, s[8:11], s16 offen
    s_add_u32 s16, s15, 1024
    buffer_load_dwordx2 v[20:21], v5, s[8:11], s16 offen
    s_add_u32 s16, s15, 1536
    buffer_load_dwordx2 v[22:23], v5, s[8:11], s16 offen
    s_add_u32 s16, s15, 2048
    buffer_load_dwordx2 v[24:25], v5, s[8:11], s16 offen
    s_add_u32 s16, s15, 2560
    buffer_load_dwordx2 v[26:27], v5, s[8:11], s16 offen
    s_add_u32 s16, s15, 3072
    buffer_load_dwordx2 v[28:29], v5, s[8:11], s16 offen
    s_add_u32 s16, s15, 3584
    buffer_load_dwordx2 v[30:31], v5, s[8:11], s16 offen
    s_add_u32 s16, s15, 4096
    buffer_load_dwordx2 v[32:33], v5, s[8:11], s16 offen
    s_add_u32 s16, s15, 4608
    buffer_load_dwordx2 v[34:35], v5, s[8:11], s16 offen
    s_add_u32 s16, s15, 5120
    buffer_load_dwordx2 v[36:37], v5, s[8:11], s16 offen
    s_add_u32 s16, s15, 5632
    buffer_load_dwordx2 v[38:39], v5, s[8:11], s16 offen
    s_add_u32 s16, s15, 6144
    buffer_load_dwordx2 v[40:41], v5, s[8:11], s16 offen
    s_add_u32 s16, s15, 6656
    buffer_load_dwordx2 v[42:43], v5, s[8:11], s16 offen
    s_add_u32 s16, s15, 7168
    buffer_load_dwordx2 v[44:45], v5, s[8:11], s16 offen
    s_add_u32 s16, s15, 7680
    buffer_load_dwordx2 v[46:47], v5, s[8:11], s16 offen
    s_add_u32 s16, s15, 8192
    buffer_load_dwordx2 v[48:49], v5, s[8:11], s16 offen
    s_add_u32 s16, s15, 8704
    buffer_load_dwordx2 v[50:51], v5, s[8:11], s16 offen
    s_add_u32 s16, s15, 9216
    buffer_load_dwordx2 v[52:53], v5, s[8:11], s16 offen
    s_add_u32 s16, s15, 9728
    buffer_load_dwordx2 v[54:55], v5, s[8:11], s16 offen
    s_add_u32 s16, s15, 10240
    buffer_load_dwordx2 v[56:57], v5, s[8:11], s16 offen
    s_add_u32 s16, s15, 10752
    buffer_load_dwordx2 v[58:59], v5, s[8:11], s16 offen
    s_add_u32 s16, s15, 11264
    buffer_load_dwordx2 v[60:61], v5, s[8:11], s16 offen
    s_add_u32 s16, s15, 11776
    buffer_load_dwordx2 v[62:63], v5, s[8:11], s16 offen
    s_add_u32 s16, s15, 12288
    buffer_load_dwordx2 v[64:65], v5, s[8:11], s16 offen
    s_add_u32 s16, s15, 12800
    buffer_load_dwordx2 v[66:67], v5, s[8:11], s16 offen
    s_add_u32 s16, s15, 13312
    buffer_load_dwordx2 v[68:69], v5, s[8:11], s16 offen
    s_add_u32 s16, s15, 13824
    buffer_load_dwordx2 v[70:71], v5, s[8:11], s16 offen
    s_add_u32 s16, s15, 14336
    buffer_load_dwordx2 v[72:73], v5, s[8:11], s16 offen
    s_add_u32 s16, s15, 14848
    buffer_load_dwordx2 v[74:75], v5, s[8:11], s16 offen
    s_add_u32 s16, s15, 15360
    buffer_load_dwordx2 v[76:77], v5, s[8:11], s16 offen
    s_add_u32 s16, s15, 15872
    buffer_load_dwordx2 v[78:79], v5, s[8:11], s16 offen
    s_mul_i32 s17, s12, 16896
    v_lshlrev_b32 v3, 3, v1
    v_add_u32 v3, s17, v3
    v_and_b32 v7, 1, v1
    v_lshrrev_b32 v6, 1, v1
    v_cvt_f32_u32 v8, v6
    v_cvt_f32_u32 v10, v7
    s_movk_i32 s18, 528
    v_mul_lo_u32 v4, v6, s18
    v_lshl_add_u32 v4, v7, 3, v4
    v_add_u32 v4, s17, v4
    v_mov_b32 v9, 1.0
    v_fma_f32 v9, v10, -2.0, v9
    v_lshlrev_b32 v5, 12, v7
    v_lshl_add_u32 v11, v6, 2, v5
    s_lshl_b32 s19, s13, 13
    s_add_u32 s19, s19, 121634816
    s_waitcnt vmcnt(0)
    v_sub_f32 v80, v16, v48
    v_sub_f32 v81, v17, v49
    v_add_f32 v16, v16, v48
    v_add_f32 v17, v17, v49
    v_sub_f32 v48, v18, v50
    v_sub_f32 v49, v19, v51
    v_add_f32 v18, v18, v50
    v_add_f32 v19, v19, v51
    v_mul_f32 v50, 0x3f7b14be, v48
    v_mul_f32 v51, 0xbe47c5c2, v48
    v_fmac_f32 v50, 0x3e47c5c2, v49
    v_fmac_f32 v51, 0x3f7b14be, v49
    v_sub_f32 v48, v20, v52
    v_sub_f32 v49, v21, v53
    v_add_f32 v20, v20, v52
    v_add_f32 v21, v21, v53
    v_mul_f32 v52, 0x3f6c835e, v48
    v_mul_f32 v53, 0xbec3ef15, v48
    v_fmac_f32 v52, 0x3ec3ef15, v49
    v_fmac_f32 v53, 0x3f6c835e, v49
    v_sub_f32 v48, v22, v54
    v_sub_f32 v49, v23, v55
    v_add_f32 v22, v22, v54
    v_add_f32 v23, v23, v55
    v_mul_f32 v54, 0x3f54db31, v48
    v_mul_f32 v55, 0xbf0e39da, v48
    v_fmac_f32 v54, 0x3f0e39da, v49
    v_fmac_f32 v55, 0x3f54db31, v49
    v_sub_f32 v48, v24, v56
    v_sub_f32 v49, v25, v57
    v_add_f32 v24, v24, v56
    v_add_f32 v25, v25, v57
    v_mul_f32 v56, 0x3f3504f3, v48
    v_mul_f32 v57, 0xbf3504f3, v48
    v_fmac_f32 v56, 0x3f3504f3, v49
    v_fmac_f32 v57, 0x3f3504f3, v49
    v_sub_f32 v48, v26, v58
    v_sub_f32 v49, v27, v59
    v_add_f32 v26, v26, v58
    v_add_f32 v27, v27, v59
    v_mul_f32 v58, 0x3f0e39da, v48
    v_mul_f32 v59, 0xbf54db31, v48
    v_fmac_f32 v58, 0x3f54db31, v49
    v_fmac_f32 v59, 0x3f0e39da, v49
    v_sub_f32 v48, v28, v60
    v_sub_f32 v49, v29, v61
    v_add_f32 v28, v28, v60
    v_add_f32 v29, v29, v61
    v_mul_f32 v60, 0x3ec3ef15, v48
    v_mul_f32 v61, 0xbf6c835e, v48
    v_fmac_f32 v60, 0x3f6c835e, v49
    v_fmac_f32 v61, 0x3ec3ef15, v49
    v_sub_f32 v48, v30, v62
    v_sub_f32 v49, v31, v63
    v_add_f32 v30, v30, v62
    v_add_f32 v31, v31, v63
    v_mul_f32 v62, 0x3e47c5c2, v48
    v_mul_f32 v63, 0xbf7b14be, v48
    v_fmac_f32 v62, 0x3f7b14be, v49
    v_fmac_f32 v63, 0x3e47c5c2, v49
    v_sub_f32 v48, v33, v65
    v_sub_f32 v49, v64, v32
    v_add_f32 v32, v32, v64
    v_add_f32 v33, v33, v65
    v_sub_f32 v64, v34, v66
    v_sub_f32 v65, v35, v67
    v_add_f32 v34, v34, v66
    v_add_f32 v35, v35, v67
    v_mul_f32 v66, 0xbe47c5c2, v64
    v_mul_f32 v67, 0xbf7b14be, v64
    v_fmac_f32 v66, 0x3f7b14be, v65
    v_fmac_f32 v67, 0xbe47c5c2, v65
    v_sub_f32 v64, v36, v68
    v_sub_f32 v65, v37, v69
    v_add_f32 v36, v36, v68
    v_add_f32 v37, v37, v69
    v_mul_f32 v68, 0xbec3ef15, v64
    v_mul_f32 v69, 0xbf6c835e, v64
    v_fmac_f32 v68, 0x3f6c835e, v65
    v_fmac_f32 v69, 0xbec3ef15, v65
    v_sub_f32 v64, v38, v70
    v_sub_f32 v65, v39, v71
    v_add_f32 v38, v38, v70
    v_add_f32 v39, v39, v71
    v_mul_f32 v70, 0xbf0e39da, v64
    v_mul_f32 v71, 0xbf54db31, v64
    v_fmac_f32 v70, 0x3f54db31, v65
    v_fmac_f32 v71, 0xbf0e39da, v65
    v_sub_f32 v64, v40, v72
    v_sub_f32 v65, v41, v73
    v_add_f32 v40, v40, v72
    v_add_f32 v41, v41, v73
    v_mul_f32 v72, 0xbf3504f3, v64
    v_mul_f32 v73, 0xbf3504f3, v64
    v_fmac_f32 v72, 0x3f3504f3, v65
    v_fmac_f32 v73, 0xbf3504f3, v65
    v_sub_f32 v64, v42, v74
    v_sub_f32 v65, v43, v75
    v_add_f32 v42, v42, v74
    v_add_f32 v43, v43, v75
    v_mul_f32 v74, 0xbf54db31, v64
    v_mul_f32 v75, 0xbf0e39da, v64
    v_fmac_f32 v74, 0x3f0e39da, v65
    v_fmac_f32 v75, 0xbf54db31, v65
    v_sub_f32 v64, v44, v76
    v_sub_f32 v65, v45, v77
    v_add_f32 v44, v44, v76
    v_add_f32 v45, v45, v77
    v_mul_f32 v76, 0xbf6c835e, v64
    v_mul_f32 v77, 0xbec3ef15, v64
    v_fmac_f32 v76, 0x3ec3ef15, v65
    v_fmac_f32 v77, 0xbf6c835e, v65
    v_sub_f32 v64, v46, v78
    v_sub_f32 v65, v47, v79
    v_add_f32 v46, v46, v78
    v_add_f32 v47, v47, v79
    v_mul_f32 v78, 0xbf7b14be, v64
    v_mul_f32 v79, 0xbe47c5c2, v64
    v_fmac_f32 v78, 0x3e47c5c2, v65
    v_fmac_f32 v79, 0xbf7b14be, v65
    v_sub_f32 v64, v16, v32
    v_sub_f32 v65, v17, v33
    v_add_f32 v16, v16, v32
    v_add_f32 v17, v17, v33
    v_sub_f32 v32, v18, v34
    v_sub_f32 v33, v19, v35
    v_add_f32 v18, v18, v34
    v_add_f32 v19, v19, v35
    v_mul_f32 v34, 0x3f6c835e, v32
    v_mul_f32 v35, 0xbec3ef15, v32
    v_fmac_f32 v34, 0x3ec3ef15, v33
    v_fmac_f32 v35, 0x3f6c835e, v33
    v_sub_f32 v32, v20, v36
    v_sub_f32 v33, v21, v37
    v_add_f32 v20, v20, v36
    v_add_f32 v21, v21, v37
    v_mul_f32 v36, 0x3f3504f3, v32
    v_mul_f32 v37, 0xbf3504f3, v32
    v_fmac_f32 v36, 0x3f3504f3, v33
    v_fmac_f32 v37, 0x3f3504f3, v33
    v_sub_f32 v32, v22, v38
    v_sub_f32 v33, v23, v39
    v_add_f32 v22, v22, v38
    v_add_f32 v23, v23, v39
    v_mul_f32 v38, 0x3ec3ef15, v32
    v_mul_f32 v39, 0xbf6c835e, v32
    v_fmac_f32 v38, 0x3f6c835e, v33
    v_fmac_f32 v39, 0x3ec3ef15, v33
    v_sub_f32 v32, v25, v41
    v_sub_f32 v33, v40, v24
    v_add_f32 v24, v24, v40
    v_add_f32 v25, v25, v41
    v_sub_f32 v40, v26, v42
    v_sub_f32 v41, v27, v43
    v_add_f32 v26, v26, v42
    v_add_f32 v27, v27, v43
    v_mul_f32 v42, 0xbec3ef15, v40
    v_mul_f32 v43, 0xbf6c835e, v40
    v_fmac_f32 v42, 0x3f6c835e, v41
    v_fmac_f32 v43, 0xbec3ef15, v41
    v_sub_f32 v40, v28, v44
    v_sub_f32 v41, v29, v45
    v_add_f32 v28, v28, v44
    v_add_f32 v29, v29, v45
    v_mul_f32 v44, 0xbf3504f3, v40
    v_mul_f32 v45, 0xbf3504f3, v40
    v_fmac_f32 v44, 0x3f3504f3, v41
    v_fmac_f32 v45, 0xbf3504f3, v41
    v_sub_f32 v40, v30, v46
    v_sub_f32 v41, v31, v47
    v_add_f32 v30, v30, v46
    v_add_f32 v31, v31, v47
    v_mul_f32 v46, 0xbf6c835e, v40
    v_mul_f32 v47, 0xbec3ef15, v40
    v_fmac_f32 v46, 0x3ec3ef15, v41
    v_fmac_f32 v47, 0xbf6c835e, v41
    v_sub_f32 v40, v80, v48
    v_sub_f32 v41, v81, v49
    v_add_f32 v80, v80, v48
    v_add_f32 v81, v81, v49
    v_sub_f32 v48, v50, v66
    v_sub_f32 v49, v51, v67
    v_add_f32 v50, v50, v66
    v_add_f32 v51, v51, v67
    v_mul_f32 v66, 0x3f6c835e, v48
    v_mul_f32 v67, 0xbec3ef15, v48
    v_fmac_f32 v66, 0x3ec3ef15, v49
    v_fmac_f32 v67, 0x3f6c835e, v49
    v_sub_f32 v48, v52, v68
    v_sub_f32 v49, v53, v69
    v_add_f32 v52, v52, v68
    v_add_f32 v53, v53, v69
    v_mul_f32 v68, 0x3f3504f3, v48
    v_mul_f32 v69, 0xbf3504f3, v48
    v_fmac_f32 v68, 0x3f3504f3, v49
    v_fmac_f32 v69, 0x3f3504f3, v49
    v_sub_f32 v48, v54, v70
    v_sub_f32 v49, v55, v71
    v_add_f32 v54, v54, v70
    v_add_f32 v55, v55, v71
    v_mul_f32 v70, 0x3ec3ef15, v48
    v_mul_f32 v71, 0xbf6c835e, v48
    v_fmac_f32 v70, 0x3f6c835e, v49
    v_fmac_f32 v71, 0x3ec3ef15, v49
    v_sub_f32 v48, v57, v73
    v_sub_f32 v49, v72, v56
    v_add_f32 v56, v56, v72
    v_add_f32 v57, v57, v73
    v_sub_f32 v72, v58, v74
    v_sub_f32 v73, v59, v75
    v_add_f32 v58, v58, v74
    v_add_f32 v59, v59, v75
    v_mul_f32 v74, 0xbec3ef15, v72
    v_mul_f32 v75, 0xbf6c835e, v72
    v_fmac_f32 v74, 0x3f6c835e, v73
    v_fmac_f32 v75, 0xbec3ef15, v73
    v_sub_f32 v72, v60, v76
    v_sub_f32 v73, v61, v77
    v_add_f32 v60, v60, v76
    v_add_f32 v61, v61, v77
    v_mul_f32 v76, 0xbf3504f3, v72
    v_mul_f32 v77, 0xbf3504f3, v72
    v_fmac_f32 v76, 0x3f3504f3, v73
    v_fmac_f32 v77, 0xbf3504f3, v73
    v_sub_f32 v72, v62, v78
    v_sub_f32 v73, v63, v79
    v_add_f32 v62, v62, v78
    v_add_f32 v63, v63, v79
    v_mul_f32 v78, 0xbf6c835e, v72
    v_mul_f32 v79, 0xbec3ef15, v72
    v_fmac_f32 v78, 0x3ec3ef15, v73
    v_fmac_f32 v79, 0xbf6c835e, v73
    v_sub_f32 v72, v16, v24
    v_sub_f32 v73, v17, v25
    v_add_f32 v16, v16, v24
    v_add_f32 v17, v17, v25
    v_sub_f32 v24, v18, v26
    v_sub_f32 v25, v19, v27
    v_add_f32 v18, v18, v26
    v_add_f32 v19, v19, v27
    v_mul_f32 v26, 0x3f3504f3, v24
    v_mul_f32 v27, 0xbf3504f3, v24
    v_fmac_f32 v26, 0x3f3504f3, v25
    v_fmac_f32 v27, 0x3f3504f3, v25
    v_sub_f32 v24, v21, v29
    v_sub_f32 v25, v28, v20
    v_add_f32 v20, v20, v28
    v_add_f32 v21, v21, v29
    v_sub_f32 v28, v22, v30
    v_sub_f32 v29, v23, v31
    v_add_f32 v22, v22, v30
    v_add_f32 v23, v23, v31
    v_mul_f32 v30, 0xbf3504f3, v28
    v_mul_f32 v31, 0xbf3504f3, v28
    v_fmac_f32 v30, 0x3f3504f3, v29
    v_fmac_f32 v31, 0xbf3504f3, v29
    v_sub_f32 v28, v64, v32
    v_sub_f32 v29, v65, v33
    v_add_f32 v64, v64, v32
    v_add_f32 v65, v65, v33
    v_sub_f32 v32, v34, v42
    v_sub_f32 v33, v35, v43
    v_add_f32 v34, v34, v42
    v_add_f32 v35, v35, v43
    v_mul_f32 v42, 0x3f3504f3, v32
    v_mul_f32 v43, 0xbf3504f3, v32
    v_fmac_f32 v42, 0x3f3504f3, v33
    v_fmac_f32 v43, 0x3f3504f3, v33
    v_sub_f32 v32, v37, v45
    v_sub_f32 v33, v44, v36
    v_add_f32 v36, v36, v44
    v_add_f32 v37, v37, v45
    v_sub_f32 v44, v38, v46
    v_sub_f32 v45, v39, v47
    v_add_f32 v38, v38, v46
    v_add_f32 v39, v39, v47
    v_mul_f32 v46, 0xbf3504f3, v44
    v_mul_f32 v47, 0xbf3504f3, v44
    v_fmac_f32 v46, 0x3f3504f3, v45
    v_fmac_f32 v47, 0xbf3504f3, v45
    v_sub_f32 v44, v80, v56
    v_sub_f32 v45, v81, v57
    v_add_f32 v80, v80, v56
    v_add_f32 v81, v81, v57
    v_sub_f32 v56, v50, v58
    v_sub_f32 v57, v51, v59
    v_add_f32 v50, v50, v58
    v_add_f32 v51, v51, v59
    v_mul_f32 v58, 0x3f3504f3, v56
    v_mul_f32 v59, 0xbf3504f3, v56
    v_fmac_f32 v58, 0x3f3504f3, v57
    v_fmac_f32 v59, 0x3f3504f3, v57
    v_sub_f32 v56, v53, v61
    v_sub_f32 v57, v60, v52
    v_add_f32 v52, v52, v60
    v_add_f32 v53, v53, v61
    v_sub_f32 v60, v54, v62
    v_sub_f32 v61, v55, v63
    v_add_f32 v54, v54, v62
    v_add_f32 v55, v55, v63
    v_mul_f32 v62, 0xbf3504f3, v60
    v_mul_f32 v63, 0xbf3504f3, v60
    v_fmac_f32 v62, 0x3f3504f3, v61
    v_fmac_f32 v63, 0xbf3504f3, v61
    v_sub_f32 v60, v40, v48
    v_sub_f32 v61, v41, v49
    v_add_f32 v40, v40, v48
    v_add_f32 v41, v41, v49
    v_sub_f32 v48, v66, v74
    v_sub_f32 v49, v67, v75
    v_add_f32 v66, v66, v74
    v_add_f32 v67, v67, v75
    v_mul_f32 v74, 0x3f3504f3, v48
    v_mul_f32 v75, 0xbf3504f3, v48
    v_fmac_f32 v74, 0x3f3504f3, v49
    v_fmac_f32 v75, 0x3f3504f3, v49
    v_sub_f32 v48, v69, v77
    v_sub_f32 v49, v76, v68
    v_add_f32 v68, v68, v76
    v_add_f32 v69, v69, v77
    v_sub_f32 v76, v70, v78
    v_sub_f32 v77, v71, v79
    v_add_f32 v70, v70, v78
    v_add_f32 v71, v71, v79
    v_mul_f32 v78, 0xbf3504f3, v76
    v_mul_f32 v79, 0xbf3504f3, v76
    v_fmac_f32 v78, 0x3f3504f3, v77
    v_fmac_f32 v79, 0xbf3504f3, v77
    v_sub_f32 v76, v16, v20
    v_sub_f32 v77, v17, v21
    v_add_f32 v16, v16, v20
    v_add_f32 v17, v17, v21
    v_sub_f32 v20, v19, v23
    v_sub_f32 v21, v22, v18
    v_add_f32 v18, v18, v22
    v_add_f32 v19, v19, v23
    v_sub_f32 v22, v72, v24
    v_sub_f32 v23, v73, v25
    v_add_f32 v72, v72, v24
    v_add_f32 v73, v73, v25
    v_sub_f32 v24, v27, v31
    v_sub_f32 v25, v30, v26
    v_add_f32 v26, v26, v30
    v_add_f32 v27, v27, v31
    v_sub_f32 v30, v64, v36
    v_sub_f32 v31, v65, v37
    v_add_f32 v64, v64, v36
    v_add_f32 v65, v65, v37
    v_sub_f32 v36, v35, v39
    v_sub_f32 v37, v38, v34
    v_add_f32 v34, v34, v38
    v_add_f32 v35, v35, v39
    v_sub_f32 v38, v28, v32
    v_sub_f32 v39, v29, v33
    v_add_f32 v28, v28, v32
    v_add_f32 v29, v29, v33
    v_sub_f32 v32, v43, v47
    v_sub_f32 v33, v46, v42
    v_add_f32 v42, v42, v46
    v_add_f32 v43, v43, v47
    v_sub_f32 v46, v80, v52
    v_sub_f32 v47, v81, v53
    v_add_f32 v80, v80, v52
    v_add_f32 v81, v81, v53
    v_sub_f32 v52, v51, v55
    v_sub_f32 v53, v54, v50
    v_add_f32 v50, v50, v54
    v_add_f32 v51, v51, v55
    v_sub_f32 v54, v44, v56
    v_sub_f32 v55, v45, v57
    v_add_f32 v44, v44, v56
    v_add_f32 v45, v45, v57
    v_sub_f32 v56, v59, v63
    v_sub_f32 v57, v62, v58
    v_add_f32 v58, v58, v62
    v_add_f32 v59, v59, v63
    v_sub_f32 v62, v40, v68
    v_sub_f32 v63, v41, v69
    v_add_f32 v40, v40, v68
    v_add_f32 v41, v41, v69
    v_sub_f32 v68, v67, v71
    v_sub_f32 v69, v70, v66
    v_add_f32 v66, v66, v70
    v_add_f32 v67, v67, v71
    v_sub_f32 v70, v60, v48
    v_sub_f32 v71, v61, v49
    v_add_f32 v60, v60, v48
    v_add_f32 v61, v61, v49
    v_sub_f32 v48, v75, v79
    v_sub_f32 v49, v78, v74
    v_add_f32 v74, v74, v78
    v_add_f32 v75, v75, v79
    v_sub_f32 v78, v16, v18
    v_sub_f32 v79, v17, v19
    v_add_f32 v16, v16, v18
    v_add_f32 v17, v17, v19
    v_sub_f32 v18, v76, v20
    v_sub_f32 v19, v77, v21
    v_add_f32 v76, v76, v20
    v_add_f32 v77, v77, v21
    v_sub_f32 v20, v72, v26
    v_sub_f32 v21, v73, v27
    v_add_f32 v72, v72, v26
    v_add_f32 v73, v73, v27
    v_sub_f32 v26, v22, v24
    v_sub_f32 v27, v23, v25
    v_add_f32 v22, v22, v24
    v_add_f32 v23, v23, v25
    v_sub_f32 v24, v64, v34
    v_sub_f32 v25, v65, v35
    v_add_f32 v64, v64, v34
    v_add_f32 v65, v65, v35
    v_sub_f32 v34, v30, v36
    v_sub_f32 v35, v31, v37
    v_add_f32 v30, v30, v36
    v_add_f32 v31, v31, v37
    v_sub_f32 v36, v28, v42
    v_sub_f32 v37, v29, v43
    v_add_f32 v28, v28, v42
    v_add_f32 v29, v29, v43
    v_sub_f32 v42, v38, v32
    v_sub_f32 v43, v39, v33
    v_add_f32 v38, v38, v32
    v_add_f32 v39, v39, v33
    v_sub_f32 v32, v80, v50
    v_sub_f32 v33, v81, v51
    v_add_f32 v80, v80, v50
    v_add_f32 v81, v81, v51
    v_sub_f32 v50, v46, v52
    v_sub_f32 v51, v47, v53
    v_add_f32 v46, v46, v52
    v_add_f32 v47, v47, v53
    v_sub_f32 v52, v44, v58
    v_sub_f32 v53, v45, v59
    v_add_f32 v44, v44, v58
    v_add_f32 v45, v45, v59
    v_sub_f32 v58, v54, v56
    v_sub_f32 v59, v55, v57
    v_add_f32 v54, v54, v56
    v_add_f32 v55, v55, v57
    v_sub_f32 v56, v40, v66
    v_sub_f32 v57, v41, v67
    v_add_f32 v40, v40, v66
    v_add_f32 v41, v41, v67
    v_sub_f32 v66, v62, v68
    v_sub_f32 v67, v63, v69
    v_add_f32 v62, v62, v68
    v_add_f32 v63, v63, v69
    v_sub_f32 v68, v60, v74
    v_sub_f32 v69, v61, v75
    v_add_f32 v60, v60, v74
    v_add_f32 v61, v61, v75
    v_sub_f32 v74, v70, v48
    v_sub_f32 v75, v71, v49
    v_add_f32 v70, v70, v48
    v_add_f32 v71, v71, v49
    v_mul_f32 v48, 0xba000000, v2
    v_cos_f32 v49, v48
    v_sin_f32 v82, v48
    s_nop 0
    v_mul_f32 v83, v80, v49
    v_fma_f32 v83, -v81, v82, v83
    v_mul_f32 v81, v81, v49
    v_fmac_f32 v81, v80, v82
    v_mul_f32 v48, 0xba800000, v2
    v_cos_f32 v49, v48
    v_sin_f32 v82, v48
    s_nop 0
    v_mul_f32 v80, v64, v49
    v_fma_f32 v80, -v65, v82, v80
    v_mul_f32 v65, v65, v49
    v_fmac_f32 v65, v64, v82
    v_mul_f32 v48, 0xbac00000, v2
    v_cos_f32 v49, v48
    v_sin_f32 v82, v48
    s_nop 0
    v_mul_f32 v64, v40, v49
    v_fma_f32 v64, -v41, v82, v64
    v_mul_f32 v41, v41, v49
    v_fmac_f32 v41, v40, v82
    v_mul_f32 v48, 0xbb000000, v2
    v_cos_f32 v49, v48
    v_sin_f32 v82, v48
    s_nop 0
    v_mul_f32 v40, v72, v49
    v_fma_f32 v40, -v73, v82, v40
    v_mul_f32 v73, v73, v49
    v_fmac_f32 v73, v72, v82
    v_mul_f32 v48, 0xbb200000, v2
    v_cos_f32 v49, v48
    v_sin_f32 v82, v48
    s_nop 0
    v_mul_f32 v72, v44, v49
    v_fma_f32 v72, -v45, v82, v72
    v_mul_f32 v45, v45, v49
    v_fmac_f32 v45, v44, v82
    v_mul_f32 v48, 0xbb400000, v2
    v_cos_f32 v49, v48
    v_sin_f32 v82, v48
    s_nop 0
    v_mul_f32 v44, v28, v49
    v_fma_f32 v44, -v29, v82, v44
    v_mul_f32 v29, v29, v49
    v_fmac_f32 v29, v28, v82
    v_mul_f32 v48, 0xbb600000, v2
    v_cos_f32 v49, v48
    v_sin_f32 v82, v48
    s_nop 0
    v_mul_f32 v28, v60, v49
    v_fma_f32 v28, -v61, v82, v28
    v_mul_f32 v61, v61, v49
    v_fmac_f32 v61, v60, v82
    v_mul_f32 v48, 0xbb800000, v2
    v_cos_f32 v49, v48
    v_sin_f32 v82, v48
    s_nop 0
    v_mul_f32 v60, v76, v49
    v_fma_f32 v60, -v77, v82, v60
    v_mul_f32 v77, v77, v49
    v_fmac_f32 v77, v76, v82
    v_mul_f32 v48, 0xbb900000, v2
    v_cos_f32 v49, v48
    v_sin_f32 v82, v48
    s_nop 0
    v_mul_f32 v76, v46, v49
    v_fma_f32 v76, -v47, v82, v76
    v_mul_f32 v47, v47, v49
    v_fmac_f32 v47, v46, v82
    v_mul_f32 v48, 0xbba00000, v2
    v_cos_f32 v49, v48
    v_sin_f32 v82, v48
    s_nop 0
    v_mul_f32 v46, v30, v49
    v_fma_f32 v46, -v31, v82, v46
    v_mul_f32 v31, v31, v49
    v_fmac_f32 v31, v30, v82
    v_mul_f32 v48, 0xbbb00000, v2
    v_cos_f32 v49, v48
    v_sin_f32 v82, v48
    s_nop 0
    v_mul_f32 v30, v62, v49
    v_fma_f32 v30, -v63, v82, v30
    v_mul_f32 v63, v63, v49
    v_fmac_f32 v63, v62, v82
    v_mul_f32 v48, 0xbbc00000, v2
    v_cos_f32 v49, v48
    v_sin_f32 v82, v48
    s_nop 0
    v_mul_f32 v62, v22, v49
    v_fma_f32 v62, -v23, v82, v62
    v_mul_f32 v23, v23, v49
    v_fmac_f32 v23, v22, v82
    v_mul_f32 v48, 0xbbd00000, v2
    v_cos_f32 v49, v48
    v_sin_f32 v82, v48
    s_nop 0
    v_mul_f32 v22, v54, v49
    v_fma_f32 v22, -v55, v82, v22
    v_mul_f32 v55, v55, v49
    v_fmac_f32 v55, v54, v82
    v_mul_f32 v48, 0xbbe00000, v2
    v_cos_f32 v49, v48
    v_sin_f32 v82, v48
    s_nop 0
    v_mul_f32 v54, v38, v49
    v_fma_f32 v54, -v39, v82, v54
    v_mul_f32 v39, v39, v49
    v_fmac_f32 v39, v38, v82
    v_mul_f32 v48, 0xbbf00000, v2
    v_cos_f32 v49, v48
    v_sin_f32 v82, v48
    s_nop 0
    v_mul_f32 v38, v70, v49
    v_fma_f32 v38, -v71, v82, v38
    v_mul_f32 v71, v71, v49
    v_fmac_f32 v71, v70, v82
    v_mul_f32 v48, 0xbc000000, v2
    v_cos_f32 v49, v48
    v_sin_f32 v82, v48
    s_nop 0
    v_mul_f32 v70, v78, v49
    v_fma_f32 v70, -v79, v82, v70
    v_mul_f32 v79, v79, v49
    v_fmac_f32 v79, v78, v82
    v_mul_f32 v48, 0xbc080000, v2
    v_cos_f32 v49, v48
    v_sin_f32 v82, v48
    s_nop 0
    v_mul_f32 v78, v32, v49
    v_fma_f32 v78, -v33, v82, v78
    v_mul_f32 v33, v33, v49
    v_fmac_f32 v33, v32, v82
    v_mul_f32 v48, 0xbc100000, v2
    v_cos_f32 v49, v48
    v_sin_f32 v82, v48
    s_nop 0
    v_mul_f32 v32, v24, v49
    v_fma_f32 v32, -v25, v82, v32
    v_mul_f32 v25, v25, v49
    v_fmac_f32 v25, v24, v82
    v_mul_f32 v48, 0xbc180000, v2
    v_cos_f32 v49, v48
    v_sin_f32 v82, v48
    s_nop 0
    v_mul_f32 v24, v56, v49
    v_fma_f32 v24, -v57, v82, v24
    v_mul_f32 v57, v57, v49
    v_fmac_f32 v57, v56, v82
    v_mul_f32 v48, 0xbc200000, v2
    v_cos_f32 v49, v48
    v_sin_f32 v82, v48
    s_nop 0
    v_mul_f32 v56, v20, v49
    v_fma_f32 v56, -v21, v82, v56
    v_mul_f32 v21, v21, v49
    v_fmac_f32 v21, v20, v82
    v_mul_f32 v48, 0xbc280000, v2
    v_cos_f32 v49, v48
    v_sin_f32 v82, v48
    s_nop 0
    v_mul_f32 v20, v52, v49
    v_fma_f32 v20, -v53, v82, v20
    v_mul_f32 v53, v53, v49
    v_fmac_f32 v53, v52, v82
    v_mul_f32 v48, 0xbc300000, v2
    v_cos_f32 v49, v48
    v_sin_f32 v82, v48
    s_nop 0
    v_mul_f32 v52, v36, v49
    v_fma_f32 v52, -v37, v82, v52
    v_mul_f32 v37, v37, v49
    v_fmac_f32 v37, v36, v82
    v_mul_f32 v48, 0xbc380000, v2
    v_cos_f32 v49, v48
    v_sin_f32 v82, v48
    s_nop 0
    v_mul_f32 v36, v68, v49
    v_fma_f32 v36, -v69, v82, v36
    v_mul_f32 v69, v69, v49
    v_fmac_f32 v69, v68, v82
    v_mul_f32 v48, 0xbc400000, v2
    v_cos_f32 v49, v48
    v_sin_f32 v82, v48
    s_nop 0
    v_mul_f32 v68, v18, v49
    v_fma_f32 v68, -v19, v82, v68
    v_mul_f32 v19, v19, v49
    v_fmac_f32 v19, v18, v82
    v_mul_f32 v48, 0xbc480000, v2
    v_cos_f32 v49, v48
    v_sin_f32 v82, v48
    s_nop 0
    v_mul_f32 v18, v50, v49
    v_fma_f32 v18, -v51, v82, v18
    v_mul_f32 v51, v51, v49
    v_fmac_f32 v51, v50, v82
    v_mul_f32 v48, 0xbc500000, v2
    v_cos_f32 v49, v48
    v_sin_f32 v82, v48
    s_nop 0
    v_mul_f32 v50, v34, v49
    v_fma_f32 v50, -v35, v82, v50
    v_mul_f32 v35, v35, v49
    v_fmac_f32 v35, v34, v82
    v_mul_f32 v48, 0xbc580000, v2
    v_cos_f32 v49, v48
    v_sin_f32 v82, v48
    s_nop 0
    v_mul_f32 v34, v66, v49
    v_fma_f32 v34, -v67, v82, v34
    v_mul_f32 v67, v67, v49
    v_fmac_f32 v67, v66, v82
    v_mul_f32 v48, 0xbc600000, v2
    v_cos_f32 v49, v48
    v_sin_f32 v82, v48
    s_nop 0
    v_mul_f32 v66, v26, v49
    v_fma_f32 v66, -v27, v82, v66
    v_mul_f32 v27, v27, v49
    v_fmac_f32 v27, v26, v82
    v_mul_f32 v48, 0xbc680000, v2
    v_cos_f32 v49, v48
    v_sin_f32 v82, v48
    s_nop 0
    v_mul_f32 v26, v58, v49
    v_fma_f32 v26, -v59, v82, v26
    v_mul_f32 v59, v59, v49
    v_fmac_f32 v59, v58, v82
    v_mul_f32 v48, 0xbc700000, v2
    v_cos_f32 v49, v48
    v_sin_f32 v82, v48
    s_nop 0
    v_mul_f32 v58, v42, v49
    v_fma_f32 v58, -v43, v82, v58
    v_mul_f32 v43, v43, v49
    v_fmac_f32 v43, v42, v82
    v_mul_f32 v48, 0xbc780000, v2
    v_cos_f32 v49, v48
    v_sin_f32 v82, v48
    s_nop 0
    v_mul_f32 v42, v74, v49
    v_fma_f32 v42, -v75, v82, v42
    v_mul_f32 v75, v75, v49
    v_fmac_f32 v75, v74, v82
    ds_write_b32 v3, v16 offset:0
    ds_write_b32 v3, v17 offset:4
    ds_write_b32 v3, v83 offset:528
    ds_write_b32 v3, v81 offset:532
    ds_write_b32 v3, v80 offset:1056
    ds_write_b32 v3, v65 offset:1060
    ds_write_b32 v3, v64 offset:1584
    ds_write_b32 v3, v41 offset:1588
    ds_write_b32 v3, v40 offset:2112
    ds_write_b32 v3, v73 offset:2116
    ds_write_b32 v3, v72 offset:2640
    ds_write_b32 v3, v45 offset:2644
    ds_write_b32 v3, v44 offset:3168
    ds_write_b32 v3, v29 offset:3172
    ds_write_b32 v3, v28 offset:3696
    ds_write_b32 v3, v61 offset:3700
    ds_write_b32 v3, v60 offset:4224
    ds_write_b32 v3, v77 offset:4228
    ds_write_b32 v3, v76 offset:4752
    ds_write_b32 v3, v47 offset:4756
    ds_write_b32 v3, v46 offset:5280
    ds_write_b32 v3, v31 offset:5284
    ds_write_b32 v3, v30 offset:5808
    ds_write_b32 v3, v63 offset:5812
    ds_write_b32 v3, v62 offset:6336
    ds_write_b32 v3, v23 offset:6340
    ds_write_b32 v3, v22 offset:6864
    ds_write_b32 v3, v55 offset:6868
    ds_write_b32 v3, v54 offset:7392
    ds_write_b32 v3, v39 offset:7396
    ds_write_b32 v3, v38 offset:7920
    ds_write_b32 v3, v71 offset:7924
    ds_write_b32 v3, v70 offset:8448
    ds_write_b32 v3, v79 offset:8452
    ds_write_b32 v3, v78 offset:8976
    ds_write_b32 v3, v33 offset:8980
    ds_write_b32 v3, v32 offset:9504
    ds_write_b32 v3, v25 offset:9508
    ds_write_b32 v3, v24 offset:10032
    ds_write_b32 v3, v57 offset:10036
    ds_write_b32 v3, v56 offset:10560
    ds_write_b32 v3, v21 offset:10564
    ds_write_b32 v3, v20 offset:11088
    ds_write_b32 v3, v53 offset:11092
    ds_write_b32 v3, v52 offset:11616
    ds_write_b32 v3, v37 offset:11620
    ds_write_b32 v3, v36 offset:12144
    ds_write_b32 v3, v69 offset:12148
    ds_write_b32 v3, v68 offset:12672
    ds_write_b32 v3, v19 offset:12676
    ds_write_b32 v3, v18 offset:13200
    ds_write_b32 v3, v51 offset:13204
    ds_write_b32 v3, v50 offset:13728
    ds_write_b32 v3, v35 offset:13732
    ds_write_b32 v3, v34 offset:14256
    ds_write_b32 v3, v67 offset:14260
    ds_write_b32 v3, v66 offset:14784
    ds_write_b32 v3, v27 offset:14788
    ds_write_b32 v3, v26 offset:15312
    ds_write_b32 v3, v59 offset:15316
    ds_write_b32 v3, v58 offset:15840
    ds_write_b32 v3, v43 offset:15844
    ds_write_b32 v3, v42 offset:16368
    ds_write_b32 v3, v75 offset:16372
    s_waitcnt lgkmcnt(0)
    ds_read_b32 v16, v4 offset:0
    ds_read_b32 v17, v4 offset:4
    ds_read_b32 v83, v4 offset:16
    ds_read_b32 v81, v4 offset:20
    ds_read_b32 v80, v4 offset:32
    ds_read_b32 v65, v4 offset:36
    ds_read_b32 v64, v4 offset:48
    ds_read_b32 v41, v4 offset:52
    ds_read_b32 v40, v4 offset:64
    ds_read_b32 v73, v4 offset:68
    ds_read_b32 v72, v4 offset:80
    ds_read_b32 v45, v4 offset:84
    ds_read_b32 v44, v4 offset:96
    ds_read_b32 v29, v4 offset:100
    s_waitcnt lgkmcnt(0)
    ds_read_b32 v28, v4 offset:112
    ds_read_b32 v61, v4 offset:116
    ds_read_b32 v60, v4 offset:128
    ds_read_b32 v77, v4 offset:132
    ds_read_b32 v76, v4 offset:144
    ds_read_b32 v47, v4 offset:148
    ds_read_b32 v46, v4 offset:160
    ds_read_b32 v31, v4 offset:164
    ds_read_b32 v30, v4 offset:176
    ds_read_b32 v63, v4 offset:180
    ds_read_b32 v62, v4 offset:192
    ds_read_b32 v23, v4 offset:196
    ds_read_b32 v22, v4 offset:208
    ds_read_b32 v55, v4 offset:212
    s_waitcnt lgkmcnt(0)
    ds_read_b32 v54, v4 offset:224
    ds_read_b32 v39, v4 offset:228
    ds_read_b32 v38, v4 offset:240
    ds_read_b32 v71, v4 offset:244
    ds_read_b32 v70, v4 offset:256
    ds_read_b32 v79, v4 offset:260
    ds_read_b32 v78, v4 offset:272
    ds_read_b32 v33, v4 offset:276
    ds_read_b32 v32, v4 offset:288
    ds_read_b32 v25, v4 offset:292
    ds_read_b32 v24, v4 offset:304
    ds_read_b32 v57, v4 offset:308
    ds_read_b32 v56, v4 offset:320
    ds_read_b32 v21, v4 offset:324
    s_waitcnt lgkmcnt(0)
    ds_read_b32 v20, v4 offset:336
    ds_read_b32 v53, v4 offset:340
    ds_read_b32 v52, v4 offset:352
    ds_read_b32 v37, v4 offset:356
    ds_read_b32 v36, v4 offset:368
    ds_read_b32 v69, v4 offset:372
    ds_read_b32 v68, v4 offset:384
    ds_read_b32 v19, v4 offset:388
    ds_read_b32 v18, v4 offset:400
    ds_read_b32 v51, v4 offset:404
    ds_read_b32 v50, v4 offset:416
    ds_read_b32 v35, v4 offset:420
    ds_read_b32 v34, v4 offset:432
    ds_read_b32 v67, v4 offset:436
    s_waitcnt lgkmcnt(0)
    ds_read_b32 v66, v4 offset:448
    ds_read_b32 v27, v4 offset:452
    ds_read_b32 v26, v4 offset:464
    ds_read_b32 v59, v4 offset:468
    ds_read_b32 v58, v4 offset:480
    ds_read_b32 v43, v4 offset:484
    ds_read_b32 v42, v4 offset:496
    ds_read_b32 v75, v4 offset:500
    s_waitcnt lgkmcnt(0)
    buffer_load_dword v88, v11, s[8:11], s19 offen offset:0
    buffer_load_dword v89, v11, s[8:11], s19 offen offset:128
    buffer_load_dword v90, v11, s[8:11], s19 offen offset:256
    buffer_load_dword v91, v11, s[8:11], s19 offen offset:384
    buffer_load_dword v92, v11, s[8:11], s19 offen offset:512
    buffer_load_dword v93, v11, s[8:11], s19 offen offset:640
    buffer_load_dword v94, v11, s[8:11], s19 offen offset:768
    buffer_load_dword v95, v11, s[8:11], s19 offen offset:896
    buffer_load_dword v96, v11, s[8:11], s19 offen offset:1024
    buffer_load_dword v97, v11, s[8:11], s19 offen offset:1152
    buffer_load_dword v98, v11, s[8:11], s19 offen offset:1280
    buffer_load_dword v99, v11, s[8:11], s19 offen offset:1408
    buffer_load_dword v100, v11, s[8:11], s19 offen offset:1536
    buffer_load_dword v101, v11, s[8:11], s19 offen offset:1664
    buffer_load_dword v102, v11, s[8:11], s19 offen offset:1792
    buffer_load_dword v103, v11, s[8:11], s19 offen offset:1920
    buffer_load_dword v104, v11, s[8:11], s19 offen offset:2048
    buffer_load_dword v105, v11, s[8:11], s19 offen offset:2176
    buffer_load_dword v106, v11, s[8:11], s19 offen offset:2304
    buffer_load_dword v107, v11, s[8:11], s19 offen offset:2432
    buffer_load_dword v108, v11, s[8:11], s19 offen offset:2560
    buffer_load_dword v109, v11, s[8:11], s19 offen offset:2688
    buffer_load_dword v110, v11, s[8:11], s19 offen offset:2816
    buffer_load_dword v111, v11, s[8:11], s19 offen offset:2944
    buffer_load_dword v112, v11, s[8:11], s19 offen offset:3072
    buffer_load_dword v113, v11, s[8:11], s19 offen offset:3200
    buffer_load_dword v114, v11, s[8:11], s19 offen offset:3328
    buffer_load_dword v115, v11, s[8:11], s19 offen offset:3456
    buffer_load_dword v116, v11, s[8:11], s19 offen offset:3584
    buffer_load_dword v117, v11, s[8:11], s19 offen offset:3712
    buffer_load_dword v118, v11, s[8:11], s19 offen offset:3840
    buffer_load_dword v119, v11, s[8:11], s19 offen offset:3968
    v_sub_f32 v48, v16, v70
    v_sub_f32 v49, v17, v79
    v_add_f32 v16, v16, v70
    v_add_f32 v17, v17, v79
    v_sub_f32 v70, v83, v78
    v_sub_f32 v79, v81, v33
    v_add_f32 v83, v83, v78
    v_add_f32 v81, v81, v33
    v_mul_f32 v78, 0x3f7b14be, v70
    v_mul_f32 v33, 0xbe47c5c2, v70
    v_fmac_f32 v78, 0x3e47c5c2, v79
    v_fmac_f32 v33, 0x3f7b14be, v79
    v_sub_f32 v70, v80, v32
    v_sub_f32 v79, v65, v25
    v_add_f32 v80, v80, v32
    v_add_f32 v65, v65, v25
    v_mul_f32 v32, 0x3f6c835e, v70
    v_mul_f32 v25, 0xbec3ef15, v70
    v_fmac_f32 v32, 0x3ec3ef15, v79
    v_fmac_f32 v25, 0x3f6c835e, v79
    v_sub_f32 v70, v64, v24
    v_sub_f32 v79, v41, v57
    v_add_f32 v64, v64, v24
    v_add_f32 v41, v41, v57
    v_mul_f32 v24, 0x3f54db31, v70
    v_mul_f32 v57, 0xbf0e39da, v70
    v_fmac_f32 v24, 0x3f0e39da, v79
    v_fmac_f32 v57, 0x3f54db31, v79
    v_sub_f32 v70, v40, v56
    v_sub_f32 v79, v73, v21
    v_add_f32 v40, v40, v56
    v_add_f32 v73, v73, v21
    v_mul_f32 v56, 0x3f3504f3, v70
    v_mul_f32 v21, 0xbf3504f3, v70
    v_fmac_f32 v56, 0x3f3504f3, v79
    v_fmac_f32 v21, 0x3f3504f3, v79
    v_sub_f32 v70, v72, v20
    v_sub_f32 v79, v45, v53
    v_add_f32 v72, v72, v20
    v_add_f32 v45, v45, v53
    v_mul_f32 v20, 0x3f0e39da, v70
    v_mul_f32 v53, 0xbf54db31, v70
    v_fmac_f32 v20, 0x3f54db31, v79
    v_fmac_f32 v53, 0x3f0e39da, v79
    v_sub_f32 v70, v44, v52
    v_sub_f32 v79, v29, v37
    v_add_f32 v44, v44, v52
    v_add_f32 v29, v29, v37
    v_mul_f32 v52, 0x3ec3ef15, v70
    v_mul_f32 v37, 0xbf6c835e, v70
    v_fmac_f32 v52, 0x3f6c835e, v79
    v_fmac_f32 v37, 0x3ec3ef15, v79
    v_sub_f32 v70, v28, v36
    v_sub_f32 v79, v61, v69
    v_add_f32 v28, v28, v36
    v_add_f32 v61, v61, v69
    v_mul_f32 v36, 0x3e47c5c2, v70
    v_mul_f32 v69, 0xbf7b14be, v70
    v_fmac_f32 v36, 0x3f7b14be, v79
    v_fmac_f32 v69, 0x3e47c5c2, v79
    v_sub_f32 v70, v77, v19
    v_sub_f32 v79, v68, v60
    v_add_f32 v60, v60, v68
    v_add_f32 v77, v77, v19
    v_sub_f32 v68, v76, v18
    v_sub_f32 v19, v47, v51
    v_add_f32 v76, v76, v18
    v_add_f32 v47, v47, v51
    v_mul_f32 v18, 0xbe47c5c2, v68
    v_mul_f32 v51, 0xbf7b14be, v68
    v_fmac_f32 v18, 0x3f7b14be, v19
    v_fmac_f32 v51, 0xbe47c5c2, v19
    v_sub_f32 v68, v46, v50
    v_sub_f32 v19, v31, v35
    v_add_f32 v46, v46, v50
    v_add_f32 v31, v31, v35
    v_mul_f32 v50, 0xbec3ef15, v68
    v_mul_f32 v35, 0xbf6c835e, v68
    v_fmac_f32 v50, 0x3f6c835e, v19
    v_fmac_f32 v35, 0xbec3ef15, v19
    v_sub_f32 v68, v30, v34
    v_sub_f32 v19, v63, v67
    v_add_f32 v30, v30, v34
    v_add_f32 v63, v63, v67
    v_mul_f32 v34, 0xbf0e39da, v68
    v_mul_f32 v67, 0xbf54db31, v68
    v_fmac_f32 v34, 0x3f54db31, v19
    v_fmac_f32 v67, 0xbf0e39da, v19
    v_sub_f32 v68, v62, v66
    v_sub_f32 v19, v23, v27
    v_add_f32 v62, v62, v66
    v_add_f32 v23, v23, v27
    v_mul_f32 v66, 0xbf3504f3, v68
    v_mul_f32 v27, 0xbf3504f3, v68
    v_fmac_f32 v66, 0x3f3504f3, v19
    v_fmac_f32 v27, 0xbf3504f3, v19
    v_sub_f32 v68, v22, v26
    v_sub_f32 v19, v55, v59
    v_add_f32 v22, v22, v26
    v_add_f32 v55, v55, v59
    v_mul_f32 v26, 0xbf54db31, v68
    v_mul_f32 v59, 0xbf0e39da, v68
    v_fmac_f32 v26, 0x3f0e39da, v19
    v_fmac_f32 v59, 0xbf54db31, v19
    v_sub_f32 v68, v54, v58
    v_sub_f32 v19, v39, v43
    v_add_f32 v54, v54, v58
    v_add_f32 v39, v39, v43
    v_mul_f32 v58, 0xbf6c835e, v68
    v_mul_f32 v43, 0xbec3ef15, v68
    v_fmac_f32 v58, 0x3ec3ef15, v19
    v_fmac_f32 v43, 0xbf6c835e, v19
    v_sub_f32 v68, v38, v42
    v_sub_f32 v19, v71, v75
    v_add_f32 v38, v38, v42
    v_add_f32 v71, v71, v75
    v_mul_f32 v42, 0xbf7b14be, v68
    v_mul_f32 v75, 0xbe47c5c2, v68
    v_fmac_f32 v42, 0x3e47c5c2, v19
    v_fmac_f32 v75, 0xbf7b14be, v19
    v_sub_f32 v68, v16, v60
    v_sub_f32 v19, v17, v77
    v_add_f32 v16, v16, v60
    v_add_f32 v17, v17, v77
    v_sub_f32 v60, v83, v76
    v_sub_f32 v77, v81, v47
    v_add_f32 v83, v83, v76
    v_add_f32 v81, v81, v47
    v_mul_f32 v76, 0x3f6c835e, v60
    v_mul_f32 v47, 0xbec3ef15, v60
    v_fmac_f32 v76, 0x3ec3ef15, v77
    v_fmac_f32 v47, 0x3f6c835e, v77
    v_sub_f32 v60, v80, v46
    v_sub_f32 v77, v65, v31
    v_add_f32 v80, v80, v46
    v_add_f32 v65, v65, v31
    v_mul_f32 v46, 0x3f3504f3, v60
    v_mul_f32 v31, 0xbf3504f3, v60
    v_fmac_f32 v46, 0x3f3504f3, v77
    v_fmac_f32 v31, 0x3f3504f3, v77
    v_sub_f32 v60, v64, v30
    v_sub_f32 v77, v41, v63
    v_add_f32 v64, v64, v30
    v_add_f32 v41, v41, v63
    v_mul_f32 v30, 0x3ec3ef15, v60
    v_mul_f32 v63, 0xbf6c835e, v60
    v_fmac_f32 v30, 0x3f6c835e, v77
    v_fmac_f32 v63, 0x3ec3ef15, v77
    v_sub_f32 v60, v73, v23
    v_sub_f32 v77, v62, v40
    v_add_f32 v40, v40, v62
    v_add_f32 v73, v73, v23
    v_sub_f32 v62, v72, v22
    v_sub_f32 v23, v45, v55
    v_add_f32 v72, v72, v22
    v_add_f32 v45, v45, v55
    v_mul_f32 v22, 0xbec3ef15, v62
    v_mul_f32 v55, 0xbf6c835e, v62
    v_fmac_f32 v22, 0x3f6c835e, v23
    v_fmac_f32 v55, 0xbec3ef15, v23
    v_sub_f32 v62, v44, v54
    v_sub_f32 v23, v29, v39
    v_add_f32 v44, v44, v54
    v_add_f32 v29, v29, v39
    v_mul_f32 v54, 0xbf3504f3, v62
    v_mul_f32 v39, 0xbf3504f3, v62
    v_fmac_f32 v54, 0x3f3504f3, v23
    v_fmac_f32 v39, 0xbf3504f3, v23
    v_sub_f32 v62, v28, v38
    v_sub_f32 v23, v61, v71
    v_add_f32 v28, v28, v38
    v_add_f32 v61, v61, v71
    v_mul_f32 v38, 0xbf6c835e, v62
    v_mul_f32 v71, 0xbec3ef15, v62
    v_fmac_f32 v38, 0x3ec3ef15, v23
    v_fmac_f32 v71, 0xbf6c835e, v23
    v_sub_f32 v62, v48, v70
    v_sub_f32 v23, v49, v79
    v_add_f32 v48, v48, v70
    v_add_f32 v49, v49, v79
    v_sub_f32 v70, v78, v18
    v_sub_f32 v79, v33, v51
    v_add_f32 v78, v78, v18
    v_add_f32 v33, v33, v51
    v_mul_f32 v18, 0x3f6c835e, v70
    v_mul_f32 v51, 0xbec3ef15, v70
    v_fmac_f32 v18, 0x3ec3ef15, v79
    v_fmac_f32 v51, 0x3f6c835e, v79
    v_sub_f32 v70, v32, v50
    v_sub_f32 v79, v25, v35
    v_add_f32 v32, v32, v50
    v_add_f32 v25, v25, v35
    v_mul_f32 v50, 0x3f3504f3, v70
    v_mul_f32 v35, 0xbf3504f3, v70
    v_fmac_f32 v50, 0x3f3504f3, v79
    v_fmac_f32 v35, 0x3f3504f3, v79
    v_sub_f32 v70, v24, v34
    v_sub_f32 v79, v57, v67
    v_add_f32 v24, v24, v34
    v_add_f32 v57, v57, v67
    v_mul_f32 v34, 0x3ec3ef15, v70
    v_mul_f32 v67, 0xbf6c835e, v70
    v_fmac_f32 v34, 0x3f6c835e, v79
    v_fmac_f32 v67, 0x3ec3ef15, v79
    v_sub_f32 v70, v21, v27
    v_sub_f32 v79, v66, v56
    v_add_f32 v56, v56, v66
    v_add_f32 v21, v21, v27
    v_sub_f32 v66, v20, v26
    v_sub_f32 v27, v53, v59
    v_add_f32 v20, v20, v26
    v_add_f32 v53, v53, v59
    v_mul_f32 v26, 0xbec3ef15, v66
    v_mul_f32 v59, 0xbf6c835e, v66
    v_fmac_f32 v26, 0x3f6c835e, v27
    v_fmac_f32 v59, 0xbec3ef15, v27
    v_sub_f32 v66, v52, v58
    v_sub_f32 v27, v37, v43
    v_add_f32 v52, v52, v58
    v_add_f32 v37, v37, v43
    v_mul_f32 v58, 0xbf3504f3, v66
    v_mul_f32 v43, 0xbf3504f3, v66
    v_fmac_f32 v58, 0x3f3504f3, v27
    v_fmac_f32 v43, 0xbf3504f3, v27
    v_sub_f32 v66, v36, v42
    v_sub_f32 v27, v69, v75
    v_add_f32 v36, v36, v42
    v_add_f32 v69, v69, v75
    v_mul_f32 v42, 0xbf6c835e, v66
    v_mul_f32 v75, 0xbec3ef15, v66
    v_fmac_f32 v42, 0x3ec3ef15, v27
    v_fmac_f32 v75, 0xbf6c835e, v27
    v_sub_f32 v66, v16, v40
    v_sub_f32 v27, v17, v73
    v_add_f32 v16, v16, v40
    v_add_f32 v17, v17, v73
    v_sub_f32 v40, v83, v72
    v_sub_f32 v73, v81, v45
    v_add_f32 v83, v83, v72
    v_add_f32 v81, v81, v45
    v_mul_f32 v72, 0x3f3504f3, v40
    v_mul_f32 v45, 0xbf3504f3, v40
    v_fmac_f32 v72, 0x3f3504f3, v73
    v_fmac_f32 v45, 0x3f3504f3, v73
    v_sub_f32 v40, v65, v29
    v_sub_f32 v73, v44, v80
    v_add_f32 v80, v80, v44
    v_add_f32 v65, v65, v29
    v_sub_f32 v44, v64, v28
    v_sub_f32 v29, v41, v61
    v_add_f32 v64, v64, v28
    v_add_f32 v41, v41, v61
    v_mul_f32 v28, 0xbf3504f3, v44
    v_mul_f32 v61, 0xbf3504f3, v44
    v_fmac_f32 v28, 0x3f3504f3, v29
    v_fmac_f32 v61, 0xbf3504f3, v29
    v_sub_f32 v44, v68, v60
    v_sub_f32 v29, v19, v77
    v_add_f32 v68, v68, v60
    v_add_f32 v19, v19, v77
    v_sub_f32 v60, v76, v22
    v_sub_f32 v77, v47, v55
    v_add_f32 v76, v76, v22
    v_add_f32 v47, v47, v55
    v_mul_f32 v22, 0x3f3504f3, v60
    v_mul_f32 v55, 0xbf3504f3, v60
    v_fmac_f32 v22, 0x3f3504f3, v77
    v_fmac_f32 v55, 0x3f3504f3, v77
    v_sub_f32 v60, v31, v39
    v_sub_f32 v77, v54, v46
    v_add_f32 v46, v46, v54
    v_add_f32 v31, v31, v39
    v_sub_f32 v54, v30, v38
    v_sub_f32 v39, v63, v71
    v_add_f32 v30, v30, v38
    v_add_f32 v63, v63, v71
    v_mul_f32 v38, 0xbf3504f3, v54
    v_mul_f32 v71, 0xbf3504f3, v54
    v_fmac_f32 v38, 0x3f3504f3, v39
    v_fmac_f32 v71, 0xbf3504f3, v39
    v_sub_f32 v54, v48, v56
    v_sub_f32 v39, v49, v21
    v_add_f32 v48, v48, v56
    v_add_f32 v49, v49, v21
    v_sub_f32 v56, v78, v20
    v_sub_f32 v21, v33, v53
    v_add_f32 v78, v78, v20
    v_add_f32 v33, v33, v53
    v_mul_f32 v20, 0x3f3504f3, v56
    v_mul_f32 v53, 0xbf3504f3, v56
    v_fmac_f32 v20, 0x3f3504f3, v21
    v_fmac_f32 v53, 0x3f3504f3, v21
    v_sub_f32 v56, v25, v37
    v_sub_f32 v21, v52, v32
    v_add_f32 v32, v32, v52
    v_add_f32 v25, v25, v37
    v_sub_f32 v52, v24, v36
    v_sub_f32 v37, v57, v69
    v_add_f32 v24, v24, v36
    v_add_f32 v57, v57, v69
    v_mul_f32 v36, 0xbf3504f3, v52
    v_mul_f32 v69, 0xbf3504f3, v52
    v_fmac_f32 v36, 0x3f3504f3, v37
    v_fmac_f32 v69, 0xbf3504f3, v37
    v_sub_f32 v52, v62, v70
    v_sub_f32 v37, v23, v79
    v_add_f32 v62, v62, v70
    v_add_f32 v23, v23, v79
    v_sub_f32 v70, v18, v26
    v_sub_f32 v79, v51, v59
    v_add_f32 v18, v18, v26
    v_add_f32 v51, v51, v59
    v_mul_f32 v26, 0x3f3504f3, v70
    v_mul_f32 v59, 0xbf3504f3, v70
    v_fmac_f32 v26, 0x3f3504f3, v79
    v_fmac_f32 v59, 0x3f3504f3, v79
    v_sub_f32 v70, v35, v43
    v_sub_f32 v79, v58, v50
    v_add_f32 v50, v50, v58
    v_add_f32 v35, v35, v43
    v_sub_f32 v58, v34, v42
    v_sub_f32 v43, v67, v75
    v_add_f32 v34, v34, v42
    v_add_f32 v67, v67, v75
    v_mul_f32 v42, 0xbf3504f3, v58
    v_mul_f32 v75, 0xbf3504f3, v58
    v_fmac_f32 v42, 0x3f3504f3, v43
    v_fmac_f32 v75, 0xbf3504f3, v43
    v_sub_f32 v58, v16, v80
    v_sub_f32 v43, v17, v65
    v_add_f32 v16, v16, v80
    v_add_f32 v17, v17, v65
    v_sub_f32 v80, v81, v41
    v_sub_f32 v65, v64, v83
    v_add_f32 v83, v83, v64
    v_add_f32 v81, v81, v41
    v_sub_f32 v64, v66, v40
    v_sub_f32 v41, v27, v73
    v_add_f32 v66, v66, v40
    v_add_f32 v27, v27, v73
    v_sub_f32 v40, v45, v61
    v_sub_f32 v73, v28, v72
    v_add_f32 v72, v72, v28
    v_add_f32 v45, v45, v61
    v_sub_f32 v28, v68, v46
    v_sub_f32 v61, v19, v31
    v_add_f32 v68, v68, v46
    v_add_f32 v19, v19, v31
    v_sub_f32 v46, v47, v63
    v_sub_f32 v31, v30, v76
    v_add_f32 v76, v76, v30
    v_add_f32 v47, v47, v63
    v_sub_f32 v30, v44, v60
    v_sub_f32 v63, v29, v77
    v_add_f32 v44, v44, v60
    v_add_f32 v29, v29, v77
    v_sub_f32 v60, v55, v71
    v_sub_f32 v77, v38, v22
    v_add_f32 v22, v22, v38
    v_add_f32 v55, v55, v71
    v_sub_f32 v38, v48, v32
    v_sub_f32 v71, v49, v25
    v_add_f32 v48, v48, v32
    v_add_f32 v49, v49, v25
    v_sub_f32 v32, v33, v57
    v_sub_f32 v25, v24, v78
    v_add_f32 v78, v78, v24
    v_add_f32 v33, v33, v57
    v_sub_f32 v24, v54, v56
    v_sub_f32 v57, v39, v21
    v_add_f32 v54, v54, v56
    v_add_f32 v39, v39, v21
    v_sub_f32 v56, v53, v69
    v_sub_f32 v21, v36, v20
    v_add_f32 v20, v20, v36
    v_add_f32 v53, v53, v69
    v_sub_f32 v36, v62, v50
    v_sub_f32 v69, v23, v35
    v_add_f32 v62, v62, v50
    v_add_f32 v23, v23, v35
    v_sub_f32 v50, v51, v67
    v_sub_f32 v35, v34, v18
    v_add_f32 v18, v18, v34
    v_add_f32 v51, v51, v67
    v_sub_f32 v34, v52, v70
    v_sub_f32 v67, v37, v79
    v_add_f32 v52, v52, v70
    v_add_f32 v37, v37, v79
    v_sub_f32 v70, v59, v75
    v_sub_f32 v79, v42, v26
    v_add_f32 v26, v26, v42
    v_add_f32 v59, v59, v75
    v_sub_f32 v42, v16, v83
    v_sub_f32 v75, v17, v81
    v_add_f32 v16, v16, v83
    v_add_f32 v17, v17, v81
    v_sub_f32 v83, v58, v80
    v_sub_f32 v81, v43, v65
    v_add_f32 v58, v58, v80
    v_add_f32 v43, v43, v65
    v_sub_f32 v80, v66, v72
    v_sub_f32 v65, v27, v45
    v_add_f32 v66, v66, v72
    v_add_f32 v27, v27, v45
    v_sub_f32 v72, v64, v40
    v_sub_f32 v45, v41, v73
    v_add_f32 v64, v64, v40
    v_add_f32 v41, v41, v73
    v_sub_f32 v40, v68, v76
    v_sub_f32 v73, v19, v47
    v_add_f32 v68, v68, v76
    v_add_f32 v19, v19, v47
    v_sub_f32 v76, v28, v46
    v_sub_f32 v47, v61, v31
    v_add_f32 v28, v28, v46
    v_add_f32 v61, v61, v31
    v_sub_f32 v46, v44, v22
    v_sub_f32 v31, v29, v55
    v_add_f32 v44, v44, v22
    v_add_f32 v29, v29, v55
    v_sub_f32 v22, v30, v60
    v_sub_f32 v55, v63, v77
    v_add_f32 v30, v30, v60
    v_add_f32 v63, v63, v77
    v_sub_f32 v60, v48, v78
    v_sub_f32 v77, v49, v33
    v_add_f32 v48, v48, v78
    v_add_f32 v49, v49, v33
    v_sub_f32 v78, v38, v32
    v_sub_f32 v33, v71, v25
    v_add_f32 v38, v38, v32
    v_add_f32 v71, v71, v25
    v_sub_f32 v32, v54, v20
    v_sub_f32 v25, v39, v53
    v_add_f32 v54, v54, v20
    v_add_f32 v39, v39, v53
    v_sub_f32 v20, v24, v56
    v_sub_f32 v53, v57, v21
    v_add_f32 v24, v24, v56
    v_add_f32 v57, v57, v21
    v_sub_f32 v56, v62, v18
    v_sub_f32 v21, v23, v51
    v_add_f32 v62, v62, v18
    v_add_f32 v23, v23, v51
    v_sub_f32 v18, v36, v50
    v_sub_f32 v51, v69, v35
    v_add_f32 v36, v36, v50
    v_add_f32 v69, v69, v35
    v_sub_f32 v50, v52, v26
    v_sub_f32 v35, v37, v59
    v_add_f32 v52, v52, v26
    v_add_f32 v37, v37, v59
    v_sub_f32 v26, v34, v70
    v_sub_f32 v59, v67, v79
    v_add_f32 v34, v34, v70
    v_add_f32 v67, v67, v79
    v_mul_f32 v70, 0xbc800000, v10
    v_cos_f32 v79, v70
    v_sin_f32 v82, v70
    s_nop 0
    v_mul_f32 v74, v48, v79
    v_fma_f32 v74, -v49, v82, v74
    v_mul_f32 v49, v49, v79
    v_fmac_f32 v49, v48, v82
    v_mul_f32 v70, 0xbd000000, v10
    v_cos_f32 v79, v70
    v_sin_f32 v82, v70
    s_nop 0
    v_mul_f32 v48, v68, v79
    v_fma_f32 v48, -v19, v82, v48
    v_mul_f32 v19, v19, v79
    v_fmac_f32 v19, v68, v82
    v_mul_f32 v70, 0xbd400000, v10
    v_cos_f32 v79, v70
    v_sin_f32 v82, v70
    s_nop 0
    v_mul_f32 v68, v62, v79
    v_fma_f32 v68, -v23, v82, v68
    v_mul_f32 v23, v23, v79
    v_fmac_f32 v23, v62, v82
    v_mul_f32 v70, 0xbd800000, v10
    v_cos_f32 v79, v70
    v_sin_f32 v82, v70
    s_nop 0
    v_mul_f32 v62, v66, v79
    v_fma_f32 v62, -v27, v82, v62
    v_mul_f32 v27, v27, v79
    v_fmac_f32 v27, v66, v82
    v_mul_f32 v70, 0xbda00000, v10
    v_cos_f32 v79, v70
    v_sin_f32 v82, v70
    s_nop 0
    v_mul_f32 v66, v54, v79
    v_fma_f32 v66, -v39, v82, v66
    v_mul_f32 v39, v39, v79
    v_fmac_f32 v39, v54, v82
    v_mul_f32 v70, 0xbdc00000, v10
    v_cos_f32 v79, v70
    v_sin_f32 v82, v70
    s_nop 0
    v_mul_f32 v54, v44, v79
    v_fma_f32 v54, -v29, v82, v54
    v_mul_f32 v29, v29, v79
    v_fmac_f32 v29, v44, v82
    v_mul_f32 v70, 0xbde00000, v10
    v_cos_f32 v79, v70
    v_sin_f32 v82, v70
    s_nop 0
    v_mul_f32 v44, v52, v79
    v_fma_f32 v44, -v37, v82, v44
    v_mul_f32 v37, v37, v79
    v_fmac_f32 v37, v52, v82
    v_mul_f32 v70, 0xbe000000, v10
    v_cos_f32 v79, v70
    v_sin_f32 v82, v70
    s_nop 0
    v_mul_f32 v52, v58, v79
    v_fma_f32 v52, -v43, v82, v52
    v_mul_f32 v43, v43, v79
    v_fmac_f32 v43, v58, v82
    v_mul_f32 v70, 0xbe100000, v10
    v_cos_f32 v79, v70
    v_sin_f32 v82, v70
    s_nop 0
    v_mul_f32 v58, v38, v79
    v_fma_f32 v58, -v71, v82, v58
    v_mul_f32 v71, v71, v79
    v_fmac_f32 v71, v38, v82
    v_mul_f32 v70, 0xbe200000, v10
    v_cos_f32 v79, v70
    v_sin_f32 v82, v70
    s_nop 0
    v_mul_f32 v38, v28, v79
    v_fma_f32 v38, -v61, v82, v38
    v_mul_f32 v61, v61, v79
    v_fmac_f32 v61, v28, v82
    v_mul_f32 v70, 0xbe300000, v10
    v_cos_f32 v79, v70
    v_sin_f32 v82, v70
    s_nop 0
    v_mul_f32 v28, v36, v79
    v_fma_f32 v28, -v69, v82, v28
    v_mul_f32 v69, v69, v79
    v_fmac_f32 v69, v36, v82
    v_mul_f32 v70, 0xbe400000, v10
    v_cos_f32 v79, v70
    v_sin_f32 v82, v70
    s_nop 0
    v_mul_f32 v36, v64, v79
    v_fma_f32 v36, -v41, v82, v36
    v_mul_f32 v41, v41, v79
    v_fmac_f32 v41, v64, v82
    v_mul_f32 v70, 0xbe500000, v10
    v_cos_f32 v79, v70
    v_sin_f32 v82, v70
    s_nop 0
    v_mul_f32 v64, v24, v79
    v_fma_f32 v64, -v57, v82, v64
    v_mul_f32 v57, v57, v79
    v_fmac_f32 v57, v24, v82
    v_mul_f32 v70, 0xbe600000, v10
    v_cos_f32 v79, v70
    v_sin_f32 v82, v70
    s_nop 0
    v_mul_f32 v24, v30, v79
    v_fma_f32 v24, -v63, v82, v24
    v_mul_f32 v63, v63, v79
    v_fmac_f32 v63, v30, v82
    v_mul_f32 v70, 0xbe700000, v10
    v_cos_f32 v79, v70
    v_sin_f32 v82, v70
    s_nop 0
    v_mul_f32 v30, v34, v79
    v_fma_f32 v30, -v67, v82, v30
    v_mul_f32 v67, v67, v79
    v_fmac_f32 v67, v34, v82
    v_mul_f32 v70, 0xbe800000, v10
    v_cos_f32 v79, v70
    v_sin_f32 v82, v70
    s_nop 0
    v_mul_f32 v34, v42, v79
    v_fma_f32 v34, -v75, v82, v34
    v_mul_f32 v75, v75, v79
    v_fmac_f32 v75, v42, v82
    v_mul_f32 v70, 0xbe880000, v10
    v_cos_f32 v79, v70
    v_sin_f32 v82, v70
    s_nop 0
    v_mul_f32 v42, v60, v79
    v_fma_f32 v42, -v77, v82, v42
    v_mul_f32 v77, v77, v79
    v_fmac_f32 v77, v60, v82
    v_mul_f32 v70, 0xbe900000, v10
    v_cos_f32 v79, v70
    v_sin_f32 v82, v70
    s_nop 0
    v_mul_f32 v60, v40, v79
    v_fma_f32 v60, -v73, v82, v60
    v_mul_f32 v73, v73, v79
    v_fmac_f32 v73, v40, v82
    v_mul_f32 v70, 0xbe980000, v10
    v_cos_f32 v79, v70
    v_sin_f32 v82, v70
    s_nop 0
    v_mul_f32 v40, v56, v79
    v_fma_f32 v40, -v21, v82, v40
    v_mul_f32 v21, v21, v79
    v_fmac_f32 v21, v56, v82
    v_mul_f32 v70, 0xbea00000, v10
    v_cos_f32 v79, v70
    v_sin_f32 v82, v70
    s_nop 0
    v_mul_f32 v56, v80, v79
    v_fma_f32 v56, -v65, v82, v56
    v_mul_f32 v65, v65, v79
    v_fmac_f32 v65, v80, v82
    v_mul_f32 v70, 0xbea80000, v10
    v_cos_f32 v79, v70
    v_sin_f32 v82, v70
    s_nop 0
    v_mul_f32 v80, v32, v79
    v_fma_f32 v80, -v25, v82, v80
    v_mul_f32 v25, v25, v79
    v_fmac_f32 v25, v32, v82
    v_mul_f32 v70, 0xbeb00000, v10
    v_cos_f32 v79, v70
    v_sin_f32 v82, v70
    s_nop 0
    v_mul_f32 v32, v46, v79
    v_fma_f32 v32, -v31, v82, v32
    v_mul_f32 v31, v31, v79
    v_fmac_f32 v31, v46, v82
    v_mul_f32 v70, 0xbeb80000, v10
    v_cos_f32 v79, v70
    v_sin_f32 v82, v70
    s_nop 0
    v_mul_f32 v46, v50, v79
    v_fma_f32 v46, -v35, v82, v46
    v_mul_f32 v35, v35, v79
    v_fmac_f32 v35, v50, v82
    v_mul_f32 v70, 0xbec00000, v10
    v_cos_f32 v79, v70
    v_sin_f32 v82, v70
    s_nop 0
    v_mul_f32 v50, v83, v79
    v_fma_f32 v50, -v81, v82, v50
    v_mul_f32 v81, v81, v79
    v_fmac_f32 v81, v83, v82
    v_mul_f32 v70, 0xbec80000, v10
    v_cos_f32 v79, v70
    v_sin_f32 v82, v70
    s_nop 0
    v_mul_f32 v83, v78, v79
    v_fma_f32 v83, -v33, v82, v83
    v_mul_f32 v33, v33, v79
    v_fmac_f32 v33, v78, v82
    v_mul_f32 v70, 0xbed00000, v10
    v_cos_f32 v79, v70
    v_sin_f32 v82, v70
    s_nop 0
    v_mul_f32 v78, v76, v79
    v_fma_f32 v78, -v47, v82, v78
    v_mul_f32 v47, v47, v79
    v_fmac_f32 v47, v76, v82
    v_mul_f32 v70, 0xbed80000, v10
    v_cos_f32 v79, v70
    v_sin_f32 v82, v70
    s_nop 0
    v_mul_f32 v76, v18, v79
    v_fma_f32 v76, -v51, v82, v76
    v_mul_f32 v51, v51, v79
    v_fmac_f32 v51, v18, v82
    v_mul_f32 v70, 0xbee00000, v10
    v_cos_f32 v79, v70
    v_sin_f32 v82, v70
    s_nop 0
    v_mul_f32 v18, v72, v79
    v_fma_f32 v18, -v45, v82, v18
    v_mul_f32 v45, v45, v79
    v_fmac_f32 v45, v72, v82
    v_mul_f32 v70, 0xbee80000, v10
    v_cos_f32 v79, v70
    v_sin_f32 v82, v70
    s_nop 0
    v_mul_f32 v72, v20, v79
    v_fma_f32 v72, -v53, v82, v72
    v_mul_f32 v53, v53, v79
    v_fmac_f32 v53, v20, v82
    v_mul_f32 v70, 0xbef00000, v10
    v_cos_f32 v79, v70
    v_sin_f32 v82, v70
    s_nop 0
    v_mul_f32 v20, v22, v79
    v_fma_f32 v20, -v55, v82, v20
    v_mul_f32 v55, v55, v79
    v_fmac_f32 v55, v22, v82
    v_mul_f32 v70, 0xbef80000, v10
    v_cos_f32 v79, v70
    v_sin_f32 v82, v70
    s_nop 0
    v_mul_f32 v22, v26, v79
    v_fma_f32 v22, -v59, v82, v22
    v_mul_f32 v59, v59, v79
    v_fmac_f32 v59, v26, v82
    s_nop 1
    v_mov_b32_dpp v70, v16 quad_perm:[1,0,3,2] row_mask:0xf bank_mask:0xf
    v_fma_f32 v16, v16, v9, v70
    v_mov_b32_dpp v70, v17 quad_perm:[1,0,3,2] row_mask:0xf bank_mask:0xf
    v_fma_f32 v17, v17, v9, v70
    v_mov_b32_dpp v70, v74 quad_perm:[1,0,3,2] row_mask:0xf bank_mask:0xf
    v_fma_f32 v74, v74, v9, v70
    v_mov_b32_dpp v70, v49 quad_perm:[1,0,3,2] row_mask:0xf bank_mask:0xf
    v_fma_f32 v49, v49, v9, v70
    v_mov_b32_dpp v70, v48 quad_perm:[1,0,3,2] row_mask:0xf bank_mask:0xf
    v_fma_f32 v48, v48, v9, v70
    v_mov_b32_dpp v70, v19 quad_perm:[1,0,3,2] row_mask:0xf bank_mask:0xf
    v_fma_f32 v19, v19, v9, v70
    v_mov_b32_dpp v70, v68 quad_perm:[1,0,3,2] row_mask:0xf bank_mask:0xf
    v_fma_f32 v68, v68, v9, v70
    v_mov_b32_dpp v70, v23 quad_perm:[1,0,3,2] row_mask:0xf bank_mask:0xf
    v_fma_f32 v23, v23, v9, v70
    v_mov_b32_dpp v70, v62 quad_perm:[1,0,3,2] row_mask:0xf bank_mask:0xf
    v_fma_f32 v62, v62, v9, v70
    v_mov_b32_dpp v70, v27 quad_perm:[1,0,3,2] row_mask:0xf bank_mask:0xf
    v_fma_f32 v27, v27, v9, v70
    v_mov_b32_dpp v70, v66 quad_perm:[1,0,3,2] row_mask:0xf bank_mask:0xf
    v_fma_f32 v66, v66, v9, v70
    v_mov_b32_dpp v70, v39 quad_perm:[1,0,3,2] row_mask:0xf bank_mask:0xf
    v_fma_f32 v39, v39, v9, v70
    v_mov_b32_dpp v70, v54 quad_perm:[1,0,3,2] row_mask:0xf bank_mask:0xf
    v_fma_f32 v54, v54, v9, v70
    v_mov_b32_dpp v70, v29 quad_perm:[1,0,3,2] row_mask:0xf bank_mask:0xf
    v_fma_f32 v29, v29, v9, v70
    v_mov_b32_dpp v70, v44 quad_perm:[1,0,3,2] row_mask:0xf bank_mask:0xf
    v_fma_f32 v44, v44, v9, v70
    v_mov_b32_dpp v70, v37 quad_perm:[1,0,3,2] row_mask:0xf bank_mask:0xf
    v_fma_f32 v37, v37, v9, v70
    v_mov_b32_dpp v70, v52 quad_perm:[1,0,3,2] row_mask:0xf bank_mask:0xf
    v_fma_f32 v52, v52, v9, v70
    v_mov_b32_dpp v70, v43 quad_perm:[1,0,3,2] row_mask:0xf bank_mask:0xf
    v_fma_f32 v43, v43, v9, v70
    v_mov_b32_dpp v70, v58 quad_perm:[1,0,3,2] row_mask:0xf bank_mask:0xf
    v_fma_f32 v58, v58, v9, v70
    v_mov_b32_dpp v70, v71 quad_perm:[1,0,3,2] row_mask:0xf bank_mask:0xf
    v_fma_f32 v71, v71, v9, v70
    v_mov_b32_dpp v70, v38 quad_perm:[1,0,3,2] row_mask:0xf bank_mask:0xf
    v_fma_f32 v38, v38, v9, v70
    v_mov_b32_dpp v70, v61 quad_perm:[1,0,3,2] row_mask:0xf bank_mask:0xf
    v_fma_f32 v61, v61, v9, v70
    v_mov_b32_dpp v70, v28 quad_perm:[1,0,3,2] row_mask:0xf bank_mask:0xf
    v_fma_f32 v28, v28, v9, v70
    v_mov_b32_dpp v70, v69 quad_perm:[1,0,3,2] row_mask:0xf bank_mask:0xf
    v_fma_f32 v69, v69, v9, v70
    v_mov_b32_dpp v70, v36 quad_perm:[1,0,3,2] row_mask:0xf bank_mask:0xf
    v_fma_f32 v36, v36, v9, v70
    v_mov_b32_dpp v70, v41 quad_perm:[1,0,3,2] row_mask:0xf bank_mask:0xf
    v_fma_f32 v41, v41, v9, v70
    v_mov_b32_dpp v70, v64 quad_perm:[1,0,3,2] row_mask:0xf bank_mask:0xf
    v_fma_f32 v64, v64, v9, v70
    v_mov_b32_dpp v70, v57 quad_perm:[1,0,3,2] row_mask:0xf bank_mask:0xf
    v_fma_f32 v57, v57, v9, v70
    v_mov_b32_dpp v70, v24 quad_perm:[1,0,3,2] row_mask:0xf bank_mask:0xf
    v_fma_f32 v24, v24, v9, v70
    v_mov_b32_dpp v70, v63 quad_perm:[1,0,3,2] row_mask:0xf bank_mask:0xf
    v_fma_f32 v63, v63, v9, v70
    v_mov_b32_dpp v70, v30 quad_perm:[1,0,3,2] row_mask:0xf bank_mask:0xf
    v_fma_f32 v30, v30, v9, v70
    v_mov_b32_dpp v70, v67 quad_perm:[1,0,3,2] row_mask:0xf bank_mask:0xf
    v_fma_f32 v67, v67, v9, v70
    v_mov_b32_dpp v70, v34 quad_perm:[1,0,3,2] row_mask:0xf bank_mask:0xf
    v_fma_f32 v34, v34, v9, v70
    v_mov_b32_dpp v70, v75 quad_perm:[1,0,3,2] row_mask:0xf bank_mask:0xf
    v_fma_f32 v75, v75, v9, v70
    v_mov_b32_dpp v70, v42 quad_perm:[1,0,3,2] row_mask:0xf bank_mask:0xf
    v_fma_f32 v42, v42, v9, v70
    v_mov_b32_dpp v70, v77 quad_perm:[1,0,3,2] row_mask:0xf bank_mask:0xf
    v_fma_f32 v77, v77, v9, v70
    v_mov_b32_dpp v70, v60 quad_perm:[1,0,3,2] row_mask:0xf bank_mask:0xf
    v_fma_f32 v60, v60, v9, v70
    v_mov_b32_dpp v70, v73 quad_perm:[1,0,3,2] row_mask:0xf bank_mask:0xf
    v_fma_f32 v73, v73, v9, v70
    v_mov_b32_dpp v70, v40 quad_perm:[1,0,3,2] row_mask:0xf bank_mask:0xf
    v_fma_f32 v40, v40, v9, v70
    v_mov_b32_dpp v70, v21 quad_perm:[1,0,3,2] row_mask:0xf bank_mask:0xf
    v_fma_f32 v21, v21, v9, v70
    v_mov_b32_dpp v70, v56 quad_perm:[1,0,3,2] row_mask:0xf bank_mask:0xf
    v_fma_f32 v56, v56, v9, v70
    v_mov_b32_dpp v70, v65 quad_perm:[1,0,3,2] row_mask:0xf bank_mask:0xf
    v_fma_f32 v65, v65, v9, v70
    v_mov_b32_dpp v70, v80 quad_perm:[1,0,3,2] row_mask:0xf bank_mask:0xf
    v_fma_f32 v80, v80, v9, v70
    v_mov_b32_dpp v70, v25 quad_perm:[1,0,3,2] row_mask:0xf bank_mask:0xf
    v_fma_f32 v25, v25, v9, v70
    v_mov_b32_dpp v70, v32 quad_perm:[1,0,3,2] row_mask:0xf bank_mask:0xf
    v_fma_f32 v32, v32, v9, v70
    v_mov_b32_dpp v70, v31 quad_perm:[1,0,3,2] row_mask:0xf bank_mask:0xf
    v_fma_f32 v31, v31, v9, v70
    v_mov_b32_dpp v70, v46 quad_perm:[1,0,3,2] row_mask:0xf bank_mask:0xf
    v_fma_f32 v46, v46, v9, v70
    v_mov_b32_dpp v70, v35 quad_perm:[1,0,3,2] row_mask:0xf bank_mask:0xf
    v_fma_f32 v35, v35, v9, v70
    v_mov_b32_dpp v70, v50 quad_perm:[1,0,3,2] row_mask:0xf bank_mask:0xf
    v_fma_f32 v50, v50, v9, v70
    v_mov_b32_dpp v70, v81 quad_perm:[1,0,3,2] row_mask:0xf bank_mask:0xf
    v_fma_f32 v81, v81, v9, v70
    v_mov_b32_dpp v70, v83 quad_perm:[1,0,3,2] row_mask:0xf bank_mask:0xf
    v_fma_f32 v83, v83, v9, v70
    v_mov_b32_dpp v70, v33 quad_perm:[1,0,3,2] row_mask:0xf bank_mask:0xf
    v_fma_f32 v33, v33, v9, v70
    v_mov_b32_dpp v70, v78 quad_perm:[1,0,3,2] row_mask:0xf bank_mask:0xf
    v_fma_f32 v78, v78, v9, v70
    v_mov_b32_dpp v70, v47 quad_perm:[1,0,3,2] row_mask:0xf bank_mask:0xf
    v_fma_f32 v47, v47, v9, v70
    v_mov_b32_dpp v70, v76 quad_perm:[1,0,3,2] row_mask:0xf bank_mask:0xf
    v_fma_f32 v76, v76, v9, v70
    v_mov_b32_dpp v70, v51 quad_perm:[1,0,3,2] row_mask:0xf bank_mask:0xf
    v_fma_f32 v51, v51, v9, v70
    v_mov_b32_dpp v70, v18 quad_perm:[1,0,3,2] row_mask:0xf bank_mask:0xf
    v_fma_f32 v18, v18, v9, v70
    v_mov_b32_dpp v70, v45 quad_perm:[1,0,3,2] row_mask:0xf bank_mask:0xf
    v_fma_f32 v45, v45, v9, v70
    v_mov_b32_dpp v70, v72 quad_perm:[1,0,3,2] row_mask:0xf bank_mask:0xf
    v_fma_f32 v72, v72, v9, v70
    v_mov_b32_dpp v70, v53 quad_perm:[1,0,3,2] row_mask:0xf bank_mask:0xf
    v_fma_f32 v53, v53, v9, v70
    v_mov_b32_dpp v70, v20 quad_perm:[1,0,3,2] row_mask:0xf bank_mask:0xf
    v_fma_f32 v20, v20, v9, v70
    v_mov_b32_dpp v70, v55 quad_perm:[1,0,3,2] row_mask:0xf bank_mask:0xf
    v_fma_f32 v55, v55, v9, v70
    v_mov_b32_dpp v70, v22 quad_perm:[1,0,3,2] row_mask:0xf bank_mask:0xf
    v_fma_f32 v22, v22, v9, v70
    v_mov_b32_dpp v70, v59 quad_perm:[1,0,3,2] row_mask:0xf bank_mask:0xf
    v_fma_f32 v59, v59, v9, v70
    s_waitcnt vmcnt(0)
    s_mov_b32 s20, 0x34800000
    v_lshlrev_b32 v70, 16, v88
    v_and_b32 v79, 0xffff0000, v88
    v_mul_f32 v70, s20, v70
    v_mul_f32 v79, s20, v79
    v_mul_f32 v82, v16, v70
    v_fma_f32 v82, -v17, v79, v82
    v_mul_f32 v17, v17, v70
    v_fmac_f32 v17, v16, v79
    v_lshlrev_b32 v70, 16, v89
    v_and_b32 v79, 0xffff0000, v89
    v_mul_f32 v70, s20, v70
    v_mul_f32 v79, s20, v79
    v_mul_f32 v16, v74, v70
    v_fma_f32 v16, -v49, v79, v16
    v_mul_f32 v49, v49, v70
    v_fmac_f32 v49, v74, v79
    v_lshlrev_b32 v70, 16, v90
    v_and_b32 v79, 0xffff0000, v90
    v_mul_f32 v70, s20, v70
    v_mul_f32 v79, s20, v79
    v_mul_f32 v74, v48, v70
    v_fma_f32 v74, -v19, v79, v74
    v_mul_f32 v19, v19, v70
    v_fmac_f32 v19, v48, v79
    v_lshlrev_b32 v70, 16, v91
    v_and_b32 v79, 0xffff0000, v91
    v_mul_f32 v70, s20, v70
    v_mul_f32 v79, s20, v79
    v_mul_f32 v48, v68, v70
    v_fma_f32 v48, -v23, v79, v48
    v_mul_f32 v23, v23, v70
    v_fmac_f32 v23, v68, v79
    v_lshlrev_b32 v70, 16, v92
    v_and_b32 v79, 0xffff0000, v92
    v_mul_f32 v70, s20, v70
    v_mul_f32 v79, s20, v79
    v_mul_f32 v68, v62, v70
    v_fma_f32 v68, -v27, v79, v68
    v_mul_f32 v27, v27, v70
    v_fmac_f32 v27, v62, v79
    v_lshlrev_b32 v70, 16, v93
    v_and_b32 v79, 0xffff0000, v93
    v_mul_f32 v70, s20, v70
    v_mul_f32 v79, s20, v79
    v_mul_f32 v62, v66, v70
    v_fma_f32 v62, -v39, v79, v62
    v_mul_f32 v39, v39, v70
    v_fmac_f32 v39, v66, v79
    v_lshlrev_b32 v70, 16, v94
    v_and_b32 v79, 0xffff0000, v94
    v_mul_f32 v70, s20, v70
    v_mul_f32 v79, s20, v79
    v_mul_f32 v66, v54, v70
    v_fma_f32 v66, -v29, v79, v66
    v_mul_f32 v29, v29, v70
    v_fmac_f32 v29, v54, v79
    v_lshlrev_b32 v70, 16, v95
    v_and_b32 v79, 0xffff0000, v95
    v_mul_f32 v70, s20, v70
    v_mul_f32 v79, s20, v79
    v_mul_f32 v54, v44, v70
    v_fma_f32 v54, -v37, v79, v54
    v_mul_f32 v37, v37, v70
    v_fmac_f32 v37, v44, v79
    v_lshlrev_b32 v70, 16, v96
    v_and_b32 v79, 0xffff0000, v96
    v_mul_f32 v70, s20, v70
    v_mul_f32 v79, s20, v79
    v_mul_f32 v44, v52, v70
    v_fma_f32 v44, -v43, v79, v44
    v_mul_f32 v43, v43, v70
    v_fmac_f32 v43, v52, v79
    v_lshlrev_b32 v70, 16, v97
    v_and_b32 v79, 0xffff0000, v97
    v_mul_f32 v70, s20, v70
    v_mul_f32 v79, s20, v79
    v_mul_f32 v52, v58, v70
    v_fma_f32 v52, -v71, v79, v52
    v_mul_f32 v71, v71, v70
    v_fmac_f32 v71, v58, v79
    v_lshlrev_b32 v70, 16, v98
    v_and_b32 v79, 0xffff0000, v98
    v_mul_f32 v70, s20, v70
    v_mul_f32 v79, s20, v79
    v_mul_f32 v58, v38, v70
    v_fma_f32 v58, -v61, v79, v58
    v_mul_f32 v61, v61, v70
    v_fmac_f32 v61, v38, v79
    v_lshlrev_b32 v70, 16, v99
    v_and_b32 v79, 0xffff0000, v99
    v_mul_f32 v70, s20, v70
    v_mul_f32 v79, s20, v79
    v_mul_f32 v38, v28, v70
    v_fma_f32 v38, -v69, v79, v38
    v_mul_f32 v69, v69, v70
    v_fmac_f32 v69, v28, v79
    v_lshlrev_b32 v70, 16, v100
    v_and_b32 v79, 0xffff0000, v100
    v_mul_f32 v70, s20, v70
    v_mul_f32 v79, s20, v79
    v_mul_f32 v28, v36, v70
    v_fma_f32 v28, -v41, v79, v28
    v_mul_f32 v41, v41, v70
    v_fmac_f32 v41, v36, v79
    v_lshlrev_b32 v70, 16, v101
    v_and_b32 v79, 0xffff0000, v101
    v_mul_f32 v70, s20, v70
    v_mul_f32 v79, s20, v79
    v_mul_f32 v36, v64, v70
    v_fma_f32 v36, -v57, v79, v36
    v_mul_f32 v57, v57, v70
    v_fmac_f32 v57, v64, v79
    v_lshlrev_b32 v70, 16, v102
    v_and_b32 v79, 0xffff0000, v102
    v_mul_f32 v70, s20, v70
    v_mul_f32 v79, s20, v79
    v_mul_f32 v64, v24, v70
    v_fma_f32 v64, -v63, v79, v64
    v_mul_f32 v63, v63, v70
    v_fmac_f32 v63, v24, v79
    v_lshlrev_b32 v70, 16, v103
    v_and_b32 v79, 0xffff0000, v103
    v_mul_f32 v70, s20, v70
    v_mul_f32 v79, s20, v79
    v_mul_f32 v24, v30, v70
    v_fma_f32 v24, -v67, v79, v24
    v_mul_f32 v67, v67, v70
    v_fmac_f32 v67, v30, v79
    v_lshlrev_b32 v70, 16, v104
    v_and_b32 v79, 0xffff0000, v104
    v_mul_f32 v70, s20, v70
    v_mul_f32 v79, s20, v79
    v_mul_f32 v30, v34, v70
    v_fma_f32 v30, -v75, v79, v30
    v_mul_f32 v75, v75, v70
    v_fmac_f32 v75, v34, v79
    v_lshlrev_b32 v70, 16, v105
    v_and_b32 v79, 0xffff0000, v105
    v_mul_f32 v70, s20, v70
    v_mul_f32 v79, s20, v79
    v_mul_f32 v34, v42, v70
    v_fma_f32 v34, -v77, v79, v34
    v_mul_f32 v77, v77, v70
    v_fmac_f32 v77, v42, v79
    v_lshlrev_b32 v70, 16, v106
    v_and_b32 v79, 0xffff0000, v106
    v_mul_f32 v70, s20, v70
    v_mul_f32 v79, s20, v79
    v_mul_f32 v42, v60, v70
    v_fma_f32 v42, -v73, v79, v42
    v_mul_f32 v73, v73, v70
    v_fmac_f32 v73, v60, v79
    v_lshlrev_b32 v70, 16, v107
    v_and_b32 v79, 0xffff0000, v107
    v_mul_f32 v70, s20, v70
    v_mul_f32 v79, s20, v79
    v_mul_f32 v60, v40, v70
    v_fma_f32 v60, -v21, v79, v60
    v_mul_f32 v21, v21, v70
    v_fmac_f32 v21, v40, v79
    v_lshlrev_b32 v70, 16, v108
    v_and_b32 v79, 0xffff0000, v108
    v_mul_f32 v70, s20, v70
    v_mul_f32 v79, s20, v79
    v_mul_f32 v40, v56, v70
    v_fma_f32 v40, -v65, v79, v40
    v_mul_f32 v65, v65, v70
    v_fmac_f32 v65, v56, v79
    v_lshlrev_b32 v70, 16, v109
    v_and_b32 v79, 0xffff0000, v109
    v_mul_f32 v70, s20, v70
    v_mul_f32 v79, s20, v79
    v_mul_f32 v56, v80, v70
    v_fma_f32 v56, -v25, v79, v56
    v_mul_f32 v25, v25, v70
    v_fmac_f32 v25, v80, v79
    v_lshlrev_b32 v70, 16, v110
    v_and_b32 v79, 0xffff0000, v110
    v_mul_f32 v70, s20, v70
    v_mul_f32 v79, s20, v79
    v_mul_f32 v80, v32, v70
    v_fma_f32 v80, -v31, v79, v80
    v_mul_f32 v31, v31, v70
    v_fmac_f32 v31, v32, v79
    v_lshlrev_b32 v70, 16, v111
    v_and_b32 v79, 0xffff0000, v111
    v_mul_f32 v70, s20, v70
    v_mul_f32 v79, s20, v79
    v_mul_f32 v32, v46, v70
    v_fma_f32 v32, -v35, v79, v32
    v_mul_f32 v35, v35, v70
    v_fmac_f32 v35, v46, v79
    v_lshlrev_b32 v70, 16, v112
    v_and_b32 v79, 0xffff0000, v112
    v_mul_f32 v70, s20, v70
    v_mul_f32 v79, s20, v79
    v_mul_f32 v46, v50, v70
    v_fma_f32 v46, -v81, v79, v46
    v_mul_f32 v81, v81, v70
    v_fmac_f32 v81, v50, v79
    v_lshlrev_b32 v70, 16, v113
    v_and_b32 v79, 0xffff0000, v113
    v_mul_f32 v70, s20, v70
    v_mul_f32 v79, s20, v79
    v_mul_f32 v50, v83, v70
    v_fma_f32 v50, -v33, v79, v50
    v_mul_f32 v33, v33, v70
    v_fmac_f32 v33, v83, v79
    v_lshlrev_b32 v70, 16, v114
    v_and_b32 v79, 0xffff0000, v114
    v_mul_f32 v70, s20, v70
    v_mul_f32 v79, s20, v79
    v_mul_f32 v83, v78, v70
    v_fma_f32 v83, -v47, v79, v83
    v_mul_f32 v47, v47, v70
    v_fmac_f32 v47, v78, v79
    v_lshlrev_b32 v70, 16, v115
    v_and_b32 v79, 0xffff0000, v115
    v_mul_f32 v70, s20, v70
    v_mul_f32 v79, s20, v79
    v_mul_f32 v78, v76, v70
    v_fma_f32 v78, -v51, v79, v78
    v_mul_f32 v51, v51, v70
    v_fmac_f32 v51, v76, v79
    v_lshlrev_b32 v70, 16, v116
    v_and_b32 v79, 0xffff0000, v116
    v_mul_f32 v70, s20, v70
    v_mul_f32 v79, s20, v79
    v_mul_f32 v76, v18, v70
    v_fma_f32 v76, -v45, v79, v76
    v_mul_f32 v45, v45, v70
    v_fmac_f32 v45, v18, v79
    v_lshlrev_b32 v70, 16, v117
    v_and_b32 v79, 0xffff0000, v117
    v_mul_f32 v70, s20, v70
    v_mul_f32 v79, s20, v79
    v_mul_f32 v18, v72, v70
    v_fma_f32 v18, -v53, v79, v18
    v_mul_f32 v53, v53, v70
    v_fmac_f32 v53, v72, v79
    v_lshlrev_b32 v70, 16, v118
    v_and_b32 v79, 0xffff0000, v118
    v_mul_f32 v70, s20, v70
    v_mul_f32 v79, s20, v79
    v_mul_f32 v72, v20, v70
    v_fma_f32 v72, -v55, v79, v72
    v_mul_f32 v55, v55, v70
    v_fmac_f32 v55, v20, v79
    v_lshlrev_b32 v70, 16, v119
    v_and_b32 v79, 0xffff0000, v119
    v_mul_f32 v70, s20, v70
    v_mul_f32 v79, s20, v79
    v_mul_f32 v20, v22, v70
    v_fma_f32 v20, -v59, v79, v20
    v_mul_f32 v59, v59, v70
    v_fmac_f32 v59, v22, v79
    s_waitcnt vmcnt(0)
    ds_read_b64_tr_b16 a[64:65], v201 offset:0
    ds_read_b64_tr_b16 a[66:67], v201 offset:256
    ds_read_b64_tr_b16 a[68:69], v201 offset:1024
    ds_read_b64_tr_b16 a[70:71], v201 offset:1280
    ds_read_b64_tr_b16 a[72:73], v201 offset:2048
    ds_read_b64_tr_b16 a[74:75], v201 offset:2304
    ds_read_b64_tr_b16 a[76:77], v201 offset:3072
    ds_read_b64_tr_b16 a[78:79], v201 offset:3328
    s_waitcnt lgkmcnt(0)
    ds_read_b64_tr_b16 a[80:81], v201 offset:4096
    ds_read_b64_tr_b16 a[82:83], v201 offset:4352
    ds_read_b64_tr_b16 a[84:85], v201 offset:5120
    ds_read_b64_tr_b16 a[86:87], v201 offset:5376
    ds_read_b64_tr_b16 a[88:89], v201 offset:6144
    ds_read_b64_tr_b16 a[90:91], v201 offset:6400
    ds_read_b64_tr_b16 a[92:93], v201 offset:7168
    ds_read_b64_tr_b16 a[94:95], v201 offset:7424
    s_waitcnt lgkmcnt(0)
    ds_read_b64_tr_b16 a[96:97], v201 offset:8192
    ds_read_b64_tr_b16 a[98:99], v201 offset:8448
    ds_read_b64_tr_b16 a[100:101], v201 offset:9216
    ds_read_b64_tr_b16 a[102:103], v201 offset:9472
    ds_read_b64_tr_b16 a[104:105], v201 offset:10240
    ds_read_b64_tr_b16 a[106:107], v201 offset:10496
    ds_read_b64_tr_b16 a[108:109], v201 offset:11264
    ds_read_b64_tr_b16 a[110:111], v201 offset:11520
    s_waitcnt lgkmcnt(0)
    ds_read_b64_tr_b16 a[112:113], v201 offset:12288
    ds_read_b64_tr_b16 a[114:115], v201 offset:12544
    ds_read_b64_tr_b16 a[116:117], v201 offset:13312
    ds_read_b64_tr_b16 a[118:119], v201 offset:13568
    ds_read_b64_tr_b16 a[120:121], v201 offset:14336
    ds_read_b64_tr_b16 a[122:123], v201 offset:14592
    ds_read_b64_tr_b16 a[124:125], v201 offset:15360
    ds_read_b64_tr_b16 a[126:127], v201 offset:15616
    s_waitcnt lgkmcnt(0)
    s_add_u32 m0, s56, 0
    s_add_u32 s58, s57, 32768
    s_and_b32 s58, s58, 0xffff
    s_lshl_b32 s58, s58, 5
    buffer_load_dwordx4 v200, s[52:55], s58 offen lds
    s_add_u32 m0, s56, 1024
    s_add_u32 s58, s57, 33792
    s_and_b32 s58, s58, 0xffff
    s_lshl_b32 s58, s58, 5
    buffer_load_dwordx4 v200, s[52:55], s58 offen lds
    s_add_u32 m0, s56, 2048
    s_add_u32 s58, s57, 34816
    s_and_b32 s58, s58, 0xffff
    s_lshl_b32 s58, s58, 5
    buffer_load_dwordx4 v200, s[52:55], s58 offen lds
    s_add_u32 m0, s56, 3072
    s_add_u32 s58, s57, 35840
    s_and_b32 s58, s58, 0xffff
    s_lshl_b32 s58, s58, 5
    buffer_load_dwordx4 v200, s[52:55], s58 offen lds
    s_add_u32 m0, s56, 4096
    s_add_u32 s58, s57, 36864
    s_and_b32 s58, s58, 0xffff
    s_lshl_b32 s58, s58, 5
    buffer_load_dwordx4 v200, s[52:55], s58 offen lds
    s_add_u32 m0, s56, 5120
    s_add_u32 s58, s57, 37888
    s_and_b32 s58, s58, 0xffff
    s_lshl_b32 s58, s58, 5
    buffer_load_dwordx4 v200, s[52:55], s58 offen lds
    s_add_u32 m0, s56, 6144
    s_add_u32 s58, s57, 38912
    s_and_b32 s58, s58, 0xffff
    s_lshl_b32 s58, s58, 5
    buffer_load_dwordx4 v200, s[52:55], s58 offen lds
    s_add_u32 m0, s56, 7168
    s_add_u32 s58, s57, 39936
    s_and_b32 s58, s58, 0xffff
    s_lshl_b32 s58, s58, 5
    buffer_load_dwordx4 v200, s[52:55], s58 offen lds
    s_add_u32 m0, s56, 8192
    s_add_u32 s58, s57, 40960
    s_and_b32 s58, s58, 0xffff
    s_lshl_b32 s58, s58, 5
    buffer_load_dwordx4 v200, s[52:55], s58 offen lds
    s_add_u32 m0, s56, 9216
    s_add_u32 s58, s57, 41984
    s_and_b32 s58, s58, 0xffff
    s_lshl_b32 s58, s58, 5
    buffer_load_dwordx4 v200, s[52:55], s58 offen lds
    s_add_u32 m0, s56, 10240
    s_add_u32 s58, s57, 43008
    s_and_b32 s58, s58, 0xffff
    s_lshl_b32 s58, s58, 5
    buffer_load_dwordx4 v200, s[52:55], s58 offen lds
    s_add_u32 m0, s56, 11264
    s_add_u32 s58, s57, 44032
    s_and_b32 s58, s58, 0xffff
    s_lshl_b32 s58, s58, 5
    buffer_load_dwordx4 v200, s[52:55], s58 offen lds
    s_add_u32 m0, s56, 12288
    s_add_u32 s58, s57, 45056
    s_and_b32 s58, s58, 0xffff
    s_lshl_b32 s58, s58, 5
    buffer_load_dwordx4 v200, s[52:55], s58 offen lds
    s_add_u32 m0, s56, 13312
    s_add_u32 s58, s57, 46080
    s_and_b32 s58, s58, 0xffff
    s_lshl_b32 s58, s58, 5
    buffer_load_dwordx4 v200, s[52:55], s58 offen lds
    s_add_u32 m0, s56, 14336
    s_add_u32 s58, s57, 47104
    s_and_b32 s58, s58, 0xffff
    s_lshl_b32 s58, s58, 5
    buffer_load_dwordx4 v200, s[52:55], s58 offen lds
    s_add_u32 m0, s56, 15360
    s_add_u32 s58, s57, 48128
    s_and_b32 s58, s58, 0xffff
    s_lshl_b32 s58, s58, 5
    buffer_load_dwordx4 v200, s[52:55], s58 offen lds
    s_nop 1
    v_mov_b32_dpp v70, v82 quad_perm:[1,0,3,2] row_mask:0xf bank_mask:0xf
    v_fma_f32 v82, v82, v9, v70
    v_mov_b32_dpp v70, v17 quad_perm:[1,0,3,2] row_mask:0xf bank_mask:0xf
    v_fma_f32 v17, v17, v9, v70
    v_mov_b32_dpp v70, v16 quad_perm:[1,0,3,2] row_mask:0xf bank_mask:0xf
    v_fma_f32 v16, v16, v9, v70
    v_mov_b32_dpp v70, v49 quad_perm:[1,0,3,2] row_mask:0xf bank_mask:0xf
    v_fma_f32 v49, v49, v9, v70
    v_mov_b32_dpp v70, v74 quad_perm:[1,0,3,2] row_mask:0xf bank_mask:0xf
    v_fma_f32 v74, v74, v9, v70
    v_mov_b32_dpp v70, v19 quad_perm:[1,0,3,2] row_mask:0xf bank_mask:0xf
    v_fma_f32 v19, v19, v9, v70
    v_mov_b32_dpp v70, v48 quad_perm:[1,0,3,2] row_mask:0xf bank_mask:0xf
    v_fma_f32 v48, v48, v9, v70
    v_mov_b32_dpp v70, v23 quad_perm:[1,0,3,2] row_mask:0xf bank_mask:0xf
    v_fma_f32 v23, v23, v9, v70
    v_mov_b32_dpp v70, v68 quad_perm:[1,0,3,2] row_mask:0xf bank_mask:0xf
    v_fma_f32 v68, v68, v9, v70
    v_mov_b32_dpp v70, v27 quad_perm:[1,0,3,2] row_mask:0xf bank_mask:0xf
    v_fma_f32 v27, v27, v9, v70
    v_mov_b32_dpp v70, v62 quad_perm:[1,0,3,2] row_mask:0xf bank_mask:0xf
    v_fma_f32 v62, v62, v9, v70
    v_mov_b32_dpp v70, v39 quad_perm:[1,0,3,2] row_mask:0xf bank_mask:0xf
    v_fma_f32 v39, v39, v9, v70
    v_mov_b32_dpp v70, v66 quad_perm:[1,0,3,2] row_mask:0xf bank_mask:0xf
    v_fma_f32 v66, v66, v9, v70
    v_mov_b32_dpp v70, v29 quad_perm:[1,0,3,2] row_mask:0xf bank_mask:0xf
    v_fma_f32 v29, v29, v9, v70
    v_mov_b32_dpp v70, v54 quad_perm:[1,0,3,2] row_mask:0xf bank_mask:0xf
    v_fma_f32 v54, v54, v9, v70
    v_mov_b32_dpp v70, v37 quad_perm:[1,0,3,2] row_mask:0xf bank_mask:0xf
    v_fma_f32 v37, v37, v9, v70
    v_mov_b32_dpp v70, v44 quad_perm:[1,0,3,2] row_mask:0xf bank_mask:0xf
    v_fma_f32 v44, v44, v9, v70
    v_mov_b32_dpp v70, v43 quad_perm:[1,0,3,2] row_mask:0xf bank_mask:0xf
    v_fma_f32 v43, v43, v9, v70
    v_mov_b32_dpp v70, v52 quad_perm:[1,0,3,2] row_mask:0xf bank_mask:0xf
    v_fma_f32 v52, v52, v9, v70
    v_mov_b32_dpp v70, v71 quad_perm:[1,0,3,2] row_mask:0xf bank_mask:0xf
    v_fma_f32 v71, v71, v9, v70
    v_mov_b32_dpp v70, v58 quad_perm:[1,0,3,2] row_mask:0xf bank_mask:0xf
    v_fma_f32 v58, v58, v9, v70
    v_mov_b32_dpp v70, v61 quad_perm:[1,0,3,2] row_mask:0xf bank_mask:0xf
    v_fma_f32 v61, v61, v9, v70
    v_mov_b32_dpp v70, v38 quad_perm:[1,0,3,2] row_mask:0xf bank_mask:0xf
    v_fma_f32 v38, v38, v9, v70
    v_mov_b32_dpp v70, v69 quad_perm:[1,0,3,2] row_mask:0xf bank_mask:0xf
    v_fma_f32 v69, v69, v9, v70
    v_mov_b32_dpp v70, v28 quad_perm:[1,0,3,2] row_mask:0xf bank_mask:0xf
    v_fma_f32 v28, v28, v9, v70
    v_mov_b32_dpp v70, v41 quad_perm:[1,0,3,2] row_mask:0xf bank_mask:0xf
    v_fma_f32 v41, v41, v9, v70
    v_mov_b32_dpp v70, v36 quad_perm:[1,0,3,2] row_mask:0xf bank_mask:0xf
    v_fma_f32 v36, v36, v9, v70
    v_mov_b32_dpp v70, v57 quad_perm:[1,0,3,2] row_mask:0xf bank_mask:0xf
    v_fma_f32 v57, v57, v9, v70
    v_mov_b32_dpp v70, v64 quad_perm:[1,0,3,2] row_mask:0xf bank_mask:0xf
    v_fma_f32 v64, v64, v9, v70
    v_mov_b32_dpp v70, v63 quad_perm:[1,0,3,2] row_mask:0xf bank_mask:0xf
    v_fma_f32 v63, v63, v9, v70
    v_mov_b32_dpp v70, v24 quad_perm:[1,0,3,2] row_mask:0xf bank_mask:0xf
    v_fma_f32 v24, v24, v9, v70
    v_mov_b32_dpp v70, v67 quad_perm:[1,0,3,2] row_mask:0xf bank_mask:0xf
    v_fma_f32 v67, v67, v9, v70
    v_mov_b32_dpp v70, v30 quad_perm:[1,0,3,2] row_mask:0xf bank_mask:0xf
    v_fma_f32 v30, v30, v9, v70
    v_mov_b32_dpp v70, v75 quad_perm:[1,0,3,2] row_mask:0xf bank_mask:0xf
    v_fma_f32 v75, v75, v9, v70
    v_mov_b32_dpp v70, v34 quad_perm:[1,0,3,2] row_mask:0xf bank_mask:0xf
    v_fma_f32 v34, v34, v9, v70
    v_mov_b32_dpp v70, v77 quad_perm:[1,0,3,2] row_mask:0xf bank_mask:0xf
    v_fma_f32 v77, v77, v9, v70
    v_mov_b32_dpp v70, v42 quad_perm:[1,0,3,2] row_mask:0xf bank_mask:0xf
    v_fma_f32 v42, v42, v9, v70
    v_mov_b32_dpp v70, v73 quad_perm:[1,0,3,2] row_mask:0xf bank_mask:0xf
    v_fma_f32 v73, v73, v9, v70
    v_mov_b32_dpp v70, v60 quad_perm:[1,0,3,2] row_mask:0xf bank_mask:0xf
    v_fma_f32 v60, v60, v9, v70
    v_mov_b32_dpp v70, v21 quad_perm:[1,0,3,2] row_mask:0xf bank_mask:0xf
    v_fma_f32 v21, v21, v9, v70
    v_mov_b32_dpp v70, v40 quad_perm:[1,0,3,2] row_mask:0xf bank_mask:0xf
    v_fma_f32 v40, v40, v9, v70
    v_mov_b32_dpp v70, v65 quad_perm:[1,0,3,2] row_mask:0xf bank_mask:0xf
    v_fma_f32 v65, v65, v9, v70
    v_mov_b32_dpp v70, v56 quad_perm:[1,0,3,2] row_mask:0xf bank_mask:0xf
    v_fma_f32 v56, v56, v9, v70
    v_mov_b32_dpp v70, v25 quad_perm:[1,0,3,2] row_mask:0xf bank_mask:0xf
    v_fma_f32 v25, v25, v9, v70
    v_mov_b32_dpp v70, v80 quad_perm:[1,0,3,2] row_mask:0xf bank_mask:0xf
    v_fma_f32 v80, v80, v9, v70
    v_mov_b32_dpp v70, v31 quad_perm:[1,0,3,2] row_mask:0xf bank_mask:0xf
    v_fma_f32 v31, v31, v9, v70
    v_mov_b32_dpp v70, v32 quad_perm:[1,0,3,2] row_mask:0xf bank_mask:0xf
    v_fma_f32 v32, v32, v9, v70
    v_mov_b32_dpp v70, v35 quad_perm:[1,0,3,2] row_mask:0xf bank_mask:0xf
    v_fma_f32 v35, v35, v9, v70
    v_mov_b32_dpp v70, v46 quad_perm:[1,0,3,2] row_mask:0xf bank_mask:0xf
    v_fma_f32 v46, v46, v9, v70
    v_mov_b32_dpp v70, v81 quad_perm:[1,0,3,2] row_mask:0xf bank_mask:0xf
    v_fma_f32 v81, v81, v9, v70
    v_mov_b32_dpp v70, v50 quad_perm:[1,0,3,2] row_mask:0xf bank_mask:0xf
    v_fma_f32 v50, v50, v9, v70
    v_mov_b32_dpp v70, v33 quad_perm:[1,0,3,2] row_mask:0xf bank_mask:0xf
    v_fma_f32 v33, v33, v9, v70
    v_mov_b32_dpp v70, v83 quad_perm:[1,0,3,2] row_mask:0xf bank_mask:0xf
    v_fma_f32 v83, v83, v9, v70
    v_mov_b32_dpp v70, v47 quad_perm:[1,0,3,2] row_mask:0xf bank_mask:0xf
    v_fma_f32 v47, v47, v9, v70
    v_mov_b32_dpp v70, v78 quad_perm:[1,0,3,2] row_mask:0xf bank_mask:0xf
    v_fma_f32 v78, v78, v9, v70
    v_mov_b32_dpp v70, v51 quad_perm:[1,0,3,2] row_mask:0xf bank_mask:0xf
    v_fma_f32 v51, v51, v9, v70
    v_mov_b32_dpp v70, v76 quad_perm:[1,0,3,2] row_mask:0xf bank_mask:0xf
    v_fma_f32 v76, v76, v9, v70
    v_mov_b32_dpp v70, v45 quad_perm:[1,0,3,2] row_mask:0xf bank_mask:0xf
    v_fma_f32 v45, v45, v9, v70
    v_mov_b32_dpp v70, v18 quad_perm:[1,0,3,2] row_mask:0xf bank_mask:0xf
    v_fma_f32 v18, v18, v9, v70
    v_mov_b32_dpp v70, v53 quad_perm:[1,0,3,2] row_mask:0xf bank_mask:0xf
    v_fma_f32 v53, v53, v9, v70
    v_mov_b32_dpp v70, v72 quad_perm:[1,0,3,2] row_mask:0xf bank_mask:0xf
    v_fma_f32 v72, v72, v9, v70
    v_mov_b32_dpp v70, v55 quad_perm:[1,0,3,2] row_mask:0xf bank_mask:0xf
    v_fma_f32 v55, v55, v9, v70
    v_mov_b32_dpp v70, v20 quad_perm:[1,0,3,2] row_mask:0xf bank_mask:0xf
    v_fma_f32 v20, v20, v9, v70
    v_mov_b32_dpp v70, v59 quad_perm:[1,0,3,2] row_mask:0xf bank_mask:0xf
    v_fma_f32 v59, v59, v9, v70
    v_mul_f32 v70, 0x3c800000, v10
    v_cos_f32 v79, v70
    v_sin_f32 v22, v70
    s_nop 0
    v_mul_f32 v26, v16, v79
    v_fma_f32 v26, -v49, v22, v26
    v_mul_f32 v49, v49, v79
    v_fmac_f32 v49, v16, v22
    v_mul_f32 v70, 0x3d000000, v10
    v_cos_f32 v79, v70
    v_sin_f32 v22, v70
    s_nop 0
    v_mul_f32 v16, v74, v79
    v_fma_f32 v16, -v19, v22, v16
    v_mul_f32 v19, v19, v79
    v_fmac_f32 v19, v74, v22
    v_mul_f32 v70, 0x3d400000, v10
    v_cos_f32 v79, v70
    v_sin_f32 v22, v70
    s_nop 0
    v_mul_f32 v74, v48, v79
    v_fma_f32 v74, -v23, v22, v74
    v_mul_f32 v23, v23, v79
    v_fmac_f32 v23, v48, v22
    v_mul_f32 v70, 0x3d800000, v10
    v_cos_f32 v79, v70
    v_sin_f32 v22, v70
    s_nop 0
    v_mul_f32 v48, v68, v79
    v_fma_f32 v48, -v27, v22, v48
    v_mul_f32 v27, v27, v79
    v_fmac_f32 v27, v68, v22
    v_mul_f32 v70, 0x3da00000, v10
    v_cos_f32 v79, v70
    v_sin_f32 v22, v70
    s_nop 0
    v_mul_f32 v68, v62, v79
    v_fma_f32 v68, -v39, v22, v68
    v_mul_f32 v39, v39, v79
    v_fmac_f32 v39, v62, v22
    v_mul_f32 v70, 0x3dc00000, v10
    v_cos_f32 v79, v70
    v_sin_f32 v22, v70
    s_nop 0
    v_mul_f32 v62, v66, v79
    v_fma_f32 v62, -v29, v22, v62
    v_mul_f32 v29, v29, v79
    v_fmac_f32 v29, v66, v22
    v_mul_f32 v70, 0x3de00000, v10
    v_cos_f32 v79, v70
    v_sin_f32 v22, v70
    s_nop 0
    v_mul_f32 v66, v54, v79
    v_fma_f32 v66, -v37, v22, v66
    v_mul_f32 v37, v37, v79
    v_fmac_f32 v37, v54, v22
    v_mul_f32 v70, 0x3e000000, v10
    v_cos_f32 v79, v70
    v_sin_f32 v22, v70
    s_nop 0
    v_mul_f32 v54, v44, v79
    v_fma_f32 v54, -v43, v22, v54
    v_mul_f32 v43, v43, v79
    v_fmac_f32 v43, v44, v22
    v_mul_f32 v70, 0x3e100000, v10
    v_cos_f32 v79, v70
    v_sin_f32 v22, v70
    s_nop 0
    v_mul_f32 v44, v52, v79
    v_fma_f32 v44, -v71, v22, v44
    v_mul_f32 v71, v71, v79
    v_fmac_f32 v71, v52, v22
    v_mul_f32 v70, 0x3e200000, v10
    v_cos_f32 v79, v70
    v_sin_f32 v22, v70
    s_nop 0
    v_mul_f32 v52, v58, v79
    v_fma_f32 v52, -v61, v22, v52
    v_mul_f32 v61, v61, v79
    v_fmac_f32 v61, v58, v22
    v_mul_f32 v70, 0x3e300000, v10
    v_cos_f32 v79, v70
    v_sin_f32 v22, v70
    s_nop 0
    v_mul_f32 v58, v38, v79
    v_fma_f32 v58, -v69, v22, v58
    v_mul_f32 v69, v69, v79
    v_fmac_f32 v69, v38, v22
    v_mul_f32 v70, 0x3e400000, v10
    v_cos_f32 v79, v70
    v_sin_f32 v22, v70
    s_nop 0
    v_mul_f32 v38, v28, v79
    v_fma_f32 v38, -v41, v22, v38
    v_mul_f32 v41, v41, v79
    v_fmac_f32 v41, v28, v22
    v_mul_f32 v70, 0x3e500000, v10
    v_cos_f32 v79, v70
    v_sin_f32 v22, v70
    s_nop 0
    v_mul_f32 v28, v36, v79
    v_fma_f32 v28, -v57, v22, v28
    v_mul_f32 v57, v57, v79
    v_fmac_f32 v57, v36, v22
    v_mul_f32 v70, 0x3e600000, v10
    v_cos_f32 v79, v70
    v_sin_f32 v22, v70
    s_nop 0
    v_mul_f32 v36, v64, v79
    v_fma_f32 v36, -v63, v22, v36
    v_mul_f32 v63, v63, v79
    v_fmac_f32 v63, v64, v22
    v_mul_f32 v70, 0x3e700000, v10
    v_cos_f32 v79, v70
    v_sin_f32 v22, v70
    s_nop 0
    v_mul_f32 v64, v24, v79
    v_fma_f32 v64, -v67, v22, v64
    v_mul_f32 v67, v67, v79
    v_fmac_f32 v67, v24, v22
    v_mul_f32 v70, 0x3e800000, v10
    v_cos_f32 v79, v70
    v_sin_f32 v22, v70
    s_nop 0
    v_mul_f32 v24, v30, v79
    v_fma_f32 v24, -v75, v22, v24
    v_mul_f32 v75, v75, v79
    v_fmac_f32 v75, v30, v22
    v_mul_f32 v70, 0x3e880000, v10
    v_cos_f32 v79, v70
    v_sin_f32 v22, v70
    s_nop 0
    v_mul_f32 v30, v34, v79
    v_fma_f32 v30, -v77, v22, v30
    v_mul_f32 v77, v77, v79
    v_fmac_f32 v77, v34, v22
    v_mul_f32 v70, 0x3e900000, v10
    v_cos_f32 v79, v70
    v_sin_f32 v22, v70
    s_nop 0
    v_mul_f32 v34, v42, v79
    v_fma_f32 v34, -v73, v22, v34
    v_mul_f32 v73, v73, v79
    v_fmac_f32 v73, v42, v22
    v_mul_f32 v70, 0x3e980000, v10
    v_cos_f32 v79, v70
    v_sin_f32 v22, v70
    s_nop 0
    v_mul_f32 v42, v60, v79
    v_fma_f32 v42, -v21, v22, v42
    v_mul_f32 v21, v21, v79
    v_fmac_f32 v21, v60, v22
    v_mul_f32 v70, 0x3ea00000, v10
    v_cos_f32 v79, v70
    v_sin_f32 v22, v70
    s_nop 0
    v_mul_f32 v60, v40, v79
    v_fma_f32 v60, -v65, v22, v60
    v_mul_f32 v65, v65, v79
    v_fmac_f32 v65, v40, v22
    v_mul_f32 v70, 0x3ea80000, v10
    v_cos_f32 v79, v70
    v_sin_f32 v22, v70
    s_nop 0
    v_mul_f32 v40, v56, v79
    v_fma_f32 v40, -v25, v22, v40
    v_mul_f32 v25, v25, v79
    v_fmac_f32 v25, v56, v22
    v_mul_f32 v70, 0x3eb00000, v10
    v_cos_f32 v79, v70
    v_sin_f32 v22, v70
    s_nop 0
    v_mul_f32 v56, v80, v79
    v_fma_f32 v56, -v31, v22, v56
    v_mul_f32 v31, v31, v79
    v_fmac_f32 v31, v80, v22
    v_mul_f32 v70, 0x3eb80000, v10
    v_cos_f32 v79, v70
    v_sin_f32 v22, v70
    s_nop 0
    v_mul_f32 v80, v32, v79
    v_fma_f32 v80, -v35, v22, v80
    v_mul_f32 v35, v35, v79
    v_fmac_f32 v35, v32, v22
    v_mul_f32 v70, 0x3ec00000, v10
    v_cos_f32 v79, v70
    v_sin_f32 v22, v70
    s_nop 0
    v_mul_f32 v32, v46, v79
    v_fma_f32 v32, -v81, v22, v32
    v_mul_f32 v81, v81, v79
    v_fmac_f32 v81, v46, v22
    v_mul_f32 v70, 0x3ec80000, v10
    v_cos_f32 v79, v70
    v_sin_f32 v22, v70
    s_nop 0
    v_mul_f32 v46, v50, v79
    v_fma_f32 v46, -v33, v22, v46
    v_mul_f32 v33, v33, v79
    v_fmac_f32 v33, v50, v22
    v_mul_f32 v70, 0x3ed00000, v10
    v_cos_f32 v79, v70
    v_sin_f32 v22, v70
    s_nop 0
    v_mul_f32 v50, v83, v79
    v_fma_f32 v50, -v47, v22, v50
    v_mul_f32 v47, v47, v79
    v_fmac_f32 v47, v83, v22
    v_mul_f32 v70, 0x3ed80000, v10
    v_cos_f32 v79, v70
    v_sin_f32 v22, v70
    s_nop 0
    v_mul_f32 v83, v78, v79
    v_fma_f32 v83, -v51, v22, v83
    v_mul_f32 v51, v51, v79
    v_fmac_f32 v51, v78, v22
    v_mul_f32 v70, 0x3ee00000, v10
    v_cos_f32 v79, v70
    v_sin_f32 v22, v70
    s_nop 0
    v_mul_f32 v78, v76, v79
    v_fma_f32 v78, -v45, v22, v78
    v_mul_f32 v45, v45, v79
    v_fmac_f32 v45, v76, v22
    v_mul_f32 v70, 0x3ee80000, v10
    v_cos_f32 v79, v70
    v_sin_f32 v22, v70
    s_nop 0
    v_mul_f32 v76, v18, v79
    v_fma_f32 v76, -v53, v22, v76
    v_mul_f32 v53, v53, v79
    v_fmac_f32 v53, v18, v22
    v_mul_f32 v70, 0x3ef00000, v10
    v_cos_f32 v79, v70
    v_sin_f32 v22, v70
    s_nop 0
    v_mul_f32 v18, v72, v79
    v_fma_f32 v18, -v55, v22, v18
    v_mul_f32 v55, v55, v79
    v_fmac_f32 v55, v72, v22
    v_mul_f32 v70, 0x3ef80000, v10
    v_cos_f32 v79, v70
    v_sin_f32 v22, v70
    s_nop 0
    v_mul_f32 v72, v20, v79
    v_fma_f32 v72, -v59, v22, v72
    v_mul_f32 v59, v59, v79
    v_fmac_f32 v59, v20, v22
    v_sub_f32 v70, v82, v24
    v_sub_f32 v79, v17, v75
    v_add_f32 v82, v82, v24
    v_add_f32 v17, v17, v75
    v_sub_f32 v24, v26, v30
    v_sub_f32 v75, v49, v77
    v_add_f32 v26, v26, v30
    v_add_f32 v49, v49, v77
    v_mul_f32 v30, 0x3f7b14be, v24
    v_mul_f32 v77, 0x3e47c5c2, v24
    v_fmac_f32 v30, 0xbe47c5c2, v75
    v_fmac_f32 v77, 0x3f7b14be, v75
    v_sub_f32 v24, v16, v34
    v_sub_f32 v75, v19, v73
    v_add_f32 v16, v16, v34
    v_add_f32 v19, v19, v73
    v_mul_f32 v34, 0x3f6c835e, v24
    v_mul_f32 v73, 0x3ec3ef15, v24
    v_fmac_f32 v34, 0xbec3ef15, v75
    v_fmac_f32 v73, 0x3f6c835e, v75
    v_sub_f32 v24, v74, v42
    v_sub_f32 v75, v23, v21
    v_add_f32 v74, v74, v42
    v_add_f32 v23, v23, v21
    v_mul_f32 v42, 0x3f54db31, v24
    v_mul_f32 v21, 0x3f0e39da, v24
    v_fmac_f32 v42, 0xbf0e39da, v75
    v_fmac_f32 v21, 0x3f54db31, v75
    v_sub_f32 v24, v48, v60
    v_sub_f32 v75, v27, v65
    v_add_f32 v48, v48, v60
    v_add_f32 v27, v27, v65
    v_mul_f32 v60, 0x3f3504f3, v24
    v_mul_f32 v65, 0x3f3504f3, v24
    v_fmac_f32 v60, 0xbf3504f3, v75
    v_fmac_f32 v65, 0x3f3504f3, v75
    v_sub_f32 v24, v68, v40
    v_sub_f32 v75, v39, v25
    v_add_f32 v68, v68, v40
    v_add_f32 v39, v39, v25
    v_mul_f32 v40, 0x3f0e39da, v24
    v_mul_f32 v25, 0x3f54db31, v24
    v_fmac_f32 v40, 0xbf54db31, v75
    v_fmac_f32 v25, 0x3f0e39da, v75
    v_sub_f32 v24, v62, v56
    v_sub_f32 v75, v29, v31
    v_add_f32 v62, v62, v56
    v_add_f32 v29, v29, v31
    v_mul_f32 v56, 0x3ec3ef15, v24
    v_mul_f32 v31, 0x3f6c835e, v24
    v_fmac_f32 v56, 0xbf6c835e, v75
    v_fmac_f32 v31, 0x3ec3ef15, v75
    v_sub_f32 v24, v66, v80
    v_sub_f32 v75, v37, v35
    v_add_f32 v66, v66, v80
    v_add_f32 v37, v37, v35
    v_mul_f32 v80, 0x3e47c5c2, v24
    v_mul_f32 v35, 0x3f7b14be, v24
    v_fmac_f32 v80, 0xbf7b14be, v75
    v_fmac_f32 v35, 0x3e47c5c2, v75
    v_sub_f32 v24, v81, v43
    v_sub_f32 v75, v54, v32
    v_add_f32 v54, v54, v32
    v_add_f32 v43, v43, v81
    v_sub_f32 v32, v44, v46
    v_sub_f32 v81, v71, v33
    v_add_f32 v44, v44, v46
    v_add_f32 v71, v71, v33
    v_mul_f32 v46, 0xbe47c5c2, v32
    v_mul_f32 v33, 0x3f7b14be, v32
    v_fmac_f32 v46, 0xbf7b14be, v81
    v_fmac_f32 v33, 0xbe47c5c2, v81
    v_sub_f32 v32, v52, v50
    v_sub_f32 v81, v61, v47
    v_add_f32 v52, v52, v50
    v_add_f32 v61, v61, v47
    v_mul_f32 v50, 0xbec3ef15, v32
    v_mul_f32 v47, 0x3f6c835e, v32
    v_fmac_f32 v50, 0xbf6c835e, v81
    v_fmac_f32 v47, 0xbec3ef15, v81
    v_sub_f32 v32, v58, v83
    v_sub_f32 v81, v69, v51
    v_add_f32 v58, v58, v83
    v_add_f32 v69, v69, v51
    v_mul_f32 v83, 0xbf0e39da, v32
    v_mul_f32 v51, 0x3f54db31, v32
    v_fmac_f32 v83, 0xbf54db31, v81
    v_fmac_f32 v51, 0xbf0e39da, v81
    v_sub_f32 v32, v38, v78
    v_sub_f32 v81, v41, v45
    v_add_f32 v38, v38, v78
    v_add_f32 v41, v41, v45
    v_mul_f32 v78, 0xbf3504f3, v32
    v_mul_f32 v45, 0x3f3504f3, v32
    v_fmac_f32 v78, 0xbf3504f3, v81
    v_fmac_f32 v45, 0xbf3504f3, v81
    v_sub_f32 v32, v28, v76
    v_sub_f32 v81, v57, v53
    v_add_f32 v28, v28, v76
    v_add_f32 v57, v57, v53
    v_mul_f32 v76, 0xbf54db31, v32
    v_mul_f32 v53, 0x3f0e39da, v32
    v_fmac_f32 v76, 0xbf0e39da, v81
    v_fmac_f32 v53, 0xbf54db31, v81
    v_sub_f32 v32, v36, v18
    v_sub_f32 v81, v63, v55
    v_add_f32 v36, v36, v18
    v_add_f32 v63, v63, v55
    v_mul_f32 v18, 0xbf6c835e, v32
    v_mul_f32 v55, 0x3ec3ef15, v32
    v_fmac_f32 v18, 0xbec3ef15, v81
    v_fmac_f32 v55, 0xbf6c835e, v81
    v_sub_f32 v32, v64, v72
    v_sub_f32 v81, v67, v59
    v_add_f32 v64, v64, v72
    v_add_f32 v67, v67, v59
    v_mul_f32 v72, 0xbf7b14be, v32
    v_mul_f32 v59, 0x3e47c5c2, v32
    v_fmac_f32 v72, 0xbe47c5c2, v81
    v_fmac_f32 v59, 0xbf7b14be, v81
    v_sub_f32 v32, v82, v54
    v_sub_f32 v81, v17, v43
    v_add_f32 v82, v82, v54
    v_add_f32 v17, v17, v43
    v_sub_f32 v54, v26, v44
    v_sub_f32 v43, v49, v71
    v_add_f32 v26, v26, v44
    v_add_f32 v49, v49, v71
    v_mul_f32 v44, 0x3f6c835e, v54
    v_mul_f32 v71, 0x3ec3ef15, v54
    v_fmac_f32 v44, 0xbec3ef15, v43
    v_fmac_f32 v71, 0x3f6c835e, v43
    v_sub_f32 v54, v16, v52
    v_sub_f32 v43, v19, v61
    v_add_f32 v16, v16, v52
    v_add_f32 v19, v19, v61
    v_mul_f32 v52, 0x3f3504f3, v54
    v_mul_f32 v61, 0x3f3504f3, v54
    v_fmac_f32 v52, 0xbf3504f3, v43
    v_fmac_f32 v61, 0x3f3504f3, v43
    v_sub_f32 v54, v74, v58
    v_sub_f32 v43, v23, v69
    v_add_f32 v74, v74, v58
    v_add_f32 v23, v23, v69
    v_mul_f32 v58, 0x3ec3ef15, v54
    v_mul_f32 v69, 0x3f6c835e, v54
    v_fmac_f32 v58, 0xbf6c835e, v43
    v_fmac_f32 v69, 0x3ec3ef15, v43
    v_sub_f32 v54, v41, v27
    v_sub_f32 v43, v48, v38
    v_add_f32 v48, v48, v38
    v_add_f32 v27, v27, v41
    v_sub_f32 v38, v68, v28
    v_sub_f32 v41, v39, v57
    v_add_f32 v68, v68, v28
    v_add_f32 v39, v39, v57
    v_mul_f32 v28, 0xbec3ef15, v38
    v_mul_f32 v57, 0x3f6c835e, v38
    v_fmac_f32 v28, 0xbf6c835e, v41
    v_fmac_f32 v57, 0xbec3ef15, v41
    v_sub_f32 v38, v62, v36
    v_sub_f32 v41, v29, v63
    v_add_f32 v62, v62, v36
    v_add_f32 v29, v29, v63
    v_mul_f32 v36, 0xbf3504f3, v38
    v_mul_f32 v63, 0x3f3504f3, v38
    v_fmac_f32 v36, 0xbf3504f3, v41
    v_fmac_f32 v63, 0xbf3504f3, v41
    v_sub_f32 v38, v66, v64
    v_sub_f32 v41, v37, v67
    v_add_f32 v66, v66, v64
    v_add_f32 v37, v37, v67
    v_mul_f32 v64, 0xbf6c835e, v38
    v_mul_f32 v67, 0x3ec3ef15, v38
    v_fmac_f32 v64, 0xbec3ef15, v41
    v_fmac_f32 v67, 0xbf6c835e, v41
    v_sub_f32 v38, v70, v24
    v_sub_f32 v41, v79, v75
    v_add_f32 v70, v70, v24
    v_add_f32 v79, v79, v75
    v_sub_f32 v24, v30, v46
    v_sub_f32 v75, v77, v33
    v_add_f32 v30, v30, v46
    v_add_f32 v77, v77, v33
    v_mul_f32 v46, 0x3f6c835e, v24
    v_mul_f32 v33, 0x3ec3ef15, v24
    v_fmac_f32 v46, 0xbec3ef15, v75
    v_fmac_f32 v33, 0x3f6c835e, v75
    v_sub_f32 v24, v34, v50
    v_sub_f32 v75, v73, v47
    v_add_f32 v34, v34, v50
    v_add_f32 v73, v73, v47
    v_mul_f32 v50, 0x3f3504f3, v24
    v_mul_f32 v47, 0x3f3504f3, v24
    v_fmac_f32 v50, 0xbf3504f3, v75
    v_fmac_f32 v47, 0x3f3504f3, v75
    v_sub_f32 v24, v42, v83
    v_sub_f32 v75, v21, v51
    v_add_f32 v42, v42, v83
    v_add_f32 v21, v21, v51
    v_mul_f32 v83, 0x3ec3ef15, v24
    v_mul_f32 v51, 0x3f6c835e, v24
    v_fmac_f32 v83, 0xbf6c835e, v75
    v_fmac_f32 v51, 0x3ec3ef15, v75
    v_sub_f32 v24, v45, v65
    v_sub_f32 v75, v60, v78
    v_add_f32 v60, v60, v78
    v_add_f32 v65, v65, v45
    v_sub_f32 v78, v40, v76
    v_sub_f32 v45, v25, v53
    v_add_f32 v40, v40, v76
    v_add_f32 v25, v25, v53
    v_mul_f32 v76, 0xbec3ef15, v78
    v_mul_f32 v53, 0x3f6c835e, v78
    v_fmac_f32 v76, 0xbf6c835e, v45
    v_fmac_f32 v53, 0xbec3ef15, v45
    v_sub_f32 v78, v56, v18
    v_sub_f32 v45, v31, v55
    v_add_f32 v56, v56, v18
    v_add_f32 v31, v31, v55
    v_mul_f32 v18, 0xbf3504f3, v78
    v_mul_f32 v55, 0x3f3504f3, v78
    v_fmac_f32 v18, 0xbf3504f3, v45
    v_fmac_f32 v55, 0xbf3504f3, v45
    v_sub_f32 v78, v80, v72
    v_sub_f32 v45, v35, v59
    v_add_f32 v80, v80, v72
    v_add_f32 v35, v35, v59
    v_mul_f32 v72, 0xbf6c835e, v78
    v_mul_f32 v59, 0x3ec3ef15, v78
    v_fmac_f32 v72, 0xbec3ef15, v45
    v_fmac_f32 v59, 0xbf6c835e, v45
    v_sub_f32 v78, v82, v48
    v_sub_f32 v45, v17, v27
    v_add_f32 v82, v82, v48
    v_add_f32 v17, v17, v27
    v_sub_f32 v48, v26, v68
    v_sub_f32 v27, v49, v39
    v_add_f32 v26, v26, v68
    v_add_f32 v49, v49, v39
    v_mul_f32 v68, 0x3f3504f3, v48
    v_mul_f32 v39, 0x3f3504f3, v48
    v_fmac_f32 v68, 0xbf3504f3, v27
    v_fmac_f32 v39, 0x3f3504f3, v27
    v_sub_f32 v48, v29, v19
    v_sub_f32 v27, v16, v62
    v_add_f32 v16, v16, v62
    v_add_f32 v19, v19, v29
    v_sub_f32 v62, v74, v66
    v_sub_f32 v29, v23, v37
    v_add_f32 v74, v74, v66
    v_add_f32 v23, v23, v37
    v_mul_f32 v66, 0xbf3504f3, v62
    v_mul_f32 v37, 0x3f3504f3, v62
    v_fmac_f32 v66, 0xbf3504f3, v29
    v_fmac_f32 v37, 0xbf3504f3, v29
    v_sub_f32 v62, v32, v54
    v_sub_f32 v29, v81, v43
    v_add_f32 v32, v32, v54
    v_add_f32 v81, v81, v43
    v_sub_f32 v54, v44, v28
    v_sub_f32 v43, v71, v57
    v_add_f32 v44, v44, v28
    v_add_f32 v71, v71, v57
    v_mul_f32 v28, 0x3f3504f3, v54
    v_mul_f32 v57, 0x3f3504f3, v54
    v_fmac_f32 v28, 0xbf3504f3, v43
    v_fmac_f32 v57, 0x3f3504f3, v43
    v_sub_f32 v54, v63, v61
    v_sub_f32 v43, v52, v36
    v_add_f32 v52, v52, v36
    v_add_f32 v61, v61, v63
    v_sub_f32 v36, v58, v64
    v_sub_f32 v63, v69, v67
    v_add_f32 v58, v58, v64
    v_add_f32 v69, v69, v67
    v_mul_f32 v64, 0xbf3504f3, v36
    v_mul_f32 v67, 0x3f3504f3, v36
    v_fmac_f32 v64, 0xbf3504f3, v63
    v_fmac_f32 v67, 0xbf3504f3, v63
    v_sub_f32 v36, v70, v60
    v_sub_f32 v63, v79, v65
    v_add_f32 v70, v70, v60
    v_add_f32 v79, v79, v65
    v_sub_f32 v60, v30, v40
    v_sub_f32 v65, v77, v25
    v_add_f32 v30, v30, v40
    v_add_f32 v77, v77, v25
    v_mul_f32 v40, 0x3f3504f3, v60
    v_mul_f32 v25, 0x3f3504f3, v60
    v_fmac_f32 v40, 0xbf3504f3, v65
    v_fmac_f32 v25, 0x3f3504f3, v65
    v_sub_f32 v60, v31, v73
    v_sub_f32 v65, v34, v56
    v_add_f32 v34, v34, v56
    v_add_f32 v73, v73, v31
    v_sub_f32 v56, v42, v80
    v_sub_f32 v31, v21, v35
    v_add_f32 v42, v42, v80
    v_add_f32 v21, v21, v35
    v_mul_f32 v80, 0xbf3504f3, v56
    v_mul_f32 v35, 0x3f3504f3, v56
    v_fmac_f32 v80, 0xbf3504f3, v31
    v_fmac_f32 v35, 0xbf3504f3, v31
    v_sub_f32 v56, v38, v24
    v_sub_f32 v31, v41, v75
    v_add_f32 v38, v38, v24
    v_add_f32 v41, v41, v75
    v_sub_f32 v24, v46, v76
    v_sub_f32 v75, v33, v53
    v_add_f32 v46, v46, v76
    v_add_f32 v33, v33, v53
    v_mul_f32 v76, 0x3f3504f3, v24
    v_mul_f32 v53, 0x3f3504f3, v24
    v_fmac_f32 v76, 0xbf3504f3, v75
    v_fmac_f32 v53, 0x3f3504f3, v75
    v_sub_f32 v24, v55, v47
    v_sub_f32 v75, v50, v18
    v_add_f32 v50, v50, v18
    v_add_f32 v47, v47, v55
    v_sub_f32 v18, v83, v72
    v_sub_f32 v55, v51, v59
    v_add_f32 v83, v83, v72
    v_add_f32 v51, v51, v59
    v_mul_f32 v72, 0xbf3504f3, v18
    v_mul_f32 v59, 0x3f3504f3, v18
    v_fmac_f32 v72, 0xbf3504f3, v55
    v_fmac_f32 v59, 0xbf3504f3, v55
    v_sub_f32 v18, v82, v16
    v_sub_f32 v55, v17, v19
    v_add_f32 v82, v82, v16
    v_add_f32 v17, v17, v19
    v_sub_f32 v16, v23, v49
    v_sub_f32 v19, v26, v74
    v_add_f32 v26, v26, v74
    v_add_f32 v49, v49, v23
    v_sub_f32 v74, v78, v48
    v_sub_f32 v23, v45, v27
    v_add_f32 v78, v78, v48
    v_add_f32 v45, v45, v27
    v_sub_f32 v48, v37, v39
    v_sub_f32 v27, v68, v66
    v_add_f32 v68, v68, v66
    v_add_f32 v39, v39, v37
    v_sub_f32 v66, v32, v52
    v_sub_f32 v37, v81, v61
    v_add_f32 v32, v32, v52
    v_add_f32 v81, v81, v61
    v_sub_f32 v52, v69, v71
    v_sub_f32 v61, v44, v58
    v_add_f32 v44, v44, v58
    v_add_f32 v71, v71, v69
    v_sub_f32 v58, v62, v54
    v_sub_f32 v69, v29, v43
    v_add_f32 v62, v62, v54
    v_add_f32 v29, v29, v43
    v_sub_f32 v54, v67, v57
    v_sub_f32 v43, v28, v64
    v_add_f32 v28, v28, v64
    v_add_f32 v57, v57, v67
    v_sub_f32 v64, v70, v34
    v_sub_f32 v67, v79, v73
    v_add_f32 v70, v70, v34
    v_add_f32 v79, v79, v73
    v_sub_f32 v34, v21, v77
    v_sub_f32 v73, v30, v42
    v_add_f32 v30, v30, v42
    v_add_f32 v77, v77, v21
    v_sub_f32 v42, v36, v60
    v_sub_f32 v21, v63, v65
    v_add_f32 v36, v36, v60
    v_add_f32 v63, v63, v65
    v_sub_f32 v60, v35, v25
    v_sub_f32 v65, v40, v80
    v_add_f32 v40, v40, v80
    v_add_f32 v25, v25, v35
    v_sub_f32 v80, v38, v50
    v_sub_f32 v35, v41, v47
    v_add_f32 v38, v38, v50
    v_add_f32 v41, v41, v47
    v_sub_f32 v50, v51, v33
    v_sub_f32 v47, v46, v83
    v_add_f32 v46, v46, v83
    v_add_f32 v33, v33, v51
    v_sub_f32 v83, v56, v24
    v_sub_f32 v51, v31, v75
    v_add_f32 v56, v56, v24
    v_add_f32 v31, v31, v75
    v_sub_f32 v24, v59, v53
    v_sub_f32 v75, v76, v72
    v_add_f32 v76, v76, v72
    v_add_f32 v53, v53, v59
    v_sub_f32 v72, v82, v26
    v_sub_f32 v59, v17, v49
    v_add_f32 v82, v82, v26
    v_add_f32 v17, v17, v49
    v_sub_f32 v26, v18, v16
    v_sub_f32 v49, v55, v19
    v_add_f32 v18, v18, v16
    v_add_f32 v55, v55, v19
    v_sub_f32 v16, v78, v68
    v_sub_f32 v19, v45, v39
    v_add_f32 v78, v78, v68
    v_add_f32 v45, v45, v39
    v_sub_f32 v68, v74, v48
    v_sub_f32 v39, v23, v27
    v_add_f32 v74, v74, v48
    v_add_f32 v23, v23, v27
    v_sub_f32 v48, v32, v44
    v_sub_f32 v27, v81, v71
    v_add_f32 v32, v32, v44
    v_add_f32 v81, v81, v71
    v_sub_f32 v44, v66, v52
    v_sub_f32 v71, v37, v61
    v_add_f32 v66, v66, v52
    v_add_f32 v37, v37, v61
    v_sub_f32 v52, v62, v28
    v_sub_f32 v61, v29, v57
    v_add_f32 v62, v62, v28
    v_add_f32 v29, v29, v57
    v_sub_f32 v28, v58, v54
    v_sub_f32 v57, v69, v43
    v_add_f32 v58, v58, v54
    v_add_f32 v69, v69, v43
    v_sub_f32 v54, v70, v30
    v_sub_f32 v43, v79, v77
    v_add_f32 v70, v70, v30
    v_add_f32 v79, v79, v77
    v_sub_f32 v30, v64, v34
    v_sub_f32 v77, v67, v73
    v_add_f32 v64, v64, v34
    v_add_f32 v67, v67, v73
    v_sub_f32 v34, v36, v40
    v_sub_f32 v73, v63, v25
    v_add_f32 v36, v36, v40
    v_add_f32 v63, v63, v25
    v_sub_f32 v40, v42, v60
    v_sub_f32 v25, v21, v65
    v_add_f32 v42, v42, v60
    v_add_f32 v21, v21, v65
    v_sub_f32 v60, v38, v46
    v_sub_f32 v65, v41, v33
    v_add_f32 v38, v38, v46
    v_add_f32 v41, v41, v33
    v_sub_f32 v46, v80, v50
    v_sub_f32 v33, v35, v47
    v_add_f32 v80, v80, v50
    v_add_f32 v35, v35, v47
    v_sub_f32 v50, v56, v76
    v_sub_f32 v47, v31, v53
    v_add_f32 v56, v56, v76
    v_add_f32 v31, v31, v53
    v_sub_f32 v76, v83, v24
    v_sub_f32 v53, v51, v75
    v_add_f32 v83, v83, v24
    v_add_f32 v51, v51, v75
    v_mul_f32 v12, v10, v8
    v_mul_f32 v12, 0x3a000000, v12
    v_mov_b32 v24, v12
    v_fmac_f32 v24, 0x00000000, v8
    v_cos_f32 v75, v24
    v_sin_f32 v22, v24
    s_nop 0
    v_mul_f32 v20, v82, v75
    v_fma_f32 v20, -v17, v22, v20
    v_mul_f32 v17, v17, v75
    v_fmac_f32 v17, v82, v22
    v_mov_b32 v24, v12
    v_fmac_f32 v24, 0x3a800000, v8
    v_cos_f32 v75, v24
    v_sin_f32 v22, v24
    s_nop 0
    v_mul_f32 v82, v70, v75
    v_fma_f32 v82, -v79, v22, v82
    v_mul_f32 v79, v79, v75
    v_fmac_f32 v79, v70, v22
    v_mov_b32 v24, v12
    v_fmac_f32 v24, 0x3b000000, v8
    v_cos_f32 v75, v24
    v_sin_f32 v22, v24
    s_nop 0
    v_mul_f32 v70, v32, v75
    v_fma_f32 v70, -v81, v22, v70
    v_mul_f32 v81, v81, v75
    v_fmac_f32 v81, v32, v22
    v_mov_b32 v24, v12
    v_fmac_f32 v24, 0x3b400000, v8
    v_cos_f32 v75, v24
    v_sin_f32 v22, v24
    s_nop 0
    v_mul_f32 v32, v38, v75
    v_fma_f32 v32, -v41, v22, v32
    v_mul_f32 v41, v41, v75
    v_fmac_f32 v41, v38, v22
    v_mov_b32 v24, v12
    v_fmac_f32 v24, 0x3b800000, v8
    v_cos_f32 v75, v24
    v_sin_f32 v22, v24
    s_nop 0
    v_mul_f32 v38, v78, v75
    v_fma_f32 v38, -v45, v22, v38
    v_mul_f32 v45, v45, v75
    v_fmac_f32 v45, v78, v22
    v_mov_b32 v24, v12
    v_fmac_f32 v24, 0x3ba00000, v8
    v_cos_f32 v75, v24
    v_sin_f32 v22, v24
    s_nop 0
    v_mul_f32 v78, v36, v75
    v_fma_f32 v78, -v63, v22, v78
    v_mul_f32 v63, v63, v75
    v_fmac_f32 v63, v36, v22
    v_mov_b32 v24, v12
    v_fmac_f32 v24, 0x3bc00000, v8
    v_cos_f32 v75, v24
    v_sin_f32 v22, v24
    s_nop 0
    v_mul_f32 v36, v62, v75
    v_fma_f32 v36, -v29, v22, v36
    v_mul_f32 v29, v29, v75
    v_fmac_f32 v29, v62, v22
    v_mov_b32 v24, v12
    v_fmac_f32 v24, 0x3be00000, v8
    v_cos_f32 v75, v24
    v_sin_f32 v22, v24
    s_nop 0
    v_mul_f32 v62, v56, v75
    v_fma_f32 v62, -v31, v22, v62
    v_mul_f32 v31, v31, v75
    v_fmac_f32 v31, v56, v22
    v_mov_b32 v24, v12
    v_fmac_f32 v24, 0x3c000000, v8
    v_cos_f32 v75, v24
    v_sin_f32 v22, v24
    s_nop 0
    v_mul_f32 v56, v18, v75
    v_fma_f32 v56, -v55, v22, v56
    v_mul_f32 v55, v55, v75
    v_fmac_f32 v55, v18, v22
    v_mov_b32 v24, v12
    v_fmac_f32 v24, 0x3c100000, v8
    v_cos_f32 v75, v24
    v_sin_f32 v22, v24
    s_nop 0
    v_mul_f32 v18, v64, v75
    v_fma_f32 v18, -v67, v22, v18
    v_mul_f32 v67, v67, v75
    v_fmac_f32 v67, v64, v22
    v_mov_b32 v24, v12
    v_fmac_f32 v24, 0x3c200000, v8
    v_cos_f32 v75, v24
    v_sin_f32 v22, v24
    s_nop 0
    v_mul_f32 v64, v66, v75
    v_fma_f32 v64, -v37, v22, v64
    v_mul_f32 v37, v37, v75
    v_fmac_f32 v37, v66, v22
    v_mov_b32 v24, v12
    v_fmac_f32 v24, 0x3c300000, v8
    v_cos_f32 v75, v24
    v_sin_f32 v22, v24
    s_nop 0
    v_mul_f32 v66, v80, v75
    v_fma_f32 v66, -v35, v22, v66
    v_mul_f32 v35, v35, v75
    v_fmac_f32 v35, v80, v22
    v_mov_b32 v24, v12
    v_fmac_f32 v24, 0x3c400000, v8
    v_cos_f32 v75, v24
    v_sin_f32 v22, v24
    s_nop 0
    v_mul_f32 v80, v74, v75
    v_fma_f32 v80, -v23, v22, v80
    v_mul_f32 v23, v23, v75
    v_fmac_f32 v23, v74, v22
    v_mov_b32 v24, v12
    v_fmac_f32 v24, 0x3c500000, v8
    v_cos_f32 v75, v24
    v_sin_f32 v22, v24
    s_nop 0
    v_mul_f32 v74, v42, v75
    v_fma_f32 v74, -v21, v22, v74
    v_mul_f32 v21, v21, v75
    v_fmac_f32 v21, v42, v22
    v_mov_b32 v24, v12
    v_fmac_f32 v24, 0x3c600000, v8
    v_cos_f32 v75, v24
    v_sin_f32 v22, v24
    s_nop 0
    v_mul_f32 v42, v58, v75
    v_fma_f32 v42, -v69, v22, v42
    v_mul_f32 v69, v69, v75
    v_fmac_f32 v69, v58, v22
    v_mov_b32 v24, v12
    v_fmac_f32 v24, 0x3c700000, v8
    v_cos_f32 v75, v24
    v_sin_f32 v22, v24
    s_nop 0
    v_mul_f32 v58, v83, v75
    v_fma_f32 v58, -v51, v22, v58
    v_mul_f32 v51, v51, v75
    v_fmac_f32 v51, v83, v22
    v_mov_b32 v24, v12
    v_fmac_f32 v24, 0x3c800000, v8
    v_cos_f32 v75, v24
    v_sin_f32 v22, v24
    s_nop 0
    v_mul_f32 v83, v72, v75
    v_fma_f32 v83, -v59, v22, v83
    v_mul_f32 v59, v59, v75
    v_fmac_f32 v59, v72, v22
    v_mov_b32 v24, v12
    v_fmac_f32 v24, 0x3c880000, v8
    v_cos_f32 v75, v24
    v_sin_f32 v22, v24
    s_nop 0
    v_mul_f32 v72, v54, v75
    v_fma_f32 v72, -v43, v22, v72
    v_mul_f32 v43, v43, v75
    v_fmac_f32 v43, v54, v22
    v_mov_b32 v24, v12
    v_fmac_f32 v24, 0x3c900000, v8
    v_cos_f32 v75, v24
    v_sin_f32 v22, v24
    s_nop 0
    v_mul_f32 v54, v48, v75
    v_fma_f32 v54, -v27, v22, v54
    v_mul_f32 v27, v27, v75
    v_fmac_f32 v27, v48, v22
    v_mov_b32 v24, v12
    v_fmac_f32 v24, 0x3c980000, v8
    v_cos_f32 v75, v24
    v_sin_f32 v22, v24
    s_nop 0
    v_mul_f32 v48, v60, v75
    v_fma_f32 v48, -v65, v22, v48
    v_mul_f32 v65, v65, v75
    v_fmac_f32 v65, v60, v22
    v_mov_b32 v24, v12
    v_fmac_f32 v24, 0x3ca00000, v8
    v_cos_f32 v75, v24
    v_sin_f32 v22, v24
    s_nop 0
    v_mul_f32 v60, v16, v75
    v_fma_f32 v60, -v19, v22, v60
    v_mul_f32 v19, v19, v75
    v_fmac_f32 v19, v16, v22
    v_mov_b32 v24, v12
    v_fmac_f32 v24, 0x3ca80000, v8
    v_cos_f32 v75, v24
    v_sin_f32 v22, v24
    s_nop 0
    v_mul_f32 v16, v34, v75
    v_fma_f32 v16, -v73, v22, v16
    v_mul_f32 v73, v73, v75
    v_fmac_f32 v73, v34, v22
    v_mov_b32 v24, v12
    v_fmac_f32 v24, 0x3cb00000, v8
    v_cos_f32 v75, v24
    v_sin_f32 v22, v24
    s_nop 0
    v_mul_f32 v34, v52, v75
    v_fma_f32 v34, -v61, v22, v34
    v_mul_f32 v61, v61, v75
    v_fmac_f32 v61, v52, v22
    v_mov_b32 v24, v12
    v_fmac_f32 v24, 0x3cb80000, v8
    v_cos_f32 v75, v24
    v_sin_f32 v22, v24
    s_nop 0
    v_mul_f32 v52, v50, v75
    v_fma_f32 v52, -v47, v22, v52
    v_mul_f32 v47, v47, v75
    v_fmac_f32 v47, v50, v22
    v_mov_b32 v24, v12
    v_fmac_f32 v24, 0x3cc00000, v8
    v_cos_f32 v75, v24
    v_sin_f32 v22, v24
    s_nop 0
    v_mul_f32 v50, v26, v75
    v_fma_f32 v50, -v49, v22, v50
    v_mul_f32 v49, v49, v75
    v_fmac_f32 v49, v26, v22
    v_mov_b32 v24, v12
    v_fmac_f32 v24, 0x3cc80000, v8
    v_cos_f32 v75, v24
    v_sin_f32 v22, v24
    s_nop 0
    v_mul_f32 v26, v30, v75
    v_fma_f32 v26, -v77, v22, v26
    v_mul_f32 v77, v77, v75
    v_fmac_f32 v77, v30, v22
    v_mov_b32 v24, v12
    v_fmac_f32 v24, 0x3cd00000, v8
    v_cos_f32 v75, v24
    v_sin_f32 v22, v24
    s_nop 0
    v_mul_f32 v30, v44, v75
    v_fma_f32 v30, -v71, v22, v30
    v_mul_f32 v71, v71, v75
    v_fmac_f32 v71, v44, v22
    v_mov_b32 v24, v12
    v_fmac_f32 v24, 0x3cd80000, v8
    v_cos_f32 v75, v24
    v_sin_f32 v22, v24
    s_nop 0
    v_mul_f32 v44, v46, v75
    v_fma_f32 v44, -v33, v22, v44
    v_mul_f32 v33, v33, v75
    v_fmac_f32 v33, v46, v22
    v_mov_b32 v24, v12
    v_fmac_f32 v24, 0x3ce00000, v8
    v_cos_f32 v75, v24
    v_sin_f32 v22, v24
    s_nop 0
    v_mul_f32 v46, v68, v75
    v_fma_f32 v46, -v39, v22, v46
    v_mul_f32 v39, v39, v75
    v_fmac_f32 v39, v68, v22
    v_mov_b32 v24, v12
    v_fmac_f32 v24, 0x3ce80000, v8
    v_cos_f32 v75, v24
    v_sin_f32 v22, v24
    s_nop 0
    v_mul_f32 v68, v40, v75
    v_fma_f32 v68, -v25, v22, v68
    v_mul_f32 v25, v25, v75
    v_fmac_f32 v25, v40, v22
    v_mov_b32 v24, v12
    v_fmac_f32 v24, 0x3cf00000, v8
    v_cos_f32 v75, v24
    v_sin_f32 v22, v24
    s_nop 0
    v_mul_f32 v40, v28, v75
    v_fma_f32 v40, -v57, v22, v40
    v_mul_f32 v57, v57, v75
    v_fmac_f32 v57, v28, v22
    v_mov_b32 v24, v12
    v_fmac_f32 v24, 0x3cf80000, v8
    v_cos_f32 v75, v24
    v_sin_f32 v22, v24
    s_nop 0
    v_mul_f32 v28, v76, v75
    v_fma_f32 v28, -v53, v22, v28
    v_mul_f32 v53, v53, v75
    v_fmac_f32 v53, v76, v22
    ds_write_b32 v4, v20 offset:0
    ds_write_b32 v4, v17 offset:4
    ds_write_b32 v4, v82 offset:16
    ds_write_b32 v4, v79 offset:20
    ds_write_b32 v4, v70 offset:32
    ds_write_b32 v4, v81 offset:36
    ds_write_b32 v4, v32 offset:48
    ds_write_b32 v4, v41 offset:52
    ds_write_b32 v4, v38 offset:64
    ds_write_b32 v4, v45 offset:68
    ds_write_b32 v4, v78 offset:80
    ds_write_b32 v4, v63 offset:84
    ds_write_b32 v4, v36 offset:96
    ds_write_b32 v4, v29 offset:100
    ds_write_b32 v4, v62 offset:112
    ds_write_b32 v4, v31 offset:116
    ds_write_b32 v4, v56 offset:128
    ds_write_b32 v4, v55 offset:132
    ds_write_b32 v4, v18 offset:144
    ds_write_b32 v4, v67 offset:148
    ds_write_b32 v4, v64 offset:160
    ds_write_b32 v4, v37 offset:164
    ds_write_b32 v4, v66 offset:176
    ds_write_b32 v4, v35 offset:180
    ds_write_b32 v4, v80 offset:192
    ds_write_b32 v4, v23 offset:196
    ds_write_b32 v4, v74 offset:208
    ds_write_b32 v4, v21 offset:212
    ds_write_b32 v4, v42 offset:224
    ds_write_b32 v4, v69 offset:228
    ds_write_b32 v4, v58 offset:240
    ds_write_b32 v4, v51 offset:244
    ds_write_b32 v4, v83 offset:256
    ds_write_b32 v4, v59 offset:260
    ds_write_b32 v4, v72 offset:272
    ds_write_b32 v4, v43 offset:276
    ds_write_b32 v4, v54 offset:288
    ds_write_b32 v4, v27 offset:292
    ds_write_b32 v4, v48 offset:304
    ds_write_b32 v4, v65 offset:308
    ds_write_b32 v4, v60 offset:320
    ds_write_b32 v4, v19 offset:324
    ds_write_b32 v4, v16 offset:336
    ds_write_b32 v4, v73 offset:340
    ds_write_b32 v4, v34 offset:352
    ds_write_b32 v4, v61 offset:356
    ds_write_b32 v4, v52 offset:368
    ds_write_b32 v4, v47 offset:372
    ds_write_b32 v4, v50 offset:384
    ds_write_b32 v4, v49 offset:388
    ds_write_b32 v4, v26 offset:400
    ds_write_b32 v4, v77 offset:404
    ds_write_b32 v4, v30 offset:416
    ds_write_b32 v4, v71 offset:420
    ds_write_b32 v4, v44 offset:432
    ds_write_b32 v4, v33 offset:436
    ds_write_b32 v4, v46 offset:448
    ds_write_b32 v4, v39 offset:452
    ds_write_b32 v4, v68 offset:464
    ds_write_b32 v4, v25 offset:468
    ds_write_b32 v4, v40 offset:480
    ds_write_b32 v4, v57 offset:484
    ds_write_b32 v4, v28 offset:496
    ds_write_b32 v4, v53 offset:500
    s_waitcnt lgkmcnt(0)
    ds_read_b32 v20, v3 offset:0
    ds_read_b32 v17, v3 offset:4
    ds_read_b32 v82, v3 offset:528
    ds_read_b32 v79, v3 offset:532
    ds_read_b32 v70, v3 offset:1056
    ds_read_b32 v81, v3 offset:1060
    ds_read_b32 v32, v3 offset:1584
    ds_read_b32 v41, v3 offset:1588
    ds_read_b32 v38, v3 offset:2112
    ds_read_b32 v45, v3 offset:2116
    ds_read_b32 v78, v3 offset:2640
    ds_read_b32 v63, v3 offset:2644
    ds_read_b32 v36, v3 offset:3168
    ds_read_b32 v29, v3 offset:3172
    s_waitcnt lgkmcnt(0)
    ds_read_b32 v62, v3 offset:3696
    ds_read_b32 v31, v3 offset:3700
    ds_read_b32 v56, v3 offset:4224
    ds_read_b32 v55, v3 offset:4228
    ds_read_b32 v18, v3 offset:4752
    ds_read_b32 v67, v3 offset:4756
    ds_read_b32 v64, v3 offset:5280
    ds_read_b32 v37, v3 offset:5284
    ds_read_b32 v66, v3 offset:5808
    ds_read_b32 v35, v3 offset:5812
    ds_read_b32 v80, v3 offset:6336
    ds_read_b32 v23, v3 offset:6340
    ds_read_b32 v74, v3 offset:6864
    ds_read_b32 v21, v3 offset:6868
    s_waitcnt lgkmcnt(0)
    ds_read_b32 v42, v3 offset:7392
    ds_read_b32 v69, v3 offset:7396
    ds_read_b32 v58, v3 offset:7920
    ds_read_b32 v51, v3 offset:7924
    ds_read_b32 v83, v3 offset:8448
    ds_read_b32 v59, v3 offset:8452
    ds_read_b32 v72, v3 offset:8976
    ds_read_b32 v43, v3 offset:8980
    ds_read_b32 v54, v3 offset:9504
    ds_read_b32 v27, v3 offset:9508
    ds_read_b32 v48, v3 offset:10032
    ds_read_b32 v65, v3 offset:10036
    ds_read_b32 v60, v3 offset:10560
    ds_read_b32 v19, v3 offset:10564
    s_waitcnt lgkmcnt(0)
    ds_read_b32 v16, v3 offset:11088
    ds_read_b32 v73, v3 offset:11092
    ds_read_b32 v34, v3 offset:11616
    ds_read_b32 v61, v3 offset:11620
    ds_read_b32 v52, v3 offset:12144
    ds_read_b32 v47, v3 offset:12148
    ds_read_b32 v50, v3 offset:12672
    ds_read_b32 v49, v3 offset:12676
    ds_read_b32 v26, v3 offset:13200
    ds_read_b32 v77, v3 offset:13204
    ds_read_b32 v30, v3 offset:13728
    ds_read_b32 v71, v3 offset:13732
    ds_read_b32 v44, v3 offset:14256
    ds_read_b32 v33, v3 offset:14260
    s_waitcnt lgkmcnt(0)
    ds_read_b32 v46, v3 offset:14784
    ds_read_b32 v39, v3 offset:14788
    ds_read_b32 v68, v3 offset:15312
    ds_read_b32 v25, v3 offset:15316
    ds_read_b32 v40, v3 offset:15840
    ds_read_b32 v57, v3 offset:15844
    ds_read_b32 v28, v3 offset:16368
    ds_read_b32 v53, v3 offset:16372
    s_waitcnt lgkmcnt(0)
    v_sub_f32 v24, v20, v83
    v_sub_f32 v75, v17, v59
    v_add_f32 v20, v20, v83
    v_add_f32 v17, v17, v59
    v_sub_f32 v83, v82, v72
    v_sub_f32 v59, v79, v43
    v_add_f32 v82, v82, v72
    v_add_f32 v79, v79, v43
    v_mul_f32 v72, 0x3f7b14be, v83
    v_mul_f32 v43, 0x3e47c5c2, v83
    v_fmac_f32 v72, 0xbe47c5c2, v59
    v_fmac_f32 v43, 0x3f7b14be, v59
    v_sub_f32 v83, v70, v54
    v_sub_f32 v59, v81, v27
    v_add_f32 v70, v70, v54
    v_add_f32 v81, v81, v27
    v_mul_f32 v54, 0x3f6c835e, v83
    v_mul_f32 v27, 0x3ec3ef15, v83
    v_fmac_f32 v54, 0xbec3ef15, v59
    v_fmac_f32 v27, 0x3f6c835e, v59
    v_sub_f32 v83, v32, v48
    v_sub_f32 v59, v41, v65
    v_add_f32 v32, v32, v48
    v_add_f32 v41, v41, v65
    v_mul_f32 v48, 0x3f54db31, v83
    v_mul_f32 v65, 0x3f0e39da, v83
    v_fmac_f32 v48, 0xbf0e39da, v59
    v_fmac_f32 v65, 0x3f54db31, v59
    v_sub_f32 v83, v38, v60
    v_sub_f32 v59, v45, v19
    v_add_f32 v38, v38, v60
    v_add_f32 v45, v45, v19
    v_mul_f32 v60, 0x3f3504f3, v83
    v_mul_f32 v19, 0x3f3504f3, v83
    v_fmac_f32 v60, 0xbf3504f3, v59
    v_fmac_f32 v19, 0x3f3504f3, v59
    v_sub_f32 v83, v78, v16
    v_sub_f32 v59, v63, v73
    v_add_f32 v78, v78, v16
    v_add_f32 v63, v63, v73
    v_mul_f32 v16, 0x3f0e39da, v83
    v_mul_f32 v73, 0x3f54db31, v83
    v_fmac_f32 v16, 0xbf54db31, v59
    v_fmac_f32 v73, 0x3f0e39da, v59
    v_sub_f32 v83, v36, v34
    v_sub_f32 v59, v29, v61
    v_add_f32 v36, v36, v34
    v_add_f32 v29, v29, v61
    v_mul_f32 v34, 0x3ec3ef15, v83
    v_mul_f32 v61, 0x3f6c835e, v83
    v_fmac_f32 v34, 0xbf6c835e, v59
    v_fmac_f32 v61, 0x3ec3ef15, v59
    v_sub_f32 v83, v62, v52
    v_sub_f32 v59, v31, v47
    v_add_f32 v62, v62, v52
    v_add_f32 v31, v31, v47
    v_mul_f32 v52, 0x3e47c5c2, v83
    v_mul_f32 v47, 0x3f7b14be, v83
    v_fmac_f32 v52, 0xbf7b14be, v59
    v_fmac_f32 v47, 0x3e47c5c2, v59
    v_sub_f32 v83, v49, v55
    v_sub_f32 v59, v56, v50
    v_add_f32 v56, v56, v50
    v_add_f32 v55, v55, v49
    v_sub_f32 v50, v18, v26
    v_sub_f32 v49, v67, v77
    v_add_f32 v18, v18, v26
    v_add_f32 v67, v67, v77
    v_mul_f32 v26, 0xbe47c5c2, v50
    v_mul_f32 v77, 0x3f7b14be, v50
    v_fmac_f32 v26, 0xbf7b14be, v49
    v_fmac_f32 v77, 0xbe47c5c2, v49
    v_sub_f32 v50, v64, v30
    v_sub_f32 v49, v37, v71
    v_add_f32 v64, v64, v30
    v_add_f32 v37, v37, v71
    v_mul_f32 v30, 0xbec3ef15, v50
    v_mul_f32 v71, 0x3f6c835e, v50
    v_fmac_f32 v30, 0xbf6c835e, v49
    v_fmac_f32 v71, 0xbec3ef15, v49
    v_sub_f32 v50, v66, v44
    v_sub_f32 v49, v35, v33
    v_add_f32 v66, v66, v44
    v_add_f32 v35, v35, v33
    v_mul_f32 v44, 0xbf0e39da, v50
    v_mul_f32 v33, 0x3f54db31, v50
    v_fmac_f32 v44, 0xbf54db31, v49
    v_fmac_f32 v33, 0xbf0e39da, v49
    v_sub_f32 v50, v80, v46
    v_sub_f32 v49, v23, v39
    v_add_f32 v80, v80, v46
    v_add_f32 v23, v23, v39
    v_mul_f32 v46, 0xbf3504f3, v50
    v_mul_f32 v39, 0x3f3504f3, v50
    v_fmac_f32 v46, 0xbf3504f3, v49
    v_fmac_f32 v39, 0xbf3504f3, v49
    v_sub_f32 v50, v74, v68
    v_sub_f32 v49, v21, v25
    v_add_f32 v74, v74, v68
    v_add_f32 v21, v21, v25
    v_mul_f32 v68, 0xbf54db31, v50
    v_mul_f32 v25, 0x3f0e39da, v50
    v_fmac_f32 v68, 0xbf0e39da, v49
    v_fmac_f32 v25, 0xbf54db31, v49
    v_sub_f32 v50, v42, v40
    v_sub_f32 v49, v69, v57
    v_add_f32 v42, v42, v40
    v_add_f32 v69, v69, v57
    v_mul_f32 v40, 0xbf6c835e, v50
    v_mul_f32 v57, 0x3ec3ef15, v50
    v_fmac_f32 v40, 0xbec3ef15, v49
    v_fmac_f32 v57, 0xbf6c835e, v49
    v_sub_f32 v50, v58, v28
    v_sub_f32 v49, v51, v53
    v_add_f32 v58, v58, v28
    v_add_f32 v51, v51, v53
    v_mul_f32 v28, 0xbf7b14be, v50
    v_mul_f32 v53, 0x3e47c5c2, v50
    v_fmac_f32 v28, 0xbe47c5c2, v49
    v_fmac_f32 v53, 0xbf7b14be, v49
    v_sub_f32 v50, v20, v56
    v_sub_f32 v49, v17, v55
    v_add_f32 v20, v20, v56
    v_add_f32 v17, v17, v55
    v_sub_f32 v56, v82, v18
    v_sub_f32 v55, v79, v67
    v_add_f32 v82, v82, v18
    v_add_f32 v79, v79, v67
    v_mul_f32 v18, 0x3f6c835e, v56
    v_mul_f32 v67, 0x3ec3ef15, v56
    v_fmac_f32 v18, 0xbec3ef15, v55
    v_fmac_f32 v67, 0x3f6c835e, v55
    v_sub_f32 v56, v70, v64
    v_sub_f32 v55, v81, v37
    v_add_f32 v70, v70, v64
    v_add_f32 v81, v81, v37
    v_mul_f32 v64, 0x3f3504f3, v56
    v_mul_f32 v37, 0x3f3504f3, v56
    v_fmac_f32 v64, 0xbf3504f3, v55
    v_fmac_f32 v37, 0x3f3504f3, v55
    v_sub_f32 v56, v32, v66
    v_sub_f32 v55, v41, v35
    v_add_f32 v32, v32, v66
    v_add_f32 v41, v41, v35
    v_mul_f32 v66, 0x3ec3ef15, v56
    v_mul_f32 v35, 0x3f6c835e, v56
    v_fmac_f32 v66, 0xbf6c835e, v55
    v_fmac_f32 v35, 0x3ec3ef15, v55
    v_sub_f32 v56, v23, v45
    v_sub_f32 v55, v38, v80
    v_add_f32 v38, v38, v80
    v_add_f32 v45, v45, v23
    v_sub_f32 v80, v78, v74
    v_sub_f32 v23, v63, v21
    v_add_f32 v78, v78, v74
    v_add_f32 v63, v63, v21
    v_mul_f32 v74, 0xbec3ef15, v80
    v_mul_f32 v21, 0x3f6c835e, v80
    v_fmac_f32 v74, 0xbf6c835e, v23
    v_fmac_f32 v21, 0xbec3ef15, v23
    v_sub_f32 v80, v36, v42
    v_sub_f32 v23, v29, v69
    v_add_f32 v36, v36, v42
    v_add_f32 v29, v29, v69
    v_mul_f32 v42, 0xbf3504f3, v80
    v_mul_f32 v69, 0x3f3504f3, v80
    v_fmac_f32 v42, 0xbf3504f3, v23
    v_fmac_f32 v69, 0xbf3504f3, v23
    v_sub_f32 v80, v62, v58
    v_sub_f32 v23, v31, v51
    v_add_f32 v62, v62, v58
    v_add_f32 v31, v31, v51
    v_mul_f32 v58, 0xbf6c835e, v80
    v_mul_f32 v51, 0x3ec3ef15, v80
    v_fmac_f32 v58, 0xbec3ef15, v23
    v_fmac_f32 v51, 0xbf6c835e, v23
    v_sub_f32 v80, v24, v83
    v_sub_f32 v23, v75, v59
    v_add_f32 v24, v24, v83
    v_add_f32 v75, v75, v59
    v_sub_f32 v83, v72, v26
    v_sub_f32 v59, v43, v77
    v_add_f32 v72, v72, v26
    v_add_f32 v43, v43, v77
    v_mul_f32 v26, 0x3f6c835e, v83
    v_mul_f32 v77, 0x3ec3ef15, v83
    v_fmac_f32 v26, 0xbec3ef15, v59
    v_fmac_f32 v77, 0x3f6c835e, v59
    v_sub_f32 v83, v54, v30
    v_sub_f32 v59, v27, v71
    v_add_f32 v54, v54, v30
    v_add_f32 v27, v27, v71
    v_mul_f32 v30, 0x3f3504f3, v83
    v_mul_f32 v71, 0x3f3504f3, v83
    v_fmac_f32 v30, 0xbf3504f3, v59
    v_fmac_f32 v71, 0x3f3504f3, v59
    v_sub_f32 v83, v48, v44
    v_sub_f32 v59, v65, v33
    v_add_f32 v48, v48, v44
    v_add_f32 v65, v65, v33
    v_mul_f32 v44, 0x3ec3ef15, v83
    v_mul_f32 v33, 0x3f6c835e, v83
    v_fmac_f32 v44, 0xbf6c835e, v59
    v_fmac_f32 v33, 0x3ec3ef15, v59
    v_sub_f32 v83, v39, v19
    v_sub_f32 v59, v60, v46
    v_add_f32 v60, v60, v46
    v_add_f32 v19, v19, v39
    v_sub_f32 v46, v16, v68
    v_sub_f32 v39, v73, v25
    v_add_f32 v16, v16, v68
    v_add_f32 v73, v73, v25
    v_mul_f32 v68, 0xbec3ef15, v46
    v_mul_f32 v25, 0x3f6c835e, v46
    v_fmac_f32 v68, 0xbf6c835e, v39
    v_fmac_f32 v25, 0xbec3ef15, v39
    v_sub_f32 v46, v34, v40
    v_sub_f32 v39, v61, v57
    v_add_f32 v34, v34, v40
    v_add_f32 v61, v61, v57
    v_mul_f32 v40, 0xbf3504f3, v46
    v_mul_f32 v57, 0x3f3504f3, v46
    v_fmac_f32 v40, 0xbf3504f3, v39
    v_fmac_f32 v57, 0xbf3504f3, v39
    v_sub_f32 v46, v52, v28
    v_sub_f32 v39, v47, v53
    v_add_f32 v52, v52, v28
    v_add_f32 v47, v47, v53
    v_mul_f32 v28, 0xbf6c835e, v46
    v_mul_f32 v53, 0x3ec3ef15, v46
    v_fmac_f32 v28, 0xbec3ef15, v39
    v_fmac_f32 v53, 0xbf6c835e, v39
    v_sub_f32 v46, v20, v38
    v_sub_f32 v39, v17, v45
    v_add_f32 v20, v20, v38
    v_add_f32 v17, v17, v45
    v_sub_f32 v38, v82, v78
    v_sub_f32 v45, v79, v63
    v_add_f32 v82, v82, v78
    v_add_f32 v79, v79, v63
    v_mul_f32 v78, 0x3f3504f3, v38
    v_mul_f32 v63, 0x3f3504f3, v38
    v_fmac_f32 v78, 0xbf3504f3, v45
    v_fmac_f32 v63, 0x3f3504f3, v45
    v_sub_f32 v38, v29, v81
    v_sub_f32 v45, v70, v36
    v_add_f32 v70, v70, v36
    v_add_f32 v81, v81, v29
    v_sub_f32 v36, v32, v62
    v_sub_f32 v29, v41, v31
    v_add_f32 v32, v32, v62
    v_add_f32 v41, v41, v31
    v_mul_f32 v62, 0xbf3504f3, v36
    v_mul_f32 v31, 0x3f3504f3, v36
    v_fmac_f32 v62, 0xbf3504f3, v29
    v_fmac_f32 v31, 0xbf3504f3, v29
    v_sub_f32 v36, v50, v56
    v_sub_f32 v29, v49, v55
    v_add_f32 v50, v50, v56
    v_add_f32 v49, v49, v55
    v_sub_f32 v56, v18, v74
    v_sub_f32 v55, v67, v21
    v_add_f32 v18, v18, v74
    v_add_f32 v67, v67, v21
    v_mul_f32 v74, 0x3f3504f3, v56
    v_mul_f32 v21, 0x3f3504f3, v56
    v_fmac_f32 v74, 0xbf3504f3, v55
    v_fmac_f32 v21, 0x3f3504f3, v55
    v_sub_f32 v56, v69, v37
    v_sub_f32 v55, v64, v42
    v_add_f32 v64, v64, v42
    v_add_f32 v37, v37, v69
    v_sub_f32 v42, v66, v58
    v_sub_f32 v69, v35, v51
    v_add_f32 v66, v66, v58
    v_add_f32 v35, v35, v51
    v_mul_f32 v58, 0xbf3504f3, v42
    v_mul_f32 v51, 0x3f3504f3, v42
    v_fmac_f32 v58, 0xbf3504f3, v69
    v_fmac_f32 v51, 0xbf3504f3, v69
    v_sub_f32 v42, v24, v60
    v_sub_f32 v69, v75, v19
    v_add_f32 v24, v24, v60
    v_add_f32 v75, v75, v19
    v_sub_f32 v60, v72, v16
    v_sub_f32 v19, v43, v73
    v_add_f32 v72, v72, v16
    v_add_f32 v43, v43, v73
    v_mul_f32 v16, 0x3f3504f3, v60
    v_mul_f32 v73, 0x3f3504f3, v60
    v_fmac_f32 v16, 0xbf3504f3, v19
    v_fmac_f32 v73, 0x3f3504f3, v19
    v_sub_f32 v60, v61, v27
    v_sub_f32 v19, v54, v34
    v_add_f32 v54, v54, v34
    v_add_f32 v27, v27, v61
    v_sub_f32 v34, v48, v52
    v_sub_f32 v61, v65, v47
    v_add_f32 v48, v48, v52
    v_add_f32 v65, v65, v47
    v_mul_f32 v52, 0xbf3504f3, v34
    v_mul_f32 v47, 0x3f3504f3, v34
    v_fmac_f32 v52, 0xbf3504f3, v61
    v_fmac_f32 v47, 0xbf3504f3, v61
    v_sub_f32 v34, v80, v83
    v_sub_f32 v61, v23, v59
    v_add_f32 v80, v80, v83
    v_add_f32 v23, v23, v59
    v_sub_f32 v83, v26, v68
    v_sub_f32 v59, v77, v25
    v_add_f32 v26, v26, v68
    v_add_f32 v77, v77, v25
    v_mul_f32 v68, 0x3f3504f3, v83
    v_mul_f32 v25, 0x3f3504f3, v83
    v_fmac_f32 v68, 0xbf3504f3, v59
    v_fmac_f32 v25, 0x3f3504f3, v59
    v_sub_f32 v83, v57, v71
    v_sub_f32 v59, v30, v40
    v_add_f32 v30, v30, v40
    v_add_f32 v71, v71, v57
    v_sub_f32 v40, v44, v28
    v_sub_f32 v57, v33, v53
    v_add_f32 v44, v44, v28
    v_add_f32 v33, v33, v53
    v_mul_f32 v28, 0xbf3504f3, v40
    v_mul_f32 v53, 0x3f3504f3, v40
    v_fmac_f32 v28, 0xbf3504f3, v57
    v_fmac_f32 v53, 0xbf3504f3, v57
    v_sub_f32 v40, v20, v70
    v_sub_f32 v57, v17, v81
    v_add_f32 v20, v20, v70
    v_add_f32 v17, v17, v81
    v_sub_f32 v70, v41, v79
    v_sub_f32 v81, v82, v32
    v_add_f32 v82, v82, v32
    v_add_f32 v79, v79, v41
    v_sub_f32 v32, v46, v38
    v_sub_f32 v41, v39, v45
    v_add_f32 v46, v46, v38
    v_add_f32 v39, v39, v45
    v_sub_f32 v38, v31, v63
    v_sub_f32 v45, v78, v62
    v_add_f32 v78, v78, v62
    v_add_f32 v63, v63, v31
    v_sub_f32 v62, v50, v64
    v_sub_f32 v31, v49, v37
    v_add_f32 v50, v50, v64
    v_add_f32 v49, v49, v37
    v_sub_f32 v64, v35, v67
    v_sub_f32 v37, v18, v66
    v_add_f32 v18, v18, v66
    v_add_f32 v67, v67, v35
    v_sub_f32 v66, v36, v56
    v_sub_f32 v35, v29, v55
    v_add_f32 v36, v36, v56
    v_add_f32 v29, v29, v55
    v_sub_f32 v56, v51, v21
    v_sub_f32 v55, v74, v58
    v_add_f32 v74, v74, v58
    v_add_f32 v21, v21, v51
    v_sub_f32 v58, v24, v54
    v_sub_f32 v51, v75, v27
    v_add_f32 v24, v24, v54
    v_add_f32 v75, v75, v27
    v_sub_f32 v54, v65, v43
    v_sub_f32 v27, v72, v48
    v_add_f32 v72, v72, v48
    v_add_f32 v43, v43, v65
    v_sub_f32 v48, v42, v60
    v_sub_f32 v65, v69, v19
    v_add_f32 v42, v42, v60
    v_add_f32 v69, v69, v19
    v_sub_f32 v60, v47, v73
    v_sub_f32 v19, v16, v52
    v_add_f32 v16, v16, v52
    v_add_f32 v73, v73, v47
    v_sub_f32 v52, v80, v30
    v_sub_f32 v47, v23, v71
    v_add_f32 v80, v80, v30
    v_add_f32 v23, v23, v71
    v_sub_f32 v30, v33, v77
    v_sub_f32 v71, v26, v44
    v_add_f32 v26, v26, v44
    v_add_f32 v77, v77, v33
    v_sub_f32 v44, v34, v83
    v_sub_f32 v33, v61, v59
    v_add_f32 v34, v34, v83
    v_add_f32 v61, v61, v59
    v_sub_f32 v83, v53, v25
    v_sub_f32 v59, v68, v28
    v_add_f32 v68, v68, v28
    v_add_f32 v25, v25, v53
    v_sub_f32 v28, v20, v82
    v_sub_f32 v53, v17, v79
    v_add_f32 v20, v20, v82
    v_add_f32 v17, v17, v79
    v_sub_f32 v82, v40, v70
    v_sub_f32 v79, v57, v81
    v_add_f32 v40, v40, v70
    v_add_f32 v57, v57, v81
    v_sub_f32 v70, v46, v78
    v_sub_f32 v81, v39, v63
    v_add_f32 v46, v46, v78
    v_add_f32 v39, v39, v63
    v_sub_f32 v78, v32, v38
    v_sub_f32 v63, v41, v45
    v_add_f32 v32, v32, v38
    v_add_f32 v41, v41, v45
    v_sub_f32 v38, v50, v18
    v_sub_f32 v45, v49, v67
    v_add_f32 v50, v50, v18
    v_add_f32 v49, v49, v67
    v_sub_f32 v18, v62, v64
    v_sub_f32 v67, v31, v37
    v_add_f32 v62, v62, v64
    v_add_f32 v31, v31, v37
    v_sub_f32 v64, v36, v74
    v_sub_f32 v37, v29, v21
    v_add_f32 v36, v36, v74
    v_add_f32 v29, v29, v21
    v_sub_f32 v74, v66, v56
    v_sub_f32 v21, v35, v55
    v_add_f32 v66, v66, v56
    v_add_f32 v35, v35, v55
    v_sub_f32 v56, v24, v72
    v_sub_f32 v55, v75, v43
    v_add_f32 v24, v24, v72
    v_add_f32 v75, v75, v43
    v_sub_f32 v72, v58, v54
    v_sub_f32 v43, v51, v27
    v_add_f32 v58, v58, v54
    v_add_f32 v51, v51, v27
    v_sub_f32 v54, v42, v16
    v_sub_f32 v27, v69, v73
    v_add_f32 v42, v42, v16
    v_add_f32 v69, v69, v73
    v_sub_f32 v16, v48, v60
    v_sub_f32 v73, v65, v19
    v_add_f32 v48, v48, v60
    v_add_f32 v65, v65, v19
    v_sub_f32 v60, v80, v26
    v_sub_f32 v19, v23, v77
    v_add_f32 v80, v80, v26
    v_add_f32 v23, v23, v77
    v_sub_f32 v26, v52, v30
    v_sub_f32 v77, v47, v71
    v_add_f32 v52, v52, v30
    v_add_f32 v47, v47, v71
    v_sub_f32 v30, v34, v68
    v_sub_f32 v71, v61, v25
    v_add_f32 v34, v34, v68
    v_add_f32 v61, v61, v25
    v_sub_f32 v68, v44, v83
    v_sub_f32 v25, v33, v59
    v_add_f32 v44, v44, v83
    v_add_f32 v33, v33, v59
    s_add_u32 s15, s14, 109051904
    v_lshlrev_b32 v5, 3, v1
    s_add_u32 s16, s15, 0
    v_mov_b32 v88, v20
    v_mov_b32 v89, v17
    buffer_store_dwordx2 v[88:89], v5, s[8:11], s16 offen sc1
    s_add_u32 s16, s15, 512
    v_mov_b32 v90, v24
    v_mov_b32 v91, v75
    buffer_store_dwordx2 v[90:91], v5, s[8:11], s16 offen sc1
    s_add_u32 s16, s15, 1024
    v_mov_b32 v92, v50
    v_mov_b32 v93, v49
    buffer_store_dwordx2 v[92:93], v5, s[8:11], s16 offen sc1
    s_add_u32 s16, s15, 1536
    v_mov_b32 v94, v80
    v_mov_b32 v95, v23
    buffer_store_dwordx2 v[94:95], v5, s[8:11], s16 offen sc1
    s_add_u32 s16, s15, 2048
    v_mov_b32 v96, v46
    v_mov_b32 v97, v39
    buffer_store_dwordx2 v[96:97], v5, s[8:11], s16 offen sc1
    s_add_u32 s16, s15, 2560
    v_mov_b32 v98, v42
    v_mov_b32 v99, v69
    buffer_store_dwordx2 v[98:99], v5, s[8:11], s16 offen sc1
    s_add_u32 s16, s15, 3072
    v_mov_b32 v100, v36
    v_mov_b32 v101, v29
    buffer_store_dwordx2 v[100:101], v5, s[8:11], s16 offen sc1
    s_add_u32 s16, s15, 3584
    v_mov_b32 v102, v34
    v_mov_b32 v103, v61
    buffer_store_dwordx2 v[102:103], v5, s[8:11], s16 offen sc1
    s_add_u32 s16, s15, 4096
    v_mov_b32 v88, v40
    v_mov_b32 v89, v57
    buffer_store_dwordx2 v[88:89], v5, s[8:11], s16 offen sc1
    s_add_u32 s16, s15, 4608
    v_mov_b32 v90, v58
    v_mov_b32 v91, v51
    buffer_store_dwordx2 v[90:91], v5, s[8:11], s16 offen sc1
    s_add_u32 s16, s15, 5120
    v_mov_b32 v92, v62
    v_mov_b32 v93, v31
    buffer_store_dwordx2 v[92:93], v5, s[8:11], s16 offen sc1
    s_add_u32 s16, s15, 5632
    v_mov_b32 v94, v52
    v_mov_b32 v95, v47
    buffer_store_dwordx2 v[94:95], v5, s[8:11], s16 offen sc1
    s_add_u32 s16, s15, 6144
    v_mov_b32 v96, v32
    v_mov_b32 v97, v41
    buffer_store_dwordx2 v[96:97], v5, s[8:11], s16 offen sc1
    s_add_u32 s16, s15, 6656
    v_mov_b32 v98, v48
    v_mov_b32 v99, v65
    buffer_store_dwordx2 v[98:99], v5, s[8:11], s16 offen sc1
    s_add_u32 s16, s15, 7168
    v_mov_b32 v100, v66
    v_mov_b32 v101, v35
    buffer_store_dwordx2 v[100:101], v5, s[8:11], s16 offen sc1
    s_add_u32 s16, s15, 7680
    v_mov_b32 v102, v44
    v_mov_b32 v103, v33
    buffer_store_dwordx2 v[102:103], v5, s[8:11], s16 offen sc1
    s_add_u32 s16, s15, 8192
    v_mov_b32 v88, v28
    v_mov_b32 v89, v53
    buffer_store_dwordx2 v[88:89], v5, s[8:11], s16 offen sc1
    s_add_u32 s16, s15, 8704
    v_mov_b32 v90, v56
    v_mov_b32 v91, v55
    buffer_store_dwordx2 v[90:91], v5, s[8:11], s16 offen sc1
    s_add_u32 s16, s15, 9216
    v_mov_b32 v92, v38
    v_mov_b32 v93, v45
    buffer_store_dwordx2 v[92:93], v5, s[8:11], s16 offen sc1
    s_add_u32 s16, s15, 9728
    v_mov_b32 v94, v60
    v_mov_b32 v95, v19
    buffer_store_dwordx2 v[94:95], v5, s[8:11], s16 offen sc1
    s_add_u32 s16, s15, 10240
    v_mov_b32 v96, v70
    v_mov_b32 v97, v81
    buffer_store_dwordx2 v[96:97], v5, s[8:11], s16 offen sc1
    s_add_u32 s16, s15, 10752
    v_mov_b32 v98, v54
    v_mov_b32 v99, v27
    buffer_store_dwordx2 v[98:99], v5, s[8:11], s16 offen sc1
    s_add_u32 s16, s15, 11264
    v_mov_b32 v100, v64
    v_mov_b32 v101, v37
    buffer_store_dwordx2 v[100:101], v5, s[8:11], s16 offen sc1
    s_add_u32 s16, s15, 11776
    v_mov_b32 v102, v30
    v_mov_b32 v103, v71
    buffer_store_dwordx2 v[102:103], v5, s[8:11], s16 offen sc1
    s_add_u32 s16, s15, 12288
    v_mov_b32 v88, v82
    v_mov_b32 v89, v79
    buffer_store_dwordx2 v[88:89], v5, s[8:11], s16 offen sc1
    s_add_u32 s16, s15, 12800
    v_mov_b32 v90, v72
    v_mov_b32 v91, v43
    buffer_store_dwordx2 v[90:91], v5, s[8:11], s16 offen sc1
    s_add_u32 s16, s15, 13312
    v_mov_b32 v92, v18
    v_mov_b32 v93, v67
    buffer_store_dwordx2 v[92:93], v5, s[8:11], s16 offen sc1
    s_add_u32 s16, s15, 13824
    v_mov_b32 v94, v26
    v_mov_b32 v95, v77
    buffer_store_dwordx2 v[94:95], v5, s[8:11], s16 offen sc1
    s_add_u32 s16, s15, 14336
    v_mov_b32 v96, v78
    v_mov_b32 v97, v63
    buffer_store_dwordx2 v[96:97], v5, s[8:11], s16 offen sc1
    s_add_u32 s16, s15, 14848
    v_mov_b32 v98, v16
    v_mov_b32 v99, v73
    buffer_store_dwordx2 v[98:99], v5, s[8:11], s16 offen sc1
    s_add_u32 s16, s15, 15360
    v_mov_b32 v100, v74
    v_mov_b32 v101, v21
    buffer_store_dwordx2 v[100:101], v5, s[8:11], s16 offen sc1
    s_add_u32 s16, s15, 15872
    v_mov_b32 v102, v68
    v_mov_b32 v103, v25
    buffer_store_dwordx2 v[102:103], v5, s[8:11], s16 offen sc1
mega_kernel_f2_end:
    s_cmp_eq_u32 s99, 128
    s_cbranch_scc1 mega_kernel_f2ret
    s_waitcnt vmcnt(0)
    s_barrier
    v_mov_b32 v2, 1
    v_cmp_eq_u32 vcc, 0, v0
    s_and_saveexec_b64 s[80:81], vcc
    s_cbranch_execz mega_kernel_sg136_5
    buffer_atomic_add v2, off, s[88:91], 0 offset:136 sc1
mega_kernel_sg136_5:
    s_mov_b64 exec, s[80:81]
    s_waitcnt vmcnt(0)
    ds_read_b64_tr_b16 a[128:129], v201 offset:0
    ds_read_b64_tr_b16 a[130:131], v201 offset:256
    ds_read_b64_tr_b16 a[132:133], v201 offset:1024
    ds_read_b64_tr_b16 a[134:135], v201 offset:1280
    ds_read_b64_tr_b16 a[136:137], v201 offset:2048
    ds_read_b64_tr_b16 a[138:139], v201 offset:2304
    ds_read_b64_tr_b16 a[140:141], v201 offset:3072
    ds_read_b64_tr_b16 a[142:143], v201 offset:3328
    s_waitcnt lgkmcnt(0)
    ds_read_b64_tr_b16 a[144:145], v201 offset:4096
    ds_read_b64_tr_b16 a[146:147], v201 offset:4352
    ds_read_b64_tr_b16 a[148:149], v201 offset:5120
    ds_read_b64_tr_b16 a[150:151], v201 offset:5376
    ds_read_b64_tr_b16 a[152:153], v201 offset:6144
    ds_read_b64_tr_b16 a[154:155], v201 offset:6400
    ds_read_b64_tr_b16 a[156:157], v201 offset:7168
    ds_read_b64_tr_b16 a[158:159], v201 offset:7424
    s_waitcnt lgkmcnt(0)
    ds_read_b64_tr_b16 a[160:161], v201 offset:8192
    ds_read_b64_tr_b16 a[162:163], v201 offset:8448
    ds_read_b64_tr_b16 a[164:165], v201 offset:9216
    ds_read_b64_tr_b16 a[166:167], v201 offset:9472
    ds_read_b64_tr_b16 a[168:169], v201 offset:10240
    ds_read_b64_tr_b16 a[170:171], v201 offset:10496
    ds_read_b64_tr_b16 a[172:173], v201 offset:11264
    ds_read_b64_tr_b16 a[174:175], v201 offset:11520
    s_waitcnt lgkmcnt(0)
    ds_read_b64_tr_b16 a[176:177], v201 offset:12288
    ds_read_b64_tr_b16 a[178:179], v201 offset:12544
    ds_read_b64_tr_b16 a[180:181], v201 offset:13312
    ds_read_b64_tr_b16 a[182:183], v201 offset:13568
    ds_read_b64_tr_b16 a[184:185], v201 offset:14336
    ds_read_b64_tr_b16 a[186:187], v201 offset:14592
    ds_read_b64_tr_b16 a[188:189], v201 offset:15360
    ds_read_b64_tr_b16 a[190:191], v201 offset:15616
    s_waitcnt lgkmcnt(0)
    s_add_u32 m0, s56, 0
    s_add_u32 s58, s57, 49152
    s_and_b32 s58, s58, 0xffff
    s_lshl_b32 s58, s58, 5
    buffer_load_dwordx4 v200, s[52:55], s58 offen lds
    s_add_u32 m0, s56, 1024
    s_add_u32 s58, s57, 50176
    s_and_b32 s58, s58, 0xffff
    s_lshl_b32 s58, s58, 5
    buffer_load_dwordx4 v200, s[52:55], s58 offen lds
    s_add_u32 m0, s56, 2048
    s_add_u32 s58, s57, 51200
    s_and_b32 s58, s58, 0xffff
    s_lshl_b32 s58, s58, 5
    buffer_load_dwordx4 v200, s[52:55], s58 offen lds
    s_add_u32 m0, s56, 3072
    s_add_u32 s58, s57, 52224
    s_and_b32 s58, s58, 0xffff
    s_lshl_b32 s58, s58, 5
    buffer_load_dwordx4 v200, s[52:55], s58 offen lds
    s_add_u32 m0, s56, 4096
    s_add_u32 s58, s57, 53248
    s_and_b32 s58, s58, 0xffff
    s_lshl_b32 s58, s58, 5
    buffer_load_dwordx4 v200, s[52:55], s58 offen lds
    s_add_u32 m0, s56, 5120
    s_add_u32 s58, s57, 54272
    s_and_b32 s58, s58, 0xffff
    s_lshl_b32 s58, s58, 5
    buffer_load_dwordx4 v200, s[52:55], s58 offen lds
    s_add_u32 m0, s56, 6144
    s_add_u32 s58, s57, 55296
    s_and_b32 s58, s58, 0xffff
    s_lshl_b32 s58, s58, 5
    buffer_load_dwordx4 v200, s[52:55], s58 offen lds
    s_add_u32 m0, s56, 7168
    s_add_u32 s58, s57, 56320
    s_and_b32 s58, s58, 0xffff
    s_lshl_b32 s58, s58, 5
    buffer_load_dwordx4 v200, s[52:55], s58 offen lds
    s_add_u32 m0, s56, 8192
    s_add_u32 s58, s57, 57344
    s_and_b32 s58, s58, 0xffff
    s_lshl_b32 s58, s58, 5
    buffer_load_dwordx4 v200, s[52:55], s58 offen lds
    s_add_u32 m0, s56, 9216
    s_add_u32 s58, s57, 58368
    s_and_b32 s58, s58, 0xffff
    s_lshl_b32 s58, s58, 5
    buffer_load_dwordx4 v200, s[52:55], s58 offen lds
    s_add_u32 m0, s56, 10240
    s_add_u32 s58, s57, 59392
    s_and_b32 s58, s58, 0xffff
    s_lshl_b32 s58, s58, 5
    buffer_load_dwordx4 v200, s[52:55], s58 offen lds
    s_add_u32 m0, s56, 11264
    s_add_u32 s58, s57, 60416
    s_and_b32 s58, s58, 0xffff
    s_lshl_b32 s58, s58, 5
    buffer_load_dwordx4 v200, s[52:55], s58 offen lds
    s_add_u32 m0, s56, 12288
    s_add_u32 s58, s57, 61440
    s_and_b32 s58, s58, 0xffff
    s_lshl_b32 s58, s58, 5
    buffer_load_dwordx4 v200, s[52:55], s58 offen lds
    s_add_u32 m0, s56, 13312
    s_add_u32 s58, s57, 62464
    s_and_b32 s58, s58, 0xffff
    s_lshl_b32 s58, s58, 5
    buffer_load_dwordx4 v200, s[52:55], s58 offen lds
    s_add_u32 m0, s56, 14336
    s_add_u32 s58, s57, 63488
    s_and_b32 s58, s58, 0xffff
    s_lshl_b32 s58, s58, 5
    buffer_load_dwordx4 v200, s[52:55], s58 offen lds
    s_add_u32 m0, s56, 15360
    s_add_u32 s58, s57, 64512
    s_and_b32 s58, s58, 0xffff
    s_lshl_b32 s58, s58, 5
    buffer_load_dwordx4 v200, s[52:55], s58 offen lds
mega_kernel_wf2:
    s_sleep 8
    buffer_load_dword v2, off, s[88:91], 0 offset:136 sc1
    s_waitcnt vmcnt(0)
    v_cmp_ne_u32 vcc, 129, v2
    s_cbranch_vccnz mega_kernel_wf2
    s_barrier
    s_load_dwordx2 s[4:5], s[0:1], 80
    s_load_dwordx2 s[8:9], s[0:1], 96
    v_and_b32 v6, 7, v0
    v_lshrrev_b32 v7, 3, v0
    s_movk_i32 s13, 8448
    v_mul_lo_u32 v8, v6, s13
    v_lshl_add_u32 v4, v7, 3, v8
    v_lshlrev_b32 v5, 14, v7
    v_lshl_add_u32 v5, v6, 4, v5
    s_lshl_b32 s12, s92, 7
    s_add_u32 s12, s12, 109051904
    s_waitcnt lgkmcnt(0)
    s_mov_b32 s6, 8388608
    s_mov_b32 s7, 0x00020000
    s_mov_b32 s10, 268435456
    s_mov_b32 s11, 0x00020000
    s_add_u32 s13, s12, 0
    buffer_load_dwordx4 v[16:19], v5, s[8:11], s13 offen
    s_add_u32 s13, s12, 524288
    buffer_load_dwordx4 v[20:23], v5, s[8:11], s13 offen
    s_add_u32 s13, s12, 1048576
    buffer_load_dwordx4 v[24:27], v5, s[8:11], s13 offen
    s_add_u32 s13, s12, 1572864
    buffer_load_dwordx4 v[28:31], v5, s[8:11], s13 offen
    s_add_u32 s13, s12, 2097152
    buffer_load_dwordx4 v[32:35], v5, s[8:11], s13 offen
    s_add_u32 s13, s12, 2621440
    buffer_load_dwordx4 v[36:39], v5, s[8:11], s13 offen
    s_add_u32 s13, s12, 3145728
    buffer_load_dwordx4 v[40:43], v5, s[8:11], s13 offen
    s_add_u32 s13, s12, 3670016
    buffer_load_dwordx4 v[44:47], v5, s[8:11], s13 offen
    s_add_u32 s13, s12, 4194304
    buffer_load_dwordx4 v[48:51], v5, s[8:11], s13 offen
    s_add_u32 s13, s12, 4718592
    buffer_load_dwordx4 v[52:55], v5, s[8:11], s13 offen
    s_add_u32 s13, s12, 5242880
    buffer_load_dwordx4 v[56:59], v5, s[8:11], s13 offen
    s_add_u32 s13, s12, 5767168
    buffer_load_dwordx4 v[60:63], v5, s[8:11], s13 offen
    s_add_u32 s13, s12, 6291456
    buffer_load_dwordx4 v[64:67], v5, s[8:11], s13 offen
    s_add_u32 s13, s12, 6815744
    buffer_load_dwordx4 v[68:71], v5, s[8:11], s13 offen
    s_add_u32 s13, s12, 7340032
    buffer_load_dwordx4 v[72:75], v5, s[8:11], s13 offen
    s_add_u32 s13, s12, 7864320
    buffer_load_dwordx4 v[76:79], v5, s[8:11], s13 offen
    s_add_u32 s13, s12, 8388608
    buffer_load_dwordx4 v[80:83], v5, s[8:11], s13 offen
    s_waitcnt vmcnt(0)
    v_cmp_eq_u32 vcc, 0, v7
    s_nop 1
    v_mov_b32 v9, 0
    v_cndmask_b32 v17, v17, v9, vcc
    v_cndmask_b32 v19, v19, v9, vcc
    v_cndmask_b32 v81, v81, v9, vcc
    v_cndmask_b32 v83, v83, v9, vcc
    v_sub_u32 v6, 1024, v7
    v_and_b32 v6, 1023, v6
    v_lshl_add_u32 v6, v6, 3, v8
    v_sub_f32 v10, v16, v19
    v_add_f32 v11, v17, v18
    v_add_f32 v12, v16, v19
    v_sub_f32 v13, v18, v17
    ds_write_b64 v4, v[10:11] offset:0
    ds_write_b64 v6, v[12:13]
    v_sub_u32 v6, 992, v7
    v_and_b32 v6, 1023, v6
    v_lshl_add_u32 v6, v6, 3, v8
    v_sub_f32 v10, v20, v23
    v_add_f32 v11, v21, v22
    v_add_f32 v12, v20, v23
    v_sub_f32 v13, v22, v21
    ds_write_b64 v4, v[10:11] offset:256
    ds_write_b64 v6, v[12:13]
    v_sub_u32 v6, 960, v7
    v_and_b32 v6, 1023, v6
    v_lshl_add_u32 v6, v6, 3, v8
    v_sub_f32 v10, v24, v27
    v_add_f32 v11, v25, v26
    v_add_f32 v12, v24, v27
    v_sub_f32 v13, v26, v25
    ds_write_b64 v4, v[10:11] offset:512
    ds_write_b64 v6, v[12:13]
    v_sub_u32 v6, 928, v7
    v_and_b32 v6, 1023, v6
    v_lshl_add_u32 v6, v6, 3, v8
    v_sub_f32 v10, v28, v31
    v_add_f32 v11, v29, v30
    v_add_f32 v12, v28, v31
    v_sub_f32 v13, v30, v29
    ds_write_b64 v4, v[10:11] offset:768
    ds_write_b64 v6, v[12:13]
    v_sub_u32 v6, 896, v7
    v_and_b32 v6, 1023, v6
    v_lshl_add_u32 v6, v6, 3, v8
    v_sub_f32 v10, v32, v35
    v_add_f32 v11, v33, v34
    v_add_f32 v12, v32, v35
    v_sub_f32 v13, v34, v33
    ds_write_b64 v4, v[10:11] offset:1024
    ds_write_b64 v6, v[12:13]
    v_sub_u32 v6, 864, v7
    v_and_b32 v6, 1023, v6
    v_lshl_add_u32 v6, v6, 3, v8
    v_sub_f32 v10, v36, v39
    v_add_f32 v11, v37, v38
    v_add_f32 v12, v36, v39
    v_sub_f32 v13, v38, v37
    ds_write_b64 v4, v[10:11] offset:1280
    ds_write_b64 v6, v[12:13]
    v_sub_u32 v6, 832, v7
    v_and_b32 v6, 1023, v6
    v_lshl_add_u32 v6, v6, 3, v8
    v_sub_f32 v10, v40, v43
    v_add_f32 v11, v41, v42
    v_add_f32 v12, v40, v43
    v_sub_f32 v13, v42, v41
    ds_write_b64 v4, v[10:11] offset:1536
    ds_write_b64 v6, v[12:13]
    v_sub_u32 v6, 800, v7
    v_and_b32 v6, 1023, v6
    v_lshl_add_u32 v6, v6, 3, v8
    v_sub_f32 v10, v44, v47
    v_add_f32 v11, v45, v46
    v_add_f32 v12, v44, v47
    v_sub_f32 v13, v46, v45
    ds_write_b64 v4, v[10:11] offset:1792
    ds_write_b64 v6, v[12:13]
    v_sub_u32 v6, 768, v7
    v_and_b32 v6, 1023, v6
    v_lshl_add_u32 v6, v6, 3, v8
    v_sub_f32 v10, v48, v51
    v_add_f32 v11, v49, v50
    v_add_f32 v12, v48, v51
    v_sub_f32 v13, v50, v49
    ds_write_b64 v4, v[10:11] offset:2048
    ds_write_b64 v6, v[12:13]
    v_sub_u32 v6, 736, v7
    v_and_b32 v6, 1023, v6
    v_lshl_add_u32 v6, v6, 3, v8
    v_sub_f32 v10, v52, v55
    v_add_f32 v11, v53, v54
    v_add_f32 v12, v52, v55
    v_sub_f32 v13, v54, v53
    ds_write_b64 v4, v[10:11] offset:2304
    ds_write_b64 v6, v[12:13]
    v_sub_u32 v6, 704, v7
    v_and_b32 v6, 1023, v6
    v_lshl_add_u32 v6, v6, 3, v8
    v_sub_f32 v10, v56, v59
    v_add_f32 v11, v57, v58
    v_add_f32 v12, v56, v59
    v_sub_f32 v13, v58, v57
    ds_write_b64 v4, v[10:11] offset:2560
    ds_write_b64 v6, v[12:13]
    v_sub_u32 v6, 672, v7
    v_and_b32 v6, 1023, v6
    v_lshl_add_u32 v6, v6, 3, v8
    v_sub_f32 v10, v60, v63
    v_add_f32 v11, v61, v62
    v_add_f32 v12, v60, v63
    v_sub_f32 v13, v62, v61
    ds_write_b64 v4, v[10:11] offset:2816
    ds_write_b64 v6, v[12:13]
    v_sub_u32 v6, 640, v7
    v_and_b32 v6, 1023, v6
    v_lshl_add_u32 v6, v6, 3, v8
    v_sub_f32 v10, v64, v67
    v_add_f32 v11, v65, v66
    v_add_f32 v12, v64, v67
    v_sub_f32 v13, v66, v65
    ds_write_b64 v4, v[10:11] offset:3072
    ds_write_b64 v6, v[12:13]
    v_sub_u32 v6, 608, v7
    v_and_b32 v6, 1023, v6
    v_lshl_add_u32 v6, v6, 3, v8
    v_sub_f32 v10, v68, v71
    v_add_f32 v11, v69, v70
    v_add_f32 v12, v68, v71
    v_sub_f32 v13, v70, v69
    ds_write_b64 v4, v[10:11] offset:3328
    ds_write_b64 v6, v[12:13]
    v_sub_u32 v6, 576, v7
    v_and_b32 v6, 1023, v6
    v_lshl_add_u32 v6, v6, 3, v8
    v_sub_f32 v10, v72, v75
    v_add_f32 v11, v73, v74
    v_add_f32 v12, v72, v75
    v_sub_f32 v13, v74, v73
    ds_write_b64 v4, v[10:11] offset:3584
    ds_write_b64 v6, v[12:13]
    v_sub_u32 v6, 544, v7
    v_and_b32 v6, 1023, v6
    v_lshl_add_u32 v6, v6, 3, v8
    v_sub_f32 v10, v76, v79
    v_add_f32 v11, v77, v78
    v_add_f32 v12, v76, v79
    v_sub_f32 v13, v78, v77
    ds_write_b64 v4, v[10:11] offset:3840
    ds_write_b64 v6, v[12:13]
    s_and_saveexec_b64 s[14:15], vcc
    v_sub_u32 v6, 512, v7
    v_and_b32 v6, 1023, v6
    v_lshl_add_u32 v6, v6, 3, v8
    v_sub_f32 v10, v80, v83
    v_add_f32 v11, v81, v82
    v_add_f32 v12, v80, v83
    v_sub_f32 v13, v82, v81
    ds_write_b64 v4, v[10:11] offset:4096
    ds_write_b64 v6, v[12:13]
    s_mov_b64 exec, s[14:15]
    s_waitcnt lgkmcnt(0)
    s_barrier
    v_and_b32 v1, 31, v0
    v_lshrrev_b32 v2, 5, v0
    v_cvt_f32_u32 v3, v1
    s_movk_i32 s13, 8448
    v_mul_lo_u32 v7, v2, s13
    v_lshl_add_u32 v4, v1, 3, v7
    s_movk_i32 s13, 264
    v_mul_lo_u32 v5, v1, s13
    v_add_u32 v5, v5, v7
    ds_read_b32 v16, v4 offset:0
    ds_read_b32 v48, v4 offset:4
    ds_read_b32 v17, v4 offset:256
    ds_read_b32 v49, v4 offset:260
    ds_read_b32 v18, v4 offset:512
    ds_read_b32 v50, v4 offset:516
    ds_read_b32 v19, v4 offset:768
    ds_read_b32 v51, v4 offset:772
    ds_read_b32 v20, v4 offset:1024
    ds_read_b32 v52, v4 offset:1028
    ds_read_b32 v21, v4 offset:1280
    ds_read_b32 v53, v4 offset:1284
    ds_read_b32 v22, v4 offset:1536
    ds_read_b32 v54, v4 offset:1540
    s_waitcnt lgkmcnt(0)
    ds_read_b32 v23, v4 offset:1792
    ds_read_b32 v55, v4 offset:1796
    ds_read_b32 v24, v4 offset:2048
    ds_read_b32 v56, v4 offset:2052
    ds_read_b32 v25, v4 offset:2304
    ds_read_b32 v57, v4 offset:2308
    ds_read_b32 v26, v4 offset:2560
    ds_read_b32 v58, v4 offset:2564
    ds_read_b32 v27, v4 offset:2816
    ds_read_b32 v59, v4 offset:2820
    ds_read_b32 v28, v4 offset:3072
    ds_read_b32 v60, v4 offset:3076
    ds_read_b32 v29, v4 offset:3328
    ds_read_b32 v61, v4 offset:3332
    s_waitcnt lgkmcnt(0)
    ds_read_b32 v30, v4 offset:3584
    ds_read_b32 v62, v4 offset:3588
    ds_read_b32 v31, v4 offset:3840
    ds_read_b32 v63, v4 offset:3844
    ds_read_b32 v32, v4 offset:4096
    ds_read_b32 v64, v4 offset:4100
    ds_read_b32 v33, v4 offset:4352
    ds_read_b32 v65, v4 offset:4356
    ds_read_b32 v34, v4 offset:4608
    ds_read_b32 v66, v4 offset:4612
    ds_read_b32 v35, v4 offset:4864
    ds_read_b32 v67, v4 offset:4868
    ds_read_b32 v36, v4 offset:5120
    ds_read_b32 v68, v4 offset:5124
    s_waitcnt lgkmcnt(0)
    ds_read_b32 v37, v4 offset:5376
    ds_read_b32 v69, v4 offset:5380
    ds_read_b32 v38, v4 offset:5632
    ds_read_b32 v70, v4 offset:5636
    ds_read_b32 v39, v4 offset:5888
    ds_read_b32 v71, v4 offset:5892
    ds_read_b32 v40, v4 offset:6144
    ds_read_b32 v72, v4 offset:6148
    ds_read_b32 v41, v4 offset:6400
    ds_read_b32 v73, v4 offset:6404
    ds_read_b32 v42, v4 offset:6656
    ds_read_b32 v74, v4 offset:6660
    ds_read_b32 v43, v4 offset:6912
    ds_read_b32 v75, v4 offset:6916
    s_waitcnt lgkmcnt(0)
    ds_read_b32 v44, v4 offset:7168
    ds_read_b32 v76, v4 offset:7172
    ds_read_b32 v45, v4 offset:7424
    ds_read_b32 v77, v4 offset:7428
    ds_read_b32 v46, v4 offset:7680
    ds_read_b32 v78, v4 offset:7684
    ds_read_b32 v47, v4 offset:7936
    ds_read_b32 v79, v4 offset:7940
    s_waitcnt lgkmcnt(0)
    v_sub_f32 v80, v16, v32
    v_sub_f32 v81, v48, v64
    v_add_f32 v16, v16, v32
    v_add_f32 v48, v48, v64
    v_sub_f32 v32, v17, v33
    v_sub_f32 v64, v49, v65
    v_add_f32 v17, v17, v33
    v_add_f32 v49, v49, v65
    v_mul_f32 v33, 0x3f7b14be, v32
    v_mul_f32 v65, 0x3e47c5c2, v32
    v_fmac_f32 v33, 0xbe47c5c2, v64
    v_fmac_f32 v65, 0x3f7b14be, v64
    v_sub_f32 v32, v18, v34
    v_sub_f32 v64, v50, v66
    v_add_f32 v18, v18, v34
    v_add_f32 v50, v50, v66
    v_mul_f32 v34, 0x3f6c835e, v32
    v_mul_f32 v66, 0x3ec3ef15, v32
    v_fmac_f32 v34, 0xbec3ef15, v64
    v_fmac_f32 v66, 0x3f6c835e, v64
    v_sub_f32 v32, v19, v35
    v_sub_f32 v64, v51, v67
    v_add_f32 v19, v19, v35
    v_add_f32 v51, v51, v67
    v_mul_f32 v35, 0x3f54db31, v32
    v_mul_f32 v67, 0x3f0e39da, v32
    v_fmac_f32 v35, 0xbf0e39da, v64
    v_fmac_f32 v67, 0x3f54db31, v64
    v_sub_f32 v32, v20, v36
    v_sub_f32 v64, v52, v68
    v_add_f32 v20, v20, v36
    v_add_f32 v52, v52, v68
    v_mul_f32 v36, 0x3f3504f3, v32
    v_mul_f32 v68, 0x3f3504f3, v32
    v_fmac_f32 v36, 0xbf3504f3, v64
    v_fmac_f32 v68, 0x3f3504f3, v64
    v_sub_f32 v32, v21, v37
    v_sub_f32 v64, v53, v69
    v_add_f32 v21, v21, v37
    v_add_f32 v53, v53, v69
    v_mul_f32 v37, 0x3f0e39da, v32
    v_mul_f32 v69, 0x3f54db31, v32
    v_fmac_f32 v37, 0xbf54db31, v64
    v_fmac_f32 v69, 0x3f0e39da, v64
    v_sub_f32 v32, v22, v38
    v_sub_f32 v64, v54, v70
    v_add_f32 v22, v22, v38
    v_add_f32 v54, v54, v70
    v_mul_f32 v38, 0x3ec3ef15, v32
    v_mul_f32 v70, 0x3f6c835e, v32
    v_fmac_f32 v38, 0xbf6c835e, v64
    v_fmac_f32 v70, 0x3ec3ef15, v64
    v_sub_f32 v32, v23, v39
    v_sub_f32 v64, v55, v71
    v_add_f32 v23, v23, v39
    v_add_f32 v55, v55, v71
    v_mul_f32 v39, 0x3e47c5c2, v32
    v_mul_f32 v71, 0x3f7b14be, v32
    v_fmac_f32 v39, 0xbf7b14be, v64
    v_fmac_f32 v71, 0x3e47c5c2, v64
    v_sub_f32 v32, v72, v56
    v_sub_f32 v64, v24, v40
    v_add_f32 v24, v24, v40
    v_add_f32 v56, v56, v72
    v_sub_f32 v40, v25, v41
    v_sub_f32 v72, v57, v73
    v_add_f32 v25, v25, v41
    v_add_f32 v57, v57, v73
    v_mul_f32 v41, 0xbe47c5c2, v40
    v_mul_f32 v73, 0x3f7b14be, v40
    v_fmac_f32 v41, 0xbf7b14be, v72
    v_fmac_f32 v73, 0xbe47c5c2, v72
    v_sub_f32 v40, v26, v42
    v_sub_f32 v72, v58, v74
    v_add_f32 v26, v26, v42
    v_add_f32 v58, v58, v74
    v_mul_f32 v42, 0xbec3ef15, v40
    v_mul_f32 v74, 0x3f6c835e, v40
    v_fmac_f32 v42, 0xbf6c835e, v72
    v_fmac_f32 v74, 0xbec3ef15, v72
    v_sub_f32 v40, v27, v43
    v_sub_f32 v72, v59, v75
    v_add_f32 v27, v27, v43
    v_add_f32 v59, v59, v75
    v_mul_f32 v43, 0xbf0e39da, v40
    v_mul_f32 v75, 0x3f54db31, v40
    v_fmac_f32 v43, 0xbf54db31, v72
    v_fmac_f32 v75, 0xbf0e39da, v72
    v_sub_f32 v40, v28, v44
    v_sub_f32 v72, v60, v76
    v_add_f32 v28, v28, v44
    v_add_f32 v60, v60, v76
    v_mul_f32 v44, 0xbf3504f3, v40
    v_mul_f32 v76, 0x3f3504f3, v40
    v_fmac_f32 v44, 0xbf3504f3, v72
    v_fmac_f32 v76, 0xbf3504f3, v72
    v_sub_f32 v40, v29, v45
    v_sub_f32 v72, v61, v77
    v_add_f32 v29, v29, v45
    v_add_f32 v61, v61, v77
    v_mul_f32 v45, 0xbf54db31, v40
    v_mul_f32 v77, 0x3f0e39da, v40
    v_fmac_f32 v45, 0xbf0e39da, v72
    v_fmac_f32 v77, 0xbf54db31, v72
    v_sub_f32 v40, v30, v46
    v_sub_f32 v72, v62, v78
    v_add_f32 v30, v30, v46
    v_add_f32 v62, v62, v78
    v_mul_f32 v46, 0xbf6c835e, v40
    v_mul_f32 v78, 0x3ec3ef15, v40
    v_fmac_f32 v46, 0xbec3ef15, v72
    v_fmac_f32 v78, 0xbf6c835e, v72
    v_sub_f32 v40, v31, v47
    v_sub_f32 v72, v63, v79
    v_add_f32 v31, v31, v47
    v_add_f32 v63, v63, v79
    v_mul_f32 v47, 0xbf7b14be, v40
    v_mul_f32 v79, 0x3e47c5c2, v40
    v_fmac_f32 v47, 0xbe47c5c2, v72
    v_fmac_f32 v79, 0xbf7b14be, v72
    v_sub_f32 v40, v16, v24
    v_sub_f32 v72, v48, v56
    v_add_f32 v16, v16, v24
    v_add_f32 v48, v48, v56
    v_sub_f32 v24, v17, v25
    v_sub_f32 v56, v49, v57
    v_add_f32 v17, v17, v25
    v_add_f32 v49, v49, v57
    v_mul_f32 v25, 0x3f6c835e, v24
    v_mul_f32 v57, 0x3ec3ef15, v24
    v_fmac_f32 v25, 0xbec3ef15, v56
    v_fmac_f32 v57, 0x3f6c835e, v56
    v_sub_f32 v24, v18, v26
    v_sub_f32 v56, v50, v58
    v_add_f32 v18, v18, v26
    v_add_f32 v50, v50, v58
    v_mul_f32 v26, 0x3f3504f3, v24
    v_mul_f32 v58, 0x3f3504f3, v24
    v_fmac_f32 v26, 0xbf3504f3, v56
    v_fmac_f32 v58, 0x3f3504f3, v56
    v_sub_f32 v24, v19, v27
    v_sub_f32 v56, v51, v59
    v_add_f32 v19, v19, v27
    v_add_f32 v51, v51, v59
    v_mul_f32 v27, 0x3ec3ef15, v24
    v_mul_f32 v59, 0x3f6c835e, v24
    v_fmac_f32 v27, 0xbf6c835e, v56
    v_fmac_f32 v59, 0x3ec3ef15, v56
    v_sub_f32 v24, v60, v52
    v_sub_f32 v56, v20, v28
    v_add_f32 v20, v20, v28
    v_add_f32 v52, v52, v60
    v_sub_f32 v28, v21, v29
    v_sub_f32 v60, v53, v61
    v_add_f32 v21, v21, v29
    v_add_f32 v53, v53, v61
    v_mul_f32 v29, 0xbec3ef15, v28
    v_mul_f32 v61, 0x3f6c835e, v28
    v_fmac_f32 v29, 0xbf6c835e, v60
    v_fmac_f32 v61, 0xbec3ef15, v60
    v_sub_f32 v28, v22, v30
    v_sub_f32 v60, v54, v62
    v_add_f32 v22, v22, v30
    v_add_f32 v54, v54, v62
    v_mul_f32 v30, 0xbf3504f3, v28
    v_mul_f32 v62, 0x3f3504f3, v28
    v_fmac_f32 v30, 0xbf3504f3, v60
    v_fmac_f32 v62, 0xbf3504f3, v60
    v_sub_f32 v28, v23, v31
    v_sub_f32 v60, v55, v63
    v_add_f32 v23, v23, v31
    v_add_f32 v55, v55, v63
    v_mul_f32 v31, 0xbf6c835e, v28
    v_mul_f32 v63, 0x3ec3ef15, v28
    v_fmac_f32 v31, 0xbec3ef15, v60
    v_fmac_f32 v63, 0xbf6c835e, v60
    v_sub_f32 v28, v80, v32
    v_sub_f32 v60, v81, v64
    v_add_f32 v80, v80, v32
    v_add_f32 v81, v81, v64
    v_sub_f32 v32, v33, v41
    v_sub_f32 v64, v65, v73
    v_add_f32 v33, v33, v41
    v_add_f32 v65, v65, v73
    v_mul_f32 v41, 0x3f6c835e, v32
    v_mul_f32 v73, 0x3ec3ef15, v32
    v_fmac_f32 v41, 0xbec3ef15, v64
    v_fmac_f32 v73, 0x3f6c835e, v64
    v_sub_f32 v32, v34, v42
    v_sub_f32 v64, v66, v74
    v_add_f32 v34, v34, v42
    v_add_f32 v66, v66, v74
    v_mul_f32 v42, 0x3f3504f3, v32
    v_mul_f32 v74, 0x3f3504f3, v32
    v_fmac_f32 v42, 0xbf3504f3, v64
    v_fmac_f32 v74, 0x3f3504f3, v64
    v_sub_f32 v32, v35, v43
    v_sub_f32 v64, v67, v75
    v_add_f32 v35, v35, v43
    v_add_f32 v67, v67, v75
    v_mul_f32 v43, 0x3ec3ef15, v32
    v_mul_f32 v75, 0x3f6c835e, v32
    v_fmac_f32 v43, 0xbf6c835e, v64
    v_fmac_f32 v75, 0x3ec3ef15, v64
    v_sub_f32 v32, v76, v68
    v_sub_f32 v64, v36, v44
    v_add_f32 v36, v36, v44
    v_add_f32 v68, v68, v76
    v_sub_f32 v44, v37, v45
    v_sub_f32 v76, v69, v77
    v_add_f32 v37, v37, v45
    v_add_f32 v69, v69, v77
    v_mul_f32 v45, 0xbec3ef15, v44
    v_mul_f32 v77, 0x3f6c835e, v44
    v_fmac_f32 v45, 0xbf6c835e, v76
    v_fmac_f32 v77, 0xbec3ef15, v76
    v_sub_f32 v44, v38, v46
    v_sub_f32 v76, v70, v78
    v_add_f32 v38, v38, v46
    v_add_f32 v70, v70, v78
    v_mul_f32 v46, 0xbf3504f3, v44
    v_mul_f32 v78, 0x3f3504f3, v44
    v_fmac_f32 v46, 0xbf3504f3, v76
    v_fmac_f32 v78, 0xbf3504f3, v76
    v_sub_f32 v44, v39, v47
    v_sub_f32 v76, v71, v79
    v_add_f32 v39, v39, v47
    v_add_f32 v71, v71, v79
    v_mul_f32 v47, 0xbf6c835e, v44
    v_mul_f32 v79, 0x3ec3ef15, v44
    v_fmac_f32 v47, 0xbec3ef15, v76
    v_fmac_f32 v79, 0xbf6c835e, v76
    v_sub_f32 v44, v16, v20
    v_sub_f32 v76, v48, v52
    v_add_f32 v16, v16, v20
    v_add_f32 v48, v48, v52
    v_sub_f32 v20, v17, v21
    v_sub_f32 v52, v49, v53
    v_add_f32 v17, v17, v21
    v_add_f32 v49, v49, v53
    v_mul_f32 v21, 0x3f3504f3, v20
    v_mul_f32 v53, 0x3f3504f3, v20
    v_fmac_f32 v21, 0xbf3504f3, v52
    v_fmac_f32 v53, 0x3f3504f3, v52
    v_sub_f32 v20, v54, v50
    v_sub_f32 v52, v18, v22
    v_add_f32 v18, v18, v22
    v_add_f32 v50, v50, v54
    v_sub_f32 v22, v19, v23
    v_sub_f32 v54, v51, v55
    v_add_f32 v19, v19, v23
    v_add_f32 v51, v51, v55
    v_mul_f32 v23, 0xbf3504f3, v22
    v_mul_f32 v55, 0x3f3504f3, v22
    v_fmac_f32 v23, 0xbf3504f3, v54
    v_fmac_f32 v55, 0xbf3504f3, v54
    v_sub_f32 v22, v40, v24
    v_sub_f32 v54, v72, v56
    v_add_f32 v40, v40, v24
    v_add_f32 v72, v72, v56
    v_sub_f32 v24, v25, v29
    v_sub_f32 v56, v57, v61
    v_add_f32 v25, v25, v29
    v_add_f32 v57, v57, v61
    v_mul_f32 v29, 0x3f3504f3, v24
    v_mul_f32 v61, 0x3f3504f3, v24
    v_fmac_f32 v29, 0xbf3504f3, v56
    v_fmac_f32 v61, 0x3f3504f3, v56
    v_sub_f32 v24, v62, v58
    v_sub_f32 v56, v26, v30
    v_add_f32 v26, v26, v30
    v_add_f32 v58, v58, v62
    v_sub_f32 v30, v27, v31
    v_sub_f32 v62, v59, v63
    v_add_f32 v27, v27, v31
    v_add_f32 v59, v59, v63
    v_mul_f32 v31, 0xbf3504f3, v30
    v_mul_f32 v63, 0x3f3504f3, v30
    v_fmac_f32 v31, 0xbf3504f3, v62
    v_fmac_f32 v63, 0xbf3504f3, v62
    v_sub_f32 v30, v80, v36
    v_sub_f32 v62, v81, v68
    v_add_f32 v80, v80, v36
    v_add_f32 v81, v81, v68
    v_sub_f32 v36, v33, v37
    v_sub_f32 v68, v65, v69
    v_add_f32 v33, v33, v37
    v_add_f32 v65, v65, v69
    v_mul_f32 v37, 0x3f3504f3, v36
    v_mul_f32 v69, 0x3f3504f3, v36
    v_fmac_f32 v37, 0xbf3504f3, v68
    v_fmac_f32 v69, 0x3f3504f3, v68
    v_sub_f32 v36, v70, v66
    v_sub_f32 v68, v34, v38
    v_add_f32 v34, v34, v38
    v_add_f32 v66, v66, v70
    v_sub_f32 v38, v35, v39
    v_sub_f32 v70, v67, v71
    v_add_f32 v35, v35, v39
    v_add_f32 v67, v67, v71
    v_mul_f32 v39, 0xbf3504f3, v38
    v_mul_f32 v71, 0x3f3504f3, v38
    v_fmac_f32 v39, 0xbf3504f3, v70
    v_fmac_f32 v71, 0xbf3504f3, v70
    v_sub_f32 v38, v28, v32
    v_sub_f32 v70, v60, v64
    v_add_f32 v28, v28, v32
    v_add_f32 v60, v60, v64
    v_sub_f32 v32, v41, v45
    v_sub_f32 v64, v73, v77
    v_add_f32 v41, v41, v45
    v_add_f32 v73, v73, v77
    v_mul_f32 v45, 0x3f3504f3, v32
    v_mul_f32 v77, 0x3f3504f3, v32
    v_fmac_f32 v45, 0xbf3504f3, v64
    v_fmac_f32 v77, 0x3f3504f3, v64
    v_sub_f32 v32, v78, v74
    v_sub_f32 v64, v42, v46
    v_add_f32 v42, v42, v46
    v_add_f32 v74, v74, v78
    v_sub_f32 v46, v43, v47
    v_sub_f32 v78, v75, v79
    v_add_f32 v43, v43, v47
    v_add_f32 v75, v75, v79
    v_mul_f32 v47, 0xbf3504f3, v46
    v_mul_f32 v79, 0x3f3504f3, v46
    v_fmac_f32 v47, 0xbf3504f3, v78
    v_fmac_f32 v79, 0xbf3504f3, v78
    v_sub_f32 v46, v16, v18
    v_sub_f32 v78, v48, v50
    v_add_f32 v16, v16, v18
    v_add_f32 v48, v48, v50
    v_sub_f32 v18, v51, v49
    v_sub_f32 v50, v17, v19
    v_add_f32 v17, v17, v19
    v_add_f32 v49, v49, v51
    v_sub_f32 v19, v44, v20
    v_sub_f32 v51, v76, v52
    v_add_f32 v44, v44, v20
    v_add_f32 v76, v76, v52
    v_sub_f32 v20, v55, v53
    v_sub_f32 v52, v21, v23
    v_add_f32 v21, v21, v23
    v_add_f32 v53, v53, v55
    v_sub_f32 v23, v40, v26
    v_sub_f32 v55, v72, v58
    v_add_f32 v40, v40, v26
    v_add_f32 v72, v72, v58
    v_sub_f32 v26, v59, v57
    v_sub_f32 v58, v25, v27
    v_add_f32 v25, v25, v27
    v_add_f32 v57, v57, v59
    v_sub_f32 v27, v22, v24
    v_sub_f32 v59, v54, v56
    v_add_f32 v22, v22, v24
    v_add_f32 v54, v54, v56
    v_sub_f32 v24, v63, v61
    v_sub_f32 v56, v29, v31
    v_add_f32 v29, v29, v31
    v_add_f32 v61, v61, v63
    v_sub_f32 v31, v80, v34
    v_sub_f32 v63, v81, v66
    v_add_f32 v80, v80, v34
    v_add_f32 v81, v81, v66
    v_sub_f32 v34, v67, v65
    v_sub_f32 v66, v33, v35
    v_add_f32 v33, v33, v35
    v_add_f32 v65, v65, v67
    v_sub_f32 v35, v30, v36
    v_sub_f32 v67, v62, v68
    v_add_f32 v30, v30, v36
    v_add_f32 v62, v62, v68
    v_sub_f32 v36, v71, v69
    v_sub_f32 v68, v37, v39
    v_add_f32 v37, v37, v39
    v_add_f32 v69, v69, v71
    v_sub_f32 v39, v28, v42
    v_sub_f32 v71, v60, v74
    v_add_f32 v28, v28, v42
    v_add_f32 v60, v60, v74
    v_sub_f32 v42, v75, v73
    v_sub_f32 v74, v41, v43
    v_add_f32 v41, v41, v43
    v_add_f32 v73, v73, v75
    v_sub_f32 v43, v38, v32
    v_sub_f32 v75, v70, v64
    v_add_f32 v38, v38, v32
    v_add_f32 v70, v70, v64
    v_sub_f32 v32, v79, v77
    v_sub_f32 v64, v45, v47
    v_add_f32 v45, v45, v47
    v_add_f32 v77, v77, v79
    v_sub_f32 v47, v16, v17
    v_sub_f32 v79, v48, v49
    v_add_f32 v16, v16, v17
    v_add_f32 v48, v48, v49
    v_sub_f32 v17, v46, v18
    v_sub_f32 v49, v78, v50
    v_add_f32 v46, v46, v18
    v_add_f32 v78, v78, v50
    v_sub_f32 v18, v44, v21
    v_sub_f32 v50, v76, v53
    v_add_f32 v44, v44, v21
    v_add_f32 v76, v76, v53
    v_sub_f32 v21, v19, v20
    v_sub_f32 v53, v51, v52
    v_add_f32 v19, v19, v20
    v_add_f32 v51, v51, v52
    v_sub_f32 v20, v40, v25
    v_sub_f32 v52, v72, v57
    v_add_f32 v40, v40, v25
    v_add_f32 v72, v72, v57
    v_sub_f32 v25, v23, v26
    v_sub_f32 v57, v55, v58
    v_add_f32 v23, v23, v26
    v_add_f32 v55, v55, v58
    v_sub_f32 v26, v22, v29
    v_sub_f32 v58, v54, v61
    v_add_f32 v22, v22, v29
    v_add_f32 v54, v54, v61
    v_sub_f32 v29, v27, v24
    v_sub_f32 v61, v59, v56
    v_add_f32 v27, v27, v24
    v_add_f32 v59, v59, v56
    v_sub_f32 v24, v80, v33
    v_sub_f32 v56, v81, v65
    v_add_f32 v80, v80, v33
    v_add_f32 v81, v81, v65
    v_sub_f32 v33, v31, v34
    v_sub_f32 v65, v63, v66
    v_add_f32 v31, v31, v34
    v_add_f32 v63, v63, v66
    v_sub_f32 v34, v30, v37
    v_sub_f32 v66, v62, v69
    v_add_f32 v30, v30, v37
    v_add_f32 v62, v62, v69
    v_sub_f32 v37, v35, v36
    v_sub_f32 v69, v67, v68
    v_add_f32 v35, v35, v36
    v_add_f32 v67, v67, v68
    v_sub_f32 v36, v28, v41
    v_sub_f32 v68, v60, v73
    v_add_f32 v28, v28, v41
    v_add_f32 v60, v60, v73
    v_sub_f32 v41, v39, v42
    v_sub_f32 v73, v71, v74
    v_add_f32 v39, v39, v42
    v_add_f32 v71, v71, v74
    v_sub_f32 v42, v38, v45
    v_sub_f32 v74, v70, v77
    v_add_f32 v38, v38, v45
    v_add_f32 v70, v70, v77
    v_sub_f32 v45, v43, v32
    v_sub_f32 v77, v75, v64
    v_add_f32 v43, v43, v32
    v_add_f32 v75, v75, v64
    v_mul_f32 v32, 0x3a800000, v3
    v_cos_f32 v64, v32
    v_sin_f32 v82, v32
    s_nop 0
    v_mul_f32 v83, v80, v64
    v_fma_f32 v83, -v81, v82, v83
    v_mul_f32 v81, v81, v64
    v_fmac_f32 v81, v80, v82
    v_mul_f32 v32, 0x3b000000, v3
    v_cos_f32 v64, v32
    v_sin_f32 v82, v32
    s_nop 0
    v_mul_f32 v80, v40, v64
    v_fma_f32 v80, -v72, v82, v80
    v_mul_f32 v72, v72, v64
    v_fmac_f32 v72, v40, v82
    v_mul_f32 v32, 0x3b400000, v3
    v_cos_f32 v64, v32
    v_sin_f32 v82, v32
    s_nop 0
    v_mul_f32 v40, v28, v64
    v_fma_f32 v40, -v60, v82, v40
    v_mul_f32 v60, v60, v64
    v_fmac_f32 v60, v28, v82
    v_mul_f32 v32, 0x3b800000, v3
    v_cos_f32 v64, v32
    v_sin_f32 v82, v32
    s_nop 0
    v_mul_f32 v28, v44, v64
    v_fma_f32 v28, -v76, v82, v28
    v_mul_f32 v76, v76, v64
    v_fmac_f32 v76, v44, v82
    v_mul_f32 v32, 0x3ba00000, v3
    v_cos_f32 v64, v32
    v_sin_f32 v82, v32
    s_nop 0
    v_mul_f32 v44, v30, v64
    v_fma_f32 v44, -v62, v82, v44
    v_mul_f32 v62, v62, v64
    v_fmac_f32 v62, v30, v82
    v_mul_f32 v32, 0x3bc00000, v3
    v_cos_f32 v64, v32
    v_sin_f32 v82, v32
    s_nop 0
    v_mul_f32 v30, v22, v64
    v_fma_f32 v30, -v54, v82, v30
    v_mul_f32 v54, v54, v64
    v_fmac_f32 v54, v22, v82
    v_mul_f32 v32, 0x3be00000, v3
    v_cos_f32 v64, v32
    v_sin_f32 v82, v32
    s_nop 0
    v_mul_f32 v22, v38, v64
    v_fma_f32 v22, -v70, v82, v22
    v_mul_f32 v70, v70, v64
    v_fmac_f32 v70, v38, v82
    v_mul_f32 v32, 0x3c000000, v3
    v_cos_f32 v64, v32
    v_sin_f32 v82, v32
    s_nop 0
    v_mul_f32 v38, v46, v64
    v_fma_f32 v38, -v78, v82, v38
    v_mul_f32 v78, v78, v64
    v_fmac_f32 v78, v46, v82
    v_mul_f32 v32, 0x3c100000, v3
    v_cos_f32 v64, v32
    v_sin_f32 v82, v32
    s_nop 0
    v_mul_f32 v46, v31, v64
    v_fma_f32 v46, -v63, v82, v46
    v_mul_f32 v63, v63, v64
    v_fmac_f32 v63, v31, v82
    v_mul_f32 v32, 0x3c200000, v3
    v_cos_f32 v64, v32
    v_sin_f32 v82, v32
    s_nop 0
    v_mul_f32 v31, v23, v64
    v_fma_f32 v31, -v55, v82, v31
    v_mul_f32 v55, v55, v64
    v_fmac_f32 v55, v23, v82
    v_mul_f32 v32, 0x3c300000, v3
    v_cos_f32 v64, v32
    v_sin_f32 v82, v32
    s_nop 0
    v_mul_f32 v23, v39, v64
    v_fma_f32 v23, -v71, v82, v23
    v_mul_f32 v71, v71, v64
    v_fmac_f32 v71, v39, v82
    v_mul_f32 v32, 0x3c400000, v3
    v_cos_f32 v64, v32
    v_sin_f32 v82, v32
    s_nop 0
    v_mul_f32 v39, v19, v64
    v_fma_f32 v39, -v51, v82, v39
    v_mul_f32 v51, v51, v64
    v_fmac_f32 v51, v19, v82
    v_mul_f32 v32, 0x3c500000, v3
    v_cos_f32 v64, v32
    v_sin_f32 v82, v32
    s_nop 0
    v_mul_f32 v19, v35, v64
    v_fma_f32 v19, -v67, v82, v19
    v_mul_f32 v67, v67, v64
    v_fmac_f32 v67, v35, v82
    v_mul_f32 v32, 0x3c600000, v3
    v_cos_f32 v64, v32
    v_sin_f32 v82, v32
    s_nop 0
    v_mul_f32 v35, v27, v64
    v_fma_f32 v35, -v59, v82, v35
    v_mul_f32 v59, v59, v64
    v_fmac_f32 v59, v27, v82
    v_mul_f32 v32, 0x3c700000, v3
    v_cos_f32 v64, v32
    v_sin_f32 v82, v32
    s_nop 0
    v_mul_f32 v27, v43, v64
    v_fma_f32 v27, -v75, v82, v27
    v_mul_f32 v75, v75, v64
    v_fmac_f32 v75, v43, v82
    v_mul_f32 v32, 0x3c800000, v3
    v_cos_f32 v64, v32
    v_sin_f32 v82, v32
    s_nop 0
    v_mul_f32 v43, v47, v64
    v_fma_f32 v43, -v79, v82, v43
    v_mul_f32 v79, v79, v64
    v_fmac_f32 v79, v47, v82
    v_mul_f32 v32, 0x3c880000, v3
    v_cos_f32 v64, v32
    v_sin_f32 v82, v32
    s_nop 0
    v_mul_f32 v47, v24, v64
    v_fma_f32 v47, -v56, v82, v47
    v_mul_f32 v56, v56, v64
    v_fmac_f32 v56, v24, v82
    v_mul_f32 v32, 0x3c900000, v3
    v_cos_f32 v64, v32
    v_sin_f32 v82, v32
    s_nop 0
    v_mul_f32 v24, v20, v64
    v_fma_f32 v24, -v52, v82, v24
    v_mul_f32 v52, v52, v64
    v_fmac_f32 v52, v20, v82
    v_mul_f32 v32, 0x3c980000, v3
    v_cos_f32 v64, v32
    v_sin_f32 v82, v32
    s_nop 0
    v_mul_f32 v20, v36, v64
    v_fma_f32 v20, -v68, v82, v20
    v_mul_f32 v68, v68, v64
    v_fmac_f32 v68, v36, v82
    v_mul_f32 v32, 0x3ca00000, v3
    v_cos_f32 v64, v32
    v_sin_f32 v82, v32
    s_nop 0
    v_mul_f32 v36, v18, v64
    v_fma_f32 v36, -v50, v82, v36
    v_mul_f32 v50, v50, v64
    v_fmac_f32 v50, v18, v82
    v_mul_f32 v32, 0x3ca80000, v3
    v_cos_f32 v64, v32
    v_sin_f32 v82, v32
    s_nop 0
    v_mul_f32 v18, v34, v64
    v_fma_f32 v18, -v66, v82, v18
    v_mul_f32 v66, v66, v64
    v_fmac_f32 v66, v34, v82
    v_mul_f32 v32, 0x3cb00000, v3
    v_cos_f32 v64, v32
    v_sin_f32 v82, v32
    s_nop 0
    v_mul_f32 v34, v26, v64
    v_fma_f32 v34, -v58, v82, v34
    v_mul_f32 v58, v58, v64
    v_fmac_f32 v58, v26, v82
    v_mul_f32 v32, 0x3cb80000, v3
    v_cos_f32 v64, v32
    v_sin_f32 v82, v32
    s_nop 0
    v_mul_f32 v26, v42, v64
    v_fma_f32 v26, -v74, v82, v26
    v_mul_f32 v74, v74, v64
    v_fmac_f32 v74, v42, v82
    v_mul_f32 v32, 0x3cc00000, v3
    v_cos_f32 v64, v32
    v_sin_f32 v82, v32
    s_nop 0
    v_mul_f32 v42, v17, v64
    v_fma_f32 v42, -v49, v82, v42
    v_mul_f32 v49, v49, v64
    v_fmac_f32 v49, v17, v82
    v_mul_f32 v32, 0x3cc80000, v3
    v_cos_f32 v64, v32
    v_sin_f32 v82, v32
    s_nop 0
    v_mul_f32 v17, v33, v64
    v_fma_f32 v17, -v65, v82, v17
    v_mul_f32 v65, v65, v64
    v_fmac_f32 v65, v33, v82
    v_mul_f32 v32, 0x3cd00000, v3
    v_cos_f32 v64, v32
    v_sin_f32 v82, v32
    s_nop 0
    v_mul_f32 v33, v25, v64
    v_fma_f32 v33, -v57, v82, v33
    v_mul_f32 v57, v57, v64
    v_fmac_f32 v57, v25, v82
    v_mul_f32 v32, 0x3cd80000, v3
    v_cos_f32 v64, v32
    v_sin_f32 v82, v32
    s_nop 0
    v_mul_f32 v25, v41, v64
    v_fma_f32 v25, -v73, v82, v25
    v_mul_f32 v73, v73, v64
    v_fmac_f32 v73, v41, v82
    v_mul_f32 v32, 0x3ce00000, v3
    v_cos_f32 v64, v32
    v_sin_f32 v82, v32
    s_nop 0
    v_mul_f32 v41, v21, v64
    v_fma_f32 v41, -v53, v82, v41
    v_mul_f32 v53, v53, v64
    v_fmac_f32 v53, v21, v82
    v_mul_f32 v32, 0x3ce80000, v3
    v_cos_f32 v64, v32
    v_sin_f32 v82, v32
    s_nop 0
    v_mul_f32 v21, v37, v64
    v_fma_f32 v21, -v69, v82, v21
    v_mul_f32 v69, v69, v64
    v_fmac_f32 v69, v37, v82
    v_mul_f32 v32, 0x3cf00000, v3
    v_cos_f32 v64, v32
    v_sin_f32 v82, v32
    s_nop 0
    v_mul_f32 v37, v29, v64
    v_fma_f32 v37, -v61, v82, v37
    v_mul_f32 v61, v61, v64
    v_fmac_f32 v61, v29, v82
    v_mul_f32 v32, 0x3cf80000, v3
    v_cos_f32 v64, v32
    v_sin_f32 v82, v32
    s_nop 0
    v_mul_f32 v29, v45, v64
    v_fma_f32 v29, -v77, v82, v29
    v_mul_f32 v77, v77, v64
    v_fmac_f32 v77, v45, v82
    ds_write_b32 v4, v16 offset:0
    ds_write_b32 v4, v48 offset:4
    ds_write_b32 v4, v83 offset:264
    ds_write_b32 v4, v81 offset:268
    ds_write_b32 v4, v80 offset:528
    ds_write_b32 v4, v72 offset:532
    ds_write_b32 v4, v40 offset:792
    ds_write_b32 v4, v60 offset:796
    ds_write_b32 v4, v28 offset:1056
    ds_write_b32 v4, v76 offset:1060
    ds_write_b32 v4, v44 offset:1320
    ds_write_b32 v4, v62 offset:1324
    ds_write_b32 v4, v30 offset:1584
    ds_write_b32 v4, v54 offset:1588
    ds_write_b32 v4, v22 offset:1848
    ds_write_b32 v4, v70 offset:1852
    ds_write_b32 v4, v38 offset:2112
    ds_write_b32 v4, v78 offset:2116
    ds_write_b32 v4, v46 offset:2376
    ds_write_b32 v4, v63 offset:2380
    ds_write_b32 v4, v31 offset:2640
    ds_write_b32 v4, v55 offset:2644
    ds_write_b32 v4, v23 offset:2904
    ds_write_b32 v4, v71 offset:2908
    ds_write_b32 v4, v39 offset:3168
    ds_write_b32 v4, v51 offset:3172
    ds_write_b32 v4, v19 offset:3432
    ds_write_b32 v4, v67 offset:3436
    ds_write_b32 v4, v35 offset:3696
    ds_write_b32 v4, v59 offset:3700
    ds_write_b32 v4, v27 offset:3960
    ds_write_b32 v4, v75 offset:3964
    ds_write_b32 v4, v43 offset:4224
    ds_write_b32 v4, v79 offset:4228
    ds_write_b32 v4, v47 offset:4488
    ds_write_b32 v4, v56 offset:4492
    ds_write_b32 v4, v24 offset:4752
    ds_write_b32 v4, v52 offset:4756
    ds_write_b32 v4, v20 offset:5016
    ds_write_b32 v4, v68 offset:5020
    ds_write_b32 v4, v36 offset:5280
    ds_write_b32 v4, v50 offset:5284
    ds_write_b32 v4, v18 offset:5544
    ds_write_b32 v4, v66 offset:5548
    ds_write_b32 v4, v34 offset:5808
    ds_write_b32 v4, v58 offset:5812
    ds_write_b32 v4, v26 offset:6072
    ds_write_b32 v4, v74 offset:6076
    ds_write_b32 v4, v42 offset:6336
    ds_write_b32 v4, v49 offset:6340
    ds_write_b32 v4, v17 offset:6600
    ds_write_b32 v4, v65 offset:6604
    ds_write_b32 v4, v33 offset:6864
    ds_write_b32 v4, v57 offset:6868
    ds_write_b32 v4, v25 offset:7128
    ds_write_b32 v4, v73 offset:7132
    ds_write_b32 v4, v41 offset:7392
    ds_write_b32 v4, v53 offset:7396
    ds_write_b32 v4, v21 offset:7656
    ds_write_b32 v4, v69 offset:7660
    ds_write_b32 v4, v37 offset:7920
    ds_write_b32 v4, v61 offset:7924
    ds_write_b32 v4, v29 offset:8184
    ds_write_b32 v4, v77 offset:8188
    s_waitcnt lgkmcnt(0)
    ds_read_b32 v16, v5 offset:0
    ds_read_b32 v48, v5 offset:4
    ds_read_b32 v83, v5 offset:8
    ds_read_b32 v81, v5 offset:12
    ds_read_b32 v80, v5 offset:16
    ds_read_b32 v72, v5 offset:20
    ds_read_b32 v40, v5 offset:24
    ds_read_b32 v60, v5 offset:28
    ds_read_b32 v28, v5 offset:32
    ds_read_b32 v76, v5 offset:36
    ds_read_b32 v44, v5 offset:40
    ds_read_b32 v62, v5 offset:44
    ds_read_b32 v30, v5 offset:48
    ds_read_b32 v54, v5 offset:52
    s_waitcnt lgkmcnt(0)
    ds_read_b32 v22, v5 offset:56
    ds_read_b32 v70, v5 offset:60
    ds_read_b32 v38, v5 offset:64
    ds_read_b32 v78, v5 offset:68
    ds_read_b32 v46, v5 offset:72
    ds_read_b32 v63, v5 offset:76
    ds_read_b32 v31, v5 offset:80
    ds_read_b32 v55, v5 offset:84
    ds_read_b32 v23, v5 offset:88
    ds_read_b32 v71, v5 offset:92
    ds_read_b32 v39, v5 offset:96
    ds_read_b32 v51, v5 offset:100
    ds_read_b32 v19, v5 offset:104
    ds_read_b32 v67, v5 offset:108
    s_waitcnt lgkmcnt(0)
    ds_read_b32 v35, v5 offset:112
    ds_read_b32 v59, v5 offset:116
    ds_read_b32 v27, v5 offset:120
    ds_read_b32 v75, v5 offset:124
    ds_read_b32 v43, v5 offset:128
    ds_read_b32 v79, v5 offset:132
    ds_read_b32 v47, v5 offset:136
    ds_read_b32 v56, v5 offset:140
    ds_read_b32 v24, v5 offset:144
    ds_read_b32 v52, v5 offset:148
    ds_read_b32 v20, v5 offset:152
    ds_read_b32 v68, v5 offset:156
    ds_read_b32 v36, v5 offset:160
    ds_read_b32 v50, v5 offset:164
    s_waitcnt lgkmcnt(0)
    ds_read_b32 v18, v5 offset:168
    ds_read_b32 v66, v5 offset:172
    ds_read_b32 v34, v5 offset:176
    ds_read_b32 v58, v5 offset:180
    ds_read_b32 v26, v5 offset:184
    ds_read_b32 v74, v5 offset:188
    ds_read_b32 v42, v5 offset:192
    ds_read_b32 v49, v5 offset:196
    ds_read_b32 v17, v5 offset:200
    ds_read_b32 v65, v5 offset:204
    ds_read_b32 v33, v5 offset:208
    ds_read_b32 v57, v5 offset:212
    ds_read_b32 v25, v5 offset:216
    ds_read_b32 v73, v5 offset:220
    s_waitcnt lgkmcnt(0)
    ds_read_b32 v41, v5 offset:224
    ds_read_b32 v53, v5 offset:228
    ds_read_b32 v21, v5 offset:232
    ds_read_b32 v69, v5 offset:236
    ds_read_b32 v37, v5 offset:240
    ds_read_b32 v61, v5 offset:244
    ds_read_b32 v29, v5 offset:248
    ds_read_b32 v77, v5 offset:252
    s_waitcnt lgkmcnt(0)
    v_sub_f32 v32, v16, v43
    v_sub_f32 v64, v48, v79
    v_add_f32 v16, v16, v43
    v_add_f32 v48, v48, v79
    v_sub_f32 v43, v83, v47
    v_sub_f32 v79, v81, v56
    v_add_f32 v83, v83, v47
    v_add_f32 v81, v81, v56
    v_mul_f32 v47, 0x3f7b14be, v43
    v_mul_f32 v56, 0x3e47c5c2, v43
    v_fmac_f32 v47, 0xbe47c5c2, v79
    v_fmac_f32 v56, 0x3f7b14be, v79
    v_sub_f32 v43, v80, v24
    v_sub_f32 v79, v72, v52
    v_add_f32 v80, v80, v24
    v_add_f32 v72, v72, v52
    v_mul_f32 v24, 0x3f6c835e, v43
    v_mul_f32 v52, 0x3ec3ef15, v43
    v_fmac_f32 v24, 0xbec3ef15, v79
    v_fmac_f32 v52, 0x3f6c835e, v79
    v_sub_f32 v43, v40, v20
    v_sub_f32 v79, v60, v68
    v_add_f32 v40, v40, v20
    v_add_f32 v60, v60, v68
    v_mul_f32 v20, 0x3f54db31, v43
    v_mul_f32 v68, 0x3f0e39da, v43
    v_fmac_f32 v20, 0xbf0e39da, v79
    v_fmac_f32 v68, 0x3f54db31, v79
    v_sub_f32 v43, v28, v36
    v_sub_f32 v79, v76, v50
    v_add_f32 v28, v28, v36
    v_add_f32 v76, v76, v50
    v_mul_f32 v36, 0x3f3504f3, v43
    v_mul_f32 v50, 0x3f3504f3, v43
    v_fmac_f32 v36, 0xbf3504f3, v79
    v_fmac_f32 v50, 0x3f3504f3, v79
    v_sub_f32 v43, v44, v18
    v_sub_f32 v79, v62, v66
    v_add_f32 v44, v44, v18
    v_add_f32 v62, v62, v66
    v_mul_f32 v18, 0x3f0e39da, v43
    v_mul_f32 v66, 0x3f54db31, v43
    v_fmac_f32 v18, 0xbf54db31, v79
    v_fmac_f32 v66, 0x3f0e39da, v79
    v_sub_f32 v43, v30, v34
    v_sub_f32 v79, v54, v58
    v_add_f32 v30, v30, v34
    v_add_f32 v54, v54, v58
    v_mul_f32 v34, 0x3ec3ef15, v43
    v_mul_f32 v58, 0x3f6c835e, v43
    v_fmac_f32 v34, 0xbf6c835e, v79
    v_fmac_f32 v58, 0x3ec3ef15, v79
    v_sub_f32 v43, v22, v26
    v_sub_f32 v79, v70, v74
    v_add_f32 v22, v22, v26
    v_add_f32 v70, v70, v74
    v_mul_f32 v26, 0x3e47c5c2, v43
    v_mul_f32 v74, 0x3f7b14be, v43
    v_fmac_f32 v26, 0xbf7b14be, v79
    v_fmac_f32 v74, 0x3e47c5c2, v79
    v_sub_f32 v43, v49, v78
    v_sub_f32 v79, v38, v42
    v_add_f32 v38, v38, v42
    v_add_f32 v78, v78, v49
    v_sub_f32 v42, v46, v17
    v_sub_f32 v49, v63, v65
    v_add_f32 v46, v46, v17
    v_add_f32 v63, v63, v65
    v_mul_f32 v17, 0xbe47c5c2, v42
    v_mul_f32 v65, 0x3f7b14be, v42
    v_fmac_f32 v17, 0xbf7b14be, v49
    v_fmac_f32 v65, 0xbe47c5c2, v49
    v_sub_f32 v42, v31, v33
    v_sub_f32 v49, v55, v57
    v_add_f32 v31, v31, v33
    v_add_f32 v55, v55, v57
    v_mul_f32 v33, 0xbec3ef15, v42
    v_mul_f32 v57, 0x3f6c835e, v42
    v_fmac_f32 v33, 0xbf6c835e, v49
    v_fmac_f32 v57, 0xbec3ef15, v49
    v_sub_f32 v42, v23, v25
    v_sub_f32 v49, v71, v73
    v_add_f32 v23, v23, v25
    v_add_f32 v71, v71, v73
    v_mul_f32 v25, 0xbf0e39da, v42
    v_mul_f32 v73, 0x3f54db31, v42
    v_fmac_f32 v25, 0xbf54db31, v49
    v_fmac_f32 v73, 0xbf0e39da, v49
    v_sub_f32 v42, v39, v41
    v_sub_f32 v49, v51, v53
    v_add_f32 v39, v39, v41
    v_add_f32 v51, v51, v53
    v_mul_f32 v41, 0xbf3504f3, v42
    v_mul_f32 v53, 0x3f3504f3, v42
    v_fmac_f32 v41, 0xbf3504f3, v49
    v_fmac_f32 v53, 0xbf3504f3, v49
    v_sub_f32 v42, v19, v21
    v_sub_f32 v49, v67, v69
    v_add_f32 v19, v19, v21
    v_add_f32 v67, v67, v69
    v_mul_f32 v21, 0xbf54db31, v42
    v_mul_f32 v69, 0x3f0e39da, v42
    v_fmac_f32 v21, 0xbf0e39da, v49
    v_fmac_f32 v69, 0xbf54db31, v49
    v_sub_f32 v42, v35, v37
    v_sub_f32 v49, v59, v61
    v_add_f32 v35, v35, v37
    v_add_f32 v59, v59, v61
    v_mul_f32 v37, 0xbf6c835e, v42
    v_mul_f32 v61, 0x3ec3ef15, v42
    v_fmac_f32 v37, 0xbec3ef15, v49
    v_fmac_f32 v61, 0xbf6c835e, v49
    v_sub_f32 v42, v27, v29
    v_sub_f32 v49, v75, v77
    v_add_f32 v27, v27, v29
    v_add_f32 v75, v75, v77
    v_mul_f32 v29, 0xbf7b14be, v42
    v_mul_f32 v77, 0x3e47c5c2, v42
    v_fmac_f32 v29, 0xbe47c5c2, v49
    v_fmac_f32 v77, 0xbf7b14be, v49
    v_sub_f32 v42, v16, v38
    v_sub_f32 v49, v48, v78
    v_add_f32 v16, v16, v38
    v_add_f32 v48, v48, v78
    v_sub_f32 v38, v83, v46
    v_sub_f32 v78, v81, v63
    v_add_f32 v83, v83, v46
    v_add_f32 v81, v81, v63
    v_mul_f32 v46, 0x3f6c835e, v38
    v_mul_f32 v63, 0x3ec3ef15, v38
    v_fmac_f32 v46, 0xbec3ef15, v78
    v_fmac_f32 v63, 0x3f6c835e, v78
    v_sub_f32 v38, v80, v31
    v_sub_f32 v78, v72, v55
    v_add_f32 v80, v80, v31
    v_add_f32 v72, v72, v55
    v_mul_f32 v31, 0x3f3504f3, v38
    v_mul_f32 v55, 0x3f3504f3, v38
    v_fmac_f32 v31, 0xbf3504f3, v78
    v_fmac_f32 v55, 0x3f3504f3, v78
    v_sub_f32 v38, v40, v23
    v_sub_f32 v78, v60, v71
    v_add_f32 v40, v40, v23
    v_add_f32 v60, v60, v71
    v_mul_f32 v23, 0x3ec3ef15, v38
    v_mul_f32 v71, 0x3f6c835e, v38
    v_fmac_f32 v23, 0xbf6c835e, v78
    v_fmac_f32 v71, 0x3ec3ef15, v78
    v_sub_f32 v38, v51, v76
    v_sub_f32 v78, v28, v39
    v_add_f32 v28, v28, v39
    v_add_f32 v76, v76, v51
    v_sub_f32 v39, v44, v19
    v_sub_f32 v51, v62, v67
    v_add_f32 v44, v44, v19
    v_add_f32 v62, v62, v67
    v_mul_f32 v19, 0xbec3ef15, v39
    v_mul_f32 v67, 0x3f6c835e, v39
    v_fmac_f32 v19, 0xbf6c835e, v51
    v_fmac_f32 v67, 0xbec3ef15, v51
    v_sub_f32 v39, v30, v35
    v_sub_f32 v51, v54, v59
    v_add_f32 v30, v30, v35
    v_add_f32 v54, v54, v59
    v_mul_f32 v35, 0xbf3504f3, v39
    v_mul_f32 v59, 0x3f3504f3, v39
    v_fmac_f32 v35, 0xbf3504f3, v51
    v_fmac_f32 v59, 0xbf3504f3, v51
    v_sub_f32 v39, v22, v27
    v_sub_f32 v51, v70, v75
    v_add_f32 v22, v22, v27
    v_add_f32 v70, v70, v75
    v_mul_f32 v27, 0xbf6c835e, v39
    v_mul_f32 v75, 0x3ec3ef15, v39
    v_fmac_f32 v27, 0xbec3ef15, v51
    v_fmac_f32 v75, 0xbf6c835e, v51
    v_sub_f32 v39, v32, v43
    v_sub_f32 v51, v64, v79
    v_add_f32 v32, v32, v43
    v_add_f32 v64, v64, v79
    v_sub_f32 v43, v47, v17
    v_sub_f32 v79, v56, v65
    v_add_f32 v47, v47, v17
    v_add_f32 v56, v56, v65
    v_mul_f32 v17, 0x3f6c835e, v43
    v_mul_f32 v65, 0x3ec3ef15, v43
    v_fmac_f32 v17, 0xbec3ef15, v79
    v_fmac_f32 v65, 0x3f6c835e, v79
    v_sub_f32 v43, v24, v33
    v_sub_f32 v79, v52, v57
    v_add_f32 v24, v24, v33
    v_add_f32 v52, v52, v57
    v_mul_f32 v33, 0x3f3504f3, v43
    v_mul_f32 v57, 0x3f3504f3, v43
    v_fmac_f32 v33, 0xbf3504f3, v79
    v_fmac_f32 v57, 0x3f3504f3, v79
    v_sub_f32 v43, v20, v25
    v_sub_f32 v79, v68, v73
    v_add_f32 v20, v20, v25
    v_add_f32 v68, v68, v73
    v_mul_f32 v25, 0x3ec3ef15, v43
    v_mul_f32 v73, 0x3f6c835e, v43
    v_fmac_f32 v25, 0xbf6c835e, v79
    v_fmac_f32 v73, 0x3ec3ef15, v79
    v_sub_f32 v43, v53, v50
    v_sub_f32 v79, v36, v41
    v_add_f32 v36, v36, v41
    v_add_f32 v50, v50, v53
    v_sub_f32 v41, v18, v21
    v_sub_f32 v53, v66, v69
    v_add_f32 v18, v18, v21
    v_add_f32 v66, v66, v69
    v_mul_f32 v21, 0xbec3ef15, v41
    v_mul_f32 v69, 0x3f6c835e, v41
    v_fmac_f32 v21, 0xbf6c835e, v53
    v_fmac_f32 v69, 0xbec3ef15, v53
    v_sub_f32 v41, v34, v37
    v_sub_f32 v53, v58, v61
    v_add_f32 v34, v34, v37
    v_add_f32 v58, v58, v61
    v_mul_f32 v37, 0xbf3504f3, v41
    v_mul_f32 v61, 0x3f3504f3, v41
    v_fmac_f32 v37, 0xbf3504f3, v53
    v_fmac_f32 v61, 0xbf3504f3, v53
    v_sub_f32 v41, v26, v29
    v_sub_f32 v53, v74, v77
    v_add_f32 v26, v26, v29
    v_add_f32 v74, v74, v77
    v_mul_f32 v29, 0xbf6c835e, v41
    v_mul_f32 v77, 0x3ec3ef15, v41
    v_fmac_f32 v29, 0xbec3ef15, v53
    v_fmac_f32 v77, 0xbf6c835e, v53
    v_sub_f32 v41, v16, v28
    v_sub_f32 v53, v48, v76
    v_add_f32 v16, v16, v28
    v_add_f32 v48, v48, v76
    v_sub_f32 v28, v83, v44
    v_sub_f32 v76, v81, v62
    v_add_f32 v83, v83, v44
    v_add_f32 v81, v81, v62
    v_mul_f32 v44, 0x3f3504f3, v28
    v_mul_f32 v62, 0x3f3504f3, v28
    v_fmac_f32 v44, 0xbf3504f3, v76
    v_fmac_f32 v62, 0x3f3504f3, v76
    v_sub_f32 v28, v54, v72
    v_sub_f32 v76, v80, v30
    v_add_f32 v80, v80, v30
    v_add_f32 v72, v72, v54
    v_sub_f32 v30, v40, v22
    v_sub_f32 v54, v60, v70
    v_add_f32 v40, v40, v22
    v_add_f32 v60, v60, v70
    v_mul_f32 v22, 0xbf3504f3, v30
    v_mul_f32 v70, 0x3f3504f3, v30
    v_fmac_f32 v22, 0xbf3504f3, v54
    v_fmac_f32 v70, 0xbf3504f3, v54
    v_sub_f32 v30, v42, v38
    v_sub_f32 v54, v49, v78
    v_add_f32 v42, v42, v38
    v_add_f32 v49, v49, v78
    v_sub_f32 v38, v46, v19
    v_sub_f32 v78, v63, v67
    v_add_f32 v46, v46, v19
    v_add_f32 v63, v63, v67
    v_mul_f32 v19, 0x3f3504f3, v38
    v_mul_f32 v67, 0x3f3504f3, v38
    v_fmac_f32 v19, 0xbf3504f3, v78
    v_fmac_f32 v67, 0x3f3504f3, v78
    v_sub_f32 v38, v59, v55
    v_sub_f32 v78, v31, v35
    v_add_f32 v31, v31, v35
    v_add_f32 v55, v55, v59
    v_sub_f32 v35, v23, v27
    v_sub_f32 v59, v71, v75
    v_add_f32 v23, v23, v27
    v_add_f32 v71, v71, v75
    v_mul_f32 v27, 0xbf3504f3, v35
    v_mul_f32 v75, 0x3f3504f3, v35
    v_fmac_f32 v27, 0xbf3504f3, v59
    v_fmac_f32 v75, 0xbf3504f3, v59
    v_sub_f32 v35, v32, v36
    v_sub_f32 v59, v64, v50
    v_add_f32 v32, v32, v36
    v_add_f32 v64, v64, v50
    v_sub_f32 v36, v47, v18
    v_sub_f32 v50, v56, v66
    v_add_f32 v47, v47, v18
    v_add_f32 v56, v56, v66
    v_mul_f32 v18, 0x3f3504f3, v36
    v_mul_f32 v66, 0x3f3504f3, v36
    v_fmac_f32 v18, 0xbf3504f3, v50
    v_fmac_f32 v66, 0x3f3504f3, v50
    v_sub_f32 v36, v58, v52
    v_sub_f32 v50, v24, v34
    v_add_f32 v24, v24, v34
    v_add_f32 v52, v52, v58
    v_sub_f32 v34, v20, v26
    v_sub_f32 v58, v68, v74
    v_add_f32 v20, v20, v26
    v_add_f32 v68, v68, v74
    v_mul_f32 v26, 0xbf3504f3, v34
    v_mul_f32 v74, 0x3f3504f3, v34
    v_fmac_f32 v26, 0xbf3504f3, v58
    v_fmac_f32 v74, 0xbf3504f3, v58
    v_sub_f32 v34, v39, v43
    v_sub_f32 v58, v51, v79
    v_add_f32 v39, v39, v43
    v_add_f32 v51, v51, v79
    v_sub_f32 v43, v17, v21
    v_sub_f32 v79, v65, v69
    v_add_f32 v17, v17, v21
    v_add_f32 v65, v65, v69
    v_mul_f32 v21, 0x3f3504f3, v43
    v_mul_f32 v69, 0x3f3504f3, v43
    v_fmac_f32 v21, 0xbf3504f3, v79
    v_fmac_f32 v69, 0x3f3504f3, v79
    v_sub_f32 v43, v61, v57
    v_sub_f32 v79, v33, v37
    v_add_f32 v33, v33, v37
    v_add_f32 v57, v57, v61
    v_sub_f32 v37, v25, v29
    v_sub_f32 v61, v73, v77
    v_add_f32 v25, v25, v29
    v_add_f32 v73, v73, v77
    v_mul_f32 v29, 0xbf3504f3, v37
    v_mul_f32 v77, 0x3f3504f3, v37
    v_fmac_f32 v29, 0xbf3504f3, v61
    v_fmac_f32 v77, 0xbf3504f3, v61
    v_sub_f32 v37, v16, v80
    v_sub_f32 v61, v48, v72
    v_add_f32 v16, v16, v80
    v_add_f32 v48, v48, v72
    v_sub_f32 v80, v60, v81
    v_sub_f32 v72, v83, v40
    v_add_f32 v83, v83, v40
    v_add_f32 v81, v81, v60
    v_sub_f32 v40, v41, v28
    v_sub_f32 v60, v53, v76
    v_add_f32 v41, v41, v28
    v_add_f32 v53, v53, v76
    v_sub_f32 v28, v70, v62
    v_sub_f32 v76, v44, v22
    v_add_f32 v44, v44, v22
    v_add_f32 v62, v62, v70
    v_sub_f32 v22, v42, v31
    v_sub_f32 v70, v49, v55
    v_add_f32 v42, v42, v31
    v_add_f32 v49, v49, v55
    v_sub_f32 v31, v71, v63
    v_sub_f32 v55, v46, v23
    v_add_f32 v46, v46, v23
    v_add_f32 v63, v63, v71
    v_sub_f32 v23, v30, v38
    v_sub_f32 v71, v54, v78
    v_add_f32 v30, v30, v38
    v_add_f32 v54, v54, v78
    v_sub_f32 v38, v75, v67
    v_sub_f32 v78, v19, v27
    v_add_f32 v19, v19, v27
    v_add_f32 v67, v67, v75
    v_sub_f32 v27, v32, v24
    v_sub_f32 v75, v64, v52
    v_add_f32 v32, v32, v24
    v_add_f32 v64, v64, v52
    v_sub_f32 v24, v68, v56
    v_sub_f32 v52, v47, v20
    v_add_f32 v47, v47, v20
    v_add_f32 v56, v56, v68
    v_sub_f32 v20, v35, v36
    v_sub_f32 v68, v59, v50
    v_add_f32 v35, v35, v36
    v_add_f32 v59, v59, v50
    v_sub_f32 v36, v74, v66
    v_sub_f32 v50, v18, v26
    v_add_f32 v18, v18, v26
    v_add_f32 v66, v66, v74
    v_sub_f32 v26, v39, v33
    v_sub_f32 v74, v51, v57
    v_add_f32 v39, v39, v33
    v_add_f32 v51, v51, v57
    v_sub_f32 v33, v73, v65
    v_sub_f32 v57, v17, v25
    v_add_f32 v17, v17, v25
    v_add_f32 v65, v65, v73
    v_sub_f32 v25, v34, v43
    v_sub_f32 v73, v58, v79
    v_add_f32 v34, v34, v43
    v_add_f32 v58, v58, v79
    v_sub_f32 v43, v77, v69
    v_sub_f32 v79, v21, v29
    v_add_f32 v21, v21, v29
    v_add_f32 v69, v69, v77
    v_sub_f32 v29, v16, v83
    v_sub_f32 v77, v48, v81
    v_add_f32 v16, v16, v83
    v_add_f32 v48, v48, v81
    v_sub_f32 v83, v37, v80
    v_sub_f32 v81, v61, v72
    v_add_f32 v37, v37, v80
    v_add_f32 v61, v61, v72
    v_sub_f32 v80, v41, v44
    v_sub_f32 v72, v53, v62
    v_add_f32 v41, v41, v44
    v_add_f32 v53, v53, v62
    v_sub_f32 v44, v40, v28
    v_sub_f32 v62, v60, v76
    v_add_f32 v40, v40, v28
    v_add_f32 v60, v60, v76
    v_sub_f32 v28, v42, v46
    v_sub_f32 v76, v49, v63
    v_add_f32 v42, v42, v46
    v_add_f32 v49, v49, v63
    v_sub_f32 v46, v22, v31
    v_sub_f32 v63, v70, v55
    v_add_f32 v22, v22, v31
    v_add_f32 v70, v70, v55
    v_sub_f32 v31, v30, v19
    v_sub_f32 v55, v54, v67
    v_add_f32 v30, v30, v19
    v_add_f32 v54, v54, v67
    v_sub_f32 v19, v23, v38
    v_sub_f32 v67, v71, v78
    v_add_f32 v23, v23, v38
    v_add_f32 v71, v71, v78
    v_sub_f32 v38, v32, v47
    v_sub_f32 v78, v64, v56
    v_add_f32 v32, v32, v47
    v_add_f32 v64, v64, v56
    v_sub_f32 v47, v27, v24
    v_sub_f32 v56, v75, v52
    v_add_f32 v27, v27, v24
    v_add_f32 v75, v75, v52
    v_sub_f32 v24, v35, v18
    v_sub_f32 v52, v59, v66
    v_add_f32 v35, v35, v18
    v_add_f32 v59, v59, v66
    v_sub_f32 v18, v20, v36
    v_sub_f32 v66, v68, v50
    v_add_f32 v20, v20, v36
    v_add_f32 v68, v68, v50
    v_sub_f32 v36, v39, v17
    v_sub_f32 v50, v51, v65
    v_add_f32 v39, v39, v17
    v_add_f32 v51, v51, v65
    v_sub_f32 v17, v26, v33
    v_sub_f32 v65, v74, v57
    v_add_f32 v26, v26, v33
    v_add_f32 v74, v74, v57
    v_sub_f32 v33, v34, v21
    v_sub_f32 v57, v58, v69
    v_add_f32 v34, v34, v21
    v_add_f32 v58, v58, v69
    v_sub_f32 v21, v25, v43
    v_sub_f32 v69, v73, v79
    v_add_f32 v25, v25, v43
    v_add_f32 v73, v73, v79
    v_lshl_add_u32 v6, v1, 2, v7
    ds_write_b32 v6, v16 offset:0
    ds_write_b32 v6, v48 offset:4096
    ds_write_b32 v6, v32 offset:128
    ds_write_b32 v6, v64 offset:4224
    ds_write_b32 v6, v42 offset:256
    ds_write_b32 v6, v49 offset:4352
    ds_write_b32 v6, v39 offset:384
    ds_write_b32 v6, v51 offset:4480
    ds_write_b32 v6, v41 offset:512
    ds_write_b32 v6, v53 offset:4608
    ds_write_b32 v6, v35 offset:640
    ds_write_b32 v6, v59 offset:4736
    ds_write_b32 v6, v30 offset:768
    ds_write_b32 v6, v54 offset:4864
    ds_write_b32 v6, v34 offset:896
    ds_write_b32 v6, v58 offset:4992
    ds_write_b32 v6, v37 offset:1024
    ds_write_b32 v6, v61 offset:5120
    ds_write_b32 v6, v27 offset:1152
    ds_write_b32 v6, v75 offset:5248
    ds_write_b32 v6, v22 offset:1280
    ds_write_b32 v6, v70 offset:5376
    ds_write_b32 v6, v26 offset:1408
    ds_write_b32 v6, v74 offset:5504
    ds_write_b32 v6, v40 offset:1536
    ds_write_b32 v6, v60 offset:5632
    ds_write_b32 v6, v20 offset:1664
    ds_write_b32 v6, v68 offset:5760
    ds_write_b32 v6, v23 offset:1792
    ds_write_b32 v6, v71 offset:5888
    ds_write_b32 v6, v25 offset:1920
    ds_write_b32 v6, v73 offset:6016
    ds_write_b32 v6, v29 offset:2048
    ds_write_b32 v6, v77 offset:6144
    ds_write_b32 v6, v38 offset:2176
    ds_write_b32 v6, v78 offset:6272
    ds_write_b32 v6, v28 offset:2304
    ds_write_b32 v6, v76 offset:6400
    ds_write_b32 v6, v36 offset:2432
    ds_write_b32 v6, v50 offset:6528
    ds_write_b32 v6, v80 offset:2560
    ds_write_b32 v6, v72 offset:6656
    ds_write_b32 v6, v24 offset:2688
    ds_write_b32 v6, v52 offset:6784
    ds_write_b32 v6, v31 offset:2816
    ds_write_b32 v6, v55 offset:6912
    ds_write_b32 v6, v33 offset:2944
    ds_write_b32 v6, v57 offset:7040
    ds_write_b32 v6, v83 offset:3072
    ds_write_b32 v6, v81 offset:7168
    ds_write_b32 v6, v47 offset:3200
    ds_write_b32 v6, v56 offset:7296
    ds_write_b32 v6, v46 offset:3328
    ds_write_b32 v6, v63 offset:7424
    ds_write_b32 v6, v17 offset:3456
    ds_write_b32 v6, v65 offset:7552
    ds_write_b32 v6, v44 offset:3584
    ds_write_b32 v6, v62 offset:7680
    ds_write_b32 v6, v18 offset:3712
    ds_write_b32 v6, v66 offset:7808
    ds_write_b32 v6, v19 offset:3840
    ds_write_b32 v6, v67 offset:7936
    ds_write_b32 v6, v21 offset:3968
    ds_write_b32 v6, v69 offset:8064
    s_waitcnt lgkmcnt(0)
    s_barrier
    v_and_b32 v6, 127, v0
    v_lshrrev_b32 v7, 7, v0
    v_lshlrev_b32 v8, 5, v6
    v_lshl_add_u32 v8, v7, 12, v8
    v_lshlrev_b32 v5, 4, v6
    v_lshl_add_u32 v5, v7, 12, v5
    v_add_u32 v5, 2048, v5
    s_lshl_b32 s12, s92, 16
    ds_read_b128 v[16:19], v8 offset:0
    ds_read_b128 v[20:23], v8 offset:16
    s_waitcnt lgkmcnt(0)
    v_cvt_pk_bf16_f32 v24, v16, v17
    v_cvt_pk_bf16_f32 v25, v18, v19
    v_cvt_pk_bf16_f32 v26, v20, v21
    v_cvt_pk_bf16_f32 v27, v22, v23
    s_add_u32 s13, s12, 0
    buffer_store_dwordx4 v[24:27], v5, s[4:7], s13 offen
    s_nop 1
    ds_read_b128 v[16:19], v8 offset:8448
    ds_read_b128 v[20:23], v8 offset:8464
    s_waitcnt lgkmcnt(0)
    v_cvt_pk_bf16_f32 v24, v16, v17
    v_cvt_pk_bf16_f32 v25, v18, v19
    v_cvt_pk_bf16_f32 v26, v20, v21
    v_cvt_pk_bf16_f32 v27, v22, v23
    s_add_u32 s13, s12, 8192
    buffer_store_dwordx4 v[24:27], v5, s[4:7], s13 offen
    s_nop 1
    ds_read_b128 v[16:19], v8 offset:16896
    ds_read_b128 v[20:23], v8 offset:16912
    s_waitcnt lgkmcnt(0)
    v_cvt_pk_bf16_f32 v24, v16, v17
    v_cvt_pk_bf16_f32 v25, v18, v19
    v_cvt_pk_bf16_f32 v26, v20, v21
    v_cvt_pk_bf16_f32 v27, v22, v23
    s_add_u32 s13, s12, 16384
    buffer_store_dwordx4 v[24:27], v5, s[4:7], s13 offen
    s_nop 1
    ds_read_b128 v[16:19], v8 offset:25344
    ds_read_b128 v[20:23], v8 offset:25360
    s_waitcnt lgkmcnt(0)
    v_cvt_pk_bf16_f32 v24, v16, v17
    v_cvt_pk_bf16_f32 v25, v18, v19
    v_cvt_pk_bf16_f32 v26, v20, v21
    v_cvt_pk_bf16_f32 v27, v22, v23
    s_add_u32 s13, s12, 24576
    buffer_store_dwordx4 v[24:27], v5, s[4:7], s13 offen
    s_nop 1
    ds_read_b128 v[16:19], v8 offset:33792
    ds_read_b128 v[20:23], v8 offset:33808
    s_waitcnt lgkmcnt(0)
    v_cvt_pk_bf16_f32 v24, v16, v17
    v_cvt_pk_bf16_f32 v25, v18, v19
    v_cvt_pk_bf16_f32 v26, v20, v21
    v_cvt_pk_bf16_f32 v27, v22, v23
    s_add_u32 s13, s12, 32768
    buffer_store_dwordx4 v[24:27], v5, s[4:7], s13 offen
    s_nop 1
    ds_read_b128 v[16:19], v8 offset:42240
    ds_read_b128 v[20:23], v8 offset:42256
    s_waitcnt lgkmcnt(0)
    v_cvt_pk_bf16_f32 v24, v16, v17
    v_cvt_pk_bf16_f32 v25, v18, v19
    v_cvt_pk_bf16_f32 v26, v20, v21
    v_cvt_pk_bf16_f32 v27, v22, v23
    s_add_u32 s13, s12, 40960
    buffer_store_dwordx4 v[24:27], v5, s[4:7], s13 offen
    s_nop 1
    ds_read_b128 v[16:19], v8 offset:50688
    ds_read_b128 v[20:23], v8 offset:50704
    s_waitcnt lgkmcnt(0)
    v_cvt_pk_bf16_f32 v24, v16, v17
    v_cvt_pk_bf16_f32 v25, v18, v19
    v_cvt_pk_bf16_f32 v26, v20, v21
    v_cvt_pk_bf16_f32 v27, v22, v23
    s_add_u32 s13, s12, 49152
    buffer_store_dwordx4 v[24:27], v5, s[4:7], s13 offen
    s_nop 1
    ds_read_b128 v[16:19], v8 offset:59136
    ds_read_b128 v[20:23], v8 offset:59152
    s_waitcnt lgkmcnt(0)
    v_cvt_pk_bf16_f32 v24, v16, v17
    v_cvt_pk_bf16_f32 v25, v18, v19
    v_cvt_pk_bf16_f32 v26, v20, v21
    v_cvt_pk_bf16_f32 v27, v22, v23
    s_add_u32 s13, s12, 57344
    buffer_store_dwordx4 v[24:27], v5, s[4:7], s13 offen
    s_nop 1
    s_branch mega_kernel_xo4
mega_kernel_xo:
    s_cmp_lg_u32 s92, 128
    s_cbranch_scc1 mega_kernel_xo2
    s_cmp_lg_u32 s98, 0
    s_cbranch_scc1 mega_kernel_xo2
mega_kernel_wf1b:
    s_sleep 8
    buffer_load_dword v2, off, s[88:91], 0 offset:72 sc1
    s_waitcnt vmcnt(0)
    v_cmp_ne_u32 vcc, 192, v2
    s_cbranch_vccnz mega_kernel_wf1b
    s_mov_b32 s99, 128
    s_branch mega_kernel_f2_in
mega_kernel_f2ret:
    s_waitcnt vmcnt(0)
    v_mov_b32 v2, 1
    s_mov_b64 exec, 1
    buffer_atomic_add v2, off, s[88:91], 0 offset:136 sc1
    s_mov_b64 exec, -1
    s_branch mega_kernel_xo3
mega_kernel_xo2:
    s_waitcnt vmcnt(0)
    ds_read_b64_tr_b16 a[64:65], v201 offset:0
    ds_read_b64_tr_b16 a[66:67], v201 offset:256
    ds_read_b64_tr_b16 a[68:69], v201 offset:1024
    ds_read_b64_tr_b16 a[70:71], v201 offset:1280
    ds_read_b64_tr_b16 a[72:73], v201 offset:2048
    ds_read_b64_tr_b16 a[74:75], v201 offset:2304
    ds_read_b64_tr_b16 a[76:77], v201 offset:3072
    ds_read_b64_tr_b16 a[78:79], v201 offset:3328
    s_waitcnt lgkmcnt(0)
    ds_read_b64_tr_b16 a[80:81], v201 offset:4096
    ds_read_b64_tr_b16 a[82:83], v201 offset:4352
    ds_read_b64_tr_b16 a[84:85], v201 offset:5120
    ds_read_b64_tr_b16 a[86:87], v201 offset:5376
    ds_read_b64_tr_b16 a[88:89], v201 offset:6144
    ds_read_b64_tr_b16 a[90:91], v201 offset:6400
    ds_read_b64_tr_b16 a[92:93], v201 offset:7168
    ds_read_b64_tr_b16 a[94:95], v201 offset:7424
    s_waitcnt lgkmcnt(0)
    ds_read_b64_tr_b16 a[96:97], v201 offset:8192
    ds_read_b64_tr_b16 a[98:99], v201 offset:8448
    ds_read_b64_tr_b16 a[100:101], v201 offset:9216
    ds_read_b64_tr_b16 a[102:103], v201 offset:9472
    ds_read_b64_tr_b16 a[104:105], v201 offset:10240
    ds_read_b64_tr_b16 a[106:107], v201 offset:10496
    ds_read_b64_tr_b16 a[108:109], v201 offset:11264
    ds_read_b64_tr_b16 a[110:111], v201 offset:11520
    s_waitcnt lgkmcnt(0)
    ds_read_b64_tr_b16 a[112:113], v201 offset:12288
    ds_read_b64_tr_b16 a[114:115], v201 offset:12544
    ds_read_b64_tr_b16 a[116:117], v201 offset:13312
    ds_read_b64_tr_b16 a[118:119], v201 offset:13568
    ds_read_b64_tr_b16 a[120:121], v201 offset:14336
    ds_read_b64_tr_b16 a[122:123], v201 offset:14592
    ds_read_b64_tr_b16 a[124:125], v201 offset:15360
    ds_read_b64_tr_b16 a[126:127], v201 offset:15616
    s_waitcnt lgkmcnt(0)
    s_add_u32 m0, s56, 0
    s_add_u32 s58, s57, 32768
    s_and_b32 s58, s58, 0xffff
    s_lshl_b32 s58, s58, 5
    buffer_load_dwordx4 v200, s[52:55], s58 offen lds
    s_add_u32 m0, s56, 1024
    s_add_u32 s58, s57, 33792
    s_and_b32 s58, s58, 0xffff
    s_lshl_b32 s58, s58, 5
    buffer_load_dwordx4 v200, s[52:55], s58 offen lds
    s_add_u32 m0, s56, 2048
    s_add_u32 s58, s57, 34816
    s_and_b32 s58, s58, 0xffff
    s_lshl_b32 s58, s58, 5
    buffer_load_dwordx4 v200, s[52:55], s58 offen lds
    s_add_u32 m0, s56, 3072
    s_add_u32 s58, s57, 35840
    s_and_b32 s58, s58, 0xffff
    s_lshl_b32 s58, s58, 5
    buffer_load_dwordx4 v200, s[52:55], s58 offen lds
    s_add_u32 m0, s56, 4096
    s_add_u32 s58, s57, 36864
    s_and_b32 s58, s58, 0xffff
    s_lshl_b32 s58, s58, 5
    buffer_load_dwordx4 v200, s[52:55], s58 offen lds
    s_add_u32 m0, s56, 5120
    s_add_u32 s58, s57, 37888
    s_and_b32 s58, s58, 0xffff
    s_lshl_b32 s58, s58, 5
    buffer_load_dwordx4 v200, s[52:55], s58 offen lds
    s_add_u32 m0, s56, 6144
    s_add_u32 s58, s57, 38912
    s_and_b32 s58, s58, 0xffff
    s_lshl_b32 s58, s58, 5
    buffer_load_dwordx4 v200, s[52:55], s58 offen lds
    s_add_u32 m0, s56, 7168
    s_add_u32 s58, s57, 39936
    s_and_b32 s58, s58, 0xffff
    s_lshl_b32 s58, s58, 5
    buffer_load_dwordx4 v200, s[52:55], s58 offen lds
    s_add_u32 m0, s56, 8192
    s_add_u32 s58, s57, 40960
    s_and_b32 s58, s58, 0xffff
    s_lshl_b32 s58, s58, 5
    buffer_load_dwordx4 v200, s[52:55], s58 offen lds
    s_add_u32 m0, s56, 9216
    s_add_u32 s58, s57, 41984
    s_and_b32 s58, s58, 0xffff
    s_lshl_b32 s58, s58, 5
    buffer_load_dwordx4 v200, s[52:55], s58 offen lds
    s_add_u32 m0, s56, 10240
    s_add_u32 s58, s57, 43008
    s_and_b32 s58, s58, 0xffff
    s_lshl_b32 s58, s58, 5
    buffer_load_dwordx4 v200, s[52:55], s58 offen lds
    s_add_u32 m0, s56, 11264
    s_add_u32 s58, s57, 44032
    s_and_b32 s58, s58, 0xffff
    s_lshl_b32 s58, s58, 5
    buffer_load_dwordx4 v200, s[52:55], s58 offen lds
    s_add_u32 m0, s56, 12288
    s_add_u32 s58, s57, 45056
    s_and_b32 s58, s58, 0xffff
    s_lshl_b32 s58, s58, 5
    buffer_load_dwordx4 v200, s[52:55], s58 offen lds
    s_add_u32 m0, s56, 13312
    s_add_u32 s58, s57, 46080
    s_and_b32 s58, s58, 0xffff
    s_lshl_b32 s58, s58, 5
    buffer_load_dwordx4 v200, s[52:55], s58 offen lds
    s_add_u32 m0, s56, 14336
    s_add_u32 s58, s57, 47104
    s_and_b32 s58, s58, 0xffff
    s_lshl_b32 s58, s58, 5
    buffer_load_dwordx4 v200, s[52:55], s58 offen lds
    s_add_u32 m0, s56, 15360
    s_add_u32 s58, s57, 48128
    s_and_b32 s58, s58, 0xffff
    s_lshl_b32 s58, s58, 5
    buffer_load_dwordx4 v200, s[52:55], s58 offen lds
mega_kernel_xo3:
    s_waitcnt vmcnt(0)
    ds_read_b64_tr_b16 a[128:129], v201 offset:0
    ds_read_b64_tr_b16 a[130:131], v201 offset:256
    ds_read_b64_tr_b16 a[132:133], v201 offset:1024
    ds_read_b64_tr_b16 a[134:135], v201 offset:1280
    ds_read_b64_tr_b16 a[136:137], v201 offset:2048
    ds_read_b64_tr_b16 a[138:139], v201 offset:2304
    ds_read_b64_tr_b16 a[140:141], v201 offset:3072
    ds_read_b64_tr_b16 a[142:143], v201 offset:3328
    s_waitcnt lgkmcnt(0)
    ds_read_b64_tr_b16 a[144:145], v201 offset:4096
    ds_read_b64_tr_b16 a[146:147], v201 offset:4352
    ds_read_b64_tr_b16 a[148:149], v201 offset:5120
    ds_read_b64_tr_b16 a[150:151], v201 offset:5376
    ds_read_b64_tr_b16 a[152:153], v201 offset:6144
    ds_read_b64_tr_b16 a[154:155], v201 offset:6400
    ds_read_b64_tr_b16 a[156:157], v201 offset:7168
    ds_read_b64_tr_b16 a[158:159], v201 offset:7424
    s_waitcnt lgkmcnt(0)
    ds_read_b64_tr_b16 a[160:161], v201 offset:8192
    ds_read_b64_tr_b16 a[162:163], v201 offset:8448
    ds_read_b64_tr_b16 a[164:165], v201 offset:9216
    ds_read_b64_tr_b16 a[166:167], v201 offset:9472
    ds_read_b64_tr_b16 a[168:169], v201 offset:10240
    ds_read_b64_tr_b16 a[170:171], v201 offset:10496
    ds_read_b64_tr_b16 a[172:173], v201 offset:11264
    ds_read_b64_tr_b16 a[174:175], v201 offset:11520
    s_waitcnt lgkmcnt(0)
    ds_read_b64_tr_b16 a[176:177], v201 offset:12288
    ds_read_b64_tr_b16 a[178:179], v201 offset:12544
    ds_read_b64_tr_b16 a[180:181], v201 offset:13312
    ds_read_b64_tr_b16 a[182:183], v201 offset:13568
    ds_read_b64_tr_b16 a[184:185], v201 offset:14336
    ds_read_b64_tr_b16 a[186:187], v201 offset:14592
    ds_read_b64_tr_b16 a[188:189], v201 offset:15360
    ds_read_b64_tr_b16 a[190:191], v201 offset:15616
    s_waitcnt lgkmcnt(0)
    s_add_u32 m0, s56, 0
    s_add_u32 s58, s57, 49152
    s_and_b32 s58, s58, 0xffff
    s_lshl_b32 s58, s58, 5
    buffer_load_dwordx4 v200, s[52:55], s58 offen lds
    s_add_u32 m0, s56, 1024
    s_add_u32 s58, s57, 50176
    s_and_b32 s58, s58, 0xffff
    s_lshl_b32 s58, s58, 5
    buffer_load_dwordx4 v200, s[52:55], s58 offen lds
    s_add_u32 m0, s56, 2048
    s_add_u32 s58, s57, 51200
    s_and_b32 s58, s58, 0xffff
    s_lshl_b32 s58, s58, 5
    buffer_load_dwordx4 v200, s[52:55], s58 offen lds
    s_add_u32 m0, s56, 3072
    s_add_u32 s58, s57, 52224
    s_and_b32 s58, s58, 0xffff
    s_lshl_b32 s58, s58, 5
    buffer_load_dwordx4 v200, s[52:55], s58 offen lds
    s_add_u32 m0, s56, 4096
    s_add_u32 s58, s57, 53248
    s_and_b32 s58, s58, 0xffff
    s_lshl_b32 s58, s58, 5
    buffer_load_dwordx4 v200, s[52:55], s58 offen lds
    s_add_u32 m0, s56, 5120
    s_add_u32 s58, s57, 54272
    s_and_b32 s58, s58, 0xffff
    s_lshl_b32 s58, s58, 5
    buffer_load_dwordx4 v200, s[52:55], s58 offen lds
    s_add_u32 m0, s56, 6144
    s_add_u32 s58, s57, 55296
    s_and_b32 s58, s58, 0xffff
    s_lshl_b32 s58, s58, 5
    buffer_load_dwordx4 v200, s[52:55], s58 offen lds
    s_add_u32 m0, s56, 7168
    s_add_u32 s58, s57, 56320
    s_and_b32 s58, s58, 0xffff
    s_lshl_b32 s58, s58, 5
    buffer_load_dwordx4 v200, s[52:55], s58 offen lds
    s_add_u32 m0, s56, 8192
    s_add_u32 s58, s57, 57344
    s_and_b32 s58, s58, 0xffff
    s_lshl_b32 s58, s58, 5
    buffer_load_dwordx4 v200, s[52:55], s58 offen lds
    s_add_u32 m0, s56, 9216
    s_add_u32 s58, s57, 58368
    s_and_b32 s58, s58, 0xffff
    s_lshl_b32 s58, s58, 5
    buffer_load_dwordx4 v200, s[52:55], s58 offen lds
    s_add_u32 m0, s56, 10240
    s_add_u32 s58, s57, 59392
    s_and_b32 s58, s58, 0xffff
    s_lshl_b32 s58, s58, 5
    buffer_load_dwordx4 v200, s[52:55], s58 offen lds
    s_add_u32 m0, s56, 11264
    s_add_u32 s58, s57, 60416
    s_and_b32 s58, s58, 0xffff
    s_lshl_b32 s58, s58, 5
    buffer_load_dwordx4 v200, s[52:55], s58 offen lds
    s_add_u32 m0, s56, 12288
    s_add_u32 s58, s57, 61440
    s_and_b32 s58, s58, 0xffff
    s_lshl_b32 s58, s58, 5
    buffer_load_dwordx4 v200, s[52:55], s58 offen lds
    s_add_u32 m0, s56, 13312
    s_add_u32 s58, s57, 62464
    s_and_b32 s58, s58, 0xffff
    s_lshl_b32 s58, s58, 5
    buffer_load_dwordx4 v200, s[52:55], s58 offen lds
    s_add_u32 m0, s56, 14336
    s_add_u32 s58, s57, 63488
    s_and_b32 s58, s58, 0xffff
    s_lshl_b32 s58, s58, 5
    buffer_load_dwordx4 v200, s[52:55], s58 offen lds
    s_add_u32 m0, s56, 15360
    s_add_u32 s58, s57, 64512
    s_and_b32 s58, s58, 0xffff
    s_lshl_b32 s58, s58, 5
    buffer_load_dwordx4 v200, s[52:55], s58 offen lds
mega_kernel_xo4:
    s_waitcnt vmcnt(0)
    ds_read_b64_tr_b16 a[192:193], v201 offset:0
    ds_read_b64_tr_b16 a[194:195], v201 offset:256
    ds_read_b64_tr_b16 a[196:197], v201 offset:1024
    ds_read_b64_tr_b16 a[198:199], v201 offset:1280
    ds_read_b64_tr_b16 a[200:201], v201 offset:2048
    ds_read_b64_tr_b16 a[202:203], v201 offset:2304
    ds_read_b64_tr_b16 a[204:205], v201 offset:3072
    ds_read_b64_tr_b16 a[206:207], v201 offset:3328
    s_waitcnt lgkmcnt(0)
    ds_read_b64_tr_b16 a[208:209], v201 offset:4096
    ds_read_b64_tr_b16 a[210:211], v201 offset:4352
    ds_read_b64_tr_b16 a[212:213], v201 offset:5120
    ds_read_b64_tr_b16 a[214:215], v201 offset:5376
    ds_read_b64_tr_b16 a[216:217], v201 offset:6144
    ds_read_b64_tr_b16 a[218:219], v201 offset:6400
    ds_read_b64_tr_b16 a[220:221], v201 offset:7168
    ds_read_b64_tr_b16 a[222:223], v201 offset:7424
    s_waitcnt lgkmcnt(0)
    ds_read_b64_tr_b16 a[224:225], v201 offset:8192
    ds_read_b64_tr_b16 a[226:227], v201 offset:8448
    ds_read_b64_tr_b16 a[228:229], v201 offset:9216
    ds_read_b64_tr_b16 a[230:231], v201 offset:9472
    ds_read_b64_tr_b16 a[232:233], v201 offset:10240
    ds_read_b64_tr_b16 a[234:235], v201 offset:10496
    ds_read_b64_tr_b16 a[236:237], v201 offset:11264
    ds_read_b64_tr_b16 a[238:239], v201 offset:11520
    s_waitcnt lgkmcnt(0)
    ds_read_b64_tr_b16 a[240:241], v201 offset:12288
    ds_read_b64_tr_b16 a[242:243], v201 offset:12544
    ds_read_b64_tr_b16 a[244:245], v201 offset:13312
    ds_read_b64_tr_b16 a[246:247], v201 offset:13568
    ds_read_b64_tr_b16 a[248:249], v201 offset:14336
    ds_read_b64_tr_b16 a[250:251], v201 offset:14592
    ds_read_b64_tr_b16 a[252:253], v201 offset:15360
    ds_read_b64_tr_b16 a[254:255], v201 offset:15616
    s_waitcnt lgkmcnt(0)
    s_load_dwordx2 s[8:9], s[0:1], 40
    s_load_dwordx2 s[12:13], s[0:1], 80
    v_lshrrev_b32 v3, 6, v0
    v_and_b32 v1, 63, v0
    v_readfirstlane_b32 s16, v3
    s_lshr_b32 s17, s92, 5
    s_and_b32 s18, s92, 31
    v_lshlrev_b32 v2, 4, v1
    s_waitcnt lgkmcnt(0)
    s_mov_b32 s10, 8388608
    s_mov_b32 s11, 0x00020000
    s_mov_b32 s14, 8388608
    s_mov_b32 s15, 0x00020000
    s_mov_b32 s24, 0x3e0293ee
    s_lshr_b32 s50, s18, 1
    s_lshl_b32 s50, s50, 12
    s_lshl_b32 s47, s17, 2
    s_add_u32 s20, s47, s16
    s_lshl_b32 s20, s20, 18
    s_lshl_b32 s21, s18, 13
    s_add_u32 s20, s20, s21
    s_add_u32 s20, s20, 50331648
    v_lshlrev_b32 v26, 7, v1
    buffer_load_dword v28, v26, s[84:87], s20 offen sc1
    v_and_b32 v4, 15, v1
    v_lshrrev_b32 v5, 4, v1
    v_lshrrev_b32 v3, 2, v4
    v_lshlrev_b32 v3, 1, v3
    v_and_b32 v26, 1, v4
    v_add_u32 v3, v3, v26
    v_lshlrev_b32 v6, 8, v3
    v_lshl_add_u32 v6, v5, 4, v6
    s_lshr_b32 s20, s16, 1
    s_lshl_b32 s20, s20, 10
    s_add_u32 s20, s20, 2048
    v_lshlrev_b32 v7, 3, v1
    v_add_u32 v7, s20, v7
    v_lshlrev_b32 v8, 9, v5
    v_lshl_add_u32 v8, v4, 4, v8
    s_lshr_b32 s20, s16, 1
    s_lshl_b32 s20, s20, 12
    s_and_b32 s21, s16, 1
    s_lshl_b32 s21, s21, 8
    s_add_u32 s20, s20, s21
    v_add_u32 v8, s20, v8
    v_lshlrev_b32 v19, 4, v4
    v_and_b32 v26, 1, v5
    v_lshl_add_u32 v19, v26, 10, v19
    v_lshrrev_b32 v26, 1, v5
    v_lshl_add_u32 v19, v26, 9, v19
    s_and_b32 s20, s17, 1
    s_lshl_b32 s20, s20, 8
    v_add_u32 v19, s20, v19
    v_lshlrev_b32 v26, 2, v5
    v_sub_u32 v9, v4, v26
    s_lshr_b32 s21, s21, 4
    v_add_u32 v9, s21, v9
    v_add_u32 v10, -16, v9
    v_mov_b32 v11, 0xff7fffff
    v_mov_b32 v20, 0x3f803f80
    v_mov_b32 v21, 0x3f803f80
    v_mov_b32 v22, 0x3f803f80
    v_mov_b32 v23, 0x3f803f80
    v_bfe_u32 v26, v1, 1, 2
    v_min_u32 v26, 2, v26
    s_lshl_b32 s20, s18, 8
    s_add_u32 s20, s20, 71303168
    v_lshlrev_b32 v12, 13, v26
    v_and_b32 v26, 1, v1
    v_lshl_add_u32 v12, v26, 7, v12
    v_add_u32 v12, s20, v12
    v_and_b32 v26, 1, v1
    v_lshlrev_b32 v13, 7, v26
    s_add_u32 s20, s20, 24576
    v_add_u32 v13, s20, v13
    v_and_b32 v26, 7, v1
    s_lshl_b32 s20, s17, 5
    s_lshl_b32 s21, s16, 3
    s_add_u32 s20, s20, s21
    v_add_u32 v26, s20, v26
    v_lshlrev_b32 v14, 7, v26
    v_add_u32 v14, 71335936, v14
    v_bfrev_b32 v26, 1
    s_lshl_b32 s20, s92, 7
    s_add_u32 s20, s20, 71335936
    v_mov_b32 v27, s20
    v_cmp_eq_u32 vcc, 0, v0
    s_lshl_b32 s20, s16, 12
    v_add_u32 v17, s20, v2
    v_cndmask_b32 v15, v26, v27, vcc
    v_lshrrev_b32 v26, 3, v0
    v_and_b32 v27, 1, v0
    v_lshl_add_u32 v27, v27, 5, v26
    v_lshlrev_b32 v16, 4, v27
    v_bfe_u32 v27, v0, 1, 2
    v_lshl_add_u32 v16, v27, 10, v16
    v_lshlrev_b32 v18, 12, v26
    v_and_b32 v27, 7, v0
    v_lshl_add_u32 v18, v27, 3, v18
    s_lshl_b32 s20, s18, 6
    v_add_u32 v18, s20, v18
    s_barrier
    s_add_u32 s22, s17, 4
    s_sub_u32 s20, s17, 4
    s_cmp_ge_u32 s17, 4
    s_cselect_b32 s22, s20, s22
mega_kernel_x_gp:
    buffer_load_dword v3, v12, s[84:87], 0 offen sc1
    s_waitcnt vmcnt(0)
    v_cmp_ne_u32 vcc, 32, v3
    s_cbranch_vccz mega_kernel_x_gk
    s_sleep 8
    s_branch mega_kernel_x_gp
mega_kernel_x_gk:
    s_mov_b32 s46, 0
    s_lshl_b32 s27, s22, 18
    s_lshl_b32 s20, s18, 13
    s_add_u32 s27, s27, s20
    s_add_u32 s29, s27, 178257920
    s_and_b32 s20, s16, 1
    s_lshl_b32 s20, s20, 10
    s_add_u32 s26, s27, s20
    s_add_u32 s26, s26, 0
    s_lshr_b32 s20, s16, 1
    s_lshl_b32 s20, s20, 12
    s_add_u32 s28, s27, s20
    s_add_u32 s28, s28, 33554432
    s_add_u32 s27, s27, 16777216
    s_add_u32 s48, s26, 4096
    s_add_u32 s49, s27, 4096
mega_kernel_x_ldq:
    buffer_load_dwordx4 v[24:27], v2, s[84:87], s26 offen offset:0
    buffer_load_dwordx4 v[28:31], v2, s[84:87], s26 offen offset:2048
    buffer_load_dwordx4 v[32:35], v2, s[84:87], s48 offen offset:0
    buffer_load_dwordx4 v[36:39], v2, s[84:87], s48 offen offset:2048
    buffer_load_dwordx4 v[40:43], v2, s[84:87], s27 offen offset:0
    buffer_load_dwordx4 v[44:47], v2, s[84:87], s27 offen offset:1024
    buffer_load_dwordx4 v[48:51], v2, s[84:87], s27 offen offset:2048
    buffer_load_dwordx4 v[52:55], v2, s[84:87], s27 offen offset:3072
    buffer_load_dwordx4 v[56:59], v2, s[84:87], s49 offen offset:0
    buffer_load_dwordx4 v[60:63], v2, s[84:87], s49 offen offset:1024
    buffer_load_dwordx4 v[64:67], v2, s[84:87], s49 offen offset:2048
    buffer_load_dwordx4 v[68:71], v2, s[84:87], s49 offen offset:3072
    buffer_load_dwordx4 v[72:75], v2, s[84:87], s28 offen offset:0
    buffer_load_dwordx4 v[76:79], v2, s[84:87], s28 offen offset:1024
    buffer_load_dwordx4 v[80:83], v2, s[84:87], s28 offen offset:2048
    buffer_load_dwordx4 v[84:87], v2, s[84:87], s28 offen offset:3072
mega_kernel_x_att:
    s_waitcnt vmcnt(0)
    v_mfma_f32_16x16x32_bf16 v[112:115], v[40:43], v[24:27], 0
    v_mfma_f32_16x16x32_bf16 v[116:119], v[44:47], v[24:27], 0
    v_mfma_f32_16x16x32_bf16 v[112:115], v[48:51], v[28:31], v[112:115]
    v_mfma_f32_16x16x32_bf16 v[116:119], v[52:55], v[28:31], v[116:119]
    v_mfma_f32_16x16x32_bf16 v[112:115], v[56:59], v[32:35], v[112:115]
    v_mfma_f32_16x16x32_bf16 v[116:119], v[60:63], v[32:35], v[116:119]
    v_mfma_f32_16x16x32_bf16 v[112:115], v[64:67], v[36:39], v[112:115]
    v_mfma_f32_16x16x32_bf16 v[116:119], v[68:71], v[36:39], v[116:119]
    s_lshl_b32 s41, s47, 18
    s_add_u32 s41, s41, 50331648
    s_lshl_b32 s20, s18, 13
    s_add_u32 s40, s41, s20
    s_lshl_b32 s20, s16, 16
    s_add_u32 s41, s41, s20
    s_lshl_b32 s42, s22, 17
    v_mov_b32 v130, v20
    v_mov_b32 v131, 0
    v_cmp_gt_i32 vcc, 0, v9
    s_nop 1
    v_cndmask_b32 v112, v112, v11, vcc
    v_cmp_gt_i32 vcc, 1, v9
    s_nop 1
    v_cndmask_b32 v113, v113, v11, vcc
    v_cmp_gt_i32 vcc, 2, v9
    s_nop 1
    v_cndmask_b32 v114, v114, v11, vcc
    v_cmp_gt_i32 vcc, 3, v9
    s_nop 1
    v_cndmask_b32 v115, v115, v11, vcc
    v_cmp_gt_i32 vcc, 0, v10
    s_nop 1
    v_cndmask_b32 v116, v116, v11, vcc
    v_cmp_gt_i32 vcc, 1, v10
    s_nop 1
    v_cndmask_b32 v117, v117, v11, vcc
    v_cmp_gt_i32 vcc, 2, v10
    s_nop 1
    v_cndmask_b32 v118, v118, v11, vcc
    v_cmp_gt_i32 vcc, 3, v10
    s_nop 1
    v_cndmask_b32 v119, v119, v11, vcc
    s_cmp_eq_u32 s46, 1
    s_cbranch_scc1 mega_kernel_x_rd
mega_kernel_x_rp:
    buffer_load_dword v3, v13, s[84:87], 0 offen sc1
    s_waitcnt vmcnt(0)
    v_cmp_ge_u32 vcc, s22, v3
    s_cbranch_vccz mega_kernel_x_rk
    s_sleep 2
    s_branch mega_kernel_x_rp
mega_kernel_x_rk:
    buffer_load_dwordx4 v[88:91], v6, s[84:87], s29 offen offset:0 sc1
    buffer_load_dwordx4 v[92:95], v6, s[84:87], s29 offen offset:64 sc1
    buffer_load_dwordx4 v[96:99], v6, s[84:87], s29 offen offset:128 sc1
    buffer_load_dwordx4 v[100:103], v6, s[84:87], s29 offen offset:192 sc1
    buffer_load_dwordx2 v[104:105], v7, s[84:87], s29 offen offset:0 sc1
    buffer_load_dwordx2 v[106:107], v7, s[84:87], s29 offen offset:2048 sc1
    buffer_load_dwordx2 v[108:109], v7, s[84:87], s29 offen offset:512 sc1
    buffer_load_dwordx2 v[110:111], v7, s[84:87], s29 offen offset:2560 sc1
mega_kernel_x_rd:
    s_waitcnt vmcnt(7)
    v_mfma_f32_16x16x32_bf16 v[120:123], v[88:91], v[24:27], 0
    s_waitcnt vmcnt(6)
    v_mfma_f32_16x16x32_bf16 v[120:123], v[92:95], v[28:31], v[120:123]
    s_waitcnt vmcnt(5)
    v_mfma_f32_16x16x32_bf16 v[120:123], v[96:99], v[32:35], v[120:123]
    s_waitcnt vmcnt(4)
    v_mfma_f32_16x16x32_bf16 v[120:123], v[100:103], v[36:39], v[120:123]
    v_max3_f32 v4, v112, v113, v114
    v_max3_f32 v4, v4, v115, v116
    v_max3_f32 v4, v4, v117, v118
    s_waitcnt vmcnt(0)
    v_swap_b32 v105, v106
    v_swap_b32 v109, v110
    s_nop 1
    v_max3_f32 v4, v4, v119, v120
    v_max_f32 v3, v4, v121
    v_max_f32 v4, v4, v121
    s_nop 1
    v_permlane16_swap_b32 v4, v3
    v_max_f32 v4, v4, v3
    v_max_f32 v3, v4, v3
    s_nop 1
    v_permlane32_swap_b32 v4, v3
    v_max_f32 v4, v4, v3
    v_mul_f32 v4, s24, v4
    v_fma_f32 v112, v112, s24, -v4
    v_fma_f32 v113, v113, s24, -v4
    v_fma_f32 v114, v114, s24, -v4
    v_fma_f32 v115, v115, s24, -v4
    v_fma_f32 v116, v116, s24, -v4
    v_fma_f32 v117, v117, s24, -v4
    v_fma_f32 v118, v118, s24, -v4
    v_fma_f32 v119, v119, s24, -v4
    v_fma_f32 v120, v120, s24, -v4
    v_fma_f32 v121, v121, s24, -v4
    v_exp_f32 v112, v112
    v_exp_f32 v113, v113
    v_exp_f32 v114, v114
    v_exp_f32 v115, v115
    v_exp_f32 v116, v116
    v_exp_f32 v117, v117
    v_exp_f32 v118, v118
    v_exp_f32 v119, v119
    v_exp_f32 v120, v120
    v_exp_f32 v121, v121
    s_nop 0
    v_cvt_pk_bf16_f32 v124, v112, v113
    v_cvt_pk_bf16_f32 v125, v114, v115
    v_cvt_pk_bf16_f32 v126, v116, v117
    v_cvt_pk_bf16_f32 v127, v118, v119
    v_cvt_pk_bf16_f32 v128, v120, v121
    v_mov_b32 v129, v128
    s_nop 1
    v_mfma_f32_16x16x32_bf16 v[132:135], v[20:23], v[124:127], 0
    v_mfma_f32_16x16x32_bf16 v[88:91], v[72:75], v[124:127], 0
    v_mfma_f32_16x16x32_bf16 v[92:95], v[76:79], v[124:127], 0
    v_mfma_f32_16x16x32_bf16 v[96:99], v[80:83], v[124:127], 0
    v_mfma_f32_16x16x32_bf16 v[100:103], v[84:87], v[124:127], 0
    s_nop 1
    v_mfma_f32_16x16x16_bf16 v[132:135], v[130:131], v[128:129], v[132:135]
    v_mfma_f32_16x16x16_bf16 v[88:91], v[104:105], v[128:129], v[88:91]
    v_mfma_f32_16x16x16_bf16 v[92:95], v[106:107], v[128:129], v[92:95]
    v_mfma_f32_16x16x16_bf16 v[96:99], v[108:109], v[128:129], v[96:99]
    v_mfma_f32_16x16x16_bf16 v[100:103], v[110:111], v[128:129], v[100:103]
    s_nop 3
    v_rcp_f32 v132, v132
    s_nop 2
    v_pk_mul_f32 v[88:89], v[88:89], v[132:133] op_sel_hi:[1,0]
    v_pk_mul_f32 v[90:91], v[90:91], v[132:133] op_sel_hi:[1,0]
    v_pk_mul_f32 v[92:93], v[92:93], v[132:133] op_sel_hi:[1,0]
    v_pk_mul_f32 v[94:95], v[94:95], v[132:133] op_sel_hi:[1,0]
    v_pk_mul_f32 v[96:97], v[96:97], v[132:133] op_sel_hi:[1,0]
    v_pk_mul_f32 v[98:99], v[98:99], v[132:133] op_sel_hi:[1,0]
    v_pk_mul_f32 v[100:101], v[100:101], v[132:133] op_sel_hi:[1,0]
    v_pk_mul_f32 v[102:103], v[102:103], v[132:133] op_sel_hi:[1,0]
    v_cvt_pk_bf16_f32 v112, v88, v89
    v_cvt_pk_bf16_f32 v113, v90, v91
    v_cvt_pk_bf16_f32 v114, v92, v93
    v_cvt_pk_bf16_f32 v115, v94, v95
    v_cvt_pk_bf16_f32 v116, v96, v97
    v_cvt_pk_bf16_f32 v117, v98, v99
    v_cvt_pk_bf16_f32 v118, v100, v101
    v_cvt_pk_bf16_f32 v119, v102, v103
    s_add_u32 s43, s22, 1
    v_mov_b32 v4, s43
    s_cmp_eq_u32 s96, 1
    s_cbranch_scc1 mega_kernel_x_of
    buffer_store_dwordx4 v[112:115], v8, s[84:87], s40 offen sc1
    buffer_store_dwordx4 v[116:119], v8, s[84:87], s40 offen offset:2048 sc1
    s_waitcnt vmcnt(0)
    s_barrier
    buffer_store_dword v4, v15, s[84:87], 0 offen sc1
    s_branch mega_kernel_x_od
mega_kernel_x_of:
    buffer_store_dwordx4 v[112:115], v8, s[84:87], s40 offen
    buffer_store_dwordx4 v[116:119], v8, s[84:87], s40 offen offset:2048
    s_waitcnt vmcnt(0)
    s_barrier
    buffer_store_dword v4, v15, s[84:87], 0 offen
mega_kernel_x_od:
    s_mov_b32 s45, s22
    s_add_u32 s20, s47, 1
    s_and_b32 s20, s20, 3
    s_andn2_b32 s47, s47, 3
    s_or_b32 s47, s47, s20
    s_add_u32 s20, s22, 2
    s_add_u32 s21, s17, 4
    s_cmp_lt_u32 s20, 4
    s_cselect_b32 s20, s20, s21
    s_add_u32 s21, s22, 6
    s_cmp_lt_u32 s22, 4
    s_cselect_b32 s22, s20, s21
    s_lshr_b32 s20, s17, 1
    s_add_u32 s20, s20, 58
    s_cmp_ge_u32 s22, 58
    s_cselect_b32 s22, s20, s22
    s_add_u32 s20, s45, 3
    s_cmp_ge_u32 s45, 58
    s_cselect_b32 s22, s20, s22
    s_lshl_b32 s27, s22, 18
    s_lshl_b32 s20, s18, 13
    s_add_u32 s27, s27, s20
    s_add_u32 s29, s27, 178257920
    s_and_b32 s20, s16, 1
    s_lshl_b32 s20, s20, 10
    s_add_u32 s26, s27, s20
    s_add_u32 s26, s26, 0
    s_lshr_b32 s20, s16, 1
    s_lshl_b32 s20, s20, 12
    s_add_u32 s28, s27, s20
    s_add_u32 s28, s28, 33554432
    s_add_u32 s27, s27, 16777216
    s_add_u32 s48, s26, 4096
    s_add_u32 s49, s27, 4096
mega_kernel_x_xp:
    buffer_load_dword v3, v14, s[84:87], 0 offen sc1
    s_waitcnt vmcnt(0)
    v_cmp_ge_u32 vcc, s45, v3
    s_cbranch_vccnz mega_kernel_x_xp
    s_cmp_ge_u32 s45, 58
    s_cbranch_scc1 mega_kernel_x_half
    s_add_u32 s20, s50, 0
    s_and_b32 s20, s20, 0xffff
    s_add_u32 s20, s20, s41
    buffer_load_dwordx4 v[136:139], v2, s[84:87], s20 offen offset:0 sc1
    buffer_load_dwordx4 v[140:143], v2, s[84:87], s20 offen offset:1024 sc1
    buffer_load_dwordx4 v[144:147], v2, s[84:87], s20 offen offset:2048 sc1
    buffer_load_dwordx4 v[148:151], v2, s[84:87], s20 offen offset:3072 sc1
    s_add_u32 s20, s50, 4096
    s_and_b32 s20, s20, 0xffff
    s_add_u32 s20, s20, s41
    buffer_load_dwordx4 v[152:155], v2, s[84:87], s20 offen offset:0 sc1
    buffer_load_dwordx4 v[156:159], v2, s[84:87], s20 offen offset:1024 sc1
    buffer_load_dwordx4 v[160:163], v2, s[84:87], s20 offen offset:2048 sc1
    buffer_load_dwordx4 v[164:167], v2, s[84:87], s20 offen offset:3072 sc1
    s_add_u32 s20, s50, 8192
    s_and_b32 s20, s20, 0xffff
    s_add_u32 s20, s20, s41
    buffer_load_dwordx4 v[168:171], v2, s[84:87], s20 offen offset:0 sc1
    buffer_load_dwordx4 v[172:175], v2, s[84:87], s20 offen offset:1024 sc1
    buffer_load_dwordx4 v[176:179], v2, s[84:87], s20 offen offset:2048 sc1
    buffer_load_dwordx4 v[180:183], v2, s[84:87], s20 offen offset:3072 sc1
    buffer_load_dword v5, v13, s[84:87], 0 offen sc1
    s_waitcnt vmcnt(12)
    v_mfma_f32_32x32x16_bf16 v[112:127], a[0:3], v[136:139], 0
    s_add_u32 s20, s50, 12288
    s_and_b32 s20, s20, 0xffff
    s_add_u32 s20, s20, s41
    buffer_load_dwordx4 v[184:187], v2, s[84:87], s20 offen offset:0 sc1
    s_waitcnt vmcnt(12)
    v_mfma_f32_32x32x16_bf16 v[112:127], a[4:7], v[140:143], v[112:127]
    buffer_load_dwordx4 v[188:191], v2, s[84:87], s20 offen offset:1024 sc1
    s_waitcnt vmcnt(12)
    v_mfma_f32_32x32x16_bf16 v[112:127], a[8:11], v[144:147], v[112:127]
    buffer_load_dwordx4 v[192:195], v2, s[84:87], s20 offen offset:2048 sc1
    s_waitcnt vmcnt(12)
    v_mfma_f32_32x32x16_bf16 v[112:127], a[12:15], v[148:151], v[112:127]
    buffer_load_dwordx4 v[196:199], v2, s[84:87], s20 offen offset:3072 sc1
    s_waitcnt vmcnt(12)
    v_mfma_f32_32x32x16_bf16 v[112:127], a[16:19], v[152:155], v[112:127]
    s_add_u32 s20, s50, 16384
    s_and_b32 s20, s20, 0xffff
    s_add_u32 s20, s20, s41
    buffer_load_dwordx4 v[200:203], v2, s[84:87], s20 offen offset:0 sc1
    s_waitcnt vmcnt(12)
    v_mfma_f32_32x32x16_bf16 v[112:127], a[20:23], v[156:159], v[112:127]
    buffer_load_dwordx4 v[204:207], v2, s[84:87], s20 offen offset:1024 sc1
    s_waitcnt vmcnt(12)
    v_mfma_f32_32x32x16_bf16 v[112:127], a[24:27], v[160:163], v[112:127]
    buffer_load_dwordx4 v[208:211], v2, s[84:87], s20 offen offset:2048 sc1
    s_waitcnt vmcnt(12)
    v_mfma_f32_32x32x16_bf16 v[112:127], a[28:31], v[164:167], v[112:127]
    buffer_load_dwordx4 v[212:215], v2, s[84:87], s20 offen offset:3072 sc1
    s_waitcnt vmcnt(12)
    v_mfma_f32_32x32x16_bf16 v[112:127], a[32:35], v[168:171], v[112:127]
    s_add_u32 s20, s50, 20480
    s_and_b32 s20, s20, 0xffff
    s_add_u32 s20, s20, s41
    buffer_load_dwordx4 v[216:219], v2, s[84:87], s20 offen offset:0 sc1
    s_waitcnt vmcnt(12)
    v_mfma_f32_32x32x16_bf16 v[112:127], a[36:39], v[172:175], v[112:127]
    buffer_load_dwordx4 v[220:223], v2, s[84:87], s20 offen offset:1024 sc1
    s_waitcnt vmcnt(12)
    v_mfma_f32_32x32x16_bf16 v[112:127], a[40:43], v[176:179], v[112:127]
    buffer_load_dwordx4 v[224:227], v2, s[84:87], s20 offen offset:2048 sc1
    s_waitcnt vmcnt(12)
    v_mfma_f32_32x32x16_bf16 v[112:127], a[44:47], v[180:183], v[112:127]
    buffer_load_dwordx4 v[228:231], v2, s[84:87], s20 offen offset:3072 sc1
    s_waitcnt vmcnt(11)
    v_mfma_f32_32x32x16_bf16 v[112:127], a[48:51], v[184:187], v[112:127]
    s_add_u32 s20, s50, 24576
    s_and_b32 s20, s20, 0xffff
    s_add_u32 s20, s20, s41
    buffer_load_dwordx4 v[232:235], v2, s[84:87], s20 offen offset:0 sc1
    v_cmp_ge_u32 vcc, s22, v5
    s_waitcnt vmcnt(11)
    v_mfma_f32_32x32x16_bf16 v[112:127], a[52:55], v[188:191], v[112:127]
    buffer_load_dwordx4 v[236:239], v2, s[84:87], s20 offen offset:1024 sc1
    s_cmp_eq_u64 vcc, 0
    s_cselect_b32 s46, 1, 0
    s_waitcnt vmcnt(11)
    v_mfma_f32_32x32x16_bf16 v[112:127], a[56:59], v[192:195], v[112:127]
    buffer_load_dwordx4 v[240:243], v2, s[84:87], s20 offen offset:2048 sc1
    s_waitcnt vmcnt(11)
    v_mfma_f32_32x32x16_bf16 v[112:127], a[60:63], v[196:199], v[112:127]
    buffer_load_dwordx4 v[244:247], v2, s[84:87], s20 offen offset:3072 sc1
    s_waitcnt vmcnt(11)
    v_mfma_f32_32x32x16_bf16 v[112:127], a[64:67], v[200:203], v[112:127]
    s_add_u32 s20, s50, 28672
    s_and_b32 s20, s20, 0xffff
    s_add_u32 s20, s20, s41
    buffer_load_dwordx4 v[248:251], v2, s[84:87], s20 offen offset:0 sc1
    s_waitcnt vmcnt(11)
    v_mfma_f32_32x32x16_bf16 v[112:127], a[68:71], v[204:207], v[112:127]
    buffer_load_dwordx4 v[252:255], v2, s[84:87], s20 offen offset:1024 sc1
    s_waitcnt vmcnt(11)
    v_mfma_f32_32x32x16_bf16 v[112:127], a[72:75], v[208:211], v[112:127]
    buffer_load_dwordx4 v[136:139], v2, s[84:87], s20 offen offset:2048 sc1
    s_waitcnt vmcnt(11)
    v_mfma_f32_32x32x16_bf16 v[112:127], a[76:79], v[212:215], v[112:127]
    buffer_load_dwordx4 v[140:143], v2, s[84:87], s20 offen offset:3072 sc1
    s_waitcnt vmcnt(11)
    v_mfma_f32_32x32x16_bf16 v[112:127], a[80:83], v[216:219], v[112:127]
    s_add_u32 s20, s50, 32768
    s_and_b32 s20, s20, 0xffff
    s_add_u32 s20, s20, s41
    buffer_load_dwordx4 v[144:147], v2, s[84:87], s20 offen offset:0 sc1
    s_waitcnt vmcnt(11)
    v_mfma_f32_32x32x16_bf16 v[112:127], a[84:87], v[220:223], v[112:127]
    buffer_load_dwordx4 v[148:151], v2, s[84:87], s20 offen offset:1024 sc1
    s_waitcnt vmcnt(11)
    v_mfma_f32_32x32x16_bf16 v[112:127], a[88:91], v[224:227], v[112:127]
    buffer_load_dwordx4 v[152:155], v2, s[84:87], s20 offen offset:2048 sc1
    s_waitcnt vmcnt(11)
    v_mfma_f32_32x32x16_bf16 v[112:127], a[92:95], v[228:231], v[112:127]
    buffer_load_dwordx4 v[156:159], v2, s[84:87], s20 offen offset:3072 sc1
    s_waitcnt vmcnt(11)
    v_mfma_f32_32x32x16_bf16 v[112:127], a[96:99], v[232:235], v[112:127]
    s_add_u32 s20, s50, 36864
    s_and_b32 s20, s20, 0xffff
    s_add_u32 s20, s20, s41
    buffer_load_dwordx4 v[160:163], v2, s[84:87], s20 offen offset:0 sc1
    s_waitcnt vmcnt(11)
    v_mfma_f32_32x32x16_bf16 v[112:127], a[100:103], v[236:239], v[112:127]
    buffer_load_dwordx4 v[164:167], v2, s[84:87], s20 offen offset:1024 sc1
    s_waitcnt vmcnt(11)
    v_mfma_f32_32x32x16_bf16 v[112:127], a[104:107], v[240:243], v[112:127]
    buffer_load_dwordx4 v[168:171], v2, s[84:87], s20 offen offset:2048 sc1
    s_waitcnt vmcnt(11)
    v_mfma_f32_32x32x16_bf16 v[112:127], a[108:111], v[244:247], v[112:127]
    buffer_load_dwordx4 v[172:175], v2, s[84:87], s20 offen offset:3072 sc1
    s_waitcnt vmcnt(11)
    v_mfma_f32_32x32x16_bf16 v[112:127], a[112:115], v[248:251], v[112:127]
    s_add_u32 s20, s50, 40960
    s_and_b32 s20, s20, 0xffff
    s_add_u32 s20, s20, s41
    buffer_load_dwordx4 v[176:179], v2, s[84:87], s20 offen offset:0 sc1
    s_waitcnt vmcnt(11)
    v_mfma_f32_32x32x16_bf16 v[112:127], a[116:119], v[252:255], v[112:127]
    buffer_load_dwordx4 v[180:183], v2, s[84:87], s20 offen offset:1024 sc1
    s_waitcnt vmcnt(11)
    v_mfma_f32_32x32x16_bf16 v[112:127], a[120:123], v[136:139], v[112:127]
    buffer_load_dwordx4 v[184:187], v2, s[84:87], s20 offen offset:2048 sc1
    s_waitcnt vmcnt(11)
    v_mfma_f32_32x32x16_bf16 v[112:127], a[124:127], v[140:143], v[112:127]
    buffer_load_dwordx4 v[188:191], v2, s[84:87], s20 offen offset:3072 sc1
    s_waitcnt vmcnt(11)
    v_mfma_f32_32x32x16_bf16 v[112:127], a[128:131], v[144:147], v[112:127]
    s_add_u32 s20, s50, 45056
    s_and_b32 s20, s20, 0xffff
    s_add_u32 s20, s20, s41
    buffer_load_dwordx4 v[192:195], v2, s[84:87], s20 offen offset:0 sc1
    s_waitcnt vmcnt(11)
    v_mfma_f32_32x32x16_bf16 v[112:127], a[132:135], v[148:151], v[112:127]
    buffer_load_dwordx4 v[196:199], v2, s[84:87], s20 offen offset:1024 sc1
    s_waitcnt vmcnt(11)
    v_mfma_f32_32x32x16_bf16 v[112:127], a[136:139], v[152:155], v[112:127]
    buffer_load_dwordx4 v[200:203], v2, s[84:87], s20 offen offset:2048 sc1
    s_waitcnt vmcnt(11)
    v_mfma_f32_32x32x16_bf16 v[112:127], a[140:143], v[156:159], v[112:127]
    buffer_load_dwordx4 v[204:207], v2, s[84:87], s20 offen offset:3072 sc1
    s_waitcnt vmcnt(11)
    v_mfma_f32_32x32x16_bf16 v[112:127], a[144:147], v[160:163], v[112:127]
    s_add_u32 s20, s50, 49152
    s_and_b32 s20, s20, 0xffff
    s_add_u32 s20, s20, s41
    buffer_load_dwordx4 v[208:211], v2, s[84:87], s20 offen offset:0 sc1
    s_waitcnt vmcnt(11)
    v_mfma_f32_32x32x16_bf16 v[112:127], a[148:151], v[164:167], v[112:127]
    buffer_load_dwordx4 v[212:215], v2, s[84:87], s20 offen offset:1024 sc1
    s_waitcnt vmcnt(11)
    v_mfma_f32_32x32x16_bf16 v[112:127], a[152:155], v[168:171], v[112:127]
    buffer_load_dwordx4 v[216:219], v2, s[84:87], s20 offen offset:2048 sc1
    s_waitcnt vmcnt(11)
    v_mfma_f32_32x32x16_bf16 v[112:127], a[156:159], v[172:175], v[112:127]
    buffer_load_dwordx4 v[220:223], v2, s[84:87], s20 offen offset:3072 sc1
    s_waitcnt vmcnt(11)
    v_mfma_f32_32x32x16_bf16 v[112:127], a[160:163], v[176:179], v[112:127]
    s_add_u32 s20, s50, 53248
    s_and_b32 s20, s20, 0xffff
    s_add_u32 s20, s20, s41
    buffer_load_dwordx4 v[224:227], v2, s[84:87], s20 offen offset:0 sc1
    s_waitcnt vmcnt(11)
    v_mfma_f32_32x32x16_bf16 v[112:127], a[164:167], v[180:183], v[112:127]
    buffer_load_dwordx4 v[228:231], v2, s[84:87], s20 offen offset:1024 sc1
    s_waitcnt vmcnt(11)
    v_mfma_f32_32x32x16_bf16 v[112:127], a[168:171], v[184:187], v[112:127]
    buffer_load_dwordx4 v[232:235], v2, s[84:87], s20 offen offset:2048 sc1
    s_waitcnt vmcnt(11)
    v_mfma_f32_32x32x16_bf16 v[112:127], a[172:175], v[188:191], v[112:127]
    buffer_load_dwordx4 v[236:239], v2, s[84:87], s20 offen offset:3072 sc1
    s_waitcnt vmcnt(11)
    v_mfma_f32_32x32x16_bf16 v[112:127], a[176:179], v[192:195], v[112:127]
    s_add_u32 s20, s50, 57344
    s_and_b32 s20, s20, 0xffff
    s_add_u32 s20, s20, s41
    buffer_load_dwordx4 v[240:243], v2, s[84:87], s20 offen offset:0 sc1
    s_waitcnt vmcnt(11)
    v_mfma_f32_32x32x16_bf16 v[112:127], a[180:183], v[196:199], v[112:127]
    buffer_load_dwordx4 v[244:247], v2, s[84:87], s20 offen offset:1024 sc1
    s_waitcnt vmcnt(11)
    v_mfma_f32_32x32x16_bf16 v[112:127], a[184:187], v[200:203], v[112:127]
    buffer_load_dwordx4 v[248:251], v2, s[84:87], s20 offen offset:2048 sc1
    s_waitcnt vmcnt(11)
    v_mfma_f32_32x32x16_bf16 v[112:127], a[188:191], v[204:207], v[112:127]
    buffer_load_dwordx4 v[252:255], v2, s[84:87], s20 offen offset:3072 sc1
    s_waitcnt vmcnt(11)
    v_mfma_f32_32x32x16_bf16 v[112:127], a[192:195], v[208:211], v[112:127]
    s_add_u32 s20, s50, 61440
    s_and_b32 s20, s20, 0xffff
    s_add_u32 s20, s20, s41
    buffer_load_dwordx4 v[136:139], v2, s[84:87], s20 offen offset:0 sc1
    s_waitcnt vmcnt(11)
    v_mfma_f32_32x32x16_bf16 v[112:127], a[196:199], v[212:215], v[112:127]
    buffer_load_dwordx4 v[140:143], v2, s[84:87], s20 offen offset:1024 sc1
    s_waitcnt vmcnt(11)
    v_mfma_f32_32x32x16_bf16 v[112:127], a[200:203], v[216:219], v[112:127]
    buffer_load_dwordx4 v[144:147], v2, s[84:87], s20 offen offset:2048 sc1
    s_waitcnt vmcnt(11)
    v_mfma_f32_32x32x16_bf16 v[112:127], a[204:207], v[220:223], v[112:127]
    buffer_load_dwordx4 v[148:151], v2, s[84:87], s20 offen offset:3072 sc1
    s_cmp_eq_u32 s46, 1
    s_cbranch_scc1 mega_kernel_x_pfx
    s_waitcnt vmcnt(11)
    v_mfma_f32_32x32x16_bf16 v[112:127], a[208:211], v[224:227], v[112:127]
    s_waitcnt vmcnt(10)
    v_mfma_f32_32x32x16_bf16 v[112:127], a[212:215], v[228:231], v[112:127]
    s_waitcnt vmcnt(9)
    v_mfma_f32_32x32x16_bf16 v[112:127], a[216:219], v[232:235], v[112:127]
    s_waitcnt vmcnt(8)
    v_mfma_f32_32x32x16_bf16 v[112:127], a[220:223], v[236:239], v[112:127]
    s_waitcnt vmcnt(7)
    v_mfma_f32_32x32x16_bf16 v[112:127], a[224:227], v[240:243], v[112:127]
    s_waitcnt vmcnt(6)
    v_mfma_f32_32x32x16_bf16 v[112:127], a[228:231], v[244:247], v[112:127]
    s_waitcnt vmcnt(5)
    v_mfma_f32_32x32x16_bf16 v[112:127], a[232:235], v[248:251], v[112:127]
    s_waitcnt vmcnt(4)
    v_mfma_f32_32x32x16_bf16 v[112:127], a[236:239], v[252:255], v[112:127]
    s_waitcnt vmcnt(3)
    v_mfma_f32_32x32x16_bf16 v[112:127], a[240:243], v[136:139], v[112:127]
    s_waitcnt vmcnt(2)
    v_mfma_f32_32x32x16_bf16 v[112:127], a[244:247], v[140:143], v[112:127]
    s_waitcnt vmcnt(1)
    v_mfma_f32_32x32x16_bf16 v[112:127], a[248:251], v[144:147], v[112:127]
    s_waitcnt vmcnt(0)
    v_mfma_f32_32x32x16_bf16 v[112:127], a[252:255], v[148:151], v[112:127]
    s_branch mega_kernel_x_pfd
mega_kernel_x_pfx:
    s_waitcnt vmcnt(11)
    v_mfma_f32_32x32x16_bf16 v[112:127], a[208:211], v[224:227], v[112:127]
    buffer_load_dwordx4 v[24:27], v2, s[84:87], s26 offen offset:0
    buffer_load_dwordx4 v[28:31], v2, s[84:87], s26 offen offset:2048
    s_waitcnt vmcnt(12)
    v_mfma_f32_32x32x16_bf16 v[112:127], a[212:215], v[228:231], v[112:127]
    buffer_load_dwordx4 v[32:35], v2, s[84:87], s48 offen offset:0
    buffer_load_dwordx4 v[36:39], v2, s[84:87], s48 offen offset:2048
    s_waitcnt vmcnt(13)
    v_mfma_f32_32x32x16_bf16 v[112:127], a[216:219], v[232:235], v[112:127]
    buffer_load_dwordx4 v[40:43], v2, s[84:87], s27 offen offset:0
    buffer_load_dwordx4 v[44:47], v2, s[84:87], s27 offen offset:1024
    s_waitcnt vmcnt(14)
    v_mfma_f32_32x32x16_bf16 v[112:127], a[220:223], v[236:239], v[112:127]
    buffer_load_dwordx4 v[48:51], v2, s[84:87], s27 offen offset:2048
    buffer_load_dwordx4 v[52:55], v2, s[84:87], s27 offen offset:3072
    s_waitcnt vmcnt(15)
    v_mfma_f32_32x32x16_bf16 v[112:127], a[224:227], v[240:243], v[112:127]
    buffer_load_dwordx4 v[56:59], v2, s[84:87], s49 offen offset:0
    buffer_load_dwordx4 v[60:63], v2, s[84:87], s49 offen offset:1024
    s_waitcnt vmcnt(16)
    v_mfma_f32_32x32x16_bf16 v[112:127], a[228:231], v[244:247], v[112:127]
    buffer_load_dwordx4 v[64:67], v2, s[84:87], s49 offen offset:2048
    buffer_load_dwordx4 v[68:71], v2, s[84:87], s49 offen offset:3072
    s_waitcnt vmcnt(17)
    v_mfma_f32_32x32x16_bf16 v[112:127], a[232:235], v[248:251], v[112:127]
    buffer_load_dwordx4 v[72:75], v2, s[84:87], s28 offen offset:0
    buffer_load_dwordx4 v[76:79], v2, s[84:87], s28 offen offset:1024
    s_waitcnt vmcnt(18)
    v_mfma_f32_32x32x16_bf16 v[112:127], a[236:239], v[252:255], v[112:127]
    buffer_load_dwordx4 v[80:83], v2, s[84:87], s28 offen offset:2048
    buffer_load_dwordx4 v[84:87], v2, s[84:87], s28 offen offset:3072
    s_waitcnt vmcnt(19)
    v_mfma_f32_32x32x16_bf16 v[112:127], a[240:243], v[136:139], v[112:127]
    buffer_load_dwordx4 v[88:91], v6, s[84:87], s29 offen offset:0 sc1
    buffer_load_dwordx4 v[92:95], v6, s[84:87], s29 offen offset:64 sc1
    s_waitcnt vmcnt(20)
    v_mfma_f32_32x32x16_bf16 v[112:127], a[244:247], v[140:143], v[112:127]
    buffer_load_dwordx4 v[96:99], v6, s[84:87], s29 offen offset:128 sc1
    buffer_load_dwordx4 v[100:103], v6, s[84:87], s29 offen offset:192 sc1
    s_waitcnt vmcnt(21)
    v_mfma_f32_32x32x16_bf16 v[112:127], a[248:251], v[144:147], v[112:127]
    buffer_load_dwordx2 v[104:105], v7, s[84:87], s29 offen offset:0 sc1
    buffer_load_dwordx2 v[106:107], v7, s[84:87], s29 offen offset:2048 sc1
    s_waitcnt vmcnt(22)
    v_mfma_f32_32x32x16_bf16 v[112:127], a[252:255], v[148:151], v[112:127]
    buffer_load_dwordx2 v[108:109], v7, s[84:87], s29 offen offset:512 sc1
    buffer_load_dwordx2 v[110:111], v7, s[84:87], s29 offen offset:2560 sc1
mega_kernel_x_pfd:
    s_nop 11
    ds_write_b128 v17, v[112:115] offset:0
    ds_write_b128 v17, v[116:119] offset:1024
    ds_write_b128 v17, v[120:123] offset:2048
    ds_write_b128 v17, v[124:127] offset:3072
    s_waitcnt lgkmcnt(0)
    s_barrier
    ds_read_b128 v[112:115], v16 offset:0
    ds_read_b128 v[116:119], v16 offset:4096
    ds_read_b128 v[120:123], v16 offset:8192
    ds_read_b128 v[124:127], v16 offset:12288
    s_waitcnt lgkmcnt(0)
    v_pk_add_f32 v[112:113], v[112:113], v[116:117]
    v_pk_add_f32 v[114:115], v[114:115], v[118:119]
    v_pk_add_f32 v[120:121], v[120:121], v[124:125]
    v_pk_add_f32 v[122:123], v[122:123], v[126:127]
    v_pk_add_f32 v[112:113], v[112:113], v[120:121]
    v_pk_add_f32 v[114:115], v[114:115], v[122:123]
    v_cvt_pk_bf16_f32 v132, v112, v113
    v_cvt_pk_bf16_f32 v133, v114, v115
    buffer_store_dwordx2 v[132:133], v18, s[12:15], s42 offen
    s_branch mega_kernel_x_nxt
mega_kernel_x_half:
    s_add_u32 s20, s50, 0
    s_and_b32 s20, s20, 0xffff
    s_add_u32 s20, s20, s41
    buffer_load_dwordx4 v[136:139], v19, s[84:87], s20 offen offset:0 sc1
    buffer_load_dwordx4 v[140:143], v19, s[84:87], s20 offen offset:2048 sc1
    s_add_u32 s20, s50, 4096
    s_and_b32 s20, s20, 0xffff
    s_add_u32 s20, s20, s41
    buffer_load_dwordx4 v[144:147], v19, s[84:87], s20 offen offset:0 sc1
    buffer_load_dwordx4 v[148:151], v19, s[84:87], s20 offen offset:2048 sc1
    s_add_u32 s20, s50, 8192
    s_and_b32 s20, s20, 0xffff
    s_add_u32 s20, s20, s41
    buffer_load_dwordx4 v[152:155], v19, s[84:87], s20 offen offset:0 sc1
    buffer_load_dwordx4 v[156:159], v19, s[84:87], s20 offen offset:2048 sc1
    s_add_u32 s20, s50, 12288
    s_and_b32 s20, s20, 0xffff
    s_add_u32 s20, s20, s41
    buffer_load_dwordx4 v[160:163], v19, s[84:87], s20 offen offset:0 sc1
    buffer_load_dwordx4 v[164:167], v19, s[84:87], s20 offen offset:2048 sc1
    s_add_u32 s20, s50, 16384
    s_and_b32 s20, s20, 0xffff
    s_add_u32 s20, s20, s41
    buffer_load_dwordx4 v[168:171], v19, s[84:87], s20 offen offset:0 sc1
    buffer_load_dwordx4 v[172:175], v19, s[84:87], s20 offen offset:2048 sc1
    s_add_u32 s20, s50, 20480
    s_and_b32 s20, s20, 0xffff
    s_add_u32 s20, s20, s41
    buffer_load_dwordx4 v[176:179], v19, s[84:87], s20 offen offset:0 sc1
    buffer_load_dwordx4 v[180:183], v19, s[84:87], s20 offen offset:2048 sc1
    s_mov_b32 s46, 0
    s_waitcnt vmcnt(11)
    v_mfma_f32_32x32x16_bf16 v[112:127], a[0:3], v[136:139], 0
    v_mfma_f32_32x32x16_bf16 v[88:103], a[4:7], v[136:139], 0
    s_add_u32 s20, s50, 24576
    s_and_b32 s20, s20, 0xffff
    s_add_u32 s20, s20, s41
    buffer_load_dwordx4 v[184:187], v19, s[84:87], s20 offen offset:0 sc1
    s_waitcnt vmcnt(11)
    v_mfma_f32_32x32x16_bf16 v[112:127], a[8:11], v[140:143], v[112:127]
    v_mfma_f32_32x32x16_bf16 v[88:103], a[12:15], v[140:143], v[88:103]
    buffer_load_dwordx4 v[188:191], v19, s[84:87], s20 offen offset:2048 sc1
    s_waitcnt vmcnt(11)
    v_mfma_f32_32x32x16_bf16 v[112:127], a[16:19], v[144:147], v[112:127]
    v_mfma_f32_32x32x16_bf16 v[88:103], a[20:23], v[144:147], v[88:103]
    s_add_u32 s20, s50, 28672
    s_and_b32 s20, s20, 0xffff
    s_add_u32 s20, s20, s41
    buffer_load_dwordx4 v[192:195], v19, s[84:87], s20 offen offset:0 sc1
    s_waitcnt vmcnt(11)
    v_mfma_f32_32x32x16_bf16 v[112:127], a[24:27], v[148:151], v[112:127]
    v_mfma_f32_32x32x16_bf16 v[88:103], a[28:31], v[148:151], v[88:103]
    buffer_load_dwordx4 v[196:199], v19, s[84:87], s20 offen offset:2048 sc1
    s_waitcnt vmcnt(11)
    v_mfma_f32_32x32x16_bf16 v[112:127], a[32:35], v[152:155], v[112:127]
    v_mfma_f32_32x32x16_bf16 v[88:103], a[36:39], v[152:155], v[88:103]
    s_add_u32 s20, s50, 32768
    s_and_b32 s20, s20, 0xffff
    s_add_u32 s20, s20, s41
    buffer_load_dwordx4 v[200:203], v19, s[84:87], s20 offen offset:0 sc1
    s_waitcnt vmcnt(11)
    v_mfma_f32_32x32x16_bf16 v[112:127], a[40:43], v[156:159], v[112:127]
    v_mfma_f32_32x32x16_bf16 v[88:103], a[44:47], v[156:159], v[88:103]
    buffer_load_dwordx4 v[204:207], v19, s[84:87], s20 offen offset:2048 sc1
    s_waitcnt vmcnt(11)
    v_mfma_f32_32x32x16_bf16 v[112:127], a[48:51], v[160:163], v[112:127]
    v_mfma_f32_32x32x16_bf16 v[88:103], a[52:55], v[160:163], v[88:103]
    s_add_u32 s20, s50, 36864
    s_and_b32 s20, s20, 0xffff
    s_add_u32 s20, s20, s41
    buffer_load_dwordx4 v[208:211], v19, s[84:87], s20 offen offset:0 sc1
    s_waitcnt vmcnt(11)
    v_mfma_f32_32x32x16_bf16 v[112:127], a[56:59], v[164:167], v[112:127]
    v_mfma_f32_32x32x16_bf16 v[88:103], a[60:63], v[164:167], v[88:103]
    buffer_load_dwordx4 v[212:215], v19, s[84:87], s20 offen offset:2048 sc1
    s_waitcnt vmcnt(11)
    v_mfma_f32_32x32x16_bf16 v[112:127], a[64:67], v[168:171], v[112:127]
    v_mfma_f32_32x32x16_bf16 v[88:103], a[68:71], v[168:171], v[88:103]
    s_add_u32 s20, s50, 40960
    s_and_b32 s20, s20, 0xffff
    s_add_u32 s20, s20, s41
    buffer_load_dwordx4 v[216:219], v19, s[84:87], s20 offen offset:0 sc1
    s_waitcnt vmcnt(11)
    v_mfma_f32_32x32x16_bf16 v[112:127], a[72:75], v[172:175], v[112:127]
    v_mfma_f32_32x32x16_bf16 v[88:103], a[76:79], v[172:175], v[88:103]
    buffer_load_dwordx4 v[220:223], v19, s[84:87], s20 offen offset:2048 sc1
    s_waitcnt vmcnt(11)
    v_mfma_f32_32x32x16_bf16 v[112:127], a[80:83], v[176:179], v[112:127]
    v_mfma_f32_32x32x16_bf16 v[88:103], a[84:87], v[176:179], v[88:103]
    s_add_u32 s20, s50, 45056
    s_and_b32 s20, s20, 0xffff
    s_add_u32 s20, s20, s41
    buffer_load_dwordx4 v[224:227], v19, s[84:87], s20 offen offset:0 sc1
    s_waitcnt vmcnt(11)
    v_mfma_f32_32x32x16_bf16 v[112:127], a[88:91], v[180:183], v[112:127]
    v_mfma_f32_32x32x16_bf16 v[88:103], a[92:95], v[180:183], v[88:103]
    buffer_load_dwordx4 v[228:231], v19, s[84:87], s20 offen offset:2048 sc1
    s_waitcnt vmcnt(11)
    v_mfma_f32_32x32x16_bf16 v[112:127], a[96:99], v[184:187], v[112:127]
    v_mfma_f32_32x32x16_bf16 v[88:103], a[100:103], v[184:187], v[88:103]
    s_add_u32 s20, s50, 49152
    s_and_b32 s20, s20, 0xffff
    s_add_u32 s20, s20, s41
    buffer_load_dwordx4 v[232:235], v19, s[84:87], s20 offen offset:0 sc1
    s_waitcnt vmcnt(11)
    v_mfma_f32_32x32x16_bf16 v[112:127], a[104:107], v[188:191], v[112:127]
    v_mfma_f32_32x32x16_bf16 v[88:103], a[108:111], v[188:191], v[88:103]
    buffer_load_dwordx4 v[236:239], v19, s[84:87], s20 offen offset:2048 sc1
    s_waitcnt vmcnt(11)
    v_mfma_f32_32x32x16_bf16 v[112:127], a[112:115], v[192:195], v[112:127]
    v_mfma_f32_32x32x16_bf16 v[88:103], a[116:119], v[192:195], v[88:103]
    s_add_u32 s20, s50, 53248
    s_and_b32 s20, s20, 0xffff
    s_add_u32 s20, s20, s41
    buffer_load_dwordx4 v[240:243], v19, s[84:87], s20 offen offset:0 sc1
    s_waitcnt vmcnt(11)
    v_mfma_f32_32x32x16_bf16 v[112:127], a[120:123], v[196:199], v[112:127]
    v_mfma_f32_32x32x16_bf16 v[88:103], a[124:127], v[196:199], v[88:103]
    buffer_load_dwordx4 v[244:247], v19, s[84:87], s20 offen offset:2048 sc1
    s_waitcnt vmcnt(11)
    v_mfma_f32_32x32x16_bf16 v[112:127], a[128:131], v[200:203], v[112:127]
    v_mfma_f32_32x32x16_bf16 v[88:103], a[132:135], v[200:203], v[88:103]
    s_add_u32 s20, s50, 57344
    s_and_b32 s20, s20, 0xffff
    s_add_u32 s20, s20, s41
    buffer_load_dwordx4 v[248:251], v19, s[84:87], s20 offen offset:0 sc1
    s_waitcnt vmcnt(11)
    v_mfma_f32_32x32x16_bf16 v[112:127], a[136:139], v[204:207], v[112:127]
    v_mfma_f32_32x32x16_bf16 v[88:103], a[140:143], v[204:207], v[88:103]
    buffer_load_dwordx4 v[252:255], v19, s[84:87], s20 offen offset:2048 sc1
    s_waitcnt vmcnt(11)
    v_mfma_f32_32x32x16_bf16 v[112:127], a[144:147], v[208:211], v[112:127]
    v_mfma_f32_32x32x16_bf16 v[88:103], a[148:151], v[208:211], v[88:103]
    s_add_u32 s20, s50, 61440
    s_and_b32 s20, s20, 0xffff
    s_add_u32 s20, s20, s41
    buffer_load_dwordx4 v[136:139], v19, s[84:87], s20 offen offset:0 sc1
    s_waitcnt vmcnt(11)
    v_mfma_f32_32x32x16_bf16 v[112:127], a[152:155], v[212:215], v[112:127]
    v_mfma_f32_32x32x16_bf16 v[88:103], a[156:159], v[212:215], v[88:103]
    buffer_load_dwordx4 v[140:143], v19, s[84:87], s20 offen offset:2048 sc1
    s_waitcnt vmcnt(11)
    v_mfma_f32_32x32x16_bf16 v[112:127], a[160:163], v[216:219], v[112:127]
    v_mfma_f32_32x32x16_bf16 v[88:103], a[164:167], v[216:219], v[88:103]
    s_waitcnt vmcnt(10)
    v_mfma_f32_32x32x16_bf16 v[112:127], a[168:171], v[220:223], v[112:127]
    v_mfma_f32_32x32x16_bf16 v[88:103], a[172:175], v[220:223], v[88:103]
    s_waitcnt vmcnt(9)
    v_mfma_f32_32x32x16_bf16 v[112:127], a[176:179], v[224:227], v[112:127]
    v_mfma_f32_32x32x16_bf16 v[88:103], a[180:183], v[224:227], v[88:103]
    s_waitcnt vmcnt(8)
    v_mfma_f32_32x32x16_bf16 v[112:127], a[184:187], v[228:231], v[112:127]
    v_mfma_f32_32x32x16_bf16 v[88:103], a[188:191], v[228:231], v[88:103]
    s_waitcnt vmcnt(7)
    v_mfma_f32_32x32x16_bf16 v[112:127], a[192:195], v[232:235], v[112:127]
    v_mfma_f32_32x32x16_bf16 v[88:103], a[196:199], v[232:235], v[88:103]
    s_waitcnt vmcnt(6)
    v_mfma_f32_32x32x16_bf16 v[112:127], a[200:203], v[236:239], v[112:127]
    v_mfma_f32_32x32x16_bf16 v[88:103], a[204:207], v[236:239], v[88:103]
    s_waitcnt vmcnt(5)
    v_mfma_f32_32x32x16_bf16 v[112:127], a[208:211], v[240:243], v[112:127]
    v_mfma_f32_32x32x16_bf16 v[88:103], a[212:215], v[240:243], v[88:103]
    s_waitcnt vmcnt(4)
    v_mfma_f32_32x32x16_bf16 v[112:127], a[216:219], v[244:247], v[112:127]
    v_mfma_f32_32x32x16_bf16 v[88:103], a[220:223], v[244:247], v[88:103]
    s_waitcnt vmcnt(3)
    v_mfma_f32_32x32x16_bf16 v[112:127], a[224:227], v[248:251], v[112:127]
    v_mfma_f32_32x32x16_bf16 v[88:103], a[228:231], v[248:251], v[88:103]
    s_waitcnt vmcnt(2)
    v_mfma_f32_32x32x16_bf16 v[112:127], a[232:235], v[252:255], v[112:127]
    v_mfma_f32_32x32x16_bf16 v[88:103], a[236:239], v[252:255], v[88:103]
    s_waitcnt vmcnt(1)
    v_mfma_f32_32x32x16_bf16 v[112:127], a[240:243], v[136:139], v[112:127]
    v_mfma_f32_32x32x16_bf16 v[88:103], a[244:247], v[136:139], v[88:103]
    s_waitcnt vmcnt(0)
    v_mfma_f32_32x32x16_bf16 v[112:127], a[248:251], v[140:143], v[112:127]
    v_mfma_f32_32x32x16_bf16 v[88:103], a[252:255], v[140:143], v[88:103]
    s_mov_b32 vcc_lo, 0xffff0000
    s_mov_b32 vcc_hi, 0xffff0000
    s_nop 9
    v_cndmask_b32 v112, v112, v88, vcc
    v_cndmask_b32 v113, v113, v89, vcc
    v_cndmask_b32 v114, v114, v90, vcc
    v_cndmask_b32 v115, v115, v91, vcc
    v_cndmask_b32 v116, v116, v92, vcc
    v_cndmask_b32 v117, v117, v93, vcc
    v_cndmask_b32 v118, v118, v94, vcc
    v_cndmask_b32 v119, v119, v95, vcc
    v_cndmask_b32 v120, v120, v96, vcc
    v_cndmask_b32 v121, v121, v97, vcc
    v_cndmask_b32 v122, v122, v98, vcc
    v_cndmask_b32 v123, v123, v99, vcc
    v_cndmask_b32 v124, v124, v100, vcc
    v_cndmask_b32 v125, v125, v101, vcc
    v_cndmask_b32 v126, v126, v102, vcc
    v_cndmask_b32 v127, v127, v103, vcc
    ds_write_b128 v17, v[112:115] offset:0
    ds_write_b128 v17, v[116:119] offset:1024
    ds_write_b128 v17, v[120:123] offset:2048
    ds_write_b128 v17, v[124:127] offset:3072
    s_waitcnt lgkmcnt(0)
    s_barrier
    s_cmp_ge_u32 s16, 2
    s_cbranch_scc1 mega_kernel_x_nxt
    ds_read_b128 v[112:115], v16 offset:0
    ds_read_b128 v[88:91], v16 offset:256
    ds_read_b128 v[116:119], v16 offset:4096
    ds_read_b128 v[92:95], v16 offset:4352
    ds_read_b128 v[120:123], v16 offset:8192
    ds_read_b128 v[96:99], v16 offset:8448
    ds_read_b128 v[124:127], v16 offset:12288
    ds_read_b128 v[100:103], v16 offset:12544
    s_and_b32 s20, s17, 1
    s_lshl_b32 s20, s20, 16
    s_add_u32 s42, s42, s20
    s_waitcnt lgkmcnt(0)
    v_pk_add_f32 v[112:113], v[112:113], v[88:89]
    v_pk_add_f32 v[114:115], v[114:115], v[90:91]
    v_pk_add_f32 v[116:117], v[116:117], v[92:93]
    v_pk_add_f32 v[118:119], v[118:119], v[94:95]
    v_pk_add_f32 v[120:121], v[120:121], v[96:97]
    v_pk_add_f32 v[122:123], v[122:123], v[98:99]
    v_pk_add_f32 v[124:125], v[124:125], v[100:101]
    v_pk_add_f32 v[126:127], v[126:127], v[102:103]
    v_pk_add_f32 v[112:113], v[112:113], v[116:117]
    v_pk_add_f32 v[114:115], v[114:115], v[118:119]
    v_pk_add_f32 v[120:121], v[120:121], v[124:125]
    v_pk_add_f32 v[122:123], v[122:123], v[126:127]
    v_pk_add_f32 v[112:113], v[112:113], v[120:121]
    v_pk_add_f32 v[114:115], v[114:115], v[122:123]
    v_cvt_pk_bf16_f32 v132, v112, v113
    v_cvt_pk_bf16_f32 v133, v114, v115
    buffer_store_dwordx2 v[132:133], v18, s[12:15], s42 offen
mega_kernel_x_nxt:
    s_cmp_eq_u32 s46, 1
    s_cbranch_scc1 mega_kernel_x_att
    s_cmp_lt_u32 s22, 64
    s_cbranch_scc1 mega_kernel_x_ldq
    s_endpgm
.section .rodata,"a"
.p2align 6
.amdhsa_kernel mega_kernel
  .amdhsa_next_free_vgpr 512
  .amdhsa_next_free_sgpr 102
  .amdhsa_accum_offset 256
  .amdhsa_group_segment_fixed_size 0
  .amdhsa_kernarg_size 104
  .amdhsa_user_sgpr_count 2
  .amdhsa_user_sgpr_kernarg_segment_ptr 1
  .amdhsa_system_sgpr_workgroup_id_x 1
.end_amdhsa_kernel
```

```asm
; @launch kernel=mega_kernel grid=(256,1,1) block=(256,1,1) lds=161792
.amdgcn_target "amdgcn-amd-amdhsa--gfx950"
.text
.globl mega_kernel
.p2align 8
.type mega_kernel,@function
mega_kernel:
    s_cmp_ge_u32 s2, 256
    s_cbranch_scc1 mega_kernel_exit
    s_load_dwordx2 s[84:85], s[0:1], 96
    s_load_dwordx2 s[88:89], s[0:1], 88
    s_getreg_b32 s93, hwreg(HW_REG_XCC_ID)
    s_and_b32 s93, s93, 7
    s_lshl_b32 s93, s93, 2
    s_lshr_b32 s93, 0x76543210, s93
    s_and_b32 s93, s93, 7
    v_lshrrev_b32 v1, 6, v0
    v_mov_b32 v4, 0
    v_readfirstlane_b32 s80, v1
    v_mov_b32 v5, 0
    v_mov_b32 v6, 0
    v_mov_b32 v7, 0
    s_mov_b32 s83, 0
    s_lshl_b32 s101, s2, 2
    s_add_u32 s101, s101, s80
    s_lshl_b32 s101, s101, 8
    s_add_u32 s101, s101, 230686720
    s_waitcnt lgkmcnt(0)
    s_mov_b32 s86, 268435456
    s_mov_b32 s87, 0x00020000
    s_mov_b32 s90, 256
    s_mov_b32 s91, 0x00020000
    s_mov_b32 s98, s80
    s_cmp_lg_u32 s80, 0
    s_cbranch_scc1 mega_kernel_st0
    v_mov_b32 v10, 1
    s_lshl_b32 s81, s93, 5
    s_mov_b64 exec, 1
    buffer_atomic_add v10, off, s[88:91], s81 offset:4 sc0
    s_lshl_b32 s81, s2, 7
    s_add_u32 s81, s81, 71303168
    s_mov_b64 exec, 3
    v_lshlrev_b32 v1, 15, v0
    buffer_store_dword v4, v1, s[84:87], s81 offen sc1
    s_mov_b64 exec, -1
mega_kernel_st0:
    s_load_dwordx2 s[72:73], s[0:1], 8
    v_mov_b32 v4, 0
    v_mov_b32 v5, 0
    v_mov_b32 v6, 0
    v_mov_b32 v7, 0
    v_lshlrev_b32 v1, 4, v0
    s_lshl_b32 s81, s2, 13
    s_add_u32 s81, s81, 67108864
    s_add_u32 s79, s81, 4096
    buffer_store_dwordx4 v[4:7], v1, s[84:87], s81 offen sc1
    buffer_store_dwordx4 v[4:7], v1, s[84:87], s79 offen sc1
    s_lshl_b32 s81, s2, 12
    s_add_u32 s81, s81, 70254592
    buffer_store_dwordx4 v[4:7], v1, s[84:87], s81 offen sc1
    s_cmp_ge_u32 s2, 64
    s_cbranch_scc1 mega_kernel_gi
    v_bfe_u32 v2, v0, 3, 1
    v_lshlrev_b32 v2, 11, v2
    v_and_b32 v3, 3, v0
    v_lshl_add_u32 v2, v3, 5, v2
    v_bfe_u32 v3, v0, 4, 3
    v_lshl_add_u32 v2, v3, 2, v2
    v_bfe_u32 v3, v0, 2, 1
    v_lshl_add_u32 v2, v3, 1, v2
    s_lshr_b32 s81, s2, 2
    s_lshl_b32 s81, s81, 7
    s_and_b32 s79, s2, 3
    s_lshl_b32 s79, s79, 12
    s_add_u32 s81, s81, s79
    s_waitcnt lgkmcnt(0)
    s_mov_b32 s74, 16384
    s_mov_b32 s75, 0x00020000
    buffer_load_ushort v8, v2, s[72:75], s81 offen
    v_mov_b32 v9, -1
    v_and_b32 v1, 31, v0
    v_lshlrev_b32 v1, 1, v1
    v_bfe_u32 v3, v0, 5, 2
    v_lshl_add_u32 v1, v3, 8, v1
    v_lshrrev_b32 v3, 7, v0
    v_lshl_add_u32 v1, v3, 14, v1
    v_cmp_gt_u32 vcc, 128, v0
    s_lshr_b32 s81, s2, 2
    s_lshl_b32 s81, s81, 10
    s_and_b32 s79, s2, 3
    s_lshl_b32 s79, s79, 6
    s_add_u32 s81, s81, s79
    s_add_u32 s81, s81, 69206016
    s_waitcnt vmcnt(0)
    v_min_u32 v8, 0xfffe, v8
    v_cndmask_b32 v8, v9, v8, vcc
    buffer_store_short v8, v1, s[84:87], s81 offen sc1
mega_kernel_gi:
    s_waitcnt lgkmcnt(0)
    s_cmp_lg_u32 s80, 0
    s_cbranch_scc1 mega_kernel_st1
    s_mov_b64 exec, 1
    s_waitcnt vmcnt(4)
    ds_write_b32 v4, v10
    s_mov_b64 exec, -1
    s_waitcnt lgkmcnt(0)
mega_kernel_st1:
    s_barrier
    ds_read_b32 v2, v4
    s_waitcnt lgkmcnt(0)
    v_readfirstlane_b32 s94, v2
    s_barrier
    s_sub_u32 s81, s93, 2
    s_cmp_ge_u32 s81, 2
    s_cbranch_scc1 mega_kernel_nopr
    s_cmp_lg_u32 s80, 0
    s_cbranch_scc1 mega_kernel_prd
    v_lshlrev_b32 v1, 4, v0
    s_and_b32 s81, s2, 127
    s_lshl_b32 s81, s81, 14
    s_add_u32 s81, s81, 67108864
    s_add_u32 s77, s81, 8192
    buffer_store_dwordx4 v[4:7], v1, s[84:87], s81 offen sc1
    buffer_store_dwordx4 v[4:7], v1, s[84:87], s77 offen sc1
    s_waitcnt vmcnt(0)
    s_memtime s[70:71]
    buffer_store_dwordx4 v[4:7], v1, s[84:87], s81 offen sc1
    s_waitcnt vmcnt(0)
    s_memtime s[72:73]
    buffer_store_dwordx4 v[4:7], v1, s[84:87], s77 offen sc1
    s_waitcnt vmcnt(0)
    buffer_store_dwordx4 v[4:7], v1, s[84:87], s77 offen sc1
    s_waitcnt vmcnt(0)
    s_memtime s[74:75]
    buffer_store_dwordx4 v[4:7], v1, s[84:87], s81 offen sc1
    s_waitcnt vmcnt(0)
    s_memtime s[76:77]
    s_waitcnt lgkmcnt(0)
    s_sub_u32 s76, s76, s74
    s_sub_u32 s74, s74, s72
    s_sub_u32 s72, s72, s70
    s_add_u32 s72, s72, s76
    s_cmp_lt_u32 s74, s72
    s_cselect_b32 s81, 0x10001, 1
    v_mov_b32 v8, s81
    s_mov_b64 exec, 1
    buffer_atomic_add v8, off, s[88:91], 0 offset:204 sc1
    s_mov_b64 exec, -1
mega_kernel_prd:
    s_barrier
mega_kernel_nopr:
    s_mov_b32 s97, 0
    s_mov_b32 s100, 64
mega_kernel_fast:
    s_mov_b32 s96, 1
    s_mov_b32 s30, s93
    s_and_b32 s31, s94, 31
    s_cmp_lt_u32 s93, 2
    s_cbranch_scc1 mega_kernel_recf
    s_sub_u32 s92, s93, 2
    s_lshl_b32 s92, s92, 5
    s_add_u32 s92, s92, s31
    s_branch mega_kernel_bulk
mega_kernel_redo:
    s_waitcnt vmcnt(0) lgkmcnt(0)
    s_barrier
    v_readlane_b32 s100, v36, 2
    v_readlane_b32 s81, v36, 3
    s_mov_b32 s97, 1
    s_nop 2
    s_add_u32 s100, s100, s81
    s_mov_b32 s95, s94
    v_readlane_b32 s81, v36, 0
    s_cmp_gt_u32 s93, 0
    s_nop 2
    s_cselect_b32 s81, s81, 0
    s_add_u32 s95, s95, s81
    v_readlane_b32 s81, v36, 1
    s_cmp_gt_u32 s93, 1
    s_nop 2
    s_cselect_b32 s81, s81, 0
    s_add_u32 s95, s95, s81
    v_readlane_b32 s81, v36, 2
    s_cmp_gt_u32 s93, 2
    s_nop 2
    s_cselect_b32 s81, s81, 0
    s_add_u32 s95, s95, s81
    v_readlane_b32 s81, v36, 3
    s_cmp_gt_u32 s93, 3
    s_nop 2
    s_cselect_b32 s81, s81, 0
    s_add_u32 s95, s95, s81
    v_readlane_b32 s81, v36, 4
    s_cmp_gt_u32 s93, 4
    s_nop 2
    s_cselect_b32 s81, s81, 0
    s_add_u32 s95, s95, s81
    v_readlane_b32 s81, v36, 5
    s_cmp_gt_u32 s93, 5
    s_nop 2
    s_cselect_b32 s81, s81, 0
    s_add_u32 s95, s95, s81
    v_readlane_b32 s81, v36, 6
    s_cmp_gt_u32 s93, 6
    s_nop 2
    s_cselect_b32 s81, s81, 0
    s_add_u32 s95, s95, s81
mega_kernel_slow:
    s_mov_b32 s96, 0
    s_lshr_b32 s30, s95, 5
    s_and_b32 s31, s95, 31
    s_cmp_lt_u32 s95, 64
    s_cbranch_scc1 mega_kernel_recs
    s_sub_u32 s92, s95, 64
    s_branch mega_kernel_bulk
mega_kernel_exit:
    s_endpgm
mega_kernel_recf:
    s_load_dwordx2 s[4:5], s[0:1], 96
    s_load_dwordx2 s[12:13], s[0:1], 88
    s_load_dwordx2 s[50:51], s[0:1], 16
    s_load_dwordx2 s[52:53], s[0:1], 24
    s_load_dwordx2 s[54:55], s[0:1], 32
    s_load_dwordx2 s[56:57], s[0:1], 40
    s_load_dwordx2 s[58:59], s[0:1], 8
    v_lshrrev_b32 v3, 6, v0
    v_and_b32 v40, 63, v0
    v_readfirstlane_b32 s20, v3
    v_lshrrev_b32 v41, 4, v40
    v_and_b32 v42, 15, v40
    v_lshlrev_b32 v1, 4, v40
    s_mov_b32 s49, 0
    s_waitcnt lgkmcnt(0)
    s_mov_b32 s6, 268435456
    s_mov_b32 s7, 0x00020000
    s_mov_b32 s14, 256
    s_mov_b32 s15, 0x00020000
    s_mov_b32 s10, 8388608
    s_mov_b32 s11, 0x00020000
    s_mov_b32 s26, 0x00030003
    s_mov_b32 s27, 0x00030003
    s_mov_b32 s28, 0xcccccccc
    s_mov_b32 s29, 0xcccccccc
    s_mov_b32 s32, 0x33333333
    s_mov_b32 s33, 0x33333333
    s_mov_b32 s34, 0x3e0293ee
    s_lshl_b32 s22, s20, 2
    v_xor_b32 v3, s22, v42
    v_lshlrev_b32 v3, 4, v3
    v_lshl_add_u32 v4, v41, 4, s20
    v_lshl_add_u32 v44, v4, 13, v3
    s_lshl_b32 s22, s30, 22
    s_lshl_b32 s23, s31, 8
    s_add_u32 s22, s22, s23
    v_add_u32 v44, s22, v44
    s_lshr_b32 s22, s20, 1
    s_lshl_b32 s22, s22, 5
    s_and_b32 s23, s20, 1
    s_lshl_b32 s23, s23, 2
    s_add_u32 s22, s22, s23
    s_lshl_b32 s23, s31, 7
    s_add_u32 s22, s22, s23
    v_add_u32 v4, s22, v41
    v_lshl_add_u32 v45, v4, 11, v3
    s_lshl_b32 s22, s30, 10
    v_add_u32 v45, s22, v45
    s_lshl_b32 s48, s20, 10
    s_mov_b32 s8, s50
    s_mov_b32 s9, s51
    s_add_u32 m0, s48, 0
    s_mov_b32 s22, 0
    buffer_load_dwordx4 v44, s[8:11], s22 offen  lds
    s_add_u32 m0, s48, 4096
    s_mov_b32 s22, 32768
    buffer_load_dwordx4 v44, s[8:11], s22 offen  lds
    s_add_u32 m0, s48, 8192
    s_mov_b32 s22, 65536
    buffer_load_dwordx4 v44, s[8:11], s22 offen  lds
    s_add_u32 m0, s48, 12288
    s_mov_b32 s22, 98304
    buffer_load_dwordx4 v44, s[8:11], s22 offen  lds
    s_add_u32 m0, s48, 16384
    s_mov_b32 s22, 524288
    buffer_load_dwordx4 v44, s[8:11], s22 offen  lds
    s_add_u32 m0, s48, 20480
    s_mov_b32 s22, 557056
    buffer_load_dwordx4 v44, s[8:11], s22 offen  lds
    s_add_u32 m0, s48, 24576
    s_mov_b32 s22, 589824
    buffer_load_dwordx4 v44, s[8:11], s22 offen  lds
    s_add_u32 m0, s48, 28672
    s_mov_b32 s22, 622592
    buffer_load_dwordx4 v44, s[8:11], s22 offen  lds
    s_add_u32 m0, s48, 32768
    s_mov_b32 s22, 1048576
    buffer_load_dwordx4 v44, s[8:11], s22 offen  lds
    s_add_u32 m0, s48, 36864
    s_mov_b32 s22, 1081344
    buffer_load_dwordx4 v44, s[8:11], s22 offen  lds
    s_add_u32 m0, s48, 40960
    s_mov_b32 s22, 1114112
    buffer_load_dwordx4 v44, s[8:11], s22 offen  lds
    s_add_u32 m0, s48, 45056
    s_mov_b32 s22, 1146880
    buffer_load_dwordx4 v44, s[8:11], s22 offen  lds
    s_waitcnt vmcnt(12)
    s_barrier
    s_or_b32 s81, s97, s98
    s_cmp_lg_u32 s81, 0
    s_cbranch_scc1 mega_kernel_h0_1
    s_lshl_b32 s81, s93, 5
    v_mov_b32 v38, 1
    s_mov_b64 exec, 1
    buffer_atomic_add v38, off, s[88:91], s81 sc1
    s_mov_b64 exec, -1
mega_kernel_h0_1:
    s_add_u32 m0, s48, 49152
    s_mov_b32 s22, 1572864
    buffer_load_dwordx4 v44, s[8:11], s22 offen  lds
    s_add_u32 m0, s48, 53248
    s_mov_b32 s22, 1605632
    buffer_load_dwordx4 v44, s[8:11], s22 offen  lds
    s_add_u32 m0, s48, 57344
    s_mov_b32 s22, 1638400
    buffer_load_dwordx4 v44, s[8:11], s22 offen  lds
    s_add_u32 m0, s48, 61440
    s_mov_b32 s22, 1671168
    buffer_load_dwordx4 v44, s[8:11], s22 offen  lds
    s_add_u32 m0, s48, 65536
    s_mov_b32 s22, 2097152
    buffer_load_dwordx4 v44, s[8:11], s22 offen  lds
    s_add_u32 m0, s48, 69632
    s_mov_b32 s22, 2129920
    buffer_load_dwordx4 v44, s[8:11], s22 offen  lds
    s_add_u32 m0, s48, 73728
    s_mov_b32 s22, 2162688
    buffer_load_dwordx4 v44, s[8:11], s22 offen  lds
    s_add_u32 m0, s48, 77824
    s_mov_b32 s22, 2195456
    buffer_load_dwordx4 v44, s[8:11], s22 offen  lds
    s_add_u32 m0, s48, 81920
    s_mov_b32 s22, 2621440
    buffer_load_dwordx4 v44, s[8:11], s22 offen  lds
    s_add_u32 m0, s48, 86016
    s_mov_b32 s22, 2654208
    buffer_load_dwordx4 v44, s[8:11], s22 offen  lds
    s_add_u32 m0, s48, 90112
    s_mov_b32 s22, 2686976
    buffer_load_dwordx4 v44, s[8:11], s22 offen  lds
    s_add_u32 m0, s48, 94208
    s_mov_b32 s22, 2719744
    buffer_load_dwordx4 v44, s[8:11], s22 offen  lds
    s_add_u32 m0, s48, 98304
    s_mov_b32 s22, 3145728
    buffer_load_dwordx4 v44, s[8:11], s22 offen  lds
    s_add_u32 m0, s48, 102400
    s_mov_b32 s22, 3178496
    buffer_load_dwordx4 v44, s[8:11], s22 offen  lds
    s_add_u32 m0, s48, 106496
    s_mov_b32 s22, 3211264
    buffer_load_dwordx4 v44, s[8:11], s22 offen  lds
    s_add_u32 m0, s48, 110592
    s_mov_b32 s22, 3244032
    buffer_load_dwordx4 v44, s[8:11], s22 offen  lds
    s_add_u32 m0, s48, 114688
    s_mov_b32 s22, 3670016
    buffer_load_dwordx4 v44, s[8:11], s22 offen  lds
    s_add_u32 m0, s48, 118784
    s_mov_b32 s22, 3702784
    buffer_load_dwordx4 v44, s[8:11], s22 offen  lds
    s_add_u32 m0, s48, 122880
    s_mov_b32 s22, 3735552
    buffer_load_dwordx4 v44, s[8:11], s22 offen  lds
    s_add_u32 m0, s48, 126976
    s_mov_b32 s22, 3768320
    buffer_load_dwordx4 v44, s[8:11], s22 offen  lds
    s_lshl_b32 s22, s30, 5
    s_add_u32 s22, s22, s31
    s_lshl_b32 s38, s22, 14
    s_xor_b32 s22, s22, 32
    s_lshl_b32 s37, s22, 14
    s_add_u32 s38, s38, 67108864
    s_add_u32 s37, s37, 67108864
    s_lshl_b32 s46, s30, 19
    s_add_u32 s46, s46, 70254592
    s_mul_i32 s22, s31, 8448
    s_add_u32 s47, s46, s22
    s_mul_i32 s22, s20, 67584
    s_add_u32 s46, s46, s22
    s_lshl_b32 s22, s31, 6
    s_add_u32 s46, s46, s22
    s_add_u32 s61, s46, 33792
    s_mul_i32 s22, s20, 2048
    s_add_u32 s25, s47, s22
    s_lshl_b32 s35, s30, 13
    s_add_u32 s35, s35, 69206016
    v_lshrrev_b32 v53, 2, v42
    v_lshlrev_b32 v53, 1, v53
    v_and_b32 v54, 1, v42
    v_add_u32 v55, v53, v54
    v_mov_b32 v14, 0
    v_mov_b32 v15, 0
    v_mov_b32 v2, 0x4444
    v_mov_b32 v3, 0xeeee
    v_cndmask_b32 v2, v2, v3, s[28:29]
    s_lshl_b32 s22, s20, 12
    v_add_u32 v32, s22, v1
    v_add_u32 v33, 0x10000, v32
    v_add_u32 v5, 0x10000, v1
    v_add_u32 v6, 131072, v1
    v_and_b32 v3, 3, v42
    v_bfe_u32 v43, v40, 1, 1
    v_lshlrev_b32 v7, 13, v43
    v_and_b32 v43, 1, v40
    v_lshl_add_u32 v7, v43, 7, v7
    s_lshl_b32 s22, s31, 8
    s_add_u32 s23, s22, 71311360
    v_add_u32 v7, s23, v7
    s_cmp_lg_u32 s20, 0
    s_cbranch_scc1 mega_kernel_rf_flk
    s_lshl_b32 s23, s30, 7
    s_add_u32 s22, s22, s23
    s_add_u32 s22, s22, 71327744
    v_bfrev_b32 v7, 1
    v_writelane_b32 v7, s22, 0
mega_kernel_rf_flk:
    v_lshlrev_b32 v11, 3, v40
    v_lshlrev_b32 v10, 8, v55
    v_lshl_add_u32 v10, v41, 4, v10
    v_mul_u32_u24 v8, 8448, v41
    v_lshl_add_u32 v8, v3, 4, v8
    v_lshrrev_b32 v4, 2, v42
    v_mul_u32_u24 v4, 2048, v4
    v_add_u32 v8, v4, v8
    v_lshrrev_b32 v9, 1, v41
    v_lshlrev_b32 v9, 5, v9
    v_and_b32 v4, 1, v42
    v_lshl_add_u32 v9, v4, 4, v9
    v_and_b32 v4, 1, v41
    v_lshl_add_u32 v9, v4, 3, v9
    s_lshr_b32 s22, s31, 2
    s_lshl_b32 s22, s22, 10
    s_and_b32 s23, s31, 3
    s_lshl_b32 s23, s23, 6
    s_add_u32 s22, s22, s23
    v_add_u32 v9, s22, v9
    v_lshrrev_b32 v4, 2, v42
    v_lshlrev_b32 v12, 8, v4
    v_lshl_add_u32 v12, v41, 6, v12
    v_lshl_add_u32 v12, v3, 4, v12
    v_lshlrev_b32 v13, 6, v41
    v_lshl_add_u32 v13, v42, 2, v13
    v_cmp_eq_u32 vcc, 0, v3
    v_mov_b32 v28, 0x3f803f80
    v_mov_b32 v29, 0x3f803f80
    v_cndmask_b32 v34, 0, 1, vcc
    v_mov_b32 v30, 0x3f803f80
    v_mov_b32 v31, 0x3f803f80
    v_and_b32 v49, 1, v42
    v_lshlrev_b32 v49, 4, v49
    v_mov_b32 v50, 0x3f80
    v_lshlrev_b32 v50, v49, v50
    v_lshrrev_b32 v51, 2, v42
    v_cmp_eq_u32 vcc, v51, v41
    v_mov_b32 v24, v50
    v_cndmask_b32 v52, 0, v50, s[28:29]
    v_cndmask_b32 v53, 0, v50, s[32:33]
    v_cndmask_b32 v16, 0, v52, vcc
    v_cndmask_b32 v17, 0, v53, vcc
    v_mov_b32 v25, v50
    v_mov_b32 v26, v50
    v_mov_b32 v27, v50
    v_bfe_u32 v60, v40, 3, 1
    v_bfe_u32 v49, v40, 2, 1
    v_and_b32 v50, 1, v41
    v_lshrrev_b32 v51, 1, v41
    v_lshlrev_b32 v52, 3, v60
    v_lshl_add_u32 v52, v50, 2, v52
    v_lshl_add_u32 v53, v51, 4, v52
    v_add_u32 v53, v53, v49
    v_and_b32 v54, 3, v40
    s_lshl_b32 s22, s20, 2
    v_add_u32 v55, s22, v54
    v_xor_b32 v55, v55, v52
    v_lshlrev_b32 v55, 4, v55
    v_lshl_add_u32 v46, v53, 8, v55
    v_lshlrev_b32 v55, 4, v52
    v_lshl_add_u32 v55, v54, 3, v55
    v_lshl_add_u32 v47, v53, 8, v55
    s_waitcnt vmcnt(28)
    s_barrier
    v_add_u32 v48, 0, v46
    ds_read_b64_tr_b16 a[0:1], v48 offset:0
    ds_read_b64_tr_b16 a[2:3], v48 offset:512
    ds_read_b64_tr_b16 a[4:5], v48 offset:8192
    ds_read_b64_tr_b16 a[6:7], v48 offset:8704
    ds_read_b64_tr_b16 a[8:9], v48 offset:8
    ds_read_b64_tr_b16 a[10:11], v48 offset:520
    ds_read_b64_tr_b16 a[12:13], v48 offset:8200
    ds_read_b64_tr_b16 a[14:15], v48 offset:8712
    s_waitcnt lgkmcnt(0)
    s_barrier
    s_mov_b32 s8, s52
    s_mov_b32 s9, s53
    s_add_u32 m0, s48, 0
    s_mov_b32 s22, 0
    buffer_load_dwordx4 v44, s[8:11], s22 offen  lds
    s_add_u32 m0, s48, 4096
    s_mov_b32 s22, 32768
    buffer_load_dwordx4 v44, s[8:11], s22 offen  lds
    s_add_u32 m0, s48, 8192
    s_mov_b32 s22, 65536
    buffer_load_dwordx4 v44, s[8:11], s22 offen  lds
    s_add_u32 m0, s48, 12288
    s_mov_b32 s22, 98304
    buffer_load_dwordx4 v44, s[8:11], s22 offen  lds
    s_waitcnt vmcnt(28)
    s_barrier
    v_add_u32 v48, 16384, v46
    ds_read_b64_tr_b16 a[16:17], v48 offset:0
    ds_read_b64_tr_b16 a[18:19], v48 offset:512
    ds_read_b64_tr_b16 a[20:21], v48 offset:8192
    ds_read_b64_tr_b16 a[22:23], v48 offset:8704
    ds_read_b64_tr_b16 a[24:25], v48 offset:8
    ds_read_b64_tr_b16 a[26:27], v48 offset:520
    ds_read_b64_tr_b16 a[28:29], v48 offset:8200
    ds_read_b64_tr_b16 a[30:31], v48 offset:8712
    s_waitcnt lgkmcnt(0)
    s_barrier
    s_add_u32 m0, s48, 16384
    s_mov_b32 s22, 524288
    buffer_load_dwordx4 v44, s[8:11], s22 offen  lds
    s_add_u32 m0, s48, 20480
    s_mov_b32 s22, 557056
    buffer_load_dwordx4 v44, s[8:11], s22 offen  lds
    s_add_u32 m0, s48, 24576
    s_mov_b32 s22, 589824
    buffer_load_dwordx4 v44, s[8:11], s22 offen  lds
    s_add_u32 m0, s48, 28672
    s_mov_b32 s22, 622592
    buffer_load_dwordx4 v44, s[8:11], s22 offen  lds
    s_waitcnt vmcnt(28)
    s_barrier
    v_add_u32 v48, 32768, v46
    ds_read_b64_tr_b16 a[32:33], v48 offset:0
    ds_read_b64_tr_b16 a[34:35], v48 offset:512
    ds_read_b64_tr_b16 a[36:37], v48 offset:8192
    ds_read_b64_tr_b16 a[38:39], v48 offset:8704
    ds_read_b64_tr_b16 a[40:41], v48 offset:8
    ds_read_b64_tr_b16 a[42:43], v48 offset:520
    ds_read_b64_tr_b16 a[44:45], v48 offset:8200
    ds_read_b64_tr_b16 a[46:47], v48 offset:8712
    s_waitcnt lgkmcnt(0)
    s_barrier
    s_add_u32 m0, s48, 32768
    s_mov_b32 s22, 1048576
    buffer_load_dwordx4 v44, s[8:11], s22 offen  lds
    s_add_u32 m0, s48, 36864
    s_mov_b32 s22, 1081344
    buffer_load_dwordx4 v44, s[8:11], s22 offen  lds
    s_add_u32 m0, s48, 40960
    s_mov_b32 s22, 1114112
    buffer_load_dwordx4 v44, s[8:11], s22 offen  lds
    s_add_u32 m0, s48, 45056
    s_mov_b32 s22, 1146880
    buffer_load_dwordx4 v44, s[8:11], s22 offen  lds
    s_waitcnt vmcnt(28)
    s_barrier
    v_add_u32 v48, 49152, v46
    ds_read_b64_tr_b16 a[48:49], v48 offset:0
    ds_read_b64_tr_b16 a[50:51], v48 offset:512
    ds_read_b64_tr_b16 a[52:53], v48 offset:8192
    ds_read_b64_tr_b16 a[54:55], v48 offset:8704
    ds_read_b64_tr_b16 a[56:57], v48 offset:8
    ds_read_b64_tr_b16 a[58:59], v48 offset:520
    ds_read_b64_tr_b16 a[60:61], v48 offset:8200
    ds_read_b64_tr_b16 a[62:63], v48 offset:8712
    s_waitcnt lgkmcnt(0)
    s_barrier
    s_add_u32 m0, s48, 49152
    s_mov_b32 s22, 1572864
    buffer_load_dwordx4 v44, s[8:11], s22 offen  lds
    s_add_u32 m0, s48, 53248
    s_mov_b32 s22, 1605632
    buffer_load_dwordx4 v44, s[8:11], s22 offen  lds
    s_add_u32 m0, s48, 57344
    s_mov_b32 s22, 1638400
    buffer_load_dwordx4 v44, s[8:11], s22 offen  lds
    s_add_u32 m0, s48, 61440
    s_mov_b32 s22, 1671168
    buffer_load_dwordx4 v44, s[8:11], s22 offen  lds
    s_waitcnt vmcnt(28)
    s_barrier
    v_add_u32 v48, 65536, v46
    ds_read_b64_tr_b16 a[64:65], v48 offset:0
    ds_read_b64_tr_b16 a[66:67], v48 offset:512
    ds_read_b64_tr_b16 a[68:69], v48 offset:8192
    ds_read_b64_tr_b16 a[70:71], v48 offset:8704
    ds_read_b64_tr_b16 a[72:73], v48 offset:8
    ds_read_b64_tr_b16 a[74:75], v48 offset:520
    ds_read_b64_tr_b16 a[76:77], v48 offset:8200
    ds_read_b64_tr_b16 a[78:79], v48 offset:8712
    s_waitcnt lgkmcnt(0)
    s_barrier
    s_add_u32 m0, s48, 65536
    s_mov_b32 s22, 2097152
    buffer_load_dwordx4 v44, s[8:11], s22 offen  lds
    s_add_u32 m0, s48, 69632
    s_mov_b32 s22, 2129920
    buffer_load_dwordx4 v44, s[8:11], s22 offen  lds
    s_add_u32 m0, s48, 73728
    s_mov_b32 s22, 2162688
    buffer_load_dwordx4 v44, s[8:11], s22 offen  lds
    s_add_u32 m0, s48, 77824
    s_mov_b32 s22, 2195456
    buffer_load_dwordx4 v44, s[8:11], s22 offen  lds
    s_waitcnt vmcnt(28)
    s_barrier
    v_add_u32 v48, 81920, v46
    ds_read_b64_tr_b16 a[80:81], v48 offset:0
    ds_read_b64_tr_b16 a[82:83], v48 offset:512
    ds_read_b64_tr_b16 a[84:85], v48 offset:8192
    ds_read_b64_tr_b16 a[86:87], v48 offset:8704
    ds_read_b64_tr_b16 a[88:89], v48 offset:8
    ds_read_b64_tr_b16 a[90:91], v48 offset:520
    ds_read_b64_tr_b16 a[92:93], v48 offset:8200
    ds_read_b64_tr_b16 a[94:95], v48 offset:8712
    s_waitcnt lgkmcnt(0)
    s_barrier
    s_add_u32 m0, s48, 81920
    s_mov_b32 s22, 2621440
    buffer_load_dwordx4 v44, s[8:11], s22 offen  lds
    s_add_u32 m0, s48, 86016
    s_mov_b32 s22, 2654208
    buffer_load_dwordx4 v44, s[8:11], s22 offen  lds
    s_add_u32 m0, s48, 90112
    s_mov_b32 s22, 2686976
    buffer_load_dwordx4 v44, s[8:11], s22 offen  lds
    s_add_u32 m0, s48, 94208
    s_mov_b32 s22, 2719744
    buffer_load_dwordx4 v44, s[8:11], s22 offen  lds
    s_waitcnt vmcnt(28)
    s_barrier
    v_add_u32 v48, 98304, v46
    ds_read_b64_tr_b16 a[96:97], v48 offset:0
    ds_read_b64_tr_b16 a[98:99], v48 offset:512
    ds_read_b64_tr_b16 a[100:101], v48 offset:8192
    ds_read_b64_tr_b16 a[102:103], v48 offset:8704
    ds_read_b64_tr_b16 a[104:105], v48 offset:8
    ds_read_b64_tr_b16 a[106:107], v48 offset:520
    ds_read_b64_tr_b16 a[108:109], v48 offset:8200
    ds_read_b64_tr_b16 a[110:111], v48 offset:8712
    s_waitcnt lgkmcnt(0)
    s_barrier
    s_add_u32 m0, s48, 98304
    s_mov_b32 s22, 3145728
    buffer_load_dwordx4 v44, s[8:11], s22 offen  lds
    s_add_u32 m0, s48, 102400
    s_mov_b32 s22, 3178496
    buffer_load_dwordx4 v44, s[8:11], s22 offen  lds
    s_add_u32 m0, s48, 106496
    s_mov_b32 s22, 3211264
    buffer_load_dwordx4 v44, s[8:11], s22 offen  lds
    s_add_u32 m0, s48, 110592
    s_mov_b32 s22, 3244032
    buffer_load_dwordx4 v44, s[8:11], s22 offen  lds
    s_waitcnt vmcnt(28)
    s_barrier
    v_add_u32 v48, 114688, v46
    ds_read_b64_tr_b16 a[112:113], v48 offset:0
    ds_read_b64_tr_b16 a[114:115], v48 offset:512
    ds_read_b64_tr_b16 a[116:117], v48 offset:8192
    ds_read_b64_tr_b16 a[118:119], v48 offset:8704
    ds_read_b64_tr_b16 a[120:121], v48 offset:8
    ds_read_b64_tr_b16 a[122:123], v48 offset:520
    ds_read_b64_tr_b16 a[124:125], v48 offset:8200
    ds_read_b64_tr_b16 a[126:127], v48 offset:8712
    s_waitcnt lgkmcnt(0)
    s_barrier
    s_add_u32 m0, s48, 114688
    s_mov_b32 s22, 3670016
    buffer_load_dwordx4 v44, s[8:11], s22 offen  lds
    s_add_u32 m0, s48, 118784
    s_mov_b32 s22, 3702784
    buffer_load_dwordx4 v44, s[8:11], s22 offen  lds
    s_add_u32 m0, s48, 122880
    s_mov_b32 s22, 3735552
    buffer_load_dwordx4 v44, s[8:11], s22 offen  lds
    s_add_u32 m0, s48, 126976
    s_mov_b32 s22, 3768320
    buffer_load_dwordx4 v44, s[8:11], s22 offen  lds
    s_waitcnt vmcnt(28)
    s_barrier
    v_add_u32 v48, 0, v46
    ds_read_b64_tr_b16 a[128:129], v48 offset:0
    ds_read_b64_tr_b16 a[130:131], v48 offset:512
    ds_read_b64_tr_b16 a[132:133], v48 offset:8192
    ds_read_b64_tr_b16 a[134:135], v48 offset:8704
    ds_read_b64_tr_b16 a[136:137], v48 offset:8
    ds_read_b64_tr_b16 a[138:139], v48 offset:520
    ds_read_b64_tr_b16 a[140:141], v48 offset:8200
    ds_read_b64_tr_b16 a[142:143], v48 offset:8712
    s_waitcnt lgkmcnt(0)
    s_barrier
    s_mov_b32 s8, s56
    s_mov_b32 s9, s57
    s_add_u32 m0, s48, 0
    s_mov_b32 s22, 0
    buffer_load_dwordx4 v45, s[8:11], s22 offen  lds
    s_add_u32 m0, s48, 4096
    s_mov_b32 s22, 16384
    buffer_load_dwordx4 v45, s[8:11], s22 offen  lds
    s_add_u32 m0, s48, 8192
    s_mov_b32 s22, 32768
    buffer_load_dwordx4 v45, s[8:11], s22 offen  lds
    s_add_u32 m0, s48, 12288
    s_mov_b32 s22, 49152
    buffer_load_dwordx4 v45, s[8:11], s22 offen  lds
    s_waitcnt vmcnt(28)
    s_barrier
    v_add_u32 v48, 16384, v46
    ds_read_b64_tr_b16 a[144:145], v48 offset:0
    ds_read_b64_tr_b16 a[146:147], v48 offset:512
    ds_read_b64_tr_b16 a[148:149], v48 offset:8192
    ds_read_b64_tr_b16 a[150:151], v48 offset:8704
    ds_read_b64_tr_b16 a[152:153], v48 offset:8
    ds_read_b64_tr_b16 a[154:155], v48 offset:520
    ds_read_b64_tr_b16 a[156:157], v48 offset:8200
    ds_read_b64_tr_b16 a[158:159], v48 offset:8712
    s_waitcnt lgkmcnt(0)
    s_barrier
    s_add_u32 m0, s48, 16384
    s_mov_b32 s22, 256
    buffer_load_dwordx4 v45, s[8:11], s22 offen  lds
    s_add_u32 m0, s48, 20480
    s_mov_b32 s22, 16640
    buffer_load_dwordx4 v45, s[8:11], s22 offen  lds
    s_add_u32 m0, s48, 24576
    s_mov_b32 s22, 33024
    buffer_load_dwordx4 v45, s[8:11], s22 offen  lds
    s_add_u32 m0, s48, 28672
    s_mov_b32 s22, 49408
    buffer_load_dwordx4 v45, s[8:11], s22 offen  lds
    s_waitcnt vmcnt(28)
    s_barrier
    v_add_u32 v48, 32768, v46
    ds_read_b64_tr_b16 a[160:161], v48 offset:0
    ds_read_b64_tr_b16 a[162:163], v48 offset:512
    ds_read_b64_tr_b16 a[164:165], v48 offset:8192
    ds_read_b64_tr_b16 a[166:167], v48 offset:8704
    ds_read_b64_tr_b16 a[168:169], v48 offset:8
    ds_read_b64_tr_b16 a[170:171], v48 offset:520
    ds_read_b64_tr_b16 a[172:173], v48 offset:8200
    ds_read_b64_tr_b16 a[174:175], v48 offset:8712
    s_waitcnt lgkmcnt(0)
    s_barrier
    s_add_u32 m0, s48, 32768
    s_mov_b32 s22, 512
    buffer_load_dwordx4 v45, s[8:11], s22 offen  lds
    s_add_u32 m0, s48, 36864
    s_mov_b32 s22, 16896
    buffer_load_dwordx4 v45, s[8:11], s22 offen  lds
    s_add_u32 m0, s48, 40960
    s_mov_b32 s22, 33280
    buffer_load_dwordx4 v45, s[8:11], s22 offen  lds
    s_add_u32 m0, s48, 45056
    s_mov_b32 s22, 49664
    buffer_load_dwordx4 v45, s[8:11], s22 offen  lds
    s_waitcnt vmcnt(28)
    s_barrier
    v_add_u32 v48, 49152, v46
    ds_read_b64_tr_b16 a[176:177], v48 offset:0
    ds_read_b64_tr_b16 a[178:179], v48 offset:512
    ds_read_b64_tr_b16 a[180:181], v48 offset:8192
    ds_read_b64_tr_b16 a[182:183], v48 offset:8704
    ds_read_b64_tr_b16 a[184:185], v48 offset:8
    ds_read_b64_tr_b16 a[186:187], v48 offset:520
    ds_read_b64_tr_b16 a[188:189], v48 offset:8200
    ds_read_b64_tr_b16 a[190:191], v48 offset:8712
    s_waitcnt lgkmcnt(0)
    s_barrier
    s_add_u32 m0, s48, 49152
    s_mov_b32 s22, 768
    buffer_load_dwordx4 v45, s[8:11], s22 offen  lds
    s_add_u32 m0, s48, 53248
    s_mov_b32 s22, 17152
    buffer_load_dwordx4 v45, s[8:11], s22 offen  lds
    s_add_u32 m0, s48, 57344
    s_mov_b32 s22, 33536
    buffer_load_dwordx4 v45, s[8:11], s22 offen  lds
    s_add_u32 m0, s48, 61440
    s_mov_b32 s22, 49920
    buffer_load_dwordx4 v45, s[8:11], s22 offen  lds
    s_waitcnt vmcnt(28)
    s_barrier
    v_and_b32 v37, 7, v0
    v_lshlrev_b32 v37, 5, v37
    buffer_load_dword v36, v37, s[88:91], 0 offen sc1
    buffer_load_dword v58, off, s[12:15], 0 offset:204 sc1
    v_add_u32 v48, 65536, v46
    ds_read_b64_tr_b16 a[192:193], v48 offset:0
    ds_read_b64_tr_b16 a[194:195], v48 offset:512
    ds_read_b64_tr_b16 a[196:197], v48 offset:8192
    ds_read_b64_tr_b16 a[198:199], v48 offset:8704
    ds_read_b64_tr_b16 a[200:201], v48 offset:8
    ds_read_b64_tr_b16 a[202:203], v48 offset:520
    ds_read_b64_tr_b16 a[204:205], v48 offset:8200
    ds_read_b64_tr_b16 a[206:207], v48 offset:8712
    s_waitcnt lgkmcnt(0)
    s_barrier
    s_add_u32 m0, s48, 65536
    s_mov_b32 s22, 131072
    buffer_load_dwordx4 v45, s[8:11], s22 offen  lds
    s_add_u32 m0, s48, 69632
    s_mov_b32 s22, 147456
    buffer_load_dwordx4 v45, s[8:11], s22 offen  lds
    s_add_u32 m0, s48, 73728
    s_mov_b32 s22, 163840
    buffer_load_dwordx4 v45, s[8:11], s22 offen  lds
    s_add_u32 m0, s48, 77824
    s_mov_b32 s22, 180224
    buffer_load_dwordx4 v45, s[8:11], s22 offen  lds
    s_waitcnt vmcnt(28)
    s_barrier
    v_add_u32 v48, 81920, v46
    ds_read_b64_tr_b16 a[208:209], v48 offset:0
    ds_read_b64_tr_b16 a[210:211], v48 offset:512
    ds_read_b64_tr_b16 a[212:213], v48 offset:8192
    ds_read_b64_tr_b16 a[214:215], v48 offset:8704
    ds_read_b64_tr_b16 a[216:217], v48 offset:8
    ds_read_b64_tr_b16 a[218:219], v48 offset:520
    ds_read_b64_tr_b16 a[220:221], v48 offset:8200
    ds_read_b64_tr_b16 a[222:223], v48 offset:8712
    s_waitcnt lgkmcnt(0)
    s_barrier
    s_add_u32 m0, s48, 81920
    s_mov_b32 s22, 131328
    buffer_load_dwordx4 v45, s[8:11], s22 offen  lds
    s_add_u32 m0, s48, 86016
    s_mov_b32 s22, 147712
    buffer_load_dwordx4 v45, s[8:11], s22 offen  lds
    s_add_u32 m0, s48, 90112
    s_mov_b32 s22, 164096
    buffer_load_dwordx4 v45, s[8:11], s22 offen  lds
    s_add_u32 m0, s48, 94208
    s_mov_b32 s22, 180480
    buffer_load_dwordx4 v45, s[8:11], s22 offen  lds
    s_waitcnt vmcnt(28)
    s_barrier
    v_add_u32 v48, 98304, v46
    ds_read_b64_tr_b16 a[224:225], v48 offset:0
    ds_read_b64_tr_b16 a[226:227], v48 offset:512
    ds_read_b64_tr_b16 a[228:229], v48 offset:8192
    ds_read_b64_tr_b16 a[230:231], v48 offset:8704
    ds_read_b64_tr_b16 a[232:233], v48 offset:8
    ds_read_b64_tr_b16 a[234:235], v48 offset:520
    ds_read_b64_tr_b16 a[236:237], v48 offset:8200
    ds_read_b64_tr_b16 a[238:239], v48 offset:8712
    s_waitcnt lgkmcnt(0)
    s_barrier
    s_add_u32 m0, s48, 98304
    s_mov_b32 s22, 131584
    buffer_load_dwordx4 v45, s[8:11], s22 offen  lds
    s_add_u32 m0, s48, 102400
    s_mov_b32 s22, 147968
    buffer_load_dwordx4 v45, s[8:11], s22 offen  lds
    s_add_u32 m0, s48, 106496
    s_mov_b32 s22, 164352
    buffer_load_dwordx4 v45, s[8:11], s22 offen  lds
    s_add_u32 m0, s48, 110592
    s_mov_b32 s22, 180736
    buffer_load_dwordx4 v45, s[8:11], s22 offen  lds
    s_waitcnt vmcnt(28)
    s_barrier
    v_add_u32 v48, 114688, v46
    ds_read_b64_tr_b16 a[240:241], v48 offset:0
    ds_read_b64_tr_b16 a[242:243], v48 offset:512
    ds_read_b64_tr_b16 a[244:245], v48 offset:8192
    ds_read_b64_tr_b16 a[246:247], v48 offset:8704
    ds_read_b64_tr_b16 a[248:249], v48 offset:8
    ds_read_b64_tr_b16 a[250:251], v48 offset:520
    ds_read_b64_tr_b16 a[252:253], v48 offset:8200
    ds_read_b64_tr_b16 a[254:255], v48 offset:8712
    s_waitcnt lgkmcnt(0)
    s_barrier
    s_add_u32 m0, s48, 114688
    s_mov_b32 s22, 131840
    buffer_load_dwordx4 v45, s[8:11], s22 offen  lds
    s_add_u32 m0, s48, 118784
    s_mov_b32 s22, 148224
    buffer_load_dwordx4 v45, s[8:11], s22 offen  lds
    s_add_u32 m0, s48, 122880
    s_mov_b32 s22, 164608
    buffer_load_dwordx4 v45, s[8:11], s22 offen  lds
    s_add_u32 m0, s48, 126976
    s_mov_b32 s22, 180992
    buffer_load_dwordx4 v45, s[8:11], s22 offen  lds
    s_waitcnt vmcnt(28)
    s_barrier
    s_cmp_lg_u32 s20, 0
    s_cbranch_scc1 mega_kernel_rf_wo0
    v_xor_b32 v48, 0, v47
    v_add_u32 v48, 0, v48
    ds_read_b64_tr_b16 v[128:129], v48 offset:0
    ds_read_b64_tr_b16 v[130:131], v48 offset:512
    ds_read_b64_tr_b16 v[132:133], v48 offset:8192
    ds_read_b64_tr_b16 v[134:135], v48 offset:8704
    ds_read_b64_tr_b16 v[144:145], v48 offset:32
    ds_read_b64_tr_b16 v[146:147], v48 offset:544
    ds_read_b64_tr_b16 v[148:149], v48 offset:8224
    ds_read_b64_tr_b16 v[150:151], v48 offset:8736
    s_waitcnt lgkmcnt(0)
    v_xor_b32 v48, 64, v47
    v_add_u32 v48, 0, v48
    ds_read_b64_tr_b16 v[160:161], v48 offset:0
    ds_read_b64_tr_b16 v[162:163], v48 offset:512
    ds_read_b64_tr_b16 v[164:165], v48 offset:8192
    ds_read_b64_tr_b16 v[166:167], v48 offset:8704
    ds_read_b64_tr_b16 v[176:177], v48 offset:32
    ds_read_b64_tr_b16 v[178:179], v48 offset:544
    ds_read_b64_tr_b16 v[180:181], v48 offset:8224
    ds_read_b64_tr_b16 v[182:183], v48 offset:8736
    s_waitcnt lgkmcnt(0)
    v_xor_b32 v48, 128, v47
    v_add_u32 v48, 0, v48
    ds_read_b64_tr_b16 v[192:193], v48 offset:0
    ds_read_b64_tr_b16 v[194:195], v48 offset:512
    ds_read_b64_tr_b16 v[196:197], v48 offset:8192
    ds_read_b64_tr_b16 v[198:199], v48 offset:8704
    ds_read_b64_tr_b16 v[208:209], v48 offset:32
    ds_read_b64_tr_b16 v[210:211], v48 offset:544
    ds_read_b64_tr_b16 v[212:213], v48 offset:8224
    ds_read_b64_tr_b16 v[214:215], v48 offset:8736
    s_waitcnt lgkmcnt(0)
    v_xor_b32 v48, 192, v47
    v_add_u32 v48, 0, v48
    ds_read_b64_tr_b16 v[224:225], v48 offset:0
    ds_read_b64_tr_b16 v[226:227], v48 offset:512
    ds_read_b64_tr_b16 v[228:229], v48 offset:8192
    ds_read_b64_tr_b16 v[230:231], v48 offset:8704
    ds_read_b64_tr_b16 v[240:241], v48 offset:32
    ds_read_b64_tr_b16 v[242:243], v48 offset:544
    ds_read_b64_tr_b16 v[244:245], v48 offset:8224
    ds_read_b64_tr_b16 v[246:247], v48 offset:8736
    s_waitcnt lgkmcnt(0)
mega_kernel_rf_wo0:
    s_barrier
    s_mov_b32 s8, s54
    s_mov_b32 s9, s55
    s_add_u32 m0, s48, 0
    s_mov_b32 s22, 0
    buffer_load_dwordx4 v44, s[8:11], s22 offen  lds
    s_add_u32 m0, s48, 4096
    s_mov_b32 s22, 32768
    buffer_load_dwordx4 v44, s[8:11], s22 offen  lds
    s_add_u32 m0, s48, 8192
    s_mov_b32 s22, 65536
    buffer_load_dwordx4 v44, s[8:11], s22 offen  lds
    s_add_u32 m0, s48, 12288
    s_mov_b32 s22, 98304
    buffer_load_dwordx4 v44, s[8:11], s22 offen  lds
    s_waitcnt vmcnt(28)
    s_barrier
    s_cmp_lg_u32 s20, 1
    s_cbranch_scc1 mega_kernel_rf_wo1
    v_xor_b32 v48, 0, v47
    v_add_u32 v48, 16384, v48
    ds_read_b64_tr_b16 v[128:129], v48 offset:0
    ds_read_b64_tr_b16 v[130:131], v48 offset:512
    ds_read_b64_tr_b16 v[132:133], v48 offset:8192
    ds_read_b64_tr_b16 v[134:135], v48 offset:8704
    ds_read_b64_tr_b16 v[144:145], v48 offset:32
    ds_read_b64_tr_b16 v[146:147], v48 offset:544
    ds_read_b64_tr_b16 v[148:149], v48 offset:8224
    ds_read_b64_tr_b16 v[150:151], v48 offset:8736
    s_waitcnt lgkmcnt(0)
    v_xor_b32 v48, 64, v47
    v_add_u32 v48, 16384, v48
    ds_read_b64_tr_b16 v[160:161], v48 offset:0
    ds_read_b64_tr_b16 v[162:163], v48 offset:512
    ds_read_b64_tr_b16 v[164:165], v48 offset:8192
    ds_read_b64_tr_b16 v[166:167], v48 offset:8704
    ds_read_b64_tr_b16 v[176:177], v48 offset:32
    ds_read_b64_tr_b16 v[178:179], v48 offset:544
    ds_read_b64_tr_b16 v[180:181], v48 offset:8224
    ds_read_b64_tr_b16 v[182:183], v48 offset:8736
    s_waitcnt lgkmcnt(0)
    v_xor_b32 v48, 128, v47
    v_add_u32 v48, 16384, v48
    ds_read_b64_tr_b16 v[192:193], v48 offset:0
    ds_read_b64_tr_b16 v[194:195], v48 offset:512
    ds_read_b64_tr_b16 v[196:197], v48 offset:8192
    ds_read_b64_tr_b16 v[198:199], v48 offset:8704
    ds_read_b64_tr_b16 v[208:209], v48 offset:32
    ds_read_b64_tr_b16 v[210:211], v48 offset:544
    ds_read_b64_tr_b16 v[212:213], v48 offset:8224
    ds_read_b64_tr_b16 v[214:215], v48 offset:8736
    s_waitcnt lgkmcnt(0)
    v_xor_b32 v48, 192, v47
    v_add_u32 v48, 16384, v48
    ds_read_b64_tr_b16 v[224:225], v48 offset:0
    ds_read_b64_tr_b16 v[226:227], v48 offset:512
    ds_read_b64_tr_b16 v[228:229], v48 offset:8192
    ds_read_b64_tr_b16 v[230:231], v48 offset:8704
    ds_read_b64_tr_b16 v[240:241], v48 offset:32
    ds_read_b64_tr_b16 v[242:243], v48 offset:544
    ds_read_b64_tr_b16 v[244:245], v48 offset:8224
    ds_read_b64_tr_b16 v[246:247], v48 offset:8736
    s_waitcnt lgkmcnt(0)
mega_kernel_rf_wo1:
    s_barrier
    s_add_u32 m0, s48, 16384
    s_mov_b32 s22, 524288
    buffer_load_dwordx4 v44, s[8:11], s22 offen  lds
    s_add_u32 m0, s48, 20480
    s_mov_b32 s22, 557056
    buffer_load_dwordx4 v44, s[8:11], s22 offen  lds
    s_add_u32 m0, s48, 24576
    s_mov_b32 s22, 589824
    buffer_load_dwordx4 v44, s[8:11], s22 offen  lds
    s_add_u32 m0, s48, 28672
    s_mov_b32 s22, 622592
    buffer_load_dwordx4 v44, s[8:11], s22 offen  lds
    s_waitcnt vmcnt(28)
    s_barrier
    s_cmp_lg_u32 s20, 2
    s_cbranch_scc1 mega_kernel_rf_wo2
    v_xor_b32 v48, 0, v47
    v_add_u32 v48, 32768, v48
    ds_read_b64_tr_b16 v[128:129], v48 offset:0
    ds_read_b64_tr_b16 v[130:131], v48 offset:512
    ds_read_b64_tr_b16 v[132:133], v48 offset:8192
    ds_read_b64_tr_b16 v[134:135], v48 offset:8704
    ds_read_b64_tr_b16 v[144:145], v48 offset:32
    ds_read_b64_tr_b16 v[146:147], v48 offset:544
    ds_read_b64_tr_b16 v[148:149], v48 offset:8224
    ds_read_b64_tr_b16 v[150:151], v48 offset:8736
    s_waitcnt lgkmcnt(0)
    v_xor_b32 v48, 64, v47
    v_add_u32 v48, 32768, v48
    ds_read_b64_tr_b16 v[160:161], v48 offset:0
    ds_read_b64_tr_b16 v[162:163], v48 offset:512
    ds_read_b64_tr_b16 v[164:165], v48 offset:8192
    ds_read_b64_tr_b16 v[166:167], v48 offset:8704
    ds_read_b64_tr_b16 v[176:177], v48 offset:32
    ds_read_b64_tr_b16 v[178:179], v48 offset:544
    ds_read_b64_tr_b16 v[180:181], v48 offset:8224
    ds_read_b64_tr_b16 v[182:183], v48 offset:8736
    s_waitcnt lgkmcnt(0)
    v_xor_b32 v48, 128, v47
    v_add_u32 v48, 32768, v48
    ds_read_b64_tr_b16 v[192:193], v48 offset:0
    ds_read_b64_tr_b16 v[194:195], v48 offset:512
    ds_read_b64_tr_b16 v[196:197], v48 offset:8192
    ds_read_b64_tr_b16 v[198:199], v48 offset:8704
    ds_read_b64_tr_b16 v[208:209], v48 offset:32
    ds_read_b64_tr_b16 v[210:211], v48 offset:544
    ds_read_b64_tr_b16 v[212:213], v48 offset:8224
    ds_read_b64_tr_b16 v[214:215], v48 offset:8736
    s_waitcnt lgkmcnt(0)
    v_xor_b32 v48, 192, v47
    v_add_u32 v48, 32768, v48
    ds_read_b64_tr_b16 v[224:225], v48 offset:0
    ds_read_b64_tr_b16 v[226:227], v48 offset:512
    ds_read_b64_tr_b16 v[228:229], v48 offset:8192
    ds_read_b64_tr_b16 v[230:231], v48 offset:8704
    ds_read_b64_tr_b16 v[240:241], v48 offset:32
    ds_read_b64_tr_b16 v[242:243], v48 offset:544
    ds_read_b64_tr_b16 v[244:245], v48 offset:8224
    ds_read_b64_tr_b16 v[246:247], v48 offset:8736
    s_waitcnt lgkmcnt(0)
mega_kernel_rf_wo2:
    s_barrier
    s_add_u32 m0, s48, 32768
    s_mov_b32 s22, 1048576
    buffer_load_dwordx4 v44, s[8:11], s22 offen  lds
    s_add_u32 m0, s48, 36864
    s_mov_b32 s22, 1081344
    buffer_load_dwordx4 v44, s[8:11], s22 offen  lds
    s_add_u32 m0, s48, 40960
    s_mov_b32 s22, 1114112
    buffer_load_dwordx4 v44, s[8:11], s22 offen  lds
    s_add_u32 m0, s48, 45056
    s_mov_b32 s22, 1146880
    buffer_load_dwordx4 v44, s[8:11], s22 offen  lds
    s_waitcnt vmcnt(28)
    s_barrier
    s_cmp_lg_u32 s20, 3
    s_cbranch_scc1 mega_kernel_rf_wo3
    v_xor_b32 v48, 0, v47
    v_add_u32 v48, 49152, v48
    ds_read_b64_tr_b16 v[128:129], v48 offset:0
    ds_read_b64_tr_b16 v[130:131], v48 offset:512
    ds_read_b64_tr_b16 v[132:133], v48 offset:8192
    ds_read_b64_tr_b16 v[134:135], v48 offset:8704
    ds_read_b64_tr_b16 v[144:145], v48 offset:32
    ds_read_b64_tr_b16 v[146:147], v48 offset:544
    ds_read_b64_tr_b16 v[148:149], v48 offset:8224
    ds_read_b64_tr_b16 v[150:151], v48 offset:8736
    s_waitcnt lgkmcnt(0)
    v_xor_b32 v48, 64, v47
    v_add_u32 v48, 49152, v48
    ds_read_b64_tr_b16 v[160:161], v48 offset:0
    ds_read_b64_tr_b16 v[162:163], v48 offset:512
    ds_read_b64_tr_b16 v[164:165], v48 offset:8192
    ds_read_b64_tr_b16 v[166:167], v48 offset:8704
    ds_read_b64_tr_b16 v[176:177], v48 offset:32
    ds_read_b64_tr_b16 v[178:179], v48 offset:544
    ds_read_b64_tr_b16 v[180:181], v48 offset:8224
    ds_read_b64_tr_b16 v[182:183], v48 offset:8736
    s_waitcnt lgkmcnt(0)
    v_xor_b32 v48, 128, v47
    v_add_u32 v48, 49152, v48
    ds_read_b64_tr_b16 v[192:193], v48 offset:0
    ds_read_b64_tr_b16 v[194:195], v48 offset:512
    ds_read_b64_tr_b16 v[196:197], v48 offset:8192
    ds_read_b64_tr_b16 v[198:199], v48 offset:8704
    ds_read_b64_tr_b16 v[208:209], v48 offset:32
    ds_read_b64_tr_b16 v[210:211], v48 offset:544
    ds_read_b64_tr_b16 v[212:213], v48 offset:8224
    ds_read_b64_tr_b16 v[214:215], v48 offset:8736
    s_waitcnt lgkmcnt(0)
    v_xor_b32 v48, 192, v47
    v_add_u32 v48, 49152, v48
    ds_read_b64_tr_b16 v[224:225], v48 offset:0
    ds_read_b64_tr_b16 v[226:227], v48 offset:512
    ds_read_b64_tr_b16 v[228:229], v48 offset:8192
    ds_read_b64_tr_b16 v[230:231], v48 offset:8704
    ds_read_b64_tr_b16 v[240:241], v48 offset:32
    ds_read_b64_tr_b16 v[242:243], v48 offset:544
    ds_read_b64_tr_b16 v[244:245], v48 offset:8224
    ds_read_b64_tr_b16 v[246:247], v48 offset:8736
    s_waitcnt lgkmcnt(0)
mega_kernel_rf_wo3:
    s_barrier
    s_add_u32 m0, s48, 49152
    s_mov_b32 s22, 1572864
    buffer_load_dwordx4 v44, s[8:11], s22 offen  lds
    s_add_u32 m0, s48, 53248
    s_mov_b32 s22, 1605632
    buffer_load_dwordx4 v44, s[8:11], s22 offen  lds
    s_add_u32 m0, s48, 57344
    s_mov_b32 s22, 1638400
    buffer_load_dwordx4 v44, s[8:11], s22 offen  lds
    s_add_u32 m0, s48, 61440
    s_mov_b32 s22, 1671168
    buffer_load_dwordx4 v44, s[8:11], s22 offen  lds
    s_waitcnt vmcnt(28)
    s_barrier
    s_cmp_lg_u32 s20, 0
    s_cbranch_scc1 mega_kernel_rf_wo4
    v_xor_b32 v48, 0, v47
    v_add_u32 v48, 65536, v48
    ds_read_b64_tr_b16 v[136:137], v48 offset:0
    ds_read_b64_tr_b16 v[138:139], v48 offset:512
    ds_read_b64_tr_b16 v[140:141], v48 offset:8192
    ds_read_b64_tr_b16 v[142:143], v48 offset:8704
    ds_read_b64_tr_b16 v[152:153], v48 offset:32
    ds_read_b64_tr_b16 v[154:155], v48 offset:544
    ds_read_b64_tr_b16 v[156:157], v48 offset:8224
    ds_read_b64_tr_b16 v[158:159], v48 offset:8736
    s_waitcnt lgkmcnt(0)
    v_xor_b32 v48, 64, v47
    v_add_u32 v48, 65536, v48
    ds_read_b64_tr_b16 v[168:169], v48 offset:0
    ds_read_b64_tr_b16 v[170:171], v48 offset:512
    ds_read_b64_tr_b16 v[172:173], v48 offset:8192
    ds_read_b64_tr_b16 v[174:175], v48 offset:8704
    ds_read_b64_tr_b16 v[184:185], v48 offset:32
    ds_read_b64_tr_b16 v[186:187], v48 offset:544
    ds_read_b64_tr_b16 v[188:189], v48 offset:8224
    ds_read_b64_tr_b16 v[190:191], v48 offset:8736
    s_waitcnt lgkmcnt(0)
    v_xor_b32 v48, 128, v47
    v_add_u32 v48, 65536, v48
    ds_read_b64_tr_b16 v[200:201], v48 offset:0
    ds_read_b64_tr_b16 v[202:203], v48 offset:512
    ds_read_b64_tr_b16 v[204:205], v48 offset:8192
    ds_read_b64_tr_b16 v[206:207], v48 offset:8704
    ds_read_b64_tr_b16 v[216:217], v48 offset:32
    ds_read_b64_tr_b16 v[218:219], v48 offset:544
    ds_read_b64_tr_b16 v[220:221], v48 offset:8224
    ds_read_b64_tr_b16 v[222:223], v48 offset:8736
    s_waitcnt lgkmcnt(0)
    v_xor_b32 v48, 192, v47
    v_add_u32 v48, 65536, v48
    ds_read_b64_tr_b16 v[232:233], v48 offset:0
    ds_read_b64_tr_b16 v[234:235], v48 offset:512
    ds_read_b64_tr_b16 v[236:237], v48 offset:8192
    ds_read_b64_tr_b16 v[238:239], v48 offset:8704
    ds_read_b64_tr_b16 v[248:249], v48 offset:32
    ds_read_b64_tr_b16 v[250:251], v48 offset:544
    ds_read_b64_tr_b16 v[252:253], v48 offset:8224
    ds_read_b64_tr_b16 v[254:255], v48 offset:8736
    s_waitcnt lgkmcnt(0)
mega_kernel_rf_wo4:
    s_barrier
    s_add_u32 m0, s48, 65536
    s_mov_b32 s22, 2097152
    buffer_load_dwordx4 v44, s[8:11], s22 offen  lds
    s_add_u32 m0, s48, 69632
    s_mov_b32 s22, 2129920
    buffer_load_dwordx4 v44, s[8:11], s22 offen  lds
    s_add_u32 m0, s48, 73728
    s_mov_b32 s22, 2162688
    buffer_load_dwordx4 v44, s[8:11], s22 offen  lds
    s_add_u32 m0, s48, 77824
    s_mov_b32 s22, 2195456
    buffer_load_dwordx4 v44, s[8:11], s22 offen  lds
    s_waitcnt vmcnt(28)
    s_barrier
    s_cmp_lg_u32 s20, 1
    s_cbranch_scc1 mega_kernel_rf_wo5
    v_xor_b32 v48, 0, v47
    v_add_u32 v48, 81920, v48
    ds_read_b64_tr_b16 v[136:137], v48 offset:0
    ds_read_b64_tr_b16 v[138:139], v48 offset:512
    ds_read_b64_tr_b16 v[140:141], v48 offset:8192
    ds_read_b64_tr_b16 v[142:143], v48 offset:8704
    ds_read_b64_tr_b16 v[152:153], v48 offset:32
    ds_read_b64_tr_b16 v[154:155], v48 offset:544
    ds_read_b64_tr_b16 v[156:157], v48 offset:8224
    ds_read_b64_tr_b16 v[158:159], v48 offset:8736
    s_waitcnt lgkmcnt(0)
    v_xor_b32 v48, 64, v47
    v_add_u32 v48, 81920, v48
    ds_read_b64_tr_b16 v[168:169], v48 offset:0
    ds_read_b64_tr_b16 v[170:171], v48 offset:512
    ds_read_b64_tr_b16 v[172:173], v48 offset:8192
    ds_read_b64_tr_b16 v[174:175], v48 offset:8704
    ds_read_b64_tr_b16 v[184:185], v48 offset:32
    ds_read_b64_tr_b16 v[186:187], v48 offset:544
    ds_read_b64_tr_b16 v[188:189], v48 offset:8224
    ds_read_b64_tr_b16 v[190:191], v48 offset:8736
    s_waitcnt lgkmcnt(0)
    v_xor_b32 v48, 128, v47
    v_add_u32 v48, 81920, v48
    ds_read_b64_tr_b16 v[200:201], v48 offset:0
    ds_read_b64_tr_b16 v[202:203], v48 offset:512
    ds_read_b64_tr_b16 v[204:205], v48 offset:8192
    ds_read_b64_tr_b16 v[206:207], v48 offset:8704
    ds_read_b64_tr_b16 v[216:217], v48 offset:32
    ds_read_b64_tr_b16 v[218:219], v48 offset:544
    ds_read_b64_tr_b16 v[220:221], v48 offset:8224
    ds_read_b64_tr_b16 v[222:223], v48 offset:8736
    s_waitcnt lgkmcnt(0)
    v_xor_b32 v48, 192, v47
    v_add_u32 v48, 81920, v48
    ds_read_b64_tr_b16 v[232:233], v48 offset:0
    ds_read_b64_tr_b16 v[234:235], v48 offset:512
    ds_read_b64_tr_b16 v[236:237], v48 offset:8192
    ds_read_b64_tr_b16 v[238:239], v48 offset:8704
    ds_read_b64_tr_b16 v[248:249], v48 offset:32
    ds_read_b64_tr_b16 v[250:251], v48 offset:544
    ds_read_b64_tr_b16 v[252:253], v48 offset:8224
    ds_read_b64_tr_b16 v[254:255], v48 offset:8736
    s_waitcnt lgkmcnt(0)
mega_kernel_rf_wo5:
    s_barrier
    s_add_u32 m0, s48, 81920
    s_mov_b32 s22, 2621440
    buffer_load_dwordx4 v44, s[8:11], s22 offen  lds
    s_add_u32 m0, s48, 86016
    s_mov_b32 s22, 2654208
    buffer_load_dwordx4 v44, s[8:11], s22 offen  lds
    s_add_u32 m0, s48, 90112
    s_mov_b32 s22, 2686976
    buffer_load_dwordx4 v44, s[8:11], s22 offen  lds
    s_add_u32 m0, s48, 94208
    s_mov_b32 s22, 2719744
    buffer_load_dwordx4 v44, s[8:11], s22 offen  lds
    s_waitcnt vmcnt(28)
    s_barrier
    s_cmp_lg_u32 s97, 0
    s_cbranch_scc1 mega_kernel_h2_2_ok
mega_kernel_h2_2_ev:
    v_cmp_ne_u32 vcc, 32, v36
    s_cbranch_vccz mega_kernel_h2_2_ok
    s_mov_b32 s78, 0
    v_readlane_b32 s81, v36, 0
    s_nop 3
    s_add_u32 s78, s78, s81
    v_readlane_b32 s81, v36, 1
    s_nop 3
    s_add_u32 s78, s78, s81
    v_readlane_b32 s81, v36, 2
    s_nop 3
    s_add_u32 s78, s78, s81
    v_readlane_b32 s81, v36, 3
    s_nop 3
    s_add_u32 s78, s78, s81
    v_readlane_b32 s81, v36, 4
    s_nop 3
    s_add_u32 s78, s78, s81
    v_readlane_b32 s81, v36, 5
    s_nop 3
    s_add_u32 s78, s78, s81
    v_readlane_b32 s81, v36, 6
    s_nop 3
    s_add_u32 s78, s78, s81
    v_readlane_b32 s81, v36, 7
    s_nop 3
    s_add_u32 s78, s78, s81
    s_cmp_eq_u32 s78, 256
    s_cbranch_scc1 mega_kernel_redo
    buffer_load_dword v36, v37, s[88:91], 0 offen sc1
    s_waitcnt vmcnt(0)
    s_branch mega_kernel_h2_2_ev
mega_kernel_h2_2_ok:
    s_cmp_lg_u32 s20, 2
    s_cbranch_scc1 mega_kernel_rf_wo6
    v_xor_b32 v48, 0, v47
    v_add_u32 v48, 98304, v48
    ds_read_b64_tr_b16 v[136:137], v48 offset:0
    ds_read_b64_tr_b16 v[138:139], v48 offset:512
    ds_read_b64_tr_b16 v[140:141], v48 offset:8192
    ds_read_b64_tr_b16 v[142:143], v48 offset:8704
    ds_read_b64_tr_b16 v[152:153], v48 offset:32
    ds_read_b64_tr_b16 v[154:155], v48 offset:544
    ds_read_b64_tr_b16 v[156:157], v48 offset:8224
    ds_read_b64_tr_b16 v[158:159], v48 offset:8736
    s_waitcnt lgkmcnt(0)
    v_xor_b32 v48, 64, v47
    v_add_u32 v48, 98304, v48
    ds_read_b64_tr_b16 v[168:169], v48 offset:0
    ds_read_b64_tr_b16 v[170:171], v48 offset:512
    ds_read_b64_tr_b16 v[172:173], v48 offset:8192
    ds_read_b64_tr_b16 v[174:175], v48 offset:8704
    ds_read_b64_tr_b16 v[184:185], v48 offset:32
    ds_read_b64_tr_b16 v[186:187], v48 offset:544
    ds_read_b64_tr_b16 v[188:189], v48 offset:8224
    ds_read_b64_tr_b16 v[190:191], v48 offset:8736
    s_waitcnt lgkmcnt(0)
    v_xor_b32 v48, 128, v47
    v_add_u32 v48, 98304, v48
    ds_read_b64_tr_b16 v[200:201], v48 offset:0
    ds_read_b64_tr_b16 v[202:203], v48 offset:512
    ds_read_b64_tr_b16 v[204:205], v48 offset:8192
    ds_read_b64_tr_b16 v[206:207], v48 offset:8704
    ds_read_b64_tr_b16 v[216:217], v48 offset:32
    ds_read_b64_tr_b16 v[218:219], v48 offset:544
    ds_read_b64_tr_b16 v[220:221], v48 offset:8224
    ds_read_b64_tr_b16 v[222:223], v48 offset:8736
    s_waitcnt lgkmcnt(0)
    v_xor_b32 v48, 192, v47
    v_add_u32 v48, 98304, v48
    ds_read_b64_tr_b16 v[232:233], v48 offset:0
    ds_read_b64_tr_b16 v[234:235], v48 offset:512
    ds_read_b64_tr_b16 v[236:237], v48 offset:8192
    ds_read_b64_tr_b16 v[238:239], v48 offset:8704
    ds_read_b64_tr_b16 v[248:249], v48 offset:32
    ds_read_b64_tr_b16 v[250:251], v48 offset:544
    ds_read_b64_tr_b16 v[252:253], v48 offset:8224
    ds_read_b64_tr_b16 v[254:255], v48 offset:8736
    s_waitcnt lgkmcnt(0)
mega_kernel_rf_wo6:
    s_barrier
    s_add_u32 m0, s48, 98304
    s_mov_b32 s22, 3145728
    buffer_load_dwordx4 v44, s[8:11], s22 offen  lds
    s_add_u32 m0, s48, 102400
    s_mov_b32 s22, 3178496
    buffer_load_dwordx4 v44, s[8:11], s22 offen  lds
    s_add_u32 m0, s48, 106496
    s_mov_b32 s22, 3211264
    buffer_load_dwordx4 v44, s[8:11], s22 offen  lds
    s_add_u32 m0, s48, 110592
    s_mov_b32 s22, 3244032
    buffer_load_dwordx4 v44, s[8:11], s22 offen  lds
    s_waitcnt vmcnt(28)
    s_barrier
    s_cmp_lg_u32 s20, 3
    s_cbranch_scc1 mega_kernel_rf_wo7
    v_xor_b32 v48, 0, v47
    v_add_u32 v48, 114688, v48
    ds_read_b64_tr_b16 v[136:137], v48 offset:0
    ds_read_b64_tr_b16 v[138:139], v48 offset:512
    ds_read_b64_tr_b16 v[140:141], v48 offset:8192
    ds_read_b64_tr_b16 v[142:143], v48 offset:8704
    ds_read_b64_tr_b16 v[152:153], v48 offset:32
    ds_read_b64_tr_b16 v[154:155], v48 offset:544
    ds_read_b64_tr_b16 v[156:157], v48 offset:8224
    ds_read_b64_tr_b16 v[158:159], v48 offset:8736
    s_waitcnt lgkmcnt(0)
    v_xor_b32 v48, 64, v47
    v_add_u32 v48, 114688, v48
    ds_read_b64_tr_b16 v[168:169], v48 offset:0
    ds_read_b64_tr_b16 v[170:171], v48 offset:512
    ds_read_b64_tr_b16 v[172:173], v48 offset:8192
    ds_read_b64_tr_b16 v[174:175], v48 offset:8704
    ds_read_b64_tr_b16 v[184:185], v48 offset:32
    ds_read_b64_tr_b16 v[186:187], v48 offset:544
    ds_read_b64_tr_b16 v[188:189], v48 offset:8224
    ds_read_b64_tr_b16 v[190:191], v48 offset:8736
    s_waitcnt lgkmcnt(0)
    v_xor_b32 v48, 128, v47
    v_add_u32 v48, 114688, v48
    ds_read_b64_tr_b16 v[200:201], v48 offset:0
    ds_read_b64_tr_b16 v[202:203], v48 offset:512
    ds_read_b64_tr_b16 v[204:205], v48 offset:8192
    ds_read_b64_tr_b16 v[206:207], v48 offset:8704
    ds_read_b64_tr_b16 v[216:217], v48 offset:32
    ds_read_b64_tr_b16 v[218:219], v48 offset:544
    ds_read_b64_tr_b16 v[220:221], v48 offset:8224
    ds_read_b64_tr_b16 v[222:223], v48 offset:8736
    s_waitcnt lgkmcnt(0)
    v_xor_b32 v48, 192, v47
    v_add_u32 v48, 114688, v48
    ds_read_b64_tr_b16 v[232:233], v48 offset:0
    ds_read_b64_tr_b16 v[234:235], v48 offset:512
    ds_read_b64_tr_b16 v[236:237], v48 offset:8192
    ds_read_b64_tr_b16 v[238:239], v48 offset:8704
    ds_read_b64_tr_b16 v[248:249], v48 offset:32
    ds_read_b64_tr_b16 v[250:251], v48 offset:544
    ds_read_b64_tr_b16 v[252:253], v48 offset:8224
    ds_read_b64_tr_b16 v[254:255], v48 offset:8736
    s_waitcnt lgkmcnt(0)
mega_kernel_rf_wo7:
    s_barrier
    s_add_u32 m0, s48, 114688
    s_mov_b32 s22, 3670016
    buffer_load_dwordx4 v44, s[8:11], s22 offen  lds
    s_add_u32 m0, s48, 118784
    s_mov_b32 s22, 3702784
    buffer_load_dwordx4 v44, s[8:11], s22 offen  lds
    s_add_u32 m0, s48, 122880
    s_mov_b32 s22, 3735552
    buffer_load_dwordx4 v44, s[8:11], s22 offen  lds
    s_add_u32 m0, s48, 126976
    s_mov_b32 s22, 3768320
    buffer_load_dwordx4 v44, s[8:11], s22 offen  lds
    s_waitcnt vmcnt(28)
    s_barrier
    v_add_u32 v48, 0, v46
    ds_read_b64_tr_b16 v[64:65], v48 offset:0
    ds_read_b64_tr_b16 v[66:67], v48 offset:512
    ds_read_b64_tr_b16 v[68:69], v48 offset:8192
    ds_read_b64_tr_b16 v[70:71], v48 offset:8704
    ds_read_b64_tr_b16 v[72:73], v48 offset:8
    ds_read_b64_tr_b16 v[74:75], v48 offset:520
    ds_read_b64_tr_b16 v[76:77], v48 offset:8200
    ds_read_b64_tr_b16 v[78:79], v48 offset:8712
    s_waitcnt lgkmcnt(0)
    s_barrier
    ds_write_b128 v32, v[64:67] offset:0
    ds_write_b128 v32, v[68:71] offset:1024
    ds_write_b128 v32, v[72:75] offset:2048
    ds_write_b128 v32, v[76:79] offset:3072
    s_waitcnt lgkmcnt(0)
    s_waitcnt vmcnt(24)
    s_barrier
    v_add_u32 v48, 16384, v46
    ds_read_b64_tr_b16 v[64:65], v48 offset:0
    ds_read_b64_tr_b16 v[66:67], v48 offset:512
    ds_read_b64_tr_b16 v[68:69], v48 offset:8192
    ds_read_b64_tr_b16 v[70:71], v48 offset:8704
    ds_read_b64_tr_b16 v[72:73], v48 offset:8
    ds_read_b64_tr_b16 v[74:75], v48 offset:520
    ds_read_b64_tr_b16 v[76:77], v48 offset:8200
    ds_read_b64_tr_b16 v[78:79], v48 offset:8712
    s_waitcnt lgkmcnt(0)
    s_barrier
    ds_write_b128 v32, v[64:67] offset:16384
    ds_write_b128 v32, v[68:71] offset:17408
    ds_write_b128 v32, v[72:75] offset:18432
    ds_write_b128 v32, v[76:79] offset:19456
    s_waitcnt lgkmcnt(0)
    s_waitcnt vmcnt(20)
    s_barrier
    s_getpc_b64 s[16:17]
mega_kernel_rf_pc0:
    s_add_u32 s16, s16, mega_kernel_rf_w0_entry - mega_kernel_rf_pc0
    s_addc_u32 s17, s17, 0
    v_lshlrev_b32 v49, 7, v0
    v_min_u32 v49, mega_kernel_rf_end - mega_kernel_rf_w0_entry, v49
    global_load_dword v50, v49, s[16:17]
    v_lshlrev_b32 v49, 7, v40
    s_xor_b32 s23, s35, 16384
    s_cmp_eq_u32 s20, 1
    s_cselect_b32 s22, s35, s47
    s_cmp_eq_u32 s20, 2
    s_cselect_b32 s22, s23, s22
    s_lshl_b32 s23, s31, 13
    s_add_u32 s23, s23, 178257920
    s_cmp_eq_u32 s20, 3
    s_cselect_b32 s22, s23, s22
    buffer_load_dword v51, v49, s[4:7], s22 offen sc1
    v_lshlrev_b32 v49, 13, v0
    v_and_b32 v49, 0x1fffff, v49
    s_mov_b32 s22, 67108864
    buffer_load_dword v52, v49, s[4:7], s22 offen sc1
    buffer_load_dword v57, v7, s[4:7], 0 offen sc1
    v_add_u32 v48, 32768, v46
    ds_read_b64_tr_b16 v[64:65], v48 offset:0
    ds_read_b64_tr_b16 v[66:67], v48 offset:512
    ds_read_b64_tr_b16 v[68:69], v48 offset:8192
    ds_read_b64_tr_b16 v[70:71], v48 offset:8704
    ds_read_b64_tr_b16 v[72:73], v48 offset:8
    ds_read_b64_tr_b16 v[74:75], v48 offset:520
    ds_read_b64_tr_b16 v[76:77], v48 offset:8200
    ds_read_b64_tr_b16 v[78:79], v48 offset:8712
    s_waitcnt lgkmcnt(0)
    s_barrier
    ds_write_b128 v32, v[64:67] offset:32768
    ds_write_b128 v32, v[68:71] offset:33792
    ds_write_b128 v32, v[72:75] offset:34816
    ds_write_b128 v32, v[76:79] offset:35840
    s_waitcnt lgkmcnt(0)
    s_waitcnt vmcnt(16)
    s_barrier
    v_add_u32 v48, 49152, v46
    ds_read_b64_tr_b16 v[64:65], v48 offset:0
    ds_read_b64_tr_b16 v[66:67], v48 offset:512
    ds_read_b64_tr_b16 v[68:69], v48 offset:8192
    ds_read_b64_tr_b16 v[70:71], v48 offset:8704
    ds_read_b64_tr_b16 v[72:73], v48 offset:8
    ds_read_b64_tr_b16 v[74:75], v48 offset:520
    ds_read_b64_tr_b16 v[76:77], v48 offset:8200
    ds_read_b64_tr_b16 v[78:79], v48 offset:8712
    s_waitcnt lgkmcnt(0)
    s_barrier
    ds_write_b128 v32, v[64:67] offset:49152
    ds_write_b128 v32, v[68:71] offset:50176
    ds_write_b128 v32, v[72:75] offset:51200
    ds_write_b128 v32, v[76:79] offset:52224
    s_waitcnt lgkmcnt(0)
    s_waitcnt vmcnt(12)
    s_barrier
    v_add_u32 v48, 65536, v46
    ds_read_b64_tr_b16 v[64:65], v48 offset:0
    ds_read_b64_tr_b16 v[66:67], v48 offset:512
    ds_read_b64_tr_b16 v[68:69], v48 offset:8192
    ds_read_b64_tr_b16 v[70:71], v48 offset:8704
    ds_read_b64_tr_b16 v[72:73], v48 offset:8
    ds_read_b64_tr_b16 v[74:75], v48 offset:520
    ds_read_b64_tr_b16 v[76:77], v48 offset:8200
    ds_read_b64_tr_b16 v[78:79], v48 offset:8712
    s_waitcnt lgkmcnt(0)
    s_barrier
    ds_write_b128 v33, v[64:67] offset:0
    ds_write_b128 v33, v[68:71] offset:1024
    ds_write_b128 v33, v[72:75] offset:2048
    ds_write_b128 v33, v[76:79] offset:3072
    s_waitcnt lgkmcnt(0)
    s_waitcnt vmcnt(8)
    s_barrier
    v_add_u32 v48, 81920, v46
    ds_read_b64_tr_b16 v[64:65], v48 offset:0
    ds_read_b64_tr_b16 v[66:67], v48 offset:512
    ds_read_b64_tr_b16 v[68:69], v48 offset:8192
    ds_read_b64_tr_b16 v[70:71], v48 offset:8704
    ds_read_b64_tr_b16 v[72:73], v48 offset:8
    ds_read_b64_tr_b16 v[74:75], v48 offset:520
    ds_read_b64_tr_b16 v[76:77], v48 offset:8200
    ds_read_b64_tr_b16 v[78:79], v48 offset:8712
    s_waitcnt lgkmcnt(0)
    s_barrier
    ds_write_b128 v33, v[64:67] offset:16384
    ds_write_b128 v33, v[68:71] offset:17408
    ds_write_b128 v33, v[72:75] offset:18432
    ds_write_b128 v33, v[76:79] offset:19456
    s_waitcnt lgkmcnt(0)
    s_waitcnt vmcnt(4)
    s_barrier
    v_add_u32 v48, 98304, v46
    ds_read_b64_tr_b16 v[64:65], v48 offset:0
    ds_read_b64_tr_b16 v[66:67], v48 offset:512
    ds_read_b64_tr_b16 v[68:69], v48 offset:8192
    ds_read_b64_tr_b16 v[70:71], v48 offset:8704
    ds_read_b64_tr_b16 v[72:73], v48 offset:8
    ds_read_b64_tr_b16 v[74:75], v48 offset:520
    ds_read_b64_tr_b16 v[76:77], v48 offset:8200
    ds_read_b64_tr_b16 v[78:79], v48 offset:8712
    s_waitcnt lgkmcnt(0)
    s_barrier
    ds_write_b128 v33, v[64:67] offset:32768
    ds_write_b128 v33, v[68:71] offset:33792
    ds_write_b128 v33, v[72:75] offset:34816
    ds_write_b128 v33, v[76:79] offset:35840
    s_waitcnt lgkmcnt(0)
    s_waitcnt vmcnt(0)
    s_barrier
    v_add_u32 v48, 114688, v46
    ds_read_b64_tr_b16 v[64:65], v48 offset:0
    ds_read_b64_tr_b16 v[66:67], v48 offset:512
    ds_read_b64_tr_b16 v[68:69], v48 offset:8192
    ds_read_b64_tr_b16 v[70:71], v48 offset:8704
    ds_read_b64_tr_b16 v[72:73], v48 offset:8
    ds_read_b64_tr_b16 v[74:75], v48 offset:520
    ds_read_b64_tr_b16 v[76:77], v48 offset:8200
    ds_read_b64_tr_b16 v[78:79], v48 offset:8712
    s_waitcnt lgkmcnt(0)
    s_barrier
    ds_write_b128 v33, v[64:67] offset:49152
    ds_write_b128 v33, v[68:71] offset:50176
    ds_write_b128 v33, v[72:75] offset:51200
    ds_write_b128 v33, v[76:79] offset:52224
    s_waitcnt lgkmcnt(0)
    s_branch mega_kernel_rf_iw1
mega_kernel_rf_iw:
    buffer_load_dword v58, off, s[12:15], 0 offset:204 sc1
    s_waitcnt vmcnt(0)
mega_kernel_rf_iw1:
    v_and_b32 v50, 0xffff, v58
    v_readfirstlane_b32 s60, v58
    v_cmp_ne_u32 vcc, s100, v50
    s_cbranch_vccnz mega_kernel_rf_iw
    s_lshr_b32 s60, s60, 15
    s_cmp_gt_u32 s60, s100
    s_cselect_b32 s60, 8192, 0
    s_bfe_u32 s22, s31, 0x10001
    s_lshl_b32 s22, s22, 12
    s_add_u32 s22, s22, s60
    s_lshl_b32 s23, s20, 10
    s_add_u32 s22, s22, s23
    s_add_u32 s38, s38, s22
    s_add_u32 s37, s37, s22
    s_xor_b32 s40, s38, 4096
    s_xor_b32 s39, s37, 4096
    s_xor_b32 s36, s35, 16384
    s_mov_b32 s21, 0
    s_cmp_eq_u32 s30, 0
    s_mov_b32 s22, 0x33003300
    s_cselect_b32 s16, 0x00330033, s22
    s_mov_b32 s17, s16
    s_cselect_b32 s18, -1, 0
    s_not_b32 s19, s18
    s_lshl_b32 s22, s31, 13
    s_lshl_b32 s23, s20, 11
    s_add_u32 s22, s22, s23
    s_add_u32 s43, s22, 16777216
    s_add_u32 s44, s22, 33554432
    s_lshl_b32 s45, s31, 13
    s_add_u32 s45, s45, 178257920
    s_mul_i32 s48, s20, 5120
    s_add_u32 m0, s48, 140288
    s_mov_b32 s41, 1
    s_mov_b32 s42, 1
    v_mov_b32 v0, v34
    v_bfrev_b32 v12, 1
    v_bfrev_b32 v3, 1
    v_cndmask_b32 v10, v3, v10, s[16:17]
    v_cndmask_b32 v9, v3, v9, s[26:27]
    s_sub_u32 s45, s45, 0
    s_lshl_b32 s51, s30, 11
    s_add_u32 s51, s51, s45
    s_mov_b32 s50, 0
    s_cmp_lg_u32 s20, 3
    s_cbranch_scc1 mega_kernel_rf_kv0
    v_readlane_b32 s50, v57, 0
    v_readlane_b32 s22, v57, 2
    v_readlane_b32 s23, v57, 1
    v_readlane_b32 s24, v57, 3
    s_nop 3
    s_min_u32 s50, s50, s22
    s_min_u32 s23, s23, s24
    s_lshl_b32 s50, s50, 1
    s_lshl_b32 s23, s23, 1
    s_add_u32 s23, s23, 1
    s_min_u32 s50, s50, s23
mega_kernel_rf_kvb0:
    s_add_u32 s22, s21, 1
    s_min_u32 s22, s22, 63
    s_cmp_gt_u32 s50, s22
    s_cbranch_scc1 mega_kernel_rf_kvd0
    buffer_load_dword v48, v7, s[4:7], 0 offen sc1
    s_waitcnt vmcnt(0)
    v_readlane_b32 s50, v48, 0
    v_readlane_b32 s22, v48, 2
    v_readlane_b32 s23, v48, 1
    v_readlane_b32 s24, v48, 3
    s_nop 3
    s_min_u32 s50, s50, s22
    s_min_u32 s23, s23, s24
    s_lshl_b32 s50, s50, 1
    s_lshl_b32 s23, s23, 1
    s_add_u32 s23, s23, 1
    s_min_u32 s50, s50, s23
    s_branch mega_kernel_rf_kvb0
mega_kernel_rf_kvd0:
mega_kernel_rf_kv0:
    s_barrier
    s_cmp_eq_u32 s20, 1
    s_cbranch_scc1 mega_kernel_rf_w1_entry
    s_cmp_eq_u32 s20, 2
    s_cbranch_scc1 mega_kernel_rf_w2_entry
    s_cmp_eq_u32 s20, 3
    s_cbranch_scc1 mega_kernel_rf_w3_entry
mega_kernel_rf_w0_entry:
    v_mfma_f32_32x32x8_bf16 v[96:111], v[14:15], v[14:15], 0
    v_mfma_f32_16x16x16_bf16 v[112:115], v[14:15], v[14:15], 0
    v_mfma_f32_16x16x16_bf16 v[116:119], v[14:15], v[14:15], 0
    ds_read_b128 v[64:67], v1 offset:0
    ds_read_b128 v[68:71], v1 offset:1024
    ds_read_b128 v[72:75], v1 offset:2048
    ds_read_b128 v[76:79], v1 offset:3072
    ds_read_b128 v[80:83], v1 offset:16384
    ds_read_b128 v[84:87], v1 offset:17408
    ds_read_b128 v[88:91], v1 offset:18432
    ds_read_b128 v[92:95], v1 offset:19456
    buffer_load_dwordx4 v[120:123], v1, s[4:7], s44 offen
    buffer_load_dwordx4 v[124:127], v1, s[4:7], s44 offen offset:1024
    s_add_u32 s44, s44, 262144
mega_kernel_rf_w0_loop:
    s_add_u32 s22, s35, 0
    s_waitcnt vmcnt(0)
    buffer_load_dwordx4 v[32:35], v1, s[4:7], s22 offen sc1
    buffer_load_dwordx4 v[36:39], v1, s[4:7], s22 offen offset:1024 sc1
mega_kernel_rf_w0_pa:
    s_waitcnt vmcnt(1)
    ds_write_b128 v6, v[32:35] offset:0
    s_waitcnt vmcnt(0)
    ds_write_b128 v6, v[36:39] offset:1024
    v_max3_u32 v3, v32, v34, v36
    v_max_u32 v3, v3, v38
    v_cmp_eq_u32 vcc, -1, v3
    v_smfmac_f32_16x16x64_bf16 v[96:99], v[32:35], a[0:7], v2
    buffer_load_dwordx4 v[32:35], v1, s[4:7], s22 offen sc1
    v_smfmac_f32_16x16x64_bf16 v[100:103], v[32:35], a[8:15], v2
    buffer_load_dwordx4 v[36:39], v1, s[4:7], s22 offen offset:1024 sc1
    v_smfmac_f32_16x16x64_bf16 v[104:107], v[32:35], a[128:135], v2
    s_cbranch_vccnz mega_kernel_rf_w0_pafail
    s_waitcnt lgkmcnt(0)
    s_barrier
    ds_read_b128 v[40:43], v6 offset:2048
    ds_read_b128 v[44:47], v6 offset:3072
    v_smfmac_f32_16x16x64_bf16 v[108:111], v[32:35], a[136:143], v2
    ds_read_b128 v[48:51], v6 offset:4096
    v_smfmac_f32_16x16x64_bf16 v[96:99], v[36:39], a[16:23], v2
    ds_read_b128 v[52:55], v6 offset:5120
    v_smfmac_f32_16x16x64_bf16 v[100:103], v[36:39], a[24:31], v2
    ds_read_b128 v[56:59], v6 offset:6144
    v_smfmac_f32_16x16x64_bf16 v[104:107], v[36:39], a[144:151], v2
    ds_read_b128 v[60:63], v6 offset:7168
    v_smfmac_f32_16x16x64_bf16 v[108:111], v[36:39], a[152:159], v2
    buffer_load_dwordx4 v1, s[4:7], s43 offen lds
    s_waitcnt lgkmcnt(5)
    v_smfmac_f32_16x16x64_bf16 v[96:99], v[40:43], a[32:39], v2
    v_smfmac_f32_16x16x64_bf16 v[104:107], v[40:43], a[160:167], v2
    s_waitcnt lgkmcnt(4)
    v_smfmac_f32_16x16x64_bf16 v[96:99], v[44:47], a[48:55], v2
    v_smfmac_f32_16x16x64_bf16 v[104:107], v[44:47], a[176:183], v2
    buffer_load_dwordx4 v1, s[4:7], s43 offen offset:1024 lds
    s_waitcnt lgkmcnt(3)
    v_smfmac_f32_16x16x64_bf16 v[96:99], v[48:51], a[64:71], v2
    v_smfmac_f32_16x16x64_bf16 v[104:107], v[48:51], a[192:199], v2
    s_waitcnt lgkmcnt(2)
    v_smfmac_f32_16x16x64_bf16 v[96:99], v[52:55], a[80:87], v2
    v_smfmac_f32_16x16x64_bf16 v[104:107], v[52:55], a[208:215], v2
    v_mov_b32 v4, s21
    buffer_store_dword v4, v7, s[4:7], 0 offen sc1
    s_waitcnt lgkmcnt(1)
    v_smfmac_f32_16x16x64_bf16 v[96:99], v[56:59], a[96:103], v2
    v_smfmac_f32_16x16x64_bf16 v[104:107], v[56:59], a[224:231], v2
    s_waitcnt lgkmcnt(0)
    v_smfmac_f32_16x16x64_bf16 v[96:99], v[60:63], a[112:119], v2
    v_smfmac_f32_16x16x64_bf16 v[104:107], v[60:63], a[240:247], v2
    v_smfmac_f32_16x16x64_bf16 v[100:103], v[40:43], a[40:47], v2
    s_nop 2
    v_smfmac_f32_16x16x64_bf16 v[100:103], v[44:47], a[56:63], v2
    s_nop 1
    v_add_f32 v96, v96, v98
    v_smfmac_f32_16x16x64_bf16 v[100:103], v[48:51], a[72:79], v2
    v_add_f32 v97, v97, v99
    v_add_f32 v104, v104, v106
    v_smfmac_f32_16x16x64_bf16 v[100:103], v[52:55], a[88:95], v2
    v_add_f32 v105, v105, v107
    v_cvt_pk_bf16_f32 v96, v96, v97
    v_smfmac_f32_16x16x64_bf16 v[100:103], v[56:59], a[104:111], v2
    v_cvt_pk_bf16_f32 v97, v104, v105
    v_and_or_b32 v96, v96, -2, s41
    v_smfmac_f32_16x16x64_bf16 v[100:103], v[60:63], a[120:127], v2
    buffer_store_dwordx2 v[96:97], v11, s[4:7], s37 offen sc1
    v_smfmac_f32_16x16x64_bf16 v[108:111], v[40:43], a[168:175], v2
    v_smfmac_f32_16x16x64_bf16 v[108:111], v[44:47], a[184:191], v2
    v_smfmac_f32_16x16x64_bf16 v[108:111], v[48:51], a[200:207], v2
    v_smfmac_f32_16x16x64_bf16 v[108:111], v[52:55], a[216:223], v2
    v_smfmac_f32_16x16x64_bf16 v[108:111], v[56:59], a[232:239], v2
    s_nop 2
    v_add_f32 v100, v100, v102
    v_smfmac_f32_16x16x64_bf16 v[108:111], v[60:63], a[248:255], v2
    v_add_f32 v101, v101, v103
    v_cvt_pk_bf16_f32 v98, v100, v101
    v_and_or_b32 v98, v98, -2, s41
    s_nop 4
    v_pk_add_f32 v[108:109], v[108:109], v[110:111]
    v_cvt_pk_bf16_f32 v99, v108, v109
    buffer_store_dwordx2 v[98:99], v11, s[4:7], s37 offen offset:512 sc1
    v_smfmac_f32_16x16x64_bf16 v[112:115], v[32:35], v[64:71], v2
    ds_read_b128 v[64:67], v1 offset:32768
    ds_read_b128 v[68:71], v1 offset:33792
    v_smfmac_f32_16x16x64_bf16 v[116:119], v[32:35], v[72:79], v2
    ds_read_b128 v[72:75], v1 offset:34816
    ds_read_b128 v[76:79], v1 offset:35840
    v_smfmac_f32_16x16x64_bf16 v[112:115], v[36:39], v[80:87], v2
    ds_read_b128 v[80:83], v1 offset:49152
    ds_read_b128 v[84:87], v1 offset:50176
    v_smfmac_f32_16x16x64_bf16 v[116:119], v[36:39], v[88:95], v2
    ds_read_b128 v[88:91], v1 offset:51200
    ds_read_b128 v[92:95], v1 offset:52224
    s_waitcnt lgkmcnt(6)
    v_smfmac_f32_16x16x64_bf16 v[112:115], v[40:43], v[64:71], v2
    ds_read_b128 v[64:67], v5 offset:0
    ds_read_b128 v[68:71], v5 offset:1024
    s_waitcnt lgkmcnt(6)
    v_smfmac_f32_16x16x64_bf16 v[116:119], v[40:43], v[72:79], v2
    ds_read_b128 v[72:75], v5 offset:2048
    ds_read_b128 v[76:79], v5 offset:3072
    s_waitcnt lgkmcnt(6)
    v_smfmac_f32_16x16x64_bf16 v[112:115], v[44:47], v[80:87], v2
    ds_read_b128 v[80:83], v5 offset:16384
    ds_read_b128 v[84:87], v5 offset:17408
    s_waitcnt lgkmcnt(6)
    v_smfmac_f32_16x16x64_bf16 v[116:119], v[44:47], v[88:95], v2
    ds_read_b128 v[88:91], v5 offset:18432
    ds_read_b128 v[92:95], v5 offset:19456
    s_waitcnt lgkmcnt(6)
    v_smfmac_f32_16x16x64_bf16 v[112:115], v[48:51], v[64:71], v2
    ds_read_b128 v[64:67], v5 offset:32768
    ds_read_b128 v[68:71], v5 offset:33792
    s_waitcnt lgkmcnt(6)
    v_smfmac_f32_16x16x64_bf16 v[116:119], v[48:51], v[72:79], v2
    ds_read_b128 v[72:75], v5 offset:34816
    ds_read_b128 v[76:79], v5 offset:35840
    s_waitcnt lgkmcnt(6)
    v_smfmac_f32_16x16x64_bf16 v[112:115], v[52:55], v[80:87], v2
    ds_read_b128 v[80:83], v5 offset:49152
    ds_read_b128 v[84:87], v5 offset:50176
    s_waitcnt lgkmcnt(6)
    v_smfmac_f32_16x16x64_bf16 v[116:119], v[52:55], v[88:95], v2
    ds_read_b128 v[88:91], v5 offset:51200
    ds_read_b128 v[92:95], v5 offset:52224
    s_waitcnt lgkmcnt(6)
    v_smfmac_f32_16x16x64_bf16 v[112:115], v[56:59], v[64:71], v2
    s_waitcnt lgkmcnt(4)
    v_smfmac_f32_16x16x64_bf16 v[116:119], v[56:59], v[72:79], v2
    s_waitcnt lgkmcnt(2)
    v_smfmac_f32_16x16x64_bf16 v[112:115], v[60:63], v[80:87], v2
    s_waitcnt lgkmcnt(0)
    v_smfmac_f32_16x16x64_bf16 v[116:119], v[60:63], v[88:95], v2
    buffer_load_dwordx2 v[108:109], v11, s[4:7], s38 offen sc1
    v_mfma_f32_16x16x16_bf16 v[100:103], v[96:97], v[16:17], 0
    v_mfma_f32_16x16x16_bf16 v[104:107], v[98:99], v[16:17], 0
    s_nop 4
    v_add_f32 v112, v112, v114
    v_add_f32 v113, v113, v115
    v_add_f32 v114, v116, v118
    v_add_f32 v115, v117, v119
    v_cvt_pk_bf16_f32 v18, v112, v113
    v_cvt_pk_bf16_f32 v19, v114, v115
    v_and_or_b32 v18, v18, -2, s41
    buffer_load_dwordx2 v[110:111], v11, s[4:7], s38 offen offset:512 sc1
    s_barrier
    buffer_store_dwordx2 v[18:19], v11, s[4:7], s39 offen sc1
    v_mov_b32 v112, v18
    v_mov_b32 v114, v19
    v_mov_b32 v92, v28
    v_mov_b32 v93, 0
    s_waitcnt vmcnt(6)
    s_barrier
    ds_read_b128 v[32:35], v6 offset:9216
    ds_read_b128 v[36:39], v6 offset:10240
    ds_read_b128 v[40:43], v6 offset:14336
    ds_read_b128 v[44:47], v6 offset:15360
    ds_read_b128 v[48:51], v6 offset:19456
    ds_read_b128 v[52:55], v6 offset:20480
    ds_read_b128 v[56:59], v6 offset:24576
    ds_read_b128 v[60:63], v6 offset:25600
    buffer_load_dwordx2 v[20:21], v11, s[4:7], s38 offen sc1
    buffer_load_dwordx2 v[22:23], v11, s[4:7], s38 offen offset:512 sc1
    s_waitcnt vmcnt(4)
    v_mfma_f32_16x16x16_bf16 v[80:83], v[108:109], v[16:17], v[100:103]
    v_and_b32 v3, 1, v108
    v_cmp_ne_u32 vcc, s41, v3
    s_nop 5
    v_cvt_pk_bf16_f32 v64, v80, v81
    v_cvt_pk_bf16_f32 v65, v82, v83
    s_cbranch_vccnz mega_kernel_rf_w0_xslow
    s_waitcnt vmcnt(3)
    v_mfma_f32_16x16x16_bf16 v[84:87], v[110:111], v[16:17], v[104:107]
    v_and_b32 v3, 1, v110
    v_cmp_ne_u32 vcc, s41, v3
    s_nop 5
    v_cvt_pk_bf16_f32 v66, v84, v85
    v_cvt_pk_bf16_f32 v67, v86, v87
    ds_write_b128 v6, v[64:67] offset:8192
    s_cbranch_vccnz mega_kernel_rf_w0_xslow
mega_kernel_rf_w0_xok:
    s_cmp_eq_u32 s21, 63
    s_cbranch_scc1 mega_kernel_rf_w0_last
    buffer_load_dwordx2 v[116:117], v11, s[4:7], s40 offen sc1
    s_waitcnt lgkmcnt(1)
    v_mfma_f32_16x16x32_bf16 v[80:83], v[32:35], v[64:67], 0
    s_waitcnt lgkmcnt(0)
    s_barrier
    ds_read_b128 v[68:71], v6 offset:13312
    ds_read_b128 v[72:75], v6 offset:18432
    ds_read_b128 v[76:79], v6 offset:23552
    v_mfma_f32_16x16x32_bf16 v[84:87], v[36:39], v[64:67], 0
    v_mfma_f32_16x16x32_bf16 v[88:91], v[64:67], v[64:67], 0
    buffer_load_dwordx2 v[20:21], v11, s[4:7], s40 offen sc1
    s_waitcnt lgkmcnt(2)
    v_mfma_f32_16x16x32_bf16 v[80:83], v[40:43], v[68:71], v[80:83]
    buffer_store_dwordx4 v[64:67], v10, s[4:7], s45 offen offset:0 sc1
    s_waitcnt lgkmcnt(1)
    v_mfma_f32_16x16x32_bf16 v[80:83], v[48:51], v[72:75], v[80:83]
    s_waitcnt lgkmcnt(0)
    v_mfma_f32_16x16x32_bf16 v[80:83], v[56:59], v[76:79], v[80:83]
    v_mfma_f32_16x16x32_bf16 v[84:87], v[44:47], v[68:71], v[84:87]
    v_mfma_f32_16x16x32_bf16 v[84:87], v[52:55], v[72:75], v[84:87]
    buffer_store_dwordx2 v[18:19], v11, s[4:7], s51 offen offset:2048 sc1
    v_mfma_f32_16x16x32_bf16 v[84:87], v[60:63], v[76:79], v[84:87]
    v_mfma_f32_16x16x32_bf16 v[88:91], v[68:71], v[68:71], v[88:91]
    v_mfma_f32_16x16x32_bf16 v[88:91], v[72:75], v[72:75], v[88:91]
    v_mfma_f32_16x16x32_bf16 v[88:91], v[76:79], v[76:79], v[88:91]
    v_mfma_f32_32x32x4_2b_bf16 v[32:63], v[14:15], v[14:15], 0
    s_nop 0
    v_max3_f32 v4, v80, v81, v82
    s_nop 1
    v_max3_f32 v4, v4, v83, v84
    v_max3_f32 v4, v4, v85, v86
    v_max_f32 v4, v4, v87
    v_max3_f32 v90, v4, v88, v89
    v_max3_f32 v4, v4, v88, v89
    s_nop 1
    v_permlane16_swap_b32 v4, v90
    v_max_f32 v4, v4, v90
    v_max_f32 v90, v4, v90
    s_nop 1
    v_permlane32_swap_b32 v4, v90
    v_max_f32 v4, v4, v90
    v_mul_f32 v4, s34, v4
    v_pk_fma_f32 v[80:81], v[80:81], s[34:35], v[4:5] op_sel_hi:[1,0,0] neg_lo:[0,0,1] neg_hi:[0,0,1]
    v_pk_fma_f32 v[82:83], v[82:83], s[34:35], v[4:5] op_sel_hi:[1,0,0] neg_lo:[0,0,1] neg_hi:[0,0,1]
    v_pk_fma_f32 v[84:85], v[84:85], s[34:35], v[4:5] op_sel_hi:[1,0,0] neg_lo:[0,0,1] neg_hi:[0,0,1]
    v_pk_fma_f32 v[86:87], v[86:87], s[34:35], v[4:5] op_sel_hi:[1,0,0] neg_lo:[0,0,1] neg_hi:[0,0,1]
    v_pk_fma_f32 v[88:89], v[88:89], s[34:35], v[4:5] op_sel_hi:[1,0,0] neg_lo:[0,0,1] neg_hi:[0,0,1]
    v_exp_f32 v80, v80
    v_exp_f32 v81, v81
    v_exp_f32 v82, v82
    v_cvt_pk_bf16_f32 v68, v80, v81
    v_exp_f32 v83, v83
    v_exp_f32 v84, v84
    v_cvt_pk_bf16_f32 v69, v82, v83
    v_exp_f32 v85, v85
    v_exp_f32 v86, v86
    v_cvt_pk_bf16_f32 v70, v84, v85
    v_exp_f32 v87, v87
    v_exp_f32 v88, v88
    v_cvt_pk_bf16_f32 v71, v86, v87
    v_exp_f32 v89, v89
    s_waitcnt vmcnt(3)
    v_mfma_f32_16x16x32_bf16 v[76:79], v[28:31], v[68:71], 0
    v_and_b32 v3, 1, v116
    v_cvt_pk_bf16_f32 v72, v88, v89
    v_mfma_f32_16x16x32_bf16 v[100:103], v[120:123], v[68:71], 0
    v_cmp_ne_u32 vcc, s41, v3
    v_cvt_pk_bf16_f32 v73, v88, v89
    v_mfma_f32_16x16x32_bf16 v[104:107], v[124:127], v[68:71], 0
    v_mov_b32 v113, v116
    v_mov_b32 v115, v117
    v_mfma_f32_16x16x16_bf16 v[76:79], v[92:93], v[72:73], v[76:79]
    s_cbranch_vccnz mega_kernel_rf_w0_pv0
mega_kernel_rf_w0_pv2:
    v_mfma_f32_16x16x16_bf16 v[100:103], v[112:113], v[72:73], v[100:103]
    v_mfma_f32_16x16x16_bf16 v[104:107], v[114:115], v[72:73], v[104:107]
    buffer_load_dwordx4 v[120:123], v1, s[4:7], s44 offen
    buffer_load_dwordx4 v[124:127], v1, s[4:7], s44 offen offset:1024
    s_nop 2
    v_rcp_f32 v76, v76
    s_mov_b64 exec, s[28:29]
    v_pk_mul_f32 v[100:101], v[100:101], v[76:77] op_sel_hi:[1,0]
    v_pk_mul_f32 v[102:103], v[102:103], v[76:77] op_sel_hi:[1,0]
    v_pk_mul_f32 v[104:105], v[104:105], v[76:77] op_sel_hi:[1,0]
    v_pk_mul_f32 v[106:107], v[106:107], v[76:77] op_sel_hi:[1,0]
    v_cvt_pk_bf16_f32 v84, v100, v101
    v_cvt_pk_bf16_f32 v85, v102, v103
    v_cvt_pk_bf16_f32 v86, v104, v105
    v_cvt_pk_bf16_f32 v87, v106, v107
    ds_write_b128 v6, v[84:87] offset:28640
    s_mov_b64 exec, -1
    s_waitcnt lgkmcnt(0)
    s_barrier
    ds_read_b128 v[68:71], v6 offset:28672
    ds_read_b128 v[72:75], v6 offset:29696
    s_waitcnt lgkmcnt(1)
    v_smfmac_f32_16x16x64_bf16 v[32:35], v[68:71], v[128:135], v2
    s_add_u32 s21, s21, 1
    s_xor_b32 s38, s38, 1048576
    s_xor_b32 s37, s37, 1048576
    s_waitcnt lgkmcnt(0)
    v_smfmac_f32_16x16x64_bf16 v[32:35], v[72:75], v[136:143], v2
    s_xor_b32 s40, s40, 1048576
    s_xor_b32 s39, s39, 1048576
    s_lshr_b32 s41, s21, 1
    v_smfmac_f32_16x16x64_bf16 v[36:39], v[68:71], v[144:151], v2
    s_and_b32 s41, s41, 1
    s_xor_b32 s41, s41, 1
    s_xor_b32 s35, s35, 16384
    v_smfmac_f32_16x16x64_bf16 v[36:39], v[72:75], v[152:159], v2
    v_add_f32 v32, v32, v34
    s_xor_b32 s36, s36, 16384
    s_add_u32 s43, s43, 262144
    s_add_u32 s44, s44, 262144
    v_smfmac_f32_16x16x64_bf16 v[40:43], v[68:71], v[160:167], v2
    v_add_f32 v33, v33, v35
    v_smfmac_f32_16x16x64_bf16 v[40:43], v[72:75], v[168:175], v2
    v_cvt_pk_bf16_f32 v32, v32, v33
    v_smfmac_f32_16x16x64_bf16 v[44:47], v[68:71], v[176:183], v2
    v_and_or_b32 v32, v32, -2, s42
    v_smfmac_f32_16x16x64_bf16 v[44:47], v[72:75], v[184:191], v2
    v_add_f32 v36, v36, v38
    v_smfmac_f32_16x16x64_bf16 v[48:51], v[68:71], v[192:199], v2
    v_add_f32 v37, v37, v39
    v_smfmac_f32_16x16x64_bf16 v[48:51], v[72:75], v[200:207], v2
    v_cvt_pk_bf16_f32 v33, v36, v37
    v_smfmac_f32_16x16x64_bf16 v[52:55], v[68:71], v[208:215], v2
    v_add_f32 v40, v40, v42
    v_smfmac_f32_16x16x64_bf16 v[52:55], v[72:75], v[216:223], v2
    v_add_f32 v41, v41, v43
    v_smfmac_f32_16x16x64_bf16 v[56:59], v[68:71], v[224:231], v2
    v_cvt_pk_bf16_f32 v34, v40, v41
    v_smfmac_f32_16x16x64_bf16 v[56:59], v[72:75], v[232:239], v2
    v_add_f32 v44, v44, v46
    v_smfmac_f32_16x16x64_bf16 v[60:63], v[68:71], v[240:247], v2
    v_add_f32 v45, v45, v47
    v_smfmac_f32_16x16x64_bf16 v[60:63], v[72:75], v[248:255], v2
    v_cvt_pk_bf16_f32 v35, v44, v45
    buffer_store_dwordx4 v[32:35], v8, s[4:7], s46 offen
    v_pk_add_f32 v[48:49], v[48:49], v[50:51]
    v_cvt_pk_bf16_f32 v48, v48, v49
    v_and_or_b32 v48, v48, -2, s42
    v_pk_add_f32 v[52:53], v[52:53], v[54:55]
    v_cvt_pk_bf16_f32 v49, v52, v53
    v_pk_add_f32 v[56:57], v[56:57], v[58:59]
    v_cvt_pk_bf16_f32 v50, v56, v57
    v_pk_add_f32 v[60:61], v[60:61], v[62:63]
    v_cvt_pk_bf16_f32 v51, v60, v61
    buffer_store_dwordx4 v[48:51], v8, s[4:7], s61 offen
    s_add_u32 s45, s45, 262144
    s_add_u32 s51, s51, 262144
    v_mfma_f32_32x32x8_bf16 v[96:111], v[14:15], v[14:15], 0
    v_mfma_f32_16x16x16_bf16 v[112:115], v[14:15], v[14:15], 0
    v_mfma_f32_16x16x16_bf16 v[116:119], v[14:15], v[14:15], 0
    ds_read_b128 v[64:67], v1 offset:0
    ds_read_b128 v[68:71], v1 offset:1024
    ds_read_b128 v[72:75], v1 offset:2048
    ds_read_b128 v[76:79], v1 offset:3072
    ds_read_b128 v[80:83], v1 offset:16384
    ds_read_b128 v[84:87], v1 offset:17408
    ds_read_b128 v[88:91], v1 offset:18432
    ds_read_b128 v[92:95], v1 offset:19456
    v_mov_b32 v58, -1
    v_mov_b32 v59, -1
    s_waitcnt vmcnt(0)
mega_kernel_rf_w0_cgo:
mega_kernel_rf_w0_pc:
    buffer_load_dword v36, v13, s[4:7], s25 offen offset:0 sc1
    buffer_load_dword v37, v13, s[4:7], s25 offen offset:256 sc1
    buffer_load_dword v38, v13, s[4:7], s25 offen offset:512 sc1
    buffer_load_dword v39, v13, s[4:7], s25 offen offset:768 sc1
    buffer_load_dword v40, v13, s[4:7], s25 offen offset:1024 sc1
    buffer_load_dword v41, v13, s[4:7], s25 offen offset:1280 sc1
    buffer_load_dword v42, v13, s[4:7], s25 offen offset:1536 sc1
    buffer_load_dword v43, v13, s[4:7], s25 offen offset:1792 sc1
    s_waitcnt vmcnt(4)
    v_mfma_f32_16x16x32_bf16 v[52:55], v[36:39], v[24:27], 0
    v_bitop3_b32 v3, s42, v36, v37 bitop3:0x7e
    v_bitop3_b32 v4, s42, v38, v39 bitop3:0x7e
    s_waitcnt vmcnt(2)
    v_or_b32 v3, v3, v4
    v_bitop3_b32 v4, s42, v40, v41 bitop3:0x7e
    s_waitcnt vmcnt(0)
    v_mfma_f32_16x16x32_bf16 v[52:55], v[40:43], v[24:27], v[52:55]
    v_bitop3_b32 v56, s42, v42, v43 bitop3:0x7e
    v_or3_b32 v3, v3, v4, v56
    v_and_b32 v3, v0, v3
    v_cmp_ne_u32 vcc, 0, v3
    s_nop 3
    v_cvt_pk_bf16_f32 v56, v52, v53
    v_cvt_pk_bf16_f32 v57, v54, v55
    v_min_u32 v56, -2, v56
    s_cbranch_vccnz mega_kernel_rf_w0_pc
    s_mov_b64 exec, s[26:27]
    buffer_store_dwordx2 v[56:57], v9, s[4:7], s35 offen offset:0
    buffer_store_dwordx2 v[58:59], v9, s[4:7], s36 offen offset:0
    s_mov_b64 exec, -1
    s_xor_b32 s42, s42, 1
    s_branch mega_kernel_rf_w0_loop
mega_kernel_rf_w0_last:
    buffer_store_dwordx4 v[64:67], v10, s[4:7], s45 offen offset:0 sc1
    buffer_store_dwordx2 v[18:19], v11, s[4:7], s51 offen offset:2048 sc1
    s_branch mega_kernel_rf_end
mega_kernel_rf_w0_pafail:
    s_nop 7
    v_mov_b32 v96, 0
    v_mov_b32 v97, 0
    v_mov_b32 v98, 0
    v_mov_b32 v99, 0
    v_mov_b32 v100, 0
    v_mov_b32 v101, 0
    v_mov_b32 v102, 0
    v_mov_b32 v103, 0
    v_mov_b32 v104, 0
    v_mov_b32 v105, 0
    v_mov_b32 v106, 0
    v_mov_b32 v107, 0
    s_branch mega_kernel_rf_w0_pa
mega_kernel_rf_w0_xslow:
    buffer_load_dwordx2 v[108:109], v11, s[4:7], s38 offen sc1
    buffer_load_dwordx2 v[110:111], v11, s[4:7], s38 offen offset:512 sc1
    s_waitcnt vmcnt(2)
    v_bitop3_b32 v3, s41, v20, v22 bitop3:0x7e
    v_mfma_f32_16x16x16_bf16 v[80:83], v[20:21], v[16:17], v[100:103]
    v_and_b32 v3, 1, v3
    v_mfma_f32_16x16x16_bf16 v[84:87], v[22:23], v[16:17], v[104:107]
    v_cmp_ne_u32 vcc, 0, v3
    s_cbranch_vccz mega_kernel_rf_w0_xgot
    buffer_load_dwordx2 v[20:21], v11, s[4:7], s38 offen sc1
    buffer_load_dwordx2 v[22:23], v11, s[4:7], s38 offen offset:512 sc1
    s_waitcnt vmcnt(2)
    v_bitop3_b32 v3, s41, v108, v110 bitop3:0x7e
    v_mfma_f32_16x16x16_bf16 v[80:83], v[108:109], v[16:17], v[100:103]
    v_and_b32 v3, 1, v3
    v_mfma_f32_16x16x16_bf16 v[84:87], v[110:111], v[16:17], v[104:107]
    v_cmp_ne_u32 vcc, 0, v3
    s_cbranch_vccz mega_kernel_rf_w0_xgot
    s_branch mega_kernel_rf_w0_xslow
mega_kernel_rf_w0_xgot:
    s_nop 3
    v_cvt_pk_bf16_f32 v64, v80, v81
    v_cvt_pk_bf16_f32 v65, v82, v83
    v_cvt_pk_bf16_f32 v66, v84, v85
    v_cvt_pk_bf16_f32 v67, v86, v87
    ds_write_b128 v6, v[64:67] offset:8192
    s_branch mega_kernel_rf_w0_xok
mega_kernel_rf_w0_pv0:
    s_waitcnt vmcnt(2)
    s_branch mega_kernel_rf_w0_pv1
mega_kernel_rf_w0_pv:
    buffer_load_dwordx2 v[20:21], v11, s[4:7], s40 offen sc1
    s_waitcnt vmcnt(0)
mega_kernel_rf_w0_pv1:
    v_and_b32 v3, 1, v20
    v_cmp_ne_u32 vcc, s41, v3
    v_mov_b32 v113, v20
    v_mov_b32 v115, v21
    s_cbranch_vccnz mega_kernel_rf_w0_pv
    s_branch mega_kernel_rf_w0_pv2
mega_kernel_rf_w1_entry:
    v_mfma_f32_32x32x8_bf16 v[96:111], v[14:15], v[14:15], 0
    v_mfma_f32_16x16x16_bf16 v[112:115], v[14:15], v[14:15], 0
    v_mfma_f32_16x16x16_bf16 v[116:119], v[14:15], v[14:15], 0
    ds_read_b128 v[64:67], v1 offset:4096
    ds_read_b128 v[68:71], v1 offset:5120
    ds_read_b128 v[72:75], v1 offset:6144
    ds_read_b128 v[76:79], v1 offset:7168
    ds_read_b128 v[80:83], v1 offset:20480
    ds_read_b128 v[84:87], v1 offset:21504
    ds_read_b128 v[88:91], v1 offset:22528
    ds_read_b128 v[92:95], v1 offset:23552
    buffer_load_dwordx4 v[120:123], v1, s[4:7], s44 offen
    buffer_load_dwordx4 v[124:127], v1, s[4:7], s44 offen offset:1024
    s_add_u32 s44, s44, 262144
mega_kernel_rf_w1_loop:
    s_add_u32 s22, s35, 2048
    s_waitcnt vmcnt(0)
    buffer_load_dwordx4 v[40:43], v1, s[4:7], s22 offen sc1
    buffer_load_dwordx4 v[44:47], v1, s[4:7], s22 offen offset:1024 sc1
mega_kernel_rf_w1_pa:
    s_waitcnt vmcnt(1)
    ds_write_b128 v6, v[40:43] offset:2048
    s_waitcnt vmcnt(0)
    ds_write_b128 v6, v[44:47] offset:3072
    v_max3_u32 v3, v40, v42, v44
    v_max_u32 v3, v3, v46
    v_cmp_eq_u32 vcc, -1, v3
    v_smfmac_f32_16x16x64_bf16 v[96:99], v[40:43], a[32:39], v2
    buffer_load_dwordx4 v[40:43], v1, s[4:7], s22 offen sc1
    v_smfmac_f32_16x16x64_bf16 v[100:103], v[40:43], a[40:47], v2
    buffer_load_dwordx4 v[44:47], v1, s[4:7], s22 offen offset:1024 sc1
    v_smfmac_f32_16x16x64_bf16 v[104:107], v[40:43], a[160:167], v2
    s_cbranch_vccnz mega_kernel_rf_w1_pafail
    s_waitcnt lgkmcnt(0)
    s_barrier
    ds_read_b128 v[48:51], v6 offset:4096
    ds_read_b128 v[52:55], v6 offset:5120
    v_smfmac_f32_16x16x64_bf16 v[108:111], v[40:43], a[168:175], v2
    ds_read_b128 v[56:59], v6 offset:6144
    v_smfmac_f32_16x16x64_bf16 v[96:99], v[44:47], a[48:55], v2
    ds_read_b128 v[60:63], v6 offset:7168
    v_smfmac_f32_16x16x64_bf16 v[100:103], v[44:47], a[56:63], v2
    ds_read_b128 v[32:35], v6 offset:0
    v_smfmac_f32_16x16x64_bf16 v[104:107], v[44:47], a[176:183], v2
    ds_read_b128 v[36:39], v6 offset:1024
    v_smfmac_f32_16x16x64_bf16 v[108:111], v[44:47], a[184:191], v2
    s_waitcnt lgkmcnt(5)
    v_smfmac_f32_16x16x64_bf16 v[96:99], v[48:51], a[64:71], v2
    buffer_load_dwordx4 v1, s[4:7], s43 offen lds
    v_smfmac_f32_16x16x64_bf16 v[104:107], v[48:51], a[192:199], v2
    s_waitcnt lgkmcnt(4)
    v_smfmac_f32_16x16x64_bf16 v[96:99], v[52:55], a[80:87], v2
    v_smfmac_f32_16x16x64_bf16 v[104:107], v[52:55], a[208:215], v2
    s_waitcnt lgkmcnt(3)
    v_smfmac_f32_16x16x64_bf16 v[96:99], v[56:59], a[96:103], v2
    buffer_load_dwordx4 v1, s[4:7], s43 offen offset:1024 lds
    v_smfmac_f32_16x16x64_bf16 v[104:107], v[56:59], a[224:231], v2
    s_waitcnt lgkmcnt(2)
    v_smfmac_f32_16x16x64_bf16 v[96:99], v[60:63], a[112:119], v2
    v_smfmac_f32_16x16x64_bf16 v[104:107], v[60:63], a[240:247], v2
    s_waitcnt lgkmcnt(1)
    v_smfmac_f32_16x16x64_bf16 v[96:99], v[32:35], a[0:7], v2
    v_smfmac_f32_16x16x64_bf16 v[104:107], v[32:35], a[128:135], v2
    s_waitcnt lgkmcnt(0)
    v_smfmac_f32_16x16x64_bf16 v[96:99], v[36:39], a[16:23], v2
    v_smfmac_f32_16x16x64_bf16 v[104:107], v[36:39], a[144:151], v2
    v_smfmac_f32_16x16x64_bf16 v[100:103], v[48:51], a[72:79], v2
    s_nop 2
    v_smfmac_f32_16x16x64_bf16 v[100:103], v[52:55], a[88:95], v2
    s_nop 1
    v_add_f32 v96, v96, v98
    v_smfmac_f32_16x16x64_bf16 v[100:103], v[56:59], a[104:111], v2
    v_add_f32 v97, v97, v99
    v_add_f32 v104, v104, v106
    v_smfmac_f32_16x16x64_bf16 v[100:103], v[60:63], a[120:127], v2
    v_add_f32 v105, v105, v107
    v_cvt_pk_bf16_f32 v96, v96, v97
    v_smfmac_f32_16x16x64_bf16 v[100:103], v[32:35], a[8:15], v2
    v_cvt_pk_bf16_f32 v97, v104, v105
    v_and_or_b32 v96, v96, -2, s41
    v_smfmac_f32_16x16x64_bf16 v[100:103], v[36:39], a[24:31], v2
    buffer_store_dwordx2 v[96:97], v11, s[4:7], s37 offen sc1
    v_smfmac_f32_16x16x64_bf16 v[108:111], v[48:51], a[200:207], v2
    v_smfmac_f32_16x16x64_bf16 v[108:111], v[52:55], a[216:223], v2
    v_smfmac_f32_16x16x64_bf16 v[108:111], v[56:59], a[232:239], v2
    v_smfmac_f32_16x16x64_bf16 v[108:111], v[60:63], a[248:255], v2
    v_smfmac_f32_16x16x64_bf16 v[108:111], v[32:35], a[136:143], v2
    s_nop 2
    v_add_f32 v100, v100, v102
    v_smfmac_f32_16x16x64_bf16 v[108:111], v[36:39], a[152:159], v2
    v_add_f32 v101, v101, v103
    v_cvt_pk_bf16_f32 v98, v100, v101
    v_and_or_b32 v98, v98, -2, s41
    s_nop 4
    v_pk_add_f32 v[108:109], v[108:109], v[110:111]
    v_cvt_pk_bf16_f32 v99, v108, v109
    buffer_store_dwordx2 v[98:99], v11, s[4:7], s37 offen offset:512 sc1
    v_smfmac_f32_16x16x64_bf16 v[112:115], v[32:35], v[64:71], v2
    ds_read_b128 v[64:67], v1 offset:36864
    ds_read_b128 v[68:71], v1 offset:37888
    v_smfmac_f32_16x16x64_bf16 v[116:119], v[32:35], v[72:79], v2
    ds_read_b128 v[72:75], v1 offset:38912
    ds_read_b128 v[76:79], v1 offset:39936
    v_smfmac_f32_16x16x64_bf16 v[112:115], v[36:39], v[80:87], v2
    ds_read_b128 v[80:83], v1 offset:53248
    ds_read_b128 v[84:87], v1 offset:54272
    v_smfmac_f32_16x16x64_bf16 v[116:119], v[36:39], v[88:95], v2
    ds_read_b128 v[88:91], v1 offset:55296
    ds_read_b128 v[92:95], v1 offset:56320
    s_waitcnt lgkmcnt(6)
    v_smfmac_f32_16x16x64_bf16 v[112:115], v[40:43], v[64:71], v2
    ds_read_b128 v[64:67], v5 offset:4096
    ds_read_b128 v[68:71], v5 offset:5120
    s_waitcnt lgkmcnt(6)
    v_smfmac_f32_16x16x64_bf16 v[116:119], v[40:43], v[72:79], v2
    ds_read_b128 v[72:75], v5 offset:6144
    ds_read_b128 v[76:79], v5 offset:7168
    s_waitcnt lgkmcnt(6)
    v_smfmac_f32_16x16x64_bf16 v[112:115], v[44:47], v[80:87], v2
    ds_read_b128 v[80:83], v5 offset:20480
    ds_read_b128 v[84:87], v5 offset:21504
    s_waitcnt lgkmcnt(6)
    v_smfmac_f32_16x16x64_bf16 v[116:119], v[44:47], v[88:95], v2
    ds_read_b128 v[88:91], v5 offset:22528
    ds_read_b128 v[92:95], v5 offset:23552
    s_waitcnt lgkmcnt(6)
    v_smfmac_f32_16x16x64_bf16 v[112:115], v[48:51], v[64:71], v2
    ds_read_b128 v[64:67], v5 offset:36864
    ds_read_b128 v[68:71], v5 offset:37888
    s_waitcnt lgkmcnt(6)
    v_smfmac_f32_16x16x64_bf16 v[116:119], v[48:51], v[72:79], v2
    ds_read_b128 v[72:75], v5 offset:38912
    ds_read_b128 v[76:79], v5 offset:39936
    s_waitcnt lgkmcnt(6)
    v_smfmac_f32_16x16x64_bf16 v[112:115], v[52:55], v[80:87], v2
    ds_read_b128 v[80:83], v5 offset:53248
    ds_read_b128 v[84:87], v5 offset:54272
    s_waitcnt lgkmcnt(6)
    v_smfmac_f32_16x16x64_bf16 v[116:119], v[52:55], v[88:95], v2
    ds_read_b128 v[88:91], v5 offset:55296
    ds_read_b128 v[92:95], v5 offset:56320
    s_waitcnt lgkmcnt(6)
    v_smfmac_f32_16x16x64_bf16 v[112:115], v[56:59], v[64:71], v2
    s_waitcnt lgkmcnt(4)
    v_smfmac_f32_16x16x64_bf16 v[116:119], v[56:59], v[72:79], v2
    s_waitcnt lgkmcnt(2)
    v_smfmac_f32_16x16x64_bf16 v[112:115], v[60:63], v[80:87], v2
    s_waitcnt lgkmcnt(0)
    v_smfmac_f32_16x16x64_bf16 v[116:119], v[60:63], v[88:95], v2
    buffer_load_dwordx2 v[108:109], v11, s[4:7], s38 offen sc1
    v_mfma_f32_16x16x16_bf16 v[100:103], v[96:97], v[16:17], 0
    v_mfma_f32_16x16x16_bf16 v[104:107], v[98:99], v[16:17], 0
    s_nop 4
    v_add_f32 v112, v112, v114
    v_add_f32 v113, v113, v115
    v_add_f32 v114, v116, v118
    v_add_f32 v115, v117, v119
    v_cvt_pk_bf16_f32 v18, v112, v113
    v_cvt_pk_bf16_f32 v19, v114, v115
    v_and_or_b32 v18, v18, -2, s41
    buffer_load_dwordx2 v[110:111], v11, s[4:7], s38 offen offset:512 sc1
    s_barrier
    buffer_store_dwordx2 v[18:19], v11, s[4:7], s39 offen sc1
    v_mov_b32 v112, v18
    v_mov_b32 v114, v19
    v_mov_b32 v92, v28
    v_mov_b32 v93, 0
    s_waitcnt vmcnt(5)
    s_barrier
    ds_read_b128 v[32:35], v6 offset:14336
    ds_read_b128 v[36:39], v6 offset:15360
    ds_read_b128 v[40:43], v6 offset:9216
    ds_read_b128 v[44:47], v6 offset:10240
    ds_read_b128 v[48:51], v6 offset:24576
    ds_read_b128 v[52:55], v6 offset:25600
    ds_read_b128 v[56:59], v6 offset:19456
    ds_read_b128 v[60:63], v6 offset:20480
    buffer_load_dwordx2 v[20:21], v11, s[4:7], s38 offen sc1
    buffer_load_dwordx2 v[22:23], v11, s[4:7], s38 offen offset:512 sc1
    s_waitcnt vmcnt(4)
    v_mfma_f32_16x16x16_bf16 v[80:83], v[108:109], v[16:17], v[100:103]
    v_and_b32 v3, 1, v108
    v_cmp_ne_u32 vcc, s41, v3
    s_nop 5
    v_cvt_pk_bf16_f32 v64, v80, v81
    v_cvt_pk_bf16_f32 v65, v82, v83
    s_cbranch_vccnz mega_kernel_rf_w1_xslow
    s_waitcnt vmcnt(3)
    v_mfma_f32_16x16x16_bf16 v[84:87], v[110:111], v[16:17], v[104:107]
    v_and_b32 v3, 1, v110
    v_cmp_ne_u32 vcc, s41, v3
    s_nop 5
    v_cvt_pk_bf16_f32 v66, v84, v85
    v_cvt_pk_bf16_f32 v67, v86, v87
    ds_write_b128 v6, v[64:67] offset:13312
    s_cbranch_vccnz mega_kernel_rf_w1_xslow
mega_kernel_rf_w1_xok:
    s_cmp_eq_u32 s21, 63
    s_cbranch_scc1 mega_kernel_rf_w1_last
    buffer_load_dwordx2 v[116:117], v11, s[4:7], s40 offen sc1
    s_waitcnt lgkmcnt(1)
    v_mfma_f32_16x16x32_bf16 v[80:83], v[32:35], v[64:67], 0
    s_waitcnt lgkmcnt(0)
    s_barrier
    ds_read_b128 v[68:71], v6 offset:8192
    ds_read_b128 v[72:75], v6 offset:23552
    ds_read_b128 v[76:79], v6 offset:18432
    v_mfma_f32_16x16x32_bf16 v[84:87], v[36:39], v[64:67], 0
    v_mfma_f32_16x16x32_bf16 v[88:91], v[64:67], v[64:67], 0
    buffer_load_dwordx2 v[20:21], v11, s[4:7], s40 offen sc1
    s_waitcnt lgkmcnt(2)
    v_mfma_f32_16x16x32_bf16 v[80:83], v[40:43], v[68:71], v[80:83]
    s_waitcnt lgkmcnt(1)
    v_mfma_f32_16x16x32_bf16 v[80:83], v[48:51], v[72:75], v[80:83]
    buffer_store_dwordx4 v[64:67], v10, s[4:7], s45 offen offset:64 sc1
    s_waitcnt lgkmcnt(0)
    v_mfma_f32_16x16x32_bf16 v[80:83], v[56:59], v[76:79], v[80:83]
    v_mfma_f32_16x16x32_bf16 v[84:87], v[44:47], v[68:71], v[84:87]
    v_mfma_f32_16x16x32_bf16 v[84:87], v[52:55], v[72:75], v[84:87]
    v_mfma_f32_16x16x32_bf16 v[84:87], v[60:63], v[76:79], v[84:87]
    buffer_store_dwordx2 v[18:19], v11, s[4:7], s51 offen offset:2560 sc1
    v_mfma_f32_16x16x32_bf16 v[88:91], v[68:71], v[68:71], v[88:91]
    v_mfma_f32_16x16x32_bf16 v[88:91], v[72:75], v[72:75], v[88:91]
    v_mfma_f32_16x16x32_bf16 v[88:91], v[76:79], v[76:79], v[88:91]
    v_mfma_f32_32x32x4_2b_bf16 v[32:63], v[14:15], v[14:15], 0
    s_nop 0
    v_max3_f32 v4, v80, v81, v82
    s_nop 1
    v_max3_f32 v4, v4, v83, v84
    v_max3_f32 v4, v4, v85, v86
    v_max_f32 v4, v4, v87
    v_max3_f32 v90, v4, v88, v89
    v_max3_f32 v4, v4, v88, v89
    s_nop 1
    v_permlane16_swap_b32 v4, v90
    v_max_f32 v4, v4, v90
    v_max_f32 v90, v4, v90
    s_nop 1
    v_permlane32_swap_b32 v4, v90
    v_max_f32 v4, v4, v90
    v_mul_f32 v4, s34, v4
    v_pk_fma_f32 v[80:81], v[80:81], s[34:35], v[4:5] op_sel_hi:[1,0,0] neg_lo:[0,0,1] neg_hi:[0,0,1]
    v_pk_fma_f32 v[82:83], v[82:83], s[34:35], v[4:5] op_sel_hi:[1,0,0] neg_lo:[0,0,1] neg_hi:[0,0,1]
    v_pk_fma_f32 v[84:85], v[84:85], s[34:35], v[4:5] op_sel_hi:[1,0,0] neg_lo:[0,0,1] neg_hi:[0,0,1]
    v_pk_fma_f32 v[86:87], v[86:87], s[34:35], v[4:5] op_sel_hi:[1,0,0] neg_lo:[0,0,1] neg_hi:[0,0,1]
    v_pk_fma_f32 v[88:89], v[88:89], s[34:35], v[4:5] op_sel_hi:[1,0,0] neg_lo:[0,0,1] neg_hi:[0,0,1]
    v_exp_f32 v80, v80
    v_exp_f32 v81, v81
    v_exp_f32 v82, v82
    v_cvt_pk_bf16_f32 v68, v80, v81
    v_exp_f32 v83, v83
    v_exp_f32 v84, v84
    v_cvt_pk_bf16_f32 v69, v82, v83
    v_exp_f32 v85, v85
    v_exp_f32 v86, v86
    v_cvt_pk_bf16_f32 v70, v84, v85
    v_exp_f32 v87, v87
    v_exp_f32 v88, v88
    v_cvt_pk_bf16_f32 v71, v86, v87
    v_exp_f32 v89, v89
    s_waitcnt vmcnt(3)
    v_mfma_f32_16x16x32_bf16 v[76:79], v[28:31], v[68:71], 0
    v_and_b32 v3, 1, v116
    v_cvt_pk_bf16_f32 v72, v88, v89
    v_mfma_f32_16x16x32_bf16 v[100:103], v[120:123], v[68:71], 0
    v_cmp_ne_u32 vcc, s41, v3
    v_cvt_pk_bf16_f32 v73, v88, v89
    v_mfma_f32_16x16x32_bf16 v[104:107], v[124:127], v[68:71], 0
    v_mov_b32 v113, v116
    v_mov_b32 v115, v117
    v_mfma_f32_16x16x16_bf16 v[76:79], v[92:93], v[72:73], v[76:79]
    s_cbranch_vccnz mega_kernel_rf_w1_pv0
mega_kernel_rf_w1_pv2:
    v_mfma_f32_16x16x16_bf16 v[100:103], v[112:113], v[72:73], v[100:103]
    v_mfma_f32_16x16x16_bf16 v[104:107], v[114:115], v[72:73], v[104:107]
    buffer_load_dwordx4 v[120:123], v1, s[4:7], s44 offen
    buffer_load_dwordx4 v[124:127], v1, s[4:7], s44 offen offset:1024
    s_nop 2
    v_rcp_f32 v76, v76
    s_mov_b64 exec, s[28:29]
    v_pk_mul_f32 v[100:101], v[100:101], v[76:77] op_sel_hi:[1,0]
    v_pk_mul_f32 v[102:103], v[102:103], v[76:77] op_sel_hi:[1,0]
    v_pk_mul_f32 v[104:105], v[104:105], v[76:77] op_sel_hi:[1,0]
    v_pk_mul_f32 v[106:107], v[106:107], v[76:77] op_sel_hi:[1,0]
    v_cvt_pk_bf16_f32 v84, v100, v101
    v_cvt_pk_bf16_f32 v85, v102, v103
    v_cvt_pk_bf16_f32 v86, v104, v105
    v_cvt_pk_bf16_f32 v87, v106, v107
    ds_write_b128 v6, v[84:87] offset:28672
    s_mov_b64 exec, -1
    s_waitcnt lgkmcnt(0)
    s_barrier
    ds_read_b128 v[68:71], v6 offset:28672
    ds_read_b128 v[72:75], v6 offset:29696
    s_waitcnt lgkmcnt(1)
    v_smfmac_f32_16x16x64_bf16 v[32:35], v[68:71], v[128:135], v2
    s_add_u32 s21, s21, 1
    s_xor_b32 s38, s38, 1048576
    s_xor_b32 s37, s37, 1048576
    s_waitcnt lgkmcnt(0)
    v_smfmac_f32_16x16x64_bf16 v[32:35], v[72:75], v[136:143], v2
    s_xor_b32 s40, s40, 1048576
    s_xor_b32 s39, s39, 1048576
    s_lshr_b32 s41, s21, 1
    v_smfmac_f32_16x16x64_bf16 v[36:39], v[68:71], v[144:151], v2
    s_and_b32 s41, s41, 1
    s_xor_b32 s41, s41, 1
    s_xor_b32 s35, s35, 16384
    v_smfmac_f32_16x16x64_bf16 v[36:39], v[72:75], v[152:159], v2
    v_add_f32 v32, v32, v34
    s_xor_b32 s36, s36, 16384
    s_add_u32 s43, s43, 262144
    s_add_u32 s44, s44, 262144
    v_smfmac_f32_16x16x64_bf16 v[40:43], v[68:71], v[160:167], v2
    v_add_f32 v33, v33, v35
    v_smfmac_f32_16x16x64_bf16 v[40:43], v[72:75], v[168:175], v2
    v_cvt_pk_bf16_f32 v32, v32, v33
    v_smfmac_f32_16x16x64_bf16 v[44:47], v[68:71], v[176:183], v2
    v_and_or_b32 v32, v32, -2, s42
    v_smfmac_f32_16x16x64_bf16 v[44:47], v[72:75], v[184:191], v2
    v_add_f32 v36, v36, v38
    v_smfmac_f32_16x16x64_bf16 v[48:51], v[68:71], v[192:199], v2
    v_add_f32 v37, v37, v39
    v_smfmac_f32_16x16x64_bf16 v[48:51], v[72:75], v[200:207], v2
    v_cvt_pk_bf16_f32 v33, v36, v37
    v_smfmac_f32_16x16x64_bf16 v[52:55], v[68:71], v[208:215], v2
    v_add_f32 v40, v40, v42
    v_smfmac_f32_16x16x64_bf16 v[52:55], v[72:75], v[216:223], v2
    v_add_f32 v41, v41, v43
    v_smfmac_f32_16x16x64_bf16 v[56:59], v[68:71], v[224:231], v2
    v_cvt_pk_bf16_f32 v34, v40, v41
    v_smfmac_f32_16x16x64_bf16 v[56:59], v[72:75], v[232:239], v2
    v_add_f32 v44, v44, v46
    v_smfmac_f32_16x16x64_bf16 v[60:63], v[68:71], v[240:247], v2
    v_add_f32 v45, v45, v47
    v_smfmac_f32_16x16x64_bf16 v[60:63], v[72:75], v[248:255], v2
    v_cvt_pk_bf16_f32 v35, v44, v45
    buffer_store_dwordx4 v[32:35], v8, s[4:7], s46 offen
    v_pk_add_f32 v[48:49], v[48:49], v[50:51]
    v_cvt_pk_bf16_f32 v48, v48, v49
    v_and_or_b32 v48, v48, -2, s42
    v_pk_add_f32 v[52:53], v[52:53], v[54:55]
    v_cvt_pk_bf16_f32 v49, v52, v53
    v_pk_add_f32 v[56:57], v[56:57], v[58:59]
    v_cvt_pk_bf16_f32 v50, v56, v57
    v_pk_add_f32 v[60:61], v[60:61], v[62:63]
    v_cvt_pk_bf16_f32 v51, v60, v61
    buffer_store_dwordx4 v[48:51], v8, s[4:7], s61 offen
    s_add_u32 s45, s45, 262144
    s_add_u32 s51, s51, 262144
    v_mfma_f32_32x32x8_bf16 v[96:111], v[14:15], v[14:15], 0
    v_mfma_f32_16x16x16_bf16 v[112:115], v[14:15], v[14:15], 0
    v_mfma_f32_16x16x16_bf16 v[116:119], v[14:15], v[14:15], 0
    ds_read_b128 v[64:67], v1 offset:4096
    ds_read_b128 v[68:71], v1 offset:5120
    ds_read_b128 v[72:75], v1 offset:6144
    ds_read_b128 v[76:79], v1 offset:7168
    ds_read_b128 v[80:83], v1 offset:20480
    ds_read_b128 v[84:87], v1 offset:21504
    ds_read_b128 v[88:91], v1 offset:22528
    ds_read_b128 v[92:95], v1 offset:23552
    v_mov_b32 v58, -1
    v_mov_b32 v59, -1
    s_waitcnt vmcnt(0)
mega_kernel_rf_w1_cgo:
mega_kernel_rf_w1_pc:
    buffer_load_dword v36, v13, s[4:7], s25 offen offset:0 sc1
    buffer_load_dword v37, v13, s[4:7], s25 offen offset:256 sc1
    buffer_load_dword v38, v13, s[4:7], s25 offen offset:512 sc1
    buffer_load_dword v39, v13, s[4:7], s25 offen offset:768 sc1
    buffer_load_dword v40, v13, s[4:7], s25 offen offset:1024 sc1
    buffer_load_dword v41, v13, s[4:7], s25 offen offset:1280 sc1
    buffer_load_dword v42, v13, s[4:7], s25 offen offset:1536 sc1
    buffer_load_dword v43, v13, s[4:7], s25 offen offset:1792 sc1
    s_waitcnt vmcnt(4)
    v_mfma_f32_16x16x32_bf16 v[52:55], v[36:39], v[24:27], 0
    v_bitop3_b32 v3, s42, v36, v37 bitop3:0x7e
    v_bitop3_b32 v4, s42, v38, v39 bitop3:0x7e
    s_waitcnt vmcnt(2)
    v_or_b32 v3, v3, v4
    v_bitop3_b32 v4, s42, v40, v41 bitop3:0x7e
    s_waitcnt vmcnt(0)
    v_mfma_f32_16x16x32_bf16 v[52:55], v[40:43], v[24:27], v[52:55]
    v_bitop3_b32 v56, s42, v42, v43 bitop3:0x7e
    v_or3_b32 v3, v3, v4, v56
    v_and_b32 v3, v0, v3
    v_cmp_ne_u32 vcc, 0, v3
    s_nop 3
    v_cvt_pk_bf16_f32 v56, v52, v53
    v_cvt_pk_bf16_f32 v57, v54, v55
    v_min_u32 v56, -2, v56
    s_cbranch_vccnz mega_kernel_rf_w1_pc
    s_mov_b64 exec, s[26:27]
    buffer_store_dwordx2 v[56:57], v9, s[4:7], s35 offen offset:256
    buffer_store_dwordx2 v[58:59], v9, s[4:7], s36 offen offset:256
    s_mov_b64 exec, -1
    s_xor_b32 s42, s42, 1
    s_branch mega_kernel_rf_w1_loop
mega_kernel_rf_w1_last:
    buffer_store_dwordx4 v[64:67], v10, s[4:7], s45 offen offset:64 sc1
    buffer_store_dwordx2 v[18:19], v11, s[4:7], s51 offen offset:2560 sc1
    s_branch mega_kernel_rf_end
mega_kernel_rf_w1_pafail:
    s_nop 7
    v_mov_b32 v96, 0
    v_mov_b32 v97, 0
    v_mov_b32 v98, 0
    v_mov_b32 v99, 0
    v_mov_b32 v100, 0
    v_mov_b32 v101, 0
    v_mov_b32 v102, 0
    v_mov_b32 v103, 0
    v_mov_b32 v104, 0
    v_mov_b32 v105, 0
    v_mov_b32 v106, 0
    v_mov_b32 v107, 0
    s_branch mega_kernel_rf_w1_pa
mega_kernel_rf_w1_xslow:
    buffer_load_dwordx2 v[108:109], v11, s[4:7], s38 offen sc1
    buffer_load_dwordx2 v[110:111], v11, s[4:7], s38 offen offset:512 sc1
    s_waitcnt vmcnt(2)
    v_bitop3_b32 v3, s41, v20, v22 bitop3:0x7e
    v_mfma_f32_16x16x16_bf16 v[80:83], v[20:21], v[16:17], v[100:103]
    v_and_b32 v3, 1, v3
    v_mfma_f32_16x16x16_bf16 v[84:87], v[22:23], v[16:17], v[104:107]
    v_cmp_ne_u32 vcc, 0, v3
    s_cbranch_vccz mega_kernel_rf_w1_xgot
    buffer_load_dwordx2 v[20:21], v11, s[4:7], s38 offen sc1
    buffer_load_dwordx2 v[22:23], v11, s[4:7], s38 offen offset:512 sc1
    s_waitcnt vmcnt(2)
    v_bitop3_b32 v3, s41, v108, v110 bitop3:0x7e
    v_mfma_f32_16x16x16_bf16 v[80:83], v[108:109], v[16:17], v[100:103]
    v_and_b32 v3, 1, v3
    v_mfma_f32_16x16x16_bf16 v[84:87], v[110:111], v[16:17], v[104:107]
    v_cmp_ne_u32 vcc, 0, v3
    s_cbranch_vccz mega_kernel_rf_w1_xgot
    s_branch mega_kernel_rf_w1_xslow
mega_kernel_rf_w1_xgot:
    s_nop 3
    v_cvt_pk_bf16_f32 v64, v80, v81
    v_cvt_pk_bf16_f32 v65, v82, v83
    v_cvt_pk_bf16_f32 v66, v84, v85
    v_cvt_pk_bf16_f32 v67, v86, v87
    ds_write_b128 v6, v[64:67] offset:13312
    s_branch mega_kernel_rf_w1_xok
mega_kernel_rf_w1_pv0:
    s_waitcnt vmcnt(2)
    s_branch mega_kernel_rf_w1_pv1
mega_kernel_rf_w1_pv:
    buffer_load_dwordx2 v[20:21], v11, s[4:7], s40 offen sc1
    s_waitcnt vmcnt(0)
mega_kernel_rf_w1_pv1:
    v_and_b32 v3, 1, v20
    v_cmp_ne_u32 vcc, s41, v3
    v_mov_b32 v113, v20
    v_mov_b32 v115, v21
    s_cbranch_vccnz mega_kernel_rf_w1_pv
    s_branch mega_kernel_rf_w1_pv2
mega_kernel_rf_w2_entry:
    v_mfma_f32_32x32x8_bf16 v[96:111], v[14:15], v[14:15], 0
    v_mfma_f32_16x16x16_bf16 v[112:115], v[14:15], v[14:15], 0
    v_mfma_f32_16x16x16_bf16 v[116:119], v[14:15], v[14:15], 0
    ds_read_b128 v[64:67], v1 offset:8192
    ds_read_b128 v[68:71], v1 offset:9216
    ds_read_b128 v[72:75], v1 offset:10240
    ds_read_b128 v[76:79], v1 offset:11264
    ds_read_b128 v[80:83], v1 offset:24576
    ds_read_b128 v[84:87], v1 offset:25600
    ds_read_b128 v[88:91], v1 offset:26624
    ds_read_b128 v[92:95], v1 offset:27648
    buffer_load_dwordx4 v[120:123], v1, s[4:7], s44 offen
    buffer_load_dwordx4 v[124:127], v1, s[4:7], s44 offen offset:1024
    s_add_u32 s44, s44, 262144
mega_kernel_rf_w2_loop:
    s_add_u32 s22, s35, 4096
    s_waitcnt vmcnt(0)
    buffer_load_dwordx4 v[48:51], v1, s[4:7], s22 offen sc1
    buffer_load_dwordx4 v[52:55], v1, s[4:7], s22 offen offset:1024 sc1
mega_kernel_rf_w2_pa:
    s_waitcnt vmcnt(1)
    ds_write_b128 v6, v[48:51] offset:4096
    s_waitcnt vmcnt(0)
    ds_write_b128 v6, v[52:55] offset:5120
    v_max3_u32 v3, v48, v50, v52
    v_max_u32 v3, v3, v54
    v_cmp_eq_u32 vcc, -1, v3
    v_smfmac_f32_16x16x64_bf16 v[96:99], v[48:51], a[64:71], v2
    buffer_load_dwordx4 v[48:51], v1, s[4:7], s22 offen sc1
    v_smfmac_f32_16x16x64_bf16 v[100:103], v[48:51], a[72:79], v2
    buffer_load_dwordx4 v[52:55], v1, s[4:7], s22 offen offset:1024 sc1
    v_smfmac_f32_16x16x64_bf16 v[104:107], v[48:51], a[192:199], v2
    s_cbranch_vccnz mega_kernel_rf_w2_pafail
    s_waitcnt lgkmcnt(0)
    s_barrier
    ds_read_b128 v[56:59], v6 offset:6144
    ds_read_b128 v[60:63], v6 offset:7168
    v_smfmac_f32_16x16x64_bf16 v[108:111], v[48:51], a[200:207], v2
    ds_read_b128 v[32:35], v6 offset:0
    v_smfmac_f32_16x16x64_bf16 v[96:99], v[52:55], a[80:87], v2
    ds_read_b128 v[36:39], v6 offset:1024
    v_smfmac_f32_16x16x64_bf16 v[100:103], v[52:55], a[88:95], v2
    ds_read_b128 v[40:43], v6 offset:2048
    v_smfmac_f32_16x16x64_bf16 v[104:107], v[52:55], a[208:215], v2
    ds_read_b128 v[44:47], v6 offset:3072
    v_smfmac_f32_16x16x64_bf16 v[108:111], v[52:55], a[216:223], v2
    s_waitcnt lgkmcnt(5)
    v_smfmac_f32_16x16x64_bf16 v[96:99], v[56:59], a[96:103], v2
    v_smfmac_f32_16x16x64_bf16 v[104:107], v[56:59], a[224:231], v2
    buffer_load_dwordx4 v1, s[4:7], s43 offen lds
    s_waitcnt lgkmcnt(4)
    v_smfmac_f32_16x16x64_bf16 v[96:99], v[60:63], a[112:119], v2
    v_smfmac_f32_16x16x64_bf16 v[104:107], v[60:63], a[240:247], v2
    s_waitcnt lgkmcnt(3)
    v_smfmac_f32_16x16x64_bf16 v[96:99], v[32:35], a[0:7], v2
    v_smfmac_f32_16x16x64_bf16 v[104:107], v[32:35], a[128:135], v2
    buffer_load_dwordx4 v1, s[4:7], s43 offen offset:1024 lds
    s_waitcnt lgkmcnt(2)
    v_smfmac_f32_16x16x64_bf16 v[96:99], v[36:39], a[16:23], v2
    v_smfmac_f32_16x16x64_bf16 v[104:107], v[36:39], a[144:151], v2
    s_waitcnt lgkmcnt(1)
    v_smfmac_f32_16x16x64_bf16 v[96:99], v[40:43], a[32:39], v2
    v_smfmac_f32_16x16x64_bf16 v[104:107], v[40:43], a[160:167], v2
    s_waitcnt lgkmcnt(0)
    v_smfmac_f32_16x16x64_bf16 v[96:99], v[44:47], a[48:55], v2
    v_smfmac_f32_16x16x64_bf16 v[104:107], v[44:47], a[176:183], v2
    v_smfmac_f32_16x16x64_bf16 v[100:103], v[56:59], a[104:111], v2
    s_nop 2
    v_smfmac_f32_16x16x64_bf16 v[100:103], v[60:63], a[120:127], v2
    s_nop 1
    v_add_f32 v96, v96, v98
    v_smfmac_f32_16x16x64_bf16 v[100:103], v[32:35], a[8:15], v2
    v_add_f32 v97, v97, v99
    v_add_f32 v104, v104, v106
    v_smfmac_f32_16x16x64_bf16 v[100:103], v[36:39], a[24:31], v2
    v_add_f32 v105, v105, v107
    v_cvt_pk_bf16_f32 v96, v96, v97
    v_smfmac_f32_16x16x64_bf16 v[100:103], v[40:43], a[40:47], v2
    v_cvt_pk_bf16_f32 v97, v104, v105
    v_and_or_b32 v96, v96, -2, s41
    v_smfmac_f32_16x16x64_bf16 v[100:103], v[44:47], a[56:63], v2
    buffer_store_dwordx2 v[96:97], v11, s[4:7], s37 offen sc1
    v_smfmac_f32_16x16x64_bf16 v[108:111], v[56:59], a[232:239], v2
    v_smfmac_f32_16x16x64_bf16 v[108:111], v[60:63], a[248:255], v2
    v_smfmac_f32_16x16x64_bf16 v[108:111], v[32:35], a[136:143], v2
    v_smfmac_f32_16x16x64_bf16 v[108:111], v[36:39], a[152:159], v2
    v_smfmac_f32_16x16x64_bf16 v[108:111], v[40:43], a[168:175], v2
    s_nop 2
    v_add_f32 v100, v100, v102
    v_smfmac_f32_16x16x64_bf16 v[108:111], v[44:47], a[184:191], v2
    v_add_f32 v101, v101, v103
    v_cvt_pk_bf16_f32 v98, v100, v101
    v_and_or_b32 v98, v98, -2, s41
    s_nop 4
    v_pk_add_f32 v[108:109], v[108:109], v[110:111]
    v_cvt_pk_bf16_f32 v99, v108, v109
    buffer_store_dwordx2 v[98:99], v11, s[4:7], s37 offen offset:512 sc1
    v_smfmac_f32_16x16x64_bf16 v[112:115], v[32:35], v[64:71], v2
    ds_read_b128 v[64:67], v1 offset:40960
    ds_read_b128 v[68:71], v1 offset:41984
    v_smfmac_f32_16x16x64_bf16 v[116:119], v[32:35], v[72:79], v2
    ds_read_b128 v[72:75], v1 offset:43008
    ds_read_b128 v[76:79], v1 offset:44032
    v_smfmac_f32_16x16x64_bf16 v[112:115], v[36:39], v[80:87], v2
    ds_read_b128 v[80:83], v1 offset:57344
    ds_read_b128 v[84:87], v1 offset:58368
    v_smfmac_f32_16x16x64_bf16 v[116:119], v[36:39], v[88:95], v2
    ds_read_b128 v[88:91], v1 offset:59392
    ds_read_b128 v[92:95], v1 offset:60416
    s_waitcnt lgkmcnt(6)
    v_smfmac_f32_16x16x64_bf16 v[112:115], v[40:43], v[64:71], v2
    ds_read_b128 v[64:67], v5 offset:8192
    ds_read_b128 v[68:71], v5 offset:9216
    s_waitcnt lgkmcnt(6)
    v_smfmac_f32_16x16x64_bf16 v[116:119], v[40:43], v[72:79], v2
    ds_read_b128 v[72:75], v5 offset:10240
    ds_read_b128 v[76:79], v5 offset:11264
    s_waitcnt lgkmcnt(6)
    v_smfmac_f32_16x16x64_bf16 v[112:115], v[44:47], v[80:87], v2
    ds_read_b128 v[80:83], v5 offset:24576
    ds_read_b128 v[84:87], v5 offset:25600
    s_waitcnt lgkmcnt(6)
    v_smfmac_f32_16x16x64_bf16 v[116:119], v[44:47], v[88:95], v2
    ds_read_b128 v[88:91], v5 offset:26624
    ds_read_b128 v[92:95], v5 offset:27648
    s_waitcnt lgkmcnt(6)
    v_smfmac_f32_16x16x64_bf16 v[112:115], v[48:51], v[64:71], v2
    ds_read_b128 v[64:67], v5 offset:40960
    ds_read_b128 v[68:71], v5 offset:41984
    s_waitcnt lgkmcnt(6)
    v_smfmac_f32_16x16x64_bf16 v[116:119], v[48:51], v[72:79], v2
    ds_read_b128 v[72:75], v5 offset:43008
    ds_read_b128 v[76:79], v5 offset:44032
    s_waitcnt lgkmcnt(6)
    v_smfmac_f32_16x16x64_bf16 v[112:115], v[52:55], v[80:87], v2
    ds_read_b128 v[80:83], v5 offset:57344
    ds_read_b128 v[84:87], v5 offset:58368
    s_waitcnt lgkmcnt(6)
    v_smfmac_f32_16x16x64_bf16 v[116:119], v[52:55], v[88:95], v2
    ds_read_b128 v[88:91], v5 offset:59392
    ds_read_b128 v[92:95], v5 offset:60416
    s_waitcnt lgkmcnt(6)
    v_smfmac_f32_16x16x64_bf16 v[112:115], v[56:59], v[64:71], v2
    s_waitcnt lgkmcnt(4)
    v_smfmac_f32_16x16x64_bf16 v[116:119], v[56:59], v[72:79], v2
    s_waitcnt lgkmcnt(2)
    v_smfmac_f32_16x16x64_bf16 v[112:115], v[60:63], v[80:87], v2
    s_waitcnt lgkmcnt(0)
    v_smfmac_f32_16x16x64_bf16 v[116:119], v[60:63], v[88:95], v2
    buffer_load_dwordx2 v[108:109], v11, s[4:7], s38 offen sc1
    v_mfma_f32_16x16x16_bf16 v[100:103], v[96:97], v[16:17], 0
    v_mfma_f32_16x16x16_bf16 v[104:107], v[98:99], v[16:17], 0
    s_nop 4
    v_add_f32 v112, v112, v114
    v_add_f32 v113, v113, v115
    v_add_f32 v114, v116, v118
    v_add_f32 v115, v117, v119
    v_cvt_pk_bf16_f32 v18, v112, v113
    v_cvt_pk_bf16_f32 v19, v114, v115
    v_and_or_b32 v18, v18, -2, s41
    buffer_load_dwordx2 v[110:111], v11, s[4:7], s38 offen offset:512 sc1
    s_barrier
    buffer_store_dwordx2 v[18:19], v11, s[4:7], s39 offen sc1
    v_mov_b32 v112, v18
    v_mov_b32 v114, v19
    v_mov_b32 v92, v28
    v_mov_b32 v93, 0
    s_waitcnt vmcnt(5)
    s_barrier
    ds_read_b128 v[32:35], v6 offset:19456
    ds_read_b128 v[36:39], v6 offset:20480
    ds_read_b128 v[40:43], v6 offset:24576
    ds_read_b128 v[44:47], v6 offset:25600
    ds_read_b128 v[48:51], v6 offset:9216
    ds_read_b128 v[52:55], v6 offset:10240
    ds_read_b128 v[56:59], v6 offset:14336
    ds_read_b128 v[60:63], v6 offset:15360
    buffer_load_dwordx2 v[20:21], v11, s[4:7], s38 offen sc1
    buffer_load_dwordx2 v[22:23], v11, s[4:7], s38 offen offset:512 sc1
    s_waitcnt vmcnt(4)
    v_mfma_f32_16x16x16_bf16 v[80:83], v[108:109], v[16:17], v[100:103]
    v_and_b32 v3, 1, v108
    v_cmp_ne_u32 vcc, s41, v3
    s_nop 5
    v_cvt_pk_bf16_f32 v64, v80, v81
    v_cvt_pk_bf16_f32 v65, v82, v83
    s_cbranch_vccnz mega_kernel_rf_w2_xslow
    s_waitcnt vmcnt(3)
    v_mfma_f32_16x16x16_bf16 v[84:87], v[110:111], v[16:17], v[104:107]
    v_and_b32 v3, 1, v110
    v_cmp_ne_u32 vcc, s41, v3
    s_nop 5
    v_cvt_pk_bf16_f32 v66, v84, v85
    v_cvt_pk_bf16_f32 v67, v86, v87
    ds_write_b128 v6, v[64:67] offset:18432
    s_cbranch_vccnz mega_kernel_rf_w2_xslow
mega_kernel_rf_w2_xok:
    s_cmp_eq_u32 s21, 63
    s_cbranch_scc1 mega_kernel_rf_w2_last
    buffer_load_dwordx2 v[116:117], v11, s[4:7], s40 offen sc1
    s_waitcnt lgkmcnt(1)
    v_mfma_f32_16x16x32_bf16 v[80:83], v[32:35], v[64:67], 0
    s_waitcnt lgkmcnt(0)
    s_barrier
    ds_read_b128 v[68:71], v6 offset:23552
    ds_read_b128 v[72:75], v6 offset:8192
    ds_read_b128 v[76:79], v6 offset:13312
    v_mfma_f32_16x16x32_bf16 v[84:87], v[36:39], v[64:67], 0
    v_mfma_f32_16x16x32_bf16 v[88:91], v[64:67], v[64:67], 0
    buffer_load_dwordx2 v[20:21], v11, s[4:7], s40 offen sc1
    s_waitcnt lgkmcnt(2)
    v_mfma_f32_16x16x32_bf16 v[80:83], v[40:43], v[68:71], v[80:83]
    s_waitcnt lgkmcnt(1)
    v_mfma_f32_16x16x32_bf16 v[80:83], v[48:51], v[72:75], v[80:83]
    s_waitcnt lgkmcnt(0)
    v_mfma_f32_16x16x32_bf16 v[80:83], v[56:59], v[76:79], v[80:83]
    buffer_store_dwordx4 v[64:67], v10, s[4:7], s45 offen offset:128 sc1
    v_mfma_f32_16x16x32_bf16 v[84:87], v[44:47], v[68:71], v[84:87]
    v_mfma_f32_16x16x32_bf16 v[84:87], v[52:55], v[72:75], v[84:87]
    v_mfma_f32_16x16x32_bf16 v[84:87], v[60:63], v[76:79], v[84:87]
    v_mfma_f32_16x16x32_bf16 v[88:91], v[68:71], v[68:71], v[88:91]
    buffer_store_dwordx2 v[18:19], v11, s[4:7], s51 offen offset:3072 sc1
    v_mfma_f32_16x16x32_bf16 v[88:91], v[72:75], v[72:75], v[88:91]
    v_mfma_f32_16x16x32_bf16 v[88:91], v[76:79], v[76:79], v[88:91]
    v_mfma_f32_32x32x4_2b_bf16 v[32:63], v[14:15], v[14:15], 0
    s_nop 0
    v_max3_f32 v4, v80, v81, v82
    s_nop 1
    v_max3_f32 v4, v4, v83, v84
    v_max3_f32 v4, v4, v85, v86
    v_max_f32 v4, v4, v87
    v_max3_f32 v90, v4, v88, v89
    v_max3_f32 v4, v4, v88, v89
    s_nop 1
    v_permlane16_swap_b32 v4, v90
    v_max_f32 v4, v4, v90
    v_max_f32 v90, v4, v90
    s_nop 1
    v_permlane32_swap_b32 v4, v90
    v_max_f32 v4, v4, v90
    v_mul_f32 v4, s34, v4
    v_pk_fma_f32 v[80:81], v[80:81], s[34:35], v[4:5] op_sel_hi:[1,0,0] neg_lo:[0,0,1] neg_hi:[0,0,1]
    v_pk_fma_f32 v[82:83], v[82:83], s[34:35], v[4:5] op_sel_hi:[1,0,0] neg_lo:[0,0,1] neg_hi:[0,0,1]
    v_pk_fma_f32 v[84:85], v[84:85], s[34:35], v[4:5] op_sel_hi:[1,0,0] neg_lo:[0,0,1] neg_hi:[0,0,1]
    v_pk_fma_f32 v[86:87], v[86:87], s[34:35], v[4:5] op_sel_hi:[1,0,0] neg_lo:[0,0,1] neg_hi:[0,0,1]
    v_pk_fma_f32 v[88:89], v[88:89], s[34:35], v[4:5] op_sel_hi:[1,0,0] neg_lo:[0,0,1] neg_hi:[0,0,1]
    v_exp_f32 v80, v80
    v_exp_f32 v81, v81
    v_exp_f32 v82, v82
    v_cvt_pk_bf16_f32 v68, v80, v81
    v_exp_f32 v83, v83
    v_exp_f32 v84, v84
    v_cvt_pk_bf16_f32 v69, v82, v83
    v_exp_f32 v85, v85
    v_exp_f32 v86, v86
    v_cvt_pk_bf16_f32 v70, v84, v85
    v_exp_f32 v87, v87
    v_exp_f32 v88, v88
    v_cvt_pk_bf16_f32 v71, v86, v87
    v_exp_f32 v89, v89
    s_waitcnt vmcnt(3)
    v_mfma_f32_16x16x32_bf16 v[76:79], v[28:31], v[68:71], 0
    v_and_b32 v3, 1, v116
    v_cvt_pk_bf16_f32 v72, v88, v89
    v_mfma_f32_16x16x32_bf16 v[100:103], v[120:123], v[68:71], 0
    v_cmp_ne_u32 vcc, s41, v3
    v_cvt_pk_bf16_f32 v73, v88, v89
    v_mfma_f32_16x16x32_bf16 v[104:107], v[124:127], v[68:71], 0
    v_mov_b32 v113, v116
    v_mov_b32 v115, v117
    v_mfma_f32_16x16x16_bf16 v[76:79], v[92:93], v[72:73], v[76:79]
    s_cbranch_vccnz mega_kernel_rf_w2_pv0
mega_kernel_rf_w2_pv2:
    v_mfma_f32_16x16x16_bf16 v[100:103], v[112:113], v[72:73], v[100:103]
    v_mfma_f32_16x16x16_bf16 v[104:107], v[114:115], v[72:73], v[104:107]
    buffer_load_dwordx4 v[120:123], v1, s[4:7], s44 offen
    buffer_load_dwordx4 v[124:127], v1, s[4:7], s44 offen offset:1024
    s_nop 2
    v_rcp_f32 v76, v76
    s_mov_b64 exec, s[28:29]
    v_pk_mul_f32 v[100:101], v[100:101], v[76:77] op_sel_hi:[1,0]
    v_pk_mul_f32 v[102:103], v[102:103], v[76:77] op_sel_hi:[1,0]
    v_pk_mul_f32 v[104:105], v[104:105], v[76:77] op_sel_hi:[1,0]
    v_pk_mul_f32 v[106:107], v[106:107], v[76:77] op_sel_hi:[1,0]
    v_cvt_pk_bf16_f32 v84, v100, v101
    v_cvt_pk_bf16_f32 v85, v102, v103
    v_cvt_pk_bf16_f32 v86, v104, v105
    v_cvt_pk_bf16_f32 v87, v106, v107
    ds_write_b128 v6, v[84:87] offset:29664
    s_mov_b64 exec, -1
    s_waitcnt lgkmcnt(0)
    s_barrier
    ds_read_b128 v[68:71], v6 offset:28672
    ds_read_b128 v[72:75], v6 offset:29696
    s_waitcnt lgkmcnt(1)
    v_smfmac_f32_16x16x64_bf16 v[32:35], v[68:71], v[128:135], v2
    s_add_u32 s21, s21, 1
    s_xor_b32 s38, s38, 1048576
    s_xor_b32 s37, s37, 1048576
    s_waitcnt lgkmcnt(0)
    v_smfmac_f32_16x16x64_bf16 v[32:35], v[72:75], v[136:143], v2
    s_xor_b32 s40, s40, 1048576
    s_xor_b32 s39, s39, 1048576
    s_lshr_b32 s41, s21, 1
    v_smfmac_f32_16x16x64_bf16 v[36:39], v[68:71], v[144:151], v2
    s_and_b32 s41, s41, 1
    s_xor_b32 s41, s41, 1
    s_xor_b32 s35, s35, 16384
    v_smfmac_f32_16x16x64_bf16 v[36:39], v[72:75], v[152:159], v2
    v_add_f32 v32, v32, v34
    s_xor_b32 s36, s36, 16384
    s_add_u32 s43, s43, 262144
    s_add_u32 s44, s44, 262144
    v_smfmac_f32_16x16x64_bf16 v[40:43], v[68:71], v[160:167], v2
    v_add_f32 v33, v33, v35
    v_smfmac_f32_16x16x64_bf16 v[40:43], v[72:75], v[168:175], v2
    v_cvt_pk_bf16_f32 v32, v32, v33
    v_smfmac_f32_16x16x64_bf16 v[44:47], v[68:71], v[176:183], v2
    v_and_or_b32 v32, v32, -2, s42
    v_smfmac_f32_16x16x64_bf16 v[44:47], v[72:75], v[184:191], v2
    v_add_f32 v36, v36, v38
    v_smfmac_f32_16x16x64_bf16 v[48:51], v[68:71], v[192:199], v2
    v_add_f32 v37, v37, v39
    v_smfmac_f32_16x16x64_bf16 v[48:51], v[72:75], v[200:207], v2
    v_cvt_pk_bf16_f32 v33, v36, v37
    v_smfmac_f32_16x16x64_bf16 v[52:55], v[68:71], v[208:215], v2
    v_add_f32 v40, v40, v42
    v_smfmac_f32_16x16x64_bf16 v[52:55], v[72:75], v[216:223], v2
    v_add_f32 v41, v41, v43
    v_smfmac_f32_16x16x64_bf16 v[56:59], v[68:71], v[224:231], v2
    v_cvt_pk_bf16_f32 v34, v40, v41
    v_smfmac_f32_16x16x64_bf16 v[56:59], v[72:75], v[232:239], v2
    v_add_f32 v44, v44, v46
    v_smfmac_f32_16x16x64_bf16 v[60:63], v[68:71], v[240:247], v2
    v_add_f32 v45, v45, v47
    v_smfmac_f32_16x16x64_bf16 v[60:63], v[72:75], v[248:255], v2
    v_cvt_pk_bf16_f32 v35, v44, v45
    buffer_store_dwordx4 v[32:35], v8, s[4:7], s46 offen
    v_pk_add_f32 v[48:49], v[48:49], v[50:51]
    v_cvt_pk_bf16_f32 v48, v48, v49
    v_and_or_b32 v48, v48, -2, s42
    v_pk_add_f32 v[52:53], v[52:53], v[54:55]
    v_cvt_pk_bf16_f32 v49, v52, v53
    v_pk_add_f32 v[56:57], v[56:57], v[58:59]
    v_cvt_pk_bf16_f32 v50, v56, v57
    v_pk_add_f32 v[60:61], v[60:61], v[62:63]
    v_cvt_pk_bf16_f32 v51, v60, v61
    buffer_store_dwordx4 v[48:51], v8, s[4:7], s61 offen
    s_add_u32 s45, s45, 262144
    s_add_u32 s51, s51, 262144
    v_mfma_f32_32x32x8_bf16 v[96:111], v[14:15], v[14:15], 0
    v_mfma_f32_16x16x16_bf16 v[112:115], v[14:15], v[14:15], 0
    v_mfma_f32_16x16x16_bf16 v[116:119], v[14:15], v[14:15], 0
    ds_read_b128 v[64:67], v1 offset:8192
    ds_read_b128 v[68:71], v1 offset:9216
    ds_read_b128 v[72:75], v1 offset:10240
    ds_read_b128 v[76:79], v1 offset:11264
    ds_read_b128 v[80:83], v1 offset:24576
    ds_read_b128 v[84:87], v1 offset:25600
    ds_read_b128 v[88:91], v1 offset:26624
    ds_read_b128 v[92:95], v1 offset:27648
    v_mov_b32 v58, -1
    v_mov_b32 v59, -1
    s_waitcnt vmcnt(0)
mega_kernel_rf_w2_cgo:
mega_kernel_rf_w2_pc:
    buffer_load_dword v36, v13, s[4:7], s25 offen offset:0 sc1
    buffer_load_dword v37, v13, s[4:7], s25 offen offset:256 sc1
    buffer_load_dword v38, v13, s[4:7], s25 offen offset:512 sc1
    buffer_load_dword v39, v13, s[4:7], s25 offen offset:768 sc1
    buffer_load_dword v40, v13, s[4:7], s25 offen offset:1024 sc1
    buffer_load_dword v41, v13, s[4:7], s25 offen offset:1280 sc1
    buffer_load_dword v42, v13, s[4:7], s25 offen offset:1536 sc1
    buffer_load_dword v43, v13, s[4:7], s25 offen offset:1792 sc1
    s_waitcnt vmcnt(4)
    v_mfma_f32_16x16x32_bf16 v[52:55], v[36:39], v[24:27], 0
    v_bitop3_b32 v3, s42, v36, v37 bitop3:0x7e
    v_bitop3_b32 v4, s42, v38, v39 bitop3:0x7e
    s_waitcnt vmcnt(2)
    v_or_b32 v3, v3, v4
    v_bitop3_b32 v4, s42, v40, v41 bitop3:0x7e
    s_waitcnt vmcnt(0)
    v_mfma_f32_16x16x32_bf16 v[52:55], v[40:43], v[24:27], v[52:55]
    v_bitop3_b32 v56, s42, v42, v43 bitop3:0x7e
    v_or3_b32 v3, v3, v4, v56
    v_and_b32 v3, v0, v3
    v_cmp_ne_u32 vcc, 0, v3
    s_nop 3
    v_cvt_pk_bf16_f32 v56, v52, v53
    v_cvt_pk_bf16_f32 v57, v54, v55
    v_min_u32 v56, -2, v56
    s_cbranch_vccnz mega_kernel_rf_w2_pc
    s_mov_b64 exec, s[26:27]
    buffer_store_dwordx2 v[56:57], v9, s[4:7], s35 offen offset:512
    buffer_store_dwordx2 v[58:59], v9, s[4:7], s36 offen offset:512
    s_mov_b64 exec, -1
    s_xor_b32 s42, s42, 1
    s_branch mega_kernel_rf_w2_loop
mega_kernel_rf_w2_last:
    buffer_store_dwordx4 v[64:67], v10, s[4:7], s45 offen offset:128 sc1
    buffer_store_dwordx2 v[18:19], v11, s[4:7], s51 offen offset:3072 sc1
    s_branch mega_kernel_rf_end
mega_kernel_rf_w2_pafail:
    s_nop 7
    v_mov_b32 v96, 0
    v_mov_b32 v97, 0
    v_mov_b32 v98, 0
    v_mov_b32 v99, 0
    v_mov_b32 v100, 0
    v_mov_b32 v101, 0
    v_mov_b32 v102, 0
    v_mov_b32 v103, 0
    v_mov_b32 v104, 0
    v_mov_b32 v105, 0
    v_mov_b32 v106, 0
    v_mov_b32 v107, 0
    s_branch mega_kernel_rf_w2_pa
mega_kernel_rf_w2_xslow:
    buffer_load_dwordx2 v[108:109], v11, s[4:7], s38 offen sc1
    buffer_load_dwordx2 v[110:111], v11, s[4:7], s38 offen offset:512 sc1
    s_waitcnt vmcnt(2)
    v_bitop3_b32 v3, s41, v20, v22 bitop3:0x7e
    v_mfma_f32_16x16x16_bf16 v[80:83], v[20:21], v[16:17], v[100:103]
    v_and_b32 v3, 1, v3
    v_mfma_f32_16x16x16_bf16 v[84:87], v[22:23], v[16:17], v[104:107]
    v_cmp_ne_u32 vcc, 0, v3
    s_cbranch_vccz mega_kernel_rf_w2_xgot
    buffer_load_dwordx2 v[20:21], v11, s[4:7], s38 offen sc1
    buffer_load_dwordx2 v[22:23], v11, s[4:7], s38 offen offset:512 sc1
    s_waitcnt vmcnt(2)
    v_bitop3_b32 v3, s41, v108, v110 bitop3:0x7e
    v_mfma_f32_16x16x16_bf16 v[80:83], v[108:109], v[16:17], v[100:103]
    v_and_b32 v3, 1, v3
    v_mfma_f32_16x16x16_bf16 v[84:87], v[110:111], v[16:17], v[104:107]
    v_cmp_ne_u32 vcc, 0, v3
    s_cbranch_vccz mega_kernel_rf_w2_xgot
    s_branch mega_kernel_rf_w2_xslow
mega_kernel_rf_w2_xgot:
    s_nop 3
    v_cvt_pk_bf16_f32 v64, v80, v81
    v_cvt_pk_bf16_f32 v65, v82, v83
    v_cvt_pk_bf16_f32 v66, v84, v85
    v_cvt_pk_bf16_f32 v67, v86, v87
    ds_write_b128 v6, v[64:67] offset:18432
    s_branch mega_kernel_rf_w2_xok
mega_kernel_rf_w2_pv0:
    s_waitcnt vmcnt(2)
    s_branch mega_kernel_rf_w2_pv1
mega_kernel_rf_w2_pv:
    buffer_load_dwordx2 v[20:21], v11, s[4:7], s40 offen sc1
    s_waitcnt vmcnt(0)
mega_kernel_rf_w2_pv1:
    v_and_b32 v3, 1, v20
    v_cmp_ne_u32 vcc, s41, v3
    v_mov_b32 v113, v20
    v_mov_b32 v115, v21
    s_cbranch_vccnz mega_kernel_rf_w2_pv
    s_branch mega_kernel_rf_w2_pv2
mega_kernel_rf_w3_entry:
    v_mfma_f32_32x32x8_bf16 v[96:111], v[14:15], v[14:15], 0
    v_mfma_f32_16x16x16_bf16 v[112:115], v[14:15], v[14:15], 0
    v_mfma_f32_16x16x16_bf16 v[116:119], v[14:15], v[14:15], 0
    ds_read_b128 v[64:67], v1 offset:12288
    ds_read_b128 v[68:71], v1 offset:13312
    ds_read_b128 v[72:75], v1 offset:14336
    ds_read_b128 v[76:79], v1 offset:15360
    ds_read_b128 v[80:83], v1 offset:28672
    ds_read_b128 v[84:87], v1 offset:29696
    ds_read_b128 v[88:91], v1 offset:30720
    ds_read_b128 v[92:95], v1 offset:31744
    buffer_load_dwordx4 v[120:123], v1, s[4:7], s44 offen
    buffer_load_dwordx4 v[124:127], v1, s[4:7], s44 offen offset:1024
    s_add_u32 s44, s44, 262144
mega_kernel_rf_w3_loop:
    s_add_u32 s22, s35, 6144
    s_waitcnt vmcnt(0)
    buffer_load_dwordx4 v[56:59], v1, s[4:7], s22 offen sc1
    buffer_load_dwordx4 v[60:63], v1, s[4:7], s22 offen offset:1024 sc1
mega_kernel_rf_w3_pa:
    s_waitcnt vmcnt(1)
    ds_write_b128 v6, v[56:59] offset:6144
    s_waitcnt vmcnt(0)
    ds_write_b128 v6, v[60:63] offset:7168
    v_max3_u32 v3, v56, v58, v60
    v_max_u32 v3, v3, v62
    v_cmp_eq_u32 vcc, -1, v3
    v_smfmac_f32_16x16x64_bf16 v[96:99], v[56:59], a[96:103], v2
    buffer_load_dwordx4 v[56:59], v1, s[4:7], s22 offen sc1
    v_smfmac_f32_16x16x64_bf16 v[100:103], v[56:59], a[104:111], v2
    buffer_load_dwordx4 v[60:63], v1, s[4:7], s22 offen offset:1024 sc1
    v_smfmac_f32_16x16x64_bf16 v[104:107], v[56:59], a[224:231], v2
    s_cbranch_vccnz mega_kernel_rf_w3_pafail
    s_waitcnt lgkmcnt(0)
    s_barrier
    ds_read_b128 v[32:35], v6 offset:0
    ds_read_b128 v[36:39], v6 offset:1024
    v_smfmac_f32_16x16x64_bf16 v[108:111], v[56:59], a[232:239], v2
    ds_read_b128 v[40:43], v6 offset:2048
    v_smfmac_f32_16x16x64_bf16 v[96:99], v[60:63], a[112:119], v2
    ds_read_b128 v[44:47], v6 offset:3072
    v_smfmac_f32_16x16x64_bf16 v[100:103], v[60:63], a[120:127], v2
    ds_read_b128 v[48:51], v6 offset:4096
    v_smfmac_f32_16x16x64_bf16 v[104:107], v[60:63], a[240:247], v2
    ds_read_b128 v[52:55], v6 offset:5120
    v_smfmac_f32_16x16x64_bf16 v[108:111], v[60:63], a[248:255], v2
    s_waitcnt lgkmcnt(5)
    v_smfmac_f32_16x16x64_bf16 v[96:99], v[32:35], a[0:7], v2
    v_smfmac_f32_16x16x64_bf16 v[104:107], v[32:35], a[128:135], v2
    s_waitcnt lgkmcnt(4)
    v_smfmac_f32_16x16x64_bf16 v[96:99], v[36:39], a[16:23], v2
    buffer_load_dwordx4 v1, s[4:7], s43 offen lds
    v_smfmac_f32_16x16x64_bf16 v[104:107], v[36:39], a[144:151], v2
    s_waitcnt lgkmcnt(3)
    v_smfmac_f32_16x16x64_bf16 v[96:99], v[40:43], a[32:39], v2
    v_smfmac_f32_16x16x64_bf16 v[104:107], v[40:43], a[160:167], v2
    s_waitcnt lgkmcnt(2)
    v_smfmac_f32_16x16x64_bf16 v[96:99], v[44:47], a[48:55], v2
    buffer_load_dwordx4 v1, s[4:7], s43 offen offset:1024 lds
    v_smfmac_f32_16x16x64_bf16 v[104:107], v[44:47], a[176:183], v2
    s_waitcnt lgkmcnt(1)
    v_smfmac_f32_16x16x64_bf16 v[96:99], v[48:51], a[64:71], v2
    v_smfmac_f32_16x16x64_bf16 v[104:107], v[48:51], a[192:199], v2
    s_waitcnt lgkmcnt(0)
    v_smfmac_f32_16x16x64_bf16 v[96:99], v[52:55], a[80:87], v2
    buffer_load_dword v12, v7, s[4:7], 0 offen sc1
    v_smfmac_f32_16x16x64_bf16 v[104:107], v[52:55], a[208:215], v2
    v_smfmac_f32_16x16x64_bf16 v[100:103], v[32:35], a[8:15], v2
    s_nop 2
    v_smfmac_f32_16x16x64_bf16 v[100:103], v[36:39], a[24:31], v2
    s_nop 1
    v_add_f32 v96, v96, v98
    v_smfmac_f32_16x16x64_bf16 v[100:103], v[40:43], a[40:47], v2
    v_add_f32 v97, v97, v99
    v_add_f32 v104, v104, v106
    v_smfmac_f32_16x16x64_bf16 v[100:103], v[44:47], a[56:63], v2
    v_add_f32 v105, v105, v107
    v_cvt_pk_bf16_f32 v96, v96, v97
    v_smfmac_f32_16x16x64_bf16 v[100:103], v[48:51], a[72:79], v2
    v_cvt_pk_bf16_f32 v97, v104, v105
    v_and_or_b32 v96, v96, -2, s41
    v_smfmac_f32_16x16x64_bf16 v[100:103], v[52:55], a[88:95], v2
    buffer_store_dwordx2 v[96:97], v11, s[4:7], s37 offen sc1
    v_smfmac_f32_16x16x64_bf16 v[108:111], v[32:35], a[136:143], v2
    v_smfmac_f32_16x16x64_bf16 v[108:111], v[36:39], a[152:159], v2
    v_smfmac_f32_16x16x64_bf16 v[108:111], v[40:43], a[168:175], v2
    v_smfmac_f32_16x16x64_bf16 v[108:111], v[44:47], a[184:191], v2
    v_smfmac_f32_16x16x64_bf16 v[108:111], v[48:51], a[200:207], v2
    s_nop 2
    v_add_f32 v100, v100, v102
    v_smfmac_f32_16x16x64_bf16 v[108:111], v[52:55], a[216:223], v2
    v_add_f32 v101, v101, v103
    v_cvt_pk_bf16_f32 v98, v100, v101
    v_and_or_b32 v98, v98, -2, s41
    s_nop 4
    v_pk_add_f32 v[108:109], v[108:109], v[110:111]
    v_cvt_pk_bf16_f32 v99, v108, v109
    buffer_store_dwordx2 v[98:99], v11, s[4:7], s37 offen offset:512 sc1
    v_smfmac_f32_16x16x64_bf16 v[112:115], v[32:35], v[64:71], v2
    ds_read_b128 v[64:67], v1 offset:45056
    ds_read_b128 v[68:71], v1 offset:46080
    v_smfmac_f32_16x16x64_bf16 v[116:119], v[32:35], v[72:79], v2
    ds_read_b128 v[72:75], v1 offset:47104
    ds_read_b128 v[76:79], v1 offset:48128
    v_smfmac_f32_16x16x64_bf16 v[112:115], v[36:39], v[80:87], v2
    ds_read_b128 v[80:83], v1 offset:61440
    ds_read_b128 v[84:87], v1 offset:62464
    v_smfmac_f32_16x16x64_bf16 v[116:119], v[36:39], v[88:95], v2
    ds_read_b128 v[88:91], v1 offset:63488
    ds_read_b128 v[92:95], v1 offset:64512
    s_waitcnt lgkmcnt(6)
    v_smfmac_f32_16x16x64_bf16 v[112:115], v[40:43], v[64:71], v2
    ds_read_b128 v[64:67], v5 offset:12288
    ds_read_b128 v[68:71], v5 offset:13312
    s_waitcnt lgkmcnt(6)
    v_smfmac_f32_16x16x64_bf16 v[116:119], v[40:43], v[72:79], v2
    ds_read_b128 v[72:75], v5 offset:14336
    ds_read_b128 v[76:79], v5 offset:15360
    s_waitcnt lgkmcnt(6)
    v_smfmac_f32_16x16x64_bf16 v[112:115], v[44:47], v[80:87], v2
    ds_read_b128 v[80:83], v5 offset:28672
    ds_read_b128 v[84:87], v5 offset:29696
    s_waitcnt lgkmcnt(6)
    v_smfmac_f32_16x16x64_bf16 v[116:119], v[44:47], v[88:95], v2
    ds_read_b128 v[88:91], v5 offset:30720
    ds_read_b128 v[92:95], v5 offset:31744
    s_waitcnt lgkmcnt(6)
    v_smfmac_f32_16x16x64_bf16 v[112:115], v[48:51], v[64:71], v2
    ds_read_b128 v[64:67], v5 offset:45056
    ds_read_b128 v[68:71], v5 offset:46080
    s_waitcnt lgkmcnt(6)
    v_smfmac_f32_16x16x64_bf16 v[116:119], v[48:51], v[72:79], v2
    ds_read_b128 v[72:75], v5 offset:47104
    ds_read_b128 v[76:79], v5 offset:48128
    s_waitcnt lgkmcnt(6)
    v_smfmac_f32_16x16x64_bf16 v[112:115], v[52:55], v[80:87], v2
    ds_read_b128 v[80:83], v5 offset:61440
    ds_read_b128 v[84:87], v5 offset:62464
    s_waitcnt lgkmcnt(6)
    v_smfmac_f32_16x16x64_bf16 v[116:119], v[52:55], v[88:95], v2
    ds_read_b128 v[88:91], v5 offset:63488
    ds_read_b128 v[92:95], v5 offset:64512
    s_waitcnt lgkmcnt(6)
    v_smfmac_f32_16x16x64_bf16 v[112:115], v[56:59], v[64:71], v2
    s_waitcnt lgkmcnt(4)
    v_smfmac_f32_16x16x64_bf16 v[116:119], v[56:59], v[72:79], v2
    s_waitcnt lgkmcnt(2)
    v_smfmac_f32_16x16x64_bf16 v[112:115], v[60:63], v[80:87], v2
    s_waitcnt lgkmcnt(0)
    v_smfmac_f32_16x16x64_bf16 v[116:119], v[60:63], v[88:95], v2
    buffer_load_dwordx2 v[108:109], v11, s[4:7], s38 offen sc1
    v_mfma_f32_16x16x16_bf16 v[100:103], v[96:97], v[16:17], 0
    v_mfma_f32_16x16x16_bf16 v[104:107], v[98:99], v[16:17], 0
    s_nop 4
    v_add_f32 v112, v112, v114
    v_add_f32 v113, v113, v115
    v_add_f32 v114, v116, v118
    v_add_f32 v115, v117, v119
    v_cvt_pk_bf16_f32 v18, v112, v113
    v_cvt_pk_bf16_f32 v19, v114, v115
    v_and_or_b32 v18, v18, -2, s41
    buffer_load_dwordx2 v[110:111], v11, s[4:7], s38 offen offset:512 sc1
    s_barrier
    buffer_store_dwordx2 v[18:19], v11, s[4:7], s39 offen sc1
    v_mov_b32 v112, v18
    v_mov_b32 v114, v19
    v_mov_b32 v92, v28
    v_mov_b32 v93, 0
    s_waitcnt vmcnt(6)
    s_barrier
    ds_read_b128 v[32:35], v6 offset:24576
    ds_read_b128 v[36:39], v6 offset:25600
    ds_read_b128 v[40:43], v6 offset:19456
    ds_read_b128 v[44:47], v6 offset:20480
    ds_read_b128 v[48:51], v6 offset:14336
    ds_read_b128 v[52:55], v6 offset:15360
    ds_read_b128 v[56:59], v6 offset:9216
    ds_read_b128 v[60:63], v6 offset:10240
    buffer_load_dwordx2 v[20:21], v11, s[4:7], s38 offen sc1
    buffer_load_dwordx2 v[22:23], v11, s[4:7], s38 offen offset:512 sc1
    s_waitcnt vmcnt(4)
    v_mfma_f32_16x16x16_bf16 v[80:83], v[108:109], v[16:17], v[100:103]
    v_and_b32 v3, 1, v108
    v_cmp_ne_u32 vcc, s41, v3
    s_nop 5
    v_cvt_pk_bf16_f32 v64, v80, v81
    v_cvt_pk_bf16_f32 v65, v82, v83
    s_cbranch_vccnz mega_kernel_rf_w3_xslow
    s_waitcnt vmcnt(3)
    v_mfma_f32_16x16x16_bf16 v[84:87], v[110:111], v[16:17], v[104:107]
    v_and_b32 v3, 1, v110
    v_cmp_ne_u32 vcc, s41, v3
    s_nop 5
    v_cvt_pk_bf16_f32 v66, v84, v85
    v_cvt_pk_bf16_f32 v67, v86, v87
    ds_write_b128 v6, v[64:67] offset:23552
    s_cbranch_vccnz mega_kernel_rf_w3_xslow
mega_kernel_rf_w3_xok:
    s_cmp_eq_u32 s21, 63
    s_cbranch_scc1 mega_kernel_rf_w3_last
    buffer_load_dwordx2 v[116:117], v11, s[4:7], s40 offen sc1
    s_waitcnt lgkmcnt(1)
    v_mfma_f32_16x16x32_bf16 v[80:83], v[32:35], v[64:67], 0
    s_waitcnt lgkmcnt(0)
    s_barrier
    ds_read_b128 v[68:71], v6 offset:18432
    ds_read_b128 v[72:75], v6 offset:13312
    ds_read_b128 v[76:79], v6 offset:8192
    v_mfma_f32_16x16x32_bf16 v[84:87], v[36:39], v[64:67], 0
    v_mfma_f32_16x16x32_bf16 v[88:91], v[64:67], v[64:67], 0
    buffer_load_dwordx2 v[20:21], v11, s[4:7], s40 offen sc1
    s_waitcnt lgkmcnt(2)
    v_mfma_f32_16x16x32_bf16 v[80:83], v[40:43], v[68:71], v[80:83]
    s_waitcnt lgkmcnt(1)
    v_mfma_f32_16x16x32_bf16 v[80:83], v[48:51], v[72:75], v[80:83]
    s_waitcnt lgkmcnt(0)
    v_mfma_f32_16x16x32_bf16 v[80:83], v[56:59], v[76:79], v[80:83]
    v_mfma_f32_16x16x32_bf16 v[84:87], v[44:47], v[68:71], v[84:87]
    buffer_store_dwordx4 v[64:67], v10, s[4:7], s45 offen offset:192 sc1
    v_mfma_f32_16x16x32_bf16 v[84:87], v[52:55], v[72:75], v[84:87]
    v_mfma_f32_16x16x32_bf16 v[84:87], v[60:63], v[76:79], v[84:87]
    v_mfma_f32_16x16x32_bf16 v[88:91], v[68:71], v[68:71], v[88:91]
    v_mfma_f32_16x16x32_bf16 v[88:91], v[72:75], v[72:75], v[88:91]
    buffer_store_dwordx2 v[18:19], v11, s[4:7], s51 offen offset:3584 sc1
    v_mfma_f32_16x16x32_bf16 v[88:91], v[76:79], v[76:79], v[88:91]
    v_mfma_f32_32x32x4_2b_bf16 v[32:63], v[14:15], v[14:15], 0
    s_nop 0
    v_max3_f32 v4, v80, v81, v82
    s_nop 1
    v_max3_f32 v4, v4, v83, v84
    v_max3_f32 v4, v4, v85, v86
    v_max_f32 v4, v4, v87
    v_max3_f32 v90, v4, v88, v89
    v_max3_f32 v4, v4, v88, v89
    s_nop 1
    v_permlane16_swap_b32 v4, v90
    v_max_f32 v4, v4, v90
    v_max_f32 v90, v4, v90
    s_nop 1
    v_permlane32_swap_b32 v4, v90
    v_max_f32 v4, v4, v90
    v_mul_f32 v4, s34, v4
    v_pk_fma_f32 v[80:81], v[80:81], s[34:35], v[4:5] op_sel_hi:[1,0,0] neg_lo:[0,0,1] neg_hi:[0,0,1]
    v_pk_fma_f32 v[82:83], v[82:83], s[34:35], v[4:5] op_sel_hi:[1,0,0] neg_lo:[0,0,1] neg_hi:[0,0,1]
    v_pk_fma_f32 v[84:85], v[84:85], s[34:35], v[4:5] op_sel_hi:[1,0,0] neg_lo:[0,0,1] neg_hi:[0,0,1]
    v_pk_fma_f32 v[86:87], v[86:87], s[34:35], v[4:5] op_sel_hi:[1,0,0] neg_lo:[0,0,1] neg_hi:[0,0,1]
    v_pk_fma_f32 v[88:89], v[88:89], s[34:35], v[4:5] op_sel_hi:[1,0,0] neg_lo:[0,0,1] neg_hi:[0,0,1]
    v_exp_f32 v80, v80
    v_exp_f32 v81, v81
    v_exp_f32 v82, v82
    v_cvt_pk_bf16_f32 v68, v80, v81
    v_exp_f32 v83, v83
    v_exp_f32 v84, v84
    v_cvt_pk_bf16_f32 v69, v82, v83
    v_exp_f32 v85, v85
    v_exp_f32 v86, v86
    v_cvt_pk_bf16_f32 v70, v84, v85
    v_exp_f32 v87, v87
    v_exp_f32 v88, v88
    v_cvt_pk_bf16_f32 v71, v86, v87
    v_exp_f32 v89, v89
    s_waitcnt vmcnt(3)
    v_mfma_f32_16x16x32_bf16 v[76:79], v[28:31], v[68:71], 0
    v_and_b32 v3, 1, v116
    v_cvt_pk_bf16_f32 v72, v88, v89
    v_mfma_f32_16x16x32_bf16 v[100:103], v[120:123], v[68:71], 0
    v_cmp_ne_u32 vcc, s41, v3
    v_cvt_pk_bf16_f32 v73, v88, v89
    v_mfma_f32_16x16x32_bf16 v[104:107], v[124:127], v[68:71], 0
    v_mov_b32 v113, v116
    v_mov_b32 v115, v117
    v_mfma_f32_16x16x16_bf16 v[76:79], v[92:93], v[72:73], v[76:79]
    s_cbranch_vccnz mega_kernel_rf_w3_pv0
mega_kernel_rf_w3_pv2:
    v_mfma_f32_16x16x16_bf16 v[100:103], v[112:113], v[72:73], v[100:103]
    v_mfma_f32_16x16x16_bf16 v[104:107], v[114:115], v[72:73], v[104:107]
    buffer_load_dwordx4 v[120:123], v1, s[4:7], s44 offen
    buffer_load_dwordx4 v[124:127], v1, s[4:7], s44 offen offset:1024
    s_nop 2
    v_rcp_f32 v76, v76
    s_mov_b64 exec, s[28:29]
    v_pk_mul_f32 v[100:101], v[100:101], v[76:77] op_sel_hi:[1,0]
    v_pk_mul_f32 v[102:103], v[102:103], v[76:77] op_sel_hi:[1,0]
    v_pk_mul_f32 v[104:105], v[104:105], v[76:77] op_sel_hi:[1,0]
    v_pk_mul_f32 v[106:107], v[106:107], v[76:77] op_sel_hi:[1,0]
    v_cvt_pk_bf16_f32 v84, v100, v101
    v_cvt_pk_bf16_f32 v85, v102, v103
    v_cvt_pk_bf16_f32 v86, v104, v105
    v_cvt_pk_bf16_f32 v87, v106, v107
    ds_write_b128 v6, v[84:87] offset:29696
    s_mov_b64 exec, -1
    s_waitcnt lgkmcnt(0)
    s_barrier
    ds_read_b128 v[68:71], v6 offset:28672
    ds_read_b128 v[72:75], v6 offset:29696
    s_waitcnt lgkmcnt(1)
    v_smfmac_f32_16x16x64_bf16 v[32:35], v[68:71], v[128:135], v2
    s_add_u32 s21, s21, 1
    s_xor_b32 s38, s38, 1048576
    s_xor_b32 s37, s37, 1048576
    s_waitcnt lgkmcnt(0)
    v_smfmac_f32_16x16x64_bf16 v[32:35], v[72:75], v[136:143], v2
    s_xor_b32 s40, s40, 1048576
    s_xor_b32 s39, s39, 1048576
    s_lshr_b32 s41, s21, 1
    v_smfmac_f32_16x16x64_bf16 v[36:39], v[68:71], v[144:151], v2
    s_and_b32 s41, s41, 1
    s_xor_b32 s41, s41, 1
    s_xor_b32 s35, s35, 16384
    v_smfmac_f32_16x16x64_bf16 v[36:39], v[72:75], v[152:159], v2
    v_add_f32 v32, v32, v34
    s_xor_b32 s36, s36, 16384
    s_add_u32 s43, s43, 262144
    s_add_u32 s44, s44, 262144
    v_smfmac_f32_16x16x64_bf16 v[40:43], v[68:71], v[160:167], v2
    v_add_f32 v33, v33, v35
    v_smfmac_f32_16x16x64_bf16 v[40:43], v[72:75], v[168:175], v2
    v_cvt_pk_bf16_f32 v32, v32, v33
    v_smfmac_f32_16x16x64_bf16 v[44:47], v[68:71], v[176:183], v2
    v_and_or_b32 v32, v32, -2, s42
    v_smfmac_f32_16x16x64_bf16 v[44:47], v[72:75], v[184:191], v2
    v_add_f32 v36, v36, v38
    v_smfmac_f32_16x16x64_bf16 v[48:51], v[68:71], v[192:199], v2
    v_add_f32 v37, v37, v39
    v_smfmac_f32_16x16x64_bf16 v[48:51], v[72:75], v[200:207], v2
    v_cvt_pk_bf16_f32 v33, v36, v37
    v_smfmac_f32_16x16x64_bf16 v[52:55], v[68:71], v[208:215], v2
    v_add_f32 v40, v40, v42
    v_smfmac_f32_16x16x64_bf16 v[52:55], v[72:75], v[216:223], v2
    v_add_f32 v41, v41, v43
    v_smfmac_f32_16x16x64_bf16 v[56:59], v[68:71], v[224:231], v2
    v_cvt_pk_bf16_f32 v34, v40, v41
    v_smfmac_f32_16x16x64_bf16 v[56:59], v[72:75], v[232:239], v2
    v_add_f32 v44, v44, v46
    v_smfmac_f32_16x16x64_bf16 v[60:63], v[68:71], v[240:247], v2
    v_add_f32 v45, v45, v47
    v_smfmac_f32_16x16x64_bf16 v[60:63], v[72:75], v[248:255], v2
    v_cvt_pk_bf16_f32 v35, v44, v45
    buffer_store_dwordx4 v[32:35], v8, s[4:7], s46 offen
    v_pk_add_f32 v[48:49], v[48:49], v[50:51]
    v_cvt_pk_bf16_f32 v48, v48, v49
    v_and_or_b32 v48, v48, -2, s42
    v_pk_add_f32 v[52:53], v[52:53], v[54:55]
    v_cvt_pk_bf16_f32 v49, v52, v53
    v_pk_add_f32 v[56:57], v[56:57], v[58:59]
    v_cvt_pk_bf16_f32 v50, v56, v57
    v_pk_add_f32 v[60:61], v[60:61], v[62:63]
    v_cvt_pk_bf16_f32 v51, v60, v61
    buffer_store_dwordx4 v[48:51], v8, s[4:7], s61 offen
    s_add_u32 s45, s45, 262144
    s_add_u32 s51, s51, 262144
    v_mfma_f32_32x32x8_bf16 v[96:111], v[14:15], v[14:15], 0
    v_mfma_f32_16x16x16_bf16 v[112:115], v[14:15], v[14:15], 0
    v_mfma_f32_16x16x16_bf16 v[116:119], v[14:15], v[14:15], 0
    ds_read_b128 v[64:67], v1 offset:12288
    ds_read_b128 v[68:71], v1 offset:13312
    ds_read_b128 v[72:75], v1 offset:14336
    ds_read_b128 v[76:79], v1 offset:15360
    ds_read_b128 v[80:83], v1 offset:28672
    ds_read_b128 v[84:87], v1 offset:29696
    ds_read_b128 v[88:91], v1 offset:30720
    ds_read_b128 v[92:95], v1 offset:31744
    s_add_u32 s22, s21, 2
    s_cmp_gt_u32 s50, s22
    s_cbranch_scc1 mega_kernel_rf_w3_kvs
    v_readlane_b32 s50, v12, 0
    v_readlane_b32 s22, v12, 2
    v_readlane_b32 s23, v12, 1
    v_readlane_b32 s24, v12, 3
    s_nop 3
    s_min_u32 s50, s50, s22
    s_min_u32 s23, s23, s24
    s_lshl_b32 s50, s50, 1
    s_lshl_b32 s23, s23, 1
    s_add_u32 s23, s23, 1
    s_min_u32 s50, s50, s23
mega_kernel_rf_kvb1:
    s_add_u32 s22, s21, 1
    s_min_u32 s22, s22, 63
    s_cmp_gt_u32 s50, s22
    s_cbranch_scc1 mega_kernel_rf_kvd1
    buffer_load_dword v12, v7, s[4:7], 0 offen sc1
    s_waitcnt vmcnt(0)
    v_readlane_b32 s50, v12, 0
    v_readlane_b32 s22, v12, 2
    v_readlane_b32 s23, v12, 1
    v_readlane_b32 s24, v12, 3
    s_nop 3
    s_min_u32 s50, s50, s22
    s_min_u32 s23, s23, s24
    s_lshl_b32 s50, s50, 1
    s_lshl_b32 s23, s23, 1
    s_add_u32 s23, s23, 1
    s_min_u32 s50, s50, s23
    s_branch mega_kernel_rf_kvb1
mega_kernel_rf_kvd1:
mega_kernel_rf_w3_kvs:
    v_mov_b32 v58, -1
    v_mov_b32 v59, -1
    s_waitcnt vmcnt(0)
mega_kernel_rf_w3_cgo:
mega_kernel_rf_w3_pc:
    buffer_load_dword v36, v13, s[4:7], s25 offen offset:0 sc1
    buffer_load_dword v37, v13, s[4:7], s25 offen offset:256 sc1
    buffer_load_dword v38, v13, s[4:7], s25 offen offset:512 sc1
    buffer_load_dword v39, v13, s[4:7], s25 offen offset:768 sc1
    buffer_load_dword v40, v13, s[4:7], s25 offen offset:1024 sc1
    buffer_load_dword v41, v13, s[4:7], s25 offen offset:1280 sc1
    buffer_load_dword v42, v13, s[4:7], s25 offen offset:1536 sc1
    buffer_load_dword v43, v13, s[4:7], s25 offen offset:1792 sc1
    s_waitcnt vmcnt(4)
    v_mfma_f32_16x16x32_bf16 v[52:55], v[36:39], v[24:27], 0
    v_bitop3_b32 v3, s42, v36, v37 bitop3:0x7e
    v_bitop3_b32 v4, s42, v38, v39 bitop3:0x7e
    s_waitcnt vmcnt(2)
    v_or_b32 v3, v3, v4
    v_bitop3_b32 v4, s42, v40, v41 bitop3:0x7e
    s_waitcnt vmcnt(0)
    v_mfma_f32_16x16x32_bf16 v[52:55], v[40:43], v[24:27], v[52:55]
    v_bitop3_b32 v56, s42, v42, v43 bitop3:0x7e
    v_or3_b32 v3, v3, v4, v56
    v_and_b32 v3, v0, v3
    v_cmp_ne_u32 vcc, 0, v3
    s_nop 3
    v_cvt_pk_bf16_f32 v56, v52, v53
    v_cvt_pk_bf16_f32 v57, v54, v55
    v_min_u32 v56, -2, v56
    s_cbranch_vccnz mega_kernel_rf_w3_pc
    s_mov_b64 exec, s[26:27]
    buffer_store_dwordx2 v[56:57], v9, s[4:7], s35 offen offset:768
    buffer_store_dwordx2 v[58:59], v9, s[4:7], s36 offen offset:768
    s_mov_b64 exec, -1
    s_xor_b32 s42, s42, 1
    s_branch mega_kernel_rf_w3_loop
mega_kernel_rf_w3_last:
    buffer_store_dwordx4 v[64:67], v10, s[4:7], s45 offen offset:192 sc1
    buffer_store_dwordx2 v[18:19], v11, s[4:7], s51 offen offset:3584 sc1
    s_branch mega_kernel_rf_end
mega_kernel_rf_w3_pafail:
    s_nop 7
    v_mov_b32 v96, 0
    v_mov_b32 v97, 0
    v_mov_b32 v98, 0
    v_mov_b32 v99, 0
    v_mov_b32 v100, 0
    v_mov_b32 v101, 0
    v_mov_b32 v102, 0
    v_mov_b32 v103, 0
    v_mov_b32 v104, 0
    v_mov_b32 v105, 0
    v_mov_b32 v106, 0
    v_mov_b32 v107, 0
    s_branch mega_kernel_rf_w3_pa
mega_kernel_rf_w3_xslow:
    buffer_load_dwordx2 v[108:109], v11, s[4:7], s38 offen sc1
    buffer_load_dwordx2 v[110:111], v11, s[4:7], s38 offen offset:512 sc1
    s_waitcnt vmcnt(2)
    v_bitop3_b32 v3, s41, v20, v22 bitop3:0x7e
    v_mfma_f32_16x16x16_bf16 v[80:83], v[20:21], v[16:17], v[100:103]
    v_and_b32 v3, 1, v3
    v_mfma_f32_16x16x16_bf16 v[84:87], v[22:23], v[16:17], v[104:107]
    v_cmp_ne_u32 vcc, 0, v3
    s_cbranch_vccz mega_kernel_rf_w3_xgot
    buffer_load_dwordx2 v[20:21], v11, s[4:7], s38 offen sc1
    buffer_load_dwordx2 v[22:23], v11, s[4:7], s38 offen offset:512 sc1
    s_waitcnt vmcnt(2)
    v_bitop3_b32 v3, s41, v108, v110 bitop3:0x7e
    v_mfma_f32_16x16x16_bf16 v[80:83], v[108:109], v[16:17], v[100:103]
    v_and_b32 v3, 1, v3
    v_mfma_f32_16x16x16_bf16 v[84:87], v[110:111], v[16:17], v[104:107]
    v_cmp_ne_u32 vcc, 0, v3
    s_cbranch_vccz mega_kernel_rf_w3_xgot
    s_branch mega_kernel_rf_w3_xslow
mega_kernel_rf_w3_xgot:
    s_nop 3
    v_cvt_pk_bf16_f32 v64, v80, v81
    v_cvt_pk_bf16_f32 v65, v82, v83
    v_cvt_pk_bf16_f32 v66, v84, v85
    v_cvt_pk_bf16_f32 v67, v86, v87
    ds_write_b128 v6, v[64:67] offset:23552
    s_branch mega_kernel_rf_w3_xok
mega_kernel_rf_w3_pv0:
    s_waitcnt vmcnt(2)
    s_branch mega_kernel_rf_w3_pv1
mega_kernel_rf_w3_pv:
    buffer_load_dwordx2 v[20:21], v11, s[4:7], s40 offen sc1
    s_waitcnt vmcnt(0)
mega_kernel_rf_w3_pv1:
    v_and_b32 v3, 1, v20
    v_cmp_ne_u32 vcc, s41, v3
    v_mov_b32 v113, v20
    v_mov_b32 v115, v21
    s_cbranch_vccnz mega_kernel_rf_w3_pv
    s_branch mega_kernel_rf_w3_pv2
mega_kernel_rf_end:
    s_mov_b64 exec, -1
    v_mov_b32 v3, 64
    s_waitcnt vmcnt(0)
    s_barrier
    s_cmp_lg_u32 s20, 0
    s_cbranch_scc1 mega_kernel_rf_end2
    buffer_store_dword v3, v7, s[4:7], 0 offen sc1
mega_kernel_rf_end2:
    s_waitcnt vmcnt(0)
    s_endpgm
mega_kernel_recs:
    s_load_dwordx2 s[4:5], s[0:1], 96
    s_load_dwordx2 s[12:13], s[0:1], 88
    s_load_dwordx2 s[50:51], s[0:1], 16
    s_load_dwordx2 s[52:53], s[0:1], 24
    s_load_dwordx2 s[54:55], s[0:1], 32
    s_load_dwordx2 s[56:57], s[0:1], 40
    s_load_dwordx2 s[58:59], s[0:1], 8
    v_lshrrev_b32 v3, 6, v0
    v_and_b32 v40, 63, v0
    v_readfirstlane_b32 s20, v3
    v_lshrrev_b32 v41, 4, v40
    v_and_b32 v42, 15, v40
    v_lshlrev_b32 v1, 4, v40
    s_mov_b32 s49, 0
    s_waitcnt lgkmcnt(0)
    s_mov_b32 s6, 268435456
    s_mov_b32 s7, 0x00020000
    s_mov_b32 s14, 256
    s_mov_b32 s15, 0x00020000
    s_mov_b32 s10, 8388608
    s_mov_b32 s11, 0x00020000
    s_mov_b32 s26, 0x00030003
    s_mov_b32 s27, 0x00030003
    s_mov_b32 s28, 0xcccccccc
    s_mov_b32 s29, 0xcccccccc
    s_mov_b32 s32, 0x33333333
    s_mov_b32 s33, 0x33333333
    s_mov_b32 s34, 0x3e0293ee
    s_lshl_b32 s22, s20, 2
    v_xor_b32 v3, s22, v42
    v_lshlrev_b32 v3, 4, v3
    v_lshl_add_u32 v4, v41, 4, s20
    v_lshl_add_u32 v44, v4, 13, v3
    s_lshl_b32 s22, s30, 22
    s_lshl_b32 s23, s31, 8
    s_add_u32 s22, s22, s23
    v_add_u32 v44, s22, v44
    s_lshr_b32 s22, s20, 1
    s_lshl_b32 s22, s22, 5
    s_and_b32 s23, s20, 1
    s_lshl_b32 s23, s23, 2
    s_add_u32 s22, s22, s23
    s_lshl_b32 s23, s31, 7
    s_add_u32 s22, s22, s23
    v_add_u32 v4, s22, v41
    v_lshl_add_u32 v45, v4, 11, v3
    s_lshl_b32 s22, s30, 10
    v_add_u32 v45, s22, v45
    s_lshl_b32 s48, s20, 10
    s_mov_b32 s8, s50
    s_mov_b32 s9, s51
    s_add_u32 m0, s48, 0
    s_mov_b32 s22, 0
    buffer_load_dwordx4 v44, s[8:11], s22 offen  lds
    s_add_u32 m0, s48, 4096
    s_mov_b32 s22, 32768
    buffer_load_dwordx4 v44, s[8:11], s22 offen  lds
    s_add_u32 m0, s48, 8192
    s_mov_b32 s22, 65536
    buffer_load_dwordx4 v44, s[8:11], s22 offen  lds
    s_add_u32 m0, s48, 12288
    s_mov_b32 s22, 98304
    buffer_load_dwordx4 v44, s[8:11], s22 offen  lds
    s_add_u32 m0, s48, 16384
    s_mov_b32 s22, 524288
    buffer_load_dwordx4 v44, s[8:11], s22 offen  lds
    s_add_u32 m0, s48, 20480
    s_mov_b32 s22, 557056
    buffer_load_dwordx4 v44, s[8:11], s22 offen  lds
    s_add_u32 m0, s48, 24576
    s_mov_b32 s22, 589824
    buffer_load_dwordx4 v44, s[8:11], s22 offen  lds
    s_add_u32 m0, s48, 28672
    s_mov_b32 s22, 622592
    buffer_load_dwordx4 v44, s[8:11], s22 offen  lds
    s_add_u32 m0, s48, 32768
    s_mov_b32 s22, 1048576
    buffer_load_dwordx4 v44, s[8:11], s22 offen  lds
    s_add_u32 m0, s48, 36864
    s_mov_b32 s22, 1081344
    buffer_load_dwordx4 v44, s[8:11], s22 offen  lds
    s_add_u32 m0, s48, 40960
    s_mov_b32 s22, 1114112
    buffer_load_dwordx4 v44, s[8:11], s22 offen  lds
    s_add_u32 m0, s48, 45056
    s_mov_b32 s22, 1146880
    buffer_load_dwordx4 v44, s[8:11], s22 offen  lds
    s_add_u32 m0, s48, 49152
    s_mov_b32 s22, 1572864
    buffer_load_dwordx4 v44, s[8:11], s22 offen  lds
    s_add_u32 m0, s48, 53248
    s_mov_b32 s22, 1605632
    buffer_load_dwordx4 v44, s[8:11], s22 offen  lds
    s_add_u32 m0, s48, 57344
    s_mov_b32 s22, 1638400
    buffer_load_dwordx4 v44, s[8:11], s22 offen  lds
    s_add_u32 m0, s48, 61440
    s_mov_b32 s22, 1671168
    buffer_load_dwordx4 v44, s[8:11], s22 offen  lds
    s_add_u32 m0, s48, 65536
    s_mov_b32 s22, 2097152
    buffer_load_dwordx4 v44, s[8:11], s22 offen  lds
    s_add_u32 m0, s48, 69632
    s_mov_b32 s22, 2129920
    buffer_load_dwordx4 v44, s[8:11], s22 offen  lds
    s_add_u32 m0, s48, 73728
    s_mov_b32 s22, 2162688
    buffer_load_dwordx4 v44, s[8:11], s22 offen  lds
    s_add_u32 m0, s48, 77824
    s_mov_b32 s22, 2195456
    buffer_load_dwordx4 v44, s[8:11], s22 offen  lds
    s_add_u32 m0, s48, 81920
    s_mov_b32 s22, 2621440
    buffer_load_dwordx4 v44, s[8:11], s22 offen  lds
    s_add_u32 m0, s48, 86016
    s_mov_b32 s22, 2654208
    buffer_load_dwordx4 v44, s[8:11], s22 offen  lds
    s_add_u32 m0, s48, 90112
    s_mov_b32 s22, 2686976
    buffer_load_dwordx4 v44, s[8:11], s22 offen  lds
    s_add_u32 m0, s48, 94208
    s_mov_b32 s22, 2719744
    buffer_load_dwordx4 v44, s[8:11], s22 offen  lds
    s_add_u32 m0, s48, 98304
    s_mov_b32 s22, 3145728
    buffer_load_dwordx4 v44, s[8:11], s22 offen  lds
    s_add_u32 m0, s48, 102400
    s_mov_b32 s22, 3178496
    buffer_load_dwordx4 v44, s[8:11], s22 offen  lds
    s_add_u32 m0, s48, 106496
    s_mov_b32 s22, 3211264
    buffer_load_dwordx4 v44, s[8:11], s22 offen  lds
    s_add_u32 m0, s48, 110592
    s_mov_b32 s22, 3244032
    buffer_load_dwordx4 v44, s[8:11], s22 offen  lds
    s_add_u32 m0, s48, 114688
    s_mov_b32 s22, 3670016
    buffer_load_dwordx4 v44, s[8:11], s22 offen  lds
    s_add_u32 m0, s48, 118784
    s_mov_b32 s22, 3702784
    buffer_load_dwordx4 v44, s[8:11], s22 offen  lds
    s_add_u32 m0, s48, 122880
    s_mov_b32 s22, 3735552
    buffer_load_dwordx4 v44, s[8:11], s22 offen  lds
    s_add_u32 m0, s48, 126976
    s_mov_b32 s22, 3768320
    buffer_load_dwordx4 v44, s[8:11], s22 offen  lds
    s_lshl_b32 s22, s30, 5
    s_add_u32 s22, s22, s31
    s_lshl_b32 s38, s22, 14
    s_xor_b32 s22, s22, 32
    s_lshl_b32 s37, s22, 14
    s_add_u32 s38, s38, 67108864
    s_add_u32 s37, s37, 67108864
    s_lshl_b32 s46, s30, 19
    s_add_u32 s46, s46, 70254592
    s_mul_i32 s22, s31, 8448
    s_add_u32 s47, s46, s22
    s_mul_i32 s22, s20, 67584
    s_add_u32 s46, s46, s22
    s_lshl_b32 s22, s31, 6
    s_add_u32 s46, s46, s22
    s_add_u32 s61, s46, 33792
    s_mul_i32 s22, s20, 2048
    s_add_u32 s25, s47, s22
    s_lshl_b32 s35, s30, 13
    s_add_u32 s35, s35, 69206016
    v_lshrrev_b32 v53, 2, v42
    v_lshlrev_b32 v53, 1, v53
    v_and_b32 v54, 1, v42
    v_add_u32 v55, v53, v54
    v_mov_b32 v14, 0
    v_mov_b32 v15, 0
    v_mov_b32 v2, 0x4444
    v_mov_b32 v3, 0xeeee
    v_cndmask_b32 v2, v2, v3, s[28:29]
    s_lshl_b32 s22, s20, 12
    v_add_u32 v32, s22, v1
    v_add_u32 v33, 0x10000, v32
    v_add_u32 v5, 0x10000, v1
    v_add_u32 v6, 131072, v1
    v_and_b32 v3, 3, v42
    v_bfe_u32 v43, v40, 1, 1
    v_lshlrev_b32 v7, 13, v43
    v_and_b32 v43, 1, v40
    v_lshl_add_u32 v7, v43, 7, v7
    s_lshl_b32 s22, s31, 8
    s_add_u32 s23, s22, 71311360
    v_add_u32 v7, s23, v7
    s_cmp_lg_u32 s20, 0
    s_cbranch_scc1 mega_kernel_rs_flk
    s_lshl_b32 s23, s30, 7
    s_add_u32 s22, s22, s23
    s_add_u32 s22, s22, 71327744
    v_bfrev_b32 v7, 1
    v_writelane_b32 v7, s22, 0
mega_kernel_rs_flk:
    v_lshlrev_b32 v11, 3, v40
    v_lshlrev_b32 v10, 8, v55
    v_lshl_add_u32 v10, v41, 4, v10
    v_mul_u32_u24 v8, 8448, v41
    v_lshl_add_u32 v8, v3, 4, v8
    v_lshrrev_b32 v4, 2, v42
    v_mul_u32_u24 v4, 2048, v4
    v_add_u32 v8, v4, v8
    v_lshrrev_b32 v9, 1, v41
    v_lshlrev_b32 v9, 5, v9
    v_and_b32 v4, 1, v42
    v_lshl_add_u32 v9, v4, 4, v9
    v_and_b32 v4, 1, v41
    v_lshl_add_u32 v9, v4, 3, v9
    s_lshr_b32 s22, s31, 2
    s_lshl_b32 s22, s22, 10
    s_and_b32 s23, s31, 3
    s_lshl_b32 s23, s23, 6
    s_add_u32 s22, s22, s23
    v_add_u32 v9, s22, v9
    v_lshrrev_b32 v4, 2, v42
    v_lshlrev_b32 v12, 8, v4
    v_lshl_add_u32 v12, v41, 6, v12
    v_lshl_add_u32 v12, v3, 4, v12
    v_lshlrev_b32 v13, 6, v41
    v_lshl_add_u32 v13, v42, 2, v13
    v_cmp_eq_u32 vcc, 0, v3
    v_mov_b32 v28, 0x3f803f80
    v_mov_b32 v29, 0x3f803f80
    v_cndmask_b32 v34, 0, 1, vcc
    v_mov_b32 v30, 0x3f803f80
    v_mov_b32 v31, 0x3f803f80
    v_and_b32 v49, 1, v42
    v_lshlrev_b32 v49, 4, v49
    v_mov_b32 v50, 0x3f80
    v_lshlrev_b32 v50, v49, v50
    v_lshrrev_b32 v51, 2, v42
    v_cmp_eq_u32 vcc, v51, v41
    v_mov_b32 v24, v50
    v_cndmask_b32 v52, 0, v50, s[28:29]
    v_cndmask_b32 v53, 0, v50, s[32:33]
    v_cndmask_b32 v16, 0, v52, vcc
    v_cndmask_b32 v17, 0, v53, vcc
    v_mov_b32 v25, v50
    v_mov_b32 v26, v50
    v_mov_b32 v27, v50
    v_bfe_u32 v60, v40, 3, 1
    v_bfe_u32 v49, v40, 2, 1
    v_and_b32 v50, 1, v41
    v_lshrrev_b32 v51, 1, v41
    v_lshlrev_b32 v52, 3, v60
    v_lshl_add_u32 v52, v50, 2, v52
    v_lshl_add_u32 v53, v51, 4, v52
    v_add_u32 v53, v53, v49
    v_and_b32 v54, 3, v40
    s_lshl_b32 s22, s20, 2
    v_add_u32 v55, s22, v54
    v_xor_b32 v55, v55, v52
    v_lshlrev_b32 v55, 4, v55
    v_lshl_add_u32 v46, v53, 8, v55
    v_lshlrev_b32 v55, 4, v52
    v_lshl_add_u32 v55, v54, 3, v55
    v_lshl_add_u32 v47, v53, 8, v55
    s_waitcnt vmcnt(28)
    s_barrier
    v_add_u32 v48, 0, v46
    ds_read_b64_tr_b16 a[0:1], v48 offset:0
    ds_read_b64_tr_b16 a[2:3], v48 offset:512
    ds_read_b64_tr_b16 a[4:5], v48 offset:8192
    ds_read_b64_tr_b16 a[6:7], v48 offset:8704
    ds_read_b64_tr_b16 a[8:9], v48 offset:8
    ds_read_b64_tr_b16 a[10:11], v48 offset:520
    ds_read_b64_tr_b16 a[12:13], v48 offset:8200
    ds_read_b64_tr_b16 a[14:15], v48 offset:8712
    s_waitcnt lgkmcnt(0)
    s_barrier
    s_mov_b32 s8, s52
    s_mov_b32 s9, s53
    s_add_u32 m0, s48, 0
    s_mov_b32 s22, 0
    buffer_load_dwordx4 v44, s[8:11], s22 offen  lds
    s_add_u32 m0, s48, 4096
    s_mov_b32 s22, 32768
    buffer_load_dwordx4 v44, s[8:11], s22 offen  lds
    s_add_u32 m0, s48, 8192
    s_mov_b32 s22, 65536
    buffer_load_dwordx4 v44, s[8:11], s22 offen  lds
    s_add_u32 m0, s48, 12288
    s_mov_b32 s22, 98304
    buffer_load_dwordx4 v44, s[8:11], s22 offen  lds
    s_waitcnt vmcnt(28)
    s_barrier
    v_add_u32 v48, 16384, v46
    ds_read_b64_tr_b16 a[16:17], v48 offset:0
    ds_read_b64_tr_b16 a[18:19], v48 offset:512
    ds_read_b64_tr_b16 a[20:21], v48 offset:8192
    ds_read_b64_tr_b16 a[22:23], v48 offset:8704
    ds_read_b64_tr_b16 a[24:25], v48 offset:8
    ds_read_b64_tr_b16 a[26:27], v48 offset:520
    ds_read_b64_tr_b16 a[28:29], v48 offset:8200
    ds_read_b64_tr_b16 a[30:31], v48 offset:8712
    s_waitcnt lgkmcnt(0)
    s_barrier
    s_add_u32 m0, s48, 16384
    s_mov_b32 s22, 524288
    buffer_load_dwordx4 v44, s[8:11], s22 offen  lds
    s_add_u32 m0, s48, 20480
    s_mov_b32 s22, 557056
    buffer_load_dwordx4 v44, s[8:11], s22 offen  lds
    s_add_u32 m0, s48, 24576
    s_mov_b32 s22, 589824
    buffer_load_dwordx4 v44, s[8:11], s22 offen  lds
    s_add_u32 m0, s48, 28672
    s_mov_b32 s22, 622592
    buffer_load_dwordx4 v44, s[8:11], s22 offen  lds
    s_waitcnt vmcnt(28)
    s_barrier
    v_add_u32 v48, 32768, v46
    ds_read_b64_tr_b16 a[32:33], v48 offset:0
    ds_read_b64_tr_b16 a[34:35], v48 offset:512
    ds_read_b64_tr_b16 a[36:37], v48 offset:8192
    ds_read_b64_tr_b16 a[38:39], v48 offset:8704
    ds_read_b64_tr_b16 a[40:41], v48 offset:8
    ds_read_b64_tr_b16 a[42:43], v48 offset:520
    ds_read_b64_tr_b16 a[44:45], v48 offset:8200
    ds_read_b64_tr_b16 a[46:47], v48 offset:8712
    s_waitcnt lgkmcnt(0)
    s_barrier
    s_add_u32 m0, s48, 32768
    s_mov_b32 s22, 1048576
    buffer_load_dwordx4 v44, s[8:11], s22 offen  lds
    s_add_u32 m0, s48, 36864
    s_mov_b32 s22, 1081344
    buffer_load_dwordx4 v44, s[8:11], s22 offen  lds
    s_add_u32 m0, s48, 40960
    s_mov_b32 s22, 1114112
    buffer_load_dwordx4 v44, s[8:11], s22 offen  lds
    s_add_u32 m0, s48, 45056
    s_mov_b32 s22, 1146880
    buffer_load_dwordx4 v44, s[8:11], s22 offen  lds
    s_waitcnt vmcnt(28)
    s_barrier
    v_add_u32 v48, 49152, v46
    ds_read_b64_tr_b16 a[48:49], v48 offset:0
    ds_read_b64_tr_b16 a[50:51], v48 offset:512
    ds_read_b64_tr_b16 a[52:53], v48 offset:8192
    ds_read_b64_tr_b16 a[54:55], v48 offset:8704
    ds_read_b64_tr_b16 a[56:57], v48 offset:8
    ds_read_b64_tr_b16 a[58:59], v48 offset:520
    ds_read_b64_tr_b16 a[60:61], v48 offset:8200
    ds_read_b64_tr_b16 a[62:63], v48 offset:8712
    s_waitcnt lgkmcnt(0)
    s_barrier
    s_add_u32 m0, s48, 49152
    s_mov_b32 s22, 1572864
    buffer_load_dwordx4 v44, s[8:11], s22 offen  lds
    s_add_u32 m0, s48, 53248
    s_mov_b32 s22, 1605632
    buffer_load_dwordx4 v44, s[8:11], s22 offen  lds
    s_add_u32 m0, s48, 57344
    s_mov_b32 s22, 1638400
    buffer_load_dwordx4 v44, s[8:11], s22 offen  lds
    s_add_u32 m0, s48, 61440
    s_mov_b32 s22, 1671168
    buffer_load_dwordx4 v44, s[8:11], s22 offen  lds
    s_waitcnt vmcnt(28)
    s_barrier
    v_add_u32 v48, 65536, v46
    ds_read_b64_tr_b16 a[64:65], v48 offset:0
    ds_read_b64_tr_b16 a[66:67], v48 offset:512
    ds_read_b64_tr_b16 a[68:69], v48 offset:8192
    ds_read_b64_tr_b16 a[70:71], v48 offset:8704
    ds_read_b64_tr_b16 a[72:73], v48 offset:8
    ds_read_b64_tr_b16 a[74:75], v48 offset:520
    ds_read_b64_tr_b16 a[76:77], v48 offset:8200
    ds_read_b64_tr_b16 a[78:79], v48 offset:8712
    s_waitcnt lgkmcnt(0)
    s_barrier
    s_add_u32 m0, s48, 65536
    s_mov_b32 s22, 2097152
    buffer_load_dwordx4 v44, s[8:11], s22 offen  lds
    s_add_u32 m0, s48, 69632
    s_mov_b32 s22, 2129920
    buffer_load_dwordx4 v44, s[8:11], s22 offen  lds
    s_add_u32 m0, s48, 73728
    s_mov_b32 s22, 2162688
    buffer_load_dwordx4 v44, s[8:11], s22 offen  lds
    s_add_u32 m0, s48, 77824
    s_mov_b32 s22, 2195456
    buffer_load_dwordx4 v44, s[8:11], s22 offen  lds
    s_waitcnt vmcnt(28)
    s_barrier
    v_add_u32 v48, 81920, v46
    ds_read_b64_tr_b16 a[80:81], v48 offset:0
    ds_read_b64_tr_b16 a[82:83], v48 offset:512
    ds_read_b64_tr_b16 a[84:85], v48 offset:8192
    ds_read_b64_tr_b16 a[86:87], v48 offset:8704
    ds_read_b64_tr_b16 a[88:89], v48 offset:8
    ds_read_b64_tr_b16 a[90:91], v48 offset:520
    ds_read_b64_tr_b16 a[92:93], v48 offset:8200
    ds_read_b64_tr_b16 a[94:95], v48 offset:8712
    s_waitcnt lgkmcnt(0)
    s_barrier
    s_add_u32 m0, s48, 81920
    s_mov_b32 s22, 2621440
    buffer_load_dwordx4 v44, s[8:11], s22 offen  lds
    s_add_u32 m0, s48, 86016
    s_mov_b32 s22, 2654208
    buffer_load_dwordx4 v44, s[8:11], s22 offen  lds
    s_add_u32 m0, s48, 90112
    s_mov_b32 s22, 2686976
    buffer_load_dwordx4 v44, s[8:11], s22 offen  lds
    s_add_u32 m0, s48, 94208
    s_mov_b32 s22, 2719744
    buffer_load_dwordx4 v44, s[8:11], s22 offen  lds
    s_waitcnt vmcnt(28)
    s_barrier
    v_add_u32 v48, 98304, v46
    ds_read_b64_tr_b16 a[96:97], v48 offset:0
    ds_read_b64_tr_b16 a[98:99], v48 offset:512
    ds_read_b64_tr_b16 a[100:101], v48 offset:8192
    ds_read_b64_tr_b16 a[102:103], v48 offset:8704
    ds_read_b64_tr_b16 a[104:105], v48 offset:8
    ds_read_b64_tr_b16 a[106:107], v48 offset:520
    ds_read_b64_tr_b16 a[108:109], v48 offset:8200
    ds_read_b64_tr_b16 a[110:111], v48 offset:8712
    s_waitcnt lgkmcnt(0)
    s_barrier
    s_add_u32 m0, s48, 98304
    s_mov_b32 s22, 3145728
    buffer_load_dwordx4 v44, s[8:11], s22 offen  lds
    s_add_u32 m0, s48, 102400
    s_mov_b32 s22, 3178496
    buffer_load_dwordx4 v44, s[8:11], s22 offen  lds
    s_add_u32 m0, s48, 106496
    s_mov_b32 s22, 3211264
    buffer_load_dwordx4 v44, s[8:11], s22 offen  lds
    s_add_u32 m0, s48, 110592
    s_mov_b32 s22, 3244032
    buffer_load_dwordx4 v44, s[8:11], s22 offen  lds
    s_waitcnt vmcnt(28)
    s_barrier
    v_add_u32 v48, 114688, v46
    ds_read_b64_tr_b16 a[112:113], v48 offset:0
    ds_read_b64_tr_b16 a[114:115], v48 offset:512
    ds_read_b64_tr_b16 a[116:117], v48 offset:8192
    ds_read_b64_tr_b16 a[118:119], v48 offset:8704
    ds_read_b64_tr_b16 a[120:121], v48 offset:8
    ds_read_b64_tr_b16 a[122:123], v48 offset:520
    ds_read_b64_tr_b16 a[124:125], v48 offset:8200
    ds_read_b64_tr_b16 a[126:127], v48 offset:8712
    s_waitcnt lgkmcnt(0)
    s_barrier
    s_add_u32 m0, s48, 114688
    s_mov_b32 s22, 3670016
    buffer_load_dwordx4 v44, s[8:11], s22 offen  lds
    s_add_u32 m0, s48, 118784
    s_mov_b32 s22, 3702784
    buffer_load_dwordx4 v44, s[8:11], s22 offen  lds
    s_add_u32 m0, s48, 122880
    s_mov_b32 s22, 3735552
    buffer_load_dwordx4 v44, s[8:11], s22 offen  lds
    s_add_u32 m0, s48, 126976
    s_mov_b32 s22, 3768320
    buffer_load_dwordx4 v44, s[8:11], s22 offen  lds
    s_waitcnt vmcnt(28)
    s_barrier
    v_add_u32 v48, 0, v46
    ds_read_b64_tr_b16 a[128:129], v48 offset:0
    ds_read_b64_tr_b16 a[130:131], v48 offset:512
    ds_read_b64_tr_b16 a[132:133], v48 offset:8192
    ds_read_b64_tr_b16 a[134:135], v48 offset:8704
    ds_read_b64_tr_b16 a[136:137], v48 offset:8
    ds_read_b64_tr_b16 a[138:139], v48 offset:520
    ds_read_b64_tr_b16 a[140:141], v48 offset:8200
    ds_read_b64_tr_b16 a[142:143], v48 offset:8712
    s_waitcnt lgkmcnt(0)
    s_barrier
    s_mov_b32 s8, s56
    s_mov_b32 s9, s57
    s_add_u32 m0, s48, 0
    s_mov_b32 s22, 0
    buffer_load_dwordx4 v45, s[8:11], s22 offen  lds
    s_add_u32 m0, s48, 4096
    s_mov_b32 s22, 16384
    buffer_load_dwordx4 v45, s[8:11], s22 offen  lds
    s_add_u32 m0, s48, 8192
    s_mov_b32 s22, 32768
    buffer_load_dwordx4 v45, s[8:11], s22 offen  lds
    s_add_u32 m0, s48, 12288
    s_mov_b32 s22, 49152
    buffer_load_dwordx4 v45, s[8:11], s22 offen  lds
    s_waitcnt vmcnt(28)
    s_barrier
    v_add_u32 v48, 16384, v46
    ds_read_b64_tr_b16 a[144:145], v48 offset:0
    ds_read_b64_tr_b16 a[146:147], v48 offset:512
    ds_read_b64_tr_b16 a[148:149], v48 offset:8192
    ds_read_b64_tr_b16 a[150:151], v48 offset:8704
    ds_read_b64_tr_b16 a[152:153], v48 offset:8
    ds_read_b64_tr_b16 a[154:155], v48 offset:520
    ds_read_b64_tr_b16 a[156:157], v48 offset:8200
    ds_read_b64_tr_b16 a[158:159], v48 offset:8712
    s_waitcnt lgkmcnt(0)
    s_barrier
    s_add_u32 m0, s48, 16384
    s_mov_b32 s22, 256
    buffer_load_dwordx4 v45, s[8:11], s22 offen  lds
    s_add_u32 m0, s48, 20480
    s_mov_b32 s22, 16640
    buffer_load_dwordx4 v45, s[8:11], s22 offen  lds
    s_add_u32 m0, s48, 24576
    s_mov_b32 s22, 33024
    buffer_load_dwordx4 v45, s[8:11], s22 offen  lds
    s_add_u32 m0, s48, 28672
    s_mov_b32 s22, 49408
    buffer_load_dwordx4 v45, s[8:11], s22 offen  lds
    s_waitcnt vmcnt(28)
    s_barrier
    v_add_u32 v48, 32768, v46
    ds_read_b64_tr_b16 a[160:161], v48 offset:0
    ds_read_b64_tr_b16 a[162:163], v48 offset:512
    ds_read_b64_tr_b16 a[164:165], v48 offset:8192
    ds_read_b64_tr_b16 a[166:167], v48 offset:8704
    ds_read_b64_tr_b16 a[168:169], v48 offset:8
    ds_read_b64_tr_b16 a[170:171], v48 offset:520
    ds_read_b64_tr_b16 a[172:173], v48 offset:8200
    ds_read_b64_tr_b16 a[174:175], v48 offset:8712
    s_waitcnt lgkmcnt(0)
    s_barrier
    s_add_u32 m0, s48, 32768
    s_mov_b32 s22, 512
    buffer_load_dwordx4 v45, s[8:11], s22 offen  lds
    s_add_u32 m0, s48, 36864
    s_mov_b32 s22, 16896
    buffer_load_dwordx4 v45, s[8:11], s22 offen  lds
    s_add_u32 m0, s48, 40960
    s_mov_b32 s22, 33280
    buffer_load_dwordx4 v45, s[8:11], s22 offen  lds
    s_add_u32 m0, s48, 45056
    s_mov_b32 s22, 49664
    buffer_load_dwordx4 v45, s[8:11], s22 offen  lds
    s_waitcnt vmcnt(28)
    s_barrier
    v_add_u32 v48, 49152, v46
    ds_read_b64_tr_b16 a[176:177], v48 offset:0
    ds_read_b64_tr_b16 a[178:179], v48 offset:512
    ds_read_b64_tr_b16 a[180:181], v48 offset:8192
    ds_read_b64_tr_b16 a[182:183], v48 offset:8704
    ds_read_b64_tr_b16 a[184:185], v48 offset:8
    ds_read_b64_tr_b16 a[186:187], v48 offset:520
    ds_read_b64_tr_b16 a[188:189], v48 offset:8200
    ds_read_b64_tr_b16 a[190:191], v48 offset:8712
    s_waitcnt lgkmcnt(0)
    s_barrier
    s_add_u32 m0, s48, 49152
    s_mov_b32 s22, 768
    buffer_load_dwordx4 v45, s[8:11], s22 offen  lds
    s_add_u32 m0, s48, 53248
    s_mov_b32 s22, 17152
    buffer_load_dwordx4 v45, s[8:11], s22 offen  lds
    s_add_u32 m0, s48, 57344
    s_mov_b32 s22, 33536
    buffer_load_dwordx4 v45, s[8:11], s22 offen  lds
    s_add_u32 m0, s48, 61440
    s_mov_b32 s22, 49920
    buffer_load_dwordx4 v45, s[8:11], s22 offen  lds
    s_waitcnt vmcnt(28)
    s_barrier
    v_add_u32 v48, 65536, v46
    ds_read_b64_tr_b16 a[192:193], v48 offset:0
    ds_read_b64_tr_b16 a[194:195], v48 offset:512
    ds_read_b64_tr_b16 a[196:197], v48 offset:8192
    ds_read_b64_tr_b16 a[198:199], v48 offset:8704
    ds_read_b64_tr_b16 a[200:201], v48 offset:8
    ds_read_b64_tr_b16 a[202:203], v48 offset:520
    ds_read_b64_tr_b16 a[204:205], v48 offset:8200
    ds_read_b64_tr_b16 a[206:207], v48 offset:8712
    s_waitcnt lgkmcnt(0)
    s_barrier
    s_add_u32 m0, s48, 65536
    s_mov_b32 s22, 131072
    buffer_load_dwordx4 v45, s[8:11], s22 offen  lds
    s_add_u32 m0, s48, 69632
    s_mov_b32 s22, 147456
    buffer_load_dwordx4 v45, s[8:11], s22 offen  lds
    s_add_u32 m0, s48, 73728
    s_mov_b32 s22, 163840
    buffer_load_dwordx4 v45, s[8:11], s22 offen  lds
    s_add_u32 m0, s48, 77824
    s_mov_b32 s22, 180224
    buffer_load_dwordx4 v45, s[8:11], s22 offen  lds
    s_waitcnt vmcnt(28)
    s_barrier
    v_add_u32 v48, 81920, v46
    ds_read_b64_tr_b16 a[208:209], v48 offset:0
    ds_read_b64_tr_b16 a[210:211], v48 offset:512
    ds_read_b64_tr_b16 a[212:213], v48 offset:8192
    ds_read_b64_tr_b16 a[214:215], v48 offset:8704
    ds_read_b64_tr_b16 a[216:217], v48 offset:8
    ds_read_b64_tr_b16 a[218:219], v48 offset:520
    ds_read_b64_tr_b16 a[220:221], v48 offset:8200
    ds_read_b64_tr_b16 a[222:223], v48 offset:8712
    s_waitcnt lgkmcnt(0)
    s_barrier
    s_add_u32 m0, s48, 81920
    s_mov_b32 s22, 131328
    buffer_load_dwordx4 v45, s[8:11], s22 offen  lds
    s_add_u32 m0, s48, 86016
    s_mov_b32 s22, 147712
    buffer_load_dwordx4 v45, s[8:11], s22 offen  lds
    s_add_u32 m0, s48, 90112
    s_mov_b32 s22, 164096
    buffer_load_dwordx4 v45, s[8:11], s22 offen  lds
    s_add_u32 m0, s48, 94208
    s_mov_b32 s22, 180480
    buffer_load_dwordx4 v45, s[8:11], s22 offen  lds
    s_waitcnt vmcnt(28)
    s_barrier
    v_add_u32 v48, 98304, v46
    ds_read_b64_tr_b16 a[224:225], v48 offset:0
    ds_read_b64_tr_b16 a[226:227], v48 offset:512
    ds_read_b64_tr_b16 a[228:229], v48 offset:8192
    ds_read_b64_tr_b16 a[230:231], v48 offset:8704
    ds_read_b64_tr_b16 a[232:233], v48 offset:8
    ds_read_b64_tr_b16 a[234:235], v48 offset:520
    ds_read_b64_tr_b16 a[236:237], v48 offset:8200
    ds_read_b64_tr_b16 a[238:239], v48 offset:8712
    s_waitcnt lgkmcnt(0)
    s_barrier
    s_add_u32 m0, s48, 98304
    s_mov_b32 s22, 131584
    buffer_load_dwordx4 v45, s[8:11], s22 offen  lds
    s_add_u32 m0, s48, 102400
    s_mov_b32 s22, 147968
    buffer_load_dwordx4 v45, s[8:11], s22 offen  lds
    s_add_u32 m0, s48, 106496
    s_mov_b32 s22, 164352
    buffer_load_dwordx4 v45, s[8:11], s22 offen  lds
    s_add_u32 m0, s48, 110592
    s_mov_b32 s22, 180736
    buffer_load_dwordx4 v45, s[8:11], s22 offen  lds
    s_waitcnt vmcnt(28)
    s_barrier
    v_add_u32 v48, 114688, v46
    ds_read_b64_tr_b16 a[240:241], v48 offset:0
    ds_read_b64_tr_b16 a[242:243], v48 offset:512
    ds_read_b64_tr_b16 a[244:245], v48 offset:8192
    ds_read_b64_tr_b16 a[246:247], v48 offset:8704
    ds_read_b64_tr_b16 a[248:249], v48 offset:8
    ds_read_b64_tr_b16 a[250:251], v48 offset:520
    ds_read_b64_tr_b16 a[252:253], v48 offset:8200
    ds_read_b64_tr_b16 a[254:255], v48 offset:8712
    s_waitcnt lgkmcnt(0)
    s_barrier
    s_add_u32 m0, s48, 114688
    s_mov_b32 s22, 131840
    buffer_load_dwordx4 v45, s[8:11], s22 offen  lds
    s_add_u32 m0, s48, 118784
    s_mov_b32 s22, 148224
    buffer_load_dwordx4 v45, s[8:11], s22 offen  lds
    s_add_u32 m0, s48, 122880
    s_mov_b32 s22, 164608
    buffer_load_dwordx4 v45, s[8:11], s22 offen  lds
    s_add_u32 m0, s48, 126976
    s_mov_b32 s22, 180992
    buffer_load_dwordx4 v45, s[8:11], s22 offen  lds
    s_waitcnt vmcnt(28)
    s_barrier
    s_cmp_lg_u32 s20, 0
    s_cbranch_scc1 mega_kernel_rs_wo0
    v_xor_b32 v48, 0, v47
    v_add_u32 v48, 0, v48
    ds_read_b64_tr_b16 v[128:129], v48 offset:0
    ds_read_b64_tr_b16 v[130:131], v48 offset:512
    ds_read_b64_tr_b16 v[132:133], v48 offset:8192
    ds_read_b64_tr_b16 v[134:135], v48 offset:8704
    ds_read_b64_tr_b16 v[144:145], v48 offset:32
    ds_read_b64_tr_b16 v[146:147], v48 offset:544
    ds_read_b64_tr_b16 v[148:149], v48 offset:8224
    ds_read_b64_tr_b16 v[150:151], v48 offset:8736
    s_waitcnt lgkmcnt(0)
    v_xor_b32 v48, 64, v47
    v_add_u32 v48, 0, v48
    ds_read_b64_tr_b16 v[160:161], v48 offset:0
    ds_read_b64_tr_b16 v[162:163], v48 offset:512
    ds_read_b64_tr_b16 v[164:165], v48 offset:8192
    ds_read_b64_tr_b16 v[166:167], v48 offset:8704
    ds_read_b64_tr_b16 v[176:177], v48 offset:32
    ds_read_b64_tr_b16 v[178:179], v48 offset:544
    ds_read_b64_tr_b16 v[180:181], v48 offset:8224
    ds_read_b64_tr_b16 v[182:183], v48 offset:8736
    s_waitcnt lgkmcnt(0)
    v_xor_b32 v48, 128, v47
    v_add_u32 v48, 0, v48
    ds_read_b64_tr_b16 v[192:193], v48 offset:0
    ds_read_b64_tr_b16 v[194:195], v48 offset:512
    ds_read_b64_tr_b16 v[196:197], v48 offset:8192
    ds_read_b64_tr_b16 v[198:199], v48 offset:8704
    ds_read_b64_tr_b16 v[208:209], v48 offset:32
    ds_read_b64_tr_b16 v[210:211], v48 offset:544
    ds_read_b64_tr_b16 v[212:213], v48 offset:8224
    ds_read_b64_tr_b16 v[214:215], v48 offset:8736
    s_waitcnt lgkmcnt(0)
    v_xor_b32 v48, 192, v47
    v_add_u32 v48, 0, v48
    ds_read_b64_tr_b16 v[224:225], v48 offset:0
    ds_read_b64_tr_b16 v[226:227], v48 offset:512
    ds_read_b64_tr_b16 v[228:229], v48 offset:8192
    ds_read_b64_tr_b16 v[230:231], v48 offset:8704
    ds_read_b64_tr_b16 v[240:241], v48 offset:32
    ds_read_b64_tr_b16 v[242:243], v48 offset:544
    ds_read_b64_tr_b16 v[244:245], v48 offset:8224
    ds_read_b64_tr_b16 v[246:247], v48 offset:8736
    s_waitcnt lgkmcnt(0)
mega_kernel_rs_wo0:
    s_barrier
    s_mov_b32 s8, s54
    s_mov_b32 s9, s55
    s_add_u32 m0, s48, 0
    s_mov_b32 s22, 0
    buffer_load_dwordx4 v44, s[8:11], s22 offen  lds
    s_add_u32 m0, s48, 4096
    s_mov_b32 s22, 32768
    buffer_load_dwordx4 v44, s[8:11], s22 offen  lds
    s_add_u32 m0, s48, 8192
    s_mov_b32 s22, 65536
    buffer_load_dwordx4 v44, s[8:11], s22 offen  lds
    s_add_u32 m0, s48, 12288
    s_mov_b32 s22, 98304
    buffer_load_dwordx4 v44, s[8:11], s22 offen  lds
    s_waitcnt vmcnt(28)
    s_barrier
    s_cmp_lg_u32 s20, 1
    s_cbranch_scc1 mega_kernel_rs_wo1
    v_xor_b32 v48, 0, v47
    v_add_u32 v48, 16384, v48
    ds_read_b64_tr_b16 v[128:129], v48 offset:0
    ds_read_b64_tr_b16 v[130:131], v48 offset:512
    ds_read_b64_tr_b16 v[132:133], v48 offset:8192
    ds_read_b64_tr_b16 v[134:135], v48 offset:8704
    ds_read_b64_tr_b16 v[144:145], v48 offset:32
    ds_read_b64_tr_b16 v[146:147], v48 offset:544
    ds_read_b64_tr_b16 v[148:149], v48 offset:8224
    ds_read_b64_tr_b16 v[150:151], v48 offset:8736
    s_waitcnt lgkmcnt(0)
    v_xor_b32 v48, 64, v47
    v_add_u32 v48, 16384, v48
    ds_read_b64_tr_b16 v[160:161], v48 offset:0
    ds_read_b64_tr_b16 v[162:163], v48 offset:512
    ds_read_b64_tr_b16 v[164:165], v48 offset:8192
    ds_read_b64_tr_b16 v[166:167], v48 offset:8704
    ds_read_b64_tr_b16 v[176:177], v48 offset:32
    ds_read_b64_tr_b16 v[178:179], v48 offset:544
    ds_read_b64_tr_b16 v[180:181], v48 offset:8224
    ds_read_b64_tr_b16 v[182:183], v48 offset:8736
    s_waitcnt lgkmcnt(0)
    v_xor_b32 v48, 128, v47
    v_add_u32 v48, 16384, v48
    ds_read_b64_tr_b16 v[192:193], v48 offset:0
    ds_read_b64_tr_b16 v[194:195], v48 offset:512
    ds_read_b64_tr_b16 v[196:197], v48 offset:8192
    ds_read_b64_tr_b16 v[198:199], v48 offset:8704
    ds_read_b64_tr_b16 v[208:209], v48 offset:32
    ds_read_b64_tr_b16 v[210:211], v48 offset:544
    ds_read_b64_tr_b16 v[212:213], v48 offset:8224
    ds_read_b64_tr_b16 v[214:215], v48 offset:8736
    s_waitcnt lgkmcnt(0)
    v_xor_b32 v48, 192, v47
    v_add_u32 v48, 16384, v48
    ds_read_b64_tr_b16 v[224:225], v48 offset:0
    ds_read_b64_tr_b16 v[226:227], v48 offset:512
    ds_read_b64_tr_b16 v[228:229], v48 offset:8192
    ds_read_b64_tr_b16 v[230:231], v48 offset:8704
    ds_read_b64_tr_b16 v[240:241], v48 offset:32
    ds_read_b64_tr_b16 v[242:243], v48 offset:544
    ds_read_b64_tr_b16 v[244:245], v48 offset:8224
    ds_read_b64_tr_b16 v[246:247], v48 offset:8736
    s_waitcnt lgkmcnt(0)
mega_kernel_rs_wo1:
    s_barrier
    s_add_u32 m0, s48, 16384
    s_mov_b32 s22, 524288
    buffer_load_dwordx4 v44, s[8:11], s22 offen  lds
    s_add_u32 m0, s48, 20480
    s_mov_b32 s22, 557056
    buffer_load_dwordx4 v44, s[8:11], s22 offen  lds
    s_add_u32 m0, s48, 24576
    s_mov_b32 s22, 589824
    buffer_load_dwordx4 v44, s[8:11], s22 offen  lds
    s_add_u32 m0, s48, 28672
    s_mov_b32 s22, 622592
    buffer_load_dwordx4 v44, s[8:11], s22 offen  lds
    s_waitcnt vmcnt(28)
    s_barrier
    s_cmp_lg_u32 s20, 2
    s_cbranch_scc1 mega_kernel_rs_wo2
    v_xor_b32 v48, 0, v47
    v_add_u32 v48, 32768, v48
    ds_read_b64_tr_b16 v[128:129], v48 offset:0
    ds_read_b64_tr_b16 v[130:131], v48 offset:512
    ds_read_b64_tr_b16 v[132:133], v48 offset:8192
    ds_read_b64_tr_b16 v[134:135], v48 offset:8704
    ds_read_b64_tr_b16 v[144:145], v48 offset:32
    ds_read_b64_tr_b16 v[146:147], v48 offset:544
    ds_read_b64_tr_b16 v[148:149], v48 offset:8224
    ds_read_b64_tr_b16 v[150:151], v48 offset:8736
    s_waitcnt lgkmcnt(0)
    v_xor_b32 v48, 64, v47
    v_add_u32 v48, 32768, v48
    ds_read_b64_tr_b16 v[160:161], v48 offset:0
    ds_read_b64_tr_b16 v[162:163], v48 offset:512
    ds_read_b64_tr_b16 v[164:165], v48 offset:8192
    ds_read_b64_tr_b16 v[166:167], v48 offset:8704
    ds_read_b64_tr_b16 v[176:177], v48 offset:32
    ds_read_b64_tr_b16 v[178:179], v48 offset:544
    ds_read_b64_tr_b16 v[180:181], v48 offset:8224
    ds_read_b64_tr_b16 v[182:183], v48 offset:8736
    s_waitcnt lgkmcnt(0)
    v_xor_b32 v48, 128, v47
    v_add_u32 v48, 32768, v48
    ds_read_b64_tr_b16 v[192:193], v48 offset:0
    ds_read_b64_tr_b16 v[194:195], v48 offset:512
    ds_read_b64_tr_b16 v[196:197], v48 offset:8192
    ds_read_b64_tr_b16 v[198:199], v48 offset:8704
    ds_read_b64_tr_b16 v[208:209], v48 offset:32
    ds_read_b64_tr_b16 v[210:211], v48 offset:544
    ds_read_b64_tr_b16 v[212:213], v48 offset:8224
    ds_read_b64_tr_b16 v[214:215], v48 offset:8736
    s_waitcnt lgkmcnt(0)
    v_xor_b32 v48, 192, v47
    v_add_u32 v48, 32768, v48
    ds_read_b64_tr_b16 v[224:225], v48 offset:0
    ds_read_b64_tr_b16 v[226:227], v48 offset:512
    ds_read_b64_tr_b16 v[228:229], v48 offset:8192
    ds_read_b64_tr_b16 v[230:231], v48 offset:8704
    ds_read_b64_tr_b16 v[240:241], v48 offset:32
    ds_read_b64_tr_b16 v[242:243], v48 offset:544
    ds_read_b64_tr_b16 v[244:245], v48 offset:8224
    ds_read_b64_tr_b16 v[246:247], v48 offset:8736
    s_waitcnt lgkmcnt(0)
mega_kernel_rs_wo2:
    s_barrier
    s_add_u32 m0, s48, 32768
    s_mov_b32 s22, 1048576
    buffer_load_dwordx4 v44, s[8:11], s22 offen  lds
    s_add_u32 m0, s48, 36864
    s_mov_b32 s22, 1081344
    buffer_load_dwordx4 v44, s[8:11], s22 offen  lds
    s_add_u32 m0, s48, 40960
    s_mov_b32 s22, 1114112
    buffer_load_dwordx4 v44, s[8:11], s22 offen  lds
    s_add_u32 m0, s48, 45056
    s_mov_b32 s22, 1146880
    buffer_load_dwordx4 v44, s[8:11], s22 offen  lds
    s_waitcnt vmcnt(28)
    s_barrier
    s_cmp_lg_u32 s20, 3
    s_cbranch_scc1 mega_kernel_rs_wo3
    v_xor_b32 v48, 0, v47
    v_add_u32 v48, 49152, v48
    ds_read_b64_tr_b16 v[128:129], v48 offset:0
    ds_read_b64_tr_b16 v[130:131], v48 offset:512
    ds_read_b64_tr_b16 v[132:133], v48 offset:8192
    ds_read_b64_tr_b16 v[134:135], v48 offset:8704
    ds_read_b64_tr_b16 v[144:145], v48 offset:32
    ds_read_b64_tr_b16 v[146:147], v48 offset:544
    ds_read_b64_tr_b16 v[148:149], v48 offset:8224
    ds_read_b64_tr_b16 v[150:151], v48 offset:8736
    s_waitcnt lgkmcnt(0)
    v_xor_b32 v48, 64, v47
    v_add_u32 v48, 49152, v48
    ds_read_b64_tr_b16 v[160:161], v48 offset:0
    ds_read_b64_tr_b16 v[162:163], v48 offset:512
    ds_read_b64_tr_b16 v[164:165], v48 offset:8192
    ds_read_b64_tr_b16 v[166:167], v48 offset:8704
    ds_read_b64_tr_b16 v[176:177], v48 offset:32
    ds_read_b64_tr_b16 v[178:179], v48 offset:544
    ds_read_b64_tr_b16 v[180:181], v48 offset:8224
    ds_read_b64_tr_b16 v[182:183], v48 offset:8736
    s_waitcnt lgkmcnt(0)
    v_xor_b32 v48, 128, v47
    v_add_u32 v48, 49152, v48
    ds_read_b64_tr_b16 v[192:193], v48 offset:0
    ds_read_b64_tr_b16 v[194:195], v48 offset:512
    ds_read_b64_tr_b16 v[196:197], v48 offset:8192
    ds_read_b64_tr_b16 v[198:199], v48 offset:8704
    ds_read_b64_tr_b16 v[208:209], v48 offset:32
    ds_read_b64_tr_b16 v[210:211], v48 offset:544
    ds_read_b64_tr_b16 v[212:213], v48 offset:8224
    ds_read_b64_tr_b16 v[214:215], v48 offset:8736
    s_waitcnt lgkmcnt(0)
    v_xor_b32 v48, 192, v47
    v_add_u32 v48, 49152, v48
    ds_read_b64_tr_b16 v[224:225], v48 offset:0
    ds_read_b64_tr_b16 v[226:227], v48 offset:512
    ds_read_b64_tr_b16 v[228:229], v48 offset:8192
    ds_read_b64_tr_b16 v[230:231], v48 offset:8704
    ds_read_b64_tr_b16 v[240:241], v48 offset:32
    ds_read_b64_tr_b16 v[242:243], v48 offset:544
    ds_read_b64_tr_b16 v[244:245], v48 offset:8224
    ds_read_b64_tr_b16 v[246:247], v48 offset:8736
    s_waitcnt lgkmcnt(0)
mega_kernel_rs_wo3:
    s_barrier
    s_add_u32 m0, s48, 49152
    s_mov_b32 s22, 1572864
    buffer_load_dwordx4 v44, s[8:11], s22 offen  lds
    s_add_u32 m0, s48, 53248
    s_mov_b32 s22, 1605632
    buffer_load_dwordx4 v44, s[8:11], s22 offen  lds
    s_add_u32 m0, s48, 57344
    s_mov_b32 s22, 1638400
    buffer_load_dwordx4 v44, s[8:11], s22 offen  lds
    s_add_u32 m0, s48, 61440
    s_mov_b32 s22, 1671168
    buffer_load_dwordx4 v44, s[8:11], s22 offen  lds
    s_waitcnt vmcnt(28)
    s_barrier
    s_cmp_lg_u32 s20, 0
    s_cbranch_scc1 mega_kernel_rs_wo4
    v_xor_b32 v48, 0, v47
    v_add_u32 v48, 65536, v48
    ds_read_b64_tr_b16 v[136:137], v48 offset:0
    ds_read_b64_tr_b16 v[138:139], v48 offset:512
    ds_read_b64_tr_b16 v[140:141], v48 offset:8192
    ds_read_b64_tr_b16 v[142:143], v48 offset:8704
    ds_read_b64_tr_b16 v[152:153], v48 offset:32
    ds_read_b64_tr_b16 v[154:155], v48 offset:544
    ds_read_b64_tr_b16 v[156:157], v48 offset:8224
    ds_read_b64_tr_b16 v[158:159], v48 offset:8736
    s_waitcnt lgkmcnt(0)
    v_xor_b32 v48, 64, v47
    v_add_u32 v48, 65536, v48
    ds_read_b64_tr_b16 v[168:169], v48 offset:0
    ds_read_b64_tr_b16 v[170:171], v48 offset:512
    ds_read_b64_tr_b16 v[172:173], v48 offset:8192
    ds_read_b64_tr_b16 v[174:175], v48 offset:8704
    ds_read_b64_tr_b16 v[184:185], v48 offset:32
    ds_read_b64_tr_b16 v[186:187], v48 offset:544
    ds_read_b64_tr_b16 v[188:189], v48 offset:8224
    ds_read_b64_tr_b16 v[190:191], v48 offset:8736
    s_waitcnt lgkmcnt(0)
    v_xor_b32 v48, 128, v47
    v_add_u32 v48, 65536, v48
    ds_read_b64_tr_b16 v[200:201], v48 offset:0
    ds_read_b64_tr_b16 v[202:203], v48 offset:512
    ds_read_b64_tr_b16 v[204:205], v48 offset:8192
    ds_read_b64_tr_b16 v[206:207], v48 offset:8704
    ds_read_b64_tr_b16 v[216:217], v48 offset:32
    ds_read_b64_tr_b16 v[218:219], v48 offset:544
    ds_read_b64_tr_b16 v[220:221], v48 offset:8224
    ds_read_b64_tr_b16 v[222:223], v48 offset:8736
    s_waitcnt lgkmcnt(0)
    v_xor_b32 v48, 192, v47
    v_add_u32 v48, 65536, v48
    ds_read_b64_tr_b16 v[232:233], v48 offset:0
    ds_read_b64_tr_b16 v[234:235], v48 offset:512
    ds_read_b64_tr_b16 v[236:237], v48 offset:8192
    ds_read_b64_tr_b16 v[238:239], v48 offset:8704
    ds_read_b64_tr_b16 v[248:249], v48 offset:32
    ds_read_b64_tr_b16 v[250:251], v48 offset:544
    ds_read_b64_tr_b16 v[252:253], v48 offset:8224
    ds_read_b64_tr_b16 v[254:255], v48 offset:8736
    s_waitcnt lgkmcnt(0)
mega_kernel_rs_wo4:
    s_barrier
    s_add_u32 m0, s48, 65536
    s_mov_b32 s22, 2097152
    buffer_load_dwordx4 v44, s[8:11], s22 offen  lds
    s_add_u32 m0, s48, 69632
    s_mov_b32 s22, 2129920
    buffer_load_dwordx4 v44, s[8:11], s22 offen  lds
    s_add_u32 m0, s48, 73728
    s_mov_b32 s22, 2162688
    buffer_load_dwordx4 v44, s[8:11], s22 offen  lds
    s_add_u32 m0, s48, 77824
    s_mov_b32 s22, 2195456
    buffer_load_dwordx4 v44, s[8:11], s22 offen  lds
    s_waitcnt vmcnt(28)
    s_barrier
    s_cmp_lg_u32 s20, 1
    s_cbranch_scc1 mega_kernel_rs_wo5
    v_xor_b32 v48, 0, v47
    v_add_u32 v48, 81920, v48
    ds_read_b64_tr_b16 v[136:137], v48 offset:0
    ds_read_b64_tr_b16 v[138:139], v48 offset:512
    ds_read_b64_tr_b16 v[140:141], v48 offset:8192
    ds_read_b64_tr_b16 v[142:143], v48 offset:8704
    ds_read_b64_tr_b16 v[152:153], v48 offset:32
    ds_read_b64_tr_b16 v[154:155], v48 offset:544
    ds_read_b64_tr_b16 v[156:157], v48 offset:8224
    ds_read_b64_tr_b16 v[158:159], v48 offset:8736
    s_waitcnt lgkmcnt(0)
    v_xor_b32 v48, 64, v47
    v_add_u32 v48, 81920, v48
    ds_read_b64_tr_b16 v[168:169], v48 offset:0
    ds_read_b64_tr_b16 v[170:171], v48 offset:512
    ds_read_b64_tr_b16 v[172:173], v48 offset:8192
    ds_read_b64_tr_b16 v[174:175], v48 offset:8704
    ds_read_b64_tr_b16 v[184:185], v48 offset:32
    ds_read_b64_tr_b16 v[186:187], v48 offset:544
    ds_read_b64_tr_b16 v[188:189], v48 offset:8224
    ds_read_b64_tr_b16 v[190:191], v48 offset:8736
    s_waitcnt lgkmcnt(0)
    v_xor_b32 v48, 128, v47
    v_add_u32 v48, 81920, v48
    ds_read_b64_tr_b16 v[200:201], v48 offset:0
    ds_read_b64_tr_b16 v[202:203], v48 offset:512
    ds_read_b64_tr_b16 v[204:205], v48 offset:8192
    ds_read_b64_tr_b16 v[206:207], v48 offset:8704
    ds_read_b64_tr_b16 v[216:217], v48 offset:32
    ds_read_b64_tr_b16 v[218:219], v48 offset:544
    ds_read_b64_tr_b16 v[220:221], v48 offset:8224
    ds_read_b64_tr_b16 v[222:223], v48 offset:8736
    s_waitcnt lgkmcnt(0)
    v_xor_b32 v48, 192, v47
    v_add_u32 v48, 81920, v48
    ds_read_b64_tr_b16 v[232:233], v48 offset:0
    ds_read_b64_tr_b16 v[234:235], v48 offset:512
    ds_read_b64_tr_b16 v[236:237], v48 offset:8192
    ds_read_b64_tr_b16 v[238:239], v48 offset:8704
    ds_read_b64_tr_b16 v[248:249], v48 offset:32
    ds_read_b64_tr_b16 v[250:251], v48 offset:544
    ds_read_b64_tr_b16 v[252:253], v48 offset:8224
    ds_read_b64_tr_b16 v[254:255], v48 offset:8736
    s_waitcnt lgkmcnt(0)
mega_kernel_rs_wo5:
    s_barrier
    s_add_u32 m0, s48, 81920
    s_mov_b32 s22, 2621440
    buffer_load_dwordx4 v44, s[8:11], s22 offen  lds
    s_add_u32 m0, s48, 86016
    s_mov_b32 s22, 2654208
    buffer_load_dwordx4 v44, s[8:11], s22 offen  lds
    s_add_u32 m0, s48, 90112
    s_mov_b32 s22, 2686976
    buffer_load_dwordx4 v44, s[8:11], s22 offen  lds
    s_add_u32 m0, s48, 94208
    s_mov_b32 s22, 2719744
    buffer_load_dwordx4 v44, s[8:11], s22 offen  lds
    s_waitcnt vmcnt(28)
    s_barrier
    s_cmp_lg_u32 s20, 2
    s_cbranch_scc1 mega_kernel_rs_wo6
    v_xor_b32 v48, 0, v47
    v_add_u32 v48, 98304, v48
    ds_read_b64_tr_b16 v[136:137], v48 offset:0
    ds_read_b64_tr_b16 v[138:139], v48 offset:512
    ds_read_b64_tr_b16 v[140:141], v48 offset:8192
    ds_read_b64_tr_b16 v[142:143], v48 offset:8704
    ds_read_b64_tr_b16 v[152:153], v48 offset:32
    ds_read_b64_tr_b16 v[154:155], v48 offset:544
    ds_read_b64_tr_b16 v[156:157], v48 offset:8224
    ds_read_b64_tr_b16 v[158:159], v48 offset:8736
    s_waitcnt lgkmcnt(0)
    v_xor_b32 v48, 64, v47
    v_add_u32 v48, 98304, v48
    ds_read_b64_tr_b16 v[168:169], v48 offset:0
    ds_read_b64_tr_b16 v[170:171], v48 offset:512
    ds_read_b64_tr_b16 v[172:173], v48 offset:8192
    ds_read_b64_tr_b16 v[174:175], v48 offset:8704
    ds_read_b64_tr_b16 v[184:185], v48 offset:32
    ds_read_b64_tr_b16 v[186:187], v48 offset:544
    ds_read_b64_tr_b16 v[188:189], v48 offset:8224
    ds_read_b64_tr_b16 v[190:191], v48 offset:8736
    s_waitcnt lgkmcnt(0)
    v_xor_b32 v48, 128, v47
    v_add_u32 v48, 98304, v48
    ds_read_b64_tr_b16 v[200:201], v48 offset:0
    ds_read_b64_tr_b16 v[202:203], v48 offset:512
    ds_read_b64_tr_b16 v[204:205], v48 offset:8192
    ds_read_b64_tr_b16 v[206:207], v48 offset:8704
    ds_read_b64_tr_b16 v[216:217], v48 offset:32
    ds_read_b64_tr_b16 v[218:219], v48 offset:544
    ds_read_b64_tr_b16 v[220:221], v48 offset:8224
    ds_read_b64_tr_b16 v[222:223], v48 offset:8736
    s_waitcnt lgkmcnt(0)
    v_xor_b32 v48, 192, v47
    v_add_u32 v48, 98304, v48
    ds_read_b64_tr_b16 v[232:233], v48 offset:0
    ds_read_b64_tr_b16 v[234:235], v48 offset:512
    ds_read_b64_tr_b16 v[236:237], v48 offset:8192
    ds_read_b64_tr_b16 v[238:239], v48 offset:8704
    ds_read_b64_tr_b16 v[248:249], v48 offset:32
    ds_read_b64_tr_b16 v[250:251], v48 offset:544
    ds_read_b64_tr_b16 v[252:253], v48 offset:8224
    ds_read_b64_tr_b16 v[254:255], v48 offset:8736
    s_waitcnt lgkmcnt(0)
mega_kernel_rs_wo6:
    s_barrier
    s_add_u32 m0, s48, 98304
    s_mov_b32 s22, 3145728
    buffer_load_dwordx4 v44, s[8:11], s22 offen  lds
    s_add_u32 m0, s48, 102400
    s_mov_b32 s22, 3178496
    buffer_load_dwordx4 v44, s[8:11], s22 offen  lds
    s_add_u32 m0, s48, 106496
    s_mov_b32 s22, 3211264
    buffer_load_dwordx4 v44, s[8:11], s22 offen  lds
    s_add_u32 m0, s48, 110592
    s_mov_b32 s22, 3244032
    buffer_load_dwordx4 v44, s[8:11], s22 offen  lds
    s_waitcnt vmcnt(28)
    s_barrier
    s_cmp_lg_u32 s20, 3
    s_cbranch_scc1 mega_kernel_rs_wo7
    v_xor_b32 v48, 0, v47
    v_add_u32 v48, 114688, v48
    ds_read_b64_tr_b16 v[136:137], v48 offset:0
    ds_read_b64_tr_b16 v[138:139], v48 offset:512
    ds_read_b64_tr_b16 v[140:141], v48 offset:8192
    ds_read_b64_tr_b16 v[142:143], v48 offset:8704
    ds_read_b64_tr_b16 v[152:153], v48 offset:32
    ds_read_b64_tr_b16 v[154:155], v48 offset:544
    ds_read_b64_tr_b16 v[156:157], v48 offset:8224
    ds_read_b64_tr_b16 v[158:159], v48 offset:8736
    s_waitcnt lgkmcnt(0)
    v_xor_b32 v48, 64, v47
    v_add_u32 v48, 114688, v48
    ds_read_b64_tr_b16 v[168:169], v48 offset:0
    ds_read_b64_tr_b16 v[170:171], v48 offset:512
    ds_read_b64_tr_b16 v[172:173], v48 offset:8192
    ds_read_b64_tr_b16 v[174:175], v48 offset:8704
    ds_read_b64_tr_b16 v[184:185], v48 offset:32
    ds_read_b64_tr_b16 v[186:187], v48 offset:544
    ds_read_b64_tr_b16 v[188:189], v48 offset:8224
    ds_read_b64_tr_b16 v[190:191], v48 offset:8736
    s_waitcnt lgkmcnt(0)
    v_xor_b32 v48, 128, v47
    v_add_u32 v48, 114688, v48
    ds_read_b64_tr_b16 v[200:201], v48 offset:0
    ds_read_b64_tr_b16 v[202:203], v48 offset:512
    ds_read_b64_tr_b16 v[204:205], v48 offset:8192
    ds_read_b64_tr_b16 v[206:207], v48 offset:8704
    ds_read_b64_tr_b16 v[216:217], v48 offset:32
    ds_read_b64_tr_b16 v[218:219], v48 offset:544
    ds_read_b64_tr_b16 v[220:221], v48 offset:8224
    ds_read_b64_tr_b16 v[222:223], v48 offset:8736
    s_waitcnt lgkmcnt(0)
    v_xor_b32 v48, 192, v47
    v_add_u32 v48, 114688, v48
    ds_read_b64_tr_b16 v[232:233], v48 offset:0
    ds_read_b64_tr_b16 v[234:235], v48 offset:512
    ds_read_b64_tr_b16 v[236:237], v48 offset:8192
    ds_read_b64_tr_b16 v[238:239], v48 offset:8704
    ds_read_b64_tr_b16 v[248:249], v48 offset:32
    ds_read_b64_tr_b16 v[250:251], v48 offset:544
    ds_read_b64_tr_b16 v[252:253], v48 offset:8224
    ds_read_b64_tr_b16 v[254:255], v48 offset:8736
    s_waitcnt lgkmcnt(0)
mega_kernel_rs_wo7:
    s_barrier
    s_add_u32 m0, s48, 114688
    s_mov_b32 s22, 3670016
    buffer_load_dwordx4 v44, s[8:11], s22 offen  lds
    s_add_u32 m0, s48, 118784
    s_mov_b32 s22, 3702784
    buffer_load_dwordx4 v44, s[8:11], s22 offen  lds
    s_add_u32 m0, s48, 122880
    s_mov_b32 s22, 3735552
    buffer_load_dwordx4 v44, s[8:11], s22 offen  lds
    s_add_u32 m0, s48, 126976
    s_mov_b32 s22, 3768320
    buffer_load_dwordx4 v44, s[8:11], s22 offen  lds
    s_waitcnt vmcnt(28)
    s_barrier
    v_add_u32 v48, 0, v46
    ds_read_b64_tr_b16 v[64:65], v48 offset:0
    ds_read_b64_tr_b16 v[66:67], v48 offset:512
    ds_read_b64_tr_b16 v[68:69], v48 offset:8192
    ds_read_b64_tr_b16 v[70:71], v48 offset:8704
    ds_read_b64_tr_b16 v[72:73], v48 offset:8
    ds_read_b64_tr_b16 v[74:75], v48 offset:520
    ds_read_b64_tr_b16 v[76:77], v48 offset:8200
    ds_read_b64_tr_b16 v[78:79], v48 offset:8712
    s_waitcnt lgkmcnt(0)
    s_barrier
    ds_write_b128 v32, v[64:67] offset:0
    ds_write_b128 v32, v[68:71] offset:1024
    ds_write_b128 v32, v[72:75] offset:2048
    ds_write_b128 v32, v[76:79] offset:3072
    s_waitcnt lgkmcnt(0)
    s_waitcnt vmcnt(24)
    s_barrier
    v_add_u32 v48, 16384, v46
    ds_read_b64_tr_b16 v[64:65], v48 offset:0
    ds_read_b64_tr_b16 v[66:67], v48 offset:512
    ds_read_b64_tr_b16 v[68:69], v48 offset:8192
    ds_read_b64_tr_b16 v[70:71], v48 offset:8704
    ds_read_b64_tr_b16 v[72:73], v48 offset:8
    ds_read_b64_tr_b16 v[74:75], v48 offset:520
    ds_read_b64_tr_b16 v[76:77], v48 offset:8200
    ds_read_b64_tr_b16 v[78:79], v48 offset:8712
    s_waitcnt lgkmcnt(0)
    s_barrier
    ds_write_b128 v32, v[64:67] offset:16384
    ds_write_b128 v32, v[68:71] offset:17408
    ds_write_b128 v32, v[72:75] offset:18432
    ds_write_b128 v32, v[76:79] offset:19456
    s_waitcnt lgkmcnt(0)
    s_waitcnt vmcnt(20)
    s_barrier
    s_getpc_b64 s[16:17]
mega_kernel_rs_pc0:
    s_add_u32 s16, s16, mega_kernel_rs_w0_entry - mega_kernel_rs_pc0
    s_addc_u32 s17, s17, 0
    v_lshlrev_b32 v49, 7, v0
    v_min_u32 v49, mega_kernel_rs_end - mega_kernel_rs_w0_entry, v49
    global_load_dword v50, v49, s[16:17]
    v_lshlrev_b32 v49, 7, v40
    s_xor_b32 s23, s35, 16384
    s_cmp_eq_u32 s20, 1
    s_cselect_b32 s22, s35, s47
    s_cmp_eq_u32 s20, 2
    s_cselect_b32 s22, s23, s22
    s_lshl_b32 s23, s31, 13
    s_add_u32 s23, s23, 178257920
    s_cmp_eq_u32 s20, 3
    s_cselect_b32 s22, s23, s22
    buffer_load_dword v51, v49, s[4:7], s22 offen sc1
    v_lshlrev_b32 v49, 13, v0
    v_and_b32 v49, 0x1fffff, v49
    s_mov_b32 s22, 67108864
    buffer_load_dword v52, v49, s[4:7], s22 offen sc1
    buffer_load_dword v57, v7, s[4:7], 0 offen sc1
    v_add_u32 v48, 32768, v46
    ds_read_b64_tr_b16 v[64:65], v48 offset:0
    ds_read_b64_tr_b16 v[66:67], v48 offset:512
    ds_read_b64_tr_b16 v[68:69], v48 offset:8192
    ds_read_b64_tr_b16 v[70:71], v48 offset:8704
    ds_read_b64_tr_b16 v[72:73], v48 offset:8
    ds_read_b64_tr_b16 v[74:75], v48 offset:520
    ds_read_b64_tr_b16 v[76:77], v48 offset:8200
    ds_read_b64_tr_b16 v[78:79], v48 offset:8712
    s_waitcnt lgkmcnt(0)
    s_barrier
    ds_write_b128 v32, v[64:67] offset:32768
    ds_write_b128 v32, v[68:71] offset:33792
    ds_write_b128 v32, v[72:75] offset:34816
    ds_write_b128 v32, v[76:79] offset:35840
    s_waitcnt lgkmcnt(0)
    s_waitcnt vmcnt(16)
    s_barrier
    v_add_u32 v48, 49152, v46
    ds_read_b64_tr_b16 v[64:65], v48 offset:0
    ds_read_b64_tr_b16 v[66:67], v48 offset:512
    ds_read_b64_tr_b16 v[68:69], v48 offset:8192
    ds_read_b64_tr_b16 v[70:71], v48 offset:8704
    ds_read_b64_tr_b16 v[72:73], v48 offset:8
    ds_read_b64_tr_b16 v[74:75], v48 offset:520
    ds_read_b64_tr_b16 v[76:77], v48 offset:8200
    ds_read_b64_tr_b16 v[78:79], v48 offset:8712
    s_waitcnt lgkmcnt(0)
    s_barrier
    ds_write_b128 v32, v[64:67] offset:49152
    ds_write_b128 v32, v[68:71] offset:50176
    ds_write_b128 v32, v[72:75] offset:51200
    ds_write_b128 v32, v[76:79] offset:52224
    s_waitcnt lgkmcnt(0)
    s_waitcnt vmcnt(12)
    s_barrier
    v_add_u32 v48, 65536, v46
    ds_read_b64_tr_b16 v[64:65], v48 offset:0
    ds_read_b64_tr_b16 v[66:67], v48 offset:512
    ds_read_b64_tr_b16 v[68:69], v48 offset:8192
    ds_read_b64_tr_b16 v[70:71], v48 offset:8704
    ds_read_b64_tr_b16 v[72:73], v48 offset:8
    ds_read_b64_tr_b16 v[74:75], v48 offset:520
    ds_read_b64_tr_b16 v[76:77], v48 offset:8200
    ds_read_b64_tr_b16 v[78:79], v48 offset:8712
    s_waitcnt lgkmcnt(0)
    s_barrier
    ds_write_b128 v33, v[64:67] offset:0
    ds_write_b128 v33, v[68:71] offset:1024
    ds_write_b128 v33, v[72:75] offset:2048
    ds_write_b128 v33, v[76:79] offset:3072
    s_waitcnt lgkmcnt(0)
    s_waitcnt vmcnt(8)
    s_barrier
    v_add_u32 v48, 81920, v46
    ds_read_b64_tr_b16 v[64:65], v48 offset:0
    ds_read_b64_tr_b16 v[66:67], v48 offset:512
    ds_read_b64_tr_b16 v[68:69], v48 offset:8192
    ds_read_b64_tr_b16 v[70:71], v48 offset:8704
    ds_read_b64_tr_b16 v[72:73], v48 offset:8
    ds_read_b64_tr_b16 v[74:75], v48 offset:520
    ds_read_b64_tr_b16 v[76:77], v48 offset:8200
    ds_read_b64_tr_b16 v[78:79], v48 offset:8712
    s_waitcnt lgkmcnt(0)
    s_barrier
    ds_write_b128 v33, v[64:67] offset:16384
    ds_write_b128 v33, v[68:71] offset:17408
    ds_write_b128 v33, v[72:75] offset:18432
    ds_write_b128 v33, v[76:79] offset:19456
    s_waitcnt lgkmcnt(0)
    s_waitcnt vmcnt(4)
    s_barrier
    v_add_u32 v48, 98304, v46
    ds_read_b64_tr_b16 v[64:65], v48 offset:0
    ds_read_b64_tr_b16 v[66:67], v48 offset:512
    ds_read_b64_tr_b16 v[68:69], v48 offset:8192
    ds_read_b64_tr_b16 v[70:71], v48 offset:8704
    ds_read_b64_tr_b16 v[72:73], v48 offset:8
    ds_read_b64_tr_b16 v[74:75], v48 offset:520
    ds_read_b64_tr_b16 v[76:77], v48 offset:8200
    ds_read_b64_tr_b16 v[78:79], v48 offset:8712
    s_waitcnt lgkmcnt(0)
    s_barrier
    ds_write_b128 v33, v[64:67] offset:32768
    ds_write_b128 v33, v[68:71] offset:33792
    ds_write_b128 v33, v[72:75] offset:34816
    ds_write_b128 v33, v[76:79] offset:35840
    s_waitcnt lgkmcnt(0)
    s_waitcnt vmcnt(0)
    s_barrier
    v_add_u32 v48, 114688, v46
    ds_read_b64_tr_b16 v[64:65], v48 offset:0
    ds_read_b64_tr_b16 v[66:67], v48 offset:512
    ds_read_b64_tr_b16 v[68:69], v48 offset:8192
    ds_read_b64_tr_b16 v[70:71], v48 offset:8704
    ds_read_b64_tr_b16 v[72:73], v48 offset:8
    ds_read_b64_tr_b16 v[74:75], v48 offset:520
    ds_read_b64_tr_b16 v[76:77], v48 offset:8200
    ds_read_b64_tr_b16 v[78:79], v48 offset:8712
    s_waitcnt lgkmcnt(0)
    s_barrier
    ds_write_b128 v33, v[64:67] offset:49152
    ds_write_b128 v33, v[68:71] offset:50176
    ds_write_b128 v33, v[72:75] offset:51200
    ds_write_b128 v33, v[76:79] offset:52224
    s_waitcnt lgkmcnt(0)
mega_kernel_rs_iw:
    buffer_load_dword v58, off, s[12:15], 0 offset:204 sc1
    s_waitcnt vmcnt(0)
mega_kernel_rs_iw1:
    v_and_b32 v50, 0xffff, v58
    v_readfirstlane_b32 s60, v58
    v_cmp_ne_u32 vcc, s100, v50
    s_cbranch_vccnz mega_kernel_rs_iw
    s_lshr_b32 s60, s60, 15
    s_cmp_gt_u32 s60, s100
    s_cselect_b32 s60, 8192, 0
    s_bfe_u32 s22, s31, 0x10001
    s_lshl_b32 s22, s22, 12
    s_add_u32 s22, s22, s60
    s_lshl_b32 s23, s20, 10
    s_add_u32 s22, s22, s23
    s_add_u32 s38, s38, s22
    s_add_u32 s37, s37, s22
    s_xor_b32 s40, s38, 4096
    s_xor_b32 s39, s37, 4096
    s_xor_b32 s36, s35, 16384
    s_mov_b32 s21, 0
    s_cmp_eq_u32 s30, 0
    s_mov_b32 s22, 0x33003300
    s_cselect_b32 s16, 0x00330033, s22
    s_mov_b32 s17, s16
    s_cselect_b32 s18, -1, 0
    s_not_b32 s19, s18
    s_lshl_b32 s22, s31, 13
    s_lshl_b32 s23, s20, 11
    s_add_u32 s22, s22, s23
    s_add_u32 s43, s22, 16777216
    s_add_u32 s44, s22, 33554432
    s_lshl_b32 s45, s31, 13
    s_add_u32 s45, s45, 178257920
    s_mul_i32 s48, s20, 5120
    s_add_u32 m0, s48, 140288
    s_mov_b32 s41, 1
    s_mov_b32 s42, 1
    v_mov_b32 v0, v34
    v_bfrev_b32 v12, 1
    v_bfrev_b32 v3, 1
    v_cndmask_b32 v10, v3, v10, s[16:17]
    v_cndmask_b32 v9, v3, v9, s[26:27]
    s_sub_u32 s45, s45, 0
    s_lshl_b32 s51, s30, 11
    s_add_u32 s51, s51, s45
    s_mov_b32 s50, 0
    s_cmp_lg_u32 s20, 3
    s_cbranch_scc1 mega_kernel_rs_kv0
    v_readlane_b32 s50, v57, 0
    v_readlane_b32 s22, v57, 2
    v_readlane_b32 s23, v57, 1
    v_readlane_b32 s24, v57, 3
    s_nop 3
    s_min_u32 s50, s50, s22
    s_min_u32 s23, s23, s24
    s_lshl_b32 s50, s50, 1
    s_lshl_b32 s23, s23, 1
    s_add_u32 s23, s23, 1
    s_min_u32 s50, s50, s23
mega_kernel_rs_kvb0:
    s_add_u32 s22, s21, 1
    s_min_u32 s22, s22, 63
    s_cmp_gt_u32 s50, s22
    s_cbranch_scc1 mega_kernel_rs_kvd0
    buffer_load_dword v48, v7, s[4:7], 0 offen sc1
    s_waitcnt vmcnt(0)
    v_readlane_b32 s50, v48, 0
    v_readlane_b32 s22, v48, 2
    v_readlane_b32 s23, v48, 1
    v_readlane_b32 s24, v48, 3
    s_nop 3
    s_min_u32 s50, s50, s22
    s_min_u32 s23, s23, s24
    s_lshl_b32 s50, s50, 1
    s_lshl_b32 s23, s23, 1
    s_add_u32 s23, s23, 1
    s_min_u32 s50, s50, s23
    s_branch mega_kernel_rs_kvb0
mega_kernel_rs_kvd0:
mega_kernel_rs_kv0:
    s_barrier
    s_cmp_eq_u32 s20, 1
    s_cbranch_scc1 mega_kernel_rs_w1_entry
    s_cmp_eq_u32 s20, 2
    s_cbranch_scc1 mega_kernel_rs_w2_entry
    s_cmp_eq_u32 s20, 3
    s_cbranch_scc1 mega_kernel_rs_w3_entry
mega_kernel_rs_w0_entry:
    v_mfma_f32_32x32x8_bf16 v[96:111], v[14:15], v[14:15], 0
    v_mfma_f32_16x16x16_bf16 v[112:115], v[14:15], v[14:15], 0
    v_mfma_f32_16x16x16_bf16 v[116:119], v[14:15], v[14:15], 0
    ds_read_b128 v[64:67], v1 offset:0
    ds_read_b128 v[68:71], v1 offset:1024
    ds_read_b128 v[72:75], v1 offset:2048
    ds_read_b128 v[76:79], v1 offset:3072
    ds_read_b128 v[80:83], v1 offset:16384
    ds_read_b128 v[84:87], v1 offset:17408
    ds_read_b128 v[88:91], v1 offset:18432
    ds_read_b128 v[92:95], v1 offset:19456
    buffer_load_dwordx4 v[120:123], v1, s[4:7], s44 offen
    buffer_load_dwordx4 v[124:127], v1, s[4:7], s44 offen offset:1024
    s_add_u32 s44, s44, 262144
mega_kernel_rs_w0_loop:
    s_add_u32 s22, s35, 0
    s_waitcnt vmcnt(0)
    buffer_load_dwordx4 v[32:35], v1, s[4:7], s22 offen sc1
    buffer_load_dwordx4 v[36:39], v1, s[4:7], s22 offen offset:1024 sc1
mega_kernel_rs_w0_pa:
    s_waitcnt vmcnt(1)
    ds_write_b128 v6, v[32:35] offset:0
    s_waitcnt vmcnt(0)
    ds_write_b128 v6, v[36:39] offset:1024
    v_max3_u32 v3, v32, v34, v36
    v_max_u32 v3, v3, v38
    v_cmp_eq_u32 vcc, -1, v3
    v_smfmac_f32_16x16x64_bf16 v[96:99], v[32:35], a[0:7], v2
    buffer_load_dwordx4 v[32:35], v1, s[4:7], s22 offen sc1
    v_smfmac_f32_16x16x64_bf16 v[100:103], v[32:35], a[8:15], v2
    buffer_load_dwordx4 v[36:39], v1, s[4:7], s22 offen offset:1024 sc1
    v_smfmac_f32_16x16x64_bf16 v[104:107], v[32:35], a[128:135], v2
    s_cbranch_vccnz mega_kernel_rs_w0_pafail
    s_waitcnt lgkmcnt(0)
    s_barrier
    ds_read_b128 v[40:43], v6 offset:2048
    ds_read_b128 v[44:47], v6 offset:3072
    v_smfmac_f32_16x16x64_bf16 v[108:111], v[32:35], a[136:143], v2
    ds_read_b128 v[48:51], v6 offset:4096
    v_smfmac_f32_16x16x64_bf16 v[96:99], v[36:39], a[16:23], v2
    ds_read_b128 v[52:55], v6 offset:5120
    v_smfmac_f32_16x16x64_bf16 v[100:103], v[36:39], a[24:31], v2
    ds_read_b128 v[56:59], v6 offset:6144
    v_smfmac_f32_16x16x64_bf16 v[104:107], v[36:39], a[144:151], v2
    ds_read_b128 v[60:63], v6 offset:7168
    v_smfmac_f32_16x16x64_bf16 v[108:111], v[36:39], a[152:159], v2
    buffer_load_dwordx4 v1, s[4:7], s43 offen lds
    s_waitcnt lgkmcnt(5)
    v_smfmac_f32_16x16x64_bf16 v[96:99], v[40:43], a[32:39], v2
    v_smfmac_f32_16x16x64_bf16 v[104:107], v[40:43], a[160:167], v2
    s_waitcnt lgkmcnt(4)
    v_smfmac_f32_16x16x64_bf16 v[96:99], v[44:47], a[48:55], v2
    v_smfmac_f32_16x16x64_bf16 v[104:107], v[44:47], a[176:183], v2
    buffer_load_dwordx4 v1, s[4:7], s43 offen offset:1024 lds
    s_waitcnt lgkmcnt(3)
    v_smfmac_f32_16x16x64_bf16 v[96:99], v[48:51], a[64:71], v2
    v_smfmac_f32_16x16x64_bf16 v[104:107], v[48:51], a[192:199], v2
    s_waitcnt lgkmcnt(2)
    v_smfmac_f32_16x16x64_bf16 v[96:99], v[52:55], a[80:87], v2
    v_smfmac_f32_16x16x64_bf16 v[104:107], v[52:55], a[208:215], v2
    v_mov_b32 v4, s21
    buffer_store_dword v4, v7, s[4:7], 0 offen sc1
    s_waitcnt lgkmcnt(1)
    v_smfmac_f32_16x16x64_bf16 v[96:99], v[56:59], a[96:103], v2
    v_smfmac_f32_16x16x64_bf16 v[104:107], v[56:59], a[224:231], v2
    s_waitcnt lgkmcnt(0)
    v_smfmac_f32_16x16x64_bf16 v[96:99], v[60:63], a[112:119], v2
    v_smfmac_f32_16x16x64_bf16 v[104:107], v[60:63], a[240:247], v2
    v_smfmac_f32_16x16x64_bf16 v[100:103], v[40:43], a[40:47], v2
    s_nop 2
    v_smfmac_f32_16x16x64_bf16 v[100:103], v[44:47], a[56:63], v2
    s_nop 1
    v_add_f32 v96, v96, v98
    v_smfmac_f32_16x16x64_bf16 v[100:103], v[48:51], a[72:79], v2
    v_add_f32 v97, v97, v99
    v_add_f32 v104, v104, v106
    v_smfmac_f32_16x16x64_bf16 v[100:103], v[52:55], a[88:95], v2
    v_add_f32 v105, v105, v107
    v_cvt_pk_bf16_f32 v96, v96, v97
    v_smfmac_f32_16x16x64_bf16 v[100:103], v[56:59], a[104:111], v2
    v_cvt_pk_bf16_f32 v97, v104, v105
    v_and_or_b32 v96, v96, -2, s41
    v_smfmac_f32_16x16x64_bf16 v[100:103], v[60:63], a[120:127], v2
    buffer_store_dwordx2 v[96:97], v11, s[4:7], s37 offen sc1
    v_smfmac_f32_16x16x64_bf16 v[108:111], v[40:43], a[168:175], v2
    v_smfmac_f32_16x16x64_bf16 v[108:111], v[44:47], a[184:191], v2
    v_smfmac_f32_16x16x64_bf16 v[108:111], v[48:51], a[200:207], v2
    v_smfmac_f32_16x16x64_bf16 v[108:111], v[52:55], a[216:223], v2
    v_smfmac_f32_16x16x64_bf16 v[108:111], v[56:59], a[232:239], v2
    s_nop 2
    v_add_f32 v100, v100, v102
    v_smfmac_f32_16x16x64_bf16 v[108:111], v[60:63], a[248:255], v2
    v_add_f32 v101, v101, v103
    v_cvt_pk_bf16_f32 v98, v100, v101
    v_and_or_b32 v98, v98, -2, s41
    s_nop 4
    v_pk_add_f32 v[108:109], v[108:109], v[110:111]
    v_cvt_pk_bf16_f32 v99, v108, v109
    buffer_store_dwordx2 v[98:99], v11, s[4:7], s37 offen offset:512 sc1
    v_smfmac_f32_16x16x64_bf16 v[112:115], v[32:35], v[64:71], v2
    ds_read_b128 v[64:67], v1 offset:32768
    ds_read_b128 v[68:71], v1 offset:33792
    v_smfmac_f32_16x16x64_bf16 v[116:119], v[32:35], v[72:79], v2
    ds_read_b128 v[72:75], v1 offset:34816
    ds_read_b128 v[76:79], v1 offset:35840
    v_smfmac_f32_16x16x64_bf16 v[112:115], v[36:39], v[80:87], v2
    ds_read_b128 v[80:83], v1 offset:49152
    ds_read_b128 v[84:87], v1 offset:50176
    v_smfmac_f32_16x16x64_bf16 v[116:119], v[36:39], v[88:95], v2
    ds_read_b128 v[88:91], v1 offset:51200
    ds_read_b128 v[92:95], v1 offset:52224
    s_waitcnt lgkmcnt(6)
    v_smfmac_f32_16x16x64_bf16 v[112:115], v[40:43], v[64:71], v2
    ds_read_b128 v[64:67], v5 offset:0
    ds_read_b128 v[68:71], v5 offset:1024
    s_waitcnt lgkmcnt(6)
    v_smfmac_f32_16x16x64_bf16 v[116:119], v[40:43], v[72:79], v2
    ds_read_b128 v[72:75], v5 offset:2048
    ds_read_b128 v[76:79], v5 offset:3072
    s_waitcnt lgkmcnt(6)
    v_smfmac_f32_16x16x64_bf16 v[112:115], v[44:47], v[80:87], v2
    ds_read_b128 v[80:83], v5 offset:16384
    ds_read_b128 v[84:87], v5 offset:17408
    s_waitcnt lgkmcnt(6)
    v_smfmac_f32_16x16x64_bf16 v[116:119], v[44:47], v[88:95], v2
    ds_read_b128 v[88:91], v5 offset:18432
    ds_read_b128 v[92:95], v5 offset:19456
    s_waitcnt lgkmcnt(6)
    v_smfmac_f32_16x16x64_bf16 v[112:115], v[48:51], v[64:71], v2
    ds_read_b128 v[64:67], v5 offset:32768
    ds_read_b128 v[68:71], v5 offset:33792
    s_waitcnt lgkmcnt(6)
    v_smfmac_f32_16x16x64_bf16 v[116:119], v[48:51], v[72:79], v2
    ds_read_b128 v[72:75], v5 offset:34816
    ds_read_b128 v[76:79], v5 offset:35840
    s_waitcnt lgkmcnt(6)
    v_smfmac_f32_16x16x64_bf16 v[112:115], v[52:55], v[80:87], v2
    ds_read_b128 v[80:83], v5 offset:49152
    ds_read_b128 v[84:87], v5 offset:50176
    s_waitcnt lgkmcnt(6)
    v_smfmac_f32_16x16x64_bf16 v[116:119], v[52:55], v[88:95], v2
    ds_read_b128 v[88:91], v5 offset:51200
    ds_read_b128 v[92:95], v5 offset:52224
    s_waitcnt lgkmcnt(6)
    v_smfmac_f32_16x16x64_bf16 v[112:115], v[56:59], v[64:71], v2
    s_waitcnt lgkmcnt(4)
    v_smfmac_f32_16x16x64_bf16 v[116:119], v[56:59], v[72:79], v2
    s_waitcnt lgkmcnt(2)
    v_smfmac_f32_16x16x64_bf16 v[112:115], v[60:63], v[80:87], v2
    s_waitcnt lgkmcnt(0)
    v_smfmac_f32_16x16x64_bf16 v[116:119], v[60:63], v[88:95], v2
    buffer_load_dwordx2 v[108:109], v11, s[4:7], s38 offen sc1
    v_mfma_f32_16x16x16_bf16 v[100:103], v[96:97], v[16:17], 0
    v_mfma_f32_16x16x16_bf16 v[104:107], v[98:99], v[16:17], 0
    s_nop 4
    v_add_f32 v112, v112, v114
    v_add_f32 v113, v113, v115
    v_add_f32 v114, v116, v118
    v_add_f32 v115, v117, v119
    v_cvt_pk_bf16_f32 v18, v112, v113
    v_cvt_pk_bf16_f32 v19, v114, v115
    v_and_or_b32 v18, v18, -2, s41
    buffer_load_dwordx2 v[110:111], v11, s[4:7], s38 offen offset:512 sc1
    s_barrier
    buffer_store_dwordx2 v[18:19], v11, s[4:7], s39 offen sc1
    v_mov_b32 v112, v18
    v_mov_b32 v114, v19
    v_mov_b32 v92, v28
    v_mov_b32 v93, 0
    s_waitcnt vmcnt(6)
    s_barrier
    ds_read_b128 v[32:35], v6 offset:9216
    ds_read_b128 v[36:39], v6 offset:10240
    ds_read_b128 v[40:43], v6 offset:14336
    ds_read_b128 v[44:47], v6 offset:15360
    ds_read_b128 v[48:51], v6 offset:19456
    ds_read_b128 v[52:55], v6 offset:20480
    ds_read_b128 v[56:59], v6 offset:24576
    ds_read_b128 v[60:63], v6 offset:25600
    buffer_load_dwordx2 v[20:21], v11, s[4:7], s38 offen sc1
    buffer_load_dwordx2 v[22:23], v11, s[4:7], s38 offen offset:512 sc1
    s_waitcnt vmcnt(4)
    v_mfma_f32_16x16x16_bf16 v[80:83], v[108:109], v[16:17], v[100:103]
    v_and_b32 v3, 1, v108
    v_cmp_ne_u32 vcc, s41, v3
    s_nop 5
    v_cvt_pk_bf16_f32 v64, v80, v81
    v_cvt_pk_bf16_f32 v65, v82, v83
    s_cbranch_vccnz mega_kernel_rs_w0_xslow
    s_waitcnt vmcnt(3)
    v_mfma_f32_16x16x16_bf16 v[84:87], v[110:111], v[16:17], v[104:107]
    v_and_b32 v3, 1, v110
    v_cmp_ne_u32 vcc, s41, v3
    s_nop 5
    v_cvt_pk_bf16_f32 v66, v84, v85
    v_cvt_pk_bf16_f32 v67, v86, v87
    ds_write_b128 v6, v[64:67] offset:8192
    s_cbranch_vccnz mega_kernel_rs_w0_xslow
mega_kernel_rs_w0_xok:
    s_cmp_eq_u32 s21, 63
    s_cbranch_scc1 mega_kernel_rs_w0_last
    buffer_load_dwordx2 v[116:117], v11, s[4:7], s40 offen sc1
    s_waitcnt lgkmcnt(1)
    v_mfma_f32_16x16x32_bf16 v[80:83], v[32:35], v[64:67], 0
    s_waitcnt lgkmcnt(0)
    s_barrier
    ds_read_b128 v[68:71], v6 offset:13312
    ds_read_b128 v[72:75], v6 offset:18432
    ds_read_b128 v[76:79], v6 offset:23552
    v_mfma_f32_16x16x32_bf16 v[84:87], v[36:39], v[64:67], 0
    v_mfma_f32_16x16x32_bf16 v[88:91], v[64:67], v[64:67], 0
    buffer_load_dwordx2 v[20:21], v11, s[4:7], s40 offen sc1
    s_waitcnt lgkmcnt(2)
    v_mfma_f32_16x16x32_bf16 v[80:83], v[40:43], v[68:71], v[80:83]
    buffer_store_dwordx4 v[64:67], v10, s[4:7], s45 offen offset:0 sc1
    s_waitcnt lgkmcnt(1)
    v_mfma_f32_16x16x32_bf16 v[80:83], v[48:51], v[72:75], v[80:83]
    s_waitcnt lgkmcnt(0)
    v_mfma_f32_16x16x32_bf16 v[80:83], v[56:59], v[76:79], v[80:83]
    v_mfma_f32_16x16x32_bf16 v[84:87], v[44:47], v[68:71], v[84:87]
    v_mfma_f32_16x16x32_bf16 v[84:87], v[52:55], v[72:75], v[84:87]
    buffer_store_dwordx2 v[18:19], v11, s[4:7], s51 offen offset:2048 sc1
    v_mfma_f32_16x16x32_bf16 v[84:87], v[60:63], v[76:79], v[84:87]
    v_mfma_f32_16x16x32_bf16 v[88:91], v[68:71], v[68:71], v[88:91]
    v_mfma_f32_16x16x32_bf16 v[88:91], v[72:75], v[72:75], v[88:91]
    v_mfma_f32_16x16x32_bf16 v[88:91], v[76:79], v[76:79], v[88:91]
    v_mfma_f32_32x32x4_2b_bf16 v[32:63], v[14:15], v[14:15], 0
    s_nop 0
    v_max3_f32 v4, v80, v81, v82
    s_nop 1
    v_max3_f32 v4, v4, v83, v84
    v_max3_f32 v4, v4, v85, v86
    v_max_f32 v4, v4, v87
    v_max3_f32 v90, v4, v88, v89
    v_max3_f32 v4, v4, v88, v89
    s_nop 1
    v_permlane16_swap_b32 v4, v90
    v_max_f32 v4, v4, v90
    v_max_f32 v90, v4, v90
    s_nop 1
    v_permlane32_swap_b32 v4, v90
    v_max_f32 v4, v4, v90
    v_mul_f32 v4, s34, v4
    v_pk_fma_f32 v[80:81], v[80:81], s[34:35], v[4:5] op_sel_hi:[1,0,0] neg_lo:[0,0,1] neg_hi:[0,0,1]
    v_pk_fma_f32 v[82:83], v[82:83], s[34:35], v[4:5] op_sel_hi:[1,0,0] neg_lo:[0,0,1] neg_hi:[0,0,1]
    v_pk_fma_f32 v[84:85], v[84:85], s[34:35], v[4:5] op_sel_hi:[1,0,0] neg_lo:[0,0,1] neg_hi:[0,0,1]
    v_pk_fma_f32 v[86:87], v[86:87], s[34:35], v[4:5] op_sel_hi:[1,0,0] neg_lo:[0,0,1] neg_hi:[0,0,1]
    v_pk_fma_f32 v[88:89], v[88:89], s[34:35], v[4:5] op_sel_hi:[1,0,0] neg_lo:[0,0,1] neg_hi:[0,0,1]
    v_exp_f32 v80, v80
    v_exp_f32 v81, v81
    v_exp_f32 v82, v82
    v_cvt_pk_bf16_f32 v68, v80, v81
    v_exp_f32 v83, v83
    v_exp_f32 v84, v84
    v_cvt_pk_bf16_f32 v69, v82, v83
    v_exp_f32 v85, v85
    v_exp_f32 v86, v86
    v_cvt_pk_bf16_f32 v70, v84, v85
    v_exp_f32 v87, v87
    v_exp_f32 v88, v88
    v_cvt_pk_bf16_f32 v71, v86, v87
    v_exp_f32 v89, v89
    s_waitcnt vmcnt(3)
    v_mfma_f32_16x16x32_bf16 v[76:79], v[28:31], v[68:71], 0
    v_and_b32 v3, 1, v116
    v_cvt_pk_bf16_f32 v72, v88, v89
    v_mfma_f32_16x16x32_bf16 v[100:103], v[120:123], v[68:71], 0
    v_cmp_ne_u32 vcc, s41, v3
    v_cvt_pk_bf16_f32 v73, v88, v89
    v_mfma_f32_16x16x32_bf16 v[104:107], v[124:127], v[68:71], 0
    v_mov_b32 v113, v116
    v_mov_b32 v115, v117
    v_mfma_f32_16x16x16_bf16 v[76:79], v[92:93], v[72:73], v[76:79]
    s_cbranch_vccnz mega_kernel_rs_w0_pv0
mega_kernel_rs_w0_pv2:
    v_mfma_f32_16x16x16_bf16 v[100:103], v[112:113], v[72:73], v[100:103]
    v_mfma_f32_16x16x16_bf16 v[104:107], v[114:115], v[72:73], v[104:107]
    buffer_load_dwordx4 v[120:123], v1, s[4:7], s44 offen
    buffer_load_dwordx4 v[124:127], v1, s[4:7], s44 offen offset:1024
    s_nop 2
    v_rcp_f32 v76, v76
    s_mov_b64 exec, s[28:29]
    v_pk_mul_f32 v[100:101], v[100:101], v[76:77] op_sel_hi:[1,0]
    v_pk_mul_f32 v[102:103], v[102:103], v[76:77] op_sel_hi:[1,0]
    v_pk_mul_f32 v[104:105], v[104:105], v[76:77] op_sel_hi:[1,0]
    v_pk_mul_f32 v[106:107], v[106:107], v[76:77] op_sel_hi:[1,0]
    v_cvt_pk_bf16_f32 v84, v100, v101
    v_cvt_pk_bf16_f32 v85, v102, v103
    v_cvt_pk_bf16_f32 v86, v104, v105
    v_cvt_pk_bf16_f32 v87, v106, v107
    ds_write_b128 v6, v[84:87] offset:28640
    s_mov_b64 exec, -1
    s_waitcnt lgkmcnt(0)
    s_barrier
    ds_read_b128 v[68:71], v6 offset:28672
    ds_read_b128 v[72:75], v6 offset:29696
    s_waitcnt lgkmcnt(1)
    v_smfmac_f32_16x16x64_bf16 v[32:35], v[68:71], v[128:135], v2
    s_add_u32 s21, s21, 1
    s_xor_b32 s38, s38, 1048576
    s_xor_b32 s37, s37, 1048576
    s_waitcnt lgkmcnt(0)
    v_smfmac_f32_16x16x64_bf16 v[32:35], v[72:75], v[136:143], v2
    s_xor_b32 s40, s40, 1048576
    s_xor_b32 s39, s39, 1048576
    s_lshr_b32 s41, s21, 1
    v_smfmac_f32_16x16x64_bf16 v[36:39], v[68:71], v[144:151], v2
    s_and_b32 s41, s41, 1
    s_xor_b32 s41, s41, 1
    s_xor_b32 s35, s35, 16384
    v_smfmac_f32_16x16x64_bf16 v[36:39], v[72:75], v[152:159], v2
    v_add_f32 v32, v32, v34
    s_xor_b32 s36, s36, 16384
    s_add_u32 s43, s43, 262144
    s_add_u32 s44, s44, 262144
    v_smfmac_f32_16x16x64_bf16 v[40:43], v[68:71], v[160:167], v2
    v_add_f32 v33, v33, v35
    v_smfmac_f32_16x16x64_bf16 v[40:43], v[72:75], v[168:175], v2
    v_cvt_pk_bf16_f32 v32, v32, v33
    v_smfmac_f32_16x16x64_bf16 v[44:47], v[68:71], v[176:183], v2
    v_and_or_b32 v32, v32, -2, s42
    v_smfmac_f32_16x16x64_bf16 v[44:47], v[72:75], v[184:191], v2
    v_add_f32 v36, v36, v38
    v_smfmac_f32_16x16x64_bf16 v[48:51], v[68:71], v[192:199], v2
    v_add_f32 v37, v37, v39
    v_smfmac_f32_16x16x64_bf16 v[48:51], v[72:75], v[200:207], v2
    v_cvt_pk_bf16_f32 v33, v36, v37
    v_smfmac_f32_16x16x64_bf16 v[52:55], v[68:71], v[208:215], v2
    v_add_f32 v40, v40, v42
    v_smfmac_f32_16x16x64_bf16 v[52:55], v[72:75], v[216:223], v2
    v_add_f32 v41, v41, v43
    v_smfmac_f32_16x16x64_bf16 v[56:59], v[68:71], v[224:231], v2
    v_cvt_pk_bf16_f32 v34, v40, v41
    v_smfmac_f32_16x16x64_bf16 v[56:59], v[72:75], v[232:239], v2
    v_add_f32 v44, v44, v46
    v_smfmac_f32_16x16x64_bf16 v[60:63], v[68:71], v[240:247], v2
    v_add_f32 v45, v45, v47
    v_smfmac_f32_16x16x64_bf16 v[60:63], v[72:75], v[248:255], v2
    v_cvt_pk_bf16_f32 v35, v44, v45
    buffer_store_dwordx4 v[32:35], v8, s[4:7], s46 offen sc1
    v_pk_add_f32 v[48:49], v[48:49], v[50:51]
    v_cvt_pk_bf16_f32 v48, v48, v49
    v_and_or_b32 v48, v48, -2, s42
    v_pk_add_f32 v[52:53], v[52:53], v[54:55]
    v_cvt_pk_bf16_f32 v49, v52, v53
    v_pk_add_f32 v[56:57], v[56:57], v[58:59]
    v_cvt_pk_bf16_f32 v50, v56, v57
    v_pk_add_f32 v[60:61], v[60:61], v[62:63]
    v_cvt_pk_bf16_f32 v51, v60, v61
    buffer_store_dwordx4 v[48:51], v8, s[4:7], s61 offen sc1
    s_add_u32 s45, s45, 262144
    s_add_u32 s51, s51, 262144
    v_mfma_f32_32x32x8_bf16 v[96:111], v[14:15], v[14:15], 0
    v_mfma_f32_16x16x16_bf16 v[112:115], v[14:15], v[14:15], 0
    v_mfma_f32_16x16x16_bf16 v[116:119], v[14:15], v[14:15], 0
    ds_read_b128 v[64:67], v1 offset:0
    ds_read_b128 v[68:71], v1 offset:1024
    ds_read_b128 v[72:75], v1 offset:2048
    ds_read_b128 v[76:79], v1 offset:3072
    ds_read_b128 v[80:83], v1 offset:16384
    ds_read_b128 v[84:87], v1 offset:17408
    ds_read_b128 v[88:91], v1 offset:18432
    ds_read_b128 v[92:95], v1 offset:19456
    v_mov_b32 v58, -1
    v_mov_b32 v59, -1
    s_waitcnt vmcnt(0)
mega_kernel_rs_w0_cgo:
mega_kernel_rs_w0_pc:
    buffer_load_dword v36, v13, s[4:7], s25 offen offset:0 sc1
    buffer_load_dword v37, v13, s[4:7], s25 offen offset:256 sc1
    buffer_load_dword v38, v13, s[4:7], s25 offen offset:512 sc1
    buffer_load_dword v39, v13, s[4:7], s25 offen offset:768 sc1
    buffer_load_dword v40, v13, s[4:7], s25 offen offset:1024 sc1
    buffer_load_dword v41, v13, s[4:7], s25 offen offset:1280 sc1
    buffer_load_dword v42, v13, s[4:7], s25 offen offset:1536 sc1
    buffer_load_dword v43, v13, s[4:7], s25 offen offset:1792 sc1
    s_waitcnt vmcnt(4)
    v_mfma_f32_16x16x32_bf16 v[52:55], v[36:39], v[24:27], 0
    v_bitop3_b32 v3, s42, v36, v37 bitop3:0x7e
    v_bitop3_b32 v4, s42, v38, v39 bitop3:0x7e
    s_waitcnt vmcnt(2)
    v_or_b32 v3, v3, v4
    v_bitop3_b32 v4, s42, v40, v41 bitop3:0x7e
    s_waitcnt vmcnt(0)
    v_mfma_f32_16x16x32_bf16 v[52:55], v[40:43], v[24:27], v[52:55]
    v_bitop3_b32 v56, s42, v42, v43 bitop3:0x7e
    v_or3_b32 v3, v3, v4, v56
    v_and_b32 v3, v0, v3
    v_cmp_ne_u32 vcc, 0, v3
    s_nop 3
    v_cvt_pk_bf16_f32 v56, v52, v53
    v_cvt_pk_bf16_f32 v57, v54, v55
    v_min_u32 v56, -2, v56
    s_cbranch_vccnz mega_kernel_rs_w0_pc
    s_mov_b64 exec, s[26:27]
    buffer_store_dwordx2 v[56:57], v9, s[4:7], s35 offen offset:0 sc1
    buffer_store_dwordx2 v[58:59], v9, s[4:7], s36 offen offset:0 sc1
    s_mov_b64 exec, -1
    s_xor_b32 s42, s42, 1
    s_branch mega_kernel_rs_w0_loop
mega_kernel_rs_w0_last:
    buffer_store_dwordx4 v[64:67], v10, s[4:7], s45 offen offset:0 sc1
    buffer_store_dwordx2 v[18:19], v11, s[4:7], s51 offen offset:2048 sc1
    s_branch mega_kernel_rs_end
mega_kernel_rs_w0_pafail:
    s_nop 7
    v_mov_b32 v96, 0
    v_mov_b32 v97, 0
    v_mov_b32 v98, 0
    v_mov_b32 v99, 0
    v_mov_b32 v100, 0
    v_mov_b32 v101, 0
    v_mov_b32 v102, 0
    v_mov_b32 v103, 0
    v_mov_b32 v104, 0
    v_mov_b32 v105, 0
    v_mov_b32 v106, 0
    v_mov_b32 v107, 0
    s_branch mega_kernel_rs_w0_pa
mega_kernel_rs_w0_xslow:
    buffer_load_dwordx2 v[108:109], v11, s[4:7], s38 offen sc1
    buffer_load_dwordx2 v[110:111], v11, s[4:7], s38 offen offset:512 sc1
    s_waitcnt vmcnt(2)
    v_bitop3_b32 v3, s41, v20, v22 bitop3:0x7e
    v_mfma_f32_16x16x16_bf16 v[80:83], v[20:21], v[16:17], v[100:103]
    v_and_b32 v3, 1, v3
    v_mfma_f32_16x16x16_bf16 v[84:87], v[22:23], v[16:17], v[104:107]
    v_cmp_ne_u32 vcc, 0, v3
    s_cbranch_vccz mega_kernel_rs_w0_xgot
    buffer_load_dwordx2 v[20:21], v11, s[4:7], s38 offen sc1
    buffer_load_dwordx2 v[22:23], v11, s[4:7], s38 offen offset:512 sc1
    s_waitcnt vmcnt(2)
    v_bitop3_b32 v3, s41, v108, v110 bitop3:0x7e
    v_mfma_f32_16x16x16_bf16 v[80:83], v[108:109], v[16:17], v[100:103]
    v_and_b32 v3, 1, v3
    v_mfma_f32_16x16x16_bf16 v[84:87], v[110:111], v[16:17], v[104:107]
    v_cmp_ne_u32 vcc, 0, v3
    s_cbranch_vccz mega_kernel_rs_w0_xgot
    s_branch mega_kernel_rs_w0_xslow
mega_kernel_rs_w0_xgot:
    s_nop 3
    v_cvt_pk_bf16_f32 v64, v80, v81
    v_cvt_pk_bf16_f32 v65, v82, v83
    v_cvt_pk_bf16_f32 v66, v84, v85
    v_cvt_pk_bf16_f32 v67, v86, v87
    ds_write_b128 v6, v[64:67] offset:8192
    s_branch mega_kernel_rs_w0_xok
mega_kernel_rs_w0_pv0:
    s_waitcnt vmcnt(2)
    s_branch mega_kernel_rs_w0_pv1
mega_kernel_rs_w0_pv:
    buffer_load_dwordx2 v[20:21], v11, s[4:7], s40 offen sc1
    s_waitcnt vmcnt(0)
mega_kernel_rs_w0_pv1:
    v_and_b32 v3, 1, v20
    v_cmp_ne_u32 vcc, s41, v3
    v_mov_b32 v113, v20
    v_mov_b32 v115, v21
    s_cbranch_vccnz mega_kernel_rs_w0_pv
    s_branch mega_kernel_rs_w0_pv2
mega_kernel_rs_w1_entry:
    v_mfma_f32_32x32x8_bf16 v[96:111], v[14:15], v[14:15], 0
    v_mfma_f32_16x16x16_bf16 v[112:115], v[14:15], v[14:15], 0
    v_mfma_f32_16x16x16_bf16 v[116:119], v[14:15], v[14:15], 0
    ds_read_b128 v[64:67], v1 offset:4096
    ds_read_b128 v[68:71], v1 offset:5120
    ds_read_b128 v[72:75], v1 offset:6144
    ds_read_b128 v[76:79], v1 offset:7168
    ds_read_b128 v[80:83], v1 offset:20480
    ds_read_b128 v[84:87], v1 offset:21504
    ds_read_b128 v[88:91], v1 offset:22528
    ds_read_b128 v[92:95], v1 offset:23552
    buffer_load_dwordx4 v[120:123], v1, s[4:7], s44 offen
    buffer_load_dwordx4 v[124:127], v1, s[4:7], s44 offen offset:1024
    s_add_u32 s44, s44, 262144
mega_kernel_rs_w1_loop:
    s_add_u32 s22, s35, 2048
    s_waitcnt vmcnt(0)
    buffer_load_dwordx4 v[40:43], v1, s[4:7], s22 offen sc1
    buffer_load_dwordx4 v[44:47], v1, s[4:7], s22 offen offset:1024 sc1
mega_kernel_rs_w1_pa:
    s_waitcnt vmcnt(1)
    ds_write_b128 v6, v[40:43] offset:2048
    s_waitcnt vmcnt(0)
    ds_write_b128 v6, v[44:47] offset:3072
    v_max3_u32 v3, v40, v42, v44
    v_max_u32 v3, v3, v46
    v_cmp_eq_u32 vcc, -1, v3
    v_smfmac_f32_16x16x64_bf16 v[96:99], v[40:43], a[32:39], v2
    buffer_load_dwordx4 v[40:43], v1, s[4:7], s22 offen sc1
    v_smfmac_f32_16x16x64_bf16 v[100:103], v[40:43], a[40:47], v2
    buffer_load_dwordx4 v[44:47], v1, s[4:7], s22 offen offset:1024 sc1
    v_smfmac_f32_16x16x64_bf16 v[104:107], v[40:43], a[160:167], v2
    s_cbranch_vccnz mega_kernel_rs_w1_pafail
    s_waitcnt lgkmcnt(0)
    s_barrier
    ds_read_b128 v[48:51], v6 offset:4096
    ds_read_b128 v[52:55], v6 offset:5120
    v_smfmac_f32_16x16x64_bf16 v[108:111], v[40:43], a[168:175], v2
    ds_read_b128 v[56:59], v6 offset:6144
    v_smfmac_f32_16x16x64_bf16 v[96:99], v[44:47], a[48:55], v2
    ds_read_b128 v[60:63], v6 offset:7168
    v_smfmac_f32_16x16x64_bf16 v[100:103], v[44:47], a[56:63], v2
    ds_read_b128 v[32:35], v6 offset:0
    v_smfmac_f32_16x16x64_bf16 v[104:107], v[44:47], a[176:183], v2
    ds_read_b128 v[36:39], v6 offset:1024
    v_smfmac_f32_16x16x64_bf16 v[108:111], v[44:47], a[184:191], v2
    s_waitcnt lgkmcnt(5)
    v_smfmac_f32_16x16x64_bf16 v[96:99], v[48:51], a[64:71], v2
    buffer_load_dwordx4 v1, s[4:7], s43 offen lds
    v_smfmac_f32_16x16x64_bf16 v[104:107], v[48:51], a[192:199], v2
    s_waitcnt lgkmcnt(4)
    v_smfmac_f32_16x16x64_bf16 v[96:99], v[52:55], a[80:87], v2
    v_smfmac_f32_16x16x64_bf16 v[104:107], v[52:55], a[208:215], v2
    s_waitcnt lgkmcnt(3)
    v_smfmac_f32_16x16x64_bf16 v[96:99], v[56:59], a[96:103], v2
    buffer_load_dwordx4 v1, s[4:7], s43 offen offset:1024 lds
    v_smfmac_f32_16x16x64_bf16 v[104:107], v[56:59], a[224:231], v2
    s_waitcnt lgkmcnt(2)
    v_smfmac_f32_16x16x64_bf16 v[96:99], v[60:63], a[112:119], v2
    v_smfmac_f32_16x16x64_bf16 v[104:107], v[60:63], a[240:247], v2
    s_waitcnt lgkmcnt(1)
    v_smfmac_f32_16x16x64_bf16 v[96:99], v[32:35], a[0:7], v2
    v_smfmac_f32_16x16x64_bf16 v[104:107], v[32:35], a[128:135], v2
    s_waitcnt lgkmcnt(0)
    v_smfmac_f32_16x16x64_bf16 v[96:99], v[36:39], a[16:23], v2
    v_smfmac_f32_16x16x64_bf16 v[104:107], v[36:39], a[144:151], v2
    v_smfmac_f32_16x16x64_bf16 v[100:103], v[48:51], a[72:79], v2
    s_nop 2
    v_smfmac_f32_16x16x64_bf16 v[100:103], v[52:55], a[88:95], v2
    s_nop 1
    v_add_f32 v96, v96, v98
    v_smfmac_f32_16x16x64_bf16 v[100:103], v[56:59], a[104:111], v2
    v_add_f32 v97, v97, v99
    v_add_f32 v104, v104, v106
    v_smfmac_f32_16x16x64_bf16 v[100:103], v[60:63], a[120:127], v2
    v_add_f32 v105, v105, v107
    v_cvt_pk_bf16_f32 v96, v96, v97
    v_smfmac_f32_16x16x64_bf16 v[100:103], v[32:35], a[8:15], v2
    v_cvt_pk_bf16_f32 v97, v104, v105
    v_and_or_b32 v96, v96, -2, s41
    v_smfmac_f32_16x16x64_bf16 v[100:103], v[36:39], a[24:31], v2
    buffer_store_dwordx2 v[96:97], v11, s[4:7], s37 offen sc1
    v_smfmac_f32_16x16x64_bf16 v[108:111], v[48:51], a[200:207], v2
    v_smfmac_f32_16x16x64_bf16 v[108:111], v[52:55], a[216:223], v2
    v_smfmac_f32_16x16x64_bf16 v[108:111], v[56:59], a[232:239], v2
    v_smfmac_f32_16x16x64_bf16 v[108:111], v[60:63], a[248:255], v2
    v_smfmac_f32_16x16x64_bf16 v[108:111], v[32:35], a[136:143], v2
    s_nop 2
    v_add_f32 v100, v100, v102
    v_smfmac_f32_16x16x64_bf16 v[108:111], v[36:39], a[152:159], v2
    v_add_f32 v101, v101, v103
    v_cvt_pk_bf16_f32 v98, v100, v101
    v_and_or_b32 v98, v98, -2, s41
    s_nop 4
    v_pk_add_f32 v[108:109], v[108:109], v[110:111]
    v_cvt_pk_bf16_f32 v99, v108, v109
    buffer_store_dwordx2 v[98:99], v11, s[4:7], s37 offen offset:512 sc1
    v_smfmac_f32_16x16x64_bf16 v[112:115], v[32:35], v[64:71], v2
    ds_read_b128 v[64:67], v1 offset:36864
    ds_read_b128 v[68:71], v1 offset:37888
    v_smfmac_f32_16x16x64_bf16 v[116:119], v[32:35], v[72:79], v2
    ds_read_b128 v[72:75], v1 offset:38912
    ds_read_b128 v[76:79], v1 offset:39936
    v_smfmac_f32_16x16x64_bf16 v[112:115], v[36:39], v[80:87], v2
    ds_read_b128 v[80:83], v1 offset:53248
    ds_read_b128 v[84:87], v1 offset:54272
    v_smfmac_f32_16x16x64_bf16 v[116:119], v[36:39], v[88:95], v2
    ds_read_b128 v[88:91], v1 offset:55296
    ds_read_b128 v[92:95], v1 offset:56320
    s_waitcnt lgkmcnt(6)
    v_smfmac_f32_16x16x64_bf16 v[112:115], v[40:43], v[64:71], v2
    ds_read_b128 v[64:67], v5 offset:4096
    ds_read_b128 v[68:71], v5 offset:5120
    s_waitcnt lgkmcnt(6)
    v_smfmac_f32_16x16x64_bf16 v[116:119], v[40:43], v[72:79], v2
    ds_read_b128 v[72:75], v5 offset:6144
    ds_read_b128 v[76:79], v5 offset:7168
    s_waitcnt lgkmcnt(6)
    v_smfmac_f32_16x16x64_bf16 v[112:115], v[44:47], v[80:87], v2
    ds_read_b128 v[80:83], v5 offset:20480
    ds_read_b128 v[84:87], v5 offset:21504
    s_waitcnt lgkmcnt(6)
    v_smfmac_f32_16x16x64_bf16 v[116:119], v[44:47], v[88:95], v2
    ds_read_b128 v[88:91], v5 offset:22528
    ds_read_b128 v[92:95], v5 offset:23552
    s_waitcnt lgkmcnt(6)
    v_smfmac_f32_16x16x64_bf16 v[112:115], v[48:51], v[64:71], v2
    ds_read_b128 v[64:67], v5 offset:36864
    ds_read_b128 v[68:71], v5 offset:37888
    s_waitcnt lgkmcnt(6)
    v_smfmac_f32_16x16x64_bf16 v[116:119], v[48:51], v[72:79], v2
    ds_read_b128 v[72:75], v5 offset:38912
    ds_read_b128 v[76:79], v5 offset:39936
    s_waitcnt lgkmcnt(6)
    v_smfmac_f32_16x16x64_bf16 v[112:115], v[52:55], v[80:87], v2
    ds_read_b128 v[80:83], v5 offset:53248
    ds_read_b128 v[84:87], v5 offset:54272
    s_waitcnt lgkmcnt(6)
    v_smfmac_f32_16x16x64_bf16 v[116:119], v[52:55], v[88:95], v2
    ds_read_b128 v[88:91], v5 offset:55296
    ds_read_b128 v[92:95], v5 offset:56320
    s_waitcnt lgkmcnt(6)
    v_smfmac_f32_16x16x64_bf16 v[112:115], v[56:59], v[64:71], v2
    s_waitcnt lgkmcnt(4)
    v_smfmac_f32_16x16x64_bf16 v[116:119], v[56:59], v[72:79], v2
    s_waitcnt lgkmcnt(2)
    v_smfmac_f32_16x16x64_bf16 v[112:115], v[60:63], v[80:87], v2
    s_waitcnt lgkmcnt(0)
    v_smfmac_f32_16x16x64_bf16 v[116:119], v[60:63], v[88:95], v2
    buffer_load_dwordx2 v[108:109], v11, s[4:7], s38 offen sc1
    v_mfma_f32_16x16x16_bf16 v[100:103], v[96:97], v[16:17], 0
    v_mfma_f32_16x16x16_bf16 v[104:107], v[98:99], v[16:17], 0
    s_nop 4
    v_add_f32 v112, v112, v114
    v_add_f32 v113, v113, v115
    v_add_f32 v114, v116, v118
    v_add_f32 v115, v117, v119
    v_cvt_pk_bf16_f32 v18, v112, v113
    v_cvt_pk_bf16_f32 v19, v114, v115
    v_and_or_b32 v18, v18, -2, s41
    buffer_load_dwordx2 v[110:111], v11, s[4:7], s38 offen offset:512 sc1
    s_barrier
    buffer_store_dwordx2 v[18:19], v11, s[4:7], s39 offen sc1
    v_mov_b32 v112, v18
    v_mov_b32 v114, v19
    v_mov_b32 v92, v28
    v_mov_b32 v93, 0
    s_waitcnt vmcnt(5)
    s_barrier
    ds_read_b128 v[32:35], v6 offset:14336
    ds_read_b128 v[36:39], v6 offset:15360
    ds_read_b128 v[40:43], v6 offset:9216
    ds_read_b128 v[44:47], v6 offset:10240
    ds_read_b128 v[48:51], v6 offset:24576
    ds_read_b128 v[52:55], v6 offset:25600
    ds_read_b128 v[56:59], v6 offset:19456
    ds_read_b128 v[60:63], v6 offset:20480
    buffer_load_dwordx2 v[20:21], v11, s[4:7], s38 offen sc1
    buffer_load_dwordx2 v[22:23], v11, s[4:7], s38 offen offset:512 sc1
    s_waitcnt vmcnt(4)
    v_mfma_f32_16x16x16_bf16 v[80:83], v[108:109], v[16:17], v[100:103]
    v_and_b32 v3, 1, v108
    v_cmp_ne_u32 vcc, s41, v3
    s_nop 5
    v_cvt_pk_bf16_f32 v64, v80, v81
    v_cvt_pk_bf16_f32 v65, v82, v83
    s_cbranch_vccnz mega_kernel_rs_w1_xslow
    s_waitcnt vmcnt(3)
    v_mfma_f32_16x16x16_bf16 v[84:87], v[110:111], v[16:17], v[104:107]
    v_and_b32 v3, 1, v110
    v_cmp_ne_u32 vcc, s41, v3
    s_nop 5
    v_cvt_pk_bf16_f32 v66, v84, v85
    v_cvt_pk_bf16_f32 v67, v86, v87
    ds_write_b128 v6, v[64:67] offset:13312
    s_cbranch_vccnz mega_kernel_rs_w1_xslow
mega_kernel_rs_w1_xok:
    s_cmp_eq_u32 s21, 63
    s_cbranch_scc1 mega_kernel_rs_w1_last
    buffer_load_dwordx2 v[116:117], v11, s[4:7], s40 offen sc1
    s_waitcnt lgkmcnt(1)
    v_mfma_f32_16x16x32_bf16 v[80:83], v[32:35], v[64:67], 0
    s_waitcnt lgkmcnt(0)
    s_barrier
    ds_read_b128 v[68:71], v6 offset:8192
    ds_read_b128 v[72:75], v6 offset:23552
    ds_read_b128 v[76:79], v6 offset:18432
    v_mfma_f32_16x16x32_bf16 v[84:87], v[36:39], v[64:67], 0
    v_mfma_f32_16x16x32_bf16 v[88:91], v[64:67], v[64:67], 0
    buffer_load_dwordx2 v[20:21], v11, s[4:7], s40 offen sc1
    s_waitcnt lgkmcnt(2)
    v_mfma_f32_16x16x32_bf16 v[80:83], v[40:43], v[68:71], v[80:83]
    s_waitcnt lgkmcnt(1)
    v_mfma_f32_16x16x32_bf16 v[80:83], v[48:51], v[72:75], v[80:83]
    buffer_store_dwordx4 v[64:67], v10, s[4:7], s45 offen offset:64 sc1
    s_waitcnt lgkmcnt(0)
    v_mfma_f32_16x16x32_bf16 v[80:83], v[56:59], v[76:79], v[80:83]
    v_mfma_f32_16x16x32_bf16 v[84:87], v[44:47], v[68:71], v[84:87]
    v_mfma_f32_16x16x32_bf16 v[84:87], v[52:55], v[72:75], v[84:87]
    v_mfma_f32_16x16x32_bf16 v[84:87], v[60:63], v[76:79], v[84:87]
    buffer_store_dwordx2 v[18:19], v11, s[4:7], s51 offen offset:2560 sc1
    v_mfma_f32_16x16x32_bf16 v[88:91], v[68:71], v[68:71], v[88:91]
    v_mfma_f32_16x16x32_bf16 v[88:91], v[72:75], v[72:75], v[88:91]
    v_mfma_f32_16x16x32_bf16 v[88:91], v[76:79], v[76:79], v[88:91]
    v_mfma_f32_32x32x4_2b_bf16 v[32:63], v[14:15], v[14:15], 0
    s_nop 0
    v_max3_f32 v4, v80, v81, v82
    s_nop 1
    v_max3_f32 v4, v4, v83, v84
    v_max3_f32 v4, v4, v85, v86
    v_max_f32 v4, v4, v87
    v_max3_f32 v90, v4, v88, v89
    v_max3_f32 v4, v4, v88, v89
    s_nop 1
    v_permlane16_swap_b32 v4, v90
    v_max_f32 v4, v4, v90
    v_max_f32 v90, v4, v90
    s_nop 1
    v_permlane32_swap_b32 v4, v90
    v_max_f32 v4, v4, v90
    v_mul_f32 v4, s34, v4
    v_pk_fma_f32 v[80:81], v[80:81], s[34:35], v[4:5] op_sel_hi:[1,0,0] neg_lo:[0,0,1] neg_hi:[0,0,1]
    v_pk_fma_f32 v[82:83], v[82:83], s[34:35], v[4:5] op_sel_hi:[1,0,0] neg_lo:[0,0,1] neg_hi:[0,0,1]
    v_pk_fma_f32 v[84:85], v[84:85], s[34:35], v[4:5] op_sel_hi:[1,0,0] neg_lo:[0,0,1] neg_hi:[0,0,1]
    v_pk_fma_f32 v[86:87], v[86:87], s[34:35], v[4:5] op_sel_hi:[1,0,0] neg_lo:[0,0,1] neg_hi:[0,0,1]
    v_pk_fma_f32 v[88:89], v[88:89], s[34:35], v[4:5] op_sel_hi:[1,0,0] neg_lo:[0,0,1] neg_hi:[0,0,1]
    v_exp_f32 v80, v80
    v_exp_f32 v81, v81
    v_exp_f32 v82, v82
    v_cvt_pk_bf16_f32 v68, v80, v81
    v_exp_f32 v83, v83
    v_exp_f32 v84, v84
    v_cvt_pk_bf16_f32 v69, v82, v83
    v_exp_f32 v85, v85
    v_exp_f32 v86, v86
    v_cvt_pk_bf16_f32 v70, v84, v85
    v_exp_f32 v87, v87
    v_exp_f32 v88, v88
    v_cvt_pk_bf16_f32 v71, v86, v87
    v_exp_f32 v89, v89
    s_waitcnt vmcnt(3)
    v_mfma_f32_16x16x32_bf16 v[76:79], v[28:31], v[68:71], 0
    v_and_b32 v3, 1, v116
    v_cvt_pk_bf16_f32 v72, v88, v89
    v_mfma_f32_16x16x32_bf16 v[100:103], v[120:123], v[68:71], 0
    v_cmp_ne_u32 vcc, s41, v3
    v_cvt_pk_bf16_f32 v73, v88, v89
    v_mfma_f32_16x16x32_bf16 v[104:107], v[124:127], v[68:71], 0
    v_mov_b32 v113, v116
    v_mov_b32 v115, v117
    v_mfma_f32_16x16x16_bf16 v[76:79], v[92:93], v[72:73], v[76:79]
    s_cbranch_vccnz mega_kernel_rs_w1_pv0
mega_kernel_rs_w1_pv2:
    v_mfma_f32_16x16x16_bf16 v[100:103], v[112:113], v[72:73], v[100:103]
    v_mfma_f32_16x16x16_bf16 v[104:107], v[114:115], v[72:73], v[104:107]
    buffer_load_dwordx4 v[120:123], v1, s[4:7], s44 offen
    buffer_load_dwordx4 v[124:127], v1, s[4:7], s44 offen offset:1024
    s_nop 2
    v_rcp_f32 v76, v76
    s_mov_b64 exec, s[28:29]
    v_pk_mul_f32 v[100:101], v[100:101], v[76:77] op_sel_hi:[1,0]
    v_pk_mul_f32 v[102:103], v[102:103], v[76:77] op_sel_hi:[1,0]
    v_pk_mul_f32 v[104:105], v[104:105], v[76:77] op_sel_hi:[1,0]
    v_pk_mul_f32 v[106:107], v[106:107], v[76:77] op_sel_hi:[1,0]
    v_cvt_pk_bf16_f32 v84, v100, v101
    v_cvt_pk_bf16_f32 v85, v102, v103
    v_cvt_pk_bf16_f32 v86, v104, v105
    v_cvt_pk_bf16_f32 v87, v106, v107
    ds_write_b128 v6, v[84:87] offset:28672
    s_mov_b64 exec, -1
    s_waitcnt lgkmcnt(0)
    s_barrier
    ds_read_b128 v[68:71], v6 offset:28672
    ds_read_b128 v[72:75], v6 offset:29696
    s_waitcnt lgkmcnt(1)
    v_smfmac_f32_16x16x64_bf16 v[32:35], v[68:71], v[128:135], v2
    s_add_u32 s21, s21, 1
    s_xor_b32 s38, s38, 1048576
    s_xor_b32 s37, s37, 1048576
    s_waitcnt lgkmcnt(0)
    v_smfmac_f32_16x16x64_bf16 v[32:35], v[72:75], v[136:143], v2
    s_xor_b32 s40, s40, 1048576
    s_xor_b32 s39, s39, 1048576
    s_lshr_b32 s41, s21, 1
    v_smfmac_f32_16x16x64_bf16 v[36:39], v[68:71], v[144:151], v2
    s_and_b32 s41, s41, 1
    s_xor_b32 s41, s41, 1
    s_xor_b32 s35, s35, 16384
    v_smfmac_f32_16x16x64_bf16 v[36:39], v[72:75], v[152:159], v2
    v_add_f32 v32, v32, v34
    s_xor_b32 s36, s36, 16384
    s_add_u32 s43, s43, 262144
    s_add_u32 s44, s44, 262144
    v_smfmac_f32_16x16x64_bf16 v[40:43], v[68:71], v[160:167], v2
    v_add_f32 v33, v33, v35
    v_smfmac_f32_16x16x64_bf16 v[40:43], v[72:75], v[168:175], v2
    v_cvt_pk_bf16_f32 v32, v32, v33
    v_smfmac_f32_16x16x64_bf16 v[44:47], v[68:71], v[176:183], v2
    v_and_or_b32 v32, v32, -2, s42
    v_smfmac_f32_16x16x64_bf16 v[44:47], v[72:75], v[184:191], v2
    v_add_f32 v36, v36, v38
    v_smfmac_f32_16x16x64_bf16 v[48:51], v[68:71], v[192:199], v2
    v_add_f32 v37, v37, v39
    v_smfmac_f32_16x16x64_bf16 v[48:51], v[72:75], v[200:207], v2
    v_cvt_pk_bf16_f32 v33, v36, v37
    v_smfmac_f32_16x16x64_bf16 v[52:55], v[68:71], v[208:215], v2
    v_add_f32 v40, v40, v42
    v_smfmac_f32_16x16x64_bf16 v[52:55], v[72:75], v[216:223], v2
    v_add_f32 v41, v41, v43
    v_smfmac_f32_16x16x64_bf16 v[56:59], v[68:71], v[224:231], v2
    v_cvt_pk_bf16_f32 v34, v40, v41
    v_smfmac_f32_16x16x64_bf16 v[56:59], v[72:75], v[232:239], v2
    v_add_f32 v44, v44, v46
    v_smfmac_f32_16x16x64_bf16 v[60:63], v[68:71], v[240:247], v2
    v_add_f32 v45, v45, v47
    v_smfmac_f32_16x16x64_bf16 v[60:63], v[72:75], v[248:255], v2
    v_cvt_pk_bf16_f32 v35, v44, v45
    buffer_store_dwordx4 v[32:35], v8, s[4:7], s46 offen sc1
    v_pk_add_f32 v[48:49], v[48:49], v[50:51]
    v_cvt_pk_bf16_f32 v48, v48, v49
    v_and_or_b32 v48, v48, -2, s42
    v_pk_add_f32 v[52:53], v[52:53], v[54:55]
    v_cvt_pk_bf16_f32 v49, v52, v53
    v_pk_add_f32 v[56:57], v[56:57], v[58:59]
    v_cvt_pk_bf16_f32 v50, v56, v57
    v_pk_add_f32 v[60:61], v[60:61], v[62:63]
    v_cvt_pk_bf16_f32 v51, v60, v61
    buffer_store_dwordx4 v[48:51], v8, s[4:7], s61 offen sc1
    s_add_u32 s45, s45, 262144
    s_add_u32 s51, s51, 262144
    v_mfma_f32_32x32x8_bf16 v[96:111], v[14:15], v[14:15], 0
    v_mfma_f32_16x16x16_bf16 v[112:115], v[14:15], v[14:15], 0
    v_mfma_f32_16x16x16_bf16 v[116:119], v[14:15], v[14:15], 0
    ds_read_b128 v[64:67], v1 offset:4096
    ds_read_b128 v[68:71], v1 offset:5120
    ds_read_b128 v[72:75], v1 offset:6144
    ds_read_b128 v[76:79], v1 offset:7168
    ds_read_b128 v[80:83], v1 offset:20480
    ds_read_b128 v[84:87], v1 offset:21504
    ds_read_b128 v[88:91], v1 offset:22528
    ds_read_b128 v[92:95], v1 offset:23552
    v_mov_b32 v58, -1
    v_mov_b32 v59, -1
    s_waitcnt vmcnt(0)
mega_kernel_rs_w1_cgo:
mega_kernel_rs_w1_pc:
    buffer_load_dword v36, v13, s[4:7], s25 offen offset:0 sc1
    buffer_load_dword v37, v13, s[4:7], s25 offen offset:256 sc1
    buffer_load_dword v38, v13, s[4:7], s25 offen offset:512 sc1
    buffer_load_dword v39, v13, s[4:7], s25 offen offset:768 sc1
    buffer_load_dword v40, v13, s[4:7], s25 offen offset:1024 sc1
    buffer_load_dword v41, v13, s[4:7], s25 offen offset:1280 sc1
    buffer_load_dword v42, v13, s[4:7], s25 offen offset:1536 sc1
    buffer_load_dword v43, v13, s[4:7], s25 offen offset:1792 sc1
    s_waitcnt vmcnt(4)
    v_mfma_f32_16x16x32_bf16 v[52:55], v[36:39], v[24:27], 0
    v_bitop3_b32 v3, s42, v36, v37 bitop3:0x7e
    v_bitop3_b32 v4, s42, v38, v39 bitop3:0x7e
    s_waitcnt vmcnt(2)
    v_or_b32 v3, v3, v4
    v_bitop3_b32 v4, s42, v40, v41 bitop3:0x7e
    s_waitcnt vmcnt(0)
    v_mfma_f32_16x16x32_bf16 v[52:55], v[40:43], v[24:27], v[52:55]
    v_bitop3_b32 v56, s42, v42, v43 bitop3:0x7e
    v_or3_b32 v3, v3, v4, v56
    v_and_b32 v3, v0, v3
    v_cmp_ne_u32 vcc, 0, v3
    s_nop 3
    v_cvt_pk_bf16_f32 v56, v52, v53
    v_cvt_pk_bf16_f32 v57, v54, v55
    v_min_u32 v56, -2, v56
    s_cbranch_vccnz mega_kernel_rs_w1_pc
    s_mov_b64 exec, s[26:27]
    buffer_store_dwordx2 v[56:57], v9, s[4:7], s35 offen offset:256 sc1
    buffer_store_dwordx2 v[58:59], v9, s[4:7], s36 offen offset:256 sc1
    s_mov_b64 exec, -1
    s_xor_b32 s42, s42, 1
    s_branch mega_kernel_rs_w1_loop
mega_kernel_rs_w1_last:
    buffer_store_dwordx4 v[64:67], v10, s[4:7], s45 offen offset:64 sc1
    buffer_store_dwordx2 v[18:19], v11, s[4:7], s51 offen offset:2560 sc1
    s_branch mega_kernel_rs_end
mega_kernel_rs_w1_pafail:
    s_nop 7
    v_mov_b32 v96, 0
    v_mov_b32 v97, 0
    v_mov_b32 v98, 0
    v_mov_b32 v99, 0
    v_mov_b32 v100, 0
    v_mov_b32 v101, 0
    v_mov_b32 v102, 0
    v_mov_b32 v103, 0
    v_mov_b32 v104, 0
    v_mov_b32 v105, 0
    v_mov_b32 v106, 0
    v_mov_b32 v107, 0
    s_branch mega_kernel_rs_w1_pa
mega_kernel_rs_w1_xslow:
    buffer_load_dwordx2 v[108:109], v11, s[4:7], s38 offen sc1
    buffer_load_dwordx2 v[110:111], v11, s[4:7], s38 offen offset:512 sc1
    s_waitcnt vmcnt(2)
    v_bitop3_b32 v3, s41, v20, v22 bitop3:0x7e
    v_mfma_f32_16x16x16_bf16 v[80:83], v[20:21], v[16:17], v[100:103]
    v_and_b32 v3, 1, v3
    v_mfma_f32_16x16x16_bf16 v[84:87], v[22:23], v[16:17], v[104:107]
    v_cmp_ne_u32 vcc, 0, v3
    s_cbranch_vccz mega_kernel_rs_w1_xgot
    buffer_load_dwordx2 v[20:21], v11, s[4:7], s38 offen sc1
    buffer_load_dwordx2 v[22:23], v11, s[4:7], s38 offen offset:512 sc1
    s_waitcnt vmcnt(2)
    v_bitop3_b32 v3, s41, v108, v110 bitop3:0x7e
    v_mfma_f32_16x16x16_bf16 v[80:83], v[108:109], v[16:17], v[100:103]
    v_and_b32 v3, 1, v3
    v_mfma_f32_16x16x16_bf16 v[84:87], v[110:111], v[16:17], v[104:107]
    v_cmp_ne_u32 vcc, 0, v3
    s_cbranch_vccz mega_kernel_rs_w1_xgot
    s_branch mega_kernel_rs_w1_xslow
mega_kernel_rs_w1_xgot:
    s_nop 3
    v_cvt_pk_bf16_f32 v64, v80, v81
    v_cvt_pk_bf16_f32 v65, v82, v83
    v_cvt_pk_bf16_f32 v66, v84, v85
    v_cvt_pk_bf16_f32 v67, v86, v87
    ds_write_b128 v6, v[64:67] offset:13312
    s_branch mega_kernel_rs_w1_xok
mega_kernel_rs_w1_pv0:
    s_waitcnt vmcnt(2)
    s_branch mega_kernel_rs_w1_pv1
mega_kernel_rs_w1_pv:
    buffer_load_dwordx2 v[20:21], v11, s[4:7], s40 offen sc1
    s_waitcnt vmcnt(0)
mega_kernel_rs_w1_pv1:
    v_and_b32 v3, 1, v20
    v_cmp_ne_u32 vcc, s41, v3
    v_mov_b32 v113, v20
    v_mov_b32 v115, v21
    s_cbranch_vccnz mega_kernel_rs_w1_pv
    s_branch mega_kernel_rs_w1_pv2
mega_kernel_rs_w2_entry:
    v_mfma_f32_32x32x8_bf16 v[96:111], v[14:15], v[14:15], 0
    v_mfma_f32_16x16x16_bf16 v[112:115], v[14:15], v[14:15], 0
    v_mfma_f32_16x16x16_bf16 v[116:119], v[14:15], v[14:15], 0
    ds_read_b128 v[64:67], v1 offset:8192
    ds_read_b128 v[68:71], v1 offset:9216
    ds_read_b128 v[72:75], v1 offset:10240
    ds_read_b128 v[76:79], v1 offset:11264
    ds_read_b128 v[80:83], v1 offset:24576
    ds_read_b128 v[84:87], v1 offset:25600
    ds_read_b128 v[88:91], v1 offset:26624
    ds_read_b128 v[92:95], v1 offset:27648
    buffer_load_dwordx4 v[120:123], v1, s[4:7], s44 offen
    buffer_load_dwordx4 v[124:127], v1, s[4:7], s44 offen offset:1024
    s_add_u32 s44, s44, 262144
mega_kernel_rs_w2_loop:
    s_add_u32 s22, s35, 4096
    s_waitcnt vmcnt(0)
    buffer_load_dwordx4 v[48:51], v1, s[4:7], s22 offen sc1
    buffer_load_dwordx4 v[52:55], v1, s[4:7], s22 offen offset:1024 sc1
mega_kernel_rs_w2_pa:
    s_waitcnt vmcnt(1)
    ds_write_b128 v6, v[48:51] offset:4096
    s_waitcnt vmcnt(0)
    ds_write_b128 v6, v[52:55] offset:5120
    v_max3_u32 v3, v48, v50, v52
    v_max_u32 v3, v3, v54
    v_cmp_eq_u32 vcc, -1, v3
    v_smfmac_f32_16x16x64_bf16 v[96:99], v[48:51], a[64:71], v2
    buffer_load_dwordx4 v[48:51], v1, s[4:7], s22 offen sc1
    v_smfmac_f32_16x16x64_bf16 v[100:103], v[48:51], a[72:79], v2
    buffer_load_dwordx4 v[52:55], v1, s[4:7], s22 offen offset:1024 sc1
    v_smfmac_f32_16x16x64_bf16 v[104:107], v[48:51], a[192:199], v2
    s_cbranch_vccnz mega_kernel_rs_w2_pafail
    s_waitcnt lgkmcnt(0)
    s_barrier
    ds_read_b128 v[56:59], v6 offset:6144
    ds_read_b128 v[60:63], v6 offset:7168
    v_smfmac_f32_16x16x64_bf16 v[108:111], v[48:51], a[200:207], v2
    ds_read_b128 v[32:35], v6 offset:0
    v_smfmac_f32_16x16x64_bf16 v[96:99], v[52:55], a[80:87], v2
    ds_read_b128 v[36:39], v6 offset:1024
    v_smfmac_f32_16x16x64_bf16 v[100:103], v[52:55], a[88:95], v2
    ds_read_b128 v[40:43], v6 offset:2048
    v_smfmac_f32_16x16x64_bf16 v[104:107], v[52:55], a[208:215], v2
    ds_read_b128 v[44:47], v6 offset:3072
    v_smfmac_f32_16x16x64_bf16 v[108:111], v[52:55], a[216:223], v2
    s_waitcnt lgkmcnt(5)
    v_smfmac_f32_16x16x64_bf16 v[96:99], v[56:59], a[96:103], v2
    v_smfmac_f32_16x16x64_bf16 v[104:107], v[56:59], a[224:231], v2
    buffer_load_dwordx4 v1, s[4:7], s43 offen lds
    s_waitcnt lgkmcnt(4)
    v_smfmac_f32_16x16x64_bf16 v[96:99], v[60:63], a[112:119], v2
    v_smfmac_f32_16x16x64_bf16 v[104:107], v[60:63], a[240:247], v2
    s_waitcnt lgkmcnt(3)
    v_smfmac_f32_16x16x64_bf16 v[96:99], v[32:35], a[0:7], v2
    v_smfmac_f32_16x16x64_bf16 v[104:107], v[32:35], a[128:135], v2
    buffer_load_dwordx4 v1, s[4:7], s43 offen offset:1024 lds
    s_waitcnt lgkmcnt(2)
    v_smfmac_f32_16x16x64_bf16 v[96:99], v[36:39], a[16:23], v2
    v_smfmac_f32_16x16x64_bf16 v[104:107], v[36:39], a[144:151], v2
    s_waitcnt lgkmcnt(1)
    v_smfmac_f32_16x16x64_bf16 v[96:99], v[40:43], a[32:39], v2
    v_smfmac_f32_16x16x64_bf16 v[104:107], v[40:43], a[160:167], v2
    s_waitcnt lgkmcnt(0)
    v_smfmac_f32_16x16x64_bf16 v[96:99], v[44:47], a[48:55], v2
    v_smfmac_f32_16x16x64_bf16 v[104:107], v[44:47], a[176:183], v2
    v_smfmac_f32_16x16x64_bf16 v[100:103], v[56:59], a[104:111], v2
    s_nop 2
    v_smfmac_f32_16x16x64_bf16 v[100:103], v[60:63], a[120:127], v2
    s_nop 1
    v_add_f32 v96, v96, v98
    v_smfmac_f32_16x16x64_bf16 v[100:103], v[32:35], a[8:15], v2
    v_add_f32 v97, v97, v99
    v_add_f32 v104, v104, v106
    v_smfmac_f32_16x16x64_bf16 v[100:103], v[36:39], a[24:31], v2
    v_add_f32 v105, v105, v107
    v_cvt_pk_bf16_f32 v96, v96, v97
    v_smfmac_f32_16x16x64_bf16 v[100:103], v[40:43], a[40:47], v2
    v_cvt_pk_bf16_f32 v97, v104, v105
    v_and_or_b32 v96, v96, -2, s41
    v_smfmac_f32_16x16x64_bf16 v[100:103], v[44:47], a[56:63], v2
    buffer_store_dwordx2 v[96:97], v11, s[4:7], s37 offen sc1
    v_smfmac_f32_16x16x64_bf16 v[108:111], v[56:59], a[232:239], v2
    v_smfmac_f32_16x16x64_bf16 v[108:111], v[60:63], a[248:255], v2
    v_smfmac_f32_16x16x64_bf16 v[108:111], v[32:35], a[136:143], v2
    v_smfmac_f32_16x16x64_bf16 v[108:111], v[36:39], a[152:159], v2
    v_smfmac_f32_16x16x64_bf16 v[108:111], v[40:43], a[168:175], v2
    s_nop 2
    v_add_f32 v100, v100, v102
    v_smfmac_f32_16x16x64_bf16 v[108:111], v[44:47], a[184:191], v2
    v_add_f32 v101, v101, v103
    v_cvt_pk_bf16_f32 v98, v100, v101
    v_and_or_b32 v98, v98, -2, s41
    s_nop 4
    v_pk_add_f32 v[108:109], v[108:109], v[110:111]
    v_cvt_pk_bf16_f32 v99, v108, v109
    buffer_store_dwordx2 v[98:99], v11, s[4:7], s37 offen offset:512 sc1
    v_smfmac_f32_16x16x64_bf16 v[112:115], v[32:35], v[64:71], v2
    ds_read_b128 v[64:67], v1 offset:40960
    ds_read_b128 v[68:71], v1 offset:41984
    v_smfmac_f32_16x16x64_bf16 v[116:119], v[32:35], v[72:79], v2
    ds_read_b128 v[72:75], v1 offset:43008
    ds_read_b128 v[76:79], v1 offset:44032
    v_smfmac_f32_16x16x64_bf16 v[112:115], v[36:39], v[80:87], v2
    ds_read_b128 v[80:83], v1 offset:57344
    ds_read_b128 v[84:87], v1 offset:58368
    v_smfmac_f32_16x16x64_bf16 v[116:119], v[36:39], v[88:95], v2
    ds_read_b128 v[88:91], v1 offset:59392
    ds_read_b128 v[92:95], v1 offset:60416
    s_waitcnt lgkmcnt(6)
    v_smfmac_f32_16x16x64_bf16 v[112:115], v[40:43], v[64:71], v2
    ds_read_b128 v[64:67], v5 offset:8192
    ds_read_b128 v[68:71], v5 offset:9216
    s_waitcnt lgkmcnt(6)
    v_smfmac_f32_16x16x64_bf16 v[116:119], v[40:43], v[72:79], v2
    ds_read_b128 v[72:75], v5 offset:10240
    ds_read_b128 v[76:79], v5 offset:11264
    s_waitcnt lgkmcnt(6)
    v_smfmac_f32_16x16x64_bf16 v[112:115], v[44:47], v[80:87], v2
    ds_read_b128 v[80:83], v5 offset:24576
    ds_read_b128 v[84:87], v5 offset:25600
    s_waitcnt lgkmcnt(6)
    v_smfmac_f32_16x16x64_bf16 v[116:119], v[44:47], v[88:95], v2
    ds_read_b128 v[88:91], v5 offset:26624
    ds_read_b128 v[92:95], v5 offset:27648
    s_waitcnt lgkmcnt(6)
    v_smfmac_f32_16x16x64_bf16 v[112:115], v[48:51], v[64:71], v2
    ds_read_b128 v[64:67], v5 offset:40960
    ds_read_b128 v[68:71], v5 offset:41984
    s_waitcnt lgkmcnt(6)
    v_smfmac_f32_16x16x64_bf16 v[116:119], v[48:51], v[72:79], v2
    ds_read_b128 v[72:75], v5 offset:43008
    ds_read_b128 v[76:79], v5 offset:44032
    s_waitcnt lgkmcnt(6)
    v_smfmac_f32_16x16x64_bf16 v[112:115], v[52:55], v[80:87], v2
    ds_read_b128 v[80:83], v5 offset:57344
    ds_read_b128 v[84:87], v5 offset:58368
    s_waitcnt lgkmcnt(6)
    v_smfmac_f32_16x16x64_bf16 v[116:119], v[52:55], v[88:95], v2
    ds_read_b128 v[88:91], v5 offset:59392
    ds_read_b128 v[92:95], v5 offset:60416
    s_waitcnt lgkmcnt(6)
    v_smfmac_f32_16x16x64_bf16 v[112:115], v[56:59], v[64:71], v2
    s_waitcnt lgkmcnt(4)
    v_smfmac_f32_16x16x64_bf16 v[116:119], v[56:59], v[72:79], v2
    s_waitcnt lgkmcnt(2)
    v_smfmac_f32_16x16x64_bf16 v[112:115], v[60:63], v[80:87], v2
    s_waitcnt lgkmcnt(0)
    v_smfmac_f32_16x16x64_bf16 v[116:119], v[60:63], v[88:95], v2
    buffer_load_dwordx2 v[108:109], v11, s[4:7], s38 offen sc1
    v_mfma_f32_16x16x16_bf16 v[100:103], v[96:97], v[16:17], 0
    v_mfma_f32_16x16x16_bf16 v[104:107], v[98:99], v[16:17], 0
    s_nop 4
    v_add_f32 v112, v112, v114
    v_add_f32 v113, v113, v115
    v_add_f32 v114, v116, v118
    v_add_f32 v115, v117, v119
    v_cvt_pk_bf16_f32 v18, v112, v113
    v_cvt_pk_bf16_f32 v19, v114, v115
    v_and_or_b32 v18, v18, -2, s41
    buffer_load_dwordx2 v[110:111], v11, s[4:7], s38 offen offset:512 sc1
    s_barrier
    buffer_store_dwordx2 v[18:19], v11, s[4:7], s39 offen sc1
    v_mov_b32 v112, v18
    v_mov_b32 v114, v19
    v_mov_b32 v92, v28
    v_mov_b32 v93, 0
    s_waitcnt vmcnt(5)
    s_barrier
    ds_read_b128 v[32:35], v6 offset:19456
    ds_read_b128 v[36:39], v6 offset:20480
    ds_read_b128 v[40:43], v6 offset:24576
    ds_read_b128 v[44:47], v6 offset:25600
    ds_read_b128 v[48:51], v6 offset:9216
    ds_read_b128 v[52:55], v6 offset:10240
    ds_read_b128 v[56:59], v6 offset:14336
    ds_read_b128 v[60:63], v6 offset:15360
    buffer_load_dwordx2 v[20:21], v11, s[4:7], s38 offen sc1
    buffer_load_dwordx2 v[22:23], v11, s[4:7], s38 offen offset:512 sc1
    s_waitcnt vmcnt(4)
    v_mfma_f32_16x16x16_bf16 v[80:83], v[108:109], v[16:17], v[100:103]
    v_and_b32 v3, 1, v108
    v_cmp_ne_u32 vcc, s41, v3
    s_nop 5
    v_cvt_pk_bf16_f32 v64, v80, v81
    v_cvt_pk_bf16_f32 v65, v82, v83
    s_cbranch_vccnz mega_kernel_rs_w2_xslow
    s_waitcnt vmcnt(3)
    v_mfma_f32_16x16x16_bf16 v[84:87], v[110:111], v[16:17], v[104:107]
    v_and_b32 v3, 1, v110
    v_cmp_ne_u32 vcc, s41, v3
    s_nop 5
    v_cvt_pk_bf16_f32 v66, v84, v85
    v_cvt_pk_bf16_f32 v67, v86, v87
    ds_write_b128 v6, v[64:67] offset:18432
    s_cbranch_vccnz mega_kernel_rs_w2_xslow
mega_kernel_rs_w2_xok:
    s_cmp_eq_u32 s21, 63
    s_cbranch_scc1 mega_kernel_rs_w2_last
    buffer_load_dwordx2 v[116:117], v11, s[4:7], s40 offen sc1
    s_waitcnt lgkmcnt(1)
    v_mfma_f32_16x16x32_bf16 v[80:83], v[32:35], v[64:67], 0
    s_waitcnt lgkmcnt(0)
    s_barrier
    ds_read_b128 v[68:71], v6 offset:23552
    ds_read_b128 v[72:75], v6 offset:8192
    ds_read_b128 v[76:79], v6 offset:13312
    v_mfma_f32_16x16x32_bf16 v[84:87], v[36:39], v[64:67], 0
    v_mfma_f32_16x16x32_bf16 v[88:91], v[64:67], v[64:67], 0
    buffer_load_dwordx2 v[20:21], v11, s[4:7], s40 offen sc1
    s_waitcnt lgkmcnt(2)
    v_mfma_f32_16x16x32_bf16 v[80:83], v[40:43], v[68:71], v[80:83]
    s_waitcnt lgkmcnt(1)
    v_mfma_f32_16x16x32_bf16 v[80:83], v[48:51], v[72:75], v[80:83]
    s_waitcnt lgkmcnt(0)
    v_mfma_f32_16x16x32_bf16 v[80:83], v[56:59], v[76:79], v[80:83]
    buffer_store_dwordx4 v[64:67], v10, s[4:7], s45 offen offset:128 sc1
    v_mfma_f32_16x16x32_bf16 v[84:87], v[44:47], v[68:71], v[84:87]
    v_mfma_f32_16x16x32_bf16 v[84:87], v[52:55], v[72:75], v[84:87]
    v_mfma_f32_16x16x32_bf16 v[84:87], v[60:63], v[76:79], v[84:87]
    v_mfma_f32_16x16x32_bf16 v[88:91], v[68:71], v[68:71], v[88:91]
    buffer_store_dwordx2 v[18:19], v11, s[4:7], s51 offen offset:3072 sc1
    v_mfma_f32_16x16x32_bf16 v[88:91], v[72:75], v[72:75], v[88:91]
    v_mfma_f32_16x16x32_bf16 v[88:91], v[76:79], v[76:79], v[88:91]
    v_mfma_f32_32x32x4_2b_bf16 v[32:63], v[14:15], v[14:15], 0
    s_nop 0
    v_max3_f32 v4, v80, v81, v82
    s_nop 1
    v_max3_f32 v4, v4, v83, v84
    v_max3_f32 v4, v4, v85, v86
    v_max_f32 v4, v4, v87
    v_max3_f32 v90, v4, v88, v89
    v_max3_f32 v4, v4, v88, v89
    s_nop 1
    v_permlane16_swap_b32 v4, v90
    v_max_f32 v4, v4, v90
    v_max_f32 v90, v4, v90
    s_nop 1
    v_permlane32_swap_b32 v4, v90
    v_max_f32 v4, v4, v90
    v_mul_f32 v4, s34, v4
    v_pk_fma_f32 v[80:81], v[80:81], s[34:35], v[4:5] op_sel_hi:[1,0,0] neg_lo:[0,0,1] neg_hi:[0,0,1]
    v_pk_fma_f32 v[82:83], v[82:83], s[34:35], v[4:5] op_sel_hi:[1,0,0] neg_lo:[0,0,1] neg_hi:[0,0,1]
    v_pk_fma_f32 v[84:85], v[84:85], s[34:35], v[4:5] op_sel_hi:[1,0,0] neg_lo:[0,0,1] neg_hi:[0,0,1]
    v_pk_fma_f32 v[86:87], v[86:87], s[34:35], v[4:5] op_sel_hi:[1,0,0] neg_lo:[0,0,1] neg_hi:[0,0,1]
    v_pk_fma_f32 v[88:89], v[88:89], s[34:35], v[4:5] op_sel_hi:[1,0,0] neg_lo:[0,0,1] neg_hi:[0,0,1]
    v_exp_f32 v80, v80
    v_exp_f32 v81, v81
    v_exp_f32 v82, v82
    v_cvt_pk_bf16_f32 v68, v80, v81
    v_exp_f32 v83, v83
    v_exp_f32 v84, v84
    v_cvt_pk_bf16_f32 v69, v82, v83
    v_exp_f32 v85, v85
    v_exp_f32 v86, v86
    v_cvt_pk_bf16_f32 v70, v84, v85
    v_exp_f32 v87, v87
    v_exp_f32 v88, v88
    v_cvt_pk_bf16_f32 v71, v86, v87
    v_exp_f32 v89, v89
    s_waitcnt vmcnt(3)
    v_mfma_f32_16x16x32_bf16 v[76:79], v[28:31], v[68:71], 0
    v_and_b32 v3, 1, v116
    v_cvt_pk_bf16_f32 v72, v88, v89
    v_mfma_f32_16x16x32_bf16 v[100:103], v[120:123], v[68:71], 0
    v_cmp_ne_u32 vcc, s41, v3
    v_cvt_pk_bf16_f32 v73, v88, v89
    v_mfma_f32_16x16x32_bf16 v[104:107], v[124:127], v[68:71], 0
    v_mov_b32 v113, v116
    v_mov_b32 v115, v117
    v_mfma_f32_16x16x16_bf16 v[76:79], v[92:93], v[72:73], v[76:79]
    s_cbranch_vccnz mega_kernel_rs_w2_pv0
mega_kernel_rs_w2_pv2:
    v_mfma_f32_16x16x16_bf16 v[100:103], v[112:113], v[72:73], v[100:103]
    v_mfma_f32_16x16x16_bf16 v[104:107], v[114:115], v[72:73], v[104:107]
    buffer_load_dwordx4 v[120:123], v1, s[4:7], s44 offen
    buffer_load_dwordx4 v[124:127], v1, s[4:7], s44 offen offset:1024
    s_nop 2
    v_rcp_f32 v76, v76
    s_mov_b64 exec, s[28:29]
    v_pk_mul_f32 v[100:101], v[100:101], v[76:77] op_sel_hi:[1,0]
    v_pk_mul_f32 v[102:103], v[102:103], v[76:77] op_sel_hi:[1,0]
    v_pk_mul_f32 v[104:105], v[104:105], v[76:77] op_sel_hi:[1,0]
    v_pk_mul_f32 v[106:107], v[106:107], v[76:77] op_sel_hi:[1,0]
    v_cvt_pk_bf16_f32 v84, v100, v101
    v_cvt_pk_bf16_f32 v85, v102, v103
    v_cvt_pk_bf16_f32 v86, v104, v105
    v_cvt_pk_bf16_f32 v87, v106, v107
    ds_write_b128 v6, v[84:87] offset:29664
    s_mov_b64 exec, -1
    s_waitcnt lgkmcnt(0)
    s_barrier
    ds_read_b128 v[68:71], v6 offset:28672
    ds_read_b128 v[72:75], v6 offset:29696
    s_waitcnt lgkmcnt(1)
    v_smfmac_f32_16x16x64_bf16 v[32:35], v[68:71], v[128:135], v2
    s_add_u32 s21, s21, 1
    s_xor_b32 s38, s38, 1048576
    s_xor_b32 s37, s37, 1048576
    s_waitcnt lgkmcnt(0)
    v_smfmac_f32_16x16x64_bf16 v[32:35], v[72:75], v[136:143], v2
    s_xor_b32 s40, s40, 1048576
    s_xor_b32 s39, s39, 1048576
    s_lshr_b32 s41, s21, 1
    v_smfmac_f32_16x16x64_bf16 v[36:39], v[68:71], v[144:151], v2
    s_and_b32 s41, s41, 1
    s_xor_b32 s41, s41, 1
    s_xor_b32 s35, s35, 16384
    v_smfmac_f32_16x16x64_bf16 v[36:39], v[72:75], v[152:159], v2
    v_add_f32 v32, v32, v34
    s_xor_b32 s36, s36, 16384
    s_add_u32 s43, s43, 262144
    s_add_u32 s44, s44, 262144
    v_smfmac_f32_16x16x64_bf16 v[40:43], v[68:71], v[160:167], v2
    v_add_f32 v33, v33, v35
    v_smfmac_f32_16x16x64_bf16 v[40:43], v[72:75], v[168:175], v2
    v_cvt_pk_bf16_f32 v32, v32, v33
    v_smfmac_f32_16x16x64_bf16 v[44:47], v[68:71], v[176:183], v2
    v_and_or_b32 v32, v32, -2, s42
    v_smfmac_f32_16x16x64_bf16 v[44:47], v[72:75], v[184:191], v2
    v_add_f32 v36, v36, v38
    v_smfmac_f32_16x16x64_bf16 v[48:51], v[68:71], v[192:199], v2
    v_add_f32 v37, v37, v39
    v_smfmac_f32_16x16x64_bf16 v[48:51], v[72:75], v[200:207], v2
    v_cvt_pk_bf16_f32 v33, v36, v37
    v_smfmac_f32_16x16x64_bf16 v[52:55], v[68:71], v[208:215], v2
    v_add_f32 v40, v40, v42
    v_smfmac_f32_16x16x64_bf16 v[52:55], v[72:75], v[216:223], v2
    v_add_f32 v41, v41, v43
    v_smfmac_f32_16x16x64_bf16 v[56:59], v[68:71], v[224:231], v2
    v_cvt_pk_bf16_f32 v34, v40, v41
    v_smfmac_f32_16x16x64_bf16 v[56:59], v[72:75], v[232:239], v2
    v_add_f32 v44, v44, v46
    v_smfmac_f32_16x16x64_bf16 v[60:63], v[68:71], v[240:247], v2
    v_add_f32 v45, v45, v47
    v_smfmac_f32_16x16x64_bf16 v[60:63], v[72:75], v[248:255], v2
    v_cvt_pk_bf16_f32 v35, v44, v45
    buffer_store_dwordx4 v[32:35], v8, s[4:7], s46 offen sc1
    v_pk_add_f32 v[48:49], v[48:49], v[50:51]
    v_cvt_pk_bf16_f32 v48, v48, v49
    v_and_or_b32 v48, v48, -2, s42
    v_pk_add_f32 v[52:53], v[52:53], v[54:55]
    v_cvt_pk_bf16_f32 v49, v52, v53
    v_pk_add_f32 v[56:57], v[56:57], v[58:59]
    v_cvt_pk_bf16_f32 v50, v56, v57
    v_pk_add_f32 v[60:61], v[60:61], v[62:63]
    v_cvt_pk_bf16_f32 v51, v60, v61
    buffer_store_dwordx4 v[48:51], v8, s[4:7], s61 offen sc1
    s_add_u32 s45, s45, 262144
    s_add_u32 s51, s51, 262144
    v_mfma_f32_32x32x8_bf16 v[96:111], v[14:15], v[14:15], 0
    v_mfma_f32_16x16x16_bf16 v[112:115], v[14:15], v[14:15], 0
    v_mfma_f32_16x16x16_bf16 v[116:119], v[14:15], v[14:15], 0
    ds_read_b128 v[64:67], v1 offset:8192
    ds_read_b128 v[68:71], v1 offset:9216
    ds_read_b128 v[72:75], v1 offset:10240
    ds_read_b128 v[76:79], v1 offset:11264
    ds_read_b128 v[80:83], v1 offset:24576
    ds_read_b128 v[84:87], v1 offset:25600
    ds_read_b128 v[88:91], v1 offset:26624
    ds_read_b128 v[92:95], v1 offset:27648
    v_mov_b32 v58, -1
    v_mov_b32 v59, -1
    s_waitcnt vmcnt(0)
mega_kernel_rs_w2_cgo:
mega_kernel_rs_w2_pc:
    buffer_load_dword v36, v13, s[4:7], s25 offen offset:0 sc1
    buffer_load_dword v37, v13, s[4:7], s25 offen offset:256 sc1
    buffer_load_dword v38, v13, s[4:7], s25 offen offset:512 sc1
    buffer_load_dword v39, v13, s[4:7], s25 offen offset:768 sc1
    buffer_load_dword v40, v13, s[4:7], s25 offen offset:1024 sc1
    buffer_load_dword v41, v13, s[4:7], s25 offen offset:1280 sc1
    buffer_load_dword v42, v13, s[4:7], s25 offen offset:1536 sc1
    buffer_load_dword v43, v13, s[4:7], s25 offen offset:1792 sc1
    s_waitcnt vmcnt(4)
    v_mfma_f32_16x16x32_bf16 v[52:55], v[36:39], v[24:27], 0
    v_bitop3_b32 v3, s42, v36, v37 bitop3:0x7e
    v_bitop3_b32 v4, s42, v38, v39 bitop3:0x7e
    s_waitcnt vmcnt(2)
    v_or_b32 v3, v3, v4
    v_bitop3_b32 v4, s42, v40, v41 bitop3:0x7e
    s_waitcnt vmcnt(0)
    v_mfma_f32_16x16x32_bf16 v[52:55], v[40:43], v[24:27], v[52:55]
    v_bitop3_b32 v56, s42, v42, v43 bitop3:0x7e
    v_or3_b32 v3, v3, v4, v56
    v_and_b32 v3, v0, v3
    v_cmp_ne_u32 vcc, 0, v3
    s_nop 3
    v_cvt_pk_bf16_f32 v56, v52, v53
    v_cvt_pk_bf16_f32 v57, v54, v55
    v_min_u32 v56, -2, v56
    s_cbranch_vccnz mega_kernel_rs_w2_pc
    s_mov_b64 exec, s[26:27]
    buffer_store_dwordx2 v[56:57], v9, s[4:7], s35 offen offset:512 sc1
    buffer_store_dwordx2 v[58:59], v9, s[4:7], s36 offen offset:512 sc1
    s_mov_b64 exec, -1
    s_xor_b32 s42, s42, 1
    s_branch mega_kernel_rs_w2_loop
mega_kernel_rs_w2_last:
    buffer_store_dwordx4 v[64:67], v10, s[4:7], s45 offen offset:128 sc1
    buffer_store_dwordx2 v[18:19], v11, s[4:7], s51 offen offset:3072 sc1
    s_branch mega_kernel_rs_end
mega_kernel_rs_w2_pafail:
    s_nop 7
    v_mov_b32 v96, 0
    v_mov_b32 v97, 0
    v_mov_b32 v98, 0
    v_mov_b32 v99, 0
    v_mov_b32 v100, 0
    v_mov_b32 v101, 0
    v_mov_b32 v102, 0
    v_mov_b32 v103, 0
    v_mov_b32 v104, 0
    v_mov_b32 v105, 0
    v_mov_b32 v106, 0
    v_mov_b32 v107, 0
    s_branch mega_kernel_rs_w2_pa
mega_kernel_rs_w2_xslow:
    buffer_load_dwordx2 v[108:109], v11, s[4:7], s38 offen sc1
    buffer_load_dwordx2 v[110:111], v11, s[4:7], s38 offen offset:512 sc1
    s_waitcnt vmcnt(2)
    v_bitop3_b32 v3, s41, v20, v22 bitop3:0x7e
    v_mfma_f32_16x16x16_bf16 v[80:83], v[20:21], v[16:17], v[100:103]
    v_and_b32 v3, 1, v3
    v_mfma_f32_16x16x16_bf16 v[84:87], v[22:23], v[16:17], v[104:107]
    v_cmp_ne_u32 vcc, 0, v3
    s_cbranch_vccz mega_kernel_rs_w2_xgot
    buffer_load_dwordx2 v[20:21], v11, s[4:7], s38 offen sc1
    buffer_load_dwordx2 v[22:23], v11, s[4:7], s38 offen offset:512 sc1
    s_waitcnt vmcnt(2)
    v_bitop3_b32 v3, s41, v108, v110 bitop3:0x7e
    v_mfma_f32_16x16x16_bf16 v[80:83], v[108:109], v[16:17], v[100:103]
    v_and_b32 v3, 1, v3
    v_mfma_f32_16x16x16_bf16 v[84:87], v[110:111], v[16:17], v[104:107]
    v_cmp_ne_u32 vcc, 0, v3
    s_cbranch_vccz mega_kernel_rs_w2_xgot
    s_branch mega_kernel_rs_w2_xslow
mega_kernel_rs_w2_xgot:
    s_nop 3
    v_cvt_pk_bf16_f32 v64, v80, v81
    v_cvt_pk_bf16_f32 v65, v82, v83
    v_cvt_pk_bf16_f32 v66, v84, v85
    v_cvt_pk_bf16_f32 v67, v86, v87
    ds_write_b128 v6, v[64:67] offset:18432
    s_branch mega_kernel_rs_w2_xok
mega_kernel_rs_w2_pv0:
    s_waitcnt vmcnt(2)
    s_branch mega_kernel_rs_w2_pv1
mega_kernel_rs_w2_pv:
    buffer_load_dwordx2 v[20:21], v11, s[4:7], s40 offen sc1
    s_waitcnt vmcnt(0)
mega_kernel_rs_w2_pv1:
    v_and_b32 v3, 1, v20
    v_cmp_ne_u32 vcc, s41, v3
    v_mov_b32 v113, v20
    v_mov_b32 v115, v21
    s_cbranch_vccnz mega_kernel_rs_w2_pv
    s_branch mega_kernel_rs_w2_pv2
mega_kernel_rs_w3_entry:
    v_mfma_f32_32x32x8_bf16 v[96:111], v[14:15], v[14:15], 0
    v_mfma_f32_16x16x16_bf16 v[112:115], v[14:15], v[14:15], 0
    v_mfma_f32_16x16x16_bf16 v[116:119], v[14:15], v[14:15], 0
    ds_read_b128 v[64:67], v1 offset:12288
    ds_read_b128 v[68:71], v1 offset:13312
    ds_read_b128 v[72:75], v1 offset:14336
    ds_read_b128 v[76:79], v1 offset:15360
    ds_read_b128 v[80:83], v1 offset:28672
    ds_read_b128 v[84:87], v1 offset:29696
    ds_read_b128 v[88:91], v1 offset:30720
    ds_read_b128 v[92:95], v1 offset:31744
    buffer_load_dwordx4 v[120:123], v1, s[4:7], s44 offen
    buffer_load_dwordx4 v[124:127], v1, s[4:7], s44 offen offset:1024
    s_add_u32 s44, s44, 262144
mega_kernel_rs_w3_loop:
    s_add_u32 s22, s35, 6144
    s_waitcnt vmcnt(0)
    buffer_load_dwordx4 v[56:59], v1, s[4:7], s22 offen sc1
    buffer_load_dwordx4 v[60:63], v1, s[4:7], s22 offen offset:1024 sc1
mega_kernel_rs_w3_pa:
    s_waitcnt vmcnt(1)
    ds_write_b128 v6, v[56:59] offset:6144
    s_waitcnt vmcnt(0)
    ds_write_b128 v6, v[60:63] offset:7168
    v_max3_u32 v3, v56, v58, v60
    v_max_u32 v3, v3, v62
    v_cmp_eq_u32 vcc, -1, v3
    v_smfmac_f32_16x16x64_bf16 v[96:99], v[56:59], a[96:103], v2
    buffer_load_dwordx4 v[56:59], v1, s[4:7], s22 offen sc1
    v_smfmac_f32_16x16x64_bf16 v[100:103], v[56:59], a[104:111], v2
    buffer_load_dwordx4 v[60:63], v1, s[4:7], s22 offen offset:1024 sc1
    v_smfmac_f32_16x16x64_bf16 v[104:107], v[56:59], a[224:231], v2
    s_cbranch_vccnz mega_kernel_rs_w3_pafail
    s_waitcnt lgkmcnt(0)
    s_barrier
    ds_read_b128 v[32:35], v6 offset:0
    ds_read_b128 v[36:39], v6 offset:1024
    v_smfmac_f32_16x16x64_bf16 v[108:111], v[56:59], a[232:239], v2
    ds_read_b128 v[40:43], v6 offset:2048
    v_smfmac_f32_16x16x64_bf16 v[96:99], v[60:63], a[112:119], v2
    ds_read_b128 v[44:47], v6 offset:3072
    v_smfmac_f32_16x16x64_bf16 v[100:103], v[60:63], a[120:127], v2
    ds_read_b128 v[48:51], v6 offset:4096
    v_smfmac_f32_16x16x64_bf16 v[104:107], v[60:63], a[240:247], v2
    ds_read_b128 v[52:55], v6 offset:5120
    v_smfmac_f32_16x16x64_bf16 v[108:111], v[60:63], a[248:255], v2
    s_waitcnt lgkmcnt(5)
    v_smfmac_f32_16x16x64_bf16 v[96:99], v[32:35], a[0:7], v2
    v_smfmac_f32_16x16x64_bf16 v[104:107], v[32:35], a[128:135], v2
    s_waitcnt lgkmcnt(4)
    v_smfmac_f32_16x16x64_bf16 v[96:99], v[36:39], a[16:23], v2
    buffer_load_dwordx4 v1, s[4:7], s43 offen lds
    v_smfmac_f32_16x16x64_bf16 v[104:107], v[36:39], a[144:151], v2
    s_waitcnt lgkmcnt(3)
    v_smfmac_f32_16x16x64_bf16 v[96:99], v[40:43], a[32:39], v2
    v_smfmac_f32_16x16x64_bf16 v[104:107], v[40:43], a[160:167], v2
    s_waitcnt lgkmcnt(2)
    v_smfmac_f32_16x16x64_bf16 v[96:99], v[44:47], a[48:55], v2
    buffer_load_dwordx4 v1, s[4:7], s43 offen offset:1024 lds
    v_smfmac_f32_16x16x64_bf16 v[104:107], v[44:47], a[176:183], v2
    s_waitcnt lgkmcnt(1)
    v_smfmac_f32_16x16x64_bf16 v[96:99], v[48:51], a[64:71], v2
    v_smfmac_f32_16x16x64_bf16 v[104:107], v[48:51], a[192:199], v2
    s_waitcnt lgkmcnt(0)
    v_smfmac_f32_16x16x64_bf16 v[96:99], v[52:55], a[80:87], v2
    buffer_load_dword v12, v7, s[4:7], 0 offen sc1
    v_smfmac_f32_16x16x64_bf16 v[104:107], v[52:55], a[208:215], v2
    v_smfmac_f32_16x16x64_bf16 v[100:103], v[32:35], a[8:15], v2
    s_nop 2
    v_smfmac_f32_16x16x64_bf16 v[100:103], v[36:39], a[24:31], v2
    s_nop 1
    v_add_f32 v96, v96, v98
    v_smfmac_f32_16x16x64_bf16 v[100:103], v[40:43], a[40:47], v2
    v_add_f32 v97, v97, v99
    v_add_f32 v104, v104, v106
    v_smfmac_f32_16x16x64_bf16 v[100:103], v[44:47], a[56:63], v2
    v_add_f32 v105, v105, v107
    v_cvt_pk_bf16_f32 v96, v96, v97
    v_smfmac_f32_16x16x64_bf16 v[100:103], v[48:51], a[72:79], v2
    v_cvt_pk_bf16_f32 v97, v104, v105
    v_and_or_b32 v96, v96, -2, s41
    v_smfmac_f32_16x16x64_bf16 v[100:103], v[52:55], a[88:95], v2
    buffer_store_dwordx2 v[96:97], v11, s[4:7], s37 offen sc1
    v_smfmac_f32_16x16x64_bf16 v[108:111], v[32:35], a[136:143], v2
    v_smfmac_f32_16x16x64_bf16 v[108:111], v[36:39], a[152:159], v2
    v_smfmac_f32_16x16x64_bf16 v[108:111], v[40:43], a[168:175], v2
    v_smfmac_f32_16x16x64_bf16 v[108:111], v[44:47], a[184:191], v2
    v_smfmac_f32_16x16x64_bf16 v[108:111], v[48:51], a[200:207], v2
    s_nop 2
    v_add_f32 v100, v100, v102
    v_smfmac_f32_16x16x64_bf16 v[108:111], v[52:55], a[216:223], v2
    v_add_f32 v101, v101, v103
    v_cvt_pk_bf16_f32 v98, v100, v101
    v_and_or_b32 v98, v98, -2, s41
    s_nop 4
    v_pk_add_f32 v[108:109], v[108:109], v[110:111]
    v_cvt_pk_bf16_f32 v99, v108, v109
    buffer_store_dwordx2 v[98:99], v11, s[4:7], s37 offen offset:512 sc1
    v_smfmac_f32_16x16x64_bf16 v[112:115], v[32:35], v[64:71], v2
    ds_read_b128 v[64:67], v1 offset:45056
    ds_read_b128 v[68:71], v1 offset:46080
    v_smfmac_f32_16x16x64_bf16 v[116:119], v[32:35], v[72:79], v2
    ds_read_b128 v[72:75], v1 offset:47104
    ds_read_b128 v[76:79], v1 offset:48128
    v_smfmac_f32_16x16x64_bf16 v[112:115], v[36:39], v[80:87], v2
    ds_read_b128 v[80:83], v1 offset:61440
    ds_read_b128 v[84:87], v1 offset:62464
    v_smfmac_f32_16x16x64_bf16 v[116:119], v[36:39], v[88:95], v2
    ds_read_b128 v[88:91], v1 offset:63488
    ds_read_b128 v[92:95], v1 offset:64512
    s_waitcnt lgkmcnt(6)
    v_smfmac_f32_16x16x64_bf16 v[112:115], v[40:43], v[64:71], v2
    ds_read_b128 v[64:67], v5 offset:12288
    ds_read_b128 v[68:71], v5 offset:13312
    s_waitcnt lgkmcnt(6)
    v_smfmac_f32_16x16x64_bf16 v[116:119], v[40:43], v[72:79], v2
    ds_read_b128 v[72:75], v5 offset:14336
    ds_read_b128 v[76:79], v5 offset:15360
    s_waitcnt lgkmcnt(6)
    v_smfmac_f32_16x16x64_bf16 v[112:115], v[44:47], v[80:87], v2
    ds_read_b128 v[80:83], v5 offset:28672
    ds_read_b128 v[84:87], v5 offset:29696
    s_waitcnt lgkmcnt(6)
    v_smfmac_f32_16x16x64_bf16 v[116:119], v[44:47], v[88:95], v2
    ds_read_b128 v[88:91], v5 offset:30720
    ds_read_b128 v[92:95], v5 offset:31744
    s_waitcnt lgkmcnt(6)
    v_smfmac_f32_16x16x64_bf16 v[112:115], v[48:51], v[64:71], v2
    ds_read_b128 v[64:67], v5 offset:45056
    ds_read_b128 v[68:71], v5 offset:46080
    s_waitcnt lgkmcnt(6)
    v_smfmac_f32_16x16x64_bf16 v[116:119], v[48:51], v[72:79], v2
    ds_read_b128 v[72:75], v5 offset:47104
    ds_read_b128 v[76:79], v5 offset:48128
    s_waitcnt lgkmcnt(6)
    v_smfmac_f32_16x16x64_bf16 v[112:115], v[52:55], v[80:87], v2
    ds_read_b128 v[80:83], v5 offset:61440
    ds_read_b128 v[84:87], v5 offset:62464
    s_waitcnt lgkmcnt(6)
    v_smfmac_f32_16x16x64_bf16 v[116:119], v[52:55], v[88:95], v2
    ds_read_b128 v[88:91], v5 offset:63488
    ds_read_b128 v[92:95], v5 offset:64512
    s_waitcnt lgkmcnt(6)
    v_smfmac_f32_16x16x64_bf16 v[112:115], v[56:59], v[64:71], v2
    s_waitcnt lgkmcnt(4)
    v_smfmac_f32_16x16x64_bf16 v[116:119], v[56:59], v[72:79], v2
    s_waitcnt lgkmcnt(2)
    v_smfmac_f32_16x16x64_bf16 v[112:115], v[60:63], v[80:87], v2
    s_waitcnt lgkmcnt(0)
    v_smfmac_f32_16x16x64_bf16 v[116:119], v[60:63], v[88:95], v2
    buffer_load_dwordx2 v[108:109], v11, s[4:7], s38 offen sc1
    v_mfma_f32_16x16x16_bf16 v[100:103], v[96:97], v[16:17], 0
    v_mfma_f32_16x16x16_bf16 v[104:107], v[98:99], v[16:17], 0
    s_nop 4
    v_add_f32 v112, v112, v114
    v_add_f32 v113, v113, v115
    v_add_f32 v114, v116, v118
    v_add_f32 v115, v117, v119
    v_cvt_pk_bf16_f32 v18, v112, v113
    v_cvt_pk_bf16_f32 v19, v114, v115
    v_and_or_b32 v18, v18, -2, s41
    buffer_load_dwordx2 v[110:111], v11, s[4:7], s38 offen offset:512 sc1
    s_barrier
    buffer_store_dwordx2 v[18:19], v11, s[4:7], s39 offen sc1
    v_mov_b32 v112, v18
    v_mov_b32 v114, v19
    v_mov_b32 v92, v28
    v_mov_b32 v93, 0
    s_waitcnt vmcnt(6)
    s_barrier
    ds_read_b128 v[32:35], v6 offset:24576
    ds_read_b128 v[36:39], v6 offset:25600
    ds_read_b128 v[40:43], v6 offset:19456
    ds_read_b128 v[44:47], v6 offset:20480
    ds_read_b128 v[48:51], v6 offset:14336
    ds_read_b128 v[52:55], v6 offset:15360
    ds_read_b128 v[56:59], v6 offset:9216
    ds_read_b128 v[60:63], v6 offset:10240
    buffer_load_dwordx2 v[20:21], v11, s[4:7], s38 offen sc1
    buffer_load_dwordx2 v[22:23], v11, s[4:7], s38 offen offset:512 sc1
    s_waitcnt vmcnt(4)
    v_mfma_f32_16x16x16_bf16 v[80:83], v[108:109], v[16:17], v[100:103]
    v_and_b32 v3, 1, v108
    v_cmp_ne_u32 vcc, s41, v3
    s_nop 5
    v_cvt_pk_bf16_f32 v64, v80, v81
    v_cvt_pk_bf16_f32 v65, v82, v83
    s_cbranch_vccnz mega_kernel_rs_w3_xslow
    s_waitcnt vmcnt(3)
    v_mfma_f32_16x16x16_bf16 v[84:87], v[110:111], v[16:17], v[104:107]
    v_and_b32 v3, 1, v110
    v_cmp_ne_u32 vcc, s41, v3
    s_nop 5
    v_cvt_pk_bf16_f32 v66, v84, v85
    v_cvt_pk_bf16_f32 v67, v86, v87
    ds_write_b128 v6, v[64:67] offset:23552
    s_cbranch_vccnz mega_kernel_rs_w3_xslow
mega_kernel_rs_w3_xok:
    s_cmp_eq_u32 s21, 63
    s_cbranch_scc1 mega_kernel_rs_w3_last
    buffer_load_dwordx2 v[116:117], v11, s[4:7], s40 offen sc1
    s_waitcnt lgkmcnt(1)
    v_mfma_f32_16x16x32_bf16 v[80:83], v[32:35], v[64:67], 0
    s_waitcnt lgkmcnt(0)
    s_barrier
    ds_read_b128 v[68:71], v6 offset:18432
    ds_read_b128 v[72:75], v6 offset:13312
    ds_read_b128 v[76:79], v6 offset:8192
    v_mfma_f32_16x16x32_bf16 v[84:87], v[36:39], v[64:67], 0
    v_mfma_f32_16x16x32_bf16 v[88:91], v[64:67], v[64:67], 0
    buffer_load_dwordx2 v[20:21], v11, s[4:7], s40 offen sc1
    s_waitcnt lgkmcnt(2)
    v_mfma_f32_16x16x32_bf16 v[80:83], v[40:43], v[68:71], v[80:83]
    s_waitcnt lgkmcnt(1)
    v_mfma_f32_16x16x32_bf16 v[80:83], v[48:51], v[72:75], v[80:83]
    s_waitcnt lgkmcnt(0)
    v_mfma_f32_16x16x32_bf16 v[80:83], v[56:59], v[76:79], v[80:83]
    v_mfma_f32_16x16x32_bf16 v[84:87], v[44:47], v[68:71], v[84:87]
    buffer_store_dwordx4 v[64:67], v10, s[4:7], s45 offen offset:192 sc1
    v_mfma_f32_16x16x32_bf16 v[84:87], v[52:55], v[72:75], v[84:87]
    v_mfma_f32_16x16x32_bf16 v[84:87], v[60:63], v[76:79], v[84:87]
    v_mfma_f32_16x16x32_bf16 v[88:91], v[68:71], v[68:71], v[88:91]
    v_mfma_f32_16x16x32_bf16 v[88:91], v[72:75], v[72:75], v[88:91]
    buffer_store_dwordx2 v[18:19], v11, s[4:7], s51 offen offset:3584 sc1
    v_mfma_f32_16x16x32_bf16 v[88:91], v[76:79], v[76:79], v[88:91]
    v_mfma_f32_32x32x4_2b_bf16 v[32:63], v[14:15], v[14:15], 0
    s_nop 0
    v_max3_f32 v4, v80, v81, v82
    s_nop 1
    v_max3_f32 v4, v4, v83, v84
    v_max3_f32 v4, v4, v85, v86
    v_max_f32 v4, v4, v87
    v_max3_f32 v90, v4, v88, v89
    v_max3_f32 v4, v4, v88, v89
    s_nop 1
    v_permlane16_swap_b32 v4, v90
    v_max_f32 v4, v4, v90
    v_max_f32 v90, v4, v90
    s_nop 1
    v_permlane32_swap_b32 v4, v90
    v_max_f32 v4, v4, v90
    v_mul_f32 v4, s34, v4
    v_pk_fma_f32 v[80:81], v[80:81], s[34:35], v[4:5] op_sel_hi:[1,0,0] neg_lo:[0,0,1] neg_hi:[0,0,1]
    v_pk_fma_f32 v[82:83], v[82:83], s[34:35], v[4:5] op_sel_hi:[1,0,0] neg_lo:[0,0,1] neg_hi:[0,0,1]
    v_pk_fma_f32 v[84:85], v[84:85], s[34:35], v[4:5] op_sel_hi:[1,0,0] neg_lo:[0,0,1] neg_hi:[0,0,1]
    v_pk_fma_f32 v[86:87], v[86:87], s[34:35], v[4:5] op_sel_hi:[1,0,0] neg_lo:[0,0,1] neg_hi:[0,0,1]
    v_pk_fma_f32 v[88:89], v[88:89], s[34:35], v[4:5] op_sel_hi:[1,0,0] neg_lo:[0,0,1] neg_hi:[0,0,1]
    v_exp_f32 v80, v80
    v_exp_f32 v81, v81
    v_exp_f32 v82, v82
    v_cvt_pk_bf16_f32 v68, v80, v81
    v_exp_f32 v83, v83
    v_exp_f32 v84, v84
    v_cvt_pk_bf16_f32 v69, v82, v83
    v_exp_f32 v85, v85
    v_exp_f32 v86, v86
    v_cvt_pk_bf16_f32 v70, v84, v85
    v_exp_f32 v87, v87
    v_exp_f32 v88, v88
    v_cvt_pk_bf16_f32 v71, v86, v87
    v_exp_f32 v89, v89
    s_waitcnt vmcnt(3)
    v_mfma_f32_16x16x32_bf16 v[76:79], v[28:31], v[68:71], 0
    v_and_b32 v3, 1, v116
    v_cvt_pk_bf16_f32 v72, v88, v89
    v_mfma_f32_16x16x32_bf16 v[100:103], v[120:123], v[68:71], 0
    v_cmp_ne_u32 vcc, s41, v3
    v_cvt_pk_bf16_f32 v73, v88, v89
    v_mfma_f32_16x16x32_bf16 v[104:107], v[124:127], v[68:71], 0
    v_mov_b32 v113, v116
    v_mov_b32 v115, v117
    v_mfma_f32_16x16x16_bf16 v[76:79], v[92:93], v[72:73], v[76:79]
    s_cbranch_vccnz mega_kernel_rs_w3_pv0
mega_kernel_rs_w3_pv2:
    v_mfma_f32_16x16x16_bf16 v[100:103], v[112:113], v[72:73], v[100:103]
    v_mfma_f32_16x16x16_bf16 v[104:107], v[114:115], v[72:73], v[104:107]
    buffer_load_dwordx4 v[120:123], v1, s[4:7], s44 offen
    buffer_load_dwordx4 v[124:127], v1, s[4:7], s44 offen offset:1024
    s_nop 2
    v_rcp_f32 v76, v76
    s_mov_b64 exec, s[28:29]
    v_pk_mul_f32 v[100:101], v[100:101], v[76:77] op_sel_hi:[1,0]
    v_pk_mul_f32 v[102:103], v[102:103], v[76:77] op_sel_hi:[1,0]
    v_pk_mul_f32 v[104:105], v[104:105], v[76:77] op_sel_hi:[1,0]
    v_pk_mul_f32 v[106:107], v[106:107], v[76:77] op_sel_hi:[1,0]
    v_cvt_pk_bf16_f32 v84, v100, v101
    v_cvt_pk_bf16_f32 v85, v102, v103
    v_cvt_pk_bf16_f32 v86, v104, v105
    v_cvt_pk_bf16_f32 v87, v106, v107
    ds_write_b128 v6, v[84:87] offset:29696
    s_mov_b64 exec, -1
    s_waitcnt lgkmcnt(0)
    s_barrier
    ds_read_b128 v[68:71], v6 offset:28672
    ds_read_b128 v[72:75], v6 offset:29696
    s_waitcnt lgkmcnt(1)
    v_smfmac_f32_16x16x64_bf16 v[32:35], v[68:71], v[128:135], v2
    s_add_u32 s21, s21, 1
    s_xor_b32 s38, s38, 1048576
    s_xor_b32 s37, s37, 1048576
    s_waitcnt lgkmcnt(0)
    v_smfmac_f32_16x16x64_bf16 v[32:35], v[72:75], v[136:143], v2
    s_xor_b32 s40, s40, 1048576
    s_xor_b32 s39, s39, 1048576
    s_lshr_b32 s41, s21, 1
    v_smfmac_f32_16x16x64_bf16 v[36:39], v[68:71], v[144:151], v2
    s_and_b32 s41, s41, 1
    s_xor_b32 s41, s41, 1
    s_xor_b32 s35, s35, 16384
    v_smfmac_f32_16x16x64_bf16 v[36:39], v[72:75], v[152:159], v2
    v_add_f32 v32, v32, v34
    s_xor_b32 s36, s36, 16384
    s_add_u32 s43, s43, 262144
    s_add_u32 s44, s44, 262144
    v_smfmac_f32_16x16x64_bf16 v[40:43], v[68:71], v[160:167], v2
    v_add_f32 v33, v33, v35
    v_smfmac_f32_16x16x64_bf16 v[40:43], v[72:75], v[168:175], v2
    v_cvt_pk_bf16_f32 v32, v32, v33
    v_smfmac_f32_16x16x64_bf16 v[44:47], v[68:71], v[176:183], v2
    v_and_or_b32 v32, v32, -2, s42
    v_smfmac_f32_16x16x64_bf16 v[44:47], v[72:75], v[184:191], v2
    v_add_f32 v36, v36, v38
    v_smfmac_f32_16x16x64_bf16 v[48:51], v[68:71], v[192:199], v2
    v_add_f32 v37, v37, v39
    v_smfmac_f32_16x16x64_bf16 v[48:51], v[72:75], v[200:207], v2
    v_cvt_pk_bf16_f32 v33, v36, v37
    v_smfmac_f32_16x16x64_bf16 v[52:55], v[68:71], v[208:215], v2
    v_add_f32 v40, v40, v42
    v_smfmac_f32_16x16x64_bf16 v[52:55], v[72:75], v[216:223], v2
    v_add_f32 v41, v41, v43
    v_smfmac_f32_16x16x64_bf16 v[56:59], v[68:71], v[224:231], v2
    v_cvt_pk_bf16_f32 v34, v40, v41
    v_smfmac_f32_16x16x64_bf16 v[56:59], v[72:75], v[232:239], v2
    v_add_f32 v44, v44, v46
    v_smfmac_f32_16x16x64_bf16 v[60:63], v[68:71], v[240:247], v2
    v_add_f32 v45, v45, v47
    v_smfmac_f32_16x16x64_bf16 v[60:63], v[72:75], v[248:255], v2
    v_cvt_pk_bf16_f32 v35, v44, v45
    buffer_store_dwordx4 v[32:35], v8, s[4:7], s46 offen sc1
    v_pk_add_f32 v[48:49], v[48:49], v[50:51]
    v_cvt_pk_bf16_f32 v48, v48, v49
    v_and_or_b32 v48, v48, -2, s42
    v_pk_add_f32 v[52:53], v[52:53], v[54:55]
    v_cvt_pk_bf16_f32 v49, v52, v53
    v_pk_add_f32 v[56:57], v[56:57], v[58:59]
    v_cvt_pk_bf16_f32 v50, v56, v57
    v_pk_add_f32 v[60:61], v[60:61], v[62:63]
    v_cvt_pk_bf16_f32 v51, v60, v61
    buffer_store_dwordx4 v[48:51], v8, s[4:7], s61 offen sc1
    s_add_u32 s45, s45, 262144
    s_add_u32 s51, s51, 262144
    v_mfma_f32_32x32x8_bf16 v[96:111], v[14:15], v[14:15], 0
    v_mfma_f32_16x16x16_bf16 v[112:115], v[14:15], v[14:15], 0
    v_mfma_f32_16x16x16_bf16 v[116:119], v[14:15], v[14:15], 0
    ds_read_b128 v[64:67], v1 offset:12288
    ds_read_b128 v[68:71], v1 offset:13312
    ds_read_b128 v[72:75], v1 offset:14336
    ds_read_b128 v[76:79], v1 offset:15360
    ds_read_b128 v[80:83], v1 offset:28672
    ds_read_b128 v[84:87], v1 offset:29696
    ds_read_b128 v[88:91], v1 offset:30720
    ds_read_b128 v[92:95], v1 offset:31744
    s_add_u32 s22, s21, 2
    s_cmp_gt_u32 s50, s22
    s_cbranch_scc1 mega_kernel_rs_w3_kvs
    v_readlane_b32 s50, v12, 0
    v_readlane_b32 s22, v12, 2
    v_readlane_b32 s23, v12, 1
    v_readlane_b32 s24, v12, 3
    s_nop 3
    s_min_u32 s50, s50, s22
    s_min_u32 s23, s23, s24
    s_lshl_b32 s50, s50, 1
    s_lshl_b32 s23, s23, 1
    s_add_u32 s23, s23, 1
    s_min_u32 s50, s50, s23
mega_kernel_rs_kvb1:
    s_add_u32 s22, s21, 1
    s_min_u32 s22, s22, 63
    s_cmp_gt_u32 s50, s22
    s_cbranch_scc1 mega_kernel_rs_kvd1
    buffer_load_dword v12, v7, s[4:7], 0 offen sc1
    s_waitcnt vmcnt(0)
    v_readlane_b32 s50, v12, 0
    v_readlane_b32 s22, v12, 2
    v_readlane_b32 s23, v12, 1
    v_readlane_b32 s24, v12, 3
    s_nop 3
    s_min_u32 s50, s50, s22
    s_min_u32 s23, s23, s24
    s_lshl_b32 s50, s50, 1
    s_lshl_b32 s23, s23, 1
    s_add_u32 s23, s23, 1
    s_min_u32 s50, s50, s23
    s_branch mega_kernel_rs_kvb1
mega_kernel_rs_kvd1:
mega_kernel_rs_w3_kvs:
    v_mov_b32 v58, -1
    v_mov_b32 v59, -1
    s_waitcnt vmcnt(0)
mega_kernel_rs_w3_cgo:
mega_kernel_rs_w3_pc:
    buffer_load_dword v36, v13, s[4:7], s25 offen offset:0 sc1
    buffer_load_dword v37, v13, s[4:7], s25 offen offset:256 sc1
    buffer_load_dword v38, v13, s[4:7], s25 offen offset:512 sc1
    buffer_load_dword v39, v13, s[4:7], s25 offen offset:768 sc1
    buffer_load_dword v40, v13, s[4:7], s25 offen offset:1024 sc1
    buffer_load_dword v41, v13, s[4:7], s25 offen offset:1280 sc1
    buffer_load_dword v42, v13, s[4:7], s25 offen offset:1536 sc1
    buffer_load_dword v43, v13, s[4:7], s25 offen offset:1792 sc1
    s_waitcnt vmcnt(4)
    v_mfma_f32_16x16x32_bf16 v[52:55], v[36:39], v[24:27], 0
    v_bitop3_b32 v3, s42, v36, v37 bitop3:0x7e
    v_bitop3_b32 v4, s42, v38, v39 bitop3:0x7e
    s_waitcnt vmcnt(2)
    v_or_b32 v3, v3, v4
    v_bitop3_b32 v4, s42, v40, v41 bitop3:0x7e
    s_waitcnt vmcnt(0)
    v_mfma_f32_16x16x32_bf16 v[52:55], v[40:43], v[24:27], v[52:55]
    v_bitop3_b32 v56, s42, v42, v43 bitop3:0x7e
    v_or3_b32 v3, v3, v4, v56
    v_and_b32 v3, v0, v3
    v_cmp_ne_u32 vcc, 0, v3
    s_nop 3
    v_cvt_pk_bf16_f32 v56, v52, v53
    v_cvt_pk_bf16_f32 v57, v54, v55
    v_min_u32 v56, -2, v56
    s_cbranch_vccnz mega_kernel_rs_w3_pc
    s_mov_b64 exec, s[26:27]
    buffer_store_dwordx2 v[56:57], v9, s[4:7], s35 offen offset:768 sc1
    buffer_store_dwordx2 v[58:59], v9, s[4:7], s36 offen offset:768 sc1
    s_mov_b64 exec, -1
    s_xor_b32 s42, s42, 1
    s_branch mega_kernel_rs_w3_loop
mega_kernel_rs_w3_last:
    buffer_store_dwordx4 v[64:67], v10, s[4:7], s45 offen offset:192 sc1
    buffer_store_dwordx2 v[18:19], v11, s[4:7], s51 offen offset:3584 sc1
    s_branch mega_kernel_rs_end
mega_kernel_rs_w3_pafail:
    s_nop 7
    v_mov_b32 v96, 0
    v_mov_b32 v97, 0
    v_mov_b32 v98, 0
    v_mov_b32 v99, 0
    v_mov_b32 v100, 0
    v_mov_b32 v101, 0
    v_mov_b32 v102, 0
    v_mov_b32 v103, 0
    v_mov_b32 v104, 0
    v_mov_b32 v105, 0
    v_mov_b32 v106, 0
    v_mov_b32 v107, 0
    s_branch mega_kernel_rs_w3_pa
mega_kernel_rs_w3_xslow:
    buffer_load_dwordx2 v[108:109], v11, s[4:7], s38 offen sc1
    buffer_load_dwordx2 v[110:111], v11, s[4:7], s38 offen offset:512 sc1
    s_waitcnt vmcnt(2)
    v_bitop3_b32 v3, s41, v20, v22 bitop3:0x7e
    v_mfma_f32_16x16x16_bf16 v[80:83], v[20:21], v[16:17], v[100:103]
    v_and_b32 v3, 1, v3
    v_mfma_f32_16x16x16_bf16 v[84:87], v[22:23], v[16:17], v[104:107]
    v_cmp_ne_u32 vcc, 0, v3
    s_cbranch_vccz mega_kernel_rs_w3_xgot
    buffer_load_dwordx2 v[20:21], v11, s[4:7], s38 offen sc1
    buffer_load_dwordx2 v[22:23], v11, s[4:7], s38 offen offset:512 sc1
    s_waitcnt vmcnt(2)
    v_bitop3_b32 v3, s41, v108, v110 bitop3:0x7e
    v_mfma_f32_16x16x16_bf16 v[80:83], v[108:109], v[16:17], v[100:103]
    v_and_b32 v3, 1, v3
    v_mfma_f32_16x16x16_bf16 v[84:87], v[110:111], v[16:17], v[104:107]
    v_cmp_ne_u32 vcc, 0, v3
    s_cbranch_vccz mega_kernel_rs_w3_xgot
    s_branch mega_kernel_rs_w3_xslow
mega_kernel_rs_w3_xgot:
    s_nop 3
    v_cvt_pk_bf16_f32 v64, v80, v81
    v_cvt_pk_bf16_f32 v65, v82, v83
    v_cvt_pk_bf16_f32 v66, v84, v85
    v_cvt_pk_bf16_f32 v67, v86, v87
    ds_write_b128 v6, v[64:67] offset:23552
    s_branch mega_kernel_rs_w3_xok
mega_kernel_rs_w3_pv0:
    s_waitcnt vmcnt(2)
    s_branch mega_kernel_rs_w3_pv1
mega_kernel_rs_w3_pv:
    buffer_load_dwordx2 v[20:21], v11, s[4:7], s40 offen sc1
    s_waitcnt vmcnt(0)
mega_kernel_rs_w3_pv1:
    v_and_b32 v3, 1, v20
    v_cmp_ne_u32 vcc, s41, v3
    v_mov_b32 v113, v20
    v_mov_b32 v115, v21
    s_cbranch_vccnz mega_kernel_rs_w3_pv
    s_branch mega_kernel_rs_w3_pv2
mega_kernel_rs_end:
    s_mov_b64 exec, -1
    v_mov_b32 v3, 64
    s_waitcnt vmcnt(0)
    s_barrier
    s_cmp_lg_u32 s20, 0
    s_cbranch_scc1 mega_kernel_rs_end2
    buffer_store_dword v3, v7, s[4:7], 0 offen sc1
mega_kernel_rs_end2:
    s_waitcnt vmcnt(0)
    s_endpgm
mega_kernel_bulk:
    s_load_dwordx2 s[8:9], s[0:1], 0
    s_load_dwordx2 s[40:41], s[0:1], 16
    s_load_dwordx2 s[42:43], s[0:1], 24
    s_load_dwordx2 s[44:45], s[0:1], 32
    v_lshrrev_b32 v2, 6, v0
    v_and_b32 v1, 63, v0
    v_readfirstlane_b32 s16, v2
    s_lshr_b32 s17, s92, 6
    s_bfe_u32 s18, s92, 0x50001
    s_and_b32 s19, s92, 1
    s_waitcnt lgkmcnt(0)
    s_mov_b32 s10, 4194304
    s_mov_b32 s11, 0x00020000
    s_cmp_eq_u32 s17, 1
    s_cselect_b32 s12, s42, s40
    s_cselect_b32 s13, s43, s41
    s_cmp_eq_u32 s17, 2
    s_cselect_b32 s12, s44, s12
    s_cselect_b32 s13, s45, s13
    s_mov_b32 s14, 8388608
    s_mov_b32 s15, 0x00020000
    v_lshrrev_b32 v2, 4, v1
    v_and_b32 v3, 15, v1
    v_lshlrev_b32 v4, 2, v2
    v_xor_b32 v4, v4, v3
    v_lshlrev_b32 v4, 4, v4
    s_lshl_b32 s20, s16, 5
    v_add_u32 v11, s20, v2
    v_lshl_add_u32 v11, v11, 13, v4
    s_lshl_b32 s20, s18, 8
    v_add_u32 v11, s20, v11
    s_lshl_b32 s22, s16, 13
    s_lshl_b32 s27, s19, 23
    s_and_b32 s27, s27, 4194304
    s_add_u32 m0, s22, 0
    s_xor_b32 s20, s27, 0
    buffer_load_dwordx4 v11, s[12:15], s20 offen lds
    s_add_u32 m0, s22, 1024
    s_xor_b32 s20, s27, 32768
    buffer_load_dwordx4 v11, s[12:15], s20 offen lds
    s_add_u32 m0, s22, 2048
    s_xor_b32 s20, s27, 65536
    buffer_load_dwordx4 v11, s[12:15], s20 offen lds
    s_add_u32 m0, s22, 3072
    s_xor_b32 s20, s27, 98304
    buffer_load_dwordx4 v11, s[12:15], s20 offen lds
    s_add_u32 m0, s22, 4096
    s_xor_b32 s20, s27, 131072
    buffer_load_dwordx4 v11, s[12:15], s20 offen lds
    s_add_u32 m0, s22, 5120
    s_xor_b32 s20, s27, 163840
    buffer_load_dwordx4 v11, s[12:15], s20 offen lds
    s_add_u32 m0, s22, 6144
    s_xor_b32 s20, s27, 196608
    buffer_load_dwordx4 v11, s[12:15], s20 offen lds
    s_add_u32 m0, s22, 7168
    s_xor_b32 s20, s27, 229376
    buffer_load_dwordx4 v11, s[12:15], s20 offen lds
    s_waitcnt vmcnt(8)
    s_barrier
    s_or_b32 s81, s97, s98
    s_cmp_lg_u32 s81, 0
    s_cbranch_scc1 mega_kernel_h0_3
    s_lshl_b32 s81, s93, 5
    v_mov_b32 v38, 1
    s_mov_b64 exec, 1
    buffer_atomic_add v38, off, s[88:91], s81 sc1
    s_mov_b64 exec, -1
mega_kernel_h0_3:
    s_add_u32 m0, s22, 32768
    s_xor_b32 s20, s27, 1048576
    buffer_load_dwordx4 v11, s[12:15], s20 offen lds
    s_add_u32 m0, s22, 33792
    s_xor_b32 s20, s27, 1081344
    buffer_load_dwordx4 v11, s[12:15], s20 offen lds
    s_add_u32 m0, s22, 34816
    s_xor_b32 s20, s27, 1114112
    buffer_load_dwordx4 v11, s[12:15], s20 offen lds
    s_add_u32 m0, s22, 35840
    s_xor_b32 s20, s27, 1146880
    buffer_load_dwordx4 v11, s[12:15], s20 offen lds
    s_add_u32 m0, s22, 36864
    s_xor_b32 s20, s27, 1179648
    buffer_load_dwordx4 v11, s[12:15], s20 offen lds
    s_add_u32 m0, s22, 37888
    s_xor_b32 s20, s27, 1212416
    buffer_load_dwordx4 v11, s[12:15], s20 offen lds
    s_add_u32 m0, s22, 38912
    s_xor_b32 s20, s27, 1245184
    buffer_load_dwordx4 v11, s[12:15], s20 offen lds
    s_add_u32 m0, s22, 39936
    s_xor_b32 s20, s27, 1277952
    buffer_load_dwordx4 v11, s[12:15], s20 offen lds
    s_add_u32 m0, s22, 65536
    s_xor_b32 s20, s27, 2097152
    buffer_load_dwordx4 v11, s[12:15], s20 offen lds
    s_add_u32 m0, s22, 66560
    s_xor_b32 s20, s27, 2129920
    buffer_load_dwordx4 v11, s[12:15], s20 offen lds
    s_add_u32 m0, s22, 67584
    s_xor_b32 s20, s27, 2162688
    buffer_load_dwordx4 v11, s[12:15], s20 offen lds
    s_add_u32 m0, s22, 68608
    s_xor_b32 s20, s27, 2195456
    buffer_load_dwordx4 v11, s[12:15], s20 offen lds
    s_add_u32 m0, s22, 69632
    s_xor_b32 s20, s27, 2228224
    buffer_load_dwordx4 v11, s[12:15], s20 offen lds
    s_add_u32 m0, s22, 70656
    s_xor_b32 s20, s27, 2260992
    buffer_load_dwordx4 v11, s[12:15], s20 offen lds
    s_add_u32 m0, s22, 71680
    s_xor_b32 s20, s27, 2293760
    buffer_load_dwordx4 v11, s[12:15], s20 offen lds
    s_add_u32 m0, s22, 72704
    s_xor_b32 s20, s27, 2326528
    buffer_load_dwordx4 v11, s[12:15], s20 offen lds
    s_add_u32 m0, s22, 98304
    s_xor_b32 s20, s27, 3145728
    buffer_load_dwordx4 v11, s[12:15], s20 offen lds
    s_add_u32 m0, s22, 99328
    s_xor_b32 s20, s27, 3178496
    buffer_load_dwordx4 v11, s[12:15], s20 offen lds
    s_add_u32 m0, s22, 100352
    s_xor_b32 s20, s27, 3211264
    buffer_load_dwordx4 v11, s[12:15], s20 offen lds
    s_add_u32 m0, s22, 101376
    s_xor_b32 s20, s27, 3244032
    buffer_load_dwordx4 v11, s[12:15], s20 offen lds
    s_add_u32 m0, s22, 102400
    s_xor_b32 s20, s27, 3276800
    buffer_load_dwordx4 v11, s[12:15], s20 offen lds
    s_add_u32 m0, s22, 103424
    s_xor_b32 s20, s27, 3309568
    buffer_load_dwordx4 v11, s[12:15], s20 offen lds
    s_add_u32 m0, s22, 104448
    s_xor_b32 s20, s27, 3342336
    buffer_load_dwordx4 v11, s[12:15], s20 offen lds
    s_add_u32 m0, s22, 105472
    s_xor_b32 s20, s27, 3375104
    buffer_load_dwordx4 v11, s[12:15], s20 offen lds
    v_and_b32 v3, 3, v1
    v_bfe_u32 v4, v1, 4, 1
    v_lshl_add_u32 v13, v3, 1, v4
    v_and_b32 v14, 1, v3
    v_lshlrev_b32 v14, 1, v14
    v_lshrrev_b32 v15, 1, v3
    v_add_u32 v14, v14, v15
    v_lshl_add_u32 v14, v4, 2, v14
    s_cmp_eq_u32 s17, 2
    s_cselect_b64 vcc, -1, 0
    v_cndmask_b32 v13, v14, v13, vcc
    v_bfe_u32 v14, v1, 2, 2
    v_xor_b32 v15, s16, v14
    v_lshlrev_b32 v15, 6, v15
    v_lshl_add_u32 v15, v13, 3, v15
    v_lshrrev_b32 v13, 5, v1
    v_lshl_add_u32 v13, v13, 3, v14
    v_lshl_add_u32 v12, v13, 8, v15
    v_and_b32 v3, 15, v1
    s_lshl_b32 s20, s16, 3
    v_add_u32 v13, s20, v2
    v_add_u32 v13, 0, v13
    v_and_b32 v14, 15, v13
    v_xor_b32 v14, v14, v3
    v_lshlrev_b32 v14, 4, v14
    v_lshl_add_u32 v6, v13, 11, v14
    v_add_u32 v13, s20, v2
    v_add_u32 v13, 4, v13
    v_and_b32 v14, 15, v13
    v_xor_b32 v14, v14, v3
    v_lshlrev_b32 v14, 4, v14
    v_lshl_add_u32 v7, v13, 11, v14
    v_and_b32 v13, 31, v1
    v_lshrrev_b32 v14, 5, v1
    v_xor_b32 v14, v14, v3
    v_lshlrev_b32 v14, 4, v14
    v_lshl_add_u32 v13, v13, 8, v14
    v_xor_b32 v16, 0, v13
    v_add_u32 v24, 0x10000, v16
    v_xor_b32 v17, 32, v13
    v_add_u32 v25, 0x10000, v17
    v_xor_b32 v18, 64, v13
    v_add_u32 v26, 0x10000, v18
    v_xor_b32 v19, 96, v13
    v_add_u32 v27, 0x10000, v19
    v_xor_b32 v20, 128, v13
    v_add_u32 v28, 0x10000, v20
    v_xor_b32 v21, 160, v13
    v_add_u32 v29, 0x10000, v21
    v_xor_b32 v22, 192, v13
    v_add_u32 v30, 0x10000, v22
    v_xor_b32 v23, 224, v13
    v_add_u32 v31, 0x10000, v23
    v_bfe_u32 v13, v1, 4, 1
    v_lshlrev_b32 v8, 10, v13
    v_lshrrev_b32 v13, 5, v1
    v_lshl_add_u32 v8, v13, 8, v8
    v_lshl_add_u32 v8, v3, 4, v8
    v_bfrev_b32 v13, 1
    s_lshl_b32 s20, s92, 7
    s_add_u32 s20, s20, 71303168
    v_mov_b32 v14, s20
    v_cmp_eq_u32 vcc, 0, v0
    s_lshl_b32 s24, s17, 24
    s_lshl_b32 s20, s19, 18
    v_cndmask_b32 v9, v13, v14, vcc
    s_add_u32 s24, s24, s20
    s_lshl_b32 s20, s18, 13
    s_add_u32 s24, s24, s20
    s_lshl_b32 s20, s16, 11
    s_add_u32 s24, s24, s20
    s_add_u32 s24, s24, 0
    s_lshl_b32 s23, s19, 16
    s_lshr_b32 s20, s27, 12
    s_add_u32 s23, s23, s20
    v_mov_b32 v10, 0
    s_lshl_b32 s21, s16, 11
    s_waitcnt vmcnt(24)
    s_barrier
    v_add_u32 v13, 0, v12
    ds_read_b64_tr_b16 a[0:1], v13 offset:0
    ds_read_b64_tr_b16 a[2:3], v13 offset:1024
    ds_read_b64_tr_b16 a[4:5], v13 offset:4096
    ds_read_b64_tr_b16 a[6:7], v13 offset:5120
    ds_read_b64_tr_b16 a[8:9], v13 offset:8192
    ds_read_b64_tr_b16 a[10:11], v13 offset:9216
    ds_read_b64_tr_b16 a[12:13], v13 offset:12288
    ds_read_b64_tr_b16 a[14:15], v13 offset:13312
    s_waitcnt lgkmcnt(0)
    ds_read_b64_tr_b16 a[16:17], v13 offset:16384
    ds_read_b64_tr_b16 a[18:19], v13 offset:17408
    ds_read_b64_tr_b16 a[20:21], v13 offset:20480
    ds_read_b64_tr_b16 a[22:23], v13 offset:21504
    ds_read_b64_tr_b16 a[24:25], v13 offset:24576
    ds_read_b64_tr_b16 a[26:27], v13 offset:25600
    ds_read_b64_tr_b16 a[28:29], v13 offset:28672
    ds_read_b64_tr_b16 a[30:31], v13 offset:29696
    s_waitcnt lgkmcnt(0)
    s_barrier
    s_add_u32 m0, s22, 0
    s_xor_b32 s20, s27, 4194304
    buffer_load_dwordx4 v11, s[12:15], s20 offen lds
    s_add_u32 m0, s22, 1024
    s_xor_b32 s20, s27, 4227072
    buffer_load_dwordx4 v11, s[12:15], s20 offen lds
    s_add_u32 m0, s22, 2048
    s_xor_b32 s20, s27, 4259840
    buffer_load_dwordx4 v11, s[12:15], s20 offen lds
    s_add_u32 m0, s22, 3072
    s_xor_b32 s20, s27, 4292608
    buffer_load_dwordx4 v11, s[12:15], s20 offen lds
    s_add_u32 m0, s22, 4096
    s_xor_b32 s20, s27, 4325376
    buffer_load_dwordx4 v11, s[12:15], s20 offen lds
    s_add_u32 m0, s22, 5120
    s_xor_b32 s20, s27, 4358144
    buffer_load_dwordx4 v11, s[12:15], s20 offen lds
    s_add_u32 m0, s22, 6144
    s_xor_b32 s20, s27, 4390912
    buffer_load_dwordx4 v11, s[12:15], s20 offen lds
    s_add_u32 m0, s22, 7168
    s_xor_b32 s20, s27, 4423680
    buffer_load_dwordx4 v11, s[12:15], s20 offen lds
    s_waitcnt vmcnt(24)
    s_barrier
    v_add_u32 v13, 32768, v12
    ds_read_b64_tr_b16 a[32:33], v13 offset:0
    ds_read_b64_tr_b16 a[34:35], v13 offset:1024
    ds_read_b64_tr_b16 a[36:37], v13 offset:4096
    ds_read_b64_tr_b16 a[38:39], v13 offset:5120
    ds_read_b64_tr_b16 a[40:41], v13 offset:8192
    ds_read_b64_tr_b16 a[42:43], v13 offset:9216
    ds_read_b64_tr_b16 a[44:45], v13 offset:12288
    ds_read_b64_tr_b16 a[46:47], v13 offset:13312
    s_waitcnt lgkmcnt(0)
    ds_read_b64_tr_b16 a[48:49], v13 offset:16384
    ds_read_b64_tr_b16 a[50:51], v13 offset:17408
    ds_read_b64_tr_b16 a[52:53], v13 offset:20480
    ds_read_b64_tr_b16 a[54:55], v13 offset:21504
    ds_read_b64_tr_b16 a[56:57], v13 offset:24576
    ds_read_b64_tr_b16 a[58:59], v13 offset:25600
    ds_read_b64_tr_b16 a[60:61], v13 offset:28672
    ds_read_b64_tr_b16 a[62:63], v13 offset:29696
    s_waitcnt lgkmcnt(0)
    s_barrier
    s_add_u32 m0, s22, 32768
    s_xor_b32 s20, s27, 5242880
    buffer_load_dwordx4 v11, s[12:15], s20 offen lds
    s_add_u32 m0, s22, 33792
    s_xor_b32 s20, s27, 5275648
    buffer_load_dwordx4 v11, s[12:15], s20 offen lds
    s_add_u32 m0, s22, 34816
    s_xor_b32 s20, s27, 5308416
    buffer_load_dwordx4 v11, s[12:15], s20 offen lds
    s_add_u32 m0, s22, 35840
    s_xor_b32 s20, s27, 5341184
    buffer_load_dwordx4 v11, s[12:15], s20 offen lds
    s_add_u32 m0, s22, 36864
    s_xor_b32 s20, s27, 5373952
    buffer_load_dwordx4 v11, s[12:15], s20 offen lds
    s_add_u32 m0, s22, 37888
    s_xor_b32 s20, s27, 5406720
    buffer_load_dwordx4 v11, s[12:15], s20 offen lds
    s_add_u32 m0, s22, 38912
    s_xor_b32 s20, s27, 5439488
    buffer_load_dwordx4 v11, s[12:15], s20 offen lds
    s_add_u32 m0, s22, 39936
    s_xor_b32 s20, s27, 5472256
    buffer_load_dwordx4 v11, s[12:15], s20 offen lds
    s_waitcnt vmcnt(24)
    s_barrier
    v_add_u32 v13, 65536, v12
    ds_read_b64_tr_b16 a[64:65], v13 offset:0
    ds_read_b64_tr_b16 a[66:67], v13 offset:1024
    ds_read_b64_tr_b16 a[68:69], v13 offset:4096
    ds_read_b64_tr_b16 a[70:71], v13 offset:5120
    ds_read_b64_tr_b16 a[72:73], v13 offset:8192
    ds_read_b64_tr_b16 a[74:75], v13 offset:9216
    ds_read_b64_tr_b16 a[76:77], v13 offset:12288
    ds_read_b64_tr_b16 a[78:79], v13 offset:13312
    s_waitcnt lgkmcnt(0)
    ds_read_b64_tr_b16 a[80:81], v13 offset:16384
    ds_read_b64_tr_b16 a[82:83], v13 offset:17408
    ds_read_b64_tr_b16 a[84:85], v13 offset:20480
    ds_read_b64_tr_b16 a[86:87], v13 offset:21504
    ds_read_b64_tr_b16 a[88:89], v13 offset:24576
    ds_read_b64_tr_b16 a[90:91], v13 offset:25600
    ds_read_b64_tr_b16 a[92:93], v13 offset:28672
    ds_read_b64_tr_b16 a[94:95], v13 offset:29696
    s_waitcnt lgkmcnt(0)
    s_barrier
    s_add_u32 m0, s22, 65536
    s_xor_b32 s20, s27, 6291456
    buffer_load_dwordx4 v11, s[12:15], s20 offen lds
    s_add_u32 m0, s22, 66560
    s_xor_b32 s20, s27, 6324224
    buffer_load_dwordx4 v11, s[12:15], s20 offen lds
    s_add_u32 m0, s22, 67584
    s_xor_b32 s20, s27, 6356992
    buffer_load_dwordx4 v11, s[12:15], s20 offen lds
    s_add_u32 m0, s22, 68608
    s_xor_b32 s20, s27, 6389760
    buffer_load_dwordx4 v11, s[12:15], s20 offen lds
    s_add_u32 m0, s22, 69632
    s_xor_b32 s20, s27, 6422528
    buffer_load_dwordx4 v11, s[12:15], s20 offen lds
    s_add_u32 m0, s22, 70656
    s_xor_b32 s20, s27, 6455296
    buffer_load_dwordx4 v11, s[12:15], s20 offen lds
    s_add_u32 m0, s22, 71680
    s_xor_b32 s20, s27, 6488064
    buffer_load_dwordx4 v11, s[12:15], s20 offen lds
    s_add_u32 m0, s22, 72704
    s_xor_b32 s20, s27, 6520832
    buffer_load_dwordx4 v11, s[12:15], s20 offen lds
    s_waitcnt vmcnt(24)
    s_barrier
    v_and_b32 v37, 7, v0
    v_lshlrev_b32 v37, 5, v37
    buffer_load_dword v36, v37, s[88:91], 0 offen sc1
    v_add_u32 v13, 98304, v12
    ds_read_b64_tr_b16 a[96:97], v13 offset:0
    ds_read_b64_tr_b16 a[98:99], v13 offset:1024
    ds_read_b64_tr_b16 a[100:101], v13 offset:4096
    ds_read_b64_tr_b16 a[102:103], v13 offset:5120
    ds_read_b64_tr_b16 a[104:105], v13 offset:8192
    ds_read_b64_tr_b16 a[106:107], v13 offset:9216
    ds_read_b64_tr_b16 a[108:109], v13 offset:12288
    ds_read_b64_tr_b16 a[110:111], v13 offset:13312
    s_waitcnt lgkmcnt(0)
    ds_read_b64_tr_b16 a[112:113], v13 offset:16384
    ds_read_b64_tr_b16 a[114:115], v13 offset:17408
    ds_read_b64_tr_b16 a[116:117], v13 offset:20480
    ds_read_b64_tr_b16 a[118:119], v13 offset:21504
    ds_read_b64_tr_b16 a[120:121], v13 offset:24576
    ds_read_b64_tr_b16 a[122:123], v13 offset:25600
    ds_read_b64_tr_b16 a[124:125], v13 offset:28672
    ds_read_b64_tr_b16 a[126:127], v13 offset:29696
    s_waitcnt lgkmcnt(0)
    s_barrier
    s_add_u32 m0, s22, 98304
    s_xor_b32 s20, s27, 7340032
    buffer_load_dwordx4 v11, s[12:15], s20 offen lds
    s_add_u32 m0, s22, 99328
    s_xor_b32 s20, s27, 7372800
    buffer_load_dwordx4 v11, s[12:15], s20 offen lds
    s_add_u32 m0, s22, 100352
    s_xor_b32 s20, s27, 7405568
    buffer_load_dwordx4 v11, s[12:15], s20 offen lds
    s_add_u32 m0, s22, 101376
    s_xor_b32 s20, s27, 7438336
    buffer_load_dwordx4 v11, s[12:15], s20 offen lds
    s_add_u32 m0, s22, 102400
    s_xor_b32 s20, s27, 7471104
    buffer_load_dwordx4 v11, s[12:15], s20 offen lds
    s_add_u32 m0, s22, 103424
    s_xor_b32 s20, s27, 7503872
    buffer_load_dwordx4 v11, s[12:15], s20 offen lds
    s_add_u32 m0, s22, 104448
    s_xor_b32 s20, s27, 7536640
    buffer_load_dwordx4 v11, s[12:15], s20 offen lds
    s_add_u32 m0, s22, 105472
    s_xor_b32 s20, s27, 7569408
    buffer_load_dwordx4 v11, s[12:15], s20 offen lds
    s_waitcnt vmcnt(24)
    s_barrier
    v_add_u32 v13, 0, v12
    ds_read_b64_tr_b16 a[128:129], v13 offset:0
    ds_read_b64_tr_b16 a[130:131], v13 offset:1024
    ds_read_b64_tr_b16 a[132:133], v13 offset:4096
    ds_read_b64_tr_b16 a[134:135], v13 offset:5120
    ds_read_b64_tr_b16 a[136:137], v13 offset:8192
    ds_read_b64_tr_b16 a[138:139], v13 offset:9216
    ds_read_b64_tr_b16 a[140:141], v13 offset:12288
    ds_read_b64_tr_b16 a[142:143], v13 offset:13312
    s_waitcnt lgkmcnt(0)
    ds_read_b64_tr_b16 a[144:145], v13 offset:16384
    ds_read_b64_tr_b16 a[146:147], v13 offset:17408
    ds_read_b64_tr_b16 a[148:149], v13 offset:20480
    ds_read_b64_tr_b16 a[150:151], v13 offset:21504
    ds_read_b64_tr_b16 a[152:153], v13 offset:24576
    ds_read_b64_tr_b16 a[154:155], v13 offset:25600
    ds_read_b64_tr_b16 a[156:157], v13 offset:28672
    ds_read_b64_tr_b16 a[158:159], v13 offset:29696
    s_waitcnt lgkmcnt(0)
    s_barrier
    s_add_u32 m0, s21, 0
    s_xor_b32 s20, s23, 0
    buffer_load_dwordx4 v6, s[8:11], s20 offen lds
    s_add_u32 m0, s21, 1024
    s_xor_b32 s20, s23, 0
    buffer_load_dwordx4 v7, s[8:11], s20 offen lds
    s_add_u32 m0, s21, 8192
    s_xor_b32 s20, s23, 256
    buffer_load_dwordx4 v6, s[8:11], s20 offen lds
    s_add_u32 m0, s21, 9216
    s_xor_b32 s20, s23, 256
    buffer_load_dwordx4 v7, s[8:11], s20 offen lds
    s_add_u32 m0, s21, 16384
    s_xor_b32 s20, s23, 512
    buffer_load_dwordx4 v6, s[8:11], s20 offen lds
    s_add_u32 m0, s21, 17408
    s_xor_b32 s20, s23, 512
    buffer_load_dwordx4 v7, s[8:11], s20 offen lds
    s_add_u32 m0, s21, 24576
    s_xor_b32 s20, s23, 768
    buffer_load_dwordx4 v6, s[8:11], s20 offen lds
    s_add_u32 m0, s21, 25600
    s_xor_b32 s20, s23, 768
    buffer_load_dwordx4 v7, s[8:11], s20 offen lds
    s_waitcnt vmcnt(24)
    s_barrier
    v_add_u32 v13, 32768, v12
    ds_read_b64_tr_b16 a[160:161], v13 offset:0
    ds_read_b64_tr_b16 a[162:163], v13 offset:1024
    ds_read_b64_tr_b16 a[164:165], v13 offset:4096
    ds_read_b64_tr_b16 a[166:167], v13 offset:5120
    ds_read_b64_tr_b16 a[168:169], v13 offset:8192
    ds_read_b64_tr_b16 a[170:171], v13 offset:9216
    ds_read_b64_tr_b16 a[172:173], v13 offset:12288
    ds_read_b64_tr_b16 a[174:175], v13 offset:13312
    s_waitcnt lgkmcnt(0)
    ds_read_b64_tr_b16 a[176:177], v13 offset:16384
    ds_read_b64_tr_b16 a[178:179], v13 offset:17408
    ds_read_b64_tr_b16 a[180:181], v13 offset:20480
    ds_read_b64_tr_b16 a[182:183], v13 offset:21504
    ds_read_b64_tr_b16 a[184:185], v13 offset:24576
    ds_read_b64_tr_b16 a[186:187], v13 offset:25600
    ds_read_b64_tr_b16 a[188:189], v13 offset:28672
    ds_read_b64_tr_b16 a[190:191], v13 offset:29696
    s_waitcnt lgkmcnt(0)
    s_barrier
    s_add_u32 m0, s21, 32768
    s_xor_b32 s20, s23, 1024
    buffer_load_dwordx4 v6, s[8:11], s20 offen lds
    s_add_u32 m0, s21, 33792
    s_xor_b32 s20, s23, 1024
    buffer_load_dwordx4 v7, s[8:11], s20 offen lds
    s_add_u32 m0, s21, 40960
    s_xor_b32 s20, s23, 1280
    buffer_load_dwordx4 v6, s[8:11], s20 offen lds
    s_add_u32 m0, s21, 41984
    s_xor_b32 s20, s23, 1280
    buffer_load_dwordx4 v7, s[8:11], s20 offen lds
    s_add_u32 m0, s21, 49152
    s_xor_b32 s20, s23, 1536
    buffer_load_dwordx4 v6, s[8:11], s20 offen lds
    s_add_u32 m0, s21, 50176
    s_xor_b32 s20, s23, 1536
    buffer_load_dwordx4 v7, s[8:11], s20 offen lds
    s_add_u32 m0, s21, 57344
    s_xor_b32 s20, s23, 1792
    buffer_load_dwordx4 v6, s[8:11], s20 offen lds
    s_add_u32 m0, s21, 58368
    s_xor_b32 s20, s23, 1792
    buffer_load_dwordx4 v7, s[8:11], s20 offen lds
    s_waitcnt vmcnt(24)
    s_barrier
    v_add_u32 v13, 65536, v12
    ds_read_b64_tr_b16 a[192:193], v13 offset:0
    ds_read_b64_tr_b16 a[194:195], v13 offset:1024
    ds_read_b64_tr_b16 a[196:197], v13 offset:4096
    ds_read_b64_tr_b16 a[198:199], v13 offset:5120
    ds_read_b64_tr_b16 a[200:201], v13 offset:8192
    ds_read_b64_tr_b16 a[202:203], v13 offset:9216
    ds_read_b64_tr_b16 a[204:205], v13 offset:12288
    ds_read_b64_tr_b16 a[206:207], v13 offset:13312
    s_waitcnt lgkmcnt(0)
    ds_read_b64_tr_b16 a[208:209], v13 offset:16384
    ds_read_b64_tr_b16 a[210:211], v13 offset:17408
    ds_read_b64_tr_b16 a[212:213], v13 offset:20480
    ds_read_b64_tr_b16 a[214:215], v13 offset:21504
    ds_read_b64_tr_b16 a[216:217], v13 offset:24576
    ds_read_b64_tr_b16 a[218:219], v13 offset:25600
    ds_read_b64_tr_b16 a[220:221], v13 offset:28672
    ds_read_b64_tr_b16 a[222:223], v13 offset:29696
    s_waitcnt lgkmcnt(0)
    s_barrier
    s_add_u32 s23, s23, 131072
    s_add_u32 m0, s21, 65536
    s_xor_b32 s20, s23, 0
    buffer_load_dwordx4 v6, s[8:11], s20 offen lds
    s_add_u32 m0, s21, 66560
    s_xor_b32 s20, s23, 0
    buffer_load_dwordx4 v7, s[8:11], s20 offen lds
    s_add_u32 m0, s21, 73728
    s_xor_b32 s20, s23, 256
    buffer_load_dwordx4 v6, s[8:11], s20 offen lds
    s_add_u32 m0, s21, 74752
    s_xor_b32 s20, s23, 256
    buffer_load_dwordx4 v7, s[8:11], s20 offen lds
    s_add_u32 m0, s21, 81920
    s_xor_b32 s20, s23, 512
    buffer_load_dwordx4 v6, s[8:11], s20 offen lds
    s_add_u32 m0, s21, 82944
    s_xor_b32 s20, s23, 512
    buffer_load_dwordx4 v7, s[8:11], s20 offen lds
    s_add_u32 m0, s21, 90112
    s_xor_b32 s20, s23, 768
    buffer_load_dwordx4 v6, s[8:11], s20 offen lds
    s_add_u32 m0, s21, 91136
    s_xor_b32 s20, s23, 768
    buffer_load_dwordx4 v7, s[8:11], s20 offen lds
    s_waitcnt vmcnt(24)
    s_barrier
    s_cmp_lg_u32 s97, 0
    s_cbranch_scc1 mega_kernel_h2_4_ok
mega_kernel_h2_4_ev:
    v_cmp_ne_u32 vcc, 32, v36
    s_cbranch_vccz mega_kernel_h2_4_ok
    s_mov_b32 s78, 0
    v_readlane_b32 s81, v36, 0
    s_nop 3
    s_add_u32 s78, s78, s81
    v_readlane_b32 s81, v36, 1
    s_nop 3
    s_add_u32 s78, s78, s81
    v_readlane_b32 s81, v36, 2
    s_nop 3
    s_add_u32 s78, s78, s81
    v_readlane_b32 s81, v36, 3
    s_nop 3
    s_add_u32 s78, s78, s81
    v_readlane_b32 s81, v36, 4
    s_nop 3
    s_add_u32 s78, s78, s81
    v_readlane_b32 s81, v36, 5
    s_nop 3
    s_add_u32 s78, s78, s81
    v_readlane_b32 s81, v36, 6
    s_nop 3
    s_add_u32 s78, s78, s81
    v_readlane_b32 s81, v36, 7
    s_nop 3
    s_add_u32 s78, s78, s81
    s_cmp_eq_u32 s78, 256
    s_cbranch_scc1 mega_kernel_redo
    buffer_load_dword v36, v37, s[88:91], 0 offen sc1
    s_waitcnt vmcnt(0)
    s_branch mega_kernel_h2_4_ev
mega_kernel_h2_4_ok:
    v_add_u32 v13, 98304, v12
    ds_read_b64_tr_b16 a[224:225], v13 offset:0
    ds_read_b64_tr_b16 a[226:227], v13 offset:1024
    ds_read_b64_tr_b16 a[228:229], v13 offset:4096
    ds_read_b64_tr_b16 a[230:231], v13 offset:5120
    ds_read_b64_tr_b16 a[232:233], v13 offset:8192
    ds_read_b64_tr_b16 a[234:235], v13 offset:9216
    ds_read_b64_tr_b16 a[236:237], v13 offset:12288
    ds_read_b64_tr_b16 a[238:239], v13 offset:13312
    s_waitcnt lgkmcnt(0)
    ds_read_b64_tr_b16 a[240:241], v13 offset:16384
    ds_read_b64_tr_b16 a[242:243], v13 offset:17408
    ds_read_b64_tr_b16 a[244:245], v13 offset:20480
    ds_read_b64_tr_b16 a[246:247], v13 offset:21504
    ds_read_b64_tr_b16 a[248:249], v13 offset:24576
    ds_read_b64_tr_b16 a[250:251], v13 offset:25600
    ds_read_b64_tr_b16 a[252:253], v13 offset:28672
    ds_read_b64_tr_b16 a[254:255], v13 offset:29696
    s_waitcnt lgkmcnt(0)
    s_barrier
    s_waitcnt vmcnt(16)
    s_barrier
    s_cmp_eq_u32 s17, 2
    s_cbranch_scc1 mega_kernel_q_v
    ds_read_b128 v[32:35], v16 offset:0
    ds_read_b128 v[36:39], v17 offset:0
    ds_read_b128 v[40:43], v18 offset:0
    ds_read_b128 v[44:47], v19 offset:0
    ds_read_b128 v[48:51], v20 offset:0
    ds_read_b128 v[52:55], v21 offset:0
    s_mov_b32 s25, 0
mega_kernel_q_qk_loop:
    s_waitcnt lgkmcnt(5)
    v_mfma_f32_32x32x16_bf16 v[64:79], a[0:3], v[32:35], 0
    ds_read_b128 v[56:59], v22 offset:0
    s_waitcnt lgkmcnt(5)
    v_mfma_f32_32x32x16_bf16 v[64:79], a[4:7], v[36:39], v[64:79]
    ds_read_b128 v[60:63], v23 offset:0
    s_waitcnt lgkmcnt(5)
    v_mfma_f32_32x32x16_bf16 v[64:79], a[8:11], v[40:43], v[64:79]
    ds_read_b128 v[32:35], v16 offset:8192
    s_cmp_eq_u32 s25, 0
    s_cbranch_scc1 mega_kernel_q_qk_sk2
    s_add_u32 m0, s21, 74752
    s_xor_b32 s20, s23, 256
    buffer_load_dwordx4 v7, s[8:11], s20 offen lds
mega_kernel_q_qk_sk2:
    s_waitcnt lgkmcnt(5)
    v_mfma_f32_32x32x16_bf16 v[64:79], a[12:15], v[44:47], v[64:79]
    ds_read_b128 v[36:39], v17 offset:8192
    s_waitcnt lgkmcnt(5)
    v_mfma_f32_32x32x16_bf16 v[64:79], a[16:19], v[48:51], v[64:79]
    ds_read_b128 v[40:43], v18 offset:8192
    s_waitcnt lgkmcnt(5)
    v_mfma_f32_32x32x16_bf16 v[64:79], a[20:23], v[52:55], v[64:79]
    ds_read_b128 v[44:47], v19 offset:8192
    s_cmp_eq_u32 s25, 0
    s_cbranch_scc1 mega_kernel_q_qk_sk5
    s_add_u32 m0, s21, 81920
    s_xor_b32 s20, s23, 512
    buffer_load_dwordx4 v6, s[8:11], s20 offen lds
mega_kernel_q_qk_sk5:
    s_waitcnt lgkmcnt(5)
    v_mfma_f32_32x32x16_bf16 v[64:79], a[24:27], v[56:59], v[64:79]
    ds_read_b128 v[48:51], v20 offset:8192
    s_waitcnt lgkmcnt(5)
    v_mfma_f32_32x32x16_bf16 v[64:79], a[28:31], v[60:63], v[64:79]
    ds_read_b128 v[52:55], v21 offset:8192
    s_waitcnt lgkmcnt(5)
    v_mfma_f32_32x32x16_bf16 v[64:79], a[32:35], v[32:35], v[64:79]
    ds_read_b128 v[56:59], v22 offset:8192
    s_cmp_eq_u32 s25, 0
    s_cbranch_scc1 mega_kernel_q_qk_sk8
    s_add_u32 m0, s21, 82944
    s_xor_b32 s20, s23, 512
    buffer_load_dwordx4 v7, s[8:11], s20 offen lds
mega_kernel_q_qk_sk8:
    s_waitcnt lgkmcnt(5)
    v_mfma_f32_32x32x16_bf16 v[64:79], a[36:39], v[36:39], v[64:79]
    ds_read_b128 v[60:63], v23 offset:8192
    s_waitcnt lgkmcnt(5)
    v_mfma_f32_32x32x16_bf16 v[64:79], a[40:43], v[40:43], v[64:79]
    ds_read_b128 v[32:35], v16 offset:16384
    s_waitcnt lgkmcnt(5)
    v_mfma_f32_32x32x16_bf16 v[64:79], a[44:47], v[44:47], v[64:79]
    ds_read_b128 v[36:39], v17 offset:16384
    s_cmp_eq_u32 s25, 0
    s_cbranch_scc1 mega_kernel_q_qk_sk11
    s_add_u32 m0, s21, 90112
    s_xor_b32 s20, s23, 768
    buffer_load_dwordx4 v6, s[8:11], s20 offen lds
mega_kernel_q_qk_sk11:
    s_waitcnt lgkmcnt(5)
    v_mfma_f32_32x32x16_bf16 v[64:79], a[48:51], v[48:51], v[64:79]
    ds_read_b128 v[40:43], v18 offset:16384
    s_waitcnt lgkmcnt(5)
    v_mfma_f32_32x32x16_bf16 v[64:79], a[52:55], v[52:55], v[64:79]
    ds_read_b128 v[44:47], v19 offset:16384
    s_waitcnt lgkmcnt(5)
    v_mfma_f32_32x32x16_bf16 v[64:79], a[56:59], v[56:59], v[64:79]
    ds_read_b128 v[48:51], v20 offset:16384
    s_cmp_eq_u32 s25, 0
    s_cbranch_scc1 mega_kernel_q_qk_sk14
    s_add_u32 m0, s21, 91136
    s_xor_b32 s20, s23, 768
    buffer_load_dwordx4 v7, s[8:11], s20 offen lds
mega_kernel_q_qk_sk14:
    s_waitcnt lgkmcnt(5)
    v_mfma_f32_32x32x16_bf16 v[64:79], a[60:63], v[60:63], v[64:79]
    ds_read_b128 v[52:55], v21 offset:16384
    s_waitcnt lgkmcnt(5)
    v_mfma_f32_32x32x16_bf16 v[64:79], a[64:67], v[32:35], v[64:79]
    ds_read_b128 v[56:59], v22 offset:16384
    s_cmp_eq_u32 s25, 0
    s_cbranch_scc1 mega_kernel_q_qk_ne0
    v_cvt_pk_bf16_f32 v96, v80, v81
    v_cvt_pk_bf16_f32 v97, v82, v83
    v_cvt_pk_bf16_f32 v98, v84, v85
    v_cvt_pk_bf16_f32 v99, v86, v87
    buffer_store_dwordx4 v[96:99], v8, s[84:87], s24 offen offset:0 sc1
mega_kernel_q_qk_ne0:
    s_waitcnt lgkmcnt(5)
    v_mfma_f32_32x32x16_bf16 v[64:79], a[68:71], v[36:39], v[64:79]
    ds_read_b128 v[60:63], v23 offset:16384
    s_waitcnt lgkmcnt(5)
    v_mfma_f32_32x32x16_bf16 v[64:79], a[72:75], v[40:43], v[64:79]
    ds_read_b128 v[32:35], v16 offset:24576
    s_cmp_eq_u32 s25, 0
    s_cbranch_scc1 mega_kernel_q_qk_ne1
    v_cvt_pk_bf16_f32 v100, v88, v89
    v_cvt_pk_bf16_f32 v101, v90, v91
    v_cvt_pk_bf16_f32 v102, v92, v93
    v_cvt_pk_bf16_f32 v103, v94, v95
    buffer_store_dwordx4 v[100:103], v8, s[84:87], s24 offen offset:512 sc1
    s_add_u32 s24, s24, 524288
mega_kernel_q_qk_ne1:
    s_waitcnt lgkmcnt(5)
    v_mfma_f32_32x32x16_bf16 v[64:79], a[76:79], v[44:47], v[64:79]
    ds_read_b128 v[36:39], v17 offset:24576
    s_waitcnt lgkmcnt(5)
    v_mfma_f32_32x32x16_bf16 v[64:79], a[80:83], v[48:51], v[64:79]
    ds_read_b128 v[40:43], v18 offset:24576
    s_waitcnt lgkmcnt(5)
    v_mfma_f32_32x32x16_bf16 v[64:79], a[84:87], v[52:55], v[64:79]
    ds_read_b128 v[44:47], v19 offset:24576
    s_waitcnt lgkmcnt(5)
    v_mfma_f32_32x32x16_bf16 v[64:79], a[88:91], v[56:59], v[64:79]
    ds_read_b128 v[48:51], v20 offset:24576
    s_waitcnt lgkmcnt(5)
    v_mfma_f32_32x32x16_bf16 v[64:79], a[92:95], v[60:63], v[64:79]
    ds_read_b128 v[52:55], v21 offset:24576
    s_waitcnt vmcnt(8)
    s_barrier
    s_waitcnt lgkmcnt(5)
    v_mfma_f32_32x32x16_bf16 v[64:79], a[96:99], v[32:35], v[64:79]
    ds_read_b128 v[56:59], v22 offset:24576
    s_waitcnt lgkmcnt(5)
    v_mfma_f32_32x32x16_bf16 v[64:79], a[100:103], v[36:39], v[64:79]
    ds_read_b128 v[60:63], v23 offset:24576
    s_add_u32 m0, s21, 98304
    s_xor_b32 s20, s23, 1024
    buffer_load_dwordx4 v6, s[8:11], s20 offen lds
    s_waitcnt lgkmcnt(5)
    v_mfma_f32_32x32x16_bf16 v[64:79], a[104:107], v[40:43], v[64:79]
    ds_read_b128 v[32:35], v16 offset:32768
    s_waitcnt lgkmcnt(5)
    v_mfma_f32_32x32x16_bf16 v[64:79], a[108:111], v[44:47], v[64:79]
    ds_read_b128 v[36:39], v17 offset:32768
    s_waitcnt lgkmcnt(5)
    v_mfma_f32_32x32x16_bf16 v[64:79], a[112:115], v[48:51], v[64:79]
    ds_read_b128 v[40:43], v18 offset:32768
    s_add_u32 m0, s21, 99328
    s_xor_b32 s20, s23, 1024
    buffer_load_dwordx4 v7, s[8:11], s20 offen lds
    s_waitcnt lgkmcnt(5)
    v_mfma_f32_32x32x16_bf16 v[64:79], a[116:119], v[52:55], v[64:79]
    ds_read_b128 v[44:47], v19 offset:32768
    s_waitcnt lgkmcnt(5)
    v_mfma_f32_32x32x16_bf16 v[64:79], a[120:123], v[56:59], v[64:79]
    ds_read_b128 v[48:51], v20 offset:32768
    s_waitcnt lgkmcnt(5)
    v_mfma_f32_32x32x16_bf16 v[64:79], a[124:127], v[60:63], v[64:79]
    ds_read_b128 v[52:55], v21 offset:32768
    s_add_u32 m0, s21, 106496
    s_xor_b32 s20, s23, 1280
    buffer_load_dwordx4 v6, s[8:11], s20 offen lds
    s_waitcnt lgkmcnt(5)
    v_mfma_f32_32x32x16_bf16 v[64:79], a[128:131], v[32:35], v[64:79]
    ds_read_b128 v[56:59], v22 offset:32768
    s_waitcnt lgkmcnt(5)
    v_mfma_f32_32x32x16_bf16 v[64:79], a[132:135], v[36:39], v[64:79]
    ds_read_b128 v[60:63], v23 offset:32768
    s_waitcnt lgkmcnt(5)
    v_mfma_f32_32x32x16_bf16 v[64:79], a[136:139], v[40:43], v[64:79]
    ds_read_b128 v[32:35], v16 offset:40960
    s_add_u32 m0, s21, 107520
    s_xor_b32 s20, s23, 1280
    buffer_load_dwordx4 v7, s[8:11], s20 offen lds
    s_waitcnt lgkmcnt(5)
    v_mfma_f32_32x32x16_bf16 v[64:79], a[140:143], v[44:47], v[64:79]
    ds_read_b128 v[36:39], v17 offset:40960
    s_waitcnt lgkmcnt(5)
    v_mfma_f32_32x32x16_bf16 v[64:79], a[144:147], v[48:51], v[64:79]
    ds_read_b128 v[40:43], v18 offset:40960
    s_waitcnt lgkmcnt(5)
    v_mfma_f32_32x32x16_bf16 v[64:79], a[148:151], v[52:55], v[64:79]
    ds_read_b128 v[44:47], v19 offset:40960
    s_add_u32 m0, s21, 114688
    s_xor_b32 s20, s23, 1536
    buffer_load_dwordx4 v6, s[8:11], s20 offen lds
    s_waitcnt lgkmcnt(5)
    v_mfma_f32_32x32x16_bf16 v[64:79], a[152:155], v[56:59], v[64:79]
    ds_read_b128 v[48:51], v20 offset:40960
    s_waitcnt lgkmcnt(5)
    v_mfma_f32_32x32x16_bf16 v[64:79], a[156:159], v[60:63], v[64:79]
    ds_read_b128 v[52:55], v21 offset:40960
    s_waitcnt lgkmcnt(5)
    v_mfma_f32_32x32x16_bf16 v[64:79], a[160:163], v[32:35], v[64:79]
    ds_read_b128 v[56:59], v22 offset:40960
    s_add_u32 m0, s21, 115712
    s_xor_b32 s20, s23, 1536
    buffer_load_dwordx4 v7, s[8:11], s20 offen lds
    s_waitcnt lgkmcnt(5)
    v_mfma_f32_32x32x16_bf16 v[64:79], a[164:167], v[36:39], v[64:79]
    ds_read_b128 v[60:63], v23 offset:40960
    s_waitcnt lgkmcnt(5)
    v_mfma_f32_32x32x16_bf16 v[64:79], a[168:171], v[40:43], v[64:79]
    ds_read_b128 v[32:35], v16 offset:49152
    s_waitcnt lgkmcnt(5)
    v_mfma_f32_32x32x16_bf16 v[64:79], a[172:175], v[44:47], v[64:79]
    ds_read_b128 v[36:39], v17 offset:49152
    s_add_u32 m0, s21, 122880
    s_xor_b32 s20, s23, 1792
    buffer_load_dwordx4 v6, s[8:11], s20 offen lds
    s_waitcnt lgkmcnt(5)
    v_mfma_f32_32x32x16_bf16 v[64:79], a[176:179], v[48:51], v[64:79]
    ds_read_b128 v[40:43], v18 offset:49152
    s_waitcnt lgkmcnt(5)
    v_mfma_f32_32x32x16_bf16 v[64:79], a[180:183], v[52:55], v[64:79]
    ds_read_b128 v[44:47], v19 offset:49152
    s_waitcnt lgkmcnt(5)
    v_mfma_f32_32x32x16_bf16 v[64:79], a[184:187], v[56:59], v[64:79]
    ds_read_b128 v[48:51], v20 offset:49152
    s_add_u32 m0, s21, 123904
    s_xor_b32 s20, s23, 1792
    buffer_load_dwordx4 v7, s[8:11], s20 offen lds
    s_waitcnt lgkmcnt(5)
    v_mfma_f32_32x32x16_bf16 v[64:79], a[188:191], v[60:63], v[64:79]
    ds_read_b128 v[52:55], v21 offset:49152
    s_waitcnt lgkmcnt(5)
    v_mfma_f32_32x32x16_bf16 v[64:79], a[192:195], v[32:35], v[64:79]
    ds_read_b128 v[56:59], v22 offset:49152
    s_waitcnt lgkmcnt(5)
    v_mfma_f32_32x32x16_bf16 v[64:79], a[196:199], v[36:39], v[64:79]
    ds_read_b128 v[60:63], v23 offset:49152
    s_waitcnt lgkmcnt(5)
    v_mfma_f32_32x32x16_bf16 v[64:79], a[200:203], v[40:43], v[64:79]
    ds_read_b128 v[32:35], v16 offset:57344
    s_waitcnt lgkmcnt(5)
    v_mfma_f32_32x32x16_bf16 v[64:79], a[204:207], v[44:47], v[64:79]
    ds_read_b128 v[36:39], v17 offset:57344
    s_waitcnt lgkmcnt(5)
    v_mfma_f32_32x32x16_bf16 v[64:79], a[208:211], v[48:51], v[64:79]
    ds_read_b128 v[40:43], v18 offset:57344
    s_waitcnt lgkmcnt(5)
    v_mfma_f32_32x32x16_bf16 v[64:79], a[212:215], v[52:55], v[64:79]
    ds_read_b128 v[44:47], v19 offset:57344
    s_waitcnt lgkmcnt(5)
    v_mfma_f32_32x32x16_bf16 v[64:79], a[216:219], v[56:59], v[64:79]
    ds_read_b128 v[48:51], v20 offset:57344
    s_waitcnt lgkmcnt(5)
    v_mfma_f32_32x32x16_bf16 v[64:79], a[220:223], v[60:63], v[64:79]
    ds_read_b128 v[52:55], v21 offset:57344
    s_waitcnt vmcnt(8)
    s_barrier
    s_waitcnt lgkmcnt(5)
    v_mfma_f32_32x32x16_bf16 v[64:79], a[224:227], v[32:35], v[64:79]
    ds_read_b128 v[56:59], v22 offset:57344
    s_waitcnt lgkmcnt(5)
    v_mfma_f32_32x32x16_bf16 v[64:79], a[228:231], v[36:39], v[64:79]
    ds_read_b128 v[60:63], v23 offset:57344
    s_add_u32 s23, s23, 131072
    s_add_u32 m0, s21, 0
    s_xor_b32 s20, s23, 0
    buffer_load_dwordx4 v6, s[8:11], s20 offen lds
    s_waitcnt lgkmcnt(5)
    v_mfma_f32_32x32x16_bf16 v[64:79], a[232:235], v[40:43], v[64:79]
    ds_read_b128 v[32:35], v24 offset:0
    s_cmp_eq_u32 s25, 0
    s_cbranch_scc1 mega_kernel_q_qk_nf
    v_add_u32 v10, 1, v10
    buffer_store_dword v10, v9, s[84:87], 0 offen sc1
mega_kernel_q_qk_nf:
    s_waitcnt lgkmcnt(5)
    v_mfma_f32_32x32x16_bf16 v[64:79], a[236:239], v[44:47], v[64:79]
    ds_read_b128 v[36:39], v25 offset:0
    s_waitcnt lgkmcnt(5)
    v_mfma_f32_32x32x16_bf16 v[64:79], a[240:243], v[48:51], v[64:79]
    ds_read_b128 v[40:43], v26 offset:0
    s_add_u32 m0, s21, 1024
    s_xor_b32 s20, s23, 0
    buffer_load_dwordx4 v7, s[8:11], s20 offen lds
    s_waitcnt lgkmcnt(5)
    v_mfma_f32_32x32x16_bf16 v[64:79], a[244:247], v[52:55], v[64:79]
    ds_read_b128 v[44:47], v27 offset:0
    s_waitcnt lgkmcnt(5)
    v_mfma_f32_32x32x16_bf16 v[64:79], a[248:251], v[56:59], v[64:79]
    ds_read_b128 v[48:51], v28 offset:0
    s_waitcnt lgkmcnt(5)
    v_mfma_f32_32x32x16_bf16 v[64:79], a[252:255], v[60:63], v[64:79]
    ds_read_b128 v[52:55], v29 offset:0
    s_add_u32 m0, s21, 8192
    s_xor_b32 s20, s23, 256
    buffer_load_dwordx4 v6, s[8:11], s20 offen lds
    s_waitcnt lgkmcnt(5)
    v_mfma_f32_32x32x16_bf16 v[80:95], a[0:3], v[32:35], 0
    ds_read_b128 v[56:59], v30 offset:0
    s_waitcnt lgkmcnt(5)
    v_mfma_f32_32x32x16_bf16 v[80:95], a[4:7], v[36:39], v[80:95]
    ds_read_b128 v[60:63], v31 offset:0
    s_waitcnt lgkmcnt(5)
    v_mfma_f32_32x32x16_bf16 v[80:95], a[8:11], v[40:43], v[80:95]
    ds_read_b128 v[32:35], v24 offset:8192
    s_add_u32 m0, s21, 9216
    s_xor_b32 s20, s23, 256
    buffer_load_dwordx4 v7, s[8:11], s20 offen lds
    s_waitcnt lgkmcnt(5)
    v_mfma_f32_32x32x16_bf16 v[80:95], a[12:15], v[44:47], v[80:95]
    ds_read_b128 v[36:39], v25 offset:8192
    s_waitcnt lgkmcnt(5)
    v_mfma_f32_32x32x16_bf16 v[80:95], a[16:19], v[48:51], v[80:95]
    ds_read_b128 v[40:43], v26 offset:8192
    s_waitcnt lgkmcnt(5)
    v_mfma_f32_32x32x16_bf16 v[80:95], a[20:23], v[52:55], v[80:95]
    ds_read_b128 v[44:47], v27 offset:8192
    s_add_u32 m0, s21, 16384
    s_xor_b32 s20, s23, 512
    buffer_load_dwordx4 v6, s[8:11], s20 offen lds
    s_waitcnt lgkmcnt(5)
    v_mfma_f32_32x32x16_bf16 v[80:95], a[24:27], v[56:59], v[80:95]
    ds_read_b128 v[48:51], v28 offset:8192
    s_waitcnt lgkmcnt(5)
    v_mfma_f32_32x32x16_bf16 v[80:95], a[28:31], v[60:63], v[80:95]
    ds_read_b128 v[52:55], v29 offset:8192
    s_waitcnt lgkmcnt(5)
    v_mfma_f32_32x32x16_bf16 v[80:95], a[32:35], v[32:35], v[80:95]
    ds_read_b128 v[56:59], v30 offset:8192
    s_add_u32 m0, s21, 17408
    s_xor_b32 s20, s23, 512
    buffer_load_dwordx4 v7, s[8:11], s20 offen lds
    s_waitcnt lgkmcnt(5)
    v_mfma_f32_32x32x16_bf16 v[80:95], a[36:39], v[36:39], v[80:95]
    ds_read_b128 v[60:63], v31 offset:8192
    s_waitcnt lgkmcnt(5)
    v_mfma_f32_32x32x16_bf16 v[80:95], a[40:43], v[40:43], v[80:95]
    ds_read_b128 v[32:35], v24 offset:16384
    s_waitcnt lgkmcnt(5)
    v_mfma_f32_32x32x16_bf16 v[80:95], a[44:47], v[44:47], v[80:95]
    ds_read_b128 v[36:39], v25 offset:16384
    s_add_u32 m0, s21, 24576
    s_xor_b32 s20, s23, 768
    buffer_load_dwordx4 v6, s[8:11], s20 offen lds
    s_waitcnt lgkmcnt(5)
    v_mfma_f32_32x32x16_bf16 v[80:95], a[48:51], v[48:51], v[80:95]
    ds_read_b128 v[40:43], v26 offset:16384
    s_waitcnt lgkmcnt(5)
    v_mfma_f32_32x32x16_bf16 v[80:95], a[52:55], v[52:55], v[80:95]
    ds_read_b128 v[44:47], v27 offset:16384
    s_waitcnt lgkmcnt(5)
    v_mfma_f32_32x32x16_bf16 v[80:95], a[56:59], v[56:59], v[80:95]
    ds_read_b128 v[48:51], v28 offset:16384
    s_add_u32 m0, s21, 25600
    s_xor_b32 s20, s23, 768
    buffer_load_dwordx4 v7, s[8:11], s20 offen lds
    s_waitcnt lgkmcnt(5)
    v_mfma_f32_32x32x16_bf16 v[80:95], a[60:63], v[60:63], v[80:95]
    ds_read_b128 v[52:55], v29 offset:16384
    s_waitcnt lgkmcnt(5)
    v_mfma_f32_32x32x16_bf16 v[80:95], a[64:67], v[32:35], v[80:95]
    ds_read_b128 v[56:59], v30 offset:16384
    v_cvt_pk_bf16_f32 v96, v64, v65
    v_cvt_pk_bf16_f32 v97, v66, v67
    v_cvt_pk_bf16_f32 v98, v68, v69
    v_cvt_pk_bf16_f32 v99, v70, v71
    buffer_store_dwordx4 v[96:99], v8, s[84:87], s24 offen offset:0 sc1
    s_waitcnt lgkmcnt(5)
    v_mfma_f32_32x32x16_bf16 v[80:95], a[68:71], v[36:39], v[80:95]
    ds_read_b128 v[60:63], v31 offset:16384
    s_waitcnt lgkmcnt(5)
    v_mfma_f32_32x32x16_bf16 v[80:95], a[72:75], v[40:43], v[80:95]
    ds_read_b128 v[32:35], v24 offset:24576
    v_cvt_pk_bf16_f32 v100, v72, v73
    v_cvt_pk_bf16_f32 v101, v74, v75
    v_cvt_pk_bf16_f32 v102, v76, v77
    v_cvt_pk_bf16_f32 v103, v78, v79
    buffer_store_dwordx4 v[100:103], v8, s[84:87], s24 offen offset:512 sc1
    s_add_u32 s24, s24, 524288
    s_waitcnt lgkmcnt(5)
    v_mfma_f32_32x32x16_bf16 v[80:95], a[76:79], v[44:47], v[80:95]
    ds_read_b128 v[36:39], v25 offset:24576
    s_waitcnt lgkmcnt(5)
    v_mfma_f32_32x32x16_bf16 v[80:95], a[80:83], v[48:51], v[80:95]
    ds_read_b128 v[40:43], v26 offset:24576
    s_waitcnt lgkmcnt(5)
    v_mfma_f32_32x32x16_bf16 v[80:95], a[84:87], v[52:55], v[80:95]
    ds_read_b128 v[44:47], v27 offset:24576
    s_waitcnt lgkmcnt(5)
    v_mfma_f32_32x32x16_bf16 v[80:95], a[88:91], v[56:59], v[80:95]
    ds_read_b128 v[48:51], v28 offset:24576
    s_waitcnt lgkmcnt(5)
    v_mfma_f32_32x32x16_bf16 v[80:95], a[92:95], v[60:63], v[80:95]
    ds_read_b128 v[52:55], v29 offset:24576
    s_waitcnt vmcnt(8)
    s_barrier
    s_waitcnt lgkmcnt(5)
    v_mfma_f32_32x32x16_bf16 v[80:95], a[96:99], v[32:35], v[80:95]
    ds_read_b128 v[56:59], v30 offset:24576
    s_waitcnt lgkmcnt(5)
    v_mfma_f32_32x32x16_bf16 v[80:95], a[100:103], v[36:39], v[80:95]
    ds_read_b128 v[60:63], v31 offset:24576
    s_add_u32 m0, s21, 32768
    s_xor_b32 s20, s23, 1024
    buffer_load_dwordx4 v6, s[8:11], s20 offen lds
    s_waitcnt lgkmcnt(5)
    v_mfma_f32_32x32x16_bf16 v[80:95], a[104:107], v[40:43], v[80:95]
    ds_read_b128 v[32:35], v24 offset:32768
    s_waitcnt lgkmcnt(5)
    v_mfma_f32_32x32x16_bf16 v[80:95], a[108:111], v[44:47], v[80:95]
    ds_read_b128 v[36:39], v25 offset:32768
    s_waitcnt lgkmcnt(5)
    v_mfma_f32_32x32x16_bf16 v[80:95], a[112:115], v[48:51], v[80:95]
    ds_read_b128 v[40:43], v26 offset:32768
    s_add_u32 m0, s21, 33792
    s_xor_b32 s20, s23, 1024
    buffer_load_dwordx4 v7, s[8:11], s20 offen lds
    s_waitcnt lgkmcnt(5)
    v_mfma_f32_32x32x16_bf16 v[80:95], a[116:119], v[52:55], v[80:95]
    ds_read_b128 v[44:47], v27 offset:32768
    s_waitcnt lgkmcnt(5)
    v_mfma_f32_32x32x16_bf16 v[80:95], a[120:123], v[56:59], v[80:95]
    ds_read_b128 v[48:51], v28 offset:32768
    s_waitcnt lgkmcnt(5)
    v_mfma_f32_32x32x16_bf16 v[80:95], a[124:127], v[60:63], v[80:95]
    ds_read_b128 v[52:55], v29 offset:32768
    s_add_u32 m0, s21, 40960
    s_xor_b32 s20, s23, 1280
    buffer_load_dwordx4 v6, s[8:11], s20 offen lds
    s_waitcnt lgkmcnt(5)
    v_mfma_f32_32x32x16_bf16 v[80:95], a[128:131], v[32:35], v[80:95]
    ds_read_b128 v[56:59], v30 offset:32768
    s_waitcnt lgkmcnt(5)
    v_mfma_f32_32x32x16_bf16 v[80:95], a[132:135], v[36:39], v[80:95]
    ds_read_b128 v[60:63], v31 offset:32768
    s_waitcnt lgkmcnt(5)
    v_mfma_f32_32x32x16_bf16 v[80:95], a[136:139], v[40:43], v[80:95]
    ds_read_b128 v[32:35], v24 offset:40960
    s_add_u32 m0, s21, 41984
    s_xor_b32 s20, s23, 1280
    buffer_load_dwordx4 v7, s[8:11], s20 offen lds
    s_waitcnt lgkmcnt(5)
    v_mfma_f32_32x32x16_bf16 v[80:95], a[140:143], v[44:47], v[80:95]
    ds_read_b128 v[36:39], v25 offset:40960
    s_waitcnt lgkmcnt(5)
    v_mfma_f32_32x32x16_bf16 v[80:95], a[144:147], v[48:51], v[80:95]
    ds_read_b128 v[40:43], v26 offset:40960
    s_waitcnt lgkmcnt(5)
    v_mfma_f32_32x32x16_bf16 v[80:95], a[148:151], v[52:55], v[80:95]
    ds_read_b128 v[44:47], v27 offset:40960
    s_add_u32 m0, s21, 49152
    s_xor_b32 s20, s23, 1536
    buffer_load_dwordx4 v6, s[8:11], s20 offen lds
    s_waitcnt lgkmcnt(5)
    v_mfma_f32_32x32x16_bf16 v[80:95], a[152:155], v[56:59], v[80:95]
    ds_read_b128 v[48:51], v28 offset:40960
    s_waitcnt lgkmcnt(5)
    v_mfma_f32_32x32x16_bf16 v[80:95], a[156:159], v[60:63], v[80:95]
    ds_read_b128 v[52:55], v29 offset:40960
    s_waitcnt lgkmcnt(5)
    v_mfma_f32_32x32x16_bf16 v[80:95], a[160:163], v[32:35], v[80:95]
    ds_read_b128 v[56:59], v30 offset:40960
    s_add_u32 m0, s21, 50176
    s_xor_b32 s20, s23, 1536
    buffer_load_dwordx4 v7, s[8:11], s20 offen lds
    s_waitcnt lgkmcnt(5)
    v_mfma_f32_32x32x16_bf16 v[80:95], a[164:167], v[36:39], v[80:95]
    ds_read_b128 v[60:63], v31 offset:40960
    s_waitcnt lgkmcnt(5)
    v_mfma_f32_32x32x16_bf16 v[80:95], a[168:171], v[40:43], v[80:95]
    ds_read_b128 v[32:35], v24 offset:49152
    s_waitcnt lgkmcnt(5)
    v_mfma_f32_32x32x16_bf16 v[80:95], a[172:175], v[44:47], v[80:95]
    ds_read_b128 v[36:39], v25 offset:49152
    s_add_u32 m0, s21, 57344
    s_xor_b32 s20, s23, 1792
    buffer_load_dwordx4 v6, s[8:11], s20 offen lds
    s_waitcnt lgkmcnt(5)
    v_mfma_f32_32x32x16_bf16 v[80:95], a[176:179], v[48:51], v[80:95]
    ds_read_b128 v[40:43], v26 offset:49152
    s_waitcnt lgkmcnt(5)
    v_mfma_f32_32x32x16_bf16 v[80:95], a[180:183], v[52:55], v[80:95]
    ds_read_b128 v[44:47], v27 offset:49152
    s_waitcnt lgkmcnt(5)
    v_mfma_f32_32x32x16_bf16 v[80:95], a[184:187], v[56:59], v[80:95]
    ds_read_b128 v[48:51], v28 offset:49152
    s_add_u32 m0, s21, 58368
    s_xor_b32 s20, s23, 1792
    buffer_load_dwordx4 v7, s[8:11], s20 offen lds
    s_waitcnt lgkmcnt(5)
    v_mfma_f32_32x32x16_bf16 v[80:95], a[188:191], v[60:63], v[80:95]
    ds_read_b128 v[52:55], v29 offset:49152
    s_waitcnt lgkmcnt(5)
    v_mfma_f32_32x32x16_bf16 v[80:95], a[192:195], v[32:35], v[80:95]
    ds_read_b128 v[56:59], v30 offset:49152
    s_waitcnt lgkmcnt(5)
    v_mfma_f32_32x32x16_bf16 v[80:95], a[196:199], v[36:39], v[80:95]
    ds_read_b128 v[60:63], v31 offset:49152
    s_waitcnt lgkmcnt(5)
    v_mfma_f32_32x32x16_bf16 v[80:95], a[200:203], v[40:43], v[80:95]
    ds_read_b128 v[32:35], v24 offset:57344
    s_waitcnt lgkmcnt(5)
    v_mfma_f32_32x32x16_bf16 v[80:95], a[204:207], v[44:47], v[80:95]
    ds_read_b128 v[36:39], v25 offset:57344
    s_waitcnt lgkmcnt(5)
    v_mfma_f32_32x32x16_bf16 v[80:95], a[208:211], v[48:51], v[80:95]
    ds_read_b128 v[40:43], v26 offset:57344
    s_waitcnt lgkmcnt(5)
    v_mfma_f32_32x32x16_bf16 v[80:95], a[212:215], v[52:55], v[80:95]
    ds_read_b128 v[44:47], v27 offset:57344
    s_waitcnt lgkmcnt(5)
    v_mfma_f32_32x32x16_bf16 v[80:95], a[216:219], v[56:59], v[80:95]
    ds_read_b128 v[48:51], v28 offset:57344
    s_waitcnt lgkmcnt(5)
    v_mfma_f32_32x32x16_bf16 v[80:95], a[220:223], v[60:63], v[80:95]
    ds_read_b128 v[52:55], v29 offset:57344
    s_waitcnt vmcnt(8)
    s_barrier
    s_waitcnt lgkmcnt(5)
    v_mfma_f32_32x32x16_bf16 v[80:95], a[224:227], v[32:35], v[80:95]
    ds_read_b128 v[56:59], v30 offset:57344
    s_waitcnt lgkmcnt(5)
    v_mfma_f32_32x32x16_bf16 v[80:95], a[228:231], v[36:39], v[80:95]
    ds_read_b128 v[60:63], v31 offset:57344
    s_add_u32 s23, s23, 131072
    s_add_u32 m0, s21, 65536
    s_xor_b32 s20, s23, 0
    buffer_load_dwordx4 v6, s[8:11], s20 offen lds
    s_waitcnt lgkmcnt(5)
    v_mfma_f32_32x32x16_bf16 v[80:95], a[232:235], v[40:43], v[80:95]
    ds_read_b128 v[32:35], v16 offset:0
    v_add_u32 v10, 1, v10
    buffer_store_dword v10, v9, s[84:87], 0 offen sc1
    s_waitcnt lgkmcnt(5)
    v_mfma_f32_32x32x16_bf16 v[80:95], a[236:239], v[44:47], v[80:95]
    ds_read_b128 v[36:39], v17 offset:0
    s_waitcnt lgkmcnt(5)
    v_mfma_f32_32x32x16_bf16 v[80:95], a[240:243], v[48:51], v[80:95]
    ds_read_b128 v[40:43], v18 offset:0
    s_add_u32 m0, s21, 66560
    s_xor_b32 s20, s23, 0
    buffer_load_dwordx4 v7, s[8:11], s20 offen lds
    s_waitcnt lgkmcnt(5)
    v_mfma_f32_32x32x16_bf16 v[80:95], a[244:247], v[52:55], v[80:95]
    ds_read_b128 v[44:47], v19 offset:0
    s_waitcnt lgkmcnt(5)
    v_mfma_f32_32x32x16_bf16 v[80:95], a[248:251], v[56:59], v[80:95]
    ds_read_b128 v[48:51], v20 offset:0
    s_waitcnt lgkmcnt(5)
    v_mfma_f32_32x32x16_bf16 v[80:95], a[252:255], v[60:63], v[80:95]
    ds_read_b128 v[52:55], v21 offset:0
    s_add_u32 m0, s21, 73728
    s_xor_b32 s20, s23, 256
    buffer_load_dwordx4 v6, s[8:11], s20 offen lds
    s_add_u32 s25, s25, 1
    s_cmp_lt_u32 s25, 16
    s_cbranch_scc1 mega_kernel_q_qk_loop
    s_nop 11
    v_cvt_pk_bf16_f32 v96, v80, v81
    v_cvt_pk_bf16_f32 v97, v82, v83
    v_cvt_pk_bf16_f32 v98, v84, v85
    v_cvt_pk_bf16_f32 v99, v86, v87
    buffer_store_dwordx4 v[96:99], v8, s[84:87], s24 offen offset:0 sc1
    v_cvt_pk_bf16_f32 v100, v88, v89
    v_cvt_pk_bf16_f32 v101, v90, v91
    v_cvt_pk_bf16_f32 v102, v92, v93
    v_cvt_pk_bf16_f32 v103, v94, v95
    buffer_store_dwordx4 v[100:103], v8, s[84:87], s24 offen offset:512 sc1
    s_add_u32 s24, s24, 524288
    s_waitcnt vmcnt(0) lgkmcnt(0)
    s_barrier
    v_add_u32 v10, 1, v10
    buffer_store_dword v10, v9, s[84:87], 0 offen sc1
    s_branch mega_kernel_q_done
mega_kernel_q_v:
    ds_read_b128 v[32:35], v16 offset:0
    ds_read_b128 v[36:39], v17 offset:0
    ds_read_b128 v[40:43], v18 offset:0
    ds_read_b128 v[44:47], v19 offset:0
    ds_read_b128 v[48:51], v20 offset:0
    ds_read_b128 v[52:55], v21 offset:0
    s_mov_b32 s25, 0
mega_kernel_q_v_loop:
    s_waitcnt lgkmcnt(5)
    v_mfma_f32_32x32x16_bf16 v[64:79], v[32:35], a[0:3], 0
    ds_read_b128 v[56:59], v22 offset:0
    s_waitcnt lgkmcnt(5)
    v_mfma_f32_32x32x16_bf16 v[64:79], v[36:39], a[4:7], v[64:79]
    ds_read_b128 v[60:63], v23 offset:0
    s_waitcnt lgkmcnt(5)
    v_mfma_f32_32x32x16_bf16 v[64:79], v[40:43], a[8:11], v[64:79]
    ds_read_b128 v[32:35], v16 offset:8192
    s_cmp_eq_u32 s25, 0
    s_cbranch_scc1 mega_kernel_q_v_sk2
    s_add_u32 m0, s21, 74752
    s_xor_b32 s20, s23, 256
    buffer_load_dwordx4 v7, s[8:11], s20 offen lds
mega_kernel_q_v_sk2:
    s_waitcnt lgkmcnt(5)
    v_mfma_f32_32x32x16_bf16 v[64:79], v[44:47], a[12:15], v[64:79]
    ds_read_b128 v[36:39], v17 offset:8192
    s_waitcnt lgkmcnt(5)
    v_mfma_f32_32x32x16_bf16 v[64:79], v[48:51], a[16:19], v[64:79]
    ds_read_b128 v[40:43], v18 offset:8192
    s_waitcnt lgkmcnt(5)
    v_mfma_f32_32x32x16_bf16 v[64:79], v[52:55], a[20:23], v[64:79]
    ds_read_b128 v[44:47], v19 offset:8192
    s_cmp_eq_u32 s25, 0
    s_cbranch_scc1 mega_kernel_q_v_sk5
    s_add_u32 m0, s21, 81920
    s_xor_b32 s20, s23, 512
    buffer_load_dwordx4 v6, s[8:11], s20 offen lds
mega_kernel_q_v_sk5:
    s_waitcnt lgkmcnt(5)
    v_mfma_f32_32x32x16_bf16 v[64:79], v[56:59], a[24:27], v[64:79]
    ds_read_b128 v[48:51], v20 offset:8192
    s_waitcnt lgkmcnt(5)
    v_mfma_f32_32x32x16_bf16 v[64:79], v[60:63], a[28:31], v[64:79]
    ds_read_b128 v[52:55], v21 offset:8192
    s_waitcnt lgkmcnt(5)
    v_mfma_f32_32x32x16_bf16 v[64:79], v[32:35], a[32:35], v[64:79]
    ds_read_b128 v[56:59], v22 offset:8192
    s_cmp_eq_u32 s25, 0
    s_cbranch_scc1 mega_kernel_q_v_sk8
    s_add_u32 m0, s21, 82944
    s_xor_b32 s20, s23, 512
    buffer_load_dwordx4 v7, s[8:11], s20 offen lds
mega_kernel_q_v_sk8:
    s_waitcnt lgkmcnt(5)
    v_mfma_f32_32x32x16_bf16 v[64:79], v[36:39], a[36:39], v[64:79]
    ds_read_b128 v[60:63], v23 offset:8192
    s_waitcnt lgkmcnt(5)
    v_mfma_f32_32x32x16_bf16 v[64:79], v[40:43], a[40:43], v[64:79]
    ds_read_b128 v[32:35], v16 offset:16384
    s_waitcnt lgkmcnt(5)
    v_mfma_f32_32x32x16_bf16 v[64:79], v[44:47], a[44:47], v[64:79]
    ds_read_b128 v[36:39], v17 offset:16384
    s_cmp_eq_u32 s25, 0
    s_cbranch_scc1 mega_kernel_q_v_sk11
    s_add_u32 m0, s21, 90112
    s_xor_b32 s20, s23, 768
    buffer_load_dwordx4 v6, s[8:11], s20 offen lds
mega_kernel_q_v_sk11:
    s_waitcnt lgkmcnt(5)
    v_mfma_f32_32x32x16_bf16 v[64:79], v[48:51], a[48:51], v[64:79]
    ds_read_b128 v[40:43], v18 offset:16384
    s_waitcnt lgkmcnt(5)
    v_mfma_f32_32x32x16_bf16 v[64:79], v[52:55], a[52:55], v[64:79]
    ds_read_b128 v[44:47], v19 offset:16384
    s_waitcnt lgkmcnt(5)
    v_mfma_f32_32x32x16_bf16 v[64:79], v[56:59], a[56:59], v[64:79]
    ds_read_b128 v[48:51], v20 offset:16384
    s_cmp_eq_u32 s25, 0
    s_cbranch_scc1 mega_kernel_q_v_sk14
    s_add_u32 m0, s21, 91136
    s_xor_b32 s20, s23, 768
    buffer_load_dwordx4 v7, s[8:11], s20 offen lds
mega_kernel_q_v_sk14:
    s_waitcnt lgkmcnt(5)
    v_mfma_f32_32x32x16_bf16 v[64:79], v[60:63], a[60:63], v[64:79]
    ds_read_b128 v[52:55], v21 offset:16384
    s_waitcnt lgkmcnt(5)
    v_mfma_f32_32x32x16_bf16 v[64:79], v[32:35], a[64:67], v[64:79]
    ds_read_b128 v[56:59], v22 offset:16384
    s_cmp_eq_u32 s25, 0
    s_cbranch_scc1 mega_kernel_q_v_ne0
    v_cvt_pk_bf16_f32 v96, v80, v81
    v_cvt_pk_bf16_f32 v97, v82, v83
    v_cvt_pk_bf16_f32 v98, v88, v89
    v_cvt_pk_bf16_f32 v99, v90, v91
    buffer_store_dwordx4 v[96:99], v8, s[84:87], s24 offen offset:0 sc1
mega_kernel_q_v_ne0:
    s_waitcnt lgkmcnt(5)
    v_mfma_f32_32x32x16_bf16 v[64:79], v[36:39], a[68:71], v[64:79]
    ds_read_b128 v[60:63], v23 offset:16384
    s_waitcnt lgkmcnt(5)
    v_mfma_f32_32x32x16_bf16 v[64:79], v[40:43], a[72:75], v[64:79]
    ds_read_b128 v[32:35], v16 offset:24576
    s_cmp_eq_u32 s25, 0
    s_cbranch_scc1 mega_kernel_q_v_ne1
    v_cvt_pk_bf16_f32 v100, v84, v85
    v_cvt_pk_bf16_f32 v101, v86, v87
    v_cvt_pk_bf16_f32 v102, v92, v93
    v_cvt_pk_bf16_f32 v103, v94, v95
    buffer_store_dwordx4 v[100:103], v8, s[84:87], s24 offen offset:512 sc1
    s_add_u32 s24, s24, 524288
mega_kernel_q_v_ne1:
    s_waitcnt lgkmcnt(5)
    v_mfma_f32_32x32x16_bf16 v[64:79], v[44:47], a[76:79], v[64:79]
    ds_read_b128 v[36:39], v17 offset:24576
    s_waitcnt lgkmcnt(5)
    v_mfma_f32_32x32x16_bf16 v[64:79], v[48:51], a[80:83], v[64:79]
    ds_read_b128 v[40:43], v18 offset:24576
    s_waitcnt lgkmcnt(5)
    v_mfma_f32_32x32x16_bf16 v[64:79], v[52:55], a[84:87], v[64:79]
    ds_read_b128 v[44:47], v19 offset:24576
    s_waitcnt lgkmcnt(5)
    v_mfma_f32_32x32x16_bf16 v[64:79], v[56:59], a[88:91], v[64:79]
    ds_read_b128 v[48:51], v20 offset:24576
    s_waitcnt lgkmcnt(5)
    v_mfma_f32_32x32x16_bf16 v[64:79], v[60:63], a[92:95], v[64:79]
    ds_read_b128 v[52:55], v21 offset:24576
    s_waitcnt vmcnt(8)
    s_barrier
    s_waitcnt lgkmcnt(5)
    v_mfma_f32_32x32x16_bf16 v[64:79], v[32:35], a[96:99], v[64:79]
    ds_read_b128 v[56:59], v22 offset:24576
    s_waitcnt lgkmcnt(5)
    v_mfma_f32_32x32x16_bf16 v[64:79], v[36:39], a[100:103], v[64:79]
    ds_read_b128 v[60:63], v23 offset:24576
    s_add_u32 m0, s21, 98304
    s_xor_b32 s20, s23, 1024
    buffer_load_dwordx4 v6, s[8:11], s20 offen lds
    s_waitcnt lgkmcnt(5)
    v_mfma_f32_32x32x16_bf16 v[64:79], v[40:43], a[104:107], v[64:79]
    ds_read_b128 v[32:35], v16 offset:32768
    s_waitcnt lgkmcnt(5)
    v_mfma_f32_32x32x16_bf16 v[64:79], v[44:47], a[108:111], v[64:79]
    ds_read_b128 v[36:39], v17 offset:32768
    s_waitcnt lgkmcnt(5)
    v_mfma_f32_32x32x16_bf16 v[64:79], v[48:51], a[112:115], v[64:79]
    ds_read_b128 v[40:43], v18 offset:32768
    s_add_u32 m0, s21, 99328
    s_xor_b32 s20, s23, 1024
    buffer_load_dwordx4 v7, s[8:11], s20 offen lds
    s_waitcnt lgkmcnt(5)
    v_mfma_f32_32x32x16_bf16 v[64:79], v[52:55], a[116:119], v[64:79]
    ds_read_b128 v[44:47], v19 offset:32768
    s_waitcnt lgkmcnt(5)
    v_mfma_f32_32x32x16_bf16 v[64:79], v[56:59], a[120:123], v[64:79]
    ds_read_b128 v[48:51], v20 offset:32768
    s_waitcnt lgkmcnt(5)
    v_mfma_f32_32x32x16_bf16 v[64:79], v[60:63], a[124:127], v[64:79]
    ds_read_b128 v[52:55], v21 offset:32768
    s_add_u32 m0, s21, 106496
    s_xor_b32 s20, s23, 1280
    buffer_load_dwordx4 v6, s[8:11], s20 offen lds
    s_waitcnt lgkmcnt(5)
    v_mfma_f32_32x32x16_bf16 v[64:79], v[32:35], a[128:131], v[64:79]
    ds_read_b128 v[56:59], v22 offset:32768
    s_waitcnt lgkmcnt(5)
    v_mfma_f32_32x32x16_bf16 v[64:79], v[36:39], a[132:135], v[64:79]
    ds_read_b128 v[60:63], v23 offset:32768
    s_waitcnt lgkmcnt(5)
    v_mfma_f32_32x32x16_bf16 v[64:79], v[40:43], a[136:139], v[64:79]
    ds_read_b128 v[32:35], v16 offset:40960
    s_add_u32 m0, s21, 107520
    s_xor_b32 s20, s23, 1280
    buffer_load_dwordx4 v7, s[8:11], s20 offen lds
    s_waitcnt lgkmcnt(5)
    v_mfma_f32_32x32x16_bf16 v[64:79], v[44:47], a[140:143], v[64:79]
    ds_read_b128 v[36:39], v17 offset:40960
    s_waitcnt lgkmcnt(5)
    v_mfma_f32_32x32x16_bf16 v[64:79], v[48:51], a[144:147], v[64:79]
    ds_read_b128 v[40:43], v18 offset:40960
    s_waitcnt lgkmcnt(5)
    v_mfma_f32_32x32x16_bf16 v[64:79], v[52:55], a[148:151], v[64:79]
    ds_read_b128 v[44:47], v19 offset:40960
    s_add_u32 m0, s21, 114688
    s_xor_b32 s20, s23, 1536
    buffer_load_dwordx4 v6, s[8:11], s20 offen lds
    s_waitcnt lgkmcnt(5)
    v_mfma_f32_32x32x16_bf16 v[64:79], v[56:59], a[152:155], v[64:79]
    ds_read_b128 v[48:51], v20 offset:40960
    s_waitcnt lgkmcnt(5)
    v_mfma_f32_32x32x16_bf16 v[64:79], v[60:63], a[156:159], v[64:79]
    ds_read_b128 v[52:55], v21 offset:40960
    s_waitcnt lgkmcnt(5)
    v_mfma_f32_32x32x16_bf16 v[64:79], v[32:35], a[160:163], v[64:79]
    ds_read_b128 v[56:59], v22 offset:40960
    s_add_u32 m0, s21, 115712
    s_xor_b32 s20, s23, 1536
    buffer_load_dwordx4 v7, s[8:11], s20 offen lds
    s_waitcnt lgkmcnt(5)
    v_mfma_f32_32x32x16_bf16 v[64:79], v[36:39], a[164:167], v[64:79]
    ds_read_b128 v[60:63], v23 offset:40960
    s_waitcnt lgkmcnt(5)
    v_mfma_f32_32x32x16_bf16 v[64:79], v[40:43], a[168:171], v[64:79]
    ds_read_b128 v[32:35], v16 offset:49152
    s_waitcnt lgkmcnt(5)
    v_mfma_f32_32x32x16_bf16 v[64:79], v[44:47], a[172:175], v[64:79]
    ds_read_b128 v[36:39], v17 offset:49152
    s_add_u32 m0, s21, 122880
    s_xor_b32 s20, s23, 1792
    buffer_load_dwordx4 v6, s[8:11], s20 offen lds
    s_waitcnt lgkmcnt(5)
    v_mfma_f32_32x32x16_bf16 v[64:79], v[48:51], a[176:179], v[64:79]
    ds_read_b128 v[40:43], v18 offset:49152
    s_waitcnt lgkmcnt(5)
    v_mfma_f32_32x32x16_bf16 v[64:79], v[52:55], a[180:183], v[64:79]
    ds_read_b128 v[44:47], v19 offset:49152
    s_waitcnt lgkmcnt(5)
    v_mfma_f32_32x32x16_bf16 v[64:79], v[56:59], a[184:187], v[64:79]
    ds_read_b128 v[48:51], v20 offset:49152
    s_add_u32 m0, s21, 123904
    s_xor_b32 s20, s23, 1792
    buffer_load_dwordx4 v7, s[8:11], s20 offen lds
    s_waitcnt lgkmcnt(5)
    v_mfma_f32_32x32x16_bf16 v[64:79], v[60:63], a[188:191], v[64:79]
    ds_read_b128 v[52:55], v21 offset:49152
    s_waitcnt lgkmcnt(5)
    v_mfma_f32_32x32x16_bf16 v[64:79], v[32:35], a[192:195], v[64:79]
    ds_read_b128 v[56:59], v22 offset:49152
    s_waitcnt lgkmcnt(5)
    v_mfma_f32_32x32x16_bf16 v[64:79], v[36:39], a[196:199], v[64:79]
    ds_read_b128 v[60:63], v23 offset:49152
    s_waitcnt lgkmcnt(5)
    v_mfma_f32_32x32x16_bf16 v[64:79], v[40:43], a[200:203], v[64:79]
    ds_read_b128 v[32:35], v16 offset:57344
    s_waitcnt lgkmcnt(5)
    v_mfma_f32_32x32x16_bf16 v[64:79], v[44:47], a[204:207], v[64:79]
    ds_read_b128 v[36:39], v17 offset:57344
    s_waitcnt lgkmcnt(5)
    v_mfma_f32_32x32x16_bf16 v[64:79], v[48:51], a[208:211], v[64:79]
    ds_read_b128 v[40:43], v18 offset:57344
    s_waitcnt lgkmcnt(5)
    v_mfma_f32_32x32x16_bf16 v[64:79], v[52:55], a[212:215], v[64:79]
    ds_read_b128 v[44:47], v19 offset:57344
    s_waitcnt lgkmcnt(5)
    v_mfma_f32_32x32x16_bf16 v[64:79], v[56:59], a[216:219], v[64:79]
    ds_read_b128 v[48:51], v20 offset:57344
    s_waitcnt lgkmcnt(5)
    v_mfma_f32_32x32x16_bf16 v[64:79], v[60:63], a[220:223], v[64:79]
    ds_read_b128 v[52:55], v21 offset:57344
    s_waitcnt vmcnt(8)
    s_barrier
    s_waitcnt lgkmcnt(5)
    v_mfma_f32_32x32x16_bf16 v[64:79], v[32:35], a[224:227], v[64:79]
    ds_read_b128 v[56:59], v22 offset:57344
    s_waitcnt lgkmcnt(5)
    v_mfma_f32_32x32x16_bf16 v[64:79], v[36:39], a[228:231], v[64:79]
    ds_read_b128 v[60:63], v23 offset:57344
    s_add_u32 s23, s23, 131072
    s_add_u32 m0, s21, 0
    s_xor_b32 s20, s23, 0
    buffer_load_dwordx4 v6, s[8:11], s20 offen lds
    s_waitcnt lgkmcnt(5)
    v_mfma_f32_32x32x16_bf16 v[64:79], v[40:43], a[232:235], v[64:79]
    ds_read_b128 v[32:35], v24 offset:0
    s_cmp_eq_u32 s25, 0
    s_cbranch_scc1 mega_kernel_q_v_nf
    v_add_u32 v10, 1, v10
    buffer_store_dword v10, v9, s[84:87], 0 offen sc1
mega_kernel_q_v_nf:
    s_waitcnt lgkmcnt(5)
    v_mfma_f32_32x32x16_bf16 v[64:79], v[44:47], a[236:239], v[64:79]
    ds_read_b128 v[36:39], v25 offset:0
    s_waitcnt lgkmcnt(5)
    v_mfma_f32_32x32x16_bf16 v[64:79], v[48:51], a[240:243], v[64:79]
    ds_read_b128 v[40:43], v26 offset:0
    s_add_u32 m0, s21, 1024
    s_xor_b32 s20, s23, 0
    buffer_load_dwordx4 v7, s[8:11], s20 offen lds
    s_waitcnt lgkmcnt(5)
    v_mfma_f32_32x32x16_bf16 v[64:79], v[52:55], a[244:247], v[64:79]
    ds_read_b128 v[44:47], v27 offset:0
    s_waitcnt lgkmcnt(5)
    v_mfma_f32_32x32x16_bf16 v[64:79], v[56:59], a[248:251], v[64:79]
    ds_read_b128 v[48:51], v28 offset:0
    s_waitcnt lgkmcnt(5)
    v_mfma_f32_32x32x16_bf16 v[64:79], v[60:63], a[252:255], v[64:79]
    ds_read_b128 v[52:55], v29 offset:0
    s_add_u32 m0, s21, 8192
    s_xor_b32 s20, s23, 256
    buffer_load_dwordx4 v6, s[8:11], s20 offen lds
    s_waitcnt lgkmcnt(5)
    v_mfma_f32_32x32x16_bf16 v[80:95], v[32:35], a[0:3], 0
    ds_read_b128 v[56:59], v30 offset:0
    s_waitcnt lgkmcnt(5)
    v_mfma_f32_32x32x16_bf16 v[80:95], v[36:39], a[4:7], v[80:95]
    ds_read_b128 v[60:63], v31 offset:0
    s_waitcnt lgkmcnt(5)
    v_mfma_f32_32x32x16_bf16 v[80:95], v[40:43], a[8:11], v[80:95]
    ds_read_b128 v[32:35], v24 offset:8192
    s_add_u32 m0, s21, 9216
    s_xor_b32 s20, s23, 256
    buffer_load_dwordx4 v7, s[8:11], s20 offen lds
    s_waitcnt lgkmcnt(5)
    v_mfma_f32_32x32x16_bf16 v[80:95], v[44:47], a[12:15], v[80:95]
    ds_read_b128 v[36:39], v25 offset:8192
    s_waitcnt lgkmcnt(5)
    v_mfma_f32_32x32x16_bf16 v[80:95], v[48:51], a[16:19], v[80:95]
    ds_read_b128 v[40:43], v26 offset:8192
    s_waitcnt lgkmcnt(5)
    v_mfma_f32_32x32x16_bf16 v[80:95], v[52:55], a[20:23], v[80:95]
    ds_read_b128 v[44:47], v27 offset:8192
    s_add_u32 m0, s21, 16384
    s_xor_b32 s20, s23, 512
    buffer_load_dwordx4 v6, s[8:11], s20 offen lds
    s_waitcnt lgkmcnt(5)
    v_mfma_f32_32x32x16_bf16 v[80:95], v[56:59], a[24:27], v[80:95]
    ds_read_b128 v[48:51], v28 offset:8192
    s_waitcnt lgkmcnt(5)
    v_mfma_f32_32x32x16_bf16 v[80:95], v[60:63], a[28:31], v[80:95]
    ds_read_b128 v[52:55], v29 offset:8192
    s_waitcnt lgkmcnt(5)
    v_mfma_f32_32x32x16_bf16 v[80:95], v[32:35], a[32:35], v[80:95]
    ds_read_b128 v[56:59], v30 offset:8192
    s_add_u32 m0, s21, 17408
    s_xor_b32 s20, s23, 512
    buffer_load_dwordx4 v7, s[8:11], s20 offen lds
    s_waitcnt lgkmcnt(5)
    v_mfma_f32_32x32x16_bf16 v[80:95], v[36:39], a[36:39], v[80:95]
    ds_read_b128 v[60:63], v31 offset:8192
    s_waitcnt lgkmcnt(5)
    v_mfma_f32_32x32x16_bf16 v[80:95], v[40:43], a[40:43], v[80:95]
    ds_read_b128 v[32:35], v24 offset:16384
    s_waitcnt lgkmcnt(5)
    v_mfma_f32_32x32x16_bf16 v[80:95], v[44:47], a[44:47], v[80:95]
    ds_read_b128 v[36:39], v25 offset:16384
    s_add_u32 m0, s21, 24576
    s_xor_b32 s20, s23, 768
    buffer_load_dwordx4 v6, s[8:11], s20 offen lds
    s_waitcnt lgkmcnt(5)
    v_mfma_f32_32x32x16_bf16 v[80:95], v[48:51], a[48:51], v[80:95]
    ds_read_b128 v[40:43], v26 offset:16384
    s_waitcnt lgkmcnt(5)
    v_mfma_f32_32x32x16_bf16 v[80:95], v[52:55], a[52:55], v[80:95]
    ds_read_b128 v[44:47], v27 offset:16384
    s_waitcnt lgkmcnt(5)
    v_mfma_f32_32x32x16_bf16 v[80:95], v[56:59], a[56:59], v[80:95]
    ds_read_b128 v[48:51], v28 offset:16384
    s_add_u32 m0, s21, 25600
    s_xor_b32 s20, s23, 768
    buffer_load_dwordx4 v7, s[8:11], s20 offen lds
    s_waitcnt lgkmcnt(5)
    v_mfma_f32_32x32x16_bf16 v[80:95], v[60:63], a[60:63], v[80:95]
    ds_read_b128 v[52:55], v29 offset:16384
    s_waitcnt lgkmcnt(5)
    v_mfma_f32_32x32x16_bf16 v[80:95], v[32:35], a[64:67], v[80:95]
    ds_read_b128 v[56:59], v30 offset:16384
    v_cvt_pk_bf16_f32 v96, v64, v65
    v_cvt_pk_bf16_f32 v97, v66, v67
    v_cvt_pk_bf16_f32 v98, v72, v73
    v_cvt_pk_bf16_f32 v99, v74, v75
    buffer_store_dwordx4 v[96:99], v8, s[84:87], s24 offen offset:0 sc1
    s_waitcnt lgkmcnt(5)
    v_mfma_f32_32x32x16_bf16 v[80:95], v[36:39], a[68:71], v[80:95]
    ds_read_b128 v[60:63], v31 offset:16384
    s_waitcnt lgkmcnt(5)
    v_mfma_f32_32x32x16_bf16 v[80:95], v[40:43], a[72:75], v[80:95]
    ds_read_b128 v[32:35], v24 offset:24576
    v_cvt_pk_bf16_f32 v100, v68, v69
    v_cvt_pk_bf16_f32 v101, v70, v71
    v_cvt_pk_bf16_f32 v102, v76, v77
    v_cvt_pk_bf16_f32 v103, v78, v79
    buffer_store_dwordx4 v[100:103], v8, s[84:87], s24 offen offset:512 sc1
    s_add_u32 s24, s24, 524288
    s_waitcnt lgkmcnt(5)
    v_mfma_f32_32x32x16_bf16 v[80:95], v[44:47], a[76:79], v[80:95]
    ds_read_b128 v[36:39], v25 offset:24576
    s_waitcnt lgkmcnt(5)
    v_mfma_f32_32x32x16_bf16 v[80:95], v[48:51], a[80:83], v[80:95]
    ds_read_b128 v[40:43], v26 offset:24576
    s_waitcnt lgkmcnt(5)
    v_mfma_f32_32x32x16_bf16 v[80:95], v[52:55], a[84:87], v[80:95]
    ds_read_b128 v[44:47], v27 offset:24576
    s_waitcnt lgkmcnt(5)
    v_mfma_f32_32x32x16_bf16 v[80:95], v[56:59], a[88:91], v[80:95]
    ds_read_b128 v[48:51], v28 offset:24576
    s_waitcnt lgkmcnt(5)
    v_mfma_f32_32x32x16_bf16 v[80:95], v[60:63], a[92:95], v[80:95]
    ds_read_b128 v[52:55], v29 offset:24576
    s_waitcnt vmcnt(8)
    s_barrier
    s_waitcnt lgkmcnt(5)
    v_mfma_f32_32x32x16_bf16 v[80:95], v[32:35], a[96:99], v[80:95]
    ds_read_b128 v[56:59], v30 offset:24576
    s_waitcnt lgkmcnt(5)
    v_mfma_f32_32x32x16_bf16 v[80:95], v[36:39], a[100:103], v[80:95]
    ds_read_b128 v[60:63], v31 offset:24576
    s_add_u32 m0, s21, 32768
    s_xor_b32 s20, s23, 1024
    buffer_load_dwordx4 v6, s[8:11], s20 offen lds
    s_waitcnt lgkmcnt(5)
    v_mfma_f32_32x32x16_bf16 v[80:95], v[40:43], a[104:107], v[80:95]
    ds_read_b128 v[32:35], v24 offset:32768
    s_waitcnt lgkmcnt(5)
    v_mfma_f32_32x32x16_bf16 v[80:95], v[44:47], a[108:111], v[80:95]
    ds_read_b128 v[36:39], v25 offset:32768
    s_waitcnt lgkmcnt(5)
    v_mfma_f32_32x32x16_bf16 v[80:95], v[48:51], a[112:115], v[80:95]
    ds_read_b128 v[40:43], v26 offset:32768
    s_add_u32 m0, s21, 33792
    s_xor_b32 s20, s23, 1024
    buffer_load_dwordx4 v7, s[8:11], s20 offen lds
    s_waitcnt lgkmcnt(5)
    v_mfma_f32_32x32x16_bf16 v[80:95], v[52:55], a[116:119], v[80:95]
    ds_read_b128 v[44:47], v27 offset:32768
    s_waitcnt lgkmcnt(5)
    v_mfma_f32_32x32x16_bf16 v[80:95], v[56:59], a[120:123], v[80:95]
    ds_read_b128 v[48:51], v28 offset:32768
    s_waitcnt lgkmcnt(5)
    v_mfma_f32_32x32x16_bf16 v[80:95], v[60:63], a[124:127], v[80:95]
    ds_read_b128 v[52:55], v29 offset:32768
    s_add_u32 m0, s21, 40960
    s_xor_b32 s20, s23, 1280
    buffer_load_dwordx4 v6, s[8:11], s20 offen lds
    s_waitcnt lgkmcnt(5)
    v_mfma_f32_32x32x16_bf16 v[80:95], v[32:35], a[128:131], v[80:95]
    ds_read_b128 v[56:59], v30 offset:32768
    s_waitcnt lgkmcnt(5)
    v_mfma_f32_32x32x16_bf16 v[80:95], v[36:39], a[132:135], v[80:95]
    ds_read_b128 v[60:63], v31 offset:32768
    s_waitcnt lgkmcnt(5)
    v_mfma_f32_32x32x16_bf16 v[80:95], v[40:43], a[136:139], v[80:95]
    ds_read_b128 v[32:35], v24 offset:40960
    s_add_u32 m0, s21, 41984
    s_xor_b32 s20, s23, 1280
    buffer_load_dwordx4 v7, s[8:11], s20 offen lds
    s_waitcnt lgkmcnt(5)
    v_mfma_f32_32x32x16_bf16 v[80:95], v[44:47], a[140:143], v[80:95]
    ds_read_b128 v[36:39], v25 offset:40960
    s_waitcnt lgkmcnt(5)
    v_mfma_f32_32x32x16_bf16 v[80:95], v[48:51], a[144:147], v[80:95]
    ds_read_b128 v[40:43], v26 offset:40960
    s_waitcnt lgkmcnt(5)
    v_mfma_f32_32x32x16_bf16 v[80:95], v[52:55], a[148:151], v[80:95]
    ds_read_b128 v[44:47], v27 offset:40960
    s_add_u32 m0, s21, 49152
    s_xor_b32 s20, s23, 1536
    buffer_load_dwordx4 v6, s[8:11], s20 offen lds
    s_waitcnt lgkmcnt(5)
    v_mfma_f32_32x32x16_bf16 v[80:95], v[56:59], a[152:155], v[80:95]
    ds_read_b128 v[48:51], v28 offset:40960
    s_waitcnt lgkmcnt(5)
    v_mfma_f32_32x32x16_bf16 v[80:95], v[60:63], a[156:159], v[80:95]
    ds_read_b128 v[52:55], v29 offset:40960
    s_waitcnt lgkmcnt(5)
    v_mfma_f32_32x32x16_bf16 v[80:95], v[32:35], a[160:163], v[80:95]
    ds_read_b128 v[56:59], v30 offset:40960
    s_add_u32 m0, s21, 50176
    s_xor_b32 s20, s23, 1536
    buffer_load_dwordx4 v7, s[8:11], s20 offen lds
    s_waitcnt lgkmcnt(5)
    v_mfma_f32_32x32x16_bf16 v[80:95], v[36:39], a[164:167], v[80:95]
    ds_read_b128 v[60:63], v31 offset:40960
    s_waitcnt lgkmcnt(5)
    v_mfma_f32_32x32x16_bf16 v[80:95], v[40:43], a[168:171], v[80:95]
    ds_read_b128 v[32:35], v24 offset:49152
    s_waitcnt lgkmcnt(5)
    v_mfma_f32_32x32x16_bf16 v[80:95], v[44:47], a[172:175], v[80:95]
    ds_read_b128 v[36:39], v25 offset:49152
    s_add_u32 m0, s21, 57344
    s_xor_b32 s20, s23, 1792
    buffer_load_dwordx4 v6, s[8:11], s20 offen lds
    s_waitcnt lgkmcnt(5)
    v_mfma_f32_32x32x16_bf16 v[80:95], v[48:51], a[176:179], v[80:95]
    ds_read_b128 v[40:43], v26 offset:49152
    s_waitcnt lgkmcnt(5)
    v_mfma_f32_32x32x16_bf16 v[80:95], v[52:55], a[180:183], v[80:95]
    ds_read_b128 v[44:47], v27 offset:49152
    s_waitcnt lgkmcnt(5)
    v_mfma_f32_32x32x16_bf16 v[80:95], v[56:59], a[184:187], v[80:95]
    ds_read_b128 v[48:51], v28 offset:49152
    s_add_u32 m0, s21, 58368
    s_xor_b32 s20, s23, 1792
    buffer_load_dwordx4 v7, s[8:11], s20 offen lds
    s_waitcnt lgkmcnt(5)
    v_mfma_f32_32x32x16_bf16 v[80:95], v[60:63], a[188:191], v[80:95]
    ds_read_b128 v[52:55], v29 offset:49152
    s_waitcnt lgkmcnt(5)
    v_mfma_f32_32x32x16_bf16 v[80:95], v[32:35], a[192:195], v[80:95]
    ds_read_b128 v[56:59], v30 offset:49152
    s_waitcnt lgkmcnt(5)
    v_mfma_f32_32x32x16_bf16 v[80:95], v[36:39], a[196:199], v[80:95]
    ds_read_b128 v[60:63], v31 offset:49152
    s_waitcnt lgkmcnt(5)
    v_mfma_f32_32x32x16_bf16 v[80:95], v[40:43], a[200:203], v[80:95]
    ds_read_b128 v[32:35], v24 offset:57344
    s_waitcnt lgkmcnt(5)
    v_mfma_f32_32x32x16_bf16 v[80:95], v[44:47], a[204:207], v[80:95]
    ds_read_b128 v[36:39], v25 offset:57344
    s_waitcnt lgkmcnt(5)
    v_mfma_f32_32x32x16_bf16 v[80:95], v[48:51], a[208:211], v[80:95]
    ds_read_b128 v[40:43], v26 offset:57344
    s_waitcnt lgkmcnt(5)
    v_mfma_f32_32x32x16_bf16 v[80:95], v[52:55], a[212:215], v[80:95]
    ds_read_b128 v[44:47], v27 offset:57344
    s_waitcnt lgkmcnt(5)
    v_mfma_f32_32x32x16_bf16 v[80:95], v[56:59], a[216:219], v[80:95]
    ds_read_b128 v[48:51], v28 offset:57344
    s_waitcnt lgkmcnt(5)
    v_mfma_f32_32x32x16_bf16 v[80:95], v[60:63], a[220:223], v[80:95]
    ds_read_b128 v[52:55], v29 offset:57344
    s_waitcnt vmcnt(8)
    s_barrier
    s_waitcnt lgkmcnt(5)
    v_mfma_f32_32x32x16_bf16 v[80:95], v[32:35], a[224:227], v[80:95]
    ds_read_b128 v[56:59], v30 offset:57344
    s_waitcnt lgkmcnt(5)
    v_mfma_f32_32x32x16_bf16 v[80:95], v[36:39], a[228:231], v[80:95]
    ds_read_b128 v[60:63], v31 offset:57344
    s_add_u32 s23, s23, 131072
    s_add_u32 m0, s21, 65536
    s_xor_b32 s20, s23, 0
    buffer_load_dwordx4 v6, s[8:11], s20 offen lds
    s_waitcnt lgkmcnt(5)
    v_mfma_f32_32x32x16_bf16 v[80:95], v[40:43], a[232:235], v[80:95]
    ds_read_b128 v[32:35], v16 offset:0
    v_add_u32 v10, 1, v10
    buffer_store_dword v10, v9, s[84:87], 0 offen sc1
    s_waitcnt lgkmcnt(5)
    v_mfma_f32_32x32x16_bf16 v[80:95], v[44:47], a[236:239], v[80:95]
    ds_read_b128 v[36:39], v17 offset:0
    s_waitcnt lgkmcnt(5)
    v_mfma_f32_32x32x16_bf16 v[80:95], v[48:51], a[240:243], v[80:95]
    ds_read_b128 v[40:43], v18 offset:0
    s_add_u32 m0, s21, 66560
    s_xor_b32 s20, s23, 0
    buffer_load_dwordx4 v7, s[8:11], s20 offen lds
    s_waitcnt lgkmcnt(5)
    v_mfma_f32_32x32x16_bf16 v[80:95], v[52:55], a[244:247], v[80:95]
    ds_read_b128 v[44:47], v19 offset:0
    s_waitcnt lgkmcnt(5)
    v_mfma_f32_32x32x16_bf16 v[80:95], v[56:59], a[248:251], v[80:95]
    ds_read_b128 v[48:51], v20 offset:0
    s_waitcnt lgkmcnt(5)
    v_mfma_f32_32x32x16_bf16 v[80:95], v[60:63], a[252:255], v[80:95]
    ds_read_b128 v[52:55], v21 offset:0
    s_add_u32 m0, s21, 73728
    s_xor_b32 s20, s23, 256
    buffer_load_dwordx4 v6, s[8:11], s20 offen lds
    s_add_u32 s25, s25, 1
    s_cmp_lt_u32 s25, 16
    s_cbranch_scc1 mega_kernel_q_v_loop
    s_nop 11
    v_cvt_pk_bf16_f32 v96, v80, v81
    v_cvt_pk_bf16_f32 v97, v82, v83
    v_cvt_pk_bf16_f32 v98, v88, v89
    v_cvt_pk_bf16_f32 v99, v90, v91
    buffer_store_dwordx4 v[96:99], v8, s[84:87], s24 offen offset:0 sc1
    v_cvt_pk_bf16_f32 v100, v84, v85
    v_cvt_pk_bf16_f32 v101, v86, v87
    v_cvt_pk_bf16_f32 v102, v92, v93
    v_cvt_pk_bf16_f32 v103, v94, v95
    buffer_store_dwordx4 v[100:103], v8, s[84:87], s24 offen offset:512 sc1
    s_add_u32 s24, s24, 524288
    s_waitcnt vmcnt(0) lgkmcnt(0)
    s_barrier
    v_add_u32 v10, 1, v10
    buffer_store_dword v10, v9, s[84:87], 0 offen sc1
mega_kernel_q_done:
    s_load_dwordx2 s[52:53], s[0:1], 40
    v_and_b32 v202, 63, v0
    s_and_b32 s58, s92, 31
    v_lshrrev_b32 v200, 2, v202
    v_lshlrev_b32 v200, 11, v200
    v_and_b32 v203, 3, v202
    v_lshl_add_u32 v200, v203, 4, v200
    s_lshl_b32 s56, s98, 21
    s_lshl_b32 s57, s58, 6
    s_add_u32 s56, s56, s57
    v_add_u32 v200, s56, v200
    s_lshl_b32 s56, s98, 14
    s_add_u32 s56, s56, 81920
    s_lshr_b32 s57, s58, 1
    s_lshl_b32 s57, s57, 12
    v_lshrrev_b32 v201, 5, v202
    v_bfe_u32 v204, v202, 2, 2
    v_lshl_add_u32 v201, v201, 3, v204
    v_lshlrev_b32 v201, 6, v201
    v_bfe_u32 v204, v202, 4, 1
    v_lshl_add_u32 v201, v204, 5, v201
    v_lshl_add_u32 v201, v203, 3, v201
    v_add_u32 v201, s56, v201
    s_waitcnt lgkmcnt(0)
    s_mov_b32 s54, 8388608
    s_mov_b32 s55, 0x00020000
    s_add_u32 m0, s56, 0
    s_add_u32 s58, s57, 0
    s_and_b32 s58, s58, 0xffff
    s_lshl_b32 s58, s58, 5
    buffer_load_dwordx4 v200, s[52:55], s58 offen lds
    s_add_u32 m0, s56, 1024
    s_add_u32 s58, s57, 1024
    s_and_b32 s58, s58, 0xffff
    s_lshl_b32 s58, s58, 5
    buffer_load_dwordx4 v200, s[52:55], s58 offen lds
    s_add_u32 m0, s56, 2048
    s_add_u32 s58, s57, 2048
    s_and_b32 s58, s58, 0xffff
    s_lshl_b32 s58, s58, 5
    buffer_load_dwordx4 v200, s[52:55], s58 offen lds
    s_add_u32 m0, s56, 3072
    s_add_u32 s58, s57, 3072
    s_and_b32 s58, s58, 0xffff
    s_lshl_b32 s58, s58, 5
    buffer_load_dwordx4 v200, s[52:55], s58 offen lds
    s_add_u32 m0, s56, 4096
    s_add_u32 s58, s57, 4096
    s_and_b32 s58, s58, 0xffff
    s_lshl_b32 s58, s58, 5
    buffer_load_dwordx4 v200, s[52:55], s58 offen lds
    s_add_u32 m0, s56, 5120
    s_add_u32 s58, s57, 5120
    s_and_b32 s58, s58, 0xffff
    s_lshl_b32 s58, s58, 5
    buffer_load_dwordx4 v200, s[52:55], s58 offen lds
    s_add_u32 m0, s56, 6144
    s_add_u32 s58, s57, 6144
    s_and_b32 s58, s58, 0xffff
    s_lshl_b32 s58, s58, 5
    buffer_load_dwordx4 v200, s[52:55], s58 offen lds
    s_add_u32 m0, s56, 7168
    s_add_u32 s58, s57, 7168
    s_and_b32 s58, s58, 0xffff
    s_lshl_b32 s58, s58, 5
    buffer_load_dwordx4 v200, s[52:55], s58 offen lds
    s_add_u32 m0, s56, 8192
    s_add_u32 s58, s57, 8192
    s_and_b32 s58, s58, 0xffff
    s_lshl_b32 s58, s58, 5
    buffer_load_dwordx4 v200, s[52:55], s58 offen lds
    s_add_u32 m0, s56, 9216
    s_add_u32 s58, s57, 9216
    s_and_b32 s58, s58, 0xffff
    s_lshl_b32 s58, s58, 5
    buffer_load_dwordx4 v200, s[52:55], s58 offen lds
    s_add_u32 m0, s56, 10240
    s_add_u32 s58, s57, 10240
    s_and_b32 s58, s58, 0xffff
    s_lshl_b32 s58, s58, 5
    buffer_load_dwordx4 v200, s[52:55], s58 offen lds
    s_add_u32 m0, s56, 11264
    s_add_u32 s58, s57, 11264
    s_and_b32 s58, s58, 0xffff
    s_lshl_b32 s58, s58, 5
    buffer_load_dwordx4 v200, s[52:55], s58 offen lds
    s_add_u32 m0, s56, 12288
    s_add_u32 s58, s57, 12288
    s_and_b32 s58, s58, 0xffff
    s_lshl_b32 s58, s58, 5
    buffer_load_dwordx4 v200, s[52:55], s58 offen lds
    s_add_u32 m0, s56, 13312
    s_add_u32 s58, s57, 13312
    s_and_b32 s58, s58, 0xffff
    s_lshl_b32 s58, s58, 5
    buffer_load_dwordx4 v200, s[52:55], s58 offen lds
    s_add_u32 m0, s56, 14336
    s_add_u32 s58, s57, 14336
    s_and_b32 s58, s58, 0xffff
    s_lshl_b32 s58, s58, 5
    buffer_load_dwordx4 v200, s[52:55], s58 offen lds
    s_add_u32 m0, s56, 15360
    s_add_u32 s58, s57, 15360
    s_and_b32 s58, s58, 0xffff
    s_lshl_b32 s58, s58, 5
    buffer_load_dwordx4 v200, s[52:55], s58 offen lds
    s_cmp_lt_u32 s92, 128
    s_cbranch_scc1 mega_kernel_f1
    s_sub_u32 s99, s92, 128
mega_kernel_f0l:
    s_barrier
    s_load_dwordx2 s[4:5], s[0:1], 64
    s_load_dwordx2 s[8:9], s[0:1], 72
    s_load_dwordx2 s[12:13], s[0:1], 96
    s_and_b32 s16, s99, 31
    s_lshr_b32 s17, s99, 5
    v_and_b32 v1, 63, v0
    v_lshrrev_b32 v2, 6, v0
    s_waitcnt lgkmcnt(0)
    s_mov_b32 s6, 2101248
    s_mov_b32 s7, 0x00020000
    s_mov_b32 s10, 2101248
    s_mov_b32 s11, 0x00020000
    s_add_u32 s12, s12, 121634816
    s_addc_u32 s13, s13, 0
    s_mov_b32 s14, 4202496
    s_mov_b32 s15, 0x00020000
    s_lshl_b32 s18, s16, 6
    v_add_u32 v3, s18, v2
    s_movk_i32 s19, 1026
    v_mul_lo_u32 v3, v3, s19
    s_lshl_b32 s18, s17, 7
    v_add_u32 v3, s18, v3
    v_lshl_add_u32 v3, v1, 1, v3
    s_mov_b32 s18, 0
    buffer_load_ushort v16, v3, s[4:7], s18 offen
    buffer_load_ushort v32, v3, s[8:11], s18 offen
    s_mov_b32 s18, 4104
    buffer_load_ushort v17, v3, s[4:7], s18 offen
    buffer_load_ushort v33, v3, s[8:11], s18 offen
    s_mov_b32 s18, 8208
    buffer_load_ushort v18, v3, s[4:7], s18 offen
    buffer_load_ushort v34, v3, s[8:11], s18 offen
    s_mov_b32 s18, 12312
    buffer_load_ushort v19, v3, s[4:7], s18 offen
    buffer_load_ushort v35, v3, s[8:11], s18 offen
    s_mov_b32 s18, 16416
    buffer_load_ushort v20, v3, s[4:7], s18 offen
    buffer_load_ushort v36, v3, s[8:11], s18 offen
    s_mov_b32 s18, 20520
    buffer_load_ushort v21, v3, s[4:7], s18 offen
    buffer_load_ushort v37, v3, s[8:11], s18 offen
    s_mov_b32 s18, 24624
    buffer_load_ushort v22, v3, s[4:7], s18 offen
    buffer_load_ushort v38, v3, s[8:11], s18 offen
    s_mov_b32 s18, 28728
    buffer_load_ushort v23, v3, s[4:7], s18 offen
    buffer_load_ushort v39, v3, s[8:11], s18 offen
    s_mov_b32 s18, 32832
    buffer_load_ushort v24, v3, s[4:7], s18 offen
    buffer_load_ushort v40, v3, s[8:11], s18 offen
    s_mov_b32 s18, 36936
    buffer_load_ushort v25, v3, s[4:7], s18 offen
    buffer_load_ushort v41, v3, s[8:11], s18 offen
    s_mov_b32 s18, 41040
    buffer_load_ushort v26, v3, s[4:7], s18 offen
    buffer_load_ushort v42, v3, s[8:11], s18 offen
    s_mov_b32 s18, 45144
    buffer_load_ushort v27, v3, s[4:7], s18 offen
    buffer_load_ushort v43, v3, s[8:11], s18 offen
    s_mov_b32 s18, 49248
    buffer_load_ushort v28, v3, s[4:7], s18 offen
    buffer_load_ushort v44, v3, s[8:11], s18 offen
    s_mov_b32 s18, 53352
    buffer_load_ushort v29, v3, s[4:7], s18 offen
    buffer_load_ushort v45, v3, s[8:11], s18 offen
    s_mov_b32 s18, 57456
    buffer_load_ushort v30, v3, s[4:7], s18 offen
    buffer_load_ushort v46, v3, s[8:11], s18 offen
    s_mov_b32 s18, 61560
    buffer_load_ushort v31, v3, s[4:7], s18 offen
    buffer_load_ushort v47, v3, s[8:11], s18 offen
    v_mul_u32_u24 v4, 65, v1
    v_add_u32 v4, v4, v2
    v_lshlrev_b32 v4, 2, v4
    s_waitcnt vmcnt(0)
    v_lshl_or_b32 v16, v32, 16, v16
    ds_write_b32 v4, v16 offset:0
    v_lshl_or_b32 v17, v33, 16, v17
    ds_write_b32 v4, v17 offset:16
    v_lshl_or_b32 v18, v34, 16, v18
    ds_write_b32 v4, v18 offset:32
    v_lshl_or_b32 v19, v35, 16, v19
    ds_write_b32 v4, v19 offset:48
    v_lshl_or_b32 v20, v36, 16, v20
    ds_write_b32 v4, v20 offset:64
    v_lshl_or_b32 v21, v37, 16, v21
    ds_write_b32 v4, v21 offset:80
    v_lshl_or_b32 v22, v38, 16, v22
    ds_write_b32 v4, v22 offset:96
    v_lshl_or_b32 v23, v39, 16, v23
    ds_write_b32 v4, v23 offset:112
    v_lshl_or_b32 v24, v40, 16, v24
    ds_write_b32 v4, v24 offset:128
    v_lshl_or_b32 v25, v41, 16, v25
    ds_write_b32 v4, v25 offset:144
    v_lshl_or_b32 v26, v42, 16, v26
    ds_write_b32 v4, v26 offset:160
    v_lshl_or_b32 v27, v43, 16, v27
    ds_write_b32 v4, v27 offset:176
    v_lshl_or_b32 v28, v44, 16, v28
    ds_write_b32 v4, v28 offset:192
    v_lshl_or_b32 v29, v45, 16, v29
    ds_write_b32 v4, v29 offset:208
    v_lshl_or_b32 v30, v46, 16, v30
    ds_write_b32 v4, v30 offset:224
    v_lshl_or_b32 v31, v47, 16, v31
    ds_write_b32 v4, v31 offset:240
    v_lshrrev_b32 v7, 4, v0
    v_and_b32 v8, 15, v0
    v_mul_u32_u24 v5, 65, v7
    v_lshl_add_u32 v5, v8, 2, v5
    v_lshlrev_b32 v5, 2, v5
    s_waitcnt lgkmcnt(0)
    s_barrier
    ds_read_b32 v16, v5 offset:0
    ds_read_b32 v17, v5 offset:4
    ds_read_b32 v18, v5 offset:8
    ds_read_b32 v19, v5 offset:12
    ds_read_b32 v20, v5 offset:4160
    ds_read_b32 v21, v5 offset:4164
    ds_read_b32 v22, v5 offset:4168
    ds_read_b32 v23, v5 offset:4172
    ds_read_b32 v24, v5 offset:8320
    ds_read_b32 v25, v5 offset:8324
    ds_read_b32 v26, v5 offset:8328
    ds_read_b32 v27, v5 offset:8332
    ds_read_b32 v28, v5 offset:12480
    ds_read_b32 v29, v5 offset:12484
    ds_read_b32 v30, v5 offset:12488
    ds_read_b32 v31, v5 offset:12492
    s_lshl_b32 s18, s17, 6
    v_add_u32 v6, s18, v7
    v_lshlrev_b32 v6, 13, v6
    s_lshl_b32 s18, s16, 8
    v_add_u32 v6, s18, v6
    v_lshl_add_u32 v6, v8, 4, v6
    s_waitcnt lgkmcnt(0)
    s_mov_b32 s18, 0
    buffer_store_dwordx4 v[16:19], v6, s[12:15], s18 offen sc1
    s_mov_b32 s18, 131072
    buffer_store_dwordx4 v[20:23], v6, s[12:15], s18 offen sc1
    s_mov_b32 s18, 262144
    buffer_store_dwordx4 v[24:27], v6, s[12:15], s18 offen sc1
    s_mov_b32 s18, 393216
    buffer_store_dwordx4 v[28:31], v6, s[12:15], s18 offen sc1
    s_add_u32 s99, s99, 64
    s_cmp_lt_u32 s99, 288
    s_cbranch_scc1 mega_kernel_f0l
    s_branch mega_kernel_f1d
mega_kernel_f1:
    s_barrier
    s_load_dwordx2 s[4:5], s[0:1], 56
    s_load_dwordx2 s[8:9], s[0:1], 96
    v_and_b32 v1, 31, v0
    v_lshrrev_b32 v2, 5, v0
    v_cvt_f32_u32 v3, v1
    s_waitcnt lgkmcnt(0)
    s_mov_b32 s6, 4194304
    s_mov_b32 s7, 0x00020000
    s_mov_b32 s10, 268435456
    s_mov_b32 s11, 0x00020000
    s_lshl_b32 s12, s92, 15
    v_lshlrev_b32 v6, 12, v2
    v_lshl_add_u32 v6, v1, 1, v6
    buffer_load_ushort v16, v6, s[4:7], s12 offen offset:0
    buffer_load_ushort v48, v6, s[4:7], s12 offen offset:2048
    buffer_load_ushort v17, v6, s[4:7], s12 offen offset:64
    buffer_load_ushort v49, v6, s[4:7], s12 offen offset:2112
    buffer_load_ushort v18, v6, s[4:7], s12 offen offset:128
    buffer_load_ushort v50, v6, s[4:7], s12 offen offset:2176
    buffer_load_ushort v19, v6, s[4:7], s12 offen offset:192
    buffer_load_ushort v51, v6, s[4:7], s12 offen offset:2240
    buffer_load_ushort v20, v6, s[4:7], s12 offen offset:256
    buffer_load_ushort v52, v6, s[4:7], s12 offen offset:2304
    buffer_load_ushort v21, v6, s[4:7], s12 offen offset:320
    buffer_load_ushort v53, v6, s[4:7], s12 offen offset:2368
    buffer_load_ushort v22, v6, s[4:7], s12 offen offset:384
    buffer_load_ushort v54, v6, s[4:7], s12 offen offset:2432
    buffer_load_ushort v23, v6, s[4:7], s12 offen offset:448
    buffer_load_ushort v55, v6, s[4:7], s12 offen offset:2496
    buffer_load_ushort v24, v6, s[4:7], s12 offen offset:512
    buffer_load_ushort v56, v6, s[4:7], s12 offen offset:2560
    buffer_load_ushort v25, v6, s[4:7], s12 offen offset:576
    buffer_load_ushort v57, v6, s[4:7], s12 offen offset:2624
    buffer_load_ushort v26, v6, s[4:7], s12 offen offset:640
    buffer_load_ushort v58, v6, s[4:7], s12 offen offset:2688
    buffer_load_ushort v27, v6, s[4:7], s12 offen offset:704
    buffer_load_ushort v59, v6, s[4:7], s12 offen offset:2752
    buffer_load_ushort v28, v6, s[4:7], s12 offen offset:768
    buffer_load_ushort v60, v6, s[4:7], s12 offen offset:2816
    buffer_load_ushort v29, v6, s[4:7], s12 offen offset:832
    buffer_load_ushort v61, v6, s[4:7], s12 offen offset:2880
    buffer_load_ushort v30, v6, s[4:7], s12 offen offset:896
    buffer_load_ushort v62, v6, s[4:7], s12 offen offset:2944
    buffer_load_ushort v31, v6, s[4:7], s12 offen offset:960
    buffer_load_ushort v63, v6, s[4:7], s12 offen offset:3008
    buffer_load_ushort v32, v6, s[4:7], s12 offen offset:1024
    buffer_load_ushort v64, v6, s[4:7], s12 offen offset:3072
    buffer_load_ushort v33, v6, s[4:7], s12 offen offset:1088
    buffer_load_ushort v65, v6, s[4:7], s12 offen offset:3136
    buffer_load_ushort v34, v6, s[4:7], s12 offen offset:1152
    buffer_load_ushort v66, v6, s[4:7], s12 offen offset:3200
    buffer_load_ushort v35, v6, s[4:7], s12 offen offset:1216
    buffer_load_ushort v67, v6, s[4:7], s12 offen offset:3264
    buffer_load_ushort v36, v6, s[4:7], s12 offen offset:1280
    buffer_load_ushort v68, v6, s[4:7], s12 offen offset:3328
    buffer_load_ushort v37, v6, s[4:7], s12 offen offset:1344
    buffer_load_ushort v69, v6, s[4:7], s12 offen offset:3392
    buffer_load_ushort v38, v6, s[4:7], s12 offen offset:1408
    buffer_load_ushort v70, v6, s[4:7], s12 offen offset:3456
    buffer_load_ushort v39, v6, s[4:7], s12 offen offset:1472
    buffer_load_ushort v71, v6, s[4:7], s12 offen offset:3520
    buffer_load_ushort v40, v6, s[4:7], s12 offen offset:1536
    buffer_load_ushort v72, v6, s[4:7], s12 offen offset:3584
    buffer_load_ushort v41, v6, s[4:7], s12 offen offset:1600
    buffer_load_ushort v73, v6, s[4:7], s12 offen offset:3648
    buffer_load_ushort v42, v6, s[4:7], s12 offen offset:1664
    buffer_load_ushort v74, v6, s[4:7], s12 offen offset:3712
    buffer_load_ushort v43, v6, s[4:7], s12 offen offset:1728
    buffer_load_ushort v75, v6, s[4:7], s12 offen offset:3776
    buffer_load_ushort v44, v6, s[4:7], s12 offen offset:1792
    buffer_load_ushort v76, v6, s[4:7], s12 offen offset:3840
    buffer_load_ushort v45, v6, s[4:7], s12 offen offset:1856
    buffer_load_ushort v77, v6, s[4:7], s12 offen offset:3904
    buffer_load_ushort v46, v6, s[4:7], s12 offen offset:1920
    buffer_load_ushort v78, v6, s[4:7], s12 offen offset:3968
    buffer_load_ushort v47, v6, s[4:7], s12 offen offset:1984
    buffer_load_ushort v79, v6, s[4:7], s12 offen offset:4032
    s_movk_i32 s13, 8448
    v_mul_lo_u32 v7, v2, s13
    v_lshl_add_u32 v4, v1, 3, v7
    s_movk_i32 s13, 264
    v_mul_lo_u32 v5, v1, s13
    v_add_u32 v5, v5, v7
    s_waitcnt vmcnt(0)
    v_lshlrev_b32 v16, 16, v16
    v_lshlrev_b32 v48, 16, v48
    v_lshlrev_b32 v17, 16, v17
    v_lshlrev_b32 v49, 16, v49
    v_lshlrev_b32 v18, 16, v18
    v_lshlrev_b32 v50, 16, v50
    v_lshlrev_b32 v19, 16, v19
    v_lshlrev_b32 v51, 16, v51
    v_lshlrev_b32 v20, 16, v20
    v_lshlrev_b32 v52, 16, v52
    v_lshlrev_b32 v21, 16, v21
    v_lshlrev_b32 v53, 16, v53
    v_lshlrev_b32 v22, 16, v22
    v_lshlrev_b32 v54, 16, v54
    v_lshlrev_b32 v23, 16, v23
    v_lshlrev_b32 v55, 16, v55
    v_lshlrev_b32 v24, 16, v24
    v_lshlrev_b32 v56, 16, v56
    v_lshlrev_b32 v25, 16, v25
    v_lshlrev_b32 v57, 16, v57
    v_lshlrev_b32 v26, 16, v26
    v_lshlrev_b32 v58, 16, v58
    v_lshlrev_b32 v27, 16, v27
    v_lshlrev_b32 v59, 16, v59
    v_lshlrev_b32 v28, 16, v28
    v_lshlrev_b32 v60, 16, v60
    v_lshlrev_b32 v29, 16, v29
    v_lshlrev_b32 v61, 16, v61
    v_lshlrev_b32 v30, 16, v30
    v_lshlrev_b32 v62, 16, v62
    v_lshlrev_b32 v31, 16, v31
    v_lshlrev_b32 v63, 16, v63
    v_lshlrev_b32 v32, 16, v32
    v_lshlrev_b32 v64, 16, v64
    v_lshlrev_b32 v33, 16, v33
    v_lshlrev_b32 v65, 16, v65
    v_lshlrev_b32 v34, 16, v34
    v_lshlrev_b32 v66, 16, v66
    v_lshlrev_b32 v35, 16, v35
    v_lshlrev_b32 v67, 16, v67
    v_lshlrev_b32 v36, 16, v36
    v_lshlrev_b32 v68, 16, v68
    v_lshlrev_b32 v37, 16, v37
    v_lshlrev_b32 v69, 16, v69
    v_lshlrev_b32 v38, 16, v38
    v_lshlrev_b32 v70, 16, v70
    v_lshlrev_b32 v39, 16, v39
    v_lshlrev_b32 v71, 16, v71
    v_lshlrev_b32 v40, 16, v40
    v_lshlrev_b32 v72, 16, v72
    v_lshlrev_b32 v41, 16, v41
    v_lshlrev_b32 v73, 16, v73
    v_lshlrev_b32 v42, 16, v42
    v_lshlrev_b32 v74, 16, v74
    v_lshlrev_b32 v43, 16, v43
    v_lshlrev_b32 v75, 16, v75
    v_lshlrev_b32 v44, 16, v44
    v_lshlrev_b32 v76, 16, v76
    v_lshlrev_b32 v45, 16, v45
    v_lshlrev_b32 v77, 16, v77
    v_lshlrev_b32 v46, 16, v46
    v_lshlrev_b32 v78, 16, v78
    v_lshlrev_b32 v47, 16, v47
    v_lshlrev_b32 v79, 16, v79
    v_sub_f32 v80, v16, v32
    v_sub_f32 v81, v48, v64
    v_add_f32 v16, v16, v32
    v_add_f32 v48, v48, v64
    v_sub_f32 v32, v17, v33
    v_sub_f32 v64, v49, v65
    v_add_f32 v17, v17, v33
    v_add_f32 v49, v49, v65
    v_mul_f32 v33, 0x3f7b14be, v32
    v_mul_f32 v65, 0xbe47c5c2, v32
    v_fmac_f32 v33, 0x3e47c5c2, v64
    v_fmac_f32 v65, 0x3f7b14be, v64
    v_sub_f32 v32, v18, v34
    v_sub_f32 v64, v50, v66
    v_add_f32 v18, v18, v34
    v_add_f32 v50, v50, v66
    v_mul_f32 v34, 0x3f6c835e, v32
    v_mul_f32 v66, 0xbec3ef15, v32
    v_fmac_f32 v34, 0x3ec3ef15, v64
    v_fmac_f32 v66, 0x3f6c835e, v64
    v_sub_f32 v32, v19, v35
    v_sub_f32 v64, v51, v67
    v_add_f32 v19, v19, v35
    v_add_f32 v51, v51, v67
    v_mul_f32 v35, 0x3f54db31, v32
    v_mul_f32 v67, 0xbf0e39da, v32
    v_fmac_f32 v35, 0x3f0e39da, v64
    v_fmac_f32 v67, 0x3f54db31, v64
    v_sub_f32 v32, v20, v36
    v_sub_f32 v64, v52, v68
    v_add_f32 v20, v20, v36
    v_add_f32 v52, v52, v68
    v_mul_f32 v36, 0x3f3504f3, v32
    v_mul_f32 v68, 0xbf3504f3, v32
    v_fmac_f32 v36, 0x3f3504f3, v64
    v_fmac_f32 v68, 0x3f3504f3, v64
    v_sub_f32 v32, v21, v37
    v_sub_f32 v64, v53, v69
    v_add_f32 v21, v21, v37
    v_add_f32 v53, v53, v69
    v_mul_f32 v37, 0x3f0e39da, v32
    v_mul_f32 v69, 0xbf54db31, v32
    v_fmac_f32 v37, 0x3f54db31, v64
    v_fmac_f32 v69, 0x3f0e39da, v64
    v_sub_f32 v32, v22, v38
    v_sub_f32 v64, v54, v70
    v_add_f32 v22, v22, v38
    v_add_f32 v54, v54, v70
    v_mul_f32 v38, 0x3ec3ef15, v32
    v_mul_f32 v70, 0xbf6c835e, v32
    v_fmac_f32 v38, 0x3f6c835e, v64
    v_fmac_f32 v70, 0x3ec3ef15, v64
    v_sub_f32 v32, v23, v39
    v_sub_f32 v64, v55, v71
    v_add_f32 v23, v23, v39
    v_add_f32 v55, v55, v71
    v_mul_f32 v39, 0x3e47c5c2, v32
    v_mul_f32 v71, 0xbf7b14be, v32
    v_fmac_f32 v39, 0x3f7b14be, v64
    v_fmac_f32 v71, 0x3e47c5c2, v64
    v_sub_f32 v32, v56, v72
    v_sub_f32 v64, v40, v24
    v_add_f32 v24, v24, v40
    v_add_f32 v56, v56, v72
    v_sub_f32 v40, v25, v41
    v_sub_f32 v72, v57, v73
    v_add_f32 v25, v25, v41
    v_add_f32 v57, v57, v73
    v_mul_f32 v41, 0xbe47c5c2, v40
    v_mul_f32 v73, 0xbf7b14be, v40
    v_fmac_f32 v41, 0x3f7b14be, v72
    v_fmac_f32 v73, 0xbe47c5c2, v72
    v_sub_f32 v40, v26, v42
    v_sub_f32 v72, v58, v74
    v_add_f32 v26, v26, v42
    v_add_f32 v58, v58, v74
    v_mul_f32 v42, 0xbec3ef15, v40
    v_mul_f32 v74, 0xbf6c835e, v40
    v_fmac_f32 v42, 0x3f6c835e, v72
    v_fmac_f32 v74, 0xbec3ef15, v72
    v_sub_f32 v40, v27, v43
    v_sub_f32 v72, v59, v75
    v_add_f32 v27, v27, v43
    v_add_f32 v59, v59, v75
    v_mul_f32 v43, 0xbf0e39da, v40
    v_mul_f32 v75, 0xbf54db31, v40
    v_fmac_f32 v43, 0x3f54db31, v72
    v_fmac_f32 v75, 0xbf0e39da, v72
    v_sub_f32 v40, v28, v44
    v_sub_f32 v72, v60, v76
    v_add_f32 v28, v28, v44
    v_add_f32 v60, v60, v76
    v_mul_f32 v44, 0xbf3504f3, v40
    v_mul_f32 v76, 0xbf3504f3, v40
    v_fmac_f32 v44, 0x3f3504f3, v72
    v_fmac_f32 v76, 0xbf3504f3, v72
    v_sub_f32 v40, v29, v45
    v_sub_f32 v72, v61, v77
    v_add_f32 v29, v29, v45
    v_add_f32 v61, v61, v77
    v_mul_f32 v45, 0xbf54db31, v40
    v_mul_f32 v77, 0xbf0e39da, v40
    v_fmac_f32 v45, 0x3f0e39da, v72
    v_fmac_f32 v77, 0xbf54db31, v72
    v_sub_f32 v40, v30, v46
    v_sub_f32 v72, v62, v78
    v_add_f32 v30, v30, v46
    v_add_f32 v62, v62, v78
    v_mul_f32 v46, 0xbf6c835e, v40
    v_mul_f32 v78, 0xbec3ef15, v40
    v_fmac_f32 v46, 0x3ec3ef15, v72
    v_fmac_f32 v78, 0xbf6c835e, v72
    v_sub_f32 v40, v31, v47
    v_sub_f32 v72, v63, v79
    v_add_f32 v31, v31, v47
    v_add_f32 v63, v63, v79
    v_mul_f32 v47, 0xbf7b14be, v40
    v_mul_f32 v79, 0xbe47c5c2, v40
    v_fmac_f32 v47, 0x3e47c5c2, v72
    v_fmac_f32 v79, 0xbf7b14be, v72
    v_sub_f32 v40, v16, v24
    v_sub_f32 v72, v48, v56
    v_add_f32 v16, v16, v24
    v_add_f32 v48, v48, v56
    v_sub_f32 v24, v17, v25
    v_sub_f32 v56, v49, v57
    v_add_f32 v17, v17, v25
    v_add_f32 v49, v49, v57
    v_mul_f32 v25, 0x3f6c835e, v24
    v_mul_f32 v57, 0xbec3ef15, v24
    v_fmac_f32 v25, 0x3ec3ef15, v56
    v_fmac_f32 v57, 0x3f6c835e, v56
    v_sub_f32 v24, v18, v26
    v_sub_f32 v56, v50, v58
    v_add_f32 v18, v18, v26
    v_add_f32 v50, v50, v58
    v_mul_f32 v26, 0x3f3504f3, v24
    v_mul_f32 v58, 0xbf3504f3, v24
    v_fmac_f32 v26, 0x3f3504f3, v56
    v_fmac_f32 v58, 0x3f3504f3, v56
    v_sub_f32 v24, v19, v27
    v_sub_f32 v56, v51, v59
    v_add_f32 v19, v19, v27
    v_add_f32 v51, v51, v59
    v_mul_f32 v27, 0x3ec3ef15, v24
    v_mul_f32 v59, 0xbf6c835e, v24
    v_fmac_f32 v27, 0x3f6c835e, v56
    v_fmac_f32 v59, 0x3ec3ef15, v56
    v_sub_f32 v24, v52, v60
    v_sub_f32 v56, v28, v20
    v_add_f32 v20, v20, v28
    v_add_f32 v52, v52, v60
    v_sub_f32 v28, v21, v29
    v_sub_f32 v60, v53, v61
    v_add_f32 v21, v21, v29
    v_add_f32 v53, v53, v61
    v_mul_f32 v29, 0xbec3ef15, v28
    v_mul_f32 v61, 0xbf6c835e, v28
    v_fmac_f32 v29, 0x3f6c835e, v60
    v_fmac_f32 v61, 0xbec3ef15, v60
    v_sub_f32 v28, v22, v30
    v_sub_f32 v60, v54, v62
    v_add_f32 v22, v22, v30
    v_add_f32 v54, v54, v62
    v_mul_f32 v30, 0xbf3504f3, v28
    v_mul_f32 v62, 0xbf3504f3, v28
    v_fmac_f32 v30, 0x3f3504f3, v60
    v_fmac_f32 v62, 0xbf3504f3, v60
    v_sub_f32 v28, v23, v31
    v_sub_f32 v60, v55, v63
    v_add_f32 v23, v23, v31
    v_add_f32 v55, v55, v63
    v_mul_f32 v31, 0xbf6c835e, v28
    v_mul_f32 v63, 0xbec3ef15, v28
    v_fmac_f32 v31, 0x3ec3ef15, v60
    v_fmac_f32 v63, 0xbf6c835e, v60
    v_sub_f32 v28, v80, v32
    v_sub_f32 v60, v81, v64
    v_add_f32 v80, v80, v32
    v_add_f32 v81, v81, v64
    v_sub_f32 v32, v33, v41
    v_sub_f32 v64, v65, v73
    v_add_f32 v33, v33, v41
    v_add_f32 v65, v65, v73
    v_mul_f32 v41, 0x3f6c835e, v32
    v_mul_f32 v73, 0xbec3ef15, v32
    v_fmac_f32 v41, 0x3ec3ef15, v64
    v_fmac_f32 v73, 0x3f6c835e, v64
    v_sub_f32 v32, v34, v42
    v_sub_f32 v64, v66, v74
    v_add_f32 v34, v34, v42
    v_add_f32 v66, v66, v74
    v_mul_f32 v42, 0x3f3504f3, v32
    v_mul_f32 v74, 0xbf3504f3, v32
    v_fmac_f32 v42, 0x3f3504f3, v64
    v_fmac_f32 v74, 0x3f3504f3, v64
    v_sub_f32 v32, v35, v43
    v_sub_f32 v64, v67, v75
    v_add_f32 v35, v35, v43
    v_add_f32 v67, v67, v75
    v_mul_f32 v43, 0x3ec3ef15, v32
    v_mul_f32 v75, 0xbf6c835e, v32
    v_fmac_f32 v43, 0x3f6c835e, v64
    v_fmac_f32 v75, 0x3ec3ef15, v64
    v_sub_f32 v32, v68, v76
    v_sub_f32 v64, v44, v36
    v_add_f32 v36, v36, v44
    v_add_f32 v68, v68, v76
    v_sub_f32 v44, v37, v45
    v_sub_f32 v76, v69, v77
    v_add_f32 v37, v37, v45
    v_add_f32 v69, v69, v77
    v_mul_f32 v45, 0xbec3ef15, v44
    v_mul_f32 v77, 0xbf6c835e, v44
    v_fmac_f32 v45, 0x3f6c835e, v76
    v_fmac_f32 v77, 0xbec3ef15, v76
    v_sub_f32 v44, v38, v46
    v_sub_f32 v76, v70, v78
    v_add_f32 v38, v38, v46
    v_add_f32 v70, v70, v78
    v_mul_f32 v46, 0xbf3504f3, v44
    v_mul_f32 v78, 0xbf3504f3, v44
    v_fmac_f32 v46, 0x3f3504f3, v76
    v_fmac_f32 v78, 0xbf3504f3, v76
    v_sub_f32 v44, v39, v47
    v_sub_f32 v76, v71, v79
    v_add_f32 v39, v39, v47
    v_add_f32 v71, v71, v79
    v_mul_f32 v47, 0xbf6c835e, v44
    v_mul_f32 v79, 0xbec3ef15, v44
    v_fmac_f32 v47, 0x3ec3ef15, v76
    v_fmac_f32 v79, 0xbf6c835e, v76
    v_sub_f32 v44, v16, v20
    v_sub_f32 v76, v48, v52
    v_add_f32 v16, v16, v20
    v_add_f32 v48, v48, v52
    v_sub_f32 v20, v17, v21
    v_sub_f32 v52, v49, v53
    v_add_f32 v17, v17, v21
    v_add_f32 v49, v49, v53
    v_mul_f32 v21, 0x3f3504f3, v20
    v_mul_f32 v53, 0xbf3504f3, v20
    v_fmac_f32 v21, 0x3f3504f3, v52
    v_fmac_f32 v53, 0x3f3504f3, v52
    v_sub_f32 v20, v50, v54
    v_sub_f32 v52, v22, v18
    v_add_f32 v18, v18, v22
    v_add_f32 v50, v50, v54
    v_sub_f32 v22, v19, v23
    v_sub_f32 v54, v51, v55
    v_add_f32 v19, v19, v23
    v_add_f32 v51, v51, v55
    v_mul_f32 v23, 0xbf3504f3, v22
    v_mul_f32 v55, 0xbf3504f3, v22
    v_fmac_f32 v23, 0x3f3504f3, v54
    v_fmac_f32 v55, 0xbf3504f3, v54
    v_sub_f32 v22, v40, v24
    v_sub_f32 v54, v72, v56
    v_add_f32 v40, v40, v24
    v_add_f32 v72, v72, v56
    v_sub_f32 v24, v25, v29
    v_sub_f32 v56, v57, v61
    v_add_f32 v25, v25, v29
    v_add_f32 v57, v57, v61
    v_mul_f32 v29, 0x3f3504f3, v24
    v_mul_f32 v61, 0xbf3504f3, v24
    v_fmac_f32 v29, 0x3f3504f3, v56
    v_fmac_f32 v61, 0x3f3504f3, v56
    v_sub_f32 v24, v58, v62
    v_sub_f32 v56, v30, v26
    v_add_f32 v26, v26, v30
    v_add_f32 v58, v58, v62
    v_sub_f32 v30, v27, v31
    v_sub_f32 v62, v59, v63
    v_add_f32 v27, v27, v31
    v_add_f32 v59, v59, v63
    v_mul_f32 v31, 0xbf3504f3, v30
    v_mul_f32 v63, 0xbf3504f3, v30
    v_fmac_f32 v31, 0x3f3504f3, v62
    v_fmac_f32 v63, 0xbf3504f3, v62
    v_sub_f32 v30, v80, v36
    v_sub_f32 v62, v81, v68
    v_add_f32 v80, v80, v36
    v_add_f32 v81, v81, v68
    v_sub_f32 v36, v33, v37
    v_sub_f32 v68, v65, v69
    v_add_f32 v33, v33, v37
    v_add_f32 v65, v65, v69
    v_mul_f32 v37, 0x3f3504f3, v36
    v_mul_f32 v69, 0xbf3504f3, v36
    v_fmac_f32 v37, 0x3f3504f3, v68
    v_fmac_f32 v69, 0x3f3504f3, v68
    v_sub_f32 v36, v66, v70
    v_sub_f32 v68, v38, v34
    v_add_f32 v34, v34, v38
    v_add_f32 v66, v66, v70
    v_sub_f32 v38, v35, v39
    v_sub_f32 v70, v67, v71
    v_add_f32 v35, v35, v39
    v_add_f32 v67, v67, v71
    v_mul_f32 v39, 0xbf3504f3, v38
    v_mul_f32 v71, 0xbf3504f3, v38
    v_fmac_f32 v39, 0x3f3504f3, v70
    v_fmac_f32 v71, 0xbf3504f3, v70
    v_sub_f32 v38, v28, v32
    v_sub_f32 v70, v60, v64
    v_add_f32 v28, v28, v32
    v_add_f32 v60, v60, v64
    v_sub_f32 v32, v41, v45
    v_sub_f32 v64, v73, v77
    v_add_f32 v41, v41, v45
    v_add_f32 v73, v73, v77
    v_mul_f32 v45, 0x3f3504f3, v32
    v_mul_f32 v77, 0xbf3504f3, v32
    v_fmac_f32 v45, 0x3f3504f3, v64
    v_fmac_f32 v77, 0x3f3504f3, v64
    v_sub_f32 v32, v74, v78
    v_sub_f32 v64, v46, v42
    v_add_f32 v42, v42, v46
    v_add_f32 v74, v74, v78
    v_sub_f32 v46, v43, v47
    v_sub_f32 v78, v75, v79
    v_add_f32 v43, v43, v47
    v_add_f32 v75, v75, v79
    v_mul_f32 v47, 0xbf3504f3, v46
    v_mul_f32 v79, 0xbf3504f3, v46
    v_fmac_f32 v47, 0x3f3504f3, v78
    v_fmac_f32 v79, 0xbf3504f3, v78
    v_sub_f32 v46, v16, v18
    v_sub_f32 v78, v48, v50
    v_add_f32 v16, v16, v18
    v_add_f32 v48, v48, v50
    v_sub_f32 v18, v49, v51
    v_sub_f32 v50, v19, v17
    v_add_f32 v17, v17, v19
    v_add_f32 v49, v49, v51
    v_sub_f32 v19, v44, v20
    v_sub_f32 v51, v76, v52
    v_add_f32 v44, v44, v20
    v_add_f32 v76, v76, v52
    v_sub_f32 v20, v53, v55
    v_sub_f32 v52, v23, v21
    v_add_f32 v21, v21, v23
    v_add_f32 v53, v53, v55
    v_sub_f32 v23, v40, v26
    v_sub_f32 v55, v72, v58
    v_add_f32 v40, v40, v26
    v_add_f32 v72, v72, v58
    v_sub_f32 v26, v57, v59
    v_sub_f32 v58, v27, v25
    v_add_f32 v25, v25, v27
    v_add_f32 v57, v57, v59
    v_sub_f32 v27, v22, v24
    v_sub_f32 v59, v54, v56
    v_add_f32 v22, v22, v24
    v_add_f32 v54, v54, v56
    v_sub_f32 v24, v61, v63
    v_sub_f32 v56, v31, v29
    v_add_f32 v29, v29, v31
    v_add_f32 v61, v61, v63
    v_sub_f32 v31, v80, v34
    v_sub_f32 v63, v81, v66
    v_add_f32 v80, v80, v34
    v_add_f32 v81, v81, v66
    v_sub_f32 v34, v65, v67
    v_sub_f32 v66, v35, v33
    v_add_f32 v33, v33, v35
    v_add_f32 v65, v65, v67
    v_sub_f32 v35, v30, v36
    v_sub_f32 v67, v62, v68
    v_add_f32 v30, v30, v36
    v_add_f32 v62, v62, v68
    v_sub_f32 v36, v69, v71
    v_sub_f32 v68, v39, v37
    v_add_f32 v37, v37, v39
    v_add_f32 v69, v69, v71
    v_sub_f32 v39, v28, v42
    v_sub_f32 v71, v60, v74
    v_add_f32 v28, v28, v42
    v_add_f32 v60, v60, v74
    v_sub_f32 v42, v73, v75
    v_sub_f32 v74, v43, v41
    v_add_f32 v41, v41, v43
    v_add_f32 v73, v73, v75
    v_sub_f32 v43, v38, v32
    v_sub_f32 v75, v70, v64
    v_add_f32 v38, v38, v32
    v_add_f32 v70, v70, v64
    v_sub_f32 v32, v77, v79
    v_sub_f32 v64, v47, v45
    v_add_f32 v45, v45, v47
    v_add_f32 v77, v77, v79
    v_sub_f32 v47, v16, v17
    v_sub_f32 v79, v48, v49
    v_add_f32 v16, v16, v17
    v_add_f32 v48, v48, v49
    v_sub_f32 v17, v46, v18
    v_sub_f32 v49, v78, v50
    v_add_f32 v46, v46, v18
    v_add_f32 v78, v78, v50
    v_sub_f32 v18, v44, v21
    v_sub_f32 v50, v76, v53
    v_add_f32 v44, v44, v21
    v_add_f32 v76, v76, v53
    v_sub_f32 v21, v19, v20
    v_sub_f32 v53, v51, v52
    v_add_f32 v19, v19, v20
    v_add_f32 v51, v51, v52
    v_sub_f32 v20, v40, v25
    v_sub_f32 v52, v72, v57
    v_add_f32 v40, v40, v25
    v_add_f32 v72, v72, v57
    v_sub_f32 v25, v23, v26
    v_sub_f32 v57, v55, v58
    v_add_f32 v23, v23, v26
    v_add_f32 v55, v55, v58
    v_sub_f32 v26, v22, v29
    v_sub_f32 v58, v54, v61
    v_add_f32 v22, v22, v29
    v_add_f32 v54, v54, v61
    v_sub_f32 v29, v27, v24
    v_sub_f32 v61, v59, v56
    v_add_f32 v27, v27, v24
    v_add_f32 v59, v59, v56
    v_sub_f32 v24, v80, v33
    v_sub_f32 v56, v81, v65
    v_add_f32 v80, v80, v33
    v_add_f32 v81, v81, v65
    v_sub_f32 v33, v31, v34
    v_sub_f32 v65, v63, v66
    v_add_f32 v31, v31, v34
    v_add_f32 v63, v63, v66
    v_sub_f32 v34, v30, v37
    v_sub_f32 v66, v62, v69
    v_add_f32 v30, v30, v37
    v_add_f32 v62, v62, v69
    v_sub_f32 v37, v35, v36
    v_sub_f32 v69, v67, v68
    v_add_f32 v35, v35, v36
    v_add_f32 v67, v67, v68
    v_sub_f32 v36, v28, v41
    v_sub_f32 v68, v60, v73
    v_add_f32 v28, v28, v41
    v_add_f32 v60, v60, v73
    v_sub_f32 v41, v39, v42
    v_sub_f32 v73, v71, v74
    v_add_f32 v39, v39, v42
    v_add_f32 v71, v71, v74
    v_sub_f32 v42, v38, v45
    v_sub_f32 v74, v70, v77
    v_add_f32 v38, v38, v45
    v_add_f32 v70, v70, v77
    v_sub_f32 v45, v43, v32
    v_sub_f32 v77, v75, v64
    v_add_f32 v43, v43, v32
    v_add_f32 v75, v75, v64
    v_mul_f32 v32, 0xba800000, v3
    v_cos_f32 v64, v32
    v_sin_f32 v82, v32
    s_nop 0
    v_mul_f32 v83, v80, v64
    v_fma_f32 v83, -v81, v82, v83
    v_mul_f32 v81, v81, v64
    v_fmac_f32 v81, v80, v82
    v_mul_f32 v32, 0xbb000000, v3
    v_cos_f32 v64, v32
    v_sin_f32 v82, v32
    s_nop 0
    v_mul_f32 v80, v40, v64
    v_fma_f32 v80, -v72, v82, v80
    v_mul_f32 v72, v72, v64
    v_fmac_f32 v72, v40, v82
    v_mul_f32 v32, 0xbb400000, v3
    v_cos_f32 v64, v32
    v_sin_f32 v82, v32
    s_nop 0
    v_mul_f32 v40, v28, v64
    v_fma_f32 v40, -v60, v82, v40
    v_mul_f32 v60, v60, v64
    v_fmac_f32 v60, v28, v82
    v_mul_f32 v32, 0xbb800000, v3
    v_cos_f32 v64, v32
    v_sin_f32 v82, v32
    s_nop 0
    v_mul_f32 v28, v44, v64
    v_fma_f32 v28, -v76, v82, v28
    v_mul_f32 v76, v76, v64
    v_fmac_f32 v76, v44, v82
    v_mul_f32 v32, 0xbba00000, v3
    v_cos_f32 v64, v32
    v_sin_f32 v82, v32
    s_nop 0
    v_mul_f32 v44, v30, v64
    v_fma_f32 v44, -v62, v82, v44
    v_mul_f32 v62, v62, v64
    v_fmac_f32 v62, v30, v82
    v_mul_f32 v32, 0xbbc00000, v3
    v_cos_f32 v64, v32
    v_sin_f32 v82, v32
    s_nop 0
    v_mul_f32 v30, v22, v64
    v_fma_f32 v30, -v54, v82, v30
    v_mul_f32 v54, v54, v64
    v_fmac_f32 v54, v22, v82
    v_mul_f32 v32, 0xbbe00000, v3
    v_cos_f32 v64, v32
    v_sin_f32 v82, v32
    s_nop 0
    v_mul_f32 v22, v38, v64
    v_fma_f32 v22, -v70, v82, v22
    v_mul_f32 v70, v70, v64
    v_fmac_f32 v70, v38, v82
    v_mul_f32 v32, 0xbc000000, v3
    v_cos_f32 v64, v32
    v_sin_f32 v82, v32
    s_nop 0
    v_mul_f32 v38, v46, v64
    v_fma_f32 v38, -v78, v82, v38
    v_mul_f32 v78, v78, v64
    v_fmac_f32 v78, v46, v82
    v_mul_f32 v32, 0xbc100000, v3
    v_cos_f32 v64, v32
    v_sin_f32 v82, v32
    s_nop 0
    v_mul_f32 v46, v31, v64
    v_fma_f32 v46, -v63, v82, v46
    v_mul_f32 v63, v63, v64
    v_fmac_f32 v63, v31, v82
    v_mul_f32 v32, 0xbc200000, v3
    v_cos_f32 v64, v32
    v_sin_f32 v82, v32
    s_nop 0
    v_mul_f32 v31, v23, v64
    v_fma_f32 v31, -v55, v82, v31
    v_mul_f32 v55, v55, v64
    v_fmac_f32 v55, v23, v82
    v_mul_f32 v32, 0xbc300000, v3
    v_cos_f32 v64, v32
    v_sin_f32 v82, v32
    s_nop 0
    v_mul_f32 v23, v39, v64
    v_fma_f32 v23, -v71, v82, v23
    v_mul_f32 v71, v71, v64
    v_fmac_f32 v71, v39, v82
    v_mul_f32 v32, 0xbc400000, v3
    v_cos_f32 v64, v32
    v_sin_f32 v82, v32
    s_nop 0
    v_mul_f32 v39, v19, v64
    v_fma_f32 v39, -v51, v82, v39
    v_mul_f32 v51, v51, v64
    v_fmac_f32 v51, v19, v82
    v_mul_f32 v32, 0xbc500000, v3
    v_cos_f32 v64, v32
    v_sin_f32 v82, v32
    s_nop 0
    v_mul_f32 v19, v35, v64
    v_fma_f32 v19, -v67, v82, v19
    v_mul_f32 v67, v67, v64
    v_fmac_f32 v67, v35, v82
    v_mul_f32 v32, 0xbc600000, v3
    v_cos_f32 v64, v32
    v_sin_f32 v82, v32
    s_nop 0
    v_mul_f32 v35, v27, v64
    v_fma_f32 v35, -v59, v82, v35
    v_mul_f32 v59, v59, v64
    v_fmac_f32 v59, v27, v82
    v_mul_f32 v32, 0xbc700000, v3
    v_cos_f32 v64, v32
    v_sin_f32 v82, v32
    s_nop 0
    v_mul_f32 v27, v43, v64
    v_fma_f32 v27, -v75, v82, v27
    v_mul_f32 v75, v75, v64
    v_fmac_f32 v75, v43, v82
    v_mul_f32 v32, 0xbc800000, v3
    v_cos_f32 v64, v32
    v_sin_f32 v82, v32
    s_nop 0
    v_mul_f32 v43, v47, v64
    v_fma_f32 v43, -v79, v82, v43
    v_mul_f32 v79, v79, v64
    v_fmac_f32 v79, v47, v82
    v_mul_f32 v32, 0xbc880000, v3
    v_cos_f32 v64, v32
    v_sin_f32 v82, v32
    s_nop 0
    v_mul_f32 v47, v24, v64
    v_fma_f32 v47, -v56, v82, v47
    v_mul_f32 v56, v56, v64
    v_fmac_f32 v56, v24, v82
    v_mul_f32 v32, 0xbc900000, v3
    v_cos_f32 v64, v32
    v_sin_f32 v82, v32
    s_nop 0
    v_mul_f32 v24, v20, v64
    v_fma_f32 v24, -v52, v82, v24
    v_mul_f32 v52, v52, v64
    v_fmac_f32 v52, v20, v82
    v_mul_f32 v32, 0xbc980000, v3
    v_cos_f32 v64, v32
    v_sin_f32 v82, v32
    s_nop 0
    v_mul_f32 v20, v36, v64
    v_fma_f32 v20, -v68, v82, v20
    v_mul_f32 v68, v68, v64
    v_fmac_f32 v68, v36, v82
    v_mul_f32 v32, 0xbca00000, v3
    v_cos_f32 v64, v32
    v_sin_f32 v82, v32
    s_nop 0
    v_mul_f32 v36, v18, v64
    v_fma_f32 v36, -v50, v82, v36
    v_mul_f32 v50, v50, v64
    v_fmac_f32 v50, v18, v82
    v_mul_f32 v32, 0xbca80000, v3
    v_cos_f32 v64, v32
    v_sin_f32 v82, v32
    s_nop 0
    v_mul_f32 v18, v34, v64
    v_fma_f32 v18, -v66, v82, v18
    v_mul_f32 v66, v66, v64
    v_fmac_f32 v66, v34, v82
    v_mul_f32 v32, 0xbcb00000, v3
    v_cos_f32 v64, v32
    v_sin_f32 v82, v32
    s_nop 0
    v_mul_f32 v34, v26, v64
    v_fma_f32 v34, -v58, v82, v34
    v_mul_f32 v58, v58, v64
    v_fmac_f32 v58, v26, v82
    v_mul_f32 v32, 0xbcb80000, v3
    v_cos_f32 v64, v32
    v_sin_f32 v82, v32
    s_nop 0
    v_mul_f32 v26, v42, v64
    v_fma_f32 v26, -v74, v82, v26
    v_mul_f32 v74, v74, v64
    v_fmac_f32 v74, v42, v82
    v_mul_f32 v32, 0xbcc00000, v3
    v_cos_f32 v64, v32
    v_sin_f32 v82, v32
    s_nop 0
    v_mul_f32 v42, v17, v64
    v_fma_f32 v42, -v49, v82, v42
    v_mul_f32 v49, v49, v64
    v_fmac_f32 v49, v17, v82
    v_mul_f32 v32, 0xbcc80000, v3
    v_cos_f32 v64, v32
    v_sin_f32 v82, v32
    s_nop 0
    v_mul_f32 v17, v33, v64
    v_fma_f32 v17, -v65, v82, v17
    v_mul_f32 v65, v65, v64
    v_fmac_f32 v65, v33, v82
    v_mul_f32 v32, 0xbcd00000, v3
    v_cos_f32 v64, v32
    v_sin_f32 v82, v32
    s_nop 0
    v_mul_f32 v33, v25, v64
    v_fma_f32 v33, -v57, v82, v33
    v_mul_f32 v57, v57, v64
    v_fmac_f32 v57, v25, v82
    v_mul_f32 v32, 0xbcd80000, v3
    v_cos_f32 v64, v32
    v_sin_f32 v82, v32
    s_nop 0
    v_mul_f32 v25, v41, v64
    v_fma_f32 v25, -v73, v82, v25
    v_mul_f32 v73, v73, v64
    v_fmac_f32 v73, v41, v82
    v_mul_f32 v32, 0xbce00000, v3
    v_cos_f32 v64, v32
    v_sin_f32 v82, v32
    s_nop 0
    v_mul_f32 v41, v21, v64
    v_fma_f32 v41, -v53, v82, v41
    v_mul_f32 v53, v53, v64
    v_fmac_f32 v53, v21, v82
    v_mul_f32 v32, 0xbce80000, v3
    v_cos_f32 v64, v32
    v_sin_f32 v82, v32
    s_nop 0
    v_mul_f32 v21, v37, v64
    v_fma_f32 v21, -v69, v82, v21
    v_mul_f32 v69, v69, v64
    v_fmac_f32 v69, v37, v82
    v_mul_f32 v32, 0xbcf00000, v3
    v_cos_f32 v64, v32
    v_sin_f32 v82, v32
    s_nop 0
    v_mul_f32 v37, v29, v64
    v_fma_f32 v37, -v61, v82, v37
    v_mul_f32 v61, v61, v64
    v_fmac_f32 v61, v29, v82
    v_mul_f32 v32, 0xbcf80000, v3
    v_cos_f32 v64, v32
    v_sin_f32 v82, v32
    s_nop 0
    v_mul_f32 v29, v45, v64
    v_fma_f32 v29, -v77, v82, v29
    v_mul_f32 v77, v77, v64
    v_fmac_f32 v77, v45, v82
    ds_write_b32 v4, v16 offset:0
    ds_write_b32 v4, v48 offset:4
    ds_write_b32 v4, v83 offset:264
    ds_write_b32 v4, v81 offset:268
    ds_write_b32 v4, v80 offset:528
    ds_write_b32 v4, v72 offset:532
    ds_write_b32 v4, v40 offset:792
    ds_write_b32 v4, v60 offset:796
    ds_write_b32 v4, v28 offset:1056
    ds_write_b32 v4, v76 offset:1060
    ds_write_b32 v4, v44 offset:1320
    ds_write_b32 v4, v62 offset:1324
    ds_write_b32 v4, v30 offset:1584
    ds_write_b32 v4, v54 offset:1588
    ds_write_b32 v4, v22 offset:1848
    ds_write_b32 v4, v70 offset:1852
    ds_write_b32 v4, v38 offset:2112
    ds_write_b32 v4, v78 offset:2116
    ds_write_b32 v4, v46 offset:2376
    ds_write_b32 v4, v63 offset:2380
    ds_write_b32 v4, v31 offset:2640
    ds_write_b32 v4, v55 offset:2644
    ds_write_b32 v4, v23 offset:2904
    ds_write_b32 v4, v71 offset:2908
    ds_write_b32 v4, v39 offset:3168
    ds_write_b32 v4, v51 offset:3172
    ds_write_b32 v4, v19 offset:3432
    ds_write_b32 v4, v67 offset:3436
    ds_write_b32 v4, v35 offset:3696
    ds_write_b32 v4, v59 offset:3700
    ds_write_b32 v4, v27 offset:3960
    ds_write_b32 v4, v75 offset:3964
    ds_write_b32 v4, v43 offset:4224
    ds_write_b32 v4, v79 offset:4228
    ds_write_b32 v4, v47 offset:4488
    ds_write_b32 v4, v56 offset:4492
    ds_write_b32 v4, v24 offset:4752
    ds_write_b32 v4, v52 offset:4756
    ds_write_b32 v4, v20 offset:5016
    ds_write_b32 v4, v68 offset:5020
    ds_write_b32 v4, v36 offset:5280
    ds_write_b32 v4, v50 offset:5284
    ds_write_b32 v4, v18 offset:5544
    ds_write_b32 v4, v66 offset:5548
    ds_write_b32 v4, v34 offset:5808
    ds_write_b32 v4, v58 offset:5812
    ds_write_b32 v4, v26 offset:6072
    ds_write_b32 v4, v74 offset:6076
    ds_write_b32 v4, v42 offset:6336
    ds_write_b32 v4, v49 offset:6340
    ds_write_b32 v4, v17 offset:6600
    ds_write_b32 v4, v65 offset:6604
    ds_write_b32 v4, v33 offset:6864
    ds_write_b32 v4, v57 offset:6868
    ds_write_b32 v4, v25 offset:7128
    ds_write_b32 v4, v73 offset:7132
    ds_write_b32 v4, v41 offset:7392
    ds_write_b32 v4, v53 offset:7396
    ds_write_b32 v4, v21 offset:7656
    ds_write_b32 v4, v69 offset:7660
    ds_write_b32 v4, v37 offset:7920
    ds_write_b32 v4, v61 offset:7924
    ds_write_b32 v4, v29 offset:8184
    ds_write_b32 v4, v77 offset:8188
    s_waitcnt lgkmcnt(0)
    ds_read_b32 v16, v5 offset:0
    ds_read_b32 v48, v5 offset:4
    ds_read_b32 v83, v5 offset:8
    ds_read_b32 v81, v5 offset:12
    ds_read_b32 v80, v5 offset:16
    ds_read_b32 v72, v5 offset:20
    ds_read_b32 v40, v5 offset:24
    ds_read_b32 v60, v5 offset:28
    ds_read_b32 v28, v5 offset:32
    ds_read_b32 v76, v5 offset:36
    ds_read_b32 v44, v5 offset:40
    ds_read_b32 v62, v5 offset:44
    ds_read_b32 v30, v5 offset:48
    ds_read_b32 v54, v5 offset:52
    s_waitcnt lgkmcnt(0)
    ds_read_b32 v22, v5 offset:56
    ds_read_b32 v70, v5 offset:60
    ds_read_b32 v38, v5 offset:64
    ds_read_b32 v78, v5 offset:68
    ds_read_b32 v46, v5 offset:72
    ds_read_b32 v63, v5 offset:76
    ds_read_b32 v31, v5 offset:80
    ds_read_b32 v55, v5 offset:84
    ds_read_b32 v23, v5 offset:88
    ds_read_b32 v71, v5 offset:92
    ds_read_b32 v39, v5 offset:96
    ds_read_b32 v51, v5 offset:100
    ds_read_b32 v19, v5 offset:104
    ds_read_b32 v67, v5 offset:108
    s_waitcnt lgkmcnt(0)
    ds_read_b32 v35, v5 offset:112
    ds_read_b32 v59, v5 offset:116
    ds_read_b32 v27, v5 offset:120
    ds_read_b32 v75, v5 offset:124
    ds_read_b32 v43, v5 offset:128
    ds_read_b32 v79, v5 offset:132
    ds_read_b32 v47, v5 offset:136
    ds_read_b32 v56, v5 offset:140
    ds_read_b32 v24, v5 offset:144
    ds_read_b32 v52, v5 offset:148
    ds_read_b32 v20, v5 offset:152
    ds_read_b32 v68, v5 offset:156
    ds_read_b32 v36, v5 offset:160
    ds_read_b32 v50, v5 offset:164
    s_waitcnt lgkmcnt(0)
    ds_read_b32 v18, v5 offset:168
    ds_read_b32 v66, v5 offset:172
    ds_read_b32 v34, v5 offset:176
    ds_read_b32 v58, v5 offset:180
    ds_read_b32 v26, v5 offset:184
    ds_read_b32 v74, v5 offset:188
    ds_read_b32 v42, v5 offset:192
    ds_read_b32 v49, v5 offset:196
    ds_read_b32 v17, v5 offset:200
    ds_read_b32 v65, v5 offset:204
    ds_read_b32 v33, v5 offset:208
    ds_read_b32 v57, v5 offset:212
    ds_read_b32 v25, v5 offset:216
    ds_read_b32 v73, v5 offset:220
    s_waitcnt lgkmcnt(0)
    ds_read_b32 v41, v5 offset:224
    ds_read_b32 v53, v5 offset:228
    ds_read_b32 v21, v5 offset:232
    ds_read_b32 v69, v5 offset:236
    ds_read_b32 v37, v5 offset:240
    ds_read_b32 v61, v5 offset:244
    ds_read_b32 v29, v5 offset:248
    ds_read_b32 v77, v5 offset:252
    s_waitcnt lgkmcnt(0)
    v_sub_f32 v32, v16, v43
    v_sub_f32 v64, v48, v79
    v_add_f32 v16, v16, v43
    v_add_f32 v48, v48, v79
    v_sub_f32 v43, v83, v47
    v_sub_f32 v79, v81, v56
    v_add_f32 v83, v83, v47
    v_add_f32 v81, v81, v56
    v_mul_f32 v47, 0x3f7b14be, v43
    v_mul_f32 v56, 0xbe47c5c2, v43
    v_fmac_f32 v47, 0x3e47c5c2, v79
    v_fmac_f32 v56, 0x3f7b14be, v79
    v_sub_f32 v43, v80, v24
    v_sub_f32 v79, v72, v52
    v_add_f32 v80, v80, v24
    v_add_f32 v72, v72, v52
    v_mul_f32 v24, 0x3f6c835e, v43
    v_mul_f32 v52, 0xbec3ef15, v43
    v_fmac_f32 v24, 0x3ec3ef15, v79
    v_fmac_f32 v52, 0x3f6c835e, v79
    v_sub_f32 v43, v40, v20
    v_sub_f32 v79, v60, v68
    v_add_f32 v40, v40, v20
    v_add_f32 v60, v60, v68
    v_mul_f32 v20, 0x3f54db31, v43
    v_mul_f32 v68, 0xbf0e39da, v43
    v_fmac_f32 v20, 0x3f0e39da, v79
    v_fmac_f32 v68, 0x3f54db31, v79
    v_sub_f32 v43, v28, v36
    v_sub_f32 v79, v76, v50
    v_add_f32 v28, v28, v36
    v_add_f32 v76, v76, v50
    v_mul_f32 v36, 0x3f3504f3, v43
    v_mul_f32 v50, 0xbf3504f3, v43
    v_fmac_f32 v36, 0x3f3504f3, v79
    v_fmac_f32 v50, 0x3f3504f3, v79
    v_sub_f32 v43, v44, v18
    v_sub_f32 v79, v62, v66
    v_add_f32 v44, v44, v18
    v_add_f32 v62, v62, v66
    v_mul_f32 v18, 0x3f0e39da, v43
    v_mul_f32 v66, 0xbf54db31, v43
    v_fmac_f32 v18, 0x3f54db31, v79
    v_fmac_f32 v66, 0x3f0e39da, v79
    v_sub_f32 v43, v30, v34
    v_sub_f32 v79, v54, v58
    v_add_f32 v30, v30, v34
    v_add_f32 v54, v54, v58
    v_mul_f32 v34, 0x3ec3ef15, v43
    v_mul_f32 v58, 0xbf6c835e, v43
    v_fmac_f32 v34, 0x3f6c835e, v79
    v_fmac_f32 v58, 0x3ec3ef15, v79
    v_sub_f32 v43, v22, v26
    v_sub_f32 v79, v70, v74
    v_add_f32 v22, v22, v26
    v_add_f32 v70, v70, v74
    v_mul_f32 v26, 0x3e47c5c2, v43
    v_mul_f32 v74, 0xbf7b14be, v43
    v_fmac_f32 v26, 0x3f7b14be, v79
    v_fmac_f32 v74, 0x3e47c5c2, v79
    v_sub_f32 v43, v78, v49
    v_sub_f32 v79, v42, v38
    v_add_f32 v38, v38, v42
    v_add_f32 v78, v78, v49
    v_sub_f32 v42, v46, v17
    v_sub_f32 v49, v63, v65
    v_add_f32 v46, v46, v17
    v_add_f32 v63, v63, v65
    v_mul_f32 v17, 0xbe47c5c2, v42
    v_mul_f32 v65, 0xbf7b14be, v42
    v_fmac_f32 v17, 0x3f7b14be, v49
    v_fmac_f32 v65, 0xbe47c5c2, v49
    v_sub_f32 v42, v31, v33
    v_sub_f32 v49, v55, v57
    v_add_f32 v31, v31, v33
    v_add_f32 v55, v55, v57
    v_mul_f32 v33, 0xbec3ef15, v42
    v_mul_f32 v57, 0xbf6c835e, v42
    v_fmac_f32 v33, 0x3f6c835e, v49
    v_fmac_f32 v57, 0xbec3ef15, v49
    v_sub_f32 v42, v23, v25
    v_sub_f32 v49, v71, v73
    v_add_f32 v23, v23, v25
    v_add_f32 v71, v71, v73
    v_mul_f32 v25, 0xbf0e39da, v42
    v_mul_f32 v73, 0xbf54db31, v42
    v_fmac_f32 v25, 0x3f54db31, v49
    v_fmac_f32 v73, 0xbf0e39da, v49
    v_sub_f32 v42, v39, v41
    v_sub_f32 v49, v51, v53
    v_add_f32 v39, v39, v41
    v_add_f32 v51, v51, v53
    v_mul_f32 v41, 0xbf3504f3, v42
    v_mul_f32 v53, 0xbf3504f3, v42
    v_fmac_f32 v41, 0x3f3504f3, v49
    v_fmac_f32 v53, 0xbf3504f3, v49
    v_sub_f32 v42, v19, v21
    v_sub_f32 v49, v67, v69
    v_add_f32 v19, v19, v21
    v_add_f32 v67, v67, v69
    v_mul_f32 v21, 0xbf54db31, v42
    v_mul_f32 v69, 0xbf0e39da, v42
    v_fmac_f32 v21, 0x3f0e39da, v49
    v_fmac_f32 v69, 0xbf54db31, v49
    v_sub_f32 v42, v35, v37
    v_sub_f32 v49, v59, v61
    v_add_f32 v35, v35, v37
    v_add_f32 v59, v59, v61
    v_mul_f32 v37, 0xbf6c835e, v42
    v_mul_f32 v61, 0xbec3ef15, v42
    v_fmac_f32 v37, 0x3ec3ef15, v49
    v_fmac_f32 v61, 0xbf6c835e, v49
    v_sub_f32 v42, v27, v29
    v_sub_f32 v49, v75, v77
    v_add_f32 v27, v27, v29
    v_add_f32 v75, v75, v77
    v_mul_f32 v29, 0xbf7b14be, v42
    v_mul_f32 v77, 0xbe47c5c2, v42
    v_fmac_f32 v29, 0x3e47c5c2, v49
    v_fmac_f32 v77, 0xbf7b14be, v49
    v_sub_f32 v42, v16, v38
    v_sub_f32 v49, v48, v78
    v_add_f32 v16, v16, v38
    v_add_f32 v48, v48, v78
    v_sub_f32 v38, v83, v46
    v_sub_f32 v78, v81, v63
    v_add_f32 v83, v83, v46
    v_add_f32 v81, v81, v63
    v_mul_f32 v46, 0x3f6c835e, v38
    v_mul_f32 v63, 0xbec3ef15, v38
    v_fmac_f32 v46, 0x3ec3ef15, v78
    v_fmac_f32 v63, 0x3f6c835e, v78
    v_sub_f32 v38, v80, v31
    v_sub_f32 v78, v72, v55
    v_add_f32 v80, v80, v31
    v_add_f32 v72, v72, v55
    v_mul_f32 v31, 0x3f3504f3, v38
    v_mul_f32 v55, 0xbf3504f3, v38
    v_fmac_f32 v31, 0x3f3504f3, v78
    v_fmac_f32 v55, 0x3f3504f3, v78
    v_sub_f32 v38, v40, v23
    v_sub_f32 v78, v60, v71
    v_add_f32 v40, v40, v23
    v_add_f32 v60, v60, v71
    v_mul_f32 v23, 0x3ec3ef15, v38
    v_mul_f32 v71, 0xbf6c835e, v38
    v_fmac_f32 v23, 0x3f6c835e, v78
    v_fmac_f32 v71, 0x3ec3ef15, v78
    v_sub_f32 v38, v76, v51
    v_sub_f32 v78, v39, v28
    v_add_f32 v28, v28, v39
    v_add_f32 v76, v76, v51
    v_sub_f32 v39, v44, v19
    v_sub_f32 v51, v62, v67
    v_add_f32 v44, v44, v19
    v_add_f32 v62, v62, v67
    v_mul_f32 v19, 0xbec3ef15, v39
    v_mul_f32 v67, 0xbf6c835e, v39
    v_fmac_f32 v19, 0x3f6c835e, v51
    v_fmac_f32 v67, 0xbec3ef15, v51
    v_sub_f32 v39, v30, v35
    v_sub_f32 v51, v54, v59
    v_add_f32 v30, v30, v35
    v_add_f32 v54, v54, v59
    v_mul_f32 v35, 0xbf3504f3, v39
    v_mul_f32 v59, 0xbf3504f3, v39
    v_fmac_f32 v35, 0x3f3504f3, v51
    v_fmac_f32 v59, 0xbf3504f3, v51
    v_sub_f32 v39, v22, v27
    v_sub_f32 v51, v70, v75
    v_add_f32 v22, v22, v27
    v_add_f32 v70, v70, v75
    v_mul_f32 v27, 0xbf6c835e, v39
    v_mul_f32 v75, 0xbec3ef15, v39
    v_fmac_f32 v27, 0x3ec3ef15, v51
    v_fmac_f32 v75, 0xbf6c835e, v51
    v_sub_f32 v39, v32, v43
    v_sub_f32 v51, v64, v79
    v_add_f32 v32, v32, v43
    v_add_f32 v64, v64, v79
    v_sub_f32 v43, v47, v17
    v_sub_f32 v79, v56, v65
    v_add_f32 v47, v47, v17
    v_add_f32 v56, v56, v65
    v_mul_f32 v17, 0x3f6c835e, v43
    v_mul_f32 v65, 0xbec3ef15, v43
    v_fmac_f32 v17, 0x3ec3ef15, v79
    v_fmac_f32 v65, 0x3f6c835e, v79
    v_sub_f32 v43, v24, v33
    v_sub_f32 v79, v52, v57
    v_add_f32 v24, v24, v33
    v_add_f32 v52, v52, v57
    v_mul_f32 v33, 0x3f3504f3, v43
    v_mul_f32 v57, 0xbf3504f3, v43
    v_fmac_f32 v33, 0x3f3504f3, v79
    v_fmac_f32 v57, 0x3f3504f3, v79
    v_sub_f32 v43, v20, v25
    v_sub_f32 v79, v68, v73
    v_add_f32 v20, v20, v25
    v_add_f32 v68, v68, v73
    v_mul_f32 v25, 0x3ec3ef15, v43
    v_mul_f32 v73, 0xbf6c835e, v43
    v_fmac_f32 v25, 0x3f6c835e, v79
    v_fmac_f32 v73, 0x3ec3ef15, v79
    v_sub_f32 v43, v50, v53
    v_sub_f32 v79, v41, v36
    v_add_f32 v36, v36, v41
    v_add_f32 v50, v50, v53
    v_sub_f32 v41, v18, v21
    v_sub_f32 v53, v66, v69
    v_add_f32 v18, v18, v21
    v_add_f32 v66, v66, v69
    v_mul_f32 v21, 0xbec3ef15, v41
    v_mul_f32 v69, 0xbf6c835e, v41
    v_fmac_f32 v21, 0x3f6c835e, v53
    v_fmac_f32 v69, 0xbec3ef15, v53
    v_sub_f32 v41, v34, v37
    v_sub_f32 v53, v58, v61
    v_add_f32 v34, v34, v37
    v_add_f32 v58, v58, v61
    v_mul_f32 v37, 0xbf3504f3, v41
    v_mul_f32 v61, 0xbf3504f3, v41
    v_fmac_f32 v37, 0x3f3504f3, v53
    v_fmac_f32 v61, 0xbf3504f3, v53
    v_sub_f32 v41, v26, v29
    v_sub_f32 v53, v74, v77
    v_add_f32 v26, v26, v29
    v_add_f32 v74, v74, v77
    v_mul_f32 v29, 0xbf6c835e, v41
    v_mul_f32 v77, 0xbec3ef15, v41
    v_fmac_f32 v29, 0x3ec3ef15, v53
    v_fmac_f32 v77, 0xbf6c835e, v53
    v_sub_f32 v41, v16, v28
    v_sub_f32 v53, v48, v76
    v_add_f32 v16, v16, v28
    v_add_f32 v48, v48, v76
    v_sub_f32 v28, v83, v44
    v_sub_f32 v76, v81, v62
    v_add_f32 v83, v83, v44
    v_add_f32 v81, v81, v62
    v_mul_f32 v44, 0x3f3504f3, v28
    v_mul_f32 v62, 0xbf3504f3, v28
    v_fmac_f32 v44, 0x3f3504f3, v76
    v_fmac_f32 v62, 0x3f3504f3, v76
    v_sub_f32 v28, v72, v54
    v_sub_f32 v76, v30, v80
    v_add_f32 v80, v80, v30
    v_add_f32 v72, v72, v54
    v_sub_f32 v30, v40, v22
    v_sub_f32 v54, v60, v70
    v_add_f32 v40, v40, v22
    v_add_f32 v60, v60, v70
    v_mul_f32 v22, 0xbf3504f3, v30
    v_mul_f32 v70, 0xbf3504f3, v30
    v_fmac_f32 v22, 0x3f3504f3, v54
    v_fmac_f32 v70, 0xbf3504f3, v54
    v_sub_f32 v30, v42, v38
    v_sub_f32 v54, v49, v78
    v_add_f32 v42, v42, v38
    v_add_f32 v49, v49, v78
    v_sub_f32 v38, v46, v19
    v_sub_f32 v78, v63, v67
    v_add_f32 v46, v46, v19
    v_add_f32 v63, v63, v67
    v_mul_f32 v19, 0x3f3504f3, v38
    v_mul_f32 v67, 0xbf3504f3, v38
    v_fmac_f32 v19, 0x3f3504f3, v78
    v_fmac_f32 v67, 0x3f3504f3, v78
    v_sub_f32 v38, v55, v59
    v_sub_f32 v78, v35, v31
    v_add_f32 v31, v31, v35
    v_add_f32 v55, v55, v59
    v_sub_f32 v35, v23, v27
    v_sub_f32 v59, v71, v75
    v_add_f32 v23, v23, v27
    v_add_f32 v71, v71, v75
    v_mul_f32 v27, 0xbf3504f3, v35
    v_mul_f32 v75, 0xbf3504f3, v35
    v_fmac_f32 v27, 0x3f3504f3, v59
    v_fmac_f32 v75, 0xbf3504f3, v59
    v_sub_f32 v35, v32, v36
    v_sub_f32 v59, v64, v50
    v_add_f32 v32, v32, v36
    v_add_f32 v64, v64, v50
    v_sub_f32 v36, v47, v18
    v_sub_f32 v50, v56, v66
    v_add_f32 v47, v47, v18
    v_add_f32 v56, v56, v66
    v_mul_f32 v18, 0x3f3504f3, v36
    v_mul_f32 v66, 0xbf3504f3, v36
    v_fmac_f32 v18, 0x3f3504f3, v50
    v_fmac_f32 v66, 0x3f3504f3, v50
    v_sub_f32 v36, v52, v58
    v_sub_f32 v50, v34, v24
    v_add_f32 v24, v24, v34
    v_add_f32 v52, v52, v58
    v_sub_f32 v34, v20, v26
    v_sub_f32 v58, v68, v74
    v_add_f32 v20, v20, v26
    v_add_f32 v68, v68, v74
    v_mul_f32 v26, 0xbf3504f3, v34
    v_mul_f32 v74, 0xbf3504f3, v34
    v_fmac_f32 v26, 0x3f3504f3, v58
    v_fmac_f32 v74, 0xbf3504f3, v58
    v_sub_f32 v34, v39, v43
    v_sub_f32 v58, v51, v79
    v_add_f32 v39, v39, v43
    v_add_f32 v51, v51, v79
    v_sub_f32 v43, v17, v21
    v_sub_f32 v79, v65, v69
    v_add_f32 v17, v17, v21
    v_add_f32 v65, v65, v69
    v_mul_f32 v21, 0x3f3504f3, v43
    v_mul_f32 v69, 0xbf3504f3, v43
    v_fmac_f32 v21, 0x3f3504f3, v79
    v_fmac_f32 v69, 0x3f3504f3, v79
    v_sub_f32 v43, v57, v61
    v_sub_f32 v79, v37, v33
    v_add_f32 v33, v33, v37
    v_add_f32 v57, v57, v61
    v_sub_f32 v37, v25, v29
    v_sub_f32 v61, v73, v77
    v_add_f32 v25, v25, v29
    v_add_f32 v73, v73, v77
    v_mul_f32 v29, 0xbf3504f3, v37
    v_mul_f32 v77, 0xbf3504f3, v37
    v_fmac_f32 v29, 0x3f3504f3, v61
    v_fmac_f32 v77, 0xbf3504f3, v61
    v_sub_f32 v37, v16, v80
    v_sub_f32 v61, v48, v72
    v_add_f32 v16, v16, v80
    v_add_f32 v48, v48, v72
    v_sub_f32 v80, v81, v60
    v_sub_f32 v72, v40, v83
    v_add_f32 v83, v83, v40
    v_add_f32 v81, v81, v60
    v_sub_f32 v40, v41, v28
    v_sub_f32 v60, v53, v76
    v_add_f32 v41, v41, v28
    v_add_f32 v53, v53, v76
    v_sub_f32 v28, v62, v70
    v_sub_f32 v76, v22, v44
    v_add_f32 v44, v44, v22
    v_add_f32 v62, v62, v70
    v_sub_f32 v22, v42, v31
    v_sub_f32 v70, v49, v55
    v_add_f32 v42, v42, v31
    v_add_f32 v49, v49, v55
    v_sub_f32 v31, v63, v71
    v_sub_f32 v55, v23, v46
    v_add_f32 v46, v46, v23
    v_add_f32 v63, v63, v71
    v_sub_f32 v23, v30, v38
    v_sub_f32 v71, v54, v78
    v_add_f32 v30, v30, v38
    v_add_f32 v54, v54, v78
    v_sub_f32 v38, v67, v75
    v_sub_f32 v78, v27, v19
    v_add_f32 v19, v19, v27
    v_add_f32 v67, v67, v75
    v_sub_f32 v27, v32, v24
    v_sub_f32 v75, v64, v52
    v_add_f32 v32, v32, v24
    v_add_f32 v64, v64, v52
    v_sub_f32 v24, v56, v68
    v_sub_f32 v52, v20, v47
    v_add_f32 v47, v47, v20
    v_add_f32 v56, v56, v68
    v_sub_f32 v20, v35, v36
    v_sub_f32 v68, v59, v50
    v_add_f32 v35, v35, v36
    v_add_f32 v59, v59, v50
    v_sub_f32 v36, v66, v74
    v_sub_f32 v50, v26, v18
    v_add_f32 v18, v18, v26
    v_add_f32 v66, v66, v74
    v_sub_f32 v26, v39, v33
    v_sub_f32 v74, v51, v57
    v_add_f32 v39, v39, v33
    v_add_f32 v51, v51, v57
    v_sub_f32 v33, v65, v73
    v_sub_f32 v57, v25, v17
    v_add_f32 v17, v17, v25
    v_add_f32 v65, v65, v73
    v_sub_f32 v25, v34, v43
    v_sub_f32 v73, v58, v79
    v_add_f32 v34, v34, v43
    v_add_f32 v58, v58, v79
    v_sub_f32 v43, v69, v77
    v_sub_f32 v79, v29, v21
    v_add_f32 v21, v21, v29
    v_add_f32 v69, v69, v77
    v_sub_f32 v29, v16, v83
    v_sub_f32 v77, v48, v81
    v_add_f32 v16, v16, v83
    v_add_f32 v48, v48, v81
    v_sub_f32 v83, v37, v80
    v_sub_f32 v81, v61, v72
    v_add_f32 v37, v37, v80
    v_add_f32 v61, v61, v72
    v_sub_f32 v80, v41, v44
    v_sub_f32 v72, v53, v62
    v_add_f32 v41, v41, v44
    v_add_f32 v53, v53, v62
    v_sub_f32 v44, v40, v28
    v_sub_f32 v62, v60, v76
    v_add_f32 v40, v40, v28
    v_add_f32 v60, v60, v76
    v_sub_f32 v28, v42, v46
    v_sub_f32 v76, v49, v63
    v_add_f32 v42, v42, v46
    v_add_f32 v49, v49, v63
    v_sub_f32 v46, v22, v31
    v_sub_f32 v63, v70, v55
    v_add_f32 v22, v22, v31
    v_add_f32 v70, v70, v55
    v_sub_f32 v31, v30, v19
    v_sub_f32 v55, v54, v67
    v_add_f32 v30, v30, v19
    v_add_f32 v54, v54, v67
    v_sub_f32 v19, v23, v38
    v_sub_f32 v67, v71, v78
    v_add_f32 v23, v23, v38
    v_add_f32 v71, v71, v78
    v_sub_f32 v38, v32, v47
    v_sub_f32 v78, v64, v56
    v_add_f32 v32, v32, v47
    v_add_f32 v64, v64, v56
    v_sub_f32 v47, v27, v24
    v_sub_f32 v56, v75, v52
    v_add_f32 v27, v27, v24
    v_add_f32 v75, v75, v52
    v_sub_f32 v24, v35, v18
    v_sub_f32 v52, v59, v66
    v_add_f32 v35, v35, v18
    v_add_f32 v59, v59, v66
    v_sub_f32 v18, v20, v36
    v_sub_f32 v66, v68, v50
    v_add_f32 v20, v20, v36
    v_add_f32 v68, v68, v50
    v_sub_f32 v36, v39, v17
    v_sub_f32 v50, v51, v65
    v_add_f32 v39, v39, v17
    v_add_f32 v51, v51, v65
    v_sub_f32 v17, v26, v33
    v_sub_f32 v65, v74, v57
    v_add_f32 v26, v26, v33
    v_add_f32 v74, v74, v57
    v_sub_f32 v33, v34, v21
    v_sub_f32 v57, v58, v69
    v_add_f32 v34, v34, v21
    v_add_f32 v58, v58, v69
    v_sub_f32 v21, v25, v43
    v_sub_f32 v69, v73, v79
    v_add_f32 v25, v25, v43
    v_add_f32 v73, v73, v79
    ds_write_b32 v4, v16 offset:0
    ds_write_b32 v4, v48 offset:4
    ds_write_b32 v4, v32 offset:256
    ds_write_b32 v4, v64 offset:260
    ds_write_b32 v4, v42 offset:512
    ds_write_b32 v4, v49 offset:516
    ds_write_b32 v4, v39 offset:768
    ds_write_b32 v4, v51 offset:772
    ds_write_b32 v4, v41 offset:1024
    ds_write_b32 v4, v53 offset:1028
    ds_write_b32 v4, v35 offset:1280
    ds_write_b32 v4, v59 offset:1284
    ds_write_b32 v4, v30 offset:1536
    ds_write_b32 v4, v54 offset:1540
    ds_write_b32 v4, v34 offset:1792
    ds_write_b32 v4, v58 offset:1796
    ds_write_b32 v4, v37 offset:2048
    ds_write_b32 v4, v61 offset:2052
    ds_write_b32 v4, v27 offset:2304
    ds_write_b32 v4, v75 offset:2308
    ds_write_b32 v4, v22 offset:2560
    ds_write_b32 v4, v70 offset:2564
    ds_write_b32 v4, v26 offset:2816
    ds_write_b32 v4, v74 offset:2820
    ds_write_b32 v4, v40 offset:3072
    ds_write_b32 v4, v60 offset:3076
    ds_write_b32 v4, v20 offset:3328
    ds_write_b32 v4, v68 offset:3332
    ds_write_b32 v4, v23 offset:3584
    ds_write_b32 v4, v71 offset:3588
    ds_write_b32 v4, v25 offset:3840
    ds_write_b32 v4, v73 offset:3844
    ds_write_b32 v4, v29 offset:4096
    ds_write_b32 v4, v77 offset:4100
    ds_write_b32 v4, v38 offset:4352
    ds_write_b32 v4, v78 offset:4356
    ds_write_b32 v4, v28 offset:4608
    ds_write_b32 v4, v76 offset:4612
    ds_write_b32 v4, v36 offset:4864
    ds_write_b32 v4, v50 offset:4868
    ds_write_b32 v4, v80 offset:5120
    ds_write_b32 v4, v72 offset:5124
    ds_write_b32 v4, v24 offset:5376
    ds_write_b32 v4, v52 offset:5380
    ds_write_b32 v4, v31 offset:5632
    ds_write_b32 v4, v55 offset:5636
    ds_write_b32 v4, v33 offset:5888
    ds_write_b32 v4, v57 offset:5892
    ds_write_b32 v4, v83 offset:6144
    ds_write_b32 v4, v81 offset:6148
    ds_write_b32 v4, v47 offset:6400
    ds_write_b32 v4, v56 offset:6404
    ds_write_b32 v4, v46 offset:6656
    ds_write_b32 v4, v63 offset:6660
    ds_write_b32 v4, v17 offset:6912
    ds_write_b32 v4, v65 offset:6916
    ds_write_b32 v4, v44 offset:7168
    ds_write_b32 v4, v62 offset:7172
    ds_write_b32 v4, v18 offset:7424
    ds_write_b32 v4, v66 offset:7428
    ds_write_b32 v4, v19 offset:7680
    ds_write_b32 v4, v67 offset:7684
    ds_write_b32 v4, v21 offset:7936
    ds_write_b32 v4, v69 offset:7940
    s_waitcnt lgkmcnt(0)
    s_barrier
    v_and_b32 v6, 7, v0
    v_lshrrev_b32 v7, 3, v0
    s_movk_i32 s13, 8448
    v_mul_lo_u32 v8, v6, s13
    v_lshl_add_u32 v4, v7, 3, v8
    v_lshlrev_b32 v5, 14, v7
    v_lshl_add_u32 v5, v6, 4, v5
    s_lshl_b32 s12, s92, 7
    s_add_u32 s12, s12, 96468992
    v_sub_u32 v6, 1024, v7
    v_and_b32 v6, 1023, v6
    v_lshl_add_u32 v6, v6, 3, v8
    ds_read_b64 v[16:17], v4 offset:0
    ds_read_b64 v[18:19], v6
    s_waitcnt lgkmcnt(0)
    v_add_f32 v20, v16, v18
    v_sub_f32 v21, v17, v19
    v_add_f32 v22, v17, v19
    v_sub_f32 v23, v18, v16
    s_mov_b32 s13, s12
    s_add_u32 s13, s12, 0
    buffer_store_dwordx4 v[20:23], v5, s[8:11], s13 offen sc1
    s_nop 1
    v_sub_u32 v6, 992, v7
    v_and_b32 v6, 1023, v6
    v_lshl_add_u32 v6, v6, 3, v8
    ds_read_b64 v[16:17], v4 offset:256
    ds_read_b64 v[18:19], v6
    s_waitcnt lgkmcnt(0)
    v_add_f32 v20, v16, v18
    v_sub_f32 v21, v17, v19
    v_add_f32 v22, v17, v19
    v_sub_f32 v23, v18, v16
    s_mov_b32 s13, s12
    s_add_u32 s13, s12, 524288
    buffer_store_dwordx4 v[20:23], v5, s[8:11], s13 offen sc1
    s_nop 1
    v_sub_u32 v6, 960, v7
    v_and_b32 v6, 1023, v6
    v_lshl_add_u32 v6, v6, 3, v8
    ds_read_b64 v[16:17], v4 offset:512
    ds_read_b64 v[18:19], v6
    s_waitcnt lgkmcnt(0)
    v_add_f32 v20, v16, v18
    v_sub_f32 v21, v17, v19
    v_add_f32 v22, v17, v19
    v_sub_f32 v23, v18, v16
    s_mov_b32 s13, s12
    s_add_u32 s13, s12, 1048576
    buffer_store_dwordx4 v[20:23], v5, s[8:11], s13 offen sc1
    s_nop 1
    v_sub_u32 v6, 928, v7
    v_and_b32 v6, 1023, v6
    v_lshl_add_u32 v6, v6, 3, v8
    ds_read_b64 v[16:17], v4 offset:768
    ds_read_b64 v[18:19], v6
    s_waitcnt lgkmcnt(0)
    v_add_f32 v20, v16, v18
    v_sub_f32 v21, v17, v19
    v_add_f32 v22, v17, v19
    v_sub_f32 v23, v18, v16
    s_mov_b32 s13, s12
    s_add_u32 s13, s12, 1572864
    buffer_store_dwordx4 v[20:23], v5, s[8:11], s13 offen sc1
    s_nop 1
    v_sub_u32 v6, 896, v7
    v_and_b32 v6, 1023, v6
    v_lshl_add_u32 v6, v6, 3, v8
    ds_read_b64 v[16:17], v4 offset:1024
    ds_read_b64 v[18:19], v6
    s_waitcnt lgkmcnt(0)
    v_add_f32 v20, v16, v18
    v_sub_f32 v21, v17, v19
    v_add_f32 v22, v17, v19
    v_sub_f32 v23, v18, v16
    s_mov_b32 s13, s12
    s_add_u32 s13, s12, 2097152
    buffer_store_dwordx4 v[20:23], v5, s[8:11], s13 offen sc1
    s_nop 1
    v_sub_u32 v6, 864, v7
    v_and_b32 v6, 1023, v6
    v_lshl_add_u32 v6, v6, 3, v8
    ds_read_b64 v[16:17], v4 offset:1280
    ds_read_b64 v[18:19], v6
    s_waitcnt lgkmcnt(0)
    v_add_f32 v20, v16, v18
    v_sub_f32 v21, v17, v19
    v_add_f32 v22, v17, v19
    v_sub_f32 v23, v18, v16
    s_mov_b32 s13, s12
    s_add_u32 s13, s12, 2621440
    buffer_store_dwordx4 v[20:23], v5, s[8:11], s13 offen sc1
    s_nop 1
    v_sub_u32 v6, 832, v7
    v_and_b32 v6, 1023, v6
    v_lshl_add_u32 v6, v6, 3, v8
    ds_read_b64 v[16:17], v4 offset:1536
    ds_read_b64 v[18:19], v6
    s_waitcnt lgkmcnt(0)
    v_add_f32 v20, v16, v18
    v_sub_f32 v21, v17, v19
    v_add_f32 v22, v17, v19
    v_sub_f32 v23, v18, v16
    s_mov_b32 s13, s12
    s_add_u32 s13, s12, 3145728
    buffer_store_dwordx4 v[20:23], v5, s[8:11], s13 offen sc1
    s_nop 1
    v_sub_u32 v6, 800, v7
    v_and_b32 v6, 1023, v6
    v_lshl_add_u32 v6, v6, 3, v8
    ds_read_b64 v[16:17], v4 offset:1792
    ds_read_b64 v[18:19], v6
    s_waitcnt lgkmcnt(0)
    v_add_f32 v20, v16, v18
    v_sub_f32 v21, v17, v19
    v_add_f32 v22, v17, v19
    v_sub_f32 v23, v18, v16
    s_mov_b32 s13, s12
    s_add_u32 s13, s12, 3670016
    buffer_store_dwordx4 v[20:23], v5, s[8:11], s13 offen sc1
    s_nop 1
    v_sub_u32 v6, 768, v7
    v_and_b32 v6, 1023, v6
    v_lshl_add_u32 v6, v6, 3, v8
    ds_read_b64 v[16:17], v4 offset:2048
    ds_read_b64 v[18:19], v6
    s_waitcnt lgkmcnt(0)
    v_add_f32 v20, v16, v18
    v_sub_f32 v21, v17, v19
    v_add_f32 v22, v17, v19
    v_sub_f32 v23, v18, v16
    s_mov_b32 s13, s12
    s_add_u32 s13, s12, 4194304
    buffer_store_dwordx4 v[20:23], v5, s[8:11], s13 offen sc1
    s_nop 1
    v_sub_u32 v6, 736, v7
    v_and_b32 v6, 1023, v6
    v_lshl_add_u32 v6, v6, 3, v8
    ds_read_b64 v[16:17], v4 offset:2304
    ds_read_b64 v[18:19], v6
    s_waitcnt lgkmcnt(0)
    v_add_f32 v20, v16, v18
    v_sub_f32 v21, v17, v19
    v_add_f32 v22, v17, v19
    v_sub_f32 v23, v18, v16
    s_mov_b32 s13, s12
    s_add_u32 s13, s12, 4718592
    buffer_store_dwordx4 v[20:23], v5, s[8:11], s13 offen sc1
    s_nop 1
    v_sub_u32 v6, 704, v7
    v_and_b32 v6, 1023, v6
    v_lshl_add_u32 v6, v6, 3, v8
    ds_read_b64 v[16:17], v4 offset:2560
    ds_read_b64 v[18:19], v6
    s_waitcnt lgkmcnt(0)
    v_add_f32 v20, v16, v18
    v_sub_f32 v21, v17, v19
    v_add_f32 v22, v17, v19
    v_sub_f32 v23, v18, v16
    s_mov_b32 s13, s12
    s_add_u32 s13, s12, 5242880
    buffer_store_dwordx4 v[20:23], v5, s[8:11], s13 offen sc1
    s_nop 1
    v_sub_u32 v6, 672, v7
    v_and_b32 v6, 1023, v6
    v_lshl_add_u32 v6, v6, 3, v8
    ds_read_b64 v[16:17], v4 offset:2816
    ds_read_b64 v[18:19], v6
    s_waitcnt lgkmcnt(0)
    v_add_f32 v20, v16, v18
    v_sub_f32 v21, v17, v19
    v_add_f32 v22, v17, v19
    v_sub_f32 v23, v18, v16
    s_mov_b32 s13, s12
    s_add_u32 s13, s12, 5767168
    buffer_store_dwordx4 v[20:23], v5, s[8:11], s13 offen sc1
    s_nop 1
    v_sub_u32 v6, 640, v7
    v_and_b32 v6, 1023, v6
    v_lshl_add_u32 v6, v6, 3, v8
    ds_read_b64 v[16:17], v4 offset:3072
    ds_read_b64 v[18:19], v6
    s_waitcnt lgkmcnt(0)
    v_add_f32 v20, v16, v18
    v_sub_f32 v21, v17, v19
    v_add_f32 v22, v17, v19
    v_sub_f32 v23, v18, v16
    s_mov_b32 s13, s12
    s_add_u32 s13, s12, 6291456
    buffer_store_dwordx4 v[20:23], v5, s[8:11], s13 offen sc1
    s_nop 1
    v_sub_u32 v6, 608, v7
    v_and_b32 v6, 1023, v6
    v_lshl_add_u32 v6, v6, 3, v8
    ds_read_b64 v[16:17], v4 offset:3328
    ds_read_b64 v[18:19], v6
    s_waitcnt lgkmcnt(0)
    v_add_f32 v20, v16, v18
    v_sub_f32 v21, v17, v19
    v_add_f32 v22, v17, v19
    v_sub_f32 v23, v18, v16
    s_mov_b32 s13, s12
    s_add_u32 s13, s12, 6815744
    buffer_store_dwordx4 v[20:23], v5, s[8:11], s13 offen sc1
    s_nop 1
    v_sub_u32 v6, 576, v7
    v_and_b32 v6, 1023, v6
    v_lshl_add_u32 v6, v6, 3, v8
    ds_read_b64 v[16:17], v4 offset:3584
    ds_read_b64 v[18:19], v6
    s_waitcnt lgkmcnt(0)
    v_add_f32 v20, v16, v18
    v_sub_f32 v21, v17, v19
    v_add_f32 v22, v17, v19
    v_sub_f32 v23, v18, v16
    s_mov_b32 s13, s12
    s_add_u32 s13, s12, 7340032
    buffer_store_dwordx4 v[20:23], v5, s[8:11], s13 offen sc1
    s_nop 1
    v_sub_u32 v6, 544, v7
    v_and_b32 v6, 1023, v6
    v_lshl_add_u32 v6, v6, 3, v8
    ds_read_b64 v[16:17], v4 offset:3840
    ds_read_b64 v[18:19], v6
    s_waitcnt lgkmcnt(0)
    v_add_f32 v20, v16, v18
    v_sub_f32 v21, v17, v19
    v_add_f32 v22, v17, v19
    v_sub_f32 v23, v18, v16
    s_mov_b32 s13, s12
    s_add_u32 s13, s12, 7864320
    buffer_store_dwordx4 v[20:23], v5, s[8:11], s13 offen sc1
    s_nop 1
    v_sub_u32 v6, 512, v7
    v_and_b32 v6, 1023, v6
    v_lshl_add_u32 v6, v6, 3, v8
    ds_read_b64 v[16:17], v4 offset:4096
    ds_read_b64 v[18:19], v6
    s_waitcnt lgkmcnt(0)
    v_add_f32 v20, v16, v18
    v_sub_f32 v21, v17, v19
    v_add_f32 v22, v17, v19
    v_sub_f32 v23, v18, v16
    s_mov_b32 s13, s12
    v_cmp_eq_u32 vcc, 0, v7
    s_and_saveexec_b64 s[14:15], vcc
    s_add_u32 s13, s12, 8388608
    buffer_store_dwordx4 v[20:23], v5, s[8:11], s13 offen sc1
    s_nop 1
    s_mov_b64 exec, -1
mega_kernel_f1d:
    s_waitcnt vmcnt(0)
    s_barrier
    v_mov_b32 v2, 1
    v_cmp_eq_u32 vcc, 0, v0
    s_and_saveexec_b64 s[80:81], vcc
    s_cbranch_execz mega_kernel_sg72_4
    buffer_atomic_add v2, off, s[88:91], 0 offset:72 sc1
mega_kernel_sg72_4:
    s_mov_b64 exec, s[80:81]
    s_waitcnt vmcnt(0)
    ds_read_b64_tr_b16 a[0:1], v201 offset:0
    ds_read_b64_tr_b16 a[2:3], v201 offset:256
    ds_read_b64_tr_b16 a[4:5], v201 offset:1024
    ds_read_b64_tr_b16 a[6:7], v201 offset:1280
    ds_read_b64_tr_b16 a[8:9], v201 offset:2048
    ds_read_b64_tr_b16 a[10:11], v201 offset:2304
    ds_read_b64_tr_b16 a[12:13], v201 offset:3072
    ds_read_b64_tr_b16 a[14:15], v201 offset:3328
    s_waitcnt lgkmcnt(0)
    ds_read_b64_tr_b16 a[16:17], v201 offset:4096
    ds_read_b64_tr_b16 a[18:19], v201 offset:4352
    ds_read_b64_tr_b16 a[20:21], v201 offset:5120
    ds_read_b64_tr_b16 a[22:23], v201 offset:5376
    ds_read_b64_tr_b16 a[24:25], v201 offset:6144
    ds_read_b64_tr_b16 a[26:27], v201 offset:6400
    ds_read_b64_tr_b16 a[28:29], v201 offset:7168
    ds_read_b64_tr_b16 a[30:31], v201 offset:7424
    s_waitcnt lgkmcnt(0)
    ds_read_b64_tr_b16 a[32:33], v201 offset:8192
    ds_read_b64_tr_b16 a[34:35], v201 offset:8448
    ds_read_b64_tr_b16 a[36:37], v201 offset:9216
    ds_read_b64_tr_b16 a[38:39], v201 offset:9472
    ds_read_b64_tr_b16 a[40:41], v201 offset:10240
    ds_read_b64_tr_b16 a[42:43], v201 offset:10496
    ds_read_b64_tr_b16 a[44:45], v201 offset:11264
    ds_read_b64_tr_b16 a[46:47], v201 offset:11520
    s_waitcnt lgkmcnt(0)
    ds_read_b64_tr_b16 a[48:49], v201 offset:12288
    ds_read_b64_tr_b16 a[50:51], v201 offset:12544
    ds_read_b64_tr_b16 a[52:53], v201 offset:13312
    ds_read_b64_tr_b16 a[54:55], v201 offset:13568
    ds_read_b64_tr_b16 a[56:57], v201 offset:14336
    ds_read_b64_tr_b16 a[58:59], v201 offset:14592
    ds_read_b64_tr_b16 a[60:61], v201 offset:15360
    ds_read_b64_tr_b16 a[62:63], v201 offset:15616
    s_waitcnt lgkmcnt(0)
    s_add_u32 m0, s56, 0
    s_add_u32 s58, s57, 16384
    s_and_b32 s58, s58, 0xffff
    s_lshl_b32 s58, s58, 5
    buffer_load_dwordx4 v200, s[52:55], s58 offen lds
    s_add_u32 m0, s56, 1024
    s_add_u32 s58, s57, 17408
    s_and_b32 s58, s58, 0xffff
    s_lshl_b32 s58, s58, 5
    buffer_load_dwordx4 v200, s[52:55], s58 offen lds
    s_add_u32 m0, s56, 2048
    s_add_u32 s58, s57, 18432
    s_and_b32 s58, s58, 0xffff
    s_lshl_b32 s58, s58, 5
    buffer_load_dwordx4 v200, s[52:55], s58 offen lds
    s_add_u32 m0, s56, 3072
    s_add_u32 s58, s57, 19456
    s_and_b32 s58, s58, 0xffff
    s_lshl_b32 s58, s58, 5
    buffer_load_dwordx4 v200, s[52:55], s58 offen lds
    s_add_u32 m0, s56, 4096
    s_add_u32 s58, s57, 20480
    s_and_b32 s58, s58, 0xffff
    s_lshl_b32 s58, s58, 5
    buffer_load_dwordx4 v200, s[52:55], s58 offen lds
    s_add_u32 m0, s56, 5120
    s_add_u32 s58, s57, 21504
    s_and_b32 s58, s58, 0xffff
    s_lshl_b32 s58, s58, 5
    buffer_load_dwordx4 v200, s[52:55], s58 offen lds
    s_add_u32 m0, s56, 6144
    s_add_u32 s58, s57, 22528
    s_and_b32 s58, s58, 0xffff
    s_lshl_b32 s58, s58, 5
    buffer_load_dwordx4 v200, s[52:55], s58 offen lds
    s_add_u32 m0, s56, 7168
    s_add_u32 s58, s57, 23552
    s_and_b32 s58, s58, 0xffff
    s_lshl_b32 s58, s58, 5
    buffer_load_dwordx4 v200, s[52:55], s58 offen lds
    s_add_u32 m0, s56, 8192
    s_add_u32 s58, s57, 24576
    s_and_b32 s58, s58, 0xffff
    s_lshl_b32 s58, s58, 5
    buffer_load_dwordx4 v200, s[52:55], s58 offen lds
    s_add_u32 m0, s56, 9216
    s_add_u32 s58, s57, 25600
    s_and_b32 s58, s58, 0xffff
    s_lshl_b32 s58, s58, 5
    buffer_load_dwordx4 v200, s[52:55], s58 offen lds
    s_add_u32 m0, s56, 10240
    s_add_u32 s58, s57, 26624
    s_and_b32 s58, s58, 0xffff
    s_lshl_b32 s58, s58, 5
    buffer_load_dwordx4 v200, s[52:55], s58 offen lds
    s_add_u32 m0, s56, 11264
    s_add_u32 s58, s57, 27648
    s_and_b32 s58, s58, 0xffff
    s_lshl_b32 s58, s58, 5
    buffer_load_dwordx4 v200, s[52:55], s58 offen lds
    s_add_u32 m0, s56, 12288
    s_add_u32 s58, s57, 28672
    s_and_b32 s58, s58, 0xffff
    s_lshl_b32 s58, s58, 5
    buffer_load_dwordx4 v200, s[52:55], s58 offen lds
    s_add_u32 m0, s56, 13312
    s_add_u32 s58, s57, 29696
    s_and_b32 s58, s58, 0xffff
    s_lshl_b32 s58, s58, 5
    buffer_load_dwordx4 v200, s[52:55], s58 offen lds
    s_add_u32 m0, s56, 14336
    s_add_u32 s58, s57, 30720
    s_and_b32 s58, s58, 0xffff
    s_lshl_b32 s58, s58, 5
    buffer_load_dwordx4 v200, s[52:55], s58 offen lds
    s_add_u32 m0, s56, 15360
    s_add_u32 s58, s57, 31744
    s_and_b32 s58, s58, 0xffff
    s_lshl_b32 s58, s58, 5
    buffer_load_dwordx4 v200, s[52:55], s58 offen lds
    s_cmp_ge_u32 s92, 128
    s_cbranch_scc1 mega_kernel_xo
mega_kernel_wf1:
    s_sleep 8
    buffer_load_dword v2, off, s[88:91], 0 offset:72 sc1
    s_waitcnt vmcnt(0)
    v_cmp_ne_u32 vcc, 192, v2
    s_cbranch_vccnz mega_kernel_wf1
    s_mov_b32 s99, s92
    s_barrier
mega_kernel_f2_in:
    s_load_dwordx2 s[8:9], s[0:1], 96
    v_lshrrev_b32 v5, 6, v0
    v_and_b32 v1, 63, v0
    v_readfirstlane_b32 s12, v5
    s_lshl_b32 s13, s99, 2
    s_add_u32 s13, s13, s12
    s_cmp_ge_u32 s13, 513
    s_cbranch_scc1 mega_kernel_f2_end
    v_cvt_f32_u32 v2, v1
    s_waitcnt lgkmcnt(0)
    s_mov_b32 s10, 268435456
    s_mov_b32 s11, 0x00020000
    s_lshl_b32 s14, s13, 14
    s_add_u32 s15, s14, 96468992
    v_lshlrev_b32 v5, 3, v1
    s_add_u32 s16, s15, 0
    buffer_load_dwordx2 v[16:17], v5, s[8:11], s16 offen
    s_add_u32 s16, s15, 512
    buffer_load_dwordx2 v[18:19], v5, s[8:11], s16 offen
    s_add_u32 s16, s15, 1024
    buffer_load_dwordx2 v[20:21], v5, s[8:11], s16 offen
    s_add_u32 s16, s15, 1536
    buffer_load_dwordx2 v[22:23], v5, s[8:11], s16 offen
    s_add_u32 s16, s15, 2048
    buffer_load_dwordx2 v[24:25], v5, s[8:11], s16 offen
    s_add_u32 s16, s15, 2560
    buffer_load_dwordx2 v[26:27], v5, s[8:11], s16 offen
    s_add_u32 s16, s15, 3072
    buffer_load_dwordx2 v[28:29], v5, s[8:11], s16 offen
    s_add_u32 s16, s15, 3584
    buffer_load_dwordx2 v[30:31], v5, s[8:11], s16 offen
    s_add_u32 s16, s15, 4096
    buffer_load_dwordx2 v[32:33], v5, s[8:11], s16 offen
    s_add_u32 s16, s15, 4608
    buffer_load_dwordx2 v[34:35], v5, s[8:11], s16 offen
    s_add_u32 s16, s15, 5120
    buffer_load_dwordx2 v[36:37], v5, s[8:11], s16 offen
    s_add_u32 s16, s15, 5632
    buffer_load_dwordx2 v[38:39], v5, s[8:11], s16 offen
    s_add_u32 s16, s15, 6144
    buffer_load_dwordx2 v[40:41], v5, s[8:11], s16 offen
    s_add_u32 s16, s15, 6656
    buffer_load_dwordx2 v[42:43], v5, s[8:11], s16 offen
    s_add_u32 s16, s15, 7168
    buffer_load_dwordx2 v[44:45], v5, s[8:11], s16 offen
    s_add_u32 s16, s15, 7680
    buffer_load_dwordx2 v[46:47], v5, s[8:11], s16 offen
    s_add_u32 s16, s15, 8192
    buffer_load_dwordx2 v[48:49], v5, s[8:11], s16 offen
    s_add_u32 s16, s15, 8704
    buffer_load_dwordx2 v[50:51], v5, s[8:11], s16 offen
    s_add_u32 s16, s15, 9216
    buffer_load_dwordx2 v[52:53], v5, s[8:11], s16 offen
    s_add_u32 s16, s15, 9728
    buffer_load_dwordx2 v[54:55], v5, s[8:11], s16 offen
    s_add_u32 s16, s15, 10240
    buffer_load_dwordx2 v[56:57], v5, s[8:11], s16 offen
    s_add_u32 s16, s15, 10752
    buffer_load_dwordx2 v[58:59], v5, s[8:11], s16 offen
    s_add_u32 s16, s15, 11264
    buffer_load_dwordx2 v[60:61], v5, s[8:11], s16 offen
    s_add_u32 s16, s15, 11776
    buffer_load_dwordx2 v[62:63], v5, s[8:11], s16 offen
    s_add_u32 s16, s15, 12288
    buffer_load_dwordx2 v[64:65], v5, s[8:11], s16 offen
    s_add_u32 s16, s15, 12800
    buffer_load_dwordx2 v[66:67], v5, s[8:11], s16 offen
    s_add_u32 s16, s15, 13312
    buffer_load_dwordx2 v[68:69], v5, s[8:11], s16 offen
    s_add_u32 s16, s15, 13824
    buffer_load_dwordx2 v[70:71], v5, s[8:11], s16 offen
    s_add_u32 s16, s15, 14336
    buffer_load_dwordx2 v[72:73], v5, s[8:11], s16 offen
    s_add_u32 s16, s15, 14848
    buffer_load_dwordx2 v[74:75], v5, s[8:11], s16 offen
    s_add_u32 s16, s15, 15360
    buffer_load_dwordx2 v[76:77], v5, s[8:11], s16 offen
    s_add_u32 s16, s15, 15872
    buffer_load_dwordx2 v[78:79], v5, s[8:11], s16 offen
    s_mul_i32 s17, s12, 16896
    v_lshlrev_b32 v3, 3, v1
    v_add_u32 v3, s17, v3
    v_and_b32 v7, 1, v1
    v_lshrrev_b32 v6, 1, v1
    v_cvt_f32_u32 v8, v6
    v_cvt_f32_u32 v10, v7
    s_movk_i32 s18, 528
    v_mul_lo_u32 v4, v6, s18
    v_lshl_add_u32 v4, v7, 3, v4
    v_add_u32 v4, s17, v4
    v_mov_b32 v9, 1.0
    v_fma_f32 v9, v10, -2.0, v9
    v_lshlrev_b32 v5, 12, v7
    v_lshl_add_u32 v11, v6, 2, v5
    s_lshl_b32 s19, s13, 13
    s_add_u32 s19, s19, 121634816
    s_waitcnt vmcnt(0)
    v_sub_f32 v80, v16, v48
    v_sub_f32 v81, v17, v49
    v_add_f32 v16, v16, v48
    v_add_f32 v17, v17, v49
    v_sub_f32 v48, v18, v50
    v_sub_f32 v49, v19, v51
    v_add_f32 v18, v18, v50
    v_add_f32 v19, v19, v51
    v_mul_f32 v50, 0x3f7b14be, v48
    v_mul_f32 v51, 0xbe47c5c2, v48
    v_fmac_f32 v50, 0x3e47c5c2, v49
    v_fmac_f32 v51, 0x3f7b14be, v49
    v_sub_f32 v48, v20, v52
    v_sub_f32 v49, v21, v53
    v_add_f32 v20, v20, v52
    v_add_f32 v21, v21, v53
    v_mul_f32 v52, 0x3f6c835e, v48
    v_mul_f32 v53, 0xbec3ef15, v48
    v_fmac_f32 v52, 0x3ec3ef15, v49
    v_fmac_f32 v53, 0x3f6c835e, v49
    v_sub_f32 v48, v22, v54
    v_sub_f32 v49, v23, v55
    v_add_f32 v22, v22, v54
    v_add_f32 v23, v23, v55
    v_mul_f32 v54, 0x3f54db31, v48
    v_mul_f32 v55, 0xbf0e39da, v48
    v_fmac_f32 v54, 0x3f0e39da, v49
    v_fmac_f32 v55, 0x3f54db31, v49
    v_sub_f32 v48, v24, v56
    v_sub_f32 v49, v25, v57
    v_add_f32 v24, v24, v56
    v_add_f32 v25, v25, v57
    v_mul_f32 v56, 0x3f3504f3, v48
    v_mul_f32 v57, 0xbf3504f3, v48
    v_fmac_f32 v56, 0x3f3504f3, v49
    v_fmac_f32 v57, 0x3f3504f3, v49
    v_sub_f32 v48, v26, v58
    v_sub_f32 v49, v27, v59
    v_add_f32 v26, v26, v58
    v_add_f32 v27, v27, v59
    v_mul_f32 v58, 0x3f0e39da, v48
    v_mul_f32 v59, 0xbf54db31, v48
    v_fmac_f32 v58, 0x3f54db31, v49
    v_fmac_f32 v59, 0x3f0e39da, v49
    v_sub_f32 v48, v28, v60
    v_sub_f32 v49, v29, v61
    v_add_f32 v28, v28, v60
    v_add_f32 v29, v29, v61
    v_mul_f32 v60, 0x3ec3ef15, v48
    v_mul_f32 v61, 0xbf6c835e, v48
    v_fmac_f32 v60, 0x3f6c835e, v49
    v_fmac_f32 v61, 0x3ec3ef15, v49
    v_sub_f32 v48, v30, v62
    v_sub_f32 v49, v31, v63
    v_add_f32 v30, v30, v62
    v_add_f32 v31, v31, v63
    v_mul_f32 v62, 0x3e47c5c2, v48
    v_mul_f32 v63, 0xbf7b14be, v48
    v_fmac_f32 v62, 0x3f7b14be, v49
    v_fmac_f32 v63, 0x3e47c5c2, v49
    v_sub_f32 v48, v33, v65
    v_sub_f32 v49, v64, v32
    v_add_f32 v32, v32, v64
    v_add_f32 v33, v33, v65
    v_sub_f32 v64, v34, v66
    v_sub_f32 v65, v35, v67
    v_add_f32 v34, v34, v66
    v_add_f32 v35, v35, v67
    v_mul_f32 v66, 0xbe47c5c2, v64
    v_mul_f32 v67, 0xbf7b14be, v64
    v_fmac_f32 v66, 0x3f7b14be, v65
    v_fmac_f32 v67, 0xbe47c5c2, v65
    v_sub_f32 v64, v36, v68
    v_sub_f32 v65, v37, v69
    v_add_f32 v36, v36, v68
    v_add_f32 v37, v37, v69
    v_mul_f32 v68, 0xbec3ef15, v64
    v_mul_f32 v69, 0xbf6c835e, v64
    v_fmac_f32 v68, 0x3f6c835e, v65
    v_fmac_f32 v69, 0xbec3ef15, v65
    v_sub_f32 v64, v38, v70
    v_sub_f32 v65, v39, v71
    v_add_f32 v38, v38, v70
    v_add_f32 v39, v39, v71
    v_mul_f32 v70, 0xbf0e39da, v64
    v_mul_f32 v71, 0xbf54db31, v64
    v_fmac_f32 v70, 0x3f54db31, v65
    v_fmac_f32 v71, 0xbf0e39da, v65
    v_sub_f32 v64, v40, v72
    v_sub_f32 v65, v41, v73
    v_add_f32 v40, v40, v72
    v_add_f32 v41, v41, v73
    v_mul_f32 v72, 0xbf3504f3, v64
    v_mul_f32 v73, 0xbf3504f3, v64
    v_fmac_f32 v72, 0x3f3504f3, v65
    v_fmac_f32 v73, 0xbf3504f3, v65
    v_sub_f32 v64, v42, v74
    v_sub_f32 v65, v43, v75
    v_add_f32 v42, v42, v74
    v_add_f32 v43, v43, v75
    v_mul_f32 v74, 0xbf54db31, v64
    v_mul_f32 v75, 0xbf0e39da, v64
    v_fmac_f32 v74, 0x3f0e39da, v65
    v_fmac_f32 v75, 0xbf54db31, v65
    v_sub_f32 v64, v44, v76
    v_sub_f32 v65, v45, v77
    v_add_f32 v44, v44, v76
    v_add_f32 v45, v45, v77
    v_mul_f32 v76, 0xbf6c835e, v64
    v_mul_f32 v77, 0xbec3ef15, v64
    v_fmac_f32 v76, 0x3ec3ef15, v65
    v_fmac_f32 v77, 0xbf6c835e, v65
    v_sub_f32 v64, v46, v78
    v_sub_f32 v65, v47, v79
    v_add_f32 v46, v46, v78
    v_add_f32 v47, v47, v79
    v_mul_f32 v78, 0xbf7b14be, v64
    v_mul_f32 v79, 0xbe47c5c2, v64
    v_fmac_f32 v78, 0x3e47c5c2, v65
    v_fmac_f32 v79, 0xbf7b14be, v65
    v_sub_f32 v64, v16, v32
    v_sub_f32 v65, v17, v33
    v_add_f32 v16, v16, v32
    v_add_f32 v17, v17, v33
    v_sub_f32 v32, v18, v34
    v_sub_f32 v33, v19, v35
    v_add_f32 v18, v18, v34
    v_add_f32 v19, v19, v35
    v_mul_f32 v34, 0x3f6c835e, v32
    v_mul_f32 v35, 0xbec3ef15, v32
    v_fmac_f32 v34, 0x3ec3ef15, v33
    v_fmac_f32 v35, 0x3f6c835e, v33
    v_sub_f32 v32, v20, v36
    v_sub_f32 v33, v21, v37
    v_add_f32 v20, v20, v36
    v_add_f32 v21, v21, v37
    v_mul_f32 v36, 0x3f3504f3, v32
    v_mul_f32 v37, 0xbf3504f3, v32
    v_fmac_f32 v36, 0x3f3504f3, v33
    v_fmac_f32 v37, 0x3f3504f3, v33
    v_sub_f32 v32, v22, v38
    v_sub_f32 v33, v23, v39
    v_add_f32 v22, v22, v38
    v_add_f32 v23, v23, v39
    v_mul_f32 v38, 0x3ec3ef15, v32
    v_mul_f32 v39, 0xbf6c835e, v32
    v_fmac_f32 v38, 0x3f6c835e, v33
    v_fmac_f32 v39, 0x3ec3ef15, v33
    v_sub_f32 v32, v25, v41
    v_sub_f32 v33, v40, v24
    v_add_f32 v24, v24, v40
    v_add_f32 v25, v25, v41
    v_sub_f32 v40, v26, v42
    v_sub_f32 v41, v27, v43
    v_add_f32 v26, v26, v42
    v_add_f32 v27, v27, v43
    v_mul_f32 v42, 0xbec3ef15, v40
    v_mul_f32 v43, 0xbf6c835e, v40
    v_fmac_f32 v42, 0x3f6c835e, v41
    v_fmac_f32 v43, 0xbec3ef15, v41
    v_sub_f32 v40, v28, v44
    v_sub_f32 v41, v29, v45
    v_add_f32 v28, v28, v44
    v_add_f32 v29, v29, v45
    v_mul_f32 v44, 0xbf3504f3, v40
    v_mul_f32 v45, 0xbf3504f3, v40
    v_fmac_f32 v44, 0x3f3504f3, v41
    v_fmac_f32 v45, 0xbf3504f3, v41
    v_sub_f32 v40, v30, v46
    v_sub_f32 v41, v31, v47
    v_add_f32 v30, v30, v46
    v_add_f32 v31, v31, v47
    v_mul_f32 v46, 0xbf6c835e, v40
    v_mul_f32 v47, 0xbec3ef15, v40
    v_fmac_f32 v46, 0x3ec3ef15, v41
    v_fmac_f32 v47, 0xbf6c835e, v41
    v_sub_f32 v40, v80, v48
    v_sub_f32 v41, v81, v49
    v_add_f32 v80, v80, v48
    v_add_f32 v81, v81, v49
    v_sub_f32 v48, v50, v66
    v_sub_f32 v49, v51, v67
    v_add_f32 v50, v50, v66
    v_add_f32 v51, v51, v67
    v_mul_f32 v66, 0x3f6c835e, v48
    v_mul_f32 v67, 0xbec3ef15, v48
    v_fmac_f32 v66, 0x3ec3ef15, v49
    v_fmac_f32 v67, 0x3f6c835e, v49
    v_sub_f32 v48, v52, v68
    v_sub_f32 v49, v53, v69
    v_add_f32 v52, v52, v68
    v_add_f32 v53, v53, v69
    v_mul_f32 v68, 0x3f3504f3, v48
    v_mul_f32 v69, 0xbf3504f3, v48
    v_fmac_f32 v68, 0x3f3504f3, v49
    v_fmac_f32 v69, 0x3f3504f3, v49
    v_sub_f32 v48, v54, v70
    v_sub_f32 v49, v55, v71
    v_add_f32 v54, v54, v70
    v_add_f32 v55, v55, v71
    v_mul_f32 v70, 0x3ec3ef15, v48
    v_mul_f32 v71, 0xbf6c835e, v48
    v_fmac_f32 v70, 0x3f6c835e, v49
    v_fmac_f32 v71, 0x3ec3ef15, v49
    v_sub_f32 v48, v57, v73
    v_sub_f32 v49, v72, v56
    v_add_f32 v56, v56, v72
    v_add_f32 v57, v57, v73
    v_sub_f32 v72, v58, v74
    v_sub_f32 v73, v59, v75
    v_add_f32 v58, v58, v74
    v_add_f32 v59, v59, v75
    v_mul_f32 v74, 0xbec3ef15, v72
    v_mul_f32 v75, 0xbf6c835e, v72
    v_fmac_f32 v74, 0x3f6c835e, v73
    v_fmac_f32 v75, 0xbec3ef15, v73
    v_sub_f32 v72, v60, v76
    v_sub_f32 v73, v61, v77
    v_add_f32 v60, v60, v76
    v_add_f32 v61, v61, v77
    v_mul_f32 v76, 0xbf3504f3, v72
    v_mul_f32 v77, 0xbf3504f3, v72
    v_fmac_f32 v76, 0x3f3504f3, v73
    v_fmac_f32 v77, 0xbf3504f3, v73
    v_sub_f32 v72, v62, v78
    v_sub_f32 v73, v63, v79
    v_add_f32 v62, v62, v78
    v_add_f32 v63, v63, v79
    v_mul_f32 v78, 0xbf6c835e, v72
    v_mul_f32 v79, 0xbec3ef15, v72
    v_fmac_f32 v78, 0x3ec3ef15, v73
    v_fmac_f32 v79, 0xbf6c835e, v73
    v_sub_f32 v72, v16, v24
    v_sub_f32 v73, v17, v25
    v_add_f32 v16, v16, v24
    v_add_f32 v17, v17, v25
    v_sub_f32 v24, v18, v26
    v_sub_f32 v25, v19, v27
    v_add_f32 v18, v18, v26
    v_add_f32 v19, v19, v27
    v_mul_f32 v26, 0x3f3504f3, v24
    v_mul_f32 v27, 0xbf3504f3, v24
    v_fmac_f32 v26, 0x3f3504f3, v25
    v_fmac_f32 v27, 0x3f3504f3, v25
    v_sub_f32 v24, v21, v29
    v_sub_f32 v25, v28, v20
    v_add_f32 v20, v20, v28
    v_add_f32 v21, v21, v29
    v_sub_f32 v28, v22, v30
    v_sub_f32 v29, v23, v31
    v_add_f32 v22, v22, v30
    v_add_f32 v23, v23, v31
    v_mul_f32 v30, 0xbf3504f3, v28
    v_mul_f32 v31, 0xbf3504f3, v28
    v_fmac_f32 v30, 0x3f3504f3, v29
    v_fmac_f32 v31, 0xbf3504f3, v29
    v_sub_f32 v28, v64, v32
    v_sub_f32 v29, v65, v33
    v_add_f32 v64, v64, v32
    v_add_f32 v65, v65, v33
    v_sub_f32 v32, v34, v42
    v_sub_f32 v33, v35, v43
    v_add_f32 v34, v34, v42
    v_add_f32 v35, v35, v43
    v_mul_f32 v42, 0x3f3504f3, v32
    v_mul_f32 v43, 0xbf3504f3, v32
    v_fmac_f32 v42, 0x3f3504f3, v33
    v_fmac_f32 v43, 0x3f3504f3, v33
    v_sub_f32 v32, v37, v45
    v_sub_f32 v33, v44, v36
    v_add_f32 v36, v36, v44
    v_add_f32 v37, v37, v45
    v_sub_f32 v44, v38, v46
    v_sub_f32 v45, v39, v47
    v_add_f32 v38, v38, v46
    v_add_f32 v39, v39, v47
    v_mul_f32 v46, 0xbf3504f3, v44
    v_mul_f32 v47, 0xbf3504f3, v44
    v_fmac_f32 v46, 0x3f3504f3, v45
    v_fmac_f32 v47, 0xbf3504f3, v45
    v_sub_f32 v44, v80, v56
    v_sub_f32 v45, v81, v57
    v_add_f32 v80, v80, v56
    v_add_f32 v81, v81, v57
    v_sub_f32 v56, v50, v58
    v_sub_f32 v57, v51, v59
    v_add_f32 v50, v50, v58
    v_add_f32 v51, v51, v59
    v_mul_f32 v58, 0x3f3504f3, v56
    v_mul_f32 v59, 0xbf3504f3, v56
    v_fmac_f32 v58, 0x3f3504f3, v57
    v_fmac_f32 v59, 0x3f3504f3, v57
    v_sub_f32 v56, v53, v61
    v_sub_f32 v57, v60, v52
    v_add_f32 v52, v52, v60
    v_add_f32 v53, v53, v61
    v_sub_f32 v60, v54, v62
    v_sub_f32 v61, v55, v63
    v_add_f32 v54, v54, v62
    v_add_f32 v55, v55, v63
    v_mul_f32 v62, 0xbf3504f3, v60
    v_mul_f32 v63, 0xbf3504f3, v60
    v_fmac_f32 v62, 0x3f3504f3, v61
    v_fmac_f32 v63, 0xbf3504f3, v61
    v_sub_f32 v60, v40, v48
    v_sub_f32 v61, v41, v49
    v_add_f32 v40, v40, v48
    v_add_f32 v41, v41, v49
    v_sub_f32 v48, v66, v74
    v_sub_f32 v49, v67, v75
    v_add_f32 v66, v66, v74
    v_add_f32 v67, v67, v75
    v_mul_f32 v74, 0x3f3504f3, v48
    v_mul_f32 v75, 0xbf3504f3, v48
    v_fmac_f32 v74, 0x3f3504f3, v49
    v_fmac_f32 v75, 0x3f3504f3, v49
    v_sub_f32 v48, v69, v77
    v_sub_f32 v49, v76, v68
    v_add_f32 v68, v68, v76
    v_add_f32 v69, v69, v77
    v_sub_f32 v76, v70, v78
    v_sub_f32 v77, v71, v79
    v_add_f32 v70, v70, v78
    v_add_f32 v71, v71, v79
    v_mul_f32 v78, 0xbf3504f3, v76
    v_mul_f32 v79, 0xbf3504f3, v76
    v_fmac_f32 v78, 0x3f3504f3, v77
    v_fmac_f32 v79, 0xbf3504f3, v77
    v_sub_f32 v76, v16, v20
    v_sub_f32 v77, v17, v21
    v_add_f32 v16, v16, v20
    v_add_f32 v17, v17, v21
    v_sub_f32 v20, v19, v23
    v_sub_f32 v21, v22, v18
    v_add_f32 v18, v18, v22
    v_add_f32 v19, v19, v23
    v_sub_f32 v22, v72, v24
    v_sub_f32 v23, v73, v25
    v_add_f32 v72, v72, v24
    v_add_f32 v73, v73, v25
    v_sub_f32 v24, v27, v31
    v_sub_f32 v25, v30, v26
    v_add_f32 v26, v26, v30
    v_add_f32 v27, v27, v31
    v_sub_f32 v30, v64, v36
    v_sub_f32 v31, v65, v37
    v_add_f32 v64, v64, v36
    v_add_f32 v65, v65, v37
    v_sub_f32 v36, v35, v39
    v_sub_f32 v37, v38, v34
    v_add_f32 v34, v34, v38
    v_add_f32 v35, v35, v39
    v_sub_f32 v38, v28, v32
    v_sub_f32 v39, v29, v33
    v_add_f32 v28, v28, v32
    v_add_f32 v29, v29, v33
    v_sub_f32 v32, v43, v47
    v_sub_f32 v33, v46, v42
    v_add_f32 v42, v42, v46
    v_add_f32 v43, v43, v47
    v_sub_f32 v46, v80, v52
    v_sub_f32 v47, v81, v53
    v_add_f32 v80, v80, v52
    v_add_f32 v81, v81, v53
    v_sub_f32 v52, v51, v55
    v_sub_f32 v53, v54, v50
    v_add_f32 v50, v50, v54
    v_add_f32 v51, v51, v55
    v_sub_f32 v54, v44, v56
    v_sub_f32 v55, v45, v57
    v_add_f32 v44, v44, v56
    v_add_f32 v45, v45, v57
    v_sub_f32 v56, v59, v63
    v_sub_f32 v57, v62, v58
    v_add_f32 v58, v58, v62
    v_add_f32 v59, v59, v63
    v_sub_f32 v62, v40, v68
    v_sub_f32 v63, v41, v69
    v_add_f32 v40, v40, v68
    v_add_f32 v41, v41, v69
    v_sub_f32 v68, v67, v71
    v_sub_f32 v69, v70, v66
    v_add_f32 v66, v66, v70
    v_add_f32 v67, v67, v71
    v_sub_f32 v70, v60, v48
    v_sub_f32 v71, v61, v49
    v_add_f32 v60, v60, v48
    v_add_f32 v61, v61, v49
    v_sub_f32 v48, v75, v79
    v_sub_f32 v49, v78, v74
    v_add_f32 v74, v74, v78
    v_add_f32 v75, v75, v79
    v_sub_f32 v78, v16, v18
    v_sub_f32 v79, v17, v19
    v_add_f32 v16, v16, v18
    v_add_f32 v17, v17, v19
    v_sub_f32 v18, v76, v20
    v_sub_f32 v19, v77, v21
    v_add_f32 v76, v76, v20
    v_add_f32 v77, v77, v21
    v_sub_f32 v20, v72, v26
    v_sub_f32 v21, v73, v27
    v_add_f32 v72, v72, v26
    v_add_f32 v73, v73, v27
    v_sub_f32 v26, v22, v24
    v_sub_f32 v27, v23, v25
    v_add_f32 v22, v22, v24
    v_add_f32 v23, v23, v25
    v_sub_f32 v24, v64, v34
    v_sub_f32 v25, v65, v35
    v_add_f32 v64, v64, v34
    v_add_f32 v65, v65, v35
    v_sub_f32 v34, v30, v36
    v_sub_f32 v35, v31, v37
    v_add_f32 v30, v30, v36
    v_add_f32 v31, v31, v37
    v_sub_f32 v36, v28, v42
    v_sub_f32 v37, v29, v43
    v_add_f32 v28, v28, v42
    v_add_f32 v29, v29, v43
    v_sub_f32 v42, v38, v32
    v_sub_f32 v43, v39, v33
    v_add_f32 v38, v38, v32
    v_add_f32 v39, v39, v33
    v_sub_f32 v32, v80, v50
    v_sub_f32 v33, v81, v51
    v_add_f32 v80, v80, v50
    v_add_f32 v81, v81, v51
    v_sub_f32 v50, v46, v52
    v_sub_f32 v51, v47, v53
    v_add_f32 v46, v46, v52
    v_add_f32 v47, v47, v53
    v_sub_f32 v52, v44, v58
    v_sub_f32 v53, v45, v59
    v_add_f32 v44, v44, v58
    v_add_f32 v45, v45, v59
    v_sub_f32 v58, v54, v56
    v_sub_f32 v59, v55, v57
    v_add_f32 v54, v54, v56
    v_add_f32 v55, v55, v57
    v_sub_f32 v56, v40, v66
    v_sub_f32 v57, v41, v67
    v_add_f32 v40, v40, v66
    v_add_f32 v41, v41, v67
    v_sub_f32 v66, v62, v68
    v_sub_f32 v67, v63, v69
    v_add_f32 v62, v62, v68
    v_add_f32 v63, v63, v69
    v_sub_f32 v68, v60, v74
    v_sub_f32 v69, v61, v75
    v_add_f32 v60, v60, v74
    v_add_f32 v61, v61, v75
    v_sub_f32 v74, v70, v48
    v_sub_f32 v75, v71, v49
    v_add_f32 v70, v70, v48
    v_add_f32 v71, v71, v49
    v_mul_f32 v48, 0xba000000, v2
    v_cos_f32 v49, v48
    v_sin_f32 v82, v48
    s_nop 0
    v_mul_f32 v83, v80, v49
    v_fma_f32 v83, -v81, v82, v83
    v_mul_f32 v81, v81, v49
    v_fmac_f32 v81, v80, v82
    v_mul_f32 v48, 0xba800000, v2
    v_cos_f32 v49, v48
    v_sin_f32 v82, v48
    s_nop 0
    v_mul_f32 v80, v64, v49
    v_fma_f32 v80, -v65, v82, v80
    v_mul_f32 v65, v65, v49
    v_fmac_f32 v65, v64, v82
    v_mul_f32 v48, 0xbac00000, v2
    v_cos_f32 v49, v48
    v_sin_f32 v82, v48
    s_nop 0
    v_mul_f32 v64, v40, v49
    v_fma_f32 v64, -v41, v82, v64
    v_mul_f32 v41, v41, v49
    v_fmac_f32 v41, v40, v82
    v_mul_f32 v48, 0xbb000000, v2
    v_cos_f32 v49, v48
    v_sin_f32 v82, v48
    s_nop 0
    v_mul_f32 v40, v72, v49
    v_fma_f32 v40, -v73, v82, v40
    v_mul_f32 v73, v73, v49
    v_fmac_f32 v73, v72, v82
    v_mul_f32 v48, 0xbb200000, v2
    v_cos_f32 v49, v48
    v_sin_f32 v82, v48
    s_nop 0
    v_mul_f32 v72, v44, v49
    v_fma_f32 v72, -v45, v82, v72
    v_mul_f32 v45, v45, v49
    v_fmac_f32 v45, v44, v82
    v_mul_f32 v48, 0xbb400000, v2
    v_cos_f32 v49, v48
    v_sin_f32 v82, v48
    s_nop 0
    v_mul_f32 v44, v28, v49
    v_fma_f32 v44, -v29, v82, v44
    v_mul_f32 v29, v29, v49
    v_fmac_f32 v29, v28, v82
    v_mul_f32 v48, 0xbb600000, v2
    v_cos_f32 v49, v48
    v_sin_f32 v82, v48
    s_nop 0
    v_mul_f32 v28, v60, v49
    v_fma_f32 v28, -v61, v82, v28
    v_mul_f32 v61, v61, v49
    v_fmac_f32 v61, v60, v82
    v_mul_f32 v48, 0xbb800000, v2
    v_cos_f32 v49, v48
    v_sin_f32 v82, v48
    s_nop 0
    v_mul_f32 v60, v76, v49
    v_fma_f32 v60, -v77, v82, v60
    v_mul_f32 v77, v77, v49
    v_fmac_f32 v77, v76, v82
    v_mul_f32 v48, 0xbb900000, v2
    v_cos_f32 v49, v48
    v_sin_f32 v82, v48
    s_nop 0
    v_mul_f32 v76, v46, v49
    v_fma_f32 v76, -v47, v82, v76
    v_mul_f32 v47, v47, v49
    v_fmac_f32 v47, v46, v82
    v_mul_f32 v48, 0xbba00000, v2
    v_cos_f32 v49, v48
    v_sin_f32 v82, v48
    s_nop 0
    v_mul_f32 v46, v30, v49
    v_fma_f32 v46, -v31, v82, v46
    v_mul_f32 v31, v31, v49
    v_fmac_f32 v31, v30, v82
    v_mul_f32 v48, 0xbbb00000, v2
    v_cos_f32 v49, v48
    v_sin_f32 v82, v48
    s_nop 0
    v_mul_f32 v30, v62, v49
    v_fma_f32 v30, -v63, v82, v30
    v_mul_f32 v63, v63, v49
    v_fmac_f32 v63, v62, v82
    v_mul_f32 v48, 0xbbc00000, v2
    v_cos_f32 v49, v48
    v_sin_f32 v82, v48
    s_nop 0
    v_mul_f32 v62, v22, v49
    v_fma_f32 v62, -v23, v82, v62
    v_mul_f32 v23, v23, v49
    v_fmac_f32 v23, v22, v82
    v_mul_f32 v48, 0xbbd00000, v2
    v_cos_f32 v49, v48
    v_sin_f32 v82, v48
    s_nop 0
    v_mul_f32 v22, v54, v49
    v_fma_f32 v22, -v55, v82, v22
    v_mul_f32 v55, v55, v49
    v_fmac_f32 v55, v54, v82
    v_mul_f32 v48, 0xbbe00000, v2
    v_cos_f32 v49, v48
    v_sin_f32 v82, v48
    s_nop 0
    v_mul_f32 v54, v38, v49
    v_fma_f32 v54, -v39, v82, v54
    v_mul_f32 v39, v39, v49
    v_fmac_f32 v39, v38, v82
    v_mul_f32 v48, 0xbbf00000, v2
    v_cos_f32 v49, v48
    v_sin_f32 v82, v48
    s_nop 0
    v_mul_f32 v38, v70, v49
    v_fma_f32 v38, -v71, v82, v38
    v_mul_f32 v71, v71, v49
    v_fmac_f32 v71, v70, v82
    v_mul_f32 v48, 0xbc000000, v2
    v_cos_f32 v49, v48
    v_sin_f32 v82, v48
    s_nop 0
    v_mul_f32 v70, v78, v49
    v_fma_f32 v70, -v79, v82, v70
    v_mul_f32 v79, v79, v49
    v_fmac_f32 v79, v78, v82
    v_mul_f32 v48, 0xbc080000, v2
    v_cos_f32 v49, v48
    v_sin_f32 v82, v48
    s_nop 0
    v_mul_f32 v78, v32, v49
    v_fma_f32 v78, -v33, v82, v78
    v_mul_f32 v33, v33, v49
    v_fmac_f32 v33, v32, v82
    v_mul_f32 v48, 0xbc100000, v2
    v_cos_f32 v49, v48
    v_sin_f32 v82, v48
    s_nop 0
    v_mul_f32 v32, v24, v49
    v_fma_f32 v32, -v25, v82, v32
    v_mul_f32 v25, v25, v49
    v_fmac_f32 v25, v24, v82
    v_mul_f32 v48, 0xbc180000, v2
    v_cos_f32 v49, v48
    v_sin_f32 v82, v48
    s_nop 0
    v_mul_f32 v24, v56, v49
    v_fma_f32 v24, -v57, v82, v24
    v_mul_f32 v57, v57, v49
    v_fmac_f32 v57, v56, v82
    v_mul_f32 v48, 0xbc200000, v2
    v_cos_f32 v49, v48
    v_sin_f32 v82, v48
    s_nop 0
    v_mul_f32 v56, v20, v49
    v_fma_f32 v56, -v21, v82, v56
    v_mul_f32 v21, v21, v49
    v_fmac_f32 v21, v20, v82
    v_mul_f32 v48, 0xbc280000, v2
    v_cos_f32 v49, v48
    v_sin_f32 v82, v48
    s_nop 0
    v_mul_f32 v20, v52, v49
    v_fma_f32 v20, -v53, v82, v20
    v_mul_f32 v53, v53, v49
    v_fmac_f32 v53, v52, v82
    v_mul_f32 v48, 0xbc300000, v2
    v_cos_f32 v49, v48
    v_sin_f32 v82, v48
    s_nop 0
    v_mul_f32 v52, v36, v49
    v_fma_f32 v52, -v37, v82, v52
    v_mul_f32 v37, v37, v49
    v_fmac_f32 v37, v36, v82
    v_mul_f32 v48, 0xbc380000, v2
    v_cos_f32 v49, v48
    v_sin_f32 v82, v48
    s_nop 0
    v_mul_f32 v36, v68, v49
    v_fma_f32 v36, -v69, v82, v36
    v_mul_f32 v69, v69, v49
    v_fmac_f32 v69, v68, v82
    v_mul_f32 v48, 0xbc400000, v2
    v_cos_f32 v49, v48
    v_sin_f32 v82, v48
    s_nop 0
    v_mul_f32 v68, v18, v49
    v_fma_f32 v68, -v19, v82, v68
    v_mul_f32 v19, v19, v49
    v_fmac_f32 v19, v18, v82
    v_mul_f32 v48, 0xbc480000, v2
    v_cos_f32 v49, v48
    v_sin_f32 v82, v48
    s_nop 0
    v_mul_f32 v18, v50, v49
    v_fma_f32 v18, -v51, v82, v18
    v_mul_f32 v51, v51, v49
    v_fmac_f32 v51, v50, v82
    v_mul_f32 v48, 0xbc500000, v2
    v_cos_f32 v49, v48
    v_sin_f32 v82, v48
    s_nop 0
    v_mul_f32 v50, v34, v49
    v_fma_f32 v50, -v35, v82, v50
    v_mul_f32 v35, v35, v49
    v_fmac_f32 v35, v34, v82
    v_mul_f32 v48, 0xbc580000, v2
    v_cos_f32 v49, v48
    v_sin_f32 v82, v48
    s_nop 0
    v_mul_f32 v34, v66, v49
    v_fma_f32 v34, -v67, v82, v34
    v_mul_f32 v67, v67, v49
    v_fmac_f32 v67, v66, v82
    v_mul_f32 v48, 0xbc600000, v2
    v_cos_f32 v49, v48
    v_sin_f32 v82, v48
    s_nop 0
    v_mul_f32 v66, v26, v49
    v_fma_f32 v66, -v27, v82, v66
    v_mul_f32 v27, v27, v49
    v_fmac_f32 v27, v26, v82
    v_mul_f32 v48, 0xbc680000, v2
    v_cos_f32 v49, v48
    v_sin_f32 v82, v48
    s_nop 0
    v_mul_f32 v26, v58, v49
    v_fma_f32 v26, -v59, v82, v26
    v_mul_f32 v59, v59, v49
    v_fmac_f32 v59, v58, v82
    v_mul_f32 v48, 0xbc700000, v2
    v_cos_f32 v49, v48
    v_sin_f32 v82, v48
    s_nop 0
    v_mul_f32 v58, v42, v49
    v_fma_f32 v58, -v43, v82, v58
    v_mul_f32 v43, v43, v49
    v_fmac_f32 v43, v42, v82
    v_mul_f32 v48, 0xbc780000, v2
    v_cos_f32 v49, v48
    v_sin_f32 v82, v48
    s_nop 0
    v_mul_f32 v42, v74, v49
    v_fma_f32 v42, -v75, v82, v42
    v_mul_f32 v75, v75, v49
    v_fmac_f32 v75, v74, v82
    ds_write_b32 v3, v16 offset:0
    ds_write_b32 v3, v17 offset:4
    ds_write_b32 v3, v83 offset:528
    ds_write_b32 v3, v81 offset:532
    ds_write_b32 v3, v80 offset:1056
    ds_write_b32 v3, v65 offset:1060
    ds_write_b32 v3, v64 offset:1584
    ds_write_b32 v3, v41 offset:1588
    ds_write_b32 v3, v40 offset:2112
    ds_write_b32 v3, v73 offset:2116
    ds_write_b32 v3, v72 offset:2640
    ds_write_b32 v3, v45 offset:2644
    ds_write_b32 v3, v44 offset:3168
    ds_write_b32 v3, v29 offset:3172
    ds_write_b32 v3, v28 offset:3696
    ds_write_b32 v3, v61 offset:3700
    ds_write_b32 v3, v60 offset:4224
    ds_write_b32 v3, v77 offset:4228
    ds_write_b32 v3, v76 offset:4752
    ds_write_b32 v3, v47 offset:4756
    ds_write_b32 v3, v46 offset:5280
    ds_write_b32 v3, v31 offset:5284
    ds_write_b32 v3, v30 offset:5808
    ds_write_b32 v3, v63 offset:5812
    ds_write_b32 v3, v62 offset:6336
    ds_write_b32 v3, v23 offset:6340
    ds_write_b32 v3, v22 offset:6864
    ds_write_b32 v3, v55 offset:6868
    ds_write_b32 v3, v54 offset:7392
    ds_write_b32 v3, v39 offset:7396
    ds_write_b32 v3, v38 offset:7920
    ds_write_b32 v3, v71 offset:7924
    ds_write_b32 v3, v70 offset:8448
    ds_write_b32 v3, v79 offset:8452
    ds_write_b32 v3, v78 offset:8976
    ds_write_b32 v3, v33 offset:8980
    ds_write_b32 v3, v32 offset:9504
    ds_write_b32 v3, v25 offset:9508
    ds_write_b32 v3, v24 offset:10032
    ds_write_b32 v3, v57 offset:10036
    ds_write_b32 v3, v56 offset:10560
    ds_write_b32 v3, v21 offset:10564
    ds_write_b32 v3, v20 offset:11088
    ds_write_b32 v3, v53 offset:11092
    ds_write_b32 v3, v52 offset:11616
    ds_write_b32 v3, v37 offset:11620
    ds_write_b32 v3, v36 offset:12144
    ds_write_b32 v3, v69 offset:12148
    ds_write_b32 v3, v68 offset:12672
    ds_write_b32 v3, v19 offset:12676
    ds_write_b32 v3, v18 offset:13200
    ds_write_b32 v3, v51 offset:13204
    ds_write_b32 v3, v50 offset:13728
    ds_write_b32 v3, v35 offset:13732
    ds_write_b32 v3, v34 offset:14256
    ds_write_b32 v3, v67 offset:14260
    ds_write_b32 v3, v66 offset:14784
    ds_write_b32 v3, v27 offset:14788
    ds_write_b32 v3, v26 offset:15312
    ds_write_b32 v3, v59 offset:15316
    ds_write_b32 v3, v58 offset:15840
    ds_write_b32 v3, v43 offset:15844
    ds_write_b32 v3, v42 offset:16368
    ds_write_b32 v3, v75 offset:16372
    s_waitcnt lgkmcnt(0)
    ds_read_b32 v16, v4 offset:0
    ds_read_b32 v17, v4 offset:4
    ds_read_b32 v83, v4 offset:16
    ds_read_b32 v81, v4 offset:20
    ds_read_b32 v80, v4 offset:32
    ds_read_b32 v65, v4 offset:36
    ds_read_b32 v64, v4 offset:48
    ds_read_b32 v41, v4 offset:52
    ds_read_b32 v40, v4 offset:64
    ds_read_b32 v73, v4 offset:68
    ds_read_b32 v72, v4 offset:80
    ds_read_b32 v45, v4 offset:84
    ds_read_b32 v44, v4 offset:96
    ds_read_b32 v29, v4 offset:100
    s_waitcnt lgkmcnt(0)
    ds_read_b32 v28, v4 offset:112
    ds_read_b32 v61, v4 offset:116
    ds_read_b32 v60, v4 offset:128
    ds_read_b32 v77, v4 offset:132
    ds_read_b32 v76, v4 offset:144
    ds_read_b32 v47, v4 offset:148
    ds_read_b32 v46, v4 offset:160
    ds_read_b32 v31, v4 offset:164
    ds_read_b32 v30, v4 offset:176
    ds_read_b32 v63, v4 offset:180
    ds_read_b32 v62, v4 offset:192
    ds_read_b32 v23, v4 offset:196
    ds_read_b32 v22, v4 offset:208
    ds_read_b32 v55, v4 offset:212
    s_waitcnt lgkmcnt(0)
    ds_read_b32 v54, v4 offset:224
    ds_read_b32 v39, v4 offset:228
    ds_read_b32 v38, v4 offset:240
    ds_read_b32 v71, v4 offset:244
    ds_read_b32 v70, v4 offset:256
    ds_read_b32 v79, v4 offset:260
    ds_read_b32 v78, v4 offset:272
    ds_read_b32 v33, v4 offset:276
    ds_read_b32 v32, v4 offset:288
    ds_read_b32 v25, v4 offset:292
    ds_read_b32 v24, v4 offset:304
    ds_read_b32 v57, v4 offset:308
    ds_read_b32 v56, v4 offset:320
    ds_read_b32 v21, v4 offset:324
    s_waitcnt lgkmcnt(0)
    ds_read_b32 v20, v4 offset:336
    ds_read_b32 v53, v4 offset:340
    ds_read_b32 v52, v4 offset:352
    ds_read_b32 v37, v4 offset:356
    ds_read_b32 v36, v4 offset:368
    ds_read_b32 v69, v4 offset:372
    ds_read_b32 v68, v4 offset:384
    ds_read_b32 v19, v4 offset:388
    ds_read_b32 v18, v4 offset:400
    ds_read_b32 v51, v4 offset:404
    ds_read_b32 v50, v4 offset:416
    ds_read_b32 v35, v4 offset:420
    ds_read_b32 v34, v4 offset:432
    ds_read_b32 v67, v4 offset:436
    s_waitcnt lgkmcnt(0)
    ds_read_b32 v66, v4 offset:448
    ds_read_b32 v27, v4 offset:452
    ds_read_b32 v26, v4 offset:464
    ds_read_b32 v59, v4 offset:468
    ds_read_b32 v58, v4 offset:480
    ds_read_b32 v43, v4 offset:484
    ds_read_b32 v42, v4 offset:496
    ds_read_b32 v75, v4 offset:500
    s_waitcnt lgkmcnt(0)
    buffer_load_dword v88, v11, s[8:11], s19 offen offset:0
    buffer_load_dword v89, v11, s[8:11], s19 offen offset:128
    buffer_load_dword v90, v11, s[8:11], s19 offen offset:256
    buffer_load_dword v91, v11, s[8:11], s19 offen offset:384
    buffer_load_dword v92, v11, s[8:11], s19 offen offset:512
    buffer_load_dword v93, v11, s[8:11], s19 offen offset:640
    buffer_load_dword v94, v11, s[8:11], s19 offen offset:768
    buffer_load_dword v95, v11, s[8:11], s19 offen offset:896
    buffer_load_dword v96, v11, s[8:11], s19 offen offset:1024
    buffer_load_dword v97, v11, s[8:11], s19 offen offset:1152
    buffer_load_dword v98, v11, s[8:11], s19 offen offset:1280
    buffer_load_dword v99, v11, s[8:11], s19 offen offset:1408
    buffer_load_dword v100, v11, s[8:11], s19 offen offset:1536
    buffer_load_dword v101, v11, s[8:11], s19 offen offset:1664
    buffer_load_dword v102, v11, s[8:11], s19 offen offset:1792
    buffer_load_dword v103, v11, s[8:11], s19 offen offset:1920
    buffer_load_dword v104, v11, s[8:11], s19 offen offset:2048
    buffer_load_dword v105, v11, s[8:11], s19 offen offset:2176
    buffer_load_dword v106, v11, s[8:11], s19 offen offset:2304
    buffer_load_dword v107, v11, s[8:11], s19 offen offset:2432
    buffer_load_dword v108, v11, s[8:11], s19 offen offset:2560
    buffer_load_dword v109, v11, s[8:11], s19 offen offset:2688
    buffer_load_dword v110, v11, s[8:11], s19 offen offset:2816
    buffer_load_dword v111, v11, s[8:11], s19 offen offset:2944
    buffer_load_dword v112, v11, s[8:11], s19 offen offset:3072
    buffer_load_dword v113, v11, s[8:11], s19 offen offset:3200
    buffer_load_dword v114, v11, s[8:11], s19 offen offset:3328
    buffer_load_dword v115, v11, s[8:11], s19 offen offset:3456
    buffer_load_dword v116, v11, s[8:11], s19 offen offset:3584
    buffer_load_dword v117, v11, s[8:11], s19 offen offset:3712
    buffer_load_dword v118, v11, s[8:11], s19 offen offset:3840
    buffer_load_dword v119, v11, s[8:11], s19 offen offset:3968
    v_sub_f32 v48, v16, v70
    v_sub_f32 v49, v17, v79
    v_add_f32 v16, v16, v70
    v_add_f32 v17, v17, v79
    v_sub_f32 v70, v83, v78
    v_sub_f32 v79, v81, v33
    v_add_f32 v83, v83, v78
    v_add_f32 v81, v81, v33
    v_mul_f32 v78, 0x3f7b14be, v70
    v_mul_f32 v33, 0xbe47c5c2, v70
    v_fmac_f32 v78, 0x3e47c5c2, v79
    v_fmac_f32 v33, 0x3f7b14be, v79
    v_sub_f32 v70, v80, v32
    v_sub_f32 v79, v65, v25
    v_add_f32 v80, v80, v32
    v_add_f32 v65, v65, v25
    v_mul_f32 v32, 0x3f6c835e, v70
    v_mul_f32 v25, 0xbec3ef15, v70
    v_fmac_f32 v32, 0x3ec3ef15, v79
    v_fmac_f32 v25, 0x3f6c835e, v79
    v_sub_f32 v70, v64, v24
    v_sub_f32 v79, v41, v57
    v_add_f32 v64, v64, v24
    v_add_f32 v41, v41, v57
    v_mul_f32 v24, 0x3f54db31, v70
    v_mul_f32 v57, 0xbf0e39da, v70
    v_fmac_f32 v24, 0x3f0e39da, v79
    v_fmac_f32 v57, 0x3f54db31, v79
    v_sub_f32 v70, v40, v56
    v_sub_f32 v79, v73, v21
    v_add_f32 v40, v40, v56
    v_add_f32 v73, v73, v21
    v_mul_f32 v56, 0x3f3504f3, v70
    v_mul_f32 v21, 0xbf3504f3, v70
    v_fmac_f32 v56, 0x3f3504f3, v79
    v_fmac_f32 v21, 0x3f3504f3, v79
    v_sub_f32 v70, v72, v20
    v_sub_f32 v79, v45, v53
    v_add_f32 v72, v72, v20
    v_add_f32 v45, v45, v53
    v_mul_f32 v20, 0x3f0e39da, v70
    v_mul_f32 v53, 0xbf54db31, v70
    v_fmac_f32 v20, 0x3f54db31, v79
    v_fmac_f32 v53, 0x3f0e39da, v79
    v_sub_f32 v70, v44, v52
    v_sub_f32 v79, v29, v37
    v_add_f32 v44, v44, v52
    v_add_f32 v29, v29, v37
    v_mul_f32 v52, 0x3ec3ef15, v70
    v_mul_f32 v37, 0xbf6c835e, v70
    v_fmac_f32 v52, 0x3f6c835e, v79
    v_fmac_f32 v37, 0x3ec3ef15, v79
    v_sub_f32 v70, v28, v36
    v_sub_f32 v79, v61, v69
    v_add_f32 v28, v28, v36
    v_add_f32 v61, v61, v69
    v_mul_f32 v36, 0x3e47c5c2, v70
    v_mul_f32 v69, 0xbf7b14be, v70
    v_fmac_f32 v36, 0x3f7b14be, v79
    v_fmac_f32 v69, 0x3e47c5c2, v79
    v_sub_f32 v70, v77, v19
    v_sub_f32 v79, v68, v60
    v_add_f32 v60, v60, v68
    v_add_f32 v77, v77, v19
    v_sub_f32 v68, v76, v18
    v_sub_f32 v19, v47, v51
    v_add_f32 v76, v76, v18
    v_add_f32 v47, v47, v51
    v_mul_f32 v18, 0xbe47c5c2, v68
    v_mul_f32 v51, 0xbf7b14be, v68
    v_fmac_f32 v18, 0x3f7b14be, v19
    v_fmac_f32 v51, 0xbe47c5c2, v19
    v_sub_f32 v68, v46, v50
    v_sub_f32 v19, v31, v35
    v_add_f32 v46, v46, v50
    v_add_f32 v31, v31, v35
    v_mul_f32 v50, 0xbec3ef15, v68
    v_mul_f32 v35, 0xbf6c835e, v68
    v_fmac_f32 v50, 0x3f6c835e, v19
    v_fmac_f32 v35, 0xbec3ef15, v19
    v_sub_f32 v68, v30, v34
    v_sub_f32 v19, v63, v67
    v_add_f32 v30, v30, v34
    v_add_f32 v63, v63, v67
    v_mul_f32 v34, 0xbf0e39da, v68
    v_mul_f32 v67, 0xbf54db31, v68
    v_fmac_f32 v34, 0x3f54db31, v19
    v_fmac_f32 v67, 0xbf0e39da, v19
    v_sub_f32 v68, v62, v66
    v_sub_f32 v19, v23, v27
    v_add_f32 v62, v62, v66
    v_add_f32 v23, v23, v27
    v_mul_f32 v66, 0xbf3504f3, v68
    v_mul_f32 v27, 0xbf3504f3, v68
    v_fmac_f32 v66, 0x3f3504f3, v19
    v_fmac_f32 v27, 0xbf3504f3, v19
    v_sub_f32 v68, v22, v26
    v_sub_f32 v19, v55, v59
    v_add_f32 v22, v22, v26
    v_add_f32 v55, v55, v59
    v_mul_f32 v26, 0xbf54db31, v68
    v_mul_f32 v59, 0xbf0e39da, v68
    v_fmac_f32 v26, 0x3f0e39da, v19
    v_fmac_f32 v59, 0xbf54db31, v19
    v_sub_f32 v68, v54, v58
    v_sub_f32 v19, v39, v43
    v_add_f32 v54, v54, v58
    v_add_f32 v39, v39, v43
    v_mul_f32 v58, 0xbf6c835e, v68
    v_mul_f32 v43, 0xbec3ef15, v68
    v_fmac_f32 v58, 0x3ec3ef15, v19
    v_fmac_f32 v43, 0xbf6c835e, v19
    v_sub_f32 v68, v38, v42
    v_sub_f32 v19, v71, v75
    v_add_f32 v38, v38, v42
    v_add_f32 v71, v71, v75
    v_mul_f32 v42, 0xbf7b14be, v68
    v_mul_f32 v75, 0xbe47c5c2, v68
    v_fmac_f32 v42, 0x3e47c5c2, v19
    v_fmac_f32 v75, 0xbf7b14be, v19
    v_sub_f32 v68, v16, v60
    v_sub_f32 v19, v17, v77
    v_add_f32 v16, v16, v60
    v_add_f32 v17, v17, v77
    v_sub_f32 v60, v83, v76
    v_sub_f32 v77, v81, v47
    v_add_f32 v83, v83, v76
    v_add_f32 v81, v81, v47
    v_mul_f32 v76, 0x3f6c835e, v60
    v_mul_f32 v47, 0xbec3ef15, v60
    v_fmac_f32 v76, 0x3ec3ef15, v77
    v_fmac_f32 v47, 0x3f6c835e, v77
    v_sub_f32 v60, v80, v46
    v_sub_f32 v77, v65, v31
    v_add_f32 v80, v80, v46
    v_add_f32 v65, v65, v31
    v_mul_f32 v46, 0x3f3504f3, v60
    v_mul_f32 v31, 0xbf3504f3, v60
    v_fmac_f32 v46, 0x3f3504f3, v77
    v_fmac_f32 v31, 0x3f3504f3, v77
    v_sub_f32 v60, v64, v30
    v_sub_f32 v77, v41, v63
    v_add_f32 v64, v64, v30
    v_add_f32 v41, v41, v63
    v_mul_f32 v30, 0x3ec3ef15, v60
    v_mul_f32 v63, 0xbf6c835e, v60
    v_fmac_f32 v30, 0x3f6c835e, v77
    v_fmac_f32 v63, 0x3ec3ef15, v77
    v_sub_f32 v60, v73, v23
    v_sub_f32 v77, v62, v40
    v_add_f32 v40, v40, v62
    v_add_f32 v73, v73, v23
    v_sub_f32 v62, v72, v22
    v_sub_f32 v23, v45, v55
    v_add_f32 v72, v72, v22
    v_add_f32 v45, v45, v55
    v_mul_f32 v22, 0xbec3ef15, v62
    v_mul_f32 v55, 0xbf6c835e, v62
    v_fmac_f32 v22, 0x3f6c835e, v23
    v_fmac_f32 v55, 0xbec3ef15, v23
    v_sub_f32 v62, v44, v54
    v_sub_f32 v23, v29, v39
    v_add_f32 v44, v44, v54
    v_add_f32 v29, v29, v39
    v_mul_f32 v54, 0xbf3504f3, v62
    v_mul_f32 v39, 0xbf3504f3, v62
    v_fmac_f32 v54, 0x3f3504f3, v23
    v_fmac_f32 v39, 0xbf3504f3, v23
    v_sub_f32 v62, v28, v38
    v_sub_f32 v23, v61, v71
    v_add_f32 v28, v28, v38
    v_add_f32 v61, v61, v71
    v_mul_f32 v38, 0xbf6c835e, v62
    v_mul_f32 v71, 0xbec3ef15, v62
    v_fmac_f32 v38, 0x3ec3ef15, v23
    v_fmac_f32 v71, 0xbf6c835e, v23
    v_sub_f32 v62, v48, v70
    v_sub_f32 v23, v49, v79
    v_add_f32 v48, v48, v70
    v_add_f32 v49, v49, v79
    v_sub_f32 v70, v78, v18
    v_sub_f32 v79, v33, v51
    v_add_f32 v78, v78, v18
    v_add_f32 v33, v33, v51
    v_mul_f32 v18, 0x3f6c835e, v70
    v_mul_f32 v51, 0xbec3ef15, v70
    v_fmac_f32 v18, 0x3ec3ef15, v79
    v_fmac_f32 v51, 0x3f6c835e, v79
    v_sub_f32 v70, v32, v50
    v_sub_f32 v79, v25, v35
    v_add_f32 v32, v32, v50
    v_add_f32 v25, v25, v35
    v_mul_f32 v50, 0x3f3504f3, v70
    v_mul_f32 v35, 0xbf3504f3, v70
    v_fmac_f32 v50, 0x3f3504f3, v79
    v_fmac_f32 v35, 0x3f3504f3, v79
    v_sub_f32 v70, v24, v34
    v_sub_f32 v79, v57, v67
    v_add_f32 v24, v24, v34
    v_add_f32 v57, v57, v67
    v_mul_f32 v34, 0x3ec3ef15, v70
    v_mul_f32 v67, 0xbf6c835e, v70
    v_fmac_f32 v34, 0x3f6c835e, v79
    v_fmac_f32 v67, 0x3ec3ef15, v79
    v_sub_f32 v70, v21, v27
    v_sub_f32 v79, v66, v56
    v_add_f32 v56, v56, v66
    v_add_f32 v21, v21, v27
    v_sub_f32 v66, v20, v26
    v_sub_f32 v27, v53, v59
    v_add_f32 v20, v20, v26
    v_add_f32 v53, v53, v59
    v_mul_f32 v26, 0xbec3ef15, v66
    v_mul_f32 v59, 0xbf6c835e, v66
    v_fmac_f32 v26, 0x3f6c835e, v27
    v_fmac_f32 v59, 0xbec3ef15, v27
    v_sub_f32 v66, v52, v58
    v_sub_f32 v27, v37, v43
    v_add_f32 v52, v52, v58
    v_add_f32 v37, v37, v43
    v_mul_f32 v58, 0xbf3504f3, v66
    v_mul_f32 v43, 0xbf3504f3, v66
    v_fmac_f32 v58, 0x3f3504f3, v27
    v_fmac_f32 v43, 0xbf3504f3, v27
    v_sub_f32 v66, v36, v42
    v_sub_f32 v27, v69, v75
    v_add_f32 v36, v36, v42
    v_add_f32 v69, v69, v75
    v_mul_f32 v42, 0xbf6c835e, v66
    v_mul_f32 v75, 0xbec3ef15, v66
    v_fmac_f32 v42, 0x3ec3ef15, v27
    v_fmac_f32 v75, 0xbf6c835e, v27
    v_sub_f32 v66, v16, v40
    v_sub_f32 v27, v17, v73
    v_add_f32 v16, v16, v40
    v_add_f32 v17, v17, v73
    v_sub_f32 v40, v83, v72
    v_sub_f32 v73, v81, v45
    v_add_f32 v83, v83, v72
    v_add_f32 v81, v81, v45
    v_mul_f32 v72, 0x3f3504f3, v40
    v_mul_f32 v45, 0xbf3504f3, v40
    v_fmac_f32 v72, 0x3f3504f3, v73
    v_fmac_f32 v45, 0x3f3504f3, v73
    v_sub_f32 v40, v65, v29
    v_sub_f32 v73, v44, v80
    v_add_f32 v80, v80, v44
    v_add_f32 v65, v65, v29
    v_sub_f32 v44, v64, v28
    v_sub_f32 v29, v41, v61
    v_add_f32 v64, v64, v28
    v_add_f32 v41, v41, v61
    v_mul_f32 v28, 0xbf3504f3, v44
    v_mul_f32 v61, 0xbf3504f3, v44
    v_fmac_f32 v28, 0x3f3504f3, v29
    v_fmac_f32 v61, 0xbf3504f3, v29
    v_sub_f32 v44, v68, v60
    v_sub_f32 v29, v19, v77
    v_add_f32 v68, v68, v60
    v_add_f32 v19, v19, v77
    v_sub_f32 v60, v76, v22
    v_sub_f32 v77, v47, v55
    v_add_f32 v76, v76, v22
    v_add_f32 v47, v47, v55
    v_mul_f32 v22, 0x3f3504f3, v60
    v_mul_f32 v55, 0xbf3504f3, v60
    v_fmac_f32 v22, 0x3f3504f3, v77
    v_fmac_f32 v55, 0x3f3504f3, v77
    v_sub_f32 v60, v31, v39
    v_sub_f32 v77, v54, v46
    v_add_f32 v46, v46, v54
    v_add_f32 v31, v31, v39
    v_sub_f32 v54, v30, v38
    v_sub_f32 v39, v63, v71
    v_add_f32 v30, v30, v38
    v_add_f32 v63, v63, v71
    v_mul_f32 v38, 0xbf3504f3, v54
    v_mul_f32 v71, 0xbf3504f3, v54
    v_fmac_f32 v38, 0x3f3504f3, v39
    v_fmac_f32 v71, 0xbf3504f3, v39
    v_sub_f32 v54, v48, v56
    v_sub_f32 v39, v49, v21
    v_add_f32 v48, v48, v56
    v_add_f32 v49, v49, v21
    v_sub_f32 v56, v78, v20
    v_sub_f32 v21, v33, v53
    v_add_f32 v78, v78, v20
    v_add_f32 v33, v33, v53
    v_mul_f32 v20, 0x3f3504f3, v56
    v_mul_f32 v53, 0xbf3504f3, v56
    v_fmac_f32 v20, 0x3f3504f3, v21
    v_fmac_f32 v53, 0x3f3504f3, v21
    v_sub_f32 v56, v25, v37
    v_sub_f32 v21, v52, v32
    v_add_f32 v32, v32, v52
    v_add_f32 v25, v25, v37
    v_sub_f32 v52, v24, v36
    v_sub_f32 v37, v57, v69
    v_add_f32 v24, v24, v36
    v_add_f32 v57, v57, v69
    v_mul_f32 v36, 0xbf3504f3, v52
    v_mul_f32 v69, 0xbf3504f3, v52
    v_fmac_f32 v36, 0x3f3504f3, v37
    v_fmac_f32 v69, 0xbf3504f3, v37
    v_sub_f32 v52, v62, v70
    v_sub_f32 v37, v23, v79
    v_add_f32 v62, v62, v70
    v_add_f32 v23, v23, v79
    v_sub_f32 v70, v18, v26
    v_sub_f32 v79, v51, v59
    v_add_f32 v18, v18, v26
    v_add_f32 v51, v51, v59
    v_mul_f32 v26, 0x3f3504f3, v70
    v_mul_f32 v59, 0xbf3504f3, v70
    v_fmac_f32 v26, 0x3f3504f3, v79
    v_fmac_f32 v59, 0x3f3504f3, v79
    v_sub_f32 v70, v35, v43
    v_sub_f32 v79, v58, v50
    v_add_f32 v50, v50, v58
    v_add_f32 v35, v35, v43
    v_sub_f32 v58, v34, v42
    v_sub_f32 v43, v67, v75
    v_add_f32 v34, v34, v42
    v_add_f32 v67, v67, v75
    v_mul_f32 v42, 0xbf3504f3, v58
    v_mul_f32 v75, 0xbf3504f3, v58
    v_fmac_f32 v42, 0x3f3504f3, v43
    v_fmac_f32 v75, 0xbf3504f3, v43
    v_sub_f32 v58, v16, v80
    v_sub_f32 v43, v17, v65
    v_add_f32 v16, v16, v80
    v_add_f32 v17, v17, v65
    v_sub_f32 v80, v81, v41
    v_sub_f32 v65, v64, v83
    v_add_f32 v83, v83, v64
    v_add_f32 v81, v81, v41
    v_sub_f32 v64, v66, v40
    v_sub_f32 v41, v27, v73
    v_add_f32 v66, v66, v40
    v_add_f32 v27, v27, v73
    v_sub_f32 v40, v45, v61
    v_sub_f32 v73, v28, v72
    v_add_f32 v72, v72, v28
    v_add_f32 v45, v45, v61
    v_sub_f32 v28, v68, v46
    v_sub_f32 v61, v19, v31
    v_add_f32 v68, v68, v46
    v_add_f32 v19, v19, v31
    v_sub_f32 v46, v47, v63
    v_sub_f32 v31, v30, v76
    v_add_f32 v76, v76, v30
    v_add_f32 v47, v47, v63
    v_sub_f32 v30, v44, v60
    v_sub_f32 v63, v29, v77
    v_add_f32 v44, v44, v60
    v_add_f32 v29, v29, v77
    v_sub_f32 v60, v55, v71
    v_sub_f32 v77, v38, v22
    v_add_f32 v22, v22, v38
    v_add_f32 v55, v55, v71
    v_sub_f32 v38, v48, v32
    v_sub_f32 v71, v49, v25
    v_add_f32 v48, v48, v32
    v_add_f32 v49, v49, v25
    v_sub_f32 v32, v33, v57
    v_sub_f32 v25, v24, v78
    v_add_f32 v78, v78, v24
    v_add_f32 v33, v33, v57
    v_sub_f32 v24, v54, v56
    v_sub_f32 v57, v39, v21
    v_add_f32 v54, v54, v56
    v_add_f32 v39, v39, v21
    v_sub_f32 v56, v53, v69
    v_sub_f32 v21, v36, v20
    v_add_f32 v20, v20, v36
    v_add_f32 v53, v53, v69
    v_sub_f32 v36, v62, v50
    v_sub_f32 v69, v23, v35
    v_add_f32 v62, v62, v50
    v_add_f32 v23, v23, v35
    v_sub_f32 v50, v51, v67
    v_sub_f32 v35, v34, v18
    v_add_f32 v18, v18, v34
    v_add_f32 v51, v51, v67
    v_sub_f32 v34, v52, v70
    v_sub_f32 v67, v37, v79
    v_add_f32 v52, v52, v70
    v_add_f32 v37, v37, v79
    v_sub_f32 v70, v59, v75
    v_sub_f32 v79, v42, v26
    v_add_f32 v26, v26, v42
    v_add_f32 v59, v59, v75
    v_sub_f32 v42, v16, v83
    v_sub_f32 v75, v17, v81
    v_add_f32 v16, v16, v83
    v_add_f32 v17, v17, v81
    v_sub_f32 v83, v58, v80
    v_sub_f32 v81, v43, v65
    v_add_f32 v58, v58, v80
    v_add_f32 v43, v43, v65
    v_sub_f32 v80, v66, v72
    v_sub_f32 v65, v27, v45
    v_add_f32 v66, v66, v72
    v_add_f32 v27, v27, v45
    v_sub_f32 v72, v64, v40
    v_sub_f32 v45, v41, v73
    v_add_f32 v64, v64, v40
    v_add_f32 v41, v41, v73
    v_sub_f32 v40, v68, v76
    v_sub_f32 v73, v19, v47
    v_add_f32 v68, v68, v76
    v_add_f32 v19, v19, v47
    v_sub_f32 v76, v28, v46
    v_sub_f32 v47, v61, v31
    v_add_f32 v28, v28, v46
    v_add_f32 v61, v61, v31
    v_sub_f32 v46, v44, v22
    v_sub_f32 v31, v29, v55
    v_add_f32 v44, v44, v22
    v_add_f32 v29, v29, v55
    v_sub_f32 v22, v30, v60
    v_sub_f32 v55, v63, v77
    v_add_f32 v30, v30, v60
    v_add_f32 v63, v63, v77
    v_sub_f32 v60, v48, v78
    v_sub_f32 v77, v49, v33
    v_add_f32 v48, v48, v78
    v_add_f32 v49, v49, v33
    v_sub_f32 v78, v38, v32
    v_sub_f32 v33, v71, v25
    v_add_f32 v38, v38, v32
    v_add_f32 v71, v71, v25
    v_sub_f32 v32, v54, v20
    v_sub_f32 v25, v39, v53
    v_add_f32 v54, v54, v20
    v_add_f32 v39, v39, v53
    v_sub_f32 v20, v24, v56
    v_sub_f32 v53, v57, v21
    v_add_f32 v24, v24, v56
    v_add_f32 v57, v57, v21
    v_sub_f32 v56, v62, v18
    v_sub_f32 v21, v23, v51
    v_add_f32 v62, v62, v18
    v_add_f32 v23, v23, v51
    v_sub_f32 v18, v36, v50
    v_sub_f32 v51, v69, v35
    v_add_f32 v36, v36, v50
    v_add_f32 v69, v69, v35
    v_sub_f32 v50, v52, v26
    v_sub_f32 v35, v37, v59
    v_add_f32 v52, v52, v26
    v_add_f32 v37, v37, v59
    v_sub_f32 v26, v34, v70
    v_sub_f32 v59, v67, v79
    v_add_f32 v34, v34, v70
    v_add_f32 v67, v67, v79
    v_mul_f32 v70, 0xbc800000, v10
    v_cos_f32 v79, v70
    v_sin_f32 v82, v70
    s_nop 0
    v_mul_f32 v74, v48, v79
    v_fma_f32 v74, -v49, v82, v74
    v_mul_f32 v49, v49, v79
    v_fmac_f32 v49, v48, v82
    v_mul_f32 v70, 0xbd000000, v10
    v_cos_f32 v79, v70
    v_sin_f32 v82, v70
    s_nop 0
    v_mul_f32 v48, v68, v79
    v_fma_f32 v48, -v19, v82, v48
    v_mul_f32 v19, v19, v79
    v_fmac_f32 v19, v68, v82
    v_mul_f32 v70, 0xbd400000, v10
    v_cos_f32 v79, v70
    v_sin_f32 v82, v70
    s_nop 0
    v_mul_f32 v68, v62, v79
    v_fma_f32 v68, -v23, v82, v68
    v_mul_f32 v23, v23, v79
    v_fmac_f32 v23, v62, v82
    v_mul_f32 v70, 0xbd800000, v10
    v_cos_f32 v79, v70
    v_sin_f32 v82, v70
    s_nop 0
    v_mul_f32 v62, v66, v79
    v_fma_f32 v62, -v27, v82, v62
    v_mul_f32 v27, v27, v79
    v_fmac_f32 v27, v66, v82
    v_mul_f32 v70, 0xbda00000, v10
    v_cos_f32 v79, v70
    v_sin_f32 v82, v70
    s_nop 0
    v_mul_f32 v66, v54, v79
    v_fma_f32 v66, -v39, v82, v66
    v_mul_f32 v39, v39, v79
    v_fmac_f32 v39, v54, v82
    v_mul_f32 v70, 0xbdc00000, v10
    v_cos_f32 v79, v70
    v_sin_f32 v82, v70
    s_nop 0
    v_mul_f32 v54, v44, v79
    v_fma_f32 v54, -v29, v82, v54
    v_mul_f32 v29, v29, v79
    v_fmac_f32 v29, v44, v82
    v_mul_f32 v70, 0xbde00000, v10
    v_cos_f32 v79, v70
    v_sin_f32 v82, v70
    s_nop 0
    v_mul_f32 v44, v52, v79
    v_fma_f32 v44, -v37, v82, v44
    v_mul_f32 v37, v37, v79
    v_fmac_f32 v37, v52, v82
    v_mul_f32 v70, 0xbe000000, v10
    v_cos_f32 v79, v70
    v_sin_f32 v82, v70
    s_nop 0
    v_mul_f32 v52, v58, v79
    v_fma_f32 v52, -v43, v82, v52
    v_mul_f32 v43, v43, v79
    v_fmac_f32 v43, v58, v82
    v_mul_f32 v70, 0xbe100000, v10
    v_cos_f32 v79, v70
    v_sin_f32 v82, v70
    s_nop 0
    v_mul_f32 v58, v38, v79
    v_fma_f32 v58, -v71, v82, v58
    v_mul_f32 v71, v71, v79
    v_fmac_f32 v71, v38, v82
    v_mul_f32 v70, 0xbe200000, v10
    v_cos_f32 v79, v70
    v_sin_f32 v82, v70
    s_nop 0
    v_mul_f32 v38, v28, v79
    v_fma_f32 v38, -v61, v82, v38
    v_mul_f32 v61, v61, v79
    v_fmac_f32 v61, v28, v82
    v_mul_f32 v70, 0xbe300000, v10
    v_cos_f32 v79, v70
    v_sin_f32 v82, v70
    s_nop 0
    v_mul_f32 v28, v36, v79
    v_fma_f32 v28, -v69, v82, v28
    v_mul_f32 v69, v69, v79
    v_fmac_f32 v69, v36, v82
    v_mul_f32 v70, 0xbe400000, v10
    v_cos_f32 v79, v70
    v_sin_f32 v82, v70
    s_nop 0
    v_mul_f32 v36, v64, v79
    v_fma_f32 v36, -v41, v82, v36
    v_mul_f32 v41, v41, v79
    v_fmac_f32 v41, v64, v82
    v_mul_f32 v70, 0xbe500000, v10
    v_cos_f32 v79, v70
    v_sin_f32 v82, v70
    s_nop 0
    v_mul_f32 v64, v24, v79
    v_fma_f32 v64, -v57, v82, v64
    v_mul_f32 v57, v57, v79
    v_fmac_f32 v57, v24, v82
    v_mul_f32 v70, 0xbe600000, v10
    v_cos_f32 v79, v70
    v_sin_f32 v82, v70
    s_nop 0
    v_mul_f32 v24, v30, v79
    v_fma_f32 v24, -v63, v82, v24
    v_mul_f32 v63, v63, v79
    v_fmac_f32 v63, v30, v82
    v_mul_f32 v70, 0xbe700000, v10
    v_cos_f32 v79, v70
    v_sin_f32 v82, v70
    s_nop 0
    v_mul_f32 v30, v34, v79
    v_fma_f32 v30, -v67, v82, v30
    v_mul_f32 v67, v67, v79
    v_fmac_f32 v67, v34, v82
    v_mul_f32 v70, 0xbe800000, v10
    v_cos_f32 v79, v70
    v_sin_f32 v82, v70
    s_nop 0
    v_mul_f32 v34, v42, v79
    v_fma_f32 v34, -v75, v82, v34
    v_mul_f32 v75, v75, v79
    v_fmac_f32 v75, v42, v82
    v_mul_f32 v70, 0xbe880000, v10
    v_cos_f32 v79, v70
    v_sin_f32 v82, v70
    s_nop 0
    v_mul_f32 v42, v60, v79
    v_fma_f32 v42, -v77, v82, v42
    v_mul_f32 v77, v77, v79
    v_fmac_f32 v77, v60, v82
    v_mul_f32 v70, 0xbe900000, v10
    v_cos_f32 v79, v70
    v_sin_f32 v82, v70
    s_nop 0
    v_mul_f32 v60, v40, v79
    v_fma_f32 v60, -v73, v82, v60
    v_mul_f32 v73, v73, v79
    v_fmac_f32 v73, v40, v82
    v_mul_f32 v70, 0xbe980000, v10
    v_cos_f32 v79, v70
    v_sin_f32 v82, v70
    s_nop 0
    v_mul_f32 v40, v56, v79
    v_fma_f32 v40, -v21, v82, v40
    v_mul_f32 v21, v21, v79
    v_fmac_f32 v21, v56, v82
    v_mul_f32 v70, 0xbea00000, v10
    v_cos_f32 v79, v70
    v_sin_f32 v82, v70
    s_nop 0
    v_mul_f32 v56, v80, v79
    v_fma_f32 v56, -v65, v82, v56
    v_mul_f32 v65, v65, v79
    v_fmac_f32 v65, v80, v82
    v_mul_f32 v70, 0xbea80000, v10
    v_cos_f32 v79, v70
    v_sin_f32 v82, v70
    s_nop 0
    v_mul_f32 v80, v32, v79
    v_fma_f32 v80, -v25, v82, v80
    v_mul_f32 v25, v25, v79
    v_fmac_f32 v25, v32, v82
    v_mul_f32 v70, 0xbeb00000, v10
    v_cos_f32 v79, v70
    v_sin_f32 v82, v70
    s_nop 0
    v_mul_f32 v32, v46, v79
    v_fma_f32 v32, -v31, v82, v32
    v_mul_f32 v31, v31, v79
    v_fmac_f32 v31, v46, v82
    v_mul_f32 v70, 0xbeb80000, v10
    v_cos_f32 v79, v70
    v_sin_f32 v82, v70
    s_nop 0
    v_mul_f32 v46, v50, v79
    v_fma_f32 v46, -v35, v82, v46
    v_mul_f32 v35, v35, v79
    v_fmac_f32 v35, v50, v82
    v_mul_f32 v70, 0xbec00000, v10
    v_cos_f32 v79, v70
    v_sin_f32 v82, v70
    s_nop 0
    v_mul_f32 v50, v83, v79
    v_fma_f32 v50, -v81, v82, v50
    v_mul_f32 v81, v81, v79
    v_fmac_f32 v81, v83, v82
    v_mul_f32 v70, 0xbec80000, v10
    v_cos_f32 v79, v70
    v_sin_f32 v82, v70
    s_nop 0
    v_mul_f32 v83, v78, v79
    v_fma_f32 v83, -v33, v82, v83
    v_mul_f32 v33, v33, v79
    v_fmac_f32 v33, v78, v82
    v_mul_f32 v70, 0xbed00000, v10
    v_cos_f32 v79, v70
    v_sin_f32 v82, v70
    s_nop 0
    v_mul_f32 v78, v76, v79
    v_fma_f32 v78, -v47, v82, v78
    v_mul_f32 v47, v47, v79
    v_fmac_f32 v47, v76, v82
    v_mul_f32 v70, 0xbed80000, v10
    v_cos_f32 v79, v70
    v_sin_f32 v82, v70
    s_nop 0
    v_mul_f32 v76, v18, v79
    v_fma_f32 v76, -v51, v82, v76
    v_mul_f32 v51, v51, v79
    v_fmac_f32 v51, v18, v82
    v_mul_f32 v70, 0xbee00000, v10
    v_cos_f32 v79, v70
    v_sin_f32 v82, v70
    s_nop 0
    v_mul_f32 v18, v72, v79
    v_fma_f32 v18, -v45, v82, v18
    v_mul_f32 v45, v45, v79
    v_fmac_f32 v45, v72, v82
    v_mul_f32 v70, 0xbee80000, v10
    v_cos_f32 v79, v70
    v_sin_f32 v82, v70
    s_nop 0
    v_mul_f32 v72, v20, v79
    v_fma_f32 v72, -v53, v82, v72
    v_mul_f32 v53, v53, v79
    v_fmac_f32 v53, v20, v82
    v_mul_f32 v70, 0xbef00000, v10
    v_cos_f32 v79, v70
    v_sin_f32 v82, v70
    s_nop 0
    v_mul_f32 v20, v22, v79
    v_fma_f32 v20, -v55, v82, v20
    v_mul_f32 v55, v55, v79
    v_fmac_f32 v55, v22, v82
    v_mul_f32 v70, 0xbef80000, v10
    v_cos_f32 v79, v70
    v_sin_f32 v82, v70
    s_nop 0
    v_mul_f32 v22, v26, v79
    v_fma_f32 v22, -v59, v82, v22
    v_mul_f32 v59, v59, v79
    v_fmac_f32 v59, v26, v82
    s_nop 1
    v_mov_b32_dpp v70, v16 quad_perm:[1,0,3,2] row_mask:0xf bank_mask:0xf
    v_fma_f32 v16, v16, v9, v70
    v_mov_b32_dpp v70, v17 quad_perm:[1,0,3,2] row_mask:0xf bank_mask:0xf
    v_fma_f32 v17, v17, v9, v70
    v_mov_b32_dpp v70, v74 quad_perm:[1,0,3,2] row_mask:0xf bank_mask:0xf
    v_fma_f32 v74, v74, v9, v70
    v_mov_b32_dpp v70, v49 quad_perm:[1,0,3,2] row_mask:0xf bank_mask:0xf
    v_fma_f32 v49, v49, v9, v70
    v_mov_b32_dpp v70, v48 quad_perm:[1,0,3,2] row_mask:0xf bank_mask:0xf
    v_fma_f32 v48, v48, v9, v70
    v_mov_b32_dpp v70, v19 quad_perm:[1,0,3,2] row_mask:0xf bank_mask:0xf
    v_fma_f32 v19, v19, v9, v70
    v_mov_b32_dpp v70, v68 quad_perm:[1,0,3,2] row_mask:0xf bank_mask:0xf
    v_fma_f32 v68, v68, v9, v70
    v_mov_b32_dpp v70, v23 quad_perm:[1,0,3,2] row_mask:0xf bank_mask:0xf
    v_fma_f32 v23, v23, v9, v70
    v_mov_b32_dpp v70, v62 quad_perm:[1,0,3,2] row_mask:0xf bank_mask:0xf
    v_fma_f32 v62, v62, v9, v70
    v_mov_b32_dpp v70, v27 quad_perm:[1,0,3,2] row_mask:0xf bank_mask:0xf
    v_fma_f32 v27, v27, v9, v70
    v_mov_b32_dpp v70, v66 quad_perm:[1,0,3,2] row_mask:0xf bank_mask:0xf
    v_fma_f32 v66, v66, v9, v70
    v_mov_b32_dpp v70, v39 quad_perm:[1,0,3,2] row_mask:0xf bank_mask:0xf
    v_fma_f32 v39, v39, v9, v70
    v_mov_b32_dpp v70, v54 quad_perm:[1,0,3,2] row_mask:0xf bank_mask:0xf
    v_fma_f32 v54, v54, v9, v70
    v_mov_b32_dpp v70, v29 quad_perm:[1,0,3,2] row_mask:0xf bank_mask:0xf
    v_fma_f32 v29, v29, v9, v70
    v_mov_b32_dpp v70, v44 quad_perm:[1,0,3,2] row_mask:0xf bank_mask:0xf
    v_fma_f32 v44, v44, v9, v70
    v_mov_b32_dpp v70, v37 quad_perm:[1,0,3,2] row_mask:0xf bank_mask:0xf
    v_fma_f32 v37, v37, v9, v70
    v_mov_b32_dpp v70, v52 quad_perm:[1,0,3,2] row_mask:0xf bank_mask:0xf
    v_fma_f32 v52, v52, v9, v70
    v_mov_b32_dpp v70, v43 quad_perm:[1,0,3,2] row_mask:0xf bank_mask:0xf
    v_fma_f32 v43, v43, v9, v70
    v_mov_b32_dpp v70, v58 quad_perm:[1,0,3,2] row_mask:0xf bank_mask:0xf
    v_fma_f32 v58, v58, v9, v70
    v_mov_b32_dpp v70, v71 quad_perm:[1,0,3,2] row_mask:0xf bank_mask:0xf
    v_fma_f32 v71, v71, v9, v70
    v_mov_b32_dpp v70, v38 quad_perm:[1,0,3,2] row_mask:0xf bank_mask:0xf
    v_fma_f32 v38, v38, v9, v70
    v_mov_b32_dpp v70, v61 quad_perm:[1,0,3,2] row_mask:0xf bank_mask:0xf
    v_fma_f32 v61, v61, v9, v70
    v_mov_b32_dpp v70, v28 quad_perm:[1,0,3,2] row_mask:0xf bank_mask:0xf
    v_fma_f32 v28, v28, v9, v70
    v_mov_b32_dpp v70, v69 quad_perm:[1,0,3,2] row_mask:0xf bank_mask:0xf
    v_fma_f32 v69, v69, v9, v70
    v_mov_b32_dpp v70, v36 quad_perm:[1,0,3,2] row_mask:0xf bank_mask:0xf
    v_fma_f32 v36, v36, v9, v70
    v_mov_b32_dpp v70, v41 quad_perm:[1,0,3,2] row_mask:0xf bank_mask:0xf
    v_fma_f32 v41, v41, v9, v70
    v_mov_b32_dpp v70, v64 quad_perm:[1,0,3,2] row_mask:0xf bank_mask:0xf
    v_fma_f32 v64, v64, v9, v70
    v_mov_b32_dpp v70, v57 quad_perm:[1,0,3,2] row_mask:0xf bank_mask:0xf
    v_fma_f32 v57, v57, v9, v70
    v_mov_b32_dpp v70, v24 quad_perm:[1,0,3,2] row_mask:0xf bank_mask:0xf
    v_fma_f32 v24, v24, v9, v70
    v_mov_b32_dpp v70, v63 quad_perm:[1,0,3,2] row_mask:0xf bank_mask:0xf
    v_fma_f32 v63, v63, v9, v70
    v_mov_b32_dpp v70, v30 quad_perm:[1,0,3,2] row_mask:0xf bank_mask:0xf
    v_fma_f32 v30, v30, v9, v70
    v_mov_b32_dpp v70, v67 quad_perm:[1,0,3,2] row_mask:0xf bank_mask:0xf
    v_fma_f32 v67, v67, v9, v70
    v_mov_b32_dpp v70, v34 quad_perm:[1,0,3,2] row_mask:0xf bank_mask:0xf
    v_fma_f32 v34, v34, v9, v70
    v_mov_b32_dpp v70, v75 quad_perm:[1,0,3,2] row_mask:0xf bank_mask:0xf
    v_fma_f32 v75, v75, v9, v70
    v_mov_b32_dpp v70, v42 quad_perm:[1,0,3,2] row_mask:0xf bank_mask:0xf
    v_fma_f32 v42, v42, v9, v70
    v_mov_b32_dpp v70, v77 quad_perm:[1,0,3,2] row_mask:0xf bank_mask:0xf
    v_fma_f32 v77, v77, v9, v70
    v_mov_b32_dpp v70, v60 quad_perm:[1,0,3,2] row_mask:0xf bank_mask:0xf
    v_fma_f32 v60, v60, v9, v70
    v_mov_b32_dpp v70, v73 quad_perm:[1,0,3,2] row_mask:0xf bank_mask:0xf
    v_fma_f32 v73, v73, v9, v70
    v_mov_b32_dpp v70, v40 quad_perm:[1,0,3,2] row_mask:0xf bank_mask:0xf
    v_fma_f32 v40, v40, v9, v70
    v_mov_b32_dpp v70, v21 quad_perm:[1,0,3,2] row_mask:0xf bank_mask:0xf
    v_fma_f32 v21, v21, v9, v70
    v_mov_b32_dpp v70, v56 quad_perm:[1,0,3,2] row_mask:0xf bank_mask:0xf
    v_fma_f32 v56, v56, v9, v70
    v_mov_b32_dpp v70, v65 quad_perm:[1,0,3,2] row_mask:0xf bank_mask:0xf
    v_fma_f32 v65, v65, v9, v70
    v_mov_b32_dpp v70, v80 quad_perm:[1,0,3,2] row_mask:0xf bank_mask:0xf
    v_fma_f32 v80, v80, v9, v70
    v_mov_b32_dpp v70, v25 quad_perm:[1,0,3,2] row_mask:0xf bank_mask:0xf
    v_fma_f32 v25, v25, v9, v70
    v_mov_b32_dpp v70, v32 quad_perm:[1,0,3,2] row_mask:0xf bank_mask:0xf
    v_fma_f32 v32, v32, v9, v70
    v_mov_b32_dpp v70, v31 quad_perm:[1,0,3,2] row_mask:0xf bank_mask:0xf
    v_fma_f32 v31, v31, v9, v70
    v_mov_b32_dpp v70, v46 quad_perm:[1,0,3,2] row_mask:0xf bank_mask:0xf
    v_fma_f32 v46, v46, v9, v70
    v_mov_b32_dpp v70, v35 quad_perm:[1,0,3,2] row_mask:0xf bank_mask:0xf
    v_fma_f32 v35, v35, v9, v70
    v_mov_b32_dpp v70, v50 quad_perm:[1,0,3,2] row_mask:0xf bank_mask:0xf
    v_fma_f32 v50, v50, v9, v70
    v_mov_b32_dpp v70, v81 quad_perm:[1,0,3,2] row_mask:0xf bank_mask:0xf
    v_fma_f32 v81, v81, v9, v70
    v_mov_b32_dpp v70, v83 quad_perm:[1,0,3,2] row_mask:0xf bank_mask:0xf
    v_fma_f32 v83, v83, v9, v70
    v_mov_b32_dpp v70, v33 quad_perm:[1,0,3,2] row_mask:0xf bank_mask:0xf
    v_fma_f32 v33, v33, v9, v70
    v_mov_b32_dpp v70, v78 quad_perm:[1,0,3,2] row_mask:0xf bank_mask:0xf
    v_fma_f32 v78, v78, v9, v70
    v_mov_b32_dpp v70, v47 quad_perm:[1,0,3,2] row_mask:0xf bank_mask:0xf
    v_fma_f32 v47, v47, v9, v70
    v_mov_b32_dpp v70, v76 quad_perm:[1,0,3,2] row_mask:0xf bank_mask:0xf
    v_fma_f32 v76, v76, v9, v70
    v_mov_b32_dpp v70, v51 quad_perm:[1,0,3,2] row_mask:0xf bank_mask:0xf
    v_fma_f32 v51, v51, v9, v70
    v_mov_b32_dpp v70, v18 quad_perm:[1,0,3,2] row_mask:0xf bank_mask:0xf
    v_fma_f32 v18, v18, v9, v70
    v_mov_b32_dpp v70, v45 quad_perm:[1,0,3,2] row_mask:0xf bank_mask:0xf
    v_fma_f32 v45, v45, v9, v70
    v_mov_b32_dpp v70, v72 quad_perm:[1,0,3,2] row_mask:0xf bank_mask:0xf
    v_fma_f32 v72, v72, v9, v70
    v_mov_b32_dpp v70, v53 quad_perm:[1,0,3,2] row_mask:0xf bank_mask:0xf
    v_fma_f32 v53, v53, v9, v70
    v_mov_b32_dpp v70, v20 quad_perm:[1,0,3,2] row_mask:0xf bank_mask:0xf
    v_fma_f32 v20, v20, v9, v70
    v_mov_b32_dpp v70, v55 quad_perm:[1,0,3,2] row_mask:0xf bank_mask:0xf
    v_fma_f32 v55, v55, v9, v70
    v_mov_b32_dpp v70, v22 quad_perm:[1,0,3,2] row_mask:0xf bank_mask:0xf
    v_fma_f32 v22, v22, v9, v70
    v_mov_b32_dpp v70, v59 quad_perm:[1,0,3,2] row_mask:0xf bank_mask:0xf
    v_fma_f32 v59, v59, v9, v70
    s_waitcnt vmcnt(0)
    s_mov_b32 s20, 0x34800000
    v_lshlrev_b32 v70, 16, v88
    v_and_b32 v79, 0xffff0000, v88
    v_mul_f32 v70, s20, v70
    v_mul_f32 v79, s20, v79
    v_mul_f32 v82, v16, v70
    v_fma_f32 v82, -v17, v79, v82
    v_mul_f32 v17, v17, v70
    v_fmac_f32 v17, v16, v79
    v_lshlrev_b32 v70, 16, v89
    v_and_b32 v79, 0xffff0000, v89
    v_mul_f32 v70, s20, v70
    v_mul_f32 v79, s20, v79
    v_mul_f32 v16, v74, v70
    v_fma_f32 v16, -v49, v79, v16
    v_mul_f32 v49, v49, v70
    v_fmac_f32 v49, v74, v79
    v_lshlrev_b32 v70, 16, v90
    v_and_b32 v79, 0xffff0000, v90
    v_mul_f32 v70, s20, v70
    v_mul_f32 v79, s20, v79
    v_mul_f32 v74, v48, v70
    v_fma_f32 v74, -v19, v79, v74
    v_mul_f32 v19, v19, v70
    v_fmac_f32 v19, v48, v79
    v_lshlrev_b32 v70, 16, v91
    v_and_b32 v79, 0xffff0000, v91
    v_mul_f32 v70, s20, v70
    v_mul_f32 v79, s20, v79
    v_mul_f32 v48, v68, v70
    v_fma_f32 v48, -v23, v79, v48
    v_mul_f32 v23, v23, v70
    v_fmac_f32 v23, v68, v79
    v_lshlrev_b32 v70, 16, v92
    v_and_b32 v79, 0xffff0000, v92
    v_mul_f32 v70, s20, v70
    v_mul_f32 v79, s20, v79
    v_mul_f32 v68, v62, v70
    v_fma_f32 v68, -v27, v79, v68
    v_mul_f32 v27, v27, v70
    v_fmac_f32 v27, v62, v79
    v_lshlrev_b32 v70, 16, v93
    v_and_b32 v79, 0xffff0000, v93
    v_mul_f32 v70, s20, v70
    v_mul_f32 v79, s20, v79
    v_mul_f32 v62, v66, v70
    v_fma_f32 v62, -v39, v79, v62
    v_mul_f32 v39, v39, v70
    v_fmac_f32 v39, v66, v79
    v_lshlrev_b32 v70, 16, v94
    v_and_b32 v79, 0xffff0000, v94
    v_mul_f32 v70, s20, v70
    v_mul_f32 v79, s20, v79
    v_mul_f32 v66, v54, v70
    v_fma_f32 v66, -v29, v79, v66
    v_mul_f32 v29, v29, v70
    v_fmac_f32 v29, v54, v79
    v_lshlrev_b32 v70, 16, v95
    v_and_b32 v79, 0xffff0000, v95
    v_mul_f32 v70, s20, v70
    v_mul_f32 v79, s20, v79
    v_mul_f32 v54, v44, v70
    v_fma_f32 v54, -v37, v79, v54
    v_mul_f32 v37, v37, v70
    v_fmac_f32 v37, v44, v79
    v_lshlrev_b32 v70, 16, v96
    v_and_b32 v79, 0xffff0000, v96
    v_mul_f32 v70, s20, v70
    v_mul_f32 v79, s20, v79
    v_mul_f32 v44, v52, v70
    v_fma_f32 v44, -v43, v79, v44
    v_mul_f32 v43, v43, v70
    v_fmac_f32 v43, v52, v79
    v_lshlrev_b32 v70, 16, v97
    v_and_b32 v79, 0xffff0000, v97
    v_mul_f32 v70, s20, v70
    v_mul_f32 v79, s20, v79
    v_mul_f32 v52, v58, v70
    v_fma_f32 v52, -v71, v79, v52
    v_mul_f32 v71, v71, v70
    v_fmac_f32 v71, v58, v79
    v_lshlrev_b32 v70, 16, v98
    v_and_b32 v79, 0xffff0000, v98
    v_mul_f32 v70, s20, v70
    v_mul_f32 v79, s20, v79
    v_mul_f32 v58, v38, v70
    v_fma_f32 v58, -v61, v79, v58
    v_mul_f32 v61, v61, v70
    v_fmac_f32 v61, v38, v79
    v_lshlrev_b32 v70, 16, v99
    v_and_b32 v79, 0xffff0000, v99
    v_mul_f32 v70, s20, v70
    v_mul_f32 v79, s20, v79
    v_mul_f32 v38, v28, v70
    v_fma_f32 v38, -v69, v79, v38
    v_mul_f32 v69, v69, v70
    v_fmac_f32 v69, v28, v79
    v_lshlrev_b32 v70, 16, v100
    v_and_b32 v79, 0xffff0000, v100
    v_mul_f32 v70, s20, v70
    v_mul_f32 v79, s20, v79
    v_mul_f32 v28, v36, v70
    v_fma_f32 v28, -v41, v79, v28
    v_mul_f32 v41, v41, v70
    v_fmac_f32 v41, v36, v79
    v_lshlrev_b32 v70, 16, v101
    v_and_b32 v79, 0xffff0000, v101
    v_mul_f32 v70, s20, v70
    v_mul_f32 v79, s20, v79
    v_mul_f32 v36, v64, v70
    v_fma_f32 v36, -v57, v79, v36
    v_mul_f32 v57, v57, v70
    v_fmac_f32 v57, v64, v79
    v_lshlrev_b32 v70, 16, v102
    v_and_b32 v79, 0xffff0000, v102
    v_mul_f32 v70, s20, v70
    v_mul_f32 v79, s20, v79
    v_mul_f32 v64, v24, v70
    v_fma_f32 v64, -v63, v79, v64
    v_mul_f32 v63, v63, v70
    v_fmac_f32 v63, v24, v79
    v_lshlrev_b32 v70, 16, v103
    v_and_b32 v79, 0xffff0000, v103
    v_mul_f32 v70, s20, v70
    v_mul_f32 v79, s20, v79
    v_mul_f32 v24, v30, v70
    v_fma_f32 v24, -v67, v79, v24
    v_mul_f32 v67, v67, v70
    v_fmac_f32 v67, v30, v79
    v_lshlrev_b32 v70, 16, v104
    v_and_b32 v79, 0xffff0000, v104
    v_mul_f32 v70, s20, v70
    v_mul_f32 v79, s20, v79
    v_mul_f32 v30, v34, v70
    v_fma_f32 v30, -v75, v79, v30
    v_mul_f32 v75, v75, v70
    v_fmac_f32 v75, v34, v79
    v_lshlrev_b32 v70, 16, v105
    v_and_b32 v79, 0xffff0000, v105
    v_mul_f32 v70, s20, v70
    v_mul_f32 v79, s20, v79
    v_mul_f32 v34, v42, v70
    v_fma_f32 v34, -v77, v79, v34
    v_mul_f32 v77, v77, v70
    v_fmac_f32 v77, v42, v79
    v_lshlrev_b32 v70, 16, v106
    v_and_b32 v79, 0xffff0000, v106
    v_mul_f32 v70, s20, v70
    v_mul_f32 v79, s20, v79
    v_mul_f32 v42, v60, v70
    v_fma_f32 v42, -v73, v79, v42
    v_mul_f32 v73, v73, v70
    v_fmac_f32 v73, v60, v79
    v_lshlrev_b32 v70, 16, v107
    v_and_b32 v79, 0xffff0000, v107
    v_mul_f32 v70, s20, v70
    v_mul_f32 v79, s20, v79
    v_mul_f32 v60, v40, v70
    v_fma_f32 v60, -v21, v79, v60
    v_mul_f32 v21, v21, v70
    v_fmac_f32 v21, v40, v79
    v_lshlrev_b32 v70, 16, v108
    v_and_b32 v79, 0xffff0000, v108
    v_mul_f32 v70, s20, v70
    v_mul_f32 v79, s20, v79
    v_mul_f32 v40, v56, v70
    v_fma_f32 v40, -v65, v79, v40
    v_mul_f32 v65, v65, v70
    v_fmac_f32 v65, v56, v79
    v_lshlrev_b32 v70, 16, v109
    v_and_b32 v79, 0xffff0000, v109
    v_mul_f32 v70, s20, v70
    v_mul_f32 v79, s20, v79
    v_mul_f32 v56, v80, v70
    v_fma_f32 v56, -v25, v79, v56
    v_mul_f32 v25, v25, v70
    v_fmac_f32 v25, v80, v79
    v_lshlrev_b32 v70, 16, v110
    v_and_b32 v79, 0xffff0000, v110
    v_mul_f32 v70, s20, v70
    v_mul_f32 v79, s20, v79
    v_mul_f32 v80, v32, v70
    v_fma_f32 v80, -v31, v79, v80
    v_mul_f32 v31, v31, v70
    v_fmac_f32 v31, v32, v79
    v_lshlrev_b32 v70, 16, v111
    v_and_b32 v79, 0xffff0000, v111
    v_mul_f32 v70, s20, v70
    v_mul_f32 v79, s20, v79
    v_mul_f32 v32, v46, v70
    v_fma_f32 v32, -v35, v79, v32
    v_mul_f32 v35, v35, v70
    v_fmac_f32 v35, v46, v79
    v_lshlrev_b32 v70, 16, v112
    v_and_b32 v79, 0xffff0000, v112
    v_mul_f32 v70, s20, v70
    v_mul_f32 v79, s20, v79
    v_mul_f32 v46, v50, v70
    v_fma_f32 v46, -v81, v79, v46
    v_mul_f32 v81, v81, v70
    v_fmac_f32 v81, v50, v79
    v_lshlrev_b32 v70, 16, v113
    v_and_b32 v79, 0xffff0000, v113
    v_mul_f32 v70, s20, v70
    v_mul_f32 v79, s20, v79
    v_mul_f32 v50, v83, v70
    v_fma_f32 v50, -v33, v79, v50
    v_mul_f32 v33, v33, v70
    v_fmac_f32 v33, v83, v79
    v_lshlrev_b32 v70, 16, v114
    v_and_b32 v79, 0xffff0000, v114
    v_mul_f32 v70, s20, v70
    v_mul_f32 v79, s20, v79
    v_mul_f32 v83, v78, v70
    v_fma_f32 v83, -v47, v79, v83
    v_mul_f32 v47, v47, v70
    v_fmac_f32 v47, v78, v79
    v_lshlrev_b32 v70, 16, v115
    v_and_b32 v79, 0xffff0000, v115
    v_mul_f32 v70, s20, v70
    v_mul_f32 v79, s20, v79
    v_mul_f32 v78, v76, v70
    v_fma_f32 v78, -v51, v79, v78
    v_mul_f32 v51, v51, v70
    v_fmac_f32 v51, v76, v79
    v_lshlrev_b32 v70, 16, v116
    v_and_b32 v79, 0xffff0000, v116
    v_mul_f32 v70, s20, v70
    v_mul_f32 v79, s20, v79
    v_mul_f32 v76, v18, v70
    v_fma_f32 v76, -v45, v79, v76
    v_mul_f32 v45, v45, v70
    v_fmac_f32 v45, v18, v79
    v_lshlrev_b32 v70, 16, v117
    v_and_b32 v79, 0xffff0000, v117
    v_mul_f32 v70, s20, v70
    v_mul_f32 v79, s20, v79
    v_mul_f32 v18, v72, v70
    v_fma_f32 v18, -v53, v79, v18
    v_mul_f32 v53, v53, v70
    v_fmac_f32 v53, v72, v79
    v_lshlrev_b32 v70, 16, v118
    v_and_b32 v79, 0xffff0000, v118
    v_mul_f32 v70, s20, v70
    v_mul_f32 v79, s20, v79
    v_mul_f32 v72, v20, v70
    v_fma_f32 v72, -v55, v79, v72
    v_mul_f32 v55, v55, v70
    v_fmac_f32 v55, v20, v79
    v_lshlrev_b32 v70, 16, v119
    v_and_b32 v79, 0xffff0000, v119
    v_mul_f32 v70, s20, v70
    v_mul_f32 v79, s20, v79
    v_mul_f32 v20, v22, v70
    v_fma_f32 v20, -v59, v79, v20
    v_mul_f32 v59, v59, v70
    v_fmac_f32 v59, v22, v79
    s_waitcnt vmcnt(0)
    ds_read_b64_tr_b16 a[64:65], v201 offset:0
    ds_read_b64_tr_b16 a[66:67], v201 offset:256
    ds_read_b64_tr_b16 a[68:69], v201 offset:1024
    ds_read_b64_tr_b16 a[70:71], v201 offset:1280
    ds_read_b64_tr_b16 a[72:73], v201 offset:2048
    ds_read_b64_tr_b16 a[74:75], v201 offset:2304
    ds_read_b64_tr_b16 a[76:77], v201 offset:3072
    ds_read_b64_tr_b16 a[78:79], v201 offset:3328
    s_waitcnt lgkmcnt(0)
    ds_read_b64_tr_b16 a[80:81], v201 offset:4096
    ds_read_b64_tr_b16 a[82:83], v201 offset:4352
    ds_read_b64_tr_b16 a[84:85], v201 offset:5120
    ds_read_b64_tr_b16 a[86:87], v201 offset:5376
    ds_read_b64_tr_b16 a[88:89], v201 offset:6144
    ds_read_b64_tr_b16 a[90:91], v201 offset:6400
    ds_read_b64_tr_b16 a[92:93], v201 offset:7168
    ds_read_b64_tr_b16 a[94:95], v201 offset:7424
    s_waitcnt lgkmcnt(0)
    ds_read_b64_tr_b16 a[96:97], v201 offset:8192
    ds_read_b64_tr_b16 a[98:99], v201 offset:8448
    ds_read_b64_tr_b16 a[100:101], v201 offset:9216
    ds_read_b64_tr_b16 a[102:103], v201 offset:9472
    ds_read_b64_tr_b16 a[104:105], v201 offset:10240
    ds_read_b64_tr_b16 a[106:107], v201 offset:10496
    ds_read_b64_tr_b16 a[108:109], v201 offset:11264
    ds_read_b64_tr_b16 a[110:111], v201 offset:11520
    s_waitcnt lgkmcnt(0)
    ds_read_b64_tr_b16 a[112:113], v201 offset:12288
    ds_read_b64_tr_b16 a[114:115], v201 offset:12544
    ds_read_b64_tr_b16 a[116:117], v201 offset:13312
    ds_read_b64_tr_b16 a[118:119], v201 offset:13568
    ds_read_b64_tr_b16 a[120:121], v201 offset:14336
    ds_read_b64_tr_b16 a[122:123], v201 offset:14592
    ds_read_b64_tr_b16 a[124:125], v201 offset:15360
    ds_read_b64_tr_b16 a[126:127], v201 offset:15616
    s_waitcnt lgkmcnt(0)
    s_add_u32 m0, s56, 0
    s_add_u32 s58, s57, 32768
    s_and_b32 s58, s58, 0xffff
    s_lshl_b32 s58, s58, 5
    buffer_load_dwordx4 v200, s[52:55], s58 offen lds
    s_add_u32 m0, s56, 1024
    s_add_u32 s58, s57, 33792
    s_and_b32 s58, s58, 0xffff
    s_lshl_b32 s58, s58, 5
    buffer_load_dwordx4 v200, s[52:55], s58 offen lds
    s_add_u32 m0, s56, 2048
    s_add_u32 s58, s57, 34816
    s_and_b32 s58, s58, 0xffff
    s_lshl_b32 s58, s58, 5
    buffer_load_dwordx4 v200, s[52:55], s58 offen lds
    s_add_u32 m0, s56, 3072
    s_add_u32 s58, s57, 35840
    s_and_b32 s58, s58, 0xffff
    s_lshl_b32 s58, s58, 5
    buffer_load_dwordx4 v200, s[52:55], s58 offen lds
    s_add_u32 m0, s56, 4096
    s_add_u32 s58, s57, 36864
    s_and_b32 s58, s58, 0xffff
    s_lshl_b32 s58, s58, 5
    buffer_load_dwordx4 v200, s[52:55], s58 offen lds
    s_add_u32 m0, s56, 5120
    s_add_u32 s58, s57, 37888
    s_and_b32 s58, s58, 0xffff
    s_lshl_b32 s58, s58, 5
    buffer_load_dwordx4 v200, s[52:55], s58 offen lds
    s_add_u32 m0, s56, 6144
    s_add_u32 s58, s57, 38912
    s_and_b32 s58, s58, 0xffff
    s_lshl_b32 s58, s58, 5
    buffer_load_dwordx4 v200, s[52:55], s58 offen lds
    s_add_u32 m0, s56, 7168
    s_add_u32 s58, s57, 39936
    s_and_b32 s58, s58, 0xffff
    s_lshl_b32 s58, s58, 5
    buffer_load_dwordx4 v200, s[52:55], s58 offen lds
    s_add_u32 m0, s56, 8192
    s_add_u32 s58, s57, 40960
    s_and_b32 s58, s58, 0xffff
    s_lshl_b32 s58, s58, 5
    buffer_load_dwordx4 v200, s[52:55], s58 offen lds
    s_add_u32 m0, s56, 9216
    s_add_u32 s58, s57, 41984
    s_and_b32 s58, s58, 0xffff
    s_lshl_b32 s58, s58, 5
    buffer_load_dwordx4 v200, s[52:55], s58 offen lds
    s_add_u32 m0, s56, 10240
    s_add_u32 s58, s57, 43008
    s_and_b32 s58, s58, 0xffff
    s_lshl_b32 s58, s58, 5
    buffer_load_dwordx4 v200, s[52:55], s58 offen lds
    s_add_u32 m0, s56, 11264
    s_add_u32 s58, s57, 44032
    s_and_b32 s58, s58, 0xffff
    s_lshl_b32 s58, s58, 5
    buffer_load_dwordx4 v200, s[52:55], s58 offen lds
    s_add_u32 m0, s56, 12288
    s_add_u32 s58, s57, 45056
    s_and_b32 s58, s58, 0xffff
    s_lshl_b32 s58, s58, 5
    buffer_load_dwordx4 v200, s[52:55], s58 offen lds
    s_add_u32 m0, s56, 13312
    s_add_u32 s58, s57, 46080
    s_and_b32 s58, s58, 0xffff
    s_lshl_b32 s58, s58, 5
    buffer_load_dwordx4 v200, s[52:55], s58 offen lds
    s_add_u32 m0, s56, 14336
    s_add_u32 s58, s57, 47104
    s_and_b32 s58, s58, 0xffff
    s_lshl_b32 s58, s58, 5
    buffer_load_dwordx4 v200, s[52:55], s58 offen lds
    s_add_u32 m0, s56, 15360
    s_add_u32 s58, s57, 48128
    s_and_b32 s58, s58, 0xffff
    s_lshl_b32 s58, s58, 5
    buffer_load_dwordx4 v200, s[52:55], s58 offen lds
    s_nop 1
    v_mov_b32_dpp v70, v82 quad_perm:[1,0,3,2] row_mask:0xf bank_mask:0xf
    v_fma_f32 v82, v82, v9, v70
    v_mov_b32_dpp v70, v17 quad_perm:[1,0,3,2] row_mask:0xf bank_mask:0xf
    v_fma_f32 v17, v17, v9, v70
    v_mov_b32_dpp v70, v16 quad_perm:[1,0,3,2] row_mask:0xf bank_mask:0xf
    v_fma_f32 v16, v16, v9, v70
    v_mov_b32_dpp v70, v49 quad_perm:[1,0,3,2] row_mask:0xf bank_mask:0xf
    v_fma_f32 v49, v49, v9, v70
    v_mov_b32_dpp v70, v74 quad_perm:[1,0,3,2] row_mask:0xf bank_mask:0xf
    v_fma_f32 v74, v74, v9, v70
    v_mov_b32_dpp v70, v19 quad_perm:[1,0,3,2] row_mask:0xf bank_mask:0xf
    v_fma_f32 v19, v19, v9, v70
    v_mov_b32_dpp v70, v48 quad_perm:[1,0,3,2] row_mask:0xf bank_mask:0xf
    v_fma_f32 v48, v48, v9, v70
    v_mov_b32_dpp v70, v23 quad_perm:[1,0,3,2] row_mask:0xf bank_mask:0xf
    v_fma_f32 v23, v23, v9, v70
    v_mov_b32_dpp v70, v68 quad_perm:[1,0,3,2] row_mask:0xf bank_mask:0xf
    v_fma_f32 v68, v68, v9, v70
    v_mov_b32_dpp v70, v27 quad_perm:[1,0,3,2] row_mask:0xf bank_mask:0xf
    v_fma_f32 v27, v27, v9, v70
    v_mov_b32_dpp v70, v62 quad_perm:[1,0,3,2] row_mask:0xf bank_mask:0xf
    v_fma_f32 v62, v62, v9, v70
    v_mov_b32_dpp v70, v39 quad_perm:[1,0,3,2] row_mask:0xf bank_mask:0xf
    v_fma_f32 v39, v39, v9, v70
    v_mov_b32_dpp v70, v66 quad_perm:[1,0,3,2] row_mask:0xf bank_mask:0xf
    v_fma_f32 v66, v66, v9, v70
    v_mov_b32_dpp v70, v29 quad_perm:[1,0,3,2] row_mask:0xf bank_mask:0xf
    v_fma_f32 v29, v29, v9, v70
    v_mov_b32_dpp v70, v54 quad_perm:[1,0,3,2] row_mask:0xf bank_mask:0xf
    v_fma_f32 v54, v54, v9, v70
    v_mov_b32_dpp v70, v37 quad_perm:[1,0,3,2] row_mask:0xf bank_mask:0xf
    v_fma_f32 v37, v37, v9, v70
    v_mov_b32_dpp v70, v44 quad_perm:[1,0,3,2] row_mask:0xf bank_mask:0xf
    v_fma_f32 v44, v44, v9, v70
    v_mov_b32_dpp v70, v43 quad_perm:[1,0,3,2] row_mask:0xf bank_mask:0xf
    v_fma_f32 v43, v43, v9, v70
    v_mov_b32_dpp v70, v52 quad_perm:[1,0,3,2] row_mask:0xf bank_mask:0xf
    v_fma_f32 v52, v52, v9, v70
    v_mov_b32_dpp v70, v71 quad_perm:[1,0,3,2] row_mask:0xf bank_mask:0xf
    v_fma_f32 v71, v71, v9, v70
    v_mov_b32_dpp v70, v58 quad_perm:[1,0,3,2] row_mask:0xf bank_mask:0xf
    v_fma_f32 v58, v58, v9, v70
    v_mov_b32_dpp v70, v61 quad_perm:[1,0,3,2] row_mask:0xf bank_mask:0xf
    v_fma_f32 v61, v61, v9, v70
    v_mov_b32_dpp v70, v38 quad_perm:[1,0,3,2] row_mask:0xf bank_mask:0xf
    v_fma_f32 v38, v38, v9, v70
    v_mov_b32_dpp v70, v69 quad_perm:[1,0,3,2] row_mask:0xf bank_mask:0xf
    v_fma_f32 v69, v69, v9, v70
    v_mov_b32_dpp v70, v28 quad_perm:[1,0,3,2] row_mask:0xf bank_mask:0xf
    v_fma_f32 v28, v28, v9, v70
    v_mov_b32_dpp v70, v41 quad_perm:[1,0,3,2] row_mask:0xf bank_mask:0xf
    v_fma_f32 v41, v41, v9, v70
    v_mov_b32_dpp v70, v36 quad_perm:[1,0,3,2] row_mask:0xf bank_mask:0xf
    v_fma_f32 v36, v36, v9, v70
    v_mov_b32_dpp v70, v57 quad_perm:[1,0,3,2] row_mask:0xf bank_mask:0xf
    v_fma_f32 v57, v57, v9, v70
    v_mov_b32_dpp v70, v64 quad_perm:[1,0,3,2] row_mask:0xf bank_mask:0xf
    v_fma_f32 v64, v64, v9, v70
    v_mov_b32_dpp v70, v63 quad_perm:[1,0,3,2] row_mask:0xf bank_mask:0xf
    v_fma_f32 v63, v63, v9, v70
    v_mov_b32_dpp v70, v24 quad_perm:[1,0,3,2] row_mask:0xf bank_mask:0xf
    v_fma_f32 v24, v24, v9, v70
    v_mov_b32_dpp v70, v67 quad_perm:[1,0,3,2] row_mask:0xf bank_mask:0xf
    v_fma_f32 v67, v67, v9, v70
    v_mov_b32_dpp v70, v30 quad_perm:[1,0,3,2] row_mask:0xf bank_mask:0xf
    v_fma_f32 v30, v30, v9, v70
    v_mov_b32_dpp v70, v75 quad_perm:[1,0,3,2] row_mask:0xf bank_mask:0xf
    v_fma_f32 v75, v75, v9, v70
    v_mov_b32_dpp v70, v34 quad_perm:[1,0,3,2] row_mask:0xf bank_mask:0xf
    v_fma_f32 v34, v34, v9, v70
    v_mov_b32_dpp v70, v77 quad_perm:[1,0,3,2] row_mask:0xf bank_mask:0xf
    v_fma_f32 v77, v77, v9, v70
    v_mov_b32_dpp v70, v42 quad_perm:[1,0,3,2] row_mask:0xf bank_mask:0xf
    v_fma_f32 v42, v42, v9, v70
    v_mov_b32_dpp v70, v73 quad_perm:[1,0,3,2] row_mask:0xf bank_mask:0xf
    v_fma_f32 v73, v73, v9, v70
    v_mov_b32_dpp v70, v60 quad_perm:[1,0,3,2] row_mask:0xf bank_mask:0xf
    v_fma_f32 v60, v60, v9, v70
    v_mov_b32_dpp v70, v21 quad_perm:[1,0,3,2] row_mask:0xf bank_mask:0xf
    v_fma_f32 v21, v21, v9, v70
    v_mov_b32_dpp v70, v40 quad_perm:[1,0,3,2] row_mask:0xf bank_mask:0xf
    v_fma_f32 v40, v40, v9, v70
    v_mov_b32_dpp v70, v65 quad_perm:[1,0,3,2] row_mask:0xf bank_mask:0xf
    v_fma_f32 v65, v65, v9, v70
    v_mov_b32_dpp v70, v56 quad_perm:[1,0,3,2] row_mask:0xf bank_mask:0xf
    v_fma_f32 v56, v56, v9, v70
    v_mov_b32_dpp v70, v25 quad_perm:[1,0,3,2] row_mask:0xf bank_mask:0xf
    v_fma_f32 v25, v25, v9, v70
    v_mov_b32_dpp v70, v80 quad_perm:[1,0,3,2] row_mask:0xf bank_mask:0xf
    v_fma_f32 v80, v80, v9, v70
    v_mov_b32_dpp v70, v31 quad_perm:[1,0,3,2] row_mask:0xf bank_mask:0xf
    v_fma_f32 v31, v31, v9, v70
    v_mov_b32_dpp v70, v32 quad_perm:[1,0,3,2] row_mask:0xf bank_mask:0xf
    v_fma_f32 v32, v32, v9, v70
    v_mov_b32_dpp v70, v35 quad_perm:[1,0,3,2] row_mask:0xf bank_mask:0xf
    v_fma_f32 v35, v35, v9, v70
    v_mov_b32_dpp v70, v46 quad_perm:[1,0,3,2] row_mask:0xf bank_mask:0xf
    v_fma_f32 v46, v46, v9, v70
    v_mov_b32_dpp v70, v81 quad_perm:[1,0,3,2] row_mask:0xf bank_mask:0xf
    v_fma_f32 v81, v81, v9, v70
    v_mov_b32_dpp v70, v50 quad_perm:[1,0,3,2] row_mask:0xf bank_mask:0xf
    v_fma_f32 v50, v50, v9, v70
    v_mov_b32_dpp v70, v33 quad_perm:[1,0,3,2] row_mask:0xf bank_mask:0xf
    v_fma_f32 v33, v33, v9, v70
    v_mov_b32_dpp v70, v83 quad_perm:[1,0,3,2] row_mask:0xf bank_mask:0xf
    v_fma_f32 v83, v83, v9, v70
    v_mov_b32_dpp v70, v47 quad_perm:[1,0,3,2] row_mask:0xf bank_mask:0xf
    v_fma_f32 v47, v47, v9, v70
    v_mov_b32_dpp v70, v78 quad_perm:[1,0,3,2] row_mask:0xf bank_mask:0xf
    v_fma_f32 v78, v78, v9, v70
    v_mov_b32_dpp v70, v51 quad_perm:[1,0,3,2] row_mask:0xf bank_mask:0xf
    v_fma_f32 v51, v51, v9, v70
    v_mov_b32_dpp v70, v76 quad_perm:[1,0,3,2] row_mask:0xf bank_mask:0xf
    v_fma_f32 v76, v76, v9, v70
    v_mov_b32_dpp v70, v45 quad_perm:[1,0,3,2] row_mask:0xf bank_mask:0xf
    v_fma_f32 v45, v45, v9, v70
    v_mov_b32_dpp v70, v18 quad_perm:[1,0,3,2] row_mask:0xf bank_mask:0xf
    v_fma_f32 v18, v18, v9, v70
    v_mov_b32_dpp v70, v53 quad_perm:[1,0,3,2] row_mask:0xf bank_mask:0xf
    v_fma_f32 v53, v53, v9, v70
    v_mov_b32_dpp v70, v72 quad_perm:[1,0,3,2] row_mask:0xf bank_mask:0xf
    v_fma_f32 v72, v72, v9, v70
    v_mov_b32_dpp v70, v55 quad_perm:[1,0,3,2] row_mask:0xf bank_mask:0xf
    v_fma_f32 v55, v55, v9, v70
    v_mov_b32_dpp v70, v20 quad_perm:[1,0,3,2] row_mask:0xf bank_mask:0xf
    v_fma_f32 v20, v20, v9, v70
    v_mov_b32_dpp v70, v59 quad_perm:[1,0,3,2] row_mask:0xf bank_mask:0xf
    v_fma_f32 v59, v59, v9, v70
    v_mul_f32 v70, 0x3c800000, v10
    v_cos_f32 v79, v70
    v_sin_f32 v22, v70
    s_nop 0
    v_mul_f32 v26, v16, v79
    v_fma_f32 v26, -v49, v22, v26
    v_mul_f32 v49, v49, v79
    v_fmac_f32 v49, v16, v22
    v_mul_f32 v70, 0x3d000000, v10
    v_cos_f32 v79, v70
    v_sin_f32 v22, v70
    s_nop 0
    v_mul_f32 v16, v74, v79
    v_fma_f32 v16, -v19, v22, v16
    v_mul_f32 v19, v19, v79
    v_fmac_f32 v19, v74, v22
    v_mul_f32 v70, 0x3d400000, v10
    v_cos_f32 v79, v70
    v_sin_f32 v22, v70
    s_nop 0
    v_mul_f32 v74, v48, v79
    v_fma_f32 v74, -v23, v22, v74
    v_mul_f32 v23, v23, v79
    v_fmac_f32 v23, v48, v22
    v_mul_f32 v70, 0x3d800000, v10
    v_cos_f32 v79, v70
    v_sin_f32 v22, v70
    s_nop 0
    v_mul_f32 v48, v68, v79
    v_fma_f32 v48, -v27, v22, v48
    v_mul_f32 v27, v27, v79
    v_fmac_f32 v27, v68, v22
    v_mul_f32 v70, 0x3da00000, v10
    v_cos_f32 v79, v70
    v_sin_f32 v22, v70
    s_nop 0
    v_mul_f32 v68, v62, v79
    v_fma_f32 v68, -v39, v22, v68
    v_mul_f32 v39, v39, v79
    v_fmac_f32 v39, v62, v22
    v_mul_f32 v70, 0x3dc00000, v10
    v_cos_f32 v79, v70
    v_sin_f32 v22, v70
    s_nop 0
    v_mul_f32 v62, v66, v79
    v_fma_f32 v62, -v29, v22, v62
    v_mul_f32 v29, v29, v79
    v_fmac_f32 v29, v66, v22
    v_mul_f32 v70, 0x3de00000, v10
    v_cos_f32 v79, v70
    v_sin_f32 v22, v70
    s_nop 0
    v_mul_f32 v66, v54, v79
    v_fma_f32 v66, -v37, v22, v66
    v_mul_f32 v37, v37, v79
    v_fmac_f32 v37, v54, v22
    v_mul_f32 v70, 0x3e000000, v10
    v_cos_f32 v79, v70
    v_sin_f32 v22, v70
    s_nop 0
    v_mul_f32 v54, v44, v79
    v_fma_f32 v54, -v43, v22, v54
    v_mul_f32 v43, v43, v79
    v_fmac_f32 v43, v44, v22
    v_mul_f32 v70, 0x3e100000, v10
    v_cos_f32 v79, v70
    v_sin_f32 v22, v70
    s_nop 0
    v_mul_f32 v44, v52, v79
    v_fma_f32 v44, -v71, v22, v44
    v_mul_f32 v71, v71, v79
    v_fmac_f32 v71, v52, v22
    v_mul_f32 v70, 0x3e200000, v10
    v_cos_f32 v79, v70
    v_sin_f32 v22, v70
    s_nop 0
    v_mul_f32 v52, v58, v79
    v_fma_f32 v52, -v61, v22, v52
    v_mul_f32 v61, v61, v79
    v_fmac_f32 v61, v58, v22
    v_mul_f32 v70, 0x3e300000, v10
    v_cos_f32 v79, v70
    v_sin_f32 v22, v70
    s_nop 0
    v_mul_f32 v58, v38, v79
    v_fma_f32 v58, -v69, v22, v58
    v_mul_f32 v69, v69, v79
    v_fmac_f32 v69, v38, v22
    v_mul_f32 v70, 0x3e400000, v10
    v_cos_f32 v79, v70
    v_sin_f32 v22, v70
    s_nop 0
    v_mul_f32 v38, v28, v79
    v_fma_f32 v38, -v41, v22, v38
    v_mul_f32 v41, v41, v79
    v_fmac_f32 v41, v28, v22
    v_mul_f32 v70, 0x3e500000, v10
    v_cos_f32 v79, v70
    v_sin_f32 v22, v70
    s_nop 0
    v_mul_f32 v28, v36, v79
    v_fma_f32 v28, -v57, v22, v28
    v_mul_f32 v57, v57, v79
    v_fmac_f32 v57, v36, v22
    v_mul_f32 v70, 0x3e600000, v10
    v_cos_f32 v79, v70
    v_sin_f32 v22, v70
    s_nop 0
    v_mul_f32 v36, v64, v79
    v_fma_f32 v36, -v63, v22, v36
    v_mul_f32 v63, v63, v79
    v_fmac_f32 v63, v64, v22
    v_mul_f32 v70, 0x3e700000, v10
    v_cos_f32 v79, v70
    v_sin_f32 v22, v70
    s_nop 0
    v_mul_f32 v64, v24, v79
    v_fma_f32 v64, -v67, v22, v64
    v_mul_f32 v67, v67, v79
    v_fmac_f32 v67, v24, v22
    v_mul_f32 v70, 0x3e800000, v10
    v_cos_f32 v79, v70
    v_sin_f32 v22, v70
    s_nop 0
    v_mul_f32 v24, v30, v79
    v_fma_f32 v24, -v75, v22, v24
    v_mul_f32 v75, v75, v79
    v_fmac_f32 v75, v30, v22
    v_mul_f32 v70, 0x3e880000, v10
    v_cos_f32 v79, v70
    v_sin_f32 v22, v70
    s_nop 0
    v_mul_f32 v30, v34, v79
    v_fma_f32 v30, -v77, v22, v30
    v_mul_f32 v77, v77, v79
    v_fmac_f32 v77, v34, v22
    v_mul_f32 v70, 0x3e900000, v10
    v_cos_f32 v79, v70
    v_sin_f32 v22, v70
    s_nop 0
    v_mul_f32 v34, v42, v79
    v_fma_f32 v34, -v73, v22, v34
    v_mul_f32 v73, v73, v79
    v_fmac_f32 v73, v42, v22
    v_mul_f32 v70, 0x3e980000, v10
    v_cos_f32 v79, v70
    v_sin_f32 v22, v70
    s_nop 0
    v_mul_f32 v42, v60, v79
    v_fma_f32 v42, -v21, v22, v42
    v_mul_f32 v21, v21, v79
    v_fmac_f32 v21, v60, v22
    v_mul_f32 v70, 0x3ea00000, v10
    v_cos_f32 v79, v70
    v_sin_f32 v22, v70
    s_nop 0
    v_mul_f32 v60, v40, v79
    v_fma_f32 v60, -v65, v22, v60
    v_mul_f32 v65, v65, v79
    v_fmac_f32 v65, v40, v22
    v_mul_f32 v70, 0x3ea80000, v10
    v_cos_f32 v79, v70
    v_sin_f32 v22, v70
    s_nop 0
    v_mul_f32 v40, v56, v79
    v_fma_f32 v40, -v25, v22, v40
    v_mul_f32 v25, v25, v79
    v_fmac_f32 v25, v56, v22
    v_mul_f32 v70, 0x3eb00000, v10
    v_cos_f32 v79, v70
    v_sin_f32 v22, v70
    s_nop 0
    v_mul_f32 v56, v80, v79
    v_fma_f32 v56, -v31, v22, v56
    v_mul_f32 v31, v31, v79
    v_fmac_f32 v31, v80, v22
    v_mul_f32 v70, 0x3eb80000, v10
    v_cos_f32 v79, v70
    v_sin_f32 v22, v70
    s_nop 0
    v_mul_f32 v80, v32, v79
    v_fma_f32 v80, -v35, v22, v80
    v_mul_f32 v35, v35, v79
    v_fmac_f32 v35, v32, v22
    v_mul_f32 v70, 0x3ec00000, v10
    v_cos_f32 v79, v70
    v_sin_f32 v22, v70
    s_nop 0
    v_mul_f32 v32, v46, v79
    v_fma_f32 v32, -v81, v22, v32
    v_mul_f32 v81, v81, v79
    v_fmac_f32 v81, v46, v22
    v_mul_f32 v70, 0x3ec80000, v10
    v_cos_f32 v79, v70
    v_sin_f32 v22, v70
    s_nop 0
    v_mul_f32 v46, v50, v79
    v_fma_f32 v46, -v33, v22, v46
    v_mul_f32 v33, v33, v79
    v_fmac_f32 v33, v50, v22
    v_mul_f32 v70, 0x3ed00000, v10
    v_cos_f32 v79, v70
    v_sin_f32 v22, v70
    s_nop 0
    v_mul_f32 v50, v83, v79
    v_fma_f32 v50, -v47, v22, v50
    v_mul_f32 v47, v47, v79
    v_fmac_f32 v47, v83, v22
    v_mul_f32 v70, 0x3ed80000, v10
    v_cos_f32 v79, v70
    v_sin_f32 v22, v70
    s_nop 0
    v_mul_f32 v83, v78, v79
    v_fma_f32 v83, -v51, v22, v83
    v_mul_f32 v51, v51, v79
    v_fmac_f32 v51, v78, v22
    v_mul_f32 v70, 0x3ee00000, v10
    v_cos_f32 v79, v70
    v_sin_f32 v22, v70
    s_nop 0
    v_mul_f32 v78, v76, v79
    v_fma_f32 v78, -v45, v22, v78
    v_mul_f32 v45, v45, v79
    v_fmac_f32 v45, v76, v22
    v_mul_f32 v70, 0x3ee80000, v10
    v_cos_f32 v79, v70
    v_sin_f32 v22, v70
    s_nop 0
    v_mul_f32 v76, v18, v79
    v_fma_f32 v76, -v53, v22, v76
    v_mul_f32 v53, v53, v79
    v_fmac_f32 v53, v18, v22
    v_mul_f32 v70, 0x3ef00000, v10
    v_cos_f32 v79, v70
    v_sin_f32 v22, v70
    s_nop 0
    v_mul_f32 v18, v72, v79
    v_fma_f32 v18, -v55, v22, v18
    v_mul_f32 v55, v55, v79
    v_fmac_f32 v55, v72, v22
    v_mul_f32 v70, 0x3ef80000, v10
    v_cos_f32 v79, v70
    v_sin_f32 v22, v70
    s_nop 0
    v_mul_f32 v72, v20, v79
    v_fma_f32 v72, -v59, v22, v72
    v_mul_f32 v59, v59, v79
    v_fmac_f32 v59, v20, v22
    v_sub_f32 v70, v82, v24
    v_sub_f32 v79, v17, v75
    v_add_f32 v82, v82, v24
    v_add_f32 v17, v17, v75
    v_sub_f32 v24, v26, v30
    v_sub_f32 v75, v49, v77
    v_add_f32 v26, v26, v30
    v_add_f32 v49, v49, v77
    v_mul_f32 v30, 0x3f7b14be, v24
    v_mul_f32 v77, 0x3e47c5c2, v24
    v_fmac_f32 v30, 0xbe47c5c2, v75
    v_fmac_f32 v77, 0x3f7b14be, v75
    v_sub_f32 v24, v16, v34
    v_sub_f32 v75, v19, v73
    v_add_f32 v16, v16, v34
    v_add_f32 v19, v19, v73
    v_mul_f32 v34, 0x3f6c835e, v24
    v_mul_f32 v73, 0x3ec3ef15, v24
    v_fmac_f32 v34, 0xbec3ef15, v75
    v_fmac_f32 v73, 0x3f6c835e, v75
    v_sub_f32 v24, v74, v42
    v_sub_f32 v75, v23, v21
    v_add_f32 v74, v74, v42
    v_add_f32 v23, v23, v21
    v_mul_f32 v42, 0x3f54db31, v24
    v_mul_f32 v21, 0x3f0e39da, v24
    v_fmac_f32 v42, 0xbf0e39da, v75
    v_fmac_f32 v21, 0x3f54db31, v75
    v_sub_f32 v24, v48, v60
    v_sub_f32 v75, v27, v65
    v_add_f32 v48, v48, v60
    v_add_f32 v27, v27, v65
    v_mul_f32 v60, 0x3f3504f3, v24
    v_mul_f32 v65, 0x3f3504f3, v24
    v_fmac_f32 v60, 0xbf3504f3, v75
    v_fmac_f32 v65, 0x3f3504f3, v75
    v_sub_f32 v24, v68, v40
    v_sub_f32 v75, v39, v25
    v_add_f32 v68, v68, v40
    v_add_f32 v39, v39, v25
    v_mul_f32 v40, 0x3f0e39da, v24
    v_mul_f32 v25, 0x3f54db31, v24
    v_fmac_f32 v40, 0xbf54db31, v75
    v_fmac_f32 v25, 0x3f0e39da, v75
    v_sub_f32 v24, v62, v56
    v_sub_f32 v75, v29, v31
    v_add_f32 v62, v62, v56
    v_add_f32 v29, v29, v31
    v_mul_f32 v56, 0x3ec3ef15, v24
    v_mul_f32 v31, 0x3f6c835e, v24
    v_fmac_f32 v56, 0xbf6c835e, v75
    v_fmac_f32 v31, 0x3ec3ef15, v75
    v_sub_f32 v24, v66, v80
    v_sub_f32 v75, v37, v35
    v_add_f32 v66, v66, v80
    v_add_f32 v37, v37, v35
    v_mul_f32 v80, 0x3e47c5c2, v24
    v_mul_f32 v35, 0x3f7b14be, v24
    v_fmac_f32 v80, 0xbf7b14be, v75
    v_fmac_f32 v35, 0x3e47c5c2, v75
    v_sub_f32 v24, v81, v43
    v_sub_f32 v75, v54, v32
    v_add_f32 v54, v54, v32
    v_add_f32 v43, v43, v81
    v_sub_f32 v32, v44, v46
    v_sub_f32 v81, v71, v33
    v_add_f32 v44, v44, v46
    v_add_f32 v71, v71, v33
    v_mul_f32 v46, 0xbe47c5c2, v32
    v_mul_f32 v33, 0x3f7b14be, v32
    v_fmac_f32 v46, 0xbf7b14be, v81
    v_fmac_f32 v33, 0xbe47c5c2, v81
    v_sub_f32 v32, v52, v50
    v_sub_f32 v81, v61, v47
    v_add_f32 v52, v52, v50
    v_add_f32 v61, v61, v47
    v_mul_f32 v50, 0xbec3ef15, v32
    v_mul_f32 v47, 0x3f6c835e, v32
    v_fmac_f32 v50, 0xbf6c835e, v81
    v_fmac_f32 v47, 0xbec3ef15, v81
    v_sub_f32 v32, v58, v83
    v_sub_f32 v81, v69, v51
    v_add_f32 v58, v58, v83
    v_add_f32 v69, v69, v51
    v_mul_f32 v83, 0xbf0e39da, v32
    v_mul_f32 v51, 0x3f54db31, v32
    v_fmac_f32 v83, 0xbf54db31, v81
    v_fmac_f32 v51, 0xbf0e39da, v81
    v_sub_f32 v32, v38, v78
    v_sub_f32 v81, v41, v45
    v_add_f32 v38, v38, v78
    v_add_f32 v41, v41, v45
    v_mul_f32 v78, 0xbf3504f3, v32
    v_mul_f32 v45, 0x3f3504f3, v32
    v_fmac_f32 v78, 0xbf3504f3, v81
    v_fmac_f32 v45, 0xbf3504f3, v81
    v_sub_f32 v32, v28, v76
    v_sub_f32 v81, v57, v53
    v_add_f32 v28, v28, v76
    v_add_f32 v57, v57, v53
    v_mul_f32 v76, 0xbf54db31, v32
    v_mul_f32 v53, 0x3f0e39da, v32
    v_fmac_f32 v76, 0xbf0e39da, v81
    v_fmac_f32 v53, 0xbf54db31, v81
    v_sub_f32 v32, v36, v18
    v_sub_f32 v81, v63, v55
    v_add_f32 v36, v36, v18
    v_add_f32 v63, v63, v55
    v_mul_f32 v18, 0xbf6c835e, v32
    v_mul_f32 v55, 0x3ec3ef15, v32
    v_fmac_f32 v18, 0xbec3ef15, v81
    v_fmac_f32 v55, 0xbf6c835e, v81
    v_sub_f32 v32, v64, v72
    v_sub_f32 v81, v67, v59
    v_add_f32 v64, v64, v72
    v_add_f32 v67, v67, v59
    v_mul_f32 v72, 0xbf7b14be, v32
    v_mul_f32 v59, 0x3e47c5c2, v32
    v_fmac_f32 v72, 0xbe47c5c2, v81
    v_fmac_f32 v59, 0xbf7b14be, v81
    v_sub_f32 v32, v82, v54
    v_sub_f32 v81, v17, v43
    v_add_f32 v82, v82, v54
    v_add_f32 v17, v17, v43
    v_sub_f32 v54, v26, v44
    v_sub_f32 v43, v49, v71
    v_add_f32 v26, v26, v44
    v_add_f32 v49, v49, v71
    v_mul_f32 v44, 0x3f6c835e, v54
    v_mul_f32 v71, 0x3ec3ef15, v54
    v_fmac_f32 v44, 0xbec3ef15, v43
    v_fmac_f32 v71, 0x3f6c835e, v43
    v_sub_f32 v54, v16, v52
    v_sub_f32 v43, v19, v61
    v_add_f32 v16, v16, v52
    v_add_f32 v19, v19, v61
    v_mul_f32 v52, 0x3f3504f3, v54
    v_mul_f32 v61, 0x3f3504f3, v54
    v_fmac_f32 v52, 0xbf3504f3, v43
    v_fmac_f32 v61, 0x3f3504f3, v43
    v_sub_f32 v54, v74, v58
    v_sub_f32 v43, v23, v69
    v_add_f32 v74, v74, v58
    v_add_f32 v23, v23, v69
    v_mul_f32 v58, 0x3ec3ef15, v54
    v_mul_f32 v69, 0x3f6c835e, v54
    v_fmac_f32 v58, 0xbf6c835e, v43
    v_fmac_f32 v69, 0x3ec3ef15, v43
    v_sub_f32 v54, v41, v27
    v_sub_f32 v43, v48, v38
    v_add_f32 v48, v48, v38
    v_add_f32 v27, v27, v41
    v_sub_f32 v38, v68, v28
    v_sub_f32 v41, v39, v57
    v_add_f32 v68, v68, v28
    v_add_f32 v39, v39, v57
    v_mul_f32 v28, 0xbec3ef15, v38
    v_mul_f32 v57, 0x3f6c835e, v38
    v_fmac_f32 v28, 0xbf6c835e, v41
    v_fmac_f32 v57, 0xbec3ef15, v41
    v_sub_f32 v38, v62, v36
    v_sub_f32 v41, v29, v63
    v_add_f32 v62, v62, v36
    v_add_f32 v29, v29, v63
    v_mul_f32 v36, 0xbf3504f3, v38
    v_mul_f32 v63, 0x3f3504f3, v38
    v_fmac_f32 v36, 0xbf3504f3, v41
    v_fmac_f32 v63, 0xbf3504f3, v41
    v_sub_f32 v38, v66, v64
    v_sub_f32 v41, v37, v67
    v_add_f32 v66, v66, v64
    v_add_f32 v37, v37, v67
    v_mul_f32 v64, 0xbf6c835e, v38
    v_mul_f32 v67, 0x3ec3ef15, v38
    v_fmac_f32 v64, 0xbec3ef15, v41
    v_fmac_f32 v67, 0xbf6c835e, v41
    v_sub_f32 v38, v70, v24
    v_sub_f32 v41, v79, v75
    v_add_f32 v70, v70, v24
    v_add_f32 v79, v79, v75
    v_sub_f32 v24, v30, v46
    v_sub_f32 v75, v77, v33
    v_add_f32 v30, v30, v46
    v_add_f32 v77, v77, v33
    v_mul_f32 v46, 0x3f6c835e, v24
    v_mul_f32 v33, 0x3ec3ef15, v24
    v_fmac_f32 v46, 0xbec3ef15, v75
    v_fmac_f32 v33, 0x3f6c835e, v75
    v_sub_f32 v24, v34, v50
    v_sub_f32 v75, v73, v47
    v_add_f32 v34, v34, v50
    v_add_f32 v73, v73, v47
    v_mul_f32 v50, 0x3f3504f3, v24
    v_mul_f32 v47, 0x3f3504f3, v24
    v_fmac_f32 v50, 0xbf3504f3, v75
    v_fmac_f32 v47, 0x3f3504f3, v75
    v_sub_f32 v24, v42, v83
    v_sub_f32 v75, v21, v51
    v_add_f32 v42, v42, v83
    v_add_f32 v21, v21, v51
    v_mul_f32 v83, 0x3ec3ef15, v24
    v_mul_f32 v51, 0x3f6c835e, v24
    v_fmac_f32 v83, 0xbf6c835e, v75
    v_fmac_f32 v51, 0x3ec3ef15, v75
    v_sub_f32 v24, v45, v65
    v_sub_f32 v75, v60, v78
    v_add_f32 v60, v60, v78
    v_add_f32 v65, v65, v45
    v_sub_f32 v78, v40, v76
    v_sub_f32 v45, v25, v53
    v_add_f32 v40, v40, v76
    v_add_f32 v25, v25, v53
    v_mul_f32 v76, 0xbec3ef15, v78
    v_mul_f32 v53, 0x3f6c835e, v78
    v_fmac_f32 v76, 0xbf6c835e, v45
    v_fmac_f32 v53, 0xbec3ef15, v45
    v_sub_f32 v78, v56, v18
    v_sub_f32 v45, v31, v55
    v_add_f32 v56, v56, v18
    v_add_f32 v31, v31, v55
    v_mul_f32 v18, 0xbf3504f3, v78
    v_mul_f32 v55, 0x3f3504f3, v78
    v_fmac_f32 v18, 0xbf3504f3, v45
    v_fmac_f32 v55, 0xbf3504f3, v45
    v_sub_f32 v78, v80, v72
    v_sub_f32 v45, v35, v59
    v_add_f32 v80, v80, v72
    v_add_f32 v35, v35, v59
    v_mul_f32 v72, 0xbf6c835e, v78
    v_mul_f32 v59, 0x3ec3ef15, v78
    v_fmac_f32 v72, 0xbec3ef15, v45
    v_fmac_f32 v59, 0xbf6c835e, v45
    v_sub_f32 v78, v82, v48
    v_sub_f32 v45, v17, v27
    v_add_f32 v82, v82, v48
    v_add_f32 v17, v17, v27
    v_sub_f32 v48, v26, v68
    v_sub_f32 v27, v49, v39
    v_add_f32 v26, v26, v68
    v_add_f32 v49, v49, v39
    v_mul_f32 v68, 0x3f3504f3, v48
    v_mul_f32 v39, 0x3f3504f3, v48
    v_fmac_f32 v68, 0xbf3504f3, v27
    v_fmac_f32 v39, 0x3f3504f3, v27
    v_sub_f32 v48, v29, v19
    v_sub_f32 v27, v16, v62
    v_add_f32 v16, v16, v62
    v_add_f32 v19, v19, v29
    v_sub_f32 v62, v74, v66
    v_sub_f32 v29, v23, v37
    v_add_f32 v74, v74, v66
    v_add_f32 v23, v23, v37
    v_mul_f32 v66, 0xbf3504f3, v62
    v_mul_f32 v37, 0x3f3504f3, v62
    v_fmac_f32 v66, 0xbf3504f3, v29
    v_fmac_f32 v37, 0xbf3504f3, v29
    v_sub_f32 v62, v32, v54
    v_sub_f32 v29, v81, v43
    v_add_f32 v32, v32, v54
    v_add_f32 v81, v81, v43
    v_sub_f32 v54, v44, v28
    v_sub_f32 v43, v71, v57
    v_add_f32 v44, v44, v28
    v_add_f32 v71, v71, v57
    v_mul_f32 v28, 0x3f3504f3, v54
    v_mul_f32 v57, 0x3f3504f3, v54
    v_fmac_f32 v28, 0xbf3504f3, v43
    v_fmac_f32 v57, 0x3f3504f3, v43
    v_sub_f32 v54, v63, v61
    v_sub_f32 v43, v52, v36
    v_add_f32 v52, v52, v36
    v_add_f32 v61, v61, v63
    v_sub_f32 v36, v58, v64
    v_sub_f32 v63, v69, v67
    v_add_f32 v58, v58, v64
    v_add_f32 v69, v69, v67
    v_mul_f32 v64, 0xbf3504f3, v36
    v_mul_f32 v67, 0x3f3504f3, v36
    v_fmac_f32 v64, 0xbf3504f3, v63
    v_fmac_f32 v67, 0xbf3504f3, v63
    v_sub_f32 v36, v70, v60
    v_sub_f32 v63, v79, v65
    v_add_f32 v70, v70, v60
    v_add_f32 v79, v79, v65
    v_sub_f32 v60, v30, v40
    v_sub_f32 v65, v77, v25
    v_add_f32 v30, v30, v40
    v_add_f32 v77, v77, v25
    v_mul_f32 v40, 0x3f3504f3, v60
    v_mul_f32 v25, 0x3f3504f3, v60
    v_fmac_f32 v40, 0xbf3504f3, v65
    v_fmac_f32 v25, 0x3f3504f3, v65
    v_sub_f32 v60, v31, v73
    v_sub_f32 v65, v34, v56
    v_add_f32 v34, v34, v56
    v_add_f32 v73, v73, v31
    v_sub_f32 v56, v42, v80
    v_sub_f32 v31, v21, v35
    v_add_f32 v42, v42, v80
    v_add_f32 v21, v21, v35
    v_mul_f32 v80, 0xbf3504f3, v56
    v_mul_f32 v35, 0x3f3504f3, v56
    v_fmac_f32 v80, 0xbf3504f3, v31
    v_fmac_f32 v35, 0xbf3504f3, v31
    v_sub_f32 v56, v38, v24
    v_sub_f32 v31, v41, v75
    v_add_f32 v38, v38, v24
    v_add_f32 v41, v41, v75
    v_sub_f32 v24, v46, v76
    v_sub_f32 v75, v33, v53
    v_add_f32 v46, v46, v76
    v_add_f32 v33, v33, v53
    v_mul_f32 v76, 0x3f3504f3, v24
    v_mul_f32 v53, 0x3f3504f3, v24
    v_fmac_f32 v76, 0xbf3504f3, v75
    v_fmac_f32 v53, 0x3f3504f3, v75
    v_sub_f32 v24, v55, v47
    v_sub_f32 v75, v50, v18
    v_add_f32 v50, v50, v18
    v_add_f32 v47, v47, v55
    v_sub_f32 v18, v83, v72
    v_sub_f32 v55, v51, v59
    v_add_f32 v83, v83, v72
    v_add_f32 v51, v51, v59
    v_mul_f32 v72, 0xbf3504f3, v18
    v_mul_f32 v59, 0x3f3504f3, v18
    v_fmac_f32 v72, 0xbf3504f3, v55
    v_fmac_f32 v59, 0xbf3504f3, v55
    v_sub_f32 v18, v82, v16
    v_sub_f32 v55, v17, v19
    v_add_f32 v82, v82, v16
    v_add_f32 v17, v17, v19
    v_sub_f32 v16, v23, v49
    v_sub_f32 v19, v26, v74
    v_add_f32 v26, v26, v74
    v_add_f32 v49, v49, v23
    v_sub_f32 v74, v78, v48
    v_sub_f32 v23, v45, v27
    v_add_f32 v78, v78, v48
    v_add_f32 v45, v45, v27
    v_sub_f32 v48, v37, v39
    v_sub_f32 v27, v68, v66
    v_add_f32 v68, v68, v66
    v_add_f32 v39, v39, v37
    v_sub_f32 v66, v32, v52
    v_sub_f32 v37, v81, v61
    v_add_f32 v32, v32, v52
    v_add_f32 v81, v81, v61
    v_sub_f32 v52, v69, v71
    v_sub_f32 v61, v44, v58
    v_add_f32 v44, v44, v58
    v_add_f32 v71, v71, v69
    v_sub_f32 v58, v62, v54
    v_sub_f32 v69, v29, v43
    v_add_f32 v62, v62, v54
    v_add_f32 v29, v29, v43
    v_sub_f32 v54, v67, v57
    v_sub_f32 v43, v28, v64
    v_add_f32 v28, v28, v64
    v_add_f32 v57, v57, v67
    v_sub_f32 v64, v70, v34
    v_sub_f32 v67, v79, v73
    v_add_f32 v70, v70, v34
    v_add_f32 v79, v79, v73
    v_sub_f32 v34, v21, v77
    v_sub_f32 v73, v30, v42
    v_add_f32 v30, v30, v42
    v_add_f32 v77, v77, v21
    v_sub_f32 v42, v36, v60
    v_sub_f32 v21, v63, v65
    v_add_f32 v36, v36, v60
    v_add_f32 v63, v63, v65
    v_sub_f32 v60, v35, v25
    v_sub_f32 v65, v40, v80
    v_add_f32 v40, v40, v80
    v_add_f32 v25, v25, v35
    v_sub_f32 v80, v38, v50
    v_sub_f32 v35, v41, v47
    v_add_f32 v38, v38, v50
    v_add_f32 v41, v41, v47
    v_sub_f32 v50, v51, v33
    v_sub_f32 v47, v46, v83
    v_add_f32 v46, v46, v83
    v_add_f32 v33, v33, v51
    v_sub_f32 v83, v56, v24
    v_sub_f32 v51, v31, v75
    v_add_f32 v56, v56, v24
    v_add_f32 v31, v31, v75
    v_sub_f32 v24, v59, v53
    v_sub_f32 v75, v76, v72
    v_add_f32 v76, v76, v72
    v_add_f32 v53, v53, v59
    v_sub_f32 v72, v82, v26
    v_sub_f32 v59, v17, v49
    v_add_f32 v82, v82, v26
    v_add_f32 v17, v17, v49
    v_sub_f32 v26, v18, v16
    v_sub_f32 v49, v55, v19
    v_add_f32 v18, v18, v16
    v_add_f32 v55, v55, v19
    v_sub_f32 v16, v78, v68
    v_sub_f32 v19, v45, v39
    v_add_f32 v78, v78, v68
    v_add_f32 v45, v45, v39
    v_sub_f32 v68, v74, v48
    v_sub_f32 v39, v23, v27
    v_add_f32 v74, v74, v48
    v_add_f32 v23, v23, v27
    v_sub_f32 v48, v32, v44
    v_sub_f32 v27, v81, v71
    v_add_f32 v32, v32, v44
    v_add_f32 v81, v81, v71
    v_sub_f32 v44, v66, v52
    v_sub_f32 v71, v37, v61
    v_add_f32 v66, v66, v52
    v_add_f32 v37, v37, v61
    v_sub_f32 v52, v62, v28
    v_sub_f32 v61, v29, v57
    v_add_f32 v62, v62, v28
    v_add_f32 v29, v29, v57
    v_sub_f32 v28, v58, v54
    v_sub_f32 v57, v69, v43
    v_add_f32 v58, v58, v54
    v_add_f32 v69, v69, v43
    v_sub_f32 v54, v70, v30
    v_sub_f32 v43, v79, v77
    v_add_f32 v70, v70, v30
    v_add_f32 v79, v79, v77
    v_sub_f32 v30, v64, v34
    v_sub_f32 v77, v67, v73
    v_add_f32 v64, v64, v34
    v_add_f32 v67, v67, v73
    v_sub_f32 v34, v36, v40
    v_sub_f32 v73, v63, v25
    v_add_f32 v36, v36, v40
    v_add_f32 v63, v63, v25
    v_sub_f32 v40, v42, v60
    v_sub_f32 v25, v21, v65
    v_add_f32 v42, v42, v60
    v_add_f32 v21, v21, v65
    v_sub_f32 v60, v38, v46
    v_sub_f32 v65, v41, v33
    v_add_f32 v38, v38, v46
    v_add_f32 v41, v41, v33
    v_sub_f32 v46, v80, v50
    v_sub_f32 v33, v35, v47
    v_add_f32 v80, v80, v50
    v_add_f32 v35, v35, v47
    v_sub_f32 v50, v56, v76
    v_sub_f32 v47, v31, v53
    v_add_f32 v56, v56, v76
    v_add_f32 v31, v31, v53
    v_sub_f32 v76, v83, v24
    v_sub_f32 v53, v51, v75
    v_add_f32 v83, v83, v24
    v_add_f32 v51, v51, v75
    v_mul_f32 v12, v10, v8
    v_mul_f32 v12, 0x3a000000, v12
    v_mov_b32 v24, v12
    v_fmac_f32 v24, 0x00000000, v8
    v_cos_f32 v75, v24
    v_sin_f32 v22, v24
    s_nop 0
    v_mul_f32 v20, v82, v75
    v_fma_f32 v20, -v17, v22, v20
    v_mul_f32 v17, v17, v75
    v_fmac_f32 v17, v82, v22
    v_mov_b32 v24, v12
    v_fmac_f32 v24, 0x3a800000, v8
    v_cos_f32 v75, v24
    v_sin_f32 v22, v24
    s_nop 0
    v_mul_f32 v82, v70, v75
    v_fma_f32 v82, -v79, v22, v82
    v_mul_f32 v79, v79, v75
    v_fmac_f32 v79, v70, v22
    v_mov_b32 v24, v12
    v_fmac_f32 v24, 0x3b000000, v8
    v_cos_f32 v75, v24
    v_sin_f32 v22, v24
    s_nop 0
    v_mul_f32 v70, v32, v75
    v_fma_f32 v70, -v81, v22, v70
    v_mul_f32 v81, v81, v75
    v_fmac_f32 v81, v32, v22
    v_mov_b32 v24, v12
    v_fmac_f32 v24, 0x3b400000, v8
    v_cos_f32 v75, v24
    v_sin_f32 v22, v24
    s_nop 0
    v_mul_f32 v32, v38, v75
    v_fma_f32 v32, -v41, v22, v32
    v_mul_f32 v41, v41, v75
    v_fmac_f32 v41, v38, v22
    v_mov_b32 v24, v12
    v_fmac_f32 v24, 0x3b800000, v8
    v_cos_f32 v75, v24
    v_sin_f32 v22, v24
    s_nop 0
    v_mul_f32 v38, v78, v75
    v_fma_f32 v38, -v45, v22, v38
    v_mul_f32 v45, v45, v75
    v_fmac_f32 v45, v78, v22
    v_mov_b32 v24, v12
    v_fmac_f32 v24, 0x3ba00000, v8
    v_cos_f32 v75, v24
    v_sin_f32 v22, v24
    s_nop 0
    v_mul_f32 v78, v36, v75
    v_fma_f32 v78, -v63, v22, v78
    v_mul_f32 v63, v63, v75
    v_fmac_f32 v63, v36, v22
    v_mov_b32 v24, v12
    v_fmac_f32 v24, 0x3bc00000, v8
    v_cos_f32 v75, v24
    v_sin_f32 v22, v24
    s_nop 0
    v_mul_f32 v36, v62, v75
    v_fma_f32 v36, -v29, v22, v36
    v_mul_f32 v29, v29, v75
    v_fmac_f32 v29, v62, v22
    v_mov_b32 v24, v12
    v_fmac_f32 v24, 0x3be00000, v8
    v_cos_f32 v75, v24
    v_sin_f32 v22, v24
    s_nop 0
    v_mul_f32 v62, v56, v75
    v_fma_f32 v62, -v31, v22, v62
    v_mul_f32 v31, v31, v75
    v_fmac_f32 v31, v56, v22
    v_mov_b32 v24, v12
    v_fmac_f32 v24, 0x3c000000, v8
    v_cos_f32 v75, v24
    v_sin_f32 v22, v24
    s_nop 0
    v_mul_f32 v56, v18, v75
    v_fma_f32 v56, -v55, v22, v56
    v_mul_f32 v55, v55, v75
    v_fmac_f32 v55, v18, v22
    v_mov_b32 v24, v12
    v_fmac_f32 v24, 0x3c100000, v8
    v_cos_f32 v75, v24
    v_sin_f32 v22, v24
    s_nop 0
    v_mul_f32 v18, v64, v75
    v_fma_f32 v18, -v67, v22, v18
    v_mul_f32 v67, v67, v75
    v_fmac_f32 v67, v64, v22
    v_mov_b32 v24, v12
    v_fmac_f32 v24, 0x3c200000, v8
    v_cos_f32 v75, v24
    v_sin_f32 v22, v24
    s_nop 0
    v_mul_f32 v64, v66, v75
    v_fma_f32 v64, -v37, v22, v64
    v_mul_f32 v37, v37, v75
    v_fmac_f32 v37, v66, v22
    v_mov_b32 v24, v12
    v_fmac_f32 v24, 0x3c300000, v8
    v_cos_f32 v75, v24
    v_sin_f32 v22, v24
    s_nop 0
    v_mul_f32 v66, v80, v75
    v_fma_f32 v66, -v35, v22, v66
    v_mul_f32 v35, v35, v75
    v_fmac_f32 v35, v80, v22
    v_mov_b32 v24, v12
    v_fmac_f32 v24, 0x3c400000, v8
    v_cos_f32 v75, v24
    v_sin_f32 v22, v24
    s_nop 0
    v_mul_f32 v80, v74, v75
    v_fma_f32 v80, -v23, v22, v80
    v_mul_f32 v23, v23, v75
    v_fmac_f32 v23, v74, v22
    v_mov_b32 v24, v12
    v_fmac_f32 v24, 0x3c500000, v8
    v_cos_f32 v75, v24
    v_sin_f32 v22, v24
    s_nop 0
    v_mul_f32 v74, v42, v75
    v_fma_f32 v74, -v21, v22, v74
    v_mul_f32 v21, v21, v75
    v_fmac_f32 v21, v42, v22
    v_mov_b32 v24, v12
    v_fmac_f32 v24, 0x3c600000, v8
    v_cos_f32 v75, v24
    v_sin_f32 v22, v24
    s_nop 0
    v_mul_f32 v42, v58, v75
    v_fma_f32 v42, -v69, v22, v42
    v_mul_f32 v69, v69, v75
    v_fmac_f32 v69, v58, v22
    v_mov_b32 v24, v12
    v_fmac_f32 v24, 0x3c700000, v8
    v_cos_f32 v75, v24
    v_sin_f32 v22, v24
    s_nop 0
    v_mul_f32 v58, v83, v75
    v_fma_f32 v58, -v51, v22, v58
    v_mul_f32 v51, v51, v75
    v_fmac_f32 v51, v83, v22
    v_mov_b32 v24, v12
    v_fmac_f32 v24, 0x3c800000, v8
    v_cos_f32 v75, v24
    v_sin_f32 v22, v24
    s_nop 0
    v_mul_f32 v83, v72, v75
    v_fma_f32 v83, -v59, v22, v83
    v_mul_f32 v59, v59, v75
    v_fmac_f32 v59, v72, v22
    v_mov_b32 v24, v12
    v_fmac_f32 v24, 0x3c880000, v8
    v_cos_f32 v75, v24
    v_sin_f32 v22, v24
    s_nop 0
    v_mul_f32 v72, v54, v75
    v_fma_f32 v72, -v43, v22, v72
    v_mul_f32 v43, v43, v75
    v_fmac_f32 v43, v54, v22
    v_mov_b32 v24, v12
    v_fmac_f32 v24, 0x3c900000, v8
    v_cos_f32 v75, v24
    v_sin_f32 v22, v24
    s_nop 0
    v_mul_f32 v54, v48, v75
    v_fma_f32 v54, -v27, v22, v54
    v_mul_f32 v27, v27, v75
    v_fmac_f32 v27, v48, v22
    v_mov_b32 v24, v12
    v_fmac_f32 v24, 0x3c980000, v8
    v_cos_f32 v75, v24
    v_sin_f32 v22, v24
    s_nop 0
    v_mul_f32 v48, v60, v75
    v_fma_f32 v48, -v65, v22, v48
    v_mul_f32 v65, v65, v75
    v_fmac_f32 v65, v60, v22
    v_mov_b32 v24, v12
    v_fmac_f32 v24, 0x3ca00000, v8
    v_cos_f32 v75, v24
    v_sin_f32 v22, v24
    s_nop 0
    v_mul_f32 v60, v16, v75
    v_fma_f32 v60, -v19, v22, v60
    v_mul_f32 v19, v19, v75
    v_fmac_f32 v19, v16, v22
    v_mov_b32 v24, v12
    v_fmac_f32 v24, 0x3ca80000, v8
    v_cos_f32 v75, v24
    v_sin_f32 v22, v24
    s_nop 0
    v_mul_f32 v16, v34, v75
    v_fma_f32 v16, -v73, v22, v16
    v_mul_f32 v73, v73, v75
    v_fmac_f32 v73, v34, v22
    v_mov_b32 v24, v12
    v_fmac_f32 v24, 0x3cb00000, v8
    v_cos_f32 v75, v24
    v_sin_f32 v22, v24
    s_nop 0
    v_mul_f32 v34, v52, v75
    v_fma_f32 v34, -v61, v22, v34
    v_mul_f32 v61, v61, v75
    v_fmac_f32 v61, v52, v22
    v_mov_b32 v24, v12
    v_fmac_f32 v24, 0x3cb80000, v8
    v_cos_f32 v75, v24
    v_sin_f32 v22, v24
    s_nop 0
    v_mul_f32 v52, v50, v75
    v_fma_f32 v52, -v47, v22, v52
    v_mul_f32 v47, v47, v75
    v_fmac_f32 v47, v50, v22
    v_mov_b32 v24, v12
    v_fmac_f32 v24, 0x3cc00000, v8
    v_cos_f32 v75, v24
    v_sin_f32 v22, v24
    s_nop 0
    v_mul_f32 v50, v26, v75
    v_fma_f32 v50, -v49, v22, v50
    v_mul_f32 v49, v49, v75
    v_fmac_f32 v49, v26, v22
    v_mov_b32 v24, v12
    v_fmac_f32 v24, 0x3cc80000, v8
    v_cos_f32 v75, v24
    v_sin_f32 v22, v24
    s_nop 0
    v_mul_f32 v26, v30, v75
    v_fma_f32 v26, -v77, v22, v26
    v_mul_f32 v77, v77, v75
    v_fmac_f32 v77, v30, v22
    v_mov_b32 v24, v12
    v_fmac_f32 v24, 0x3cd00000, v8
    v_cos_f32 v75, v24
    v_sin_f32 v22, v24
    s_nop 0
    v_mul_f32 v30, v44, v75
    v_fma_f32 v30, -v71, v22, v30
    v_mul_f32 v71, v71, v75
    v_fmac_f32 v71, v44, v22
    v_mov_b32 v24, v12
    v_fmac_f32 v24, 0x3cd80000, v8
    v_cos_f32 v75, v24
    v_sin_f32 v22, v24
    s_nop 0
    v_mul_f32 v44, v46, v75
    v_fma_f32 v44, -v33, v22, v44
    v_mul_f32 v33, v33, v75
    v_fmac_f32 v33, v46, v22
    v_mov_b32 v24, v12
    v_fmac_f32 v24, 0x3ce00000, v8
    v_cos_f32 v75, v24
    v_sin_f32 v22, v24
    s_nop 0
    v_mul_f32 v46, v68, v75
    v_fma_f32 v46, -v39, v22, v46
    v_mul_f32 v39, v39, v75
    v_fmac_f32 v39, v68, v22
    v_mov_b32 v24, v12
    v_fmac_f32 v24, 0x3ce80000, v8
    v_cos_f32 v75, v24
    v_sin_f32 v22, v24
    s_nop 0
    v_mul_f32 v68, v40, v75
    v_fma_f32 v68, -v25, v22, v68
    v_mul_f32 v25, v25, v75
    v_fmac_f32 v25, v40, v22
    v_mov_b32 v24, v12
    v_fmac_f32 v24, 0x3cf00000, v8
    v_cos_f32 v75, v24
    v_sin_f32 v22, v24
    s_nop 0
    v_mul_f32 v40, v28, v75
    v_fma_f32 v40, -v57, v22, v40
    v_mul_f32 v57, v57, v75
    v_fmac_f32 v57, v28, v22
    v_mov_b32 v24, v12
    v_fmac_f32 v24, 0x3cf80000, v8
    v_cos_f32 v75, v24
    v_sin_f32 v22, v24
    s_nop 0
    v_mul_f32 v28, v76, v75
    v_fma_f32 v28, -v53, v22, v28
    v_mul_f32 v53, v53, v75
    v_fmac_f32 v53, v76, v22
    ds_write_b32 v4, v20 offset:0
    ds_write_b32 v4, v17 offset:4
    ds_write_b32 v4, v82 offset:16
    ds_write_b32 v4, v79 offset:20
    ds_write_b32 v4, v70 offset:32
    ds_write_b32 v4, v81 offset:36
    ds_write_b32 v4, v32 offset:48
    ds_write_b32 v4, v41 offset:52
    ds_write_b32 v4, v38 offset:64
    ds_write_b32 v4, v45 offset:68
    ds_write_b32 v4, v78 offset:80
    ds_write_b32 v4, v63 offset:84
    ds_write_b32 v4, v36 offset:96
    ds_write_b32 v4, v29 offset:100
    ds_write_b32 v4, v62 offset:112
    ds_write_b32 v4, v31 offset:116
    ds_write_b32 v4, v56 offset:128
    ds_write_b32 v4, v55 offset:132
    ds_write_b32 v4, v18 offset:144
    ds_write_b32 v4, v67 offset:148
    ds_write_b32 v4, v64 offset:160
    ds_write_b32 v4, v37 offset:164
    ds_write_b32 v4, v66 offset:176
    ds_write_b32 v4, v35 offset:180
    ds_write_b32 v4, v80 offset:192
    ds_write_b32 v4, v23 offset:196
    ds_write_b32 v4, v74 offset:208
    ds_write_b32 v4, v21 offset:212
    ds_write_b32 v4, v42 offset:224
    ds_write_b32 v4, v69 offset:228
    ds_write_b32 v4, v58 offset:240
    ds_write_b32 v4, v51 offset:244
    ds_write_b32 v4, v83 offset:256
    ds_write_b32 v4, v59 offset:260
    ds_write_b32 v4, v72 offset:272
    ds_write_b32 v4, v43 offset:276
    ds_write_b32 v4, v54 offset:288
    ds_write_b32 v4, v27 offset:292
    ds_write_b32 v4, v48 offset:304
    ds_write_b32 v4, v65 offset:308
    ds_write_b32 v4, v60 offset:320
    ds_write_b32 v4, v19 offset:324
    ds_write_b32 v4, v16 offset:336
    ds_write_b32 v4, v73 offset:340
    ds_write_b32 v4, v34 offset:352
    ds_write_b32 v4, v61 offset:356
    ds_write_b32 v4, v52 offset:368
    ds_write_b32 v4, v47 offset:372
    ds_write_b32 v4, v50 offset:384
    ds_write_b32 v4, v49 offset:388
    ds_write_b32 v4, v26 offset:400
    ds_write_b32 v4, v77 offset:404
    ds_write_b32 v4, v30 offset:416
    ds_write_b32 v4, v71 offset:420
    ds_write_b32 v4, v44 offset:432
    ds_write_b32 v4, v33 offset:436
    ds_write_b32 v4, v46 offset:448
    ds_write_b32 v4, v39 offset:452
    ds_write_b32 v4, v68 offset:464
    ds_write_b32 v4, v25 offset:468
    ds_write_b32 v4, v40 offset:480
    ds_write_b32 v4, v57 offset:484
    ds_write_b32 v4, v28 offset:496
    ds_write_b32 v4, v53 offset:500
    s_waitcnt lgkmcnt(0)
    ds_read_b32 v20, v3 offset:0
    ds_read_b32 v17, v3 offset:4
    ds_read_b32 v82, v3 offset:528
    ds_read_b32 v79, v3 offset:532
    ds_read_b32 v70, v3 offset:1056
    ds_read_b32 v81, v3 offset:1060
    ds_read_b32 v32, v3 offset:1584
    ds_read_b32 v41, v3 offset:1588
    ds_read_b32 v38, v3 offset:2112
    ds_read_b32 v45, v3 offset:2116
    ds_read_b32 v78, v3 offset:2640
    ds_read_b32 v63, v3 offset:2644
    ds_read_b32 v36, v3 offset:3168
    ds_read_b32 v29, v3 offset:3172
    s_waitcnt lgkmcnt(0)
    ds_read_b32 v62, v3 offset:3696
    ds_read_b32 v31, v3 offset:3700
    ds_read_b32 v56, v3 offset:4224
    ds_read_b32 v55, v3 offset:4228
    ds_read_b32 v18, v3 offset:4752
    ds_read_b32 v67, v3 offset:4756
    ds_read_b32 v64, v3 offset:5280
    ds_read_b32 v37, v3 offset:5284
    ds_read_b32 v66, v3 offset:5808
    ds_read_b32 v35, v3 offset:5812
    ds_read_b32 v80, v3 offset:6336
    ds_read_b32 v23, v3 offset:6340
    ds_read_b32 v74, v3 offset:6864
    ds_read_b32 v21, v3 offset:6868
    s_waitcnt lgkmcnt(0)
    ds_read_b32 v42, v3 offset:7392
    ds_read_b32 v69, v3 offset:7396
    ds_read_b32 v58, v3 offset:7920
    ds_read_b32 v51, v3 offset:7924
    ds_read_b32 v83, v3 offset:8448
    ds_read_b32 v59, v3 offset:8452
    ds_read_b32 v72, v3 offset:8976
    ds_read_b32 v43, v3 offset:8980
    ds_read_b32 v54, v3 offset:9504
    ds_read_b32 v27, v3 offset:9508
    ds_read_b32 v48, v3 offset:10032
    ds_read_b32 v65, v3 offset:10036
    ds_read_b32 v60, v3 offset:10560
    ds_read_b32 v19, v3 offset:10564
    s_waitcnt lgkmcnt(0)
    ds_read_b32 v16, v3 offset:11088
    ds_read_b32 v73, v3 offset:11092
    ds_read_b32 v34, v3 offset:11616
    ds_read_b32 v61, v3 offset:11620
    ds_read_b32 v52, v3 offset:12144
    ds_read_b32 v47, v3 offset:12148
    ds_read_b32 v50, v3 offset:12672
    ds_read_b32 v49, v3 offset:12676
    ds_read_b32 v26, v3 offset:13200
    ds_read_b32 v77, v3 offset:13204
    ds_read_b32 v30, v3 offset:13728
    ds_read_b32 v71, v3 offset:13732
    ds_read_b32 v44, v3 offset:14256
    ds_read_b32 v33, v3 offset:14260
    s_waitcnt lgkmcnt(0)
    ds_read_b32 v46, v3 offset:14784
    ds_read_b32 v39, v3 offset:14788
    ds_read_b32 v68, v3 offset:15312
    ds_read_b32 v25, v3 offset:15316
    ds_read_b32 v40, v3 offset:15840
    ds_read_b32 v57, v3 offset:15844
    ds_read_b32 v28, v3 offset:16368
    ds_read_b32 v53, v3 offset:16372
    s_waitcnt lgkmcnt(0)
    v_sub_f32 v24, v20, v83
    v_sub_f32 v75, v17, v59
    v_add_f32 v20, v20, v83
    v_add_f32 v17, v17, v59
    v_sub_f32 v83, v82, v72
    v_sub_f32 v59, v79, v43
    v_add_f32 v82, v82, v72
    v_add_f32 v79, v79, v43
    v_mul_f32 v72, 0x3f7b14be, v83
    v_mul_f32 v43, 0x3e47c5c2, v83
    v_fmac_f32 v72, 0xbe47c5c2, v59
    v_fmac_f32 v43, 0x3f7b14be, v59
    v_sub_f32 v83, v70, v54
    v_sub_f32 v59, v81, v27
    v_add_f32 v70, v70, v54
    v_add_f32 v81, v81, v27
    v_mul_f32 v54, 0x3f6c835e, v83
    v_mul_f32 v27, 0x3ec3ef15, v83
    v_fmac_f32 v54, 0xbec3ef15, v59
    v_fmac_f32 v27, 0x3f6c835e, v59
    v_sub_f32 v83, v32, v48
    v_sub_f32 v59, v41, v65
    v_add_f32 v32, v32, v48
    v_add_f32 v41, v41, v65
    v_mul_f32 v48, 0x3f54db31, v83
    v_mul_f32 v65, 0x3f0e39da, v83
    v_fmac_f32 v48, 0xbf0e39da, v59
    v_fmac_f32 v65, 0x3f54db31, v59
    v_sub_f32 v83, v38, v60
    v_sub_f32 v59, v45, v19
    v_add_f32 v38, v38, v60
    v_add_f32 v45, v45, v19
    v_mul_f32 v60, 0x3f3504f3, v83
    v_mul_f32 v19, 0x3f3504f3, v83
    v_fmac_f32 v60, 0xbf3504f3, v59
    v_fmac_f32 v19, 0x3f3504f3, v59
    v_sub_f32 v83, v78, v16
    v_sub_f32 v59, v63, v73
    v_add_f32 v78, v78, v16
    v_add_f32 v63, v63, v73
    v_mul_f32 v16, 0x3f0e39da, v83
    v_mul_f32 v73, 0x3f54db31, v83
    v_fmac_f32 v16, 0xbf54db31, v59
    v_fmac_f32 v73, 0x3f0e39da, v59
    v_sub_f32 v83, v36, v34
    v_sub_f32 v59, v29, v61
    v_add_f32 v36, v36, v34
    v_add_f32 v29, v29, v61
    v_mul_f32 v34, 0x3ec3ef15, v83
    v_mul_f32 v61, 0x3f6c835e, v83
    v_fmac_f32 v34, 0xbf6c835e, v59
    v_fmac_f32 v61, 0x3ec3ef15, v59
    v_sub_f32 v83, v62, v52
    v_sub_f32 v59, v31, v47
    v_add_f32 v62, v62, v52
    v_add_f32 v31, v31, v47
    v_mul_f32 v52, 0x3e47c5c2, v83
    v_mul_f32 v47, 0x3f7b14be, v83
    v_fmac_f32 v52, 0xbf7b14be, v59
    v_fmac_f32 v47, 0x3e47c5c2, v59
    v_sub_f32 v83, v49, v55
    v_sub_f32 v59, v56, v50
    v_add_f32 v56, v56, v50
    v_add_f32 v55, v55, v49
    v_sub_f32 v50, v18, v26
    v_sub_f32 v49, v67, v77
    v_add_f32 v18, v18, v26
    v_add_f32 v67, v67, v77
    v_mul_f32 v26, 0xbe47c5c2, v50
    v_mul_f32 v77, 0x3f7b14be, v50
    v_fmac_f32 v26, 0xbf7b14be, v49
    v_fmac_f32 v77, 0xbe47c5c2, v49
    v_sub_f32 v50, v64, v30
    v_sub_f32 v49, v37, v71
    v_add_f32 v64, v64, v30
    v_add_f32 v37, v37, v71
    v_mul_f32 v30, 0xbec3ef15, v50
    v_mul_f32 v71, 0x3f6c835e, v50
    v_fmac_f32 v30, 0xbf6c835e, v49
    v_fmac_f32 v71, 0xbec3ef15, v49
    v_sub_f32 v50, v66, v44
    v_sub_f32 v49, v35, v33
    v_add_f32 v66, v66, v44
    v_add_f32 v35, v35, v33
    v_mul_f32 v44, 0xbf0e39da, v50
    v_mul_f32 v33, 0x3f54db31, v50
    v_fmac_f32 v44, 0xbf54db31, v49
    v_fmac_f32 v33, 0xbf0e39da, v49
    v_sub_f32 v50, v80, v46
    v_sub_f32 v49, v23, v39
    v_add_f32 v80, v80, v46
    v_add_f32 v23, v23, v39
    v_mul_f32 v46, 0xbf3504f3, v50
    v_mul_f32 v39, 0x3f3504f3, v50
    v_fmac_f32 v46, 0xbf3504f3, v49
    v_fmac_f32 v39, 0xbf3504f3, v49
    v_sub_f32 v50, v74, v68
    v_sub_f32 v49, v21, v25
    v_add_f32 v74, v74, v68
    v_add_f32 v21, v21, v25
    v_mul_f32 v68, 0xbf54db31, v50
    v_mul_f32 v25, 0x3f0e39da, v50
    v_fmac_f32 v68, 0xbf0e39da, v49
    v_fmac_f32 v25, 0xbf54db31, v49
    v_sub_f32 v50, v42, v40
    v_sub_f32 v49, v69, v57
    v_add_f32 v42, v42, v40
    v_add_f32 v69, v69, v57
    v_mul_f32 v40, 0xbf6c835e, v50
    v_mul_f32 v57, 0x3ec3ef15, v50
    v_fmac_f32 v40, 0xbec3ef15, v49
    v_fmac_f32 v57, 0xbf6c835e, v49
    v_sub_f32 v50, v58, v28
    v_sub_f32 v49, v51, v53
    v_add_f32 v58, v58, v28
    v_add_f32 v51, v51, v53
    v_mul_f32 v28, 0xbf7b14be, v50
    v_mul_f32 v53, 0x3e47c5c2, v50
    v_fmac_f32 v28, 0xbe47c5c2, v49
    v_fmac_f32 v53, 0xbf7b14be, v49
    v_sub_f32 v50, v20, v56
    v_sub_f32 v49, v17, v55
    v_add_f32 v20, v20, v56
    v_add_f32 v17, v17, v55
    v_sub_f32 v56, v82, v18
    v_sub_f32 v55, v79, v67
    v_add_f32 v82, v82, v18
    v_add_f32 v79, v79, v67
    v_mul_f32 v18, 0x3f6c835e, v56
    v_mul_f32 v67, 0x3ec3ef15, v56
    v_fmac_f32 v18, 0xbec3ef15, v55
    v_fmac_f32 v67, 0x3f6c835e, v55
    v_sub_f32 v56, v70, v64
    v_sub_f32 v55, v81, v37
    v_add_f32 v70, v70, v64
    v_add_f32 v81, v81, v37
    v_mul_f32 v64, 0x3f3504f3, v56
    v_mul_f32 v37, 0x3f3504f3, v56
    v_fmac_f32 v64, 0xbf3504f3, v55
    v_fmac_f32 v37, 0x3f3504f3, v55
    v_sub_f32 v56, v32, v66
    v_sub_f32 v55, v41, v35
    v_add_f32 v32, v32, v66
    v_add_f32 v41, v41, v35
    v_mul_f32 v66, 0x3ec3ef15, v56
    v_mul_f32 v35, 0x3f6c835e, v56
    v_fmac_f32 v66, 0xbf6c835e, v55
    v_fmac_f32 v35, 0x3ec3ef15, v55
    v_sub_f32 v56, v23, v45
    v_sub_f32 v55, v38, v80
    v_add_f32 v38, v38, v80
    v_add_f32 v45, v45, v23
    v_sub_f32 v80, v78, v74
    v_sub_f32 v23, v63, v21
    v_add_f32 v78, v78, v74
    v_add_f32 v63, v63, v21
    v_mul_f32 v74, 0xbec3ef15, v80
    v_mul_f32 v21, 0x3f6c835e, v80
    v_fmac_f32 v74, 0xbf6c835e, v23
    v_fmac_f32 v21, 0xbec3ef15, v23
    v_sub_f32 v80, v36, v42
    v_sub_f32 v23, v29, v69
    v_add_f32 v36, v36, v42
    v_add_f32 v29, v29, v69
    v_mul_f32 v42, 0xbf3504f3, v80
    v_mul_f32 v69, 0x3f3504f3, v80
    v_fmac_f32 v42, 0xbf3504f3, v23
    v_fmac_f32 v69, 0xbf3504f3, v23
    v_sub_f32 v80, v62, v58
    v_sub_f32 v23, v31, v51
    v_add_f32 v62, v62, v58
    v_add_f32 v31, v31, v51
    v_mul_f32 v58, 0xbf6c835e, v80
    v_mul_f32 v51, 0x3ec3ef15, v80
    v_fmac_f32 v58, 0xbec3ef15, v23
    v_fmac_f32 v51, 0xbf6c835e, v23
    v_sub_f32 v80, v24, v83
    v_sub_f32 v23, v75, v59
    v_add_f32 v24, v24, v83
    v_add_f32 v75, v75, v59
    v_sub_f32 v83, v72, v26
    v_sub_f32 v59, v43, v77
    v_add_f32 v72, v72, v26
    v_add_f32 v43, v43, v77
    v_mul_f32 v26, 0x3f6c835e, v83
    v_mul_f32 v77, 0x3ec3ef15, v83
    v_fmac_f32 v26, 0xbec3ef15, v59
    v_fmac_f32 v77, 0x3f6c835e, v59
    v_sub_f32 v83, v54, v30
    v_sub_f32 v59, v27, v71
    v_add_f32 v54, v54, v30
    v_add_f32 v27, v27, v71
    v_mul_f32 v30, 0x3f3504f3, v83
    v_mul_f32 v71, 0x3f3504f3, v83
    v_fmac_f32 v30, 0xbf3504f3, v59
    v_fmac_f32 v71, 0x3f3504f3, v59
    v_sub_f32 v83, v48, v44
    v_sub_f32 v59, v65, v33
    v_add_f32 v48, v48, v44
    v_add_f32 v65, v65, v33
    v_mul_f32 v44, 0x3ec3ef15, v83
    v_mul_f32 v33, 0x3f6c835e, v83
    v_fmac_f32 v44, 0xbf6c835e, v59
    v_fmac_f32 v33, 0x3ec3ef15, v59
    v_sub_f32 v83, v39, v19
    v_sub_f32 v59, v60, v46
    v_add_f32 v60, v60, v46
    v_add_f32 v19, v19, v39
    v_sub_f32 v46, v16, v68
    v_sub_f32 v39, v73, v25
    v_add_f32 v16, v16, v68
    v_add_f32 v73, v73, v25
    v_mul_f32 v68, 0xbec3ef15, v46
    v_mul_f32 v25, 0x3f6c835e, v46
    v_fmac_f32 v68, 0xbf6c835e, v39
    v_fmac_f32 v25, 0xbec3ef15, v39
    v_sub_f32 v46, v34, v40
    v_sub_f32 v39, v61, v57
    v_add_f32 v34, v34, v40
    v_add_f32 v61, v61, v57
    v_mul_f32 v40, 0xbf3504f3, v46
    v_mul_f32 v57, 0x3f3504f3, v46
    v_fmac_f32 v40, 0xbf3504f3, v39
    v_fmac_f32 v57, 0xbf3504f3, v39
    v_sub_f32 v46, v52, v28
    v_sub_f32 v39, v47, v53
    v_add_f32 v52, v52, v28
    v_add_f32 v47, v47, v53
    v_mul_f32 v28, 0xbf6c835e, v46
    v_mul_f32 v53, 0x3ec3ef15, v46
    v_fmac_f32 v28, 0xbec3ef15, v39
    v_fmac_f32 v53, 0xbf6c835e, v39
    v_sub_f32 v46, v20, v38
    v_sub_f32 v39, v17, v45
    v_add_f32 v20, v20, v38
    v_add_f32 v17, v17, v45
    v_sub_f32 v38, v82, v78
    v_sub_f32 v45, v79, v63
    v_add_f32 v82, v82, v78
    v_add_f32 v79, v79, v63
    v_mul_f32 v78, 0x3f3504f3, v38
    v_mul_f32 v63, 0x3f3504f3, v38
    v_fmac_f32 v78, 0xbf3504f3, v45
    v_fmac_f32 v63, 0x3f3504f3, v45
    v_sub_f32 v38, v29, v81
    v_sub_f32 v45, v70, v36
    v_add_f32 v70, v70, v36
    v_add_f32 v81, v81, v29
    v_sub_f32 v36, v32, v62
    v_sub_f32 v29, v41, v31
    v_add_f32 v32, v32, v62
    v_add_f32 v41, v41, v31
    v_mul_f32 v62, 0xbf3504f3, v36
    v_mul_f32 v31, 0x3f3504f3, v36
    v_fmac_f32 v62, 0xbf3504f3, v29
    v_fmac_f32 v31, 0xbf3504f3, v29
    v_sub_f32 v36, v50, v56
    v_sub_f32 v29, v49, v55
    v_add_f32 v50, v50, v56
    v_add_f32 v49, v49, v55
    v_sub_f32 v56, v18, v74
    v_sub_f32 v55, v67, v21
    v_add_f32 v18, v18, v74
    v_add_f32 v67, v67, v21
    v_mul_f32 v74, 0x3f3504f3, v56
    v_mul_f32 v21, 0x3f3504f3, v56
    v_fmac_f32 v74, 0xbf3504f3, v55
    v_fmac_f32 v21, 0x3f3504f3, v55
    v_sub_f32 v56, v69, v37
    v_sub_f32 v55, v64, v42
    v_add_f32 v64, v64, v42
    v_add_f32 v37, v37, v69
    v_sub_f32 v42, v66, v58
    v_sub_f32 v69, v35, v51
    v_add_f32 v66, v66, v58
    v_add_f32 v35, v35, v51
    v_mul_f32 v58, 0xbf3504f3, v42
    v_mul_f32 v51, 0x3f3504f3, v42
    v_fmac_f32 v58, 0xbf3504f3, v69
    v_fmac_f32 v51, 0xbf3504f3, v69
    v_sub_f32 v42, v24, v60
    v_sub_f32 v69, v75, v19
    v_add_f32 v24, v24, v60
    v_add_f32 v75, v75, v19
    v_sub_f32 v60, v72, v16
    v_sub_f32 v19, v43, v73
    v_add_f32 v72, v72, v16
    v_add_f32 v43, v43, v73
    v_mul_f32 v16, 0x3f3504f3, v60
    v_mul_f32 v73, 0x3f3504f3, v60
    v_fmac_f32 v16, 0xbf3504f3, v19
    v_fmac_f32 v73, 0x3f3504f3, v19
    v_sub_f32 v60, v61, v27
    v_sub_f32 v19, v54, v34
    v_add_f32 v54, v54, v34
    v_add_f32 v27, v27, v61
    v_sub_f32 v34, v48, v52
    v_sub_f32 v61, v65, v47
    v_add_f32 v48, v48, v52
    v_add_f32 v65, v65, v47
    v_mul_f32 v52, 0xbf3504f3, v34
    v_mul_f32 v47, 0x3f3504f3, v34
    v_fmac_f32 v52, 0xbf3504f3, v61
    v_fmac_f32 v47, 0xbf3504f3, v61
    v_sub_f32 v34, v80, v83
    v_sub_f32 v61, v23, v59
    v_add_f32 v80, v80, v83
    v_add_f32 v23, v23, v59
    v_sub_f32 v83, v26, v68
    v_sub_f32 v59, v77, v25
    v_add_f32 v26, v26, v68
    v_add_f32 v77, v77, v25
    v_mul_f32 v68, 0x3f3504f3, v83
    v_mul_f32 v25, 0x3f3504f3, v83
    v_fmac_f32 v68, 0xbf3504f3, v59
    v_fmac_f32 v25, 0x3f3504f3, v59
    v_sub_f32 v83, v57, v71
    v_sub_f32 v59, v30, v40
    v_add_f32 v30, v30, v40
    v_add_f32 v71, v71, v57
    v_sub_f32 v40, v44, v28
    v_sub_f32 v57, v33, v53
    v_add_f32 v44, v44, v28
    v_add_f32 v33, v33, v53
    v_mul_f32 v28, 0xbf3504f3, v40
    v_mul_f32 v53, 0x3f3504f3, v40
    v_fmac_f32 v28, 0xbf3504f3, v57
    v_fmac_f32 v53, 0xbf3504f3, v57
    v_sub_f32 v40, v20, v70
    v_sub_f32 v57, v17, v81
    v_add_f32 v20, v20, v70
    v_add_f32 v17, v17, v81
    v_sub_f32 v70, v41, v79
    v_sub_f32 v81, v82, v32
    v_add_f32 v82, v82, v32
    v_add_f32 v79, v79, v41
    v_sub_f32 v32, v46, v38
    v_sub_f32 v41, v39, v45
    v_add_f32 v46, v46, v38
    v_add_f32 v39, v39, v45
    v_sub_f32 v38, v31, v63
    v_sub_f32 v45, v78, v62
    v_add_f32 v78, v78, v62
    v_add_f32 v63, v63, v31
    v_sub_f32 v62, v50, v64
    v_sub_f32 v31, v49, v37
    v_add_f32 v50, v50, v64
    v_add_f32 v49, v49, v37
    v_sub_f32 v64, v35, v67
    v_sub_f32 v37, v18, v66
    v_add_f32 v18, v18, v66
    v_add_f32 v67, v67, v35
    v_sub_f32 v66, v36, v56
    v_sub_f32 v35, v29, v55
    v_add_f32 v36, v36, v56
    v_add_f32 v29, v29, v55
    v_sub_f32 v56, v51, v21
    v_sub_f32 v55, v74, v58
    v_add_f32 v74, v74, v58
    v_add_f32 v21, v21, v51
    v_sub_f32 v58, v24, v54
    v_sub_f32 v51, v75, v27
    v_add_f32 v24, v24, v54
    v_add_f32 v75, v75, v27
    v_sub_f32 v54, v65, v43
    v_sub_f32 v27, v72, v48
    v_add_f32 v72, v72, v48
    v_add_f32 v43, v43, v65
    v_sub_f32 v48, v42, v60
    v_sub_f32 v65, v69, v19
    v_add_f32 v42, v42, v60
    v_add_f32 v69, v69, v19
    v_sub_f32 v60, v47, v73
    v_sub_f32 v19, v16, v52
    v_add_f32 v16, v16, v52
    v_add_f32 v73, v73, v47
    v_sub_f32 v52, v80, v30
    v_sub_f32 v47, v23, v71
    v_add_f32 v80, v80, v30
    v_add_f32 v23, v23, v71
    v_sub_f32 v30, v33, v77
    v_sub_f32 v71, v26, v44
    v_add_f32 v26, v26, v44
    v_add_f32 v77, v77, v33
    v_sub_f32 v44, v34, v83
    v_sub_f32 v33, v61, v59
    v_add_f32 v34, v34, v83
    v_add_f32 v61, v61, v59
    v_sub_f32 v83, v53, v25
    v_sub_f32 v59, v68, v28
    v_add_f32 v68, v68, v28
    v_add_f32 v25, v25, v53
    v_sub_f32 v28, v20, v82
    v_sub_f32 v53, v17, v79
    v_add_f32 v20, v20, v82
    v_add_f32 v17, v17, v79
    v_sub_f32 v82, v40, v70
    v_sub_f32 v79, v57, v81
    v_add_f32 v40, v40, v70
    v_add_f32 v57, v57, v81
    v_sub_f32 v70, v46, v78
    v_sub_f32 v81, v39, v63
    v_add_f32 v46, v46, v78
    v_add_f32 v39, v39, v63
    v_sub_f32 v78, v32, v38
    v_sub_f32 v63, v41, v45
    v_add_f32 v32, v32, v38
    v_add_f32 v41, v41, v45
    v_sub_f32 v38, v50, v18
    v_sub_f32 v45, v49, v67
    v_add_f32 v50, v50, v18
    v_add_f32 v49, v49, v67
    v_sub_f32 v18, v62, v64
    v_sub_f32 v67, v31, v37
    v_add_f32 v62, v62, v64
    v_add_f32 v31, v31, v37
    v_sub_f32 v64, v36, v74
    v_sub_f32 v37, v29, v21
    v_add_f32 v36, v36, v74
    v_add_f32 v29, v29, v21
    v_sub_f32 v74, v66, v56
    v_sub_f32 v21, v35, v55
    v_add_f32 v66, v66, v56
    v_add_f32 v35, v35, v55
    v_sub_f32 v56, v24, v72
    v_sub_f32 v55, v75, v43
    v_add_f32 v24, v24, v72
    v_add_f32 v75, v75, v43
    v_sub_f32 v72, v58, v54
    v_sub_f32 v43, v51, v27
    v_add_f32 v58, v58, v54
    v_add_f32 v51, v51, v27
    v_sub_f32 v54, v42, v16
    v_sub_f32 v27, v69, v73
    v_add_f32 v42, v42, v16
    v_add_f32 v69, v69, v73
    v_sub_f32 v16, v48, v60
    v_sub_f32 v73, v65, v19
    v_add_f32 v48, v48, v60
    v_add_f32 v65, v65, v19
    v_sub_f32 v60, v80, v26
    v_sub_f32 v19, v23, v77
    v_add_f32 v80, v80, v26
    v_add_f32 v23, v23, v77
    v_sub_f32 v26, v52, v30
    v_sub_f32 v77, v47, v71
    v_add_f32 v52, v52, v30
    v_add_f32 v47, v47, v71
    v_sub_f32 v30, v34, v68
    v_sub_f32 v71, v61, v25
    v_add_f32 v34, v34, v68
    v_add_f32 v61, v61, v25
    v_sub_f32 v68, v44, v83
    v_sub_f32 v25, v33, v59
    v_add_f32 v44, v44, v83
    v_add_f32 v33, v33, v59
    s_add_u32 s15, s14, 109051904
    v_lshlrev_b32 v5, 3, v1
    s_add_u32 s16, s15, 0
    v_mov_b32 v88, v20
    v_mov_b32 v89, v17
    buffer_store_dwordx2 v[88:89], v5, s[8:11], s16 offen sc1
    s_add_u32 s16, s15, 512
    v_mov_b32 v90, v24
    v_mov_b32 v91, v75
    buffer_store_dwordx2 v[90:91], v5, s[8:11], s16 offen sc1
    s_add_u32 s16, s15, 1024
    v_mov_b32 v92, v50
    v_mov_b32 v93, v49
    buffer_store_dwordx2 v[92:93], v5, s[8:11], s16 offen sc1
    s_add_u32 s16, s15, 1536
    v_mov_b32 v94, v80
    v_mov_b32 v95, v23
    buffer_store_dwordx2 v[94:95], v5, s[8:11], s16 offen sc1
    s_add_u32 s16, s15, 2048
    v_mov_b32 v96, v46
    v_mov_b32 v97, v39
    buffer_store_dwordx2 v[96:97], v5, s[8:11], s16 offen sc1
    s_add_u32 s16, s15, 2560
    v_mov_b32 v98, v42
    v_mov_b32 v99, v69
    buffer_store_dwordx2 v[98:99], v5, s[8:11], s16 offen sc1
    s_add_u32 s16, s15, 3072
    v_mov_b32 v100, v36
    v_mov_b32 v101, v29
    buffer_store_dwordx2 v[100:101], v5, s[8:11], s16 offen sc1
    s_add_u32 s16, s15, 3584
    v_mov_b32 v102, v34
    v_mov_b32 v103, v61
    buffer_store_dwordx2 v[102:103], v5, s[8:11], s16 offen sc1
    s_add_u32 s16, s15, 4096
    v_mov_b32 v88, v40
    v_mov_b32 v89, v57
    buffer_store_dwordx2 v[88:89], v5, s[8:11], s16 offen sc1
    s_add_u32 s16, s15, 4608
    v_mov_b32 v90, v58
    v_mov_b32 v91, v51
    buffer_store_dwordx2 v[90:91], v5, s[8:11], s16 offen sc1
    s_add_u32 s16, s15, 5120
    v_mov_b32 v92, v62
    v_mov_b32 v93, v31
    buffer_store_dwordx2 v[92:93], v5, s[8:11], s16 offen sc1
    s_add_u32 s16, s15, 5632
    v_mov_b32 v94, v52
    v_mov_b32 v95, v47
    buffer_store_dwordx2 v[94:95], v5, s[8:11], s16 offen sc1
    s_add_u32 s16, s15, 6144
    v_mov_b32 v96, v32
    v_mov_b32 v97, v41
    buffer_store_dwordx2 v[96:97], v5, s[8:11], s16 offen sc1
    s_add_u32 s16, s15, 6656
    v_mov_b32 v98, v48
    v_mov_b32 v99, v65
    buffer_store_dwordx2 v[98:99], v5, s[8:11], s16 offen sc1
    s_add_u32 s16, s15, 7168
    v_mov_b32 v100, v66
    v_mov_b32 v101, v35
    buffer_store_dwordx2 v[100:101], v5, s[8:11], s16 offen sc1
    s_add_u32 s16, s15, 7680
    v_mov_b32 v102, v44
    v_mov_b32 v103, v33
    buffer_store_dwordx2 v[102:103], v5, s[8:11], s16 offen sc1
    s_add_u32 s16, s15, 8192
    v_mov_b32 v88, v28
    v_mov_b32 v89, v53
    buffer_store_dwordx2 v[88:89], v5, s[8:11], s16 offen sc1
    s_add_u32 s16, s15, 8704
    v_mov_b32 v90, v56
    v_mov_b32 v91, v55
    buffer_store_dwordx2 v[90:91], v5, s[8:11], s16 offen sc1
    s_add_u32 s16, s15, 9216
    v_mov_b32 v92, v38
    v_mov_b32 v93, v45
    buffer_store_dwordx2 v[92:93], v5, s[8:11], s16 offen sc1
    s_add_u32 s16, s15, 9728
    v_mov_b32 v94, v60
    v_mov_b32 v95, v19
    buffer_store_dwordx2 v[94:95], v5, s[8:11], s16 offen sc1
    s_add_u32 s16, s15, 10240
    v_mov_b32 v96, v70
    v_mov_b32 v97, v81
    buffer_store_dwordx2 v[96:97], v5, s[8:11], s16 offen sc1
    s_add_u32 s16, s15, 10752
    v_mov_b32 v98, v54
    v_mov_b32 v99, v27
    buffer_store_dwordx2 v[98:99], v5, s[8:11], s16 offen sc1
    s_add_u32 s16, s15, 11264
    v_mov_b32 v100, v64
    v_mov_b32 v101, v37
    buffer_store_dwordx2 v[100:101], v5, s[8:11], s16 offen sc1
    s_add_u32 s16, s15, 11776
    v_mov_b32 v102, v30
    v_mov_b32 v103, v71
    buffer_store_dwordx2 v[102:103], v5, s[8:11], s16 offen sc1
    s_add_u32 s16, s15, 12288
    v_mov_b32 v88, v82
    v_mov_b32 v89, v79
    buffer_store_dwordx2 v[88:89], v5, s[8:11], s16 offen sc1
    s_add_u32 s16, s15, 12800
    v_mov_b32 v90, v72
    v_mov_b32 v91, v43
    buffer_store_dwordx2 v[90:91], v5, s[8:11], s16 offen sc1
    s_add_u32 s16, s15, 13312
    v_mov_b32 v92, v18
    v_mov_b32 v93, v67
    buffer_store_dwordx2 v[92:93], v5, s[8:11], s16 offen sc1
    s_add_u32 s16, s15, 13824
    v_mov_b32 v94, v26
    v_mov_b32 v95, v77
    buffer_store_dwordx2 v[94:95], v5, s[8:11], s16 offen sc1
    s_add_u32 s16, s15, 14336
    v_mov_b32 v96, v78
    v_mov_b32 v97, v63
    buffer_store_dwordx2 v[96:97], v5, s[8:11], s16 offen sc1
    s_add_u32 s16, s15, 14848
    v_mov_b32 v98, v16
    v_mov_b32 v99, v73
    buffer_store_dwordx2 v[98:99], v5, s[8:11], s16 offen sc1
    s_add_u32 s16, s15, 15360
    v_mov_b32 v100, v74
    v_mov_b32 v101, v21
    buffer_store_dwordx2 v[100:101], v5, s[8:11], s16 offen sc1
    s_add_u32 s16, s15, 15872
    v_mov_b32 v102, v68
    v_mov_b32 v103, v25
    buffer_store_dwordx2 v[102:103], v5, s[8:11], s16 offen sc1
mega_kernel_f2_end:
    s_cmp_eq_u32 s99, 128
    s_cbranch_scc1 mega_kernel_f2ret
    s_waitcnt vmcnt(0)
    s_barrier
    v_mov_b32 v2, 1
    v_cmp_eq_u32 vcc, 0, v0
    s_and_saveexec_b64 s[80:81], vcc
    s_cbranch_execz mega_kernel_sg136_5
    buffer_atomic_add v2, off, s[88:91], 0 offset:136 sc1
mega_kernel_sg136_5:
    s_mov_b64 exec, s[80:81]
    s_waitcnt vmcnt(0)
    ds_read_b64_tr_b16 a[128:129], v201 offset:0
    ds_read_b64_tr_b16 a[130:131], v201 offset:256
    ds_read_b64_tr_b16 a[132:133], v201 offset:1024
    ds_read_b64_tr_b16 a[134:135], v201 offset:1280
    ds_read_b64_tr_b16 a[136:137], v201 offset:2048
    ds_read_b64_tr_b16 a[138:139], v201 offset:2304
    ds_read_b64_tr_b16 a[140:141], v201 offset:3072
    ds_read_b64_tr_b16 a[142:143], v201 offset:3328
    s_waitcnt lgkmcnt(0)
    ds_read_b64_tr_b16 a[144:145], v201 offset:4096
    ds_read_b64_tr_b16 a[146:147], v201 offset:4352
    ds_read_b64_tr_b16 a[148:149], v201 offset:5120
    ds_read_b64_tr_b16 a[150:151], v201 offset:5376
    ds_read_b64_tr_b16 a[152:153], v201 offset:6144
    ds_read_b64_tr_b16 a[154:155], v201 offset:6400
    ds_read_b64_tr_b16 a[156:157], v201 offset:7168
    ds_read_b64_tr_b16 a[158:159], v201 offset:7424
    s_waitcnt lgkmcnt(0)
    ds_read_b64_tr_b16 a[160:161], v201 offset:8192
    ds_read_b64_tr_b16 a[162:163], v201 offset:8448
    ds_read_b64_tr_b16 a[164:165], v201 offset:9216
    ds_read_b64_tr_b16 a[166:167], v201 offset:9472
    ds_read_b64_tr_b16 a[168:169], v201 offset:10240
    ds_read_b64_tr_b16 a[170:171], v201 offset:10496
    ds_read_b64_tr_b16 a[172:173], v201 offset:11264
    ds_read_b64_tr_b16 a[174:175], v201 offset:11520
    s_waitcnt lgkmcnt(0)
    ds_read_b64_tr_b16 a[176:177], v201 offset:12288
    ds_read_b64_tr_b16 a[178:179], v201 offset:12544
    ds_read_b64_tr_b16 a[180:181], v201 offset:13312
    ds_read_b64_tr_b16 a[182:183], v201 offset:13568
    ds_read_b64_tr_b16 a[184:185], v201 offset:14336
    ds_read_b64_tr_b16 a[186:187], v201 offset:14592
    ds_read_b64_tr_b16 a[188:189], v201 offset:15360
    ds_read_b64_tr_b16 a[190:191], v201 offset:15616
    s_waitcnt lgkmcnt(0)
    s_add_u32 m0, s56, 0
    s_add_u32 s58, s57, 49152
    s_and_b32 s58, s58, 0xffff
    s_lshl_b32 s58, s58, 5
    buffer_load_dwordx4 v200, s[52:55], s58 offen lds
    s_add_u32 m0, s56, 1024
    s_add_u32 s58, s57, 50176
    s_and_b32 s58, s58, 0xffff
    s_lshl_b32 s58, s58, 5
    buffer_load_dwordx4 v200, s[52:55], s58 offen lds
    s_add_u32 m0, s56, 2048
    s_add_u32 s58, s57, 51200
    s_and_b32 s58, s58, 0xffff
    s_lshl_b32 s58, s58, 5
    buffer_load_dwordx4 v200, s[52:55], s58 offen lds
    s_add_u32 m0, s56, 3072
    s_add_u32 s58, s57, 52224
    s_and_b32 s58, s58, 0xffff
    s_lshl_b32 s58, s58, 5
    buffer_load_dwordx4 v200, s[52:55], s58 offen lds
    s_add_u32 m0, s56, 4096
    s_add_u32 s58, s57, 53248
    s_and_b32 s58, s58, 0xffff
    s_lshl_b32 s58, s58, 5
    buffer_load_dwordx4 v200, s[52:55], s58 offen lds
    s_add_u32 m0, s56, 5120
    s_add_u32 s58, s57, 54272
    s_and_b32 s58, s58, 0xffff
    s_lshl_b32 s58, s58, 5
    buffer_load_dwordx4 v200, s[52:55], s58 offen lds
    s_add_u32 m0, s56, 6144
    s_add_u32 s58, s57, 55296
    s_and_b32 s58, s58, 0xffff
    s_lshl_b32 s58, s58, 5
    buffer_load_dwordx4 v200, s[52:55], s58 offen lds
    s_add_u32 m0, s56, 7168
    s_add_u32 s58, s57, 56320
    s_and_b32 s58, s58, 0xffff
    s_lshl_b32 s58, s58, 5
    buffer_load_dwordx4 v200, s[52:55], s58 offen lds
    s_add_u32 m0, s56, 8192
    s_add_u32 s58, s57, 57344
    s_and_b32 s58, s58, 0xffff
    s_lshl_b32 s58, s58, 5
    buffer_load_dwordx4 v200, s[52:55], s58 offen lds
    s_add_u32 m0, s56, 9216
    s_add_u32 s58, s57, 58368
    s_and_b32 s58, s58, 0xffff
    s_lshl_b32 s58, s58, 5
    buffer_load_dwordx4 v200, s[52:55], s58 offen lds
    s_add_u32 m0, s56, 10240
    s_add_u32 s58, s57, 59392
    s_and_b32 s58, s58, 0xffff
    s_lshl_b32 s58, s58, 5
    buffer_load_dwordx4 v200, s[52:55], s58 offen lds
    s_add_u32 m0, s56, 11264
    s_add_u32 s58, s57, 60416
    s_and_b32 s58, s58, 0xffff
    s_lshl_b32 s58, s58, 5
    buffer_load_dwordx4 v200, s[52:55], s58 offen lds
    s_add_u32 m0, s56, 12288
    s_add_u32 s58, s57, 61440
    s_and_b32 s58, s58, 0xffff
    s_lshl_b32 s58, s58, 5
    buffer_load_dwordx4 v200, s[52:55], s58 offen lds
    s_add_u32 m0, s56, 13312
    s_add_u32 s58, s57, 62464
    s_and_b32 s58, s58, 0xffff
    s_lshl_b32 s58, s58, 5
    buffer_load_dwordx4 v200, s[52:55], s58 offen lds
    s_add_u32 m0, s56, 14336
    s_add_u32 s58, s57, 63488
    s_and_b32 s58, s58, 0xffff
    s_lshl_b32 s58, s58, 5
    buffer_load_dwordx4 v200, s[52:55], s58 offen lds
    s_add_u32 m0, s56, 15360
    s_add_u32 s58, s57, 64512
    s_and_b32 s58, s58, 0xffff
    s_lshl_b32 s58, s58, 5
    buffer_load_dwordx4 v200, s[52:55], s58 offen lds
mega_kernel_wf2:
    s_sleep 8
    buffer_load_dword v2, off, s[88:91], 0 offset:136 sc1
    s_waitcnt vmcnt(0)
    v_cmp_ne_u32 vcc, 129, v2
    s_cbranch_vccnz mega_kernel_wf2
    s_barrier
    s_load_dwordx2 s[4:5], s[0:1], 80
    s_load_dwordx2 s[8:9], s[0:1], 96
    v_and_b32 v6, 7, v0
    v_lshrrev_b32 v7, 3, v0
    s_movk_i32 s13, 8448
    v_mul_lo_u32 v8, v6, s13
    v_lshl_add_u32 v4, v7, 3, v8
    v_lshlrev_b32 v5, 14, v7
    v_lshl_add_u32 v5, v6, 4, v5
    s_lshl_b32 s12, s92, 7
    s_add_u32 s12, s12, 109051904
    s_waitcnt lgkmcnt(0)
    s_mov_b32 s6, 8388608
    s_mov_b32 s7, 0x00020000
    s_mov_b32 s10, 268435456
    s_mov_b32 s11, 0x00020000
    s_add_u32 s13, s12, 0
    buffer_load_dwordx4 v[16:19], v5, s[8:11], s13 offen
    s_add_u32 s13, s12, 524288
    buffer_load_dwordx4 v[20:23], v5, s[8:11], s13 offen
    s_add_u32 s13, s12, 1048576
    buffer_load_dwordx4 v[24:27], v5, s[8:11], s13 offen
    s_add_u32 s13, s12, 1572864
    buffer_load_dwordx4 v[28:31], v5, s[8:11], s13 offen
    s_add_u32 s13, s12, 2097152
    buffer_load_dwordx4 v[32:35], v5, s[8:11], s13 offen
    s_add_u32 s13, s12, 2621440
    buffer_load_dwordx4 v[36:39], v5, s[8:11], s13 offen
    s_add_u32 s13, s12, 3145728
    buffer_load_dwordx4 v[40:43], v5, s[8:11], s13 offen
    s_add_u32 s13, s12, 3670016
    buffer_load_dwordx4 v[44:47], v5, s[8:11], s13 offen
    s_add_u32 s13, s12, 4194304
    buffer_load_dwordx4 v[48:51], v5, s[8:11], s13 offen
    s_add_u32 s13, s12, 4718592
    buffer_load_dwordx4 v[52:55], v5, s[8:11], s13 offen
    s_add_u32 s13, s12, 5242880
    buffer_load_dwordx4 v[56:59], v5, s[8:11], s13 offen
    s_add_u32 s13, s12, 5767168
    buffer_load_dwordx4 v[60:63], v5, s[8:11], s13 offen
    s_add_u32 s13, s12, 6291456
    buffer_load_dwordx4 v[64:67], v5, s[8:11], s13 offen
    s_add_u32 s13, s12, 6815744
    buffer_load_dwordx4 v[68:71], v5, s[8:11], s13 offen
    s_add_u32 s13, s12, 7340032
    buffer_load_dwordx4 v[72:75], v5, s[8:11], s13 offen
    s_add_u32 s13, s12, 7864320
    buffer_load_dwordx4 v[76:79], v5, s[8:11], s13 offen
    s_add_u32 s13, s12, 8388608
    buffer_load_dwordx4 v[80:83], v5, s[8:11], s13 offen
    s_waitcnt vmcnt(0)
    v_cmp_eq_u32 vcc, 0, v7
    s_nop 1
    v_mov_b32 v9, 0
    v_cndmask_b32 v17, v17, v9, vcc
    v_cndmask_b32 v19, v19, v9, vcc
    v_cndmask_b32 v81, v81, v9, vcc
    v_cndmask_b32 v83, v83, v9, vcc
    v_sub_u32 v6, 1024, v7
    v_and_b32 v6, 1023, v6
    v_lshl_add_u32 v6, v6, 3, v8
    v_sub_f32 v10, v16, v19
    v_add_f32 v11, v17, v18
    v_add_f32 v12, v16, v19
    v_sub_f32 v13, v18, v17
    ds_write_b64 v4, v[10:11] offset:0
    ds_write_b64 v6, v[12:13]
    v_sub_u32 v6, 992, v7
    v_and_b32 v6, 1023, v6
    v_lshl_add_u32 v6, v6, 3, v8
    v_sub_f32 v10, v20, v23
    v_add_f32 v11, v21, v22
    v_add_f32 v12, v20, v23
    v_sub_f32 v13, v22, v21
    ds_write_b64 v4, v[10:11] offset:256
    ds_write_b64 v6, v[12:13]
    v_sub_u32 v6, 960, v7
    v_and_b32 v6, 1023, v6
    v_lshl_add_u32 v6, v6, 3, v8
    v_sub_f32 v10, v24, v27
    v_add_f32 v11, v25, v26
    v_add_f32 v12, v24, v27
    v_sub_f32 v13, v26, v25
    ds_write_b64 v4, v[10:11] offset:512
    ds_write_b64 v6, v[12:13]
    v_sub_u32 v6, 928, v7
    v_and_b32 v6, 1023, v6
    v_lshl_add_u32 v6, v6, 3, v8
    v_sub_f32 v10, v28, v31
    v_add_f32 v11, v29, v30
    v_add_f32 v12, v28, v31
    v_sub_f32 v13, v30, v29
    ds_write_b64 v4, v[10:11] offset:768
    ds_write_b64 v6, v[12:13]
    v_sub_u32 v6, 896, v7
    v_and_b32 v6, 1023, v6
    v_lshl_add_u32 v6, v6, 3, v8
    v_sub_f32 v10, v32, v35
    v_add_f32 v11, v33, v34
    v_add_f32 v12, v32, v35
    v_sub_f32 v13, v34, v33
    ds_write_b64 v4, v[10:11] offset:1024
    ds_write_b64 v6, v[12:13]
    v_sub_u32 v6, 864, v7
    v_and_b32 v6, 1023, v6
    v_lshl_add_u32 v6, v6, 3, v8
    v_sub_f32 v10, v36, v39
    v_add_f32 v11, v37, v38
    v_add_f32 v12, v36, v39
    v_sub_f32 v13, v38, v37
    ds_write_b64 v4, v[10:11] offset:1280
    ds_write_b64 v6, v[12:13]
    v_sub_u32 v6, 832, v7
    v_and_b32 v6, 1023, v6
    v_lshl_add_u32 v6, v6, 3, v8
    v_sub_f32 v10, v40, v43
    v_add_f32 v11, v41, v42
    v_add_f32 v12, v40, v43
    v_sub_f32 v13, v42, v41
    ds_write_b64 v4, v[10:11] offset:1536
    ds_write_b64 v6, v[12:13]
    v_sub_u32 v6, 800, v7
    v_and_b32 v6, 1023, v6
    v_lshl_add_u32 v6, v6, 3, v8
    v_sub_f32 v10, v44, v47
    v_add_f32 v11, v45, v46
    v_add_f32 v12, v44, v47
    v_sub_f32 v13, v46, v45
    ds_write_b64 v4, v[10:11] offset:1792
    ds_write_b64 v6, v[12:13]
    v_sub_u32 v6, 768, v7
    v_and_b32 v6, 1023, v6
    v_lshl_add_u32 v6, v6, 3, v8
    v_sub_f32 v10, v48, v51
    v_add_f32 v11, v49, v50
    v_add_f32 v12, v48, v51
    v_sub_f32 v13, v50, v49
    ds_write_b64 v4, v[10:11] offset:2048
    ds_write_b64 v6, v[12:13]
    v_sub_u32 v6, 736, v7
    v_and_b32 v6, 1023, v6
    v_lshl_add_u32 v6, v6, 3, v8
    v_sub_f32 v10, v52, v55
    v_add_f32 v11, v53, v54
    v_add_f32 v12, v52, v55
    v_sub_f32 v13, v54, v53
    ds_write_b64 v4, v[10:11] offset:2304
    ds_write_b64 v6, v[12:13]
    v_sub_u32 v6, 704, v7
    v_and_b32 v6, 1023, v6
    v_lshl_add_u32 v6, v6, 3, v8
    v_sub_f32 v10, v56, v59
    v_add_f32 v11, v57, v58
    v_add_f32 v12, v56, v59
    v_sub_f32 v13, v58, v57
    ds_write_b64 v4, v[10:11] offset:2560
    ds_write_b64 v6, v[12:13]
    v_sub_u32 v6, 672, v7
    v_and_b32 v6, 1023, v6
    v_lshl_add_u32 v6, v6, 3, v8
    v_sub_f32 v10, v60, v63
    v_add_f32 v11, v61, v62
    v_add_f32 v12, v60, v63
    v_sub_f32 v13, v62, v61
    ds_write_b64 v4, v[10:11] offset:2816
    ds_write_b64 v6, v[12:13]
    v_sub_u32 v6, 640, v7
    v_and_b32 v6, 1023, v6
    v_lshl_add_u32 v6, v6, 3, v8
    v_sub_f32 v10, v64, v67
    v_add_f32 v11, v65, v66
    v_add_f32 v12, v64, v67
    v_sub_f32 v13, v66, v65
    ds_write_b64 v4, v[10:11] offset:3072
    ds_write_b64 v6, v[12:13]
    v_sub_u32 v6, 608, v7
    v_and_b32 v6, 1023, v6
    v_lshl_add_u32 v6, v6, 3, v8
    v_sub_f32 v10, v68, v71
    v_add_f32 v11, v69, v70
    v_add_f32 v12, v68, v71
    v_sub_f32 v13, v70, v69
    ds_write_b64 v4, v[10:11] offset:3328
    ds_write_b64 v6, v[12:13]
    v_sub_u32 v6, 576, v7
    v_and_b32 v6, 1023, v6
    v_lshl_add_u32 v6, v6, 3, v8
    v_sub_f32 v10, v72, v75
    v_add_f32 v11, v73, v74
    v_add_f32 v12, v72, v75
    v_sub_f32 v13, v74, v73
    ds_write_b64 v4, v[10:11] offset:3584
    ds_write_b64 v6, v[12:13]
    v_sub_u32 v6, 544, v7
    v_and_b32 v6, 1023, v6
    v_lshl_add_u32 v6, v6, 3, v8
    v_sub_f32 v10, v76, v79
    v_add_f32 v11, v77, v78
    v_add_f32 v12, v76, v79
    v_sub_f32 v13, v78, v77
    ds_write_b64 v4, v[10:11] offset:3840
    ds_write_b64 v6, v[12:13]
    s_and_saveexec_b64 s[14:15], vcc
    v_sub_u32 v6, 512, v7
    v_and_b32 v6, 1023, v6
    v_lshl_add_u32 v6, v6, 3, v8
    v_sub_f32 v10, v80, v83
    v_add_f32 v11, v81, v82
    v_add_f32 v12, v80, v83
    v_sub_f32 v13, v82, v81
    ds_write_b64 v4, v[10:11] offset:4096
    ds_write_b64 v6, v[12:13]
    s_mov_b64 exec, s[14:15]
    s_waitcnt lgkmcnt(0)
    s_barrier
    v_and_b32 v1, 31, v0
    v_lshrrev_b32 v2, 5, v0
    v_cvt_f32_u32 v3, v1
    s_movk_i32 s13, 8448
    v_mul_lo_u32 v7, v2, s13
    v_lshl_add_u32 v4, v1, 3, v7
    s_movk_i32 s13, 264
    v_mul_lo_u32 v5, v1, s13
    v_add_u32 v5, v5, v7
    ds_read_b32 v16, v4 offset:0
    ds_read_b32 v48, v4 offset:4
    ds_read_b32 v17, v4 offset:256
    ds_read_b32 v49, v4 offset:260
    ds_read_b32 v18, v4 offset:512
    ds_read_b32 v50, v4 offset:516
    ds_read_b32 v19, v4 offset:768
    ds_read_b32 v51, v4 offset:772
    ds_read_b32 v20, v4 offset:1024
    ds_read_b32 v52, v4 offset:1028
    ds_read_b32 v21, v4 offset:1280
    ds_read_b32 v53, v4 offset:1284
    ds_read_b32 v22, v4 offset:1536
    ds_read_b32 v54, v4 offset:1540
    s_waitcnt lgkmcnt(0)
    ds_read_b32 v23, v4 offset:1792
    ds_read_b32 v55, v4 offset:1796
    ds_read_b32 v24, v4 offset:2048
    ds_read_b32 v56, v4 offset:2052
    ds_read_b32 v25, v4 offset:2304
    ds_read_b32 v57, v4 offset:2308
    ds_read_b32 v26, v4 offset:2560
    ds_read_b32 v58, v4 offset:2564
    ds_read_b32 v27, v4 offset:2816
    ds_read_b32 v59, v4 offset:2820
    ds_read_b32 v28, v4 offset:3072
    ds_read_b32 v60, v4 offset:3076
    ds_read_b32 v29, v4 offset:3328
    ds_read_b32 v61, v4 offset:3332
    s_waitcnt lgkmcnt(0)
    ds_read_b32 v30, v4 offset:3584
    ds_read_b32 v62, v4 offset:3588
    ds_read_b32 v31, v4 offset:3840
    ds_read_b32 v63, v4 offset:3844
    ds_read_b32 v32, v4 offset:4096
    ds_read_b32 v64, v4 offset:4100
    ds_read_b32 v33, v4 offset:4352
    ds_read_b32 v65, v4 offset:4356
    ds_read_b32 v34, v4 offset:4608
    ds_read_b32 v66, v4 offset:4612
    ds_read_b32 v35, v4 offset:4864
    ds_read_b32 v67, v4 offset:4868
    ds_read_b32 v36, v4 offset:5120
    ds_read_b32 v68, v4 offset:5124
    s_waitcnt lgkmcnt(0)
    ds_read_b32 v37, v4 offset:5376
    ds_read_b32 v69, v4 offset:5380
    ds_read_b32 v38, v4 offset:5632
    ds_read_b32 v70, v4 offset:5636
    ds_read_b32 v39, v4 offset:5888
    ds_read_b32 v71, v4 offset:5892
    ds_read_b32 v40, v4 offset:6144
    ds_read_b32 v72, v4 offset:6148
    ds_read_b32 v41, v4 offset:6400
    ds_read_b32 v73, v4 offset:6404
    ds_read_b32 v42, v4 offset:6656
    ds_read_b32 v74, v4 offset:6660
    ds_read_b32 v43, v4 offset:6912
    ds_read_b32 v75, v4 offset:6916
    s_waitcnt lgkmcnt(0)
    ds_read_b32 v44, v4 offset:7168
    ds_read_b32 v76, v4 offset:7172
    ds_read_b32 v45, v4 offset:7424
    ds_read_b32 v77, v4 offset:7428
    ds_read_b32 v46, v4 offset:7680
    ds_read_b32 v78, v4 offset:7684
    ds_read_b32 v47, v4 offset:7936
    ds_read_b32 v79, v4 offset:7940
    s_waitcnt lgkmcnt(0)
    v_sub_f32 v80, v16, v32
    v_sub_f32 v81, v48, v64
    v_add_f32 v16, v16, v32
    v_add_f32 v48, v48, v64
    v_sub_f32 v32, v17, v33
    v_sub_f32 v64, v49, v65
    v_add_f32 v17, v17, v33
    v_add_f32 v49, v49, v65
    v_mul_f32 v33, 0x3f7b14be, v32
    v_mul_f32 v65, 0x3e47c5c2, v32
    v_fmac_f32 v33, 0xbe47c5c2, v64
    v_fmac_f32 v65, 0x3f7b14be, v64
    v_sub_f32 v32, v18, v34
    v_sub_f32 v64, v50, v66
    v_add_f32 v18, v18, v34
    v_add_f32 v50, v50, v66
    v_mul_f32 v34, 0x3f6c835e, v32
    v_mul_f32 v66, 0x3ec3ef15, v32
    v_fmac_f32 v34, 0xbec3ef15, v64
    v_fmac_f32 v66, 0x3f6c835e, v64
    v_sub_f32 v32, v19, v35
    v_sub_f32 v64, v51, v67
    v_add_f32 v19, v19, v35
    v_add_f32 v51, v51, v67
    v_mul_f32 v35, 0x3f54db31, v32
    v_mul_f32 v67, 0x3f0e39da, v32
    v_fmac_f32 v35, 0xbf0e39da, v64
    v_fmac_f32 v67, 0x3f54db31, v64
    v_sub_f32 v32, v20, v36
    v_sub_f32 v64, v52, v68
    v_add_f32 v20, v20, v36
    v_add_f32 v52, v52, v68
    v_mul_f32 v36, 0x3f3504f3, v32
    v_mul_f32 v68, 0x3f3504f3, v32
    v_fmac_f32 v36, 0xbf3504f3, v64
    v_fmac_f32 v68, 0x3f3504f3, v64
    v_sub_f32 v32, v21, v37
    v_sub_f32 v64, v53, v69
    v_add_f32 v21, v21, v37
    v_add_f32 v53, v53, v69
    v_mul_f32 v37, 0x3f0e39da, v32
    v_mul_f32 v69, 0x3f54db31, v32
    v_fmac_f32 v37, 0xbf54db31, v64
    v_fmac_f32 v69, 0x3f0e39da, v64
    v_sub_f32 v32, v22, v38
    v_sub_f32 v64, v54, v70
    v_add_f32 v22, v22, v38
    v_add_f32 v54, v54, v70
    v_mul_f32 v38, 0x3ec3ef15, v32
    v_mul_f32 v70, 0x3f6c835e, v32
    v_fmac_f32 v38, 0xbf6c835e, v64
    v_fmac_f32 v70, 0x3ec3ef15, v64
    v_sub_f32 v32, v23, v39
    v_sub_f32 v64, v55, v71
    v_add_f32 v23, v23, v39
    v_add_f32 v55, v55, v71
    v_mul_f32 v39, 0x3e47c5c2, v32
    v_mul_f32 v71, 0x3f7b14be, v32
    v_fmac_f32 v39, 0xbf7b14be, v64
    v_fmac_f32 v71, 0x3e47c5c2, v64
    v_sub_f32 v32, v72, v56
    v_sub_f32 v64, v24, v40
    v_add_f32 v24, v24, v40
    v_add_f32 v56, v56, v72
    v_sub_f32 v40, v25, v41
    v_sub_f32 v72, v57, v73
    v_add_f32 v25, v25, v41
    v_add_f32 v57, v57, v73
    v_mul_f32 v41, 0xbe47c5c2, v40
    v_mul_f32 v73, 0x3f7b14be, v40
    v_fmac_f32 v41, 0xbf7b14be, v72
    v_fmac_f32 v73, 0xbe47c5c2, v72
    v_sub_f32 v40, v26, v42
    v_sub_f32 v72, v58, v74
    v_add_f32 v26, v26, v42
    v_add_f32 v58, v58, v74
    v_mul_f32 v42, 0xbec3ef15, v40
    v_mul_f32 v74, 0x3f6c835e, v40
    v_fmac_f32 v42, 0xbf6c835e, v72
    v_fmac_f32 v74, 0xbec3ef15, v72
    v_sub_f32 v40, v27, v43
    v_sub_f32 v72, v59, v75
    v_add_f32 v27, v27, v43
    v_add_f32 v59, v59, v75
    v_mul_f32 v43, 0xbf0e39da, v40
    v_mul_f32 v75, 0x3f54db31, v40
    v_fmac_f32 v43, 0xbf54db31, v72
    v_fmac_f32 v75, 0xbf0e39da, v72
    v_sub_f32 v40, v28, v44
    v_sub_f32 v72, v60, v76
    v_add_f32 v28, v28, v44
    v_add_f32 v60, v60, v76
    v_mul_f32 v44, 0xbf3504f3, v40
    v_mul_f32 v76, 0x3f3504f3, v40
    v_fmac_f32 v44, 0xbf3504f3, v72
    v_fmac_f32 v76, 0xbf3504f3, v72
    v_sub_f32 v40, v29, v45
    v_sub_f32 v72, v61, v77
    v_add_f32 v29, v29, v45
    v_add_f32 v61, v61, v77
    v_mul_f32 v45, 0xbf54db31, v40
    v_mul_f32 v77, 0x3f0e39da, v40
    v_fmac_f32 v45, 0xbf0e39da, v72
    v_fmac_f32 v77, 0xbf54db31, v72
    v_sub_f32 v40, v30, v46
    v_sub_f32 v72, v62, v78
    v_add_f32 v30, v30, v46
    v_add_f32 v62, v62, v78
    v_mul_f32 v46, 0xbf6c835e, v40
    v_mul_f32 v78, 0x3ec3ef15, v40
    v_fmac_f32 v46, 0xbec3ef15, v72
    v_fmac_f32 v78, 0xbf6c835e, v72
    v_sub_f32 v40, v31, v47
    v_sub_f32 v72, v63, v79
    v_add_f32 v31, v31, v47
    v_add_f32 v63, v63, v79
    v_mul_f32 v47, 0xbf7b14be, v40
    v_mul_f32 v79, 0x3e47c5c2, v40
    v_fmac_f32 v47, 0xbe47c5c2, v72
    v_fmac_f32 v79, 0xbf7b14be, v72
    v_sub_f32 v40, v16, v24
    v_sub_f32 v72, v48, v56
    v_add_f32 v16, v16, v24
    v_add_f32 v48, v48, v56
    v_sub_f32 v24, v17, v25
    v_sub_f32 v56, v49, v57
    v_add_f32 v17, v17, v25
    v_add_f32 v49, v49, v57
    v_mul_f32 v25, 0x3f6c835e, v24
    v_mul_f32 v57, 0x3ec3ef15, v24
    v_fmac_f32 v25, 0xbec3ef15, v56
    v_fmac_f32 v57, 0x3f6c835e, v56
    v_sub_f32 v24, v18, v26
    v_sub_f32 v56, v50, v58
    v_add_f32 v18, v18, v26
    v_add_f32 v50, v50, v58
    v_mul_f32 v26, 0x3f3504f3, v24
    v_mul_f32 v58, 0x3f3504f3, v24
    v_fmac_f32 v26, 0xbf3504f3, v56
    v_fmac_f32 v58, 0x3f3504f3, v56
    v_sub_f32 v24, v19, v27
    v_sub_f32 v56, v51, v59
    v_add_f32 v19, v19, v27
    v_add_f32 v51, v51, v59
    v_mul_f32 v27, 0x3ec3ef15, v24
    v_mul_f32 v59, 0x3f6c835e, v24
    v_fmac_f32 v27, 0xbf6c835e, v56
    v_fmac_f32 v59, 0x3ec3ef15, v56
    v_sub_f32 v24, v60, v52
    v_sub_f32 v56, v20, v28
    v_add_f32 v20, v20, v28
    v_add_f32 v52, v52, v60
    v_sub_f32 v28, v21, v29
    v_sub_f32 v60, v53, v61
    v_add_f32 v21, v21, v29
    v_add_f32 v53, v53, v61
    v_mul_f32 v29, 0xbec3ef15, v28
    v_mul_f32 v61, 0x3f6c835e, v28
    v_fmac_f32 v29, 0xbf6c835e, v60
    v_fmac_f32 v61, 0xbec3ef15, v60
    v_sub_f32 v28, v22, v30
    v_sub_f32 v60, v54, v62
    v_add_f32 v22, v22, v30
    v_add_f32 v54, v54, v62
    v_mul_f32 v30, 0xbf3504f3, v28
    v_mul_f32 v62, 0x3f3504f3, v28
    v_fmac_f32 v30, 0xbf3504f3, v60
    v_fmac_f32 v62, 0xbf3504f3, v60
    v_sub_f32 v28, v23, v31
    v_sub_f32 v60, v55, v63
    v_add_f32 v23, v23, v31
    v_add_f32 v55, v55, v63
    v_mul_f32 v31, 0xbf6c835e, v28
    v_mul_f32 v63, 0x3ec3ef15, v28
    v_fmac_f32 v31, 0xbec3ef15, v60
    v_fmac_f32 v63, 0xbf6c835e, v60
    v_sub_f32 v28, v80, v32
    v_sub_f32 v60, v81, v64
    v_add_f32 v80, v80, v32
    v_add_f32 v81, v81, v64
    v_sub_f32 v32, v33, v41
    v_sub_f32 v64, v65, v73
    v_add_f32 v33, v33, v41
    v_add_f32 v65, v65, v73
    v_mul_f32 v41, 0x3f6c835e, v32
    v_mul_f32 v73, 0x3ec3ef15, v32
    v_fmac_f32 v41, 0xbec3ef15, v64
    v_fmac_f32 v73, 0x3f6c835e, v64
    v_sub_f32 v32, v34, v42
    v_sub_f32 v64, v66, v74
    v_add_f32 v34, v34, v42
    v_add_f32 v66, v66, v74
    v_mul_f32 v42, 0x3f3504f3, v32
    v_mul_f32 v74, 0x3f3504f3, v32
    v_fmac_f32 v42, 0xbf3504f3, v64
    v_fmac_f32 v74, 0x3f3504f3, v64
    v_sub_f32 v32, v35, v43
    v_sub_f32 v64, v67, v75
    v_add_f32 v35, v35, v43
    v_add_f32 v67, v67, v75
    v_mul_f32 v43, 0x3ec3ef15, v32
    v_mul_f32 v75, 0x3f6c835e, v32
    v_fmac_f32 v43, 0xbf6c835e, v64
    v_fmac_f32 v75, 0x3ec3ef15, v64
    v_sub_f32 v32, v76, v68
    v_sub_f32 v64, v36, v44
    v_add_f32 v36, v36, v44
    v_add_f32 v68, v68, v76
    v_sub_f32 v44, v37, v45
    v_sub_f32 v76, v69, v77
    v_add_f32 v37, v37, v45
    v_add_f32 v69, v69, v77
    v_mul_f32 v45, 0xbec3ef15, v44
    v_mul_f32 v77, 0x3f6c835e, v44
    v_fmac_f32 v45, 0xbf6c835e, v76
    v_fmac_f32 v77, 0xbec3ef15, v76
    v_sub_f32 v44, v38, v46
    v_sub_f32 v76, v70, v78
    v_add_f32 v38, v38, v46
    v_add_f32 v70, v70, v78
    v_mul_f32 v46, 0xbf3504f3, v44
    v_mul_f32 v78, 0x3f3504f3, v44
    v_fmac_f32 v46, 0xbf3504f3, v76
    v_fmac_f32 v78, 0xbf3504f3, v76
    v_sub_f32 v44, v39, v47
    v_sub_f32 v76, v71, v79
    v_add_f32 v39, v39, v47
    v_add_f32 v71, v71, v79
    v_mul_f32 v47, 0xbf6c835e, v44
    v_mul_f32 v79, 0x3ec3ef15, v44
    v_fmac_f32 v47, 0xbec3ef15, v76
    v_fmac_f32 v79, 0xbf6c835e, v76
    v_sub_f32 v44, v16, v20
    v_sub_f32 v76, v48, v52
    v_add_f32 v16, v16, v20
    v_add_f32 v48, v48, v52
    v_sub_f32 v20, v17, v21
    v_sub_f32 v52, v49, v53
    v_add_f32 v17, v17, v21
    v_add_f32 v49, v49, v53
    v_mul_f32 v21, 0x3f3504f3, v20
    v_mul_f32 v53, 0x3f3504f3, v20
    v_fmac_f32 v21, 0xbf3504f3, v52
    v_fmac_f32 v53, 0x3f3504f3, v52
    v_sub_f32 v20, v54, v50
    v_sub_f32 v52, v18, v22
    v_add_f32 v18, v18, v22
    v_add_f32 v50, v50, v54
    v_sub_f32 v22, v19, v23
    v_sub_f32 v54, v51, v55
    v_add_f32 v19, v19, v23
    v_add_f32 v51, v51, v55
    v_mul_f32 v23, 0xbf3504f3, v22
    v_mul_f32 v55, 0x3f3504f3, v22
    v_fmac_f32 v23, 0xbf3504f3, v54
    v_fmac_f32 v55, 0xbf3504f3, v54
    v_sub_f32 v22, v40, v24
    v_sub_f32 v54, v72, v56
    v_add_f32 v40, v40, v24
    v_add_f32 v72, v72, v56
    v_sub_f32 v24, v25, v29
    v_sub_f32 v56, v57, v61
    v_add_f32 v25, v25, v29
    v_add_f32 v57, v57, v61
    v_mul_f32 v29, 0x3f3504f3, v24
    v_mul_f32 v61, 0x3f3504f3, v24
    v_fmac_f32 v29, 0xbf3504f3, v56
    v_fmac_f32 v61, 0x3f3504f3, v56
    v_sub_f32 v24, v62, v58
    v_sub_f32 v56, v26, v30
    v_add_f32 v26, v26, v30
    v_add_f32 v58, v58, v62
    v_sub_f32 v30, v27, v31
    v_sub_f32 v62, v59, v63
    v_add_f32 v27, v27, v31
    v_add_f32 v59, v59, v63
    v_mul_f32 v31, 0xbf3504f3, v30
    v_mul_f32 v63, 0x3f3504f3, v30
    v_fmac_f32 v31, 0xbf3504f3, v62
    v_fmac_f32 v63, 0xbf3504f3, v62
    v_sub_f32 v30, v80, v36
    v_sub_f32 v62, v81, v68
    v_add_f32 v80, v80, v36
    v_add_f32 v81, v81, v68
    v_sub_f32 v36, v33, v37
    v_sub_f32 v68, v65, v69
    v_add_f32 v33, v33, v37
    v_add_f32 v65, v65, v69
    v_mul_f32 v37, 0x3f3504f3, v36
    v_mul_f32 v69, 0x3f3504f3, v36
    v_fmac_f32 v37, 0xbf3504f3, v68
    v_fmac_f32 v69, 0x3f3504f3, v68
    v_sub_f32 v36, v70, v66
    v_sub_f32 v68, v34, v38
    v_add_f32 v34, v34, v38
    v_add_f32 v66, v66, v70
    v_sub_f32 v38, v35, v39
    v_sub_f32 v70, v67, v71
    v_add_f32 v35, v35, v39
    v_add_f32 v67, v67, v71
    v_mul_f32 v39, 0xbf3504f3, v38
    v_mul_f32 v71, 0x3f3504f3, v38
    v_fmac_f32 v39, 0xbf3504f3, v70
    v_fmac_f32 v71, 0xbf3504f3, v70
    v_sub_f32 v38, v28, v32
    v_sub_f32 v70, v60, v64
    v_add_f32 v28, v28, v32
    v_add_f32 v60, v60, v64
    v_sub_f32 v32, v41, v45
    v_sub_f32 v64, v73, v77
    v_add_f32 v41, v41, v45
    v_add_f32 v73, v73, v77
    v_mul_f32 v45, 0x3f3504f3, v32
    v_mul_f32 v77, 0x3f3504f3, v32
    v_fmac_f32 v45, 0xbf3504f3, v64
    v_fmac_f32 v77, 0x3f3504f3, v64
    v_sub_f32 v32, v78, v74
    v_sub_f32 v64, v42, v46
    v_add_f32 v42, v42, v46
    v_add_f32 v74, v74, v78
    v_sub_f32 v46, v43, v47
    v_sub_f32 v78, v75, v79
    v_add_f32 v43, v43, v47
    v_add_f32 v75, v75, v79
    v_mul_f32 v47, 0xbf3504f3, v46
    v_mul_f32 v79, 0x3f3504f3, v46
    v_fmac_f32 v47, 0xbf3504f3, v78
    v_fmac_f32 v79, 0xbf3504f3, v78
    v_sub_f32 v46, v16, v18
    v_sub_f32 v78, v48, v50
    v_add_f32 v16, v16, v18
    v_add_f32 v48, v48, v50
    v_sub_f32 v18, v51, v49
    v_sub_f32 v50, v17, v19
    v_add_f32 v17, v17, v19
    v_add_f32 v49, v49, v51
    v_sub_f32 v19, v44, v20
    v_sub_f32 v51, v76, v52
    v_add_f32 v44, v44, v20
    v_add_f32 v76, v76, v52
    v_sub_f32 v20, v55, v53
    v_sub_f32 v52, v21, v23
    v_add_f32 v21, v21, v23
    v_add_f32 v53, v53, v55
    v_sub_f32 v23, v40, v26
    v_sub_f32 v55, v72, v58
    v_add_f32 v40, v40, v26
    v_add_f32 v72, v72, v58
    v_sub_f32 v26, v59, v57
    v_sub_f32 v58, v25, v27
    v_add_f32 v25, v25, v27
    v_add_f32 v57, v57, v59
    v_sub_f32 v27, v22, v24
    v_sub_f32 v59, v54, v56
    v_add_f32 v22, v22, v24
    v_add_f32 v54, v54, v56
    v_sub_f32 v24, v63, v61
    v_sub_f32 v56, v29, v31
    v_add_f32 v29, v29, v31
    v_add_f32 v61, v61, v63
    v_sub_f32 v31, v80, v34
    v_sub_f32 v63, v81, v66
    v_add_f32 v80, v80, v34
    v_add_f32 v81, v81, v66
    v_sub_f32 v34, v67, v65
    v_sub_f32 v66, v33, v35
    v_add_f32 v33, v33, v35
    v_add_f32 v65, v65, v67
    v_sub_f32 v35, v30, v36
    v_sub_f32 v67, v62, v68
    v_add_f32 v30, v30, v36
    v_add_f32 v62, v62, v68
    v_sub_f32 v36, v71, v69
    v_sub_f32 v68, v37, v39
    v_add_f32 v37, v37, v39
    v_add_f32 v69, v69, v71
    v_sub_f32 v39, v28, v42
    v_sub_f32 v71, v60, v74
    v_add_f32 v28, v28, v42
    v_add_f32 v60, v60, v74
    v_sub_f32 v42, v75, v73
    v_sub_f32 v74, v41, v43
    v_add_f32 v41, v41, v43
    v_add_f32 v73, v73, v75
    v_sub_f32 v43, v38, v32
    v_sub_f32 v75, v70, v64
    v_add_f32 v38, v38, v32
    v_add_f32 v70, v70, v64
    v_sub_f32 v32, v79, v77
    v_sub_f32 v64, v45, v47
    v_add_f32 v45, v45, v47
    v_add_f32 v77, v77, v79
    v_sub_f32 v47, v16, v17
    v_sub_f32 v79, v48, v49
    v_add_f32 v16, v16, v17
    v_add_f32 v48, v48, v49
    v_sub_f32 v17, v46, v18
    v_sub_f32 v49, v78, v50
    v_add_f32 v46, v46, v18
    v_add_f32 v78, v78, v50
    v_sub_f32 v18, v44, v21
    v_sub_f32 v50, v76, v53
    v_add_f32 v44, v44, v21
    v_add_f32 v76, v76, v53
    v_sub_f32 v21, v19, v20
    v_sub_f32 v53, v51, v52
    v_add_f32 v19, v19, v20
    v_add_f32 v51, v51, v52
    v_sub_f32 v20, v40, v25
    v_sub_f32 v52, v72, v57
    v_add_f32 v40, v40, v25
    v_add_f32 v72, v72, v57
    v_sub_f32 v25, v23, v26
    v_sub_f32 v57, v55, v58
    v_add_f32 v23, v23, v26
    v_add_f32 v55, v55, v58
    v_sub_f32 v26, v22, v29
    v_sub_f32 v58, v54, v61
    v_add_f32 v22, v22, v29
    v_add_f32 v54, v54, v61
    v_sub_f32 v29, v27, v24
    v_sub_f32 v61, v59, v56
    v_add_f32 v27, v27, v24
    v_add_f32 v59, v59, v56
    v_sub_f32 v24, v80, v33
    v_sub_f32 v56, v81, v65
    v_add_f32 v80, v80, v33
    v_add_f32 v81, v81, v65
    v_sub_f32 v33, v31, v34
    v_sub_f32 v65, v63, v66
    v_add_f32 v31, v31, v34
    v_add_f32 v63, v63, v66
    v_sub_f32 v34, v30, v37
    v_sub_f32 v66, v62, v69
    v_add_f32 v30, v30, v37
    v_add_f32 v62, v62, v69
    v_sub_f32 v37, v35, v36
    v_sub_f32 v69, v67, v68
    v_add_f32 v35, v35, v36
    v_add_f32 v67, v67, v68
    v_sub_f32 v36, v28, v41
    v_sub_f32 v68, v60, v73
    v_add_f32 v28, v28, v41
    v_add_f32 v60, v60, v73
    v_sub_f32 v41, v39, v42
    v_sub_f32 v73, v71, v74
    v_add_f32 v39, v39, v42
    v_add_f32 v71, v71, v74
    v_sub_f32 v42, v38, v45
    v_sub_f32 v74, v70, v77
    v_add_f32 v38, v38, v45
    v_add_f32 v70, v70, v77
    v_sub_f32 v45, v43, v32
    v_sub_f32 v77, v75, v64
    v_add_f32 v43, v43, v32
    v_add_f32 v75, v75, v64
    v_mul_f32 v32, 0x3a800000, v3
    v_cos_f32 v64, v32
    v_sin_f32 v82, v32
    s_nop 0
    v_mul_f32 v83, v80, v64
    v_fma_f32 v83, -v81, v82, v83
    v_mul_f32 v81, v81, v64
    v_fmac_f32 v81, v80, v82
    v_mul_f32 v32, 0x3b000000, v3
    v_cos_f32 v64, v32
    v_sin_f32 v82, v32
    s_nop 0
    v_mul_f32 v80, v40, v64
    v_fma_f32 v80, -v72, v82, v80
    v_mul_f32 v72, v72, v64
    v_fmac_f32 v72, v40, v82
    v_mul_f32 v32, 0x3b400000, v3
    v_cos_f32 v64, v32
    v_sin_f32 v82, v32
    s_nop 0
    v_mul_f32 v40, v28, v64
    v_fma_f32 v40, -v60, v82, v40
    v_mul_f32 v60, v60, v64
    v_fmac_f32 v60, v28, v82
    v_mul_f32 v32, 0x3b800000, v3
    v_cos_f32 v64, v32
    v_sin_f32 v82, v32
    s_nop 0
    v_mul_f32 v28, v44, v64
    v_fma_f32 v28, -v76, v82, v28
    v_mul_f32 v76, v76, v64
    v_fmac_f32 v76, v44, v82
    v_mul_f32 v32, 0x3ba00000, v3
    v_cos_f32 v64, v32
    v_sin_f32 v82, v32
    s_nop 0
    v_mul_f32 v44, v30, v64
    v_fma_f32 v44, -v62, v82, v44
    v_mul_f32 v62, v62, v64
    v_fmac_f32 v62, v30, v82
    v_mul_f32 v32, 0x3bc00000, v3
    v_cos_f32 v64, v32
    v_sin_f32 v82, v32
    s_nop 0
    v_mul_f32 v30, v22, v64
    v_fma_f32 v30, -v54, v82, v30
    v_mul_f32 v54, v54, v64
    v_fmac_f32 v54, v22, v82
    v_mul_f32 v32, 0x3be00000, v3
    v_cos_f32 v64, v32
    v_sin_f32 v82, v32
    s_nop 0
    v_mul_f32 v22, v38, v64
    v_fma_f32 v22, -v70, v82, v22
    v_mul_f32 v70, v70, v64
    v_fmac_f32 v70, v38, v82
    v_mul_f32 v32, 0x3c000000, v3
    v_cos_f32 v64, v32
    v_sin_f32 v82, v32
    s_nop 0
    v_mul_f32 v38, v46, v64
    v_fma_f32 v38, -v78, v82, v38
    v_mul_f32 v78, v78, v64
    v_fmac_f32 v78, v46, v82
    v_mul_f32 v32, 0x3c100000, v3
    v_cos_f32 v64, v32
    v_sin_f32 v82, v32
    s_nop 0
    v_mul_f32 v46, v31, v64
    v_fma_f32 v46, -v63, v82, v46
    v_mul_f32 v63, v63, v64
    v_fmac_f32 v63, v31, v82
    v_mul_f32 v32, 0x3c200000, v3
    v_cos_f32 v64, v32
    v_sin_f32 v82, v32
    s_nop 0
    v_mul_f32 v31, v23, v64
    v_fma_f32 v31, -v55, v82, v31
    v_mul_f32 v55, v55, v64
    v_fmac_f32 v55, v23, v82
    v_mul_f32 v32, 0x3c300000, v3
    v_cos_f32 v64, v32
    v_sin_f32 v82, v32
    s_nop 0
    v_mul_f32 v23, v39, v64
    v_fma_f32 v23, -v71, v82, v23
    v_mul_f32 v71, v71, v64
    v_fmac_f32 v71, v39, v82
    v_mul_f32 v32, 0x3c400000, v3
    v_cos_f32 v64, v32
    v_sin_f32 v82, v32
    s_nop 0
    v_mul_f32 v39, v19, v64
    v_fma_f32 v39, -v51, v82, v39
    v_mul_f32 v51, v51, v64
    v_fmac_f32 v51, v19, v82
    v_mul_f32 v32, 0x3c500000, v3
    v_cos_f32 v64, v32
    v_sin_f32 v82, v32
    s_nop 0
    v_mul_f32 v19, v35, v64
    v_fma_f32 v19, -v67, v82, v19
    v_mul_f32 v67, v67, v64
    v_fmac_f32 v67, v35, v82
    v_mul_f32 v32, 0x3c600000, v3
    v_cos_f32 v64, v32
    v_sin_f32 v82, v32
    s_nop 0
    v_mul_f32 v35, v27, v64
    v_fma_f32 v35, -v59, v82, v35
    v_mul_f32 v59, v59, v64
    v_fmac_f32 v59, v27, v82
    v_mul_f32 v32, 0x3c700000, v3
    v_cos_f32 v64, v32
    v_sin_f32 v82, v32
    s_nop 0
    v_mul_f32 v27, v43, v64
    v_fma_f32 v27, -v75, v82, v27
    v_mul_f32 v75, v75, v64
    v_fmac_f32 v75, v43, v82
    v_mul_f32 v32, 0x3c800000, v3
    v_cos_f32 v64, v32
    v_sin_f32 v82, v32
    s_nop 0
    v_mul_f32 v43, v47, v64
    v_fma_f32 v43, -v79, v82, v43
    v_mul_f32 v79, v79, v64
    v_fmac_f32 v79, v47, v82
    v_mul_f32 v32, 0x3c880000, v3
    v_cos_f32 v64, v32
    v_sin_f32 v82, v32
    s_nop 0
    v_mul_f32 v47, v24, v64
    v_fma_f32 v47, -v56, v82, v47
    v_mul_f32 v56, v56, v64
    v_fmac_f32 v56, v24, v82
    v_mul_f32 v32, 0x3c900000, v3
    v_cos_f32 v64, v32
    v_sin_f32 v82, v32
    s_nop 0
    v_mul_f32 v24, v20, v64
    v_fma_f32 v24, -v52, v82, v24
    v_mul_f32 v52, v52, v64
    v_fmac_f32 v52, v20, v82
    v_mul_f32 v32, 0x3c980000, v3
    v_cos_f32 v64, v32
    v_sin_f32 v82, v32
    s_nop 0
    v_mul_f32 v20, v36, v64
    v_fma_f32 v20, -v68, v82, v20
    v_mul_f32 v68, v68, v64
    v_fmac_f32 v68, v36, v82
    v_mul_f32 v32, 0x3ca00000, v3
    v_cos_f32 v64, v32
    v_sin_f32 v82, v32
    s_nop 0
    v_mul_f32 v36, v18, v64
    v_fma_f32 v36, -v50, v82, v36
    v_mul_f32 v50, v50, v64
    v_fmac_f32 v50, v18, v82
    v_mul_f32 v32, 0x3ca80000, v3
    v_cos_f32 v64, v32
    v_sin_f32 v82, v32
    s_nop 0
    v_mul_f32 v18, v34, v64
    v_fma_f32 v18, -v66, v82, v18
    v_mul_f32 v66, v66, v64
    v_fmac_f32 v66, v34, v82
    v_mul_f32 v32, 0x3cb00000, v3
    v_cos_f32 v64, v32
    v_sin_f32 v82, v32
    s_nop 0
    v_mul_f32 v34, v26, v64
    v_fma_f32 v34, -v58, v82, v34
    v_mul_f32 v58, v58, v64
    v_fmac_f32 v58, v26, v82
    v_mul_f32 v32, 0x3cb80000, v3
    v_cos_f32 v64, v32
    v_sin_f32 v82, v32
    s_nop 0
    v_mul_f32 v26, v42, v64
    v_fma_f32 v26, -v74, v82, v26
    v_mul_f32 v74, v74, v64
    v_fmac_f32 v74, v42, v82
    v_mul_f32 v32, 0x3cc00000, v3
    v_cos_f32 v64, v32
    v_sin_f32 v82, v32
    s_nop 0
    v_mul_f32 v42, v17, v64
    v_fma_f32 v42, -v49, v82, v42
    v_mul_f32 v49, v49, v64
    v_fmac_f32 v49, v17, v82
    v_mul_f32 v32, 0x3cc80000, v3
    v_cos_f32 v64, v32
    v_sin_f32 v82, v32
    s_nop 0
    v_mul_f32 v17, v33, v64
    v_fma_f32 v17, -v65, v82, v17
    v_mul_f32 v65, v65, v64
    v_fmac_f32 v65, v33, v82
    v_mul_f32 v32, 0x3cd00000, v3
    v_cos_f32 v64, v32
    v_sin_f32 v82, v32
    s_nop 0
    v_mul_f32 v33, v25, v64
    v_fma_f32 v33, -v57, v82, v33
    v_mul_f32 v57, v57, v64
    v_fmac_f32 v57, v25, v82
    v_mul_f32 v32, 0x3cd80000, v3
    v_cos_f32 v64, v32
    v_sin_f32 v82, v32
    s_nop 0
    v_mul_f32 v25, v41, v64
    v_fma_f32 v25, -v73, v82, v25
    v_mul_f32 v73, v73, v64
    v_fmac_f32 v73, v41, v82
    v_mul_f32 v32, 0x3ce00000, v3
    v_cos_f32 v64, v32
    v_sin_f32 v82, v32
    s_nop 0
    v_mul_f32 v41, v21, v64
    v_fma_f32 v41, -v53, v82, v41
    v_mul_f32 v53, v53, v64
    v_fmac_f32 v53, v21, v82
    v_mul_f32 v32, 0x3ce80000, v3
    v_cos_f32 v64, v32
    v_sin_f32 v82, v32
    s_nop 0
    v_mul_f32 v21, v37, v64
    v_fma_f32 v21, -v69, v82, v21
    v_mul_f32 v69, v69, v64
    v_fmac_f32 v69, v37, v82
    v_mul_f32 v32, 0x3cf00000, v3
    v_cos_f32 v64, v32
    v_sin_f32 v82, v32
    s_nop 0
    v_mul_f32 v37, v29, v64
    v_fma_f32 v37, -v61, v82, v37
    v_mul_f32 v61, v61, v64
    v_fmac_f32 v61, v29, v82
    v_mul_f32 v32, 0x3cf80000, v3
    v_cos_f32 v64, v32
    v_sin_f32 v82, v32
    s_nop 0
    v_mul_f32 v29, v45, v64
    v_fma_f32 v29, -v77, v82, v29
    v_mul_f32 v77, v77, v64
    v_fmac_f32 v77, v45, v82
    ds_write_b32 v4, v16 offset:0
    ds_write_b32 v4, v48 offset:4
    ds_write_b32 v4, v83 offset:264
    ds_write_b32 v4, v81 offset:268
    ds_write_b32 v4, v80 offset:528
    ds_write_b32 v4, v72 offset:532
    ds_write_b32 v4, v40 offset:792
    ds_write_b32 v4, v60 offset:796
    ds_write_b32 v4, v28 offset:1056
    ds_write_b32 v4, v76 offset:1060
    ds_write_b32 v4, v44 offset:1320
    ds_write_b32 v4, v62 offset:1324
    ds_write_b32 v4, v30 offset:1584
    ds_write_b32 v4, v54 offset:1588
    ds_write_b32 v4, v22 offset:1848
    ds_write_b32 v4, v70 offset:1852
    ds_write_b32 v4, v38 offset:2112
    ds_write_b32 v4, v78 offset:2116
    ds_write_b32 v4, v46 offset:2376
    ds_write_b32 v4, v63 offset:2380
    ds_write_b32 v4, v31 offset:2640
    ds_write_b32 v4, v55 offset:2644
    ds_write_b32 v4, v23 offset:2904
    ds_write_b32 v4, v71 offset:2908
    ds_write_b32 v4, v39 offset:3168
    ds_write_b32 v4, v51 offset:3172
    ds_write_b32 v4, v19 offset:3432
    ds_write_b32 v4, v67 offset:3436
    ds_write_b32 v4, v35 offset:3696
    ds_write_b32 v4, v59 offset:3700
    ds_write_b32 v4, v27 offset:3960
    ds_write_b32 v4, v75 offset:3964
    ds_write_b32 v4, v43 offset:4224
    ds_write_b32 v4, v79 offset:4228
    ds_write_b32 v4, v47 offset:4488
    ds_write_b32 v4, v56 offset:4492
    ds_write_b32 v4, v24 offset:4752
    ds_write_b32 v4, v52 offset:4756
    ds_write_b32 v4, v20 offset:5016
    ds_write_b32 v4, v68 offset:5020
    ds_write_b32 v4, v36 offset:5280
    ds_write_b32 v4, v50 offset:5284
    ds_write_b32 v4, v18 offset:5544
    ds_write_b32 v4, v66 offset:5548
    ds_write_b32 v4, v34 offset:5808
    ds_write_b32 v4, v58 offset:5812
    ds_write_b32 v4, v26 offset:6072
    ds_write_b32 v4, v74 offset:6076
    ds_write_b32 v4, v42 offset:6336
    ds_write_b32 v4, v49 offset:6340
    ds_write_b32 v4, v17 offset:6600
    ds_write_b32 v4, v65 offset:6604
    ds_write_b32 v4, v33 offset:6864
    ds_write_b32 v4, v57 offset:6868
    ds_write_b32 v4, v25 offset:7128
    ds_write_b32 v4, v73 offset:7132
    ds_write_b32 v4, v41 offset:7392
    ds_write_b32 v4, v53 offset:7396
    ds_write_b32 v4, v21 offset:7656
    ds_write_b32 v4, v69 offset:7660
    ds_write_b32 v4, v37 offset:7920
    ds_write_b32 v4, v61 offset:7924
    ds_write_b32 v4, v29 offset:8184
    ds_write_b32 v4, v77 offset:8188
    s_waitcnt lgkmcnt(0)
    ds_read_b32 v16, v5 offset:0
    ds_read_b32 v48, v5 offset:4
    ds_read_b32 v83, v5 offset:8
    ds_read_b32 v81, v5 offset:12
    ds_read_b32 v80, v5 offset:16
    ds_read_b32 v72, v5 offset:20
    ds_read_b32 v40, v5 offset:24
    ds_read_b32 v60, v5 offset:28
    ds_read_b32 v28, v5 offset:32
    ds_read_b32 v76, v5 offset:36
    ds_read_b32 v44, v5 offset:40
    ds_read_b32 v62, v5 offset:44
    ds_read_b32 v30, v5 offset:48
    ds_read_b32 v54, v5 offset:52
    s_waitcnt lgkmcnt(0)
    ds_read_b32 v22, v5 offset:56
    ds_read_b32 v70, v5 offset:60
    ds_read_b32 v38, v5 offset:64
    ds_read_b32 v78, v5 offset:68
    ds_read_b32 v46, v5 offset:72
    ds_read_b32 v63, v5 offset:76
    ds_read_b32 v31, v5 offset:80
    ds_read_b32 v55, v5 offset:84
    ds_read_b32 v23, v5 offset:88
    ds_read_b32 v71, v5 offset:92
    ds_read_b32 v39, v5 offset:96
    ds_read_b32 v51, v5 offset:100
    ds_read_b32 v19, v5 offset:104
    ds_read_b32 v67, v5 offset:108
    s_waitcnt lgkmcnt(0)
    ds_read_b32 v35, v5 offset:112
    ds_read_b32 v59, v5 offset:116
    ds_read_b32 v27, v5 offset:120
    ds_read_b32 v75, v5 offset:124
    ds_read_b32 v43, v5 offset:128
    ds_read_b32 v79, v5 offset:132
    ds_read_b32 v47, v5 offset:136
    ds_read_b32 v56, v5 offset:140
    ds_read_b32 v24, v5 offset:144
    ds_read_b32 v52, v5 offset:148
    ds_read_b32 v20, v5 offset:152
    ds_read_b32 v68, v5 offset:156
    ds_read_b32 v36, v5 offset:160
    ds_read_b32 v50, v5 offset:164
    s_waitcnt lgkmcnt(0)
    ds_read_b32 v18, v5 offset:168
    ds_read_b32 v66, v5 offset:172
    ds_read_b32 v34, v5 offset:176
    ds_read_b32 v58, v5 offset:180
    ds_read_b32 v26, v5 offset:184
    ds_read_b32 v74, v5 offset:188
    ds_read_b32 v42, v5 offset:192
    ds_read_b32 v49, v5 offset:196
    ds_read_b32 v17, v5 offset:200
    ds_read_b32 v65, v5 offset:204
    ds_read_b32 v33, v5 offset:208
    ds_read_b32 v57, v5 offset:212
    ds_read_b32 v25, v5 offset:216
    ds_read_b32 v73, v5 offset:220
    s_waitcnt lgkmcnt(0)
    ds_read_b32 v41, v5 offset:224
    ds_read_b32 v53, v5 offset:228
    ds_read_b32 v21, v5 offset:232
    ds_read_b32 v69, v5 offset:236
    ds_read_b32 v37, v5 offset:240
    ds_read_b32 v61, v5 offset:244
    ds_read_b32 v29, v5 offset:248
    ds_read_b32 v77, v5 offset:252
    s_waitcnt lgkmcnt(0)
    v_sub_f32 v32, v16, v43
    v_sub_f32 v64, v48, v79
    v_add_f32 v16, v16, v43
    v_add_f32 v48, v48, v79
    v_sub_f32 v43, v83, v47
    v_sub_f32 v79, v81, v56
    v_add_f32 v83, v83, v47
    v_add_f32 v81, v81, v56
    v_mul_f32 v47, 0x3f7b14be, v43
    v_mul_f32 v56, 0x3e47c5c2, v43
    v_fmac_f32 v47, 0xbe47c5c2, v79
    v_fmac_f32 v56, 0x3f7b14be, v79
    v_sub_f32 v43, v80, v24
    v_sub_f32 v79, v72, v52
    v_add_f32 v80, v80, v24
    v_add_f32 v72, v72, v52
    v_mul_f32 v24, 0x3f6c835e, v43
    v_mul_f32 v52, 0x3ec3ef15, v43
    v_fmac_f32 v24, 0xbec3ef15, v79
    v_fmac_f32 v52, 0x3f6c835e, v79
    v_sub_f32 v43, v40, v20
    v_sub_f32 v79, v60, v68
    v_add_f32 v40, v40, v20
    v_add_f32 v60, v60, v68
    v_mul_f32 v20, 0x3f54db31, v43
    v_mul_f32 v68, 0x3f0e39da, v43
    v_fmac_f32 v20, 0xbf0e39da, v79
    v_fmac_f32 v68, 0x3f54db31, v79
    v_sub_f32 v43, v28, v36
    v_sub_f32 v79, v76, v50
    v_add_f32 v28, v28, v36
    v_add_f32 v76, v76, v50
    v_mul_f32 v36, 0x3f3504f3, v43
    v_mul_f32 v50, 0x3f3504f3, v43
    v_fmac_f32 v36, 0xbf3504f3, v79
    v_fmac_f32 v50, 0x3f3504f3, v79
    v_sub_f32 v43, v44, v18
    v_sub_f32 v79, v62, v66
    v_add_f32 v44, v44, v18
    v_add_f32 v62, v62, v66
    v_mul_f32 v18, 0x3f0e39da, v43
    v_mul_f32 v66, 0x3f54db31, v43
    v_fmac_f32 v18, 0xbf54db31, v79
    v_fmac_f32 v66, 0x3f0e39da, v79
    v_sub_f32 v43, v30, v34
    v_sub_f32 v79, v54, v58
    v_add_f32 v30, v30, v34
    v_add_f32 v54, v54, v58
    v_mul_f32 v34, 0x3ec3ef15, v43
    v_mul_f32 v58, 0x3f6c835e, v43
    v_fmac_f32 v34, 0xbf6c835e, v79
    v_fmac_f32 v58, 0x3ec3ef15, v79
    v_sub_f32 v43, v22, v26
    v_sub_f32 v79, v70, v74
    v_add_f32 v22, v22, v26
    v_add_f32 v70, v70, v74
    v_mul_f32 v26, 0x3e47c5c2, v43
    v_mul_f32 v74, 0x3f7b14be, v43
    v_fmac_f32 v26, 0xbf7b14be, v79
    v_fmac_f32 v74, 0x3e47c5c2, v79
    v_sub_f32 v43, v49, v78
    v_sub_f32 v79, v38, v42
    v_add_f32 v38, v38, v42
    v_add_f32 v78, v78, v49
    v_sub_f32 v42, v46, v17
    v_sub_f32 v49, v63, v65
    v_add_f32 v46, v46, v17
    v_add_f32 v63, v63, v65
    v_mul_f32 v17, 0xbe47c5c2, v42
    v_mul_f32 v65, 0x3f7b14be, v42
    v_fmac_f32 v17, 0xbf7b14be, v49
    v_fmac_f32 v65, 0xbe47c5c2, v49
    v_sub_f32 v42, v31, v33
    v_sub_f32 v49, v55, v57
    v_add_f32 v31, v31, v33
    v_add_f32 v55, v55, v57
    v_mul_f32 v33, 0xbec3ef15, v42
    v_mul_f32 v57, 0x3f6c835e, v42
    v_fmac_f32 v33, 0xbf6c835e, v49
    v_fmac_f32 v57, 0xbec3ef15, v49
    v_sub_f32 v42, v23, v25
    v_sub_f32 v49, v71, v73
    v_add_f32 v23, v23, v25
    v_add_f32 v71, v71, v73
    v_mul_f32 v25, 0xbf0e39da, v42
    v_mul_f32 v73, 0x3f54db31, v42
    v_fmac_f32 v25, 0xbf54db31, v49
    v_fmac_f32 v73, 0xbf0e39da, v49
    v_sub_f32 v42, v39, v41
    v_sub_f32 v49, v51, v53
    v_add_f32 v39, v39, v41
    v_add_f32 v51, v51, v53
    v_mul_f32 v41, 0xbf3504f3, v42
    v_mul_f32 v53, 0x3f3504f3, v42
    v_fmac_f32 v41, 0xbf3504f3, v49
    v_fmac_f32 v53, 0xbf3504f3, v49
    v_sub_f32 v42, v19, v21
    v_sub_f32 v49, v67, v69
    v_add_f32 v19, v19, v21
    v_add_f32 v67, v67, v69
    v_mul_f32 v21, 0xbf54db31, v42
    v_mul_f32 v69, 0x3f0e39da, v42
    v_fmac_f32 v21, 0xbf0e39da, v49
    v_fmac_f32 v69, 0xbf54db31, v49
    v_sub_f32 v42, v35, v37
    v_sub_f32 v49, v59, v61
    v_add_f32 v35, v35, v37
    v_add_f32 v59, v59, v61
    v_mul_f32 v37, 0xbf6c835e, v42
    v_mul_f32 v61, 0x3ec3ef15, v42
    v_fmac_f32 v37, 0xbec3ef15, v49
    v_fmac_f32 v61, 0xbf6c835e, v49
    v_sub_f32 v42, v27, v29
    v_sub_f32 v49, v75, v77
    v_add_f32 v27, v27, v29
    v_add_f32 v75, v75, v77
    v_mul_f32 v29, 0xbf7b14be, v42
    v_mul_f32 v77, 0x3e47c5c2, v42
    v_fmac_f32 v29, 0xbe47c5c2, v49
    v_fmac_f32 v77, 0xbf7b14be, v49
    v_sub_f32 v42, v16, v38
    v_sub_f32 v49, v48, v78
    v_add_f32 v16, v16, v38
    v_add_f32 v48, v48, v78
    v_sub_f32 v38, v83, v46
    v_sub_f32 v78, v81, v63
    v_add_f32 v83, v83, v46
    v_add_f32 v81, v81, v63
    v_mul_f32 v46, 0x3f6c835e, v38
    v_mul_f32 v63, 0x3ec3ef15, v38
    v_fmac_f32 v46, 0xbec3ef15, v78
    v_fmac_f32 v63, 0x3f6c835e, v78
    v_sub_f32 v38, v80, v31
    v_sub_f32 v78, v72, v55
    v_add_f32 v80, v80, v31
    v_add_f32 v72, v72, v55
    v_mul_f32 v31, 0x3f3504f3, v38
    v_mul_f32 v55, 0x3f3504f3, v38
    v_fmac_f32 v31, 0xbf3504f3, v78
    v_fmac_f32 v55, 0x3f3504f3, v78
    v_sub_f32 v38, v40, v23
    v_sub_f32 v78, v60, v71
    v_add_f32 v40, v40, v23
    v_add_f32 v60, v60, v71
    v_mul_f32 v23, 0x3ec3ef15, v38
    v_mul_f32 v71, 0x3f6c835e, v38
    v_fmac_f32 v23, 0xbf6c835e, v78
    v_fmac_f32 v71, 0x3ec3ef15, v78
    v_sub_f32 v38, v51, v76
    v_sub_f32 v78, v28, v39
    v_add_f32 v28, v28, v39
    v_add_f32 v76, v76, v51
    v_sub_f32 v39, v44, v19
    v_sub_f32 v51, v62, v67
    v_add_f32 v44, v44, v19
    v_add_f32 v62, v62, v67
    v_mul_f32 v19, 0xbec3ef15, v39
    v_mul_f32 v67, 0x3f6c835e, v39
    v_fmac_f32 v19, 0xbf6c835e, v51
    v_fmac_f32 v67, 0xbec3ef15, v51
    v_sub_f32 v39, v30, v35
    v_sub_f32 v51, v54, v59
    v_add_f32 v30, v30, v35
    v_add_f32 v54, v54, v59
    v_mul_f32 v35, 0xbf3504f3, v39
    v_mul_f32 v59, 0x3f3504f3, v39
    v_fmac_f32 v35, 0xbf3504f3, v51
    v_fmac_f32 v59, 0xbf3504f3, v51
    v_sub_f32 v39, v22, v27
    v_sub_f32 v51, v70, v75
    v_add_f32 v22, v22, v27
    v_add_f32 v70, v70, v75
    v_mul_f32 v27, 0xbf6c835e, v39
    v_mul_f32 v75, 0x3ec3ef15, v39
    v_fmac_f32 v27, 0xbec3ef15, v51
    v_fmac_f32 v75, 0xbf6c835e, v51
    v_sub_f32 v39, v32, v43
    v_sub_f32 v51, v64, v79
    v_add_f32 v32, v32, v43
    v_add_f32 v64, v64, v79
    v_sub_f32 v43, v47, v17
    v_sub_f32 v79, v56, v65
    v_add_f32 v47, v47, v17
    v_add_f32 v56, v56, v65
    v_mul_f32 v17, 0x3f6c835e, v43
    v_mul_f32 v65, 0x3ec3ef15, v43
    v_fmac_f32 v17, 0xbec3ef15, v79
    v_fmac_f32 v65, 0x3f6c835e, v79
    v_sub_f32 v43, v24, v33
    v_sub_f32 v79, v52, v57
    v_add_f32 v24, v24, v33
    v_add_f32 v52, v52, v57
    v_mul_f32 v33, 0x3f3504f3, v43
    v_mul_f32 v57, 0x3f3504f3, v43
    v_fmac_f32 v33, 0xbf3504f3, v79
    v_fmac_f32 v57, 0x3f3504f3, v79
    v_sub_f32 v43, v20, v25
    v_sub_f32 v79, v68, v73
    v_add_f32 v20, v20, v25
    v_add_f32 v68, v68, v73
    v_mul_f32 v25, 0x3ec3ef15, v43
    v_mul_f32 v73, 0x3f6c835e, v43
    v_fmac_f32 v25, 0xbf6c835e, v79
    v_fmac_f32 v73, 0x3ec3ef15, v79
    v_sub_f32 v43, v53, v50
    v_sub_f32 v79, v36, v41
    v_add_f32 v36, v36, v41
    v_add_f32 v50, v50, v53
    v_sub_f32 v41, v18, v21
    v_sub_f32 v53, v66, v69
    v_add_f32 v18, v18, v21
    v_add_f32 v66, v66, v69
    v_mul_f32 v21, 0xbec3ef15, v41
    v_mul_f32 v69, 0x3f6c835e, v41
    v_fmac_f32 v21, 0xbf6c835e, v53
    v_fmac_f32 v69, 0xbec3ef15, v53
    v_sub_f32 v41, v34, v37
    v_sub_f32 v53, v58, v61
    v_add_f32 v34, v34, v37
    v_add_f32 v58, v58, v61
    v_mul_f32 v37, 0xbf3504f3, v41
    v_mul_f32 v61, 0x3f3504f3, v41
    v_fmac_f32 v37, 0xbf3504f3, v53
    v_fmac_f32 v61, 0xbf3504f3, v53
    v_sub_f32 v41, v26, v29
    v_sub_f32 v53, v74, v77
    v_add_f32 v26, v26, v29
    v_add_f32 v74, v74, v77
    v_mul_f32 v29, 0xbf6c835e, v41
    v_mul_f32 v77, 0x3ec3ef15, v41
    v_fmac_f32 v29, 0xbec3ef15, v53
    v_fmac_f32 v77, 0xbf6c835e, v53
    v_sub_f32 v41, v16, v28
    v_sub_f32 v53, v48, v76
    v_add_f32 v16, v16, v28
    v_add_f32 v48, v48, v76
    v_sub_f32 v28, v83, v44
    v_sub_f32 v76, v81, v62
    v_add_f32 v83, v83, v44
    v_add_f32 v81, v81, v62
    v_mul_f32 v44, 0x3f3504f3, v28
    v_mul_f32 v62, 0x3f3504f3, v28
    v_fmac_f32 v44, 0xbf3504f3, v76
    v_fmac_f32 v62, 0x3f3504f3, v76
    v_sub_f32 v28, v54, v72
    v_sub_f32 v76, v80, v30
    v_add_f32 v80, v80, v30
    v_add_f32 v72, v72, v54
    v_sub_f32 v30, v40, v22
    v_sub_f32 v54, v60, v70
    v_add_f32 v40, v40, v22
    v_add_f32 v60, v60, v70
    v_mul_f32 v22, 0xbf3504f3, v30
    v_mul_f32 v70, 0x3f3504f3, v30
    v_fmac_f32 v22, 0xbf3504f3, v54
    v_fmac_f32 v70, 0xbf3504f3, v54
    v_sub_f32 v30, v42, v38
    v_sub_f32 v54, v49, v78
    v_add_f32 v42, v42, v38
    v_add_f32 v49, v49, v78
    v_sub_f32 v38, v46, v19
    v_sub_f32 v78, v63, v67
    v_add_f32 v46, v46, v19
    v_add_f32 v63, v63, v67
    v_mul_f32 v19, 0x3f3504f3, v38
    v_mul_f32 v67, 0x3f3504f3, v38
    v_fmac_f32 v19, 0xbf3504f3, v78
    v_fmac_f32 v67, 0x3f3504f3, v78
    v_sub_f32 v38, v59, v55
    v_sub_f32 v78, v31, v35
    v_add_f32 v31, v31, v35
    v_add_f32 v55, v55, v59
    v_sub_f32 v35, v23, v27
    v_sub_f32 v59, v71, v75
    v_add_f32 v23, v23, v27
    v_add_f32 v71, v71, v75
    v_mul_f32 v27, 0xbf3504f3, v35
    v_mul_f32 v75, 0x3f3504f3, v35
    v_fmac_f32 v27, 0xbf3504f3, v59
    v_fmac_f32 v75, 0xbf3504f3, v59
    v_sub_f32 v35, v32, v36
    v_sub_f32 v59, v64, v50
    v_add_f32 v32, v32, v36
    v_add_f32 v64, v64, v50
    v_sub_f32 v36, v47, v18
    v_sub_f32 v50, v56, v66
    v_add_f32 v47, v47, v18
    v_add_f32 v56, v56, v66
    v_mul_f32 v18, 0x3f3504f3, v36
    v_mul_f32 v66, 0x3f3504f3, v36
    v_fmac_f32 v18, 0xbf3504f3, v50
    v_fmac_f32 v66, 0x3f3504f3, v50
    v_sub_f32 v36, v58, v52
    v_sub_f32 v50, v24, v34
    v_add_f32 v24, v24, v34
    v_add_f32 v52, v52, v58
    v_sub_f32 v34, v20, v26
    v_sub_f32 v58, v68, v74
    v_add_f32 v20, v20, v26
    v_add_f32 v68, v68, v74
    v_mul_f32 v26, 0xbf3504f3, v34
    v_mul_f32 v74, 0x3f3504f3, v34
    v_fmac_f32 v26, 0xbf3504f3, v58
    v_fmac_f32 v74, 0xbf3504f3, v58
    v_sub_f32 v34, v39, v43
    v_sub_f32 v58, v51, v79
    v_add_f32 v39, v39, v43
    v_add_f32 v51, v51, v79
    v_sub_f32 v43, v17, v21
    v_sub_f32 v79, v65, v69
    v_add_f32 v17, v17, v21
    v_add_f32 v65, v65, v69
    v_mul_f32 v21, 0x3f3504f3, v43
    v_mul_f32 v69, 0x3f3504f3, v43
    v_fmac_f32 v21, 0xbf3504f3, v79
    v_fmac_f32 v69, 0x3f3504f3, v79
    v_sub_f32 v43, v61, v57
    v_sub_f32 v79, v33, v37
    v_add_f32 v33, v33, v37
    v_add_f32 v57, v57, v61
    v_sub_f32 v37, v25, v29
    v_sub_f32 v61, v73, v77
    v_add_f32 v25, v25, v29
    v_add_f32 v73, v73, v77
    v_mul_f32 v29, 0xbf3504f3, v37
    v_mul_f32 v77, 0x3f3504f3, v37
    v_fmac_f32 v29, 0xbf3504f3, v61
    v_fmac_f32 v77, 0xbf3504f3, v61
    v_sub_f32 v37, v16, v80
    v_sub_f32 v61, v48, v72
    v_add_f32 v16, v16, v80
    v_add_f32 v48, v48, v72
    v_sub_f32 v80, v60, v81
    v_sub_f32 v72, v83, v40
    v_add_f32 v83, v83, v40
    v_add_f32 v81, v81, v60
    v_sub_f32 v40, v41, v28
    v_sub_f32 v60, v53, v76
    v_add_f32 v41, v41, v28
    v_add_f32 v53, v53, v76
    v_sub_f32 v28, v70, v62
    v_sub_f32 v76, v44, v22
    v_add_f32 v44, v44, v22
    v_add_f32 v62, v62, v70
    v_sub_f32 v22, v42, v31
    v_sub_f32 v70, v49, v55
    v_add_f32 v42, v42, v31
    v_add_f32 v49, v49, v55
    v_sub_f32 v31, v71, v63
    v_sub_f32 v55, v46, v23
    v_add_f32 v46, v46, v23
    v_add_f32 v63, v63, v71
    v_sub_f32 v23, v30, v38
    v_sub_f32 v71, v54, v78
    v_add_f32 v30, v30, v38
    v_add_f32 v54, v54, v78
    v_sub_f32 v38, v75, v67
    v_sub_f32 v78, v19, v27
    v_add_f32 v19, v19, v27
    v_add_f32 v67, v67, v75
    v_sub_f32 v27, v32, v24
    v_sub_f32 v75, v64, v52
    v_add_f32 v32, v32, v24
    v_add_f32 v64, v64, v52
    v_sub_f32 v24, v68, v56
    v_sub_f32 v52, v47, v20
    v_add_f32 v47, v47, v20
    v_add_f32 v56, v56, v68
    v_sub_f32 v20, v35, v36
    v_sub_f32 v68, v59, v50
    v_add_f32 v35, v35, v36
    v_add_f32 v59, v59, v50
    v_sub_f32 v36, v74, v66
    v_sub_f32 v50, v18, v26
    v_add_f32 v18, v18, v26
    v_add_f32 v66, v66, v74
    v_sub_f32 v26, v39, v33
    v_sub_f32 v74, v51, v57
    v_add_f32 v39, v39, v33
    v_add_f32 v51, v51, v57
    v_sub_f32 v33, v73, v65
    v_sub_f32 v57, v17, v25
    v_add_f32 v17, v17, v25
    v_add_f32 v65, v65, v73
    v_sub_f32 v25, v34, v43
    v_sub_f32 v73, v58, v79
    v_add_f32 v34, v34, v43
    v_add_f32 v58, v58, v79
    v_sub_f32 v43, v77, v69
    v_sub_f32 v79, v21, v29
    v_add_f32 v21, v21, v29
    v_add_f32 v69, v69, v77
    v_sub_f32 v29, v16, v83
    v_sub_f32 v77, v48, v81
    v_add_f32 v16, v16, v83
    v_add_f32 v48, v48, v81
    v_sub_f32 v83, v37, v80
    v_sub_f32 v81, v61, v72
    v_add_f32 v37, v37, v80
    v_add_f32 v61, v61, v72
    v_sub_f32 v80, v41, v44
    v_sub_f32 v72, v53, v62
    v_add_f32 v41, v41, v44
    v_add_f32 v53, v53, v62
    v_sub_f32 v44, v40, v28
    v_sub_f32 v62, v60, v76
    v_add_f32 v40, v40, v28
    v_add_f32 v60, v60, v76
    v_sub_f32 v28, v42, v46
    v_sub_f32 v76, v49, v63
    v_add_f32 v42, v42, v46
    v_add_f32 v49, v49, v63
    v_sub_f32 v46, v22, v31
    v_sub_f32 v63, v70, v55
    v_add_f32 v22, v22, v31
    v_add_f32 v70, v70, v55
    v_sub_f32 v31, v30, v19
    v_sub_f32 v55, v54, v67
    v_add_f32 v30, v30, v19
    v_add_f32 v54, v54, v67
    v_sub_f32 v19, v23, v38
    v_sub_f32 v67, v71, v78
    v_add_f32 v23, v23, v38
    v_add_f32 v71, v71, v78
    v_sub_f32 v38, v32, v47
    v_sub_f32 v78, v64, v56
    v_add_f32 v32, v32, v47
    v_add_f32 v64, v64, v56
    v_sub_f32 v47, v27, v24
    v_sub_f32 v56, v75, v52
    v_add_f32 v27, v27, v24
    v_add_f32 v75, v75, v52
    v_sub_f32 v24, v35, v18
    v_sub_f32 v52, v59, v66
    v_add_f32 v35, v35, v18
    v_add_f32 v59, v59, v66
    v_sub_f32 v18, v20, v36
    v_sub_f32 v66, v68, v50
    v_add_f32 v20, v20, v36
    v_add_f32 v68, v68, v50
    v_sub_f32 v36, v39, v17
    v_sub_f32 v50, v51, v65
    v_add_f32 v39, v39, v17
    v_add_f32 v51, v51, v65
    v_sub_f32 v17, v26, v33
    v_sub_f32 v65, v74, v57
    v_add_f32 v26, v26, v33
    v_add_f32 v74, v74, v57
    v_sub_f32 v33, v34, v21
    v_sub_f32 v57, v58, v69
    v_add_f32 v34, v34, v21
    v_add_f32 v58, v58, v69
    v_sub_f32 v21, v25, v43
    v_sub_f32 v69, v73, v79
    v_add_f32 v25, v25, v43
    v_add_f32 v73, v73, v79
    v_lshl_add_u32 v6, v1, 2, v7
    ds_write_b32 v6, v16 offset:0
    ds_write_b32 v6, v48 offset:4096
    ds_write_b32 v6, v32 offset:128
    ds_write_b32 v6, v64 offset:4224
    ds_write_b32 v6, v42 offset:256
    ds_write_b32 v6, v49 offset:4352
    ds_write_b32 v6, v39 offset:384
    ds_write_b32 v6, v51 offset:4480
    ds_write_b32 v6, v41 offset:512
    ds_write_b32 v6, v53 offset:4608
    ds_write_b32 v6, v35 offset:640
    ds_write_b32 v6, v59 offset:4736
    ds_write_b32 v6, v30 offset:768
    ds_write_b32 v6, v54 offset:4864
    ds_write_b32 v6, v34 offset:896
    ds_write_b32 v6, v58 offset:4992
    ds_write_b32 v6, v37 offset:1024
    ds_write_b32 v6, v61 offset:5120
    ds_write_b32 v6, v27 offset:1152
    ds_write_b32 v6, v75 offset:5248
    ds_write_b32 v6, v22 offset:1280
    ds_write_b32 v6, v70 offset:5376
    ds_write_b32 v6, v26 offset:1408
    ds_write_b32 v6, v74 offset:5504
    ds_write_b32 v6, v40 offset:1536
    ds_write_b32 v6, v60 offset:5632
    ds_write_b32 v6, v20 offset:1664
    ds_write_b32 v6, v68 offset:5760
    ds_write_b32 v6, v23 offset:1792
    ds_write_b32 v6, v71 offset:5888
    ds_write_b32 v6, v25 offset:1920
    ds_write_b32 v6, v73 offset:6016
    ds_write_b32 v6, v29 offset:2048
    ds_write_b32 v6, v77 offset:6144
    ds_write_b32 v6, v38 offset:2176
    ds_write_b32 v6, v78 offset:6272
    ds_write_b32 v6, v28 offset:2304
    ds_write_b32 v6, v76 offset:6400
    ds_write_b32 v6, v36 offset:2432
    ds_write_b32 v6, v50 offset:6528
    ds_write_b32 v6, v80 offset:2560
    ds_write_b32 v6, v72 offset:6656
    ds_write_b32 v6, v24 offset:2688
    ds_write_b32 v6, v52 offset:6784
    ds_write_b32 v6, v31 offset:2816
    ds_write_b32 v6, v55 offset:6912
    ds_write_b32 v6, v33 offset:2944
    ds_write_b32 v6, v57 offset:7040
    ds_write_b32 v6, v83 offset:3072
    ds_write_b32 v6, v81 offset:7168
    ds_write_b32 v6, v47 offset:3200
    ds_write_b32 v6, v56 offset:7296
    ds_write_b32 v6, v46 offset:3328
    ds_write_b32 v6, v63 offset:7424
    ds_write_b32 v6, v17 offset:3456
    ds_write_b32 v6, v65 offset:7552
    ds_write_b32 v6, v44 offset:3584
    ds_write_b32 v6, v62 offset:7680
    ds_write_b32 v6, v18 offset:3712
    ds_write_b32 v6, v66 offset:7808
    ds_write_b32 v6, v19 offset:3840
    ds_write_b32 v6, v67 offset:7936
    ds_write_b32 v6, v21 offset:3968
    ds_write_b32 v6, v69 offset:8064
    s_waitcnt lgkmcnt(0)
    s_barrier
    v_and_b32 v6, 127, v0
    v_lshrrev_b32 v7, 7, v0
    v_lshlrev_b32 v8, 5, v6
    v_lshl_add_u32 v8, v7, 12, v8
    v_lshlrev_b32 v5, 4, v6
    v_lshl_add_u32 v5, v7, 12, v5
    v_add_u32 v5, 2048, v5
    s_lshl_b32 s12, s92, 16
    ds_read_b128 v[16:19], v8 offset:0
    ds_read_b128 v[20:23], v8 offset:16
    s_waitcnt lgkmcnt(0)
    v_cvt_pk_bf16_f32 v24, v16, v17
    v_cvt_pk_bf16_f32 v25, v18, v19
    v_cvt_pk_bf16_f32 v26, v20, v21
    v_cvt_pk_bf16_f32 v27, v22, v23
    s_add_u32 s13, s12, 0
    buffer_store_dwordx4 v[24:27], v5, s[4:7], s13 offen
    s_nop 1
    ds_read_b128 v[16:19], v8 offset:8448
    ds_read_b128 v[20:23], v8 offset:8464
    s_waitcnt lgkmcnt(0)
    v_cvt_pk_bf16_f32 v24, v16, v17
    v_cvt_pk_bf16_f32 v25, v18, v19
    v_cvt_pk_bf16_f32 v26, v20, v21
    v_cvt_pk_bf16_f32 v27, v22, v23
    s_add_u32 s13, s12, 8192
    buffer_store_dwordx4 v[24:27], v5, s[4:7], s13 offen
    s_nop 1
    ds_read_b128 v[16:19], v8 offset:16896
    ds_read_b128 v[20:23], v8 offset:16912
    s_waitcnt lgkmcnt(0)
    v_cvt_pk_bf16_f32 v24, v16, v17
    v_cvt_pk_bf16_f32 v25, v18, v19
    v_cvt_pk_bf16_f32 v26, v20, v21
    v_cvt_pk_bf16_f32 v27, v22, v23
    s_add_u32 s13, s12, 16384
    buffer_store_dwordx4 v[24:27], v5, s[4:7], s13 offen
    s_nop 1
    ds_read_b128 v[16:19], v8 offset:25344
    ds_read_b128 v[20:23], v8 offset:25360
    s_waitcnt lgkmcnt(0)
    v_cvt_pk_bf16_f32 v24, v16, v17
    v_cvt_pk_bf16_f32 v25, v18, v19
    v_cvt_pk_bf16_f32 v26, v20, v21
    v_cvt_pk_bf16_f32 v27, v22, v23
    s_add_u32 s13, s12, 24576
    buffer_store_dwordx4 v[24:27], v5, s[4:7], s13 offen
    s_nop 1
    ds_read_b128 v[16:19], v8 offset:33792
    ds_read_b128 v[20:23], v8 offset:33808
    s_waitcnt lgkmcnt(0)
    v_cvt_pk_bf16_f32 v24, v16, v17
    v_cvt_pk_bf16_f32 v25, v18, v19
    v_cvt_pk_bf16_f32 v26, v20, v21
    v_cvt_pk_bf16_f32 v27, v22, v23
    s_add_u32 s13, s12, 32768
    buffer_store_dwordx4 v[24:27], v5, s[4:7], s13 offen
    s_nop 1
    ds_read_b128 v[16:19], v8 offset:42240
    ds_read_b128 v[20:23], v8 offset:42256
    s_waitcnt lgkmcnt(0)
    v_cvt_pk_bf16_f32 v24, v16, v17
    v_cvt_pk_bf16_f32 v25, v18, v19
    v_cvt_pk_bf16_f32 v26, v20, v21
    v_cvt_pk_bf16_f32 v27, v22, v23
    s_add_u32 s13, s12, 40960
    buffer_store_dwordx4 v[24:27], v5, s[4:7], s13 offen
    s_nop 1
    ds_read_b128 v[16:19], v8 offset:50688
    ds_read_b128 v[20:23], v8 offset:50704
    s_waitcnt lgkmcnt(0)
    v_cvt_pk_bf16_f32 v24, v16, v17
    v_cvt_pk_bf16_f32 v25, v18, v19
    v_cvt_pk_bf16_f32 v26, v20, v21
    v_cvt_pk_bf16_f32 v27, v22, v23
    s_add_u32 s13, s12, 49152
    buffer_store_dwordx4 v[24:27], v5, s[4:7], s13 offen
    s_nop 1
    ds_read_b128 v[16:19], v8 offset:59136
    ds_read_b128 v[20:23], v8 offset:59152
    s_waitcnt lgkmcnt(0)
    v_cvt_pk_bf16_f32 v24, v16, v17
    v_cvt_pk_bf16_f32 v25, v18, v19
    v_cvt_pk_bf16_f32 v26, v20, v21
    v_cvt_pk_bf16_f32 v27, v22, v23
    s_add_u32 s13, s12, 57344
    buffer_store_dwordx4 v[24:27], v5, s[4:7], s13 offen
    s_nop 1
    s_branch mega_kernel_xo4
mega_kernel_xo:
    s_cmp_lg_u32 s92, 128
    s_cbranch_scc1 mega_kernel_xo2
    s_cmp_lg_u32 s98, 0
    s_cbranch_scc1 mega_kernel_xo2
mega_kernel_wf1b:
    s_sleep 8
    buffer_load_dword v2, off, s[88:91], 0 offset:72 sc1
    s_waitcnt vmcnt(0)
    v_cmp_ne_u32 vcc, 192, v2
    s_cbranch_vccnz mega_kernel_wf1b
    s_mov_b32 s99, 128
    s_branch mega_kernel_f2_in
mega_kernel_f2ret:
    s_waitcnt vmcnt(0)
    v_mov_b32 v2, 1
    s_mov_b64 exec, 1
    buffer_atomic_add v2, off, s[88:91], 0 offset:136 sc1
    s_mov_b64 exec, -1
    s_branch mega_kernel_xo3
mega_kernel_xo2:
    s_waitcnt vmcnt(0)
    ds_read_b64_tr_b16 a[64:65], v201 offset:0
    ds_read_b64_tr_b16 a[66:67], v201 offset:256
    ds_read_b64_tr_b16 a[68:69], v201 offset:1024
    ds_read_b64_tr_b16 a[70:71], v201 offset:1280
    ds_read_b64_tr_b16 a[72:73], v201 offset:2048
    ds_read_b64_tr_b16 a[74:75], v201 offset:2304
    ds_read_b64_tr_b16 a[76:77], v201 offset:3072
    ds_read_b64_tr_b16 a[78:79], v201 offset:3328
    s_waitcnt lgkmcnt(0)
    ds_read_b64_tr_b16 a[80:81], v201 offset:4096
    ds_read_b64_tr_b16 a[82:83], v201 offset:4352
    ds_read_b64_tr_b16 a[84:85], v201 offset:5120
    ds_read_b64_tr_b16 a[86:87], v201 offset:5376
    ds_read_b64_tr_b16 a[88:89], v201 offset:6144
    ds_read_b64_tr_b16 a[90:91], v201 offset:6400
    ds_read_b64_tr_b16 a[92:93], v201 offset:7168
    ds_read_b64_tr_b16 a[94:95], v201 offset:7424
    s_waitcnt lgkmcnt(0)
    ds_read_b64_tr_b16 a[96:97], v201 offset:8192
    ds_read_b64_tr_b16 a[98:99], v201 offset:8448
    ds_read_b64_tr_b16 a[100:101], v201 offset:9216
    ds_read_b64_tr_b16 a[102:103], v201 offset:9472
    ds_read_b64_tr_b16 a[104:105], v201 offset:10240
    ds_read_b64_tr_b16 a[106:107], v201 offset:10496
    ds_read_b64_tr_b16 a[108:109], v201 offset:11264
    ds_read_b64_tr_b16 a[110:111], v201 offset:11520
    s_waitcnt lgkmcnt(0)
    ds_read_b64_tr_b16 a[112:113], v201 offset:12288
    ds_read_b64_tr_b16 a[114:115], v201 offset:12544
    ds_read_b64_tr_b16 a[116:117], v201 offset:13312
    ds_read_b64_tr_b16 a[118:119], v201 offset:13568
    ds_read_b64_tr_b16 a[120:121], v201 offset:14336
    ds_read_b64_tr_b16 a[122:123], v201 offset:14592
    ds_read_b64_tr_b16 a[124:125], v201 offset:15360
    ds_read_b64_tr_b16 a[126:127], v201 offset:15616
    s_waitcnt lgkmcnt(0)
    s_add_u32 m0, s56, 0
    s_add_u32 s58, s57, 32768
    s_and_b32 s58, s58, 0xffff
    s_lshl_b32 s58, s58, 5
    buffer_load_dwordx4 v200, s[52:55], s58 offen lds
    s_add_u32 m0, s56, 1024
    s_add_u32 s58, s57, 33792
    s_and_b32 s58, s58, 0xffff
    s_lshl_b32 s58, s58, 5
    buffer_load_dwordx4 v200, s[52:55], s58 offen lds
    s_add_u32 m0, s56, 2048
    s_add_u32 s58, s57, 34816
    s_and_b32 s58, s58, 0xffff
    s_lshl_b32 s58, s58, 5
    buffer_load_dwordx4 v200, s[52:55], s58 offen lds
    s_add_u32 m0, s56, 3072
    s_add_u32 s58, s57, 35840
    s_and_b32 s58, s58, 0xffff
    s_lshl_b32 s58, s58, 5
    buffer_load_dwordx4 v200, s[52:55], s58 offen lds
    s_add_u32 m0, s56, 4096
    s_add_u32 s58, s57, 36864
    s_and_b32 s58, s58, 0xffff
    s_lshl_b32 s58, s58, 5
    buffer_load_dwordx4 v200, s[52:55], s58 offen lds
    s_add_u32 m0, s56, 5120
    s_add_u32 s58, s57, 37888
    s_and_b32 s58, s58, 0xffff
    s_lshl_b32 s58, s58, 5
    buffer_load_dwordx4 v200, s[52:55], s58 offen lds
    s_add_u32 m0, s56, 6144
    s_add_u32 s58, s57, 38912
    s_and_b32 s58, s58, 0xffff
    s_lshl_b32 s58, s58, 5
    buffer_load_dwordx4 v200, s[52:55], s58 offen lds
    s_add_u32 m0, s56, 7168
    s_add_u32 s58, s57, 39936
    s_and_b32 s58, s58, 0xffff
    s_lshl_b32 s58, s58, 5
    buffer_load_dwordx4 v200, s[52:55], s58 offen lds
    s_add_u32 m0, s56, 8192
    s_add_u32 s58, s57, 40960
    s_and_b32 s58, s58, 0xffff
    s_lshl_b32 s58, s58, 5
    buffer_load_dwordx4 v200, s[52:55], s58 offen lds
    s_add_u32 m0, s56, 9216
    s_add_u32 s58, s57, 41984
    s_and_b32 s58, s58, 0xffff
    s_lshl_b32 s58, s58, 5
    buffer_load_dwordx4 v200, s[52:55], s58 offen lds
    s_add_u32 m0, s56, 10240
    s_add_u32 s58, s57, 43008
    s_and_b32 s58, s58, 0xffff
    s_lshl_b32 s58, s58, 5
    buffer_load_dwordx4 v200, s[52:55], s58 offen lds
    s_add_u32 m0, s56, 11264
    s_add_u32 s58, s57, 44032
    s_and_b32 s58, s58, 0xffff
    s_lshl_b32 s58, s58, 5
    buffer_load_dwordx4 v200, s[52:55], s58 offen lds
    s_add_u32 m0, s56, 12288
    s_add_u32 s58, s57, 45056
    s_and_b32 s58, s58, 0xffff
    s_lshl_b32 s58, s58, 5
    buffer_load_dwordx4 v200, s[52:55], s58 offen lds
    s_add_u32 m0, s56, 13312
    s_add_u32 s58, s57, 46080
    s_and_b32 s58, s58, 0xffff
    s_lshl_b32 s58, s58, 5
    buffer_load_dwordx4 v200, s[52:55], s58 offen lds
    s_add_u32 m0, s56, 14336
    s_add_u32 s58, s57, 47104
    s_and_b32 s58, s58, 0xffff
    s_lshl_b32 s58, s58, 5
    buffer_load_dwordx4 v200, s[52:55], s58 offen lds
    s_add_u32 m0, s56, 15360
    s_add_u32 s58, s57, 48128
    s_and_b32 s58, s58, 0xffff
    s_lshl_b32 s58, s58, 5
    buffer_load_dwordx4 v200, s[52:55], s58 offen lds
mega_kernel_xo3:
    s_waitcnt vmcnt(0)
    ds_read_b64_tr_b16 a[128:129], v201 offset:0
    ds_read_b64_tr_b16 a[130:131], v201 offset:256
    ds_read_b64_tr_b16 a[132:133], v201 offset:1024
    ds_read_b64_tr_b16 a[134:135], v201 offset:1280
    ds_read_b64_tr_b16 a[136:137], v201 offset:2048
    ds_read_b64_tr_b16 a[138:139], v201 offset:2304
    ds_read_b64_tr_b16 a[140:141], v201 offset:3072
    ds_read_b64_tr_b16 a[142:143], v201 offset:3328
    s_waitcnt lgkmcnt(0)
    ds_read_b64_tr_b16 a[144:145], v201 offset:4096
    ds_read_b64_tr_b16 a[146:147], v201 offset:4352
    ds_read_b64_tr_b16 a[148:149], v201 offset:5120
    ds_read_b64_tr_b16 a[150:151], v201 offset:5376
    ds_read_b64_tr_b16 a[152:153], v201 offset:6144
    ds_read_b64_tr_b16 a[154:155], v201 offset:6400
    ds_read_b64_tr_b16 a[156:157], v201 offset:7168
    ds_read_b64_tr_b16 a[158:159], v201 offset:7424
    s_waitcnt lgkmcnt(0)
    ds_read_b64_tr_b16 a[160:161], v201 offset:8192
    ds_read_b64_tr_b16 a[162:163], v201 offset:8448
    ds_read_b64_tr_b16 a[164:165], v201 offset:9216
    ds_read_b64_tr_b16 a[166:167], v201 offset:9472
    ds_read_b64_tr_b16 a[168:169], v201 offset:10240
    ds_read_b64_tr_b16 a[170:171], v201 offset:10496
    ds_read_b64_tr_b16 a[172:173], v201 offset:11264
    ds_read_b64_tr_b16 a[174:175], v201 offset:11520
    s_waitcnt lgkmcnt(0)
    ds_read_b64_tr_b16 a[176:177], v201 offset:12288
    ds_read_b64_tr_b16 a[178:179], v201 offset:12544
    ds_read_b64_tr_b16 a[180:181], v201 offset:13312
    ds_read_b64_tr_b16 a[182:183], v201 offset:13568
    ds_read_b64_tr_b16 a[184:185], v201 offset:14336
    ds_read_b64_tr_b16 a[186:187], v201 offset:14592
    ds_read_b64_tr_b16 a[188:189], v201 offset:15360
    ds_read_b64_tr_b16 a[190:191], v201 offset:15616
    s_waitcnt lgkmcnt(0)
    s_add_u32 m0, s56, 0
    s_add_u32 s58, s57, 49152
    s_and_b32 s58, s58, 0xffff
    s_lshl_b32 s58, s58, 5
    buffer_load_dwordx4 v200, s[52:55], s58 offen lds
    s_add_u32 m0, s56, 1024
    s_add_u32 s58, s57, 50176
    s_and_b32 s58, s58, 0xffff
    s_lshl_b32 s58, s58, 5
    buffer_load_dwordx4 v200, s[52:55], s58 offen lds
    s_add_u32 m0, s56, 2048
    s_add_u32 s58, s57, 51200
    s_and_b32 s58, s58, 0xffff
    s_lshl_b32 s58, s58, 5
    buffer_load_dwordx4 v200, s[52:55], s58 offen lds
    s_add_u32 m0, s56, 3072
    s_add_u32 s58, s57, 52224
    s_and_b32 s58, s58, 0xffff
    s_lshl_b32 s58, s58, 5
    buffer_load_dwordx4 v200, s[52:55], s58 offen lds
    s_add_u32 m0, s56, 4096
    s_add_u32 s58, s57, 53248
    s_and_b32 s58, s58, 0xffff
    s_lshl_b32 s58, s58, 5
    buffer_load_dwordx4 v200, s[52:55], s58 offen lds
    s_add_u32 m0, s56, 5120
    s_add_u32 s58, s57, 54272
    s_and_b32 s58, s58, 0xffff
    s_lshl_b32 s58, s58, 5
    buffer_load_dwordx4 v200, s[52:55], s58 offen lds
    s_add_u32 m0, s56, 6144
    s_add_u32 s58, s57, 55296
    s_and_b32 s58, s58, 0xffff
    s_lshl_b32 s58, s58, 5
    buffer_load_dwordx4 v200, s[52:55], s58 offen lds
    s_add_u32 m0, s56, 7168
    s_add_u32 s58, s57, 56320
    s_and_b32 s58, s58, 0xffff
    s_lshl_b32 s58, s58, 5
    buffer_load_dwordx4 v200, s[52:55], s58 offen lds
    s_add_u32 m0, s56, 8192
    s_add_u32 s58, s57, 57344
    s_and_b32 s58, s58, 0xffff
    s_lshl_b32 s58, s58, 5
    buffer_load_dwordx4 v200, s[52:55], s58 offen lds
    s_add_u32 m0, s56, 9216
    s_add_u32 s58, s57, 58368
    s_and_b32 s58, s58, 0xffff
    s_lshl_b32 s58, s58, 5
    buffer_load_dwordx4 v200, s[52:55], s58 offen lds
    s_add_u32 m0, s56, 10240
    s_add_u32 s58, s57, 59392
    s_and_b32 s58, s58, 0xffff
    s_lshl_b32 s58, s58, 5
    buffer_load_dwordx4 v200, s[52:55], s58 offen lds
    s_add_u32 m0, s56, 11264
    s_add_u32 s58, s57, 60416
    s_and_b32 s58, s58, 0xffff
    s_lshl_b32 s58, s58, 5
    buffer_load_dwordx4 v200, s[52:55], s58 offen lds
    s_add_u32 m0, s56, 12288
    s_add_u32 s58, s57, 61440
    s_and_b32 s58, s58, 0xffff
    s_lshl_b32 s58, s58, 5
    buffer_load_dwordx4 v200, s[52:55], s58 offen lds
    s_add_u32 m0, s56, 13312
    s_add_u32 s58, s57, 62464
    s_and_b32 s58, s58, 0xffff
    s_lshl_b32 s58, s58, 5
    buffer_load_dwordx4 v200, s[52:55], s58 offen lds
    s_add_u32 m0, s56, 14336
    s_add_u32 s58, s57, 63488
    s_and_b32 s58, s58, 0xffff
    s_lshl_b32 s58, s58, 5
    buffer_load_dwordx4 v200, s[52:55], s58 offen lds
    s_add_u32 m0, s56, 15360
    s_add_u32 s58, s57, 64512
    s_and_b32 s58, s58, 0xffff
    s_lshl_b32 s58, s58, 5
    buffer_load_dwordx4 v200, s[52:55], s58 offen lds
mega_kernel_xo4:
    s_waitcnt vmcnt(0)
    ds_read_b64_tr_b16 a[192:193], v201 offset:0
    ds_read_b64_tr_b16 a[194:195], v201 offset:256
    ds_read_b64_tr_b16 a[196:197], v201 offset:1024
    ds_read_b64_tr_b16 a[198:199], v201 offset:1280
    ds_read_b64_tr_b16 a[200:201], v201 offset:2048
    ds_read_b64_tr_b16 a[202:203], v201 offset:2304
    ds_read_b64_tr_b16 a[204:205], v201 offset:3072
    ds_read_b64_tr_b16 a[206:207], v201 offset:3328
    s_waitcnt lgkmcnt(0)
    ds_read_b64_tr_b16 a[208:209], v201 offset:4096
    ds_read_b64_tr_b16 a[210:211], v201 offset:4352
    ds_read_b64_tr_b16 a[212:213], v201 offset:5120
    ds_read_b64_tr_b16 a[214:215], v201 offset:5376
    ds_read_b64_tr_b16 a[216:217], v201 offset:6144
    ds_read_b64_tr_b16 a[218:219], v201 offset:6400
    ds_read_b64_tr_b16 a[220:221], v201 offset:7168
    ds_read_b64_tr_b16 a[222:223], v201 offset:7424
    s_waitcnt lgkmcnt(0)
    ds_read_b64_tr_b16 a[224:225], v201 offset:8192
    ds_read_b64_tr_b16 a[226:227], v201 offset:8448
    ds_read_b64_tr_b16 a[228:229], v201 offset:9216
    ds_read_b64_tr_b16 a[230:231], v201 offset:9472
    ds_read_b64_tr_b16 a[232:233], v201 offset:10240
    ds_read_b64_tr_b16 a[234:235], v201 offset:10496
    ds_read_b64_tr_b16 a[236:237], v201 offset:11264
    ds_read_b64_tr_b16 a[238:239], v201 offset:11520
    s_waitcnt lgkmcnt(0)
    ds_read_b64_tr_b16 a[240:241], v201 offset:12288
    ds_read_b64_tr_b16 a[242:243], v201 offset:12544
    ds_read_b64_tr_b16 a[244:245], v201 offset:13312
    ds_read_b64_tr_b16 a[246:247], v201 offset:13568
    ds_read_b64_tr_b16 a[248:249], v201 offset:14336
    ds_read_b64_tr_b16 a[250:251], v201 offset:14592
    ds_read_b64_tr_b16 a[252:253], v201 offset:15360
    ds_read_b64_tr_b16 a[254:255], v201 offset:15616
    s_waitcnt lgkmcnt(0)
    s_load_dwordx2 s[8:9], s[0:1], 40
    s_load_dwordx2 s[12:13], s[0:1], 80
    v_lshrrev_b32 v3, 6, v0
    v_and_b32 v1, 63, v0
    v_readfirstlane_b32 s16, v3
    s_lshr_b32 s17, s92, 5
    s_and_b32 s18, s92, 31
    v_lshlrev_b32 v2, 4, v1
    s_waitcnt lgkmcnt(0)
    s_mov_b32 s10, 8388608
    s_mov_b32 s11, 0x00020000
    s_mov_b32 s14, 8388608
    s_mov_b32 s15, 0x00020000
    s_mov_b32 s24, 0x3e0293ee
    s_mov_b64 s[60:61], 0
    s_lshr_b32 s50, s18, 1
    s_lshl_b32 s50, s50, 12
    s_lshl_b32 s47, s17, 2
    s_add_u32 s20, s47, s16
    s_lshl_b32 s20, s20, 18
    s_lshl_b32 s21, s18, 13
    s_add_u32 s20, s20, s21
    s_add_u32 s20, s20, 50331648
    v_lshlrev_b32 v26, 7, v1
    buffer_load_dword v28, v26, s[84:87], s20 offen sc1
    v_and_b32 v4, 15, v1
    v_lshrrev_b32 v5, 4, v1
    v_lshrrev_b32 v3, 2, v4
    v_lshlrev_b32 v3, 1, v3
    v_and_b32 v26, 1, v4
    v_add_u32 v3, v3, v26
    v_lshlrev_b32 v6, 8, v3
    v_lshl_add_u32 v6, v5, 4, v6
    s_lshr_b32 s20, s16, 1
    s_lshl_b32 s20, s20, 10
    s_add_u32 s20, s20, 2048
    v_lshlrev_b32 v7, 3, v1
    v_add_u32 v7, s20, v7
    v_lshlrev_b32 v8, 9, v5
    v_lshl_add_u32 v8, v4, 4, v8
    s_lshr_b32 s20, s16, 1
    s_lshl_b32 s20, s20, 12
    s_and_b32 s21, s16, 1
    s_lshl_b32 s21, s21, 8
    s_add_u32 s20, s20, s21
    v_add_u32 v8, s20, v8
    v_lshlrev_b32 v19, 4, v4
    v_and_b32 v26, 1, v5
    v_lshl_add_u32 v19, v26, 10, v19
    v_lshrrev_b32 v26, 1, v5
    v_lshl_add_u32 v19, v26, 9, v19
    s_and_b32 s20, s17, 1
    s_lshl_b32 s20, s20, 8
    v_add_u32 v19, s20, v19
    v_lshlrev_b32 v26, 2, v5
    v_sub_u32 v9, v4, v26
    s_lshr_b32 s21, s21, 4
    v_add_u32 v9, s21, v9
    v_add_u32 v10, -16, v9
    v_mov_b32 v11, 0xff7fffff
    v_mov_b32 v20, 0x3f803f80
    v_mov_b32 v21, 0x3f803f80
    v_mov_b32 v22, 0x3f803f80
    v_mov_b32 v23, 0x3f803f80
    v_bfe_u32 v26, v1, 1, 2
    v_min_u32 v26, 2, v26
    s_lshl_b32 s20, s18, 8
    s_add_u32 s20, s20, 71303168
    v_lshlrev_b32 v12, 13, v26
    v_and_b32 v26, 1, v1
    v_lshl_add_u32 v12, v26, 7, v12
    v_add_u32 v12, s20, v12
    v_and_b32 v26, 1, v1
    v_lshlrev_b32 v13, 7, v26
    s_add_u32 s20, s20, 24576
    v_add_u32 v13, s20, v13
    v_and_b32 v26, 7, v1
    s_lshl_b32 s20, s17, 5
    s_lshl_b32 s21, s16, 3
    s_add_u32 s20, s20, s21
    v_add_u32 v26, s20, v26
    v_lshlrev_b32 v14, 7, v26
    v_add_u32 v14, 71335936, v14
    v_bfrev_b32 v26, 1
    s_lshl_b32 s20, s92, 7
    s_add_u32 s20, s20, 71335936
    v_mov_b32 v27, s20
    v_cmp_eq_u32 vcc, 0, v0
    s_lshl_b32 s20, s16, 12
    v_add_u32 v17, s20, v2
    v_cndmask_b32 v15, v26, v27, vcc
    v_lshrrev_b32 v26, 3, v0
    v_and_b32 v27, 1, v0
    v_lshl_add_u32 v27, v27, 5, v26
    v_lshlrev_b32 v16, 4, v27
    v_bfe_u32 v27, v0, 1, 2
    v_lshl_add_u32 v16, v27, 10, v16
    v_lshlrev_b32 v18, 12, v26
    v_and_b32 v27, 7, v0
    v_lshl_add_u32 v18, v27, 3, v18
    s_lshl_b32 s20, s18, 6
    v_add_u32 v18, s20, v18
    s_barrier
    s_cmp_eq_u32 s17, 0
    s_cselect_b32 s60, 0x41041000, s60
    s_cselect_b32 s61, 0x24110410, s61
    s_cmp_eq_u32 s17, 1
    s_cselect_b32 s60, 0x20820800, s60
    s_cselect_b32 s61, 0x24208208, s61
    s_cmp_eq_u32 s17, 2
    s_cselect_b32 s60, 0x10410400, s60
    s_cselect_b32 s61, 0x48404104, s61
    s_cmp_eq_u32 s17, 3
    s_cselect_b32 s60, 0x8208200, s60
    s_cselect_b32 s61, 0x48882082, s61
    s_cmp_eq_u32 s17, 4
    s_cselect_b32 s60, 0x820820a8, s60
    s_cselect_b32 s61, 0x91020820, s61
    s_cmp_eq_u32 s17, 5
    s_cselect_b32 s60, 0x4104157, s60
    s_cselect_b32 s61, 0x92041041, s61
    s_ff1_i32_b64 s22, s[60:61]
mega_kernel_x_gp:
    buffer_load_dword v3, v12, s[84:87], 0 offen sc1
    s_waitcnt vmcnt(0)
    v_cmp_ne_u32 vcc, 32, v3
    s_cbranch_vccz mega_kernel_x_gk
    s_sleep 8
    s_branch mega_kernel_x_gp
mega_kernel_x_gk:
    s_mov_b32 s46, 0
    s_lshl_b32 s27, s22, 18
    s_lshl_b32 s20, s18, 13
    s_add_u32 s27, s27, s20
    s_add_u32 s29, s27, 178257920
    s_and_b32 s20, s16, 1
    s_lshl_b32 s20, s20, 10
    s_add_u32 s26, s27, s20
    s_add_u32 s26, s26, 0
    s_lshr_b32 s20, s16, 1
    s_lshl_b32 s20, s20, 12
    s_add_u32 s28, s27, s20
    s_add_u32 s28, s28, 33554432
    s_add_u32 s27, s27, 16777216
    s_add_u32 s48, s26, 4096
    s_add_u32 s49, s27, 4096
mega_kernel_x_ldq:
    buffer_load_dwordx4 v[24:27], v2, s[84:87], s26 offen offset:0
    buffer_load_dwordx4 v[28:31], v2, s[84:87], s26 offen offset:2048
    buffer_load_dwordx4 v[32:35], v2, s[84:87], s48 offen offset:0
    buffer_load_dwordx4 v[36:39], v2, s[84:87], s48 offen offset:2048
    buffer_load_dwordx4 v[40:43], v2, s[84:87], s27 offen offset:0
    buffer_load_dwordx4 v[44:47], v2, s[84:87], s27 offen offset:1024
    buffer_load_dwordx4 v[48:51], v2, s[84:87], s27 offen offset:2048
    buffer_load_dwordx4 v[52:55], v2, s[84:87], s27 offen offset:3072
    buffer_load_dwordx4 v[56:59], v2, s[84:87], s49 offen offset:0
    buffer_load_dwordx4 v[60:63], v2, s[84:87], s49 offen offset:1024
    buffer_load_dwordx4 v[64:67], v2, s[84:87], s49 offen offset:2048
    buffer_load_dwordx4 v[68:71], v2, s[84:87], s49 offen offset:3072
    buffer_load_dwordx4 v[72:75], v2, s[84:87], s28 offen offset:0
    buffer_load_dwordx4 v[76:79], v2, s[84:87], s28 offen offset:1024
    buffer_load_dwordx4 v[80:83], v2, s[84:87], s28 offen offset:2048
    buffer_load_dwordx4 v[84:87], v2, s[84:87], s28 offen offset:3072
mega_kernel_x_att:
    s_waitcnt vmcnt(0)
    v_mfma_f32_16x16x32_bf16 v[112:115], v[40:43], v[24:27], 0
    v_mfma_f32_16x16x32_bf16 v[116:119], v[44:47], v[24:27], 0
    v_mfma_f32_16x16x32_bf16 v[112:115], v[48:51], v[28:31], v[112:115]
    v_mfma_f32_16x16x32_bf16 v[116:119], v[52:55], v[28:31], v[116:119]
    v_mfma_f32_16x16x32_bf16 v[112:115], v[56:59], v[32:35], v[112:115]
    v_mfma_f32_16x16x32_bf16 v[116:119], v[60:63], v[32:35], v[116:119]
    v_mfma_f32_16x16x32_bf16 v[112:115], v[64:67], v[36:39], v[112:115]
    v_mfma_f32_16x16x32_bf16 v[116:119], v[68:71], v[36:39], v[116:119]
    s_lshl_b32 s41, s47, 18
    s_add_u32 s41, s41, 50331648
    s_lshl_b32 s20, s18, 13
    s_add_u32 s40, s41, s20
    s_lshl_b32 s20, s16, 16
    s_add_u32 s41, s41, s20
    s_lshl_b32 s42, s22, 17
    v_mov_b32 v130, v20
    v_mov_b32 v131, 0
    v_cmp_gt_i32 vcc, 0, v9
    s_nop 1
    v_cndmask_b32 v112, v112, v11, vcc
    v_cmp_gt_i32 vcc, 1, v9
    s_nop 1
    v_cndmask_b32 v113, v113, v11, vcc
    v_cmp_gt_i32 vcc, 2, v9
    s_nop 1
    v_cndmask_b32 v114, v114, v11, vcc
    v_cmp_gt_i32 vcc, 3, v9
    s_nop 1
    v_cndmask_b32 v115, v115, v11, vcc
    v_cmp_gt_i32 vcc, 0, v10
    s_nop 1
    v_cndmask_b32 v116, v116, v11, vcc
    v_cmp_gt_i32 vcc, 1, v10
    s_nop 1
    v_cndmask_b32 v117, v117, v11, vcc
    v_cmp_gt_i32 vcc, 2, v10
    s_nop 1
    v_cndmask_b32 v118, v118, v11, vcc
    v_cmp_gt_i32 vcc, 3, v10
    s_nop 1
    v_cndmask_b32 v119, v119, v11, vcc
    s_cmp_eq_u32 s46, 1
    s_cbranch_scc1 mega_kernel_x_rd
mega_kernel_x_rp:
    buffer_load_dword v3, v13, s[84:87], 0 offen sc1
    s_waitcnt vmcnt(0)
    v_cmp_ge_u32 vcc, s22, v3
    s_cbranch_vccz mega_kernel_x_rk
    s_sleep 2
    s_branch mega_kernel_x_rp
mega_kernel_x_rk:
    buffer_load_dwordx4 v[88:91], v6, s[84:87], s29 offen offset:0 sc1
    buffer_load_dwordx4 v[92:95], v6, s[84:87], s29 offen offset:64 sc1
    buffer_load_dwordx4 v[96:99], v6, s[84:87], s29 offen offset:128 sc1
    buffer_load_dwordx4 v[100:103], v6, s[84:87], s29 offen offset:192 sc1
    buffer_load_dwordx2 v[104:105], v7, s[84:87], s29 offen offset:0 sc1
    buffer_load_dwordx2 v[106:107], v7, s[84:87], s29 offen offset:2048 sc1
    buffer_load_dwordx2 v[108:109], v7, s[84:87], s29 offen offset:512 sc1
    buffer_load_dwordx2 v[110:111], v7, s[84:87], s29 offen offset:2560 sc1
mega_kernel_x_rd:
    s_waitcnt vmcnt(7)
    v_mfma_f32_16x16x32_bf16 v[120:123], v[88:91], v[24:27], 0
    s_waitcnt vmcnt(6)
    v_mfma_f32_16x16x32_bf16 v[120:123], v[92:95], v[28:31], v[120:123]
    s_waitcnt vmcnt(5)
    v_mfma_f32_16x16x32_bf16 v[120:123], v[96:99], v[32:35], v[120:123]
    s_waitcnt vmcnt(4)
    v_mfma_f32_16x16x32_bf16 v[120:123], v[100:103], v[36:39], v[120:123]
    v_max3_f32 v4, v112, v113, v114
    v_max3_f32 v4, v4, v115, v116
    v_max3_f32 v4, v4, v117, v118
    s_waitcnt vmcnt(0)
    v_swap_b32 v105, v106
    v_swap_b32 v109, v110
    s_nop 1
    v_max3_f32 v4, v4, v119, v120
    v_max_f32 v3, v4, v121
    v_max_f32 v4, v4, v121
    s_nop 1
    v_permlane16_swap_b32 v4, v3
    v_max_f32 v4, v4, v3
    v_max_f32 v3, v4, v3
    s_nop 1
    v_permlane32_swap_b32 v4, v3
    v_max_f32 v4, v4, v3
    v_mul_f32 v4, s24, v4
    v_fma_f32 v112, v112, s24, -v4
    v_fma_f32 v113, v113, s24, -v4
    v_fma_f32 v114, v114, s24, -v4
    v_fma_f32 v115, v115, s24, -v4
    v_fma_f32 v116, v116, s24, -v4
    v_fma_f32 v117, v117, s24, -v4
    v_fma_f32 v118, v118, s24, -v4
    v_fma_f32 v119, v119, s24, -v4
    v_fma_f32 v120, v120, s24, -v4
    v_fma_f32 v121, v121, s24, -v4
    v_exp_f32 v112, v112
    v_exp_f32 v113, v113
    v_exp_f32 v114, v114
    v_exp_f32 v115, v115
    v_exp_f32 v116, v116
    v_exp_f32 v117, v117
    v_exp_f32 v118, v118
    v_exp_f32 v119, v119
    v_exp_f32 v120, v120
    v_exp_f32 v121, v121
    s_nop 0
    v_cvt_pk_bf16_f32 v124, v112, v113
    v_cvt_pk_bf16_f32 v125, v114, v115
    v_cvt_pk_bf16_f32 v126, v116, v117
    v_cvt_pk_bf16_f32 v127, v118, v119
    v_cvt_pk_bf16_f32 v128, v120, v121
    v_mov_b32 v129, v128
    s_nop 1
    v_mfma_f32_16x16x32_bf16 v[132:135], v[20:23], v[124:127], 0
    v_mfma_f32_16x16x32_bf16 v[88:91], v[72:75], v[124:127], 0
    v_mfma_f32_16x16x32_bf16 v[92:95], v[76:79], v[124:127], 0
    v_mfma_f32_16x16x32_bf16 v[96:99], v[80:83], v[124:127], 0
    v_mfma_f32_16x16x32_bf16 v[100:103], v[84:87], v[124:127], 0
    s_nop 1
    v_mfma_f32_16x16x16_bf16 v[132:135], v[130:131], v[128:129], v[132:135]
    v_mfma_f32_16x16x16_bf16 v[88:91], v[104:105], v[128:129], v[88:91]
    v_mfma_f32_16x16x16_bf16 v[92:95], v[106:107], v[128:129], v[92:95]
    v_mfma_f32_16x16x16_bf16 v[96:99], v[108:109], v[128:129], v[96:99]
    v_mfma_f32_16x16x16_bf16 v[100:103], v[110:111], v[128:129], v[100:103]
    s_nop 3
    v_rcp_f32 v132, v132
    s_nop 2
    v_pk_mul_f32 v[88:89], v[88:89], v[132:133] op_sel_hi:[1,0]
    v_pk_mul_f32 v[90:91], v[90:91], v[132:133] op_sel_hi:[1,0]
    v_pk_mul_f32 v[92:93], v[92:93], v[132:133] op_sel_hi:[1,0]
    v_pk_mul_f32 v[94:95], v[94:95], v[132:133] op_sel_hi:[1,0]
    v_pk_mul_f32 v[96:97], v[96:97], v[132:133] op_sel_hi:[1,0]
    v_pk_mul_f32 v[98:99], v[98:99], v[132:133] op_sel_hi:[1,0]
    v_pk_mul_f32 v[100:101], v[100:101], v[132:133] op_sel_hi:[1,0]
    v_pk_mul_f32 v[102:103], v[102:103], v[132:133] op_sel_hi:[1,0]
    v_cvt_pk_bf16_f32 v112, v88, v89
    v_cvt_pk_bf16_f32 v113, v90, v91
    v_cvt_pk_bf16_f32 v114, v92, v93
    v_cvt_pk_bf16_f32 v115, v94, v95
    v_cvt_pk_bf16_f32 v116, v96, v97
    v_cvt_pk_bf16_f32 v117, v98, v99
    v_cvt_pk_bf16_f32 v118, v100, v101
    v_cvt_pk_bf16_f32 v119, v102, v103
    s_add_u32 s43, s22, 1
    v_mov_b32 v4, s43
    s_cmp_eq_u32 s96, 1
    s_cbranch_scc1 mega_kernel_x_of
    buffer_store_dwordx4 v[112:115], v8, s[84:87], s40 offen sc1
    buffer_store_dwordx4 v[116:119], v8, s[84:87], s40 offen offset:2048 sc1
    s_waitcnt vmcnt(0)
    s_barrier
    buffer_store_dword v4, v15, s[84:87], 0 offen sc1
    s_branch mega_kernel_x_od
mega_kernel_x_of:
    buffer_store_dwordx4 v[112:115], v8, s[84:87], s40 offen
    buffer_store_dwordx4 v[116:119], v8, s[84:87], s40 offen offset:2048
    s_waitcnt vmcnt(0)
    s_barrier
    buffer_store_dword v4, v15, s[84:87], 0 offen
mega_kernel_x_od:
    s_mov_b32 s45, s22
    s_add_u32 s20, s47, 1
    s_and_b32 s20, s20, 3
    s_andn2_b32 s47, s47, 3
    s_or_b32 s47, s47, s20
    s_bitset0_b64 s[60:61], s22
    s_ff1_i32_b64 s22, s[60:61]
    s_min_u32 s22, s22, 64
    s_lshl_b32 s27, s22, 18
    s_lshl_b32 s20, s18, 13
    s_add_u32 s27, s27, s20
    s_add_u32 s29, s27, 178257920
    s_and_b32 s20, s16, 1
    s_lshl_b32 s20, s20, 10
    s_add_u32 s26, s27, s20
    s_add_u32 s26, s26, 0
    s_lshr_b32 s20, s16, 1
    s_lshl_b32 s20, s20, 12
    s_add_u32 s28, s27, s20
    s_add_u32 s28, s28, 33554432
    s_add_u32 s27, s27, 16777216
    s_add_u32 s48, s26, 4096
    s_add_u32 s49, s27, 4096
mega_kernel_x_xp:
    buffer_load_dword v3, v14, s[84:87], 0 offen sc1
    s_waitcnt vmcnt(0)
    v_cmp_ge_u32 vcc, s45, v3
    s_cbranch_vccnz mega_kernel_x_xp
    s_cmp_ge_u32 s45, 58
    s_cbranch_scc1 mega_kernel_x_half
    s_add_u32 s20, s50, 0
    s_and_b32 s20, s20, 0xffff
    s_add_u32 s20, s20, s41
    buffer_load_dwordx4 v[136:139], v2, s[84:87], s20 offen offset:0 sc1
    buffer_load_dwordx4 v[140:143], v2, s[84:87], s20 offen offset:1024 sc1
    buffer_load_dwordx4 v[144:147], v2, s[84:87], s20 offen offset:2048 sc1
    buffer_load_dwordx4 v[148:151], v2, s[84:87], s20 offen offset:3072 sc1
    s_add_u32 s20, s50, 4096
    s_and_b32 s20, s20, 0xffff
    s_add_u32 s20, s20, s41
    buffer_load_dwordx4 v[152:155], v2, s[84:87], s20 offen offset:0 sc1
    buffer_load_dwordx4 v[156:159], v2, s[84:87], s20 offen offset:1024 sc1
    buffer_load_dwordx4 v[160:163], v2, s[84:87], s20 offen offset:2048 sc1
    buffer_load_dwordx4 v[164:167], v2, s[84:87], s20 offen offset:3072 sc1
    s_add_u32 s20, s50, 8192
    s_and_b32 s20, s20, 0xffff
    s_add_u32 s20, s20, s41
    buffer_load_dwordx4 v[168:171], v2, s[84:87], s20 offen offset:0 sc1
    buffer_load_dwordx4 v[172:175], v2, s[84:87], s20 offen offset:1024 sc1
    buffer_load_dwordx4 v[176:179], v2, s[84:87], s20 offen offset:2048 sc1
    buffer_load_dwordx4 v[180:183], v2, s[84:87], s20 offen offset:3072 sc1
    buffer_load_dword v5, v13, s[84:87], 0 offen sc1
    s_waitcnt vmcnt(12)
    v_mfma_f32_32x32x16_bf16 v[112:127], a[0:3], v[136:139], 0
    s_add_u32 s20, s50, 12288
    s_and_b32 s20, s20, 0xffff
    s_add_u32 s20, s20, s41
    buffer_load_dwordx4 v[184:187], v2, s[84:87], s20 offen offset:0 sc1
    s_waitcnt vmcnt(12)
    v_mfma_f32_32x32x16_bf16 v[112:127], a[4:7], v[140:143], v[112:127]
    buffer_load_dwordx4 v[188:191], v2, s[84:87], s20 offen offset:1024 sc1
    s_waitcnt vmcnt(12)
    v_mfma_f32_32x32x16_bf16 v[112:127], a[8:11], v[144:147], v[112:127]
    buffer_load_dwordx4 v[192:195], v2, s[84:87], s20 offen offset:2048 sc1
    s_waitcnt vmcnt(12)
    v_mfma_f32_32x32x16_bf16 v[112:127], a[12:15], v[148:151], v[112:127]
    buffer_load_dwordx4 v[196:199], v2, s[84:87], s20 offen offset:3072 sc1
    s_waitcnt vmcnt(12)
    v_mfma_f32_32x32x16_bf16 v[112:127], a[16:19], v[152:155], v[112:127]
    s_add_u32 s20, s50, 16384
    s_and_b32 s20, s20, 0xffff
    s_add_u32 s20, s20, s41
    buffer_load_dwordx4 v[200:203], v2, s[84:87], s20 offen offset:0 sc1
    s_waitcnt vmcnt(12)
    v_mfma_f32_32x32x16_bf16 v[112:127], a[20:23], v[156:159], v[112:127]
    buffer_load_dwordx4 v[204:207], v2, s[84:87], s20 offen offset:1024 sc1
    s_waitcnt vmcnt(12)
    v_mfma_f32_32x32x16_bf16 v[112:127], a[24:27], v[160:163], v[112:127]
    buffer_load_dwordx4 v[208:211], v2, s[84:87], s20 offen offset:2048 sc1
    s_waitcnt vmcnt(12)
    v_mfma_f32_32x32x16_bf16 v[112:127], a[28:31], v[164:167], v[112:127]
    buffer_load_dwordx4 v[212:215], v2, s[84:87], s20 offen offset:3072 sc1
    s_waitcnt vmcnt(12)
    v_mfma_f32_32x32x16_bf16 v[112:127], a[32:35], v[168:171], v[112:127]
    s_add_u32 s20, s50, 20480
    s_and_b32 s20, s20, 0xffff
    s_add_u32 s20, s20, s41
    buffer_load_dwordx4 v[216:219], v2, s[84:87], s20 offen offset:0 sc1
    s_waitcnt vmcnt(12)
    v_mfma_f32_32x32x16_bf16 v[112:127], a[36:39], v[172:175], v[112:127]
    buffer_load_dwordx4 v[220:223], v2, s[84:87], s20 offen offset:1024 sc1
    s_waitcnt vmcnt(12)
    v_mfma_f32_32x32x16_bf16 v[112:127], a[40:43], v[176:179], v[112:127]
    buffer_load_dwordx4 v[224:227], v2, s[84:87], s20 offen offset:2048 sc1
    s_waitcnt vmcnt(12)
    v_mfma_f32_32x32x16_bf16 v[112:127], a[44:47], v[180:183], v[112:127]
    buffer_load_dwordx4 v[228:231], v2, s[84:87], s20 offen offset:3072 sc1
    s_waitcnt vmcnt(11)
    v_mfma_f32_32x32x16_bf16 v[112:127], a[48:51], v[184:187], v[112:127]
    s_add_u32 s20, s50, 24576
    s_and_b32 s20, s20, 0xffff
    s_add_u32 s20, s20, s41
    buffer_load_dwordx4 v[232:235], v2, s[84:87], s20 offen offset:0 sc1
    v_cmp_ge_u32 vcc, s22, v5
    s_waitcnt vmcnt(11)
    v_mfma_f32_32x32x16_bf16 v[112:127], a[52:55], v[188:191], v[112:127]
    buffer_load_dwordx4 v[236:239], v2, s[84:87], s20 offen offset:1024 sc1
    s_cmp_eq_u64 vcc, 0
    s_cselect_b32 s46, 1, 0
    s_waitcnt vmcnt(11)
    v_mfma_f32_32x32x16_bf16 v[112:127], a[56:59], v[192:195], v[112:127]
    buffer_load_dwordx4 v[240:243], v2, s[84:87], s20 offen offset:2048 sc1
    s_waitcnt vmcnt(11)
    v_mfma_f32_32x32x16_bf16 v[112:127], a[60:63], v[196:199], v[112:127]
    buffer_load_dwordx4 v[244:247], v2, s[84:87], s20 offen offset:3072 sc1
    s_waitcnt vmcnt(11)
    v_mfma_f32_32x32x16_bf16 v[112:127], a[64:67], v[200:203], v[112:127]
    s_add_u32 s20, s50, 28672
    s_and_b32 s20, s20, 0xffff
    s_add_u32 s20, s20, s41
    buffer_load_dwordx4 v[248:251], v2, s[84:87], s20 offen offset:0 sc1
    s_waitcnt vmcnt(11)
    v_mfma_f32_32x32x16_bf16 v[112:127], a[68:71], v[204:207], v[112:127]
    buffer_load_dwordx4 v[252:255], v2, s[84:87], s20 offen offset:1024 sc1
    s_waitcnt vmcnt(11)
    v_mfma_f32_32x32x16_bf16 v[112:127], a[72:75], v[208:211], v[112:127]
    buffer_load_dwordx4 v[136:139], v2, s[84:87], s20 offen offset:2048 sc1
    s_waitcnt vmcnt(11)
    v_mfma_f32_32x32x16_bf16 v[112:127], a[76:79], v[212:215], v[112:127]
    buffer_load_dwordx4 v[140:143], v2, s[84:87], s20 offen offset:3072 sc1
    s_waitcnt vmcnt(11)
    v_mfma_f32_32x32x16_bf16 v[112:127], a[80:83], v[216:219], v[112:127]
    s_add_u32 s20, s50, 32768
    s_and_b32 s20, s20, 0xffff
    s_add_u32 s20, s20, s41
    buffer_load_dwordx4 v[144:147], v2, s[84:87], s20 offen offset:0 sc1
    s_waitcnt vmcnt(11)
    v_mfma_f32_32x32x16_bf16 v[112:127], a[84:87], v[220:223], v[112:127]
    buffer_load_dwordx4 v[148:151], v2, s[84:87], s20 offen offset:1024 sc1
    s_waitcnt vmcnt(11)
    v_mfma_f32_32x32x16_bf16 v[112:127], a[88:91], v[224:227], v[112:127]
    buffer_load_dwordx4 v[152:155], v2, s[84:87], s20 offen offset:2048 sc1
    s_waitcnt vmcnt(11)
    v_mfma_f32_32x32x16_bf16 v[112:127], a[92:95], v[228:231], v[112:127]
    buffer_load_dwordx4 v[156:159], v2, s[84:87], s20 offen offset:3072 sc1
    s_waitcnt vmcnt(11)
    v_mfma_f32_32x32x16_bf16 v[112:127], a[96:99], v[232:235], v[112:127]
    s_add_u32 s20, s50, 36864
    s_and_b32 s20, s20, 0xffff
    s_add_u32 s20, s20, s41
    buffer_load_dwordx4 v[160:163], v2, s[84:87], s20 offen offset:0 sc1
    s_waitcnt vmcnt(11)
    v_mfma_f32_32x32x16_bf16 v[112:127], a[100:103], v[236:239], v[112:127]
    buffer_load_dwordx4 v[164:167], v2, s[84:87], s20 offen offset:1024 sc1
    s_waitcnt vmcnt(11)
    v_mfma_f32_32x32x16_bf16 v[112:127], a[104:107], v[240:243], v[112:127]
    buffer_load_dwordx4 v[168:171], v2, s[84:87], s20 offen offset:2048 sc1
    s_waitcnt vmcnt(11)
    v_mfma_f32_32x32x16_bf16 v[112:127], a[108:111], v[244:247], v[112:127]
    buffer_load_dwordx4 v[172:175], v2, s[84:87], s20 offen offset:3072 sc1
    s_waitcnt vmcnt(11)
    v_mfma_f32_32x32x16_bf16 v[112:127], a[112:115], v[248:251], v[112:127]
    s_add_u32 s20, s50, 40960
    s_and_b32 s20, s20, 0xffff
    s_add_u32 s20, s20, s41
    buffer_load_dwordx4 v[176:179], v2, s[84:87], s20 offen offset:0 sc1
    s_waitcnt vmcnt(11)
    v_mfma_f32_32x32x16_bf16 v[112:127], a[116:119], v[252:255], v[112:127]
    buffer_load_dwordx4 v[180:183], v2, s[84:87], s20 offen offset:1024 sc1
    s_waitcnt vmcnt(11)
    v_mfma_f32_32x32x16_bf16 v[112:127], a[120:123], v[136:139], v[112:127]
    buffer_load_dwordx4 v[184:187], v2, s[84:87], s20 offen offset:2048 sc1
    s_waitcnt vmcnt(11)
    v_mfma_f32_32x32x16_bf16 v[112:127], a[124:127], v[140:143], v[112:127]
    buffer_load_dwordx4 v[188:191], v2, s[84:87], s20 offen offset:3072 sc1
    s_waitcnt vmcnt(11)
    v_mfma_f32_32x32x16_bf16 v[112:127], a[128:131], v[144:147], v[112:127]
    s_add_u32 s20, s50, 45056
    s_and_b32 s20, s20, 0xffff
    s_add_u32 s20, s20, s41
    buffer_load_dwordx4 v[192:195], v2, s[84:87], s20 offen offset:0 sc1
    s_waitcnt vmcnt(11)
    v_mfma_f32_32x32x16_bf16 v[112:127], a[132:135], v[148:151], v[112:127]
    buffer_load_dwordx4 v[196:199], v2, s[84:87], s20 offen offset:1024 sc1
    s_waitcnt vmcnt(11)
    v_mfma_f32_32x32x16_bf16 v[112:127], a[136:139], v[152:155], v[112:127]
    buffer_load_dwordx4 v[200:203], v2, s[84:87], s20 offen offset:2048 sc1
    s_waitcnt vmcnt(11)
    v_mfma_f32_32x32x16_bf16 v[112:127], a[140:143], v[156:159], v[112:127]
    buffer_load_dwordx4 v[204:207], v2, s[84:87], s20 offen offset:3072 sc1
    s_waitcnt vmcnt(11)
    v_mfma_f32_32x32x16_bf16 v[112:127], a[144:147], v[160:163], v[112:127]
    s_add_u32 s20, s50, 49152
    s_and_b32 s20, s20, 0xffff
    s_add_u32 s20, s20, s41
    buffer_load_dwordx4 v[208:211], v2, s[84:87], s20 offen offset:0 sc1
    s_waitcnt vmcnt(11)
    v_mfma_f32_32x32x16_bf16 v[112:127], a[148:151], v[164:167], v[112:127]
    buffer_load_dwordx4 v[212:215], v2, s[84:87], s20 offen offset:1024 sc1
    s_waitcnt vmcnt(11)
    v_mfma_f32_32x32x16_bf16 v[112:127], a[152:155], v[168:171], v[112:127]
    buffer_load_dwordx4 v[216:219], v2, s[84:87], s20 offen offset:2048 sc1
    s_waitcnt vmcnt(11)
    v_mfma_f32_32x32x16_bf16 v[112:127], a[156:159], v[172:175], v[112:127]
    buffer_load_dwordx4 v[220:223], v2, s[84:87], s20 offen offset:3072 sc1
    s_waitcnt vmcnt(11)
    v_mfma_f32_32x32x16_bf16 v[112:127], a[160:163], v[176:179], v[112:127]
    s_add_u32 s20, s50, 53248
    s_and_b32 s20, s20, 0xffff
    s_add_u32 s20, s20, s41
    buffer_load_dwordx4 v[224:227], v2, s[84:87], s20 offen offset:0 sc1
    s_waitcnt vmcnt(11)
    v_mfma_f32_32x32x16_bf16 v[112:127], a[164:167], v[180:183], v[112:127]
    buffer_load_dwordx4 v[228:231], v2, s[84:87], s20 offen offset:1024 sc1
    s_waitcnt vmcnt(11)
    v_mfma_f32_32x32x16_bf16 v[112:127], a[168:171], v[184:187], v[112:127]
    buffer_load_dwordx4 v[232:235], v2, s[84:87], s20 offen offset:2048 sc1
    s_waitcnt vmcnt(11)
    v_mfma_f32_32x32x16_bf16 v[112:127], a[172:175], v[188:191], v[112:127]
    buffer_load_dwordx4 v[236:239], v2, s[84:87], s20 offen offset:3072 sc1
    s_waitcnt vmcnt(11)
    v_mfma_f32_32x32x16_bf16 v[112:127], a[176:179], v[192:195], v[112:127]
    s_add_u32 s20, s50, 57344
    s_and_b32 s20, s20, 0xffff
    s_add_u32 s20, s20, s41
    buffer_load_dwordx4 v[240:243], v2, s[84:87], s20 offen offset:0 sc1
    s_waitcnt vmcnt(11)
    v_mfma_f32_32x32x16_bf16 v[112:127], a[180:183], v[196:199], v[112:127]
    buffer_load_dwordx4 v[244:247], v2, s[84:87], s20 offen offset:1024 sc1
    s_waitcnt vmcnt(11)
    v_mfma_f32_32x32x16_bf16 v[112:127], a[184:187], v[200:203], v[112:127]
    buffer_load_dwordx4 v[248:251], v2, s[84:87], s20 offen offset:2048 sc1
    s_waitcnt vmcnt(11)
    v_mfma_f32_32x32x16_bf16 v[112:127], a[188:191], v[204:207], v[112:127]
    buffer_load_dwordx4 v[252:255], v2, s[84:87], s20 offen offset:3072 sc1
    s_waitcnt vmcnt(11)
    v_mfma_f32_32x32x16_bf16 v[112:127], a[192:195], v[208:211], v[112:127]
    s_add_u32 s20, s50, 61440
    s_and_b32 s20, s20, 0xffff
    s_add_u32 s20, s20, s41
    buffer_load_dwordx4 v[136:139], v2, s[84:87], s20 offen offset:0 sc1
    s_waitcnt vmcnt(11)
    v_mfma_f32_32x32x16_bf16 v[112:127], a[196:199], v[212:215], v[112:127]
    buffer_load_dwordx4 v[140:143], v2, s[84:87], s20 offen offset:1024 sc1
    s_waitcnt vmcnt(11)
    v_mfma_f32_32x32x16_bf16 v[112:127], a[200:203], v[216:219], v[112:127]
    buffer_load_dwordx4 v[144:147], v2, s[84:87], s20 offen offset:2048 sc1
    s_waitcnt vmcnt(11)
    v_mfma_f32_32x32x16_bf16 v[112:127], a[204:207], v[220:223], v[112:127]
    buffer_load_dwordx4 v[148:151], v2, s[84:87], s20 offen offset:3072 sc1
    s_cmp_eq_u32 s46, 1
    s_cbranch_scc1 mega_kernel_x_pfx
    s_waitcnt vmcnt(11)
    v_mfma_f32_32x32x16_bf16 v[112:127], a[208:211], v[224:227], v[112:127]
    s_waitcnt vmcnt(10)
    v_mfma_f32_32x32x16_bf16 v[112:127], a[212:215], v[228:231], v[112:127]
    s_waitcnt vmcnt(9)
    v_mfma_f32_32x32x16_bf16 v[112:127], a[216:219], v[232:235], v[112:127]
    s_waitcnt vmcnt(8)
    v_mfma_f32_32x32x16_bf16 v[112:127], a[220:223], v[236:239], v[112:127]
    s_waitcnt vmcnt(7)
    v_mfma_f32_32x32x16_bf16 v[112:127], a[224:227], v[240:243], v[112:127]
    s_waitcnt vmcnt(6)
    v_mfma_f32_32x32x16_bf16 v[112:127], a[228:231], v[244:247], v[112:127]
    s_waitcnt vmcnt(5)
    v_mfma_f32_32x32x16_bf16 v[112:127], a[232:235], v[248:251], v[112:127]
    s_waitcnt vmcnt(4)
    v_mfma_f32_32x32x16_bf16 v[112:127], a[236:239], v[252:255], v[112:127]
    s_waitcnt vmcnt(3)
    v_mfma_f32_32x32x16_bf16 v[112:127], a[240:243], v[136:139], v[112:127]
    s_waitcnt vmcnt(2)
    v_mfma_f32_32x32x16_bf16 v[112:127], a[244:247], v[140:143], v[112:127]
    s_waitcnt vmcnt(1)
    v_mfma_f32_32x32x16_bf16 v[112:127], a[248:251], v[144:147], v[112:127]
    s_waitcnt vmcnt(0)
    v_mfma_f32_32x32x16_bf16 v[112:127], a[252:255], v[148:151], v[112:127]
    s_branch mega_kernel_x_pfd
mega_kernel_x_pfx:
    s_waitcnt vmcnt(11)
    v_mfma_f32_32x32x16_bf16 v[112:127], a[208:211], v[224:227], v[112:127]
    buffer_load_dwordx4 v[24:27], v2, s[84:87], s26 offen offset:0
    buffer_load_dwordx4 v[28:31], v2, s[84:87], s26 offen offset:2048
    s_waitcnt vmcnt(12)
    v_mfma_f32_32x32x16_bf16 v[112:127], a[212:215], v[228:231], v[112:127]
    buffer_load_dwordx4 v[32:35], v2, s[84:87], s48 offen offset:0
    buffer_load_dwordx4 v[36:39], v2, s[84:87], s48 offen offset:2048
    s_waitcnt vmcnt(13)
    v_mfma_f32_32x32x16_bf16 v[112:127], a[216:219], v[232:235], v[112:127]
    buffer_load_dwordx4 v[40:43], v2, s[84:87], s27 offen offset:0
    buffer_load_dwordx4 v[44:47], v2, s[84:87], s27 offen offset:1024
    s_waitcnt vmcnt(14)
    v_mfma_f32_32x32x16_bf16 v[112:127], a[220:223], v[236:239], v[112:127]
    buffer_load_dwordx4 v[48:51], v2, s[84:87], s27 offen offset:2048
    buffer_load_dwordx4 v[52:55], v2, s[84:87], s27 offen offset:3072
    s_waitcnt vmcnt(15)
    v_mfma_f32_32x32x16_bf16 v[112:127], a[224:227], v[240:243], v[112:127]
    buffer_load_dwordx4 v[56:59], v2, s[84:87], s49 offen offset:0
    buffer_load_dwordx4 v[60:63], v2, s[84:87], s49 offen offset:1024
    s_waitcnt vmcnt(16)
    v_mfma_f32_32x32x16_bf16 v[112:127], a[228:231], v[244:247], v[112:127]
    buffer_load_dwordx4 v[64:67], v2, s[84:87], s49 offen offset:2048
    buffer_load_dwordx4 v[68:71], v2, s[84:87], s49 offen offset:3072
    s_waitcnt vmcnt(17)
    v_mfma_f32_32x32x16_bf16 v[112:127], a[232:235], v[248:251], v[112:127]
    buffer_load_dwordx4 v[72:75], v2, s[84:87], s28 offen offset:0
    buffer_load_dwordx4 v[76:79], v2, s[84:87], s28 offen offset:1024
    s_waitcnt vmcnt(18)
    v_mfma_f32_32x32x16_bf16 v[112:127], a[236:239], v[252:255], v[112:127]
    buffer_load_dwordx4 v[80:83], v2, s[84:87], s28 offen offset:2048
    buffer_load_dwordx4 v[84:87], v2, s[84:87], s28 offen offset:3072
    s_waitcnt vmcnt(19)
    v_mfma_f32_32x32x16_bf16 v[112:127], a[240:243], v[136:139], v[112:127]
    buffer_load_dwordx4 v[88:91], v6, s[84:87], s29 offen offset:0 sc1
    buffer_load_dwordx4 v[92:95], v6, s[84:87], s29 offen offset:64 sc1
    s_waitcnt vmcnt(20)
    v_mfma_f32_32x32x16_bf16 v[112:127], a[244:247], v[140:143], v[112:127]
    buffer_load_dwordx4 v[96:99], v6, s[84:87], s29 offen offset:128 sc1
    buffer_load_dwordx4 v[100:103], v6, s[84:87], s29 offen offset:192 sc1
    s_waitcnt vmcnt(21)
    v_mfma_f32_32x32x16_bf16 v[112:127], a[248:251], v[144:147], v[112:127]
    buffer_load_dwordx2 v[104:105], v7, s[84:87], s29 offen offset:0 sc1
    buffer_load_dwordx2 v[106:107], v7, s[84:87], s29 offen offset:2048 sc1
    s_waitcnt vmcnt(22)
    v_mfma_f32_32x32x16_bf16 v[112:127], a[252:255], v[148:151], v[112:127]
    buffer_load_dwordx2 v[108:109], v7, s[84:87], s29 offen offset:512 sc1
    buffer_load_dwordx2 v[110:111], v7, s[84:87], s29 offen offset:2560 sc1
mega_kernel_x_pfd:
    s_nop 11
    ds_write_b128 v17, v[112:115] offset:0
    ds_write_b128 v17, v[116:119] offset:1024
    ds_write_b128 v17, v[120:123] offset:2048
    ds_write_b128 v17, v[124:127] offset:3072
    s_waitcnt lgkmcnt(0)
    s_barrier
    ds_read_b128 v[112:115], v16 offset:0
    ds_read_b128 v[116:119], v16 offset:4096
    ds_read_b128 v[120:123], v16 offset:8192
    ds_read_b128 v[124:127], v16 offset:12288
    s_waitcnt lgkmcnt(0)
    v_pk_add_f32 v[112:113], v[112:113], v[116:117]
    v_pk_add_f32 v[114:115], v[114:115], v[118:119]
    v_pk_add_f32 v[120:121], v[120:121], v[124:125]
    v_pk_add_f32 v[122:123], v[122:123], v[126:127]
    v_pk_add_f32 v[112:113], v[112:113], v[120:121]
    v_pk_add_f32 v[114:115], v[114:115], v[122:123]
    v_cvt_pk_bf16_f32 v132, v112, v113
    v_cvt_pk_bf16_f32 v133, v114, v115
    buffer_store_dwordx2 v[132:133], v18, s[12:15], s42 offen
    s_branch mega_kernel_x_nxt
mega_kernel_x_half:
    s_add_u32 s20, s50, 0
    s_and_b32 s20, s20, 0xffff
    s_add_u32 s20, s20, s41
    buffer_load_dwordx4 v[136:139], v19, s[84:87], s20 offen offset:0 sc1
    buffer_load_dwordx4 v[140:143], v19, s[84:87], s20 offen offset:2048 sc1
    s_add_u32 s20, s50, 4096
    s_and_b32 s20, s20, 0xffff
    s_add_u32 s20, s20, s41
    buffer_load_dwordx4 v[144:147], v19, s[84:87], s20 offen offset:0 sc1
    buffer_load_dwordx4 v[148:151], v19, s[84:87], s20 offen offset:2048 sc1
    s_add_u32 s20, s50, 8192
    s_and_b32 s20, s20, 0xffff
    s_add_u32 s20, s20, s41
    buffer_load_dwordx4 v[152:155], v19, s[84:87], s20 offen offset:0 sc1
    buffer_load_dwordx4 v[156:159], v19, s[84:87], s20 offen offset:2048 sc1
    s_add_u32 s20, s50, 12288
    s_and_b32 s20, s20, 0xffff
    s_add_u32 s20, s20, s41
    buffer_load_dwordx4 v[160:163], v19, s[84:87], s20 offen offset:0 sc1
    buffer_load_dwordx4 v[164:167], v19, s[84:87], s20 offen offset:2048 sc1
    s_add_u32 s20, s50, 16384
    s_and_b32 s20, s20, 0xffff
    s_add_u32 s20, s20, s41
    buffer_load_dwordx4 v[168:171], v19, s[84:87], s20 offen offset:0 sc1
    buffer_load_dwordx4 v[172:175], v19, s[84:87], s20 offen offset:2048 sc1
    s_add_u32 s20, s50, 20480
    s_and_b32 s20, s20, 0xffff
    s_add_u32 s20, s20, s41
    buffer_load_dwordx4 v[176:179], v19, s[84:87], s20 offen offset:0 sc1
    buffer_load_dwordx4 v[180:183], v19, s[84:87], s20 offen offset:2048 sc1
    s_mov_b32 s46, 0
    s_waitcnt vmcnt(11)
    v_mfma_f32_32x32x16_bf16 v[112:127], a[0:3], v[136:139], 0
    v_mfma_f32_32x32x16_bf16 v[88:103], a[4:7], v[136:139], 0
    s_add_u32 s20, s50, 24576
    s_and_b32 s20, s20, 0xffff
    s_add_u32 s20, s20, s41
    buffer_load_dwordx4 v[184:187], v19, s[84:87], s20 offen offset:0 sc1
    s_waitcnt vmcnt(11)
    v_mfma_f32_32x32x16_bf16 v[112:127], a[8:11], v[140:143], v[112:127]
    v_mfma_f32_32x32x16_bf16 v[88:103], a[12:15], v[140:143], v[88:103]
    buffer_load_dwordx4 v[188:191], v19, s[84:87], s20 offen offset:2048 sc1
    s_waitcnt vmcnt(11)
    v_mfma_f32_32x32x16_bf16 v[112:127], a[16:19], v[144:147], v[112:127]
    v_mfma_f32_32x32x16_bf16 v[88:103], a[20:23], v[144:147], v[88:103]
    s_add_u32 s20, s50, 28672
    s_and_b32 s20, s20, 0xffff
    s_add_u32 s20, s20, s41
    buffer_load_dwordx4 v[192:195], v19, s[84:87], s20 offen offset:0 sc1
    s_waitcnt vmcnt(11)
    v_mfma_f32_32x32x16_bf16 v[112:127], a[24:27], v[148:151], v[112:127]
    v_mfma_f32_32x32x16_bf16 v[88:103], a[28:31], v[148:151], v[88:103]
    buffer_load_dwordx4 v[196:199], v19, s[84:87], s20 offen offset:2048 sc1
    s_waitcnt vmcnt(11)
    v_mfma_f32_32x32x16_bf16 v[112:127], a[32:35], v[152:155], v[112:127]
    v_mfma_f32_32x32x16_bf16 v[88:103], a[36:39], v[152:155], v[88:103]
    s_add_u32 s20, s50, 32768
    s_and_b32 s20, s20, 0xffff
    s_add_u32 s20, s20, s41
    buffer_load_dwordx4 v[200:203], v19, s[84:87], s20 offen offset:0 sc1
    s_waitcnt vmcnt(11)
    v_mfma_f32_32x32x16_bf16 v[112:127], a[40:43], v[156:159], v[112:127]
    v_mfma_f32_32x32x16_bf16 v[88:103], a[44:47], v[156:159], v[88:103]
    buffer_load_dwordx4 v[204:207], v19, s[84:87], s20 offen offset:2048 sc1
    s_waitcnt vmcnt(11)
    v_mfma_f32_32x32x16_bf16 v[112:127], a[48:51], v[160:163], v[112:127]
    v_mfma_f32_32x32x16_bf16 v[88:103], a[52:55], v[160:163], v[88:103]
    s_add_u32 s20, s50, 36864
    s_and_b32 s20, s20, 0xffff
    s_add_u32 s20, s20, s41
    buffer_load_dwordx4 v[208:211], v19, s[84:87], s20 offen offset:0 sc1
    s_waitcnt vmcnt(11)
    v_mfma_f32_32x32x16_bf16 v[112:127], a[56:59], v[164:167], v[112:127]
    v_mfma_f32_32x32x16_bf16 v[88:103], a[60:63], v[164:167], v[88:103]
    buffer_load_dwordx4 v[212:215], v19, s[84:87], s20 offen offset:2048 sc1
    s_waitcnt vmcnt(11)
    v_mfma_f32_32x32x16_bf16 v[112:127], a[64:67], v[168:171], v[112:127]
    v_mfma_f32_32x32x16_bf16 v[88:103], a[68:71], v[168:171], v[88:103]
    s_add_u32 s20, s50, 40960
    s_and_b32 s20, s20, 0xffff
    s_add_u32 s20, s20, s41
    buffer_load_dwordx4 v[216:219], v19, s[84:87], s20 offen offset:0 sc1
    s_waitcnt vmcnt(11)
    v_mfma_f32_32x32x16_bf16 v[112:127], a[72:75], v[172:175], v[112:127]
    v_mfma_f32_32x32x16_bf16 v[88:103], a[76:79], v[172:175], v[88:103]
    buffer_load_dwordx4 v[220:223], v19, s[84:87], s20 offen offset:2048 sc1
    s_waitcnt vmcnt(11)
    v_mfma_f32_32x32x16_bf16 v[112:127], a[80:83], v[176:179], v[112:127]
    v_mfma_f32_32x32x16_bf16 v[88:103], a[84:87], v[176:179], v[88:103]
    s_add_u32 s20, s50, 45056
    s_and_b32 s20, s20, 0xffff
    s_add_u32 s20, s20, s41
    buffer_load_dwordx4 v[224:227], v19, s[84:87], s20 offen offset:0 sc1
    s_waitcnt vmcnt(11)
    v_mfma_f32_32x32x16_bf16 v[112:127], a[88:91], v[180:183], v[112:127]
    v_mfma_f32_32x32x16_bf16 v[88:103], a[92:95], v[180:183], v[88:103]
    buffer_load_dwordx4 v[228:231], v19, s[84:87], s20 offen offset:2048 sc1
    s_waitcnt vmcnt(11)
    v_mfma_f32_32x32x16_bf16 v[112:127], a[96:99], v[184:187], v[112:127]
    v_mfma_f32_32x32x16_bf16 v[88:103], a[100:103], v[184:187], v[88:103]
    s_add_u32 s20, s50, 49152
    s_and_b32 s20, s20, 0xffff
    s_add_u32 s20, s20, s41
    buffer_load_dwordx4 v[232:235], v19, s[84:87], s20 offen offset:0 sc1
    s_waitcnt vmcnt(11)
    v_mfma_f32_32x32x16_bf16 v[112:127], a[104:107], v[188:191], v[112:127]
    v_mfma_f32_32x32x16_bf16 v[88:103], a[108:111], v[188:191], v[88:103]
    buffer_load_dwordx4 v[236:239], v19, s[84:87], s20 offen offset:2048 sc1
    s_waitcnt vmcnt(11)
    v_mfma_f32_32x32x16_bf16 v[112:127], a[112:115], v[192:195], v[112:127]
    v_mfma_f32_32x32x16_bf16 v[88:103], a[116:119], v[192:195], v[88:103]
    s_add_u32 s20, s50, 53248
    s_and_b32 s20, s20, 0xffff
    s_add_u32 s20, s20, s41
    buffer_load_dwordx4 v[240:243], v19, s[84:87], s20 offen offset:0 sc1
    s_waitcnt vmcnt(11)
    v_mfma_f32_32x32x16_bf16 v[112:127], a[120:123], v[196:199], v[112:127]
    v_mfma_f32_32x32x16_bf16 v[88:103], a[124:127], v[196:199], v[88:103]
    buffer_load_dwordx4 v[244:247], v19, s[84:87], s20 offen offset:2048 sc1
    s_waitcnt vmcnt(11)
    v_mfma_f32_32x32x16_bf16 v[112:127], a[128:131], v[200:203], v[112:127]
    v_mfma_f32_32x32x16_bf16 v[88:103], a[132:135], v[200:203], v[88:103]
    s_add_u32 s20, s50, 57344
    s_and_b32 s20, s20, 0xffff
    s_add_u32 s20, s20, s41
    buffer_load_dwordx4 v[248:251], v19, s[84:87], s20 offen offset:0 sc1
    s_waitcnt vmcnt(11)
    v_mfma_f32_32x32x16_bf16 v[112:127], a[136:139], v[204:207], v[112:127]
    v_mfma_f32_32x32x16_bf16 v[88:103], a[140:143], v[204:207], v[88:103]
    buffer_load_dwordx4 v[252:255], v19, s[84:87], s20 offen offset:2048 sc1
    s_waitcnt vmcnt(11)
    v_mfma_f32_32x32x16_bf16 v[112:127], a[144:147], v[208:211], v[112:127]
    v_mfma_f32_32x32x16_bf16 v[88:103], a[148:151], v[208:211], v[88:103]
    s_add_u32 s20, s50, 61440
    s_and_b32 s20, s20, 0xffff
    s_add_u32 s20, s20, s41
    buffer_load_dwordx4 v[136:139], v19, s[84:87], s20 offen offset:0 sc1
    s_waitcnt vmcnt(11)
    v_mfma_f32_32x32x16_bf16 v[112:127], a[152:155], v[212:215], v[112:127]
    v_mfma_f32_32x32x16_bf16 v[88:103], a[156:159], v[212:215], v[88:103]
    buffer_load_dwordx4 v[140:143], v19, s[84:87], s20 offen offset:2048 sc1
    s_waitcnt vmcnt(11)
    v_mfma_f32_32x32x16_bf16 v[112:127], a[160:163], v[216:219], v[112:127]
    v_mfma_f32_32x32x16_bf16 v[88:103], a[164:167], v[216:219], v[88:103]
    s_waitcnt vmcnt(10)
    v_mfma_f32_32x32x16_bf16 v[112:127], a[168:171], v[220:223], v[112:127]
    v_mfma_f32_32x32x16_bf16 v[88:103], a[172:175], v[220:223], v[88:103]
    s_waitcnt vmcnt(9)
    v_mfma_f32_32x32x16_bf16 v[112:127], a[176:179], v[224:227], v[112:127]
    v_mfma_f32_32x32x16_bf16 v[88:103], a[180:183], v[224:227], v[88:103]
    s_waitcnt vmcnt(8)
    v_mfma_f32_32x32x16_bf16 v[112:127], a[184:187], v[228:231], v[112:127]
    v_mfma_f32_32x32x16_bf16 v[88:103], a[188:191], v[228:231], v[88:103]
    s_waitcnt vmcnt(7)
    v_mfma_f32_32x32x16_bf16 v[112:127], a[192:195], v[232:235], v[112:127]
    v_mfma_f32_32x32x16_bf16 v[88:103], a[196:199], v[232:235], v[88:103]
    s_waitcnt vmcnt(6)
    v_mfma_f32_32x32x16_bf16 v[112:127], a[200:203], v[236:239], v[112:127]
    v_mfma_f32_32x32x16_bf16 v[88:103], a[204:207], v[236:239], v[88:103]
    s_waitcnt vmcnt(5)
    v_mfma_f32_32x32x16_bf16 v[112:127], a[208:211], v[240:243], v[112:127]
    v_mfma_f32_32x32x16_bf16 v[88:103], a[212:215], v[240:243], v[88:103]
    s_waitcnt vmcnt(4)
    v_mfma_f32_32x32x16_bf16 v[112:127], a[216:219], v[244:247], v[112:127]
    v_mfma_f32_32x32x16_bf16 v[88:103], a[220:223], v[244:247], v[88:103]
    s_waitcnt vmcnt(3)
    v_mfma_f32_32x32x16_bf16 v[112:127], a[224:227], v[248:251], v[112:127]
    v_mfma_f32_32x32x16_bf16 v[88:103], a[228:231], v[248:251], v[88:103]
    s_waitcnt vmcnt(2)
    v_mfma_f32_32x32x16_bf16 v[112:127], a[232:235], v[252:255], v[112:127]
    v_mfma_f32_32x32x16_bf16 v[88:103], a[236:239], v[252:255], v[88:103]
    s_waitcnt vmcnt(1)
    v_mfma_f32_32x32x16_bf16 v[112:127], a[240:243], v[136:139], v[112:127]
    v_mfma_f32_32x32x16_bf16 v[88:103], a[244:247], v[136:139], v[88:103]
    s_waitcnt vmcnt(0)
    v_mfma_f32_32x32x16_bf16 v[112:127], a[248:251], v[140:143], v[112:127]
    v_mfma_f32_32x32x16_bf16 v[88:103], a[252:255], v[140:143], v[88:103]
    s_mov_b32 vcc_lo, 0xffff0000
    s_mov_b32 vcc_hi, 0xffff0000
    s_nop 9
    v_cndmask_b32 v112, v112, v88, vcc
    v_cndmask_b32 v113, v113, v89, vcc
    v_cndmask_b32 v114, v114, v90, vcc
    v_cndmask_b32 v115, v115, v91, vcc
    v_cndmask_b32 v116, v116, v92, vcc
    v_cndmask_b32 v117, v117, v93, vcc
    v_cndmask_b32 v118, v118, v94, vcc
    v_cndmask_b32 v119, v119, v95, vcc
    v_cndmask_b32 v120, v120, v96, vcc
    v_cndmask_b32 v121, v121, v97, vcc
    v_cndmask_b32 v122, v122, v98, vcc
    v_cndmask_b32 v123, v123, v99, vcc
    v_cndmask_b32 v124, v124, v100, vcc
    v_cndmask_b32 v125, v125, v101, vcc
    v_cndmask_b32 v126, v126, v102, vcc
    v_cndmask_b32 v127, v127, v103, vcc
    ds_write_b128 v17, v[112:115] offset:0
    ds_write_b128 v17, v[116:119] offset:1024
    ds_write_b128 v17, v[120:123] offset:2048
    ds_write_b128 v17, v[124:127] offset:3072
    s_waitcnt lgkmcnt(0)
    s_barrier
    s_cmp_ge_u32 s16, 2
    s_cbranch_scc1 mega_kernel_x_nxt
    ds_read_b128 v[112:115], v16 offset:0
    ds_read_b128 v[88:91], v16 offset:256
    ds_read_b128 v[116:119], v16 offset:4096
    ds_read_b128 v[92:95], v16 offset:4352
    ds_read_b128 v[120:123], v16 offset:8192
    ds_read_b128 v[96:99], v16 offset:8448
    ds_read_b128 v[124:127], v16 offset:12288
    ds_read_b128 v[100:103], v16 offset:12544
    s_and_b32 s20, s17, 1
    s_lshl_b32 s20, s20, 16
    s_add_u32 s42, s42, s20
    s_waitcnt lgkmcnt(0)
    v_pk_add_f32 v[112:113], v[112:113], v[88:89]
    v_pk_add_f32 v[114:115], v[114:115], v[90:91]
    v_pk_add_f32 v[116:117], v[116:117], v[92:93]
    v_pk_add_f32 v[118:119], v[118:119], v[94:95]
    v_pk_add_f32 v[120:121], v[120:121], v[96:97]
    v_pk_add_f32 v[122:123], v[122:123], v[98:99]
    v_pk_add_f32 v[124:125], v[124:125], v[100:101]
    v_pk_add_f32 v[126:127], v[126:127], v[102:103]
    v_pk_add_f32 v[112:113], v[112:113], v[116:117]
    v_pk_add_f32 v[114:115], v[114:115], v[118:119]
    v_pk_add_f32 v[120:121], v[120:121], v[124:125]
    v_pk_add_f32 v[122:123], v[122:123], v[126:127]
    v_pk_add_f32 v[112:113], v[112:113], v[120:121]
    v_pk_add_f32 v[114:115], v[114:115], v[122:123]
    v_cvt_pk_bf16_f32 v132, v112, v113
    v_cvt_pk_bf16_f32 v133, v114, v115
    buffer_store_dwordx2 v[132:133], v18, s[12:15], s42 offen
mega_kernel_x_nxt:
    s_cmp_eq_u32 s46, 1
    s_cbranch_scc1 mega_kernel_x_att
    s_cmp_lt_u32 s22, 64
    s_cbranch_scc1 mega_kernel_x_ldq
    s_endpgm
.section .rodata,"a"
.p2align 6
.amdhsa_kernel mega_kernel
  .amdhsa_next_free_vgpr 512
  .amdhsa_next_free_sgpr 102
  .amdhsa_accum_offset 256
  .amdhsa_group_segment_fixed_size 0
  .amdhsa_kernarg_size 104
  .amdhsa_user_sgpr_count 2
  .amdhsa_user_sgpr_kernarg_segment_ptr 1
  .amdhsa_system_sgpr_workgroup_id_x 1
.end_amdhsa_kernel
```

```asm
; @launch kernel=mega_kernel grid=(256,1,1) block=(256,1,1) lds=161792
.amdgcn_target "amdgcn-amd-amdhsa--gfx950"
.text
.globl mega_kernel
.p2align 8
.type mega_kernel,@function
mega_kernel:
    s_cmp_ge_u32 s2, 256
    s_cbranch_scc1 mega_kernel_exit
    s_load_dwordx2 s[84:85], s[0:1], 96
    s_load_dwordx2 s[88:89], s[0:1], 88
    s_getreg_b32 s93, hwreg(HW_REG_XCC_ID)
    s_and_b32 s93, s93, 7
    s_lshl_b32 s93, s93, 2
    s_lshr_b32 s93, 0x76543210, s93
    s_and_b32 s93, s93, 7
    v_lshrrev_b32 v1, 6, v0
    v_mov_b32 v4, 0
    v_readfirstlane_b32 s80, v1
    v_mov_b32 v5, 0
    v_mov_b32 v6, 0
    v_mov_b32 v7, 0
    s_mov_b32 s83, 0
    s_lshl_b32 s101, s2, 2
    s_add_u32 s101, s101, s80
    s_lshl_b32 s101, s101, 8
    s_add_u32 s101, s101, 230686720
    s_waitcnt lgkmcnt(0)
    s_mov_b32 s86, 268435456
    s_mov_b32 s87, 0x00020000
    s_mov_b32 s90, 256
    s_mov_b32 s91, 0x00020000
    s_mov_b32 s98, s80
    s_cmp_lg_u32 s80, 0
    s_cbranch_scc1 mega_kernel_st0
    v_mov_b32 v10, 1
    s_lshl_b32 s81, s93, 5
    s_mov_b64 exec, 1
    buffer_atomic_add v10, off, s[88:91], s81 offset:4 sc0
    s_lshl_b32 s81, s2, 7
    s_add_u32 s81, s81, 71303168
    s_mov_b64 exec, 3
    v_lshlrev_b32 v1, 15, v0
    buffer_store_dword v4, v1, s[84:87], s81 offen sc1
    s_mov_b64 exec, -1
mega_kernel_st0:
    s_load_dwordx2 s[72:73], s[0:1], 8
    v_mov_b32 v4, 0
    v_mov_b32 v5, 0
    v_mov_b32 v6, 0
    v_mov_b32 v7, 0
    v_lshlrev_b32 v1, 4, v0
    s_lshl_b32 s81, s2, 13
    s_add_u32 s81, s81, 67108864
    s_add_u32 s79, s81, 4096
    buffer_store_dwordx4 v[4:7], v1, s[84:87], s81 offen sc1
    buffer_store_dwordx4 v[4:7], v1, s[84:87], s79 offen sc1
    s_lshl_b32 s81, s2, 12
    s_add_u32 s81, s81, 70254592
    buffer_store_dwordx4 v[4:7], v1, s[84:87], s81 offen sc1
    s_cmp_ge_u32 s2, 64
    s_cbranch_scc1 mega_kernel_gi
    v_bfe_u32 v2, v0, 3, 1
    v_lshlrev_b32 v2, 11, v2
    v_and_b32 v3, 3, v0
    v_lshl_add_u32 v2, v3, 5, v2
    v_bfe_u32 v3, v0, 4, 3
    v_lshl_add_u32 v2, v3, 2, v2
    v_bfe_u32 v3, v0, 2, 1
    v_lshl_add_u32 v2, v3, 1, v2
    s_lshr_b32 s81, s2, 2
    s_lshl_b32 s81, s81, 7
    s_and_b32 s79, s2, 3
    s_lshl_b32 s79, s79, 12
    s_add_u32 s81, s81, s79
    s_waitcnt lgkmcnt(0)
    s_mov_b32 s74, 16384
    s_mov_b32 s75, 0x00020000
    buffer_load_ushort v8, v2, s[72:75], s81 offen
    v_mov_b32 v9, -1
    v_and_b32 v1, 31, v0
    v_lshlrev_b32 v1, 1, v1
    v_bfe_u32 v3, v0, 5, 2
    v_lshl_add_u32 v1, v3, 8, v1
    v_lshrrev_b32 v3, 7, v0
    v_lshl_add_u32 v1, v3, 14, v1
    v_cmp_gt_u32 vcc, 128, v0
    s_lshr_b32 s81, s2, 2
    s_lshl_b32 s81, s81, 10
    s_and_b32 s79, s2, 3
    s_lshl_b32 s79, s79, 6
    s_add_u32 s81, s81, s79
    s_add_u32 s81, s81, 69206016
    s_waitcnt vmcnt(0)
    v_min_u32 v8, 0xfffe, v8
    v_cndmask_b32 v8, v9, v8, vcc
    buffer_store_short v8, v1, s[84:87], s81 offen sc1
mega_kernel_gi:
    s_waitcnt lgkmcnt(0)
    s_cmp_lg_u32 s80, 0
    s_cbranch_scc1 mega_kernel_st1
    s_mov_b64 exec, 1
    s_waitcnt vmcnt(4)
    ds_write_b32 v4, v10
    s_mov_b64 exec, -1
    s_waitcnt lgkmcnt(0)
mega_kernel_st1:
    s_barrier
    ds_read_b32 v2, v4
    s_waitcnt lgkmcnt(0)
    v_readfirstlane_b32 s94, v2
    s_barrier
    s_sub_u32 s81, s93, 2
    s_cmp_ge_u32 s81, 2
    s_cbranch_scc1 mega_kernel_nopr
    s_cmp_lg_u32 s80, 0
    s_cbranch_scc1 mega_kernel_prd
    v_lshlrev_b32 v1, 4, v0
    s_and_b32 s81, s2, 127
    s_lshl_b32 s81, s81, 14
    s_add_u32 s81, s81, 67108864
    s_add_u32 s77, s81, 8192
    buffer_store_dwordx4 v[4:7], v1, s[84:87], s81 offen sc1
    buffer_store_dwordx4 v[4:7], v1, s[84:87], s77 offen sc1
    s_waitcnt vmcnt(0)
    s_memtime s[70:71]
    buffer_store_dwordx4 v[4:7], v1, s[84:87], s81 offen sc1
    s_waitcnt vmcnt(0)
    s_memtime s[72:73]
    buffer_store_dwordx4 v[4:7], v1, s[84:87], s77 offen sc1
    s_waitcnt vmcnt(0)
    buffer_store_dwordx4 v[4:7], v1, s[84:87], s77 offen sc1
    s_waitcnt vmcnt(0)
    s_memtime s[74:75]
    buffer_store_dwordx4 v[4:7], v1, s[84:87], s81 offen sc1
    s_waitcnt vmcnt(0)
    s_memtime s[76:77]
    s_waitcnt lgkmcnt(0)
    s_sub_u32 s76, s76, s74
    s_sub_u32 s74, s74, s72
    s_sub_u32 s72, s72, s70
    s_add_u32 s72, s72, s76
    s_cmp_lt_u32 s74, s72
    s_cselect_b32 s81, 0x10001, 1
    v_mov_b32 v8, s81
    s_mov_b64 exec, 1
    buffer_atomic_add v8, off, s[88:91], 0 offset:204 sc1
    s_mov_b64 exec, -1
mega_kernel_prd:
    s_barrier
mega_kernel_nopr:
    s_mov_b32 s97, 0
    s_mov_b32 s100, 64
mega_kernel_fast:
    s_mov_b32 s96, 1
    s_mov_b32 s30, s93
    s_and_b32 s31, s94, 31
    s_cmp_lt_u32 s93, 2
    s_cbranch_scc1 mega_kernel_recf
    s_sub_u32 s92, s93, 2
    s_lshl_b32 s92, s92, 5
    s_add_u32 s92, s92, s31
    s_branch mega_kernel_bulk
mega_kernel_redo:
    s_waitcnt vmcnt(0) lgkmcnt(0)
    s_barrier
    v_readlane_b32 s100, v36, 2
    v_readlane_b32 s81, v36, 3
    s_mov_b32 s97, 1
    s_nop 2
    s_add_u32 s100, s100, s81
    s_mov_b32 s95, s94
    v_readlane_b32 s81, v36, 0
    s_cmp_gt_u32 s93, 0
    s_nop 2
    s_cselect_b32 s81, s81, 0
    s_add_u32 s95, s95, s81
    v_readlane_b32 s81, v36, 1
    s_cmp_gt_u32 s93, 1
    s_nop 2
    s_cselect_b32 s81, s81, 0
    s_add_u32 s95, s95, s81
    v_readlane_b32 s81, v36, 2
    s_cmp_gt_u32 s93, 2
    s_nop 2
    s_cselect_b32 s81, s81, 0
    s_add_u32 s95, s95, s81
    v_readlane_b32 s81, v36, 3
    s_cmp_gt_u32 s93, 3
    s_nop 2
    s_cselect_b32 s81, s81, 0
    s_add_u32 s95, s95, s81
    v_readlane_b32 s81, v36, 4
    s_cmp_gt_u32 s93, 4
    s_nop 2
    s_cselect_b32 s81, s81, 0
    s_add_u32 s95, s95, s81
    v_readlane_b32 s81, v36, 5
    s_cmp_gt_u32 s93, 5
    s_nop 2
    s_cselect_b32 s81, s81, 0
    s_add_u32 s95, s95, s81
    v_readlane_b32 s81, v36, 6
    s_cmp_gt_u32 s93, 6
    s_nop 2
    s_cselect_b32 s81, s81, 0
    s_add_u32 s95, s95, s81
mega_kernel_slow:
    s_mov_b32 s96, 0
    s_lshr_b32 s30, s95, 5
    s_and_b32 s31, s95, 31
    s_cmp_lt_u32 s95, 64
    s_cbranch_scc1 mega_kernel_recs
    s_sub_u32 s92, s95, 64
    s_branch mega_kernel_bulk
mega_kernel_exit:
    s_endpgm
mega_kernel_recf:
    s_load_dwordx2 s[4:5], s[0:1], 96
    s_load_dwordx2 s[12:13], s[0:1], 88
    s_load_dwordx2 s[50:51], s[0:1], 16
    s_load_dwordx2 s[52:53], s[0:1], 24
    s_load_dwordx2 s[54:55], s[0:1], 32
    s_load_dwordx2 s[56:57], s[0:1], 40
    s_load_dwordx2 s[58:59], s[0:1], 8
    v_lshrrev_b32 v3, 6, v0
    v_and_b32 v40, 63, v0
    v_readfirstlane_b32 s20, v3
    v_lshrrev_b32 v41, 4, v40
    v_and_b32 v42, 15, v40
    v_lshlrev_b32 v1, 4, v40
    s_mov_b32 s49, 0
    s_waitcnt lgkmcnt(0)
    s_mov_b32 s6, 268435456
    s_mov_b32 s7, 0x00020000
    s_mov_b32 s14, 256
    s_mov_b32 s15, 0x00020000
    s_mov_b32 s10, 8388608
    s_mov_b32 s11, 0x00020000
    s_mov_b32 s26, 0x00030003
    s_mov_b32 s27, 0x00030003
    s_mov_b32 s28, 0xcccccccc
    s_mov_b32 s29, 0xcccccccc
    s_mov_b32 s32, 0x33333333
    s_mov_b32 s33, 0x33333333
    s_mov_b32 s34, 0x3e0293ee
    s_lshl_b32 s22, s20, 2
    v_xor_b32 v3, s22, v42
    v_lshlrev_b32 v3, 4, v3
    v_lshl_add_u32 v4, v41, 4, s20
    v_lshl_add_u32 v44, v4, 13, v3
    s_lshl_b32 s22, s30, 22
    s_lshl_b32 s23, s31, 8
    s_add_u32 s22, s22, s23
    v_add_u32 v44, s22, v44
    s_lshr_b32 s22, s20, 1
    s_lshl_b32 s22, s22, 5
    s_and_b32 s23, s20, 1
    s_lshl_b32 s23, s23, 2
    s_add_u32 s22, s22, s23
    s_lshl_b32 s23, s31, 7
    s_add_u32 s22, s22, s23
    v_add_u32 v4, s22, v41
    v_lshl_add_u32 v45, v4, 11, v3
    s_lshl_b32 s22, s30, 10
    v_add_u32 v45, s22, v45
    s_lshl_b32 s48, s20, 10
    s_mov_b32 s8, s50
    s_mov_b32 s9, s51
    s_add_u32 m0, s48, 0
    s_mov_b32 s22, 0
    buffer_load_dwordx4 v44, s[8:11], s22 offen  lds
    s_add_u32 m0, s48, 4096
    s_mov_b32 s22, 32768
    buffer_load_dwordx4 v44, s[8:11], s22 offen  lds
    s_add_u32 m0, s48, 8192
    s_mov_b32 s22, 65536
    buffer_load_dwordx4 v44, s[8:11], s22 offen  lds
    s_add_u32 m0, s48, 12288
    s_mov_b32 s22, 98304
    buffer_load_dwordx4 v44, s[8:11], s22 offen  lds
    s_add_u32 m0, s48, 16384
    s_mov_b32 s22, 524288
    buffer_load_dwordx4 v44, s[8:11], s22 offen  lds
    s_add_u32 m0, s48, 20480
    s_mov_b32 s22, 557056
    buffer_load_dwordx4 v44, s[8:11], s22 offen  lds
    s_add_u32 m0, s48, 24576
    s_mov_b32 s22, 589824
    buffer_load_dwordx4 v44, s[8:11], s22 offen  lds
    s_add_u32 m0, s48, 28672
    s_mov_b32 s22, 622592
    buffer_load_dwordx4 v44, s[8:11], s22 offen  lds
    s_add_u32 m0, s48, 32768
    s_mov_b32 s22, 1048576
    buffer_load_dwordx4 v44, s[8:11], s22 offen  lds
    s_add_u32 m0, s48, 36864
    s_mov_b32 s22, 1081344
    buffer_load_dwordx4 v44, s[8:11], s22 offen  lds
    s_add_u32 m0, s48, 40960
    s_mov_b32 s22, 1114112
    buffer_load_dwordx4 v44, s[8:11], s22 offen  lds
    s_add_u32 m0, s48, 45056
    s_mov_b32 s22, 1146880
    buffer_load_dwordx4 v44, s[8:11], s22 offen  lds
    s_waitcnt vmcnt(12)
    s_barrier
    s_or_b32 s81, s97, s98
    s_cmp_lg_u32 s81, 0
    s_cbranch_scc1 mega_kernel_h0_1
    s_lshl_b32 s81, s93, 5
    v_mov_b32 v38, 1
    s_mov_b64 exec, 1
    buffer_atomic_add v38, off, s[88:91], s81 sc1
    s_mov_b64 exec, -1
mega_kernel_h0_1:
    s_add_u32 m0, s48, 49152
    s_mov_b32 s22, 1572864
    buffer_load_dwordx4 v44, s[8:11], s22 offen  lds
    s_add_u32 m0, s48, 53248
    s_mov_b32 s22, 1605632
    buffer_load_dwordx4 v44, s[8:11], s22 offen  lds
    s_add_u32 m0, s48, 57344
    s_mov_b32 s22, 1638400
    buffer_load_dwordx4 v44, s[8:11], s22 offen  lds
    s_add_u32 m0, s48, 61440
    s_mov_b32 s22, 1671168
    buffer_load_dwordx4 v44, s[8:11], s22 offen  lds
    s_add_u32 m0, s48, 65536
    s_mov_b32 s22, 2097152
    buffer_load_dwordx4 v44, s[8:11], s22 offen  lds
    s_add_u32 m0, s48, 69632
    s_mov_b32 s22, 2129920
    buffer_load_dwordx4 v44, s[8:11], s22 offen  lds
    s_add_u32 m0, s48, 73728
    s_mov_b32 s22, 2162688
    buffer_load_dwordx4 v44, s[8:11], s22 offen  lds
    s_add_u32 m0, s48, 77824
    s_mov_b32 s22, 2195456
    buffer_load_dwordx4 v44, s[8:11], s22 offen  lds
    s_add_u32 m0, s48, 81920
    s_mov_b32 s22, 2621440
    buffer_load_dwordx4 v44, s[8:11], s22 offen  lds
    s_add_u32 m0, s48, 86016
    s_mov_b32 s22, 2654208
    buffer_load_dwordx4 v44, s[8:11], s22 offen  lds
    s_add_u32 m0, s48, 90112
    s_mov_b32 s22, 2686976
    buffer_load_dwordx4 v44, s[8:11], s22 offen  lds
    s_add_u32 m0, s48, 94208
    s_mov_b32 s22, 2719744
    buffer_load_dwordx4 v44, s[8:11], s22 offen  lds
    s_add_u32 m0, s48, 98304
    s_mov_b32 s22, 3145728
    buffer_load_dwordx4 v44, s[8:11], s22 offen  lds
    s_add_u32 m0, s48, 102400
    s_mov_b32 s22, 3178496
    buffer_load_dwordx4 v44, s[8:11], s22 offen  lds
    s_add_u32 m0, s48, 106496
    s_mov_b32 s22, 3211264
    buffer_load_dwordx4 v44, s[8:11], s22 offen  lds
    s_add_u32 m0, s48, 110592
    s_mov_b32 s22, 3244032
    buffer_load_dwordx4 v44, s[8:11], s22 offen  lds
    s_add_u32 m0, s48, 114688
    s_mov_b32 s22, 3670016
    buffer_load_dwordx4 v44, s[8:11], s22 offen  lds
    s_add_u32 m0, s48, 118784
    s_mov_b32 s22, 3702784
    buffer_load_dwordx4 v44, s[8:11], s22 offen  lds
    s_add_u32 m0, s48, 122880
    s_mov_b32 s22, 3735552
    buffer_load_dwordx4 v44, s[8:11], s22 offen  lds
    s_add_u32 m0, s48, 126976
    s_mov_b32 s22, 3768320
    buffer_load_dwordx4 v44, s[8:11], s22 offen  lds
    s_lshl_b32 s22, s30, 5
    s_add_u32 s22, s22, s31
    s_lshl_b32 s38, s22, 14
    s_xor_b32 s22, s22, 32
    s_lshl_b32 s37, s22, 14
    s_add_u32 s38, s38, 67108864
    s_add_u32 s37, s37, 67108864
    s_lshl_b32 s46, s30, 19
    s_add_u32 s46, s46, 70254592
    s_mul_i32 s22, s31, 8448
    s_add_u32 s47, s46, s22
    s_mul_i32 s22, s20, 67584
    s_add_u32 s46, s46, s22
    s_lshl_b32 s22, s31, 6
    s_add_u32 s46, s46, s22
    s_add_u32 s61, s46, 33792
    s_mul_i32 s22, s20, 2048
    s_add_u32 s25, s47, s22
    s_lshl_b32 s35, s30, 13
    s_add_u32 s35, s35, 69206016
    v_lshrrev_b32 v53, 2, v42
    v_lshlrev_b32 v53, 1, v53
    v_and_b32 v54, 1, v42
    v_add_u32 v55, v53, v54
    v_mov_b32 v14, 0
    v_mov_b32 v15, 0
    v_mov_b32 v2, 0x4444
    v_mov_b32 v3, 0xeeee
    v_cndmask_b32 v2, v2, v3, s[28:29]
    s_lshl_b32 s22, s20, 12
    v_add_u32 v32, s22, v1
    v_add_u32 v33, 0x10000, v32
    v_add_u32 v5, 0x10000, v1
    v_add_u32 v6, 131072, v1
    v_and_b32 v3, 3, v42
    v_bfe_u32 v43, v40, 1, 1
    v_lshlrev_b32 v7, 13, v43
    v_and_b32 v43, 1, v40
    v_lshl_add_u32 v7, v43, 7, v7
    s_lshl_b32 s22, s31, 8
    s_add_u32 s23, s22, 71311360
    v_add_u32 v7, s23, v7
    s_cmp_lg_u32 s20, 0
    s_cbranch_scc1 mega_kernel_rf_flk
    s_lshl_b32 s23, s30, 7
    s_add_u32 s22, s22, s23
    s_add_u32 s22, s22, 71327744
    v_bfrev_b32 v7, 1
    v_writelane_b32 v7, s22, 0
mega_kernel_rf_flk:
    v_lshlrev_b32 v11, 3, v40
    v_lshlrev_b32 v10, 8, v55
    v_lshl_add_u32 v10, v41, 4, v10
    v_mul_u32_u24 v8, 8448, v41
    v_lshl_add_u32 v8, v3, 4, v8
    v_lshrrev_b32 v4, 2, v42
    v_mul_u32_u24 v4, 2048, v4
    v_add_u32 v8, v4, v8
    v_lshrrev_b32 v9, 1, v41
    v_lshlrev_b32 v9, 5, v9
    v_and_b32 v4, 1, v42
    v_lshl_add_u32 v9, v4, 4, v9
    v_and_b32 v4, 1, v41
    v_lshl_add_u32 v9, v4, 3, v9
    s_lshr_b32 s22, s31, 2
    s_lshl_b32 s22, s22, 10
    s_and_b32 s23, s31, 3
    s_lshl_b32 s23, s23, 6
    s_add_u32 s22, s22, s23
    v_add_u32 v9, s22, v9
    v_lshrrev_b32 v4, 2, v42
    v_lshlrev_b32 v12, 8, v4
    v_lshl_add_u32 v12, v41, 6, v12
    v_lshl_add_u32 v12, v3, 4, v12
    v_lshlrev_b32 v13, 6, v41
    v_lshl_add_u32 v13, v42, 2, v13
    v_cmp_eq_u32 vcc, 0, v3
    v_mov_b32 v28, 0x3f803f80
    v_mov_b32 v29, 0x3f803f80
    v_cndmask_b32 v34, 0, 1, vcc
    v_mov_b32 v30, 0x3f803f80
    v_mov_b32 v31, 0x3f803f80
    v_and_b32 v49, 1, v42
    v_lshlrev_b32 v49, 4, v49
    v_mov_b32 v50, 0x3f80
    v_lshlrev_b32 v50, v49, v50
    v_lshrrev_b32 v51, 2, v42
    v_cmp_eq_u32 vcc, v51, v41
    v_mov_b32 v24, v50
    v_cndmask_b32 v52, 0, v50, s[28:29]
    v_cndmask_b32 v53, 0, v50, s[32:33]
    v_cndmask_b32 v16, 0, v52, vcc
    v_cndmask_b32 v17, 0, v53, vcc
    v_mov_b32 v25, v50
    v_mov_b32 v26, v50
    v_mov_b32 v27, v50
    v_bfe_u32 v60, v40, 3, 1
    v_bfe_u32 v49, v40, 2, 1
    v_and_b32 v50, 1, v41
    v_lshrrev_b32 v51, 1, v41
    v_lshlrev_b32 v52, 3, v60
    v_lshl_add_u32 v52, v50, 2, v52
    v_lshl_add_u32 v53, v51, 4, v52
    v_add_u32 v53, v53, v49
    v_and_b32 v54, 3, v40
    s_lshl_b32 s22, s20, 2
    v_add_u32 v55, s22, v54
    v_xor_b32 v55, v55, v52
    v_lshlrev_b32 v55, 4, v55
    v_lshl_add_u32 v46, v53, 8, v55
    v_lshlrev_b32 v55, 4, v52
    v_lshl_add_u32 v55, v54, 3, v55
    v_lshl_add_u32 v47, v53, 8, v55
    s_waitcnt vmcnt(28)
    s_barrier
    v_add_u32 v48, 0, v46
    ds_read_b64_tr_b16 a[0:1], v48 offset:0
    ds_read_b64_tr_b16 a[2:3], v48 offset:512
    ds_read_b64_tr_b16 a[4:5], v48 offset:8192
    ds_read_b64_tr_b16 a[6:7], v48 offset:8704
    ds_read_b64_tr_b16 a[8:9], v48 offset:8
    ds_read_b64_tr_b16 a[10:11], v48 offset:520
    ds_read_b64_tr_b16 a[12:13], v48 offset:8200
    ds_read_b64_tr_b16 a[14:15], v48 offset:8712
    s_waitcnt lgkmcnt(0)
    s_barrier
    s_mov_b32 s8, s52
    s_mov_b32 s9, s53
    s_add_u32 m0, s48, 0
    s_mov_b32 s22, 0
    buffer_load_dwordx4 v44, s[8:11], s22 offen  lds
    s_add_u32 m0, s48, 4096
    s_mov_b32 s22, 32768
    buffer_load_dwordx4 v44, s[8:11], s22 offen  lds
    s_add_u32 m0, s48, 8192
    s_mov_b32 s22, 65536
    buffer_load_dwordx4 v44, s[8:11], s22 offen  lds
    s_add_u32 m0, s48, 12288
    s_mov_b32 s22, 98304
    buffer_load_dwordx4 v44, s[8:11], s22 offen  lds
    s_waitcnt vmcnt(28)
    s_barrier
    v_add_u32 v48, 16384, v46
    ds_read_b64_tr_b16 a[16:17], v48 offset:0
    ds_read_b64_tr_b16 a[18:19], v48 offset:512
    ds_read_b64_tr_b16 a[20:21], v48 offset:8192
    ds_read_b64_tr_b16 a[22:23], v48 offset:8704
    ds_read_b64_tr_b16 a[24:25], v48 offset:8
    ds_read_b64_tr_b16 a[26:27], v48 offset:520
    ds_read_b64_tr_b16 a[28:29], v48 offset:8200
    ds_read_b64_tr_b16 a[30:31], v48 offset:8712
    s_waitcnt lgkmcnt(0)
    s_barrier
    s_add_u32 m0, s48, 16384
    s_mov_b32 s22, 524288
    buffer_load_dwordx4 v44, s[8:11], s22 offen  lds
    s_add_u32 m0, s48, 20480
    s_mov_b32 s22, 557056
    buffer_load_dwordx4 v44, s[8:11], s22 offen  lds
    s_add_u32 m0, s48, 24576
    s_mov_b32 s22, 589824
    buffer_load_dwordx4 v44, s[8:11], s22 offen  lds
    s_add_u32 m0, s48, 28672
    s_mov_b32 s22, 622592
    buffer_load_dwordx4 v44, s[8:11], s22 offen  lds
    s_waitcnt vmcnt(28)
    s_barrier
    v_add_u32 v48, 32768, v46
    ds_read_b64_tr_b16 a[32:33], v48 offset:0
    ds_read_b64_tr_b16 a[34:35], v48 offset:512
    ds_read_b64_tr_b16 a[36:37], v48 offset:8192
    ds_read_b64_tr_b16 a[38:39], v48 offset:8704
    ds_read_b64_tr_b16 a[40:41], v48 offset:8
    ds_read_b64_tr_b16 a[42:43], v48 offset:520
    ds_read_b64_tr_b16 a[44:45], v48 offset:8200
    ds_read_b64_tr_b16 a[46:47], v48 offset:8712
    s_waitcnt lgkmcnt(0)
    s_barrier
    s_add_u32 m0, s48, 32768
    s_mov_b32 s22, 1048576
    buffer_load_dwordx4 v44, s[8:11], s22 offen  lds
    s_add_u32 m0, s48, 36864
    s_mov_b32 s22, 1081344
    buffer_load_dwordx4 v44, s[8:11], s22 offen  lds
    s_add_u32 m0, s48, 40960
    s_mov_b32 s22, 1114112
    buffer_load_dwordx4 v44, s[8:11], s22 offen  lds
    s_add_u32 m0, s48, 45056
    s_mov_b32 s22, 1146880
    buffer_load_dwordx4 v44, s[8:11], s22 offen  lds
    s_waitcnt vmcnt(28)
    s_barrier
    v_add_u32 v48, 49152, v46
    ds_read_b64_tr_b16 a[48:49], v48 offset:0
    ds_read_b64_tr_b16 a[50:51], v48 offset:512
    ds_read_b64_tr_b16 a[52:53], v48 offset:8192
    ds_read_b64_tr_b16 a[54:55], v48 offset:8704
    ds_read_b64_tr_b16 a[56:57], v48 offset:8
    ds_read_b64_tr_b16 a[58:59], v48 offset:520
    ds_read_b64_tr_b16 a[60:61], v48 offset:8200
    ds_read_b64_tr_b16 a[62:63], v48 offset:8712
    s_waitcnt lgkmcnt(0)
    s_barrier
    s_add_u32 m0, s48, 49152
    s_mov_b32 s22, 1572864
    buffer_load_dwordx4 v44, s[8:11], s22 offen  lds
    s_add_u32 m0, s48, 53248
    s_mov_b32 s22, 1605632
    buffer_load_dwordx4 v44, s[8:11], s22 offen  lds
    s_add_u32 m0, s48, 57344
    s_mov_b32 s22, 1638400
    buffer_load_dwordx4 v44, s[8:11], s22 offen  lds
    s_add_u32 m0, s48, 61440
    s_mov_b32 s22, 1671168
    buffer_load_dwordx4 v44, s[8:11], s22 offen  lds
    s_waitcnt vmcnt(28)
    s_barrier
    v_add_u32 v48, 65536, v46
    ds_read_b64_tr_b16 a[64:65], v48 offset:0
    ds_read_b64_tr_b16 a[66:67], v48 offset:512
    ds_read_b64_tr_b16 a[68:69], v48 offset:8192
    ds_read_b64_tr_b16 a[70:71], v48 offset:8704
    ds_read_b64_tr_b16 a[72:73], v48 offset:8
    ds_read_b64_tr_b16 a[74:75], v48 offset:520
    ds_read_b64_tr_b16 a[76:77], v48 offset:8200
    ds_read_b64_tr_b16 a[78:79], v48 offset:8712
    s_waitcnt lgkmcnt(0)
    s_barrier
    s_add_u32 m0, s48, 65536
    s_mov_b32 s22, 2097152
    buffer_load_dwordx4 v44, s[8:11], s22 offen  lds
    s_add_u32 m0, s48, 69632
    s_mov_b32 s22, 2129920
    buffer_load_dwordx4 v44, s[8:11], s22 offen  lds
    s_add_u32 m0, s48, 73728
    s_mov_b32 s22, 2162688
    buffer_load_dwordx4 v44, s[8:11], s22 offen  lds
    s_add_u32 m0, s48, 77824
    s_mov_b32 s22, 2195456
    buffer_load_dwordx4 v44, s[8:11], s22 offen  lds
    s_waitcnt vmcnt(28)
    s_barrier
    v_add_u32 v48, 81920, v46
    ds_read_b64_tr_b16 a[80:81], v48 offset:0
    ds_read_b64_tr_b16 a[82:83], v48 offset:512
    ds_read_b64_tr_b16 a[84:85], v48 offset:8192
    ds_read_b64_tr_b16 a[86:87], v48 offset:8704
    ds_read_b64_tr_b16 a[88:89], v48 offset:8
    ds_read_b64_tr_b16 a[90:91], v48 offset:520
    ds_read_b64_tr_b16 a[92:93], v48 offset:8200
    ds_read_b64_tr_b16 a[94:95], v48 offset:8712
    s_waitcnt lgkmcnt(0)
    s_barrier
    s_add_u32 m0, s48, 81920
    s_mov_b32 s22, 2621440
    buffer_load_dwordx4 v44, s[8:11], s22 offen  lds
    s_add_u32 m0, s48, 86016
    s_mov_b32 s22, 2654208
    buffer_load_dwordx4 v44, s[8:11], s22 offen  lds
    s_add_u32 m0, s48, 90112
    s_mov_b32 s22, 2686976
    buffer_load_dwordx4 v44, s[8:11], s22 offen  lds
    s_add_u32 m0, s48, 94208
    s_mov_b32 s22, 2719744
    buffer_load_dwordx4 v44, s[8:11], s22 offen  lds
    s_waitcnt vmcnt(28)
    s_barrier
    v_add_u32 v48, 98304, v46
    ds_read_b64_tr_b16 a[96:97], v48 offset:0
    ds_read_b64_tr_b16 a[98:99], v48 offset:512
    ds_read_b64_tr_b16 a[100:101], v48 offset:8192
    ds_read_b64_tr_b16 a[102:103], v48 offset:8704
    ds_read_b64_tr_b16 a[104:105], v48 offset:8
    ds_read_b64_tr_b16 a[106:107], v48 offset:520
    ds_read_b64_tr_b16 a[108:109], v48 offset:8200
    ds_read_b64_tr_b16 a[110:111], v48 offset:8712
    s_waitcnt lgkmcnt(0)
    s_barrier
    s_add_u32 m0, s48, 98304
    s_mov_b32 s22, 3145728
    buffer_load_dwordx4 v44, s[8:11], s22 offen  lds
    s_add_u32 m0, s48, 102400
    s_mov_b32 s22, 3178496
    buffer_load_dwordx4 v44, s[8:11], s22 offen  lds
    s_add_u32 m0, s48, 106496
    s_mov_b32 s22, 3211264
    buffer_load_dwordx4 v44, s[8:11], s22 offen  lds
    s_add_u32 m0, s48, 110592
    s_mov_b32 s22, 3244032
    buffer_load_dwordx4 v44, s[8:11], s22 offen  lds
    s_waitcnt vmcnt(28)
    s_barrier
    v_add_u32 v48, 114688, v46
    ds_read_b64_tr_b16 a[112:113], v48 offset:0
    ds_read_b64_tr_b16 a[114:115], v48 offset:512
    ds_read_b64_tr_b16 a[116:117], v48 offset:8192
    ds_read_b64_tr_b16 a[118:119], v48 offset:8704
    ds_read_b64_tr_b16 a[120:121], v48 offset:8
    ds_read_b64_tr_b16 a[122:123], v48 offset:520
    ds_read_b64_tr_b16 a[124:125], v48 offset:8200
    ds_read_b64_tr_b16 a[126:127], v48 offset:8712
    s_waitcnt lgkmcnt(0)
    s_barrier
    s_add_u32 m0, s48, 114688
    s_mov_b32 s22, 3670016
    buffer_load_dwordx4 v44, s[8:11], s22 offen  lds
    s_add_u32 m0, s48, 118784
    s_mov_b32 s22, 3702784
    buffer_load_dwordx4 v44, s[8:11], s22 offen  lds
    s_add_u32 m0, s48, 122880
    s_mov_b32 s22, 3735552
    buffer_load_dwordx4 v44, s[8:11], s22 offen  lds
    s_add_u32 m0, s48, 126976
    s_mov_b32 s22, 3768320
    buffer_load_dwordx4 v44, s[8:11], s22 offen  lds
    s_waitcnt vmcnt(28)
    s_barrier
    v_add_u32 v48, 0, v46
    ds_read_b64_tr_b16 a[128:129], v48 offset:0
    ds_read_b64_tr_b16 a[130:131], v48 offset:512
    ds_read_b64_tr_b16 a[132:133], v48 offset:8192
    ds_read_b64_tr_b16 a[134:135], v48 offset:8704
    ds_read_b64_tr_b16 a[136:137], v48 offset:8
    ds_read_b64_tr_b16 a[138:139], v48 offset:520
    ds_read_b64_tr_b16 a[140:141], v48 offset:8200
    ds_read_b64_tr_b16 a[142:143], v48 offset:8712
    s_waitcnt lgkmcnt(0)
    s_barrier
    s_mov_b32 s8, s56
    s_mov_b32 s9, s57
    s_add_u32 m0, s48, 0
    s_mov_b32 s22, 0
    buffer_load_dwordx4 v45, s[8:11], s22 offen  lds
    s_add_u32 m0, s48, 4096
    s_mov_b32 s22, 16384
    buffer_load_dwordx4 v45, s[8:11], s22 offen  lds
    s_add_u32 m0, s48, 8192
    s_mov_b32 s22, 32768
    buffer_load_dwordx4 v45, s[8:11], s22 offen  lds
    s_add_u32 m0, s48, 12288
    s_mov_b32 s22, 49152
    buffer_load_dwordx4 v45, s[8:11], s22 offen  lds
    s_waitcnt vmcnt(28)
    s_barrier
    v_add_u32 v48, 16384, v46
    ds_read_b64_tr_b16 a[144:145], v48 offset:0
    ds_read_b64_tr_b16 a[146:147], v48 offset:512
    ds_read_b64_tr_b16 a[148:149], v48 offset:8192
    ds_read_b64_tr_b16 a[150:151], v48 offset:8704
    ds_read_b64_tr_b16 a[152:153], v48 offset:8
    ds_read_b64_tr_b16 a[154:155], v48 offset:520
    ds_read_b64_tr_b16 a[156:157], v48 offset:8200
    ds_read_b64_tr_b16 a[158:159], v48 offset:8712
    s_waitcnt lgkmcnt(0)
    s_barrier
    s_add_u32 m0, s48, 16384
    s_mov_b32 s22, 256
    buffer_load_dwordx4 v45, s[8:11], s22 offen  lds
    s_add_u32 m0, s48, 20480
    s_mov_b32 s22, 16640
    buffer_load_dwordx4 v45, s[8:11], s22 offen  lds
    s_add_u32 m0, s48, 24576
    s_mov_b32 s22, 33024
    buffer_load_dwordx4 v45, s[8:11], s22 offen  lds
    s_add_u32 m0, s48, 28672
    s_mov_b32 s22, 49408
    buffer_load_dwordx4 v45, s[8:11], s22 offen  lds
    s_waitcnt vmcnt(28)
    s_barrier
    v_add_u32 v48, 32768, v46
    ds_read_b64_tr_b16 a[160:161], v48 offset:0
    ds_read_b64_tr_b16 a[162:163], v48 offset:512
    ds_read_b64_tr_b16 a[164:165], v48 offset:8192
    ds_read_b64_tr_b16 a[166:167], v48 offset:8704
    ds_read_b64_tr_b16 a[168:169], v48 offset:8
    ds_read_b64_tr_b16 a[170:171], v48 offset:520
    ds_read_b64_tr_b16 a[172:173], v48 offset:8200
    ds_read_b64_tr_b16 a[174:175], v48 offset:8712
    s_waitcnt lgkmcnt(0)
    s_barrier
    s_add_u32 m0, s48, 32768
    s_mov_b32 s22, 512
    buffer_load_dwordx4 v45, s[8:11], s22 offen  lds
    s_add_u32 m0, s48, 36864
    s_mov_b32 s22, 16896
    buffer_load_dwordx4 v45, s[8:11], s22 offen  lds
    s_add_u32 m0, s48, 40960
    s_mov_b32 s22, 33280
    buffer_load_dwordx4 v45, s[8:11], s22 offen  lds
    s_add_u32 m0, s48, 45056
    s_mov_b32 s22, 49664
    buffer_load_dwordx4 v45, s[8:11], s22 offen  lds
    s_waitcnt vmcnt(28)
    s_barrier
    v_add_u32 v48, 49152, v46
    ds_read_b64_tr_b16 a[176:177], v48 offset:0
    ds_read_b64_tr_b16 a[178:179], v48 offset:512
    ds_read_b64_tr_b16 a[180:181], v48 offset:8192
    ds_read_b64_tr_b16 a[182:183], v48 offset:8704
    ds_read_b64_tr_b16 a[184:185], v48 offset:8
    ds_read_b64_tr_b16 a[186:187], v48 offset:520
    ds_read_b64_tr_b16 a[188:189], v48 offset:8200
    ds_read_b64_tr_b16 a[190:191], v48 offset:8712
    s_waitcnt lgkmcnt(0)
    s_barrier
    s_add_u32 m0, s48, 49152
    s_mov_b32 s22, 768
    buffer_load_dwordx4 v45, s[8:11], s22 offen  lds
    s_add_u32 m0, s48, 53248
    s_mov_b32 s22, 17152
    buffer_load_dwordx4 v45, s[8:11], s22 offen  lds
    s_add_u32 m0, s48, 57344
    s_mov_b32 s22, 33536
    buffer_load_dwordx4 v45, s[8:11], s22 offen  lds
    s_add_u32 m0, s48, 61440
    s_mov_b32 s22, 49920
    buffer_load_dwordx4 v45, s[8:11], s22 offen  lds
    s_waitcnt vmcnt(28)
    s_barrier
    v_and_b32 v37, 7, v0
    v_lshlrev_b32 v37, 5, v37
    buffer_load_dword v36, v37, s[88:91], 0 offen sc1
    buffer_load_dword v58, off, s[12:15], 0 offset:204 sc1
    v_add_u32 v48, 65536, v46
    ds_read_b64_tr_b16 a[192:193], v48 offset:0
    ds_read_b64_tr_b16 a[194:195], v48 offset:512
    ds_read_b64_tr_b16 a[196:197], v48 offset:8192
    ds_read_b64_tr_b16 a[198:199], v48 offset:8704
    ds_read_b64_tr_b16 a[200:201], v48 offset:8
    ds_read_b64_tr_b16 a[202:203], v48 offset:520
    ds_read_b64_tr_b16 a[204:205], v48 offset:8200
    ds_read_b64_tr_b16 a[206:207], v48 offset:8712
    s_waitcnt lgkmcnt(0)
    s_barrier
    s_add_u32 m0, s48, 65536
    s_mov_b32 s22, 131072
    buffer_load_dwordx4 v45, s[8:11], s22 offen  lds
    s_add_u32 m0, s48, 69632
    s_mov_b32 s22, 147456
    buffer_load_dwordx4 v45, s[8:11], s22 offen  lds
    s_add_u32 m0, s48, 73728
    s_mov_b32 s22, 163840
    buffer_load_dwordx4 v45, s[8:11], s22 offen  lds
    s_add_u32 m0, s48, 77824
    s_mov_b32 s22, 180224
    buffer_load_dwordx4 v45, s[8:11], s22 offen  lds
    s_waitcnt vmcnt(28)
    s_barrier
    v_add_u32 v48, 81920, v46
    ds_read_b64_tr_b16 a[208:209], v48 offset:0
    ds_read_b64_tr_b16 a[210:211], v48 offset:512
    ds_read_b64_tr_b16 a[212:213], v48 offset:8192
    ds_read_b64_tr_b16 a[214:215], v48 offset:8704
    ds_read_b64_tr_b16 a[216:217], v48 offset:8
    ds_read_b64_tr_b16 a[218:219], v48 offset:520
    ds_read_b64_tr_b16 a[220:221], v48 offset:8200
    ds_read_b64_tr_b16 a[222:223], v48 offset:8712
    s_waitcnt lgkmcnt(0)
    s_barrier
    s_add_u32 m0, s48, 81920
    s_mov_b32 s22, 131328
    buffer_load_dwordx4 v45, s[8:11], s22 offen  lds
    s_add_u32 m0, s48, 86016
    s_mov_b32 s22, 147712
    buffer_load_dwordx4 v45, s[8:11], s22 offen  lds
    s_add_u32 m0, s48, 90112
    s_mov_b32 s22, 164096
    buffer_load_dwordx4 v45, s[8:11], s22 offen  lds
    s_add_u32 m0, s48, 94208
    s_mov_b32 s22, 180480
    buffer_load_dwordx4 v45, s[8:11], s22 offen  lds
    s_waitcnt vmcnt(28)
    s_barrier
    v_add_u32 v48, 98304, v46
    ds_read_b64_tr_b16 a[224:225], v48 offset:0
    ds_read_b64_tr_b16 a[226:227], v48 offset:512
    ds_read_b64_tr_b16 a[228:229], v48 offset:8192
    ds_read_b64_tr_b16 a[230:231], v48 offset:8704
    ds_read_b64_tr_b16 a[232:233], v48 offset:8
    ds_read_b64_tr_b16 a[234:235], v48 offset:520
    ds_read_b64_tr_b16 a[236:237], v48 offset:8200
    ds_read_b64_tr_b16 a[238:239], v48 offset:8712
    s_waitcnt lgkmcnt(0)
    s_barrier
    s_add_u32 m0, s48, 98304
    s_mov_b32 s22, 131584
    buffer_load_dwordx4 v45, s[8:11], s22 offen  lds
    s_add_u32 m0, s48, 102400
    s_mov_b32 s22, 147968
    buffer_load_dwordx4 v45, s[8:11], s22 offen  lds
    s_add_u32 m0, s48, 106496
    s_mov_b32 s22, 164352
    buffer_load_dwordx4 v45, s[8:11], s22 offen  lds
    s_add_u32 m0, s48, 110592
    s_mov_b32 s22, 180736
    buffer_load_dwordx4 v45, s[8:11], s22 offen  lds
    s_waitcnt vmcnt(28)
    s_barrier
    v_add_u32 v48, 114688, v46
    ds_read_b64_tr_b16 a[240:241], v48 offset:0
    ds_read_b64_tr_b16 a[242:243], v48 offset:512
    ds_read_b64_tr_b16 a[244:245], v48 offset:8192
    ds_read_b64_tr_b16 a[246:247], v48 offset:8704
    ds_read_b64_tr_b16 a[248:249], v48 offset:8
    ds_read_b64_tr_b16 a[250:251], v48 offset:520
    ds_read_b64_tr_b16 a[252:253], v48 offset:8200
    ds_read_b64_tr_b16 a[254:255], v48 offset:8712
    s_waitcnt lgkmcnt(0)
    s_barrier
    s_add_u32 m0, s48, 114688
    s_mov_b32 s22, 131840
    buffer_load_dwordx4 v45, s[8:11], s22 offen  lds
    s_add_u32 m0, s48, 118784
    s_mov_b32 s22, 148224
    buffer_load_dwordx4 v45, s[8:11], s22 offen  lds
    s_add_u32 m0, s48, 122880
    s_mov_b32 s22, 164608
    buffer_load_dwordx4 v45, s[8:11], s22 offen  lds
    s_add_u32 m0, s48, 126976
    s_mov_b32 s22, 180992
    buffer_load_dwordx4 v45, s[8:11], s22 offen  lds
    s_waitcnt vmcnt(28)
    s_barrier
    s_cmp_lg_u32 s20, 0
    s_cbranch_scc1 mega_kernel_rf_wo0
    v_xor_b32 v48, 0, v47
    v_add_u32 v48, 0, v48
    ds_read_b64_tr_b16 v[128:129], v48 offset:0
    ds_read_b64_tr_b16 v[130:131], v48 offset:512
    ds_read_b64_tr_b16 v[132:133], v48 offset:8192
    ds_read_b64_tr_b16 v[134:135], v48 offset:8704
    ds_read_b64_tr_b16 v[144:145], v48 offset:32
    ds_read_b64_tr_b16 v[146:147], v48 offset:544
    ds_read_b64_tr_b16 v[148:149], v48 offset:8224
    ds_read_b64_tr_b16 v[150:151], v48 offset:8736
    s_waitcnt lgkmcnt(0)
    v_xor_b32 v48, 64, v47
    v_add_u32 v48, 0, v48
    ds_read_b64_tr_b16 v[160:161], v48 offset:0
    ds_read_b64_tr_b16 v[162:163], v48 offset:512
    ds_read_b64_tr_b16 v[164:165], v48 offset:8192
    ds_read_b64_tr_b16 v[166:167], v48 offset:8704
    ds_read_b64_tr_b16 v[176:177], v48 offset:32
    ds_read_b64_tr_b16 v[178:179], v48 offset:544
    ds_read_b64_tr_b16 v[180:181], v48 offset:8224
    ds_read_b64_tr_b16 v[182:183], v48 offset:8736
    s_waitcnt lgkmcnt(0)
    v_xor_b32 v48, 128, v47
    v_add_u32 v48, 0, v48
    ds_read_b64_tr_b16 v[192:193], v48 offset:0
    ds_read_b64_tr_b16 v[194:195], v48 offset:512
    ds_read_b64_tr_b16 v[196:197], v48 offset:8192
    ds_read_b64_tr_b16 v[198:199], v48 offset:8704
    ds_read_b64_tr_b16 v[208:209], v48 offset:32
    ds_read_b64_tr_b16 v[210:211], v48 offset:544
    ds_read_b64_tr_b16 v[212:213], v48 offset:8224
    ds_read_b64_tr_b16 v[214:215], v48 offset:8736
    s_waitcnt lgkmcnt(0)
    v_xor_b32 v48, 192, v47
    v_add_u32 v48, 0, v48
    ds_read_b64_tr_b16 v[224:225], v48 offset:0
    ds_read_b64_tr_b16 v[226:227], v48 offset:512
    ds_read_b64_tr_b16 v[228:229], v48 offset:8192
    ds_read_b64_tr_b16 v[230:231], v48 offset:8704
    ds_read_b64_tr_b16 v[240:241], v48 offset:32
    ds_read_b64_tr_b16 v[242:243], v48 offset:544
    ds_read_b64_tr_b16 v[244:245], v48 offset:8224
    ds_read_b64_tr_b16 v[246:247], v48 offset:8736
    s_waitcnt lgkmcnt(0)
mega_kernel_rf_wo0:
    s_barrier
    s_mov_b32 s8, s54
    s_mov_b32 s9, s55
    s_add_u32 m0, s48, 0
    s_mov_b32 s22, 0
    buffer_load_dwordx4 v44, s[8:11], s22 offen  lds
    s_add_u32 m0, s48, 4096
    s_mov_b32 s22, 32768
    buffer_load_dwordx4 v44, s[8:11], s22 offen  lds
    s_add_u32 m0, s48, 8192
    s_mov_b32 s22, 65536
    buffer_load_dwordx4 v44, s[8:11], s22 offen  lds
    s_add_u32 m0, s48, 12288
    s_mov_b32 s22, 98304
    buffer_load_dwordx4 v44, s[8:11], s22 offen  lds
    s_waitcnt vmcnt(28)
    s_barrier
    s_cmp_lg_u32 s20, 1
    s_cbranch_scc1 mega_kernel_rf_wo1
    v_xor_b32 v48, 0, v47
    v_add_u32 v48, 16384, v48
    ds_read_b64_tr_b16 v[128:129], v48 offset:0
    ds_read_b64_tr_b16 v[130:131], v48 offset:512
    ds_read_b64_tr_b16 v[132:133], v48 offset:8192
    ds_read_b64_tr_b16 v[134:135], v48 offset:8704
    ds_read_b64_tr_b16 v[144:145], v48 offset:32
    ds_read_b64_tr_b16 v[146:147], v48 offset:544
    ds_read_b64_tr_b16 v[148:149], v48 offset:8224
    ds_read_b64_tr_b16 v[150:151], v48 offset:8736
    s_waitcnt lgkmcnt(0)
    v_xor_b32 v48, 64, v47
    v_add_u32 v48, 16384, v48
    ds_read_b64_tr_b16 v[160:161], v48 offset:0
    ds_read_b64_tr_b16 v[162:163], v48 offset:512
    ds_read_b64_tr_b16 v[164:165], v48 offset:8192
    ds_read_b64_tr_b16 v[166:167], v48 offset:8704
    ds_read_b64_tr_b16 v[176:177], v48 offset:32
    ds_read_b64_tr_b16 v[178:179], v48 offset:544
    ds_read_b64_tr_b16 v[180:181], v48 offset:8224
    ds_read_b64_tr_b16 v[182:183], v48 offset:8736
    s_waitcnt lgkmcnt(0)
    v_xor_b32 v48, 128, v47
    v_add_u32 v48, 16384, v48
    ds_read_b64_tr_b16 v[192:193], v48 offset:0
    ds_read_b64_tr_b16 v[194:195], v48 offset:512
    ds_read_b64_tr_b16 v[196:197], v48 offset:8192
    ds_read_b64_tr_b16 v[198:199], v48 offset:8704
    ds_read_b64_tr_b16 v[208:209], v48 offset:32
    ds_read_b64_tr_b16 v[210:211], v48 offset:544
    ds_read_b64_tr_b16 v[212:213], v48 offset:8224
    ds_read_b64_tr_b16 v[214:215], v48 offset:8736
    s_waitcnt lgkmcnt(0)
    v_xor_b32 v48, 192, v47
    v_add_u32 v48, 16384, v48
    ds_read_b64_tr_b16 v[224:225], v48 offset:0
    ds_read_b64_tr_b16 v[226:227], v48 offset:512
    ds_read_b64_tr_b16 v[228:229], v48 offset:8192
    ds_read_b64_tr_b16 v[230:231], v48 offset:8704
    ds_read_b64_tr_b16 v[240:241], v48 offset:32
    ds_read_b64_tr_b16 v[242:243], v48 offset:544
    ds_read_b64_tr_b16 v[244:245], v48 offset:8224
    ds_read_b64_tr_b16 v[246:247], v48 offset:8736
    s_waitcnt lgkmcnt(0)
mega_kernel_rf_wo1:
    s_barrier
    s_add_u32 m0, s48, 16384
    s_mov_b32 s22, 524288
    buffer_load_dwordx4 v44, s[8:11], s22 offen  lds
    s_add_u32 m0, s48, 20480
    s_mov_b32 s22, 557056
    buffer_load_dwordx4 v44, s[8:11], s22 offen  lds
    s_add_u32 m0, s48, 24576
    s_mov_b32 s22, 589824
    buffer_load_dwordx4 v44, s[8:11], s22 offen  lds
    s_add_u32 m0, s48, 28672
    s_mov_b32 s22, 622592
    buffer_load_dwordx4 v44, s[8:11], s22 offen  lds
    s_waitcnt vmcnt(28)
    s_barrier
    s_cmp_lg_u32 s20, 2
    s_cbranch_scc1 mega_kernel_rf_wo2
    v_xor_b32 v48, 0, v47
    v_add_u32 v48, 32768, v48
    ds_read_b64_tr_b16 v[128:129], v48 offset:0
    ds_read_b64_tr_b16 v[130:131], v48 offset:512
    ds_read_b64_tr_b16 v[132:133], v48 offset:8192
    ds_read_b64_tr_b16 v[134:135], v48 offset:8704
    ds_read_b64_tr_b16 v[144:145], v48 offset:32
    ds_read_b64_tr_b16 v[146:147], v48 offset:544
    ds_read_b64_tr_b16 v[148:149], v48 offset:8224
    ds_read_b64_tr_b16 v[150:151], v48 offset:8736
    s_waitcnt lgkmcnt(0)
    v_xor_b32 v48, 64, v47
    v_add_u32 v48, 32768, v48
    ds_read_b64_tr_b16 v[160:161], v48 offset:0
    ds_read_b64_tr_b16 v[162:163], v48 offset:512
    ds_read_b64_tr_b16 v[164:165], v48 offset:8192
    ds_read_b64_tr_b16 v[166:167], v48 offset:8704
    ds_read_b64_tr_b16 v[176:177], v48 offset:32
    ds_read_b64_tr_b16 v[178:179], v48 offset:544
    ds_read_b64_tr_b16 v[180:181], v48 offset:8224
    ds_read_b64_tr_b16 v[182:183], v48 offset:8736
    s_waitcnt lgkmcnt(0)
    v_xor_b32 v48, 128, v47
    v_add_u32 v48, 32768, v48
    ds_read_b64_tr_b16 v[192:193], v48 offset:0
    ds_read_b64_tr_b16 v[194:195], v48 offset:512
    ds_read_b64_tr_b16 v[196:197], v48 offset:8192
    ds_read_b64_tr_b16 v[198:199], v48 offset:8704
    ds_read_b64_tr_b16 v[208:209], v48 offset:32
    ds_read_b64_tr_b16 v[210:211], v48 offset:544
    ds_read_b64_tr_b16 v[212:213], v48 offset:8224
    ds_read_b64_tr_b16 v[214:215], v48 offset:8736
    s_waitcnt lgkmcnt(0)
    v_xor_b32 v48, 192, v47
    v_add_u32 v48, 32768, v48
    ds_read_b64_tr_b16 v[224:225], v48 offset:0
    ds_read_b64_tr_b16 v[226:227], v48 offset:512
    ds_read_b64_tr_b16 v[228:229], v48 offset:8192
    ds_read_b64_tr_b16 v[230:231], v48 offset:8704
    ds_read_b64_tr_b16 v[240:241], v48 offset:32
    ds_read_b64_tr_b16 v[242:243], v48 offset:544
    ds_read_b64_tr_b16 v[244:245], v48 offset:8224
    ds_read_b64_tr_b16 v[246:247], v48 offset:8736
    s_waitcnt lgkmcnt(0)
mega_kernel_rf_wo2:
    s_barrier
    s_add_u32 m0, s48, 32768
    s_mov_b32 s22, 1048576
    buffer_load_dwordx4 v44, s[8:11], s22 offen  lds
    s_add_u32 m0, s48, 36864
    s_mov_b32 s22, 1081344
    buffer_load_dwordx4 v44, s[8:11], s22 offen  lds
    s_add_u32 m0, s48, 40960
    s_mov_b32 s22, 1114112
    buffer_load_dwordx4 v44, s[8:11], s22 offen  lds
    s_add_u32 m0, s48, 45056
    s_mov_b32 s22, 1146880
    buffer_load_dwordx4 v44, s[8:11], s22 offen  lds
    s_waitcnt vmcnt(28)
    s_barrier
    s_cmp_lg_u32 s20, 3
    s_cbranch_scc1 mega_kernel_rf_wo3
    v_xor_b32 v48, 0, v47
    v_add_u32 v48, 49152, v48
    ds_read_b64_tr_b16 v[128:129], v48 offset:0
    ds_read_b64_tr_b16 v[130:131], v48 offset:512
    ds_read_b64_tr_b16 v[132:133], v48 offset:8192
    ds_read_b64_tr_b16 v[134:135], v48 offset:8704
    ds_read_b64_tr_b16 v[144:145], v48 offset:32
    ds_read_b64_tr_b16 v[146:147], v48 offset:544
    ds_read_b64_tr_b16 v[148:149], v48 offset:8224
    ds_read_b64_tr_b16 v[150:151], v48 offset:8736
    s_waitcnt lgkmcnt(0)
    v_xor_b32 v48, 64, v47
    v_add_u32 v48, 49152, v48
    ds_read_b64_tr_b16 v[160:161], v48 offset:0
    ds_read_b64_tr_b16 v[162:163], v48 offset:512
    ds_read_b64_tr_b16 v[164:165], v48 offset:8192
    ds_read_b64_tr_b16 v[166:167], v48 offset:8704
    ds_read_b64_tr_b16 v[176:177], v48 offset:32
    ds_read_b64_tr_b16 v[178:179], v48 offset:544
    ds_read_b64_tr_b16 v[180:181], v48 offset:8224
    ds_read_b64_tr_b16 v[182:183], v48 offset:8736
    s_waitcnt lgkmcnt(0)
    v_xor_b32 v48, 128, v47
    v_add_u32 v48, 49152, v48
    ds_read_b64_tr_b16 v[192:193], v48 offset:0
    ds_read_b64_tr_b16 v[194:195], v48 offset:512
    ds_read_b64_tr_b16 v[196:197], v48 offset:8192
    ds_read_b64_tr_b16 v[198:199], v48 offset:8704
    ds_read_b64_tr_b16 v[208:209], v48 offset:32
    ds_read_b64_tr_b16 v[210:211], v48 offset:544
    ds_read_b64_tr_b16 v[212:213], v48 offset:8224
    ds_read_b64_tr_b16 v[214:215], v48 offset:8736
    s_waitcnt lgkmcnt(0)
    v_xor_b32 v48, 192, v47
    v_add_u32 v48, 49152, v48
    ds_read_b64_tr_b16 v[224:225], v48 offset:0
    ds_read_b64_tr_b16 v[226:227], v48 offset:512
    ds_read_b64_tr_b16 v[228:229], v48 offset:8192
    ds_read_b64_tr_b16 v[230:231], v48 offset:8704
    ds_read_b64_tr_b16 v[240:241], v48 offset:32
    ds_read_b64_tr_b16 v[242:243], v48 offset:544
    ds_read_b64_tr_b16 v[244:245], v48 offset:8224
    ds_read_b64_tr_b16 v[246:247], v48 offset:8736
    s_waitcnt lgkmcnt(0)
mega_kernel_rf_wo3:
    s_barrier
    s_add_u32 m0, s48, 49152
    s_mov_b32 s22, 1572864
    buffer_load_dwordx4 v44, s[8:11], s22 offen  lds
    s_add_u32 m0, s48, 53248
    s_mov_b32 s22, 1605632
    buffer_load_dwordx4 v44, s[8:11], s22 offen  lds
    s_add_u32 m0, s48, 57344
    s_mov_b32 s22, 1638400
    buffer_load_dwordx4 v44, s[8:11], s22 offen  lds
    s_add_u32 m0, s48, 61440
    s_mov_b32 s22, 1671168
    buffer_load_dwordx4 v44, s[8:11], s22 offen  lds
    s_waitcnt vmcnt(28)
    s_barrier
    s_cmp_lg_u32 s20, 0
    s_cbranch_scc1 mega_kernel_rf_wo4
    v_xor_b32 v48, 0, v47
    v_add_u32 v48, 65536, v48
    ds_read_b64_tr_b16 v[136:137], v48 offset:0
    ds_read_b64_tr_b16 v[138:139], v48 offset:512
    ds_read_b64_tr_b16 v[140:141], v48 offset:8192
    ds_read_b64_tr_b16 v[142:143], v48 offset:8704
    ds_read_b64_tr_b16 v[152:153], v48 offset:32
    ds_read_b64_tr_b16 v[154:155], v48 offset:544
    ds_read_b64_tr_b16 v[156:157], v48 offset:8224
    ds_read_b64_tr_b16 v[158:159], v48 offset:8736
    s_waitcnt lgkmcnt(0)
    v_xor_b32 v48, 64, v47
    v_add_u32 v48, 65536, v48
    ds_read_b64_tr_b16 v[168:169], v48 offset:0
    ds_read_b64_tr_b16 v[170:171], v48 offset:512
    ds_read_b64_tr_b16 v[172:173], v48 offset:8192
    ds_read_b64_tr_b16 v[174:175], v48 offset:8704
    ds_read_b64_tr_b16 v[184:185], v48 offset:32
    ds_read_b64_tr_b16 v[186:187], v48 offset:544
    ds_read_b64_tr_b16 v[188:189], v48 offset:8224
    ds_read_b64_tr_b16 v[190:191], v48 offset:8736
    s_waitcnt lgkmcnt(0)
    v_xor_b32 v48, 128, v47
    v_add_u32 v48, 65536, v48
    ds_read_b64_tr_b16 v[200:201], v48 offset:0
    ds_read_b64_tr_b16 v[202:203], v48 offset:512
    ds_read_b64_tr_b16 v[204:205], v48 offset:8192
    ds_read_b64_tr_b16 v[206:207], v48 offset:8704
    ds_read_b64_tr_b16 v[216:217], v48 offset:32
    ds_read_b64_tr_b16 v[218:219], v48 offset:544
    ds_read_b64_tr_b16 v[220:221], v48 offset:8224
    ds_read_b64_tr_b16 v[222:223], v48 offset:8736
    s_waitcnt lgkmcnt(0)
    v_xor_b32 v48, 192, v47
    v_add_u32 v48, 65536, v48
    ds_read_b64_tr_b16 v[232:233], v48 offset:0
    ds_read_b64_tr_b16 v[234:235], v48 offset:512
    ds_read_b64_tr_b16 v[236:237], v48 offset:8192
    ds_read_b64_tr_b16 v[238:239], v48 offset:8704
    ds_read_b64_tr_b16 v[248:249], v48 offset:32
    ds_read_b64_tr_b16 v[250:251], v48 offset:544
    ds_read_b64_tr_b16 v[252:253], v48 offset:8224
    ds_read_b64_tr_b16 v[254:255], v48 offset:8736
    s_waitcnt lgkmcnt(0)
mega_kernel_rf_wo4:
    s_barrier
    s_add_u32 m0, s48, 65536
    s_mov_b32 s22, 2097152
    buffer_load_dwordx4 v44, s[8:11], s22 offen  lds
    s_add_u32 m0, s48, 69632
    s_mov_b32 s22, 2129920
    buffer_load_dwordx4 v44, s[8:11], s22 offen  lds
    s_add_u32 m0, s48, 73728
    s_mov_b32 s22, 2162688
    buffer_load_dwordx4 v44, s[8:11], s22 offen  lds
    s_add_u32 m0, s48, 77824
    s_mov_b32 s22, 2195456
    buffer_load_dwordx4 v44, s[8:11], s22 offen  lds
    s_waitcnt vmcnt(28)
    s_barrier
    s_cmp_lg_u32 s20, 1
    s_cbranch_scc1 mega_kernel_rf_wo5
    v_xor_b32 v48, 0, v47
    v_add_u32 v48, 81920, v48
    ds_read_b64_tr_b16 v[136:137], v48 offset:0
    ds_read_b64_tr_b16 v[138:139], v48 offset:512
    ds_read_b64_tr_b16 v[140:141], v48 offset:8192
    ds_read_b64_tr_b16 v[142:143], v48 offset:8704
    ds_read_b64_tr_b16 v[152:153], v48 offset:32
    ds_read_b64_tr_b16 v[154:155], v48 offset:544
    ds_read_b64_tr_b16 v[156:157], v48 offset:8224
    ds_read_b64_tr_b16 v[158:159], v48 offset:8736
    s_waitcnt lgkmcnt(0)
    v_xor_b32 v48, 64, v47
    v_add_u32 v48, 81920, v48
    ds_read_b64_tr_b16 v[168:169], v48 offset:0
    ds_read_b64_tr_b16 v[170:171], v48 offset:512
    ds_read_b64_tr_b16 v[172:173], v48 offset:8192
    ds_read_b64_tr_b16 v[174:175], v48 offset:8704
    ds_read_b64_tr_b16 v[184:185], v48 offset:32
    ds_read_b64_tr_b16 v[186:187], v48 offset:544
    ds_read_b64_tr_b16 v[188:189], v48 offset:8224
    ds_read_b64_tr_b16 v[190:191], v48 offset:8736
    s_waitcnt lgkmcnt(0)
    v_xor_b32 v48, 128, v47
    v_add_u32 v48, 81920, v48
    ds_read_b64_tr_b16 v[200:201], v48 offset:0
    ds_read_b64_tr_b16 v[202:203], v48 offset:512
    ds_read_b64_tr_b16 v[204:205], v48 offset:8192
    ds_read_b64_tr_b16 v[206:207], v48 offset:8704
    ds_read_b64_tr_b16 v[216:217], v48 offset:32
    ds_read_b64_tr_b16 v[218:219], v48 offset:544
    ds_read_b64_tr_b16 v[220:221], v48 offset:8224
    ds_read_b64_tr_b16 v[222:223], v48 offset:8736
    s_waitcnt lgkmcnt(0)
    v_xor_b32 v48, 192, v47
    v_add_u32 v48, 81920, v48
    ds_read_b64_tr_b16 v[232:233], v48 offset:0
    ds_read_b64_tr_b16 v[234:235], v48 offset:512
    ds_read_b64_tr_b16 v[236:237], v48 offset:8192
    ds_read_b64_tr_b16 v[238:239], v48 offset:8704
    ds_read_b64_tr_b16 v[248:249], v48 offset:32
    ds_read_b64_tr_b16 v[250:251], v48 offset:544
    ds_read_b64_tr_b16 v[252:253], v48 offset:8224
    ds_read_b64_tr_b16 v[254:255], v48 offset:8736
    s_waitcnt lgkmcnt(0)
mega_kernel_rf_wo5:
    s_barrier
    s_add_u32 m0, s48, 81920
    s_mov_b32 s22, 2621440
    buffer_load_dwordx4 v44, s[8:11], s22 offen  lds
    s_add_u32 m0, s48, 86016
    s_mov_b32 s22, 2654208
    buffer_load_dwordx4 v44, s[8:11], s22 offen  lds
    s_add_u32 m0, s48, 90112
    s_mov_b32 s22, 2686976
    buffer_load_dwordx4 v44, s[8:11], s22 offen  lds
    s_add_u32 m0, s48, 94208
    s_mov_b32 s22, 2719744
    buffer_load_dwordx4 v44, s[8:11], s22 offen  lds
    s_waitcnt vmcnt(28)
    s_barrier
    s_cmp_lg_u32 s97, 0
    s_cbranch_scc1 mega_kernel_h2_2_ok
mega_kernel_h2_2_ev:
    v_cmp_ne_u32 vcc, 32, v36
    s_cbranch_vccz mega_kernel_h2_2_ok
    s_mov_b32 s78, 0
    v_readlane_b32 s81, v36, 0
    s_nop 3
    s_add_u32 s78, s78, s81
    v_readlane_b32 s81, v36, 1
    s_nop 3
    s_add_u32 s78, s78, s81
    v_readlane_b32 s81, v36, 2
    s_nop 3
    s_add_u32 s78, s78, s81
    v_readlane_b32 s81, v36, 3
    s_nop 3
    s_add_u32 s78, s78, s81
    v_readlane_b32 s81, v36, 4
    s_nop 3
    s_add_u32 s78, s78, s81
    v_readlane_b32 s81, v36, 5
    s_nop 3
    s_add_u32 s78, s78, s81
    v_readlane_b32 s81, v36, 6
    s_nop 3
    s_add_u32 s78, s78, s81
    v_readlane_b32 s81, v36, 7
    s_nop 3
    s_add_u32 s78, s78, s81
    s_cmp_eq_u32 s78, 256
    s_cbranch_scc1 mega_kernel_redo
    buffer_load_dword v36, v37, s[88:91], 0 offen sc1
    s_waitcnt vmcnt(0)
    s_branch mega_kernel_h2_2_ev
mega_kernel_h2_2_ok:
    s_cmp_lg_u32 s20, 2
    s_cbranch_scc1 mega_kernel_rf_wo6
    v_xor_b32 v48, 0, v47
    v_add_u32 v48, 98304, v48
    ds_read_b64_tr_b16 v[136:137], v48 offset:0
    ds_read_b64_tr_b16 v[138:139], v48 offset:512
    ds_read_b64_tr_b16 v[140:141], v48 offset:8192
    ds_read_b64_tr_b16 v[142:143], v48 offset:8704
    ds_read_b64_tr_b16 v[152:153], v48 offset:32
    ds_read_b64_tr_b16 v[154:155], v48 offset:544
    ds_read_b64_tr_b16 v[156:157], v48 offset:8224
    ds_read_b64_tr_b16 v[158:159], v48 offset:8736
    s_waitcnt lgkmcnt(0)
    v_xor_b32 v48, 64, v47
    v_add_u32 v48, 98304, v48
    ds_read_b64_tr_b16 v[168:169], v48 offset:0
    ds_read_b64_tr_b16 v[170:171], v48 offset:512
    ds_read_b64_tr_b16 v[172:173], v48 offset:8192
    ds_read_b64_tr_b16 v[174:175], v48 offset:8704
    ds_read_b64_tr_b16 v[184:185], v48 offset:32
    ds_read_b64_tr_b16 v[186:187], v48 offset:544
    ds_read_b64_tr_b16 v[188:189], v48 offset:8224
    ds_read_b64_tr_b16 v[190:191], v48 offset:8736
    s_waitcnt lgkmcnt(0)
    v_xor_b32 v48, 128, v47
    v_add_u32 v48, 98304, v48
    ds_read_b64_tr_b16 v[200:201], v48 offset:0
    ds_read_b64_tr_b16 v[202:203], v48 offset:512
    ds_read_b64_tr_b16 v[204:205], v48 offset:8192
    ds_read_b64_tr_b16 v[206:207], v48 offset:8704
    ds_read_b64_tr_b16 v[216:217], v48 offset:32
    ds_read_b64_tr_b16 v[218:219], v48 offset:544
    ds_read_b64_tr_b16 v[220:221], v48 offset:8224
    ds_read_b64_tr_b16 v[222:223], v48 offset:8736
    s_waitcnt lgkmcnt(0)
    v_xor_b32 v48, 192, v47
    v_add_u32 v48, 98304, v48
    ds_read_b64_tr_b16 v[232:233], v48 offset:0
    ds_read_b64_tr_b16 v[234:235], v48 offset:512
    ds_read_b64_tr_b16 v[236:237], v48 offset:8192
    ds_read_b64_tr_b16 v[238:239], v48 offset:8704
    ds_read_b64_tr_b16 v[248:249], v48 offset:32
    ds_read_b64_tr_b16 v[250:251], v48 offset:544
    ds_read_b64_tr_b16 v[252:253], v48 offset:8224
    ds_read_b64_tr_b16 v[254:255], v48 offset:8736
    s_waitcnt lgkmcnt(0)
mega_kernel_rf_wo6:
    s_barrier
    s_add_u32 m0, s48, 98304
    s_mov_b32 s22, 3145728
    buffer_load_dwordx4 v44, s[8:11], s22 offen  lds
    s_add_u32 m0, s48, 102400
    s_mov_b32 s22, 3178496
    buffer_load_dwordx4 v44, s[8:11], s22 offen  lds
    s_add_u32 m0, s48, 106496
    s_mov_b32 s22, 3211264
    buffer_load_dwordx4 v44, s[8:11], s22 offen  lds
    s_add_u32 m0, s48, 110592
    s_mov_b32 s22, 3244032
    buffer_load_dwordx4 v44, s[8:11], s22 offen  lds
    s_waitcnt vmcnt(28)
    s_barrier
    s_cmp_lg_u32 s20, 3
    s_cbranch_scc1 mega_kernel_rf_wo7
    v_xor_b32 v48, 0, v47
    v_add_u32 v48, 114688, v48
    ds_read_b64_tr_b16 v[136:137], v48 offset:0
    ds_read_b64_tr_b16 v[138:139], v48 offset:512
    ds_read_b64_tr_b16 v[140:141], v48 offset:8192
    ds_read_b64_tr_b16 v[142:143], v48 offset:8704
    ds_read_b64_tr_b16 v[152:153], v48 offset:32
    ds_read_b64_tr_b16 v[154:155], v48 offset:544
    ds_read_b64_tr_b16 v[156:157], v48 offset:8224
    ds_read_b64_tr_b16 v[158:159], v48 offset:8736
    s_waitcnt lgkmcnt(0)
    v_xor_b32 v48, 64, v47
    v_add_u32 v48, 114688, v48
    ds_read_b64_tr_b16 v[168:169], v48 offset:0
    ds_read_b64_tr_b16 v[170:171], v48 offset:512
    ds_read_b64_tr_b16 v[172:173], v48 offset:8192
    ds_read_b64_tr_b16 v[174:175], v48 offset:8704
    ds_read_b64_tr_b16 v[184:185], v48 offset:32
    ds_read_b64_tr_b16 v[186:187], v48 offset:544
    ds_read_b64_tr_b16 v[188:189], v48 offset:8224
    ds_read_b64_tr_b16 v[190:191], v48 offset:8736
    s_waitcnt lgkmcnt(0)
    v_xor_b32 v48, 128, v47
    v_add_u32 v48, 114688, v48
    ds_read_b64_tr_b16 v[200:201], v48 offset:0
    ds_read_b64_tr_b16 v[202:203], v48 offset:512
    ds_read_b64_tr_b16 v[204:205], v48 offset:8192
    ds_read_b64_tr_b16 v[206:207], v48 offset:8704
    ds_read_b64_tr_b16 v[216:217], v48 offset:32
    ds_read_b64_tr_b16 v[218:219], v48 offset:544
    ds_read_b64_tr_b16 v[220:221], v48 offset:8224
    ds_read_b64_tr_b16 v[222:223], v48 offset:8736
    s_waitcnt lgkmcnt(0)
    v_xor_b32 v48, 192, v47
    v_add_u32 v48, 114688, v48
    ds_read_b64_tr_b16 v[232:233], v48 offset:0
    ds_read_b64_tr_b16 v[234:235], v48 offset:512
    ds_read_b64_tr_b16 v[236:237], v48 offset:8192
    ds_read_b64_tr_b16 v[238:239], v48 offset:8704
    ds_read_b64_tr_b16 v[248:249], v48 offset:32
    ds_read_b64_tr_b16 v[250:251], v48 offset:544
    ds_read_b64_tr_b16 v[252:253], v48 offset:8224
    ds_read_b64_tr_b16 v[254:255], v48 offset:8736
    s_waitcnt lgkmcnt(0)
mega_kernel_rf_wo7:
    s_barrier
    s_add_u32 m0, s48, 114688
    s_mov_b32 s22, 3670016
    buffer_load_dwordx4 v44, s[8:11], s22 offen  lds
    s_add_u32 m0, s48, 118784
    s_mov_b32 s22, 3702784
    buffer_load_dwordx4 v44, s[8:11], s22 offen  lds
    s_add_u32 m0, s48, 122880
    s_mov_b32 s22, 3735552
    buffer_load_dwordx4 v44, s[8:11], s22 offen  lds
    s_add_u32 m0, s48, 126976
    s_mov_b32 s22, 3768320
    buffer_load_dwordx4 v44, s[8:11], s22 offen  lds
    s_waitcnt vmcnt(28)
    s_barrier
    v_add_u32 v48, 0, v46
    ds_read_b64_tr_b16 v[64:65], v48 offset:0
    ds_read_b64_tr_b16 v[66:67], v48 offset:512
    ds_read_b64_tr_b16 v[68:69], v48 offset:8192
    ds_read_b64_tr_b16 v[70:71], v48 offset:8704
    ds_read_b64_tr_b16 v[72:73], v48 offset:8
    ds_read_b64_tr_b16 v[74:75], v48 offset:520
    ds_read_b64_tr_b16 v[76:77], v48 offset:8200
    ds_read_b64_tr_b16 v[78:79], v48 offset:8712
    s_waitcnt lgkmcnt(0)
    s_barrier
    ds_write_b128 v32, v[64:67] offset:0
    ds_write_b128 v32, v[68:71] offset:1024
    ds_write_b128 v32, v[72:75] offset:2048
    ds_write_b128 v32, v[76:79] offset:3072
    s_waitcnt lgkmcnt(0)
    s_waitcnt vmcnt(24)
    s_barrier
    v_add_u32 v48, 16384, v46
    ds_read_b64_tr_b16 v[64:65], v48 offset:0
    ds_read_b64_tr_b16 v[66:67], v48 offset:512
    ds_read_b64_tr_b16 v[68:69], v48 offset:8192
    ds_read_b64_tr_b16 v[70:71], v48 offset:8704
    ds_read_b64_tr_b16 v[72:73], v48 offset:8
    ds_read_b64_tr_b16 v[74:75], v48 offset:520
    ds_read_b64_tr_b16 v[76:77], v48 offset:8200
    ds_read_b64_tr_b16 v[78:79], v48 offset:8712
    s_waitcnt lgkmcnt(0)
    s_barrier
    ds_write_b128 v32, v[64:67] offset:16384
    ds_write_b128 v32, v[68:71] offset:17408
    ds_write_b128 v32, v[72:75] offset:18432
    ds_write_b128 v32, v[76:79] offset:19456
    s_waitcnt lgkmcnt(0)
    s_waitcnt vmcnt(20)
    s_barrier
    s_getpc_b64 s[16:17]
mega_kernel_rf_pc0:
    s_add_u32 s16, s16, mega_kernel_rf_w0_entry - mega_kernel_rf_pc0
    s_addc_u32 s17, s17, 0
    v_lshlrev_b32 v49, 7, v0
    v_min_u32 v49, mega_kernel_rf_end - mega_kernel_rf_w0_entry, v49
    global_load_dword v50, v49, s[16:17]
    v_lshlrev_b32 v49, 7, v40
    s_xor_b32 s23, s35, 16384
    s_cmp_eq_u32 s20, 1
    s_cselect_b32 s22, s35, s47
    s_cmp_eq_u32 s20, 2
    s_cselect_b32 s22, s23, s22
    s_lshl_b32 s23, s31, 13
    s_add_u32 s23, s23, 178257920
    s_cmp_eq_u32 s20, 3
    s_cselect_b32 s22, s23, s22
    buffer_load_dword v51, v49, s[4:7], s22 offen sc1
    v_lshlrev_b32 v49, 13, v0
    v_and_b32 v49, 0x1fffff, v49
    s_mov_b32 s22, 67108864
    buffer_load_dword v52, v49, s[4:7], s22 offen sc1
    buffer_load_dword v57, v7, s[4:7], 0 offen sc1
    v_add_u32 v48, 32768, v46
    ds_read_b64_tr_b16 v[64:65], v48 offset:0
    ds_read_b64_tr_b16 v[66:67], v48 offset:512
    ds_read_b64_tr_b16 v[68:69], v48 offset:8192
    ds_read_b64_tr_b16 v[70:71], v48 offset:8704
    ds_read_b64_tr_b16 v[72:73], v48 offset:8
    ds_read_b64_tr_b16 v[74:75], v48 offset:520
    ds_read_b64_tr_b16 v[76:77], v48 offset:8200
    ds_read_b64_tr_b16 v[78:79], v48 offset:8712
    s_waitcnt lgkmcnt(0)
    s_barrier
    ds_write_b128 v32, v[64:67] offset:32768
    ds_write_b128 v32, v[68:71] offset:33792
    ds_write_b128 v32, v[72:75] offset:34816
    ds_write_b128 v32, v[76:79] offset:35840
    s_waitcnt lgkmcnt(0)
    s_waitcnt vmcnt(16)
    s_barrier
    v_add_u32 v48, 49152, v46
    ds_read_b64_tr_b16 v[64:65], v48 offset:0
    ds_read_b64_tr_b16 v[66:67], v48 offset:512
    ds_read_b64_tr_b16 v[68:69], v48 offset:8192
    ds_read_b64_tr_b16 v[70:71], v48 offset:8704
    ds_read_b64_tr_b16 v[72:73], v48 offset:8
    ds_read_b64_tr_b16 v[74:75], v48 offset:520
    ds_read_b64_tr_b16 v[76:77], v48 offset:8200
    ds_read_b64_tr_b16 v[78:79], v48 offset:8712
    s_waitcnt lgkmcnt(0)
    s_barrier
    ds_write_b128 v32, v[64:67] offset:49152
    ds_write_b128 v32, v[68:71] offset:50176
    ds_write_b128 v32, v[72:75] offset:51200
    ds_write_b128 v32, v[76:79] offset:52224
    s_waitcnt lgkmcnt(0)
    s_waitcnt vmcnt(12)
    s_barrier
    v_add_u32 v48, 65536, v46
    ds_read_b64_tr_b16 v[64:65], v48 offset:0
    ds_read_b64_tr_b16 v[66:67], v48 offset:512
    ds_read_b64_tr_b16 v[68:69], v48 offset:8192
    ds_read_b64_tr_b16 v[70:71], v48 offset:8704
    ds_read_b64_tr_b16 v[72:73], v48 offset:8
    ds_read_b64_tr_b16 v[74:75], v48 offset:520
    ds_read_b64_tr_b16 v[76:77], v48 offset:8200
    ds_read_b64_tr_b16 v[78:79], v48 offset:8712
    s_waitcnt lgkmcnt(0)
    s_barrier
    ds_write_b128 v33, v[64:67] offset:0
    ds_write_b128 v33, v[68:71] offset:1024
    ds_write_b128 v33, v[72:75] offset:2048
    ds_write_b128 v33, v[76:79] offset:3072
    s_waitcnt lgkmcnt(0)
    s_waitcnt vmcnt(8)
    s_barrier
    v_add_u32 v48, 81920, v46
    ds_read_b64_tr_b16 v[64:65], v48 offset:0
    ds_read_b64_tr_b16 v[66:67], v48 offset:512
    ds_read_b64_tr_b16 v[68:69], v48 offset:8192
    ds_read_b64_tr_b16 v[70:71], v48 offset:8704
    ds_read_b64_tr_b16 v[72:73], v48 offset:8
    ds_read_b64_tr_b16 v[74:75], v48 offset:520
    ds_read_b64_tr_b16 v[76:77], v48 offset:8200
    ds_read_b64_tr_b16 v[78:79], v48 offset:8712
    s_waitcnt lgkmcnt(0)
    s_barrier
    ds_write_b128 v33, v[64:67] offset:16384
    ds_write_b128 v33, v[68:71] offset:17408
    ds_write_b128 v33, v[72:75] offset:18432
    ds_write_b128 v33, v[76:79] offset:19456
    s_waitcnt lgkmcnt(0)
    s_waitcnt vmcnt(4)
    s_barrier
    v_add_u32 v48, 98304, v46
    ds_read_b64_tr_b16 v[64:65], v48 offset:0
    ds_read_b64_tr_b16 v[66:67], v48 offset:512
    ds_read_b64_tr_b16 v[68:69], v48 offset:8192
    ds_read_b64_tr_b16 v[70:71], v48 offset:8704
    ds_read_b64_tr_b16 v[72:73], v48 offset:8
    ds_read_b64_tr_b16 v[74:75], v48 offset:520
    ds_read_b64_tr_b16 v[76:77], v48 offset:8200
    ds_read_b64_tr_b16 v[78:79], v48 offset:8712
    s_waitcnt lgkmcnt(0)
    s_barrier
    ds_write_b128 v33, v[64:67] offset:32768
    ds_write_b128 v33, v[68:71] offset:33792
    ds_write_b128 v33, v[72:75] offset:34816
    ds_write_b128 v33, v[76:79] offset:35840
    s_waitcnt lgkmcnt(0)
    s_waitcnt vmcnt(0)
    s_barrier
    v_add_u32 v48, 114688, v46
    ds_read_b64_tr_b16 v[64:65], v48 offset:0
    ds_read_b64_tr_b16 v[66:67], v48 offset:512
    ds_read_b64_tr_b16 v[68:69], v48 offset:8192
    ds_read_b64_tr_b16 v[70:71], v48 offset:8704
    ds_read_b64_tr_b16 v[72:73], v48 offset:8
    ds_read_b64_tr_b16 v[74:75], v48 offset:520
    ds_read_b64_tr_b16 v[76:77], v48 offset:8200
    ds_read_b64_tr_b16 v[78:79], v48 offset:8712
    s_waitcnt lgkmcnt(0)
    s_barrier
    ds_write_b128 v33, v[64:67] offset:49152
    ds_write_b128 v33, v[68:71] offset:50176
    ds_write_b128 v33, v[72:75] offset:51200
    ds_write_b128 v33, v[76:79] offset:52224
    s_waitcnt lgkmcnt(0)
    s_branch mega_kernel_rf_iw1
mega_kernel_rf_iw:
    buffer_load_dword v58, off, s[12:15], 0 offset:204 sc1
    s_waitcnt vmcnt(0)
mega_kernel_rf_iw1:
    v_and_b32 v50, 0xffff, v58
    v_readfirstlane_b32 s60, v58
    v_cmp_ne_u32 vcc, s100, v50
    s_cbranch_vccnz mega_kernel_rf_iw
    s_lshr_b32 s60, s60, 15
    s_cmp_gt_u32 s60, s100
    s_cselect_b32 s60, 8192, 0
    s_bfe_u32 s22, s31, 0x10001
    s_lshl_b32 s22, s22, 12
    s_add_u32 s22, s22, s60
    s_lshl_b32 s23, s20, 10
    s_add_u32 s22, s22, s23
    s_add_u32 s38, s38, s22
    s_add_u32 s37, s37, s22
    s_xor_b32 s40, s38, 4096
    s_xor_b32 s39, s37, 4096
    s_xor_b32 s36, s35, 16384
    s_mov_b32 s21, 0
    s_cmp_eq_u32 s30, 0
    s_mov_b32 s22, 0x33003300
    s_cselect_b32 s16, 0x00330033, s22
    s_mov_b32 s17, s16
    s_cselect_b32 s18, -1, 0
    s_not_b32 s19, s18
    s_lshl_b32 s22, s31, 13
    s_lshl_b32 s23, s20, 11
    s_add_u32 s22, s22, s23
    s_add_u32 s43, s22, 16777216
    s_add_u32 s44, s22, 33554432
    s_lshl_b32 s45, s31, 13
    s_add_u32 s45, s45, 178257920
    s_mul_i32 s48, s20, 5120
    s_add_u32 m0, s48, 140288
    s_mov_b32 s41, 1
    s_mov_b32 s42, 1
    v_mov_b32 v0, v34
    v_bfrev_b32 v12, 1
    v_bfrev_b32 v3, 1
    v_cndmask_b32 v10, v3, v10, s[16:17]
    v_cndmask_b32 v9, v3, v9, s[26:27]
    s_sub_u32 s45, s45, 0
    s_lshl_b32 s51, s30, 11
    s_add_u32 s51, s51, s45
    s_mov_b32 s50, 0
    s_cmp_lg_u32 s20, 3
    s_cbranch_scc1 mega_kernel_rf_kv0
    v_readlane_b32 s50, v57, 0
    v_readlane_b32 s22, v57, 2
    v_readlane_b32 s23, v57, 1
    v_readlane_b32 s24, v57, 3
    s_nop 3
    s_min_u32 s50, s50, s22
    s_min_u32 s23, s23, s24
    s_lshl_b32 s50, s50, 1
    s_lshl_b32 s23, s23, 1
    s_add_u32 s23, s23, 1
    s_min_u32 s50, s50, s23
mega_kernel_rf_kvb0:
    s_add_u32 s22, s21, 1
    s_min_u32 s22, s22, 63
    s_cmp_gt_u32 s50, s22
    s_cbranch_scc1 mega_kernel_rf_kvd0
    buffer_load_dword v48, v7, s[4:7], 0 offen sc1
    s_waitcnt vmcnt(0)
    v_readlane_b32 s50, v48, 0
    v_readlane_b32 s22, v48, 2
    v_readlane_b32 s23, v48, 1
    v_readlane_b32 s24, v48, 3
    s_nop 3
    s_min_u32 s50, s50, s22
    s_min_u32 s23, s23, s24
    s_lshl_b32 s50, s50, 1
    s_lshl_b32 s23, s23, 1
    s_add_u32 s23, s23, 1
    s_min_u32 s50, s50, s23
    s_branch mega_kernel_rf_kvb0
mega_kernel_rf_kvd0:
mega_kernel_rf_kv0:
    s_barrier
    s_cmp_eq_u32 s20, 1
    s_cbranch_scc1 mega_kernel_rf_w1_entry
    s_cmp_eq_u32 s20, 2
    s_cbranch_scc1 mega_kernel_rf_w2_entry
    s_cmp_eq_u32 s20, 3
    s_cbranch_scc1 mega_kernel_rf_w3_entry
mega_kernel_rf_w0_entry:
    v_mfma_f32_32x32x8_bf16 v[96:111], v[14:15], v[14:15], 0
    v_mfma_f32_16x16x16_bf16 v[112:115], v[14:15], v[14:15], 0
    v_mfma_f32_16x16x16_bf16 v[116:119], v[14:15], v[14:15], 0
    ds_read_b128 v[64:67], v1 offset:0
    ds_read_b128 v[68:71], v1 offset:1024
    ds_read_b128 v[72:75], v1 offset:2048
    ds_read_b128 v[76:79], v1 offset:3072
    ds_read_b128 v[80:83], v1 offset:16384
    ds_read_b128 v[84:87], v1 offset:17408
    ds_read_b128 v[88:91], v1 offset:18432
    ds_read_b128 v[92:95], v1 offset:19456
    buffer_load_dwordx4 v[120:123], v1, s[4:7], s44 offen
    buffer_load_dwordx4 v[124:127], v1, s[4:7], s44 offen offset:1024
    s_add_u32 s44, s44, 262144
mega_kernel_rf_w0_loop:
    s_add_u32 s22, s35, 0
    s_waitcnt vmcnt(0)
    buffer_load_dwordx4 v[32:35], v1, s[4:7], s22 offen sc1
    buffer_load_dwordx4 v[36:39], v1, s[4:7], s22 offen offset:1024 sc1
mega_kernel_rf_w0_pa:
    s_waitcnt vmcnt(1)
    ds_write_b128 v6, v[32:35] offset:0
    s_waitcnt vmcnt(0)
    ds_write_b128 v6, v[36:39] offset:1024
    v_max3_u32 v3, v32, v34, v36
    v_max_u32 v3, v3, v38
    v_cmp_eq_u32 vcc, -1, v3
    v_smfmac_f32_16x16x64_bf16 v[96:99], v[32:35], a[0:7], v2
    buffer_load_dwordx4 v[32:35], v1, s[4:7], s22 offen sc1
    v_smfmac_f32_16x16x64_bf16 v[100:103], v[32:35], a[8:15], v2
    buffer_load_dwordx4 v[36:39], v1, s[4:7], s22 offen offset:1024 sc1
    v_smfmac_f32_16x16x64_bf16 v[104:107], v[32:35], a[128:135], v2
    s_cbranch_vccnz mega_kernel_rf_w0_pafail
    s_waitcnt lgkmcnt(0)
    s_barrier
    ds_read_b128 v[40:43], v6 offset:2048
    ds_read_b128 v[44:47], v6 offset:3072
    v_smfmac_f32_16x16x64_bf16 v[108:111], v[32:35], a[136:143], v2
    ds_read_b128 v[48:51], v6 offset:4096
    v_smfmac_f32_16x16x64_bf16 v[96:99], v[36:39], a[16:23], v2
    ds_read_b128 v[52:55], v6 offset:5120
    v_smfmac_f32_16x16x64_bf16 v[100:103], v[36:39], a[24:31], v2
    ds_read_b128 v[56:59], v6 offset:6144
    v_smfmac_f32_16x16x64_bf16 v[104:107], v[36:39], a[144:151], v2
    ds_read_b128 v[60:63], v6 offset:7168
    v_smfmac_f32_16x16x64_bf16 v[108:111], v[36:39], a[152:159], v2
    buffer_load_dwordx4 v1, s[4:7], s43 offen lds
    s_waitcnt lgkmcnt(5)
    v_smfmac_f32_16x16x64_bf16 v[96:99], v[40:43], a[32:39], v2
    v_smfmac_f32_16x16x64_bf16 v[104:107], v[40:43], a[160:167], v2
    s_waitcnt lgkmcnt(4)
    v_smfmac_f32_16x16x64_bf16 v[96:99], v[44:47], a[48:55], v2
    v_smfmac_f32_16x16x64_bf16 v[104:107], v[44:47], a[176:183], v2
    buffer_load_dwordx4 v1, s[4:7], s43 offen offset:1024 lds
    s_waitcnt lgkmcnt(3)
    v_smfmac_f32_16x16x64_bf16 v[96:99], v[48:51], a[64:71], v2
    v_smfmac_f32_16x16x64_bf16 v[104:107], v[48:51], a[192:199], v2
    s_waitcnt lgkmcnt(2)
    v_smfmac_f32_16x16x64_bf16 v[96:99], v[52:55], a[80:87], v2
    v_smfmac_f32_16x16x64_bf16 v[104:107], v[52:55], a[208:215], v2
    v_mov_b32 v4, s21
    buffer_store_dword v4, v7, s[4:7], 0 offen sc1
    s_waitcnt lgkmcnt(1)
    v_smfmac_f32_16x16x64_bf16 v[96:99], v[56:59], a[96:103], v2
    v_smfmac_f32_16x16x64_bf16 v[104:107], v[56:59], a[224:231], v2
    s_waitcnt lgkmcnt(0)
    v_smfmac_f32_16x16x64_bf16 v[96:99], v[60:63], a[112:119], v2
    v_smfmac_f32_16x16x64_bf16 v[104:107], v[60:63], a[240:247], v2
    v_smfmac_f32_16x16x64_bf16 v[100:103], v[40:43], a[40:47], v2
    s_nop 2
    v_smfmac_f32_16x16x64_bf16 v[100:103], v[44:47], a[56:63], v2
    s_nop 1
    v_add_f32 v96, v96, v98
    v_smfmac_f32_16x16x64_bf16 v[100:103], v[48:51], a[72:79], v2
    v_add_f32 v97, v97, v99
    v_add_f32 v104, v104, v106
    v_smfmac_f32_16x16x64_bf16 v[100:103], v[52:55], a[88:95], v2
    v_add_f32 v105, v105, v107
    v_cvt_pk_bf16_f32 v96, v96, v97
    v_smfmac_f32_16x16x64_bf16 v[100:103], v[56:59], a[104:111], v2
    v_cvt_pk_bf16_f32 v97, v104, v105
    v_and_or_b32 v96, v96, -2, s41
    v_smfmac_f32_16x16x64_bf16 v[100:103], v[60:63], a[120:127], v2
    buffer_store_dwordx2 v[96:97], v11, s[4:7], s37 offen sc1
    v_smfmac_f32_16x16x64_bf16 v[108:111], v[40:43], a[168:175], v2
    v_smfmac_f32_16x16x64_bf16 v[108:111], v[44:47], a[184:191], v2
    v_smfmac_f32_16x16x64_bf16 v[108:111], v[48:51], a[200:207], v2
    v_smfmac_f32_16x16x64_bf16 v[108:111], v[52:55], a[216:223], v2
    v_smfmac_f32_16x16x64_bf16 v[108:111], v[56:59], a[232:239], v2
    s_nop 2
    v_add_f32 v100, v100, v102
    v_smfmac_f32_16x16x64_bf16 v[108:111], v[60:63], a[248:255], v2
    v_add_f32 v101, v101, v103
    v_cvt_pk_bf16_f32 v98, v100, v101
    v_and_or_b32 v98, v98, -2, s41
    s_nop 4
    v_pk_add_f32 v[108:109], v[108:109], v[110:111]
    v_cvt_pk_bf16_f32 v99, v108, v109
    buffer_store_dwordx2 v[98:99], v11, s[4:7], s37 offen offset:512 sc1
    v_smfmac_f32_16x16x64_bf16 v[112:115], v[32:35], v[64:71], v2
    ds_read_b128 v[64:67], v1 offset:32768
    ds_read_b128 v[68:71], v1 offset:33792
    v_smfmac_f32_16x16x64_bf16 v[116:119], v[32:35], v[72:79], v2
    ds_read_b128 v[72:75], v1 offset:34816
    ds_read_b128 v[76:79], v1 offset:35840
    v_smfmac_f32_16x16x64_bf16 v[112:115], v[36:39], v[80:87], v2
    ds_read_b128 v[80:83], v1 offset:49152
    ds_read_b128 v[84:87], v1 offset:50176
    v_smfmac_f32_16x16x64_bf16 v[116:119], v[36:39], v[88:95], v2
    ds_read_b128 v[88:91], v1 offset:51200
    ds_read_b128 v[92:95], v1 offset:52224
    s_waitcnt lgkmcnt(6)
    v_smfmac_f32_16x16x64_bf16 v[112:115], v[40:43], v[64:71], v2
    ds_read_b128 v[64:67], v5 offset:0
    ds_read_b128 v[68:71], v5 offset:1024
    s_waitcnt lgkmcnt(6)
    v_smfmac_f32_16x16x64_bf16 v[116:119], v[40:43], v[72:79], v2
    ds_read_b128 v[72:75], v5 offset:2048
    ds_read_b128 v[76:79], v5 offset:3072
    s_waitcnt lgkmcnt(6)
    v_smfmac_f32_16x16x64_bf16 v[112:115], v[44:47], v[80:87], v2
    ds_read_b128 v[80:83], v5 offset:16384
    ds_read_b128 v[84:87], v5 offset:17408
    s_waitcnt lgkmcnt(6)
    v_smfmac_f32_16x16x64_bf16 v[116:119], v[44:47], v[88:95], v2
    ds_read_b128 v[88:91], v5 offset:18432
    ds_read_b128 v[92:95], v5 offset:19456
    s_waitcnt lgkmcnt(6)
    v_smfmac_f32_16x16x64_bf16 v[112:115], v[48:51], v[64:71], v2
    ds_read_b128 v[64:67], v5 offset:32768
    ds_read_b128 v[68:71], v5 offset:33792
    s_waitcnt lgkmcnt(6)
    v_smfmac_f32_16x16x64_bf16 v[116:119], v[48:51], v[72:79], v2
    ds_read_b128 v[72:75], v5 offset:34816
    ds_read_b128 v[76:79], v5 offset:35840
    s_waitcnt lgkmcnt(6)
    v_smfmac_f32_16x16x64_bf16 v[112:115], v[52:55], v[80:87], v2
    ds_read_b128 v[80:83], v5 offset:49152
    ds_read_b128 v[84:87], v5 offset:50176
    s_waitcnt lgkmcnt(6)
    v_smfmac_f32_16x16x64_bf16 v[116:119], v[52:55], v[88:95], v2
    ds_read_b128 v[88:91], v5 offset:51200
    ds_read_b128 v[92:95], v5 offset:52224
    s_waitcnt lgkmcnt(6)
    v_smfmac_f32_16x16x64_bf16 v[112:115], v[56:59], v[64:71], v2
    s_waitcnt lgkmcnt(4)
    v_smfmac_f32_16x16x64_bf16 v[116:119], v[56:59], v[72:79], v2
    s_waitcnt lgkmcnt(2)
    v_smfmac_f32_16x16x64_bf16 v[112:115], v[60:63], v[80:87], v2
    s_waitcnt lgkmcnt(0)
    v_smfmac_f32_16x16x64_bf16 v[116:119], v[60:63], v[88:95], v2
    buffer_load_dwordx2 v[108:109], v11, s[4:7], s38 offen sc1
    v_mfma_f32_16x16x16_bf16 v[100:103], v[96:97], v[16:17], 0
    v_mfma_f32_16x16x16_bf16 v[104:107], v[98:99], v[16:17], 0
    s_nop 4
    v_add_f32 v112, v112, v114
    v_add_f32 v113, v113, v115
    v_add_f32 v114, v116, v118
    v_add_f32 v115, v117, v119
    v_cvt_pk_bf16_f32 v18, v112, v113
    v_cvt_pk_bf16_f32 v19, v114, v115
    v_and_or_b32 v18, v18, -2, s41
    buffer_load_dwordx2 v[110:111], v11, s[4:7], s38 offen offset:512 sc1
    s_barrier
    buffer_store_dwordx2 v[18:19], v11, s[4:7], s39 offen sc1
    v_mov_b32 v112, v18
    v_mov_b32 v114, v19
    v_mov_b32 v92, v28
    v_mov_b32 v93, 0
    s_waitcnt vmcnt(6)
    s_barrier
    ds_read_b128 v[32:35], v6 offset:9216
    ds_read_b128 v[36:39], v6 offset:10240
    ds_read_b128 v[40:43], v6 offset:14336
    ds_read_b128 v[44:47], v6 offset:15360
    ds_read_b128 v[48:51], v6 offset:19456
    ds_read_b128 v[52:55], v6 offset:20480
    ds_read_b128 v[56:59], v6 offset:24576
    ds_read_b128 v[60:63], v6 offset:25600
    buffer_load_dwordx2 v[20:21], v11, s[4:7], s38 offen sc1
    buffer_load_dwordx2 v[22:23], v11, s[4:7], s38 offen offset:512 sc1
    s_waitcnt vmcnt(4)
    v_mfma_f32_16x16x16_bf16 v[80:83], v[108:109], v[16:17], v[100:103]
    v_and_b32 v3, 1, v108
    v_cmp_ne_u32 vcc, s41, v3
    s_nop 5
    v_cvt_pk_bf16_f32 v64, v80, v81
    v_cvt_pk_bf16_f32 v65, v82, v83
    s_cbranch_vccnz mega_kernel_rf_w0_xslow
    s_waitcnt vmcnt(3)
    v_mfma_f32_16x16x16_bf16 v[84:87], v[110:111], v[16:17], v[104:107]
    v_and_b32 v3, 1, v110
    v_cmp_ne_u32 vcc, s41, v3
    s_nop 5
    v_cvt_pk_bf16_f32 v66, v84, v85
    v_cvt_pk_bf16_f32 v67, v86, v87
    ds_write_b128 v6, v[64:67] offset:8192
    s_cbranch_vccnz mega_kernel_rf_w0_xslow
mega_kernel_rf_w0_xok:
    s_cmp_eq_u32 s21, 63
    s_cbranch_scc1 mega_kernel_rf_w0_last
    buffer_load_dwordx2 v[116:117], v11, s[4:7], s40 offen sc1
    s_waitcnt lgkmcnt(1)
    v_mfma_f32_16x16x32_bf16 v[80:83], v[32:35], v[64:67], 0
    s_waitcnt lgkmcnt(0)
    s_barrier
    ds_read_b128 v[68:71], v6 offset:13312
    ds_read_b128 v[72:75], v6 offset:18432
    ds_read_b128 v[76:79], v6 offset:23552
    v_mfma_f32_16x16x32_bf16 v[84:87], v[36:39], v[64:67], 0
    v_mfma_f32_16x16x32_bf16 v[88:91], v[64:67], v[64:67], 0
    buffer_load_dwordx2 v[20:21], v11, s[4:7], s40 offen sc1
    s_waitcnt lgkmcnt(2)
    v_mfma_f32_16x16x32_bf16 v[80:83], v[40:43], v[68:71], v[80:83]
    buffer_store_dwordx4 v[64:67], v10, s[4:7], s45 offen offset:0 sc1
    s_waitcnt lgkmcnt(1)
    v_mfma_f32_16x16x32_bf16 v[80:83], v[48:51], v[72:75], v[80:83]
    s_waitcnt lgkmcnt(0)
    v_mfma_f32_16x16x32_bf16 v[80:83], v[56:59], v[76:79], v[80:83]
    v_mfma_f32_16x16x32_bf16 v[84:87], v[44:47], v[68:71], v[84:87]
    v_mfma_f32_16x16x32_bf16 v[84:87], v[52:55], v[72:75], v[84:87]
    buffer_store_dwordx2 v[18:19], v11, s[4:7], s51 offen offset:2048 sc1
    v_mfma_f32_16x16x32_bf16 v[84:87], v[60:63], v[76:79], v[84:87]
    v_mfma_f32_16x16x32_bf16 v[88:91], v[68:71], v[68:71], v[88:91]
    v_mfma_f32_16x16x32_bf16 v[88:91], v[72:75], v[72:75], v[88:91]
    v_mfma_f32_16x16x32_bf16 v[88:91], v[76:79], v[76:79], v[88:91]
    v_mfma_f32_32x32x4_2b_bf16 v[32:63], v[14:15], v[14:15], 0
    s_nop 0
    v_max3_f32 v4, v80, v81, v82
    s_nop 1
    v_max3_f32 v4, v4, v83, v84
    v_max3_f32 v4, v4, v85, v86
    v_max_f32 v4, v4, v87
    v_max3_f32 v90, v4, v88, v89
    v_max3_f32 v4, v4, v88, v89
    s_nop 1
    v_permlane16_swap_b32 v4, v90
    v_max_f32 v4, v4, v90
    v_max_f32 v90, v4, v90
    s_nop 1
    v_permlane32_swap_b32 v4, v90
    v_max_f32 v4, v4, v90
    v_mul_f32 v4, s34, v4
    v_pk_fma_f32 v[80:81], v[80:81], s[34:35], v[4:5] op_sel_hi:[1,0,0] neg_lo:[0,0,1] neg_hi:[0,0,1]
    v_pk_fma_f32 v[82:83], v[82:83], s[34:35], v[4:5] op_sel_hi:[1,0,0] neg_lo:[0,0,1] neg_hi:[0,0,1]
    v_pk_fma_f32 v[84:85], v[84:85], s[34:35], v[4:5] op_sel_hi:[1,0,0] neg_lo:[0,0,1] neg_hi:[0,0,1]
    v_pk_fma_f32 v[86:87], v[86:87], s[34:35], v[4:5] op_sel_hi:[1,0,0] neg_lo:[0,0,1] neg_hi:[0,0,1]
    v_pk_fma_f32 v[88:89], v[88:89], s[34:35], v[4:5] op_sel_hi:[1,0,0] neg_lo:[0,0,1] neg_hi:[0,0,1]
    v_exp_f32 v80, v80
    v_exp_f32 v81, v81
    v_exp_f32 v82, v82
    v_cvt_pk_bf16_f32 v68, v80, v81
    v_exp_f32 v83, v83
    v_exp_f32 v84, v84
    v_cvt_pk_bf16_f32 v69, v82, v83
    v_exp_f32 v85, v85
    v_exp_f32 v86, v86
    v_cvt_pk_bf16_f32 v70, v84, v85
    v_exp_f32 v87, v87
    v_exp_f32 v88, v88
    v_cvt_pk_bf16_f32 v71, v86, v87
    v_exp_f32 v89, v89
    s_waitcnt vmcnt(3)
    v_mfma_f32_16x16x32_bf16 v[76:79], v[28:31], v[68:71], 0
    v_and_b32 v3, 1, v116
    v_cvt_pk_bf16_f32 v72, v88, v89
    v_mfma_f32_16x16x32_bf16 v[100:103], v[120:123], v[68:71], 0
    v_cmp_ne_u32 vcc, s41, v3
    v_cvt_pk_bf16_f32 v73, v88, v89
    v_mfma_f32_16x16x32_bf16 v[104:107], v[124:127], v[68:71], 0
    v_mov_b32 v113, v116
    v_mov_b32 v115, v117
    v_mfma_f32_16x16x16_bf16 v[76:79], v[92:93], v[72:73], v[76:79]
    s_cbranch_vccnz mega_kernel_rf_w0_pv0
mega_kernel_rf_w0_pv2:
    v_mfma_f32_16x16x16_bf16 v[100:103], v[112:113], v[72:73], v[100:103]
    v_mfma_f32_16x16x16_bf16 v[104:107], v[114:115], v[72:73], v[104:107]
    buffer_load_dwordx4 v[120:123], v1, s[4:7], s44 offen
    buffer_load_dwordx4 v[124:127], v1, s[4:7], s44 offen offset:1024
    s_nop 2
    v_rcp_f32 v76, v76
    s_mov_b64 exec, s[28:29]
    v_pk_mul_f32 v[100:101], v[100:101], v[76:77] op_sel_hi:[1,0]
    v_pk_mul_f32 v[102:103], v[102:103], v[76:77] op_sel_hi:[1,0]
    v_pk_mul_f32 v[104:105], v[104:105], v[76:77] op_sel_hi:[1,0]
    v_pk_mul_f32 v[106:107], v[106:107], v[76:77] op_sel_hi:[1,0]
    v_cvt_pk_bf16_f32 v84, v100, v101
    v_cvt_pk_bf16_f32 v85, v102, v103
    v_cvt_pk_bf16_f32 v86, v104, v105
    v_cvt_pk_bf16_f32 v87, v106, v107
    ds_write_b128 v6, v[84:87] offset:28640
    s_mov_b64 exec, -1
    s_waitcnt lgkmcnt(0)
    s_barrier
    ds_read_b128 v[68:71], v6 offset:28672
    ds_read_b128 v[72:75], v6 offset:29696
    s_waitcnt lgkmcnt(1)
    v_smfmac_f32_16x16x64_bf16 v[32:35], v[68:71], v[128:135], v2
    s_add_u32 s21, s21, 1
    s_xor_b32 s38, s38, 1048576
    s_xor_b32 s37, s37, 1048576
    s_waitcnt lgkmcnt(0)
    v_smfmac_f32_16x16x64_bf16 v[32:35], v[72:75], v[136:143], v2
    s_xor_b32 s40, s40, 1048576
    s_xor_b32 s39, s39, 1048576
    s_lshr_b32 s41, s21, 1
    v_smfmac_f32_16x16x64_bf16 v[36:39], v[68:71], v[144:151], v2
    s_and_b32 s41, s41, 1
    s_xor_b32 s41, s41, 1
    s_xor_b32 s35, s35, 16384
    v_smfmac_f32_16x16x64_bf16 v[36:39], v[72:75], v[152:159], v2
    v_add_f32 v32, v32, v34
    s_xor_b32 s36, s36, 16384
    s_add_u32 s43, s43, 262144
    s_add_u32 s44, s44, 262144
    v_smfmac_f32_16x16x64_bf16 v[40:43], v[68:71], v[160:167], v2
    v_add_f32 v33, v33, v35
    v_smfmac_f32_16x16x64_bf16 v[40:43], v[72:75], v[168:175], v2
    v_cvt_pk_bf16_f32 v32, v32, v33
    v_smfmac_f32_16x16x64_bf16 v[44:47], v[68:71], v[176:183], v2
    v_and_or_b32 v32, v32, -2, s42
    v_smfmac_f32_16x16x64_bf16 v[44:47], v[72:75], v[184:191], v2
    v_add_f32 v36, v36, v38
    v_smfmac_f32_16x16x64_bf16 v[48:51], v[68:71], v[192:199], v2
    v_add_f32 v37, v37, v39
    v_smfmac_f32_16x16x64_bf16 v[48:51], v[72:75], v[200:207], v2
    v_cvt_pk_bf16_f32 v33, v36, v37
    v_smfmac_f32_16x16x64_bf16 v[52:55], v[68:71], v[208:215], v2
    v_add_f32 v40, v40, v42
    v_smfmac_f32_16x16x64_bf16 v[52:55], v[72:75], v[216:223], v2
    v_add_f32 v41, v41, v43
    v_smfmac_f32_16x16x64_bf16 v[56:59], v[68:71], v[224:231], v2
    v_cvt_pk_bf16_f32 v34, v40, v41
    v_smfmac_f32_16x16x64_bf16 v[56:59], v[72:75], v[232:239], v2
    v_add_f32 v44, v44, v46
    v_smfmac_f32_16x16x64_bf16 v[60:63], v[68:71], v[240:247], v2
    v_add_f32 v45, v45, v47
    v_smfmac_f32_16x16x64_bf16 v[60:63], v[72:75], v[248:255], v2
    v_cvt_pk_bf16_f32 v35, v44, v45
    buffer_store_dwordx4 v[32:35], v8, s[4:7], s46 offen
    v_pk_add_f32 v[48:49], v[48:49], v[50:51]
    v_cvt_pk_bf16_f32 v48, v48, v49
    v_and_or_b32 v48, v48, -2, s42
    v_pk_add_f32 v[52:53], v[52:53], v[54:55]
    v_cvt_pk_bf16_f32 v49, v52, v53
    v_pk_add_f32 v[56:57], v[56:57], v[58:59]
    v_cvt_pk_bf16_f32 v50, v56, v57
    v_pk_add_f32 v[60:61], v[60:61], v[62:63]
    v_cvt_pk_bf16_f32 v51, v60, v61
    buffer_store_dwordx4 v[48:51], v8, s[4:7], s61 offen
    s_add_u32 s45, s45, 262144
    s_add_u32 s51, s51, 262144
    v_mfma_f32_32x32x8_bf16 v[96:111], v[14:15], v[14:15], 0
    v_mfma_f32_16x16x16_bf16 v[112:115], v[14:15], v[14:15], 0
    v_mfma_f32_16x16x16_bf16 v[116:119], v[14:15], v[14:15], 0
    ds_read_b128 v[64:67], v1 offset:0
    ds_read_b128 v[68:71], v1 offset:1024
    ds_read_b128 v[72:75], v1 offset:2048
    ds_read_b128 v[76:79], v1 offset:3072
    ds_read_b128 v[80:83], v1 offset:16384
    ds_read_b128 v[84:87], v1 offset:17408
    ds_read_b128 v[88:91], v1 offset:18432
    ds_read_b128 v[92:95], v1 offset:19456
    v_mov_b32 v58, -1
    v_mov_b32 v59, -1
    s_waitcnt vmcnt(0)
mega_kernel_rf_w0_cgo:
mega_kernel_rf_w0_pc:
    buffer_load_dword v36, v13, s[4:7], s25 offen offset:0 sc1
    buffer_load_dword v37, v13, s[4:7], s25 offen offset:256 sc1
    buffer_load_dword v38, v13, s[4:7], s25 offen offset:512 sc1
    buffer_load_dword v39, v13, s[4:7], s25 offen offset:768 sc1
    buffer_load_dword v40, v13, s[4:7], s25 offen offset:1024 sc1
    buffer_load_dword v41, v13, s[4:7], s25 offen offset:1280 sc1
    buffer_load_dword v42, v13, s[4:7], s25 offen offset:1536 sc1
    buffer_load_dword v43, v13, s[4:7], s25 offen offset:1792 sc1
    s_waitcnt vmcnt(4)
    v_mfma_f32_16x16x32_bf16 v[52:55], v[36:39], v[24:27], 0
    v_bitop3_b32 v3, s42, v36, v37 bitop3:0x7e
    v_bitop3_b32 v4, s42, v38, v39 bitop3:0x7e
    s_waitcnt vmcnt(2)
    v_or_b32 v3, v3, v4
    v_bitop3_b32 v4, s42, v40, v41 bitop3:0x7e
    s_waitcnt vmcnt(0)
    v_mfma_f32_16x16x32_bf16 v[52:55], v[40:43], v[24:27], v[52:55]
    v_bitop3_b32 v56, s42, v42, v43 bitop3:0x7e
    v_or3_b32 v3, v3, v4, v56
    v_and_b32 v3, v0, v3
    v_cmp_ne_u32 vcc, 0, v3
    s_nop 3
    v_cvt_pk_bf16_f32 v56, v52, v53
    v_cvt_pk_bf16_f32 v57, v54, v55
    v_min_u32 v56, -2, v56
    s_cbranch_vccnz mega_kernel_rf_w0_pc
    s_mov_b64 exec, s[26:27]
    buffer_store_dwordx2 v[56:57], v9, s[4:7], s35 offen offset:0
    buffer_store_dwordx2 v[58:59], v9, s[4:7], s36 offen offset:0
    s_mov_b64 exec, -1
    s_xor_b32 s42, s42, 1
    s_branch mega_kernel_rf_w0_loop
mega_kernel_rf_w0_last:
    buffer_store_dwordx4 v[64:67], v10, s[4:7], s45 offen offset:0 sc1
    buffer_store_dwordx2 v[18:19], v11, s[4:7], s51 offen offset:2048 sc1
    s_branch mega_kernel_rf_end
mega_kernel_rf_w0_pafail:
    s_nop 7
    v_mov_b32 v96, 0
    v_mov_b32 v97, 0
    v_mov_b32 v98, 0
    v_mov_b32 v99, 0
    v_mov_b32 v100, 0
    v_mov_b32 v101, 0
    v_mov_b32 v102, 0
    v_mov_b32 v103, 0
    v_mov_b32 v104, 0
    v_mov_b32 v105, 0
    v_mov_b32 v106, 0
    v_mov_b32 v107, 0
    s_branch mega_kernel_rf_w0_pa
mega_kernel_rf_w0_xslow:
    buffer_load_dwordx2 v[108:109], v11, s[4:7], s38 offen sc1
    buffer_load_dwordx2 v[110:111], v11, s[4:7], s38 offen offset:512 sc1
    s_waitcnt vmcnt(2)
    v_bitop3_b32 v3, s41, v20, v22 bitop3:0x7e
    v_mfma_f32_16x16x16_bf16 v[80:83], v[20:21], v[16:17], v[100:103]
    v_and_b32 v3, 1, v3
    v_mfma_f32_16x16x16_bf16 v[84:87], v[22:23], v[16:17], v[104:107]
    v_cmp_ne_u32 vcc, 0, v3
    s_cbranch_vccz mega_kernel_rf_w0_xgot
    buffer_load_dwordx2 v[20:21], v11, s[4:7], s38 offen sc1
    buffer_load_dwordx2 v[22:23], v11, s[4:7], s38 offen offset:512 sc1
    s_waitcnt vmcnt(2)
    v_bitop3_b32 v3, s41, v108, v110 bitop3:0x7e
    v_mfma_f32_16x16x16_bf16 v[80:83], v[108:109], v[16:17], v[100:103]
    v_and_b32 v3, 1, v3
    v_mfma_f32_16x16x16_bf16 v[84:87], v[110:111], v[16:17], v[104:107]
    v_cmp_ne_u32 vcc, 0, v3
    s_cbranch_vccz mega_kernel_rf_w0_xgot
    s_branch mega_kernel_rf_w0_xslow
mega_kernel_rf_w0_xgot:
    s_nop 3
    v_cvt_pk_bf16_f32 v64, v80, v81
    v_cvt_pk_bf16_f32 v65, v82, v83
    v_cvt_pk_bf16_f32 v66, v84, v85
    v_cvt_pk_bf16_f32 v67, v86, v87
    ds_write_b128 v6, v[64:67] offset:8192
    s_branch mega_kernel_rf_w0_xok
mega_kernel_rf_w0_pv0:
    s_waitcnt vmcnt(2)
    s_branch mega_kernel_rf_w0_pv1
mega_kernel_rf_w0_pv:
    buffer_load_dwordx2 v[20:21], v11, s[4:7], s40 offen sc1
    s_waitcnt vmcnt(0)
mega_kernel_rf_w0_pv1:
    v_and_b32 v3, 1, v20
    v_cmp_ne_u32 vcc, s41, v3
    v_mov_b32 v113, v20
    v_mov_b32 v115, v21
    s_cbranch_vccnz mega_kernel_rf_w0_pv
    s_branch mega_kernel_rf_w0_pv2
mega_kernel_rf_w1_entry:
    v_mfma_f32_32x32x8_bf16 v[96:111], v[14:15], v[14:15], 0
    v_mfma_f32_16x16x16_bf16 v[112:115], v[14:15], v[14:15], 0
    v_mfma_f32_16x16x16_bf16 v[116:119], v[14:15], v[14:15], 0
    ds_read_b128 v[64:67], v1 offset:4096
    ds_read_b128 v[68:71], v1 offset:5120
    ds_read_b128 v[72:75], v1 offset:6144
    ds_read_b128 v[76:79], v1 offset:7168
    ds_read_b128 v[80:83], v1 offset:20480
    ds_read_b128 v[84:87], v1 offset:21504
    ds_read_b128 v[88:91], v1 offset:22528
    ds_read_b128 v[92:95], v1 offset:23552
    buffer_load_dwordx4 v[120:123], v1, s[4:7], s44 offen
    buffer_load_dwordx4 v[124:127], v1, s[4:7], s44 offen offset:1024
    s_add_u32 s44, s44, 262144
mega_kernel_rf_w1_loop:
    s_add_u32 s22, s35, 2048
    s_waitcnt vmcnt(0)
    buffer_load_dwordx4 v[40:43], v1, s[4:7], s22 offen sc1
    buffer_load_dwordx4 v[44:47], v1, s[4:7], s22 offen offset:1024 sc1
mega_kernel_rf_w1_pa:
    s_waitcnt vmcnt(1)
    ds_write_b128 v6, v[40:43] offset:2048
    s_waitcnt vmcnt(0)
    ds_write_b128 v6, v[44:47] offset:3072
    v_max3_u32 v3, v40, v42, v44
    v_max_u32 v3, v3, v46
    v_cmp_eq_u32 vcc, -1, v3
    v_smfmac_f32_16x16x64_bf16 v[96:99], v[40:43], a[32:39], v2
    buffer_load_dwordx4 v[40:43], v1, s[4:7], s22 offen sc1
    v_smfmac_f32_16x16x64_bf16 v[100:103], v[40:43], a[40:47], v2
    buffer_load_dwordx4 v[44:47], v1, s[4:7], s22 offen offset:1024 sc1
    v_smfmac_f32_16x16x64_bf16 v[104:107], v[40:43], a[160:167], v2
    s_cbranch_vccnz mega_kernel_rf_w1_pafail
    s_waitcnt lgkmcnt(0)
    s_barrier
    ds_read_b128 v[48:51], v6 offset:4096
    ds_read_b128 v[52:55], v6 offset:5120
    v_smfmac_f32_16x16x64_bf16 v[108:111], v[40:43], a[168:175], v2
    ds_read_b128 v[56:59], v6 offset:6144
    v_smfmac_f32_16x16x64_bf16 v[96:99], v[44:47], a[48:55], v2
    ds_read_b128 v[60:63], v6 offset:7168
    v_smfmac_f32_16x16x64_bf16 v[100:103], v[44:47], a[56:63], v2
    ds_read_b128 v[32:35], v6 offset:0
    v_smfmac_f32_16x16x64_bf16 v[104:107], v[44:47], a[176:183], v2
    ds_read_b128 v[36:39], v6 offset:1024
    v_smfmac_f32_16x16x64_bf16 v[108:111], v[44:47], a[184:191], v2
    s_waitcnt lgkmcnt(5)
    v_smfmac_f32_16x16x64_bf16 v[96:99], v[48:51], a[64:71], v2
    buffer_load_dwordx4 v1, s[4:7], s43 offen lds
    v_smfmac_f32_16x16x64_bf16 v[104:107], v[48:51], a[192:199], v2
    s_waitcnt lgkmcnt(4)
    v_smfmac_f32_16x16x64_bf16 v[96:99], v[52:55], a[80:87], v2
    v_smfmac_f32_16x16x64_bf16 v[104:107], v[52:55], a[208:215], v2
    s_waitcnt lgkmcnt(3)
    v_smfmac_f32_16x16x64_bf16 v[96:99], v[56:59], a[96:103], v2
    buffer_load_dwordx4 v1, s[4:7], s43 offen offset:1024 lds
    v_smfmac_f32_16x16x64_bf16 v[104:107], v[56:59], a[224:231], v2
    s_waitcnt lgkmcnt(2)
    v_smfmac_f32_16x16x64_bf16 v[96:99], v[60:63], a[112:119], v2
    v_smfmac_f32_16x16x64_bf16 v[104:107], v[60:63], a[240:247], v2
    s_waitcnt lgkmcnt(1)
    v_smfmac_f32_16x16x64_bf16 v[96:99], v[32:35], a[0:7], v2
    v_smfmac_f32_16x16x64_bf16 v[104:107], v[32:35], a[128:135], v2
    s_waitcnt lgkmcnt(0)
    v_smfmac_f32_16x16x64_bf16 v[96:99], v[36:39], a[16:23], v2
    v_smfmac_f32_16x16x64_bf16 v[104:107], v[36:39], a[144:151], v2
    v_smfmac_f32_16x16x64_bf16 v[100:103], v[48:51], a[72:79], v2
    s_nop 2
    v_smfmac_f32_16x16x64_bf16 v[100:103], v[52:55], a[88:95], v2
    s_nop 1
    v_add_f32 v96, v96, v98
    v_smfmac_f32_16x16x64_bf16 v[100:103], v[56:59], a[104:111], v2
    v_add_f32 v97, v97, v99
    v_add_f32 v104, v104, v106
    v_smfmac_f32_16x16x64_bf16 v[100:103], v[60:63], a[120:127], v2
    v_add_f32 v105, v105, v107
    v_cvt_pk_bf16_f32 v96, v96, v97
    v_smfmac_f32_16x16x64_bf16 v[100:103], v[32:35], a[8:15], v2
    v_cvt_pk_bf16_f32 v97, v104, v105
    v_and_or_b32 v96, v96, -2, s41
    v_smfmac_f32_16x16x64_bf16 v[100:103], v[36:39], a[24:31], v2
    buffer_store_dwordx2 v[96:97], v11, s[4:7], s37 offen sc1
    v_smfmac_f32_16x16x64_bf16 v[108:111], v[48:51], a[200:207], v2
    v_smfmac_f32_16x16x64_bf16 v[108:111], v[52:55], a[216:223], v2
    v_smfmac_f32_16x16x64_bf16 v[108:111], v[56:59], a[232:239], v2
    v_smfmac_f32_16x16x64_bf16 v[108:111], v[60:63], a[248:255], v2
    v_smfmac_f32_16x16x64_bf16 v[108:111], v[32:35], a[136:143], v2
    s_nop 2
    v_add_f32 v100, v100, v102
    v_smfmac_f32_16x16x64_bf16 v[108:111], v[36:39], a[152:159], v2
    v_add_f32 v101, v101, v103
    v_cvt_pk_bf16_f32 v98, v100, v101
    v_and_or_b32 v98, v98, -2, s41
    s_nop 4
    v_pk_add_f32 v[108:109], v[108:109], v[110:111]
    v_cvt_pk_bf16_f32 v99, v108, v109
    buffer_store_dwordx2 v[98:99], v11, s[4:7], s37 offen offset:512 sc1
    v_smfmac_f32_16x16x64_bf16 v[112:115], v[32:35], v[64:71], v2
    ds_read_b128 v[64:67], v1 offset:36864
    ds_read_b128 v[68:71], v1 offset:37888
    v_smfmac_f32_16x16x64_bf16 v[116:119], v[32:35], v[72:79], v2
    ds_read_b128 v[72:75], v1 offset:38912
    ds_read_b128 v[76:79], v1 offset:39936
    v_smfmac_f32_16x16x64_bf16 v[112:115], v[36:39], v[80:87], v2
    ds_read_b128 v[80:83], v1 offset:53248
    ds_read_b128 v[84:87], v1 offset:54272
    v_smfmac_f32_16x16x64_bf16 v[116:119], v[36:39], v[88:95], v2
    ds_read_b128 v[88:91], v1 offset:55296
    ds_read_b128 v[92:95], v1 offset:56320
    s_waitcnt lgkmcnt(6)
    v_smfmac_f32_16x16x64_bf16 v[112:115], v[40:43], v[64:71], v2
    ds_read_b128 v[64:67], v5 offset:4096
    ds_read_b128 v[68:71], v5 offset:5120
    s_waitcnt lgkmcnt(6)
    v_smfmac_f32_16x16x64_bf16 v[116:119], v[40:43], v[72:79], v2
    ds_read_b128 v[72:75], v5 offset:6144
    ds_read_b128 v[76:79], v5 offset:7168
    s_waitcnt lgkmcnt(6)
    v_smfmac_f32_16x16x64_bf16 v[112:115], v[44:47], v[80:87], v2
    ds_read_b128 v[80:83], v5 offset:20480
    ds_read_b128 v[84:87], v5 offset:21504
    s_waitcnt lgkmcnt(6)
    v_smfmac_f32_16x16x64_bf16 v[116:119], v[44:47], v[88:95], v2
    ds_read_b128 v[88:91], v5 offset:22528
    ds_read_b128 v[92:95], v5 offset:23552
    s_waitcnt lgkmcnt(6)
    v_smfmac_f32_16x16x64_bf16 v[112:115], v[48:51], v[64:71], v2
    ds_read_b128 v[64:67], v5 offset:36864
    ds_read_b128 v[68:71], v5 offset:37888
    s_waitcnt lgkmcnt(6)
    v_smfmac_f32_16x16x64_bf16 v[116:119], v[48:51], v[72:79], v2
    ds_read_b128 v[72:75], v5 offset:38912
    ds_read_b128 v[76:79], v5 offset:39936
    s_waitcnt lgkmcnt(6)
    v_smfmac_f32_16x16x64_bf16 v[112:115], v[52:55], v[80:87], v2
    ds_read_b128 v[80:83], v5 offset:53248
    ds_read_b128 v[84:87], v5 offset:54272
    s_waitcnt lgkmcnt(6)
    v_smfmac_f32_16x16x64_bf16 v[116:119], v[52:55], v[88:95], v2
    ds_read_b128 v[88:91], v5 offset:55296
    ds_read_b128 v[92:95], v5 offset:56320
    s_waitcnt lgkmcnt(6)
    v_smfmac_f32_16x16x64_bf16 v[112:115], v[56:59], v[64:71], v2
    s_waitcnt lgkmcnt(4)
    v_smfmac_f32_16x16x64_bf16 v[116:119], v[56:59], v[72:79], v2
    s_waitcnt lgkmcnt(2)
    v_smfmac_f32_16x16x64_bf16 v[112:115], v[60:63], v[80:87], v2
    s_waitcnt lgkmcnt(0)
    v_smfmac_f32_16x16x64_bf16 v[116:119], v[60:63], v[88:95], v2
    buffer_load_dwordx2 v[108:109], v11, s[4:7], s38 offen sc1
    v_mfma_f32_16x16x16_bf16 v[100:103], v[96:97], v[16:17], 0
    v_mfma_f32_16x16x16_bf16 v[104:107], v[98:99], v[16:17], 0
    s_nop 4
    v_add_f32 v112, v112, v114
    v_add_f32 v113, v113, v115
    v_add_f32 v114, v116, v118
    v_add_f32 v115, v117, v119
    v_cvt_pk_bf16_f32 v18, v112, v113
    v_cvt_pk_bf16_f32 v19, v114, v115
    v_and_or_b32 v18, v18, -2, s41
    buffer_load_dwordx2 v[110:111], v11, s[4:7], s38 offen offset:512 sc1
    s_barrier
    buffer_store_dwordx2 v[18:19], v11, s[4:7], s39 offen sc1
    v_mov_b32 v112, v18
    v_mov_b32 v114, v19
    v_mov_b32 v92, v28
    v_mov_b32 v93, 0
    s_waitcnt vmcnt(5)
    s_barrier
    ds_read_b128 v[32:35], v6 offset:14336
    ds_read_b128 v[36:39], v6 offset:15360
    ds_read_b128 v[40:43], v6 offset:9216
    ds_read_b128 v[44:47], v6 offset:10240
    ds_read_b128 v[48:51], v6 offset:24576
    ds_read_b128 v[52:55], v6 offset:25600
    ds_read_b128 v[56:59], v6 offset:19456
    ds_read_b128 v[60:63], v6 offset:20480
    buffer_load_dwordx2 v[20:21], v11, s[4:7], s38 offen sc1
    buffer_load_dwordx2 v[22:23], v11, s[4:7], s38 offen offset:512 sc1
    s_waitcnt vmcnt(4)
    v_mfma_f32_16x16x16_bf16 v[80:83], v[108:109], v[16:17], v[100:103]
    v_and_b32 v3, 1, v108
    v_cmp_ne_u32 vcc, s41, v3
    s_nop 5
    v_cvt_pk_bf16_f32 v64, v80, v81
    v_cvt_pk_bf16_f32 v65, v82, v83
    s_cbranch_vccnz mega_kernel_rf_w1_xslow
    s_waitcnt vmcnt(3)
    v_mfma_f32_16x16x16_bf16 v[84:87], v[110:111], v[16:17], v[104:107]
    v_and_b32 v3, 1, v110
    v_cmp_ne_u32 vcc, s41, v3
    s_nop 5
    v_cvt_pk_bf16_f32 v66, v84, v85
    v_cvt_pk_bf16_f32 v67, v86, v87
    ds_write_b128 v6, v[64:67] offset:13312
    s_cbranch_vccnz mega_kernel_rf_w1_xslow
mega_kernel_rf_w1_xok:
    s_cmp_eq_u32 s21, 63
    s_cbranch_scc1 mega_kernel_rf_w1_last
    buffer_load_dwordx2 v[116:117], v11, s[4:7], s40 offen sc1
    s_waitcnt lgkmcnt(1)
    v_mfma_f32_16x16x32_bf16 v[80:83], v[32:35], v[64:67], 0
    s_waitcnt lgkmcnt(0)
    s_barrier
    ds_read_b128 v[68:71], v6 offset:8192
    ds_read_b128 v[72:75], v6 offset:23552
    ds_read_b128 v[76:79], v6 offset:18432
    v_mfma_f32_16x16x32_bf16 v[84:87], v[36:39], v[64:67], 0
    v_mfma_f32_16x16x32_bf16 v[88:91], v[64:67], v[64:67], 0
    buffer_load_dwordx2 v[20:21], v11, s[4:7], s40 offen sc1
    s_waitcnt lgkmcnt(2)
    v_mfma_f32_16x16x32_bf16 v[80:83], v[40:43], v[68:71], v[80:83]
    s_waitcnt lgkmcnt(1)
    v_mfma_f32_16x16x32_bf16 v[80:83], v[48:51], v[72:75], v[80:83]
    buffer_store_dwordx4 v[64:67], v10, s[4:7], s45 offen offset:64 sc1
    s_waitcnt lgkmcnt(0)
    v_mfma_f32_16x16x32_bf16 v[80:83], v[56:59], v[76:79], v[80:83]
    v_mfma_f32_16x16x32_bf16 v[84:87], v[44:47], v[68:71], v[84:87]
    v_mfma_f32_16x16x32_bf16 v[84:87], v[52:55], v[72:75], v[84:87]
    v_mfma_f32_16x16x32_bf16 v[84:87], v[60:63], v[76:79], v[84:87]
    buffer_store_dwordx2 v[18:19], v11, s[4:7], s51 offen offset:2560 sc1
    v_mfma_f32_16x16x32_bf16 v[88:91], v[68:71], v[68:71], v[88:91]
    v_mfma_f32_16x16x32_bf16 v[88:91], v[72:75], v[72:75], v[88:91]
    v_mfma_f32_16x16x32_bf16 v[88:91], v[76:79], v[76:79], v[88:91]
    v_mfma_f32_32x32x4_2b_bf16 v[32:63], v[14:15], v[14:15], 0
    s_nop 0
    v_max3_f32 v4, v80, v81, v82
    s_nop 1
    v_max3_f32 v4, v4, v83, v84
    v_max3_f32 v4, v4, v85, v86
    v_max_f32 v4, v4, v87
    v_max3_f32 v90, v4, v88, v89
    v_max3_f32 v4, v4, v88, v89
    s_nop 1
    v_permlane16_swap_b32 v4, v90
    v_max_f32 v4, v4, v90
    v_max_f32 v90, v4, v90
    s_nop 1
    v_permlane32_swap_b32 v4, v90
    v_max_f32 v4, v4, v90
    v_mul_f32 v4, s34, v4
    v_pk_fma_f32 v[80:81], v[80:81], s[34:35], v[4:5] op_sel_hi:[1,0,0] neg_lo:[0,0,1] neg_hi:[0,0,1]
    v_pk_fma_f32 v[82:83], v[82:83], s[34:35], v[4:5] op_sel_hi:[1,0,0] neg_lo:[0,0,1] neg_hi:[0,0,1]
    v_pk_fma_f32 v[84:85], v[84:85], s[34:35], v[4:5] op_sel_hi:[1,0,0] neg_lo:[0,0,1] neg_hi:[0,0,1]
    v_pk_fma_f32 v[86:87], v[86:87], s[34:35], v[4:5] op_sel_hi:[1,0,0] neg_lo:[0,0,1] neg_hi:[0,0,1]
    v_pk_fma_f32 v[88:89], v[88:89], s[34:35], v[4:5] op_sel_hi:[1,0,0] neg_lo:[0,0,1] neg_hi:[0,0,1]
    v_exp_f32 v80, v80
    v_exp_f32 v81, v81
    v_exp_f32 v82, v82
    v_cvt_pk_bf16_f32 v68, v80, v81
    v_exp_f32 v83, v83
    v_exp_f32 v84, v84
    v_cvt_pk_bf16_f32 v69, v82, v83
    v_exp_f32 v85, v85
    v_exp_f32 v86, v86
    v_cvt_pk_bf16_f32 v70, v84, v85
    v_exp_f32 v87, v87
    v_exp_f32 v88, v88
    v_cvt_pk_bf16_f32 v71, v86, v87
    v_exp_f32 v89, v89
    s_waitcnt vmcnt(3)
    v_mfma_f32_16x16x32_bf16 v[76:79], v[28:31], v[68:71], 0
    v_and_b32 v3, 1, v116
    v_cvt_pk_bf16_f32 v72, v88, v89
    v_mfma_f32_16x16x32_bf16 v[100:103], v[120:123], v[68:71], 0
    v_cmp_ne_u32 vcc, s41, v3
    v_cvt_pk_bf16_f32 v73, v88, v89
    v_mfma_f32_16x16x32_bf16 v[104:107], v[124:127], v[68:71], 0
    v_mov_b32 v113, v116
    v_mov_b32 v115, v117
    v_mfma_f32_16x16x16_bf16 v[76:79], v[92:93], v[72:73], v[76:79]
    s_cbranch_vccnz mega_kernel_rf_w1_pv0
mega_kernel_rf_w1_pv2:
    v_mfma_f32_16x16x16_bf16 v[100:103], v[112:113], v[72:73], v[100:103]
    v_mfma_f32_16x16x16_bf16 v[104:107], v[114:115], v[72:73], v[104:107]
    buffer_load_dwordx4 v[120:123], v1, s[4:7], s44 offen
    buffer_load_dwordx4 v[124:127], v1, s[4:7], s44 offen offset:1024
    s_nop 2
    v_rcp_f32 v76, v76
    s_mov_b64 exec, s[28:29]
    v_pk_mul_f32 v[100:101], v[100:101], v[76:77] op_sel_hi:[1,0]
    v_pk_mul_f32 v[102:103], v[102:103], v[76:77] op_sel_hi:[1,0]
    v_pk_mul_f32 v[104:105], v[104:105], v[76:77] op_sel_hi:[1,0]
    v_pk_mul_f32 v[106:107], v[106:107], v[76:77] op_sel_hi:[1,0]
    v_cvt_pk_bf16_f32 v84, v100, v101
    v_cvt_pk_bf16_f32 v85, v102, v103
    v_cvt_pk_bf16_f32 v86, v104, v105
    v_cvt_pk_bf16_f32 v87, v106, v107
    ds_write_b128 v6, v[84:87] offset:28672
    s_mov_b64 exec, -1
    s_waitcnt lgkmcnt(0)
    s_barrier
    ds_read_b128 v[68:71], v6 offset:28672
    ds_read_b128 v[72:75], v6 offset:29696
    s_waitcnt lgkmcnt(1)
    v_smfmac_f32_16x16x64_bf16 v[32:35], v[68:71], v[128:135], v2
    s_add_u32 s21, s21, 1
    s_xor_b32 s38, s38, 1048576
    s_xor_b32 s37, s37, 1048576
    s_waitcnt lgkmcnt(0)
    v_smfmac_f32_16x16x64_bf16 v[32:35], v[72:75], v[136:143], v2
    s_xor_b32 s40, s40, 1048576
    s_xor_b32 s39, s39, 1048576
    s_lshr_b32 s41, s21, 1
    v_smfmac_f32_16x16x64_bf16 v[36:39], v[68:71], v[144:151], v2
    s_and_b32 s41, s41, 1
    s_xor_b32 s41, s41, 1
    s_xor_b32 s35, s35, 16384
    v_smfmac_f32_16x16x64_bf16 v[36:39], v[72:75], v[152:159], v2
    v_add_f32 v32, v32, v34
    s_xor_b32 s36, s36, 16384
    s_add_u32 s43, s43, 262144
    s_add_u32 s44, s44, 262144
    v_smfmac_f32_16x16x64_bf16 v[40:43], v[68:71], v[160:167], v2
    v_add_f32 v33, v33, v35
    v_smfmac_f32_16x16x64_bf16 v[40:43], v[72:75], v[168:175], v2
    v_cvt_pk_bf16_f32 v32, v32, v33
    v_smfmac_f32_16x16x64_bf16 v[44:47], v[68:71], v[176:183], v2
    v_and_or_b32 v32, v32, -2, s42
    v_smfmac_f32_16x16x64_bf16 v[44:47], v[72:75], v[184:191], v2
    v_add_f32 v36, v36, v38
    v_smfmac_f32_16x16x64_bf16 v[48:51], v[68:71], v[192:199], v2
    v_add_f32 v37, v37, v39
    v_smfmac_f32_16x16x64_bf16 v[48:51], v[72:75], v[200:207], v2
    v_cvt_pk_bf16_f32 v33, v36, v37
    v_smfmac_f32_16x16x64_bf16 v[52:55], v[68:71], v[208:215], v2
    v_add_f32 v40, v40, v42
    v_smfmac_f32_16x16x64_bf16 v[52:55], v[72:75], v[216:223], v2
    v_add_f32 v41, v41, v43
    v_smfmac_f32_16x16x64_bf16 v[56:59], v[68:71], v[224:231], v2
    v_cvt_pk_bf16_f32 v34, v40, v41
    v_smfmac_f32_16x16x64_bf16 v[56:59], v[72:75], v[232:239], v2
    v_add_f32 v44, v44, v46
    v_smfmac_f32_16x16x64_bf16 v[60:63], v[68:71], v[240:247], v2
    v_add_f32 v45, v45, v47
    v_smfmac_f32_16x16x64_bf16 v[60:63], v[72:75], v[248:255], v2
    v_cvt_pk_bf16_f32 v35, v44, v45
    buffer_store_dwordx4 v[32:35], v8, s[4:7], s46 offen
    v_pk_add_f32 v[48:49], v[48:49], v[50:51]
    v_cvt_pk_bf16_f32 v48, v48, v49
    v_and_or_b32 v48, v48, -2, s42
    v_pk_add_f32 v[52:53], v[52:53], v[54:55]
    v_cvt_pk_bf16_f32 v49, v52, v53
    v_pk_add_f32 v[56:57], v[56:57], v[58:59]
    v_cvt_pk_bf16_f32 v50, v56, v57
    v_pk_add_f32 v[60:61], v[60:61], v[62:63]
    v_cvt_pk_bf16_f32 v51, v60, v61
    buffer_store_dwordx4 v[48:51], v8, s[4:7], s61 offen
    s_add_u32 s45, s45, 262144
    s_add_u32 s51, s51, 262144
    v_mfma_f32_32x32x8_bf16 v[96:111], v[14:15], v[14:15], 0
    v_mfma_f32_16x16x16_bf16 v[112:115], v[14:15], v[14:15], 0
    v_mfma_f32_16x16x16_bf16 v[116:119], v[14:15], v[14:15], 0
    ds_read_b128 v[64:67], v1 offset:4096
    ds_read_b128 v[68:71], v1 offset:5120
    ds_read_b128 v[72:75], v1 offset:6144
    ds_read_b128 v[76:79], v1 offset:7168
    ds_read_b128 v[80:83], v1 offset:20480
    ds_read_b128 v[84:87], v1 offset:21504
    ds_read_b128 v[88:91], v1 offset:22528
    ds_read_b128 v[92:95], v1 offset:23552
    v_mov_b32 v58, -1
    v_mov_b32 v59, -1
    s_waitcnt vmcnt(0)
mega_kernel_rf_w1_cgo:
mega_kernel_rf_w1_pc:
    buffer_load_dword v36, v13, s[4:7], s25 offen offset:0 sc1
    buffer_load_dword v37, v13, s[4:7], s25 offen offset:256 sc1
    buffer_load_dword v38, v13, s[4:7], s25 offen offset:512 sc1
    buffer_load_dword v39, v13, s[4:7], s25 offen offset:768 sc1
    buffer_load_dword v40, v13, s[4:7], s25 offen offset:1024 sc1
    buffer_load_dword v41, v13, s[4:7], s25 offen offset:1280 sc1
    buffer_load_dword v42, v13, s[4:7], s25 offen offset:1536 sc1
    buffer_load_dword v43, v13, s[4:7], s25 offen offset:1792 sc1
    s_waitcnt vmcnt(4)
    v_mfma_f32_16x16x32_bf16 v[52:55], v[36:39], v[24:27], 0
    v_bitop3_b32 v3, s42, v36, v37 bitop3:0x7e
    v_bitop3_b32 v4, s42, v38, v39 bitop3:0x7e
    s_waitcnt vmcnt(2)
    v_or_b32 v3, v3, v4
    v_bitop3_b32 v4, s42, v40, v41 bitop3:0x7e
    s_waitcnt vmcnt(0)
    v_mfma_f32_16x16x32_bf16 v[52:55], v[40:43], v[24:27], v[52:55]
    v_bitop3_b32 v56, s42, v42, v43 bitop3:0x7e
    v_or3_b32 v3, v3, v4, v56
    v_and_b32 v3, v0, v3
    v_cmp_ne_u32 vcc, 0, v3
    s_nop 3
    v_cvt_pk_bf16_f32 v56, v52, v53
    v_cvt_pk_bf16_f32 v57, v54, v55
    v_min_u32 v56, -2, v56
    s_cbranch_vccnz mega_kernel_rf_w1_pc
    s_mov_b64 exec, s[26:27]
    buffer_store_dwordx2 v[56:57], v9, s[4:7], s35 offen offset:256
    buffer_store_dwordx2 v[58:59], v9, s[4:7], s36 offen offset:256
    s_mov_b64 exec, -1
    s_xor_b32 s42, s42, 1
    s_branch mega_kernel_rf_w1_loop
mega_kernel_rf_w1_last:
    buffer_store_dwordx4 v[64:67], v10, s[4:7], s45 offen offset:64 sc1
    buffer_store_dwordx2 v[18:19], v11, s[4:7], s51 offen offset:2560 sc1
    s_branch mega_kernel_rf_end
mega_kernel_rf_w1_pafail:
    s_nop 7
    v_mov_b32 v96, 0
    v_mov_b32 v97, 0
    v_mov_b32 v98, 0
    v_mov_b32 v99, 0
    v_mov_b32 v100, 0
    v_mov_b32 v101, 0
    v_mov_b32 v102, 0
    v_mov_b32 v103, 0
    v_mov_b32 v104, 0
    v_mov_b32 v105, 0
    v_mov_b32 v106, 0
    v_mov_b32 v107, 0
    s_branch mega_kernel_rf_w1_pa
mega_kernel_rf_w1_xslow:
    buffer_load_dwordx2 v[108:109], v11, s[4:7], s38 offen sc1
    buffer_load_dwordx2 v[110:111], v11, s[4:7], s38 offen offset:512 sc1
    s_waitcnt vmcnt(2)
    v_bitop3_b32 v3, s41, v20, v22 bitop3:0x7e
    v_mfma_f32_16x16x16_bf16 v[80:83], v[20:21], v[16:17], v[100:103]
    v_and_b32 v3, 1, v3
    v_mfma_f32_16x16x16_bf16 v[84:87], v[22:23], v[16:17], v[104:107]
    v_cmp_ne_u32 vcc, 0, v3
    s_cbranch_vccz mega_kernel_rf_w1_xgot
    buffer_load_dwordx2 v[20:21], v11, s[4:7], s38 offen sc1
    buffer_load_dwordx2 v[22:23], v11, s[4:7], s38 offen offset:512 sc1
    s_waitcnt vmcnt(2)
    v_bitop3_b32 v3, s41, v108, v110 bitop3:0x7e
    v_mfma_f32_16x16x16_bf16 v[80:83], v[108:109], v[16:17], v[100:103]
    v_and_b32 v3, 1, v3
    v_mfma_f32_16x16x16_bf16 v[84:87], v[110:111], v[16:17], v[104:107]
    v_cmp_ne_u32 vcc, 0, v3
    s_cbranch_vccz mega_kernel_rf_w1_xgot
    s_branch mega_kernel_rf_w1_xslow
mega_kernel_rf_w1_xgot:
    s_nop 3
    v_cvt_pk_bf16_f32 v64, v80, v81
    v_cvt_pk_bf16_f32 v65, v82, v83
    v_cvt_pk_bf16_f32 v66, v84, v85
    v_cvt_pk_bf16_f32 v67, v86, v87
    ds_write_b128 v6, v[64:67] offset:13312
    s_branch mega_kernel_rf_w1_xok
mega_kernel_rf_w1_pv0:
    s_waitcnt vmcnt(2)
    s_branch mega_kernel_rf_w1_pv1
mega_kernel_rf_w1_pv:
    buffer_load_dwordx2 v[20:21], v11, s[4:7], s40 offen sc1
    s_waitcnt vmcnt(0)
mega_kernel_rf_w1_pv1:
    v_and_b32 v3, 1, v20
    v_cmp_ne_u32 vcc, s41, v3
    v_mov_b32 v113, v20
    v_mov_b32 v115, v21
    s_cbranch_vccnz mega_kernel_rf_w1_pv
    s_branch mega_kernel_rf_w1_pv2
mega_kernel_rf_w2_entry:
    v_mfma_f32_32x32x8_bf16 v[96:111], v[14:15], v[14:15], 0
    v_mfma_f32_16x16x16_bf16 v[112:115], v[14:15], v[14:15], 0
    v_mfma_f32_16x16x16_bf16 v[116:119], v[14:15], v[14:15], 0
    ds_read_b128 v[64:67], v1 offset:8192
    ds_read_b128 v[68:71], v1 offset:9216
    ds_read_b128 v[72:75], v1 offset:10240
    ds_read_b128 v[76:79], v1 offset:11264
    ds_read_b128 v[80:83], v1 offset:24576
    ds_read_b128 v[84:87], v1 offset:25600
    ds_read_b128 v[88:91], v1 offset:26624
    ds_read_b128 v[92:95], v1 offset:27648
    buffer_load_dwordx4 v[120:123], v1, s[4:7], s44 offen
    buffer_load_dwordx4 v[124:127], v1, s[4:7], s44 offen offset:1024
    s_add_u32 s44, s44, 262144
mega_kernel_rf_w2_loop:
    s_add_u32 s22, s35, 4096
    s_waitcnt vmcnt(0)
    buffer_load_dwordx4 v[48:51], v1, s[4:7], s22 offen sc1
    buffer_load_dwordx4 v[52:55], v1, s[4:7], s22 offen offset:1024 sc1
mega_kernel_rf_w2_pa:
    s_waitcnt vmcnt(1)
    ds_write_b128 v6, v[48:51] offset:4096
    s_waitcnt vmcnt(0)
    ds_write_b128 v6, v[52:55] offset:5120
    v_max3_u32 v3, v48, v50, v52
    v_max_u32 v3, v3, v54
    v_cmp_eq_u32 vcc, -1, v3
    v_smfmac_f32_16x16x64_bf16 v[96:99], v[48:51], a[64:71], v2
    buffer_load_dwordx4 v[48:51], v1, s[4:7], s22 offen sc1
    v_smfmac_f32_16x16x64_bf16 v[100:103], v[48:51], a[72:79], v2
    buffer_load_dwordx4 v[52:55], v1, s[4:7], s22 offen offset:1024 sc1
    v_smfmac_f32_16x16x64_bf16 v[104:107], v[48:51], a[192:199], v2
    s_cbranch_vccnz mega_kernel_rf_w2_pafail
    s_waitcnt lgkmcnt(0)
    s_barrier
    ds_read_b128 v[56:59], v6 offset:6144
    ds_read_b128 v[60:63], v6 offset:7168
    v_smfmac_f32_16x16x64_bf16 v[108:111], v[48:51], a[200:207], v2
    ds_read_b128 v[32:35], v6 offset:0
    v_smfmac_f32_16x16x64_bf16 v[96:99], v[52:55], a[80:87], v2
    ds_read_b128 v[36:39], v6 offset:1024
    v_smfmac_f32_16x16x64_bf16 v[100:103], v[52:55], a[88:95], v2
    ds_read_b128 v[40:43], v6 offset:2048
    v_smfmac_f32_16x16x64_bf16 v[104:107], v[52:55], a[208:215], v2
    ds_read_b128 v[44:47], v6 offset:3072
    v_smfmac_f32_16x16x64_bf16 v[108:111], v[52:55], a[216:223], v2
    s_waitcnt lgkmcnt(5)
    v_smfmac_f32_16x16x64_bf16 v[96:99], v[56:59], a[96:103], v2
    v_smfmac_f32_16x16x64_bf16 v[104:107], v[56:59], a[224:231], v2
    buffer_load_dwordx4 v1, s[4:7], s43 offen lds
    s_waitcnt lgkmcnt(4)
    v_smfmac_f32_16x16x64_bf16 v[96:99], v[60:63], a[112:119], v2
    v_smfmac_f32_16x16x64_bf16 v[104:107], v[60:63], a[240:247], v2
    s_waitcnt lgkmcnt(3)
    v_smfmac_f32_16x16x64_bf16 v[96:99], v[32:35], a[0:7], v2
    v_smfmac_f32_16x16x64_bf16 v[104:107], v[32:35], a[128:135], v2
    buffer_load_dwordx4 v1, s[4:7], s43 offen offset:1024 lds
    s_waitcnt lgkmcnt(2)
    v_smfmac_f32_16x16x64_bf16 v[96:99], v[36:39], a[16:23], v2
    v_smfmac_f32_16x16x64_bf16 v[104:107], v[36:39], a[144:151], v2
    s_waitcnt lgkmcnt(1)
    v_smfmac_f32_16x16x64_bf16 v[96:99], v[40:43], a[32:39], v2
    v_smfmac_f32_16x16x64_bf16 v[104:107], v[40:43], a[160:167], v2
    s_waitcnt lgkmcnt(0)
    v_smfmac_f32_16x16x64_bf16 v[96:99], v[44:47], a[48:55], v2
    v_smfmac_f32_16x16x64_bf16 v[104:107], v[44:47], a[176:183], v2
    v_smfmac_f32_16x16x64_bf16 v[100:103], v[56:59], a[104:111], v2
    s_nop 2
    v_smfmac_f32_16x16x64_bf16 v[100:103], v[60:63], a[120:127], v2
    s_nop 1
    v_add_f32 v96, v96, v98
    v_smfmac_f32_16x16x64_bf16 v[100:103], v[32:35], a[8:15], v2
    v_add_f32 v97, v97, v99
    v_add_f32 v104, v104, v106
    v_smfmac_f32_16x16x64_bf16 v[100:103], v[36:39], a[24:31], v2
    v_add_f32 v105, v105, v107
    v_cvt_pk_bf16_f32 v96, v96, v97
    v_smfmac_f32_16x16x64_bf16 v[100:103], v[40:43], a[40:47], v2
    v_cvt_pk_bf16_f32 v97, v104, v105
    v_and_or_b32 v96, v96, -2, s41
    v_smfmac_f32_16x16x64_bf16 v[100:103], v[44:47], a[56:63], v2
    buffer_store_dwordx2 v[96:97], v11, s[4:7], s37 offen sc1
    v_smfmac_f32_16x16x64_bf16 v[108:111], v[56:59], a[232:239], v2
    v_smfmac_f32_16x16x64_bf16 v[108:111], v[60:63], a[248:255], v2
    v_smfmac_f32_16x16x64_bf16 v[108:111], v[32:35], a[136:143], v2
    v_smfmac_f32_16x16x64_bf16 v[108:111], v[36:39], a[152:159], v2
    v_smfmac_f32_16x16x64_bf16 v[108:111], v[40:43], a[168:175], v2
    s_nop 2
    v_add_f32 v100, v100, v102
    v_smfmac_f32_16x16x64_bf16 v[108:111], v[44:47], a[184:191], v2
    v_add_f32 v101, v101, v103
    v_cvt_pk_bf16_f32 v98, v100, v101
    v_and_or_b32 v98, v98, -2, s41
    s_nop 4
    v_pk_add_f32 v[108:109], v[108:109], v[110:111]
    v_cvt_pk_bf16_f32 v99, v108, v109
    buffer_store_dwordx2 v[98:99], v11, s[4:7], s37 offen offset:512 sc1
    v_smfmac_f32_16x16x64_bf16 v[112:115], v[32:35], v[64:71], v2
    ds_read_b128 v[64:67], v1 offset:40960
    ds_read_b128 v[68:71], v1 offset:41984
    v_smfmac_f32_16x16x64_bf16 v[116:119], v[32:35], v[72:79], v2
    ds_read_b128 v[72:75], v1 offset:43008
    ds_read_b128 v[76:79], v1 offset:44032
    v_smfmac_f32_16x16x64_bf16 v[112:115], v[36:39], v[80:87], v2
    ds_read_b128 v[80:83], v1 offset:57344
    ds_read_b128 v[84:87], v1 offset:58368
    v_smfmac_f32_16x16x64_bf16 v[116:119], v[36:39], v[88:95], v2
    ds_read_b128 v[88:91], v1 offset:59392
    ds_read_b128 v[92:95], v1 offset:60416
    s_waitcnt lgkmcnt(6)
    v_smfmac_f32_16x16x64_bf16 v[112:115], v[40:43], v[64:71], v2
    ds_read_b128 v[64:67], v5 offset:8192
    ds_read_b128 v[68:71], v5 offset:9216
    s_waitcnt lgkmcnt(6)
    v_smfmac_f32_16x16x64_bf16 v[116:119], v[40:43], v[72:79], v2
    ds_read_b128 v[72:75], v5 offset:10240
    ds_read_b128 v[76:79], v5 offset:11264
    s_waitcnt lgkmcnt(6)
    v_smfmac_f32_16x16x64_bf16 v[112:115], v[44:47], v[80:87], v2
    ds_read_b128 v[80:83], v5 offset:24576
    ds_read_b128 v[84:87], v5 offset:25600
    s_waitcnt lgkmcnt(6)
    v_smfmac_f32_16x16x64_bf16 v[116:119], v[44:47], v[88:95], v2
    ds_read_b128 v[88:91], v5 offset:26624
    ds_read_b128 v[92:95], v5 offset:27648
    s_waitcnt lgkmcnt(6)
    v_smfmac_f32_16x16x64_bf16 v[112:115], v[48:51], v[64:71], v2
    ds_read_b128 v[64:67], v5 offset:40960
    ds_read_b128 v[68:71], v5 offset:41984
    s_waitcnt lgkmcnt(6)
    v_smfmac_f32_16x16x64_bf16 v[116:119], v[48:51], v[72:79], v2
    ds_read_b128 v[72:75], v5 offset:43008
    ds_read_b128 v[76:79], v5 offset:44032
    s_waitcnt lgkmcnt(6)
    v_smfmac_f32_16x16x64_bf16 v[112:115], v[52:55], v[80:87], v2
    ds_read_b128 v[80:83], v5 offset:57344
    ds_read_b128 v[84:87], v5 offset:58368
    s_waitcnt lgkmcnt(6)
    v_smfmac_f32_16x16x64_bf16 v[116:119], v[52:55], v[88:95], v2
    ds_read_b128 v[88:91], v5 offset:59392
    ds_read_b128 v[92:95], v5 offset:60416
    s_waitcnt lgkmcnt(6)
    v_smfmac_f32_16x16x64_bf16 v[112:115], v[56:59], v[64:71], v2
    s_waitcnt lgkmcnt(4)
    v_smfmac_f32_16x16x64_bf16 v[116:119], v[56:59], v[72:79], v2
    s_waitcnt lgkmcnt(2)
    v_smfmac_f32_16x16x64_bf16 v[112:115], v[60:63], v[80:87], v2
    s_waitcnt lgkmcnt(0)
    v_smfmac_f32_16x16x64_bf16 v[116:119], v[60:63], v[88:95], v2
    buffer_load_dwordx2 v[108:109], v11, s[4:7], s38 offen sc1
    v_mfma_f32_16x16x16_bf16 v[100:103], v[96:97], v[16:17], 0
    v_mfma_f32_16x16x16_bf16 v[104:107], v[98:99], v[16:17], 0
    s_nop 4
    v_add_f32 v112, v112, v114
    v_add_f32 v113, v113, v115
    v_add_f32 v114, v116, v118
    v_add_f32 v115, v117, v119
    v_cvt_pk_bf16_f32 v18, v112, v113
    v_cvt_pk_bf16_f32 v19, v114, v115
    v_and_or_b32 v18, v18, -2, s41
    buffer_load_dwordx2 v[110:111], v11, s[4:7], s38 offen offset:512 sc1
    s_barrier
    buffer_store_dwordx2 v[18:19], v11, s[4:7], s39 offen sc1
    v_mov_b32 v112, v18
    v_mov_b32 v114, v19
    v_mov_b32 v92, v28
    v_mov_b32 v93, 0
    s_waitcnt vmcnt(5)
    s_barrier
    ds_read_b128 v[32:35], v6 offset:19456
    ds_read_b128 v[36:39], v6 offset:20480
    ds_read_b128 v[40:43], v6 offset:24576
    ds_read_b128 v[44:47], v6 offset:25600
    ds_read_b128 v[48:51], v6 offset:9216
    ds_read_b128 v[52:55], v6 offset:10240
    ds_read_b128 v[56:59], v6 offset:14336
    ds_read_b128 v[60:63], v6 offset:15360
    buffer_load_dwordx2 v[20:21], v11, s[4:7], s38 offen sc1
    buffer_load_dwordx2 v[22:23], v11, s[4:7], s38 offen offset:512 sc1
    s_waitcnt vmcnt(4)
    v_mfma_f32_16x16x16_bf16 v[80:83], v[108:109], v[16:17], v[100:103]
    v_and_b32 v3, 1, v108
    v_cmp_ne_u32 vcc, s41, v3
    s_nop 5
    v_cvt_pk_bf16_f32 v64, v80, v81
    v_cvt_pk_bf16_f32 v65, v82, v83
    s_cbranch_vccnz mega_kernel_rf_w2_xslow
    s_waitcnt vmcnt(3)
    v_mfma_f32_16x16x16_bf16 v[84:87], v[110:111], v[16:17], v[104:107]
    v_and_b32 v3, 1, v110
    v_cmp_ne_u32 vcc, s41, v3
    s_nop 5
    v_cvt_pk_bf16_f32 v66, v84, v85
    v_cvt_pk_bf16_f32 v67, v86, v87
    ds_write_b128 v6, v[64:67] offset:18432
    s_cbranch_vccnz mega_kernel_rf_w2_xslow
mega_kernel_rf_w2_xok:
    s_cmp_eq_u32 s21, 63
    s_cbranch_scc1 mega_kernel_rf_w2_last
    buffer_load_dwordx2 v[116:117], v11, s[4:7], s40 offen sc1
    s_waitcnt lgkmcnt(1)
    v_mfma_f32_16x16x32_bf16 v[80:83], v[32:35], v[64:67], 0
    s_waitcnt lgkmcnt(0)
    s_barrier
    ds_read_b128 v[68:71], v6 offset:23552
    ds_read_b128 v[72:75], v6 offset:8192
    ds_read_b128 v[76:79], v6 offset:13312
    v_mfma_f32_16x16x32_bf16 v[84:87], v[36:39], v[64:67], 0
    v_mfma_f32_16x16x32_bf16 v[88:91], v[64:67], v[64:67], 0
    buffer_load_dwordx2 v[20:21], v11, s[4:7], s40 offen sc1
    s_waitcnt lgkmcnt(2)
    v_mfma_f32_16x16x32_bf16 v[80:83], v[40:43], v[68:71], v[80:83]
    s_waitcnt lgkmcnt(1)
    v_mfma_f32_16x16x32_bf16 v[80:83], v[48:51], v[72:75], v[80:83]
    s_waitcnt lgkmcnt(0)
    v_mfma_f32_16x16x32_bf16 v[80:83], v[56:59], v[76:79], v[80:83]
    buffer_store_dwordx4 v[64:67], v10, s[4:7], s45 offen offset:128 sc1
    v_mfma_f32_16x16x32_bf16 v[84:87], v[44:47], v[68:71], v[84:87]
    v_mfma_f32_16x16x32_bf16 v[84:87], v[52:55], v[72:75], v[84:87]
    v_mfma_f32_16x16x32_bf16 v[84:87], v[60:63], v[76:79], v[84:87]
    v_mfma_f32_16x16x32_bf16 v[88:91], v[68:71], v[68:71], v[88:91]
    buffer_store_dwordx2 v[18:19], v11, s[4:7], s51 offen offset:3072 sc1
    v_mfma_f32_16x16x32_bf16 v[88:91], v[72:75], v[72:75], v[88:91]
    v_mfma_f32_16x16x32_bf16 v[88:91], v[76:79], v[76:79], v[88:91]
    v_mfma_f32_32x32x4_2b_bf16 v[32:63], v[14:15], v[14:15], 0
    s_nop 0
    v_max3_f32 v4, v80, v81, v82
    s_nop 1
    v_max3_f32 v4, v4, v83, v84
    v_max3_f32 v4, v4, v85, v86
    v_max_f32 v4, v4, v87
    v_max3_f32 v90, v4, v88, v89
    v_max3_f32 v4, v4, v88, v89
    s_nop 1
    v_permlane16_swap_b32 v4, v90
    v_max_f32 v4, v4, v90
    v_max_f32 v90, v4, v90
    s_nop 1
    v_permlane32_swap_b32 v4, v90
    v_max_f32 v4, v4, v90
    v_mul_f32 v4, s34, v4
    v_pk_fma_f32 v[80:81], v[80:81], s[34:35], v[4:5] op_sel_hi:[1,0,0] neg_lo:[0,0,1] neg_hi:[0,0,1]
    v_pk_fma_f32 v[82:83], v[82:83], s[34:35], v[4:5] op_sel_hi:[1,0,0] neg_lo:[0,0,1] neg_hi:[0,0,1]
    v_pk_fma_f32 v[84:85], v[84:85], s[34:35], v[4:5] op_sel_hi:[1,0,0] neg_lo:[0,0,1] neg_hi:[0,0,1]
    v_pk_fma_f32 v[86:87], v[86:87], s[34:35], v[4:5] op_sel_hi:[1,0,0] neg_lo:[0,0,1] neg_hi:[0,0,1]
    v_pk_fma_f32 v[88:89], v[88:89], s[34:35], v[4:5] op_sel_hi:[1,0,0] neg_lo:[0,0,1] neg_hi:[0,0,1]
    v_exp_f32 v80, v80
    v_exp_f32 v81, v81
    v_exp_f32 v82, v82
    v_cvt_pk_bf16_f32 v68, v80, v81
    v_exp_f32 v83, v83
    v_exp_f32 v84, v84
    v_cvt_pk_bf16_f32 v69, v82, v83
    v_exp_f32 v85, v85
    v_exp_f32 v86, v86
    v_cvt_pk_bf16_f32 v70, v84, v85
    v_exp_f32 v87, v87
    v_exp_f32 v88, v88
    v_cvt_pk_bf16_f32 v71, v86, v87
    v_exp_f32 v89, v89
    s_waitcnt vmcnt(3)
    v_mfma_f32_16x16x32_bf16 v[76:79], v[28:31], v[68:71], 0
    v_and_b32 v3, 1, v116
    v_cvt_pk_bf16_f32 v72, v88, v89
    v_mfma_f32_16x16x32_bf16 v[100:103], v[120:123], v[68:71], 0
    v_cmp_ne_u32 vcc, s41, v3
    v_cvt_pk_bf16_f32 v73, v88, v89
    v_mfma_f32_16x16x32_bf16 v[104:107], v[124:127], v[68:71], 0
    v_mov_b32 v113, v116
    v_mov_b32 v115, v117
    v_mfma_f32_16x16x16_bf16 v[76:79], v[92:93], v[72:73], v[76:79]
    s_cbranch_vccnz mega_kernel_rf_w2_pv0
mega_kernel_rf_w2_pv2:
    v_mfma_f32_16x16x16_bf16 v[100:103], v[112:113], v[72:73], v[100:103]
    v_mfma_f32_16x16x16_bf16 v[104:107], v[114:115], v[72:73], v[104:107]
    buffer_load_dwordx4 v[120:123], v1, s[4:7], s44 offen
    buffer_load_dwordx4 v[124:127], v1, s[4:7], s44 offen offset:1024
    s_nop 2
    v_rcp_f32 v76, v76
    s_mov_b64 exec, s[28:29]
    v_pk_mul_f32 v[100:101], v[100:101], v[76:77] op_sel_hi:[1,0]
    v_pk_mul_f32 v[102:103], v[102:103], v[76:77] op_sel_hi:[1,0]
    v_pk_mul_f32 v[104:105], v[104:105], v[76:77] op_sel_hi:[1,0]
    v_pk_mul_f32 v[106:107], v[106:107], v[76:77] op_sel_hi:[1,0]
    v_cvt_pk_bf16_f32 v84, v100, v101
    v_cvt_pk_bf16_f32 v85, v102, v103
    v_cvt_pk_bf16_f32 v86, v104, v105
    v_cvt_pk_bf16_f32 v87, v106, v107
    ds_write_b128 v6, v[84:87] offset:29664
    s_mov_b64 exec, -1
    s_waitcnt lgkmcnt(0)
    s_barrier
    ds_read_b128 v[68:71], v6 offset:28672
    ds_read_b128 v[72:75], v6 offset:29696
    s_waitcnt lgkmcnt(1)
    v_smfmac_f32_16x16x64_bf16 v[32:35], v[68:71], v[128:135], v2
    s_add_u32 s21, s21, 1
    s_xor_b32 s38, s38, 1048576
    s_xor_b32 s37, s37, 1048576
    s_waitcnt lgkmcnt(0)
    v_smfmac_f32_16x16x64_bf16 v[32:35], v[72:75], v[136:143], v2
    s_xor_b32 s40, s40, 1048576
    s_xor_b32 s39, s39, 1048576
    s_lshr_b32 s41, s21, 1
    v_smfmac_f32_16x16x64_bf16 v[36:39], v[68:71], v[144:151], v2
    s_and_b32 s41, s41, 1
    s_xor_b32 s41, s41, 1
    s_xor_b32 s35, s35, 16384
    v_smfmac_f32_16x16x64_bf16 v[36:39], v[72:75], v[152:159], v2
    v_add_f32 v32, v32, v34
    s_xor_b32 s36, s36, 16384
    s_add_u32 s43, s43, 262144
    s_add_u32 s44, s44, 262144
    v_smfmac_f32_16x16x64_bf16 v[40:43], v[68:71], v[160:167], v2
    v_add_f32 v33, v33, v35
    v_smfmac_f32_16x16x64_bf16 v[40:43], v[72:75], v[168:175], v2
    v_cvt_pk_bf16_f32 v32, v32, v33
    v_smfmac_f32_16x16x64_bf16 v[44:47], v[68:71], v[176:183], v2
    v_and_or_b32 v32, v32, -2, s42
    v_smfmac_f32_16x16x64_bf16 v[44:47], v[72:75], v[184:191], v2
    v_add_f32 v36, v36, v38
    v_smfmac_f32_16x16x64_bf16 v[48:51], v[68:71], v[192:199], v2
    v_add_f32 v37, v37, v39
    v_smfmac_f32_16x16x64_bf16 v[48:51], v[72:75], v[200:207], v2
    v_cvt_pk_bf16_f32 v33, v36, v37
    v_smfmac_f32_16x16x64_bf16 v[52:55], v[68:71], v[208:215], v2
    v_add_f32 v40, v40, v42
    v_smfmac_f32_16x16x64_bf16 v[52:55], v[72:75], v[216:223], v2
    v_add_f32 v41, v41, v43
    v_smfmac_f32_16x16x64_bf16 v[56:59], v[68:71], v[224:231], v2
    v_cvt_pk_bf16_f32 v34, v40, v41
    v_smfmac_f32_16x16x64_bf16 v[56:59], v[72:75], v[232:239], v2
    v_add_f32 v44, v44, v46
    v_smfmac_f32_16x16x64_bf16 v[60:63], v[68:71], v[240:247], v2
    v_add_f32 v45, v45, v47
    v_smfmac_f32_16x16x64_bf16 v[60:63], v[72:75], v[248:255], v2
    v_cvt_pk_bf16_f32 v35, v44, v45
    buffer_store_dwordx4 v[32:35], v8, s[4:7], s46 offen
    v_pk_add_f32 v[48:49], v[48:49], v[50:51]
    v_cvt_pk_bf16_f32 v48, v48, v49
    v_and_or_b32 v48, v48, -2, s42
    v_pk_add_f32 v[52:53], v[52:53], v[54:55]
    v_cvt_pk_bf16_f32 v49, v52, v53
    v_pk_add_f32 v[56:57], v[56:57], v[58:59]
    v_cvt_pk_bf16_f32 v50, v56, v57
    v_pk_add_f32 v[60:61], v[60:61], v[62:63]
    v_cvt_pk_bf16_f32 v51, v60, v61
    buffer_store_dwordx4 v[48:51], v8, s[4:7], s61 offen
    s_add_u32 s45, s45, 262144
    s_add_u32 s51, s51, 262144
    v_mfma_f32_32x32x8_bf16 v[96:111], v[14:15], v[14:15], 0
    v_mfma_f32_16x16x16_bf16 v[112:115], v[14:15], v[14:15], 0
    v_mfma_f32_16x16x16_bf16 v[116:119], v[14:15], v[14:15], 0
    ds_read_b128 v[64:67], v1 offset:8192
    ds_read_b128 v[68:71], v1 offset:9216
    ds_read_b128 v[72:75], v1 offset:10240
    ds_read_b128 v[76:79], v1 offset:11264
    ds_read_b128 v[80:83], v1 offset:24576
    ds_read_b128 v[84:87], v1 offset:25600
    ds_read_b128 v[88:91], v1 offset:26624
    ds_read_b128 v[92:95], v1 offset:27648
    v_mov_b32 v58, -1
    v_mov_b32 v59, -1
    s_waitcnt vmcnt(0)
mega_kernel_rf_w2_cgo:
mega_kernel_rf_w2_pc:
    buffer_load_dword v36, v13, s[4:7], s25 offen offset:0 sc1
    buffer_load_dword v37, v13, s[4:7], s25 offen offset:256 sc1
    buffer_load_dword v38, v13, s[4:7], s25 offen offset:512 sc1
    buffer_load_dword v39, v13, s[4:7], s25 offen offset:768 sc1
    buffer_load_dword v40, v13, s[4:7], s25 offen offset:1024 sc1
    buffer_load_dword v41, v13, s[4:7], s25 offen offset:1280 sc1
    buffer_load_dword v42, v13, s[4:7], s25 offen offset:1536 sc1
    buffer_load_dword v43, v13, s[4:7], s25 offen offset:1792 sc1
    s_waitcnt vmcnt(4)
    v_mfma_f32_16x16x32_bf16 v[52:55], v[36:39], v[24:27], 0
    v_bitop3_b32 v3, s42, v36, v37 bitop3:0x7e
    v_bitop3_b32 v4, s42, v38, v39 bitop3:0x7e
    s_waitcnt vmcnt(2)
    v_or_b32 v3, v3, v4
    v_bitop3_b32 v4, s42, v40, v41 bitop3:0x7e
    s_waitcnt vmcnt(0)
    v_mfma_f32_16x16x32_bf16 v[52:55], v[40:43], v[24:27], v[52:55]
    v_bitop3_b32 v56, s42, v42, v43 bitop3:0x7e
    v_or3_b32 v3, v3, v4, v56
    v_and_b32 v3, v0, v3
    v_cmp_ne_u32 vcc, 0, v3
    s_nop 3
    v_cvt_pk_bf16_f32 v56, v52, v53
    v_cvt_pk_bf16_f32 v57, v54, v55
    v_min_u32 v56, -2, v56
    s_cbranch_vccnz mega_kernel_rf_w2_pc
    s_mov_b64 exec, s[26:27]
    buffer_store_dwordx2 v[56:57], v9, s[4:7], s35 offen offset:512
    buffer_store_dwordx2 v[58:59], v9, s[4:7], s36 offen offset:512
    s_mov_b64 exec, -1
    s_xor_b32 s42, s42, 1
    s_branch mega_kernel_rf_w2_loop
mega_kernel_rf_w2_last:
    buffer_store_dwordx4 v[64:67], v10, s[4:7], s45 offen offset:128 sc1
    buffer_store_dwordx2 v[18:19], v11, s[4:7], s51 offen offset:3072 sc1
    s_branch mega_kernel_rf_end
mega_kernel_rf_w2_pafail:
    s_nop 7
    v_mov_b32 v96, 0
    v_mov_b32 v97, 0
    v_mov_b32 v98, 0
    v_mov_b32 v99, 0
    v_mov_b32 v100, 0
    v_mov_b32 v101, 0
    v_mov_b32 v102, 0
    v_mov_b32 v103, 0
    v_mov_b32 v104, 0
    v_mov_b32 v105, 0
    v_mov_b32 v106, 0
    v_mov_b32 v107, 0
    s_branch mega_kernel_rf_w2_pa
mega_kernel_rf_w2_xslow:
    buffer_load_dwordx2 v[108:109], v11, s[4:7], s38 offen sc1
    buffer_load_dwordx2 v[110:111], v11, s[4:7], s38 offen offset:512 sc1
    s_waitcnt vmcnt(2)
    v_bitop3_b32 v3, s41, v20, v22 bitop3:0x7e
    v_mfma_f32_16x16x16_bf16 v[80:83], v[20:21], v[16:17], v[100:103]
    v_and_b32 v3, 1, v3
    v_mfma_f32_16x16x16_bf16 v[84:87], v[22:23], v[16:17], v[104:107]
    v_cmp_ne_u32 vcc, 0, v3
    s_cbranch_vccz mega_kernel_rf_w2_xgot
    buffer_load_dwordx2 v[20:21], v11, s[4:7], s38 offen sc1
    buffer_load_dwordx2 v[22:23], v11, s[4:7], s38 offen offset:512 sc1
    s_waitcnt vmcnt(2)
    v_bitop3_b32 v3, s41, v108, v110 bitop3:0x7e
    v_mfma_f32_16x16x16_bf16 v[80:83], v[108:109], v[16:17], v[100:103]
    v_and_b32 v3, 1, v3
    v_mfma_f32_16x16x16_bf16 v[84:87], v[110:111], v[16:17], v[104:107]
    v_cmp_ne_u32 vcc, 0, v3
    s_cbranch_vccz mega_kernel_rf_w2_xgot
    s_branch mega_kernel_rf_w2_xslow
mega_kernel_rf_w2_xgot:
    s_nop 3
    v_cvt_pk_bf16_f32 v64, v80, v81
    v_cvt_pk_bf16_f32 v65, v82, v83
    v_cvt_pk_bf16_f32 v66, v84, v85
    v_cvt_pk_bf16_f32 v67, v86, v87
    ds_write_b128 v6, v[64:67] offset:18432
    s_branch mega_kernel_rf_w2_xok
mega_kernel_rf_w2_pv0:
    s_waitcnt vmcnt(2)
    s_branch mega_kernel_rf_w2_pv1
mega_kernel_rf_w2_pv:
    buffer_load_dwordx2 v[20:21], v11, s[4:7], s40 offen sc1
    s_waitcnt vmcnt(0)
mega_kernel_rf_w2_pv1:
    v_and_b32 v3, 1, v20
    v_cmp_ne_u32 vcc, s41, v3
    v_mov_b32 v113, v20
    v_mov_b32 v115, v21
    s_cbranch_vccnz mega_kernel_rf_w2_pv
    s_branch mega_kernel_rf_w2_pv2
mega_kernel_rf_w3_entry:
    v_mfma_f32_32x32x8_bf16 v[96:111], v[14:15], v[14:15], 0
    v_mfma_f32_16x16x16_bf16 v[112:115], v[14:15], v[14:15], 0
    v_mfma_f32_16x16x16_bf16 v[116:119], v[14:15], v[14:15], 0
    ds_read_b128 v[64:67], v1 offset:12288
    ds_read_b128 v[68:71], v1 offset:13312
    ds_read_b128 v[72:75], v1 offset:14336
    ds_read_b128 v[76:79], v1 offset:15360
    ds_read_b128 v[80:83], v1 offset:28672
    ds_read_b128 v[84:87], v1 offset:29696
    ds_read_b128 v[88:91], v1 offset:30720
    ds_read_b128 v[92:95], v1 offset:31744
    buffer_load_dwordx4 v[120:123], v1, s[4:7], s44 offen
    buffer_load_dwordx4 v[124:127], v1, s[4:7], s44 offen offset:1024
    s_add_u32 s44, s44, 262144
mega_kernel_rf_w3_loop:
    s_add_u32 s22, s35, 6144
    s_waitcnt vmcnt(0)
    buffer_load_dwordx4 v[56:59], v1, s[4:7], s22 offen sc1
    buffer_load_dwordx4 v[60:63], v1, s[4:7], s22 offen offset:1024 sc1
mega_kernel_rf_w3_pa:
    s_waitcnt vmcnt(1)
    ds_write_b128 v6, v[56:59] offset:6144
    s_waitcnt vmcnt(0)
    ds_write_b128 v6, v[60:63] offset:7168
    v_max3_u32 v3, v56, v58, v60
    v_max_u32 v3, v3, v62
    v_cmp_eq_u32 vcc, -1, v3
    v_smfmac_f32_16x16x64_bf16 v[96:99], v[56:59], a[96:103], v2
    buffer_load_dwordx4 v[56:59], v1, s[4:7], s22 offen sc1
    v_smfmac_f32_16x16x64_bf16 v[100:103], v[56:59], a[104:111], v2
    buffer_load_dwordx4 v[60:63], v1, s[4:7], s22 offen offset:1024 sc1
    v_smfmac_f32_16x16x64_bf16 v[104:107], v[56:59], a[224:231], v2
    s_cbranch_vccnz mega_kernel_rf_w3_pafail
    s_waitcnt lgkmcnt(0)
    s_barrier
    ds_read_b128 v[32:35], v6 offset:0
    ds_read_b128 v[36:39], v6 offset:1024
    v_smfmac_f32_16x16x64_bf16 v[108:111], v[56:59], a[232:239], v2
    ds_read_b128 v[40:43], v6 offset:2048
    v_smfmac_f32_16x16x64_bf16 v[96:99], v[60:63], a[112:119], v2
    ds_read_b128 v[44:47], v6 offset:3072
    v_smfmac_f32_16x16x64_bf16 v[100:103], v[60:63], a[120:127], v2
    ds_read_b128 v[48:51], v6 offset:4096
    v_smfmac_f32_16x16x64_bf16 v[104:107], v[60:63], a[240:247], v2
    ds_read_b128 v[52:55], v6 offset:5120
    v_smfmac_f32_16x16x64_bf16 v[108:111], v[60:63], a[248:255], v2
    s_waitcnt lgkmcnt(5)
    v_smfmac_f32_16x16x64_bf16 v[96:99], v[32:35], a[0:7], v2
    v_smfmac_f32_16x16x64_bf16 v[104:107], v[32:35], a[128:135], v2
    s_waitcnt lgkmcnt(4)
    v_smfmac_f32_16x16x64_bf16 v[96:99], v[36:39], a[16:23], v2
    buffer_load_dwordx4 v1, s[4:7], s43 offen lds
    v_smfmac_f32_16x16x64_bf16 v[104:107], v[36:39], a[144:151], v2
    s_waitcnt lgkmcnt(3)
    v_smfmac_f32_16x16x64_bf16 v[96:99], v[40:43], a[32:39], v2
    v_smfmac_f32_16x16x64_bf16 v[104:107], v[40:43], a[160:167], v2
    s_waitcnt lgkmcnt(2)
    v_smfmac_f32_16x16x64_bf16 v[96:99], v[44:47], a[48:55], v2
    buffer_load_dwordx4 v1, s[4:7], s43 offen offset:1024 lds
    v_smfmac_f32_16x16x64_bf16 v[104:107], v[44:47], a[176:183], v2
    s_waitcnt lgkmcnt(1)
    v_smfmac_f32_16x16x64_bf16 v[96:99], v[48:51], a[64:71], v2
    v_smfmac_f32_16x16x64_bf16 v[104:107], v[48:51], a[192:199], v2
    s_waitcnt lgkmcnt(0)
    v_smfmac_f32_16x16x64_bf16 v[96:99], v[52:55], a[80:87], v2
    buffer_load_dword v12, v7, s[4:7], 0 offen sc1
    v_smfmac_f32_16x16x64_bf16 v[104:107], v[52:55], a[208:215], v2
    v_smfmac_f32_16x16x64_bf16 v[100:103], v[32:35], a[8:15], v2
    s_nop 2
    v_smfmac_f32_16x16x64_bf16 v[100:103], v[36:39], a[24:31], v2
    s_nop 1
    v_add_f32 v96, v96, v98
    v_smfmac_f32_16x16x64_bf16 v[100:103], v[40:43], a[40:47], v2
    v_add_f32 v97, v97, v99
    v_add_f32 v104, v104, v106
    v_smfmac_f32_16x16x64_bf16 v[100:103], v[44:47], a[56:63], v2
    v_add_f32 v105, v105, v107
    v_cvt_pk_bf16_f32 v96, v96, v97
    v_smfmac_f32_16x16x64_bf16 v[100:103], v[48:51], a[72:79], v2
    v_cvt_pk_bf16_f32 v97, v104, v105
    v_and_or_b32 v96, v96, -2, s41
    v_smfmac_f32_16x16x64_bf16 v[100:103], v[52:55], a[88:95], v2
    buffer_store_dwordx2 v[96:97], v11, s[4:7], s37 offen sc1
    v_smfmac_f32_16x16x64_bf16 v[108:111], v[32:35], a[136:143], v2
    v_smfmac_f32_16x16x64_bf16 v[108:111], v[36:39], a[152:159], v2
    v_smfmac_f32_16x16x64_bf16 v[108:111], v[40:43], a[168:175], v2
    v_smfmac_f32_16x16x64_bf16 v[108:111], v[44:47], a[184:191], v2
    v_smfmac_f32_16x16x64_bf16 v[108:111], v[48:51], a[200:207], v2
    s_nop 2
    v_add_f32 v100, v100, v102
    v_smfmac_f32_16x16x64_bf16 v[108:111], v[52:55], a[216:223], v2
    v_add_f32 v101, v101, v103
    v_cvt_pk_bf16_f32 v98, v100, v101
    v_and_or_b32 v98, v98, -2, s41
    s_nop 4
    v_pk_add_f32 v[108:109], v[108:109], v[110:111]
    v_cvt_pk_bf16_f32 v99, v108, v109
    buffer_store_dwordx2 v[98:99], v11, s[4:7], s37 offen offset:512 sc1
    v_smfmac_f32_16x16x64_bf16 v[112:115], v[32:35], v[64:71], v2
    ds_read_b128 v[64:67], v1 offset:45056
    ds_read_b128 v[68:71], v1 offset:46080
    v_smfmac_f32_16x16x64_bf16 v[116:119], v[32:35], v[72:79], v2
    ds_read_b128 v[72:75], v1 offset:47104
    ds_read_b128 v[76:79], v1 offset:48128
    v_smfmac_f32_16x16x64_bf16 v[112:115], v[36:39], v[80:87], v2
    ds_read_b128 v[80:83], v1 offset:61440
    ds_read_b128 v[84:87], v1 offset:62464
    v_smfmac_f32_16x16x64_bf16 v[116:119], v[36:39], v[88:95], v2
    ds_read_b128 v[88:91], v1 offset:63488
    ds_read_b128 v[92:95], v1 offset:64512
    s_waitcnt lgkmcnt(6)
    v_smfmac_f32_16x16x64_bf16 v[112:115], v[40:43], v[64:71], v2
    ds_read_b128 v[64:67], v5 offset:12288
    ds_read_b128 v[68:71], v5 offset:13312
    s_waitcnt lgkmcnt(6)
    v_smfmac_f32_16x16x64_bf16 v[116:119], v[40:43], v[72:79], v2
    ds_read_b128 v[72:75], v5 offset:14336
    ds_read_b128 v[76:79], v5 offset:15360
    s_waitcnt lgkmcnt(6)
    v_smfmac_f32_16x16x64_bf16 v[112:115], v[44:47], v[80:87], v2
    ds_read_b128 v[80:83], v5 offset:28672
    ds_read_b128 v[84:87], v5 offset:29696
    s_waitcnt lgkmcnt(6)
    v_smfmac_f32_16x16x64_bf16 v[116:119], v[44:47], v[88:95], v2
    ds_read_b128 v[88:91], v5 offset:30720
    ds_read_b128 v[92:95], v5 offset:31744
    s_waitcnt lgkmcnt(6)
    v_smfmac_f32_16x16x64_bf16 v[112:115], v[48:51], v[64:71], v2
    ds_read_b128 v[64:67], v5 offset:45056
    ds_read_b128 v[68:71], v5 offset:46080
    s_waitcnt lgkmcnt(6)
    v_smfmac_f32_16x16x64_bf16 v[116:119], v[48:51], v[72:79], v2
    ds_read_b128 v[72:75], v5 offset:47104
    ds_read_b128 v[76:79], v5 offset:48128
    s_waitcnt lgkmcnt(6)
    v_smfmac_f32_16x16x64_bf16 v[112:115], v[52:55], v[80:87], v2
    ds_read_b128 v[80:83], v5 offset:61440
    ds_read_b128 v[84:87], v5 offset:62464
    s_waitcnt lgkmcnt(6)
    v_smfmac_f32_16x16x64_bf16 v[116:119], v[52:55], v[88:95], v2
    ds_read_b128 v[88:91], v5 offset:63488
    ds_read_b128 v[92:95], v5 offset:64512
    s_waitcnt lgkmcnt(6)
    v_smfmac_f32_16x16x64_bf16 v[112:115], v[56:59], v[64:71], v2
    s_waitcnt lgkmcnt(4)
    v_smfmac_f32_16x16x64_bf16 v[116:119], v[56:59], v[72:79], v2
    s_waitcnt lgkmcnt(2)
    v_smfmac_f32_16x16x64_bf16 v[112:115], v[60:63], v[80:87], v2
    s_waitcnt lgkmcnt(0)
    v_smfmac_f32_16x16x64_bf16 v[116:119], v[60:63], v[88:95], v2
    buffer_load_dwordx2 v[108:109], v11, s[4:7], s38 offen sc1
    v_mfma_f32_16x16x16_bf16 v[100:103], v[96:97], v[16:17], 0
    v_mfma_f32_16x16x16_bf16 v[104:107], v[98:99], v[16:17], 0
    s_nop 4
    v_add_f32 v112, v112, v114
    v_add_f32 v113, v113, v115
    v_add_f32 v114, v116, v118
    v_add_f32 v115, v117, v119
    v_cvt_pk_bf16_f32 v18, v112, v113
    v_cvt_pk_bf16_f32 v19, v114, v115
    v_and_or_b32 v18, v18, -2, s41
    buffer_load_dwordx2 v[110:111], v11, s[4:7], s38 offen offset:512 sc1
    s_barrier
    buffer_store_dwordx2 v[18:19], v11, s[4:7], s39 offen sc1
    v_mov_b32 v112, v18
    v_mov_b32 v114, v19
    v_mov_b32 v92, v28
    v_mov_b32 v93, 0
    s_waitcnt vmcnt(6)
    s_barrier
    ds_read_b128 v[32:35], v6 offset:24576
    ds_read_b128 v[36:39], v6 offset:25600
    ds_read_b128 v[40:43], v6 offset:19456
    ds_read_b128 v[44:47], v6 offset:20480
    ds_read_b128 v[48:51], v6 offset:14336
    ds_read_b128 v[52:55], v6 offset:15360
    ds_read_b128 v[56:59], v6 offset:9216
    ds_read_b128 v[60:63], v6 offset:10240
    buffer_load_dwordx2 v[20:21], v11, s[4:7], s38 offen sc1
    buffer_load_dwordx2 v[22:23], v11, s[4:7], s38 offen offset:512 sc1
    s_waitcnt vmcnt(4)
    v_mfma_f32_16x16x16_bf16 v[80:83], v[108:109], v[16:17], v[100:103]
    v_and_b32 v3, 1, v108
    v_cmp_ne_u32 vcc, s41, v3
    s_nop 5
    v_cvt_pk_bf16_f32 v64, v80, v81
    v_cvt_pk_bf16_f32 v65, v82, v83
    s_cbranch_vccnz mega_kernel_rf_w3_xslow
    s_waitcnt vmcnt(3)
    v_mfma_f32_16x16x16_bf16 v[84:87], v[110:111], v[16:17], v[104:107]
    v_and_b32 v3, 1, v110
    v_cmp_ne_u32 vcc, s41, v3
    s_nop 5
    v_cvt_pk_bf16_f32 v66, v84, v85
    v_cvt_pk_bf16_f32 v67, v86, v87
    ds_write_b128 v6, v[64:67] offset:23552
    s_cbranch_vccnz mega_kernel_rf_w3_xslow
mega_kernel_rf_w3_xok:
    s_cmp_eq_u32 s21, 63
    s_cbranch_scc1 mega_kernel_rf_w3_last
    buffer_load_dwordx2 v[116:117], v11, s[4:7], s40 offen sc1
    s_waitcnt lgkmcnt(1)
    v_mfma_f32_16x16x32_bf16 v[80:83], v[32:35], v[64:67], 0
    s_waitcnt lgkmcnt(0)
    s_barrier
    ds_read_b128 v[68:71], v6 offset:18432
    ds_read_b128 v[72:75], v6 offset:13312
    ds_read_b128 v[76:79], v6 offset:8192
    v_mfma_f32_16x16x32_bf16 v[84:87], v[36:39], v[64:67], 0
    v_mfma_f32_16x16x32_bf16 v[88:91], v[64:67], v[64:67], 0
    buffer_load_dwordx2 v[20:21], v11, s[4:7], s40 offen sc1
    s_waitcnt lgkmcnt(2)
    v_mfma_f32_16x16x32_bf16 v[80:83], v[40:43], v[68:71], v[80:83]
    s_waitcnt lgkmcnt(1)
    v_mfma_f32_16x16x32_bf16 v[80:83], v[48:51], v[72:75], v[80:83]
    s_waitcnt lgkmcnt(0)
    v_mfma_f32_16x16x32_bf16 v[80:83], v[56:59], v[76:79], v[80:83]
    v_mfma_f32_16x16x32_bf16 v[84:87], v[44:47], v[68:71], v[84:87]
    buffer_store_dwordx4 v[64:67], v10, s[4:7], s45 offen offset:192 sc1
    v_mfma_f32_16x16x32_bf16 v[84:87], v[52:55], v[72:75], v[84:87]
    v_mfma_f32_16x16x32_bf16 v[84:87], v[60:63], v[76:79], v[84:87]
    v_mfma_f32_16x16x32_bf16 v[88:91], v[68:71], v[68:71], v[88:91]
    v_mfma_f32_16x16x32_bf16 v[88:91], v[72:75], v[72:75], v[88:91]
    buffer_store_dwordx2 v[18:19], v11, s[4:7], s51 offen offset:3584 sc1
    v_mfma_f32_16x16x32_bf16 v[88:91], v[76:79], v[76:79], v[88:91]
    v_mfma_f32_32x32x4_2b_bf16 v[32:63], v[14:15], v[14:15], 0
    s_nop 0
    v_max3_f32 v4, v80, v81, v82
    s_nop 1
    v_max3_f32 v4, v4, v83, v84
    v_max3_f32 v4, v4, v85, v86
    v_max_f32 v4, v4, v87
    v_max3_f32 v90, v4, v88, v89
    v_max3_f32 v4, v4, v88, v89
    s_nop 1
    v_permlane16_swap_b32 v4, v90
    v_max_f32 v4, v4, v90
    v_max_f32 v90, v4, v90
    s_nop 1
    v_permlane32_swap_b32 v4, v90
    v_max_f32 v4, v4, v90
    v_mul_f32 v4, s34, v4
    v_pk_fma_f32 v[80:81], v[80:81], s[34:35], v[4:5] op_sel_hi:[1,0,0] neg_lo:[0,0,1] neg_hi:[0,0,1]
    v_pk_fma_f32 v[82:83], v[82:83], s[34:35], v[4:5] op_sel_hi:[1,0,0] neg_lo:[0,0,1] neg_hi:[0,0,1]
    v_pk_fma_f32 v[84:85], v[84:85], s[34:35], v[4:5] op_sel_hi:[1,0,0] neg_lo:[0,0,1] neg_hi:[0,0,1]
    v_pk_fma_f32 v[86:87], v[86:87], s[34:35], v[4:5] op_sel_hi:[1,0,0] neg_lo:[0,0,1] neg_hi:[0,0,1]
    v_pk_fma_f32 v[88:89], v[88:89], s[34:35], v[4:5] op_sel_hi:[1,0,0] neg_lo:[0,0,1] neg_hi:[0,0,1]
    v_exp_f32 v80, v80
    v_exp_f32 v81, v81
    v_exp_f32 v82, v82
    v_cvt_pk_bf16_f32 v68, v80, v81
    v_exp_f32 v83, v83
    v_exp_f32 v84, v84
    v_cvt_pk_bf16_f32 v69, v82, v83
    v_exp_f32 v85, v85
    v_exp_f32 v86, v86
    v_cvt_pk_bf16_f32 v70, v84, v85
    v_exp_f32 v87, v87
    v_exp_f32 v88, v88
    v_cvt_pk_bf16_f32 v71, v86, v87
    v_exp_f32 v89, v89
    s_waitcnt vmcnt(3)
    v_mfma_f32_16x16x32_bf16 v[76:79], v[28:31], v[68:71], 0
    v_and_b32 v3, 1, v116
    v_cvt_pk_bf16_f32 v72, v88, v89
    v_mfma_f32_16x16x32_bf16 v[100:103], v[120:123], v[68:71], 0
    v_cmp_ne_u32 vcc, s41, v3
    v_cvt_pk_bf16_f32 v73, v88, v89
    v_mfma_f32_16x16x32_bf16 v[104:107], v[124:127], v[68:71], 0
    v_mov_b32 v113, v116
    v_mov_b32 v115, v117
    v_mfma_f32_16x16x16_bf16 v[76:79], v[92:93], v[72:73], v[76:79]
    s_cbranch_vccnz mega_kernel_rf_w3_pv0
mega_kernel_rf_w3_pv2:
    v_mfma_f32_16x16x16_bf16 v[100:103], v[112:113], v[72:73], v[100:103]
    v_mfma_f32_16x16x16_bf16 v[104:107], v[114:115], v[72:73], v[104:107]
    buffer_load_dwordx4 v[120:123], v1, s[4:7], s44 offen
    buffer_load_dwordx4 v[124:127], v1, s[4:7], s44 offen offset:1024
    s_nop 2
    v_rcp_f32 v76, v76
    s_mov_b64 exec, s[28:29]
    v_pk_mul_f32 v[100:101], v[100:101], v[76:77] op_sel_hi:[1,0]
    v_pk_mul_f32 v[102:103], v[102:103], v[76:77] op_sel_hi:[1,0]
    v_pk_mul_f32 v[104:105], v[104:105], v[76:77] op_sel_hi:[1,0]
    v_pk_mul_f32 v[106:107], v[106:107], v[76:77] op_sel_hi:[1,0]
    v_cvt_pk_bf16_f32 v84, v100, v101
    v_cvt_pk_bf16_f32 v85, v102, v103
    v_cvt_pk_bf16_f32 v86, v104, v105
    v_cvt_pk_bf16_f32 v87, v106, v107
    ds_write_b128 v6, v[84:87] offset:29696
    s_mov_b64 exec, -1
    s_waitcnt lgkmcnt(0)
    s_barrier
    ds_read_b128 v[68:71], v6 offset:28672
    ds_read_b128 v[72:75], v6 offset:29696
    s_waitcnt lgkmcnt(1)
    v_smfmac_f32_16x16x64_bf16 v[32:35], v[68:71], v[128:135], v2
    s_add_u32 s21, s21, 1
    s_xor_b32 s38, s38, 1048576
    s_xor_b32 s37, s37, 1048576
    s_waitcnt lgkmcnt(0)
    v_smfmac_f32_16x16x64_bf16 v[32:35], v[72:75], v[136:143], v2
    s_xor_b32 s40, s40, 1048576
    s_xor_b32 s39, s39, 1048576
    s_lshr_b32 s41, s21, 1
    v_smfmac_f32_16x16x64_bf16 v[36:39], v[68:71], v[144:151], v2
    s_and_b32 s41, s41, 1
    s_xor_b32 s41, s41, 1
    s_xor_b32 s35, s35, 16384
    v_smfmac_f32_16x16x64_bf16 v[36:39], v[72:75], v[152:159], v2
    v_add_f32 v32, v32, v34
    s_xor_b32 s36, s36, 16384
    s_add_u32 s43, s43, 262144
    s_add_u32 s44, s44, 262144
    v_smfmac_f32_16x16x64_bf16 v[40:43], v[68:71], v[160:167], v2
    v_add_f32 v33, v33, v35
    v_smfmac_f32_16x16x64_bf16 v[40:43], v[72:75], v[168:175], v2
    v_cvt_pk_bf16_f32 v32, v32, v33
    v_smfmac_f32_16x16x64_bf16 v[44:47], v[68:71], v[176:183], v2
    v_and_or_b32 v32, v32, -2, s42
    v_smfmac_f32_16x16x64_bf16 v[44:47], v[72:75], v[184:191], v2
    v_add_f32 v36, v36, v38
    v_smfmac_f32_16x16x64_bf16 v[48:51], v[68:71], v[192:199], v2
    v_add_f32 v37, v37, v39
    v_smfmac_f32_16x16x64_bf16 v[48:51], v[72:75], v[200:207], v2
    v_cvt_pk_bf16_f32 v33, v36, v37
    v_smfmac_f32_16x16x64_bf16 v[52:55], v[68:71], v[208:215], v2
    v_add_f32 v40, v40, v42
    v_smfmac_f32_16x16x64_bf16 v[52:55], v[72:75], v[216:223], v2
    v_add_f32 v41, v41, v43
    v_smfmac_f32_16x16x64_bf16 v[56:59], v[68:71], v[224:231], v2
    v_cvt_pk_bf16_f32 v34, v40, v41
    v_smfmac_f32_16x16x64_bf16 v[56:59], v[72:75], v[232:239], v2
    v_add_f32 v44, v44, v46
    v_smfmac_f32_16x16x64_bf16 v[60:63], v[68:71], v[240:247], v2
    v_add_f32 v45, v45, v47
    v_smfmac_f32_16x16x64_bf16 v[60:63], v[72:75], v[248:255], v2
    v_cvt_pk_bf16_f32 v35, v44, v45
    buffer_store_dwordx4 v[32:35], v8, s[4:7], s46 offen
    v_pk_add_f32 v[48:49], v[48:49], v[50:51]
    v_cvt_pk_bf16_f32 v48, v48, v49
    v_and_or_b32 v48, v48, -2, s42
    v_pk_add_f32 v[52:53], v[52:53], v[54:55]
    v_cvt_pk_bf16_f32 v49, v52, v53
    v_pk_add_f32 v[56:57], v[56:57], v[58:59]
    v_cvt_pk_bf16_f32 v50, v56, v57
    v_pk_add_f32 v[60:61], v[60:61], v[62:63]
    v_cvt_pk_bf16_f32 v51, v60, v61
    buffer_store_dwordx4 v[48:51], v8, s[4:7], s61 offen
    s_add_u32 s45, s45, 262144
    s_add_u32 s51, s51, 262144
    v_mfma_f32_32x32x8_bf16 v[96:111], v[14:15], v[14:15], 0
    v_mfma_f32_16x16x16_bf16 v[112:115], v[14:15], v[14:15], 0
    v_mfma_f32_16x16x16_bf16 v[116:119], v[14:15], v[14:15], 0
    ds_read_b128 v[64:67], v1 offset:12288
    ds_read_b128 v[68:71], v1 offset:13312
    ds_read_b128 v[72:75], v1 offset:14336
    ds_read_b128 v[76:79], v1 offset:15360
    ds_read_b128 v[80:83], v1 offset:28672
    ds_read_b128 v[84:87], v1 offset:29696
    ds_read_b128 v[88:91], v1 offset:30720
    ds_read_b128 v[92:95], v1 offset:31744
    s_add_u32 s22, s21, 2
    s_cmp_gt_u32 s50, s22
    s_cbranch_scc1 mega_kernel_rf_w3_kvs
    v_readlane_b32 s50, v12, 0
    v_readlane_b32 s22, v12, 2
    v_readlane_b32 s23, v12, 1
    v_readlane_b32 s24, v12, 3
    s_nop 3
    s_min_u32 s50, s50, s22
    s_min_u32 s23, s23, s24
    s_lshl_b32 s50, s50, 1
    s_lshl_b32 s23, s23, 1
    s_add_u32 s23, s23, 1
    s_min_u32 s50, s50, s23
mega_kernel_rf_kvb1:
    s_add_u32 s22, s21, 1
    s_min_u32 s22, s22, 63
    s_cmp_gt_u32 s50, s22
    s_cbranch_scc1 mega_kernel_rf_kvd1
    buffer_load_dword v12, v7, s[4:7], 0 offen sc1
    s_waitcnt vmcnt(0)
    v_readlane_b32 s50, v12, 0
    v_readlane_b32 s22, v12, 2
    v_readlane_b32 s23, v12, 1
    v_readlane_b32 s24, v12, 3
    s_nop 3
    s_min_u32 s50, s50, s22
    s_min_u32 s23, s23, s24
    s_lshl_b32 s50, s50, 1
    s_lshl_b32 s23, s23, 1
    s_add_u32 s23, s23, 1
    s_min_u32 s50, s50, s23
    s_branch mega_kernel_rf_kvb1
mega_kernel_rf_kvd1:
mega_kernel_rf_w3_kvs:
    v_mov_b32 v58, -1
    v_mov_b32 v59, -1
    s_waitcnt vmcnt(0)
mega_kernel_rf_w3_cgo:
mega_kernel_rf_w3_pc:
    buffer_load_dword v36, v13, s[4:7], s25 offen offset:0 sc1
    buffer_load_dword v37, v13, s[4:7], s25 offen offset:256 sc1
    buffer_load_dword v38, v13, s[4:7], s25 offen offset:512 sc1
    buffer_load_dword v39, v13, s[4:7], s25 offen offset:768 sc1
    buffer_load_dword v40, v13, s[4:7], s25 offen offset:1024 sc1
    buffer_load_dword v41, v13, s[4:7], s25 offen offset:1280 sc1
    buffer_load_dword v42, v13, s[4:7], s25 offen offset:1536 sc1
    buffer_load_dword v43, v13, s[4:7], s25 offen offset:1792 sc1
    s_waitcnt vmcnt(4)
    v_mfma_f32_16x16x32_bf16 v[52:55], v[36:39], v[24:27], 0
    v_bitop3_b32 v3, s42, v36, v37 bitop3:0x7e
    v_bitop3_b32 v4, s42, v38, v39 bitop3:0x7e
    s_waitcnt vmcnt(2)
    v_or_b32 v3, v3, v4
    v_bitop3_b32 v4, s42, v40, v41 bitop3:0x7e
    s_waitcnt vmcnt(0)
    v_mfma_f32_16x16x32_bf16 v[52:55], v[40:43], v[24:27], v[52:55]
    v_bitop3_b32 v56, s42, v42, v43 bitop3:0x7e
    v_or3_b32 v3, v3, v4, v56
    v_and_b32 v3, v0, v3
    v_cmp_ne_u32 vcc, 0, v3
    s_nop 3
    v_cvt_pk_bf16_f32 v56, v52, v53
    v_cvt_pk_bf16_f32 v57, v54, v55
    v_min_u32 v56, -2, v56
    s_cbranch_vccnz mega_kernel_rf_w3_pc
    s_mov_b64 exec, s[26:27]
    buffer_store_dwordx2 v[56:57], v9, s[4:7], s35 offen offset:768
    buffer_store_dwordx2 v[58:59], v9, s[4:7], s36 offen offset:768
    s_mov_b64 exec, -1
    s_xor_b32 s42, s42, 1
    s_branch mega_kernel_rf_w3_loop
mega_kernel_rf_w3_last:
    buffer_store_dwordx4 v[64:67], v10, s[4:7], s45 offen offset:192 sc1
    buffer_store_dwordx2 v[18:19], v11, s[4:7], s51 offen offset:3584 sc1
    s_branch mega_kernel_rf_end
mega_kernel_rf_w3_pafail:
    s_nop 7
    v_mov_b32 v96, 0
    v_mov_b32 v97, 0
    v_mov_b32 v98, 0
    v_mov_b32 v99, 0
    v_mov_b32 v100, 0
    v_mov_b32 v101, 0
    v_mov_b32 v102, 0
    v_mov_b32 v103, 0
    v_mov_b32 v104, 0
    v_mov_b32 v105, 0
    v_mov_b32 v106, 0
    v_mov_b32 v107, 0
    s_branch mega_kernel_rf_w3_pa
mega_kernel_rf_w3_xslow:
    buffer_load_dwordx2 v[108:109], v11, s[4:7], s38 offen sc1
    buffer_load_dwordx2 v[110:111], v11, s[4:7], s38 offen offset:512 sc1
    s_waitcnt vmcnt(2)
    v_bitop3_b32 v3, s41, v20, v22 bitop3:0x7e
    v_mfma_f32_16x16x16_bf16 v[80:83], v[20:21], v[16:17], v[100:103]
    v_and_b32 v3, 1, v3
    v_mfma_f32_16x16x16_bf16 v[84:87], v[22:23], v[16:17], v[104:107]
    v_cmp_ne_u32 vcc, 0, v3
    s_cbranch_vccz mega_kernel_rf_w3_xgot
    buffer_load_dwordx2 v[20:21], v11, s[4:7], s38 offen sc1
    buffer_load_dwordx2 v[22:23], v11, s[4:7], s38 offen offset:512 sc1
    s_waitcnt vmcnt(2)
    v_bitop3_b32 v3, s41, v108, v110 bitop3:0x7e
    v_mfma_f32_16x16x16_bf16 v[80:83], v[108:109], v[16:17], v[100:103]
    v_and_b32 v3, 1, v3
    v_mfma_f32_16x16x16_bf16 v[84:87], v[110:111], v[16:17], v[104:107]
    v_cmp_ne_u32 vcc, 0, v3
    s_cbranch_vccz mega_kernel_rf_w3_xgot
    s_branch mega_kernel_rf_w3_xslow
mega_kernel_rf_w3_xgot:
    s_nop 3
    v_cvt_pk_bf16_f32 v64, v80, v81
    v_cvt_pk_bf16_f32 v65, v82, v83
    v_cvt_pk_bf16_f32 v66, v84, v85
    v_cvt_pk_bf16_f32 v67, v86, v87
    ds_write_b128 v6, v[64:67] offset:23552
    s_branch mega_kernel_rf_w3_xok
mega_kernel_rf_w3_pv0:
    s_waitcnt vmcnt(2)
    s_branch mega_kernel_rf_w3_pv1
mega_kernel_rf_w3_pv:
    buffer_load_dwordx2 v[20:21], v11, s[4:7], s40 offen sc1
    s_waitcnt vmcnt(0)
mega_kernel_rf_w3_pv1:
    v_and_b32 v3, 1, v20
    v_cmp_ne_u32 vcc, s41, v3
    v_mov_b32 v113, v20
    v_mov_b32 v115, v21
    s_cbranch_vccnz mega_kernel_rf_w3_pv
    s_branch mega_kernel_rf_w3_pv2
mega_kernel_rf_end:
    s_mov_b64 exec, -1
    v_mov_b32 v3, 64
    s_waitcnt vmcnt(0)
    s_barrier
    s_cmp_lg_u32 s20, 0
    s_cbranch_scc1 mega_kernel_rf_end2
    buffer_store_dword v3, v7, s[4:7], 0 offen sc1
mega_kernel_rf_end2:
    s_waitcnt vmcnt(0)
    s_endpgm
mega_kernel_recs:
    s_load_dwordx2 s[4:5], s[0:1], 96
    s_load_dwordx2 s[12:13], s[0:1], 88
    s_load_dwordx2 s[50:51], s[0:1], 16
    s_load_dwordx2 s[52:53], s[0:1], 24
    s_load_dwordx2 s[54:55], s[0:1], 32
    s_load_dwordx2 s[56:57], s[0:1], 40
    s_load_dwordx2 s[58:59], s[0:1], 8
    v_lshrrev_b32 v3, 6, v0
    v_and_b32 v40, 63, v0
    v_readfirstlane_b32 s20, v3
    v_lshrrev_b32 v41, 4, v40
    v_and_b32 v42, 15, v40
    v_lshlrev_b32 v1, 4, v40
    s_mov_b32 s49, 0
    s_waitcnt lgkmcnt(0)
    s_mov_b32 s6, 268435456
    s_mov_b32 s7, 0x00020000
    s_mov_b32 s14, 256
    s_mov_b32 s15, 0x00020000
    s_mov_b32 s10, 8388608
    s_mov_b32 s11, 0x00020000
    s_mov_b32 s26, 0x00030003
    s_mov_b32 s27, 0x00030003
    s_mov_b32 s28, 0xcccccccc
    s_mov_b32 s29, 0xcccccccc
    s_mov_b32 s32, 0x33333333
    s_mov_b32 s33, 0x33333333
    s_mov_b32 s34, 0x3e0293ee
    s_lshl_b32 s22, s20, 2
    v_xor_b32 v3, s22, v42
    v_lshlrev_b32 v3, 4, v3
    v_lshl_add_u32 v4, v41, 4, s20
    v_lshl_add_u32 v44, v4, 13, v3
    s_lshl_b32 s22, s30, 22
    s_lshl_b32 s23, s31, 8
    s_add_u32 s22, s22, s23
    v_add_u32 v44, s22, v44
    s_lshr_b32 s22, s20, 1
    s_lshl_b32 s22, s22, 5
    s_and_b32 s23, s20, 1
    s_lshl_b32 s23, s23, 2
    s_add_u32 s22, s22, s23
    s_lshl_b32 s23, s31, 7
    s_add_u32 s22, s22, s23
    v_add_u32 v4, s22, v41
    v_lshl_add_u32 v45, v4, 11, v3
    s_lshl_b32 s22, s30, 10
    v_add_u32 v45, s22, v45
    s_lshl_b32 s48, s20, 10
    s_mov_b32 s8, s50
    s_mov_b32 s9, s51
    s_add_u32 m0, s48, 0
    s_mov_b32 s22, 0
    buffer_load_dwordx4 v44, s[8:11], s22 offen  lds
    s_add_u32 m0, s48, 4096
    s_mov_b32 s22, 32768
    buffer_load_dwordx4 v44, s[8:11], s22 offen  lds
    s_add_u32 m0, s48, 8192
    s_mov_b32 s22, 65536
    buffer_load_dwordx4 v44, s[8:11], s22 offen  lds
    s_add_u32 m0, s48, 12288
    s_mov_b32 s22, 98304
    buffer_load_dwordx4 v44, s[8:11], s22 offen  lds
    s_add_u32 m0, s48, 16384
    s_mov_b32 s22, 524288
    buffer_load_dwordx4 v44, s[8:11], s22 offen  lds
    s_add_u32 m0, s48, 20480
    s_mov_b32 s22, 557056
    buffer_load_dwordx4 v44, s[8:11], s22 offen  lds
    s_add_u32 m0, s48, 24576
    s_mov_b32 s22, 589824
    buffer_load_dwordx4 v44, s[8:11], s22 offen  lds
    s_add_u32 m0, s48, 28672
    s_mov_b32 s22, 622592
    buffer_load_dwordx4 v44, s[8:11], s22 offen  lds
    s_add_u32 m0, s48, 32768
    s_mov_b32 s22, 1048576
    buffer_load_dwordx4 v44, s[8:11], s22 offen  lds
    s_add_u32 m0, s48, 36864
    s_mov_b32 s22, 1081344
    buffer_load_dwordx4 v44, s[8:11], s22 offen  lds
    s_add_u32 m0, s48, 40960
    s_mov_b32 s22, 1114112
    buffer_load_dwordx4 v44, s[8:11], s22 offen  lds
    s_add_u32 m0, s48, 45056
    s_mov_b32 s22, 1146880
    buffer_load_dwordx4 v44, s[8:11], s22 offen  lds
    s_add_u32 m0, s48, 49152
    s_mov_b32 s22, 1572864
    buffer_load_dwordx4 v44, s[8:11], s22 offen  lds
    s_add_u32 m0, s48, 53248
    s_mov_b32 s22, 1605632
    buffer_load_dwordx4 v44, s[8:11], s22 offen  lds
    s_add_u32 m0, s48, 57344
    s_mov_b32 s22, 1638400
    buffer_load_dwordx4 v44, s[8:11], s22 offen  lds
    s_add_u32 m0, s48, 61440
    s_mov_b32 s22, 1671168
    buffer_load_dwordx4 v44, s[8:11], s22 offen  lds
    s_add_u32 m0, s48, 65536
    s_mov_b32 s22, 2097152
    buffer_load_dwordx4 v44, s[8:11], s22 offen  lds
    s_add_u32 m0, s48, 69632
    s_mov_b32 s22, 2129920
    buffer_load_dwordx4 v44, s[8:11], s22 offen  lds
    s_add_u32 m0, s48, 73728
    s_mov_b32 s22, 2162688
    buffer_load_dwordx4 v44, s[8:11], s22 offen  lds
    s_add_u32 m0, s48, 77824
    s_mov_b32 s22, 2195456
    buffer_load_dwordx4 v44, s[8:11], s22 offen  lds
    s_add_u32 m0, s48, 81920
    s_mov_b32 s22, 2621440
    buffer_load_dwordx4 v44, s[8:11], s22 offen  lds
    s_add_u32 m0, s48, 86016
    s_mov_b32 s22, 2654208
    buffer_load_dwordx4 v44, s[8:11], s22 offen  lds
    s_add_u32 m0, s48, 90112
    s_mov_b32 s22, 2686976
    buffer_load_dwordx4 v44, s[8:11], s22 offen  lds
    s_add_u32 m0, s48, 94208
    s_mov_b32 s22, 2719744
    buffer_load_dwordx4 v44, s[8:11], s22 offen  lds
    s_add_u32 m0, s48, 98304
    s_mov_b32 s22, 3145728
    buffer_load_dwordx4 v44, s[8:11], s22 offen  lds
    s_add_u32 m0, s48, 102400
    s_mov_b32 s22, 3178496
    buffer_load_dwordx4 v44, s[8:11], s22 offen  lds
    s_add_u32 m0, s48, 106496
    s_mov_b32 s22, 3211264
    buffer_load_dwordx4 v44, s[8:11], s22 offen  lds
    s_add_u32 m0, s48, 110592
    s_mov_b32 s22, 3244032
    buffer_load_dwordx4 v44, s[8:11], s22 offen  lds
    s_add_u32 m0, s48, 114688
    s_mov_b32 s22, 3670016
    buffer_load_dwordx4 v44, s[8:11], s22 offen  lds
    s_add_u32 m0, s48, 118784
    s_mov_b32 s22, 3702784
    buffer_load_dwordx4 v44, s[8:11], s22 offen  lds
    s_add_u32 m0, s48, 122880
    s_mov_b32 s22, 3735552
    buffer_load_dwordx4 v44, s[8:11], s22 offen  lds
    s_add_u32 m0, s48, 126976
    s_mov_b32 s22, 3768320
    buffer_load_dwordx4 v44, s[8:11], s22 offen  lds
    s_lshl_b32 s22, s30, 5
    s_add_u32 s22, s22, s31
    s_lshl_b32 s38, s22, 14
    s_xor_b32 s22, s22, 32
    s_lshl_b32 s37, s22, 14
    s_add_u32 s38, s38, 67108864
    s_add_u32 s37, s37, 67108864
    s_lshl_b32 s46, s30, 19
    s_add_u32 s46, s46, 70254592
    s_mul_i32 s22, s31, 8448
    s_add_u32 s47, s46, s22
    s_mul_i32 s22, s20, 67584
    s_add_u32 s46, s46, s22
    s_lshl_b32 s22, s31, 6
    s_add_u32 s46, s46, s22
    s_add_u32 s61, s46, 33792
    s_mul_i32 s22, s20, 2048
    s_add_u32 s25, s47, s22
    s_lshl_b32 s35, s30, 13
    s_add_u32 s35, s35, 69206016
    v_lshrrev_b32 v53, 2, v42
    v_lshlrev_b32 v53, 1, v53
    v_and_b32 v54, 1, v42
    v_add_u32 v55, v53, v54
    v_mov_b32 v14, 0
    v_mov_b32 v15, 0
    v_mov_b32 v2, 0x4444
    v_mov_b32 v3, 0xeeee
    v_cndmask_b32 v2, v2, v3, s[28:29]
    s_lshl_b32 s22, s20, 12
    v_add_u32 v32, s22, v1
    v_add_u32 v33, 0x10000, v32
    v_add_u32 v5, 0x10000, v1
    v_add_u32 v6, 131072, v1
    v_and_b32 v3, 3, v42
    v_bfe_u32 v43, v40, 1, 1
    v_lshlrev_b32 v7, 13, v43
    v_and_b32 v43, 1, v40
    v_lshl_add_u32 v7, v43, 7, v7
    s_lshl_b32 s22, s31, 8
    s_add_u32 s23, s22, 71311360
    v_add_u32 v7, s23, v7
    s_cmp_lg_u32 s20, 0
    s_cbranch_scc1 mega_kernel_rs_flk
    s_lshl_b32 s23, s30, 7
    s_add_u32 s22, s22, s23
    s_add_u32 s22, s22, 71327744
    v_bfrev_b32 v7, 1
    v_writelane_b32 v7, s22, 0
mega_kernel_rs_flk:
    v_lshlrev_b32 v11, 3, v40
    v_lshlrev_b32 v10, 8, v55
    v_lshl_add_u32 v10, v41, 4, v10
    v_mul_u32_u24 v8, 8448, v41
    v_lshl_add_u32 v8, v3, 4, v8
    v_lshrrev_b32 v4, 2, v42
    v_mul_u32_u24 v4, 2048, v4
    v_add_u32 v8, v4, v8
    v_lshrrev_b32 v9, 1, v41
    v_lshlrev_b32 v9, 5, v9
    v_and_b32 v4, 1, v42
    v_lshl_add_u32 v9, v4, 4, v9
    v_and_b32 v4, 1, v41
    v_lshl_add_u32 v9, v4, 3, v9
    s_lshr_b32 s22, s31, 2
    s_lshl_b32 s22, s22, 10
    s_and_b32 s23, s31, 3
    s_lshl_b32 s23, s23, 6
    s_add_u32 s22, s22, s23
    v_add_u32 v9, s22, v9
    v_lshrrev_b32 v4, 2, v42
    v_lshlrev_b32 v12, 8, v4
    v_lshl_add_u32 v12, v41, 6, v12
    v_lshl_add_u32 v12, v3, 4, v12
    v_lshlrev_b32 v13, 6, v41
    v_lshl_add_u32 v13, v42, 2, v13
    v_cmp_eq_u32 vcc, 0, v3
    v_mov_b32 v28, 0x3f803f80
    v_mov_b32 v29, 0x3f803f80
    v_cndmask_b32 v34, 0, 1, vcc
    v_mov_b32 v30, 0x3f803f80
    v_mov_b32 v31, 0x3f803f80
    v_and_b32 v49, 1, v42
    v_lshlrev_b32 v49, 4, v49
    v_mov_b32 v50, 0x3f80
    v_lshlrev_b32 v50, v49, v50
    v_lshrrev_b32 v51, 2, v42
    v_cmp_eq_u32 vcc, v51, v41
    v_mov_b32 v24, v50
    v_cndmask_b32 v52, 0, v50, s[28:29]
    v_cndmask_b32 v53, 0, v50, s[32:33]
    v_cndmask_b32 v16, 0, v52, vcc
    v_cndmask_b32 v17, 0, v53, vcc
    v_mov_b32 v25, v50
    v_mov_b32 v26, v50
    v_mov_b32 v27, v50
    v_bfe_u32 v60, v40, 3, 1
    v_bfe_u32 v49, v40, 2, 1
    v_and_b32 v50, 1, v41
    v_lshrrev_b32 v51, 1, v41
    v_lshlrev_b32 v52, 3, v60
    v_lshl_add_u32 v52, v50, 2, v52
    v_lshl_add_u32 v53, v51, 4, v52
    v_add_u32 v53, v53, v49
    v_and_b32 v54, 3, v40
    s_lshl_b32 s22, s20, 2
    v_add_u32 v55, s22, v54
    v_xor_b32 v55, v55, v52
    v_lshlrev_b32 v55, 4, v55
    v_lshl_add_u32 v46, v53, 8, v55
    v_lshlrev_b32 v55, 4, v52
    v_lshl_add_u32 v55, v54, 3, v55
    v_lshl_add_u32 v47, v53, 8, v55
    s_waitcnt vmcnt(28)
    s_barrier
    v_add_u32 v48, 0, v46
    ds_read_b64_tr_b16 a[0:1], v48 offset:0
    ds_read_b64_tr_b16 a[2:3], v48 offset:512
    ds_read_b64_tr_b16 a[4:5], v48 offset:8192
    ds_read_b64_tr_b16 a[6:7], v48 offset:8704
    ds_read_b64_tr_b16 a[8:9], v48 offset:8
    ds_read_b64_tr_b16 a[10:11], v48 offset:520
    ds_read_b64_tr_b16 a[12:13], v48 offset:8200
    ds_read_b64_tr_b16 a[14:15], v48 offset:8712
    s_waitcnt lgkmcnt(0)
    s_barrier
    s_mov_b32 s8, s52
    s_mov_b32 s9, s53
    s_add_u32 m0, s48, 0
    s_mov_b32 s22, 0
    buffer_load_dwordx4 v44, s[8:11], s22 offen  lds
    s_add_u32 m0, s48, 4096
    s_mov_b32 s22, 32768
    buffer_load_dwordx4 v44, s[8:11], s22 offen  lds
    s_add_u32 m0, s48, 8192
    s_mov_b32 s22, 65536
    buffer_load_dwordx4 v44, s[8:11], s22 offen  lds
    s_add_u32 m0, s48, 12288
    s_mov_b32 s22, 98304
    buffer_load_dwordx4 v44, s[8:11], s22 offen  lds
    s_waitcnt vmcnt(28)
    s_barrier
    v_add_u32 v48, 16384, v46
    ds_read_b64_tr_b16 a[16:17], v48 offset:0
    ds_read_b64_tr_b16 a[18:19], v48 offset:512
    ds_read_b64_tr_b16 a[20:21], v48 offset:8192
    ds_read_b64_tr_b16 a[22:23], v48 offset:8704
    ds_read_b64_tr_b16 a[24:25], v48 offset:8
    ds_read_b64_tr_b16 a[26:27], v48 offset:520
    ds_read_b64_tr_b16 a[28:29], v48 offset:8200
    ds_read_b64_tr_b16 a[30:31], v48 offset:8712
    s_waitcnt lgkmcnt(0)
    s_barrier
    s_add_u32 m0, s48, 16384
    s_mov_b32 s22, 524288
    buffer_load_dwordx4 v44, s[8:11], s22 offen  lds
    s_add_u32 m0, s48, 20480
    s_mov_b32 s22, 557056
    buffer_load_dwordx4 v44, s[8:11], s22 offen  lds
    s_add_u32 m0, s48, 24576
    s_mov_b32 s22, 589824
    buffer_load_dwordx4 v44, s[8:11], s22 offen  lds
    s_add_u32 m0, s48, 28672
    s_mov_b32 s22, 622592
    buffer_load_dwordx4 v44, s[8:11], s22 offen  lds
    s_waitcnt vmcnt(28)
    s_barrier
    v_add_u32 v48, 32768, v46
    ds_read_b64_tr_b16 a[32:33], v48 offset:0
    ds_read_b64_tr_b16 a[34:35], v48 offset:512
    ds_read_b64_tr_b16 a[36:37], v48 offset:8192
    ds_read_b64_tr_b16 a[38:39], v48 offset:8704
    ds_read_b64_tr_b16 a[40:41], v48 offset:8
    ds_read_b64_tr_b16 a[42:43], v48 offset:520
    ds_read_b64_tr_b16 a[44:45], v48 offset:8200
    ds_read_b64_tr_b16 a[46:47], v48 offset:8712
    s_waitcnt lgkmcnt(0)
    s_barrier
    s_add_u32 m0, s48, 32768
    s_mov_b32 s22, 1048576
    buffer_load_dwordx4 v44, s[8:11], s22 offen  lds
    s_add_u32 m0, s48, 36864
    s_mov_b32 s22, 1081344
    buffer_load_dwordx4 v44, s[8:11], s22 offen  lds
    s_add_u32 m0, s48, 40960
    s_mov_b32 s22, 1114112
    buffer_load_dwordx4 v44, s[8:11], s22 offen  lds
    s_add_u32 m0, s48, 45056
    s_mov_b32 s22, 1146880
    buffer_load_dwordx4 v44, s[8:11], s22 offen  lds
    s_waitcnt vmcnt(28)
    s_barrier
    v_add_u32 v48, 49152, v46
    ds_read_b64_tr_b16 a[48:49], v48 offset:0
    ds_read_b64_tr_b16 a[50:51], v48 offset:512
    ds_read_b64_tr_b16 a[52:53], v48 offset:8192
    ds_read_b64_tr_b16 a[54:55], v48 offset:8704
    ds_read_b64_tr_b16 a[56:57], v48 offset:8
    ds_read_b64_tr_b16 a[58:59], v48 offset:520
    ds_read_b64_tr_b16 a[60:61], v48 offset:8200
    ds_read_b64_tr_b16 a[62:63], v48 offset:8712
    s_waitcnt lgkmcnt(0)
    s_barrier
    s_add_u32 m0, s48, 49152
    s_mov_b32 s22, 1572864
    buffer_load_dwordx4 v44, s[8:11], s22 offen  lds
    s_add_u32 m0, s48, 53248
    s_mov_b32 s22, 1605632
    buffer_load_dwordx4 v44, s[8:11], s22 offen  lds
    s_add_u32 m0, s48, 57344
    s_mov_b32 s22, 1638400
    buffer_load_dwordx4 v44, s[8:11], s22 offen  lds
    s_add_u32 m0, s48, 61440
    s_mov_b32 s22, 1671168
    buffer_load_dwordx4 v44, s[8:11], s22 offen  lds
    s_waitcnt vmcnt(28)
    s_barrier
    v_add_u32 v48, 65536, v46
    ds_read_b64_tr_b16 a[64:65], v48 offset:0
    ds_read_b64_tr_b16 a[66:67], v48 offset:512
    ds_read_b64_tr_b16 a[68:69], v48 offset:8192
    ds_read_b64_tr_b16 a[70:71], v48 offset:8704
    ds_read_b64_tr_b16 a[72:73], v48 offset:8
    ds_read_b64_tr_b16 a[74:75], v48 offset:520
    ds_read_b64_tr_b16 a[76:77], v48 offset:8200
    ds_read_b64_tr_b16 a[78:79], v48 offset:8712
    s_waitcnt lgkmcnt(0)
    s_barrier
    s_add_u32 m0, s48, 65536
    s_mov_b32 s22, 2097152
    buffer_load_dwordx4 v44, s[8:11], s22 offen  lds
    s_add_u32 m0, s48, 69632
    s_mov_b32 s22, 2129920
    buffer_load_dwordx4 v44, s[8:11], s22 offen  lds
    s_add_u32 m0, s48, 73728
    s_mov_b32 s22, 2162688
    buffer_load_dwordx4 v44, s[8:11], s22 offen  lds
    s_add_u32 m0, s48, 77824
    s_mov_b32 s22, 2195456
    buffer_load_dwordx4 v44, s[8:11], s22 offen  lds
    s_waitcnt vmcnt(28)
    s_barrier
    v_add_u32 v48, 81920, v46
    ds_read_b64_tr_b16 a[80:81], v48 offset:0
    ds_read_b64_tr_b16 a[82:83], v48 offset:512
    ds_read_b64_tr_b16 a[84:85], v48 offset:8192
    ds_read_b64_tr_b16 a[86:87], v48 offset:8704
    ds_read_b64_tr_b16 a[88:89], v48 offset:8
    ds_read_b64_tr_b16 a[90:91], v48 offset:520
    ds_read_b64_tr_b16 a[92:93], v48 offset:8200
    ds_read_b64_tr_b16 a[94:95], v48 offset:8712
    s_waitcnt lgkmcnt(0)
    s_barrier
    s_add_u32 m0, s48, 81920
    s_mov_b32 s22, 2621440
    buffer_load_dwordx4 v44, s[8:11], s22 offen  lds
    s_add_u32 m0, s48, 86016
    s_mov_b32 s22, 2654208
    buffer_load_dwordx4 v44, s[8:11], s22 offen  lds
    s_add_u32 m0, s48, 90112
    s_mov_b32 s22, 2686976
    buffer_load_dwordx4 v44, s[8:11], s22 offen  lds
    s_add_u32 m0, s48, 94208
    s_mov_b32 s22, 2719744
    buffer_load_dwordx4 v44, s[8:11], s22 offen  lds
    s_waitcnt vmcnt(28)
    s_barrier
    v_add_u32 v48, 98304, v46
    ds_read_b64_tr_b16 a[96:97], v48 offset:0
    ds_read_b64_tr_b16 a[98:99], v48 offset:512
    ds_read_b64_tr_b16 a[100:101], v48 offset:8192
    ds_read_b64_tr_b16 a[102:103], v48 offset:8704
    ds_read_b64_tr_b16 a[104:105], v48 offset:8
    ds_read_b64_tr_b16 a[106:107], v48 offset:520
    ds_read_b64_tr_b16 a[108:109], v48 offset:8200
    ds_read_b64_tr_b16 a[110:111], v48 offset:8712
    s_waitcnt lgkmcnt(0)
    s_barrier
    s_add_u32 m0, s48, 98304
    s_mov_b32 s22, 3145728
    buffer_load_dwordx4 v44, s[8:11], s22 offen  lds
    s_add_u32 m0, s48, 102400
    s_mov_b32 s22, 3178496
    buffer_load_dwordx4 v44, s[8:11], s22 offen  lds
    s_add_u32 m0, s48, 106496
    s_mov_b32 s22, 3211264
    buffer_load_dwordx4 v44, s[8:11], s22 offen  lds
    s_add_u32 m0, s48, 110592
    s_mov_b32 s22, 3244032
    buffer_load_dwordx4 v44, s[8:11], s22 offen  lds
    s_waitcnt vmcnt(28)
    s_barrier
    v_add_u32 v48, 114688, v46
    ds_read_b64_tr_b16 a[112:113], v48 offset:0
    ds_read_b64_tr_b16 a[114:115], v48 offset:512
    ds_read_b64_tr_b16 a[116:117], v48 offset:8192
    ds_read_b64_tr_b16 a[118:119], v48 offset:8704
    ds_read_b64_tr_b16 a[120:121], v48 offset:8
    ds_read_b64_tr_b16 a[122:123], v48 offset:520
    ds_read_b64_tr_b16 a[124:125], v48 offset:8200
    ds_read_b64_tr_b16 a[126:127], v48 offset:8712
    s_waitcnt lgkmcnt(0)
    s_barrier
    s_add_u32 m0, s48, 114688
    s_mov_b32 s22, 3670016
    buffer_load_dwordx4 v44, s[8:11], s22 offen  lds
    s_add_u32 m0, s48, 118784
    s_mov_b32 s22, 3702784
    buffer_load_dwordx4 v44, s[8:11], s22 offen  lds
    s_add_u32 m0, s48, 122880
    s_mov_b32 s22, 3735552
    buffer_load_dwordx4 v44, s[8:11], s22 offen  lds
    s_add_u32 m0, s48, 126976
    s_mov_b32 s22, 3768320
    buffer_load_dwordx4 v44, s[8:11], s22 offen  lds
    s_waitcnt vmcnt(28)
    s_barrier
    v_add_u32 v48, 0, v46
    ds_read_b64_tr_b16 a[128:129], v48 offset:0
    ds_read_b64_tr_b16 a[130:131], v48 offset:512
    ds_read_b64_tr_b16 a[132:133], v48 offset:8192
    ds_read_b64_tr_b16 a[134:135], v48 offset:8704
    ds_read_b64_tr_b16 a[136:137], v48 offset:8
    ds_read_b64_tr_b16 a[138:139], v48 offset:520
    ds_read_b64_tr_b16 a[140:141], v48 offset:8200
    ds_read_b64_tr_b16 a[142:143], v48 offset:8712
    s_waitcnt lgkmcnt(0)
    s_barrier
    s_mov_b32 s8, s56
    s_mov_b32 s9, s57
    s_add_u32 m0, s48, 0
    s_mov_b32 s22, 0
    buffer_load_dwordx4 v45, s[8:11], s22 offen  lds
    s_add_u32 m0, s48, 4096
    s_mov_b32 s22, 16384
    buffer_load_dwordx4 v45, s[8:11], s22 offen  lds
    s_add_u32 m0, s48, 8192
    s_mov_b32 s22, 32768
    buffer_load_dwordx4 v45, s[8:11], s22 offen  lds
    s_add_u32 m0, s48, 12288
    s_mov_b32 s22, 49152
    buffer_load_dwordx4 v45, s[8:11], s22 offen  lds
    s_waitcnt vmcnt(28)
    s_barrier
    v_add_u32 v48, 16384, v46
    ds_read_b64_tr_b16 a[144:145], v48 offset:0
    ds_read_b64_tr_b16 a[146:147], v48 offset:512
    ds_read_b64_tr_b16 a[148:149], v48 offset:8192
    ds_read_b64_tr_b16 a[150:151], v48 offset:8704
    ds_read_b64_tr_b16 a[152:153], v48 offset:8
    ds_read_b64_tr_b16 a[154:155], v48 offset:520
    ds_read_b64_tr_b16 a[156:157], v48 offset:8200
    ds_read_b64_tr_b16 a[158:159], v48 offset:8712
    s_waitcnt lgkmcnt(0)
    s_barrier
    s_add_u32 m0, s48, 16384
    s_mov_b32 s22, 256
    buffer_load_dwordx4 v45, s[8:11], s22 offen  lds
    s_add_u32 m0, s48, 20480
    s_mov_b32 s22, 16640
    buffer_load_dwordx4 v45, s[8:11], s22 offen  lds
    s_add_u32 m0, s48, 24576
    s_mov_b32 s22, 33024
    buffer_load_dwordx4 v45, s[8:11], s22 offen  lds
    s_add_u32 m0, s48, 28672
    s_mov_b32 s22, 49408
    buffer_load_dwordx4 v45, s[8:11], s22 offen  lds
    s_waitcnt vmcnt(28)
    s_barrier
    v_add_u32 v48, 32768, v46
    ds_read_b64_tr_b16 a[160:161], v48 offset:0
    ds_read_b64_tr_b16 a[162:163], v48 offset:512
    ds_read_b64_tr_b16 a[164:165], v48 offset:8192
    ds_read_b64_tr_b16 a[166:167], v48 offset:8704
    ds_read_b64_tr_b16 a[168:169], v48 offset:8
    ds_read_b64_tr_b16 a[170:171], v48 offset:520
    ds_read_b64_tr_b16 a[172:173], v48 offset:8200
    ds_read_b64_tr_b16 a[174:175], v48 offset:8712
    s_waitcnt lgkmcnt(0)
    s_barrier
    s_add_u32 m0, s48, 32768
    s_mov_b32 s22, 512
    buffer_load_dwordx4 v45, s[8:11], s22 offen  lds
    s_add_u32 m0, s48, 36864
    s_mov_b32 s22, 16896
    buffer_load_dwordx4 v45, s[8:11], s22 offen  lds
    s_add_u32 m0, s48, 40960
    s_mov_b32 s22, 33280
    buffer_load_dwordx4 v45, s[8:11], s22 offen  lds
    s_add_u32 m0, s48, 45056
    s_mov_b32 s22, 49664
    buffer_load_dwordx4 v45, s[8:11], s22 offen  lds
    s_waitcnt vmcnt(28)
    s_barrier
    v_add_u32 v48, 49152, v46
    ds_read_b64_tr_b16 a[176:177], v48 offset:0
    ds_read_b64_tr_b16 a[178:179], v48 offset:512
    ds_read_b64_tr_b16 a[180:181], v48 offset:8192
    ds_read_b64_tr_b16 a[182:183], v48 offset:8704
    ds_read_b64_tr_b16 a[184:185], v48 offset:8
    ds_read_b64_tr_b16 a[186:187], v48 offset:520
    ds_read_b64_tr_b16 a[188:189], v48 offset:8200
    ds_read_b64_tr_b16 a[190:191], v48 offset:8712
    s_waitcnt lgkmcnt(0)
    s_barrier
    s_add_u32 m0, s48, 49152
    s_mov_b32 s22, 768
    buffer_load_dwordx4 v45, s[8:11], s22 offen  lds
    s_add_u32 m0, s48, 53248
    s_mov_b32 s22, 17152
    buffer_load_dwordx4 v45, s[8:11], s22 offen  lds
    s_add_u32 m0, s48, 57344
    s_mov_b32 s22, 33536
    buffer_load_dwordx4 v45, s[8:11], s22 offen  lds
    s_add_u32 m0, s48, 61440
    s_mov_b32 s22, 49920
    buffer_load_dwordx4 v45, s[8:11], s22 offen  lds
    s_waitcnt vmcnt(28)
    s_barrier
    v_add_u32 v48, 65536, v46
    ds_read_b64_tr_b16 a[192:193], v48 offset:0
    ds_read_b64_tr_b16 a[194:195], v48 offset:512
    ds_read_b64_tr_b16 a[196:197], v48 offset:8192
    ds_read_b64_tr_b16 a[198:199], v48 offset:8704
    ds_read_b64_tr_b16 a[200:201], v48 offset:8
    ds_read_b64_tr_b16 a[202:203], v48 offset:520
    ds_read_b64_tr_b16 a[204:205], v48 offset:8200
    ds_read_b64_tr_b16 a[206:207], v48 offset:8712
    s_waitcnt lgkmcnt(0)
    s_barrier
    s_add_u32 m0, s48, 65536
    s_mov_b32 s22, 131072
    buffer_load_dwordx4 v45, s[8:11], s22 offen  lds
    s_add_u32 m0, s48, 69632
    s_mov_b32 s22, 147456
    buffer_load_dwordx4 v45, s[8:11], s22 offen  lds
    s_add_u32 m0, s48, 73728
    s_mov_b32 s22, 163840
    buffer_load_dwordx4 v45, s[8:11], s22 offen  lds
    s_add_u32 m0, s48, 77824
    s_mov_b32 s22, 180224
    buffer_load_dwordx4 v45, s[8:11], s22 offen  lds
    s_waitcnt vmcnt(28)
    s_barrier
    v_add_u32 v48, 81920, v46
    ds_read_b64_tr_b16 a[208:209], v48 offset:0
    ds_read_b64_tr_b16 a[210:211], v48 offset:512
    ds_read_b64_tr_b16 a[212:213], v48 offset:8192
    ds_read_b64_tr_b16 a[214:215], v48 offset:8704
    ds_read_b64_tr_b16 a[216:217], v48 offset:8
    ds_read_b64_tr_b16 a[218:219], v48 offset:520
    ds_read_b64_tr_b16 a[220:221], v48 offset:8200
    ds_read_b64_tr_b16 a[222:223], v48 offset:8712
    s_waitcnt lgkmcnt(0)
    s_barrier
    s_add_u32 m0, s48, 81920
    s_mov_b32 s22, 131328
    buffer_load_dwordx4 v45, s[8:11], s22 offen  lds
    s_add_u32 m0, s48, 86016
    s_mov_b32 s22, 147712
    buffer_load_dwordx4 v45, s[8:11], s22 offen  lds
    s_add_u32 m0, s48, 90112
    s_mov_b32 s22, 164096
    buffer_load_dwordx4 v45, s[8:11], s22 offen  lds
    s_add_u32 m0, s48, 94208
    s_mov_b32 s22, 180480
    buffer_load_dwordx4 v45, s[8:11], s22 offen  lds
    s_waitcnt vmcnt(28)
    s_barrier
    v_add_u32 v48, 98304, v46
    ds_read_b64_tr_b16 a[224:225], v48 offset:0
    ds_read_b64_tr_b16 a[226:227], v48 offset:512
    ds_read_b64_tr_b16 a[228:229], v48 offset:8192
    ds_read_b64_tr_b16 a[230:231], v48 offset:8704
    ds_read_b64_tr_b16 a[232:233], v48 offset:8
    ds_read_b64_tr_b16 a[234:235], v48 offset:520
    ds_read_b64_tr_b16 a[236:237], v48 offset:8200
    ds_read_b64_tr_b16 a[238:239], v48 offset:8712
    s_waitcnt lgkmcnt(0)
    s_barrier
    s_add_u32 m0, s48, 98304
    s_mov_b32 s22, 131584
    buffer_load_dwordx4 v45, s[8:11], s22 offen  lds
    s_add_u32 m0, s48, 102400
    s_mov_b32 s22, 147968
    buffer_load_dwordx4 v45, s[8:11], s22 offen  lds
    s_add_u32 m0, s48, 106496
    s_mov_b32 s22, 164352
    buffer_load_dwordx4 v45, s[8:11], s22 offen  lds
    s_add_u32 m0, s48, 110592
    s_mov_b32 s22, 180736
    buffer_load_dwordx4 v45, s[8:11], s22 offen  lds
    s_waitcnt vmcnt(28)
    s_barrier
    v_add_u32 v48, 114688, v46
    ds_read_b64_tr_b16 a[240:241], v48 offset:0
    ds_read_b64_tr_b16 a[242:243], v48 offset:512
    ds_read_b64_tr_b16 a[244:245], v48 offset:8192
    ds_read_b64_tr_b16 a[246:247], v48 offset:8704
    ds_read_b64_tr_b16 a[248:249], v48 offset:8
    ds_read_b64_tr_b16 a[250:251], v48 offset:520
    ds_read_b64_tr_b16 a[252:253], v48 offset:8200
    ds_read_b64_tr_b16 a[254:255], v48 offset:8712
    s_waitcnt lgkmcnt(0)
    s_barrier
    s_add_u32 m0, s48, 114688
    s_mov_b32 s22, 131840
    buffer_load_dwordx4 v45, s[8:11], s22 offen  lds
    s_add_u32 m0, s48, 118784
    s_mov_b32 s22, 148224
    buffer_load_dwordx4 v45, s[8:11], s22 offen  lds
    s_add_u32 m0, s48, 122880
    s_mov_b32 s22, 164608
    buffer_load_dwordx4 v45, s[8:11], s22 offen  lds
    s_add_u32 m0, s48, 126976
    s_mov_b32 s22, 180992
    buffer_load_dwordx4 v45, s[8:11], s22 offen  lds
    s_waitcnt vmcnt(28)
    s_barrier
    s_cmp_lg_u32 s20, 0
    s_cbranch_scc1 mega_kernel_rs_wo0
    v_xor_b32 v48, 0, v47
    v_add_u32 v48, 0, v48
    ds_read_b64_tr_b16 v[128:129], v48 offset:0
    ds_read_b64_tr_b16 v[130:131], v48 offset:512
    ds_read_b64_tr_b16 v[132:133], v48 offset:8192
    ds_read_b64_tr_b16 v[134:135], v48 offset:8704
    ds_read_b64_tr_b16 v[144:145], v48 offset:32
    ds_read_b64_tr_b16 v[146:147], v48 offset:544
    ds_read_b64_tr_b16 v[148:149], v48 offset:8224
    ds_read_b64_tr_b16 v[150:151], v48 offset:8736
    s_waitcnt lgkmcnt(0)
    v_xor_b32 v48, 64, v47
    v_add_u32 v48, 0, v48
    ds_read_b64_tr_b16 v[160:161], v48 offset:0
    ds_read_b64_tr_b16 v[162:163], v48 offset:512
    ds_read_b64_tr_b16 v[164:165], v48 offset:8192
    ds_read_b64_tr_b16 v[166:167], v48 offset:8704
    ds_read_b64_tr_b16 v[176:177], v48 offset:32
    ds_read_b64_tr_b16 v[178:179], v48 offset:544
    ds_read_b64_tr_b16 v[180:181], v48 offset:8224
    ds_read_b64_tr_b16 v[182:183], v48 offset:8736
    s_waitcnt lgkmcnt(0)
    v_xor_b32 v48, 128, v47
    v_add_u32 v48, 0, v48
    ds_read_b64_tr_b16 v[192:193], v48 offset:0
    ds_read_b64_tr_b16 v[194:195], v48 offset:512
    ds_read_b64_tr_b16 v[196:197], v48 offset:8192
    ds_read_b64_tr_b16 v[198:199], v48 offset:8704
    ds_read_b64_tr_b16 v[208:209], v48 offset:32
    ds_read_b64_tr_b16 v[210:211], v48 offset:544
    ds_read_b64_tr_b16 v[212:213], v48 offset:8224
    ds_read_b64_tr_b16 v[214:215], v48 offset:8736
    s_waitcnt lgkmcnt(0)
    v_xor_b32 v48, 192, v47
    v_add_u32 v48, 0, v48
    ds_read_b64_tr_b16 v[224:225], v48 offset:0
    ds_read_b64_tr_b16 v[226:227], v48 offset:512
    ds_read_b64_tr_b16 v[228:229], v48 offset:8192
    ds_read_b64_tr_b16 v[230:231], v48 offset:8704
    ds_read_b64_tr_b16 v[240:241], v48 offset:32
    ds_read_b64_tr_b16 v[242:243], v48 offset:544
    ds_read_b64_tr_b16 v[244:245], v48 offset:8224
    ds_read_b64_tr_b16 v[246:247], v48 offset:8736
    s_waitcnt lgkmcnt(0)
mega_kernel_rs_wo0:
    s_barrier
    s_mov_b32 s8, s54
    s_mov_b32 s9, s55
    s_add_u32 m0, s48, 0
    s_mov_b32 s22, 0
    buffer_load_dwordx4 v44, s[8:11], s22 offen  lds
    s_add_u32 m0, s48, 4096
    s_mov_b32 s22, 32768
    buffer_load_dwordx4 v44, s[8:11], s22 offen  lds
    s_add_u32 m0, s48, 8192
    s_mov_b32 s22, 65536
    buffer_load_dwordx4 v44, s[8:11], s22 offen  lds
    s_add_u32 m0, s48, 12288
    s_mov_b32 s22, 98304
    buffer_load_dwordx4 v44, s[8:11], s22 offen  lds
    s_waitcnt vmcnt(28)
    s_barrier
    s_cmp_lg_u32 s20, 1
    s_cbranch_scc1 mega_kernel_rs_wo1
    v_xor_b32 v48, 0, v47
    v_add_u32 v48, 16384, v48
    ds_read_b64_tr_b16 v[128:129], v48 offset:0
    ds_read_b64_tr_b16 v[130:131], v48 offset:512
    ds_read_b64_tr_b16 v[132:133], v48 offset:8192
    ds_read_b64_tr_b16 v[134:135], v48 offset:8704
    ds_read_b64_tr_b16 v[144:145], v48 offset:32
    ds_read_b64_tr_b16 v[146:147], v48 offset:544
    ds_read_b64_tr_b16 v[148:149], v48 offset:8224
    ds_read_b64_tr_b16 v[150:151], v48 offset:8736
    s_waitcnt lgkmcnt(0)
    v_xor_b32 v48, 64, v47
    v_add_u32 v48, 16384, v48
    ds_read_b64_tr_b16 v[160:161], v48 offset:0
    ds_read_b64_tr_b16 v[162:163], v48 offset:512
    ds_read_b64_tr_b16 v[164:165], v48 offset:8192
    ds_read_b64_tr_b16 v[166:167], v48 offset:8704
    ds_read_b64_tr_b16 v[176:177], v48 offset:32
    ds_read_b64_tr_b16 v[178:179], v48 offset:544
    ds_read_b64_tr_b16 v[180:181], v48 offset:8224
    ds_read_b64_tr_b16 v[182:183], v48 offset:8736
    s_waitcnt lgkmcnt(0)
    v_xor_b32 v48, 128, v47
    v_add_u32 v48, 16384, v48
    ds_read_b64_tr_b16 v[192:193], v48 offset:0
    ds_read_b64_tr_b16 v[194:195], v48 offset:512
    ds_read_b64_tr_b16 v[196:197], v48 offset:8192
    ds_read_b64_tr_b16 v[198:199], v48 offset:8704
    ds_read_b64_tr_b16 v[208:209], v48 offset:32
    ds_read_b64_tr_b16 v[210:211], v48 offset:544
    ds_read_b64_tr_b16 v[212:213], v48 offset:8224
    ds_read_b64_tr_b16 v[214:215], v48 offset:8736
    s_waitcnt lgkmcnt(0)
    v_xor_b32 v48, 192, v47
    v_add_u32 v48, 16384, v48
    ds_read_b64_tr_b16 v[224:225], v48 offset:0
    ds_read_b64_tr_b16 v[226:227], v48 offset:512
    ds_read_b64_tr_b16 v[228:229], v48 offset:8192
    ds_read_b64_tr_b16 v[230:231], v48 offset:8704
    ds_read_b64_tr_b16 v[240:241], v48 offset:32
    ds_read_b64_tr_b16 v[242:243], v48 offset:544
    ds_read_b64_tr_b16 v[244:245], v48 offset:8224
    ds_read_b64_tr_b16 v[246:247], v48 offset:8736
    s_waitcnt lgkmcnt(0)
mega_kernel_rs_wo1:
    s_barrier
    s_add_u32 m0, s48, 16384
    s_mov_b32 s22, 524288
    buffer_load_dwordx4 v44, s[8:11], s22 offen  lds
    s_add_u32 m0, s48, 20480
    s_mov_b32 s22, 557056
    buffer_load_dwordx4 v44, s[8:11], s22 offen  lds
    s_add_u32 m0, s48, 24576
    s_mov_b32 s22, 589824
    buffer_load_dwordx4 v44, s[8:11], s22 offen  lds
    s_add_u32 m0, s48, 28672
    s_mov_b32 s22, 622592
    buffer_load_dwordx4 v44, s[8:11], s22 offen  lds
    s_waitcnt vmcnt(28)
    s_barrier
    s_cmp_lg_u32 s20, 2
    s_cbranch_scc1 mega_kernel_rs_wo2
    v_xor_b32 v48, 0, v47
    v_add_u32 v48, 32768, v48
    ds_read_b64_tr_b16 v[128:129], v48 offset:0
    ds_read_b64_tr_b16 v[130:131], v48 offset:512
    ds_read_b64_tr_b16 v[132:133], v48 offset:8192
    ds_read_b64_tr_b16 v[134:135], v48 offset:8704
    ds_read_b64_tr_b16 v[144:145], v48 offset:32
    ds_read_b64_tr_b16 v[146:147], v48 offset:544
    ds_read_b64_tr_b16 v[148:149], v48 offset:8224
    ds_read_b64_tr_b16 v[150:151], v48 offset:8736
    s_waitcnt lgkmcnt(0)
    v_xor_b32 v48, 64, v47
    v_add_u32 v48, 32768, v48
    ds_read_b64_tr_b16 v[160:161], v48 offset:0
    ds_read_b64_tr_b16 v[162:163], v48 offset:512
    ds_read_b64_tr_b16 v[164:165], v48 offset:8192
    ds_read_b64_tr_b16 v[166:167], v48 offset:8704
    ds_read_b64_tr_b16 v[176:177], v48 offset:32
    ds_read_b64_tr_b16 v[178:179], v48 offset:544
    ds_read_b64_tr_b16 v[180:181], v48 offset:8224
    ds_read_b64_tr_b16 v[182:183], v48 offset:8736
    s_waitcnt lgkmcnt(0)
    v_xor_b32 v48, 128, v47
    v_add_u32 v48, 32768, v48
    ds_read_b64_tr_b16 v[192:193], v48 offset:0
    ds_read_b64_tr_b16 v[194:195], v48 offset:512
    ds_read_b64_tr_b16 v[196:197], v48 offset:8192
    ds_read_b64_tr_b16 v[198:199], v48 offset:8704
    ds_read_b64_tr_b16 v[208:209], v48 offset:32
    ds_read_b64_tr_b16 v[210:211], v48 offset:544
    ds_read_b64_tr_b16 v[212:213], v48 offset:8224
    ds_read_b64_tr_b16 v[214:215], v48 offset:8736
    s_waitcnt lgkmcnt(0)
    v_xor_b32 v48, 192, v47
    v_add_u32 v48, 32768, v48
    ds_read_b64_tr_b16 v[224:225], v48 offset:0
    ds_read_b64_tr_b16 v[226:227], v48 offset:512
    ds_read_b64_tr_b16 v[228:229], v48 offset:8192
    ds_read_b64_tr_b16 v[230:231], v48 offset:8704
    ds_read_b64_tr_b16 v[240:241], v48 offset:32
    ds_read_b64_tr_b16 v[242:243], v48 offset:544
    ds_read_b64_tr_b16 v[244:245], v48 offset:8224
    ds_read_b64_tr_b16 v[246:247], v48 offset:8736
    s_waitcnt lgkmcnt(0)
mega_kernel_rs_wo2:
    s_barrier
    s_add_u32 m0, s48, 32768
    s_mov_b32 s22, 1048576
    buffer_load_dwordx4 v44, s[8:11], s22 offen  lds
    s_add_u32 m0, s48, 36864
    s_mov_b32 s22, 1081344
    buffer_load_dwordx4 v44, s[8:11], s22 offen  lds
    s_add_u32 m0, s48, 40960
    s_mov_b32 s22, 1114112
    buffer_load_dwordx4 v44, s[8:11], s22 offen  lds
    s_add_u32 m0, s48, 45056
    s_mov_b32 s22, 1146880
    buffer_load_dwordx4 v44, s[8:11], s22 offen  lds
    s_waitcnt vmcnt(28)
    s_barrier
    s_cmp_lg_u32 s20, 3
    s_cbranch_scc1 mega_kernel_rs_wo3
    v_xor_b32 v48, 0, v47
    v_add_u32 v48, 49152, v48
    ds_read_b64_tr_b16 v[128:129], v48 offset:0
    ds_read_b64_tr_b16 v[130:131], v48 offset:512
    ds_read_b64_tr_b16 v[132:133], v48 offset:8192
    ds_read_b64_tr_b16 v[134:135], v48 offset:8704
    ds_read_b64_tr_b16 v[144:145], v48 offset:32
    ds_read_b64_tr_b16 v[146:147], v48 offset:544
    ds_read_b64_tr_b16 v[148:149], v48 offset:8224
    ds_read_b64_tr_b16 v[150:151], v48 offset:8736
    s_waitcnt lgkmcnt(0)
    v_xor_b32 v48, 64, v47
    v_add_u32 v48, 49152, v48
    ds_read_b64_tr_b16 v[160:161], v48 offset:0
    ds_read_b64_tr_b16 v[162:163], v48 offset:512
    ds_read_b64_tr_b16 v[164:165], v48 offset:8192
    ds_read_b64_tr_b16 v[166:167], v48 offset:8704
    ds_read_b64_tr_b16 v[176:177], v48 offset:32
    ds_read_b64_tr_b16 v[178:179], v48 offset:544
    ds_read_b64_tr_b16 v[180:181], v48 offset:8224
    ds_read_b64_tr_b16 v[182:183], v48 offset:8736
    s_waitcnt lgkmcnt(0)
    v_xor_b32 v48, 128, v47
    v_add_u32 v48, 49152, v48
    ds_read_b64_tr_b16 v[192:193], v48 offset:0
    ds_read_b64_tr_b16 v[194:195], v48 offset:512
    ds_read_b64_tr_b16 v[196:197], v48 offset:8192
    ds_read_b64_tr_b16 v[198:199], v48 offset:8704
    ds_read_b64_tr_b16 v[208:209], v48 offset:32
    ds_read_b64_tr_b16 v[210:211], v48 offset:544
    ds_read_b64_tr_b16 v[212:213], v48 offset:8224
    ds_read_b64_tr_b16 v[214:215], v48 offset:8736
    s_waitcnt lgkmcnt(0)
    v_xor_b32 v48, 192, v47
    v_add_u32 v48, 49152, v48
    ds_read_b64_tr_b16 v[224:225], v48 offset:0
    ds_read_b64_tr_b16 v[226:227], v48 offset:512
    ds_read_b64_tr_b16 v[228:229], v48 offset:8192
    ds_read_b64_tr_b16 v[230:231], v48 offset:8704
    ds_read_b64_tr_b16 v[240:241], v48 offset:32
    ds_read_b64_tr_b16 v[242:243], v48 offset:544
    ds_read_b64_tr_b16 v[244:245], v48 offset:8224
    ds_read_b64_tr_b16 v[246:247], v48 offset:8736
    s_waitcnt lgkmcnt(0)
mega_kernel_rs_wo3:
    s_barrier
    s_add_u32 m0, s48, 49152
    s_mov_b32 s22, 1572864
    buffer_load_dwordx4 v44, s[8:11], s22 offen  lds
    s_add_u32 m0, s48, 53248
    s_mov_b32 s22, 1605632
    buffer_load_dwordx4 v44, s[8:11], s22 offen  lds
    s_add_u32 m0, s48, 57344
    s_mov_b32 s22, 1638400
    buffer_load_dwordx4 v44, s[8:11], s22 offen  lds
    s_add_u32 m0, s48, 61440
    s_mov_b32 s22, 1671168
    buffer_load_dwordx4 v44, s[8:11], s22 offen  lds
    s_waitcnt vmcnt(28)
    s_barrier
    s_cmp_lg_u32 s20, 0
    s_cbranch_scc1 mega_kernel_rs_wo4
    v_xor_b32 v48, 0, v47
    v_add_u32 v48, 65536, v48
    ds_read_b64_tr_b16 v[136:137], v48 offset:0
    ds_read_b64_tr_b16 v[138:139], v48 offset:512
    ds_read_b64_tr_b16 v[140:141], v48 offset:8192
    ds_read_b64_tr_b16 v[142:143], v48 offset:8704
    ds_read_b64_tr_b16 v[152:153], v48 offset:32
    ds_read_b64_tr_b16 v[154:155], v48 offset:544
    ds_read_b64_tr_b16 v[156:157], v48 offset:8224
    ds_read_b64_tr_b16 v[158:159], v48 offset:8736
    s_waitcnt lgkmcnt(0)
    v_xor_b32 v48, 64, v47
    v_add_u32 v48, 65536, v48
    ds_read_b64_tr_b16 v[168:169], v48 offset:0
    ds_read_b64_tr_b16 v[170:171], v48 offset:512
    ds_read_b64_tr_b16 v[172:173], v48 offset:8192
    ds_read_b64_tr_b16 v[174:175], v48 offset:8704
    ds_read_b64_tr_b16 v[184:185], v48 offset:32
    ds_read_b64_tr_b16 v[186:187], v48 offset:544
    ds_read_b64_tr_b16 v[188:189], v48 offset:8224
    ds_read_b64_tr_b16 v[190:191], v48 offset:8736
    s_waitcnt lgkmcnt(0)
    v_xor_b32 v48, 128, v47
    v_add_u32 v48, 65536, v48
    ds_read_b64_tr_b16 v[200:201], v48 offset:0
    ds_read_b64_tr_b16 v[202:203], v48 offset:512
    ds_read_b64_tr_b16 v[204:205], v48 offset:8192
    ds_read_b64_tr_b16 v[206:207], v48 offset:8704
    ds_read_b64_tr_b16 v[216:217], v48 offset:32
    ds_read_b64_tr_b16 v[218:219], v48 offset:544
    ds_read_b64_tr_b16 v[220:221], v48 offset:8224
    ds_read_b64_tr_b16 v[222:223], v48 offset:8736
    s_waitcnt lgkmcnt(0)
    v_xor_b32 v48, 192, v47
    v_add_u32 v48, 65536, v48
    ds_read_b64_tr_b16 v[232:233], v48 offset:0
    ds_read_b64_tr_b16 v[234:235], v48 offset:512
    ds_read_b64_tr_b16 v[236:237], v48 offset:8192
    ds_read_b64_tr_b16 v[238:239], v48 offset:8704
    ds_read_b64_tr_b16 v[248:249], v48 offset:32
    ds_read_b64_tr_b16 v[250:251], v48 offset:544
    ds_read_b64_tr_b16 v[252:253], v48 offset:8224
    ds_read_b64_tr_b16 v[254:255], v48 offset:8736
    s_waitcnt lgkmcnt(0)
mega_kernel_rs_wo4:
    s_barrier
    s_add_u32 m0, s48, 65536
    s_mov_b32 s22, 2097152
    buffer_load_dwordx4 v44, s[8:11], s22 offen  lds
    s_add_u32 m0, s48, 69632
    s_mov_b32 s22, 2129920
    buffer_load_dwordx4 v44, s[8:11], s22 offen  lds
    s_add_u32 m0, s48, 73728
    s_mov_b32 s22, 2162688
    buffer_load_dwordx4 v44, s[8:11], s22 offen  lds
    s_add_u32 m0, s48, 77824
    s_mov_b32 s22, 2195456
    buffer_load_dwordx4 v44, s[8:11], s22 offen  lds
    s_waitcnt vmcnt(28)
    s_barrier
    s_cmp_lg_u32 s20, 1
    s_cbranch_scc1 mega_kernel_rs_wo5
    v_xor_b32 v48, 0, v47
    v_add_u32 v48, 81920, v48
    ds_read_b64_tr_b16 v[136:137], v48 offset:0
    ds_read_b64_tr_b16 v[138:139], v48 offset:512
    ds_read_b64_tr_b16 v[140:141], v48 offset:8192
    ds_read_b64_tr_b16 v[142:143], v48 offset:8704
    ds_read_b64_tr_b16 v[152:153], v48 offset:32
    ds_read_b64_tr_b16 v[154:155], v48 offset:544
    ds_read_b64_tr_b16 v[156:157], v48 offset:8224
    ds_read_b64_tr_b16 v[158:159], v48 offset:8736
    s_waitcnt lgkmcnt(0)
    v_xor_b32 v48, 64, v47
    v_add_u32 v48, 81920, v48
    ds_read_b64_tr_b16 v[168:169], v48 offset:0
    ds_read_b64_tr_b16 v[170:171], v48 offset:512
    ds_read_b64_tr_b16 v[172:173], v48 offset:8192
    ds_read_b64_tr_b16 v[174:175], v48 offset:8704
    ds_read_b64_tr_b16 v[184:185], v48 offset:32
    ds_read_b64_tr_b16 v[186:187], v48 offset:544
    ds_read_b64_tr_b16 v[188:189], v48 offset:8224
    ds_read_b64_tr_b16 v[190:191], v48 offset:8736
    s_waitcnt lgkmcnt(0)
    v_xor_b32 v48, 128, v47
    v_add_u32 v48, 81920, v48
    ds_read_b64_tr_b16 v[200:201], v48 offset:0
    ds_read_b64_tr_b16 v[202:203], v48 offset:512
    ds_read_b64_tr_b16 v[204:205], v48 offset:8192
    ds_read_b64_tr_b16 v[206:207], v48 offset:8704
    ds_read_b64_tr_b16 v[216:217], v48 offset:32
    ds_read_b64_tr_b16 v[218:219], v48 offset:544
    ds_read_b64_tr_b16 v[220:221], v48 offset:8224
    ds_read_b64_tr_b16 v[222:223], v48 offset:8736
    s_waitcnt lgkmcnt(0)
    v_xor_b32 v48, 192, v47
    v_add_u32 v48, 81920, v48
    ds_read_b64_tr_b16 v[232:233], v48 offset:0
    ds_read_b64_tr_b16 v[234:235], v48 offset:512
    ds_read_b64_tr_b16 v[236:237], v48 offset:8192
    ds_read_b64_tr_b16 v[238:239], v48 offset:8704
    ds_read_b64_tr_b16 v[248:249], v48 offset:32
    ds_read_b64_tr_b16 v[250:251], v48 offset:544
    ds_read_b64_tr_b16 v[252:253], v48 offset:8224
    ds_read_b64_tr_b16 v[254:255], v48 offset:8736
    s_waitcnt lgkmcnt(0)
mega_kernel_rs_wo5:
    s_barrier
    s_add_u32 m0, s48, 81920
    s_mov_b32 s22, 2621440
    buffer_load_dwordx4 v44, s[8:11], s22 offen  lds
    s_add_u32 m0, s48, 86016
    s_mov_b32 s22, 2654208
    buffer_load_dwordx4 v44, s[8:11], s22 offen  lds
    s_add_u32 m0, s48, 90112
    s_mov_b32 s22, 2686976
    buffer_load_dwordx4 v44, s[8:11], s22 offen  lds
    s_add_u32 m0, s48, 94208
    s_mov_b32 s22, 2719744
    buffer_load_dwordx4 v44, s[8:11], s22 offen  lds
    s_waitcnt vmcnt(28)
    s_barrier
    s_cmp_lg_u32 s20, 2
    s_cbranch_scc1 mega_kernel_rs_wo6
    v_xor_b32 v48, 0, v47
    v_add_u32 v48, 98304, v48
    ds_read_b64_tr_b16 v[136:137], v48 offset:0
    ds_read_b64_tr_b16 v[138:139], v48 offset:512
    ds_read_b64_tr_b16 v[140:141], v48 offset:8192
    ds_read_b64_tr_b16 v[142:143], v48 offset:8704
    ds_read_b64_tr_b16 v[152:153], v48 offset:32
    ds_read_b64_tr_b16 v[154:155], v48 offset:544
    ds_read_b64_tr_b16 v[156:157], v48 offset:8224
    ds_read_b64_tr_b16 v[158:159], v48 offset:8736
    s_waitcnt lgkmcnt(0)
    v_xor_b32 v48, 64, v47
    v_add_u32 v48, 98304, v48
    ds_read_b64_tr_b16 v[168:169], v48 offset:0
    ds_read_b64_tr_b16 v[170:171], v48 offset:512
    ds_read_b64_tr_b16 v[172:173], v48 offset:8192
    ds_read_b64_tr_b16 v[174:175], v48 offset:8704
    ds_read_b64_tr_b16 v[184:185], v48 offset:32
    ds_read_b64_tr_b16 v[186:187], v48 offset:544
    ds_read_b64_tr_b16 v[188:189], v48 offset:8224
    ds_read_b64_tr_b16 v[190:191], v48 offset:8736
    s_waitcnt lgkmcnt(0)
    v_xor_b32 v48, 128, v47
    v_add_u32 v48, 98304, v48
    ds_read_b64_tr_b16 v[200:201], v48 offset:0
    ds_read_b64_tr_b16 v[202:203], v48 offset:512
    ds_read_b64_tr_b16 v[204:205], v48 offset:8192
    ds_read_b64_tr_b16 v[206:207], v48 offset:8704
    ds_read_b64_tr_b16 v[216:217], v48 offset:32
    ds_read_b64_tr_b16 v[218:219], v48 offset:544
    ds_read_b64_tr_b16 v[220:221], v48 offset:8224
    ds_read_b64_tr_b16 v[222:223], v48 offset:8736
    s_waitcnt lgkmcnt(0)
    v_xor_b32 v48, 192, v47
    v_add_u32 v48, 98304, v48
    ds_read_b64_tr_b16 v[232:233], v48 offset:0
    ds_read_b64_tr_b16 v[234:235], v48 offset:512
    ds_read_b64_tr_b16 v[236:237], v48 offset:8192
    ds_read_b64_tr_b16 v[238:239], v48 offset:8704
    ds_read_b64_tr_b16 v[248:249], v48 offset:32
    ds_read_b64_tr_b16 v[250:251], v48 offset:544
    ds_read_b64_tr_b16 v[252:253], v48 offset:8224
    ds_read_b64_tr_b16 v[254:255], v48 offset:8736
    s_waitcnt lgkmcnt(0)
mega_kernel_rs_wo6:
    s_barrier
    s_add_u32 m0, s48, 98304
    s_mov_b32 s22, 3145728
    buffer_load_dwordx4 v44, s[8:11], s22 offen  lds
    s_add_u32 m0, s48, 102400
    s_mov_b32 s22, 3178496
    buffer_load_dwordx4 v44, s[8:11], s22 offen  lds
    s_add_u32 m0, s48, 106496
    s_mov_b32 s22, 3211264
    buffer_load_dwordx4 v44, s[8:11], s22 offen  lds
    s_add_u32 m0, s48, 110592
    s_mov_b32 s22, 3244032
    buffer_load_dwordx4 v44, s[8:11], s22 offen  lds
    s_waitcnt vmcnt(28)
    s_barrier
    s_cmp_lg_u32 s20, 3
    s_cbranch_scc1 mega_kernel_rs_wo7
    v_xor_b32 v48, 0, v47
    v_add_u32 v48, 114688, v48
    ds_read_b64_tr_b16 v[136:137], v48 offset:0
    ds_read_b64_tr_b16 v[138:139], v48 offset:512
    ds_read_b64_tr_b16 v[140:141], v48 offset:8192
    ds_read_b64_tr_b16 v[142:143], v48 offset:8704
    ds_read_b64_tr_b16 v[152:153], v48 offset:32
    ds_read_b64_tr_b16 v[154:155], v48 offset:544
    ds_read_b64_tr_b16 v[156:157], v48 offset:8224
    ds_read_b64_tr_b16 v[158:159], v48 offset:8736
    s_waitcnt lgkmcnt(0)
    v_xor_b32 v48, 64, v47
    v_add_u32 v48, 114688, v48
    ds_read_b64_tr_b16 v[168:169], v48 offset:0
    ds_read_b64_tr_b16 v[170:171], v48 offset:512
    ds_read_b64_tr_b16 v[172:173], v48 offset:8192
    ds_read_b64_tr_b16 v[174:175], v48 offset:8704
    ds_read_b64_tr_b16 v[184:185], v48 offset:32
    ds_read_b64_tr_b16 v[186:187], v48 offset:544
    ds_read_b64_tr_b16 v[188:189], v48 offset:8224
    ds_read_b64_tr_b16 v[190:191], v48 offset:8736
    s_waitcnt lgkmcnt(0)
    v_xor_b32 v48, 128, v47
    v_add_u32 v48, 114688, v48
    ds_read_b64_tr_b16 v[200:201], v48 offset:0
    ds_read_b64_tr_b16 v[202:203], v48 offset:512
    ds_read_b64_tr_b16 v[204:205], v48 offset:8192
    ds_read_b64_tr_b16 v[206:207], v48 offset:8704
    ds_read_b64_tr_b16 v[216:217], v48 offset:32
    ds_read_b64_tr_b16 v[218:219], v48 offset:544
    ds_read_b64_tr_b16 v[220:221], v48 offset:8224
    ds_read_b64_tr_b16 v[222:223], v48 offset:8736
    s_waitcnt lgkmcnt(0)
    v_xor_b32 v48, 192, v47
    v_add_u32 v48, 114688, v48
    ds_read_b64_tr_b16 v[232:233], v48 offset:0
    ds_read_b64_tr_b16 v[234:235], v48 offset:512
    ds_read_b64_tr_b16 v[236:237], v48 offset:8192
    ds_read_b64_tr_b16 v[238:239], v48 offset:8704
    ds_read_b64_tr_b16 v[248:249], v48 offset:32
    ds_read_b64_tr_b16 v[250:251], v48 offset:544
    ds_read_b64_tr_b16 v[252:253], v48 offset:8224
    ds_read_b64_tr_b16 v[254:255], v48 offset:8736
    s_waitcnt lgkmcnt(0)
mega_kernel_rs_wo7:
    s_barrier
    s_add_u32 m0, s48, 114688
    s_mov_b32 s22, 3670016
    buffer_load_dwordx4 v44, s[8:11], s22 offen  lds
    s_add_u32 m0, s48, 118784
    s_mov_b32 s22, 3702784
    buffer_load_dwordx4 v44, s[8:11], s22 offen  lds
    s_add_u32 m0, s48, 122880
    s_mov_b32 s22, 3735552
    buffer_load_dwordx4 v44, s[8:11], s22 offen  lds
    s_add_u32 m0, s48, 126976
    s_mov_b32 s22, 3768320
    buffer_load_dwordx4 v44, s[8:11], s22 offen  lds
    s_waitcnt vmcnt(28)
    s_barrier
    v_add_u32 v48, 0, v46
    ds_read_b64_tr_b16 v[64:65], v48 offset:0
    ds_read_b64_tr_b16 v[66:67], v48 offset:512
    ds_read_b64_tr_b16 v[68:69], v48 offset:8192
    ds_read_b64_tr_b16 v[70:71], v48 offset:8704
    ds_read_b64_tr_b16 v[72:73], v48 offset:8
    ds_read_b64_tr_b16 v[74:75], v48 offset:520
    ds_read_b64_tr_b16 v[76:77], v48 offset:8200
    ds_read_b64_tr_b16 v[78:79], v48 offset:8712
    s_waitcnt lgkmcnt(0)
    s_barrier
    ds_write_b128 v32, v[64:67] offset:0
    ds_write_b128 v32, v[68:71] offset:1024
    ds_write_b128 v32, v[72:75] offset:2048
    ds_write_b128 v32, v[76:79] offset:3072
    s_waitcnt lgkmcnt(0)
    s_waitcnt vmcnt(24)
    s_barrier
    v_add_u32 v48, 16384, v46
    ds_read_b64_tr_b16 v[64:65], v48 offset:0
    ds_read_b64_tr_b16 v[66:67], v48 offset:512
    ds_read_b64_tr_b16 v[68:69], v48 offset:8192
    ds_read_b64_tr_b16 v[70:71], v48 offset:8704
    ds_read_b64_tr_b16 v[72:73], v48 offset:8
    ds_read_b64_tr_b16 v[74:75], v48 offset:520
    ds_read_b64_tr_b16 v[76:77], v48 offset:8200
    ds_read_b64_tr_b16 v[78:79], v48 offset:8712
    s_waitcnt lgkmcnt(0)
    s_barrier
    ds_write_b128 v32, v[64:67] offset:16384
    ds_write_b128 v32, v[68:71] offset:17408
    ds_write_b128 v32, v[72:75] offset:18432
    ds_write_b128 v32, v[76:79] offset:19456
    s_waitcnt lgkmcnt(0)
    s_waitcnt vmcnt(20)
    s_barrier
    s_getpc_b64 s[16:17]
mega_kernel_rs_pc0:
    s_add_u32 s16, s16, mega_kernel_rs_w0_entry - mega_kernel_rs_pc0
    s_addc_u32 s17, s17, 0
    v_lshlrev_b32 v49, 7, v0
    v_min_u32 v49, mega_kernel_rs_end - mega_kernel_rs_w0_entry, v49
    global_load_dword v50, v49, s[16:17]
    v_lshlrev_b32 v49, 7, v40
    s_xor_b32 s23, s35, 16384
    s_cmp_eq_u32 s20, 1
    s_cselect_b32 s22, s35, s47
    s_cmp_eq_u32 s20, 2
    s_cselect_b32 s22, s23, s22
    s_lshl_b32 s23, s31, 13
    s_add_u32 s23, s23, 178257920
    s_cmp_eq_u32 s20, 3
    s_cselect_b32 s22, s23, s22
    buffer_load_dword v51, v49, s[4:7], s22 offen sc1
    v_lshlrev_b32 v49, 13, v0
    v_and_b32 v49, 0x1fffff, v49
    s_mov_b32 s22, 67108864
    buffer_load_dword v52, v49, s[4:7], s22 offen sc1
    buffer_load_dword v57, v7, s[4:7], 0 offen sc1
    v_add_u32 v48, 32768, v46
    ds_read_b64_tr_b16 v[64:65], v48 offset:0
    ds_read_b64_tr_b16 v[66:67], v48 offset:512
    ds_read_b64_tr_b16 v[68:69], v48 offset:8192
    ds_read_b64_tr_b16 v[70:71], v48 offset:8704
    ds_read_b64_tr_b16 v[72:73], v48 offset:8
    ds_read_b64_tr_b16 v[74:75], v48 offset:520
    ds_read_b64_tr_b16 v[76:77], v48 offset:8200
    ds_read_b64_tr_b16 v[78:79], v48 offset:8712
    s_waitcnt lgkmcnt(0)
    s_barrier
    ds_write_b128 v32, v[64:67] offset:32768
    ds_write_b128 v32, v[68:71] offset:33792
    ds_write_b128 v32, v[72:75] offset:34816
    ds_write_b128 v32, v[76:79] offset:35840
    s_waitcnt lgkmcnt(0)
    s_waitcnt vmcnt(16)
    s_barrier
    v_add_u32 v48, 49152, v46
    ds_read_b64_tr_b16 v[64:65], v48 offset:0
    ds_read_b64_tr_b16 v[66:67], v48 offset:512
    ds_read_b64_tr_b16 v[68:69], v48 offset:8192
    ds_read_b64_tr_b16 v[70:71], v48 offset:8704
    ds_read_b64_tr_b16 v[72:73], v48 offset:8
    ds_read_b64_tr_b16 v[74:75], v48 offset:520
    ds_read_b64_tr_b16 v[76:77], v48 offset:8200
    ds_read_b64_tr_b16 v[78:79], v48 offset:8712
    s_waitcnt lgkmcnt(0)
    s_barrier
    ds_write_b128 v32, v[64:67] offset:49152
    ds_write_b128 v32, v[68:71] offset:50176
    ds_write_b128 v32, v[72:75] offset:51200
    ds_write_b128 v32, v[76:79] offset:52224
    s_waitcnt lgkmcnt(0)
    s_waitcnt vmcnt(12)
    s_barrier
    v_add_u32 v48, 65536, v46
    ds_read_b64_tr_b16 v[64:65], v48 offset:0
    ds_read_b64_tr_b16 v[66:67], v48 offset:512
    ds_read_b64_tr_b16 v[68:69], v48 offset:8192
    ds_read_b64_tr_b16 v[70:71], v48 offset:8704
    ds_read_b64_tr_b16 v[72:73], v48 offset:8
    ds_read_b64_tr_b16 v[74:75], v48 offset:520
    ds_read_b64_tr_b16 v[76:77], v48 offset:8200
    ds_read_b64_tr_b16 v[78:79], v48 offset:8712
    s_waitcnt lgkmcnt(0)
    s_barrier
    ds_write_b128 v33, v[64:67] offset:0
    ds_write_b128 v33, v[68:71] offset:1024
    ds_write_b128 v33, v[72:75] offset:2048
    ds_write_b128 v33, v[76:79] offset:3072
    s_waitcnt lgkmcnt(0)
    s_waitcnt vmcnt(8)
    s_barrier
    v_add_u32 v48, 81920, v46
    ds_read_b64_tr_b16 v[64:65], v48 offset:0
    ds_read_b64_tr_b16 v[66:67], v48 offset:512
    ds_read_b64_tr_b16 v[68:69], v48 offset:8192
    ds_read_b64_tr_b16 v[70:71], v48 offset:8704
    ds_read_b64_tr_b16 v[72:73], v48 offset:8
    ds_read_b64_tr_b16 v[74:75], v48 offset:520
    ds_read_b64_tr_b16 v[76:77], v48 offset:8200
    ds_read_b64_tr_b16 v[78:79], v48 offset:8712
    s_waitcnt lgkmcnt(0)
    s_barrier
    ds_write_b128 v33, v[64:67] offset:16384
    ds_write_b128 v33, v[68:71] offset:17408
    ds_write_b128 v33, v[72:75] offset:18432
    ds_write_b128 v33, v[76:79] offset:19456
    s_waitcnt lgkmcnt(0)
    s_waitcnt vmcnt(4)
    s_barrier
    v_add_u32 v48, 98304, v46
    ds_read_b64_tr_b16 v[64:65], v48 offset:0
    ds_read_b64_tr_b16 v[66:67], v48 offset:512
    ds_read_b64_tr_b16 v[68:69], v48 offset:8192
    ds_read_b64_tr_b16 v[70:71], v48 offset:8704
    ds_read_b64_tr_b16 v[72:73], v48 offset:8
    ds_read_b64_tr_b16 v[74:75], v48 offset:520
    ds_read_b64_tr_b16 v[76:77], v48 offset:8200
    ds_read_b64_tr_b16 v[78:79], v48 offset:8712
    s_waitcnt lgkmcnt(0)
    s_barrier
    ds_write_b128 v33, v[64:67] offset:32768
    ds_write_b128 v33, v[68:71] offset:33792
    ds_write_b128 v33, v[72:75] offset:34816
    ds_write_b128 v33, v[76:79] offset:35840
    s_waitcnt lgkmcnt(0)
    s_waitcnt vmcnt(0)
    s_barrier
    v_add_u32 v48, 114688, v46
    ds_read_b64_tr_b16 v[64:65], v48 offset:0
    ds_read_b64_tr_b16 v[66:67], v48 offset:512
    ds_read_b64_tr_b16 v[68:69], v48 offset:8192
    ds_read_b64_tr_b16 v[70:71], v48 offset:8704
    ds_read_b64_tr_b16 v[72:73], v48 offset:8
    ds_read_b64_tr_b16 v[74:75], v48 offset:520
    ds_read_b64_tr_b16 v[76:77], v48 offset:8200
    ds_read_b64_tr_b16 v[78:79], v48 offset:8712
    s_waitcnt lgkmcnt(0)
    s_barrier
    ds_write_b128 v33, v[64:67] offset:49152
    ds_write_b128 v33, v[68:71] offset:50176
    ds_write_b128 v33, v[72:75] offset:51200
    ds_write_b128 v33, v[76:79] offset:52224
    s_waitcnt lgkmcnt(0)
mega_kernel_rs_iw:
    buffer_load_dword v58, off, s[12:15], 0 offset:204 sc1
    s_waitcnt vmcnt(0)
mega_kernel_rs_iw1:
    v_and_b32 v50, 0xffff, v58
    v_readfirstlane_b32 s60, v58
    v_cmp_ne_u32 vcc, s100, v50
    s_cbranch_vccnz mega_kernel_rs_iw
    s_lshr_b32 s60, s60, 15
    s_cmp_gt_u32 s60, s100
    s_cselect_b32 s60, 8192, 0
    s_bfe_u32 s22, s31, 0x10001
    s_lshl_b32 s22, s22, 12
    s_add_u32 s22, s22, s60
    s_lshl_b32 s23, s20, 10
    s_add_u32 s22, s22, s23
    s_add_u32 s38, s38, s22
    s_add_u32 s37, s37, s22
    s_xor_b32 s40, s38, 4096
    s_xor_b32 s39, s37, 4096
    s_xor_b32 s36, s35, 16384
    s_mov_b32 s21, 0
    s_cmp_eq_u32 s30, 0
    s_mov_b32 s22, 0x33003300
    s_cselect_b32 s16, 0x00330033, s22
    s_mov_b32 s17, s16
    s_cselect_b32 s18, -1, 0
    s_not_b32 s19, s18
    s_lshl_b32 s22, s31, 13
    s_lshl_b32 s23, s20, 11
    s_add_u32 s22, s22, s23
    s_add_u32 s43, s22, 16777216
    s_add_u32 s44, s22, 33554432
    s_lshl_b32 s45, s31, 13
    s_add_u32 s45, s45, 178257920
    s_mul_i32 s48, s20, 5120
    s_add_u32 m0, s48, 140288
    s_mov_b32 s41, 1
    s_mov_b32 s42, 1
    v_mov_b32 v0, v34
    v_bfrev_b32 v12, 1
    v_bfrev_b32 v3, 1
    v_cndmask_b32 v10, v3, v10, s[16:17]
    v_cndmask_b32 v9, v3, v9, s[26:27]
    s_sub_u32 s45, s45, 0
    s_lshl_b32 s51, s30, 11
    s_add_u32 s51, s51, s45
    s_mov_b32 s50, 0
    s_cmp_lg_u32 s20, 3
    s_cbranch_scc1 mega_kernel_rs_kv0
    v_readlane_b32 s50, v57, 0
    v_readlane_b32 s22, v57, 2
    v_readlane_b32 s23, v57, 1
    v_readlane_b32 s24, v57, 3
    s_nop 3
    s_min_u32 s50, s50, s22
    s_min_u32 s23, s23, s24
    s_lshl_b32 s50, s50, 1
    s_lshl_b32 s23, s23, 1
    s_add_u32 s23, s23, 1
    s_min_u32 s50, s50, s23
mega_kernel_rs_kvb0:
    s_add_u32 s22, s21, 1
    s_min_u32 s22, s22, 63
    s_cmp_gt_u32 s50, s22
    s_cbranch_scc1 mega_kernel_rs_kvd0
    buffer_load_dword v48, v7, s[4:7], 0 offen sc1
    s_waitcnt vmcnt(0)
    v_readlane_b32 s50, v48, 0
    v_readlane_b32 s22, v48, 2
    v_readlane_b32 s23, v48, 1
    v_readlane_b32 s24, v48, 3
    s_nop 3
    s_min_u32 s50, s50, s22
    s_min_u32 s23, s23, s24
    s_lshl_b32 s50, s50, 1
    s_lshl_b32 s23, s23, 1
    s_add_u32 s23, s23, 1
    s_min_u32 s50, s50, s23
    s_branch mega_kernel_rs_kvb0
mega_kernel_rs_kvd0:
mega_kernel_rs_kv0:
    s_barrier
    s_cmp_eq_u32 s20, 1
    s_cbranch_scc1 mega_kernel_rs_w1_entry
    s_cmp_eq_u32 s20, 2
    s_cbranch_scc1 mega_kernel_rs_w2_entry
    s_cmp_eq_u32 s20, 3
    s_cbranch_scc1 mega_kernel_rs_w3_entry
mega_kernel_rs_w0_entry:
    v_mfma_f32_32x32x8_bf16 v[96:111], v[14:15], v[14:15], 0
    v_mfma_f32_16x16x16_bf16 v[112:115], v[14:15], v[14:15], 0
    v_mfma_f32_16x16x16_bf16 v[116:119], v[14:15], v[14:15], 0
    ds_read_b128 v[64:67], v1 offset:0
    ds_read_b128 v[68:71], v1 offset:1024
    ds_read_b128 v[72:75], v1 offset:2048
    ds_read_b128 v[76:79], v1 offset:3072
    ds_read_b128 v[80:83], v1 offset:16384
    ds_read_b128 v[84:87], v1 offset:17408
    ds_read_b128 v[88:91], v1 offset:18432
    ds_read_b128 v[92:95], v1 offset:19456
    buffer_load_dwordx4 v[120:123], v1, s[4:7], s44 offen
    buffer_load_dwordx4 v[124:127], v1, s[4:7], s44 offen offset:1024
    s_add_u32 s44, s44, 262144
mega_kernel_rs_w0_loop:
    s_add_u32 s22, s35, 0
    s_waitcnt vmcnt(0)
    buffer_load_dwordx4 v[32:35], v1, s[4:7], s22 offen sc1
    buffer_load_dwordx4 v[36:39], v1, s[4:7], s22 offen offset:1024 sc1
mega_kernel_rs_w0_pa:
    s_waitcnt vmcnt(1)
    ds_write_b128 v6, v[32:35] offset:0
    s_waitcnt vmcnt(0)
    ds_write_b128 v6, v[36:39] offset:1024
    v_max3_u32 v3, v32, v34, v36
    v_max_u32 v3, v3, v38
    v_cmp_eq_u32 vcc, -1, v3
    v_smfmac_f32_16x16x64_bf16 v[96:99], v[32:35], a[0:7], v2
    buffer_load_dwordx4 v[32:35], v1, s[4:7], s22 offen sc1
    v_smfmac_f32_16x16x64_bf16 v[100:103], v[32:35], a[8:15], v2
    buffer_load_dwordx4 v[36:39], v1, s[4:7], s22 offen offset:1024 sc1
    v_smfmac_f32_16x16x64_bf16 v[104:107], v[32:35], a[128:135], v2
    s_cbranch_vccnz mega_kernel_rs_w0_pafail
    s_waitcnt lgkmcnt(0)
    s_barrier
    ds_read_b128 v[40:43], v6 offset:2048
    ds_read_b128 v[44:47], v6 offset:3072
    v_smfmac_f32_16x16x64_bf16 v[108:111], v[32:35], a[136:143], v2
    ds_read_b128 v[48:51], v6 offset:4096
    v_smfmac_f32_16x16x64_bf16 v[96:99], v[36:39], a[16:23], v2
    ds_read_b128 v[52:55], v6 offset:5120
    v_smfmac_f32_16x16x64_bf16 v[100:103], v[36:39], a[24:31], v2
    ds_read_b128 v[56:59], v6 offset:6144
    v_smfmac_f32_16x16x64_bf16 v[104:107], v[36:39], a[144:151], v2
    ds_read_b128 v[60:63], v6 offset:7168
    v_smfmac_f32_16x16x64_bf16 v[108:111], v[36:39], a[152:159], v2
    buffer_load_dwordx4 v1, s[4:7], s43 offen lds
    s_waitcnt lgkmcnt(5)
    v_smfmac_f32_16x16x64_bf16 v[96:99], v[40:43], a[32:39], v2
    v_smfmac_f32_16x16x64_bf16 v[104:107], v[40:43], a[160:167], v2
    s_waitcnt lgkmcnt(4)
    v_smfmac_f32_16x16x64_bf16 v[96:99], v[44:47], a[48:55], v2
    v_smfmac_f32_16x16x64_bf16 v[104:107], v[44:47], a[176:183], v2
    buffer_load_dwordx4 v1, s[4:7], s43 offen offset:1024 lds
    s_waitcnt lgkmcnt(3)
    v_smfmac_f32_16x16x64_bf16 v[96:99], v[48:51], a[64:71], v2
    v_smfmac_f32_16x16x64_bf16 v[104:107], v[48:51], a[192:199], v2
    s_waitcnt lgkmcnt(2)
    v_smfmac_f32_16x16x64_bf16 v[96:99], v[52:55], a[80:87], v2
    v_smfmac_f32_16x16x64_bf16 v[104:107], v[52:55], a[208:215], v2
    v_mov_b32 v4, s21
    buffer_store_dword v4, v7, s[4:7], 0 offen sc1
    s_waitcnt lgkmcnt(1)
    v_smfmac_f32_16x16x64_bf16 v[96:99], v[56:59], a[96:103], v2
    v_smfmac_f32_16x16x64_bf16 v[104:107], v[56:59], a[224:231], v2
    s_waitcnt lgkmcnt(0)
    v_smfmac_f32_16x16x64_bf16 v[96:99], v[60:63], a[112:119], v2
    v_smfmac_f32_16x16x64_bf16 v[104:107], v[60:63], a[240:247], v2
    v_smfmac_f32_16x16x64_bf16 v[100:103], v[40:43], a[40:47], v2
    s_nop 2
    v_smfmac_f32_16x16x64_bf16 v[100:103], v[44:47], a[56:63], v2
    s_nop 1
    v_add_f32 v96, v96, v98
    v_smfmac_f32_16x16x64_bf16 v[100:103], v[48:51], a[72:79], v2
    v_add_f32 v97, v97, v99
    v_add_f32 v104, v104, v106
    v_smfmac_f32_16x16x64_bf16 v[100:103], v[52:55], a[88:95], v2
    v_add_f32 v105, v105, v107
    v_cvt_pk_bf16_f32 v96, v96, v97
    v_smfmac_f32_16x16x64_bf16 v[100:103], v[56:59], a[104:111], v2
    v_cvt_pk_bf16_f32 v97, v104, v105
    v_and_or_b32 v96, v96, -2, s41
    v_smfmac_f32_16x16x64_bf16 v[100:103], v[60:63], a[120:127], v2
    buffer_store_dwordx2 v[96:97], v11, s[4:7], s37 offen sc1
    v_smfmac_f32_16x16x64_bf16 v[108:111], v[40:43], a[168:175], v2
    v_smfmac_f32_16x16x64_bf16 v[108:111], v[44:47], a[184:191], v2
    v_smfmac_f32_16x16x64_bf16 v[108:111], v[48:51], a[200:207], v2
    v_smfmac_f32_16x16x64_bf16 v[108:111], v[52:55], a[216:223], v2
    v_smfmac_f32_16x16x64_bf16 v[108:111], v[56:59], a[232:239], v2
    s_nop 2
    v_add_f32 v100, v100, v102
    v_smfmac_f32_16x16x64_bf16 v[108:111], v[60:63], a[248:255], v2
    v_add_f32 v101, v101, v103
    v_cvt_pk_bf16_f32 v98, v100, v101
    v_and_or_b32 v98, v98, -2, s41
    s_nop 4
    v_pk_add_f32 v[108:109], v[108:109], v[110:111]
    v_cvt_pk_bf16_f32 v99, v108, v109
    buffer_store_dwordx2 v[98:99], v11, s[4:7], s37 offen offset:512 sc1
    v_smfmac_f32_16x16x64_bf16 v[112:115], v[32:35], v[64:71], v2
    ds_read_b128 v[64:67], v1 offset:32768
    ds_read_b128 v[68:71], v1 offset:33792
    v_smfmac_f32_16x16x64_bf16 v[116:119], v[32:35], v[72:79], v2
    ds_read_b128 v[72:75], v1 offset:34816
    ds_read_b128 v[76:79], v1 offset:35840
    v_smfmac_f32_16x16x64_bf16 v[112:115], v[36:39], v[80:87], v2
    ds_read_b128 v[80:83], v1 offset:49152
    ds_read_b128 v[84:87], v1 offset:50176
    v_smfmac_f32_16x16x64_bf16 v[116:119], v[36:39], v[88:95], v2
    ds_read_b128 v[88:91], v1 offset:51200
    ds_read_b128 v[92:95], v1 offset:52224
    s_waitcnt lgkmcnt(6)
    v_smfmac_f32_16x16x64_bf16 v[112:115], v[40:43], v[64:71], v2
    ds_read_b128 v[64:67], v5 offset:0
    ds_read_b128 v[68:71], v5 offset:1024
    s_waitcnt lgkmcnt(6)
    v_smfmac_f32_16x16x64_bf16 v[116:119], v[40:43], v[72:79], v2
    ds_read_b128 v[72:75], v5 offset:2048
    ds_read_b128 v[76:79], v5 offset:3072
    s_waitcnt lgkmcnt(6)
    v_smfmac_f32_16x16x64_bf16 v[112:115], v[44:47], v[80:87], v2
    ds_read_b128 v[80:83], v5 offset:16384
    ds_read_b128 v[84:87], v5 offset:17408
    s_waitcnt lgkmcnt(6)
    v_smfmac_f32_16x16x64_bf16 v[116:119], v[44:47], v[88:95], v2
    ds_read_b128 v[88:91], v5 offset:18432
    ds_read_b128 v[92:95], v5 offset:19456
    s_waitcnt lgkmcnt(6)
    v_smfmac_f32_16x16x64_bf16 v[112:115], v[48:51], v[64:71], v2
    ds_read_b128 v[64:67], v5 offset:32768
    ds_read_b128 v[68:71], v5 offset:33792
    s_waitcnt lgkmcnt(6)
    v_smfmac_f32_16x16x64_bf16 v[116:119], v[48:51], v[72:79], v2
    ds_read_b128 v[72:75], v5 offset:34816
    ds_read_b128 v[76:79], v5 offset:35840
    s_waitcnt lgkmcnt(6)
    v_smfmac_f32_16x16x64_bf16 v[112:115], v[52:55], v[80:87], v2
    ds_read_b128 v[80:83], v5 offset:49152
    ds_read_b128 v[84:87], v5 offset:50176
    s_waitcnt lgkmcnt(6)
    v_smfmac_f32_16x16x64_bf16 v[116:119], v[52:55], v[88:95], v2
    ds_read_b128 v[88:91], v5 offset:51200
    ds_read_b128 v[92:95], v5 offset:52224
    s_waitcnt lgkmcnt(6)
    v_smfmac_f32_16x16x64_bf16 v[112:115], v[56:59], v[64:71], v2
    s_waitcnt lgkmcnt(4)
    v_smfmac_f32_16x16x64_bf16 v[116:119], v[56:59], v[72:79], v2
    s_waitcnt lgkmcnt(2)
    v_smfmac_f32_16x16x64_bf16 v[112:115], v[60:63], v[80:87], v2
    s_waitcnt lgkmcnt(0)
    v_smfmac_f32_16x16x64_bf16 v[116:119], v[60:63], v[88:95], v2
    buffer_load_dwordx2 v[108:109], v11, s[4:7], s38 offen sc1
    v_mfma_f32_16x16x16_bf16 v[100:103], v[96:97], v[16:17], 0
    v_mfma_f32_16x16x16_bf16 v[104:107], v[98:99], v[16:17], 0
    s_nop 4
    v_add_f32 v112, v112, v114
    v_add_f32 v113, v113, v115
    v_add_f32 v114, v116, v118
    v_add_f32 v115, v117, v119
    v_cvt_pk_bf16_f32 v18, v112, v113
    v_cvt_pk_bf16_f32 v19, v114, v115
    v_and_or_b32 v18, v18, -2, s41
    buffer_load_dwordx2 v[110:111], v11, s[4:7], s38 offen offset:512 sc1
    s_barrier
    buffer_store_dwordx2 v[18:19], v11, s[4:7], s39 offen sc1
    v_mov_b32 v112, v18
    v_mov_b32 v114, v19
    v_mov_b32 v92, v28
    v_mov_b32 v93, 0
    s_waitcnt vmcnt(6)
    s_barrier
    ds_read_b128 v[32:35], v6 offset:9216
    ds_read_b128 v[36:39], v6 offset:10240
    ds_read_b128 v[40:43], v6 offset:14336
    ds_read_b128 v[44:47], v6 offset:15360
    ds_read_b128 v[48:51], v6 offset:19456
    ds_read_b128 v[52:55], v6 offset:20480
    ds_read_b128 v[56:59], v6 offset:24576
    ds_read_b128 v[60:63], v6 offset:25600
    buffer_load_dwordx2 v[20:21], v11, s[4:7], s38 offen sc1
    buffer_load_dwordx2 v[22:23], v11, s[4:7], s38 offen offset:512 sc1
    s_waitcnt vmcnt(4)
    v_mfma_f32_16x16x16_bf16 v[80:83], v[108:109], v[16:17], v[100:103]
    v_and_b32 v3, 1, v108
    v_cmp_ne_u32 vcc, s41, v3
    s_nop 5
    v_cvt_pk_bf16_f32 v64, v80, v81
    v_cvt_pk_bf16_f32 v65, v82, v83
    s_cbranch_vccnz mega_kernel_rs_w0_xslow
    s_waitcnt vmcnt(3)
    v_mfma_f32_16x16x16_bf16 v[84:87], v[110:111], v[16:17], v[104:107]
    v_and_b32 v3, 1, v110
    v_cmp_ne_u32 vcc, s41, v3
    s_nop 5
    v_cvt_pk_bf16_f32 v66, v84, v85
    v_cvt_pk_bf16_f32 v67, v86, v87
    ds_write_b128 v6, v[64:67] offset:8192
    s_cbranch_vccnz mega_kernel_rs_w0_xslow
mega_kernel_rs_w0_xok:
    s_cmp_eq_u32 s21, 63
    s_cbranch_scc1 mega_kernel_rs_w0_last
    buffer_load_dwordx2 v[116:117], v11, s[4:7], s40 offen sc1
    s_waitcnt lgkmcnt(1)
    v_mfma_f32_16x16x32_bf16 v[80:83], v[32:35], v[64:67], 0
    s_waitcnt lgkmcnt(0)
    s_barrier
    ds_read_b128 v[68:71], v6 offset:13312
    ds_read_b128 v[72:75], v6 offset:18432
    ds_read_b128 v[76:79], v6 offset:23552
    v_mfma_f32_16x16x32_bf16 v[84:87], v[36:39], v[64:67], 0
    v_mfma_f32_16x16x32_bf16 v[88:91], v[64:67], v[64:67], 0
    buffer_load_dwordx2 v[20:21], v11, s[4:7], s40 offen sc1
    s_waitcnt lgkmcnt(2)
    v_mfma_f32_16x16x32_bf16 v[80:83], v[40:43], v[68:71], v[80:83]
    buffer_store_dwordx4 v[64:67], v10, s[4:7], s45 offen offset:0 sc1
    s_waitcnt lgkmcnt(1)
    v_mfma_f32_16x16x32_bf16 v[80:83], v[48:51], v[72:75], v[80:83]
    s_waitcnt lgkmcnt(0)
    v_mfma_f32_16x16x32_bf16 v[80:83], v[56:59], v[76:79], v[80:83]
    v_mfma_f32_16x16x32_bf16 v[84:87], v[44:47], v[68:71], v[84:87]
    v_mfma_f32_16x16x32_bf16 v[84:87], v[52:55], v[72:75], v[84:87]
    buffer_store_dwordx2 v[18:19], v11, s[4:7], s51 offen offset:2048 sc1
    v_mfma_f32_16x16x32_bf16 v[84:87], v[60:63], v[76:79], v[84:87]
    v_mfma_f32_16x16x32_bf16 v[88:91], v[68:71], v[68:71], v[88:91]
    v_mfma_f32_16x16x32_bf16 v[88:91], v[72:75], v[72:75], v[88:91]
    v_mfma_f32_16x16x32_bf16 v[88:91], v[76:79], v[76:79], v[88:91]
    v_mfma_f32_32x32x4_2b_bf16 v[32:63], v[14:15], v[14:15], 0
    s_nop 0
    v_max3_f32 v4, v80, v81, v82
    s_nop 1
    v_max3_f32 v4, v4, v83, v84
    v_max3_f32 v4, v4, v85, v86
    v_max_f32 v4, v4, v87
    v_max3_f32 v90, v4, v88, v89
    v_max3_f32 v4, v4, v88, v89
    s_nop 1
    v_permlane16_swap_b32 v4, v90
    v_max_f32 v4, v4, v90
    v_max_f32 v90, v4, v90
    s_nop 1
    v_permlane32_swap_b32 v4, v90
    v_max_f32 v4, v4, v90
    v_mul_f32 v4, s34, v4
    v_pk_fma_f32 v[80:81], v[80:81], s[34:35], v[4:5] op_sel_hi:[1,0,0] neg_lo:[0,0,1] neg_hi:[0,0,1]
    v_pk_fma_f32 v[82:83], v[82:83], s[34:35], v[4:5] op_sel_hi:[1,0,0] neg_lo:[0,0,1] neg_hi:[0,0,1]
    v_pk_fma_f32 v[84:85], v[84:85], s[34:35], v[4:5] op_sel_hi:[1,0,0] neg_lo:[0,0,1] neg_hi:[0,0,1]
    v_pk_fma_f32 v[86:87], v[86:87], s[34:35], v[4:5] op_sel_hi:[1,0,0] neg_lo:[0,0,1] neg_hi:[0,0,1]
    v_pk_fma_f32 v[88:89], v[88:89], s[34:35], v[4:5] op_sel_hi:[1,0,0] neg_lo:[0,0,1] neg_hi:[0,0,1]
    v_exp_f32 v80, v80
    v_exp_f32 v81, v81
    v_exp_f32 v82, v82
    v_cvt_pk_bf16_f32 v68, v80, v81
    v_exp_f32 v83, v83
    v_exp_f32 v84, v84
    v_cvt_pk_bf16_f32 v69, v82, v83
    v_exp_f32 v85, v85
    v_exp_f32 v86, v86
    v_cvt_pk_bf16_f32 v70, v84, v85
    v_exp_f32 v87, v87
    v_exp_f32 v88, v88
    v_cvt_pk_bf16_f32 v71, v86, v87
    v_exp_f32 v89, v89
    s_waitcnt vmcnt(3)
    v_mfma_f32_16x16x32_bf16 v[76:79], v[28:31], v[68:71], 0
    v_and_b32 v3, 1, v116
    v_cvt_pk_bf16_f32 v72, v88, v89
    v_mfma_f32_16x16x32_bf16 v[100:103], v[120:123], v[68:71], 0
    v_cmp_ne_u32 vcc, s41, v3
    v_cvt_pk_bf16_f32 v73, v88, v89
    v_mfma_f32_16x16x32_bf16 v[104:107], v[124:127], v[68:71], 0
    v_mov_b32 v113, v116
    v_mov_b32 v115, v117
    v_mfma_f32_16x16x16_bf16 v[76:79], v[92:93], v[72:73], v[76:79]
    s_cbranch_vccnz mega_kernel_rs_w0_pv0
mega_kernel_rs_w0_pv2:
    v_mfma_f32_16x16x16_bf16 v[100:103], v[112:113], v[72:73], v[100:103]
    v_mfma_f32_16x16x16_bf16 v[104:107], v[114:115], v[72:73], v[104:107]
    buffer_load_dwordx4 v[120:123], v1, s[4:7], s44 offen
    buffer_load_dwordx4 v[124:127], v1, s[4:7], s44 offen offset:1024
    s_nop 2
    v_rcp_f32 v76, v76
    s_mov_b64 exec, s[28:29]
    v_pk_mul_f32 v[100:101], v[100:101], v[76:77] op_sel_hi:[1,0]
    v_pk_mul_f32 v[102:103], v[102:103], v[76:77] op_sel_hi:[1,0]
    v_pk_mul_f32 v[104:105], v[104:105], v[76:77] op_sel_hi:[1,0]
    v_pk_mul_f32 v[106:107], v[106:107], v[76:77] op_sel_hi:[1,0]
    v_cvt_pk_bf16_f32 v84, v100, v101
    v_cvt_pk_bf16_f32 v85, v102, v103
    v_cvt_pk_bf16_f32 v86, v104, v105
    v_cvt_pk_bf16_f32 v87, v106, v107
    ds_write_b128 v6, v[84:87] offset:28640
    s_mov_b64 exec, -1
    s_waitcnt lgkmcnt(0)
    s_barrier
    ds_read_b128 v[68:71], v6 offset:28672
    ds_read_b128 v[72:75], v6 offset:29696
    s_waitcnt lgkmcnt(1)
    v_smfmac_f32_16x16x64_bf16 v[32:35], v[68:71], v[128:135], v2
    s_add_u32 s21, s21, 1
    s_xor_b32 s38, s38, 1048576
    s_xor_b32 s37, s37, 1048576
    s_waitcnt lgkmcnt(0)
    v_smfmac_f32_16x16x64_bf16 v[32:35], v[72:75], v[136:143], v2
    s_xor_b32 s40, s40, 1048576
    s_xor_b32 s39, s39, 1048576
    s_lshr_b32 s41, s21, 1
    v_smfmac_f32_16x16x64_bf16 v[36:39], v[68:71], v[144:151], v2
    s_and_b32 s41, s41, 1
    s_xor_b32 s41, s41, 1
    s_xor_b32 s35, s35, 16384
    v_smfmac_f32_16x16x64_bf16 v[36:39], v[72:75], v[152:159], v2
    v_add_f32 v32, v32, v34
    s_xor_b32 s36, s36, 16384
    s_add_u32 s43, s43, 262144
    s_add_u32 s44, s44, 262144
    v_smfmac_f32_16x16x64_bf16 v[40:43], v[68:71], v[160:167], v2
    v_add_f32 v33, v33, v35
    v_smfmac_f32_16x16x64_bf16 v[40:43], v[72:75], v[168:175], v2
    v_cvt_pk_bf16_f32 v32, v32, v33
    v_smfmac_f32_16x16x64_bf16 v[44:47], v[68:71], v[176:183], v2
    v_and_or_b32 v32, v32, -2, s42
    v_smfmac_f32_16x16x64_bf16 v[44:47], v[72:75], v[184:191], v2
    v_add_f32 v36, v36, v38
    v_smfmac_f32_16x16x64_bf16 v[48:51], v[68:71], v[192:199], v2
    v_add_f32 v37, v37, v39
    v_smfmac_f32_16x16x64_bf16 v[48:51], v[72:75], v[200:207], v2
    v_cvt_pk_bf16_f32 v33, v36, v37
    v_smfmac_f32_16x16x64_bf16 v[52:55], v[68:71], v[208:215], v2
    v_add_f32 v40, v40, v42
    v_smfmac_f32_16x16x64_bf16 v[52:55], v[72:75], v[216:223], v2
    v_add_f32 v41, v41, v43
    v_smfmac_f32_16x16x64_bf16 v[56:59], v[68:71], v[224:231], v2
    v_cvt_pk_bf16_f32 v34, v40, v41
    v_smfmac_f32_16x16x64_bf16 v[56:59], v[72:75], v[232:239], v2
    v_add_f32 v44, v44, v46
    v_smfmac_f32_16x16x64_bf16 v[60:63], v[68:71], v[240:247], v2
    v_add_f32 v45, v45, v47
    v_smfmac_f32_16x16x64_bf16 v[60:63], v[72:75], v[248:255], v2
    v_cvt_pk_bf16_f32 v35, v44, v45
    buffer_store_dwordx4 v[32:35], v8, s[4:7], s46 offen sc1
    v_pk_add_f32 v[48:49], v[48:49], v[50:51]
    v_cvt_pk_bf16_f32 v48, v48, v49
    v_and_or_b32 v48, v48, -2, s42
    v_pk_add_f32 v[52:53], v[52:53], v[54:55]
    v_cvt_pk_bf16_f32 v49, v52, v53
    v_pk_add_f32 v[56:57], v[56:57], v[58:59]
    v_cvt_pk_bf16_f32 v50, v56, v57
    v_pk_add_f32 v[60:61], v[60:61], v[62:63]
    v_cvt_pk_bf16_f32 v51, v60, v61
    buffer_store_dwordx4 v[48:51], v8, s[4:7], s61 offen sc1
    s_add_u32 s45, s45, 262144
    s_add_u32 s51, s51, 262144
    v_mfma_f32_32x32x8_bf16 v[96:111], v[14:15], v[14:15], 0
    v_mfma_f32_16x16x16_bf16 v[112:115], v[14:15], v[14:15], 0
    v_mfma_f32_16x16x16_bf16 v[116:119], v[14:15], v[14:15], 0
    ds_read_b128 v[64:67], v1 offset:0
    ds_read_b128 v[68:71], v1 offset:1024
    ds_read_b128 v[72:75], v1 offset:2048
    ds_read_b128 v[76:79], v1 offset:3072
    ds_read_b128 v[80:83], v1 offset:16384
    ds_read_b128 v[84:87], v1 offset:17408
    ds_read_b128 v[88:91], v1 offset:18432
    ds_read_b128 v[92:95], v1 offset:19456
    v_mov_b32 v58, -1
    v_mov_b32 v59, -1
    s_waitcnt vmcnt(0)
mega_kernel_rs_w0_cgo:
mega_kernel_rs_w0_pc:
    buffer_load_dword v36, v13, s[4:7], s25 offen offset:0 sc1
    buffer_load_dword v37, v13, s[4:7], s25 offen offset:256 sc1
    buffer_load_dword v38, v13, s[4:7], s25 offen offset:512 sc1
    buffer_load_dword v39, v13, s[4:7], s25 offen offset:768 sc1
    buffer_load_dword v40, v13, s[4:7], s25 offen offset:1024 sc1
    buffer_load_dword v41, v13, s[4:7], s25 offen offset:1280 sc1
    buffer_load_dword v42, v13, s[4:7], s25 offen offset:1536 sc1
    buffer_load_dword v43, v13, s[4:7], s25 offen offset:1792 sc1
    s_waitcnt vmcnt(4)
    v_mfma_f32_16x16x32_bf16 v[52:55], v[36:39], v[24:27], 0
    v_bitop3_b32 v3, s42, v36, v37 bitop3:0x7e
    v_bitop3_b32 v4, s42, v38, v39 bitop3:0x7e
    s_waitcnt vmcnt(2)
    v_or_b32 v3, v3, v4
    v_bitop3_b32 v4, s42, v40, v41 bitop3:0x7e
    s_waitcnt vmcnt(0)
    v_mfma_f32_16x16x32_bf16 v[52:55], v[40:43], v[24:27], v[52:55]
    v_bitop3_b32 v56, s42, v42, v43 bitop3:0x7e
    v_or3_b32 v3, v3, v4, v56
    v_and_b32 v3, v0, v3
    v_cmp_ne_u32 vcc, 0, v3
    s_nop 3
    v_cvt_pk_bf16_f32 v56, v52, v53
    v_cvt_pk_bf16_f32 v57, v54, v55
    v_min_u32 v56, -2, v56
    s_cbranch_vccnz mega_kernel_rs_w0_pc
    s_mov_b64 exec, s[26:27]
    buffer_store_dwordx2 v[56:57], v9, s[4:7], s35 offen offset:0 sc1
    buffer_store_dwordx2 v[58:59], v9, s[4:7], s36 offen offset:0 sc1
    s_mov_b64 exec, -1
    s_xor_b32 s42, s42, 1
    s_branch mega_kernel_rs_w0_loop
mega_kernel_rs_w0_last:
    buffer_store_dwordx4 v[64:67], v10, s[4:7], s45 offen offset:0 sc1
    buffer_store_dwordx2 v[18:19], v11, s[4:7], s51 offen offset:2048 sc1
    s_branch mega_kernel_rs_end
mega_kernel_rs_w0_pafail:
    s_nop 7
    v_mov_b32 v96, 0
    v_mov_b32 v97, 0
    v_mov_b32 v98, 0
    v_mov_b32 v99, 0
    v_mov_b32 v100, 0
    v_mov_b32 v101, 0
    v_mov_b32 v102, 0
    v_mov_b32 v103, 0
    v_mov_b32 v104, 0
    v_mov_b32 v105, 0
    v_mov_b32 v106, 0
    v_mov_b32 v107, 0
    s_branch mega_kernel_rs_w0_pa
mega_kernel_rs_w0_xslow:
    buffer_load_dwordx2 v[108:109], v11, s[4:7], s38 offen sc1
    buffer_load_dwordx2 v[110:111], v11, s[4:7], s38 offen offset:512 sc1
    s_waitcnt vmcnt(2)
    v_bitop3_b32 v3, s41, v20, v22 bitop3:0x7e
    v_mfma_f32_16x16x16_bf16 v[80:83], v[20:21], v[16:17], v[100:103]
    v_and_b32 v3, 1, v3
    v_mfma_f32_16x16x16_bf16 v[84:87], v[22:23], v[16:17], v[104:107]
    v_cmp_ne_u32 vcc, 0, v3
    s_cbranch_vccz mega_kernel_rs_w0_xgot
    buffer_load_dwordx2 v[20:21], v11, s[4:7], s38 offen sc1
    buffer_load_dwordx2 v[22:23], v11, s[4:7], s38 offen offset:512 sc1
    s_waitcnt vmcnt(2)
    v_bitop3_b32 v3, s41, v108, v110 bitop3:0x7e
    v_mfma_f32_16x16x16_bf16 v[80:83], v[108:109], v[16:17], v[100:103]
    v_and_b32 v3, 1, v3
    v_mfma_f32_16x16x16_bf16 v[84:87], v[110:111], v[16:17], v[104:107]
    v_cmp_ne_u32 vcc, 0, v3
    s_cbranch_vccz mega_kernel_rs_w0_xgot
    s_branch mega_kernel_rs_w0_xslow
mega_kernel_rs_w0_xgot:
    s_nop 3
    v_cvt_pk_bf16_f32 v64, v80, v81
    v_cvt_pk_bf16_f32 v65, v82, v83
    v_cvt_pk_bf16_f32 v66, v84, v85
    v_cvt_pk_bf16_f32 v67, v86, v87
    ds_write_b128 v6, v[64:67] offset:8192
    s_branch mega_kernel_rs_w0_xok
mega_kernel_rs_w0_pv0:
    s_waitcnt vmcnt(2)
    s_branch mega_kernel_rs_w0_pv1
mega_kernel_rs_w0_pv:
    buffer_load_dwordx2 v[20:21], v11, s[4:7], s40 offen sc1
    s_waitcnt vmcnt(0)
mega_kernel_rs_w0_pv1:
    v_and_b32 v3, 1, v20
    v_cmp_ne_u32 vcc, s41, v3
    v_mov_b32 v113, v20
    v_mov_b32 v115, v21
    s_cbranch_vccnz mega_kernel_rs_w0_pv
    s_branch mega_kernel_rs_w0_pv2
mega_kernel_rs_w1_entry:
    v_mfma_f32_32x32x8_bf16 v[96:111], v[14:15], v[14:15], 0
    v_mfma_f32_16x16x16_bf16 v[112:115], v[14:15], v[14:15], 0
    v_mfma_f32_16x16x16_bf16 v[116:119], v[14:15], v[14:15], 0
    ds_read_b128 v[64:67], v1 offset:4096
    ds_read_b128 v[68:71], v1 offset:5120
    ds_read_b128 v[72:75], v1 offset:6144
    ds_read_b128 v[76:79], v1 offset:7168
    ds_read_b128 v[80:83], v1 offset:20480
    ds_read_b128 v[84:87], v1 offset:21504
    ds_read_b128 v[88:91], v1 offset:22528
    ds_read_b128 v[92:95], v1 offset:23552
    buffer_load_dwordx4 v[120:123], v1, s[4:7], s44 offen
    buffer_load_dwordx4 v[124:127], v1, s[4:7], s44 offen offset:1024
    s_add_u32 s44, s44, 262144
mega_kernel_rs_w1_loop:
    s_add_u32 s22, s35, 2048
    s_waitcnt vmcnt(0)
    buffer_load_dwordx4 v[40:43], v1, s[4:7], s22 offen sc1
    buffer_load_dwordx4 v[44:47], v1, s[4:7], s22 offen offset:1024 sc1
mega_kernel_rs_w1_pa:
    s_waitcnt vmcnt(1)
    ds_write_b128 v6, v[40:43] offset:2048
    s_waitcnt vmcnt(0)
    ds_write_b128 v6, v[44:47] offset:3072
    v_max3_u32 v3, v40, v42, v44
    v_max_u32 v3, v3, v46
    v_cmp_eq_u32 vcc, -1, v3
    v_smfmac_f32_16x16x64_bf16 v[96:99], v[40:43], a[32:39], v2
    buffer_load_dwordx4 v[40:43], v1, s[4:7], s22 offen sc1
    v_smfmac_f32_16x16x64_bf16 v[100:103], v[40:43], a[40:47], v2
    buffer_load_dwordx4 v[44:47], v1, s[4:7], s22 offen offset:1024 sc1
    v_smfmac_f32_16x16x64_bf16 v[104:107], v[40:43], a[160:167], v2
    s_cbranch_vccnz mega_kernel_rs_w1_pafail
    s_waitcnt lgkmcnt(0)
    s_barrier
    ds_read_b128 v[48:51], v6 offset:4096
    ds_read_b128 v[52:55], v6 offset:5120
    v_smfmac_f32_16x16x64_bf16 v[108:111], v[40:43], a[168:175], v2
    ds_read_b128 v[56:59], v6 offset:6144
    v_smfmac_f32_16x16x64_bf16 v[96:99], v[44:47], a[48:55], v2
    ds_read_b128 v[60:63], v6 offset:7168
    v_smfmac_f32_16x16x64_bf16 v[100:103], v[44:47], a[56:63], v2
    ds_read_b128 v[32:35], v6 offset:0
    v_smfmac_f32_16x16x64_bf16 v[104:107], v[44:47], a[176:183], v2
    ds_read_b128 v[36:39], v6 offset:1024
    v_smfmac_f32_16x16x64_bf16 v[108:111], v[44:47], a[184:191], v2
    s_waitcnt lgkmcnt(5)
    v_smfmac_f32_16x16x64_bf16 v[96:99], v[48:51], a[64:71], v2
    buffer_load_dwordx4 v1, s[4:7], s43 offen lds
    v_smfmac_f32_16x16x64_bf16 v[104:107], v[48:51], a[192:199], v2
    s_waitcnt lgkmcnt(4)
    v_smfmac_f32_16x16x64_bf16 v[96:99], v[52:55], a[80:87], v2
    v_smfmac_f32_16x16x64_bf16 v[104:107], v[52:55], a[208:215], v2
    s_waitcnt lgkmcnt(3)
    v_smfmac_f32_16x16x64_bf16 v[96:99], v[56:59], a[96:103], v2
    buffer_load_dwordx4 v1, s[4:7], s43 offen offset:1024 lds
    v_smfmac_f32_16x16x64_bf16 v[104:107], v[56:59], a[224:231], v2
    s_waitcnt lgkmcnt(2)
    v_smfmac_f32_16x16x64_bf16 v[96:99], v[60:63], a[112:119], v2
    v_smfmac_f32_16x16x64_bf16 v[104:107], v[60:63], a[240:247], v2
    s_waitcnt lgkmcnt(1)
    v_smfmac_f32_16x16x64_bf16 v[96:99], v[32:35], a[0:7], v2
    v_smfmac_f32_16x16x64_bf16 v[104:107], v[32:35], a[128:135], v2
    s_waitcnt lgkmcnt(0)
    v_smfmac_f32_16x16x64_bf16 v[96:99], v[36:39], a[16:23], v2
    v_smfmac_f32_16x16x64_bf16 v[104:107], v[36:39], a[144:151], v2
    v_smfmac_f32_16x16x64_bf16 v[100:103], v[48:51], a[72:79], v2
    s_nop 2
    v_smfmac_f32_16x16x64_bf16 v[100:103], v[52:55], a[88:95], v2
    s_nop 1
    v_add_f32 v96, v96, v98
    v_smfmac_f32_16x16x64_bf16 v[100:103], v[56:59], a[104:111], v2
    v_add_f32 v97, v97, v99
    v_add_f32 v104, v104, v106
    v_smfmac_f32_16x16x64_bf16 v[100:103], v[60:63], a[120:127], v2
    v_add_f32 v105, v105, v107
    v_cvt_pk_bf16_f32 v96, v96, v97
    v_smfmac_f32_16x16x64_bf16 v[100:103], v[32:35], a[8:15], v2
    v_cvt_pk_bf16_f32 v97, v104, v105
    v_and_or_b32 v96, v96, -2, s41
    v_smfmac_f32_16x16x64_bf16 v[100:103], v[36:39], a[24:31], v2
    buffer_store_dwordx2 v[96:97], v11, s[4:7], s37 offen sc1
    v_smfmac_f32_16x16x64_bf16 v[108:111], v[48:51], a[200:207], v2
    v_smfmac_f32_16x16x64_bf16 v[108:111], v[52:55], a[216:223], v2
    v_smfmac_f32_16x16x64_bf16 v[108:111], v[56:59], a[232:239], v2
    v_smfmac_f32_16x16x64_bf16 v[108:111], v[60:63], a[248:255], v2
    v_smfmac_f32_16x16x64_bf16 v[108:111], v[32:35], a[136:143], v2
    s_nop 2
    v_add_f32 v100, v100, v102
    v_smfmac_f32_16x16x64_bf16 v[108:111], v[36:39], a[152:159], v2
    v_add_f32 v101, v101, v103
    v_cvt_pk_bf16_f32 v98, v100, v101
    v_and_or_b32 v98, v98, -2, s41
    s_nop 4
    v_pk_add_f32 v[108:109], v[108:109], v[110:111]
    v_cvt_pk_bf16_f32 v99, v108, v109
    buffer_store_dwordx2 v[98:99], v11, s[4:7], s37 offen offset:512 sc1
    v_smfmac_f32_16x16x64_bf16 v[112:115], v[32:35], v[64:71], v2
    ds_read_b128 v[64:67], v1 offset:36864
    ds_read_b128 v[68:71], v1 offset:37888
    v_smfmac_f32_16x16x64_bf16 v[116:119], v[32:35], v[72:79], v2
    ds_read_b128 v[72:75], v1 offset:38912
    ds_read_b128 v[76:79], v1 offset:39936
    v_smfmac_f32_16x16x64_bf16 v[112:115], v[36:39], v[80:87], v2
    ds_read_b128 v[80:83], v1 offset:53248
    ds_read_b128 v[84:87], v1 offset:54272
    v_smfmac_f32_16x16x64_bf16 v[116:119], v[36:39], v[88:95], v2
    ds_read_b128 v[88:91], v1 offset:55296
    ds_read_b128 v[92:95], v1 offset:56320
    s_waitcnt lgkmcnt(6)
    v_smfmac_f32_16x16x64_bf16 v[112:115], v[40:43], v[64:71], v2
    ds_read_b128 v[64:67], v5 offset:4096
    ds_read_b128 v[68:71], v5 offset:5120
    s_waitcnt lgkmcnt(6)
    v_smfmac_f32_16x16x64_bf16 v[116:119], v[40:43], v[72:79], v2
    ds_read_b128 v[72:75], v5 offset:6144
    ds_read_b128 v[76:79], v5 offset:7168
    s_waitcnt lgkmcnt(6)
    v_smfmac_f32_16x16x64_bf16 v[112:115], v[44:47], v[80:87], v2
    ds_read_b128 v[80:83], v5 offset:20480
    ds_read_b128 v[84:87], v5 offset:21504
    s_waitcnt lgkmcnt(6)
    v_smfmac_f32_16x16x64_bf16 v[116:119], v[44:47], v[88:95], v2
    ds_read_b128 v[88:91], v5 offset:22528
    ds_read_b128 v[92:95], v5 offset:23552
    s_waitcnt lgkmcnt(6)
    v_smfmac_f32_16x16x64_bf16 v[112:115], v[48:51], v[64:71], v2
    ds_read_b128 v[64:67], v5 offset:36864
    ds_read_b128 v[68:71], v5 offset:37888
    s_waitcnt lgkmcnt(6)
    v_smfmac_f32_16x16x64_bf16 v[116:119], v[48:51], v[72:79], v2
    ds_read_b128 v[72:75], v5 offset:38912
    ds_read_b128 v[76:79], v5 offset:39936
    s_waitcnt lgkmcnt(6)
    v_smfmac_f32_16x16x64_bf16 v[112:115], v[52:55], v[80:87], v2
    ds_read_b128 v[80:83], v5 offset:53248
    ds_read_b128 v[84:87], v5 offset:54272
    s_waitcnt lgkmcnt(6)
    v_smfmac_f32_16x16x64_bf16 v[116:119], v[52:55], v[88:95], v2
    ds_read_b128 v[88:91], v5 offset:55296
    ds_read_b128 v[92:95], v5 offset:56320
    s_waitcnt lgkmcnt(6)
    v_smfmac_f32_16x16x64_bf16 v[112:115], v[56:59], v[64:71], v2
    s_waitcnt lgkmcnt(4)
    v_smfmac_f32_16x16x64_bf16 v[116:119], v[56:59], v[72:79], v2
    s_waitcnt lgkmcnt(2)
    v_smfmac_f32_16x16x64_bf16 v[112:115], v[60:63], v[80:87], v2
    s_waitcnt lgkmcnt(0)
    v_smfmac_f32_16x16x64_bf16 v[116:119], v[60:63], v[88:95], v2
    buffer_load_dwordx2 v[108:109], v11, s[4:7], s38 offen sc1
    v_mfma_f32_16x16x16_bf16 v[100:103], v[96:97], v[16:17], 0
    v_mfma_f32_16x16x16_bf16 v[104:107], v[98:99], v[16:17], 0
    s_nop 4
    v_add_f32 v112, v112, v114
    v_add_f32 v113, v113, v115
    v_add_f32 v114, v116, v118
    v_add_f32 v115, v117, v119
    v_cvt_pk_bf16_f32 v18, v112, v113
    v_cvt_pk_bf16_f32 v19, v114, v115
    v_and_or_b32 v18, v18, -2, s41
    buffer_load_dwordx2 v[110:111], v11, s[4:7], s38 offen offset:512 sc1
    s_barrier
    buffer_store_dwordx2 v[18:19], v11, s[4:7], s39 offen sc1
    v_mov_b32 v112, v18
    v_mov_b32 v114, v19
    v_mov_b32 v92, v28
    v_mov_b32 v93, 0
    s_waitcnt vmcnt(5)
    s_barrier
    ds_read_b128 v[32:35], v6 offset:14336
    ds_read_b128 v[36:39], v6 offset:15360
    ds_read_b128 v[40:43], v6 offset:9216
    ds_read_b128 v[44:47], v6 offset:10240
    ds_read_b128 v[48:51], v6 offset:24576
    ds_read_b128 v[52:55], v6 offset:25600
    ds_read_b128 v[56:59], v6 offset:19456
    ds_read_b128 v[60:63], v6 offset:20480
    buffer_load_dwordx2 v[20:21], v11, s[4:7], s38 offen sc1
    buffer_load_dwordx2 v[22:23], v11, s[4:7], s38 offen offset:512 sc1
    s_waitcnt vmcnt(4)
    v_mfma_f32_16x16x16_bf16 v[80:83], v[108:109], v[16:17], v[100:103]
    v_and_b32 v3, 1, v108
    v_cmp_ne_u32 vcc, s41, v3
    s_nop 5
    v_cvt_pk_bf16_f32 v64, v80, v81
    v_cvt_pk_bf16_f32 v65, v82, v83
    s_cbranch_vccnz mega_kernel_rs_w1_xslow
    s_waitcnt vmcnt(3)
    v_mfma_f32_16x16x16_bf16 v[84:87], v[110:111], v[16:17], v[104:107]
    v_and_b32 v3, 1, v110
    v_cmp_ne_u32 vcc, s41, v3
    s_nop 5
    v_cvt_pk_bf16_f32 v66, v84, v85
    v_cvt_pk_bf16_f32 v67, v86, v87
    ds_write_b128 v6, v[64:67] offset:13312
    s_cbranch_vccnz mega_kernel_rs_w1_xslow
mega_kernel_rs_w1_xok:
    s_cmp_eq_u32 s21, 63
    s_cbranch_scc1 mega_kernel_rs_w1_last
    buffer_load_dwordx2 v[116:117], v11, s[4:7], s40 offen sc1
    s_waitcnt lgkmcnt(1)
    v_mfma_f32_16x16x32_bf16 v[80:83], v[32:35], v[64:67], 0
    s_waitcnt lgkmcnt(0)
    s_barrier
    ds_read_b128 v[68:71], v6 offset:8192
    ds_read_b128 v[72:75], v6 offset:23552
    ds_read_b128 v[76:79], v6 offset:18432
    v_mfma_f32_16x16x32_bf16 v[84:87], v[36:39], v[64:67], 0
    v_mfma_f32_16x16x32_bf16 v[88:91], v[64:67], v[64:67], 0
    buffer_load_dwordx2 v[20:21], v11, s[4:7], s40 offen sc1
    s_waitcnt lgkmcnt(2)
    v_mfma_f32_16x16x32_bf16 v[80:83], v[40:43], v[68:71], v[80:83]
    s_waitcnt lgkmcnt(1)
    v_mfma_f32_16x16x32_bf16 v[80:83], v[48:51], v[72:75], v[80:83]
    buffer_store_dwordx4 v[64:67], v10, s[4:7], s45 offen offset:64 sc1
    s_waitcnt lgkmcnt(0)
    v_mfma_f32_16x16x32_bf16 v[80:83], v[56:59], v[76:79], v[80:83]
    v_mfma_f32_16x16x32_bf16 v[84:87], v[44:47], v[68:71], v[84:87]
    v_mfma_f32_16x16x32_bf16 v[84:87], v[52:55], v[72:75], v[84:87]
    v_mfma_f32_16x16x32_bf16 v[84:87], v[60:63], v[76:79], v[84:87]
    buffer_store_dwordx2 v[18:19], v11, s[4:7], s51 offen offset:2560 sc1
    v_mfma_f32_16x16x32_bf16 v[88:91], v[68:71], v[68:71], v[88:91]
    v_mfma_f32_16x16x32_bf16 v[88:91], v[72:75], v[72:75], v[88:91]
    v_mfma_f32_16x16x32_bf16 v[88:91], v[76:79], v[76:79], v[88:91]
    v_mfma_f32_32x32x4_2b_bf16 v[32:63], v[14:15], v[14:15], 0
    s_nop 0
    v_max3_f32 v4, v80, v81, v82
    s_nop 1
    v_max3_f32 v4, v4, v83, v84
    v_max3_f32 v4, v4, v85, v86
    v_max_f32 v4, v4, v87
    v_max3_f32 v90, v4, v88, v89
    v_max3_f32 v4, v4, v88, v89
    s_nop 1
    v_permlane16_swap_b32 v4, v90
    v_max_f32 v4, v4, v90
    v_max_f32 v90, v4, v90
    s_nop 1
    v_permlane32_swap_b32 v4, v90
    v_max_f32 v4, v4, v90
    v_mul_f32 v4, s34, v4
    v_pk_fma_f32 v[80:81], v[80:81], s[34:35], v[4:5] op_sel_hi:[1,0,0] neg_lo:[0,0,1] neg_hi:[0,0,1]
    v_pk_fma_f32 v[82:83], v[82:83], s[34:35], v[4:5] op_sel_hi:[1,0,0] neg_lo:[0,0,1] neg_hi:[0,0,1]
    v_pk_fma_f32 v[84:85], v[84:85], s[34:35], v[4:5] op_sel_hi:[1,0,0] neg_lo:[0,0,1] neg_hi:[0,0,1]
    v_pk_fma_f32 v[86:87], v[86:87], s[34:35], v[4:5] op_sel_hi:[1,0,0] neg_lo:[0,0,1] neg_hi:[0,0,1]
    v_pk_fma_f32 v[88:89], v[88:89], s[34:35], v[4:5] op_sel_hi:[1,0,0] neg_lo:[0,0,1] neg_hi:[0,0,1]
    v_exp_f32 v80, v80
    v_exp_f32 v81, v81
    v_exp_f32 v82, v82
    v_cvt_pk_bf16_f32 v68, v80, v81
    v_exp_f32 v83, v83
    v_exp_f32 v84, v84
    v_cvt_pk_bf16_f32 v69, v82, v83
    v_exp_f32 v85, v85
    v_exp_f32 v86, v86
    v_cvt_pk_bf16_f32 v70, v84, v85
    v_exp_f32 v87, v87
    v_exp_f32 v88, v88
    v_cvt_pk_bf16_f32 v71, v86, v87
    v_exp_f32 v89, v89
    s_waitcnt vmcnt(3)
    v_mfma_f32_16x16x32_bf16 v[76:79], v[28:31], v[68:71], 0
    v_and_b32 v3, 1, v116
    v_cvt_pk_bf16_f32 v72, v88, v89
    v_mfma_f32_16x16x32_bf16 v[100:103], v[120:123], v[68:71], 0
    v_cmp_ne_u32 vcc, s41, v3
    v_cvt_pk_bf16_f32 v73, v88, v89
    v_mfma_f32_16x16x32_bf16 v[104:107], v[124:127], v[68:71], 0
    v_mov_b32 v113, v116
    v_mov_b32 v115, v117
    v_mfma_f32_16x16x16_bf16 v[76:79], v[92:93], v[72:73], v[76:79]
    s_cbranch_vccnz mega_kernel_rs_w1_pv0
mega_kernel_rs_w1_pv2:
    v_mfma_f32_16x16x16_bf16 v[100:103], v[112:113], v[72:73], v[100:103]
    v_mfma_f32_16x16x16_bf16 v[104:107], v[114:115], v[72:73], v[104:107]
    buffer_load_dwordx4 v[120:123], v1, s[4:7], s44 offen
    buffer_load_dwordx4 v[124:127], v1, s[4:7], s44 offen offset:1024
    s_nop 2
    v_rcp_f32 v76, v76
    s_mov_b64 exec, s[28:29]
    v_pk_mul_f32 v[100:101], v[100:101], v[76:77] op_sel_hi:[1,0]
    v_pk_mul_f32 v[102:103], v[102:103], v[76:77] op_sel_hi:[1,0]
    v_pk_mul_f32 v[104:105], v[104:105], v[76:77] op_sel_hi:[1,0]
    v_pk_mul_f32 v[106:107], v[106:107], v[76:77] op_sel_hi:[1,0]
    v_cvt_pk_bf16_f32 v84, v100, v101
    v_cvt_pk_bf16_f32 v85, v102, v103
    v_cvt_pk_bf16_f32 v86, v104, v105
    v_cvt_pk_bf16_f32 v87, v106, v107
    ds_write_b128 v6, v[84:87] offset:28672
    s_mov_b64 exec, -1
    s_waitcnt lgkmcnt(0)
    s_barrier
    ds_read_b128 v[68:71], v6 offset:28672
    ds_read_b128 v[72:75], v6 offset:29696
    s_waitcnt lgkmcnt(1)
    v_smfmac_f32_16x16x64_bf16 v[32:35], v[68:71], v[128:135], v2
    s_add_u32 s21, s21, 1
    s_xor_b32 s38, s38, 1048576
    s_xor_b32 s37, s37, 1048576
    s_waitcnt lgkmcnt(0)
    v_smfmac_f32_16x16x64_bf16 v[32:35], v[72:75], v[136:143], v2
    s_xor_b32 s40, s40, 1048576
    s_xor_b32 s39, s39, 1048576
    s_lshr_b32 s41, s21, 1
    v_smfmac_f32_16x16x64_bf16 v[36:39], v[68:71], v[144:151], v2
    s_and_b32 s41, s41, 1
    s_xor_b32 s41, s41, 1
    s_xor_b32 s35, s35, 16384
    v_smfmac_f32_16x16x64_bf16 v[36:39], v[72:75], v[152:159], v2
    v_add_f32 v32, v32, v34
    s_xor_b32 s36, s36, 16384
    s_add_u32 s43, s43, 262144
    s_add_u32 s44, s44, 262144
    v_smfmac_f32_16x16x64_bf16 v[40:43], v[68:71], v[160:167], v2
    v_add_f32 v33, v33, v35
    v_smfmac_f32_16x16x64_bf16 v[40:43], v[72:75], v[168:175], v2
    v_cvt_pk_bf16_f32 v32, v32, v33
    v_smfmac_f32_16x16x64_bf16 v[44:47], v[68:71], v[176:183], v2
    v_and_or_b32 v32, v32, -2, s42
    v_smfmac_f32_16x16x64_bf16 v[44:47], v[72:75], v[184:191], v2
    v_add_f32 v36, v36, v38
    v_smfmac_f32_16x16x64_bf16 v[48:51], v[68:71], v[192:199], v2
    v_add_f32 v37, v37, v39
    v_smfmac_f32_16x16x64_bf16 v[48:51], v[72:75], v[200:207], v2
    v_cvt_pk_bf16_f32 v33, v36, v37
    v_smfmac_f32_16x16x64_bf16 v[52:55], v[68:71], v[208:215], v2
    v_add_f32 v40, v40, v42
    v_smfmac_f32_16x16x64_bf16 v[52:55], v[72:75], v[216:223], v2
    v_add_f32 v41, v41, v43
    v_smfmac_f32_16x16x64_bf16 v[56:59], v[68:71], v[224:231], v2
    v_cvt_pk_bf16_f32 v34, v40, v41
    v_smfmac_f32_16x16x64_bf16 v[56:59], v[72:75], v[232:239], v2
    v_add_f32 v44, v44, v46
    v_smfmac_f32_16x16x64_bf16 v[60:63], v[68:71], v[240:247], v2
    v_add_f32 v45, v45, v47
    v_smfmac_f32_16x16x64_bf16 v[60:63], v[72:75], v[248:255], v2
    v_cvt_pk_bf16_f32 v35, v44, v45
    buffer_store_dwordx4 v[32:35], v8, s[4:7], s46 offen sc1
    v_pk_add_f32 v[48:49], v[48:49], v[50:51]
    v_cvt_pk_bf16_f32 v48, v48, v49
    v_and_or_b32 v48, v48, -2, s42
    v_pk_add_f32 v[52:53], v[52:53], v[54:55]
    v_cvt_pk_bf16_f32 v49, v52, v53
    v_pk_add_f32 v[56:57], v[56:57], v[58:59]
    v_cvt_pk_bf16_f32 v50, v56, v57
    v_pk_add_f32 v[60:61], v[60:61], v[62:63]
    v_cvt_pk_bf16_f32 v51, v60, v61
    buffer_store_dwordx4 v[48:51], v8, s[4:7], s61 offen sc1
    s_add_u32 s45, s45, 262144
    s_add_u32 s51, s51, 262144
    v_mfma_f32_32x32x8_bf16 v[96:111], v[14:15], v[14:15], 0
    v_mfma_f32_16x16x16_bf16 v[112:115], v[14:15], v[14:15], 0
    v_mfma_f32_16x16x16_bf16 v[116:119], v[14:15], v[14:15], 0
    ds_read_b128 v[64:67], v1 offset:4096
    ds_read_b128 v[68:71], v1 offset:5120
    ds_read_b128 v[72:75], v1 offset:6144
    ds_read_b128 v[76:79], v1 offset:7168
    ds_read_b128 v[80:83], v1 offset:20480
    ds_read_b128 v[84:87], v1 offset:21504
    ds_read_b128 v[88:91], v1 offset:22528
    ds_read_b128 v[92:95], v1 offset:23552
    v_mov_b32 v58, -1
    v_mov_b32 v59, -1
    s_waitcnt vmcnt(0)
mega_kernel_rs_w1_cgo:
mega_kernel_rs_w1_pc:
    buffer_load_dword v36, v13, s[4:7], s25 offen offset:0 sc1
    buffer_load_dword v37, v13, s[4:7], s25 offen offset:256 sc1
    buffer_load_dword v38, v13, s[4:7], s25 offen offset:512 sc1
    buffer_load_dword v39, v13, s[4:7], s25 offen offset:768 sc1
    buffer_load_dword v40, v13, s[4:7], s25 offen offset:1024 sc1
    buffer_load_dword v41, v13, s[4:7], s25 offen offset:1280 sc1
    buffer_load_dword v42, v13, s[4:7], s25 offen offset:1536 sc1
    buffer_load_dword v43, v13, s[4:7], s25 offen offset:1792 sc1
    s_waitcnt vmcnt(4)
    v_mfma_f32_16x16x32_bf16 v[52:55], v[36:39], v[24:27], 0
    v_bitop3_b32 v3, s42, v36, v37 bitop3:0x7e
    v_bitop3_b32 v4, s42, v38, v39 bitop3:0x7e
    s_waitcnt vmcnt(2)
    v_or_b32 v3, v3, v4
    v_bitop3_b32 v4, s42, v40, v41 bitop3:0x7e
    s_waitcnt vmcnt(0)
    v_mfma_f32_16x16x32_bf16 v[52:55], v[40:43], v[24:27], v[52:55]
    v_bitop3_b32 v56, s42, v42, v43 bitop3:0x7e
    v_or3_b32 v3, v3, v4, v56
    v_and_b32 v3, v0, v3
    v_cmp_ne_u32 vcc, 0, v3
    s_nop 3
    v_cvt_pk_bf16_f32 v56, v52, v53
    v_cvt_pk_bf16_f32 v57, v54, v55
    v_min_u32 v56, -2, v56
    s_cbranch_vccnz mega_kernel_rs_w1_pc
    s_mov_b64 exec, s[26:27]
    buffer_store_dwordx2 v[56:57], v9, s[4:7], s35 offen offset:256 sc1
    buffer_store_dwordx2 v[58:59], v9, s[4:7], s36 offen offset:256 sc1
    s_mov_b64 exec, -1
    s_xor_b32 s42, s42, 1
    s_branch mega_kernel_rs_w1_loop
mega_kernel_rs_w1_last:
    buffer_store_dwordx4 v[64:67], v10, s[4:7], s45 offen offset:64 sc1
    buffer_store_dwordx2 v[18:19], v11, s[4:7], s51 offen offset:2560 sc1
    s_branch mega_kernel_rs_end
mega_kernel_rs_w1_pafail:
    s_nop 7
    v_mov_b32 v96, 0
    v_mov_b32 v97, 0
    v_mov_b32 v98, 0
    v_mov_b32 v99, 0
    v_mov_b32 v100, 0
    v_mov_b32 v101, 0
    v_mov_b32 v102, 0
    v_mov_b32 v103, 0
    v_mov_b32 v104, 0
    v_mov_b32 v105, 0
    v_mov_b32 v106, 0
    v_mov_b32 v107, 0
    s_branch mega_kernel_rs_w1_pa
mega_kernel_rs_w1_xslow:
    buffer_load_dwordx2 v[108:109], v11, s[4:7], s38 offen sc1
    buffer_load_dwordx2 v[110:111], v11, s[4:7], s38 offen offset:512 sc1
    s_waitcnt vmcnt(2)
    v_bitop3_b32 v3, s41, v20, v22 bitop3:0x7e
    v_mfma_f32_16x16x16_bf16 v[80:83], v[20:21], v[16:17], v[100:103]
    v_and_b32 v3, 1, v3
    v_mfma_f32_16x16x16_bf16 v[84:87], v[22:23], v[16:17], v[104:107]
    v_cmp_ne_u32 vcc, 0, v3
    s_cbranch_vccz mega_kernel_rs_w1_xgot
    buffer_load_dwordx2 v[20:21], v11, s[4:7], s38 offen sc1
    buffer_load_dwordx2 v[22:23], v11, s[4:7], s38 offen offset:512 sc1
    s_waitcnt vmcnt(2)
    v_bitop3_b32 v3, s41, v108, v110 bitop3:0x7e
    v_mfma_f32_16x16x16_bf16 v[80:83], v[108:109], v[16:17], v[100:103]
    v_and_b32 v3, 1, v3
    v_mfma_f32_16x16x16_bf16 v[84:87], v[110:111], v[16:17], v[104:107]
    v_cmp_ne_u32 vcc, 0, v3
    s_cbranch_vccz mega_kernel_rs_w1_xgot
    s_branch mega_kernel_rs_w1_xslow
mega_kernel_rs_w1_xgot:
    s_nop 3
    v_cvt_pk_bf16_f32 v64, v80, v81
    v_cvt_pk_bf16_f32 v65, v82, v83
    v_cvt_pk_bf16_f32 v66, v84, v85
    v_cvt_pk_bf16_f32 v67, v86, v87
    ds_write_b128 v6, v[64:67] offset:13312
    s_branch mega_kernel_rs_w1_xok
mega_kernel_rs_w1_pv0:
    s_waitcnt vmcnt(2)
    s_branch mega_kernel_rs_w1_pv1
mega_kernel_rs_w1_pv:
    buffer_load_dwordx2 v[20:21], v11, s[4:7], s40 offen sc1
    s_waitcnt vmcnt(0)
mega_kernel_rs_w1_pv1:
    v_and_b32 v3, 1, v20
    v_cmp_ne_u32 vcc, s41, v3
    v_mov_b32 v113, v20
    v_mov_b32 v115, v21
    s_cbranch_vccnz mega_kernel_rs_w1_pv
    s_branch mega_kernel_rs_w1_pv2
mega_kernel_rs_w2_entry:
    v_mfma_f32_32x32x8_bf16 v[96:111], v[14:15], v[14:15], 0
    v_mfma_f32_16x16x16_bf16 v[112:115], v[14:15], v[14:15], 0
    v_mfma_f32_16x16x16_bf16 v[116:119], v[14:15], v[14:15], 0
    ds_read_b128 v[64:67], v1 offset:8192
    ds_read_b128 v[68:71], v1 offset:9216
    ds_read_b128 v[72:75], v1 offset:10240
    ds_read_b128 v[76:79], v1 offset:11264
    ds_read_b128 v[80:83], v1 offset:24576
    ds_read_b128 v[84:87], v1 offset:25600
    ds_read_b128 v[88:91], v1 offset:26624
    ds_read_b128 v[92:95], v1 offset:27648
    buffer_load_dwordx4 v[120:123], v1, s[4:7], s44 offen
    buffer_load_dwordx4 v[124:127], v1, s[4:7], s44 offen offset:1024
    s_add_u32 s44, s44, 262144
mega_kernel_rs_w2_loop:
    s_add_u32 s22, s35, 4096
    s_waitcnt vmcnt(0)
    buffer_load_dwordx4 v[48:51], v1, s[4:7], s22 offen sc1
    buffer_load_dwordx4 v[52:55], v1, s[4:7], s22 offen offset:1024 sc1
mega_kernel_rs_w2_pa:
    s_waitcnt vmcnt(1)
    ds_write_b128 v6, v[48:51] offset:4096
    s_waitcnt vmcnt(0)
    ds_write_b128 v6, v[52:55] offset:5120
    v_max3_u32 v3, v48, v50, v52
    v_max_u32 v3, v3, v54
    v_cmp_eq_u32 vcc, -1, v3
    v_smfmac_f32_16x16x64_bf16 v[96:99], v[48:51], a[64:71], v2
    buffer_load_dwordx4 v[48:51], v1, s[4:7], s22 offen sc1
    v_smfmac_f32_16x16x64_bf16 v[100:103], v[48:51], a[72:79], v2
    buffer_load_dwordx4 v[52:55], v1, s[4:7], s22 offen offset:1024 sc1
    v_smfmac_f32_16x16x64_bf16 v[104:107], v[48:51], a[192:199], v2
    s_cbranch_vccnz mega_kernel_rs_w2_pafail
    s_waitcnt lgkmcnt(0)
    s_barrier
    ds_read_b128 v[56:59], v6 offset:6144
    ds_read_b128 v[60:63], v6 offset:7168
    v_smfmac_f32_16x16x64_bf16 v[108:111], v[48:51], a[200:207], v2
    ds_read_b128 v[32:35], v6 offset:0
    v_smfmac_f32_16x16x64_bf16 v[96:99], v[52:55], a[80:87], v2
    ds_read_b128 v[36:39], v6 offset:1024
    v_smfmac_f32_16x16x64_bf16 v[100:103], v[52:55], a[88:95], v2
    ds_read_b128 v[40:43], v6 offset:2048
    v_smfmac_f32_16x16x64_bf16 v[104:107], v[52:55], a[208:215], v2
    ds_read_b128 v[44:47], v6 offset:3072
    v_smfmac_f32_16x16x64_bf16 v[108:111], v[52:55], a[216:223], v2
    s_waitcnt lgkmcnt(5)
    v_smfmac_f32_16x16x64_bf16 v[96:99], v[56:59], a[96:103], v2
    v_smfmac_f32_16x16x64_bf16 v[104:107], v[56:59], a[224:231], v2
    buffer_load_dwordx4 v1, s[4:7], s43 offen lds
    s_waitcnt lgkmcnt(4)
    v_smfmac_f32_16x16x64_bf16 v[96:99], v[60:63], a[112:119], v2
    v_smfmac_f32_16x16x64_bf16 v[104:107], v[60:63], a[240:247], v2
    s_waitcnt lgkmcnt(3)
    v_smfmac_f32_16x16x64_bf16 v[96:99], v[32:35], a[0:7], v2
    v_smfmac_f32_16x16x64_bf16 v[104:107], v[32:35], a[128:135], v2
    buffer_load_dwordx4 v1, s[4:7], s43 offen offset:1024 lds
    s_waitcnt lgkmcnt(2)
    v_smfmac_f32_16x16x64_bf16 v[96:99], v[36:39], a[16:23], v2
    v_smfmac_f32_16x16x64_bf16 v[104:107], v[36:39], a[144:151], v2
    s_waitcnt lgkmcnt(1)
    v_smfmac_f32_16x16x64_bf16 v[96:99], v[40:43], a[32:39], v2
    v_smfmac_f32_16x16x64_bf16 v[104:107], v[40:43], a[160:167], v2
    s_waitcnt lgkmcnt(0)
    v_smfmac_f32_16x16x64_bf16 v[96:99], v[44:47], a[48:55], v2
    v_smfmac_f32_16x16x64_bf16 v[104:107], v[44:47], a[176:183], v2
    v_smfmac_f32_16x16x64_bf16 v[100:103], v[56:59], a[104:111], v2
    s_nop 2
    v_smfmac_f32_16x16x64_bf16 v[100:103], v[60:63], a[120:127], v2
    s_nop 1
    v_add_f32 v96, v96, v98
    v_smfmac_f32_16x16x64_bf16 v[100:103], v[32:35], a[8:15], v2
    v_add_f32 v97, v97, v99
    v_add_f32 v104, v104, v106
    v_smfmac_f32_16x16x64_bf16 v[100:103], v[36:39], a[24:31], v2
    v_add_f32 v105, v105, v107
    v_cvt_pk_bf16_f32 v96, v96, v97
    v_smfmac_f32_16x16x64_bf16 v[100:103], v[40:43], a[40:47], v2
    v_cvt_pk_bf16_f32 v97, v104, v105
    v_and_or_b32 v96, v96, -2, s41
    v_smfmac_f32_16x16x64_bf16 v[100:103], v[44:47], a[56:63], v2
    buffer_store_dwordx2 v[96:97], v11, s[4:7], s37 offen sc1
    v_smfmac_f32_16x16x64_bf16 v[108:111], v[56:59], a[232:239], v2
    v_smfmac_f32_16x16x64_bf16 v[108:111], v[60:63], a[248:255], v2
    v_smfmac_f32_16x16x64_bf16 v[108:111], v[32:35], a[136:143], v2
    v_smfmac_f32_16x16x64_bf16 v[108:111], v[36:39], a[152:159], v2
    v_smfmac_f32_16x16x64_bf16 v[108:111], v[40:43], a[168:175], v2
    s_nop 2
    v_add_f32 v100, v100, v102
    v_smfmac_f32_16x16x64_bf16 v[108:111], v[44:47], a[184:191], v2
    v_add_f32 v101, v101, v103
    v_cvt_pk_bf16_f32 v98, v100, v101
    v_and_or_b32 v98, v98, -2, s41
    s_nop 4
    v_pk_add_f32 v[108:109], v[108:109], v[110:111]
    v_cvt_pk_bf16_f32 v99, v108, v109
    buffer_store_dwordx2 v[98:99], v11, s[4:7], s37 offen offset:512 sc1
    v_smfmac_f32_16x16x64_bf16 v[112:115], v[32:35], v[64:71], v2
    ds_read_b128 v[64:67], v1 offset:40960
    ds_read_b128 v[68:71], v1 offset:41984
    v_smfmac_f32_16x16x64_bf16 v[116:119], v[32:35], v[72:79], v2
    ds_read_b128 v[72:75], v1 offset:43008
    ds_read_b128 v[76:79], v1 offset:44032
    v_smfmac_f32_16x16x64_bf16 v[112:115], v[36:39], v[80:87], v2
    ds_read_b128 v[80:83], v1 offset:57344
    ds_read_b128 v[84:87], v1 offset:58368
    v_smfmac_f32_16x16x64_bf16 v[116:119], v[36:39], v[88:95], v2
    ds_read_b128 v[88:91], v1 offset:59392
    ds_read_b128 v[92:95], v1 offset:60416
    s_waitcnt lgkmcnt(6)
    v_smfmac_f32_16x16x64_bf16 v[112:115], v[40:43], v[64:71], v2
    ds_read_b128 v[64:67], v5 offset:8192
    ds_read_b128 v[68:71], v5 offset:9216
    s_waitcnt lgkmcnt(6)
    v_smfmac_f32_16x16x64_bf16 v[116:119], v[40:43], v[72:79], v2
    ds_read_b128 v[72:75], v5 offset:10240
    ds_read_b128 v[76:79], v5 offset:11264
    s_waitcnt lgkmcnt(6)
    v_smfmac_f32_16x16x64_bf16 v[112:115], v[44:47], v[80:87], v2
    ds_read_b128 v[80:83], v5 offset:24576
    ds_read_b128 v[84:87], v5 offset:25600
    s_waitcnt lgkmcnt(6)
    v_smfmac_f32_16x16x64_bf16 v[116:119], v[44:47], v[88:95], v2
    ds_read_b128 v[88:91], v5 offset:26624
    ds_read_b128 v[92:95], v5 offset:27648
    s_waitcnt lgkmcnt(6)
    v_smfmac_f32_16x16x64_bf16 v[112:115], v[48:51], v[64:71], v2
    ds_read_b128 v[64:67], v5 offset:40960
    ds_read_b128 v[68:71], v5 offset:41984
    s_waitcnt lgkmcnt(6)
    v_smfmac_f32_16x16x64_bf16 v[116:119], v[48:51], v[72:79], v2
    ds_read_b128 v[72:75], v5 offset:43008
    ds_read_b128 v[76:79], v5 offset:44032
    s_waitcnt lgkmcnt(6)
    v_smfmac_f32_16x16x64_bf16 v[112:115], v[52:55], v[80:87], v2
    ds_read_b128 v[80:83], v5 offset:57344
    ds_read_b128 v[84:87], v5 offset:58368
    s_waitcnt lgkmcnt(6)
    v_smfmac_f32_16x16x64_bf16 v[116:119], v[52:55], v[88:95], v2
    ds_read_b128 v[88:91], v5 offset:59392
    ds_read_b128 v[92:95], v5 offset:60416
    s_waitcnt lgkmcnt(6)
    v_smfmac_f32_16x16x64_bf16 v[112:115], v[56:59], v[64:71], v2
    s_waitcnt lgkmcnt(4)
    v_smfmac_f32_16x16x64_bf16 v[116:119], v[56:59], v[72:79], v2
    s_waitcnt lgkmcnt(2)
    v_smfmac_f32_16x16x64_bf16 v[112:115], v[60:63], v[80:87], v2
    s_waitcnt lgkmcnt(0)
    v_smfmac_f32_16x16x64_bf16 v[116:119], v[60:63], v[88:95], v2
    buffer_load_dwordx2 v[108:109], v11, s[4:7], s38 offen sc1
    v_mfma_f32_16x16x16_bf16 v[100:103], v[96:97], v[16:17], 0
    v_mfma_f32_16x16x16_bf16 v[104:107], v[98:99], v[16:17], 0
    s_nop 4
    v_add_f32 v112, v112, v114
    v_add_f32 v113, v113, v115
    v_add_f32 v114, v116, v118
    v_add_f32 v115, v117, v119
    v_cvt_pk_bf16_f32 v18, v112, v113
    v_cvt_pk_bf16_f32 v19, v114, v115
    v_and_or_b32 v18, v18, -2, s41
    buffer_load_dwordx2 v[110:111], v11, s[4:7], s38 offen offset:512 sc1
    s_barrier
    buffer_store_dwordx2 v[18:19], v11, s[4:7], s39 offen sc1
    v_mov_b32 v112, v18
    v_mov_b32 v114, v19
    v_mov_b32 v92, v28
    v_mov_b32 v93, 0
    s_waitcnt vmcnt(5)
    s_barrier
    ds_read_b128 v[32:35], v6 offset:19456
    ds_read_b128 v[36:39], v6 offset:20480
    ds_read_b128 v[40:43], v6 offset:24576
    ds_read_b128 v[44:47], v6 offset:25600
    ds_read_b128 v[48:51], v6 offset:9216
    ds_read_b128 v[52:55], v6 offset:10240
    ds_read_b128 v[56:59], v6 offset:14336
    ds_read_b128 v[60:63], v6 offset:15360
    buffer_load_dwordx2 v[20:21], v11, s[4:7], s38 offen sc1
    buffer_load_dwordx2 v[22:23], v11, s[4:7], s38 offen offset:512 sc1
    s_waitcnt vmcnt(4)
    v_mfma_f32_16x16x16_bf16 v[80:83], v[108:109], v[16:17], v[100:103]
    v_and_b32 v3, 1, v108
    v_cmp_ne_u32 vcc, s41, v3
    s_nop 5
    v_cvt_pk_bf16_f32 v64, v80, v81
    v_cvt_pk_bf16_f32 v65, v82, v83
    s_cbranch_vccnz mega_kernel_rs_w2_xslow
    s_waitcnt vmcnt(3)
    v_mfma_f32_16x16x16_bf16 v[84:87], v[110:111], v[16:17], v[104:107]
    v_and_b32 v3, 1, v110
    v_cmp_ne_u32 vcc, s41, v3
    s_nop 5
    v_cvt_pk_bf16_f32 v66, v84, v85
    v_cvt_pk_bf16_f32 v67, v86, v87
    ds_write_b128 v6, v[64:67] offset:18432
    s_cbranch_vccnz mega_kernel_rs_w2_xslow
mega_kernel_rs_w2_xok:
    s_cmp_eq_u32 s21, 63
    s_cbranch_scc1 mega_kernel_rs_w2_last
    buffer_load_dwordx2 v[116:117], v11, s[4:7], s40 offen sc1
    s_waitcnt lgkmcnt(1)
    v_mfma_f32_16x16x32_bf16 v[80:83], v[32:35], v[64:67], 0
    s_waitcnt lgkmcnt(0)
    s_barrier
    ds_read_b128 v[68:71], v6 offset:23552
    ds_read_b128 v[72:75], v6 offset:8192
    ds_read_b128 v[76:79], v6 offset:13312
    v_mfma_f32_16x16x32_bf16 v[84:87], v[36:39], v[64:67], 0
    v_mfma_f32_16x16x32_bf16 v[88:91], v[64:67], v[64:67], 0
    buffer_load_dwordx2 v[20:21], v11, s[4:7], s40 offen sc1
    s_waitcnt lgkmcnt(2)
    v_mfma_f32_16x16x32_bf16 v[80:83], v[40:43], v[68:71], v[80:83]
    s_waitcnt lgkmcnt(1)
    v_mfma_f32_16x16x32_bf16 v[80:83], v[48:51], v[72:75], v[80:83]
    s_waitcnt lgkmcnt(0)
    v_mfma_f32_16x16x32_bf16 v[80:83], v[56:59], v[76:79], v[80:83]
    buffer_store_dwordx4 v[64:67], v10, s[4:7], s45 offen offset:128 sc1
    v_mfma_f32_16x16x32_bf16 v[84:87], v[44:47], v[68:71], v[84:87]
    v_mfma_f32_16x16x32_bf16 v[84:87], v[52:55], v[72:75], v[84:87]
    v_mfma_f32_16x16x32_bf16 v[84:87], v[60:63], v[76:79], v[84:87]
    v_mfma_f32_16x16x32_bf16 v[88:91], v[68:71], v[68:71], v[88:91]
    buffer_store_dwordx2 v[18:19], v11, s[4:7], s51 offen offset:3072 sc1
    v_mfma_f32_16x16x32_bf16 v[88:91], v[72:75], v[72:75], v[88:91]
    v_mfma_f32_16x16x32_bf16 v[88:91], v[76:79], v[76:79], v[88:91]
    v_mfma_f32_32x32x4_2b_bf16 v[32:63], v[14:15], v[14:15], 0
    s_nop 0
    v_max3_f32 v4, v80, v81, v82
    s_nop 1
    v_max3_f32 v4, v4, v83, v84
    v_max3_f32 v4, v4, v85, v86
    v_max_f32 v4, v4, v87
    v_max3_f32 v90, v4, v88, v89
    v_max3_f32 v4, v4, v88, v89
    s_nop 1
    v_permlane16_swap_b32 v4, v90
    v_max_f32 v4, v4, v90
    v_max_f32 v90, v4, v90
    s_nop 1
    v_permlane32_swap_b32 v4, v90
    v_max_f32 v4, v4, v90
    v_mul_f32 v4, s34, v4
    v_pk_fma_f32 v[80:81], v[80:81], s[34:35], v[4:5] op_sel_hi:[1,0,0] neg_lo:[0,0,1] neg_hi:[0,0,1]
    v_pk_fma_f32 v[82:83], v[82:83], s[34:35], v[4:5] op_sel_hi:[1,0,0] neg_lo:[0,0,1] neg_hi:[0,0,1]
    v_pk_fma_f32 v[84:85], v[84:85], s[34:35], v[4:5] op_sel_hi:[1,0,0] neg_lo:[0,0,1] neg_hi:[0,0,1]
    v_pk_fma_f32 v[86:87], v[86:87], s[34:35], v[4:5] op_sel_hi:[1,0,0] neg_lo:[0,0,1] neg_hi:[0,0,1]
    v_pk_fma_f32 v[88:89], v[88:89], s[34:35], v[4:5] op_sel_hi:[1,0,0] neg_lo:[0,0,1] neg_hi:[0,0,1]
    v_exp_f32 v80, v80
    v_exp_f32 v81, v81
    v_exp_f32 v82, v82
    v_cvt_pk_bf16_f32 v68, v80, v81
    v_exp_f32 v83, v83
    v_exp_f32 v84, v84
    v_cvt_pk_bf16_f32 v69, v82, v83
    v_exp_f32 v85, v85
    v_exp_f32 v86, v86
    v_cvt_pk_bf16_f32 v70, v84, v85
    v_exp_f32 v87, v87
    v_exp_f32 v88, v88
    v_cvt_pk_bf16_f32 v71, v86, v87
    v_exp_f32 v89, v89
    s_waitcnt vmcnt(3)
    v_mfma_f32_16x16x32_bf16 v[76:79], v[28:31], v[68:71], 0
    v_and_b32 v3, 1, v116
    v_cvt_pk_bf16_f32 v72, v88, v89
    v_mfma_f32_16x16x32_bf16 v[100:103], v[120:123], v[68:71], 0
    v_cmp_ne_u32 vcc, s41, v3
    v_cvt_pk_bf16_f32 v73, v88, v89
    v_mfma_f32_16x16x32_bf16 v[104:107], v[124:127], v[68:71], 0
    v_mov_b32 v113, v116
    v_mov_b32 v115, v117
    v_mfma_f32_16x16x16_bf16 v[76:79], v[92:93], v[72:73], v[76:79]
    s_cbranch_vccnz mega_kernel_rs_w2_pv0
mega_kernel_rs_w2_pv2:
    v_mfma_f32_16x16x16_bf16 v[100:103], v[112:113], v[72:73], v[100:103]
    v_mfma_f32_16x16x16_bf16 v[104:107], v[114:115], v[72:73], v[104:107]
    buffer_load_dwordx4 v[120:123], v1, s[4:7], s44 offen
    buffer_load_dwordx4 v[124:127], v1, s[4:7], s44 offen offset:1024
    s_nop 2
    v_rcp_f32 v76, v76
    s_mov_b64 exec, s[28:29]
    v_pk_mul_f32 v[100:101], v[100:101], v[76:77] op_sel_hi:[1,0]
    v_pk_mul_f32 v[102:103], v[102:103], v[76:77] op_sel_hi:[1,0]
    v_pk_mul_f32 v[104:105], v[104:105], v[76:77] op_sel_hi:[1,0]
    v_pk_mul_f32 v[106:107], v[106:107], v[76:77] op_sel_hi:[1,0]
    v_cvt_pk_bf16_f32 v84, v100, v101
    v_cvt_pk_bf16_f32 v85, v102, v103
    v_cvt_pk_bf16_f32 v86, v104, v105
    v_cvt_pk_bf16_f32 v87, v106, v107
    ds_write_b128 v6, v[84:87] offset:29664
    s_mov_b64 exec, -1
    s_waitcnt lgkmcnt(0)
    s_barrier
    ds_read_b128 v[68:71], v6 offset:28672
    ds_read_b128 v[72:75], v6 offset:29696
    s_waitcnt lgkmcnt(1)
    v_smfmac_f32_16x16x64_bf16 v[32:35], v[68:71], v[128:135], v2
    s_add_u32 s21, s21, 1
    s_xor_b32 s38, s38, 1048576
    s_xor_b32 s37, s37, 1048576
    s_waitcnt lgkmcnt(0)
    v_smfmac_f32_16x16x64_bf16 v[32:35], v[72:75], v[136:143], v2
    s_xor_b32 s40, s40, 1048576
    s_xor_b32 s39, s39, 1048576
    s_lshr_b32 s41, s21, 1
    v_smfmac_f32_16x16x64_bf16 v[36:39], v[68:71], v[144:151], v2
    s_and_b32 s41, s41, 1
    s_xor_b32 s41, s41, 1
    s_xor_b32 s35, s35, 16384
    v_smfmac_f32_16x16x64_bf16 v[36:39], v[72:75], v[152:159], v2
    v_add_f32 v32, v32, v34
    s_xor_b32 s36, s36, 16384
    s_add_u32 s43, s43, 262144
    s_add_u32 s44, s44, 262144
    v_smfmac_f32_16x16x64_bf16 v[40:43], v[68:71], v[160:167], v2
    v_add_f32 v33, v33, v35
    v_smfmac_f32_16x16x64_bf16 v[40:43], v[72:75], v[168:175], v2
    v_cvt_pk_bf16_f32 v32, v32, v33
    v_smfmac_f32_16x16x64_bf16 v[44:47], v[68:71], v[176:183], v2
    v_and_or_b32 v32, v32, -2, s42
    v_smfmac_f32_16x16x64_bf16 v[44:47], v[72:75], v[184:191], v2
    v_add_f32 v36, v36, v38
    v_smfmac_f32_16x16x64_bf16 v[48:51], v[68:71], v[192:199], v2
    v_add_f32 v37, v37, v39
    v_smfmac_f32_16x16x64_bf16 v[48:51], v[72:75], v[200:207], v2
    v_cvt_pk_bf16_f32 v33, v36, v37
    v_smfmac_f32_16x16x64_bf16 v[52:55], v[68:71], v[208:215], v2
    v_add_f32 v40, v40, v42
    v_smfmac_f32_16x16x64_bf16 v[52:55], v[72:75], v[216:223], v2
    v_add_f32 v41, v41, v43
    v_smfmac_f32_16x16x64_bf16 v[56:59], v[68:71], v[224:231], v2
    v_cvt_pk_bf16_f32 v34, v40, v41
    v_smfmac_f32_16x16x64_bf16 v[56:59], v[72:75], v[232:239], v2
    v_add_f32 v44, v44, v46
    v_smfmac_f32_16x16x64_bf16 v[60:63], v[68:71], v[240:247], v2
    v_add_f32 v45, v45, v47
    v_smfmac_f32_16x16x64_bf16 v[60:63], v[72:75], v[248:255], v2
    v_cvt_pk_bf16_f32 v35, v44, v45
    buffer_store_dwordx4 v[32:35], v8, s[4:7], s46 offen sc1
    v_pk_add_f32 v[48:49], v[48:49], v[50:51]
    v_cvt_pk_bf16_f32 v48, v48, v49
    v_and_or_b32 v48, v48, -2, s42
    v_pk_add_f32 v[52:53], v[52:53], v[54:55]
    v_cvt_pk_bf16_f32 v49, v52, v53
    v_pk_add_f32 v[56:57], v[56:57], v[58:59]
    v_cvt_pk_bf16_f32 v50, v56, v57
    v_pk_add_f32 v[60:61], v[60:61], v[62:63]
    v_cvt_pk_bf16_f32 v51, v60, v61
    buffer_store_dwordx4 v[48:51], v8, s[4:7], s61 offen sc1
    s_add_u32 s45, s45, 262144
    s_add_u32 s51, s51, 262144
    v_mfma_f32_32x32x8_bf16 v[96:111], v[14:15], v[14:15], 0
    v_mfma_f32_16x16x16_bf16 v[112:115], v[14:15], v[14:15], 0
    v_mfma_f32_16x16x16_bf16 v[116:119], v[14:15], v[14:15], 0
    ds_read_b128 v[64:67], v1 offset:8192
    ds_read_b128 v[68:71], v1 offset:9216
    ds_read_b128 v[72:75], v1 offset:10240
    ds_read_b128 v[76:79], v1 offset:11264
    ds_read_b128 v[80:83], v1 offset:24576
    ds_read_b128 v[84:87], v1 offset:25600
    ds_read_b128 v[88:91], v1 offset:26624
    ds_read_b128 v[92:95], v1 offset:27648
    v_mov_b32 v58, -1
    v_mov_b32 v59, -1
    s_waitcnt vmcnt(0)
mega_kernel_rs_w2_cgo:
mega_kernel_rs_w2_pc:
    buffer_load_dword v36, v13, s[4:7], s25 offen offset:0 sc1
    buffer_load_dword v37, v13, s[4:7], s25 offen offset:256 sc1
    buffer_load_dword v38, v13, s[4:7], s25 offen offset:512 sc1
    buffer_load_dword v39, v13, s[4:7], s25 offen offset:768 sc1
    buffer_load_dword v40, v13, s[4:7], s25 offen offset:1024 sc1
    buffer_load_dword v41, v13, s[4:7], s25 offen offset:1280 sc1
    buffer_load_dword v42, v13, s[4:7], s25 offen offset:1536 sc1
    buffer_load_dword v43, v13, s[4:7], s25 offen offset:1792 sc1
    s_waitcnt vmcnt(4)
    v_mfma_f32_16x16x32_bf16 v[52:55], v[36:39], v[24:27], 0
    v_bitop3_b32 v3, s42, v36, v37 bitop3:0x7e
    v_bitop3_b32 v4, s42, v38, v39 bitop3:0x7e
    s_waitcnt vmcnt(2)
    v_or_b32 v3, v3, v4
    v_bitop3_b32 v4, s42, v40, v41 bitop3:0x7e
    s_waitcnt vmcnt(0)
    v_mfma_f32_16x16x32_bf16 v[52:55], v[40:43], v[24:27], v[52:55]
    v_bitop3_b32 v56, s42, v42, v43 bitop3:0x7e
    v_or3_b32 v3, v3, v4, v56
    v_and_b32 v3, v0, v3
    v_cmp_ne_u32 vcc, 0, v3
    s_nop 3
    v_cvt_pk_bf16_f32 v56, v52, v53
    v_cvt_pk_bf16_f32 v57, v54, v55
    v_min_u32 v56, -2, v56
    s_cbranch_vccnz mega_kernel_rs_w2_pc
    s_mov_b64 exec, s[26:27]
    buffer_store_dwordx2 v[56:57], v9, s[4:7], s35 offen offset:512 sc1
    buffer_store_dwordx2 v[58:59], v9, s[4:7], s36 offen offset:512 sc1
    s_mov_b64 exec, -1
    s_xor_b32 s42, s42, 1
    s_branch mega_kernel_rs_w2_loop
mega_kernel_rs_w2_last:
    buffer_store_dwordx4 v[64:67], v10, s[4:7], s45 offen offset:128 sc1
    buffer_store_dwordx2 v[18:19], v11, s[4:7], s51 offen offset:3072 sc1
    s_branch mega_kernel_rs_end
mega_kernel_rs_w2_pafail:
    s_nop 7
    v_mov_b32 v96, 0
    v_mov_b32 v97, 0
    v_mov_b32 v98, 0
    v_mov_b32 v99, 0
    v_mov_b32 v100, 0
    v_mov_b32 v101, 0
    v_mov_b32 v102, 0
    v_mov_b32 v103, 0
    v_mov_b32 v104, 0
    v_mov_b32 v105, 0
    v_mov_b32 v106, 0
    v_mov_b32 v107, 0
    s_branch mega_kernel_rs_w2_pa
mega_kernel_rs_w2_xslow:
    buffer_load_dwordx2 v[108:109], v11, s[4:7], s38 offen sc1
    buffer_load_dwordx2 v[110:111], v11, s[4:7], s38 offen offset:512 sc1
    s_waitcnt vmcnt(2)
    v_bitop3_b32 v3, s41, v20, v22 bitop3:0x7e
    v_mfma_f32_16x16x16_bf16 v[80:83], v[20:21], v[16:17], v[100:103]
    v_and_b32 v3, 1, v3
    v_mfma_f32_16x16x16_bf16 v[84:87], v[22:23], v[16:17], v[104:107]
    v_cmp_ne_u32 vcc, 0, v3
    s_cbranch_vccz mega_kernel_rs_w2_xgot
    buffer_load_dwordx2 v[20:21], v11, s[4:7], s38 offen sc1
    buffer_load_dwordx2 v[22:23], v11, s[4:7], s38 offen offset:512 sc1
    s_waitcnt vmcnt(2)
    v_bitop3_b32 v3, s41, v108, v110 bitop3:0x7e
    v_mfma_f32_16x16x16_bf16 v[80:83], v[108:109], v[16:17], v[100:103]
    v_and_b32 v3, 1, v3
    v_mfma_f32_16x16x16_bf16 v[84:87], v[110:111], v[16:17], v[104:107]
    v_cmp_ne_u32 vcc, 0, v3
    s_cbranch_vccz mega_kernel_rs_w2_xgot
    s_branch mega_kernel_rs_w2_xslow
mega_kernel_rs_w2_xgot:
    s_nop 3
    v_cvt_pk_bf16_f32 v64, v80, v81
    v_cvt_pk_bf16_f32 v65, v82, v83
    v_cvt_pk_bf16_f32 v66, v84, v85
    v_cvt_pk_bf16_f32 v67, v86, v87
    ds_write_b128 v6, v[64:67] offset:18432
    s_branch mega_kernel_rs_w2_xok
mega_kernel_rs_w2_pv0:
    s_waitcnt vmcnt(2)
    s_branch mega_kernel_rs_w2_pv1
mega_kernel_rs_w2_pv:
    buffer_load_dwordx2 v[20:21], v11, s[4:7], s40 offen sc1
    s_waitcnt vmcnt(0)
mega_kernel_rs_w2_pv1:
    v_and_b32 v3, 1, v20
    v_cmp_ne_u32 vcc, s41, v3
    v_mov_b32 v113, v20
    v_mov_b32 v115, v21
    s_cbranch_vccnz mega_kernel_rs_w2_pv
    s_branch mega_kernel_rs_w2_pv2
mega_kernel_rs_w3_entry:
    v_mfma_f32_32x32x8_bf16 v[96:111], v[14:15], v[14:15], 0
    v_mfma_f32_16x16x16_bf16 v[112:115], v[14:15], v[14:15], 0
    v_mfma_f32_16x16x16_bf16 v[116:119], v[14:15], v[14:15], 0
    ds_read_b128 v[64:67], v1 offset:12288
    ds_read_b128 v[68:71], v1 offset:13312
    ds_read_b128 v[72:75], v1 offset:14336
    ds_read_b128 v[76:79], v1 offset:15360
    ds_read_b128 v[80:83], v1 offset:28672
    ds_read_b128 v[84:87], v1 offset:29696
    ds_read_b128 v[88:91], v1 offset:30720
    ds_read_b128 v[92:95], v1 offset:31744
    buffer_load_dwordx4 v[120:123], v1, s[4:7], s44 offen
    buffer_load_dwordx4 v[124:127], v1, s[4:7], s44 offen offset:1024
    s_add_u32 s44, s44, 262144
mega_kernel_rs_w3_loop:
    s_add_u32 s22, s35, 6144
    s_waitcnt vmcnt(0)
    buffer_load_dwordx4 v[56:59], v1, s[4:7], s22 offen sc1
    buffer_load_dwordx4 v[60:63], v1, s[4:7], s22 offen offset:1024 sc1
mega_kernel_rs_w3_pa:
    s_waitcnt vmcnt(1)
    ds_write_b128 v6, v[56:59] offset:6144
    s_waitcnt vmcnt(0)
    ds_write_b128 v6, v[60:63] offset:7168
    v_max3_u32 v3, v56, v58, v60
    v_max_u32 v3, v3, v62
    v_cmp_eq_u32 vcc, -1, v3
    v_smfmac_f32_16x16x64_bf16 v[96:99], v[56:59], a[96:103], v2
    buffer_load_dwordx4 v[56:59], v1, s[4:7], s22 offen sc1
    v_smfmac_f32_16x16x64_bf16 v[100:103], v[56:59], a[104:111], v2
    buffer_load_dwordx4 v[60:63], v1, s[4:7], s22 offen offset:1024 sc1
    v_smfmac_f32_16x16x64_bf16 v[104:107], v[56:59], a[224:231], v2
    s_cbranch_vccnz mega_kernel_rs_w3_pafail
    s_waitcnt lgkmcnt(0)
    s_barrier
    ds_read_b128 v[32:35], v6 offset:0
    ds_read_b128 v[36:39], v6 offset:1024
    v_smfmac_f32_16x16x64_bf16 v[108:111], v[56:59], a[232:239], v2
    ds_read_b128 v[40:43], v6 offset:2048
    v_smfmac_f32_16x16x64_bf16 v[96:99], v[60:63], a[112:119], v2
    ds_read_b128 v[44:47], v6 offset:3072
    v_smfmac_f32_16x16x64_bf16 v[100:103], v[60:63], a[120:127], v2
    ds_read_b128 v[48:51], v6 offset:4096
    v_smfmac_f32_16x16x64_bf16 v[104:107], v[60:63], a[240:247], v2
    ds_read_b128 v[52:55], v6 offset:5120
    v_smfmac_f32_16x16x64_bf16 v[108:111], v[60:63], a[248:255], v2
    s_waitcnt lgkmcnt(5)
    v_smfmac_f32_16x16x64_bf16 v[96:99], v[32:35], a[0:7], v2
    v_smfmac_f32_16x16x64_bf16 v[104:107], v[32:35], a[128:135], v2
    s_waitcnt lgkmcnt(4)
    v_smfmac_f32_16x16x64_bf16 v[96:99], v[36:39], a[16:23], v2
    buffer_load_dwordx4 v1, s[4:7], s43 offen lds
    v_smfmac_f32_16x16x64_bf16 v[104:107], v[36:39], a[144:151], v2
    s_waitcnt lgkmcnt(3)
    v_smfmac_f32_16x16x64_bf16 v[96:99], v[40:43], a[32:39], v2
    v_smfmac_f32_16x16x64_bf16 v[104:107], v[40:43], a[160:167], v2
    s_waitcnt lgkmcnt(2)
    v_smfmac_f32_16x16x64_bf16 v[96:99], v[44:47], a[48:55], v2
    buffer_load_dwordx4 v1, s[4:7], s43 offen offset:1024 lds
    v_smfmac_f32_16x16x64_bf16 v[104:107], v[44:47], a[176:183], v2
    s_waitcnt lgkmcnt(1)
    v_smfmac_f32_16x16x64_bf16 v[96:99], v[48:51], a[64:71], v2
    v_smfmac_f32_16x16x64_bf16 v[104:107], v[48:51], a[192:199], v2
    s_waitcnt lgkmcnt(0)
    v_smfmac_f32_16x16x64_bf16 v[96:99], v[52:55], a[80:87], v2
    buffer_load_dword v12, v7, s[4:7], 0 offen sc1
    v_smfmac_f32_16x16x64_bf16 v[104:107], v[52:55], a[208:215], v2
    v_smfmac_f32_16x16x64_bf16 v[100:103], v[32:35], a[8:15], v2
    s_nop 2
    v_smfmac_f32_16x16x64_bf16 v[100:103], v[36:39], a[24:31], v2
    s_nop 1
    v_add_f32 v96, v96, v98
    v_smfmac_f32_16x16x64_bf16 v[100:103], v[40:43], a[40:47], v2
    v_add_f32 v97, v97, v99
    v_add_f32 v104, v104, v106
    v_smfmac_f32_16x16x64_bf16 v[100:103], v[44:47], a[56:63], v2
    v_add_f32 v105, v105, v107
    v_cvt_pk_bf16_f32 v96, v96, v97
    v_smfmac_f32_16x16x64_bf16 v[100:103], v[48:51], a[72:79], v2
    v_cvt_pk_bf16_f32 v97, v104, v105
    v_and_or_b32 v96, v96, -2, s41
    v_smfmac_f32_16x16x64_bf16 v[100:103], v[52:55], a[88:95], v2
    buffer_store_dwordx2 v[96:97], v11, s[4:7], s37 offen sc1
    v_smfmac_f32_16x16x64_bf16 v[108:111], v[32:35], a[136:143], v2
    v_smfmac_f32_16x16x64_bf16 v[108:111], v[36:39], a[152:159], v2
    v_smfmac_f32_16x16x64_bf16 v[108:111], v[40:43], a[168:175], v2
    v_smfmac_f32_16x16x64_bf16 v[108:111], v[44:47], a[184:191], v2
    v_smfmac_f32_16x16x64_bf16 v[108:111], v[48:51], a[200:207], v2
    s_nop 2
    v_add_f32 v100, v100, v102
    v_smfmac_f32_16x16x64_bf16 v[108:111], v[52:55], a[216:223], v2
    v_add_f32 v101, v101, v103
    v_cvt_pk_bf16_f32 v98, v100, v101
    v_and_or_b32 v98, v98, -2, s41
    s_nop 4
    v_pk_add_f32 v[108:109], v[108:109], v[110:111]
    v_cvt_pk_bf16_f32 v99, v108, v109
    buffer_store_dwordx2 v[98:99], v11, s[4:7], s37 offen offset:512 sc1
    v_smfmac_f32_16x16x64_bf16 v[112:115], v[32:35], v[64:71], v2
    ds_read_b128 v[64:67], v1 offset:45056
    ds_read_b128 v[68:71], v1 offset:46080
    v_smfmac_f32_16x16x64_bf16 v[116:119], v[32:35], v[72:79], v2
    ds_read_b128 v[72:75], v1 offset:47104
    ds_read_b128 v[76:79], v1 offset:48128
    v_smfmac_f32_16x16x64_bf16 v[112:115], v[36:39], v[80:87], v2
    ds_read_b128 v[80:83], v1 offset:61440
    ds_read_b128 v[84:87], v1 offset:62464
    v_smfmac_f32_16x16x64_bf16 v[116:119], v[36:39], v[88:95], v2
    ds_read_b128 v[88:91], v1 offset:63488
    ds_read_b128 v[92:95], v1 offset:64512
    s_waitcnt lgkmcnt(6)
    v_smfmac_f32_16x16x64_bf16 v[112:115], v[40:43], v[64:71], v2
    ds_read_b128 v[64:67], v5 offset:12288
    ds_read_b128 v[68:71], v5 offset:13312
    s_waitcnt lgkmcnt(6)
    v_smfmac_f32_16x16x64_bf16 v[116:119], v[40:43], v[72:79], v2
    ds_read_b128 v[72:75], v5 offset:14336
    ds_read_b128 v[76:79], v5 offset:15360
    s_waitcnt lgkmcnt(6)
    v_smfmac_f32_16x16x64_bf16 v[112:115], v[44:47], v[80:87], v2
    ds_read_b128 v[80:83], v5 offset:28672
    ds_read_b128 v[84:87], v5 offset:29696
    s_waitcnt lgkmcnt(6)
    v_smfmac_f32_16x16x64_bf16 v[116:119], v[44:47], v[88:95], v2
    ds_read_b128 v[88:91], v5 offset:30720
    ds_read_b128 v[92:95], v5 offset:31744
    s_waitcnt lgkmcnt(6)
    v_smfmac_f32_16x16x64_bf16 v[112:115], v[48:51], v[64:71], v2
    ds_read_b128 v[64:67], v5 offset:45056
    ds_read_b128 v[68:71], v5 offset:46080
    s_waitcnt lgkmcnt(6)
    v_smfmac_f32_16x16x64_bf16 v[116:119], v[48:51], v[72:79], v2
    ds_read_b128 v[72:75], v5 offset:47104
    ds_read_b128 v[76:79], v5 offset:48128
    s_waitcnt lgkmcnt(6)
    v_smfmac_f32_16x16x64_bf16 v[112:115], v[52:55], v[80:87], v2
    ds_read_b128 v[80:83], v5 offset:61440
    ds_read_b128 v[84:87], v5 offset:62464
    s_waitcnt lgkmcnt(6)
    v_smfmac_f32_16x16x64_bf16 v[116:119], v[52:55], v[88:95], v2
    ds_read_b128 v[88:91], v5 offset:63488
    ds_read_b128 v[92:95], v5 offset:64512
    s_waitcnt lgkmcnt(6)
    v_smfmac_f32_16x16x64_bf16 v[112:115], v[56:59], v[64:71], v2
    s_waitcnt lgkmcnt(4)
    v_smfmac_f32_16x16x64_bf16 v[116:119], v[56:59], v[72:79], v2
    s_waitcnt lgkmcnt(2)
    v_smfmac_f32_16x16x64_bf16 v[112:115], v[60:63], v[80:87], v2
    s_waitcnt lgkmcnt(0)
    v_smfmac_f32_16x16x64_bf16 v[116:119], v[60:63], v[88:95], v2
    buffer_load_dwordx2 v[108:109], v11, s[4:7], s38 offen sc1
    v_mfma_f32_16x16x16_bf16 v[100:103], v[96:97], v[16:17], 0
    v_mfma_f32_16x16x16_bf16 v[104:107], v[98:99], v[16:17], 0
    s_nop 4
    v_add_f32 v112, v112, v114
    v_add_f32 v113, v113, v115
    v_add_f32 v114, v116, v118
    v_add_f32 v115, v117, v119
    v_cvt_pk_bf16_f32 v18, v112, v113
    v_cvt_pk_bf16_f32 v19, v114, v115
    v_and_or_b32 v18, v18, -2, s41
    buffer_load_dwordx2 v[110:111], v11, s[4:7], s38 offen offset:512 sc1
    s_barrier
    buffer_store_dwordx2 v[18:19], v11, s[4:7], s39 offen sc1
    v_mov_b32 v112, v18
    v_mov_b32 v114, v19
    v_mov_b32 v92, v28
    v_mov_b32 v93, 0
    s_waitcnt vmcnt(6)
    s_barrier
    ds_read_b128 v[32:35], v6 offset:24576
    ds_read_b128 v[36:39], v6 offset:25600
    ds_read_b128 v[40:43], v6 offset:19456
    ds_read_b128 v[44:47], v6 offset:20480
    ds_read_b128 v[48:51], v6 offset:14336
    ds_read_b128 v[52:55], v6 offset:15360
    ds_read_b128 v[56:59], v6 offset:9216
    ds_read_b128 v[60:63], v6 offset:10240
    buffer_load_dwordx2 v[20:21], v11, s[4:7], s38 offen sc1
    buffer_load_dwordx2 v[22:23], v11, s[4:7], s38 offen offset:512 sc1
    s_waitcnt vmcnt(4)
    v_mfma_f32_16x16x16_bf16 v[80:83], v[108:109], v[16:17], v[100:103]
    v_and_b32 v3, 1, v108
    v_cmp_ne_u32 vcc, s41, v3
    s_nop 5
    v_cvt_pk_bf16_f32 v64, v80, v81
    v_cvt_pk_bf16_f32 v65, v82, v83
    s_cbranch_vccnz mega_kernel_rs_w3_xslow
    s_waitcnt vmcnt(3)
    v_mfma_f32_16x16x16_bf16 v[84:87], v[110:111], v[16:17], v[104:107]
    v_and_b32 v3, 1, v110
    v_cmp_ne_u32 vcc, s41, v3
    s_nop 5
    v_cvt_pk_bf16_f32 v66, v84, v85
    v_cvt_pk_bf16_f32 v67, v86, v87
    ds_write_b128 v6, v[64:67] offset:23552
    s_cbranch_vccnz mega_kernel_rs_w3_xslow
mega_kernel_rs_w3_xok:
    s_cmp_eq_u32 s21, 63
    s_cbranch_scc1 mega_kernel_rs_w3_last
    buffer_load_dwordx2 v[116:117], v11, s[4:7], s40 offen sc1
    s_waitcnt lgkmcnt(1)
    v_mfma_f32_16x16x32_bf16 v[80:83], v[32:35], v[64:67], 0
    s_waitcnt lgkmcnt(0)
    s_barrier
    ds_read_b128 v[68:71], v6 offset:18432
    ds_read_b128 v[72:75], v6 offset:13312
    ds_read_b128 v[76:79], v6 offset:8192
    v_mfma_f32_16x16x32_bf16 v[84:87], v[36:39], v[64:67], 0
    v_mfma_f32_16x16x32_bf16 v[88:91], v[64:67], v[64:67], 0
    buffer_load_dwordx2 v[20:21], v11, s[4:7], s40 offen sc1
    s_waitcnt lgkmcnt(2)
    v_mfma_f32_16x16x32_bf16 v[80:83], v[40:43], v[68:71], v[80:83]
    s_waitcnt lgkmcnt(1)
    v_mfma_f32_16x16x32_bf16 v[80:83], v[48:51], v[72:75], v[80:83]
    s_waitcnt lgkmcnt(0)
    v_mfma_f32_16x16x32_bf16 v[80:83], v[56:59], v[76:79], v[80:83]
    v_mfma_f32_16x16x32_bf16 v[84:87], v[44:47], v[68:71], v[84:87]
    buffer_store_dwordx4 v[64:67], v10, s[4:7], s45 offen offset:192 sc1
    v_mfma_f32_16x16x32_bf16 v[84:87], v[52:55], v[72:75], v[84:87]
    v_mfma_f32_16x16x32_bf16 v[84:87], v[60:63], v[76:79], v[84:87]
    v_mfma_f32_16x16x32_bf16 v[88:91], v[68:71], v[68:71], v[88:91]
    v_mfma_f32_16x16x32_bf16 v[88:91], v[72:75], v[72:75], v[88:91]
    buffer_store_dwordx2 v[18:19], v11, s[4:7], s51 offen offset:3584 sc1
    v_mfma_f32_16x16x32_bf16 v[88:91], v[76:79], v[76:79], v[88:91]
    v_mfma_f32_32x32x4_2b_bf16 v[32:63], v[14:15], v[14:15], 0
    s_nop 0
    v_max3_f32 v4, v80, v81, v82
    s_nop 1
    v_max3_f32 v4, v4, v83, v84
    v_max3_f32 v4, v4, v85, v86
    v_max_f32 v4, v4, v87
    v_max3_f32 v90, v4, v88, v89
    v_max3_f32 v4, v4, v88, v89
    s_nop 1
    v_permlane16_swap_b32 v4, v90
    v_max_f32 v4, v4, v90
    v_max_f32 v90, v4, v90
    s_nop 1
    v_permlane32_swap_b32 v4, v90
    v_max_f32 v4, v4, v90
    v_mul_f32 v4, s34, v4
    v_pk_fma_f32 v[80:81], v[80:81], s[34:35], v[4:5] op_sel_hi:[1,0,0] neg_lo:[0,0,1] neg_hi:[0,0,1]
    v_pk_fma_f32 v[82:83], v[82:83], s[34:35], v[4:5] op_sel_hi:[1,0,0] neg_lo:[0,0,1] neg_hi:[0,0,1]
    v_pk_fma_f32 v[84:85], v[84:85], s[34:35], v[4:5] op_sel_hi:[1,0,0] neg_lo:[0,0,1] neg_hi:[0,0,1]
    v_pk_fma_f32 v[86:87], v[86:87], s[34:35], v[4:5] op_sel_hi:[1,0,0] neg_lo:[0,0,1] neg_hi:[0,0,1]
    v_pk_fma_f32 v[88:89], v[88:89], s[34:35], v[4:5] op_sel_hi:[1,0,0] neg_lo:[0,0,1] neg_hi:[0,0,1]
    v_exp_f32 v80, v80
    v_exp_f32 v81, v81
    v_exp_f32 v82, v82
    v_cvt_pk_bf16_f32 v68, v80, v81
    v_exp_f32 v83, v83
    v_exp_f32 v84, v84
    v_cvt_pk_bf16_f32 v69, v82, v83
    v_exp_f32 v85, v85
    v_exp_f32 v86, v86
    v_cvt_pk_bf16_f32 v70, v84, v85
    v_exp_f32 v87, v87
    v_exp_f32 v88, v88
    v_cvt_pk_bf16_f32 v71, v86, v87
    v_exp_f32 v89, v89
    s_waitcnt vmcnt(3)
    v_mfma_f32_16x16x32_bf16 v[76:79], v[28:31], v[68:71], 0
    v_and_b32 v3, 1, v116
    v_cvt_pk_bf16_f32 v72, v88, v89
    v_mfma_f32_16x16x32_bf16 v[100:103], v[120:123], v[68:71], 0
    v_cmp_ne_u32 vcc, s41, v3
    v_cvt_pk_bf16_f32 v73, v88, v89
    v_mfma_f32_16x16x32_bf16 v[104:107], v[124:127], v[68:71], 0
    v_mov_b32 v113, v116
    v_mov_b32 v115, v117
    v_mfma_f32_16x16x16_bf16 v[76:79], v[92:93], v[72:73], v[76:79]
    s_cbranch_vccnz mega_kernel_rs_w3_pv0
mega_kernel_rs_w3_pv2:
    v_mfma_f32_16x16x16_bf16 v[100:103], v[112:113], v[72:73], v[100:103]
    v_mfma_f32_16x16x16_bf16 v[104:107], v[114:115], v[72:73], v[104:107]
    buffer_load_dwordx4 v[120:123], v1, s[4:7], s44 offen
    buffer_load_dwordx4 v[124:127], v1, s[4:7], s44 offen offset:1024
    s_nop 2
    v_rcp_f32 v76, v76
    s_mov_b64 exec, s[28:29]
    v_pk_mul_f32 v[100:101], v[100:101], v[76:77] op_sel_hi:[1,0]
    v_pk_mul_f32 v[102:103], v[102:103], v[76:77] op_sel_hi:[1,0]
    v_pk_mul_f32 v[104:105], v[104:105], v[76:77] op_sel_hi:[1,0]
    v_pk_mul_f32 v[106:107], v[106:107], v[76:77] op_sel_hi:[1,0]
    v_cvt_pk_bf16_f32 v84, v100, v101
    v_cvt_pk_bf16_f32 v85, v102, v103
    v_cvt_pk_bf16_f32 v86, v104, v105
    v_cvt_pk_bf16_f32 v87, v106, v107
    ds_write_b128 v6, v[84:87] offset:29696
    s_mov_b64 exec, -1
    s_waitcnt lgkmcnt(0)
    s_barrier
    ds_read_b128 v[68:71], v6 offset:28672
    ds_read_b128 v[72:75], v6 offset:29696
    s_waitcnt lgkmcnt(1)
    v_smfmac_f32_16x16x64_bf16 v[32:35], v[68:71], v[128:135], v2
    s_add_u32 s21, s21, 1
    s_xor_b32 s38, s38, 1048576
    s_xor_b32 s37, s37, 1048576
    s_waitcnt lgkmcnt(0)
    v_smfmac_f32_16x16x64_bf16 v[32:35], v[72:75], v[136:143], v2
    s_xor_b32 s40, s40, 1048576
    s_xor_b32 s39, s39, 1048576
    s_lshr_b32 s41, s21, 1
    v_smfmac_f32_16x16x64_bf16 v[36:39], v[68:71], v[144:151], v2
    s_and_b32 s41, s41, 1
    s_xor_b32 s41, s41, 1
    s_xor_b32 s35, s35, 16384
    v_smfmac_f32_16x16x64_bf16 v[36:39], v[72:75], v[152:159], v2
    v_add_f32 v32, v32, v34
    s_xor_b32 s36, s36, 16384
    s_add_u32 s43, s43, 262144
    s_add_u32 s44, s44, 262144
    v_smfmac_f32_16x16x64_bf16 v[40:43], v[68:71], v[160:167], v2
    v_add_f32 v33, v33, v35
    v_smfmac_f32_16x16x64_bf16 v[40:43], v[72:75], v[168:175], v2
    v_cvt_pk_bf16_f32 v32, v32, v33
    v_smfmac_f32_16x16x64_bf16 v[44:47], v[68:71], v[176:183], v2
    v_and_or_b32 v32, v32, -2, s42
    v_smfmac_f32_16x16x64_bf16 v[44:47], v[72:75], v[184:191], v2
    v_add_f32 v36, v36, v38
    v_smfmac_f32_16x16x64_bf16 v[48:51], v[68:71], v[192:199], v2
    v_add_f32 v37, v37, v39
    v_smfmac_f32_16x16x64_bf16 v[48:51], v[72:75], v[200:207], v2
    v_cvt_pk_bf16_f32 v33, v36, v37
    v_smfmac_f32_16x16x64_bf16 v[52:55], v[68:71], v[208:215], v2
    v_add_f32 v40, v40, v42
    v_smfmac_f32_16x16x64_bf16 v[52:55], v[72:75], v[216:223], v2
    v_add_f32 v41, v41, v43
    v_smfmac_f32_16x16x64_bf16 v[56:59], v[68:71], v[224:231], v2
    v_cvt_pk_bf16_f32 v34, v40, v41
    v_smfmac_f32_16x16x64_bf16 v[56:59], v[72:75], v[232:239], v2
    v_add_f32 v44, v44, v46
    v_smfmac_f32_16x16x64_bf16 v[60:63], v[68:71], v[240:247], v2
    v_add_f32 v45, v45, v47
    v_smfmac_f32_16x16x64_bf16 v[60:63], v[72:75], v[248:255], v2
    v_cvt_pk_bf16_f32 v35, v44, v45
    buffer_store_dwordx4 v[32:35], v8, s[4:7], s46 offen sc1
    v_pk_add_f32 v[48:49], v[48:49], v[50:51]
    v_cvt_pk_bf16_f32 v48, v48, v49
    v_and_or_b32 v48, v48, -2, s42
    v_pk_add_f32 v[52:53], v[52:53], v[54:55]
    v_cvt_pk_bf16_f32 v49, v52, v53
    v_pk_add_f32 v[56:57], v[56:57], v[58:59]
    v_cvt_pk_bf16_f32 v50, v56, v57
    v_pk_add_f32 v[60:61], v[60:61], v[62:63]
    v_cvt_pk_bf16_f32 v51, v60, v61
    buffer_store_dwordx4 v[48:51], v8, s[4:7], s61 offen sc1
    s_add_u32 s45, s45, 262144
    s_add_u32 s51, s51, 262144
    v_mfma_f32_32x32x8_bf16 v[96:111], v[14:15], v[14:15], 0
    v_mfma_f32_16x16x16_bf16 v[112:115], v[14:15], v[14:15], 0
    v_mfma_f32_16x16x16_bf16 v[116:119], v[14:15], v[14:15], 0
    ds_read_b128 v[64:67], v1 offset:12288
    ds_read_b128 v[68:71], v1 offset:13312
    ds_read_b128 v[72:75], v1 offset:14336
    ds_read_b128 v[76:79], v1 offset:15360
    ds_read_b128 v[80:83], v1 offset:28672
    ds_read_b128 v[84:87], v1 offset:29696
    ds_read_b128 v[88:91], v1 offset:30720
    ds_read_b128 v[92:95], v1 offset:31744
    s_add_u32 s22, s21, 2
    s_cmp_gt_u32 s50, s22
    s_cbranch_scc1 mega_kernel_rs_w3_kvs
    v_readlane_b32 s50, v12, 0
    v_readlane_b32 s22, v12, 2
    v_readlane_b32 s23, v12, 1
    v_readlane_b32 s24, v12, 3
    s_nop 3
    s_min_u32 s50, s50, s22
    s_min_u32 s23, s23, s24
    s_lshl_b32 s50, s50, 1
    s_lshl_b32 s23, s23, 1
    s_add_u32 s23, s23, 1
    s_min_u32 s50, s50, s23
mega_kernel_rs_kvb1:
    s_add_u32 s22, s21, 1
    s_min_u32 s22, s22, 63
    s_cmp_gt_u32 s50, s22
    s_cbranch_scc1 mega_kernel_rs_kvd1
    buffer_load_dword v12, v7, s[4:7], 0 offen sc1
    s_waitcnt vmcnt(0)
    v_readlane_b32 s50, v12, 0
    v_readlane_b32 s22, v12, 2
    v_readlane_b32 s23, v12, 1
    v_readlane_b32 s24, v12, 3
    s_nop 3
    s_min_u32 s50, s50, s22
    s_min_u32 s23, s23, s24
    s_lshl_b32 s50, s50, 1
    s_lshl_b32 s23, s23, 1
    s_add_u32 s23, s23, 1
    s_min_u32 s50, s50, s23
    s_branch mega_kernel_rs_kvb1
mega_kernel_rs_kvd1:
mega_kernel_rs_w3_kvs:
    v_mov_b32 v58, -1
    v_mov_b32 v59, -1
    s_waitcnt vmcnt(0)
mega_kernel_rs_w3_cgo:
mega_kernel_rs_w3_pc:
    buffer_load_dword v36, v13, s[4:7], s25 offen offset:0 sc1
    buffer_load_dword v37, v13, s[4:7], s25 offen offset:256 sc1
    buffer_load_dword v38, v13, s[4:7], s25 offen offset:512 sc1
    buffer_load_dword v39, v13, s[4:7], s25 offen offset:768 sc1
    buffer_load_dword v40, v13, s[4:7], s25 offen offset:1024 sc1
    buffer_load_dword v41, v13, s[4:7], s25 offen offset:1280 sc1
    buffer_load_dword v42, v13, s[4:7], s25 offen offset:1536 sc1
    buffer_load_dword v43, v13, s[4:7], s25 offen offset:1792 sc1
    s_waitcnt vmcnt(4)
    v_mfma_f32_16x16x32_bf16 v[52:55], v[36:39], v[24:27], 0
    v_bitop3_b32 v3, s42, v36, v37 bitop3:0x7e
    v_bitop3_b32 v4, s42, v38, v39 bitop3:0x7e
    s_waitcnt vmcnt(2)
    v_or_b32 v3, v3, v4
    v_bitop3_b32 v4, s42, v40, v41 bitop3:0x7e
    s_waitcnt vmcnt(0)
    v_mfma_f32_16x16x32_bf16 v[52:55], v[40:43], v[24:27], v[52:55]
    v_bitop3_b32 v56, s42, v42, v43 bitop3:0x7e
    v_or3_b32 v3, v3, v4, v56
    v_and_b32 v3, v0, v3
    v_cmp_ne_u32 vcc, 0, v3
    s_nop 3
    v_cvt_pk_bf16_f32 v56, v52, v53
    v_cvt_pk_bf16_f32 v57, v54, v55
    v_min_u32 v56, -2, v56
    s_cbranch_vccnz mega_kernel_rs_w3_pc
    s_mov_b64 exec, s[26:27]
    buffer_store_dwordx2 v[56:57], v9, s[4:7], s35 offen offset:768 sc1
    buffer_store_dwordx2 v[58:59], v9, s[4:7], s36 offen offset:768 sc1
    s_mov_b64 exec, -1
    s_xor_b32 s42, s42, 1
    s_branch mega_kernel_rs_w3_loop
mega_kernel_rs_w3_last:
    buffer_store_dwordx4 v[64:67], v10, s[4:7], s45 offen offset:192 sc1
    buffer_store_dwordx2 v[18:19], v11, s[4:7], s51 offen offset:3584 sc1
    s_branch mega_kernel_rs_end
mega_kernel_rs_w3_pafail:
    s_nop 7
    v_mov_b32 v96, 0
    v_mov_b32 v97, 0
    v_mov_b32 v98, 0
    v_mov_b32 v99, 0
    v_mov_b32 v100, 0
    v_mov_b32 v101, 0
    v_mov_b32 v102, 0
    v_mov_b32 v103, 0
    v_mov_b32 v104, 0
    v_mov_b32 v105, 0
    v_mov_b32 v106, 0
    v_mov_b32 v107, 0
    s_branch mega_kernel_rs_w3_pa
mega_kernel_rs_w3_xslow:
    buffer_load_dwordx2 v[108:109], v11, s[4:7], s38 offen sc1
    buffer_load_dwordx2 v[110:111], v11, s[4:7], s38 offen offset:512 sc1
    s_waitcnt vmcnt(2)
    v_bitop3_b32 v3, s41, v20, v22 bitop3:0x7e
    v_mfma_f32_16x16x16_bf16 v[80:83], v[20:21], v[16:17], v[100:103]
    v_and_b32 v3, 1, v3
    v_mfma_f32_16x16x16_bf16 v[84:87], v[22:23], v[16:17], v[104:107]
    v_cmp_ne_u32 vcc, 0, v3
    s_cbranch_vccz mega_kernel_rs_w3_xgot
    buffer_load_dwordx2 v[20:21], v11, s[4:7], s38 offen sc1
    buffer_load_dwordx2 v[22:23], v11, s[4:7], s38 offen offset:512 sc1
    s_waitcnt vmcnt(2)
    v_bitop3_b32 v3, s41, v108, v110 bitop3:0x7e
    v_mfma_f32_16x16x16_bf16 v[80:83], v[108:109], v[16:17], v[100:103]
    v_and_b32 v3, 1, v3
    v_mfma_f32_16x16x16_bf16 v[84:87], v[110:111], v[16:17], v[104:107]
    v_cmp_ne_u32 vcc, 0, v3
    s_cbranch_vccz mega_kernel_rs_w3_xgot
    s_branch mega_kernel_rs_w3_xslow
mega_kernel_rs_w3_xgot:
    s_nop 3
    v_cvt_pk_bf16_f32 v64, v80, v81
    v_cvt_pk_bf16_f32 v65, v82, v83
    v_cvt_pk_bf16_f32 v66, v84, v85
    v_cvt_pk_bf16_f32 v67, v86, v87
    ds_write_b128 v6, v[64:67] offset:23552
    s_branch mega_kernel_rs_w3_xok
mega_kernel_rs_w3_pv0:
    s_waitcnt vmcnt(2)
    s_branch mega_kernel_rs_w3_pv1
mega_kernel_rs_w3_pv:
    buffer_load_dwordx2 v[20:21], v11, s[4:7], s40 offen sc1
    s_waitcnt vmcnt(0)
mega_kernel_rs_w3_pv1:
    v_and_b32 v3, 1, v20
    v_cmp_ne_u32 vcc, s41, v3
    v_mov_b32 v113, v20
    v_mov_b32 v115, v21
    s_cbranch_vccnz mega_kernel_rs_w3_pv
    s_branch mega_kernel_rs_w3_pv2
mega_kernel_rs_end:
    s_mov_b64 exec, -1
    v_mov_b32 v3, 64
    s_waitcnt vmcnt(0)
    s_barrier
    s_cmp_lg_u32 s20, 0
    s_cbranch_scc1 mega_kernel_rs_end2
    buffer_store_dword v3, v7, s[4:7], 0 offen sc1
mega_kernel_rs_end2:
    s_waitcnt vmcnt(0)
    s_endpgm
mega_kernel_bulk:
    s_load_dwordx2 s[8:9], s[0:1], 0
    s_load_dwordx2 s[40:41], s[0:1], 16
    s_load_dwordx2 s[42:43], s[0:1], 24
    s_load_dwordx2 s[44:45], s[0:1], 32
    v_lshrrev_b32 v2, 6, v0
    v_and_b32 v1, 63, v0
    v_readfirstlane_b32 s16, v2
    s_lshr_b32 s17, s92, 6
    s_bfe_u32 s18, s92, 0x50001
    s_and_b32 s19, s92, 1
    s_waitcnt lgkmcnt(0)
    s_mov_b32 s10, 4194304
    s_mov_b32 s11, 0x00020000
    s_cmp_eq_u32 s17, 1
    s_cselect_b32 s12, s42, s40
    s_cselect_b32 s13, s43, s41
    s_cmp_eq_u32 s17, 2
    s_cselect_b32 s12, s44, s12
    s_cselect_b32 s13, s45, s13
    s_mov_b32 s14, 8388608
    s_mov_b32 s15, 0x00020000
    v_lshrrev_b32 v2, 4, v1
    v_and_b32 v3, 15, v1
    v_lshlrev_b32 v4, 2, v2
    v_xor_b32 v4, v4, v3
    v_lshlrev_b32 v4, 4, v4
    s_lshl_b32 s20, s16, 5
    v_add_u32 v11, s20, v2
    v_lshl_add_u32 v11, v11, 13, v4
    s_lshl_b32 s20, s18, 8
    v_add_u32 v11, s20, v11
    s_lshl_b32 s22, s16, 13
    s_lshl_b32 s27, s19, 23
    s_and_b32 s27, s27, 4194304
    s_add_u32 m0, s22, 0
    s_xor_b32 s20, s27, 0
    buffer_load_dwordx4 v11, s[12:15], s20 offen lds
    s_add_u32 m0, s22, 1024
    s_xor_b32 s20, s27, 32768
    buffer_load_dwordx4 v11, s[12:15], s20 offen lds
    s_add_u32 m0, s22, 2048
    s_xor_b32 s20, s27, 65536
    buffer_load_dwordx4 v11, s[12:15], s20 offen lds
    s_add_u32 m0, s22, 3072
    s_xor_b32 s20, s27, 98304
    buffer_load_dwordx4 v11, s[12:15], s20 offen lds
    s_add_u32 m0, s22, 4096
    s_xor_b32 s20, s27, 131072
    buffer_load_dwordx4 v11, s[12:15], s20 offen lds
    s_add_u32 m0, s22, 5120
    s_xor_b32 s20, s27, 163840
    buffer_load_dwordx4 v11, s[12:15], s20 offen lds
    s_add_u32 m0, s22, 6144
    s_xor_b32 s20, s27, 196608
    buffer_load_dwordx4 v11, s[12:15], s20 offen lds
    s_add_u32 m0, s22, 7168
    s_xor_b32 s20, s27, 229376
    buffer_load_dwordx4 v11, s[12:15], s20 offen lds
    s_waitcnt vmcnt(8)
    s_barrier
    s_or_b32 s81, s97, s98
    s_cmp_lg_u32 s81, 0
    s_cbranch_scc1 mega_kernel_h0_3
    s_lshl_b32 s81, s93, 5
    v_mov_b32 v38, 1
    s_mov_b64 exec, 1
    buffer_atomic_add v38, off, s[88:91], s81 sc1
    s_mov_b64 exec, -1
mega_kernel_h0_3:
    s_add_u32 m0, s22, 32768
    s_xor_b32 s20, s27, 1048576
    buffer_load_dwordx4 v11, s[12:15], s20 offen lds
    s_add_u32 m0, s22, 33792
    s_xor_b32 s20, s27, 1081344
    buffer_load_dwordx4 v11, s[12:15], s20 offen lds
    s_add_u32 m0, s22, 34816
    s_xor_b32 s20, s27, 1114112
    buffer_load_dwordx4 v11, s[12:15], s20 offen lds
    s_add_u32 m0, s22, 35840
    s_xor_b32 s20, s27, 1146880
    buffer_load_dwordx4 v11, s[12:15], s20 offen lds
    s_add_u32 m0, s22, 36864
    s_xor_b32 s20, s27, 1179648
    buffer_load_dwordx4 v11, s[12:15], s20 offen lds
    s_add_u32 m0, s22, 37888
    s_xor_b32 s20, s27, 1212416
    buffer_load_dwordx4 v11, s[12:15], s20 offen lds
    s_add_u32 m0, s22, 38912
    s_xor_b32 s20, s27, 1245184
    buffer_load_dwordx4 v11, s[12:15], s20 offen lds
    s_add_u32 m0, s22, 39936
    s_xor_b32 s20, s27, 1277952
    buffer_load_dwordx4 v11, s[12:15], s20 offen lds
    s_add_u32 m0, s22, 65536
    s_xor_b32 s20, s27, 2097152
    buffer_load_dwordx4 v11, s[12:15], s20 offen lds
    s_add_u32 m0, s22, 66560
    s_xor_b32 s20, s27, 2129920
    buffer_load_dwordx4 v11, s[12:15], s20 offen lds
    s_add_u32 m0, s22, 67584
    s_xor_b32 s20, s27, 2162688
    buffer_load_dwordx4 v11, s[12:15], s20 offen lds
    s_add_u32 m0, s22, 68608
    s_xor_b32 s20, s27, 2195456
    buffer_load_dwordx4 v11, s[12:15], s20 offen lds
    s_add_u32 m0, s22, 69632
    s_xor_b32 s20, s27, 2228224
    buffer_load_dwordx4 v11, s[12:15], s20 offen lds
    s_add_u32 m0, s22, 70656
    s_xor_b32 s20, s27, 2260992
    buffer_load_dwordx4 v11, s[12:15], s20 offen lds
    s_add_u32 m0, s22, 71680
    s_xor_b32 s20, s27, 2293760
    buffer_load_dwordx4 v11, s[12:15], s20 offen lds
    s_add_u32 m0, s22, 72704
    s_xor_b32 s20, s27, 2326528
    buffer_load_dwordx4 v11, s[12:15], s20 offen lds
    s_add_u32 m0, s22, 98304
    s_xor_b32 s20, s27, 3145728
    buffer_load_dwordx4 v11, s[12:15], s20 offen lds
    s_add_u32 m0, s22, 99328
    s_xor_b32 s20, s27, 3178496
    buffer_load_dwordx4 v11, s[12:15], s20 offen lds
    s_add_u32 m0, s22, 100352
    s_xor_b32 s20, s27, 3211264
    buffer_load_dwordx4 v11, s[12:15], s20 offen lds
    s_add_u32 m0, s22, 101376
    s_xor_b32 s20, s27, 3244032
    buffer_load_dwordx4 v11, s[12:15], s20 offen lds
    s_add_u32 m0, s22, 102400
    s_xor_b32 s20, s27, 3276800
    buffer_load_dwordx4 v11, s[12:15], s20 offen lds
    s_add_u32 m0, s22, 103424
    s_xor_b32 s20, s27, 3309568
    buffer_load_dwordx4 v11, s[12:15], s20 offen lds
    s_add_u32 m0, s22, 104448
    s_xor_b32 s20, s27, 3342336
    buffer_load_dwordx4 v11, s[12:15], s20 offen lds
    s_add_u32 m0, s22, 105472
    s_xor_b32 s20, s27, 3375104
    buffer_load_dwordx4 v11, s[12:15], s20 offen lds
    v_and_b32 v3, 3, v1
    v_bfe_u32 v4, v1, 4, 1
    v_lshl_add_u32 v13, v3, 1, v4
    v_and_b32 v14, 1, v3
    v_lshlrev_b32 v14, 1, v14
    v_lshrrev_b32 v15, 1, v3
    v_add_u32 v14, v14, v15
    v_lshl_add_u32 v14, v4, 2, v14
    s_cmp_eq_u32 s17, 2
    s_cselect_b64 vcc, -1, 0
    v_cndmask_b32 v13, v14, v13, vcc
    v_bfe_u32 v14, v1, 2, 2
    v_xor_b32 v15, s16, v14
    v_lshlrev_b32 v15, 6, v15
    v_lshl_add_u32 v15, v13, 3, v15
    v_lshrrev_b32 v13, 5, v1
    v_lshl_add_u32 v13, v13, 3, v14
    v_lshl_add_u32 v12, v13, 8, v15
    v_and_b32 v3, 15, v1
    s_lshl_b32 s20, s16, 3
    v_add_u32 v13, s20, v2
    v_add_u32 v13, 0, v13
    v_and_b32 v14, 15, v13
    v_xor_b32 v14, v14, v3
    v_lshlrev_b32 v14, 4, v14
    v_lshl_add_u32 v6, v13, 11, v14
    v_add_u32 v13, s20, v2
    v_add_u32 v13, 4, v13
    v_and_b32 v14, 15, v13
    v_xor_b32 v14, v14, v3
    v_lshlrev_b32 v14, 4, v14
    v_lshl_add_u32 v7, v13, 11, v14
    v_and_b32 v13, 31, v1
    v_lshrrev_b32 v14, 5, v1
    v_xor_b32 v14, v14, v3
    v_lshlrev_b32 v14, 4, v14
    v_lshl_add_u32 v13, v13, 8, v14
    v_xor_b32 v16, 0, v13
    v_add_u32 v24, 0x10000, v16
    v_xor_b32 v17, 32, v13
    v_add_u32 v25, 0x10000, v17
    v_xor_b32 v18, 64, v13
    v_add_u32 v26, 0x10000, v18
    v_xor_b32 v19, 96, v13
    v_add_u32 v27, 0x10000, v19
    v_xor_b32 v20, 128, v13
    v_add_u32 v28, 0x10000, v20
    v_xor_b32 v21, 160, v13
    v_add_u32 v29, 0x10000, v21
    v_xor_b32 v22, 192, v13
    v_add_u32 v30, 0x10000, v22
    v_xor_b32 v23, 224, v13
    v_add_u32 v31, 0x10000, v23
    v_bfe_u32 v13, v1, 4, 1
    v_lshlrev_b32 v8, 10, v13
    v_lshrrev_b32 v13, 5, v1
    v_lshl_add_u32 v8, v13, 8, v8
    v_lshl_add_u32 v8, v3, 4, v8
    v_bfrev_b32 v13, 1
    s_lshl_b32 s20, s92, 7
    s_add_u32 s20, s20, 71303168
    v_mov_b32 v14, s20
    v_cmp_eq_u32 vcc, 0, v0
    s_lshl_b32 s24, s17, 24
    s_lshl_b32 s20, s19, 18
    v_cndmask_b32 v9, v13, v14, vcc
    s_add_u32 s24, s24, s20
    s_lshl_b32 s20, s18, 13
    s_add_u32 s24, s24, s20
    s_lshl_b32 s20, s16, 11
    s_add_u32 s24, s24, s20
    s_add_u32 s24, s24, 0
    s_lshl_b32 s23, s19, 16
    s_lshr_b32 s20, s27, 12
    s_add_u32 s23, s23, s20
    v_mov_b32 v10, 0
    s_lshl_b32 s21, s16, 11
    s_waitcnt vmcnt(24)
    s_barrier
    v_add_u32 v13, 0, v12
    ds_read_b64_tr_b16 a[0:1], v13 offset:0
    ds_read_b64_tr_b16 a[2:3], v13 offset:1024
    ds_read_b64_tr_b16 a[4:5], v13 offset:4096
    ds_read_b64_tr_b16 a[6:7], v13 offset:5120
    ds_read_b64_tr_b16 a[8:9], v13 offset:8192
    ds_read_b64_tr_b16 a[10:11], v13 offset:9216
    ds_read_b64_tr_b16 a[12:13], v13 offset:12288
    ds_read_b64_tr_b16 a[14:15], v13 offset:13312
    s_waitcnt lgkmcnt(0)
    ds_read_b64_tr_b16 a[16:17], v13 offset:16384
    ds_read_b64_tr_b16 a[18:19], v13 offset:17408
    ds_read_b64_tr_b16 a[20:21], v13 offset:20480
    ds_read_b64_tr_b16 a[22:23], v13 offset:21504
    ds_read_b64_tr_b16 a[24:25], v13 offset:24576
    ds_read_b64_tr_b16 a[26:27], v13 offset:25600
    ds_read_b64_tr_b16 a[28:29], v13 offset:28672
    ds_read_b64_tr_b16 a[30:31], v13 offset:29696
    s_waitcnt lgkmcnt(0)
    s_barrier
    s_add_u32 m0, s22, 0
    s_xor_b32 s20, s27, 4194304
    buffer_load_dwordx4 v11, s[12:15], s20 offen lds
    s_add_u32 m0, s22, 1024
    s_xor_b32 s20, s27, 4227072
    buffer_load_dwordx4 v11, s[12:15], s20 offen lds
    s_add_u32 m0, s22, 2048
    s_xor_b32 s20, s27, 4259840
    buffer_load_dwordx4 v11, s[12:15], s20 offen lds
    s_add_u32 m0, s22, 3072
    s_xor_b32 s20, s27, 4292608
    buffer_load_dwordx4 v11, s[12:15], s20 offen lds
    s_add_u32 m0, s22, 4096
    s_xor_b32 s20, s27, 4325376
    buffer_load_dwordx4 v11, s[12:15], s20 offen lds
    s_add_u32 m0, s22, 5120
    s_xor_b32 s20, s27, 4358144
    buffer_load_dwordx4 v11, s[12:15], s20 offen lds
    s_add_u32 m0, s22, 6144
    s_xor_b32 s20, s27, 4390912
    buffer_load_dwordx4 v11, s[12:15], s20 offen lds
    s_add_u32 m0, s22, 7168
    s_xor_b32 s20, s27, 4423680
    buffer_load_dwordx4 v11, s[12:15], s20 offen lds
    s_waitcnt vmcnt(24)
    s_barrier
    v_add_u32 v13, 32768, v12
    ds_read_b64_tr_b16 a[32:33], v13 offset:0
    ds_read_b64_tr_b16 a[34:35], v13 offset:1024
    ds_read_b64_tr_b16 a[36:37], v13 offset:4096
    ds_read_b64_tr_b16 a[38:39], v13 offset:5120
    ds_read_b64_tr_b16 a[40:41], v13 offset:8192
    ds_read_b64_tr_b16 a[42:43], v13 offset:9216
    ds_read_b64_tr_b16 a[44:45], v13 offset:12288
    ds_read_b64_tr_b16 a[46:47], v13 offset:13312
    s_waitcnt lgkmcnt(0)
    ds_read_b64_tr_b16 a[48:49], v13 offset:16384
    ds_read_b64_tr_b16 a[50:51], v13 offset:17408
    ds_read_b64_tr_b16 a[52:53], v13 offset:20480
    ds_read_b64_tr_b16 a[54:55], v13 offset:21504
    ds_read_b64_tr_b16 a[56:57], v13 offset:24576
    ds_read_b64_tr_b16 a[58:59], v13 offset:25600
    ds_read_b64_tr_b16 a[60:61], v13 offset:28672
    ds_read_b64_tr_b16 a[62:63], v13 offset:29696
    s_waitcnt lgkmcnt(0)
    s_barrier
    s_add_u32 m0, s22, 32768
    s_xor_b32 s20, s27, 5242880
    buffer_load_dwordx4 v11, s[12:15], s20 offen lds
    s_add_u32 m0, s22, 33792
    s_xor_b32 s20, s27, 5275648
    buffer_load_dwordx4 v11, s[12:15], s20 offen lds
    s_add_u32 m0, s22, 34816
    s_xor_b32 s20, s27, 5308416
    buffer_load_dwordx4 v11, s[12:15], s20 offen lds
    s_add_u32 m0, s22, 35840
    s_xor_b32 s20, s27, 5341184
    buffer_load_dwordx4 v11, s[12:15], s20 offen lds
    s_add_u32 m0, s22, 36864
    s_xor_b32 s20, s27, 5373952
    buffer_load_dwordx4 v11, s[12:15], s20 offen lds
    s_add_u32 m0, s22, 37888
    s_xor_b32 s20, s27, 5406720
    buffer_load_dwordx4 v11, s[12:15], s20 offen lds
    s_add_u32 m0, s22, 38912
    s_xor_b32 s20, s27, 5439488
    buffer_load_dwordx4 v11, s[12:15], s20 offen lds
    s_add_u32 m0, s22, 39936
    s_xor_b32 s20, s27, 5472256
    buffer_load_dwordx4 v11, s[12:15], s20 offen lds
    s_waitcnt vmcnt(24)
    s_barrier
    v_add_u32 v13, 65536, v12
    ds_read_b64_tr_b16 a[64:65], v13 offset:0
    ds_read_b64_tr_b16 a[66:67], v13 offset:1024
    ds_read_b64_tr_b16 a[68:69], v13 offset:4096
    ds_read_b64_tr_b16 a[70:71], v13 offset:5120
    ds_read_b64_tr_b16 a[72:73], v13 offset:8192
    ds_read_b64_tr_b16 a[74:75], v13 offset:9216
    ds_read_b64_tr_b16 a[76:77], v13 offset:12288
    ds_read_b64_tr_b16 a[78:79], v13 offset:13312
    s_waitcnt lgkmcnt(0)
    ds_read_b64_tr_b16 a[80:81], v13 offset:16384
    ds_read_b64_tr_b16 a[82:83], v13 offset:17408
    ds_read_b64_tr_b16 a[84:85], v13 offset:20480
    ds_read_b64_tr_b16 a[86:87], v13 offset:21504
    ds_read_b64_tr_b16 a[88:89], v13 offset:24576
    ds_read_b64_tr_b16 a[90:91], v13 offset:25600
    ds_read_b64_tr_b16 a[92:93], v13 offset:28672
    ds_read_b64_tr_b16 a[94:95], v13 offset:29696
    s_waitcnt lgkmcnt(0)
    s_barrier
    s_add_u32 m0, s22, 65536
    s_xor_b32 s20, s27, 6291456
    buffer_load_dwordx4 v11, s[12:15], s20 offen lds
    s_add_u32 m0, s22, 66560
    s_xor_b32 s20, s27, 6324224
    buffer_load_dwordx4 v11, s[12:15], s20 offen lds
    s_add_u32 m0, s22, 67584
    s_xor_b32 s20, s27, 6356992
    buffer_load_dwordx4 v11, s[12:15], s20 offen lds
    s_add_u32 m0, s22, 68608
    s_xor_b32 s20, s27, 6389760
    buffer_load_dwordx4 v11, s[12:15], s20 offen lds
    s_add_u32 m0, s22, 69632
    s_xor_b32 s20, s27, 6422528
    buffer_load_dwordx4 v11, s[12:15], s20 offen lds
    s_add_u32 m0, s22, 70656
    s_xor_b32 s20, s27, 6455296
    buffer_load_dwordx4 v11, s[12:15], s20 offen lds
    s_add_u32 m0, s22, 71680
    s_xor_b32 s20, s27, 6488064
    buffer_load_dwordx4 v11, s[12:15], s20 offen lds
    s_add_u32 m0, s22, 72704
    s_xor_b32 s20, s27, 6520832
    buffer_load_dwordx4 v11, s[12:15], s20 offen lds
    s_waitcnt vmcnt(24)
    s_barrier
    v_and_b32 v37, 7, v0
    v_lshlrev_b32 v37, 5, v37
    buffer_load_dword v36, v37, s[88:91], 0 offen sc1
    v_add_u32 v13, 98304, v12
    ds_read_b64_tr_b16 a[96:97], v13 offset:0
    ds_read_b64_tr_b16 a[98:99], v13 offset:1024
    ds_read_b64_tr_b16 a[100:101], v13 offset:4096
    ds_read_b64_tr_b16 a[102:103], v13 offset:5120
    ds_read_b64_tr_b16 a[104:105], v13 offset:8192
    ds_read_b64_tr_b16 a[106:107], v13 offset:9216
    ds_read_b64_tr_b16 a[108:109], v13 offset:12288
    ds_read_b64_tr_b16 a[110:111], v13 offset:13312
    s_waitcnt lgkmcnt(0)
    ds_read_b64_tr_b16 a[112:113], v13 offset:16384
    ds_read_b64_tr_b16 a[114:115], v13 offset:17408
    ds_read_b64_tr_b16 a[116:117], v13 offset:20480
    ds_read_b64_tr_b16 a[118:119], v13 offset:21504
    ds_read_b64_tr_b16 a[120:121], v13 offset:24576
    ds_read_b64_tr_b16 a[122:123], v13 offset:25600
    ds_read_b64_tr_b16 a[124:125], v13 offset:28672
    ds_read_b64_tr_b16 a[126:127], v13 offset:29696
    s_waitcnt lgkmcnt(0)
    s_barrier
    s_add_u32 m0, s22, 98304
    s_xor_b32 s20, s27, 7340032
    buffer_load_dwordx4 v11, s[12:15], s20 offen lds
    s_add_u32 m0, s22, 99328
    s_xor_b32 s20, s27, 7372800
    buffer_load_dwordx4 v11, s[12:15], s20 offen lds
    s_add_u32 m0, s22, 100352
    s_xor_b32 s20, s27, 7405568
    buffer_load_dwordx4 v11, s[12:15], s20 offen lds
    s_add_u32 m0, s22, 101376
    s_xor_b32 s20, s27, 7438336
    buffer_load_dwordx4 v11, s[12:15], s20 offen lds
    s_add_u32 m0, s22, 102400
    s_xor_b32 s20, s27, 7471104
    buffer_load_dwordx4 v11, s[12:15], s20 offen lds
    s_add_u32 m0, s22, 103424
    s_xor_b32 s20, s27, 7503872
    buffer_load_dwordx4 v11, s[12:15], s20 offen lds
    s_add_u32 m0, s22, 104448
    s_xor_b32 s20, s27, 7536640
    buffer_load_dwordx4 v11, s[12:15], s20 offen lds
    s_add_u32 m0, s22, 105472
    s_xor_b32 s20, s27, 7569408
    buffer_load_dwordx4 v11, s[12:15], s20 offen lds
    s_waitcnt vmcnt(24)
    s_barrier
    v_add_u32 v13, 0, v12
    ds_read_b64_tr_b16 a[128:129], v13 offset:0
    ds_read_b64_tr_b16 a[130:131], v13 offset:1024
    ds_read_b64_tr_b16 a[132:133], v13 offset:4096
    ds_read_b64_tr_b16 a[134:135], v13 offset:5120
    ds_read_b64_tr_b16 a[136:137], v13 offset:8192
    ds_read_b64_tr_b16 a[138:139], v13 offset:9216
    ds_read_b64_tr_b16 a[140:141], v13 offset:12288
    ds_read_b64_tr_b16 a[142:143], v13 offset:13312
    s_waitcnt lgkmcnt(0)
    ds_read_b64_tr_b16 a[144:145], v13 offset:16384
    ds_read_b64_tr_b16 a[146:147], v13 offset:17408
    ds_read_b64_tr_b16 a[148:149], v13 offset:20480
    ds_read_b64_tr_b16 a[150:151], v13 offset:21504
    ds_read_b64_tr_b16 a[152:153], v13 offset:24576
    ds_read_b64_tr_b16 a[154:155], v13 offset:25600
    ds_read_b64_tr_b16 a[156:157], v13 offset:28672
    ds_read_b64_tr_b16 a[158:159], v13 offset:29696
    s_waitcnt lgkmcnt(0)
    s_barrier
    s_add_u32 m0, s21, 0
    s_xor_b32 s20, s23, 0
    buffer_load_dwordx4 v6, s[8:11], s20 offen lds
    s_add_u32 m0, s21, 1024
    s_xor_b32 s20, s23, 0
    buffer_load_dwordx4 v7, s[8:11], s20 offen lds
    s_add_u32 m0, s21, 8192
    s_xor_b32 s20, s23, 256
    buffer_load_dwordx4 v6, s[8:11], s20 offen lds
    s_add_u32 m0, s21, 9216
    s_xor_b32 s20, s23, 256
    buffer_load_dwordx4 v7, s[8:11], s20 offen lds
    s_add_u32 m0, s21, 16384
    s_xor_b32 s20, s23, 512
    buffer_load_dwordx4 v6, s[8:11], s20 offen lds
    s_add_u32 m0, s21, 17408
    s_xor_b32 s20, s23, 512
    buffer_load_dwordx4 v7, s[8:11], s20 offen lds
    s_add_u32 m0, s21, 24576
    s_xor_b32 s20, s23, 768
    buffer_load_dwordx4 v6, s[8:11], s20 offen lds
    s_add_u32 m0, s21, 25600
    s_xor_b32 s20, s23, 768
    buffer_load_dwordx4 v7, s[8:11], s20 offen lds
    s_waitcnt vmcnt(24)
    s_barrier
    v_add_u32 v13, 32768, v12
    ds_read_b64_tr_b16 a[160:161], v13 offset:0
    ds_read_b64_tr_b16 a[162:163], v13 offset:1024
    ds_read_b64_tr_b16 a[164:165], v13 offset:4096
    ds_read_b64_tr_b16 a[166:167], v13 offset:5120
    ds_read_b64_tr_b16 a[168:169], v13 offset:8192
    ds_read_b64_tr_b16 a[170:171], v13 offset:9216
    ds_read_b64_tr_b16 a[172:173], v13 offset:12288
    ds_read_b64_tr_b16 a[174:175], v13 offset:13312
    s_waitcnt lgkmcnt(0)
    ds_read_b64_tr_b16 a[176:177], v13 offset:16384
    ds_read_b64_tr_b16 a[178:179], v13 offset:17408
    ds_read_b64_tr_b16 a[180:181], v13 offset:20480
    ds_read_b64_tr_b16 a[182:183], v13 offset:21504
    ds_read_b64_tr_b16 a[184:185], v13 offset:24576
    ds_read_b64_tr_b16 a[186:187], v13 offset:25600
    ds_read_b64_tr_b16 a[188:189], v13 offset:28672
    ds_read_b64_tr_b16 a[190:191], v13 offset:29696
    s_waitcnt lgkmcnt(0)
    s_barrier
    s_add_u32 m0, s21, 32768
    s_xor_b32 s20, s23, 1024
    buffer_load_dwordx4 v6, s[8:11], s20 offen lds
    s_add_u32 m0, s21, 33792
    s_xor_b32 s20, s23, 1024
    buffer_load_dwordx4 v7, s[8:11], s20 offen lds
    s_add_u32 m0, s21, 40960
    s_xor_b32 s20, s23, 1280
    buffer_load_dwordx4 v6, s[8:11], s20 offen lds
    s_add_u32 m0, s21, 41984
    s_xor_b32 s20, s23, 1280
    buffer_load_dwordx4 v7, s[8:11], s20 offen lds
    s_add_u32 m0, s21, 49152
    s_xor_b32 s20, s23, 1536
    buffer_load_dwordx4 v6, s[8:11], s20 offen lds
    s_add_u32 m0, s21, 50176
    s_xor_b32 s20, s23, 1536
    buffer_load_dwordx4 v7, s[8:11], s20 offen lds
    s_add_u32 m0, s21, 57344
    s_xor_b32 s20, s23, 1792
    buffer_load_dwordx4 v6, s[8:11], s20 offen lds
    s_add_u32 m0, s21, 58368
    s_xor_b32 s20, s23, 1792
    buffer_load_dwordx4 v7, s[8:11], s20 offen lds
    s_waitcnt vmcnt(24)
    s_barrier
    v_add_u32 v13, 65536, v12
    ds_read_b64_tr_b16 a[192:193], v13 offset:0
    ds_read_b64_tr_b16 a[194:195], v13 offset:1024
    ds_read_b64_tr_b16 a[196:197], v13 offset:4096
    ds_read_b64_tr_b16 a[198:199], v13 offset:5120
    ds_read_b64_tr_b16 a[200:201], v13 offset:8192
    ds_read_b64_tr_b16 a[202:203], v13 offset:9216
    ds_read_b64_tr_b16 a[204:205], v13 offset:12288
    ds_read_b64_tr_b16 a[206:207], v13 offset:13312
    s_waitcnt lgkmcnt(0)
    ds_read_b64_tr_b16 a[208:209], v13 offset:16384
    ds_read_b64_tr_b16 a[210:211], v13 offset:17408
    ds_read_b64_tr_b16 a[212:213], v13 offset:20480
    ds_read_b64_tr_b16 a[214:215], v13 offset:21504
    ds_read_b64_tr_b16 a[216:217], v13 offset:24576
    ds_read_b64_tr_b16 a[218:219], v13 offset:25600
    ds_read_b64_tr_b16 a[220:221], v13 offset:28672
    ds_read_b64_tr_b16 a[222:223], v13 offset:29696
    s_waitcnt lgkmcnt(0)
    s_barrier
    s_add_u32 s23, s23, 131072
    s_add_u32 m0, s21, 65536
    s_xor_b32 s20, s23, 0
    buffer_load_dwordx4 v6, s[8:11], s20 offen lds
    s_add_u32 m0, s21, 66560
    s_xor_b32 s20, s23, 0
    buffer_load_dwordx4 v7, s[8:11], s20 offen lds
    s_add_u32 m0, s21, 73728
    s_xor_b32 s20, s23, 256
    buffer_load_dwordx4 v6, s[8:11], s20 offen lds
    s_add_u32 m0, s21, 74752
    s_xor_b32 s20, s23, 256
    buffer_load_dwordx4 v7, s[8:11], s20 offen lds
    s_add_u32 m0, s21, 81920
    s_xor_b32 s20, s23, 512
    buffer_load_dwordx4 v6, s[8:11], s20 offen lds
    s_add_u32 m0, s21, 82944
    s_xor_b32 s20, s23, 512
    buffer_load_dwordx4 v7, s[8:11], s20 offen lds
    s_add_u32 m0, s21, 90112
    s_xor_b32 s20, s23, 768
    buffer_load_dwordx4 v6, s[8:11], s20 offen lds
    s_add_u32 m0, s21, 91136
    s_xor_b32 s20, s23, 768
    buffer_load_dwordx4 v7, s[8:11], s20 offen lds
    s_waitcnt vmcnt(24)
    s_barrier
    s_cmp_lg_u32 s97, 0
    s_cbranch_scc1 mega_kernel_h2_4_ok
mega_kernel_h2_4_ev:
    v_cmp_ne_u32 vcc, 32, v36
    s_cbranch_vccz mega_kernel_h2_4_ok
    s_mov_b32 s78, 0
    v_readlane_b32 s81, v36, 0
    s_nop 3
    s_add_u32 s78, s78, s81
    v_readlane_b32 s81, v36, 1
    s_nop 3
    s_add_u32 s78, s78, s81
    v_readlane_b32 s81, v36, 2
    s_nop 3
    s_add_u32 s78, s78, s81
    v_readlane_b32 s81, v36, 3
    s_nop 3
    s_add_u32 s78, s78, s81
    v_readlane_b32 s81, v36, 4
    s_nop 3
    s_add_u32 s78, s78, s81
    v_readlane_b32 s81, v36, 5
    s_nop 3
    s_add_u32 s78, s78, s81
    v_readlane_b32 s81, v36, 6
    s_nop 3
    s_add_u32 s78, s78, s81
    v_readlane_b32 s81, v36, 7
    s_nop 3
    s_add_u32 s78, s78, s81
    s_cmp_eq_u32 s78, 256
    s_cbranch_scc1 mega_kernel_redo
    buffer_load_dword v36, v37, s[88:91], 0 offen sc1
    s_waitcnt vmcnt(0)
    s_branch mega_kernel_h2_4_ev
mega_kernel_h2_4_ok:
    v_add_u32 v13, 98304, v12
    ds_read_b64_tr_b16 a[224:225], v13 offset:0
    ds_read_b64_tr_b16 a[226:227], v13 offset:1024
    ds_read_b64_tr_b16 a[228:229], v13 offset:4096
    ds_read_b64_tr_b16 a[230:231], v13 offset:5120
    ds_read_b64_tr_b16 a[232:233], v13 offset:8192
    ds_read_b64_tr_b16 a[234:235], v13 offset:9216
    ds_read_b64_tr_b16 a[236:237], v13 offset:12288
    ds_read_b64_tr_b16 a[238:239], v13 offset:13312
    s_waitcnt lgkmcnt(0)
    ds_read_b64_tr_b16 a[240:241], v13 offset:16384
    ds_read_b64_tr_b16 a[242:243], v13 offset:17408
    ds_read_b64_tr_b16 a[244:245], v13 offset:20480
    ds_read_b64_tr_b16 a[246:247], v13 offset:21504
    ds_read_b64_tr_b16 a[248:249], v13 offset:24576
    ds_read_b64_tr_b16 a[250:251], v13 offset:25600
    ds_read_b64_tr_b16 a[252:253], v13 offset:28672
    ds_read_b64_tr_b16 a[254:255], v13 offset:29696
    s_waitcnt lgkmcnt(0)
    s_barrier
    s_waitcnt vmcnt(16)
    s_barrier
    s_cmp_eq_u32 s17, 2
    s_cbranch_scc1 mega_kernel_q_v
    ds_read_b128 v[32:35], v16 offset:0
    ds_read_b128 v[36:39], v17 offset:0
    ds_read_b128 v[40:43], v18 offset:0
    ds_read_b128 v[44:47], v19 offset:0
    ds_read_b128 v[48:51], v20 offset:0
    ds_read_b128 v[52:55], v21 offset:0
    s_mov_b32 s25, 0
mega_kernel_q_qk_loop:
    s_waitcnt lgkmcnt(5)
    v_mfma_f32_32x32x16_bf16 v[64:79], a[0:3], v[32:35], 0
    ds_read_b128 v[56:59], v22 offset:0
    s_waitcnt lgkmcnt(5)
    v_mfma_f32_32x32x16_bf16 v[64:79], a[4:7], v[36:39], v[64:79]
    ds_read_b128 v[60:63], v23 offset:0
    s_waitcnt lgkmcnt(5)
    v_mfma_f32_32x32x16_bf16 v[64:79], a[8:11], v[40:43], v[64:79]
    ds_read_b128 v[32:35], v16 offset:8192
    s_cmp_eq_u32 s25, 0
    s_cbranch_scc1 mega_kernel_q_qk_sk2
    s_add_u32 m0, s21, 74752
    s_xor_b32 s20, s23, 256
    buffer_load_dwordx4 v7, s[8:11], s20 offen lds
mega_kernel_q_qk_sk2:
    s_waitcnt lgkmcnt(5)
    v_mfma_f32_32x32x16_bf16 v[64:79], a[12:15], v[44:47], v[64:79]
    ds_read_b128 v[36:39], v17 offset:8192
    s_waitcnt lgkmcnt(5)
    v_mfma_f32_32x32x16_bf16 v[64:79], a[16:19], v[48:51], v[64:79]
    ds_read_b128 v[40:43], v18 offset:8192
    s_waitcnt lgkmcnt(5)
    v_mfma_f32_32x32x16_bf16 v[64:79], a[20:23], v[52:55], v[64:79]
    ds_read_b128 v[44:47], v19 offset:8192
    s_cmp_eq_u32 s25, 0
    s_cbranch_scc1 mega_kernel_q_qk_sk5
    s_add_u32 m0, s21, 81920
    s_xor_b32 s20, s23, 512
    buffer_load_dwordx4 v6, s[8:11], s20 offen lds
mega_kernel_q_qk_sk5:
    s_waitcnt lgkmcnt(5)
    v_mfma_f32_32x32x16_bf16 v[64:79], a[24:27], v[56:59], v[64:79]
    ds_read_b128 v[48:51], v20 offset:8192
    s_waitcnt lgkmcnt(5)
    v_mfma_f32_32x32x16_bf16 v[64:79], a[28:31], v[60:63], v[64:79]
    ds_read_b128 v[52:55], v21 offset:8192
    s_waitcnt lgkmcnt(5)
    v_mfma_f32_32x32x16_bf16 v[64:79], a[32:35], v[32:35], v[64:79]
    ds_read_b128 v[56:59], v22 offset:8192
    s_cmp_eq_u32 s25, 0
    s_cbranch_scc1 mega_kernel_q_qk_sk8
    s_add_u32 m0, s21, 82944
    s_xor_b32 s20, s23, 512
    buffer_load_dwordx4 v7, s[8:11], s20 offen lds
mega_kernel_q_qk_sk8:
    s_waitcnt lgkmcnt(5)
    v_mfma_f32_32x32x16_bf16 v[64:79], a[36:39], v[36:39], v[64:79]
    ds_read_b128 v[60:63], v23 offset:8192
    s_waitcnt lgkmcnt(5)
    v_mfma_f32_32x32x16_bf16 v[64:79], a[40:43], v[40:43], v[64:79]
    ds_read_b128 v[32:35], v16 offset:16384
    s_waitcnt lgkmcnt(5)
    v_mfma_f32_32x32x16_bf16 v[64:79], a[44:47], v[44:47], v[64:79]
    ds_read_b128 v[36:39], v17 offset:16384
    s_cmp_eq_u32 s25, 0
    s_cbranch_scc1 mega_kernel_q_qk_sk11
    s_add_u32 m0, s21, 90112
    s_xor_b32 s20, s23, 768
    buffer_load_dwordx4 v6, s[8:11], s20 offen lds
mega_kernel_q_qk_sk11:
    s_waitcnt lgkmcnt(5)
    v_mfma_f32_32x32x16_bf16 v[64:79], a[48:51], v[48:51], v[64:79]
    ds_read_b128 v[40:43], v18 offset:16384
    s_waitcnt lgkmcnt(5)
    v_mfma_f32_32x32x16_bf16 v[64:79], a[52:55], v[52:55], v[64:79]
    ds_read_b128 v[44:47], v19 offset:16384
    s_waitcnt lgkmcnt(5)
    v_mfma_f32_32x32x16_bf16 v[64:79], a[56:59], v[56:59], v[64:79]
    ds_read_b128 v[48:51], v20 offset:16384
    s_cmp_eq_u32 s25, 0
    s_cbranch_scc1 mega_kernel_q_qk_sk14
    s_add_u32 m0, s21, 91136
    s_xor_b32 s20, s23, 768
    buffer_load_dwordx4 v7, s[8:11], s20 offen lds
mega_kernel_q_qk_sk14:
    s_waitcnt lgkmcnt(5)
    v_mfma_f32_32x32x16_bf16 v[64:79], a[60:63], v[60:63], v[64:79]
    ds_read_b128 v[52:55], v21 offset:16384
    s_waitcnt lgkmcnt(5)
    v_mfma_f32_32x32x16_bf16 v[64:79], a[64:67], v[32:35], v[64:79]
    ds_read_b128 v[56:59], v22 offset:16384
    s_cmp_eq_u32 s25, 0
    s_cbranch_scc1 mega_kernel_q_qk_ne0
    v_cvt_pk_bf16_f32 v96, v80, v81
    v_cvt_pk_bf16_f32 v97, v82, v83
    v_cvt_pk_bf16_f32 v98, v84, v85
    v_cvt_pk_bf16_f32 v99, v86, v87
    buffer_store_dwordx4 v[96:99], v8, s[84:87], s24 offen offset:0 sc1
mega_kernel_q_qk_ne0:
    s_waitcnt lgkmcnt(5)
    v_mfma_f32_32x32x16_bf16 v[64:79], a[68:71], v[36:39], v[64:79]
    ds_read_b128 v[60:63], v23 offset:16384
    s_waitcnt lgkmcnt(5)
    v_mfma_f32_32x32x16_bf16 v[64:79], a[72:75], v[40:43], v[64:79]
    ds_read_b128 v[32:35], v16 offset:24576
    s_cmp_eq_u32 s25, 0
    s_cbranch_scc1 mega_kernel_q_qk_ne1
    v_cvt_pk_bf16_f32 v100, v88, v89
    v_cvt_pk_bf16_f32 v101, v90, v91
    v_cvt_pk_bf16_f32 v102, v92, v93
    v_cvt_pk_bf16_f32 v103, v94, v95
    buffer_store_dwordx4 v[100:103], v8, s[84:87], s24 offen offset:512 sc1
    s_add_u32 s24, s24, 524288
mega_kernel_q_qk_ne1:
    s_waitcnt lgkmcnt(5)
    v_mfma_f32_32x32x16_bf16 v[64:79], a[76:79], v[44:47], v[64:79]
    ds_read_b128 v[36:39], v17 offset:24576
    s_waitcnt lgkmcnt(5)
    v_mfma_f32_32x32x16_bf16 v[64:79], a[80:83], v[48:51], v[64:79]
    ds_read_b128 v[40:43], v18 offset:24576
    s_waitcnt lgkmcnt(5)
    v_mfma_f32_32x32x16_bf16 v[64:79], a[84:87], v[52:55], v[64:79]
    ds_read_b128 v[44:47], v19 offset:24576
    s_waitcnt lgkmcnt(5)
    v_mfma_f32_32x32x16_bf16 v[64:79], a[88:91], v[56:59], v[64:79]
    ds_read_b128 v[48:51], v20 offset:24576
    s_waitcnt lgkmcnt(5)
    v_mfma_f32_32x32x16_bf16 v[64:79], a[92:95], v[60:63], v[64:79]
    ds_read_b128 v[52:55], v21 offset:24576
    s_waitcnt vmcnt(8)
    s_barrier
    s_waitcnt lgkmcnt(5)
    v_mfma_f32_32x32x16_bf16 v[64:79], a[96:99], v[32:35], v[64:79]
    ds_read_b128 v[56:59], v22 offset:24576
    s_waitcnt lgkmcnt(5)
    v_mfma_f32_32x32x16_bf16 v[64:79], a[100:103], v[36:39], v[64:79]
    ds_read_b128 v[60:63], v23 offset:24576
    s_add_u32 m0, s21, 98304
    s_xor_b32 s20, s23, 1024
    buffer_load_dwordx4 v6, s[8:11], s20 offen lds
    s_waitcnt lgkmcnt(5)
    v_mfma_f32_32x32x16_bf16 v[64:79], a[104:107], v[40:43], v[64:79]
    ds_read_b128 v[32:35], v16 offset:32768
    s_waitcnt lgkmcnt(5)
    v_mfma_f32_32x32x16_bf16 v[64:79], a[108:111], v[44:47], v[64:79]
    ds_read_b128 v[36:39], v17 offset:32768
    s_waitcnt lgkmcnt(5)
    v_mfma_f32_32x32x16_bf16 v[64:79], a[112:115], v[48:51], v[64:79]
    ds_read_b128 v[40:43], v18 offset:32768
    s_add_u32 m0, s21, 99328
    s_xor_b32 s20, s23, 1024
    buffer_load_dwordx4 v7, s[8:11], s20 offen lds
    s_waitcnt lgkmcnt(5)
    v_mfma_f32_32x32x16_bf16 v[64:79], a[116:119], v[52:55], v[64:79]
    ds_read_b128 v[44:47], v19 offset:32768
    s_waitcnt lgkmcnt(5)
    v_mfma_f32_32x32x16_bf16 v[64:79], a[120:123], v[56:59], v[64:79]
    ds_read_b128 v[48:51], v20 offset:32768
    s_waitcnt lgkmcnt(5)
    v_mfma_f32_32x32x16_bf16 v[64:79], a[124:127], v[60:63], v[64:79]
    ds_read_b128 v[52:55], v21 offset:32768
    s_add_u32 m0, s21, 106496
    s_xor_b32 s20, s23, 1280
    buffer_load_dwordx4 v6, s[8:11], s20 offen lds
    s_waitcnt lgkmcnt(5)
    v_mfma_f32_32x32x16_bf16 v[64:79], a[128:131], v[32:35], v[64:79]
    ds_read_b128 v[56:59], v22 offset:32768
    s_waitcnt lgkmcnt(5)
    v_mfma_f32_32x32x16_bf16 v[64:79], a[132:135], v[36:39], v[64:79]
    ds_read_b128 v[60:63], v23 offset:32768
    s_waitcnt lgkmcnt(5)
    v_mfma_f32_32x32x16_bf16 v[64:79], a[136:139], v[40:43], v[64:79]
    ds_read_b128 v[32:35], v16 offset:40960
    s_add_u32 m0, s21, 107520
    s_xor_b32 s20, s23, 1280
    buffer_load_dwordx4 v7, s[8:11], s20 offen lds
    s_waitcnt lgkmcnt(5)
    v_mfma_f32_32x32x16_bf16 v[64:79], a[140:143], v[44:47], v[64:79]
    ds_read_b128 v[36:39], v17 offset:40960
    s_waitcnt lgkmcnt(5)
    v_mfma_f32_32x32x16_bf16 v[64:79], a[144:147], v[48:51], v[64:79]
    ds_read_b128 v[40:43], v18 offset:40960
    s_waitcnt lgkmcnt(5)
    v_mfma_f32_32x32x16_bf16 v[64:79], a[148:151], v[52:55], v[64:79]
    ds_read_b128 v[44:47], v19 offset:40960
    s_add_u32 m0, s21, 114688
    s_xor_b32 s20, s23, 1536
    buffer_load_dwordx4 v6, s[8:11], s20 offen lds
    s_waitcnt lgkmcnt(5)
    v_mfma_f32_32x32x16_bf16 v[64:79], a[152:155], v[56:59], v[64:79]
    ds_read_b128 v[48:51], v20 offset:40960
    s_waitcnt lgkmcnt(5)
    v_mfma_f32_32x32x16_bf16 v[64:79], a[156:159], v[60:63], v[64:79]
    ds_read_b128 v[52:55], v21 offset:40960
    s_waitcnt lgkmcnt(5)
    v_mfma_f32_32x32x16_bf16 v[64:79], a[160:163], v[32:35], v[64:79]
    ds_read_b128 v[56:59], v22 offset:40960
    s_add_u32 m0, s21, 115712
    s_xor_b32 s20, s23, 1536
    buffer_load_dwordx4 v7, s[8:11], s20 offen lds
    s_waitcnt lgkmcnt(5)
    v_mfma_f32_32x32x16_bf16 v[64:79], a[164:167], v[36:39], v[64:79]
    ds_read_b128 v[60:63], v23 offset:40960
    s_waitcnt lgkmcnt(5)
    v_mfma_f32_32x32x16_bf16 v[64:79], a[168:171], v[40:43], v[64:79]
    ds_read_b128 v[32:35], v16 offset:49152
    s_waitcnt lgkmcnt(5)
    v_mfma_f32_32x32x16_bf16 v[64:79], a[172:175], v[44:47], v[64:79]
    ds_read_b128 v[36:39], v17 offset:49152
    s_add_u32 m0, s21, 122880
    s_xor_b32 s20, s23, 1792
    buffer_load_dwordx4 v6, s[8:11], s20 offen lds
    s_waitcnt lgkmcnt(5)
    v_mfma_f32_32x32x16_bf16 v[64:79], a[176:179], v[48:51], v[64:79]
    ds_read_b128 v[40:43], v18 offset:49152
    s_waitcnt lgkmcnt(5)
    v_mfma_f32_32x32x16_bf16 v[64:79], a[180:183], v[52:55], v[64:79]
    ds_read_b128 v[44:47], v19 offset:49152
    s_waitcnt lgkmcnt(5)
    v_mfma_f32_32x32x16_bf16 v[64:79], a[184:187], v[56:59], v[64:79]
    ds_read_b128 v[48:51], v20 offset:49152
    s_add_u32 m0, s21, 123904
    s_xor_b32 s20, s23, 1792
    buffer_load_dwordx4 v7, s[8:11], s20 offen lds
    s_waitcnt lgkmcnt(5)
    v_mfma_f32_32x32x16_bf16 v[64:79], a[188:191], v[60:63], v[64:79]
    ds_read_b128 v[52:55], v21 offset:49152
    s_waitcnt lgkmcnt(5)
    v_mfma_f32_32x32x16_bf16 v[64:79], a[192:195], v[32:35], v[64:79]
    ds_read_b128 v[56:59], v22 offset:49152
    s_waitcnt lgkmcnt(5)
    v_mfma_f32_32x32x16_bf16 v[64:79], a[196:199], v[36:39], v[64:79]
    ds_read_b128 v[60:63], v23 offset:49152
    s_waitcnt lgkmcnt(5)
    v_mfma_f32_32x32x16_bf16 v[64:79], a[200:203], v[40:43], v[64:79]
    ds_read_b128 v[32:35], v16 offset:57344
    s_waitcnt lgkmcnt(5)
    v_mfma_f32_32x32x16_bf16 v[64:79], a[204:207], v[44:47], v[64:79]
    ds_read_b128 v[36:39], v17 offset:57344
    s_waitcnt lgkmcnt(5)
    v_mfma_f32_32x32x16_bf16 v[64:79], a[208:211], v[48:51], v[64:79]
    ds_read_b128 v[40:43], v18 offset:57344
    s_waitcnt lgkmcnt(5)
    v_mfma_f32_32x32x16_bf16 v[64:79], a[212:215], v[52:55], v[64:79]
    ds_read_b128 v[44:47], v19 offset:57344
    s_waitcnt lgkmcnt(5)
    v_mfma_f32_32x32x16_bf16 v[64:79], a[216:219], v[56:59], v[64:79]
    ds_read_b128 v[48:51], v20 offset:57344
    s_waitcnt lgkmcnt(5)
    v_mfma_f32_32x32x16_bf16 v[64:79], a[220:223], v[60:63], v[64:79]
    ds_read_b128 v[52:55], v21 offset:57344
    s_waitcnt vmcnt(8)
    s_barrier
    s_waitcnt lgkmcnt(5)
    v_mfma_f32_32x32x16_bf16 v[64:79], a[224:227], v[32:35], v[64:79]
    ds_read_b128 v[56:59], v22 offset:57344
    s_waitcnt lgkmcnt(5)
    v_mfma_f32_32x32x16_bf16 v[64:79], a[228:231], v[36:39], v[64:79]
    ds_read_b128 v[60:63], v23 offset:57344
    s_add_u32 s23, s23, 131072
    s_add_u32 m0, s21, 0
    s_xor_b32 s20, s23, 0
    buffer_load_dwordx4 v6, s[8:11], s20 offen lds
    s_waitcnt lgkmcnt(5)
    v_mfma_f32_32x32x16_bf16 v[64:79], a[232:235], v[40:43], v[64:79]
    ds_read_b128 v[32:35], v24 offset:0
    s_cmp_eq_u32 s25, 0
    s_cbranch_scc1 mega_kernel_q_qk_nf
    v_add_u32 v10, 1, v10
    buffer_store_dword v10, v9, s[84:87], 0 offen sc1
mega_kernel_q_qk_nf:
    s_waitcnt lgkmcnt(5)
    v_mfma_f32_32x32x16_bf16 v[64:79], a[236:239], v[44:47], v[64:79]
    ds_read_b128 v[36:39], v25 offset:0
    s_waitcnt lgkmcnt(5)
    v_mfma_f32_32x32x16_bf16 v[64:79], a[240:243], v[48:51], v[64:79]
    ds_read_b128 v[40:43], v26 offset:0
    s_add_u32 m0, s21, 1024
    s_xor_b32 s20, s23, 0
    buffer_load_dwordx4 v7, s[8:11], s20 offen lds
    s_waitcnt lgkmcnt(5)
    v_mfma_f32_32x32x16_bf16 v[64:79], a[244:247], v[52:55], v[64:79]
    ds_read_b128 v[44:47], v27 offset:0
    s_waitcnt lgkmcnt(5)
    v_mfma_f32_32x32x16_bf16 v[64:79], a[248:251], v[56:59], v[64:79]
    ds_read_b128 v[48:51], v28 offset:0
    s_waitcnt lgkmcnt(5)
    v_mfma_f32_32x32x16_bf16 v[64:79], a[252:255], v[60:63], v[64:79]
    ds_read_b128 v[52:55], v29 offset:0
    s_add_u32 m0, s21, 8192
    s_xor_b32 s20, s23, 256
    buffer_load_dwordx4 v6, s[8:11], s20 offen lds
    s_waitcnt lgkmcnt(5)
    v_mfma_f32_32x32x16_bf16 v[80:95], a[0:3], v[32:35], 0
    ds_read_b128 v[56:59], v30 offset:0
    s_waitcnt lgkmcnt(5)
    v_mfma_f32_32x32x16_bf16 v[80:95], a[4:7], v[36:39], v[80:95]
    ds_read_b128 v[60:63], v31 offset:0
    s_waitcnt lgkmcnt(5)
    v_mfma_f32_32x32x16_bf16 v[80:95], a[8:11], v[40:43], v[80:95]
    ds_read_b128 v[32:35], v24 offset:8192
    s_add_u32 m0, s21, 9216
    s_xor_b32 s20, s23, 256
    buffer_load_dwordx4 v7, s[8:11], s20 offen lds
    s_waitcnt lgkmcnt(5)
    v_mfma_f32_32x32x16_bf16 v[80:95], a[12:15], v[44:47], v[80:95]
    ds_read_b128 v[36:39], v25 offset:8192
    s_waitcnt lgkmcnt(5)
    v_mfma_f32_32x32x16_bf16 v[80:95], a[16:19], v[48:51], v[80:95]
    ds_read_b128 v[40:43], v26 offset:8192
    s_waitcnt lgkmcnt(5)
    v_mfma_f32_32x32x16_bf16 v[80:95], a[20:23], v[52:55], v[80:95]
    ds_read_b128 v[44:47], v27 offset:8192
    s_add_u32 m0, s21, 16384
    s_xor_b32 s20, s23, 512
    buffer_load_dwordx4 v6, s[8:11], s20 offen lds
    s_waitcnt lgkmcnt(5)
    v_mfma_f32_32x32x16_bf16 v[80:95], a[24:27], v[56:59], v[80:95]
    ds_read_b128 v[48:51], v28 offset:8192
    s_waitcnt lgkmcnt(5)
    v_mfma_f32_32x32x16_bf16 v[80:95], a[28:31], v[60:63], v[80:95]
    ds_read_b128 v[52:55], v29 offset:8192
    s_waitcnt lgkmcnt(5)
    v_mfma_f32_32x32x16_bf16 v[80:95], a[32:35], v[32:35], v[80:95]
    ds_read_b128 v[56:59], v30 offset:8192
    s_add_u32 m0, s21, 17408
    s_xor_b32 s20, s23, 512
    buffer_load_dwordx4 v7, s[8:11], s20 offen lds
    s_waitcnt lgkmcnt(5)
    v_mfma_f32_32x32x16_bf16 v[80:95], a[36:39], v[36:39], v[80:95]
    ds_read_b128 v[60:63], v31 offset:8192
    s_waitcnt lgkmcnt(5)
    v_mfma_f32_32x32x16_bf16 v[80:95], a[40:43], v[40:43], v[80:95]
    ds_read_b128 v[32:35], v24 offset:16384
    s_waitcnt lgkmcnt(5)
    v_mfma_f32_32x32x16_bf16 v[80:95], a[44:47], v[44:47], v[80:95]
    ds_read_b128 v[36:39], v25 offset:16384
    s_add_u32 m0, s21, 24576
    s_xor_b32 s20, s23, 768
    buffer_load_dwordx4 v6, s[8:11], s20 offen lds
    s_waitcnt lgkmcnt(5)
    v_mfma_f32_32x32x16_bf16 v[80:95], a[48:51], v[48:51], v[80:95]
    ds_read_b128 v[40:43], v26 offset:16384
    s_waitcnt lgkmcnt(5)
    v_mfma_f32_32x32x16_bf16 v[80:95], a[52:55], v[52:55], v[80:95]
    ds_read_b128 v[44:47], v27 offset:16384
    s_waitcnt lgkmcnt(5)
    v_mfma_f32_32x32x16_bf16 v[80:95], a[56:59], v[56:59], v[80:95]
    ds_read_b128 v[48:51], v28 offset:16384
    s_add_u32 m0, s21, 25600
    s_xor_b32 s20, s23, 768
    buffer_load_dwordx4 v7, s[8:11], s20 offen lds
    s_waitcnt lgkmcnt(5)
    v_mfma_f32_32x32x16_bf16 v[80:95], a[60:63], v[60:63], v[80:95]
    ds_read_b128 v[52:55], v29 offset:16384
    s_waitcnt lgkmcnt(5)
    v_mfma_f32_32x32x16_bf16 v[80:95], a[64:67], v[32:35], v[80:95]
    ds_read_b128 v[56:59], v30 offset:16384
    v_cvt_pk_bf16_f32 v96, v64, v65
    v_cvt_pk_bf16_f32 v97, v66, v67
    v_cvt_pk_bf16_f32 v98, v68, v69
    v_cvt_pk_bf16_f32 v99, v70, v71
    buffer_store_dwordx4 v[96:99], v8, s[84:87], s24 offen offset:0 sc1
    s_waitcnt lgkmcnt(5)
    v_mfma_f32_32x32x16_bf16 v[80:95], a[68:71], v[36:39], v[80:95]
    ds_read_b128 v[60:63], v31 offset:16384
    s_waitcnt lgkmcnt(5)
    v_mfma_f32_32x32x16_bf16 v[80:95], a[72:75], v[40:43], v[80:95]
    ds_read_b128 v[32:35], v24 offset:24576
    v_cvt_pk_bf16_f32 v100, v72, v73
    v_cvt_pk_bf16_f32 v101, v74, v75
    v_cvt_pk_bf16_f32 v102, v76, v77
    v_cvt_pk_bf16_f32 v103, v78, v79
    buffer_store_dwordx4 v[100:103], v8, s[84:87], s24 offen offset:512 sc1
    s_add_u32 s24, s24, 524288
    s_waitcnt lgkmcnt(5)
    v_mfma_f32_32x32x16_bf16 v[80:95], a[76:79], v[44:47], v[80:95]
    ds_read_b128 v[36:39], v25 offset:24576
    s_waitcnt lgkmcnt(5)
    v_mfma_f32_32x32x16_bf16 v[80:95], a[80:83], v[48:51], v[80:95]
    ds_read_b128 v[40:43], v26 offset:24576
    s_waitcnt lgkmcnt(5)
    v_mfma_f32_32x32x16_bf16 v[80:95], a[84:87], v[52:55], v[80:95]
    ds_read_b128 v[44:47], v27 offset:24576
    s_waitcnt lgkmcnt(5)
    v_mfma_f32_32x32x16_bf16 v[80:95], a[88:91], v[56:59], v[80:95]
    ds_read_b128 v[48:51], v28 offset:24576
    s_waitcnt lgkmcnt(5)
    v_mfma_f32_32x32x16_bf16 v[80:95], a[92:95], v[60:63], v[80:95]
    ds_read_b128 v[52:55], v29 offset:24576
    s_waitcnt vmcnt(8)
    s_barrier
    s_waitcnt lgkmcnt(5)
    v_mfma_f32_32x32x16_bf16 v[80:95], a[96:99], v[32:35], v[80:95]
    ds_read_b128 v[56:59], v30 offset:24576
    s_waitcnt lgkmcnt(5)
    v_mfma_f32_32x32x16_bf16 v[80:95], a[100:103], v[36:39], v[80:95]
    ds_read_b128 v[60:63], v31 offset:24576
    s_add_u32 m0, s21, 32768
    s_xor_b32 s20, s23, 1024
    buffer_load_dwordx4 v6, s[8:11], s20 offen lds
    s_waitcnt lgkmcnt(5)
    v_mfma_f32_32x32x16_bf16 v[80:95], a[104:107], v[40:43], v[80:95]
    ds_read_b128 v[32:35], v24 offset:32768
    s_waitcnt lgkmcnt(5)
    v_mfma_f32_32x32x16_bf16 v[80:95], a[108:111], v[44:47], v[80:95]
    ds_read_b128 v[36:39], v25 offset:32768
    s_waitcnt lgkmcnt(5)
    v_mfma_f32_32x32x16_bf16 v[80:95], a[112:115], v[48:51], v[80:95]
    ds_read_b128 v[40:43], v26 offset:32768
    s_add_u32 m0, s21, 33792
    s_xor_b32 s20, s23, 1024
    buffer_load_dwordx4 v7, s[8:11], s20 offen lds
    s_waitcnt lgkmcnt(5)
    v_mfma_f32_32x32x16_bf16 v[80:95], a[116:119], v[52:55], v[80:95]
    ds_read_b128 v[44:47], v27 offset:32768
    s_waitcnt lgkmcnt(5)
    v_mfma_f32_32x32x16_bf16 v[80:95], a[120:123], v[56:59], v[80:95]
    ds_read_b128 v[48:51], v28 offset:32768
    s_waitcnt lgkmcnt(5)
    v_mfma_f32_32x32x16_bf16 v[80:95], a[124:127], v[60:63], v[80:95]
    ds_read_b128 v[52:55], v29 offset:32768
    s_add_u32 m0, s21, 40960
    s_xor_b32 s20, s23, 1280
    buffer_load_dwordx4 v6, s[8:11], s20 offen lds
    s_waitcnt lgkmcnt(5)
    v_mfma_f32_32x32x16_bf16 v[80:95], a[128:131], v[32:35], v[80:95]
    ds_read_b128 v[56:59], v30 offset:32768
    s_waitcnt lgkmcnt(5)
    v_mfma_f32_32x32x16_bf16 v[80:95], a[132:135], v[36:39], v[80:95]
    ds_read_b128 v[60:63], v31 offset:32768
    s_waitcnt lgkmcnt(5)
    v_mfma_f32_32x32x16_bf16 v[80:95], a[136:139], v[40:43], v[80:95]
    ds_read_b128 v[32:35], v24 offset:40960
    s_add_u32 m0, s21, 41984
    s_xor_b32 s20, s23, 1280
    buffer_load_dwordx4 v7, s[8:11], s20 offen lds
    s_waitcnt lgkmcnt(5)
    v_mfma_f32_32x32x16_bf16 v[80:95], a[140:143], v[44:47], v[80:95]
    ds_read_b128 v[36:39], v25 offset:40960
    s_waitcnt lgkmcnt(5)
    v_mfma_f32_32x32x16_bf16 v[80:95], a[144:147], v[48:51], v[80:95]
    ds_read_b128 v[40:43], v26 offset:40960
    s_waitcnt lgkmcnt(5)
    v_mfma_f32_32x32x16_bf16 v[80:95], a[148:151], v[52:55], v[80:95]
    ds_read_b128 v[44:47], v27 offset:40960
    s_add_u32 m0, s21, 49152
    s_xor_b32 s20, s23, 1536
    buffer_load_dwordx4 v6, s[8:11], s20 offen lds
    s_waitcnt lgkmcnt(5)
    v_mfma_f32_32x32x16_bf16 v[80:95], a[152:155], v[56:59], v[80:95]
    ds_read_b128 v[48:51], v28 offset:40960
    s_waitcnt lgkmcnt(5)
    v_mfma_f32_32x32x16_bf16 v[80:95], a[156:159], v[60:63], v[80:95]
    ds_read_b128 v[52:55], v29 offset:40960
    s_waitcnt lgkmcnt(5)
    v_mfma_f32_32x32x16_bf16 v[80:95], a[160:163], v[32:35], v[80:95]
    ds_read_b128 v[56:59], v30 offset:40960
    s_add_u32 m0, s21, 50176
    s_xor_b32 s20, s23, 1536
    buffer_load_dwordx4 v7, s[8:11], s20 offen lds
    s_waitcnt lgkmcnt(5)
    v_mfma_f32_32x32x16_bf16 v[80:95], a[164:167], v[36:39], v[80:95]
    ds_read_b128 v[60:63], v31 offset:40960
    s_waitcnt lgkmcnt(5)
    v_mfma_f32_32x32x16_bf16 v[80:95], a[168:171], v[40:43], v[80:95]
    ds_read_b128 v[32:35], v24 offset:49152
    s_waitcnt lgkmcnt(5)
    v_mfma_f32_32x32x16_bf16 v[80:95], a[172:175], v[44:47], v[80:95]
    ds_read_b128 v[36:39], v25 offset:49152
    s_add_u32 m0, s21, 57344
    s_xor_b32 s20, s23, 1792
    buffer_load_dwordx4 v6, s[8:11], s20 offen lds
    s_waitcnt lgkmcnt(5)
    v_mfma_f32_32x32x16_bf16 v[80:95], a[176:179], v[48:51], v[80:95]
    ds_read_b128 v[40:43], v26 offset:49152
    s_waitcnt lgkmcnt(5)
    v_mfma_f32_32x32x16_bf16 v[80:95], a[180:183], v[52:55], v[80:95]
    ds_read_b128 v[44:47], v27 offset:49152
    s_waitcnt lgkmcnt(5)
    v_mfma_f32_32x32x16_bf16 v[80:95], a[184:187], v[56:59], v[80:95]
    ds_read_b128 v[48:51], v28 offset:49152
    s_add_u32 m0, s21, 58368
    s_xor_b32 s20, s23, 1792
    buffer_load_dwordx4 v7, s[8:11], s20 offen lds
    s_waitcnt lgkmcnt(5)
    v_mfma_f32_32x32x16_bf16 v[80:95], a[188:191], v[60:63], v[80:95]
    ds_read_b128 v[52:55], v29 offset:49152
    s_waitcnt lgkmcnt(5)
    v_mfma_f32_32x32x16_bf16 v[80:95], a[192:195], v[32:35], v[80:95]
    ds_read_b128 v[56:59], v30 offset:49152
    s_waitcnt lgkmcnt(5)
    v_mfma_f32_32x32x16_bf16 v[80:95], a[196:199], v[36:39], v[80:95]
    ds_read_b128 v[60:63], v31 offset:49152
    s_waitcnt lgkmcnt(5)
    v_mfma_f32_32x32x16_bf16 v[80:95], a[200:203], v[40:43], v[80:95]
    ds_read_b128 v[32:35], v24 offset:57344
    s_waitcnt lgkmcnt(5)
    v_mfma_f32_32x32x16_bf16 v[80:95], a[204:207], v[44:47], v[80:95]
    ds_read_b128 v[36:39], v25 offset:57344
    s_waitcnt lgkmcnt(5)
    v_mfma_f32_32x32x16_bf16 v[80:95], a[208:211], v[48:51], v[80:95]
    ds_read_b128 v[40:43], v26 offset:57344
    s_waitcnt lgkmcnt(5)
    v_mfma_f32_32x32x16_bf16 v[80:95], a[212:215], v[52:55], v[80:95]
    ds_read_b128 v[44:47], v27 offset:57344
    s_waitcnt lgkmcnt(5)
    v_mfma_f32_32x32x16_bf16 v[80:95], a[216:219], v[56:59], v[80:95]
    ds_read_b128 v[48:51], v28 offset:57344
    s_waitcnt lgkmcnt(5)
    v_mfma_f32_32x32x16_bf16 v[80:95], a[220:223], v[60:63], v[80:95]
    ds_read_b128 v[52:55], v29 offset:57344
    s_waitcnt vmcnt(8)
    s_barrier
    s_waitcnt lgkmcnt(5)
    v_mfma_f32_32x32x16_bf16 v[80:95], a[224:227], v[32:35], v[80:95]
    ds_read_b128 v[56:59], v30 offset:57344
    s_waitcnt lgkmcnt(5)
    v_mfma_f32_32x32x16_bf16 v[80:95], a[228:231], v[36:39], v[80:95]
    ds_read_b128 v[60:63], v31 offset:57344
    s_add_u32 s23, s23, 131072
    s_add_u32 m0, s21, 65536
    s_xor_b32 s20, s23, 0
    buffer_load_dwordx4 v6, s[8:11], s20 offen lds
    s_waitcnt lgkmcnt(5)
    v_mfma_f32_32x32x16_bf16 v[80:95], a[232:235], v[40:43], v[80:95]
    ds_read_b128 v[32:35], v16 offset:0
    v_add_u32 v10, 1, v10
    buffer_store_dword v10, v9, s[84:87], 0 offen sc1
    s_waitcnt lgkmcnt(5)
    v_mfma_f32_32x32x16_bf16 v[80:95], a[236:239], v[44:47], v[80:95]
    ds_read_b128 v[36:39], v17 offset:0
    s_waitcnt lgkmcnt(5)
    v_mfma_f32_32x32x16_bf16 v[80:95], a[240:243], v[48:51], v[80:95]
    ds_read_b128 v[40:43], v18 offset:0
    s_add_u32 m0, s21, 66560
    s_xor_b32 s20, s23, 0
    buffer_load_dwordx4 v7, s[8:11], s20 offen lds
    s_waitcnt lgkmcnt(5)
    v_mfma_f32_32x32x16_bf16 v[80:95], a[244:247], v[52:55], v[80:95]
    ds_read_b128 v[44:47], v19 offset:0
    s_waitcnt lgkmcnt(5)
    v_mfma_f32_32x32x16_bf16 v[80:95], a[248:251], v[56:59], v[80:95]
    ds_read_b128 v[48:51], v20 offset:0
    s_waitcnt lgkmcnt(5)
    v_mfma_f32_32x32x16_bf16 v[80:95], a[252:255], v[60:63], v[80:95]
    ds_read_b128 v[52:55], v21 offset:0
    s_add_u32 m0, s21, 73728
    s_xor_b32 s20, s23, 256
    buffer_load_dwordx4 v6, s[8:11], s20 offen lds
    s_add_u32 s25, s25, 1
    s_cmp_lt_u32 s25, 16
    s_cbranch_scc1 mega_kernel_q_qk_loop
    s_nop 11
    v_cvt_pk_bf16_f32 v96, v80, v81
    v_cvt_pk_bf16_f32 v97, v82, v83
    v_cvt_pk_bf16_f32 v98, v84, v85
    v_cvt_pk_bf16_f32 v99, v86, v87
    buffer_store_dwordx4 v[96:99], v8, s[84:87], s24 offen offset:0 sc1
    v_cvt_pk_bf16_f32 v100, v88, v89
    v_cvt_pk_bf16_f32 v101, v90, v91
    v_cvt_pk_bf16_f32 v102, v92, v93
    v_cvt_pk_bf16_f32 v103, v94, v95
    buffer_store_dwordx4 v[100:103], v8, s[84:87], s24 offen offset:512 sc1
    s_add_u32 s24, s24, 524288
    s_waitcnt vmcnt(0) lgkmcnt(0)
    s_barrier
    v_add_u32 v10, 1, v10
    buffer_store_dword v10, v9, s[84:87], 0 offen sc1
    s_branch mega_kernel_q_done
mega_kernel_q_v:
    ds_read_b128 v[32:35], v16 offset:0
    ds_read_b128 v[36:39], v17 offset:0
    ds_read_b128 v[40:43], v18 offset:0
    ds_read_b128 v[44:47], v19 offset:0
    ds_read_b128 v[48:51], v20 offset:0
    ds_read_b128 v[52:55], v21 offset:0
    s_mov_b32 s25, 0
mega_kernel_q_v_loop:
    s_waitcnt lgkmcnt(5)
    v_mfma_f32_32x32x16_bf16 v[64:79], v[32:35], a[0:3], 0
    ds_read_b128 v[56:59], v22 offset:0
    s_waitcnt lgkmcnt(5)
    v_mfma_f32_32x32x16_bf16 v[64:79], v[36:39], a[4:7], v[64:79]
    ds_read_b128 v[60:63], v23 offset:0
    s_waitcnt lgkmcnt(5)
    v_mfma_f32_32x32x16_bf16 v[64:79], v[40:43], a[8:11], v[64:79]
    ds_read_b128 v[32:35], v16 offset:8192
    s_cmp_eq_u32 s25, 0
    s_cbranch_scc1 mega_kernel_q_v_sk2
    s_add_u32 m0, s21, 74752
    s_xor_b32 s20, s23, 256
    buffer_load_dwordx4 v7, s[8:11], s20 offen lds
mega_kernel_q_v_sk2:
    s_waitcnt lgkmcnt(5)
    v_mfma_f32_32x32x16_bf16 v[64:79], v[44:47], a[12:15], v[64:79]
    ds_read_b128 v[36:39], v17 offset:8192
    s_waitcnt lgkmcnt(5)
    v_mfma_f32_32x32x16_bf16 v[64:79], v[48:51], a[16:19], v[64:79]
    ds_read_b128 v[40:43], v18 offset:8192
    s_waitcnt lgkmcnt(5)
    v_mfma_f32_32x32x16_bf16 v[64:79], v[52:55], a[20:23], v[64:79]
    ds_read_b128 v[44:47], v19 offset:8192
    s_cmp_eq_u32 s25, 0
    s_cbranch_scc1 mega_kernel_q_v_sk5
    s_add_u32 m0, s21, 81920
    s_xor_b32 s20, s23, 512
    buffer_load_dwordx4 v6, s[8:11], s20 offen lds
mega_kernel_q_v_sk5:
    s_waitcnt lgkmcnt(5)
    v_mfma_f32_32x32x16_bf16 v[64:79], v[56:59], a[24:27], v[64:79]
    ds_read_b128 v[48:51], v20 offset:8192
    s_waitcnt lgkmcnt(5)
    v_mfma_f32_32x32x16_bf16 v[64:79], v[60:63], a[28:31], v[64:79]
    ds_read_b128 v[52:55], v21 offset:8192
    s_waitcnt lgkmcnt(5)
    v_mfma_f32_32x32x16_bf16 v[64:79], v[32:35], a[32:35], v[64:79]
    ds_read_b128 v[56:59], v22 offset:8192
    s_cmp_eq_u32 s25, 0
    s_cbranch_scc1 mega_kernel_q_v_sk8
    s_add_u32 m0, s21, 82944
    s_xor_b32 s20, s23, 512
    buffer_load_dwordx4 v7, s[8:11], s20 offen lds
mega_kernel_q_v_sk8:
    s_waitcnt lgkmcnt(5)
    v_mfma_f32_32x32x16_bf16 v[64:79], v[36:39], a[36:39], v[64:79]
    ds_read_b128 v[60:63], v23 offset:8192
    s_waitcnt lgkmcnt(5)
    v_mfma_f32_32x32x16_bf16 v[64:79], v[40:43], a[40:43], v[64:79]
    ds_read_b128 v[32:35], v16 offset:16384
    s_waitcnt lgkmcnt(5)
    v_mfma_f32_32x32x16_bf16 v[64:79], v[44:47], a[44:47], v[64:79]
    ds_read_b128 v[36:39], v17 offset:16384
    s_cmp_eq_u32 s25, 0
    s_cbranch_scc1 mega_kernel_q_v_sk11
    s_add_u32 m0, s21, 90112
    s_xor_b32 s20, s23, 768
    buffer_load_dwordx4 v6, s[8:11], s20 offen lds
mega_kernel_q_v_sk11:
    s_waitcnt lgkmcnt(5)
    v_mfma_f32_32x32x16_bf16 v[64:79], v[48:51], a[48:51], v[64:79]
    ds_read_b128 v[40:43], v18 offset:16384
    s_waitcnt lgkmcnt(5)
    v_mfma_f32_32x32x16_bf16 v[64:79], v[52:55], a[52:55], v[64:79]
    ds_read_b128 v[44:47], v19 offset:16384
    s_waitcnt lgkmcnt(5)
    v_mfma_f32_32x32x16_bf16 v[64:79], v[56:59], a[56:59], v[64:79]
    ds_read_b128 v[48:51], v20 offset:16384
    s_cmp_eq_u32 s25, 0
    s_cbranch_scc1 mega_kernel_q_v_sk14
    s_add_u32 m0, s21, 91136
    s_xor_b32 s20, s23, 768
    buffer_load_dwordx4 v7, s[8:11], s20 offen lds
mega_kernel_q_v_sk14:
    s_waitcnt lgkmcnt(5)
    v_mfma_f32_32x32x16_bf16 v[64:79], v[60:63], a[60:63], v[64:79]
    ds_read_b128 v[52:55], v21 offset:16384
    s_waitcnt lgkmcnt(5)
    v_mfma_f32_32x32x16_bf16 v[64:79], v[32:35], a[64:67], v[64:79]
    ds_read_b128 v[56:59], v22 offset:16384
    s_cmp_eq_u32 s25, 0
    s_cbranch_scc1 mega_kernel_q_v_ne0
    v_cvt_pk_bf16_f32 v96, v80, v81
    v_cvt_pk_bf16_f32 v97, v82, v83
    v_cvt_pk_bf16_f32 v98, v88, v89
    v_cvt_pk_bf16_f32 v99, v90, v91
    buffer_store_dwordx4 v[96:99], v8, s[84:87], s24 offen offset:0 sc1
mega_kernel_q_v_ne0:
    s_waitcnt lgkmcnt(5)
    v_mfma_f32_32x32x16_bf16 v[64:79], v[36:39], a[68:71], v[64:79]
    ds_read_b128 v[60:63], v23 offset:16384
    s_waitcnt lgkmcnt(5)
    v_mfma_f32_32x32x16_bf16 v[64:79], v[40:43], a[72:75], v[64:79]
    ds_read_b128 v[32:35], v16 offset:24576
    s_cmp_eq_u32 s25, 0
    s_cbranch_scc1 mega_kernel_q_v_ne1
    v_cvt_pk_bf16_f32 v100, v84, v85
    v_cvt_pk_bf16_f32 v101, v86, v87
    v_cvt_pk_bf16_f32 v102, v92, v93
    v_cvt_pk_bf16_f32 v103, v94, v95
    buffer_store_dwordx4 v[100:103], v8, s[84:87], s24 offen offset:512 sc1
    s_add_u32 s24, s24, 524288
mega_kernel_q_v_ne1:
    s_waitcnt lgkmcnt(5)
    v_mfma_f32_32x32x16_bf16 v[64:79], v[44:47], a[76:79], v[64:79]
    ds_read_b128 v[36:39], v17 offset:24576
    s_waitcnt lgkmcnt(5)
    v_mfma_f32_32x32x16_bf16 v[64:79], v[48:51], a[80:83], v[64:79]
    ds_read_b128 v[40:43], v18 offset:24576
    s_waitcnt lgkmcnt(5)
    v_mfma_f32_32x32x16_bf16 v[64:79], v[52:55], a[84:87], v[64:79]
    ds_read_b128 v[44:47], v19 offset:24576
    s_waitcnt lgkmcnt(5)
    v_mfma_f32_32x32x16_bf16 v[64:79], v[56:59], a[88:91], v[64:79]
    ds_read_b128 v[48:51], v20 offset:24576
    s_waitcnt lgkmcnt(5)
    v_mfma_f32_32x32x16_bf16 v[64:79], v[60:63], a[92:95], v[64:79]
    ds_read_b128 v[52:55], v21 offset:24576
    s_waitcnt vmcnt(8)
    s_barrier
    s_waitcnt lgkmcnt(5)
    v_mfma_f32_32x32x16_bf16 v[64:79], v[32:35], a[96:99], v[64:79]
    ds_read_b128 v[56:59], v22 offset:24576
    s_waitcnt lgkmcnt(5)
    v_mfma_f32_32x32x16_bf16 v[64:79], v[36:39], a[100:103], v[64:79]
    ds_read_b128 v[60:63], v23 offset:24576
    s_add_u32 m0, s21, 98304
    s_xor_b32 s20, s23, 1024
    buffer_load_dwordx4 v6, s[8:11], s20 offen lds
    s_waitcnt lgkmcnt(5)
    v_mfma_f32_32x32x16_bf16 v[64:79], v[40:43], a[104:107], v[64:79]
    ds_read_b128 v[32:35], v16 offset:32768
    s_waitcnt lgkmcnt(5)
    v_mfma_f32_32x32x16_bf16 v[64:79], v[44:47], a[108:111], v[64:79]
    ds_read_b128 v[36:39], v17 offset:32768
    s_waitcnt lgkmcnt(5)
    v_mfma_f32_32x32x16_bf16 v[64:79], v[48:51], a[112:115], v[64:79]
    ds_read_b128 v[40:43], v18 offset:32768
    s_add_u32 m0, s21, 99328
    s_xor_b32 s20, s23, 1024
    buffer_load_dwordx4 v7, s[8:11], s20 offen lds
    s_waitcnt lgkmcnt(5)
    v_mfma_f32_32x32x16_bf16 v[64:79], v[52:55], a[116:119], v[64:79]
    ds_read_b128 v[44:47], v19 offset:32768
    s_waitcnt lgkmcnt(5)
    v_mfma_f32_32x32x16_bf16 v[64:79], v[56:59], a[120:123], v[64:79]
    ds_read_b128 v[48:51], v20 offset:32768
    s_waitcnt lgkmcnt(5)
    v_mfma_f32_32x32x16_bf16 v[64:79], v[60:63], a[124:127], v[64:79]
    ds_read_b128 v[52:55], v21 offset:32768
    s_add_u32 m0, s21, 106496
    s_xor_b32 s20, s23, 1280
    buffer_load_dwordx4 v6, s[8:11], s20 offen lds
    s_waitcnt lgkmcnt(5)
    v_mfma_f32_32x32x16_bf16 v[64:79], v[32:35], a[128:131], v[64:79]
    ds_read_b128 v[56:59], v22 offset:32768
    s_waitcnt lgkmcnt(5)
    v_mfma_f32_32x32x16_bf16 v[64:79], v[36:39], a[132:135], v[64:79]
    ds_read_b128 v[60:63], v23 offset:32768
    s_waitcnt lgkmcnt(5)
    v_mfma_f32_32x32x16_bf16 v[64:79], v[40:43], a[136:139], v[64:79]
    ds_read_b128 v[32:35], v16 offset:40960
    s_add_u32 m0, s21, 107520
    s_xor_b32 s20, s23, 1280
    buffer_load_dwordx4 v7, s[8:11], s20 offen lds
    s_waitcnt lgkmcnt(5)
    v_mfma_f32_32x32x16_bf16 v[64:79], v[44:47], a[140:143], v[64:79]
    ds_read_b128 v[36:39], v17 offset:40960
    s_waitcnt lgkmcnt(5)
    v_mfma_f32_32x32x16_bf16 v[64:79], v[48:51], a[144:147], v[64:79]
    ds_read_b128 v[40:43], v18 offset:40960
    s_waitcnt lgkmcnt(5)
    v_mfma_f32_32x32x16_bf16 v[64:79], v[52:55], a[148:151], v[64:79]
    ds_read_b128 v[44:47], v19 offset:40960
    s_add_u32 m0, s21, 114688
    s_xor_b32 s20, s23, 1536
    buffer_load_dwordx4 v6, s[8:11], s20 offen lds
    s_waitcnt lgkmcnt(5)
    v_mfma_f32_32x32x16_bf16 v[64:79], v[56:59], a[152:155], v[64:79]
    ds_read_b128 v[48:51], v20 offset:40960
    s_waitcnt lgkmcnt(5)
    v_mfma_f32_32x32x16_bf16 v[64:79], v[60:63], a[156:159], v[64:79]
    ds_read_b128 v[52:55], v21 offset:40960
    s_waitcnt lgkmcnt(5)
    v_mfma_f32_32x32x16_bf16 v[64:79], v[32:35], a[160:163], v[64:79]
    ds_read_b128 v[56:59], v22 offset:40960
    s_add_u32 m0, s21, 115712
    s_xor_b32 s20, s23, 1536
    buffer_load_dwordx4 v7, s[8:11], s20 offen lds
    s_waitcnt lgkmcnt(5)
    v_mfma_f32_32x32x16_bf16 v[64:79], v[36:39], a[164:167], v[64:79]
    ds_read_b128 v[60:63], v23 offset:40960
    s_waitcnt lgkmcnt(5)
    v_mfma_f32_32x32x16_bf16 v[64:79], v[40:43], a[168:171], v[64:79]
    ds_read_b128 v[32:35], v16 offset:49152
    s_waitcnt lgkmcnt(5)
    v_mfma_f32_32x32x16_bf16 v[64:79], v[44:47], a[172:175], v[64:79]
    ds_read_b128 v[36:39], v17 offset:49152
    s_add_u32 m0, s21, 122880
    s_xor_b32 s20, s23, 1792
    buffer_load_dwordx4 v6, s[8:11], s20 offen lds
    s_waitcnt lgkmcnt(5)
    v_mfma_f32_32x32x16_bf16 v[64:79], v[48:51], a[176:179], v[64:79]
    ds_read_b128 v[40:43], v18 offset:49152
    s_waitcnt lgkmcnt(5)
    v_mfma_f32_32x32x16_bf16 v[64:79], v[52:55], a[180:183], v[64:79]
    ds_read_b128 v[44:47], v19 offset:49152
    s_waitcnt lgkmcnt(5)
    v_mfma_f32_32x32x16_bf16 v[64:79], v[56:59], a[184:187], v[64:79]
    ds_read_b128 v[48:51], v20 offset:49152
    s_add_u32 m0, s21, 123904
    s_xor_b32 s20, s23, 1792
    buffer_load_dwordx4 v7, s[8:11], s20 offen lds
    s_waitcnt lgkmcnt(5)
    v_mfma_f32_32x32x16_bf16 v[64:79], v[60:63], a[188:191], v[64:79]
    ds_read_b128 v[52:55], v21 offset:49152
    s_waitcnt lgkmcnt(5)
    v_mfma_f32_32x32x16_bf16 v[64:79], v[32:35], a[192:195], v[64:79]
    ds_read_b128 v[56:59], v22 offset:49152
    s_waitcnt lgkmcnt(5)
    v_mfma_f32_32x32x16_bf16 v[64:79], v[36:39], a[196:199], v[64:79]
    ds_read_b128 v[60:63], v23 offset:49152
    s_waitcnt lgkmcnt(5)
    v_mfma_f32_32x32x16_bf16 v[64:79], v[40:43], a[200:203], v[64:79]
    ds_read_b128 v[32:35], v16 offset:57344
    s_waitcnt lgkmcnt(5)
    v_mfma_f32_32x32x16_bf16 v[64:79], v[44:47], a[204:207], v[64:79]
    ds_read_b128 v[36:39], v17 offset:57344
    s_waitcnt lgkmcnt(5)
    v_mfma_f32_32x32x16_bf16 v[64:79], v[48:51], a[208:211], v[64:79]
    ds_read_b128 v[40:43], v18 offset:57344
    s_waitcnt lgkmcnt(5)
    v_mfma_f32_32x32x16_bf16 v[64:79], v[52:55], a[212:215], v[64:79]
    ds_read_b128 v[44:47], v19 offset:57344
    s_waitcnt lgkmcnt(5)
    v_mfma_f32_32x32x16_bf16 v[64:79], v[56:59], a[216:219], v[64:79]
    ds_read_b128 v[48:51], v20 offset:57344
    s_waitcnt lgkmcnt(5)
    v_mfma_f32_32x32x16_bf16 v[64:79], v[60:63], a[220:223], v[64:79]
    ds_read_b128 v[52:55], v21 offset:57344
    s_waitcnt vmcnt(8)
    s_barrier
    s_waitcnt lgkmcnt(5)
    v_mfma_f32_32x32x16_bf16 v[64:79], v[32:35], a[224:227], v[64:79]
    ds_read_b128 v[56:59], v22 offset:57344
    s_waitcnt lgkmcnt(5)
    v_mfma_f32_32x32x16_bf16 v[64:79], v[36:39], a[228:231], v[64:79]
    ds_read_b128 v[60:63], v23 offset:57344
    s_add_u32 s23, s23, 131072
    s_add_u32 m0, s21, 0
    s_xor_b32 s20, s23, 0
    buffer_load_dwordx4 v6, s[8:11], s20 offen lds
    s_waitcnt lgkmcnt(5)
    v_mfma_f32_32x32x16_bf16 v[64:79], v[40:43], a[232:235], v[64:79]
    ds_read_b128 v[32:35], v24 offset:0
    s_cmp_eq_u32 s25, 0
    s_cbranch_scc1 mega_kernel_q_v_nf
    v_add_u32 v10, 1, v10
    buffer_store_dword v10, v9, s[84:87], 0 offen sc1
mega_kernel_q_v_nf:
    s_waitcnt lgkmcnt(5)
    v_mfma_f32_32x32x16_bf16 v[64:79], v[44:47], a[236:239], v[64:79]
    ds_read_b128 v[36:39], v25 offset:0
    s_waitcnt lgkmcnt(5)
    v_mfma_f32_32x32x16_bf16 v[64:79], v[48:51], a[240:243], v[64:79]
    ds_read_b128 v[40:43], v26 offset:0
    s_add_u32 m0, s21, 1024
    s_xor_b32 s20, s23, 0
    buffer_load_dwordx4 v7, s[8:11], s20 offen lds
    s_waitcnt lgkmcnt(5)
    v_mfma_f32_32x32x16_bf16 v[64:79], v[52:55], a[244:247], v[64:79]
    ds_read_b128 v[44:47], v27 offset:0
    s_waitcnt lgkmcnt(5)
    v_mfma_f32_32x32x16_bf16 v[64:79], v[56:59], a[248:251], v[64:79]
    ds_read_b128 v[48:51], v28 offset:0
    s_waitcnt lgkmcnt(5)
    v_mfma_f32_32x32x16_bf16 v[64:79], v[60:63], a[252:255], v[64:79]
    ds_read_b128 v[52:55], v29 offset:0
    s_add_u32 m0, s21, 8192
    s_xor_b32 s20, s23, 256
    buffer_load_dwordx4 v6, s[8:11], s20 offen lds
    s_waitcnt lgkmcnt(5)
    v_mfma_f32_32x32x16_bf16 v[80:95], v[32:35], a[0:3], 0
    ds_read_b128 v[56:59], v30 offset:0
    s_waitcnt lgkmcnt(5)
    v_mfma_f32_32x32x16_bf16 v[80:95], v[36:39], a[4:7], v[80:95]
    ds_read_b128 v[60:63], v31 offset:0
    s_waitcnt lgkmcnt(5)
    v_mfma_f32_32x32x16_bf16 v[80:95], v[40:43], a[8:11], v[80:95]
    ds_read_b128 v[32:35], v24 offset:8192
    s_add_u32 m0, s21, 9216
    s_xor_b32 s20, s23, 256
    buffer_load_dwordx4 v7, s[8:11], s20 offen lds
    s_waitcnt lgkmcnt(5)
    v_mfma_f32_32x32x16_bf16 v[80:95], v[44:47], a[12:15], v[80:95]
    ds_read_b128 v[36:39], v25 offset:8192
    s_waitcnt lgkmcnt(5)
    v_mfma_f32_32x32x16_bf16 v[80:95], v[48:51], a[16:19], v[80:95]
    ds_read_b128 v[40:43], v26 offset:8192
    s_waitcnt lgkmcnt(5)
    v_mfma_f32_32x32x16_bf16 v[80:95], v[52:55], a[20:23], v[80:95]
    ds_read_b128 v[44:47], v27 offset:8192
    s_add_u32 m0, s21, 16384
    s_xor_b32 s20, s23, 512
    buffer_load_dwordx4 v6, s[8:11], s20 offen lds
    s_waitcnt lgkmcnt(5)
    v_mfma_f32_32x32x16_bf16 v[80:95], v[56:59], a[24:27], v[80:95]
    ds_read_b128 v[48:51], v28 offset:8192
    s_waitcnt lgkmcnt(5)
    v_mfma_f32_32x32x16_bf16 v[80:95], v[60:63], a[28:31], v[80:95]
    ds_read_b128 v[52:55], v29 offset:8192
    s_waitcnt lgkmcnt(5)
    v_mfma_f32_32x32x16_bf16 v[80:95], v[32:35], a[32:35], v[80:95]
    ds_read_b128 v[56:59], v30 offset:8192
    s_add_u32 m0, s21, 17408
    s_xor_b32 s20, s23, 512
    buffer_load_dwordx4 v7, s[8:11], s20 offen lds
    s_waitcnt lgkmcnt(5)
    v_mfma_f32_32x32x16_bf16 v[80:95], v[36:39], a[36:39], v[80:95]
    ds_read_b128 v[60:63], v31 offset:8192
    s_waitcnt lgkmcnt(5)
    v_mfma_f32_32x32x16_bf16 v[80:95], v[40:43], a[40:43], v[80:95]
    ds_read_b128 v[32:35], v24 offset:16384
    s_waitcnt lgkmcnt(5)
    v_mfma_f32_32x32x16_bf16 v[80:95], v[44:47], a[44:47], v[80:95]
    ds_read_b128 v[36:39], v25 offset:16384
    s_add_u32 m0, s21, 24576
    s_xor_b32 s20, s23, 768
    buffer_load_dwordx4 v6, s[8:11], s20 offen lds
    s_waitcnt lgkmcnt(5)
    v_mfma_f32_32x32x16_bf16 v[80:95], v[48:51], a[48:51], v[80:95]
    ds_read_b128 v[40:43], v26 offset:16384
    s_waitcnt lgkmcnt(5)
    v_mfma_f32_32x32x16_bf16 v[80:95], v[52:55], a[52:55], v[80:95]
    ds_read_b128 v[44:47], v27 offset:16384
    s_waitcnt lgkmcnt(5)
    v_mfma_f32_32x32x16_bf16 v[80:95], v[56:59], a[56:59], v[80:95]
    ds_read_b128 v[48:51], v28 offset:16384
    s_add_u32 m0, s21, 25600
    s_xor_b32 s20, s23, 768
    buffer_load_dwordx4 v7, s[8:11], s20 offen lds
    s_waitcnt lgkmcnt(5)
    v_mfma_f32_32x32x16_bf16 v[80:95], v[60:63], a[60:63], v[80:95]
    ds_read_b128 v[52:55], v29 offset:16384
    s_waitcnt lgkmcnt(5)
    v_mfma_f32_32x32x16_bf16 v[80:95], v[32:35], a[64:67], v[80:95]
    ds_read_b128 v[56:59], v30 offset:16384
    v_cvt_pk_bf16_f32 v96, v64, v65
    v_cvt_pk_bf16_f32 v97, v66, v67
    v_cvt_pk_bf16_f32 v98, v72, v73
    v_cvt_pk_bf16_f32 v99, v74, v75
    buffer_store_dwordx4 v[96:99], v8, s[84:87], s24 offen offset:0 sc1
    s_waitcnt lgkmcnt(5)
    v_mfma_f32_32x32x16_bf16 v[80:95], v[36:39], a[68:71], v[80:95]
    ds_read_b128 v[60:63], v31 offset:16384
    s_waitcnt lgkmcnt(5)
    v_mfma_f32_32x32x16_bf16 v[80:95], v[40:43], a[72:75], v[80:95]
    ds_read_b128 v[32:35], v24 offset:24576
    v_cvt_pk_bf16_f32 v100, v68, v69
    v_cvt_pk_bf16_f32 v101, v70, v71
    v_cvt_pk_bf16_f32 v102, v76, v77
    v_cvt_pk_bf16_f32 v103, v78, v79
    buffer_store_dwordx4 v[100:103], v8, s[84:87], s24 offen offset:512 sc1
    s_add_u32 s24, s24, 524288
    s_waitcnt lgkmcnt(5)
    v_mfma_f32_32x32x16_bf16 v[80:95], v[44:47], a[76:79], v[80:95]
    ds_read_b128 v[36:39], v25 offset:24576
    s_waitcnt lgkmcnt(5)
    v_mfma_f32_32x32x16_bf16 v[80:95], v[48:51], a[80:83], v[80:95]
    ds_read_b128 v[40:43], v26 offset:24576
    s_waitcnt lgkmcnt(5)
    v_mfma_f32_32x32x16_bf16 v[80:95], v[52:55], a[84:87], v[80:95]
    ds_read_b128 v[44:47], v27 offset:24576
    s_waitcnt lgkmcnt(5)
    v_mfma_f32_32x32x16_bf16 v[80:95], v[56:59], a[88:91], v[80:95]
    ds_read_b128 v[48:51], v28 offset:24576
    s_waitcnt lgkmcnt(5)
    v_mfma_f32_32x32x16_bf16 v[80:95], v[60:63], a[92:95], v[80:95]
    ds_read_b128 v[52:55], v29 offset:24576
    s_waitcnt vmcnt(8)
    s_barrier
    s_waitcnt lgkmcnt(5)
    v_mfma_f32_32x32x16_bf16 v[80:95], v[32:35], a[96:99], v[80:95]
    ds_read_b128 v[56:59], v30 offset:24576
    s_waitcnt lgkmcnt(5)
    v_mfma_f32_32x32x16_bf16 v[80:95], v[36:39], a[100:103], v[80:95]
    ds_read_b128 v[60:63], v31 offset:24576
    s_add_u32 m0, s21, 32768
    s_xor_b32 s20, s23, 1024
    buffer_load_dwordx4 v6, s[8:11], s20 offen lds
    s_waitcnt lgkmcnt(5)
    v_mfma_f32_32x32x16_bf16 v[80:95], v[40:43], a[104:107], v[80:95]
    ds_read_b128 v[32:35], v24 offset:32768
    s_waitcnt lgkmcnt(5)
    v_mfma_f32_32x32x16_bf16 v[80:95], v[44:47], a[108:111], v[80:95]
    ds_read_b128 v[36:39], v25 offset:32768
    s_waitcnt lgkmcnt(5)
    v_mfma_f32_32x32x16_bf16 v[80:95], v[48:51], a[112:115], v[80:95]
    ds_read_b128 v[40:43], v26 offset:32768
    s_add_u32 m0, s21, 33792
    s_xor_b32 s20, s23, 1024
    buffer_load_dwordx4 v7, s[8:11], s20 offen lds
    s_waitcnt lgkmcnt(5)
    v_mfma_f32_32x32x16_bf16 v[80:95], v[52:55], a[116:119], v[80:95]
    ds_read_b128 v[44:47], v27 offset:32768
    s_waitcnt lgkmcnt(5)
    v_mfma_f32_32x32x16_bf16 v[80:95], v[56:59], a[120:123], v[80:95]
    ds_read_b128 v[48:51], v28 offset:32768
    s_waitcnt lgkmcnt(5)
    v_mfma_f32_32x32x16_bf16 v[80:95], v[60:63], a[124:127], v[80:95]
    ds_read_b128 v[52:55], v29 offset:32768
    s_add_u32 m0, s21, 40960
    s_xor_b32 s20, s23, 1280
    buffer_load_dwordx4 v6, s[8:11], s20 offen lds
    s_waitcnt lgkmcnt(5)
    v_mfma_f32_32x32x16_bf16 v[80:95], v[32:35], a[128:131], v[80:95]
    ds_read_b128 v[56:59], v30 offset:32768
    s_waitcnt lgkmcnt(5)
    v_mfma_f32_32x32x16_bf16 v[80:95], v[36:39], a[132:135], v[80:95]
    ds_read_b128 v[60:63], v31 offset:32768
    s_waitcnt lgkmcnt(5)
    v_mfma_f32_32x32x16_bf16 v[80:95], v[40:43], a[136:139], v[80:95]
    ds_read_b128 v[32:35], v24 offset:40960
    s_add_u32 m0, s21, 41984
    s_xor_b32 s20, s23, 1280
    buffer_load_dwordx4 v7, s[8:11], s20 offen lds
    s_waitcnt lgkmcnt(5)
    v_mfma_f32_32x32x16_bf16 v[80:95], v[44:47], a[140:143], v[80:95]
    ds_read_b128 v[36:39], v25 offset:40960
    s_waitcnt lgkmcnt(5)
    v_mfma_f32_32x32x16_bf16 v[80:95], v[48:51], a[144:147], v[80:95]
    ds_read_b128 v[40:43], v26 offset:40960
    s_waitcnt lgkmcnt(5)
    v_mfma_f32_32x32x16_bf16 v[80:95], v[52:55], a[148:151], v[80:95]
    ds_read_b128 v[44:47], v27 offset:40960
    s_add_u32 m0, s21, 49152
    s_xor_b32 s20, s23, 1536
    buffer_load_dwordx4 v6, s[8:11], s20 offen lds
    s_waitcnt lgkmcnt(5)
    v_mfma_f32_32x32x16_bf16 v[80:95], v[56:59], a[152:155], v[80:95]
    ds_read_b128 v[48:51], v28 offset:40960
    s_waitcnt lgkmcnt(5)
    v_mfma_f32_32x32x16_bf16 v[80:95], v[60:63], a[156:159], v[80:95]
    ds_read_b128 v[52:55], v29 offset:40960
    s_waitcnt lgkmcnt(5)
    v_mfma_f32_32x32x16_bf16 v[80:95], v[32:35], a[160:163], v[80:95]
    ds_read_b128 v[56:59], v30 offset:40960
    s_add_u32 m0, s21, 50176
    s_xor_b32 s20, s23, 1536
    buffer_load_dwordx4 v7, s[8:11], s20 offen lds
    s_waitcnt lgkmcnt(5)
    v_mfma_f32_32x32x16_bf16 v[80:95], v[36:39], a[164:167], v[80:95]
    ds_read_b128 v[60:63], v31 offset:40960
    s_waitcnt lgkmcnt(5)
    v_mfma_f32_32x32x16_bf16 v[80:95], v[40:43], a[168:171], v[80:95]
    ds_read_b128 v[32:35], v24 offset:49152
    s_waitcnt lgkmcnt(5)
    v_mfma_f32_32x32x16_bf16 v[80:95], v[44:47], a[172:175], v[80:95]
    ds_read_b128 v[36:39], v25 offset:49152
    s_add_u32 m0, s21, 57344
    s_xor_b32 s20, s23, 1792
    buffer_load_dwordx4 v6, s[8:11], s20 offen lds
    s_waitcnt lgkmcnt(5)
    v_mfma_f32_32x32x16_bf16 v[80:95], v[48:51], a[176:179], v[80:95]
    ds_read_b128 v[40:43], v26 offset:49152
    s_waitcnt lgkmcnt(5)
    v_mfma_f32_32x32x16_bf16 v[80:95], v[52:55], a[180:183], v[80:95]
    ds_read_b128 v[44:47], v27 offset:49152
    s_waitcnt lgkmcnt(5)
    v_mfma_f32_32x32x16_bf16 v[80:95], v[56:59], a[184:187], v[80:95]
    ds_read_b128 v[48:51], v28 offset:49152
    s_add_u32 m0, s21, 58368
    s_xor_b32 s20, s23, 1792
    buffer_load_dwordx4 v7, s[8:11], s20 offen lds
    s_waitcnt lgkmcnt(5)
    v_mfma_f32_32x32x16_bf16 v[80:95], v[60:63], a[188:191], v[80:95]
    ds_read_b128 v[52:55], v29 offset:49152
    s_waitcnt lgkmcnt(5)
    v_mfma_f32_32x32x16_bf16 v[80:95], v[32:35], a[192:195], v[80:95]
    ds_read_b128 v[56:59], v30 offset:49152
    s_waitcnt lgkmcnt(5)
    v_mfma_f32_32x32x16_bf16 v[80:95], v[36:39], a[196:199], v[80:95]
    ds_read_b128 v[60:63], v31 offset:49152
    s_waitcnt lgkmcnt(5)
    v_mfma_f32_32x32x16_bf16 v[80:95], v[40:43], a[200:203], v[80:95]
    ds_read_b128 v[32:35], v24 offset:57344
    s_waitcnt lgkmcnt(5)
    v_mfma_f32_32x32x16_bf16 v[80:95], v[44:47], a[204:207], v[80:95]
    ds_read_b128 v[36:39], v25 offset:57344
    s_waitcnt lgkmcnt(5)
    v_mfma_f32_32x32x16_bf16 v[80:95], v[48:51], a[208:211], v[80:95]
    ds_read_b128 v[40:43], v26 offset:57344
    s_waitcnt lgkmcnt(5)
    v_mfma_f32_32x32x16_bf16 v[80:95], v[52:55], a[212:215], v[80:95]
    ds_read_b128 v[44:47], v27 offset:57344
    s_waitcnt lgkmcnt(5)
    v_mfma_f32_32x32x16_bf16 v[80:95], v[56:59], a[216:219], v[80:95]
    ds_read_b128 v[48:51], v28 offset:57344
    s_waitcnt lgkmcnt(5)
    v_mfma_f32_32x32x16_bf16 v[80:95], v[60:63], a[220:223], v[80:95]
    ds_read_b128 v[52:55], v29 offset:57344
    s_waitcnt vmcnt(8)
    s_barrier
    s_waitcnt lgkmcnt(5)
    v_mfma_f32_32x32x16_bf16 v[80:95], v[32:35], a[224:227], v[80:95]
    ds_read_b128 v[56:59], v30 offset:57344
    s_waitcnt lgkmcnt(5)
    v_mfma_f32_32x32x16_bf16 v[80:95], v[36:39], a[228:231], v[80:95]
    ds_read_b128 v[60:63], v31 offset:57344
    s_add_u32 s23, s23, 131072
    s_add_u32 m0, s21, 65536
    s_xor_b32 s20, s23, 0
    buffer_load_dwordx4 v6, s[8:11], s20 offen lds
    s_waitcnt lgkmcnt(5)
    v_mfma_f32_32x32x16_bf16 v[80:95], v[40:43], a[232:235], v[80:95]
    ds_read_b128 v[32:35], v16 offset:0
    v_add_u32 v10, 1, v10
    buffer_store_dword v10, v9, s[84:87], 0 offen sc1
    s_waitcnt lgkmcnt(5)
    v_mfma_f32_32x32x16_bf16 v[80:95], v[44:47], a[236:239], v[80:95]
    ds_read_b128 v[36:39], v17 offset:0
    s_waitcnt lgkmcnt(5)
    v_mfma_f32_32x32x16_bf16 v[80:95], v[48:51], a[240:243], v[80:95]
    ds_read_b128 v[40:43], v18 offset:0
    s_add_u32 m0, s21, 66560
    s_xor_b32 s20, s23, 0
    buffer_load_dwordx4 v7, s[8:11], s20 offen lds
    s_waitcnt lgkmcnt(5)
    v_mfma_f32_32x32x16_bf16 v[80:95], v[52:55], a[244:247], v[80:95]
    ds_read_b128 v[44:47], v19 offset:0
    s_waitcnt lgkmcnt(5)
    v_mfma_f32_32x32x16_bf16 v[80:95], v[56:59], a[248:251], v[80:95]
    ds_read_b128 v[48:51], v20 offset:0
    s_waitcnt lgkmcnt(5)
    v_mfma_f32_32x32x16_bf16 v[80:95], v[60:63], a[252:255], v[80:95]
    ds_read_b128 v[52:55], v21 offset:0
    s_add_u32 m0, s21, 73728
    s_xor_b32 s20, s23, 256
    buffer_load_dwordx4 v6, s[8:11], s20 offen lds
    s_add_u32 s25, s25, 1
    s_cmp_lt_u32 s25, 16
    s_cbranch_scc1 mega_kernel_q_v_loop
    s_nop 11
    v_cvt_pk_bf16_f32 v96, v80, v81
    v_cvt_pk_bf16_f32 v97, v82, v83
    v_cvt_pk_bf16_f32 v98, v88, v89
    v_cvt_pk_bf16_f32 v99, v90, v91
    buffer_store_dwordx4 v[96:99], v8, s[84:87], s24 offen offset:0 sc1
    v_cvt_pk_bf16_f32 v100, v84, v85
    v_cvt_pk_bf16_f32 v101, v86, v87
    v_cvt_pk_bf16_f32 v102, v92, v93
    v_cvt_pk_bf16_f32 v103, v94, v95
    buffer_store_dwordx4 v[100:103], v8, s[84:87], s24 offen offset:512 sc1
    s_add_u32 s24, s24, 524288
    s_waitcnt vmcnt(0) lgkmcnt(0)
    s_barrier
    v_add_u32 v10, 1, v10
    buffer_store_dword v10, v9, s[84:87], 0 offen sc1
mega_kernel_q_done:
    s_load_dwordx2 s[52:53], s[0:1], 40
    v_and_b32 v202, 63, v0
    s_and_b32 s58, s92, 31
    v_lshrrev_b32 v200, 2, v202
    v_lshlrev_b32 v200, 11, v200
    v_and_b32 v203, 3, v202
    v_lshl_add_u32 v200, v203, 4, v200
    s_lshl_b32 s56, s98, 21
    s_lshl_b32 s57, s58, 6
    s_add_u32 s56, s56, s57
    v_add_u32 v200, s56, v200
    s_lshl_b32 s56, s98, 14
    s_add_u32 s56, s56, 81920
    s_lshr_b32 s57, s58, 1
    s_lshl_b32 s57, s57, 12
    v_lshrrev_b32 v201, 5, v202
    v_bfe_u32 v204, v202, 2, 2
    v_lshl_add_u32 v201, v201, 3, v204
    v_lshlrev_b32 v201, 6, v201
    v_bfe_u32 v204, v202, 4, 1
    v_lshl_add_u32 v201, v204, 5, v201
    v_lshl_add_u32 v201, v203, 3, v201
    v_add_u32 v201, s56, v201
    s_waitcnt lgkmcnt(0)
    s_mov_b32 s54, 8388608
    s_mov_b32 s55, 0x00020000
    s_cmp_lt_u32 s92, 128
    s_cbranch_scc1 mega_kernel_f1
    s_add_u32 m0, s56, 0
    s_add_u32 s58, s57, 0
    s_and_b32 s58, s58, 0xffff
    s_lshl_b32 s58, s58, 5
    buffer_load_dwordx4 v200, s[52:55], s58 offen lds
    s_add_u32 m0, s56, 1024
    s_add_u32 s58, s57, 1024
    s_and_b32 s58, s58, 0xffff
    s_lshl_b32 s58, s58, 5
    buffer_load_dwordx4 v200, s[52:55], s58 offen lds
    s_add_u32 m0, s56, 2048
    s_add_u32 s58, s57, 2048
    s_and_b32 s58, s58, 0xffff
    s_lshl_b32 s58, s58, 5
    buffer_load_dwordx4 v200, s[52:55], s58 offen lds
    s_add_u32 m0, s56, 3072
    s_add_u32 s58, s57, 3072
    s_and_b32 s58, s58, 0xffff
    s_lshl_b32 s58, s58, 5
    buffer_load_dwordx4 v200, s[52:55], s58 offen lds
    s_add_u32 m0, s56, 4096
    s_add_u32 s58, s57, 4096
    s_and_b32 s58, s58, 0xffff
    s_lshl_b32 s58, s58, 5
    buffer_load_dwordx4 v200, s[52:55], s58 offen lds
    s_add_u32 m0, s56, 5120
    s_add_u32 s58, s57, 5120
    s_and_b32 s58, s58, 0xffff
    s_lshl_b32 s58, s58, 5
    buffer_load_dwordx4 v200, s[52:55], s58 offen lds
    s_add_u32 m0, s56, 6144
    s_add_u32 s58, s57, 6144
    s_and_b32 s58, s58, 0xffff
    s_lshl_b32 s58, s58, 5
    buffer_load_dwordx4 v200, s[52:55], s58 offen lds
    s_add_u32 m0, s56, 7168
    s_add_u32 s58, s57, 7168
    s_and_b32 s58, s58, 0xffff
    s_lshl_b32 s58, s58, 5
    buffer_load_dwordx4 v200, s[52:55], s58 offen lds
    s_add_u32 m0, s56, 8192
    s_add_u32 s58, s57, 8192
    s_and_b32 s58, s58, 0xffff
    s_lshl_b32 s58, s58, 5
    buffer_load_dwordx4 v200, s[52:55], s58 offen lds
    s_add_u32 m0, s56, 9216
    s_add_u32 s58, s57, 9216
    s_and_b32 s58, s58, 0xffff
    s_lshl_b32 s58, s58, 5
    buffer_load_dwordx4 v200, s[52:55], s58 offen lds
    s_add_u32 m0, s56, 10240
    s_add_u32 s58, s57, 10240
    s_and_b32 s58, s58, 0xffff
    s_lshl_b32 s58, s58, 5
    buffer_load_dwordx4 v200, s[52:55], s58 offen lds
    s_add_u32 m0, s56, 11264
    s_add_u32 s58, s57, 11264
    s_and_b32 s58, s58, 0xffff
    s_lshl_b32 s58, s58, 5
    buffer_load_dwordx4 v200, s[52:55], s58 offen lds
    s_add_u32 m0, s56, 12288
    s_add_u32 s58, s57, 12288
    s_and_b32 s58, s58, 0xffff
    s_lshl_b32 s58, s58, 5
    buffer_load_dwordx4 v200, s[52:55], s58 offen lds
    s_add_u32 m0, s56, 13312
    s_add_u32 s58, s57, 13312
    s_and_b32 s58, s58, 0xffff
    s_lshl_b32 s58, s58, 5
    buffer_load_dwordx4 v200, s[52:55], s58 offen lds
    s_add_u32 m0, s56, 14336
    s_add_u32 s58, s57, 14336
    s_and_b32 s58, s58, 0xffff
    s_lshl_b32 s58, s58, 5
    buffer_load_dwordx4 v200, s[52:55], s58 offen lds
    s_add_u32 m0, s56, 15360
    s_add_u32 s58, s57, 15360
    s_and_b32 s58, s58, 0xffff
    s_lshl_b32 s58, s58, 5
    buffer_load_dwordx4 v200, s[52:55], s58 offen lds
    s_sub_u32 s99, s92, 128
mega_kernel_f0l:
    s_barrier
    s_load_dwordx2 s[4:5], s[0:1], 64
    s_load_dwordx2 s[8:9], s[0:1], 72
    s_load_dwordx2 s[12:13], s[0:1], 96
    s_and_b32 s16, s99, 31
    s_lshr_b32 s17, s99, 5
    v_and_b32 v1, 63, v0
    v_lshrrev_b32 v2, 6, v0
    s_waitcnt lgkmcnt(0)
    s_mov_b32 s6, 2101248
    s_mov_b32 s7, 0x00020000
    s_mov_b32 s10, 2101248
    s_mov_b32 s11, 0x00020000
    s_add_u32 s12, s12, 121634816
    s_addc_u32 s13, s13, 0
    s_mov_b32 s14, 4202496
    s_mov_b32 s15, 0x00020000
    s_lshl_b32 s18, s16, 6
    v_add_u32 v3, s18, v2
    s_movk_i32 s19, 1026
    v_mul_lo_u32 v3, v3, s19
    s_lshl_b32 s18, s17, 7
    v_add_u32 v3, s18, v3
    v_lshl_add_u32 v3, v1, 1, v3
    s_mov_b32 s18, 0
    buffer_load_ushort v16, v3, s[4:7], s18 offen
    buffer_load_ushort v32, v3, s[8:11], s18 offen
    s_mov_b32 s18, 4104
    buffer_load_ushort v17, v3, s[4:7], s18 offen
    buffer_load_ushort v33, v3, s[8:11], s18 offen
    s_mov_b32 s18, 8208
    buffer_load_ushort v18, v3, s[4:7], s18 offen
    buffer_load_ushort v34, v3, s[8:11], s18 offen
    s_mov_b32 s18, 12312
    buffer_load_ushort v19, v3, s[4:7], s18 offen
    buffer_load_ushort v35, v3, s[8:11], s18 offen
    s_mov_b32 s18, 16416
    buffer_load_ushort v20, v3, s[4:7], s18 offen
    buffer_load_ushort v36, v3, s[8:11], s18 offen
    s_mov_b32 s18, 20520
    buffer_load_ushort v21, v3, s[4:7], s18 offen
    buffer_load_ushort v37, v3, s[8:11], s18 offen
    s_mov_b32 s18, 24624
    buffer_load_ushort v22, v3, s[4:7], s18 offen
    buffer_load_ushort v38, v3, s[8:11], s18 offen
    s_mov_b32 s18, 28728
    buffer_load_ushort v23, v3, s[4:7], s18 offen
    buffer_load_ushort v39, v3, s[8:11], s18 offen
    s_mov_b32 s18, 32832
    buffer_load_ushort v24, v3, s[4:7], s18 offen
    buffer_load_ushort v40, v3, s[8:11], s18 offen
    s_mov_b32 s18, 36936
    buffer_load_ushort v25, v3, s[4:7], s18 offen
    buffer_load_ushort v41, v3, s[8:11], s18 offen
    s_mov_b32 s18, 41040
    buffer_load_ushort v26, v3, s[4:7], s18 offen
    buffer_load_ushort v42, v3, s[8:11], s18 offen
    s_mov_b32 s18, 45144
    buffer_load_ushort v27, v3, s[4:7], s18 offen
    buffer_load_ushort v43, v3, s[8:11], s18 offen
    s_mov_b32 s18, 49248
    buffer_load_ushort v28, v3, s[4:7], s18 offen
    buffer_load_ushort v44, v3, s[8:11], s18 offen
    s_mov_b32 s18, 53352
    buffer_load_ushort v29, v3, s[4:7], s18 offen
    buffer_load_ushort v45, v3, s[8:11], s18 offen
    s_mov_b32 s18, 57456
    buffer_load_ushort v30, v3, s[4:7], s18 offen
    buffer_load_ushort v46, v3, s[8:11], s18 offen
    s_mov_b32 s18, 61560
    buffer_load_ushort v31, v3, s[4:7], s18 offen
    buffer_load_ushort v47, v3, s[8:11], s18 offen
    v_mul_u32_u24 v4, 65, v1
    v_add_u32 v4, v4, v2
    v_lshlrev_b32 v4, 2, v4
    s_waitcnt vmcnt(0)
    v_lshl_or_b32 v16, v32, 16, v16
    ds_write_b32 v4, v16 offset:0
    v_lshl_or_b32 v17, v33, 16, v17
    ds_write_b32 v4, v17 offset:16
    v_lshl_or_b32 v18, v34, 16, v18
    ds_write_b32 v4, v18 offset:32
    v_lshl_or_b32 v19, v35, 16, v19
    ds_write_b32 v4, v19 offset:48
    v_lshl_or_b32 v20, v36, 16, v20
    ds_write_b32 v4, v20 offset:64
    v_lshl_or_b32 v21, v37, 16, v21
    ds_write_b32 v4, v21 offset:80
    v_lshl_or_b32 v22, v38, 16, v22
    ds_write_b32 v4, v22 offset:96
    v_lshl_or_b32 v23, v39, 16, v23
    ds_write_b32 v4, v23 offset:112
    v_lshl_or_b32 v24, v40, 16, v24
    ds_write_b32 v4, v24 offset:128
    v_lshl_or_b32 v25, v41, 16, v25
    ds_write_b32 v4, v25 offset:144
    v_lshl_or_b32 v26, v42, 16, v26
    ds_write_b32 v4, v26 offset:160
    v_lshl_or_b32 v27, v43, 16, v27
    ds_write_b32 v4, v27 offset:176
    v_lshl_or_b32 v28, v44, 16, v28
    ds_write_b32 v4, v28 offset:192
    v_lshl_or_b32 v29, v45, 16, v29
    ds_write_b32 v4, v29 offset:208
    v_lshl_or_b32 v30, v46, 16, v30
    ds_write_b32 v4, v30 offset:224
    v_lshl_or_b32 v31, v47, 16, v31
    ds_write_b32 v4, v31 offset:240
    v_lshrrev_b32 v7, 4, v0
    v_and_b32 v8, 15, v0
    v_mul_u32_u24 v5, 65, v7
    v_lshl_add_u32 v5, v8, 2, v5
    v_lshlrev_b32 v5, 2, v5
    s_waitcnt lgkmcnt(0)
    s_barrier
    ds_read_b32 v16, v5 offset:0
    ds_read_b32 v17, v5 offset:4
    ds_read_b32 v18, v5 offset:8
    ds_read_b32 v19, v5 offset:12
    ds_read_b32 v20, v5 offset:4160
    ds_read_b32 v21, v5 offset:4164
    ds_read_b32 v22, v5 offset:4168
    ds_read_b32 v23, v5 offset:4172
    ds_read_b32 v24, v5 offset:8320
    ds_read_b32 v25, v5 offset:8324
    ds_read_b32 v26, v5 offset:8328
    ds_read_b32 v27, v5 offset:8332
    ds_read_b32 v28, v5 offset:12480
    ds_read_b32 v29, v5 offset:12484
    ds_read_b32 v30, v5 offset:12488
    ds_read_b32 v31, v5 offset:12492
    s_lshl_b32 s18, s17, 6
    v_add_u32 v6, s18, v7
    v_lshlrev_b32 v6, 13, v6
    s_lshl_b32 s18, s16, 8
    v_add_u32 v6, s18, v6
    v_lshl_add_u32 v6, v8, 4, v6
    s_waitcnt lgkmcnt(0)
    s_mov_b32 s18, 0
    buffer_store_dwordx4 v[16:19], v6, s[12:15], s18 offen sc1
    s_mov_b32 s18, 131072
    buffer_store_dwordx4 v[20:23], v6, s[12:15], s18 offen sc1
    s_mov_b32 s18, 262144
    buffer_store_dwordx4 v[24:27], v6, s[12:15], s18 offen sc1
    s_mov_b32 s18, 393216
    buffer_store_dwordx4 v[28:31], v6, s[12:15], s18 offen sc1
    s_add_u32 s99, s99, 64
    s_cmp_lt_u32 s99, 288
    s_cbranch_scc1 mega_kernel_f0l
    s_waitcnt vmcnt(0)
    s_barrier
    s_cmp_lg_u32 s98, 0
    s_cbranch_scc1 mega_kernel_sg_5
    v_mov_b32 v2, 1
    s_mov_b32 s81, 71361024
    s_mov_b64 exec, 1
    buffer_atomic_add v2, off, s[84:87], s81 sc1
    s_mov_b64 exec, -1
mega_kernel_sg_5:
    s_cmp_lg_u32 s92, 191
    s_cbranch_scc1 mega_kernel_xo2
    s_cmp_lg_u32 s98, 0
    s_cbranch_scc1 mega_kernel_xo2
    s_waitcnt vmcnt(0)
    ds_read_b64_tr_b16 a[0:1], v201 offset:0
    ds_read_b64_tr_b16 a[2:3], v201 offset:256
    ds_read_b64_tr_b16 a[4:5], v201 offset:1024
    ds_read_b64_tr_b16 a[6:7], v201 offset:1280
    ds_read_b64_tr_b16 a[8:9], v201 offset:2048
    ds_read_b64_tr_b16 a[10:11], v201 offset:2304
    ds_read_b64_tr_b16 a[12:13], v201 offset:3072
    ds_read_b64_tr_b16 a[14:15], v201 offset:3328
    s_waitcnt lgkmcnt(0)
    ds_read_b64_tr_b16 a[16:17], v201 offset:4096
    ds_read_b64_tr_b16 a[18:19], v201 offset:4352
    ds_read_b64_tr_b16 a[20:21], v201 offset:5120
    ds_read_b64_tr_b16 a[22:23], v201 offset:5376
    ds_read_b64_tr_b16 a[24:25], v201 offset:6144
    ds_read_b64_tr_b16 a[26:27], v201 offset:6400
    ds_read_b64_tr_b16 a[28:29], v201 offset:7168
    ds_read_b64_tr_b16 a[30:31], v201 offset:7424
    s_waitcnt lgkmcnt(0)
    ds_read_b64_tr_b16 a[32:33], v201 offset:8192
    ds_read_b64_tr_b16 a[34:35], v201 offset:8448
    ds_read_b64_tr_b16 a[36:37], v201 offset:9216
    ds_read_b64_tr_b16 a[38:39], v201 offset:9472
    ds_read_b64_tr_b16 a[40:41], v201 offset:10240
    ds_read_b64_tr_b16 a[42:43], v201 offset:10496
    ds_read_b64_tr_b16 a[44:45], v201 offset:11264
    ds_read_b64_tr_b16 a[46:47], v201 offset:11520
    s_waitcnt lgkmcnt(0)
    ds_read_b64_tr_b16 a[48:49], v201 offset:12288
    ds_read_b64_tr_b16 a[50:51], v201 offset:12544
    ds_read_b64_tr_b16 a[52:53], v201 offset:13312
    ds_read_b64_tr_b16 a[54:55], v201 offset:13568
    ds_read_b64_tr_b16 a[56:57], v201 offset:14336
    ds_read_b64_tr_b16 a[58:59], v201 offset:14592
    ds_read_b64_tr_b16 a[60:61], v201 offset:15360
    ds_read_b64_tr_b16 a[62:63], v201 offset:15616
    s_waitcnt lgkmcnt(0)
    s_add_u32 m0, s56, 0
    s_add_u32 s58, s57, 16384
    s_and_b32 s58, s58, 0xffff
    s_lshl_b32 s58, s58, 5
    buffer_load_dwordx4 v200, s[52:55], s58 offen lds
    s_add_u32 m0, s56, 1024
    s_add_u32 s58, s57, 17408
    s_and_b32 s58, s58, 0xffff
    s_lshl_b32 s58, s58, 5
    buffer_load_dwordx4 v200, s[52:55], s58 offen lds
    s_add_u32 m0, s56, 2048
    s_add_u32 s58, s57, 18432
    s_and_b32 s58, s58, 0xffff
    s_lshl_b32 s58, s58, 5
    buffer_load_dwordx4 v200, s[52:55], s58 offen lds
    s_add_u32 m0, s56, 3072
    s_add_u32 s58, s57, 19456
    s_and_b32 s58, s58, 0xffff
    s_lshl_b32 s58, s58, 5
    buffer_load_dwordx4 v200, s[52:55], s58 offen lds
    s_add_u32 m0, s56, 4096
    s_add_u32 s58, s57, 20480
    s_and_b32 s58, s58, 0xffff
    s_lshl_b32 s58, s58, 5
    buffer_load_dwordx4 v200, s[52:55], s58 offen lds
    s_add_u32 m0, s56, 5120
    s_add_u32 s58, s57, 21504
    s_and_b32 s58, s58, 0xffff
    s_lshl_b32 s58, s58, 5
    buffer_load_dwordx4 v200, s[52:55], s58 offen lds
    s_add_u32 m0, s56, 6144
    s_add_u32 s58, s57, 22528
    s_and_b32 s58, s58, 0xffff
    s_lshl_b32 s58, s58, 5
    buffer_load_dwordx4 v200, s[52:55], s58 offen lds
    s_add_u32 m0, s56, 7168
    s_add_u32 s58, s57, 23552
    s_and_b32 s58, s58, 0xffff
    s_lshl_b32 s58, s58, 5
    buffer_load_dwordx4 v200, s[52:55], s58 offen lds
    s_add_u32 m0, s56, 8192
    s_add_u32 s58, s57, 24576
    s_and_b32 s58, s58, 0xffff
    s_lshl_b32 s58, s58, 5
    buffer_load_dwordx4 v200, s[52:55], s58 offen lds
    s_add_u32 m0, s56, 9216
    s_add_u32 s58, s57, 25600
    s_and_b32 s58, s58, 0xffff
    s_lshl_b32 s58, s58, 5
    buffer_load_dwordx4 v200, s[52:55], s58 offen lds
    s_add_u32 m0, s56, 10240
    s_add_u32 s58, s57, 26624
    s_and_b32 s58, s58, 0xffff
    s_lshl_b32 s58, s58, 5
    buffer_load_dwordx4 v200, s[52:55], s58 offen lds
    s_add_u32 m0, s56, 11264
    s_add_u32 s58, s57, 27648
    s_and_b32 s58, s58, 0xffff
    s_lshl_b32 s58, s58, 5
    buffer_load_dwordx4 v200, s[52:55], s58 offen lds
    s_add_u32 m0, s56, 12288
    s_add_u32 s58, s57, 28672
    s_and_b32 s58, s58, 0xffff
    s_lshl_b32 s58, s58, 5
    buffer_load_dwordx4 v200, s[52:55], s58 offen lds
    s_add_u32 m0, s56, 13312
    s_add_u32 s58, s57, 29696
    s_and_b32 s58, s58, 0xffff
    s_lshl_b32 s58, s58, 5
    buffer_load_dwordx4 v200, s[52:55], s58 offen lds
    s_add_u32 m0, s56, 14336
    s_add_u32 s58, s57, 30720
    s_and_b32 s58, s58, 0xffff
    s_lshl_b32 s58, s58, 5
    buffer_load_dwordx4 v200, s[52:55], s58 offen lds
    s_add_u32 m0, s56, 15360
    s_add_u32 s58, s57, 31744
    s_and_b32 s58, s58, 0xffff
    s_lshl_b32 s58, s58, 5
    buffer_load_dwordx4 v200, s[52:55], s58 offen lds
    s_cmp_lg_u32 s98, 0
    s_cbranch_scc1 mega_kernel_wf1bd
    s_mov_b32 s81, 71360512
mega_kernel_wf1b:
    buffer_load_dword v120, off, s[84:87], s81 sc1
    s_waitcnt vmcnt(0)
    v_cmp_ne_u32 vcc, 128, v120
    s_cbranch_vccz mega_kernel_wf1bd
    s_sleep 6
    s_branch mega_kernel_wf1b
mega_kernel_wf1bd:
    s_mov_b32 s99, 128
    s_branch mega_kernel_f2_in
mega_kernel_f2ret:
    s_waitcnt vmcnt(0)
    v_mov_b32 v2, 1
    s_mov_b64 exec, 1
    s_mov_b32 s81, 71360768
    buffer_atomic_add v2, off, s[84:87], s81 sc1
    s_mov_b64 exec, -1
    s_branch mega_kernel_xo3
mega_kernel_xo2:
    s_waitcnt vmcnt(0)
    ds_read_b64_tr_b16 a[0:1], v201 offset:0
    ds_read_b64_tr_b16 a[2:3], v201 offset:256
    ds_read_b64_tr_b16 a[4:5], v201 offset:1024
    ds_read_b64_tr_b16 a[6:7], v201 offset:1280
    ds_read_b64_tr_b16 a[8:9], v201 offset:2048
    ds_read_b64_tr_b16 a[10:11], v201 offset:2304
    ds_read_b64_tr_b16 a[12:13], v201 offset:3072
    ds_read_b64_tr_b16 a[14:15], v201 offset:3328
    s_waitcnt lgkmcnt(0)
    ds_read_b64_tr_b16 a[16:17], v201 offset:4096
    ds_read_b64_tr_b16 a[18:19], v201 offset:4352
    ds_read_b64_tr_b16 a[20:21], v201 offset:5120
    ds_read_b64_tr_b16 a[22:23], v201 offset:5376
    ds_read_b64_tr_b16 a[24:25], v201 offset:6144
    ds_read_b64_tr_b16 a[26:27], v201 offset:6400
    ds_read_b64_tr_b16 a[28:29], v201 offset:7168
    ds_read_b64_tr_b16 a[30:31], v201 offset:7424
    s_waitcnt lgkmcnt(0)
    ds_read_b64_tr_b16 a[32:33], v201 offset:8192
    ds_read_b64_tr_b16 a[34:35], v201 offset:8448
    ds_read_b64_tr_b16 a[36:37], v201 offset:9216
    ds_read_b64_tr_b16 a[38:39], v201 offset:9472
    ds_read_b64_tr_b16 a[40:41], v201 offset:10240
    ds_read_b64_tr_b16 a[42:43], v201 offset:10496
    ds_read_b64_tr_b16 a[44:45], v201 offset:11264
    ds_read_b64_tr_b16 a[46:47], v201 offset:11520
    s_waitcnt lgkmcnt(0)
    ds_read_b64_tr_b16 a[48:49], v201 offset:12288
    ds_read_b64_tr_b16 a[50:51], v201 offset:12544
    ds_read_b64_tr_b16 a[52:53], v201 offset:13312
    ds_read_b64_tr_b16 a[54:55], v201 offset:13568
    ds_read_b64_tr_b16 a[56:57], v201 offset:14336
    ds_read_b64_tr_b16 a[58:59], v201 offset:14592
    ds_read_b64_tr_b16 a[60:61], v201 offset:15360
    ds_read_b64_tr_b16 a[62:63], v201 offset:15616
    s_waitcnt lgkmcnt(0)
    s_add_u32 m0, s56, 0
    s_add_u32 s58, s57, 16384
    s_and_b32 s58, s58, 0xffff
    s_lshl_b32 s58, s58, 5
    buffer_load_dwordx4 v200, s[52:55], s58 offen lds
    s_add_u32 m0, s56, 1024
    s_add_u32 s58, s57, 17408
    s_and_b32 s58, s58, 0xffff
    s_lshl_b32 s58, s58, 5
    buffer_load_dwordx4 v200, s[52:55], s58 offen lds
    s_add_u32 m0, s56, 2048
    s_add_u32 s58, s57, 18432
    s_and_b32 s58, s58, 0xffff
    s_lshl_b32 s58, s58, 5
    buffer_load_dwordx4 v200, s[52:55], s58 offen lds
    s_add_u32 m0, s56, 3072
    s_add_u32 s58, s57, 19456
    s_and_b32 s58, s58, 0xffff
    s_lshl_b32 s58, s58, 5
    buffer_load_dwordx4 v200, s[52:55], s58 offen lds
    s_add_u32 m0, s56, 4096
    s_add_u32 s58, s57, 20480
    s_and_b32 s58, s58, 0xffff
    s_lshl_b32 s58, s58, 5
    buffer_load_dwordx4 v200, s[52:55], s58 offen lds
    s_add_u32 m0, s56, 5120
    s_add_u32 s58, s57, 21504
    s_and_b32 s58, s58, 0xffff
    s_lshl_b32 s58, s58, 5
    buffer_load_dwordx4 v200, s[52:55], s58 offen lds
    s_add_u32 m0, s56, 6144
    s_add_u32 s58, s57, 22528
    s_and_b32 s58, s58, 0xffff
    s_lshl_b32 s58, s58, 5
    buffer_load_dwordx4 v200, s[52:55], s58 offen lds
    s_add_u32 m0, s56, 7168
    s_add_u32 s58, s57, 23552
    s_and_b32 s58, s58, 0xffff
    s_lshl_b32 s58, s58, 5
    buffer_load_dwordx4 v200, s[52:55], s58 offen lds
    s_add_u32 m0, s56, 8192
    s_add_u32 s58, s57, 24576
    s_and_b32 s58, s58, 0xffff
    s_lshl_b32 s58, s58, 5
    buffer_load_dwordx4 v200, s[52:55], s58 offen lds
    s_add_u32 m0, s56, 9216
    s_add_u32 s58, s57, 25600
    s_and_b32 s58, s58, 0xffff
    s_lshl_b32 s58, s58, 5
    buffer_load_dwordx4 v200, s[52:55], s58 offen lds
    s_add_u32 m0, s56, 10240
    s_add_u32 s58, s57, 26624
    s_and_b32 s58, s58, 0xffff
    s_lshl_b32 s58, s58, 5
    buffer_load_dwordx4 v200, s[52:55], s58 offen lds
    s_add_u32 m0, s56, 11264
    s_add_u32 s58, s57, 27648
    s_and_b32 s58, s58, 0xffff
    s_lshl_b32 s58, s58, 5
    buffer_load_dwordx4 v200, s[52:55], s58 offen lds
    s_add_u32 m0, s56, 12288
    s_add_u32 s58, s57, 28672
    s_and_b32 s58, s58, 0xffff
    s_lshl_b32 s58, s58, 5
    buffer_load_dwordx4 v200, s[52:55], s58 offen lds
    s_add_u32 m0, s56, 13312
    s_add_u32 s58, s57, 29696
    s_and_b32 s58, s58, 0xffff
    s_lshl_b32 s58, s58, 5
    buffer_load_dwordx4 v200, s[52:55], s58 offen lds
    s_add_u32 m0, s56, 14336
    s_add_u32 s58, s57, 30720
    s_and_b32 s58, s58, 0xffff
    s_lshl_b32 s58, s58, 5
    buffer_load_dwordx4 v200, s[52:55], s58 offen lds
    s_add_u32 m0, s56, 15360
    s_add_u32 s58, s57, 31744
    s_and_b32 s58, s58, 0xffff
    s_lshl_b32 s58, s58, 5
    buffer_load_dwordx4 v200, s[52:55], s58 offen lds
    s_waitcnt vmcnt(0)
    ds_read_b64_tr_b16 a[64:65], v201 offset:0
    ds_read_b64_tr_b16 a[66:67], v201 offset:256
    ds_read_b64_tr_b16 a[68:69], v201 offset:1024
    ds_read_b64_tr_b16 a[70:71], v201 offset:1280
    ds_read_b64_tr_b16 a[72:73], v201 offset:2048
    ds_read_b64_tr_b16 a[74:75], v201 offset:2304
    ds_read_b64_tr_b16 a[76:77], v201 offset:3072
    ds_read_b64_tr_b16 a[78:79], v201 offset:3328
    s_waitcnt lgkmcnt(0)
    ds_read_b64_tr_b16 a[80:81], v201 offset:4096
    ds_read_b64_tr_b16 a[82:83], v201 offset:4352
    ds_read_b64_tr_b16 a[84:85], v201 offset:5120
    ds_read_b64_tr_b16 a[86:87], v201 offset:5376
    ds_read_b64_tr_b16 a[88:89], v201 offset:6144
    ds_read_b64_tr_b16 a[90:91], v201 offset:6400
    ds_read_b64_tr_b16 a[92:93], v201 offset:7168
    ds_read_b64_tr_b16 a[94:95], v201 offset:7424
    s_waitcnt lgkmcnt(0)
    ds_read_b64_tr_b16 a[96:97], v201 offset:8192
    ds_read_b64_tr_b16 a[98:99], v201 offset:8448
    ds_read_b64_tr_b16 a[100:101], v201 offset:9216
    ds_read_b64_tr_b16 a[102:103], v201 offset:9472
    ds_read_b64_tr_b16 a[104:105], v201 offset:10240
    ds_read_b64_tr_b16 a[106:107], v201 offset:10496
    ds_read_b64_tr_b16 a[108:109], v201 offset:11264
    ds_read_b64_tr_b16 a[110:111], v201 offset:11520
    s_waitcnt lgkmcnt(0)
    ds_read_b64_tr_b16 a[112:113], v201 offset:12288
    ds_read_b64_tr_b16 a[114:115], v201 offset:12544
    ds_read_b64_tr_b16 a[116:117], v201 offset:13312
    ds_read_b64_tr_b16 a[118:119], v201 offset:13568
    ds_read_b64_tr_b16 a[120:121], v201 offset:14336
    ds_read_b64_tr_b16 a[122:123], v201 offset:14592
    ds_read_b64_tr_b16 a[124:125], v201 offset:15360
    ds_read_b64_tr_b16 a[126:127], v201 offset:15616
    s_waitcnt lgkmcnt(0)
    s_add_u32 m0, s56, 0
    s_add_u32 s58, s57, 32768
    s_and_b32 s58, s58, 0xffff
    s_lshl_b32 s58, s58, 5
    buffer_load_dwordx4 v200, s[52:55], s58 offen lds
    s_add_u32 m0, s56, 1024
    s_add_u32 s58, s57, 33792
    s_and_b32 s58, s58, 0xffff
    s_lshl_b32 s58, s58, 5
    buffer_load_dwordx4 v200, s[52:55], s58 offen lds
    s_add_u32 m0, s56, 2048
    s_add_u32 s58, s57, 34816
    s_and_b32 s58, s58, 0xffff
    s_lshl_b32 s58, s58, 5
    buffer_load_dwordx4 v200, s[52:55], s58 offen lds
    s_add_u32 m0, s56, 3072
    s_add_u32 s58, s57, 35840
    s_and_b32 s58, s58, 0xffff
    s_lshl_b32 s58, s58, 5
    buffer_load_dwordx4 v200, s[52:55], s58 offen lds
    s_add_u32 m0, s56, 4096
    s_add_u32 s58, s57, 36864
    s_and_b32 s58, s58, 0xffff
    s_lshl_b32 s58, s58, 5
    buffer_load_dwordx4 v200, s[52:55], s58 offen lds
    s_add_u32 m0, s56, 5120
    s_add_u32 s58, s57, 37888
    s_and_b32 s58, s58, 0xffff
    s_lshl_b32 s58, s58, 5
    buffer_load_dwordx4 v200, s[52:55], s58 offen lds
    s_add_u32 m0, s56, 6144
    s_add_u32 s58, s57, 38912
    s_and_b32 s58, s58, 0xffff
    s_lshl_b32 s58, s58, 5
    buffer_load_dwordx4 v200, s[52:55], s58 offen lds
    s_add_u32 m0, s56, 7168
    s_add_u32 s58, s57, 39936
    s_and_b32 s58, s58, 0xffff
    s_lshl_b32 s58, s58, 5
    buffer_load_dwordx4 v200, s[52:55], s58 offen lds
    s_add_u32 m0, s56, 8192
    s_add_u32 s58, s57, 40960
    s_and_b32 s58, s58, 0xffff
    s_lshl_b32 s58, s58, 5
    buffer_load_dwordx4 v200, s[52:55], s58 offen lds
    s_add_u32 m0, s56, 9216
    s_add_u32 s58, s57, 41984
    s_and_b32 s58, s58, 0xffff
    s_lshl_b32 s58, s58, 5
    buffer_load_dwordx4 v200, s[52:55], s58 offen lds
    s_add_u32 m0, s56, 10240
    s_add_u32 s58, s57, 43008
    s_and_b32 s58, s58, 0xffff
    s_lshl_b32 s58, s58, 5
    buffer_load_dwordx4 v200, s[52:55], s58 offen lds
    s_add_u32 m0, s56, 11264
    s_add_u32 s58, s57, 44032
    s_and_b32 s58, s58, 0xffff
    s_lshl_b32 s58, s58, 5
    buffer_load_dwordx4 v200, s[52:55], s58 offen lds
    s_add_u32 m0, s56, 12288
    s_add_u32 s58, s57, 45056
    s_and_b32 s58, s58, 0xffff
    s_lshl_b32 s58, s58, 5
    buffer_load_dwordx4 v200, s[52:55], s58 offen lds
    s_add_u32 m0, s56, 13312
    s_add_u32 s58, s57, 46080
    s_and_b32 s58, s58, 0xffff
    s_lshl_b32 s58, s58, 5
    buffer_load_dwordx4 v200, s[52:55], s58 offen lds
    s_add_u32 m0, s56, 14336
    s_add_u32 s58, s57, 47104
    s_and_b32 s58, s58, 0xffff
    s_lshl_b32 s58, s58, 5
    buffer_load_dwordx4 v200, s[52:55], s58 offen lds
    s_add_u32 m0, s56, 15360
    s_add_u32 s58, s57, 48128
    s_and_b32 s58, s58, 0xffff
    s_lshl_b32 s58, s58, 5
    buffer_load_dwordx4 v200, s[52:55], s58 offen lds
mega_kernel_xo3:
    s_waitcnt vmcnt(0)
    ds_read_b64_tr_b16 a[128:129], v201 offset:0
    ds_read_b64_tr_b16 a[130:131], v201 offset:256
    ds_read_b64_tr_b16 a[132:133], v201 offset:1024
    ds_read_b64_tr_b16 a[134:135], v201 offset:1280
    ds_read_b64_tr_b16 a[136:137], v201 offset:2048
    ds_read_b64_tr_b16 a[138:139], v201 offset:2304
    ds_read_b64_tr_b16 a[140:141], v201 offset:3072
    ds_read_b64_tr_b16 a[142:143], v201 offset:3328
    s_waitcnt lgkmcnt(0)
    ds_read_b64_tr_b16 a[144:145], v201 offset:4096
    ds_read_b64_tr_b16 a[146:147], v201 offset:4352
    ds_read_b64_tr_b16 a[148:149], v201 offset:5120
    ds_read_b64_tr_b16 a[150:151], v201 offset:5376
    ds_read_b64_tr_b16 a[152:153], v201 offset:6144
    ds_read_b64_tr_b16 a[154:155], v201 offset:6400
    ds_read_b64_tr_b16 a[156:157], v201 offset:7168
    ds_read_b64_tr_b16 a[158:159], v201 offset:7424
    s_waitcnt lgkmcnt(0)
    ds_read_b64_tr_b16 a[160:161], v201 offset:8192
    ds_read_b64_tr_b16 a[162:163], v201 offset:8448
    ds_read_b64_tr_b16 a[164:165], v201 offset:9216
    ds_read_b64_tr_b16 a[166:167], v201 offset:9472
    ds_read_b64_tr_b16 a[168:169], v201 offset:10240
    ds_read_b64_tr_b16 a[170:171], v201 offset:10496
    ds_read_b64_tr_b16 a[172:173], v201 offset:11264
    ds_read_b64_tr_b16 a[174:175], v201 offset:11520
    s_waitcnt lgkmcnt(0)
    ds_read_b64_tr_b16 a[176:177], v201 offset:12288
    ds_read_b64_tr_b16 a[178:179], v201 offset:12544
    ds_read_b64_tr_b16 a[180:181], v201 offset:13312
    ds_read_b64_tr_b16 a[182:183], v201 offset:13568
    ds_read_b64_tr_b16 a[184:185], v201 offset:14336
    ds_read_b64_tr_b16 a[186:187], v201 offset:14592
    ds_read_b64_tr_b16 a[188:189], v201 offset:15360
    ds_read_b64_tr_b16 a[190:191], v201 offset:15616
    s_waitcnt lgkmcnt(0)
    s_add_u32 m0, s56, 0
    s_add_u32 s58, s57, 49152
    s_and_b32 s58, s58, 0xffff
    s_lshl_b32 s58, s58, 5
    buffer_load_dwordx4 v200, s[52:55], s58 offen lds
    s_add_u32 m0, s56, 1024
    s_add_u32 s58, s57, 50176
    s_and_b32 s58, s58, 0xffff
    s_lshl_b32 s58, s58, 5
    buffer_load_dwordx4 v200, s[52:55], s58 offen lds
    s_add_u32 m0, s56, 2048
    s_add_u32 s58, s57, 51200
    s_and_b32 s58, s58, 0xffff
    s_lshl_b32 s58, s58, 5
    buffer_load_dwordx4 v200, s[52:55], s58 offen lds
    s_add_u32 m0, s56, 3072
    s_add_u32 s58, s57, 52224
    s_and_b32 s58, s58, 0xffff
    s_lshl_b32 s58, s58, 5
    buffer_load_dwordx4 v200, s[52:55], s58 offen lds
    s_add_u32 m0, s56, 4096
    s_add_u32 s58, s57, 53248
    s_and_b32 s58, s58, 0xffff
    s_lshl_b32 s58, s58, 5
    buffer_load_dwordx4 v200, s[52:55], s58 offen lds
    s_add_u32 m0, s56, 5120
    s_add_u32 s58, s57, 54272
    s_and_b32 s58, s58, 0xffff
    s_lshl_b32 s58, s58, 5
    buffer_load_dwordx4 v200, s[52:55], s58 offen lds
    s_add_u32 m0, s56, 6144
    s_add_u32 s58, s57, 55296
    s_and_b32 s58, s58, 0xffff
    s_lshl_b32 s58, s58, 5
    buffer_load_dwordx4 v200, s[52:55], s58 offen lds
    s_add_u32 m0, s56, 7168
    s_add_u32 s58, s57, 56320
    s_and_b32 s58, s58, 0xffff
    s_lshl_b32 s58, s58, 5
    buffer_load_dwordx4 v200, s[52:55], s58 offen lds
    s_add_u32 m0, s56, 8192
    s_add_u32 s58, s57, 57344
    s_and_b32 s58, s58, 0xffff
    s_lshl_b32 s58, s58, 5
    buffer_load_dwordx4 v200, s[52:55], s58 offen lds
    s_add_u32 m0, s56, 9216
    s_add_u32 s58, s57, 58368
    s_and_b32 s58, s58, 0xffff
    s_lshl_b32 s58, s58, 5
    buffer_load_dwordx4 v200, s[52:55], s58 offen lds
    s_add_u32 m0, s56, 10240
    s_add_u32 s58, s57, 59392
    s_and_b32 s58, s58, 0xffff
    s_lshl_b32 s58, s58, 5
    buffer_load_dwordx4 v200, s[52:55], s58 offen lds
    s_add_u32 m0, s56, 11264
    s_add_u32 s58, s57, 60416
    s_and_b32 s58, s58, 0xffff
    s_lshl_b32 s58, s58, 5
    buffer_load_dwordx4 v200, s[52:55], s58 offen lds
    s_add_u32 m0, s56, 12288
    s_add_u32 s58, s57, 61440
    s_and_b32 s58, s58, 0xffff
    s_lshl_b32 s58, s58, 5
    buffer_load_dwordx4 v200, s[52:55], s58 offen lds
    s_add_u32 m0, s56, 13312
    s_add_u32 s58, s57, 62464
    s_and_b32 s58, s58, 0xffff
    s_lshl_b32 s58, s58, 5
    buffer_load_dwordx4 v200, s[52:55], s58 offen lds
    s_add_u32 m0, s56, 14336
    s_add_u32 s58, s57, 63488
    s_and_b32 s58, s58, 0xffff
    s_lshl_b32 s58, s58, 5
    buffer_load_dwordx4 v200, s[52:55], s58 offen lds
    s_add_u32 m0, s56, 15360
    s_add_u32 s58, s57, 64512
    s_and_b32 s58, s58, 0xffff
    s_lshl_b32 s58, s58, 5
    buffer_load_dwordx4 v200, s[52:55], s58 offen lds
    s_branch mega_kernel_xo4
mega_kernel_f1:
    s_barrier
    s_load_dwordx2 s[4:5], s[0:1], 56
    s_load_dwordx2 s[8:9], s[0:1], 96
    v_and_b32 v1, 31, v0
    v_lshrrev_b32 v2, 5, v0
    v_cvt_f32_u32 v3, v1
    s_waitcnt lgkmcnt(0)
    s_mov_b32 s6, 4194304
    s_mov_b32 s7, 0x00020000
    s_mov_b32 s10, 268435456
    s_mov_b32 s11, 0x00020000
    s_lshl_b32 s12, s92, 15
    v_lshlrev_b32 v6, 12, v2
    v_lshl_add_u32 v6, v1, 1, v6
    buffer_load_ushort v16, v6, s[4:7], s12 offen offset:0
    buffer_load_ushort v48, v6, s[4:7], s12 offen offset:2048
    buffer_load_ushort v17, v6, s[4:7], s12 offen offset:64
    buffer_load_ushort v49, v6, s[4:7], s12 offen offset:2112
    buffer_load_ushort v18, v6, s[4:7], s12 offen offset:128
    buffer_load_ushort v50, v6, s[4:7], s12 offen offset:2176
    buffer_load_ushort v19, v6, s[4:7], s12 offen offset:192
    buffer_load_ushort v51, v6, s[4:7], s12 offen offset:2240
    buffer_load_ushort v20, v6, s[4:7], s12 offen offset:256
    buffer_load_ushort v52, v6, s[4:7], s12 offen offset:2304
    buffer_load_ushort v21, v6, s[4:7], s12 offen offset:320
    buffer_load_ushort v53, v6, s[4:7], s12 offen offset:2368
    buffer_load_ushort v22, v6, s[4:7], s12 offen offset:384
    buffer_load_ushort v54, v6, s[4:7], s12 offen offset:2432
    buffer_load_ushort v23, v6, s[4:7], s12 offen offset:448
    buffer_load_ushort v55, v6, s[4:7], s12 offen offset:2496
    buffer_load_ushort v24, v6, s[4:7], s12 offen offset:512
    buffer_load_ushort v56, v6, s[4:7], s12 offen offset:2560
    buffer_load_ushort v25, v6, s[4:7], s12 offen offset:576
    buffer_load_ushort v57, v6, s[4:7], s12 offen offset:2624
    buffer_load_ushort v26, v6, s[4:7], s12 offen offset:640
    buffer_load_ushort v58, v6, s[4:7], s12 offen offset:2688
    buffer_load_ushort v27, v6, s[4:7], s12 offen offset:704
    buffer_load_ushort v59, v6, s[4:7], s12 offen offset:2752
    buffer_load_ushort v28, v6, s[4:7], s12 offen offset:768
    buffer_load_ushort v60, v6, s[4:7], s12 offen offset:2816
    buffer_load_ushort v29, v6, s[4:7], s12 offen offset:832
    buffer_load_ushort v61, v6, s[4:7], s12 offen offset:2880
    buffer_load_ushort v30, v6, s[4:7], s12 offen offset:896
    buffer_load_ushort v62, v6, s[4:7], s12 offen offset:2944
    buffer_load_ushort v31, v6, s[4:7], s12 offen offset:960
    buffer_load_ushort v63, v6, s[4:7], s12 offen offset:3008
    buffer_load_ushort v32, v6, s[4:7], s12 offen offset:1024
    buffer_load_ushort v64, v6, s[4:7], s12 offen offset:3072
    buffer_load_ushort v33, v6, s[4:7], s12 offen offset:1088
    buffer_load_ushort v65, v6, s[4:7], s12 offen offset:3136
    buffer_load_ushort v34, v6, s[4:7], s12 offen offset:1152
    buffer_load_ushort v66, v6, s[4:7], s12 offen offset:3200
    buffer_load_ushort v35, v6, s[4:7], s12 offen offset:1216
    buffer_load_ushort v67, v6, s[4:7], s12 offen offset:3264
    buffer_load_ushort v36, v6, s[4:7], s12 offen offset:1280
    buffer_load_ushort v68, v6, s[4:7], s12 offen offset:3328
    buffer_load_ushort v37, v6, s[4:7], s12 offen offset:1344
    buffer_load_ushort v69, v6, s[4:7], s12 offen offset:3392
    buffer_load_ushort v38, v6, s[4:7], s12 offen offset:1408
    buffer_load_ushort v70, v6, s[4:7], s12 offen offset:3456
    buffer_load_ushort v39, v6, s[4:7], s12 offen offset:1472
    buffer_load_ushort v71, v6, s[4:7], s12 offen offset:3520
    buffer_load_ushort v40, v6, s[4:7], s12 offen offset:1536
    buffer_load_ushort v72, v6, s[4:7], s12 offen offset:3584
    buffer_load_ushort v41, v6, s[4:7], s12 offen offset:1600
    buffer_load_ushort v73, v6, s[4:7], s12 offen offset:3648
    buffer_load_ushort v42, v6, s[4:7], s12 offen offset:1664
    buffer_load_ushort v74, v6, s[4:7], s12 offen offset:3712
    buffer_load_ushort v43, v6, s[4:7], s12 offen offset:1728
    buffer_load_ushort v75, v6, s[4:7], s12 offen offset:3776
    buffer_load_ushort v44, v6, s[4:7], s12 offen offset:1792
    buffer_load_ushort v76, v6, s[4:7], s12 offen offset:3840
    buffer_load_ushort v45, v6, s[4:7], s12 offen offset:1856
    buffer_load_ushort v77, v6, s[4:7], s12 offen offset:3904
    buffer_load_ushort v46, v6, s[4:7], s12 offen offset:1920
    buffer_load_ushort v78, v6, s[4:7], s12 offen offset:3968
    buffer_load_ushort v47, v6, s[4:7], s12 offen offset:1984
    buffer_load_ushort v79, v6, s[4:7], s12 offen offset:4032
    s_movk_i32 s13, 8448
    v_mul_lo_u32 v7, v2, s13
    v_lshl_add_u32 v4, v1, 3, v7
    s_movk_i32 s13, 264
    v_mul_lo_u32 v5, v1, s13
    v_add_u32 v5, v5, v7
    s_waitcnt vmcnt(0)
    v_lshlrev_b32 v16, 16, v16
    v_lshlrev_b32 v48, 16, v48
    v_lshlrev_b32 v17, 16, v17
    v_lshlrev_b32 v49, 16, v49
    v_lshlrev_b32 v18, 16, v18
    v_lshlrev_b32 v50, 16, v50
    v_lshlrev_b32 v19, 16, v19
    v_lshlrev_b32 v51, 16, v51
    v_lshlrev_b32 v20, 16, v20
    v_lshlrev_b32 v52, 16, v52
    v_lshlrev_b32 v21, 16, v21
    v_lshlrev_b32 v53, 16, v53
    v_lshlrev_b32 v22, 16, v22
    v_lshlrev_b32 v54, 16, v54
    v_lshlrev_b32 v23, 16, v23
    v_lshlrev_b32 v55, 16, v55
    v_lshlrev_b32 v24, 16, v24
    v_lshlrev_b32 v56, 16, v56
    v_lshlrev_b32 v25, 16, v25
    v_lshlrev_b32 v57, 16, v57
    v_lshlrev_b32 v26, 16, v26
    v_lshlrev_b32 v58, 16, v58
    v_lshlrev_b32 v27, 16, v27
    v_lshlrev_b32 v59, 16, v59
    v_lshlrev_b32 v28, 16, v28
    v_lshlrev_b32 v60, 16, v60
    v_lshlrev_b32 v29, 16, v29
    v_lshlrev_b32 v61, 16, v61
    v_lshlrev_b32 v30, 16, v30
    v_lshlrev_b32 v62, 16, v62
    v_lshlrev_b32 v31, 16, v31
    v_lshlrev_b32 v63, 16, v63
    v_lshlrev_b32 v32, 16, v32
    v_lshlrev_b32 v64, 16, v64
    v_lshlrev_b32 v33, 16, v33
    v_lshlrev_b32 v65, 16, v65
    v_lshlrev_b32 v34, 16, v34
    v_lshlrev_b32 v66, 16, v66
    v_lshlrev_b32 v35, 16, v35
    v_lshlrev_b32 v67, 16, v67
    v_lshlrev_b32 v36, 16, v36
    v_lshlrev_b32 v68, 16, v68
    v_lshlrev_b32 v37, 16, v37
    v_lshlrev_b32 v69, 16, v69
    v_lshlrev_b32 v38, 16, v38
    v_lshlrev_b32 v70, 16, v70
    v_lshlrev_b32 v39, 16, v39
    v_lshlrev_b32 v71, 16, v71
    v_lshlrev_b32 v40, 16, v40
    v_lshlrev_b32 v72, 16, v72
    v_lshlrev_b32 v41, 16, v41
    v_lshlrev_b32 v73, 16, v73
    v_lshlrev_b32 v42, 16, v42
    v_lshlrev_b32 v74, 16, v74
    v_lshlrev_b32 v43, 16, v43
    v_lshlrev_b32 v75, 16, v75
    v_lshlrev_b32 v44, 16, v44
    v_lshlrev_b32 v76, 16, v76
    v_lshlrev_b32 v45, 16, v45
    v_lshlrev_b32 v77, 16, v77
    v_lshlrev_b32 v46, 16, v46
    v_lshlrev_b32 v78, 16, v78
    v_lshlrev_b32 v47, 16, v47
    v_lshlrev_b32 v79, 16, v79
    v_sub_f32 v80, v16, v32
    v_sub_f32 v81, v48, v64
    v_add_f32 v16, v16, v32
    v_add_f32 v48, v48, v64
    v_sub_f32 v32, v17, v33
    v_sub_f32 v64, v49, v65
    v_add_f32 v17, v17, v33
    v_add_f32 v49, v49, v65
    v_mul_f32 v33, 0x3f7b14be, v32
    v_mul_f32 v65, 0xbe47c5c2, v32
    v_fmac_f32 v33, 0x3e47c5c2, v64
    v_fmac_f32 v65, 0x3f7b14be, v64
    v_sub_f32 v32, v18, v34
    v_sub_f32 v64, v50, v66
    v_add_f32 v18, v18, v34
    v_add_f32 v50, v50, v66
    v_mul_f32 v34, 0x3f6c835e, v32
    v_mul_f32 v66, 0xbec3ef15, v32
    v_fmac_f32 v34, 0x3ec3ef15, v64
    v_fmac_f32 v66, 0x3f6c835e, v64
    v_sub_f32 v32, v19, v35
    v_sub_f32 v64, v51, v67
    v_add_f32 v19, v19, v35
    v_add_f32 v51, v51, v67
    v_mul_f32 v35, 0x3f54db31, v32
    v_mul_f32 v67, 0xbf0e39da, v32
    v_fmac_f32 v35, 0x3f0e39da, v64
    v_fmac_f32 v67, 0x3f54db31, v64
    v_sub_f32 v32, v20, v36
    v_sub_f32 v64, v52, v68
    v_add_f32 v20, v20, v36
    v_add_f32 v52, v52, v68
    v_mul_f32 v36, 0x3f3504f3, v32
    v_mul_f32 v68, 0xbf3504f3, v32
    v_fmac_f32 v36, 0x3f3504f3, v64
    v_fmac_f32 v68, 0x3f3504f3, v64
    v_sub_f32 v32, v21, v37
    v_sub_f32 v64, v53, v69
    v_add_f32 v21, v21, v37
    v_add_f32 v53, v53, v69
    v_mul_f32 v37, 0x3f0e39da, v32
    v_mul_f32 v69, 0xbf54db31, v32
    v_fmac_f32 v37, 0x3f54db31, v64
    v_fmac_f32 v69, 0x3f0e39da, v64
    v_sub_f32 v32, v22, v38
    v_sub_f32 v64, v54, v70
    v_add_f32 v22, v22, v38
    v_add_f32 v54, v54, v70
    v_mul_f32 v38, 0x3ec3ef15, v32
    v_mul_f32 v70, 0xbf6c835e, v32
    v_fmac_f32 v38, 0x3f6c835e, v64
    v_fmac_f32 v70, 0x3ec3ef15, v64
    v_sub_f32 v32, v23, v39
    v_sub_f32 v64, v55, v71
    v_add_f32 v23, v23, v39
    v_add_f32 v55, v55, v71
    v_mul_f32 v39, 0x3e47c5c2, v32
    v_mul_f32 v71, 0xbf7b14be, v32
    v_fmac_f32 v39, 0x3f7b14be, v64
    v_fmac_f32 v71, 0x3e47c5c2, v64
    v_sub_f32 v32, v56, v72
    v_sub_f32 v64, v40, v24
    v_add_f32 v24, v24, v40
    v_add_f32 v56, v56, v72
    v_sub_f32 v40, v25, v41
    v_sub_f32 v72, v57, v73
    v_add_f32 v25, v25, v41
    v_add_f32 v57, v57, v73
    v_mul_f32 v41, 0xbe47c5c2, v40
    v_mul_f32 v73, 0xbf7b14be, v40
    v_fmac_f32 v41, 0x3f7b14be, v72
    v_fmac_f32 v73, 0xbe47c5c2, v72
    v_sub_f32 v40, v26, v42
    v_sub_f32 v72, v58, v74
    v_add_f32 v26, v26, v42
    v_add_f32 v58, v58, v74
    v_mul_f32 v42, 0xbec3ef15, v40
    v_mul_f32 v74, 0xbf6c835e, v40
    v_fmac_f32 v42, 0x3f6c835e, v72
    v_fmac_f32 v74, 0xbec3ef15, v72
    v_sub_f32 v40, v27, v43
    v_sub_f32 v72, v59, v75
    v_add_f32 v27, v27, v43
    v_add_f32 v59, v59, v75
    v_mul_f32 v43, 0xbf0e39da, v40
    v_mul_f32 v75, 0xbf54db31, v40
    v_fmac_f32 v43, 0x3f54db31, v72
    v_fmac_f32 v75, 0xbf0e39da, v72
    v_sub_f32 v40, v28, v44
    v_sub_f32 v72, v60, v76
    v_add_f32 v28, v28, v44
    v_add_f32 v60, v60, v76
    v_mul_f32 v44, 0xbf3504f3, v40
    v_mul_f32 v76, 0xbf3504f3, v40
    v_fmac_f32 v44, 0x3f3504f3, v72
    v_fmac_f32 v76, 0xbf3504f3, v72
    v_sub_f32 v40, v29, v45
    v_sub_f32 v72, v61, v77
    v_add_f32 v29, v29, v45
    v_add_f32 v61, v61, v77
    v_mul_f32 v45, 0xbf54db31, v40
    v_mul_f32 v77, 0xbf0e39da, v40
    v_fmac_f32 v45, 0x3f0e39da, v72
    v_fmac_f32 v77, 0xbf54db31, v72
    v_sub_f32 v40, v30, v46
    v_sub_f32 v72, v62, v78
    v_add_f32 v30, v30, v46
    v_add_f32 v62, v62, v78
    v_mul_f32 v46, 0xbf6c835e, v40
    v_mul_f32 v78, 0xbec3ef15, v40
    v_fmac_f32 v46, 0x3ec3ef15, v72
    v_fmac_f32 v78, 0xbf6c835e, v72
    v_sub_f32 v40, v31, v47
    v_sub_f32 v72, v63, v79
    v_add_f32 v31, v31, v47
    v_add_f32 v63, v63, v79
    v_mul_f32 v47, 0xbf7b14be, v40
    v_mul_f32 v79, 0xbe47c5c2, v40
    v_fmac_f32 v47, 0x3e47c5c2, v72
    v_fmac_f32 v79, 0xbf7b14be, v72
    v_sub_f32 v40, v16, v24
    v_sub_f32 v72, v48, v56
    v_add_f32 v16, v16, v24
    v_add_f32 v48, v48, v56
    v_sub_f32 v24, v17, v25
    v_sub_f32 v56, v49, v57
    v_add_f32 v17, v17, v25
    v_add_f32 v49, v49, v57
    v_mul_f32 v25, 0x3f6c835e, v24
    v_mul_f32 v57, 0xbec3ef15, v24
    v_fmac_f32 v25, 0x3ec3ef15, v56
    v_fmac_f32 v57, 0x3f6c835e, v56
    v_sub_f32 v24, v18, v26
    v_sub_f32 v56, v50, v58
    v_add_f32 v18, v18, v26
    v_add_f32 v50, v50, v58
    v_mul_f32 v26, 0x3f3504f3, v24
    v_mul_f32 v58, 0xbf3504f3, v24
    v_fmac_f32 v26, 0x3f3504f3, v56
    v_fmac_f32 v58, 0x3f3504f3, v56
    v_sub_f32 v24, v19, v27
    v_sub_f32 v56, v51, v59
    v_add_f32 v19, v19, v27
    v_add_f32 v51, v51, v59
    v_mul_f32 v27, 0x3ec3ef15, v24
    v_mul_f32 v59, 0xbf6c835e, v24
    v_fmac_f32 v27, 0x3f6c835e, v56
    v_fmac_f32 v59, 0x3ec3ef15, v56
    v_sub_f32 v24, v52, v60
    v_sub_f32 v56, v28, v20
    v_add_f32 v20, v20, v28
    v_add_f32 v52, v52, v60
    v_sub_f32 v28, v21, v29
    v_sub_f32 v60, v53, v61
    v_add_f32 v21, v21, v29
    v_add_f32 v53, v53, v61
    v_mul_f32 v29, 0xbec3ef15, v28
    v_mul_f32 v61, 0xbf6c835e, v28
    v_fmac_f32 v29, 0x3f6c835e, v60
    v_fmac_f32 v61, 0xbec3ef15, v60
    v_sub_f32 v28, v22, v30
    v_sub_f32 v60, v54, v62
    v_add_f32 v22, v22, v30
    v_add_f32 v54, v54, v62
    v_mul_f32 v30, 0xbf3504f3, v28
    v_mul_f32 v62, 0xbf3504f3, v28
    v_fmac_f32 v30, 0x3f3504f3, v60
    v_fmac_f32 v62, 0xbf3504f3, v60
    v_sub_f32 v28, v23, v31
    v_sub_f32 v60, v55, v63
    v_add_f32 v23, v23, v31
    v_add_f32 v55, v55, v63
    v_mul_f32 v31, 0xbf6c835e, v28
    v_mul_f32 v63, 0xbec3ef15, v28
    v_fmac_f32 v31, 0x3ec3ef15, v60
    v_fmac_f32 v63, 0xbf6c835e, v60
    v_sub_f32 v28, v80, v32
    v_sub_f32 v60, v81, v64
    v_add_f32 v80, v80, v32
    v_add_f32 v81, v81, v64
    v_sub_f32 v32, v33, v41
    v_sub_f32 v64, v65, v73
    v_add_f32 v33, v33, v41
    v_add_f32 v65, v65, v73
    v_mul_f32 v41, 0x3f6c835e, v32
    v_mul_f32 v73, 0xbec3ef15, v32
    v_fmac_f32 v41, 0x3ec3ef15, v64
    v_fmac_f32 v73, 0x3f6c835e, v64
    v_sub_f32 v32, v34, v42
    v_sub_f32 v64, v66, v74
    v_add_f32 v34, v34, v42
    v_add_f32 v66, v66, v74
    v_mul_f32 v42, 0x3f3504f3, v32
    v_mul_f32 v74, 0xbf3504f3, v32
    v_fmac_f32 v42, 0x3f3504f3, v64
    v_fmac_f32 v74, 0x3f3504f3, v64
    v_sub_f32 v32, v35, v43
    v_sub_f32 v64, v67, v75
    v_add_f32 v35, v35, v43
    v_add_f32 v67, v67, v75
    v_mul_f32 v43, 0x3ec3ef15, v32
    v_mul_f32 v75, 0xbf6c835e, v32
    v_fmac_f32 v43, 0x3f6c835e, v64
    v_fmac_f32 v75, 0x3ec3ef15, v64
    v_sub_f32 v32, v68, v76
    v_sub_f32 v64, v44, v36
    v_add_f32 v36, v36, v44
    v_add_f32 v68, v68, v76
    v_sub_f32 v44, v37, v45
    v_sub_f32 v76, v69, v77
    v_add_f32 v37, v37, v45
    v_add_f32 v69, v69, v77
    v_mul_f32 v45, 0xbec3ef15, v44
    v_mul_f32 v77, 0xbf6c835e, v44
    v_fmac_f32 v45, 0x3f6c835e, v76
    v_fmac_f32 v77, 0xbec3ef15, v76
    v_sub_f32 v44, v38, v46
    v_sub_f32 v76, v70, v78
    v_add_f32 v38, v38, v46
    v_add_f32 v70, v70, v78
    v_mul_f32 v46, 0xbf3504f3, v44
    v_mul_f32 v78, 0xbf3504f3, v44
    v_fmac_f32 v46, 0x3f3504f3, v76
    v_fmac_f32 v78, 0xbf3504f3, v76
    v_sub_f32 v44, v39, v47
    v_sub_f32 v76, v71, v79
    v_add_f32 v39, v39, v47
    v_add_f32 v71, v71, v79
    v_mul_f32 v47, 0xbf6c835e, v44
    v_mul_f32 v79, 0xbec3ef15, v44
    v_fmac_f32 v47, 0x3ec3ef15, v76
    v_fmac_f32 v79, 0xbf6c835e, v76
    v_sub_f32 v44, v16, v20
    v_sub_f32 v76, v48, v52
    v_add_f32 v16, v16, v20
    v_add_f32 v48, v48, v52
    v_sub_f32 v20, v17, v21
    v_sub_f32 v52, v49, v53
    v_add_f32 v17, v17, v21
    v_add_f32 v49, v49, v53
    v_mul_f32 v21, 0x3f3504f3, v20
    v_mul_f32 v53, 0xbf3504f3, v20
    v_fmac_f32 v21, 0x3f3504f3, v52
    v_fmac_f32 v53, 0x3f3504f3, v52
    v_sub_f32 v20, v50, v54
    v_sub_f32 v52, v22, v18
    v_add_f32 v18, v18, v22
    v_add_f32 v50, v50, v54
    v_sub_f32 v22, v19, v23
    v_sub_f32 v54, v51, v55
    v_add_f32 v19, v19, v23
    v_add_f32 v51, v51, v55
    v_mul_f32 v23, 0xbf3504f3, v22
    v_mul_f32 v55, 0xbf3504f3, v22
    v_fmac_f32 v23, 0x3f3504f3, v54
    v_fmac_f32 v55, 0xbf3504f3, v54
    v_sub_f32 v22, v40, v24
    v_sub_f32 v54, v72, v56
    v_add_f32 v40, v40, v24
    v_add_f32 v72, v72, v56
    v_sub_f32 v24, v25, v29
    v_sub_f32 v56, v57, v61
    v_add_f32 v25, v25, v29
    v_add_f32 v57, v57, v61
    v_mul_f32 v29, 0x3f3504f3, v24
    v_mul_f32 v61, 0xbf3504f3, v24
    v_fmac_f32 v29, 0x3f3504f3, v56
    v_fmac_f32 v61, 0x3f3504f3, v56
    v_sub_f32 v24, v58, v62
    v_sub_f32 v56, v30, v26
    v_add_f32 v26, v26, v30
    v_add_f32 v58, v58, v62
    v_sub_f32 v30, v27, v31
    v_sub_f32 v62, v59, v63
    v_add_f32 v27, v27, v31
    v_add_f32 v59, v59, v63
    v_mul_f32 v31, 0xbf3504f3, v30
    v_mul_f32 v63, 0xbf3504f3, v30
    v_fmac_f32 v31, 0x3f3504f3, v62
    v_fmac_f32 v63, 0xbf3504f3, v62
    v_sub_f32 v30, v80, v36
    v_sub_f32 v62, v81, v68
    v_add_f32 v80, v80, v36
    v_add_f32 v81, v81, v68
    v_sub_f32 v36, v33, v37
    v_sub_f32 v68, v65, v69
    v_add_f32 v33, v33, v37
    v_add_f32 v65, v65, v69
    v_mul_f32 v37, 0x3f3504f3, v36
    v_mul_f32 v69, 0xbf3504f3, v36
    v_fmac_f32 v37, 0x3f3504f3, v68
    v_fmac_f32 v69, 0x3f3504f3, v68
    v_sub_f32 v36, v66, v70
    v_sub_f32 v68, v38, v34
    v_add_f32 v34, v34, v38
    v_add_f32 v66, v66, v70
    v_sub_f32 v38, v35, v39
    v_sub_f32 v70, v67, v71
    v_add_f32 v35, v35, v39
    v_add_f32 v67, v67, v71
    v_mul_f32 v39, 0xbf3504f3, v38
    v_mul_f32 v71, 0xbf3504f3, v38
    v_fmac_f32 v39, 0x3f3504f3, v70
    v_fmac_f32 v71, 0xbf3504f3, v70
    v_sub_f32 v38, v28, v32
    v_sub_f32 v70, v60, v64
    v_add_f32 v28, v28, v32
    v_add_f32 v60, v60, v64
    v_sub_f32 v32, v41, v45
    v_sub_f32 v64, v73, v77
    v_add_f32 v41, v41, v45
    v_add_f32 v73, v73, v77
    v_mul_f32 v45, 0x3f3504f3, v32
    v_mul_f32 v77, 0xbf3504f3, v32
    v_fmac_f32 v45, 0x3f3504f3, v64
    v_fmac_f32 v77, 0x3f3504f3, v64
    v_sub_f32 v32, v74, v78
    v_sub_f32 v64, v46, v42
    v_add_f32 v42, v42, v46
    v_add_f32 v74, v74, v78
    v_sub_f32 v46, v43, v47
    v_sub_f32 v78, v75, v79
    v_add_f32 v43, v43, v47
    v_add_f32 v75, v75, v79
    v_mul_f32 v47, 0xbf3504f3, v46
    v_mul_f32 v79, 0xbf3504f3, v46
    v_fmac_f32 v47, 0x3f3504f3, v78
    v_fmac_f32 v79, 0xbf3504f3, v78
    v_sub_f32 v46, v16, v18
    v_sub_f32 v78, v48, v50
    v_add_f32 v16, v16, v18
    v_add_f32 v48, v48, v50
    v_sub_f32 v18, v49, v51
    v_sub_f32 v50, v19, v17
    v_add_f32 v17, v17, v19
    v_add_f32 v49, v49, v51
    v_sub_f32 v19, v44, v20
    v_sub_f32 v51, v76, v52
    v_add_f32 v44, v44, v20
    v_add_f32 v76, v76, v52
    v_sub_f32 v20, v53, v55
    v_sub_f32 v52, v23, v21
    v_add_f32 v21, v21, v23
    v_add_f32 v53, v53, v55
    v_sub_f32 v23, v40, v26
    v_sub_f32 v55, v72, v58
    v_add_f32 v40, v40, v26
    v_add_f32 v72, v72, v58
    v_sub_f32 v26, v57, v59
    v_sub_f32 v58, v27, v25
    v_add_f32 v25, v25, v27
    v_add_f32 v57, v57, v59
    v_sub_f32 v27, v22, v24
    v_sub_f32 v59, v54, v56
    v_add_f32 v22, v22, v24
    v_add_f32 v54, v54, v56
    v_sub_f32 v24, v61, v63
    v_sub_f32 v56, v31, v29
    v_add_f32 v29, v29, v31
    v_add_f32 v61, v61, v63
    v_sub_f32 v31, v80, v34
    v_sub_f32 v63, v81, v66
    v_add_f32 v80, v80, v34
    v_add_f32 v81, v81, v66
    v_sub_f32 v34, v65, v67
    v_sub_f32 v66, v35, v33
    v_add_f32 v33, v33, v35
    v_add_f32 v65, v65, v67
    v_sub_f32 v35, v30, v36
    v_sub_f32 v67, v62, v68
    v_add_f32 v30, v30, v36
    v_add_f32 v62, v62, v68
    v_sub_f32 v36, v69, v71
    v_sub_f32 v68, v39, v37
    v_add_f32 v37, v37, v39
    v_add_f32 v69, v69, v71
    v_sub_f32 v39, v28, v42
    v_sub_f32 v71, v60, v74
    v_add_f32 v28, v28, v42
    v_add_f32 v60, v60, v74
    v_sub_f32 v42, v73, v75
    v_sub_f32 v74, v43, v41
    v_add_f32 v41, v41, v43
    v_add_f32 v73, v73, v75
    v_sub_f32 v43, v38, v32
    v_sub_f32 v75, v70, v64
    v_add_f32 v38, v38, v32
    v_add_f32 v70, v70, v64
    v_sub_f32 v32, v77, v79
    v_sub_f32 v64, v47, v45
    v_add_f32 v45, v45, v47
    v_add_f32 v77, v77, v79
    v_sub_f32 v47, v16, v17
    v_sub_f32 v79, v48, v49
    v_add_f32 v16, v16, v17
    v_add_f32 v48, v48, v49
    v_sub_f32 v17, v46, v18
    v_sub_f32 v49, v78, v50
    v_add_f32 v46, v46, v18
    v_add_f32 v78, v78, v50
    v_sub_f32 v18, v44, v21
    v_sub_f32 v50, v76, v53
    v_add_f32 v44, v44, v21
    v_add_f32 v76, v76, v53
    v_sub_f32 v21, v19, v20
    v_sub_f32 v53, v51, v52
    v_add_f32 v19, v19, v20
    v_add_f32 v51, v51, v52
    v_sub_f32 v20, v40, v25
    v_sub_f32 v52, v72, v57
    v_add_f32 v40, v40, v25
    v_add_f32 v72, v72, v57
    v_sub_f32 v25, v23, v26
    v_sub_f32 v57, v55, v58
    v_add_f32 v23, v23, v26
    v_add_f32 v55, v55, v58
    v_sub_f32 v26, v22, v29
    v_sub_f32 v58, v54, v61
    v_add_f32 v22, v22, v29
    v_add_f32 v54, v54, v61
    v_sub_f32 v29, v27, v24
    v_sub_f32 v61, v59, v56
    v_add_f32 v27, v27, v24
    v_add_f32 v59, v59, v56
    v_sub_f32 v24, v80, v33
    v_sub_f32 v56, v81, v65
    v_add_f32 v80, v80, v33
    v_add_f32 v81, v81, v65
    v_sub_f32 v33, v31, v34
    v_sub_f32 v65, v63, v66
    v_add_f32 v31, v31, v34
    v_add_f32 v63, v63, v66
    v_sub_f32 v34, v30, v37
    v_sub_f32 v66, v62, v69
    v_add_f32 v30, v30, v37
    v_add_f32 v62, v62, v69
    v_sub_f32 v37, v35, v36
    v_sub_f32 v69, v67, v68
    v_add_f32 v35, v35, v36
    v_add_f32 v67, v67, v68
    v_sub_f32 v36, v28, v41
    v_sub_f32 v68, v60, v73
    v_add_f32 v28, v28, v41
    v_add_f32 v60, v60, v73
    v_sub_f32 v41, v39, v42
    v_sub_f32 v73, v71, v74
    v_add_f32 v39, v39, v42
    v_add_f32 v71, v71, v74
    v_sub_f32 v42, v38, v45
    v_sub_f32 v74, v70, v77
    v_add_f32 v38, v38, v45
    v_add_f32 v70, v70, v77
    v_sub_f32 v45, v43, v32
    v_sub_f32 v77, v75, v64
    v_add_f32 v43, v43, v32
    v_add_f32 v75, v75, v64
    v_mul_f32 v32, 0xba800000, v3
    v_cos_f32 v64, v32
    v_sin_f32 v82, v32
    s_nop 0
    v_mul_f32 v83, v80, v64
    v_fma_f32 v83, -v81, v82, v83
    v_mul_f32 v81, v81, v64
    v_fmac_f32 v81, v80, v82
    v_mul_f32 v32, 0xbb000000, v3
    v_cos_f32 v64, v32
    v_sin_f32 v82, v32
    s_nop 0
    v_mul_f32 v80, v40, v64
    v_fma_f32 v80, -v72, v82, v80
    v_mul_f32 v72, v72, v64
    v_fmac_f32 v72, v40, v82
    v_mul_f32 v32, 0xbb400000, v3
    v_cos_f32 v64, v32
    v_sin_f32 v82, v32
    s_nop 0
    v_mul_f32 v40, v28, v64
    v_fma_f32 v40, -v60, v82, v40
    v_mul_f32 v60, v60, v64
    v_fmac_f32 v60, v28, v82
    v_mul_f32 v32, 0xbb800000, v3
    v_cos_f32 v64, v32
    v_sin_f32 v82, v32
    s_nop 0
    v_mul_f32 v28, v44, v64
    v_fma_f32 v28, -v76, v82, v28
    v_mul_f32 v76, v76, v64
    v_fmac_f32 v76, v44, v82
    v_mul_f32 v32, 0xbba00000, v3
    v_cos_f32 v64, v32
    v_sin_f32 v82, v32
    s_nop 0
    v_mul_f32 v44, v30, v64
    v_fma_f32 v44, -v62, v82, v44
    v_mul_f32 v62, v62, v64
    v_fmac_f32 v62, v30, v82
    v_mul_f32 v32, 0xbbc00000, v3
    v_cos_f32 v64, v32
    v_sin_f32 v82, v32
    s_nop 0
    v_mul_f32 v30, v22, v64
    v_fma_f32 v30, -v54, v82, v30
    v_mul_f32 v54, v54, v64
    v_fmac_f32 v54, v22, v82
    v_mul_f32 v32, 0xbbe00000, v3
    v_cos_f32 v64, v32
    v_sin_f32 v82, v32
    s_nop 0
    v_mul_f32 v22, v38, v64
    v_fma_f32 v22, -v70, v82, v22
    v_mul_f32 v70, v70, v64
    v_fmac_f32 v70, v38, v82
    v_mul_f32 v32, 0xbc000000, v3
    v_cos_f32 v64, v32
    v_sin_f32 v82, v32
    s_nop 0
    v_mul_f32 v38, v46, v64
    v_fma_f32 v38, -v78, v82, v38
    v_mul_f32 v78, v78, v64
    v_fmac_f32 v78, v46, v82
    v_mul_f32 v32, 0xbc100000, v3
    v_cos_f32 v64, v32
    v_sin_f32 v82, v32
    s_nop 0
    v_mul_f32 v46, v31, v64
    v_fma_f32 v46, -v63, v82, v46
    v_mul_f32 v63, v63, v64
    v_fmac_f32 v63, v31, v82
    v_mul_f32 v32, 0xbc200000, v3
    v_cos_f32 v64, v32
    v_sin_f32 v82, v32
    s_nop 0
    v_mul_f32 v31, v23, v64
    v_fma_f32 v31, -v55, v82, v31
    v_mul_f32 v55, v55, v64
    v_fmac_f32 v55, v23, v82
    v_mul_f32 v32, 0xbc300000, v3
    v_cos_f32 v64, v32
    v_sin_f32 v82, v32
    s_nop 0
    v_mul_f32 v23, v39, v64
    v_fma_f32 v23, -v71, v82, v23
    v_mul_f32 v71, v71, v64
    v_fmac_f32 v71, v39, v82
    v_mul_f32 v32, 0xbc400000, v3
    v_cos_f32 v64, v32
    v_sin_f32 v82, v32
    s_nop 0
    v_mul_f32 v39, v19, v64
    v_fma_f32 v39, -v51, v82, v39
    v_mul_f32 v51, v51, v64
    v_fmac_f32 v51, v19, v82
    v_mul_f32 v32, 0xbc500000, v3
    v_cos_f32 v64, v32
    v_sin_f32 v82, v32
    s_nop 0
    v_mul_f32 v19, v35, v64
    v_fma_f32 v19, -v67, v82, v19
    v_mul_f32 v67, v67, v64
    v_fmac_f32 v67, v35, v82
    v_mul_f32 v32, 0xbc600000, v3
    v_cos_f32 v64, v32
    v_sin_f32 v82, v32
    s_nop 0
    v_mul_f32 v35, v27, v64
    v_fma_f32 v35, -v59, v82, v35
    v_mul_f32 v59, v59, v64
    v_fmac_f32 v59, v27, v82
    v_mul_f32 v32, 0xbc700000, v3
    v_cos_f32 v64, v32
    v_sin_f32 v82, v32
    s_nop 0
    v_mul_f32 v27, v43, v64
    v_fma_f32 v27, -v75, v82, v27
    v_mul_f32 v75, v75, v64
    v_fmac_f32 v75, v43, v82
    v_mul_f32 v32, 0xbc800000, v3
    v_cos_f32 v64, v32
    v_sin_f32 v82, v32
    s_nop 0
    v_mul_f32 v43, v47, v64
    v_fma_f32 v43, -v79, v82, v43
    v_mul_f32 v79, v79, v64
    v_fmac_f32 v79, v47, v82
    v_mul_f32 v32, 0xbc880000, v3
    v_cos_f32 v64, v32
    v_sin_f32 v82, v32
    s_nop 0
    v_mul_f32 v47, v24, v64
    v_fma_f32 v47, -v56, v82, v47
    v_mul_f32 v56, v56, v64
    v_fmac_f32 v56, v24, v82
    v_mul_f32 v32, 0xbc900000, v3
    v_cos_f32 v64, v32
    v_sin_f32 v82, v32
    s_nop 0
    v_mul_f32 v24, v20, v64
    v_fma_f32 v24, -v52, v82, v24
    v_mul_f32 v52, v52, v64
    v_fmac_f32 v52, v20, v82
    v_mul_f32 v32, 0xbc980000, v3
    v_cos_f32 v64, v32
    v_sin_f32 v82, v32
    s_nop 0
    v_mul_f32 v20, v36, v64
    v_fma_f32 v20, -v68, v82, v20
    v_mul_f32 v68, v68, v64
    v_fmac_f32 v68, v36, v82
    v_mul_f32 v32, 0xbca00000, v3
    v_cos_f32 v64, v32
    v_sin_f32 v82, v32
    s_nop 0
    v_mul_f32 v36, v18, v64
    v_fma_f32 v36, -v50, v82, v36
    v_mul_f32 v50, v50, v64
    v_fmac_f32 v50, v18, v82
    v_mul_f32 v32, 0xbca80000, v3
    v_cos_f32 v64, v32
    v_sin_f32 v82, v32
    s_nop 0
    v_mul_f32 v18, v34, v64
    v_fma_f32 v18, -v66, v82, v18
    v_mul_f32 v66, v66, v64
    v_fmac_f32 v66, v34, v82
    v_mul_f32 v32, 0xbcb00000, v3
    v_cos_f32 v64, v32
    v_sin_f32 v82, v32
    s_nop 0
    v_mul_f32 v34, v26, v64
    v_fma_f32 v34, -v58, v82, v34
    v_mul_f32 v58, v58, v64
    v_fmac_f32 v58, v26, v82
    v_mul_f32 v32, 0xbcb80000, v3
    v_cos_f32 v64, v32
    v_sin_f32 v82, v32
    s_nop 0
    v_mul_f32 v26, v42, v64
    v_fma_f32 v26, -v74, v82, v26
    v_mul_f32 v74, v74, v64
    v_fmac_f32 v74, v42, v82
    v_mul_f32 v32, 0xbcc00000, v3
    v_cos_f32 v64, v32
    v_sin_f32 v82, v32
    s_nop 0
    v_mul_f32 v42, v17, v64
    v_fma_f32 v42, -v49, v82, v42
    v_mul_f32 v49, v49, v64
    v_fmac_f32 v49, v17, v82
    v_mul_f32 v32, 0xbcc80000, v3
    v_cos_f32 v64, v32
    v_sin_f32 v82, v32
    s_nop 0
    v_mul_f32 v17, v33, v64
    v_fma_f32 v17, -v65, v82, v17
    v_mul_f32 v65, v65, v64
    v_fmac_f32 v65, v33, v82
    v_mul_f32 v32, 0xbcd00000, v3
    v_cos_f32 v64, v32
    v_sin_f32 v82, v32
    s_nop 0
    v_mul_f32 v33, v25, v64
    v_fma_f32 v33, -v57, v82, v33
    v_mul_f32 v57, v57, v64
    v_fmac_f32 v57, v25, v82
    v_mul_f32 v32, 0xbcd80000, v3
    v_cos_f32 v64, v32
    v_sin_f32 v82, v32
    s_nop 0
    v_mul_f32 v25, v41, v64
    v_fma_f32 v25, -v73, v82, v25
    v_mul_f32 v73, v73, v64
    v_fmac_f32 v73, v41, v82
    v_mul_f32 v32, 0xbce00000, v3
    v_cos_f32 v64, v32
    v_sin_f32 v82, v32
    s_nop 0
    v_mul_f32 v41, v21, v64
    v_fma_f32 v41, -v53, v82, v41
    v_mul_f32 v53, v53, v64
    v_fmac_f32 v53, v21, v82
    v_mul_f32 v32, 0xbce80000, v3
    v_cos_f32 v64, v32
    v_sin_f32 v82, v32
    s_nop 0
    v_mul_f32 v21, v37, v64
    v_fma_f32 v21, -v69, v82, v21
    v_mul_f32 v69, v69, v64
    v_fmac_f32 v69, v37, v82
    v_mul_f32 v32, 0xbcf00000, v3
    v_cos_f32 v64, v32
    v_sin_f32 v82, v32
    s_nop 0
    v_mul_f32 v37, v29, v64
    v_fma_f32 v37, -v61, v82, v37
    v_mul_f32 v61, v61, v64
    v_fmac_f32 v61, v29, v82
    v_mul_f32 v32, 0xbcf80000, v3
    v_cos_f32 v64, v32
    v_sin_f32 v82, v32
    s_nop 0
    v_mul_f32 v29, v45, v64
    v_fma_f32 v29, -v77, v82, v29
    v_mul_f32 v77, v77, v64
    v_fmac_f32 v77, v45, v82
    ds_write_b32 v4, v16 offset:0
    ds_write_b32 v4, v48 offset:4
    ds_write_b32 v4, v83 offset:264
    ds_write_b32 v4, v81 offset:268
    ds_write_b32 v4, v80 offset:528
    ds_write_b32 v4, v72 offset:532
    ds_write_b32 v4, v40 offset:792
    ds_write_b32 v4, v60 offset:796
    ds_write_b32 v4, v28 offset:1056
    ds_write_b32 v4, v76 offset:1060
    ds_write_b32 v4, v44 offset:1320
    ds_write_b32 v4, v62 offset:1324
    ds_write_b32 v4, v30 offset:1584
    ds_write_b32 v4, v54 offset:1588
    ds_write_b32 v4, v22 offset:1848
    ds_write_b32 v4, v70 offset:1852
    ds_write_b32 v4, v38 offset:2112
    ds_write_b32 v4, v78 offset:2116
    ds_write_b32 v4, v46 offset:2376
    ds_write_b32 v4, v63 offset:2380
    ds_write_b32 v4, v31 offset:2640
    ds_write_b32 v4, v55 offset:2644
    ds_write_b32 v4, v23 offset:2904
    ds_write_b32 v4, v71 offset:2908
    ds_write_b32 v4, v39 offset:3168
    ds_write_b32 v4, v51 offset:3172
    ds_write_b32 v4, v19 offset:3432
    ds_write_b32 v4, v67 offset:3436
    ds_write_b32 v4, v35 offset:3696
    ds_write_b32 v4, v59 offset:3700
    ds_write_b32 v4, v27 offset:3960
    ds_write_b32 v4, v75 offset:3964
    ds_write_b32 v4, v43 offset:4224
    ds_write_b32 v4, v79 offset:4228
    ds_write_b32 v4, v47 offset:4488
    ds_write_b32 v4, v56 offset:4492
    ds_write_b32 v4, v24 offset:4752
    ds_write_b32 v4, v52 offset:4756
    ds_write_b32 v4, v20 offset:5016
    ds_write_b32 v4, v68 offset:5020
    ds_write_b32 v4, v36 offset:5280
    ds_write_b32 v4, v50 offset:5284
    ds_write_b32 v4, v18 offset:5544
    ds_write_b32 v4, v66 offset:5548
    ds_write_b32 v4, v34 offset:5808
    ds_write_b32 v4, v58 offset:5812
    ds_write_b32 v4, v26 offset:6072
    ds_write_b32 v4, v74 offset:6076
    ds_write_b32 v4, v42 offset:6336
    ds_write_b32 v4, v49 offset:6340
    ds_write_b32 v4, v17 offset:6600
    ds_write_b32 v4, v65 offset:6604
    ds_write_b32 v4, v33 offset:6864
    ds_write_b32 v4, v57 offset:6868
    ds_write_b32 v4, v25 offset:7128
    ds_write_b32 v4, v73 offset:7132
    ds_write_b32 v4, v41 offset:7392
    ds_write_b32 v4, v53 offset:7396
    ds_write_b32 v4, v21 offset:7656
    ds_write_b32 v4, v69 offset:7660
    ds_write_b32 v4, v37 offset:7920
    ds_write_b32 v4, v61 offset:7924
    ds_write_b32 v4, v29 offset:8184
    ds_write_b32 v4, v77 offset:8188
    s_waitcnt lgkmcnt(0)
    ds_read_b32 v16, v5 offset:0
    ds_read_b32 v48, v5 offset:4
    ds_read_b32 v83, v5 offset:8
    ds_read_b32 v81, v5 offset:12
    ds_read_b32 v80, v5 offset:16
    ds_read_b32 v72, v5 offset:20
    ds_read_b32 v40, v5 offset:24
    ds_read_b32 v60, v5 offset:28
    ds_read_b32 v28, v5 offset:32
    ds_read_b32 v76, v5 offset:36
    ds_read_b32 v44, v5 offset:40
    ds_read_b32 v62, v5 offset:44
    ds_read_b32 v30, v5 offset:48
    ds_read_b32 v54, v5 offset:52
    s_waitcnt lgkmcnt(0)
    ds_read_b32 v22, v5 offset:56
    ds_read_b32 v70, v5 offset:60
    ds_read_b32 v38, v5 offset:64
    ds_read_b32 v78, v5 offset:68
    ds_read_b32 v46, v5 offset:72
    ds_read_b32 v63, v5 offset:76
    ds_read_b32 v31, v5 offset:80
    ds_read_b32 v55, v5 offset:84
    ds_read_b32 v23, v5 offset:88
    ds_read_b32 v71, v5 offset:92
    ds_read_b32 v39, v5 offset:96
    ds_read_b32 v51, v5 offset:100
    ds_read_b32 v19, v5 offset:104
    ds_read_b32 v67, v5 offset:108
    s_waitcnt lgkmcnt(0)
    ds_read_b32 v35, v5 offset:112
    ds_read_b32 v59, v5 offset:116
    ds_read_b32 v27, v5 offset:120
    ds_read_b32 v75, v5 offset:124
    ds_read_b32 v43, v5 offset:128
    ds_read_b32 v79, v5 offset:132
    ds_read_b32 v47, v5 offset:136
    ds_read_b32 v56, v5 offset:140
    ds_read_b32 v24, v5 offset:144
    ds_read_b32 v52, v5 offset:148
    ds_read_b32 v20, v5 offset:152
    ds_read_b32 v68, v5 offset:156
    ds_read_b32 v36, v5 offset:160
    ds_read_b32 v50, v5 offset:164
    s_waitcnt lgkmcnt(0)
    ds_read_b32 v18, v5 offset:168
    ds_read_b32 v66, v5 offset:172
    ds_read_b32 v34, v5 offset:176
    ds_read_b32 v58, v5 offset:180
    ds_read_b32 v26, v5 offset:184
    ds_read_b32 v74, v5 offset:188
    ds_read_b32 v42, v5 offset:192
    ds_read_b32 v49, v5 offset:196
    ds_read_b32 v17, v5 offset:200
    ds_read_b32 v65, v5 offset:204
    ds_read_b32 v33, v5 offset:208
    ds_read_b32 v57, v5 offset:212
    ds_read_b32 v25, v5 offset:216
    ds_read_b32 v73, v5 offset:220
    s_waitcnt lgkmcnt(0)
    ds_read_b32 v41, v5 offset:224
    ds_read_b32 v53, v5 offset:228
    ds_read_b32 v21, v5 offset:232
    ds_read_b32 v69, v5 offset:236
    ds_read_b32 v37, v5 offset:240
    ds_read_b32 v61, v5 offset:244
    ds_read_b32 v29, v5 offset:248
    ds_read_b32 v77, v5 offset:252
    s_waitcnt lgkmcnt(0)
    v_sub_f32 v32, v16, v43
    v_sub_f32 v64, v48, v79
    v_add_f32 v16, v16, v43
    v_add_f32 v48, v48, v79
    v_sub_f32 v43, v83, v47
    v_sub_f32 v79, v81, v56
    v_add_f32 v83, v83, v47
    v_add_f32 v81, v81, v56
    v_mul_f32 v47, 0x3f7b14be, v43
    v_mul_f32 v56, 0xbe47c5c2, v43
    v_fmac_f32 v47, 0x3e47c5c2, v79
    v_fmac_f32 v56, 0x3f7b14be, v79
    v_sub_f32 v43, v80, v24
    v_sub_f32 v79, v72, v52
    v_add_f32 v80, v80, v24
    v_add_f32 v72, v72, v52
    v_mul_f32 v24, 0x3f6c835e, v43
    v_mul_f32 v52, 0xbec3ef15, v43
    v_fmac_f32 v24, 0x3ec3ef15, v79
    v_fmac_f32 v52, 0x3f6c835e, v79
    v_sub_f32 v43, v40, v20
    v_sub_f32 v79, v60, v68
    v_add_f32 v40, v40, v20
    v_add_f32 v60, v60, v68
    v_mul_f32 v20, 0x3f54db31, v43
    v_mul_f32 v68, 0xbf0e39da, v43
    v_fmac_f32 v20, 0x3f0e39da, v79
    v_fmac_f32 v68, 0x3f54db31, v79
    v_sub_f32 v43, v28, v36
    v_sub_f32 v79, v76, v50
    v_add_f32 v28, v28, v36
    v_add_f32 v76, v76, v50
    v_mul_f32 v36, 0x3f3504f3, v43
    v_mul_f32 v50, 0xbf3504f3, v43
    v_fmac_f32 v36, 0x3f3504f3, v79
    v_fmac_f32 v50, 0x3f3504f3, v79
    v_sub_f32 v43, v44, v18
    v_sub_f32 v79, v62, v66
    v_add_f32 v44, v44, v18
    v_add_f32 v62, v62, v66
    v_mul_f32 v18, 0x3f0e39da, v43
    v_mul_f32 v66, 0xbf54db31, v43
    v_fmac_f32 v18, 0x3f54db31, v79
    v_fmac_f32 v66, 0x3f0e39da, v79
    v_sub_f32 v43, v30, v34
    v_sub_f32 v79, v54, v58
    v_add_f32 v30, v30, v34
    v_add_f32 v54, v54, v58
    v_mul_f32 v34, 0x3ec3ef15, v43
    v_mul_f32 v58, 0xbf6c835e, v43
    v_fmac_f32 v34, 0x3f6c835e, v79
    v_fmac_f32 v58, 0x3ec3ef15, v79
    v_sub_f32 v43, v22, v26
    v_sub_f32 v79, v70, v74
    v_add_f32 v22, v22, v26
    v_add_f32 v70, v70, v74
    v_mul_f32 v26, 0x3e47c5c2, v43
    v_mul_f32 v74, 0xbf7b14be, v43
    v_fmac_f32 v26, 0x3f7b14be, v79
    v_fmac_f32 v74, 0x3e47c5c2, v79
    v_sub_f32 v43, v78, v49
    v_sub_f32 v79, v42, v38
    v_add_f32 v38, v38, v42
    v_add_f32 v78, v78, v49
    v_sub_f32 v42, v46, v17
    v_sub_f32 v49, v63, v65
    v_add_f32 v46, v46, v17
    v_add_f32 v63, v63, v65
    v_mul_f32 v17, 0xbe47c5c2, v42
    v_mul_f32 v65, 0xbf7b14be, v42
    v_fmac_f32 v17, 0x3f7b14be, v49
    v_fmac_f32 v65, 0xbe47c5c2, v49
    v_sub_f32 v42, v31, v33
    v_sub_f32 v49, v55, v57
    v_add_f32 v31, v31, v33
    v_add_f32 v55, v55, v57
    v_mul_f32 v33, 0xbec3ef15, v42
    v_mul_f32 v57, 0xbf6c835e, v42
    v_fmac_f32 v33, 0x3f6c835e, v49
    v_fmac_f32 v57, 0xbec3ef15, v49
    v_sub_f32 v42, v23, v25
    v_sub_f32 v49, v71, v73
    v_add_f32 v23, v23, v25
    v_add_f32 v71, v71, v73
    v_mul_f32 v25, 0xbf0e39da, v42
    v_mul_f32 v73, 0xbf54db31, v42
    v_fmac_f32 v25, 0x3f54db31, v49
    v_fmac_f32 v73, 0xbf0e39da, v49
    v_sub_f32 v42, v39, v41
    v_sub_f32 v49, v51, v53
    v_add_f32 v39, v39, v41
    v_add_f32 v51, v51, v53
    v_mul_f32 v41, 0xbf3504f3, v42
    v_mul_f32 v53, 0xbf3504f3, v42
    v_fmac_f32 v41, 0x3f3504f3, v49
    v_fmac_f32 v53, 0xbf3504f3, v49
    v_sub_f32 v42, v19, v21
    v_sub_f32 v49, v67, v69
    v_add_f32 v19, v19, v21
    v_add_f32 v67, v67, v69
    v_mul_f32 v21, 0xbf54db31, v42
    v_mul_f32 v69, 0xbf0e39da, v42
    v_fmac_f32 v21, 0x3f0e39da, v49
    v_fmac_f32 v69, 0xbf54db31, v49
    v_sub_f32 v42, v35, v37
    v_sub_f32 v49, v59, v61
    v_add_f32 v35, v35, v37
    v_add_f32 v59, v59, v61
    v_mul_f32 v37, 0xbf6c835e, v42
    v_mul_f32 v61, 0xbec3ef15, v42
    v_fmac_f32 v37, 0x3ec3ef15, v49
    v_fmac_f32 v61, 0xbf6c835e, v49
    v_sub_f32 v42, v27, v29
    v_sub_f32 v49, v75, v77
    v_add_f32 v27, v27, v29
    v_add_f32 v75, v75, v77
    v_mul_f32 v29, 0xbf7b14be, v42
    v_mul_f32 v77, 0xbe47c5c2, v42
    v_fmac_f32 v29, 0x3e47c5c2, v49
    v_fmac_f32 v77, 0xbf7b14be, v49
    v_sub_f32 v42, v16, v38
    v_sub_f32 v49, v48, v78
    v_add_f32 v16, v16, v38
    v_add_f32 v48, v48, v78
    v_sub_f32 v38, v83, v46
    v_sub_f32 v78, v81, v63
    v_add_f32 v83, v83, v46
    v_add_f32 v81, v81, v63
    v_mul_f32 v46, 0x3f6c835e, v38
    v_mul_f32 v63, 0xbec3ef15, v38
    v_fmac_f32 v46, 0x3ec3ef15, v78
    v_fmac_f32 v63, 0x3f6c835e, v78
    v_sub_f32 v38, v80, v31
    v_sub_f32 v78, v72, v55
    v_add_f32 v80, v80, v31
    v_add_f32 v72, v72, v55
    v_mul_f32 v31, 0x3f3504f3, v38
    v_mul_f32 v55, 0xbf3504f3, v38
    v_fmac_f32 v31, 0x3f3504f3, v78
    v_fmac_f32 v55, 0x3f3504f3, v78
    v_sub_f32 v38, v40, v23
    v_sub_f32 v78, v60, v71
    v_add_f32 v40, v40, v23
    v_add_f32 v60, v60, v71
    v_mul_f32 v23, 0x3ec3ef15, v38
    v_mul_f32 v71, 0xbf6c835e, v38
    v_fmac_f32 v23, 0x3f6c835e, v78
    v_fmac_f32 v71, 0x3ec3ef15, v78
    v_sub_f32 v38, v76, v51
    v_sub_f32 v78, v39, v28
    v_add_f32 v28, v28, v39
    v_add_f32 v76, v76, v51
    v_sub_f32 v39, v44, v19
    v_sub_f32 v51, v62, v67
    v_add_f32 v44, v44, v19
    v_add_f32 v62, v62, v67
    v_mul_f32 v19, 0xbec3ef15, v39
    v_mul_f32 v67, 0xbf6c835e, v39
    v_fmac_f32 v19, 0x3f6c835e, v51
    v_fmac_f32 v67, 0xbec3ef15, v51
    v_sub_f32 v39, v30, v35
    v_sub_f32 v51, v54, v59
    v_add_f32 v30, v30, v35
    v_add_f32 v54, v54, v59
    v_mul_f32 v35, 0xbf3504f3, v39
    v_mul_f32 v59, 0xbf3504f3, v39
    v_fmac_f32 v35, 0x3f3504f3, v51
    v_fmac_f32 v59, 0xbf3504f3, v51
    v_sub_f32 v39, v22, v27
    v_sub_f32 v51, v70, v75
    v_add_f32 v22, v22, v27
    v_add_f32 v70, v70, v75
    v_mul_f32 v27, 0xbf6c835e, v39
    v_mul_f32 v75, 0xbec3ef15, v39
    v_fmac_f32 v27, 0x3ec3ef15, v51
    v_fmac_f32 v75, 0xbf6c835e, v51
    v_sub_f32 v39, v32, v43
    v_sub_f32 v51, v64, v79
    v_add_f32 v32, v32, v43
    v_add_f32 v64, v64, v79
    v_sub_f32 v43, v47, v17
    v_sub_f32 v79, v56, v65
    v_add_f32 v47, v47, v17
    v_add_f32 v56, v56, v65
    v_mul_f32 v17, 0x3f6c835e, v43
    v_mul_f32 v65, 0xbec3ef15, v43
    v_fmac_f32 v17, 0x3ec3ef15, v79
    v_fmac_f32 v65, 0x3f6c835e, v79
    v_sub_f32 v43, v24, v33
    v_sub_f32 v79, v52, v57
    v_add_f32 v24, v24, v33
    v_add_f32 v52, v52, v57
    v_mul_f32 v33, 0x3f3504f3, v43
    v_mul_f32 v57, 0xbf3504f3, v43
    v_fmac_f32 v33, 0x3f3504f3, v79
    v_fmac_f32 v57, 0x3f3504f3, v79
    v_sub_f32 v43, v20, v25
    v_sub_f32 v79, v68, v73
    v_add_f32 v20, v20, v25
    v_add_f32 v68, v68, v73
    v_mul_f32 v25, 0x3ec3ef15, v43
    v_mul_f32 v73, 0xbf6c835e, v43
    v_fmac_f32 v25, 0x3f6c835e, v79
    v_fmac_f32 v73, 0x3ec3ef15, v79
    v_sub_f32 v43, v50, v53
    v_sub_f32 v79, v41, v36
    v_add_f32 v36, v36, v41
    v_add_f32 v50, v50, v53
    v_sub_f32 v41, v18, v21
    v_sub_f32 v53, v66, v69
    v_add_f32 v18, v18, v21
    v_add_f32 v66, v66, v69
    v_mul_f32 v21, 0xbec3ef15, v41
    v_mul_f32 v69, 0xbf6c835e, v41
    v_fmac_f32 v21, 0x3f6c835e, v53
    v_fmac_f32 v69, 0xbec3ef15, v53
    v_sub_f32 v41, v34, v37
    v_sub_f32 v53, v58, v61
    v_add_f32 v34, v34, v37
    v_add_f32 v58, v58, v61
    v_mul_f32 v37, 0xbf3504f3, v41
    v_mul_f32 v61, 0xbf3504f3, v41
    v_fmac_f32 v37, 0x3f3504f3, v53
    v_fmac_f32 v61, 0xbf3504f3, v53
    v_sub_f32 v41, v26, v29
    v_sub_f32 v53, v74, v77
    v_add_f32 v26, v26, v29
    v_add_f32 v74, v74, v77
    v_mul_f32 v29, 0xbf6c835e, v41
    v_mul_f32 v77, 0xbec3ef15, v41
    v_fmac_f32 v29, 0x3ec3ef15, v53
    v_fmac_f32 v77, 0xbf6c835e, v53
    v_sub_f32 v41, v16, v28
    v_sub_f32 v53, v48, v76
    v_add_f32 v16, v16, v28
    v_add_f32 v48, v48, v76
    v_sub_f32 v28, v83, v44
    v_sub_f32 v76, v81, v62
    v_add_f32 v83, v83, v44
    v_add_f32 v81, v81, v62
    v_mul_f32 v44, 0x3f3504f3, v28
    v_mul_f32 v62, 0xbf3504f3, v28
    v_fmac_f32 v44, 0x3f3504f3, v76
    v_fmac_f32 v62, 0x3f3504f3, v76
    v_sub_f32 v28, v72, v54
    v_sub_f32 v76, v30, v80
    v_add_f32 v80, v80, v30
    v_add_f32 v72, v72, v54
    v_sub_f32 v30, v40, v22
    v_sub_f32 v54, v60, v70
    v_add_f32 v40, v40, v22
    v_add_f32 v60, v60, v70
    v_mul_f32 v22, 0xbf3504f3, v30
    v_mul_f32 v70, 0xbf3504f3, v30
    v_fmac_f32 v22, 0x3f3504f3, v54
    v_fmac_f32 v70, 0xbf3504f3, v54
    v_sub_f32 v30, v42, v38
    v_sub_f32 v54, v49, v78
    v_add_f32 v42, v42, v38
    v_add_f32 v49, v49, v78
    v_sub_f32 v38, v46, v19
    v_sub_f32 v78, v63, v67
    v_add_f32 v46, v46, v19
    v_add_f32 v63, v63, v67
    v_mul_f32 v19, 0x3f3504f3, v38
    v_mul_f32 v67, 0xbf3504f3, v38
    v_fmac_f32 v19, 0x3f3504f3, v78
    v_fmac_f32 v67, 0x3f3504f3, v78
    v_sub_f32 v38, v55, v59
    v_sub_f32 v78, v35, v31
    v_add_f32 v31, v31, v35
    v_add_f32 v55, v55, v59
    v_sub_f32 v35, v23, v27
    v_sub_f32 v59, v71, v75
    v_add_f32 v23, v23, v27
    v_add_f32 v71, v71, v75
    v_mul_f32 v27, 0xbf3504f3, v35
    v_mul_f32 v75, 0xbf3504f3, v35
    v_fmac_f32 v27, 0x3f3504f3, v59
    v_fmac_f32 v75, 0xbf3504f3, v59
    v_sub_f32 v35, v32, v36
    v_sub_f32 v59, v64, v50
    v_add_f32 v32, v32, v36
    v_add_f32 v64, v64, v50
    v_sub_f32 v36, v47, v18
    v_sub_f32 v50, v56, v66
    v_add_f32 v47, v47, v18
    v_add_f32 v56, v56, v66
    v_mul_f32 v18, 0x3f3504f3, v36
    v_mul_f32 v66, 0xbf3504f3, v36
    v_fmac_f32 v18, 0x3f3504f3, v50
    v_fmac_f32 v66, 0x3f3504f3, v50
    v_sub_f32 v36, v52, v58
    v_sub_f32 v50, v34, v24
    v_add_f32 v24, v24, v34
    v_add_f32 v52, v52, v58
    v_sub_f32 v34, v20, v26
    v_sub_f32 v58, v68, v74
    v_add_f32 v20, v20, v26
    v_add_f32 v68, v68, v74
    v_mul_f32 v26, 0xbf3504f3, v34
    v_mul_f32 v74, 0xbf3504f3, v34
    v_fmac_f32 v26, 0x3f3504f3, v58
    v_fmac_f32 v74, 0xbf3504f3, v58
    v_sub_f32 v34, v39, v43
    v_sub_f32 v58, v51, v79
    v_add_f32 v39, v39, v43
    v_add_f32 v51, v51, v79
    v_sub_f32 v43, v17, v21
    v_sub_f32 v79, v65, v69
    v_add_f32 v17, v17, v21
    v_add_f32 v65, v65, v69
    v_mul_f32 v21, 0x3f3504f3, v43
    v_mul_f32 v69, 0xbf3504f3, v43
    v_fmac_f32 v21, 0x3f3504f3, v79
    v_fmac_f32 v69, 0x3f3504f3, v79
    v_sub_f32 v43, v57, v61
    v_sub_f32 v79, v37, v33
    v_add_f32 v33, v33, v37
    v_add_f32 v57, v57, v61
    v_sub_f32 v37, v25, v29
    v_sub_f32 v61, v73, v77
    v_add_f32 v25, v25, v29
    v_add_f32 v73, v73, v77
    v_mul_f32 v29, 0xbf3504f3, v37
    v_mul_f32 v77, 0xbf3504f3, v37
    v_fmac_f32 v29, 0x3f3504f3, v61
    v_fmac_f32 v77, 0xbf3504f3, v61
    v_sub_f32 v37, v16, v80
    v_sub_f32 v61, v48, v72
    v_add_f32 v16, v16, v80
    v_add_f32 v48, v48, v72
    v_sub_f32 v80, v81, v60
    v_sub_f32 v72, v40, v83
    v_add_f32 v83, v83, v40
    v_add_f32 v81, v81, v60
    v_sub_f32 v40, v41, v28
    v_sub_f32 v60, v53, v76
    v_add_f32 v41, v41, v28
    v_add_f32 v53, v53, v76
    v_sub_f32 v28, v62, v70
    v_sub_f32 v76, v22, v44
    v_add_f32 v44, v44, v22
    v_add_f32 v62, v62, v70
    v_sub_f32 v22, v42, v31
    v_sub_f32 v70, v49, v55
    v_add_f32 v42, v42, v31
    v_add_f32 v49, v49, v55
    v_sub_f32 v31, v63, v71
    v_sub_f32 v55, v23, v46
    v_add_f32 v46, v46, v23
    v_add_f32 v63, v63, v71
    v_sub_f32 v23, v30, v38
    v_sub_f32 v71, v54, v78
    v_add_f32 v30, v30, v38
    v_add_f32 v54, v54, v78
    v_sub_f32 v38, v67, v75
    v_sub_f32 v78, v27, v19
    v_add_f32 v19, v19, v27
    v_add_f32 v67, v67, v75
    v_sub_f32 v27, v32, v24
    v_sub_f32 v75, v64, v52
    v_add_f32 v32, v32, v24
    v_add_f32 v64, v64, v52
    v_sub_f32 v24, v56, v68
    v_sub_f32 v52, v20, v47
    v_add_f32 v47, v47, v20
    v_add_f32 v56, v56, v68
    v_sub_f32 v20, v35, v36
    v_sub_f32 v68, v59, v50
    v_add_f32 v35, v35, v36
    v_add_f32 v59, v59, v50
    v_sub_f32 v36, v66, v74
    v_sub_f32 v50, v26, v18
    v_add_f32 v18, v18, v26
    v_add_f32 v66, v66, v74
    v_sub_f32 v26, v39, v33
    v_sub_f32 v74, v51, v57
    v_add_f32 v39, v39, v33
    v_add_f32 v51, v51, v57
    v_sub_f32 v33, v65, v73
    v_sub_f32 v57, v25, v17
    v_add_f32 v17, v17, v25
    v_add_f32 v65, v65, v73
    v_sub_f32 v25, v34, v43
    v_sub_f32 v73, v58, v79
    v_add_f32 v34, v34, v43
    v_add_f32 v58, v58, v79
    v_sub_f32 v43, v69, v77
    v_sub_f32 v79, v29, v21
    v_add_f32 v21, v21, v29
    v_add_f32 v69, v69, v77
    v_sub_f32 v29, v16, v83
    v_sub_f32 v77, v48, v81
    v_add_f32 v16, v16, v83
    v_add_f32 v48, v48, v81
    v_sub_f32 v83, v37, v80
    v_sub_f32 v81, v61, v72
    v_add_f32 v37, v37, v80
    v_add_f32 v61, v61, v72
    v_sub_f32 v80, v41, v44
    v_sub_f32 v72, v53, v62
    v_add_f32 v41, v41, v44
    v_add_f32 v53, v53, v62
    v_sub_f32 v44, v40, v28
    v_sub_f32 v62, v60, v76
    v_add_f32 v40, v40, v28
    v_add_f32 v60, v60, v76
    v_sub_f32 v28, v42, v46
    v_sub_f32 v76, v49, v63
    v_add_f32 v42, v42, v46
    v_add_f32 v49, v49, v63
    v_sub_f32 v46, v22, v31
    v_sub_f32 v63, v70, v55
    v_add_f32 v22, v22, v31
    v_add_f32 v70, v70, v55
    v_sub_f32 v31, v30, v19
    v_sub_f32 v55, v54, v67
    v_add_f32 v30, v30, v19
    v_add_f32 v54, v54, v67
    v_sub_f32 v19, v23, v38
    v_sub_f32 v67, v71, v78
    v_add_f32 v23, v23, v38
    v_add_f32 v71, v71, v78
    v_sub_f32 v38, v32, v47
    v_sub_f32 v78, v64, v56
    v_add_f32 v32, v32, v47
    v_add_f32 v64, v64, v56
    v_sub_f32 v47, v27, v24
    v_sub_f32 v56, v75, v52
    v_add_f32 v27, v27, v24
    v_add_f32 v75, v75, v52
    v_sub_f32 v24, v35, v18
    v_sub_f32 v52, v59, v66
    v_add_f32 v35, v35, v18
    v_add_f32 v59, v59, v66
    v_sub_f32 v18, v20, v36
    v_sub_f32 v66, v68, v50
    v_add_f32 v20, v20, v36
    v_add_f32 v68, v68, v50
    v_sub_f32 v36, v39, v17
    v_sub_f32 v50, v51, v65
    v_add_f32 v39, v39, v17
    v_add_f32 v51, v51, v65
    v_sub_f32 v17, v26, v33
    v_sub_f32 v65, v74, v57
    v_add_f32 v26, v26, v33
    v_add_f32 v74, v74, v57
    v_sub_f32 v33, v34, v21
    v_sub_f32 v57, v58, v69
    v_add_f32 v34, v34, v21
    v_add_f32 v58, v58, v69
    v_sub_f32 v21, v25, v43
    v_sub_f32 v69, v73, v79
    v_add_f32 v25, v25, v43
    v_add_f32 v73, v73, v79
    ds_write_b32 v4, v16 offset:0
    ds_write_b32 v4, v48 offset:4
    ds_write_b32 v4, v32 offset:256
    ds_write_b32 v4, v64 offset:260
    ds_write_b32 v4, v42 offset:512
    ds_write_b32 v4, v49 offset:516
    ds_write_b32 v4, v39 offset:768
    ds_write_b32 v4, v51 offset:772
    ds_write_b32 v4, v41 offset:1024
    ds_write_b32 v4, v53 offset:1028
    ds_write_b32 v4, v35 offset:1280
    ds_write_b32 v4, v59 offset:1284
    ds_write_b32 v4, v30 offset:1536
    ds_write_b32 v4, v54 offset:1540
    ds_write_b32 v4, v34 offset:1792
    ds_write_b32 v4, v58 offset:1796
    ds_write_b32 v4, v37 offset:2048
    ds_write_b32 v4, v61 offset:2052
    ds_write_b32 v4, v27 offset:2304
    ds_write_b32 v4, v75 offset:2308
    ds_write_b32 v4, v22 offset:2560
    ds_write_b32 v4, v70 offset:2564
    ds_write_b32 v4, v26 offset:2816
    ds_write_b32 v4, v74 offset:2820
    ds_write_b32 v4, v40 offset:3072
    ds_write_b32 v4, v60 offset:3076
    ds_write_b32 v4, v20 offset:3328
    ds_write_b32 v4, v68 offset:3332
    ds_write_b32 v4, v23 offset:3584
    ds_write_b32 v4, v71 offset:3588
    ds_write_b32 v4, v25 offset:3840
    ds_write_b32 v4, v73 offset:3844
    ds_write_b32 v4, v29 offset:4096
    ds_write_b32 v4, v77 offset:4100
    ds_write_b32 v4, v38 offset:4352
    ds_write_b32 v4, v78 offset:4356
    ds_write_b32 v4, v28 offset:4608
    ds_write_b32 v4, v76 offset:4612
    ds_write_b32 v4, v36 offset:4864
    ds_write_b32 v4, v50 offset:4868
    ds_write_b32 v4, v80 offset:5120
    ds_write_b32 v4, v72 offset:5124
    ds_write_b32 v4, v24 offset:5376
    ds_write_b32 v4, v52 offset:5380
    ds_write_b32 v4, v31 offset:5632
    ds_write_b32 v4, v55 offset:5636
    ds_write_b32 v4, v33 offset:5888
    ds_write_b32 v4, v57 offset:5892
    ds_write_b32 v4, v83 offset:6144
    ds_write_b32 v4, v81 offset:6148
    ds_write_b32 v4, v47 offset:6400
    ds_write_b32 v4, v56 offset:6404
    ds_write_b32 v4, v46 offset:6656
    ds_write_b32 v4, v63 offset:6660
    ds_write_b32 v4, v17 offset:6912
    ds_write_b32 v4, v65 offset:6916
    ds_write_b32 v4, v44 offset:7168
    ds_write_b32 v4, v62 offset:7172
    ds_write_b32 v4, v18 offset:7424
    ds_write_b32 v4, v66 offset:7428
    ds_write_b32 v4, v19 offset:7680
    ds_write_b32 v4, v67 offset:7684
    ds_write_b32 v4, v21 offset:7936
    ds_write_b32 v4, v69 offset:7940
    s_waitcnt lgkmcnt(0)
    s_barrier
    s_add_u32 m0, s56, 0
    s_add_u32 s58, s57, 0
    s_and_b32 s58, s58, 0xffff
    s_lshl_b32 s58, s58, 5
    buffer_load_dwordx4 v200, s[52:55], s58 offen lds
    s_add_u32 m0, s56, 1024
    s_add_u32 s58, s57, 1024
    s_and_b32 s58, s58, 0xffff
    s_lshl_b32 s58, s58, 5
    buffer_load_dwordx4 v200, s[52:55], s58 offen lds
    s_add_u32 m0, s56, 2048
    s_add_u32 s58, s57, 2048
    s_and_b32 s58, s58, 0xffff
    s_lshl_b32 s58, s58, 5
    buffer_load_dwordx4 v200, s[52:55], s58 offen lds
    s_add_u32 m0, s56, 3072
    s_add_u32 s58, s57, 3072
    s_and_b32 s58, s58, 0xffff
    s_lshl_b32 s58, s58, 5
    buffer_load_dwordx4 v200, s[52:55], s58 offen lds
    s_add_u32 m0, s56, 4096
    s_add_u32 s58, s57, 4096
    s_and_b32 s58, s58, 0xffff
    s_lshl_b32 s58, s58, 5
    buffer_load_dwordx4 v200, s[52:55], s58 offen lds
    s_add_u32 m0, s56, 5120
    s_add_u32 s58, s57, 5120
    s_and_b32 s58, s58, 0xffff
    s_lshl_b32 s58, s58, 5
    buffer_load_dwordx4 v200, s[52:55], s58 offen lds
    s_add_u32 m0, s56, 6144
    s_add_u32 s58, s57, 6144
    s_and_b32 s58, s58, 0xffff
    s_lshl_b32 s58, s58, 5
    buffer_load_dwordx4 v200, s[52:55], s58 offen lds
    s_add_u32 m0, s56, 7168
    s_add_u32 s58, s57, 7168
    s_and_b32 s58, s58, 0xffff
    s_lshl_b32 s58, s58, 5
    buffer_load_dwordx4 v200, s[52:55], s58 offen lds
    s_add_u32 m0, s56, 8192
    s_add_u32 s58, s57, 8192
    s_and_b32 s58, s58, 0xffff
    s_lshl_b32 s58, s58, 5
    buffer_load_dwordx4 v200, s[52:55], s58 offen lds
    s_add_u32 m0, s56, 9216
    s_add_u32 s58, s57, 9216
    s_and_b32 s58, s58, 0xffff
    s_lshl_b32 s58, s58, 5
    buffer_load_dwordx4 v200, s[52:55], s58 offen lds
    s_add_u32 m0, s56, 10240
    s_add_u32 s58, s57, 10240
    s_and_b32 s58, s58, 0xffff
    s_lshl_b32 s58, s58, 5
    buffer_load_dwordx4 v200, s[52:55], s58 offen lds
    s_add_u32 m0, s56, 11264
    s_add_u32 s58, s57, 11264
    s_and_b32 s58, s58, 0xffff
    s_lshl_b32 s58, s58, 5
    buffer_load_dwordx4 v200, s[52:55], s58 offen lds
    s_add_u32 m0, s56, 12288
    s_add_u32 s58, s57, 12288
    s_and_b32 s58, s58, 0xffff
    s_lshl_b32 s58, s58, 5
    buffer_load_dwordx4 v200, s[52:55], s58 offen lds
    s_add_u32 m0, s56, 13312
    s_add_u32 s58, s57, 13312
    s_and_b32 s58, s58, 0xffff
    s_lshl_b32 s58, s58, 5
    buffer_load_dwordx4 v200, s[52:55], s58 offen lds
    s_add_u32 m0, s56, 14336
    s_add_u32 s58, s57, 14336
    s_and_b32 s58, s58, 0xffff
    s_lshl_b32 s58, s58, 5
    buffer_load_dwordx4 v200, s[52:55], s58 offen lds
    s_add_u32 m0, s56, 15360
    s_add_u32 s58, s57, 15360
    s_and_b32 s58, s58, 0xffff
    s_lshl_b32 s58, s58, 5
    buffer_load_dwordx4 v200, s[52:55], s58 offen lds
    v_and_b32 v6, 7, v0
    v_lshrrev_b32 v7, 3, v0
    s_movk_i32 s13, 8448
    v_mul_lo_u32 v8, v6, s13
    v_lshl_add_u32 v4, v7, 3, v8
    v_lshlrev_b32 v5, 14, v7
    v_lshl_add_u32 v5, v6, 4, v5
    s_lshl_b32 s12, s92, 7
    s_add_u32 s12, s12, 96468992
    v_sub_u32 v6, 1024, v7
    v_and_b32 v6, 1023, v6
    v_lshl_add_u32 v6, v6, 3, v8
    ds_read_b64 v[16:17], v4 offset:0
    ds_read_b64 v[18:19], v6
    s_waitcnt lgkmcnt(0)
    v_add_f32 v20, v16, v18
    v_sub_f32 v21, v17, v19
    v_add_f32 v22, v17, v19
    v_sub_f32 v23, v18, v16
    s_mov_b32 s13, s12
    s_add_u32 s13, s12, 0
    buffer_store_dwordx4 v[20:23], v5, s[8:11], s13 offen sc1
    s_nop 1
    v_sub_u32 v6, 992, v7
    v_and_b32 v6, 1023, v6
    v_lshl_add_u32 v6, v6, 3, v8
    ds_read_b64 v[16:17], v4 offset:256
    ds_read_b64 v[18:19], v6
    s_waitcnt lgkmcnt(0)
    v_add_f32 v20, v16, v18
    v_sub_f32 v21, v17, v19
    v_add_f32 v22, v17, v19
    v_sub_f32 v23, v18, v16
    s_mov_b32 s13, s12
    s_add_u32 s13, s12, 524288
    buffer_store_dwordx4 v[20:23], v5, s[8:11], s13 offen sc1
    s_nop 1
    v_sub_u32 v6, 960, v7
    v_and_b32 v6, 1023, v6
    v_lshl_add_u32 v6, v6, 3, v8
    ds_read_b64 v[16:17], v4 offset:512
    ds_read_b64 v[18:19], v6
    s_waitcnt lgkmcnt(0)
    v_add_f32 v20, v16, v18
    v_sub_f32 v21, v17, v19
    v_add_f32 v22, v17, v19
    v_sub_f32 v23, v18, v16
    s_mov_b32 s13, s12
    s_add_u32 s13, s12, 1048576
    buffer_store_dwordx4 v[20:23], v5, s[8:11], s13 offen sc1
    s_nop 1
    v_sub_u32 v6, 928, v7
    v_and_b32 v6, 1023, v6
    v_lshl_add_u32 v6, v6, 3, v8
    ds_read_b64 v[16:17], v4 offset:768
    ds_read_b64 v[18:19], v6
    s_waitcnt lgkmcnt(0)
    v_add_f32 v20, v16, v18
    v_sub_f32 v21, v17, v19
    v_add_f32 v22, v17, v19
    v_sub_f32 v23, v18, v16
    s_mov_b32 s13, s12
    s_add_u32 s13, s12, 1572864
    buffer_store_dwordx4 v[20:23], v5, s[8:11], s13 offen sc1
    s_nop 1
    v_sub_u32 v6, 896, v7
    v_and_b32 v6, 1023, v6
    v_lshl_add_u32 v6, v6, 3, v8
    ds_read_b64 v[16:17], v4 offset:1024
    ds_read_b64 v[18:19], v6
    s_waitcnt lgkmcnt(0)
    v_add_f32 v20, v16, v18
    v_sub_f32 v21, v17, v19
    v_add_f32 v22, v17, v19
    v_sub_f32 v23, v18, v16
    s_mov_b32 s13, s12
    s_add_u32 s13, s12, 2097152
    buffer_store_dwordx4 v[20:23], v5, s[8:11], s13 offen sc1
    s_nop 1
    v_sub_u32 v6, 864, v7
    v_and_b32 v6, 1023, v6
    v_lshl_add_u32 v6, v6, 3, v8
    ds_read_b64 v[16:17], v4 offset:1280
    ds_read_b64 v[18:19], v6
    s_waitcnt lgkmcnt(0)
    v_add_f32 v20, v16, v18
    v_sub_f32 v21, v17, v19
    v_add_f32 v22, v17, v19
    v_sub_f32 v23, v18, v16
    s_mov_b32 s13, s12
    s_add_u32 s13, s12, 2621440
    buffer_store_dwordx4 v[20:23], v5, s[8:11], s13 offen sc1
    s_nop 1
    v_sub_u32 v6, 832, v7
    v_and_b32 v6, 1023, v6
    v_lshl_add_u32 v6, v6, 3, v8
    ds_read_b64 v[16:17], v4 offset:1536
    ds_read_b64 v[18:19], v6
    s_waitcnt lgkmcnt(0)
    v_add_f32 v20, v16, v18
    v_sub_f32 v21, v17, v19
    v_add_f32 v22, v17, v19
    v_sub_f32 v23, v18, v16
    s_mov_b32 s13, s12
    s_add_u32 s13, s12, 3145728
    buffer_store_dwordx4 v[20:23], v5, s[8:11], s13 offen sc1
    s_nop 1
    v_sub_u32 v6, 800, v7
    v_and_b32 v6, 1023, v6
    v_lshl_add_u32 v6, v6, 3, v8
    ds_read_b64 v[16:17], v4 offset:1792
    ds_read_b64 v[18:19], v6
    s_waitcnt lgkmcnt(0)
    v_add_f32 v20, v16, v18
    v_sub_f32 v21, v17, v19
    v_add_f32 v22, v17, v19
    v_sub_f32 v23, v18, v16
    s_mov_b32 s13, s12
    s_add_u32 s13, s12, 3670016
    buffer_store_dwordx4 v[20:23], v5, s[8:11], s13 offen sc1
    s_nop 1
    v_sub_u32 v6, 768, v7
    v_and_b32 v6, 1023, v6
    v_lshl_add_u32 v6, v6, 3, v8
    ds_read_b64 v[16:17], v4 offset:2048
    ds_read_b64 v[18:19], v6
    s_waitcnt lgkmcnt(0)
    v_add_f32 v20, v16, v18
    v_sub_f32 v21, v17, v19
    v_add_f32 v22, v17, v19
    v_sub_f32 v23, v18, v16
    s_mov_b32 s13, s12
    s_add_u32 s13, s12, 4194304
    buffer_store_dwordx4 v[20:23], v5, s[8:11], s13 offen sc1
    s_nop 1
    v_sub_u32 v6, 736, v7
    v_and_b32 v6, 1023, v6
    v_lshl_add_u32 v6, v6, 3, v8
    ds_read_b64 v[16:17], v4 offset:2304
    ds_read_b64 v[18:19], v6
    s_waitcnt lgkmcnt(0)
    v_add_f32 v20, v16, v18
    v_sub_f32 v21, v17, v19
    v_add_f32 v22, v17, v19
    v_sub_f32 v23, v18, v16
    s_mov_b32 s13, s12
    s_add_u32 s13, s12, 4718592
    buffer_store_dwordx4 v[20:23], v5, s[8:11], s13 offen sc1
    s_nop 1
    v_sub_u32 v6, 704, v7
    v_and_b32 v6, 1023, v6
    v_lshl_add_u32 v6, v6, 3, v8
    ds_read_b64 v[16:17], v4 offset:2560
    ds_read_b64 v[18:19], v6
    s_waitcnt lgkmcnt(0)
    v_add_f32 v20, v16, v18
    v_sub_f32 v21, v17, v19
    v_add_f32 v22, v17, v19
    v_sub_f32 v23, v18, v16
    s_mov_b32 s13, s12
    s_add_u32 s13, s12, 5242880
    buffer_store_dwordx4 v[20:23], v5, s[8:11], s13 offen sc1
    s_nop 1
    v_sub_u32 v6, 672, v7
    v_and_b32 v6, 1023, v6
    v_lshl_add_u32 v6, v6, 3, v8
    ds_read_b64 v[16:17], v4 offset:2816
    ds_read_b64 v[18:19], v6
    s_waitcnt lgkmcnt(0)
    v_add_f32 v20, v16, v18
    v_sub_f32 v21, v17, v19
    v_add_f32 v22, v17, v19
    v_sub_f32 v23, v18, v16
    s_mov_b32 s13, s12
    s_add_u32 s13, s12, 5767168
    buffer_store_dwordx4 v[20:23], v5, s[8:11], s13 offen sc1
    s_nop 1
    v_sub_u32 v6, 640, v7
    v_and_b32 v6, 1023, v6
    v_lshl_add_u32 v6, v6, 3, v8
    ds_read_b64 v[16:17], v4 offset:3072
    ds_read_b64 v[18:19], v6
    s_waitcnt lgkmcnt(0)
    v_add_f32 v20, v16, v18
    v_sub_f32 v21, v17, v19
    v_add_f32 v22, v17, v19
    v_sub_f32 v23, v18, v16
    s_mov_b32 s13, s12
    s_add_u32 s13, s12, 6291456
    buffer_store_dwordx4 v[20:23], v5, s[8:11], s13 offen sc1
    s_nop 1
    v_sub_u32 v6, 608, v7
    v_and_b32 v6, 1023, v6
    v_lshl_add_u32 v6, v6, 3, v8
    ds_read_b64 v[16:17], v4 offset:3328
    ds_read_b64 v[18:19], v6
    s_waitcnt lgkmcnt(0)
    v_add_f32 v20, v16, v18
    v_sub_f32 v21, v17, v19
    v_add_f32 v22, v17, v19
    v_sub_f32 v23, v18, v16
    s_mov_b32 s13, s12
    s_add_u32 s13, s12, 6815744
    buffer_store_dwordx4 v[20:23], v5, s[8:11], s13 offen sc1
    s_nop 1
    v_sub_u32 v6, 576, v7
    v_and_b32 v6, 1023, v6
    v_lshl_add_u32 v6, v6, 3, v8
    ds_read_b64 v[16:17], v4 offset:3584
    ds_read_b64 v[18:19], v6
    s_waitcnt lgkmcnt(0)
    v_add_f32 v20, v16, v18
    v_sub_f32 v21, v17, v19
    v_add_f32 v22, v17, v19
    v_sub_f32 v23, v18, v16
    s_mov_b32 s13, s12
    s_add_u32 s13, s12, 7340032
    buffer_store_dwordx4 v[20:23], v5, s[8:11], s13 offen sc1
    s_nop 1
    v_sub_u32 v6, 544, v7
    v_and_b32 v6, 1023, v6
    v_lshl_add_u32 v6, v6, 3, v8
    ds_read_b64 v[16:17], v4 offset:3840
    ds_read_b64 v[18:19], v6
    s_waitcnt lgkmcnt(0)
    v_add_f32 v20, v16, v18
    v_sub_f32 v21, v17, v19
    v_add_f32 v22, v17, v19
    v_sub_f32 v23, v18, v16
    s_mov_b32 s13, s12
    s_add_u32 s13, s12, 7864320
    buffer_store_dwordx4 v[20:23], v5, s[8:11], s13 offen sc1
    s_nop 1
    v_sub_u32 v6, 512, v7
    v_and_b32 v6, 1023, v6
    v_lshl_add_u32 v6, v6, 3, v8
    ds_read_b64 v[16:17], v4 offset:4096
    ds_read_b64 v[18:19], v6
    s_waitcnt lgkmcnt(0)
    v_add_f32 v20, v16, v18
    v_sub_f32 v21, v17, v19
    v_add_f32 v22, v17, v19
    v_sub_f32 v23, v18, v16
    s_mov_b32 s13, s12
    v_cmp_eq_u32 vcc, 0, v7
    s_and_saveexec_b64 s[14:15], vcc
    s_add_u32 s13, s12, 8388608
    buffer_store_dwordx4 v[20:23], v5, s[8:11], s13 offen sc1
    s_nop 1
    s_mov_b64 exec, -1
    s_waitcnt vmcnt(0)
    s_barrier
    s_cmp_lg_u32 s98, 0
    s_cbranch_scc1 mega_kernel_sg_6
    v_mov_b32 v2, 1
    s_mov_b32 s81, 71360512
    s_mov_b64 exec, 1
    buffer_atomic_add v2, off, s[84:87], s81 sc1
    s_mov_b64 exec, -1
mega_kernel_sg_6:
    s_waitcnt vmcnt(0)
    ds_read_b64_tr_b16 a[0:1], v201 offset:0
    ds_read_b64_tr_b16 a[2:3], v201 offset:256
    ds_read_b64_tr_b16 a[4:5], v201 offset:1024
    ds_read_b64_tr_b16 a[6:7], v201 offset:1280
    ds_read_b64_tr_b16 a[8:9], v201 offset:2048
    ds_read_b64_tr_b16 a[10:11], v201 offset:2304
    ds_read_b64_tr_b16 a[12:13], v201 offset:3072
    ds_read_b64_tr_b16 a[14:15], v201 offset:3328
    s_waitcnt lgkmcnt(0)
    ds_read_b64_tr_b16 a[16:17], v201 offset:4096
    ds_read_b64_tr_b16 a[18:19], v201 offset:4352
    ds_read_b64_tr_b16 a[20:21], v201 offset:5120
    ds_read_b64_tr_b16 a[22:23], v201 offset:5376
    ds_read_b64_tr_b16 a[24:25], v201 offset:6144
    ds_read_b64_tr_b16 a[26:27], v201 offset:6400
    ds_read_b64_tr_b16 a[28:29], v201 offset:7168
    ds_read_b64_tr_b16 a[30:31], v201 offset:7424
    s_waitcnt lgkmcnt(0)
    ds_read_b64_tr_b16 a[32:33], v201 offset:8192
    ds_read_b64_tr_b16 a[34:35], v201 offset:8448
    ds_read_b64_tr_b16 a[36:37], v201 offset:9216
    ds_read_b64_tr_b16 a[38:39], v201 offset:9472
    ds_read_b64_tr_b16 a[40:41], v201 offset:10240
    ds_read_b64_tr_b16 a[42:43], v201 offset:10496
    ds_read_b64_tr_b16 a[44:45], v201 offset:11264
    ds_read_b64_tr_b16 a[46:47], v201 offset:11520
    s_waitcnt lgkmcnt(0)
    ds_read_b64_tr_b16 a[48:49], v201 offset:12288
    ds_read_b64_tr_b16 a[50:51], v201 offset:12544
    ds_read_b64_tr_b16 a[52:53], v201 offset:13312
    ds_read_b64_tr_b16 a[54:55], v201 offset:13568
    ds_read_b64_tr_b16 a[56:57], v201 offset:14336
    ds_read_b64_tr_b16 a[58:59], v201 offset:14592
    ds_read_b64_tr_b16 a[60:61], v201 offset:15360
    ds_read_b64_tr_b16 a[62:63], v201 offset:15616
    s_waitcnt lgkmcnt(0)
    s_add_u32 m0, s56, 0
    s_add_u32 s58, s57, 16384
    s_and_b32 s58, s58, 0xffff
    s_lshl_b32 s58, s58, 5
    buffer_load_dwordx4 v200, s[52:55], s58 offen lds
    s_add_u32 m0, s56, 1024
    s_add_u32 s58, s57, 17408
    s_and_b32 s58, s58, 0xffff
    s_lshl_b32 s58, s58, 5
    buffer_load_dwordx4 v200, s[52:55], s58 offen lds
    s_add_u32 m0, s56, 2048
    s_add_u32 s58, s57, 18432
    s_and_b32 s58, s58, 0xffff
    s_lshl_b32 s58, s58, 5
    buffer_load_dwordx4 v200, s[52:55], s58 offen lds
    s_add_u32 m0, s56, 3072
    s_add_u32 s58, s57, 19456
    s_and_b32 s58, s58, 0xffff
    s_lshl_b32 s58, s58, 5
    buffer_load_dwordx4 v200, s[52:55], s58 offen lds
    s_add_u32 m0, s56, 4096
    s_add_u32 s58, s57, 20480
    s_and_b32 s58, s58, 0xffff
    s_lshl_b32 s58, s58, 5
    buffer_load_dwordx4 v200, s[52:55], s58 offen lds
    s_add_u32 m0, s56, 5120
    s_add_u32 s58, s57, 21504
    s_and_b32 s58, s58, 0xffff
    s_lshl_b32 s58, s58, 5
    buffer_load_dwordx4 v200, s[52:55], s58 offen lds
    s_add_u32 m0, s56, 6144
    s_add_u32 s58, s57, 22528
    s_and_b32 s58, s58, 0xffff
    s_lshl_b32 s58, s58, 5
    buffer_load_dwordx4 v200, s[52:55], s58 offen lds
    s_add_u32 m0, s56, 7168
    s_add_u32 s58, s57, 23552
    s_and_b32 s58, s58, 0xffff
    s_lshl_b32 s58, s58, 5
    buffer_load_dwordx4 v200, s[52:55], s58 offen lds
    s_add_u32 m0, s56, 8192
    s_add_u32 s58, s57, 24576
    s_and_b32 s58, s58, 0xffff
    s_lshl_b32 s58, s58, 5
    buffer_load_dwordx4 v200, s[52:55], s58 offen lds
    s_add_u32 m0, s56, 9216
    s_add_u32 s58, s57, 25600
    s_and_b32 s58, s58, 0xffff
    s_lshl_b32 s58, s58, 5
    buffer_load_dwordx4 v200, s[52:55], s58 offen lds
    s_add_u32 m0, s56, 10240
    s_add_u32 s58, s57, 26624
    s_and_b32 s58, s58, 0xffff
    s_lshl_b32 s58, s58, 5
    buffer_load_dwordx4 v200, s[52:55], s58 offen lds
    s_add_u32 m0, s56, 11264
    s_add_u32 s58, s57, 27648
    s_and_b32 s58, s58, 0xffff
    s_lshl_b32 s58, s58, 5
    buffer_load_dwordx4 v200, s[52:55], s58 offen lds
    s_add_u32 m0, s56, 12288
    s_add_u32 s58, s57, 28672
    s_and_b32 s58, s58, 0xffff
    s_lshl_b32 s58, s58, 5
    buffer_load_dwordx4 v200, s[52:55], s58 offen lds
    s_add_u32 m0, s56, 13312
    s_add_u32 s58, s57, 29696
    s_and_b32 s58, s58, 0xffff
    s_lshl_b32 s58, s58, 5
    buffer_load_dwordx4 v200, s[52:55], s58 offen lds
    s_add_u32 m0, s56, 14336
    s_add_u32 s58, s57, 30720
    s_and_b32 s58, s58, 0xffff
    s_lshl_b32 s58, s58, 5
    buffer_load_dwordx4 v200, s[52:55], s58 offen lds
    s_add_u32 m0, s56, 15360
    s_add_u32 s58, s57, 31744
    s_and_b32 s58, s58, 0xffff
    s_lshl_b32 s58, s58, 5
    buffer_load_dwordx4 v200, s[52:55], s58 offen lds
    s_cmp_lg_u32 s98, 0
    s_cbranch_scc1 mega_kernel_wf1d
    s_mov_b32 s81, 71360512
mega_kernel_wf1:
    buffer_load_dword v120, off, s[84:87], s81 sc1
    s_waitcnt vmcnt(0)
    v_cmp_ne_u32 vcc, 128, v120
    s_cbranch_vccz mega_kernel_wf1d
    s_sleep 6
    s_branch mega_kernel_wf1
mega_kernel_wf1d:
    s_mov_b32 s99, s92
    s_barrier
mega_kernel_f2_in:
    s_load_dwordx2 s[8:9], s[0:1], 96
    v_lshrrev_b32 v5, 6, v0
    v_and_b32 v1, 63, v0
    v_readfirstlane_b32 s12, v5
    s_lshl_b32 s13, s99, 2
    s_add_u32 s13, s13, s12
    s_cmp_ge_u32 s13, 513
    s_cbranch_scc1 mega_kernel_f2_end
    v_cvt_f32_u32 v2, v1
    s_waitcnt lgkmcnt(0)
    s_mov_b32 s10, 268435456
    s_mov_b32 s11, 0x00020000
    s_lshl_b32 s14, s13, 14
    s_add_u32 s15, s14, 96468992
    v_lshlrev_b32 v5, 3, v1
    s_add_u32 s16, s15, 0
    buffer_load_dwordx2 v[16:17], v5, s[8:11], s16 offen
    s_add_u32 s16, s15, 512
    buffer_load_dwordx2 v[18:19], v5, s[8:11], s16 offen
    s_add_u32 s16, s15, 1024
    buffer_load_dwordx2 v[20:21], v5, s[8:11], s16 offen
    s_add_u32 s16, s15, 1536
    buffer_load_dwordx2 v[22:23], v5, s[8:11], s16 offen
    s_add_u32 s16, s15, 2048
    buffer_load_dwordx2 v[24:25], v5, s[8:11], s16 offen
    s_add_u32 s16, s15, 2560
    buffer_load_dwordx2 v[26:27], v5, s[8:11], s16 offen
    s_add_u32 s16, s15, 3072
    buffer_load_dwordx2 v[28:29], v5, s[8:11], s16 offen
    s_add_u32 s16, s15, 3584
    buffer_load_dwordx2 v[30:31], v5, s[8:11], s16 offen
    s_add_u32 s16, s15, 4096
    buffer_load_dwordx2 v[32:33], v5, s[8:11], s16 offen
    s_add_u32 s16, s15, 4608
    buffer_load_dwordx2 v[34:35], v5, s[8:11], s16 offen
    s_add_u32 s16, s15, 5120
    buffer_load_dwordx2 v[36:37], v5, s[8:11], s16 offen
    s_add_u32 s16, s15, 5632
    buffer_load_dwordx2 v[38:39], v5, s[8:11], s16 offen
    s_add_u32 s16, s15, 6144
    buffer_load_dwordx2 v[40:41], v5, s[8:11], s16 offen
    s_add_u32 s16, s15, 6656
    buffer_load_dwordx2 v[42:43], v5, s[8:11], s16 offen
    s_add_u32 s16, s15, 7168
    buffer_load_dwordx2 v[44:45], v5, s[8:11], s16 offen
    s_add_u32 s16, s15, 7680
    buffer_load_dwordx2 v[46:47], v5, s[8:11], s16 offen
    s_add_u32 s16, s15, 8192
    buffer_load_dwordx2 v[48:49], v5, s[8:11], s16 offen
    s_add_u32 s16, s15, 8704
    buffer_load_dwordx2 v[50:51], v5, s[8:11], s16 offen
    s_add_u32 s16, s15, 9216
    buffer_load_dwordx2 v[52:53], v5, s[8:11], s16 offen
    s_add_u32 s16, s15, 9728
    buffer_load_dwordx2 v[54:55], v5, s[8:11], s16 offen
    s_add_u32 s16, s15, 10240
    buffer_load_dwordx2 v[56:57], v5, s[8:11], s16 offen
    s_add_u32 s16, s15, 10752
    buffer_load_dwordx2 v[58:59], v5, s[8:11], s16 offen
    s_add_u32 s16, s15, 11264
    buffer_load_dwordx2 v[60:61], v5, s[8:11], s16 offen
    s_add_u32 s16, s15, 11776
    buffer_load_dwordx2 v[62:63], v5, s[8:11], s16 offen
    s_add_u32 s16, s15, 12288
    buffer_load_dwordx2 v[64:65], v5, s[8:11], s16 offen
    s_add_u32 s16, s15, 12800
    buffer_load_dwordx2 v[66:67], v5, s[8:11], s16 offen
    s_add_u32 s16, s15, 13312
    buffer_load_dwordx2 v[68:69], v5, s[8:11], s16 offen
    s_add_u32 s16, s15, 13824
    buffer_load_dwordx2 v[70:71], v5, s[8:11], s16 offen
    s_add_u32 s16, s15, 14336
    buffer_load_dwordx2 v[72:73], v5, s[8:11], s16 offen
    s_add_u32 s16, s15, 14848
    buffer_load_dwordx2 v[74:75], v5, s[8:11], s16 offen
    s_add_u32 s16, s15, 15360
    buffer_load_dwordx2 v[76:77], v5, s[8:11], s16 offen
    s_add_u32 s16, s15, 15872
    buffer_load_dwordx2 v[78:79], v5, s[8:11], s16 offen
    s_mul_i32 s17, s12, 16896
    v_lshlrev_b32 v3, 3, v1
    v_add_u32 v3, s17, v3
    v_and_b32 v7, 1, v1
    v_lshrrev_b32 v6, 1, v1
    v_cvt_f32_u32 v8, v6
    v_cvt_f32_u32 v10, v7
    s_movk_i32 s18, 528
    v_mul_lo_u32 v4, v6, s18
    v_lshl_add_u32 v4, v7, 3, v4
    v_add_u32 v4, s17, v4
    v_mov_b32 v9, 1.0
    v_fma_f32 v9, v10, -2.0, v9
    v_lshlrev_b32 v5, 12, v7
    v_lshl_add_u32 v11, v6, 2, v5
    s_lshl_b32 s19, s13, 13
    s_add_u32 s19, s19, 121634816
    s_waitcnt vmcnt(0)
    v_sub_f32 v80, v16, v48
    v_sub_f32 v81, v17, v49
    v_add_f32 v16, v16, v48
    v_add_f32 v17, v17, v49
    v_sub_f32 v48, v18, v50
    v_sub_f32 v49, v19, v51
    v_add_f32 v18, v18, v50
    v_add_f32 v19, v19, v51
    v_mul_f32 v50, 0x3f7b14be, v48
    v_mul_f32 v51, 0xbe47c5c2, v48
    v_fmac_f32 v50, 0x3e47c5c2, v49
    v_fmac_f32 v51, 0x3f7b14be, v49
    v_sub_f32 v48, v20, v52
    v_sub_f32 v49, v21, v53
    v_add_f32 v20, v20, v52
    v_add_f32 v21, v21, v53
    v_mul_f32 v52, 0x3f6c835e, v48
    v_mul_f32 v53, 0xbec3ef15, v48
    v_fmac_f32 v52, 0x3ec3ef15, v49
    v_fmac_f32 v53, 0x3f6c835e, v49
    v_sub_f32 v48, v22, v54
    v_sub_f32 v49, v23, v55
    v_add_f32 v22, v22, v54
    v_add_f32 v23, v23, v55
    v_mul_f32 v54, 0x3f54db31, v48
    v_mul_f32 v55, 0xbf0e39da, v48
    v_fmac_f32 v54, 0x3f0e39da, v49
    v_fmac_f32 v55, 0x3f54db31, v49
    v_sub_f32 v48, v24, v56
    v_sub_f32 v49, v25, v57
    v_add_f32 v24, v24, v56
    v_add_f32 v25, v25, v57
    v_mul_f32 v56, 0x3f3504f3, v48
    v_mul_f32 v57, 0xbf3504f3, v48
    v_fmac_f32 v56, 0x3f3504f3, v49
    v_fmac_f32 v57, 0x3f3504f3, v49
    v_sub_f32 v48, v26, v58
    v_sub_f32 v49, v27, v59
    v_add_f32 v26, v26, v58
    v_add_f32 v27, v27, v59
    v_mul_f32 v58, 0x3f0e39da, v48
    v_mul_f32 v59, 0xbf54db31, v48
    v_fmac_f32 v58, 0x3f54db31, v49
    v_fmac_f32 v59, 0x3f0e39da, v49
    v_sub_f32 v48, v28, v60
    v_sub_f32 v49, v29, v61
    v_add_f32 v28, v28, v60
    v_add_f32 v29, v29, v61
    v_mul_f32 v60, 0x3ec3ef15, v48
    v_mul_f32 v61, 0xbf6c835e, v48
    v_fmac_f32 v60, 0x3f6c835e, v49
    v_fmac_f32 v61, 0x3ec3ef15, v49
    v_sub_f32 v48, v30, v62
    v_sub_f32 v49, v31, v63
    v_add_f32 v30, v30, v62
    v_add_f32 v31, v31, v63
    v_mul_f32 v62, 0x3e47c5c2, v48
    v_mul_f32 v63, 0xbf7b14be, v48
    v_fmac_f32 v62, 0x3f7b14be, v49
    v_fmac_f32 v63, 0x3e47c5c2, v49
    v_sub_f32 v48, v33, v65
    v_sub_f32 v49, v64, v32
    v_add_f32 v32, v32, v64
    v_add_f32 v33, v33, v65
    v_sub_f32 v64, v34, v66
    v_sub_f32 v65, v35, v67
    v_add_f32 v34, v34, v66
    v_add_f32 v35, v35, v67
    v_mul_f32 v66, 0xbe47c5c2, v64
    v_mul_f32 v67, 0xbf7b14be, v64
    v_fmac_f32 v66, 0x3f7b14be, v65
    v_fmac_f32 v67, 0xbe47c5c2, v65
    v_sub_f32 v64, v36, v68
    v_sub_f32 v65, v37, v69
    v_add_f32 v36, v36, v68
    v_add_f32 v37, v37, v69
    v_mul_f32 v68, 0xbec3ef15, v64
    v_mul_f32 v69, 0xbf6c835e, v64
    v_fmac_f32 v68, 0x3f6c835e, v65
    v_fmac_f32 v69, 0xbec3ef15, v65
    v_sub_f32 v64, v38, v70
    v_sub_f32 v65, v39, v71
    v_add_f32 v38, v38, v70
    v_add_f32 v39, v39, v71
    v_mul_f32 v70, 0xbf0e39da, v64
    v_mul_f32 v71, 0xbf54db31, v64
    v_fmac_f32 v70, 0x3f54db31, v65
    v_fmac_f32 v71, 0xbf0e39da, v65
    v_sub_f32 v64, v40, v72
    v_sub_f32 v65, v41, v73
    v_add_f32 v40, v40, v72
    v_add_f32 v41, v41, v73
    v_mul_f32 v72, 0xbf3504f3, v64
    v_mul_f32 v73, 0xbf3504f3, v64
    v_fmac_f32 v72, 0x3f3504f3, v65
    v_fmac_f32 v73, 0xbf3504f3, v65
    v_sub_f32 v64, v42, v74
    v_sub_f32 v65, v43, v75
    v_add_f32 v42, v42, v74
    v_add_f32 v43, v43, v75
    v_mul_f32 v74, 0xbf54db31, v64
    v_mul_f32 v75, 0xbf0e39da, v64
    v_fmac_f32 v74, 0x3f0e39da, v65
    v_fmac_f32 v75, 0xbf54db31, v65
    v_sub_f32 v64, v44, v76
    v_sub_f32 v65, v45, v77
    v_add_f32 v44, v44, v76
    v_add_f32 v45, v45, v77
    v_mul_f32 v76, 0xbf6c835e, v64
    v_mul_f32 v77, 0xbec3ef15, v64
    v_fmac_f32 v76, 0x3ec3ef15, v65
    v_fmac_f32 v77, 0xbf6c835e, v65
    v_sub_f32 v64, v46, v78
    v_sub_f32 v65, v47, v79
    v_add_f32 v46, v46, v78
    v_add_f32 v47, v47, v79
    v_mul_f32 v78, 0xbf7b14be, v64
    v_mul_f32 v79, 0xbe47c5c2, v64
    v_fmac_f32 v78, 0x3e47c5c2, v65
    v_fmac_f32 v79, 0xbf7b14be, v65
    v_sub_f32 v64, v16, v32
    v_sub_f32 v65, v17, v33
    v_add_f32 v16, v16, v32
    v_add_f32 v17, v17, v33
    v_sub_f32 v32, v18, v34
    v_sub_f32 v33, v19, v35
    v_add_f32 v18, v18, v34
    v_add_f32 v19, v19, v35
    v_mul_f32 v34, 0x3f6c835e, v32
    v_mul_f32 v35, 0xbec3ef15, v32
    v_fmac_f32 v34, 0x3ec3ef15, v33
    v_fmac_f32 v35, 0x3f6c835e, v33
    v_sub_f32 v32, v20, v36
    v_sub_f32 v33, v21, v37
    v_add_f32 v20, v20, v36
    v_add_f32 v21, v21, v37
    v_mul_f32 v36, 0x3f3504f3, v32
    v_mul_f32 v37, 0xbf3504f3, v32
    v_fmac_f32 v36, 0x3f3504f3, v33
    v_fmac_f32 v37, 0x3f3504f3, v33
    v_sub_f32 v32, v22, v38
    v_sub_f32 v33, v23, v39
    v_add_f32 v22, v22, v38
    v_add_f32 v23, v23, v39
    v_mul_f32 v38, 0x3ec3ef15, v32
    v_mul_f32 v39, 0xbf6c835e, v32
    v_fmac_f32 v38, 0x3f6c835e, v33
    v_fmac_f32 v39, 0x3ec3ef15, v33
    v_sub_f32 v32, v25, v41
    v_sub_f32 v33, v40, v24
    v_add_f32 v24, v24, v40
    v_add_f32 v25, v25, v41
    v_sub_f32 v40, v26, v42
    v_sub_f32 v41, v27, v43
    v_add_f32 v26, v26, v42
    v_add_f32 v27, v27, v43
    v_mul_f32 v42, 0xbec3ef15, v40
    v_mul_f32 v43, 0xbf6c835e, v40
    v_fmac_f32 v42, 0x3f6c835e, v41
    v_fmac_f32 v43, 0xbec3ef15, v41
    v_sub_f32 v40, v28, v44
    v_sub_f32 v41, v29, v45
    v_add_f32 v28, v28, v44
    v_add_f32 v29, v29, v45
    v_mul_f32 v44, 0xbf3504f3, v40
    v_mul_f32 v45, 0xbf3504f3, v40
    v_fmac_f32 v44, 0x3f3504f3, v41
    v_fmac_f32 v45, 0xbf3504f3, v41
    v_sub_f32 v40, v30, v46
    v_sub_f32 v41, v31, v47
    v_add_f32 v30, v30, v46
    v_add_f32 v31, v31, v47
    v_mul_f32 v46, 0xbf6c835e, v40
    v_mul_f32 v47, 0xbec3ef15, v40
    v_fmac_f32 v46, 0x3ec3ef15, v41
    v_fmac_f32 v47, 0xbf6c835e, v41
    v_sub_f32 v40, v80, v48
    v_sub_f32 v41, v81, v49
    v_add_f32 v80, v80, v48
    v_add_f32 v81, v81, v49
    v_sub_f32 v48, v50, v66
    v_sub_f32 v49, v51, v67
    v_add_f32 v50, v50, v66
    v_add_f32 v51, v51, v67
    v_mul_f32 v66, 0x3f6c835e, v48
    v_mul_f32 v67, 0xbec3ef15, v48
    v_fmac_f32 v66, 0x3ec3ef15, v49
    v_fmac_f32 v67, 0x3f6c835e, v49
    v_sub_f32 v48, v52, v68
    v_sub_f32 v49, v53, v69
    v_add_f32 v52, v52, v68
    v_add_f32 v53, v53, v69
    v_mul_f32 v68, 0x3f3504f3, v48
    v_mul_f32 v69, 0xbf3504f3, v48
    v_fmac_f32 v68, 0x3f3504f3, v49
    v_fmac_f32 v69, 0x3f3504f3, v49
    v_sub_f32 v48, v54, v70
    v_sub_f32 v49, v55, v71
    v_add_f32 v54, v54, v70
    v_add_f32 v55, v55, v71
    v_mul_f32 v70, 0x3ec3ef15, v48
    v_mul_f32 v71, 0xbf6c835e, v48
    v_fmac_f32 v70, 0x3f6c835e, v49
    v_fmac_f32 v71, 0x3ec3ef15, v49
    v_sub_f32 v48, v57, v73
    v_sub_f32 v49, v72, v56
    v_add_f32 v56, v56, v72
    v_add_f32 v57, v57, v73
    v_sub_f32 v72, v58, v74
    v_sub_f32 v73, v59, v75
    v_add_f32 v58, v58, v74
    v_add_f32 v59, v59, v75
    v_mul_f32 v74, 0xbec3ef15, v72
    v_mul_f32 v75, 0xbf6c835e, v72
    v_fmac_f32 v74, 0x3f6c835e, v73
    v_fmac_f32 v75, 0xbec3ef15, v73
    v_sub_f32 v72, v60, v76
    v_sub_f32 v73, v61, v77
    v_add_f32 v60, v60, v76
    v_add_f32 v61, v61, v77
    v_mul_f32 v76, 0xbf3504f3, v72
    v_mul_f32 v77, 0xbf3504f3, v72
    v_fmac_f32 v76, 0x3f3504f3, v73
    v_fmac_f32 v77, 0xbf3504f3, v73
    v_sub_f32 v72, v62, v78
    v_sub_f32 v73, v63, v79
    v_add_f32 v62, v62, v78
    v_add_f32 v63, v63, v79
    v_mul_f32 v78, 0xbf6c835e, v72
    v_mul_f32 v79, 0xbec3ef15, v72
    v_fmac_f32 v78, 0x3ec3ef15, v73
    v_fmac_f32 v79, 0xbf6c835e, v73
    v_sub_f32 v72, v16, v24
    v_sub_f32 v73, v17, v25
    v_add_f32 v16, v16, v24
    v_add_f32 v17, v17, v25
    v_sub_f32 v24, v18, v26
    v_sub_f32 v25, v19, v27
    v_add_f32 v18, v18, v26
    v_add_f32 v19, v19, v27
    v_mul_f32 v26, 0x3f3504f3, v24
    v_mul_f32 v27, 0xbf3504f3, v24
    v_fmac_f32 v26, 0x3f3504f3, v25
    v_fmac_f32 v27, 0x3f3504f3, v25
    v_sub_f32 v24, v21, v29
    v_sub_f32 v25, v28, v20
    v_add_f32 v20, v20, v28
    v_add_f32 v21, v21, v29
    v_sub_f32 v28, v22, v30
    v_sub_f32 v29, v23, v31
    v_add_f32 v22, v22, v30
    v_add_f32 v23, v23, v31
    v_mul_f32 v30, 0xbf3504f3, v28
    v_mul_f32 v31, 0xbf3504f3, v28
    v_fmac_f32 v30, 0x3f3504f3, v29
    v_fmac_f32 v31, 0xbf3504f3, v29
    v_sub_f32 v28, v64, v32
    v_sub_f32 v29, v65, v33
    v_add_f32 v64, v64, v32
    v_add_f32 v65, v65, v33
    v_sub_f32 v32, v34, v42
    v_sub_f32 v33, v35, v43
    v_add_f32 v34, v34, v42
    v_add_f32 v35, v35, v43
    v_mul_f32 v42, 0x3f3504f3, v32
    v_mul_f32 v43, 0xbf3504f3, v32
    v_fmac_f32 v42, 0x3f3504f3, v33
    v_fmac_f32 v43, 0x3f3504f3, v33
    v_sub_f32 v32, v37, v45
    v_sub_f32 v33, v44, v36
    v_add_f32 v36, v36, v44
    v_add_f32 v37, v37, v45
    v_sub_f32 v44, v38, v46
    v_sub_f32 v45, v39, v47
    v_add_f32 v38, v38, v46
    v_add_f32 v39, v39, v47
    v_mul_f32 v46, 0xbf3504f3, v44
    v_mul_f32 v47, 0xbf3504f3, v44
    v_fmac_f32 v46, 0x3f3504f3, v45
    v_fmac_f32 v47, 0xbf3504f3, v45
    v_sub_f32 v44, v80, v56
    v_sub_f32 v45, v81, v57
    v_add_f32 v80, v80, v56
    v_add_f32 v81, v81, v57
    v_sub_f32 v56, v50, v58
    v_sub_f32 v57, v51, v59
    v_add_f32 v50, v50, v58
    v_add_f32 v51, v51, v59
    v_mul_f32 v58, 0x3f3504f3, v56
    v_mul_f32 v59, 0xbf3504f3, v56
    v_fmac_f32 v58, 0x3f3504f3, v57
    v_fmac_f32 v59, 0x3f3504f3, v57
    v_sub_f32 v56, v53, v61
    v_sub_f32 v57, v60, v52
    v_add_f32 v52, v52, v60
    v_add_f32 v53, v53, v61
    v_sub_f32 v60, v54, v62
    v_sub_f32 v61, v55, v63
    v_add_f32 v54, v54, v62
    v_add_f32 v55, v55, v63
    v_mul_f32 v62, 0xbf3504f3, v60
    v_mul_f32 v63, 0xbf3504f3, v60
    v_fmac_f32 v62, 0x3f3504f3, v61
    v_fmac_f32 v63, 0xbf3504f3, v61
    v_sub_f32 v60, v40, v48
    v_sub_f32 v61, v41, v49
    v_add_f32 v40, v40, v48
    v_add_f32 v41, v41, v49
    v_sub_f32 v48, v66, v74
    v_sub_f32 v49, v67, v75
    v_add_f32 v66, v66, v74
    v_add_f32 v67, v67, v75
    v_mul_f32 v74, 0x3f3504f3, v48
    v_mul_f32 v75, 0xbf3504f3, v48
    v_fmac_f32 v74, 0x3f3504f3, v49
    v_fmac_f32 v75, 0x3f3504f3, v49
    v_sub_f32 v48, v69, v77
    v_sub_f32 v49, v76, v68
    v_add_f32 v68, v68, v76
    v_add_f32 v69, v69, v77
    v_sub_f32 v76, v70, v78
    v_sub_f32 v77, v71, v79
    v_add_f32 v70, v70, v78
    v_add_f32 v71, v71, v79
    v_mul_f32 v78, 0xbf3504f3, v76
    v_mul_f32 v79, 0xbf3504f3, v76
    v_fmac_f32 v78, 0x3f3504f3, v77
    v_fmac_f32 v79, 0xbf3504f3, v77
    v_sub_f32 v76, v16, v20
    v_sub_f32 v77, v17, v21
    v_add_f32 v16, v16, v20
    v_add_f32 v17, v17, v21
    v_sub_f32 v20, v19, v23
    v_sub_f32 v21, v22, v18
    v_add_f32 v18, v18, v22
    v_add_f32 v19, v19, v23
    v_sub_f32 v22, v72, v24
    v_sub_f32 v23, v73, v25
    v_add_f32 v72, v72, v24
    v_add_f32 v73, v73, v25
    v_sub_f32 v24, v27, v31
    v_sub_f32 v25, v30, v26
    v_add_f32 v26, v26, v30
    v_add_f32 v27, v27, v31
    v_sub_f32 v30, v64, v36
    v_sub_f32 v31, v65, v37
    v_add_f32 v64, v64, v36
    v_add_f32 v65, v65, v37
    v_sub_f32 v36, v35, v39
    v_sub_f32 v37, v38, v34
    v_add_f32 v34, v34, v38
    v_add_f32 v35, v35, v39
    v_sub_f32 v38, v28, v32
    v_sub_f32 v39, v29, v33
    v_add_f32 v28, v28, v32
    v_add_f32 v29, v29, v33
    v_sub_f32 v32, v43, v47
    v_sub_f32 v33, v46, v42
    v_add_f32 v42, v42, v46
    v_add_f32 v43, v43, v47
    v_sub_f32 v46, v80, v52
    v_sub_f32 v47, v81, v53
    v_add_f32 v80, v80, v52
    v_add_f32 v81, v81, v53
    v_sub_f32 v52, v51, v55
    v_sub_f32 v53, v54, v50
    v_add_f32 v50, v50, v54
    v_add_f32 v51, v51, v55
    v_sub_f32 v54, v44, v56
    v_sub_f32 v55, v45, v57
    v_add_f32 v44, v44, v56
    v_add_f32 v45, v45, v57
    v_sub_f32 v56, v59, v63
    v_sub_f32 v57, v62, v58
    v_add_f32 v58, v58, v62
    v_add_f32 v59, v59, v63
    v_sub_f32 v62, v40, v68
    v_sub_f32 v63, v41, v69
    v_add_f32 v40, v40, v68
    v_add_f32 v41, v41, v69
    v_sub_f32 v68, v67, v71
    v_sub_f32 v69, v70, v66
    v_add_f32 v66, v66, v70
    v_add_f32 v67, v67, v71
    v_sub_f32 v70, v60, v48
    v_sub_f32 v71, v61, v49
    v_add_f32 v60, v60, v48
    v_add_f32 v61, v61, v49
    v_sub_f32 v48, v75, v79
    v_sub_f32 v49, v78, v74
    v_add_f32 v74, v74, v78
    v_add_f32 v75, v75, v79
    v_sub_f32 v78, v16, v18
    v_sub_f32 v79, v17, v19
    v_add_f32 v16, v16, v18
    v_add_f32 v17, v17, v19
    v_sub_f32 v18, v76, v20
    v_sub_f32 v19, v77, v21
    v_add_f32 v76, v76, v20
    v_add_f32 v77, v77, v21
    v_sub_f32 v20, v72, v26
    v_sub_f32 v21, v73, v27
    v_add_f32 v72, v72, v26
    v_add_f32 v73, v73, v27
    v_sub_f32 v26, v22, v24
    v_sub_f32 v27, v23, v25
    v_add_f32 v22, v22, v24
    v_add_f32 v23, v23, v25
    v_sub_f32 v24, v64, v34
    v_sub_f32 v25, v65, v35
    v_add_f32 v64, v64, v34
    v_add_f32 v65, v65, v35
    v_sub_f32 v34, v30, v36
    v_sub_f32 v35, v31, v37
    v_add_f32 v30, v30, v36
    v_add_f32 v31, v31, v37
    v_sub_f32 v36, v28, v42
    v_sub_f32 v37, v29, v43
    v_add_f32 v28, v28, v42
    v_add_f32 v29, v29, v43
    v_sub_f32 v42, v38, v32
    v_sub_f32 v43, v39, v33
    v_add_f32 v38, v38, v32
    v_add_f32 v39, v39, v33
    v_sub_f32 v32, v80, v50
    v_sub_f32 v33, v81, v51
    v_add_f32 v80, v80, v50
    v_add_f32 v81, v81, v51
    v_sub_f32 v50, v46, v52
    v_sub_f32 v51, v47, v53
    v_add_f32 v46, v46, v52
    v_add_f32 v47, v47, v53
    v_sub_f32 v52, v44, v58
    v_sub_f32 v53, v45, v59
    v_add_f32 v44, v44, v58
    v_add_f32 v45, v45, v59
    v_sub_f32 v58, v54, v56
    v_sub_f32 v59, v55, v57
    v_add_f32 v54, v54, v56
    v_add_f32 v55, v55, v57
    v_sub_f32 v56, v40, v66
    v_sub_f32 v57, v41, v67
    v_add_f32 v40, v40, v66
    v_add_f32 v41, v41, v67
    v_sub_f32 v66, v62, v68
    v_sub_f32 v67, v63, v69
    v_add_f32 v62, v62, v68
    v_add_f32 v63, v63, v69
    v_sub_f32 v68, v60, v74
    v_sub_f32 v69, v61, v75
    v_add_f32 v60, v60, v74
    v_add_f32 v61, v61, v75
    v_sub_f32 v74, v70, v48
    v_sub_f32 v75, v71, v49
    v_add_f32 v70, v70, v48
    v_add_f32 v71, v71, v49
    v_mul_f32 v48, 0xba000000, v2
    v_cos_f32 v49, v48
    v_sin_f32 v82, v48
    s_nop 0
    v_mul_f32 v83, v80, v49
    v_fma_f32 v83, -v81, v82, v83
    v_mul_f32 v81, v81, v49
    v_fmac_f32 v81, v80, v82
    v_mul_f32 v48, 0xba800000, v2
    v_cos_f32 v49, v48
    v_sin_f32 v82, v48
    s_nop 0
    v_mul_f32 v80, v64, v49
    v_fma_f32 v80, -v65, v82, v80
    v_mul_f32 v65, v65, v49
    v_fmac_f32 v65, v64, v82
    v_mul_f32 v48, 0xbac00000, v2
    v_cos_f32 v49, v48
    v_sin_f32 v82, v48
    s_nop 0
    v_mul_f32 v64, v40, v49
    v_fma_f32 v64, -v41, v82, v64
    v_mul_f32 v41, v41, v49
    v_fmac_f32 v41, v40, v82
    v_mul_f32 v48, 0xbb000000, v2
    v_cos_f32 v49, v48
    v_sin_f32 v82, v48
    s_nop 0
    v_mul_f32 v40, v72, v49
    v_fma_f32 v40, -v73, v82, v40
    v_mul_f32 v73, v73, v49
    v_fmac_f32 v73, v72, v82
    v_mul_f32 v48, 0xbb200000, v2
    v_cos_f32 v49, v48
    v_sin_f32 v82, v48
    s_nop 0
    v_mul_f32 v72, v44, v49
    v_fma_f32 v72, -v45, v82, v72
    v_mul_f32 v45, v45, v49
    v_fmac_f32 v45, v44, v82
    v_mul_f32 v48, 0xbb400000, v2
    v_cos_f32 v49, v48
    v_sin_f32 v82, v48
    s_nop 0
    v_mul_f32 v44, v28, v49
    v_fma_f32 v44, -v29, v82, v44
    v_mul_f32 v29, v29, v49
    v_fmac_f32 v29, v28, v82
    v_mul_f32 v48, 0xbb600000, v2
    v_cos_f32 v49, v48
    v_sin_f32 v82, v48
    s_nop 0
    v_mul_f32 v28, v60, v49
    v_fma_f32 v28, -v61, v82, v28
    v_mul_f32 v61, v61, v49
    v_fmac_f32 v61, v60, v82
    v_mul_f32 v48, 0xbb800000, v2
    v_cos_f32 v49, v48
    v_sin_f32 v82, v48
    s_nop 0
    v_mul_f32 v60, v76, v49
    v_fma_f32 v60, -v77, v82, v60
    v_mul_f32 v77, v77, v49
    v_fmac_f32 v77, v76, v82
    v_mul_f32 v48, 0xbb900000, v2
    v_cos_f32 v49, v48
    v_sin_f32 v82, v48
    s_nop 0
    v_mul_f32 v76, v46, v49
    v_fma_f32 v76, -v47, v82, v76
    v_mul_f32 v47, v47, v49
    v_fmac_f32 v47, v46, v82
    v_mul_f32 v48, 0xbba00000, v2
    v_cos_f32 v49, v48
    v_sin_f32 v82, v48
    s_nop 0
    v_mul_f32 v46, v30, v49
    v_fma_f32 v46, -v31, v82, v46
    v_mul_f32 v31, v31, v49
    v_fmac_f32 v31, v30, v82
    v_mul_f32 v48, 0xbbb00000, v2
    v_cos_f32 v49, v48
    v_sin_f32 v82, v48
    s_nop 0
    v_mul_f32 v30, v62, v49
    v_fma_f32 v30, -v63, v82, v30
    v_mul_f32 v63, v63, v49
    v_fmac_f32 v63, v62, v82
    v_mul_f32 v48, 0xbbc00000, v2
    v_cos_f32 v49, v48
    v_sin_f32 v82, v48
    s_nop 0
    v_mul_f32 v62, v22, v49
    v_fma_f32 v62, -v23, v82, v62
    v_mul_f32 v23, v23, v49
    v_fmac_f32 v23, v22, v82
    v_mul_f32 v48, 0xbbd00000, v2
    v_cos_f32 v49, v48
    v_sin_f32 v82, v48
    s_nop 0
    v_mul_f32 v22, v54, v49
    v_fma_f32 v22, -v55, v82, v22
    v_mul_f32 v55, v55, v49
    v_fmac_f32 v55, v54, v82
    v_mul_f32 v48, 0xbbe00000, v2
    v_cos_f32 v49, v48
    v_sin_f32 v82, v48
    s_nop 0
    v_mul_f32 v54, v38, v49
    v_fma_f32 v54, -v39, v82, v54
    v_mul_f32 v39, v39, v49
    v_fmac_f32 v39, v38, v82
    v_mul_f32 v48, 0xbbf00000, v2
    v_cos_f32 v49, v48
    v_sin_f32 v82, v48
    s_nop 0
    v_mul_f32 v38, v70, v49
    v_fma_f32 v38, -v71, v82, v38
    v_mul_f32 v71, v71, v49
    v_fmac_f32 v71, v70, v82
    v_mul_f32 v48, 0xbc000000, v2
    v_cos_f32 v49, v48
    v_sin_f32 v82, v48
    s_nop 0
    v_mul_f32 v70, v78, v49
    v_fma_f32 v70, -v79, v82, v70
    v_mul_f32 v79, v79, v49
    v_fmac_f32 v79, v78, v82
    v_mul_f32 v48, 0xbc080000, v2
    v_cos_f32 v49, v48
    v_sin_f32 v82, v48
    s_nop 0
    v_mul_f32 v78, v32, v49
    v_fma_f32 v78, -v33, v82, v78
    v_mul_f32 v33, v33, v49
    v_fmac_f32 v33, v32, v82
    v_mul_f32 v48, 0xbc100000, v2
    v_cos_f32 v49, v48
    v_sin_f32 v82, v48
    s_nop 0
    v_mul_f32 v32, v24, v49
    v_fma_f32 v32, -v25, v82, v32
    v_mul_f32 v25, v25, v49
    v_fmac_f32 v25, v24, v82
    v_mul_f32 v48, 0xbc180000, v2
    v_cos_f32 v49, v48
    v_sin_f32 v82, v48
    s_nop 0
    v_mul_f32 v24, v56, v49
    v_fma_f32 v24, -v57, v82, v24
    v_mul_f32 v57, v57, v49
    v_fmac_f32 v57, v56, v82
    v_mul_f32 v48, 0xbc200000, v2
    v_cos_f32 v49, v48
    v_sin_f32 v82, v48
    s_nop 0
    v_mul_f32 v56, v20, v49
    v_fma_f32 v56, -v21, v82, v56
    v_mul_f32 v21, v21, v49
    v_fmac_f32 v21, v20, v82
    v_mul_f32 v48, 0xbc280000, v2
    v_cos_f32 v49, v48
    v_sin_f32 v82, v48
    s_nop 0
    v_mul_f32 v20, v52, v49
    v_fma_f32 v20, -v53, v82, v20
    v_mul_f32 v53, v53, v49
    v_fmac_f32 v53, v52, v82
    v_mul_f32 v48, 0xbc300000, v2
    v_cos_f32 v49, v48
    v_sin_f32 v82, v48
    s_nop 0
    v_mul_f32 v52, v36, v49
    v_fma_f32 v52, -v37, v82, v52
    v_mul_f32 v37, v37, v49
    v_fmac_f32 v37, v36, v82
    v_mul_f32 v48, 0xbc380000, v2
    v_cos_f32 v49, v48
    v_sin_f32 v82, v48
    s_nop 0
    v_mul_f32 v36, v68, v49
    v_fma_f32 v36, -v69, v82, v36
    v_mul_f32 v69, v69, v49
    v_fmac_f32 v69, v68, v82
    v_mul_f32 v48, 0xbc400000, v2
    v_cos_f32 v49, v48
    v_sin_f32 v82, v48
    s_nop 0
    v_mul_f32 v68, v18, v49
    v_fma_f32 v68, -v19, v82, v68
    v_mul_f32 v19, v19, v49
    v_fmac_f32 v19, v18, v82
    v_mul_f32 v48, 0xbc480000, v2
    v_cos_f32 v49, v48
    v_sin_f32 v82, v48
    s_nop 0
    v_mul_f32 v18, v50, v49
    v_fma_f32 v18, -v51, v82, v18
    v_mul_f32 v51, v51, v49
    v_fmac_f32 v51, v50, v82
    v_mul_f32 v48, 0xbc500000, v2
    v_cos_f32 v49, v48
    v_sin_f32 v82, v48
    s_nop 0
    v_mul_f32 v50, v34, v49
    v_fma_f32 v50, -v35, v82, v50
    v_mul_f32 v35, v35, v49
    v_fmac_f32 v35, v34, v82
    v_mul_f32 v48, 0xbc580000, v2
    v_cos_f32 v49, v48
    v_sin_f32 v82, v48
    s_nop 0
    v_mul_f32 v34, v66, v49
    v_fma_f32 v34, -v67, v82, v34
    v_mul_f32 v67, v67, v49
    v_fmac_f32 v67, v66, v82
    v_mul_f32 v48, 0xbc600000, v2
    v_cos_f32 v49, v48
    v_sin_f32 v82, v48
    s_nop 0
    v_mul_f32 v66, v26, v49
    v_fma_f32 v66, -v27, v82, v66
    v_mul_f32 v27, v27, v49
    v_fmac_f32 v27, v26, v82
    v_mul_f32 v48, 0xbc680000, v2
    v_cos_f32 v49, v48
    v_sin_f32 v82, v48
    s_nop 0
    v_mul_f32 v26, v58, v49
    v_fma_f32 v26, -v59, v82, v26
    v_mul_f32 v59, v59, v49
    v_fmac_f32 v59, v58, v82
    v_mul_f32 v48, 0xbc700000, v2
    v_cos_f32 v49, v48
    v_sin_f32 v82, v48
    s_nop 0
    v_mul_f32 v58, v42, v49
    v_fma_f32 v58, -v43, v82, v58
    v_mul_f32 v43, v43, v49
    v_fmac_f32 v43, v42, v82
    v_mul_f32 v48, 0xbc780000, v2
    v_cos_f32 v49, v48
    v_sin_f32 v82, v48
    s_nop 0
    v_mul_f32 v42, v74, v49
    v_fma_f32 v42, -v75, v82, v42
    v_mul_f32 v75, v75, v49
    v_fmac_f32 v75, v74, v82
    ds_write_b32 v3, v16 offset:0
    ds_write_b32 v3, v17 offset:4
    ds_write_b32 v3, v83 offset:528
    ds_write_b32 v3, v81 offset:532
    ds_write_b32 v3, v80 offset:1056
    ds_write_b32 v3, v65 offset:1060
    ds_write_b32 v3, v64 offset:1584
    ds_write_b32 v3, v41 offset:1588
    ds_write_b32 v3, v40 offset:2112
    ds_write_b32 v3, v73 offset:2116
    ds_write_b32 v3, v72 offset:2640
    ds_write_b32 v3, v45 offset:2644
    ds_write_b32 v3, v44 offset:3168
    ds_write_b32 v3, v29 offset:3172
    ds_write_b32 v3, v28 offset:3696
    ds_write_b32 v3, v61 offset:3700
    ds_write_b32 v3, v60 offset:4224
    ds_write_b32 v3, v77 offset:4228
    ds_write_b32 v3, v76 offset:4752
    ds_write_b32 v3, v47 offset:4756
    ds_write_b32 v3, v46 offset:5280
    ds_write_b32 v3, v31 offset:5284
    ds_write_b32 v3, v30 offset:5808
    ds_write_b32 v3, v63 offset:5812
    ds_write_b32 v3, v62 offset:6336
    ds_write_b32 v3, v23 offset:6340
    ds_write_b32 v3, v22 offset:6864
    ds_write_b32 v3, v55 offset:6868
    ds_write_b32 v3, v54 offset:7392
    ds_write_b32 v3, v39 offset:7396
    ds_write_b32 v3, v38 offset:7920
    ds_write_b32 v3, v71 offset:7924
    ds_write_b32 v3, v70 offset:8448
    ds_write_b32 v3, v79 offset:8452
    ds_write_b32 v3, v78 offset:8976
    ds_write_b32 v3, v33 offset:8980
    ds_write_b32 v3, v32 offset:9504
    ds_write_b32 v3, v25 offset:9508
    ds_write_b32 v3, v24 offset:10032
    ds_write_b32 v3, v57 offset:10036
    ds_write_b32 v3, v56 offset:10560
    ds_write_b32 v3, v21 offset:10564
    ds_write_b32 v3, v20 offset:11088
    ds_write_b32 v3, v53 offset:11092
    ds_write_b32 v3, v52 offset:11616
    ds_write_b32 v3, v37 offset:11620
    ds_write_b32 v3, v36 offset:12144
    ds_write_b32 v3, v69 offset:12148
    ds_write_b32 v3, v68 offset:12672
    ds_write_b32 v3, v19 offset:12676
    ds_write_b32 v3, v18 offset:13200
    ds_write_b32 v3, v51 offset:13204
    ds_write_b32 v3, v50 offset:13728
    ds_write_b32 v3, v35 offset:13732
    ds_write_b32 v3, v34 offset:14256
    ds_write_b32 v3, v67 offset:14260
    ds_write_b32 v3, v66 offset:14784
    ds_write_b32 v3, v27 offset:14788
    ds_write_b32 v3, v26 offset:15312
    ds_write_b32 v3, v59 offset:15316
    ds_write_b32 v3, v58 offset:15840
    ds_write_b32 v3, v43 offset:15844
    ds_write_b32 v3, v42 offset:16368
    ds_write_b32 v3, v75 offset:16372
    s_waitcnt lgkmcnt(0)
    ds_read_b32 v16, v4 offset:0
    ds_read_b32 v17, v4 offset:4
    ds_read_b32 v83, v4 offset:16
    ds_read_b32 v81, v4 offset:20
    ds_read_b32 v80, v4 offset:32
    ds_read_b32 v65, v4 offset:36
    ds_read_b32 v64, v4 offset:48
    ds_read_b32 v41, v4 offset:52
    ds_read_b32 v40, v4 offset:64
    ds_read_b32 v73, v4 offset:68
    ds_read_b32 v72, v4 offset:80
    ds_read_b32 v45, v4 offset:84
    ds_read_b32 v44, v4 offset:96
    ds_read_b32 v29, v4 offset:100
    s_waitcnt lgkmcnt(0)
    ds_read_b32 v28, v4 offset:112
    ds_read_b32 v61, v4 offset:116
    ds_read_b32 v60, v4 offset:128
    ds_read_b32 v77, v4 offset:132
    ds_read_b32 v76, v4 offset:144
    ds_read_b32 v47, v4 offset:148
    ds_read_b32 v46, v4 offset:160
    ds_read_b32 v31, v4 offset:164
    ds_read_b32 v30, v4 offset:176
    ds_read_b32 v63, v4 offset:180
    ds_read_b32 v62, v4 offset:192
    ds_read_b32 v23, v4 offset:196
    ds_read_b32 v22, v4 offset:208
    ds_read_b32 v55, v4 offset:212
    s_waitcnt lgkmcnt(0)
    ds_read_b32 v54, v4 offset:224
    ds_read_b32 v39, v4 offset:228
    ds_read_b32 v38, v4 offset:240
    ds_read_b32 v71, v4 offset:244
    ds_read_b32 v70, v4 offset:256
    ds_read_b32 v79, v4 offset:260
    ds_read_b32 v78, v4 offset:272
    ds_read_b32 v33, v4 offset:276
    ds_read_b32 v32, v4 offset:288
    ds_read_b32 v25, v4 offset:292
    ds_read_b32 v24, v4 offset:304
    ds_read_b32 v57, v4 offset:308
    ds_read_b32 v56, v4 offset:320
    ds_read_b32 v21, v4 offset:324
    s_waitcnt lgkmcnt(0)
    ds_read_b32 v20, v4 offset:336
    ds_read_b32 v53, v4 offset:340
    ds_read_b32 v52, v4 offset:352
    ds_read_b32 v37, v4 offset:356
    ds_read_b32 v36, v4 offset:368
    ds_read_b32 v69, v4 offset:372
    ds_read_b32 v68, v4 offset:384
    ds_read_b32 v19, v4 offset:388
    ds_read_b32 v18, v4 offset:400
    ds_read_b32 v51, v4 offset:404
    ds_read_b32 v50, v4 offset:416
    ds_read_b32 v35, v4 offset:420
    ds_read_b32 v34, v4 offset:432
    ds_read_b32 v67, v4 offset:436
    s_waitcnt lgkmcnt(0)
    ds_read_b32 v66, v4 offset:448
    ds_read_b32 v27, v4 offset:452
    ds_read_b32 v26, v4 offset:464
    ds_read_b32 v59, v4 offset:468
    ds_read_b32 v58, v4 offset:480
    ds_read_b32 v43, v4 offset:484
    ds_read_b32 v42, v4 offset:496
    ds_read_b32 v75, v4 offset:500
    s_waitcnt lgkmcnt(0)
    s_mov_b32 s81, 71361024
mega_kernel_wf0:
    buffer_load_dword v120, off, s[84:87], s81 sc1
    s_waitcnt vmcnt(0)
    v_cmp_ne_u32 vcc, 64, v120
    s_cbranch_vccz mega_kernel_wf0d
    s_sleep 6
    s_branch mega_kernel_wf0
mega_kernel_wf0d:
    buffer_load_dword v88, v11, s[8:11], s19 offen offset:0
    buffer_load_dword v89, v11, s[8:11], s19 offen offset:128
    buffer_load_dword v90, v11, s[8:11], s19 offen offset:256
    buffer_load_dword v91, v11, s[8:11], s19 offen offset:384
    buffer_load_dword v92, v11, s[8:11], s19 offen offset:512
    buffer_load_dword v93, v11, s[8:11], s19 offen offset:640
    buffer_load_dword v94, v11, s[8:11], s19 offen offset:768
    buffer_load_dword v95, v11, s[8:11], s19 offen offset:896
    buffer_load_dword v96, v11, s[8:11], s19 offen offset:1024
    buffer_load_dword v97, v11, s[8:11], s19 offen offset:1152
    buffer_load_dword v98, v11, s[8:11], s19 offen offset:1280
    buffer_load_dword v99, v11, s[8:11], s19 offen offset:1408
    buffer_load_dword v100, v11, s[8:11], s19 offen offset:1536
    buffer_load_dword v101, v11, s[8:11], s19 offen offset:1664
    buffer_load_dword v102, v11, s[8:11], s19 offen offset:1792
    buffer_load_dword v103, v11, s[8:11], s19 offen offset:1920
    buffer_load_dword v104, v11, s[8:11], s19 offen offset:2048
    buffer_load_dword v105, v11, s[8:11], s19 offen offset:2176
    buffer_load_dword v106, v11, s[8:11], s19 offen offset:2304
    buffer_load_dword v107, v11, s[8:11], s19 offen offset:2432
    buffer_load_dword v108, v11, s[8:11], s19 offen offset:2560
    buffer_load_dword v109, v11, s[8:11], s19 offen offset:2688
    buffer_load_dword v110, v11, s[8:11], s19 offen offset:2816
    buffer_load_dword v111, v11, s[8:11], s19 offen offset:2944
    buffer_load_dword v112, v11, s[8:11], s19 offen offset:3072
    buffer_load_dword v113, v11, s[8:11], s19 offen offset:3200
    buffer_load_dword v114, v11, s[8:11], s19 offen offset:3328
    buffer_load_dword v115, v11, s[8:11], s19 offen offset:3456
    buffer_load_dword v116, v11, s[8:11], s19 offen offset:3584
    buffer_load_dword v117, v11, s[8:11], s19 offen offset:3712
    buffer_load_dword v118, v11, s[8:11], s19 offen offset:3840
    buffer_load_dword v119, v11, s[8:11], s19 offen offset:3968
    v_sub_f32 v48, v16, v70
    v_sub_f32 v49, v17, v79
    v_add_f32 v16, v16, v70
    v_add_f32 v17, v17, v79
    v_sub_f32 v70, v83, v78
    v_sub_f32 v79, v81, v33
    v_add_f32 v83, v83, v78
    v_add_f32 v81, v81, v33
    v_mul_f32 v78, 0x3f7b14be, v70
    v_mul_f32 v33, 0xbe47c5c2, v70
    v_fmac_f32 v78, 0x3e47c5c2, v79
    v_fmac_f32 v33, 0x3f7b14be, v79
    v_sub_f32 v70, v80, v32
    v_sub_f32 v79, v65, v25
    v_add_f32 v80, v80, v32
    v_add_f32 v65, v65, v25
    v_mul_f32 v32, 0x3f6c835e, v70
    v_mul_f32 v25, 0xbec3ef15, v70
    v_fmac_f32 v32, 0x3ec3ef15, v79
    v_fmac_f32 v25, 0x3f6c835e, v79
    v_sub_f32 v70, v64, v24
    v_sub_f32 v79, v41, v57
    v_add_f32 v64, v64, v24
    v_add_f32 v41, v41, v57
    v_mul_f32 v24, 0x3f54db31, v70
    v_mul_f32 v57, 0xbf0e39da, v70
    v_fmac_f32 v24, 0x3f0e39da, v79
    v_fmac_f32 v57, 0x3f54db31, v79
    v_sub_f32 v70, v40, v56
    v_sub_f32 v79, v73, v21
    v_add_f32 v40, v40, v56
    v_add_f32 v73, v73, v21
    v_mul_f32 v56, 0x3f3504f3, v70
    v_mul_f32 v21, 0xbf3504f3, v70
    v_fmac_f32 v56, 0x3f3504f3, v79
    v_fmac_f32 v21, 0x3f3504f3, v79
    v_sub_f32 v70, v72, v20
    v_sub_f32 v79, v45, v53
    v_add_f32 v72, v72, v20
    v_add_f32 v45, v45, v53
    v_mul_f32 v20, 0x3f0e39da, v70
    v_mul_f32 v53, 0xbf54db31, v70
    v_fmac_f32 v20, 0x3f54db31, v79
    v_fmac_f32 v53, 0x3f0e39da, v79
    v_sub_f32 v70, v44, v52
    v_sub_f32 v79, v29, v37
    v_add_f32 v44, v44, v52
    v_add_f32 v29, v29, v37
    v_mul_f32 v52, 0x3ec3ef15, v70
    v_mul_f32 v37, 0xbf6c835e, v70
    v_fmac_f32 v52, 0x3f6c835e, v79
    v_fmac_f32 v37, 0x3ec3ef15, v79
    v_sub_f32 v70, v28, v36
    v_sub_f32 v79, v61, v69
    v_add_f32 v28, v28, v36
    v_add_f32 v61, v61, v69
    v_mul_f32 v36, 0x3e47c5c2, v70
    v_mul_f32 v69, 0xbf7b14be, v70
    v_fmac_f32 v36, 0x3f7b14be, v79
    v_fmac_f32 v69, 0x3e47c5c2, v79
    v_sub_f32 v70, v77, v19
    v_sub_f32 v79, v68, v60
    v_add_f32 v60, v60, v68
    v_add_f32 v77, v77, v19
    v_sub_f32 v68, v76, v18
    v_sub_f32 v19, v47, v51
    v_add_f32 v76, v76, v18
    v_add_f32 v47, v47, v51
    v_mul_f32 v18, 0xbe47c5c2, v68
    v_mul_f32 v51, 0xbf7b14be, v68
    v_fmac_f32 v18, 0x3f7b14be, v19
    v_fmac_f32 v51, 0xbe47c5c2, v19
    v_sub_f32 v68, v46, v50
    v_sub_f32 v19, v31, v35
    v_add_f32 v46, v46, v50
    v_add_f32 v31, v31, v35
    v_mul_f32 v50, 0xbec3ef15, v68
    v_mul_f32 v35, 0xbf6c835e, v68
    v_fmac_f32 v50, 0x3f6c835e, v19
    v_fmac_f32 v35, 0xbec3ef15, v19
    v_sub_f32 v68, v30, v34
    v_sub_f32 v19, v63, v67
    v_add_f32 v30, v30, v34
    v_add_f32 v63, v63, v67
    v_mul_f32 v34, 0xbf0e39da, v68
    v_mul_f32 v67, 0xbf54db31, v68
    v_fmac_f32 v34, 0x3f54db31, v19
    v_fmac_f32 v67, 0xbf0e39da, v19
    v_sub_f32 v68, v62, v66
    v_sub_f32 v19, v23, v27
    v_add_f32 v62, v62, v66
    v_add_f32 v23, v23, v27
    v_mul_f32 v66, 0xbf3504f3, v68
    v_mul_f32 v27, 0xbf3504f3, v68
    v_fmac_f32 v66, 0x3f3504f3, v19
    v_fmac_f32 v27, 0xbf3504f3, v19
    v_sub_f32 v68, v22, v26
    v_sub_f32 v19, v55, v59
    v_add_f32 v22, v22, v26
    v_add_f32 v55, v55, v59
    v_mul_f32 v26, 0xbf54db31, v68
    v_mul_f32 v59, 0xbf0e39da, v68
    v_fmac_f32 v26, 0x3f0e39da, v19
    v_fmac_f32 v59, 0xbf54db31, v19
    v_sub_f32 v68, v54, v58
    v_sub_f32 v19, v39, v43
    v_add_f32 v54, v54, v58
    v_add_f32 v39, v39, v43
    v_mul_f32 v58, 0xbf6c835e, v68
    v_mul_f32 v43, 0xbec3ef15, v68
    v_fmac_f32 v58, 0x3ec3ef15, v19
    v_fmac_f32 v43, 0xbf6c835e, v19
    v_sub_f32 v68, v38, v42
    v_sub_f32 v19, v71, v75
    v_add_f32 v38, v38, v42
    v_add_f32 v71, v71, v75
    v_mul_f32 v42, 0xbf7b14be, v68
    v_mul_f32 v75, 0xbe47c5c2, v68
    v_fmac_f32 v42, 0x3e47c5c2, v19
    v_fmac_f32 v75, 0xbf7b14be, v19
    v_sub_f32 v68, v16, v60
    v_sub_f32 v19, v17, v77
    v_add_f32 v16, v16, v60
    v_add_f32 v17, v17, v77
    v_sub_f32 v60, v83, v76
    v_sub_f32 v77, v81, v47
    v_add_f32 v83, v83, v76
    v_add_f32 v81, v81, v47
    v_mul_f32 v76, 0x3f6c835e, v60
    v_mul_f32 v47, 0xbec3ef15, v60
    v_fmac_f32 v76, 0x3ec3ef15, v77
    v_fmac_f32 v47, 0x3f6c835e, v77
    v_sub_f32 v60, v80, v46
    v_sub_f32 v77, v65, v31
    v_add_f32 v80, v80, v46
    v_add_f32 v65, v65, v31
    v_mul_f32 v46, 0x3f3504f3, v60
    v_mul_f32 v31, 0xbf3504f3, v60
    v_fmac_f32 v46, 0x3f3504f3, v77
    v_fmac_f32 v31, 0x3f3504f3, v77
    v_sub_f32 v60, v64, v30
    v_sub_f32 v77, v41, v63
    v_add_f32 v64, v64, v30
    v_add_f32 v41, v41, v63
    v_mul_f32 v30, 0x3ec3ef15, v60
    v_mul_f32 v63, 0xbf6c835e, v60
    v_fmac_f32 v30, 0x3f6c835e, v77
    v_fmac_f32 v63, 0x3ec3ef15, v77
    v_sub_f32 v60, v73, v23
    v_sub_f32 v77, v62, v40
    v_add_f32 v40, v40, v62
    v_add_f32 v73, v73, v23
    v_sub_f32 v62, v72, v22
    v_sub_f32 v23, v45, v55
    v_add_f32 v72, v72, v22
    v_add_f32 v45, v45, v55
    v_mul_f32 v22, 0xbec3ef15, v62
    v_mul_f32 v55, 0xbf6c835e, v62
    v_fmac_f32 v22, 0x3f6c835e, v23
    v_fmac_f32 v55, 0xbec3ef15, v23
    v_sub_f32 v62, v44, v54
    v_sub_f32 v23, v29, v39
    v_add_f32 v44, v44, v54
    v_add_f32 v29, v29, v39
    v_mul_f32 v54, 0xbf3504f3, v62
    v_mul_f32 v39, 0xbf3504f3, v62
    v_fmac_f32 v54, 0x3f3504f3, v23
    v_fmac_f32 v39, 0xbf3504f3, v23
    v_sub_f32 v62, v28, v38
    v_sub_f32 v23, v61, v71
    v_add_f32 v28, v28, v38
    v_add_f32 v61, v61, v71
    v_mul_f32 v38, 0xbf6c835e, v62
    v_mul_f32 v71, 0xbec3ef15, v62
    v_fmac_f32 v38, 0x3ec3ef15, v23
    v_fmac_f32 v71, 0xbf6c835e, v23
    v_sub_f32 v62, v48, v70
    v_sub_f32 v23, v49, v79
    v_add_f32 v48, v48, v70
    v_add_f32 v49, v49, v79
    v_sub_f32 v70, v78, v18
    v_sub_f32 v79, v33, v51
    v_add_f32 v78, v78, v18
    v_add_f32 v33, v33, v51
    v_mul_f32 v18, 0x3f6c835e, v70
    v_mul_f32 v51, 0xbec3ef15, v70
    v_fmac_f32 v18, 0x3ec3ef15, v79
    v_fmac_f32 v51, 0x3f6c835e, v79
    v_sub_f32 v70, v32, v50
    v_sub_f32 v79, v25, v35
    v_add_f32 v32, v32, v50
    v_add_f32 v25, v25, v35
    v_mul_f32 v50, 0x3f3504f3, v70
    v_mul_f32 v35, 0xbf3504f3, v70
    v_fmac_f32 v50, 0x3f3504f3, v79
    v_fmac_f32 v35, 0x3f3504f3, v79
    v_sub_f32 v70, v24, v34
    v_sub_f32 v79, v57, v67
    v_add_f32 v24, v24, v34
    v_add_f32 v57, v57, v67
    v_mul_f32 v34, 0x3ec3ef15, v70
    v_mul_f32 v67, 0xbf6c835e, v70
    v_fmac_f32 v34, 0x3f6c835e, v79
    v_fmac_f32 v67, 0x3ec3ef15, v79
    v_sub_f32 v70, v21, v27
    v_sub_f32 v79, v66, v56
    v_add_f32 v56, v56, v66
    v_add_f32 v21, v21, v27
    v_sub_f32 v66, v20, v26
    v_sub_f32 v27, v53, v59
    v_add_f32 v20, v20, v26
    v_add_f32 v53, v53, v59
    v_mul_f32 v26, 0xbec3ef15, v66
    v_mul_f32 v59, 0xbf6c835e, v66
    v_fmac_f32 v26, 0x3f6c835e, v27
    v_fmac_f32 v59, 0xbec3ef15, v27
    v_sub_f32 v66, v52, v58
    v_sub_f32 v27, v37, v43
    v_add_f32 v52, v52, v58
    v_add_f32 v37, v37, v43
    v_mul_f32 v58, 0xbf3504f3, v66
    v_mul_f32 v43, 0xbf3504f3, v66
    v_fmac_f32 v58, 0x3f3504f3, v27
    v_fmac_f32 v43, 0xbf3504f3, v27
    v_sub_f32 v66, v36, v42
    v_sub_f32 v27, v69, v75
    v_add_f32 v36, v36, v42
    v_add_f32 v69, v69, v75
    v_mul_f32 v42, 0xbf6c835e, v66
    v_mul_f32 v75, 0xbec3ef15, v66
    v_fmac_f32 v42, 0x3ec3ef15, v27
    v_fmac_f32 v75, 0xbf6c835e, v27
    v_sub_f32 v66, v16, v40
    v_sub_f32 v27, v17, v73
    v_add_f32 v16, v16, v40
    v_add_f32 v17, v17, v73
    v_sub_f32 v40, v83, v72
    v_sub_f32 v73, v81, v45
    v_add_f32 v83, v83, v72
    v_add_f32 v81, v81, v45
    v_mul_f32 v72, 0x3f3504f3, v40
    v_mul_f32 v45, 0xbf3504f3, v40
    v_fmac_f32 v72, 0x3f3504f3, v73
    v_fmac_f32 v45, 0x3f3504f3, v73
    v_sub_f32 v40, v65, v29
    v_sub_f32 v73, v44, v80
    v_add_f32 v80, v80, v44
    v_add_f32 v65, v65, v29
    v_sub_f32 v44, v64, v28
    v_sub_f32 v29, v41, v61
    v_add_f32 v64, v64, v28
    v_add_f32 v41, v41, v61
    v_mul_f32 v28, 0xbf3504f3, v44
    v_mul_f32 v61, 0xbf3504f3, v44
    v_fmac_f32 v28, 0x3f3504f3, v29
    v_fmac_f32 v61, 0xbf3504f3, v29
    v_sub_f32 v44, v68, v60
    v_sub_f32 v29, v19, v77
    v_add_f32 v68, v68, v60
    v_add_f32 v19, v19, v77
    v_sub_f32 v60, v76, v22
    v_sub_f32 v77, v47, v55
    v_add_f32 v76, v76, v22
    v_add_f32 v47, v47, v55
    v_mul_f32 v22, 0x3f3504f3, v60
    v_mul_f32 v55, 0xbf3504f3, v60
    v_fmac_f32 v22, 0x3f3504f3, v77
    v_fmac_f32 v55, 0x3f3504f3, v77
    v_sub_f32 v60, v31, v39
    v_sub_f32 v77, v54, v46
    v_add_f32 v46, v46, v54
    v_add_f32 v31, v31, v39
    v_sub_f32 v54, v30, v38
    v_sub_f32 v39, v63, v71
    v_add_f32 v30, v30, v38
    v_add_f32 v63, v63, v71
    v_mul_f32 v38, 0xbf3504f3, v54
    v_mul_f32 v71, 0xbf3504f3, v54
    v_fmac_f32 v38, 0x3f3504f3, v39
    v_fmac_f32 v71, 0xbf3504f3, v39
    v_sub_f32 v54, v48, v56
    v_sub_f32 v39, v49, v21
    v_add_f32 v48, v48, v56
    v_add_f32 v49, v49, v21
    v_sub_f32 v56, v78, v20
    v_sub_f32 v21, v33, v53
    v_add_f32 v78, v78, v20
    v_add_f32 v33, v33, v53
    v_mul_f32 v20, 0x3f3504f3, v56
    v_mul_f32 v53, 0xbf3504f3, v56
    v_fmac_f32 v20, 0x3f3504f3, v21
    v_fmac_f32 v53, 0x3f3504f3, v21
    v_sub_f32 v56, v25, v37
    v_sub_f32 v21, v52, v32
    v_add_f32 v32, v32, v52
    v_add_f32 v25, v25, v37
    v_sub_f32 v52, v24, v36
    v_sub_f32 v37, v57, v69
    v_add_f32 v24, v24, v36
    v_add_f32 v57, v57, v69
    v_mul_f32 v36, 0xbf3504f3, v52
    v_mul_f32 v69, 0xbf3504f3, v52
    v_fmac_f32 v36, 0x3f3504f3, v37
    v_fmac_f32 v69, 0xbf3504f3, v37
    v_sub_f32 v52, v62, v70
    v_sub_f32 v37, v23, v79
    v_add_f32 v62, v62, v70
    v_add_f32 v23, v23, v79
    v_sub_f32 v70, v18, v26
    v_sub_f32 v79, v51, v59
    v_add_f32 v18, v18, v26
    v_add_f32 v51, v51, v59
    v_mul_f32 v26, 0x3f3504f3, v70
    v_mul_f32 v59, 0xbf3504f3, v70
    v_fmac_f32 v26, 0x3f3504f3, v79
    v_fmac_f32 v59, 0x3f3504f3, v79
    v_sub_f32 v70, v35, v43
    v_sub_f32 v79, v58, v50
    v_add_f32 v50, v50, v58
    v_add_f32 v35, v35, v43
    v_sub_f32 v58, v34, v42
    v_sub_f32 v43, v67, v75
    v_add_f32 v34, v34, v42
    v_add_f32 v67, v67, v75
    v_mul_f32 v42, 0xbf3504f3, v58
    v_mul_f32 v75, 0xbf3504f3, v58
    v_fmac_f32 v42, 0x3f3504f3, v43
    v_fmac_f32 v75, 0xbf3504f3, v43
    v_sub_f32 v58, v16, v80
    v_sub_f32 v43, v17, v65
    v_add_f32 v16, v16, v80
    v_add_f32 v17, v17, v65
    v_sub_f32 v80, v81, v41
    v_sub_f32 v65, v64, v83
    v_add_f32 v83, v83, v64
    v_add_f32 v81, v81, v41
    v_sub_f32 v64, v66, v40
    v_sub_f32 v41, v27, v73
    v_add_f32 v66, v66, v40
    v_add_f32 v27, v27, v73
    v_sub_f32 v40, v45, v61
    v_sub_f32 v73, v28, v72
    v_add_f32 v72, v72, v28
    v_add_f32 v45, v45, v61
    v_sub_f32 v28, v68, v46
    v_sub_f32 v61, v19, v31
    v_add_f32 v68, v68, v46
    v_add_f32 v19, v19, v31
    v_sub_f32 v46, v47, v63
    v_sub_f32 v31, v30, v76
    v_add_f32 v76, v76, v30
    v_add_f32 v47, v47, v63
    v_sub_f32 v30, v44, v60
    v_sub_f32 v63, v29, v77
    v_add_f32 v44, v44, v60
    v_add_f32 v29, v29, v77
    v_sub_f32 v60, v55, v71
    v_sub_f32 v77, v38, v22
    v_add_f32 v22, v22, v38
    v_add_f32 v55, v55, v71
    v_sub_f32 v38, v48, v32
    v_sub_f32 v71, v49, v25
    v_add_f32 v48, v48, v32
    v_add_f32 v49, v49, v25
    v_sub_f32 v32, v33, v57
    v_sub_f32 v25, v24, v78
    v_add_f32 v78, v78, v24
    v_add_f32 v33, v33, v57
    v_sub_f32 v24, v54, v56
    v_sub_f32 v57, v39, v21
    v_add_f32 v54, v54, v56
    v_add_f32 v39, v39, v21
    v_sub_f32 v56, v53, v69
    v_sub_f32 v21, v36, v20
    v_add_f32 v20, v20, v36
    v_add_f32 v53, v53, v69
    v_sub_f32 v36, v62, v50
    v_sub_f32 v69, v23, v35
    v_add_f32 v62, v62, v50
    v_add_f32 v23, v23, v35
    v_sub_f32 v50, v51, v67
    v_sub_f32 v35, v34, v18
    v_add_f32 v18, v18, v34
    v_add_f32 v51, v51, v67
    v_sub_f32 v34, v52, v70
    v_sub_f32 v67, v37, v79
    v_add_f32 v52, v52, v70
    v_add_f32 v37, v37, v79
    v_sub_f32 v70, v59, v75
    v_sub_f32 v79, v42, v26
    v_add_f32 v26, v26, v42
    v_add_f32 v59, v59, v75
    v_sub_f32 v42, v16, v83
    v_sub_f32 v75, v17, v81
    v_add_f32 v16, v16, v83
    v_add_f32 v17, v17, v81
    v_sub_f32 v83, v58, v80
    v_sub_f32 v81, v43, v65
    v_add_f32 v58, v58, v80
    v_add_f32 v43, v43, v65
    v_sub_f32 v80, v66, v72
    v_sub_f32 v65, v27, v45
    v_add_f32 v66, v66, v72
    v_add_f32 v27, v27, v45
    v_sub_f32 v72, v64, v40
    v_sub_f32 v45, v41, v73
    v_add_f32 v64, v64, v40
    v_add_f32 v41, v41, v73
    v_sub_f32 v40, v68, v76
    v_sub_f32 v73, v19, v47
    v_add_f32 v68, v68, v76
    v_add_f32 v19, v19, v47
    v_sub_f32 v76, v28, v46
    v_sub_f32 v47, v61, v31
    v_add_f32 v28, v28, v46
    v_add_f32 v61, v61, v31
    v_sub_f32 v46, v44, v22
    v_sub_f32 v31, v29, v55
    v_add_f32 v44, v44, v22
    v_add_f32 v29, v29, v55
    v_sub_f32 v22, v30, v60
    v_sub_f32 v55, v63, v77
    v_add_f32 v30, v30, v60
    v_add_f32 v63, v63, v77
    v_sub_f32 v60, v48, v78
    v_sub_f32 v77, v49, v33
    v_add_f32 v48, v48, v78
    v_add_f32 v49, v49, v33
    v_sub_f32 v78, v38, v32
    v_sub_f32 v33, v71, v25
    v_add_f32 v38, v38, v32
    v_add_f32 v71, v71, v25
    v_sub_f32 v32, v54, v20
    v_sub_f32 v25, v39, v53
    v_add_f32 v54, v54, v20
    v_add_f32 v39, v39, v53
    v_sub_f32 v20, v24, v56
    v_sub_f32 v53, v57, v21
    v_add_f32 v24, v24, v56
    v_add_f32 v57, v57, v21
    v_sub_f32 v56, v62, v18
    v_sub_f32 v21, v23, v51
    v_add_f32 v62, v62, v18
    v_add_f32 v23, v23, v51
    v_sub_f32 v18, v36, v50
    v_sub_f32 v51, v69, v35
    v_add_f32 v36, v36, v50
    v_add_f32 v69, v69, v35
    v_sub_f32 v50, v52, v26
    v_sub_f32 v35, v37, v59
    v_add_f32 v52, v52, v26
    v_add_f32 v37, v37, v59
    v_sub_f32 v26, v34, v70
    v_sub_f32 v59, v67, v79
    v_add_f32 v34, v34, v70
    v_add_f32 v67, v67, v79
    v_mul_f32 v70, 0xbc800000, v10
    v_cos_f32 v79, v70
    v_sin_f32 v82, v70
    s_nop 0
    v_mul_f32 v74, v48, v79
    v_fma_f32 v74, -v49, v82, v74
    v_mul_f32 v49, v49, v79
    v_fmac_f32 v49, v48, v82
    v_mul_f32 v70, 0xbd000000, v10
    v_cos_f32 v79, v70
    v_sin_f32 v82, v70
    s_nop 0
    v_mul_f32 v48, v68, v79
    v_fma_f32 v48, -v19, v82, v48
    v_mul_f32 v19, v19, v79
    v_fmac_f32 v19, v68, v82
    v_mul_f32 v70, 0xbd400000, v10
    v_cos_f32 v79, v70
    v_sin_f32 v82, v70
    s_nop 0
    v_mul_f32 v68, v62, v79
    v_fma_f32 v68, -v23, v82, v68
    v_mul_f32 v23, v23, v79
    v_fmac_f32 v23, v62, v82
    v_mul_f32 v70, 0xbd800000, v10
    v_cos_f32 v79, v70
    v_sin_f32 v82, v70
    s_nop 0
    v_mul_f32 v62, v66, v79
    v_fma_f32 v62, -v27, v82, v62
    v_mul_f32 v27, v27, v79
    v_fmac_f32 v27, v66, v82
    v_mul_f32 v70, 0xbda00000, v10
    v_cos_f32 v79, v70
    v_sin_f32 v82, v70
    s_nop 0
    v_mul_f32 v66, v54, v79
    v_fma_f32 v66, -v39, v82, v66
    v_mul_f32 v39, v39, v79
    v_fmac_f32 v39, v54, v82
    v_mul_f32 v70, 0xbdc00000, v10
    v_cos_f32 v79, v70
    v_sin_f32 v82, v70
    s_nop 0
    v_mul_f32 v54, v44, v79
    v_fma_f32 v54, -v29, v82, v54
    v_mul_f32 v29, v29, v79
    v_fmac_f32 v29, v44, v82
    v_mul_f32 v70, 0xbde00000, v10
    v_cos_f32 v79, v70
    v_sin_f32 v82, v70
    s_nop 0
    v_mul_f32 v44, v52, v79
    v_fma_f32 v44, -v37, v82, v44
    v_mul_f32 v37, v37, v79
    v_fmac_f32 v37, v52, v82
    v_mul_f32 v70, 0xbe000000, v10
    v_cos_f32 v79, v70
    v_sin_f32 v82, v70
    s_nop 0
    v_mul_f32 v52, v58, v79
    v_fma_f32 v52, -v43, v82, v52
    v_mul_f32 v43, v43, v79
    v_fmac_f32 v43, v58, v82
    v_mul_f32 v70, 0xbe100000, v10
    v_cos_f32 v79, v70
    v_sin_f32 v82, v70
    s_nop 0
    v_mul_f32 v58, v38, v79
    v_fma_f32 v58, -v71, v82, v58
    v_mul_f32 v71, v71, v79
    v_fmac_f32 v71, v38, v82
    v_mul_f32 v70, 0xbe200000, v10
    v_cos_f32 v79, v70
    v_sin_f32 v82, v70
    s_nop 0
    v_mul_f32 v38, v28, v79
    v_fma_f32 v38, -v61, v82, v38
    v_mul_f32 v61, v61, v79
    v_fmac_f32 v61, v28, v82
    v_mul_f32 v70, 0xbe300000, v10
    v_cos_f32 v79, v70
    v_sin_f32 v82, v70
    s_nop 0
    v_mul_f32 v28, v36, v79
    v_fma_f32 v28, -v69, v82, v28
    v_mul_f32 v69, v69, v79
    v_fmac_f32 v69, v36, v82
    v_mul_f32 v70, 0xbe400000, v10
    v_cos_f32 v79, v70
    v_sin_f32 v82, v70
    s_nop 0
    v_mul_f32 v36, v64, v79
    v_fma_f32 v36, -v41, v82, v36
    v_mul_f32 v41, v41, v79
    v_fmac_f32 v41, v64, v82
    v_mul_f32 v70, 0xbe500000, v10
    v_cos_f32 v79, v70
    v_sin_f32 v82, v70
    s_nop 0
    v_mul_f32 v64, v24, v79
    v_fma_f32 v64, -v57, v82, v64
    v_mul_f32 v57, v57, v79
    v_fmac_f32 v57, v24, v82
    v_mul_f32 v70, 0xbe600000, v10
    v_cos_f32 v79, v70
    v_sin_f32 v82, v70
    s_nop 0
    v_mul_f32 v24, v30, v79
    v_fma_f32 v24, -v63, v82, v24
    v_mul_f32 v63, v63, v79
    v_fmac_f32 v63, v30, v82
    v_mul_f32 v70, 0xbe700000, v10
    v_cos_f32 v79, v70
    v_sin_f32 v82, v70
    s_nop 0
    v_mul_f32 v30, v34, v79
    v_fma_f32 v30, -v67, v82, v30
    v_mul_f32 v67, v67, v79
    v_fmac_f32 v67, v34, v82
    v_mul_f32 v70, 0xbe800000, v10
    v_cos_f32 v79, v70
    v_sin_f32 v82, v70
    s_nop 0
    v_mul_f32 v34, v42, v79
    v_fma_f32 v34, -v75, v82, v34
    v_mul_f32 v75, v75, v79
    v_fmac_f32 v75, v42, v82
    v_mul_f32 v70, 0xbe880000, v10
    v_cos_f32 v79, v70
    v_sin_f32 v82, v70
    s_nop 0
    v_mul_f32 v42, v60, v79
    v_fma_f32 v42, -v77, v82, v42
    v_mul_f32 v77, v77, v79
    v_fmac_f32 v77, v60, v82
    v_mul_f32 v70, 0xbe900000, v10
    v_cos_f32 v79, v70
    v_sin_f32 v82, v70
    s_nop 0
    v_mul_f32 v60, v40, v79
    v_fma_f32 v60, -v73, v82, v60
    v_mul_f32 v73, v73, v79
    v_fmac_f32 v73, v40, v82
    v_mul_f32 v70, 0xbe980000, v10
    v_cos_f32 v79, v70
    v_sin_f32 v82, v70
    s_nop 0
    v_mul_f32 v40, v56, v79
    v_fma_f32 v40, -v21, v82, v40
    v_mul_f32 v21, v21, v79
    v_fmac_f32 v21, v56, v82
    v_mul_f32 v70, 0xbea00000, v10
    v_cos_f32 v79, v70
    v_sin_f32 v82, v70
    s_nop 0
    v_mul_f32 v56, v80, v79
    v_fma_f32 v56, -v65, v82, v56
    v_mul_f32 v65, v65, v79
    v_fmac_f32 v65, v80, v82
    v_mul_f32 v70, 0xbea80000, v10
    v_cos_f32 v79, v70
    v_sin_f32 v82, v70
    s_nop 0
    v_mul_f32 v80, v32, v79
    v_fma_f32 v80, -v25, v82, v80
    v_mul_f32 v25, v25, v79
    v_fmac_f32 v25, v32, v82
    v_mul_f32 v70, 0xbeb00000, v10
    v_cos_f32 v79, v70
    v_sin_f32 v82, v70
    s_nop 0
    v_mul_f32 v32, v46, v79
    v_fma_f32 v32, -v31, v82, v32
    v_mul_f32 v31, v31, v79
    v_fmac_f32 v31, v46, v82
    v_mul_f32 v70, 0xbeb80000, v10
    v_cos_f32 v79, v70
    v_sin_f32 v82, v70
    s_nop 0
    v_mul_f32 v46, v50, v79
    v_fma_f32 v46, -v35, v82, v46
    v_mul_f32 v35, v35, v79
    v_fmac_f32 v35, v50, v82
    v_mul_f32 v70, 0xbec00000, v10
    v_cos_f32 v79, v70
    v_sin_f32 v82, v70
    s_nop 0
    v_mul_f32 v50, v83, v79
    v_fma_f32 v50, -v81, v82, v50
    v_mul_f32 v81, v81, v79
    v_fmac_f32 v81, v83, v82
    v_mul_f32 v70, 0xbec80000, v10
    v_cos_f32 v79, v70
    v_sin_f32 v82, v70
    s_nop 0
    v_mul_f32 v83, v78, v79
    v_fma_f32 v83, -v33, v82, v83
    v_mul_f32 v33, v33, v79
    v_fmac_f32 v33, v78, v82
    v_mul_f32 v70, 0xbed00000, v10
    v_cos_f32 v79, v70
    v_sin_f32 v82, v70
    s_nop 0
    v_mul_f32 v78, v76, v79
    v_fma_f32 v78, -v47, v82, v78
    v_mul_f32 v47, v47, v79
    v_fmac_f32 v47, v76, v82
    v_mul_f32 v70, 0xbed80000, v10
    v_cos_f32 v79, v70
    v_sin_f32 v82, v70
    s_nop 0
    v_mul_f32 v76, v18, v79
    v_fma_f32 v76, -v51, v82, v76
    v_mul_f32 v51, v51, v79
    v_fmac_f32 v51, v18, v82
    v_mul_f32 v70, 0xbee00000, v10
    v_cos_f32 v79, v70
    v_sin_f32 v82, v70
    s_nop 0
    v_mul_f32 v18, v72, v79
    v_fma_f32 v18, -v45, v82, v18
    v_mul_f32 v45, v45, v79
    v_fmac_f32 v45, v72, v82
    v_mul_f32 v70, 0xbee80000, v10
    v_cos_f32 v79, v70
    v_sin_f32 v82, v70
    s_nop 0
    v_mul_f32 v72, v20, v79
    v_fma_f32 v72, -v53, v82, v72
    v_mul_f32 v53, v53, v79
    v_fmac_f32 v53, v20, v82
    v_mul_f32 v70, 0xbef00000, v10
    v_cos_f32 v79, v70
    v_sin_f32 v82, v70
    s_nop 0
    v_mul_f32 v20, v22, v79
    v_fma_f32 v20, -v55, v82, v20
    v_mul_f32 v55, v55, v79
    v_fmac_f32 v55, v22, v82
    v_mul_f32 v70, 0xbef80000, v10
    v_cos_f32 v79, v70
    v_sin_f32 v82, v70
    s_nop 0
    v_mul_f32 v22, v26, v79
    v_fma_f32 v22, -v59, v82, v22
    v_mul_f32 v59, v59, v79
    v_fmac_f32 v59, v26, v82
    s_nop 1
    v_mov_b32_dpp v70, v16 quad_perm:[1,0,3,2] row_mask:0xf bank_mask:0xf
    v_fma_f32 v16, v16, v9, v70
    v_mov_b32_dpp v70, v17 quad_perm:[1,0,3,2] row_mask:0xf bank_mask:0xf
    v_fma_f32 v17, v17, v9, v70
    v_mov_b32_dpp v70, v74 quad_perm:[1,0,3,2] row_mask:0xf bank_mask:0xf
    v_fma_f32 v74, v74, v9, v70
    v_mov_b32_dpp v70, v49 quad_perm:[1,0,3,2] row_mask:0xf bank_mask:0xf
    v_fma_f32 v49, v49, v9, v70
    v_mov_b32_dpp v70, v48 quad_perm:[1,0,3,2] row_mask:0xf bank_mask:0xf
    v_fma_f32 v48, v48, v9, v70
    v_mov_b32_dpp v70, v19 quad_perm:[1,0,3,2] row_mask:0xf bank_mask:0xf
    v_fma_f32 v19, v19, v9, v70
    v_mov_b32_dpp v70, v68 quad_perm:[1,0,3,2] row_mask:0xf bank_mask:0xf
    v_fma_f32 v68, v68, v9, v70
    v_mov_b32_dpp v70, v23 quad_perm:[1,0,3,2] row_mask:0xf bank_mask:0xf
    v_fma_f32 v23, v23, v9, v70
    v_mov_b32_dpp v70, v62 quad_perm:[1,0,3,2] row_mask:0xf bank_mask:0xf
    v_fma_f32 v62, v62, v9, v70
    v_mov_b32_dpp v70, v27 quad_perm:[1,0,3,2] row_mask:0xf bank_mask:0xf
    v_fma_f32 v27, v27, v9, v70
    v_mov_b32_dpp v70, v66 quad_perm:[1,0,3,2] row_mask:0xf bank_mask:0xf
    v_fma_f32 v66, v66, v9, v70
    v_mov_b32_dpp v70, v39 quad_perm:[1,0,3,2] row_mask:0xf bank_mask:0xf
    v_fma_f32 v39, v39, v9, v70
    v_mov_b32_dpp v70, v54 quad_perm:[1,0,3,2] row_mask:0xf bank_mask:0xf
    v_fma_f32 v54, v54, v9, v70
    v_mov_b32_dpp v70, v29 quad_perm:[1,0,3,2] row_mask:0xf bank_mask:0xf
    v_fma_f32 v29, v29, v9, v70
    v_mov_b32_dpp v70, v44 quad_perm:[1,0,3,2] row_mask:0xf bank_mask:0xf
    v_fma_f32 v44, v44, v9, v70
    v_mov_b32_dpp v70, v37 quad_perm:[1,0,3,2] row_mask:0xf bank_mask:0xf
    v_fma_f32 v37, v37, v9, v70
    v_mov_b32_dpp v70, v52 quad_perm:[1,0,3,2] row_mask:0xf bank_mask:0xf
    v_fma_f32 v52, v52, v9, v70
    v_mov_b32_dpp v70, v43 quad_perm:[1,0,3,2] row_mask:0xf bank_mask:0xf
    v_fma_f32 v43, v43, v9, v70
    v_mov_b32_dpp v70, v58 quad_perm:[1,0,3,2] row_mask:0xf bank_mask:0xf
    v_fma_f32 v58, v58, v9, v70
    v_mov_b32_dpp v70, v71 quad_perm:[1,0,3,2] row_mask:0xf bank_mask:0xf
    v_fma_f32 v71, v71, v9, v70
    v_mov_b32_dpp v70, v38 quad_perm:[1,0,3,2] row_mask:0xf bank_mask:0xf
    v_fma_f32 v38, v38, v9, v70
    v_mov_b32_dpp v70, v61 quad_perm:[1,0,3,2] row_mask:0xf bank_mask:0xf
    v_fma_f32 v61, v61, v9, v70
    v_mov_b32_dpp v70, v28 quad_perm:[1,0,3,2] row_mask:0xf bank_mask:0xf
    v_fma_f32 v28, v28, v9, v70
    v_mov_b32_dpp v70, v69 quad_perm:[1,0,3,2] row_mask:0xf bank_mask:0xf
    v_fma_f32 v69, v69, v9, v70
    v_mov_b32_dpp v70, v36 quad_perm:[1,0,3,2] row_mask:0xf bank_mask:0xf
    v_fma_f32 v36, v36, v9, v70
    v_mov_b32_dpp v70, v41 quad_perm:[1,0,3,2] row_mask:0xf bank_mask:0xf
    v_fma_f32 v41, v41, v9, v70
    v_mov_b32_dpp v70, v64 quad_perm:[1,0,3,2] row_mask:0xf bank_mask:0xf
    v_fma_f32 v64, v64, v9, v70
    v_mov_b32_dpp v70, v57 quad_perm:[1,0,3,2] row_mask:0xf bank_mask:0xf
    v_fma_f32 v57, v57, v9, v70
    v_mov_b32_dpp v70, v24 quad_perm:[1,0,3,2] row_mask:0xf bank_mask:0xf
    v_fma_f32 v24, v24, v9, v70
    v_mov_b32_dpp v70, v63 quad_perm:[1,0,3,2] row_mask:0xf bank_mask:0xf
    v_fma_f32 v63, v63, v9, v70
    v_mov_b32_dpp v70, v30 quad_perm:[1,0,3,2] row_mask:0xf bank_mask:0xf
    v_fma_f32 v30, v30, v9, v70
    v_mov_b32_dpp v70, v67 quad_perm:[1,0,3,2] row_mask:0xf bank_mask:0xf
    v_fma_f32 v67, v67, v9, v70
    v_mov_b32_dpp v70, v34 quad_perm:[1,0,3,2] row_mask:0xf bank_mask:0xf
    v_fma_f32 v34, v34, v9, v70
    v_mov_b32_dpp v70, v75 quad_perm:[1,0,3,2] row_mask:0xf bank_mask:0xf
    v_fma_f32 v75, v75, v9, v70
    v_mov_b32_dpp v70, v42 quad_perm:[1,0,3,2] row_mask:0xf bank_mask:0xf
    v_fma_f32 v42, v42, v9, v70
    v_mov_b32_dpp v70, v77 quad_perm:[1,0,3,2] row_mask:0xf bank_mask:0xf
    v_fma_f32 v77, v77, v9, v70
    v_mov_b32_dpp v70, v60 quad_perm:[1,0,3,2] row_mask:0xf bank_mask:0xf
    v_fma_f32 v60, v60, v9, v70
    v_mov_b32_dpp v70, v73 quad_perm:[1,0,3,2] row_mask:0xf bank_mask:0xf
    v_fma_f32 v73, v73, v9, v70
    v_mov_b32_dpp v70, v40 quad_perm:[1,0,3,2] row_mask:0xf bank_mask:0xf
    v_fma_f32 v40, v40, v9, v70
    v_mov_b32_dpp v70, v21 quad_perm:[1,0,3,2] row_mask:0xf bank_mask:0xf
    v_fma_f32 v21, v21, v9, v70
    v_mov_b32_dpp v70, v56 quad_perm:[1,0,3,2] row_mask:0xf bank_mask:0xf
    v_fma_f32 v56, v56, v9, v70
    v_mov_b32_dpp v70, v65 quad_perm:[1,0,3,2] row_mask:0xf bank_mask:0xf
    v_fma_f32 v65, v65, v9, v70
    v_mov_b32_dpp v70, v80 quad_perm:[1,0,3,2] row_mask:0xf bank_mask:0xf
    v_fma_f32 v80, v80, v9, v70
    v_mov_b32_dpp v70, v25 quad_perm:[1,0,3,2] row_mask:0xf bank_mask:0xf
    v_fma_f32 v25, v25, v9, v70
    v_mov_b32_dpp v70, v32 quad_perm:[1,0,3,2] row_mask:0xf bank_mask:0xf
    v_fma_f32 v32, v32, v9, v70
    v_mov_b32_dpp v70, v31 quad_perm:[1,0,3,2] row_mask:0xf bank_mask:0xf
    v_fma_f32 v31, v31, v9, v70
    v_mov_b32_dpp v70, v46 quad_perm:[1,0,3,2] row_mask:0xf bank_mask:0xf
    v_fma_f32 v46, v46, v9, v70
    v_mov_b32_dpp v70, v35 quad_perm:[1,0,3,2] row_mask:0xf bank_mask:0xf
    v_fma_f32 v35, v35, v9, v70
    v_mov_b32_dpp v70, v50 quad_perm:[1,0,3,2] row_mask:0xf bank_mask:0xf
    v_fma_f32 v50, v50, v9, v70
    v_mov_b32_dpp v70, v81 quad_perm:[1,0,3,2] row_mask:0xf bank_mask:0xf
    v_fma_f32 v81, v81, v9, v70
    v_mov_b32_dpp v70, v83 quad_perm:[1,0,3,2] row_mask:0xf bank_mask:0xf
    v_fma_f32 v83, v83, v9, v70
    v_mov_b32_dpp v70, v33 quad_perm:[1,0,3,2] row_mask:0xf bank_mask:0xf
    v_fma_f32 v33, v33, v9, v70
    v_mov_b32_dpp v70, v78 quad_perm:[1,0,3,2] row_mask:0xf bank_mask:0xf
    v_fma_f32 v78, v78, v9, v70
    v_mov_b32_dpp v70, v47 quad_perm:[1,0,3,2] row_mask:0xf bank_mask:0xf
    v_fma_f32 v47, v47, v9, v70
    v_mov_b32_dpp v70, v76 quad_perm:[1,0,3,2] row_mask:0xf bank_mask:0xf
    v_fma_f32 v76, v76, v9, v70
    v_mov_b32_dpp v70, v51 quad_perm:[1,0,3,2] row_mask:0xf bank_mask:0xf
    v_fma_f32 v51, v51, v9, v70
    v_mov_b32_dpp v70, v18 quad_perm:[1,0,3,2] row_mask:0xf bank_mask:0xf
    v_fma_f32 v18, v18, v9, v70
    v_mov_b32_dpp v70, v45 quad_perm:[1,0,3,2] row_mask:0xf bank_mask:0xf
    v_fma_f32 v45, v45, v9, v70
    v_mov_b32_dpp v70, v72 quad_perm:[1,0,3,2] row_mask:0xf bank_mask:0xf
    v_fma_f32 v72, v72, v9, v70
    v_mov_b32_dpp v70, v53 quad_perm:[1,0,3,2] row_mask:0xf bank_mask:0xf
    v_fma_f32 v53, v53, v9, v70
    v_mov_b32_dpp v70, v20 quad_perm:[1,0,3,2] row_mask:0xf bank_mask:0xf
    v_fma_f32 v20, v20, v9, v70
    v_mov_b32_dpp v70, v55 quad_perm:[1,0,3,2] row_mask:0xf bank_mask:0xf
    v_fma_f32 v55, v55, v9, v70
    v_mov_b32_dpp v70, v22 quad_perm:[1,0,3,2] row_mask:0xf bank_mask:0xf
    v_fma_f32 v22, v22, v9, v70
    v_mov_b32_dpp v70, v59 quad_perm:[1,0,3,2] row_mask:0xf bank_mask:0xf
    v_fma_f32 v59, v59, v9, v70
    s_waitcnt vmcnt(0)
    s_mov_b32 s20, 0x34800000
    v_lshlrev_b32 v70, 16, v88
    v_and_b32 v79, 0xffff0000, v88
    v_mul_f32 v70, s20, v70
    v_mul_f32 v79, s20, v79
    v_mul_f32 v82, v16, v70
    v_fma_f32 v82, -v17, v79, v82
    v_mul_f32 v17, v17, v70
    v_fmac_f32 v17, v16, v79
    v_lshlrev_b32 v70, 16, v89
    v_and_b32 v79, 0xffff0000, v89
    v_mul_f32 v70, s20, v70
    v_mul_f32 v79, s20, v79
    v_mul_f32 v16, v74, v70
    v_fma_f32 v16, -v49, v79, v16
    v_mul_f32 v49, v49, v70
    v_fmac_f32 v49, v74, v79
    v_lshlrev_b32 v70, 16, v90
    v_and_b32 v79, 0xffff0000, v90
    v_mul_f32 v70, s20, v70
    v_mul_f32 v79, s20, v79
    v_mul_f32 v74, v48, v70
    v_fma_f32 v74, -v19, v79, v74
    v_mul_f32 v19, v19, v70
    v_fmac_f32 v19, v48, v79
    v_lshlrev_b32 v70, 16, v91
    v_and_b32 v79, 0xffff0000, v91
    v_mul_f32 v70, s20, v70
    v_mul_f32 v79, s20, v79
    v_mul_f32 v48, v68, v70
    v_fma_f32 v48, -v23, v79, v48
    v_mul_f32 v23, v23, v70
    v_fmac_f32 v23, v68, v79
    v_lshlrev_b32 v70, 16, v92
    v_and_b32 v79, 0xffff0000, v92
    v_mul_f32 v70, s20, v70
    v_mul_f32 v79, s20, v79
    v_mul_f32 v68, v62, v70
    v_fma_f32 v68, -v27, v79, v68
    v_mul_f32 v27, v27, v70
    v_fmac_f32 v27, v62, v79
    v_lshlrev_b32 v70, 16, v93
    v_and_b32 v79, 0xffff0000, v93
    v_mul_f32 v70, s20, v70
    v_mul_f32 v79, s20, v79
    v_mul_f32 v62, v66, v70
    v_fma_f32 v62, -v39, v79, v62
    v_mul_f32 v39, v39, v70
    v_fmac_f32 v39, v66, v79
    v_lshlrev_b32 v70, 16, v94
    v_and_b32 v79, 0xffff0000, v94
    v_mul_f32 v70, s20, v70
    v_mul_f32 v79, s20, v79
    v_mul_f32 v66, v54, v70
    v_fma_f32 v66, -v29, v79, v66
    v_mul_f32 v29, v29, v70
    v_fmac_f32 v29, v54, v79
    v_lshlrev_b32 v70, 16, v95
    v_and_b32 v79, 0xffff0000, v95
    v_mul_f32 v70, s20, v70
    v_mul_f32 v79, s20, v79
    v_mul_f32 v54, v44, v70
    v_fma_f32 v54, -v37, v79, v54
    v_mul_f32 v37, v37, v70
    v_fmac_f32 v37, v44, v79
    v_lshlrev_b32 v70, 16, v96
    v_and_b32 v79, 0xffff0000, v96
    v_mul_f32 v70, s20, v70
    v_mul_f32 v79, s20, v79
    v_mul_f32 v44, v52, v70
    v_fma_f32 v44, -v43, v79, v44
    v_mul_f32 v43, v43, v70
    v_fmac_f32 v43, v52, v79
    v_lshlrev_b32 v70, 16, v97
    v_and_b32 v79, 0xffff0000, v97
    v_mul_f32 v70, s20, v70
    v_mul_f32 v79, s20, v79
    v_mul_f32 v52, v58, v70
    v_fma_f32 v52, -v71, v79, v52
    v_mul_f32 v71, v71, v70
    v_fmac_f32 v71, v58, v79
    v_lshlrev_b32 v70, 16, v98
    v_and_b32 v79, 0xffff0000, v98
    v_mul_f32 v70, s20, v70
    v_mul_f32 v79, s20, v79
    v_mul_f32 v58, v38, v70
    v_fma_f32 v58, -v61, v79, v58
    v_mul_f32 v61, v61, v70
    v_fmac_f32 v61, v38, v79
    v_lshlrev_b32 v70, 16, v99
    v_and_b32 v79, 0xffff0000, v99
    v_mul_f32 v70, s20, v70
    v_mul_f32 v79, s20, v79
    v_mul_f32 v38, v28, v70
    v_fma_f32 v38, -v69, v79, v38
    v_mul_f32 v69, v69, v70
    v_fmac_f32 v69, v28, v79
    v_lshlrev_b32 v70, 16, v100
    v_and_b32 v79, 0xffff0000, v100
    v_mul_f32 v70, s20, v70
    v_mul_f32 v79, s20, v79
    v_mul_f32 v28, v36, v70
    v_fma_f32 v28, -v41, v79, v28
    v_mul_f32 v41, v41, v70
    v_fmac_f32 v41, v36, v79
    v_lshlrev_b32 v70, 16, v101
    v_and_b32 v79, 0xffff0000, v101
    v_mul_f32 v70, s20, v70
    v_mul_f32 v79, s20, v79
    v_mul_f32 v36, v64, v70
    v_fma_f32 v36, -v57, v79, v36
    v_mul_f32 v57, v57, v70
    v_fmac_f32 v57, v64, v79
    v_lshlrev_b32 v70, 16, v102
    v_and_b32 v79, 0xffff0000, v102
    v_mul_f32 v70, s20, v70
    v_mul_f32 v79, s20, v79
    v_mul_f32 v64, v24, v70
    v_fma_f32 v64, -v63, v79, v64
    v_mul_f32 v63, v63, v70
    v_fmac_f32 v63, v24, v79
    v_lshlrev_b32 v70, 16, v103
    v_and_b32 v79, 0xffff0000, v103
    v_mul_f32 v70, s20, v70
    v_mul_f32 v79, s20, v79
    v_mul_f32 v24, v30, v70
    v_fma_f32 v24, -v67, v79, v24
    v_mul_f32 v67, v67, v70
    v_fmac_f32 v67, v30, v79
    v_lshlrev_b32 v70, 16, v104
    v_and_b32 v79, 0xffff0000, v104
    v_mul_f32 v70, s20, v70
    v_mul_f32 v79, s20, v79
    v_mul_f32 v30, v34, v70
    v_fma_f32 v30, -v75, v79, v30
    v_mul_f32 v75, v75, v70
    v_fmac_f32 v75, v34, v79
    v_lshlrev_b32 v70, 16, v105
    v_and_b32 v79, 0xffff0000, v105
    v_mul_f32 v70, s20, v70
    v_mul_f32 v79, s20, v79
    v_mul_f32 v34, v42, v70
    v_fma_f32 v34, -v77, v79, v34
    v_mul_f32 v77, v77, v70
    v_fmac_f32 v77, v42, v79
    v_lshlrev_b32 v70, 16, v106
    v_and_b32 v79, 0xffff0000, v106
    v_mul_f32 v70, s20, v70
    v_mul_f32 v79, s20, v79
    v_mul_f32 v42, v60, v70
    v_fma_f32 v42, -v73, v79, v42
    v_mul_f32 v73, v73, v70
    v_fmac_f32 v73, v60, v79
    v_lshlrev_b32 v70, 16, v107
    v_and_b32 v79, 0xffff0000, v107
    v_mul_f32 v70, s20, v70
    v_mul_f32 v79, s20, v79
    v_mul_f32 v60, v40, v70
    v_fma_f32 v60, -v21, v79, v60
    v_mul_f32 v21, v21, v70
    v_fmac_f32 v21, v40, v79
    v_lshlrev_b32 v70, 16, v108
    v_and_b32 v79, 0xffff0000, v108
    v_mul_f32 v70, s20, v70
    v_mul_f32 v79, s20, v79
    v_mul_f32 v40, v56, v70
    v_fma_f32 v40, -v65, v79, v40
    v_mul_f32 v65, v65, v70
    v_fmac_f32 v65, v56, v79
    v_lshlrev_b32 v70, 16, v109
    v_and_b32 v79, 0xffff0000, v109
    v_mul_f32 v70, s20, v70
    v_mul_f32 v79, s20, v79
    v_mul_f32 v56, v80, v70
    v_fma_f32 v56, -v25, v79, v56
    v_mul_f32 v25, v25, v70
    v_fmac_f32 v25, v80, v79
    v_lshlrev_b32 v70, 16, v110
    v_and_b32 v79, 0xffff0000, v110
    v_mul_f32 v70, s20, v70
    v_mul_f32 v79, s20, v79
    v_mul_f32 v80, v32, v70
    v_fma_f32 v80, -v31, v79, v80
    v_mul_f32 v31, v31, v70
    v_fmac_f32 v31, v32, v79
    v_lshlrev_b32 v70, 16, v111
    v_and_b32 v79, 0xffff0000, v111
    v_mul_f32 v70, s20, v70
    v_mul_f32 v79, s20, v79
    v_mul_f32 v32, v46, v70
    v_fma_f32 v32, -v35, v79, v32
    v_mul_f32 v35, v35, v70
    v_fmac_f32 v35, v46, v79
    v_lshlrev_b32 v70, 16, v112
    v_and_b32 v79, 0xffff0000, v112
    v_mul_f32 v70, s20, v70
    v_mul_f32 v79, s20, v79
    v_mul_f32 v46, v50, v70
    v_fma_f32 v46, -v81, v79, v46
    v_mul_f32 v81, v81, v70
    v_fmac_f32 v81, v50, v79
    v_lshlrev_b32 v70, 16, v113
    v_and_b32 v79, 0xffff0000, v113
    v_mul_f32 v70, s20, v70
    v_mul_f32 v79, s20, v79
    v_mul_f32 v50, v83, v70
    v_fma_f32 v50, -v33, v79, v50
    v_mul_f32 v33, v33, v70
    v_fmac_f32 v33, v83, v79
    v_lshlrev_b32 v70, 16, v114
    v_and_b32 v79, 0xffff0000, v114
    v_mul_f32 v70, s20, v70
    v_mul_f32 v79, s20, v79
    v_mul_f32 v83, v78, v70
    v_fma_f32 v83, -v47, v79, v83
    v_mul_f32 v47, v47, v70
    v_fmac_f32 v47, v78, v79
    v_lshlrev_b32 v70, 16, v115
    v_and_b32 v79, 0xffff0000, v115
    v_mul_f32 v70, s20, v70
    v_mul_f32 v79, s20, v79
    v_mul_f32 v78, v76, v70
    v_fma_f32 v78, -v51, v79, v78
    v_mul_f32 v51, v51, v70
    v_fmac_f32 v51, v76, v79
    v_lshlrev_b32 v70, 16, v116
    v_and_b32 v79, 0xffff0000, v116
    v_mul_f32 v70, s20, v70
    v_mul_f32 v79, s20, v79
    v_mul_f32 v76, v18, v70
    v_fma_f32 v76, -v45, v79, v76
    v_mul_f32 v45, v45, v70
    v_fmac_f32 v45, v18, v79
    v_lshlrev_b32 v70, 16, v117
    v_and_b32 v79, 0xffff0000, v117
    v_mul_f32 v70, s20, v70
    v_mul_f32 v79, s20, v79
    v_mul_f32 v18, v72, v70
    v_fma_f32 v18, -v53, v79, v18
    v_mul_f32 v53, v53, v70
    v_fmac_f32 v53, v72, v79
    v_lshlrev_b32 v70, 16, v118
    v_and_b32 v79, 0xffff0000, v118
    v_mul_f32 v70, s20, v70
    v_mul_f32 v79, s20, v79
    v_mul_f32 v72, v20, v70
    v_fma_f32 v72, -v55, v79, v72
    v_mul_f32 v55, v55, v70
    v_fmac_f32 v55, v20, v79
    v_lshlrev_b32 v70, 16, v119
    v_and_b32 v79, 0xffff0000, v119
    v_mul_f32 v70, s20, v70
    v_mul_f32 v79, s20, v79
    v_mul_f32 v20, v22, v70
    v_fma_f32 v20, -v59, v79, v20
    v_mul_f32 v59, v59, v70
    v_fmac_f32 v59, v22, v79
    s_waitcnt vmcnt(0)
    ds_read_b64_tr_b16 a[64:65], v201 offset:0
    ds_read_b64_tr_b16 a[66:67], v201 offset:256
    ds_read_b64_tr_b16 a[68:69], v201 offset:1024
    ds_read_b64_tr_b16 a[70:71], v201 offset:1280
    ds_read_b64_tr_b16 a[72:73], v201 offset:2048
    ds_read_b64_tr_b16 a[74:75], v201 offset:2304
    ds_read_b64_tr_b16 a[76:77], v201 offset:3072
    ds_read_b64_tr_b16 a[78:79], v201 offset:3328
    s_waitcnt lgkmcnt(0)
    ds_read_b64_tr_b16 a[80:81], v201 offset:4096
    ds_read_b64_tr_b16 a[82:83], v201 offset:4352
    ds_read_b64_tr_b16 a[84:85], v201 offset:5120
    ds_read_b64_tr_b16 a[86:87], v201 offset:5376
    ds_read_b64_tr_b16 a[88:89], v201 offset:6144
    ds_read_b64_tr_b16 a[90:91], v201 offset:6400
    ds_read_b64_tr_b16 a[92:93], v201 offset:7168
    ds_read_b64_tr_b16 a[94:95], v201 offset:7424
    s_waitcnt lgkmcnt(0)
    ds_read_b64_tr_b16 a[96:97], v201 offset:8192
    ds_read_b64_tr_b16 a[98:99], v201 offset:8448
    ds_read_b64_tr_b16 a[100:101], v201 offset:9216
    ds_read_b64_tr_b16 a[102:103], v201 offset:9472
    ds_read_b64_tr_b16 a[104:105], v201 offset:10240
    ds_read_b64_tr_b16 a[106:107], v201 offset:10496
    ds_read_b64_tr_b16 a[108:109], v201 offset:11264
    ds_read_b64_tr_b16 a[110:111], v201 offset:11520
    s_waitcnt lgkmcnt(0)
    ds_read_b64_tr_b16 a[112:113], v201 offset:12288
    ds_read_b64_tr_b16 a[114:115], v201 offset:12544
    ds_read_b64_tr_b16 a[116:117], v201 offset:13312
    ds_read_b64_tr_b16 a[118:119], v201 offset:13568
    ds_read_b64_tr_b16 a[120:121], v201 offset:14336
    ds_read_b64_tr_b16 a[122:123], v201 offset:14592
    ds_read_b64_tr_b16 a[124:125], v201 offset:15360
    ds_read_b64_tr_b16 a[126:127], v201 offset:15616
    s_waitcnt lgkmcnt(0)
    s_add_u32 m0, s56, 0
    s_add_u32 s58, s57, 32768
    s_and_b32 s58, s58, 0xffff
    s_lshl_b32 s58, s58, 5
    buffer_load_dwordx4 v200, s[52:55], s58 offen lds
    s_add_u32 m0, s56, 1024
    s_add_u32 s58, s57, 33792
    s_and_b32 s58, s58, 0xffff
    s_lshl_b32 s58, s58, 5
    buffer_load_dwordx4 v200, s[52:55], s58 offen lds
    s_add_u32 m0, s56, 2048
    s_add_u32 s58, s57, 34816
    s_and_b32 s58, s58, 0xffff
    s_lshl_b32 s58, s58, 5
    buffer_load_dwordx4 v200, s[52:55], s58 offen lds
    s_add_u32 m0, s56, 3072
    s_add_u32 s58, s57, 35840
    s_and_b32 s58, s58, 0xffff
    s_lshl_b32 s58, s58, 5
    buffer_load_dwordx4 v200, s[52:55], s58 offen lds
    s_add_u32 m0, s56, 4096
    s_add_u32 s58, s57, 36864
    s_and_b32 s58, s58, 0xffff
    s_lshl_b32 s58, s58, 5
    buffer_load_dwordx4 v200, s[52:55], s58 offen lds
    s_add_u32 m0, s56, 5120
    s_add_u32 s58, s57, 37888
    s_and_b32 s58, s58, 0xffff
    s_lshl_b32 s58, s58, 5
    buffer_load_dwordx4 v200, s[52:55], s58 offen lds
    s_add_u32 m0, s56, 6144
    s_add_u32 s58, s57, 38912
    s_and_b32 s58, s58, 0xffff
    s_lshl_b32 s58, s58, 5
    buffer_load_dwordx4 v200, s[52:55], s58 offen lds
    s_add_u32 m0, s56, 7168
    s_add_u32 s58, s57, 39936
    s_and_b32 s58, s58, 0xffff
    s_lshl_b32 s58, s58, 5
    buffer_load_dwordx4 v200, s[52:55], s58 offen lds
    s_add_u32 m0, s56, 8192
    s_add_u32 s58, s57, 40960
    s_and_b32 s58, s58, 0xffff
    s_lshl_b32 s58, s58, 5
    buffer_load_dwordx4 v200, s[52:55], s58 offen lds
    s_add_u32 m0, s56, 9216
    s_add_u32 s58, s57, 41984
    s_and_b32 s58, s58, 0xffff
    s_lshl_b32 s58, s58, 5
    buffer_load_dwordx4 v200, s[52:55], s58 offen lds
    s_add_u32 m0, s56, 10240
    s_add_u32 s58, s57, 43008
    s_and_b32 s58, s58, 0xffff
    s_lshl_b32 s58, s58, 5
    buffer_load_dwordx4 v200, s[52:55], s58 offen lds
    s_add_u32 m0, s56, 11264
    s_add_u32 s58, s57, 44032
    s_and_b32 s58, s58, 0xffff
    s_lshl_b32 s58, s58, 5
    buffer_load_dwordx4 v200, s[52:55], s58 offen lds
    s_add_u32 m0, s56, 12288
    s_add_u32 s58, s57, 45056
    s_and_b32 s58, s58, 0xffff
    s_lshl_b32 s58, s58, 5
    buffer_load_dwordx4 v200, s[52:55], s58 offen lds
    s_add_u32 m0, s56, 13312
    s_add_u32 s58, s57, 46080
    s_and_b32 s58, s58, 0xffff
    s_lshl_b32 s58, s58, 5
    buffer_load_dwordx4 v200, s[52:55], s58 offen lds
    s_add_u32 m0, s56, 14336
    s_add_u32 s58, s57, 47104
    s_and_b32 s58, s58, 0xffff
    s_lshl_b32 s58, s58, 5
    buffer_load_dwordx4 v200, s[52:55], s58 offen lds
    s_add_u32 m0, s56, 15360
    s_add_u32 s58, s57, 48128
    s_and_b32 s58, s58, 0xffff
    s_lshl_b32 s58, s58, 5
    buffer_load_dwordx4 v200, s[52:55], s58 offen lds
    s_nop 1
    v_mov_b32_dpp v70, v82 quad_perm:[1,0,3,2] row_mask:0xf bank_mask:0xf
    v_fma_f32 v82, v82, v9, v70
    v_mov_b32_dpp v70, v17 quad_perm:[1,0,3,2] row_mask:0xf bank_mask:0xf
    v_fma_f32 v17, v17, v9, v70
    v_mov_b32_dpp v70, v16 quad_perm:[1,0,3,2] row_mask:0xf bank_mask:0xf
    v_fma_f32 v16, v16, v9, v70
    v_mov_b32_dpp v70, v49 quad_perm:[1,0,3,2] row_mask:0xf bank_mask:0xf
    v_fma_f32 v49, v49, v9, v70
    v_mov_b32_dpp v70, v74 quad_perm:[1,0,3,2] row_mask:0xf bank_mask:0xf
    v_fma_f32 v74, v74, v9, v70
    v_mov_b32_dpp v70, v19 quad_perm:[1,0,3,2] row_mask:0xf bank_mask:0xf
    v_fma_f32 v19, v19, v9, v70
    v_mov_b32_dpp v70, v48 quad_perm:[1,0,3,2] row_mask:0xf bank_mask:0xf
    v_fma_f32 v48, v48, v9, v70
    v_mov_b32_dpp v70, v23 quad_perm:[1,0,3,2] row_mask:0xf bank_mask:0xf
    v_fma_f32 v23, v23, v9, v70
    v_mov_b32_dpp v70, v68 quad_perm:[1,0,3,2] row_mask:0xf bank_mask:0xf
    v_fma_f32 v68, v68, v9, v70
    v_mov_b32_dpp v70, v27 quad_perm:[1,0,3,2] row_mask:0xf bank_mask:0xf
    v_fma_f32 v27, v27, v9, v70
    v_mov_b32_dpp v70, v62 quad_perm:[1,0,3,2] row_mask:0xf bank_mask:0xf
    v_fma_f32 v62, v62, v9, v70
    v_mov_b32_dpp v70, v39 quad_perm:[1,0,3,2] row_mask:0xf bank_mask:0xf
    v_fma_f32 v39, v39, v9, v70
    v_mov_b32_dpp v70, v66 quad_perm:[1,0,3,2] row_mask:0xf bank_mask:0xf
    v_fma_f32 v66, v66, v9, v70
    v_mov_b32_dpp v70, v29 quad_perm:[1,0,3,2] row_mask:0xf bank_mask:0xf
    v_fma_f32 v29, v29, v9, v70
    v_mov_b32_dpp v70, v54 quad_perm:[1,0,3,2] row_mask:0xf bank_mask:0xf
    v_fma_f32 v54, v54, v9, v70
    v_mov_b32_dpp v70, v37 quad_perm:[1,0,3,2] row_mask:0xf bank_mask:0xf
    v_fma_f32 v37, v37, v9, v70
    v_mov_b32_dpp v70, v44 quad_perm:[1,0,3,2] row_mask:0xf bank_mask:0xf
    v_fma_f32 v44, v44, v9, v70
    v_mov_b32_dpp v70, v43 quad_perm:[1,0,3,2] row_mask:0xf bank_mask:0xf
    v_fma_f32 v43, v43, v9, v70
    v_mov_b32_dpp v70, v52 quad_perm:[1,0,3,2] row_mask:0xf bank_mask:0xf
    v_fma_f32 v52, v52, v9, v70
    v_mov_b32_dpp v70, v71 quad_perm:[1,0,3,2] row_mask:0xf bank_mask:0xf
    v_fma_f32 v71, v71, v9, v70
    v_mov_b32_dpp v70, v58 quad_perm:[1,0,3,2] row_mask:0xf bank_mask:0xf
    v_fma_f32 v58, v58, v9, v70
    v_mov_b32_dpp v70, v61 quad_perm:[1,0,3,2] row_mask:0xf bank_mask:0xf
    v_fma_f32 v61, v61, v9, v70
    v_mov_b32_dpp v70, v38 quad_perm:[1,0,3,2] row_mask:0xf bank_mask:0xf
    v_fma_f32 v38, v38, v9, v70
    v_mov_b32_dpp v70, v69 quad_perm:[1,0,3,2] row_mask:0xf bank_mask:0xf
    v_fma_f32 v69, v69, v9, v70
    v_mov_b32_dpp v70, v28 quad_perm:[1,0,3,2] row_mask:0xf bank_mask:0xf
    v_fma_f32 v28, v28, v9, v70
    v_mov_b32_dpp v70, v41 quad_perm:[1,0,3,2] row_mask:0xf bank_mask:0xf
    v_fma_f32 v41, v41, v9, v70
    v_mov_b32_dpp v70, v36 quad_perm:[1,0,3,2] row_mask:0xf bank_mask:0xf
    v_fma_f32 v36, v36, v9, v70
    v_mov_b32_dpp v70, v57 quad_perm:[1,0,3,2] row_mask:0xf bank_mask:0xf
    v_fma_f32 v57, v57, v9, v70
    v_mov_b32_dpp v70, v64 quad_perm:[1,0,3,2] row_mask:0xf bank_mask:0xf
    v_fma_f32 v64, v64, v9, v70
    v_mov_b32_dpp v70, v63 quad_perm:[1,0,3,2] row_mask:0xf bank_mask:0xf
    v_fma_f32 v63, v63, v9, v70
    v_mov_b32_dpp v70, v24 quad_perm:[1,0,3,2] row_mask:0xf bank_mask:0xf
    v_fma_f32 v24, v24, v9, v70
    v_mov_b32_dpp v70, v67 quad_perm:[1,0,3,2] row_mask:0xf bank_mask:0xf
    v_fma_f32 v67, v67, v9, v70
    v_mov_b32_dpp v70, v30 quad_perm:[1,0,3,2] row_mask:0xf bank_mask:0xf
    v_fma_f32 v30, v30, v9, v70
    v_mov_b32_dpp v70, v75 quad_perm:[1,0,3,2] row_mask:0xf bank_mask:0xf
    v_fma_f32 v75, v75, v9, v70
    v_mov_b32_dpp v70, v34 quad_perm:[1,0,3,2] row_mask:0xf bank_mask:0xf
    v_fma_f32 v34, v34, v9, v70
    v_mov_b32_dpp v70, v77 quad_perm:[1,0,3,2] row_mask:0xf bank_mask:0xf
    v_fma_f32 v77, v77, v9, v70
    v_mov_b32_dpp v70, v42 quad_perm:[1,0,3,2] row_mask:0xf bank_mask:0xf
    v_fma_f32 v42, v42, v9, v70
    v_mov_b32_dpp v70, v73 quad_perm:[1,0,3,2] row_mask:0xf bank_mask:0xf
    v_fma_f32 v73, v73, v9, v70
    v_mov_b32_dpp v70, v60 quad_perm:[1,0,3,2] row_mask:0xf bank_mask:0xf
    v_fma_f32 v60, v60, v9, v70
    v_mov_b32_dpp v70, v21 quad_perm:[1,0,3,2] row_mask:0xf bank_mask:0xf
    v_fma_f32 v21, v21, v9, v70
    v_mov_b32_dpp v70, v40 quad_perm:[1,0,3,2] row_mask:0xf bank_mask:0xf
    v_fma_f32 v40, v40, v9, v70
    v_mov_b32_dpp v70, v65 quad_perm:[1,0,3,2] row_mask:0xf bank_mask:0xf
    v_fma_f32 v65, v65, v9, v70
    v_mov_b32_dpp v70, v56 quad_perm:[1,0,3,2] row_mask:0xf bank_mask:0xf
    v_fma_f32 v56, v56, v9, v70
    v_mov_b32_dpp v70, v25 quad_perm:[1,0,3,2] row_mask:0xf bank_mask:0xf
    v_fma_f32 v25, v25, v9, v70
    v_mov_b32_dpp v70, v80 quad_perm:[1,0,3,2] row_mask:0xf bank_mask:0xf
    v_fma_f32 v80, v80, v9, v70
    v_mov_b32_dpp v70, v31 quad_perm:[1,0,3,2] row_mask:0xf bank_mask:0xf
    v_fma_f32 v31, v31, v9, v70
    v_mov_b32_dpp v70, v32 quad_perm:[1,0,3,2] row_mask:0xf bank_mask:0xf
    v_fma_f32 v32, v32, v9, v70
    v_mov_b32_dpp v70, v35 quad_perm:[1,0,3,2] row_mask:0xf bank_mask:0xf
    v_fma_f32 v35, v35, v9, v70
    v_mov_b32_dpp v70, v46 quad_perm:[1,0,3,2] row_mask:0xf bank_mask:0xf
    v_fma_f32 v46, v46, v9, v70
    v_mov_b32_dpp v70, v81 quad_perm:[1,0,3,2] row_mask:0xf bank_mask:0xf
    v_fma_f32 v81, v81, v9, v70
    v_mov_b32_dpp v70, v50 quad_perm:[1,0,3,2] row_mask:0xf bank_mask:0xf
    v_fma_f32 v50, v50, v9, v70
    v_mov_b32_dpp v70, v33 quad_perm:[1,0,3,2] row_mask:0xf bank_mask:0xf
    v_fma_f32 v33, v33, v9, v70
    v_mov_b32_dpp v70, v83 quad_perm:[1,0,3,2] row_mask:0xf bank_mask:0xf
    v_fma_f32 v83, v83, v9, v70
    v_mov_b32_dpp v70, v47 quad_perm:[1,0,3,2] row_mask:0xf bank_mask:0xf
    v_fma_f32 v47, v47, v9, v70
    v_mov_b32_dpp v70, v78 quad_perm:[1,0,3,2] row_mask:0xf bank_mask:0xf
    v_fma_f32 v78, v78, v9, v70
    v_mov_b32_dpp v70, v51 quad_perm:[1,0,3,2] row_mask:0xf bank_mask:0xf
    v_fma_f32 v51, v51, v9, v70
    v_mov_b32_dpp v70, v76 quad_perm:[1,0,3,2] row_mask:0xf bank_mask:0xf
    v_fma_f32 v76, v76, v9, v70
    v_mov_b32_dpp v70, v45 quad_perm:[1,0,3,2] row_mask:0xf bank_mask:0xf
    v_fma_f32 v45, v45, v9, v70
    v_mov_b32_dpp v70, v18 quad_perm:[1,0,3,2] row_mask:0xf bank_mask:0xf
    v_fma_f32 v18, v18, v9, v70
    v_mov_b32_dpp v70, v53 quad_perm:[1,0,3,2] row_mask:0xf bank_mask:0xf
    v_fma_f32 v53, v53, v9, v70
    v_mov_b32_dpp v70, v72 quad_perm:[1,0,3,2] row_mask:0xf bank_mask:0xf
    v_fma_f32 v72, v72, v9, v70
    v_mov_b32_dpp v70, v55 quad_perm:[1,0,3,2] row_mask:0xf bank_mask:0xf
    v_fma_f32 v55, v55, v9, v70
    v_mov_b32_dpp v70, v20 quad_perm:[1,0,3,2] row_mask:0xf bank_mask:0xf
    v_fma_f32 v20, v20, v9, v70
    v_mov_b32_dpp v70, v59 quad_perm:[1,0,3,2] row_mask:0xf bank_mask:0xf
    v_fma_f32 v59, v59, v9, v70
    v_mul_f32 v70, 0x3c800000, v10
    v_cos_f32 v79, v70
    v_sin_f32 v22, v70
    s_nop 0
    v_mul_f32 v26, v16, v79
    v_fma_f32 v26, -v49, v22, v26
    v_mul_f32 v49, v49, v79
    v_fmac_f32 v49, v16, v22
    v_mul_f32 v70, 0x3d000000, v10
    v_cos_f32 v79, v70
    v_sin_f32 v22, v70
    s_nop 0
    v_mul_f32 v16, v74, v79
    v_fma_f32 v16, -v19, v22, v16
    v_mul_f32 v19, v19, v79
    v_fmac_f32 v19, v74, v22
    v_mul_f32 v70, 0x3d400000, v10
    v_cos_f32 v79, v70
    v_sin_f32 v22, v70
    s_nop 0
    v_mul_f32 v74, v48, v79
    v_fma_f32 v74, -v23, v22, v74
    v_mul_f32 v23, v23, v79
    v_fmac_f32 v23, v48, v22
    v_mul_f32 v70, 0x3d800000, v10
    v_cos_f32 v79, v70
    v_sin_f32 v22, v70
    s_nop 0
    v_mul_f32 v48, v68, v79
    v_fma_f32 v48, -v27, v22, v48
    v_mul_f32 v27, v27, v79
    v_fmac_f32 v27, v68, v22
    v_mul_f32 v70, 0x3da00000, v10
    v_cos_f32 v79, v70
    v_sin_f32 v22, v70
    s_nop 0
    v_mul_f32 v68, v62, v79
    v_fma_f32 v68, -v39, v22, v68
    v_mul_f32 v39, v39, v79
    v_fmac_f32 v39, v62, v22
    v_mul_f32 v70, 0x3dc00000, v10
    v_cos_f32 v79, v70
    v_sin_f32 v22, v70
    s_nop 0
    v_mul_f32 v62, v66, v79
    v_fma_f32 v62, -v29, v22, v62
    v_mul_f32 v29, v29, v79
    v_fmac_f32 v29, v66, v22
    v_mul_f32 v70, 0x3de00000, v10
    v_cos_f32 v79, v70
    v_sin_f32 v22, v70
    s_nop 0
    v_mul_f32 v66, v54, v79
    v_fma_f32 v66, -v37, v22, v66
    v_mul_f32 v37, v37, v79
    v_fmac_f32 v37, v54, v22
    v_mul_f32 v70, 0x3e000000, v10
    v_cos_f32 v79, v70
    v_sin_f32 v22, v70
    s_nop 0
    v_mul_f32 v54, v44, v79
    v_fma_f32 v54, -v43, v22, v54
    v_mul_f32 v43, v43, v79
    v_fmac_f32 v43, v44, v22
    v_mul_f32 v70, 0x3e100000, v10
    v_cos_f32 v79, v70
    v_sin_f32 v22, v70
    s_nop 0
    v_mul_f32 v44, v52, v79
    v_fma_f32 v44, -v71, v22, v44
    v_mul_f32 v71, v71, v79
    v_fmac_f32 v71, v52, v22
    v_mul_f32 v70, 0x3e200000, v10
    v_cos_f32 v79, v70
    v_sin_f32 v22, v70
    s_nop 0
    v_mul_f32 v52, v58, v79
    v_fma_f32 v52, -v61, v22, v52
    v_mul_f32 v61, v61, v79
    v_fmac_f32 v61, v58, v22
    v_mul_f32 v70, 0x3e300000, v10
    v_cos_f32 v79, v70
    v_sin_f32 v22, v70
    s_nop 0
    v_mul_f32 v58, v38, v79
    v_fma_f32 v58, -v69, v22, v58
    v_mul_f32 v69, v69, v79
    v_fmac_f32 v69, v38, v22
    v_mul_f32 v70, 0x3e400000, v10
    v_cos_f32 v79, v70
    v_sin_f32 v22, v70
    s_nop 0
    v_mul_f32 v38, v28, v79
    v_fma_f32 v38, -v41, v22, v38
    v_mul_f32 v41, v41, v79
    v_fmac_f32 v41, v28, v22
    v_mul_f32 v70, 0x3e500000, v10
    v_cos_f32 v79, v70
    v_sin_f32 v22, v70
    s_nop 0
    v_mul_f32 v28, v36, v79
    v_fma_f32 v28, -v57, v22, v28
    v_mul_f32 v57, v57, v79
    v_fmac_f32 v57, v36, v22
    v_mul_f32 v70, 0x3e600000, v10
    v_cos_f32 v79, v70
    v_sin_f32 v22, v70
    s_nop 0
    v_mul_f32 v36, v64, v79
    v_fma_f32 v36, -v63, v22, v36
    v_mul_f32 v63, v63, v79
    v_fmac_f32 v63, v64, v22
    v_mul_f32 v70, 0x3e700000, v10
    v_cos_f32 v79, v70
    v_sin_f32 v22, v70
    s_nop 0
    v_mul_f32 v64, v24, v79
    v_fma_f32 v64, -v67, v22, v64
    v_mul_f32 v67, v67, v79
    v_fmac_f32 v67, v24, v22
    v_mul_f32 v70, 0x3e800000, v10
    v_cos_f32 v79, v70
    v_sin_f32 v22, v70
    s_nop 0
    v_mul_f32 v24, v30, v79
    v_fma_f32 v24, -v75, v22, v24
    v_mul_f32 v75, v75, v79
    v_fmac_f32 v75, v30, v22
    v_mul_f32 v70, 0x3e880000, v10
    v_cos_f32 v79, v70
    v_sin_f32 v22, v70
    s_nop 0
    v_mul_f32 v30, v34, v79
    v_fma_f32 v30, -v77, v22, v30
    v_mul_f32 v77, v77, v79
    v_fmac_f32 v77, v34, v22
    v_mul_f32 v70, 0x3e900000, v10
    v_cos_f32 v79, v70
    v_sin_f32 v22, v70
    s_nop 0
    v_mul_f32 v34, v42, v79
    v_fma_f32 v34, -v73, v22, v34
    v_mul_f32 v73, v73, v79
    v_fmac_f32 v73, v42, v22
    v_mul_f32 v70, 0x3e980000, v10
    v_cos_f32 v79, v70
    v_sin_f32 v22, v70
    s_nop 0
    v_mul_f32 v42, v60, v79
    v_fma_f32 v42, -v21, v22, v42
    v_mul_f32 v21, v21, v79
    v_fmac_f32 v21, v60, v22
    v_mul_f32 v70, 0x3ea00000, v10
    v_cos_f32 v79, v70
    v_sin_f32 v22, v70
    s_nop 0
    v_mul_f32 v60, v40, v79
    v_fma_f32 v60, -v65, v22, v60
    v_mul_f32 v65, v65, v79
    v_fmac_f32 v65, v40, v22
    v_mul_f32 v70, 0x3ea80000, v10
    v_cos_f32 v79, v70
    v_sin_f32 v22, v70
    s_nop 0
    v_mul_f32 v40, v56, v79
    v_fma_f32 v40, -v25, v22, v40
    v_mul_f32 v25, v25, v79
    v_fmac_f32 v25, v56, v22
    v_mul_f32 v70, 0x3eb00000, v10
    v_cos_f32 v79, v70
    v_sin_f32 v22, v70
    s_nop 0
    v_mul_f32 v56, v80, v79
    v_fma_f32 v56, -v31, v22, v56
    v_mul_f32 v31, v31, v79
    v_fmac_f32 v31, v80, v22
    v_mul_f32 v70, 0x3eb80000, v10
    v_cos_f32 v79, v70
    v_sin_f32 v22, v70
    s_nop 0
    v_mul_f32 v80, v32, v79
    v_fma_f32 v80, -v35, v22, v80
    v_mul_f32 v35, v35, v79
    v_fmac_f32 v35, v32, v22
    v_mul_f32 v70, 0x3ec00000, v10
    v_cos_f32 v79, v70
    v_sin_f32 v22, v70
    s_nop 0
    v_mul_f32 v32, v46, v79
    v_fma_f32 v32, -v81, v22, v32
    v_mul_f32 v81, v81, v79
    v_fmac_f32 v81, v46, v22
    v_mul_f32 v70, 0x3ec80000, v10
    v_cos_f32 v79, v70
    v_sin_f32 v22, v70
    s_nop 0
    v_mul_f32 v46, v50, v79
    v_fma_f32 v46, -v33, v22, v46
    v_mul_f32 v33, v33, v79
    v_fmac_f32 v33, v50, v22
    v_mul_f32 v70, 0x3ed00000, v10
    v_cos_f32 v79, v70
    v_sin_f32 v22, v70
    s_nop 0
    v_mul_f32 v50, v83, v79
    v_fma_f32 v50, -v47, v22, v50
    v_mul_f32 v47, v47, v79
    v_fmac_f32 v47, v83, v22
    v_mul_f32 v70, 0x3ed80000, v10
    v_cos_f32 v79, v70
    v_sin_f32 v22, v70
    s_nop 0
    v_mul_f32 v83, v78, v79
    v_fma_f32 v83, -v51, v22, v83
    v_mul_f32 v51, v51, v79
    v_fmac_f32 v51, v78, v22
    v_mul_f32 v70, 0x3ee00000, v10
    v_cos_f32 v79, v70
    v_sin_f32 v22, v70
    s_nop 0
    v_mul_f32 v78, v76, v79
    v_fma_f32 v78, -v45, v22, v78
    v_mul_f32 v45, v45, v79
    v_fmac_f32 v45, v76, v22
    v_mul_f32 v70, 0x3ee80000, v10
    v_cos_f32 v79, v70
    v_sin_f32 v22, v70
    s_nop 0
    v_mul_f32 v76, v18, v79
    v_fma_f32 v76, -v53, v22, v76
    v_mul_f32 v53, v53, v79
    v_fmac_f32 v53, v18, v22
    v_mul_f32 v70, 0x3ef00000, v10
    v_cos_f32 v79, v70
    v_sin_f32 v22, v70
    s_nop 0
    v_mul_f32 v18, v72, v79
    v_fma_f32 v18, -v55, v22, v18
    v_mul_f32 v55, v55, v79
    v_fmac_f32 v55, v72, v22
    v_mul_f32 v70, 0x3ef80000, v10
    v_cos_f32 v79, v70
    v_sin_f32 v22, v70
    s_nop 0
    v_mul_f32 v72, v20, v79
    v_fma_f32 v72, -v59, v22, v72
    v_mul_f32 v59, v59, v79
    v_fmac_f32 v59, v20, v22
    v_sub_f32 v70, v82, v24
    v_sub_f32 v79, v17, v75
    v_add_f32 v82, v82, v24
    v_add_f32 v17, v17, v75
    v_sub_f32 v24, v26, v30
    v_sub_f32 v75, v49, v77
    v_add_f32 v26, v26, v30
    v_add_f32 v49, v49, v77
    v_mul_f32 v30, 0x3f7b14be, v24
    v_mul_f32 v77, 0x3e47c5c2, v24
    v_fmac_f32 v30, 0xbe47c5c2, v75
    v_fmac_f32 v77, 0x3f7b14be, v75
    v_sub_f32 v24, v16, v34
    v_sub_f32 v75, v19, v73
    v_add_f32 v16, v16, v34
    v_add_f32 v19, v19, v73
    v_mul_f32 v34, 0x3f6c835e, v24
    v_mul_f32 v73, 0x3ec3ef15, v24
    v_fmac_f32 v34, 0xbec3ef15, v75
    v_fmac_f32 v73, 0x3f6c835e, v75
    v_sub_f32 v24, v74, v42
    v_sub_f32 v75, v23, v21
    v_add_f32 v74, v74, v42
    v_add_f32 v23, v23, v21
    v_mul_f32 v42, 0x3f54db31, v24
    v_mul_f32 v21, 0x3f0e39da, v24
    v_fmac_f32 v42, 0xbf0e39da, v75
    v_fmac_f32 v21, 0x3f54db31, v75
    v_sub_f32 v24, v48, v60
    v_sub_f32 v75, v27, v65
    v_add_f32 v48, v48, v60
    v_add_f32 v27, v27, v65
    v_mul_f32 v60, 0x3f3504f3, v24
    v_mul_f32 v65, 0x3f3504f3, v24
    v_fmac_f32 v60, 0xbf3504f3, v75
    v_fmac_f32 v65, 0x3f3504f3, v75
    v_sub_f32 v24, v68, v40
    v_sub_f32 v75, v39, v25
    v_add_f32 v68, v68, v40
    v_add_f32 v39, v39, v25
    v_mul_f32 v40, 0x3f0e39da, v24
    v_mul_f32 v25, 0x3f54db31, v24
    v_fmac_f32 v40, 0xbf54db31, v75
    v_fmac_f32 v25, 0x3f0e39da, v75
    v_sub_f32 v24, v62, v56
    v_sub_f32 v75, v29, v31
    v_add_f32 v62, v62, v56
    v_add_f32 v29, v29, v31
    v_mul_f32 v56, 0x3ec3ef15, v24
    v_mul_f32 v31, 0x3f6c835e, v24
    v_fmac_f32 v56, 0xbf6c835e, v75
    v_fmac_f32 v31, 0x3ec3ef15, v75
    v_sub_f32 v24, v66, v80
    v_sub_f32 v75, v37, v35
    v_add_f32 v66, v66, v80
    v_add_f32 v37, v37, v35
    v_mul_f32 v80, 0x3e47c5c2, v24
    v_mul_f32 v35, 0x3f7b14be, v24
    v_fmac_f32 v80, 0xbf7b14be, v75
    v_fmac_f32 v35, 0x3e47c5c2, v75
    v_sub_f32 v24, v81, v43
    v_sub_f32 v75, v54, v32
    v_add_f32 v54, v54, v32
    v_add_f32 v43, v43, v81
    v_sub_f32 v32, v44, v46
    v_sub_f32 v81, v71, v33
    v_add_f32 v44, v44, v46
    v_add_f32 v71, v71, v33
    v_mul_f32 v46, 0xbe47c5c2, v32
    v_mul_f32 v33, 0x3f7b14be, v32
    v_fmac_f32 v46, 0xbf7b14be, v81
    v_fmac_f32 v33, 0xbe47c5c2, v81
    v_sub_f32 v32, v52, v50
    v_sub_f32 v81, v61, v47
    v_add_f32 v52, v52, v50
    v_add_f32 v61, v61, v47
    v_mul_f32 v50, 0xbec3ef15, v32
    v_mul_f32 v47, 0x3f6c835e, v32
    v_fmac_f32 v50, 0xbf6c835e, v81
    v_fmac_f32 v47, 0xbec3ef15, v81
    v_sub_f32 v32, v58, v83
    v_sub_f32 v81, v69, v51
    v_add_f32 v58, v58, v83
    v_add_f32 v69, v69, v51
    v_mul_f32 v83, 0xbf0e39da, v32
    v_mul_f32 v51, 0x3f54db31, v32
    v_fmac_f32 v83, 0xbf54db31, v81
    v_fmac_f32 v51, 0xbf0e39da, v81
    v_sub_f32 v32, v38, v78
    v_sub_f32 v81, v41, v45
    v_add_f32 v38, v38, v78
    v_add_f32 v41, v41, v45
    v_mul_f32 v78, 0xbf3504f3, v32
    v_mul_f32 v45, 0x3f3504f3, v32
    v_fmac_f32 v78, 0xbf3504f3, v81
    v_fmac_f32 v45, 0xbf3504f3, v81
    v_sub_f32 v32, v28, v76
    v_sub_f32 v81, v57, v53
    v_add_f32 v28, v28, v76
    v_add_f32 v57, v57, v53
    v_mul_f32 v76, 0xbf54db31, v32
    v_mul_f32 v53, 0x3f0e39da, v32
    v_fmac_f32 v76, 0xbf0e39da, v81
    v_fmac_f32 v53, 0xbf54db31, v81
    v_sub_f32 v32, v36, v18
    v_sub_f32 v81, v63, v55
    v_add_f32 v36, v36, v18
    v_add_f32 v63, v63, v55
    v_mul_f32 v18, 0xbf6c835e, v32
    v_mul_f32 v55, 0x3ec3ef15, v32
    v_fmac_f32 v18, 0xbec3ef15, v81
    v_fmac_f32 v55, 0xbf6c835e, v81
    v_sub_f32 v32, v64, v72
    v_sub_f32 v81, v67, v59
    v_add_f32 v64, v64, v72
    v_add_f32 v67, v67, v59
    v_mul_f32 v72, 0xbf7b14be, v32
    v_mul_f32 v59, 0x3e47c5c2, v32
    v_fmac_f32 v72, 0xbe47c5c2, v81
    v_fmac_f32 v59, 0xbf7b14be, v81
    v_sub_f32 v32, v82, v54
    v_sub_f32 v81, v17, v43
    v_add_f32 v82, v82, v54
    v_add_f32 v17, v17, v43
    v_sub_f32 v54, v26, v44
    v_sub_f32 v43, v49, v71
    v_add_f32 v26, v26, v44
    v_add_f32 v49, v49, v71
    v_mul_f32 v44, 0x3f6c835e, v54
    v_mul_f32 v71, 0x3ec3ef15, v54
    v_fmac_f32 v44, 0xbec3ef15, v43
    v_fmac_f32 v71, 0x3f6c835e, v43
    v_sub_f32 v54, v16, v52
    v_sub_f32 v43, v19, v61
    v_add_f32 v16, v16, v52
    v_add_f32 v19, v19, v61
    v_mul_f32 v52, 0x3f3504f3, v54
    v_mul_f32 v61, 0x3f3504f3, v54
    v_fmac_f32 v52, 0xbf3504f3, v43
    v_fmac_f32 v61, 0x3f3504f3, v43
    v_sub_f32 v54, v74, v58
    v_sub_f32 v43, v23, v69
    v_add_f32 v74, v74, v58
    v_add_f32 v23, v23, v69
    v_mul_f32 v58, 0x3ec3ef15, v54
    v_mul_f32 v69, 0x3f6c835e, v54
    v_fmac_f32 v58, 0xbf6c835e, v43
    v_fmac_f32 v69, 0x3ec3ef15, v43
    v_sub_f32 v54, v41, v27
    v_sub_f32 v43, v48, v38
    v_add_f32 v48, v48, v38
    v_add_f32 v27, v27, v41
    v_sub_f32 v38, v68, v28
    v_sub_f32 v41, v39, v57
    v_add_f32 v68, v68, v28
    v_add_f32 v39, v39, v57
    v_mul_f32 v28, 0xbec3ef15, v38
    v_mul_f32 v57, 0x3f6c835e, v38
    v_fmac_f32 v28, 0xbf6c835e, v41
    v_fmac_f32 v57, 0xbec3ef15, v41
    v_sub_f32 v38, v62, v36
    v_sub_f32 v41, v29, v63
    v_add_f32 v62, v62, v36
    v_add_f32 v29, v29, v63
    v_mul_f32 v36, 0xbf3504f3, v38
    v_mul_f32 v63, 0x3f3504f3, v38
    v_fmac_f32 v36, 0xbf3504f3, v41
    v_fmac_f32 v63, 0xbf3504f3, v41
    v_sub_f32 v38, v66, v64
    v_sub_f32 v41, v37, v67
    v_add_f32 v66, v66, v64
    v_add_f32 v37, v37, v67
    v_mul_f32 v64, 0xbf6c835e, v38
    v_mul_f32 v67, 0x3ec3ef15, v38
    v_fmac_f32 v64, 0xbec3ef15, v41
    v_fmac_f32 v67, 0xbf6c835e, v41
    v_sub_f32 v38, v70, v24
    v_sub_f32 v41, v79, v75
    v_add_f32 v70, v70, v24
    v_add_f32 v79, v79, v75
    v_sub_f32 v24, v30, v46
    v_sub_f32 v75, v77, v33
    v_add_f32 v30, v30, v46
    v_add_f32 v77, v77, v33
    v_mul_f32 v46, 0x3f6c835e, v24
    v_mul_f32 v33, 0x3ec3ef15, v24
    v_fmac_f32 v46, 0xbec3ef15, v75
    v_fmac_f32 v33, 0x3f6c835e, v75
    v_sub_f32 v24, v34, v50
    v_sub_f32 v75, v73, v47
    v_add_f32 v34, v34, v50
    v_add_f32 v73, v73, v47
    v_mul_f32 v50, 0x3f3504f3, v24
    v_mul_f32 v47, 0x3f3504f3, v24
    v_fmac_f32 v50, 0xbf3504f3, v75
    v_fmac_f32 v47, 0x3f3504f3, v75
    v_sub_f32 v24, v42, v83
    v_sub_f32 v75, v21, v51
    v_add_f32 v42, v42, v83
    v_add_f32 v21, v21, v51
    v_mul_f32 v83, 0x3ec3ef15, v24
    v_mul_f32 v51, 0x3f6c835e, v24
    v_fmac_f32 v83, 0xbf6c835e, v75
    v_fmac_f32 v51, 0x3ec3ef15, v75
    v_sub_f32 v24, v45, v65
    v_sub_f32 v75, v60, v78
    v_add_f32 v60, v60, v78
    v_add_f32 v65, v65, v45
    v_sub_f32 v78, v40, v76
    v_sub_f32 v45, v25, v53
    v_add_f32 v40, v40, v76
    v_add_f32 v25, v25, v53
    v_mul_f32 v76, 0xbec3ef15, v78
    v_mul_f32 v53, 0x3f6c835e, v78
    v_fmac_f32 v76, 0xbf6c835e, v45
    v_fmac_f32 v53, 0xbec3ef15, v45
    v_sub_f32 v78, v56, v18
    v_sub_f32 v45, v31, v55
    v_add_f32 v56, v56, v18
    v_add_f32 v31, v31, v55
    v_mul_f32 v18, 0xbf3504f3, v78
    v_mul_f32 v55, 0x3f3504f3, v78
    v_fmac_f32 v18, 0xbf3504f3, v45
    v_fmac_f32 v55, 0xbf3504f3, v45
    v_sub_f32 v78, v80, v72
    v_sub_f32 v45, v35, v59
    v_add_f32 v80, v80, v72
    v_add_f32 v35, v35, v59
    v_mul_f32 v72, 0xbf6c835e, v78
    v_mul_f32 v59, 0x3ec3ef15, v78
    v_fmac_f32 v72, 0xbec3ef15, v45
    v_fmac_f32 v59, 0xbf6c835e, v45
    v_sub_f32 v78, v82, v48
    v_sub_f32 v45, v17, v27
    v_add_f32 v82, v82, v48
    v_add_f32 v17, v17, v27
    v_sub_f32 v48, v26, v68
    v_sub_f32 v27, v49, v39
    v_add_f32 v26, v26, v68
    v_add_f32 v49, v49, v39
    v_mul_f32 v68, 0x3f3504f3, v48
    v_mul_f32 v39, 0x3f3504f3, v48
    v_fmac_f32 v68, 0xbf3504f3, v27
    v_fmac_f32 v39, 0x3f3504f3, v27
    v_sub_f32 v48, v29, v19
    v_sub_f32 v27, v16, v62
    v_add_f32 v16, v16, v62
    v_add_f32 v19, v19, v29
    v_sub_f32 v62, v74, v66
    v_sub_f32 v29, v23, v37
    v_add_f32 v74, v74, v66
    v_add_f32 v23, v23, v37
    v_mul_f32 v66, 0xbf3504f3, v62
    v_mul_f32 v37, 0x3f3504f3, v62
    v_fmac_f32 v66, 0xbf3504f3, v29
    v_fmac_f32 v37, 0xbf3504f3, v29
    v_sub_f32 v62, v32, v54
    v_sub_f32 v29, v81, v43
    v_add_f32 v32, v32, v54
    v_add_f32 v81, v81, v43
    v_sub_f32 v54, v44, v28
    v_sub_f32 v43, v71, v57
    v_add_f32 v44, v44, v28
    v_add_f32 v71, v71, v57
    v_mul_f32 v28, 0x3f3504f3, v54
    v_mul_f32 v57, 0x3f3504f3, v54
    v_fmac_f32 v28, 0xbf3504f3, v43
    v_fmac_f32 v57, 0x3f3504f3, v43
    v_sub_f32 v54, v63, v61
    v_sub_f32 v43, v52, v36
    v_add_f32 v52, v52, v36
    v_add_f32 v61, v61, v63
    v_sub_f32 v36, v58, v64
    v_sub_f32 v63, v69, v67
    v_add_f32 v58, v58, v64
    v_add_f32 v69, v69, v67
    v_mul_f32 v64, 0xbf3504f3, v36
    v_mul_f32 v67, 0x3f3504f3, v36
    v_fmac_f32 v64, 0xbf3504f3, v63
    v_fmac_f32 v67, 0xbf3504f3, v63
    v_sub_f32 v36, v70, v60
    v_sub_f32 v63, v79, v65
    v_add_f32 v70, v70, v60
    v_add_f32 v79, v79, v65
    v_sub_f32 v60, v30, v40
    v_sub_f32 v65, v77, v25
    v_add_f32 v30, v30, v40
    v_add_f32 v77, v77, v25
    v_mul_f32 v40, 0x3f3504f3, v60
    v_mul_f32 v25, 0x3f3504f3, v60
    v_fmac_f32 v40, 0xbf3504f3, v65
    v_fmac_f32 v25, 0x3f3504f3, v65
    v_sub_f32 v60, v31, v73
    v_sub_f32 v65, v34, v56
    v_add_f32 v34, v34, v56
    v_add_f32 v73, v73, v31
    v_sub_f32 v56, v42, v80
    v_sub_f32 v31, v21, v35
    v_add_f32 v42, v42, v80
    v_add_f32 v21, v21, v35
    v_mul_f32 v80, 0xbf3504f3, v56
    v_mul_f32 v35, 0x3f3504f3, v56
    v_fmac_f32 v80, 0xbf3504f3, v31
    v_fmac_f32 v35, 0xbf3504f3, v31
    v_sub_f32 v56, v38, v24
    v_sub_f32 v31, v41, v75
    v_add_f32 v38, v38, v24
    v_add_f32 v41, v41, v75
    v_sub_f32 v24, v46, v76
    v_sub_f32 v75, v33, v53
    v_add_f32 v46, v46, v76
    v_add_f32 v33, v33, v53
    v_mul_f32 v76, 0x3f3504f3, v24
    v_mul_f32 v53, 0x3f3504f3, v24
    v_fmac_f32 v76, 0xbf3504f3, v75
    v_fmac_f32 v53, 0x3f3504f3, v75
    v_sub_f32 v24, v55, v47
    v_sub_f32 v75, v50, v18
    v_add_f32 v50, v50, v18
    v_add_f32 v47, v47, v55
    v_sub_f32 v18, v83, v72
    v_sub_f32 v55, v51, v59
    v_add_f32 v83, v83, v72
    v_add_f32 v51, v51, v59
    v_mul_f32 v72, 0xbf3504f3, v18
    v_mul_f32 v59, 0x3f3504f3, v18
    v_fmac_f32 v72, 0xbf3504f3, v55
    v_fmac_f32 v59, 0xbf3504f3, v55
    v_sub_f32 v18, v82, v16
    v_sub_f32 v55, v17, v19
    v_add_f32 v82, v82, v16
    v_add_f32 v17, v17, v19
    v_sub_f32 v16, v23, v49
    v_sub_f32 v19, v26, v74
    v_add_f32 v26, v26, v74
    v_add_f32 v49, v49, v23
    v_sub_f32 v74, v78, v48
    v_sub_f32 v23, v45, v27
    v_add_f32 v78, v78, v48
    v_add_f32 v45, v45, v27
    v_sub_f32 v48, v37, v39
    v_sub_f32 v27, v68, v66
    v_add_f32 v68, v68, v66
    v_add_f32 v39, v39, v37
    v_sub_f32 v66, v32, v52
    v_sub_f32 v37, v81, v61
    v_add_f32 v32, v32, v52
    v_add_f32 v81, v81, v61
    v_sub_f32 v52, v69, v71
    v_sub_f32 v61, v44, v58
    v_add_f32 v44, v44, v58
    v_add_f32 v71, v71, v69
    v_sub_f32 v58, v62, v54
    v_sub_f32 v69, v29, v43
    v_add_f32 v62, v62, v54
    v_add_f32 v29, v29, v43
    v_sub_f32 v54, v67, v57
    v_sub_f32 v43, v28, v64
    v_add_f32 v28, v28, v64
    v_add_f32 v57, v57, v67
    v_sub_f32 v64, v70, v34
    v_sub_f32 v67, v79, v73
    v_add_f32 v70, v70, v34
    v_add_f32 v79, v79, v73
    v_sub_f32 v34, v21, v77
    v_sub_f32 v73, v30, v42
    v_add_f32 v30, v30, v42
    v_add_f32 v77, v77, v21
    v_sub_f32 v42, v36, v60
    v_sub_f32 v21, v63, v65
    v_add_f32 v36, v36, v60
    v_add_f32 v63, v63, v65
    v_sub_f32 v60, v35, v25
    v_sub_f32 v65, v40, v80
    v_add_f32 v40, v40, v80
    v_add_f32 v25, v25, v35
    v_sub_f32 v80, v38, v50
    v_sub_f32 v35, v41, v47
    v_add_f32 v38, v38, v50
    v_add_f32 v41, v41, v47
    v_sub_f32 v50, v51, v33
    v_sub_f32 v47, v46, v83
    v_add_f32 v46, v46, v83
    v_add_f32 v33, v33, v51
    v_sub_f32 v83, v56, v24
    v_sub_f32 v51, v31, v75
    v_add_f32 v56, v56, v24
    v_add_f32 v31, v31, v75
    v_sub_f32 v24, v59, v53
    v_sub_f32 v75, v76, v72
    v_add_f32 v76, v76, v72
    v_add_f32 v53, v53, v59
    v_sub_f32 v72, v82, v26
    v_sub_f32 v59, v17, v49
    v_add_f32 v82, v82, v26
    v_add_f32 v17, v17, v49
    v_sub_f32 v26, v18, v16
    v_sub_f32 v49, v55, v19
    v_add_f32 v18, v18, v16
    v_add_f32 v55, v55, v19
    v_sub_f32 v16, v78, v68
    v_sub_f32 v19, v45, v39
    v_add_f32 v78, v78, v68
    v_add_f32 v45, v45, v39
    v_sub_f32 v68, v74, v48
    v_sub_f32 v39, v23, v27
    v_add_f32 v74, v74, v48
    v_add_f32 v23, v23, v27
    v_sub_f32 v48, v32, v44
    v_sub_f32 v27, v81, v71
    v_add_f32 v32, v32, v44
    v_add_f32 v81, v81, v71
    v_sub_f32 v44, v66, v52
    v_sub_f32 v71, v37, v61
    v_add_f32 v66, v66, v52
    v_add_f32 v37, v37, v61
    v_sub_f32 v52, v62, v28
    v_sub_f32 v61, v29, v57
    v_add_f32 v62, v62, v28
    v_add_f32 v29, v29, v57
    v_sub_f32 v28, v58, v54
    v_sub_f32 v57, v69, v43
    v_add_f32 v58, v58, v54
    v_add_f32 v69, v69, v43
    v_sub_f32 v54, v70, v30
    v_sub_f32 v43, v79, v77
    v_add_f32 v70, v70, v30
    v_add_f32 v79, v79, v77
    v_sub_f32 v30, v64, v34
    v_sub_f32 v77, v67, v73
    v_add_f32 v64, v64, v34
    v_add_f32 v67, v67, v73
    v_sub_f32 v34, v36, v40
    v_sub_f32 v73, v63, v25
    v_add_f32 v36, v36, v40
    v_add_f32 v63, v63, v25
    v_sub_f32 v40, v42, v60
    v_sub_f32 v25, v21, v65
    v_add_f32 v42, v42, v60
    v_add_f32 v21, v21, v65
    v_sub_f32 v60, v38, v46
    v_sub_f32 v65, v41, v33
    v_add_f32 v38, v38, v46
    v_add_f32 v41, v41, v33
    v_sub_f32 v46, v80, v50
    v_sub_f32 v33, v35, v47
    v_add_f32 v80, v80, v50
    v_add_f32 v35, v35, v47
    v_sub_f32 v50, v56, v76
    v_sub_f32 v47, v31, v53
    v_add_f32 v56, v56, v76
    v_add_f32 v31, v31, v53
    v_sub_f32 v76, v83, v24
    v_sub_f32 v53, v51, v75
    v_add_f32 v83, v83, v24
    v_add_f32 v51, v51, v75
    v_mul_f32 v12, v10, v8
    v_mul_f32 v12, 0x3a000000, v12
    v_mov_b32 v24, v12
    v_fmac_f32 v24, 0x00000000, v8
    v_cos_f32 v75, v24
    v_sin_f32 v22, v24
    s_nop 0
    v_mul_f32 v20, v82, v75
    v_fma_f32 v20, -v17, v22, v20
    v_mul_f32 v17, v17, v75
    v_fmac_f32 v17, v82, v22
    v_mov_b32 v24, v12
    v_fmac_f32 v24, 0x3a800000, v8
    v_cos_f32 v75, v24
    v_sin_f32 v22, v24
    s_nop 0
    v_mul_f32 v82, v70, v75
    v_fma_f32 v82, -v79, v22, v82
    v_mul_f32 v79, v79, v75
    v_fmac_f32 v79, v70, v22
    v_mov_b32 v24, v12
    v_fmac_f32 v24, 0x3b000000, v8
    v_cos_f32 v75, v24
    v_sin_f32 v22, v24
    s_nop 0
    v_mul_f32 v70, v32, v75
    v_fma_f32 v70, -v81, v22, v70
    v_mul_f32 v81, v81, v75
    v_fmac_f32 v81, v32, v22
    v_mov_b32 v24, v12
    v_fmac_f32 v24, 0x3b400000, v8
    v_cos_f32 v75, v24
    v_sin_f32 v22, v24
    s_nop 0
    v_mul_f32 v32, v38, v75
    v_fma_f32 v32, -v41, v22, v32
    v_mul_f32 v41, v41, v75
    v_fmac_f32 v41, v38, v22
    v_mov_b32 v24, v12
    v_fmac_f32 v24, 0x3b800000, v8
    v_cos_f32 v75, v24
    v_sin_f32 v22, v24
    s_nop 0
    v_mul_f32 v38, v78, v75
    v_fma_f32 v38, -v45, v22, v38
    v_mul_f32 v45, v45, v75
    v_fmac_f32 v45, v78, v22
    v_mov_b32 v24, v12
    v_fmac_f32 v24, 0x3ba00000, v8
    v_cos_f32 v75, v24
    v_sin_f32 v22, v24
    s_nop 0
    v_mul_f32 v78, v36, v75
    v_fma_f32 v78, -v63, v22, v78
    v_mul_f32 v63, v63, v75
    v_fmac_f32 v63, v36, v22
    v_mov_b32 v24, v12
    v_fmac_f32 v24, 0x3bc00000, v8
    v_cos_f32 v75, v24
    v_sin_f32 v22, v24
    s_nop 0
    v_mul_f32 v36, v62, v75
    v_fma_f32 v36, -v29, v22, v36
    v_mul_f32 v29, v29, v75
    v_fmac_f32 v29, v62, v22
    v_mov_b32 v24, v12
    v_fmac_f32 v24, 0x3be00000, v8
    v_cos_f32 v75, v24
    v_sin_f32 v22, v24
    s_nop 0
    v_mul_f32 v62, v56, v75
    v_fma_f32 v62, -v31, v22, v62
    v_mul_f32 v31, v31, v75
    v_fmac_f32 v31, v56, v22
    v_mov_b32 v24, v12
    v_fmac_f32 v24, 0x3c000000, v8
    v_cos_f32 v75, v24
    v_sin_f32 v22, v24
    s_nop 0
    v_mul_f32 v56, v18, v75
    v_fma_f32 v56, -v55, v22, v56
    v_mul_f32 v55, v55, v75
    v_fmac_f32 v55, v18, v22
    v_mov_b32 v24, v12
    v_fmac_f32 v24, 0x3c100000, v8
    v_cos_f32 v75, v24
    v_sin_f32 v22, v24
    s_nop 0
    v_mul_f32 v18, v64, v75
    v_fma_f32 v18, -v67, v22, v18
    v_mul_f32 v67, v67, v75
    v_fmac_f32 v67, v64, v22
    v_mov_b32 v24, v12
    v_fmac_f32 v24, 0x3c200000, v8
    v_cos_f32 v75, v24
    v_sin_f32 v22, v24
    s_nop 0
    v_mul_f32 v64, v66, v75
    v_fma_f32 v64, -v37, v22, v64
    v_mul_f32 v37, v37, v75
    v_fmac_f32 v37, v66, v22
    v_mov_b32 v24, v12
    v_fmac_f32 v24, 0x3c300000, v8
    v_cos_f32 v75, v24
    v_sin_f32 v22, v24
    s_nop 0
    v_mul_f32 v66, v80, v75
    v_fma_f32 v66, -v35, v22, v66
    v_mul_f32 v35, v35, v75
    v_fmac_f32 v35, v80, v22
    v_mov_b32 v24, v12
    v_fmac_f32 v24, 0x3c400000, v8
    v_cos_f32 v75, v24
    v_sin_f32 v22, v24
    s_nop 0
    v_mul_f32 v80, v74, v75
    v_fma_f32 v80, -v23, v22, v80
    v_mul_f32 v23, v23, v75
    v_fmac_f32 v23, v74, v22
    v_mov_b32 v24, v12
    v_fmac_f32 v24, 0x3c500000, v8
    v_cos_f32 v75, v24
    v_sin_f32 v22, v24
    s_nop 0
    v_mul_f32 v74, v42, v75
    v_fma_f32 v74, -v21, v22, v74
    v_mul_f32 v21, v21, v75
    v_fmac_f32 v21, v42, v22
    v_mov_b32 v24, v12
    v_fmac_f32 v24, 0x3c600000, v8
    v_cos_f32 v75, v24
    v_sin_f32 v22, v24
    s_nop 0
    v_mul_f32 v42, v58, v75
    v_fma_f32 v42, -v69, v22, v42
    v_mul_f32 v69, v69, v75
    v_fmac_f32 v69, v58, v22
    v_mov_b32 v24, v12
    v_fmac_f32 v24, 0x3c700000, v8
    v_cos_f32 v75, v24
    v_sin_f32 v22, v24
    s_nop 0
    v_mul_f32 v58, v83, v75
    v_fma_f32 v58, -v51, v22, v58
    v_mul_f32 v51, v51, v75
    v_fmac_f32 v51, v83, v22
    v_mov_b32 v24, v12
    v_fmac_f32 v24, 0x3c800000, v8
    v_cos_f32 v75, v24
    v_sin_f32 v22, v24
    s_nop 0
    v_mul_f32 v83, v72, v75
    v_fma_f32 v83, -v59, v22, v83
    v_mul_f32 v59, v59, v75
    v_fmac_f32 v59, v72, v22
    v_mov_b32 v24, v12
    v_fmac_f32 v24, 0x3c880000, v8
    v_cos_f32 v75, v24
    v_sin_f32 v22, v24
    s_nop 0
    v_mul_f32 v72, v54, v75
    v_fma_f32 v72, -v43, v22, v72
    v_mul_f32 v43, v43, v75
    v_fmac_f32 v43, v54, v22
    v_mov_b32 v24, v12
    v_fmac_f32 v24, 0x3c900000, v8
    v_cos_f32 v75, v24
    v_sin_f32 v22, v24
    s_nop 0
    v_mul_f32 v54, v48, v75
    v_fma_f32 v54, -v27, v22, v54
    v_mul_f32 v27, v27, v75
    v_fmac_f32 v27, v48, v22
    v_mov_b32 v24, v12
    v_fmac_f32 v24, 0x3c980000, v8
    v_cos_f32 v75, v24
    v_sin_f32 v22, v24
    s_nop 0
    v_mul_f32 v48, v60, v75
    v_fma_f32 v48, -v65, v22, v48
    v_mul_f32 v65, v65, v75
    v_fmac_f32 v65, v60, v22
    v_mov_b32 v24, v12
    v_fmac_f32 v24, 0x3ca00000, v8
    v_cos_f32 v75, v24
    v_sin_f32 v22, v24
    s_nop 0
    v_mul_f32 v60, v16, v75
    v_fma_f32 v60, -v19, v22, v60
    v_mul_f32 v19, v19, v75
    v_fmac_f32 v19, v16, v22
    v_mov_b32 v24, v12
    v_fmac_f32 v24, 0x3ca80000, v8
    v_cos_f32 v75, v24
    v_sin_f32 v22, v24
    s_nop 0
    v_mul_f32 v16, v34, v75
    v_fma_f32 v16, -v73, v22, v16
    v_mul_f32 v73, v73, v75
    v_fmac_f32 v73, v34, v22
    v_mov_b32 v24, v12
    v_fmac_f32 v24, 0x3cb00000, v8
    v_cos_f32 v75, v24
    v_sin_f32 v22, v24
    s_nop 0
    v_mul_f32 v34, v52, v75
    v_fma_f32 v34, -v61, v22, v34
    v_mul_f32 v61, v61, v75
    v_fmac_f32 v61, v52, v22
    v_mov_b32 v24, v12
    v_fmac_f32 v24, 0x3cb80000, v8
    v_cos_f32 v75, v24
    v_sin_f32 v22, v24
    s_nop 0
    v_mul_f32 v52, v50, v75
    v_fma_f32 v52, -v47, v22, v52
    v_mul_f32 v47, v47, v75
    v_fmac_f32 v47, v50, v22
    v_mov_b32 v24, v12
    v_fmac_f32 v24, 0x3cc00000, v8
    v_cos_f32 v75, v24
    v_sin_f32 v22, v24
    s_nop 0
    v_mul_f32 v50, v26, v75
    v_fma_f32 v50, -v49, v22, v50
    v_mul_f32 v49, v49, v75
    v_fmac_f32 v49, v26, v22
    v_mov_b32 v24, v12
    v_fmac_f32 v24, 0x3cc80000, v8
    v_cos_f32 v75, v24
    v_sin_f32 v22, v24
    s_nop 0
    v_mul_f32 v26, v30, v75
    v_fma_f32 v26, -v77, v22, v26
    v_mul_f32 v77, v77, v75
    v_fmac_f32 v77, v30, v22
    v_mov_b32 v24, v12
    v_fmac_f32 v24, 0x3cd00000, v8
    v_cos_f32 v75, v24
    v_sin_f32 v22, v24
    s_nop 0
    v_mul_f32 v30, v44, v75
    v_fma_f32 v30, -v71, v22, v30
    v_mul_f32 v71, v71, v75
    v_fmac_f32 v71, v44, v22
    v_mov_b32 v24, v12
    v_fmac_f32 v24, 0x3cd80000, v8
    v_cos_f32 v75, v24
    v_sin_f32 v22, v24
    s_nop 0
    v_mul_f32 v44, v46, v75
    v_fma_f32 v44, -v33, v22, v44
    v_mul_f32 v33, v33, v75
    v_fmac_f32 v33, v46, v22
    v_mov_b32 v24, v12
    v_fmac_f32 v24, 0x3ce00000, v8
    v_cos_f32 v75, v24
    v_sin_f32 v22, v24
    s_nop 0
    v_mul_f32 v46, v68, v75
    v_fma_f32 v46, -v39, v22, v46
    v_mul_f32 v39, v39, v75
    v_fmac_f32 v39, v68, v22
    v_mov_b32 v24, v12
    v_fmac_f32 v24, 0x3ce80000, v8
    v_cos_f32 v75, v24
    v_sin_f32 v22, v24
    s_nop 0
    v_mul_f32 v68, v40, v75
    v_fma_f32 v68, -v25, v22, v68
    v_mul_f32 v25, v25, v75
    v_fmac_f32 v25, v40, v22
    v_mov_b32 v24, v12
    v_fmac_f32 v24, 0x3cf00000, v8
    v_cos_f32 v75, v24
    v_sin_f32 v22, v24
    s_nop 0
    v_mul_f32 v40, v28, v75
    v_fma_f32 v40, -v57, v22, v40
    v_mul_f32 v57, v57, v75
    v_fmac_f32 v57, v28, v22
    v_mov_b32 v24, v12
    v_fmac_f32 v24, 0x3cf80000, v8
    v_cos_f32 v75, v24
    v_sin_f32 v22, v24
    s_nop 0
    v_mul_f32 v28, v76, v75
    v_fma_f32 v28, -v53, v22, v28
    v_mul_f32 v53, v53, v75
    v_fmac_f32 v53, v76, v22
    ds_write_b32 v4, v20 offset:0
    ds_write_b32 v4, v17 offset:4
    ds_write_b32 v4, v82 offset:16
    ds_write_b32 v4, v79 offset:20
    ds_write_b32 v4, v70 offset:32
    ds_write_b32 v4, v81 offset:36
    ds_write_b32 v4, v32 offset:48
    ds_write_b32 v4, v41 offset:52
    ds_write_b32 v4, v38 offset:64
    ds_write_b32 v4, v45 offset:68
    ds_write_b32 v4, v78 offset:80
    ds_write_b32 v4, v63 offset:84
    ds_write_b32 v4, v36 offset:96
    ds_write_b32 v4, v29 offset:100
    ds_write_b32 v4, v62 offset:112
    ds_write_b32 v4, v31 offset:116
    ds_write_b32 v4, v56 offset:128
    ds_write_b32 v4, v55 offset:132
    ds_write_b32 v4, v18 offset:144
    ds_write_b32 v4, v67 offset:148
    ds_write_b32 v4, v64 offset:160
    ds_write_b32 v4, v37 offset:164
    ds_write_b32 v4, v66 offset:176
    ds_write_b32 v4, v35 offset:180
    ds_write_b32 v4, v80 offset:192
    ds_write_b32 v4, v23 offset:196
    ds_write_b32 v4, v74 offset:208
    ds_write_b32 v4, v21 offset:212
    ds_write_b32 v4, v42 offset:224
    ds_write_b32 v4, v69 offset:228
    ds_write_b32 v4, v58 offset:240
    ds_write_b32 v4, v51 offset:244
    ds_write_b32 v4, v83 offset:256
    ds_write_b32 v4, v59 offset:260
    ds_write_b32 v4, v72 offset:272
    ds_write_b32 v4, v43 offset:276
    ds_write_b32 v4, v54 offset:288
    ds_write_b32 v4, v27 offset:292
    ds_write_b32 v4, v48 offset:304
    ds_write_b32 v4, v65 offset:308
    ds_write_b32 v4, v60 offset:320
    ds_write_b32 v4, v19 offset:324
    ds_write_b32 v4, v16 offset:336
    ds_write_b32 v4, v73 offset:340
    ds_write_b32 v4, v34 offset:352
    ds_write_b32 v4, v61 offset:356
    ds_write_b32 v4, v52 offset:368
    ds_write_b32 v4, v47 offset:372
    ds_write_b32 v4, v50 offset:384
    ds_write_b32 v4, v49 offset:388
    ds_write_b32 v4, v26 offset:400
    ds_write_b32 v4, v77 offset:404
    ds_write_b32 v4, v30 offset:416
    ds_write_b32 v4, v71 offset:420
    ds_write_b32 v4, v44 offset:432
    ds_write_b32 v4, v33 offset:436
    ds_write_b32 v4, v46 offset:448
    ds_write_b32 v4, v39 offset:452
    ds_write_b32 v4, v68 offset:464
    ds_write_b32 v4, v25 offset:468
    ds_write_b32 v4, v40 offset:480
    ds_write_b32 v4, v57 offset:484
    ds_write_b32 v4, v28 offset:496
    ds_write_b32 v4, v53 offset:500
    s_waitcnt lgkmcnt(0)
    ds_read_b32 v20, v3 offset:0
    ds_read_b32 v17, v3 offset:4
    ds_read_b32 v82, v3 offset:528
    ds_read_b32 v79, v3 offset:532
    ds_read_b32 v70, v3 offset:1056
    ds_read_b32 v81, v3 offset:1060
    ds_read_b32 v32, v3 offset:1584
    ds_read_b32 v41, v3 offset:1588
    ds_read_b32 v38, v3 offset:2112
    ds_read_b32 v45, v3 offset:2116
    ds_read_b32 v78, v3 offset:2640
    ds_read_b32 v63, v3 offset:2644
    ds_read_b32 v36, v3 offset:3168
    ds_read_b32 v29, v3 offset:3172
    s_waitcnt lgkmcnt(0)
    ds_read_b32 v62, v3 offset:3696
    ds_read_b32 v31, v3 offset:3700
    ds_read_b32 v56, v3 offset:4224
    ds_read_b32 v55, v3 offset:4228
    ds_read_b32 v18, v3 offset:4752
    ds_read_b32 v67, v3 offset:4756
    ds_read_b32 v64, v3 offset:5280
    ds_read_b32 v37, v3 offset:5284
    ds_read_b32 v66, v3 offset:5808
    ds_read_b32 v35, v3 offset:5812
    ds_read_b32 v80, v3 offset:6336
    ds_read_b32 v23, v3 offset:6340
    ds_read_b32 v74, v3 offset:6864
    ds_read_b32 v21, v3 offset:6868
    s_waitcnt lgkmcnt(0)
    ds_read_b32 v42, v3 offset:7392
    ds_read_b32 v69, v3 offset:7396
    ds_read_b32 v58, v3 offset:7920
    ds_read_b32 v51, v3 offset:7924
    ds_read_b32 v83, v3 offset:8448
    ds_read_b32 v59, v3 offset:8452
    ds_read_b32 v72, v3 offset:8976
    ds_read_b32 v43, v3 offset:8980
    ds_read_b32 v54, v3 offset:9504
    ds_read_b32 v27, v3 offset:9508
    ds_read_b32 v48, v3 offset:10032
    ds_read_b32 v65, v3 offset:10036
    ds_read_b32 v60, v3 offset:10560
    ds_read_b32 v19, v3 offset:10564
    s_waitcnt lgkmcnt(0)
    ds_read_b32 v16, v3 offset:11088
    ds_read_b32 v73, v3 offset:11092
    ds_read_b32 v34, v3 offset:11616
    ds_read_b32 v61, v3 offset:11620
    ds_read_b32 v52, v3 offset:12144
    ds_read_b32 v47, v3 offset:12148
    ds_read_b32 v50, v3 offset:12672
    ds_read_b32 v49, v3 offset:12676
    ds_read_b32 v26, v3 offset:13200
    ds_read_b32 v77, v3 offset:13204
    ds_read_b32 v30, v3 offset:13728
    ds_read_b32 v71, v3 offset:13732
    ds_read_b32 v44, v3 offset:14256
    ds_read_b32 v33, v3 offset:14260
    s_waitcnt lgkmcnt(0)
    ds_read_b32 v46, v3 offset:14784
    ds_read_b32 v39, v3 offset:14788
    ds_read_b32 v68, v3 offset:15312
    ds_read_b32 v25, v3 offset:15316
    ds_read_b32 v40, v3 offset:15840
    ds_read_b32 v57, v3 offset:15844
    ds_read_b32 v28, v3 offset:16368
    ds_read_b32 v53, v3 offset:16372
    s_waitcnt lgkmcnt(0)
    v_sub_f32 v24, v20, v83
    v_sub_f32 v75, v17, v59
    v_add_f32 v20, v20, v83
    v_add_f32 v17, v17, v59
    v_sub_f32 v83, v82, v72
    v_sub_f32 v59, v79, v43
    v_add_f32 v82, v82, v72
    v_add_f32 v79, v79, v43
    v_mul_f32 v72, 0x3f7b14be, v83
    v_mul_f32 v43, 0x3e47c5c2, v83
    v_fmac_f32 v72, 0xbe47c5c2, v59
    v_fmac_f32 v43, 0x3f7b14be, v59
    v_sub_f32 v83, v70, v54
    v_sub_f32 v59, v81, v27
    v_add_f32 v70, v70, v54
    v_add_f32 v81, v81, v27
    v_mul_f32 v54, 0x3f6c835e, v83
    v_mul_f32 v27, 0x3ec3ef15, v83
    v_fmac_f32 v54, 0xbec3ef15, v59
    v_fmac_f32 v27, 0x3f6c835e, v59
    v_sub_f32 v83, v32, v48
    v_sub_f32 v59, v41, v65
    v_add_f32 v32, v32, v48
    v_add_f32 v41, v41, v65
    v_mul_f32 v48, 0x3f54db31, v83
    v_mul_f32 v65, 0x3f0e39da, v83
    v_fmac_f32 v48, 0xbf0e39da, v59
    v_fmac_f32 v65, 0x3f54db31, v59
    v_sub_f32 v83, v38, v60
    v_sub_f32 v59, v45, v19
    v_add_f32 v38, v38, v60
    v_add_f32 v45, v45, v19
    v_mul_f32 v60, 0x3f3504f3, v83
    v_mul_f32 v19, 0x3f3504f3, v83
    v_fmac_f32 v60, 0xbf3504f3, v59
    v_fmac_f32 v19, 0x3f3504f3, v59
    v_sub_f32 v83, v78, v16
    v_sub_f32 v59, v63, v73
    v_add_f32 v78, v78, v16
    v_add_f32 v63, v63, v73
    v_mul_f32 v16, 0x3f0e39da, v83
    v_mul_f32 v73, 0x3f54db31, v83
    v_fmac_f32 v16, 0xbf54db31, v59
    v_fmac_f32 v73, 0x3f0e39da, v59
    v_sub_f32 v83, v36, v34
    v_sub_f32 v59, v29, v61
    v_add_f32 v36, v36, v34
    v_add_f32 v29, v29, v61
    v_mul_f32 v34, 0x3ec3ef15, v83
    v_mul_f32 v61, 0x3f6c835e, v83
    v_fmac_f32 v34, 0xbf6c835e, v59
    v_fmac_f32 v61, 0x3ec3ef15, v59
    v_sub_f32 v83, v62, v52
    v_sub_f32 v59, v31, v47
    v_add_f32 v62, v62, v52
    v_add_f32 v31, v31, v47
    v_mul_f32 v52, 0x3e47c5c2, v83
    v_mul_f32 v47, 0x3f7b14be, v83
    v_fmac_f32 v52, 0xbf7b14be, v59
    v_fmac_f32 v47, 0x3e47c5c2, v59
    v_sub_f32 v83, v49, v55
    v_sub_f32 v59, v56, v50
    v_add_f32 v56, v56, v50
    v_add_f32 v55, v55, v49
    v_sub_f32 v50, v18, v26
    v_sub_f32 v49, v67, v77
    v_add_f32 v18, v18, v26
    v_add_f32 v67, v67, v77
    v_mul_f32 v26, 0xbe47c5c2, v50
    v_mul_f32 v77, 0x3f7b14be, v50
    v_fmac_f32 v26, 0xbf7b14be, v49
    v_fmac_f32 v77, 0xbe47c5c2, v49
    v_sub_f32 v50, v64, v30
    v_sub_f32 v49, v37, v71
    v_add_f32 v64, v64, v30
    v_add_f32 v37, v37, v71
    v_mul_f32 v30, 0xbec3ef15, v50
    v_mul_f32 v71, 0x3f6c835e, v50
    v_fmac_f32 v30, 0xbf6c835e, v49
    v_fmac_f32 v71, 0xbec3ef15, v49
    v_sub_f32 v50, v66, v44
    v_sub_f32 v49, v35, v33
    v_add_f32 v66, v66, v44
    v_add_f32 v35, v35, v33
    v_mul_f32 v44, 0xbf0e39da, v50
    v_mul_f32 v33, 0x3f54db31, v50
    v_fmac_f32 v44, 0xbf54db31, v49
    v_fmac_f32 v33, 0xbf0e39da, v49
    v_sub_f32 v50, v80, v46
    v_sub_f32 v49, v23, v39
    v_add_f32 v80, v80, v46
    v_add_f32 v23, v23, v39
    v_mul_f32 v46, 0xbf3504f3, v50
    v_mul_f32 v39, 0x3f3504f3, v50
    v_fmac_f32 v46, 0xbf3504f3, v49
    v_fmac_f32 v39, 0xbf3504f3, v49
    v_sub_f32 v50, v74, v68
    v_sub_f32 v49, v21, v25
    v_add_f32 v74, v74, v68
    v_add_f32 v21, v21, v25
    v_mul_f32 v68, 0xbf54db31, v50
    v_mul_f32 v25, 0x3f0e39da, v50
    v_fmac_f32 v68, 0xbf0e39da, v49
    v_fmac_f32 v25, 0xbf54db31, v49
    v_sub_f32 v50, v42, v40
    v_sub_f32 v49, v69, v57
    v_add_f32 v42, v42, v40
    v_add_f32 v69, v69, v57
    v_mul_f32 v40, 0xbf6c835e, v50
    v_mul_f32 v57, 0x3ec3ef15, v50
    v_fmac_f32 v40, 0xbec3ef15, v49
    v_fmac_f32 v57, 0xbf6c835e, v49
    v_sub_f32 v50, v58, v28
    v_sub_f32 v49, v51, v53
    v_add_f32 v58, v58, v28
    v_add_f32 v51, v51, v53
    v_mul_f32 v28, 0xbf7b14be, v50
    v_mul_f32 v53, 0x3e47c5c2, v50
    v_fmac_f32 v28, 0xbe47c5c2, v49
    v_fmac_f32 v53, 0xbf7b14be, v49
    v_sub_f32 v50, v20, v56
    v_sub_f32 v49, v17, v55
    v_add_f32 v20, v20, v56
    v_add_f32 v17, v17, v55
    v_sub_f32 v56, v82, v18
    v_sub_f32 v55, v79, v67
    v_add_f32 v82, v82, v18
    v_add_f32 v79, v79, v67
    v_mul_f32 v18, 0x3f6c835e, v56
    v_mul_f32 v67, 0x3ec3ef15, v56
    v_fmac_f32 v18, 0xbec3ef15, v55
    v_fmac_f32 v67, 0x3f6c835e, v55
    v_sub_f32 v56, v70, v64
    v_sub_f32 v55, v81, v37
    v_add_f32 v70, v70, v64
    v_add_f32 v81, v81, v37
    v_mul_f32 v64, 0x3f3504f3, v56
    v_mul_f32 v37, 0x3f3504f3, v56
    v_fmac_f32 v64, 0xbf3504f3, v55
    v_fmac_f32 v37, 0x3f3504f3, v55
    v_sub_f32 v56, v32, v66
    v_sub_f32 v55, v41, v35
    v_add_f32 v32, v32, v66
    v_add_f32 v41, v41, v35
    v_mul_f32 v66, 0x3ec3ef15, v56
    v_mul_f32 v35, 0x3f6c835e, v56
    v_fmac_f32 v66, 0xbf6c835e, v55
    v_fmac_f32 v35, 0x3ec3ef15, v55
    v_sub_f32 v56, v23, v45
    v_sub_f32 v55, v38, v80
    v_add_f32 v38, v38, v80
    v_add_f32 v45, v45, v23
    v_sub_f32 v80, v78, v74
    v_sub_f32 v23, v63, v21
    v_add_f32 v78, v78, v74
    v_add_f32 v63, v63, v21
    v_mul_f32 v74, 0xbec3ef15, v80
    v_mul_f32 v21, 0x3f6c835e, v80
    v_fmac_f32 v74, 0xbf6c835e, v23
    v_fmac_f32 v21, 0xbec3ef15, v23
    v_sub_f32 v80, v36, v42
    v_sub_f32 v23, v29, v69
    v_add_f32 v36, v36, v42
    v_add_f32 v29, v29, v69
    v_mul_f32 v42, 0xbf3504f3, v80
    v_mul_f32 v69, 0x3f3504f3, v80
    v_fmac_f32 v42, 0xbf3504f3, v23
    v_fmac_f32 v69, 0xbf3504f3, v23
    v_sub_f32 v80, v62, v58
    v_sub_f32 v23, v31, v51
    v_add_f32 v62, v62, v58
    v_add_f32 v31, v31, v51
    v_mul_f32 v58, 0xbf6c835e, v80
    v_mul_f32 v51, 0x3ec3ef15, v80
    v_fmac_f32 v58, 0xbec3ef15, v23
    v_fmac_f32 v51, 0xbf6c835e, v23
    v_sub_f32 v80, v24, v83
    v_sub_f32 v23, v75, v59
    v_add_f32 v24, v24, v83
    v_add_f32 v75, v75, v59
    v_sub_f32 v83, v72, v26
    v_sub_f32 v59, v43, v77
    v_add_f32 v72, v72, v26
    v_add_f32 v43, v43, v77
    v_mul_f32 v26, 0x3f6c835e, v83
    v_mul_f32 v77, 0x3ec3ef15, v83
    v_fmac_f32 v26, 0xbec3ef15, v59
    v_fmac_f32 v77, 0x3f6c835e, v59
    v_sub_f32 v83, v54, v30
    v_sub_f32 v59, v27, v71
    v_add_f32 v54, v54, v30
    v_add_f32 v27, v27, v71
    v_mul_f32 v30, 0x3f3504f3, v83
    v_mul_f32 v71, 0x3f3504f3, v83
    v_fmac_f32 v30, 0xbf3504f3, v59
    v_fmac_f32 v71, 0x3f3504f3, v59
    v_sub_f32 v83, v48, v44
    v_sub_f32 v59, v65, v33
    v_add_f32 v48, v48, v44
    v_add_f32 v65, v65, v33
    v_mul_f32 v44, 0x3ec3ef15, v83
    v_mul_f32 v33, 0x3f6c835e, v83
    v_fmac_f32 v44, 0xbf6c835e, v59
    v_fmac_f32 v33, 0x3ec3ef15, v59
    v_sub_f32 v83, v39, v19
    v_sub_f32 v59, v60, v46
    v_add_f32 v60, v60, v46
    v_add_f32 v19, v19, v39
    v_sub_f32 v46, v16, v68
    v_sub_f32 v39, v73, v25
    v_add_f32 v16, v16, v68
    v_add_f32 v73, v73, v25
    v_mul_f32 v68, 0xbec3ef15, v46
    v_mul_f32 v25, 0x3f6c835e, v46
    v_fmac_f32 v68, 0xbf6c835e, v39
    v_fmac_f32 v25, 0xbec3ef15, v39
    v_sub_f32 v46, v34, v40
    v_sub_f32 v39, v61, v57
    v_add_f32 v34, v34, v40
    v_add_f32 v61, v61, v57
    v_mul_f32 v40, 0xbf3504f3, v46
    v_mul_f32 v57, 0x3f3504f3, v46
    v_fmac_f32 v40, 0xbf3504f3, v39
    v_fmac_f32 v57, 0xbf3504f3, v39
    v_sub_f32 v46, v52, v28
    v_sub_f32 v39, v47, v53
    v_add_f32 v52, v52, v28
    v_add_f32 v47, v47, v53
    v_mul_f32 v28, 0xbf6c835e, v46
    v_mul_f32 v53, 0x3ec3ef15, v46
    v_fmac_f32 v28, 0xbec3ef15, v39
    v_fmac_f32 v53, 0xbf6c835e, v39
    v_sub_f32 v46, v20, v38
    v_sub_f32 v39, v17, v45
    v_add_f32 v20, v20, v38
    v_add_f32 v17, v17, v45
    v_sub_f32 v38, v82, v78
    v_sub_f32 v45, v79, v63
    v_add_f32 v82, v82, v78
    v_add_f32 v79, v79, v63
    v_mul_f32 v78, 0x3f3504f3, v38
    v_mul_f32 v63, 0x3f3504f3, v38
    v_fmac_f32 v78, 0xbf3504f3, v45
    v_fmac_f32 v63, 0x3f3504f3, v45
    v_sub_f32 v38, v29, v81
    v_sub_f32 v45, v70, v36
    v_add_f32 v70, v70, v36
    v_add_f32 v81, v81, v29
    v_sub_f32 v36, v32, v62
    v_sub_f32 v29, v41, v31
    v_add_f32 v32, v32, v62
    v_add_f32 v41, v41, v31
    v_mul_f32 v62, 0xbf3504f3, v36
    v_mul_f32 v31, 0x3f3504f3, v36
    v_fmac_f32 v62, 0xbf3504f3, v29
    v_fmac_f32 v31, 0xbf3504f3, v29
    v_sub_f32 v36, v50, v56
    v_sub_f32 v29, v49, v55
    v_add_f32 v50, v50, v56
    v_add_f32 v49, v49, v55
    v_sub_f32 v56, v18, v74
    v_sub_f32 v55, v67, v21
    v_add_f32 v18, v18, v74
    v_add_f32 v67, v67, v21
    v_mul_f32 v74, 0x3f3504f3, v56
    v_mul_f32 v21, 0x3f3504f3, v56
    v_fmac_f32 v74, 0xbf3504f3, v55
    v_fmac_f32 v21, 0x3f3504f3, v55
    v_sub_f32 v56, v69, v37
    v_sub_f32 v55, v64, v42
    v_add_f32 v64, v64, v42
    v_add_f32 v37, v37, v69
    v_sub_f32 v42, v66, v58
    v_sub_f32 v69, v35, v51
    v_add_f32 v66, v66, v58
    v_add_f32 v35, v35, v51
    v_mul_f32 v58, 0xbf3504f3, v42
    v_mul_f32 v51, 0x3f3504f3, v42
    v_fmac_f32 v58, 0xbf3504f3, v69
    v_fmac_f32 v51, 0xbf3504f3, v69
    v_sub_f32 v42, v24, v60
    v_sub_f32 v69, v75, v19
    v_add_f32 v24, v24, v60
    v_add_f32 v75, v75, v19
    v_sub_f32 v60, v72, v16
    v_sub_f32 v19, v43, v73
    v_add_f32 v72, v72, v16
    v_add_f32 v43, v43, v73
    v_mul_f32 v16, 0x3f3504f3, v60
    v_mul_f32 v73, 0x3f3504f3, v60
    v_fmac_f32 v16, 0xbf3504f3, v19
    v_fmac_f32 v73, 0x3f3504f3, v19
    v_sub_f32 v60, v61, v27
    v_sub_f32 v19, v54, v34
    v_add_f32 v54, v54, v34
    v_add_f32 v27, v27, v61
    v_sub_f32 v34, v48, v52
    v_sub_f32 v61, v65, v47
    v_add_f32 v48, v48, v52
    v_add_f32 v65, v65, v47
    v_mul_f32 v52, 0xbf3504f3, v34
    v_mul_f32 v47, 0x3f3504f3, v34
    v_fmac_f32 v52, 0xbf3504f3, v61
    v_fmac_f32 v47, 0xbf3504f3, v61
    v_sub_f32 v34, v80, v83
    v_sub_f32 v61, v23, v59
    v_add_f32 v80, v80, v83
    v_add_f32 v23, v23, v59
    v_sub_f32 v83, v26, v68
    v_sub_f32 v59, v77, v25
    v_add_f32 v26, v26, v68
    v_add_f32 v77, v77, v25
    v_mul_f32 v68, 0x3f3504f3, v83
    v_mul_f32 v25, 0x3f3504f3, v83
    v_fmac_f32 v68, 0xbf3504f3, v59
    v_fmac_f32 v25, 0x3f3504f3, v59
    v_sub_f32 v83, v57, v71
    v_sub_f32 v59, v30, v40
    v_add_f32 v30, v30, v40
    v_add_f32 v71, v71, v57
    v_sub_f32 v40, v44, v28
    v_sub_f32 v57, v33, v53
    v_add_f32 v44, v44, v28
    v_add_f32 v33, v33, v53
    v_mul_f32 v28, 0xbf3504f3, v40
    v_mul_f32 v53, 0x3f3504f3, v40
    v_fmac_f32 v28, 0xbf3504f3, v57
    v_fmac_f32 v53, 0xbf3504f3, v57
    v_sub_f32 v40, v20, v70
    v_sub_f32 v57, v17, v81
    v_add_f32 v20, v20, v70
    v_add_f32 v17, v17, v81
    v_sub_f32 v70, v41, v79
    v_sub_f32 v81, v82, v32
    v_add_f32 v82, v82, v32
    v_add_f32 v79, v79, v41
    v_sub_f32 v32, v46, v38
    v_sub_f32 v41, v39, v45
    v_add_f32 v46, v46, v38
    v_add_f32 v39, v39, v45
    v_sub_f32 v38, v31, v63
    v_sub_f32 v45, v78, v62
    v_add_f32 v78, v78, v62
    v_add_f32 v63, v63, v31
    v_sub_f32 v62, v50, v64
    v_sub_f32 v31, v49, v37
    v_add_f32 v50, v50, v64
    v_add_f32 v49, v49, v37
    v_sub_f32 v64, v35, v67
    v_sub_f32 v37, v18, v66
    v_add_f32 v18, v18, v66
    v_add_f32 v67, v67, v35
    v_sub_f32 v66, v36, v56
    v_sub_f32 v35, v29, v55
    v_add_f32 v36, v36, v56
    v_add_f32 v29, v29, v55
    v_sub_f32 v56, v51, v21
    v_sub_f32 v55, v74, v58
    v_add_f32 v74, v74, v58
    v_add_f32 v21, v21, v51
    v_sub_f32 v58, v24, v54
    v_sub_f32 v51, v75, v27
    v_add_f32 v24, v24, v54
    v_add_f32 v75, v75, v27
    v_sub_f32 v54, v65, v43
    v_sub_f32 v27, v72, v48
    v_add_f32 v72, v72, v48
    v_add_f32 v43, v43, v65
    v_sub_f32 v48, v42, v60
    v_sub_f32 v65, v69, v19
    v_add_f32 v42, v42, v60
    v_add_f32 v69, v69, v19
    v_sub_f32 v60, v47, v73
    v_sub_f32 v19, v16, v52
    v_add_f32 v16, v16, v52
    v_add_f32 v73, v73, v47
    v_sub_f32 v52, v80, v30
    v_sub_f32 v47, v23, v71
    v_add_f32 v80, v80, v30
    v_add_f32 v23, v23, v71
    v_sub_f32 v30, v33, v77
    v_sub_f32 v71, v26, v44
    v_add_f32 v26, v26, v44
    v_add_f32 v77, v77, v33
    v_sub_f32 v44, v34, v83
    v_sub_f32 v33, v61, v59
    v_add_f32 v34, v34, v83
    v_add_f32 v61, v61, v59
    v_sub_f32 v83, v53, v25
    v_sub_f32 v59, v68, v28
    v_add_f32 v68, v68, v28
    v_add_f32 v25, v25, v53
    v_sub_f32 v28, v20, v82
    v_sub_f32 v53, v17, v79
    v_add_f32 v20, v20, v82
    v_add_f32 v17, v17, v79
    v_sub_f32 v82, v40, v70
    v_sub_f32 v79, v57, v81
    v_add_f32 v40, v40, v70
    v_add_f32 v57, v57, v81
    v_sub_f32 v70, v46, v78
    v_sub_f32 v81, v39, v63
    v_add_f32 v46, v46, v78
    v_add_f32 v39, v39, v63
    v_sub_f32 v78, v32, v38
    v_sub_f32 v63, v41, v45
    v_add_f32 v32, v32, v38
    v_add_f32 v41, v41, v45
    v_sub_f32 v38, v50, v18
    v_sub_f32 v45, v49, v67
    v_add_f32 v50, v50, v18
    v_add_f32 v49, v49, v67
    v_sub_f32 v18, v62, v64
    v_sub_f32 v67, v31, v37
    v_add_f32 v62, v62, v64
    v_add_f32 v31, v31, v37
    v_sub_f32 v64, v36, v74
    v_sub_f32 v37, v29, v21
    v_add_f32 v36, v36, v74
    v_add_f32 v29, v29, v21
    v_sub_f32 v74, v66, v56
    v_sub_f32 v21, v35, v55
    v_add_f32 v66, v66, v56
    v_add_f32 v35, v35, v55
    v_sub_f32 v56, v24, v72
    v_sub_f32 v55, v75, v43
    v_add_f32 v24, v24, v72
    v_add_f32 v75, v75, v43
    v_sub_f32 v72, v58, v54
    v_sub_f32 v43, v51, v27
    v_add_f32 v58, v58, v54
    v_add_f32 v51, v51, v27
    v_sub_f32 v54, v42, v16
    v_sub_f32 v27, v69, v73
    v_add_f32 v42, v42, v16
    v_add_f32 v69, v69, v73
    v_sub_f32 v16, v48, v60
    v_sub_f32 v73, v65, v19
    v_add_f32 v48, v48, v60
    v_add_f32 v65, v65, v19
    v_sub_f32 v60, v80, v26
    v_sub_f32 v19, v23, v77
    v_add_f32 v80, v80, v26
    v_add_f32 v23, v23, v77
    v_sub_f32 v26, v52, v30
    v_sub_f32 v77, v47, v71
    v_add_f32 v52, v52, v30
    v_add_f32 v47, v47, v71
    v_sub_f32 v30, v34, v68
    v_sub_f32 v71, v61, v25
    v_add_f32 v34, v34, v68
    v_add_f32 v61, v61, v25
    v_sub_f32 v68, v44, v83
    v_sub_f32 v25, v33, v59
    v_add_f32 v44, v44, v83
    v_add_f32 v33, v33, v59
    s_add_u32 s15, s14, 109051904
    v_lshlrev_b32 v5, 3, v1
    s_add_u32 s16, s15, 0
    v_mov_b32 v88, v20
    v_mov_b32 v89, v17
    buffer_store_dwordx2 v[88:89], v5, s[8:11], s16 offen sc1
    s_add_u32 s16, s15, 512
    v_mov_b32 v90, v24
    v_mov_b32 v91, v75
    buffer_store_dwordx2 v[90:91], v5, s[8:11], s16 offen sc1
    s_add_u32 s16, s15, 1024
    v_mov_b32 v92, v50
    v_mov_b32 v93, v49
    buffer_store_dwordx2 v[92:93], v5, s[8:11], s16 offen sc1
    s_add_u32 s16, s15, 1536
    v_mov_b32 v94, v80
    v_mov_b32 v95, v23
    buffer_store_dwordx2 v[94:95], v5, s[8:11], s16 offen sc1
    s_add_u32 s16, s15, 2048
    v_mov_b32 v96, v46
    v_mov_b32 v97, v39
    buffer_store_dwordx2 v[96:97], v5, s[8:11], s16 offen sc1
    s_add_u32 s16, s15, 2560
    v_mov_b32 v98, v42
    v_mov_b32 v99, v69
    buffer_store_dwordx2 v[98:99], v5, s[8:11], s16 offen sc1
    s_add_u32 s16, s15, 3072
    v_mov_b32 v100, v36
    v_mov_b32 v101, v29
    buffer_store_dwordx2 v[100:101], v5, s[8:11], s16 offen sc1
    s_add_u32 s16, s15, 3584
    v_mov_b32 v102, v34
    v_mov_b32 v103, v61
    buffer_store_dwordx2 v[102:103], v5, s[8:11], s16 offen sc1
    s_add_u32 s16, s15, 4096
    v_mov_b32 v88, v40
    v_mov_b32 v89, v57
    buffer_store_dwordx2 v[88:89], v5, s[8:11], s16 offen sc1
    s_add_u32 s16, s15, 4608
    v_mov_b32 v90, v58
    v_mov_b32 v91, v51
    buffer_store_dwordx2 v[90:91], v5, s[8:11], s16 offen sc1
    s_add_u32 s16, s15, 5120
    v_mov_b32 v92, v62
    v_mov_b32 v93, v31
    buffer_store_dwordx2 v[92:93], v5, s[8:11], s16 offen sc1
    s_add_u32 s16, s15, 5632
    v_mov_b32 v94, v52
    v_mov_b32 v95, v47
    buffer_store_dwordx2 v[94:95], v5, s[8:11], s16 offen sc1
    s_add_u32 s16, s15, 6144
    v_mov_b32 v96, v32
    v_mov_b32 v97, v41
    buffer_store_dwordx2 v[96:97], v5, s[8:11], s16 offen sc1
    s_add_u32 s16, s15, 6656
    v_mov_b32 v98, v48
    v_mov_b32 v99, v65
    buffer_store_dwordx2 v[98:99], v5, s[8:11], s16 offen sc1
    s_add_u32 s16, s15, 7168
    v_mov_b32 v100, v66
    v_mov_b32 v101, v35
    buffer_store_dwordx2 v[100:101], v5, s[8:11], s16 offen sc1
    s_add_u32 s16, s15, 7680
    v_mov_b32 v102, v44
    v_mov_b32 v103, v33
    buffer_store_dwordx2 v[102:103], v5, s[8:11], s16 offen sc1
    s_add_u32 s16, s15, 8192
    v_mov_b32 v88, v28
    v_mov_b32 v89, v53
    buffer_store_dwordx2 v[88:89], v5, s[8:11], s16 offen sc1
    s_add_u32 s16, s15, 8704
    v_mov_b32 v90, v56
    v_mov_b32 v91, v55
    buffer_store_dwordx2 v[90:91], v5, s[8:11], s16 offen sc1
    s_add_u32 s16, s15, 9216
    v_mov_b32 v92, v38
    v_mov_b32 v93, v45
    buffer_store_dwordx2 v[92:93], v5, s[8:11], s16 offen sc1
    s_add_u32 s16, s15, 9728
    v_mov_b32 v94, v60
    v_mov_b32 v95, v19
    buffer_store_dwordx2 v[94:95], v5, s[8:11], s16 offen sc1
    s_add_u32 s16, s15, 10240
    v_mov_b32 v96, v70
    v_mov_b32 v97, v81
    buffer_store_dwordx2 v[96:97], v5, s[8:11], s16 offen sc1
    s_add_u32 s16, s15, 10752
    v_mov_b32 v98, v54
    v_mov_b32 v99, v27
    buffer_store_dwordx2 v[98:99], v5, s[8:11], s16 offen sc1
    s_add_u32 s16, s15, 11264
    v_mov_b32 v100, v64
    v_mov_b32 v101, v37
    buffer_store_dwordx2 v[100:101], v5, s[8:11], s16 offen sc1
    s_add_u32 s16, s15, 11776
    v_mov_b32 v102, v30
    v_mov_b32 v103, v71
    buffer_store_dwordx2 v[102:103], v5, s[8:11], s16 offen sc1
    s_add_u32 s16, s15, 12288
    v_mov_b32 v88, v82
    v_mov_b32 v89, v79
    buffer_store_dwordx2 v[88:89], v5, s[8:11], s16 offen sc1
    s_add_u32 s16, s15, 12800
    v_mov_b32 v90, v72
    v_mov_b32 v91, v43
    buffer_store_dwordx2 v[90:91], v5, s[8:11], s16 offen sc1
    s_add_u32 s16, s15, 13312
    v_mov_b32 v92, v18
    v_mov_b32 v93, v67
    buffer_store_dwordx2 v[92:93], v5, s[8:11], s16 offen sc1
    s_add_u32 s16, s15, 13824
    v_mov_b32 v94, v26
    v_mov_b32 v95, v77
    buffer_store_dwordx2 v[94:95], v5, s[8:11], s16 offen sc1
    s_add_u32 s16, s15, 14336
    v_mov_b32 v96, v78
    v_mov_b32 v97, v63
    buffer_store_dwordx2 v[96:97], v5, s[8:11], s16 offen sc1
    s_add_u32 s16, s15, 14848
    v_mov_b32 v98, v16
    v_mov_b32 v99, v73
    buffer_store_dwordx2 v[98:99], v5, s[8:11], s16 offen sc1
    s_add_u32 s16, s15, 15360
    v_mov_b32 v100, v74
    v_mov_b32 v101, v21
    buffer_store_dwordx2 v[100:101], v5, s[8:11], s16 offen sc1
    s_add_u32 s16, s15, 15872
    v_mov_b32 v102, v68
    v_mov_b32 v103, v25
    buffer_store_dwordx2 v[102:103], v5, s[8:11], s16 offen sc1
mega_kernel_f2_end:
    s_cmp_eq_u32 s99, 128
    s_cbranch_scc1 mega_kernel_f2ret
    s_waitcnt vmcnt(0)
    s_barrier
    s_cmp_lg_u32 s98, 0
    s_cbranch_scc1 mega_kernel_sg_7
    v_mov_b32 v2, 1
    s_mov_b32 s81, 71360768
    s_mov_b64 exec, 1
    buffer_atomic_add v2, off, s[84:87], s81 sc1
    s_mov_b64 exec, -1
mega_kernel_sg_7:
    s_waitcnt vmcnt(0)
    ds_read_b64_tr_b16 a[128:129], v201 offset:0
    ds_read_b64_tr_b16 a[130:131], v201 offset:256
    ds_read_b64_tr_b16 a[132:133], v201 offset:1024
    ds_read_b64_tr_b16 a[134:135], v201 offset:1280
    ds_read_b64_tr_b16 a[136:137], v201 offset:2048
    ds_read_b64_tr_b16 a[138:139], v201 offset:2304
    ds_read_b64_tr_b16 a[140:141], v201 offset:3072
    ds_read_b64_tr_b16 a[142:143], v201 offset:3328
    s_waitcnt lgkmcnt(0)
    ds_read_b64_tr_b16 a[144:145], v201 offset:4096
    ds_read_b64_tr_b16 a[146:147], v201 offset:4352
    ds_read_b64_tr_b16 a[148:149], v201 offset:5120
    ds_read_b64_tr_b16 a[150:151], v201 offset:5376
    ds_read_b64_tr_b16 a[152:153], v201 offset:6144
    ds_read_b64_tr_b16 a[154:155], v201 offset:6400
    ds_read_b64_tr_b16 a[156:157], v201 offset:7168
    ds_read_b64_tr_b16 a[158:159], v201 offset:7424
    s_waitcnt lgkmcnt(0)
    ds_read_b64_tr_b16 a[160:161], v201 offset:8192
    ds_read_b64_tr_b16 a[162:163], v201 offset:8448
    ds_read_b64_tr_b16 a[164:165], v201 offset:9216
    ds_read_b64_tr_b16 a[166:167], v201 offset:9472
    ds_read_b64_tr_b16 a[168:169], v201 offset:10240
    ds_read_b64_tr_b16 a[170:171], v201 offset:10496
    ds_read_b64_tr_b16 a[172:173], v201 offset:11264
    ds_read_b64_tr_b16 a[174:175], v201 offset:11520
    s_waitcnt lgkmcnt(0)
    ds_read_b64_tr_b16 a[176:177], v201 offset:12288
    ds_read_b64_tr_b16 a[178:179], v201 offset:12544
    ds_read_b64_tr_b16 a[180:181], v201 offset:13312
    ds_read_b64_tr_b16 a[182:183], v201 offset:13568
    ds_read_b64_tr_b16 a[184:185], v201 offset:14336
    ds_read_b64_tr_b16 a[186:187], v201 offset:14592
    ds_read_b64_tr_b16 a[188:189], v201 offset:15360
    ds_read_b64_tr_b16 a[190:191], v201 offset:15616
    s_waitcnt lgkmcnt(0)
    s_add_u32 m0, s56, 0
    s_add_u32 s58, s57, 49152
    s_and_b32 s58, s58, 0xffff
    s_lshl_b32 s58, s58, 5
    buffer_load_dwordx4 v200, s[52:55], s58 offen lds
    s_add_u32 m0, s56, 1024
    s_add_u32 s58, s57, 50176
    s_and_b32 s58, s58, 0xffff
    s_lshl_b32 s58, s58, 5
    buffer_load_dwordx4 v200, s[52:55], s58 offen lds
    s_add_u32 m0, s56, 2048
    s_add_u32 s58, s57, 51200
    s_and_b32 s58, s58, 0xffff
    s_lshl_b32 s58, s58, 5
    buffer_load_dwordx4 v200, s[52:55], s58 offen lds
    s_add_u32 m0, s56, 3072
    s_add_u32 s58, s57, 52224
    s_and_b32 s58, s58, 0xffff
    s_lshl_b32 s58, s58, 5
    buffer_load_dwordx4 v200, s[52:55], s58 offen lds
    s_add_u32 m0, s56, 4096
    s_add_u32 s58, s57, 53248
    s_and_b32 s58, s58, 0xffff
    s_lshl_b32 s58, s58, 5
    buffer_load_dwordx4 v200, s[52:55], s58 offen lds
    s_add_u32 m0, s56, 5120
    s_add_u32 s58, s57, 54272
    s_and_b32 s58, s58, 0xffff
    s_lshl_b32 s58, s58, 5
    buffer_load_dwordx4 v200, s[52:55], s58 offen lds
    s_add_u32 m0, s56, 6144
    s_add_u32 s58, s57, 55296
    s_and_b32 s58, s58, 0xffff
    s_lshl_b32 s58, s58, 5
    buffer_load_dwordx4 v200, s[52:55], s58 offen lds
    s_add_u32 m0, s56, 7168
    s_add_u32 s58, s57, 56320
    s_and_b32 s58, s58, 0xffff
    s_lshl_b32 s58, s58, 5
    buffer_load_dwordx4 v200, s[52:55], s58 offen lds
    s_add_u32 m0, s56, 8192
    s_add_u32 s58, s57, 57344
    s_and_b32 s58, s58, 0xffff
    s_lshl_b32 s58, s58, 5
    buffer_load_dwordx4 v200, s[52:55], s58 offen lds
    s_add_u32 m0, s56, 9216
    s_add_u32 s58, s57, 58368
    s_and_b32 s58, s58, 0xffff
    s_lshl_b32 s58, s58, 5
    buffer_load_dwordx4 v200, s[52:55], s58 offen lds
    s_add_u32 m0, s56, 10240
    s_add_u32 s58, s57, 59392
    s_and_b32 s58, s58, 0xffff
    s_lshl_b32 s58, s58, 5
    buffer_load_dwordx4 v200, s[52:55], s58 offen lds
    s_add_u32 m0, s56, 11264
    s_add_u32 s58, s57, 60416
    s_and_b32 s58, s58, 0xffff
    s_lshl_b32 s58, s58, 5
    buffer_load_dwordx4 v200, s[52:55], s58 offen lds
    s_add_u32 m0, s56, 12288
    s_add_u32 s58, s57, 61440
    s_and_b32 s58, s58, 0xffff
    s_lshl_b32 s58, s58, 5
    buffer_load_dwordx4 v200, s[52:55], s58 offen lds
    s_add_u32 m0, s56, 13312
    s_add_u32 s58, s57, 62464
    s_and_b32 s58, s58, 0xffff
    s_lshl_b32 s58, s58, 5
    buffer_load_dwordx4 v200, s[52:55], s58 offen lds
    s_add_u32 m0, s56, 14336
    s_add_u32 s58, s57, 63488
    s_and_b32 s58, s58, 0xffff
    s_lshl_b32 s58, s58, 5
    buffer_load_dwordx4 v200, s[52:55], s58 offen lds
    s_add_u32 m0, s56, 15360
    s_add_u32 s58, s57, 64512
    s_and_b32 s58, s58, 0xffff
    s_lshl_b32 s58, s58, 5
    buffer_load_dwordx4 v200, s[52:55], s58 offen lds
    s_cmp_lg_u32 s98, 0
    s_cbranch_scc1 mega_kernel_wf2d
    s_mov_b32 s81, 71360768
mega_kernel_wf2:
    buffer_load_dword v120, off, s[84:87], s81 sc1
    s_waitcnt vmcnt(0)
    v_cmp_ne_u32 vcc, 129, v120
    s_cbranch_vccz mega_kernel_wf2d
    s_sleep 6
    s_branch mega_kernel_wf2
mega_kernel_wf2d:
    s_barrier
    s_load_dwordx2 s[4:5], s[0:1], 80
    s_load_dwordx2 s[8:9], s[0:1], 96
    v_and_b32 v6, 7, v0
    v_lshrrev_b32 v7, 3, v0
    s_movk_i32 s13, 8448
    v_mul_lo_u32 v8, v6, s13
    v_lshl_add_u32 v4, v7, 3, v8
    v_lshlrev_b32 v5, 14, v7
    v_lshl_add_u32 v5, v6, 4, v5
    s_lshl_b32 s12, s92, 7
    s_add_u32 s12, s12, 109051904
    s_waitcnt lgkmcnt(0)
    s_mov_b32 s6, 8388608
    s_mov_b32 s7, 0x00020000
    s_mov_b32 s10, 268435456
    s_mov_b32 s11, 0x00020000
    s_add_u32 s13, s12, 0
    buffer_load_dwordx4 v[16:19], v5, s[8:11], s13 offen
    s_add_u32 s13, s12, 524288
    buffer_load_dwordx4 v[20:23], v5, s[8:11], s13 offen
    s_add_u32 s13, s12, 1048576
    buffer_load_dwordx4 v[24:27], v5, s[8:11], s13 offen
    s_add_u32 s13, s12, 1572864
    buffer_load_dwordx4 v[28:31], v5, s[8:11], s13 offen
    s_add_u32 s13, s12, 2097152
    buffer_load_dwordx4 v[32:35], v5, s[8:11], s13 offen
    s_add_u32 s13, s12, 2621440
    buffer_load_dwordx4 v[36:39], v5, s[8:11], s13 offen
    s_add_u32 s13, s12, 3145728
    buffer_load_dwordx4 v[40:43], v5, s[8:11], s13 offen
    s_add_u32 s13, s12, 3670016
    buffer_load_dwordx4 v[44:47], v5, s[8:11], s13 offen
    s_add_u32 s13, s12, 4194304
    buffer_load_dwordx4 v[48:51], v5, s[8:11], s13 offen
    s_add_u32 s13, s12, 4718592
    buffer_load_dwordx4 v[52:55], v5, s[8:11], s13 offen
    s_add_u32 s13, s12, 5242880
    buffer_load_dwordx4 v[56:59], v5, s[8:11], s13 offen
    s_add_u32 s13, s12, 5767168
    buffer_load_dwordx4 v[60:63], v5, s[8:11], s13 offen
    s_add_u32 s13, s12, 6291456
    buffer_load_dwordx4 v[64:67], v5, s[8:11], s13 offen
    s_add_u32 s13, s12, 6815744
    buffer_load_dwordx4 v[68:71], v5, s[8:11], s13 offen
    s_add_u32 s13, s12, 7340032
    buffer_load_dwordx4 v[72:75], v5, s[8:11], s13 offen
    s_add_u32 s13, s12, 7864320
    buffer_load_dwordx4 v[76:79], v5, s[8:11], s13 offen
    s_add_u32 s13, s12, 8388608
    buffer_load_dwordx4 v[80:83], v5, s[8:11], s13 offen
    s_waitcnt vmcnt(0)
    v_cmp_eq_u32 vcc, 0, v7
    s_nop 1
    v_mov_b32 v9, 0
    v_cndmask_b32 v17, v17, v9, vcc
    v_cndmask_b32 v19, v19, v9, vcc
    v_cndmask_b32 v81, v81, v9, vcc
    v_cndmask_b32 v83, v83, v9, vcc
    v_sub_u32 v6, 1024, v7
    v_and_b32 v6, 1023, v6
    v_lshl_add_u32 v6, v6, 3, v8
    v_sub_f32 v10, v16, v19
    v_add_f32 v11, v17, v18
    v_add_f32 v12, v16, v19
    v_sub_f32 v13, v18, v17
    ds_write_b64 v4, v[10:11] offset:0
    ds_write_b64 v6, v[12:13]
    v_sub_u32 v6, 992, v7
    v_and_b32 v6, 1023, v6
    v_lshl_add_u32 v6, v6, 3, v8
    v_sub_f32 v10, v20, v23
    v_add_f32 v11, v21, v22
    v_add_f32 v12, v20, v23
    v_sub_f32 v13, v22, v21
    ds_write_b64 v4, v[10:11] offset:256
    ds_write_b64 v6, v[12:13]
    v_sub_u32 v6, 960, v7
    v_and_b32 v6, 1023, v6
    v_lshl_add_u32 v6, v6, 3, v8
    v_sub_f32 v10, v24, v27
    v_add_f32 v11, v25, v26
    v_add_f32 v12, v24, v27
    v_sub_f32 v13, v26, v25
    ds_write_b64 v4, v[10:11] offset:512
    ds_write_b64 v6, v[12:13]
    v_sub_u32 v6, 928, v7
    v_and_b32 v6, 1023, v6
    v_lshl_add_u32 v6, v6, 3, v8
    v_sub_f32 v10, v28, v31
    v_add_f32 v11, v29, v30
    v_add_f32 v12, v28, v31
    v_sub_f32 v13, v30, v29
    ds_write_b64 v4, v[10:11] offset:768
    ds_write_b64 v6, v[12:13]
    v_sub_u32 v6, 896, v7
    v_and_b32 v6, 1023, v6
    v_lshl_add_u32 v6, v6, 3, v8
    v_sub_f32 v10, v32, v35
    v_add_f32 v11, v33, v34
    v_add_f32 v12, v32, v35
    v_sub_f32 v13, v34, v33
    ds_write_b64 v4, v[10:11] offset:1024
    ds_write_b64 v6, v[12:13]
    v_sub_u32 v6, 864, v7
    v_and_b32 v6, 1023, v6
    v_lshl_add_u32 v6, v6, 3, v8
    v_sub_f32 v10, v36, v39
    v_add_f32 v11, v37, v38
    v_add_f32 v12, v36, v39
    v_sub_f32 v13, v38, v37
    ds_write_b64 v4, v[10:11] offset:1280
    ds_write_b64 v6, v[12:13]
    v_sub_u32 v6, 832, v7
    v_and_b32 v6, 1023, v6
    v_lshl_add_u32 v6, v6, 3, v8
    v_sub_f32 v10, v40, v43
    v_add_f32 v11, v41, v42
    v_add_f32 v12, v40, v43
    v_sub_f32 v13, v42, v41
    ds_write_b64 v4, v[10:11] offset:1536
    ds_write_b64 v6, v[12:13]
    v_sub_u32 v6, 800, v7
    v_and_b32 v6, 1023, v6
    v_lshl_add_u32 v6, v6, 3, v8
    v_sub_f32 v10, v44, v47
    v_add_f32 v11, v45, v46
    v_add_f32 v12, v44, v47
    v_sub_f32 v13, v46, v45
    ds_write_b64 v4, v[10:11] offset:1792
    ds_write_b64 v6, v[12:13]
    v_sub_u32 v6, 768, v7
    v_and_b32 v6, 1023, v6
    v_lshl_add_u32 v6, v6, 3, v8
    v_sub_f32 v10, v48, v51
    v_add_f32 v11, v49, v50
    v_add_f32 v12, v48, v51
    v_sub_f32 v13, v50, v49
    ds_write_b64 v4, v[10:11] offset:2048
    ds_write_b64 v6, v[12:13]
    v_sub_u32 v6, 736, v7
    v_and_b32 v6, 1023, v6
    v_lshl_add_u32 v6, v6, 3, v8
    v_sub_f32 v10, v52, v55
    v_add_f32 v11, v53, v54
    v_add_f32 v12, v52, v55
    v_sub_f32 v13, v54, v53
    ds_write_b64 v4, v[10:11] offset:2304
    ds_write_b64 v6, v[12:13]
    v_sub_u32 v6, 704, v7
    v_and_b32 v6, 1023, v6
    v_lshl_add_u32 v6, v6, 3, v8
    v_sub_f32 v10, v56, v59
    v_add_f32 v11, v57, v58
    v_add_f32 v12, v56, v59
    v_sub_f32 v13, v58, v57
    ds_write_b64 v4, v[10:11] offset:2560
    ds_write_b64 v6, v[12:13]
    v_sub_u32 v6, 672, v7
    v_and_b32 v6, 1023, v6
    v_lshl_add_u32 v6, v6, 3, v8
    v_sub_f32 v10, v60, v63
    v_add_f32 v11, v61, v62
    v_add_f32 v12, v60, v63
    v_sub_f32 v13, v62, v61
    ds_write_b64 v4, v[10:11] offset:2816
    ds_write_b64 v6, v[12:13]
    v_sub_u32 v6, 640, v7
    v_and_b32 v6, 1023, v6
    v_lshl_add_u32 v6, v6, 3, v8
    v_sub_f32 v10, v64, v67
    v_add_f32 v11, v65, v66
    v_add_f32 v12, v64, v67
    v_sub_f32 v13, v66, v65
    ds_write_b64 v4, v[10:11] offset:3072
    ds_write_b64 v6, v[12:13]
    v_sub_u32 v6, 608, v7
    v_and_b32 v6, 1023, v6
    v_lshl_add_u32 v6, v6, 3, v8
    v_sub_f32 v10, v68, v71
    v_add_f32 v11, v69, v70
    v_add_f32 v12, v68, v71
    v_sub_f32 v13, v70, v69
    ds_write_b64 v4, v[10:11] offset:3328
    ds_write_b64 v6, v[12:13]
    v_sub_u32 v6, 576, v7
    v_and_b32 v6, 1023, v6
    v_lshl_add_u32 v6, v6, 3, v8
    v_sub_f32 v10, v72, v75
    v_add_f32 v11, v73, v74
    v_add_f32 v12, v72, v75
    v_sub_f32 v13, v74, v73
    ds_write_b64 v4, v[10:11] offset:3584
    ds_write_b64 v6, v[12:13]
    v_sub_u32 v6, 544, v7
    v_and_b32 v6, 1023, v6
    v_lshl_add_u32 v6, v6, 3, v8
    v_sub_f32 v10, v76, v79
    v_add_f32 v11, v77, v78
    v_add_f32 v12, v76, v79
    v_sub_f32 v13, v78, v77
    ds_write_b64 v4, v[10:11] offset:3840
    ds_write_b64 v6, v[12:13]
    s_and_saveexec_b64 s[14:15], vcc
    v_sub_u32 v6, 512, v7
    v_and_b32 v6, 1023, v6
    v_lshl_add_u32 v6, v6, 3, v8
    v_sub_f32 v10, v80, v83
    v_add_f32 v11, v81, v82
    v_add_f32 v12, v80, v83
    v_sub_f32 v13, v82, v81
    ds_write_b64 v4, v[10:11] offset:4096
    ds_write_b64 v6, v[12:13]
    s_mov_b64 exec, s[14:15]
    s_waitcnt lgkmcnt(0)
    s_barrier
    v_and_b32 v1, 31, v0
    v_lshrrev_b32 v2, 5, v0
    v_cvt_f32_u32 v3, v1
    s_movk_i32 s13, 8448
    v_mul_lo_u32 v7, v2, s13
    v_lshl_add_u32 v4, v1, 3, v7
    s_movk_i32 s13, 264
    v_mul_lo_u32 v5, v1, s13
    v_add_u32 v5, v5, v7
    ds_read_b32 v16, v4 offset:0
    ds_read_b32 v48, v4 offset:4
    ds_read_b32 v17, v4 offset:256
    ds_read_b32 v49, v4 offset:260
    ds_read_b32 v18, v4 offset:512
    ds_read_b32 v50, v4 offset:516
    ds_read_b32 v19, v4 offset:768
    ds_read_b32 v51, v4 offset:772
    ds_read_b32 v20, v4 offset:1024
    ds_read_b32 v52, v4 offset:1028
    ds_read_b32 v21, v4 offset:1280
    ds_read_b32 v53, v4 offset:1284
    ds_read_b32 v22, v4 offset:1536
    ds_read_b32 v54, v4 offset:1540
    s_waitcnt lgkmcnt(0)
    ds_read_b32 v23, v4 offset:1792
    ds_read_b32 v55, v4 offset:1796
    ds_read_b32 v24, v4 offset:2048
    ds_read_b32 v56, v4 offset:2052
    ds_read_b32 v25, v4 offset:2304
    ds_read_b32 v57, v4 offset:2308
    ds_read_b32 v26, v4 offset:2560
    ds_read_b32 v58, v4 offset:2564
    ds_read_b32 v27, v4 offset:2816
    ds_read_b32 v59, v4 offset:2820
    ds_read_b32 v28, v4 offset:3072
    ds_read_b32 v60, v4 offset:3076
    ds_read_b32 v29, v4 offset:3328
    ds_read_b32 v61, v4 offset:3332
    s_waitcnt lgkmcnt(0)
    ds_read_b32 v30, v4 offset:3584
    ds_read_b32 v62, v4 offset:3588
    ds_read_b32 v31, v4 offset:3840
    ds_read_b32 v63, v4 offset:3844
    ds_read_b32 v32, v4 offset:4096
    ds_read_b32 v64, v4 offset:4100
    ds_read_b32 v33, v4 offset:4352
    ds_read_b32 v65, v4 offset:4356
    ds_read_b32 v34, v4 offset:4608
    ds_read_b32 v66, v4 offset:4612
    ds_read_b32 v35, v4 offset:4864
    ds_read_b32 v67, v4 offset:4868
    ds_read_b32 v36, v4 offset:5120
    ds_read_b32 v68, v4 offset:5124
    s_waitcnt lgkmcnt(0)
    ds_read_b32 v37, v4 offset:5376
    ds_read_b32 v69, v4 offset:5380
    ds_read_b32 v38, v4 offset:5632
    ds_read_b32 v70, v4 offset:5636
    ds_read_b32 v39, v4 offset:5888
    ds_read_b32 v71, v4 offset:5892
    ds_read_b32 v40, v4 offset:6144
    ds_read_b32 v72, v4 offset:6148
    ds_read_b32 v41, v4 offset:6400
    ds_read_b32 v73, v4 offset:6404
    ds_read_b32 v42, v4 offset:6656
    ds_read_b32 v74, v4 offset:6660
    ds_read_b32 v43, v4 offset:6912
    ds_read_b32 v75, v4 offset:6916
    s_waitcnt lgkmcnt(0)
    ds_read_b32 v44, v4 offset:7168
    ds_read_b32 v76, v4 offset:7172
    ds_read_b32 v45, v4 offset:7424
    ds_read_b32 v77, v4 offset:7428
    ds_read_b32 v46, v4 offset:7680
    ds_read_b32 v78, v4 offset:7684
    ds_read_b32 v47, v4 offset:7936
    ds_read_b32 v79, v4 offset:7940
    s_waitcnt lgkmcnt(0)
    v_sub_f32 v80, v16, v32
    v_sub_f32 v81, v48, v64
    v_add_f32 v16, v16, v32
    v_add_f32 v48, v48, v64
    v_sub_f32 v32, v17, v33
    v_sub_f32 v64, v49, v65
    v_add_f32 v17, v17, v33
    v_add_f32 v49, v49, v65
    v_mul_f32 v33, 0x3f7b14be, v32
    v_mul_f32 v65, 0x3e47c5c2, v32
    v_fmac_f32 v33, 0xbe47c5c2, v64
    v_fmac_f32 v65, 0x3f7b14be, v64
    v_sub_f32 v32, v18, v34
    v_sub_f32 v64, v50, v66
    v_add_f32 v18, v18, v34
    v_add_f32 v50, v50, v66
    v_mul_f32 v34, 0x3f6c835e, v32
    v_mul_f32 v66, 0x3ec3ef15, v32
    v_fmac_f32 v34, 0xbec3ef15, v64
    v_fmac_f32 v66, 0x3f6c835e, v64
    v_sub_f32 v32, v19, v35
    v_sub_f32 v64, v51, v67
    v_add_f32 v19, v19, v35
    v_add_f32 v51, v51, v67
    v_mul_f32 v35, 0x3f54db31, v32
    v_mul_f32 v67, 0x3f0e39da, v32
    v_fmac_f32 v35, 0xbf0e39da, v64
    v_fmac_f32 v67, 0x3f54db31, v64
    v_sub_f32 v32, v20, v36
    v_sub_f32 v64, v52, v68
    v_add_f32 v20, v20, v36
    v_add_f32 v52, v52, v68
    v_mul_f32 v36, 0x3f3504f3, v32
    v_mul_f32 v68, 0x3f3504f3, v32
    v_fmac_f32 v36, 0xbf3504f3, v64
    v_fmac_f32 v68, 0x3f3504f3, v64
    v_sub_f32 v32, v21, v37
    v_sub_f32 v64, v53, v69
    v_add_f32 v21, v21, v37
    v_add_f32 v53, v53, v69
    v_mul_f32 v37, 0x3f0e39da, v32
    v_mul_f32 v69, 0x3f54db31, v32
    v_fmac_f32 v37, 0xbf54db31, v64
    v_fmac_f32 v69, 0x3f0e39da, v64
    v_sub_f32 v32, v22, v38
    v_sub_f32 v64, v54, v70
    v_add_f32 v22, v22, v38
    v_add_f32 v54, v54, v70
    v_mul_f32 v38, 0x3ec3ef15, v32
    v_mul_f32 v70, 0x3f6c835e, v32
    v_fmac_f32 v38, 0xbf6c835e, v64
    v_fmac_f32 v70, 0x3ec3ef15, v64
    v_sub_f32 v32, v23, v39
    v_sub_f32 v64, v55, v71
    v_add_f32 v23, v23, v39
    v_add_f32 v55, v55, v71
    v_mul_f32 v39, 0x3e47c5c2, v32
    v_mul_f32 v71, 0x3f7b14be, v32
    v_fmac_f32 v39, 0xbf7b14be, v64
    v_fmac_f32 v71, 0x3e47c5c2, v64
    v_sub_f32 v32, v72, v56
    v_sub_f32 v64, v24, v40
    v_add_f32 v24, v24, v40
    v_add_f32 v56, v56, v72
    v_sub_f32 v40, v25, v41
    v_sub_f32 v72, v57, v73
    v_add_f32 v25, v25, v41
    v_add_f32 v57, v57, v73
    v_mul_f32 v41, 0xbe47c5c2, v40
    v_mul_f32 v73, 0x3f7b14be, v40
    v_fmac_f32 v41, 0xbf7b14be, v72
    v_fmac_f32 v73, 0xbe47c5c2, v72
    v_sub_f32 v40, v26, v42
    v_sub_f32 v72, v58, v74
    v_add_f32 v26, v26, v42
    v_add_f32 v58, v58, v74
    v_mul_f32 v42, 0xbec3ef15, v40
    v_mul_f32 v74, 0x3f6c835e, v40
    v_fmac_f32 v42, 0xbf6c835e, v72
    v_fmac_f32 v74, 0xbec3ef15, v72
    v_sub_f32 v40, v27, v43
    v_sub_f32 v72, v59, v75
    v_add_f32 v27, v27, v43
    v_add_f32 v59, v59, v75
    v_mul_f32 v43, 0xbf0e39da, v40
    v_mul_f32 v75, 0x3f54db31, v40
    v_fmac_f32 v43, 0xbf54db31, v72
    v_fmac_f32 v75, 0xbf0e39da, v72
    v_sub_f32 v40, v28, v44
    v_sub_f32 v72, v60, v76
    v_add_f32 v28, v28, v44
    v_add_f32 v60, v60, v76
    v_mul_f32 v44, 0xbf3504f3, v40
    v_mul_f32 v76, 0x3f3504f3, v40
    v_fmac_f32 v44, 0xbf3504f3, v72
    v_fmac_f32 v76, 0xbf3504f3, v72
    v_sub_f32 v40, v29, v45
    v_sub_f32 v72, v61, v77
    v_add_f32 v29, v29, v45
    v_add_f32 v61, v61, v77
    v_mul_f32 v45, 0xbf54db31, v40
    v_mul_f32 v77, 0x3f0e39da, v40
    v_fmac_f32 v45, 0xbf0e39da, v72
    v_fmac_f32 v77, 0xbf54db31, v72
    v_sub_f32 v40, v30, v46
    v_sub_f32 v72, v62, v78
    v_add_f32 v30, v30, v46
    v_add_f32 v62, v62, v78
    v_mul_f32 v46, 0xbf6c835e, v40
    v_mul_f32 v78, 0x3ec3ef15, v40
    v_fmac_f32 v46, 0xbec3ef15, v72
    v_fmac_f32 v78, 0xbf6c835e, v72
    v_sub_f32 v40, v31, v47
    v_sub_f32 v72, v63, v79
    v_add_f32 v31, v31, v47
    v_add_f32 v63, v63, v79
    v_mul_f32 v47, 0xbf7b14be, v40
    v_mul_f32 v79, 0x3e47c5c2, v40
    v_fmac_f32 v47, 0xbe47c5c2, v72
    v_fmac_f32 v79, 0xbf7b14be, v72
    v_sub_f32 v40, v16, v24
    v_sub_f32 v72, v48, v56
    v_add_f32 v16, v16, v24
    v_add_f32 v48, v48, v56
    v_sub_f32 v24, v17, v25
    v_sub_f32 v56, v49, v57
    v_add_f32 v17, v17, v25
    v_add_f32 v49, v49, v57
    v_mul_f32 v25, 0x3f6c835e, v24
    v_mul_f32 v57, 0x3ec3ef15, v24
    v_fmac_f32 v25, 0xbec3ef15, v56
    v_fmac_f32 v57, 0x3f6c835e, v56
    v_sub_f32 v24, v18, v26
    v_sub_f32 v56, v50, v58
    v_add_f32 v18, v18, v26
    v_add_f32 v50, v50, v58
    v_mul_f32 v26, 0x3f3504f3, v24
    v_mul_f32 v58, 0x3f3504f3, v24
    v_fmac_f32 v26, 0xbf3504f3, v56
    v_fmac_f32 v58, 0x3f3504f3, v56
    v_sub_f32 v24, v19, v27
    v_sub_f32 v56, v51, v59
    v_add_f32 v19, v19, v27
    v_add_f32 v51, v51, v59
    v_mul_f32 v27, 0x3ec3ef15, v24
    v_mul_f32 v59, 0x3f6c835e, v24
    v_fmac_f32 v27, 0xbf6c835e, v56
    v_fmac_f32 v59, 0x3ec3ef15, v56
    v_sub_f32 v24, v60, v52
    v_sub_f32 v56, v20, v28
    v_add_f32 v20, v20, v28
    v_add_f32 v52, v52, v60
    v_sub_f32 v28, v21, v29
    v_sub_f32 v60, v53, v61
    v_add_f32 v21, v21, v29
    v_add_f32 v53, v53, v61
    v_mul_f32 v29, 0xbec3ef15, v28
    v_mul_f32 v61, 0x3f6c835e, v28
    v_fmac_f32 v29, 0xbf6c835e, v60
    v_fmac_f32 v61, 0xbec3ef15, v60
    v_sub_f32 v28, v22, v30
    v_sub_f32 v60, v54, v62
    v_add_f32 v22, v22, v30
    v_add_f32 v54, v54, v62
    v_mul_f32 v30, 0xbf3504f3, v28
    v_mul_f32 v62, 0x3f3504f3, v28
    v_fmac_f32 v30, 0xbf3504f3, v60
    v_fmac_f32 v62, 0xbf3504f3, v60
    v_sub_f32 v28, v23, v31
    v_sub_f32 v60, v55, v63
    v_add_f32 v23, v23, v31
    v_add_f32 v55, v55, v63
    v_mul_f32 v31, 0xbf6c835e, v28
    v_mul_f32 v63, 0x3ec3ef15, v28
    v_fmac_f32 v31, 0xbec3ef15, v60
    v_fmac_f32 v63, 0xbf6c835e, v60
    v_sub_f32 v28, v80, v32
    v_sub_f32 v60, v81, v64
    v_add_f32 v80, v80, v32
    v_add_f32 v81, v81, v64
    v_sub_f32 v32, v33, v41
    v_sub_f32 v64, v65, v73
    v_add_f32 v33, v33, v41
    v_add_f32 v65, v65, v73
    v_mul_f32 v41, 0x3f6c835e, v32
    v_mul_f32 v73, 0x3ec3ef15, v32
    v_fmac_f32 v41, 0xbec3ef15, v64
    v_fmac_f32 v73, 0x3f6c835e, v64
    v_sub_f32 v32, v34, v42
    v_sub_f32 v64, v66, v74
    v_add_f32 v34, v34, v42
    v_add_f32 v66, v66, v74
    v_mul_f32 v42, 0x3f3504f3, v32
    v_mul_f32 v74, 0x3f3504f3, v32
    v_fmac_f32 v42, 0xbf3504f3, v64
    v_fmac_f32 v74, 0x3f3504f3, v64
    v_sub_f32 v32, v35, v43
    v_sub_f32 v64, v67, v75
    v_add_f32 v35, v35, v43
    v_add_f32 v67, v67, v75
    v_mul_f32 v43, 0x3ec3ef15, v32
    v_mul_f32 v75, 0x3f6c835e, v32
    v_fmac_f32 v43, 0xbf6c835e, v64
    v_fmac_f32 v75, 0x3ec3ef15, v64
    v_sub_f32 v32, v76, v68
    v_sub_f32 v64, v36, v44
    v_add_f32 v36, v36, v44
    v_add_f32 v68, v68, v76
    v_sub_f32 v44, v37, v45
    v_sub_f32 v76, v69, v77
    v_add_f32 v37, v37, v45
    v_add_f32 v69, v69, v77
    v_mul_f32 v45, 0xbec3ef15, v44
    v_mul_f32 v77, 0x3f6c835e, v44
    v_fmac_f32 v45, 0xbf6c835e, v76
    v_fmac_f32 v77, 0xbec3ef15, v76
    v_sub_f32 v44, v38, v46
    v_sub_f32 v76, v70, v78
    v_add_f32 v38, v38, v46
    v_add_f32 v70, v70, v78
    v_mul_f32 v46, 0xbf3504f3, v44
    v_mul_f32 v78, 0x3f3504f3, v44
    v_fmac_f32 v46, 0xbf3504f3, v76
    v_fmac_f32 v78, 0xbf3504f3, v76
    v_sub_f32 v44, v39, v47
    v_sub_f32 v76, v71, v79
    v_add_f32 v39, v39, v47
    v_add_f32 v71, v71, v79
    v_mul_f32 v47, 0xbf6c835e, v44
    v_mul_f32 v79, 0x3ec3ef15, v44
    v_fmac_f32 v47, 0xbec3ef15, v76
    v_fmac_f32 v79, 0xbf6c835e, v76
    v_sub_f32 v44, v16, v20
    v_sub_f32 v76, v48, v52
    v_add_f32 v16, v16, v20
    v_add_f32 v48, v48, v52
    v_sub_f32 v20, v17, v21
    v_sub_f32 v52, v49, v53
    v_add_f32 v17, v17, v21
    v_add_f32 v49, v49, v53
    v_mul_f32 v21, 0x3f3504f3, v20
    v_mul_f32 v53, 0x3f3504f3, v20
    v_fmac_f32 v21, 0xbf3504f3, v52
    v_fmac_f32 v53, 0x3f3504f3, v52
    v_sub_f32 v20, v54, v50
    v_sub_f32 v52, v18, v22
    v_add_f32 v18, v18, v22
    v_add_f32 v50, v50, v54
    v_sub_f32 v22, v19, v23
    v_sub_f32 v54, v51, v55
    v_add_f32 v19, v19, v23
    v_add_f32 v51, v51, v55
    v_mul_f32 v23, 0xbf3504f3, v22
    v_mul_f32 v55, 0x3f3504f3, v22
    v_fmac_f32 v23, 0xbf3504f3, v54
    v_fmac_f32 v55, 0xbf3504f3, v54
    v_sub_f32 v22, v40, v24
    v_sub_f32 v54, v72, v56
    v_add_f32 v40, v40, v24
    v_add_f32 v72, v72, v56
    v_sub_f32 v24, v25, v29
    v_sub_f32 v56, v57, v61
    v_add_f32 v25, v25, v29
    v_add_f32 v57, v57, v61
    v_mul_f32 v29, 0x3f3504f3, v24
    v_mul_f32 v61, 0x3f3504f3, v24
    v_fmac_f32 v29, 0xbf3504f3, v56
    v_fmac_f32 v61, 0x3f3504f3, v56
    v_sub_f32 v24, v62, v58
    v_sub_f32 v56, v26, v30
    v_add_f32 v26, v26, v30
    v_add_f32 v58, v58, v62
    v_sub_f32 v30, v27, v31
    v_sub_f32 v62, v59, v63
    v_add_f32 v27, v27, v31
    v_add_f32 v59, v59, v63
    v_mul_f32 v31, 0xbf3504f3, v30
    v_mul_f32 v63, 0x3f3504f3, v30
    v_fmac_f32 v31, 0xbf3504f3, v62
    v_fmac_f32 v63, 0xbf3504f3, v62
    v_sub_f32 v30, v80, v36
    v_sub_f32 v62, v81, v68
    v_add_f32 v80, v80, v36
    v_add_f32 v81, v81, v68
    v_sub_f32 v36, v33, v37
    v_sub_f32 v68, v65, v69
    v_add_f32 v33, v33, v37
    v_add_f32 v65, v65, v69
    v_mul_f32 v37, 0x3f3504f3, v36
    v_mul_f32 v69, 0x3f3504f3, v36
    v_fmac_f32 v37, 0xbf3504f3, v68
    v_fmac_f32 v69, 0x3f3504f3, v68
    v_sub_f32 v36, v70, v66
    v_sub_f32 v68, v34, v38
    v_add_f32 v34, v34, v38
    v_add_f32 v66, v66, v70
    v_sub_f32 v38, v35, v39
    v_sub_f32 v70, v67, v71
    v_add_f32 v35, v35, v39
    v_add_f32 v67, v67, v71
    v_mul_f32 v39, 0xbf3504f3, v38
    v_mul_f32 v71, 0x3f3504f3, v38
    v_fmac_f32 v39, 0xbf3504f3, v70
    v_fmac_f32 v71, 0xbf3504f3, v70
    v_sub_f32 v38, v28, v32
    v_sub_f32 v70, v60, v64
    v_add_f32 v28, v28, v32
    v_add_f32 v60, v60, v64
    v_sub_f32 v32, v41, v45
    v_sub_f32 v64, v73, v77
    v_add_f32 v41, v41, v45
    v_add_f32 v73, v73, v77
    v_mul_f32 v45, 0x3f3504f3, v32
    v_mul_f32 v77, 0x3f3504f3, v32
    v_fmac_f32 v45, 0xbf3504f3, v64
    v_fmac_f32 v77, 0x3f3504f3, v64
    v_sub_f32 v32, v78, v74
    v_sub_f32 v64, v42, v46
    v_add_f32 v42, v42, v46
    v_add_f32 v74, v74, v78
    v_sub_f32 v46, v43, v47
    v_sub_f32 v78, v75, v79
    v_add_f32 v43, v43, v47
    v_add_f32 v75, v75, v79
    v_mul_f32 v47, 0xbf3504f3, v46
    v_mul_f32 v79, 0x3f3504f3, v46
    v_fmac_f32 v47, 0xbf3504f3, v78
    v_fmac_f32 v79, 0xbf3504f3, v78
    v_sub_f32 v46, v16, v18
    v_sub_f32 v78, v48, v50
    v_add_f32 v16, v16, v18
    v_add_f32 v48, v48, v50
    v_sub_f32 v18, v51, v49
    v_sub_f32 v50, v17, v19
    v_add_f32 v17, v17, v19
    v_add_f32 v49, v49, v51
    v_sub_f32 v19, v44, v20
    v_sub_f32 v51, v76, v52
    v_add_f32 v44, v44, v20
    v_add_f32 v76, v76, v52
    v_sub_f32 v20, v55, v53
    v_sub_f32 v52, v21, v23
    v_add_f32 v21, v21, v23
    v_add_f32 v53, v53, v55
    v_sub_f32 v23, v40, v26
    v_sub_f32 v55, v72, v58
    v_add_f32 v40, v40, v26
    v_add_f32 v72, v72, v58
    v_sub_f32 v26, v59, v57
    v_sub_f32 v58, v25, v27
    v_add_f32 v25, v25, v27
    v_add_f32 v57, v57, v59
    v_sub_f32 v27, v22, v24
    v_sub_f32 v59, v54, v56
    v_add_f32 v22, v22, v24
    v_add_f32 v54, v54, v56
    v_sub_f32 v24, v63, v61
    v_sub_f32 v56, v29, v31
    v_add_f32 v29, v29, v31
    v_add_f32 v61, v61, v63
    v_sub_f32 v31, v80, v34
    v_sub_f32 v63, v81, v66
    v_add_f32 v80, v80, v34
    v_add_f32 v81, v81, v66
    v_sub_f32 v34, v67, v65
    v_sub_f32 v66, v33, v35
    v_add_f32 v33, v33, v35
    v_add_f32 v65, v65, v67
    v_sub_f32 v35, v30, v36
    v_sub_f32 v67, v62, v68
    v_add_f32 v30, v30, v36
    v_add_f32 v62, v62, v68
    v_sub_f32 v36, v71, v69
    v_sub_f32 v68, v37, v39
    v_add_f32 v37, v37, v39
    v_add_f32 v69, v69, v71
    v_sub_f32 v39, v28, v42
    v_sub_f32 v71, v60, v74
    v_add_f32 v28, v28, v42
    v_add_f32 v60, v60, v74
    v_sub_f32 v42, v75, v73
    v_sub_f32 v74, v41, v43
    v_add_f32 v41, v41, v43
    v_add_f32 v73, v73, v75
    v_sub_f32 v43, v38, v32
    v_sub_f32 v75, v70, v64
    v_add_f32 v38, v38, v32
    v_add_f32 v70, v70, v64
    v_sub_f32 v32, v79, v77
    v_sub_f32 v64, v45, v47
    v_add_f32 v45, v45, v47
    v_add_f32 v77, v77, v79
    v_sub_f32 v47, v16, v17
    v_sub_f32 v79, v48, v49
    v_add_f32 v16, v16, v17
    v_add_f32 v48, v48, v49
    v_sub_f32 v17, v46, v18
    v_sub_f32 v49, v78, v50
    v_add_f32 v46, v46, v18
    v_add_f32 v78, v78, v50
    v_sub_f32 v18, v44, v21
    v_sub_f32 v50, v76, v53
    v_add_f32 v44, v44, v21
    v_add_f32 v76, v76, v53
    v_sub_f32 v21, v19, v20
    v_sub_f32 v53, v51, v52
    v_add_f32 v19, v19, v20
    v_add_f32 v51, v51, v52
    v_sub_f32 v20, v40, v25
    v_sub_f32 v52, v72, v57
    v_add_f32 v40, v40, v25
    v_add_f32 v72, v72, v57
    v_sub_f32 v25, v23, v26
    v_sub_f32 v57, v55, v58
    v_add_f32 v23, v23, v26
    v_add_f32 v55, v55, v58
    v_sub_f32 v26, v22, v29
    v_sub_f32 v58, v54, v61
    v_add_f32 v22, v22, v29
    v_add_f32 v54, v54, v61
    v_sub_f32 v29, v27, v24
    v_sub_f32 v61, v59, v56
    v_add_f32 v27, v27, v24
    v_add_f32 v59, v59, v56
    v_sub_f32 v24, v80, v33
    v_sub_f32 v56, v81, v65
    v_add_f32 v80, v80, v33
    v_add_f32 v81, v81, v65
    v_sub_f32 v33, v31, v34
    v_sub_f32 v65, v63, v66
    v_add_f32 v31, v31, v34
    v_add_f32 v63, v63, v66
    v_sub_f32 v34, v30, v37
    v_sub_f32 v66, v62, v69
    v_add_f32 v30, v30, v37
    v_add_f32 v62, v62, v69
    v_sub_f32 v37, v35, v36
    v_sub_f32 v69, v67, v68
    v_add_f32 v35, v35, v36
    v_add_f32 v67, v67, v68
    v_sub_f32 v36, v28, v41
    v_sub_f32 v68, v60, v73
    v_add_f32 v28, v28, v41
    v_add_f32 v60, v60, v73
    v_sub_f32 v41, v39, v42
    v_sub_f32 v73, v71, v74
    v_add_f32 v39, v39, v42
    v_add_f32 v71, v71, v74
    v_sub_f32 v42, v38, v45
    v_sub_f32 v74, v70, v77
    v_add_f32 v38, v38, v45
    v_add_f32 v70, v70, v77
    v_sub_f32 v45, v43, v32
    v_sub_f32 v77, v75, v64
    v_add_f32 v43, v43, v32
    v_add_f32 v75, v75, v64
    v_mul_f32 v32, 0x3a800000, v3
    v_cos_f32 v64, v32
    v_sin_f32 v82, v32
    s_nop 0
    v_mul_f32 v83, v80, v64
    v_fma_f32 v83, -v81, v82, v83
    v_mul_f32 v81, v81, v64
    v_fmac_f32 v81, v80, v82
    v_mul_f32 v32, 0x3b000000, v3
    v_cos_f32 v64, v32
    v_sin_f32 v82, v32
    s_nop 0
    v_mul_f32 v80, v40, v64
    v_fma_f32 v80, -v72, v82, v80
    v_mul_f32 v72, v72, v64
    v_fmac_f32 v72, v40, v82
    v_mul_f32 v32, 0x3b400000, v3
    v_cos_f32 v64, v32
    v_sin_f32 v82, v32
    s_nop 0
    v_mul_f32 v40, v28, v64
    v_fma_f32 v40, -v60, v82, v40
    v_mul_f32 v60, v60, v64
    v_fmac_f32 v60, v28, v82
    v_mul_f32 v32, 0x3b800000, v3
    v_cos_f32 v64, v32
    v_sin_f32 v82, v32
    s_nop 0
    v_mul_f32 v28, v44, v64
    v_fma_f32 v28, -v76, v82, v28
    v_mul_f32 v76, v76, v64
    v_fmac_f32 v76, v44, v82
    v_mul_f32 v32, 0x3ba00000, v3
    v_cos_f32 v64, v32
    v_sin_f32 v82, v32
    s_nop 0
    v_mul_f32 v44, v30, v64
    v_fma_f32 v44, -v62, v82, v44
    v_mul_f32 v62, v62, v64
    v_fmac_f32 v62, v30, v82
    v_mul_f32 v32, 0x3bc00000, v3
    v_cos_f32 v64, v32
    v_sin_f32 v82, v32
    s_nop 0
    v_mul_f32 v30, v22, v64
    v_fma_f32 v30, -v54, v82, v30
    v_mul_f32 v54, v54, v64
    v_fmac_f32 v54, v22, v82
    v_mul_f32 v32, 0x3be00000, v3
    v_cos_f32 v64, v32
    v_sin_f32 v82, v32
    s_nop 0
    v_mul_f32 v22, v38, v64
    v_fma_f32 v22, -v70, v82, v22
    v_mul_f32 v70, v70, v64
    v_fmac_f32 v70, v38, v82
    v_mul_f32 v32, 0x3c000000, v3
    v_cos_f32 v64, v32
    v_sin_f32 v82, v32
    s_nop 0
    v_mul_f32 v38, v46, v64
    v_fma_f32 v38, -v78, v82, v38
    v_mul_f32 v78, v78, v64
    v_fmac_f32 v78, v46, v82
    v_mul_f32 v32, 0x3c100000, v3
    v_cos_f32 v64, v32
    v_sin_f32 v82, v32
    s_nop 0
    v_mul_f32 v46, v31, v64
    v_fma_f32 v46, -v63, v82, v46
    v_mul_f32 v63, v63, v64
    v_fmac_f32 v63, v31, v82
    v_mul_f32 v32, 0x3c200000, v3
    v_cos_f32 v64, v32
    v_sin_f32 v82, v32
    s_nop 0
    v_mul_f32 v31, v23, v64
    v_fma_f32 v31, -v55, v82, v31
    v_mul_f32 v55, v55, v64
    v_fmac_f32 v55, v23, v82
    v_mul_f32 v32, 0x3c300000, v3
    v_cos_f32 v64, v32
    v_sin_f32 v82, v32
    s_nop 0
    v_mul_f32 v23, v39, v64
    v_fma_f32 v23, -v71, v82, v23
    v_mul_f32 v71, v71, v64
    v_fmac_f32 v71, v39, v82
    v_mul_f32 v32, 0x3c400000, v3
    v_cos_f32 v64, v32
    v_sin_f32 v82, v32
    s_nop 0
    v_mul_f32 v39, v19, v64
    v_fma_f32 v39, -v51, v82, v39
    v_mul_f32 v51, v51, v64
    v_fmac_f32 v51, v19, v82
    v_mul_f32 v32, 0x3c500000, v3
    v_cos_f32 v64, v32
    v_sin_f32 v82, v32
    s_nop 0
    v_mul_f32 v19, v35, v64
    v_fma_f32 v19, -v67, v82, v19
    v_mul_f32 v67, v67, v64
    v_fmac_f32 v67, v35, v82
    v_mul_f32 v32, 0x3c600000, v3
    v_cos_f32 v64, v32
    v_sin_f32 v82, v32
    s_nop 0
    v_mul_f32 v35, v27, v64
    v_fma_f32 v35, -v59, v82, v35
    v_mul_f32 v59, v59, v64
    v_fmac_f32 v59, v27, v82
    v_mul_f32 v32, 0x3c700000, v3
    v_cos_f32 v64, v32
    v_sin_f32 v82, v32
    s_nop 0
    v_mul_f32 v27, v43, v64
    v_fma_f32 v27, -v75, v82, v27
    v_mul_f32 v75, v75, v64
    v_fmac_f32 v75, v43, v82
    v_mul_f32 v32, 0x3c800000, v3
    v_cos_f32 v64, v32
    v_sin_f32 v82, v32
    s_nop 0
    v_mul_f32 v43, v47, v64
    v_fma_f32 v43, -v79, v82, v43
    v_mul_f32 v79, v79, v64
    v_fmac_f32 v79, v47, v82
    v_mul_f32 v32, 0x3c880000, v3
    v_cos_f32 v64, v32
    v_sin_f32 v82, v32
    s_nop 0
    v_mul_f32 v47, v24, v64
    v_fma_f32 v47, -v56, v82, v47
    v_mul_f32 v56, v56, v64
    v_fmac_f32 v56, v24, v82
    v_mul_f32 v32, 0x3c900000, v3
    v_cos_f32 v64, v32
    v_sin_f32 v82, v32
    s_nop 0
    v_mul_f32 v24, v20, v64
    v_fma_f32 v24, -v52, v82, v24
    v_mul_f32 v52, v52, v64
    v_fmac_f32 v52, v20, v82
    v_mul_f32 v32, 0x3c980000, v3
    v_cos_f32 v64, v32
    v_sin_f32 v82, v32
    s_nop 0
    v_mul_f32 v20, v36, v64
    v_fma_f32 v20, -v68, v82, v20
    v_mul_f32 v68, v68, v64
    v_fmac_f32 v68, v36, v82
    v_mul_f32 v32, 0x3ca00000, v3
    v_cos_f32 v64, v32
    v_sin_f32 v82, v32
    s_nop 0
    v_mul_f32 v36, v18, v64
    v_fma_f32 v36, -v50, v82, v36
    v_mul_f32 v50, v50, v64
    v_fmac_f32 v50, v18, v82
    v_mul_f32 v32, 0x3ca80000, v3
    v_cos_f32 v64, v32
    v_sin_f32 v82, v32
    s_nop 0
    v_mul_f32 v18, v34, v64
    v_fma_f32 v18, -v66, v82, v18
    v_mul_f32 v66, v66, v64
    v_fmac_f32 v66, v34, v82
    v_mul_f32 v32, 0x3cb00000, v3
    v_cos_f32 v64, v32
    v_sin_f32 v82, v32
    s_nop 0
    v_mul_f32 v34, v26, v64
    v_fma_f32 v34, -v58, v82, v34
    v_mul_f32 v58, v58, v64
    v_fmac_f32 v58, v26, v82
    v_mul_f32 v32, 0x3cb80000, v3
    v_cos_f32 v64, v32
    v_sin_f32 v82, v32
    s_nop 0
    v_mul_f32 v26, v42, v64
    v_fma_f32 v26, -v74, v82, v26
    v_mul_f32 v74, v74, v64
    v_fmac_f32 v74, v42, v82
    v_mul_f32 v32, 0x3cc00000, v3
    v_cos_f32 v64, v32
    v_sin_f32 v82, v32
    s_nop 0
    v_mul_f32 v42, v17, v64
    v_fma_f32 v42, -v49, v82, v42
    v_mul_f32 v49, v49, v64
    v_fmac_f32 v49, v17, v82
    v_mul_f32 v32, 0x3cc80000, v3
    v_cos_f32 v64, v32
    v_sin_f32 v82, v32
    s_nop 0
    v_mul_f32 v17, v33, v64
    v_fma_f32 v17, -v65, v82, v17
    v_mul_f32 v65, v65, v64
    v_fmac_f32 v65, v33, v82
    v_mul_f32 v32, 0x3cd00000, v3
    v_cos_f32 v64, v32
    v_sin_f32 v82, v32
    s_nop 0
    v_mul_f32 v33, v25, v64
    v_fma_f32 v33, -v57, v82, v33
    v_mul_f32 v57, v57, v64
    v_fmac_f32 v57, v25, v82
    v_mul_f32 v32, 0x3cd80000, v3
    v_cos_f32 v64, v32
    v_sin_f32 v82, v32
    s_nop 0
    v_mul_f32 v25, v41, v64
    v_fma_f32 v25, -v73, v82, v25
    v_mul_f32 v73, v73, v64
    v_fmac_f32 v73, v41, v82
    v_mul_f32 v32, 0x3ce00000, v3
    v_cos_f32 v64, v32
    v_sin_f32 v82, v32
    s_nop 0
    v_mul_f32 v41, v21, v64
    v_fma_f32 v41, -v53, v82, v41
    v_mul_f32 v53, v53, v64
    v_fmac_f32 v53, v21, v82
    v_mul_f32 v32, 0x3ce80000, v3
    v_cos_f32 v64, v32
    v_sin_f32 v82, v32
    s_nop 0
    v_mul_f32 v21, v37, v64
    v_fma_f32 v21, -v69, v82, v21
    v_mul_f32 v69, v69, v64
    v_fmac_f32 v69, v37, v82
    v_mul_f32 v32, 0x3cf00000, v3
    v_cos_f32 v64, v32
    v_sin_f32 v82, v32
    s_nop 0
    v_mul_f32 v37, v29, v64
    v_fma_f32 v37, -v61, v82, v37
    v_mul_f32 v61, v61, v64
    v_fmac_f32 v61, v29, v82
    v_mul_f32 v32, 0x3cf80000, v3
    v_cos_f32 v64, v32
    v_sin_f32 v82, v32
    s_nop 0
    v_mul_f32 v29, v45, v64
    v_fma_f32 v29, -v77, v82, v29
    v_mul_f32 v77, v77, v64
    v_fmac_f32 v77, v45, v82
    ds_write_b32 v4, v16 offset:0
    ds_write_b32 v4, v48 offset:4
    ds_write_b32 v4, v83 offset:264
    ds_write_b32 v4, v81 offset:268
    ds_write_b32 v4, v80 offset:528
    ds_write_b32 v4, v72 offset:532
    ds_write_b32 v4, v40 offset:792
    ds_write_b32 v4, v60 offset:796
    ds_write_b32 v4, v28 offset:1056
    ds_write_b32 v4, v76 offset:1060
    ds_write_b32 v4, v44 offset:1320
    ds_write_b32 v4, v62 offset:1324
    ds_write_b32 v4, v30 offset:1584
    ds_write_b32 v4, v54 offset:1588
    ds_write_b32 v4, v22 offset:1848
    ds_write_b32 v4, v70 offset:1852
    ds_write_b32 v4, v38 offset:2112
    ds_write_b32 v4, v78 offset:2116
    ds_write_b32 v4, v46 offset:2376
    ds_write_b32 v4, v63 offset:2380
    ds_write_b32 v4, v31 offset:2640
    ds_write_b32 v4, v55 offset:2644
    ds_write_b32 v4, v23 offset:2904
    ds_write_b32 v4, v71 offset:2908
    ds_write_b32 v4, v39 offset:3168
    ds_write_b32 v4, v51 offset:3172
    ds_write_b32 v4, v19 offset:3432
    ds_write_b32 v4, v67 offset:3436
    ds_write_b32 v4, v35 offset:3696
    ds_write_b32 v4, v59 offset:3700
    ds_write_b32 v4, v27 offset:3960
    ds_write_b32 v4, v75 offset:3964
    ds_write_b32 v4, v43 offset:4224
    ds_write_b32 v4, v79 offset:4228
    ds_write_b32 v4, v47 offset:4488
    ds_write_b32 v4, v56 offset:4492
    ds_write_b32 v4, v24 offset:4752
    ds_write_b32 v4, v52 offset:4756
    ds_write_b32 v4, v20 offset:5016
    ds_write_b32 v4, v68 offset:5020
    ds_write_b32 v4, v36 offset:5280
    ds_write_b32 v4, v50 offset:5284
    ds_write_b32 v4, v18 offset:5544
    ds_write_b32 v4, v66 offset:5548
    ds_write_b32 v4, v34 offset:5808
    ds_write_b32 v4, v58 offset:5812
    ds_write_b32 v4, v26 offset:6072
    ds_write_b32 v4, v74 offset:6076
    ds_write_b32 v4, v42 offset:6336
    ds_write_b32 v4, v49 offset:6340
    ds_write_b32 v4, v17 offset:6600
    ds_write_b32 v4, v65 offset:6604
    ds_write_b32 v4, v33 offset:6864
    ds_write_b32 v4, v57 offset:6868
    ds_write_b32 v4, v25 offset:7128
    ds_write_b32 v4, v73 offset:7132
    ds_write_b32 v4, v41 offset:7392
    ds_write_b32 v4, v53 offset:7396
    ds_write_b32 v4, v21 offset:7656
    ds_write_b32 v4, v69 offset:7660
    ds_write_b32 v4, v37 offset:7920
    ds_write_b32 v4, v61 offset:7924
    ds_write_b32 v4, v29 offset:8184
    ds_write_b32 v4, v77 offset:8188
    s_waitcnt lgkmcnt(0)
    ds_read_b32 v16, v5 offset:0
    ds_read_b32 v48, v5 offset:4
    ds_read_b32 v83, v5 offset:8
    ds_read_b32 v81, v5 offset:12
    ds_read_b32 v80, v5 offset:16
    ds_read_b32 v72, v5 offset:20
    ds_read_b32 v40, v5 offset:24
    ds_read_b32 v60, v5 offset:28
    ds_read_b32 v28, v5 offset:32
    ds_read_b32 v76, v5 offset:36
    ds_read_b32 v44, v5 offset:40
    ds_read_b32 v62, v5 offset:44
    ds_read_b32 v30, v5 offset:48
    ds_read_b32 v54, v5 offset:52
    s_waitcnt lgkmcnt(0)
    ds_read_b32 v22, v5 offset:56
    ds_read_b32 v70, v5 offset:60
    ds_read_b32 v38, v5 offset:64
    ds_read_b32 v78, v5 offset:68
    ds_read_b32 v46, v5 offset:72
    ds_read_b32 v63, v5 offset:76
    ds_read_b32 v31, v5 offset:80
    ds_read_b32 v55, v5 offset:84
    ds_read_b32 v23, v5 offset:88
    ds_read_b32 v71, v5 offset:92
    ds_read_b32 v39, v5 offset:96
    ds_read_b32 v51, v5 offset:100
    ds_read_b32 v19, v5 offset:104
    ds_read_b32 v67, v5 offset:108
    s_waitcnt lgkmcnt(0)
    ds_read_b32 v35, v5 offset:112
    ds_read_b32 v59, v5 offset:116
    ds_read_b32 v27, v5 offset:120
    ds_read_b32 v75, v5 offset:124
    ds_read_b32 v43, v5 offset:128
    ds_read_b32 v79, v5 offset:132
    ds_read_b32 v47, v5 offset:136
    ds_read_b32 v56, v5 offset:140
    ds_read_b32 v24, v5 offset:144
    ds_read_b32 v52, v5 offset:148
    ds_read_b32 v20, v5 offset:152
    ds_read_b32 v68, v5 offset:156
    ds_read_b32 v36, v5 offset:160
    ds_read_b32 v50, v5 offset:164
    s_waitcnt lgkmcnt(0)
    ds_read_b32 v18, v5 offset:168
    ds_read_b32 v66, v5 offset:172
    ds_read_b32 v34, v5 offset:176
    ds_read_b32 v58, v5 offset:180
    ds_read_b32 v26, v5 offset:184
    ds_read_b32 v74, v5 offset:188
    ds_read_b32 v42, v5 offset:192
    ds_read_b32 v49, v5 offset:196
    ds_read_b32 v17, v5 offset:200
    ds_read_b32 v65, v5 offset:204
    ds_read_b32 v33, v5 offset:208
    ds_read_b32 v57, v5 offset:212
    ds_read_b32 v25, v5 offset:216
    ds_read_b32 v73, v5 offset:220
    s_waitcnt lgkmcnt(0)
    ds_read_b32 v41, v5 offset:224
    ds_read_b32 v53, v5 offset:228
    ds_read_b32 v21, v5 offset:232
    ds_read_b32 v69, v5 offset:236
    ds_read_b32 v37, v5 offset:240
    ds_read_b32 v61, v5 offset:244
    ds_read_b32 v29, v5 offset:248
    ds_read_b32 v77, v5 offset:252
    s_waitcnt lgkmcnt(0)
    v_sub_f32 v32, v16, v43
    v_sub_f32 v64, v48, v79
    v_add_f32 v16, v16, v43
    v_add_f32 v48, v48, v79
    v_sub_f32 v43, v83, v47
    v_sub_f32 v79, v81, v56
    v_add_f32 v83, v83, v47
    v_add_f32 v81, v81, v56
    v_mul_f32 v47, 0x3f7b14be, v43
    v_mul_f32 v56, 0x3e47c5c2, v43
    v_fmac_f32 v47, 0xbe47c5c2, v79
    v_fmac_f32 v56, 0x3f7b14be, v79
    v_sub_f32 v43, v80, v24
    v_sub_f32 v79, v72, v52
    v_add_f32 v80, v80, v24
    v_add_f32 v72, v72, v52
    v_mul_f32 v24, 0x3f6c835e, v43
    v_mul_f32 v52, 0x3ec3ef15, v43
    v_fmac_f32 v24, 0xbec3ef15, v79
    v_fmac_f32 v52, 0x3f6c835e, v79
    v_sub_f32 v43, v40, v20
    v_sub_f32 v79, v60, v68
    v_add_f32 v40, v40, v20
    v_add_f32 v60, v60, v68
    v_mul_f32 v20, 0x3f54db31, v43
    v_mul_f32 v68, 0x3f0e39da, v43
    v_fmac_f32 v20, 0xbf0e39da, v79
    v_fmac_f32 v68, 0x3f54db31, v79
    v_sub_f32 v43, v28, v36
    v_sub_f32 v79, v76, v50
    v_add_f32 v28, v28, v36
    v_add_f32 v76, v76, v50
    v_mul_f32 v36, 0x3f3504f3, v43
    v_mul_f32 v50, 0x3f3504f3, v43
    v_fmac_f32 v36, 0xbf3504f3, v79
    v_fmac_f32 v50, 0x3f3504f3, v79
    v_sub_f32 v43, v44, v18
    v_sub_f32 v79, v62, v66
    v_add_f32 v44, v44, v18
    v_add_f32 v62, v62, v66
    v_mul_f32 v18, 0x3f0e39da, v43
    v_mul_f32 v66, 0x3f54db31, v43
    v_fmac_f32 v18, 0xbf54db31, v79
    v_fmac_f32 v66, 0x3f0e39da, v79
    v_sub_f32 v43, v30, v34
    v_sub_f32 v79, v54, v58
    v_add_f32 v30, v30, v34
    v_add_f32 v54, v54, v58
    v_mul_f32 v34, 0x3ec3ef15, v43
    v_mul_f32 v58, 0x3f6c835e, v43
    v_fmac_f32 v34, 0xbf6c835e, v79
    v_fmac_f32 v58, 0x3ec3ef15, v79
    v_sub_f32 v43, v22, v26
    v_sub_f32 v79, v70, v74
    v_add_f32 v22, v22, v26
    v_add_f32 v70, v70, v74
    v_mul_f32 v26, 0x3e47c5c2, v43
    v_mul_f32 v74, 0x3f7b14be, v43
    v_fmac_f32 v26, 0xbf7b14be, v79
    v_fmac_f32 v74, 0x3e47c5c2, v79
    v_sub_f32 v43, v49, v78
    v_sub_f32 v79, v38, v42
    v_add_f32 v38, v38, v42
    v_add_f32 v78, v78, v49
    v_sub_f32 v42, v46, v17
    v_sub_f32 v49, v63, v65
    v_add_f32 v46, v46, v17
    v_add_f32 v63, v63, v65
    v_mul_f32 v17, 0xbe47c5c2, v42
    v_mul_f32 v65, 0x3f7b14be, v42
    v_fmac_f32 v17, 0xbf7b14be, v49
    v_fmac_f32 v65, 0xbe47c5c2, v49
    v_sub_f32 v42, v31, v33
    v_sub_f32 v49, v55, v57
    v_add_f32 v31, v31, v33
    v_add_f32 v55, v55, v57
    v_mul_f32 v33, 0xbec3ef15, v42
    v_mul_f32 v57, 0x3f6c835e, v42
    v_fmac_f32 v33, 0xbf6c835e, v49
    v_fmac_f32 v57, 0xbec3ef15, v49
    v_sub_f32 v42, v23, v25
    v_sub_f32 v49, v71, v73
    v_add_f32 v23, v23, v25
    v_add_f32 v71, v71, v73
    v_mul_f32 v25, 0xbf0e39da, v42
    v_mul_f32 v73, 0x3f54db31, v42
    v_fmac_f32 v25, 0xbf54db31, v49
    v_fmac_f32 v73, 0xbf0e39da, v49
    v_sub_f32 v42, v39, v41
    v_sub_f32 v49, v51, v53
    v_add_f32 v39, v39, v41
    v_add_f32 v51, v51, v53
    v_mul_f32 v41, 0xbf3504f3, v42
    v_mul_f32 v53, 0x3f3504f3, v42
    v_fmac_f32 v41, 0xbf3504f3, v49
    v_fmac_f32 v53, 0xbf3504f3, v49
    v_sub_f32 v42, v19, v21
    v_sub_f32 v49, v67, v69
    v_add_f32 v19, v19, v21
    v_add_f32 v67, v67, v69
    v_mul_f32 v21, 0xbf54db31, v42
    v_mul_f32 v69, 0x3f0e39da, v42
    v_fmac_f32 v21, 0xbf0e39da, v49
    v_fmac_f32 v69, 0xbf54db31, v49
    v_sub_f32 v42, v35, v37
    v_sub_f32 v49, v59, v61
    v_add_f32 v35, v35, v37
    v_add_f32 v59, v59, v61
    v_mul_f32 v37, 0xbf6c835e, v42
    v_mul_f32 v61, 0x3ec3ef15, v42
    v_fmac_f32 v37, 0xbec3ef15, v49
    v_fmac_f32 v61, 0xbf6c835e, v49
    v_sub_f32 v42, v27, v29
    v_sub_f32 v49, v75, v77
    v_add_f32 v27, v27, v29
    v_add_f32 v75, v75, v77
    v_mul_f32 v29, 0xbf7b14be, v42
    v_mul_f32 v77, 0x3e47c5c2, v42
    v_fmac_f32 v29, 0xbe47c5c2, v49
    v_fmac_f32 v77, 0xbf7b14be, v49
    v_sub_f32 v42, v16, v38
    v_sub_f32 v49, v48, v78
    v_add_f32 v16, v16, v38
    v_add_f32 v48, v48, v78
    v_sub_f32 v38, v83, v46
    v_sub_f32 v78, v81, v63
    v_add_f32 v83, v83, v46
    v_add_f32 v81, v81, v63
    v_mul_f32 v46, 0x3f6c835e, v38
    v_mul_f32 v63, 0x3ec3ef15, v38
    v_fmac_f32 v46, 0xbec3ef15, v78
    v_fmac_f32 v63, 0x3f6c835e, v78
    v_sub_f32 v38, v80, v31
    v_sub_f32 v78, v72, v55
    v_add_f32 v80, v80, v31
    v_add_f32 v72, v72, v55
    v_mul_f32 v31, 0x3f3504f3, v38
    v_mul_f32 v55, 0x3f3504f3, v38
    v_fmac_f32 v31, 0xbf3504f3, v78
    v_fmac_f32 v55, 0x3f3504f3, v78
    v_sub_f32 v38, v40, v23
    v_sub_f32 v78, v60, v71
    v_add_f32 v40, v40, v23
    v_add_f32 v60, v60, v71
    v_mul_f32 v23, 0x3ec3ef15, v38
    v_mul_f32 v71, 0x3f6c835e, v38
    v_fmac_f32 v23, 0xbf6c835e, v78
    v_fmac_f32 v71, 0x3ec3ef15, v78
    v_sub_f32 v38, v51, v76
    v_sub_f32 v78, v28, v39
    v_add_f32 v28, v28, v39
    v_add_f32 v76, v76, v51
    v_sub_f32 v39, v44, v19
    v_sub_f32 v51, v62, v67
    v_add_f32 v44, v44, v19
    v_add_f32 v62, v62, v67
    v_mul_f32 v19, 0xbec3ef15, v39
    v_mul_f32 v67, 0x3f6c835e, v39
    v_fmac_f32 v19, 0xbf6c835e, v51
    v_fmac_f32 v67, 0xbec3ef15, v51
    v_sub_f32 v39, v30, v35
    v_sub_f32 v51, v54, v59
    v_add_f32 v30, v30, v35
    v_add_f32 v54, v54, v59
    v_mul_f32 v35, 0xbf3504f3, v39
    v_mul_f32 v59, 0x3f3504f3, v39
    v_fmac_f32 v35, 0xbf3504f3, v51
    v_fmac_f32 v59, 0xbf3504f3, v51
    v_sub_f32 v39, v22, v27
    v_sub_f32 v51, v70, v75
    v_add_f32 v22, v22, v27
    v_add_f32 v70, v70, v75
    v_mul_f32 v27, 0xbf6c835e, v39
    v_mul_f32 v75, 0x3ec3ef15, v39
    v_fmac_f32 v27, 0xbec3ef15, v51
    v_fmac_f32 v75, 0xbf6c835e, v51
    v_sub_f32 v39, v32, v43
    v_sub_f32 v51, v64, v79
    v_add_f32 v32, v32, v43
    v_add_f32 v64, v64, v79
    v_sub_f32 v43, v47, v17
    v_sub_f32 v79, v56, v65
    v_add_f32 v47, v47, v17
    v_add_f32 v56, v56, v65
    v_mul_f32 v17, 0x3f6c835e, v43
    v_mul_f32 v65, 0x3ec3ef15, v43
    v_fmac_f32 v17, 0xbec3ef15, v79
    v_fmac_f32 v65, 0x3f6c835e, v79
    v_sub_f32 v43, v24, v33
    v_sub_f32 v79, v52, v57
    v_add_f32 v24, v24, v33
    v_add_f32 v52, v52, v57
    v_mul_f32 v33, 0x3f3504f3, v43
    v_mul_f32 v57, 0x3f3504f3, v43
    v_fmac_f32 v33, 0xbf3504f3, v79
    v_fmac_f32 v57, 0x3f3504f3, v79
    v_sub_f32 v43, v20, v25
    v_sub_f32 v79, v68, v73
    v_add_f32 v20, v20, v25
    v_add_f32 v68, v68, v73
    v_mul_f32 v25, 0x3ec3ef15, v43
    v_mul_f32 v73, 0x3f6c835e, v43
    v_fmac_f32 v25, 0xbf6c835e, v79
    v_fmac_f32 v73, 0x3ec3ef15, v79
    v_sub_f32 v43, v53, v50
    v_sub_f32 v79, v36, v41
    v_add_f32 v36, v36, v41
    v_add_f32 v50, v50, v53
    v_sub_f32 v41, v18, v21
    v_sub_f32 v53, v66, v69
    v_add_f32 v18, v18, v21
    v_add_f32 v66, v66, v69
    v_mul_f32 v21, 0xbec3ef15, v41
    v_mul_f32 v69, 0x3f6c835e, v41
    v_fmac_f32 v21, 0xbf6c835e, v53
    v_fmac_f32 v69, 0xbec3ef15, v53
    v_sub_f32 v41, v34, v37
    v_sub_f32 v53, v58, v61
    v_add_f32 v34, v34, v37
    v_add_f32 v58, v58, v61
    v_mul_f32 v37, 0xbf3504f3, v41
    v_mul_f32 v61, 0x3f3504f3, v41
    v_fmac_f32 v37, 0xbf3504f3, v53
    v_fmac_f32 v61, 0xbf3504f3, v53
    v_sub_f32 v41, v26, v29
    v_sub_f32 v53, v74, v77
    v_add_f32 v26, v26, v29
    v_add_f32 v74, v74, v77
    v_mul_f32 v29, 0xbf6c835e, v41
    v_mul_f32 v77, 0x3ec3ef15, v41
    v_fmac_f32 v29, 0xbec3ef15, v53
    v_fmac_f32 v77, 0xbf6c835e, v53
    v_sub_f32 v41, v16, v28
    v_sub_f32 v53, v48, v76
    v_add_f32 v16, v16, v28
    v_add_f32 v48, v48, v76
    v_sub_f32 v28, v83, v44
    v_sub_f32 v76, v81, v62
    v_add_f32 v83, v83, v44
    v_add_f32 v81, v81, v62
    v_mul_f32 v44, 0x3f3504f3, v28
    v_mul_f32 v62, 0x3f3504f3, v28
    v_fmac_f32 v44, 0xbf3504f3, v76
    v_fmac_f32 v62, 0x3f3504f3, v76
    v_sub_f32 v28, v54, v72
    v_sub_f32 v76, v80, v30
    v_add_f32 v80, v80, v30
    v_add_f32 v72, v72, v54
    v_sub_f32 v30, v40, v22
    v_sub_f32 v54, v60, v70
    v_add_f32 v40, v40, v22
    v_add_f32 v60, v60, v70
    v_mul_f32 v22, 0xbf3504f3, v30
    v_mul_f32 v70, 0x3f3504f3, v30
    v_fmac_f32 v22, 0xbf3504f3, v54
    v_fmac_f32 v70, 0xbf3504f3, v54
    v_sub_f32 v30, v42, v38
    v_sub_f32 v54, v49, v78
    v_add_f32 v42, v42, v38
    v_add_f32 v49, v49, v78
    v_sub_f32 v38, v46, v19
    v_sub_f32 v78, v63, v67
    v_add_f32 v46, v46, v19
    v_add_f32 v63, v63, v67
    v_mul_f32 v19, 0x3f3504f3, v38
    v_mul_f32 v67, 0x3f3504f3, v38
    v_fmac_f32 v19, 0xbf3504f3, v78
    v_fmac_f32 v67, 0x3f3504f3, v78
    v_sub_f32 v38, v59, v55
    v_sub_f32 v78, v31, v35
    v_add_f32 v31, v31, v35
    v_add_f32 v55, v55, v59
    v_sub_f32 v35, v23, v27
    v_sub_f32 v59, v71, v75
    v_add_f32 v23, v23, v27
    v_add_f32 v71, v71, v75
    v_mul_f32 v27, 0xbf3504f3, v35
    v_mul_f32 v75, 0x3f3504f3, v35
    v_fmac_f32 v27, 0xbf3504f3, v59
    v_fmac_f32 v75, 0xbf3504f3, v59
    v_sub_f32 v35, v32, v36
    v_sub_f32 v59, v64, v50
    v_add_f32 v32, v32, v36
    v_add_f32 v64, v64, v50
    v_sub_f32 v36, v47, v18
    v_sub_f32 v50, v56, v66
    v_add_f32 v47, v47, v18
    v_add_f32 v56, v56, v66
    v_mul_f32 v18, 0x3f3504f3, v36
    v_mul_f32 v66, 0x3f3504f3, v36
    v_fmac_f32 v18, 0xbf3504f3, v50
    v_fmac_f32 v66, 0x3f3504f3, v50
    v_sub_f32 v36, v58, v52
    v_sub_f32 v50, v24, v34
    v_add_f32 v24, v24, v34
    v_add_f32 v52, v52, v58
    v_sub_f32 v34, v20, v26
    v_sub_f32 v58, v68, v74
    v_add_f32 v20, v20, v26
    v_add_f32 v68, v68, v74
    v_mul_f32 v26, 0xbf3504f3, v34
    v_mul_f32 v74, 0x3f3504f3, v34
    v_fmac_f32 v26, 0xbf3504f3, v58
    v_fmac_f32 v74, 0xbf3504f3, v58
    v_sub_f32 v34, v39, v43
    v_sub_f32 v58, v51, v79
    v_add_f32 v39, v39, v43
    v_add_f32 v51, v51, v79
    v_sub_f32 v43, v17, v21
    v_sub_f32 v79, v65, v69
    v_add_f32 v17, v17, v21
    v_add_f32 v65, v65, v69
    v_mul_f32 v21, 0x3f3504f3, v43
    v_mul_f32 v69, 0x3f3504f3, v43
    v_fmac_f32 v21, 0xbf3504f3, v79
    v_fmac_f32 v69, 0x3f3504f3, v79
    v_sub_f32 v43, v61, v57
    v_sub_f32 v79, v33, v37
    v_add_f32 v33, v33, v37
    v_add_f32 v57, v57, v61
    v_sub_f32 v37, v25, v29
    v_sub_f32 v61, v73, v77
    v_add_f32 v25, v25, v29
    v_add_f32 v73, v73, v77
    v_mul_f32 v29, 0xbf3504f3, v37
    v_mul_f32 v77, 0x3f3504f3, v37
    v_fmac_f32 v29, 0xbf3504f3, v61
    v_fmac_f32 v77, 0xbf3504f3, v61
    v_sub_f32 v37, v16, v80
    v_sub_f32 v61, v48, v72
    v_add_f32 v16, v16, v80
    v_add_f32 v48, v48, v72
    v_sub_f32 v80, v60, v81
    v_sub_f32 v72, v83, v40
    v_add_f32 v83, v83, v40
    v_add_f32 v81, v81, v60
    v_sub_f32 v40, v41, v28
    v_sub_f32 v60, v53, v76
    v_add_f32 v41, v41, v28
    v_add_f32 v53, v53, v76
    v_sub_f32 v28, v70, v62
    v_sub_f32 v76, v44, v22
    v_add_f32 v44, v44, v22
    v_add_f32 v62, v62, v70
    v_sub_f32 v22, v42, v31
    v_sub_f32 v70, v49, v55
    v_add_f32 v42, v42, v31
    v_add_f32 v49, v49, v55
    v_sub_f32 v31, v71, v63
    v_sub_f32 v55, v46, v23
    v_add_f32 v46, v46, v23
    v_add_f32 v63, v63, v71
    v_sub_f32 v23, v30, v38
    v_sub_f32 v71, v54, v78
    v_add_f32 v30, v30, v38
    v_add_f32 v54, v54, v78
    v_sub_f32 v38, v75, v67
    v_sub_f32 v78, v19, v27
    v_add_f32 v19, v19, v27
    v_add_f32 v67, v67, v75
    v_sub_f32 v27, v32, v24
    v_sub_f32 v75, v64, v52
    v_add_f32 v32, v32, v24
    v_add_f32 v64, v64, v52
    v_sub_f32 v24, v68, v56
    v_sub_f32 v52, v47, v20
    v_add_f32 v47, v47, v20
    v_add_f32 v56, v56, v68
    v_sub_f32 v20, v35, v36
    v_sub_f32 v68, v59, v50
    v_add_f32 v35, v35, v36
    v_add_f32 v59, v59, v50
    v_sub_f32 v36, v74, v66
    v_sub_f32 v50, v18, v26
    v_add_f32 v18, v18, v26
    v_add_f32 v66, v66, v74
    v_sub_f32 v26, v39, v33
    v_sub_f32 v74, v51, v57
    v_add_f32 v39, v39, v33
    v_add_f32 v51, v51, v57
    v_sub_f32 v33, v73, v65
    v_sub_f32 v57, v17, v25
    v_add_f32 v17, v17, v25
    v_add_f32 v65, v65, v73
    v_sub_f32 v25, v34, v43
    v_sub_f32 v73, v58, v79
    v_add_f32 v34, v34, v43
    v_add_f32 v58, v58, v79
    v_sub_f32 v43, v77, v69
    v_sub_f32 v79, v21, v29
    v_add_f32 v21, v21, v29
    v_add_f32 v69, v69, v77
    v_sub_f32 v29, v16, v83
    v_sub_f32 v77, v48, v81
    v_add_f32 v16, v16, v83
    v_add_f32 v48, v48, v81
    v_sub_f32 v83, v37, v80
    v_sub_f32 v81, v61, v72
    v_add_f32 v37, v37, v80
    v_add_f32 v61, v61, v72
    v_sub_f32 v80, v41, v44
    v_sub_f32 v72, v53, v62
    v_add_f32 v41, v41, v44
    v_add_f32 v53, v53, v62
    v_sub_f32 v44, v40, v28
    v_sub_f32 v62, v60, v76
    v_add_f32 v40, v40, v28
    v_add_f32 v60, v60, v76
    v_sub_f32 v28, v42, v46
    v_sub_f32 v76, v49, v63
    v_add_f32 v42, v42, v46
    v_add_f32 v49, v49, v63
    v_sub_f32 v46, v22, v31
    v_sub_f32 v63, v70, v55
    v_add_f32 v22, v22, v31
    v_add_f32 v70, v70, v55
    v_sub_f32 v31, v30, v19
    v_sub_f32 v55, v54, v67
    v_add_f32 v30, v30, v19
    v_add_f32 v54, v54, v67
    v_sub_f32 v19, v23, v38
    v_sub_f32 v67, v71, v78
    v_add_f32 v23, v23, v38
    v_add_f32 v71, v71, v78
    v_sub_f32 v38, v32, v47
    v_sub_f32 v78, v64, v56
    v_add_f32 v32, v32, v47
    v_add_f32 v64, v64, v56
    v_sub_f32 v47, v27, v24
    v_sub_f32 v56, v75, v52
    v_add_f32 v27, v27, v24
    v_add_f32 v75, v75, v52
    v_sub_f32 v24, v35, v18
    v_sub_f32 v52, v59, v66
    v_add_f32 v35, v35, v18
    v_add_f32 v59, v59, v66
    v_sub_f32 v18, v20, v36
    v_sub_f32 v66, v68, v50
    v_add_f32 v20, v20, v36
    v_add_f32 v68, v68, v50
    v_sub_f32 v36, v39, v17
    v_sub_f32 v50, v51, v65
    v_add_f32 v39, v39, v17
    v_add_f32 v51, v51, v65
    v_sub_f32 v17, v26, v33
    v_sub_f32 v65, v74, v57
    v_add_f32 v26, v26, v33
    v_add_f32 v74, v74, v57
    v_sub_f32 v33, v34, v21
    v_sub_f32 v57, v58, v69
    v_add_f32 v34, v34, v21
    v_add_f32 v58, v58, v69
    v_sub_f32 v21, v25, v43
    v_sub_f32 v69, v73, v79
    v_add_f32 v25, v25, v43
    v_add_f32 v73, v73, v79
    v_lshl_add_u32 v6, v1, 2, v7
    ds_write_b32 v6, v16 offset:0
    ds_write_b32 v6, v48 offset:4096
    ds_write_b32 v6, v32 offset:128
    ds_write_b32 v6, v64 offset:4224
    ds_write_b32 v6, v42 offset:256
    ds_write_b32 v6, v49 offset:4352
    ds_write_b32 v6, v39 offset:384
    ds_write_b32 v6, v51 offset:4480
    ds_write_b32 v6, v41 offset:512
    ds_write_b32 v6, v53 offset:4608
    ds_write_b32 v6, v35 offset:640
    ds_write_b32 v6, v59 offset:4736
    ds_write_b32 v6, v30 offset:768
    ds_write_b32 v6, v54 offset:4864
    ds_write_b32 v6, v34 offset:896
    ds_write_b32 v6, v58 offset:4992
    ds_write_b32 v6, v37 offset:1024
    ds_write_b32 v6, v61 offset:5120
    ds_write_b32 v6, v27 offset:1152
    ds_write_b32 v6, v75 offset:5248
    ds_write_b32 v6, v22 offset:1280
    ds_write_b32 v6, v70 offset:5376
    ds_write_b32 v6, v26 offset:1408
    ds_write_b32 v6, v74 offset:5504
    ds_write_b32 v6, v40 offset:1536
    ds_write_b32 v6, v60 offset:5632
    ds_write_b32 v6, v20 offset:1664
    ds_write_b32 v6, v68 offset:5760
    ds_write_b32 v6, v23 offset:1792
    ds_write_b32 v6, v71 offset:5888
    ds_write_b32 v6, v25 offset:1920
    ds_write_b32 v6, v73 offset:6016
    ds_write_b32 v6, v29 offset:2048
    ds_write_b32 v6, v77 offset:6144
    ds_write_b32 v6, v38 offset:2176
    ds_write_b32 v6, v78 offset:6272
    ds_write_b32 v6, v28 offset:2304
    ds_write_b32 v6, v76 offset:6400
    ds_write_b32 v6, v36 offset:2432
    ds_write_b32 v6, v50 offset:6528
    ds_write_b32 v6, v80 offset:2560
    ds_write_b32 v6, v72 offset:6656
    ds_write_b32 v6, v24 offset:2688
    ds_write_b32 v6, v52 offset:6784
    ds_write_b32 v6, v31 offset:2816
    ds_write_b32 v6, v55 offset:6912
    ds_write_b32 v6, v33 offset:2944
    ds_write_b32 v6, v57 offset:7040
    ds_write_b32 v6, v83 offset:3072
    ds_write_b32 v6, v81 offset:7168
    ds_write_b32 v6, v47 offset:3200
    ds_write_b32 v6, v56 offset:7296
    ds_write_b32 v6, v46 offset:3328
    ds_write_b32 v6, v63 offset:7424
    ds_write_b32 v6, v17 offset:3456
    ds_write_b32 v6, v65 offset:7552
    ds_write_b32 v6, v44 offset:3584
    ds_write_b32 v6, v62 offset:7680
    ds_write_b32 v6, v18 offset:3712
    ds_write_b32 v6, v66 offset:7808
    ds_write_b32 v6, v19 offset:3840
    ds_write_b32 v6, v67 offset:7936
    ds_write_b32 v6, v21 offset:3968
    ds_write_b32 v6, v69 offset:8064
    s_waitcnt lgkmcnt(0)
    s_barrier
    v_and_b32 v6, 127, v0
    v_lshrrev_b32 v7, 7, v0
    v_lshlrev_b32 v8, 5, v6
    v_lshl_add_u32 v8, v7, 12, v8
    v_lshlrev_b32 v5, 4, v6
    v_lshl_add_u32 v5, v7, 12, v5
    v_add_u32 v5, 2048, v5
    s_lshl_b32 s12, s92, 16
    ds_read_b128 v[16:19], v8 offset:0
    ds_read_b128 v[20:23], v8 offset:16
    s_waitcnt lgkmcnt(0)
    v_cvt_pk_bf16_f32 v24, v16, v17
    v_cvt_pk_bf16_f32 v25, v18, v19
    v_cvt_pk_bf16_f32 v26, v20, v21
    v_cvt_pk_bf16_f32 v27, v22, v23
    s_add_u32 s13, s12, 0
    buffer_store_dwordx4 v[24:27], v5, s[4:7], s13 offen
    s_nop 1
    ds_read_b128 v[16:19], v8 offset:8448
    ds_read_b128 v[20:23], v8 offset:8464
    s_waitcnt lgkmcnt(0)
    v_cvt_pk_bf16_f32 v24, v16, v17
    v_cvt_pk_bf16_f32 v25, v18, v19
    v_cvt_pk_bf16_f32 v26, v20, v21
    v_cvt_pk_bf16_f32 v27, v22, v23
    s_add_u32 s13, s12, 8192
    buffer_store_dwordx4 v[24:27], v5, s[4:7], s13 offen
    s_nop 1
    ds_read_b128 v[16:19], v8 offset:16896
    ds_read_b128 v[20:23], v8 offset:16912
    s_waitcnt lgkmcnt(0)
    v_cvt_pk_bf16_f32 v24, v16, v17
    v_cvt_pk_bf16_f32 v25, v18, v19
    v_cvt_pk_bf16_f32 v26, v20, v21
    v_cvt_pk_bf16_f32 v27, v22, v23
    s_add_u32 s13, s12, 16384
    buffer_store_dwordx4 v[24:27], v5, s[4:7], s13 offen
    s_nop 1
    ds_read_b128 v[16:19], v8 offset:25344
    ds_read_b128 v[20:23], v8 offset:25360
    s_waitcnt lgkmcnt(0)
    v_cvt_pk_bf16_f32 v24, v16, v17
    v_cvt_pk_bf16_f32 v25, v18, v19
    v_cvt_pk_bf16_f32 v26, v20, v21
    v_cvt_pk_bf16_f32 v27, v22, v23
    s_add_u32 s13, s12, 24576
    buffer_store_dwordx4 v[24:27], v5, s[4:7], s13 offen
    s_nop 1
    ds_read_b128 v[16:19], v8 offset:33792
    ds_read_b128 v[20:23], v8 offset:33808
    s_waitcnt lgkmcnt(0)
    v_cvt_pk_bf16_f32 v24, v16, v17
    v_cvt_pk_bf16_f32 v25, v18, v19
    v_cvt_pk_bf16_f32 v26, v20, v21
    v_cvt_pk_bf16_f32 v27, v22, v23
    s_add_u32 s13, s12, 32768
    buffer_store_dwordx4 v[24:27], v5, s[4:7], s13 offen
    s_nop 1
    ds_read_b128 v[16:19], v8 offset:42240
    ds_read_b128 v[20:23], v8 offset:42256
    s_waitcnt lgkmcnt(0)
    v_cvt_pk_bf16_f32 v24, v16, v17
    v_cvt_pk_bf16_f32 v25, v18, v19
    v_cvt_pk_bf16_f32 v26, v20, v21
    v_cvt_pk_bf16_f32 v27, v22, v23
    s_add_u32 s13, s12, 40960
    buffer_store_dwordx4 v[24:27], v5, s[4:7], s13 offen
    s_nop 1
    ds_read_b128 v[16:19], v8 offset:50688
    ds_read_b128 v[20:23], v8 offset:50704
    s_waitcnt lgkmcnt(0)
    v_cvt_pk_bf16_f32 v24, v16, v17
    v_cvt_pk_bf16_f32 v25, v18, v19
    v_cvt_pk_bf16_f32 v26, v20, v21
    v_cvt_pk_bf16_f32 v27, v22, v23
    s_add_u32 s13, s12, 49152
    buffer_store_dwordx4 v[24:27], v5, s[4:7], s13 offen
    s_nop 1
    ds_read_b128 v[16:19], v8 offset:59136
    ds_read_b128 v[20:23], v8 offset:59152
    s_waitcnt lgkmcnt(0)
    v_cvt_pk_bf16_f32 v24, v16, v17
    v_cvt_pk_bf16_f32 v25, v18, v19
    v_cvt_pk_bf16_f32 v26, v20, v21
    v_cvt_pk_bf16_f32 v27, v22, v23
    s_add_u32 s13, s12, 57344
    buffer_store_dwordx4 v[24:27], v5, s[4:7], s13 offen
    s_nop 1
mega_kernel_xo4:
    s_waitcnt vmcnt(0)
    ds_read_b64_tr_b16 a[192:193], v201 offset:0
    ds_read_b64_tr_b16 a[194:195], v201 offset:256
    ds_read_b64_tr_b16 a[196:197], v201 offset:1024
    ds_read_b64_tr_b16 a[198:199], v201 offset:1280
    ds_read_b64_tr_b16 a[200:201], v201 offset:2048
    ds_read_b64_tr_b16 a[202:203], v201 offset:2304
    ds_read_b64_tr_b16 a[204:205], v201 offset:3072
    ds_read_b64_tr_b16 a[206:207], v201 offset:3328
    s_waitcnt lgkmcnt(0)
    ds_read_b64_tr_b16 a[208:209], v201 offset:4096
    ds_read_b64_tr_b16 a[210:211], v201 offset:4352
    ds_read_b64_tr_b16 a[212:213], v201 offset:5120
    ds_read_b64_tr_b16 a[214:215], v201 offset:5376
    ds_read_b64_tr_b16 a[216:217], v201 offset:6144
    ds_read_b64_tr_b16 a[218:219], v201 offset:6400
    ds_read_b64_tr_b16 a[220:221], v201 offset:7168
    ds_read_b64_tr_b16 a[222:223], v201 offset:7424
    s_waitcnt lgkmcnt(0)
    ds_read_b64_tr_b16 a[224:225], v201 offset:8192
    ds_read_b64_tr_b16 a[226:227], v201 offset:8448
    ds_read_b64_tr_b16 a[228:229], v201 offset:9216
    ds_read_b64_tr_b16 a[230:231], v201 offset:9472
    ds_read_b64_tr_b16 a[232:233], v201 offset:10240
    ds_read_b64_tr_b16 a[234:235], v201 offset:10496
    ds_read_b64_tr_b16 a[236:237], v201 offset:11264
    ds_read_b64_tr_b16 a[238:239], v201 offset:11520
    s_waitcnt lgkmcnt(0)
    ds_read_b64_tr_b16 a[240:241], v201 offset:12288
    ds_read_b64_tr_b16 a[242:243], v201 offset:12544
    ds_read_b64_tr_b16 a[244:245], v201 offset:13312
    ds_read_b64_tr_b16 a[246:247], v201 offset:13568
    ds_read_b64_tr_b16 a[248:249], v201 offset:14336
    ds_read_b64_tr_b16 a[250:251], v201 offset:14592
    ds_read_b64_tr_b16 a[252:253], v201 offset:15360
    ds_read_b64_tr_b16 a[254:255], v201 offset:15616
    s_waitcnt lgkmcnt(0)
    s_load_dwordx2 s[8:9], s[0:1], 40
    s_load_dwordx2 s[12:13], s[0:1], 80
    v_lshrrev_b32 v3, 6, v0
    v_and_b32 v1, 63, v0
    v_readfirstlane_b32 s16, v3
    s_lshr_b32 s17, s92, 5
    s_and_b32 s18, s92, 31
    v_lshlrev_b32 v2, 4, v1
    s_waitcnt lgkmcnt(0)
    s_mov_b32 s10, 8388608
    s_mov_b32 s11, 0x00020000
    s_mov_b32 s14, 8388608
    s_mov_b32 s15, 0x00020000
    s_mov_b32 s24, 0x3e0293ee
    s_mov_b64 s[60:61], 0
    s_lshr_b32 s50, s18, 1
    s_lshl_b32 s50, s50, 12
    s_lshl_b32 s47, s17, 2
    s_add_u32 s20, s47, s16
    s_lshl_b32 s20, s20, 18
    s_lshl_b32 s21, s18, 13
    s_add_u32 s20, s20, s21
    s_add_u32 s20, s20, 50331648
    v_lshlrev_b32 v26, 7, v1
    buffer_load_dword v28, v26, s[84:87], s20 offen sc1
    v_and_b32 v4, 15, v1
    v_lshrrev_b32 v5, 4, v1
    v_lshrrev_b32 v3, 2, v4
    v_lshlrev_b32 v3, 1, v3
    v_and_b32 v26, 1, v4
    v_add_u32 v3, v3, v26
    v_lshlrev_b32 v6, 8, v3
    v_lshl_add_u32 v6, v5, 4, v6
    s_lshr_b32 s20, s16, 1
    s_lshl_b32 s20, s20, 10
    s_add_u32 s20, s20, 2048
    v_lshlrev_b32 v7, 3, v1
    v_add_u32 v7, s20, v7
    v_lshlrev_b32 v8, 9, v5
    v_lshl_add_u32 v8, v4, 4, v8
    s_lshr_b32 s20, s16, 1
    s_lshl_b32 s20, s20, 12
    s_and_b32 s21, s16, 1
    s_lshl_b32 s21, s21, 8
    s_add_u32 s20, s20, s21
    v_add_u32 v8, s20, v8
    v_lshlrev_b32 v19, 4, v4
    v_and_b32 v26, 1, v5
    v_lshl_add_u32 v19, v26, 10, v19
    v_lshrrev_b32 v26, 1, v5
    v_lshl_add_u32 v19, v26, 9, v19
    s_and_b32 s20, s17, 1
    s_lshl_b32 s20, s20, 8
    v_add_u32 v19, s20, v19
    v_lshlrev_b32 v26, 2, v5
    v_sub_u32 v9, v4, v26
    s_lshr_b32 s21, s21, 4
    v_add_u32 v9, s21, v9
    v_add_u32 v10, -16, v9
    v_mov_b32 v11, 0xff7fffff
    v_mov_b32 v20, 0x3f803f80
    v_mov_b32 v21, 0x3f803f80
    v_mov_b32 v22, 0x3f803f80
    v_mov_b32 v23, 0x3f803f80
    v_bfe_u32 v26, v1, 1, 2
    v_min_u32 v26, 2, v26
    s_lshl_b32 s20, s18, 8
    s_add_u32 s20, s20, 71303168
    v_lshlrev_b32 v12, 13, v26
    v_and_b32 v26, 1, v1
    v_lshl_add_u32 v12, v26, 7, v12
    v_add_u32 v12, s20, v12
    v_and_b32 v26, 1, v1
    v_lshlrev_b32 v13, 7, v26
    s_add_u32 s20, s20, 24576
    v_add_u32 v13, s20, v13
    v_and_b32 v26, 7, v1
    s_lshl_b32 s20, s17, 5
    s_lshl_b32 s21, s16, 3
    s_add_u32 s20, s20, s21
    v_add_u32 v26, s20, v26
    v_lshlrev_b32 v14, 7, v26
    v_add_u32 v14, 71335936, v14
    v_bfrev_b32 v26, 1
    s_lshl_b32 s20, s92, 7
    s_add_u32 s20, s20, 71335936
    v_mov_b32 v27, s20
    v_cmp_eq_u32 vcc, 0, v0
    s_lshl_b32 s20, s16, 12
    v_add_u32 v17, s20, v2
    v_cndmask_b32 v15, v26, v27, vcc
    v_lshrrev_b32 v26, 3, v0
    v_and_b32 v27, 1, v0
    v_lshl_add_u32 v27, v27, 5, v26
    v_lshlrev_b32 v16, 4, v27
    v_bfe_u32 v27, v0, 1, 2
    v_lshl_add_u32 v16, v27, 10, v16
    v_lshlrev_b32 v18, 12, v26
    v_and_b32 v27, 7, v0
    v_lshl_add_u32 v18, v27, 3, v18
    s_lshl_b32 s20, s18, 6
    v_add_u32 v18, s20, v18
    s_barrier
    s_cmp_eq_u32 s17, 0
    s_cselect_b32 s60, 0x4104100, s60
    s_cselect_b32 s61, 0x88441041, s61
    s_cmp_eq_u32 s17, 1
    s_cselect_b32 s60, 0x8208200, s60
    s_cselect_b32 s61, 0x88882082, s61
    s_cmp_eq_u32 s17, 2
    s_cselect_b32 s60, 0x20820800, s60
    s_cselect_b32 s61, 0x24108208, s61
    s_cmp_eq_u32 s17, 3
    s_cselect_b32 s60, 0x41041000, s60
    s_cselect_b32 s61, 0x24210410, s61
    s_cmp_eq_u32 s17, 4
    s_cselect_b32 s60, 0x820820ab, s60
    s_cselect_b32 s61, 0x51020820, s61
    s_cmp_eq_u32 s17, 5
    s_cselect_b32 s60, 0x10410454, s60
    s_cselect_b32 s61, 0x52004104, s61
    s_ff1_i32_b64 s22, s[60:61]
mega_kernel_x_gp:
    buffer_load_dword v3, v12, s[84:87], 0 offen sc1
    s_waitcnt vmcnt(0)
    v_cmp_ne_u32 vcc, 32, v3
    s_cbranch_vccz mega_kernel_x_gk
    s_sleep 8
    s_branch mega_kernel_x_gp
mega_kernel_x_gk:
    s_mov_b32 s46, 0
    s_lshl_b32 s27, s22, 18
    s_lshl_b32 s20, s18, 13
    s_add_u32 s27, s27, s20
    s_add_u32 s29, s27, 178257920
    s_and_b32 s20, s16, 1
    s_lshl_b32 s20, s20, 10
    s_add_u32 s26, s27, s20
    s_add_u32 s26, s26, 0
    s_lshr_b32 s20, s16, 1
    s_lshl_b32 s20, s20, 12
    s_add_u32 s28, s27, s20
    s_add_u32 s28, s28, 33554432
    s_add_u32 s27, s27, 16777216
    s_add_u32 s48, s26, 4096
    s_add_u32 s49, s27, 4096
mega_kernel_x_ldq:
    buffer_load_dwordx4 v[24:27], v2, s[84:87], s26 offen offset:0
    buffer_load_dwordx4 v[28:31], v2, s[84:87], s26 offen offset:2048
    buffer_load_dwordx4 v[32:35], v2, s[84:87], s48 offen offset:0
    buffer_load_dwordx4 v[36:39], v2, s[84:87], s48 offen offset:2048
    buffer_load_dwordx4 v[40:43], v2, s[84:87], s27 offen offset:0
    buffer_load_dwordx4 v[44:47], v2, s[84:87], s27 offen offset:1024
    buffer_load_dwordx4 v[48:51], v2, s[84:87], s27 offen offset:2048
    buffer_load_dwordx4 v[52:55], v2, s[84:87], s27 offen offset:3072
    buffer_load_dwordx4 v[56:59], v2, s[84:87], s49 offen offset:0
    buffer_load_dwordx4 v[60:63], v2, s[84:87], s49 offen offset:1024
    buffer_load_dwordx4 v[64:67], v2, s[84:87], s49 offen offset:2048
    buffer_load_dwordx4 v[68:71], v2, s[84:87], s49 offen offset:3072
    buffer_load_dwordx4 v[72:75], v2, s[84:87], s28 offen offset:0
    buffer_load_dwordx4 v[76:79], v2, s[84:87], s28 offen offset:1024
    buffer_load_dwordx4 v[80:83], v2, s[84:87], s28 offen offset:2048
    buffer_load_dwordx4 v[84:87], v2, s[84:87], s28 offen offset:3072
mega_kernel_x_att:
    s_waitcnt vmcnt(0)
    v_mfma_f32_16x16x32_bf16 v[112:115], v[40:43], v[24:27], 0
    v_mfma_f32_16x16x32_bf16 v[116:119], v[44:47], v[24:27], 0
    v_mfma_f32_16x16x32_bf16 v[112:115], v[48:51], v[28:31], v[112:115]
    v_mfma_f32_16x16x32_bf16 v[116:119], v[52:55], v[28:31], v[116:119]
    v_mfma_f32_16x16x32_bf16 v[112:115], v[56:59], v[32:35], v[112:115]
    v_mfma_f32_16x16x32_bf16 v[116:119], v[60:63], v[32:35], v[116:119]
    v_mfma_f32_16x16x32_bf16 v[112:115], v[64:67], v[36:39], v[112:115]
    v_mfma_f32_16x16x32_bf16 v[116:119], v[68:71], v[36:39], v[116:119]
    s_lshl_b32 s41, s47, 18
    s_add_u32 s41, s41, 50331648
    s_lshl_b32 s20, s18, 13
    s_add_u32 s40, s41, s20
    s_lshl_b32 s20, s16, 16
    s_add_u32 s41, s41, s20
    s_lshl_b32 s42, s22, 17
    v_mov_b32 v130, v20
    v_mov_b32 v131, 0
    v_cmp_gt_i32 vcc, 0, v9
    s_nop 1
    v_cndmask_b32 v112, v112, v11, vcc
    v_cmp_gt_i32 vcc, 1, v9
    s_nop 1
    v_cndmask_b32 v113, v113, v11, vcc
    v_cmp_gt_i32 vcc, 2, v9
    s_nop 1
    v_cndmask_b32 v114, v114, v11, vcc
    v_cmp_gt_i32 vcc, 3, v9
    s_nop 1
    v_cndmask_b32 v115, v115, v11, vcc
    v_cmp_gt_i32 vcc, 0, v10
    s_nop 1
    v_cndmask_b32 v116, v116, v11, vcc
    v_cmp_gt_i32 vcc, 1, v10
    s_nop 1
    v_cndmask_b32 v117, v117, v11, vcc
    v_cmp_gt_i32 vcc, 2, v10
    s_nop 1
    v_cndmask_b32 v118, v118, v11, vcc
    v_cmp_gt_i32 vcc, 3, v10
    s_nop 1
    v_cndmask_b32 v119, v119, v11, vcc
    s_cmp_ge_u32 s22, 63
    s_cbranch_scc1 mega_kernel_x_dx
    s_cmp_eq_u32 s46, 1
    s_cbranch_scc1 mega_kernel_x_rd
mega_kernel_x_rp:
    buffer_load_dword v3, v13, s[84:87], 0 offen sc1
    s_waitcnt vmcnt(0)
    v_cmp_ge_u32 vcc, s22, v3
    s_cbranch_vccz mega_kernel_x_rk
    s_sleep 2
    s_branch mega_kernel_x_rp
mega_kernel_x_rk:
    buffer_load_dwordx4 v[88:91], v6, s[84:87], s29 offen offset:0 sc1
    buffer_load_dwordx4 v[92:95], v6, s[84:87], s29 offen offset:64 sc1
    buffer_load_dwordx4 v[96:99], v6, s[84:87], s29 offen offset:128 sc1
    buffer_load_dwordx4 v[100:103], v6, s[84:87], s29 offen offset:192 sc1
    buffer_load_dwordx2 v[104:105], v7, s[84:87], s29 offen offset:0 sc1
    buffer_load_dwordx2 v[106:107], v7, s[84:87], s29 offen offset:2048 sc1
    buffer_load_dwordx2 v[108:109], v7, s[84:87], s29 offen offset:512 sc1
    buffer_load_dwordx2 v[110:111], v7, s[84:87], s29 offen offset:2560 sc1
mega_kernel_x_rd:
    s_waitcnt vmcnt(7)
    v_mfma_f32_16x16x32_bf16 v[120:123], v[88:91], v[24:27], 0
    s_waitcnt vmcnt(6)
    v_mfma_f32_16x16x32_bf16 v[120:123], v[92:95], v[28:31], v[120:123]
    s_waitcnt vmcnt(5)
    v_mfma_f32_16x16x32_bf16 v[120:123], v[96:99], v[32:35], v[120:123]
    s_waitcnt vmcnt(4)
    v_mfma_f32_16x16x32_bf16 v[120:123], v[100:103], v[36:39], v[120:123]
    v_max3_f32 v4, v112, v113, v114
    v_max3_f32 v4, v4, v115, v116
    v_max3_f32 v4, v4, v117, v118
    s_waitcnt vmcnt(0)
    v_swap_b32 v105, v106
    v_swap_b32 v109, v110
    s_nop 1
    v_max3_f32 v4, v4, v119, v120
    v_max_f32 v3, v4, v121
    v_max_f32 v4, v4, v121
    s_nop 1
    v_permlane16_swap_b32 v4, v3
    v_max_f32 v4, v4, v3
    v_max_f32 v3, v4, v3
    s_nop 1
    v_permlane32_swap_b32 v4, v3
    v_max_f32 v4, v4, v3
    v_mul_f32 v4, s24, v4
    v_fma_f32 v112, v112, s24, -v4
    v_fma_f32 v113, v113, s24, -v4
    v_fma_f32 v114, v114, s24, -v4
    v_fma_f32 v115, v115, s24, -v4
    v_fma_f32 v116, v116, s24, -v4
    v_fma_f32 v117, v117, s24, -v4
    v_fma_f32 v118, v118, s24, -v4
    v_fma_f32 v119, v119, s24, -v4
    v_fma_f32 v120, v120, s24, -v4
    v_fma_f32 v121, v121, s24, -v4
    v_exp_f32 v112, v112
    v_exp_f32 v113, v113
    v_exp_f32 v114, v114
    v_exp_f32 v115, v115
    v_exp_f32 v116, v116
    v_exp_f32 v117, v117
    v_exp_f32 v118, v118
    v_exp_f32 v119, v119
    v_exp_f32 v120, v120
    v_exp_f32 v121, v121
    s_nop 0
    v_cvt_pk_bf16_f32 v124, v112, v113
    v_cvt_pk_bf16_f32 v125, v114, v115
    v_cvt_pk_bf16_f32 v126, v116, v117
    v_cvt_pk_bf16_f32 v127, v118, v119
    v_cvt_pk_bf16_f32 v128, v120, v121
    v_mov_b32 v129, v128
    s_nop 1
    v_mfma_f32_16x16x32_bf16 v[132:135], v[20:23], v[124:127], 0
    v_mfma_f32_16x16x32_bf16 v[88:91], v[72:75], v[124:127], 0
    v_mfma_f32_16x16x32_bf16 v[92:95], v[76:79], v[124:127], 0
    v_mfma_f32_16x16x32_bf16 v[96:99], v[80:83], v[124:127], 0
    v_mfma_f32_16x16x32_bf16 v[100:103], v[84:87], v[124:127], 0
    s_nop 1
    v_mfma_f32_16x16x16_bf16 v[132:135], v[130:131], v[128:129], v[132:135]
    v_mfma_f32_16x16x16_bf16 v[88:91], v[104:105], v[128:129], v[88:91]
    v_mfma_f32_16x16x16_bf16 v[92:95], v[106:107], v[128:129], v[92:95]
    v_mfma_f32_16x16x16_bf16 v[96:99], v[108:109], v[128:129], v[96:99]
    v_mfma_f32_16x16x16_bf16 v[100:103], v[110:111], v[128:129], v[100:103]
    s_nop 3
    v_rcp_f32 v132, v132
    s_nop 2
    v_pk_mul_f32 v[88:89], v[88:89], v[132:133] op_sel_hi:[1,0]
    v_pk_mul_f32 v[90:91], v[90:91], v[132:133] op_sel_hi:[1,0]
    v_pk_mul_f32 v[92:93], v[92:93], v[132:133] op_sel_hi:[1,0]
    v_pk_mul_f32 v[94:95], v[94:95], v[132:133] op_sel_hi:[1,0]
    v_pk_mul_f32 v[96:97], v[96:97], v[132:133] op_sel_hi:[1,0]
    v_pk_mul_f32 v[98:99], v[98:99], v[132:133] op_sel_hi:[1,0]
    v_pk_mul_f32 v[100:101], v[100:101], v[132:133] op_sel_hi:[1,0]
    v_pk_mul_f32 v[102:103], v[102:103], v[132:133] op_sel_hi:[1,0]
    v_cvt_pk_bf16_f32 v112, v88, v89
    v_cvt_pk_bf16_f32 v113, v90, v91
    v_cvt_pk_bf16_f32 v114, v92, v93
    v_cvt_pk_bf16_f32 v115, v94, v95
    v_cvt_pk_bf16_f32 v116, v96, v97
    v_cvt_pk_bf16_f32 v117, v98, v99
    v_cvt_pk_bf16_f32 v118, v100, v101
    v_cvt_pk_bf16_f32 v119, v102, v103
    s_add_u32 s43, s22, 1
    v_mov_b32 v4, s43
    s_cmp_eq_u32 s96, 1
    s_cbranch_scc1 mega_kernel_x_of
    buffer_store_dwordx4 v[112:115], v8, s[84:87], s40 offen sc1
    buffer_store_dwordx4 v[116:119], v8, s[84:87], s40 offen offset:2048 sc1
    s_waitcnt vmcnt(0)
    s_barrier
    buffer_store_dword v4, v15, s[84:87], 0 offen sc1
    s_branch mega_kernel_x_od
mega_kernel_x_of:
    buffer_store_dwordx4 v[112:115], v8, s[84:87], s40 offen
    buffer_store_dwordx4 v[116:119], v8, s[84:87], s40 offen offset:2048
    s_waitcnt vmcnt(0)
    s_barrier
    buffer_store_dword v4, v15, s[84:87], 0 offen
mega_kernel_x_od:
    s_mov_b32 s45, s22
    s_add_u32 s20, s47, 1
    s_and_b32 s20, s20, 3
    s_andn2_b32 s47, s47, 3
    s_or_b32 s47, s47, s20
    s_bitset0_b64 s[60:61], s22
    s_ff1_i32_b64 s22, s[60:61]
    s_min_u32 s22, s22, 64
    s_lshl_b32 s27, s22, 18
    s_lshl_b32 s20, s18, 13
    s_add_u32 s27, s27, s20
    s_add_u32 s29, s27, 178257920
    s_and_b32 s20, s16, 1
    s_lshl_b32 s20, s20, 10
    s_add_u32 s26, s27, s20
    s_add_u32 s26, s26, 0
    s_lshr_b32 s20, s16, 1
    s_lshl_b32 s20, s20, 12
    s_add_u32 s28, s27, s20
    s_add_u32 s28, s28, 33554432
    s_add_u32 s27, s27, 16777216
    s_add_u32 s48, s26, 4096
    s_add_u32 s49, s27, 4096
mega_kernel_x_xp:
    buffer_load_dword v3, v14, s[84:87], 0 offen sc1
    s_waitcnt vmcnt(0)
    v_cmp_ge_u32 vcc, s45, v3
    s_cbranch_vccnz mega_kernel_x_xp
    s_cmp_ge_u32 s45, 58
    s_cbranch_scc1 mega_kernel_x_half
    s_add_u32 s20, s50, 0
    s_and_b32 s20, s20, 0xffff
    s_add_u32 s20, s20, s41
    buffer_load_dwordx4 v[136:139], v2, s[84:87], s20 offen offset:0 sc1
    buffer_load_dwordx4 v[140:143], v2, s[84:87], s20 offen offset:1024 sc1
    buffer_load_dwordx4 v[144:147], v2, s[84:87], s20 offen offset:2048 sc1
    buffer_load_dwordx4 v[148:151], v2, s[84:87], s20 offen offset:3072 sc1
    s_add_u32 s20, s50, 4096
    s_and_b32 s20, s20, 0xffff
    s_add_u32 s20, s20, s41
    buffer_load_dwordx4 v[152:155], v2, s[84:87], s20 offen offset:0 sc1
    buffer_load_dwordx4 v[156:159], v2, s[84:87], s20 offen offset:1024 sc1
    buffer_load_dwordx4 v[160:163], v2, s[84:87], s20 offen offset:2048 sc1
    buffer_load_dwordx4 v[164:167], v2, s[84:87], s20 offen offset:3072 sc1
    s_add_u32 s20, s50, 8192
    s_and_b32 s20, s20, 0xffff
    s_add_u32 s20, s20, s41
    buffer_load_dwordx4 v[168:171], v2, s[84:87], s20 offen offset:0 sc1
    buffer_load_dwordx4 v[172:175], v2, s[84:87], s20 offen offset:1024 sc1
    buffer_load_dwordx4 v[176:179], v2, s[84:87], s20 offen offset:2048 sc1
    buffer_load_dwordx4 v[180:183], v2, s[84:87], s20 offen offset:3072 sc1
    buffer_load_dword v5, v13, s[84:87], 0 offen sc1
    s_waitcnt vmcnt(12)
    v_mfma_f32_32x32x16_bf16 v[112:127], a[0:3], v[136:139], 0
    s_add_u32 s20, s50, 12288
    s_and_b32 s20, s20, 0xffff
    s_add_u32 s20, s20, s41
    buffer_load_dwordx4 v[184:187], v2, s[84:87], s20 offen offset:0 sc1
    s_waitcnt vmcnt(12)
    v_mfma_f32_32x32x16_bf16 v[112:127], a[4:7], v[140:143], v[112:127]
    buffer_load_dwordx4 v[188:191], v2, s[84:87], s20 offen offset:1024 sc1
    s_waitcnt vmcnt(12)
    v_mfma_f32_32x32x16_bf16 v[112:127], a[8:11], v[144:147], v[112:127]
    buffer_load_dwordx4 v[192:195], v2, s[84:87], s20 offen offset:2048 sc1
    s_waitcnt vmcnt(12)
    v_mfma_f32_32x32x16_bf16 v[112:127], a[12:15], v[148:151], v[112:127]
    buffer_load_dwordx4 v[196:199], v2, s[84:87], s20 offen offset:3072 sc1
    s_waitcnt vmcnt(12)
    v_mfma_f32_32x32x16_bf16 v[112:127], a[16:19], v[152:155], v[112:127]
    s_add_u32 s20, s50, 16384
    s_and_b32 s20, s20, 0xffff
    s_add_u32 s20, s20, s41
    buffer_load_dwordx4 v[200:203], v2, s[84:87], s20 offen offset:0 sc1
    s_waitcnt vmcnt(12)
    v_mfma_f32_32x32x16_bf16 v[112:127], a[20:23], v[156:159], v[112:127]
    buffer_load_dwordx4 v[204:207], v2, s[84:87], s20 offen offset:1024 sc1
    s_waitcnt vmcnt(12)
    v_mfma_f32_32x32x16_bf16 v[112:127], a[24:27], v[160:163], v[112:127]
    buffer_load_dwordx4 v[208:211], v2, s[84:87], s20 offen offset:2048 sc1
    s_waitcnt vmcnt(12)
    v_mfma_f32_32x32x16_bf16 v[112:127], a[28:31], v[164:167], v[112:127]
    buffer_load_dwordx4 v[212:215], v2, s[84:87], s20 offen offset:3072 sc1
    s_waitcnt vmcnt(12)
    v_mfma_f32_32x32x16_bf16 v[112:127], a[32:35], v[168:171], v[112:127]
    s_add_u32 s20, s50, 20480
    s_and_b32 s20, s20, 0xffff
    s_add_u32 s20, s20, s41
    buffer_load_dwordx4 v[216:219], v2, s[84:87], s20 offen offset:0 sc1
    s_waitcnt vmcnt(12)
    v_mfma_f32_32x32x16_bf16 v[112:127], a[36:39], v[172:175], v[112:127]
    buffer_load_dwordx4 v[220:223], v2, s[84:87], s20 offen offset:1024 sc1
    s_waitcnt vmcnt(12)
    v_mfma_f32_32x32x16_bf16 v[112:127], a[40:43], v[176:179], v[112:127]
    buffer_load_dwordx4 v[224:227], v2, s[84:87], s20 offen offset:2048 sc1
    s_waitcnt vmcnt(12)
    v_mfma_f32_32x32x16_bf16 v[112:127], a[44:47], v[180:183], v[112:127]
    buffer_load_dwordx4 v[228:231], v2, s[84:87], s20 offen offset:3072 sc1
    s_waitcnt vmcnt(11)
    v_mfma_f32_32x32x16_bf16 v[112:127], a[48:51], v[184:187], v[112:127]
    s_add_u32 s20, s50, 24576
    s_and_b32 s20, s20, 0xffff
    s_add_u32 s20, s20, s41
    buffer_load_dwordx4 v[232:235], v2, s[84:87], s20 offen offset:0 sc1
    v_cmp_ge_u32 vcc, s22, v5
    s_waitcnt vmcnt(11)
    v_mfma_f32_32x32x16_bf16 v[112:127], a[52:55], v[188:191], v[112:127]
    buffer_load_dwordx4 v[236:239], v2, s[84:87], s20 offen offset:1024 sc1
    s_cmp_eq_u64 vcc, 0
    s_cselect_b32 s46, 1, 0
    s_waitcnt vmcnt(11)
    v_mfma_f32_32x32x16_bf16 v[112:127], a[56:59], v[192:195], v[112:127]
    buffer_load_dwordx4 v[240:243], v2, s[84:87], s20 offen offset:2048 sc1
    s_waitcnt vmcnt(11)
    v_mfma_f32_32x32x16_bf16 v[112:127], a[60:63], v[196:199], v[112:127]
    buffer_load_dwordx4 v[244:247], v2, s[84:87], s20 offen offset:3072 sc1
    s_waitcnt vmcnt(11)
    v_mfma_f32_32x32x16_bf16 v[112:127], a[64:67], v[200:203], v[112:127]
    s_add_u32 s20, s50, 28672
    s_and_b32 s20, s20, 0xffff
    s_add_u32 s20, s20, s41
    buffer_load_dwordx4 v[248:251], v2, s[84:87], s20 offen offset:0 sc1
    s_waitcnt vmcnt(11)
    v_mfma_f32_32x32x16_bf16 v[112:127], a[68:71], v[204:207], v[112:127]
    buffer_load_dwordx4 v[252:255], v2, s[84:87], s20 offen offset:1024 sc1
    s_waitcnt vmcnt(11)
    v_mfma_f32_32x32x16_bf16 v[112:127], a[72:75], v[208:211], v[112:127]
    buffer_load_dwordx4 v[136:139], v2, s[84:87], s20 offen offset:2048 sc1
    s_waitcnt vmcnt(11)
    v_mfma_f32_32x32x16_bf16 v[112:127], a[76:79], v[212:215], v[112:127]
    buffer_load_dwordx4 v[140:143], v2, s[84:87], s20 offen offset:3072 sc1
    s_waitcnt vmcnt(11)
    v_mfma_f32_32x32x16_bf16 v[112:127], a[80:83], v[216:219], v[112:127]
    s_add_u32 s20, s50, 32768
    s_and_b32 s20, s20, 0xffff
    s_add_u32 s20, s20, s41
    buffer_load_dwordx4 v[144:147], v2, s[84:87], s20 offen offset:0 sc1
    s_waitcnt vmcnt(11)
    v_mfma_f32_32x32x16_bf16 v[112:127], a[84:87], v[220:223], v[112:127]
    buffer_load_dwordx4 v[148:151], v2, s[84:87], s20 offen offset:1024 sc1
    s_waitcnt vmcnt(11)
    v_mfma_f32_32x32x16_bf16 v[112:127], a[88:91], v[224:227], v[112:127]
    buffer_load_dwordx4 v[152:155], v2, s[84:87], s20 offen offset:2048 sc1
    s_waitcnt vmcnt(11)
    v_mfma_f32_32x32x16_bf16 v[112:127], a[92:95], v[228:231], v[112:127]
    buffer_load_dwordx4 v[156:159], v2, s[84:87], s20 offen offset:3072 sc1
    s_waitcnt vmcnt(11)
    v_mfma_f32_32x32x16_bf16 v[112:127], a[96:99], v[232:235], v[112:127]
    s_add_u32 s20, s50, 36864
    s_and_b32 s20, s20, 0xffff
    s_add_u32 s20, s20, s41
    buffer_load_dwordx4 v[160:163], v2, s[84:87], s20 offen offset:0 sc1
    s_waitcnt vmcnt(11)
    v_mfma_f32_32x32x16_bf16 v[112:127], a[100:103], v[236:239], v[112:127]
    buffer_load_dwordx4 v[164:167], v2, s[84:87], s20 offen offset:1024 sc1
    s_waitcnt vmcnt(11)
    v_mfma_f32_32x32x16_bf16 v[112:127], a[104:107], v[240:243], v[112:127]
    buffer_load_dwordx4 v[168:171], v2, s[84:87], s20 offen offset:2048 sc1
    s_waitcnt vmcnt(11)
    v_mfma_f32_32x32x16_bf16 v[112:127], a[108:111], v[244:247], v[112:127]
    buffer_load_dwordx4 v[172:175], v2, s[84:87], s20 offen offset:3072 sc1
    s_waitcnt vmcnt(11)
    v_mfma_f32_32x32x16_bf16 v[112:127], a[112:115], v[248:251], v[112:127]
    s_add_u32 s20, s50, 40960
    s_and_b32 s20, s20, 0xffff
    s_add_u32 s20, s20, s41
    buffer_load_dwordx4 v[176:179], v2, s[84:87], s20 offen offset:0 sc1
    s_waitcnt vmcnt(11)
    v_mfma_f32_32x32x16_bf16 v[112:127], a[116:119], v[252:255], v[112:127]
    buffer_load_dwordx4 v[180:183], v2, s[84:87], s20 offen offset:1024 sc1
    s_waitcnt vmcnt(11)
    v_mfma_f32_32x32x16_bf16 v[112:127], a[120:123], v[136:139], v[112:127]
    buffer_load_dwordx4 v[184:187], v2, s[84:87], s20 offen offset:2048 sc1
    s_waitcnt vmcnt(11)
    v_mfma_f32_32x32x16_bf16 v[112:127], a[124:127], v[140:143], v[112:127]
    buffer_load_dwordx4 v[188:191], v2, s[84:87], s20 offen offset:3072 sc1
    s_waitcnt vmcnt(11)
    v_mfma_f32_32x32x16_bf16 v[112:127], a[128:131], v[144:147], v[112:127]
    s_add_u32 s20, s50, 45056
    s_and_b32 s20, s20, 0xffff
    s_add_u32 s20, s20, s41
    buffer_load_dwordx4 v[192:195], v2, s[84:87], s20 offen offset:0 sc1
    s_waitcnt vmcnt(11)
    v_mfma_f32_32x32x16_bf16 v[112:127], a[132:135], v[148:151], v[112:127]
    buffer_load_dwordx4 v[196:199], v2, s[84:87], s20 offen offset:1024 sc1
    s_waitcnt vmcnt(11)
    v_mfma_f32_32x32x16_bf16 v[112:127], a[136:139], v[152:155], v[112:127]
    buffer_load_dwordx4 v[200:203], v2, s[84:87], s20 offen offset:2048 sc1
    s_waitcnt vmcnt(11)
    v_mfma_f32_32x32x16_bf16 v[112:127], a[140:143], v[156:159], v[112:127]
    buffer_load_dwordx4 v[204:207], v2, s[84:87], s20 offen offset:3072 sc1
    s_waitcnt vmcnt(11)
    v_mfma_f32_32x32x16_bf16 v[112:127], a[144:147], v[160:163], v[112:127]
    s_add_u32 s20, s50, 49152
    s_and_b32 s20, s20, 0xffff
    s_add_u32 s20, s20, s41
    buffer_load_dwordx4 v[208:211], v2, s[84:87], s20 offen offset:0 sc1
    s_waitcnt vmcnt(11)
    v_mfma_f32_32x32x16_bf16 v[112:127], a[148:151], v[164:167], v[112:127]
    buffer_load_dwordx4 v[212:215], v2, s[84:87], s20 offen offset:1024 sc1
    s_waitcnt vmcnt(11)
    v_mfma_f32_32x32x16_bf16 v[112:127], a[152:155], v[168:171], v[112:127]
    buffer_load_dwordx4 v[216:219], v2, s[84:87], s20 offen offset:2048 sc1
    s_waitcnt vmcnt(11)
    v_mfma_f32_32x32x16_bf16 v[112:127], a[156:159], v[172:175], v[112:127]
    buffer_load_dwordx4 v[220:223], v2, s[84:87], s20 offen offset:3072 sc1
    s_waitcnt vmcnt(11)
    v_mfma_f32_32x32x16_bf16 v[112:127], a[160:163], v[176:179], v[112:127]
    s_add_u32 s20, s50, 53248
    s_and_b32 s20, s20, 0xffff
    s_add_u32 s20, s20, s41
    buffer_load_dwordx4 v[224:227], v2, s[84:87], s20 offen offset:0 sc1
    s_waitcnt vmcnt(11)
    v_mfma_f32_32x32x16_bf16 v[112:127], a[164:167], v[180:183], v[112:127]
    buffer_load_dwordx4 v[228:231], v2, s[84:87], s20 offen offset:1024 sc1
    s_waitcnt vmcnt(11)
    v_mfma_f32_32x32x16_bf16 v[112:127], a[168:171], v[184:187], v[112:127]
    buffer_load_dwordx4 v[232:235], v2, s[84:87], s20 offen offset:2048 sc1
    s_waitcnt vmcnt(11)
    v_mfma_f32_32x32x16_bf16 v[112:127], a[172:175], v[188:191], v[112:127]
    buffer_load_dwordx4 v[236:239], v2, s[84:87], s20 offen offset:3072 sc1
    s_waitcnt vmcnt(11)
    v_mfma_f32_32x32x16_bf16 v[112:127], a[176:179], v[192:195], v[112:127]
    s_add_u32 s20, s50, 57344
    s_and_b32 s20, s20, 0xffff
    s_add_u32 s20, s20, s41
    buffer_load_dwordx4 v[240:243], v2, s[84:87], s20 offen offset:0 sc1
    s_waitcnt vmcnt(11)
    v_mfma_f32_32x32x16_bf16 v[112:127], a[180:183], v[196:199], v[112:127]
    buffer_load_dwordx4 v[244:247], v2, s[84:87], s20 offen offset:1024 sc1
    s_waitcnt vmcnt(11)
    v_mfma_f32_32x32x16_bf16 v[112:127], a[184:187], v[200:203], v[112:127]
    buffer_load_dwordx4 v[248:251], v2, s[84:87], s20 offen offset:2048 sc1
    s_waitcnt vmcnt(11)
    v_mfma_f32_32x32x16_bf16 v[112:127], a[188:191], v[204:207], v[112:127]
    buffer_load_dwordx4 v[252:255], v2, s[84:87], s20 offen offset:3072 sc1
    s_waitcnt vmcnt(11)
    v_mfma_f32_32x32x16_bf16 v[112:127], a[192:195], v[208:211], v[112:127]
    s_add_u32 s20, s50, 61440
    s_and_b32 s20, s20, 0xffff
    s_add_u32 s20, s20, s41
    buffer_load_dwordx4 v[136:139], v2, s[84:87], s20 offen offset:0 sc1
    s_waitcnt vmcnt(11)
    v_mfma_f32_32x32x16_bf16 v[112:127], a[196:199], v[212:215], v[112:127]
    buffer_load_dwordx4 v[140:143], v2, s[84:87], s20 offen offset:1024 sc1
    s_waitcnt vmcnt(11)
    v_mfma_f32_32x32x16_bf16 v[112:127], a[200:203], v[216:219], v[112:127]
    buffer_load_dwordx4 v[144:147], v2, s[84:87], s20 offen offset:2048 sc1
    s_waitcnt vmcnt(11)
    v_mfma_f32_32x32x16_bf16 v[112:127], a[204:207], v[220:223], v[112:127]
    buffer_load_dwordx4 v[148:151], v2, s[84:87], s20 offen offset:3072 sc1
    s_cmp_eq_u32 s46, 1
    s_cbranch_scc1 mega_kernel_x_pfx
    s_waitcnt vmcnt(11)
    v_mfma_f32_32x32x16_bf16 v[112:127], a[208:211], v[224:227], v[112:127]
    s_waitcnt vmcnt(10)
    v_mfma_f32_32x32x16_bf16 v[112:127], a[212:215], v[228:231], v[112:127]
    s_waitcnt vmcnt(9)
    v_mfma_f32_32x32x16_bf16 v[112:127], a[216:219], v[232:235], v[112:127]
    s_waitcnt vmcnt(8)
    v_mfma_f32_32x32x16_bf16 v[112:127], a[220:223], v[236:239], v[112:127]
    s_waitcnt vmcnt(7)
    v_mfma_f32_32x32x16_bf16 v[112:127], a[224:227], v[240:243], v[112:127]
    s_waitcnt vmcnt(6)
    v_mfma_f32_32x32x16_bf16 v[112:127], a[228:231], v[244:247], v[112:127]
    s_waitcnt vmcnt(5)
    v_mfma_f32_32x32x16_bf16 v[112:127], a[232:235], v[248:251], v[112:127]
    s_waitcnt vmcnt(4)
    v_mfma_f32_32x32x16_bf16 v[112:127], a[236:239], v[252:255], v[112:127]
    s_waitcnt vmcnt(3)
    v_mfma_f32_32x32x16_bf16 v[112:127], a[240:243], v[136:139], v[112:127]
    s_waitcnt vmcnt(2)
    v_mfma_f32_32x32x16_bf16 v[112:127], a[244:247], v[140:143], v[112:127]
    s_waitcnt vmcnt(1)
    v_mfma_f32_32x32x16_bf16 v[112:127], a[248:251], v[144:147], v[112:127]
    s_waitcnt vmcnt(0)
    v_mfma_f32_32x32x16_bf16 v[112:127], a[252:255], v[148:151], v[112:127]
    s_branch mega_kernel_x_pfd
mega_kernel_x_pfx:
    s_waitcnt vmcnt(11)
    v_mfma_f32_32x32x16_bf16 v[112:127], a[208:211], v[224:227], v[112:127]
    buffer_load_dwordx4 v[24:27], v2, s[84:87], s26 offen offset:0
    buffer_load_dwordx4 v[28:31], v2, s[84:87], s26 offen offset:2048
    s_waitcnt vmcnt(12)
    v_mfma_f32_32x32x16_bf16 v[112:127], a[212:215], v[228:231], v[112:127]
    buffer_load_dwordx4 v[32:35], v2, s[84:87], s48 offen offset:0
    buffer_load_dwordx4 v[36:39], v2, s[84:87], s48 offen offset:2048
    s_waitcnt vmcnt(13)
    v_mfma_f32_32x32x16_bf16 v[112:127], a[216:219], v[232:235], v[112:127]
    buffer_load_dwordx4 v[40:43], v2, s[84:87], s27 offen offset:0
    buffer_load_dwordx4 v[44:47], v2, s[84:87], s27 offen offset:1024
    s_waitcnt vmcnt(14)
    v_mfma_f32_32x32x16_bf16 v[112:127], a[220:223], v[236:239], v[112:127]
    buffer_load_dwordx4 v[48:51], v2, s[84:87], s27 offen offset:2048
    buffer_load_dwordx4 v[52:55], v2, s[84:87], s27 offen offset:3072
    s_waitcnt vmcnt(15)
    v_mfma_f32_32x32x16_bf16 v[112:127], a[224:227], v[240:243], v[112:127]
    buffer_load_dwordx4 v[56:59], v2, s[84:87], s49 offen offset:0
    buffer_load_dwordx4 v[60:63], v2, s[84:87], s49 offen offset:1024
    s_waitcnt vmcnt(16)
    v_mfma_f32_32x32x16_bf16 v[112:127], a[228:231], v[244:247], v[112:127]
    buffer_load_dwordx4 v[64:67], v2, s[84:87], s49 offen offset:2048
    buffer_load_dwordx4 v[68:71], v2, s[84:87], s49 offen offset:3072
    s_waitcnt vmcnt(17)
    v_mfma_f32_32x32x16_bf16 v[112:127], a[232:235], v[248:251], v[112:127]
    buffer_load_dwordx4 v[72:75], v2, s[84:87], s28 offen offset:0
    buffer_load_dwordx4 v[76:79], v2, s[84:87], s28 offen offset:1024
    s_waitcnt vmcnt(18)
    v_mfma_f32_32x32x16_bf16 v[112:127], a[236:239], v[252:255], v[112:127]
    buffer_load_dwordx4 v[80:83], v2, s[84:87], s28 offen offset:2048
    buffer_load_dwordx4 v[84:87], v2, s[84:87], s28 offen offset:3072
    s_waitcnt vmcnt(19)
    v_mfma_f32_32x32x16_bf16 v[112:127], a[240:243], v[136:139], v[112:127]
    buffer_load_dwordx4 v[88:91], v6, s[84:87], s29 offen offset:0 sc1
    buffer_load_dwordx4 v[92:95], v6, s[84:87], s29 offen offset:64 sc1
    s_waitcnt vmcnt(20)
    v_mfma_f32_32x32x16_bf16 v[112:127], a[244:247], v[140:143], v[112:127]
    buffer_load_dwordx4 v[96:99], v6, s[84:87], s29 offen offset:128 sc1
    buffer_load_dwordx4 v[100:103], v6, s[84:87], s29 offen offset:192 sc1
    s_waitcnt vmcnt(21)
    v_mfma_f32_32x32x16_bf16 v[112:127], a[248:251], v[144:147], v[112:127]
    buffer_load_dwordx2 v[104:105], v7, s[84:87], s29 offen offset:0 sc1
    buffer_load_dwordx2 v[106:107], v7, s[84:87], s29 offen offset:2048 sc1
    s_waitcnt vmcnt(22)
    v_mfma_f32_32x32x16_bf16 v[112:127], a[252:255], v[148:151], v[112:127]
    buffer_load_dwordx2 v[108:109], v7, s[84:87], s29 offen offset:512 sc1
    buffer_load_dwordx2 v[110:111], v7, s[84:87], s29 offen offset:2560 sc1
mega_kernel_x_pfd:
    s_nop 11
    ds_write_b128 v17, v[112:115] offset:0
    ds_write_b128 v17, v[116:119] offset:1024
    ds_write_b128 v17, v[120:123] offset:2048
    ds_write_b128 v17, v[124:127] offset:3072
    s_waitcnt lgkmcnt(0)
    s_barrier
    ds_read_b128 v[112:115], v16 offset:0
    ds_read_b128 v[116:119], v16 offset:4096
    ds_read_b128 v[120:123], v16 offset:8192
    ds_read_b128 v[124:127], v16 offset:12288
    s_waitcnt lgkmcnt(0)
    v_pk_add_f32 v[112:113], v[112:113], v[116:117]
    v_pk_add_f32 v[114:115], v[114:115], v[118:119]
    v_pk_add_f32 v[120:121], v[120:121], v[124:125]
    v_pk_add_f32 v[122:123], v[122:123], v[126:127]
    v_pk_add_f32 v[112:113], v[112:113], v[120:121]
    v_pk_add_f32 v[114:115], v[114:115], v[122:123]
    v_cvt_pk_bf16_f32 v132, v112, v113
    v_cvt_pk_bf16_f32 v133, v114, v115
    buffer_store_dwordx2 v[132:133], v18, s[12:15], s42 offen
    s_branch mega_kernel_x_nxt
mega_kernel_x_half:
    s_add_u32 s20, s50, 0
    s_and_b32 s20, s20, 0xffff
    s_add_u32 s20, s20, s41
    buffer_load_dwordx4 v[136:139], v19, s[84:87], s20 offen offset:0 sc1
    buffer_load_dwordx4 v[140:143], v19, s[84:87], s20 offen offset:2048 sc1
    s_add_u32 s20, s50, 4096
    s_and_b32 s20, s20, 0xffff
    s_add_u32 s20, s20, s41
    buffer_load_dwordx4 v[144:147], v19, s[84:87], s20 offen offset:0 sc1
    buffer_load_dwordx4 v[148:151], v19, s[84:87], s20 offen offset:2048 sc1
    s_add_u32 s20, s50, 8192
    s_and_b32 s20, s20, 0xffff
    s_add_u32 s20, s20, s41
    buffer_load_dwordx4 v[152:155], v19, s[84:87], s20 offen offset:0 sc1
    buffer_load_dwordx4 v[156:159], v19, s[84:87], s20 offen offset:2048 sc1
    s_add_u32 s20, s50, 12288
    s_and_b32 s20, s20, 0xffff
    s_add_u32 s20, s20, s41
    buffer_load_dwordx4 v[160:163], v19, s[84:87], s20 offen offset:0 sc1
    buffer_load_dwordx4 v[164:167], v19, s[84:87], s20 offen offset:2048 sc1
    s_add_u32 s20, s50, 16384
    s_and_b32 s20, s20, 0xffff
    s_add_u32 s20, s20, s41
    buffer_load_dwordx4 v[168:171], v19, s[84:87], s20 offen offset:0 sc1
    buffer_load_dwordx4 v[172:175], v19, s[84:87], s20 offen offset:2048 sc1
    s_add_u32 s20, s50, 20480
    s_and_b32 s20, s20, 0xffff
    s_add_u32 s20, s20, s41
    buffer_load_dwordx4 v[176:179], v19, s[84:87], s20 offen offset:0 sc1
    buffer_load_dwordx4 v[180:183], v19, s[84:87], s20 offen offset:2048 sc1
    s_mov_b32 s46, 0
    s_waitcnt vmcnt(11)
    v_mfma_f32_32x32x16_bf16 v[112:127], a[0:3], v[136:139], 0
    v_mfma_f32_32x32x16_bf16 v[88:103], a[4:7], v[136:139], 0
    s_add_u32 s20, s50, 24576
    s_and_b32 s20, s20, 0xffff
    s_add_u32 s20, s20, s41
    buffer_load_dwordx4 v[184:187], v19, s[84:87], s20 offen offset:0 sc1
    s_waitcnt vmcnt(11)
    v_mfma_f32_32x32x16_bf16 v[112:127], a[8:11], v[140:143], v[112:127]
    v_mfma_f32_32x32x16_bf16 v[88:103], a[12:15], v[140:143], v[88:103]
    buffer_load_dwordx4 v[188:191], v19, s[84:87], s20 offen offset:2048 sc1
    s_waitcnt vmcnt(11)
    v_mfma_f32_32x32x16_bf16 v[112:127], a[16:19], v[144:147], v[112:127]
    v_mfma_f32_32x32x16_bf16 v[88:103], a[20:23], v[144:147], v[88:103]
    s_add_u32 s20, s50, 28672
    s_and_b32 s20, s20, 0xffff
    s_add_u32 s20, s20, s41
    buffer_load_dwordx4 v[192:195], v19, s[84:87], s20 offen offset:0 sc1
    s_waitcnt vmcnt(11)
    v_mfma_f32_32x32x16_bf16 v[112:127], a[24:27], v[148:151], v[112:127]
    v_mfma_f32_32x32x16_bf16 v[88:103], a[28:31], v[148:151], v[88:103]
    buffer_load_dwordx4 v[196:199], v19, s[84:87], s20 offen offset:2048 sc1
    s_waitcnt vmcnt(11)
    v_mfma_f32_32x32x16_bf16 v[112:127], a[32:35], v[152:155], v[112:127]
    v_mfma_f32_32x32x16_bf16 v[88:103], a[36:39], v[152:155], v[88:103]
    s_add_u32 s20, s50, 32768
    s_and_b32 s20, s20, 0xffff
    s_add_u32 s20, s20, s41
    buffer_load_dwordx4 v[200:203], v19, s[84:87], s20 offen offset:0 sc1
    s_waitcnt vmcnt(11)
    v_mfma_f32_32x32x16_bf16 v[112:127], a[40:43], v[156:159], v[112:127]
    v_mfma_f32_32x32x16_bf16 v[88:103], a[44:47], v[156:159], v[88:103]
    buffer_load_dwordx4 v[204:207], v19, s[84:87], s20 offen offset:2048 sc1
    s_waitcnt vmcnt(11)
    v_mfma_f32_32x32x16_bf16 v[112:127], a[48:51], v[160:163], v[112:127]
    v_mfma_f32_32x32x16_bf16 v[88:103], a[52:55], v[160:163], v[88:103]
    s_add_u32 s20, s50, 36864
    s_and_b32 s20, s20, 0xffff
    s_add_u32 s20, s20, s41
    buffer_load_dwordx4 v[208:211], v19, s[84:87], s20 offen offset:0 sc1
    s_waitcnt vmcnt(11)
    v_mfma_f32_32x32x16_bf16 v[112:127], a[56:59], v[164:167], v[112:127]
    v_mfma_f32_32x32x16_bf16 v[88:103], a[60:63], v[164:167], v[88:103]
    buffer_load_dwordx4 v[212:215], v19, s[84:87], s20 offen offset:2048 sc1
    s_waitcnt vmcnt(11)
    v_mfma_f32_32x32x16_bf16 v[112:127], a[64:67], v[168:171], v[112:127]
    v_mfma_f32_32x32x16_bf16 v[88:103], a[68:71], v[168:171], v[88:103]
    s_add_u32 s20, s50, 40960
    s_and_b32 s20, s20, 0xffff
    s_add_u32 s20, s20, s41
    buffer_load_dwordx4 v[216:219], v19, s[84:87], s20 offen offset:0 sc1
    s_waitcnt vmcnt(11)
    v_mfma_f32_32x32x16_bf16 v[112:127], a[72:75], v[172:175], v[112:127]
    v_mfma_f32_32x32x16_bf16 v[88:103], a[76:79], v[172:175], v[88:103]
    buffer_load_dwordx4 v[220:223], v19, s[84:87], s20 offen offset:2048 sc1
    s_waitcnt vmcnt(11)
    v_mfma_f32_32x32x16_bf16 v[112:127], a[80:83], v[176:179], v[112:127]
    v_mfma_f32_32x32x16_bf16 v[88:103], a[84:87], v[176:179], v[88:103]
    s_add_u32 s20, s50, 45056
    s_and_b32 s20, s20, 0xffff
    s_add_u32 s20, s20, s41
    buffer_load_dwordx4 v[224:227], v19, s[84:87], s20 offen offset:0 sc1
    s_waitcnt vmcnt(11)
    v_mfma_f32_32x32x16_bf16 v[112:127], a[88:91], v[180:183], v[112:127]
    v_mfma_f32_32x32x16_bf16 v[88:103], a[92:95], v[180:183], v[88:103]
    buffer_load_dwordx4 v[228:231], v19, s[84:87], s20 offen offset:2048 sc1
    s_waitcnt vmcnt(11)
    v_mfma_f32_32x32x16_bf16 v[112:127], a[96:99], v[184:187], v[112:127]
    v_mfma_f32_32x32x16_bf16 v[88:103], a[100:103], v[184:187], v[88:103]
    s_add_u32 s20, s50, 49152
    s_and_b32 s20, s20, 0xffff
    s_add_u32 s20, s20, s41
    buffer_load_dwordx4 v[232:235], v19, s[84:87], s20 offen offset:0 sc1
    s_waitcnt vmcnt(11)
    v_mfma_f32_32x32x16_bf16 v[112:127], a[104:107], v[188:191], v[112:127]
    v_mfma_f32_32x32x16_bf16 v[88:103], a[108:111], v[188:191], v[88:103]
    buffer_load_dwordx4 v[236:239], v19, s[84:87], s20 offen offset:2048 sc1
    s_waitcnt vmcnt(11)
    v_mfma_f32_32x32x16_bf16 v[112:127], a[112:115], v[192:195], v[112:127]
    v_mfma_f32_32x32x16_bf16 v[88:103], a[116:119], v[192:195], v[88:103]
    s_add_u32 s20, s50, 53248
    s_and_b32 s20, s20, 0xffff
    s_add_u32 s20, s20, s41
    buffer_load_dwordx4 v[240:243], v19, s[84:87], s20 offen offset:0 sc1
    s_waitcnt vmcnt(11)
    v_mfma_f32_32x32x16_bf16 v[112:127], a[120:123], v[196:199], v[112:127]
    v_mfma_f32_32x32x16_bf16 v[88:103], a[124:127], v[196:199], v[88:103]
    buffer_load_dwordx4 v[244:247], v19, s[84:87], s20 offen offset:2048 sc1
    s_waitcnt vmcnt(11)
    v_mfma_f32_32x32x16_bf16 v[112:127], a[128:131], v[200:203], v[112:127]
    v_mfma_f32_32x32x16_bf16 v[88:103], a[132:135], v[200:203], v[88:103]
    s_add_u32 s20, s50, 57344
    s_and_b32 s20, s20, 0xffff
    s_add_u32 s20, s20, s41
    buffer_load_dwordx4 v[248:251], v19, s[84:87], s20 offen offset:0 sc1
    s_waitcnt vmcnt(11)
    v_mfma_f32_32x32x16_bf16 v[112:127], a[136:139], v[204:207], v[112:127]
    v_mfma_f32_32x32x16_bf16 v[88:103], a[140:143], v[204:207], v[88:103]
    buffer_load_dwordx4 v[252:255], v19, s[84:87], s20 offen offset:2048 sc1
    s_waitcnt vmcnt(11)
    v_mfma_f32_32x32x16_bf16 v[112:127], a[144:147], v[208:211], v[112:127]
    v_mfma_f32_32x32x16_bf16 v[88:103], a[148:151], v[208:211], v[88:103]
    s_add_u32 s20, s50, 61440
    s_and_b32 s20, s20, 0xffff
    s_add_u32 s20, s20, s41
    buffer_load_dwordx4 v[136:139], v19, s[84:87], s20 offen offset:0 sc1
    s_waitcnt vmcnt(11)
    v_mfma_f32_32x32x16_bf16 v[112:127], a[152:155], v[212:215], v[112:127]
    v_mfma_f32_32x32x16_bf16 v[88:103], a[156:159], v[212:215], v[88:103]
    buffer_load_dwordx4 v[140:143], v19, s[84:87], s20 offen offset:2048 sc1
    s_waitcnt vmcnt(11)
    v_mfma_f32_32x32x16_bf16 v[112:127], a[160:163], v[216:219], v[112:127]
    v_mfma_f32_32x32x16_bf16 v[88:103], a[164:167], v[216:219], v[88:103]
    s_waitcnt vmcnt(10)
    v_mfma_f32_32x32x16_bf16 v[112:127], a[168:171], v[220:223], v[112:127]
    v_mfma_f32_32x32x16_bf16 v[88:103], a[172:175], v[220:223], v[88:103]
    s_waitcnt vmcnt(9)
    v_mfma_f32_32x32x16_bf16 v[112:127], a[176:179], v[224:227], v[112:127]
    v_mfma_f32_32x32x16_bf16 v[88:103], a[180:183], v[224:227], v[88:103]
    s_waitcnt vmcnt(8)
    v_mfma_f32_32x32x16_bf16 v[112:127], a[184:187], v[228:231], v[112:127]
    v_mfma_f32_32x32x16_bf16 v[88:103], a[188:191], v[228:231], v[88:103]
    s_waitcnt vmcnt(7)
    v_mfma_f32_32x32x16_bf16 v[112:127], a[192:195], v[232:235], v[112:127]
    v_mfma_f32_32x32x16_bf16 v[88:103], a[196:199], v[232:235], v[88:103]
    s_waitcnt vmcnt(6)
    v_mfma_f32_32x32x16_bf16 v[112:127], a[200:203], v[236:239], v[112:127]
    v_mfma_f32_32x32x16_bf16 v[88:103], a[204:207], v[236:239], v[88:103]
    s_waitcnt vmcnt(5)
    v_mfma_f32_32x32x16_bf16 v[112:127], a[208:211], v[240:243], v[112:127]
    v_mfma_f32_32x32x16_bf16 v[88:103], a[212:215], v[240:243], v[88:103]
    s_waitcnt vmcnt(4)
    v_mfma_f32_32x32x16_bf16 v[112:127], a[216:219], v[244:247], v[112:127]
    v_mfma_f32_32x32x16_bf16 v[88:103], a[220:223], v[244:247], v[88:103]
    s_waitcnt vmcnt(3)
    v_mfma_f32_32x32x16_bf16 v[112:127], a[224:227], v[248:251], v[112:127]
    v_mfma_f32_32x32x16_bf16 v[88:103], a[228:231], v[248:251], v[88:103]
    s_waitcnt vmcnt(2)
    v_mfma_f32_32x32x16_bf16 v[112:127], a[232:235], v[252:255], v[112:127]
    v_mfma_f32_32x32x16_bf16 v[88:103], a[236:239], v[252:255], v[88:103]
    s_waitcnt vmcnt(1)
    v_mfma_f32_32x32x16_bf16 v[112:127], a[240:243], v[136:139], v[112:127]
    v_mfma_f32_32x32x16_bf16 v[88:103], a[244:247], v[136:139], v[88:103]
    s_waitcnt vmcnt(0)
    v_mfma_f32_32x32x16_bf16 v[112:127], a[248:251], v[140:143], v[112:127]
    v_mfma_f32_32x32x16_bf16 v[88:103], a[252:255], v[140:143], v[88:103]
    s_cmp_ge_u32 s22, 64
    s_cbranch_scc1 mega_kernel_x_hnp
    s_mov_b32 s46, 2
    buffer_load_dwordx4 v[24:27], v2, s[84:87], s26 offen offset:0
    buffer_load_dwordx4 v[28:31], v2, s[84:87], s26 offen offset:2048
    buffer_load_dwordx4 v[32:35], v2, s[84:87], s48 offen offset:0
    buffer_load_dwordx4 v[36:39], v2, s[84:87], s48 offen offset:2048
    buffer_load_dwordx4 v[40:43], v2, s[84:87], s27 offen offset:0
    buffer_load_dwordx4 v[44:47], v2, s[84:87], s27 offen offset:1024
    buffer_load_dwordx4 v[48:51], v2, s[84:87], s27 offen offset:2048
    buffer_load_dwordx4 v[52:55], v2, s[84:87], s27 offen offset:3072
    buffer_load_dwordx4 v[56:59], v2, s[84:87], s49 offen offset:0
    buffer_load_dwordx4 v[60:63], v2, s[84:87], s49 offen offset:1024
    buffer_load_dwordx4 v[64:67], v2, s[84:87], s49 offen offset:2048
    buffer_load_dwordx4 v[68:71], v2, s[84:87], s49 offen offset:3072
    buffer_load_dwordx4 v[72:75], v2, s[84:87], s28 offen offset:0
    buffer_load_dwordx4 v[76:79], v2, s[84:87], s28 offen offset:1024
    buffer_load_dwordx4 v[80:83], v2, s[84:87], s28 offen offset:2048
    buffer_load_dwordx4 v[84:87], v2, s[84:87], s28 offen offset:3072
mega_kernel_x_hnp:
    s_mov_b32 vcc_lo, 0xffff0000
    s_mov_b32 vcc_hi, 0xffff0000
    s_nop 9
    v_cndmask_b32 v112, v112, v88, vcc
    v_cndmask_b32 v113, v113, v89, vcc
    v_cndmask_b32 v114, v114, v90, vcc
    v_cndmask_b32 v115, v115, v91, vcc
    v_cndmask_b32 v116, v116, v92, vcc
    v_cndmask_b32 v117, v117, v93, vcc
    v_cndmask_b32 v118, v118, v94, vcc
    v_cndmask_b32 v119, v119, v95, vcc
    v_cndmask_b32 v120, v120, v96, vcc
    v_cndmask_b32 v121, v121, v97, vcc
    v_cndmask_b32 v122, v122, v98, vcc
    v_cndmask_b32 v123, v123, v99, vcc
    v_cndmask_b32 v124, v124, v100, vcc
    v_cndmask_b32 v125, v125, v101, vcc
    v_cndmask_b32 v126, v126, v102, vcc
    v_cndmask_b32 v127, v127, v103, vcc
    ds_write_b128 v17, v[112:115] offset:0
    ds_write_b128 v17, v[116:119] offset:1024
    ds_write_b128 v17, v[120:123] offset:2048
    ds_write_b128 v17, v[124:127] offset:3072
    s_waitcnt lgkmcnt(0)
    s_barrier
    s_cmp_ge_u32 s16, 2
    s_cbranch_scc1 mega_kernel_x_nxt
    ds_read_b128 v[112:115], v16 offset:0
    ds_read_b128 v[88:91], v16 offset:256
    ds_read_b128 v[116:119], v16 offset:4096
    ds_read_b128 v[92:95], v16 offset:4352
    ds_read_b128 v[120:123], v16 offset:8192
    ds_read_b128 v[96:99], v16 offset:8448
    ds_read_b128 v[124:127], v16 offset:12288
    ds_read_b128 v[100:103], v16 offset:12544
    s_and_b32 s20, s17, 1
    s_lshl_b32 s20, s20, 16
    s_add_u32 s42, s42, s20
    s_waitcnt lgkmcnt(0)
    v_pk_add_f32 v[112:113], v[112:113], v[88:89]
    v_pk_add_f32 v[114:115], v[114:115], v[90:91]
    v_pk_add_f32 v[116:117], v[116:117], v[92:93]
    v_pk_add_f32 v[118:119], v[118:119], v[94:95]
    v_pk_add_f32 v[120:121], v[120:121], v[96:97]
    v_pk_add_f32 v[122:123], v[122:123], v[98:99]
    v_pk_add_f32 v[124:125], v[124:125], v[100:101]
    v_pk_add_f32 v[126:127], v[126:127], v[102:103]
    v_pk_add_f32 v[112:113], v[112:113], v[116:117]
    v_pk_add_f32 v[114:115], v[114:115], v[118:119]
    v_pk_add_f32 v[120:121], v[120:121], v[124:125]
    v_pk_add_f32 v[122:123], v[122:123], v[126:127]
    v_pk_add_f32 v[112:113], v[112:113], v[120:121]
    v_pk_add_f32 v[114:115], v[114:115], v[122:123]
    v_cvt_pk_bf16_f32 v132, v112, v113
    v_cvt_pk_bf16_f32 v133, v114, v115
    buffer_store_dwordx2 v[132:133], v18, s[12:15], s42 offen
mega_kernel_x_nxt:
    s_cmp_lg_u32 s46, 0
    s_cbranch_scc1 mega_kernel_x_att
    s_cmp_lt_u32 s22, 64
    s_cbranch_scc1 mega_kernel_x_ldq
    s_branch mega_kernel_x_fin
mega_kernel_x_dx:
    buffer_load_dword v3, off, s[88:91], 0 offset:204 sc1
    v_and_b32 v4, 15, v1
    v_lshrrev_b32 v5, 4, v1
    v_lshlrev_b32 v170, 3, v1
    v_and_b32 v168, 1, v4
    v_lshlrev_b32 v168, 4, v168
    v_mov_b32 v169, 0x3f80
    v_lshlrev_b32 v169, v168, v169
    v_lshrrev_b32 v4, 2, v4
    v_cmp_eq_u32 vcc, v4, v5
    v_mov_b32 v168, 0
    s_waitcnt vmcnt(0)
    v_cndmask_b32 v169, 0, v169, vcc
    v_readfirstlane_b32 s20, v3
    s_and_b32 s21, s22, 1
    s_lshl_b32 s21, s21, 20
    s_lshl_b32 s26, s18, 14
    s_add_u32 s26, s26, s21
    s_add_u32 s26, s26, 67108864
    s_lshr_b32 s20, s20, 15
    s_cmp_gt_u32 s20, s100
    s_cselect_b32 s20, 8192, 0
    s_add_u32 s26, s26, s20
    s_bfe_u32 s20, s18, 0x10001
    s_lshl_b32 s20, s20, 12
    s_add_u32 s26, s26, s20
    s_add_u32 s48, s26, 524288
    s_lshr_b32 s20, s16, 1
    s_lshl_b32 s20, s20, 11
    s_xor_b32 s27, s26, 4096
    s_add_u32 s27, s27, s20
    s_add_u32 s49, s27, 524288
    s_lshl_b32 s20, s16, 10
    s_add_u32 s26, s26, s20
    s_add_u32 s48, s48, s20
    v_add_u32 v171, s20, v2
mega_kernel_x_dr:
    buffer_load_dword v3, v13, s[84:87], 0 offen sc1
    s_waitcnt vmcnt(0)
    v_cmp_gt_u32 vcc, s22, v3
    s_cbranch_vccz mega_kernel_x_dp
    s_sleep 2
    s_branch mega_kernel_x_dr
mega_kernel_x_dp:
    buffer_load_dwordx2 v[136:137], v170, s[84:87], s26 offen offset:0 sc1
    buffer_load_dwordx2 v[138:139], v170, s[84:87], s26 offen offset:512 sc1
    buffer_load_dwordx2 v[140:141], v170, s[84:87], s48 offen offset:0 sc1
    buffer_load_dwordx2 v[142:143], v170, s[84:87], s48 offen offset:512 sc1
    s_waitcnt vmcnt(0)
    v_mfma_f32_16x16x16_bf16 v[172:175], v[136:137], v[168:169], 0
    v_mfma_f32_16x16x16_bf16 v[176:179], v[138:139], v[168:169], 0
    v_mfma_f32_16x16x16_bf16 v[172:175], v[140:141], v[168:169], v[172:175]
    v_mfma_f32_16x16x16_bf16 v[176:179], v[142:143], v[168:169], v[176:179]
    v_or3_b32 v3, v136, v138, v140
    v_or_b32 v3, v3, v142
    v_and_b32 v3, 1, v3
    v_cmp_ne_u32 vcc, 0, v3
    s_nop 3
    s_cbranch_vccnz mega_kernel_x_dp
    v_cvt_pk_bf16_f32 v136, v172, v173
    v_cvt_pk_bf16_f32 v137, v174, v175
    v_cvt_pk_bf16_f32 v138, v176, v177
    v_cvt_pk_bf16_f32 v139, v178, v179
    ds_write_b128 v171, v[136:139] offset:20480
    s_waitcnt lgkmcnt(0)
    s_barrier
    ds_read_b128 v[88:91], v2 offset:20480
    ds_read_b128 v[92:95], v2 offset:21504
    ds_read_b128 v[96:99], v2 offset:22528
    ds_read_b128 v[100:103], v2 offset:23552
mega_kernel_x_dv:
    buffer_load_dwordx2 v[104:105], v170, s[84:87], s27 offen offset:0 sc1
    buffer_load_dwordx2 v[106:107], v170, s[84:87], s49 offen offset:0 sc1
    buffer_load_dwordx2 v[108:109], v170, s[84:87], s27 offen offset:1024 sc1
    buffer_load_dwordx2 v[110:111], v170, s[84:87], s49 offen offset:1024 sc1
    s_waitcnt vmcnt(0) lgkmcnt(0)
    v_or3_b32 v3, v104, v106, v108
    v_or_b32 v3, v3, v110
    v_and_b32 v3, 1, v3
    v_cmp_ne_u32 vcc, 0, v3
    s_cbranch_vccnz mega_kernel_x_dv
    s_branch mega_kernel_x_rd
mega_kernel_x_fin:
mega_kernel_cE:
    s_endpgm
.section .rodata,"a"
.p2align 6
.amdhsa_kernel mega_kernel
  .amdhsa_next_free_vgpr 512
  .amdhsa_next_free_sgpr 102
  .amdhsa_accum_offset 256
  .amdhsa_group_segment_fixed_size 0
  .amdhsa_kernarg_size 104
  .amdhsa_user_sgpr_count 2
  .amdhsa_user_sgpr_kernarg_segment_ptr 1
  .amdhsa_system_sgpr_workgroup_id_x 1
.end_amdhsa_kernel
```

```asm
; @launch kernel=mega_kernel grid=(256,1,1) block=(256,1,1) lds=161792
.amdgcn_target "amdgcn-amd-amdhsa--gfx950"
.text
.globl mega_kernel
.p2align 8
.type mega_kernel,@function
mega_kernel:
    s_cmp_ge_u32 s2, 256
    s_cbranch_scc1 mega_kernel_exit
    s_load_dwordx2 s[84:85], s[0:1], 96
    s_load_dwordx2 s[88:89], s[0:1], 88
    s_getreg_b32 s93, hwreg(HW_REG_XCC_ID)
    s_and_b32 s93, s93, 7
    s_lshl_b32 s93, s93, 2
    s_lshr_b32 s93, 0x76541032, s93
    s_and_b32 s93, s93, 7
    v_lshrrev_b32 v1, 6, v0
    v_mov_b32 v4, 0
    v_readfirstlane_b32 s80, v1
    v_mov_b32 v5, 0
    v_mov_b32 v6, 0
    v_mov_b32 v7, 0
    s_mov_b32 s83, 0
    s_lshl_b32 s101, s2, 2
    s_add_u32 s101, s101, s80
    s_lshl_b32 s101, s101, 8
    s_add_u32 s101, s101, 230686720
    s_waitcnt lgkmcnt(0)
    s_mov_b32 s86, 268435456
    s_mov_b32 s87, 0x00020000
    s_mov_b32 s90, 256
    s_mov_b32 s91, 0x00020000
    s_mov_b32 s98, s80
    s_cmp_lg_u32 s80, 0
    s_cbranch_scc1 mega_kernel_st0
    v_mov_b32 v10, 1
    s_lshl_b32 s81, s93, 5
    s_mov_b64 exec, 1
    buffer_atomic_add v10, off, s[88:91], s81 offset:4 sc0
    s_lshl_b32 s81, s2, 7
    s_add_u32 s81, s81, 71303168
    s_mov_b64 exec, 3
    v_lshlrev_b32 v1, 15, v0
    buffer_store_dword v4, v1, s[84:87], s81 offen sc1
    s_mov_b64 exec, -1
mega_kernel_st0:
    s_load_dwordx2 s[72:73], s[0:1], 8
    v_mov_b32 v4, 0
    v_mov_b32 v5, 0
    v_mov_b32 v6, 0
    v_mov_b32 v7, 0
    v_lshlrev_b32 v1, 4, v0
    s_lshl_b32 s81, s2, 13
    s_add_u32 s81, s81, 67108864
    s_add_u32 s79, s81, 4096
    buffer_store_dwordx4 v[4:7], v1, s[84:87], s81 offen sc1
    buffer_store_dwordx4 v[4:7], v1, s[84:87], s79 offen sc1
    s_lshl_b32 s81, s2, 12
    s_add_u32 s81, s81, 70254592
    buffer_store_dwordx4 v[4:7], v1, s[84:87], s81 offen sc1
    s_cmp_ge_u32 s2, 64
    s_cbranch_scc1 mega_kernel_gi
    v_bfe_u32 v2, v0, 3, 1
    v_lshlrev_b32 v2, 11, v2
    v_and_b32 v3, 3, v0
    v_lshl_add_u32 v2, v3, 5, v2
    v_bfe_u32 v3, v0, 4, 3
    v_lshl_add_u32 v2, v3, 2, v2
    v_bfe_u32 v3, v0, 2, 1
    v_lshl_add_u32 v2, v3, 1, v2
    s_lshr_b32 s81, s2, 2
    s_lshl_b32 s81, s81, 7
    s_and_b32 s79, s2, 3
    s_lshl_b32 s79, s79, 12
    s_add_u32 s81, s81, s79
    s_waitcnt lgkmcnt(0)
    s_mov_b32 s74, 16384
    s_mov_b32 s75, 0x00020000
    buffer_load_ushort v8, v2, s[72:75], s81 offen
    v_mov_b32 v9, -1
    v_and_b32 v1, 31, v0
    v_lshlrev_b32 v1, 1, v1
    v_bfe_u32 v3, v0, 5, 2
    v_lshl_add_u32 v1, v3, 8, v1
    v_lshrrev_b32 v3, 7, v0
    v_lshl_add_u32 v1, v3, 14, v1
    v_cmp_gt_u32 vcc, 128, v0
    s_lshr_b32 s81, s2, 2
    s_lshl_b32 s81, s81, 10
    s_and_b32 s79, s2, 3
    s_lshl_b32 s79, s79, 6
    s_add_u32 s81, s81, s79
    s_add_u32 s81, s81, 69206016
    s_waitcnt vmcnt(0)
    v_min_u32 v8, 0xfffe, v8
    v_cndmask_b32 v8, v9, v8, vcc
    buffer_store_short v8, v1, s[84:87], s81 offen sc1
mega_kernel_gi:
    s_waitcnt lgkmcnt(0)
    s_cmp_lg_u32 s80, 0
    s_cbranch_scc1 mega_kernel_st1
    s_mov_b64 exec, 1
    s_waitcnt vmcnt(4)
    ds_write_b32 v4, v10
    s_mov_b64 exec, -1
    s_waitcnt lgkmcnt(0)
mega_kernel_st1:
    s_barrier
    ds_read_b32 v2, v4
    s_waitcnt lgkmcnt(0)
    v_readfirstlane_b32 s94, v2
    s_barrier
    s_sub_u32 s81, s93, 2
    s_cmp_ge_u32 s81, 2
    s_cbranch_scc1 mega_kernel_nopr
    s_cmp_lg_u32 s80, 0
    s_cbranch_scc1 mega_kernel_prd
    v_lshlrev_b32 v1, 4, v0
    s_and_b32 s81, s2, 127
    s_lshl_b32 s81, s81, 14
    s_add_u32 s81, s81, 67108864
    s_add_u32 s77, s81, 8192
    buffer_store_dwordx4 v[4:7], v1, s[84:87], s81 offen sc1
    buffer_store_dwordx4 v[4:7], v1, s[84:87], s77 offen sc1
    s_waitcnt vmcnt(0)
    s_memtime s[70:71]
    buffer_store_dwordx4 v[4:7], v1, s[84:87], s81 offen sc1
    s_waitcnt vmcnt(0)
    s_memtime s[72:73]
    buffer_store_dwordx4 v[4:7], v1, s[84:87], s77 offen sc1
    s_waitcnt vmcnt(0)
    buffer_store_dwordx4 v[4:7], v1, s[84:87], s77 offen sc1
    s_waitcnt vmcnt(0)
    s_memtime s[74:75]
    buffer_store_dwordx4 v[4:7], v1, s[84:87], s81 offen sc1
    s_waitcnt vmcnt(0)
    s_memtime s[76:77]
    s_waitcnt lgkmcnt(0)
    s_sub_u32 s76, s76, s74
    s_sub_u32 s74, s74, s72
    s_sub_u32 s72, s72, s70
    s_add_u32 s72, s72, s76
    s_cmp_lt_u32 s74, s72
    s_cselect_b32 s81, 0x10001, 1
    v_mov_b32 v8, s81
    s_mov_b64 exec, 1
    buffer_atomic_add v8, off, s[88:91], 0 offset:204 sc1
    s_mov_b64 exec, -1
mega_kernel_prd:
    s_barrier
mega_kernel_nopr:
    s_mov_b32 s97, 0
    s_mov_b32 s100, 64
mega_kernel_fast:
    s_mov_b32 s96, 1
    s_mov_b32 s30, s93
    s_and_b32 s31, s94, 31
    s_cmp_lt_u32 s93, 2
    s_cbranch_scc1 mega_kernel_recf
    s_sub_u32 s92, s93, 2
    s_lshl_b32 s92, s92, 5
    s_add_u32 s92, s92, s31
    s_branch mega_kernel_bulk
mega_kernel_redo:
    s_waitcnt vmcnt(0) lgkmcnt(0)
    s_barrier
    v_readlane_b32 s100, v36, 2
    v_readlane_b32 s81, v36, 3
    s_mov_b32 s97, 1
    s_nop 2
    s_add_u32 s100, s100, s81
    s_mov_b32 s95, s94
    v_readlane_b32 s81, v36, 0
    s_cmp_gt_u32 s93, 0
    s_nop 2
    s_cselect_b32 s81, s81, 0
    s_add_u32 s95, s95, s81
    v_readlane_b32 s81, v36, 1
    s_cmp_gt_u32 s93, 1
    s_nop 2
    s_cselect_b32 s81, s81, 0
    s_add_u32 s95, s95, s81
    v_readlane_b32 s81, v36, 2
    s_cmp_gt_u32 s93, 2
    s_nop 2
    s_cselect_b32 s81, s81, 0
    s_add_u32 s95, s95, s81
    v_readlane_b32 s81, v36, 3
    s_cmp_gt_u32 s93, 3
    s_nop 2
    s_cselect_b32 s81, s81, 0
    s_add_u32 s95, s95, s81
    v_readlane_b32 s81, v36, 4
    s_cmp_gt_u32 s93, 4
    s_nop 2
    s_cselect_b32 s81, s81, 0
    s_add_u32 s95, s95, s81
    v_readlane_b32 s81, v36, 5
    s_cmp_gt_u32 s93, 5
    s_nop 2
    s_cselect_b32 s81, s81, 0
    s_add_u32 s95, s95, s81
    v_readlane_b32 s81, v36, 6
    s_cmp_gt_u32 s93, 6
    s_nop 2
    s_cselect_b32 s81, s81, 0
    s_add_u32 s95, s95, s81
mega_kernel_slow:
    s_mov_b32 s96, 0
    s_lshr_b32 s30, s95, 5
    s_and_b32 s31, s95, 31
    s_cmp_lt_u32 s95, 64
    s_cbranch_scc1 mega_kernel_recs
    s_sub_u32 s92, s95, 64
    s_branch mega_kernel_bulk
mega_kernel_exit:
    s_endpgm
mega_kernel_recf:
    s_load_dwordx2 s[4:5], s[0:1], 96
    s_load_dwordx2 s[12:13], s[0:1], 88
    s_load_dwordx2 s[50:51], s[0:1], 16
    s_load_dwordx2 s[52:53], s[0:1], 24
    s_load_dwordx2 s[54:55], s[0:1], 32
    s_load_dwordx2 s[56:57], s[0:1], 40
    s_load_dwordx2 s[58:59], s[0:1], 8
    v_lshrrev_b32 v3, 6, v0
    v_and_b32 v40, 63, v0
    v_readfirstlane_b32 s20, v3
    v_lshrrev_b32 v41, 4, v40
    v_and_b32 v42, 15, v40
    v_lshlrev_b32 v1, 4, v40
    s_mov_b32 s49, 0
    s_waitcnt lgkmcnt(0)
    s_mov_b32 s6, 268435456
    s_mov_b32 s7, 0x00020000
    s_mov_b32 s14, 256
    s_mov_b32 s15, 0x00020000
    s_mov_b32 s10, 8388608
    s_mov_b32 s11, 0x00020000
    s_mov_b32 s26, 0x00030003
    s_mov_b32 s27, 0x00030003
    s_mov_b32 s28, 0xcccccccc
    s_mov_b32 s29, 0xcccccccc
    s_mov_b32 s32, 0x33333333
    s_mov_b32 s33, 0x33333333
    s_mov_b32 s34, 0x3e0293ee
    s_lshl_b32 s22, s20, 2
    v_xor_b32 v3, s22, v42
    v_lshlrev_b32 v3, 4, v3
    v_lshl_add_u32 v4, v41, 4, s20
    v_lshl_add_u32 v44, v4, 13, v3
    s_lshl_b32 s22, s30, 22
    s_lshl_b32 s23, s31, 8
    s_add_u32 s22, s22, s23
    v_add_u32 v44, s22, v44
    s_lshr_b32 s22, s20, 1
    s_lshl_b32 s22, s22, 5
    s_and_b32 s23, s20, 1
    s_lshl_b32 s23, s23, 2
    s_add_u32 s22, s22, s23
    s_lshl_b32 s23, s31, 7
    s_add_u32 s22, s22, s23
    v_add_u32 v4, s22, v41
    v_lshl_add_u32 v45, v4, 11, v3
    s_lshl_b32 s22, s30, 10
    v_add_u32 v45, s22, v45
    s_lshl_b32 s48, s20, 10
    s_mov_b32 s8, s50
    s_mov_b32 s9, s51
    s_add_u32 m0, s48, 0
    s_mov_b32 s22, 0
    buffer_load_dwordx4 v44, s[8:11], s22 offen  lds
    s_add_u32 m0, s48, 4096
    s_mov_b32 s22, 32768
    buffer_load_dwordx4 v44, s[8:11], s22 offen  lds
    s_add_u32 m0, s48, 8192
    s_mov_b32 s22, 65536
    buffer_load_dwordx4 v44, s[8:11], s22 offen  lds
    s_add_u32 m0, s48, 12288
    s_mov_b32 s22, 98304
    buffer_load_dwordx4 v44, s[8:11], s22 offen  lds
    s_add_u32 m0, s48, 16384
    s_mov_b32 s22, 524288
    buffer_load_dwordx4 v44, s[8:11], s22 offen  lds
    s_add_u32 m0, s48, 20480
    s_mov_b32 s22, 557056
    buffer_load_dwordx4 v44, s[8:11], s22 offen  lds
    s_add_u32 m0, s48, 24576
    s_mov_b32 s22, 589824
    buffer_load_dwordx4 v44, s[8:11], s22 offen  lds
    s_add_u32 m0, s48, 28672
    s_mov_b32 s22, 622592
    buffer_load_dwordx4 v44, s[8:11], s22 offen  lds
    s_add_u32 m0, s48, 32768
    s_mov_b32 s22, 1048576
    buffer_load_dwordx4 v44, s[8:11], s22 offen  lds
    s_add_u32 m0, s48, 36864
    s_mov_b32 s22, 1081344
    buffer_load_dwordx4 v44, s[8:11], s22 offen  lds
    s_add_u32 m0, s48, 40960
    s_mov_b32 s22, 1114112
    buffer_load_dwordx4 v44, s[8:11], s22 offen  lds
    s_add_u32 m0, s48, 45056
    s_mov_b32 s22, 1146880
    buffer_load_dwordx4 v44, s[8:11], s22 offen  lds
    s_waitcnt vmcnt(12)
    s_barrier
    s_or_b32 s81, s97, s98
    s_cmp_lg_u32 s81, 0
    s_cbranch_scc1 mega_kernel_h0_1
    s_lshl_b32 s81, s93, 5
    v_mov_b32 v38, 1
    s_mov_b64 exec, 1
    buffer_atomic_add v38, off, s[88:91], s81 sc1
    s_mov_b64 exec, -1
mega_kernel_h0_1:
    s_add_u32 m0, s48, 49152
    s_mov_b32 s22, 1572864
    buffer_load_dwordx4 v44, s[8:11], s22 offen  lds
    s_add_u32 m0, s48, 53248
    s_mov_b32 s22, 1605632
    buffer_load_dwordx4 v44, s[8:11], s22 offen  lds
    s_add_u32 m0, s48, 57344
    s_mov_b32 s22, 1638400
    buffer_load_dwordx4 v44, s[8:11], s22 offen  lds
    s_add_u32 m0, s48, 61440
    s_mov_b32 s22, 1671168
    buffer_load_dwordx4 v44, s[8:11], s22 offen  lds
    s_add_u32 m0, s48, 65536
    s_mov_b32 s22, 2097152
    buffer_load_dwordx4 v44, s[8:11], s22 offen  lds
    s_add_u32 m0, s48, 69632
    s_mov_b32 s22, 2129920
    buffer_load_dwordx4 v44, s[8:11], s22 offen  lds
    s_add_u32 m0, s48, 73728
    s_mov_b32 s22, 2162688
    buffer_load_dwordx4 v44, s[8:11], s22 offen  lds
    s_add_u32 m0, s48, 77824
    s_mov_b32 s22, 2195456
    buffer_load_dwordx4 v44, s[8:11], s22 offen  lds
    s_add_u32 m0, s48, 81920
    s_mov_b32 s22, 2621440
    buffer_load_dwordx4 v44, s[8:11], s22 offen  lds
    s_add_u32 m0, s48, 86016
    s_mov_b32 s22, 2654208
    buffer_load_dwordx4 v44, s[8:11], s22 offen  lds
    s_add_u32 m0, s48, 90112
    s_mov_b32 s22, 2686976
    buffer_load_dwordx4 v44, s[8:11], s22 offen  lds
    s_add_u32 m0, s48, 94208
    s_mov_b32 s22, 2719744
    buffer_load_dwordx4 v44, s[8:11], s22 offen  lds
    s_add_u32 m0, s48, 98304
    s_mov_b32 s22, 3145728
    buffer_load_dwordx4 v44, s[8:11], s22 offen  lds
    s_add_u32 m0, s48, 102400
    s_mov_b32 s22, 3178496
    buffer_load_dwordx4 v44, s[8:11], s22 offen  lds
    s_add_u32 m0, s48, 106496
    s_mov_b32 s22, 3211264
    buffer_load_dwordx4 v44, s[8:11], s22 offen  lds
    s_add_u32 m0, s48, 110592
    s_mov_b32 s22, 3244032
    buffer_load_dwordx4 v44, s[8:11], s22 offen  lds
    s_add_u32 m0, s48, 114688
    s_mov_b32 s22, 3670016
    buffer_load_dwordx4 v44, s[8:11], s22 offen  lds
    s_add_u32 m0, s48, 118784
    s_mov_b32 s22, 3702784
    buffer_load_dwordx4 v44, s[8:11], s22 offen  lds
    s_add_u32 m0, s48, 122880
    s_mov_b32 s22, 3735552
    buffer_load_dwordx4 v44, s[8:11], s22 offen  lds
    s_add_u32 m0, s48, 126976
    s_mov_b32 s22, 3768320
    buffer_load_dwordx4 v44, s[8:11], s22 offen  lds
    s_lshl_b32 s22, s30, 5
    s_add_u32 s22, s22, s31
    s_lshl_b32 s38, s22, 14
    s_xor_b32 s22, s22, 32
    s_lshl_b32 s37, s22, 14
    s_add_u32 s38, s38, 67108864
    s_add_u32 s37, s37, 67108864
    s_lshl_b32 s46, s30, 19
    s_add_u32 s46, s46, 70254592
    s_mul_i32 s22, s31, 8448
    s_add_u32 s47, s46, s22
    s_mul_i32 s22, s20, 67584
    s_add_u32 s46, s46, s22
    s_lshl_b32 s22, s31, 6
    s_add_u32 s46, s46, s22
    s_add_u32 s61, s46, 33792
    s_mul_i32 s22, s20, 2048
    s_add_u32 s25, s47, s22
    s_lshl_b32 s35, s30, 13
    s_add_u32 s35, s35, 69206016
    v_lshrrev_b32 v53, 2, v42
    v_lshlrev_b32 v53, 1, v53
    v_and_b32 v54, 1, v42
    v_add_u32 v55, v53, v54
    v_mov_b32 v14, 0
    v_mov_b32 v15, 0
    v_mov_b32 v2, 0x4444
    v_mov_b32 v3, 0xeeee
    v_cndmask_b32 v2, v2, v3, s[28:29]
    s_lshl_b32 s22, s20, 12
    v_add_u32 v32, s22, v1
    v_add_u32 v33, 0x10000, v32
    v_add_u32 v5, 0x10000, v1
    v_add_u32 v6, 131072, v1
    v_and_b32 v3, 3, v42
    v_bfe_u32 v43, v40, 1, 1
    v_lshlrev_b32 v7, 13, v43
    v_and_b32 v43, 1, v40
    v_lshl_add_u32 v7, v43, 7, v7
    s_lshl_b32 s22, s31, 8
    s_add_u32 s23, s22, 71311360
    v_add_u32 v7, s23, v7
    s_cmp_lg_u32 s20, 0
    s_cbranch_scc1 mega_kernel_rf_flk
    s_lshl_b32 s23, s30, 7
    s_add_u32 s22, s22, s23
    s_add_u32 s22, s22, 71327744
    v_bfrev_b32 v7, 1
    v_writelane_b32 v7, s22, 0
mega_kernel_rf_flk:
    v_lshlrev_b32 v11, 3, v40
    v_lshlrev_b32 v10, 8, v55
    v_lshl_add_u32 v10, v41, 4, v10
    v_mul_u32_u24 v8, 8448, v41
    v_lshl_add_u32 v8, v3, 4, v8
    v_lshrrev_b32 v4, 2, v42
    v_mul_u32_u24 v4, 2048, v4
    v_add_u32 v8, v4, v8
    v_lshrrev_b32 v9, 1, v41
    v_lshlrev_b32 v9, 5, v9
    v_and_b32 v4, 1, v42
    v_lshl_add_u32 v9, v4, 4, v9
    v_and_b32 v4, 1, v41
    v_lshl_add_u32 v9, v4, 3, v9
    s_lshr_b32 s22, s31, 2
    s_lshl_b32 s22, s22, 10
    s_and_b32 s23, s31, 3
    s_lshl_b32 s23, s23, 6
    s_add_u32 s22, s22, s23
    v_add_u32 v9, s22, v9
    v_lshrrev_b32 v4, 2, v42
    v_lshlrev_b32 v12, 8, v4
    v_lshl_add_u32 v12, v41, 6, v12
    v_lshl_add_u32 v12, v3, 4, v12
    v_lshlrev_b32 v13, 6, v41
    v_lshl_add_u32 v13, v42, 2, v13
    v_cmp_eq_u32 vcc, 0, v3
    v_mov_b32 v28, 0x3f803f80
    v_mov_b32 v29, 0x3f803f80
    v_cndmask_b32 v34, 0, 1, vcc
    v_mov_b32 v30, 0x3f803f80
    v_mov_b32 v31, 0x3f803f80
    v_and_b32 v49, 1, v42
    v_lshlrev_b32 v49, 4, v49
    v_mov_b32 v50, 0x3f80
    v_lshlrev_b32 v50, v49, v50
    v_lshrrev_b32 v51, 2, v42
    v_cmp_eq_u32 vcc, v51, v41
    v_mov_b32 v24, v50
    v_cndmask_b32 v52, 0, v50, s[28:29]
    v_cndmask_b32 v53, 0, v50, s[32:33]
    v_cndmask_b32 v16, 0, v52, vcc
    v_cndmask_b32 v17, 0, v53, vcc
    v_mov_b32 v25, v50
    v_mov_b32 v26, v50
    v_mov_b32 v27, v50
    v_bfe_u32 v60, v40, 3, 1
    v_bfe_u32 v49, v40, 2, 1
    v_and_b32 v50, 1, v41
    v_lshrrev_b32 v51, 1, v41
    v_lshlrev_b32 v52, 3, v60
    v_lshl_add_u32 v52, v50, 2, v52
    v_lshl_add_u32 v53, v51, 4, v52
    v_add_u32 v53, v53, v49
    v_and_b32 v54, 3, v40
    s_lshl_b32 s22, s20, 2
    v_add_u32 v55, s22, v54
    v_xor_b32 v55, v55, v52
    v_lshlrev_b32 v55, 4, v55
    v_lshl_add_u32 v46, v53, 8, v55
    v_lshlrev_b32 v55, 4, v52
    v_lshl_add_u32 v55, v54, 3, v55
    v_lshl_add_u32 v47, v53, 8, v55
    s_waitcnt vmcnt(28)
    s_barrier
    v_add_u32 v48, 0, v46
    ds_read_b64_tr_b16 a[0:1], v48 offset:0
    ds_read_b64_tr_b16 a[2:3], v48 offset:512
    ds_read_b64_tr_b16 a[4:5], v48 offset:8192
    ds_read_b64_tr_b16 a[6:7], v48 offset:8704
    ds_read_b64_tr_b16 a[8:9], v48 offset:8
    ds_read_b64_tr_b16 a[10:11], v48 offset:520
    ds_read_b64_tr_b16 a[12:13], v48 offset:8200
    ds_read_b64_tr_b16 a[14:15], v48 offset:8712
    s_waitcnt lgkmcnt(0)
    s_barrier
    s_mov_b32 s8, s52
    s_mov_b32 s9, s53
    s_add_u32 m0, s48, 0
    s_mov_b32 s22, 0
    buffer_load_dwordx4 v44, s[8:11], s22 offen  lds
    s_add_u32 m0, s48, 4096
    s_mov_b32 s22, 32768
    buffer_load_dwordx4 v44, s[8:11], s22 offen  lds
    s_add_u32 m0, s48, 8192
    s_mov_b32 s22, 65536
    buffer_load_dwordx4 v44, s[8:11], s22 offen  lds
    s_add_u32 m0, s48, 12288
    s_mov_b32 s22, 98304
    buffer_load_dwordx4 v44, s[8:11], s22 offen  lds
    s_waitcnt vmcnt(28)
    s_barrier
    v_add_u32 v48, 16384, v46
    ds_read_b64_tr_b16 a[16:17], v48 offset:0
    ds_read_b64_tr_b16 a[18:19], v48 offset:512
    ds_read_b64_tr_b16 a[20:21], v48 offset:8192
    ds_read_b64_tr_b16 a[22:23], v48 offset:8704
    ds_read_b64_tr_b16 a[24:25], v48 offset:8
    ds_read_b64_tr_b16 a[26:27], v48 offset:520
    ds_read_b64_tr_b16 a[28:29], v48 offset:8200
    ds_read_b64_tr_b16 a[30:31], v48 offset:8712
    s_waitcnt lgkmcnt(0)
    s_barrier
    s_add_u32 m0, s48, 16384
    s_mov_b32 s22, 524288
    buffer_load_dwordx4 v44, s[8:11], s22 offen  lds
    s_add_u32 m0, s48, 20480
    s_mov_b32 s22, 557056
    buffer_load_dwordx4 v44, s[8:11], s22 offen  lds
    s_add_u32 m0, s48, 24576
    s_mov_b32 s22, 589824
    buffer_load_dwordx4 v44, s[8:11], s22 offen  lds
    s_add_u32 m0, s48, 28672
    s_mov_b32 s22, 622592
    buffer_load_dwordx4 v44, s[8:11], s22 offen  lds
    s_waitcnt vmcnt(28)
    s_barrier
    v_add_u32 v48, 32768, v46
    ds_read_b64_tr_b16 a[32:33], v48 offset:0
    ds_read_b64_tr_b16 a[34:35], v48 offset:512
    ds_read_b64_tr_b16 a[36:37], v48 offset:8192
    ds_read_b64_tr_b16 a[38:39], v48 offset:8704
    ds_read_b64_tr_b16 a[40:41], v48 offset:8
    ds_read_b64_tr_b16 a[42:43], v48 offset:520
    ds_read_b64_tr_b16 a[44:45], v48 offset:8200
    ds_read_b64_tr_b16 a[46:47], v48 offset:8712
    s_waitcnt lgkmcnt(0)
    s_barrier
    s_add_u32 m0, s48, 32768
    s_mov_b32 s22, 1048576
    buffer_load_dwordx4 v44, s[8:11], s22 offen  lds
    s_add_u32 m0, s48, 36864
    s_mov_b32 s22, 1081344
    buffer_load_dwordx4 v44, s[8:11], s22 offen  lds
    s_add_u32 m0, s48, 40960
    s_mov_b32 s22, 1114112
    buffer_load_dwordx4 v44, s[8:11], s22 offen  lds
    s_add_u32 m0, s48, 45056
    s_mov_b32 s22, 1146880
    buffer_load_dwordx4 v44, s[8:11], s22 offen  lds
    s_waitcnt vmcnt(28)
    s_barrier
    v_add_u32 v48, 49152, v46
    ds_read_b64_tr_b16 a[48:49], v48 offset:0
    ds_read_b64_tr_b16 a[50:51], v48 offset:512
    ds_read_b64_tr_b16 a[52:53], v48 offset:8192
    ds_read_b64_tr_b16 a[54:55], v48 offset:8704
    ds_read_b64_tr_b16 a[56:57], v48 offset:8
    ds_read_b64_tr_b16 a[58:59], v48 offset:520
    ds_read_b64_tr_b16 a[60:61], v48 offset:8200
    ds_read_b64_tr_b16 a[62:63], v48 offset:8712
    s_waitcnt lgkmcnt(0)
    s_barrier
    s_add_u32 m0, s48, 49152
    s_mov_b32 s22, 1572864
    buffer_load_dwordx4 v44, s[8:11], s22 offen  lds
    s_add_u32 m0, s48, 53248
    s_mov_b32 s22, 1605632
    buffer_load_dwordx4 v44, s[8:11], s22 offen  lds
    s_add_u32 m0, s48, 57344
    s_mov_b32 s22, 1638400
    buffer_load_dwordx4 v44, s[8:11], s22 offen  lds
    s_add_u32 m0, s48, 61440
    s_mov_b32 s22, 1671168
    buffer_load_dwordx4 v44, s[8:11], s22 offen  lds
    s_waitcnt vmcnt(28)
    s_barrier
    v_add_u32 v48, 65536, v46
    ds_read_b64_tr_b16 a[64:65], v48 offset:0
    ds_read_b64_tr_b16 a[66:67], v48 offset:512
    ds_read_b64_tr_b16 a[68:69], v48 offset:8192
    ds_read_b64_tr_b16 a[70:71], v48 offset:8704
    ds_read_b64_tr_b16 a[72:73], v48 offset:8
    ds_read_b64_tr_b16 a[74:75], v48 offset:520
    ds_read_b64_tr_b16 a[76:77], v48 offset:8200
    ds_read_b64_tr_b16 a[78:79], v48 offset:8712
    s_waitcnt lgkmcnt(0)
    s_barrier
    s_add_u32 m0, s48, 65536
    s_mov_b32 s22, 2097152
    buffer_load_dwordx4 v44, s[8:11], s22 offen  lds
    s_add_u32 m0, s48, 69632
    s_mov_b32 s22, 2129920
    buffer_load_dwordx4 v44, s[8:11], s22 offen  lds
    s_add_u32 m0, s48, 73728
    s_mov_b32 s22, 2162688
    buffer_load_dwordx4 v44, s[8:11], s22 offen  lds
    s_add_u32 m0, s48, 77824
    s_mov_b32 s22, 2195456
    buffer_load_dwordx4 v44, s[8:11], s22 offen  lds
    s_waitcnt vmcnt(28)
    s_barrier
    v_add_u32 v48, 81920, v46
    ds_read_b64_tr_b16 a[80:81], v48 offset:0
    ds_read_b64_tr_b16 a[82:83], v48 offset:512
    ds_read_b64_tr_b16 a[84:85], v48 offset:8192
    ds_read_b64_tr_b16 a[86:87], v48 offset:8704
    ds_read_b64_tr_b16 a[88:89], v48 offset:8
    ds_read_b64_tr_b16 a[90:91], v48 offset:520
    ds_read_b64_tr_b16 a[92:93], v48 offset:8200
    ds_read_b64_tr_b16 a[94:95], v48 offset:8712
    s_waitcnt lgkmcnt(0)
    s_barrier
    s_add_u32 m0, s48, 81920
    s_mov_b32 s22, 2621440
    buffer_load_dwordx4 v44, s[8:11], s22 offen  lds
    s_add_u32 m0, s48, 86016
    s_mov_b32 s22, 2654208
    buffer_load_dwordx4 v44, s[8:11], s22 offen  lds
    s_add_u32 m0, s48, 90112
    s_mov_b32 s22, 2686976
    buffer_load_dwordx4 v44, s[8:11], s22 offen  lds
    s_add_u32 m0, s48, 94208
    s_mov_b32 s22, 2719744
    buffer_load_dwordx4 v44, s[8:11], s22 offen  lds
    s_waitcnt vmcnt(28)
    s_barrier
    v_add_u32 v48, 98304, v46
    ds_read_b64_tr_b16 a[96:97], v48 offset:0
    ds_read_b64_tr_b16 a[98:99], v48 offset:512
    ds_read_b64_tr_b16 a[100:101], v48 offset:8192
    ds_read_b64_tr_b16 a[102:103], v48 offset:8704
    ds_read_b64_tr_b16 a[104:105], v48 offset:8
    ds_read_b64_tr_b16 a[106:107], v48 offset:520
    ds_read_b64_tr_b16 a[108:109], v48 offset:8200
    ds_read_b64_tr_b16 a[110:111], v48 offset:8712
    s_waitcnt lgkmcnt(0)
    s_barrier
    s_add_u32 m0, s48, 98304
    s_mov_b32 s22, 3145728
    buffer_load_dwordx4 v44, s[8:11], s22 offen  lds
    s_add_u32 m0, s48, 102400
    s_mov_b32 s22, 3178496
    buffer_load_dwordx4 v44, s[8:11], s22 offen  lds
    s_add_u32 m0, s48, 106496
    s_mov_b32 s22, 3211264
    buffer_load_dwordx4 v44, s[8:11], s22 offen  lds
    s_add_u32 m0, s48, 110592
    s_mov_b32 s22, 3244032
    buffer_load_dwordx4 v44, s[8:11], s22 offen  lds
    s_waitcnt vmcnt(28)
    s_barrier
    v_add_u32 v48, 114688, v46
    ds_read_b64_tr_b16 a[112:113], v48 offset:0
    ds_read_b64_tr_b16 a[114:115], v48 offset:512
    ds_read_b64_tr_b16 a[116:117], v48 offset:8192
    ds_read_b64_tr_b16 a[118:119], v48 offset:8704
    ds_read_b64_tr_b16 a[120:121], v48 offset:8
    ds_read_b64_tr_b16 a[122:123], v48 offset:520
    ds_read_b64_tr_b16 a[124:125], v48 offset:8200
    ds_read_b64_tr_b16 a[126:127], v48 offset:8712
    s_waitcnt lgkmcnt(0)
    s_barrier
    s_add_u32 m0, s48, 114688
    s_mov_b32 s22, 3670016
    buffer_load_dwordx4 v44, s[8:11], s22 offen  lds
    s_add_u32 m0, s48, 118784
    s_mov_b32 s22, 3702784
    buffer_load_dwordx4 v44, s[8:11], s22 offen  lds
    s_add_u32 m0, s48, 122880
    s_mov_b32 s22, 3735552
    buffer_load_dwordx4 v44, s[8:11], s22 offen  lds
    s_add_u32 m0, s48, 126976
    s_mov_b32 s22, 3768320
    buffer_load_dwordx4 v44, s[8:11], s22 offen  lds
    s_waitcnt vmcnt(28)
    s_barrier
    v_add_u32 v48, 0, v46
    ds_read_b64_tr_b16 a[128:129], v48 offset:0
    ds_read_b64_tr_b16 a[130:131], v48 offset:512
    ds_read_b64_tr_b16 a[132:133], v48 offset:8192
    ds_read_b64_tr_b16 a[134:135], v48 offset:8704
    ds_read_b64_tr_b16 a[136:137], v48 offset:8
    ds_read_b64_tr_b16 a[138:139], v48 offset:520
    ds_read_b64_tr_b16 a[140:141], v48 offset:8200
    ds_read_b64_tr_b16 a[142:143], v48 offset:8712
    s_waitcnt lgkmcnt(0)
    s_barrier
    s_mov_b32 s8, s56
    s_mov_b32 s9, s57
    s_add_u32 m0, s48, 0
    s_mov_b32 s22, 0
    buffer_load_dwordx4 v45, s[8:11], s22 offen  lds
    s_add_u32 m0, s48, 4096
    s_mov_b32 s22, 16384
    buffer_load_dwordx4 v45, s[8:11], s22 offen  lds
    s_add_u32 m0, s48, 8192
    s_mov_b32 s22, 32768
    buffer_load_dwordx4 v45, s[8:11], s22 offen  lds
    s_add_u32 m0, s48, 12288
    s_mov_b32 s22, 49152
    buffer_load_dwordx4 v45, s[8:11], s22 offen  lds
    s_waitcnt vmcnt(28)
    s_barrier
    v_add_u32 v48, 16384, v46
    ds_read_b64_tr_b16 a[144:145], v48 offset:0
    ds_read_b64_tr_b16 a[146:147], v48 offset:512
    ds_read_b64_tr_b16 a[148:149], v48 offset:8192
    ds_read_b64_tr_b16 a[150:151], v48 offset:8704
    ds_read_b64_tr_b16 a[152:153], v48 offset:8
    ds_read_b64_tr_b16 a[154:155], v48 offset:520
    ds_read_b64_tr_b16 a[156:157], v48 offset:8200
    ds_read_b64_tr_b16 a[158:159], v48 offset:8712
    s_waitcnt lgkmcnt(0)
    s_barrier
    s_add_u32 m0, s48, 16384
    s_mov_b32 s22, 256
    buffer_load_dwordx4 v45, s[8:11], s22 offen  lds
    s_add_u32 m0, s48, 20480
    s_mov_b32 s22, 16640
    buffer_load_dwordx4 v45, s[8:11], s22 offen  lds
    s_add_u32 m0, s48, 24576
    s_mov_b32 s22, 33024
    buffer_load_dwordx4 v45, s[8:11], s22 offen  lds
    s_add_u32 m0, s48, 28672
    s_mov_b32 s22, 49408
    buffer_load_dwordx4 v45, s[8:11], s22 offen  lds
    s_waitcnt vmcnt(28)
    s_barrier
    v_add_u32 v48, 32768, v46
    ds_read_b64_tr_b16 a[160:161], v48 offset:0
    ds_read_b64_tr_b16 a[162:163], v48 offset:512
    ds_read_b64_tr_b16 a[164:165], v48 offset:8192
    ds_read_b64_tr_b16 a[166:167], v48 offset:8704
    ds_read_b64_tr_b16 a[168:169], v48 offset:8
    ds_read_b64_tr_b16 a[170:171], v48 offset:520
    ds_read_b64_tr_b16 a[172:173], v48 offset:8200
    ds_read_b64_tr_b16 a[174:175], v48 offset:8712
    s_waitcnt lgkmcnt(0)
    s_barrier
    s_add_u32 m0, s48, 32768
    s_mov_b32 s22, 512
    buffer_load_dwordx4 v45, s[8:11], s22 offen  lds
    s_add_u32 m0, s48, 36864
    s_mov_b32 s22, 16896
    buffer_load_dwordx4 v45, s[8:11], s22 offen  lds
    s_add_u32 m0, s48, 40960
    s_mov_b32 s22, 33280
    buffer_load_dwordx4 v45, s[8:11], s22 offen  lds
    s_add_u32 m0, s48, 45056
    s_mov_b32 s22, 49664
    buffer_load_dwordx4 v45, s[8:11], s22 offen  lds
    s_waitcnt vmcnt(28)
    s_barrier
    v_add_u32 v48, 49152, v46
    ds_read_b64_tr_b16 a[176:177], v48 offset:0
    ds_read_b64_tr_b16 a[178:179], v48 offset:512
    ds_read_b64_tr_b16 a[180:181], v48 offset:8192
    ds_read_b64_tr_b16 a[182:183], v48 offset:8704
    ds_read_b64_tr_b16 a[184:185], v48 offset:8
    ds_read_b64_tr_b16 a[186:187], v48 offset:520
    ds_read_b64_tr_b16 a[188:189], v48 offset:8200
    ds_read_b64_tr_b16 a[190:191], v48 offset:8712
    s_waitcnt lgkmcnt(0)
    s_barrier
    s_add_u32 m0, s48, 49152
    s_mov_b32 s22, 768
    buffer_load_dwordx4 v45, s[8:11], s22 offen  lds
    s_add_u32 m0, s48, 53248
    s_mov_b32 s22, 17152
    buffer_load_dwordx4 v45, s[8:11], s22 offen  lds
    s_add_u32 m0, s48, 57344
    s_mov_b32 s22, 33536
    buffer_load_dwordx4 v45, s[8:11], s22 offen  lds
    s_add_u32 m0, s48, 61440
    s_mov_b32 s22, 49920
    buffer_load_dwordx4 v45, s[8:11], s22 offen  lds
    s_waitcnt vmcnt(28)
    s_barrier
    v_and_b32 v37, 7, v0
    v_lshlrev_b32 v37, 5, v37
    buffer_load_dword v36, v37, s[88:91], 0 offen sc1
    buffer_load_dword v58, off, s[12:15], 0 offset:204 sc1
    v_add_u32 v48, 65536, v46
    ds_read_b64_tr_b16 a[192:193], v48 offset:0
    ds_read_b64_tr_b16 a[194:195], v48 offset:512
    ds_read_b64_tr_b16 a[196:197], v48 offset:8192
    ds_read_b64_tr_b16 a[198:199], v48 offset:8704
    ds_read_b64_tr_b16 a[200:201], v48 offset:8
    ds_read_b64_tr_b16 a[202:203], v48 offset:520
    ds_read_b64_tr_b16 a[204:205], v48 offset:8200
    ds_read_b64_tr_b16 a[206:207], v48 offset:8712
    s_waitcnt lgkmcnt(0)
    s_barrier
    s_add_u32 m0, s48, 65536
    s_mov_b32 s22, 131072
    buffer_load_dwordx4 v45, s[8:11], s22 offen  lds
    s_add_u32 m0, s48, 69632
    s_mov_b32 s22, 147456
    buffer_load_dwordx4 v45, s[8:11], s22 offen  lds
    s_add_u32 m0, s48, 73728
    s_mov_b32 s22, 163840
    buffer_load_dwordx4 v45, s[8:11], s22 offen  lds
    s_add_u32 m0, s48, 77824
    s_mov_b32 s22, 180224
    buffer_load_dwordx4 v45, s[8:11], s22 offen  lds
    s_waitcnt vmcnt(28)
    s_barrier
    v_add_u32 v48, 81920, v46
    ds_read_b64_tr_b16 a[208:209], v48 offset:0
    ds_read_b64_tr_b16 a[210:211], v48 offset:512
    ds_read_b64_tr_b16 a[212:213], v48 offset:8192
    ds_read_b64_tr_b16 a[214:215], v48 offset:8704
    ds_read_b64_tr_b16 a[216:217], v48 offset:8
    ds_read_b64_tr_b16 a[218:219], v48 offset:520
    ds_read_b64_tr_b16 a[220:221], v48 offset:8200
    ds_read_b64_tr_b16 a[222:223], v48 offset:8712
    s_waitcnt lgkmcnt(0)
    s_barrier
    s_add_u32 m0, s48, 81920
    s_mov_b32 s22, 131328
    buffer_load_dwordx4 v45, s[8:11], s22 offen  lds
    s_add_u32 m0, s48, 86016
    s_mov_b32 s22, 147712
    buffer_load_dwordx4 v45, s[8:11], s22 offen  lds
    s_add_u32 m0, s48, 90112
    s_mov_b32 s22, 164096
    buffer_load_dwordx4 v45, s[8:11], s22 offen  lds
    s_add_u32 m0, s48, 94208
    s_mov_b32 s22, 180480
    buffer_load_dwordx4 v45, s[8:11], s22 offen  lds
    s_waitcnt vmcnt(28)
    s_barrier
    v_add_u32 v48, 98304, v46
    ds_read_b64_tr_b16 a[224:225], v48 offset:0
    ds_read_b64_tr_b16 a[226:227], v48 offset:512
    ds_read_b64_tr_b16 a[228:229], v48 offset:8192
    ds_read_b64_tr_b16 a[230:231], v48 offset:8704
    ds_read_b64_tr_b16 a[232:233], v48 offset:8
    ds_read_b64_tr_b16 a[234:235], v48 offset:520
    ds_read_b64_tr_b16 a[236:237], v48 offset:8200
    ds_read_b64_tr_b16 a[238:239], v48 offset:8712
    s_waitcnt lgkmcnt(0)
    s_barrier
    s_add_u32 m0, s48, 98304
    s_mov_b32 s22, 131584
    buffer_load_dwordx4 v45, s[8:11], s22 offen  lds
    s_add_u32 m0, s48, 102400
    s_mov_b32 s22, 147968
    buffer_load_dwordx4 v45, s[8:11], s22 offen  lds
    s_add_u32 m0, s48, 106496
    s_mov_b32 s22, 164352
    buffer_load_dwordx4 v45, s[8:11], s22 offen  lds
    s_add_u32 m0, s48, 110592
    s_mov_b32 s22, 180736
    buffer_load_dwordx4 v45, s[8:11], s22 offen  lds
    s_waitcnt vmcnt(28)
    s_barrier
    v_add_u32 v48, 114688, v46
    ds_read_b64_tr_b16 a[240:241], v48 offset:0
    ds_read_b64_tr_b16 a[242:243], v48 offset:512
    ds_read_b64_tr_b16 a[244:245], v48 offset:8192
    ds_read_b64_tr_b16 a[246:247], v48 offset:8704
    ds_read_b64_tr_b16 a[248:249], v48 offset:8
    ds_read_b64_tr_b16 a[250:251], v48 offset:520
    ds_read_b64_tr_b16 a[252:253], v48 offset:8200
    ds_read_b64_tr_b16 a[254:255], v48 offset:8712
    s_waitcnt lgkmcnt(0)
    s_barrier
    s_add_u32 m0, s48, 114688
    s_mov_b32 s22, 131840
    buffer_load_dwordx4 v45, s[8:11], s22 offen  lds
    s_add_u32 m0, s48, 118784
    s_mov_b32 s22, 148224
    buffer_load_dwordx4 v45, s[8:11], s22 offen  lds
    s_add_u32 m0, s48, 122880
    s_mov_b32 s22, 164608
    buffer_load_dwordx4 v45, s[8:11], s22 offen  lds
    s_add_u32 m0, s48, 126976
    s_mov_b32 s22, 180992
    buffer_load_dwordx4 v45, s[8:11], s22 offen  lds
    s_waitcnt vmcnt(28)
    s_barrier
    s_cmp_lg_u32 s20, 0
    s_cbranch_scc1 mega_kernel_rf_wo0
    v_xor_b32 v48, 0, v47
    v_add_u32 v48, 0, v48
    ds_read_b64_tr_b16 v[128:129], v48 offset:0
    ds_read_b64_tr_b16 v[130:131], v48 offset:512
    ds_read_b64_tr_b16 v[132:133], v48 offset:8192
    ds_read_b64_tr_b16 v[134:135], v48 offset:8704
    ds_read_b64_tr_b16 v[144:145], v48 offset:32
    ds_read_b64_tr_b16 v[146:147], v48 offset:544
    ds_read_b64_tr_b16 v[148:149], v48 offset:8224
    ds_read_b64_tr_b16 v[150:151], v48 offset:8736
    s_waitcnt lgkmcnt(0)
    v_xor_b32 v48, 64, v47
    v_add_u32 v48, 0, v48
    ds_read_b64_tr_b16 v[160:161], v48 offset:0
    ds_read_b64_tr_b16 v[162:163], v48 offset:512
    ds_read_b64_tr_b16 v[164:165], v48 offset:8192
    ds_read_b64_tr_b16 v[166:167], v48 offset:8704
    ds_read_b64_tr_b16 v[176:177], v48 offset:32
    ds_read_b64_tr_b16 v[178:179], v48 offset:544
    ds_read_b64_tr_b16 v[180:181], v48 offset:8224
    ds_read_b64_tr_b16 v[182:183], v48 offset:8736
    s_waitcnt lgkmcnt(0)
    v_xor_b32 v48, 128, v47
    v_add_u32 v48, 0, v48
    ds_read_b64_tr_b16 v[192:193], v48 offset:0
    ds_read_b64_tr_b16 v[194:195], v48 offset:512
    ds_read_b64_tr_b16 v[196:197], v48 offset:8192
    ds_read_b64_tr_b16 v[198:199], v48 offset:8704
    ds_read_b64_tr_b16 v[208:209], v48 offset:32
    ds_read_b64_tr_b16 v[210:211], v48 offset:544
    ds_read_b64_tr_b16 v[212:213], v48 offset:8224
    ds_read_b64_tr_b16 v[214:215], v48 offset:8736
    s_waitcnt lgkmcnt(0)
    v_xor_b32 v48, 192, v47
    v_add_u32 v48, 0, v48
    ds_read_b64_tr_b16 v[224:225], v48 offset:0
    ds_read_b64_tr_b16 v[226:227], v48 offset:512
    ds_read_b64_tr_b16 v[228:229], v48 offset:8192
    ds_read_b64_tr_b16 v[230:231], v48 offset:8704
    ds_read_b64_tr_b16 v[240:241], v48 offset:32
    ds_read_b64_tr_b16 v[242:243], v48 offset:544
    ds_read_b64_tr_b16 v[244:245], v48 offset:8224
    ds_read_b64_tr_b16 v[246:247], v48 offset:8736
    s_waitcnt lgkmcnt(0)
mega_kernel_rf_wo0:
    s_barrier
    s_mov_b32 s8, s54
    s_mov_b32 s9, s55
    s_add_u32 m0, s48, 0
    s_mov_b32 s22, 0
    buffer_load_dwordx4 v44, s[8:11], s22 offen  lds
    s_add_u32 m0, s48, 4096
    s_mov_b32 s22, 32768
    buffer_load_dwordx4 v44, s[8:11], s22 offen  lds
    s_add_u32 m0, s48, 8192
    s_mov_b32 s22, 65536
    buffer_load_dwordx4 v44, s[8:11], s22 offen  lds
    s_add_u32 m0, s48, 12288
    s_mov_b32 s22, 98304
    buffer_load_dwordx4 v44, s[8:11], s22 offen  lds
    s_waitcnt vmcnt(28)
    s_barrier
    s_cmp_lg_u32 s20, 1
    s_cbranch_scc1 mega_kernel_rf_wo1
    v_xor_b32 v48, 0, v47
    v_add_u32 v48, 16384, v48
    ds_read_b64_tr_b16 v[128:129], v48 offset:0
    ds_read_b64_tr_b16 v[130:131], v48 offset:512
    ds_read_b64_tr_b16 v[132:133], v48 offset:8192
    ds_read_b64_tr_b16 v[134:135], v48 offset:8704
    ds_read_b64_tr_b16 v[144:145], v48 offset:32
    ds_read_b64_tr_b16 v[146:147], v48 offset:544
    ds_read_b64_tr_b16 v[148:149], v48 offset:8224
    ds_read_b64_tr_b16 v[150:151], v48 offset:8736
    s_waitcnt lgkmcnt(0)
    v_xor_b32 v48, 64, v47
    v_add_u32 v48, 16384, v48
    ds_read_b64_tr_b16 v[160:161], v48 offset:0
    ds_read_b64_tr_b16 v[162:163], v48 offset:512
    ds_read_b64_tr_b16 v[164:165], v48 offset:8192
    ds_read_b64_tr_b16 v[166:167], v48 offset:8704
    ds_read_b64_tr_b16 v[176:177], v48 offset:32
    ds_read_b64_tr_b16 v[178:179], v48 offset:544
    ds_read_b64_tr_b16 v[180:181], v48 offset:8224
    ds_read_b64_tr_b16 v[182:183], v48 offset:8736
    s_waitcnt lgkmcnt(0)
    v_xor_b32 v48, 128, v47
    v_add_u32 v48, 16384, v48
    ds_read_b64_tr_b16 v[192:193], v48 offset:0
    ds_read_b64_tr_b16 v[194:195], v48 offset:512
    ds_read_b64_tr_b16 v[196:197], v48 offset:8192
    ds_read_b64_tr_b16 v[198:199], v48 offset:8704
    ds_read_b64_tr_b16 v[208:209], v48 offset:32
    ds_read_b64_tr_b16 v[210:211], v48 offset:544
    ds_read_b64_tr_b16 v[212:213], v48 offset:8224
    ds_read_b64_tr_b16 v[214:215], v48 offset:8736
    s_waitcnt lgkmcnt(0)
    v_xor_b32 v48, 192, v47
    v_add_u32 v48, 16384, v48
    ds_read_b64_tr_b16 v[224:225], v48 offset:0
    ds_read_b64_tr_b16 v[226:227], v48 offset:512
    ds_read_b64_tr_b16 v[228:229], v48 offset:8192
    ds_read_b64_tr_b16 v[230:231], v48 offset:8704
    ds_read_b64_tr_b16 v[240:241], v48 offset:32
    ds_read_b64_tr_b16 v[242:243], v48 offset:544
    ds_read_b64_tr_b16 v[244:245], v48 offset:8224
    ds_read_b64_tr_b16 v[246:247], v48 offset:8736
    s_waitcnt lgkmcnt(0)
mega_kernel_rf_wo1:
    s_barrier
    s_add_u32 m0, s48, 16384
    s_mov_b32 s22, 524288
    buffer_load_dwordx4 v44, s[8:11], s22 offen  lds
    s_add_u32 m0, s48, 20480
    s_mov_b32 s22, 557056
    buffer_load_dwordx4 v44, s[8:11], s22 offen  lds
    s_add_u32 m0, s48, 24576
    s_mov_b32 s22, 589824
    buffer_load_dwordx4 v44, s[8:11], s22 offen  lds
    s_add_u32 m0, s48, 28672
    s_mov_b32 s22, 622592
    buffer_load_dwordx4 v44, s[8:11], s22 offen  lds
    s_waitcnt vmcnt(28)
    s_barrier
    s_cmp_lg_u32 s20, 2
    s_cbranch_scc1 mega_kernel_rf_wo2
    v_xor_b32 v48, 0, v47
    v_add_u32 v48, 32768, v48
    ds_read_b64_tr_b16 v[128:129], v48 offset:0
    ds_read_b64_tr_b16 v[130:131], v48 offset:512
    ds_read_b64_tr_b16 v[132:133], v48 offset:8192
    ds_read_b64_tr_b16 v[134:135], v48 offset:8704
    ds_read_b64_tr_b16 v[144:145], v48 offset:32
    ds_read_b64_tr_b16 v[146:147], v48 offset:544
    ds_read_b64_tr_b16 v[148:149], v48 offset:8224
    ds_read_b64_tr_b16 v[150:151], v48 offset:8736
    s_waitcnt lgkmcnt(0)
    v_xor_b32 v48, 64, v47
    v_add_u32 v48, 32768, v48
    ds_read_b64_tr_b16 v[160:161], v48 offset:0
    ds_read_b64_tr_b16 v[162:163], v48 offset:512
    ds_read_b64_tr_b16 v[164:165], v48 offset:8192
    ds_read_b64_tr_b16 v[166:167], v48 offset:8704
    ds_read_b64_tr_b16 v[176:177], v48 offset:32
    ds_read_b64_tr_b16 v[178:179], v48 offset:544
    ds_read_b64_tr_b16 v[180:181], v48 offset:8224
    ds_read_b64_tr_b16 v[182:183], v48 offset:8736
    s_waitcnt lgkmcnt(0)
    v_xor_b32 v48, 128, v47
    v_add_u32 v48, 32768, v48
    ds_read_b64_tr_b16 v[192:193], v48 offset:0
    ds_read_b64_tr_b16 v[194:195], v48 offset:512
    ds_read_b64_tr_b16 v[196:197], v48 offset:8192
    ds_read_b64_tr_b16 v[198:199], v48 offset:8704
    ds_read_b64_tr_b16 v[208:209], v48 offset:32
    ds_read_b64_tr_b16 v[210:211], v48 offset:544
    ds_read_b64_tr_b16 v[212:213], v48 offset:8224
    ds_read_b64_tr_b16 v[214:215], v48 offset:8736
    s_waitcnt lgkmcnt(0)
    v_xor_b32 v48, 192, v47
    v_add_u32 v48, 32768, v48
    ds_read_b64_tr_b16 v[224:225], v48 offset:0
    ds_read_b64_tr_b16 v[226:227], v48 offset:512
    ds_read_b64_tr_b16 v[228:229], v48 offset:8192
    ds_read_b64_tr_b16 v[230:231], v48 offset:8704
    ds_read_b64_tr_b16 v[240:241], v48 offset:32
    ds_read_b64_tr_b16 v[242:243], v48 offset:544
    ds_read_b64_tr_b16 v[244:245], v48 offset:8224
    ds_read_b64_tr_b16 v[246:247], v48 offset:8736
    s_waitcnt lgkmcnt(0)
mega_kernel_rf_wo2:
    s_barrier
    s_add_u32 m0, s48, 32768
    s_mov_b32 s22, 1048576
    buffer_load_dwordx4 v44, s[8:11], s22 offen  lds
    s_add_u32 m0, s48, 36864
    s_mov_b32 s22, 1081344
    buffer_load_dwordx4 v44, s[8:11], s22 offen  lds
    s_add_u32 m0, s48, 40960
    s_mov_b32 s22, 1114112
    buffer_load_dwordx4 v44, s[8:11], s22 offen  lds
    s_add_u32 m0, s48, 45056
    s_mov_b32 s22, 1146880
    buffer_load_dwordx4 v44, s[8:11], s22 offen  lds
    s_waitcnt vmcnt(28)
    s_barrier
    s_cmp_lg_u32 s20, 3
    s_cbranch_scc1 mega_kernel_rf_wo3
    v_xor_b32 v48, 0, v47
    v_add_u32 v48, 49152, v48
    ds_read_b64_tr_b16 v[128:129], v48 offset:0
    ds_read_b64_tr_b16 v[130:131], v48 offset:512
    ds_read_b64_tr_b16 v[132:133], v48 offset:8192
    ds_read_b64_tr_b16 v[134:135], v48 offset:8704
    ds_read_b64_tr_b16 v[144:145], v48 offset:32
    ds_read_b64_tr_b16 v[146:147], v48 offset:544
    ds_read_b64_tr_b16 v[148:149], v48 offset:8224
    ds_read_b64_tr_b16 v[150:151], v48 offset:8736
    s_waitcnt lgkmcnt(0)
    v_xor_b32 v48, 64, v47
    v_add_u32 v48, 49152, v48
    ds_read_b64_tr_b16 v[160:161], v48 offset:0
    ds_read_b64_tr_b16 v[162:163], v48 offset:512
    ds_read_b64_tr_b16 v[164:165], v48 offset:8192
    ds_read_b64_tr_b16 v[166:167], v48 offset:8704
    ds_read_b64_tr_b16 v[176:177], v48 offset:32
    ds_read_b64_tr_b16 v[178:179], v48 offset:544
    ds_read_b64_tr_b16 v[180:181], v48 offset:8224
    ds_read_b64_tr_b16 v[182:183], v48 offset:8736
    s_waitcnt lgkmcnt(0)
    v_xor_b32 v48, 128, v47
    v_add_u32 v48, 49152, v48
    ds_read_b64_tr_b16 v[192:193], v48 offset:0
    ds_read_b64_tr_b16 v[194:195], v48 offset:512
    ds_read_b64_tr_b16 v[196:197], v48 offset:8192
    ds_read_b64_tr_b16 v[198:199], v48 offset:8704
    ds_read_b64_tr_b16 v[208:209], v48 offset:32
    ds_read_b64_tr_b16 v[210:211], v48 offset:544
    ds_read_b64_tr_b16 v[212:213], v48 offset:8224
    ds_read_b64_tr_b16 v[214:215], v48 offset:8736
    s_waitcnt lgkmcnt(0)
    v_xor_b32 v48, 192, v47
    v_add_u32 v48, 49152, v48
    ds_read_b64_tr_b16 v[224:225], v48 offset:0
    ds_read_b64_tr_b16 v[226:227], v48 offset:512
    ds_read_b64_tr_b16 v[228:229], v48 offset:8192
    ds_read_b64_tr_b16 v[230:231], v48 offset:8704
    ds_read_b64_tr_b16 v[240:241], v48 offset:32
    ds_read_b64_tr_b16 v[242:243], v48 offset:544
    ds_read_b64_tr_b16 v[244:245], v48 offset:8224
    ds_read_b64_tr_b16 v[246:247], v48 offset:8736
    s_waitcnt lgkmcnt(0)
mega_kernel_rf_wo3:
    s_barrier
    s_add_u32 m0, s48, 49152
    s_mov_b32 s22, 1572864
    buffer_load_dwordx4 v44, s[8:11], s22 offen  lds
    s_add_u32 m0, s48, 53248
    s_mov_b32 s22, 1605632
    buffer_load_dwordx4 v44, s[8:11], s22 offen  lds
    s_add_u32 m0, s48, 57344
    s_mov_b32 s22, 1638400
    buffer_load_dwordx4 v44, s[8:11], s22 offen  lds
    s_add_u32 m0, s48, 61440
    s_mov_b32 s22, 1671168
    buffer_load_dwordx4 v44, s[8:11], s22 offen  lds
    s_waitcnt vmcnt(28)
    s_barrier
    s_cmp_lg_u32 s20, 0
    s_cbranch_scc1 mega_kernel_rf_wo4
    v_xor_b32 v48, 0, v47
    v_add_u32 v48, 65536, v48
    ds_read_b64_tr_b16 v[136:137], v48 offset:0
    ds_read_b64_tr_b16 v[138:139], v48 offset:512
    ds_read_b64_tr_b16 v[140:141], v48 offset:8192
    ds_read_b64_tr_b16 v[142:143], v48 offset:8704
    ds_read_b64_tr_b16 v[152:153], v48 offset:32
    ds_read_b64_tr_b16 v[154:155], v48 offset:544
    ds_read_b64_tr_b16 v[156:157], v48 offset:8224
    ds_read_b64_tr_b16 v[158:159], v48 offset:8736
    s_waitcnt lgkmcnt(0)
    v_xor_b32 v48, 64, v47
    v_add_u32 v48, 65536, v48
    ds_read_b64_tr_b16 v[168:169], v48 offset:0
    ds_read_b64_tr_b16 v[170:171], v48 offset:512
    ds_read_b64_tr_b16 v[172:173], v48 offset:8192
    ds_read_b64_tr_b16 v[174:175], v48 offset:8704
    ds_read_b64_tr_b16 v[184:185], v48 offset:32
    ds_read_b64_tr_b16 v[186:187], v48 offset:544
    ds_read_b64_tr_b16 v[188:189], v48 offset:8224
    ds_read_b64_tr_b16 v[190:191], v48 offset:8736
    s_waitcnt lgkmcnt(0)
    v_xor_b32 v48, 128, v47
    v_add_u32 v48, 65536, v48
    ds_read_b64_tr_b16 v[200:201], v48 offset:0
    ds_read_b64_tr_b16 v[202:203], v48 offset:512
    ds_read_b64_tr_b16 v[204:205], v48 offset:8192
    ds_read_b64_tr_b16 v[206:207], v48 offset:8704
    ds_read_b64_tr_b16 v[216:217], v48 offset:32
    ds_read_b64_tr_b16 v[218:219], v48 offset:544
    ds_read_b64_tr_b16 v[220:221], v48 offset:8224
    ds_read_b64_tr_b16 v[222:223], v48 offset:8736
    s_waitcnt lgkmcnt(0)
    v_xor_b32 v48, 192, v47
    v_add_u32 v48, 65536, v48
    ds_read_b64_tr_b16 v[232:233], v48 offset:0
    ds_read_b64_tr_b16 v[234:235], v48 offset:512
    ds_read_b64_tr_b16 v[236:237], v48 offset:8192
    ds_read_b64_tr_b16 v[238:239], v48 offset:8704
    ds_read_b64_tr_b16 v[248:249], v48 offset:32
    ds_read_b64_tr_b16 v[250:251], v48 offset:544
    ds_read_b64_tr_b16 v[252:253], v48 offset:8224
    ds_read_b64_tr_b16 v[254:255], v48 offset:8736
    s_waitcnt lgkmcnt(0)
mega_kernel_rf_wo4:
    s_barrier
    s_add_u32 m0, s48, 65536
    s_mov_b32 s22, 2097152
    buffer_load_dwordx4 v44, s[8:11], s22 offen  lds
    s_add_u32 m0, s48, 69632
    s_mov_b32 s22, 2129920
    buffer_load_dwordx4 v44, s[8:11], s22 offen  lds
    s_add_u32 m0, s48, 73728
    s_mov_b32 s22, 2162688
    buffer_load_dwordx4 v44, s[8:11], s22 offen  lds
    s_add_u32 m0, s48, 77824
    s_mov_b32 s22, 2195456
    buffer_load_dwordx4 v44, s[8:11], s22 offen  lds
    s_waitcnt vmcnt(28)
    s_barrier
    s_cmp_lg_u32 s20, 1
    s_cbranch_scc1 mega_kernel_rf_wo5
    v_xor_b32 v48, 0, v47
    v_add_u32 v48, 81920, v48
    ds_read_b64_tr_b16 v[136:137], v48 offset:0
    ds_read_b64_tr_b16 v[138:139], v48 offset:512
    ds_read_b64_tr_b16 v[140:141], v48 offset:8192
    ds_read_b64_tr_b16 v[142:143], v48 offset:8704
    ds_read_b64_tr_b16 v[152:153], v48 offset:32
    ds_read_b64_tr_b16 v[154:155], v48 offset:544
    ds_read_b64_tr_b16 v[156:157], v48 offset:8224
    ds_read_b64_tr_b16 v[158:159], v48 offset:8736
    s_waitcnt lgkmcnt(0)
    v_xor_b32 v48, 64, v47
    v_add_u32 v48, 81920, v48
    ds_read_b64_tr_b16 v[168:169], v48 offset:0
    ds_read_b64_tr_b16 v[170:171], v48 offset:512
    ds_read_b64_tr_b16 v[172:173], v48 offset:8192
    ds_read_b64_tr_b16 v[174:175], v48 offset:8704
    ds_read_b64_tr_b16 v[184:185], v48 offset:32
    ds_read_b64_tr_b16 v[186:187], v48 offset:544
    ds_read_b64_tr_b16 v[188:189], v48 offset:8224
    ds_read_b64_tr_b16 v[190:191], v48 offset:8736
    s_waitcnt lgkmcnt(0)
    v_xor_b32 v48, 128, v47
    v_add_u32 v48, 81920, v48
    ds_read_b64_tr_b16 v[200:201], v48 offset:0
    ds_read_b64_tr_b16 v[202:203], v48 offset:512
    ds_read_b64_tr_b16 v[204:205], v48 offset:8192
    ds_read_b64_tr_b16 v[206:207], v48 offset:8704
    ds_read_b64_tr_b16 v[216:217], v48 offset:32
    ds_read_b64_tr_b16 v[218:219], v48 offset:544
    ds_read_b64_tr_b16 v[220:221], v48 offset:8224
    ds_read_b64_tr_b16 v[222:223], v48 offset:8736
    s_waitcnt lgkmcnt(0)
    v_xor_b32 v48, 192, v47
    v_add_u32 v48, 81920, v48
    ds_read_b64_tr_b16 v[232:233], v48 offset:0
    ds_read_b64_tr_b16 v[234:235], v48 offset:512
    ds_read_b64_tr_b16 v[236:237], v48 offset:8192
    ds_read_b64_tr_b16 v[238:239], v48 offset:8704
    ds_read_b64_tr_b16 v[248:249], v48 offset:32
    ds_read_b64_tr_b16 v[250:251], v48 offset:544
    ds_read_b64_tr_b16 v[252:253], v48 offset:8224
    ds_read_b64_tr_b16 v[254:255], v48 offset:8736
    s_waitcnt lgkmcnt(0)
mega_kernel_rf_wo5:
    s_barrier
    s_add_u32 m0, s48, 81920
    s_mov_b32 s22, 2621440
    buffer_load_dwordx4 v44, s[8:11], s22 offen  lds
    s_add_u32 m0, s48, 86016
    s_mov_b32 s22, 2654208
    buffer_load_dwordx4 v44, s[8:11], s22 offen  lds
    s_add_u32 m0, s48, 90112
    s_mov_b32 s22, 2686976
    buffer_load_dwordx4 v44, s[8:11], s22 offen  lds
    s_add_u32 m0, s48, 94208
    s_mov_b32 s22, 2719744
    buffer_load_dwordx4 v44, s[8:11], s22 offen  lds
    s_waitcnt vmcnt(28)
    s_barrier
    s_cmp_lg_u32 s97, 0
    s_cbranch_scc1 mega_kernel_h2_2_ok
mega_kernel_h2_2_ev:
    v_cmp_ne_u32 vcc, 32, v36
    s_cbranch_vccz mega_kernel_h2_2_ok
    s_mov_b32 s78, 0
    v_readlane_b32 s81, v36, 0
    s_nop 3
    s_add_u32 s78, s78, s81
    v_readlane_b32 s81, v36, 1
    s_nop 3
    s_add_u32 s78, s78, s81
    v_readlane_b32 s81, v36, 2
    s_nop 3
    s_add_u32 s78, s78, s81
    v_readlane_b32 s81, v36, 3
    s_nop 3
    s_add_u32 s78, s78, s81
    v_readlane_b32 s81, v36, 4
    s_nop 3
    s_add_u32 s78, s78, s81
    v_readlane_b32 s81, v36, 5
    s_nop 3
    s_add_u32 s78, s78, s81
    v_readlane_b32 s81, v36, 6
    s_nop 3
    s_add_u32 s78, s78, s81
    v_readlane_b32 s81, v36, 7
    s_nop 3
    s_add_u32 s78, s78, s81
    s_cmp_eq_u32 s78, 256
    s_cbranch_scc1 mega_kernel_redo
    buffer_load_dword v36, v37, s[88:91], 0 offen sc1
    s_waitcnt vmcnt(0)
    s_branch mega_kernel_h2_2_ev
mega_kernel_h2_2_ok:
    s_cmp_lg_u32 s20, 2
    s_cbranch_scc1 mega_kernel_rf_wo6
    v_xor_b32 v48, 0, v47
    v_add_u32 v48, 98304, v48
    ds_read_b64_tr_b16 v[136:137], v48 offset:0
    ds_read_b64_tr_b16 v[138:139], v48 offset:512
    ds_read_b64_tr_b16 v[140:141], v48 offset:8192
    ds_read_b64_tr_b16 v[142:143], v48 offset:8704
    ds_read_b64_tr_b16 v[152:153], v48 offset:32
    ds_read_b64_tr_b16 v[154:155], v48 offset:544
    ds_read_b64_tr_b16 v[156:157], v48 offset:8224
    ds_read_b64_tr_b16 v[158:159], v48 offset:8736
    s_waitcnt lgkmcnt(0)
    v_xor_b32 v48, 64, v47
    v_add_u32 v48, 98304, v48
    ds_read_b64_tr_b16 v[168:169], v48 offset:0
    ds_read_b64_tr_b16 v[170:171], v48 offset:512
    ds_read_b64_tr_b16 v[172:173], v48 offset:8192
    ds_read_b64_tr_b16 v[174:175], v48 offset:8704
    ds_read_b64_tr_b16 v[184:185], v48 offset:32
    ds_read_b64_tr_b16 v[186:187], v48 offset:544
    ds_read_b64_tr_b16 v[188:189], v48 offset:8224
    ds_read_b64_tr_b16 v[190:191], v48 offset:8736
    s_waitcnt lgkmcnt(0)
    v_xor_b32 v48, 128, v47
    v_add_u32 v48, 98304, v48
    ds_read_b64_tr_b16 v[200:201], v48 offset:0
    ds_read_b64_tr_b16 v[202:203], v48 offset:512
    ds_read_b64_tr_b16 v[204:205], v48 offset:8192
    ds_read_b64_tr_b16 v[206:207], v48 offset:8704
    ds_read_b64_tr_b16 v[216:217], v48 offset:32
    ds_read_b64_tr_b16 v[218:219], v48 offset:544
    ds_read_b64_tr_b16 v[220:221], v48 offset:8224
    ds_read_b64_tr_b16 v[222:223], v48 offset:8736
    s_waitcnt lgkmcnt(0)
    v_xor_b32 v48, 192, v47
    v_add_u32 v48, 98304, v48
    ds_read_b64_tr_b16 v[232:233], v48 offset:0
    ds_read_b64_tr_b16 v[234:235], v48 offset:512
    ds_read_b64_tr_b16 v[236:237], v48 offset:8192
    ds_read_b64_tr_b16 v[238:239], v48 offset:8704
    ds_read_b64_tr_b16 v[248:249], v48 offset:32
    ds_read_b64_tr_b16 v[250:251], v48 offset:544
    ds_read_b64_tr_b16 v[252:253], v48 offset:8224
    ds_read_b64_tr_b16 v[254:255], v48 offset:8736
    s_waitcnt lgkmcnt(0)
mega_kernel_rf_wo6:
    s_barrier
    s_add_u32 m0, s48, 98304
    s_mov_b32 s22, 3145728
    buffer_load_dwordx4 v44, s[8:11], s22 offen  lds
    s_add_u32 m0, s48, 102400
    s_mov_b32 s22, 3178496
    buffer_load_dwordx4 v44, s[8:11], s22 offen  lds
    s_add_u32 m0, s48, 106496
    s_mov_b32 s22, 3211264
    buffer_load_dwordx4 v44, s[8:11], s22 offen  lds
    s_add_u32 m0, s48, 110592
    s_mov_b32 s22, 3244032
    buffer_load_dwordx4 v44, s[8:11], s22 offen  lds
    s_waitcnt vmcnt(28)
    s_barrier
    s_cmp_lg_u32 s20, 3
    s_cbranch_scc1 mega_kernel_rf_wo7
    v_xor_b32 v48, 0, v47
    v_add_u32 v48, 114688, v48
    ds_read_b64_tr_b16 v[136:137], v48 offset:0
    ds_read_b64_tr_b16 v[138:139], v48 offset:512
    ds_read_b64_tr_b16 v[140:141], v48 offset:8192
    ds_read_b64_tr_b16 v[142:143], v48 offset:8704
    ds_read_b64_tr_b16 v[152:153], v48 offset:32
    ds_read_b64_tr_b16 v[154:155], v48 offset:544
    ds_read_b64_tr_b16 v[156:157], v48 offset:8224
    ds_read_b64_tr_b16 v[158:159], v48 offset:8736
    s_waitcnt lgkmcnt(0)
    v_xor_b32 v48, 64, v47
    v_add_u32 v48, 114688, v48
    ds_read_b64_tr_b16 v[168:169], v48 offset:0
    ds_read_b64_tr_b16 v[170:171], v48 offset:512
    ds_read_b64_tr_b16 v[172:173], v48 offset:8192
    ds_read_b64_tr_b16 v[174:175], v48 offset:8704
    ds_read_b64_tr_b16 v[184:185], v48 offset:32
    ds_read_b64_tr_b16 v[186:187], v48 offset:544
    ds_read_b64_tr_b16 v[188:189], v48 offset:8224
    ds_read_b64_tr_b16 v[190:191], v48 offset:8736
    s_waitcnt lgkmcnt(0)
    v_xor_b32 v48, 128, v47
    v_add_u32 v48, 114688, v48
    ds_read_b64_tr_b16 v[200:201], v48 offset:0
    ds_read_b64_tr_b16 v[202:203], v48 offset:512
    ds_read_b64_tr_b16 v[204:205], v48 offset:8192
    ds_read_b64_tr_b16 v[206:207], v48 offset:8704
    ds_read_b64_tr_b16 v[216:217], v48 offset:32
    ds_read_b64_tr_b16 v[218:219], v48 offset:544
    ds_read_b64_tr_b16 v[220:221], v48 offset:8224
    ds_read_b64_tr_b16 v[222:223], v48 offset:8736
    s_waitcnt lgkmcnt(0)
    v_xor_b32 v48, 192, v47
    v_add_u32 v48, 114688, v48
    ds_read_b64_tr_b16 v[232:233], v48 offset:0
    ds_read_b64_tr_b16 v[234:235], v48 offset:512
    ds_read_b64_tr_b16 v[236:237], v48 offset:8192
    ds_read_b64_tr_b16 v[238:239], v48 offset:8704
    ds_read_b64_tr_b16 v[248:249], v48 offset:32
    ds_read_b64_tr_b16 v[250:251], v48 offset:544
    ds_read_b64_tr_b16 v[252:253], v48 offset:8224
    ds_read_b64_tr_b16 v[254:255], v48 offset:8736
    s_waitcnt lgkmcnt(0)
mega_kernel_rf_wo7:
    s_barrier
    s_add_u32 m0, s48, 114688
    s_mov_b32 s22, 3670016
    buffer_load_dwordx4 v44, s[8:11], s22 offen  lds
    s_add_u32 m0, s48, 118784
    s_mov_b32 s22, 3702784
    buffer_load_dwordx4 v44, s[8:11], s22 offen  lds
    s_add_u32 m0, s48, 122880
    s_mov_b32 s22, 3735552
    buffer_load_dwordx4 v44, s[8:11], s22 offen  lds
    s_add_u32 m0, s48, 126976
    s_mov_b32 s22, 3768320
    buffer_load_dwordx4 v44, s[8:11], s22 offen  lds
    s_waitcnt vmcnt(28)
    s_barrier
    v_add_u32 v48, 0, v46
    ds_read_b64_tr_b16 v[64:65], v48 offset:0
    ds_read_b64_tr_b16 v[66:67], v48 offset:512
    ds_read_b64_tr_b16 v[68:69], v48 offset:8192
    ds_read_b64_tr_b16 v[70:71], v48 offset:8704
    ds_read_b64_tr_b16 v[72:73], v48 offset:8
    ds_read_b64_tr_b16 v[74:75], v48 offset:520
    ds_read_b64_tr_b16 v[76:77], v48 offset:8200
    ds_read_b64_tr_b16 v[78:79], v48 offset:8712
    s_waitcnt lgkmcnt(0)
    s_barrier
    ds_write_b128 v32, v[64:67] offset:0
    ds_write_b128 v32, v[68:71] offset:1024
    ds_write_b128 v32, v[72:75] offset:2048
    ds_write_b128 v32, v[76:79] offset:3072
    s_waitcnt lgkmcnt(0)
    s_waitcnt vmcnt(24)
    s_barrier
    v_add_u32 v48, 16384, v46
    ds_read_b64_tr_b16 v[64:65], v48 offset:0
    ds_read_b64_tr_b16 v[66:67], v48 offset:512
    ds_read_b64_tr_b16 v[68:69], v48 offset:8192
    ds_read_b64_tr_b16 v[70:71], v48 offset:8704
    ds_read_b64_tr_b16 v[72:73], v48 offset:8
    ds_read_b64_tr_b16 v[74:75], v48 offset:520
    ds_read_b64_tr_b16 v[76:77], v48 offset:8200
    ds_read_b64_tr_b16 v[78:79], v48 offset:8712
    s_waitcnt lgkmcnt(0)
    s_barrier
    ds_write_b128 v32, v[64:67] offset:16384
    ds_write_b128 v32, v[68:71] offset:17408
    ds_write_b128 v32, v[72:75] offset:18432
    ds_write_b128 v32, v[76:79] offset:19456
    s_waitcnt lgkmcnt(0)
    s_waitcnt vmcnt(20)
    s_barrier
    s_getpc_b64 s[16:17]
mega_kernel_rf_pc0:
    s_add_u32 s16, s16, mega_kernel_rf_w0_entry - mega_kernel_rf_pc0
    s_addc_u32 s17, s17, 0
    v_lshlrev_b32 v49, 7, v0
    v_min_u32 v49, mega_kernel_rf_end - mega_kernel_rf_w0_entry, v49
    global_load_dword v50, v49, s[16:17]
    v_lshlrev_b32 v49, 7, v40
    s_xor_b32 s23, s35, 16384
    s_cmp_eq_u32 s20, 1
    s_cselect_b32 s22, s35, s47
    s_cmp_eq_u32 s20, 2
    s_cselect_b32 s22, s23, s22
    s_lshl_b32 s23, s31, 13
    s_add_u32 s23, s23, 178257920
    s_cmp_eq_u32 s20, 3
    s_cselect_b32 s22, s23, s22
    buffer_load_dword v51, v49, s[4:7], s22 offen sc1
    v_lshlrev_b32 v49, 13, v0
    v_and_b32 v49, 0x1fffff, v49
    s_mov_b32 s22, 67108864
    buffer_load_dword v52, v49, s[4:7], s22 offen sc1
    buffer_load_dword v57, v7, s[4:7], 0 offen sc1
    v_add_u32 v48, 32768, v46
    ds_read_b64_tr_b16 v[64:65], v48 offset:0
    ds_read_b64_tr_b16 v[66:67], v48 offset:512
    ds_read_b64_tr_b16 v[68:69], v48 offset:8192
    ds_read_b64_tr_b16 v[70:71], v48 offset:8704
    ds_read_b64_tr_b16 v[72:73], v48 offset:8
    ds_read_b64_tr_b16 v[74:75], v48 offset:520
    ds_read_b64_tr_b16 v[76:77], v48 offset:8200
    ds_read_b64_tr_b16 v[78:79], v48 offset:8712
    s_waitcnt lgkmcnt(0)
    s_barrier
    ds_write_b128 v32, v[64:67] offset:32768
    ds_write_b128 v32, v[68:71] offset:33792
    ds_write_b128 v32, v[72:75] offset:34816
    ds_write_b128 v32, v[76:79] offset:35840
    s_waitcnt lgkmcnt(0)
    s_waitcnt vmcnt(16)
    s_barrier
    v_add_u32 v48, 49152, v46
    ds_read_b64_tr_b16 v[64:65], v48 offset:0
    ds_read_b64_tr_b16 v[66:67], v48 offset:512
    ds_read_b64_tr_b16 v[68:69], v48 offset:8192
    ds_read_b64_tr_b16 v[70:71], v48 offset:8704
    ds_read_b64_tr_b16 v[72:73], v48 offset:8
    ds_read_b64_tr_b16 v[74:75], v48 offset:520
    ds_read_b64_tr_b16 v[76:77], v48 offset:8200
    ds_read_b64_tr_b16 v[78:79], v48 offset:8712
    s_waitcnt lgkmcnt(0)
    s_barrier
    ds_write_b128 v32, v[64:67] offset:49152
    ds_write_b128 v32, v[68:71] offset:50176
    ds_write_b128 v32, v[72:75] offset:51200
    ds_write_b128 v32, v[76:79] offset:52224
    s_waitcnt lgkmcnt(0)
    s_waitcnt vmcnt(12)
    s_barrier
    v_add_u32 v48, 65536, v46
    ds_read_b64_tr_b16 v[64:65], v48 offset:0
    ds_read_b64_tr_b16 v[66:67], v48 offset:512
    ds_read_b64_tr_b16 v[68:69], v48 offset:8192
    ds_read_b64_tr_b16 v[70:71], v48 offset:8704
    ds_read_b64_tr_b16 v[72:73], v48 offset:8
    ds_read_b64_tr_b16 v[74:75], v48 offset:520
    ds_read_b64_tr_b16 v[76:77], v48 offset:8200
    ds_read_b64_tr_b16 v[78:79], v48 offset:8712
    s_waitcnt lgkmcnt(0)
    s_barrier
    ds_write_b128 v33, v[64:67] offset:0
    ds_write_b128 v33, v[68:71] offset:1024
    ds_write_b128 v33, v[72:75] offset:2048
    ds_write_b128 v33, v[76:79] offset:3072
    s_waitcnt lgkmcnt(0)
    s_waitcnt vmcnt(8)
    s_barrier
    v_add_u32 v48, 81920, v46
    ds_read_b64_tr_b16 v[64:65], v48 offset:0
    ds_read_b64_tr_b16 v[66:67], v48 offset:512
    ds_read_b64_tr_b16 v[68:69], v48 offset:8192
    ds_read_b64_tr_b16 v[70:71], v48 offset:8704
    ds_read_b64_tr_b16 v[72:73], v48 offset:8
    ds_read_b64_tr_b16 v[74:75], v48 offset:520
    ds_read_b64_tr_b16 v[76:77], v48 offset:8200
    ds_read_b64_tr_b16 v[78:79], v48 offset:8712
    s_waitcnt lgkmcnt(0)
    s_barrier
    ds_write_b128 v33, v[64:67] offset:16384
    ds_write_b128 v33, v[68:71] offset:17408
    ds_write_b128 v33, v[72:75] offset:18432
    ds_write_b128 v33, v[76:79] offset:19456
    s_waitcnt lgkmcnt(0)
    s_waitcnt vmcnt(4)
    s_barrier
    v_add_u32 v48, 98304, v46
    ds_read_b64_tr_b16 v[64:65], v48 offset:0
    ds_read_b64_tr_b16 v[66:67], v48 offset:512
    ds_read_b64_tr_b16 v[68:69], v48 offset:8192
    ds_read_b64_tr_b16 v[70:71], v48 offset:8704
    ds_read_b64_tr_b16 v[72:73], v48 offset:8
    ds_read_b64_tr_b16 v[74:75], v48 offset:520
    ds_read_b64_tr_b16 v[76:77], v48 offset:8200
    ds_read_b64_tr_b16 v[78:79], v48 offset:8712
    s_waitcnt lgkmcnt(0)
    s_barrier
    ds_write_b128 v33, v[64:67] offset:32768
    ds_write_b128 v33, v[68:71] offset:33792
    ds_write_b128 v33, v[72:75] offset:34816
    ds_write_b128 v33, v[76:79] offset:35840
    s_waitcnt lgkmcnt(0)
    s_waitcnt vmcnt(0)
    s_barrier
    v_add_u32 v48, 114688, v46
    ds_read_b64_tr_b16 v[64:65], v48 offset:0
    ds_read_b64_tr_b16 v[66:67], v48 offset:512
    ds_read_b64_tr_b16 v[68:69], v48 offset:8192
    ds_read_b64_tr_b16 v[70:71], v48 offset:8704
    ds_read_b64_tr_b16 v[72:73], v48 offset:8
    ds_read_b64_tr_b16 v[74:75], v48 offset:520
    ds_read_b64_tr_b16 v[76:77], v48 offset:8200
    ds_read_b64_tr_b16 v[78:79], v48 offset:8712
    s_waitcnt lgkmcnt(0)
    s_barrier
    ds_write_b128 v33, v[64:67] offset:49152
    ds_write_b128 v33, v[68:71] offset:50176
    ds_write_b128 v33, v[72:75] offset:51200
    ds_write_b128 v33, v[76:79] offset:52224
    s_waitcnt lgkmcnt(0)
    s_branch mega_kernel_rf_iw1
mega_kernel_rf_iw:
    buffer_load_dword v58, off, s[12:15], 0 offset:204 sc1
    s_waitcnt vmcnt(0)
mega_kernel_rf_iw1:
    v_and_b32 v50, 0xffff, v58
    v_readfirstlane_b32 s60, v58
    v_cmp_ne_u32 vcc, s100, v50
    s_cbranch_vccnz mega_kernel_rf_iw
    s_lshr_b32 s60, s60, 15
    s_cmp_gt_u32 s60, s100
    s_cselect_b32 s60, 8192, 0
    s_bfe_u32 s22, s31, 0x10001
    s_lshl_b32 s22, s22, 12
    s_add_u32 s22, s22, s60
    s_lshl_b32 s23, s20, 10
    s_add_u32 s22, s22, s23
    s_add_u32 s38, s38, s22
    s_add_u32 s37, s37, s22
    s_xor_b32 s40, s38, 4096
    s_xor_b32 s39, s37, 4096
    s_xor_b32 s36, s35, 16384
    s_mov_b32 s21, 0
    s_cmp_eq_u32 s30, 0
    s_mov_b32 s22, 0x33003300
    s_cselect_b32 s16, 0x00330033, s22
    s_mov_b32 s17, s16
    s_cselect_b32 s18, -1, 0
    s_not_b32 s19, s18
    s_lshl_b32 s22, s31, 13
    s_lshl_b32 s23, s20, 11
    s_add_u32 s22, s22, s23
    s_add_u32 s43, s22, 16777216
    s_add_u32 s44, s22, 33554432
    s_lshl_b32 s45, s31, 13
    s_add_u32 s45, s45, 178257920
    s_mul_i32 s48, s20, 5120
    s_add_u32 m0, s48, 140288
    s_mov_b32 s41, 1
    s_mov_b32 s42, 1
    v_mov_b32 v0, v34
    v_bfrev_b32 v12, 1
    v_bfrev_b32 v3, 1
    v_cndmask_b32 v10, v3, v10, s[16:17]
    v_cndmask_b32 v9, v3, v9, s[26:27]
    s_sub_u32 s45, s45, 0
    s_lshl_b32 s51, s30, 11
    s_add_u32 s51, s51, s45
    s_mov_b32 s50, 0
    s_cmp_lg_u32 s20, 3
    s_cbranch_scc1 mega_kernel_rf_kv0
    v_readlane_b32 s50, v57, 0
    v_readlane_b32 s22, v57, 2
    v_readlane_b32 s23, v57, 1
    v_readlane_b32 s24, v57, 3
    s_nop 3
    s_min_u32 s50, s50, s22
    s_min_u32 s23, s23, s24
    s_lshl_b32 s50, s50, 1
    s_lshl_b32 s23, s23, 1
    s_add_u32 s23, s23, 1
    s_min_u32 s50, s50, s23
mega_kernel_rf_kvb0:
    s_add_u32 s22, s21, 1
    s_min_u32 s22, s22, 63
    s_cmp_gt_u32 s50, s22
    s_cbranch_scc1 mega_kernel_rf_kvd0
    buffer_load_dword v48, v7, s[4:7], 0 offen sc1
    s_waitcnt vmcnt(0)
    v_readlane_b32 s50, v48, 0
    v_readlane_b32 s22, v48, 2
    v_readlane_b32 s23, v48, 1
    v_readlane_b32 s24, v48, 3
    s_nop 3
    s_min_u32 s50, s50, s22
    s_min_u32 s23, s23, s24
    s_lshl_b32 s50, s50, 1
    s_lshl_b32 s23, s23, 1
    s_add_u32 s23, s23, 1
    s_min_u32 s50, s50, s23
    s_branch mega_kernel_rf_kvb0
mega_kernel_rf_kvd0:
mega_kernel_rf_kv0:
    s_barrier
    s_cmp_eq_u32 s20, 1
    s_cbranch_scc1 mega_kernel_rf_w1_entry
    s_cmp_eq_u32 s20, 2
    s_cbranch_scc1 mega_kernel_rf_w2_entry
    s_cmp_eq_u32 s20, 3
    s_cbranch_scc1 mega_kernel_rf_w3_entry
mega_kernel_rf_w0_entry:
    v_mfma_f32_32x32x8_bf16 v[96:111], v[14:15], v[14:15], 0
    v_mfma_f32_16x16x16_bf16 v[112:115], v[14:15], v[14:15], 0
    v_mfma_f32_16x16x16_bf16 v[116:119], v[14:15], v[14:15], 0
    ds_read_b128 v[64:67], v1 offset:0
    ds_read_b128 v[68:71], v1 offset:1024
    ds_read_b128 v[72:75], v1 offset:2048
    ds_read_b128 v[76:79], v1 offset:3072
    ds_read_b128 v[80:83], v1 offset:16384
    ds_read_b128 v[84:87], v1 offset:17408
    ds_read_b128 v[88:91], v1 offset:18432
    ds_read_b128 v[92:95], v1 offset:19456
    buffer_load_dwordx4 v[120:123], v1, s[4:7], s44 offen
    buffer_load_dwordx4 v[124:127], v1, s[4:7], s44 offen offset:1024
    s_add_u32 s44, s44, 262144
mega_kernel_rf_w0_loop:
    s_add_u32 s22, s35, 0
    s_waitcnt vmcnt(0)
    buffer_load_dwordx4 v[32:35], v1, s[4:7], s22 offen sc1
    buffer_load_dwordx4 v[36:39], v1, s[4:7], s22 offen offset:1024 sc1
mega_kernel_rf_w0_pa:
    s_waitcnt vmcnt(1)
    ds_write_b128 v6, v[32:35] offset:0
    s_waitcnt vmcnt(0)
    ds_write_b128 v6, v[36:39] offset:1024
    v_max3_u32 v3, v32, v34, v36
    v_max_u32 v3, v3, v38
    v_cmp_eq_u32 vcc, -1, v3
    v_smfmac_f32_16x16x64_bf16 v[96:99], v[32:35], a[0:7], v2
    buffer_load_dwordx4 v[32:35], v1, s[4:7], s22 offen sc1
    v_smfmac_f32_16x16x64_bf16 v[100:103], v[32:35], a[8:15], v2
    buffer_load_dwordx4 v[36:39], v1, s[4:7], s22 offen offset:1024 sc1
    v_smfmac_f32_16x16x64_bf16 v[104:107], v[32:35], a[128:135], v2
    s_cbranch_vccnz mega_kernel_rf_w0_pafail
    s_waitcnt lgkmcnt(0)
    s_barrier
    ds_read_b128 v[40:43], v6 offset:2048
    ds_read_b128 v[44:47], v6 offset:3072
    v_smfmac_f32_16x16x64_bf16 v[108:111], v[32:35], a[136:143], v2
    ds_read_b128 v[48:51], v6 offset:4096
    v_smfmac_f32_16x16x64_bf16 v[96:99], v[36:39], a[16:23], v2
    ds_read_b128 v[52:55], v6 offset:5120
    v_smfmac_f32_16x16x64_bf16 v[100:103], v[36:39], a[24:31], v2
    ds_read_b128 v[56:59], v6 offset:6144
    v_smfmac_f32_16x16x64_bf16 v[104:107], v[36:39], a[144:151], v2
    ds_read_b128 v[60:63], v6 offset:7168
    v_smfmac_f32_16x16x64_bf16 v[108:111], v[36:39], a[152:159], v2
    buffer_load_dwordx4 v1, s[4:7], s43 offen lds
    s_waitcnt lgkmcnt(5)
    v_smfmac_f32_16x16x64_bf16 v[96:99], v[40:43], a[32:39], v2
    v_smfmac_f32_16x16x64_bf16 v[104:107], v[40:43], a[160:167], v2
    s_waitcnt lgkmcnt(4)
    v_smfmac_f32_16x16x64_bf16 v[96:99], v[44:47], a[48:55], v2
    v_smfmac_f32_16x16x64_bf16 v[104:107], v[44:47], a[176:183], v2
    buffer_load_dwordx4 v1, s[4:7], s43 offen offset:1024 lds
    s_waitcnt lgkmcnt(3)
    v_smfmac_f32_16x16x64_bf16 v[96:99], v[48:51], a[64:71], v2
    v_smfmac_f32_16x16x64_bf16 v[104:107], v[48:51], a[192:199], v2
    s_waitcnt lgkmcnt(2)
    v_smfmac_f32_16x16x64_bf16 v[96:99], v[52:55], a[80:87], v2
    v_smfmac_f32_16x16x64_bf16 v[104:107], v[52:55], a[208:215], v2
    v_mov_b32 v4, s21
    buffer_store_dword v4, v7, s[4:7], 0 offen sc1
    s_waitcnt lgkmcnt(1)
    v_smfmac_f32_16x16x64_bf16 v[96:99], v[56:59], a[96:103], v2
    v_smfmac_f32_16x16x64_bf16 v[104:107], v[56:59], a[224:231], v2
    s_waitcnt lgkmcnt(0)
    v_smfmac_f32_16x16x64_bf16 v[96:99], v[60:63], a[112:119], v2
    v_smfmac_f32_16x16x64_bf16 v[104:107], v[60:63], a[240:247], v2
    v_smfmac_f32_16x16x64_bf16 v[100:103], v[40:43], a[40:47], v2
    s_nop 2
    v_smfmac_f32_16x16x64_bf16 v[100:103], v[44:47], a[56:63], v2
    s_nop 1
    v_add_f32 v96, v96, v98
    v_smfmac_f32_16x16x64_bf16 v[100:103], v[48:51], a[72:79], v2
    v_add_f32 v97, v97, v99
    v_add_f32 v104, v104, v106
    v_smfmac_f32_16x16x64_bf16 v[100:103], v[52:55], a[88:95], v2
    v_add_f32 v105, v105, v107
    v_cvt_pk_bf16_f32 v96, v96, v97
    v_smfmac_f32_16x16x64_bf16 v[100:103], v[56:59], a[104:111], v2
    v_cvt_pk_bf16_f32 v97, v104, v105
    v_and_or_b32 v96, v96, -2, s41
    v_smfmac_f32_16x16x64_bf16 v[100:103], v[60:63], a[120:127], v2
    buffer_store_dwordx2 v[96:97], v11, s[4:7], s37 offen sc1
    v_smfmac_f32_16x16x64_bf16 v[108:111], v[40:43], a[168:175], v2
    v_smfmac_f32_16x16x64_bf16 v[108:111], v[44:47], a[184:191], v2
    v_smfmac_f32_16x16x64_bf16 v[108:111], v[48:51], a[200:207], v2
    v_smfmac_f32_16x16x64_bf16 v[108:111], v[52:55], a[216:223], v2
    v_smfmac_f32_16x16x64_bf16 v[108:111], v[56:59], a[232:239], v2
    s_nop 2
    v_add_f32 v100, v100, v102
    v_smfmac_f32_16x16x64_bf16 v[108:111], v[60:63], a[248:255], v2
    v_add_f32 v101, v101, v103
    v_cvt_pk_bf16_f32 v98, v100, v101
    v_and_or_b32 v98, v98, -2, s41
    s_nop 4
    v_pk_add_f32 v[108:109], v[108:109], v[110:111]
    v_cvt_pk_bf16_f32 v99, v108, v109
    buffer_store_dwordx2 v[98:99], v11, s[4:7], s37 offen offset:512 sc1
    v_smfmac_f32_16x16x64_bf16 v[112:115], v[32:35], v[64:71], v2
    ds_read_b128 v[64:67], v1 offset:32768
    ds_read_b128 v[68:71], v1 offset:33792
    v_smfmac_f32_16x16x64_bf16 v[116:119], v[32:35], v[72:79], v2
    ds_read_b128 v[72:75], v1 offset:34816
    ds_read_b128 v[76:79], v1 offset:35840
    v_smfmac_f32_16x16x64_bf16 v[112:115], v[36:39], v[80:87], v2
    ds_read_b128 v[80:83], v1 offset:49152
    ds_read_b128 v[84:87], v1 offset:50176
    v_smfmac_f32_16x16x64_bf16 v[116:119], v[36:39], v[88:95], v2
    ds_read_b128 v[88:91], v1 offset:51200
    ds_read_b128 v[92:95], v1 offset:52224
    s_waitcnt lgkmcnt(6)
    v_smfmac_f32_16x16x64_bf16 v[112:115], v[40:43], v[64:71], v2
    ds_read_b128 v[64:67], v5 offset:0
    ds_read_b128 v[68:71], v5 offset:1024
    s_waitcnt lgkmcnt(6)
    v_smfmac_f32_16x16x64_bf16 v[116:119], v[40:43], v[72:79], v2
    ds_read_b128 v[72:75], v5 offset:2048
    ds_read_b128 v[76:79], v5 offset:3072
    s_waitcnt lgkmcnt(6)
    v_smfmac_f32_16x16x64_bf16 v[112:115], v[44:47], v[80:87], v2
    ds_read_b128 v[80:83], v5 offset:16384
    ds_read_b128 v[84:87], v5 offset:17408
    s_waitcnt lgkmcnt(6)
    v_smfmac_f32_16x16x64_bf16 v[116:119], v[44:47], v[88:95], v2
    ds_read_b128 v[88:91], v5 offset:18432
    ds_read_b128 v[92:95], v5 offset:19456
    s_waitcnt lgkmcnt(6)
    v_smfmac_f32_16x16x64_bf16 v[112:115], v[48:51], v[64:71], v2
    ds_read_b128 v[64:67], v5 offset:32768
    ds_read_b128 v[68:71], v5 offset:33792
    s_waitcnt lgkmcnt(6)
    v_smfmac_f32_16x16x64_bf16 v[116:119], v[48:51], v[72:79], v2
    ds_read_b128 v[72:75], v5 offset:34816
    ds_read_b128 v[76:79], v5 offset:35840
    s_waitcnt lgkmcnt(6)
    v_smfmac_f32_16x16x64_bf16 v[112:115], v[52:55], v[80:87], v2
    ds_read_b128 v[80:83], v5 offset:49152
    ds_read_b128 v[84:87], v5 offset:50176
    s_waitcnt lgkmcnt(6)
    v_smfmac_f32_16x16x64_bf16 v[116:119], v[52:55], v[88:95], v2
    ds_read_b128 v[88:91], v5 offset:51200
    ds_read_b128 v[92:95], v5 offset:52224
    s_waitcnt lgkmcnt(6)
    v_smfmac_f32_16x16x64_bf16 v[112:115], v[56:59], v[64:71], v2
    s_waitcnt lgkmcnt(4)
    v_smfmac_f32_16x16x64_bf16 v[116:119], v[56:59], v[72:79], v2
    s_waitcnt lgkmcnt(2)
    v_smfmac_f32_16x16x64_bf16 v[112:115], v[60:63], v[80:87], v2
    s_waitcnt lgkmcnt(0)
    v_smfmac_f32_16x16x64_bf16 v[116:119], v[60:63], v[88:95], v2
    buffer_load_dwordx2 v[108:109], v11, s[4:7], s38 offen sc1
    v_mfma_f32_16x16x16_bf16 v[100:103], v[96:97], v[16:17], 0
    v_mfma_f32_16x16x16_bf16 v[104:107], v[98:99], v[16:17], 0
    s_nop 4
    v_add_f32 v112, v112, v114
    v_add_f32 v113, v113, v115
    v_add_f32 v114, v116, v118
    v_add_f32 v115, v117, v119
    v_cvt_pk_bf16_f32 v18, v112, v113
    v_cvt_pk_bf16_f32 v19, v114, v115
    v_and_or_b32 v18, v18, -2, s41
    buffer_load_dwordx2 v[110:111], v11, s[4:7], s38 offen offset:512 sc1
    s_barrier
    buffer_store_dwordx2 v[18:19], v11, s[4:7], s39 offen sc1
    v_mov_b32 v112, v18
    v_mov_b32 v114, v19
    v_mov_b32 v92, v28
    v_mov_b32 v93, 0
    s_waitcnt vmcnt(6)
    s_barrier
    ds_read_b128 v[32:35], v6 offset:9216
    ds_read_b128 v[36:39], v6 offset:10240
    ds_read_b128 v[40:43], v6 offset:14336
    ds_read_b128 v[44:47], v6 offset:15360
    ds_read_b128 v[48:51], v6 offset:19456
    ds_read_b128 v[52:55], v6 offset:20480
    ds_read_b128 v[56:59], v6 offset:24576
    ds_read_b128 v[60:63], v6 offset:25600
    buffer_load_dwordx2 v[20:21], v11, s[4:7], s38 offen sc1
    buffer_load_dwordx2 v[22:23], v11, s[4:7], s38 offen offset:512 sc1
    s_waitcnt vmcnt(4)
    v_mfma_f32_16x16x16_bf16 v[80:83], v[108:109], v[16:17], v[100:103]
    v_and_b32 v3, 1, v108
    v_cmp_ne_u32 vcc, s41, v3
    s_nop 5
    v_cvt_pk_bf16_f32 v64, v80, v81
    v_cvt_pk_bf16_f32 v65, v82, v83
    s_cbranch_vccnz mega_kernel_rf_w0_xslow
    s_waitcnt vmcnt(3)
    v_mfma_f32_16x16x16_bf16 v[84:87], v[110:111], v[16:17], v[104:107]
    v_and_b32 v3, 1, v110
    v_cmp_ne_u32 vcc, s41, v3
    s_nop 5
    v_cvt_pk_bf16_f32 v66, v84, v85
    v_cvt_pk_bf16_f32 v67, v86, v87
    ds_write_b128 v6, v[64:67] offset:8192
    s_cbranch_vccnz mega_kernel_rf_w0_xslow
mega_kernel_rf_w0_xok:
    s_cmp_eq_u32 s21, 63
    s_cbranch_scc1 mega_kernel_rf_w0_last
    buffer_load_dwordx2 v[116:117], v11, s[4:7], s40 offen sc1
    s_waitcnt lgkmcnt(1)
    v_mfma_f32_16x16x32_bf16 v[80:83], v[32:35], v[64:67], 0
    s_waitcnt lgkmcnt(0)
    s_barrier
    ds_read_b128 v[68:71], v6 offset:13312
    ds_read_b128 v[72:75], v6 offset:18432
    ds_read_b128 v[76:79], v6 offset:23552
    v_mfma_f32_16x16x32_bf16 v[84:87], v[36:39], v[64:67], 0
    v_mfma_f32_16x16x32_bf16 v[88:91], v[64:67], v[64:67], 0
    buffer_load_dwordx2 v[20:21], v11, s[4:7], s40 offen sc1
    s_waitcnt lgkmcnt(2)
    v_mfma_f32_16x16x32_bf16 v[80:83], v[40:43], v[68:71], v[80:83]
    buffer_store_dwordx4 v[64:67], v10, s[4:7], s45 offen offset:0 sc1
    s_waitcnt lgkmcnt(1)
    v_mfma_f32_16x16x32_bf16 v[80:83], v[48:51], v[72:75], v[80:83]
    s_waitcnt lgkmcnt(0)
    v_mfma_f32_16x16x32_bf16 v[80:83], v[56:59], v[76:79], v[80:83]
    v_mfma_f32_16x16x32_bf16 v[84:87], v[44:47], v[68:71], v[84:87]
    v_mfma_f32_16x16x32_bf16 v[84:87], v[52:55], v[72:75], v[84:87]
    buffer_store_dwordx2 v[18:19], v11, s[4:7], s51 offen offset:2048 sc1
    v_mfma_f32_16x16x32_bf16 v[84:87], v[60:63], v[76:79], v[84:87]
    v_mfma_f32_16x16x32_bf16 v[88:91], v[68:71], v[68:71], v[88:91]
    v_mfma_f32_16x16x32_bf16 v[88:91], v[72:75], v[72:75], v[88:91]
    v_mfma_f32_16x16x32_bf16 v[88:91], v[76:79], v[76:79], v[88:91]
    v_mfma_f32_32x32x4_2b_bf16 v[32:63], v[14:15], v[14:15], 0
    s_nop 0
    v_max3_f32 v4, v80, v81, v82
    s_nop 1
    v_max3_f32 v4, v4, v83, v84
    v_max3_f32 v4, v4, v85, v86
    v_max_f32 v4, v4, v87
    v_max3_f32 v90, v4, v88, v89
    v_max3_f32 v4, v4, v88, v89
    s_nop 1
    v_permlane16_swap_b32 v4, v90
    v_max_f32 v4, v4, v90
    v_max_f32 v90, v4, v90
    s_nop 1
    v_permlane32_swap_b32 v4, v90
    v_max_f32 v4, v4, v90
    v_mul_f32 v4, s34, v4
    v_pk_fma_f32 v[80:81], v[80:81], s[34:35], v[4:5] op_sel_hi:[1,0,0] neg_lo:[0,0,1] neg_hi:[0,0,1]
    v_pk_fma_f32 v[82:83], v[82:83], s[34:35], v[4:5] op_sel_hi:[1,0,0] neg_lo:[0,0,1] neg_hi:[0,0,1]
    v_pk_fma_f32 v[84:85], v[84:85], s[34:35], v[4:5] op_sel_hi:[1,0,0] neg_lo:[0,0,1] neg_hi:[0,0,1]
    v_pk_fma_f32 v[86:87], v[86:87], s[34:35], v[4:5] op_sel_hi:[1,0,0] neg_lo:[0,0,1] neg_hi:[0,0,1]
    v_pk_fma_f32 v[88:89], v[88:89], s[34:35], v[4:5] op_sel_hi:[1,0,0] neg_lo:[0,0,1] neg_hi:[0,0,1]
    v_exp_f32 v80, v80
    v_exp_f32 v81, v81
    v_exp_f32 v82, v82
    v_cvt_pk_bf16_f32 v68, v80, v81
    v_exp_f32 v83, v83
    v_exp_f32 v84, v84
    v_cvt_pk_bf16_f32 v69, v82, v83
    v_exp_f32 v85, v85
    v_exp_f32 v86, v86
    v_cvt_pk_bf16_f32 v70, v84, v85
    v_exp_f32 v87, v87
    v_exp_f32 v88, v88
    v_cvt_pk_bf16_f32 v71, v86, v87
    v_exp_f32 v89, v89
    s_waitcnt vmcnt(3)
    v_mfma_f32_16x16x32_bf16 v[76:79], v[28:31], v[68:71], 0
    v_and_b32 v3, 1, v116
    v_cvt_pk_bf16_f32 v72, v88, v89
    v_mfma_f32_16x16x32_bf16 v[100:103], v[120:123], v[68:71], 0
    v_cmp_ne_u32 vcc, s41, v3
    v_cvt_pk_bf16_f32 v73, v88, v89
    v_mfma_f32_16x16x32_bf16 v[104:107], v[124:127], v[68:71], 0
    v_mov_b32 v113, v116
    v_mov_b32 v115, v117
    v_mfma_f32_16x16x16_bf16 v[76:79], v[92:93], v[72:73], v[76:79]
    s_cbranch_vccnz mega_kernel_rf_w0_pv0
mega_kernel_rf_w0_pv2:
    v_mfma_f32_16x16x16_bf16 v[100:103], v[112:113], v[72:73], v[100:103]
    v_mfma_f32_16x16x16_bf16 v[104:107], v[114:115], v[72:73], v[104:107]
    buffer_load_dwordx4 v[120:123], v1, s[4:7], s44 offen
    buffer_load_dwordx4 v[124:127], v1, s[4:7], s44 offen offset:1024
    s_nop 2
    v_rcp_f32 v76, v76
    s_mov_b64 exec, s[28:29]
    v_pk_mul_f32 v[100:101], v[100:101], v[76:77] op_sel_hi:[1,0]
    v_pk_mul_f32 v[102:103], v[102:103], v[76:77] op_sel_hi:[1,0]
    v_pk_mul_f32 v[104:105], v[104:105], v[76:77] op_sel_hi:[1,0]
    v_pk_mul_f32 v[106:107], v[106:107], v[76:77] op_sel_hi:[1,0]
    v_cvt_pk_bf16_f32 v84, v100, v101
    v_cvt_pk_bf16_f32 v85, v102, v103
    v_cvt_pk_bf16_f32 v86, v104, v105
    v_cvt_pk_bf16_f32 v87, v106, v107
    ds_write_b128 v6, v[84:87] offset:28640
    s_mov_b64 exec, -1
    s_waitcnt lgkmcnt(0)
    s_barrier
    ds_read_b128 v[68:71], v6 offset:28672
    ds_read_b128 v[72:75], v6 offset:29696
    s_waitcnt lgkmcnt(1)
    v_smfmac_f32_16x16x64_bf16 v[32:35], v[68:71], v[128:135], v2
    s_add_u32 s21, s21, 1
    s_xor_b32 s38, s38, 1048576
    s_xor_b32 s37, s37, 1048576
    s_waitcnt lgkmcnt(0)
    v_smfmac_f32_16x16x64_bf16 v[32:35], v[72:75], v[136:143], v2
    s_xor_b32 s40, s40, 1048576
    s_xor_b32 s39, s39, 1048576
    s_lshr_b32 s41, s21, 1
    v_smfmac_f32_16x16x64_bf16 v[36:39], v[68:71], v[144:151], v2
    s_and_b32 s41, s41, 1
    s_xor_b32 s41, s41, 1
    s_xor_b32 s35, s35, 16384
    v_smfmac_f32_16x16x64_bf16 v[36:39], v[72:75], v[152:159], v2
    v_add_f32 v32, v32, v34
    s_xor_b32 s36, s36, 16384
    s_add_u32 s43, s43, 262144
    s_add_u32 s44, s44, 262144
    v_smfmac_f32_16x16x64_bf16 v[40:43], v[68:71], v[160:167], v2
    v_add_f32 v33, v33, v35
    v_smfmac_f32_16x16x64_bf16 v[40:43], v[72:75], v[168:175], v2
    v_cvt_pk_bf16_f32 v32, v32, v33
    v_smfmac_f32_16x16x64_bf16 v[44:47], v[68:71], v[176:183], v2
    v_and_or_b32 v32, v32, -2, s42
    v_smfmac_f32_16x16x64_bf16 v[44:47], v[72:75], v[184:191], v2
    v_add_f32 v36, v36, v38
    v_smfmac_f32_16x16x64_bf16 v[48:51], v[68:71], v[192:199], v2
    v_add_f32 v37, v37, v39
    v_smfmac_f32_16x16x64_bf16 v[48:51], v[72:75], v[200:207], v2
    v_cvt_pk_bf16_f32 v33, v36, v37
    v_smfmac_f32_16x16x64_bf16 v[52:55], v[68:71], v[208:215], v2
    v_add_f32 v40, v40, v42
    v_smfmac_f32_16x16x64_bf16 v[52:55], v[72:75], v[216:223], v2
    v_add_f32 v41, v41, v43
    v_smfmac_f32_16x16x64_bf16 v[56:59], v[68:71], v[224:231], v2
    v_cvt_pk_bf16_f32 v34, v40, v41
    v_smfmac_f32_16x16x64_bf16 v[56:59], v[72:75], v[232:239], v2
    v_add_f32 v44, v44, v46
    v_smfmac_f32_16x16x64_bf16 v[60:63], v[68:71], v[240:247], v2
    v_add_f32 v45, v45, v47
    v_smfmac_f32_16x16x64_bf16 v[60:63], v[72:75], v[248:255], v2
    v_cvt_pk_bf16_f32 v35, v44, v45
    buffer_store_dwordx4 v[32:35], v8, s[4:7], s46 offen
    v_pk_add_f32 v[48:49], v[48:49], v[50:51]
    v_cvt_pk_bf16_f32 v48, v48, v49
    v_and_or_b32 v48, v48, -2, s42
    v_pk_add_f32 v[52:53], v[52:53], v[54:55]
    v_cvt_pk_bf16_f32 v49, v52, v53
    v_pk_add_f32 v[56:57], v[56:57], v[58:59]
    v_cvt_pk_bf16_f32 v50, v56, v57
    v_pk_add_f32 v[60:61], v[60:61], v[62:63]
    v_cvt_pk_bf16_f32 v51, v60, v61
    buffer_store_dwordx4 v[48:51], v8, s[4:7], s61 offen
    s_add_u32 s45, s45, 262144
    s_add_u32 s51, s51, 262144
    v_mfma_f32_32x32x8_bf16 v[96:111], v[14:15], v[14:15], 0
    v_mfma_f32_16x16x16_bf16 v[112:115], v[14:15], v[14:15], 0
    v_mfma_f32_16x16x16_bf16 v[116:119], v[14:15], v[14:15], 0
    ds_read_b128 v[64:67], v1 offset:0
    ds_read_b128 v[68:71], v1 offset:1024
    ds_read_b128 v[72:75], v1 offset:2048
    ds_read_b128 v[76:79], v1 offset:3072
    ds_read_b128 v[80:83], v1 offset:16384
    ds_read_b128 v[84:87], v1 offset:17408
    ds_read_b128 v[88:91], v1 offset:18432
    ds_read_b128 v[92:95], v1 offset:19456
    v_mov_b32 v58, -1
    v_mov_b32 v59, -1
    s_waitcnt vmcnt(0)
mega_kernel_rf_w0_cgo:
mega_kernel_rf_w0_pc:
    buffer_load_dword v36, v13, s[4:7], s25 offen offset:0 sc1
    buffer_load_dword v37, v13, s[4:7], s25 offen offset:256 sc1
    buffer_load_dword v38, v13, s[4:7], s25 offen offset:512 sc1
    buffer_load_dword v39, v13, s[4:7], s25 offen offset:768 sc1
    buffer_load_dword v40, v13, s[4:7], s25 offen offset:1024 sc1
    buffer_load_dword v41, v13, s[4:7], s25 offen offset:1280 sc1
    buffer_load_dword v42, v13, s[4:7], s25 offen offset:1536 sc1
    buffer_load_dword v43, v13, s[4:7], s25 offen offset:1792 sc1
    s_waitcnt vmcnt(4)
    v_mfma_f32_16x16x32_bf16 v[52:55], v[36:39], v[24:27], 0
    v_bitop3_b32 v3, s42, v36, v37 bitop3:0x7e
    v_bitop3_b32 v4, s42, v38, v39 bitop3:0x7e
    s_waitcnt vmcnt(2)
    v_or_b32 v3, v3, v4
    v_bitop3_b32 v4, s42, v40, v41 bitop3:0x7e
    s_waitcnt vmcnt(0)
    v_mfma_f32_16x16x32_bf16 v[52:55], v[40:43], v[24:27], v[52:55]
    v_bitop3_b32 v56, s42, v42, v43 bitop3:0x7e
    v_or3_b32 v3, v3, v4, v56
    v_and_b32 v3, v0, v3
    v_cmp_ne_u32 vcc, 0, v3
    s_nop 3
    v_cvt_pk_bf16_f32 v56, v52, v53
    v_cvt_pk_bf16_f32 v57, v54, v55
    v_min_u32 v56, -2, v56
    s_cbranch_vccnz mega_kernel_rf_w0_pc
    s_mov_b64 exec, s[26:27]
    buffer_store_dwordx2 v[56:57], v9, s[4:7], s35 offen offset:0
    buffer_store_dwordx2 v[58:59], v9, s[4:7], s36 offen offset:0
    s_mov_b64 exec, -1
    s_xor_b32 s42, s42, 1
    s_branch mega_kernel_rf_w0_loop
mega_kernel_rf_w0_last:
    buffer_store_dwordx4 v[64:67], v10, s[4:7], s45 offen offset:0 sc1
    buffer_store_dwordx2 v[18:19], v11, s[4:7], s51 offen offset:2048 sc1
    s_branch mega_kernel_rf_end
mega_kernel_rf_w0_pafail:
    s_nop 7
    v_mov_b32 v96, 0
    v_mov_b32 v97, 0
    v_mov_b32 v98, 0
    v_mov_b32 v99, 0
    v_mov_b32 v100, 0
    v_mov_b32 v101, 0
    v_mov_b32 v102, 0
    v_mov_b32 v103, 0
    v_mov_b32 v104, 0
    v_mov_b32 v105, 0
    v_mov_b32 v106, 0
    v_mov_b32 v107, 0
    s_branch mega_kernel_rf_w0_pa
mega_kernel_rf_w0_xslow:
    buffer_load_dwordx2 v[108:109], v11, s[4:7], s38 offen sc1
    buffer_load_dwordx2 v[110:111], v11, s[4:7], s38 offen offset:512 sc1
    s_waitcnt vmcnt(2)
    v_bitop3_b32 v3, s41, v20, v22 bitop3:0x7e
    v_mfma_f32_16x16x16_bf16 v[80:83], v[20:21], v[16:17], v[100:103]
    v_and_b32 v3, 1, v3
    v_mfma_f32_16x16x16_bf16 v[84:87], v[22:23], v[16:17], v[104:107]
    v_cmp_ne_u32 vcc, 0, v3
    s_cbranch_vccz mega_kernel_rf_w0_xgot
    buffer_load_dwordx2 v[20:21], v11, s[4:7], s38 offen sc1
    buffer_load_dwordx2 v[22:23], v11, s[4:7], s38 offen offset:512 sc1
    s_waitcnt vmcnt(2)
    v_bitop3_b32 v3, s41, v108, v110 bitop3:0x7e
    v_mfma_f32_16x16x16_bf16 v[80:83], v[108:109], v[16:17], v[100:103]
    v_and_b32 v3, 1, v3
    v_mfma_f32_16x16x16_bf16 v[84:87], v[110:111], v[16:17], v[104:107]
    v_cmp_ne_u32 vcc, 0, v3
    s_cbranch_vccz mega_kernel_rf_w0_xgot
    s_branch mega_kernel_rf_w0_xslow
mega_kernel_rf_w0_xgot:
    s_nop 3
    v_cvt_pk_bf16_f32 v64, v80, v81
    v_cvt_pk_bf16_f32 v65, v82, v83
    v_cvt_pk_bf16_f32 v66, v84, v85
    v_cvt_pk_bf16_f32 v67, v86, v87
    ds_write_b128 v6, v[64:67] offset:8192
    s_branch mega_kernel_rf_w0_xok
mega_kernel_rf_w0_pv0:
    s_waitcnt vmcnt(2)
    s_branch mega_kernel_rf_w0_pv1
mega_kernel_rf_w0_pv:
    buffer_load_dwordx2 v[20:21], v11, s[4:7], s40 offen sc1
    s_waitcnt vmcnt(0)
mega_kernel_rf_w0_pv1:
    v_and_b32 v3, 1, v20
    v_cmp_ne_u32 vcc, s41, v3
    v_mov_b32 v113, v20
    v_mov_b32 v115, v21
    s_cbranch_vccnz mega_kernel_rf_w0_pv
    s_branch mega_kernel_rf_w0_pv2
mega_kernel_rf_w1_entry:
    v_mfma_f32_32x32x8_bf16 v[96:111], v[14:15], v[14:15], 0
    v_mfma_f32_16x16x16_bf16 v[112:115], v[14:15], v[14:15], 0
    v_mfma_f32_16x16x16_bf16 v[116:119], v[14:15], v[14:15], 0
    ds_read_b128 v[64:67], v1 offset:4096
    ds_read_b128 v[68:71], v1 offset:5120
    ds_read_b128 v[72:75], v1 offset:6144
    ds_read_b128 v[76:79], v1 offset:7168
    ds_read_b128 v[80:83], v1 offset:20480
    ds_read_b128 v[84:87], v1 offset:21504
    ds_read_b128 v[88:91], v1 offset:22528
    ds_read_b128 v[92:95], v1 offset:23552
    buffer_load_dwordx4 v[120:123], v1, s[4:7], s44 offen
    buffer_load_dwordx4 v[124:127], v1, s[4:7], s44 offen offset:1024
    s_add_u32 s44, s44, 262144
mega_kernel_rf_w1_loop:
    s_add_u32 s22, s35, 2048
    s_waitcnt vmcnt(0)
    buffer_load_dwordx4 v[40:43], v1, s[4:7], s22 offen sc1
    buffer_load_dwordx4 v[44:47], v1, s[4:7], s22 offen offset:1024 sc1
mega_kernel_rf_w1_pa:
    s_waitcnt vmcnt(1)
    ds_write_b128 v6, v[40:43] offset:2048
    s_waitcnt vmcnt(0)
    ds_write_b128 v6, v[44:47] offset:3072
    v_max3_u32 v3, v40, v42, v44
    v_max_u32 v3, v3, v46
    v_cmp_eq_u32 vcc, -1, v3
    v_smfmac_f32_16x16x64_bf16 v[96:99], v[40:43], a[32:39], v2
    buffer_load_dwordx4 v[40:43], v1, s[4:7], s22 offen sc1
    v_smfmac_f32_16x16x64_bf16 v[100:103], v[40:43], a[40:47], v2
    buffer_load_dwordx4 v[44:47], v1, s[4:7], s22 offen offset:1024 sc1
    v_smfmac_f32_16x16x64_bf16 v[104:107], v[40:43], a[160:167], v2
    s_cbranch_vccnz mega_kernel_rf_w1_pafail
    s_waitcnt lgkmcnt(0)
    s_barrier
    ds_read_b128 v[48:51], v6 offset:4096
    ds_read_b128 v[52:55], v6 offset:5120
    v_smfmac_f32_16x16x64_bf16 v[108:111], v[40:43], a[168:175], v2
    ds_read_b128 v[56:59], v6 offset:6144
    v_smfmac_f32_16x16x64_bf16 v[96:99], v[44:47], a[48:55], v2
    ds_read_b128 v[60:63], v6 offset:7168
    v_smfmac_f32_16x16x64_bf16 v[100:103], v[44:47], a[56:63], v2
    ds_read_b128 v[32:35], v6 offset:0
    v_smfmac_f32_16x16x64_bf16 v[104:107], v[44:47], a[176:183], v2
    ds_read_b128 v[36:39], v6 offset:1024
    v_smfmac_f32_16x16x64_bf16 v[108:111], v[44:47], a[184:191], v2
    s_waitcnt lgkmcnt(5)
    v_smfmac_f32_16x16x64_bf16 v[96:99], v[48:51], a[64:71], v2
    buffer_load_dwordx4 v1, s[4:7], s43 offen lds
    v_smfmac_f32_16x16x64_bf16 v[104:107], v[48:51], a[192:199], v2
    s_waitcnt lgkmcnt(4)
    v_smfmac_f32_16x16x64_bf16 v[96:99], v[52:55], a[80:87], v2
    v_smfmac_f32_16x16x64_bf16 v[104:107], v[52:55], a[208:215], v2
    s_waitcnt lgkmcnt(3)
    v_smfmac_f32_16x16x64_bf16 v[96:99], v[56:59], a[96:103], v2
    buffer_load_dwordx4 v1, s[4:7], s43 offen offset:1024 lds
    v_smfmac_f32_16x16x64_bf16 v[104:107], v[56:59], a[224:231], v2
    s_waitcnt lgkmcnt(2)
    v_smfmac_f32_16x16x64_bf16 v[96:99], v[60:63], a[112:119], v2
    v_smfmac_f32_16x16x64_bf16 v[104:107], v[60:63], a[240:247], v2
    s_waitcnt lgkmcnt(1)
    v_smfmac_f32_16x16x64_bf16 v[96:99], v[32:35], a[0:7], v2
    v_smfmac_f32_16x16x64_bf16 v[104:107], v[32:35], a[128:135], v2
    s_waitcnt lgkmcnt(0)
    v_smfmac_f32_16x16x64_bf16 v[96:99], v[36:39], a[16:23], v2
    v_smfmac_f32_16x16x64_bf16 v[104:107], v[36:39], a[144:151], v2
    v_smfmac_f32_16x16x64_bf16 v[100:103], v[48:51], a[72:79], v2
    s_nop 2
    v_smfmac_f32_16x16x64_bf16 v[100:103], v[52:55], a[88:95], v2
    s_nop 1
    v_add_f32 v96, v96, v98
    v_smfmac_f32_16x16x64_bf16 v[100:103], v[56:59], a[104:111], v2
    v_add_f32 v97, v97, v99
    v_add_f32 v104, v104, v106
    v_smfmac_f32_16x16x64_bf16 v[100:103], v[60:63], a[120:127], v2
    v_add_f32 v105, v105, v107
    v_cvt_pk_bf16_f32 v96, v96, v97
    v_smfmac_f32_16x16x64_bf16 v[100:103], v[32:35], a[8:15], v2
    v_cvt_pk_bf16_f32 v97, v104, v105
    v_and_or_b32 v96, v96, -2, s41
    v_smfmac_f32_16x16x64_bf16 v[100:103], v[36:39], a[24:31], v2
    buffer_store_dwordx2 v[96:97], v11, s[4:7], s37 offen sc1
    v_smfmac_f32_16x16x64_bf16 v[108:111], v[48:51], a[200:207], v2
    v_smfmac_f32_16x16x64_bf16 v[108:111], v[52:55], a[216:223], v2
    v_smfmac_f32_16x16x64_bf16 v[108:111], v[56:59], a[232:239], v2
    v_smfmac_f32_16x16x64_bf16 v[108:111], v[60:63], a[248:255], v2
    v_smfmac_f32_16x16x64_bf16 v[108:111], v[32:35], a[136:143], v2
    s_nop 2
    v_add_f32 v100, v100, v102
    v_smfmac_f32_16x16x64_bf16 v[108:111], v[36:39], a[152:159], v2
    v_add_f32 v101, v101, v103
    v_cvt_pk_bf16_f32 v98, v100, v101
    v_and_or_b32 v98, v98, -2, s41
    s_nop 4
    v_pk_add_f32 v[108:109], v[108:109], v[110:111]
    v_cvt_pk_bf16_f32 v99, v108, v109
    buffer_store_dwordx2 v[98:99], v11, s[4:7], s37 offen offset:512 sc1
    v_smfmac_f32_16x16x64_bf16 v[112:115], v[32:35], v[64:71], v2
    ds_read_b128 v[64:67], v1 offset:36864
    ds_read_b128 v[68:71], v1 offset:37888
    v_smfmac_f32_16x16x64_bf16 v[116:119], v[32:35], v[72:79], v2
    ds_read_b128 v[72:75], v1 offset:38912
    ds_read_b128 v[76:79], v1 offset:39936
    v_smfmac_f32_16x16x64_bf16 v[112:115], v[36:39], v[80:87], v2
    ds_read_b128 v[80:83], v1 offset:53248
    ds_read_b128 v[84:87], v1 offset:54272
    v_smfmac_f32_16x16x64_bf16 v[116:119], v[36:39], v[88:95], v2
    ds_read_b128 v[88:91], v1 offset:55296
    ds_read_b128 v[92:95], v1 offset:56320
    s_waitcnt lgkmcnt(6)
    v_smfmac_f32_16x16x64_bf16 v[112:115], v[40:43], v[64:71], v2
    ds_read_b128 v[64:67], v5 offset:4096
    ds_read_b128 v[68:71], v5 offset:5120
    s_waitcnt lgkmcnt(6)
    v_smfmac_f32_16x16x64_bf16 v[116:119], v[40:43], v[72:79], v2
    ds_read_b128 v[72:75], v5 offset:6144
    ds_read_b128 v[76:79], v5 offset:7168
    s_waitcnt lgkmcnt(6)
    v_smfmac_f32_16x16x64_bf16 v[112:115], v[44:47], v[80:87], v2
    ds_read_b128 v[80:83], v5 offset:20480
    ds_read_b128 v[84:87], v5 offset:21504
    s_waitcnt lgkmcnt(6)
    v_smfmac_f32_16x16x64_bf16 v[116:119], v[44:47], v[88:95], v2
    ds_read_b128 v[88:91], v5 offset:22528
    ds_read_b128 v[92:95], v5 offset:23552
    s_waitcnt lgkmcnt(6)
    v_smfmac_f32_16x16x64_bf16 v[112:115], v[48:51], v[64:71], v2
    ds_read_b128 v[64:67], v5 offset:36864
    ds_read_b128 v[68:71], v5 offset:37888
    s_waitcnt lgkmcnt(6)
    v_smfmac_f32_16x16x64_bf16 v[116:119], v[48:51], v[72:79], v2
    ds_read_b128 v[72:75], v5 offset:38912
    ds_read_b128 v[76:79], v5 offset:39936
    s_waitcnt lgkmcnt(6)
    v_smfmac_f32_16x16x64_bf16 v[112:115], v[52:55], v[80:87], v2
    ds_read_b128 v[80:83], v5 offset:53248
    ds_read_b128 v[84:87], v5 offset:54272
    s_waitcnt lgkmcnt(6)
    v_smfmac_f32_16x16x64_bf16 v[116:119], v[52:55], v[88:95], v2
    ds_read_b128 v[88:91], v5 offset:55296
    ds_read_b128 v[92:95], v5 offset:56320
    s_waitcnt lgkmcnt(6)
    v_smfmac_f32_16x16x64_bf16 v[112:115], v[56:59], v[64:71], v2
    s_waitcnt lgkmcnt(4)
    v_smfmac_f32_16x16x64_bf16 v[116:119], v[56:59], v[72:79], v2
    s_waitcnt lgkmcnt(2)
    v_smfmac_f32_16x16x64_bf16 v[112:115], v[60:63], v[80:87], v2
    s_waitcnt lgkmcnt(0)
    v_smfmac_f32_16x16x64_bf16 v[116:119], v[60:63], v[88:95], v2
    buffer_load_dwordx2 v[108:109], v11, s[4:7], s38 offen sc1
    v_mfma_f32_16x16x16_bf16 v[100:103], v[96:97], v[16:17], 0
    v_mfma_f32_16x16x16_bf16 v[104:107], v[98:99], v[16:17], 0
    s_nop 4
    v_add_f32 v112, v112, v114
    v_add_f32 v113, v113, v115
    v_add_f32 v114, v116, v118
    v_add_f32 v115, v117, v119
    v_cvt_pk_bf16_f32 v18, v112, v113
    v_cvt_pk_bf16_f32 v19, v114, v115
    v_and_or_b32 v18, v18, -2, s41
    buffer_load_dwordx2 v[110:111], v11, s[4:7], s38 offen offset:512 sc1
    s_barrier
    buffer_store_dwordx2 v[18:19], v11, s[4:7], s39 offen sc1
    v_mov_b32 v112, v18
    v_mov_b32 v114, v19
    v_mov_b32 v92, v28
    v_mov_b32 v93, 0
    s_waitcnt vmcnt(5)
    s_barrier
    ds_read_b128 v[32:35], v6 offset:14336
    ds_read_b128 v[36:39], v6 offset:15360
    ds_read_b128 v[40:43], v6 offset:9216
    ds_read_b128 v[44:47], v6 offset:10240
    ds_read_b128 v[48:51], v6 offset:24576
    ds_read_b128 v[52:55], v6 offset:25600
    ds_read_b128 v[56:59], v6 offset:19456
    ds_read_b128 v[60:63], v6 offset:20480
    buffer_load_dwordx2 v[20:21], v11, s[4:7], s38 offen sc1
    buffer_load_dwordx2 v[22:23], v11, s[4:7], s38 offen offset:512 sc1
    s_waitcnt vmcnt(4)
    v_mfma_f32_16x16x16_bf16 v[80:83], v[108:109], v[16:17], v[100:103]
    v_and_b32 v3, 1, v108
    v_cmp_ne_u32 vcc, s41, v3
    s_nop 5
    v_cvt_pk_bf16_f32 v64, v80, v81
    v_cvt_pk_bf16_f32 v65, v82, v83
    s_cbranch_vccnz mega_kernel_rf_w1_xslow
    s_waitcnt vmcnt(3)
    v_mfma_f32_16x16x16_bf16 v[84:87], v[110:111], v[16:17], v[104:107]
    v_and_b32 v3, 1, v110
    v_cmp_ne_u32 vcc, s41, v3
    s_nop 5
    v_cvt_pk_bf16_f32 v66, v84, v85
    v_cvt_pk_bf16_f32 v67, v86, v87
    ds_write_b128 v6, v[64:67] offset:13312
    s_cbranch_vccnz mega_kernel_rf_w1_xslow
mega_kernel_rf_w1_xok:
    s_cmp_eq_u32 s21, 63
    s_cbranch_scc1 mega_kernel_rf_w1_last
    buffer_load_dwordx2 v[116:117], v11, s[4:7], s40 offen sc1
    s_waitcnt lgkmcnt(1)
    v_mfma_f32_16x16x32_bf16 v[80:83], v[32:35], v[64:67], 0
    s_waitcnt lgkmcnt(0)
    s_barrier
    ds_read_b128 v[68:71], v6 offset:8192
    ds_read_b128 v[72:75], v6 offset:23552
    ds_read_b128 v[76:79], v6 offset:18432
    v_mfma_f32_16x16x32_bf16 v[84:87], v[36:39], v[64:67], 0
    v_mfma_f32_16x16x32_bf16 v[88:91], v[64:67], v[64:67], 0
    buffer_load_dwordx2 v[20:21], v11, s[4:7], s40 offen sc1
    s_waitcnt lgkmcnt(2)
    v_mfma_f32_16x16x32_bf16 v[80:83], v[40:43], v[68:71], v[80:83]
    s_waitcnt lgkmcnt(1)
    v_mfma_f32_16x16x32_bf16 v[80:83], v[48:51], v[72:75], v[80:83]
    buffer_store_dwordx4 v[64:67], v10, s[4:7], s45 offen offset:64 sc1
    s_waitcnt lgkmcnt(0)
    v_mfma_f32_16x16x32_bf16 v[80:83], v[56:59], v[76:79], v[80:83]
    v_mfma_f32_16x16x32_bf16 v[84:87], v[44:47], v[68:71], v[84:87]
    v_mfma_f32_16x16x32_bf16 v[84:87], v[52:55], v[72:75], v[84:87]
    v_mfma_f32_16x16x32_bf16 v[84:87], v[60:63], v[76:79], v[84:87]
    buffer_store_dwordx2 v[18:19], v11, s[4:7], s51 offen offset:2560 sc1
    v_mfma_f32_16x16x32_bf16 v[88:91], v[68:71], v[68:71], v[88:91]
    v_mfma_f32_16x16x32_bf16 v[88:91], v[72:75], v[72:75], v[88:91]
    v_mfma_f32_16x16x32_bf16 v[88:91], v[76:79], v[76:79], v[88:91]
    v_mfma_f32_32x32x4_2b_bf16 v[32:63], v[14:15], v[14:15], 0
    s_nop 0
    v_max3_f32 v4, v80, v81, v82
    s_nop 1
    v_max3_f32 v4, v4, v83, v84
    v_max3_f32 v4, v4, v85, v86
    v_max_f32 v4, v4, v87
    v_max3_f32 v90, v4, v88, v89
    v_max3_f32 v4, v4, v88, v89
    s_nop 1
    v_permlane16_swap_b32 v4, v90
    v_max_f32 v4, v4, v90
    v_max_f32 v90, v4, v90
    s_nop 1
    v_permlane32_swap_b32 v4, v90
    v_max_f32 v4, v4, v90
    v_mul_f32 v4, s34, v4
    v_pk_fma_f32 v[80:81], v[80:81], s[34:35], v[4:5] op_sel_hi:[1,0,0] neg_lo:[0,0,1] neg_hi:[0,0,1]
    v_pk_fma_f32 v[82:83], v[82:83], s[34:35], v[4:5] op_sel_hi:[1,0,0] neg_lo:[0,0,1] neg_hi:[0,0,1]
    v_pk_fma_f32 v[84:85], v[84:85], s[34:35], v[4:5] op_sel_hi:[1,0,0] neg_lo:[0,0,1] neg_hi:[0,0,1]
    v_pk_fma_f32 v[86:87], v[86:87], s[34:35], v[4:5] op_sel_hi:[1,0,0] neg_lo:[0,0,1] neg_hi:[0,0,1]
    v_pk_fma_f32 v[88:89], v[88:89], s[34:35], v[4:5] op_sel_hi:[1,0,0] neg_lo:[0,0,1] neg_hi:[0,0,1]
    v_exp_f32 v80, v80
    v_exp_f32 v81, v81
    v_exp_f32 v82, v82
    v_cvt_pk_bf16_f32 v68, v80, v81
    v_exp_f32 v83, v83
    v_exp_f32 v84, v84
    v_cvt_pk_bf16_f32 v69, v82, v83
    v_exp_f32 v85, v85
    v_exp_f32 v86, v86
    v_cvt_pk_bf16_f32 v70, v84, v85
    v_exp_f32 v87, v87
    v_exp_f32 v88, v88
    v_cvt_pk_bf16_f32 v71, v86, v87
    v_exp_f32 v89, v89
    s_waitcnt vmcnt(3)
    v_mfma_f32_16x16x32_bf16 v[76:79], v[28:31], v[68:71], 0
    v_and_b32 v3, 1, v116
    v_cvt_pk_bf16_f32 v72, v88, v89
    v_mfma_f32_16x16x32_bf16 v[100:103], v[120:123], v[68:71], 0
    v_cmp_ne_u32 vcc, s41, v3
    v_cvt_pk_bf16_f32 v73, v88, v89
    v_mfma_f32_16x16x32_bf16 v[104:107], v[124:127], v[68:71], 0
    v_mov_b32 v113, v116
    v_mov_b32 v115, v117
    v_mfma_f32_16x16x16_bf16 v[76:79], v[92:93], v[72:73], v[76:79]
    s_cbranch_vccnz mega_kernel_rf_w1_pv0
mega_kernel_rf_w1_pv2:
    v_mfma_f32_16x16x16_bf16 v[100:103], v[112:113], v[72:73], v[100:103]
    v_mfma_f32_16x16x16_bf16 v[104:107], v[114:115], v[72:73], v[104:107]
    buffer_load_dwordx4 v[120:123], v1, s[4:7], s44 offen
    buffer_load_dwordx4 v[124:127], v1, s[4:7], s44 offen offset:1024
    s_nop 2
    v_rcp_f32 v76, v76
    s_mov_b64 exec, s[28:29]
    v_pk_mul_f32 v[100:101], v[100:101], v[76:77] op_sel_hi:[1,0]
    v_pk_mul_f32 v[102:103], v[102:103], v[76:77] op_sel_hi:[1,0]
    v_pk_mul_f32 v[104:105], v[104:105], v[76:77] op_sel_hi:[1,0]
    v_pk_mul_f32 v[106:107], v[106:107], v[76:77] op_sel_hi:[1,0]
    v_cvt_pk_bf16_f32 v84, v100, v101
    v_cvt_pk_bf16_f32 v85, v102, v103
    v_cvt_pk_bf16_f32 v86, v104, v105
    v_cvt_pk_bf16_f32 v87, v106, v107
    ds_write_b128 v6, v[84:87] offset:28672
    s_mov_b64 exec, -1
    s_waitcnt lgkmcnt(0)
    s_barrier
    ds_read_b128 v[68:71], v6 offset:28672
    ds_read_b128 v[72:75], v6 offset:29696
    s_waitcnt lgkmcnt(1)
    v_smfmac_f32_16x16x64_bf16 v[32:35], v[68:71], v[128:135], v2
    s_add_u32 s21, s21, 1
    s_xor_b32 s38, s38, 1048576
    s_xor_b32 s37, s37, 1048576
    s_waitcnt lgkmcnt(0)
    v_smfmac_f32_16x16x64_bf16 v[32:35], v[72:75], v[136:143], v2
    s_xor_b32 s40, s40, 1048576
    s_xor_b32 s39, s39, 1048576
    s_lshr_b32 s41, s21, 1
    v_smfmac_f32_16x16x64_bf16 v[36:39], v[68:71], v[144:151], v2
    s_and_b32 s41, s41, 1
    s_xor_b32 s41, s41, 1
    s_xor_b32 s35, s35, 16384
    v_smfmac_f32_16x16x64_bf16 v[36:39], v[72:75], v[152:159], v2
    v_add_f32 v32, v32, v34
    s_xor_b32 s36, s36, 16384
    s_add_u32 s43, s43, 262144
    s_add_u32 s44, s44, 262144
    v_smfmac_f32_16x16x64_bf16 v[40:43], v[68:71], v[160:167], v2
    v_add_f32 v33, v33, v35
    v_smfmac_f32_16x16x64_bf16 v[40:43], v[72:75], v[168:175], v2
    v_cvt_pk_bf16_f32 v32, v32, v33
    v_smfmac_f32_16x16x64_bf16 v[44:47], v[68:71], v[176:183], v2
    v_and_or_b32 v32, v32, -2, s42
    v_smfmac_f32_16x16x64_bf16 v[44:47], v[72:75], v[184:191], v2
    v_add_f32 v36, v36, v38
    v_smfmac_f32_16x16x64_bf16 v[48:51], v[68:71], v[192:199], v2
    v_add_f32 v37, v37, v39
    v_smfmac_f32_16x16x64_bf16 v[48:51], v[72:75], v[200:207], v2
    v_cvt_pk_bf16_f32 v33, v36, v37
    v_smfmac_f32_16x16x64_bf16 v[52:55], v[68:71], v[208:215], v2
    v_add_f32 v40, v40, v42
    v_smfmac_f32_16x16x64_bf16 v[52:55], v[72:75], v[216:223], v2
    v_add_f32 v41, v41, v43
    v_smfmac_f32_16x16x64_bf16 v[56:59], v[68:71], v[224:231], v2
    v_cvt_pk_bf16_f32 v34, v40, v41
    v_smfmac_f32_16x16x64_bf16 v[56:59], v[72:75], v[232:239], v2
    v_add_f32 v44, v44, v46
    v_smfmac_f32_16x16x64_bf16 v[60:63], v[68:71], v[240:247], v2
    v_add_f32 v45, v45, v47
    v_smfmac_f32_16x16x64_bf16 v[60:63], v[72:75], v[248:255], v2
    v_cvt_pk_bf16_f32 v35, v44, v45
    buffer_store_dwordx4 v[32:35], v8, s[4:7], s46 offen
    v_pk_add_f32 v[48:49], v[48:49], v[50:51]
    v_cvt_pk_bf16_f32 v48, v48, v49
    v_and_or_b32 v48, v48, -2, s42
    v_pk_add_f32 v[52:53], v[52:53], v[54:55]
    v_cvt_pk_bf16_f32 v49, v52, v53
    v_pk_add_f32 v[56:57], v[56:57], v[58:59]
    v_cvt_pk_bf16_f32 v50, v56, v57
    v_pk_add_f32 v[60:61], v[60:61], v[62:63]
    v_cvt_pk_bf16_f32 v51, v60, v61
    buffer_store_dwordx4 v[48:51], v8, s[4:7], s61 offen
    s_add_u32 s45, s45, 262144
    s_add_u32 s51, s51, 262144
    v_mfma_f32_32x32x8_bf16 v[96:111], v[14:15], v[14:15], 0
    v_mfma_f32_16x16x16_bf16 v[112:115], v[14:15], v[14:15], 0
    v_mfma_f32_16x16x16_bf16 v[116:119], v[14:15], v[14:15], 0
    ds_read_b128 v[64:67], v1 offset:4096
    ds_read_b128 v[68:71], v1 offset:5120
    ds_read_b128 v[72:75], v1 offset:6144
    ds_read_b128 v[76:79], v1 offset:7168
    ds_read_b128 v[80:83], v1 offset:20480
    ds_read_b128 v[84:87], v1 offset:21504
    ds_read_b128 v[88:91], v1 offset:22528
    ds_read_b128 v[92:95], v1 offset:23552
    v_mov_b32 v58, -1
    v_mov_b32 v59, -1
    s_waitcnt vmcnt(0)
mega_kernel_rf_w1_cgo:
mega_kernel_rf_w1_pc:
    buffer_load_dword v36, v13, s[4:7], s25 offen offset:0 sc1
    buffer_load_dword v37, v13, s[4:7], s25 offen offset:256 sc1
    buffer_load_dword v38, v13, s[4:7], s25 offen offset:512 sc1
    buffer_load_dword v39, v13, s[4:7], s25 offen offset:768 sc1
    buffer_load_dword v40, v13, s[4:7], s25 offen offset:1024 sc1
    buffer_load_dword v41, v13, s[4:7], s25 offen offset:1280 sc1
    buffer_load_dword v42, v13, s[4:7], s25 offen offset:1536 sc1
    buffer_load_dword v43, v13, s[4:7], s25 offen offset:1792 sc1
    s_waitcnt vmcnt(4)
    v_mfma_f32_16x16x32_bf16 v[52:55], v[36:39], v[24:27], 0
    v_bitop3_b32 v3, s42, v36, v37 bitop3:0x7e
    v_bitop3_b32 v4, s42, v38, v39 bitop3:0x7e
    s_waitcnt vmcnt(2)
    v_or_b32 v3, v3, v4
    v_bitop3_b32 v4, s42, v40, v41 bitop3:0x7e
    s_waitcnt vmcnt(0)
    v_mfma_f32_16x16x32_bf16 v[52:55], v[40:43], v[24:27], v[52:55]
    v_bitop3_b32 v56, s42, v42, v43 bitop3:0x7e
    v_or3_b32 v3, v3, v4, v56
    v_and_b32 v3, v0, v3
    v_cmp_ne_u32 vcc, 0, v3
    s_nop 3
    v_cvt_pk_bf16_f32 v56, v52, v53
    v_cvt_pk_bf16_f32 v57, v54, v55
    v_min_u32 v56, -2, v56
    s_cbranch_vccnz mega_kernel_rf_w1_pc
    s_mov_b64 exec, s[26:27]
    buffer_store_dwordx2 v[56:57], v9, s[4:7], s35 offen offset:256
    buffer_store_dwordx2 v[58:59], v9, s[4:7], s36 offen offset:256
    s_mov_b64 exec, -1
    s_xor_b32 s42, s42, 1
    s_branch mega_kernel_rf_w1_loop
mega_kernel_rf_w1_last:
    buffer_store_dwordx4 v[64:67], v10, s[4:7], s45 offen offset:64 sc1
    buffer_store_dwordx2 v[18:19], v11, s[4:7], s51 offen offset:2560 sc1
    s_branch mega_kernel_rf_end
mega_kernel_rf_w1_pafail:
    s_nop 7
    v_mov_b32 v96, 0
    v_mov_b32 v97, 0
    v_mov_b32 v98, 0
    v_mov_b32 v99, 0
    v_mov_b32 v100, 0
    v_mov_b32 v101, 0
    v_mov_b32 v102, 0
    v_mov_b32 v103, 0
    v_mov_b32 v104, 0
    v_mov_b32 v105, 0
    v_mov_b32 v106, 0
    v_mov_b32 v107, 0
    s_branch mega_kernel_rf_w1_pa
mega_kernel_rf_w1_xslow:
    buffer_load_dwordx2 v[108:109], v11, s[4:7], s38 offen sc1
    buffer_load_dwordx2 v[110:111], v11, s[4:7], s38 offen offset:512 sc1
    s_waitcnt vmcnt(2)
    v_bitop3_b32 v3, s41, v20, v22 bitop3:0x7e
    v_mfma_f32_16x16x16_bf16 v[80:83], v[20:21], v[16:17], v[100:103]
    v_and_b32 v3, 1, v3
    v_mfma_f32_16x16x16_bf16 v[84:87], v[22:23], v[16:17], v[104:107]
    v_cmp_ne_u32 vcc, 0, v3
    s_cbranch_vccz mega_kernel_rf_w1_xgot
    buffer_load_dwordx2 v[20:21], v11, s[4:7], s38 offen sc1
    buffer_load_dwordx2 v[22:23], v11, s[4:7], s38 offen offset:512 sc1
    s_waitcnt vmcnt(2)
    v_bitop3_b32 v3, s41, v108, v110 bitop3:0x7e
    v_mfma_f32_16x16x16_bf16 v[80:83], v[108:109], v[16:17], v[100:103]
    v_and_b32 v3, 1, v3
    v_mfma_f32_16x16x16_bf16 v[84:87], v[110:111], v[16:17], v[104:107]
    v_cmp_ne_u32 vcc, 0, v3
    s_cbranch_vccz mega_kernel_rf_w1_xgot
    s_branch mega_kernel_rf_w1_xslow
mega_kernel_rf_w1_xgot:
    s_nop 3
    v_cvt_pk_bf16_f32 v64, v80, v81
    v_cvt_pk_bf16_f32 v65, v82, v83
    v_cvt_pk_bf16_f32 v66, v84, v85
    v_cvt_pk_bf16_f32 v67, v86, v87
    ds_write_b128 v6, v[64:67] offset:13312
    s_branch mega_kernel_rf_w1_xok
mega_kernel_rf_w1_pv0:
    s_waitcnt vmcnt(2)
    s_branch mega_kernel_rf_w1_pv1
mega_kernel_rf_w1_pv:
    buffer_load_dwordx2 v[20:21], v11, s[4:7], s40 offen sc1
    s_waitcnt vmcnt(0)
mega_kernel_rf_w1_pv1:
    v_and_b32 v3, 1, v20
    v_cmp_ne_u32 vcc, s41, v3
    v_mov_b32 v113, v20
    v_mov_b32 v115, v21
    s_cbranch_vccnz mega_kernel_rf_w1_pv
    s_branch mega_kernel_rf_w1_pv2
mega_kernel_rf_w2_entry:
    v_mfma_f32_32x32x8_bf16 v[96:111], v[14:15], v[14:15], 0
    v_mfma_f32_16x16x16_bf16 v[112:115], v[14:15], v[14:15], 0
    v_mfma_f32_16x16x16_bf16 v[116:119], v[14:15], v[14:15], 0
    ds_read_b128 v[64:67], v1 offset:8192
    ds_read_b128 v[68:71], v1 offset:9216
    ds_read_b128 v[72:75], v1 offset:10240
    ds_read_b128 v[76:79], v1 offset:11264
    ds_read_b128 v[80:83], v1 offset:24576
    ds_read_b128 v[84:87], v1 offset:25600
    ds_read_b128 v[88:91], v1 offset:26624
    ds_read_b128 v[92:95], v1 offset:27648
    buffer_load_dwordx4 v[120:123], v1, s[4:7], s44 offen
    buffer_load_dwordx4 v[124:127], v1, s[4:7], s44 offen offset:1024
    s_add_u32 s44, s44, 262144
mega_kernel_rf_w2_loop:
    s_add_u32 s22, s35, 4096
    s_waitcnt vmcnt(0)
    buffer_load_dwordx4 v[48:51], v1, s[4:7], s22 offen sc1
    buffer_load_dwordx4 v[52:55], v1, s[4:7], s22 offen offset:1024 sc1
mega_kernel_rf_w2_pa:
    s_waitcnt vmcnt(1)
    ds_write_b128 v6, v[48:51] offset:4096
    s_waitcnt vmcnt(0)
    ds_write_b128 v6, v[52:55] offset:5120
    v_max3_u32 v3, v48, v50, v52
    v_max_u32 v3, v3, v54
    v_cmp_eq_u32 vcc, -1, v3
    v_smfmac_f32_16x16x64_bf16 v[96:99], v[48:51], a[64:71], v2
    buffer_load_dwordx4 v[48:51], v1, s[4:7], s22 offen sc1
    v_smfmac_f32_16x16x64_bf16 v[100:103], v[48:51], a[72:79], v2
    buffer_load_dwordx4 v[52:55], v1, s[4:7], s22 offen offset:1024 sc1
    v_smfmac_f32_16x16x64_bf16 v[104:107], v[48:51], a[192:199], v2
    s_cbranch_vccnz mega_kernel_rf_w2_pafail
    s_waitcnt lgkmcnt(0)
    s_barrier
    ds_read_b128 v[56:59], v6 offset:6144
    ds_read_b128 v[60:63], v6 offset:7168
    v_smfmac_f32_16x16x64_bf16 v[108:111], v[48:51], a[200:207], v2
    ds_read_b128 v[32:35], v6 offset:0
    v_smfmac_f32_16x16x64_bf16 v[96:99], v[52:55], a[80:87], v2
    ds_read_b128 v[36:39], v6 offset:1024
    v_smfmac_f32_16x16x64_bf16 v[100:103], v[52:55], a[88:95], v2
    ds_read_b128 v[40:43], v6 offset:2048
    v_smfmac_f32_16x16x64_bf16 v[104:107], v[52:55], a[208:215], v2
    ds_read_b128 v[44:47], v6 offset:3072
    v_smfmac_f32_16x16x64_bf16 v[108:111], v[52:55], a[216:223], v2
    s_waitcnt lgkmcnt(5)
    v_smfmac_f32_16x16x64_bf16 v[96:99], v[56:59], a[96:103], v2
    v_smfmac_f32_16x16x64_bf16 v[104:107], v[56:59], a[224:231], v2
    buffer_load_dwordx4 v1, s[4:7], s43 offen lds
    s_waitcnt lgkmcnt(4)
    v_smfmac_f32_16x16x64_bf16 v[96:99], v[60:63], a[112:119], v2
    v_smfmac_f32_16x16x64_bf16 v[104:107], v[60:63], a[240:247], v2
    s_waitcnt lgkmcnt(3)
    v_smfmac_f32_16x16x64_bf16 v[96:99], v[32:35], a[0:7], v2
    v_smfmac_f32_16x16x64_bf16 v[104:107], v[32:35], a[128:135], v2
    buffer_load_dwordx4 v1, s[4:7], s43 offen offset:1024 lds
    s_waitcnt lgkmcnt(2)
    v_smfmac_f32_16x16x64_bf16 v[96:99], v[36:39], a[16:23], v2
    v_smfmac_f32_16x16x64_bf16 v[104:107], v[36:39], a[144:151], v2
    s_waitcnt lgkmcnt(1)
    v_smfmac_f32_16x16x64_bf16 v[96:99], v[40:43], a[32:39], v2
    v_smfmac_f32_16x16x64_bf16 v[104:107], v[40:43], a[160:167], v2
    s_waitcnt lgkmcnt(0)
    v_smfmac_f32_16x16x64_bf16 v[96:99], v[44:47], a[48:55], v2
    v_smfmac_f32_16x16x64_bf16 v[104:107], v[44:47], a[176:183], v2
    v_smfmac_f32_16x16x64_bf16 v[100:103], v[56:59], a[104:111], v2
    s_nop 2
    v_smfmac_f32_16x16x64_bf16 v[100:103], v[60:63], a[120:127], v2
    s_nop 1
    v_add_f32 v96, v96, v98
    v_smfmac_f32_16x16x64_bf16 v[100:103], v[32:35], a[8:15], v2
    v_add_f32 v97, v97, v99
    v_add_f32 v104, v104, v106
    v_smfmac_f32_16x16x64_bf16 v[100:103], v[36:39], a[24:31], v2
    v_add_f32 v105, v105, v107
    v_cvt_pk_bf16_f32 v96, v96, v97
    v_smfmac_f32_16x16x64_bf16 v[100:103], v[40:43], a[40:47], v2
    v_cvt_pk_bf16_f32 v97, v104, v105
    v_and_or_b32 v96, v96, -2, s41
    v_smfmac_f32_16x16x64_bf16 v[100:103], v[44:47], a[56:63], v2
    buffer_store_dwordx2 v[96:97], v11, s[4:7], s37 offen sc1
    v_smfmac_f32_16x16x64_bf16 v[108:111], v[56:59], a[232:239], v2
    v_smfmac_f32_16x16x64_bf16 v[108:111], v[60:63], a[248:255], v2
    v_smfmac_f32_16x16x64_bf16 v[108:111], v[32:35], a[136:143], v2
    v_smfmac_f32_16x16x64_bf16 v[108:111], v[36:39], a[152:159], v2
    v_smfmac_f32_16x16x64_bf16 v[108:111], v[40:43], a[168:175], v2
    s_nop 2
    v_add_f32 v100, v100, v102
    v_smfmac_f32_16x16x64_bf16 v[108:111], v[44:47], a[184:191], v2
    v_add_f32 v101, v101, v103
    v_cvt_pk_bf16_f32 v98, v100, v101
    v_and_or_b32 v98, v98, -2, s41
    s_nop 4
    v_pk_add_f32 v[108:109], v[108:109], v[110:111]
    v_cvt_pk_bf16_f32 v99, v108, v109
    buffer_store_dwordx2 v[98:99], v11, s[4:7], s37 offen offset:512 sc1
    v_smfmac_f32_16x16x64_bf16 v[112:115], v[32:35], v[64:71], v2
    ds_read_b128 v[64:67], v1 offset:40960
    ds_read_b128 v[68:71], v1 offset:41984
    v_smfmac_f32_16x16x64_bf16 v[116:119], v[32:35], v[72:79], v2
    ds_read_b128 v[72:75], v1 offset:43008
    ds_read_b128 v[76:79], v1 offset:44032
    v_smfmac_f32_16x16x64_bf16 v[112:115], v[36:39], v[80:87], v2
    ds_read_b128 v[80:83], v1 offset:57344
    ds_read_b128 v[84:87], v1 offset:58368
    v_smfmac_f32_16x16x64_bf16 v[116:119], v[36:39], v[88:95], v2
    ds_read_b128 v[88:91], v1 offset:59392
    ds_read_b128 v[92:95], v1 offset:60416
    s_waitcnt lgkmcnt(6)
    v_smfmac_f32_16x16x64_bf16 v[112:115], v[40:43], v[64:71], v2
    ds_read_b128 v[64:67], v5 offset:8192
    ds_read_b128 v[68:71], v5 offset:9216
    s_waitcnt lgkmcnt(6)
    v_smfmac_f32_16x16x64_bf16 v[116:119], v[40:43], v[72:79], v2
    ds_read_b128 v[72:75], v5 offset:10240
    ds_read_b128 v[76:79], v5 offset:11264
    s_waitcnt lgkmcnt(6)
    v_smfmac_f32_16x16x64_bf16 v[112:115], v[44:47], v[80:87], v2
    ds_read_b128 v[80:83], v5 offset:24576
    ds_read_b128 v[84:87], v5 offset:25600
    s_waitcnt lgkmcnt(6)
    v_smfmac_f32_16x16x64_bf16 v[116:119], v[44:47], v[88:95], v2
    ds_read_b128 v[88:91], v5 offset:26624
    ds_read_b128 v[92:95], v5 offset:27648
    s_waitcnt lgkmcnt(6)
    v_smfmac_f32_16x16x64_bf16 v[112:115], v[48:51], v[64:71], v2
    ds_read_b128 v[64:67], v5 offset:40960
    ds_read_b128 v[68:71], v5 offset:41984
    s_waitcnt lgkmcnt(6)
    v_smfmac_f32_16x16x64_bf16 v[116:119], v[48:51], v[72:79], v2
    ds_read_b128 v[72:75], v5 offset:43008
    ds_read_b128 v[76:79], v5 offset:44032
    s_waitcnt lgkmcnt(6)
    v_smfmac_f32_16x16x64_bf16 v[112:115], v[52:55], v[80:87], v2
    ds_read_b128 v[80:83], v5 offset:57344
    ds_read_b128 v[84:87], v5 offset:58368
    s_waitcnt lgkmcnt(6)
    v_smfmac_f32_16x16x64_bf16 v[116:119], v[52:55], v[88:95], v2
    ds_read_b128 v[88:91], v5 offset:59392
    ds_read_b128 v[92:95], v5 offset:60416
    s_waitcnt lgkmcnt(6)
    v_smfmac_f32_16x16x64_bf16 v[112:115], v[56:59], v[64:71], v2
    s_waitcnt lgkmcnt(4)
    v_smfmac_f32_16x16x64_bf16 v[116:119], v[56:59], v[72:79], v2
    s_waitcnt lgkmcnt(2)
    v_smfmac_f32_16x16x64_bf16 v[112:115], v[60:63], v[80:87], v2
    s_waitcnt lgkmcnt(0)
    v_smfmac_f32_16x16x64_bf16 v[116:119], v[60:63], v[88:95], v2
    buffer_load_dwordx2 v[108:109], v11, s[4:7], s38 offen sc1
    v_mfma_f32_16x16x16_bf16 v[100:103], v[96:97], v[16:17], 0
    v_mfma_f32_16x16x16_bf16 v[104:107], v[98:99], v[16:17], 0
    s_nop 4
    v_add_f32 v112, v112, v114
    v_add_f32 v113, v113, v115
    v_add_f32 v114, v116, v118
    v_add_f32 v115, v117, v119
    v_cvt_pk_bf16_f32 v18, v112, v113
    v_cvt_pk_bf16_f32 v19, v114, v115
    v_and_or_b32 v18, v18, -2, s41
    buffer_load_dwordx2 v[110:111], v11, s[4:7], s38 offen offset:512 sc1
    s_barrier
    buffer_store_dwordx2 v[18:19], v11, s[4:7], s39 offen sc1
    v_mov_b32 v112, v18
    v_mov_b32 v114, v19
    v_mov_b32 v92, v28
    v_mov_b32 v93, 0
    s_waitcnt vmcnt(5)
    s_barrier
    ds_read_b128 v[32:35], v6 offset:19456
    ds_read_b128 v[36:39], v6 offset:20480
    ds_read_b128 v[40:43], v6 offset:24576
    ds_read_b128 v[44:47], v6 offset:25600
    ds_read_b128 v[48:51], v6 offset:9216
    ds_read_b128 v[52:55], v6 offset:10240
    ds_read_b128 v[56:59], v6 offset:14336
    ds_read_b128 v[60:63], v6 offset:15360
    buffer_load_dwordx2 v[20:21], v11, s[4:7], s38 offen sc1
    buffer_load_dwordx2 v[22:23], v11, s[4:7], s38 offen offset:512 sc1
    s_waitcnt vmcnt(4)
    v_mfma_f32_16x16x16_bf16 v[80:83], v[108:109], v[16:17], v[100:103]
    v_and_b32 v3, 1, v108
    v_cmp_ne_u32 vcc, s41, v3
    s_nop 5
    v_cvt_pk_bf16_f32 v64, v80, v81
    v_cvt_pk_bf16_f32 v65, v82, v83
    s_cbranch_vccnz mega_kernel_rf_w2_xslow
    s_waitcnt vmcnt(3)
    v_mfma_f32_16x16x16_bf16 v[84:87], v[110:111], v[16:17], v[104:107]
    v_and_b32 v3, 1, v110
    v_cmp_ne_u32 vcc, s41, v3
    s_nop 5
    v_cvt_pk_bf16_f32 v66, v84, v85
    v_cvt_pk_bf16_f32 v67, v86, v87
    ds_write_b128 v6, v[64:67] offset:18432
    s_cbranch_vccnz mega_kernel_rf_w2_xslow
mega_kernel_rf_w2_xok:
    s_cmp_eq_u32 s21, 63
    s_cbranch_scc1 mega_kernel_rf_w2_last
    buffer_load_dwordx2 v[116:117], v11, s[4:7], s40 offen sc1
    s_waitcnt lgkmcnt(1)
    v_mfma_f32_16x16x32_bf16 v[80:83], v[32:35], v[64:67], 0
    s_waitcnt lgkmcnt(0)
    s_barrier
    ds_read_b128 v[68:71], v6 offset:23552
    ds_read_b128 v[72:75], v6 offset:8192
    ds_read_b128 v[76:79], v6 offset:13312
    v_mfma_f32_16x16x32_bf16 v[84:87], v[36:39], v[64:67], 0
    v_mfma_f32_16x16x32_bf16 v[88:91], v[64:67], v[64:67], 0
    buffer_load_dwordx2 v[20:21], v11, s[4:7], s40 offen sc1
    s_waitcnt lgkmcnt(2)
    v_mfma_f32_16x16x32_bf16 v[80:83], v[40:43], v[68:71], v[80:83]
    s_waitcnt lgkmcnt(1)
    v_mfma_f32_16x16x32_bf16 v[80:83], v[48:51], v[72:75], v[80:83]
    s_waitcnt lgkmcnt(0)
    v_mfma_f32_16x16x32_bf16 v[80:83], v[56:59], v[76:79], v[80:83]
    buffer_store_dwordx4 v[64:67], v10, s[4:7], s45 offen offset:128 sc1
    v_mfma_f32_16x16x32_bf16 v[84:87], v[44:47], v[68:71], v[84:87]
    v_mfma_f32_16x16x32_bf16 v[84:87], v[52:55], v[72:75], v[84:87]
    v_mfma_f32_16x16x32_bf16 v[84:87], v[60:63], v[76:79], v[84:87]
    v_mfma_f32_16x16x32_bf16 v[88:91], v[68:71], v[68:71], v[88:91]
    buffer_store_dwordx2 v[18:19], v11, s[4:7], s51 offen offset:3072 sc1
    v_mfma_f32_16x16x32_bf16 v[88:91], v[72:75], v[72:75], v[88:91]
    v_mfma_f32_16x16x32_bf16 v[88:91], v[76:79], v[76:79], v[88:91]
    v_mfma_f32_32x32x4_2b_bf16 v[32:63], v[14:15], v[14:15], 0
    s_nop 0
    v_max3_f32 v4, v80, v81, v82
    s_nop 1
    v_max3_f32 v4, v4, v83, v84
    v_max3_f32 v4, v4, v85, v86
    v_max_f32 v4, v4, v87
    v_max3_f32 v90, v4, v88, v89
    v_max3_f32 v4, v4, v88, v89
    s_nop 1
    v_permlane16_swap_b32 v4, v90
    v_max_f32 v4, v4, v90
    v_max_f32 v90, v4, v90
    s_nop 1
    v_permlane32_swap_b32 v4, v90
    v_max_f32 v4, v4, v90
    v_mul_f32 v4, s34, v4
    v_pk_fma_f32 v[80:81], v[80:81], s[34:35], v[4:5] op_sel_hi:[1,0,0] neg_lo:[0,0,1] neg_hi:[0,0,1]
    v_pk_fma_f32 v[82:83], v[82:83], s[34:35], v[4:5] op_sel_hi:[1,0,0] neg_lo:[0,0,1] neg_hi:[0,0,1]
    v_pk_fma_f32 v[84:85], v[84:85], s[34:35], v[4:5] op_sel_hi:[1,0,0] neg_lo:[0,0,1] neg_hi:[0,0,1]
    v_pk_fma_f32 v[86:87], v[86:87], s[34:35], v[4:5] op_sel_hi:[1,0,0] neg_lo:[0,0,1] neg_hi:[0,0,1]
    v_pk_fma_f32 v[88:89], v[88:89], s[34:35], v[4:5] op_sel_hi:[1,0,0] neg_lo:[0,0,1] neg_hi:[0,0,1]
    v_exp_f32 v80, v80
    v_exp_f32 v81, v81
    v_exp_f32 v82, v82
    v_cvt_pk_bf16_f32 v68, v80, v81
    v_exp_f32 v83, v83
    v_exp_f32 v84, v84
    v_cvt_pk_bf16_f32 v69, v82, v83
    v_exp_f32 v85, v85
    v_exp_f32 v86, v86
    v_cvt_pk_bf16_f32 v70, v84, v85
    v_exp_f32 v87, v87
    v_exp_f32 v88, v88
    v_cvt_pk_bf16_f32 v71, v86, v87
    v_exp_f32 v89, v89
    s_waitcnt vmcnt(3)
    v_mfma_f32_16x16x32_bf16 v[76:79], v[28:31], v[68:71], 0
    v_and_b32 v3, 1, v116
    v_cvt_pk_bf16_f32 v72, v88, v89
    v_mfma_f32_16x16x32_bf16 v[100:103], v[120:123], v[68:71], 0
    v_cmp_ne_u32 vcc, s41, v3
    v_cvt_pk_bf16_f32 v73, v88, v89
    v_mfma_f32_16x16x32_bf16 v[104:107], v[124:127], v[68:71], 0
    v_mov_b32 v113, v116
    v_mov_b32 v115, v117
    v_mfma_f32_16x16x16_bf16 v[76:79], v[92:93], v[72:73], v[76:79]
    s_cbranch_vccnz mega_kernel_rf_w2_pv0
mega_kernel_rf_w2_pv2:
    v_mfma_f32_16x16x16_bf16 v[100:103], v[112:113], v[72:73], v[100:103]
    v_mfma_f32_16x16x16_bf16 v[104:107], v[114:115], v[72:73], v[104:107]
    buffer_load_dwordx4 v[120:123], v1, s[4:7], s44 offen
    buffer_load_dwordx4 v[124:127], v1, s[4:7], s44 offen offset:1024
    s_nop 2
    v_rcp_f32 v76, v76
    s_mov_b64 exec, s[28:29]
    v_pk_mul_f32 v[100:101], v[100:101], v[76:77] op_sel_hi:[1,0]
    v_pk_mul_f32 v[102:103], v[102:103], v[76:77] op_sel_hi:[1,0]
    v_pk_mul_f32 v[104:105], v[104:105], v[76:77] op_sel_hi:[1,0]
    v_pk_mul_f32 v[106:107], v[106:107], v[76:77] op_sel_hi:[1,0]
    v_cvt_pk_bf16_f32 v84, v100, v101
    v_cvt_pk_bf16_f32 v85, v102, v103
    v_cvt_pk_bf16_f32 v86, v104, v105
    v_cvt_pk_bf16_f32 v87, v106, v107
    ds_write_b128 v6, v[84:87] offset:29664
    s_mov_b64 exec, -1
    s_waitcnt lgkmcnt(0)
    s_barrier
    ds_read_b128 v[68:71], v6 offset:28672
    ds_read_b128 v[72:75], v6 offset:29696
    s_waitcnt lgkmcnt(1)
    v_smfmac_f32_16x16x64_bf16 v[32:35], v[68:71], v[128:135], v2
    s_add_u32 s21, s21, 1
    s_xor_b32 s38, s38, 1048576
    s_xor_b32 s37, s37, 1048576
    s_waitcnt lgkmcnt(0)
    v_smfmac_f32_16x16x64_bf16 v[32:35], v[72:75], v[136:143], v2
    s_xor_b32 s40, s40, 1048576
    s_xor_b32 s39, s39, 1048576
    s_lshr_b32 s41, s21, 1
    v_smfmac_f32_16x16x64_bf16 v[36:39], v[68:71], v[144:151], v2
    s_and_b32 s41, s41, 1
    s_xor_b32 s41, s41, 1
    s_xor_b32 s35, s35, 16384
    v_smfmac_f32_16x16x64_bf16 v[36:39], v[72:75], v[152:159], v2
    v_add_f32 v32, v32, v34
    s_xor_b32 s36, s36, 16384
    s_add_u32 s43, s43, 262144
    s_add_u32 s44, s44, 262144
    v_smfmac_f32_16x16x64_bf16 v[40:43], v[68:71], v[160:167], v2
    v_add_f32 v33, v33, v35
    v_smfmac_f32_16x16x64_bf16 v[40:43], v[72:75], v[168:175], v2
    v_cvt_pk_bf16_f32 v32, v32, v33
    v_smfmac_f32_16x16x64_bf16 v[44:47], v[68:71], v[176:183], v2
    v_and_or_b32 v32, v32, -2, s42
    v_smfmac_f32_16x16x64_bf16 v[44:47], v[72:75], v[184:191], v2
    v_add_f32 v36, v36, v38
    v_smfmac_f32_16x16x64_bf16 v[48:51], v[68:71], v[192:199], v2
    v_add_f32 v37, v37, v39
    v_smfmac_f32_16x16x64_bf16 v[48:51], v[72:75], v[200:207], v2
    v_cvt_pk_bf16_f32 v33, v36, v37
    v_smfmac_f32_16x16x64_bf16 v[52:55], v[68:71], v[208:215], v2
    v_add_f32 v40, v40, v42
    v_smfmac_f32_16x16x64_bf16 v[52:55], v[72:75], v[216:223], v2
    v_add_f32 v41, v41, v43
    v_smfmac_f32_16x16x64_bf16 v[56:59], v[68:71], v[224:231], v2
    v_cvt_pk_bf16_f32 v34, v40, v41
    v_smfmac_f32_16x16x64_bf16 v[56:59], v[72:75], v[232:239], v2
    v_add_f32 v44, v44, v46
    v_smfmac_f32_16x16x64_bf16 v[60:63], v[68:71], v[240:247], v2
    v_add_f32 v45, v45, v47
    v_smfmac_f32_16x16x64_bf16 v[60:63], v[72:75], v[248:255], v2
    v_cvt_pk_bf16_f32 v35, v44, v45
    buffer_store_dwordx4 v[32:35], v8, s[4:7], s46 offen
    v_pk_add_f32 v[48:49], v[48:49], v[50:51]
    v_cvt_pk_bf16_f32 v48, v48, v49
    v_and_or_b32 v48, v48, -2, s42
    v_pk_add_f32 v[52:53], v[52:53], v[54:55]
    v_cvt_pk_bf16_f32 v49, v52, v53
    v_pk_add_f32 v[56:57], v[56:57], v[58:59]
    v_cvt_pk_bf16_f32 v50, v56, v57
    v_pk_add_f32 v[60:61], v[60:61], v[62:63]
    v_cvt_pk_bf16_f32 v51, v60, v61
    buffer_store_dwordx4 v[48:51], v8, s[4:7], s61 offen
    s_add_u32 s45, s45, 262144
    s_add_u32 s51, s51, 262144
    v_mfma_f32_32x32x8_bf16 v[96:111], v[14:15], v[14:15], 0
    v_mfma_f32_16x16x16_bf16 v[112:115], v[14:15], v[14:15], 0
    v_mfma_f32_16x16x16_bf16 v[116:119], v[14:15], v[14:15], 0
    ds_read_b128 v[64:67], v1 offset:8192
    ds_read_b128 v[68:71], v1 offset:9216
    ds_read_b128 v[72:75], v1 offset:10240
    ds_read_b128 v[76:79], v1 offset:11264
    ds_read_b128 v[80:83], v1 offset:24576
    ds_read_b128 v[84:87], v1 offset:25600
    ds_read_b128 v[88:91], v1 offset:26624
    ds_read_b128 v[92:95], v1 offset:27648
    v_mov_b32 v58, -1
    v_mov_b32 v59, -1
    s_waitcnt vmcnt(0)
mega_kernel_rf_w2_cgo:
mega_kernel_rf_w2_pc:
    buffer_load_dword v36, v13, s[4:7], s25 offen offset:0 sc1
    buffer_load_dword v37, v13, s[4:7], s25 offen offset:256 sc1
    buffer_load_dword v38, v13, s[4:7], s25 offen offset:512 sc1
    buffer_load_dword v39, v13, s[4:7], s25 offen offset:768 sc1
    buffer_load_dword v40, v13, s[4:7], s25 offen offset:1024 sc1
    buffer_load_dword v41, v13, s[4:7], s25 offen offset:1280 sc1
    buffer_load_dword v42, v13, s[4:7], s25 offen offset:1536 sc1
    buffer_load_dword v43, v13, s[4:7], s25 offen offset:1792 sc1
    s_waitcnt vmcnt(4)
    v_mfma_f32_16x16x32_bf16 v[52:55], v[36:39], v[24:27], 0
    v_bitop3_b32 v3, s42, v36, v37 bitop3:0x7e
    v_bitop3_b32 v4, s42, v38, v39 bitop3:0x7e
    s_waitcnt vmcnt(2)
    v_or_b32 v3, v3, v4
    v_bitop3_b32 v4, s42, v40, v41 bitop3:0x7e
    s_waitcnt vmcnt(0)
    v_mfma_f32_16x16x32_bf16 v[52:55], v[40:43], v[24:27], v[52:55]
    v_bitop3_b32 v56, s42, v42, v43 bitop3:0x7e
    v_or3_b32 v3, v3, v4, v56
    v_and_b32 v3, v0, v3
    v_cmp_ne_u32 vcc, 0, v3
    s_nop 3
    v_cvt_pk_bf16_f32 v56, v52, v53
    v_cvt_pk_bf16_f32 v57, v54, v55
    v_min_u32 v56, -2, v56
    s_cbranch_vccnz mega_kernel_rf_w2_pc
    s_mov_b64 exec, s[26:27]
    buffer_store_dwordx2 v[56:57], v9, s[4:7], s35 offen offset:512
    buffer_store_dwordx2 v[58:59], v9, s[4:7], s36 offen offset:512
    s_mov_b64 exec, -1
    s_xor_b32 s42, s42, 1
    s_branch mega_kernel_rf_w2_loop
mega_kernel_rf_w2_last:
    buffer_store_dwordx4 v[64:67], v10, s[4:7], s45 offen offset:128 sc1
    buffer_store_dwordx2 v[18:19], v11, s[4:7], s51 offen offset:3072 sc1
    s_branch mega_kernel_rf_end
mega_kernel_rf_w2_pafail:
    s_nop 7
    v_mov_b32 v96, 0
    v_mov_b32 v97, 0
    v_mov_b32 v98, 0
    v_mov_b32 v99, 0
    v_mov_b32 v100, 0
    v_mov_b32 v101, 0
    v_mov_b32 v102, 0
    v_mov_b32 v103, 0
    v_mov_b32 v104, 0
    v_mov_b32 v105, 0
    v_mov_b32 v106, 0
    v_mov_b32 v107, 0
    s_branch mega_kernel_rf_w2_pa
mega_kernel_rf_w2_xslow:
    buffer_load_dwordx2 v[108:109], v11, s[4:7], s38 offen sc1
    buffer_load_dwordx2 v[110:111], v11, s[4:7], s38 offen offset:512 sc1
    s_waitcnt vmcnt(2)
    v_bitop3_b32 v3, s41, v20, v22 bitop3:0x7e
    v_mfma_f32_16x16x16_bf16 v[80:83], v[20:21], v[16:17], v[100:103]
    v_and_b32 v3, 1, v3
    v_mfma_f32_16x16x16_bf16 v[84:87], v[22:23], v[16:17], v[104:107]
    v_cmp_ne_u32 vcc, 0, v3
    s_cbranch_vccz mega_kernel_rf_w2_xgot
    buffer_load_dwordx2 v[20:21], v11, s[4:7], s38 offen sc1
    buffer_load_dwordx2 v[22:23], v11, s[4:7], s38 offen offset:512 sc1
    s_waitcnt vmcnt(2)
    v_bitop3_b32 v3, s41, v108, v110 bitop3:0x7e
    v_mfma_f32_16x16x16_bf16 v[80:83], v[108:109], v[16:17], v[100:103]
    v_and_b32 v3, 1, v3
    v_mfma_f32_16x16x16_bf16 v[84:87], v[110:111], v[16:17], v[104:107]
    v_cmp_ne_u32 vcc, 0, v3
    s_cbranch_vccz mega_kernel_rf_w2_xgot
    s_branch mega_kernel_rf_w2_xslow
mega_kernel_rf_w2_xgot:
    s_nop 3
    v_cvt_pk_bf16_f32 v64, v80, v81
    v_cvt_pk_bf16_f32 v65, v82, v83
    v_cvt_pk_bf16_f32 v66, v84, v85
    v_cvt_pk_bf16_f32 v67, v86, v87
    ds_write_b128 v6, v[64:67] offset:18432
    s_branch mega_kernel_rf_w2_xok
mega_kernel_rf_w2_pv0:
    s_waitcnt vmcnt(2)
    s_branch mega_kernel_rf_w2_pv1
mega_kernel_rf_w2_pv:
    buffer_load_dwordx2 v[20:21], v11, s[4:7], s40 offen sc1
    s_waitcnt vmcnt(0)
mega_kernel_rf_w2_pv1:
    v_and_b32 v3, 1, v20
    v_cmp_ne_u32 vcc, s41, v3
    v_mov_b32 v113, v20
    v_mov_b32 v115, v21
    s_cbranch_vccnz mega_kernel_rf_w2_pv
    s_branch mega_kernel_rf_w2_pv2
mega_kernel_rf_w3_entry:
    v_mfma_f32_32x32x8_bf16 v[96:111], v[14:15], v[14:15], 0
    v_mfma_f32_16x16x16_bf16 v[112:115], v[14:15], v[14:15], 0
    v_mfma_f32_16x16x16_bf16 v[116:119], v[14:15], v[14:15], 0
    ds_read_b128 v[64:67], v1 offset:12288
    ds_read_b128 v[68:71], v1 offset:13312
    ds_read_b128 v[72:75], v1 offset:14336
    ds_read_b128 v[76:79], v1 offset:15360
    ds_read_b128 v[80:83], v1 offset:28672
    ds_read_b128 v[84:87], v1 offset:29696
    ds_read_b128 v[88:91], v1 offset:30720
    ds_read_b128 v[92:95], v1 offset:31744
    buffer_load_dwordx4 v[120:123], v1, s[4:7], s44 offen
    buffer_load_dwordx4 v[124:127], v1, s[4:7], s44 offen offset:1024
    s_add_u32 s44, s44, 262144
mega_kernel_rf_w3_loop:
    s_add_u32 s22, s35, 6144
    s_waitcnt vmcnt(0)
    buffer_load_dwordx4 v[56:59], v1, s[4:7], s22 offen sc1
    buffer_load_dwordx4 v[60:63], v1, s[4:7], s22 offen offset:1024 sc1
mega_kernel_rf_w3_pa:
    s_waitcnt vmcnt(1)
    ds_write_b128 v6, v[56:59] offset:6144
    s_waitcnt vmcnt(0)
    ds_write_b128 v6, v[60:63] offset:7168
    v_max3_u32 v3, v56, v58, v60
    v_max_u32 v3, v3, v62
    v_cmp_eq_u32 vcc, -1, v3
    v_smfmac_f32_16x16x64_bf16 v[96:99], v[56:59], a[96:103], v2
    buffer_load_dwordx4 v[56:59], v1, s[4:7], s22 offen sc1
    v_smfmac_f32_16x16x64_bf16 v[100:103], v[56:59], a[104:111], v2
    buffer_load_dwordx4 v[60:63], v1, s[4:7], s22 offen offset:1024 sc1
    v_smfmac_f32_16x16x64_bf16 v[104:107], v[56:59], a[224:231], v2
    s_cbranch_vccnz mega_kernel_rf_w3_pafail
    s_waitcnt lgkmcnt(0)
    s_barrier
    ds_read_b128 v[32:35], v6 offset:0
    ds_read_b128 v[36:39], v6 offset:1024
    v_smfmac_f32_16x16x64_bf16 v[108:111], v[56:59], a[232:239], v2
    ds_read_b128 v[40:43], v6 offset:2048
    v_smfmac_f32_16x16x64_bf16 v[96:99], v[60:63], a[112:119], v2
    ds_read_b128 v[44:47], v6 offset:3072
    v_smfmac_f32_16x16x64_bf16 v[100:103], v[60:63], a[120:127], v2
    ds_read_b128 v[48:51], v6 offset:4096
    v_smfmac_f32_16x16x64_bf16 v[104:107], v[60:63], a[240:247], v2
    ds_read_b128 v[52:55], v6 offset:5120
    v_smfmac_f32_16x16x64_bf16 v[108:111], v[60:63], a[248:255], v2
    s_waitcnt lgkmcnt(5)
    v_smfmac_f32_16x16x64_bf16 v[96:99], v[32:35], a[0:7], v2
    v_smfmac_f32_16x16x64_bf16 v[104:107], v[32:35], a[128:135], v2
    s_waitcnt lgkmcnt(4)
    v_smfmac_f32_16x16x64_bf16 v[96:99], v[36:39], a[16:23], v2
    buffer_load_dwordx4 v1, s[4:7], s43 offen lds
    v_smfmac_f32_16x16x64_bf16 v[104:107], v[36:39], a[144:151], v2
    s_waitcnt lgkmcnt(3)
    v_smfmac_f32_16x16x64_bf16 v[96:99], v[40:43], a[32:39], v2
    v_smfmac_f32_16x16x64_bf16 v[104:107], v[40:43], a[160:167], v2
    s_waitcnt lgkmcnt(2)
    v_smfmac_f32_16x16x64_bf16 v[96:99], v[44:47], a[48:55], v2
    buffer_load_dwordx4 v1, s[4:7], s43 offen offset:1024 lds
    v_smfmac_f32_16x16x64_bf16 v[104:107], v[44:47], a[176:183], v2
    s_waitcnt lgkmcnt(1)
    v_smfmac_f32_16x16x64_bf16 v[96:99], v[48:51], a[64:71], v2
    v_smfmac_f32_16x16x64_bf16 v[104:107], v[48:51], a[192:199], v2
    s_waitcnt lgkmcnt(0)
    v_smfmac_f32_16x16x64_bf16 v[96:99], v[52:55], a[80:87], v2
    buffer_load_dword v12, v7, s[4:7], 0 offen sc1
    v_smfmac_f32_16x16x64_bf16 v[104:107], v[52:55], a[208:215], v2
    v_smfmac_f32_16x16x64_bf16 v[100:103], v[32:35], a[8:15], v2
    s_nop 2
    v_smfmac_f32_16x16x64_bf16 v[100:103], v[36:39], a[24:31], v2
    s_nop 1
    v_add_f32 v96, v96, v98
    v_smfmac_f32_16x16x64_bf16 v[100:103], v[40:43], a[40:47], v2
    v_add_f32 v97, v97, v99
    v_add_f32 v104, v104, v106
    v_smfmac_f32_16x16x64_bf16 v[100:103], v[44:47], a[56:63], v2
    v_add_f32 v105, v105, v107
    v_cvt_pk_bf16_f32 v96, v96, v97
    v_smfmac_f32_16x16x64_bf16 v[100:103], v[48:51], a[72:79], v2
    v_cvt_pk_bf16_f32 v97, v104, v105
    v_and_or_b32 v96, v96, -2, s41
    v_smfmac_f32_16x16x64_bf16 v[100:103], v[52:55], a[88:95], v2
    buffer_store_dwordx2 v[96:97], v11, s[4:7], s37 offen sc1
    v_smfmac_f32_16x16x64_bf16 v[108:111], v[32:35], a[136:143], v2
    v_smfmac_f32_16x16x64_bf16 v[108:111], v[36:39], a[152:159], v2
    v_smfmac_f32_16x16x64_bf16 v[108:111], v[40:43], a[168:175], v2
    v_smfmac_f32_16x16x64_bf16 v[108:111], v[44:47], a[184:191], v2
    v_smfmac_f32_16x16x64_bf16 v[108:111], v[48:51], a[200:207], v2
    s_nop 2
    v_add_f32 v100, v100, v102
    v_smfmac_f32_16x16x64_bf16 v[108:111], v[52:55], a[216:223], v2
    v_add_f32 v101, v101, v103
    v_cvt_pk_bf16_f32 v98, v100, v101
    v_and_or_b32 v98, v98, -2, s41
    s_nop 4
    v_pk_add_f32 v[108:109], v[108:109], v[110:111]
    v_cvt_pk_bf16_f32 v99, v108, v109
    buffer_store_dwordx2 v[98:99], v11, s[4:7], s37 offen offset:512 sc1
    v_smfmac_f32_16x16x64_bf16 v[112:115], v[32:35], v[64:71], v2
    ds_read_b128 v[64:67], v1 offset:45056
    ds_read_b128 v[68:71], v1 offset:46080
    v_smfmac_f32_16x16x64_bf16 v[116:119], v[32:35], v[72:79], v2
    ds_read_b128 v[72:75], v1 offset:47104
    ds_read_b128 v[76:79], v1 offset:48128
    v_smfmac_f32_16x16x64_bf16 v[112:115], v[36:39], v[80:87], v2
    ds_read_b128 v[80:83], v1 offset:61440
    ds_read_b128 v[84:87], v1 offset:62464
    v_smfmac_f32_16x16x64_bf16 v[116:119], v[36:39], v[88:95], v2
    ds_read_b128 v[88:91], v1 offset:63488
    ds_read_b128 v[92:95], v1 offset:64512
    s_waitcnt lgkmcnt(6)
    v_smfmac_f32_16x16x64_bf16 v[112:115], v[40:43], v[64:71], v2
    ds_read_b128 v[64:67], v5 offset:12288
    ds_read_b128 v[68:71], v5 offset:13312
    s_waitcnt lgkmcnt(6)
    v_smfmac_f32_16x16x64_bf16 v[116:119], v[40:43], v[72:79], v2
    ds_read_b128 v[72:75], v5 offset:14336
    ds_read_b128 v[76:79], v5 offset:15360
    s_waitcnt lgkmcnt(6)
    v_smfmac_f32_16x16x64_bf16 v[112:115], v[44:47], v[80:87], v2
    ds_read_b128 v[80:83], v5 offset:28672
    ds_read_b128 v[84:87], v5 offset:29696
    s_waitcnt lgkmcnt(6)
    v_smfmac_f32_16x16x64_bf16 v[116:119], v[44:47], v[88:95], v2
    ds_read_b128 v[88:91], v5 offset:30720
    ds_read_b128 v[92:95], v5 offset:31744
    s_waitcnt lgkmcnt(6)
    v_smfmac_f32_16x16x64_bf16 v[112:115], v[48:51], v[64:71], v2
    ds_read_b128 v[64:67], v5 offset:45056
    ds_read_b128 v[68:71], v5 offset:46080
    s_waitcnt lgkmcnt(6)
    v_smfmac_f32_16x16x64_bf16 v[116:119], v[48:51], v[72:79], v2
    ds_read_b128 v[72:75], v5 offset:47104
    ds_read_b128 v[76:79], v5 offset:48128
    s_waitcnt lgkmcnt(6)
    v_smfmac_f32_16x16x64_bf16 v[112:115], v[52:55], v[80:87], v2
    ds_read_b128 v[80:83], v5 offset:61440
    ds_read_b128 v[84:87], v5 offset:62464
    s_waitcnt lgkmcnt(6)
    v_smfmac_f32_16x16x64_bf16 v[116:119], v[52:55], v[88:95], v2
    ds_read_b128 v[88:91], v5 offset:63488
    ds_read_b128 v[92:95], v5 offset:64512
    s_waitcnt lgkmcnt(6)
    v_smfmac_f32_16x16x64_bf16 v[112:115], v[56:59], v[64:71], v2
    s_waitcnt lgkmcnt(4)
    v_smfmac_f32_16x16x64_bf16 v[116:119], v[56:59], v[72:79], v2
    s_waitcnt lgkmcnt(2)
    v_smfmac_f32_16x16x64_bf16 v[112:115], v[60:63], v[80:87], v2
    s_waitcnt lgkmcnt(0)
    v_smfmac_f32_16x16x64_bf16 v[116:119], v[60:63], v[88:95], v2
    buffer_load_dwordx2 v[108:109], v11, s[4:7], s38 offen sc1
    v_mfma_f32_16x16x16_bf16 v[100:103], v[96:97], v[16:17], 0
    v_mfma_f32_16x16x16_bf16 v[104:107], v[98:99], v[16:17], 0
    s_nop 4
    v_add_f32 v112, v112, v114
    v_add_f32 v113, v113, v115
    v_add_f32 v114, v116, v118
    v_add_f32 v115, v117, v119
    v_cvt_pk_bf16_f32 v18, v112, v113
    v_cvt_pk_bf16_f32 v19, v114, v115
    v_and_or_b32 v18, v18, -2, s41
    buffer_load_dwordx2 v[110:111], v11, s[4:7], s38 offen offset:512 sc1
    s_barrier
    buffer_store_dwordx2 v[18:19], v11, s[4:7], s39 offen sc1
    v_mov_b32 v112, v18
    v_mov_b32 v114, v19
    v_mov_b32 v92, v28
    v_mov_b32 v93, 0
    s_waitcnt vmcnt(6)
    s_barrier
    ds_read_b128 v[32:35], v6 offset:24576
    ds_read_b128 v[36:39], v6 offset:25600
    ds_read_b128 v[40:43], v6 offset:19456
    ds_read_b128 v[44:47], v6 offset:20480
    ds_read_b128 v[48:51], v6 offset:14336
    ds_read_b128 v[52:55], v6 offset:15360
    ds_read_b128 v[56:59], v6 offset:9216
    ds_read_b128 v[60:63], v6 offset:10240
    buffer_load_dwordx2 v[20:21], v11, s[4:7], s38 offen sc1
    buffer_load_dwordx2 v[22:23], v11, s[4:7], s38 offen offset:512 sc1
    s_waitcnt vmcnt(4)
    v_mfma_f32_16x16x16_bf16 v[80:83], v[108:109], v[16:17], v[100:103]
    v_and_b32 v3, 1, v108
    v_cmp_ne_u32 vcc, s41, v3
    s_nop 5
    v_cvt_pk_bf16_f32 v64, v80, v81
    v_cvt_pk_bf16_f32 v65, v82, v83
    s_cbranch_vccnz mega_kernel_rf_w3_xslow
    s_waitcnt vmcnt(3)
    v_mfma_f32_16x16x16_bf16 v[84:87], v[110:111], v[16:17], v[104:107]
    v_and_b32 v3, 1, v110
    v_cmp_ne_u32 vcc, s41, v3
    s_nop 5
    v_cvt_pk_bf16_f32 v66, v84, v85
    v_cvt_pk_bf16_f32 v67, v86, v87
    ds_write_b128 v6, v[64:67] offset:23552
    s_cbranch_vccnz mega_kernel_rf_w3_xslow
mega_kernel_rf_w3_xok:
    s_cmp_eq_u32 s21, 63
    s_cbranch_scc1 mega_kernel_rf_w3_last
    buffer_load_dwordx2 v[116:117], v11, s[4:7], s40 offen sc1
    s_waitcnt lgkmcnt(1)
    v_mfma_f32_16x16x32_bf16 v[80:83], v[32:35], v[64:67], 0
    s_waitcnt lgkmcnt(0)
    s_barrier
    ds_read_b128 v[68:71], v6 offset:18432
    ds_read_b128 v[72:75], v6 offset:13312
    ds_read_b128 v[76:79], v6 offset:8192
    v_mfma_f32_16x16x32_bf16 v[84:87], v[36:39], v[64:67], 0
    v_mfma_f32_16x16x32_bf16 v[88:91], v[64:67], v[64:67], 0
    buffer_load_dwordx2 v[20:21], v11, s[4:7], s40 offen sc1
    s_waitcnt lgkmcnt(2)
    v_mfma_f32_16x16x32_bf16 v[80:83], v[40:43], v[68:71], v[80:83]
    s_waitcnt lgkmcnt(1)
    v_mfma_f32_16x16x32_bf16 v[80:83], v[48:51], v[72:75], v[80:83]
    s_waitcnt lgkmcnt(0)
    v_mfma_f32_16x16x32_bf16 v[80:83], v[56:59], v[76:79], v[80:83]
    v_mfma_f32_16x16x32_bf16 v[84:87], v[44:47], v[68:71], v[84:87]
    buffer_store_dwordx4 v[64:67], v10, s[4:7], s45 offen offset:192 sc1
    v_mfma_f32_16x16x32_bf16 v[84:87], v[52:55], v[72:75], v[84:87]
    v_mfma_f32_16x16x32_bf16 v[84:87], v[60:63], v[76:79], v[84:87]
    v_mfma_f32_16x16x32_bf16 v[88:91], v[68:71], v[68:71], v[88:91]
    v_mfma_f32_16x16x32_bf16 v[88:91], v[72:75], v[72:75], v[88:91]
    buffer_store_dwordx2 v[18:19], v11, s[4:7], s51 offen offset:3584 sc1
    v_mfma_f32_16x16x32_bf16 v[88:91], v[76:79], v[76:79], v[88:91]
    v_mfma_f32_32x32x4_2b_bf16 v[32:63], v[14:15], v[14:15], 0
    s_nop 0
    v_max3_f32 v4, v80, v81, v82
    s_nop 1
    v_max3_f32 v4, v4, v83, v84
    v_max3_f32 v4, v4, v85, v86
    v_max_f32 v4, v4, v87
    v_max3_f32 v90, v4, v88, v89
    v_max3_f32 v4, v4, v88, v89
    s_nop 1
    v_permlane16_swap_b32 v4, v90
    v_max_f32 v4, v4, v90
    v_max_f32 v90, v4, v90
    s_nop 1
    v_permlane32_swap_b32 v4, v90
    v_max_f32 v4, v4, v90
    v_mul_f32 v4, s34, v4
    v_pk_fma_f32 v[80:81], v[80:81], s[34:35], v[4:5] op_sel_hi:[1,0,0] neg_lo:[0,0,1] neg_hi:[0,0,1]
    v_pk_fma_f32 v[82:83], v[82:83], s[34:35], v[4:5] op_sel_hi:[1,0,0] neg_lo:[0,0,1] neg_hi:[0,0,1]
    v_pk_fma_f32 v[84:85], v[84:85], s[34:35], v[4:5] op_sel_hi:[1,0,0] neg_lo:[0,0,1] neg_hi:[0,0,1]
    v_pk_fma_f32 v[86:87], v[86:87], s[34:35], v[4:5] op_sel_hi:[1,0,0] neg_lo:[0,0,1] neg_hi:[0,0,1]
    v_pk_fma_f32 v[88:89], v[88:89], s[34:35], v[4:5] op_sel_hi:[1,0,0] neg_lo:[0,0,1] neg_hi:[0,0,1]
    v_exp_f32 v80, v80
    v_exp_f32 v81, v81
    v_exp_f32 v82, v82
    v_cvt_pk_bf16_f32 v68, v80, v81
    v_exp_f32 v83, v83
    v_exp_f32 v84, v84
    v_cvt_pk_bf16_f32 v69, v82, v83
    v_exp_f32 v85, v85
    v_exp_f32 v86, v86
    v_cvt_pk_bf16_f32 v70, v84, v85
    v_exp_f32 v87, v87
    v_exp_f32 v88, v88
    v_cvt_pk_bf16_f32 v71, v86, v87
    v_exp_f32 v89, v89
    s_waitcnt vmcnt(3)
    v_mfma_f32_16x16x32_bf16 v[76:79], v[28:31], v[68:71], 0
    v_and_b32 v3, 1, v116
    v_cvt_pk_bf16_f32 v72, v88, v89
    v_mfma_f32_16x16x32_bf16 v[100:103], v[120:123], v[68:71], 0
    v_cmp_ne_u32 vcc, s41, v3
    v_cvt_pk_bf16_f32 v73, v88, v89
    v_mfma_f32_16x16x32_bf16 v[104:107], v[124:127], v[68:71], 0
    v_mov_b32 v113, v116
    v_mov_b32 v115, v117
    v_mfma_f32_16x16x16_bf16 v[76:79], v[92:93], v[72:73], v[76:79]
    s_cbranch_vccnz mega_kernel_rf_w3_pv0
mega_kernel_rf_w3_pv2:
    v_mfma_f32_16x16x16_bf16 v[100:103], v[112:113], v[72:73], v[100:103]
    v_mfma_f32_16x16x16_bf16 v[104:107], v[114:115], v[72:73], v[104:107]
    buffer_load_dwordx4 v[120:123], v1, s[4:7], s44 offen
    buffer_load_dwordx4 v[124:127], v1, s[4:7], s44 offen offset:1024
    s_nop 2
    v_rcp_f32 v76, v76
    s_mov_b64 exec, s[28:29]
    v_pk_mul_f32 v[100:101], v[100:101], v[76:77] op_sel_hi:[1,0]
    v_pk_mul_f32 v[102:103], v[102:103], v[76:77] op_sel_hi:[1,0]
    v_pk_mul_f32 v[104:105], v[104:105], v[76:77] op_sel_hi:[1,0]
    v_pk_mul_f32 v[106:107], v[106:107], v[76:77] op_sel_hi:[1,0]
    v_cvt_pk_bf16_f32 v84, v100, v101
    v_cvt_pk_bf16_f32 v85, v102, v103
    v_cvt_pk_bf16_f32 v86, v104, v105
    v_cvt_pk_bf16_f32 v87, v106, v107
    ds_write_b128 v6, v[84:87] offset:29696
    s_mov_b64 exec, -1
    s_waitcnt lgkmcnt(0)
    s_barrier
    ds_read_b128 v[68:71], v6 offset:28672
    ds_read_b128 v[72:75], v6 offset:29696
    s_waitcnt lgkmcnt(1)
    v_smfmac_f32_16x16x64_bf16 v[32:35], v[68:71], v[128:135], v2
    s_add_u32 s21, s21, 1
    s_xor_b32 s38, s38, 1048576
    s_xor_b32 s37, s37, 1048576
    s_waitcnt lgkmcnt(0)
    v_smfmac_f32_16x16x64_bf16 v[32:35], v[72:75], v[136:143], v2
    s_xor_b32 s40, s40, 1048576
    s_xor_b32 s39, s39, 1048576
    s_lshr_b32 s41, s21, 1
    v_smfmac_f32_16x16x64_bf16 v[36:39], v[68:71], v[144:151], v2
    s_and_b32 s41, s41, 1
    s_xor_b32 s41, s41, 1
    s_xor_b32 s35, s35, 16384
    v_smfmac_f32_16x16x64_bf16 v[36:39], v[72:75], v[152:159], v2
    v_add_f32 v32, v32, v34
    s_xor_b32 s36, s36, 16384
    s_add_u32 s43, s43, 262144
    s_add_u32 s44, s44, 262144
    v_smfmac_f32_16x16x64_bf16 v[40:43], v[68:71], v[160:167], v2
    v_add_f32 v33, v33, v35
    v_smfmac_f32_16x16x64_bf16 v[40:43], v[72:75], v[168:175], v2
    v_cvt_pk_bf16_f32 v32, v32, v33
    v_smfmac_f32_16x16x64_bf16 v[44:47], v[68:71], v[176:183], v2
    v_and_or_b32 v32, v32, -2, s42
    v_smfmac_f32_16x16x64_bf16 v[44:47], v[72:75], v[184:191], v2
    v_add_f32 v36, v36, v38
    v_smfmac_f32_16x16x64_bf16 v[48:51], v[68:71], v[192:199], v2
    v_add_f32 v37, v37, v39
    v_smfmac_f32_16x16x64_bf16 v[48:51], v[72:75], v[200:207], v2
    v_cvt_pk_bf16_f32 v33, v36, v37
    v_smfmac_f32_16x16x64_bf16 v[52:55], v[68:71], v[208:215], v2
    v_add_f32 v40, v40, v42
    v_smfmac_f32_16x16x64_bf16 v[52:55], v[72:75], v[216:223], v2
    v_add_f32 v41, v41, v43
    v_smfmac_f32_16x16x64_bf16 v[56:59], v[68:71], v[224:231], v2
    v_cvt_pk_bf16_f32 v34, v40, v41
    v_smfmac_f32_16x16x64_bf16 v[56:59], v[72:75], v[232:239], v2
    v_add_f32 v44, v44, v46
    v_smfmac_f32_16x16x64_bf16 v[60:63], v[68:71], v[240:247], v2
    v_add_f32 v45, v45, v47
    v_smfmac_f32_16x16x64_bf16 v[60:63], v[72:75], v[248:255], v2
    v_cvt_pk_bf16_f32 v35, v44, v45
    buffer_store_dwordx4 v[32:35], v8, s[4:7], s46 offen
    v_pk_add_f32 v[48:49], v[48:49], v[50:51]
    v_cvt_pk_bf16_f32 v48, v48, v49
    v_and_or_b32 v48, v48, -2, s42
    v_pk_add_f32 v[52:53], v[52:53], v[54:55]
    v_cvt_pk_bf16_f32 v49, v52, v53
    v_pk_add_f32 v[56:57], v[56:57], v[58:59]
    v_cvt_pk_bf16_f32 v50, v56, v57
    v_pk_add_f32 v[60:61], v[60:61], v[62:63]
    v_cvt_pk_bf16_f32 v51, v60, v61
    buffer_store_dwordx4 v[48:51], v8, s[4:7], s61 offen
    s_add_u32 s45, s45, 262144
    s_add_u32 s51, s51, 262144
    v_mfma_f32_32x32x8_bf16 v[96:111], v[14:15], v[14:15], 0
    v_mfma_f32_16x16x16_bf16 v[112:115], v[14:15], v[14:15], 0
    v_mfma_f32_16x16x16_bf16 v[116:119], v[14:15], v[14:15], 0
    ds_read_b128 v[64:67], v1 offset:12288
    ds_read_b128 v[68:71], v1 offset:13312
    ds_read_b128 v[72:75], v1 offset:14336
    ds_read_b128 v[76:79], v1 offset:15360
    ds_read_b128 v[80:83], v1 offset:28672
    ds_read_b128 v[84:87], v1 offset:29696
    ds_read_b128 v[88:91], v1 offset:30720
    ds_read_b128 v[92:95], v1 offset:31744
    s_add_u32 s22, s21, 2
    s_cmp_gt_u32 s50, s22
    s_cbranch_scc1 mega_kernel_rf_w3_kvs
    v_readlane_b32 s50, v12, 0
    v_readlane_b32 s22, v12, 2
    v_readlane_b32 s23, v12, 1
    v_readlane_b32 s24, v12, 3
    s_nop 3
    s_min_u32 s50, s50, s22
    s_min_u32 s23, s23, s24
    s_lshl_b32 s50, s50, 1
    s_lshl_b32 s23, s23, 1
    s_add_u32 s23, s23, 1
    s_min_u32 s50, s50, s23
mega_kernel_rf_kvb1:
    s_add_u32 s22, s21, 1
    s_min_u32 s22, s22, 63
    s_cmp_gt_u32 s50, s22
    s_cbranch_scc1 mega_kernel_rf_kvd1
    buffer_load_dword v12, v7, s[4:7], 0 offen sc1
    s_waitcnt vmcnt(0)
    v_readlane_b32 s50, v12, 0
    v_readlane_b32 s22, v12, 2
    v_readlane_b32 s23, v12, 1
    v_readlane_b32 s24, v12, 3
    s_nop 3
    s_min_u32 s50, s50, s22
    s_min_u32 s23, s23, s24
    s_lshl_b32 s50, s50, 1
    s_lshl_b32 s23, s23, 1
    s_add_u32 s23, s23, 1
    s_min_u32 s50, s50, s23
    s_branch mega_kernel_rf_kvb1
mega_kernel_rf_kvd1:
mega_kernel_rf_w3_kvs:
    v_mov_b32 v58, -1
    v_mov_b32 v59, -1
    s_waitcnt vmcnt(0)
mega_kernel_rf_w3_cgo:
mega_kernel_rf_w3_pc:
    buffer_load_dword v36, v13, s[4:7], s25 offen offset:0 sc1
    buffer_load_dword v37, v13, s[4:7], s25 offen offset:256 sc1
    buffer_load_dword v38, v13, s[4:7], s25 offen offset:512 sc1
    buffer_load_dword v39, v13, s[4:7], s25 offen offset:768 sc1
    buffer_load_dword v40, v13, s[4:7], s25 offen offset:1024 sc1
    buffer_load_dword v41, v13, s[4:7], s25 offen offset:1280 sc1
    buffer_load_dword v42, v13, s[4:7], s25 offen offset:1536 sc1
    buffer_load_dword v43, v13, s[4:7], s25 offen offset:1792 sc1
    s_waitcnt vmcnt(4)
    v_mfma_f32_16x16x32_bf16 v[52:55], v[36:39], v[24:27], 0
    v_bitop3_b32 v3, s42, v36, v37 bitop3:0x7e
    v_bitop3_b32 v4, s42, v38, v39 bitop3:0x7e
    s_waitcnt vmcnt(2)
    v_or_b32 v3, v3, v4
    v_bitop3_b32 v4, s42, v40, v41 bitop3:0x7e
    s_waitcnt vmcnt(0)
    v_mfma_f32_16x16x32_bf16 v[52:55], v[40:43], v[24:27], v[52:55]
    v_bitop3_b32 v56, s42, v42, v43 bitop3:0x7e
    v_or3_b32 v3, v3, v4, v56
    v_and_b32 v3, v0, v3
    v_cmp_ne_u32 vcc, 0, v3
    s_nop 3
    v_cvt_pk_bf16_f32 v56, v52, v53
    v_cvt_pk_bf16_f32 v57, v54, v55
    v_min_u32 v56, -2, v56
    s_cbranch_vccnz mega_kernel_rf_w3_pc
    s_mov_b64 exec, s[26:27]
    buffer_store_dwordx2 v[56:57], v9, s[4:7], s35 offen offset:768
    buffer_store_dwordx2 v[58:59], v9, s[4:7], s36 offen offset:768
    s_mov_b64 exec, -1
    s_xor_b32 s42, s42, 1
    s_branch mega_kernel_rf_w3_loop
mega_kernel_rf_w3_last:
    buffer_store_dwordx4 v[64:67], v10, s[4:7], s45 offen offset:192 sc1
    buffer_store_dwordx2 v[18:19], v11, s[4:7], s51 offen offset:3584 sc1
    s_branch mega_kernel_rf_end
mega_kernel_rf_w3_pafail:
    s_nop 7
    v_mov_b32 v96, 0
    v_mov_b32 v97, 0
    v_mov_b32 v98, 0
    v_mov_b32 v99, 0
    v_mov_b32 v100, 0
    v_mov_b32 v101, 0
    v_mov_b32 v102, 0
    v_mov_b32 v103, 0
    v_mov_b32 v104, 0
    v_mov_b32 v105, 0
    v_mov_b32 v106, 0
    v_mov_b32 v107, 0
    s_branch mega_kernel_rf_w3_pa
mega_kernel_rf_w3_xslow:
    buffer_load_dwordx2 v[108:109], v11, s[4:7], s38 offen sc1
    buffer_load_dwordx2 v[110:111], v11, s[4:7], s38 offen offset:512 sc1
    s_waitcnt vmcnt(2)
    v_bitop3_b32 v3, s41, v20, v22 bitop3:0x7e
    v_mfma_f32_16x16x16_bf16 v[80:83], v[20:21], v[16:17], v[100:103]
    v_and_b32 v3, 1, v3
    v_mfma_f32_16x16x16_bf16 v[84:87], v[22:23], v[16:17], v[104:107]
    v_cmp_ne_u32 vcc, 0, v3
    s_cbranch_vccz mega_kernel_rf_w3_xgot
    buffer_load_dwordx2 v[20:21], v11, s[4:7], s38 offen sc1
    buffer_load_dwordx2 v[22:23], v11, s[4:7], s38 offen offset:512 sc1
    s_waitcnt vmcnt(2)
    v_bitop3_b32 v3, s41, v108, v110 bitop3:0x7e
    v_mfma_f32_16x16x16_bf16 v[80:83], v[108:109], v[16:17], v[100:103]
    v_and_b32 v3, 1, v3
    v_mfma_f32_16x16x16_bf16 v[84:87], v[110:111], v[16:17], v[104:107]
    v_cmp_ne_u32 vcc, 0, v3
    s_cbranch_vccz mega_kernel_rf_w3_xgot
    s_branch mega_kernel_rf_w3_xslow
mega_kernel_rf_w3_xgot:
    s_nop 3
    v_cvt_pk_bf16_f32 v64, v80, v81
    v_cvt_pk_bf16_f32 v65, v82, v83
    v_cvt_pk_bf16_f32 v66, v84, v85
    v_cvt_pk_bf16_f32 v67, v86, v87
    ds_write_b128 v6, v[64:67] offset:23552
    s_branch mega_kernel_rf_w3_xok
mega_kernel_rf_w3_pv0:
    s_waitcnt vmcnt(2)
    s_branch mega_kernel_rf_w3_pv1
mega_kernel_rf_w3_pv:
    buffer_load_dwordx2 v[20:21], v11, s[4:7], s40 offen sc1
    s_waitcnt vmcnt(0)
mega_kernel_rf_w3_pv1:
    v_and_b32 v3, 1, v20
    v_cmp_ne_u32 vcc, s41, v3
    v_mov_b32 v113, v20
    v_mov_b32 v115, v21
    s_cbranch_vccnz mega_kernel_rf_w3_pv
    s_branch mega_kernel_rf_w3_pv2
mega_kernel_rf_end:
    s_mov_b64 exec, -1
    v_mov_b32 v3, 64
    s_waitcnt vmcnt(0)
    s_barrier
    s_cmp_lg_u32 s20, 0
    s_cbranch_scc1 mega_kernel_rf_end2
    buffer_store_dword v3, v7, s[4:7], 0 offen sc1
mega_kernel_rf_end2:
    s_waitcnt vmcnt(0)
    s_endpgm
mega_kernel_recs:
    s_load_dwordx2 s[4:5], s[0:1], 96
    s_load_dwordx2 s[12:13], s[0:1], 88
    s_load_dwordx2 s[50:51], s[0:1], 16
    s_load_dwordx2 s[52:53], s[0:1], 24
    s_load_dwordx2 s[54:55], s[0:1], 32
    s_load_dwordx2 s[56:57], s[0:1], 40
    s_load_dwordx2 s[58:59], s[0:1], 8
    v_lshrrev_b32 v3, 6, v0
    v_and_b32 v40, 63, v0
    v_readfirstlane_b32 s20, v3
    v_lshrrev_b32 v41, 4, v40
    v_and_b32 v42, 15, v40
    v_lshlrev_b32 v1, 4, v40
    s_mov_b32 s49, 0
    s_waitcnt lgkmcnt(0)
    s_mov_b32 s6, 268435456
    s_mov_b32 s7, 0x00020000
    s_mov_b32 s14, 256
    s_mov_b32 s15, 0x00020000
    s_mov_b32 s10, 8388608
    s_mov_b32 s11, 0x00020000
    s_mov_b32 s26, 0x00030003
    s_mov_b32 s27, 0x00030003
    s_mov_b32 s28, 0xcccccccc
    s_mov_b32 s29, 0xcccccccc
    s_mov_b32 s32, 0x33333333
    s_mov_b32 s33, 0x33333333
    s_mov_b32 s34, 0x3e0293ee
    s_lshl_b32 s22, s20, 2
    v_xor_b32 v3, s22, v42
    v_lshlrev_b32 v3, 4, v3
    v_lshl_add_u32 v4, v41, 4, s20
    v_lshl_add_u32 v44, v4, 13, v3
    s_lshl_b32 s22, s30, 22
    s_lshl_b32 s23, s31, 8
    s_add_u32 s22, s22, s23
    v_add_u32 v44, s22, v44
    s_lshr_b32 s22, s20, 1
    s_lshl_b32 s22, s22, 5
    s_and_b32 s23, s20, 1
    s_lshl_b32 s23, s23, 2
    s_add_u32 s22, s22, s23
    s_lshl_b32 s23, s31, 7
    s_add_u32 s22, s22, s23
    v_add_u32 v4, s22, v41
    v_lshl_add_u32 v45, v4, 11, v3
    s_lshl_b32 s22, s30, 10
    v_add_u32 v45, s22, v45
    s_lshl_b32 s48, s20, 10
    s_mov_b32 s8, s50
    s_mov_b32 s9, s51
    s_add_u32 m0, s48, 0
    s_mov_b32 s22, 0
    buffer_load_dwordx4 v44, s[8:11], s22 offen  lds
    s_add_u32 m0, s48, 4096
    s_mov_b32 s22, 32768
    buffer_load_dwordx4 v44, s[8:11], s22 offen  lds
    s_add_u32 m0, s48, 8192
    s_mov_b32 s22, 65536
    buffer_load_dwordx4 v44, s[8:11], s22 offen  lds
    s_add_u32 m0, s48, 12288
    s_mov_b32 s22, 98304
    buffer_load_dwordx4 v44, s[8:11], s22 offen  lds
    s_add_u32 m0, s48, 16384
    s_mov_b32 s22, 524288
    buffer_load_dwordx4 v44, s[8:11], s22 offen  lds
    s_add_u32 m0, s48, 20480
    s_mov_b32 s22, 557056
    buffer_load_dwordx4 v44, s[8:11], s22 offen  lds
    s_add_u32 m0, s48, 24576
    s_mov_b32 s22, 589824
    buffer_load_dwordx4 v44, s[8:11], s22 offen  lds
    s_add_u32 m0, s48, 28672
    s_mov_b32 s22, 622592
    buffer_load_dwordx4 v44, s[8:11], s22 offen  lds
    s_add_u32 m0, s48, 32768
    s_mov_b32 s22, 1048576
    buffer_load_dwordx4 v44, s[8:11], s22 offen  lds
    s_add_u32 m0, s48, 36864
    s_mov_b32 s22, 1081344
    buffer_load_dwordx4 v44, s[8:11], s22 offen  lds
    s_add_u32 m0, s48, 40960
    s_mov_b32 s22, 1114112
    buffer_load_dwordx4 v44, s[8:11], s22 offen  lds
    s_add_u32 m0, s48, 45056
    s_mov_b32 s22, 1146880
    buffer_load_dwordx4 v44, s[8:11], s22 offen  lds
    s_add_u32 m0, s48, 49152
    s_mov_b32 s22, 1572864
    buffer_load_dwordx4 v44, s[8:11], s22 offen  lds
    s_add_u32 m0, s48, 53248
    s_mov_b32 s22, 1605632
    buffer_load_dwordx4 v44, s[8:11], s22 offen  lds
    s_add_u32 m0, s48, 57344
    s_mov_b32 s22, 1638400
    buffer_load_dwordx4 v44, s[8:11], s22 offen  lds
    s_add_u32 m0, s48, 61440
    s_mov_b32 s22, 1671168
    buffer_load_dwordx4 v44, s[8:11], s22 offen  lds
    s_add_u32 m0, s48, 65536
    s_mov_b32 s22, 2097152
    buffer_load_dwordx4 v44, s[8:11], s22 offen  lds
    s_add_u32 m0, s48, 69632
    s_mov_b32 s22, 2129920
    buffer_load_dwordx4 v44, s[8:11], s22 offen  lds
    s_add_u32 m0, s48, 73728
    s_mov_b32 s22, 2162688
    buffer_load_dwordx4 v44, s[8:11], s22 offen  lds
    s_add_u32 m0, s48, 77824
    s_mov_b32 s22, 2195456
    buffer_load_dwordx4 v44, s[8:11], s22 offen  lds
    s_add_u32 m0, s48, 81920
    s_mov_b32 s22, 2621440
    buffer_load_dwordx4 v44, s[8:11], s22 offen  lds
    s_add_u32 m0, s48, 86016
    s_mov_b32 s22, 2654208
    buffer_load_dwordx4 v44, s[8:11], s22 offen  lds
    s_add_u32 m0, s48, 90112
    s_mov_b32 s22, 2686976
    buffer_load_dwordx4 v44, s[8:11], s22 offen  lds
    s_add_u32 m0, s48, 94208
    s_mov_b32 s22, 2719744
    buffer_load_dwordx4 v44, s[8:11], s22 offen  lds
    s_add_u32 m0, s48, 98304
    s_mov_b32 s22, 3145728
    buffer_load_dwordx4 v44, s[8:11], s22 offen  lds
    s_add_u32 m0, s48, 102400
    s_mov_b32 s22, 3178496
    buffer_load_dwordx4 v44, s[8:11], s22 offen  lds
    s_add_u32 m0, s48, 106496
    s_mov_b32 s22, 3211264
    buffer_load_dwordx4 v44, s[8:11], s22 offen  lds
    s_add_u32 m0, s48, 110592
    s_mov_b32 s22, 3244032
    buffer_load_dwordx4 v44, s[8:11], s22 offen  lds
    s_add_u32 m0, s48, 114688
    s_mov_b32 s22, 3670016
    buffer_load_dwordx4 v44, s[8:11], s22 offen  lds
    s_add_u32 m0, s48, 118784
    s_mov_b32 s22, 3702784
    buffer_load_dwordx4 v44, s[8:11], s22 offen  lds
    s_add_u32 m0, s48, 122880
    s_mov_b32 s22, 3735552
    buffer_load_dwordx4 v44, s[8:11], s22 offen  lds
    s_add_u32 m0, s48, 126976
    s_mov_b32 s22, 3768320
    buffer_load_dwordx4 v44, s[8:11], s22 offen  lds
    s_lshl_b32 s22, s30, 5
    s_add_u32 s22, s22, s31
    s_lshl_b32 s38, s22, 14
    s_xor_b32 s22, s22, 32
    s_lshl_b32 s37, s22, 14
    s_add_u32 s38, s38, 67108864
    s_add_u32 s37, s37, 67108864
    s_lshl_b32 s46, s30, 19
    s_add_u32 s46, s46, 70254592
    s_mul_i32 s22, s31, 8448
    s_add_u32 s47, s46, s22
    s_mul_i32 s22, s20, 67584
    s_add_u32 s46, s46, s22
    s_lshl_b32 s22, s31, 6
    s_add_u32 s46, s46, s22
    s_add_u32 s61, s46, 33792
    s_mul_i32 s22, s20, 2048
    s_add_u32 s25, s47, s22
    s_lshl_b32 s35, s30, 13
    s_add_u32 s35, s35, 69206016
    v_lshrrev_b32 v53, 2, v42
    v_lshlrev_b32 v53, 1, v53
    v_and_b32 v54, 1, v42
    v_add_u32 v55, v53, v54
    v_mov_b32 v14, 0
    v_mov_b32 v15, 0
    v_mov_b32 v2, 0x4444
    v_mov_b32 v3, 0xeeee
    v_cndmask_b32 v2, v2, v3, s[28:29]
    s_lshl_b32 s22, s20, 12
    v_add_u32 v32, s22, v1
    v_add_u32 v33, 0x10000, v32
    v_add_u32 v5, 0x10000, v1
    v_add_u32 v6, 131072, v1
    v_and_b32 v3, 3, v42
    v_bfe_u32 v43, v40, 1, 1
    v_lshlrev_b32 v7, 13, v43
    v_and_b32 v43, 1, v40
    v_lshl_add_u32 v7, v43, 7, v7
    s_lshl_b32 s22, s31, 8
    s_add_u32 s23, s22, 71311360
    v_add_u32 v7, s23, v7
    s_cmp_lg_u32 s20, 0
    s_cbranch_scc1 mega_kernel_rs_flk
    s_lshl_b32 s23, s30, 7
    s_add_u32 s22, s22, s23
    s_add_u32 s22, s22, 71327744
    v_bfrev_b32 v7, 1
    v_writelane_b32 v7, s22, 0
mega_kernel_rs_flk:
    v_lshlrev_b32 v11, 3, v40
    v_lshlrev_b32 v10, 8, v55
    v_lshl_add_u32 v10, v41, 4, v10
    v_mul_u32_u24 v8, 8448, v41
    v_lshl_add_u32 v8, v3, 4, v8
    v_lshrrev_b32 v4, 2, v42
    v_mul_u32_u24 v4, 2048, v4
    v_add_u32 v8, v4, v8
    v_lshrrev_b32 v9, 1, v41
    v_lshlrev_b32 v9, 5, v9
    v_and_b32 v4, 1, v42
    v_lshl_add_u32 v9, v4, 4, v9
    v_and_b32 v4, 1, v41
    v_lshl_add_u32 v9, v4, 3, v9
    s_lshr_b32 s22, s31, 2
    s_lshl_b32 s22, s22, 10
    s_and_b32 s23, s31, 3
    s_lshl_b32 s23, s23, 6
    s_add_u32 s22, s22, s23
    v_add_u32 v9, s22, v9
    v_lshrrev_b32 v4, 2, v42
    v_lshlrev_b32 v12, 8, v4
    v_lshl_add_u32 v12, v41, 6, v12
    v_lshl_add_u32 v12, v3, 4, v12
    v_lshlrev_b32 v13, 6, v41
    v_lshl_add_u32 v13, v42, 2, v13
    v_cmp_eq_u32 vcc, 0, v3
    v_mov_b32 v28, 0x3f803f80
    v_mov_b32 v29, 0x3f803f80
    v_cndmask_b32 v34, 0, 1, vcc
    v_mov_b32 v30, 0x3f803f80
    v_mov_b32 v31, 0x3f803f80
    v_and_b32 v49, 1, v42
    v_lshlrev_b32 v49, 4, v49
    v_mov_b32 v50, 0x3f80
    v_lshlrev_b32 v50, v49, v50
    v_lshrrev_b32 v51, 2, v42
    v_cmp_eq_u32 vcc, v51, v41
    v_mov_b32 v24, v50
    v_cndmask_b32 v52, 0, v50, s[28:29]
    v_cndmask_b32 v53, 0, v50, s[32:33]
    v_cndmask_b32 v16, 0, v52, vcc
    v_cndmask_b32 v17, 0, v53, vcc
    v_mov_b32 v25, v50
    v_mov_b32 v26, v50
    v_mov_b32 v27, v50
    v_bfe_u32 v60, v40, 3, 1
    v_bfe_u32 v49, v40, 2, 1
    v_and_b32 v50, 1, v41
    v_lshrrev_b32 v51, 1, v41
    v_lshlrev_b32 v52, 3, v60
    v_lshl_add_u32 v52, v50, 2, v52
    v_lshl_add_u32 v53, v51, 4, v52
    v_add_u32 v53, v53, v49
    v_and_b32 v54, 3, v40
    s_lshl_b32 s22, s20, 2
    v_add_u32 v55, s22, v54
    v_xor_b32 v55, v55, v52
    v_lshlrev_b32 v55, 4, v55
    v_lshl_add_u32 v46, v53, 8, v55
    v_lshlrev_b32 v55, 4, v52
    v_lshl_add_u32 v55, v54, 3, v55
    v_lshl_add_u32 v47, v53, 8, v55
    s_waitcnt vmcnt(28)
    s_barrier
    v_add_u32 v48, 0, v46
    ds_read_b64_tr_b16 a[0:1], v48 offset:0
    ds_read_b64_tr_b16 a[2:3], v48 offset:512
    ds_read_b64_tr_b16 a[4:5], v48 offset:8192
    ds_read_b64_tr_b16 a[6:7], v48 offset:8704
    ds_read_b64_tr_b16 a[8:9], v48 offset:8
    ds_read_b64_tr_b16 a[10:11], v48 offset:520
    ds_read_b64_tr_b16 a[12:13], v48 offset:8200
    ds_read_b64_tr_b16 a[14:15], v48 offset:8712
    s_waitcnt lgkmcnt(0)
    s_barrier
    s_mov_b32 s8, s52
    s_mov_b32 s9, s53
    s_add_u32 m0, s48, 0
    s_mov_b32 s22, 0
    buffer_load_dwordx4 v44, s[8:11], s22 offen  lds
    s_add_u32 m0, s48, 4096
    s_mov_b32 s22, 32768
    buffer_load_dwordx4 v44, s[8:11], s22 offen  lds
    s_add_u32 m0, s48, 8192
    s_mov_b32 s22, 65536
    buffer_load_dwordx4 v44, s[8:11], s22 offen  lds
    s_add_u32 m0, s48, 12288
    s_mov_b32 s22, 98304
    buffer_load_dwordx4 v44, s[8:11], s22 offen  lds
    s_waitcnt vmcnt(28)
    s_barrier
    v_add_u32 v48, 16384, v46
    ds_read_b64_tr_b16 a[16:17], v48 offset:0
    ds_read_b64_tr_b16 a[18:19], v48 offset:512
    ds_read_b64_tr_b16 a[20:21], v48 offset:8192
    ds_read_b64_tr_b16 a[22:23], v48 offset:8704
    ds_read_b64_tr_b16 a[24:25], v48 offset:8
    ds_read_b64_tr_b16 a[26:27], v48 offset:520
    ds_read_b64_tr_b16 a[28:29], v48 offset:8200
    ds_read_b64_tr_b16 a[30:31], v48 offset:8712
    s_waitcnt lgkmcnt(0)
    s_barrier
    s_add_u32 m0, s48, 16384
    s_mov_b32 s22, 524288
    buffer_load_dwordx4 v44, s[8:11], s22 offen  lds
    s_add_u32 m0, s48, 20480
    s_mov_b32 s22, 557056
    buffer_load_dwordx4 v44, s[8:11], s22 offen  lds
    s_add_u32 m0, s48, 24576
    s_mov_b32 s22, 589824
    buffer_load_dwordx4 v44, s[8:11], s22 offen  lds
    s_add_u32 m0, s48, 28672
    s_mov_b32 s22, 622592
    buffer_load_dwordx4 v44, s[8:11], s22 offen  lds
    s_waitcnt vmcnt(28)
    s_barrier
    v_add_u32 v48, 32768, v46
    ds_read_b64_tr_b16 a[32:33], v48 offset:0
    ds_read_b64_tr_b16 a[34:35], v48 offset:512
    ds_read_b64_tr_b16 a[36:37], v48 offset:8192
    ds_read_b64_tr_b16 a[38:39], v48 offset:8704
    ds_read_b64_tr_b16 a[40:41], v48 offset:8
    ds_read_b64_tr_b16 a[42:43], v48 offset:520
    ds_read_b64_tr_b16 a[44:45], v48 offset:8200
    ds_read_b64_tr_b16 a[46:47], v48 offset:8712
    s_waitcnt lgkmcnt(0)
    s_barrier
    s_add_u32 m0, s48, 32768
    s_mov_b32 s22, 1048576
    buffer_load_dwordx4 v44, s[8:11], s22 offen  lds
    s_add_u32 m0, s48, 36864
    s_mov_b32 s22, 1081344
    buffer_load_dwordx4 v44, s[8:11], s22 offen  lds
    s_add_u32 m0, s48, 40960
    s_mov_b32 s22, 1114112
    buffer_load_dwordx4 v44, s[8:11], s22 offen  lds
    s_add_u32 m0, s48, 45056
    s_mov_b32 s22, 1146880
    buffer_load_dwordx4 v44, s[8:11], s22 offen  lds
    s_waitcnt vmcnt(28)
    s_barrier
    v_add_u32 v48, 49152, v46
    ds_read_b64_tr_b16 a[48:49], v48 offset:0
    ds_read_b64_tr_b16 a[50:51], v48 offset:512
    ds_read_b64_tr_b16 a[52:53], v48 offset:8192
    ds_read_b64_tr_b16 a[54:55], v48 offset:8704
    ds_read_b64_tr_b16 a[56:57], v48 offset:8
    ds_read_b64_tr_b16 a[58:59], v48 offset:520
    ds_read_b64_tr_b16 a[60:61], v48 offset:8200
    ds_read_b64_tr_b16 a[62:63], v48 offset:8712
    s_waitcnt lgkmcnt(0)
    s_barrier
    s_add_u32 m0, s48, 49152
    s_mov_b32 s22, 1572864
    buffer_load_dwordx4 v44, s[8:11], s22 offen  lds
    s_add_u32 m0, s48, 53248
    s_mov_b32 s22, 1605632
    buffer_load_dwordx4 v44, s[8:11], s22 offen  lds
    s_add_u32 m0, s48, 57344
    s_mov_b32 s22, 1638400
    buffer_load_dwordx4 v44, s[8:11], s22 offen  lds
    s_add_u32 m0, s48, 61440
    s_mov_b32 s22, 1671168
    buffer_load_dwordx4 v44, s[8:11], s22 offen  lds
    s_waitcnt vmcnt(28)
    s_barrier
    v_add_u32 v48, 65536, v46
    ds_read_b64_tr_b16 a[64:65], v48 offset:0
    ds_read_b64_tr_b16 a[66:67], v48 offset:512
    ds_read_b64_tr_b16 a[68:69], v48 offset:8192
    ds_read_b64_tr_b16 a[70:71], v48 offset:8704
    ds_read_b64_tr_b16 a[72:73], v48 offset:8
    ds_read_b64_tr_b16 a[74:75], v48 offset:520
    ds_read_b64_tr_b16 a[76:77], v48 offset:8200
    ds_read_b64_tr_b16 a[78:79], v48 offset:8712
    s_waitcnt lgkmcnt(0)
    s_barrier
    s_add_u32 m0, s48, 65536
    s_mov_b32 s22, 2097152
    buffer_load_dwordx4 v44, s[8:11], s22 offen  lds
    s_add_u32 m0, s48, 69632
    s_mov_b32 s22, 2129920
    buffer_load_dwordx4 v44, s[8:11], s22 offen  lds
    s_add_u32 m0, s48, 73728
    s_mov_b32 s22, 2162688
    buffer_load_dwordx4 v44, s[8:11], s22 offen  lds
    s_add_u32 m0, s48, 77824
    s_mov_b32 s22, 2195456
    buffer_load_dwordx4 v44, s[8:11], s22 offen  lds
    s_waitcnt vmcnt(28)
    s_barrier
    v_add_u32 v48, 81920, v46
    ds_read_b64_tr_b16 a[80:81], v48 offset:0
    ds_read_b64_tr_b16 a[82:83], v48 offset:512
    ds_read_b64_tr_b16 a[84:85], v48 offset:8192
    ds_read_b64_tr_b16 a[86:87], v48 offset:8704
    ds_read_b64_tr_b16 a[88:89], v48 offset:8
    ds_read_b64_tr_b16 a[90:91], v48 offset:520
    ds_read_b64_tr_b16 a[92:93], v48 offset:8200
    ds_read_b64_tr_b16 a[94:95], v48 offset:8712
    s_waitcnt lgkmcnt(0)
    s_barrier
    s_add_u32 m0, s48, 81920
    s_mov_b32 s22, 2621440
    buffer_load_dwordx4 v44, s[8:11], s22 offen  lds
    s_add_u32 m0, s48, 86016
    s_mov_b32 s22, 2654208
    buffer_load_dwordx4 v44, s[8:11], s22 offen  lds
    s_add_u32 m0, s48, 90112
    s_mov_b32 s22, 2686976
    buffer_load_dwordx4 v44, s[8:11], s22 offen  lds
    s_add_u32 m0, s48, 94208
    s_mov_b32 s22, 2719744
    buffer_load_dwordx4 v44, s[8:11], s22 offen  lds
    s_waitcnt vmcnt(28)
    s_barrier
    v_add_u32 v48, 98304, v46
    ds_read_b64_tr_b16 a[96:97], v48 offset:0
    ds_read_b64_tr_b16 a[98:99], v48 offset:512
    ds_read_b64_tr_b16 a[100:101], v48 offset:8192
    ds_read_b64_tr_b16 a[102:103], v48 offset:8704
    ds_read_b64_tr_b16 a[104:105], v48 offset:8
    ds_read_b64_tr_b16 a[106:107], v48 offset:520
    ds_read_b64_tr_b16 a[108:109], v48 offset:8200
    ds_read_b64_tr_b16 a[110:111], v48 offset:8712
    s_waitcnt lgkmcnt(0)
    s_barrier
    s_add_u32 m0, s48, 98304
    s_mov_b32 s22, 3145728
    buffer_load_dwordx4 v44, s[8:11], s22 offen  lds
    s_add_u32 m0, s48, 102400
    s_mov_b32 s22, 3178496
    buffer_load_dwordx4 v44, s[8:11], s22 offen  lds
    s_add_u32 m0, s48, 106496
    s_mov_b32 s22, 3211264
    buffer_load_dwordx4 v44, s[8:11], s22 offen  lds
    s_add_u32 m0, s48, 110592
    s_mov_b32 s22, 3244032
    buffer_load_dwordx4 v44, s[8:11], s22 offen  lds
    s_waitcnt vmcnt(28)
    s_barrier
    v_add_u32 v48, 114688, v46
    ds_read_b64_tr_b16 a[112:113], v48 offset:0
    ds_read_b64_tr_b16 a[114:115], v48 offset:512
    ds_read_b64_tr_b16 a[116:117], v48 offset:8192
    ds_read_b64_tr_b16 a[118:119], v48 offset:8704
    ds_read_b64_tr_b16 a[120:121], v48 offset:8
    ds_read_b64_tr_b16 a[122:123], v48 offset:520
    ds_read_b64_tr_b16 a[124:125], v48 offset:8200
    ds_read_b64_tr_b16 a[126:127], v48 offset:8712
    s_waitcnt lgkmcnt(0)
    s_barrier
    s_add_u32 m0, s48, 114688
    s_mov_b32 s22, 3670016
    buffer_load_dwordx4 v44, s[8:11], s22 offen  lds
    s_add_u32 m0, s48, 118784
    s_mov_b32 s22, 3702784
    buffer_load_dwordx4 v44, s[8:11], s22 offen  lds
    s_add_u32 m0, s48, 122880
    s_mov_b32 s22, 3735552
    buffer_load_dwordx4 v44, s[8:11], s22 offen  lds
    s_add_u32 m0, s48, 126976
    s_mov_b32 s22, 3768320
    buffer_load_dwordx4 v44, s[8:11], s22 offen  lds
    s_waitcnt vmcnt(28)
    s_barrier
    v_add_u32 v48, 0, v46
    ds_read_b64_tr_b16 a[128:129], v48 offset:0
    ds_read_b64_tr_b16 a[130:131], v48 offset:512
    ds_read_b64_tr_b16 a[132:133], v48 offset:8192
    ds_read_b64_tr_b16 a[134:135], v48 offset:8704
    ds_read_b64_tr_b16 a[136:137], v48 offset:8
    ds_read_b64_tr_b16 a[138:139], v48 offset:520
    ds_read_b64_tr_b16 a[140:141], v48 offset:8200
    ds_read_b64_tr_b16 a[142:143], v48 offset:8712
    s_waitcnt lgkmcnt(0)
    s_barrier
    s_mov_b32 s8, s56
    s_mov_b32 s9, s57
    s_add_u32 m0, s48, 0
    s_mov_b32 s22, 0
    buffer_load_dwordx4 v45, s[8:11], s22 offen  lds
    s_add_u32 m0, s48, 4096
    s_mov_b32 s22, 16384
    buffer_load_dwordx4 v45, s[8:11], s22 offen  lds
    s_add_u32 m0, s48, 8192
    s_mov_b32 s22, 32768
    buffer_load_dwordx4 v45, s[8:11], s22 offen  lds
    s_add_u32 m0, s48, 12288
    s_mov_b32 s22, 49152
    buffer_load_dwordx4 v45, s[8:11], s22 offen  lds
    s_waitcnt vmcnt(28)
    s_barrier
    v_add_u32 v48, 16384, v46
    ds_read_b64_tr_b16 a[144:145], v48 offset:0
    ds_read_b64_tr_b16 a[146:147], v48 offset:512
    ds_read_b64_tr_b16 a[148:149], v48 offset:8192
    ds_read_b64_tr_b16 a[150:151], v48 offset:8704
    ds_read_b64_tr_b16 a[152:153], v48 offset:8
    ds_read_b64_tr_b16 a[154:155], v48 offset:520
    ds_read_b64_tr_b16 a[156:157], v48 offset:8200
    ds_read_b64_tr_b16 a[158:159], v48 offset:8712
    s_waitcnt lgkmcnt(0)
    s_barrier
    s_add_u32 m0, s48, 16384
    s_mov_b32 s22, 256
    buffer_load_dwordx4 v45, s[8:11], s22 offen  lds
    s_add_u32 m0, s48, 20480
    s_mov_b32 s22, 16640
    buffer_load_dwordx4 v45, s[8:11], s22 offen  lds
    s_add_u32 m0, s48, 24576
    s_mov_b32 s22, 33024
    buffer_load_dwordx4 v45, s[8:11], s22 offen  lds
    s_add_u32 m0, s48, 28672
    s_mov_b32 s22, 49408
    buffer_load_dwordx4 v45, s[8:11], s22 offen  lds
    s_waitcnt vmcnt(28)
    s_barrier
    v_add_u32 v48, 32768, v46
    ds_read_b64_tr_b16 a[160:161], v48 offset:0
    ds_read_b64_tr_b16 a[162:163], v48 offset:512
    ds_read_b64_tr_b16 a[164:165], v48 offset:8192
    ds_read_b64_tr_b16 a[166:167], v48 offset:8704
    ds_read_b64_tr_b16 a[168:169], v48 offset:8
    ds_read_b64_tr_b16 a[170:171], v48 offset:520
    ds_read_b64_tr_b16 a[172:173], v48 offset:8200
    ds_read_b64_tr_b16 a[174:175], v48 offset:8712
    s_waitcnt lgkmcnt(0)
    s_barrier
    s_add_u32 m0, s48, 32768
    s_mov_b32 s22, 512
    buffer_load_dwordx4 v45, s[8:11], s22 offen  lds
    s_add_u32 m0, s48, 36864
    s_mov_b32 s22, 16896
    buffer_load_dwordx4 v45, s[8:11], s22 offen  lds
    s_add_u32 m0, s48, 40960
    s_mov_b32 s22, 33280
    buffer_load_dwordx4 v45, s[8:11], s22 offen  lds
    s_add_u32 m0, s48, 45056
    s_mov_b32 s22, 49664
    buffer_load_dwordx4 v45, s[8:11], s22 offen  lds
    s_waitcnt vmcnt(28)
    s_barrier
    v_add_u32 v48, 49152, v46
    ds_read_b64_tr_b16 a[176:177], v48 offset:0
    ds_read_b64_tr_b16 a[178:179], v48 offset:512
    ds_read_b64_tr_b16 a[180:181], v48 offset:8192
    ds_read_b64_tr_b16 a[182:183], v48 offset:8704
    ds_read_b64_tr_b16 a[184:185], v48 offset:8
    ds_read_b64_tr_b16 a[186:187], v48 offset:520
    ds_read_b64_tr_b16 a[188:189], v48 offset:8200
    ds_read_b64_tr_b16 a[190:191], v48 offset:8712
    s_waitcnt lgkmcnt(0)
    s_barrier
    s_add_u32 m0, s48, 49152
    s_mov_b32 s22, 768
    buffer_load_dwordx4 v45, s[8:11], s22 offen  lds
    s_add_u32 m0, s48, 53248
    s_mov_b32 s22, 17152
    buffer_load_dwordx4 v45, s[8:11], s22 offen  lds
    s_add_u32 m0, s48, 57344
    s_mov_b32 s22, 33536
    buffer_load_dwordx4 v45, s[8:11], s22 offen  lds
    s_add_u32 m0, s48, 61440
    s_mov_b32 s22, 49920
    buffer_load_dwordx4 v45, s[8:11], s22 offen  lds
    s_waitcnt vmcnt(28)
    s_barrier
    v_add_u32 v48, 65536, v46
    ds_read_b64_tr_b16 a[192:193], v48 offset:0
    ds_read_b64_tr_b16 a[194:195], v48 offset:512
    ds_read_b64_tr_b16 a[196:197], v48 offset:8192
    ds_read_b64_tr_b16 a[198:199], v48 offset:8704
    ds_read_b64_tr_b16 a[200:201], v48 offset:8
    ds_read_b64_tr_b16 a[202:203], v48 offset:520
    ds_read_b64_tr_b16 a[204:205], v48 offset:8200
    ds_read_b64_tr_b16 a[206:207], v48 offset:8712
    s_waitcnt lgkmcnt(0)
    s_barrier
    s_add_u32 m0, s48, 65536
    s_mov_b32 s22, 131072
    buffer_load_dwordx4 v45, s[8:11], s22 offen  lds
    s_add_u32 m0, s48, 69632
    s_mov_b32 s22, 147456
    buffer_load_dwordx4 v45, s[8:11], s22 offen  lds
    s_add_u32 m0, s48, 73728
    s_mov_b32 s22, 163840
    buffer_load_dwordx4 v45, s[8:11], s22 offen  lds
    s_add_u32 m0, s48, 77824
    s_mov_b32 s22, 180224
    buffer_load_dwordx4 v45, s[8:11], s22 offen  lds
    s_waitcnt vmcnt(28)
    s_barrier
    v_add_u32 v48, 81920, v46
    ds_read_b64_tr_b16 a[208:209], v48 offset:0
    ds_read_b64_tr_b16 a[210:211], v48 offset:512
    ds_read_b64_tr_b16 a[212:213], v48 offset:8192
    ds_read_b64_tr_b16 a[214:215], v48 offset:8704
    ds_read_b64_tr_b16 a[216:217], v48 offset:8
    ds_read_b64_tr_b16 a[218:219], v48 offset:520
    ds_read_b64_tr_b16 a[220:221], v48 offset:8200
    ds_read_b64_tr_b16 a[222:223], v48 offset:8712
    s_waitcnt lgkmcnt(0)
    s_barrier
    s_add_u32 m0, s48, 81920
    s_mov_b32 s22, 131328
    buffer_load_dwordx4 v45, s[8:11], s22 offen  lds
    s_add_u32 m0, s48, 86016
    s_mov_b32 s22, 147712
    buffer_load_dwordx4 v45, s[8:11], s22 offen  lds
    s_add_u32 m0, s48, 90112
    s_mov_b32 s22, 164096
    buffer_load_dwordx4 v45, s[8:11], s22 offen  lds
    s_add_u32 m0, s48, 94208
    s_mov_b32 s22, 180480
    buffer_load_dwordx4 v45, s[8:11], s22 offen  lds
    s_waitcnt vmcnt(28)
    s_barrier
    v_add_u32 v48, 98304, v46
    ds_read_b64_tr_b16 a[224:225], v48 offset:0
    ds_read_b64_tr_b16 a[226:227], v48 offset:512
    ds_read_b64_tr_b16 a[228:229], v48 offset:8192
    ds_read_b64_tr_b16 a[230:231], v48 offset:8704
    ds_read_b64_tr_b16 a[232:233], v48 offset:8
    ds_read_b64_tr_b16 a[234:235], v48 offset:520
    ds_read_b64_tr_b16 a[236:237], v48 offset:8200
    ds_read_b64_tr_b16 a[238:239], v48 offset:8712
    s_waitcnt lgkmcnt(0)
    s_barrier
    s_add_u32 m0, s48, 98304
    s_mov_b32 s22, 131584
    buffer_load_dwordx4 v45, s[8:11], s22 offen  lds
    s_add_u32 m0, s48, 102400
    s_mov_b32 s22, 147968
    buffer_load_dwordx4 v45, s[8:11], s22 offen  lds
    s_add_u32 m0, s48, 106496
    s_mov_b32 s22, 164352
    buffer_load_dwordx4 v45, s[8:11], s22 offen  lds
    s_add_u32 m0, s48, 110592
    s_mov_b32 s22, 180736
    buffer_load_dwordx4 v45, s[8:11], s22 offen  lds
    s_waitcnt vmcnt(28)
    s_barrier
    v_add_u32 v48, 114688, v46
    ds_read_b64_tr_b16 a[240:241], v48 offset:0
    ds_read_b64_tr_b16 a[242:243], v48 offset:512
    ds_read_b64_tr_b16 a[244:245], v48 offset:8192
    ds_read_b64_tr_b16 a[246:247], v48 offset:8704
    ds_read_b64_tr_b16 a[248:249], v48 offset:8
    ds_read_b64_tr_b16 a[250:251], v48 offset:520
    ds_read_b64_tr_b16 a[252:253], v48 offset:8200
    ds_read_b64_tr_b16 a[254:255], v48 offset:8712
    s_waitcnt lgkmcnt(0)
    s_barrier
    s_add_u32 m0, s48, 114688
    s_mov_b32 s22, 131840
    buffer_load_dwordx4 v45, s[8:11], s22 offen  lds
    s_add_u32 m0, s48, 118784
    s_mov_b32 s22, 148224
    buffer_load_dwordx4 v45, s[8:11], s22 offen  lds
    s_add_u32 m0, s48, 122880
    s_mov_b32 s22, 164608
    buffer_load_dwordx4 v45, s[8:11], s22 offen  lds
    s_add_u32 m0, s48, 126976
    s_mov_b32 s22, 180992
    buffer_load_dwordx4 v45, s[8:11], s22 offen  lds
    s_waitcnt vmcnt(28)
    s_barrier
    s_cmp_lg_u32 s20, 0
    s_cbranch_scc1 mega_kernel_rs_wo0
    v_xor_b32 v48, 0, v47
    v_add_u32 v48, 0, v48
    ds_read_b64_tr_b16 v[128:129], v48 offset:0
    ds_read_b64_tr_b16 v[130:131], v48 offset:512
    ds_read_b64_tr_b16 v[132:133], v48 offset:8192
    ds_read_b64_tr_b16 v[134:135], v48 offset:8704
    ds_read_b64_tr_b16 v[144:145], v48 offset:32
    ds_read_b64_tr_b16 v[146:147], v48 offset:544
    ds_read_b64_tr_b16 v[148:149], v48 offset:8224
    ds_read_b64_tr_b16 v[150:151], v48 offset:8736
    s_waitcnt lgkmcnt(0)
    v_xor_b32 v48, 64, v47
    v_add_u32 v48, 0, v48
    ds_read_b64_tr_b16 v[160:161], v48 offset:0
    ds_read_b64_tr_b16 v[162:163], v48 offset:512
    ds_read_b64_tr_b16 v[164:165], v48 offset:8192
    ds_read_b64_tr_b16 v[166:167], v48 offset:8704
    ds_read_b64_tr_b16 v[176:177], v48 offset:32
    ds_read_b64_tr_b16 v[178:179], v48 offset:544
    ds_read_b64_tr_b16 v[180:181], v48 offset:8224
    ds_read_b64_tr_b16 v[182:183], v48 offset:8736
    s_waitcnt lgkmcnt(0)
    v_xor_b32 v48, 128, v47
    v_add_u32 v48, 0, v48
    ds_read_b64_tr_b16 v[192:193], v48 offset:0
    ds_read_b64_tr_b16 v[194:195], v48 offset:512
    ds_read_b64_tr_b16 v[196:197], v48 offset:8192
    ds_read_b64_tr_b16 v[198:199], v48 offset:8704
    ds_read_b64_tr_b16 v[208:209], v48 offset:32
    ds_read_b64_tr_b16 v[210:211], v48 offset:544
    ds_read_b64_tr_b16 v[212:213], v48 offset:8224
    ds_read_b64_tr_b16 v[214:215], v48 offset:8736
    s_waitcnt lgkmcnt(0)
    v_xor_b32 v48, 192, v47
    v_add_u32 v48, 0, v48
    ds_read_b64_tr_b16 v[224:225], v48 offset:0
    ds_read_b64_tr_b16 v[226:227], v48 offset:512
    ds_read_b64_tr_b16 v[228:229], v48 offset:8192
    ds_read_b64_tr_b16 v[230:231], v48 offset:8704
    ds_read_b64_tr_b16 v[240:241], v48 offset:32
    ds_read_b64_tr_b16 v[242:243], v48 offset:544
    ds_read_b64_tr_b16 v[244:245], v48 offset:8224
    ds_read_b64_tr_b16 v[246:247], v48 offset:8736
    s_waitcnt lgkmcnt(0)
mega_kernel_rs_wo0:
    s_barrier
    s_mov_b32 s8, s54
    s_mov_b32 s9, s55
    s_add_u32 m0, s48, 0
    s_mov_b32 s22, 0
    buffer_load_dwordx4 v44, s[8:11], s22 offen  lds
    s_add_u32 m0, s48, 4096
    s_mov_b32 s22, 32768
    buffer_load_dwordx4 v44, s[8:11], s22 offen  lds
    s_add_u32 m0, s48, 8192
    s_mov_b32 s22, 65536
    buffer_load_dwordx4 v44, s[8:11], s22 offen  lds
    s_add_u32 m0, s48, 12288
    s_mov_b32 s22, 98304
    buffer_load_dwordx4 v44, s[8:11], s22 offen  lds
    s_waitcnt vmcnt(28)
    s_barrier
    s_cmp_lg_u32 s20, 1
    s_cbranch_scc1 mega_kernel_rs_wo1
    v_xor_b32 v48, 0, v47
    v_add_u32 v48, 16384, v48
    ds_read_b64_tr_b16 v[128:129], v48 offset:0
    ds_read_b64_tr_b16 v[130:131], v48 offset:512
    ds_read_b64_tr_b16 v[132:133], v48 offset:8192
    ds_read_b64_tr_b16 v[134:135], v48 offset:8704
    ds_read_b64_tr_b16 v[144:145], v48 offset:32
    ds_read_b64_tr_b16 v[146:147], v48 offset:544
    ds_read_b64_tr_b16 v[148:149], v48 offset:8224
    ds_read_b64_tr_b16 v[150:151], v48 offset:8736
    s_waitcnt lgkmcnt(0)
    v_xor_b32 v48, 64, v47
    v_add_u32 v48, 16384, v48
    ds_read_b64_tr_b16 v[160:161], v48 offset:0
    ds_read_b64_tr_b16 v[162:163], v48 offset:512
    ds_read_b64_tr_b16 v[164:165], v48 offset:8192
    ds_read_b64_tr_b16 v[166:167], v48 offset:8704
    ds_read_b64_tr_b16 v[176:177], v48 offset:32
    ds_read_b64_tr_b16 v[178:179], v48 offset:544
    ds_read_b64_tr_b16 v[180:181], v48 offset:8224
    ds_read_b64_tr_b16 v[182:183], v48 offset:8736
    s_waitcnt lgkmcnt(0)
    v_xor_b32 v48, 128, v47
    v_add_u32 v48, 16384, v48
    ds_read_b64_tr_b16 v[192:193], v48 offset:0
    ds_read_b64_tr_b16 v[194:195], v48 offset:512
    ds_read_b64_tr_b16 v[196:197], v48 offset:8192
    ds_read_b64_tr_b16 v[198:199], v48 offset:8704
    ds_read_b64_tr_b16 v[208:209], v48 offset:32
    ds_read_b64_tr_b16 v[210:211], v48 offset:544
    ds_read_b64_tr_b16 v[212:213], v48 offset:8224
    ds_read_b64_tr_b16 v[214:215], v48 offset:8736
    s_waitcnt lgkmcnt(0)
    v_xor_b32 v48, 192, v47
    v_add_u32 v48, 16384, v48
    ds_read_b64_tr_b16 v[224:225], v48 offset:0
    ds_read_b64_tr_b16 v[226:227], v48 offset:512
    ds_read_b64_tr_b16 v[228:229], v48 offset:8192
    ds_read_b64_tr_b16 v[230:231], v48 offset:8704
    ds_read_b64_tr_b16 v[240:241], v48 offset:32
    ds_read_b64_tr_b16 v[242:243], v48 offset:544
    ds_read_b64_tr_b16 v[244:245], v48 offset:8224
    ds_read_b64_tr_b16 v[246:247], v48 offset:8736
    s_waitcnt lgkmcnt(0)
mega_kernel_rs_wo1:
    s_barrier
    s_add_u32 m0, s48, 16384
    s_mov_b32 s22, 524288
    buffer_load_dwordx4 v44, s[8:11], s22 offen  lds
    s_add_u32 m0, s48, 20480
    s_mov_b32 s22, 557056
    buffer_load_dwordx4 v44, s[8:11], s22 offen  lds
    s_add_u32 m0, s48, 24576
    s_mov_b32 s22, 589824
    buffer_load_dwordx4 v44, s[8:11], s22 offen  lds
    s_add_u32 m0, s48, 28672
    s_mov_b32 s22, 622592
    buffer_load_dwordx4 v44, s[8:11], s22 offen  lds
    s_waitcnt vmcnt(28)
    s_barrier
    s_cmp_lg_u32 s20, 2
    s_cbranch_scc1 mega_kernel_rs_wo2
    v_xor_b32 v48, 0, v47
    v_add_u32 v48, 32768, v48
    ds_read_b64_tr_b16 v[128:129], v48 offset:0
    ds_read_b64_tr_b16 v[130:131], v48 offset:512
    ds_read_b64_tr_b16 v[132:133], v48 offset:8192
    ds_read_b64_tr_b16 v[134:135], v48 offset:8704
    ds_read_b64_tr_b16 v[144:145], v48 offset:32
    ds_read_b64_tr_b16 v[146:147], v48 offset:544
    ds_read_b64_tr_b16 v[148:149], v48 offset:8224
    ds_read_b64_tr_b16 v[150:151], v48 offset:8736
    s_waitcnt lgkmcnt(0)
    v_xor_b32 v48, 64, v47
    v_add_u32 v48, 32768, v48
    ds_read_b64_tr_b16 v[160:161], v48 offset:0
    ds_read_b64_tr_b16 v[162:163], v48 offset:512
    ds_read_b64_tr_b16 v[164:165], v48 offset:8192
    ds_read_b64_tr_b16 v[166:167], v48 offset:8704
    ds_read_b64_tr_b16 v[176:177], v48 offset:32
    ds_read_b64_tr_b16 v[178:179], v48 offset:544
    ds_read_b64_tr_b16 v[180:181], v48 offset:8224
    ds_read_b64_tr_b16 v[182:183], v48 offset:8736
    s_waitcnt lgkmcnt(0)
    v_xor_b32 v48, 128, v47
    v_add_u32 v48, 32768, v48
    ds_read_b64_tr_b16 v[192:193], v48 offset:0
    ds_read_b64_tr_b16 v[194:195], v48 offset:512
    ds_read_b64_tr_b16 v[196:197], v48 offset:8192
    ds_read_b64_tr_b16 v[198:199], v48 offset:8704
    ds_read_b64_tr_b16 v[208:209], v48 offset:32
    ds_read_b64_tr_b16 v[210:211], v48 offset:544
    ds_read_b64_tr_b16 v[212:213], v48 offset:8224
    ds_read_b64_tr_b16 v[214:215], v48 offset:8736
    s_waitcnt lgkmcnt(0)
    v_xor_b32 v48, 192, v47
    v_add_u32 v48, 32768, v48
    ds_read_b64_tr_b16 v[224:225], v48 offset:0
    ds_read_b64_tr_b16 v[226:227], v48 offset:512
    ds_read_b64_tr_b16 v[228:229], v48 offset:8192
    ds_read_b64_tr_b16 v[230:231], v48 offset:8704
    ds_read_b64_tr_b16 v[240:241], v48 offset:32
    ds_read_b64_tr_b16 v[242:243], v48 offset:544
    ds_read_b64_tr_b16 v[244:245], v48 offset:8224
    ds_read_b64_tr_b16 v[246:247], v48 offset:8736
    s_waitcnt lgkmcnt(0)
mega_kernel_rs_wo2:
    s_barrier
    s_add_u32 m0, s48, 32768
    s_mov_b32 s22, 1048576
    buffer_load_dwordx4 v44, s[8:11], s22 offen  lds
    s_add_u32 m0, s48, 36864
    s_mov_b32 s22, 1081344
    buffer_load_dwordx4 v44, s[8:11], s22 offen  lds
    s_add_u32 m0, s48, 40960
    s_mov_b32 s22, 1114112
    buffer_load_dwordx4 v44, s[8:11], s22 offen  lds
    s_add_u32 m0, s48, 45056
    s_mov_b32 s22, 1146880
    buffer_load_dwordx4 v44, s[8:11], s22 offen  lds
    s_waitcnt vmcnt(28)
    s_barrier
    s_cmp_lg_u32 s20, 3
    s_cbranch_scc1 mega_kernel_rs_wo3
    v_xor_b32 v48, 0, v47
    v_add_u32 v48, 49152, v48
    ds_read_b64_tr_b16 v[128:129], v48 offset:0
    ds_read_b64_tr_b16 v[130:131], v48 offset:512
    ds_read_b64_tr_b16 v[132:133], v48 offset:8192
    ds_read_b64_tr_b16 v[134:135], v48 offset:8704
    ds_read_b64_tr_b16 v[144:145], v48 offset:32
    ds_read_b64_tr_b16 v[146:147], v48 offset:544
    ds_read_b64_tr_b16 v[148:149], v48 offset:8224
    ds_read_b64_tr_b16 v[150:151], v48 offset:8736
    s_waitcnt lgkmcnt(0)
    v_xor_b32 v48, 64, v47
    v_add_u32 v48, 49152, v48
    ds_read_b64_tr_b16 v[160:161], v48 offset:0
    ds_read_b64_tr_b16 v[162:163], v48 offset:512
    ds_read_b64_tr_b16 v[164:165], v48 offset:8192
    ds_read_b64_tr_b16 v[166:167], v48 offset:8704
    ds_read_b64_tr_b16 v[176:177], v48 offset:32
    ds_read_b64_tr_b16 v[178:179], v48 offset:544
    ds_read_b64_tr_b16 v[180:181], v48 offset:8224
    ds_read_b64_tr_b16 v[182:183], v48 offset:8736
    s_waitcnt lgkmcnt(0)
    v_xor_b32 v48, 128, v47
    v_add_u32 v48, 49152, v48
    ds_read_b64_tr_b16 v[192:193], v48 offset:0
    ds_read_b64_tr_b16 v[194:195], v48 offset:512
    ds_read_b64_tr_b16 v[196:197], v48 offset:8192
    ds_read_b64_tr_b16 v[198:199], v48 offset:8704
    ds_read_b64_tr_b16 v[208:209], v48 offset:32
    ds_read_b64_tr_b16 v[210:211], v48 offset:544
    ds_read_b64_tr_b16 v[212:213], v48 offset:8224
    ds_read_b64_tr_b16 v[214:215], v48 offset:8736
    s_waitcnt lgkmcnt(0)
    v_xor_b32 v48, 192, v47
    v_add_u32 v48, 49152, v48
    ds_read_b64_tr_b16 v[224:225], v48 offset:0
    ds_read_b64_tr_b16 v[226:227], v48 offset:512
    ds_read_b64_tr_b16 v[228:229], v48 offset:8192
    ds_read_b64_tr_b16 v[230:231], v48 offset:8704
    ds_read_b64_tr_b16 v[240:241], v48 offset:32
    ds_read_b64_tr_b16 v[242:243], v48 offset:544
    ds_read_b64_tr_b16 v[244:245], v48 offset:8224
    ds_read_b64_tr_b16 v[246:247], v48 offset:8736
    s_waitcnt lgkmcnt(0)
mega_kernel_rs_wo3:
    s_barrier
    s_add_u32 m0, s48, 49152
    s_mov_b32 s22, 1572864
    buffer_load_dwordx4 v44, s[8:11], s22 offen  lds
    s_add_u32 m0, s48, 53248
    s_mov_b32 s22, 1605632
    buffer_load_dwordx4 v44, s[8:11], s22 offen  lds
    s_add_u32 m0, s48, 57344
    s_mov_b32 s22, 1638400
    buffer_load_dwordx4 v44, s[8:11], s22 offen  lds
    s_add_u32 m0, s48, 61440
    s_mov_b32 s22, 1671168
    buffer_load_dwordx4 v44, s[8:11], s22 offen  lds
    s_waitcnt vmcnt(28)
    s_barrier
    s_cmp_lg_u32 s20, 0
    s_cbranch_scc1 mega_kernel_rs_wo4
    v_xor_b32 v48, 0, v47
    v_add_u32 v48, 65536, v48
    ds_read_b64_tr_b16 v[136:137], v48 offset:0
    ds_read_b64_tr_b16 v[138:139], v48 offset:512
    ds_read_b64_tr_b16 v[140:141], v48 offset:8192
    ds_read_b64_tr_b16 v[142:143], v48 offset:8704
    ds_read_b64_tr_b16 v[152:153], v48 offset:32
    ds_read_b64_tr_b16 v[154:155], v48 offset:544
    ds_read_b64_tr_b16 v[156:157], v48 offset:8224
    ds_read_b64_tr_b16 v[158:159], v48 offset:8736
    s_waitcnt lgkmcnt(0)
    v_xor_b32 v48, 64, v47
    v_add_u32 v48, 65536, v48
    ds_read_b64_tr_b16 v[168:169], v48 offset:0
    ds_read_b64_tr_b16 v[170:171], v48 offset:512
    ds_read_b64_tr_b16 v[172:173], v48 offset:8192
    ds_read_b64_tr_b16 v[174:175], v48 offset:8704
    ds_read_b64_tr_b16 v[184:185], v48 offset:32
    ds_read_b64_tr_b16 v[186:187], v48 offset:544
    ds_read_b64_tr_b16 v[188:189], v48 offset:8224
    ds_read_b64_tr_b16 v[190:191], v48 offset:8736
    s_waitcnt lgkmcnt(0)
    v_xor_b32 v48, 128, v47
    v_add_u32 v48, 65536, v48
    ds_read_b64_tr_b16 v[200:201], v48 offset:0
    ds_read_b64_tr_b16 v[202:203], v48 offset:512
    ds_read_b64_tr_b16 v[204:205], v48 offset:8192
    ds_read_b64_tr_b16 v[206:207], v48 offset:8704
    ds_read_b64_tr_b16 v[216:217], v48 offset:32
    ds_read_b64_tr_b16 v[218:219], v48 offset:544
    ds_read_b64_tr_b16 v[220:221], v48 offset:8224
    ds_read_b64_tr_b16 v[222:223], v48 offset:8736
    s_waitcnt lgkmcnt(0)
    v_xor_b32 v48, 192, v47
    v_add_u32 v48, 65536, v48
    ds_read_b64_tr_b16 v[232:233], v48 offset:0
    ds_read_b64_tr_b16 v[234:235], v48 offset:512
    ds_read_b64_tr_b16 v[236:237], v48 offset:8192
    ds_read_b64_tr_b16 v[238:239], v48 offset:8704
    ds_read_b64_tr_b16 v[248:249], v48 offset:32
    ds_read_b64_tr_b16 v[250:251], v48 offset:544
    ds_read_b64_tr_b16 v[252:253], v48 offset:8224
    ds_read_b64_tr_b16 v[254:255], v48 offset:8736
    s_waitcnt lgkmcnt(0)
mega_kernel_rs_wo4:
    s_barrier
    s_add_u32 m0, s48, 65536
    s_mov_b32 s22, 2097152
    buffer_load_dwordx4 v44, s[8:11], s22 offen  lds
    s_add_u32 m0, s48, 69632
    s_mov_b32 s22, 2129920
    buffer_load_dwordx4 v44, s[8:11], s22 offen  lds
    s_add_u32 m0, s48, 73728
    s_mov_b32 s22, 2162688
    buffer_load_dwordx4 v44, s[8:11], s22 offen  lds
    s_add_u32 m0, s48, 77824
    s_mov_b32 s22, 2195456
    buffer_load_dwordx4 v44, s[8:11], s22 offen  lds
    s_waitcnt vmcnt(28)
    s_barrier
    s_cmp_lg_u32 s20, 1
    s_cbranch_scc1 mega_kernel_rs_wo5
    v_xor_b32 v48, 0, v47
    v_add_u32 v48, 81920, v48
    ds_read_b64_tr_b16 v[136:137], v48 offset:0
    ds_read_b64_tr_b16 v[138:139], v48 offset:512
    ds_read_b64_tr_b16 v[140:141], v48 offset:8192
    ds_read_b64_tr_b16 v[142:143], v48 offset:8704
    ds_read_b64_tr_b16 v[152:153], v48 offset:32
    ds_read_b64_tr_b16 v[154:155], v48 offset:544
    ds_read_b64_tr_b16 v[156:157], v48 offset:8224
    ds_read_b64_tr_b16 v[158:159], v48 offset:8736
    s_waitcnt lgkmcnt(0)
    v_xor_b32 v48, 64, v47
    v_add_u32 v48, 81920, v48
    ds_read_b64_tr_b16 v[168:169], v48 offset:0
    ds_read_b64_tr_b16 v[170:171], v48 offset:512
    ds_read_b64_tr_b16 v[172:173], v48 offset:8192
    ds_read_b64_tr_b16 v[174:175], v48 offset:8704
    ds_read_b64_tr_b16 v[184:185], v48 offset:32
    ds_read_b64_tr_b16 v[186:187], v48 offset:544
    ds_read_b64_tr_b16 v[188:189], v48 offset:8224
    ds_read_b64_tr_b16 v[190:191], v48 offset:8736
    s_waitcnt lgkmcnt(0)
    v_xor_b32 v48, 128, v47
    v_add_u32 v48, 81920, v48
    ds_read_b64_tr_b16 v[200:201], v48 offset:0
    ds_read_b64_tr_b16 v[202:203], v48 offset:512
    ds_read_b64_tr_b16 v[204:205], v48 offset:8192
    ds_read_b64_tr_b16 v[206:207], v48 offset:8704
    ds_read_b64_tr_b16 v[216:217], v48 offset:32
    ds_read_b64_tr_b16 v[218:219], v48 offset:544
    ds_read_b64_tr_b16 v[220:221], v48 offset:8224
    ds_read_b64_tr_b16 v[222:223], v48 offset:8736
    s_waitcnt lgkmcnt(0)
    v_xor_b32 v48, 192, v47
    v_add_u32 v48, 81920, v48
    ds_read_b64_tr_b16 v[232:233], v48 offset:0
    ds_read_b64_tr_b16 v[234:235], v48 offset:512
    ds_read_b64_tr_b16 v[236:237], v48 offset:8192
    ds_read_b64_tr_b16 v[238:239], v48 offset:8704
    ds_read_b64_tr_b16 v[248:249], v48 offset:32
    ds_read_b64_tr_b16 v[250:251], v48 offset:544
    ds_read_b64_tr_b16 v[252:253], v48 offset:8224
    ds_read_b64_tr_b16 v[254:255], v48 offset:8736
    s_waitcnt lgkmcnt(0)
mega_kernel_rs_wo5:
    s_barrier
    s_add_u32 m0, s48, 81920
    s_mov_b32 s22, 2621440
    buffer_load_dwordx4 v44, s[8:11], s22 offen  lds
    s_add_u32 m0, s48, 86016
    s_mov_b32 s22, 2654208
    buffer_load_dwordx4 v44, s[8:11], s22 offen  lds
    s_add_u32 m0, s48, 90112
    s_mov_b32 s22, 2686976
    buffer_load_dwordx4 v44, s[8:11], s22 offen  lds
    s_add_u32 m0, s48, 94208
    s_mov_b32 s22, 2719744
    buffer_load_dwordx4 v44, s[8:11], s22 offen  lds
    s_waitcnt vmcnt(28)
    s_barrier
    s_cmp_lg_u32 s20, 2
    s_cbranch_scc1 mega_kernel_rs_wo6
    v_xor_b32 v48, 0, v47
    v_add_u32 v48, 98304, v48
    ds_read_b64_tr_b16 v[136:137], v48 offset:0
    ds_read_b64_tr_b16 v[138:139], v48 offset:512
    ds_read_b64_tr_b16 v[140:141], v48 offset:8192
    ds_read_b64_tr_b16 v[142:143], v48 offset:8704
    ds_read_b64_tr_b16 v[152:153], v48 offset:32
    ds_read_b64_tr_b16 v[154:155], v48 offset:544
    ds_read_b64_tr_b16 v[156:157], v48 offset:8224
    ds_read_b64_tr_b16 v[158:159], v48 offset:8736
    s_waitcnt lgkmcnt(0)
    v_xor_b32 v48, 64, v47
    v_add_u32 v48, 98304, v48
    ds_read_b64_tr_b16 v[168:169], v48 offset:0
    ds_read_b64_tr_b16 v[170:171], v48 offset:512
    ds_read_b64_tr_b16 v[172:173], v48 offset:8192
    ds_read_b64_tr_b16 v[174:175], v48 offset:8704
    ds_read_b64_tr_b16 v[184:185], v48 offset:32
    ds_read_b64_tr_b16 v[186:187], v48 offset:544
    ds_read_b64_tr_b16 v[188:189], v48 offset:8224
    ds_read_b64_tr_b16 v[190:191], v48 offset:8736
    s_waitcnt lgkmcnt(0)
    v_xor_b32 v48, 128, v47
    v_add_u32 v48, 98304, v48
    ds_read_b64_tr_b16 v[200:201], v48 offset:0
    ds_read_b64_tr_b16 v[202:203], v48 offset:512
    ds_read_b64_tr_b16 v[204:205], v48 offset:8192
    ds_read_b64_tr_b16 v[206:207], v48 offset:8704
    ds_read_b64_tr_b16 v[216:217], v48 offset:32
    ds_read_b64_tr_b16 v[218:219], v48 offset:544
    ds_read_b64_tr_b16 v[220:221], v48 offset:8224
    ds_read_b64_tr_b16 v[222:223], v48 offset:8736
    s_waitcnt lgkmcnt(0)
    v_xor_b32 v48, 192, v47
    v_add_u32 v48, 98304, v48
    ds_read_b64_tr_b16 v[232:233], v48 offset:0
    ds_read_b64_tr_b16 v[234:235], v48 offset:512
    ds_read_b64_tr_b16 v[236:237], v48 offset:8192
    ds_read_b64_tr_b16 v[238:239], v48 offset:8704
    ds_read_b64_tr_b16 v[248:249], v48 offset:32
    ds_read_b64_tr_b16 v[250:251], v48 offset:544
    ds_read_b64_tr_b16 v[252:253], v48 offset:8224
    ds_read_b64_tr_b16 v[254:255], v48 offset:8736
    s_waitcnt lgkmcnt(0)
mega_kernel_rs_wo6:
    s_barrier
    s_add_u32 m0, s48, 98304
    s_mov_b32 s22, 3145728
    buffer_load_dwordx4 v44, s[8:11], s22 offen  lds
    s_add_u32 m0, s48, 102400
    s_mov_b32 s22, 3178496
    buffer_load_dwordx4 v44, s[8:11], s22 offen  lds
    s_add_u32 m0, s48, 106496
    s_mov_b32 s22, 3211264
    buffer_load_dwordx4 v44, s[8:11], s22 offen  lds
    s_add_u32 m0, s48, 110592
    s_mov_b32 s22, 3244032
    buffer_load_dwordx4 v44, s[8:11], s22 offen  lds
    s_waitcnt vmcnt(28)
    s_barrier
    s_cmp_lg_u32 s20, 3
    s_cbranch_scc1 mega_kernel_rs_wo7
    v_xor_b32 v48, 0, v47
    v_add_u32 v48, 114688, v48
    ds_read_b64_tr_b16 v[136:137], v48 offset:0
    ds_read_b64_tr_b16 v[138:139], v48 offset:512
    ds_read_b64_tr_b16 v[140:141], v48 offset:8192
    ds_read_b64_tr_b16 v[142:143], v48 offset:8704
    ds_read_b64_tr_b16 v[152:153], v48 offset:32
    ds_read_b64_tr_b16 v[154:155], v48 offset:544
    ds_read_b64_tr_b16 v[156:157], v48 offset:8224
    ds_read_b64_tr_b16 v[158:159], v48 offset:8736
    s_waitcnt lgkmcnt(0)
    v_xor_b32 v48, 64, v47
    v_add_u32 v48, 114688, v48
    ds_read_b64_tr_b16 v[168:169], v48 offset:0
    ds_read_b64_tr_b16 v[170:171], v48 offset:512
    ds_read_b64_tr_b16 v[172:173], v48 offset:8192
    ds_read_b64_tr_b16 v[174:175], v48 offset:8704
    ds_read_b64_tr_b16 v[184:185], v48 offset:32
    ds_read_b64_tr_b16 v[186:187], v48 offset:544
    ds_read_b64_tr_b16 v[188:189], v48 offset:8224
    ds_read_b64_tr_b16 v[190:191], v48 offset:8736
    s_waitcnt lgkmcnt(0)
    v_xor_b32 v48, 128, v47
    v_add_u32 v48, 114688, v48
    ds_read_b64_tr_b16 v[200:201], v48 offset:0
    ds_read_b64_tr_b16 v[202:203], v48 offset:512
    ds_read_b64_tr_b16 v[204:205], v48 offset:8192
    ds_read_b64_tr_b16 v[206:207], v48 offset:8704
    ds_read_b64_tr_b16 v[216:217], v48 offset:32
    ds_read_b64_tr_b16 v[218:219], v48 offset:544
    ds_read_b64_tr_b16 v[220:221], v48 offset:8224
    ds_read_b64_tr_b16 v[222:223], v48 offset:8736
    s_waitcnt lgkmcnt(0)
    v_xor_b32 v48, 192, v47
    v_add_u32 v48, 114688, v48
    ds_read_b64_tr_b16 v[232:233], v48 offset:0
    ds_read_b64_tr_b16 v[234:235], v48 offset:512
    ds_read_b64_tr_b16 v[236:237], v48 offset:8192
    ds_read_b64_tr_b16 v[238:239], v48 offset:8704
    ds_read_b64_tr_b16 v[248:249], v48 offset:32
    ds_read_b64_tr_b16 v[250:251], v48 offset:544
    ds_read_b64_tr_b16 v[252:253], v48 offset:8224
    ds_read_b64_tr_b16 v[254:255], v48 offset:8736
    s_waitcnt lgkmcnt(0)
mega_kernel_rs_wo7:
    s_barrier
    s_add_u32 m0, s48, 114688
    s_mov_b32 s22, 3670016
    buffer_load_dwordx4 v44, s[8:11], s22 offen  lds
    s_add_u32 m0, s48, 118784
    s_mov_b32 s22, 3702784
    buffer_load_dwordx4 v44, s[8:11], s22 offen  lds
    s_add_u32 m0, s48, 122880
    s_mov_b32 s22, 3735552
    buffer_load_dwordx4 v44, s[8:11], s22 offen  lds
    s_add_u32 m0, s48, 126976
    s_mov_b32 s22, 3768320
    buffer_load_dwordx4 v44, s[8:11], s22 offen  lds
    s_waitcnt vmcnt(28)
    s_barrier
    v_add_u32 v48, 0, v46
    ds_read_b64_tr_b16 v[64:65], v48 offset:0
    ds_read_b64_tr_b16 v[66:67], v48 offset:512
    ds_read_b64_tr_b16 v[68:69], v48 offset:8192
    ds_read_b64_tr_b16 v[70:71], v48 offset:8704
    ds_read_b64_tr_b16 v[72:73], v48 offset:8
    ds_read_b64_tr_b16 v[74:75], v48 offset:520
    ds_read_b64_tr_b16 v[76:77], v48 offset:8200
    ds_read_b64_tr_b16 v[78:79], v48 offset:8712
    s_waitcnt lgkmcnt(0)
    s_barrier
    ds_write_b128 v32, v[64:67] offset:0
    ds_write_b128 v32, v[68:71] offset:1024
    ds_write_b128 v32, v[72:75] offset:2048
    ds_write_b128 v32, v[76:79] offset:3072
    s_waitcnt lgkmcnt(0)
    s_waitcnt vmcnt(24)
    s_barrier
    v_add_u32 v48, 16384, v46
    ds_read_b64_tr_b16 v[64:65], v48 offset:0
    ds_read_b64_tr_b16 v[66:67], v48 offset:512
    ds_read_b64_tr_b16 v[68:69], v48 offset:8192
    ds_read_b64_tr_b16 v[70:71], v48 offset:8704
    ds_read_b64_tr_b16 v[72:73], v48 offset:8
    ds_read_b64_tr_b16 v[74:75], v48 offset:520
    ds_read_b64_tr_b16 v[76:77], v48 offset:8200
    ds_read_b64_tr_b16 v[78:79], v48 offset:8712
    s_waitcnt lgkmcnt(0)
    s_barrier
    ds_write_b128 v32, v[64:67] offset:16384
    ds_write_b128 v32, v[68:71] offset:17408
    ds_write_b128 v32, v[72:75] offset:18432
    ds_write_b128 v32, v[76:79] offset:19456
    s_waitcnt lgkmcnt(0)
    s_waitcnt vmcnt(20)
    s_barrier
    s_getpc_b64 s[16:17]
mega_kernel_rs_pc0:
    s_add_u32 s16, s16, mega_kernel_rs_w0_entry - mega_kernel_rs_pc0
    s_addc_u32 s17, s17, 0
    v_lshlrev_b32 v49, 7, v0
    v_min_u32 v49, mega_kernel_rs_end - mega_kernel_rs_w0_entry, v49
    global_load_dword v50, v49, s[16:17]
    v_lshlrev_b32 v49, 7, v40
    s_xor_b32 s23, s35, 16384
    s_cmp_eq_u32 s20, 1
    s_cselect_b32 s22, s35, s47
    s_cmp_eq_u32 s20, 2
    s_cselect_b32 s22, s23, s22
    s_lshl_b32 s23, s31, 13
    s_add_u32 s23, s23, 178257920
    s_cmp_eq_u32 s20, 3
    s_cselect_b32 s22, s23, s22
    buffer_load_dword v51, v49, s[4:7], s22 offen sc1
    v_lshlrev_b32 v49, 13, v0
    v_and_b32 v49, 0x1fffff, v49
    s_mov_b32 s22, 67108864
    buffer_load_dword v52, v49, s[4:7], s22 offen sc1
    buffer_load_dword v57, v7, s[4:7], 0 offen sc1
    v_add_u32 v48, 32768, v46
    ds_read_b64_tr_b16 v[64:65], v48 offset:0
    ds_read_b64_tr_b16 v[66:67], v48 offset:512
    ds_read_b64_tr_b16 v[68:69], v48 offset:8192
    ds_read_b64_tr_b16 v[70:71], v48 offset:8704
    ds_read_b64_tr_b16 v[72:73], v48 offset:8
    ds_read_b64_tr_b16 v[74:75], v48 offset:520
    ds_read_b64_tr_b16 v[76:77], v48 offset:8200
    ds_read_b64_tr_b16 v[78:79], v48 offset:8712
    s_waitcnt lgkmcnt(0)
    s_barrier
    ds_write_b128 v32, v[64:67] offset:32768
    ds_write_b128 v32, v[68:71] offset:33792
    ds_write_b128 v32, v[72:75] offset:34816
    ds_write_b128 v32, v[76:79] offset:35840
    s_waitcnt lgkmcnt(0)
    s_waitcnt vmcnt(16)
    s_barrier
    v_add_u32 v48, 49152, v46
    ds_read_b64_tr_b16 v[64:65], v48 offset:0
    ds_read_b64_tr_b16 v[66:67], v48 offset:512
    ds_read_b64_tr_b16 v[68:69], v48 offset:8192
    ds_read_b64_tr_b16 v[70:71], v48 offset:8704
    ds_read_b64_tr_b16 v[72:73], v48 offset:8
    ds_read_b64_tr_b16 v[74:75], v48 offset:520
    ds_read_b64_tr_b16 v[76:77], v48 offset:8200
    ds_read_b64_tr_b16 v[78:79], v48 offset:8712
    s_waitcnt lgkmcnt(0)
    s_barrier
    ds_write_b128 v32, v[64:67] offset:49152
    ds_write_b128 v32, v[68:71] offset:50176
    ds_write_b128 v32, v[72:75] offset:51200
    ds_write_b128 v32, v[76:79] offset:52224
    s_waitcnt lgkmcnt(0)
    s_waitcnt vmcnt(12)
    s_barrier
    v_add_u32 v48, 65536, v46
    ds_read_b64_tr_b16 v[64:65], v48 offset:0
    ds_read_b64_tr_b16 v[66:67], v48 offset:512
    ds_read_b64_tr_b16 v[68:69], v48 offset:8192
    ds_read_b64_tr_b16 v[70:71], v48 offset:8704
    ds_read_b64_tr_b16 v[72:73], v48 offset:8
    ds_read_b64_tr_b16 v[74:75], v48 offset:520
    ds_read_b64_tr_b16 v[76:77], v48 offset:8200
    ds_read_b64_tr_b16 v[78:79], v48 offset:8712
    s_waitcnt lgkmcnt(0)
    s_barrier
    ds_write_b128 v33, v[64:67] offset:0
    ds_write_b128 v33, v[68:71] offset:1024
    ds_write_b128 v33, v[72:75] offset:2048
    ds_write_b128 v33, v[76:79] offset:3072
    s_waitcnt lgkmcnt(0)
    s_waitcnt vmcnt(8)
    s_barrier
    v_add_u32 v48, 81920, v46
    ds_read_b64_tr_b16 v[64:65], v48 offset:0
    ds_read_b64_tr_b16 v[66:67], v48 offset:512
    ds_read_b64_tr_b16 v[68:69], v48 offset:8192
    ds_read_b64_tr_b16 v[70:71], v48 offset:8704
    ds_read_b64_tr_b16 v[72:73], v48 offset:8
    ds_read_b64_tr_b16 v[74:75], v48 offset:520
    ds_read_b64_tr_b16 v[76:77], v48 offset:8200
    ds_read_b64_tr_b16 v[78:79], v48 offset:8712
    s_waitcnt lgkmcnt(0)
    s_barrier
    ds_write_b128 v33, v[64:67] offset:16384
    ds_write_b128 v33, v[68:71] offset:17408
    ds_write_b128 v33, v[72:75] offset:18432
    ds_write_b128 v33, v[76:79] offset:19456
    s_waitcnt lgkmcnt(0)
    s_waitcnt vmcnt(4)
    s_barrier
    v_add_u32 v48, 98304, v46
    ds_read_b64_tr_b16 v[64:65], v48 offset:0
    ds_read_b64_tr_b16 v[66:67], v48 offset:512
    ds_read_b64_tr_b16 v[68:69], v48 offset:8192
    ds_read_b64_tr_b16 v[70:71], v48 offset:8704
    ds_read_b64_tr_b16 v[72:73], v48 offset:8
    ds_read_b64_tr_b16 v[74:75], v48 offset:520
    ds_read_b64_tr_b16 v[76:77], v48 offset:8200
    ds_read_b64_tr_b16 v[78:79], v48 offset:8712
    s_waitcnt lgkmcnt(0)
    s_barrier
    ds_write_b128 v33, v[64:67] offset:32768
    ds_write_b128 v33, v[68:71] offset:33792
    ds_write_b128 v33, v[72:75] offset:34816
    ds_write_b128 v33, v[76:79] offset:35840
    s_waitcnt lgkmcnt(0)
    s_waitcnt vmcnt(0)
    s_barrier
    v_add_u32 v48, 114688, v46
    ds_read_b64_tr_b16 v[64:65], v48 offset:0
    ds_read_b64_tr_b16 v[66:67], v48 offset:512
    ds_read_b64_tr_b16 v[68:69], v48 offset:8192
    ds_read_b64_tr_b16 v[70:71], v48 offset:8704
    ds_read_b64_tr_b16 v[72:73], v48 offset:8
    ds_read_b64_tr_b16 v[74:75], v48 offset:520
    ds_read_b64_tr_b16 v[76:77], v48 offset:8200
    ds_read_b64_tr_b16 v[78:79], v48 offset:8712
    s_waitcnt lgkmcnt(0)
    s_barrier
    ds_write_b128 v33, v[64:67] offset:49152
    ds_write_b128 v33, v[68:71] offset:50176
    ds_write_b128 v33, v[72:75] offset:51200
    ds_write_b128 v33, v[76:79] offset:52224
    s_waitcnt lgkmcnt(0)
mega_kernel_rs_iw:
    buffer_load_dword v58, off, s[12:15], 0 offset:204 sc1
    s_waitcnt vmcnt(0)
mega_kernel_rs_iw1:
    v_and_b32 v50, 0xffff, v58
    v_readfirstlane_b32 s60, v58
    v_cmp_ne_u32 vcc, s100, v50
    s_cbranch_vccnz mega_kernel_rs_iw
    s_lshr_b32 s60, s60, 15
    s_cmp_gt_u32 s60, s100
    s_cselect_b32 s60, 8192, 0
    s_bfe_u32 s22, s31, 0x10001
    s_lshl_b32 s22, s22, 12
    s_add_u32 s22, s22, s60
    s_lshl_b32 s23, s20, 10
    s_add_u32 s22, s22, s23
    s_add_u32 s38, s38, s22
    s_add_u32 s37, s37, s22
    s_xor_b32 s40, s38, 4096
    s_xor_b32 s39, s37, 4096
    s_xor_b32 s36, s35, 16384
    s_mov_b32 s21, 0
    s_cmp_eq_u32 s30, 0
    s_mov_b32 s22, 0x33003300
    s_cselect_b32 s16, 0x00330033, s22
    s_mov_b32 s17, s16
    s_cselect_b32 s18, -1, 0
    s_not_b32 s19, s18
    s_lshl_b32 s22, s31, 13
    s_lshl_b32 s23, s20, 11
    s_add_u32 s22, s22, s23
    s_add_u32 s43, s22, 16777216
    s_add_u32 s44, s22, 33554432
    s_lshl_b32 s45, s31, 13
    s_add_u32 s45, s45, 178257920
    s_mul_i32 s48, s20, 5120
    s_add_u32 m0, s48, 140288
    s_mov_b32 s41, 1
    s_mov_b32 s42, 1
    v_mov_b32 v0, v34
    v_bfrev_b32 v12, 1
    v_bfrev_b32 v3, 1
    v_cndmask_b32 v10, v3, v10, s[16:17]
    v_cndmask_b32 v9, v3, v9, s[26:27]
    s_sub_u32 s45, s45, 0
    s_lshl_b32 s51, s30, 11
    s_add_u32 s51, s51, s45
    s_mov_b32 s50, 0
    s_cmp_lg_u32 s20, 3
    s_cbranch_scc1 mega_kernel_rs_kv0
    v_readlane_b32 s50, v57, 0
    v_readlane_b32 s22, v57, 2
    v_readlane_b32 s23, v57, 1
    v_readlane_b32 s24, v57, 3
    s_nop 3
    s_min_u32 s50, s50, s22
    s_min_u32 s23, s23, s24
    s_lshl_b32 s50, s50, 1
    s_lshl_b32 s23, s23, 1
    s_add_u32 s23, s23, 1
    s_min_u32 s50, s50, s23
mega_kernel_rs_kvb0:
    s_add_u32 s22, s21, 1
    s_min_u32 s22, s22, 63
    s_cmp_gt_u32 s50, s22
    s_cbranch_scc1 mega_kernel_rs_kvd0
    buffer_load_dword v48, v7, s[4:7], 0 offen sc1
    s_waitcnt vmcnt(0)
    v_readlane_b32 s50, v48, 0
    v_readlane_b32 s22, v48, 2
    v_readlane_b32 s23, v48, 1
    v_readlane_b32 s24, v48, 3
    s_nop 3
    s_min_u32 s50, s50, s22
    s_min_u32 s23, s23, s24
    s_lshl_b32 s50, s50, 1
    s_lshl_b32 s23, s23, 1
    s_add_u32 s23, s23, 1
    s_min_u32 s50, s50, s23
    s_branch mega_kernel_rs_kvb0
mega_kernel_rs_kvd0:
mega_kernel_rs_kv0:
    s_barrier
    s_cmp_eq_u32 s20, 1
    s_cbranch_scc1 mega_kernel_rs_w1_entry
    s_cmp_eq_u32 s20, 2
    s_cbranch_scc1 mega_kernel_rs_w2_entry
    s_cmp_eq_u32 s20, 3
    s_cbranch_scc1 mega_kernel_rs_w3_entry
mega_kernel_rs_w0_entry:
    v_mfma_f32_32x32x8_bf16 v[96:111], v[14:15], v[14:15], 0
    v_mfma_f32_16x16x16_bf16 v[112:115], v[14:15], v[14:15], 0
    v_mfma_f32_16x16x16_bf16 v[116:119], v[14:15], v[14:15], 0
    ds_read_b128 v[64:67], v1 offset:0
    ds_read_b128 v[68:71], v1 offset:1024
    ds_read_b128 v[72:75], v1 offset:2048
    ds_read_b128 v[76:79], v1 offset:3072
    ds_read_b128 v[80:83], v1 offset:16384
    ds_read_b128 v[84:87], v1 offset:17408
    ds_read_b128 v[88:91], v1 offset:18432
    ds_read_b128 v[92:95], v1 offset:19456
    buffer_load_dwordx4 v[120:123], v1, s[4:7], s44 offen
    buffer_load_dwordx4 v[124:127], v1, s[4:7], s44 offen offset:1024
    s_add_u32 s44, s44, 262144
mega_kernel_rs_w0_loop:
    s_add_u32 s22, s35, 0
    s_waitcnt vmcnt(0)
    buffer_load_dwordx4 v[32:35], v1, s[4:7], s22 offen sc1
    buffer_load_dwordx4 v[36:39], v1, s[4:7], s22 offen offset:1024 sc1
mega_kernel_rs_w0_pa:
    s_waitcnt vmcnt(1)
    ds_write_b128 v6, v[32:35] offset:0
    s_waitcnt vmcnt(0)
    ds_write_b128 v6, v[36:39] offset:1024
    v_max3_u32 v3, v32, v34, v36
    v_max_u32 v3, v3, v38
    v_cmp_eq_u32 vcc, -1, v3
    v_smfmac_f32_16x16x64_bf16 v[96:99], v[32:35], a[0:7], v2
    buffer_load_dwordx4 v[32:35], v1, s[4:7], s22 offen sc1
    v_smfmac_f32_16x16x64_bf16 v[100:103], v[32:35], a[8:15], v2
    buffer_load_dwordx4 v[36:39], v1, s[4:7], s22 offen offset:1024 sc1
    v_smfmac_f32_16x16x64_bf16 v[104:107], v[32:35], a[128:135], v2
    s_cbranch_vccnz mega_kernel_rs_w0_pafail
    s_waitcnt lgkmcnt(0)
    s_barrier
    ds_read_b128 v[40:43], v6 offset:2048
    ds_read_b128 v[44:47], v6 offset:3072
    v_smfmac_f32_16x16x64_bf16 v[108:111], v[32:35], a[136:143], v2
    ds_read_b128 v[48:51], v6 offset:4096
    v_smfmac_f32_16x16x64_bf16 v[96:99], v[36:39], a[16:23], v2
    ds_read_b128 v[52:55], v6 offset:5120
    v_smfmac_f32_16x16x64_bf16 v[100:103], v[36:39], a[24:31], v2
    ds_read_b128 v[56:59], v6 offset:6144
    v_smfmac_f32_16x16x64_bf16 v[104:107], v[36:39], a[144:151], v2
    ds_read_b128 v[60:63], v6 offset:7168
    v_smfmac_f32_16x16x64_bf16 v[108:111], v[36:39], a[152:159], v2
    buffer_load_dwordx4 v1, s[4:7], s43 offen lds
    s_waitcnt lgkmcnt(5)
    v_smfmac_f32_16x16x64_bf16 v[96:99], v[40:43], a[32:39], v2
    v_smfmac_f32_16x16x64_bf16 v[104:107], v[40:43], a[160:167], v2
    s_waitcnt lgkmcnt(4)
    v_smfmac_f32_16x16x64_bf16 v[96:99], v[44:47], a[48:55], v2
    v_smfmac_f32_16x16x64_bf16 v[104:107], v[44:47], a[176:183], v2
    buffer_load_dwordx4 v1, s[4:7], s43 offen offset:1024 lds
    s_waitcnt lgkmcnt(3)
    v_smfmac_f32_16x16x64_bf16 v[96:99], v[48:51], a[64:71], v2
    v_smfmac_f32_16x16x64_bf16 v[104:107], v[48:51], a[192:199], v2
    s_waitcnt lgkmcnt(2)
    v_smfmac_f32_16x16x64_bf16 v[96:99], v[52:55], a[80:87], v2
    v_smfmac_f32_16x16x64_bf16 v[104:107], v[52:55], a[208:215], v2
    v_mov_b32 v4, s21
    buffer_store_dword v4, v7, s[4:7], 0 offen sc1
    s_waitcnt lgkmcnt(1)
    v_smfmac_f32_16x16x64_bf16 v[96:99], v[56:59], a[96:103], v2
    v_smfmac_f32_16x16x64_bf16 v[104:107], v[56:59], a[224:231], v2
    s_waitcnt lgkmcnt(0)
    v_smfmac_f32_16x16x64_bf16 v[96:99], v[60:63], a[112:119], v2
    v_smfmac_f32_16x16x64_bf16 v[104:107], v[60:63], a[240:247], v2
    v_smfmac_f32_16x16x64_bf16 v[100:103], v[40:43], a[40:47], v2
    s_nop 2
    v_smfmac_f32_16x16x64_bf16 v[100:103], v[44:47], a[56:63], v2
    s_nop 1
    v_add_f32 v96, v96, v98
    v_smfmac_f32_16x16x64_bf16 v[100:103], v[48:51], a[72:79], v2
    v_add_f32 v97, v97, v99
    v_add_f32 v104, v104, v106
    v_smfmac_f32_16x16x64_bf16 v[100:103], v[52:55], a[88:95], v2
    v_add_f32 v105, v105, v107
    v_cvt_pk_bf16_f32 v96, v96, v97
    v_smfmac_f32_16x16x64_bf16 v[100:103], v[56:59], a[104:111], v2
    v_cvt_pk_bf16_f32 v97, v104, v105
    v_and_or_b32 v96, v96, -2, s41
    v_smfmac_f32_16x16x64_bf16 v[100:103], v[60:63], a[120:127], v2
    buffer_store_dwordx2 v[96:97], v11, s[4:7], s37 offen sc1
    v_smfmac_f32_16x16x64_bf16 v[108:111], v[40:43], a[168:175], v2
    v_smfmac_f32_16x16x64_bf16 v[108:111], v[44:47], a[184:191], v2
    v_smfmac_f32_16x16x64_bf16 v[108:111], v[48:51], a[200:207], v2
    v_smfmac_f32_16x16x64_bf16 v[108:111], v[52:55], a[216:223], v2
    v_smfmac_f32_16x16x64_bf16 v[108:111], v[56:59], a[232:239], v2
    s_nop 2
    v_add_f32 v100, v100, v102
    v_smfmac_f32_16x16x64_bf16 v[108:111], v[60:63], a[248:255], v2
    v_add_f32 v101, v101, v103
    v_cvt_pk_bf16_f32 v98, v100, v101
    v_and_or_b32 v98, v98, -2, s41
    s_nop 4
    v_pk_add_f32 v[108:109], v[108:109], v[110:111]
    v_cvt_pk_bf16_f32 v99, v108, v109
    buffer_store_dwordx2 v[98:99], v11, s[4:7], s37 offen offset:512 sc1
    v_smfmac_f32_16x16x64_bf16 v[112:115], v[32:35], v[64:71], v2
    ds_read_b128 v[64:67], v1 offset:32768
    ds_read_b128 v[68:71], v1 offset:33792
    v_smfmac_f32_16x16x64_bf16 v[116:119], v[32:35], v[72:79], v2
    ds_read_b128 v[72:75], v1 offset:34816
    ds_read_b128 v[76:79], v1 offset:35840
    v_smfmac_f32_16x16x64_bf16 v[112:115], v[36:39], v[80:87], v2
    ds_read_b128 v[80:83], v1 offset:49152
    ds_read_b128 v[84:87], v1 offset:50176
    v_smfmac_f32_16x16x64_bf16 v[116:119], v[36:39], v[88:95], v2
    ds_read_b128 v[88:91], v1 offset:51200
    ds_read_b128 v[92:95], v1 offset:52224
    s_waitcnt lgkmcnt(6)
    v_smfmac_f32_16x16x64_bf16 v[112:115], v[40:43], v[64:71], v2
    ds_read_b128 v[64:67], v5 offset:0
    ds_read_b128 v[68:71], v5 offset:1024
    s_waitcnt lgkmcnt(6)
    v_smfmac_f32_16x16x64_bf16 v[116:119], v[40:43], v[72:79], v2
    ds_read_b128 v[72:75], v5 offset:2048
    ds_read_b128 v[76:79], v5 offset:3072
    s_waitcnt lgkmcnt(6)
    v_smfmac_f32_16x16x64_bf16 v[112:115], v[44:47], v[80:87], v2
    ds_read_b128 v[80:83], v5 offset:16384
    ds_read_b128 v[84:87], v5 offset:17408
    s_waitcnt lgkmcnt(6)
    v_smfmac_f32_16x16x64_bf16 v[116:119], v[44:47], v[88:95], v2
    ds_read_b128 v[88:91], v5 offset:18432
    ds_read_b128 v[92:95], v5 offset:19456
    s_waitcnt lgkmcnt(6)
    v_smfmac_f32_16x16x64_bf16 v[112:115], v[48:51], v[64:71], v2
    ds_read_b128 v[64:67], v5 offset:32768
    ds_read_b128 v[68:71], v5 offset:33792
    s_waitcnt lgkmcnt(6)
    v_smfmac_f32_16x16x64_bf16 v[116:119], v[48:51], v[72:79], v2
    ds_read_b128 v[72:75], v5 offset:34816
    ds_read_b128 v[76:79], v5 offset:35840
    s_waitcnt lgkmcnt(6)
    v_smfmac_f32_16x16x64_bf16 v[112:115], v[52:55], v[80:87], v2
    ds_read_b128 v[80:83], v5 offset:49152
    ds_read_b128 v[84:87], v5 offset:50176
    s_waitcnt lgkmcnt(6)
    v_smfmac_f32_16x16x64_bf16 v[116:119], v[52:55], v[88:95], v2
    ds_read_b128 v[88:91], v5 offset:51200
    ds_read_b128 v[92:95], v5 offset:52224
    s_waitcnt lgkmcnt(6)
    v_smfmac_f32_16x16x64_bf16 v[112:115], v[56:59], v[64:71], v2
    s_waitcnt lgkmcnt(4)
    v_smfmac_f32_16x16x64_bf16 v[116:119], v[56:59], v[72:79], v2
    s_waitcnt lgkmcnt(2)
    v_smfmac_f32_16x16x64_bf16 v[112:115], v[60:63], v[80:87], v2
    s_waitcnt lgkmcnt(0)
    v_smfmac_f32_16x16x64_bf16 v[116:119], v[60:63], v[88:95], v2
    buffer_load_dwordx2 v[108:109], v11, s[4:7], s38 offen sc1
    v_mfma_f32_16x16x16_bf16 v[100:103], v[96:97], v[16:17], 0
    v_mfma_f32_16x16x16_bf16 v[104:107], v[98:99], v[16:17], 0
    s_nop 4
    v_add_f32 v112, v112, v114
    v_add_f32 v113, v113, v115
    v_add_f32 v114, v116, v118
    v_add_f32 v115, v117, v119
    v_cvt_pk_bf16_f32 v18, v112, v113
    v_cvt_pk_bf16_f32 v19, v114, v115
    v_and_or_b32 v18, v18, -2, s41
    buffer_load_dwordx2 v[110:111], v11, s[4:7], s38 offen offset:512 sc1
    s_barrier
    buffer_store_dwordx2 v[18:19], v11, s[4:7], s39 offen sc1
    v_mov_b32 v112, v18
    v_mov_b32 v114, v19
    v_mov_b32 v92, v28
    v_mov_b32 v93, 0
    s_waitcnt vmcnt(6)
    s_barrier
    ds_read_b128 v[32:35], v6 offset:9216
    ds_read_b128 v[36:39], v6 offset:10240
    ds_read_b128 v[40:43], v6 offset:14336
    ds_read_b128 v[44:47], v6 offset:15360
    ds_read_b128 v[48:51], v6 offset:19456
    ds_read_b128 v[52:55], v6 offset:20480
    ds_read_b128 v[56:59], v6 offset:24576
    ds_read_b128 v[60:63], v6 offset:25600
    buffer_load_dwordx2 v[20:21], v11, s[4:7], s38 offen sc1
    buffer_load_dwordx2 v[22:23], v11, s[4:7], s38 offen offset:512 sc1
    s_waitcnt vmcnt(4)
    v_mfma_f32_16x16x16_bf16 v[80:83], v[108:109], v[16:17], v[100:103]
    v_and_b32 v3, 1, v108
    v_cmp_ne_u32 vcc, s41, v3
    s_nop 5
    v_cvt_pk_bf16_f32 v64, v80, v81
    v_cvt_pk_bf16_f32 v65, v82, v83
    s_cbranch_vccnz mega_kernel_rs_w0_xslow
    s_waitcnt vmcnt(3)
    v_mfma_f32_16x16x16_bf16 v[84:87], v[110:111], v[16:17], v[104:107]
    v_and_b32 v3, 1, v110
    v_cmp_ne_u32 vcc, s41, v3
    s_nop 5
    v_cvt_pk_bf16_f32 v66, v84, v85
    v_cvt_pk_bf16_f32 v67, v86, v87
    ds_write_b128 v6, v[64:67] offset:8192
    s_cbranch_vccnz mega_kernel_rs_w0_xslow
mega_kernel_rs_w0_xok:
    s_cmp_eq_u32 s21, 63
    s_cbranch_scc1 mega_kernel_rs_w0_last
    buffer_load_dwordx2 v[116:117], v11, s[4:7], s40 offen sc1
    s_waitcnt lgkmcnt(1)
    v_mfma_f32_16x16x32_bf16 v[80:83], v[32:35], v[64:67], 0
    s_waitcnt lgkmcnt(0)
    s_barrier
    ds_read_b128 v[68:71], v6 offset:13312
    ds_read_b128 v[72:75], v6 offset:18432
    ds_read_b128 v[76:79], v6 offset:23552
    v_mfma_f32_16x16x32_bf16 v[84:87], v[36:39], v[64:67], 0
    v_mfma_f32_16x16x32_bf16 v[88:91], v[64:67], v[64:67], 0
    buffer_load_dwordx2 v[20:21], v11, s[4:7], s40 offen sc1
    s_waitcnt lgkmcnt(2)
    v_mfma_f32_16x16x32_bf16 v[80:83], v[40:43], v[68:71], v[80:83]
    buffer_store_dwordx4 v[64:67], v10, s[4:7], s45 offen offset:0 sc1
    s_waitcnt lgkmcnt(1)
    v_mfma_f32_16x16x32_bf16 v[80:83], v[48:51], v[72:75], v[80:83]
    s_waitcnt lgkmcnt(0)
    v_mfma_f32_16x16x32_bf16 v[80:83], v[56:59], v[76:79], v[80:83]
    v_mfma_f32_16x16x32_bf16 v[84:87], v[44:47], v[68:71], v[84:87]
    v_mfma_f32_16x16x32_bf16 v[84:87], v[52:55], v[72:75], v[84:87]
    buffer_store_dwordx2 v[18:19], v11, s[4:7], s51 offen offset:2048 sc1
    v_mfma_f32_16x16x32_bf16 v[84:87], v[60:63], v[76:79], v[84:87]
    v_mfma_f32_16x16x32_bf16 v[88:91], v[68:71], v[68:71], v[88:91]
    v_mfma_f32_16x16x32_bf16 v[88:91], v[72:75], v[72:75], v[88:91]
    v_mfma_f32_16x16x32_bf16 v[88:91], v[76:79], v[76:79], v[88:91]
    v_mfma_f32_32x32x4_2b_bf16 v[32:63], v[14:15], v[14:15], 0
    s_nop 0
    v_max3_f32 v4, v80, v81, v82
    s_nop 1
    v_max3_f32 v4, v4, v83, v84
    v_max3_f32 v4, v4, v85, v86
    v_max_f32 v4, v4, v87
    v_max3_f32 v90, v4, v88, v89
    v_max3_f32 v4, v4, v88, v89
    s_nop 1
    v_permlane16_swap_b32 v4, v90
    v_max_f32 v4, v4, v90
    v_max_f32 v90, v4, v90
    s_nop 1
    v_permlane32_swap_b32 v4, v90
    v_max_f32 v4, v4, v90
    v_mul_f32 v4, s34, v4
    v_pk_fma_f32 v[80:81], v[80:81], s[34:35], v[4:5] op_sel_hi:[1,0,0] neg_lo:[0,0,1] neg_hi:[0,0,1]
    v_pk_fma_f32 v[82:83], v[82:83], s[34:35], v[4:5] op_sel_hi:[1,0,0] neg_lo:[0,0,1] neg_hi:[0,0,1]
    v_pk_fma_f32 v[84:85], v[84:85], s[34:35], v[4:5] op_sel_hi:[1,0,0] neg_lo:[0,0,1] neg_hi:[0,0,1]
    v_pk_fma_f32 v[86:87], v[86:87], s[34:35], v[4:5] op_sel_hi:[1,0,0] neg_lo:[0,0,1] neg_hi:[0,0,1]
    v_pk_fma_f32 v[88:89], v[88:89], s[34:35], v[4:5] op_sel_hi:[1,0,0] neg_lo:[0,0,1] neg_hi:[0,0,1]
    v_exp_f32 v80, v80
    v_exp_f32 v81, v81
    v_exp_f32 v82, v82
    v_cvt_pk_bf16_f32 v68, v80, v81
    v_exp_f32 v83, v83
    v_exp_f32 v84, v84
    v_cvt_pk_bf16_f32 v69, v82, v83
    v_exp_f32 v85, v85
    v_exp_f32 v86, v86
    v_cvt_pk_bf16_f32 v70, v84, v85
    v_exp_f32 v87, v87
    v_exp_f32 v88, v88
    v_cvt_pk_bf16_f32 v71, v86, v87
    v_exp_f32 v89, v89
    s_waitcnt vmcnt(3)
    v_mfma_f32_16x16x32_bf16 v[76:79], v[28:31], v[68:71], 0
    v_and_b32 v3, 1, v116
    v_cvt_pk_bf16_f32 v72, v88, v89
    v_mfma_f32_16x16x32_bf16 v[100:103], v[120:123], v[68:71], 0
    v_cmp_ne_u32 vcc, s41, v3
    v_cvt_pk_bf16_f32 v73, v88, v89
    v_mfma_f32_16x16x32_bf16 v[104:107], v[124:127], v[68:71], 0
    v_mov_b32 v113, v116
    v_mov_b32 v115, v117
    v_mfma_f32_16x16x16_bf16 v[76:79], v[92:93], v[72:73], v[76:79]
    s_cbranch_vccnz mega_kernel_rs_w0_pv0
mega_kernel_rs_w0_pv2:
    v_mfma_f32_16x16x16_bf16 v[100:103], v[112:113], v[72:73], v[100:103]
    v_mfma_f32_16x16x16_bf16 v[104:107], v[114:115], v[72:73], v[104:107]
    buffer_load_dwordx4 v[120:123], v1, s[4:7], s44 offen
    buffer_load_dwordx4 v[124:127], v1, s[4:7], s44 offen offset:1024
    s_nop 2
    v_rcp_f32 v76, v76
    s_mov_b64 exec, s[28:29]
    v_pk_mul_f32 v[100:101], v[100:101], v[76:77] op_sel_hi:[1,0]
    v_pk_mul_f32 v[102:103], v[102:103], v[76:77] op_sel_hi:[1,0]
    v_pk_mul_f32 v[104:105], v[104:105], v[76:77] op_sel_hi:[1,0]
    v_pk_mul_f32 v[106:107], v[106:107], v[76:77] op_sel_hi:[1,0]
    v_cvt_pk_bf16_f32 v84, v100, v101
    v_cvt_pk_bf16_f32 v85, v102, v103
    v_cvt_pk_bf16_f32 v86, v104, v105
    v_cvt_pk_bf16_f32 v87, v106, v107
    ds_write_b128 v6, v[84:87] offset:28640
    s_mov_b64 exec, -1
    s_waitcnt lgkmcnt(0)
    s_barrier
    ds_read_b128 v[68:71], v6 offset:28672
    ds_read_b128 v[72:75], v6 offset:29696
    s_waitcnt lgkmcnt(1)
    v_smfmac_f32_16x16x64_bf16 v[32:35], v[68:71], v[128:135], v2
    s_add_u32 s21, s21, 1
    s_xor_b32 s38, s38, 1048576
    s_xor_b32 s37, s37, 1048576
    s_waitcnt lgkmcnt(0)
    v_smfmac_f32_16x16x64_bf16 v[32:35], v[72:75], v[136:143], v2
    s_xor_b32 s40, s40, 1048576
    s_xor_b32 s39, s39, 1048576
    s_lshr_b32 s41, s21, 1
    v_smfmac_f32_16x16x64_bf16 v[36:39], v[68:71], v[144:151], v2
    s_and_b32 s41, s41, 1
    s_xor_b32 s41, s41, 1
    s_xor_b32 s35, s35, 16384
    v_smfmac_f32_16x16x64_bf16 v[36:39], v[72:75], v[152:159], v2
    v_add_f32 v32, v32, v34
    s_xor_b32 s36, s36, 16384
    s_add_u32 s43, s43, 262144
    s_add_u32 s44, s44, 262144
    v_smfmac_f32_16x16x64_bf16 v[40:43], v[68:71], v[160:167], v2
    v_add_f32 v33, v33, v35
    v_smfmac_f32_16x16x64_bf16 v[40:43], v[72:75], v[168:175], v2
    v_cvt_pk_bf16_f32 v32, v32, v33
    v_smfmac_f32_16x16x64_bf16 v[44:47], v[68:71], v[176:183], v2
    v_and_or_b32 v32, v32, -2, s42
    v_smfmac_f32_16x16x64_bf16 v[44:47], v[72:75], v[184:191], v2
    v_add_f32 v36, v36, v38
    v_smfmac_f32_16x16x64_bf16 v[48:51], v[68:71], v[192:199], v2
    v_add_f32 v37, v37, v39
    v_smfmac_f32_16x16x64_bf16 v[48:51], v[72:75], v[200:207], v2
    v_cvt_pk_bf16_f32 v33, v36, v37
    v_smfmac_f32_16x16x64_bf16 v[52:55], v[68:71], v[208:215], v2
    v_add_f32 v40, v40, v42
    v_smfmac_f32_16x16x64_bf16 v[52:55], v[72:75], v[216:223], v2
    v_add_f32 v41, v41, v43
    v_smfmac_f32_16x16x64_bf16 v[56:59], v[68:71], v[224:231], v2
    v_cvt_pk_bf16_f32 v34, v40, v41
    v_smfmac_f32_16x16x64_bf16 v[56:59], v[72:75], v[232:239], v2
    v_add_f32 v44, v44, v46
    v_smfmac_f32_16x16x64_bf16 v[60:63], v[68:71], v[240:247], v2
    v_add_f32 v45, v45, v47
    v_smfmac_f32_16x16x64_bf16 v[60:63], v[72:75], v[248:255], v2
    v_cvt_pk_bf16_f32 v35, v44, v45
    buffer_store_dwordx4 v[32:35], v8, s[4:7], s46 offen sc1
    v_pk_add_f32 v[48:49], v[48:49], v[50:51]
    v_cvt_pk_bf16_f32 v48, v48, v49
    v_and_or_b32 v48, v48, -2, s42
    v_pk_add_f32 v[52:53], v[52:53], v[54:55]
    v_cvt_pk_bf16_f32 v49, v52, v53
    v_pk_add_f32 v[56:57], v[56:57], v[58:59]
    v_cvt_pk_bf16_f32 v50, v56, v57
    v_pk_add_f32 v[60:61], v[60:61], v[62:63]
    v_cvt_pk_bf16_f32 v51, v60, v61
    buffer_store_dwordx4 v[48:51], v8, s[4:7], s61 offen sc1
    s_add_u32 s45, s45, 262144
    s_add_u32 s51, s51, 262144
    v_mfma_f32_32x32x8_bf16 v[96:111], v[14:15], v[14:15], 0
    v_mfma_f32_16x16x16_bf16 v[112:115], v[14:15], v[14:15], 0
    v_mfma_f32_16x16x16_bf16 v[116:119], v[14:15], v[14:15], 0
    ds_read_b128 v[64:67], v1 offset:0
    ds_read_b128 v[68:71], v1 offset:1024
    ds_read_b128 v[72:75], v1 offset:2048
    ds_read_b128 v[76:79], v1 offset:3072
    ds_read_b128 v[80:83], v1 offset:16384
    ds_read_b128 v[84:87], v1 offset:17408
    ds_read_b128 v[88:91], v1 offset:18432
    ds_read_b128 v[92:95], v1 offset:19456
    v_mov_b32 v58, -1
    v_mov_b32 v59, -1
    s_waitcnt vmcnt(0)
mega_kernel_rs_w0_cgo:
mega_kernel_rs_w0_pc:
    buffer_load_dword v36, v13, s[4:7], s25 offen offset:0 sc1
    buffer_load_dword v37, v13, s[4:7], s25 offen offset:256 sc1
    buffer_load_dword v38, v13, s[4:7], s25 offen offset:512 sc1
    buffer_load_dword v39, v13, s[4:7], s25 offen offset:768 sc1
    buffer_load_dword v40, v13, s[4:7], s25 offen offset:1024 sc1
    buffer_load_dword v41, v13, s[4:7], s25 offen offset:1280 sc1
    buffer_load_dword v42, v13, s[4:7], s25 offen offset:1536 sc1
    buffer_load_dword v43, v13, s[4:7], s25 offen offset:1792 sc1
    s_waitcnt vmcnt(4)
    v_mfma_f32_16x16x32_bf16 v[52:55], v[36:39], v[24:27], 0
    v_bitop3_b32 v3, s42, v36, v37 bitop3:0x7e
    v_bitop3_b32 v4, s42, v38, v39 bitop3:0x7e
    s_waitcnt vmcnt(2)
    v_or_b32 v3, v3, v4
    v_bitop3_b32 v4, s42, v40, v41 bitop3:0x7e
    s_waitcnt vmcnt(0)
    v_mfma_f32_16x16x32_bf16 v[52:55], v[40:43], v[24:27], v[52:55]
    v_bitop3_b32 v56, s42, v42, v43 bitop3:0x7e
    v_or3_b32 v3, v3, v4, v56
    v_and_b32 v3, v0, v3
    v_cmp_ne_u32 vcc, 0, v3
    s_nop 3
    v_cvt_pk_bf16_f32 v56, v52, v53
    v_cvt_pk_bf16_f32 v57, v54, v55
    v_min_u32 v56, -2, v56
    s_cbranch_vccnz mega_kernel_rs_w0_pc
    s_mov_b64 exec, s[26:27]
    buffer_store_dwordx2 v[56:57], v9, s[4:7], s35 offen offset:0 sc1
    buffer_store_dwordx2 v[58:59], v9, s[4:7], s36 offen offset:0 sc1
    s_mov_b64 exec, -1
    s_xor_b32 s42, s42, 1
    s_branch mega_kernel_rs_w0_loop
mega_kernel_rs_w0_last:
    buffer_store_dwordx4 v[64:67], v10, s[4:7], s45 offen offset:0 sc1
    buffer_store_dwordx2 v[18:19], v11, s[4:7], s51 offen offset:2048 sc1
    s_branch mega_kernel_rs_end
mega_kernel_rs_w0_pafail:
    s_nop 7
    v_mov_b32 v96, 0
    v_mov_b32 v97, 0
    v_mov_b32 v98, 0
    v_mov_b32 v99, 0
    v_mov_b32 v100, 0
    v_mov_b32 v101, 0
    v_mov_b32 v102, 0
    v_mov_b32 v103, 0
    v_mov_b32 v104, 0
    v_mov_b32 v105, 0
    v_mov_b32 v106, 0
    v_mov_b32 v107, 0
    s_branch mega_kernel_rs_w0_pa
mega_kernel_rs_w0_xslow:
    buffer_load_dwordx2 v[108:109], v11, s[4:7], s38 offen sc1
    buffer_load_dwordx2 v[110:111], v11, s[4:7], s38 offen offset:512 sc1
    s_waitcnt vmcnt(2)
    v_bitop3_b32 v3, s41, v20, v22 bitop3:0x7e
    v_mfma_f32_16x16x16_bf16 v[80:83], v[20:21], v[16:17], v[100:103]
    v_and_b32 v3, 1, v3
    v_mfma_f32_16x16x16_bf16 v[84:87], v[22:23], v[16:17], v[104:107]
    v_cmp_ne_u32 vcc, 0, v3
    s_cbranch_vccz mega_kernel_rs_w0_xgot
    buffer_load_dwordx2 v[20:21], v11, s[4:7], s38 offen sc1
    buffer_load_dwordx2 v[22:23], v11, s[4:7], s38 offen offset:512 sc1
    s_waitcnt vmcnt(2)
    v_bitop3_b32 v3, s41, v108, v110 bitop3:0x7e
    v_mfma_f32_16x16x16_bf16 v[80:83], v[108:109], v[16:17], v[100:103]
    v_and_b32 v3, 1, v3
    v_mfma_f32_16x16x16_bf16 v[84:87], v[110:111], v[16:17], v[104:107]
    v_cmp_ne_u32 vcc, 0, v3
    s_cbranch_vccz mega_kernel_rs_w0_xgot
    s_branch mega_kernel_rs_w0_xslow
mega_kernel_rs_w0_xgot:
    s_nop 3
    v_cvt_pk_bf16_f32 v64, v80, v81
    v_cvt_pk_bf16_f32 v65, v82, v83
    v_cvt_pk_bf16_f32 v66, v84, v85
    v_cvt_pk_bf16_f32 v67, v86, v87
    ds_write_b128 v6, v[64:67] offset:8192
    s_branch mega_kernel_rs_w0_xok
mega_kernel_rs_w0_pv0:
    s_waitcnt vmcnt(2)
    s_branch mega_kernel_rs_w0_pv1
mega_kernel_rs_w0_pv:
    buffer_load_dwordx2 v[20:21], v11, s[4:7], s40 offen sc1
    s_waitcnt vmcnt(0)
mega_kernel_rs_w0_pv1:
    v_and_b32 v3, 1, v20
    v_cmp_ne_u32 vcc, s41, v3
    v_mov_b32 v113, v20
    v_mov_b32 v115, v21
    s_cbranch_vccnz mega_kernel_rs_w0_pv
    s_branch mega_kernel_rs_w0_pv2
mega_kernel_rs_w1_entry:
    v_mfma_f32_32x32x8_bf16 v[96:111], v[14:15], v[14:15], 0
    v_mfma_f32_16x16x16_bf16 v[112:115], v[14:15], v[14:15], 0
    v_mfma_f32_16x16x16_bf16 v[116:119], v[14:15], v[14:15], 0
    ds_read_b128 v[64:67], v1 offset:4096
    ds_read_b128 v[68:71], v1 offset:5120
    ds_read_b128 v[72:75], v1 offset:6144
    ds_read_b128 v[76:79], v1 offset:7168
    ds_read_b128 v[80:83], v1 offset:20480
    ds_read_b128 v[84:87], v1 offset:21504
    ds_read_b128 v[88:91], v1 offset:22528
    ds_read_b128 v[92:95], v1 offset:23552
    buffer_load_dwordx4 v[120:123], v1, s[4:7], s44 offen
    buffer_load_dwordx4 v[124:127], v1, s[4:7], s44 offen offset:1024
    s_add_u32 s44, s44, 262144
mega_kernel_rs_w1_loop:
    s_add_u32 s22, s35, 2048
    s_waitcnt vmcnt(0)
    buffer_load_dwordx4 v[40:43], v1, s[4:7], s22 offen sc1
    buffer_load_dwordx4 v[44:47], v1, s[4:7], s22 offen offset:1024 sc1
mega_kernel_rs_w1_pa:
    s_waitcnt vmcnt(1)
    ds_write_b128 v6, v[40:43] offset:2048
    s_waitcnt vmcnt(0)
    ds_write_b128 v6, v[44:47] offset:3072
    v_max3_u32 v3, v40, v42, v44
    v_max_u32 v3, v3, v46
    v_cmp_eq_u32 vcc, -1, v3
    v_smfmac_f32_16x16x64_bf16 v[96:99], v[40:43], a[32:39], v2
    buffer_load_dwordx4 v[40:43], v1, s[4:7], s22 offen sc1
    v_smfmac_f32_16x16x64_bf16 v[100:103], v[40:43], a[40:47], v2
    buffer_load_dwordx4 v[44:47], v1, s[4:7], s22 offen offset:1024 sc1
    v_smfmac_f32_16x16x64_bf16 v[104:107], v[40:43], a[160:167], v2
    s_cbranch_vccnz mega_kernel_rs_w1_pafail
    s_waitcnt lgkmcnt(0)
    s_barrier
    ds_read_b128 v[48:51], v6 offset:4096
    ds_read_b128 v[52:55], v6 offset:5120
    v_smfmac_f32_16x16x64_bf16 v[108:111], v[40:43], a[168:175], v2
    ds_read_b128 v[56:59], v6 offset:6144
    v_smfmac_f32_16x16x64_bf16 v[96:99], v[44:47], a[48:55], v2
    ds_read_b128 v[60:63], v6 offset:7168
    v_smfmac_f32_16x16x64_bf16 v[100:103], v[44:47], a[56:63], v2
    ds_read_b128 v[32:35], v6 offset:0
    v_smfmac_f32_16x16x64_bf16 v[104:107], v[44:47], a[176:183], v2
    ds_read_b128 v[36:39], v6 offset:1024
    v_smfmac_f32_16x16x64_bf16 v[108:111], v[44:47], a[184:191], v2
    s_waitcnt lgkmcnt(5)
    v_smfmac_f32_16x16x64_bf16 v[96:99], v[48:51], a[64:71], v2
    buffer_load_dwordx4 v1, s[4:7], s43 offen lds
    v_smfmac_f32_16x16x64_bf16 v[104:107], v[48:51], a[192:199], v2
    s_waitcnt lgkmcnt(4)
    v_smfmac_f32_16x16x64_bf16 v[96:99], v[52:55], a[80:87], v2
    v_smfmac_f32_16x16x64_bf16 v[104:107], v[52:55], a[208:215], v2
    s_waitcnt lgkmcnt(3)
    v_smfmac_f32_16x16x64_bf16 v[96:99], v[56:59], a[96:103], v2
    buffer_load_dwordx4 v1, s[4:7], s43 offen offset:1024 lds
    v_smfmac_f32_16x16x64_bf16 v[104:107], v[56:59], a[224:231], v2
    s_waitcnt lgkmcnt(2)
    v_smfmac_f32_16x16x64_bf16 v[96:99], v[60:63], a[112:119], v2
    v_smfmac_f32_16x16x64_bf16 v[104:107], v[60:63], a[240:247], v2
    s_waitcnt lgkmcnt(1)
    v_smfmac_f32_16x16x64_bf16 v[96:99], v[32:35], a[0:7], v2
    v_smfmac_f32_16x16x64_bf16 v[104:107], v[32:35], a[128:135], v2
    s_waitcnt lgkmcnt(0)
    v_smfmac_f32_16x16x64_bf16 v[96:99], v[36:39], a[16:23], v2
    v_smfmac_f32_16x16x64_bf16 v[104:107], v[36:39], a[144:151], v2
    v_smfmac_f32_16x16x64_bf16 v[100:103], v[48:51], a[72:79], v2
    s_nop 2
    v_smfmac_f32_16x16x64_bf16 v[100:103], v[52:55], a[88:95], v2
    s_nop 1
    v_add_f32 v96, v96, v98
    v_smfmac_f32_16x16x64_bf16 v[100:103], v[56:59], a[104:111], v2
    v_add_f32 v97, v97, v99
    v_add_f32 v104, v104, v106
    v_smfmac_f32_16x16x64_bf16 v[100:103], v[60:63], a[120:127], v2
    v_add_f32 v105, v105, v107
    v_cvt_pk_bf16_f32 v96, v96, v97
    v_smfmac_f32_16x16x64_bf16 v[100:103], v[32:35], a[8:15], v2
    v_cvt_pk_bf16_f32 v97, v104, v105
    v_and_or_b32 v96, v96, -2, s41
    v_smfmac_f32_16x16x64_bf16 v[100:103], v[36:39], a[24:31], v2
    buffer_store_dwordx2 v[96:97], v11, s[4:7], s37 offen sc1
    v_smfmac_f32_16x16x64_bf16 v[108:111], v[48:51], a[200:207], v2
    v_smfmac_f32_16x16x64_bf16 v[108:111], v[52:55], a[216:223], v2
    v_smfmac_f32_16x16x64_bf16 v[108:111], v[56:59], a[232:239], v2
    v_smfmac_f32_16x16x64_bf16 v[108:111], v[60:63], a[248:255], v2
    v_smfmac_f32_16x16x64_bf16 v[108:111], v[32:35], a[136:143], v2
    s_nop 2
    v_add_f32 v100, v100, v102
    v_smfmac_f32_16x16x64_bf16 v[108:111], v[36:39], a[152:159], v2
    v_add_f32 v101, v101, v103
    v_cvt_pk_bf16_f32 v98, v100, v101
    v_and_or_b32 v98, v98, -2, s41
    s_nop 4
    v_pk_add_f32 v[108:109], v[108:109], v[110:111]
    v_cvt_pk_bf16_f32 v99, v108, v109
    buffer_store_dwordx2 v[98:99], v11, s[4:7], s37 offen offset:512 sc1
    v_smfmac_f32_16x16x64_bf16 v[112:115], v[32:35], v[64:71], v2
    ds_read_b128 v[64:67], v1 offset:36864
    ds_read_b128 v[68:71], v1 offset:37888
    v_smfmac_f32_16x16x64_bf16 v[116:119], v[32:35], v[72:79], v2
    ds_read_b128 v[72:75], v1 offset:38912
    ds_read_b128 v[76:79], v1 offset:39936
    v_smfmac_f32_16x16x64_bf16 v[112:115], v[36:39], v[80:87], v2
    ds_read_b128 v[80:83], v1 offset:53248
    ds_read_b128 v[84:87], v1 offset:54272
    v_smfmac_f32_16x16x64_bf16 v[116:119], v[36:39], v[88:95], v2
    ds_read_b128 v[88:91], v1 offset:55296
    ds_read_b128 v[92:95], v1 offset:56320
    s_waitcnt lgkmcnt(6)
    v_smfmac_f32_16x16x64_bf16 v[112:115], v[40:43], v[64:71], v2
    ds_read_b128 v[64:67], v5 offset:4096
    ds_read_b128 v[68:71], v5 offset:5120
    s_waitcnt lgkmcnt(6)
    v_smfmac_f32_16x16x64_bf16 v[116:119], v[40:43], v[72:79], v2
    ds_read_b128 v[72:75], v5 offset:6144
    ds_read_b128 v[76:79], v5 offset:7168
    s_waitcnt lgkmcnt(6)
    v_smfmac_f32_16x16x64_bf16 v[112:115], v[44:47], v[80:87], v2
    ds_read_b128 v[80:83], v5 offset:20480
    ds_read_b128 v[84:87], v5 offset:21504
    s_waitcnt lgkmcnt(6)
    v_smfmac_f32_16x16x64_bf16 v[116:119], v[44:47], v[88:95], v2
    ds_read_b128 v[88:91], v5 offset:22528
    ds_read_b128 v[92:95], v5 offset:23552
    s_waitcnt lgkmcnt(6)
    v_smfmac_f32_16x16x64_bf16 v[112:115], v[48:51], v[64:71], v2
    ds_read_b128 v[64:67], v5 offset:36864
    ds_read_b128 v[68:71], v5 offset:37888
    s_waitcnt lgkmcnt(6)
    v_smfmac_f32_16x16x64_bf16 v[116:119], v[48:51], v[72:79], v2
    ds_read_b128 v[72:75], v5 offset:38912
    ds_read_b128 v[76:79], v5 offset:39936
    s_waitcnt lgkmcnt(6)
    v_smfmac_f32_16x16x64_bf16 v[112:115], v[52:55], v[80:87], v2
    ds_read_b128 v[80:83], v5 offset:53248
    ds_read_b128 v[84:87], v5 offset:54272
    s_waitcnt lgkmcnt(6)
    v_smfmac_f32_16x16x64_bf16 v[116:119], v[52:55], v[88:95], v2
    ds_read_b128 v[88:91], v5 offset:55296
    ds_read_b128 v[92:95], v5 offset:56320
    s_waitcnt lgkmcnt(6)
    v_smfmac_f32_16x16x64_bf16 v[112:115], v[56:59], v[64:71], v2
    s_waitcnt lgkmcnt(4)
    v_smfmac_f32_16x16x64_bf16 v[116:119], v[56:59], v[72:79], v2
    s_waitcnt lgkmcnt(2)
    v_smfmac_f32_16x16x64_bf16 v[112:115], v[60:63], v[80:87], v2
    s_waitcnt lgkmcnt(0)
    v_smfmac_f32_16x16x64_bf16 v[116:119], v[60:63], v[88:95], v2
    buffer_load_dwordx2 v[108:109], v11, s[4:7], s38 offen sc1
    v_mfma_f32_16x16x16_bf16 v[100:103], v[96:97], v[16:17], 0
    v_mfma_f32_16x16x16_bf16 v[104:107], v[98:99], v[16:17], 0
    s_nop 4
    v_add_f32 v112, v112, v114
    v_add_f32 v113, v113, v115
    v_add_f32 v114, v116, v118
    v_add_f32 v115, v117, v119
    v_cvt_pk_bf16_f32 v18, v112, v113
    v_cvt_pk_bf16_f32 v19, v114, v115
    v_and_or_b32 v18, v18, -2, s41
    buffer_load_dwordx2 v[110:111], v11, s[4:7], s38 offen offset:512 sc1
    s_barrier
    buffer_store_dwordx2 v[18:19], v11, s[4:7], s39 offen sc1
    v_mov_b32 v112, v18
    v_mov_b32 v114, v19
    v_mov_b32 v92, v28
    v_mov_b32 v93, 0
    s_waitcnt vmcnt(5)
    s_barrier
    ds_read_b128 v[32:35], v6 offset:14336
    ds_read_b128 v[36:39], v6 offset:15360
    ds_read_b128 v[40:43], v6 offset:9216
    ds_read_b128 v[44:47], v6 offset:10240
    ds_read_b128 v[48:51], v6 offset:24576
    ds_read_b128 v[52:55], v6 offset:25600
    ds_read_b128 v[56:59], v6 offset:19456
    ds_read_b128 v[60:63], v6 offset:20480
    buffer_load_dwordx2 v[20:21], v11, s[4:7], s38 offen sc1
    buffer_load_dwordx2 v[22:23], v11, s[4:7], s38 offen offset:512 sc1
    s_waitcnt vmcnt(4)
    v_mfma_f32_16x16x16_bf16 v[80:83], v[108:109], v[16:17], v[100:103]
    v_and_b32 v3, 1, v108
    v_cmp_ne_u32 vcc, s41, v3
    s_nop 5
    v_cvt_pk_bf16_f32 v64, v80, v81
    v_cvt_pk_bf16_f32 v65, v82, v83
    s_cbranch_vccnz mega_kernel_rs_w1_xslow
    s_waitcnt vmcnt(3)
    v_mfma_f32_16x16x16_bf16 v[84:87], v[110:111], v[16:17], v[104:107]
    v_and_b32 v3, 1, v110
    v_cmp_ne_u32 vcc, s41, v3
    s_nop 5
    v_cvt_pk_bf16_f32 v66, v84, v85
    v_cvt_pk_bf16_f32 v67, v86, v87
    ds_write_b128 v6, v[64:67] offset:13312
    s_cbranch_vccnz mega_kernel_rs_w1_xslow
mega_kernel_rs_w1_xok:
    s_cmp_eq_u32 s21, 63
    s_cbranch_scc1 mega_kernel_rs_w1_last
    buffer_load_dwordx2 v[116:117], v11, s[4:7], s40 offen sc1
    s_waitcnt lgkmcnt(1)
    v_mfma_f32_16x16x32_bf16 v[80:83], v[32:35], v[64:67], 0
    s_waitcnt lgkmcnt(0)
    s_barrier
    ds_read_b128 v[68:71], v6 offset:8192
    ds_read_b128 v[72:75], v6 offset:23552
    ds_read_b128 v[76:79], v6 offset:18432
    v_mfma_f32_16x16x32_bf16 v[84:87], v[36:39], v[64:67], 0
    v_mfma_f32_16x16x32_bf16 v[88:91], v[64:67], v[64:67], 0
    buffer_load_dwordx2 v[20:21], v11, s[4:7], s40 offen sc1
    s_waitcnt lgkmcnt(2)
    v_mfma_f32_16x16x32_bf16 v[80:83], v[40:43], v[68:71], v[80:83]
    s_waitcnt lgkmcnt(1)
    v_mfma_f32_16x16x32_bf16 v[80:83], v[48:51], v[72:75], v[80:83]
    buffer_store_dwordx4 v[64:67], v10, s[4:7], s45 offen offset:64 sc1
    s_waitcnt lgkmcnt(0)
    v_mfma_f32_16x16x32_bf16 v[80:83], v[56:59], v[76:79], v[80:83]
    v_mfma_f32_16x16x32_bf16 v[84:87], v[44:47], v[68:71], v[84:87]
    v_mfma_f32_16x16x32_bf16 v[84:87], v[52:55], v[72:75], v[84:87]
    v_mfma_f32_16x16x32_bf16 v[84:87], v[60:63], v[76:79], v[84:87]
    buffer_store_dwordx2 v[18:19], v11, s[4:7], s51 offen offset:2560 sc1
    v_mfma_f32_16x16x32_bf16 v[88:91], v[68:71], v[68:71], v[88:91]
    v_mfma_f32_16x16x32_bf16 v[88:91], v[72:75], v[72:75], v[88:91]
    v_mfma_f32_16x16x32_bf16 v[88:91], v[76:79], v[76:79], v[88:91]
    v_mfma_f32_32x32x4_2b_bf16 v[32:63], v[14:15], v[14:15], 0
    s_nop 0
    v_max3_f32 v4, v80, v81, v82
    s_nop 1
    v_max3_f32 v4, v4, v83, v84
    v_max3_f32 v4, v4, v85, v86
    v_max_f32 v4, v4, v87
    v_max3_f32 v90, v4, v88, v89
    v_max3_f32 v4, v4, v88, v89
    s_nop 1
    v_permlane16_swap_b32 v4, v90
    v_max_f32 v4, v4, v90
    v_max_f32 v90, v4, v90
    s_nop 1
    v_permlane32_swap_b32 v4, v90
    v_max_f32 v4, v4, v90
    v_mul_f32 v4, s34, v4
    v_pk_fma_f32 v[80:81], v[80:81], s[34:35], v[4:5] op_sel_hi:[1,0,0] neg_lo:[0,0,1] neg_hi:[0,0,1]
    v_pk_fma_f32 v[82:83], v[82:83], s[34:35], v[4:5] op_sel_hi:[1,0,0] neg_lo:[0,0,1] neg_hi:[0,0,1]
    v_pk_fma_f32 v[84:85], v[84:85], s[34:35], v[4:5] op_sel_hi:[1,0,0] neg_lo:[0,0,1] neg_hi:[0,0,1]
    v_pk_fma_f32 v[86:87], v[86:87], s[34:35], v[4:5] op_sel_hi:[1,0,0] neg_lo:[0,0,1] neg_hi:[0,0,1]
    v_pk_fma_f32 v[88:89], v[88:89], s[34:35], v[4:5] op_sel_hi:[1,0,0] neg_lo:[0,0,1] neg_hi:[0,0,1]
    v_exp_f32 v80, v80
    v_exp_f32 v81, v81
    v_exp_f32 v82, v82
    v_cvt_pk_bf16_f32 v68, v80, v81
    v_exp_f32 v83, v83
    v_exp_f32 v84, v84
    v_cvt_pk_bf16_f32 v69, v82, v83
    v_exp_f32 v85, v85
    v_exp_f32 v86, v86
    v_cvt_pk_bf16_f32 v70, v84, v85
    v_exp_f32 v87, v87
    v_exp_f32 v88, v88
    v_cvt_pk_bf16_f32 v71, v86, v87
    v_exp_f32 v89, v89
    s_waitcnt vmcnt(3)
    v_mfma_f32_16x16x32_bf16 v[76:79], v[28:31], v[68:71], 0
    v_and_b32 v3, 1, v116
    v_cvt_pk_bf16_f32 v72, v88, v89
    v_mfma_f32_16x16x32_bf16 v[100:103], v[120:123], v[68:71], 0
    v_cmp_ne_u32 vcc, s41, v3
    v_cvt_pk_bf16_f32 v73, v88, v89
    v_mfma_f32_16x16x32_bf16 v[104:107], v[124:127], v[68:71], 0
    v_mov_b32 v113, v116
    v_mov_b32 v115, v117
    v_mfma_f32_16x16x16_bf16 v[76:79], v[92:93], v[72:73], v[76:79]
    s_cbranch_vccnz mega_kernel_rs_w1_pv0
mega_kernel_rs_w1_pv2:
    v_mfma_f32_16x16x16_bf16 v[100:103], v[112:113], v[72:73], v[100:103]
    v_mfma_f32_16x16x16_bf16 v[104:107], v[114:115], v[72:73], v[104:107]
    buffer_load_dwordx4 v[120:123], v1, s[4:7], s44 offen
    buffer_load_dwordx4 v[124:127], v1, s[4:7], s44 offen offset:1024
    s_nop 2
    v_rcp_f32 v76, v76
    s_mov_b64 exec, s[28:29]
    v_pk_mul_f32 v[100:101], v[100:101], v[76:77] op_sel_hi:[1,0]
    v_pk_mul_f32 v[102:103], v[102:103], v[76:77] op_sel_hi:[1,0]
    v_pk_mul_f32 v[104:105], v[104:105], v[76:77] op_sel_hi:[1,0]
    v_pk_mul_f32 v[106:107], v[106:107], v[76:77] op_sel_hi:[1,0]
    v_cvt_pk_bf16_f32 v84, v100, v101
    v_cvt_pk_bf16_f32 v85, v102, v103
    v_cvt_pk_bf16_f32 v86, v104, v105
    v_cvt_pk_bf16_f32 v87, v106, v107
    ds_write_b128 v6, v[84:87] offset:28672
    s_mov_b64 exec, -1
    s_waitcnt lgkmcnt(0)
    s_barrier
    ds_read_b128 v[68:71], v6 offset:28672
    ds_read_b128 v[72:75], v6 offset:29696
    s_waitcnt lgkmcnt(1)
    v_smfmac_f32_16x16x64_bf16 v[32:35], v[68:71], v[128:135], v2
    s_add_u32 s21, s21, 1
    s_xor_b32 s38, s38, 1048576
    s_xor_b32 s37, s37, 1048576
    s_waitcnt lgkmcnt(0)
    v_smfmac_f32_16x16x64_bf16 v[32:35], v[72:75], v[136:143], v2
    s_xor_b32 s40, s40, 1048576
    s_xor_b32 s39, s39, 1048576
    s_lshr_b32 s41, s21, 1
    v_smfmac_f32_16x16x64_bf16 v[36:39], v[68:71], v[144:151], v2
    s_and_b32 s41, s41, 1
    s_xor_b32 s41, s41, 1
    s_xor_b32 s35, s35, 16384
    v_smfmac_f32_16x16x64_bf16 v[36:39], v[72:75], v[152:159], v2
    v_add_f32 v32, v32, v34
    s_xor_b32 s36, s36, 16384
    s_add_u32 s43, s43, 262144
    s_add_u32 s44, s44, 262144
    v_smfmac_f32_16x16x64_bf16 v[40:43], v[68:71], v[160:167], v2
    v_add_f32 v33, v33, v35
    v_smfmac_f32_16x16x64_bf16 v[40:43], v[72:75], v[168:175], v2
    v_cvt_pk_bf16_f32 v32, v32, v33
    v_smfmac_f32_16x16x64_bf16 v[44:47], v[68:71], v[176:183], v2
    v_and_or_b32 v32, v32, -2, s42
    v_smfmac_f32_16x16x64_bf16 v[44:47], v[72:75], v[184:191], v2
    v_add_f32 v36, v36, v38
    v_smfmac_f32_16x16x64_bf16 v[48:51], v[68:71], v[192:199], v2
    v_add_f32 v37, v37, v39
    v_smfmac_f32_16x16x64_bf16 v[48:51], v[72:75], v[200:207], v2
    v_cvt_pk_bf16_f32 v33, v36, v37
    v_smfmac_f32_16x16x64_bf16 v[52:55], v[68:71], v[208:215], v2
    v_add_f32 v40, v40, v42
    v_smfmac_f32_16x16x64_bf16 v[52:55], v[72:75], v[216:223], v2
    v_add_f32 v41, v41, v43
    v_smfmac_f32_16x16x64_bf16 v[56:59], v[68:71], v[224:231], v2
    v_cvt_pk_bf16_f32 v34, v40, v41
    v_smfmac_f32_16x16x64_bf16 v[56:59], v[72:75], v[232:239], v2
    v_add_f32 v44, v44, v46
    v_smfmac_f32_16x16x64_bf16 v[60:63], v[68:71], v[240:247], v2
    v_add_f32 v45, v45, v47
    v_smfmac_f32_16x16x64_bf16 v[60:63], v[72:75], v[248:255], v2
    v_cvt_pk_bf16_f32 v35, v44, v45
    buffer_store_dwordx4 v[32:35], v8, s[4:7], s46 offen sc1
    v_pk_add_f32 v[48:49], v[48:49], v[50:51]
    v_cvt_pk_bf16_f32 v48, v48, v49
    v_and_or_b32 v48, v48, -2, s42
    v_pk_add_f32 v[52:53], v[52:53], v[54:55]
    v_cvt_pk_bf16_f32 v49, v52, v53
    v_pk_add_f32 v[56:57], v[56:57], v[58:59]
    v_cvt_pk_bf16_f32 v50, v56, v57
    v_pk_add_f32 v[60:61], v[60:61], v[62:63]
    v_cvt_pk_bf16_f32 v51, v60, v61
    buffer_store_dwordx4 v[48:51], v8, s[4:7], s61 offen sc1
    s_add_u32 s45, s45, 262144
    s_add_u32 s51, s51, 262144
    v_mfma_f32_32x32x8_bf16 v[96:111], v[14:15], v[14:15], 0
    v_mfma_f32_16x16x16_bf16 v[112:115], v[14:15], v[14:15], 0
    v_mfma_f32_16x16x16_bf16 v[116:119], v[14:15], v[14:15], 0
    ds_read_b128 v[64:67], v1 offset:4096
    ds_read_b128 v[68:71], v1 offset:5120
    ds_read_b128 v[72:75], v1 offset:6144
    ds_read_b128 v[76:79], v1 offset:7168
    ds_read_b128 v[80:83], v1 offset:20480
    ds_read_b128 v[84:87], v1 offset:21504
    ds_read_b128 v[88:91], v1 offset:22528
    ds_read_b128 v[92:95], v1 offset:23552
    v_mov_b32 v58, -1
    v_mov_b32 v59, -1
    s_waitcnt vmcnt(0)
mega_kernel_rs_w1_cgo:
mega_kernel_rs_w1_pc:
    buffer_load_dword v36, v13, s[4:7], s25 offen offset:0 sc1
    buffer_load_dword v37, v13, s[4:7], s25 offen offset:256 sc1
    buffer_load_dword v38, v13, s[4:7], s25 offen offset:512 sc1
    buffer_load_dword v39, v13, s[4:7], s25 offen offset:768 sc1
    buffer_load_dword v40, v13, s[4:7], s25 offen offset:1024 sc1
    buffer_load_dword v41, v13, s[4:7], s25 offen offset:1280 sc1
    buffer_load_dword v42, v13, s[4:7], s25 offen offset:1536 sc1
    buffer_load_dword v43, v13, s[4:7], s25 offen offset:1792 sc1
    s_waitcnt vmcnt(4)
    v_mfma_f32_16x16x32_bf16 v[52:55], v[36:39], v[24:27], 0
    v_bitop3_b32 v3, s42, v36, v37 bitop3:0x7e
    v_bitop3_b32 v4, s42, v38, v39 bitop3:0x7e
    s_waitcnt vmcnt(2)
    v_or_b32 v3, v3, v4
    v_bitop3_b32 v4, s42, v40, v41 bitop3:0x7e
    s_waitcnt vmcnt(0)
    v_mfma_f32_16x16x32_bf16 v[52:55], v[40:43], v[24:27], v[52:55]
    v_bitop3_b32 v56, s42, v42, v43 bitop3:0x7e
    v_or3_b32 v3, v3, v4, v56
    v_and_b32 v3, v0, v3
    v_cmp_ne_u32 vcc, 0, v3
    s_nop 3
    v_cvt_pk_bf16_f32 v56, v52, v53
    v_cvt_pk_bf16_f32 v57, v54, v55
    v_min_u32 v56, -2, v56
    s_cbranch_vccnz mega_kernel_rs_w1_pc
    s_mov_b64 exec, s[26:27]
    buffer_store_dwordx2 v[56:57], v9, s[4:7], s35 offen offset:256 sc1
    buffer_store_dwordx2 v[58:59], v9, s[4:7], s36 offen offset:256 sc1
    s_mov_b64 exec, -1
    s_xor_b32 s42, s42, 1
    s_branch mega_kernel_rs_w1_loop
mega_kernel_rs_w1_last:
    buffer_store_dwordx4 v[64:67], v10, s[4:7], s45 offen offset:64 sc1
    buffer_store_dwordx2 v[18:19], v11, s[4:7], s51 offen offset:2560 sc1
    s_branch mega_kernel_rs_end
mega_kernel_rs_w1_pafail:
    s_nop 7
    v_mov_b32 v96, 0
    v_mov_b32 v97, 0
    v_mov_b32 v98, 0
    v_mov_b32 v99, 0
    v_mov_b32 v100, 0
    v_mov_b32 v101, 0
    v_mov_b32 v102, 0
    v_mov_b32 v103, 0
    v_mov_b32 v104, 0
    v_mov_b32 v105, 0
    v_mov_b32 v106, 0
    v_mov_b32 v107, 0
    s_branch mega_kernel_rs_w1_pa
mega_kernel_rs_w1_xslow:
    buffer_load_dwordx2 v[108:109], v11, s[4:7], s38 offen sc1
    buffer_load_dwordx2 v[110:111], v11, s[4:7], s38 offen offset:512 sc1
    s_waitcnt vmcnt(2)
    v_bitop3_b32 v3, s41, v20, v22 bitop3:0x7e
    v_mfma_f32_16x16x16_bf16 v[80:83], v[20:21], v[16:17], v[100:103]
    v_and_b32 v3, 1, v3
    v_mfma_f32_16x16x16_bf16 v[84:87], v[22:23], v[16:17], v[104:107]
    v_cmp_ne_u32 vcc, 0, v3
    s_cbranch_vccz mega_kernel_rs_w1_xgot
    buffer_load_dwordx2 v[20:21], v11, s[4:7], s38 offen sc1
    buffer_load_dwordx2 v[22:23], v11, s[4:7], s38 offen offset:512 sc1
    s_waitcnt vmcnt(2)
    v_bitop3_b32 v3, s41, v108, v110 bitop3:0x7e
    v_mfma_f32_16x16x16_bf16 v[80:83], v[108:109], v[16:17], v[100:103]
    v_and_b32 v3, 1, v3
    v_mfma_f32_16x16x16_bf16 v[84:87], v[110:111], v[16:17], v[104:107]
    v_cmp_ne_u32 vcc, 0, v3
    s_cbranch_vccz mega_kernel_rs_w1_xgot
    s_branch mega_kernel_rs_w1_xslow
mega_kernel_rs_w1_xgot:
    s_nop 3
    v_cvt_pk_bf16_f32 v64, v80, v81
    v_cvt_pk_bf16_f32 v65, v82, v83
    v_cvt_pk_bf16_f32 v66, v84, v85
    v_cvt_pk_bf16_f32 v67, v86, v87
    ds_write_b128 v6, v[64:67] offset:13312
    s_branch mega_kernel_rs_w1_xok
mega_kernel_rs_w1_pv0:
    s_waitcnt vmcnt(2)
    s_branch mega_kernel_rs_w1_pv1
mega_kernel_rs_w1_pv:
    buffer_load_dwordx2 v[20:21], v11, s[4:7], s40 offen sc1
    s_waitcnt vmcnt(0)
mega_kernel_rs_w1_pv1:
    v_and_b32 v3, 1, v20
    v_cmp_ne_u32 vcc, s41, v3
    v_mov_b32 v113, v20
    v_mov_b32 v115, v21
    s_cbranch_vccnz mega_kernel_rs_w1_pv
    s_branch mega_kernel_rs_w1_pv2
mega_kernel_rs_w2_entry:
    v_mfma_f32_32x32x8_bf16 v[96:111], v[14:15], v[14:15], 0
    v_mfma_f32_16x16x16_bf16 v[112:115], v[14:15], v[14:15], 0
    v_mfma_f32_16x16x16_bf16 v[116:119], v[14:15], v[14:15], 0
    ds_read_b128 v[64:67], v1 offset:8192
    ds_read_b128 v[68:71], v1 offset:9216
    ds_read_b128 v[72:75], v1 offset:10240
    ds_read_b128 v[76:79], v1 offset:11264
    ds_read_b128 v[80:83], v1 offset:24576
    ds_read_b128 v[84:87], v1 offset:25600
    ds_read_b128 v[88:91], v1 offset:26624
    ds_read_b128 v[92:95], v1 offset:27648
    buffer_load_dwordx4 v[120:123], v1, s[4:7], s44 offen
    buffer_load_dwordx4 v[124:127], v1, s[4:7], s44 offen offset:1024
    s_add_u32 s44, s44, 262144
mega_kernel_rs_w2_loop:
    s_add_u32 s22, s35, 4096
    s_waitcnt vmcnt(0)
    buffer_load_dwordx4 v[48:51], v1, s[4:7], s22 offen sc1
    buffer_load_dwordx4 v[52:55], v1, s[4:7], s22 offen offset:1024 sc1
mega_kernel_rs_w2_pa:
    s_waitcnt vmcnt(1)
    ds_write_b128 v6, v[48:51] offset:4096
    s_waitcnt vmcnt(0)
    ds_write_b128 v6, v[52:55] offset:5120
    v_max3_u32 v3, v48, v50, v52
    v_max_u32 v3, v3, v54
    v_cmp_eq_u32 vcc, -1, v3
    v_smfmac_f32_16x16x64_bf16 v[96:99], v[48:51], a[64:71], v2
    buffer_load_dwordx4 v[48:51], v1, s[4:7], s22 offen sc1
    v_smfmac_f32_16x16x64_bf16 v[100:103], v[48:51], a[72:79], v2
    buffer_load_dwordx4 v[52:55], v1, s[4:7], s22 offen offset:1024 sc1
    v_smfmac_f32_16x16x64_bf16 v[104:107], v[48:51], a[192:199], v2
    s_cbranch_vccnz mega_kernel_rs_w2_pafail
    s_waitcnt lgkmcnt(0)
    s_barrier
    ds_read_b128 v[56:59], v6 offset:6144
    ds_read_b128 v[60:63], v6 offset:7168
    v_smfmac_f32_16x16x64_bf16 v[108:111], v[48:51], a[200:207], v2
    ds_read_b128 v[32:35], v6 offset:0
    v_smfmac_f32_16x16x64_bf16 v[96:99], v[52:55], a[80:87], v2
    ds_read_b128 v[36:39], v6 offset:1024
    v_smfmac_f32_16x16x64_bf16 v[100:103], v[52:55], a[88:95], v2
    ds_read_b128 v[40:43], v6 offset:2048
    v_smfmac_f32_16x16x64_bf16 v[104:107], v[52:55], a[208:215], v2
    ds_read_b128 v[44:47], v6 offset:3072
    v_smfmac_f32_16x16x64_bf16 v[108:111], v[52:55], a[216:223], v2
    s_waitcnt lgkmcnt(5)
    v_smfmac_f32_16x16x64_bf16 v[96:99], v[56:59], a[96:103], v2
    v_smfmac_f32_16x16x64_bf16 v[104:107], v[56:59], a[224:231], v2
    buffer_load_dwordx4 v1, s[4:7], s43 offen lds
    s_waitcnt lgkmcnt(4)
    v_smfmac_f32_16x16x64_bf16 v[96:99], v[60:63], a[112:119], v2
    v_smfmac_f32_16x16x64_bf16 v[104:107], v[60:63], a[240:247], v2
    s_waitcnt lgkmcnt(3)
    v_smfmac_f32_16x16x64_bf16 v[96:99], v[32:35], a[0:7], v2
    v_smfmac_f32_16x16x64_bf16 v[104:107], v[32:35], a[128:135], v2
    buffer_load_dwordx4 v1, s[4:7], s43 offen offset:1024 lds
    s_waitcnt lgkmcnt(2)
    v_smfmac_f32_16x16x64_bf16 v[96:99], v[36:39], a[16:23], v2
    v_smfmac_f32_16x16x64_bf16 v[104:107], v[36:39], a[144:151], v2
    s_waitcnt lgkmcnt(1)
    v_smfmac_f32_16x16x64_bf16 v[96:99], v[40:43], a[32:39], v2
    v_smfmac_f32_16x16x64_bf16 v[104:107], v[40:43], a[160:167], v2
    s_waitcnt lgkmcnt(0)
    v_smfmac_f32_16x16x64_bf16 v[96:99], v[44:47], a[48:55], v2
    v_smfmac_f32_16x16x64_bf16 v[104:107], v[44:47], a[176:183], v2
    v_smfmac_f32_16x16x64_bf16 v[100:103], v[56:59], a[104:111], v2
    s_nop 2
    v_smfmac_f32_16x16x64_bf16 v[100:103], v[60:63], a[120:127], v2
    s_nop 1
    v_add_f32 v96, v96, v98
    v_smfmac_f32_16x16x64_bf16 v[100:103], v[32:35], a[8:15], v2
    v_add_f32 v97, v97, v99
    v_add_f32 v104, v104, v106
    v_smfmac_f32_16x16x64_bf16 v[100:103], v[36:39], a[24:31], v2
    v_add_f32 v105, v105, v107
    v_cvt_pk_bf16_f32 v96, v96, v97
    v_smfmac_f32_16x16x64_bf16 v[100:103], v[40:43], a[40:47], v2
    v_cvt_pk_bf16_f32 v97, v104, v105
    v_and_or_b32 v96, v96, -2, s41
    v_smfmac_f32_16x16x64_bf16 v[100:103], v[44:47], a[56:63], v2
    buffer_store_dwordx2 v[96:97], v11, s[4:7], s37 offen sc1
    v_smfmac_f32_16x16x64_bf16 v[108:111], v[56:59], a[232:239], v2
    v_smfmac_f32_16x16x64_bf16 v[108:111], v[60:63], a[248:255], v2
    v_smfmac_f32_16x16x64_bf16 v[108:111], v[32:35], a[136:143], v2
    v_smfmac_f32_16x16x64_bf16 v[108:111], v[36:39], a[152:159], v2
    v_smfmac_f32_16x16x64_bf16 v[108:111], v[40:43], a[168:175], v2
    s_nop 2
    v_add_f32 v100, v100, v102
    v_smfmac_f32_16x16x64_bf16 v[108:111], v[44:47], a[184:191], v2
    v_add_f32 v101, v101, v103
    v_cvt_pk_bf16_f32 v98, v100, v101
    v_and_or_b32 v98, v98, -2, s41
    s_nop 4
    v_pk_add_f32 v[108:109], v[108:109], v[110:111]
    v_cvt_pk_bf16_f32 v99, v108, v109
    buffer_store_dwordx2 v[98:99], v11, s[4:7], s37 offen offset:512 sc1
    v_smfmac_f32_16x16x64_bf16 v[112:115], v[32:35], v[64:71], v2
    ds_read_b128 v[64:67], v1 offset:40960
    ds_read_b128 v[68:71], v1 offset:41984
    v_smfmac_f32_16x16x64_bf16 v[116:119], v[32:35], v[72:79], v2
    ds_read_b128 v[72:75], v1 offset:43008
    ds_read_b128 v[76:79], v1 offset:44032
    v_smfmac_f32_16x16x64_bf16 v[112:115], v[36:39], v[80:87], v2
    ds_read_b128 v[80:83], v1 offset:57344
    ds_read_b128 v[84:87], v1 offset:58368
    v_smfmac_f32_16x16x64_bf16 v[116:119], v[36:39], v[88:95], v2
    ds_read_b128 v[88:91], v1 offset:59392
    ds_read_b128 v[92:95], v1 offset:60416
    s_waitcnt lgkmcnt(6)
    v_smfmac_f32_16x16x64_bf16 v[112:115], v[40:43], v[64:71], v2
    ds_read_b128 v[64:67], v5 offset:8192
    ds_read_b128 v[68:71], v5 offset:9216
    s_waitcnt lgkmcnt(6)
    v_smfmac_f32_16x16x64_bf16 v[116:119], v[40:43], v[72:79], v2
    ds_read_b128 v[72:75], v5 offset:10240
    ds_read_b128 v[76:79], v5 offset:11264
    s_waitcnt lgkmcnt(6)
    v_smfmac_f32_16x16x64_bf16 v[112:115], v[44:47], v[80:87], v2
    ds_read_b128 v[80:83], v5 offset:24576
    ds_read_b128 v[84:87], v5 offset:25600
    s_waitcnt lgkmcnt(6)
    v_smfmac_f32_16x16x64_bf16 v[116:119], v[44:47], v[88:95], v2
    ds_read_b128 v[88:91], v5 offset:26624
    ds_read_b128 v[92:95], v5 offset:27648
    s_waitcnt lgkmcnt(6)
    v_smfmac_f32_16x16x64_bf16 v[112:115], v[48:51], v[64:71], v2
    ds_read_b128 v[64:67], v5 offset:40960
    ds_read_b128 v[68:71], v5 offset:41984
    s_waitcnt lgkmcnt(6)
    v_smfmac_f32_16x16x64_bf16 v[116:119], v[48:51], v[72:79], v2
    ds_read_b128 v[72:75], v5 offset:43008
    ds_read_b128 v[76:79], v5 offset:44032
    s_waitcnt lgkmcnt(6)
    v_smfmac_f32_16x16x64_bf16 v[112:115], v[52:55], v[80:87], v2
    ds_read_b128 v[80:83], v5 offset:57344
    ds_read_b128 v[84:87], v5 offset:58368
    s_waitcnt lgkmcnt(6)
    v_smfmac_f32_16x16x64_bf16 v[116:119], v[52:55], v[88:95], v2
    ds_read_b128 v[88:91], v5 offset:59392
    ds_read_b128 v[92:95], v5 offset:60416
    s_waitcnt lgkmcnt(6)
    v_smfmac_f32_16x16x64_bf16 v[112:115], v[56:59], v[64:71], v2
    s_waitcnt lgkmcnt(4)
    v_smfmac_f32_16x16x64_bf16 v[116:119], v[56:59], v[72:79], v2
    s_waitcnt lgkmcnt(2)
    v_smfmac_f32_16x16x64_bf16 v[112:115], v[60:63], v[80:87], v2
    s_waitcnt lgkmcnt(0)
    v_smfmac_f32_16x16x64_bf16 v[116:119], v[60:63], v[88:95], v2
    buffer_load_dwordx2 v[108:109], v11, s[4:7], s38 offen sc1
    v_mfma_f32_16x16x16_bf16 v[100:103], v[96:97], v[16:17], 0
    v_mfma_f32_16x16x16_bf16 v[104:107], v[98:99], v[16:17], 0
    s_nop 4
    v_add_f32 v112, v112, v114
    v_add_f32 v113, v113, v115
    v_add_f32 v114, v116, v118
    v_add_f32 v115, v117, v119
    v_cvt_pk_bf16_f32 v18, v112, v113
    v_cvt_pk_bf16_f32 v19, v114, v115
    v_and_or_b32 v18, v18, -2, s41
    buffer_load_dwordx2 v[110:111], v11, s[4:7], s38 offen offset:512 sc1
    s_barrier
    buffer_store_dwordx2 v[18:19], v11, s[4:7], s39 offen sc1
    v_mov_b32 v112, v18
    v_mov_b32 v114, v19
    v_mov_b32 v92, v28
    v_mov_b32 v93, 0
    s_waitcnt vmcnt(5)
    s_barrier
    ds_read_b128 v[32:35], v6 offset:19456
    ds_read_b128 v[36:39], v6 offset:20480
    ds_read_b128 v[40:43], v6 offset:24576
    ds_read_b128 v[44:47], v6 offset:25600
    ds_read_b128 v[48:51], v6 offset:9216
    ds_read_b128 v[52:55], v6 offset:10240
    ds_read_b128 v[56:59], v6 offset:14336
    ds_read_b128 v[60:63], v6 offset:15360
    buffer_load_dwordx2 v[20:21], v11, s[4:7], s38 offen sc1
    buffer_load_dwordx2 v[22:23], v11, s[4:7], s38 offen offset:512 sc1
    s_waitcnt vmcnt(4)
    v_mfma_f32_16x16x16_bf16 v[80:83], v[108:109], v[16:17], v[100:103]
    v_and_b32 v3, 1, v108
    v_cmp_ne_u32 vcc, s41, v3
    s_nop 5
    v_cvt_pk_bf16_f32 v64, v80, v81
    v_cvt_pk_bf16_f32 v65, v82, v83
    s_cbranch_vccnz mega_kernel_rs_w2_xslow
    s_waitcnt vmcnt(3)
    v_mfma_f32_16x16x16_bf16 v[84:87], v[110:111], v[16:17], v[104:107]
    v_and_b32 v3, 1, v110
    v_cmp_ne_u32 vcc, s41, v3
    s_nop 5
    v_cvt_pk_bf16_f32 v66, v84, v85
    v_cvt_pk_bf16_f32 v67, v86, v87
    ds_write_b128 v6, v[64:67] offset:18432
    s_cbranch_vccnz mega_kernel_rs_w2_xslow
mega_kernel_rs_w2_xok:
    s_cmp_eq_u32 s21, 63
    s_cbranch_scc1 mega_kernel_rs_w2_last
    buffer_load_dwordx2 v[116:117], v11, s[4:7], s40 offen sc1
    s_waitcnt lgkmcnt(1)
    v_mfma_f32_16x16x32_bf16 v[80:83], v[32:35], v[64:67], 0
    s_waitcnt lgkmcnt(0)
    s_barrier
    ds_read_b128 v[68:71], v6 offset:23552
    ds_read_b128 v[72:75], v6 offset:8192
    ds_read_b128 v[76:79], v6 offset:13312
    v_mfma_f32_16x16x32_bf16 v[84:87], v[36:39], v[64:67], 0
    v_mfma_f32_16x16x32_bf16 v[88:91], v[64:67], v[64:67], 0
    buffer_load_dwordx2 v[20:21], v11, s[4:7], s40 offen sc1
    s_waitcnt lgkmcnt(2)
    v_mfma_f32_16x16x32_bf16 v[80:83], v[40:43], v[68:71], v[80:83]
    s_waitcnt lgkmcnt(1)
    v_mfma_f32_16x16x32_bf16 v[80:83], v[48:51], v[72:75], v[80:83]
    s_waitcnt lgkmcnt(0)
    v_mfma_f32_16x16x32_bf16 v[80:83], v[56:59], v[76:79], v[80:83]
    buffer_store_dwordx4 v[64:67], v10, s[4:7], s45 offen offset:128 sc1
    v_mfma_f32_16x16x32_bf16 v[84:87], v[44:47], v[68:71], v[84:87]
    v_mfma_f32_16x16x32_bf16 v[84:87], v[52:55], v[72:75], v[84:87]
    v_mfma_f32_16x16x32_bf16 v[84:87], v[60:63], v[76:79], v[84:87]
    v_mfma_f32_16x16x32_bf16 v[88:91], v[68:71], v[68:71], v[88:91]
    buffer_store_dwordx2 v[18:19], v11, s[4:7], s51 offen offset:3072 sc1
    v_mfma_f32_16x16x32_bf16 v[88:91], v[72:75], v[72:75], v[88:91]
    v_mfma_f32_16x16x32_bf16 v[88:91], v[76:79], v[76:79], v[88:91]
    v_mfma_f32_32x32x4_2b_bf16 v[32:63], v[14:15], v[14:15], 0
    s_nop 0
    v_max3_f32 v4, v80, v81, v82
    s_nop 1
    v_max3_f32 v4, v4, v83, v84
    v_max3_f32 v4, v4, v85, v86
    v_max_f32 v4, v4, v87
    v_max3_f32 v90, v4, v88, v89
    v_max3_f32 v4, v4, v88, v89
    s_nop 1
    v_permlane16_swap_b32 v4, v90
    v_max_f32 v4, v4, v90
    v_max_f32 v90, v4, v90
    s_nop 1
    v_permlane32_swap_b32 v4, v90
    v_max_f32 v4, v4, v90
    v_mul_f32 v4, s34, v4
    v_pk_fma_f32 v[80:81], v[80:81], s[34:35], v[4:5] op_sel_hi:[1,0,0] neg_lo:[0,0,1] neg_hi:[0,0,1]
    v_pk_fma_f32 v[82:83], v[82:83], s[34:35], v[4:5] op_sel_hi:[1,0,0] neg_lo:[0,0,1] neg_hi:[0,0,1]
    v_pk_fma_f32 v[84:85], v[84:85], s[34:35], v[4:5] op_sel_hi:[1,0,0] neg_lo:[0,0,1] neg_hi:[0,0,1]
    v_pk_fma_f32 v[86:87], v[86:87], s[34:35], v[4:5] op_sel_hi:[1,0,0] neg_lo:[0,0,1] neg_hi:[0,0,1]
    v_pk_fma_f32 v[88:89], v[88:89], s[34:35], v[4:5] op_sel_hi:[1,0,0] neg_lo:[0,0,1] neg_hi:[0,0,1]
    v_exp_f32 v80, v80
    v_exp_f32 v81, v81
    v_exp_f32 v82, v82
    v_cvt_pk_bf16_f32 v68, v80, v81
    v_exp_f32 v83, v83
    v_exp_f32 v84, v84
    v_cvt_pk_bf16_f32 v69, v82, v83
    v_exp_f32 v85, v85
    v_exp_f32 v86, v86
    v_cvt_pk_bf16_f32 v70, v84, v85
    v_exp_f32 v87, v87
    v_exp_f32 v88, v88
    v_cvt_pk_bf16_f32 v71, v86, v87
    v_exp_f32 v89, v89
    s_waitcnt vmcnt(3)
    v_mfma_f32_16x16x32_bf16 v[76:79], v[28:31], v[68:71], 0
    v_and_b32 v3, 1, v116
    v_cvt_pk_bf16_f32 v72, v88, v89
    v_mfma_f32_16x16x32_bf16 v[100:103], v[120:123], v[68:71], 0
    v_cmp_ne_u32 vcc, s41, v3
    v_cvt_pk_bf16_f32 v73, v88, v89
    v_mfma_f32_16x16x32_bf16 v[104:107], v[124:127], v[68:71], 0
    v_mov_b32 v113, v116
    v_mov_b32 v115, v117
    v_mfma_f32_16x16x16_bf16 v[76:79], v[92:93], v[72:73], v[76:79]
    s_cbranch_vccnz mega_kernel_rs_w2_pv0
mega_kernel_rs_w2_pv2:
    v_mfma_f32_16x16x16_bf16 v[100:103], v[112:113], v[72:73], v[100:103]
    v_mfma_f32_16x16x16_bf16 v[104:107], v[114:115], v[72:73], v[104:107]
    buffer_load_dwordx4 v[120:123], v1, s[4:7], s44 offen
    buffer_load_dwordx4 v[124:127], v1, s[4:7], s44 offen offset:1024
    s_nop 2
    v_rcp_f32 v76, v76
    s_mov_b64 exec, s[28:29]
    v_pk_mul_f32 v[100:101], v[100:101], v[76:77] op_sel_hi:[1,0]
    v_pk_mul_f32 v[102:103], v[102:103], v[76:77] op_sel_hi:[1,0]
    v_pk_mul_f32 v[104:105], v[104:105], v[76:77] op_sel_hi:[1,0]
    v_pk_mul_f32 v[106:107], v[106:107], v[76:77] op_sel_hi:[1,0]
    v_cvt_pk_bf16_f32 v84, v100, v101
    v_cvt_pk_bf16_f32 v85, v102, v103
    v_cvt_pk_bf16_f32 v86, v104, v105
    v_cvt_pk_bf16_f32 v87, v106, v107
    ds_write_b128 v6, v[84:87] offset:29664
    s_mov_b64 exec, -1
    s_waitcnt lgkmcnt(0)
    s_barrier
    ds_read_b128 v[68:71], v6 offset:28672
    ds_read_b128 v[72:75], v6 offset:29696
    s_waitcnt lgkmcnt(1)
    v_smfmac_f32_16x16x64_bf16 v[32:35], v[68:71], v[128:135], v2
    s_add_u32 s21, s21, 1
    s_xor_b32 s38, s38, 1048576
    s_xor_b32 s37, s37, 1048576
    s_waitcnt lgkmcnt(0)
    v_smfmac_f32_16x16x64_bf16 v[32:35], v[72:75], v[136:143], v2
    s_xor_b32 s40, s40, 1048576
    s_xor_b32 s39, s39, 1048576
    s_lshr_b32 s41, s21, 1
    v_smfmac_f32_16x16x64_bf16 v[36:39], v[68:71], v[144:151], v2
    s_and_b32 s41, s41, 1
    s_xor_b32 s41, s41, 1
    s_xor_b32 s35, s35, 16384
    v_smfmac_f32_16x16x64_bf16 v[36:39], v[72:75], v[152:159], v2
    v_add_f32 v32, v32, v34
    s_xor_b32 s36, s36, 16384
    s_add_u32 s43, s43, 262144
    s_add_u32 s44, s44, 262144
    v_smfmac_f32_16x16x64_bf16 v[40:43], v[68:71], v[160:167], v2
    v_add_f32 v33, v33, v35
    v_smfmac_f32_16x16x64_bf16 v[40:43], v[72:75], v[168:175], v2
    v_cvt_pk_bf16_f32 v32, v32, v33
    v_smfmac_f32_16x16x64_bf16 v[44:47], v[68:71], v[176:183], v2
    v_and_or_b32 v32, v32, -2, s42
    v_smfmac_f32_16x16x64_bf16 v[44:47], v[72:75], v[184:191], v2
    v_add_f32 v36, v36, v38
    v_smfmac_f32_16x16x64_bf16 v[48:51], v[68:71], v[192:199], v2
    v_add_f32 v37, v37, v39
    v_smfmac_f32_16x16x64_bf16 v[48:51], v[72:75], v[200:207], v2
    v_cvt_pk_bf16_f32 v33, v36, v37
    v_smfmac_f32_16x16x64_bf16 v[52:55], v[68:71], v[208:215], v2
    v_add_f32 v40, v40, v42
    v_smfmac_f32_16x16x64_bf16 v[52:55], v[72:75], v[216:223], v2
    v_add_f32 v41, v41, v43
    v_smfmac_f32_16x16x64_bf16 v[56:59], v[68:71], v[224:231], v2
    v_cvt_pk_bf16_f32 v34, v40, v41
    v_smfmac_f32_16x16x64_bf16 v[56:59], v[72:75], v[232:239], v2
    v_add_f32 v44, v44, v46
    v_smfmac_f32_16x16x64_bf16 v[60:63], v[68:71], v[240:247], v2
    v_add_f32 v45, v45, v47
    v_smfmac_f32_16x16x64_bf16 v[60:63], v[72:75], v[248:255], v2
    v_cvt_pk_bf16_f32 v35, v44, v45
    buffer_store_dwordx4 v[32:35], v8, s[4:7], s46 offen sc1
    v_pk_add_f32 v[48:49], v[48:49], v[50:51]
    v_cvt_pk_bf16_f32 v48, v48, v49
    v_and_or_b32 v48, v48, -2, s42
    v_pk_add_f32 v[52:53], v[52:53], v[54:55]
    v_cvt_pk_bf16_f32 v49, v52, v53
    v_pk_add_f32 v[56:57], v[56:57], v[58:59]
    v_cvt_pk_bf16_f32 v50, v56, v57
    v_pk_add_f32 v[60:61], v[60:61], v[62:63]
    v_cvt_pk_bf16_f32 v51, v60, v61
    buffer_store_dwordx4 v[48:51], v8, s[4:7], s61 offen sc1
    s_add_u32 s45, s45, 262144
    s_add_u32 s51, s51, 262144
    v_mfma_f32_32x32x8_bf16 v[96:111], v[14:15], v[14:15], 0
    v_mfma_f32_16x16x16_bf16 v[112:115], v[14:15], v[14:15], 0
    v_mfma_f32_16x16x16_bf16 v[116:119], v[14:15], v[14:15], 0
    ds_read_b128 v[64:67], v1 offset:8192
    ds_read_b128 v[68:71], v1 offset:9216
    ds_read_b128 v[72:75], v1 offset:10240
    ds_read_b128 v[76:79], v1 offset:11264
    ds_read_b128 v[80:83], v1 offset:24576
    ds_read_b128 v[84:87], v1 offset:25600
    ds_read_b128 v[88:91], v1 offset:26624
    ds_read_b128 v[92:95], v1 offset:27648
    v_mov_b32 v58, -1
    v_mov_b32 v59, -1
    s_waitcnt vmcnt(0)
mega_kernel_rs_w2_cgo:
mega_kernel_rs_w2_pc:
    buffer_load_dword v36, v13, s[4:7], s25 offen offset:0 sc1
    buffer_load_dword v37, v13, s[4:7], s25 offen offset:256 sc1
    buffer_load_dword v38, v13, s[4:7], s25 offen offset:512 sc1
    buffer_load_dword v39, v13, s[4:7], s25 offen offset:768 sc1
    buffer_load_dword v40, v13, s[4:7], s25 offen offset:1024 sc1
    buffer_load_dword v41, v13, s[4:7], s25 offen offset:1280 sc1
    buffer_load_dword v42, v13, s[4:7], s25 offen offset:1536 sc1
    buffer_load_dword v43, v13, s[4:7], s25 offen offset:1792 sc1
    s_waitcnt vmcnt(4)
    v_mfma_f32_16x16x32_bf16 v[52:55], v[36:39], v[24:27], 0
    v_bitop3_b32 v3, s42, v36, v37 bitop3:0x7e
    v_bitop3_b32 v4, s42, v38, v39 bitop3:0x7e
    s_waitcnt vmcnt(2)
    v_or_b32 v3, v3, v4
    v_bitop3_b32 v4, s42, v40, v41 bitop3:0x7e
    s_waitcnt vmcnt(0)
    v_mfma_f32_16x16x32_bf16 v[52:55], v[40:43], v[24:27], v[52:55]
    v_bitop3_b32 v56, s42, v42, v43 bitop3:0x7e
    v_or3_b32 v3, v3, v4, v56
    v_and_b32 v3, v0, v3
    v_cmp_ne_u32 vcc, 0, v3
    s_nop 3
    v_cvt_pk_bf16_f32 v56, v52, v53
    v_cvt_pk_bf16_f32 v57, v54, v55
    v_min_u32 v56, -2, v56
    s_cbranch_vccnz mega_kernel_rs_w2_pc
    s_mov_b64 exec, s[26:27]
    buffer_store_dwordx2 v[56:57], v9, s[4:7], s35 offen offset:512 sc1
    buffer_store_dwordx2 v[58:59], v9, s[4:7], s36 offen offset:512 sc1
    s_mov_b64 exec, -1
    s_xor_b32 s42, s42, 1
    s_branch mega_kernel_rs_w2_loop
mega_kernel_rs_w2_last:
    buffer_store_dwordx4 v[64:67], v10, s[4:7], s45 offen offset:128 sc1
    buffer_store_dwordx2 v[18:19], v11, s[4:7], s51 offen offset:3072 sc1
    s_branch mega_kernel_rs_end
mega_kernel_rs_w2_pafail:
    s_nop 7
    v_mov_b32 v96, 0
    v_mov_b32 v97, 0
    v_mov_b32 v98, 0
    v_mov_b32 v99, 0
    v_mov_b32 v100, 0
    v_mov_b32 v101, 0
    v_mov_b32 v102, 0
    v_mov_b32 v103, 0
    v_mov_b32 v104, 0
    v_mov_b32 v105, 0
    v_mov_b32 v106, 0
    v_mov_b32 v107, 0
    s_branch mega_kernel_rs_w2_pa
mega_kernel_rs_w2_xslow:
    buffer_load_dwordx2 v[108:109], v11, s[4:7], s38 offen sc1
    buffer_load_dwordx2 v[110:111], v11, s[4:7], s38 offen offset:512 sc1
    s_waitcnt vmcnt(2)
    v_bitop3_b32 v3, s41, v20, v22 bitop3:0x7e
    v_mfma_f32_16x16x16_bf16 v[80:83], v[20:21], v[16:17], v[100:103]
    v_and_b32 v3, 1, v3
    v_mfma_f32_16x16x16_bf16 v[84:87], v[22:23], v[16:17], v[104:107]
    v_cmp_ne_u32 vcc, 0, v3
    s_cbranch_vccz mega_kernel_rs_w2_xgot
    buffer_load_dwordx2 v[20:21], v11, s[4:7], s38 offen sc1
    buffer_load_dwordx2 v[22:23], v11, s[4:7], s38 offen offset:512 sc1
    s_waitcnt vmcnt(2)
    v_bitop3_b32 v3, s41, v108, v110 bitop3:0x7e
    v_mfma_f32_16x16x16_bf16 v[80:83], v[108:109], v[16:17], v[100:103]
    v_and_b32 v3, 1, v3
    v_mfma_f32_16x16x16_bf16 v[84:87], v[110:111], v[16:17], v[104:107]
    v_cmp_ne_u32 vcc, 0, v3
    s_cbranch_vccz mega_kernel_rs_w2_xgot
    s_branch mega_kernel_rs_w2_xslow
mega_kernel_rs_w2_xgot:
    s_nop 3
    v_cvt_pk_bf16_f32 v64, v80, v81
    v_cvt_pk_bf16_f32 v65, v82, v83
    v_cvt_pk_bf16_f32 v66, v84, v85
    v_cvt_pk_bf16_f32 v67, v86, v87
    ds_write_b128 v6, v[64:67] offset:18432
    s_branch mega_kernel_rs_w2_xok
mega_kernel_rs_w2_pv0:
    s_waitcnt vmcnt(2)
    s_branch mega_kernel_rs_w2_pv1
mega_kernel_rs_w2_pv:
    buffer_load_dwordx2 v[20:21], v11, s[4:7], s40 offen sc1
    s_waitcnt vmcnt(0)
mega_kernel_rs_w2_pv1:
    v_and_b32 v3, 1, v20
    v_cmp_ne_u32 vcc, s41, v3
    v_mov_b32 v113, v20
    v_mov_b32 v115, v21
    s_cbranch_vccnz mega_kernel_rs_w2_pv
    s_branch mega_kernel_rs_w2_pv2
mega_kernel_rs_w3_entry:
    v_mfma_f32_32x32x8_bf16 v[96:111], v[14:15], v[14:15], 0
    v_mfma_f32_16x16x16_bf16 v[112:115], v[14:15], v[14:15], 0
    v_mfma_f32_16x16x16_bf16 v[116:119], v[14:15], v[14:15], 0
    ds_read_b128 v[64:67], v1 offset:12288
    ds_read_b128 v[68:71], v1 offset:13312
    ds_read_b128 v[72:75], v1 offset:14336
    ds_read_b128 v[76:79], v1 offset:15360
    ds_read_b128 v[80:83], v1 offset:28672
    ds_read_b128 v[84:87], v1 offset:29696
    ds_read_b128 v[88:91], v1 offset:30720
    ds_read_b128 v[92:95], v1 offset:31744
    buffer_load_dwordx4 v[120:123], v1, s[4:7], s44 offen
    buffer_load_dwordx4 v[124:127], v1, s[4:7], s44 offen offset:1024
    s_add_u32 s44, s44, 262144
mega_kernel_rs_w3_loop:
    s_add_u32 s22, s35, 6144
    s_waitcnt vmcnt(0)
    buffer_load_dwordx4 v[56:59], v1, s[4:7], s22 offen sc1
    buffer_load_dwordx4 v[60:63], v1, s[4:7], s22 offen offset:1024 sc1
mega_kernel_rs_w3_pa:
    s_waitcnt vmcnt(1)
    ds_write_b128 v6, v[56:59] offset:6144
    s_waitcnt vmcnt(0)
    ds_write_b128 v6, v[60:63] offset:7168
    v_max3_u32 v3, v56, v58, v60
    v_max_u32 v3, v3, v62
    v_cmp_eq_u32 vcc, -1, v3
    v_smfmac_f32_16x16x64_bf16 v[96:99], v[56:59], a[96:103], v2
    buffer_load_dwordx4 v[56:59], v1, s[4:7], s22 offen sc1
    v_smfmac_f32_16x16x64_bf16 v[100:103], v[56:59], a[104:111], v2
    buffer_load_dwordx4 v[60:63], v1, s[4:7], s22 offen offset:1024 sc1
    v_smfmac_f32_16x16x64_bf16 v[104:107], v[56:59], a[224:231], v2
    s_cbranch_vccnz mega_kernel_rs_w3_pafail
    s_waitcnt lgkmcnt(0)
    s_barrier
    ds_read_b128 v[32:35], v6 offset:0
    ds_read_b128 v[36:39], v6 offset:1024
    v_smfmac_f32_16x16x64_bf16 v[108:111], v[56:59], a[232:239], v2
    ds_read_b128 v[40:43], v6 offset:2048
    v_smfmac_f32_16x16x64_bf16 v[96:99], v[60:63], a[112:119], v2
    ds_read_b128 v[44:47], v6 offset:3072
    v_smfmac_f32_16x16x64_bf16 v[100:103], v[60:63], a[120:127], v2
    ds_read_b128 v[48:51], v6 offset:4096
    v_smfmac_f32_16x16x64_bf16 v[104:107], v[60:63], a[240:247], v2
    ds_read_b128 v[52:55], v6 offset:5120
    v_smfmac_f32_16x16x64_bf16 v[108:111], v[60:63], a[248:255], v2
    s_waitcnt lgkmcnt(5)
    v_smfmac_f32_16x16x64_bf16 v[96:99], v[32:35], a[0:7], v2
    v_smfmac_f32_16x16x64_bf16 v[104:107], v[32:35], a[128:135], v2
    s_waitcnt lgkmcnt(4)
    v_smfmac_f32_16x16x64_bf16 v[96:99], v[36:39], a[16:23], v2
    buffer_load_dwordx4 v1, s[4:7], s43 offen lds
    v_smfmac_f32_16x16x64_bf16 v[104:107], v[36:39], a[144:151], v2
    s_waitcnt lgkmcnt(3)
    v_smfmac_f32_16x16x64_bf16 v[96:99], v[40:43], a[32:39], v2
    v_smfmac_f32_16x16x64_bf16 v[104:107], v[40:43], a[160:167], v2
    s_waitcnt lgkmcnt(2)
    v_smfmac_f32_16x16x64_bf16 v[96:99], v[44:47], a[48:55], v2
    buffer_load_dwordx4 v1, s[4:7], s43 offen offset:1024 lds
    v_smfmac_f32_16x16x64_bf16 v[104:107], v[44:47], a[176:183], v2
    s_waitcnt lgkmcnt(1)
    v_smfmac_f32_16x16x64_bf16 v[96:99], v[48:51], a[64:71], v2
    v_smfmac_f32_16x16x64_bf16 v[104:107], v[48:51], a[192:199], v2
    s_waitcnt lgkmcnt(0)
    v_smfmac_f32_16x16x64_bf16 v[96:99], v[52:55], a[80:87], v2
    buffer_load_dword v12, v7, s[4:7], 0 offen sc1
    v_smfmac_f32_16x16x64_bf16 v[104:107], v[52:55], a[208:215], v2
    v_smfmac_f32_16x16x64_bf16 v[100:103], v[32:35], a[8:15], v2
    s_nop 2
    v_smfmac_f32_16x16x64_bf16 v[100:103], v[36:39], a[24:31], v2
    s_nop 1
    v_add_f32 v96, v96, v98
    v_smfmac_f32_16x16x64_bf16 v[100:103], v[40:43], a[40:47], v2
    v_add_f32 v97, v97, v99
    v_add_f32 v104, v104, v106
    v_smfmac_f32_16x16x64_bf16 v[100:103], v[44:47], a[56:63], v2
    v_add_f32 v105, v105, v107
    v_cvt_pk_bf16_f32 v96, v96, v97
    v_smfmac_f32_16x16x64_bf16 v[100:103], v[48:51], a[72:79], v2
    v_cvt_pk_bf16_f32 v97, v104, v105
    v_and_or_b32 v96, v96, -2, s41
    v_smfmac_f32_16x16x64_bf16 v[100:103], v[52:55], a[88:95], v2
    buffer_store_dwordx2 v[96:97], v11, s[4:7], s37 offen sc1
    v_smfmac_f32_16x16x64_bf16 v[108:111], v[32:35], a[136:143], v2
    v_smfmac_f32_16x16x64_bf16 v[108:111], v[36:39], a[152:159], v2
    v_smfmac_f32_16x16x64_bf16 v[108:111], v[40:43], a[168:175], v2
    v_smfmac_f32_16x16x64_bf16 v[108:111], v[44:47], a[184:191], v2
    v_smfmac_f32_16x16x64_bf16 v[108:111], v[48:51], a[200:207], v2
    s_nop 2
    v_add_f32 v100, v100, v102
    v_smfmac_f32_16x16x64_bf16 v[108:111], v[52:55], a[216:223], v2
    v_add_f32 v101, v101, v103
    v_cvt_pk_bf16_f32 v98, v100, v101
    v_and_or_b32 v98, v98, -2, s41
    s_nop 4
    v_pk_add_f32 v[108:109], v[108:109], v[110:111]
    v_cvt_pk_bf16_f32 v99, v108, v109
    buffer_store_dwordx2 v[98:99], v11, s[4:7], s37 offen offset:512 sc1
    v_smfmac_f32_16x16x64_bf16 v[112:115], v[32:35], v[64:71], v2
    ds_read_b128 v[64:67], v1 offset:45056
    ds_read_b128 v[68:71], v1 offset:46080
    v_smfmac_f32_16x16x64_bf16 v[116:119], v[32:35], v[72:79], v2
    ds_read_b128 v[72:75], v1 offset:47104
    ds_read_b128 v[76:79], v1 offset:48128
    v_smfmac_f32_16x16x64_bf16 v[112:115], v[36:39], v[80:87], v2
    ds_read_b128 v[80:83], v1 offset:61440
    ds_read_b128 v[84:87], v1 offset:62464
    v_smfmac_f32_16x16x64_bf16 v[116:119], v[36:39], v[88:95], v2
    ds_read_b128 v[88:91], v1 offset:63488
    ds_read_b128 v[92:95], v1 offset:64512
    s_waitcnt lgkmcnt(6)
    v_smfmac_f32_16x16x64_bf16 v[112:115], v[40:43], v[64:71], v2
    ds_read_b128 v[64:67], v5 offset:12288
    ds_read_b128 v[68:71], v5 offset:13312
    s_waitcnt lgkmcnt(6)
    v_smfmac_f32_16x16x64_bf16 v[116:119], v[40:43], v[72:79], v2
    ds_read_b128 v[72:75], v5 offset:14336
    ds_read_b128 v[76:79], v5 offset:15360
    s_waitcnt lgkmcnt(6)
    v_smfmac_f32_16x16x64_bf16 v[112:115], v[44:47], v[80:87], v2
    ds_read_b128 v[80:83], v5 offset:28672
    ds_read_b128 v[84:87], v5 offset:29696
    s_waitcnt lgkmcnt(6)
    v_smfmac_f32_16x16x64_bf16 v[116:119], v[44:47], v[88:95], v2
    ds_read_b128 v[88:91], v5 offset:30720
    ds_read_b128 v[92:95], v5 offset:31744
    s_waitcnt lgkmcnt(6)
    v_smfmac_f32_16x16x64_bf16 v[112:115], v[48:51], v[64:71], v2
    ds_read_b128 v[64:67], v5 offset:45056
    ds_read_b128 v[68:71], v5 offset:46080
    s_waitcnt lgkmcnt(6)
    v_smfmac_f32_16x16x64_bf16 v[116:119], v[48:51], v[72:79], v2
    ds_read_b128 v[72:75], v5 offset:47104
    ds_read_b128 v[76:79], v5 offset:48128
    s_waitcnt lgkmcnt(6)
    v_smfmac_f32_16x16x64_bf16 v[112:115], v[52:55], v[80:87], v2
    ds_read_b128 v[80:83], v5 offset:61440
    ds_read_b128 v[84:87], v5 offset:62464
    s_waitcnt lgkmcnt(6)
    v_smfmac_f32_16x16x64_bf16 v[116:119], v[52:55], v[88:95], v2
    ds_read_b128 v[88:91], v5 offset:63488
    ds_read_b128 v[92:95], v5 offset:64512
    s_waitcnt lgkmcnt(6)
    v_smfmac_f32_16x16x64_bf16 v[112:115], v[56:59], v[64:71], v2
    s_waitcnt lgkmcnt(4)
    v_smfmac_f32_16x16x64_bf16 v[116:119], v[56:59], v[72:79], v2
    s_waitcnt lgkmcnt(2)
    v_smfmac_f32_16x16x64_bf16 v[112:115], v[60:63], v[80:87], v2
    s_waitcnt lgkmcnt(0)
    v_smfmac_f32_16x16x64_bf16 v[116:119], v[60:63], v[88:95], v2
    buffer_load_dwordx2 v[108:109], v11, s[4:7], s38 offen sc1
    v_mfma_f32_16x16x16_bf16 v[100:103], v[96:97], v[16:17], 0
    v_mfma_f32_16x16x16_bf16 v[104:107], v[98:99], v[16:17], 0
    s_nop 4
    v_add_f32 v112, v112, v114
    v_add_f32 v113, v113, v115
    v_add_f32 v114, v116, v118
    v_add_f32 v115, v117, v119
    v_cvt_pk_bf16_f32 v18, v112, v113
    v_cvt_pk_bf16_f32 v19, v114, v115
    v_and_or_b32 v18, v18, -2, s41
    buffer_load_dwordx2 v[110:111], v11, s[4:7], s38 offen offset:512 sc1
    s_barrier
    buffer_store_dwordx2 v[18:19], v11, s[4:7], s39 offen sc1
    v_mov_b32 v112, v18
    v_mov_b32 v114, v19
    v_mov_b32 v92, v28
    v_mov_b32 v93, 0
    s_waitcnt vmcnt(6)
    s_barrier
    ds_read_b128 v[32:35], v6 offset:24576
    ds_read_b128 v[36:39], v6 offset:25600
    ds_read_b128 v[40:43], v6 offset:19456
    ds_read_b128 v[44:47], v6 offset:20480
    ds_read_b128 v[48:51], v6 offset:14336
    ds_read_b128 v[52:55], v6 offset:15360
    ds_read_b128 v[56:59], v6 offset:9216
    ds_read_b128 v[60:63], v6 offset:10240
    buffer_load_dwordx2 v[20:21], v11, s[4:7], s38 offen sc1
    buffer_load_dwordx2 v[22:23], v11, s[4:7], s38 offen offset:512 sc1
    s_waitcnt vmcnt(4)
    v_mfma_f32_16x16x16_bf16 v[80:83], v[108:109], v[16:17], v[100:103]
    v_and_b32 v3, 1, v108
    v_cmp_ne_u32 vcc, s41, v3
    s_nop 5
    v_cvt_pk_bf16_f32 v64, v80, v81
    v_cvt_pk_bf16_f32 v65, v82, v83
    s_cbranch_vccnz mega_kernel_rs_w3_xslow
    s_waitcnt vmcnt(3)
    v_mfma_f32_16x16x16_bf16 v[84:87], v[110:111], v[16:17], v[104:107]
    v_and_b32 v3, 1, v110
    v_cmp_ne_u32 vcc, s41, v3
    s_nop 5
    v_cvt_pk_bf16_f32 v66, v84, v85
    v_cvt_pk_bf16_f32 v67, v86, v87
    ds_write_b128 v6, v[64:67] offset:23552
    s_cbranch_vccnz mega_kernel_rs_w3_xslow
mega_kernel_rs_w3_xok:
    s_cmp_eq_u32 s21, 63
    s_cbranch_scc1 mega_kernel_rs_w3_last
    buffer_load_dwordx2 v[116:117], v11, s[4:7], s40 offen sc1
    s_waitcnt lgkmcnt(1)
    v_mfma_f32_16x16x32_bf16 v[80:83], v[32:35], v[64:67], 0
    s_waitcnt lgkmcnt(0)
    s_barrier
    ds_read_b128 v[68:71], v6 offset:18432
    ds_read_b128 v[72:75], v6 offset:13312
    ds_read_b128 v[76:79], v6 offset:8192
    v_mfma_f32_16x16x32_bf16 v[84:87], v[36:39], v[64:67], 0
    v_mfma_f32_16x16x32_bf16 v[88:91], v[64:67], v[64:67], 0
    buffer_load_dwordx2 v[20:21], v11, s[4:7], s40 offen sc1
    s_waitcnt lgkmcnt(2)
    v_mfma_f32_16x16x32_bf16 v[80:83], v[40:43], v[68:71], v[80:83]
    s_waitcnt lgkmcnt(1)
    v_mfma_f32_16x16x32_bf16 v[80:83], v[48:51], v[72:75], v[80:83]
    s_waitcnt lgkmcnt(0)
    v_mfma_f32_16x16x32_bf16 v[80:83], v[56:59], v[76:79], v[80:83]
    v_mfma_f32_16x16x32_bf16 v[84:87], v[44:47], v[68:71], v[84:87]
    buffer_store_dwordx4 v[64:67], v10, s[4:7], s45 offen offset:192 sc1
    v_mfma_f32_16x16x32_bf16 v[84:87], v[52:55], v[72:75], v[84:87]
    v_mfma_f32_16x16x32_bf16 v[84:87], v[60:63], v[76:79], v[84:87]
    v_mfma_f32_16x16x32_bf16 v[88:91], v[68:71], v[68:71], v[88:91]
    v_mfma_f32_16x16x32_bf16 v[88:91], v[72:75], v[72:75], v[88:91]
    buffer_store_dwordx2 v[18:19], v11, s[4:7], s51 offen offset:3584 sc1
    v_mfma_f32_16x16x32_bf16 v[88:91], v[76:79], v[76:79], v[88:91]
    v_mfma_f32_32x32x4_2b_bf16 v[32:63], v[14:15], v[14:15], 0
    s_nop 0
    v_max3_f32 v4, v80, v81, v82
    s_nop 1
    v_max3_f32 v4, v4, v83, v84
    v_max3_f32 v4, v4, v85, v86
    v_max_f32 v4, v4, v87
    v_max3_f32 v90, v4, v88, v89
    v_max3_f32 v4, v4, v88, v89
    s_nop 1
    v_permlane16_swap_b32 v4, v90
    v_max_f32 v4, v4, v90
    v_max_f32 v90, v4, v90
    s_nop 1
    v_permlane32_swap_b32 v4, v90
    v_max_f32 v4, v4, v90
    v_mul_f32 v4, s34, v4
    v_pk_fma_f32 v[80:81], v[80:81], s[34:35], v[4:5] op_sel_hi:[1,0,0] neg_lo:[0,0,1] neg_hi:[0,0,1]
    v_pk_fma_f32 v[82:83], v[82:83], s[34:35], v[4:5] op_sel_hi:[1,0,0] neg_lo:[0,0,1] neg_hi:[0,0,1]
    v_pk_fma_f32 v[84:85], v[84:85], s[34:35], v[4:5] op_sel_hi:[1,0,0] neg_lo:[0,0,1] neg_hi:[0,0,1]
    v_pk_fma_f32 v[86:87], v[86:87], s[34:35], v[4:5] op_sel_hi:[1,0,0] neg_lo:[0,0,1] neg_hi:[0,0,1]
    v_pk_fma_f32 v[88:89], v[88:89], s[34:35], v[4:5] op_sel_hi:[1,0,0] neg_lo:[0,0,1] neg_hi:[0,0,1]
    v_exp_f32 v80, v80
    v_exp_f32 v81, v81
    v_exp_f32 v82, v82
    v_cvt_pk_bf16_f32 v68, v80, v81
    v_exp_f32 v83, v83
    v_exp_f32 v84, v84
    v_cvt_pk_bf16_f32 v69, v82, v83
    v_exp_f32 v85, v85
    v_exp_f32 v86, v86
    v_cvt_pk_bf16_f32 v70, v84, v85
    v_exp_f32 v87, v87
    v_exp_f32 v88, v88
    v_cvt_pk_bf16_f32 v71, v86, v87
    v_exp_f32 v89, v89
    s_waitcnt vmcnt(3)
    v_mfma_f32_16x16x32_bf16 v[76:79], v[28:31], v[68:71], 0
    v_and_b32 v3, 1, v116
    v_cvt_pk_bf16_f32 v72, v88, v89
    v_mfma_f32_16x16x32_bf16 v[100:103], v[120:123], v[68:71], 0
    v_cmp_ne_u32 vcc, s41, v3
    v_cvt_pk_bf16_f32 v73, v88, v89
    v_mfma_f32_16x16x32_bf16 v[104:107], v[124:127], v[68:71], 0
    v_mov_b32 v113, v116
    v_mov_b32 v115, v117
    v_mfma_f32_16x16x16_bf16 v[76:79], v[92:93], v[72:73], v[76:79]
    s_cbranch_vccnz mega_kernel_rs_w3_pv0
mega_kernel_rs_w3_pv2:
    v_mfma_f32_16x16x16_bf16 v[100:103], v[112:113], v[72:73], v[100:103]
    v_mfma_f32_16x16x16_bf16 v[104:107], v[114:115], v[72:73], v[104:107]
    buffer_load_dwordx4 v[120:123], v1, s[4:7], s44 offen
    buffer_load_dwordx4 v[124:127], v1, s[4:7], s44 offen offset:1024
    s_nop 2
    v_rcp_f32 v76, v76
    s_mov_b64 exec, s[28:29]
    v_pk_mul_f32 v[100:101], v[100:101], v[76:77] op_sel_hi:[1,0]
    v_pk_mul_f32 v[102:103], v[102:103], v[76:77] op_sel_hi:[1,0]
    v_pk_mul_f32 v[104:105], v[104:105], v[76:77] op_sel_hi:[1,0]
    v_pk_mul_f32 v[106:107], v[106:107], v[76:77] op_sel_hi:[1,0]
    v_cvt_pk_bf16_f32 v84, v100, v101
    v_cvt_pk_bf16_f32 v85, v102, v103
    v_cvt_pk_bf16_f32 v86, v104, v105
    v_cvt_pk_bf16_f32 v87, v106, v107
    ds_write_b128 v6, v[84:87] offset:29696
    s_mov_b64 exec, -1
    s_waitcnt lgkmcnt(0)
    s_barrier
    ds_read_b128 v[68:71], v6 offset:28672
    ds_read_b128 v[72:75], v6 offset:29696
    s_waitcnt lgkmcnt(1)
    v_smfmac_f32_16x16x64_bf16 v[32:35], v[68:71], v[128:135], v2
    s_add_u32 s21, s21, 1
    s_xor_b32 s38, s38, 1048576
    s_xor_b32 s37, s37, 1048576
    s_waitcnt lgkmcnt(0)
    v_smfmac_f32_16x16x64_bf16 v[32:35], v[72:75], v[136:143], v2
    s_xor_b32 s40, s40, 1048576
    s_xor_b32 s39, s39, 1048576
    s_lshr_b32 s41, s21, 1
    v_smfmac_f32_16x16x64_bf16 v[36:39], v[68:71], v[144:151], v2
    s_and_b32 s41, s41, 1
    s_xor_b32 s41, s41, 1
    s_xor_b32 s35, s35, 16384
    v_smfmac_f32_16x16x64_bf16 v[36:39], v[72:75], v[152:159], v2
    v_add_f32 v32, v32, v34
    s_xor_b32 s36, s36, 16384
    s_add_u32 s43, s43, 262144
    s_add_u32 s44, s44, 262144
    v_smfmac_f32_16x16x64_bf16 v[40:43], v[68:71], v[160:167], v2
    v_add_f32 v33, v33, v35
    v_smfmac_f32_16x16x64_bf16 v[40:43], v[72:75], v[168:175], v2
    v_cvt_pk_bf16_f32 v32, v32, v33
    v_smfmac_f32_16x16x64_bf16 v[44:47], v[68:71], v[176:183], v2
    v_and_or_b32 v32, v32, -2, s42
    v_smfmac_f32_16x16x64_bf16 v[44:47], v[72:75], v[184:191], v2
    v_add_f32 v36, v36, v38
    v_smfmac_f32_16x16x64_bf16 v[48:51], v[68:71], v[192:199], v2
    v_add_f32 v37, v37, v39
    v_smfmac_f32_16x16x64_bf16 v[48:51], v[72:75], v[200:207], v2
    v_cvt_pk_bf16_f32 v33, v36, v37
    v_smfmac_f32_16x16x64_bf16 v[52:55], v[68:71], v[208:215], v2
    v_add_f32 v40, v40, v42
    v_smfmac_f32_16x16x64_bf16 v[52:55], v[72:75], v[216:223], v2
    v_add_f32 v41, v41, v43
    v_smfmac_f32_16x16x64_bf16 v[56:59], v[68:71], v[224:231], v2
    v_cvt_pk_bf16_f32 v34, v40, v41
    v_smfmac_f32_16x16x64_bf16 v[56:59], v[72:75], v[232:239], v2
    v_add_f32 v44, v44, v46
    v_smfmac_f32_16x16x64_bf16 v[60:63], v[68:71], v[240:247], v2
    v_add_f32 v45, v45, v47
    v_smfmac_f32_16x16x64_bf16 v[60:63], v[72:75], v[248:255], v2
    v_cvt_pk_bf16_f32 v35, v44, v45
    buffer_store_dwordx4 v[32:35], v8, s[4:7], s46 offen sc1
    v_pk_add_f32 v[48:49], v[48:49], v[50:51]
    v_cvt_pk_bf16_f32 v48, v48, v49
    v_and_or_b32 v48, v48, -2, s42
    v_pk_add_f32 v[52:53], v[52:53], v[54:55]
    v_cvt_pk_bf16_f32 v49, v52, v53
    v_pk_add_f32 v[56:57], v[56:57], v[58:59]
    v_cvt_pk_bf16_f32 v50, v56, v57
    v_pk_add_f32 v[60:61], v[60:61], v[62:63]
    v_cvt_pk_bf16_f32 v51, v60, v61
    buffer_store_dwordx4 v[48:51], v8, s[4:7], s61 offen sc1
    s_add_u32 s45, s45, 262144
    s_add_u32 s51, s51, 262144
    v_mfma_f32_32x32x8_bf16 v[96:111], v[14:15], v[14:15], 0
    v_mfma_f32_16x16x16_bf16 v[112:115], v[14:15], v[14:15], 0
    v_mfma_f32_16x16x16_bf16 v[116:119], v[14:15], v[14:15], 0
    ds_read_b128 v[64:67], v1 offset:12288
    ds_read_b128 v[68:71], v1 offset:13312
    ds_read_b128 v[72:75], v1 offset:14336
    ds_read_b128 v[76:79], v1 offset:15360
    ds_read_b128 v[80:83], v1 offset:28672
    ds_read_b128 v[84:87], v1 offset:29696
    ds_read_b128 v[88:91], v1 offset:30720
    ds_read_b128 v[92:95], v1 offset:31744
    s_add_u32 s22, s21, 2
    s_cmp_gt_u32 s50, s22
    s_cbranch_scc1 mega_kernel_rs_w3_kvs
    v_readlane_b32 s50, v12, 0
    v_readlane_b32 s22, v12, 2
    v_readlane_b32 s23, v12, 1
    v_readlane_b32 s24, v12, 3
    s_nop 3
    s_min_u32 s50, s50, s22
    s_min_u32 s23, s23, s24
    s_lshl_b32 s50, s50, 1
    s_lshl_b32 s23, s23, 1
    s_add_u32 s23, s23, 1
    s_min_u32 s50, s50, s23
mega_kernel_rs_kvb1:
    s_add_u32 s22, s21, 1
    s_min_u32 s22, s22, 63
    s_cmp_gt_u32 s50, s22
    s_cbranch_scc1 mega_kernel_rs_kvd1
    buffer_load_dword v12, v7, s[4:7], 0 offen sc1
    s_waitcnt vmcnt(0)
    v_readlane_b32 s50, v12, 0
    v_readlane_b32 s22, v12, 2
    v_readlane_b32 s23, v12, 1
    v_readlane_b32 s24, v12, 3
    s_nop 3
    s_min_u32 s50, s50, s22
    s_min_u32 s23, s23, s24
    s_lshl_b32 s50, s50, 1
    s_lshl_b32 s23, s23, 1
    s_add_u32 s23, s23, 1
    s_min_u32 s50, s50, s23
    s_branch mega_kernel_rs_kvb1
mega_kernel_rs_kvd1:
mega_kernel_rs_w3_kvs:
    v_mov_b32 v58, -1
    v_mov_b32 v59, -1
    s_waitcnt vmcnt(0)
mega_kernel_rs_w3_cgo:
mega_kernel_rs_w3_pc:
    buffer_load_dword v36, v13, s[4:7], s25 offen offset:0 sc1
    buffer_load_dword v37, v13, s[4:7], s25 offen offset:256 sc1
    buffer_load_dword v38, v13, s[4:7], s25 offen offset:512 sc1
    buffer_load_dword v39, v13, s[4:7], s25 offen offset:768 sc1
    buffer_load_dword v40, v13, s[4:7], s25 offen offset:1024 sc1
    buffer_load_dword v41, v13, s[4:7], s25 offen offset:1280 sc1
    buffer_load_dword v42, v13, s[4:7], s25 offen offset:1536 sc1
    buffer_load_dword v43, v13, s[4:7], s25 offen offset:1792 sc1
    s_waitcnt vmcnt(4)
    v_mfma_f32_16x16x32_bf16 v[52:55], v[36:39], v[24:27], 0
    v_bitop3_b32 v3, s42, v36, v37 bitop3:0x7e
    v_bitop3_b32 v4, s42, v38, v39 bitop3:0x7e
    s_waitcnt vmcnt(2)
    v_or_b32 v3, v3, v4
    v_bitop3_b32 v4, s42, v40, v41 bitop3:0x7e
    s_waitcnt vmcnt(0)
    v_mfma_f32_16x16x32_bf16 v[52:55], v[40:43], v[24:27], v[52:55]
    v_bitop3_b32 v56, s42, v42, v43 bitop3:0x7e
    v_or3_b32 v3, v3, v4, v56
    v_and_b32 v3, v0, v3
    v_cmp_ne_u32 vcc, 0, v3
    s_nop 3
    v_cvt_pk_bf16_f32 v56, v52, v53
    v_cvt_pk_bf16_f32 v57, v54, v55
    v_min_u32 v56, -2, v56
    s_cbranch_vccnz mega_kernel_rs_w3_pc
    s_mov_b64 exec, s[26:27]
    buffer_store_dwordx2 v[56:57], v9, s[4:7], s35 offen offset:768 sc1
    buffer_store_dwordx2 v[58:59], v9, s[4:7], s36 offen offset:768 sc1
    s_mov_b64 exec, -1
    s_xor_b32 s42, s42, 1
    s_branch mega_kernel_rs_w3_loop
mega_kernel_rs_w3_last:
    buffer_store_dwordx4 v[64:67], v10, s[4:7], s45 offen offset:192 sc1
    buffer_store_dwordx2 v[18:19], v11, s[4:7], s51 offen offset:3584 sc1
    s_branch mega_kernel_rs_end
mega_kernel_rs_w3_pafail:
    s_nop 7
    v_mov_b32 v96, 0
    v_mov_b32 v97, 0
    v_mov_b32 v98, 0
    v_mov_b32 v99, 0
    v_mov_b32 v100, 0
    v_mov_b32 v101, 0
    v_mov_b32 v102, 0
    v_mov_b32 v103, 0
    v_mov_b32 v104, 0
    v_mov_b32 v105, 0
    v_mov_b32 v106, 0
    v_mov_b32 v107, 0
    s_branch mega_kernel_rs_w3_pa
mega_kernel_rs_w3_xslow:
    buffer_load_dwordx2 v[108:109], v11, s[4:7], s38 offen sc1
    buffer_load_dwordx2 v[110:111], v11, s[4:7], s38 offen offset:512 sc1
    s_waitcnt vmcnt(2)
    v_bitop3_b32 v3, s41, v20, v22 bitop3:0x7e
    v_mfma_f32_16x16x16_bf16 v[80:83], v[20:21], v[16:17], v[100:103]
    v_and_b32 v3, 1, v3
    v_mfma_f32_16x16x16_bf16 v[84:87], v[22:23], v[16:17], v[104:107]
    v_cmp_ne_u32 vcc, 0, v3
    s_cbranch_vccz mega_kernel_rs_w3_xgot
    buffer_load_dwordx2 v[20:21], v11, s[4:7], s38 offen sc1
    buffer_load_dwordx2 v[22:23], v11, s[4:7], s38 offen offset:512 sc1
    s_waitcnt vmcnt(2)
    v_bitop3_b32 v3, s41, v108, v110 bitop3:0x7e
    v_mfma_f32_16x16x16_bf16 v[80:83], v[108:109], v[16:17], v[100:103]
    v_and_b32 v3, 1, v3
    v_mfma_f32_16x16x16_bf16 v[84:87], v[110:111], v[16:17], v[104:107]
    v_cmp_ne_u32 vcc, 0, v3
    s_cbranch_vccz mega_kernel_rs_w3_xgot
    s_branch mega_kernel_rs_w3_xslow
mega_kernel_rs_w3_xgot:
    s_nop 3
    v_cvt_pk_bf16_f32 v64, v80, v81
    v_cvt_pk_bf16_f32 v65, v82, v83
    v_cvt_pk_bf16_f32 v66, v84, v85
    v_cvt_pk_bf16_f32 v67, v86, v87
    ds_write_b128 v6, v[64:67] offset:23552
    s_branch mega_kernel_rs_w3_xok
mega_kernel_rs_w3_pv0:
    s_waitcnt vmcnt(2)
    s_branch mega_kernel_rs_w3_pv1
mega_kernel_rs_w3_pv:
    buffer_load_dwordx2 v[20:21], v11, s[4:7], s40 offen sc1
    s_waitcnt vmcnt(0)
mega_kernel_rs_w3_pv1:
    v_and_b32 v3, 1, v20
    v_cmp_ne_u32 vcc, s41, v3
    v_mov_b32 v113, v20
    v_mov_b32 v115, v21
    s_cbranch_vccnz mega_kernel_rs_w3_pv
    s_branch mega_kernel_rs_w3_pv2
mega_kernel_rs_end:
    s_mov_b64 exec, -1
    v_mov_b32 v3, 64
    s_waitcnt vmcnt(0)
    s_barrier
    s_cmp_lg_u32 s20, 0
    s_cbranch_scc1 mega_kernel_rs_end2
    buffer_store_dword v3, v7, s[4:7], 0 offen sc1
mega_kernel_rs_end2:
    s_waitcnt vmcnt(0)
    s_endpgm
mega_kernel_bulk:
    s_load_dwordx2 s[8:9], s[0:1], 0
    s_load_dwordx2 s[40:41], s[0:1], 16
    s_load_dwordx2 s[42:43], s[0:1], 24
    s_load_dwordx2 s[44:45], s[0:1], 32
    v_lshrrev_b32 v2, 6, v0
    v_and_b32 v1, 63, v0
    v_readfirstlane_b32 s16, v2
    s_lshr_b32 s17, s92, 6
    s_bfe_u32 s18, s92, 0x50001
    s_and_b32 s19, s92, 1
    s_waitcnt lgkmcnt(0)
    s_mov_b32 s10, 4194304
    s_mov_b32 s11, 0x00020000
    s_cmp_eq_u32 s17, 1
    s_cselect_b32 s12, s42, s40
    s_cselect_b32 s13, s43, s41
    s_cmp_eq_u32 s17, 2
    s_cselect_b32 s12, s44, s12
    s_cselect_b32 s13, s45, s13
    s_mov_b32 s14, 8388608
    s_mov_b32 s15, 0x00020000
    v_lshrrev_b32 v2, 4, v1
    v_and_b32 v3, 15, v1
    v_lshlrev_b32 v4, 2, v2
    v_xor_b32 v4, v4, v3
    v_lshlrev_b32 v4, 4, v4
    s_lshl_b32 s20, s16, 5
    v_add_u32 v11, s20, v2
    v_lshl_add_u32 v11, v11, 13, v4
    s_lshl_b32 s20, s18, 8
    v_add_u32 v11, s20, v11
    s_lshl_b32 s22, s16, 13
    s_lshl_b32 s27, s19, 23
    s_and_b32 s27, s27, 4194304
    s_add_u32 m0, s22, 0
    s_xor_b32 s20, s27, 0
    buffer_load_dwordx4 v11, s[12:15], s20 offen lds
    s_add_u32 m0, s22, 1024
    s_xor_b32 s20, s27, 32768
    buffer_load_dwordx4 v11, s[12:15], s20 offen lds
    s_add_u32 m0, s22, 2048
    s_xor_b32 s20, s27, 65536
    buffer_load_dwordx4 v11, s[12:15], s20 offen lds
    s_add_u32 m0, s22, 3072
    s_xor_b32 s20, s27, 98304
    buffer_load_dwordx4 v11, s[12:15], s20 offen lds
    s_add_u32 m0, s22, 4096
    s_xor_b32 s20, s27, 131072
    buffer_load_dwordx4 v11, s[12:15], s20 offen lds
    s_add_u32 m0, s22, 5120
    s_xor_b32 s20, s27, 163840
    buffer_load_dwordx4 v11, s[12:15], s20 offen lds
    s_add_u32 m0, s22, 6144
    s_xor_b32 s20, s27, 196608
    buffer_load_dwordx4 v11, s[12:15], s20 offen lds
    s_add_u32 m0, s22, 7168
    s_xor_b32 s20, s27, 229376
    buffer_load_dwordx4 v11, s[12:15], s20 offen lds
    s_waitcnt vmcnt(8)
    s_barrier
    s_or_b32 s81, s97, s98
    s_cmp_lg_u32 s81, 0
    s_cbranch_scc1 mega_kernel_h0_3
    s_lshl_b32 s81, s93, 5
    v_mov_b32 v38, 1
    s_mov_b64 exec, 1
    buffer_atomic_add v38, off, s[88:91], s81 sc1
    s_mov_b64 exec, -1
mega_kernel_h0_3:
    s_add_u32 m0, s22, 32768
    s_xor_b32 s20, s27, 1048576
    buffer_load_dwordx4 v11, s[12:15], s20 offen lds
    s_add_u32 m0, s22, 33792
    s_xor_b32 s20, s27, 1081344
    buffer_load_dwordx4 v11, s[12:15], s20 offen lds
    s_add_u32 m0, s22, 34816
    s_xor_b32 s20, s27, 1114112
    buffer_load_dwordx4 v11, s[12:15], s20 offen lds
    s_add_u32 m0, s22, 35840
    s_xor_b32 s20, s27, 1146880
    buffer_load_dwordx4 v11, s[12:15], s20 offen lds
    s_add_u32 m0, s22, 36864
    s_xor_b32 s20, s27, 1179648
    buffer_load_dwordx4 v11, s[12:15], s20 offen lds
    s_add_u32 m0, s22, 37888
    s_xor_b32 s20, s27, 1212416
    buffer_load_dwordx4 v11, s[12:15], s20 offen lds
    s_add_u32 m0, s22, 38912
    s_xor_b32 s20, s27, 1245184
    buffer_load_dwordx4 v11, s[12:15], s20 offen lds
    s_add_u32 m0, s22, 39936
    s_xor_b32 s20, s27, 1277952
    buffer_load_dwordx4 v11, s[12:15], s20 offen lds
    s_add_u32 m0, s22, 65536
    s_xor_b32 s20, s27, 2097152
    buffer_load_dwordx4 v11, s[12:15], s20 offen lds
    s_add_u32 m0, s22, 66560
    s_xor_b32 s20, s27, 2129920
    buffer_load_dwordx4 v11, s[12:15], s20 offen lds
    s_add_u32 m0, s22, 67584
    s_xor_b32 s20, s27, 2162688
    buffer_load_dwordx4 v11, s[12:15], s20 offen lds
    s_add_u32 m0, s22, 68608
    s_xor_b32 s20, s27, 2195456
    buffer_load_dwordx4 v11, s[12:15], s20 offen lds
    s_add_u32 m0, s22, 69632
    s_xor_b32 s20, s27, 2228224
    buffer_load_dwordx4 v11, s[12:15], s20 offen lds
    s_add_u32 m0, s22, 70656
    s_xor_b32 s20, s27, 2260992
    buffer_load_dwordx4 v11, s[12:15], s20 offen lds
    s_add_u32 m0, s22, 71680
    s_xor_b32 s20, s27, 2293760
    buffer_load_dwordx4 v11, s[12:15], s20 offen lds
    s_add_u32 m0, s22, 72704
    s_xor_b32 s20, s27, 2326528
    buffer_load_dwordx4 v11, s[12:15], s20 offen lds
    s_add_u32 m0, s22, 98304
    s_xor_b32 s20, s27, 3145728
    buffer_load_dwordx4 v11, s[12:15], s20 offen lds
    s_add_u32 m0, s22, 99328
    s_xor_b32 s20, s27, 3178496
    buffer_load_dwordx4 v11, s[12:15], s20 offen lds
    s_add_u32 m0, s22, 100352
    s_xor_b32 s20, s27, 3211264
    buffer_load_dwordx4 v11, s[12:15], s20 offen lds
    s_add_u32 m0, s22, 101376
    s_xor_b32 s20, s27, 3244032
    buffer_load_dwordx4 v11, s[12:15], s20 offen lds
    s_add_u32 m0, s22, 102400
    s_xor_b32 s20, s27, 3276800
    buffer_load_dwordx4 v11, s[12:15], s20 offen lds
    s_add_u32 m0, s22, 103424
    s_xor_b32 s20, s27, 3309568
    buffer_load_dwordx4 v11, s[12:15], s20 offen lds
    s_add_u32 m0, s22, 104448
    s_xor_b32 s20, s27, 3342336
    buffer_load_dwordx4 v11, s[12:15], s20 offen lds
    s_add_u32 m0, s22, 105472
    s_xor_b32 s20, s27, 3375104
    buffer_load_dwordx4 v11, s[12:15], s20 offen lds
    v_and_b32 v3, 3, v1
    v_bfe_u32 v14, v1, 2, 2
    v_xor_b32 v15, s16, v14
    v_lshlrev_b32 v15, 6, v15
    v_lshl_add_u32 v15, v3, 4, v15
    v_lshl_add_u32 v13, v2, 3, v14
    v_lshl_add_u32 v12, v13, 8, v15
    v_and_b32 v3, 15, v1
    s_lshl_b32 s20, s16, 3
    v_add_u32 v13, s20, v2
    v_add_u32 v13, 0, v13
    v_and_b32 v14, 15, v13
    v_xor_b32 v14, v14, v3
    v_lshlrev_b32 v14, 4, v14
    v_lshl_add_u32 v6, v13, 11, v14
    v_add_u32 v13, s20, v2
    v_add_u32 v13, 4, v13
    v_and_b32 v14, 15, v13
    v_xor_b32 v14, v14, v3
    v_lshlrev_b32 v14, 4, v14
    v_lshl_add_u32 v7, v13, 11, v14
    v_xor_b32 v14, v2, v3
    v_lshlrev_b32 v14, 4, v14
    v_lshl_add_u32 v13, v3, 8, v14
    v_xor_b32 v16, 0, v13
    v_add_u32 v20, 0x10000, v16
    v_xor_b32 v17, 64, v13
    v_add_u32 v21, 0x10000, v17
    v_xor_b32 v18, 128, v13
    v_add_u32 v22, 0x10000, v18
    v_xor_b32 v19, 192, v13
    v_add_u32 v23, 0x10000, v19
    v_lshlrev_b32 v8, 4, v1
    v_bfrev_b32 v13, 1
    s_lshl_b32 s20, s92, 7
    s_add_u32 s20, s20, 71303168
    v_mov_b32 v14, s20
    v_cmp_eq_u32 vcc, 0, v0
    s_lshl_b32 s24, s17, 24
    s_lshl_b32 s20, s19, 18
    v_cndmask_b32 v9, v13, v14, vcc
    s_add_u32 s24, s24, s20
    s_lshl_b32 s20, s18, 13
    s_add_u32 s24, s24, s20
    s_lshl_b32 s20, s16, 11
    s_add_u32 s24, s24, s20
    s_add_u32 s24, s24, 0
    s_lshl_b32 s23, s19, 16
    s_lshr_b32 s20, s27, 12
    s_add_u32 s23, s23, s20
    v_mov_b32 v10, 0
    s_lshl_b32 s21, s16, 11
    s_waitcnt vmcnt(24)
    s_barrier
    v_add_u32 v13, 0, v12
    ds_read_b64_tr_b16 a[0:1], v13 offset:0
    ds_read_b64_tr_b16 a[2:3], v13 offset:1024
    ds_read_b64_tr_b16 a[4:5], v13 offset:8
    ds_read_b64_tr_b16 a[6:7], v13 offset:1032
    ds_read_b64_tr_b16 a[8:9], v13 offset:8192
    ds_read_b64_tr_b16 a[10:11], v13 offset:9216
    ds_read_b64_tr_b16 a[12:13], v13 offset:8200
    ds_read_b64_tr_b16 a[14:15], v13 offset:9224
    s_waitcnt lgkmcnt(0)
    ds_read_b64_tr_b16 a[16:17], v13 offset:16384
    ds_read_b64_tr_b16 a[18:19], v13 offset:17408
    ds_read_b64_tr_b16 a[20:21], v13 offset:16392
    ds_read_b64_tr_b16 a[22:23], v13 offset:17416
    ds_read_b64_tr_b16 a[24:25], v13 offset:24576
    ds_read_b64_tr_b16 a[26:27], v13 offset:25600
    ds_read_b64_tr_b16 a[28:29], v13 offset:24584
    ds_read_b64_tr_b16 a[30:31], v13 offset:25608
    s_waitcnt lgkmcnt(0)
    s_barrier
    s_add_u32 m0, s22, 0
    s_xor_b32 s20, s27, 4194304
    buffer_load_dwordx4 v11, s[12:15], s20 offen lds
    s_add_u32 m0, s22, 1024
    s_xor_b32 s20, s27, 4227072
    buffer_load_dwordx4 v11, s[12:15], s20 offen lds
    s_add_u32 m0, s22, 2048
    s_xor_b32 s20, s27, 4259840
    buffer_load_dwordx4 v11, s[12:15], s20 offen lds
    s_add_u32 m0, s22, 3072
    s_xor_b32 s20, s27, 4292608
    buffer_load_dwordx4 v11, s[12:15], s20 offen lds
    s_add_u32 m0, s22, 4096
    s_xor_b32 s20, s27, 4325376
    buffer_load_dwordx4 v11, s[12:15], s20 offen lds
    s_add_u32 m0, s22, 5120
    s_xor_b32 s20, s27, 4358144
    buffer_load_dwordx4 v11, s[12:15], s20 offen lds
    s_add_u32 m0, s22, 6144
    s_xor_b32 s20, s27, 4390912
    buffer_load_dwordx4 v11, s[12:15], s20 offen lds
    s_add_u32 m0, s22, 7168
    s_xor_b32 s20, s27, 4423680
    buffer_load_dwordx4 v11, s[12:15], s20 offen lds
    s_waitcnt vmcnt(24)
    s_barrier
    v_add_u32 v13, 32768, v12
    ds_read_b64_tr_b16 a[32:33], v13 offset:0
    ds_read_b64_tr_b16 a[34:35], v13 offset:1024
    ds_read_b64_tr_b16 a[36:37], v13 offset:8
    ds_read_b64_tr_b16 a[38:39], v13 offset:1032
    ds_read_b64_tr_b16 a[40:41], v13 offset:8192
    ds_read_b64_tr_b16 a[42:43], v13 offset:9216
    ds_read_b64_tr_b16 a[44:45], v13 offset:8200
    ds_read_b64_tr_b16 a[46:47], v13 offset:9224
    s_waitcnt lgkmcnt(0)
    ds_read_b64_tr_b16 a[48:49], v13 offset:16384
    ds_read_b64_tr_b16 a[50:51], v13 offset:17408
    ds_read_b64_tr_b16 a[52:53], v13 offset:16392
    ds_read_b64_tr_b16 a[54:55], v13 offset:17416
    ds_read_b64_tr_b16 a[56:57], v13 offset:24576
    ds_read_b64_tr_b16 a[58:59], v13 offset:25600
    ds_read_b64_tr_b16 a[60:61], v13 offset:24584
    ds_read_b64_tr_b16 a[62:63], v13 offset:25608
    s_waitcnt lgkmcnt(0)
    s_barrier
    s_add_u32 m0, s22, 32768
    s_xor_b32 s20, s27, 5242880
    buffer_load_dwordx4 v11, s[12:15], s20 offen lds
    s_add_u32 m0, s22, 33792
    s_xor_b32 s20, s27, 5275648
    buffer_load_dwordx4 v11, s[12:15], s20 offen lds
    s_add_u32 m0, s22, 34816
    s_xor_b32 s20, s27, 5308416
    buffer_load_dwordx4 v11, s[12:15], s20 offen lds
    s_add_u32 m0, s22, 35840
    s_xor_b32 s20, s27, 5341184
    buffer_load_dwordx4 v11, s[12:15], s20 offen lds
    s_add_u32 m0, s22, 36864
    s_xor_b32 s20, s27, 5373952
    buffer_load_dwordx4 v11, s[12:15], s20 offen lds
    s_add_u32 m0, s22, 37888
    s_xor_b32 s20, s27, 5406720
    buffer_load_dwordx4 v11, s[12:15], s20 offen lds
    s_add_u32 m0, s22, 38912
    s_xor_b32 s20, s27, 5439488
    buffer_load_dwordx4 v11, s[12:15], s20 offen lds
    s_add_u32 m0, s22, 39936
    s_xor_b32 s20, s27, 5472256
    buffer_load_dwordx4 v11, s[12:15], s20 offen lds
    s_waitcnt vmcnt(24)
    s_barrier
    v_add_u32 v13, 65536, v12
    ds_read_b64_tr_b16 a[64:65], v13 offset:0
    ds_read_b64_tr_b16 a[66:67], v13 offset:1024
    ds_read_b64_tr_b16 a[68:69], v13 offset:8
    ds_read_b64_tr_b16 a[70:71], v13 offset:1032
    ds_read_b64_tr_b16 a[72:73], v13 offset:8192
    ds_read_b64_tr_b16 a[74:75], v13 offset:9216
    ds_read_b64_tr_b16 a[76:77], v13 offset:8200
    ds_read_b64_tr_b16 a[78:79], v13 offset:9224
    s_waitcnt lgkmcnt(0)
    ds_read_b64_tr_b16 a[80:81], v13 offset:16384
    ds_read_b64_tr_b16 a[82:83], v13 offset:17408
    ds_read_b64_tr_b16 a[84:85], v13 offset:16392
    ds_read_b64_tr_b16 a[86:87], v13 offset:17416
    ds_read_b64_tr_b16 a[88:89], v13 offset:24576
    ds_read_b64_tr_b16 a[90:91], v13 offset:25600
    ds_read_b64_tr_b16 a[92:93], v13 offset:24584
    ds_read_b64_tr_b16 a[94:95], v13 offset:25608
    s_waitcnt lgkmcnt(0)
    s_barrier
    s_add_u32 m0, s22, 65536
    s_xor_b32 s20, s27, 6291456
    buffer_load_dwordx4 v11, s[12:15], s20 offen lds
    s_add_u32 m0, s22, 66560
    s_xor_b32 s20, s27, 6324224
    buffer_load_dwordx4 v11, s[12:15], s20 offen lds
    s_add_u32 m0, s22, 67584
    s_xor_b32 s20, s27, 6356992
    buffer_load_dwordx4 v11, s[12:15], s20 offen lds
    s_add_u32 m0, s22, 68608
    s_xor_b32 s20, s27, 6389760
    buffer_load_dwordx4 v11, s[12:15], s20 offen lds
    s_add_u32 m0, s22, 69632
    s_xor_b32 s20, s27, 6422528
    buffer_load_dwordx4 v11, s[12:15], s20 offen lds
    s_add_u32 m0, s22, 70656
    s_xor_b32 s20, s27, 6455296
    buffer_load_dwordx4 v11, s[12:15], s20 offen lds
    s_add_u32 m0, s22, 71680
    s_xor_b32 s20, s27, 6488064
    buffer_load_dwordx4 v11, s[12:15], s20 offen lds
    s_add_u32 m0, s22, 72704
    s_xor_b32 s20, s27, 6520832
    buffer_load_dwordx4 v11, s[12:15], s20 offen lds
    s_waitcnt vmcnt(24)
    s_barrier
    v_and_b32 v37, 7, v0
    v_lshlrev_b32 v37, 5, v37
    buffer_load_dword v36, v37, s[88:91], 0 offen sc1
    v_add_u32 v13, 98304, v12
    ds_read_b64_tr_b16 a[96:97], v13 offset:0
    ds_read_b64_tr_b16 a[98:99], v13 offset:1024
    ds_read_b64_tr_b16 a[100:101], v13 offset:8
    ds_read_b64_tr_b16 a[102:103], v13 offset:1032
    ds_read_b64_tr_b16 a[104:105], v13 offset:8192
    ds_read_b64_tr_b16 a[106:107], v13 offset:9216
    ds_read_b64_tr_b16 a[108:109], v13 offset:8200
    ds_read_b64_tr_b16 a[110:111], v13 offset:9224
    s_waitcnt lgkmcnt(0)
    ds_read_b64_tr_b16 a[112:113], v13 offset:16384
    ds_read_b64_tr_b16 a[114:115], v13 offset:17408
    ds_read_b64_tr_b16 a[116:117], v13 offset:16392
    ds_read_b64_tr_b16 a[118:119], v13 offset:17416
    ds_read_b64_tr_b16 a[120:121], v13 offset:24576
    ds_read_b64_tr_b16 a[122:123], v13 offset:25600
    ds_read_b64_tr_b16 a[124:125], v13 offset:24584
    ds_read_b64_tr_b16 a[126:127], v13 offset:25608
    s_waitcnt lgkmcnt(0)
    s_barrier
    s_add_u32 m0, s22, 98304
    s_xor_b32 s20, s27, 7340032
    buffer_load_dwordx4 v11, s[12:15], s20 offen lds
    s_add_u32 m0, s22, 99328
    s_xor_b32 s20, s27, 7372800
    buffer_load_dwordx4 v11, s[12:15], s20 offen lds
    s_add_u32 m0, s22, 100352
    s_xor_b32 s20, s27, 7405568
    buffer_load_dwordx4 v11, s[12:15], s20 offen lds
    s_add_u32 m0, s22, 101376
    s_xor_b32 s20, s27, 7438336
    buffer_load_dwordx4 v11, s[12:15], s20 offen lds
    s_add_u32 m0, s22, 102400
    s_xor_b32 s20, s27, 7471104
    buffer_load_dwordx4 v11, s[12:15], s20 offen lds
    s_add_u32 m0, s22, 103424
    s_xor_b32 s20, s27, 7503872
    buffer_load_dwordx4 v11, s[12:15], s20 offen lds
    s_add_u32 m0, s22, 104448
    s_xor_b32 s20, s27, 7536640
    buffer_load_dwordx4 v11, s[12:15], s20 offen lds
    s_add_u32 m0, s22, 105472
    s_xor_b32 s20, s27, 7569408
    buffer_load_dwordx4 v11, s[12:15], s20 offen lds
    s_waitcnt vmcnt(24)
    s_barrier
    v_add_u32 v13, 0, v12
    ds_read_b64_tr_b16 a[128:129], v13 offset:0
    ds_read_b64_tr_b16 a[130:131], v13 offset:1024
    ds_read_b64_tr_b16 a[132:133], v13 offset:8
    ds_read_b64_tr_b16 a[134:135], v13 offset:1032
    ds_read_b64_tr_b16 a[136:137], v13 offset:8192
    ds_read_b64_tr_b16 a[138:139], v13 offset:9216
    ds_read_b64_tr_b16 a[140:141], v13 offset:8200
    ds_read_b64_tr_b16 a[142:143], v13 offset:9224
    s_waitcnt lgkmcnt(0)
    ds_read_b64_tr_b16 a[144:145], v13 offset:16384
    ds_read_b64_tr_b16 a[146:147], v13 offset:17408
    ds_read_b64_tr_b16 a[148:149], v13 offset:16392
    ds_read_b64_tr_b16 a[150:151], v13 offset:17416
    ds_read_b64_tr_b16 a[152:153], v13 offset:24576
    ds_read_b64_tr_b16 a[154:155], v13 offset:25600
    ds_read_b64_tr_b16 a[156:157], v13 offset:24584
    ds_read_b64_tr_b16 a[158:159], v13 offset:25608
    s_waitcnt lgkmcnt(0)
    s_barrier
    s_add_u32 m0, s21, 0
    s_xor_b32 s20, s23, 0
    buffer_load_dwordx4 v6, s[8:11], s20 offen lds
    s_add_u32 m0, s21, 1024
    s_xor_b32 s20, s23, 0
    buffer_load_dwordx4 v7, s[8:11], s20 offen lds
    s_add_u32 m0, s21, 8192
    s_xor_b32 s20, s23, 256
    buffer_load_dwordx4 v6, s[8:11], s20 offen lds
    s_add_u32 m0, s21, 9216
    s_xor_b32 s20, s23, 256
    buffer_load_dwordx4 v7, s[8:11], s20 offen lds
    s_add_u32 m0, s21, 16384
    s_xor_b32 s20, s23, 512
    buffer_load_dwordx4 v6, s[8:11], s20 offen lds
    s_add_u32 m0, s21, 17408
    s_xor_b32 s20, s23, 512
    buffer_load_dwordx4 v7, s[8:11], s20 offen lds
    s_add_u32 m0, s21, 24576
    s_xor_b32 s20, s23, 768
    buffer_load_dwordx4 v6, s[8:11], s20 offen lds
    s_add_u32 m0, s21, 25600
    s_xor_b32 s20, s23, 768
    buffer_load_dwordx4 v7, s[8:11], s20 offen lds
    s_waitcnt vmcnt(24)
    s_barrier
    v_add_u32 v13, 32768, v12
    ds_read_b64_tr_b16 a[160:161], v13 offset:0
    ds_read_b64_tr_b16 a[162:163], v13 offset:1024
    ds_read_b64_tr_b16 a[164:165], v13 offset:8
    ds_read_b64_tr_b16 a[166:167], v13 offset:1032
    ds_read_b64_tr_b16 a[168:169], v13 offset:8192
    ds_read_b64_tr_b16 a[170:171], v13 offset:9216
    ds_read_b64_tr_b16 a[172:173], v13 offset:8200
    ds_read_b64_tr_b16 a[174:175], v13 offset:9224
    s_waitcnt lgkmcnt(0)
    ds_read_b64_tr_b16 a[176:177], v13 offset:16384
    ds_read_b64_tr_b16 a[178:179], v13 offset:17408
    ds_read_b64_tr_b16 a[180:181], v13 offset:16392
    ds_read_b64_tr_b16 a[182:183], v13 offset:17416
    ds_read_b64_tr_b16 a[184:185], v13 offset:24576
    ds_read_b64_tr_b16 a[186:187], v13 offset:25600
    ds_read_b64_tr_b16 a[188:189], v13 offset:24584
    ds_read_b64_tr_b16 a[190:191], v13 offset:25608
    s_waitcnt lgkmcnt(0)
    s_barrier
    s_add_u32 m0, s21, 32768
    s_xor_b32 s20, s23, 1024
    buffer_load_dwordx4 v6, s[8:11], s20 offen lds
    s_add_u32 m0, s21, 33792
    s_xor_b32 s20, s23, 1024
    buffer_load_dwordx4 v7, s[8:11], s20 offen lds
    s_add_u32 m0, s21, 40960
    s_xor_b32 s20, s23, 1280
    buffer_load_dwordx4 v6, s[8:11], s20 offen lds
    s_add_u32 m0, s21, 41984
    s_xor_b32 s20, s23, 1280
    buffer_load_dwordx4 v7, s[8:11], s20 offen lds
    s_add_u32 m0, s21, 49152
    s_xor_b32 s20, s23, 1536
    buffer_load_dwordx4 v6, s[8:11], s20 offen lds
    s_add_u32 m0, s21, 50176
    s_xor_b32 s20, s23, 1536
    buffer_load_dwordx4 v7, s[8:11], s20 offen lds
    s_add_u32 m0, s21, 57344
    s_xor_b32 s20, s23, 1792
    buffer_load_dwordx4 v6, s[8:11], s20 offen lds
    s_add_u32 m0, s21, 58368
    s_xor_b32 s20, s23, 1792
    buffer_load_dwordx4 v7, s[8:11], s20 offen lds
    s_waitcnt vmcnt(24)
    s_barrier
    v_add_u32 v13, 65536, v12
    ds_read_b64_tr_b16 a[192:193], v13 offset:0
    ds_read_b64_tr_b16 a[194:195], v13 offset:1024
    ds_read_b64_tr_b16 a[196:197], v13 offset:8
    ds_read_b64_tr_b16 a[198:199], v13 offset:1032
    ds_read_b64_tr_b16 a[200:201], v13 offset:8192
    ds_read_b64_tr_b16 a[202:203], v13 offset:9216
    ds_read_b64_tr_b16 a[204:205], v13 offset:8200
    ds_read_b64_tr_b16 a[206:207], v13 offset:9224
    s_waitcnt lgkmcnt(0)
    ds_read_b64_tr_b16 a[208:209], v13 offset:16384
    ds_read_b64_tr_b16 a[210:211], v13 offset:17408
    ds_read_b64_tr_b16 a[212:213], v13 offset:16392
    ds_read_b64_tr_b16 a[214:215], v13 offset:17416
    ds_read_b64_tr_b16 a[216:217], v13 offset:24576
    ds_read_b64_tr_b16 a[218:219], v13 offset:25600
    ds_read_b64_tr_b16 a[220:221], v13 offset:24584
    ds_read_b64_tr_b16 a[222:223], v13 offset:25608
    s_waitcnt lgkmcnt(0)
    s_barrier
    s_add_u32 s23, s23, 131072
    s_add_u32 m0, s21, 65536
    s_xor_b32 s20, s23, 0
    buffer_load_dwordx4 v6, s[8:11], s20 offen lds
    s_add_u32 m0, s21, 66560
    s_xor_b32 s20, s23, 0
    buffer_load_dwordx4 v7, s[8:11], s20 offen lds
    s_add_u32 m0, s21, 73728
    s_xor_b32 s20, s23, 256
    buffer_load_dwordx4 v6, s[8:11], s20 offen lds
    s_add_u32 m0, s21, 74752
    s_xor_b32 s20, s23, 256
    buffer_load_dwordx4 v7, s[8:11], s20 offen lds
    s_add_u32 m0, s21, 81920
    s_xor_b32 s20, s23, 512
    buffer_load_dwordx4 v6, s[8:11], s20 offen lds
    s_add_u32 m0, s21, 82944
    s_xor_b32 s20, s23, 512
    buffer_load_dwordx4 v7, s[8:11], s20 offen lds
    s_add_u32 m0, s21, 90112
    s_xor_b32 s20, s23, 768
    buffer_load_dwordx4 v6, s[8:11], s20 offen lds
    s_add_u32 m0, s21, 91136
    s_xor_b32 s20, s23, 768
    buffer_load_dwordx4 v7, s[8:11], s20 offen lds
    s_waitcnt vmcnt(24)
    s_barrier
    s_cmp_lg_u32 s97, 0
    s_cbranch_scc1 mega_kernel_h2_4_ok
mega_kernel_h2_4_ev:
    v_cmp_ne_u32 vcc, 32, v36
    s_cbranch_vccz mega_kernel_h2_4_ok
    s_mov_b32 s78, 0
    v_readlane_b32 s81, v36, 0
    s_nop 3
    s_add_u32 s78, s78, s81
    v_readlane_b32 s81, v36, 1
    s_nop 3
    s_add_u32 s78, s78, s81
    v_readlane_b32 s81, v36, 2
    s_nop 3
    s_add_u32 s78, s78, s81
    v_readlane_b32 s81, v36, 3
    s_nop 3
    s_add_u32 s78, s78, s81
    v_readlane_b32 s81, v36, 4
    s_nop 3
    s_add_u32 s78, s78, s81
    v_readlane_b32 s81, v36, 5
    s_nop 3
    s_add_u32 s78, s78, s81
    v_readlane_b32 s81, v36, 6
    s_nop 3
    s_add_u32 s78, s78, s81
    v_readlane_b32 s81, v36, 7
    s_nop 3
    s_add_u32 s78, s78, s81
    s_cmp_eq_u32 s78, 256
    s_cbranch_scc1 mega_kernel_redo
    buffer_load_dword v36, v37, s[88:91], 0 offen sc1
    s_waitcnt vmcnt(0)
    s_branch mega_kernel_h2_4_ev
mega_kernel_h2_4_ok:
    v_add_u32 v13, 98304, v12
    ds_read_b64_tr_b16 a[224:225], v13 offset:0
    ds_read_b64_tr_b16 a[226:227], v13 offset:1024
    ds_read_b64_tr_b16 a[228:229], v13 offset:8
    ds_read_b64_tr_b16 a[230:231], v13 offset:1032
    ds_read_b64_tr_b16 a[232:233], v13 offset:8192
    ds_read_b64_tr_b16 a[234:235], v13 offset:9216
    ds_read_b64_tr_b16 a[236:237], v13 offset:8200
    ds_read_b64_tr_b16 a[238:239], v13 offset:9224
    s_waitcnt lgkmcnt(0)
    ds_read_b64_tr_b16 a[240:241], v13 offset:16384
    ds_read_b64_tr_b16 a[242:243], v13 offset:17408
    ds_read_b64_tr_b16 a[244:245], v13 offset:16392
    ds_read_b64_tr_b16 a[246:247], v13 offset:17416
    ds_read_b64_tr_b16 a[248:249], v13 offset:24576
    ds_read_b64_tr_b16 a[250:251], v13 offset:25600
    ds_read_b64_tr_b16 a[252:253], v13 offset:24584
    ds_read_b64_tr_b16 a[254:255], v13 offset:25608
    s_waitcnt lgkmcnt(0)
    s_barrier
    s_waitcnt vmcnt(16)
    s_barrier
    s_cmp_eq_u32 s17, 2
    s_cbranch_scc1 mega_kernel_q_v
    ds_read_b128 v[32:35], v16 offset:0
    ds_read_b128 v[36:39], v16 offset:4096
    ds_read_b128 v[40:43], v17 offset:0
    ds_read_b128 v[44:47], v17 offset:4096
    ds_read_b128 v[48:51], v18 offset:0
    ds_read_b128 v[52:55], v18 offset:4096
    s_mov_b32 s25, 0
mega_kernel_q_qk_loop:
    s_waitcnt lgkmcnt(5)
    v_mfma_f32_16x16x32_bf16 v[64:67], a[0:3], v[32:35], 0
    ds_read_b128 v[56:59], v19 offset:0
    v_mfma_f32_16x16x32_bf16 v[68:71], a[4:7], v[32:35], 0
    s_waitcnt lgkmcnt(5)
    v_mfma_f32_16x16x32_bf16 v[72:75], a[0:3], v[36:39], 0
    ds_read_b128 v[60:63], v19 offset:4096
    v_mfma_f32_16x16x32_bf16 v[76:79], a[4:7], v[36:39], 0
    s_waitcnt lgkmcnt(5)
    v_mfma_f32_16x16x32_bf16 v[64:67], a[8:11], v[40:43], v[64:67]
    ds_read_b128 v[32:35], v16 offset:8192
    v_mfma_f32_16x16x32_bf16 v[68:71], a[12:15], v[40:43], v[68:71]
    s_cmp_eq_u32 s25, 0
    s_cbranch_scc1 mega_kernel_q_qk_sk2
    s_add_u32 m0, s21, 74752
    s_xor_b32 s20, s23, 256
    buffer_load_dwordx4 v7, s[8:11], s20 offen lds
mega_kernel_q_qk_sk2:
    s_waitcnt lgkmcnt(5)
    v_mfma_f32_16x16x32_bf16 v[72:75], a[8:11], v[44:47], v[72:75]
    ds_read_b128 v[36:39], v16 offset:12288
    v_mfma_f32_16x16x32_bf16 v[76:79], a[12:15], v[44:47], v[76:79]
    s_waitcnt lgkmcnt(5)
    v_mfma_f32_16x16x32_bf16 v[64:67], a[16:19], v[48:51], v[64:67]
    ds_read_b128 v[40:43], v17 offset:8192
    v_mfma_f32_16x16x32_bf16 v[68:71], a[20:23], v[48:51], v[68:71]
    s_waitcnt lgkmcnt(5)
    v_mfma_f32_16x16x32_bf16 v[72:75], a[16:19], v[52:55], v[72:75]
    ds_read_b128 v[44:47], v17 offset:12288
    v_mfma_f32_16x16x32_bf16 v[76:79], a[20:23], v[52:55], v[76:79]
    s_cmp_eq_u32 s25, 0
    s_cbranch_scc1 mega_kernel_q_qk_sk5
    s_add_u32 m0, s21, 81920
    s_xor_b32 s20, s23, 512
    buffer_load_dwordx4 v6, s[8:11], s20 offen lds
mega_kernel_q_qk_sk5:
    s_waitcnt lgkmcnt(5)
    v_mfma_f32_16x16x32_bf16 v[64:67], a[24:27], v[56:59], v[64:67]
    ds_read_b128 v[48:51], v18 offset:8192
    v_mfma_f32_16x16x32_bf16 v[68:71], a[28:31], v[56:59], v[68:71]
    s_waitcnt lgkmcnt(5)
    v_mfma_f32_16x16x32_bf16 v[72:75], a[24:27], v[60:63], v[72:75]
    ds_read_b128 v[52:55], v18 offset:12288
    v_mfma_f32_16x16x32_bf16 v[76:79], a[28:31], v[60:63], v[76:79]
    s_waitcnt lgkmcnt(5)
    v_mfma_f32_16x16x32_bf16 v[64:67], a[32:35], v[32:35], v[64:67]
    ds_read_b128 v[56:59], v19 offset:8192
    v_mfma_f32_16x16x32_bf16 v[68:71], a[36:39], v[32:35], v[68:71]
    s_cmp_eq_u32 s25, 0
    s_cbranch_scc1 mega_kernel_q_qk_sk8
    s_add_u32 m0, s21, 82944
    s_xor_b32 s20, s23, 512
    buffer_load_dwordx4 v7, s[8:11], s20 offen lds
mega_kernel_q_qk_sk8:
    s_waitcnt lgkmcnt(5)
    v_mfma_f32_16x16x32_bf16 v[72:75], a[32:35], v[36:39], v[72:75]
    ds_read_b128 v[60:63], v19 offset:12288
    v_mfma_f32_16x16x32_bf16 v[76:79], a[36:39], v[36:39], v[76:79]
    s_waitcnt lgkmcnt(5)
    v_mfma_f32_16x16x32_bf16 v[64:67], a[40:43], v[40:43], v[64:67]
    ds_read_b128 v[32:35], v16 offset:16384
    v_mfma_f32_16x16x32_bf16 v[68:71], a[44:47], v[40:43], v[68:71]
    s_waitcnt lgkmcnt(5)
    v_mfma_f32_16x16x32_bf16 v[72:75], a[40:43], v[44:47], v[72:75]
    ds_read_b128 v[36:39], v16 offset:20480
    v_mfma_f32_16x16x32_bf16 v[76:79], a[44:47], v[44:47], v[76:79]
    s_cmp_eq_u32 s25, 0
    s_cbranch_scc1 mega_kernel_q_qk_sk11
    s_add_u32 m0, s21, 90112
    s_xor_b32 s20, s23, 768
    buffer_load_dwordx4 v6, s[8:11], s20 offen lds
mega_kernel_q_qk_sk11:
    s_waitcnt lgkmcnt(5)
    v_mfma_f32_16x16x32_bf16 v[64:67], a[48:51], v[48:51], v[64:67]
    ds_read_b128 v[40:43], v17 offset:16384
    v_mfma_f32_16x16x32_bf16 v[68:71], a[52:55], v[48:51], v[68:71]
    s_waitcnt lgkmcnt(5)
    v_mfma_f32_16x16x32_bf16 v[72:75], a[48:51], v[52:55], v[72:75]
    ds_read_b128 v[44:47], v17 offset:20480
    v_mfma_f32_16x16x32_bf16 v[76:79], a[52:55], v[52:55], v[76:79]
    s_waitcnt lgkmcnt(5)
    v_mfma_f32_16x16x32_bf16 v[64:67], a[56:59], v[56:59], v[64:67]
    ds_read_b128 v[48:51], v18 offset:16384
    v_mfma_f32_16x16x32_bf16 v[68:71], a[60:63], v[56:59], v[68:71]
    s_cmp_eq_u32 s25, 0
    s_cbranch_scc1 mega_kernel_q_qk_sk14
    s_add_u32 m0, s21, 91136
    s_xor_b32 s20, s23, 768
    buffer_load_dwordx4 v7, s[8:11], s20 offen lds
mega_kernel_q_qk_sk14:
    s_waitcnt lgkmcnt(5)
    v_mfma_f32_16x16x32_bf16 v[72:75], a[56:59], v[60:63], v[72:75]
    ds_read_b128 v[52:55], v18 offset:20480
    v_mfma_f32_16x16x32_bf16 v[76:79], a[60:63], v[60:63], v[76:79]
    s_cmp_eq_u32 s25, 0
    s_cbranch_scc1 mega_kernel_q_qk_ne0
    v_cvt_pk_bf16_f32 v96, v80, v81
    v_cvt_pk_bf16_f32 v97, v82, v83
mega_kernel_q_qk_ne0:
    s_waitcnt lgkmcnt(5)
    v_mfma_f32_16x16x32_bf16 v[64:67], a[64:67], v[32:35], v[64:67]
    ds_read_b128 v[56:59], v19 offset:16384
    v_mfma_f32_16x16x32_bf16 v[68:71], a[68:71], v[32:35], v[68:71]
    s_cmp_eq_u32 s25, 0
    s_cbranch_scc1 mega_kernel_q_qk_ne1
    v_cvt_pk_bf16_f32 v98, v84, v85
    v_cvt_pk_bf16_f32 v99, v86, v87
mega_kernel_q_qk_ne1:
    s_waitcnt lgkmcnt(5)
    v_mfma_f32_16x16x32_bf16 v[72:75], a[64:67], v[36:39], v[72:75]
    ds_read_b128 v[60:63], v19 offset:20480
    v_mfma_f32_16x16x32_bf16 v[76:79], a[68:71], v[36:39], v[76:79]
    s_cmp_eq_u32 s25, 0
    s_cbranch_scc1 mega_kernel_q_qk_ne2
    buffer_store_dwordx4 v[96:99], v8, s[84:87], s24 offen offset:0 sc1
    v_cvt_pk_bf16_f32 v100, v88, v89
mega_kernel_q_qk_ne2:
    s_waitcnt lgkmcnt(5)
    v_mfma_f32_16x16x32_bf16 v[64:67], a[72:75], v[40:43], v[64:67]
    ds_read_b128 v[32:35], v16 offset:24576
    v_mfma_f32_16x16x32_bf16 v[68:71], a[76:79], v[40:43], v[68:71]
    s_cmp_eq_u32 s25, 0
    s_cbranch_scc1 mega_kernel_q_qk_ne3
    v_cvt_pk_bf16_f32 v101, v90, v91
    v_cvt_pk_bf16_f32 v102, v92, v93
mega_kernel_q_qk_ne3:
    s_waitcnt lgkmcnt(5)
    v_mfma_f32_16x16x32_bf16 v[72:75], a[72:75], v[44:47], v[72:75]
    ds_read_b128 v[36:39], v16 offset:28672
    v_mfma_f32_16x16x32_bf16 v[76:79], a[76:79], v[44:47], v[76:79]
    s_cmp_eq_u32 s25, 0
    s_cbranch_scc1 mega_kernel_q_qk_ne4
    v_cvt_pk_bf16_f32 v103, v94, v95
    buffer_store_dwordx4 v[100:103], v8, s[84:87], s24 offen offset:1024 sc1
mega_kernel_q_qk_ne4:
    s_waitcnt lgkmcnt(5)
    v_mfma_f32_16x16x32_bf16 v[64:67], a[80:83], v[48:51], v[64:67]
    ds_read_b128 v[40:43], v17 offset:24576
    v_mfma_f32_16x16x32_bf16 v[68:71], a[84:87], v[48:51], v[68:71]
    s_cmp_eq_u32 s25, 0
    s_cbranch_scc1 mega_kernel_q_qk_ne5
    s_add_u32 s24, s24, 524288
mega_kernel_q_qk_ne5:
    s_waitcnt lgkmcnt(5)
    v_mfma_f32_16x16x32_bf16 v[72:75], a[80:83], v[52:55], v[72:75]
    ds_read_b128 v[44:47], v17 offset:28672
    v_mfma_f32_16x16x32_bf16 v[76:79], a[84:87], v[52:55], v[76:79]
    s_waitcnt lgkmcnt(5)
    v_mfma_f32_16x16x32_bf16 v[64:67], a[88:91], v[56:59], v[64:67]
    ds_read_b128 v[48:51], v18 offset:24576
    v_mfma_f32_16x16x32_bf16 v[68:71], a[92:95], v[56:59], v[68:71]
    s_cmp_lg_u32 s25, 2
    s_cbranch_scc1 mega_kernel_q_qk_nx
    v_lshlrev_b32 v242, 7, v0
    v_min_u32 v242, 21888, v242
    s_mul_i32 s46, s92, 21888
    buffer_load_dword v240, v242, s[8:11], s46 offen
mega_kernel_q_qk_nx:
    s_waitcnt lgkmcnt(5)
    v_mfma_f32_16x16x32_bf16 v[72:75], a[88:91], v[60:63], v[72:75]
    ds_read_b128 v[52:55], v18 offset:28672
    v_mfma_f32_16x16x32_bf16 v[76:79], a[92:95], v[60:63], v[76:79]
    s_waitcnt vmcnt(8)
    s_barrier
    s_waitcnt lgkmcnt(5)
    v_mfma_f32_16x16x32_bf16 v[64:67], a[96:99], v[32:35], v[64:67]
    ds_read_b128 v[56:59], v19 offset:24576
    v_mfma_f32_16x16x32_bf16 v[68:71], a[100:103], v[32:35], v[68:71]
    s_waitcnt lgkmcnt(5)
    v_mfma_f32_16x16x32_bf16 v[72:75], a[96:99], v[36:39], v[72:75]
    ds_read_b128 v[60:63], v19 offset:28672
    v_mfma_f32_16x16x32_bf16 v[76:79], a[100:103], v[36:39], v[76:79]
    s_add_u32 m0, s21, 98304
    s_xor_b32 s20, s23, 1024
    buffer_load_dwordx4 v6, s[8:11], s20 offen lds
    s_waitcnt lgkmcnt(5)
    v_mfma_f32_16x16x32_bf16 v[64:67], a[104:107], v[40:43], v[64:67]
    ds_read_b128 v[32:35], v16 offset:32768
    v_mfma_f32_16x16x32_bf16 v[68:71], a[108:111], v[40:43], v[68:71]
    s_waitcnt lgkmcnt(5)
    v_mfma_f32_16x16x32_bf16 v[72:75], a[104:107], v[44:47], v[72:75]
    ds_read_b128 v[36:39], v16 offset:36864
    v_mfma_f32_16x16x32_bf16 v[76:79], a[108:111], v[44:47], v[76:79]
    s_waitcnt lgkmcnt(5)
    v_mfma_f32_16x16x32_bf16 v[64:67], a[112:115], v[48:51], v[64:67]
    ds_read_b128 v[40:43], v17 offset:32768
    v_mfma_f32_16x16x32_bf16 v[68:71], a[116:119], v[48:51], v[68:71]
    s_add_u32 m0, s21, 99328
    s_xor_b32 s20, s23, 1024
    buffer_load_dwordx4 v7, s[8:11], s20 offen lds
    s_waitcnt lgkmcnt(5)
    v_mfma_f32_16x16x32_bf16 v[72:75], a[112:115], v[52:55], v[72:75]
    ds_read_b128 v[44:47], v17 offset:36864
    v_mfma_f32_16x16x32_bf16 v[76:79], a[116:119], v[52:55], v[76:79]
    s_waitcnt lgkmcnt(5)
    v_mfma_f32_16x16x32_bf16 v[64:67], a[120:123], v[56:59], v[64:67]
    ds_read_b128 v[48:51], v18 offset:32768
    v_mfma_f32_16x16x32_bf16 v[68:71], a[124:127], v[56:59], v[68:71]
    s_waitcnt lgkmcnt(5)
    v_mfma_f32_16x16x32_bf16 v[72:75], a[120:123], v[60:63], v[72:75]
    ds_read_b128 v[52:55], v18 offset:36864
    v_mfma_f32_16x16x32_bf16 v[76:79], a[124:127], v[60:63], v[76:79]
    s_add_u32 m0, s21, 106496
    s_xor_b32 s20, s23, 1280
    buffer_load_dwordx4 v6, s[8:11], s20 offen lds
    s_waitcnt lgkmcnt(5)
    v_mfma_f32_16x16x32_bf16 v[64:67], a[128:131], v[32:35], v[64:67]
    ds_read_b128 v[56:59], v19 offset:32768
    v_mfma_f32_16x16x32_bf16 v[68:71], a[132:135], v[32:35], v[68:71]
    s_waitcnt lgkmcnt(5)
    v_mfma_f32_16x16x32_bf16 v[72:75], a[128:131], v[36:39], v[72:75]
    ds_read_b128 v[60:63], v19 offset:36864
    v_mfma_f32_16x16x32_bf16 v[76:79], a[132:135], v[36:39], v[76:79]
    s_waitcnt lgkmcnt(5)
    v_mfma_f32_16x16x32_bf16 v[64:67], a[136:139], v[40:43], v[64:67]
    ds_read_b128 v[32:35], v16 offset:40960
    v_mfma_f32_16x16x32_bf16 v[68:71], a[140:143], v[40:43], v[68:71]
    s_add_u32 m0, s21, 107520
    s_xor_b32 s20, s23, 1280
    buffer_load_dwordx4 v7, s[8:11], s20 offen lds
    s_waitcnt lgkmcnt(5)
    v_mfma_f32_16x16x32_bf16 v[72:75], a[136:139], v[44:47], v[72:75]
    ds_read_b128 v[36:39], v16 offset:45056
    v_mfma_f32_16x16x32_bf16 v[76:79], a[140:143], v[44:47], v[76:79]
    s_waitcnt lgkmcnt(5)
    v_mfma_f32_16x16x32_bf16 v[64:67], a[144:147], v[48:51], v[64:67]
    ds_read_b128 v[40:43], v17 offset:40960
    v_mfma_f32_16x16x32_bf16 v[68:71], a[148:151], v[48:51], v[68:71]
    s_waitcnt lgkmcnt(5)
    v_mfma_f32_16x16x32_bf16 v[72:75], a[144:147], v[52:55], v[72:75]
    ds_read_b128 v[44:47], v17 offset:45056
    v_mfma_f32_16x16x32_bf16 v[76:79], a[148:151], v[52:55], v[76:79]
    s_add_u32 m0, s21, 114688
    s_xor_b32 s20, s23, 1536
    buffer_load_dwordx4 v6, s[8:11], s20 offen lds
    s_waitcnt lgkmcnt(5)
    v_mfma_f32_16x16x32_bf16 v[64:67], a[152:155], v[56:59], v[64:67]
    ds_read_b128 v[48:51], v18 offset:40960
    v_mfma_f32_16x16x32_bf16 v[68:71], a[156:159], v[56:59], v[68:71]
    s_waitcnt lgkmcnt(5)
    v_mfma_f32_16x16x32_bf16 v[72:75], a[152:155], v[60:63], v[72:75]
    ds_read_b128 v[52:55], v18 offset:45056
    v_mfma_f32_16x16x32_bf16 v[76:79], a[156:159], v[60:63], v[76:79]
    s_waitcnt lgkmcnt(5)
    v_mfma_f32_16x16x32_bf16 v[64:67], a[160:163], v[32:35], v[64:67]
    ds_read_b128 v[56:59], v19 offset:40960
    v_mfma_f32_16x16x32_bf16 v[68:71], a[164:167], v[32:35], v[68:71]
    s_add_u32 m0, s21, 115712
    s_xor_b32 s20, s23, 1536
    buffer_load_dwordx4 v7, s[8:11], s20 offen lds
    s_waitcnt lgkmcnt(5)
    v_mfma_f32_16x16x32_bf16 v[72:75], a[160:163], v[36:39], v[72:75]
    ds_read_b128 v[60:63], v19 offset:45056
    v_mfma_f32_16x16x32_bf16 v[76:79], a[164:167], v[36:39], v[76:79]
    s_waitcnt lgkmcnt(5)
    v_mfma_f32_16x16x32_bf16 v[64:67], a[168:171], v[40:43], v[64:67]
    ds_read_b128 v[32:35], v16 offset:49152
    v_mfma_f32_16x16x32_bf16 v[68:71], a[172:175], v[40:43], v[68:71]
    s_waitcnt lgkmcnt(5)
    v_mfma_f32_16x16x32_bf16 v[72:75], a[168:171], v[44:47], v[72:75]
    ds_read_b128 v[36:39], v16 offset:53248
    v_mfma_f32_16x16x32_bf16 v[76:79], a[172:175], v[44:47], v[76:79]
    s_add_u32 m0, s21, 122880
    s_xor_b32 s20, s23, 1792
    buffer_load_dwordx4 v6, s[8:11], s20 offen lds
    s_waitcnt lgkmcnt(5)
    v_mfma_f32_16x16x32_bf16 v[64:67], a[176:179], v[48:51], v[64:67]
    ds_read_b128 v[40:43], v17 offset:49152
    v_mfma_f32_16x16x32_bf16 v[68:71], a[180:183], v[48:51], v[68:71]
    s_waitcnt lgkmcnt(5)
    v_mfma_f32_16x16x32_bf16 v[72:75], a[176:179], v[52:55], v[72:75]
    ds_read_b128 v[44:47], v17 offset:53248
    v_mfma_f32_16x16x32_bf16 v[76:79], a[180:183], v[52:55], v[76:79]
    s_waitcnt lgkmcnt(5)
    v_mfma_f32_16x16x32_bf16 v[64:67], a[184:187], v[56:59], v[64:67]
    ds_read_b128 v[48:51], v18 offset:49152
    v_mfma_f32_16x16x32_bf16 v[68:71], a[188:191], v[56:59], v[68:71]
    s_add_u32 m0, s21, 123904
    s_xor_b32 s20, s23, 1792
    buffer_load_dwordx4 v7, s[8:11], s20 offen lds
    s_waitcnt lgkmcnt(5)
    v_mfma_f32_16x16x32_bf16 v[72:75], a[184:187], v[60:63], v[72:75]
    ds_read_b128 v[52:55], v18 offset:53248
    v_mfma_f32_16x16x32_bf16 v[76:79], a[188:191], v[60:63], v[76:79]
    s_waitcnt lgkmcnt(5)
    v_mfma_f32_16x16x32_bf16 v[64:67], a[192:195], v[32:35], v[64:67]
    ds_read_b128 v[56:59], v19 offset:49152
    v_mfma_f32_16x16x32_bf16 v[68:71], a[196:199], v[32:35], v[68:71]
    s_waitcnt lgkmcnt(5)
    v_mfma_f32_16x16x32_bf16 v[72:75], a[192:195], v[36:39], v[72:75]
    ds_read_b128 v[60:63], v19 offset:53248
    v_mfma_f32_16x16x32_bf16 v[76:79], a[196:199], v[36:39], v[76:79]
    s_waitcnt lgkmcnt(5)
    v_mfma_f32_16x16x32_bf16 v[64:67], a[200:203], v[40:43], v[64:67]
    ds_read_b128 v[32:35], v16 offset:57344
    v_mfma_f32_16x16x32_bf16 v[68:71], a[204:207], v[40:43], v[68:71]
    s_waitcnt lgkmcnt(5)
    v_mfma_f32_16x16x32_bf16 v[72:75], a[200:203], v[44:47], v[72:75]
    ds_read_b128 v[36:39], v16 offset:61440
    v_mfma_f32_16x16x32_bf16 v[76:79], a[204:207], v[44:47], v[76:79]
    s_waitcnt lgkmcnt(5)
    v_mfma_f32_16x16x32_bf16 v[64:67], a[208:211], v[48:51], v[64:67]
    ds_read_b128 v[40:43], v17 offset:57344
    v_mfma_f32_16x16x32_bf16 v[68:71], a[212:215], v[48:51], v[68:71]
    s_waitcnt lgkmcnt(5)
    v_mfma_f32_16x16x32_bf16 v[72:75], a[208:211], v[52:55], v[72:75]
    ds_read_b128 v[44:47], v17 offset:61440
    v_mfma_f32_16x16x32_bf16 v[76:79], a[212:215], v[52:55], v[76:79]
    s_waitcnt lgkmcnt(5)
    v_mfma_f32_16x16x32_bf16 v[64:67], a[216:219], v[56:59], v[64:67]
    ds_read_b128 v[48:51], v18 offset:57344
    v_mfma_f32_16x16x32_bf16 v[68:71], a[220:223], v[56:59], v[68:71]
    s_waitcnt lgkmcnt(5)
    v_mfma_f32_16x16x32_bf16 v[72:75], a[216:219], v[60:63], v[72:75]
    ds_read_b128 v[52:55], v18 offset:61440
    v_mfma_f32_16x16x32_bf16 v[76:79], a[220:223], v[60:63], v[76:79]
    s_waitcnt vmcnt(8)
    s_barrier
    s_waitcnt lgkmcnt(5)
    v_mfma_f32_16x16x32_bf16 v[64:67], a[224:227], v[32:35], v[64:67]
    ds_read_b128 v[56:59], v19 offset:57344
    v_mfma_f32_16x16x32_bf16 v[68:71], a[228:231], v[32:35], v[68:71]
    s_waitcnt lgkmcnt(5)
    v_mfma_f32_16x16x32_bf16 v[72:75], a[224:227], v[36:39], v[72:75]
    ds_read_b128 v[60:63], v19 offset:61440
    v_mfma_f32_16x16x32_bf16 v[76:79], a[228:231], v[36:39], v[76:79]
    s_add_u32 s23, s23, 131072
    s_add_u32 m0, s21, 0
    s_xor_b32 s20, s23, 0
    buffer_load_dwordx4 v6, s[8:11], s20 offen lds
    s_waitcnt lgkmcnt(5)
    v_mfma_f32_16x16x32_bf16 v[64:67], a[232:235], v[40:43], v[64:67]
    ds_read_b128 v[32:35], v20 offset:0
    v_mfma_f32_16x16x32_bf16 v[68:71], a[236:239], v[40:43], v[68:71]
    s_cmp_eq_u32 s25, 0
    s_cbranch_scc1 mega_kernel_q_qk_nf
    v_add_u32 v10, 1, v10
    buffer_store_dword v10, v9, s[84:87], 0 offen sc1
mega_kernel_q_qk_nf:
    s_waitcnt lgkmcnt(5)
    v_mfma_f32_16x16x32_bf16 v[72:75], a[232:235], v[44:47], v[72:75]
    ds_read_b128 v[36:39], v20 offset:4096
    v_mfma_f32_16x16x32_bf16 v[76:79], a[236:239], v[44:47], v[76:79]
    s_waitcnt lgkmcnt(5)
    v_mfma_f32_16x16x32_bf16 v[64:67], a[240:243], v[48:51], v[64:67]
    ds_read_b128 v[40:43], v21 offset:0
    v_mfma_f32_16x16x32_bf16 v[68:71], a[244:247], v[48:51], v[68:71]
    s_add_u32 m0, s21, 1024
    s_xor_b32 s20, s23, 0
    buffer_load_dwordx4 v7, s[8:11], s20 offen lds
    s_waitcnt lgkmcnt(5)
    v_mfma_f32_16x16x32_bf16 v[72:75], a[240:243], v[52:55], v[72:75]
    ds_read_b128 v[44:47], v21 offset:4096
    v_mfma_f32_16x16x32_bf16 v[76:79], a[244:247], v[52:55], v[76:79]
    s_waitcnt lgkmcnt(5)
    v_mfma_f32_16x16x32_bf16 v[64:67], a[248:251], v[56:59], v[64:67]
    ds_read_b128 v[48:51], v22 offset:0
    v_mfma_f32_16x16x32_bf16 v[68:71], a[252:255], v[56:59], v[68:71]
    s_waitcnt lgkmcnt(5)
    v_mfma_f32_16x16x32_bf16 v[72:75], a[248:251], v[60:63], v[72:75]
    ds_read_b128 v[52:55], v22 offset:4096
    v_mfma_f32_16x16x32_bf16 v[76:79], a[252:255], v[60:63], v[76:79]
    s_add_u32 m0, s21, 8192
    s_xor_b32 s20, s23, 256
    buffer_load_dwordx4 v6, s[8:11], s20 offen lds
    s_waitcnt lgkmcnt(5)
    v_mfma_f32_16x16x32_bf16 v[80:83], a[0:3], v[32:35], 0
    ds_read_b128 v[56:59], v23 offset:0
    v_mfma_f32_16x16x32_bf16 v[84:87], a[4:7], v[32:35], 0
    s_waitcnt lgkmcnt(5)
    v_mfma_f32_16x16x32_bf16 v[88:91], a[0:3], v[36:39], 0
    ds_read_b128 v[60:63], v23 offset:4096
    v_mfma_f32_16x16x32_bf16 v[92:95], a[4:7], v[36:39], 0
    s_waitcnt lgkmcnt(5)
    v_mfma_f32_16x16x32_bf16 v[80:83], a[8:11], v[40:43], v[80:83]
    ds_read_b128 v[32:35], v20 offset:8192
    v_mfma_f32_16x16x32_bf16 v[84:87], a[12:15], v[40:43], v[84:87]
    s_add_u32 m0, s21, 9216
    s_xor_b32 s20, s23, 256
    buffer_load_dwordx4 v7, s[8:11], s20 offen lds
    s_waitcnt lgkmcnt(5)
    v_mfma_f32_16x16x32_bf16 v[88:91], a[8:11], v[44:47], v[88:91]
    ds_read_b128 v[36:39], v20 offset:12288
    v_mfma_f32_16x16x32_bf16 v[92:95], a[12:15], v[44:47], v[92:95]
    s_waitcnt lgkmcnt(5)
    v_mfma_f32_16x16x32_bf16 v[80:83], a[16:19], v[48:51], v[80:83]
    ds_read_b128 v[40:43], v21 offset:8192
    v_mfma_f32_16x16x32_bf16 v[84:87], a[20:23], v[48:51], v[84:87]
    s_waitcnt lgkmcnt(5)
    v_mfma_f32_16x16x32_bf16 v[88:91], a[16:19], v[52:55], v[88:91]
    ds_read_b128 v[44:47], v21 offset:12288
    v_mfma_f32_16x16x32_bf16 v[92:95], a[20:23], v[52:55], v[92:95]
    s_add_u32 m0, s21, 16384
    s_xor_b32 s20, s23, 512
    buffer_load_dwordx4 v6, s[8:11], s20 offen lds
    s_waitcnt lgkmcnt(5)
    v_mfma_f32_16x16x32_bf16 v[80:83], a[24:27], v[56:59], v[80:83]
    ds_read_b128 v[48:51], v22 offset:8192
    v_mfma_f32_16x16x32_bf16 v[84:87], a[28:31], v[56:59], v[84:87]
    s_waitcnt lgkmcnt(5)
    v_mfma_f32_16x16x32_bf16 v[88:91], a[24:27], v[60:63], v[88:91]
    ds_read_b128 v[52:55], v22 offset:12288
    v_mfma_f32_16x16x32_bf16 v[92:95], a[28:31], v[60:63], v[92:95]
    s_waitcnt lgkmcnt(5)
    v_mfma_f32_16x16x32_bf16 v[80:83], a[32:35], v[32:35], v[80:83]
    ds_read_b128 v[56:59], v23 offset:8192
    v_mfma_f32_16x16x32_bf16 v[84:87], a[36:39], v[32:35], v[84:87]
    s_add_u32 m0, s21, 17408
    s_xor_b32 s20, s23, 512
    buffer_load_dwordx4 v7, s[8:11], s20 offen lds
    s_waitcnt lgkmcnt(5)
    v_mfma_f32_16x16x32_bf16 v[88:91], a[32:35], v[36:39], v[88:91]
    ds_read_b128 v[60:63], v23 offset:12288
    v_mfma_f32_16x16x32_bf16 v[92:95], a[36:39], v[36:39], v[92:95]
    s_waitcnt lgkmcnt(5)
    v_mfma_f32_16x16x32_bf16 v[80:83], a[40:43], v[40:43], v[80:83]
    ds_read_b128 v[32:35], v20 offset:16384
    v_mfma_f32_16x16x32_bf16 v[84:87], a[44:47], v[40:43], v[84:87]
    s_waitcnt lgkmcnt(5)
    v_mfma_f32_16x16x32_bf16 v[88:91], a[40:43], v[44:47], v[88:91]
    ds_read_b128 v[36:39], v20 offset:20480
    v_mfma_f32_16x16x32_bf16 v[92:95], a[44:47], v[44:47], v[92:95]
    s_add_u32 m0, s21, 24576
    s_xor_b32 s20, s23, 768
    buffer_load_dwordx4 v6, s[8:11], s20 offen lds
    s_waitcnt lgkmcnt(5)
    v_mfma_f32_16x16x32_bf16 v[80:83], a[48:51], v[48:51], v[80:83]
    ds_read_b128 v[40:43], v21 offset:16384
    v_mfma_f32_16x16x32_bf16 v[84:87], a[52:55], v[48:51], v[84:87]
    s_waitcnt lgkmcnt(5)
    v_mfma_f32_16x16x32_bf16 v[88:91], a[48:51], v[52:55], v[88:91]
    ds_read_b128 v[44:47], v21 offset:20480
    v_mfma_f32_16x16x32_bf16 v[92:95], a[52:55], v[52:55], v[92:95]
    s_waitcnt lgkmcnt(5)
    v_mfma_f32_16x16x32_bf16 v[80:83], a[56:59], v[56:59], v[80:83]
    ds_read_b128 v[48:51], v22 offset:16384
    v_mfma_f32_16x16x32_bf16 v[84:87], a[60:63], v[56:59], v[84:87]
    s_add_u32 m0, s21, 25600
    s_xor_b32 s20, s23, 768
    buffer_load_dwordx4 v7, s[8:11], s20 offen lds
    s_waitcnt lgkmcnt(5)
    v_mfma_f32_16x16x32_bf16 v[88:91], a[56:59], v[60:63], v[88:91]
    ds_read_b128 v[52:55], v22 offset:20480
    v_mfma_f32_16x16x32_bf16 v[92:95], a[60:63], v[60:63], v[92:95]
    v_cvt_pk_bf16_f32 v96, v64, v65
    v_cvt_pk_bf16_f32 v97, v66, v67
    s_waitcnt lgkmcnt(5)
    v_mfma_f32_16x16x32_bf16 v[80:83], a[64:67], v[32:35], v[80:83]
    ds_read_b128 v[56:59], v23 offset:16384
    v_mfma_f32_16x16x32_bf16 v[84:87], a[68:71], v[32:35], v[84:87]
    v_cvt_pk_bf16_f32 v98, v68, v69
    v_cvt_pk_bf16_f32 v99, v70, v71
    s_waitcnt lgkmcnt(5)
    v_mfma_f32_16x16x32_bf16 v[88:91], a[64:67], v[36:39], v[88:91]
    ds_read_b128 v[60:63], v23 offset:20480
    v_mfma_f32_16x16x32_bf16 v[92:95], a[68:71], v[36:39], v[92:95]
    buffer_store_dwordx4 v[96:99], v8, s[84:87], s24 offen offset:0 sc1
    v_cvt_pk_bf16_f32 v100, v72, v73
    s_waitcnt lgkmcnt(5)
    v_mfma_f32_16x16x32_bf16 v[80:83], a[72:75], v[40:43], v[80:83]
    ds_read_b128 v[32:35], v20 offset:24576
    v_mfma_f32_16x16x32_bf16 v[84:87], a[76:79], v[40:43], v[84:87]
    v_cvt_pk_bf16_f32 v101, v74, v75
    v_cvt_pk_bf16_f32 v102, v76, v77
    s_waitcnt lgkmcnt(5)
    v_mfma_f32_16x16x32_bf16 v[88:91], a[72:75], v[44:47], v[88:91]
    ds_read_b128 v[36:39], v20 offset:28672
    v_mfma_f32_16x16x32_bf16 v[92:95], a[76:79], v[44:47], v[92:95]
    v_cvt_pk_bf16_f32 v103, v78, v79
    buffer_store_dwordx4 v[100:103], v8, s[84:87], s24 offen offset:1024 sc1
    s_waitcnt lgkmcnt(5)
    v_mfma_f32_16x16x32_bf16 v[80:83], a[80:83], v[48:51], v[80:83]
    ds_read_b128 v[40:43], v21 offset:24576
    v_mfma_f32_16x16x32_bf16 v[84:87], a[84:87], v[48:51], v[84:87]
    s_add_u32 s24, s24, 524288
    s_waitcnt lgkmcnt(5)
    v_mfma_f32_16x16x32_bf16 v[88:91], a[80:83], v[52:55], v[88:91]
    ds_read_b128 v[44:47], v21 offset:28672
    v_mfma_f32_16x16x32_bf16 v[92:95], a[84:87], v[52:55], v[92:95]
    s_waitcnt lgkmcnt(5)
    v_mfma_f32_16x16x32_bf16 v[80:83], a[88:91], v[56:59], v[80:83]
    ds_read_b128 v[48:51], v22 offset:24576
    v_mfma_f32_16x16x32_bf16 v[84:87], a[92:95], v[56:59], v[84:87]
    s_waitcnt lgkmcnt(5)
    v_mfma_f32_16x16x32_bf16 v[88:91], a[88:91], v[60:63], v[88:91]
    ds_read_b128 v[52:55], v22 offset:28672
    v_mfma_f32_16x16x32_bf16 v[92:95], a[92:95], v[60:63], v[92:95]
    s_waitcnt vmcnt(8)
    s_barrier
    s_waitcnt lgkmcnt(5)
    v_mfma_f32_16x16x32_bf16 v[80:83], a[96:99], v[32:35], v[80:83]
    ds_read_b128 v[56:59], v23 offset:24576
    v_mfma_f32_16x16x32_bf16 v[84:87], a[100:103], v[32:35], v[84:87]
    s_waitcnt lgkmcnt(5)
    v_mfma_f32_16x16x32_bf16 v[88:91], a[96:99], v[36:39], v[88:91]
    ds_read_b128 v[60:63], v23 offset:28672
    v_mfma_f32_16x16x32_bf16 v[92:95], a[100:103], v[36:39], v[92:95]
    s_add_u32 m0, s21, 32768
    s_xor_b32 s20, s23, 1024
    buffer_load_dwordx4 v6, s[8:11], s20 offen lds
    s_waitcnt lgkmcnt(5)
    v_mfma_f32_16x16x32_bf16 v[80:83], a[104:107], v[40:43], v[80:83]
    ds_read_b128 v[32:35], v20 offset:32768
    v_mfma_f32_16x16x32_bf16 v[84:87], a[108:111], v[40:43], v[84:87]
    s_waitcnt lgkmcnt(5)
    v_mfma_f32_16x16x32_bf16 v[88:91], a[104:107], v[44:47], v[88:91]
    ds_read_b128 v[36:39], v20 offset:36864
    v_mfma_f32_16x16x32_bf16 v[92:95], a[108:111], v[44:47], v[92:95]
    s_waitcnt lgkmcnt(5)
    v_mfma_f32_16x16x32_bf16 v[80:83], a[112:115], v[48:51], v[80:83]
    ds_read_b128 v[40:43], v21 offset:32768
    v_mfma_f32_16x16x32_bf16 v[84:87], a[116:119], v[48:51], v[84:87]
    s_add_u32 m0, s21, 33792
    s_xor_b32 s20, s23, 1024
    buffer_load_dwordx4 v7, s[8:11], s20 offen lds
    s_waitcnt lgkmcnt(5)
    v_mfma_f32_16x16x32_bf16 v[88:91], a[112:115], v[52:55], v[88:91]
    ds_read_b128 v[44:47], v21 offset:36864
    v_mfma_f32_16x16x32_bf16 v[92:95], a[116:119], v[52:55], v[92:95]
    s_waitcnt lgkmcnt(5)
    v_mfma_f32_16x16x32_bf16 v[80:83], a[120:123], v[56:59], v[80:83]
    ds_read_b128 v[48:51], v22 offset:32768
    v_mfma_f32_16x16x32_bf16 v[84:87], a[124:127], v[56:59], v[84:87]
    s_waitcnt lgkmcnt(5)
    v_mfma_f32_16x16x32_bf16 v[88:91], a[120:123], v[60:63], v[88:91]
    ds_read_b128 v[52:55], v22 offset:36864
    v_mfma_f32_16x16x32_bf16 v[92:95], a[124:127], v[60:63], v[92:95]
    s_add_u32 m0, s21, 40960
    s_xor_b32 s20, s23, 1280
    buffer_load_dwordx4 v6, s[8:11], s20 offen lds
    s_waitcnt lgkmcnt(5)
    v_mfma_f32_16x16x32_bf16 v[80:83], a[128:131], v[32:35], v[80:83]
    ds_read_b128 v[56:59], v23 offset:32768
    v_mfma_f32_16x16x32_bf16 v[84:87], a[132:135], v[32:35], v[84:87]
    s_waitcnt lgkmcnt(5)
    v_mfma_f32_16x16x32_bf16 v[88:91], a[128:131], v[36:39], v[88:91]
    ds_read_b128 v[60:63], v23 offset:36864
    v_mfma_f32_16x16x32_bf16 v[92:95], a[132:135], v[36:39], v[92:95]
    s_waitcnt lgkmcnt(5)
    v_mfma_f32_16x16x32_bf16 v[80:83], a[136:139], v[40:43], v[80:83]
    ds_read_b128 v[32:35], v20 offset:40960
    v_mfma_f32_16x16x32_bf16 v[84:87], a[140:143], v[40:43], v[84:87]
    s_add_u32 m0, s21, 41984
    s_xor_b32 s20, s23, 1280
    buffer_load_dwordx4 v7, s[8:11], s20 offen lds
    s_waitcnt lgkmcnt(5)
    v_mfma_f32_16x16x32_bf16 v[88:91], a[136:139], v[44:47], v[88:91]
    ds_read_b128 v[36:39], v20 offset:45056
    v_mfma_f32_16x16x32_bf16 v[92:95], a[140:143], v[44:47], v[92:95]
    s_waitcnt lgkmcnt(5)
    v_mfma_f32_16x16x32_bf16 v[80:83], a[144:147], v[48:51], v[80:83]
    ds_read_b128 v[40:43], v21 offset:40960
    v_mfma_f32_16x16x32_bf16 v[84:87], a[148:151], v[48:51], v[84:87]
    s_waitcnt lgkmcnt(5)
    v_mfma_f32_16x16x32_bf16 v[88:91], a[144:147], v[52:55], v[88:91]
    ds_read_b128 v[44:47], v21 offset:45056
    v_mfma_f32_16x16x32_bf16 v[92:95], a[148:151], v[52:55], v[92:95]
    s_add_u32 m0, s21, 49152
    s_xor_b32 s20, s23, 1536
    buffer_load_dwordx4 v6, s[8:11], s20 offen lds
    s_waitcnt lgkmcnt(5)
    v_mfma_f32_16x16x32_bf16 v[80:83], a[152:155], v[56:59], v[80:83]
    ds_read_b128 v[48:51], v22 offset:40960
    v_mfma_f32_16x16x32_bf16 v[84:87], a[156:159], v[56:59], v[84:87]
    s_waitcnt lgkmcnt(5)
    v_mfma_f32_16x16x32_bf16 v[88:91], a[152:155], v[60:63], v[88:91]
    ds_read_b128 v[52:55], v22 offset:45056
    v_mfma_f32_16x16x32_bf16 v[92:95], a[156:159], v[60:63], v[92:95]
    s_waitcnt lgkmcnt(5)
    v_mfma_f32_16x16x32_bf16 v[80:83], a[160:163], v[32:35], v[80:83]
    ds_read_b128 v[56:59], v23 offset:40960
    v_mfma_f32_16x16x32_bf16 v[84:87], a[164:167], v[32:35], v[84:87]
    s_add_u32 m0, s21, 50176
    s_xor_b32 s20, s23, 1536
    buffer_load_dwordx4 v7, s[8:11], s20 offen lds
    s_waitcnt lgkmcnt(5)
    v_mfma_f32_16x16x32_bf16 v[88:91], a[160:163], v[36:39], v[88:91]
    ds_read_b128 v[60:63], v23 offset:45056
    v_mfma_f32_16x16x32_bf16 v[92:95], a[164:167], v[36:39], v[92:95]
    s_waitcnt lgkmcnt(5)
    v_mfma_f32_16x16x32_bf16 v[80:83], a[168:171], v[40:43], v[80:83]
    ds_read_b128 v[32:35], v20 offset:49152
    v_mfma_f32_16x16x32_bf16 v[84:87], a[172:175], v[40:43], v[84:87]
    s_waitcnt lgkmcnt(5)
    v_mfma_f32_16x16x32_bf16 v[88:91], a[168:171], v[44:47], v[88:91]
    ds_read_b128 v[36:39], v20 offset:53248
    v_mfma_f32_16x16x32_bf16 v[92:95], a[172:175], v[44:47], v[92:95]
    s_add_u32 m0, s21, 57344
    s_xor_b32 s20, s23, 1792
    buffer_load_dwordx4 v6, s[8:11], s20 offen lds
    s_waitcnt lgkmcnt(5)
    v_mfma_f32_16x16x32_bf16 v[80:83], a[176:179], v[48:51], v[80:83]
    ds_read_b128 v[40:43], v21 offset:49152
    v_mfma_f32_16x16x32_bf16 v[84:87], a[180:183], v[48:51], v[84:87]
    s_waitcnt lgkmcnt(5)
    v_mfma_f32_16x16x32_bf16 v[88:91], a[176:179], v[52:55], v[88:91]
    ds_read_b128 v[44:47], v21 offset:53248
    v_mfma_f32_16x16x32_bf16 v[92:95], a[180:183], v[52:55], v[92:95]
    s_waitcnt lgkmcnt(5)
    v_mfma_f32_16x16x32_bf16 v[80:83], a[184:187], v[56:59], v[80:83]
    ds_read_b128 v[48:51], v22 offset:49152
    v_mfma_f32_16x16x32_bf16 v[84:87], a[188:191], v[56:59], v[84:87]
    s_add_u32 m0, s21, 58368
    s_xor_b32 s20, s23, 1792
    buffer_load_dwordx4 v7, s[8:11], s20 offen lds
    s_waitcnt lgkmcnt(5)
    v_mfma_f32_16x16x32_bf16 v[88:91], a[184:187], v[60:63], v[88:91]
    ds_read_b128 v[52:55], v22 offset:53248
    v_mfma_f32_16x16x32_bf16 v[92:95], a[188:191], v[60:63], v[92:95]
    s_waitcnt lgkmcnt(5)
    v_mfma_f32_16x16x32_bf16 v[80:83], a[192:195], v[32:35], v[80:83]
    ds_read_b128 v[56:59], v23 offset:49152
    v_mfma_f32_16x16x32_bf16 v[84:87], a[196:199], v[32:35], v[84:87]
    s_waitcnt lgkmcnt(5)
    v_mfma_f32_16x16x32_bf16 v[88:91], a[192:195], v[36:39], v[88:91]
    ds_read_b128 v[60:63], v23 offset:53248
    v_mfma_f32_16x16x32_bf16 v[92:95], a[196:199], v[36:39], v[92:95]
    s_waitcnt lgkmcnt(5)
    v_mfma_f32_16x16x32_bf16 v[80:83], a[200:203], v[40:43], v[80:83]
    ds_read_b128 v[32:35], v20 offset:57344
    v_mfma_f32_16x16x32_bf16 v[84:87], a[204:207], v[40:43], v[84:87]
    s_waitcnt lgkmcnt(5)
    v_mfma_f32_16x16x32_bf16 v[88:91], a[200:203], v[44:47], v[88:91]
    ds_read_b128 v[36:39], v20 offset:61440
    v_mfma_f32_16x16x32_bf16 v[92:95], a[204:207], v[44:47], v[92:95]
    s_waitcnt lgkmcnt(5)
    v_mfma_f32_16x16x32_bf16 v[80:83], a[208:211], v[48:51], v[80:83]
    ds_read_b128 v[40:43], v21 offset:57344
    v_mfma_f32_16x16x32_bf16 v[84:87], a[212:215], v[48:51], v[84:87]
    s_waitcnt lgkmcnt(5)
    v_mfma_f32_16x16x32_bf16 v[88:91], a[208:211], v[52:55], v[88:91]
    ds_read_b128 v[44:47], v21 offset:61440
    v_mfma_f32_16x16x32_bf16 v[92:95], a[212:215], v[52:55], v[92:95]
    s_waitcnt lgkmcnt(5)
    v_mfma_f32_16x16x32_bf16 v[80:83], a[216:219], v[56:59], v[80:83]
    ds_read_b128 v[48:51], v22 offset:57344
    v_mfma_f32_16x16x32_bf16 v[84:87], a[220:223], v[56:59], v[84:87]
    s_waitcnt lgkmcnt(5)
    v_mfma_f32_16x16x32_bf16 v[88:91], a[216:219], v[60:63], v[88:91]
    ds_read_b128 v[52:55], v22 offset:61440
    v_mfma_f32_16x16x32_bf16 v[92:95], a[220:223], v[60:63], v[92:95]
    s_waitcnt vmcnt(8)
    s_barrier
    s_waitcnt lgkmcnt(5)
    v_mfma_f32_16x16x32_bf16 v[80:83], a[224:227], v[32:35], v[80:83]
    ds_read_b128 v[56:59], v23 offset:57344
    v_mfma_f32_16x16x32_bf16 v[84:87], a[228:231], v[32:35], v[84:87]
    s_waitcnt lgkmcnt(5)
    v_mfma_f32_16x16x32_bf16 v[88:91], a[224:227], v[36:39], v[88:91]
    ds_read_b128 v[60:63], v23 offset:61440
    v_mfma_f32_16x16x32_bf16 v[92:95], a[228:231], v[36:39], v[92:95]
    s_add_u32 s23, s23, 131072
    s_add_u32 m0, s21, 65536
    s_xor_b32 s20, s23, 0
    buffer_load_dwordx4 v6, s[8:11], s20 offen lds
    s_waitcnt lgkmcnt(5)
    v_mfma_f32_16x16x32_bf16 v[80:83], a[232:235], v[40:43], v[80:83]
    ds_read_b128 v[32:35], v16 offset:0
    v_mfma_f32_16x16x32_bf16 v[84:87], a[236:239], v[40:43], v[84:87]
    v_add_u32 v10, 1, v10
    buffer_store_dword v10, v9, s[84:87], 0 offen sc1
    s_waitcnt lgkmcnt(5)
    v_mfma_f32_16x16x32_bf16 v[88:91], a[232:235], v[44:47], v[88:91]
    ds_read_b128 v[36:39], v16 offset:4096
    v_mfma_f32_16x16x32_bf16 v[92:95], a[236:239], v[44:47], v[92:95]
    s_waitcnt lgkmcnt(5)
    v_mfma_f32_16x16x32_bf16 v[80:83], a[240:243], v[48:51], v[80:83]
    ds_read_b128 v[40:43], v17 offset:0
    v_mfma_f32_16x16x32_bf16 v[84:87], a[244:247], v[48:51], v[84:87]
    s_add_u32 m0, s21, 66560
    s_xor_b32 s20, s23, 0
    buffer_load_dwordx4 v7, s[8:11], s20 offen lds
    s_waitcnt lgkmcnt(5)
    v_mfma_f32_16x16x32_bf16 v[88:91], a[240:243], v[52:55], v[88:91]
    ds_read_b128 v[44:47], v17 offset:4096
    v_mfma_f32_16x16x32_bf16 v[92:95], a[244:247], v[52:55], v[92:95]
    s_waitcnt lgkmcnt(5)
    v_mfma_f32_16x16x32_bf16 v[80:83], a[248:251], v[56:59], v[80:83]
    ds_read_b128 v[48:51], v18 offset:0
    v_mfma_f32_16x16x32_bf16 v[84:87], a[252:255], v[56:59], v[84:87]
    s_waitcnt lgkmcnt(5)
    v_mfma_f32_16x16x32_bf16 v[88:91], a[248:251], v[60:63], v[88:91]
    ds_read_b128 v[52:55], v18 offset:4096
    v_mfma_f32_16x16x32_bf16 v[92:95], a[252:255], v[60:63], v[92:95]
    s_add_u32 m0, s21, 73728
    s_xor_b32 s20, s23, 256
    buffer_load_dwordx4 v6, s[8:11], s20 offen lds
    s_add_u32 s25, s25, 1
    s_cmp_lt_u32 s25, 16
    s_cbranch_scc1 mega_kernel_q_qk_loop
    s_nop 11
    v_cvt_pk_bf16_f32 v96, v80, v81
    v_cvt_pk_bf16_f32 v97, v82, v83
    v_cvt_pk_bf16_f32 v98, v84, v85
    v_cvt_pk_bf16_f32 v99, v86, v87
    buffer_store_dwordx4 v[96:99], v8, s[84:87], s24 offen offset:0 sc1
    v_cvt_pk_bf16_f32 v100, v88, v89
    v_cvt_pk_bf16_f32 v101, v90, v91
    v_cvt_pk_bf16_f32 v102, v92, v93
    v_cvt_pk_bf16_f32 v103, v94, v95
    buffer_store_dwordx4 v[100:103], v8, s[84:87], s24 offen offset:1024 sc1
    s_add_u32 s24, s24, 524288
    s_waitcnt vmcnt(0) lgkmcnt(0)
    s_barrier
    v_add_u32 v10, 1, v10
    buffer_store_dword v10, v9, s[84:87], 0 offen sc1
    s_branch mega_kernel_q_done
mega_kernel_q_v:
    ds_read_b128 v[32:35], v16 offset:0
    ds_read_b128 v[36:39], v16 offset:4096
    ds_read_b128 v[40:43], v17 offset:0
    ds_read_b128 v[44:47], v17 offset:4096
    ds_read_b128 v[48:51], v18 offset:0
    ds_read_b128 v[52:55], v18 offset:4096
    s_mov_b32 s25, 0
mega_kernel_q_v_loop:
    s_waitcnt lgkmcnt(5)
    v_mfma_f32_16x16x32_bf16 v[64:67], v[32:35], a[0:3], 0
    ds_read_b128 v[56:59], v19 offset:0
    v_mfma_f32_16x16x32_bf16 v[68:71], v[32:35], a[4:7], 0
    s_waitcnt lgkmcnt(5)
    v_mfma_f32_16x16x32_bf16 v[72:75], v[36:39], a[0:3], 0
    ds_read_b128 v[60:63], v19 offset:4096
    v_mfma_f32_16x16x32_bf16 v[76:79], v[36:39], a[4:7], 0
    s_waitcnt lgkmcnt(5)
    v_mfma_f32_16x16x32_bf16 v[64:67], v[40:43], a[8:11], v[64:67]
    ds_read_b128 v[32:35], v16 offset:8192
    v_mfma_f32_16x16x32_bf16 v[68:71], v[40:43], a[12:15], v[68:71]
    s_cmp_eq_u32 s25, 0
    s_cbranch_scc1 mega_kernel_q_v_sk2
    s_add_u32 m0, s21, 74752
    s_xor_b32 s20, s23, 256
    buffer_load_dwordx4 v7, s[8:11], s20 offen lds
mega_kernel_q_v_sk2:
    s_waitcnt lgkmcnt(5)
    v_mfma_f32_16x16x32_bf16 v[72:75], v[44:47], a[8:11], v[72:75]
    ds_read_b128 v[36:39], v16 offset:12288
    v_mfma_f32_16x16x32_bf16 v[76:79], v[44:47], a[12:15], v[76:79]
    s_waitcnt lgkmcnt(5)
    v_mfma_f32_16x16x32_bf16 v[64:67], v[48:51], a[16:19], v[64:67]
    ds_read_b128 v[40:43], v17 offset:8192
    v_mfma_f32_16x16x32_bf16 v[68:71], v[48:51], a[20:23], v[68:71]
    s_waitcnt lgkmcnt(5)
    v_mfma_f32_16x16x32_bf16 v[72:75], v[52:55], a[16:19], v[72:75]
    ds_read_b128 v[44:47], v17 offset:12288
    v_mfma_f32_16x16x32_bf16 v[76:79], v[52:55], a[20:23], v[76:79]
    s_cmp_eq_u32 s25, 0
    s_cbranch_scc1 mega_kernel_q_v_sk5
    s_add_u32 m0, s21, 81920
    s_xor_b32 s20, s23, 512
    buffer_load_dwordx4 v6, s[8:11], s20 offen lds
mega_kernel_q_v_sk5:
    s_waitcnt lgkmcnt(5)
    v_mfma_f32_16x16x32_bf16 v[64:67], v[56:59], a[24:27], v[64:67]
    ds_read_b128 v[48:51], v18 offset:8192
    v_mfma_f32_16x16x32_bf16 v[68:71], v[56:59], a[28:31], v[68:71]
    s_waitcnt lgkmcnt(5)
    v_mfma_f32_16x16x32_bf16 v[72:75], v[60:63], a[24:27], v[72:75]
    ds_read_b128 v[52:55], v18 offset:12288
    v_mfma_f32_16x16x32_bf16 v[76:79], v[60:63], a[28:31], v[76:79]
    s_waitcnt lgkmcnt(5)
    v_mfma_f32_16x16x32_bf16 v[64:67], v[32:35], a[32:35], v[64:67]
    ds_read_b128 v[56:59], v19 offset:8192
    v_mfma_f32_16x16x32_bf16 v[68:71], v[32:35], a[36:39], v[68:71]
    s_cmp_eq_u32 s25, 0
    s_cbranch_scc1 mega_kernel_q_v_sk8
    s_add_u32 m0, s21, 82944
    s_xor_b32 s20, s23, 512
    buffer_load_dwordx4 v7, s[8:11], s20 offen lds
mega_kernel_q_v_sk8:
    s_waitcnt lgkmcnt(5)
    v_mfma_f32_16x16x32_bf16 v[72:75], v[36:39], a[32:35], v[72:75]
    ds_read_b128 v[60:63], v19 offset:12288
    v_mfma_f32_16x16x32_bf16 v[76:79], v[36:39], a[36:39], v[76:79]
    s_waitcnt lgkmcnt(5)
    v_mfma_f32_16x16x32_bf16 v[64:67], v[40:43], a[40:43], v[64:67]
    ds_read_b128 v[32:35], v16 offset:16384
    v_mfma_f32_16x16x32_bf16 v[68:71], v[40:43], a[44:47], v[68:71]
    s_waitcnt lgkmcnt(5)
    v_mfma_f32_16x16x32_bf16 v[72:75], v[44:47], a[40:43], v[72:75]
    ds_read_b128 v[36:39], v16 offset:20480
    v_mfma_f32_16x16x32_bf16 v[76:79], v[44:47], a[44:47], v[76:79]
    s_cmp_eq_u32 s25, 0
    s_cbranch_scc1 mega_kernel_q_v_sk11
    s_add_u32 m0, s21, 90112
    s_xor_b32 s20, s23, 768
    buffer_load_dwordx4 v6, s[8:11], s20 offen lds
mega_kernel_q_v_sk11:
    s_waitcnt lgkmcnt(5)
    v_mfma_f32_16x16x32_bf16 v[64:67], v[48:51], a[48:51], v[64:67]
    ds_read_b128 v[40:43], v17 offset:16384
    v_mfma_f32_16x16x32_bf16 v[68:71], v[48:51], a[52:55], v[68:71]
    s_waitcnt lgkmcnt(5)
    v_mfma_f32_16x16x32_bf16 v[72:75], v[52:55], a[48:51], v[72:75]
    ds_read_b128 v[44:47], v17 offset:20480
    v_mfma_f32_16x16x32_bf16 v[76:79], v[52:55], a[52:55], v[76:79]
    s_waitcnt lgkmcnt(5)
    v_mfma_f32_16x16x32_bf16 v[64:67], v[56:59], a[56:59], v[64:67]
    ds_read_b128 v[48:51], v18 offset:16384
    v_mfma_f32_16x16x32_bf16 v[68:71], v[56:59], a[60:63], v[68:71]
    s_cmp_eq_u32 s25, 0
    s_cbranch_scc1 mega_kernel_q_v_sk14
    s_add_u32 m0, s21, 91136
    s_xor_b32 s20, s23, 768
    buffer_load_dwordx4 v7, s[8:11], s20 offen lds
mega_kernel_q_v_sk14:
    s_waitcnt lgkmcnt(5)
    v_mfma_f32_16x16x32_bf16 v[72:75], v[60:63], a[56:59], v[72:75]
    ds_read_b128 v[52:55], v18 offset:20480
    v_mfma_f32_16x16x32_bf16 v[76:79], v[60:63], a[60:63], v[76:79]
    s_cmp_eq_u32 s25, 0
    s_cbranch_scc1 mega_kernel_q_v_ne0
    v_cvt_pk_bf16_f32 v96, v80, v81
    v_cvt_pk_bf16_f32 v97, v82, v83
mega_kernel_q_v_ne0:
    s_waitcnt lgkmcnt(5)
    v_mfma_f32_16x16x32_bf16 v[64:67], v[32:35], a[64:67], v[64:67]
    ds_read_b128 v[56:59], v19 offset:16384
    v_mfma_f32_16x16x32_bf16 v[68:71], v[32:35], a[68:71], v[68:71]
    s_cmp_eq_u32 s25, 0
    s_cbranch_scc1 mega_kernel_q_v_ne1
    v_cvt_pk_bf16_f32 v98, v88, v89
    v_cvt_pk_bf16_f32 v99, v90, v91
mega_kernel_q_v_ne1:
    s_waitcnt lgkmcnt(5)
    v_mfma_f32_16x16x32_bf16 v[72:75], v[36:39], a[64:67], v[72:75]
    ds_read_b128 v[60:63], v19 offset:20480
    v_mfma_f32_16x16x32_bf16 v[76:79], v[36:39], a[68:71], v[76:79]
    s_cmp_eq_u32 s25, 0
    s_cbranch_scc1 mega_kernel_q_v_ne2
    buffer_store_dwordx4 v[96:99], v8, s[84:87], s24 offen offset:0 sc1
    v_cvt_pk_bf16_f32 v100, v84, v85
mega_kernel_q_v_ne2:
    s_waitcnt lgkmcnt(5)
    v_mfma_f32_16x16x32_bf16 v[64:67], v[40:43], a[72:75], v[64:67]
    ds_read_b128 v[32:35], v16 offset:24576
    v_mfma_f32_16x16x32_bf16 v[68:71], v[40:43], a[76:79], v[68:71]
    s_cmp_eq_u32 s25, 0
    s_cbranch_scc1 mega_kernel_q_v_ne3
    v_cvt_pk_bf16_f32 v101, v86, v87
    v_cvt_pk_bf16_f32 v102, v92, v93
mega_kernel_q_v_ne3:
    s_waitcnt lgkmcnt(5)
    v_mfma_f32_16x16x32_bf16 v[72:75], v[44:47], a[72:75], v[72:75]
    ds_read_b128 v[36:39], v16 offset:28672
    v_mfma_f32_16x16x32_bf16 v[76:79], v[44:47], a[76:79], v[76:79]
    s_cmp_eq_u32 s25, 0
    s_cbranch_scc1 mega_kernel_q_v_ne4
    v_cvt_pk_bf16_f32 v103, v94, v95
    buffer_store_dwordx4 v[100:103], v8, s[84:87], s24 offen offset:1024 sc1
mega_kernel_q_v_ne4:
    s_waitcnt lgkmcnt(5)
    v_mfma_f32_16x16x32_bf16 v[64:67], v[48:51], a[80:83], v[64:67]
    ds_read_b128 v[40:43], v17 offset:24576
    v_mfma_f32_16x16x32_bf16 v[68:71], v[48:51], a[84:87], v[68:71]
    s_cmp_eq_u32 s25, 0
    s_cbranch_scc1 mega_kernel_q_v_ne5
    s_add_u32 s24, s24, 524288
mega_kernel_q_v_ne5:
    s_waitcnt lgkmcnt(5)
    v_mfma_f32_16x16x32_bf16 v[72:75], v[52:55], a[80:83], v[72:75]
    ds_read_b128 v[44:47], v17 offset:28672
    v_mfma_f32_16x16x32_bf16 v[76:79], v[52:55], a[84:87], v[76:79]
    s_waitcnt lgkmcnt(5)
    v_mfma_f32_16x16x32_bf16 v[64:67], v[56:59], a[88:91], v[64:67]
    ds_read_b128 v[48:51], v18 offset:24576
    v_mfma_f32_16x16x32_bf16 v[68:71], v[56:59], a[92:95], v[68:71]
    s_cmp_lg_u32 s25, 2
    s_cbranch_scc1 mega_kernel_q_v_nx
    v_lshlrev_b32 v242, 7, v0
    v_min_u32 v242, 21888, v242
    s_mul_i32 s46, s92, 21888
    buffer_load_dword v240, v242, s[8:11], s46 offen
mega_kernel_q_v_nx:
    s_waitcnt lgkmcnt(5)
    v_mfma_f32_16x16x32_bf16 v[72:75], v[60:63], a[88:91], v[72:75]
    ds_read_b128 v[52:55], v18 offset:28672
    v_mfma_f32_16x16x32_bf16 v[76:79], v[60:63], a[92:95], v[76:79]
    s_waitcnt vmcnt(8)
    s_barrier
    s_waitcnt lgkmcnt(5)
    v_mfma_f32_16x16x32_bf16 v[64:67], v[32:35], a[96:99], v[64:67]
    ds_read_b128 v[56:59], v19 offset:24576
    v_mfma_f32_16x16x32_bf16 v[68:71], v[32:35], a[100:103], v[68:71]
    s_waitcnt lgkmcnt(5)
    v_mfma_f32_16x16x32_bf16 v[72:75], v[36:39], a[96:99], v[72:75]
    ds_read_b128 v[60:63], v19 offset:28672
    v_mfma_f32_16x16x32_bf16 v[76:79], v[36:39], a[100:103], v[76:79]
    s_add_u32 m0, s21, 98304
    s_xor_b32 s20, s23, 1024
    buffer_load_dwordx4 v6, s[8:11], s20 offen lds
    s_waitcnt lgkmcnt(5)
    v_mfma_f32_16x16x32_bf16 v[64:67], v[40:43], a[104:107], v[64:67]
    ds_read_b128 v[32:35], v16 offset:32768
    v_mfma_f32_16x16x32_bf16 v[68:71], v[40:43], a[108:111], v[68:71]
    s_waitcnt lgkmcnt(5)
    v_mfma_f32_16x16x32_bf16 v[72:75], v[44:47], a[104:107], v[72:75]
    ds_read_b128 v[36:39], v16 offset:36864
    v_mfma_f32_16x16x32_bf16 v[76:79], v[44:47], a[108:111], v[76:79]
    s_waitcnt lgkmcnt(5)
    v_mfma_f32_16x16x32_bf16 v[64:67], v[48:51], a[112:115], v[64:67]
    ds_read_b128 v[40:43], v17 offset:32768
    v_mfma_f32_16x16x32_bf16 v[68:71], v[48:51], a[116:119], v[68:71]
    s_add_u32 m0, s21, 99328
    s_xor_b32 s20, s23, 1024
    buffer_load_dwordx4 v7, s[8:11], s20 offen lds
    s_waitcnt lgkmcnt(5)
    v_mfma_f32_16x16x32_bf16 v[72:75], v[52:55], a[112:115], v[72:75]
    ds_read_b128 v[44:47], v17 offset:36864
    v_mfma_f32_16x16x32_bf16 v[76:79], v[52:55], a[116:119], v[76:79]
    s_waitcnt lgkmcnt(5)
    v_mfma_f32_16x16x32_bf16 v[64:67], v[56:59], a[120:123], v[64:67]
    ds_read_b128 v[48:51], v18 offset:32768
    v_mfma_f32_16x16x32_bf16 v[68:71], v[56:59], a[124:127], v[68:71]
    s_waitcnt lgkmcnt(5)
    v_mfma_f32_16x16x32_bf16 v[72:75], v[60:63], a[120:123], v[72:75]
    ds_read_b128 v[52:55], v18 offset:36864
    v_mfma_f32_16x16x32_bf16 v[76:79], v[60:63], a[124:127], v[76:79]
    s_add_u32 m0, s21, 106496
    s_xor_b32 s20, s23, 1280
    buffer_load_dwordx4 v6, s[8:11], s20 offen lds
    s_waitcnt lgkmcnt(5)
    v_mfma_f32_16x16x32_bf16 v[64:67], v[32:35], a[128:131], v[64:67]
    ds_read_b128 v[56:59], v19 offset:32768
    v_mfma_f32_16x16x32_bf16 v[68:71], v[32:35], a[132:135], v[68:71]
    s_waitcnt lgkmcnt(5)
    v_mfma_f32_16x16x32_bf16 v[72:75], v[36:39], a[128:131], v[72:75]
    ds_read_b128 v[60:63], v19 offset:36864
    v_mfma_f32_16x16x32_bf16 v[76:79], v[36:39], a[132:135], v[76:79]
    s_waitcnt lgkmcnt(5)
    v_mfma_f32_16x16x32_bf16 v[64:67], v[40:43], a[136:139], v[64:67]
    ds_read_b128 v[32:35], v16 offset:40960
    v_mfma_f32_16x16x32_bf16 v[68:71], v[40:43], a[140:143], v[68:71]
    s_add_u32 m0, s21, 107520
    s_xor_b32 s20, s23, 1280
    buffer_load_dwordx4 v7, s[8:11], s20 offen lds
    s_waitcnt lgkmcnt(5)
    v_mfma_f32_16x16x32_bf16 v[72:75], v[44:47], a[136:139], v[72:75]
    ds_read_b128 v[36:39], v16 offset:45056
    v_mfma_f32_16x16x32_bf16 v[76:79], v[44:47], a[140:143], v[76:79]
    s_waitcnt lgkmcnt(5)
    v_mfma_f32_16x16x32_bf16 v[64:67], v[48:51], a[144:147], v[64:67]
    ds_read_b128 v[40:43], v17 offset:40960
    v_mfma_f32_16x16x32_bf16 v[68:71], v[48:51], a[148:151], v[68:71]
    s_waitcnt lgkmcnt(5)
    v_mfma_f32_16x16x32_bf16 v[72:75], v[52:55], a[144:147], v[72:75]
    ds_read_b128 v[44:47], v17 offset:45056
    v_mfma_f32_16x16x32_bf16 v[76:79], v[52:55], a[148:151], v[76:79]
    s_add_u32 m0, s21, 114688
    s_xor_b32 s20, s23, 1536
    buffer_load_dwordx4 v6, s[8:11], s20 offen lds
    s_waitcnt lgkmcnt(5)
    v_mfma_f32_16x16x32_bf16 v[64:67], v[56:59], a[152:155], v[64:67]
    ds_read_b128 v[48:51], v18 offset:40960
    v_mfma_f32_16x16x32_bf16 v[68:71], v[56:59], a[156:159], v[68:71]
    s_waitcnt lgkmcnt(5)
    v_mfma_f32_16x16x32_bf16 v[72:75], v[60:63], a[152:155], v[72:75]
    ds_read_b128 v[52:55], v18 offset:45056
    v_mfma_f32_16x16x32_bf16 v[76:79], v[60:63], a[156:159], v[76:79]
    s_waitcnt lgkmcnt(5)
    v_mfma_f32_16x16x32_bf16 v[64:67], v[32:35], a[160:163], v[64:67]
    ds_read_b128 v[56:59], v19 offset:40960
    v_mfma_f32_16x16x32_bf16 v[68:71], v[32:35], a[164:167], v[68:71]
    s_add_u32 m0, s21, 115712
    s_xor_b32 s20, s23, 1536
    buffer_load_dwordx4 v7, s[8:11], s20 offen lds
    s_waitcnt lgkmcnt(5)
    v_mfma_f32_16x16x32_bf16 v[72:75], v[36:39], a[160:163], v[72:75]
    ds_read_b128 v[60:63], v19 offset:45056
    v_mfma_f32_16x16x32_bf16 v[76:79], v[36:39], a[164:167], v[76:79]
    s_waitcnt lgkmcnt(5)
    v_mfma_f32_16x16x32_bf16 v[64:67], v[40:43], a[168:171], v[64:67]
    ds_read_b128 v[32:35], v16 offset:49152
    v_mfma_f32_16x16x32_bf16 v[68:71], v[40:43], a[172:175], v[68:71]
    s_waitcnt lgkmcnt(5)
    v_mfma_f32_16x16x32_bf16 v[72:75], v[44:47], a[168:171], v[72:75]
    ds_read_b128 v[36:39], v16 offset:53248
    v_mfma_f32_16x16x32_bf16 v[76:79], v[44:47], a[172:175], v[76:79]
    s_add_u32 m0, s21, 122880
    s_xor_b32 s20, s23, 1792
    buffer_load_dwordx4 v6, s[8:11], s20 offen lds
    s_waitcnt lgkmcnt(5)
    v_mfma_f32_16x16x32_bf16 v[64:67], v[48:51], a[176:179], v[64:67]
    ds_read_b128 v[40:43], v17 offset:49152
    v_mfma_f32_16x16x32_bf16 v[68:71], v[48:51], a[180:183], v[68:71]
    s_waitcnt lgkmcnt(5)
    v_mfma_f32_16x16x32_bf16 v[72:75], v[52:55], a[176:179], v[72:75]
    ds_read_b128 v[44:47], v17 offset:53248
    v_mfma_f32_16x16x32_bf16 v[76:79], v[52:55], a[180:183], v[76:79]
    s_waitcnt lgkmcnt(5)
    v_mfma_f32_16x16x32_bf16 v[64:67], v[56:59], a[184:187], v[64:67]
    ds_read_b128 v[48:51], v18 offset:49152
    v_mfma_f32_16x16x32_bf16 v[68:71], v[56:59], a[188:191], v[68:71]
    s_add_u32 m0, s21, 123904
    s_xor_b32 s20, s23, 1792
    buffer_load_dwordx4 v7, s[8:11], s20 offen lds
    s_waitcnt lgkmcnt(5)
    v_mfma_f32_16x16x32_bf16 v[72:75], v[60:63], a[184:187], v[72:75]
    ds_read_b128 v[52:55], v18 offset:53248
    v_mfma_f32_16x16x32_bf16 v[76:79], v[60:63], a[188:191], v[76:79]
    s_waitcnt lgkmcnt(5)
    v_mfma_f32_16x16x32_bf16 v[64:67], v[32:35], a[192:195], v[64:67]
    ds_read_b128 v[56:59], v19 offset:49152
    v_mfma_f32_16x16x32_bf16 v[68:71], v[32:35], a[196:199], v[68:71]
    s_waitcnt lgkmcnt(5)
    v_mfma_f32_16x16x32_bf16 v[72:75], v[36:39], a[192:195], v[72:75]
    ds_read_b128 v[60:63], v19 offset:53248
    v_mfma_f32_16x16x32_bf16 v[76:79], v[36:39], a[196:199], v[76:79]
    s_waitcnt lgkmcnt(5)
    v_mfma_f32_16x16x32_bf16 v[64:67], v[40:43], a[200:203], v[64:67]
    ds_read_b128 v[32:35], v16 offset:57344
    v_mfma_f32_16x16x32_bf16 v[68:71], v[40:43], a[204:207], v[68:71]
    s_waitcnt lgkmcnt(5)
    v_mfma_f32_16x16x32_bf16 v[72:75], v[44:47], a[200:203], v[72:75]
    ds_read_b128 v[36:39], v16 offset:61440
    v_mfma_f32_16x16x32_bf16 v[76:79], v[44:47], a[204:207], v[76:79]
    s_waitcnt lgkmcnt(5)
    v_mfma_f32_16x16x32_bf16 v[64:67], v[48:51], a[208:211], v[64:67]
    ds_read_b128 v[40:43], v17 offset:57344
    v_mfma_f32_16x16x32_bf16 v[68:71], v[48:51], a[212:215], v[68:71]
    s_waitcnt lgkmcnt(5)
    v_mfma_f32_16x16x32_bf16 v[72:75], v[52:55], a[208:211], v[72:75]
    ds_read_b128 v[44:47], v17 offset:61440
    v_mfma_f32_16x16x32_bf16 v[76:79], v[52:55], a[212:215], v[76:79]
    s_waitcnt lgkmcnt(5)
    v_mfma_f32_16x16x32_bf16 v[64:67], v[56:59], a[216:219], v[64:67]
    ds_read_b128 v[48:51], v18 offset:57344
    v_mfma_f32_16x16x32_bf16 v[68:71], v[56:59], a[220:223], v[68:71]
    s_waitcnt lgkmcnt(5)
    v_mfma_f32_16x16x32_bf16 v[72:75], v[60:63], a[216:219], v[72:75]
    ds_read_b128 v[52:55], v18 offset:61440
    v_mfma_f32_16x16x32_bf16 v[76:79], v[60:63], a[220:223], v[76:79]
    s_waitcnt vmcnt(8)
    s_barrier
    s_waitcnt lgkmcnt(5)
    v_mfma_f32_16x16x32_bf16 v[64:67], v[32:35], a[224:227], v[64:67]
    ds_read_b128 v[56:59], v19 offset:57344
    v_mfma_f32_16x16x32_bf16 v[68:71], v[32:35], a[228:231], v[68:71]
    s_waitcnt lgkmcnt(5)
    v_mfma_f32_16x16x32_bf16 v[72:75], v[36:39], a[224:227], v[72:75]
    ds_read_b128 v[60:63], v19 offset:61440
    v_mfma_f32_16x16x32_bf16 v[76:79], v[36:39], a[228:231], v[76:79]
    s_add_u32 s23, s23, 131072
    s_add_u32 m0, s21, 0
    s_xor_b32 s20, s23, 0
    buffer_load_dwordx4 v6, s[8:11], s20 offen lds
    s_waitcnt lgkmcnt(5)
    v_mfma_f32_16x16x32_bf16 v[64:67], v[40:43], a[232:235], v[64:67]
    ds_read_b128 v[32:35], v20 offset:0
    v_mfma_f32_16x16x32_bf16 v[68:71], v[40:43], a[236:239], v[68:71]
    s_cmp_eq_u32 s25, 0
    s_cbranch_scc1 mega_kernel_q_v_nf
    v_add_u32 v10, 1, v10
    buffer_store_dword v10, v9, s[84:87], 0 offen sc1
mega_kernel_q_v_nf:
    s_waitcnt lgkmcnt(5)
    v_mfma_f32_16x16x32_bf16 v[72:75], v[44:47], a[232:235], v[72:75]
    ds_read_b128 v[36:39], v20 offset:4096
    v_mfma_f32_16x16x32_bf16 v[76:79], v[44:47], a[236:239], v[76:79]
    s_waitcnt lgkmcnt(5)
    v_mfma_f32_16x16x32_bf16 v[64:67], v[48:51], a[240:243], v[64:67]
    ds_read_b128 v[40:43], v21 offset:0
    v_mfma_f32_16x16x32_bf16 v[68:71], v[48:51], a[244:247], v[68:71]
    s_add_u32 m0, s21, 1024
    s_xor_b32 s20, s23, 0
    buffer_load_dwordx4 v7, s[8:11], s20 offen lds
    s_waitcnt lgkmcnt(5)
    v_mfma_f32_16x16x32_bf16 v[72:75], v[52:55], a[240:243], v[72:75]
    ds_read_b128 v[44:47], v21 offset:4096
    v_mfma_f32_16x16x32_bf16 v[76:79], v[52:55], a[244:247], v[76:79]
    s_waitcnt lgkmcnt(5)
    v_mfma_f32_16x16x32_bf16 v[64:67], v[56:59], a[248:251], v[64:67]
    ds_read_b128 v[48:51], v22 offset:0
    v_mfma_f32_16x16x32_bf16 v[68:71], v[56:59], a[252:255], v[68:71]
    s_waitcnt lgkmcnt(5)
    v_mfma_f32_16x16x32_bf16 v[72:75], v[60:63], a[248:251], v[72:75]
    ds_read_b128 v[52:55], v22 offset:4096
    v_mfma_f32_16x16x32_bf16 v[76:79], v[60:63], a[252:255], v[76:79]
    s_add_u32 m0, s21, 8192
    s_xor_b32 s20, s23, 256
    buffer_load_dwordx4 v6, s[8:11], s20 offen lds
    s_waitcnt lgkmcnt(5)
    v_mfma_f32_16x16x32_bf16 v[80:83], v[32:35], a[0:3], 0
    ds_read_b128 v[56:59], v23 offset:0
    v_mfma_f32_16x16x32_bf16 v[84:87], v[32:35], a[4:7], 0
    s_waitcnt lgkmcnt(5)
    v_mfma_f32_16x16x32_bf16 v[88:91], v[36:39], a[0:3], 0
    ds_read_b128 v[60:63], v23 offset:4096
    v_mfma_f32_16x16x32_bf16 v[92:95], v[36:39], a[4:7], 0
    s_waitcnt lgkmcnt(5)
    v_mfma_f32_16x16x32_bf16 v[80:83], v[40:43], a[8:11], v[80:83]
    ds_read_b128 v[32:35], v20 offset:8192
    v_mfma_f32_16x16x32_bf16 v[84:87], v[40:43], a[12:15], v[84:87]
    s_add_u32 m0, s21, 9216
    s_xor_b32 s20, s23, 256
    buffer_load_dwordx4 v7, s[8:11], s20 offen lds
    s_waitcnt lgkmcnt(5)
    v_mfma_f32_16x16x32_bf16 v[88:91], v[44:47], a[8:11], v[88:91]
    ds_read_b128 v[36:39], v20 offset:12288
    v_mfma_f32_16x16x32_bf16 v[92:95], v[44:47], a[12:15], v[92:95]
    s_waitcnt lgkmcnt(5)
    v_mfma_f32_16x16x32_bf16 v[80:83], v[48:51], a[16:19], v[80:83]
    ds_read_b128 v[40:43], v21 offset:8192
    v_mfma_f32_16x16x32_bf16 v[84:87], v[48:51], a[20:23], v[84:87]
    s_waitcnt lgkmcnt(5)
    v_mfma_f32_16x16x32_bf16 v[88:91], v[52:55], a[16:19], v[88:91]
    ds_read_b128 v[44:47], v21 offset:12288
    v_mfma_f32_16x16x32_bf16 v[92:95], v[52:55], a[20:23], v[92:95]
    s_add_u32 m0, s21, 16384
    s_xor_b32 s20, s23, 512
    buffer_load_dwordx4 v6, s[8:11], s20 offen lds
    s_waitcnt lgkmcnt(5)
    v_mfma_f32_16x16x32_bf16 v[80:83], v[56:59], a[24:27], v[80:83]
    ds_read_b128 v[48:51], v22 offset:8192
    v_mfma_f32_16x16x32_bf16 v[84:87], v[56:59], a[28:31], v[84:87]
    s_waitcnt lgkmcnt(5)
    v_mfma_f32_16x16x32_bf16 v[88:91], v[60:63], a[24:27], v[88:91]
    ds_read_b128 v[52:55], v22 offset:12288
    v_mfma_f32_16x16x32_bf16 v[92:95], v[60:63], a[28:31], v[92:95]
    s_waitcnt lgkmcnt(5)
    v_mfma_f32_16x16x32_bf16 v[80:83], v[32:35], a[32:35], v[80:83]
    ds_read_b128 v[56:59], v23 offset:8192
    v_mfma_f32_16x16x32_bf16 v[84:87], v[32:35], a[36:39], v[84:87]
    s_add_u32 m0, s21, 17408
    s_xor_b32 s20, s23, 512
    buffer_load_dwordx4 v7, s[8:11], s20 offen lds
    s_waitcnt lgkmcnt(5)
    v_mfma_f32_16x16x32_bf16 v[88:91], v[36:39], a[32:35], v[88:91]
    ds_read_b128 v[60:63], v23 offset:12288
    v_mfma_f32_16x16x32_bf16 v[92:95], v[36:39], a[36:39], v[92:95]
    s_waitcnt lgkmcnt(5)
    v_mfma_f32_16x16x32_bf16 v[80:83], v[40:43], a[40:43], v[80:83]
    ds_read_b128 v[32:35], v20 offset:16384
    v_mfma_f32_16x16x32_bf16 v[84:87], v[40:43], a[44:47], v[84:87]
    s_waitcnt lgkmcnt(5)
    v_mfma_f32_16x16x32_bf16 v[88:91], v[44:47], a[40:43], v[88:91]
    ds_read_b128 v[36:39], v20 offset:20480
    v_mfma_f32_16x16x32_bf16 v[92:95], v[44:47], a[44:47], v[92:95]
    s_add_u32 m0, s21, 24576
    s_xor_b32 s20, s23, 768
    buffer_load_dwordx4 v6, s[8:11], s20 offen lds
    s_waitcnt lgkmcnt(5)
    v_mfma_f32_16x16x32_bf16 v[80:83], v[48:51], a[48:51], v[80:83]
    ds_read_b128 v[40:43], v21 offset:16384
    v_mfma_f32_16x16x32_bf16 v[84:87], v[48:51], a[52:55], v[84:87]
    s_waitcnt lgkmcnt(5)
    v_mfma_f32_16x16x32_bf16 v[88:91], v[52:55], a[48:51], v[88:91]
    ds_read_b128 v[44:47], v21 offset:20480
    v_mfma_f32_16x16x32_bf16 v[92:95], v[52:55], a[52:55], v[92:95]
    s_waitcnt lgkmcnt(5)
    v_mfma_f32_16x16x32_bf16 v[80:83], v[56:59], a[56:59], v[80:83]
    ds_read_b128 v[48:51], v22 offset:16384
    v_mfma_f32_16x16x32_bf16 v[84:87], v[56:59], a[60:63], v[84:87]
    s_add_u32 m0, s21, 25600
    s_xor_b32 s20, s23, 768
    buffer_load_dwordx4 v7, s[8:11], s20 offen lds
    s_waitcnt lgkmcnt(5)
    v_mfma_f32_16x16x32_bf16 v[88:91], v[60:63], a[56:59], v[88:91]
    ds_read_b128 v[52:55], v22 offset:20480
    v_mfma_f32_16x16x32_bf16 v[92:95], v[60:63], a[60:63], v[92:95]
    v_cvt_pk_bf16_f32 v96, v64, v65
    v_cvt_pk_bf16_f32 v97, v66, v67
    s_waitcnt lgkmcnt(5)
    v_mfma_f32_16x16x32_bf16 v[80:83], v[32:35], a[64:67], v[80:83]
    ds_read_b128 v[56:59], v23 offset:16384
    v_mfma_f32_16x16x32_bf16 v[84:87], v[32:35], a[68:71], v[84:87]
    v_cvt_pk_bf16_f32 v98, v72, v73
    v_cvt_pk_bf16_f32 v99, v74, v75
    s_waitcnt lgkmcnt(5)
    v_mfma_f32_16x16x32_bf16 v[88:91], v[36:39], a[64:67], v[88:91]
    ds_read_b128 v[60:63], v23 offset:20480
    v_mfma_f32_16x16x32_bf16 v[92:95], v[36:39], a[68:71], v[92:95]
    buffer_store_dwordx4 v[96:99], v8, s[84:87], s24 offen offset:0 sc1
    v_cvt_pk_bf16_f32 v100, v68, v69
    s_waitcnt lgkmcnt(5)
    v_mfma_f32_16x16x32_bf16 v[80:83], v[40:43], a[72:75], v[80:83]
    ds_read_b128 v[32:35], v20 offset:24576
    v_mfma_f32_16x16x32_bf16 v[84:87], v[40:43], a[76:79], v[84:87]
    v_cvt_pk_bf16_f32 v101, v70, v71
    v_cvt_pk_bf16_f32 v102, v76, v77
    s_waitcnt lgkmcnt(5)
    v_mfma_f32_16x16x32_bf16 v[88:91], v[44:47], a[72:75], v[88:91]
    ds_read_b128 v[36:39], v20 offset:28672
    v_mfma_f32_16x16x32_bf16 v[92:95], v[44:47], a[76:79], v[92:95]
    v_cvt_pk_bf16_f32 v103, v78, v79
    buffer_store_dwordx4 v[100:103], v8, s[84:87], s24 offen offset:1024 sc1
    s_waitcnt lgkmcnt(5)
    v_mfma_f32_16x16x32_bf16 v[80:83], v[48:51], a[80:83], v[80:83]
    ds_read_b128 v[40:43], v21 offset:24576
    v_mfma_f32_16x16x32_bf16 v[84:87], v[48:51], a[84:87], v[84:87]
    s_add_u32 s24, s24, 524288
    s_waitcnt lgkmcnt(5)
    v_mfma_f32_16x16x32_bf16 v[88:91], v[52:55], a[80:83], v[88:91]
    ds_read_b128 v[44:47], v21 offset:28672
    v_mfma_f32_16x16x32_bf16 v[92:95], v[52:55], a[84:87], v[92:95]
    s_waitcnt lgkmcnt(5)
    v_mfma_f32_16x16x32_bf16 v[80:83], v[56:59], a[88:91], v[80:83]
    ds_read_b128 v[48:51], v22 offset:24576
    v_mfma_f32_16x16x32_bf16 v[84:87], v[56:59], a[92:95], v[84:87]
    s_waitcnt lgkmcnt(5)
    v_mfma_f32_16x16x32_bf16 v[88:91], v[60:63], a[88:91], v[88:91]
    ds_read_b128 v[52:55], v22 offset:28672
    v_mfma_f32_16x16x32_bf16 v[92:95], v[60:63], a[92:95], v[92:95]
    s_waitcnt vmcnt(8)
    s_barrier
    s_waitcnt lgkmcnt(5)
    v_mfma_f32_16x16x32_bf16 v[80:83], v[32:35], a[96:99], v[80:83]
    ds_read_b128 v[56:59], v23 offset:24576
    v_mfma_f32_16x16x32_bf16 v[84:87], v[32:35], a[100:103], v[84:87]
    s_waitcnt lgkmcnt(5)
    v_mfma_f32_16x16x32_bf16 v[88:91], v[36:39], a[96:99], v[88:91]
    ds_read_b128 v[60:63], v23 offset:28672
    v_mfma_f32_16x16x32_bf16 v[92:95], v[36:39], a[100:103], v[92:95]
    s_add_u32 m0, s21, 32768
    s_xor_b32 s20, s23, 1024
    buffer_load_dwordx4 v6, s[8:11], s20 offen lds
    s_waitcnt lgkmcnt(5)
    v_mfma_f32_16x16x32_bf16 v[80:83], v[40:43], a[104:107], v[80:83]
    ds_read_b128 v[32:35], v20 offset:32768
    v_mfma_f32_16x16x32_bf16 v[84:87], v[40:43], a[108:111], v[84:87]
    s_waitcnt lgkmcnt(5)
    v_mfma_f32_16x16x32_bf16 v[88:91], v[44:47], a[104:107], v[88:91]
    ds_read_b128 v[36:39], v20 offset:36864
    v_mfma_f32_16x16x32_bf16 v[92:95], v[44:47], a[108:111], v[92:95]
    s_waitcnt lgkmcnt(5)
    v_mfma_f32_16x16x32_bf16 v[80:83], v[48:51], a[112:115], v[80:83]
    ds_read_b128 v[40:43], v21 offset:32768
    v_mfma_f32_16x16x32_bf16 v[84:87], v[48:51], a[116:119], v[84:87]
    s_add_u32 m0, s21, 33792
    s_xor_b32 s20, s23, 1024
    buffer_load_dwordx4 v7, s[8:11], s20 offen lds
    s_waitcnt lgkmcnt(5)
    v_mfma_f32_16x16x32_bf16 v[88:91], v[52:55], a[112:115], v[88:91]
    ds_read_b128 v[44:47], v21 offset:36864
    v_mfma_f32_16x16x32_bf16 v[92:95], v[52:55], a[116:119], v[92:95]
    s_waitcnt lgkmcnt(5)
    v_mfma_f32_16x16x32_bf16 v[80:83], v[56:59], a[120:123], v[80:83]
    ds_read_b128 v[48:51], v22 offset:32768
    v_mfma_f32_16x16x32_bf16 v[84:87], v[56:59], a[124:127], v[84:87]
    s_waitcnt lgkmcnt(5)
    v_mfma_f32_16x16x32_bf16 v[88:91], v[60:63], a[120:123], v[88:91]
    ds_read_b128 v[52:55], v22 offset:36864
    v_mfma_f32_16x16x32_bf16 v[92:95], v[60:63], a[124:127], v[92:95]
    s_add_u32 m0, s21, 40960
    s_xor_b32 s20, s23, 1280
    buffer_load_dwordx4 v6, s[8:11], s20 offen lds
    s_waitcnt lgkmcnt(5)
    v_mfma_f32_16x16x32_bf16 v[80:83], v[32:35], a[128:131], v[80:83]
    ds_read_b128 v[56:59], v23 offset:32768
    v_mfma_f32_16x16x32_bf16 v[84:87], v[32:35], a[132:135], v[84:87]
    s_waitcnt lgkmcnt(5)
    v_mfma_f32_16x16x32_bf16 v[88:91], v[36:39], a[128:131], v[88:91]
    ds_read_b128 v[60:63], v23 offset:36864
    v_mfma_f32_16x16x32_bf16 v[92:95], v[36:39], a[132:135], v[92:95]
    s_waitcnt lgkmcnt(5)
    v_mfma_f32_16x16x32_bf16 v[80:83], v[40:43], a[136:139], v[80:83]
    ds_read_b128 v[32:35], v20 offset:40960
    v_mfma_f32_16x16x32_bf16 v[84:87], v[40:43], a[140:143], v[84:87]
    s_add_u32 m0, s21, 41984
    s_xor_b32 s20, s23, 1280
    buffer_load_dwordx4 v7, s[8:11], s20 offen lds
    s_waitcnt lgkmcnt(5)
    v_mfma_f32_16x16x32_bf16 v[88:91], v[44:47], a[136:139], v[88:91]
    ds_read_b128 v[36:39], v20 offset:45056
    v_mfma_f32_16x16x32_bf16 v[92:95], v[44:47], a[140:143], v[92:95]
    s_waitcnt lgkmcnt(5)
    v_mfma_f32_16x16x32_bf16 v[80:83], v[48:51], a[144:147], v[80:83]
    ds_read_b128 v[40:43], v21 offset:40960
    v_mfma_f32_16x16x32_bf16 v[84:87], v[48:51], a[148:151], v[84:87]
    s_waitcnt lgkmcnt(5)
    v_mfma_f32_16x16x32_bf16 v[88:91], v[52:55], a[144:147], v[88:91]
    ds_read_b128 v[44:47], v21 offset:45056
    v_mfma_f32_16x16x32_bf16 v[92:95], v[52:55], a[148:151], v[92:95]
    s_add_u32 m0, s21, 49152
    s_xor_b32 s20, s23, 1536
    buffer_load_dwordx4 v6, s[8:11], s20 offen lds
    s_waitcnt lgkmcnt(5)
    v_mfma_f32_16x16x32_bf16 v[80:83], v[56:59], a[152:155], v[80:83]
    ds_read_b128 v[48:51], v22 offset:40960
    v_mfma_f32_16x16x32_bf16 v[84:87], v[56:59], a[156:159], v[84:87]
    s_waitcnt lgkmcnt(5)
    v_mfma_f32_16x16x32_bf16 v[88:91], v[60:63], a[152:155], v[88:91]
    ds_read_b128 v[52:55], v22 offset:45056
    v_mfma_f32_16x16x32_bf16 v[92:95], v[60:63], a[156:159], v[92:95]
    s_waitcnt lgkmcnt(5)
    v_mfma_f32_16x16x32_bf16 v[80:83], v[32:35], a[160:163], v[80:83]
    ds_read_b128 v[56:59], v23 offset:40960
    v_mfma_f32_16x16x32_bf16 v[84:87], v[32:35], a[164:167], v[84:87]
    s_add_u32 m0, s21, 50176
    s_xor_b32 s20, s23, 1536
    buffer_load_dwordx4 v7, s[8:11], s20 offen lds
    s_waitcnt lgkmcnt(5)
    v_mfma_f32_16x16x32_bf16 v[88:91], v[36:39], a[160:163], v[88:91]
    ds_read_b128 v[60:63], v23 offset:45056
    v_mfma_f32_16x16x32_bf16 v[92:95], v[36:39], a[164:167], v[92:95]
    s_waitcnt lgkmcnt(5)
    v_mfma_f32_16x16x32_bf16 v[80:83], v[40:43], a[168:171], v[80:83]
    ds_read_b128 v[32:35], v20 offset:49152
    v_mfma_f32_16x16x32_bf16 v[84:87], v[40:43], a[172:175], v[84:87]
    s_waitcnt lgkmcnt(5)
    v_mfma_f32_16x16x32_bf16 v[88:91], v[44:47], a[168:171], v[88:91]
    ds_read_b128 v[36:39], v20 offset:53248
    v_mfma_f32_16x16x32_bf16 v[92:95], v[44:47], a[172:175], v[92:95]
    s_add_u32 m0, s21, 57344
    s_xor_b32 s20, s23, 1792
    buffer_load_dwordx4 v6, s[8:11], s20 offen lds
    s_waitcnt lgkmcnt(5)
    v_mfma_f32_16x16x32_bf16 v[80:83], v[48:51], a[176:179], v[80:83]
    ds_read_b128 v[40:43], v21 offset:49152
    v_mfma_f32_16x16x32_bf16 v[84:87], v[48:51], a[180:183], v[84:87]
    s_waitcnt lgkmcnt(5)
    v_mfma_f32_16x16x32_bf16 v[88:91], v[52:55], a[176:179], v[88:91]
    ds_read_b128 v[44:47], v21 offset:53248
    v_mfma_f32_16x16x32_bf16 v[92:95], v[52:55], a[180:183], v[92:95]
    s_waitcnt lgkmcnt(5)
    v_mfma_f32_16x16x32_bf16 v[80:83], v[56:59], a[184:187], v[80:83]
    ds_read_b128 v[48:51], v22 offset:49152
    v_mfma_f32_16x16x32_bf16 v[84:87], v[56:59], a[188:191], v[84:87]
    s_add_u32 m0, s21, 58368
    s_xor_b32 s20, s23, 1792
    buffer_load_dwordx4 v7, s[8:11], s20 offen lds
    s_waitcnt lgkmcnt(5)
    v_mfma_f32_16x16x32_bf16 v[88:91], v[60:63], a[184:187], v[88:91]
    ds_read_b128 v[52:55], v22 offset:53248
    v_mfma_f32_16x16x32_bf16 v[92:95], v[60:63], a[188:191], v[92:95]
    s_waitcnt lgkmcnt(5)
    v_mfma_f32_16x16x32_bf16 v[80:83], v[32:35], a[192:195], v[80:83]
    ds_read_b128 v[56:59], v23 offset:49152
    v_mfma_f32_16x16x32_bf16 v[84:87], v[32:35], a[196:199], v[84:87]
    s_waitcnt lgkmcnt(5)
    v_mfma_f32_16x16x32_bf16 v[88:91], v[36:39], a[192:195], v[88:91]
    ds_read_b128 v[60:63], v23 offset:53248
    v_mfma_f32_16x16x32_bf16 v[92:95], v[36:39], a[196:199], v[92:95]
    s_waitcnt lgkmcnt(5)
    v_mfma_f32_16x16x32_bf16 v[80:83], v[40:43], a[200:203], v[80:83]
    ds_read_b128 v[32:35], v20 offset:57344
    v_mfma_f32_16x16x32_bf16 v[84:87], v[40:43], a[204:207], v[84:87]
    s_waitcnt lgkmcnt(5)
    v_mfma_f32_16x16x32_bf16 v[88:91], v[44:47], a[200:203], v[88:91]
    ds_read_b128 v[36:39], v20 offset:61440
    v_mfma_f32_16x16x32_bf16 v[92:95], v[44:47], a[204:207], v[92:95]
    s_waitcnt lgkmcnt(5)
    v_mfma_f32_16x16x32_bf16 v[80:83], v[48:51], a[208:211], v[80:83]
    ds_read_b128 v[40:43], v21 offset:57344
    v_mfma_f32_16x16x32_bf16 v[84:87], v[48:51], a[212:215], v[84:87]
    s_waitcnt lgkmcnt(5)
    v_mfma_f32_16x16x32_bf16 v[88:91], v[52:55], a[208:211], v[88:91]
    ds_read_b128 v[44:47], v21 offset:61440
    v_mfma_f32_16x16x32_bf16 v[92:95], v[52:55], a[212:215], v[92:95]
    s_waitcnt lgkmcnt(5)
    v_mfma_f32_16x16x32_bf16 v[80:83], v[56:59], a[216:219], v[80:83]
    ds_read_b128 v[48:51], v22 offset:57344
    v_mfma_f32_16x16x32_bf16 v[84:87], v[56:59], a[220:223], v[84:87]
    s_waitcnt lgkmcnt(5)
    v_mfma_f32_16x16x32_bf16 v[88:91], v[60:63], a[216:219], v[88:91]
    ds_read_b128 v[52:55], v22 offset:61440
    v_mfma_f32_16x16x32_bf16 v[92:95], v[60:63], a[220:223], v[92:95]
    s_waitcnt vmcnt(8)
    s_barrier
    s_waitcnt lgkmcnt(5)
    v_mfma_f32_16x16x32_bf16 v[80:83], v[32:35], a[224:227], v[80:83]
    ds_read_b128 v[56:59], v23 offset:57344
    v_mfma_f32_16x16x32_bf16 v[84:87], v[32:35], a[228:231], v[84:87]
    s_waitcnt lgkmcnt(5)
    v_mfma_f32_16x16x32_bf16 v[88:91], v[36:39], a[224:227], v[88:91]
    ds_read_b128 v[60:63], v23 offset:61440
    v_mfma_f32_16x16x32_bf16 v[92:95], v[36:39], a[228:231], v[92:95]
    s_add_u32 s23, s23, 131072
    s_add_u32 m0, s21, 65536
    s_xor_b32 s20, s23, 0
    buffer_load_dwordx4 v6, s[8:11], s20 offen lds
    s_waitcnt lgkmcnt(5)
    v_mfma_f32_16x16x32_bf16 v[80:83], v[40:43], a[232:235], v[80:83]
    ds_read_b128 v[32:35], v16 offset:0
    v_mfma_f32_16x16x32_bf16 v[84:87], v[40:43], a[236:239], v[84:87]
    v_add_u32 v10, 1, v10
    buffer_store_dword v10, v9, s[84:87], 0 offen sc1
    s_waitcnt lgkmcnt(5)
    v_mfma_f32_16x16x32_bf16 v[88:91], v[44:47], a[232:235], v[88:91]
    ds_read_b128 v[36:39], v16 offset:4096
    v_mfma_f32_16x16x32_bf16 v[92:95], v[44:47], a[236:239], v[92:95]
    s_waitcnt lgkmcnt(5)
    v_mfma_f32_16x16x32_bf16 v[80:83], v[48:51], a[240:243], v[80:83]
    ds_read_b128 v[40:43], v17 offset:0
    v_mfma_f32_16x16x32_bf16 v[84:87], v[48:51], a[244:247], v[84:87]
    s_add_u32 m0, s21, 66560
    s_xor_b32 s20, s23, 0
    buffer_load_dwordx4 v7, s[8:11], s20 offen lds
    s_waitcnt lgkmcnt(5)
    v_mfma_f32_16x16x32_bf16 v[88:91], v[52:55], a[240:243], v[88:91]
    ds_read_b128 v[44:47], v17 offset:4096
    v_mfma_f32_16x16x32_bf16 v[92:95], v[52:55], a[244:247], v[92:95]
    s_waitcnt lgkmcnt(5)
    v_mfma_f32_16x16x32_bf16 v[80:83], v[56:59], a[248:251], v[80:83]
    ds_read_b128 v[48:51], v18 offset:0
    v_mfma_f32_16x16x32_bf16 v[84:87], v[56:59], a[252:255], v[84:87]
    s_waitcnt lgkmcnt(5)
    v_mfma_f32_16x16x32_bf16 v[88:91], v[60:63], a[248:251], v[88:91]
    ds_read_b128 v[52:55], v18 offset:4096
    v_mfma_f32_16x16x32_bf16 v[92:95], v[60:63], a[252:255], v[92:95]
    s_add_u32 m0, s21, 73728
    s_xor_b32 s20, s23, 256
    buffer_load_dwordx4 v6, s[8:11], s20 offen lds
    s_add_u32 s25, s25, 1
    s_cmp_lt_u32 s25, 16
    s_cbranch_scc1 mega_kernel_q_v_loop
    s_nop 11
    v_cvt_pk_bf16_f32 v96, v80, v81
    v_cvt_pk_bf16_f32 v97, v82, v83
    v_cvt_pk_bf16_f32 v98, v88, v89
    v_cvt_pk_bf16_f32 v99, v90, v91
    buffer_store_dwordx4 v[96:99], v8, s[84:87], s24 offen offset:0 sc1
    v_cvt_pk_bf16_f32 v100, v84, v85
    v_cvt_pk_bf16_f32 v101, v86, v87
    v_cvt_pk_bf16_f32 v102, v92, v93
    v_cvt_pk_bf16_f32 v103, v94, v95
    buffer_store_dwordx4 v[100:103], v8, s[84:87], s24 offen offset:1024 sc1
    s_add_u32 s24, s24, 524288
    s_waitcnt vmcnt(0) lgkmcnt(0)
    s_barrier
    v_add_u32 v10, 1, v10
    buffer_store_dword v10, v9, s[84:87], 0 offen sc1
mega_kernel_q_done:
    s_load_dwordx2 s[52:53], s[0:1], 40
    v_and_b32 v202, 63, v0
    s_and_b32 s58, s92, 31
    v_lshrrev_b32 v200, 2, v202
    v_lshlrev_b32 v200, 11, v200
    v_and_b32 v203, 3, v202
    v_lshl_add_u32 v200, v203, 4, v200
    s_lshl_b32 s56, s98, 21
    s_lshl_b32 s57, s58, 6
    s_add_u32 s56, s56, s57
    v_add_u32 v200, s56, v200
    s_lshl_b32 s56, s98, 14
    s_add_u32 s56, s56, 81920
    s_lshr_b32 s57, s58, 1
    s_lshl_b32 s57, s57, 12
    v_lshrrev_b32 v201, 5, v202
    v_bfe_u32 v204, v202, 2, 2
    v_lshl_add_u32 v201, v201, 3, v204
    v_lshlrev_b32 v201, 6, v201
    v_bfe_u32 v204, v202, 4, 1
    v_lshl_add_u32 v201, v204, 5, v201
    v_lshl_add_u32 v201, v203, 3, v201
    v_add_u32 v201, s56, v201
    s_waitcnt lgkmcnt(0)
    s_mov_b32 s54, 8388608
    s_mov_b32 s55, 0x00020000
    s_cmp_lt_u32 s92, 128
    s_cbranch_scc1 mega_kernel_f1
    s_add_u32 m0, s56, 0
    s_add_u32 s58, s57, 0
    s_and_b32 s58, s58, 0xffff
    s_lshl_b32 s58, s58, 5
    buffer_load_dwordx4 v200, s[52:55], s58 offen lds
    s_add_u32 m0, s56, 1024
    s_add_u32 s58, s57, 1024
    s_and_b32 s58, s58, 0xffff
    s_lshl_b32 s58, s58, 5
    buffer_load_dwordx4 v200, s[52:55], s58 offen lds
    s_add_u32 m0, s56, 2048
    s_add_u32 s58, s57, 2048
    s_and_b32 s58, s58, 0xffff
    s_lshl_b32 s58, s58, 5
    buffer_load_dwordx4 v200, s[52:55], s58 offen lds
    s_add_u32 m0, s56, 3072
    s_add_u32 s58, s57, 3072
    s_and_b32 s58, s58, 0xffff
    s_lshl_b32 s58, s58, 5
    buffer_load_dwordx4 v200, s[52:55], s58 offen lds
    s_add_u32 m0, s56, 4096
    s_add_u32 s58, s57, 4096
    s_and_b32 s58, s58, 0xffff
    s_lshl_b32 s58, s58, 5
    buffer_load_dwordx4 v200, s[52:55], s58 offen lds
    s_add_u32 m0, s56, 5120
    s_add_u32 s58, s57, 5120
    s_and_b32 s58, s58, 0xffff
    s_lshl_b32 s58, s58, 5
    buffer_load_dwordx4 v200, s[52:55], s58 offen lds
    s_add_u32 m0, s56, 6144
    s_add_u32 s58, s57, 6144
    s_and_b32 s58, s58, 0xffff
    s_lshl_b32 s58, s58, 5
    buffer_load_dwordx4 v200, s[52:55], s58 offen lds
    s_add_u32 m0, s56, 7168
    s_add_u32 s58, s57, 7168
    s_and_b32 s58, s58, 0xffff
    s_lshl_b32 s58, s58, 5
    buffer_load_dwordx4 v200, s[52:55], s58 offen lds
    s_add_u32 m0, s56, 8192
    s_add_u32 s58, s57, 8192
    s_and_b32 s58, s58, 0xffff
    s_lshl_b32 s58, s58, 5
    buffer_load_dwordx4 v200, s[52:55], s58 offen lds
    s_add_u32 m0, s56, 9216
    s_add_u32 s58, s57, 9216
    s_and_b32 s58, s58, 0xffff
    s_lshl_b32 s58, s58, 5
    buffer_load_dwordx4 v200, s[52:55], s58 offen lds
    s_add_u32 m0, s56, 10240
    s_add_u32 s58, s57, 10240
    s_and_b32 s58, s58, 0xffff
    s_lshl_b32 s58, s58, 5
    buffer_load_dwordx4 v200, s[52:55], s58 offen lds
    s_add_u32 m0, s56, 11264
    s_add_u32 s58, s57, 11264
    s_and_b32 s58, s58, 0xffff
    s_lshl_b32 s58, s58, 5
    buffer_load_dwordx4 v200, s[52:55], s58 offen lds
    s_add_u32 m0, s56, 12288
    s_add_u32 s58, s57, 12288
    s_and_b32 s58, s58, 0xffff
    s_lshl_b32 s58, s58, 5
    buffer_load_dwordx4 v200, s[52:55], s58 offen lds
    s_add_u32 m0, s56, 13312
    s_add_u32 s58, s57, 13312
    s_and_b32 s58, s58, 0xffff
    s_lshl_b32 s58, s58, 5
    buffer_load_dwordx4 v200, s[52:55], s58 offen lds
    s_add_u32 m0, s56, 14336
    s_add_u32 s58, s57, 14336
    s_and_b32 s58, s58, 0xffff
    s_lshl_b32 s58, s58, 5
    buffer_load_dwordx4 v200, s[52:55], s58 offen lds
    s_add_u32 m0, s56, 15360
    s_add_u32 s58, s57, 15360
    s_and_b32 s58, s58, 0xffff
    s_lshl_b32 s58, s58, 5
    buffer_load_dwordx4 v200, s[52:55], s58 offen lds
    s_sub_u32 s99, s92, 128
mega_kernel_f0l:
    s_barrier
    s_load_dwordx2 s[4:5], s[0:1], 64
    s_load_dwordx2 s[8:9], s[0:1], 72
    s_load_dwordx2 s[12:13], s[0:1], 96
    s_and_b32 s16, s99, 31
    s_lshr_b32 s17, s99, 5
    v_and_b32 v1, 63, v0
    v_lshrrev_b32 v2, 6, v0
    s_waitcnt lgkmcnt(0)
    s_mov_b32 s6, 2101248
    s_mov_b32 s7, 0x00020000
    s_mov_b32 s10, 2101248
    s_mov_b32 s11, 0x00020000
    s_add_u32 s12, s12, 121634816
    s_addc_u32 s13, s13, 0
    s_mov_b32 s14, 4202496
    s_mov_b32 s15, 0x00020000
    s_lshl_b32 s18, s16, 6
    v_add_u32 v3, s18, v2
    s_movk_i32 s19, 1026
    v_mul_lo_u32 v3, v3, s19
    s_lshl_b32 s18, s17, 7
    v_add_u32 v3, s18, v3
    v_lshl_add_u32 v3, v1, 1, v3
    s_mov_b32 s18, 0
    buffer_load_ushort v16, v3, s[4:7], s18 offen
    buffer_load_ushort v32, v3, s[8:11], s18 offen
    s_mov_b32 s18, 4104
    buffer_load_ushort v17, v3, s[4:7], s18 offen
    buffer_load_ushort v33, v3, s[8:11], s18 offen
    s_mov_b32 s18, 8208
    buffer_load_ushort v18, v3, s[4:7], s18 offen
    buffer_load_ushort v34, v3, s[8:11], s18 offen
    s_mov_b32 s18, 12312
    buffer_load_ushort v19, v3, s[4:7], s18 offen
    buffer_load_ushort v35, v3, s[8:11], s18 offen
    s_mov_b32 s18, 16416
    buffer_load_ushort v20, v3, s[4:7], s18 offen
    buffer_load_ushort v36, v3, s[8:11], s18 offen
    s_mov_b32 s18, 20520
    buffer_load_ushort v21, v3, s[4:7], s18 offen
    buffer_load_ushort v37, v3, s[8:11], s18 offen
    s_mov_b32 s18, 24624
    buffer_load_ushort v22, v3, s[4:7], s18 offen
    buffer_load_ushort v38, v3, s[8:11], s18 offen
    s_mov_b32 s18, 28728
    buffer_load_ushort v23, v3, s[4:7], s18 offen
    buffer_load_ushort v39, v3, s[8:11], s18 offen
    s_mov_b32 s18, 32832
    buffer_load_ushort v24, v3, s[4:7], s18 offen
    buffer_load_ushort v40, v3, s[8:11], s18 offen
    s_mov_b32 s18, 36936
    buffer_load_ushort v25, v3, s[4:7], s18 offen
    buffer_load_ushort v41, v3, s[8:11], s18 offen
    s_mov_b32 s18, 41040
    buffer_load_ushort v26, v3, s[4:7], s18 offen
    buffer_load_ushort v42, v3, s[8:11], s18 offen
    s_mov_b32 s18, 45144
    buffer_load_ushort v27, v3, s[4:7], s18 offen
    buffer_load_ushort v43, v3, s[8:11], s18 offen
    s_mov_b32 s18, 49248
    buffer_load_ushort v28, v3, s[4:7], s18 offen
    buffer_load_ushort v44, v3, s[8:11], s18 offen
    s_mov_b32 s18, 53352
    buffer_load_ushort v29, v3, s[4:7], s18 offen
    buffer_load_ushort v45, v3, s[8:11], s18 offen
    s_mov_b32 s18, 57456
    buffer_load_ushort v30, v3, s[4:7], s18 offen
    buffer_load_ushort v46, v3, s[8:11], s18 offen
    s_mov_b32 s18, 61560
    buffer_load_ushort v31, v3, s[4:7], s18 offen
    buffer_load_ushort v47, v3, s[8:11], s18 offen
    v_mul_u32_u24 v4, 65, v1
    v_add_u32 v4, v4, v2
    v_lshlrev_b32 v4, 2, v4
    s_waitcnt vmcnt(0)
    v_lshl_or_b32 v16, v32, 16, v16
    ds_write_b32 v4, v16 offset:0
    v_lshl_or_b32 v17, v33, 16, v17
    ds_write_b32 v4, v17 offset:16
    v_lshl_or_b32 v18, v34, 16, v18
    ds_write_b32 v4, v18 offset:32
    v_lshl_or_b32 v19, v35, 16, v19
    ds_write_b32 v4, v19 offset:48
    v_lshl_or_b32 v20, v36, 16, v20
    ds_write_b32 v4, v20 offset:64
    v_lshl_or_b32 v21, v37, 16, v21
    ds_write_b32 v4, v21 offset:80
    v_lshl_or_b32 v22, v38, 16, v22
    ds_write_b32 v4, v22 offset:96
    v_lshl_or_b32 v23, v39, 16, v23
    ds_write_b32 v4, v23 offset:112
    v_lshl_or_b32 v24, v40, 16, v24
    ds_write_b32 v4, v24 offset:128
    v_lshl_or_b32 v25, v41, 16, v25
    ds_write_b32 v4, v25 offset:144
    v_lshl_or_b32 v26, v42, 16, v26
    ds_write_b32 v4, v26 offset:160
    v_lshl_or_b32 v27, v43, 16, v27
    ds_write_b32 v4, v27 offset:176
    v_lshl_or_b32 v28, v44, 16, v28
    ds_write_b32 v4, v28 offset:192
    v_lshl_or_b32 v29, v45, 16, v29
    ds_write_b32 v4, v29 offset:208
    v_lshl_or_b32 v30, v46, 16, v30
    ds_write_b32 v4, v30 offset:224
    v_lshl_or_b32 v31, v47, 16, v31
    ds_write_b32 v4, v31 offset:240
    v_lshrrev_b32 v7, 4, v0
    v_and_b32 v8, 15, v0
    v_mul_u32_u24 v5, 65, v7
    v_lshl_add_u32 v5, v8, 2, v5
    v_lshlrev_b32 v5, 2, v5
    s_waitcnt lgkmcnt(0)
    s_barrier
    ds_read_b32 v16, v5 offset:0
    ds_read_b32 v17, v5 offset:4
    ds_read_b32 v18, v5 offset:8
    ds_read_b32 v19, v5 offset:12
    ds_read_b32 v20, v5 offset:4160
    ds_read_b32 v21, v5 offset:4164
    ds_read_b32 v22, v5 offset:4168
    ds_read_b32 v23, v5 offset:4172
    ds_read_b32 v24, v5 offset:8320
    ds_read_b32 v25, v5 offset:8324
    ds_read_b32 v26, v5 offset:8328
    ds_read_b32 v27, v5 offset:8332
    ds_read_b32 v28, v5 offset:12480
    ds_read_b32 v29, v5 offset:12484
    ds_read_b32 v30, v5 offset:12488
    ds_read_b32 v31, v5 offset:12492
    s_lshl_b32 s18, s17, 6
    v_add_u32 v6, s18, v7
    v_lshlrev_b32 v6, 13, v6
    s_lshl_b32 s18, s16, 8
    v_add_u32 v6, s18, v6
    v_lshl_add_u32 v6, v8, 4, v6
    s_waitcnt lgkmcnt(0)
    s_mov_b32 s18, 0
    buffer_store_dwordx4 v[16:19], v6, s[12:15], s18 offen sc1
    s_mov_b32 s18, 131072
    buffer_store_dwordx4 v[20:23], v6, s[12:15], s18 offen sc1
    s_mov_b32 s18, 262144
    buffer_store_dwordx4 v[24:27], v6, s[12:15], s18 offen sc1
    s_mov_b32 s18, 393216
    buffer_store_dwordx4 v[28:31], v6, s[12:15], s18 offen sc1
    s_add_u32 s99, s99, 64
    s_cmp_lt_u32 s99, 288
    s_cbranch_scc1 mega_kernel_f0l
    s_waitcnt vmcnt(0)
    s_barrier
    s_cmp_lg_u32 s98, 0
    s_cbranch_scc1 mega_kernel_sg_5
    v_mov_b32 v2, 1
    s_mov_b32 s81, 71361024
    s_mov_b64 exec, 1
    buffer_atomic_add v2, off, s[84:87], s81 sc1
    s_mov_b64 exec, -1
mega_kernel_sg_5:
    s_cmp_lg_u32 s92, 191
    s_cbranch_scc1 mega_kernel_xo2
    s_cmp_lg_u32 s98, 0
    s_cbranch_scc1 mega_kernel_xo2
    s_waitcnt vmcnt(0)
    ds_read_b64_tr_b16 a[0:1], v201 offset:0
    ds_read_b64_tr_b16 a[2:3], v201 offset:256
    ds_read_b64_tr_b16 a[4:5], v201 offset:1024
    ds_read_b64_tr_b16 a[6:7], v201 offset:1280
    ds_read_b64_tr_b16 a[8:9], v201 offset:2048
    ds_read_b64_tr_b16 a[10:11], v201 offset:2304
    ds_read_b64_tr_b16 a[12:13], v201 offset:3072
    ds_read_b64_tr_b16 a[14:15], v201 offset:3328
    s_waitcnt lgkmcnt(0)
    ds_read_b64_tr_b16 a[16:17], v201 offset:4096
    ds_read_b64_tr_b16 a[18:19], v201 offset:4352
    ds_read_b64_tr_b16 a[20:21], v201 offset:5120
    ds_read_b64_tr_b16 a[22:23], v201 offset:5376
    ds_read_b64_tr_b16 a[24:25], v201 offset:6144
    ds_read_b64_tr_b16 a[26:27], v201 offset:6400
    ds_read_b64_tr_b16 a[28:29], v201 offset:7168
    ds_read_b64_tr_b16 a[30:31], v201 offset:7424
    s_waitcnt lgkmcnt(0)
    ds_read_b64_tr_b16 a[32:33], v201 offset:8192
    ds_read_b64_tr_b16 a[34:35], v201 offset:8448
    ds_read_b64_tr_b16 a[36:37], v201 offset:9216
    ds_read_b64_tr_b16 a[38:39], v201 offset:9472
    ds_read_b64_tr_b16 a[40:41], v201 offset:10240
    ds_read_b64_tr_b16 a[42:43], v201 offset:10496
    ds_read_b64_tr_b16 a[44:45], v201 offset:11264
    ds_read_b64_tr_b16 a[46:47], v201 offset:11520
    s_waitcnt lgkmcnt(0)
    ds_read_b64_tr_b16 a[48:49], v201 offset:12288
    ds_read_b64_tr_b16 a[50:51], v201 offset:12544
    ds_read_b64_tr_b16 a[52:53], v201 offset:13312
    ds_read_b64_tr_b16 a[54:55], v201 offset:13568
    ds_read_b64_tr_b16 a[56:57], v201 offset:14336
    ds_read_b64_tr_b16 a[58:59], v201 offset:14592
    ds_read_b64_tr_b16 a[60:61], v201 offset:15360
    ds_read_b64_tr_b16 a[62:63], v201 offset:15616
    s_waitcnt lgkmcnt(0)
    s_add_u32 m0, s56, 0
    s_add_u32 s58, s57, 16384
    s_and_b32 s58, s58, 0xffff
    s_lshl_b32 s58, s58, 5
    buffer_load_dwordx4 v200, s[52:55], s58 offen lds
    s_add_u32 m0, s56, 1024
    s_add_u32 s58, s57, 17408
    s_and_b32 s58, s58, 0xffff
    s_lshl_b32 s58, s58, 5
    buffer_load_dwordx4 v200, s[52:55], s58 offen lds
    s_add_u32 m0, s56, 2048
    s_add_u32 s58, s57, 18432
    s_and_b32 s58, s58, 0xffff
    s_lshl_b32 s58, s58, 5
    buffer_load_dwordx4 v200, s[52:55], s58 offen lds
    s_add_u32 m0, s56, 3072
    s_add_u32 s58, s57, 19456
    s_and_b32 s58, s58, 0xffff
    s_lshl_b32 s58, s58, 5
    buffer_load_dwordx4 v200, s[52:55], s58 offen lds
    s_add_u32 m0, s56, 4096
    s_add_u32 s58, s57, 20480
    s_and_b32 s58, s58, 0xffff
    s_lshl_b32 s58, s58, 5
    buffer_load_dwordx4 v200, s[52:55], s58 offen lds
    s_add_u32 m0, s56, 5120
    s_add_u32 s58, s57, 21504
    s_and_b32 s58, s58, 0xffff
    s_lshl_b32 s58, s58, 5
    buffer_load_dwordx4 v200, s[52:55], s58 offen lds
    s_add_u32 m0, s56, 6144
    s_add_u32 s58, s57, 22528
    s_and_b32 s58, s58, 0xffff
    s_lshl_b32 s58, s58, 5
    buffer_load_dwordx4 v200, s[52:55], s58 offen lds
    s_add_u32 m0, s56, 7168
    s_add_u32 s58, s57, 23552
    s_and_b32 s58, s58, 0xffff
    s_lshl_b32 s58, s58, 5
    buffer_load_dwordx4 v200, s[52:55], s58 offen lds
    s_add_u32 m0, s56, 8192
    s_add_u32 s58, s57, 24576
    s_and_b32 s58, s58, 0xffff
    s_lshl_b32 s58, s58, 5
    buffer_load_dwordx4 v200, s[52:55], s58 offen lds
    s_add_u32 m0, s56, 9216
    s_add_u32 s58, s57, 25600
    s_and_b32 s58, s58, 0xffff
    s_lshl_b32 s58, s58, 5
    buffer_load_dwordx4 v200, s[52:55], s58 offen lds
    s_add_u32 m0, s56, 10240
    s_add_u32 s58, s57, 26624
    s_and_b32 s58, s58, 0xffff
    s_lshl_b32 s58, s58, 5
    buffer_load_dwordx4 v200, s[52:55], s58 offen lds
    s_add_u32 m0, s56, 11264
    s_add_u32 s58, s57, 27648
    s_and_b32 s58, s58, 0xffff
    s_lshl_b32 s58, s58, 5
    buffer_load_dwordx4 v200, s[52:55], s58 offen lds
    s_add_u32 m0, s56, 12288
    s_add_u32 s58, s57, 28672
    s_and_b32 s58, s58, 0xffff
    s_lshl_b32 s58, s58, 5
    buffer_load_dwordx4 v200, s[52:55], s58 offen lds
    s_add_u32 m0, s56, 13312
    s_add_u32 s58, s57, 29696
    s_and_b32 s58, s58, 0xffff
    s_lshl_b32 s58, s58, 5
    buffer_load_dwordx4 v200, s[52:55], s58 offen lds
    s_add_u32 m0, s56, 14336
    s_add_u32 s58, s57, 30720
    s_and_b32 s58, s58, 0xffff
    s_lshl_b32 s58, s58, 5
    buffer_load_dwordx4 v200, s[52:55], s58 offen lds
    s_add_u32 m0, s56, 15360
    s_add_u32 s58, s57, 31744
    s_and_b32 s58, s58, 0xffff
    s_lshl_b32 s58, s58, 5
    buffer_load_dwordx4 v200, s[52:55], s58 offen lds
    s_cmp_lg_u32 s98, 0
    s_cbranch_scc1 mega_kernel_wf1bd
    s_mov_b32 s81, 71360512
mega_kernel_wf1b:
    buffer_load_dword v120, off, s[84:87], s81 sc1
    s_waitcnt vmcnt(0)
    v_cmp_ne_u32 vcc, 128, v120
    s_cbranch_vccz mega_kernel_wf1bd
    s_sleep 6
    s_branch mega_kernel_wf1b
mega_kernel_wf1bd:
    s_mov_b32 s99, 128
    s_branch mega_kernel_f2_in
mega_kernel_f2ret:
    s_waitcnt vmcnt(0)
    v_mov_b32 v2, 1
    s_mov_b64 exec, 1
    s_mov_b32 s81, 71360768
    buffer_atomic_add v2, off, s[84:87], s81 sc1
    s_mov_b64 exec, -1
    s_branch mega_kernel_xo3
mega_kernel_xo2:
    s_waitcnt vmcnt(0)
    ds_read_b64_tr_b16 a[0:1], v201 offset:0
    ds_read_b64_tr_b16 a[2:3], v201 offset:256
    ds_read_b64_tr_b16 a[4:5], v201 offset:1024
    ds_read_b64_tr_b16 a[6:7], v201 offset:1280
    ds_read_b64_tr_b16 a[8:9], v201 offset:2048
    ds_read_b64_tr_b16 a[10:11], v201 offset:2304
    ds_read_b64_tr_b16 a[12:13], v201 offset:3072
    ds_read_b64_tr_b16 a[14:15], v201 offset:3328
    s_waitcnt lgkmcnt(0)
    ds_read_b64_tr_b16 a[16:17], v201 offset:4096
    ds_read_b64_tr_b16 a[18:19], v201 offset:4352
    ds_read_b64_tr_b16 a[20:21], v201 offset:5120
    ds_read_b64_tr_b16 a[22:23], v201 offset:5376
    ds_read_b64_tr_b16 a[24:25], v201 offset:6144
    ds_read_b64_tr_b16 a[26:27], v201 offset:6400
    ds_read_b64_tr_b16 a[28:29], v201 offset:7168
    ds_read_b64_tr_b16 a[30:31], v201 offset:7424
    s_waitcnt lgkmcnt(0)
    ds_read_b64_tr_b16 a[32:33], v201 offset:8192
    ds_read_b64_tr_b16 a[34:35], v201 offset:8448
    ds_read_b64_tr_b16 a[36:37], v201 offset:9216
    ds_read_b64_tr_b16 a[38:39], v201 offset:9472
    ds_read_b64_tr_b16 a[40:41], v201 offset:10240
    ds_read_b64_tr_b16 a[42:43], v201 offset:10496
    ds_read_b64_tr_b16 a[44:45], v201 offset:11264
    ds_read_b64_tr_b16 a[46:47], v201 offset:11520
    s_waitcnt lgkmcnt(0)
    ds_read_b64_tr_b16 a[48:49], v201 offset:12288
    ds_read_b64_tr_b16 a[50:51], v201 offset:12544
    ds_read_b64_tr_b16 a[52:53], v201 offset:13312
    ds_read_b64_tr_b16 a[54:55], v201 offset:13568
    ds_read_b64_tr_b16 a[56:57], v201 offset:14336
    ds_read_b64_tr_b16 a[58:59], v201 offset:14592
    ds_read_b64_tr_b16 a[60:61], v201 offset:15360
    ds_read_b64_tr_b16 a[62:63], v201 offset:15616
    s_waitcnt lgkmcnt(0)
    s_add_u32 m0, s56, 0
    s_add_u32 s58, s57, 16384
    s_and_b32 s58, s58, 0xffff
    s_lshl_b32 s58, s58, 5
    buffer_load_dwordx4 v200, s[52:55], s58 offen lds
    s_add_u32 m0, s56, 1024
    s_add_u32 s58, s57, 17408
    s_and_b32 s58, s58, 0xffff
    s_lshl_b32 s58, s58, 5
    buffer_load_dwordx4 v200, s[52:55], s58 offen lds
    s_add_u32 m0, s56, 2048
    s_add_u32 s58, s57, 18432
    s_and_b32 s58, s58, 0xffff
    s_lshl_b32 s58, s58, 5
    buffer_load_dwordx4 v200, s[52:55], s58 offen lds
    s_add_u32 m0, s56, 3072
    s_add_u32 s58, s57, 19456
    s_and_b32 s58, s58, 0xffff
    s_lshl_b32 s58, s58, 5
    buffer_load_dwordx4 v200, s[52:55], s58 offen lds
    s_add_u32 m0, s56, 4096
    s_add_u32 s58, s57, 20480
    s_and_b32 s58, s58, 0xffff
    s_lshl_b32 s58, s58, 5
    buffer_load_dwordx4 v200, s[52:55], s58 offen lds
    s_add_u32 m0, s56, 5120
    s_add_u32 s58, s57, 21504
    s_and_b32 s58, s58, 0xffff
    s_lshl_b32 s58, s58, 5
    buffer_load_dwordx4 v200, s[52:55], s58 offen lds
    s_add_u32 m0, s56, 6144
    s_add_u32 s58, s57, 22528
    s_and_b32 s58, s58, 0xffff
    s_lshl_b32 s58, s58, 5
    buffer_load_dwordx4 v200, s[52:55], s58 offen lds
    s_add_u32 m0, s56, 7168
    s_add_u32 s58, s57, 23552
    s_and_b32 s58, s58, 0xffff
    s_lshl_b32 s58, s58, 5
    buffer_load_dwordx4 v200, s[52:55], s58 offen lds
    s_add_u32 m0, s56, 8192
    s_add_u32 s58, s57, 24576
    s_and_b32 s58, s58, 0xffff
    s_lshl_b32 s58, s58, 5
    buffer_load_dwordx4 v200, s[52:55], s58 offen lds
    s_add_u32 m0, s56, 9216
    s_add_u32 s58, s57, 25600
    s_and_b32 s58, s58, 0xffff
    s_lshl_b32 s58, s58, 5
    buffer_load_dwordx4 v200, s[52:55], s58 offen lds
    s_add_u32 m0, s56, 10240
    s_add_u32 s58, s57, 26624
    s_and_b32 s58, s58, 0xffff
    s_lshl_b32 s58, s58, 5
    buffer_load_dwordx4 v200, s[52:55], s58 offen lds
    s_add_u32 m0, s56, 11264
    s_add_u32 s58, s57, 27648
    s_and_b32 s58, s58, 0xffff
    s_lshl_b32 s58, s58, 5
    buffer_load_dwordx4 v200, s[52:55], s58 offen lds
    s_add_u32 m0, s56, 12288
    s_add_u32 s58, s57, 28672
    s_and_b32 s58, s58, 0xffff
    s_lshl_b32 s58, s58, 5
    buffer_load_dwordx4 v200, s[52:55], s58 offen lds
    s_add_u32 m0, s56, 13312
    s_add_u32 s58, s57, 29696
    s_and_b32 s58, s58, 0xffff
    s_lshl_b32 s58, s58, 5
    buffer_load_dwordx4 v200, s[52:55], s58 offen lds
    s_add_u32 m0, s56, 14336
    s_add_u32 s58, s57, 30720
    s_and_b32 s58, s58, 0xffff
    s_lshl_b32 s58, s58, 5
    buffer_load_dwordx4 v200, s[52:55], s58 offen lds
    s_add_u32 m0, s56, 15360
    s_add_u32 s58, s57, 31744
    s_and_b32 s58, s58, 0xffff
    s_lshl_b32 s58, s58, 5
    buffer_load_dwordx4 v200, s[52:55], s58 offen lds
    s_waitcnt vmcnt(0)
    ds_read_b64_tr_b16 a[64:65], v201 offset:0
    ds_read_b64_tr_b16 a[66:67], v201 offset:256
    ds_read_b64_tr_b16 a[68:69], v201 offset:1024
    ds_read_b64_tr_b16 a[70:71], v201 offset:1280
    ds_read_b64_tr_b16 a[72:73], v201 offset:2048
    ds_read_b64_tr_b16 a[74:75], v201 offset:2304
    ds_read_b64_tr_b16 a[76:77], v201 offset:3072
    ds_read_b64_tr_b16 a[78:79], v201 offset:3328
    s_waitcnt lgkmcnt(0)
    ds_read_b64_tr_b16 a[80:81], v201 offset:4096
    ds_read_b64_tr_b16 a[82:83], v201 offset:4352
    ds_read_b64_tr_b16 a[84:85], v201 offset:5120
    ds_read_b64_tr_b16 a[86:87], v201 offset:5376
    ds_read_b64_tr_b16 a[88:89], v201 offset:6144
    ds_read_b64_tr_b16 a[90:91], v201 offset:6400
    ds_read_b64_tr_b16 a[92:93], v201 offset:7168
    ds_read_b64_tr_b16 a[94:95], v201 offset:7424
    s_waitcnt lgkmcnt(0)
    ds_read_b64_tr_b16 a[96:97], v201 offset:8192
    ds_read_b64_tr_b16 a[98:99], v201 offset:8448
    ds_read_b64_tr_b16 a[100:101], v201 offset:9216
    ds_read_b64_tr_b16 a[102:103], v201 offset:9472
    ds_read_b64_tr_b16 a[104:105], v201 offset:10240
    ds_read_b64_tr_b16 a[106:107], v201 offset:10496
    ds_read_b64_tr_b16 a[108:109], v201 offset:11264
    ds_read_b64_tr_b16 a[110:111], v201 offset:11520
    s_waitcnt lgkmcnt(0)
    ds_read_b64_tr_b16 a[112:113], v201 offset:12288
    ds_read_b64_tr_b16 a[114:115], v201 offset:12544
    ds_read_b64_tr_b16 a[116:117], v201 offset:13312
    ds_read_b64_tr_b16 a[118:119], v201 offset:13568
    ds_read_b64_tr_b16 a[120:121], v201 offset:14336
    ds_read_b64_tr_b16 a[122:123], v201 offset:14592
    ds_read_b64_tr_b16 a[124:125], v201 offset:15360
    ds_read_b64_tr_b16 a[126:127], v201 offset:15616
    s_waitcnt lgkmcnt(0)
    s_add_u32 m0, s56, 0
    s_add_u32 s58, s57, 32768
    s_and_b32 s58, s58, 0xffff
    s_lshl_b32 s58, s58, 5
    buffer_load_dwordx4 v200, s[52:55], s58 offen lds
    s_add_u32 m0, s56, 1024
    s_add_u32 s58, s57, 33792
    s_and_b32 s58, s58, 0xffff
    s_lshl_b32 s58, s58, 5
    buffer_load_dwordx4 v200, s[52:55], s58 offen lds
    s_add_u32 m0, s56, 2048
    s_add_u32 s58, s57, 34816
    s_and_b32 s58, s58, 0xffff
    s_lshl_b32 s58, s58, 5
    buffer_load_dwordx4 v200, s[52:55], s58 offen lds
    s_add_u32 m0, s56, 3072
    s_add_u32 s58, s57, 35840
    s_and_b32 s58, s58, 0xffff
    s_lshl_b32 s58, s58, 5
    buffer_load_dwordx4 v200, s[52:55], s58 offen lds
    s_add_u32 m0, s56, 4096
    s_add_u32 s58, s57, 36864
    s_and_b32 s58, s58, 0xffff
    s_lshl_b32 s58, s58, 5
    buffer_load_dwordx4 v200, s[52:55], s58 offen lds
    s_add_u32 m0, s56, 5120
    s_add_u32 s58, s57, 37888
    s_and_b32 s58, s58, 0xffff
    s_lshl_b32 s58, s58, 5
    buffer_load_dwordx4 v200, s[52:55], s58 offen lds
    s_add_u32 m0, s56, 6144
    s_add_u32 s58, s57, 38912
    s_and_b32 s58, s58, 0xffff
    s_lshl_b32 s58, s58, 5
    buffer_load_dwordx4 v200, s[52:55], s58 offen lds
    s_add_u32 m0, s56, 7168
    s_add_u32 s58, s57, 39936
    s_and_b32 s58, s58, 0xffff
    s_lshl_b32 s58, s58, 5
    buffer_load_dwordx4 v200, s[52:55], s58 offen lds
    s_add_u32 m0, s56, 8192
    s_add_u32 s58, s57, 40960
    s_and_b32 s58, s58, 0xffff
    s_lshl_b32 s58, s58, 5
    buffer_load_dwordx4 v200, s[52:55], s58 offen lds
    s_add_u32 m0, s56, 9216
    s_add_u32 s58, s57, 41984
    s_and_b32 s58, s58, 0xffff
    s_lshl_b32 s58, s58, 5
    buffer_load_dwordx4 v200, s[52:55], s58 offen lds
    s_add_u32 m0, s56, 10240
    s_add_u32 s58, s57, 43008
    s_and_b32 s58, s58, 0xffff
    s_lshl_b32 s58, s58, 5
    buffer_load_dwordx4 v200, s[52:55], s58 offen lds
    s_add_u32 m0, s56, 11264
    s_add_u32 s58, s57, 44032
    s_and_b32 s58, s58, 0xffff
    s_lshl_b32 s58, s58, 5
    buffer_load_dwordx4 v200, s[52:55], s58 offen lds
    s_add_u32 m0, s56, 12288
    s_add_u32 s58, s57, 45056
    s_and_b32 s58, s58, 0xffff
    s_lshl_b32 s58, s58, 5
    buffer_load_dwordx4 v200, s[52:55], s58 offen lds
    s_add_u32 m0, s56, 13312
    s_add_u32 s58, s57, 46080
    s_and_b32 s58, s58, 0xffff
    s_lshl_b32 s58, s58, 5
    buffer_load_dwordx4 v200, s[52:55], s58 offen lds
    s_add_u32 m0, s56, 14336
    s_add_u32 s58, s57, 47104
    s_and_b32 s58, s58, 0xffff
    s_lshl_b32 s58, s58, 5
    buffer_load_dwordx4 v200, s[52:55], s58 offen lds
    s_add_u32 m0, s56, 15360
    s_add_u32 s58, s57, 48128
    s_and_b32 s58, s58, 0xffff
    s_lshl_b32 s58, s58, 5
    buffer_load_dwordx4 v200, s[52:55], s58 offen lds
mega_kernel_xo3:
    s_waitcnt vmcnt(0)
    ds_read_b64_tr_b16 a[128:129], v201 offset:0
    ds_read_b64_tr_b16 a[130:131], v201 offset:256
    ds_read_b64_tr_b16 a[132:133], v201 offset:1024
    ds_read_b64_tr_b16 a[134:135], v201 offset:1280
    ds_read_b64_tr_b16 a[136:137], v201 offset:2048
    ds_read_b64_tr_b16 a[138:139], v201 offset:2304
    ds_read_b64_tr_b16 a[140:141], v201 offset:3072
    ds_read_b64_tr_b16 a[142:143], v201 offset:3328
    s_waitcnt lgkmcnt(0)
    ds_read_b64_tr_b16 a[144:145], v201 offset:4096
    ds_read_b64_tr_b16 a[146:147], v201 offset:4352
    ds_read_b64_tr_b16 a[148:149], v201 offset:5120
    ds_read_b64_tr_b16 a[150:151], v201 offset:5376
    ds_read_b64_tr_b16 a[152:153], v201 offset:6144
    ds_read_b64_tr_b16 a[154:155], v201 offset:6400
    ds_read_b64_tr_b16 a[156:157], v201 offset:7168
    ds_read_b64_tr_b16 a[158:159], v201 offset:7424
    s_waitcnt lgkmcnt(0)
    ds_read_b64_tr_b16 a[160:161], v201 offset:8192
    ds_read_b64_tr_b16 a[162:163], v201 offset:8448
    ds_read_b64_tr_b16 a[164:165], v201 offset:9216
    ds_read_b64_tr_b16 a[166:167], v201 offset:9472
    ds_read_b64_tr_b16 a[168:169], v201 offset:10240
    ds_read_b64_tr_b16 a[170:171], v201 offset:10496
    ds_read_b64_tr_b16 a[172:173], v201 offset:11264
    ds_read_b64_tr_b16 a[174:175], v201 offset:11520
    s_waitcnt lgkmcnt(0)
    ds_read_b64_tr_b16 a[176:177], v201 offset:12288
    ds_read_b64_tr_b16 a[178:179], v201 offset:12544
    ds_read_b64_tr_b16 a[180:181], v201 offset:13312
    ds_read_b64_tr_b16 a[182:183], v201 offset:13568
    ds_read_b64_tr_b16 a[184:185], v201 offset:14336
    ds_read_b64_tr_b16 a[186:187], v201 offset:14592
    ds_read_b64_tr_b16 a[188:189], v201 offset:15360
    ds_read_b64_tr_b16 a[190:191], v201 offset:15616
    s_waitcnt lgkmcnt(0)
    s_add_u32 m0, s56, 0
    s_add_u32 s58, s57, 49152
    s_and_b32 s58, s58, 0xffff
    s_lshl_b32 s58, s58, 5
    buffer_load_dwordx4 v200, s[52:55], s58 offen lds
    s_add_u32 m0, s56, 1024
    s_add_u32 s58, s57, 50176
    s_and_b32 s58, s58, 0xffff
    s_lshl_b32 s58, s58, 5
    buffer_load_dwordx4 v200, s[52:55], s58 offen lds
    s_add_u32 m0, s56, 2048
    s_add_u32 s58, s57, 51200
    s_and_b32 s58, s58, 0xffff
    s_lshl_b32 s58, s58, 5
    buffer_load_dwordx4 v200, s[52:55], s58 offen lds
    s_add_u32 m0, s56, 3072
    s_add_u32 s58, s57, 52224
    s_and_b32 s58, s58, 0xffff
    s_lshl_b32 s58, s58, 5
    buffer_load_dwordx4 v200, s[52:55], s58 offen lds
    s_add_u32 m0, s56, 4096
    s_add_u32 s58, s57, 53248
    s_and_b32 s58, s58, 0xffff
    s_lshl_b32 s58, s58, 5
    buffer_load_dwordx4 v200, s[52:55], s58 offen lds
    s_add_u32 m0, s56, 5120
    s_add_u32 s58, s57, 54272
    s_and_b32 s58, s58, 0xffff
    s_lshl_b32 s58, s58, 5
    buffer_load_dwordx4 v200, s[52:55], s58 offen lds
    s_add_u32 m0, s56, 6144
    s_add_u32 s58, s57, 55296
    s_and_b32 s58, s58, 0xffff
    s_lshl_b32 s58, s58, 5
    buffer_load_dwordx4 v200, s[52:55], s58 offen lds
    s_add_u32 m0, s56, 7168
    s_add_u32 s58, s57, 56320
    s_and_b32 s58, s58, 0xffff
    s_lshl_b32 s58, s58, 5
    buffer_load_dwordx4 v200, s[52:55], s58 offen lds
    s_add_u32 m0, s56, 8192
    s_add_u32 s58, s57, 57344
    s_and_b32 s58, s58, 0xffff
    s_lshl_b32 s58, s58, 5
    buffer_load_dwordx4 v200, s[52:55], s58 offen lds
    s_add_u32 m0, s56, 9216
    s_add_u32 s58, s57, 58368
    s_and_b32 s58, s58, 0xffff
    s_lshl_b32 s58, s58, 5
    buffer_load_dwordx4 v200, s[52:55], s58 offen lds
    s_add_u32 m0, s56, 10240
    s_add_u32 s58, s57, 59392
    s_and_b32 s58, s58, 0xffff
    s_lshl_b32 s58, s58, 5
    buffer_load_dwordx4 v200, s[52:55], s58 offen lds
    s_add_u32 m0, s56, 11264
    s_add_u32 s58, s57, 60416
    s_and_b32 s58, s58, 0xffff
    s_lshl_b32 s58, s58, 5
    buffer_load_dwordx4 v200, s[52:55], s58 offen lds
    s_add_u32 m0, s56, 12288
    s_add_u32 s58, s57, 61440
    s_and_b32 s58, s58, 0xffff
    s_lshl_b32 s58, s58, 5
    buffer_load_dwordx4 v200, s[52:55], s58 offen lds
    s_add_u32 m0, s56, 13312
    s_add_u32 s58, s57, 62464
    s_and_b32 s58, s58, 0xffff
    s_lshl_b32 s58, s58, 5
    buffer_load_dwordx4 v200, s[52:55], s58 offen lds
    s_add_u32 m0, s56, 14336
    s_add_u32 s58, s57, 63488
    s_and_b32 s58, s58, 0xffff
    s_lshl_b32 s58, s58, 5
    buffer_load_dwordx4 v200, s[52:55], s58 offen lds
    s_add_u32 m0, s56, 15360
    s_add_u32 s58, s57, 64512
    s_and_b32 s58, s58, 0xffff
    s_lshl_b32 s58, s58, 5
    buffer_load_dwordx4 v200, s[52:55], s58 offen lds
    s_branch mega_kernel_xo4
mega_kernel_f1:
    s_barrier
    s_load_dwordx2 s[4:5], s[0:1], 56
    s_load_dwordx2 s[8:9], s[0:1], 96
    v_and_b32 v1, 31, v0
    v_lshrrev_b32 v2, 5, v0
    v_cvt_f32_u32 v3, v1
    s_waitcnt lgkmcnt(0)
    s_mov_b32 s6, 4194304
    s_mov_b32 s7, 0x00020000
    s_mov_b32 s10, 268435456
    s_mov_b32 s11, 0x00020000
    s_lshl_b32 s12, s92, 15
    v_lshlrev_b32 v6, 12, v2
    v_lshl_add_u32 v6, v1, 1, v6
    buffer_load_ushort v16, v6, s[4:7], s12 offen offset:0
    buffer_load_ushort v48, v6, s[4:7], s12 offen offset:2048
    buffer_load_ushort v17, v6, s[4:7], s12 offen offset:64
    buffer_load_ushort v49, v6, s[4:7], s12 offen offset:2112
    buffer_load_ushort v18, v6, s[4:7], s12 offen offset:128
    buffer_load_ushort v50, v6, s[4:7], s12 offen offset:2176
    buffer_load_ushort v19, v6, s[4:7], s12 offen offset:192
    buffer_load_ushort v51, v6, s[4:7], s12 offen offset:2240
    buffer_load_ushort v20, v6, s[4:7], s12 offen offset:256
    buffer_load_ushort v52, v6, s[4:7], s12 offen offset:2304
    buffer_load_ushort v21, v6, s[4:7], s12 offen offset:320
    buffer_load_ushort v53, v6, s[4:7], s12 offen offset:2368
    buffer_load_ushort v22, v6, s[4:7], s12 offen offset:384
    buffer_load_ushort v54, v6, s[4:7], s12 offen offset:2432
    buffer_load_ushort v23, v6, s[4:7], s12 offen offset:448
    buffer_load_ushort v55, v6, s[4:7], s12 offen offset:2496
    buffer_load_ushort v24, v6, s[4:7], s12 offen offset:512
    buffer_load_ushort v56, v6, s[4:7], s12 offen offset:2560
    buffer_load_ushort v25, v6, s[4:7], s12 offen offset:576
    buffer_load_ushort v57, v6, s[4:7], s12 offen offset:2624
    buffer_load_ushort v26, v6, s[4:7], s12 offen offset:640
    buffer_load_ushort v58, v6, s[4:7], s12 offen offset:2688
    buffer_load_ushort v27, v6, s[4:7], s12 offen offset:704
    buffer_load_ushort v59, v6, s[4:7], s12 offen offset:2752
    buffer_load_ushort v28, v6, s[4:7], s12 offen offset:768
    buffer_load_ushort v60, v6, s[4:7], s12 offen offset:2816
    buffer_load_ushort v29, v6, s[4:7], s12 offen offset:832
    buffer_load_ushort v61, v6, s[4:7], s12 offen offset:2880
    buffer_load_ushort v30, v6, s[4:7], s12 offen offset:896
    buffer_load_ushort v62, v6, s[4:7], s12 offen offset:2944
    buffer_load_ushort v31, v6, s[4:7], s12 offen offset:960
    buffer_load_ushort v63, v6, s[4:7], s12 offen offset:3008
    buffer_load_ushort v32, v6, s[4:7], s12 offen offset:1024
    buffer_load_ushort v64, v6, s[4:7], s12 offen offset:3072
    buffer_load_ushort v33, v6, s[4:7], s12 offen offset:1088
    buffer_load_ushort v65, v6, s[4:7], s12 offen offset:3136
    buffer_load_ushort v34, v6, s[4:7], s12 offen offset:1152
    buffer_load_ushort v66, v6, s[4:7], s12 offen offset:3200
    buffer_load_ushort v35, v6, s[4:7], s12 offen offset:1216
    buffer_load_ushort v67, v6, s[4:7], s12 offen offset:3264
    buffer_load_ushort v36, v6, s[4:7], s12 offen offset:1280
    buffer_load_ushort v68, v6, s[4:7], s12 offen offset:3328
    buffer_load_ushort v37, v6, s[4:7], s12 offen offset:1344
    buffer_load_ushort v69, v6, s[4:7], s12 offen offset:3392
    buffer_load_ushort v38, v6, s[4:7], s12 offen offset:1408
    buffer_load_ushort v70, v6, s[4:7], s12 offen offset:3456
    buffer_load_ushort v39, v6, s[4:7], s12 offen offset:1472
    buffer_load_ushort v71, v6, s[4:7], s12 offen offset:3520
    buffer_load_ushort v40, v6, s[4:7], s12 offen offset:1536
    buffer_load_ushort v72, v6, s[4:7], s12 offen offset:3584
    buffer_load_ushort v41, v6, s[4:7], s12 offen offset:1600
    buffer_load_ushort v73, v6, s[4:7], s12 offen offset:3648
    buffer_load_ushort v42, v6, s[4:7], s12 offen offset:1664
    buffer_load_ushort v74, v6, s[4:7], s12 offen offset:3712
    buffer_load_ushort v43, v6, s[4:7], s12 offen offset:1728
    buffer_load_ushort v75, v6, s[4:7], s12 offen offset:3776
    buffer_load_ushort v44, v6, s[4:7], s12 offen offset:1792
    buffer_load_ushort v76, v6, s[4:7], s12 offen offset:3840
    buffer_load_ushort v45, v6, s[4:7], s12 offen offset:1856
    buffer_load_ushort v77, v6, s[4:7], s12 offen offset:3904
    buffer_load_ushort v46, v6, s[4:7], s12 offen offset:1920
    buffer_load_ushort v78, v6, s[4:7], s12 offen offset:3968
    buffer_load_ushort v47, v6, s[4:7], s12 offen offset:1984
    buffer_load_ushort v79, v6, s[4:7], s12 offen offset:4032
    s_movk_i32 s13, 8448
    v_mul_lo_u32 v7, v2, s13
    v_lshl_add_u32 v4, v1, 3, v7
    s_movk_i32 s13, 264
    v_mul_lo_u32 v5, v1, s13
    v_add_u32 v5, v5, v7
    s_waitcnt vmcnt(0)
    v_lshlrev_b32 v16, 16, v16
    v_lshlrev_b32 v48, 16, v48
    v_lshlrev_b32 v17, 16, v17
    v_lshlrev_b32 v49, 16, v49
    v_lshlrev_b32 v18, 16, v18
    v_lshlrev_b32 v50, 16, v50
    v_lshlrev_b32 v19, 16, v19
    v_lshlrev_b32 v51, 16, v51
    v_lshlrev_b32 v20, 16, v20
    v_lshlrev_b32 v52, 16, v52
    v_lshlrev_b32 v21, 16, v21
    v_lshlrev_b32 v53, 16, v53
    v_lshlrev_b32 v22, 16, v22
    v_lshlrev_b32 v54, 16, v54
    v_lshlrev_b32 v23, 16, v23
    v_lshlrev_b32 v55, 16, v55
    v_lshlrev_b32 v24, 16, v24
    v_lshlrev_b32 v56, 16, v56
    v_lshlrev_b32 v25, 16, v25
    v_lshlrev_b32 v57, 16, v57
    v_lshlrev_b32 v26, 16, v26
    v_lshlrev_b32 v58, 16, v58
    v_lshlrev_b32 v27, 16, v27
    v_lshlrev_b32 v59, 16, v59
    v_lshlrev_b32 v28, 16, v28
    v_lshlrev_b32 v60, 16, v60
    v_lshlrev_b32 v29, 16, v29
    v_lshlrev_b32 v61, 16, v61
    v_lshlrev_b32 v30, 16, v30
    v_lshlrev_b32 v62, 16, v62
    v_lshlrev_b32 v31, 16, v31
    v_lshlrev_b32 v63, 16, v63
    v_lshlrev_b32 v32, 16, v32
    v_lshlrev_b32 v64, 16, v64
    v_lshlrev_b32 v33, 16, v33
    v_lshlrev_b32 v65, 16, v65
    v_lshlrev_b32 v34, 16, v34
    v_lshlrev_b32 v66, 16, v66
    v_lshlrev_b32 v35, 16, v35
    v_lshlrev_b32 v67, 16, v67
    v_lshlrev_b32 v36, 16, v36
    v_lshlrev_b32 v68, 16, v68
    v_lshlrev_b32 v37, 16, v37
    v_lshlrev_b32 v69, 16, v69
    v_lshlrev_b32 v38, 16, v38
    v_lshlrev_b32 v70, 16, v70
    v_lshlrev_b32 v39, 16, v39
    v_lshlrev_b32 v71, 16, v71
    v_lshlrev_b32 v40, 16, v40
    v_lshlrev_b32 v72, 16, v72
    v_lshlrev_b32 v41, 16, v41
    v_lshlrev_b32 v73, 16, v73
    v_lshlrev_b32 v42, 16, v42
    v_lshlrev_b32 v74, 16, v74
    v_lshlrev_b32 v43, 16, v43
    v_lshlrev_b32 v75, 16, v75
    v_lshlrev_b32 v44, 16, v44
    v_lshlrev_b32 v76, 16, v76
    v_lshlrev_b32 v45, 16, v45
    v_lshlrev_b32 v77, 16, v77
    v_lshlrev_b32 v46, 16, v46
    v_lshlrev_b32 v78, 16, v78
    v_lshlrev_b32 v47, 16, v47
    v_lshlrev_b32 v79, 16, v79
    v_sub_f32 v80, v16, v32
    v_sub_f32 v81, v48, v64
    v_add_f32 v16, v16, v32
    v_add_f32 v48, v48, v64
    v_sub_f32 v32, v17, v33
    v_sub_f32 v64, v49, v65
    v_add_f32 v17, v17, v33
    v_add_f32 v49, v49, v65
    v_mul_f32 v33, 0x3f7b14be, v32
    v_mul_f32 v65, 0xbe47c5c2, v32
    v_fmac_f32 v33, 0x3e47c5c2, v64
    v_fmac_f32 v65, 0x3f7b14be, v64
    v_sub_f32 v32, v18, v34
    v_sub_f32 v64, v50, v66
    v_add_f32 v18, v18, v34
    v_add_f32 v50, v50, v66
    v_mul_f32 v34, 0x3f6c835e, v32
    v_mul_f32 v66, 0xbec3ef15, v32
    v_fmac_f32 v34, 0x3ec3ef15, v64
    v_fmac_f32 v66, 0x3f6c835e, v64
    v_sub_f32 v32, v19, v35
    v_sub_f32 v64, v51, v67
    v_add_f32 v19, v19, v35
    v_add_f32 v51, v51, v67
    v_mul_f32 v35, 0x3f54db31, v32
    v_mul_f32 v67, 0xbf0e39da, v32
    v_fmac_f32 v35, 0x3f0e39da, v64
    v_fmac_f32 v67, 0x3f54db31, v64
    v_sub_f32 v32, v20, v36
    v_sub_f32 v64, v52, v68
    v_add_f32 v20, v20, v36
    v_add_f32 v52, v52, v68
    v_mul_f32 v36, 0x3f3504f3, v32
    v_mul_f32 v68, 0xbf3504f3, v32
    v_fmac_f32 v36, 0x3f3504f3, v64
    v_fmac_f32 v68, 0x3f3504f3, v64
    v_sub_f32 v32, v21, v37
    v_sub_f32 v64, v53, v69
    v_add_f32 v21, v21, v37
    v_add_f32 v53, v53, v69
    v_mul_f32 v37, 0x3f0e39da, v32
    v_mul_f32 v69, 0xbf54db31, v32
    v_fmac_f32 v37, 0x3f54db31, v64
    v_fmac_f32 v69, 0x3f0e39da, v64
    v_sub_f32 v32, v22, v38
    v_sub_f32 v64, v54, v70
    v_add_f32 v22, v22, v38
    v_add_f32 v54, v54, v70
    v_mul_f32 v38, 0x3ec3ef15, v32
    v_mul_f32 v70, 0xbf6c835e, v32
    v_fmac_f32 v38, 0x3f6c835e, v64
    v_fmac_f32 v70, 0x3ec3ef15, v64
    v_sub_f32 v32, v23, v39
    v_sub_f32 v64, v55, v71
    v_add_f32 v23, v23, v39
    v_add_f32 v55, v55, v71
    v_mul_f32 v39, 0x3e47c5c2, v32
    v_mul_f32 v71, 0xbf7b14be, v32
    v_fmac_f32 v39, 0x3f7b14be, v64
    v_fmac_f32 v71, 0x3e47c5c2, v64
    v_sub_f32 v32, v56, v72
    v_sub_f32 v64, v40, v24
    v_add_f32 v24, v24, v40
    v_add_f32 v56, v56, v72
    v_sub_f32 v40, v25, v41
    v_sub_f32 v72, v57, v73
    v_add_f32 v25, v25, v41
    v_add_f32 v57, v57, v73
    v_mul_f32 v41, 0xbe47c5c2, v40
    v_mul_f32 v73, 0xbf7b14be, v40
    v_fmac_f32 v41, 0x3f7b14be, v72
    v_fmac_f32 v73, 0xbe47c5c2, v72
    v_sub_f32 v40, v26, v42
    v_sub_f32 v72, v58, v74
    v_add_f32 v26, v26, v42
    v_add_f32 v58, v58, v74
    v_mul_f32 v42, 0xbec3ef15, v40
    v_mul_f32 v74, 0xbf6c835e, v40
    v_fmac_f32 v42, 0x3f6c835e, v72
    v_fmac_f32 v74, 0xbec3ef15, v72
    v_sub_f32 v40, v27, v43
    v_sub_f32 v72, v59, v75
    v_add_f32 v27, v27, v43
    v_add_f32 v59, v59, v75
    v_mul_f32 v43, 0xbf0e39da, v40
    v_mul_f32 v75, 0xbf54db31, v40
    v_fmac_f32 v43, 0x3f54db31, v72
    v_fmac_f32 v75, 0xbf0e39da, v72
    v_sub_f32 v40, v28, v44
    v_sub_f32 v72, v60, v76
    v_add_f32 v28, v28, v44
    v_add_f32 v60, v60, v76
    v_mul_f32 v44, 0xbf3504f3, v40
    v_mul_f32 v76, 0xbf3504f3, v40
    v_fmac_f32 v44, 0x3f3504f3, v72
    v_fmac_f32 v76, 0xbf3504f3, v72
    v_sub_f32 v40, v29, v45
    v_sub_f32 v72, v61, v77
    v_add_f32 v29, v29, v45
    v_add_f32 v61, v61, v77
    v_mul_f32 v45, 0xbf54db31, v40
    v_mul_f32 v77, 0xbf0e39da, v40
    v_fmac_f32 v45, 0x3f0e39da, v72
    v_fmac_f32 v77, 0xbf54db31, v72
    v_sub_f32 v40, v30, v46
    v_sub_f32 v72, v62, v78
    v_add_f32 v30, v30, v46
    v_add_f32 v62, v62, v78
    v_mul_f32 v46, 0xbf6c835e, v40
    v_mul_f32 v78, 0xbec3ef15, v40
    v_fmac_f32 v46, 0x3ec3ef15, v72
    v_fmac_f32 v78, 0xbf6c835e, v72
    v_sub_f32 v40, v31, v47
    v_sub_f32 v72, v63, v79
    v_add_f32 v31, v31, v47
    v_add_f32 v63, v63, v79
    v_mul_f32 v47, 0xbf7b14be, v40
    v_mul_f32 v79, 0xbe47c5c2, v40
    v_fmac_f32 v47, 0x3e47c5c2, v72
    v_fmac_f32 v79, 0xbf7b14be, v72
    v_sub_f32 v40, v16, v24
    v_sub_f32 v72, v48, v56
    v_add_f32 v16, v16, v24
    v_add_f32 v48, v48, v56
    v_sub_f32 v24, v17, v25
    v_sub_f32 v56, v49, v57
    v_add_f32 v17, v17, v25
    v_add_f32 v49, v49, v57
    v_mul_f32 v25, 0x3f6c835e, v24
    v_mul_f32 v57, 0xbec3ef15, v24
    v_fmac_f32 v25, 0x3ec3ef15, v56
    v_fmac_f32 v57, 0x3f6c835e, v56
    v_sub_f32 v24, v18, v26
    v_sub_f32 v56, v50, v58
    v_add_f32 v18, v18, v26
    v_add_f32 v50, v50, v58
    v_mul_f32 v26, 0x3f3504f3, v24
    v_mul_f32 v58, 0xbf3504f3, v24
    v_fmac_f32 v26, 0x3f3504f3, v56
    v_fmac_f32 v58, 0x3f3504f3, v56
    v_sub_f32 v24, v19, v27
    v_sub_f32 v56, v51, v59
    v_add_f32 v19, v19, v27
    v_add_f32 v51, v51, v59
    v_mul_f32 v27, 0x3ec3ef15, v24
    v_mul_f32 v59, 0xbf6c835e, v24
    v_fmac_f32 v27, 0x3f6c835e, v56
    v_fmac_f32 v59, 0x3ec3ef15, v56
    v_sub_f32 v24, v52, v60
    v_sub_f32 v56, v28, v20
    v_add_f32 v20, v20, v28
    v_add_f32 v52, v52, v60
    v_sub_f32 v28, v21, v29
    v_sub_f32 v60, v53, v61
    v_add_f32 v21, v21, v29
    v_add_f32 v53, v53, v61
    v_mul_f32 v29, 0xbec3ef15, v28
    v_mul_f32 v61, 0xbf6c835e, v28
    v_fmac_f32 v29, 0x3f6c835e, v60
    v_fmac_f32 v61, 0xbec3ef15, v60
    v_sub_f32 v28, v22, v30
    v_sub_f32 v60, v54, v62
    v_add_f32 v22, v22, v30
    v_add_f32 v54, v54, v62
    v_mul_f32 v30, 0xbf3504f3, v28
    v_mul_f32 v62, 0xbf3504f3, v28
    v_fmac_f32 v30, 0x3f3504f3, v60
    v_fmac_f32 v62, 0xbf3504f3, v60
    v_sub_f32 v28, v23, v31
    v_sub_f32 v60, v55, v63
    v_add_f32 v23, v23, v31
    v_add_f32 v55, v55, v63
    v_mul_f32 v31, 0xbf6c835e, v28
    v_mul_f32 v63, 0xbec3ef15, v28
    v_fmac_f32 v31, 0x3ec3ef15, v60
    v_fmac_f32 v63, 0xbf6c835e, v60
    v_sub_f32 v28, v80, v32
    v_sub_f32 v60, v81, v64
    v_add_f32 v80, v80, v32
    v_add_f32 v81, v81, v64
    v_sub_f32 v32, v33, v41
    v_sub_f32 v64, v65, v73
    v_add_f32 v33, v33, v41
    v_add_f32 v65, v65, v73
    v_mul_f32 v41, 0x3f6c835e, v32
    v_mul_f32 v73, 0xbec3ef15, v32
    v_fmac_f32 v41, 0x3ec3ef15, v64
    v_fmac_f32 v73, 0x3f6c835e, v64
    v_sub_f32 v32, v34, v42
    v_sub_f32 v64, v66, v74
    v_add_f32 v34, v34, v42
    v_add_f32 v66, v66, v74
    v_mul_f32 v42, 0x3f3504f3, v32
    v_mul_f32 v74, 0xbf3504f3, v32
    v_fmac_f32 v42, 0x3f3504f3, v64
    v_fmac_f32 v74, 0x3f3504f3, v64
    v_sub_f32 v32, v35, v43
    v_sub_f32 v64, v67, v75
    v_add_f32 v35, v35, v43
    v_add_f32 v67, v67, v75
    v_mul_f32 v43, 0x3ec3ef15, v32
    v_mul_f32 v75, 0xbf6c835e, v32
    v_fmac_f32 v43, 0x3f6c835e, v64
    v_fmac_f32 v75, 0x3ec3ef15, v64
    v_sub_f32 v32, v68, v76
    v_sub_f32 v64, v44, v36
    v_add_f32 v36, v36, v44
    v_add_f32 v68, v68, v76
    v_sub_f32 v44, v37, v45
    v_sub_f32 v76, v69, v77
    v_add_f32 v37, v37, v45
    v_add_f32 v69, v69, v77
    v_mul_f32 v45, 0xbec3ef15, v44
    v_mul_f32 v77, 0xbf6c835e, v44
    v_fmac_f32 v45, 0x3f6c835e, v76
    v_fmac_f32 v77, 0xbec3ef15, v76
    v_sub_f32 v44, v38, v46
    v_sub_f32 v76, v70, v78
    v_add_f32 v38, v38, v46
    v_add_f32 v70, v70, v78
    v_mul_f32 v46, 0xbf3504f3, v44
    v_mul_f32 v78, 0xbf3504f3, v44
    v_fmac_f32 v46, 0x3f3504f3, v76
    v_fmac_f32 v78, 0xbf3504f3, v76
    v_sub_f32 v44, v39, v47
    v_sub_f32 v76, v71, v79
    v_add_f32 v39, v39, v47
    v_add_f32 v71, v71, v79
    v_mul_f32 v47, 0xbf6c835e, v44
    v_mul_f32 v79, 0xbec3ef15, v44
    v_fmac_f32 v47, 0x3ec3ef15, v76
    v_fmac_f32 v79, 0xbf6c835e, v76
    v_sub_f32 v44, v16, v20
    v_sub_f32 v76, v48, v52
    v_add_f32 v16, v16, v20
    v_add_f32 v48, v48, v52
    v_sub_f32 v20, v17, v21
    v_sub_f32 v52, v49, v53
    v_add_f32 v17, v17, v21
    v_add_f32 v49, v49, v53
    v_mul_f32 v21, 0x3f3504f3, v20
    v_mul_f32 v53, 0xbf3504f3, v20
    v_fmac_f32 v21, 0x3f3504f3, v52
    v_fmac_f32 v53, 0x3f3504f3, v52
    v_sub_f32 v20, v50, v54
    v_sub_f32 v52, v22, v18
    v_add_f32 v18, v18, v22
    v_add_f32 v50, v50, v54
    v_sub_f32 v22, v19, v23
    v_sub_f32 v54, v51, v55
    v_add_f32 v19, v19, v23
    v_add_f32 v51, v51, v55
    v_mul_f32 v23, 0xbf3504f3, v22
    v_mul_f32 v55, 0xbf3504f3, v22
    v_fmac_f32 v23, 0x3f3504f3, v54
    v_fmac_f32 v55, 0xbf3504f3, v54
    v_sub_f32 v22, v40, v24
    v_sub_f32 v54, v72, v56
    v_add_f32 v40, v40, v24
    v_add_f32 v72, v72, v56
    v_sub_f32 v24, v25, v29
    v_sub_f32 v56, v57, v61
    v_add_f32 v25, v25, v29
    v_add_f32 v57, v57, v61
    v_mul_f32 v29, 0x3f3504f3, v24
    v_mul_f32 v61, 0xbf3504f3, v24
    v_fmac_f32 v29, 0x3f3504f3, v56
    v_fmac_f32 v61, 0x3f3504f3, v56
    v_sub_f32 v24, v58, v62
    v_sub_f32 v56, v30, v26
    v_add_f32 v26, v26, v30
    v_add_f32 v58, v58, v62
    v_sub_f32 v30, v27, v31
    v_sub_f32 v62, v59, v63
    v_add_f32 v27, v27, v31
    v_add_f32 v59, v59, v63
    v_mul_f32 v31, 0xbf3504f3, v30
    v_mul_f32 v63, 0xbf3504f3, v30
    v_fmac_f32 v31, 0x3f3504f3, v62
    v_fmac_f32 v63, 0xbf3504f3, v62
    v_sub_f32 v30, v80, v36
    v_sub_f32 v62, v81, v68
    v_add_f32 v80, v80, v36
    v_add_f32 v81, v81, v68
    v_sub_f32 v36, v33, v37
    v_sub_f32 v68, v65, v69
    v_add_f32 v33, v33, v37
    v_add_f32 v65, v65, v69
    v_mul_f32 v37, 0x3f3504f3, v36
    v_mul_f32 v69, 0xbf3504f3, v36
    v_fmac_f32 v37, 0x3f3504f3, v68
    v_fmac_f32 v69, 0x3f3504f3, v68
    v_sub_f32 v36, v66, v70
    v_sub_f32 v68, v38, v34
    v_add_f32 v34, v34, v38
    v_add_f32 v66, v66, v70
    v_sub_f32 v38, v35, v39
    v_sub_f32 v70, v67, v71
    v_add_f32 v35, v35, v39
    v_add_f32 v67, v67, v71
    v_mul_f32 v39, 0xbf3504f3, v38
    v_mul_f32 v71, 0xbf3504f3, v38
    v_fmac_f32 v39, 0x3f3504f3, v70
    v_fmac_f32 v71, 0xbf3504f3, v70
    v_sub_f32 v38, v28, v32
    v_sub_f32 v70, v60, v64
    v_add_f32 v28, v28, v32
    v_add_f32 v60, v60, v64
    v_sub_f32 v32, v41, v45
    v_sub_f32 v64, v73, v77
    v_add_f32 v41, v41, v45
    v_add_f32 v73, v73, v77
    v_mul_f32 v45, 0x3f3504f3, v32
    v_mul_f32 v77, 0xbf3504f3, v32
    v_fmac_f32 v45, 0x3f3504f3, v64
    v_fmac_f32 v77, 0x3f3504f3, v64
    v_sub_f32 v32, v74, v78
    v_sub_f32 v64, v46, v42
    v_add_f32 v42, v42, v46
    v_add_f32 v74, v74, v78
    v_sub_f32 v46, v43, v47
    v_sub_f32 v78, v75, v79
    v_add_f32 v43, v43, v47
    v_add_f32 v75, v75, v79
    v_mul_f32 v47, 0xbf3504f3, v46
    v_mul_f32 v79, 0xbf3504f3, v46
    v_fmac_f32 v47, 0x3f3504f3, v78
    v_fmac_f32 v79, 0xbf3504f3, v78
    v_sub_f32 v46, v16, v18
    v_sub_f32 v78, v48, v50
    v_add_f32 v16, v16, v18
    v_add_f32 v48, v48, v50
    v_sub_f32 v18, v49, v51
    v_sub_f32 v50, v19, v17
    v_add_f32 v17, v17, v19
    v_add_f32 v49, v49, v51
    v_sub_f32 v19, v44, v20
    v_sub_f32 v51, v76, v52
    v_add_f32 v44, v44, v20
    v_add_f32 v76, v76, v52
    v_sub_f32 v20, v53, v55
    v_sub_f32 v52, v23, v21
    v_add_f32 v21, v21, v23
    v_add_f32 v53, v53, v55
    v_sub_f32 v23, v40, v26
    v_sub_f32 v55, v72, v58
    v_add_f32 v40, v40, v26
    v_add_f32 v72, v72, v58
    v_sub_f32 v26, v57, v59
    v_sub_f32 v58, v27, v25
    v_add_f32 v25, v25, v27
    v_add_f32 v57, v57, v59
    v_sub_f32 v27, v22, v24
    v_sub_f32 v59, v54, v56
    v_add_f32 v22, v22, v24
    v_add_f32 v54, v54, v56
    v_sub_f32 v24, v61, v63
    v_sub_f32 v56, v31, v29
    v_add_f32 v29, v29, v31
    v_add_f32 v61, v61, v63
    v_sub_f32 v31, v80, v34
    v_sub_f32 v63, v81, v66
    v_add_f32 v80, v80, v34
    v_add_f32 v81, v81, v66
    v_sub_f32 v34, v65, v67
    v_sub_f32 v66, v35, v33
    v_add_f32 v33, v33, v35
    v_add_f32 v65, v65, v67
    v_sub_f32 v35, v30, v36
    v_sub_f32 v67, v62, v68
    v_add_f32 v30, v30, v36
    v_add_f32 v62, v62, v68
    v_sub_f32 v36, v69, v71
    v_sub_f32 v68, v39, v37
    v_add_f32 v37, v37, v39
    v_add_f32 v69, v69, v71
    v_sub_f32 v39, v28, v42
    v_sub_f32 v71, v60, v74
    v_add_f32 v28, v28, v42
    v_add_f32 v60, v60, v74
    v_sub_f32 v42, v73, v75
    v_sub_f32 v74, v43, v41
    v_add_f32 v41, v41, v43
    v_add_f32 v73, v73, v75
    v_sub_f32 v43, v38, v32
    v_sub_f32 v75, v70, v64
    v_add_f32 v38, v38, v32
    v_add_f32 v70, v70, v64
    v_sub_f32 v32, v77, v79
    v_sub_f32 v64, v47, v45
    v_add_f32 v45, v45, v47
    v_add_f32 v77, v77, v79
    v_sub_f32 v47, v16, v17
    v_sub_f32 v79, v48, v49
    v_add_f32 v16, v16, v17
    v_add_f32 v48, v48, v49
    v_sub_f32 v17, v46, v18
    v_sub_f32 v49, v78, v50
    v_add_f32 v46, v46, v18
    v_add_f32 v78, v78, v50
    v_sub_f32 v18, v44, v21
    v_sub_f32 v50, v76, v53
    v_add_f32 v44, v44, v21
    v_add_f32 v76, v76, v53
    v_sub_f32 v21, v19, v20
    v_sub_f32 v53, v51, v52
    v_add_f32 v19, v19, v20
    v_add_f32 v51, v51, v52
    v_sub_f32 v20, v40, v25
    v_sub_f32 v52, v72, v57
    v_add_f32 v40, v40, v25
    v_add_f32 v72, v72, v57
    v_sub_f32 v25, v23, v26
    v_sub_f32 v57, v55, v58
    v_add_f32 v23, v23, v26
    v_add_f32 v55, v55, v58
    v_sub_f32 v26, v22, v29
    v_sub_f32 v58, v54, v61
    v_add_f32 v22, v22, v29
    v_add_f32 v54, v54, v61
    v_sub_f32 v29, v27, v24
    v_sub_f32 v61, v59, v56
    v_add_f32 v27, v27, v24
    v_add_f32 v59, v59, v56
    v_sub_f32 v24, v80, v33
    v_sub_f32 v56, v81, v65
    v_add_f32 v80, v80, v33
    v_add_f32 v81, v81, v65
    v_sub_f32 v33, v31, v34
    v_sub_f32 v65, v63, v66
    v_add_f32 v31, v31, v34
    v_add_f32 v63, v63, v66
    v_sub_f32 v34, v30, v37
    v_sub_f32 v66, v62, v69
    v_add_f32 v30, v30, v37
    v_add_f32 v62, v62, v69
    v_sub_f32 v37, v35, v36
    v_sub_f32 v69, v67, v68
    v_add_f32 v35, v35, v36
    v_add_f32 v67, v67, v68
    v_sub_f32 v36, v28, v41
    v_sub_f32 v68, v60, v73
    v_add_f32 v28, v28, v41
    v_add_f32 v60, v60, v73
    v_sub_f32 v41, v39, v42
    v_sub_f32 v73, v71, v74
    v_add_f32 v39, v39, v42
    v_add_f32 v71, v71, v74
    v_sub_f32 v42, v38, v45
    v_sub_f32 v74, v70, v77
    v_add_f32 v38, v38, v45
    v_add_f32 v70, v70, v77
    v_sub_f32 v45, v43, v32
    v_sub_f32 v77, v75, v64
    v_add_f32 v43, v43, v32
    v_add_f32 v75, v75, v64
    v_mul_f32 v32, 0xba800000, v3
    v_cos_f32 v64, v32
    v_sin_f32 v82, v32
    s_nop 0
    v_mul_f32 v83, v80, v64
    v_fma_f32 v83, -v81, v82, v83
    v_mul_f32 v81, v81, v64
    v_fmac_f32 v81, v80, v82
    v_mul_f32 v32, 0xbb000000, v3
    v_cos_f32 v64, v32
    v_sin_f32 v82, v32
    s_nop 0
    v_mul_f32 v80, v40, v64
    v_fma_f32 v80, -v72, v82, v80
    v_mul_f32 v72, v72, v64
    v_fmac_f32 v72, v40, v82
    v_mul_f32 v32, 0xbb400000, v3
    v_cos_f32 v64, v32
    v_sin_f32 v82, v32
    s_nop 0
    v_mul_f32 v40, v28, v64
    v_fma_f32 v40, -v60, v82, v40
    v_mul_f32 v60, v60, v64
    v_fmac_f32 v60, v28, v82
    v_mul_f32 v32, 0xbb800000, v3
    v_cos_f32 v64, v32
    v_sin_f32 v82, v32
    s_nop 0
    v_mul_f32 v28, v44, v64
    v_fma_f32 v28, -v76, v82, v28
    v_mul_f32 v76, v76, v64
    v_fmac_f32 v76, v44, v82
    v_mul_f32 v32, 0xbba00000, v3
    v_cos_f32 v64, v32
    v_sin_f32 v82, v32
    s_nop 0
    v_mul_f32 v44, v30, v64
    v_fma_f32 v44, -v62, v82, v44
    v_mul_f32 v62, v62, v64
    v_fmac_f32 v62, v30, v82
    v_mul_f32 v32, 0xbbc00000, v3
    v_cos_f32 v64, v32
    v_sin_f32 v82, v32
    s_nop 0
    v_mul_f32 v30, v22, v64
    v_fma_f32 v30, -v54, v82, v30
    v_mul_f32 v54, v54, v64
    v_fmac_f32 v54, v22, v82
    v_mul_f32 v32, 0xbbe00000, v3
    v_cos_f32 v64, v32
    v_sin_f32 v82, v32
    s_nop 0
    v_mul_f32 v22, v38, v64
    v_fma_f32 v22, -v70, v82, v22
    v_mul_f32 v70, v70, v64
    v_fmac_f32 v70, v38, v82
    v_mul_f32 v32, 0xbc000000, v3
    v_cos_f32 v64, v32
    v_sin_f32 v82, v32
    s_nop 0
    v_mul_f32 v38, v46, v64
    v_fma_f32 v38, -v78, v82, v38
    v_mul_f32 v78, v78, v64
    v_fmac_f32 v78, v46, v82
    v_mul_f32 v32, 0xbc100000, v3
    v_cos_f32 v64, v32
    v_sin_f32 v82, v32
    s_nop 0
    v_mul_f32 v46, v31, v64
    v_fma_f32 v46, -v63, v82, v46
    v_mul_f32 v63, v63, v64
    v_fmac_f32 v63, v31, v82
    v_mul_f32 v32, 0xbc200000, v3
    v_cos_f32 v64, v32
    v_sin_f32 v82, v32
    s_nop 0
    v_mul_f32 v31, v23, v64
    v_fma_f32 v31, -v55, v82, v31
    v_mul_f32 v55, v55, v64
    v_fmac_f32 v55, v23, v82
    v_mul_f32 v32, 0xbc300000, v3
    v_cos_f32 v64, v32
    v_sin_f32 v82, v32
    s_nop 0
    v_mul_f32 v23, v39, v64
    v_fma_f32 v23, -v71, v82, v23
    v_mul_f32 v71, v71, v64
    v_fmac_f32 v71, v39, v82
    v_mul_f32 v32, 0xbc400000, v3
    v_cos_f32 v64, v32
    v_sin_f32 v82, v32
    s_nop 0
    v_mul_f32 v39, v19, v64
    v_fma_f32 v39, -v51, v82, v39
    v_mul_f32 v51, v51, v64
    v_fmac_f32 v51, v19, v82
    v_mul_f32 v32, 0xbc500000, v3
    v_cos_f32 v64, v32
    v_sin_f32 v82, v32
    s_nop 0
    v_mul_f32 v19, v35, v64
    v_fma_f32 v19, -v67, v82, v19
    v_mul_f32 v67, v67, v64
    v_fmac_f32 v67, v35, v82
    v_mul_f32 v32, 0xbc600000, v3
    v_cos_f32 v64, v32
    v_sin_f32 v82, v32
    s_nop 0
    v_mul_f32 v35, v27, v64
    v_fma_f32 v35, -v59, v82, v35
    v_mul_f32 v59, v59, v64
    v_fmac_f32 v59, v27, v82
    v_mul_f32 v32, 0xbc700000, v3
    v_cos_f32 v64, v32
    v_sin_f32 v82, v32
    s_nop 0
    v_mul_f32 v27, v43, v64
    v_fma_f32 v27, -v75, v82, v27
    v_mul_f32 v75, v75, v64
    v_fmac_f32 v75, v43, v82
    v_mul_f32 v32, 0xbc800000, v3
    v_cos_f32 v64, v32
    v_sin_f32 v82, v32
    s_nop 0
    v_mul_f32 v43, v47, v64
    v_fma_f32 v43, -v79, v82, v43
    v_mul_f32 v79, v79, v64
    v_fmac_f32 v79, v47, v82
    v_mul_f32 v32, 0xbc880000, v3
    v_cos_f32 v64, v32
    v_sin_f32 v82, v32
    s_nop 0
    v_mul_f32 v47, v24, v64
    v_fma_f32 v47, -v56, v82, v47
    v_mul_f32 v56, v56, v64
    v_fmac_f32 v56, v24, v82
    v_mul_f32 v32, 0xbc900000, v3
    v_cos_f32 v64, v32
    v_sin_f32 v82, v32
    s_nop 0
    v_mul_f32 v24, v20, v64
    v_fma_f32 v24, -v52, v82, v24
    v_mul_f32 v52, v52, v64
    v_fmac_f32 v52, v20, v82
    v_mul_f32 v32, 0xbc980000, v3
    v_cos_f32 v64, v32
    v_sin_f32 v82, v32
    s_nop 0
    v_mul_f32 v20, v36, v64
    v_fma_f32 v20, -v68, v82, v20
    v_mul_f32 v68, v68, v64
    v_fmac_f32 v68, v36, v82
    v_mul_f32 v32, 0xbca00000, v3
    v_cos_f32 v64, v32
    v_sin_f32 v82, v32
    s_nop 0
    v_mul_f32 v36, v18, v64
    v_fma_f32 v36, -v50, v82, v36
    v_mul_f32 v50, v50, v64
    v_fmac_f32 v50, v18, v82
    v_mul_f32 v32, 0xbca80000, v3
    v_cos_f32 v64, v32
    v_sin_f32 v82, v32
    s_nop 0
    v_mul_f32 v18, v34, v64
    v_fma_f32 v18, -v66, v82, v18
    v_mul_f32 v66, v66, v64
    v_fmac_f32 v66, v34, v82
    v_mul_f32 v32, 0xbcb00000, v3
    v_cos_f32 v64, v32
    v_sin_f32 v82, v32
    s_nop 0
    v_mul_f32 v34, v26, v64
    v_fma_f32 v34, -v58, v82, v34
    v_mul_f32 v58, v58, v64
    v_fmac_f32 v58, v26, v82
    v_mul_f32 v32, 0xbcb80000, v3
    v_cos_f32 v64, v32
    v_sin_f32 v82, v32
    s_nop 0
    v_mul_f32 v26, v42, v64
    v_fma_f32 v26, -v74, v82, v26
    v_mul_f32 v74, v74, v64
    v_fmac_f32 v74, v42, v82
    v_mul_f32 v32, 0xbcc00000, v3
    v_cos_f32 v64, v32
    v_sin_f32 v82, v32
    s_nop 0
    v_mul_f32 v42, v17, v64
    v_fma_f32 v42, -v49, v82, v42
    v_mul_f32 v49, v49, v64
    v_fmac_f32 v49, v17, v82
    v_mul_f32 v32, 0xbcc80000, v3
    v_cos_f32 v64, v32
    v_sin_f32 v82, v32
    s_nop 0
    v_mul_f32 v17, v33, v64
    v_fma_f32 v17, -v65, v82, v17
    v_mul_f32 v65, v65, v64
    v_fmac_f32 v65, v33, v82
    v_mul_f32 v32, 0xbcd00000, v3
    v_cos_f32 v64, v32
    v_sin_f32 v82, v32
    s_nop 0
    v_mul_f32 v33, v25, v64
    v_fma_f32 v33, -v57, v82, v33
    v_mul_f32 v57, v57, v64
    v_fmac_f32 v57, v25, v82
    v_mul_f32 v32, 0xbcd80000, v3
    v_cos_f32 v64, v32
    v_sin_f32 v82, v32
    s_nop 0
    v_mul_f32 v25, v41, v64
    v_fma_f32 v25, -v73, v82, v25
    v_mul_f32 v73, v73, v64
    v_fmac_f32 v73, v41, v82
    v_mul_f32 v32, 0xbce00000, v3
    v_cos_f32 v64, v32
    v_sin_f32 v82, v32
    s_nop 0
    v_mul_f32 v41, v21, v64
    v_fma_f32 v41, -v53, v82, v41
    v_mul_f32 v53, v53, v64
    v_fmac_f32 v53, v21, v82
    v_mul_f32 v32, 0xbce80000, v3
    v_cos_f32 v64, v32
    v_sin_f32 v82, v32
    s_nop 0
    v_mul_f32 v21, v37, v64
    v_fma_f32 v21, -v69, v82, v21
    v_mul_f32 v69, v69, v64
    v_fmac_f32 v69, v37, v82
    v_mul_f32 v32, 0xbcf00000, v3
    v_cos_f32 v64, v32
    v_sin_f32 v82, v32
    s_nop 0
    v_mul_f32 v37, v29, v64
    v_fma_f32 v37, -v61, v82, v37
    v_mul_f32 v61, v61, v64
    v_fmac_f32 v61, v29, v82
    v_mul_f32 v32, 0xbcf80000, v3
    v_cos_f32 v64, v32
    v_sin_f32 v82, v32
    s_nop 0
    v_mul_f32 v29, v45, v64
    v_fma_f32 v29, -v77, v82, v29
    v_mul_f32 v77, v77, v64
    v_fmac_f32 v77, v45, v82
    ds_write_b32 v4, v16 offset:0
    ds_write_b32 v4, v48 offset:4
    ds_write_b32 v4, v83 offset:264
    ds_write_b32 v4, v81 offset:268
    ds_write_b32 v4, v80 offset:528
    ds_write_b32 v4, v72 offset:532
    ds_write_b32 v4, v40 offset:792
    ds_write_b32 v4, v60 offset:796
    ds_write_b32 v4, v28 offset:1056
    ds_write_b32 v4, v76 offset:1060
    ds_write_b32 v4, v44 offset:1320
    ds_write_b32 v4, v62 offset:1324
    ds_write_b32 v4, v30 offset:1584
    ds_write_b32 v4, v54 offset:1588
    ds_write_b32 v4, v22 offset:1848
    ds_write_b32 v4, v70 offset:1852
    ds_write_b32 v4, v38 offset:2112
    ds_write_b32 v4, v78 offset:2116
    ds_write_b32 v4, v46 offset:2376
    ds_write_b32 v4, v63 offset:2380
    ds_write_b32 v4, v31 offset:2640
    ds_write_b32 v4, v55 offset:2644
    ds_write_b32 v4, v23 offset:2904
    ds_write_b32 v4, v71 offset:2908
    ds_write_b32 v4, v39 offset:3168
    ds_write_b32 v4, v51 offset:3172
    ds_write_b32 v4, v19 offset:3432
    ds_write_b32 v4, v67 offset:3436
    ds_write_b32 v4, v35 offset:3696
    ds_write_b32 v4, v59 offset:3700
    ds_write_b32 v4, v27 offset:3960
    ds_write_b32 v4, v75 offset:3964
    ds_write_b32 v4, v43 offset:4224
    ds_write_b32 v4, v79 offset:4228
    ds_write_b32 v4, v47 offset:4488
    ds_write_b32 v4, v56 offset:4492
    ds_write_b32 v4, v24 offset:4752
    ds_write_b32 v4, v52 offset:4756
    ds_write_b32 v4, v20 offset:5016
    ds_write_b32 v4, v68 offset:5020
    ds_write_b32 v4, v36 offset:5280
    ds_write_b32 v4, v50 offset:5284
    ds_write_b32 v4, v18 offset:5544
    ds_write_b32 v4, v66 offset:5548
    ds_write_b32 v4, v34 offset:5808
    ds_write_b32 v4, v58 offset:5812
    ds_write_b32 v4, v26 offset:6072
    ds_write_b32 v4, v74 offset:6076
    ds_write_b32 v4, v42 offset:6336
    ds_write_b32 v4, v49 offset:6340
    ds_write_b32 v4, v17 offset:6600
    ds_write_b32 v4, v65 offset:6604
    ds_write_b32 v4, v33 offset:6864
    ds_write_b32 v4, v57 offset:6868
    ds_write_b32 v4, v25 offset:7128
    ds_write_b32 v4, v73 offset:7132
    ds_write_b32 v4, v41 offset:7392
    ds_write_b32 v4, v53 offset:7396
    ds_write_b32 v4, v21 offset:7656
    ds_write_b32 v4, v69 offset:7660
    ds_write_b32 v4, v37 offset:7920
    ds_write_b32 v4, v61 offset:7924
    ds_write_b32 v4, v29 offset:8184
    ds_write_b32 v4, v77 offset:8188
    s_waitcnt lgkmcnt(0)
    ds_read_b32 v16, v5 offset:0
    ds_read_b32 v48, v5 offset:4
    ds_read_b32 v83, v5 offset:8
    ds_read_b32 v81, v5 offset:12
    ds_read_b32 v80, v5 offset:16
    ds_read_b32 v72, v5 offset:20
    ds_read_b32 v40, v5 offset:24
    ds_read_b32 v60, v5 offset:28
    ds_read_b32 v28, v5 offset:32
    ds_read_b32 v76, v5 offset:36
    ds_read_b32 v44, v5 offset:40
    ds_read_b32 v62, v5 offset:44
    ds_read_b32 v30, v5 offset:48
    ds_read_b32 v54, v5 offset:52
    s_waitcnt lgkmcnt(0)
    ds_read_b32 v22, v5 offset:56
    ds_read_b32 v70, v5 offset:60
    ds_read_b32 v38, v5 offset:64
    ds_read_b32 v78, v5 offset:68
    ds_read_b32 v46, v5 offset:72
    ds_read_b32 v63, v5 offset:76
    ds_read_b32 v31, v5 offset:80
    ds_read_b32 v55, v5 offset:84
    ds_read_b32 v23, v5 offset:88
    ds_read_b32 v71, v5 offset:92
    ds_read_b32 v39, v5 offset:96
    ds_read_b32 v51, v5 offset:100
    ds_read_b32 v19, v5 offset:104
    ds_read_b32 v67, v5 offset:108
    s_waitcnt lgkmcnt(0)
    ds_read_b32 v35, v5 offset:112
    ds_read_b32 v59, v5 offset:116
    ds_read_b32 v27, v5 offset:120
    ds_read_b32 v75, v5 offset:124
    ds_read_b32 v43, v5 offset:128
    ds_read_b32 v79, v5 offset:132
    ds_read_b32 v47, v5 offset:136
    ds_read_b32 v56, v5 offset:140
    ds_read_b32 v24, v5 offset:144
    ds_read_b32 v52, v5 offset:148
    ds_read_b32 v20, v5 offset:152
    ds_read_b32 v68, v5 offset:156
    ds_read_b32 v36, v5 offset:160
    ds_read_b32 v50, v5 offset:164
    s_waitcnt lgkmcnt(0)
    ds_read_b32 v18, v5 offset:168
    ds_read_b32 v66, v5 offset:172
    ds_read_b32 v34, v5 offset:176
    ds_read_b32 v58, v5 offset:180
    ds_read_b32 v26, v5 offset:184
    ds_read_b32 v74, v5 offset:188
    ds_read_b32 v42, v5 offset:192
    ds_read_b32 v49, v5 offset:196
    ds_read_b32 v17, v5 offset:200
    ds_read_b32 v65, v5 offset:204
    ds_read_b32 v33, v5 offset:208
    ds_read_b32 v57, v5 offset:212
    ds_read_b32 v25, v5 offset:216
    ds_read_b32 v73, v5 offset:220
    s_waitcnt lgkmcnt(0)
    ds_read_b32 v41, v5 offset:224
    ds_read_b32 v53, v5 offset:228
    ds_read_b32 v21, v5 offset:232
    ds_read_b32 v69, v5 offset:236
    ds_read_b32 v37, v5 offset:240
    ds_read_b32 v61, v5 offset:244
    ds_read_b32 v29, v5 offset:248
    ds_read_b32 v77, v5 offset:252
    s_waitcnt lgkmcnt(0)
    v_sub_f32 v32, v16, v43
    v_sub_f32 v64, v48, v79
    v_add_f32 v16, v16, v43
    v_add_f32 v48, v48, v79
    v_sub_f32 v43, v83, v47
    v_sub_f32 v79, v81, v56
    v_add_f32 v83, v83, v47
    v_add_f32 v81, v81, v56
    v_mul_f32 v47, 0x3f7b14be, v43
    v_mul_f32 v56, 0xbe47c5c2, v43
    v_fmac_f32 v47, 0x3e47c5c2, v79
    v_fmac_f32 v56, 0x3f7b14be, v79
    v_sub_f32 v43, v80, v24
    v_sub_f32 v79, v72, v52
    v_add_f32 v80, v80, v24
    v_add_f32 v72, v72, v52
    v_mul_f32 v24, 0x3f6c835e, v43
    v_mul_f32 v52, 0xbec3ef15, v43
    v_fmac_f32 v24, 0x3ec3ef15, v79
    v_fmac_f32 v52, 0x3f6c835e, v79
    v_sub_f32 v43, v40, v20
    v_sub_f32 v79, v60, v68
    v_add_f32 v40, v40, v20
    v_add_f32 v60, v60, v68
    v_mul_f32 v20, 0x3f54db31, v43
    v_mul_f32 v68, 0xbf0e39da, v43
    v_fmac_f32 v20, 0x3f0e39da, v79
    v_fmac_f32 v68, 0x3f54db31, v79
    v_sub_f32 v43, v28, v36
    v_sub_f32 v79, v76, v50
    v_add_f32 v28, v28, v36
    v_add_f32 v76, v76, v50
    v_mul_f32 v36, 0x3f3504f3, v43
    v_mul_f32 v50, 0xbf3504f3, v43
    v_fmac_f32 v36, 0x3f3504f3, v79
    v_fmac_f32 v50, 0x3f3504f3, v79
    v_sub_f32 v43, v44, v18
    v_sub_f32 v79, v62, v66
    v_add_f32 v44, v44, v18
    v_add_f32 v62, v62, v66
    v_mul_f32 v18, 0x3f0e39da, v43
    v_mul_f32 v66, 0xbf54db31, v43
    v_fmac_f32 v18, 0x3f54db31, v79
    v_fmac_f32 v66, 0x3f0e39da, v79
    v_sub_f32 v43, v30, v34
    v_sub_f32 v79, v54, v58
    v_add_f32 v30, v30, v34
    v_add_f32 v54, v54, v58
    v_mul_f32 v34, 0x3ec3ef15, v43
    v_mul_f32 v58, 0xbf6c835e, v43
    v_fmac_f32 v34, 0x3f6c835e, v79
    v_fmac_f32 v58, 0x3ec3ef15, v79
    v_sub_f32 v43, v22, v26
    v_sub_f32 v79, v70, v74
    v_add_f32 v22, v22, v26
    v_add_f32 v70, v70, v74
    v_mul_f32 v26, 0x3e47c5c2, v43
    v_mul_f32 v74, 0xbf7b14be, v43
    v_fmac_f32 v26, 0x3f7b14be, v79
    v_fmac_f32 v74, 0x3e47c5c2, v79
    v_sub_f32 v43, v78, v49
    v_sub_f32 v79, v42, v38
    v_add_f32 v38, v38, v42
    v_add_f32 v78, v78, v49
    v_sub_f32 v42, v46, v17
    v_sub_f32 v49, v63, v65
    v_add_f32 v46, v46, v17
    v_add_f32 v63, v63, v65
    v_mul_f32 v17, 0xbe47c5c2, v42
    v_mul_f32 v65, 0xbf7b14be, v42
    v_fmac_f32 v17, 0x3f7b14be, v49
    v_fmac_f32 v65, 0xbe47c5c2, v49
    v_sub_f32 v42, v31, v33
    v_sub_f32 v49, v55, v57
    v_add_f32 v31, v31, v33
    v_add_f32 v55, v55, v57
    v_mul_f32 v33, 0xbec3ef15, v42
    v_mul_f32 v57, 0xbf6c835e, v42
    v_fmac_f32 v33, 0x3f6c835e, v49
    v_fmac_f32 v57, 0xbec3ef15, v49
    v_sub_f32 v42, v23, v25
    v_sub_f32 v49, v71, v73
    v_add_f32 v23, v23, v25
    v_add_f32 v71, v71, v73
    v_mul_f32 v25, 0xbf0e39da, v42
    v_mul_f32 v73, 0xbf54db31, v42
    v_fmac_f32 v25, 0x3f54db31, v49
    v_fmac_f32 v73, 0xbf0e39da, v49
    v_sub_f32 v42, v39, v41
    v_sub_f32 v49, v51, v53
    v_add_f32 v39, v39, v41
    v_add_f32 v51, v51, v53
    v_mul_f32 v41, 0xbf3504f3, v42
    v_mul_f32 v53, 0xbf3504f3, v42
    v_fmac_f32 v41, 0x3f3504f3, v49
    v_fmac_f32 v53, 0xbf3504f3, v49
    v_sub_f32 v42, v19, v21
    v_sub_f32 v49, v67, v69
    v_add_f32 v19, v19, v21
    v_add_f32 v67, v67, v69
    v_mul_f32 v21, 0xbf54db31, v42
    v_mul_f32 v69, 0xbf0e39da, v42
    v_fmac_f32 v21, 0x3f0e39da, v49
    v_fmac_f32 v69, 0xbf54db31, v49
    v_sub_f32 v42, v35, v37
    v_sub_f32 v49, v59, v61
    v_add_f32 v35, v35, v37
    v_add_f32 v59, v59, v61
    v_mul_f32 v37, 0xbf6c835e, v42
    v_mul_f32 v61, 0xbec3ef15, v42
    v_fmac_f32 v37, 0x3ec3ef15, v49
    v_fmac_f32 v61, 0xbf6c835e, v49
    v_sub_f32 v42, v27, v29
    v_sub_f32 v49, v75, v77
    v_add_f32 v27, v27, v29
    v_add_f32 v75, v75, v77
    v_mul_f32 v29, 0xbf7b14be, v42
    v_mul_f32 v77, 0xbe47c5c2, v42
    v_fmac_f32 v29, 0x3e47c5c2, v49
    v_fmac_f32 v77, 0xbf7b14be, v49
    v_sub_f32 v42, v16, v38
    v_sub_f32 v49, v48, v78
    v_add_f32 v16, v16, v38
    v_add_f32 v48, v48, v78
    v_sub_f32 v38, v83, v46
    v_sub_f32 v78, v81, v63
    v_add_f32 v83, v83, v46
    v_add_f32 v81, v81, v63
    v_mul_f32 v46, 0x3f6c835e, v38
    v_mul_f32 v63, 0xbec3ef15, v38
    v_fmac_f32 v46, 0x3ec3ef15, v78
    v_fmac_f32 v63, 0x3f6c835e, v78
    v_sub_f32 v38, v80, v31
    v_sub_f32 v78, v72, v55
    v_add_f32 v80, v80, v31
    v_add_f32 v72, v72, v55
    v_mul_f32 v31, 0x3f3504f3, v38
    v_mul_f32 v55, 0xbf3504f3, v38
    v_fmac_f32 v31, 0x3f3504f3, v78
    v_fmac_f32 v55, 0x3f3504f3, v78
    v_sub_f32 v38, v40, v23
    v_sub_f32 v78, v60, v71
    v_add_f32 v40, v40, v23
    v_add_f32 v60, v60, v71
    v_mul_f32 v23, 0x3ec3ef15, v38
    v_mul_f32 v71, 0xbf6c835e, v38
    v_fmac_f32 v23, 0x3f6c835e, v78
    v_fmac_f32 v71, 0x3ec3ef15, v78
    v_sub_f32 v38, v76, v51
    v_sub_f32 v78, v39, v28
    v_add_f32 v28, v28, v39
    v_add_f32 v76, v76, v51
    v_sub_f32 v39, v44, v19
    v_sub_f32 v51, v62, v67
    v_add_f32 v44, v44, v19
    v_add_f32 v62, v62, v67
    v_mul_f32 v19, 0xbec3ef15, v39
    v_mul_f32 v67, 0xbf6c835e, v39
    v_fmac_f32 v19, 0x3f6c835e, v51
    v_fmac_f32 v67, 0xbec3ef15, v51
    v_sub_f32 v39, v30, v35
    v_sub_f32 v51, v54, v59
    v_add_f32 v30, v30, v35
    v_add_f32 v54, v54, v59
    v_mul_f32 v35, 0xbf3504f3, v39
    v_mul_f32 v59, 0xbf3504f3, v39
    v_fmac_f32 v35, 0x3f3504f3, v51
    v_fmac_f32 v59, 0xbf3504f3, v51
    v_sub_f32 v39, v22, v27
    v_sub_f32 v51, v70, v75
    v_add_f32 v22, v22, v27
    v_add_f32 v70, v70, v75
    v_mul_f32 v27, 0xbf6c835e, v39
    v_mul_f32 v75, 0xbec3ef15, v39
    v_fmac_f32 v27, 0x3ec3ef15, v51
    v_fmac_f32 v75, 0xbf6c835e, v51
    v_sub_f32 v39, v32, v43
    v_sub_f32 v51, v64, v79
    v_add_f32 v32, v32, v43
    v_add_f32 v64, v64, v79
    v_sub_f32 v43, v47, v17
    v_sub_f32 v79, v56, v65
    v_add_f32 v47, v47, v17
    v_add_f32 v56, v56, v65
    v_mul_f32 v17, 0x3f6c835e, v43
    v_mul_f32 v65, 0xbec3ef15, v43
    v_fmac_f32 v17, 0x3ec3ef15, v79
    v_fmac_f32 v65, 0x3f6c835e, v79
    v_sub_f32 v43, v24, v33
    v_sub_f32 v79, v52, v57
    v_add_f32 v24, v24, v33
    v_add_f32 v52, v52, v57
    v_mul_f32 v33, 0x3f3504f3, v43
    v_mul_f32 v57, 0xbf3504f3, v43
    v_fmac_f32 v33, 0x3f3504f3, v79
    v_fmac_f32 v57, 0x3f3504f3, v79
    v_sub_f32 v43, v20, v25
    v_sub_f32 v79, v68, v73
    v_add_f32 v20, v20, v25
    v_add_f32 v68, v68, v73
    v_mul_f32 v25, 0x3ec3ef15, v43
    v_mul_f32 v73, 0xbf6c835e, v43
    v_fmac_f32 v25, 0x3f6c835e, v79
    v_fmac_f32 v73, 0x3ec3ef15, v79
    v_sub_f32 v43, v50, v53
    v_sub_f32 v79, v41, v36
    v_add_f32 v36, v36, v41
    v_add_f32 v50, v50, v53
    v_sub_f32 v41, v18, v21
    v_sub_f32 v53, v66, v69
    v_add_f32 v18, v18, v21
    v_add_f32 v66, v66, v69
    v_mul_f32 v21, 0xbec3ef15, v41
    v_mul_f32 v69, 0xbf6c835e, v41
    v_fmac_f32 v21, 0x3f6c835e, v53
    v_fmac_f32 v69, 0xbec3ef15, v53
    v_sub_f32 v41, v34, v37
    v_sub_f32 v53, v58, v61
    v_add_f32 v34, v34, v37
    v_add_f32 v58, v58, v61
    v_mul_f32 v37, 0xbf3504f3, v41
    v_mul_f32 v61, 0xbf3504f3, v41
    v_fmac_f32 v37, 0x3f3504f3, v53
    v_fmac_f32 v61, 0xbf3504f3, v53
    v_sub_f32 v41, v26, v29
    v_sub_f32 v53, v74, v77
    v_add_f32 v26, v26, v29
    v_add_f32 v74, v74, v77
    v_mul_f32 v29, 0xbf6c835e, v41
    v_mul_f32 v77, 0xbec3ef15, v41
    v_fmac_f32 v29, 0x3ec3ef15, v53
    v_fmac_f32 v77, 0xbf6c835e, v53
    v_sub_f32 v41, v16, v28
    v_sub_f32 v53, v48, v76
    v_add_f32 v16, v16, v28
    v_add_f32 v48, v48, v76
    v_sub_f32 v28, v83, v44
    v_sub_f32 v76, v81, v62
    v_add_f32 v83, v83, v44
    v_add_f32 v81, v81, v62
    v_mul_f32 v44, 0x3f3504f3, v28
    v_mul_f32 v62, 0xbf3504f3, v28
    v_fmac_f32 v44, 0x3f3504f3, v76
    v_fmac_f32 v62, 0x3f3504f3, v76
    v_sub_f32 v28, v72, v54
    v_sub_f32 v76, v30, v80
    v_add_f32 v80, v80, v30
    v_add_f32 v72, v72, v54
    v_sub_f32 v30, v40, v22
    v_sub_f32 v54, v60, v70
    v_add_f32 v40, v40, v22
    v_add_f32 v60, v60, v70
    v_mul_f32 v22, 0xbf3504f3, v30
    v_mul_f32 v70, 0xbf3504f3, v30
    v_fmac_f32 v22, 0x3f3504f3, v54
    v_fmac_f32 v70, 0xbf3504f3, v54
    v_sub_f32 v30, v42, v38
    v_sub_f32 v54, v49, v78
    v_add_f32 v42, v42, v38
    v_add_f32 v49, v49, v78
    v_sub_f32 v38, v46, v19
    v_sub_f32 v78, v63, v67
    v_add_f32 v46, v46, v19
    v_add_f32 v63, v63, v67
    v_mul_f32 v19, 0x3f3504f3, v38
    v_mul_f32 v67, 0xbf3504f3, v38
    v_fmac_f32 v19, 0x3f3504f3, v78
    v_fmac_f32 v67, 0x3f3504f3, v78
    v_sub_f32 v38, v55, v59
    v_sub_f32 v78, v35, v31
    v_add_f32 v31, v31, v35
    v_add_f32 v55, v55, v59
    v_sub_f32 v35, v23, v27
    v_sub_f32 v59, v71, v75
    v_add_f32 v23, v23, v27
    v_add_f32 v71, v71, v75
    v_mul_f32 v27, 0xbf3504f3, v35
    v_mul_f32 v75, 0xbf3504f3, v35
    v_fmac_f32 v27, 0x3f3504f3, v59
    v_fmac_f32 v75, 0xbf3504f3, v59
    v_sub_f32 v35, v32, v36
    v_sub_f32 v59, v64, v50
    v_add_f32 v32, v32, v36
    v_add_f32 v64, v64, v50
    v_sub_f32 v36, v47, v18
    v_sub_f32 v50, v56, v66
    v_add_f32 v47, v47, v18
    v_add_f32 v56, v56, v66
    v_mul_f32 v18, 0x3f3504f3, v36
    v_mul_f32 v66, 0xbf3504f3, v36
    v_fmac_f32 v18, 0x3f3504f3, v50
    v_fmac_f32 v66, 0x3f3504f3, v50
    v_sub_f32 v36, v52, v58
    v_sub_f32 v50, v34, v24
    v_add_f32 v24, v24, v34
    v_add_f32 v52, v52, v58
    v_sub_f32 v34, v20, v26
    v_sub_f32 v58, v68, v74
    v_add_f32 v20, v20, v26
    v_add_f32 v68, v68, v74
    v_mul_f32 v26, 0xbf3504f3, v34
    v_mul_f32 v74, 0xbf3504f3, v34
    v_fmac_f32 v26, 0x3f3504f3, v58
    v_fmac_f32 v74, 0xbf3504f3, v58
    v_sub_f32 v34, v39, v43
    v_sub_f32 v58, v51, v79
    v_add_f32 v39, v39, v43
    v_add_f32 v51, v51, v79
    v_sub_f32 v43, v17, v21
    v_sub_f32 v79, v65, v69
    v_add_f32 v17, v17, v21
    v_add_f32 v65, v65, v69
    v_mul_f32 v21, 0x3f3504f3, v43
    v_mul_f32 v69, 0xbf3504f3, v43
    v_fmac_f32 v21, 0x3f3504f3, v79
    v_fmac_f32 v69, 0x3f3504f3, v79
    v_sub_f32 v43, v57, v61
    v_sub_f32 v79, v37, v33
    v_add_f32 v33, v33, v37
    v_add_f32 v57, v57, v61
    v_sub_f32 v37, v25, v29
    v_sub_f32 v61, v73, v77
    v_add_f32 v25, v25, v29
    v_add_f32 v73, v73, v77
    v_mul_f32 v29, 0xbf3504f3, v37
    v_mul_f32 v77, 0xbf3504f3, v37
    v_fmac_f32 v29, 0x3f3504f3, v61
    v_fmac_f32 v77, 0xbf3504f3, v61
    v_sub_f32 v37, v16, v80
    v_sub_f32 v61, v48, v72
    v_add_f32 v16, v16, v80
    v_add_f32 v48, v48, v72
    v_sub_f32 v80, v81, v60
    v_sub_f32 v72, v40, v83
    v_add_f32 v83, v83, v40
    v_add_f32 v81, v81, v60
    v_sub_f32 v40, v41, v28
    v_sub_f32 v60, v53, v76
    v_add_f32 v41, v41, v28
    v_add_f32 v53, v53, v76
    v_sub_f32 v28, v62, v70
    v_sub_f32 v76, v22, v44
    v_add_f32 v44, v44, v22
    v_add_f32 v62, v62, v70
    v_sub_f32 v22, v42, v31
    v_sub_f32 v70, v49, v55
    v_add_f32 v42, v42, v31
    v_add_f32 v49, v49, v55
    v_sub_f32 v31, v63, v71
    v_sub_f32 v55, v23, v46
    v_add_f32 v46, v46, v23
    v_add_f32 v63, v63, v71
    v_sub_f32 v23, v30, v38
    v_sub_f32 v71, v54, v78
    v_add_f32 v30, v30, v38
    v_add_f32 v54, v54, v78
    v_sub_f32 v38, v67, v75
    v_sub_f32 v78, v27, v19
    v_add_f32 v19, v19, v27
    v_add_f32 v67, v67, v75
    v_sub_f32 v27, v32, v24
    v_sub_f32 v75, v64, v52
    v_add_f32 v32, v32, v24
    v_add_f32 v64, v64, v52
    v_sub_f32 v24, v56, v68
    v_sub_f32 v52, v20, v47
    v_add_f32 v47, v47, v20
    v_add_f32 v56, v56, v68
    v_sub_f32 v20, v35, v36
    v_sub_f32 v68, v59, v50
    v_add_f32 v35, v35, v36
    v_add_f32 v59, v59, v50
    v_sub_f32 v36, v66, v74
    v_sub_f32 v50, v26, v18
    v_add_f32 v18, v18, v26
    v_add_f32 v66, v66, v74
    v_sub_f32 v26, v39, v33
    v_sub_f32 v74, v51, v57
    v_add_f32 v39, v39, v33
    v_add_f32 v51, v51, v57
    v_sub_f32 v33, v65, v73
    v_sub_f32 v57, v25, v17
    v_add_f32 v17, v17, v25
    v_add_f32 v65, v65, v73
    v_sub_f32 v25, v34, v43
    v_sub_f32 v73, v58, v79
    v_add_f32 v34, v34, v43
    v_add_f32 v58, v58, v79
    v_sub_f32 v43, v69, v77
    v_sub_f32 v79, v29, v21
    v_add_f32 v21, v21, v29
    v_add_f32 v69, v69, v77
    v_sub_f32 v29, v16, v83
    v_sub_f32 v77, v48, v81
    v_add_f32 v16, v16, v83
    v_add_f32 v48, v48, v81
    v_sub_f32 v83, v37, v80
    v_sub_f32 v81, v61, v72
    v_add_f32 v37, v37, v80
    v_add_f32 v61, v61, v72
    v_sub_f32 v80, v41, v44
    v_sub_f32 v72, v53, v62
    v_add_f32 v41, v41, v44
    v_add_f32 v53, v53, v62
    v_sub_f32 v44, v40, v28
    v_sub_f32 v62, v60, v76
    v_add_f32 v40, v40, v28
    v_add_f32 v60, v60, v76
    v_sub_f32 v28, v42, v46
    v_sub_f32 v76, v49, v63
    v_add_f32 v42, v42, v46
    v_add_f32 v49, v49, v63
    v_sub_f32 v46, v22, v31
    v_sub_f32 v63, v70, v55
    v_add_f32 v22, v22, v31
    v_add_f32 v70, v70, v55
    v_sub_f32 v31, v30, v19
    v_sub_f32 v55, v54, v67
    v_add_f32 v30, v30, v19
    v_add_f32 v54, v54, v67
    v_sub_f32 v19, v23, v38
    v_sub_f32 v67, v71, v78
    v_add_f32 v23, v23, v38
    v_add_f32 v71, v71, v78
    v_sub_f32 v38, v32, v47
    v_sub_f32 v78, v64, v56
    v_add_f32 v32, v32, v47
    v_add_f32 v64, v64, v56
    v_sub_f32 v47, v27, v24
    v_sub_f32 v56, v75, v52
    v_add_f32 v27, v27, v24
    v_add_f32 v75, v75, v52
    v_sub_f32 v24, v35, v18
    v_sub_f32 v52, v59, v66
    v_add_f32 v35, v35, v18
    v_add_f32 v59, v59, v66
    v_sub_f32 v18, v20, v36
    v_sub_f32 v66, v68, v50
    v_add_f32 v20, v20, v36
    v_add_f32 v68, v68, v50
    v_sub_f32 v36, v39, v17
    v_sub_f32 v50, v51, v65
    v_add_f32 v39, v39, v17
    v_add_f32 v51, v51, v65
    v_sub_f32 v17, v26, v33
    v_sub_f32 v65, v74, v57
    v_add_f32 v26, v26, v33
    v_add_f32 v74, v74, v57
    v_sub_f32 v33, v34, v21
    v_sub_f32 v57, v58, v69
    v_add_f32 v34, v34, v21
    v_add_f32 v58, v58, v69
    v_sub_f32 v21, v25, v43
    v_sub_f32 v69, v73, v79
    v_add_f32 v25, v25, v43
    v_add_f32 v73, v73, v79
    ds_write_b32 v4, v16 offset:0
    ds_write_b32 v4, v48 offset:4
    ds_write_b32 v4, v32 offset:256
    ds_write_b32 v4, v64 offset:260
    ds_write_b32 v4, v42 offset:512
    ds_write_b32 v4, v49 offset:516
    ds_write_b32 v4, v39 offset:768
    ds_write_b32 v4, v51 offset:772
    ds_write_b32 v4, v41 offset:1024
    ds_write_b32 v4, v53 offset:1028
    ds_write_b32 v4, v35 offset:1280
    ds_write_b32 v4, v59 offset:1284
    ds_write_b32 v4, v30 offset:1536
    ds_write_b32 v4, v54 offset:1540
    ds_write_b32 v4, v34 offset:1792
    ds_write_b32 v4, v58 offset:1796
    ds_write_b32 v4, v37 offset:2048
    ds_write_b32 v4, v61 offset:2052
    ds_write_b32 v4, v27 offset:2304
    ds_write_b32 v4, v75 offset:2308
    ds_write_b32 v4, v22 offset:2560
    ds_write_b32 v4, v70 offset:2564
    ds_write_b32 v4, v26 offset:2816
    ds_write_b32 v4, v74 offset:2820
    ds_write_b32 v4, v40 offset:3072
    ds_write_b32 v4, v60 offset:3076
    ds_write_b32 v4, v20 offset:3328
    ds_write_b32 v4, v68 offset:3332
    ds_write_b32 v4, v23 offset:3584
    ds_write_b32 v4, v71 offset:3588
    ds_write_b32 v4, v25 offset:3840
    ds_write_b32 v4, v73 offset:3844
    ds_write_b32 v4, v29 offset:4096
    ds_write_b32 v4, v77 offset:4100
    ds_write_b32 v4, v38 offset:4352
    ds_write_b32 v4, v78 offset:4356
    ds_write_b32 v4, v28 offset:4608
    ds_write_b32 v4, v76 offset:4612
    ds_write_b32 v4, v36 offset:4864
    ds_write_b32 v4, v50 offset:4868
    ds_write_b32 v4, v80 offset:5120
    ds_write_b32 v4, v72 offset:5124
    ds_write_b32 v4, v24 offset:5376
    ds_write_b32 v4, v52 offset:5380
    ds_write_b32 v4, v31 offset:5632
    ds_write_b32 v4, v55 offset:5636
    ds_write_b32 v4, v33 offset:5888
    ds_write_b32 v4, v57 offset:5892
    ds_write_b32 v4, v83 offset:6144
    ds_write_b32 v4, v81 offset:6148
    ds_write_b32 v4, v47 offset:6400
    ds_write_b32 v4, v56 offset:6404
    ds_write_b32 v4, v46 offset:6656
    ds_write_b32 v4, v63 offset:6660
    ds_write_b32 v4, v17 offset:6912
    ds_write_b32 v4, v65 offset:6916
    ds_write_b32 v4, v44 offset:7168
    ds_write_b32 v4, v62 offset:7172
    ds_write_b32 v4, v18 offset:7424
    ds_write_b32 v4, v66 offset:7428
    ds_write_b32 v4, v19 offset:7680
    ds_write_b32 v4, v67 offset:7684
    ds_write_b32 v4, v21 offset:7936
    ds_write_b32 v4, v69 offset:7940
    s_waitcnt lgkmcnt(0)
    s_barrier
    s_add_u32 m0, s56, 0
    s_add_u32 s58, s57, 0
    s_and_b32 s58, s58, 0xffff
    s_lshl_b32 s58, s58, 5
    buffer_load_dwordx4 v200, s[52:55], s58 offen lds
    s_add_u32 m0, s56, 1024
    s_add_u32 s58, s57, 1024
    s_and_b32 s58, s58, 0xffff
    s_lshl_b32 s58, s58, 5
    buffer_load_dwordx4 v200, s[52:55], s58 offen lds
    s_add_u32 m0, s56, 2048
    s_add_u32 s58, s57, 2048
    s_and_b32 s58, s58, 0xffff
    s_lshl_b32 s58, s58, 5
    buffer_load_dwordx4 v200, s[52:55], s58 offen lds
    s_add_u32 m0, s56, 3072
    s_add_u32 s58, s57, 3072
    s_and_b32 s58, s58, 0xffff
    s_lshl_b32 s58, s58, 5
    buffer_load_dwordx4 v200, s[52:55], s58 offen lds
    s_add_u32 m0, s56, 4096
    s_add_u32 s58, s57, 4096
    s_and_b32 s58, s58, 0xffff
    s_lshl_b32 s58, s58, 5
    buffer_load_dwordx4 v200, s[52:55], s58 offen lds
    s_add_u32 m0, s56, 5120
    s_add_u32 s58, s57, 5120
    s_and_b32 s58, s58, 0xffff
    s_lshl_b32 s58, s58, 5
    buffer_load_dwordx4 v200, s[52:55], s58 offen lds
    s_add_u32 m0, s56, 6144
    s_add_u32 s58, s57, 6144
    s_and_b32 s58, s58, 0xffff
    s_lshl_b32 s58, s58, 5
    buffer_load_dwordx4 v200, s[52:55], s58 offen lds
    s_add_u32 m0, s56, 7168
    s_add_u32 s58, s57, 7168
    s_and_b32 s58, s58, 0xffff
    s_lshl_b32 s58, s58, 5
    buffer_load_dwordx4 v200, s[52:55], s58 offen lds
    s_add_u32 m0, s56, 8192
    s_add_u32 s58, s57, 8192
    s_and_b32 s58, s58, 0xffff
    s_lshl_b32 s58, s58, 5
    buffer_load_dwordx4 v200, s[52:55], s58 offen lds
    s_add_u32 m0, s56, 9216
    s_add_u32 s58, s57, 9216
    s_and_b32 s58, s58, 0xffff
    s_lshl_b32 s58, s58, 5
    buffer_load_dwordx4 v200, s[52:55], s58 offen lds
    s_add_u32 m0, s56, 10240
    s_add_u32 s58, s57, 10240
    s_and_b32 s58, s58, 0xffff
    s_lshl_b32 s58, s58, 5
    buffer_load_dwordx4 v200, s[52:55], s58 offen lds
    s_add_u32 m0, s56, 11264
    s_add_u32 s58, s57, 11264
    s_and_b32 s58, s58, 0xffff
    s_lshl_b32 s58, s58, 5
    buffer_load_dwordx4 v200, s[52:55], s58 offen lds
    s_add_u32 m0, s56, 12288
    s_add_u32 s58, s57, 12288
    s_and_b32 s58, s58, 0xffff
    s_lshl_b32 s58, s58, 5
    buffer_load_dwordx4 v200, s[52:55], s58 offen lds
    s_add_u32 m0, s56, 13312
    s_add_u32 s58, s57, 13312
    s_and_b32 s58, s58, 0xffff
    s_lshl_b32 s58, s58, 5
    buffer_load_dwordx4 v200, s[52:55], s58 offen lds
    s_add_u32 m0, s56, 14336
    s_add_u32 s58, s57, 14336
    s_and_b32 s58, s58, 0xffff
    s_lshl_b32 s58, s58, 5
    buffer_load_dwordx4 v200, s[52:55], s58 offen lds
    s_add_u32 m0, s56, 15360
    s_add_u32 s58, s57, 15360
    s_and_b32 s58, s58, 0xffff
    s_lshl_b32 s58, s58, 5
    buffer_load_dwordx4 v200, s[52:55], s58 offen lds
    v_and_b32 v6, 7, v0
    v_lshrrev_b32 v7, 3, v0
    s_movk_i32 s13, 8448
    v_mul_lo_u32 v8, v6, s13
    v_lshl_add_u32 v4, v7, 3, v8
    v_lshlrev_b32 v5, 14, v7
    v_lshl_add_u32 v5, v6, 4, v5
    s_lshl_b32 s12, s92, 7
    s_add_u32 s12, s12, 96468992
    v_sub_u32 v6, 1024, v7
    v_and_b32 v6, 1023, v6
    v_lshl_add_u32 v6, v6, 3, v8
    ds_read_b64 v[16:17], v4 offset:0
    ds_read_b64 v[18:19], v6
    s_waitcnt lgkmcnt(0)
    v_add_f32 v20, v16, v18
    v_sub_f32 v21, v17, v19
    v_add_f32 v22, v17, v19
    v_sub_f32 v23, v18, v16
    s_mov_b32 s13, s12
    s_add_u32 s13, s12, 0
    buffer_store_dwordx4 v[20:23], v5, s[8:11], s13 offen sc1
    s_nop 1
    v_sub_u32 v6, 992, v7
    v_and_b32 v6, 1023, v6
    v_lshl_add_u32 v6, v6, 3, v8
    ds_read_b64 v[16:17], v4 offset:256
    ds_read_b64 v[18:19], v6
    s_waitcnt lgkmcnt(0)
    v_add_f32 v20, v16, v18
    v_sub_f32 v21, v17, v19
    v_add_f32 v22, v17, v19
    v_sub_f32 v23, v18, v16
    s_mov_b32 s13, s12
    s_add_u32 s13, s12, 524288
    buffer_store_dwordx4 v[20:23], v5, s[8:11], s13 offen sc1
    s_nop 1
    v_sub_u32 v6, 960, v7
    v_and_b32 v6, 1023, v6
    v_lshl_add_u32 v6, v6, 3, v8
    ds_read_b64 v[16:17], v4 offset:512
    ds_read_b64 v[18:19], v6
    s_waitcnt lgkmcnt(0)
    v_add_f32 v20, v16, v18
    v_sub_f32 v21, v17, v19
    v_add_f32 v22, v17, v19
    v_sub_f32 v23, v18, v16
    s_mov_b32 s13, s12
    s_add_u32 s13, s12, 1048576
    buffer_store_dwordx4 v[20:23], v5, s[8:11], s13 offen sc1
    s_nop 1
    v_sub_u32 v6, 928, v7
    v_and_b32 v6, 1023, v6
    v_lshl_add_u32 v6, v6, 3, v8
    ds_read_b64 v[16:17], v4 offset:768
    ds_read_b64 v[18:19], v6
    s_waitcnt lgkmcnt(0)
    v_add_f32 v20, v16, v18
    v_sub_f32 v21, v17, v19
    v_add_f32 v22, v17, v19
    v_sub_f32 v23, v18, v16
    s_mov_b32 s13, s12
    s_add_u32 s13, s12, 1572864
    buffer_store_dwordx4 v[20:23], v5, s[8:11], s13 offen sc1
    s_nop 1
    v_sub_u32 v6, 896, v7
    v_and_b32 v6, 1023, v6
    v_lshl_add_u32 v6, v6, 3, v8
    ds_read_b64 v[16:17], v4 offset:1024
    ds_read_b64 v[18:19], v6
    s_waitcnt lgkmcnt(0)
    v_add_f32 v20, v16, v18
    v_sub_f32 v21, v17, v19
    v_add_f32 v22, v17, v19
    v_sub_f32 v23, v18, v16
    s_mov_b32 s13, s12
    s_add_u32 s13, s12, 2097152
    buffer_store_dwordx4 v[20:23], v5, s[8:11], s13 offen sc1
    s_nop 1
    v_sub_u32 v6, 864, v7
    v_and_b32 v6, 1023, v6
    v_lshl_add_u32 v6, v6, 3, v8
    ds_read_b64 v[16:17], v4 offset:1280
    ds_read_b64 v[18:19], v6
    s_waitcnt lgkmcnt(0)
    v_add_f32 v20, v16, v18
    v_sub_f32 v21, v17, v19
    v_add_f32 v22, v17, v19
    v_sub_f32 v23, v18, v16
    s_mov_b32 s13, s12
    s_add_u32 s13, s12, 2621440
    buffer_store_dwordx4 v[20:23], v5, s[8:11], s13 offen sc1
    s_nop 1
    v_sub_u32 v6, 832, v7
    v_and_b32 v6, 1023, v6
    v_lshl_add_u32 v6, v6, 3, v8
    ds_read_b64 v[16:17], v4 offset:1536
    ds_read_b64 v[18:19], v6
    s_waitcnt lgkmcnt(0)
    v_add_f32 v20, v16, v18
    v_sub_f32 v21, v17, v19
    v_add_f32 v22, v17, v19
    v_sub_f32 v23, v18, v16
    s_mov_b32 s13, s12
    s_add_u32 s13, s12, 3145728
    buffer_store_dwordx4 v[20:23], v5, s[8:11], s13 offen sc1
    s_nop 1
    v_sub_u32 v6, 800, v7
    v_and_b32 v6, 1023, v6
    v_lshl_add_u32 v6, v6, 3, v8
    ds_read_b64 v[16:17], v4 offset:1792
    ds_read_b64 v[18:19], v6
    s_waitcnt lgkmcnt(0)
    v_add_f32 v20, v16, v18
    v_sub_f32 v21, v17, v19
    v_add_f32 v22, v17, v19
    v_sub_f32 v23, v18, v16
    s_mov_b32 s13, s12
    s_add_u32 s13, s12, 3670016
    buffer_store_dwordx4 v[20:23], v5, s[8:11], s13 offen sc1
    s_nop 1
    v_sub_u32 v6, 768, v7
    v_and_b32 v6, 1023, v6
    v_lshl_add_u32 v6, v6, 3, v8
    ds_read_b64 v[16:17], v4 offset:2048
    ds_read_b64 v[18:19], v6
    s_waitcnt lgkmcnt(0)
    v_add_f32 v20, v16, v18
    v_sub_f32 v21, v17, v19
    v_add_f32 v22, v17, v19
    v_sub_f32 v23, v18, v16
    s_mov_b32 s13, s12
    s_add_u32 s13, s12, 4194304
    buffer_store_dwordx4 v[20:23], v5, s[8:11], s13 offen sc1
    s_nop 1
    v_sub_u32 v6, 736, v7
    v_and_b32 v6, 1023, v6
    v_lshl_add_u32 v6, v6, 3, v8
    ds_read_b64 v[16:17], v4 offset:2304
    ds_read_b64 v[18:19], v6
    s_waitcnt lgkmcnt(0)
    v_add_f32 v20, v16, v18
    v_sub_f32 v21, v17, v19
    v_add_f32 v22, v17, v19
    v_sub_f32 v23, v18, v16
    s_mov_b32 s13, s12
    s_add_u32 s13, s12, 4718592
    buffer_store_dwordx4 v[20:23], v5, s[8:11], s13 offen sc1
    s_nop 1
    v_sub_u32 v6, 704, v7
    v_and_b32 v6, 1023, v6
    v_lshl_add_u32 v6, v6, 3, v8
    ds_read_b64 v[16:17], v4 offset:2560
    ds_read_b64 v[18:19], v6
    s_waitcnt lgkmcnt(0)
    v_add_f32 v20, v16, v18
    v_sub_f32 v21, v17, v19
    v_add_f32 v22, v17, v19
    v_sub_f32 v23, v18, v16
    s_mov_b32 s13, s12
    s_add_u32 s13, s12, 5242880
    buffer_store_dwordx4 v[20:23], v5, s[8:11], s13 offen sc1
    s_nop 1
    v_sub_u32 v6, 672, v7
    v_and_b32 v6, 1023, v6
    v_lshl_add_u32 v6, v6, 3, v8
    ds_read_b64 v[16:17], v4 offset:2816
    ds_read_b64 v[18:19], v6
    s_waitcnt lgkmcnt(0)
    v_add_f32 v20, v16, v18
    v_sub_f32 v21, v17, v19
    v_add_f32 v22, v17, v19
    v_sub_f32 v23, v18, v16
    s_mov_b32 s13, s12
    s_add_u32 s13, s12, 5767168
    buffer_store_dwordx4 v[20:23], v5, s[8:11], s13 offen sc1
    s_nop 1
    v_sub_u32 v6, 640, v7
    v_and_b32 v6, 1023, v6
    v_lshl_add_u32 v6, v6, 3, v8
    ds_read_b64 v[16:17], v4 offset:3072
    ds_read_b64 v[18:19], v6
    s_waitcnt lgkmcnt(0)
    v_add_f32 v20, v16, v18
    v_sub_f32 v21, v17, v19
    v_add_f32 v22, v17, v19
    v_sub_f32 v23, v18, v16
    s_mov_b32 s13, s12
    s_add_u32 s13, s12, 6291456
    buffer_store_dwordx4 v[20:23], v5, s[8:11], s13 offen sc1
    s_nop 1
    v_sub_u32 v6, 608, v7
    v_and_b32 v6, 1023, v6
    v_lshl_add_u32 v6, v6, 3, v8
    ds_read_b64 v[16:17], v4 offset:3328
    ds_read_b64 v[18:19], v6
    s_waitcnt lgkmcnt(0)
    v_add_f32 v20, v16, v18
    v_sub_f32 v21, v17, v19
    v_add_f32 v22, v17, v19
    v_sub_f32 v23, v18, v16
    s_mov_b32 s13, s12
    s_add_u32 s13, s12, 6815744
    buffer_store_dwordx4 v[20:23], v5, s[8:11], s13 offen sc1
    s_nop 1
    v_sub_u32 v6, 576, v7
    v_and_b32 v6, 1023, v6
    v_lshl_add_u32 v6, v6, 3, v8
    ds_read_b64 v[16:17], v4 offset:3584
    ds_read_b64 v[18:19], v6
    s_waitcnt lgkmcnt(0)
    v_add_f32 v20, v16, v18
    v_sub_f32 v21, v17, v19
    v_add_f32 v22, v17, v19
    v_sub_f32 v23, v18, v16
    s_mov_b32 s13, s12
    s_add_u32 s13, s12, 7340032
    buffer_store_dwordx4 v[20:23], v5, s[8:11], s13 offen sc1
    s_nop 1
    v_sub_u32 v6, 544, v7
    v_and_b32 v6, 1023, v6
    v_lshl_add_u32 v6, v6, 3, v8
    ds_read_b64 v[16:17], v4 offset:3840
    ds_read_b64 v[18:19], v6
    s_waitcnt lgkmcnt(0)
    v_add_f32 v20, v16, v18
    v_sub_f32 v21, v17, v19
    v_add_f32 v22, v17, v19
    v_sub_f32 v23, v18, v16
    s_mov_b32 s13, s12
    s_add_u32 s13, s12, 7864320
    buffer_store_dwordx4 v[20:23], v5, s[8:11], s13 offen sc1
    s_nop 1
    v_sub_u32 v6, 512, v7
    v_and_b32 v6, 1023, v6
    v_lshl_add_u32 v6, v6, 3, v8
    ds_read_b64 v[16:17], v4 offset:4096
    ds_read_b64 v[18:19], v6
    s_waitcnt lgkmcnt(0)
    v_add_f32 v20, v16, v18
    v_sub_f32 v21, v17, v19
    v_add_f32 v22, v17, v19
    v_sub_f32 v23, v18, v16
    s_mov_b32 s13, s12
    v_cmp_eq_u32 vcc, 0, v7
    s_and_saveexec_b64 s[14:15], vcc
    s_add_u32 s13, s12, 8388608
    buffer_store_dwordx4 v[20:23], v5, s[8:11], s13 offen sc1
    s_nop 1
    s_mov_b64 exec, -1
    s_waitcnt vmcnt(0)
    s_barrier
    s_cmp_lg_u32 s98, 0
    s_cbranch_scc1 mega_kernel_sg_6
    v_mov_b32 v2, 1
    s_mov_b32 s81, 71360512
    s_mov_b64 exec, 1
    buffer_atomic_add v2, off, s[84:87], s81 sc1
    s_mov_b64 exec, -1
mega_kernel_sg_6:
    s_waitcnt vmcnt(0)
    ds_read_b64_tr_b16 a[0:1], v201 offset:0
    ds_read_b64_tr_b16 a[2:3], v201 offset:256
    ds_read_b64_tr_b16 a[4:5], v201 offset:1024
    ds_read_b64_tr_b16 a[6:7], v201 offset:1280
    ds_read_b64_tr_b16 a[8:9], v201 offset:2048
    ds_read_b64_tr_b16 a[10:11], v201 offset:2304
    ds_read_b64_tr_b16 a[12:13], v201 offset:3072
    ds_read_b64_tr_b16 a[14:15], v201 offset:3328
    s_waitcnt lgkmcnt(0)
    ds_read_b64_tr_b16 a[16:17], v201 offset:4096
    ds_read_b64_tr_b16 a[18:19], v201 offset:4352
    ds_read_b64_tr_b16 a[20:21], v201 offset:5120
    ds_read_b64_tr_b16 a[22:23], v201 offset:5376
    ds_read_b64_tr_b16 a[24:25], v201 offset:6144
    ds_read_b64_tr_b16 a[26:27], v201 offset:6400
    ds_read_b64_tr_b16 a[28:29], v201 offset:7168
    ds_read_b64_tr_b16 a[30:31], v201 offset:7424
    s_waitcnt lgkmcnt(0)
    ds_read_b64_tr_b16 a[32:33], v201 offset:8192
    ds_read_b64_tr_b16 a[34:35], v201 offset:8448
    ds_read_b64_tr_b16 a[36:37], v201 offset:9216
    ds_read_b64_tr_b16 a[38:39], v201 offset:9472
    ds_read_b64_tr_b16 a[40:41], v201 offset:10240
    ds_read_b64_tr_b16 a[42:43], v201 offset:10496
    ds_read_b64_tr_b16 a[44:45], v201 offset:11264
    ds_read_b64_tr_b16 a[46:47], v201 offset:11520
    s_waitcnt lgkmcnt(0)
    ds_read_b64_tr_b16 a[48:49], v201 offset:12288
    ds_read_b64_tr_b16 a[50:51], v201 offset:12544
    ds_read_b64_tr_b16 a[52:53], v201 offset:13312
    ds_read_b64_tr_b16 a[54:55], v201 offset:13568
    ds_read_b64_tr_b16 a[56:57], v201 offset:14336
    ds_read_b64_tr_b16 a[58:59], v201 offset:14592
    ds_read_b64_tr_b16 a[60:61], v201 offset:15360
    ds_read_b64_tr_b16 a[62:63], v201 offset:15616
    s_waitcnt lgkmcnt(0)
    s_add_u32 m0, s56, 0
    s_add_u32 s58, s57, 16384
    s_and_b32 s58, s58, 0xffff
    s_lshl_b32 s58, s58, 5
    buffer_load_dwordx4 v200, s[52:55], s58 offen lds
    s_add_u32 m0, s56, 1024
    s_add_u32 s58, s57, 17408
    s_and_b32 s58, s58, 0xffff
    s_lshl_b32 s58, s58, 5
    buffer_load_dwordx4 v200, s[52:55], s58 offen lds
    s_add_u32 m0, s56, 2048
    s_add_u32 s58, s57, 18432
    s_and_b32 s58, s58, 0xffff
    s_lshl_b32 s58, s58, 5
    buffer_load_dwordx4 v200, s[52:55], s58 offen lds
    s_add_u32 m0, s56, 3072
    s_add_u32 s58, s57, 19456
    s_and_b32 s58, s58, 0xffff
    s_lshl_b32 s58, s58, 5
    buffer_load_dwordx4 v200, s[52:55], s58 offen lds
    s_add_u32 m0, s56, 4096
    s_add_u32 s58, s57, 20480
    s_and_b32 s58, s58, 0xffff
    s_lshl_b32 s58, s58, 5
    buffer_load_dwordx4 v200, s[52:55], s58 offen lds
    s_add_u32 m0, s56, 5120
    s_add_u32 s58, s57, 21504
    s_and_b32 s58, s58, 0xffff
    s_lshl_b32 s58, s58, 5
    buffer_load_dwordx4 v200, s[52:55], s58 offen lds
    s_add_u32 m0, s56, 6144
    s_add_u32 s58, s57, 22528
    s_and_b32 s58, s58, 0xffff
    s_lshl_b32 s58, s58, 5
    buffer_load_dwordx4 v200, s[52:55], s58 offen lds
    s_add_u32 m0, s56, 7168
    s_add_u32 s58, s57, 23552
    s_and_b32 s58, s58, 0xffff
    s_lshl_b32 s58, s58, 5
    buffer_load_dwordx4 v200, s[52:55], s58 offen lds
    s_add_u32 m0, s56, 8192
    s_add_u32 s58, s57, 24576
    s_and_b32 s58, s58, 0xffff
    s_lshl_b32 s58, s58, 5
    buffer_load_dwordx4 v200, s[52:55], s58 offen lds
    s_add_u32 m0, s56, 9216
    s_add_u32 s58, s57, 25600
    s_and_b32 s58, s58, 0xffff
    s_lshl_b32 s58, s58, 5
    buffer_load_dwordx4 v200, s[52:55], s58 offen lds
    s_add_u32 m0, s56, 10240
    s_add_u32 s58, s57, 26624
    s_and_b32 s58, s58, 0xffff
    s_lshl_b32 s58, s58, 5
    buffer_load_dwordx4 v200, s[52:55], s58 offen lds
    s_add_u32 m0, s56, 11264
    s_add_u32 s58, s57, 27648
    s_and_b32 s58, s58, 0xffff
    s_lshl_b32 s58, s58, 5
    buffer_load_dwordx4 v200, s[52:55], s58 offen lds
    s_add_u32 m0, s56, 12288
    s_add_u32 s58, s57, 28672
    s_and_b32 s58, s58, 0xffff
    s_lshl_b32 s58, s58, 5
    buffer_load_dwordx4 v200, s[52:55], s58 offen lds
    s_add_u32 m0, s56, 13312
    s_add_u32 s58, s57, 29696
    s_and_b32 s58, s58, 0xffff
    s_lshl_b32 s58, s58, 5
    buffer_load_dwordx4 v200, s[52:55], s58 offen lds
    s_add_u32 m0, s56, 14336
    s_add_u32 s58, s57, 30720
    s_and_b32 s58, s58, 0xffff
    s_lshl_b32 s58, s58, 5
    buffer_load_dwordx4 v200, s[52:55], s58 offen lds
    s_add_u32 m0, s56, 15360
    s_add_u32 s58, s57, 31744
    s_and_b32 s58, s58, 0xffff
    s_lshl_b32 s58, s58, 5
    buffer_load_dwordx4 v200, s[52:55], s58 offen lds
    s_cmp_lg_u32 s98, 0
    s_cbranch_scc1 mega_kernel_wf1d
    s_mov_b32 s81, 71360512
mega_kernel_wf1:
    buffer_load_dword v120, off, s[84:87], s81 sc1
    s_waitcnt vmcnt(0)
    v_cmp_ne_u32 vcc, 128, v120
    s_cbranch_vccz mega_kernel_wf1d
    s_sleep 6
    s_branch mega_kernel_wf1
mega_kernel_wf1d:
    s_mov_b32 s99, s92
    s_barrier
mega_kernel_f2_in:
    s_load_dwordx2 s[8:9], s[0:1], 96
    v_lshrrev_b32 v5, 6, v0
    v_and_b32 v1, 63, v0
    v_readfirstlane_b32 s12, v5
    s_lshl_b32 s13, s99, 2
    s_add_u32 s13, s13, s12
    s_cmp_ge_u32 s13, 513
    s_cbranch_scc1 mega_kernel_f2_end
    v_cvt_f32_u32 v2, v1
    s_waitcnt lgkmcnt(0)
    s_mov_b32 s10, 268435456
    s_mov_b32 s11, 0x00020000
    s_lshl_b32 s14, s13, 14
    s_add_u32 s15, s14, 96468992
    v_lshlrev_b32 v5, 3, v1
    s_add_u32 s16, s15, 0
    buffer_load_dwordx2 v[16:17], v5, s[8:11], s16 offen
    s_add_u32 s16, s15, 512
    buffer_load_dwordx2 v[18:19], v5, s[8:11], s16 offen
    s_add_u32 s16, s15, 1024
    buffer_load_dwordx2 v[20:21], v5, s[8:11], s16 offen
    s_add_u32 s16, s15, 1536
    buffer_load_dwordx2 v[22:23], v5, s[8:11], s16 offen
    s_add_u32 s16, s15, 2048
    buffer_load_dwordx2 v[24:25], v5, s[8:11], s16 offen
    s_add_u32 s16, s15, 2560
    buffer_load_dwordx2 v[26:27], v5, s[8:11], s16 offen
    s_add_u32 s16, s15, 3072
    buffer_load_dwordx2 v[28:29], v5, s[8:11], s16 offen
    s_add_u32 s16, s15, 3584
    buffer_load_dwordx2 v[30:31], v5, s[8:11], s16 offen
    s_add_u32 s16, s15, 4096
    buffer_load_dwordx2 v[32:33], v5, s[8:11], s16 offen
    s_add_u32 s16, s15, 4608
    buffer_load_dwordx2 v[34:35], v5, s[8:11], s16 offen
    s_add_u32 s16, s15, 5120
    buffer_load_dwordx2 v[36:37], v5, s[8:11], s16 offen
    s_add_u32 s16, s15, 5632
    buffer_load_dwordx2 v[38:39], v5, s[8:11], s16 offen
    s_add_u32 s16, s15, 6144
    buffer_load_dwordx2 v[40:41], v5, s[8:11], s16 offen
    s_add_u32 s16, s15, 6656
    buffer_load_dwordx2 v[42:43], v5, s[8:11], s16 offen
    s_add_u32 s16, s15, 7168
    buffer_load_dwordx2 v[44:45], v5, s[8:11], s16 offen
    s_add_u32 s16, s15, 7680
    buffer_load_dwordx2 v[46:47], v5, s[8:11], s16 offen
    s_add_u32 s16, s15, 8192
    buffer_load_dwordx2 v[48:49], v5, s[8:11], s16 offen
    s_add_u32 s16, s15, 8704
    buffer_load_dwordx2 v[50:51], v5, s[8:11], s16 offen
    s_add_u32 s16, s15, 9216
    buffer_load_dwordx2 v[52:53], v5, s[8:11], s16 offen
    s_add_u32 s16, s15, 9728
    buffer_load_dwordx2 v[54:55], v5, s[8:11], s16 offen
    s_add_u32 s16, s15, 10240
    buffer_load_dwordx2 v[56:57], v5, s[8:11], s16 offen
    s_add_u32 s16, s15, 10752
    buffer_load_dwordx2 v[58:59], v5, s[8:11], s16 offen
    s_add_u32 s16, s15, 11264
    buffer_load_dwordx2 v[60:61], v5, s[8:11], s16 offen
    s_add_u32 s16, s15, 11776
    buffer_load_dwordx2 v[62:63], v5, s[8:11], s16 offen
    s_add_u32 s16, s15, 12288
    buffer_load_dwordx2 v[64:65], v5, s[8:11], s16 offen
    s_add_u32 s16, s15, 12800
    buffer_load_dwordx2 v[66:67], v5, s[8:11], s16 offen
    s_add_u32 s16, s15, 13312
    buffer_load_dwordx2 v[68:69], v5, s[8:11], s16 offen
    s_add_u32 s16, s15, 13824
    buffer_load_dwordx2 v[70:71], v5, s[8:11], s16 offen
    s_add_u32 s16, s15, 14336
    buffer_load_dwordx2 v[72:73], v5, s[8:11], s16 offen
    s_add_u32 s16, s15, 14848
    buffer_load_dwordx2 v[74:75], v5, s[8:11], s16 offen
    s_add_u32 s16, s15, 15360
    buffer_load_dwordx2 v[76:77], v5, s[8:11], s16 offen
    s_add_u32 s16, s15, 15872
    buffer_load_dwordx2 v[78:79], v5, s[8:11], s16 offen
    s_mul_i32 s17, s12, 16896
    v_lshlrev_b32 v3, 3, v1
    v_add_u32 v3, s17, v3
    v_and_b32 v7, 1, v1
    v_lshrrev_b32 v6, 1, v1
    v_cvt_f32_u32 v8, v6
    v_cvt_f32_u32 v10, v7
    s_movk_i32 s18, 528
    v_mul_lo_u32 v4, v6, s18
    v_lshl_add_u32 v4, v7, 3, v4
    v_add_u32 v4, s17, v4
    v_mov_b32 v9, 1.0
    v_fma_f32 v9, v10, -2.0, v9
    v_lshlrev_b32 v5, 12, v7
    v_lshl_add_u32 v11, v6, 2, v5
    s_lshl_b32 s19, s13, 13
    s_add_u32 s19, s19, 121634816
    s_waitcnt vmcnt(0)
    v_sub_f32 v80, v16, v48
    v_sub_f32 v81, v17, v49
    v_add_f32 v16, v16, v48
    v_add_f32 v17, v17, v49
    v_sub_f32 v48, v18, v50
    v_sub_f32 v49, v19, v51
    v_add_f32 v18, v18, v50
    v_add_f32 v19, v19, v51
    v_mul_f32 v50, 0x3f7b14be, v48
    v_mul_f32 v51, 0xbe47c5c2, v48
    v_fmac_f32 v50, 0x3e47c5c2, v49
    v_fmac_f32 v51, 0x3f7b14be, v49
    v_sub_f32 v48, v20, v52
    v_sub_f32 v49, v21, v53
    v_add_f32 v20, v20, v52
    v_add_f32 v21, v21, v53
    v_mul_f32 v52, 0x3f6c835e, v48
    v_mul_f32 v53, 0xbec3ef15, v48
    v_fmac_f32 v52, 0x3ec3ef15, v49
    v_fmac_f32 v53, 0x3f6c835e, v49
    v_sub_f32 v48, v22, v54
    v_sub_f32 v49, v23, v55
    v_add_f32 v22, v22, v54
    v_add_f32 v23, v23, v55
    v_mul_f32 v54, 0x3f54db31, v48
    v_mul_f32 v55, 0xbf0e39da, v48
    v_fmac_f32 v54, 0x3f0e39da, v49
    v_fmac_f32 v55, 0x3f54db31, v49
    v_sub_f32 v48, v24, v56
    v_sub_f32 v49, v25, v57
    v_add_f32 v24, v24, v56
    v_add_f32 v25, v25, v57
    v_mul_f32 v56, 0x3f3504f3, v48
    v_mul_f32 v57, 0xbf3504f3, v48
    v_fmac_f32 v56, 0x3f3504f3, v49
    v_fmac_f32 v57, 0x3f3504f3, v49
    v_sub_f32 v48, v26, v58
    v_sub_f32 v49, v27, v59
    v_add_f32 v26, v26, v58
    v_add_f32 v27, v27, v59
    v_mul_f32 v58, 0x3f0e39da, v48
    v_mul_f32 v59, 0xbf54db31, v48
    v_fmac_f32 v58, 0x3f54db31, v49
    v_fmac_f32 v59, 0x3f0e39da, v49
    v_sub_f32 v48, v28, v60
    v_sub_f32 v49, v29, v61
    v_add_f32 v28, v28, v60
    v_add_f32 v29, v29, v61
    v_mul_f32 v60, 0x3ec3ef15, v48
    v_mul_f32 v61, 0xbf6c835e, v48
    v_fmac_f32 v60, 0x3f6c835e, v49
    v_fmac_f32 v61, 0x3ec3ef15, v49
    v_sub_f32 v48, v30, v62
    v_sub_f32 v49, v31, v63
    v_add_f32 v30, v30, v62
    v_add_f32 v31, v31, v63
    v_mul_f32 v62, 0x3e47c5c2, v48
    v_mul_f32 v63, 0xbf7b14be, v48
    v_fmac_f32 v62, 0x3f7b14be, v49
    v_fmac_f32 v63, 0x3e47c5c2, v49
    v_sub_f32 v48, v33, v65
    v_sub_f32 v49, v64, v32
    v_add_f32 v32, v32, v64
    v_add_f32 v33, v33, v65
    v_sub_f32 v64, v34, v66
    v_sub_f32 v65, v35, v67
    v_add_f32 v34, v34, v66
    v_add_f32 v35, v35, v67
    v_mul_f32 v66, 0xbe47c5c2, v64
    v_mul_f32 v67, 0xbf7b14be, v64
    v_fmac_f32 v66, 0x3f7b14be, v65
    v_fmac_f32 v67, 0xbe47c5c2, v65
    v_sub_f32 v64, v36, v68
    v_sub_f32 v65, v37, v69
    v_add_f32 v36, v36, v68
    v_add_f32 v37, v37, v69
    v_mul_f32 v68, 0xbec3ef15, v64
    v_mul_f32 v69, 0xbf6c835e, v64
    v_fmac_f32 v68, 0x3f6c835e, v65
    v_fmac_f32 v69, 0xbec3ef15, v65
    v_sub_f32 v64, v38, v70
    v_sub_f32 v65, v39, v71
    v_add_f32 v38, v38, v70
    v_add_f32 v39, v39, v71
    v_mul_f32 v70, 0xbf0e39da, v64
    v_mul_f32 v71, 0xbf54db31, v64
    v_fmac_f32 v70, 0x3f54db31, v65
    v_fmac_f32 v71, 0xbf0e39da, v65
    v_sub_f32 v64, v40, v72
    v_sub_f32 v65, v41, v73
    v_add_f32 v40, v40, v72
    v_add_f32 v41, v41, v73
    v_mul_f32 v72, 0xbf3504f3, v64
    v_mul_f32 v73, 0xbf3504f3, v64
    v_fmac_f32 v72, 0x3f3504f3, v65
    v_fmac_f32 v73, 0xbf3504f3, v65
    v_sub_f32 v64, v42, v74
    v_sub_f32 v65, v43, v75
    v_add_f32 v42, v42, v74
    v_add_f32 v43, v43, v75
    v_mul_f32 v74, 0xbf54db31, v64
    v_mul_f32 v75, 0xbf0e39da, v64
    v_fmac_f32 v74, 0x3f0e39da, v65
    v_fmac_f32 v75, 0xbf54db31, v65
    v_sub_f32 v64, v44, v76
    v_sub_f32 v65, v45, v77
    v_add_f32 v44, v44, v76
    v_add_f32 v45, v45, v77
    v_mul_f32 v76, 0xbf6c835e, v64
    v_mul_f32 v77, 0xbec3ef15, v64
    v_fmac_f32 v76, 0x3ec3ef15, v65
    v_fmac_f32 v77, 0xbf6c835e, v65
    v_sub_f32 v64, v46, v78
    v_sub_f32 v65, v47, v79
    v_add_f32 v46, v46, v78
    v_add_f32 v47, v47, v79
    v_mul_f32 v78, 0xbf7b14be, v64
    v_mul_f32 v79, 0xbe47c5c2, v64
    v_fmac_f32 v78, 0x3e47c5c2, v65
    v_fmac_f32 v79, 0xbf7b14be, v65
    v_sub_f32 v64, v16, v32
    v_sub_f32 v65, v17, v33
    v_add_f32 v16, v16, v32
    v_add_f32 v17, v17, v33
    v_sub_f32 v32, v18, v34
    v_sub_f32 v33, v19, v35
    v_add_f32 v18, v18, v34
    v_add_f32 v19, v19, v35
    v_mul_f32 v34, 0x3f6c835e, v32
    v_mul_f32 v35, 0xbec3ef15, v32
    v_fmac_f32 v34, 0x3ec3ef15, v33
    v_fmac_f32 v35, 0x3f6c835e, v33
    v_sub_f32 v32, v20, v36
    v_sub_f32 v33, v21, v37
    v_add_f32 v20, v20, v36
    v_add_f32 v21, v21, v37
    v_mul_f32 v36, 0x3f3504f3, v32
    v_mul_f32 v37, 0xbf3504f3, v32
    v_fmac_f32 v36, 0x3f3504f3, v33
    v_fmac_f32 v37, 0x3f3504f3, v33
    v_sub_f32 v32, v22, v38
    v_sub_f32 v33, v23, v39
    v_add_f32 v22, v22, v38
    v_add_f32 v23, v23, v39
    v_mul_f32 v38, 0x3ec3ef15, v32
    v_mul_f32 v39, 0xbf6c835e, v32
    v_fmac_f32 v38, 0x3f6c835e, v33
    v_fmac_f32 v39, 0x3ec3ef15, v33
    v_sub_f32 v32, v25, v41
    v_sub_f32 v33, v40, v24
    v_add_f32 v24, v24, v40
    v_add_f32 v25, v25, v41
    v_sub_f32 v40, v26, v42
    v_sub_f32 v41, v27, v43
    v_add_f32 v26, v26, v42
    v_add_f32 v27, v27, v43
    v_mul_f32 v42, 0xbec3ef15, v40
    v_mul_f32 v43, 0xbf6c835e, v40
    v_fmac_f32 v42, 0x3f6c835e, v41
    v_fmac_f32 v43, 0xbec3ef15, v41
    v_sub_f32 v40, v28, v44
    v_sub_f32 v41, v29, v45
    v_add_f32 v28, v28, v44
    v_add_f32 v29, v29, v45
    v_mul_f32 v44, 0xbf3504f3, v40
    v_mul_f32 v45, 0xbf3504f3, v40
    v_fmac_f32 v44, 0x3f3504f3, v41
    v_fmac_f32 v45, 0xbf3504f3, v41
    v_sub_f32 v40, v30, v46
    v_sub_f32 v41, v31, v47
    v_add_f32 v30, v30, v46
    v_add_f32 v31, v31, v47
    v_mul_f32 v46, 0xbf6c835e, v40
    v_mul_f32 v47, 0xbec3ef15, v40
    v_fmac_f32 v46, 0x3ec3ef15, v41
    v_fmac_f32 v47, 0xbf6c835e, v41
    v_sub_f32 v40, v80, v48
    v_sub_f32 v41, v81, v49
    v_add_f32 v80, v80, v48
    v_add_f32 v81, v81, v49
    v_sub_f32 v48, v50, v66
    v_sub_f32 v49, v51, v67
    v_add_f32 v50, v50, v66
    v_add_f32 v51, v51, v67
    v_mul_f32 v66, 0x3f6c835e, v48
    v_mul_f32 v67, 0xbec3ef15, v48
    v_fmac_f32 v66, 0x3ec3ef15, v49
    v_fmac_f32 v67, 0x3f6c835e, v49
    v_sub_f32 v48, v52, v68
    v_sub_f32 v49, v53, v69
    v_add_f32 v52, v52, v68
    v_add_f32 v53, v53, v69
    v_mul_f32 v68, 0x3f3504f3, v48
    v_mul_f32 v69, 0xbf3504f3, v48
    v_fmac_f32 v68, 0x3f3504f3, v49
    v_fmac_f32 v69, 0x3f3504f3, v49
    v_sub_f32 v48, v54, v70
    v_sub_f32 v49, v55, v71
    v_add_f32 v54, v54, v70
    v_add_f32 v55, v55, v71
    v_mul_f32 v70, 0x3ec3ef15, v48
    v_mul_f32 v71, 0xbf6c835e, v48
    v_fmac_f32 v70, 0x3f6c835e, v49
    v_fmac_f32 v71, 0x3ec3ef15, v49
    v_sub_f32 v48, v57, v73
    v_sub_f32 v49, v72, v56
    v_add_f32 v56, v56, v72
    v_add_f32 v57, v57, v73
    v_sub_f32 v72, v58, v74
    v_sub_f32 v73, v59, v75
    v_add_f32 v58, v58, v74
    v_add_f32 v59, v59, v75
    v_mul_f32 v74, 0xbec3ef15, v72
    v_mul_f32 v75, 0xbf6c835e, v72
    v_fmac_f32 v74, 0x3f6c835e, v73
    v_fmac_f32 v75, 0xbec3ef15, v73
    v_sub_f32 v72, v60, v76
    v_sub_f32 v73, v61, v77
    v_add_f32 v60, v60, v76
    v_add_f32 v61, v61, v77
    v_mul_f32 v76, 0xbf3504f3, v72
    v_mul_f32 v77, 0xbf3504f3, v72
    v_fmac_f32 v76, 0x3f3504f3, v73
    v_fmac_f32 v77, 0xbf3504f3, v73
    v_sub_f32 v72, v62, v78
    v_sub_f32 v73, v63, v79
    v_add_f32 v62, v62, v78
    v_add_f32 v63, v63, v79
    v_mul_f32 v78, 0xbf6c835e, v72
    v_mul_f32 v79, 0xbec3ef15, v72
    v_fmac_f32 v78, 0x3ec3ef15, v73
    v_fmac_f32 v79, 0xbf6c835e, v73
    v_sub_f32 v72, v16, v24
    v_sub_f32 v73, v17, v25
    v_add_f32 v16, v16, v24
    v_add_f32 v17, v17, v25
    v_sub_f32 v24, v18, v26
    v_sub_f32 v25, v19, v27
    v_add_f32 v18, v18, v26
    v_add_f32 v19, v19, v27
    v_mul_f32 v26, 0x3f3504f3, v24
    v_mul_f32 v27, 0xbf3504f3, v24
    v_fmac_f32 v26, 0x3f3504f3, v25
    v_fmac_f32 v27, 0x3f3504f3, v25
    v_sub_f32 v24, v21, v29
    v_sub_f32 v25, v28, v20
    v_add_f32 v20, v20, v28
    v_add_f32 v21, v21, v29
    v_sub_f32 v28, v22, v30
    v_sub_f32 v29, v23, v31
    v_add_f32 v22, v22, v30
    v_add_f32 v23, v23, v31
    v_mul_f32 v30, 0xbf3504f3, v28
    v_mul_f32 v31, 0xbf3504f3, v28
    v_fmac_f32 v30, 0x3f3504f3, v29
    v_fmac_f32 v31, 0xbf3504f3, v29
    v_sub_f32 v28, v64, v32
    v_sub_f32 v29, v65, v33
    v_add_f32 v64, v64, v32
    v_add_f32 v65, v65, v33
    v_sub_f32 v32, v34, v42
    v_sub_f32 v33, v35, v43
    v_add_f32 v34, v34, v42
    v_add_f32 v35, v35, v43
    v_mul_f32 v42, 0x3f3504f3, v32
    v_mul_f32 v43, 0xbf3504f3, v32
    v_fmac_f32 v42, 0x3f3504f3, v33
    v_fmac_f32 v43, 0x3f3504f3, v33
    v_sub_f32 v32, v37, v45
    v_sub_f32 v33, v44, v36
    v_add_f32 v36, v36, v44
    v_add_f32 v37, v37, v45
    v_sub_f32 v44, v38, v46
    v_sub_f32 v45, v39, v47
    v_add_f32 v38, v38, v46
    v_add_f32 v39, v39, v47
    v_mul_f32 v46, 0xbf3504f3, v44
    v_mul_f32 v47, 0xbf3504f3, v44
    v_fmac_f32 v46, 0x3f3504f3, v45
    v_fmac_f32 v47, 0xbf3504f3, v45
    v_sub_f32 v44, v80, v56
    v_sub_f32 v45, v81, v57
    v_add_f32 v80, v80, v56
    v_add_f32 v81, v81, v57
    v_sub_f32 v56, v50, v58
    v_sub_f32 v57, v51, v59
    v_add_f32 v50, v50, v58
    v_add_f32 v51, v51, v59
    v_mul_f32 v58, 0x3f3504f3, v56
    v_mul_f32 v59, 0xbf3504f3, v56
    v_fmac_f32 v58, 0x3f3504f3, v57
    v_fmac_f32 v59, 0x3f3504f3, v57
    v_sub_f32 v56, v53, v61
    v_sub_f32 v57, v60, v52
    v_add_f32 v52, v52, v60
    v_add_f32 v53, v53, v61
    v_sub_f32 v60, v54, v62
    v_sub_f32 v61, v55, v63
    v_add_f32 v54, v54, v62
    v_add_f32 v55, v55, v63
    v_mul_f32 v62, 0xbf3504f3, v60
    v_mul_f32 v63, 0xbf3504f3, v60
    v_fmac_f32 v62, 0x3f3504f3, v61
    v_fmac_f32 v63, 0xbf3504f3, v61
    v_sub_f32 v60, v40, v48
    v_sub_f32 v61, v41, v49
    v_add_f32 v40, v40, v48
    v_add_f32 v41, v41, v49
    v_sub_f32 v48, v66, v74
    v_sub_f32 v49, v67, v75
    v_add_f32 v66, v66, v74
    v_add_f32 v67, v67, v75
    v_mul_f32 v74, 0x3f3504f3, v48
    v_mul_f32 v75, 0xbf3504f3, v48
    v_fmac_f32 v74, 0x3f3504f3, v49
    v_fmac_f32 v75, 0x3f3504f3, v49
    v_sub_f32 v48, v69, v77
    v_sub_f32 v49, v76, v68
    v_add_f32 v68, v68, v76
    v_add_f32 v69, v69, v77
    v_sub_f32 v76, v70, v78
    v_sub_f32 v77, v71, v79
    v_add_f32 v70, v70, v78
    v_add_f32 v71, v71, v79
    v_mul_f32 v78, 0xbf3504f3, v76
    v_mul_f32 v79, 0xbf3504f3, v76
    v_fmac_f32 v78, 0x3f3504f3, v77
    v_fmac_f32 v79, 0xbf3504f3, v77
    v_sub_f32 v76, v16, v20
    v_sub_f32 v77, v17, v21
    v_add_f32 v16, v16, v20
    v_add_f32 v17, v17, v21
    v_sub_f32 v20, v19, v23
    v_sub_f32 v21, v22, v18
    v_add_f32 v18, v18, v22
    v_add_f32 v19, v19, v23
    v_sub_f32 v22, v72, v24
    v_sub_f32 v23, v73, v25
    v_add_f32 v72, v72, v24
    v_add_f32 v73, v73, v25
    v_sub_f32 v24, v27, v31
    v_sub_f32 v25, v30, v26
    v_add_f32 v26, v26, v30
    v_add_f32 v27, v27, v31
    v_sub_f32 v30, v64, v36
    v_sub_f32 v31, v65, v37
    v_add_f32 v64, v64, v36
    v_add_f32 v65, v65, v37
    v_sub_f32 v36, v35, v39
    v_sub_f32 v37, v38, v34
    v_add_f32 v34, v34, v38
    v_add_f32 v35, v35, v39
    v_sub_f32 v38, v28, v32
    v_sub_f32 v39, v29, v33
    v_add_f32 v28, v28, v32
    v_add_f32 v29, v29, v33
    v_sub_f32 v32, v43, v47
    v_sub_f32 v33, v46, v42
    v_add_f32 v42, v42, v46
    v_add_f32 v43, v43, v47
    v_sub_f32 v46, v80, v52
    v_sub_f32 v47, v81, v53
    v_add_f32 v80, v80, v52
    v_add_f32 v81, v81, v53
    v_sub_f32 v52, v51, v55
    v_sub_f32 v53, v54, v50
    v_add_f32 v50, v50, v54
    v_add_f32 v51, v51, v55
    v_sub_f32 v54, v44, v56
    v_sub_f32 v55, v45, v57
    v_add_f32 v44, v44, v56
    v_add_f32 v45, v45, v57
    v_sub_f32 v56, v59, v63
    v_sub_f32 v57, v62, v58
    v_add_f32 v58, v58, v62
    v_add_f32 v59, v59, v63
    v_sub_f32 v62, v40, v68
    v_sub_f32 v63, v41, v69
    v_add_f32 v40, v40, v68
    v_add_f32 v41, v41, v69
    v_sub_f32 v68, v67, v71
    v_sub_f32 v69, v70, v66
    v_add_f32 v66, v66, v70
    v_add_f32 v67, v67, v71
    v_sub_f32 v70, v60, v48
    v_sub_f32 v71, v61, v49
    v_add_f32 v60, v60, v48
    v_add_f32 v61, v61, v49
    v_sub_f32 v48, v75, v79
    v_sub_f32 v49, v78, v74
    v_add_f32 v74, v74, v78
    v_add_f32 v75, v75, v79
    v_sub_f32 v78, v16, v18
    v_sub_f32 v79, v17, v19
    v_add_f32 v16, v16, v18
    v_add_f32 v17, v17, v19
    v_sub_f32 v18, v76, v20
    v_sub_f32 v19, v77, v21
    v_add_f32 v76, v76, v20
    v_add_f32 v77, v77, v21
    v_sub_f32 v20, v72, v26
    v_sub_f32 v21, v73, v27
    v_add_f32 v72, v72, v26
    v_add_f32 v73, v73, v27
    v_sub_f32 v26, v22, v24
    v_sub_f32 v27, v23, v25
    v_add_f32 v22, v22, v24
    v_add_f32 v23, v23, v25
    v_sub_f32 v24, v64, v34
    v_sub_f32 v25, v65, v35
    v_add_f32 v64, v64, v34
    v_add_f32 v65, v65, v35
    v_sub_f32 v34, v30, v36
    v_sub_f32 v35, v31, v37
    v_add_f32 v30, v30, v36
    v_add_f32 v31, v31, v37
    v_sub_f32 v36, v28, v42
    v_sub_f32 v37, v29, v43
    v_add_f32 v28, v28, v42
    v_add_f32 v29, v29, v43
    v_sub_f32 v42, v38, v32
    v_sub_f32 v43, v39, v33
    v_add_f32 v38, v38, v32
    v_add_f32 v39, v39, v33
    v_sub_f32 v32, v80, v50
    v_sub_f32 v33, v81, v51
    v_add_f32 v80, v80, v50
    v_add_f32 v81, v81, v51
    v_sub_f32 v50, v46, v52
    v_sub_f32 v51, v47, v53
    v_add_f32 v46, v46, v52
    v_add_f32 v47, v47, v53
    v_sub_f32 v52, v44, v58
    v_sub_f32 v53, v45, v59
    v_add_f32 v44, v44, v58
    v_add_f32 v45, v45, v59
    v_sub_f32 v58, v54, v56
    v_sub_f32 v59, v55, v57
    v_add_f32 v54, v54, v56
    v_add_f32 v55, v55, v57
    v_sub_f32 v56, v40, v66
    v_sub_f32 v57, v41, v67
    v_add_f32 v40, v40, v66
    v_add_f32 v41, v41, v67
    v_sub_f32 v66, v62, v68
    v_sub_f32 v67, v63, v69
    v_add_f32 v62, v62, v68
    v_add_f32 v63, v63, v69
    v_sub_f32 v68, v60, v74
    v_sub_f32 v69, v61, v75
    v_add_f32 v60, v60, v74
    v_add_f32 v61, v61, v75
    v_sub_f32 v74, v70, v48
    v_sub_f32 v75, v71, v49
    v_add_f32 v70, v70, v48
    v_add_f32 v71, v71, v49
    v_mul_f32 v48, 0xba000000, v2
    v_cos_f32 v49, v48
    v_sin_f32 v82, v48
    s_nop 0
    v_mul_f32 v83, v80, v49
    v_fma_f32 v83, -v81, v82, v83
    v_mul_f32 v81, v81, v49
    v_fmac_f32 v81, v80, v82
    v_mul_f32 v48, 0xba800000, v2
    v_cos_f32 v49, v48
    v_sin_f32 v82, v48
    s_nop 0
    v_mul_f32 v80, v64, v49
    v_fma_f32 v80, -v65, v82, v80
    v_mul_f32 v65, v65, v49
    v_fmac_f32 v65, v64, v82
    v_mul_f32 v48, 0xbac00000, v2
    v_cos_f32 v49, v48
    v_sin_f32 v82, v48
    s_nop 0
    v_mul_f32 v64, v40, v49
    v_fma_f32 v64, -v41, v82, v64
    v_mul_f32 v41, v41, v49
    v_fmac_f32 v41, v40, v82
    v_mul_f32 v48, 0xbb000000, v2
    v_cos_f32 v49, v48
    v_sin_f32 v82, v48
    s_nop 0
    v_mul_f32 v40, v72, v49
    v_fma_f32 v40, -v73, v82, v40
    v_mul_f32 v73, v73, v49
    v_fmac_f32 v73, v72, v82
    v_mul_f32 v48, 0xbb200000, v2
    v_cos_f32 v49, v48
    v_sin_f32 v82, v48
    s_nop 0
    v_mul_f32 v72, v44, v49
    v_fma_f32 v72, -v45, v82, v72
    v_mul_f32 v45, v45, v49
    v_fmac_f32 v45, v44, v82
    v_mul_f32 v48, 0xbb400000, v2
    v_cos_f32 v49, v48
    v_sin_f32 v82, v48
    s_nop 0
    v_mul_f32 v44, v28, v49
    v_fma_f32 v44, -v29, v82, v44
    v_mul_f32 v29, v29, v49
    v_fmac_f32 v29, v28, v82
    v_mul_f32 v48, 0xbb600000, v2
    v_cos_f32 v49, v48
    v_sin_f32 v82, v48
    s_nop 0
    v_mul_f32 v28, v60, v49
    v_fma_f32 v28, -v61, v82, v28
    v_mul_f32 v61, v61, v49
    v_fmac_f32 v61, v60, v82
    v_mul_f32 v48, 0xbb800000, v2
    v_cos_f32 v49, v48
    v_sin_f32 v82, v48
    s_nop 0
    v_mul_f32 v60, v76, v49
    v_fma_f32 v60, -v77, v82, v60
    v_mul_f32 v77, v77, v49
    v_fmac_f32 v77, v76, v82
    v_mul_f32 v48, 0xbb900000, v2
    v_cos_f32 v49, v48
    v_sin_f32 v82, v48
    s_nop 0
    v_mul_f32 v76, v46, v49
    v_fma_f32 v76, -v47, v82, v76
    v_mul_f32 v47, v47, v49
    v_fmac_f32 v47, v46, v82
    v_mul_f32 v48, 0xbba00000, v2
    v_cos_f32 v49, v48
    v_sin_f32 v82, v48
    s_nop 0
    v_mul_f32 v46, v30, v49
    v_fma_f32 v46, -v31, v82, v46
    v_mul_f32 v31, v31, v49
    v_fmac_f32 v31, v30, v82
    v_mul_f32 v48, 0xbbb00000, v2
    v_cos_f32 v49, v48
    v_sin_f32 v82, v48
    s_nop 0
    v_mul_f32 v30, v62, v49
    v_fma_f32 v30, -v63, v82, v30
    v_mul_f32 v63, v63, v49
    v_fmac_f32 v63, v62, v82
    v_mul_f32 v48, 0xbbc00000, v2
    v_cos_f32 v49, v48
    v_sin_f32 v82, v48
    s_nop 0
    v_mul_f32 v62, v22, v49
    v_fma_f32 v62, -v23, v82, v62
    v_mul_f32 v23, v23, v49
    v_fmac_f32 v23, v22, v82
    v_mul_f32 v48, 0xbbd00000, v2
    v_cos_f32 v49, v48
    v_sin_f32 v82, v48
    s_nop 0
    v_mul_f32 v22, v54, v49
    v_fma_f32 v22, -v55, v82, v22
    v_mul_f32 v55, v55, v49
    v_fmac_f32 v55, v54, v82
    v_mul_f32 v48, 0xbbe00000, v2
    v_cos_f32 v49, v48
    v_sin_f32 v82, v48
    s_nop 0
    v_mul_f32 v54, v38, v49
    v_fma_f32 v54, -v39, v82, v54
    v_mul_f32 v39, v39, v49
    v_fmac_f32 v39, v38, v82
    v_mul_f32 v48, 0xbbf00000, v2
    v_cos_f32 v49, v48
    v_sin_f32 v82, v48
    s_nop 0
    v_mul_f32 v38, v70, v49
    v_fma_f32 v38, -v71, v82, v38
    v_mul_f32 v71, v71, v49
    v_fmac_f32 v71, v70, v82
    v_mul_f32 v48, 0xbc000000, v2
    v_cos_f32 v49, v48
    v_sin_f32 v82, v48
    s_nop 0
    v_mul_f32 v70, v78, v49
    v_fma_f32 v70, -v79, v82, v70
    v_mul_f32 v79, v79, v49
    v_fmac_f32 v79, v78, v82
    v_mul_f32 v48, 0xbc080000, v2
    v_cos_f32 v49, v48
    v_sin_f32 v82, v48
    s_nop 0
    v_mul_f32 v78, v32, v49
    v_fma_f32 v78, -v33, v82, v78
    v_mul_f32 v33, v33, v49
    v_fmac_f32 v33, v32, v82
    v_mul_f32 v48, 0xbc100000, v2
    v_cos_f32 v49, v48
    v_sin_f32 v82, v48
    s_nop 0
    v_mul_f32 v32, v24, v49
    v_fma_f32 v32, -v25, v82, v32
    v_mul_f32 v25, v25, v49
    v_fmac_f32 v25, v24, v82
    v_mul_f32 v48, 0xbc180000, v2
    v_cos_f32 v49, v48
    v_sin_f32 v82, v48
    s_nop 0
    v_mul_f32 v24, v56, v49
    v_fma_f32 v24, -v57, v82, v24
    v_mul_f32 v57, v57, v49
    v_fmac_f32 v57, v56, v82
    v_mul_f32 v48, 0xbc200000, v2
    v_cos_f32 v49, v48
    v_sin_f32 v82, v48
    s_nop 0
    v_mul_f32 v56, v20, v49
    v_fma_f32 v56, -v21, v82, v56
    v_mul_f32 v21, v21, v49
    v_fmac_f32 v21, v20, v82
    v_mul_f32 v48, 0xbc280000, v2
    v_cos_f32 v49, v48
    v_sin_f32 v82, v48
    s_nop 0
    v_mul_f32 v20, v52, v49
    v_fma_f32 v20, -v53, v82, v20
    v_mul_f32 v53, v53, v49
    v_fmac_f32 v53, v52, v82
    v_mul_f32 v48, 0xbc300000, v2
    v_cos_f32 v49, v48
    v_sin_f32 v82, v48
    s_nop 0
    v_mul_f32 v52, v36, v49
    v_fma_f32 v52, -v37, v82, v52
    v_mul_f32 v37, v37, v49
    v_fmac_f32 v37, v36, v82
    v_mul_f32 v48, 0xbc380000, v2
    v_cos_f32 v49, v48
    v_sin_f32 v82, v48
    s_nop 0
    v_mul_f32 v36, v68, v49
    v_fma_f32 v36, -v69, v82, v36
    v_mul_f32 v69, v69, v49
    v_fmac_f32 v69, v68, v82
    v_mul_f32 v48, 0xbc400000, v2
    v_cos_f32 v49, v48
    v_sin_f32 v82, v48
    s_nop 0
    v_mul_f32 v68, v18, v49
    v_fma_f32 v68, -v19, v82, v68
    v_mul_f32 v19, v19, v49
    v_fmac_f32 v19, v18, v82
    v_mul_f32 v48, 0xbc480000, v2
    v_cos_f32 v49, v48
    v_sin_f32 v82, v48
    s_nop 0
    v_mul_f32 v18, v50, v49
    v_fma_f32 v18, -v51, v82, v18
    v_mul_f32 v51, v51, v49
    v_fmac_f32 v51, v50, v82
    v_mul_f32 v48, 0xbc500000, v2
    v_cos_f32 v49, v48
    v_sin_f32 v82, v48
    s_nop 0
    v_mul_f32 v50, v34, v49
    v_fma_f32 v50, -v35, v82, v50
    v_mul_f32 v35, v35, v49
    v_fmac_f32 v35, v34, v82
    v_mul_f32 v48, 0xbc580000, v2
    v_cos_f32 v49, v48
    v_sin_f32 v82, v48
    s_nop 0
    v_mul_f32 v34, v66, v49
    v_fma_f32 v34, -v67, v82, v34
    v_mul_f32 v67, v67, v49
    v_fmac_f32 v67, v66, v82
    v_mul_f32 v48, 0xbc600000, v2
    v_cos_f32 v49, v48
    v_sin_f32 v82, v48
    s_nop 0
    v_mul_f32 v66, v26, v49
    v_fma_f32 v66, -v27, v82, v66
    v_mul_f32 v27, v27, v49
    v_fmac_f32 v27, v26, v82
    v_mul_f32 v48, 0xbc680000, v2
    v_cos_f32 v49, v48
    v_sin_f32 v82, v48
    s_nop 0
    v_mul_f32 v26, v58, v49
    v_fma_f32 v26, -v59, v82, v26
    v_mul_f32 v59, v59, v49
    v_fmac_f32 v59, v58, v82
    v_mul_f32 v48, 0xbc700000, v2
    v_cos_f32 v49, v48
    v_sin_f32 v82, v48
    s_nop 0
    v_mul_f32 v58, v42, v49
    v_fma_f32 v58, -v43, v82, v58
    v_mul_f32 v43, v43, v49
    v_fmac_f32 v43, v42, v82
    v_mul_f32 v48, 0xbc780000, v2
    v_cos_f32 v49, v48
    v_sin_f32 v82, v48
    s_nop 0
    v_mul_f32 v42, v74, v49
    v_fma_f32 v42, -v75, v82, v42
    v_mul_f32 v75, v75, v49
    v_fmac_f32 v75, v74, v82
    ds_write_b32 v3, v16 offset:0
    ds_write_b32 v3, v17 offset:4
    ds_write_b32 v3, v83 offset:528
    ds_write_b32 v3, v81 offset:532
    ds_write_b32 v3, v80 offset:1056
    ds_write_b32 v3, v65 offset:1060
    ds_write_b32 v3, v64 offset:1584
    ds_write_b32 v3, v41 offset:1588
    ds_write_b32 v3, v40 offset:2112
    ds_write_b32 v3, v73 offset:2116
    ds_write_b32 v3, v72 offset:2640
    ds_write_b32 v3, v45 offset:2644
    ds_write_b32 v3, v44 offset:3168
    ds_write_b32 v3, v29 offset:3172
    ds_write_b32 v3, v28 offset:3696
    ds_write_b32 v3, v61 offset:3700
    ds_write_b32 v3, v60 offset:4224
    ds_write_b32 v3, v77 offset:4228
    ds_write_b32 v3, v76 offset:4752
    ds_write_b32 v3, v47 offset:4756
    ds_write_b32 v3, v46 offset:5280
    ds_write_b32 v3, v31 offset:5284
    ds_write_b32 v3, v30 offset:5808
    ds_write_b32 v3, v63 offset:5812
    ds_write_b32 v3, v62 offset:6336
    ds_write_b32 v3, v23 offset:6340
    ds_write_b32 v3, v22 offset:6864
    ds_write_b32 v3, v55 offset:6868
    ds_write_b32 v3, v54 offset:7392
    ds_write_b32 v3, v39 offset:7396
    ds_write_b32 v3, v38 offset:7920
    ds_write_b32 v3, v71 offset:7924
    ds_write_b32 v3, v70 offset:8448
    ds_write_b32 v3, v79 offset:8452
    ds_write_b32 v3, v78 offset:8976
    ds_write_b32 v3, v33 offset:8980
    ds_write_b32 v3, v32 offset:9504
    ds_write_b32 v3, v25 offset:9508
    ds_write_b32 v3, v24 offset:10032
    ds_write_b32 v3, v57 offset:10036
    ds_write_b32 v3, v56 offset:10560
    ds_write_b32 v3, v21 offset:10564
    ds_write_b32 v3, v20 offset:11088
    ds_write_b32 v3, v53 offset:11092
    ds_write_b32 v3, v52 offset:11616
    ds_write_b32 v3, v37 offset:11620
    ds_write_b32 v3, v36 offset:12144
    ds_write_b32 v3, v69 offset:12148
    ds_write_b32 v3, v68 offset:12672
    ds_write_b32 v3, v19 offset:12676
    ds_write_b32 v3, v18 offset:13200
    ds_write_b32 v3, v51 offset:13204
    ds_write_b32 v3, v50 offset:13728
    ds_write_b32 v3, v35 offset:13732
    ds_write_b32 v3, v34 offset:14256
    ds_write_b32 v3, v67 offset:14260
    ds_write_b32 v3, v66 offset:14784
    ds_write_b32 v3, v27 offset:14788
    ds_write_b32 v3, v26 offset:15312
    ds_write_b32 v3, v59 offset:15316
    ds_write_b32 v3, v58 offset:15840
    ds_write_b32 v3, v43 offset:15844
    ds_write_b32 v3, v42 offset:16368
    ds_write_b32 v3, v75 offset:16372
    s_waitcnt lgkmcnt(0)
    ds_read_b32 v16, v4 offset:0
    ds_read_b32 v17, v4 offset:4
    ds_read_b32 v83, v4 offset:16
    ds_read_b32 v81, v4 offset:20
    ds_read_b32 v80, v4 offset:32
    ds_read_b32 v65, v4 offset:36
    ds_read_b32 v64, v4 offset:48
    ds_read_b32 v41, v4 offset:52
    ds_read_b32 v40, v4 offset:64
    ds_read_b32 v73, v4 offset:68
    ds_read_b32 v72, v4 offset:80
    ds_read_b32 v45, v4 offset:84
    ds_read_b32 v44, v4 offset:96
    ds_read_b32 v29, v4 offset:100
    s_waitcnt lgkmcnt(0)
    ds_read_b32 v28, v4 offset:112
    ds_read_b32 v61, v4 offset:116
    ds_read_b32 v60, v4 offset:128
    ds_read_b32 v77, v4 offset:132
    ds_read_b32 v76, v4 offset:144
    ds_read_b32 v47, v4 offset:148
    ds_read_b32 v46, v4 offset:160
    ds_read_b32 v31, v4 offset:164
    ds_read_b32 v30, v4 offset:176
    ds_read_b32 v63, v4 offset:180
    ds_read_b32 v62, v4 offset:192
    ds_read_b32 v23, v4 offset:196
    ds_read_b32 v22, v4 offset:208
    ds_read_b32 v55, v4 offset:212
    s_waitcnt lgkmcnt(0)
    ds_read_b32 v54, v4 offset:224
    ds_read_b32 v39, v4 offset:228
    ds_read_b32 v38, v4 offset:240
    ds_read_b32 v71, v4 offset:244
    ds_read_b32 v70, v4 offset:256
    ds_read_b32 v79, v4 offset:260
    ds_read_b32 v78, v4 offset:272
    ds_read_b32 v33, v4 offset:276
    ds_read_b32 v32, v4 offset:288
    ds_read_b32 v25, v4 offset:292
    ds_read_b32 v24, v4 offset:304
    ds_read_b32 v57, v4 offset:308
    ds_read_b32 v56, v4 offset:320
    ds_read_b32 v21, v4 offset:324
    s_waitcnt lgkmcnt(0)
    ds_read_b32 v20, v4 offset:336
    ds_read_b32 v53, v4 offset:340
    ds_read_b32 v52, v4 offset:352
    ds_read_b32 v37, v4 offset:356
    ds_read_b32 v36, v4 offset:368
    ds_read_b32 v69, v4 offset:372
    ds_read_b32 v68, v4 offset:384
    ds_read_b32 v19, v4 offset:388
    ds_read_b32 v18, v4 offset:400
    ds_read_b32 v51, v4 offset:404
    ds_read_b32 v50, v4 offset:416
    ds_read_b32 v35, v4 offset:420
    ds_read_b32 v34, v4 offset:432
    ds_read_b32 v67, v4 offset:436
    s_waitcnt lgkmcnt(0)
    ds_read_b32 v66, v4 offset:448
    ds_read_b32 v27, v4 offset:452
    ds_read_b32 v26, v4 offset:464
    ds_read_b32 v59, v4 offset:468
    ds_read_b32 v58, v4 offset:480
    ds_read_b32 v43, v4 offset:484
    ds_read_b32 v42, v4 offset:496
    ds_read_b32 v75, v4 offset:500
    s_waitcnt lgkmcnt(0)
    s_mov_b32 s81, 71361024
mega_kernel_wf0:
    buffer_load_dword v120, off, s[84:87], s81 sc1
    s_waitcnt vmcnt(0)
    v_cmp_ne_u32 vcc, 64, v120
    s_cbranch_vccz mega_kernel_wf0d
    s_sleep 6
    s_branch mega_kernel_wf0
mega_kernel_wf0d:
    buffer_load_dword v88, v11, s[8:11], s19 offen offset:0
    buffer_load_dword v89, v11, s[8:11], s19 offen offset:128
    buffer_load_dword v90, v11, s[8:11], s19 offen offset:256
    buffer_load_dword v91, v11, s[8:11], s19 offen offset:384
    buffer_load_dword v92, v11, s[8:11], s19 offen offset:512
    buffer_load_dword v93, v11, s[8:11], s19 offen offset:640
    buffer_load_dword v94, v11, s[8:11], s19 offen offset:768
    buffer_load_dword v95, v11, s[8:11], s19 offen offset:896
    buffer_load_dword v96, v11, s[8:11], s19 offen offset:1024
    buffer_load_dword v97, v11, s[8:11], s19 offen offset:1152
    buffer_load_dword v98, v11, s[8:11], s19 offen offset:1280
    buffer_load_dword v99, v11, s[8:11], s19 offen offset:1408
    buffer_load_dword v100, v11, s[8:11], s19 offen offset:1536
    buffer_load_dword v101, v11, s[8:11], s19 offen offset:1664
    buffer_load_dword v102, v11, s[8:11], s19 offen offset:1792
    buffer_load_dword v103, v11, s[8:11], s19 offen offset:1920
    buffer_load_dword v104, v11, s[8:11], s19 offen offset:2048
    buffer_load_dword v105, v11, s[8:11], s19 offen offset:2176
    buffer_load_dword v106, v11, s[8:11], s19 offen offset:2304
    buffer_load_dword v107, v11, s[8:11], s19 offen offset:2432
    buffer_load_dword v108, v11, s[8:11], s19 offen offset:2560
    buffer_load_dword v109, v11, s[8:11], s19 offen offset:2688
    buffer_load_dword v110, v11, s[8:11], s19 offen offset:2816
    buffer_load_dword v111, v11, s[8:11], s19 offen offset:2944
    buffer_load_dword v112, v11, s[8:11], s19 offen offset:3072
    buffer_load_dword v113, v11, s[8:11], s19 offen offset:3200
    buffer_load_dword v114, v11, s[8:11], s19 offen offset:3328
    buffer_load_dword v115, v11, s[8:11], s19 offen offset:3456
    buffer_load_dword v116, v11, s[8:11], s19 offen offset:3584
    buffer_load_dword v117, v11, s[8:11], s19 offen offset:3712
    buffer_load_dword v118, v11, s[8:11], s19 offen offset:3840
    buffer_load_dword v119, v11, s[8:11], s19 offen offset:3968
    v_sub_f32 v48, v16, v70
    v_sub_f32 v49, v17, v79
    v_add_f32 v16, v16, v70
    v_add_f32 v17, v17, v79
    v_sub_f32 v70, v83, v78
    v_sub_f32 v79, v81, v33
    v_add_f32 v83, v83, v78
    v_add_f32 v81, v81, v33
    v_mul_f32 v78, 0x3f7b14be, v70
    v_mul_f32 v33, 0xbe47c5c2, v70
    v_fmac_f32 v78, 0x3e47c5c2, v79
    v_fmac_f32 v33, 0x3f7b14be, v79
    v_sub_f32 v70, v80, v32
    v_sub_f32 v79, v65, v25
    v_add_f32 v80, v80, v32
    v_add_f32 v65, v65, v25
    v_mul_f32 v32, 0x3f6c835e, v70
    v_mul_f32 v25, 0xbec3ef15, v70
    v_fmac_f32 v32, 0x3ec3ef15, v79
    v_fmac_f32 v25, 0x3f6c835e, v79
    v_sub_f32 v70, v64, v24
    v_sub_f32 v79, v41, v57
    v_add_f32 v64, v64, v24
    v_add_f32 v41, v41, v57
    v_mul_f32 v24, 0x3f54db31, v70
    v_mul_f32 v57, 0xbf0e39da, v70
    v_fmac_f32 v24, 0x3f0e39da, v79
    v_fmac_f32 v57, 0x3f54db31, v79
    v_sub_f32 v70, v40, v56
    v_sub_f32 v79, v73, v21
    v_add_f32 v40, v40, v56
    v_add_f32 v73, v73, v21
    v_mul_f32 v56, 0x3f3504f3, v70
    v_mul_f32 v21, 0xbf3504f3, v70
    v_fmac_f32 v56, 0x3f3504f3, v79
    v_fmac_f32 v21, 0x3f3504f3, v79
    v_sub_f32 v70, v72, v20
    v_sub_f32 v79, v45, v53
    v_add_f32 v72, v72, v20
    v_add_f32 v45, v45, v53
    v_mul_f32 v20, 0x3f0e39da, v70
    v_mul_f32 v53, 0xbf54db31, v70
    v_fmac_f32 v20, 0x3f54db31, v79
    v_fmac_f32 v53, 0x3f0e39da, v79
    v_sub_f32 v70, v44, v52
    v_sub_f32 v79, v29, v37
    v_add_f32 v44, v44, v52
    v_add_f32 v29, v29, v37
    v_mul_f32 v52, 0x3ec3ef15, v70
    v_mul_f32 v37, 0xbf6c835e, v70
    v_fmac_f32 v52, 0x3f6c835e, v79
    v_fmac_f32 v37, 0x3ec3ef15, v79
    v_sub_f32 v70, v28, v36
    v_sub_f32 v79, v61, v69
    v_add_f32 v28, v28, v36
    v_add_f32 v61, v61, v69
    v_mul_f32 v36, 0x3e47c5c2, v70
    v_mul_f32 v69, 0xbf7b14be, v70
    v_fmac_f32 v36, 0x3f7b14be, v79
    v_fmac_f32 v69, 0x3e47c5c2, v79
    v_sub_f32 v70, v77, v19
    v_sub_f32 v79, v68, v60
    v_add_f32 v60, v60, v68
    v_add_f32 v77, v77, v19
    v_sub_f32 v68, v76, v18
    v_sub_f32 v19, v47, v51
    v_add_f32 v76, v76, v18
    v_add_f32 v47, v47, v51
    v_mul_f32 v18, 0xbe47c5c2, v68
    v_mul_f32 v51, 0xbf7b14be, v68
    v_fmac_f32 v18, 0x3f7b14be, v19
    v_fmac_f32 v51, 0xbe47c5c2, v19
    v_sub_f32 v68, v46, v50
    v_sub_f32 v19, v31, v35
    v_add_f32 v46, v46, v50
    v_add_f32 v31, v31, v35
    v_mul_f32 v50, 0xbec3ef15, v68
    v_mul_f32 v35, 0xbf6c835e, v68
    v_fmac_f32 v50, 0x3f6c835e, v19
    v_fmac_f32 v35, 0xbec3ef15, v19
    v_sub_f32 v68, v30, v34
    v_sub_f32 v19, v63, v67
    v_add_f32 v30, v30, v34
    v_add_f32 v63, v63, v67
    v_mul_f32 v34, 0xbf0e39da, v68
    v_mul_f32 v67, 0xbf54db31, v68
    v_fmac_f32 v34, 0x3f54db31, v19
    v_fmac_f32 v67, 0xbf0e39da, v19
    v_sub_f32 v68, v62, v66
    v_sub_f32 v19, v23, v27
    v_add_f32 v62, v62, v66
    v_add_f32 v23, v23, v27
    v_mul_f32 v66, 0xbf3504f3, v68
    v_mul_f32 v27, 0xbf3504f3, v68
    v_fmac_f32 v66, 0x3f3504f3, v19
    v_fmac_f32 v27, 0xbf3504f3, v19
    v_sub_f32 v68, v22, v26
    v_sub_f32 v19, v55, v59
    v_add_f32 v22, v22, v26
    v_add_f32 v55, v55, v59
    v_mul_f32 v26, 0xbf54db31, v68
    v_mul_f32 v59, 0xbf0e39da, v68
    v_fmac_f32 v26, 0x3f0e39da, v19
    v_fmac_f32 v59, 0xbf54db31, v19
    v_sub_f32 v68, v54, v58
    v_sub_f32 v19, v39, v43
    v_add_f32 v54, v54, v58
    v_add_f32 v39, v39, v43
    v_mul_f32 v58, 0xbf6c835e, v68
    v_mul_f32 v43, 0xbec3ef15, v68
    v_fmac_f32 v58, 0x3ec3ef15, v19
    v_fmac_f32 v43, 0xbf6c835e, v19
    v_sub_f32 v68, v38, v42
    v_sub_f32 v19, v71, v75
    v_add_f32 v38, v38, v42
    v_add_f32 v71, v71, v75
    v_mul_f32 v42, 0xbf7b14be, v68
    v_mul_f32 v75, 0xbe47c5c2, v68
    v_fmac_f32 v42, 0x3e47c5c2, v19
    v_fmac_f32 v75, 0xbf7b14be, v19
    v_sub_f32 v68, v16, v60
    v_sub_f32 v19, v17, v77
    v_add_f32 v16, v16, v60
    v_add_f32 v17, v17, v77
    v_sub_f32 v60, v83, v76
    v_sub_f32 v77, v81, v47
    v_add_f32 v83, v83, v76
    v_add_f32 v81, v81, v47
    v_mul_f32 v76, 0x3f6c835e, v60
    v_mul_f32 v47, 0xbec3ef15, v60
    v_fmac_f32 v76, 0x3ec3ef15, v77
    v_fmac_f32 v47, 0x3f6c835e, v77
    v_sub_f32 v60, v80, v46
    v_sub_f32 v77, v65, v31
    v_add_f32 v80, v80, v46
    v_add_f32 v65, v65, v31
    v_mul_f32 v46, 0x3f3504f3, v60
    v_mul_f32 v31, 0xbf3504f3, v60
    v_fmac_f32 v46, 0x3f3504f3, v77
    v_fmac_f32 v31, 0x3f3504f3, v77
    v_sub_f32 v60, v64, v30
    v_sub_f32 v77, v41, v63
    v_add_f32 v64, v64, v30
    v_add_f32 v41, v41, v63
    v_mul_f32 v30, 0x3ec3ef15, v60
    v_mul_f32 v63, 0xbf6c835e, v60
    v_fmac_f32 v30, 0x3f6c835e, v77
    v_fmac_f32 v63, 0x3ec3ef15, v77
    v_sub_f32 v60, v73, v23
    v_sub_f32 v77, v62, v40
    v_add_f32 v40, v40, v62
    v_add_f32 v73, v73, v23
    v_sub_f32 v62, v72, v22
    v_sub_f32 v23, v45, v55
    v_add_f32 v72, v72, v22
    v_add_f32 v45, v45, v55
    v_mul_f32 v22, 0xbec3ef15, v62
    v_mul_f32 v55, 0xbf6c835e, v62
    v_fmac_f32 v22, 0x3f6c835e, v23
    v_fmac_f32 v55, 0xbec3ef15, v23
    v_sub_f32 v62, v44, v54
    v_sub_f32 v23, v29, v39
    v_add_f32 v44, v44, v54
    v_add_f32 v29, v29, v39
    v_mul_f32 v54, 0xbf3504f3, v62
    v_mul_f32 v39, 0xbf3504f3, v62
    v_fmac_f32 v54, 0x3f3504f3, v23
    v_fmac_f32 v39, 0xbf3504f3, v23
    v_sub_f32 v62, v28, v38
    v_sub_f32 v23, v61, v71
    v_add_f32 v28, v28, v38
    v_add_f32 v61, v61, v71
    v_mul_f32 v38, 0xbf6c835e, v62
    v_mul_f32 v71, 0xbec3ef15, v62
    v_fmac_f32 v38, 0x3ec3ef15, v23
    v_fmac_f32 v71, 0xbf6c835e, v23
    v_sub_f32 v62, v48, v70
    v_sub_f32 v23, v49, v79
    v_add_f32 v48, v48, v70
    v_add_f32 v49, v49, v79
    v_sub_f32 v70, v78, v18
    v_sub_f32 v79, v33, v51
    v_add_f32 v78, v78, v18
    v_add_f32 v33, v33, v51
    v_mul_f32 v18, 0x3f6c835e, v70
    v_mul_f32 v51, 0xbec3ef15, v70
    v_fmac_f32 v18, 0x3ec3ef15, v79
    v_fmac_f32 v51, 0x3f6c835e, v79
    v_sub_f32 v70, v32, v50
    v_sub_f32 v79, v25, v35
    v_add_f32 v32, v32, v50
    v_add_f32 v25, v25, v35
    v_mul_f32 v50, 0x3f3504f3, v70
    v_mul_f32 v35, 0xbf3504f3, v70
    v_fmac_f32 v50, 0x3f3504f3, v79
    v_fmac_f32 v35, 0x3f3504f3, v79
    v_sub_f32 v70, v24, v34
    v_sub_f32 v79, v57, v67
    v_add_f32 v24, v24, v34
    v_add_f32 v57, v57, v67
    v_mul_f32 v34, 0x3ec3ef15, v70
    v_mul_f32 v67, 0xbf6c835e, v70
    v_fmac_f32 v34, 0x3f6c835e, v79
    v_fmac_f32 v67, 0x3ec3ef15, v79
    v_sub_f32 v70, v21, v27
    v_sub_f32 v79, v66, v56
    v_add_f32 v56, v56, v66
    v_add_f32 v21, v21, v27
    v_sub_f32 v66, v20, v26
    v_sub_f32 v27, v53, v59
    v_add_f32 v20, v20, v26
    v_add_f32 v53, v53, v59
    v_mul_f32 v26, 0xbec3ef15, v66
    v_mul_f32 v59, 0xbf6c835e, v66
    v_fmac_f32 v26, 0x3f6c835e, v27
    v_fmac_f32 v59, 0xbec3ef15, v27
    v_sub_f32 v66, v52, v58
    v_sub_f32 v27, v37, v43
    v_add_f32 v52, v52, v58
    v_add_f32 v37, v37, v43
    v_mul_f32 v58, 0xbf3504f3, v66
    v_mul_f32 v43, 0xbf3504f3, v66
    v_fmac_f32 v58, 0x3f3504f3, v27
    v_fmac_f32 v43, 0xbf3504f3, v27
    v_sub_f32 v66, v36, v42
    v_sub_f32 v27, v69, v75
    v_add_f32 v36, v36, v42
    v_add_f32 v69, v69, v75
    v_mul_f32 v42, 0xbf6c835e, v66
    v_mul_f32 v75, 0xbec3ef15, v66
    v_fmac_f32 v42, 0x3ec3ef15, v27
    v_fmac_f32 v75, 0xbf6c835e, v27
    v_sub_f32 v66, v16, v40
    v_sub_f32 v27, v17, v73
    v_add_f32 v16, v16, v40
    v_add_f32 v17, v17, v73
    v_sub_f32 v40, v83, v72
    v_sub_f32 v73, v81, v45
    v_add_f32 v83, v83, v72
    v_add_f32 v81, v81, v45
    v_mul_f32 v72, 0x3f3504f3, v40
    v_mul_f32 v45, 0xbf3504f3, v40
    v_fmac_f32 v72, 0x3f3504f3, v73
    v_fmac_f32 v45, 0x3f3504f3, v73
    v_sub_f32 v40, v65, v29
    v_sub_f32 v73, v44, v80
    v_add_f32 v80, v80, v44
    v_add_f32 v65, v65, v29
    v_sub_f32 v44, v64, v28
    v_sub_f32 v29, v41, v61
    v_add_f32 v64, v64, v28
    v_add_f32 v41, v41, v61
    v_mul_f32 v28, 0xbf3504f3, v44
    v_mul_f32 v61, 0xbf3504f3, v44
    v_fmac_f32 v28, 0x3f3504f3, v29
    v_fmac_f32 v61, 0xbf3504f3, v29
    v_sub_f32 v44, v68, v60
    v_sub_f32 v29, v19, v77
    v_add_f32 v68, v68, v60
    v_add_f32 v19, v19, v77
    v_sub_f32 v60, v76, v22
    v_sub_f32 v77, v47, v55
    v_add_f32 v76, v76, v22
    v_add_f32 v47, v47, v55
    v_mul_f32 v22, 0x3f3504f3, v60
    v_mul_f32 v55, 0xbf3504f3, v60
    v_fmac_f32 v22, 0x3f3504f3, v77
    v_fmac_f32 v55, 0x3f3504f3, v77
    v_sub_f32 v60, v31, v39
    v_sub_f32 v77, v54, v46
    v_add_f32 v46, v46, v54
    v_add_f32 v31, v31, v39
    v_sub_f32 v54, v30, v38
    v_sub_f32 v39, v63, v71
    v_add_f32 v30, v30, v38
    v_add_f32 v63, v63, v71
    v_mul_f32 v38, 0xbf3504f3, v54
    v_mul_f32 v71, 0xbf3504f3, v54
    v_fmac_f32 v38, 0x3f3504f3, v39
    v_fmac_f32 v71, 0xbf3504f3, v39
    v_sub_f32 v54, v48, v56
    v_sub_f32 v39, v49, v21
    v_add_f32 v48, v48, v56
    v_add_f32 v49, v49, v21
    v_sub_f32 v56, v78, v20
    v_sub_f32 v21, v33, v53
    v_add_f32 v78, v78, v20
    v_add_f32 v33, v33, v53
    v_mul_f32 v20, 0x3f3504f3, v56
    v_mul_f32 v53, 0xbf3504f3, v56
    v_fmac_f32 v20, 0x3f3504f3, v21
    v_fmac_f32 v53, 0x3f3504f3, v21
    v_sub_f32 v56, v25, v37
    v_sub_f32 v21, v52, v32
    v_add_f32 v32, v32, v52
    v_add_f32 v25, v25, v37
    v_sub_f32 v52, v24, v36
    v_sub_f32 v37, v57, v69
    v_add_f32 v24, v24, v36
    v_add_f32 v57, v57, v69
    v_mul_f32 v36, 0xbf3504f3, v52
    v_mul_f32 v69, 0xbf3504f3, v52
    v_fmac_f32 v36, 0x3f3504f3, v37
    v_fmac_f32 v69, 0xbf3504f3, v37
    v_sub_f32 v52, v62, v70
    v_sub_f32 v37, v23, v79
    v_add_f32 v62, v62, v70
    v_add_f32 v23, v23, v79
    v_sub_f32 v70, v18, v26
    v_sub_f32 v79, v51, v59
    v_add_f32 v18, v18, v26
    v_add_f32 v51, v51, v59
    v_mul_f32 v26, 0x3f3504f3, v70
    v_mul_f32 v59, 0xbf3504f3, v70
    v_fmac_f32 v26, 0x3f3504f3, v79
    v_fmac_f32 v59, 0x3f3504f3, v79
    v_sub_f32 v70, v35, v43
    v_sub_f32 v79, v58, v50
    v_add_f32 v50, v50, v58
    v_add_f32 v35, v35, v43
    v_sub_f32 v58, v34, v42
    v_sub_f32 v43, v67, v75
    v_add_f32 v34, v34, v42
    v_add_f32 v67, v67, v75
    v_mul_f32 v42, 0xbf3504f3, v58
    v_mul_f32 v75, 0xbf3504f3, v58
    v_fmac_f32 v42, 0x3f3504f3, v43
    v_fmac_f32 v75, 0xbf3504f3, v43
    v_sub_f32 v58, v16, v80
    v_sub_f32 v43, v17, v65
    v_add_f32 v16, v16, v80
    v_add_f32 v17, v17, v65
    v_sub_f32 v80, v81, v41
    v_sub_f32 v65, v64, v83
    v_add_f32 v83, v83, v64
    v_add_f32 v81, v81, v41
    v_sub_f32 v64, v66, v40
    v_sub_f32 v41, v27, v73
    v_add_f32 v66, v66, v40
    v_add_f32 v27, v27, v73
    v_sub_f32 v40, v45, v61
    v_sub_f32 v73, v28, v72
    v_add_f32 v72, v72, v28
    v_add_f32 v45, v45, v61
    v_sub_f32 v28, v68, v46
    v_sub_f32 v61, v19, v31
    v_add_f32 v68, v68, v46
    v_add_f32 v19, v19, v31
    v_sub_f32 v46, v47, v63
    v_sub_f32 v31, v30, v76
    v_add_f32 v76, v76, v30
    v_add_f32 v47, v47, v63
    v_sub_f32 v30, v44, v60
    v_sub_f32 v63, v29, v77
    v_add_f32 v44, v44, v60
    v_add_f32 v29, v29, v77
    v_sub_f32 v60, v55, v71
    v_sub_f32 v77, v38, v22
    v_add_f32 v22, v22, v38
    v_add_f32 v55, v55, v71
    v_sub_f32 v38, v48, v32
    v_sub_f32 v71, v49, v25
    v_add_f32 v48, v48, v32
    v_add_f32 v49, v49, v25
    v_sub_f32 v32, v33, v57
    v_sub_f32 v25, v24, v78
    v_add_f32 v78, v78, v24
    v_add_f32 v33, v33, v57
    v_sub_f32 v24, v54, v56
    v_sub_f32 v57, v39, v21
    v_add_f32 v54, v54, v56
    v_add_f32 v39, v39, v21
    v_sub_f32 v56, v53, v69
    v_sub_f32 v21, v36, v20
    v_add_f32 v20, v20, v36
    v_add_f32 v53, v53, v69
    v_sub_f32 v36, v62, v50
    v_sub_f32 v69, v23, v35
    v_add_f32 v62, v62, v50
    v_add_f32 v23, v23, v35
    v_sub_f32 v50, v51, v67
    v_sub_f32 v35, v34, v18
    v_add_f32 v18, v18, v34
    v_add_f32 v51, v51, v67
    v_sub_f32 v34, v52, v70
    v_sub_f32 v67, v37, v79
    v_add_f32 v52, v52, v70
    v_add_f32 v37, v37, v79
    v_sub_f32 v70, v59, v75
    v_sub_f32 v79, v42, v26
    v_add_f32 v26, v26, v42
    v_add_f32 v59, v59, v75
    v_sub_f32 v42, v16, v83
    v_sub_f32 v75, v17, v81
    v_add_f32 v16, v16, v83
    v_add_f32 v17, v17, v81
    v_sub_f32 v83, v58, v80
    v_sub_f32 v81, v43, v65
    v_add_f32 v58, v58, v80
    v_add_f32 v43, v43, v65
    v_sub_f32 v80, v66, v72
    v_sub_f32 v65, v27, v45
    v_add_f32 v66, v66, v72
    v_add_f32 v27, v27, v45
    v_sub_f32 v72, v64, v40
    v_sub_f32 v45, v41, v73
    v_add_f32 v64, v64, v40
    v_add_f32 v41, v41, v73
    v_sub_f32 v40, v68, v76
    v_sub_f32 v73, v19, v47
    v_add_f32 v68, v68, v76
    v_add_f32 v19, v19, v47
    v_sub_f32 v76, v28, v46
    v_sub_f32 v47, v61, v31
    v_add_f32 v28, v28, v46
    v_add_f32 v61, v61, v31
    v_sub_f32 v46, v44, v22
    v_sub_f32 v31, v29, v55
    v_add_f32 v44, v44, v22
    v_add_f32 v29, v29, v55
    v_sub_f32 v22, v30, v60
    v_sub_f32 v55, v63, v77
    v_add_f32 v30, v30, v60
    v_add_f32 v63, v63, v77
    v_sub_f32 v60, v48, v78
    v_sub_f32 v77, v49, v33
    v_add_f32 v48, v48, v78
    v_add_f32 v49, v49, v33
    v_sub_f32 v78, v38, v32
    v_sub_f32 v33, v71, v25
    v_add_f32 v38, v38, v32
    v_add_f32 v71, v71, v25
    v_sub_f32 v32, v54, v20
    v_sub_f32 v25, v39, v53
    v_add_f32 v54, v54, v20
    v_add_f32 v39, v39, v53
    v_sub_f32 v20, v24, v56
    v_sub_f32 v53, v57, v21
    v_add_f32 v24, v24, v56
    v_add_f32 v57, v57, v21
    v_sub_f32 v56, v62, v18
    v_sub_f32 v21, v23, v51
    v_add_f32 v62, v62, v18
    v_add_f32 v23, v23, v51
    v_sub_f32 v18, v36, v50
    v_sub_f32 v51, v69, v35
    v_add_f32 v36, v36, v50
    v_add_f32 v69, v69, v35
    v_sub_f32 v50, v52, v26
    v_sub_f32 v35, v37, v59
    v_add_f32 v52, v52, v26
    v_add_f32 v37, v37, v59
    v_sub_f32 v26, v34, v70
    v_sub_f32 v59, v67, v79
    v_add_f32 v34, v34, v70
    v_add_f32 v67, v67, v79
    v_mul_f32 v70, 0xbc800000, v10
    v_cos_f32 v79, v70
    v_sin_f32 v82, v70
    s_nop 0
    v_mul_f32 v74, v48, v79
    v_fma_f32 v74, -v49, v82, v74
    v_mul_f32 v49, v49, v79
    v_fmac_f32 v49, v48, v82
    v_mul_f32 v70, 0xbd000000, v10
    v_cos_f32 v79, v70
    v_sin_f32 v82, v70
    s_nop 0
    v_mul_f32 v48, v68, v79
    v_fma_f32 v48, -v19, v82, v48
    v_mul_f32 v19, v19, v79
    v_fmac_f32 v19, v68, v82
    v_mul_f32 v70, 0xbd400000, v10
    v_cos_f32 v79, v70
    v_sin_f32 v82, v70
    s_nop 0
    v_mul_f32 v68, v62, v79
    v_fma_f32 v68, -v23, v82, v68
    v_mul_f32 v23, v23, v79
    v_fmac_f32 v23, v62, v82
    v_mul_f32 v70, 0xbd800000, v10
    v_cos_f32 v79, v70
    v_sin_f32 v82, v70
    s_nop 0
    v_mul_f32 v62, v66, v79
    v_fma_f32 v62, -v27, v82, v62
    v_mul_f32 v27, v27, v79
    v_fmac_f32 v27, v66, v82
    v_mul_f32 v70, 0xbda00000, v10
    v_cos_f32 v79, v70
    v_sin_f32 v82, v70
    s_nop 0
    v_mul_f32 v66, v54, v79
    v_fma_f32 v66, -v39, v82, v66
    v_mul_f32 v39, v39, v79
    v_fmac_f32 v39, v54, v82
    v_mul_f32 v70, 0xbdc00000, v10
    v_cos_f32 v79, v70
    v_sin_f32 v82, v70
    s_nop 0
    v_mul_f32 v54, v44, v79
    v_fma_f32 v54, -v29, v82, v54
    v_mul_f32 v29, v29, v79
    v_fmac_f32 v29, v44, v82
    v_mul_f32 v70, 0xbde00000, v10
    v_cos_f32 v79, v70
    v_sin_f32 v82, v70
    s_nop 0
    v_mul_f32 v44, v52, v79
    v_fma_f32 v44, -v37, v82, v44
    v_mul_f32 v37, v37, v79
    v_fmac_f32 v37, v52, v82
    v_mul_f32 v70, 0xbe000000, v10
    v_cos_f32 v79, v70
    v_sin_f32 v82, v70
    s_nop 0
    v_mul_f32 v52, v58, v79
    v_fma_f32 v52, -v43, v82, v52
    v_mul_f32 v43, v43, v79
    v_fmac_f32 v43, v58, v82
    v_mul_f32 v70, 0xbe100000, v10
    v_cos_f32 v79, v70
    v_sin_f32 v82, v70
    s_nop 0
    v_mul_f32 v58, v38, v79
    v_fma_f32 v58, -v71, v82, v58
    v_mul_f32 v71, v71, v79
    v_fmac_f32 v71, v38, v82
    v_mul_f32 v70, 0xbe200000, v10
    v_cos_f32 v79, v70
    v_sin_f32 v82, v70
    s_nop 0
    v_mul_f32 v38, v28, v79
    v_fma_f32 v38, -v61, v82, v38
    v_mul_f32 v61, v61, v79
    v_fmac_f32 v61, v28, v82
    v_mul_f32 v70, 0xbe300000, v10
    v_cos_f32 v79, v70
    v_sin_f32 v82, v70
    s_nop 0
    v_mul_f32 v28, v36, v79
    v_fma_f32 v28, -v69, v82, v28
    v_mul_f32 v69, v69, v79
    v_fmac_f32 v69, v36, v82
    v_mul_f32 v70, 0xbe400000, v10
    v_cos_f32 v79, v70
    v_sin_f32 v82, v70
    s_nop 0
    v_mul_f32 v36, v64, v79
    v_fma_f32 v36, -v41, v82, v36
    v_mul_f32 v41, v41, v79
    v_fmac_f32 v41, v64, v82
    v_mul_f32 v70, 0xbe500000, v10
    v_cos_f32 v79, v70
    v_sin_f32 v82, v70
    s_nop 0
    v_mul_f32 v64, v24, v79
    v_fma_f32 v64, -v57, v82, v64
    v_mul_f32 v57, v57, v79
    v_fmac_f32 v57, v24, v82
    v_mul_f32 v70, 0xbe600000, v10
    v_cos_f32 v79, v70
    v_sin_f32 v82, v70
    s_nop 0
    v_mul_f32 v24, v30, v79
    v_fma_f32 v24, -v63, v82, v24
    v_mul_f32 v63, v63, v79
    v_fmac_f32 v63, v30, v82
    v_mul_f32 v70, 0xbe700000, v10
    v_cos_f32 v79, v70
    v_sin_f32 v82, v70
    s_nop 0
    v_mul_f32 v30, v34, v79
    v_fma_f32 v30, -v67, v82, v30
    v_mul_f32 v67, v67, v79
    v_fmac_f32 v67, v34, v82
    v_mul_f32 v70, 0xbe800000, v10
    v_cos_f32 v79, v70
    v_sin_f32 v82, v70
    s_nop 0
    v_mul_f32 v34, v42, v79
    v_fma_f32 v34, -v75, v82, v34
    v_mul_f32 v75, v75, v79
    v_fmac_f32 v75, v42, v82
    v_mul_f32 v70, 0xbe880000, v10
    v_cos_f32 v79, v70
    v_sin_f32 v82, v70
    s_nop 0
    v_mul_f32 v42, v60, v79
    v_fma_f32 v42, -v77, v82, v42
    v_mul_f32 v77, v77, v79
    v_fmac_f32 v77, v60, v82
    v_mul_f32 v70, 0xbe900000, v10
    v_cos_f32 v79, v70
    v_sin_f32 v82, v70
    s_nop 0
    v_mul_f32 v60, v40, v79
    v_fma_f32 v60, -v73, v82, v60
    v_mul_f32 v73, v73, v79
    v_fmac_f32 v73, v40, v82
    v_mul_f32 v70, 0xbe980000, v10
    v_cos_f32 v79, v70
    v_sin_f32 v82, v70
    s_nop 0
    v_mul_f32 v40, v56, v79
    v_fma_f32 v40, -v21, v82, v40
    v_mul_f32 v21, v21, v79
    v_fmac_f32 v21, v56, v82
    v_mul_f32 v70, 0xbea00000, v10
    v_cos_f32 v79, v70
    v_sin_f32 v82, v70
    s_nop 0
    v_mul_f32 v56, v80, v79
    v_fma_f32 v56, -v65, v82, v56
    v_mul_f32 v65, v65, v79
    v_fmac_f32 v65, v80, v82
    v_mul_f32 v70, 0xbea80000, v10
    v_cos_f32 v79, v70
    v_sin_f32 v82, v70
    s_nop 0
    v_mul_f32 v80, v32, v79
    v_fma_f32 v80, -v25, v82, v80
    v_mul_f32 v25, v25, v79
    v_fmac_f32 v25, v32, v82
    v_mul_f32 v70, 0xbeb00000, v10
    v_cos_f32 v79, v70
    v_sin_f32 v82, v70
    s_nop 0
    v_mul_f32 v32, v46, v79
    v_fma_f32 v32, -v31, v82, v32
    v_mul_f32 v31, v31, v79
    v_fmac_f32 v31, v46, v82
    v_mul_f32 v70, 0xbeb80000, v10
    v_cos_f32 v79, v70
    v_sin_f32 v82, v70
    s_nop 0
    v_mul_f32 v46, v50, v79
    v_fma_f32 v46, -v35, v82, v46
    v_mul_f32 v35, v35, v79
    v_fmac_f32 v35, v50, v82
    v_mul_f32 v70, 0xbec00000, v10
    v_cos_f32 v79, v70
    v_sin_f32 v82, v70
    s_nop 0
    v_mul_f32 v50, v83, v79
    v_fma_f32 v50, -v81, v82, v50
    v_mul_f32 v81, v81, v79
    v_fmac_f32 v81, v83, v82
    v_mul_f32 v70, 0xbec80000, v10
    v_cos_f32 v79, v70
    v_sin_f32 v82, v70
    s_nop 0
    v_mul_f32 v83, v78, v79
    v_fma_f32 v83, -v33, v82, v83
    v_mul_f32 v33, v33, v79
    v_fmac_f32 v33, v78, v82
    v_mul_f32 v70, 0xbed00000, v10
    v_cos_f32 v79, v70
    v_sin_f32 v82, v70
    s_nop 0
    v_mul_f32 v78, v76, v79
    v_fma_f32 v78, -v47, v82, v78
    v_mul_f32 v47, v47, v79
    v_fmac_f32 v47, v76, v82
    v_mul_f32 v70, 0xbed80000, v10
    v_cos_f32 v79, v70
    v_sin_f32 v82, v70
    s_nop 0
    v_mul_f32 v76, v18, v79
    v_fma_f32 v76, -v51, v82, v76
    v_mul_f32 v51, v51, v79
    v_fmac_f32 v51, v18, v82
    v_mul_f32 v70, 0xbee00000, v10
    v_cos_f32 v79, v70
    v_sin_f32 v82, v70
    s_nop 0
    v_mul_f32 v18, v72, v79
    v_fma_f32 v18, -v45, v82, v18
    v_mul_f32 v45, v45, v79
    v_fmac_f32 v45, v72, v82
    v_mul_f32 v70, 0xbee80000, v10
    v_cos_f32 v79, v70
    v_sin_f32 v82, v70
    s_nop 0
    v_mul_f32 v72, v20, v79
    v_fma_f32 v72, -v53, v82, v72
    v_mul_f32 v53, v53, v79
    v_fmac_f32 v53, v20, v82
    v_mul_f32 v70, 0xbef00000, v10
    v_cos_f32 v79, v70
    v_sin_f32 v82, v70
    s_nop 0
    v_mul_f32 v20, v22, v79
    v_fma_f32 v20, -v55, v82, v20
    v_mul_f32 v55, v55, v79
    v_fmac_f32 v55, v22, v82
    v_mul_f32 v70, 0xbef80000, v10
    v_cos_f32 v79, v70
    v_sin_f32 v82, v70
    s_nop 0
    v_mul_f32 v22, v26, v79
    v_fma_f32 v22, -v59, v82, v22
    v_mul_f32 v59, v59, v79
    v_fmac_f32 v59, v26, v82
    s_nop 1
    v_mov_b32_dpp v70, v16 quad_perm:[1,0,3,2] row_mask:0xf bank_mask:0xf
    v_fma_f32 v16, v16, v9, v70
    v_mov_b32_dpp v70, v17 quad_perm:[1,0,3,2] row_mask:0xf bank_mask:0xf
    v_fma_f32 v17, v17, v9, v70
    v_mov_b32_dpp v70, v74 quad_perm:[1,0,3,2] row_mask:0xf bank_mask:0xf
    v_fma_f32 v74, v74, v9, v70
    v_mov_b32_dpp v70, v49 quad_perm:[1,0,3,2] row_mask:0xf bank_mask:0xf
    v_fma_f32 v49, v49, v9, v70
    v_mov_b32_dpp v70, v48 quad_perm:[1,0,3,2] row_mask:0xf bank_mask:0xf
    v_fma_f32 v48, v48, v9, v70
    v_mov_b32_dpp v70, v19 quad_perm:[1,0,3,2] row_mask:0xf bank_mask:0xf
    v_fma_f32 v19, v19, v9, v70
    v_mov_b32_dpp v70, v68 quad_perm:[1,0,3,2] row_mask:0xf bank_mask:0xf
    v_fma_f32 v68, v68, v9, v70
    v_mov_b32_dpp v70, v23 quad_perm:[1,0,3,2] row_mask:0xf bank_mask:0xf
    v_fma_f32 v23, v23, v9, v70
    v_mov_b32_dpp v70, v62 quad_perm:[1,0,3,2] row_mask:0xf bank_mask:0xf
    v_fma_f32 v62, v62, v9, v70
    v_mov_b32_dpp v70, v27 quad_perm:[1,0,3,2] row_mask:0xf bank_mask:0xf
    v_fma_f32 v27, v27, v9, v70
    v_mov_b32_dpp v70, v66 quad_perm:[1,0,3,2] row_mask:0xf bank_mask:0xf
    v_fma_f32 v66, v66, v9, v70
    v_mov_b32_dpp v70, v39 quad_perm:[1,0,3,2] row_mask:0xf bank_mask:0xf
    v_fma_f32 v39, v39, v9, v70
    v_mov_b32_dpp v70, v54 quad_perm:[1,0,3,2] row_mask:0xf bank_mask:0xf
    v_fma_f32 v54, v54, v9, v70
    v_mov_b32_dpp v70, v29 quad_perm:[1,0,3,2] row_mask:0xf bank_mask:0xf
    v_fma_f32 v29, v29, v9, v70
    v_mov_b32_dpp v70, v44 quad_perm:[1,0,3,2] row_mask:0xf bank_mask:0xf
    v_fma_f32 v44, v44, v9, v70
    v_mov_b32_dpp v70, v37 quad_perm:[1,0,3,2] row_mask:0xf bank_mask:0xf
    v_fma_f32 v37, v37, v9, v70
    v_mov_b32_dpp v70, v52 quad_perm:[1,0,3,2] row_mask:0xf bank_mask:0xf
    v_fma_f32 v52, v52, v9, v70
    v_mov_b32_dpp v70, v43 quad_perm:[1,0,3,2] row_mask:0xf bank_mask:0xf
    v_fma_f32 v43, v43, v9, v70
    v_mov_b32_dpp v70, v58 quad_perm:[1,0,3,2] row_mask:0xf bank_mask:0xf
    v_fma_f32 v58, v58, v9, v70
    v_mov_b32_dpp v70, v71 quad_perm:[1,0,3,2] row_mask:0xf bank_mask:0xf
    v_fma_f32 v71, v71, v9, v70
    v_mov_b32_dpp v70, v38 quad_perm:[1,0,3,2] row_mask:0xf bank_mask:0xf
    v_fma_f32 v38, v38, v9, v70
    v_mov_b32_dpp v70, v61 quad_perm:[1,0,3,2] row_mask:0xf bank_mask:0xf
    v_fma_f32 v61, v61, v9, v70
    v_mov_b32_dpp v70, v28 quad_perm:[1,0,3,2] row_mask:0xf bank_mask:0xf
    v_fma_f32 v28, v28, v9, v70
    v_mov_b32_dpp v70, v69 quad_perm:[1,0,3,2] row_mask:0xf bank_mask:0xf
    v_fma_f32 v69, v69, v9, v70
    v_mov_b32_dpp v70, v36 quad_perm:[1,0,3,2] row_mask:0xf bank_mask:0xf
    v_fma_f32 v36, v36, v9, v70
    v_mov_b32_dpp v70, v41 quad_perm:[1,0,3,2] row_mask:0xf bank_mask:0xf
    v_fma_f32 v41, v41, v9, v70
    v_mov_b32_dpp v70, v64 quad_perm:[1,0,3,2] row_mask:0xf bank_mask:0xf
    v_fma_f32 v64, v64, v9, v70
    v_mov_b32_dpp v70, v57 quad_perm:[1,0,3,2] row_mask:0xf bank_mask:0xf
    v_fma_f32 v57, v57, v9, v70
    v_mov_b32_dpp v70, v24 quad_perm:[1,0,3,2] row_mask:0xf bank_mask:0xf
    v_fma_f32 v24, v24, v9, v70
    v_mov_b32_dpp v70, v63 quad_perm:[1,0,3,2] row_mask:0xf bank_mask:0xf
    v_fma_f32 v63, v63, v9, v70
    v_mov_b32_dpp v70, v30 quad_perm:[1,0,3,2] row_mask:0xf bank_mask:0xf
    v_fma_f32 v30, v30, v9, v70
    v_mov_b32_dpp v70, v67 quad_perm:[1,0,3,2] row_mask:0xf bank_mask:0xf
    v_fma_f32 v67, v67, v9, v70
    v_mov_b32_dpp v70, v34 quad_perm:[1,0,3,2] row_mask:0xf bank_mask:0xf
    v_fma_f32 v34, v34, v9, v70
    v_mov_b32_dpp v70, v75 quad_perm:[1,0,3,2] row_mask:0xf bank_mask:0xf
    v_fma_f32 v75, v75, v9, v70
    v_mov_b32_dpp v70, v42 quad_perm:[1,0,3,2] row_mask:0xf bank_mask:0xf
    v_fma_f32 v42, v42, v9, v70
    v_mov_b32_dpp v70, v77 quad_perm:[1,0,3,2] row_mask:0xf bank_mask:0xf
    v_fma_f32 v77, v77, v9, v70
    v_mov_b32_dpp v70, v60 quad_perm:[1,0,3,2] row_mask:0xf bank_mask:0xf
    v_fma_f32 v60, v60, v9, v70
    v_mov_b32_dpp v70, v73 quad_perm:[1,0,3,2] row_mask:0xf bank_mask:0xf
    v_fma_f32 v73, v73, v9, v70
    v_mov_b32_dpp v70, v40 quad_perm:[1,0,3,2] row_mask:0xf bank_mask:0xf
    v_fma_f32 v40, v40, v9, v70
    v_mov_b32_dpp v70, v21 quad_perm:[1,0,3,2] row_mask:0xf bank_mask:0xf
    v_fma_f32 v21, v21, v9, v70
    v_mov_b32_dpp v70, v56 quad_perm:[1,0,3,2] row_mask:0xf bank_mask:0xf
    v_fma_f32 v56, v56, v9, v70
    v_mov_b32_dpp v70, v65 quad_perm:[1,0,3,2] row_mask:0xf bank_mask:0xf
    v_fma_f32 v65, v65, v9, v70
    v_mov_b32_dpp v70, v80 quad_perm:[1,0,3,2] row_mask:0xf bank_mask:0xf
    v_fma_f32 v80, v80, v9, v70
    v_mov_b32_dpp v70, v25 quad_perm:[1,0,3,2] row_mask:0xf bank_mask:0xf
    v_fma_f32 v25, v25, v9, v70
    v_mov_b32_dpp v70, v32 quad_perm:[1,0,3,2] row_mask:0xf bank_mask:0xf
    v_fma_f32 v32, v32, v9, v70
    v_mov_b32_dpp v70, v31 quad_perm:[1,0,3,2] row_mask:0xf bank_mask:0xf
    v_fma_f32 v31, v31, v9, v70
    v_mov_b32_dpp v70, v46 quad_perm:[1,0,3,2] row_mask:0xf bank_mask:0xf
    v_fma_f32 v46, v46, v9, v70
    v_mov_b32_dpp v70, v35 quad_perm:[1,0,3,2] row_mask:0xf bank_mask:0xf
    v_fma_f32 v35, v35, v9, v70
    v_mov_b32_dpp v70, v50 quad_perm:[1,0,3,2] row_mask:0xf bank_mask:0xf
    v_fma_f32 v50, v50, v9, v70
    v_mov_b32_dpp v70, v81 quad_perm:[1,0,3,2] row_mask:0xf bank_mask:0xf
    v_fma_f32 v81, v81, v9, v70
    v_mov_b32_dpp v70, v83 quad_perm:[1,0,3,2] row_mask:0xf bank_mask:0xf
    v_fma_f32 v83, v83, v9, v70
    v_mov_b32_dpp v70, v33 quad_perm:[1,0,3,2] row_mask:0xf bank_mask:0xf
    v_fma_f32 v33, v33, v9, v70
    v_mov_b32_dpp v70, v78 quad_perm:[1,0,3,2] row_mask:0xf bank_mask:0xf
    v_fma_f32 v78, v78, v9, v70
    v_mov_b32_dpp v70, v47 quad_perm:[1,0,3,2] row_mask:0xf bank_mask:0xf
    v_fma_f32 v47, v47, v9, v70
    v_mov_b32_dpp v70, v76 quad_perm:[1,0,3,2] row_mask:0xf bank_mask:0xf
    v_fma_f32 v76, v76, v9, v70
    v_mov_b32_dpp v70, v51 quad_perm:[1,0,3,2] row_mask:0xf bank_mask:0xf
    v_fma_f32 v51, v51, v9, v70
    v_mov_b32_dpp v70, v18 quad_perm:[1,0,3,2] row_mask:0xf bank_mask:0xf
    v_fma_f32 v18, v18, v9, v70
    v_mov_b32_dpp v70, v45 quad_perm:[1,0,3,2] row_mask:0xf bank_mask:0xf
    v_fma_f32 v45, v45, v9, v70
    v_mov_b32_dpp v70, v72 quad_perm:[1,0,3,2] row_mask:0xf bank_mask:0xf
    v_fma_f32 v72, v72, v9, v70
    v_mov_b32_dpp v70, v53 quad_perm:[1,0,3,2] row_mask:0xf bank_mask:0xf
    v_fma_f32 v53, v53, v9, v70
    v_mov_b32_dpp v70, v20 quad_perm:[1,0,3,2] row_mask:0xf bank_mask:0xf
    v_fma_f32 v20, v20, v9, v70
    v_mov_b32_dpp v70, v55 quad_perm:[1,0,3,2] row_mask:0xf bank_mask:0xf
    v_fma_f32 v55, v55, v9, v70
    v_mov_b32_dpp v70, v22 quad_perm:[1,0,3,2] row_mask:0xf bank_mask:0xf
    v_fma_f32 v22, v22, v9, v70
    v_mov_b32_dpp v70, v59 quad_perm:[1,0,3,2] row_mask:0xf bank_mask:0xf
    v_fma_f32 v59, v59, v9, v70
    s_waitcnt vmcnt(0)
    s_mov_b32 s20, 0x34800000
    v_lshlrev_b32 v70, 16, v88
    v_and_b32 v79, 0xffff0000, v88
    v_mul_f32 v70, s20, v70
    v_mul_f32 v79, s20, v79
    v_mul_f32 v82, v16, v70
    v_fma_f32 v82, -v17, v79, v82
    v_mul_f32 v17, v17, v70
    v_fmac_f32 v17, v16, v79
    v_lshlrev_b32 v70, 16, v89
    v_and_b32 v79, 0xffff0000, v89
    v_mul_f32 v70, s20, v70
    v_mul_f32 v79, s20, v79
    v_mul_f32 v16, v74, v70
    v_fma_f32 v16, -v49, v79, v16
    v_mul_f32 v49, v49, v70
    v_fmac_f32 v49, v74, v79
    v_lshlrev_b32 v70, 16, v90
    v_and_b32 v79, 0xffff0000, v90
    v_mul_f32 v70, s20, v70
    v_mul_f32 v79, s20, v79
    v_mul_f32 v74, v48, v70
    v_fma_f32 v74, -v19, v79, v74
    v_mul_f32 v19, v19, v70
    v_fmac_f32 v19, v48, v79
    v_lshlrev_b32 v70, 16, v91
    v_and_b32 v79, 0xffff0000, v91
    v_mul_f32 v70, s20, v70
    v_mul_f32 v79, s20, v79
    v_mul_f32 v48, v68, v70
    v_fma_f32 v48, -v23, v79, v48
    v_mul_f32 v23, v23, v70
    v_fmac_f32 v23, v68, v79
    v_lshlrev_b32 v70, 16, v92
    v_and_b32 v79, 0xffff0000, v92
    v_mul_f32 v70, s20, v70
    v_mul_f32 v79, s20, v79
    v_mul_f32 v68, v62, v70
    v_fma_f32 v68, -v27, v79, v68
    v_mul_f32 v27, v27, v70
    v_fmac_f32 v27, v62, v79
    v_lshlrev_b32 v70, 16, v93
    v_and_b32 v79, 0xffff0000, v93
    v_mul_f32 v70, s20, v70
    v_mul_f32 v79, s20, v79
    v_mul_f32 v62, v66, v70
    v_fma_f32 v62, -v39, v79, v62
    v_mul_f32 v39, v39, v70
    v_fmac_f32 v39, v66, v79
    v_lshlrev_b32 v70, 16, v94
    v_and_b32 v79, 0xffff0000, v94
    v_mul_f32 v70, s20, v70
    v_mul_f32 v79, s20, v79
    v_mul_f32 v66, v54, v70
    v_fma_f32 v66, -v29, v79, v66
    v_mul_f32 v29, v29, v70
    v_fmac_f32 v29, v54, v79
    v_lshlrev_b32 v70, 16, v95
    v_and_b32 v79, 0xffff0000, v95
    v_mul_f32 v70, s20, v70
    v_mul_f32 v79, s20, v79
    v_mul_f32 v54, v44, v70
    v_fma_f32 v54, -v37, v79, v54
    v_mul_f32 v37, v37, v70
    v_fmac_f32 v37, v44, v79
    v_lshlrev_b32 v70, 16, v96
    v_and_b32 v79, 0xffff0000, v96
    v_mul_f32 v70, s20, v70
    v_mul_f32 v79, s20, v79
    v_mul_f32 v44, v52, v70
    v_fma_f32 v44, -v43, v79, v44
    v_mul_f32 v43, v43, v70
    v_fmac_f32 v43, v52, v79
    v_lshlrev_b32 v70, 16, v97
    v_and_b32 v79, 0xffff0000, v97
    v_mul_f32 v70, s20, v70
    v_mul_f32 v79, s20, v79
    v_mul_f32 v52, v58, v70
    v_fma_f32 v52, -v71, v79, v52
    v_mul_f32 v71, v71, v70
    v_fmac_f32 v71, v58, v79
    v_lshlrev_b32 v70, 16, v98
    v_and_b32 v79, 0xffff0000, v98
    v_mul_f32 v70, s20, v70
    v_mul_f32 v79, s20, v79
    v_mul_f32 v58, v38, v70
    v_fma_f32 v58, -v61, v79, v58
    v_mul_f32 v61, v61, v70
    v_fmac_f32 v61, v38, v79
    v_lshlrev_b32 v70, 16, v99
    v_and_b32 v79, 0xffff0000, v99
    v_mul_f32 v70, s20, v70
    v_mul_f32 v79, s20, v79
    v_mul_f32 v38, v28, v70
    v_fma_f32 v38, -v69, v79, v38
    v_mul_f32 v69, v69, v70
    v_fmac_f32 v69, v28, v79
    v_lshlrev_b32 v70, 16, v100
    v_and_b32 v79, 0xffff0000, v100
    v_mul_f32 v70, s20, v70
    v_mul_f32 v79, s20, v79
    v_mul_f32 v28, v36, v70
    v_fma_f32 v28, -v41, v79, v28
    v_mul_f32 v41, v41, v70
    v_fmac_f32 v41, v36, v79
    v_lshlrev_b32 v70, 16, v101
    v_and_b32 v79, 0xffff0000, v101
    v_mul_f32 v70, s20, v70
    v_mul_f32 v79, s20, v79
    v_mul_f32 v36, v64, v70
    v_fma_f32 v36, -v57, v79, v36
    v_mul_f32 v57, v57, v70
    v_fmac_f32 v57, v64, v79
    v_lshlrev_b32 v70, 16, v102
    v_and_b32 v79, 0xffff0000, v102
    v_mul_f32 v70, s20, v70
    v_mul_f32 v79, s20, v79
    v_mul_f32 v64, v24, v70
    v_fma_f32 v64, -v63, v79, v64
    v_mul_f32 v63, v63, v70
    v_fmac_f32 v63, v24, v79
    v_lshlrev_b32 v70, 16, v103
    v_and_b32 v79, 0xffff0000, v103
    v_mul_f32 v70, s20, v70
    v_mul_f32 v79, s20, v79
    v_mul_f32 v24, v30, v70
    v_fma_f32 v24, -v67, v79, v24
    v_mul_f32 v67, v67, v70
    v_fmac_f32 v67, v30, v79
    v_lshlrev_b32 v70, 16, v104
    v_and_b32 v79, 0xffff0000, v104
    v_mul_f32 v70, s20, v70
    v_mul_f32 v79, s20, v79
    v_mul_f32 v30, v34, v70
    v_fma_f32 v30, -v75, v79, v30
    v_mul_f32 v75, v75, v70
    v_fmac_f32 v75, v34, v79
    v_lshlrev_b32 v70, 16, v105
    v_and_b32 v79, 0xffff0000, v105
    v_mul_f32 v70, s20, v70
    v_mul_f32 v79, s20, v79
    v_mul_f32 v34, v42, v70
    v_fma_f32 v34, -v77, v79, v34
    v_mul_f32 v77, v77, v70
    v_fmac_f32 v77, v42, v79
    v_lshlrev_b32 v70, 16, v106
    v_and_b32 v79, 0xffff0000, v106
    v_mul_f32 v70, s20, v70
    v_mul_f32 v79, s20, v79
    v_mul_f32 v42, v60, v70
    v_fma_f32 v42, -v73, v79, v42
    v_mul_f32 v73, v73, v70
    v_fmac_f32 v73, v60, v79
    v_lshlrev_b32 v70, 16, v107
    v_and_b32 v79, 0xffff0000, v107
    v_mul_f32 v70, s20, v70
    v_mul_f32 v79, s20, v79
    v_mul_f32 v60, v40, v70
    v_fma_f32 v60, -v21, v79, v60
    v_mul_f32 v21, v21, v70
    v_fmac_f32 v21, v40, v79
    v_lshlrev_b32 v70, 16, v108
    v_and_b32 v79, 0xffff0000, v108
    v_mul_f32 v70, s20, v70
    v_mul_f32 v79, s20, v79
    v_mul_f32 v40, v56, v70
    v_fma_f32 v40, -v65, v79, v40
    v_mul_f32 v65, v65, v70
    v_fmac_f32 v65, v56, v79
    v_lshlrev_b32 v70, 16, v109
    v_and_b32 v79, 0xffff0000, v109
    v_mul_f32 v70, s20, v70
    v_mul_f32 v79, s20, v79
    v_mul_f32 v56, v80, v70
    v_fma_f32 v56, -v25, v79, v56
    v_mul_f32 v25, v25, v70
    v_fmac_f32 v25, v80, v79
    v_lshlrev_b32 v70, 16, v110
    v_and_b32 v79, 0xffff0000, v110
    v_mul_f32 v70, s20, v70
    v_mul_f32 v79, s20, v79
    v_mul_f32 v80, v32, v70
    v_fma_f32 v80, -v31, v79, v80
    v_mul_f32 v31, v31, v70
    v_fmac_f32 v31, v32, v79
    v_lshlrev_b32 v70, 16, v111
    v_and_b32 v79, 0xffff0000, v111
    v_mul_f32 v70, s20, v70
    v_mul_f32 v79, s20, v79
    v_mul_f32 v32, v46, v70
    v_fma_f32 v32, -v35, v79, v32
    v_mul_f32 v35, v35, v70
    v_fmac_f32 v35, v46, v79
    v_lshlrev_b32 v70, 16, v112
    v_and_b32 v79, 0xffff0000, v112
    v_mul_f32 v70, s20, v70
    v_mul_f32 v79, s20, v79
    v_mul_f32 v46, v50, v70
    v_fma_f32 v46, -v81, v79, v46
    v_mul_f32 v81, v81, v70
    v_fmac_f32 v81, v50, v79
    v_lshlrev_b32 v70, 16, v113
    v_and_b32 v79, 0xffff0000, v113
    v_mul_f32 v70, s20, v70
    v_mul_f32 v79, s20, v79
    v_mul_f32 v50, v83, v70
    v_fma_f32 v50, -v33, v79, v50
    v_mul_f32 v33, v33, v70
    v_fmac_f32 v33, v83, v79
    v_lshlrev_b32 v70, 16, v114
    v_and_b32 v79, 0xffff0000, v114
    v_mul_f32 v70, s20, v70
    v_mul_f32 v79, s20, v79
    v_mul_f32 v83, v78, v70
    v_fma_f32 v83, -v47, v79, v83
    v_mul_f32 v47, v47, v70
    v_fmac_f32 v47, v78, v79
    v_lshlrev_b32 v70, 16, v115
    v_and_b32 v79, 0xffff0000, v115
    v_mul_f32 v70, s20, v70
    v_mul_f32 v79, s20, v79
    v_mul_f32 v78, v76, v70
    v_fma_f32 v78, -v51, v79, v78
    v_mul_f32 v51, v51, v70
    v_fmac_f32 v51, v76, v79
    v_lshlrev_b32 v70, 16, v116
    v_and_b32 v79, 0xffff0000, v116
    v_mul_f32 v70, s20, v70
    v_mul_f32 v79, s20, v79
    v_mul_f32 v76, v18, v70
    v_fma_f32 v76, -v45, v79, v76
    v_mul_f32 v45, v45, v70
    v_fmac_f32 v45, v18, v79
    v_lshlrev_b32 v70, 16, v117
    v_and_b32 v79, 0xffff0000, v117
    v_mul_f32 v70, s20, v70
    v_mul_f32 v79, s20, v79
    v_mul_f32 v18, v72, v70
    v_fma_f32 v18, -v53, v79, v18
    v_mul_f32 v53, v53, v70
    v_fmac_f32 v53, v72, v79
    v_lshlrev_b32 v70, 16, v118
    v_and_b32 v79, 0xffff0000, v118
    v_mul_f32 v70, s20, v70
    v_mul_f32 v79, s20, v79
    v_mul_f32 v72, v20, v70
    v_fma_f32 v72, -v55, v79, v72
    v_mul_f32 v55, v55, v70
    v_fmac_f32 v55, v20, v79
    v_lshlrev_b32 v70, 16, v119
    v_and_b32 v79, 0xffff0000, v119
    v_mul_f32 v70, s20, v70
    v_mul_f32 v79, s20, v79
    v_mul_f32 v20, v22, v70
    v_fma_f32 v20, -v59, v79, v20
    v_mul_f32 v59, v59, v70
    v_fmac_f32 v59, v22, v79
    s_waitcnt vmcnt(0)
    ds_read_b64_tr_b16 a[64:65], v201 offset:0
    ds_read_b64_tr_b16 a[66:67], v201 offset:256
    ds_read_b64_tr_b16 a[68:69], v201 offset:1024
    ds_read_b64_tr_b16 a[70:71], v201 offset:1280
    ds_read_b64_tr_b16 a[72:73], v201 offset:2048
    ds_read_b64_tr_b16 a[74:75], v201 offset:2304
    ds_read_b64_tr_b16 a[76:77], v201 offset:3072
    ds_read_b64_tr_b16 a[78:79], v201 offset:3328
    s_waitcnt lgkmcnt(0)
    ds_read_b64_tr_b16 a[80:81], v201 offset:4096
    ds_read_b64_tr_b16 a[82:83], v201 offset:4352
    ds_read_b64_tr_b16 a[84:85], v201 offset:5120
    ds_read_b64_tr_b16 a[86:87], v201 offset:5376
    ds_read_b64_tr_b16 a[88:89], v201 offset:6144
    ds_read_b64_tr_b16 a[90:91], v201 offset:6400
    ds_read_b64_tr_b16 a[92:93], v201 offset:7168
    ds_read_b64_tr_b16 a[94:95], v201 offset:7424
    s_waitcnt lgkmcnt(0)
    ds_read_b64_tr_b16 a[96:97], v201 offset:8192
    ds_read_b64_tr_b16 a[98:99], v201 offset:8448
    ds_read_b64_tr_b16 a[100:101], v201 offset:9216
    ds_read_b64_tr_b16 a[102:103], v201 offset:9472
    ds_read_b64_tr_b16 a[104:105], v201 offset:10240
    ds_read_b64_tr_b16 a[106:107], v201 offset:10496
    ds_read_b64_tr_b16 a[108:109], v201 offset:11264
    ds_read_b64_tr_b16 a[110:111], v201 offset:11520
    s_waitcnt lgkmcnt(0)
    ds_read_b64_tr_b16 a[112:113], v201 offset:12288
    ds_read_b64_tr_b16 a[114:115], v201 offset:12544
    ds_read_b64_tr_b16 a[116:117], v201 offset:13312
    ds_read_b64_tr_b16 a[118:119], v201 offset:13568
    ds_read_b64_tr_b16 a[120:121], v201 offset:14336
    ds_read_b64_tr_b16 a[122:123], v201 offset:14592
    ds_read_b64_tr_b16 a[124:125], v201 offset:15360
    ds_read_b64_tr_b16 a[126:127], v201 offset:15616
    s_waitcnt lgkmcnt(0)
    s_add_u32 m0, s56, 0
    s_add_u32 s58, s57, 32768
    s_and_b32 s58, s58, 0xffff
    s_lshl_b32 s58, s58, 5
    buffer_load_dwordx4 v200, s[52:55], s58 offen lds
    s_add_u32 m0, s56, 1024
    s_add_u32 s58, s57, 33792
    s_and_b32 s58, s58, 0xffff
    s_lshl_b32 s58, s58, 5
    buffer_load_dwordx4 v200, s[52:55], s58 offen lds
    s_add_u32 m0, s56, 2048
    s_add_u32 s58, s57, 34816
    s_and_b32 s58, s58, 0xffff
    s_lshl_b32 s58, s58, 5
    buffer_load_dwordx4 v200, s[52:55], s58 offen lds
    s_add_u32 m0, s56, 3072
    s_add_u32 s58, s57, 35840
    s_and_b32 s58, s58, 0xffff
    s_lshl_b32 s58, s58, 5
    buffer_load_dwordx4 v200, s[52:55], s58 offen lds
    s_add_u32 m0, s56, 4096
    s_add_u32 s58, s57, 36864
    s_and_b32 s58, s58, 0xffff
    s_lshl_b32 s58, s58, 5
    buffer_load_dwordx4 v200, s[52:55], s58 offen lds
    s_add_u32 m0, s56, 5120
    s_add_u32 s58, s57, 37888
    s_and_b32 s58, s58, 0xffff
    s_lshl_b32 s58, s58, 5
    buffer_load_dwordx4 v200, s[52:55], s58 offen lds
    s_add_u32 m0, s56, 6144
    s_add_u32 s58, s57, 38912
    s_and_b32 s58, s58, 0xffff
    s_lshl_b32 s58, s58, 5
    buffer_load_dwordx4 v200, s[52:55], s58 offen lds
    s_add_u32 m0, s56, 7168
    s_add_u32 s58, s57, 39936
    s_and_b32 s58, s58, 0xffff
    s_lshl_b32 s58, s58, 5
    buffer_load_dwordx4 v200, s[52:55], s58 offen lds
    s_add_u32 m0, s56, 8192
    s_add_u32 s58, s57, 40960
    s_and_b32 s58, s58, 0xffff
    s_lshl_b32 s58, s58, 5
    buffer_load_dwordx4 v200, s[52:55], s58 offen lds
    s_add_u32 m0, s56, 9216
    s_add_u32 s58, s57, 41984
    s_and_b32 s58, s58, 0xffff
    s_lshl_b32 s58, s58, 5
    buffer_load_dwordx4 v200, s[52:55], s58 offen lds
    s_add_u32 m0, s56, 10240
    s_add_u32 s58, s57, 43008
    s_and_b32 s58, s58, 0xffff
    s_lshl_b32 s58, s58, 5
    buffer_load_dwordx4 v200, s[52:55], s58 offen lds
    s_add_u32 m0, s56, 11264
    s_add_u32 s58, s57, 44032
    s_and_b32 s58, s58, 0xffff
    s_lshl_b32 s58, s58, 5
    buffer_load_dwordx4 v200, s[52:55], s58 offen lds
    s_add_u32 m0, s56, 12288
    s_add_u32 s58, s57, 45056
    s_and_b32 s58, s58, 0xffff
    s_lshl_b32 s58, s58, 5
    buffer_load_dwordx4 v200, s[52:55], s58 offen lds
    s_add_u32 m0, s56, 13312
    s_add_u32 s58, s57, 46080
    s_and_b32 s58, s58, 0xffff
    s_lshl_b32 s58, s58, 5
    buffer_load_dwordx4 v200, s[52:55], s58 offen lds
    s_add_u32 m0, s56, 14336
    s_add_u32 s58, s57, 47104
    s_and_b32 s58, s58, 0xffff
    s_lshl_b32 s58, s58, 5
    buffer_load_dwordx4 v200, s[52:55], s58 offen lds
    s_add_u32 m0, s56, 15360
    s_add_u32 s58, s57, 48128
    s_and_b32 s58, s58, 0xffff
    s_lshl_b32 s58, s58, 5
    buffer_load_dwordx4 v200, s[52:55], s58 offen lds
    s_nop 1
    v_mov_b32_dpp v70, v82 quad_perm:[1,0,3,2] row_mask:0xf bank_mask:0xf
    v_fma_f32 v82, v82, v9, v70
    v_mov_b32_dpp v70, v17 quad_perm:[1,0,3,2] row_mask:0xf bank_mask:0xf
    v_fma_f32 v17, v17, v9, v70
    v_mov_b32_dpp v70, v16 quad_perm:[1,0,3,2] row_mask:0xf bank_mask:0xf
    v_fma_f32 v16, v16, v9, v70
    v_mov_b32_dpp v70, v49 quad_perm:[1,0,3,2] row_mask:0xf bank_mask:0xf
    v_fma_f32 v49, v49, v9, v70
    v_mov_b32_dpp v70, v74 quad_perm:[1,0,3,2] row_mask:0xf bank_mask:0xf
    v_fma_f32 v74, v74, v9, v70
    v_mov_b32_dpp v70, v19 quad_perm:[1,0,3,2] row_mask:0xf bank_mask:0xf
    v_fma_f32 v19, v19, v9, v70
    v_mov_b32_dpp v70, v48 quad_perm:[1,0,3,2] row_mask:0xf bank_mask:0xf
    v_fma_f32 v48, v48, v9, v70
    v_mov_b32_dpp v70, v23 quad_perm:[1,0,3,2] row_mask:0xf bank_mask:0xf
    v_fma_f32 v23, v23, v9, v70
    v_mov_b32_dpp v70, v68 quad_perm:[1,0,3,2] row_mask:0xf bank_mask:0xf
    v_fma_f32 v68, v68, v9, v70
    v_mov_b32_dpp v70, v27 quad_perm:[1,0,3,2] row_mask:0xf bank_mask:0xf
    v_fma_f32 v27, v27, v9, v70
    v_mov_b32_dpp v70, v62 quad_perm:[1,0,3,2] row_mask:0xf bank_mask:0xf
    v_fma_f32 v62, v62, v9, v70
    v_mov_b32_dpp v70, v39 quad_perm:[1,0,3,2] row_mask:0xf bank_mask:0xf
    v_fma_f32 v39, v39, v9, v70
    v_mov_b32_dpp v70, v66 quad_perm:[1,0,3,2] row_mask:0xf bank_mask:0xf
    v_fma_f32 v66, v66, v9, v70
    v_mov_b32_dpp v70, v29 quad_perm:[1,0,3,2] row_mask:0xf bank_mask:0xf
    v_fma_f32 v29, v29, v9, v70
    v_mov_b32_dpp v70, v54 quad_perm:[1,0,3,2] row_mask:0xf bank_mask:0xf
    v_fma_f32 v54, v54, v9, v70
    v_mov_b32_dpp v70, v37 quad_perm:[1,0,3,2] row_mask:0xf bank_mask:0xf
    v_fma_f32 v37, v37, v9, v70
    v_mov_b32_dpp v70, v44 quad_perm:[1,0,3,2] row_mask:0xf bank_mask:0xf
    v_fma_f32 v44, v44, v9, v70
    v_mov_b32_dpp v70, v43 quad_perm:[1,0,3,2] row_mask:0xf bank_mask:0xf
    v_fma_f32 v43, v43, v9, v70
    v_mov_b32_dpp v70, v52 quad_perm:[1,0,3,2] row_mask:0xf bank_mask:0xf
    v_fma_f32 v52, v52, v9, v70
    v_mov_b32_dpp v70, v71 quad_perm:[1,0,3,2] row_mask:0xf bank_mask:0xf
    v_fma_f32 v71, v71, v9, v70
    v_mov_b32_dpp v70, v58 quad_perm:[1,0,3,2] row_mask:0xf bank_mask:0xf
    v_fma_f32 v58, v58, v9, v70
    v_mov_b32_dpp v70, v61 quad_perm:[1,0,3,2] row_mask:0xf bank_mask:0xf
    v_fma_f32 v61, v61, v9, v70
    v_mov_b32_dpp v70, v38 quad_perm:[1,0,3,2] row_mask:0xf bank_mask:0xf
    v_fma_f32 v38, v38, v9, v70
    v_mov_b32_dpp v70, v69 quad_perm:[1,0,3,2] row_mask:0xf bank_mask:0xf
    v_fma_f32 v69, v69, v9, v70
    v_mov_b32_dpp v70, v28 quad_perm:[1,0,3,2] row_mask:0xf bank_mask:0xf
    v_fma_f32 v28, v28, v9, v70
    v_mov_b32_dpp v70, v41 quad_perm:[1,0,3,2] row_mask:0xf bank_mask:0xf
    v_fma_f32 v41, v41, v9, v70
    v_mov_b32_dpp v70, v36 quad_perm:[1,0,3,2] row_mask:0xf bank_mask:0xf
    v_fma_f32 v36, v36, v9, v70
    v_mov_b32_dpp v70, v57 quad_perm:[1,0,3,2] row_mask:0xf bank_mask:0xf
    v_fma_f32 v57, v57, v9, v70
    v_mov_b32_dpp v70, v64 quad_perm:[1,0,3,2] row_mask:0xf bank_mask:0xf
    v_fma_f32 v64, v64, v9, v70
    v_mov_b32_dpp v70, v63 quad_perm:[1,0,3,2] row_mask:0xf bank_mask:0xf
    v_fma_f32 v63, v63, v9, v70
    v_mov_b32_dpp v70, v24 quad_perm:[1,0,3,2] row_mask:0xf bank_mask:0xf
    v_fma_f32 v24, v24, v9, v70
    v_mov_b32_dpp v70, v67 quad_perm:[1,0,3,2] row_mask:0xf bank_mask:0xf
    v_fma_f32 v67, v67, v9, v70
    v_mov_b32_dpp v70, v30 quad_perm:[1,0,3,2] row_mask:0xf bank_mask:0xf
    v_fma_f32 v30, v30, v9, v70
    v_mov_b32_dpp v70, v75 quad_perm:[1,0,3,2] row_mask:0xf bank_mask:0xf
    v_fma_f32 v75, v75, v9, v70
    v_mov_b32_dpp v70, v34 quad_perm:[1,0,3,2] row_mask:0xf bank_mask:0xf
    v_fma_f32 v34, v34, v9, v70
    v_mov_b32_dpp v70, v77 quad_perm:[1,0,3,2] row_mask:0xf bank_mask:0xf
    v_fma_f32 v77, v77, v9, v70
    v_mov_b32_dpp v70, v42 quad_perm:[1,0,3,2] row_mask:0xf bank_mask:0xf
    v_fma_f32 v42, v42, v9, v70
    v_mov_b32_dpp v70, v73 quad_perm:[1,0,3,2] row_mask:0xf bank_mask:0xf
    v_fma_f32 v73, v73, v9, v70
    v_mov_b32_dpp v70, v60 quad_perm:[1,0,3,2] row_mask:0xf bank_mask:0xf
    v_fma_f32 v60, v60, v9, v70
    v_mov_b32_dpp v70, v21 quad_perm:[1,0,3,2] row_mask:0xf bank_mask:0xf
    v_fma_f32 v21, v21, v9, v70
    v_mov_b32_dpp v70, v40 quad_perm:[1,0,3,2] row_mask:0xf bank_mask:0xf
    v_fma_f32 v40, v40, v9, v70
    v_mov_b32_dpp v70, v65 quad_perm:[1,0,3,2] row_mask:0xf bank_mask:0xf
    v_fma_f32 v65, v65, v9, v70
    v_mov_b32_dpp v70, v56 quad_perm:[1,0,3,2] row_mask:0xf bank_mask:0xf
    v_fma_f32 v56, v56, v9, v70
    v_mov_b32_dpp v70, v25 quad_perm:[1,0,3,2] row_mask:0xf bank_mask:0xf
    v_fma_f32 v25, v25, v9, v70
    v_mov_b32_dpp v70, v80 quad_perm:[1,0,3,2] row_mask:0xf bank_mask:0xf
    v_fma_f32 v80, v80, v9, v70
    v_mov_b32_dpp v70, v31 quad_perm:[1,0,3,2] row_mask:0xf bank_mask:0xf
    v_fma_f32 v31, v31, v9, v70
    v_mov_b32_dpp v70, v32 quad_perm:[1,0,3,2] row_mask:0xf bank_mask:0xf
    v_fma_f32 v32, v32, v9, v70
    v_mov_b32_dpp v70, v35 quad_perm:[1,0,3,2] row_mask:0xf bank_mask:0xf
    v_fma_f32 v35, v35, v9, v70
    v_mov_b32_dpp v70, v46 quad_perm:[1,0,3,2] row_mask:0xf bank_mask:0xf
    v_fma_f32 v46, v46, v9, v70
    v_mov_b32_dpp v70, v81 quad_perm:[1,0,3,2] row_mask:0xf bank_mask:0xf
    v_fma_f32 v81, v81, v9, v70
    v_mov_b32_dpp v70, v50 quad_perm:[1,0,3,2] row_mask:0xf bank_mask:0xf
    v_fma_f32 v50, v50, v9, v70
    v_mov_b32_dpp v70, v33 quad_perm:[1,0,3,2] row_mask:0xf bank_mask:0xf
    v_fma_f32 v33, v33, v9, v70
    v_mov_b32_dpp v70, v83 quad_perm:[1,0,3,2] row_mask:0xf bank_mask:0xf
    v_fma_f32 v83, v83, v9, v70
    v_mov_b32_dpp v70, v47 quad_perm:[1,0,3,2] row_mask:0xf bank_mask:0xf
    v_fma_f32 v47, v47, v9, v70
    v_mov_b32_dpp v70, v78 quad_perm:[1,0,3,2] row_mask:0xf bank_mask:0xf
    v_fma_f32 v78, v78, v9, v70
    v_mov_b32_dpp v70, v51 quad_perm:[1,0,3,2] row_mask:0xf bank_mask:0xf
    v_fma_f32 v51, v51, v9, v70
    v_mov_b32_dpp v70, v76 quad_perm:[1,0,3,2] row_mask:0xf bank_mask:0xf
    v_fma_f32 v76, v76, v9, v70
    v_mov_b32_dpp v70, v45 quad_perm:[1,0,3,2] row_mask:0xf bank_mask:0xf
    v_fma_f32 v45, v45, v9, v70
    v_mov_b32_dpp v70, v18 quad_perm:[1,0,3,2] row_mask:0xf bank_mask:0xf
    v_fma_f32 v18, v18, v9, v70
    v_mov_b32_dpp v70, v53 quad_perm:[1,0,3,2] row_mask:0xf bank_mask:0xf
    v_fma_f32 v53, v53, v9, v70
    v_mov_b32_dpp v70, v72 quad_perm:[1,0,3,2] row_mask:0xf bank_mask:0xf
    v_fma_f32 v72, v72, v9, v70
    v_mov_b32_dpp v70, v55 quad_perm:[1,0,3,2] row_mask:0xf bank_mask:0xf
    v_fma_f32 v55, v55, v9, v70
    v_mov_b32_dpp v70, v20 quad_perm:[1,0,3,2] row_mask:0xf bank_mask:0xf
    v_fma_f32 v20, v20, v9, v70
    v_mov_b32_dpp v70, v59 quad_perm:[1,0,3,2] row_mask:0xf bank_mask:0xf
    v_fma_f32 v59, v59, v9, v70
    v_mul_f32 v70, 0x3c800000, v10
    v_cos_f32 v79, v70
    v_sin_f32 v22, v70
    s_nop 0
    v_mul_f32 v26, v16, v79
    v_fma_f32 v26, -v49, v22, v26
    v_mul_f32 v49, v49, v79
    v_fmac_f32 v49, v16, v22
    v_mul_f32 v70, 0x3d000000, v10
    v_cos_f32 v79, v70
    v_sin_f32 v22, v70
    s_nop 0
    v_mul_f32 v16, v74, v79
    v_fma_f32 v16, -v19, v22, v16
    v_mul_f32 v19, v19, v79
    v_fmac_f32 v19, v74, v22
    v_mul_f32 v70, 0x3d400000, v10
    v_cos_f32 v79, v70
    v_sin_f32 v22, v70
    s_nop 0
    v_mul_f32 v74, v48, v79
    v_fma_f32 v74, -v23, v22, v74
    v_mul_f32 v23, v23, v79
    v_fmac_f32 v23, v48, v22
    v_mul_f32 v70, 0x3d800000, v10
    v_cos_f32 v79, v70
    v_sin_f32 v22, v70
    s_nop 0
    v_mul_f32 v48, v68, v79
    v_fma_f32 v48, -v27, v22, v48
    v_mul_f32 v27, v27, v79
    v_fmac_f32 v27, v68, v22
    v_mul_f32 v70, 0x3da00000, v10
    v_cos_f32 v79, v70
    v_sin_f32 v22, v70
    s_nop 0
    v_mul_f32 v68, v62, v79
    v_fma_f32 v68, -v39, v22, v68
    v_mul_f32 v39, v39, v79
    v_fmac_f32 v39, v62, v22
    v_mul_f32 v70, 0x3dc00000, v10
    v_cos_f32 v79, v70
    v_sin_f32 v22, v70
    s_nop 0
    v_mul_f32 v62, v66, v79
    v_fma_f32 v62, -v29, v22, v62
    v_mul_f32 v29, v29, v79
    v_fmac_f32 v29, v66, v22
    v_mul_f32 v70, 0x3de00000, v10
    v_cos_f32 v79, v70
    v_sin_f32 v22, v70
    s_nop 0
    v_mul_f32 v66, v54, v79
    v_fma_f32 v66, -v37, v22, v66
    v_mul_f32 v37, v37, v79
    v_fmac_f32 v37, v54, v22
    v_mul_f32 v70, 0x3e000000, v10
    v_cos_f32 v79, v70
    v_sin_f32 v22, v70
    s_nop 0
    v_mul_f32 v54, v44, v79
    v_fma_f32 v54, -v43, v22, v54
    v_mul_f32 v43, v43, v79
    v_fmac_f32 v43, v44, v22
    v_mul_f32 v70, 0x3e100000, v10
    v_cos_f32 v79, v70
    v_sin_f32 v22, v70
    s_nop 0
    v_mul_f32 v44, v52, v79
    v_fma_f32 v44, -v71, v22, v44
    v_mul_f32 v71, v71, v79
    v_fmac_f32 v71, v52, v22
    v_mul_f32 v70, 0x3e200000, v10
    v_cos_f32 v79, v70
    v_sin_f32 v22, v70
    s_nop 0
    v_mul_f32 v52, v58, v79
    v_fma_f32 v52, -v61, v22, v52
    v_mul_f32 v61, v61, v79
    v_fmac_f32 v61, v58, v22
    v_mul_f32 v70, 0x3e300000, v10
    v_cos_f32 v79, v70
    v_sin_f32 v22, v70
    s_nop 0
    v_mul_f32 v58, v38, v79
    v_fma_f32 v58, -v69, v22, v58
    v_mul_f32 v69, v69, v79
    v_fmac_f32 v69, v38, v22
    v_mul_f32 v70, 0x3e400000, v10
    v_cos_f32 v79, v70
    v_sin_f32 v22, v70
    s_nop 0
    v_mul_f32 v38, v28, v79
    v_fma_f32 v38, -v41, v22, v38
    v_mul_f32 v41, v41, v79
    v_fmac_f32 v41, v28, v22
    v_mul_f32 v70, 0x3e500000, v10
    v_cos_f32 v79, v70
    v_sin_f32 v22, v70
    s_nop 0
    v_mul_f32 v28, v36, v79
    v_fma_f32 v28, -v57, v22, v28
    v_mul_f32 v57, v57, v79
    v_fmac_f32 v57, v36, v22
    v_mul_f32 v70, 0x3e600000, v10
    v_cos_f32 v79, v70
    v_sin_f32 v22, v70
    s_nop 0
    v_mul_f32 v36, v64, v79
    v_fma_f32 v36, -v63, v22, v36
    v_mul_f32 v63, v63, v79
    v_fmac_f32 v63, v64, v22
    v_mul_f32 v70, 0x3e700000, v10
    v_cos_f32 v79, v70
    v_sin_f32 v22, v70
    s_nop 0
    v_mul_f32 v64, v24, v79
    v_fma_f32 v64, -v67, v22, v64
    v_mul_f32 v67, v67, v79
    v_fmac_f32 v67, v24, v22
    v_mul_f32 v70, 0x3e800000, v10
    v_cos_f32 v79, v70
    v_sin_f32 v22, v70
    s_nop 0
    v_mul_f32 v24, v30, v79
    v_fma_f32 v24, -v75, v22, v24
    v_mul_f32 v75, v75, v79
    v_fmac_f32 v75, v30, v22
    v_mul_f32 v70, 0x3e880000, v10
    v_cos_f32 v79, v70
    v_sin_f32 v22, v70
    s_nop 0
    v_mul_f32 v30, v34, v79
    v_fma_f32 v30, -v77, v22, v30
    v_mul_f32 v77, v77, v79
    v_fmac_f32 v77, v34, v22
    v_mul_f32 v70, 0x3e900000, v10
    v_cos_f32 v79, v70
    v_sin_f32 v22, v70
    s_nop 0
    v_mul_f32 v34, v42, v79
    v_fma_f32 v34, -v73, v22, v34
    v_mul_f32 v73, v73, v79
    v_fmac_f32 v73, v42, v22
    v_mul_f32 v70, 0x3e980000, v10
    v_cos_f32 v79, v70
    v_sin_f32 v22, v70
    s_nop 0
    v_mul_f32 v42, v60, v79
    v_fma_f32 v42, -v21, v22, v42
    v_mul_f32 v21, v21, v79
    v_fmac_f32 v21, v60, v22
    v_mul_f32 v70, 0x3ea00000, v10
    v_cos_f32 v79, v70
    v_sin_f32 v22, v70
    s_nop 0
    v_mul_f32 v60, v40, v79
    v_fma_f32 v60, -v65, v22, v60
    v_mul_f32 v65, v65, v79
    v_fmac_f32 v65, v40, v22
    v_mul_f32 v70, 0x3ea80000, v10
    v_cos_f32 v79, v70
    v_sin_f32 v22, v70
    s_nop 0
    v_mul_f32 v40, v56, v79
    v_fma_f32 v40, -v25, v22, v40
    v_mul_f32 v25, v25, v79
    v_fmac_f32 v25, v56, v22
    v_mul_f32 v70, 0x3eb00000, v10
    v_cos_f32 v79, v70
    v_sin_f32 v22, v70
    s_nop 0
    v_mul_f32 v56, v80, v79
    v_fma_f32 v56, -v31, v22, v56
    v_mul_f32 v31, v31, v79
    v_fmac_f32 v31, v80, v22
    v_mul_f32 v70, 0x3eb80000, v10
    v_cos_f32 v79, v70
    v_sin_f32 v22, v70
    s_nop 0
    v_mul_f32 v80, v32, v79
    v_fma_f32 v80, -v35, v22, v80
    v_mul_f32 v35, v35, v79
    v_fmac_f32 v35, v32, v22
    v_mul_f32 v70, 0x3ec00000, v10
    v_cos_f32 v79, v70
    v_sin_f32 v22, v70
    s_nop 0
    v_mul_f32 v32, v46, v79
    v_fma_f32 v32, -v81, v22, v32
    v_mul_f32 v81, v81, v79
    v_fmac_f32 v81, v46, v22
    v_mul_f32 v70, 0x3ec80000, v10
    v_cos_f32 v79, v70
    v_sin_f32 v22, v70
    s_nop 0
    v_mul_f32 v46, v50, v79
    v_fma_f32 v46, -v33, v22, v46
    v_mul_f32 v33, v33, v79
    v_fmac_f32 v33, v50, v22
    v_mul_f32 v70, 0x3ed00000, v10
    v_cos_f32 v79, v70
    v_sin_f32 v22, v70
    s_nop 0
    v_mul_f32 v50, v83, v79
    v_fma_f32 v50, -v47, v22, v50
    v_mul_f32 v47, v47, v79
    v_fmac_f32 v47, v83, v22
    v_mul_f32 v70, 0x3ed80000, v10
    v_cos_f32 v79, v70
    v_sin_f32 v22, v70
    s_nop 0
    v_mul_f32 v83, v78, v79
    v_fma_f32 v83, -v51, v22, v83
    v_mul_f32 v51, v51, v79
    v_fmac_f32 v51, v78, v22
    v_mul_f32 v70, 0x3ee00000, v10
    v_cos_f32 v79, v70
    v_sin_f32 v22, v70
    s_nop 0
    v_mul_f32 v78, v76, v79
    v_fma_f32 v78, -v45, v22, v78
    v_mul_f32 v45, v45, v79
    v_fmac_f32 v45, v76, v22
    v_mul_f32 v70, 0x3ee80000, v10
    v_cos_f32 v79, v70
    v_sin_f32 v22, v70
    s_nop 0
    v_mul_f32 v76, v18, v79
    v_fma_f32 v76, -v53, v22, v76
    v_mul_f32 v53, v53, v79
    v_fmac_f32 v53, v18, v22
    v_mul_f32 v70, 0x3ef00000, v10
    v_cos_f32 v79, v70
    v_sin_f32 v22, v70
    s_nop 0
    v_mul_f32 v18, v72, v79
    v_fma_f32 v18, -v55, v22, v18
    v_mul_f32 v55, v55, v79
    v_fmac_f32 v55, v72, v22
    v_mul_f32 v70, 0x3ef80000, v10
    v_cos_f32 v79, v70
    v_sin_f32 v22, v70
    s_nop 0
    v_mul_f32 v72, v20, v79
    v_fma_f32 v72, -v59, v22, v72
    v_mul_f32 v59, v59, v79
    v_fmac_f32 v59, v20, v22
    v_sub_f32 v70, v82, v24
    v_sub_f32 v79, v17, v75
    v_add_f32 v82, v82, v24
    v_add_f32 v17, v17, v75
    v_sub_f32 v24, v26, v30
    v_sub_f32 v75, v49, v77
    v_add_f32 v26, v26, v30
    v_add_f32 v49, v49, v77
    v_mul_f32 v30, 0x3f7b14be, v24
    v_mul_f32 v77, 0x3e47c5c2, v24
    v_fmac_f32 v30, 0xbe47c5c2, v75
    v_fmac_f32 v77, 0x3f7b14be, v75
    v_sub_f32 v24, v16, v34
    v_sub_f32 v75, v19, v73
    v_add_f32 v16, v16, v34
    v_add_f32 v19, v19, v73
    v_mul_f32 v34, 0x3f6c835e, v24
    v_mul_f32 v73, 0x3ec3ef15, v24
    v_fmac_f32 v34, 0xbec3ef15, v75
    v_fmac_f32 v73, 0x3f6c835e, v75
    v_sub_f32 v24, v74, v42
    v_sub_f32 v75, v23, v21
    v_add_f32 v74, v74, v42
    v_add_f32 v23, v23, v21
    v_mul_f32 v42, 0x3f54db31, v24
    v_mul_f32 v21, 0x3f0e39da, v24
    v_fmac_f32 v42, 0xbf0e39da, v75
    v_fmac_f32 v21, 0x3f54db31, v75
    v_sub_f32 v24, v48, v60
    v_sub_f32 v75, v27, v65
    v_add_f32 v48, v48, v60
    v_add_f32 v27, v27, v65
    v_mul_f32 v60, 0x3f3504f3, v24
    v_mul_f32 v65, 0x3f3504f3, v24
    v_fmac_f32 v60, 0xbf3504f3, v75
    v_fmac_f32 v65, 0x3f3504f3, v75
    v_sub_f32 v24, v68, v40
    v_sub_f32 v75, v39, v25
    v_add_f32 v68, v68, v40
    v_add_f32 v39, v39, v25
    v_mul_f32 v40, 0x3f0e39da, v24
    v_mul_f32 v25, 0x3f54db31, v24
    v_fmac_f32 v40, 0xbf54db31, v75
    v_fmac_f32 v25, 0x3f0e39da, v75
    v_sub_f32 v24, v62, v56
    v_sub_f32 v75, v29, v31
    v_add_f32 v62, v62, v56
    v_add_f32 v29, v29, v31
    v_mul_f32 v56, 0x3ec3ef15, v24
    v_mul_f32 v31, 0x3f6c835e, v24
    v_fmac_f32 v56, 0xbf6c835e, v75
    v_fmac_f32 v31, 0x3ec3ef15, v75
    v_sub_f32 v24, v66, v80
    v_sub_f32 v75, v37, v35
    v_add_f32 v66, v66, v80
    v_add_f32 v37, v37, v35
    v_mul_f32 v80, 0x3e47c5c2, v24
    v_mul_f32 v35, 0x3f7b14be, v24
    v_fmac_f32 v80, 0xbf7b14be, v75
    v_fmac_f32 v35, 0x3e47c5c2, v75
    v_sub_f32 v24, v81, v43
    v_sub_f32 v75, v54, v32
    v_add_f32 v54, v54, v32
    v_add_f32 v43, v43, v81
    v_sub_f32 v32, v44, v46
    v_sub_f32 v81, v71, v33
    v_add_f32 v44, v44, v46
    v_add_f32 v71, v71, v33
    v_mul_f32 v46, 0xbe47c5c2, v32
    v_mul_f32 v33, 0x3f7b14be, v32
    v_fmac_f32 v46, 0xbf7b14be, v81
    v_fmac_f32 v33, 0xbe47c5c2, v81
    v_sub_f32 v32, v52, v50
    v_sub_f32 v81, v61, v47
    v_add_f32 v52, v52, v50
    v_add_f32 v61, v61, v47
    v_mul_f32 v50, 0xbec3ef15, v32
    v_mul_f32 v47, 0x3f6c835e, v32
    v_fmac_f32 v50, 0xbf6c835e, v81
    v_fmac_f32 v47, 0xbec3ef15, v81
    v_sub_f32 v32, v58, v83
    v_sub_f32 v81, v69, v51
    v_add_f32 v58, v58, v83
    v_add_f32 v69, v69, v51
    v_mul_f32 v83, 0xbf0e39da, v32
    v_mul_f32 v51, 0x3f54db31, v32
    v_fmac_f32 v83, 0xbf54db31, v81
    v_fmac_f32 v51, 0xbf0e39da, v81
    v_sub_f32 v32, v38, v78
    v_sub_f32 v81, v41, v45
    v_add_f32 v38, v38, v78
    v_add_f32 v41, v41, v45
    v_mul_f32 v78, 0xbf3504f3, v32
    v_mul_f32 v45, 0x3f3504f3, v32
    v_fmac_f32 v78, 0xbf3504f3, v81
    v_fmac_f32 v45, 0xbf3504f3, v81
    v_sub_f32 v32, v28, v76
    v_sub_f32 v81, v57, v53
    v_add_f32 v28, v28, v76
    v_add_f32 v57, v57, v53
    v_mul_f32 v76, 0xbf54db31, v32
    v_mul_f32 v53, 0x3f0e39da, v32
    v_fmac_f32 v76, 0xbf0e39da, v81
    v_fmac_f32 v53, 0xbf54db31, v81
    v_sub_f32 v32, v36, v18
    v_sub_f32 v81, v63, v55
    v_add_f32 v36, v36, v18
    v_add_f32 v63, v63, v55
    v_mul_f32 v18, 0xbf6c835e, v32
    v_mul_f32 v55, 0x3ec3ef15, v32
    v_fmac_f32 v18, 0xbec3ef15, v81
    v_fmac_f32 v55, 0xbf6c835e, v81
    v_sub_f32 v32, v64, v72
    v_sub_f32 v81, v67, v59
    v_add_f32 v64, v64, v72
    v_add_f32 v67, v67, v59
    v_mul_f32 v72, 0xbf7b14be, v32
    v_mul_f32 v59, 0x3e47c5c2, v32
    v_fmac_f32 v72, 0xbe47c5c2, v81
    v_fmac_f32 v59, 0xbf7b14be, v81
    v_sub_f32 v32, v82, v54
    v_sub_f32 v81, v17, v43
    v_add_f32 v82, v82, v54
    v_add_f32 v17, v17, v43
    v_sub_f32 v54, v26, v44
    v_sub_f32 v43, v49, v71
    v_add_f32 v26, v26, v44
    v_add_f32 v49, v49, v71
    v_mul_f32 v44, 0x3f6c835e, v54
    v_mul_f32 v71, 0x3ec3ef15, v54
    v_fmac_f32 v44, 0xbec3ef15, v43
    v_fmac_f32 v71, 0x3f6c835e, v43
    v_sub_f32 v54, v16, v52
    v_sub_f32 v43, v19, v61
    v_add_f32 v16, v16, v52
    v_add_f32 v19, v19, v61
    v_mul_f32 v52, 0x3f3504f3, v54
    v_mul_f32 v61, 0x3f3504f3, v54
    v_fmac_f32 v52, 0xbf3504f3, v43
    v_fmac_f32 v61, 0x3f3504f3, v43
    v_sub_f32 v54, v74, v58
    v_sub_f32 v43, v23, v69
    v_add_f32 v74, v74, v58
    v_add_f32 v23, v23, v69
    v_mul_f32 v58, 0x3ec3ef15, v54
    v_mul_f32 v69, 0x3f6c835e, v54
    v_fmac_f32 v58, 0xbf6c835e, v43
    v_fmac_f32 v69, 0x3ec3ef15, v43
    v_sub_f32 v54, v41, v27
    v_sub_f32 v43, v48, v38
    v_add_f32 v48, v48, v38
    v_add_f32 v27, v27, v41
    v_sub_f32 v38, v68, v28
    v_sub_f32 v41, v39, v57
    v_add_f32 v68, v68, v28
    v_add_f32 v39, v39, v57
    v_mul_f32 v28, 0xbec3ef15, v38
    v_mul_f32 v57, 0x3f6c835e, v38
    v_fmac_f32 v28, 0xbf6c835e, v41
    v_fmac_f32 v57, 0xbec3ef15, v41
    v_sub_f32 v38, v62, v36
    v_sub_f32 v41, v29, v63
    v_add_f32 v62, v62, v36
    v_add_f32 v29, v29, v63
    v_mul_f32 v36, 0xbf3504f3, v38
    v_mul_f32 v63, 0x3f3504f3, v38
    v_fmac_f32 v36, 0xbf3504f3, v41
    v_fmac_f32 v63, 0xbf3504f3, v41
    v_sub_f32 v38, v66, v64
    v_sub_f32 v41, v37, v67
    v_add_f32 v66, v66, v64
    v_add_f32 v37, v37, v67
    v_mul_f32 v64, 0xbf6c835e, v38
    v_mul_f32 v67, 0x3ec3ef15, v38
    v_fmac_f32 v64, 0xbec3ef15, v41
    v_fmac_f32 v67, 0xbf6c835e, v41
    v_sub_f32 v38, v70, v24
    v_sub_f32 v41, v79, v75
    v_add_f32 v70, v70, v24
    v_add_f32 v79, v79, v75
    v_sub_f32 v24, v30, v46
    v_sub_f32 v75, v77, v33
    v_add_f32 v30, v30, v46
    v_add_f32 v77, v77, v33
    v_mul_f32 v46, 0x3f6c835e, v24
    v_mul_f32 v33, 0x3ec3ef15, v24
    v_fmac_f32 v46, 0xbec3ef15, v75
    v_fmac_f32 v33, 0x3f6c835e, v75
    v_sub_f32 v24, v34, v50
    v_sub_f32 v75, v73, v47
    v_add_f32 v34, v34, v50
    v_add_f32 v73, v73, v47
    v_mul_f32 v50, 0x3f3504f3, v24
    v_mul_f32 v47, 0x3f3504f3, v24
    v_fmac_f32 v50, 0xbf3504f3, v75
    v_fmac_f32 v47, 0x3f3504f3, v75
    v_sub_f32 v24, v42, v83
    v_sub_f32 v75, v21, v51
    v_add_f32 v42, v42, v83
    v_add_f32 v21, v21, v51
    v_mul_f32 v83, 0x3ec3ef15, v24
    v_mul_f32 v51, 0x3f6c835e, v24
    v_fmac_f32 v83, 0xbf6c835e, v75
    v_fmac_f32 v51, 0x3ec3ef15, v75
    v_sub_f32 v24, v45, v65
    v_sub_f32 v75, v60, v78
    v_add_f32 v60, v60, v78
    v_add_f32 v65, v65, v45
    v_sub_f32 v78, v40, v76
    v_sub_f32 v45, v25, v53
    v_add_f32 v40, v40, v76
    v_add_f32 v25, v25, v53
    v_mul_f32 v76, 0xbec3ef15, v78
    v_mul_f32 v53, 0x3f6c835e, v78
    v_fmac_f32 v76, 0xbf6c835e, v45
    v_fmac_f32 v53, 0xbec3ef15, v45
    v_sub_f32 v78, v56, v18
    v_sub_f32 v45, v31, v55
    v_add_f32 v56, v56, v18
    v_add_f32 v31, v31, v55
    v_mul_f32 v18, 0xbf3504f3, v78
    v_mul_f32 v55, 0x3f3504f3, v78
    v_fmac_f32 v18, 0xbf3504f3, v45
    v_fmac_f32 v55, 0xbf3504f3, v45
    v_sub_f32 v78, v80, v72
    v_sub_f32 v45, v35, v59
    v_add_f32 v80, v80, v72
    v_add_f32 v35, v35, v59
    v_mul_f32 v72, 0xbf6c835e, v78
    v_mul_f32 v59, 0x3ec3ef15, v78
    v_fmac_f32 v72, 0xbec3ef15, v45
    v_fmac_f32 v59, 0xbf6c835e, v45
    v_sub_f32 v78, v82, v48
    v_sub_f32 v45, v17, v27
    v_add_f32 v82, v82, v48
    v_add_f32 v17, v17, v27
    v_sub_f32 v48, v26, v68
    v_sub_f32 v27, v49, v39
    v_add_f32 v26, v26, v68
    v_add_f32 v49, v49, v39
    v_mul_f32 v68, 0x3f3504f3, v48
    v_mul_f32 v39, 0x3f3504f3, v48
    v_fmac_f32 v68, 0xbf3504f3, v27
    v_fmac_f32 v39, 0x3f3504f3, v27
    v_sub_f32 v48, v29, v19
    v_sub_f32 v27, v16, v62
    v_add_f32 v16, v16, v62
    v_add_f32 v19, v19, v29
    v_sub_f32 v62, v74, v66
    v_sub_f32 v29, v23, v37
    v_add_f32 v74, v74, v66
    v_add_f32 v23, v23, v37
    v_mul_f32 v66, 0xbf3504f3, v62
    v_mul_f32 v37, 0x3f3504f3, v62
    v_fmac_f32 v66, 0xbf3504f3, v29
    v_fmac_f32 v37, 0xbf3504f3, v29
    v_sub_f32 v62, v32, v54
    v_sub_f32 v29, v81, v43
    v_add_f32 v32, v32, v54
    v_add_f32 v81, v81, v43
    v_sub_f32 v54, v44, v28
    v_sub_f32 v43, v71, v57
    v_add_f32 v44, v44, v28
    v_add_f32 v71, v71, v57
    v_mul_f32 v28, 0x3f3504f3, v54
    v_mul_f32 v57, 0x3f3504f3, v54
    v_fmac_f32 v28, 0xbf3504f3, v43
    v_fmac_f32 v57, 0x3f3504f3, v43
    v_sub_f32 v54, v63, v61
    v_sub_f32 v43, v52, v36
    v_add_f32 v52, v52, v36
    v_add_f32 v61, v61, v63
    v_sub_f32 v36, v58, v64
    v_sub_f32 v63, v69, v67
    v_add_f32 v58, v58, v64
    v_add_f32 v69, v69, v67
    v_mul_f32 v64, 0xbf3504f3, v36
    v_mul_f32 v67, 0x3f3504f3, v36
    v_fmac_f32 v64, 0xbf3504f3, v63
    v_fmac_f32 v67, 0xbf3504f3, v63
    v_sub_f32 v36, v70, v60
    v_sub_f32 v63, v79, v65
    v_add_f32 v70, v70, v60
    v_add_f32 v79, v79, v65
    v_sub_f32 v60, v30, v40
    v_sub_f32 v65, v77, v25
    v_add_f32 v30, v30, v40
    v_add_f32 v77, v77, v25
    v_mul_f32 v40, 0x3f3504f3, v60
    v_mul_f32 v25, 0x3f3504f3, v60
    v_fmac_f32 v40, 0xbf3504f3, v65
    v_fmac_f32 v25, 0x3f3504f3, v65
    v_sub_f32 v60, v31, v73
    v_sub_f32 v65, v34, v56
    v_add_f32 v34, v34, v56
    v_add_f32 v73, v73, v31
    v_sub_f32 v56, v42, v80
    v_sub_f32 v31, v21, v35
    v_add_f32 v42, v42, v80
    v_add_f32 v21, v21, v35
    v_mul_f32 v80, 0xbf3504f3, v56
    v_mul_f32 v35, 0x3f3504f3, v56
    v_fmac_f32 v80, 0xbf3504f3, v31
    v_fmac_f32 v35, 0xbf3504f3, v31
    v_sub_f32 v56, v38, v24
    v_sub_f32 v31, v41, v75
    v_add_f32 v38, v38, v24
    v_add_f32 v41, v41, v75
    v_sub_f32 v24, v46, v76
    v_sub_f32 v75, v33, v53
    v_add_f32 v46, v46, v76
    v_add_f32 v33, v33, v53
    v_mul_f32 v76, 0x3f3504f3, v24
    v_mul_f32 v53, 0x3f3504f3, v24
    v_fmac_f32 v76, 0xbf3504f3, v75
    v_fmac_f32 v53, 0x3f3504f3, v75
    v_sub_f32 v24, v55, v47
    v_sub_f32 v75, v50, v18
    v_add_f32 v50, v50, v18
    v_add_f32 v47, v47, v55
    v_sub_f32 v18, v83, v72
    v_sub_f32 v55, v51, v59
    v_add_f32 v83, v83, v72
    v_add_f32 v51, v51, v59
    v_mul_f32 v72, 0xbf3504f3, v18
    v_mul_f32 v59, 0x3f3504f3, v18
    v_fmac_f32 v72, 0xbf3504f3, v55
    v_fmac_f32 v59, 0xbf3504f3, v55
    v_sub_f32 v18, v82, v16
    v_sub_f32 v55, v17, v19
    v_add_f32 v82, v82, v16
    v_add_f32 v17, v17, v19
    v_sub_f32 v16, v23, v49
    v_sub_f32 v19, v26, v74
    v_add_f32 v26, v26, v74
    v_add_f32 v49, v49, v23
    v_sub_f32 v74, v78, v48
    v_sub_f32 v23, v45, v27
    v_add_f32 v78, v78, v48
    v_add_f32 v45, v45, v27
    v_sub_f32 v48, v37, v39
    v_sub_f32 v27, v68, v66
    v_add_f32 v68, v68, v66
    v_add_f32 v39, v39, v37
    v_sub_f32 v66, v32, v52
    v_sub_f32 v37, v81, v61
    v_add_f32 v32, v32, v52
    v_add_f32 v81, v81, v61
    v_sub_f32 v52, v69, v71
    v_sub_f32 v61, v44, v58
    v_add_f32 v44, v44, v58
    v_add_f32 v71, v71, v69
    v_sub_f32 v58, v62, v54
    v_sub_f32 v69, v29, v43
    v_add_f32 v62, v62, v54
    v_add_f32 v29, v29, v43
    v_sub_f32 v54, v67, v57
    v_sub_f32 v43, v28, v64
    v_add_f32 v28, v28, v64
    v_add_f32 v57, v57, v67
    v_sub_f32 v64, v70, v34
    v_sub_f32 v67, v79, v73
    v_add_f32 v70, v70, v34
    v_add_f32 v79, v79, v73
    v_sub_f32 v34, v21, v77
    v_sub_f32 v73, v30, v42
    v_add_f32 v30, v30, v42
    v_add_f32 v77, v77, v21
    v_sub_f32 v42, v36, v60
    v_sub_f32 v21, v63, v65
    v_add_f32 v36, v36, v60
    v_add_f32 v63, v63, v65
    v_sub_f32 v60, v35, v25
    v_sub_f32 v65, v40, v80
    v_add_f32 v40, v40, v80
    v_add_f32 v25, v25, v35
    v_sub_f32 v80, v38, v50
    v_sub_f32 v35, v41, v47
    v_add_f32 v38, v38, v50
    v_add_f32 v41, v41, v47
    v_sub_f32 v50, v51, v33
    v_sub_f32 v47, v46, v83
    v_add_f32 v46, v46, v83
    v_add_f32 v33, v33, v51
    v_sub_f32 v83, v56, v24
    v_sub_f32 v51, v31, v75
    v_add_f32 v56, v56, v24
    v_add_f32 v31, v31, v75
    v_sub_f32 v24, v59, v53
    v_sub_f32 v75, v76, v72
    v_add_f32 v76, v76, v72
    v_add_f32 v53, v53, v59
    v_sub_f32 v72, v82, v26
    v_sub_f32 v59, v17, v49
    v_add_f32 v82, v82, v26
    v_add_f32 v17, v17, v49
    v_sub_f32 v26, v18, v16
    v_sub_f32 v49, v55, v19
    v_add_f32 v18, v18, v16
    v_add_f32 v55, v55, v19
    v_sub_f32 v16, v78, v68
    v_sub_f32 v19, v45, v39
    v_add_f32 v78, v78, v68
    v_add_f32 v45, v45, v39
    v_sub_f32 v68, v74, v48
    v_sub_f32 v39, v23, v27
    v_add_f32 v74, v74, v48
    v_add_f32 v23, v23, v27
    v_sub_f32 v48, v32, v44
    v_sub_f32 v27, v81, v71
    v_add_f32 v32, v32, v44
    v_add_f32 v81, v81, v71
    v_sub_f32 v44, v66, v52
    v_sub_f32 v71, v37, v61
    v_add_f32 v66, v66, v52
    v_add_f32 v37, v37, v61
    v_sub_f32 v52, v62, v28
    v_sub_f32 v61, v29, v57
    v_add_f32 v62, v62, v28
    v_add_f32 v29, v29, v57
    v_sub_f32 v28, v58, v54
    v_sub_f32 v57, v69, v43
    v_add_f32 v58, v58, v54
    v_add_f32 v69, v69, v43
    v_sub_f32 v54, v70, v30
    v_sub_f32 v43, v79, v77
    v_add_f32 v70, v70, v30
    v_add_f32 v79, v79, v77
    v_sub_f32 v30, v64, v34
    v_sub_f32 v77, v67, v73
    v_add_f32 v64, v64, v34
    v_add_f32 v67, v67, v73
    v_sub_f32 v34, v36, v40
    v_sub_f32 v73, v63, v25
    v_add_f32 v36, v36, v40
    v_add_f32 v63, v63, v25
    v_sub_f32 v40, v42, v60
    v_sub_f32 v25, v21, v65
    v_add_f32 v42, v42, v60
    v_add_f32 v21, v21, v65
    v_sub_f32 v60, v38, v46
    v_sub_f32 v65, v41, v33
    v_add_f32 v38, v38, v46
    v_add_f32 v41, v41, v33
    v_sub_f32 v46, v80, v50
    v_sub_f32 v33, v35, v47
    v_add_f32 v80, v80, v50
    v_add_f32 v35, v35, v47
    v_sub_f32 v50, v56, v76
    v_sub_f32 v47, v31, v53
    v_add_f32 v56, v56, v76
    v_add_f32 v31, v31, v53
    v_sub_f32 v76, v83, v24
    v_sub_f32 v53, v51, v75
    v_add_f32 v83, v83, v24
    v_add_f32 v51, v51, v75
    v_mul_f32 v12, v10, v8
    v_mul_f32 v12, 0x3a000000, v12
    v_mov_b32 v24, v12
    v_fmac_f32 v24, 0x00000000, v8
    v_cos_f32 v75, v24
    v_sin_f32 v22, v24
    s_nop 0
    v_mul_f32 v20, v82, v75
    v_fma_f32 v20, -v17, v22, v20
    v_mul_f32 v17, v17, v75
    v_fmac_f32 v17, v82, v22
    v_mov_b32 v24, v12
    v_fmac_f32 v24, 0x3a800000, v8
    v_cos_f32 v75, v24
    v_sin_f32 v22, v24
    s_nop 0
    v_mul_f32 v82, v70, v75
    v_fma_f32 v82, -v79, v22, v82
    v_mul_f32 v79, v79, v75
    v_fmac_f32 v79, v70, v22
    v_mov_b32 v24, v12
    v_fmac_f32 v24, 0x3b000000, v8
    v_cos_f32 v75, v24
    v_sin_f32 v22, v24
    s_nop 0
    v_mul_f32 v70, v32, v75
    v_fma_f32 v70, -v81, v22, v70
    v_mul_f32 v81, v81, v75
    v_fmac_f32 v81, v32, v22
    v_mov_b32 v24, v12
    v_fmac_f32 v24, 0x3b400000, v8
    v_cos_f32 v75, v24
    v_sin_f32 v22, v24
    s_nop 0
    v_mul_f32 v32, v38, v75
    v_fma_f32 v32, -v41, v22, v32
    v_mul_f32 v41, v41, v75
    v_fmac_f32 v41, v38, v22
    v_mov_b32 v24, v12
    v_fmac_f32 v24, 0x3b800000, v8
    v_cos_f32 v75, v24
    v_sin_f32 v22, v24
    s_nop 0
    v_mul_f32 v38, v78, v75
    v_fma_f32 v38, -v45, v22, v38
    v_mul_f32 v45, v45, v75
    v_fmac_f32 v45, v78, v22
    v_mov_b32 v24, v12
    v_fmac_f32 v24, 0x3ba00000, v8
    v_cos_f32 v75, v24
    v_sin_f32 v22, v24
    s_nop 0
    v_mul_f32 v78, v36, v75
    v_fma_f32 v78, -v63, v22, v78
    v_mul_f32 v63, v63, v75
    v_fmac_f32 v63, v36, v22
    v_mov_b32 v24, v12
    v_fmac_f32 v24, 0x3bc00000, v8
    v_cos_f32 v75, v24
    v_sin_f32 v22, v24
    s_nop 0
    v_mul_f32 v36, v62, v75
    v_fma_f32 v36, -v29, v22, v36
    v_mul_f32 v29, v29, v75
    v_fmac_f32 v29, v62, v22
    v_mov_b32 v24, v12
    v_fmac_f32 v24, 0x3be00000, v8
    v_cos_f32 v75, v24
    v_sin_f32 v22, v24
    s_nop 0
    v_mul_f32 v62, v56, v75
    v_fma_f32 v62, -v31, v22, v62
    v_mul_f32 v31, v31, v75
    v_fmac_f32 v31, v56, v22
    v_mov_b32 v24, v12
    v_fmac_f32 v24, 0x3c000000, v8
    v_cos_f32 v75, v24
    v_sin_f32 v22, v24
    s_nop 0
    v_mul_f32 v56, v18, v75
    v_fma_f32 v56, -v55, v22, v56
    v_mul_f32 v55, v55, v75
    v_fmac_f32 v55, v18, v22
    v_mov_b32 v24, v12
    v_fmac_f32 v24, 0x3c100000, v8
    v_cos_f32 v75, v24
    v_sin_f32 v22, v24
    s_nop 0
    v_mul_f32 v18, v64, v75
    v_fma_f32 v18, -v67, v22, v18
    v_mul_f32 v67, v67, v75
    v_fmac_f32 v67, v64, v22
    v_mov_b32 v24, v12
    v_fmac_f32 v24, 0x3c200000, v8
    v_cos_f32 v75, v24
    v_sin_f32 v22, v24
    s_nop 0
    v_mul_f32 v64, v66, v75
    v_fma_f32 v64, -v37, v22, v64
    v_mul_f32 v37, v37, v75
    v_fmac_f32 v37, v66, v22
    v_mov_b32 v24, v12
    v_fmac_f32 v24, 0x3c300000, v8
    v_cos_f32 v75, v24
    v_sin_f32 v22, v24
    s_nop 0
    v_mul_f32 v66, v80, v75
    v_fma_f32 v66, -v35, v22, v66
    v_mul_f32 v35, v35, v75
    v_fmac_f32 v35, v80, v22
    v_mov_b32 v24, v12
    v_fmac_f32 v24, 0x3c400000, v8
    v_cos_f32 v75, v24
    v_sin_f32 v22, v24
    s_nop 0
    v_mul_f32 v80, v74, v75
    v_fma_f32 v80, -v23, v22, v80
    v_mul_f32 v23, v23, v75
    v_fmac_f32 v23, v74, v22
    v_mov_b32 v24, v12
    v_fmac_f32 v24, 0x3c500000, v8
    v_cos_f32 v75, v24
    v_sin_f32 v22, v24
    s_nop 0
    v_mul_f32 v74, v42, v75
    v_fma_f32 v74, -v21, v22, v74
    v_mul_f32 v21, v21, v75
    v_fmac_f32 v21, v42, v22
    v_mov_b32 v24, v12
    v_fmac_f32 v24, 0x3c600000, v8
    v_cos_f32 v75, v24
    v_sin_f32 v22, v24
    s_nop 0
    v_mul_f32 v42, v58, v75
    v_fma_f32 v42, -v69, v22, v42
    v_mul_f32 v69, v69, v75
    v_fmac_f32 v69, v58, v22
    v_mov_b32 v24, v12
    v_fmac_f32 v24, 0x3c700000, v8
    v_cos_f32 v75, v24
    v_sin_f32 v22, v24
    s_nop 0
    v_mul_f32 v58, v83, v75
    v_fma_f32 v58, -v51, v22, v58
    v_mul_f32 v51, v51, v75
    v_fmac_f32 v51, v83, v22
    v_mov_b32 v24, v12
    v_fmac_f32 v24, 0x3c800000, v8
    v_cos_f32 v75, v24
    v_sin_f32 v22, v24
    s_nop 0
    v_mul_f32 v83, v72, v75
    v_fma_f32 v83, -v59, v22, v83
    v_mul_f32 v59, v59, v75
    v_fmac_f32 v59, v72, v22
    v_mov_b32 v24, v12
    v_fmac_f32 v24, 0x3c880000, v8
    v_cos_f32 v75, v24
    v_sin_f32 v22, v24
    s_nop 0
    v_mul_f32 v72, v54, v75
    v_fma_f32 v72, -v43, v22, v72
    v_mul_f32 v43, v43, v75
    v_fmac_f32 v43, v54, v22
    v_mov_b32 v24, v12
    v_fmac_f32 v24, 0x3c900000, v8
    v_cos_f32 v75, v24
    v_sin_f32 v22, v24
    s_nop 0
    v_mul_f32 v54, v48, v75
    v_fma_f32 v54, -v27, v22, v54
    v_mul_f32 v27, v27, v75
    v_fmac_f32 v27, v48, v22
    v_mov_b32 v24, v12
    v_fmac_f32 v24, 0x3c980000, v8
    v_cos_f32 v75, v24
    v_sin_f32 v22, v24
    s_nop 0
    v_mul_f32 v48, v60, v75
    v_fma_f32 v48, -v65, v22, v48
    v_mul_f32 v65, v65, v75
    v_fmac_f32 v65, v60, v22
    v_mov_b32 v24, v12
    v_fmac_f32 v24, 0x3ca00000, v8
    v_cos_f32 v75, v24
    v_sin_f32 v22, v24
    s_nop 0
    v_mul_f32 v60, v16, v75
    v_fma_f32 v60, -v19, v22, v60
    v_mul_f32 v19, v19, v75
    v_fmac_f32 v19, v16, v22
    v_mov_b32 v24, v12
    v_fmac_f32 v24, 0x3ca80000, v8
    v_cos_f32 v75, v24
    v_sin_f32 v22, v24
    s_nop 0
    v_mul_f32 v16, v34, v75
    v_fma_f32 v16, -v73, v22, v16
    v_mul_f32 v73, v73, v75
    v_fmac_f32 v73, v34, v22
    v_mov_b32 v24, v12
    v_fmac_f32 v24, 0x3cb00000, v8
    v_cos_f32 v75, v24
    v_sin_f32 v22, v24
    s_nop 0
    v_mul_f32 v34, v52, v75
    v_fma_f32 v34, -v61, v22, v34
    v_mul_f32 v61, v61, v75
    v_fmac_f32 v61, v52, v22
    v_mov_b32 v24, v12
    v_fmac_f32 v24, 0x3cb80000, v8
    v_cos_f32 v75, v24
    v_sin_f32 v22, v24
    s_nop 0
    v_mul_f32 v52, v50, v75
    v_fma_f32 v52, -v47, v22, v52
    v_mul_f32 v47, v47, v75
    v_fmac_f32 v47, v50, v22
    v_mov_b32 v24, v12
    v_fmac_f32 v24, 0x3cc00000, v8
    v_cos_f32 v75, v24
    v_sin_f32 v22, v24
    s_nop 0
    v_mul_f32 v50, v26, v75
    v_fma_f32 v50, -v49, v22, v50
    v_mul_f32 v49, v49, v75
    v_fmac_f32 v49, v26, v22
    v_mov_b32 v24, v12
    v_fmac_f32 v24, 0x3cc80000, v8
    v_cos_f32 v75, v24
    v_sin_f32 v22, v24
    s_nop 0
    v_mul_f32 v26, v30, v75
    v_fma_f32 v26, -v77, v22, v26
    v_mul_f32 v77, v77, v75
    v_fmac_f32 v77, v30, v22
    v_mov_b32 v24, v12
    v_fmac_f32 v24, 0x3cd00000, v8
    v_cos_f32 v75, v24
    v_sin_f32 v22, v24
    s_nop 0
    v_mul_f32 v30, v44, v75
    v_fma_f32 v30, -v71, v22, v30
    v_mul_f32 v71, v71, v75
    v_fmac_f32 v71, v44, v22
    v_mov_b32 v24, v12
    v_fmac_f32 v24, 0x3cd80000, v8
    v_cos_f32 v75, v24
    v_sin_f32 v22, v24
    s_nop 0
    v_mul_f32 v44, v46, v75
    v_fma_f32 v44, -v33, v22, v44
    v_mul_f32 v33, v33, v75
    v_fmac_f32 v33, v46, v22
    v_mov_b32 v24, v12
    v_fmac_f32 v24, 0x3ce00000, v8
    v_cos_f32 v75, v24
    v_sin_f32 v22, v24
    s_nop 0
    v_mul_f32 v46, v68, v75
    v_fma_f32 v46, -v39, v22, v46
    v_mul_f32 v39, v39, v75
    v_fmac_f32 v39, v68, v22
    v_mov_b32 v24, v12
    v_fmac_f32 v24, 0x3ce80000, v8
    v_cos_f32 v75, v24
    v_sin_f32 v22, v24
    s_nop 0
    v_mul_f32 v68, v40, v75
    v_fma_f32 v68, -v25, v22, v68
    v_mul_f32 v25, v25, v75
    v_fmac_f32 v25, v40, v22
    v_mov_b32 v24, v12
    v_fmac_f32 v24, 0x3cf00000, v8
    v_cos_f32 v75, v24
    v_sin_f32 v22, v24
    s_nop 0
    v_mul_f32 v40, v28, v75
    v_fma_f32 v40, -v57, v22, v40
    v_mul_f32 v57, v57, v75
    v_fmac_f32 v57, v28, v22
    v_mov_b32 v24, v12
    v_fmac_f32 v24, 0x3cf80000, v8
    v_cos_f32 v75, v24
    v_sin_f32 v22, v24
    s_nop 0
    v_mul_f32 v28, v76, v75
    v_fma_f32 v28, -v53, v22, v28
    v_mul_f32 v53, v53, v75
    v_fmac_f32 v53, v76, v22
    ds_write_b32 v4, v20 offset:0
    ds_write_b32 v4, v17 offset:4
    ds_write_b32 v4, v82 offset:16
    ds_write_b32 v4, v79 offset:20
    ds_write_b32 v4, v70 offset:32
    ds_write_b32 v4, v81 offset:36
    ds_write_b32 v4, v32 offset:48
    ds_write_b32 v4, v41 offset:52
    ds_write_b32 v4, v38 offset:64
    ds_write_b32 v4, v45 offset:68
    ds_write_b32 v4, v78 offset:80
    ds_write_b32 v4, v63 offset:84
    ds_write_b32 v4, v36 offset:96
    ds_write_b32 v4, v29 offset:100
    ds_write_b32 v4, v62 offset:112
    ds_write_b32 v4, v31 offset:116
    ds_write_b32 v4, v56 offset:128
    ds_write_b32 v4, v55 offset:132
    ds_write_b32 v4, v18 offset:144
    ds_write_b32 v4, v67 offset:148
    ds_write_b32 v4, v64 offset:160
    ds_write_b32 v4, v37 offset:164
    ds_write_b32 v4, v66 offset:176
    ds_write_b32 v4, v35 offset:180
    ds_write_b32 v4, v80 offset:192
    ds_write_b32 v4, v23 offset:196
    ds_write_b32 v4, v74 offset:208
    ds_write_b32 v4, v21 offset:212
    ds_write_b32 v4, v42 offset:224
    ds_write_b32 v4, v69 offset:228
    ds_write_b32 v4, v58 offset:240
    ds_write_b32 v4, v51 offset:244
    ds_write_b32 v4, v83 offset:256
    ds_write_b32 v4, v59 offset:260
    ds_write_b32 v4, v72 offset:272
    ds_write_b32 v4, v43 offset:276
    ds_write_b32 v4, v54 offset:288
    ds_write_b32 v4, v27 offset:292
    ds_write_b32 v4, v48 offset:304
    ds_write_b32 v4, v65 offset:308
    ds_write_b32 v4, v60 offset:320
    ds_write_b32 v4, v19 offset:324
    ds_write_b32 v4, v16 offset:336
    ds_write_b32 v4, v73 offset:340
    ds_write_b32 v4, v34 offset:352
    ds_write_b32 v4, v61 offset:356
    ds_write_b32 v4, v52 offset:368
    ds_write_b32 v4, v47 offset:372
    ds_write_b32 v4, v50 offset:384
    ds_write_b32 v4, v49 offset:388
    ds_write_b32 v4, v26 offset:400
    ds_write_b32 v4, v77 offset:404
    ds_write_b32 v4, v30 offset:416
    ds_write_b32 v4, v71 offset:420
    ds_write_b32 v4, v44 offset:432
    ds_write_b32 v4, v33 offset:436
    ds_write_b32 v4, v46 offset:448
    ds_write_b32 v4, v39 offset:452
    ds_write_b32 v4, v68 offset:464
    ds_write_b32 v4, v25 offset:468
    ds_write_b32 v4, v40 offset:480
    ds_write_b32 v4, v57 offset:484
    ds_write_b32 v4, v28 offset:496
    ds_write_b32 v4, v53 offset:500
    s_waitcnt lgkmcnt(0)
    ds_read_b32 v20, v3 offset:0
    ds_read_b32 v17, v3 offset:4
    ds_read_b32 v82, v3 offset:528
    ds_read_b32 v79, v3 offset:532
    ds_read_b32 v70, v3 offset:1056
    ds_read_b32 v81, v3 offset:1060
    ds_read_b32 v32, v3 offset:1584
    ds_read_b32 v41, v3 offset:1588
    ds_read_b32 v38, v3 offset:2112
    ds_read_b32 v45, v3 offset:2116
    ds_read_b32 v78, v3 offset:2640
    ds_read_b32 v63, v3 offset:2644
    ds_read_b32 v36, v3 offset:3168
    ds_read_b32 v29, v3 offset:3172
    s_waitcnt lgkmcnt(0)
    ds_read_b32 v62, v3 offset:3696
    ds_read_b32 v31, v3 offset:3700
    ds_read_b32 v56, v3 offset:4224
    ds_read_b32 v55, v3 offset:4228
    ds_read_b32 v18, v3 offset:4752
    ds_read_b32 v67, v3 offset:4756
    ds_read_b32 v64, v3 offset:5280
    ds_read_b32 v37, v3 offset:5284
    ds_read_b32 v66, v3 offset:5808
    ds_read_b32 v35, v3 offset:5812
    ds_read_b32 v80, v3 offset:6336
    ds_read_b32 v23, v3 offset:6340
    ds_read_b32 v74, v3 offset:6864
    ds_read_b32 v21, v3 offset:6868
    s_waitcnt lgkmcnt(0)
    ds_read_b32 v42, v3 offset:7392
    ds_read_b32 v69, v3 offset:7396
    ds_read_b32 v58, v3 offset:7920
    ds_read_b32 v51, v3 offset:7924
    ds_read_b32 v83, v3 offset:8448
    ds_read_b32 v59, v3 offset:8452
    ds_read_b32 v72, v3 offset:8976
    ds_read_b32 v43, v3 offset:8980
    ds_read_b32 v54, v3 offset:9504
    ds_read_b32 v27, v3 offset:9508
    ds_read_b32 v48, v3 offset:10032
    ds_read_b32 v65, v3 offset:10036
    ds_read_b32 v60, v3 offset:10560
    ds_read_b32 v19, v3 offset:10564
    s_waitcnt lgkmcnt(0)
    ds_read_b32 v16, v3 offset:11088
    ds_read_b32 v73, v3 offset:11092
    ds_read_b32 v34, v3 offset:11616
    ds_read_b32 v61, v3 offset:11620
    ds_read_b32 v52, v3 offset:12144
    ds_read_b32 v47, v3 offset:12148
    ds_read_b32 v50, v3 offset:12672
    ds_read_b32 v49, v3 offset:12676
    ds_read_b32 v26, v3 offset:13200
    ds_read_b32 v77, v3 offset:13204
    ds_read_b32 v30, v3 offset:13728
    ds_read_b32 v71, v3 offset:13732
    ds_read_b32 v44, v3 offset:14256
    ds_read_b32 v33, v3 offset:14260
    s_waitcnt lgkmcnt(0)
    ds_read_b32 v46, v3 offset:14784
    ds_read_b32 v39, v3 offset:14788
    ds_read_b32 v68, v3 offset:15312
    ds_read_b32 v25, v3 offset:15316
    ds_read_b32 v40, v3 offset:15840
    ds_read_b32 v57, v3 offset:15844
    ds_read_b32 v28, v3 offset:16368
    ds_read_b32 v53, v3 offset:16372
    s_waitcnt lgkmcnt(0)
    v_sub_f32 v24, v20, v83
    v_sub_f32 v75, v17, v59
    v_add_f32 v20, v20, v83
    v_add_f32 v17, v17, v59
    v_sub_f32 v83, v82, v72
    v_sub_f32 v59, v79, v43
    v_add_f32 v82, v82, v72
    v_add_f32 v79, v79, v43
    v_mul_f32 v72, 0x3f7b14be, v83
    v_mul_f32 v43, 0x3e47c5c2, v83
    v_fmac_f32 v72, 0xbe47c5c2, v59
    v_fmac_f32 v43, 0x3f7b14be, v59
    v_sub_f32 v83, v70, v54
    v_sub_f32 v59, v81, v27
    v_add_f32 v70, v70, v54
    v_add_f32 v81, v81, v27
    v_mul_f32 v54, 0x3f6c835e, v83
    v_mul_f32 v27, 0x3ec3ef15, v83
    v_fmac_f32 v54, 0xbec3ef15, v59
    v_fmac_f32 v27, 0x3f6c835e, v59
    v_sub_f32 v83, v32, v48
    v_sub_f32 v59, v41, v65
    v_add_f32 v32, v32, v48
    v_add_f32 v41, v41, v65
    v_mul_f32 v48, 0x3f54db31, v83
    v_mul_f32 v65, 0x3f0e39da, v83
    v_fmac_f32 v48, 0xbf0e39da, v59
    v_fmac_f32 v65, 0x3f54db31, v59
    v_sub_f32 v83, v38, v60
    v_sub_f32 v59, v45, v19
    v_add_f32 v38, v38, v60
    v_add_f32 v45, v45, v19
    v_mul_f32 v60, 0x3f3504f3, v83
    v_mul_f32 v19, 0x3f3504f3, v83
    v_fmac_f32 v60, 0xbf3504f3, v59
    v_fmac_f32 v19, 0x3f3504f3, v59
    v_sub_f32 v83, v78, v16
    v_sub_f32 v59, v63, v73
    v_add_f32 v78, v78, v16
    v_add_f32 v63, v63, v73
    v_mul_f32 v16, 0x3f0e39da, v83
    v_mul_f32 v73, 0x3f54db31, v83
    v_fmac_f32 v16, 0xbf54db31, v59
    v_fmac_f32 v73, 0x3f0e39da, v59
    v_sub_f32 v83, v36, v34
    v_sub_f32 v59, v29, v61
    v_add_f32 v36, v36, v34
    v_add_f32 v29, v29, v61
    v_mul_f32 v34, 0x3ec3ef15, v83
    v_mul_f32 v61, 0x3f6c835e, v83
    v_fmac_f32 v34, 0xbf6c835e, v59
    v_fmac_f32 v61, 0x3ec3ef15, v59
    v_sub_f32 v83, v62, v52
    v_sub_f32 v59, v31, v47
    v_add_f32 v62, v62, v52
    v_add_f32 v31, v31, v47
    v_mul_f32 v52, 0x3e47c5c2, v83
    v_mul_f32 v47, 0x3f7b14be, v83
    v_fmac_f32 v52, 0xbf7b14be, v59
    v_fmac_f32 v47, 0x3e47c5c2, v59
    v_sub_f32 v83, v49, v55
    v_sub_f32 v59, v56, v50
    v_add_f32 v56, v56, v50
    v_add_f32 v55, v55, v49
    v_sub_f32 v50, v18, v26
    v_sub_f32 v49, v67, v77
    v_add_f32 v18, v18, v26
    v_add_f32 v67, v67, v77
    v_mul_f32 v26, 0xbe47c5c2, v50
    v_mul_f32 v77, 0x3f7b14be, v50
    v_fmac_f32 v26, 0xbf7b14be, v49
    v_fmac_f32 v77, 0xbe47c5c2, v49
    v_sub_f32 v50, v64, v30
    v_sub_f32 v49, v37, v71
    v_add_f32 v64, v64, v30
    v_add_f32 v37, v37, v71
    v_mul_f32 v30, 0xbec3ef15, v50
    v_mul_f32 v71, 0x3f6c835e, v50
    v_fmac_f32 v30, 0xbf6c835e, v49
    v_fmac_f32 v71, 0xbec3ef15, v49
    v_sub_f32 v50, v66, v44
    v_sub_f32 v49, v35, v33
    v_add_f32 v66, v66, v44
    v_add_f32 v35, v35, v33
    v_mul_f32 v44, 0xbf0e39da, v50
    v_mul_f32 v33, 0x3f54db31, v50
    v_fmac_f32 v44, 0xbf54db31, v49
    v_fmac_f32 v33, 0xbf0e39da, v49
    v_sub_f32 v50, v80, v46
    v_sub_f32 v49, v23, v39
    v_add_f32 v80, v80, v46
    v_add_f32 v23, v23, v39
    v_mul_f32 v46, 0xbf3504f3, v50
    v_mul_f32 v39, 0x3f3504f3, v50
    v_fmac_f32 v46, 0xbf3504f3, v49
    v_fmac_f32 v39, 0xbf3504f3, v49
    v_sub_f32 v50, v74, v68
    v_sub_f32 v49, v21, v25
    v_add_f32 v74, v74, v68
    v_add_f32 v21, v21, v25
    v_mul_f32 v68, 0xbf54db31, v50
    v_mul_f32 v25, 0x3f0e39da, v50
    v_fmac_f32 v68, 0xbf0e39da, v49
    v_fmac_f32 v25, 0xbf54db31, v49
    v_sub_f32 v50, v42, v40
    v_sub_f32 v49, v69, v57
    v_add_f32 v42, v42, v40
    v_add_f32 v69, v69, v57
    v_mul_f32 v40, 0xbf6c835e, v50
    v_mul_f32 v57, 0x3ec3ef15, v50
    v_fmac_f32 v40, 0xbec3ef15, v49
    v_fmac_f32 v57, 0xbf6c835e, v49
    v_sub_f32 v50, v58, v28
    v_sub_f32 v49, v51, v53
    v_add_f32 v58, v58, v28
    v_add_f32 v51, v51, v53
    v_mul_f32 v28, 0xbf7b14be, v50
    v_mul_f32 v53, 0x3e47c5c2, v50
    v_fmac_f32 v28, 0xbe47c5c2, v49
    v_fmac_f32 v53, 0xbf7b14be, v49
    v_sub_f32 v50, v20, v56
    v_sub_f32 v49, v17, v55
    v_add_f32 v20, v20, v56
    v_add_f32 v17, v17, v55
    v_sub_f32 v56, v82, v18
    v_sub_f32 v55, v79, v67
    v_add_f32 v82, v82, v18
    v_add_f32 v79, v79, v67
    v_mul_f32 v18, 0x3f6c835e, v56
    v_mul_f32 v67, 0x3ec3ef15, v56
    v_fmac_f32 v18, 0xbec3ef15, v55
    v_fmac_f32 v67, 0x3f6c835e, v55
    v_sub_f32 v56, v70, v64
    v_sub_f32 v55, v81, v37
    v_add_f32 v70, v70, v64
    v_add_f32 v81, v81, v37
    v_mul_f32 v64, 0x3f3504f3, v56
    v_mul_f32 v37, 0x3f3504f3, v56
    v_fmac_f32 v64, 0xbf3504f3, v55
    v_fmac_f32 v37, 0x3f3504f3, v55
    v_sub_f32 v56, v32, v66
    v_sub_f32 v55, v41, v35
    v_add_f32 v32, v32, v66
    v_add_f32 v41, v41, v35
    v_mul_f32 v66, 0x3ec3ef15, v56
    v_mul_f32 v35, 0x3f6c835e, v56
    v_fmac_f32 v66, 0xbf6c835e, v55
    v_fmac_f32 v35, 0x3ec3ef15, v55
    v_sub_f32 v56, v23, v45
    v_sub_f32 v55, v38, v80
    v_add_f32 v38, v38, v80
    v_add_f32 v45, v45, v23
    v_sub_f32 v80, v78, v74
    v_sub_f32 v23, v63, v21
    v_add_f32 v78, v78, v74
    v_add_f32 v63, v63, v21
    v_mul_f32 v74, 0xbec3ef15, v80
    v_mul_f32 v21, 0x3f6c835e, v80
    v_fmac_f32 v74, 0xbf6c835e, v23
    v_fmac_f32 v21, 0xbec3ef15, v23
    v_sub_f32 v80, v36, v42
    v_sub_f32 v23, v29, v69
    v_add_f32 v36, v36, v42
    v_add_f32 v29, v29, v69
    v_mul_f32 v42, 0xbf3504f3, v80
    v_mul_f32 v69, 0x3f3504f3, v80
    v_fmac_f32 v42, 0xbf3504f3, v23
    v_fmac_f32 v69, 0xbf3504f3, v23
    v_sub_f32 v80, v62, v58
    v_sub_f32 v23, v31, v51
    v_add_f32 v62, v62, v58
    v_add_f32 v31, v31, v51
    v_mul_f32 v58, 0xbf6c835e, v80
    v_mul_f32 v51, 0x3ec3ef15, v80
    v_fmac_f32 v58, 0xbec3ef15, v23
    v_fmac_f32 v51, 0xbf6c835e, v23
    v_sub_f32 v80, v24, v83
    v_sub_f32 v23, v75, v59
    v_add_f32 v24, v24, v83
    v_add_f32 v75, v75, v59
    v_sub_f32 v83, v72, v26
    v_sub_f32 v59, v43, v77
    v_add_f32 v72, v72, v26
    v_add_f32 v43, v43, v77
    v_mul_f32 v26, 0x3f6c835e, v83
    v_mul_f32 v77, 0x3ec3ef15, v83
    v_fmac_f32 v26, 0xbec3ef15, v59
    v_fmac_f32 v77, 0x3f6c835e, v59
    v_sub_f32 v83, v54, v30
    v_sub_f32 v59, v27, v71
    v_add_f32 v54, v54, v30
    v_add_f32 v27, v27, v71
    v_mul_f32 v30, 0x3f3504f3, v83
    v_mul_f32 v71, 0x3f3504f3, v83
    v_fmac_f32 v30, 0xbf3504f3, v59
    v_fmac_f32 v71, 0x3f3504f3, v59
    v_sub_f32 v83, v48, v44
    v_sub_f32 v59, v65, v33
    v_add_f32 v48, v48, v44
    v_add_f32 v65, v65, v33
    v_mul_f32 v44, 0x3ec3ef15, v83
    v_mul_f32 v33, 0x3f6c835e, v83
    v_fmac_f32 v44, 0xbf6c835e, v59
    v_fmac_f32 v33, 0x3ec3ef15, v59
    v_sub_f32 v83, v39, v19
    v_sub_f32 v59, v60, v46
    v_add_f32 v60, v60, v46
    v_add_f32 v19, v19, v39
    v_sub_f32 v46, v16, v68
    v_sub_f32 v39, v73, v25
    v_add_f32 v16, v16, v68
    v_add_f32 v73, v73, v25
    v_mul_f32 v68, 0xbec3ef15, v46
    v_mul_f32 v25, 0x3f6c835e, v46
    v_fmac_f32 v68, 0xbf6c835e, v39
    v_fmac_f32 v25, 0xbec3ef15, v39
    v_sub_f32 v46, v34, v40
    v_sub_f32 v39, v61, v57
    v_add_f32 v34, v34, v40
    v_add_f32 v61, v61, v57
    v_mul_f32 v40, 0xbf3504f3, v46
    v_mul_f32 v57, 0x3f3504f3, v46
    v_fmac_f32 v40, 0xbf3504f3, v39
    v_fmac_f32 v57, 0xbf3504f3, v39
    v_sub_f32 v46, v52, v28
    v_sub_f32 v39, v47, v53
    v_add_f32 v52, v52, v28
    v_add_f32 v47, v47, v53
    v_mul_f32 v28, 0xbf6c835e, v46
    v_mul_f32 v53, 0x3ec3ef15, v46
    v_fmac_f32 v28, 0xbec3ef15, v39
    v_fmac_f32 v53, 0xbf6c835e, v39
    v_sub_f32 v46, v20, v38
    v_sub_f32 v39, v17, v45
    v_add_f32 v20, v20, v38
    v_add_f32 v17, v17, v45
    v_sub_f32 v38, v82, v78
    v_sub_f32 v45, v79, v63
    v_add_f32 v82, v82, v78
    v_add_f32 v79, v79, v63
    v_mul_f32 v78, 0x3f3504f3, v38
    v_mul_f32 v63, 0x3f3504f3, v38
    v_fmac_f32 v78, 0xbf3504f3, v45
    v_fmac_f32 v63, 0x3f3504f3, v45
    v_sub_f32 v38, v29, v81
    v_sub_f32 v45, v70, v36
    v_add_f32 v70, v70, v36
    v_add_f32 v81, v81, v29
    v_sub_f32 v36, v32, v62
    v_sub_f32 v29, v41, v31
    v_add_f32 v32, v32, v62
    v_add_f32 v41, v41, v31
    v_mul_f32 v62, 0xbf3504f3, v36
    v_mul_f32 v31, 0x3f3504f3, v36
    v_fmac_f32 v62, 0xbf3504f3, v29
    v_fmac_f32 v31, 0xbf3504f3, v29
    v_sub_f32 v36, v50, v56
    v_sub_f32 v29, v49, v55
    v_add_f32 v50, v50, v56
    v_add_f32 v49, v49, v55
    v_sub_f32 v56, v18, v74
    v_sub_f32 v55, v67, v21
    v_add_f32 v18, v18, v74
    v_add_f32 v67, v67, v21
    v_mul_f32 v74, 0x3f3504f3, v56
    v_mul_f32 v21, 0x3f3504f3, v56
    v_fmac_f32 v74, 0xbf3504f3, v55
    v_fmac_f32 v21, 0x3f3504f3, v55
    v_sub_f32 v56, v69, v37
    v_sub_f32 v55, v64, v42
    v_add_f32 v64, v64, v42
    v_add_f32 v37, v37, v69
    v_sub_f32 v42, v66, v58
    v_sub_f32 v69, v35, v51
    v_add_f32 v66, v66, v58
    v_add_f32 v35, v35, v51
    v_mul_f32 v58, 0xbf3504f3, v42
    v_mul_f32 v51, 0x3f3504f3, v42
    v_fmac_f32 v58, 0xbf3504f3, v69
    v_fmac_f32 v51, 0xbf3504f3, v69
    v_sub_f32 v42, v24, v60
    v_sub_f32 v69, v75, v19
    v_add_f32 v24, v24, v60
    v_add_f32 v75, v75, v19
    v_sub_f32 v60, v72, v16
    v_sub_f32 v19, v43, v73
    v_add_f32 v72, v72, v16
    v_add_f32 v43, v43, v73
    v_mul_f32 v16, 0x3f3504f3, v60
    v_mul_f32 v73, 0x3f3504f3, v60
    v_fmac_f32 v16, 0xbf3504f3, v19
    v_fmac_f32 v73, 0x3f3504f3, v19
    v_sub_f32 v60, v61, v27
    v_sub_f32 v19, v54, v34
    v_add_f32 v54, v54, v34
    v_add_f32 v27, v27, v61
    v_sub_f32 v34, v48, v52
    v_sub_f32 v61, v65, v47
    v_add_f32 v48, v48, v52
    v_add_f32 v65, v65, v47
    v_mul_f32 v52, 0xbf3504f3, v34
    v_mul_f32 v47, 0x3f3504f3, v34
    v_fmac_f32 v52, 0xbf3504f3, v61
    v_fmac_f32 v47, 0xbf3504f3, v61
    v_sub_f32 v34, v80, v83
    v_sub_f32 v61, v23, v59
    v_add_f32 v80, v80, v83
    v_add_f32 v23, v23, v59
    v_sub_f32 v83, v26, v68
    v_sub_f32 v59, v77, v25
    v_add_f32 v26, v26, v68
    v_add_f32 v77, v77, v25
    v_mul_f32 v68, 0x3f3504f3, v83
    v_mul_f32 v25, 0x3f3504f3, v83
    v_fmac_f32 v68, 0xbf3504f3, v59
    v_fmac_f32 v25, 0x3f3504f3, v59
    v_sub_f32 v83, v57, v71
    v_sub_f32 v59, v30, v40
    v_add_f32 v30, v30, v40
    v_add_f32 v71, v71, v57
    v_sub_f32 v40, v44, v28
    v_sub_f32 v57, v33, v53
    v_add_f32 v44, v44, v28
    v_add_f32 v33, v33, v53
    v_mul_f32 v28, 0xbf3504f3, v40
    v_mul_f32 v53, 0x3f3504f3, v40
    v_fmac_f32 v28, 0xbf3504f3, v57
    v_fmac_f32 v53, 0xbf3504f3, v57
    v_sub_f32 v40, v20, v70
    v_sub_f32 v57, v17, v81
    v_add_f32 v20, v20, v70
    v_add_f32 v17, v17, v81
    v_sub_f32 v70, v41, v79
    v_sub_f32 v81, v82, v32
    v_add_f32 v82, v82, v32
    v_add_f32 v79, v79, v41
    v_sub_f32 v32, v46, v38
    v_sub_f32 v41, v39, v45
    v_add_f32 v46, v46, v38
    v_add_f32 v39, v39, v45
    v_sub_f32 v38, v31, v63
    v_sub_f32 v45, v78, v62
    v_add_f32 v78, v78, v62
    v_add_f32 v63, v63, v31
    v_sub_f32 v62, v50, v64
    v_sub_f32 v31, v49, v37
    v_add_f32 v50, v50, v64
    v_add_f32 v49, v49, v37
    v_sub_f32 v64, v35, v67
    v_sub_f32 v37, v18, v66
    v_add_f32 v18, v18, v66
    v_add_f32 v67, v67, v35
    v_sub_f32 v66, v36, v56
    v_sub_f32 v35, v29, v55
    v_add_f32 v36, v36, v56
    v_add_f32 v29, v29, v55
    v_sub_f32 v56, v51, v21
    v_sub_f32 v55, v74, v58
    v_add_f32 v74, v74, v58
    v_add_f32 v21, v21, v51
    v_sub_f32 v58, v24, v54
    v_sub_f32 v51, v75, v27
    v_add_f32 v24, v24, v54
    v_add_f32 v75, v75, v27
    v_sub_f32 v54, v65, v43
    v_sub_f32 v27, v72, v48
    v_add_f32 v72, v72, v48
    v_add_f32 v43, v43, v65
    v_sub_f32 v48, v42, v60
    v_sub_f32 v65, v69, v19
    v_add_f32 v42, v42, v60
    v_add_f32 v69, v69, v19
    v_sub_f32 v60, v47, v73
    v_sub_f32 v19, v16, v52
    v_add_f32 v16, v16, v52
    v_add_f32 v73, v73, v47
    v_sub_f32 v52, v80, v30
    v_sub_f32 v47, v23, v71
    v_add_f32 v80, v80, v30
    v_add_f32 v23, v23, v71
    v_sub_f32 v30, v33, v77
    v_sub_f32 v71, v26, v44
    v_add_f32 v26, v26, v44
    v_add_f32 v77, v77, v33
    v_sub_f32 v44, v34, v83
    v_sub_f32 v33, v61, v59
    v_add_f32 v34, v34, v83
    v_add_f32 v61, v61, v59
    v_sub_f32 v83, v53, v25
    v_sub_f32 v59, v68, v28
    v_add_f32 v68, v68, v28
    v_add_f32 v25, v25, v53
    v_sub_f32 v28, v20, v82
    v_sub_f32 v53, v17, v79
    v_add_f32 v20, v20, v82
    v_add_f32 v17, v17, v79
    v_sub_f32 v82, v40, v70
    v_sub_f32 v79, v57, v81
    v_add_f32 v40, v40, v70
    v_add_f32 v57, v57, v81
    v_sub_f32 v70, v46, v78
    v_sub_f32 v81, v39, v63
    v_add_f32 v46, v46, v78
    v_add_f32 v39, v39, v63
    v_sub_f32 v78, v32, v38
    v_sub_f32 v63, v41, v45
    v_add_f32 v32, v32, v38
    v_add_f32 v41, v41, v45
    v_sub_f32 v38, v50, v18
    v_sub_f32 v45, v49, v67
    v_add_f32 v50, v50, v18
    v_add_f32 v49, v49, v67
    v_sub_f32 v18, v62, v64
    v_sub_f32 v67, v31, v37
    v_add_f32 v62, v62, v64
    v_add_f32 v31, v31, v37
    v_sub_f32 v64, v36, v74
    v_sub_f32 v37, v29, v21
    v_add_f32 v36, v36, v74
    v_add_f32 v29, v29, v21
    v_sub_f32 v74, v66, v56
    v_sub_f32 v21, v35, v55
    v_add_f32 v66, v66, v56
    v_add_f32 v35, v35, v55
    v_sub_f32 v56, v24, v72
    v_sub_f32 v55, v75, v43
    v_add_f32 v24, v24, v72
    v_add_f32 v75, v75, v43
    v_sub_f32 v72, v58, v54
    v_sub_f32 v43, v51, v27
    v_add_f32 v58, v58, v54
    v_add_f32 v51, v51, v27
    v_sub_f32 v54, v42, v16
    v_sub_f32 v27, v69, v73
    v_add_f32 v42, v42, v16
    v_add_f32 v69, v69, v73
    v_sub_f32 v16, v48, v60
    v_sub_f32 v73, v65, v19
    v_add_f32 v48, v48, v60
    v_add_f32 v65, v65, v19
    v_sub_f32 v60, v80, v26
    v_sub_f32 v19, v23, v77
    v_add_f32 v80, v80, v26
    v_add_f32 v23, v23, v77
    v_sub_f32 v26, v52, v30
    v_sub_f32 v77, v47, v71
    v_add_f32 v52, v52, v30
    v_add_f32 v47, v47, v71
    v_sub_f32 v30, v34, v68
    v_sub_f32 v71, v61, v25
    v_add_f32 v34, v34, v68
    v_add_f32 v61, v61, v25
    v_sub_f32 v68, v44, v83
    v_sub_f32 v25, v33, v59
    v_add_f32 v44, v44, v83
    v_add_f32 v33, v33, v59
    s_add_u32 s15, s14, 109051904
    v_lshlrev_b32 v5, 3, v1
    s_add_u32 s16, s15, 0
    v_mov_b32 v88, v20
    v_mov_b32 v89, v17
    buffer_store_dwordx2 v[88:89], v5, s[8:11], s16 offen sc1
    s_add_u32 s16, s15, 512
    v_mov_b32 v90, v24
    v_mov_b32 v91, v75
    buffer_store_dwordx2 v[90:91], v5, s[8:11], s16 offen sc1
    s_add_u32 s16, s15, 1024
    v_mov_b32 v92, v50
    v_mov_b32 v93, v49
    buffer_store_dwordx2 v[92:93], v5, s[8:11], s16 offen sc1
    s_add_u32 s16, s15, 1536
    v_mov_b32 v94, v80
    v_mov_b32 v95, v23
    buffer_store_dwordx2 v[94:95], v5, s[8:11], s16 offen sc1
    s_add_u32 s16, s15, 2048
    v_mov_b32 v96, v46
    v_mov_b32 v97, v39
    buffer_store_dwordx2 v[96:97], v5, s[8:11], s16 offen sc1
    s_add_u32 s16, s15, 2560
    v_mov_b32 v98, v42
    v_mov_b32 v99, v69
    buffer_store_dwordx2 v[98:99], v5, s[8:11], s16 offen sc1
    s_add_u32 s16, s15, 3072
    v_mov_b32 v100, v36
    v_mov_b32 v101, v29
    buffer_store_dwordx2 v[100:101], v5, s[8:11], s16 offen sc1
    s_add_u32 s16, s15, 3584
    v_mov_b32 v102, v34
    v_mov_b32 v103, v61
    buffer_store_dwordx2 v[102:103], v5, s[8:11], s16 offen sc1
    s_add_u32 s16, s15, 4096
    v_mov_b32 v88, v40
    v_mov_b32 v89, v57
    buffer_store_dwordx2 v[88:89], v5, s[8:11], s16 offen sc1
    s_add_u32 s16, s15, 4608
    v_mov_b32 v90, v58
    v_mov_b32 v91, v51
    buffer_store_dwordx2 v[90:91], v5, s[8:11], s16 offen sc1
    s_add_u32 s16, s15, 5120
    v_mov_b32 v92, v62
    v_mov_b32 v93, v31
    buffer_store_dwordx2 v[92:93], v5, s[8:11], s16 offen sc1
    s_add_u32 s16, s15, 5632
    v_mov_b32 v94, v52
    v_mov_b32 v95, v47
    buffer_store_dwordx2 v[94:95], v5, s[8:11], s16 offen sc1
    s_add_u32 s16, s15, 6144
    v_mov_b32 v96, v32
    v_mov_b32 v97, v41
    buffer_store_dwordx2 v[96:97], v5, s[8:11], s16 offen sc1
    s_add_u32 s16, s15, 6656
    v_mov_b32 v98, v48
    v_mov_b32 v99, v65
    buffer_store_dwordx2 v[98:99], v5, s[8:11], s16 offen sc1
    s_add_u32 s16, s15, 7168
    v_mov_b32 v100, v66
    v_mov_b32 v101, v35
    buffer_store_dwordx2 v[100:101], v5, s[8:11], s16 offen sc1
    s_add_u32 s16, s15, 7680
    v_mov_b32 v102, v44
    v_mov_b32 v103, v33
    buffer_store_dwordx2 v[102:103], v5, s[8:11], s16 offen sc1
    s_add_u32 s16, s15, 8192
    v_mov_b32 v88, v28
    v_mov_b32 v89, v53
    buffer_store_dwordx2 v[88:89], v5, s[8:11], s16 offen sc1
    s_add_u32 s16, s15, 8704
    v_mov_b32 v90, v56
    v_mov_b32 v91, v55
    buffer_store_dwordx2 v[90:91], v5, s[8:11], s16 offen sc1
    s_add_u32 s16, s15, 9216
    v_mov_b32 v92, v38
    v_mov_b32 v93, v45
    buffer_store_dwordx2 v[92:93], v5, s[8:11], s16 offen sc1
    s_add_u32 s16, s15, 9728
    v_mov_b32 v94, v60
    v_mov_b32 v95, v19
    buffer_store_dwordx2 v[94:95], v5, s[8:11], s16 offen sc1
    s_add_u32 s16, s15, 10240
    v_mov_b32 v96, v70
    v_mov_b32 v97, v81
    buffer_store_dwordx2 v[96:97], v5, s[8:11], s16 offen sc1
    s_add_u32 s16, s15, 10752
    v_mov_b32 v98, v54
    v_mov_b32 v99, v27
    buffer_store_dwordx2 v[98:99], v5, s[8:11], s16 offen sc1
    s_add_u32 s16, s15, 11264
    v_mov_b32 v100, v64
    v_mov_b32 v101, v37
    buffer_store_dwordx2 v[100:101], v5, s[8:11], s16 offen sc1
    s_add_u32 s16, s15, 11776
    v_mov_b32 v102, v30
    v_mov_b32 v103, v71
    buffer_store_dwordx2 v[102:103], v5, s[8:11], s16 offen sc1
    s_add_u32 s16, s15, 12288
    v_mov_b32 v88, v82
    v_mov_b32 v89, v79
    buffer_store_dwordx2 v[88:89], v5, s[8:11], s16 offen sc1
    s_add_u32 s16, s15, 12800
    v_mov_b32 v90, v72
    v_mov_b32 v91, v43
    buffer_store_dwordx2 v[90:91], v5, s[8:11], s16 offen sc1
    s_add_u32 s16, s15, 13312
    v_mov_b32 v92, v18
    v_mov_b32 v93, v67
    buffer_store_dwordx2 v[92:93], v5, s[8:11], s16 offen sc1
    s_add_u32 s16, s15, 13824
    v_mov_b32 v94, v26
    v_mov_b32 v95, v77
    buffer_store_dwordx2 v[94:95], v5, s[8:11], s16 offen sc1
    s_add_u32 s16, s15, 14336
    v_mov_b32 v96, v78
    v_mov_b32 v97, v63
    buffer_store_dwordx2 v[96:97], v5, s[8:11], s16 offen sc1
    s_add_u32 s16, s15, 14848
    v_mov_b32 v98, v16
    v_mov_b32 v99, v73
    buffer_store_dwordx2 v[98:99], v5, s[8:11], s16 offen sc1
    s_add_u32 s16, s15, 15360
    v_mov_b32 v100, v74
    v_mov_b32 v101, v21
    buffer_store_dwordx2 v[100:101], v5, s[8:11], s16 offen sc1
    s_add_u32 s16, s15, 15872
    v_mov_b32 v102, v68
    v_mov_b32 v103, v25
    buffer_store_dwordx2 v[102:103], v5, s[8:11], s16 offen sc1
mega_kernel_f2_end:
    s_cmp_eq_u32 s99, 128
    s_cbranch_scc1 mega_kernel_f2ret
    s_waitcnt vmcnt(0)
    s_barrier
    s_cmp_lg_u32 s98, 0
    s_cbranch_scc1 mega_kernel_sg_7
    v_mov_b32 v2, 1
    s_mov_b32 s81, 71360768
    s_mov_b64 exec, 1
    buffer_atomic_add v2, off, s[84:87], s81 sc1
    s_mov_b64 exec, -1
mega_kernel_sg_7:
    s_waitcnt vmcnt(0)
    ds_read_b64_tr_b16 a[128:129], v201 offset:0
    ds_read_b64_tr_b16 a[130:131], v201 offset:256
    ds_read_b64_tr_b16 a[132:133], v201 offset:1024
    ds_read_b64_tr_b16 a[134:135], v201 offset:1280
    ds_read_b64_tr_b16 a[136:137], v201 offset:2048
    ds_read_b64_tr_b16 a[138:139], v201 offset:2304
    ds_read_b64_tr_b16 a[140:141], v201 offset:3072
    ds_read_b64_tr_b16 a[142:143], v201 offset:3328
    s_waitcnt lgkmcnt(0)
    ds_read_b64_tr_b16 a[144:145], v201 offset:4096
    ds_read_b64_tr_b16 a[146:147], v201 offset:4352
    ds_read_b64_tr_b16 a[148:149], v201 offset:5120
    ds_read_b64_tr_b16 a[150:151], v201 offset:5376
    ds_read_b64_tr_b16 a[152:153], v201 offset:6144
    ds_read_b64_tr_b16 a[154:155], v201 offset:6400
    ds_read_b64_tr_b16 a[156:157], v201 offset:7168
    ds_read_b64_tr_b16 a[158:159], v201 offset:7424
    s_waitcnt lgkmcnt(0)
    ds_read_b64_tr_b16 a[160:161], v201 offset:8192
    ds_read_b64_tr_b16 a[162:163], v201 offset:8448
    ds_read_b64_tr_b16 a[164:165], v201 offset:9216
    ds_read_b64_tr_b16 a[166:167], v201 offset:9472
    ds_read_b64_tr_b16 a[168:169], v201 offset:10240
    ds_read_b64_tr_b16 a[170:171], v201 offset:10496
    ds_read_b64_tr_b16 a[172:173], v201 offset:11264
    ds_read_b64_tr_b16 a[174:175], v201 offset:11520
    s_waitcnt lgkmcnt(0)
    ds_read_b64_tr_b16 a[176:177], v201 offset:12288
    ds_read_b64_tr_b16 a[178:179], v201 offset:12544
    ds_read_b64_tr_b16 a[180:181], v201 offset:13312
    ds_read_b64_tr_b16 a[182:183], v201 offset:13568
    ds_read_b64_tr_b16 a[184:185], v201 offset:14336
    ds_read_b64_tr_b16 a[186:187], v201 offset:14592
    ds_read_b64_tr_b16 a[188:189], v201 offset:15360
    ds_read_b64_tr_b16 a[190:191], v201 offset:15616
    s_waitcnt lgkmcnt(0)
    s_add_u32 m0, s56, 0
    s_add_u32 s58, s57, 49152
    s_and_b32 s58, s58, 0xffff
    s_lshl_b32 s58, s58, 5
    buffer_load_dwordx4 v200, s[52:55], s58 offen lds
    s_add_u32 m0, s56, 1024
    s_add_u32 s58, s57, 50176
    s_and_b32 s58, s58, 0xffff
    s_lshl_b32 s58, s58, 5
    buffer_load_dwordx4 v200, s[52:55], s58 offen lds
    s_add_u32 m0, s56, 2048
    s_add_u32 s58, s57, 51200
    s_and_b32 s58, s58, 0xffff
    s_lshl_b32 s58, s58, 5
    buffer_load_dwordx4 v200, s[52:55], s58 offen lds
    s_add_u32 m0, s56, 3072
    s_add_u32 s58, s57, 52224
    s_and_b32 s58, s58, 0xffff
    s_lshl_b32 s58, s58, 5
    buffer_load_dwordx4 v200, s[52:55], s58 offen lds
    s_add_u32 m0, s56, 4096
    s_add_u32 s58, s57, 53248
    s_and_b32 s58, s58, 0xffff
    s_lshl_b32 s58, s58, 5
    buffer_load_dwordx4 v200, s[52:55], s58 offen lds
    s_add_u32 m0, s56, 5120
    s_add_u32 s58, s57, 54272
    s_and_b32 s58, s58, 0xffff
    s_lshl_b32 s58, s58, 5
    buffer_load_dwordx4 v200, s[52:55], s58 offen lds
    s_add_u32 m0, s56, 6144
    s_add_u32 s58, s57, 55296
    s_and_b32 s58, s58, 0xffff
    s_lshl_b32 s58, s58, 5
    buffer_load_dwordx4 v200, s[52:55], s58 offen lds
    s_add_u32 m0, s56, 7168
    s_add_u32 s58, s57, 56320
    s_and_b32 s58, s58, 0xffff
    s_lshl_b32 s58, s58, 5
    buffer_load_dwordx4 v200, s[52:55], s58 offen lds
    s_add_u32 m0, s56, 8192
    s_add_u32 s58, s57, 57344
    s_and_b32 s58, s58, 0xffff
    s_lshl_b32 s58, s58, 5
    buffer_load_dwordx4 v200, s[52:55], s58 offen lds
    s_add_u32 m0, s56, 9216
    s_add_u32 s58, s57, 58368
    s_and_b32 s58, s58, 0xffff
    s_lshl_b32 s58, s58, 5
    buffer_load_dwordx4 v200, s[52:55], s58 offen lds
    s_add_u32 m0, s56, 10240
    s_add_u32 s58, s57, 59392
    s_and_b32 s58, s58, 0xffff
    s_lshl_b32 s58, s58, 5
    buffer_load_dwordx4 v200, s[52:55], s58 offen lds
    s_add_u32 m0, s56, 11264
    s_add_u32 s58, s57, 60416
    s_and_b32 s58, s58, 0xffff
    s_lshl_b32 s58, s58, 5
    buffer_load_dwordx4 v200, s[52:55], s58 offen lds
    s_add_u32 m0, s56, 12288
    s_add_u32 s58, s57, 61440
    s_and_b32 s58, s58, 0xffff
    s_lshl_b32 s58, s58, 5
    buffer_load_dwordx4 v200, s[52:55], s58 offen lds
    s_add_u32 m0, s56, 13312
    s_add_u32 s58, s57, 62464
    s_and_b32 s58, s58, 0xffff
    s_lshl_b32 s58, s58, 5
    buffer_load_dwordx4 v200, s[52:55], s58 offen lds
    s_add_u32 m0, s56, 14336
    s_add_u32 s58, s57, 63488
    s_and_b32 s58, s58, 0xffff
    s_lshl_b32 s58, s58, 5
    buffer_load_dwordx4 v200, s[52:55], s58 offen lds
    s_add_u32 m0, s56, 15360
    s_add_u32 s58, s57, 64512
    s_and_b32 s58, s58, 0xffff
    s_lshl_b32 s58, s58, 5
    buffer_load_dwordx4 v200, s[52:55], s58 offen lds
    s_cmp_lg_u32 s98, 0
    s_cbranch_scc1 mega_kernel_wf2d
    s_mov_b32 s81, 71360768
mega_kernel_wf2:
    buffer_load_dword v120, off, s[84:87], s81 sc1
    s_waitcnt vmcnt(0)
    v_cmp_ne_u32 vcc, 129, v120
    s_cbranch_vccz mega_kernel_wf2d
    s_sleep 6
    s_branch mega_kernel_wf2
mega_kernel_wf2d:
    s_barrier
    s_load_dwordx2 s[4:5], s[0:1], 80
    s_load_dwordx2 s[8:9], s[0:1], 96
    v_and_b32 v6, 7, v0
    v_lshrrev_b32 v7, 3, v0
    s_movk_i32 s13, 8448
    v_mul_lo_u32 v8, v6, s13
    v_lshl_add_u32 v4, v7, 3, v8
    v_lshlrev_b32 v5, 14, v7
    v_lshl_add_u32 v5, v6, 4, v5
    s_lshl_b32 s12, s92, 7
    s_add_u32 s12, s12, 109051904
    s_waitcnt lgkmcnt(0)
    s_mov_b32 s6, 8388608
    s_mov_b32 s7, 0x00020000
    s_mov_b32 s10, 268435456
    s_mov_b32 s11, 0x00020000
    s_add_u32 s13, s12, 0
    buffer_load_dwordx4 v[16:19], v5, s[8:11], s13 offen
    s_add_u32 s13, s12, 524288
    buffer_load_dwordx4 v[20:23], v5, s[8:11], s13 offen
    s_add_u32 s13, s12, 1048576
    buffer_load_dwordx4 v[24:27], v5, s[8:11], s13 offen
    s_add_u32 s13, s12, 1572864
    buffer_load_dwordx4 v[28:31], v5, s[8:11], s13 offen
    s_add_u32 s13, s12, 2097152
    buffer_load_dwordx4 v[32:35], v5, s[8:11], s13 offen
    s_add_u32 s13, s12, 2621440
    buffer_load_dwordx4 v[36:39], v5, s[8:11], s13 offen
    s_add_u32 s13, s12, 3145728
    buffer_load_dwordx4 v[40:43], v5, s[8:11], s13 offen
    s_add_u32 s13, s12, 3670016
    buffer_load_dwordx4 v[44:47], v5, s[8:11], s13 offen
    s_add_u32 s13, s12, 4194304
    buffer_load_dwordx4 v[48:51], v5, s[8:11], s13 offen
    s_add_u32 s13, s12, 4718592
    buffer_load_dwordx4 v[52:55], v5, s[8:11], s13 offen
    s_add_u32 s13, s12, 5242880
    buffer_load_dwordx4 v[56:59], v5, s[8:11], s13 offen
    s_add_u32 s13, s12, 5767168
    buffer_load_dwordx4 v[60:63], v5, s[8:11], s13 offen
    s_add_u32 s13, s12, 6291456
    buffer_load_dwordx4 v[64:67], v5, s[8:11], s13 offen
    s_add_u32 s13, s12, 6815744
    buffer_load_dwordx4 v[68:71], v5, s[8:11], s13 offen
    s_add_u32 s13, s12, 7340032
    buffer_load_dwordx4 v[72:75], v5, s[8:11], s13 offen
    s_add_u32 s13, s12, 7864320
    buffer_load_dwordx4 v[76:79], v5, s[8:11], s13 offen
    s_add_u32 s13, s12, 8388608
    buffer_load_dwordx4 v[80:83], v5, s[8:11], s13 offen
    s_waitcnt vmcnt(0)
    v_cmp_eq_u32 vcc, 0, v7
    s_nop 1
    v_mov_b32 v9, 0
    v_cndmask_b32 v17, v17, v9, vcc
    v_cndmask_b32 v19, v19, v9, vcc
    v_cndmask_b32 v81, v81, v9, vcc
    v_cndmask_b32 v83, v83, v9, vcc
    v_sub_u32 v6, 1024, v7
    v_and_b32 v6, 1023, v6
    v_lshl_add_u32 v6, v6, 3, v8
    v_sub_f32 v10, v16, v19
    v_add_f32 v11, v17, v18
    v_add_f32 v12, v16, v19
    v_sub_f32 v13, v18, v17
    ds_write_b64 v4, v[10:11] offset:0
    ds_write_b64 v6, v[12:13]
    v_sub_u32 v6, 992, v7
    v_and_b32 v6, 1023, v6
    v_lshl_add_u32 v6, v6, 3, v8
    v_sub_f32 v10, v20, v23
    v_add_f32 v11, v21, v22
    v_add_f32 v12, v20, v23
    v_sub_f32 v13, v22, v21
    ds_write_b64 v4, v[10:11] offset:256
    ds_write_b64 v6, v[12:13]
    v_sub_u32 v6, 960, v7
    v_and_b32 v6, 1023, v6
    v_lshl_add_u32 v6, v6, 3, v8
    v_sub_f32 v10, v24, v27
    v_add_f32 v11, v25, v26
    v_add_f32 v12, v24, v27
    v_sub_f32 v13, v26, v25
    ds_write_b64 v4, v[10:11] offset:512
    ds_write_b64 v6, v[12:13]
    v_sub_u32 v6, 928, v7
    v_and_b32 v6, 1023, v6
    v_lshl_add_u32 v6, v6, 3, v8
    v_sub_f32 v10, v28, v31
    v_add_f32 v11, v29, v30
    v_add_f32 v12, v28, v31
    v_sub_f32 v13, v30, v29
    ds_write_b64 v4, v[10:11] offset:768
    ds_write_b64 v6, v[12:13]
    v_sub_u32 v6, 896, v7
    v_and_b32 v6, 1023, v6
    v_lshl_add_u32 v6, v6, 3, v8
    v_sub_f32 v10, v32, v35
    v_add_f32 v11, v33, v34
    v_add_f32 v12, v32, v35
    v_sub_f32 v13, v34, v33
    ds_write_b64 v4, v[10:11] offset:1024
    ds_write_b64 v6, v[12:13]
    v_sub_u32 v6, 864, v7
    v_and_b32 v6, 1023, v6
    v_lshl_add_u32 v6, v6, 3, v8
    v_sub_f32 v10, v36, v39
    v_add_f32 v11, v37, v38
    v_add_f32 v12, v36, v39
    v_sub_f32 v13, v38, v37
    ds_write_b64 v4, v[10:11] offset:1280
    ds_write_b64 v6, v[12:13]
    v_sub_u32 v6, 832, v7
    v_and_b32 v6, 1023, v6
    v_lshl_add_u32 v6, v6, 3, v8
    v_sub_f32 v10, v40, v43
    v_add_f32 v11, v41, v42
    v_add_f32 v12, v40, v43
    v_sub_f32 v13, v42, v41
    ds_write_b64 v4, v[10:11] offset:1536
    ds_write_b64 v6, v[12:13]
    v_sub_u32 v6, 800, v7
    v_and_b32 v6, 1023, v6
    v_lshl_add_u32 v6, v6, 3, v8
    v_sub_f32 v10, v44, v47
    v_add_f32 v11, v45, v46
    v_add_f32 v12, v44, v47
    v_sub_f32 v13, v46, v45
    ds_write_b64 v4, v[10:11] offset:1792
    ds_write_b64 v6, v[12:13]
    v_sub_u32 v6, 768, v7
    v_and_b32 v6, 1023, v6
    v_lshl_add_u32 v6, v6, 3, v8
    v_sub_f32 v10, v48, v51
    v_add_f32 v11, v49, v50
    v_add_f32 v12, v48, v51
    v_sub_f32 v13, v50, v49
    ds_write_b64 v4, v[10:11] offset:2048
    ds_write_b64 v6, v[12:13]
    v_sub_u32 v6, 736, v7
    v_and_b32 v6, 1023, v6
    v_lshl_add_u32 v6, v6, 3, v8
    v_sub_f32 v10, v52, v55
    v_add_f32 v11, v53, v54
    v_add_f32 v12, v52, v55
    v_sub_f32 v13, v54, v53
    ds_write_b64 v4, v[10:11] offset:2304
    ds_write_b64 v6, v[12:13]
    v_sub_u32 v6, 704, v7
    v_and_b32 v6, 1023, v6
    v_lshl_add_u32 v6, v6, 3, v8
    v_sub_f32 v10, v56, v59
    v_add_f32 v11, v57, v58
    v_add_f32 v12, v56, v59
    v_sub_f32 v13, v58, v57
    ds_write_b64 v4, v[10:11] offset:2560
    ds_write_b64 v6, v[12:13]
    v_sub_u32 v6, 672, v7
    v_and_b32 v6, 1023, v6
    v_lshl_add_u32 v6, v6, 3, v8
    v_sub_f32 v10, v60, v63
    v_add_f32 v11, v61, v62
    v_add_f32 v12, v60, v63
    v_sub_f32 v13, v62, v61
    ds_write_b64 v4, v[10:11] offset:2816
    ds_write_b64 v6, v[12:13]
    v_sub_u32 v6, 640, v7
    v_and_b32 v6, 1023, v6
    v_lshl_add_u32 v6, v6, 3, v8
    v_sub_f32 v10, v64, v67
    v_add_f32 v11, v65, v66
    v_add_f32 v12, v64, v67
    v_sub_f32 v13, v66, v65
    ds_write_b64 v4, v[10:11] offset:3072
    ds_write_b64 v6, v[12:13]
    v_sub_u32 v6, 608, v7
    v_and_b32 v6, 1023, v6
    v_lshl_add_u32 v6, v6, 3, v8
    v_sub_f32 v10, v68, v71
    v_add_f32 v11, v69, v70
    v_add_f32 v12, v68, v71
    v_sub_f32 v13, v70, v69
    ds_write_b64 v4, v[10:11] offset:3328
    ds_write_b64 v6, v[12:13]
    v_sub_u32 v6, 576, v7
    v_and_b32 v6, 1023, v6
    v_lshl_add_u32 v6, v6, 3, v8
    v_sub_f32 v10, v72, v75
    v_add_f32 v11, v73, v74
    v_add_f32 v12, v72, v75
    v_sub_f32 v13, v74, v73
    ds_write_b64 v4, v[10:11] offset:3584
    ds_write_b64 v6, v[12:13]
    v_sub_u32 v6, 544, v7
    v_and_b32 v6, 1023, v6
    v_lshl_add_u32 v6, v6, 3, v8
    v_sub_f32 v10, v76, v79
    v_add_f32 v11, v77, v78
    v_add_f32 v12, v76, v79
    v_sub_f32 v13, v78, v77
    ds_write_b64 v4, v[10:11] offset:3840
    ds_write_b64 v6, v[12:13]
    s_and_saveexec_b64 s[14:15], vcc
    v_sub_u32 v6, 512, v7
    v_and_b32 v6, 1023, v6
    v_lshl_add_u32 v6, v6, 3, v8
    v_sub_f32 v10, v80, v83
    v_add_f32 v11, v81, v82
    v_add_f32 v12, v80, v83
    v_sub_f32 v13, v82, v81
    ds_write_b64 v4, v[10:11] offset:4096
    ds_write_b64 v6, v[12:13]
    s_mov_b64 exec, s[14:15]
    s_waitcnt lgkmcnt(0)
    s_barrier
    v_and_b32 v1, 31, v0
    v_lshrrev_b32 v2, 5, v0
    v_cvt_f32_u32 v3, v1
    s_movk_i32 s13, 8448
    v_mul_lo_u32 v7, v2, s13
    v_lshl_add_u32 v4, v1, 3, v7
    s_movk_i32 s13, 264
    v_mul_lo_u32 v5, v1, s13
    v_add_u32 v5, v5, v7
    ds_read_b32 v16, v4 offset:0
    ds_read_b32 v48, v4 offset:4
    ds_read_b32 v17, v4 offset:256
    ds_read_b32 v49, v4 offset:260
    ds_read_b32 v18, v4 offset:512
    ds_read_b32 v50, v4 offset:516
    ds_read_b32 v19, v4 offset:768
    ds_read_b32 v51, v4 offset:772
    ds_read_b32 v20, v4 offset:1024
    ds_read_b32 v52, v4 offset:1028
    ds_read_b32 v21, v4 offset:1280
    ds_read_b32 v53, v4 offset:1284
    ds_read_b32 v22, v4 offset:1536
    ds_read_b32 v54, v4 offset:1540
    s_waitcnt lgkmcnt(0)
    ds_read_b32 v23, v4 offset:1792
    ds_read_b32 v55, v4 offset:1796
    ds_read_b32 v24, v4 offset:2048
    ds_read_b32 v56, v4 offset:2052
    ds_read_b32 v25, v4 offset:2304
    ds_read_b32 v57, v4 offset:2308
    ds_read_b32 v26, v4 offset:2560
    ds_read_b32 v58, v4 offset:2564
    ds_read_b32 v27, v4 offset:2816
    ds_read_b32 v59, v4 offset:2820
    ds_read_b32 v28, v4 offset:3072
    ds_read_b32 v60, v4 offset:3076
    ds_read_b32 v29, v4 offset:3328
    ds_read_b32 v61, v4 offset:3332
    s_waitcnt lgkmcnt(0)
    ds_read_b32 v30, v4 offset:3584
    ds_read_b32 v62, v4 offset:3588
    ds_read_b32 v31, v4 offset:3840
    ds_read_b32 v63, v4 offset:3844
    ds_read_b32 v32, v4 offset:4096
    ds_read_b32 v64, v4 offset:4100
    ds_read_b32 v33, v4 offset:4352
    ds_read_b32 v65, v4 offset:4356
    ds_read_b32 v34, v4 offset:4608
    ds_read_b32 v66, v4 offset:4612
    ds_read_b32 v35, v4 offset:4864
    ds_read_b32 v67, v4 offset:4868
    ds_read_b32 v36, v4 offset:5120
    ds_read_b32 v68, v4 offset:5124
    s_waitcnt lgkmcnt(0)
    ds_read_b32 v37, v4 offset:5376
    ds_read_b32 v69, v4 offset:5380
    ds_read_b32 v38, v4 offset:5632
    ds_read_b32 v70, v4 offset:5636
    ds_read_b32 v39, v4 offset:5888
    ds_read_b32 v71, v4 offset:5892
    ds_read_b32 v40, v4 offset:6144
    ds_read_b32 v72, v4 offset:6148
    ds_read_b32 v41, v4 offset:6400
    ds_read_b32 v73, v4 offset:6404
    ds_read_b32 v42, v4 offset:6656
    ds_read_b32 v74, v4 offset:6660
    ds_read_b32 v43, v4 offset:6912
    ds_read_b32 v75, v4 offset:6916
    s_waitcnt lgkmcnt(0)
    ds_read_b32 v44, v4 offset:7168
    ds_read_b32 v76, v4 offset:7172
    ds_read_b32 v45, v4 offset:7424
    ds_read_b32 v77, v4 offset:7428
    ds_read_b32 v46, v4 offset:7680
    ds_read_b32 v78, v4 offset:7684
    ds_read_b32 v47, v4 offset:7936
    ds_read_b32 v79, v4 offset:7940
    s_waitcnt lgkmcnt(0)
    v_sub_f32 v80, v16, v32
    v_sub_f32 v81, v48, v64
    v_add_f32 v16, v16, v32
    v_add_f32 v48, v48, v64
    v_sub_f32 v32, v17, v33
    v_sub_f32 v64, v49, v65
    v_add_f32 v17, v17, v33
    v_add_f32 v49, v49, v65
    v_mul_f32 v33, 0x3f7b14be, v32
    v_mul_f32 v65, 0x3e47c5c2, v32
    v_fmac_f32 v33, 0xbe47c5c2, v64
    v_fmac_f32 v65, 0x3f7b14be, v64
    v_sub_f32 v32, v18, v34
    v_sub_f32 v64, v50, v66
    v_add_f32 v18, v18, v34
    v_add_f32 v50, v50, v66
    v_mul_f32 v34, 0x3f6c835e, v32
    v_mul_f32 v66, 0x3ec3ef15, v32
    v_fmac_f32 v34, 0xbec3ef15, v64
    v_fmac_f32 v66, 0x3f6c835e, v64
    v_sub_f32 v32, v19, v35
    v_sub_f32 v64, v51, v67
    v_add_f32 v19, v19, v35
    v_add_f32 v51, v51, v67
    v_mul_f32 v35, 0x3f54db31, v32
    v_mul_f32 v67, 0x3f0e39da, v32
    v_fmac_f32 v35, 0xbf0e39da, v64
    v_fmac_f32 v67, 0x3f54db31, v64
    v_sub_f32 v32, v20, v36
    v_sub_f32 v64, v52, v68
    v_add_f32 v20, v20, v36
    v_add_f32 v52, v52, v68
    v_mul_f32 v36, 0x3f3504f3, v32
    v_mul_f32 v68, 0x3f3504f3, v32
    v_fmac_f32 v36, 0xbf3504f3, v64
    v_fmac_f32 v68, 0x3f3504f3, v64
    v_sub_f32 v32, v21, v37
    v_sub_f32 v64, v53, v69
    v_add_f32 v21, v21, v37
    v_add_f32 v53, v53, v69
    v_mul_f32 v37, 0x3f0e39da, v32
    v_mul_f32 v69, 0x3f54db31, v32
    v_fmac_f32 v37, 0xbf54db31, v64
    v_fmac_f32 v69, 0x3f0e39da, v64
    v_sub_f32 v32, v22, v38
    v_sub_f32 v64, v54, v70
    v_add_f32 v22, v22, v38
    v_add_f32 v54, v54, v70
    v_mul_f32 v38, 0x3ec3ef15, v32
    v_mul_f32 v70, 0x3f6c835e, v32
    v_fmac_f32 v38, 0xbf6c835e, v64
    v_fmac_f32 v70, 0x3ec3ef15, v64
    v_sub_f32 v32, v23, v39
    v_sub_f32 v64, v55, v71
    v_add_f32 v23, v23, v39
    v_add_f32 v55, v55, v71
    v_mul_f32 v39, 0x3e47c5c2, v32
    v_mul_f32 v71, 0x3f7b14be, v32
    v_fmac_f32 v39, 0xbf7b14be, v64
    v_fmac_f32 v71, 0x3e47c5c2, v64
    v_sub_f32 v32, v72, v56
    v_sub_f32 v64, v24, v40
    v_add_f32 v24, v24, v40
    v_add_f32 v56, v56, v72
    v_sub_f32 v40, v25, v41
    v_sub_f32 v72, v57, v73
    v_add_f32 v25, v25, v41
    v_add_f32 v57, v57, v73
    v_mul_f32 v41, 0xbe47c5c2, v40
    v_mul_f32 v73, 0x3f7b14be, v40
    v_fmac_f32 v41, 0xbf7b14be, v72
    v_fmac_f32 v73, 0xbe47c5c2, v72
    v_sub_f32 v40, v26, v42
    v_sub_f32 v72, v58, v74
    v_add_f32 v26, v26, v42
    v_add_f32 v58, v58, v74
    v_mul_f32 v42, 0xbec3ef15, v40
    v_mul_f32 v74, 0x3f6c835e, v40
    v_fmac_f32 v42, 0xbf6c835e, v72
    v_fmac_f32 v74, 0xbec3ef15, v72
    v_sub_f32 v40, v27, v43
    v_sub_f32 v72, v59, v75
    v_add_f32 v27, v27, v43
    v_add_f32 v59, v59, v75
    v_mul_f32 v43, 0xbf0e39da, v40
    v_mul_f32 v75, 0x3f54db31, v40
    v_fmac_f32 v43, 0xbf54db31, v72
    v_fmac_f32 v75, 0xbf0e39da, v72
    v_sub_f32 v40, v28, v44
    v_sub_f32 v72, v60, v76
    v_add_f32 v28, v28, v44
    v_add_f32 v60, v60, v76
    v_mul_f32 v44, 0xbf3504f3, v40
    v_mul_f32 v76, 0x3f3504f3, v40
    v_fmac_f32 v44, 0xbf3504f3, v72
    v_fmac_f32 v76, 0xbf3504f3, v72
    v_sub_f32 v40, v29, v45
    v_sub_f32 v72, v61, v77
    v_add_f32 v29, v29, v45
    v_add_f32 v61, v61, v77
    v_mul_f32 v45, 0xbf54db31, v40
    v_mul_f32 v77, 0x3f0e39da, v40
    v_fmac_f32 v45, 0xbf0e39da, v72
    v_fmac_f32 v77, 0xbf54db31, v72
    v_sub_f32 v40, v30, v46
    v_sub_f32 v72, v62, v78
    v_add_f32 v30, v30, v46
    v_add_f32 v62, v62, v78
    v_mul_f32 v46, 0xbf6c835e, v40
    v_mul_f32 v78, 0x3ec3ef15, v40
    v_fmac_f32 v46, 0xbec3ef15, v72
    v_fmac_f32 v78, 0xbf6c835e, v72
    v_sub_f32 v40, v31, v47
    v_sub_f32 v72, v63, v79
    v_add_f32 v31, v31, v47
    v_add_f32 v63, v63, v79
    v_mul_f32 v47, 0xbf7b14be, v40
    v_mul_f32 v79, 0x3e47c5c2, v40
    v_fmac_f32 v47, 0xbe47c5c2, v72
    v_fmac_f32 v79, 0xbf7b14be, v72
    v_sub_f32 v40, v16, v24
    v_sub_f32 v72, v48, v56
    v_add_f32 v16, v16, v24
    v_add_f32 v48, v48, v56
    v_sub_f32 v24, v17, v25
    v_sub_f32 v56, v49, v57
    v_add_f32 v17, v17, v25
    v_add_f32 v49, v49, v57
    v_mul_f32 v25, 0x3f6c835e, v24
    v_mul_f32 v57, 0x3ec3ef15, v24
    v_fmac_f32 v25, 0xbec3ef15, v56
    v_fmac_f32 v57, 0x3f6c835e, v56
    v_sub_f32 v24, v18, v26
    v_sub_f32 v56, v50, v58
    v_add_f32 v18, v18, v26
    v_add_f32 v50, v50, v58
    v_mul_f32 v26, 0x3f3504f3, v24
    v_mul_f32 v58, 0x3f3504f3, v24
    v_fmac_f32 v26, 0xbf3504f3, v56
    v_fmac_f32 v58, 0x3f3504f3, v56
    v_sub_f32 v24, v19, v27
    v_sub_f32 v56, v51, v59
    v_add_f32 v19, v19, v27
    v_add_f32 v51, v51, v59
    v_mul_f32 v27, 0x3ec3ef15, v24
    v_mul_f32 v59, 0x3f6c835e, v24
    v_fmac_f32 v27, 0xbf6c835e, v56
    v_fmac_f32 v59, 0x3ec3ef15, v56
    v_sub_f32 v24, v60, v52
    v_sub_f32 v56, v20, v28
    v_add_f32 v20, v20, v28
    v_add_f32 v52, v52, v60
    v_sub_f32 v28, v21, v29
    v_sub_f32 v60, v53, v61
    v_add_f32 v21, v21, v29
    v_add_f32 v53, v53, v61
    v_mul_f32 v29, 0xbec3ef15, v28
    v_mul_f32 v61, 0x3f6c835e, v28
    v_fmac_f32 v29, 0xbf6c835e, v60
    v_fmac_f32 v61, 0xbec3ef15, v60
    v_sub_f32 v28, v22, v30
    v_sub_f32 v60, v54, v62
    v_add_f32 v22, v22, v30
    v_add_f32 v54, v54, v62
    v_mul_f32 v30, 0xbf3504f3, v28
    v_mul_f32 v62, 0x3f3504f3, v28
    v_fmac_f32 v30, 0xbf3504f3, v60
    v_fmac_f32 v62, 0xbf3504f3, v60
    v_sub_f32 v28, v23, v31
    v_sub_f32 v60, v55, v63
    v_add_f32 v23, v23, v31
    v_add_f32 v55, v55, v63
    v_mul_f32 v31, 0xbf6c835e, v28
    v_mul_f32 v63, 0x3ec3ef15, v28
    v_fmac_f32 v31, 0xbec3ef15, v60
    v_fmac_f32 v63, 0xbf6c835e, v60
    v_sub_f32 v28, v80, v32
    v_sub_f32 v60, v81, v64
    v_add_f32 v80, v80, v32
    v_add_f32 v81, v81, v64
    v_sub_f32 v32, v33, v41
    v_sub_f32 v64, v65, v73
    v_add_f32 v33, v33, v41
    v_add_f32 v65, v65, v73
    v_mul_f32 v41, 0x3f6c835e, v32
    v_mul_f32 v73, 0x3ec3ef15, v32
    v_fmac_f32 v41, 0xbec3ef15, v64
    v_fmac_f32 v73, 0x3f6c835e, v64
    v_sub_f32 v32, v34, v42
    v_sub_f32 v64, v66, v74
    v_add_f32 v34, v34, v42
    v_add_f32 v66, v66, v74
    v_mul_f32 v42, 0x3f3504f3, v32
    v_mul_f32 v74, 0x3f3504f3, v32
    v_fmac_f32 v42, 0xbf3504f3, v64
    v_fmac_f32 v74, 0x3f3504f3, v64
    v_sub_f32 v32, v35, v43
    v_sub_f32 v64, v67, v75
    v_add_f32 v35, v35, v43
    v_add_f32 v67, v67, v75
    v_mul_f32 v43, 0x3ec3ef15, v32
    v_mul_f32 v75, 0x3f6c835e, v32
    v_fmac_f32 v43, 0xbf6c835e, v64
    v_fmac_f32 v75, 0x3ec3ef15, v64
    v_sub_f32 v32, v76, v68
    v_sub_f32 v64, v36, v44
    v_add_f32 v36, v36, v44
    v_add_f32 v68, v68, v76
    v_sub_f32 v44, v37, v45
    v_sub_f32 v76, v69, v77
    v_add_f32 v37, v37, v45
    v_add_f32 v69, v69, v77
    v_mul_f32 v45, 0xbec3ef15, v44
    v_mul_f32 v77, 0x3f6c835e, v44
    v_fmac_f32 v45, 0xbf6c835e, v76
    v_fmac_f32 v77, 0xbec3ef15, v76
    v_sub_f32 v44, v38, v46
    v_sub_f32 v76, v70, v78
    v_add_f32 v38, v38, v46
    v_add_f32 v70, v70, v78
    v_mul_f32 v46, 0xbf3504f3, v44
    v_mul_f32 v78, 0x3f3504f3, v44
    v_fmac_f32 v46, 0xbf3504f3, v76
    v_fmac_f32 v78, 0xbf3504f3, v76
    v_sub_f32 v44, v39, v47
    v_sub_f32 v76, v71, v79
    v_add_f32 v39, v39, v47
    v_add_f32 v71, v71, v79
    v_mul_f32 v47, 0xbf6c835e, v44
    v_mul_f32 v79, 0x3ec3ef15, v44
    v_fmac_f32 v47, 0xbec3ef15, v76
    v_fmac_f32 v79, 0xbf6c835e, v76
    v_sub_f32 v44, v16, v20
    v_sub_f32 v76, v48, v52
    v_add_f32 v16, v16, v20
    v_add_f32 v48, v48, v52
    v_sub_f32 v20, v17, v21
    v_sub_f32 v52, v49, v53
    v_add_f32 v17, v17, v21
    v_add_f32 v49, v49, v53
    v_mul_f32 v21, 0x3f3504f3, v20
    v_mul_f32 v53, 0x3f3504f3, v20
    v_fmac_f32 v21, 0xbf3504f3, v52
    v_fmac_f32 v53, 0x3f3504f3, v52
    v_sub_f32 v20, v54, v50
    v_sub_f32 v52, v18, v22
    v_add_f32 v18, v18, v22
    v_add_f32 v50, v50, v54
    v_sub_f32 v22, v19, v23
    v_sub_f32 v54, v51, v55
    v_add_f32 v19, v19, v23
    v_add_f32 v51, v51, v55
    v_mul_f32 v23, 0xbf3504f3, v22
    v_mul_f32 v55, 0x3f3504f3, v22
    v_fmac_f32 v23, 0xbf3504f3, v54
    v_fmac_f32 v55, 0xbf3504f3, v54
    v_sub_f32 v22, v40, v24
    v_sub_f32 v54, v72, v56
    v_add_f32 v40, v40, v24
    v_add_f32 v72, v72, v56
    v_sub_f32 v24, v25, v29
    v_sub_f32 v56, v57, v61
    v_add_f32 v25, v25, v29
    v_add_f32 v57, v57, v61
    v_mul_f32 v29, 0x3f3504f3, v24
    v_mul_f32 v61, 0x3f3504f3, v24
    v_fmac_f32 v29, 0xbf3504f3, v56
    v_fmac_f32 v61, 0x3f3504f3, v56
    v_sub_f32 v24, v62, v58
    v_sub_f32 v56, v26, v30
    v_add_f32 v26, v26, v30
    v_add_f32 v58, v58, v62
    v_sub_f32 v30, v27, v31
    v_sub_f32 v62, v59, v63
    v_add_f32 v27, v27, v31
    v_add_f32 v59, v59, v63
    v_mul_f32 v31, 0xbf3504f3, v30
    v_mul_f32 v63, 0x3f3504f3, v30
    v_fmac_f32 v31, 0xbf3504f3, v62
    v_fmac_f32 v63, 0xbf3504f3, v62
    v_sub_f32 v30, v80, v36
    v_sub_f32 v62, v81, v68
    v_add_f32 v80, v80, v36
    v_add_f32 v81, v81, v68
    v_sub_f32 v36, v33, v37
    v_sub_f32 v68, v65, v69
    v_add_f32 v33, v33, v37
    v_add_f32 v65, v65, v69
    v_mul_f32 v37, 0x3f3504f3, v36
    v_mul_f32 v69, 0x3f3504f3, v36
    v_fmac_f32 v37, 0xbf3504f3, v68
    v_fmac_f32 v69, 0x3f3504f3, v68
    v_sub_f32 v36, v70, v66
    v_sub_f32 v68, v34, v38
    v_add_f32 v34, v34, v38
    v_add_f32 v66, v66, v70
    v_sub_f32 v38, v35, v39
    v_sub_f32 v70, v67, v71
    v_add_f32 v35, v35, v39
    v_add_f32 v67, v67, v71
    v_mul_f32 v39, 0xbf3504f3, v38
    v_mul_f32 v71, 0x3f3504f3, v38
    v_fmac_f32 v39, 0xbf3504f3, v70
    v_fmac_f32 v71, 0xbf3504f3, v70
    v_sub_f32 v38, v28, v32
    v_sub_f32 v70, v60, v64
    v_add_f32 v28, v28, v32
    v_add_f32 v60, v60, v64
    v_sub_f32 v32, v41, v45
    v_sub_f32 v64, v73, v77
    v_add_f32 v41, v41, v45
    v_add_f32 v73, v73, v77
    v_mul_f32 v45, 0x3f3504f3, v32
    v_mul_f32 v77, 0x3f3504f3, v32
    v_fmac_f32 v45, 0xbf3504f3, v64
    v_fmac_f32 v77, 0x3f3504f3, v64
    v_sub_f32 v32, v78, v74
    v_sub_f32 v64, v42, v46
    v_add_f32 v42, v42, v46
    v_add_f32 v74, v74, v78
    v_sub_f32 v46, v43, v47
    v_sub_f32 v78, v75, v79
    v_add_f32 v43, v43, v47
    v_add_f32 v75, v75, v79
    v_mul_f32 v47, 0xbf3504f3, v46
    v_mul_f32 v79, 0x3f3504f3, v46
    v_fmac_f32 v47, 0xbf3504f3, v78
    v_fmac_f32 v79, 0xbf3504f3, v78
    v_sub_f32 v46, v16, v18
    v_sub_f32 v78, v48, v50
    v_add_f32 v16, v16, v18
    v_add_f32 v48, v48, v50
    v_sub_f32 v18, v51, v49
    v_sub_f32 v50, v17, v19
    v_add_f32 v17, v17, v19
    v_add_f32 v49, v49, v51
    v_sub_f32 v19, v44, v20
    v_sub_f32 v51, v76, v52
    v_add_f32 v44, v44, v20
    v_add_f32 v76, v76, v52
    v_sub_f32 v20, v55, v53
    v_sub_f32 v52, v21, v23
    v_add_f32 v21, v21, v23
    v_add_f32 v53, v53, v55
    v_sub_f32 v23, v40, v26
    v_sub_f32 v55, v72, v58
    v_add_f32 v40, v40, v26
    v_add_f32 v72, v72, v58
    v_sub_f32 v26, v59, v57
    v_sub_f32 v58, v25, v27
    v_add_f32 v25, v25, v27
    v_add_f32 v57, v57, v59
    v_sub_f32 v27, v22, v24
    v_sub_f32 v59, v54, v56
    v_add_f32 v22, v22, v24
    v_add_f32 v54, v54, v56
    v_sub_f32 v24, v63, v61
    v_sub_f32 v56, v29, v31
    v_add_f32 v29, v29, v31
    v_add_f32 v61, v61, v63
    v_sub_f32 v31, v80, v34
    v_sub_f32 v63, v81, v66
    v_add_f32 v80, v80, v34
    v_add_f32 v81, v81, v66
    v_sub_f32 v34, v67, v65
    v_sub_f32 v66, v33, v35
    v_add_f32 v33, v33, v35
    v_add_f32 v65, v65, v67
    v_sub_f32 v35, v30, v36
    v_sub_f32 v67, v62, v68
    v_add_f32 v30, v30, v36
    v_add_f32 v62, v62, v68
    v_sub_f32 v36, v71, v69
    v_sub_f32 v68, v37, v39
    v_add_f32 v37, v37, v39
    v_add_f32 v69, v69, v71
    v_sub_f32 v39, v28, v42
    v_sub_f32 v71, v60, v74
    v_add_f32 v28, v28, v42
    v_add_f32 v60, v60, v74
    v_sub_f32 v42, v75, v73
    v_sub_f32 v74, v41, v43
    v_add_f32 v41, v41, v43
    v_add_f32 v73, v73, v75
    v_sub_f32 v43, v38, v32
    v_sub_f32 v75, v70, v64
    v_add_f32 v38, v38, v32
    v_add_f32 v70, v70, v64
    v_sub_f32 v32, v79, v77
    v_sub_f32 v64, v45, v47
    v_add_f32 v45, v45, v47
    v_add_f32 v77, v77, v79
    v_sub_f32 v47, v16, v17
    v_sub_f32 v79, v48, v49
    v_add_f32 v16, v16, v17
    v_add_f32 v48, v48, v49
    v_sub_f32 v17, v46, v18
    v_sub_f32 v49, v78, v50
    v_add_f32 v46, v46, v18
    v_add_f32 v78, v78, v50
    v_sub_f32 v18, v44, v21
    v_sub_f32 v50, v76, v53
    v_add_f32 v44, v44, v21
    v_add_f32 v76, v76, v53
    v_sub_f32 v21, v19, v20
    v_sub_f32 v53, v51, v52
    v_add_f32 v19, v19, v20
    v_add_f32 v51, v51, v52
    v_sub_f32 v20, v40, v25
    v_sub_f32 v52, v72, v57
    v_add_f32 v40, v40, v25
    v_add_f32 v72, v72, v57
    v_sub_f32 v25, v23, v26
    v_sub_f32 v57, v55, v58
    v_add_f32 v23, v23, v26
    v_add_f32 v55, v55, v58
    v_sub_f32 v26, v22, v29
    v_sub_f32 v58, v54, v61
    v_add_f32 v22, v22, v29
    v_add_f32 v54, v54, v61
    v_sub_f32 v29, v27, v24
    v_sub_f32 v61, v59, v56
    v_add_f32 v27, v27, v24
    v_add_f32 v59, v59, v56
    v_sub_f32 v24, v80, v33
    v_sub_f32 v56, v81, v65
    v_add_f32 v80, v80, v33
    v_add_f32 v81, v81, v65
    v_sub_f32 v33, v31, v34
    v_sub_f32 v65, v63, v66
    v_add_f32 v31, v31, v34
    v_add_f32 v63, v63, v66
    v_sub_f32 v34, v30, v37
    v_sub_f32 v66, v62, v69
    v_add_f32 v30, v30, v37
    v_add_f32 v62, v62, v69
    v_sub_f32 v37, v35, v36
    v_sub_f32 v69, v67, v68
    v_add_f32 v35, v35, v36
    v_add_f32 v67, v67, v68
    v_sub_f32 v36, v28, v41
    v_sub_f32 v68, v60, v73
    v_add_f32 v28, v28, v41
    v_add_f32 v60, v60, v73
    v_sub_f32 v41, v39, v42
    v_sub_f32 v73, v71, v74
    v_add_f32 v39, v39, v42
    v_add_f32 v71, v71, v74
    v_sub_f32 v42, v38, v45
    v_sub_f32 v74, v70, v77
    v_add_f32 v38, v38, v45
    v_add_f32 v70, v70, v77
    v_sub_f32 v45, v43, v32
    v_sub_f32 v77, v75, v64
    v_add_f32 v43, v43, v32
    v_add_f32 v75, v75, v64
    v_mul_f32 v32, 0x3a800000, v3
    v_cos_f32 v64, v32
    v_sin_f32 v82, v32
    s_nop 0
    v_mul_f32 v83, v80, v64
    v_fma_f32 v83, -v81, v82, v83
    v_mul_f32 v81, v81, v64
    v_fmac_f32 v81, v80, v82
    v_mul_f32 v32, 0x3b000000, v3
    v_cos_f32 v64, v32
    v_sin_f32 v82, v32
    s_nop 0
    v_mul_f32 v80, v40, v64
    v_fma_f32 v80, -v72, v82, v80
    v_mul_f32 v72, v72, v64
    v_fmac_f32 v72, v40, v82
    v_mul_f32 v32, 0x3b400000, v3
    v_cos_f32 v64, v32
    v_sin_f32 v82, v32
    s_nop 0
    v_mul_f32 v40, v28, v64
    v_fma_f32 v40, -v60, v82, v40
    v_mul_f32 v60, v60, v64
    v_fmac_f32 v60, v28, v82
    v_mul_f32 v32, 0x3b800000, v3
    v_cos_f32 v64, v32
    v_sin_f32 v82, v32
    s_nop 0
    v_mul_f32 v28, v44, v64
    v_fma_f32 v28, -v76, v82, v28
    v_mul_f32 v76, v76, v64
    v_fmac_f32 v76, v44, v82
    v_mul_f32 v32, 0x3ba00000, v3
    v_cos_f32 v64, v32
    v_sin_f32 v82, v32
    s_nop 0
    v_mul_f32 v44, v30, v64
    v_fma_f32 v44, -v62, v82, v44
    v_mul_f32 v62, v62, v64
    v_fmac_f32 v62, v30, v82
    v_mul_f32 v32, 0x3bc00000, v3
    v_cos_f32 v64, v32
    v_sin_f32 v82, v32
    s_nop 0
    v_mul_f32 v30, v22, v64
    v_fma_f32 v30, -v54, v82, v30
    v_mul_f32 v54, v54, v64
    v_fmac_f32 v54, v22, v82
    v_mul_f32 v32, 0x3be00000, v3
    v_cos_f32 v64, v32
    v_sin_f32 v82, v32
    s_nop 0
    v_mul_f32 v22, v38, v64
    v_fma_f32 v22, -v70, v82, v22
    v_mul_f32 v70, v70, v64
    v_fmac_f32 v70, v38, v82
    v_mul_f32 v32, 0x3c000000, v3
    v_cos_f32 v64, v32
    v_sin_f32 v82, v32
    s_nop 0
    v_mul_f32 v38, v46, v64
    v_fma_f32 v38, -v78, v82, v38
    v_mul_f32 v78, v78, v64
    v_fmac_f32 v78, v46, v82
    v_mul_f32 v32, 0x3c100000, v3
    v_cos_f32 v64, v32
    v_sin_f32 v82, v32
    s_nop 0
    v_mul_f32 v46, v31, v64
    v_fma_f32 v46, -v63, v82, v46
    v_mul_f32 v63, v63, v64
    v_fmac_f32 v63, v31, v82
    v_mul_f32 v32, 0x3c200000, v3
    v_cos_f32 v64, v32
    v_sin_f32 v82, v32
    s_nop 0
    v_mul_f32 v31, v23, v64
    v_fma_f32 v31, -v55, v82, v31
    v_mul_f32 v55, v55, v64
    v_fmac_f32 v55, v23, v82
    v_mul_f32 v32, 0x3c300000, v3
    v_cos_f32 v64, v32
    v_sin_f32 v82, v32
    s_nop 0
    v_mul_f32 v23, v39, v64
    v_fma_f32 v23, -v71, v82, v23
    v_mul_f32 v71, v71, v64
    v_fmac_f32 v71, v39, v82
    v_mul_f32 v32, 0x3c400000, v3
    v_cos_f32 v64, v32
    v_sin_f32 v82, v32
    s_nop 0
    v_mul_f32 v39, v19, v64
    v_fma_f32 v39, -v51, v82, v39
    v_mul_f32 v51, v51, v64
    v_fmac_f32 v51, v19, v82
    v_mul_f32 v32, 0x3c500000, v3
    v_cos_f32 v64, v32
    v_sin_f32 v82, v32
    s_nop 0
    v_mul_f32 v19, v35, v64
    v_fma_f32 v19, -v67, v82, v19
    v_mul_f32 v67, v67, v64
    v_fmac_f32 v67, v35, v82
    v_mul_f32 v32, 0x3c600000, v3
    v_cos_f32 v64, v32
    v_sin_f32 v82, v32
    s_nop 0
    v_mul_f32 v35, v27, v64
    v_fma_f32 v35, -v59, v82, v35
    v_mul_f32 v59, v59, v64
    v_fmac_f32 v59, v27, v82
    v_mul_f32 v32, 0x3c700000, v3
    v_cos_f32 v64, v32
    v_sin_f32 v82, v32
    s_nop 0
    v_mul_f32 v27, v43, v64
    v_fma_f32 v27, -v75, v82, v27
    v_mul_f32 v75, v75, v64
    v_fmac_f32 v75, v43, v82
    v_mul_f32 v32, 0x3c800000, v3
    v_cos_f32 v64, v32
    v_sin_f32 v82, v32
    s_nop 0
    v_mul_f32 v43, v47, v64
    v_fma_f32 v43, -v79, v82, v43
    v_mul_f32 v79, v79, v64
    v_fmac_f32 v79, v47, v82
    v_mul_f32 v32, 0x3c880000, v3
    v_cos_f32 v64, v32
    v_sin_f32 v82, v32
    s_nop 0
    v_mul_f32 v47, v24, v64
    v_fma_f32 v47, -v56, v82, v47
    v_mul_f32 v56, v56, v64
    v_fmac_f32 v56, v24, v82
    v_mul_f32 v32, 0x3c900000, v3
    v_cos_f32 v64, v32
    v_sin_f32 v82, v32
    s_nop 0
    v_mul_f32 v24, v20, v64
    v_fma_f32 v24, -v52, v82, v24
    v_mul_f32 v52, v52, v64
    v_fmac_f32 v52, v20, v82
    v_mul_f32 v32, 0x3c980000, v3
    v_cos_f32 v64, v32
    v_sin_f32 v82, v32
    s_nop 0
    v_mul_f32 v20, v36, v64
    v_fma_f32 v20, -v68, v82, v20
    v_mul_f32 v68, v68, v64
    v_fmac_f32 v68, v36, v82
    v_mul_f32 v32, 0x3ca00000, v3
    v_cos_f32 v64, v32
    v_sin_f32 v82, v32
    s_nop 0
    v_mul_f32 v36, v18, v64
    v_fma_f32 v36, -v50, v82, v36
    v_mul_f32 v50, v50, v64
    v_fmac_f32 v50, v18, v82
    v_mul_f32 v32, 0x3ca80000, v3
    v_cos_f32 v64, v32
    v_sin_f32 v82, v32
    s_nop 0
    v_mul_f32 v18, v34, v64
    v_fma_f32 v18, -v66, v82, v18
    v_mul_f32 v66, v66, v64
    v_fmac_f32 v66, v34, v82
    v_mul_f32 v32, 0x3cb00000, v3
    v_cos_f32 v64, v32
    v_sin_f32 v82, v32
    s_nop 0
    v_mul_f32 v34, v26, v64
    v_fma_f32 v34, -v58, v82, v34
    v_mul_f32 v58, v58, v64
    v_fmac_f32 v58, v26, v82
    v_mul_f32 v32, 0x3cb80000, v3
    v_cos_f32 v64, v32
    v_sin_f32 v82, v32
    s_nop 0
    v_mul_f32 v26, v42, v64
    v_fma_f32 v26, -v74, v82, v26
    v_mul_f32 v74, v74, v64
    v_fmac_f32 v74, v42, v82
    v_mul_f32 v32, 0x3cc00000, v3
    v_cos_f32 v64, v32
    v_sin_f32 v82, v32
    s_nop 0
    v_mul_f32 v42, v17, v64
    v_fma_f32 v42, -v49, v82, v42
    v_mul_f32 v49, v49, v64
    v_fmac_f32 v49, v17, v82
    v_mul_f32 v32, 0x3cc80000, v3
    v_cos_f32 v64, v32
    v_sin_f32 v82, v32
    s_nop 0
    v_mul_f32 v17, v33, v64
    v_fma_f32 v17, -v65, v82, v17
    v_mul_f32 v65, v65, v64
    v_fmac_f32 v65, v33, v82
    v_mul_f32 v32, 0x3cd00000, v3
    v_cos_f32 v64, v32
    v_sin_f32 v82, v32
    s_nop 0
    v_mul_f32 v33, v25, v64
    v_fma_f32 v33, -v57, v82, v33
    v_mul_f32 v57, v57, v64
    v_fmac_f32 v57, v25, v82
    v_mul_f32 v32, 0x3cd80000, v3
    v_cos_f32 v64, v32
    v_sin_f32 v82, v32
    s_nop 0
    v_mul_f32 v25, v41, v64
    v_fma_f32 v25, -v73, v82, v25
    v_mul_f32 v73, v73, v64
    v_fmac_f32 v73, v41, v82
    v_mul_f32 v32, 0x3ce00000, v3
    v_cos_f32 v64, v32
    v_sin_f32 v82, v32
    s_nop 0
    v_mul_f32 v41, v21, v64
    v_fma_f32 v41, -v53, v82, v41
    v_mul_f32 v53, v53, v64
    v_fmac_f32 v53, v21, v82
    v_mul_f32 v32, 0x3ce80000, v3
    v_cos_f32 v64, v32
    v_sin_f32 v82, v32
    s_nop 0
    v_mul_f32 v21, v37, v64
    v_fma_f32 v21, -v69, v82, v21
    v_mul_f32 v69, v69, v64
    v_fmac_f32 v69, v37, v82
    v_mul_f32 v32, 0x3cf00000, v3
    v_cos_f32 v64, v32
    v_sin_f32 v82, v32
    s_nop 0
    v_mul_f32 v37, v29, v64
    v_fma_f32 v37, -v61, v82, v37
    v_mul_f32 v61, v61, v64
    v_fmac_f32 v61, v29, v82
    v_mul_f32 v32, 0x3cf80000, v3
    v_cos_f32 v64, v32
    v_sin_f32 v82, v32
    s_nop 0
    v_mul_f32 v29, v45, v64
    v_fma_f32 v29, -v77, v82, v29
    v_mul_f32 v77, v77, v64
    v_fmac_f32 v77, v45, v82
    ds_write_b32 v4, v16 offset:0
    ds_write_b32 v4, v48 offset:4
    ds_write_b32 v4, v83 offset:264
    ds_write_b32 v4, v81 offset:268
    ds_write_b32 v4, v80 offset:528
    ds_write_b32 v4, v72 offset:532
    ds_write_b32 v4, v40 offset:792
    ds_write_b32 v4, v60 offset:796
    ds_write_b32 v4, v28 offset:1056
    ds_write_b32 v4, v76 offset:1060
    ds_write_b32 v4, v44 offset:1320
    ds_write_b32 v4, v62 offset:1324
    ds_write_b32 v4, v30 offset:1584
    ds_write_b32 v4, v54 offset:1588
    ds_write_b32 v4, v22 offset:1848
    ds_write_b32 v4, v70 offset:1852
    ds_write_b32 v4, v38 offset:2112
    ds_write_b32 v4, v78 offset:2116
    ds_write_b32 v4, v46 offset:2376
    ds_write_b32 v4, v63 offset:2380
    ds_write_b32 v4, v31 offset:2640
    ds_write_b32 v4, v55 offset:2644
    ds_write_b32 v4, v23 offset:2904
    ds_write_b32 v4, v71 offset:2908
    ds_write_b32 v4, v39 offset:3168
    ds_write_b32 v4, v51 offset:3172
    ds_write_b32 v4, v19 offset:3432
    ds_write_b32 v4, v67 offset:3436
    ds_write_b32 v4, v35 offset:3696
    ds_write_b32 v4, v59 offset:3700
    ds_write_b32 v4, v27 offset:3960
    ds_write_b32 v4, v75 offset:3964
    ds_write_b32 v4, v43 offset:4224
    ds_write_b32 v4, v79 offset:4228
    ds_write_b32 v4, v47 offset:4488
    ds_write_b32 v4, v56 offset:4492
    ds_write_b32 v4, v24 offset:4752
    ds_write_b32 v4, v52 offset:4756
    ds_write_b32 v4, v20 offset:5016
    ds_write_b32 v4, v68 offset:5020
    ds_write_b32 v4, v36 offset:5280
    ds_write_b32 v4, v50 offset:5284
    ds_write_b32 v4, v18 offset:5544
    ds_write_b32 v4, v66 offset:5548
    ds_write_b32 v4, v34 offset:5808
    ds_write_b32 v4, v58 offset:5812
    ds_write_b32 v4, v26 offset:6072
    ds_write_b32 v4, v74 offset:6076
    ds_write_b32 v4, v42 offset:6336
    ds_write_b32 v4, v49 offset:6340
    ds_write_b32 v4, v17 offset:6600
    ds_write_b32 v4, v65 offset:6604
    ds_write_b32 v4, v33 offset:6864
    ds_write_b32 v4, v57 offset:6868
    ds_write_b32 v4, v25 offset:7128
    ds_write_b32 v4, v73 offset:7132
    ds_write_b32 v4, v41 offset:7392
    ds_write_b32 v4, v53 offset:7396
    ds_write_b32 v4, v21 offset:7656
    ds_write_b32 v4, v69 offset:7660
    ds_write_b32 v4, v37 offset:7920
    ds_write_b32 v4, v61 offset:7924
    ds_write_b32 v4, v29 offset:8184
    ds_write_b32 v4, v77 offset:8188
    s_waitcnt lgkmcnt(0)
    ds_read_b32 v16, v5 offset:0
    ds_read_b32 v48, v5 offset:4
    ds_read_b32 v83, v5 offset:8
    ds_read_b32 v81, v5 offset:12
    ds_read_b32 v80, v5 offset:16
    ds_read_b32 v72, v5 offset:20
    ds_read_b32 v40, v5 offset:24
    ds_read_b32 v60, v5 offset:28
    ds_read_b32 v28, v5 offset:32
    ds_read_b32 v76, v5 offset:36
    ds_read_b32 v44, v5 offset:40
    ds_read_b32 v62, v5 offset:44
    ds_read_b32 v30, v5 offset:48
    ds_read_b32 v54, v5 offset:52
    s_waitcnt lgkmcnt(0)
    ds_read_b32 v22, v5 offset:56
    ds_read_b32 v70, v5 offset:60
    ds_read_b32 v38, v5 offset:64
    ds_read_b32 v78, v5 offset:68
    ds_read_b32 v46, v5 offset:72
    ds_read_b32 v63, v5 offset:76
    ds_read_b32 v31, v5 offset:80
    ds_read_b32 v55, v5 offset:84
    ds_read_b32 v23, v5 offset:88
    ds_read_b32 v71, v5 offset:92
    ds_read_b32 v39, v5 offset:96
    ds_read_b32 v51, v5 offset:100
    ds_read_b32 v19, v5 offset:104
    ds_read_b32 v67, v5 offset:108
    s_waitcnt lgkmcnt(0)
    ds_read_b32 v35, v5 offset:112
    ds_read_b32 v59, v5 offset:116
    ds_read_b32 v27, v5 offset:120
    ds_read_b32 v75, v5 offset:124
    ds_read_b32 v43, v5 offset:128
    ds_read_b32 v79, v5 offset:132
    ds_read_b32 v47, v5 offset:136
    ds_read_b32 v56, v5 offset:140
    ds_read_b32 v24, v5 offset:144
    ds_read_b32 v52, v5 offset:148
    ds_read_b32 v20, v5 offset:152
    ds_read_b32 v68, v5 offset:156
    ds_read_b32 v36, v5 offset:160
    ds_read_b32 v50, v5 offset:164
    s_waitcnt lgkmcnt(0)
    ds_read_b32 v18, v5 offset:168
    ds_read_b32 v66, v5 offset:172
    ds_read_b32 v34, v5 offset:176
    ds_read_b32 v58, v5 offset:180
    ds_read_b32 v26, v5 offset:184
    ds_read_b32 v74, v5 offset:188
    ds_read_b32 v42, v5 offset:192
    ds_read_b32 v49, v5 offset:196
    ds_read_b32 v17, v5 offset:200
    ds_read_b32 v65, v5 offset:204
    ds_read_b32 v33, v5 offset:208
    ds_read_b32 v57, v5 offset:212
    ds_read_b32 v25, v5 offset:216
    ds_read_b32 v73, v5 offset:220
    s_waitcnt lgkmcnt(0)
    ds_read_b32 v41, v5 offset:224
    ds_read_b32 v53, v5 offset:228
    ds_read_b32 v21, v5 offset:232
    ds_read_b32 v69, v5 offset:236
    ds_read_b32 v37, v5 offset:240
    ds_read_b32 v61, v5 offset:244
    ds_read_b32 v29, v5 offset:248
    ds_read_b32 v77, v5 offset:252
    s_waitcnt lgkmcnt(0)
    v_sub_f32 v32, v16, v43
    v_sub_f32 v64, v48, v79
    v_add_f32 v16, v16, v43
    v_add_f32 v48, v48, v79
    v_sub_f32 v43, v83, v47
    v_sub_f32 v79, v81, v56
    v_add_f32 v83, v83, v47
    v_add_f32 v81, v81, v56
    v_mul_f32 v47, 0x3f7b14be, v43
    v_mul_f32 v56, 0x3e47c5c2, v43
    v_fmac_f32 v47, 0xbe47c5c2, v79
    v_fmac_f32 v56, 0x3f7b14be, v79
    v_sub_f32 v43, v80, v24
    v_sub_f32 v79, v72, v52
    v_add_f32 v80, v80, v24
    v_add_f32 v72, v72, v52
    v_mul_f32 v24, 0x3f6c835e, v43
    v_mul_f32 v52, 0x3ec3ef15, v43
    v_fmac_f32 v24, 0xbec3ef15, v79
    v_fmac_f32 v52, 0x3f6c835e, v79
    v_sub_f32 v43, v40, v20
    v_sub_f32 v79, v60, v68
    v_add_f32 v40, v40, v20
    v_add_f32 v60, v60, v68
    v_mul_f32 v20, 0x3f54db31, v43
    v_mul_f32 v68, 0x3f0e39da, v43
    v_fmac_f32 v20, 0xbf0e39da, v79
    v_fmac_f32 v68, 0x3f54db31, v79
    v_sub_f32 v43, v28, v36
    v_sub_f32 v79, v76, v50
    v_add_f32 v28, v28, v36
    v_add_f32 v76, v76, v50
    v_mul_f32 v36, 0x3f3504f3, v43
    v_mul_f32 v50, 0x3f3504f3, v43
    v_fmac_f32 v36, 0xbf3504f3, v79
    v_fmac_f32 v50, 0x3f3504f3, v79
    v_sub_f32 v43, v44, v18
    v_sub_f32 v79, v62, v66
    v_add_f32 v44, v44, v18
    v_add_f32 v62, v62, v66
    v_mul_f32 v18, 0x3f0e39da, v43
    v_mul_f32 v66, 0x3f54db31, v43
    v_fmac_f32 v18, 0xbf54db31, v79
    v_fmac_f32 v66, 0x3f0e39da, v79
    v_sub_f32 v43, v30, v34
    v_sub_f32 v79, v54, v58
    v_add_f32 v30, v30, v34
    v_add_f32 v54, v54, v58
    v_mul_f32 v34, 0x3ec3ef15, v43
    v_mul_f32 v58, 0x3f6c835e, v43
    v_fmac_f32 v34, 0xbf6c835e, v79
    v_fmac_f32 v58, 0x3ec3ef15, v79
    v_sub_f32 v43, v22, v26
    v_sub_f32 v79, v70, v74
    v_add_f32 v22, v22, v26
    v_add_f32 v70, v70, v74
    v_mul_f32 v26, 0x3e47c5c2, v43
    v_mul_f32 v74, 0x3f7b14be, v43
    v_fmac_f32 v26, 0xbf7b14be, v79
    v_fmac_f32 v74, 0x3e47c5c2, v79
    v_sub_f32 v43, v49, v78
    v_sub_f32 v79, v38, v42
    v_add_f32 v38, v38, v42
    v_add_f32 v78, v78, v49
    v_sub_f32 v42, v46, v17
    v_sub_f32 v49, v63, v65
    v_add_f32 v46, v46, v17
    v_add_f32 v63, v63, v65
    v_mul_f32 v17, 0xbe47c5c2, v42
    v_mul_f32 v65, 0x3f7b14be, v42
    v_fmac_f32 v17, 0xbf7b14be, v49
    v_fmac_f32 v65, 0xbe47c5c2, v49
    v_sub_f32 v42, v31, v33
    v_sub_f32 v49, v55, v57
    v_add_f32 v31, v31, v33
    v_add_f32 v55, v55, v57
    v_mul_f32 v33, 0xbec3ef15, v42
    v_mul_f32 v57, 0x3f6c835e, v42
    v_fmac_f32 v33, 0xbf6c835e, v49
    v_fmac_f32 v57, 0xbec3ef15, v49
    v_sub_f32 v42, v23, v25
    v_sub_f32 v49, v71, v73
    v_add_f32 v23, v23, v25
    v_add_f32 v71, v71, v73
    v_mul_f32 v25, 0xbf0e39da, v42
    v_mul_f32 v73, 0x3f54db31, v42
    v_fmac_f32 v25, 0xbf54db31, v49
    v_fmac_f32 v73, 0xbf0e39da, v49
    v_sub_f32 v42, v39, v41
    v_sub_f32 v49, v51, v53
    v_add_f32 v39, v39, v41
    v_add_f32 v51, v51, v53
    v_mul_f32 v41, 0xbf3504f3, v42
    v_mul_f32 v53, 0x3f3504f3, v42
    v_fmac_f32 v41, 0xbf3504f3, v49
    v_fmac_f32 v53, 0xbf3504f3, v49
    v_sub_f32 v42, v19, v21
    v_sub_f32 v49, v67, v69
    v_add_f32 v19, v19, v21
    v_add_f32 v67, v67, v69
    v_mul_f32 v21, 0xbf54db31, v42
    v_mul_f32 v69, 0x3f0e39da, v42
    v_fmac_f32 v21, 0xbf0e39da, v49
    v_fmac_f32 v69, 0xbf54db31, v49
    v_sub_f32 v42, v35, v37
    v_sub_f32 v49, v59, v61
    v_add_f32 v35, v35, v37
    v_add_f32 v59, v59, v61
    v_mul_f32 v37, 0xbf6c835e, v42
    v_mul_f32 v61, 0x3ec3ef15, v42
    v_fmac_f32 v37, 0xbec3ef15, v49
    v_fmac_f32 v61, 0xbf6c835e, v49
    v_sub_f32 v42, v27, v29
    v_sub_f32 v49, v75, v77
    v_add_f32 v27, v27, v29
    v_add_f32 v75, v75, v77
    v_mul_f32 v29, 0xbf7b14be, v42
    v_mul_f32 v77, 0x3e47c5c2, v42
    v_fmac_f32 v29, 0xbe47c5c2, v49
    v_fmac_f32 v77, 0xbf7b14be, v49
    v_sub_f32 v42, v16, v38
    v_sub_f32 v49, v48, v78
    v_add_f32 v16, v16, v38
    v_add_f32 v48, v48, v78
    v_sub_f32 v38, v83, v46
    v_sub_f32 v78, v81, v63
    v_add_f32 v83, v83, v46
    v_add_f32 v81, v81, v63
    v_mul_f32 v46, 0x3f6c835e, v38
    v_mul_f32 v63, 0x3ec3ef15, v38
    v_fmac_f32 v46, 0xbec3ef15, v78
    v_fmac_f32 v63, 0x3f6c835e, v78
    v_sub_f32 v38, v80, v31
    v_sub_f32 v78, v72, v55
    v_add_f32 v80, v80, v31
    v_add_f32 v72, v72, v55
    v_mul_f32 v31, 0x3f3504f3, v38
    v_mul_f32 v55, 0x3f3504f3, v38
    v_fmac_f32 v31, 0xbf3504f3, v78
    v_fmac_f32 v55, 0x3f3504f3, v78
    v_sub_f32 v38, v40, v23
    v_sub_f32 v78, v60, v71
    v_add_f32 v40, v40, v23
    v_add_f32 v60, v60, v71
    v_mul_f32 v23, 0x3ec3ef15, v38
    v_mul_f32 v71, 0x3f6c835e, v38
    v_fmac_f32 v23, 0xbf6c835e, v78
    v_fmac_f32 v71, 0x3ec3ef15, v78
    v_sub_f32 v38, v51, v76
    v_sub_f32 v78, v28, v39
    v_add_f32 v28, v28, v39
    v_add_f32 v76, v76, v51
    v_sub_f32 v39, v44, v19
    v_sub_f32 v51, v62, v67
    v_add_f32 v44, v44, v19
    v_add_f32 v62, v62, v67
    v_mul_f32 v19, 0xbec3ef15, v39
    v_mul_f32 v67, 0x3f6c835e, v39
    v_fmac_f32 v19, 0xbf6c835e, v51
    v_fmac_f32 v67, 0xbec3ef15, v51
    v_sub_f32 v39, v30, v35
    v_sub_f32 v51, v54, v59
    v_add_f32 v30, v30, v35
    v_add_f32 v54, v54, v59
    v_mul_f32 v35, 0xbf3504f3, v39
    v_mul_f32 v59, 0x3f3504f3, v39
    v_fmac_f32 v35, 0xbf3504f3, v51
    v_fmac_f32 v59, 0xbf3504f3, v51
    v_sub_f32 v39, v22, v27
    v_sub_f32 v51, v70, v75
    v_add_f32 v22, v22, v27
    v_add_f32 v70, v70, v75
    v_mul_f32 v27, 0xbf6c835e, v39
    v_mul_f32 v75, 0x3ec3ef15, v39
    v_fmac_f32 v27, 0xbec3ef15, v51
    v_fmac_f32 v75, 0xbf6c835e, v51
    v_sub_f32 v39, v32, v43
    v_sub_f32 v51, v64, v79
    v_add_f32 v32, v32, v43
    v_add_f32 v64, v64, v79
    v_sub_f32 v43, v47, v17
    v_sub_f32 v79, v56, v65
    v_add_f32 v47, v47, v17
    v_add_f32 v56, v56, v65
    v_mul_f32 v17, 0x3f6c835e, v43
    v_mul_f32 v65, 0x3ec3ef15, v43
    v_fmac_f32 v17, 0xbec3ef15, v79
    v_fmac_f32 v65, 0x3f6c835e, v79
    v_sub_f32 v43, v24, v33
    v_sub_f32 v79, v52, v57
    v_add_f32 v24, v24, v33
    v_add_f32 v52, v52, v57
    v_mul_f32 v33, 0x3f3504f3, v43
    v_mul_f32 v57, 0x3f3504f3, v43
    v_fmac_f32 v33, 0xbf3504f3, v79
    v_fmac_f32 v57, 0x3f3504f3, v79
    v_sub_f32 v43, v20, v25
    v_sub_f32 v79, v68, v73
    v_add_f32 v20, v20, v25
    v_add_f32 v68, v68, v73
    v_mul_f32 v25, 0x3ec3ef15, v43
    v_mul_f32 v73, 0x3f6c835e, v43
    v_fmac_f32 v25, 0xbf6c835e, v79
    v_fmac_f32 v73, 0x3ec3ef15, v79
    v_sub_f32 v43, v53, v50
    v_sub_f32 v79, v36, v41
    v_add_f32 v36, v36, v41
    v_add_f32 v50, v50, v53
    v_sub_f32 v41, v18, v21
    v_sub_f32 v53, v66, v69
    v_add_f32 v18, v18, v21
    v_add_f32 v66, v66, v69
    v_mul_f32 v21, 0xbec3ef15, v41
    v_mul_f32 v69, 0x3f6c835e, v41
    v_fmac_f32 v21, 0xbf6c835e, v53
    v_fmac_f32 v69, 0xbec3ef15, v53
    v_sub_f32 v41, v34, v37
    v_sub_f32 v53, v58, v61
    v_add_f32 v34, v34, v37
    v_add_f32 v58, v58, v61
    v_mul_f32 v37, 0xbf3504f3, v41
    v_mul_f32 v61, 0x3f3504f3, v41
    v_fmac_f32 v37, 0xbf3504f3, v53
    v_fmac_f32 v61, 0xbf3504f3, v53
    v_sub_f32 v41, v26, v29
    v_sub_f32 v53, v74, v77
    v_add_f32 v26, v26, v29
    v_add_f32 v74, v74, v77
    v_mul_f32 v29, 0xbf6c835e, v41
    v_mul_f32 v77, 0x3ec3ef15, v41
    v_fmac_f32 v29, 0xbec3ef15, v53
    v_fmac_f32 v77, 0xbf6c835e, v53
    v_sub_f32 v41, v16, v28
    v_sub_f32 v53, v48, v76
    v_add_f32 v16, v16, v28
    v_add_f32 v48, v48, v76
    v_sub_f32 v28, v83, v44
    v_sub_f32 v76, v81, v62
    v_add_f32 v83, v83, v44
    v_add_f32 v81, v81, v62
    v_mul_f32 v44, 0x3f3504f3, v28
    v_mul_f32 v62, 0x3f3504f3, v28
    v_fmac_f32 v44, 0xbf3504f3, v76
    v_fmac_f32 v62, 0x3f3504f3, v76
    v_sub_f32 v28, v54, v72
    v_sub_f32 v76, v80, v30
    v_add_f32 v80, v80, v30
    v_add_f32 v72, v72, v54
    v_sub_f32 v30, v40, v22
    v_sub_f32 v54, v60, v70
    v_add_f32 v40, v40, v22
    v_add_f32 v60, v60, v70
    v_mul_f32 v22, 0xbf3504f3, v30
    v_mul_f32 v70, 0x3f3504f3, v30
    v_fmac_f32 v22, 0xbf3504f3, v54
    v_fmac_f32 v70, 0xbf3504f3, v54
    v_sub_f32 v30, v42, v38
    v_sub_f32 v54, v49, v78
    v_add_f32 v42, v42, v38
    v_add_f32 v49, v49, v78
    v_sub_f32 v38, v46, v19
    v_sub_f32 v78, v63, v67
    v_add_f32 v46, v46, v19
    v_add_f32 v63, v63, v67
    v_mul_f32 v19, 0x3f3504f3, v38
    v_mul_f32 v67, 0x3f3504f3, v38
    v_fmac_f32 v19, 0xbf3504f3, v78
    v_fmac_f32 v67, 0x3f3504f3, v78
    v_sub_f32 v38, v59, v55
    v_sub_f32 v78, v31, v35
    v_add_f32 v31, v31, v35
    v_add_f32 v55, v55, v59
    v_sub_f32 v35, v23, v27
    v_sub_f32 v59, v71, v75
    v_add_f32 v23, v23, v27
    v_add_f32 v71, v71, v75
    v_mul_f32 v27, 0xbf3504f3, v35
    v_mul_f32 v75, 0x3f3504f3, v35
    v_fmac_f32 v27, 0xbf3504f3, v59
    v_fmac_f32 v75, 0xbf3504f3, v59
    v_sub_f32 v35, v32, v36
    v_sub_f32 v59, v64, v50
    v_add_f32 v32, v32, v36
    v_add_f32 v64, v64, v50
    v_sub_f32 v36, v47, v18
    v_sub_f32 v50, v56, v66
    v_add_f32 v47, v47, v18
    v_add_f32 v56, v56, v66
    v_mul_f32 v18, 0x3f3504f3, v36
    v_mul_f32 v66, 0x3f3504f3, v36
    v_fmac_f32 v18, 0xbf3504f3, v50
    v_fmac_f32 v66, 0x3f3504f3, v50
    v_sub_f32 v36, v58, v52
    v_sub_f32 v50, v24, v34
    v_add_f32 v24, v24, v34
    v_add_f32 v52, v52, v58
    v_sub_f32 v34, v20, v26
    v_sub_f32 v58, v68, v74
    v_add_f32 v20, v20, v26
    v_add_f32 v68, v68, v74
    v_mul_f32 v26, 0xbf3504f3, v34
    v_mul_f32 v74, 0x3f3504f3, v34
    v_fmac_f32 v26, 0xbf3504f3, v58
    v_fmac_f32 v74, 0xbf3504f3, v58
    v_sub_f32 v34, v39, v43
    v_sub_f32 v58, v51, v79
    v_add_f32 v39, v39, v43
    v_add_f32 v51, v51, v79
    v_sub_f32 v43, v17, v21
    v_sub_f32 v79, v65, v69
    v_add_f32 v17, v17, v21
    v_add_f32 v65, v65, v69
    v_mul_f32 v21, 0x3f3504f3, v43
    v_mul_f32 v69, 0x3f3504f3, v43
    v_fmac_f32 v21, 0xbf3504f3, v79
    v_fmac_f32 v69, 0x3f3504f3, v79
    v_sub_f32 v43, v61, v57
    v_sub_f32 v79, v33, v37
    v_add_f32 v33, v33, v37
    v_add_f32 v57, v57, v61
    v_sub_f32 v37, v25, v29
    v_sub_f32 v61, v73, v77
    v_add_f32 v25, v25, v29
    v_add_f32 v73, v73, v77
    v_mul_f32 v29, 0xbf3504f3, v37
    v_mul_f32 v77, 0x3f3504f3, v37
    v_fmac_f32 v29, 0xbf3504f3, v61
    v_fmac_f32 v77, 0xbf3504f3, v61
    v_sub_f32 v37, v16, v80
    v_sub_f32 v61, v48, v72
    v_add_f32 v16, v16, v80
    v_add_f32 v48, v48, v72
    v_sub_f32 v80, v60, v81
    v_sub_f32 v72, v83, v40
    v_add_f32 v83, v83, v40
    v_add_f32 v81, v81, v60
    v_sub_f32 v40, v41, v28
    v_sub_f32 v60, v53, v76
    v_add_f32 v41, v41, v28
    v_add_f32 v53, v53, v76
    v_sub_f32 v28, v70, v62
    v_sub_f32 v76, v44, v22
    v_add_f32 v44, v44, v22
    v_add_f32 v62, v62, v70
    v_sub_f32 v22, v42, v31
    v_sub_f32 v70, v49, v55
    v_add_f32 v42, v42, v31
    v_add_f32 v49, v49, v55
    v_sub_f32 v31, v71, v63
    v_sub_f32 v55, v46, v23
    v_add_f32 v46, v46, v23
    v_add_f32 v63, v63, v71
    v_sub_f32 v23, v30, v38
    v_sub_f32 v71, v54, v78
    v_add_f32 v30, v30, v38
    v_add_f32 v54, v54, v78
    v_sub_f32 v38, v75, v67
    v_sub_f32 v78, v19, v27
    v_add_f32 v19, v19, v27
    v_add_f32 v67, v67, v75
    v_sub_f32 v27, v32, v24
    v_sub_f32 v75, v64, v52
    v_add_f32 v32, v32, v24
    v_add_f32 v64, v64, v52
    v_sub_f32 v24, v68, v56
    v_sub_f32 v52, v47, v20
    v_add_f32 v47, v47, v20
    v_add_f32 v56, v56, v68
    v_sub_f32 v20, v35, v36
    v_sub_f32 v68, v59, v50
    v_add_f32 v35, v35, v36
    v_add_f32 v59, v59, v50
    v_sub_f32 v36, v74, v66
    v_sub_f32 v50, v18, v26
    v_add_f32 v18, v18, v26
    v_add_f32 v66, v66, v74
    v_sub_f32 v26, v39, v33
    v_sub_f32 v74, v51, v57
    v_add_f32 v39, v39, v33
    v_add_f32 v51, v51, v57
    v_sub_f32 v33, v73, v65
    v_sub_f32 v57, v17, v25
    v_add_f32 v17, v17, v25
    v_add_f32 v65, v65, v73
    v_sub_f32 v25, v34, v43
    v_sub_f32 v73, v58, v79
    v_add_f32 v34, v34, v43
    v_add_f32 v58, v58, v79
    v_sub_f32 v43, v77, v69
    v_sub_f32 v79, v21, v29
    v_add_f32 v21, v21, v29
    v_add_f32 v69, v69, v77
    v_sub_f32 v29, v16, v83
    v_sub_f32 v77, v48, v81
    v_add_f32 v16, v16, v83
    v_add_f32 v48, v48, v81
    v_sub_f32 v83, v37, v80
    v_sub_f32 v81, v61, v72
    v_add_f32 v37, v37, v80
    v_add_f32 v61, v61, v72
    v_sub_f32 v80, v41, v44
    v_sub_f32 v72, v53, v62
    v_add_f32 v41, v41, v44
    v_add_f32 v53, v53, v62
    v_sub_f32 v44, v40, v28
    v_sub_f32 v62, v60, v76
    v_add_f32 v40, v40, v28
    v_add_f32 v60, v60, v76
    v_sub_f32 v28, v42, v46
    v_sub_f32 v76, v49, v63
    v_add_f32 v42, v42, v46
    v_add_f32 v49, v49, v63
    v_sub_f32 v46, v22, v31
    v_sub_f32 v63, v70, v55
    v_add_f32 v22, v22, v31
    v_add_f32 v70, v70, v55
    v_sub_f32 v31, v30, v19
    v_sub_f32 v55, v54, v67
    v_add_f32 v30, v30, v19
    v_add_f32 v54, v54, v67
    v_sub_f32 v19, v23, v38
    v_sub_f32 v67, v71, v78
    v_add_f32 v23, v23, v38
    v_add_f32 v71, v71, v78
    v_sub_f32 v38, v32, v47
    v_sub_f32 v78, v64, v56
    v_add_f32 v32, v32, v47
    v_add_f32 v64, v64, v56
    v_sub_f32 v47, v27, v24
    v_sub_f32 v56, v75, v52
    v_add_f32 v27, v27, v24
    v_add_f32 v75, v75, v52
    v_sub_f32 v24, v35, v18
    v_sub_f32 v52, v59, v66
    v_add_f32 v35, v35, v18
    v_add_f32 v59, v59, v66
    v_sub_f32 v18, v20, v36
    v_sub_f32 v66, v68, v50
    v_add_f32 v20, v20, v36
    v_add_f32 v68, v68, v50
    v_sub_f32 v36, v39, v17
    v_sub_f32 v50, v51, v65
    v_add_f32 v39, v39, v17
    v_add_f32 v51, v51, v65
    v_sub_f32 v17, v26, v33
    v_sub_f32 v65, v74, v57
    v_add_f32 v26, v26, v33
    v_add_f32 v74, v74, v57
    v_sub_f32 v33, v34, v21
    v_sub_f32 v57, v58, v69
    v_add_f32 v34, v34, v21
    v_add_f32 v58, v58, v69
    v_sub_f32 v21, v25, v43
    v_sub_f32 v69, v73, v79
    v_add_f32 v25, v25, v43
    v_add_f32 v73, v73, v79
    v_lshl_add_u32 v6, v1, 2, v7
    ds_write_b32 v6, v16 offset:0
    ds_write_b32 v6, v48 offset:4096
    ds_write_b32 v6, v32 offset:128
    ds_write_b32 v6, v64 offset:4224
    ds_write_b32 v6, v42 offset:256
    ds_write_b32 v6, v49 offset:4352
    ds_write_b32 v6, v39 offset:384
    ds_write_b32 v6, v51 offset:4480
    ds_write_b32 v6, v41 offset:512
    ds_write_b32 v6, v53 offset:4608
    ds_write_b32 v6, v35 offset:640
    ds_write_b32 v6, v59 offset:4736
    ds_write_b32 v6, v30 offset:768
    ds_write_b32 v6, v54 offset:4864
    ds_write_b32 v6, v34 offset:896
    ds_write_b32 v6, v58 offset:4992
    ds_write_b32 v6, v37 offset:1024
    ds_write_b32 v6, v61 offset:5120
    ds_write_b32 v6, v27 offset:1152
    ds_write_b32 v6, v75 offset:5248
    ds_write_b32 v6, v22 offset:1280
    ds_write_b32 v6, v70 offset:5376
    ds_write_b32 v6, v26 offset:1408
    ds_write_b32 v6, v74 offset:5504
    ds_write_b32 v6, v40 offset:1536
    ds_write_b32 v6, v60 offset:5632
    ds_write_b32 v6, v20 offset:1664
    ds_write_b32 v6, v68 offset:5760
    ds_write_b32 v6, v23 offset:1792
    ds_write_b32 v6, v71 offset:5888
    ds_write_b32 v6, v25 offset:1920
    ds_write_b32 v6, v73 offset:6016
    ds_write_b32 v6, v29 offset:2048
    ds_write_b32 v6, v77 offset:6144
    ds_write_b32 v6, v38 offset:2176
    ds_write_b32 v6, v78 offset:6272
    ds_write_b32 v6, v28 offset:2304
    ds_write_b32 v6, v76 offset:6400
    ds_write_b32 v6, v36 offset:2432
    ds_write_b32 v6, v50 offset:6528
    ds_write_b32 v6, v80 offset:2560
    ds_write_b32 v6, v72 offset:6656
    ds_write_b32 v6, v24 offset:2688
    ds_write_b32 v6, v52 offset:6784
    ds_write_b32 v6, v31 offset:2816
    ds_write_b32 v6, v55 offset:6912
    ds_write_b32 v6, v33 offset:2944
    ds_write_b32 v6, v57 offset:7040
    ds_write_b32 v6, v83 offset:3072
    ds_write_b32 v6, v81 offset:7168
    ds_write_b32 v6, v47 offset:3200
    ds_write_b32 v6, v56 offset:7296
    ds_write_b32 v6, v46 offset:3328
    ds_write_b32 v6, v63 offset:7424
    ds_write_b32 v6, v17 offset:3456
    ds_write_b32 v6, v65 offset:7552
    ds_write_b32 v6, v44 offset:3584
    ds_write_b32 v6, v62 offset:7680
    ds_write_b32 v6, v18 offset:3712
    ds_write_b32 v6, v66 offset:7808
    ds_write_b32 v6, v19 offset:3840
    ds_write_b32 v6, v67 offset:7936
    ds_write_b32 v6, v21 offset:3968
    ds_write_b32 v6, v69 offset:8064
    s_waitcnt lgkmcnt(0)
    s_barrier
    v_and_b32 v6, 127, v0
    v_lshrrev_b32 v7, 7, v0
    v_lshlrev_b32 v8, 5, v6
    v_lshl_add_u32 v8, v7, 12, v8
    v_lshlrev_b32 v5, 4, v6
    v_lshl_add_u32 v5, v7, 12, v5
    v_add_u32 v5, 2048, v5
    s_lshl_b32 s12, s92, 16
    ds_read_b128 v[16:19], v8 offset:0
    ds_read_b128 v[20:23], v8 offset:16
    s_waitcnt lgkmcnt(0)
    v_cvt_pk_bf16_f32 v24, v16, v17
    v_cvt_pk_bf16_f32 v25, v18, v19
    v_cvt_pk_bf16_f32 v26, v20, v21
    v_cvt_pk_bf16_f32 v27, v22, v23
    s_add_u32 s13, s12, 0
    buffer_store_dwordx4 v[24:27], v5, s[4:7], s13 offen
    s_nop 1
    ds_read_b128 v[16:19], v8 offset:8448
    ds_read_b128 v[20:23], v8 offset:8464
    s_waitcnt lgkmcnt(0)
    v_cvt_pk_bf16_f32 v24, v16, v17
    v_cvt_pk_bf16_f32 v25, v18, v19
    v_cvt_pk_bf16_f32 v26, v20, v21
    v_cvt_pk_bf16_f32 v27, v22, v23
    s_add_u32 s13, s12, 8192
    buffer_store_dwordx4 v[24:27], v5, s[4:7], s13 offen
    s_nop 1
    ds_read_b128 v[16:19], v8 offset:16896
    ds_read_b128 v[20:23], v8 offset:16912
    s_waitcnt lgkmcnt(0)
    v_cvt_pk_bf16_f32 v24, v16, v17
    v_cvt_pk_bf16_f32 v25, v18, v19
    v_cvt_pk_bf16_f32 v26, v20, v21
    v_cvt_pk_bf16_f32 v27, v22, v23
    s_add_u32 s13, s12, 16384
    buffer_store_dwordx4 v[24:27], v5, s[4:7], s13 offen
    s_nop 1
    ds_read_b128 v[16:19], v8 offset:25344
    ds_read_b128 v[20:23], v8 offset:25360
    s_waitcnt lgkmcnt(0)
    v_cvt_pk_bf16_f32 v24, v16, v17
    v_cvt_pk_bf16_f32 v25, v18, v19
    v_cvt_pk_bf16_f32 v26, v20, v21
    v_cvt_pk_bf16_f32 v27, v22, v23
    s_add_u32 s13, s12, 24576
    buffer_store_dwordx4 v[24:27], v5, s[4:7], s13 offen
    s_nop 1
    ds_read_b128 v[16:19], v8 offset:33792
    ds_read_b128 v[20:23], v8 offset:33808
    s_waitcnt lgkmcnt(0)
    v_cvt_pk_bf16_f32 v24, v16, v17
    v_cvt_pk_bf16_f32 v25, v18, v19
    v_cvt_pk_bf16_f32 v26, v20, v21
    v_cvt_pk_bf16_f32 v27, v22, v23
    s_add_u32 s13, s12, 32768
    buffer_store_dwordx4 v[24:27], v5, s[4:7], s13 offen
    s_nop 1
    ds_read_b128 v[16:19], v8 offset:42240
    ds_read_b128 v[20:23], v8 offset:42256
    s_waitcnt lgkmcnt(0)
    v_cvt_pk_bf16_f32 v24, v16, v17
    v_cvt_pk_bf16_f32 v25, v18, v19
    v_cvt_pk_bf16_f32 v26, v20, v21
    v_cvt_pk_bf16_f32 v27, v22, v23
    s_add_u32 s13, s12, 40960
    buffer_store_dwordx4 v[24:27], v5, s[4:7], s13 offen
    s_nop 1
    ds_read_b128 v[16:19], v8 offset:50688
    ds_read_b128 v[20:23], v8 offset:50704
    s_waitcnt lgkmcnt(0)
    v_cvt_pk_bf16_f32 v24, v16, v17
    v_cvt_pk_bf16_f32 v25, v18, v19
    v_cvt_pk_bf16_f32 v26, v20, v21
    v_cvt_pk_bf16_f32 v27, v22, v23
    s_add_u32 s13, s12, 49152
    buffer_store_dwordx4 v[24:27], v5, s[4:7], s13 offen
    s_nop 1
    ds_read_b128 v[16:19], v8 offset:59136
    ds_read_b128 v[20:23], v8 offset:59152
    s_waitcnt lgkmcnt(0)
    v_cvt_pk_bf16_f32 v24, v16, v17
    v_cvt_pk_bf16_f32 v25, v18, v19
    v_cvt_pk_bf16_f32 v26, v20, v21
    v_cvt_pk_bf16_f32 v27, v22, v23
    s_add_u32 s13, s12, 57344
    buffer_store_dwordx4 v[24:27], v5, s[4:7], s13 offen
    s_nop 1
mega_kernel_xo4:
    s_waitcnt vmcnt(0)
    ds_read_b64_tr_b16 a[192:193], v201 offset:0
    ds_read_b64_tr_b16 a[194:195], v201 offset:256
    ds_read_b64_tr_b16 a[196:197], v201 offset:1024
    ds_read_b64_tr_b16 a[198:199], v201 offset:1280
    ds_read_b64_tr_b16 a[200:201], v201 offset:2048
    ds_read_b64_tr_b16 a[202:203], v201 offset:2304
    ds_read_b64_tr_b16 a[204:205], v201 offset:3072
    ds_read_b64_tr_b16 a[206:207], v201 offset:3328
    s_waitcnt lgkmcnt(0)
    ds_read_b64_tr_b16 a[208:209], v201 offset:4096
    ds_read_b64_tr_b16 a[210:211], v201 offset:4352
    ds_read_b64_tr_b16 a[212:213], v201 offset:5120
    ds_read_b64_tr_b16 a[214:215], v201 offset:5376
    ds_read_b64_tr_b16 a[216:217], v201 offset:6144
    ds_read_b64_tr_b16 a[218:219], v201 offset:6400
    ds_read_b64_tr_b16 a[220:221], v201 offset:7168
    ds_read_b64_tr_b16 a[222:223], v201 offset:7424
    s_waitcnt lgkmcnt(0)
    ds_read_b64_tr_b16 a[224:225], v201 offset:8192
    ds_read_b64_tr_b16 a[226:227], v201 offset:8448
    ds_read_b64_tr_b16 a[228:229], v201 offset:9216
    ds_read_b64_tr_b16 a[230:231], v201 offset:9472
    ds_read_b64_tr_b16 a[232:233], v201 offset:10240
    ds_read_b64_tr_b16 a[234:235], v201 offset:10496
    ds_read_b64_tr_b16 a[236:237], v201 offset:11264
    ds_read_b64_tr_b16 a[238:239], v201 offset:11520
    s_waitcnt lgkmcnt(0)
    ds_read_b64_tr_b16 a[240:241], v201 offset:12288
    ds_read_b64_tr_b16 a[242:243], v201 offset:12544
    ds_read_b64_tr_b16 a[244:245], v201 offset:13312
    ds_read_b64_tr_b16 a[246:247], v201 offset:13568
    ds_read_b64_tr_b16 a[248:249], v201 offset:14336
    ds_read_b64_tr_b16 a[250:251], v201 offset:14592
    ds_read_b64_tr_b16 a[252:253], v201 offset:15360
    ds_read_b64_tr_b16 a[254:255], v201 offset:15616
    s_waitcnt lgkmcnt(0)
    s_load_dwordx2 s[8:9], s[0:1], 40
    s_load_dwordx2 s[12:13], s[0:1], 80
    v_lshrrev_b32 v3, 6, v0
    v_and_b32 v1, 63, v0
    v_readfirstlane_b32 s16, v3
    s_lshr_b32 s17, s92, 5
    s_and_b32 s18, s92, 31
    v_lshlrev_b32 v2, 4, v1
    s_waitcnt lgkmcnt(0)
    s_mov_b32 s10, 8388608
    s_mov_b32 s11, 0x00020000
    s_mov_b32 s14, 8388608
    s_mov_b32 s15, 0x00020000
    s_mov_b32 s24, 0x3e0293ee
    s_mov_b64 s[60:61], 0
    s_lshr_b32 s50, s18, 1
    s_lshl_b32 s50, s50, 12
    s_lshl_b32 s47, s17, 2
    s_add_u32 s20, s47, s16
    s_lshl_b32 s20, s20, 18
    s_lshl_b32 s21, s18, 13
    s_add_u32 s20, s20, s21
    s_add_u32 s20, s20, 50331648
    v_lshlrev_b32 v26, 7, v1
    buffer_load_dword v28, v26, s[84:87], s20 offen sc1
    v_and_b32 v4, 15, v1
    v_lshrrev_b32 v5, 4, v1
    v_lshrrev_b32 v3, 2, v4
    v_lshlrev_b32 v3, 1, v3
    v_and_b32 v26, 1, v4
    v_add_u32 v3, v3, v26
    v_lshlrev_b32 v6, 8, v3
    v_lshl_add_u32 v6, v5, 4, v6
    s_lshr_b32 s20, s16, 1
    s_lshl_b32 s20, s20, 10
    s_add_u32 s20, s20, 2048
    v_lshlrev_b32 v7, 3, v1
    v_add_u32 v7, s20, v7
    v_lshlrev_b32 v8, 9, v5
    v_lshl_add_u32 v8, v4, 4, v8
    s_lshr_b32 s20, s16, 1
    s_lshl_b32 s20, s20, 12
    s_and_b32 s21, s16, 1
    s_lshl_b32 s21, s21, 8
    s_add_u32 s20, s20, s21
    v_add_u32 v8, s20, v8
    v_lshlrev_b32 v19, 4, v4
    v_and_b32 v26, 1, v5
    v_lshl_add_u32 v19, v26, 10, v19
    v_lshrrev_b32 v26, 1, v5
    v_lshl_add_u32 v19, v26, 9, v19
    s_and_b32 s20, s17, 1
    s_lshl_b32 s20, s20, 8
    v_add_u32 v19, s20, v19
    v_lshlrev_b32 v26, 2, v5
    v_sub_u32 v9, v4, v26
    s_lshr_b32 s21, s21, 4
    v_add_u32 v9, s21, v9
    v_add_u32 v10, -16, v9
    v_mov_b32 v11, 0xff7fffff
    v_mov_b32 v20, 0x3f803f80
    v_mov_b32 v21, 0x3f803f80
    v_mov_b32 v22, 0x3f803f80
    v_mov_b32 v23, 0x3f803f80
    v_bfe_u32 v26, v1, 1, 2
    v_min_u32 v26, 2, v26
    s_lshl_b32 s20, s18, 8
    s_add_u32 s20, s20, 71303168
    v_lshlrev_b32 v12, 13, v26
    v_and_b32 v26, 1, v1
    v_lshl_add_u32 v12, v26, 7, v12
    v_add_u32 v12, s20, v12
    v_and_b32 v26, 1, v1
    v_lshlrev_b32 v13, 7, v26
    s_add_u32 s20, s20, 24576
    v_add_u32 v13, s20, v13
    v_and_b32 v26, 7, v1
    s_lshl_b32 s20, s17, 5
    s_lshl_b32 s21, s16, 3
    s_add_u32 s20, s20, s21
    v_add_u32 v26, s20, v26
    v_lshlrev_b32 v14, 7, v26
    v_add_u32 v14, 71335936, v14
    v_bfrev_b32 v26, 1
    s_lshl_b32 s20, s92, 7
    s_add_u32 s20, s20, 71335936
    v_mov_b32 v27, s20
    v_cmp_eq_u32 vcc, 0, v0
    s_lshl_b32 s20, s16, 12
    v_add_u32 v17, s20, v2
    v_cndmask_b32 v15, v26, v27, vcc
    v_lshrrev_b32 v26, 3, v0
    v_and_b32 v27, 1, v0
    v_lshl_add_u32 v27, v27, 5, v26
    v_lshlrev_b32 v16, 4, v27
    v_bfe_u32 v27, v0, 1, 2
    v_lshl_add_u32 v16, v27, 10, v16
    v_lshlrev_b32 v18, 12, v26
    v_and_b32 v27, 7, v0
    v_lshl_add_u32 v18, v27, 3, v18
    s_lshl_b32 s20, s18, 6
    v_add_u32 v18, s20, v18
    s_barrier
    s_cmp_eq_u32 s17, 0
    s_cselect_b32 s60, 0x82082080, s60
    s_cselect_b32 s61, 0x88420820, s61
    s_cmp_eq_u32 s17, 1
    s_cselect_b32 s60, 0x4104100, s60
    s_cselect_b32 s61, 0x88841041, s61
    s_cmp_eq_u32 s17, 2
    s_cselect_b32 s60, 0x10410400, s60
    s_cselect_b32 s61, 0x24104104, s61
    s_cmp_eq_u32 s17, 3
    s_cselect_b32 s60, 0x20820800, s60
    s_cselect_b32 s61, 0x24208208, s61
    s_cmp_eq_u32 s17, 4
    s_cselect_b32 s60, 0x820822b, s60
    s_cselect_b32 s61, 0x51082082, s61
    s_cmp_eq_u32 s17, 5
    s_cselect_b32 s60, 0x41041054, s60
    s_cselect_b32 s61, 0x52010410, s61
    s_ff1_i32_b64 s22, s[60:61]
mega_kernel_x_gp:
    buffer_load_dword v3, v12, s[84:87], 0 offen sc1
    s_waitcnt vmcnt(0)
    v_cmp_ne_u32 vcc, 32, v3
    s_cbranch_vccz mega_kernel_x_gk
    s_sleep 8
    s_branch mega_kernel_x_gp
mega_kernel_x_gk:
    s_mov_b32 s46, 0
    s_lshl_b32 s27, s22, 18
    s_lshl_b32 s20, s18, 13
    s_add_u32 s27, s27, s20
    s_add_u32 s29, s27, 178257920
    s_and_b32 s20, s16, 1
    s_lshl_b32 s20, s20, 10
    s_add_u32 s26, s27, s20
    s_add_u32 s26, s26, 0
    s_lshr_b32 s20, s16, 1
    s_lshl_b32 s20, s20, 12
    s_add_u32 s28, s27, s20
    s_add_u32 s28, s28, 33554432
    s_add_u32 s27, s27, 16777216
    s_add_u32 s48, s26, 4096
    s_add_u32 s49, s27, 4096
mega_kernel_x_ldq:
    buffer_load_dwordx4 v[24:27], v2, s[84:87], s26 offen offset:0
    buffer_load_dwordx4 v[28:31], v2, s[84:87], s26 offen offset:2048
    buffer_load_dwordx4 v[32:35], v2, s[84:87], s48 offen offset:0
    buffer_load_dwordx4 v[36:39], v2, s[84:87], s48 offen offset:2048
    buffer_load_dwordx4 v[40:43], v2, s[84:87], s27 offen offset:0
    buffer_load_dwordx4 v[44:47], v2, s[84:87], s27 offen offset:1024
    buffer_load_dwordx4 v[48:51], v2, s[84:87], s27 offen offset:2048
    buffer_load_dwordx4 v[52:55], v2, s[84:87], s27 offen offset:3072
    buffer_load_dwordx4 v[56:59], v2, s[84:87], s49 offen offset:0
    buffer_load_dwordx4 v[60:63], v2, s[84:87], s49 offen offset:1024
    buffer_load_dwordx4 v[64:67], v2, s[84:87], s49 offen offset:2048
    buffer_load_dwordx4 v[68:71], v2, s[84:87], s49 offen offset:3072
    buffer_load_dwordx4 v[72:75], v2, s[84:87], s28 offen offset:0
    buffer_load_dwordx4 v[76:79], v2, s[84:87], s28 offen offset:1024
    buffer_load_dwordx4 v[80:83], v2, s[84:87], s28 offen offset:2048
    buffer_load_dwordx4 v[84:87], v2, s[84:87], s28 offen offset:3072
mega_kernel_x_att:
    s_waitcnt vmcnt(0)
    v_mfma_f32_16x16x32_bf16 v[112:115], v[40:43], v[24:27], 0
    v_mfma_f32_16x16x32_bf16 v[116:119], v[44:47], v[24:27], 0
    v_mfma_f32_16x16x32_bf16 v[112:115], v[48:51], v[28:31], v[112:115]
    v_mfma_f32_16x16x32_bf16 v[116:119], v[52:55], v[28:31], v[116:119]
    v_mfma_f32_16x16x32_bf16 v[112:115], v[56:59], v[32:35], v[112:115]
    v_mfma_f32_16x16x32_bf16 v[116:119], v[60:63], v[32:35], v[116:119]
    v_mfma_f32_16x16x32_bf16 v[112:115], v[64:67], v[36:39], v[112:115]
    v_mfma_f32_16x16x32_bf16 v[116:119], v[68:71], v[36:39], v[116:119]
    s_lshl_b32 s41, s47, 18
    s_add_u32 s41, s41, 50331648
    s_lshl_b32 s20, s18, 13
    s_add_u32 s40, s41, s20
    s_lshl_b32 s20, s16, 16
    s_add_u32 s41, s41, s20
    s_lshl_b32 s42, s22, 17
    v_mov_b32 v130, v20
    v_mov_b32 v131, 0
    v_cmp_gt_i32 vcc, 0, v9
    s_nop 1
    v_cndmask_b32 v112, v112, v11, vcc
    v_cmp_gt_i32 vcc, 1, v9
    s_nop 1
    v_cndmask_b32 v113, v113, v11, vcc
    v_cmp_gt_i32 vcc, 2, v9
    s_nop 1
    v_cndmask_b32 v114, v114, v11, vcc
    v_cmp_gt_i32 vcc, 3, v9
    s_nop 1
    v_cndmask_b32 v115, v115, v11, vcc
    v_cmp_gt_i32 vcc, 0, v10
    s_nop 1
    v_cndmask_b32 v116, v116, v11, vcc
    v_cmp_gt_i32 vcc, 1, v10
    s_nop 1
    v_cndmask_b32 v117, v117, v11, vcc
    v_cmp_gt_i32 vcc, 2, v10
    s_nop 1
    v_cndmask_b32 v118, v118, v11, vcc
    v_cmp_gt_i32 vcc, 3, v10
    s_nop 1
    v_cndmask_b32 v119, v119, v11, vcc
    s_cmp_ge_u32 s22, 63
    s_cbranch_scc1 mega_kernel_x_dx
    s_cmp_eq_u32 s46, 1
    s_cbranch_scc1 mega_kernel_x_rd
mega_kernel_x_rp:
    buffer_load_dword v3, v13, s[84:87], 0 offen sc1
    s_waitcnt vmcnt(0)
    v_cmp_ge_u32 vcc, s22, v3
    s_cbranch_vccz mega_kernel_x_rk
    s_sleep 2
    s_branch mega_kernel_x_rp
mega_kernel_x_rk:
    buffer_load_dwordx4 v[88:91], v6, s[84:87], s29 offen offset:0 sc1
    buffer_load_dwordx4 v[92:95], v6, s[84:87], s29 offen offset:64 sc1
    buffer_load_dwordx4 v[96:99], v6, s[84:87], s29 offen offset:128 sc1
    buffer_load_dwordx4 v[100:103], v6, s[84:87], s29 offen offset:192 sc1
    buffer_load_dwordx2 v[104:105], v7, s[84:87], s29 offen offset:0 sc1
    buffer_load_dwordx2 v[106:107], v7, s[84:87], s29 offen offset:2048 sc1
    buffer_load_dwordx2 v[108:109], v7, s[84:87], s29 offen offset:512 sc1
    buffer_load_dwordx2 v[110:111], v7, s[84:87], s29 offen offset:2560 sc1
mega_kernel_x_rd:
    s_waitcnt vmcnt(7)
    v_mfma_f32_16x16x32_bf16 v[120:123], v[88:91], v[24:27], 0
    s_waitcnt vmcnt(6)
    v_mfma_f32_16x16x32_bf16 v[120:123], v[92:95], v[28:31], v[120:123]
    s_waitcnt vmcnt(5)
    v_mfma_f32_16x16x32_bf16 v[120:123], v[96:99], v[32:35], v[120:123]
    s_waitcnt vmcnt(4)
    v_mfma_f32_16x16x32_bf16 v[120:123], v[100:103], v[36:39], v[120:123]
    v_max3_f32 v4, v112, v113, v114
    v_max3_f32 v4, v4, v115, v116
    v_max3_f32 v4, v4, v117, v118
    s_waitcnt vmcnt(0)
    v_swap_b32 v105, v106
    v_swap_b32 v109, v110
    s_nop 1
    v_max3_f32 v4, v4, v119, v120
    v_max_f32 v3, v4, v121
    v_max_f32 v4, v4, v121
    s_nop 1
    v_permlane16_swap_b32 v4, v3
    v_max_f32 v4, v4, v3
    v_max_f32 v3, v4, v3
    s_nop 1
    v_permlane32_swap_b32 v4, v3
    v_max_f32 v4, v4, v3
    v_mul_f32 v4, s24, v4
    v_fma_f32 v112, v112, s24, -v4
    v_fma_f32 v113, v113, s24, -v4
    v_fma_f32 v114, v114, s24, -v4
    v_fma_f32 v115, v115, s24, -v4
    v_fma_f32 v116, v116, s24, -v4
    v_fma_f32 v117, v117, s24, -v4
    v_fma_f32 v118, v118, s24, -v4
    v_fma_f32 v119, v119, s24, -v4
    v_fma_f32 v120, v120, s24, -v4
    v_fma_f32 v121, v121, s24, -v4
    v_exp_f32 v112, v112
    v_exp_f32 v113, v113
    v_exp_f32 v114, v114
    v_exp_f32 v115, v115
    v_exp_f32 v116, v116
    v_exp_f32 v117, v117
    v_exp_f32 v118, v118
    v_exp_f32 v119, v119
    v_exp_f32 v120, v120
    v_exp_f32 v121, v121
    s_nop 0
    v_cvt_pk_bf16_f32 v124, v112, v113
    v_cvt_pk_bf16_f32 v125, v114, v115
    v_cvt_pk_bf16_f32 v126, v116, v117
    v_cvt_pk_bf16_f32 v127, v118, v119
    v_cvt_pk_bf16_f32 v128, v120, v121
    v_mov_b32 v129, v128
    s_nop 1
    v_mfma_f32_16x16x32_bf16 v[132:135], v[20:23], v[124:127], 0
    v_mfma_f32_16x16x32_bf16 v[88:91], v[72:75], v[124:127], 0
    v_mfma_f32_16x16x32_bf16 v[92:95], v[76:79], v[124:127], 0
    v_mfma_f32_16x16x32_bf16 v[96:99], v[80:83], v[124:127], 0
    v_mfma_f32_16x16x32_bf16 v[100:103], v[84:87], v[124:127], 0
    s_nop 1
    v_mfma_f32_16x16x16_bf16 v[132:135], v[130:131], v[128:129], v[132:135]
    v_mfma_f32_16x16x16_bf16 v[88:91], v[104:105], v[128:129], v[88:91]
    v_mfma_f32_16x16x16_bf16 v[92:95], v[106:107], v[128:129], v[92:95]
    v_mfma_f32_16x16x16_bf16 v[96:99], v[108:109], v[128:129], v[96:99]
    v_mfma_f32_16x16x16_bf16 v[100:103], v[110:111], v[128:129], v[100:103]
    s_nop 3
    v_rcp_f32 v132, v132
    s_nop 2
    v_pk_mul_f32 v[88:89], v[88:89], v[132:133] op_sel_hi:[1,0]
    v_pk_mul_f32 v[90:91], v[90:91], v[132:133] op_sel_hi:[1,0]
    v_pk_mul_f32 v[92:93], v[92:93], v[132:133] op_sel_hi:[1,0]
    v_pk_mul_f32 v[94:95], v[94:95], v[132:133] op_sel_hi:[1,0]
    v_pk_mul_f32 v[96:97], v[96:97], v[132:133] op_sel_hi:[1,0]
    v_pk_mul_f32 v[98:99], v[98:99], v[132:133] op_sel_hi:[1,0]
    v_pk_mul_f32 v[100:101], v[100:101], v[132:133] op_sel_hi:[1,0]
    v_pk_mul_f32 v[102:103], v[102:103], v[132:133] op_sel_hi:[1,0]
    v_cvt_pk_bf16_f32 v112, v88, v89
    v_cvt_pk_bf16_f32 v113, v90, v91
    v_cvt_pk_bf16_f32 v114, v92, v93
    v_cvt_pk_bf16_f32 v115, v94, v95
    v_cvt_pk_bf16_f32 v116, v96, v97
    v_cvt_pk_bf16_f32 v117, v98, v99
    v_cvt_pk_bf16_f32 v118, v100, v101
    v_cvt_pk_bf16_f32 v119, v102, v103
    s_add_u32 s43, s22, 1
    v_mov_b32 v4, s43
    s_cmp_eq_u32 s96, 1
    s_cbranch_scc1 mega_kernel_x_of
    buffer_store_dwordx4 v[112:115], v8, s[84:87], s40 offen sc1
    buffer_store_dwordx4 v[116:119], v8, s[84:87], s40 offen offset:2048 sc1
    s_waitcnt vmcnt(0)
    s_barrier
    buffer_store_dword v4, v15, s[84:87], 0 offen sc1
    s_branch mega_kernel_x_od
mega_kernel_x_of:
    buffer_store_dwordx4 v[112:115], v8, s[84:87], s40 offen
    buffer_store_dwordx4 v[116:119], v8, s[84:87], s40 offen offset:2048
    s_waitcnt vmcnt(0)
    s_barrier
    buffer_store_dword v4, v15, s[84:87], 0 offen
mega_kernel_x_od:
    s_mov_b32 s45, s22
    s_add_u32 s20, s47, 1
    s_and_b32 s20, s20, 3
    s_andn2_b32 s47, s47, 3
    s_or_b32 s47, s47, s20
    s_bitset0_b64 s[60:61], s22
    s_ff1_i32_b64 s22, s[60:61]
    s_min_u32 s22, s22, 64
    s_lshl_b32 s27, s22, 18
    s_lshl_b32 s20, s18, 13
    s_add_u32 s27, s27, s20
    s_add_u32 s29, s27, 178257920
    s_and_b32 s20, s16, 1
    s_lshl_b32 s20, s20, 10
    s_add_u32 s26, s27, s20
    s_add_u32 s26, s26, 0
    s_lshr_b32 s20, s16, 1
    s_lshl_b32 s20, s20, 12
    s_add_u32 s28, s27, s20
    s_add_u32 s28, s28, 33554432
    s_add_u32 s27, s27, 16777216
    s_add_u32 s48, s26, 4096
    s_add_u32 s49, s27, 4096
mega_kernel_x_xp:
    buffer_load_dword v3, v14, s[84:87], 0 offen sc1
    s_waitcnt vmcnt(0)
    v_cmp_ge_u32 vcc, s45, v3
    s_cbranch_vccnz mega_kernel_x_xp
    s_cmp_ge_u32 s45, 58
    s_cbranch_scc1 mega_kernel_x_half
    s_add_u32 s20, s50, 0
    s_and_b32 s20, s20, 0xffff
    s_add_u32 s20, s20, s41
    buffer_load_dwordx4 v[136:139], v2, s[84:87], s20 offen offset:0 sc1
    buffer_load_dwordx4 v[140:143], v2, s[84:87], s20 offen offset:1024 sc1
    buffer_load_dwordx4 v[144:147], v2, s[84:87], s20 offen offset:2048 sc1
    buffer_load_dwordx4 v[148:151], v2, s[84:87], s20 offen offset:3072 sc1
    s_add_u32 s20, s50, 4096
    s_and_b32 s20, s20, 0xffff
    s_add_u32 s20, s20, s41
    buffer_load_dwordx4 v[152:155], v2, s[84:87], s20 offen offset:0 sc1
    buffer_load_dwordx4 v[156:159], v2, s[84:87], s20 offen offset:1024 sc1
    buffer_load_dwordx4 v[160:163], v2, s[84:87], s20 offen offset:2048 sc1
    buffer_load_dwordx4 v[164:167], v2, s[84:87], s20 offen offset:3072 sc1
    s_add_u32 s20, s50, 8192
    s_and_b32 s20, s20, 0xffff
    s_add_u32 s20, s20, s41
    buffer_load_dwordx4 v[168:171], v2, s[84:87], s20 offen offset:0 sc1
    buffer_load_dwordx4 v[172:175], v2, s[84:87], s20 offen offset:1024 sc1
    buffer_load_dwordx4 v[176:179], v2, s[84:87], s20 offen offset:2048 sc1
    buffer_load_dwordx4 v[180:183], v2, s[84:87], s20 offen offset:3072 sc1
    buffer_load_dword v5, v13, s[84:87], 0 offen sc1
    s_waitcnt vmcnt(12)
    v_mfma_f32_32x32x16_bf16 v[112:127], a[0:3], v[136:139], 0
    s_add_u32 s20, s50, 12288
    s_and_b32 s20, s20, 0xffff
    s_add_u32 s20, s20, s41
    buffer_load_dwordx4 v[184:187], v2, s[84:87], s20 offen offset:0 sc1
    s_waitcnt vmcnt(12)
    v_mfma_f32_32x32x16_bf16 v[112:127], a[4:7], v[140:143], v[112:127]
    buffer_load_dwordx4 v[188:191], v2, s[84:87], s20 offen offset:1024 sc1
    s_waitcnt vmcnt(12)
    v_mfma_f32_32x32x16_bf16 v[112:127], a[8:11], v[144:147], v[112:127]
    buffer_load_dwordx4 v[192:195], v2, s[84:87], s20 offen offset:2048 sc1
    s_waitcnt vmcnt(12)
    v_mfma_f32_32x32x16_bf16 v[112:127], a[12:15], v[148:151], v[112:127]
    buffer_load_dwordx4 v[196:199], v2, s[84:87], s20 offen offset:3072 sc1
    s_waitcnt vmcnt(12)
    v_mfma_f32_32x32x16_bf16 v[112:127], a[16:19], v[152:155], v[112:127]
    s_add_u32 s20, s50, 16384
    s_and_b32 s20, s20, 0xffff
    s_add_u32 s20, s20, s41
    buffer_load_dwordx4 v[200:203], v2, s[84:87], s20 offen offset:0 sc1
    s_waitcnt vmcnt(12)
    v_mfma_f32_32x32x16_bf16 v[112:127], a[20:23], v[156:159], v[112:127]
    buffer_load_dwordx4 v[204:207], v2, s[84:87], s20 offen offset:1024 sc1
    s_waitcnt vmcnt(12)
    v_mfma_f32_32x32x16_bf16 v[112:127], a[24:27], v[160:163], v[112:127]
    buffer_load_dwordx4 v[208:211], v2, s[84:87], s20 offen offset:2048 sc1
    s_waitcnt vmcnt(12)
    v_mfma_f32_32x32x16_bf16 v[112:127], a[28:31], v[164:167], v[112:127]
    buffer_load_dwordx4 v[212:215], v2, s[84:87], s20 offen offset:3072 sc1
    s_waitcnt vmcnt(12)
    v_mfma_f32_32x32x16_bf16 v[112:127], a[32:35], v[168:171], v[112:127]
    s_add_u32 s20, s50, 20480
    s_and_b32 s20, s20, 0xffff
    s_add_u32 s20, s20, s41
    buffer_load_dwordx4 v[216:219], v2, s[84:87], s20 offen offset:0 sc1
    s_waitcnt vmcnt(12)
    v_mfma_f32_32x32x16_bf16 v[112:127], a[36:39], v[172:175], v[112:127]
    buffer_load_dwordx4 v[220:223], v2, s[84:87], s20 offen offset:1024 sc1
    s_waitcnt vmcnt(12)
    v_mfma_f32_32x32x16_bf16 v[112:127], a[40:43], v[176:179], v[112:127]
    buffer_load_dwordx4 v[224:227], v2, s[84:87], s20 offen offset:2048 sc1
    s_waitcnt vmcnt(12)
    v_mfma_f32_32x32x16_bf16 v[112:127], a[44:47], v[180:183], v[112:127]
    buffer_load_dwordx4 v[228:231], v2, s[84:87], s20 offen offset:3072 sc1
    s_waitcnt vmcnt(11)
    v_mfma_f32_32x32x16_bf16 v[112:127], a[48:51], v[184:187], v[112:127]
    s_add_u32 s20, s50, 24576
    s_and_b32 s20, s20, 0xffff
    s_add_u32 s20, s20, s41
    buffer_load_dwordx4 v[232:235], v2, s[84:87], s20 offen offset:0 sc1
    v_cmp_ge_u32 vcc, s22, v5
    s_waitcnt vmcnt(11)
    v_mfma_f32_32x32x16_bf16 v[112:127], a[52:55], v[188:191], v[112:127]
    buffer_load_dwordx4 v[236:239], v2, s[84:87], s20 offen offset:1024 sc1
    s_cmp_eq_u64 vcc, 0
    s_cselect_b32 s46, 1, 0
    s_waitcnt vmcnt(11)
    v_mfma_f32_32x32x16_bf16 v[112:127], a[56:59], v[192:195], v[112:127]
    buffer_load_dwordx4 v[240:243], v2, s[84:87], s20 offen offset:2048 sc1
    s_waitcnt vmcnt(11)
    v_mfma_f32_32x32x16_bf16 v[112:127], a[60:63], v[196:199], v[112:127]
    buffer_load_dwordx4 v[244:247], v2, s[84:87], s20 offen offset:3072 sc1
    s_waitcnt vmcnt(11)
    v_mfma_f32_32x32x16_bf16 v[112:127], a[64:67], v[200:203], v[112:127]
    s_add_u32 s20, s50, 28672
    s_and_b32 s20, s20, 0xffff
    s_add_u32 s20, s20, s41
    buffer_load_dwordx4 v[248:251], v2, s[84:87], s20 offen offset:0 sc1
    s_waitcnt vmcnt(11)
    v_mfma_f32_32x32x16_bf16 v[112:127], a[68:71], v[204:207], v[112:127]
    buffer_load_dwordx4 v[252:255], v2, s[84:87], s20 offen offset:1024 sc1
    s_waitcnt vmcnt(11)
    v_mfma_f32_32x32x16_bf16 v[112:127], a[72:75], v[208:211], v[112:127]
    buffer_load_dwordx4 v[136:139], v2, s[84:87], s20 offen offset:2048 sc1
    s_waitcnt vmcnt(11)
    v_mfma_f32_32x32x16_bf16 v[112:127], a[76:79], v[212:215], v[112:127]
    buffer_load_dwordx4 v[140:143], v2, s[84:87], s20 offen offset:3072 sc1
    s_waitcnt vmcnt(11)
    v_mfma_f32_32x32x16_bf16 v[112:127], a[80:83], v[216:219], v[112:127]
    s_add_u32 s20, s50, 32768
    s_and_b32 s20, s20, 0xffff
    s_add_u32 s20, s20, s41
    buffer_load_dwordx4 v[144:147], v2, s[84:87], s20 offen offset:0 sc1
    s_waitcnt vmcnt(11)
    v_mfma_f32_32x32x16_bf16 v[112:127], a[84:87], v[220:223], v[112:127]
    buffer_load_dwordx4 v[148:151], v2, s[84:87], s20 offen offset:1024 sc1
    s_waitcnt vmcnt(11)
    v_mfma_f32_32x32x16_bf16 v[112:127], a[88:91], v[224:227], v[112:127]
    buffer_load_dwordx4 v[152:155], v2, s[84:87], s20 offen offset:2048 sc1
    s_waitcnt vmcnt(11)
    v_mfma_f32_32x32x16_bf16 v[112:127], a[92:95], v[228:231], v[112:127]
    buffer_load_dwordx4 v[156:159], v2, s[84:87], s20 offen offset:3072 sc1
    s_waitcnt vmcnt(11)
    v_mfma_f32_32x32x16_bf16 v[112:127], a[96:99], v[232:235], v[112:127]
    s_add_u32 s20, s50, 36864
    s_and_b32 s20, s20, 0xffff
    s_add_u32 s20, s20, s41
    buffer_load_dwordx4 v[160:163], v2, s[84:87], s20 offen offset:0 sc1
    s_waitcnt vmcnt(11)
    v_mfma_f32_32x32x16_bf16 v[112:127], a[100:103], v[236:239], v[112:127]
    buffer_load_dwordx4 v[164:167], v2, s[84:87], s20 offen offset:1024 sc1
    s_waitcnt vmcnt(11)
    v_mfma_f32_32x32x16_bf16 v[112:127], a[104:107], v[240:243], v[112:127]
    buffer_load_dwordx4 v[168:171], v2, s[84:87], s20 offen offset:2048 sc1
    s_waitcnt vmcnt(11)
    v_mfma_f32_32x32x16_bf16 v[112:127], a[108:111], v[244:247], v[112:127]
    buffer_load_dwordx4 v[172:175], v2, s[84:87], s20 offen offset:3072 sc1
    s_waitcnt vmcnt(11)
    v_mfma_f32_32x32x16_bf16 v[112:127], a[112:115], v[248:251], v[112:127]
    s_add_u32 s20, s50, 40960
    s_and_b32 s20, s20, 0xffff
    s_add_u32 s20, s20, s41
    buffer_load_dwordx4 v[176:179], v2, s[84:87], s20 offen offset:0 sc1
    s_waitcnt vmcnt(11)
    v_mfma_f32_32x32x16_bf16 v[112:127], a[116:119], v[252:255], v[112:127]
    buffer_load_dwordx4 v[180:183], v2, s[84:87], s20 offen offset:1024 sc1
    s_waitcnt vmcnt(11)
    v_mfma_f32_32x32x16_bf16 v[112:127], a[120:123], v[136:139], v[112:127]
    buffer_load_dwordx4 v[184:187], v2, s[84:87], s20 offen offset:2048 sc1
    s_waitcnt vmcnt(11)
    v_mfma_f32_32x32x16_bf16 v[112:127], a[124:127], v[140:143], v[112:127]
    buffer_load_dwordx4 v[188:191], v2, s[84:87], s20 offen offset:3072 sc1
    s_waitcnt vmcnt(11)
    v_mfma_f32_32x32x16_bf16 v[112:127], a[128:131], v[144:147], v[112:127]
    s_add_u32 s20, s50, 45056
    s_and_b32 s20, s20, 0xffff
    s_add_u32 s20, s20, s41
    buffer_load_dwordx4 v[192:195], v2, s[84:87], s20 offen offset:0 sc1
    s_waitcnt vmcnt(11)
    v_mfma_f32_32x32x16_bf16 v[112:127], a[132:135], v[148:151], v[112:127]
    buffer_load_dwordx4 v[196:199], v2, s[84:87], s20 offen offset:1024 sc1
    s_waitcnt vmcnt(11)
    v_mfma_f32_32x32x16_bf16 v[112:127], a[136:139], v[152:155], v[112:127]
    buffer_load_dwordx4 v[200:203], v2, s[84:87], s20 offen offset:2048 sc1
    s_waitcnt vmcnt(11)
    v_mfma_f32_32x32x16_bf16 v[112:127], a[140:143], v[156:159], v[112:127]
    buffer_load_dwordx4 v[204:207], v2, s[84:87], s20 offen offset:3072 sc1
    s_waitcnt vmcnt(11)
    v_mfma_f32_32x32x16_bf16 v[112:127], a[144:147], v[160:163], v[112:127]
    s_add_u32 s20, s50, 49152
    s_and_b32 s20, s20, 0xffff
    s_add_u32 s20, s20, s41
    buffer_load_dwordx4 v[208:211], v2, s[84:87], s20 offen offset:0 sc1
    s_waitcnt vmcnt(11)
    v_mfma_f32_32x32x16_bf16 v[112:127], a[148:151], v[164:167], v[112:127]
    buffer_load_dwordx4 v[212:215], v2, s[84:87], s20 offen offset:1024 sc1
    s_waitcnt vmcnt(11)
    v_mfma_f32_32x32x16_bf16 v[112:127], a[152:155], v[168:171], v[112:127]
    buffer_load_dwordx4 v[216:219], v2, s[84:87], s20 offen offset:2048 sc1
    s_waitcnt vmcnt(11)
    v_mfma_f32_32x32x16_bf16 v[112:127], a[156:159], v[172:175], v[112:127]
    buffer_load_dwordx4 v[220:223], v2, s[84:87], s20 offen offset:3072 sc1
    s_waitcnt vmcnt(11)
    v_mfma_f32_32x32x16_bf16 v[112:127], a[160:163], v[176:179], v[112:127]
    s_add_u32 s20, s50, 53248
    s_and_b32 s20, s20, 0xffff
    s_add_u32 s20, s20, s41
    buffer_load_dwordx4 v[224:227], v2, s[84:87], s20 offen offset:0 sc1
    s_waitcnt vmcnt(11)
    v_mfma_f32_32x32x16_bf16 v[112:127], a[164:167], v[180:183], v[112:127]
    buffer_load_dwordx4 v[228:231], v2, s[84:87], s20 offen offset:1024 sc1
    s_waitcnt vmcnt(11)
    v_mfma_f32_32x32x16_bf16 v[112:127], a[168:171], v[184:187], v[112:127]
    buffer_load_dwordx4 v[232:235], v2, s[84:87], s20 offen offset:2048 sc1
    s_waitcnt vmcnt(11)
    v_mfma_f32_32x32x16_bf16 v[112:127], a[172:175], v[188:191], v[112:127]
    buffer_load_dwordx4 v[236:239], v2, s[84:87], s20 offen offset:3072 sc1
    s_waitcnt vmcnt(11)
    v_mfma_f32_32x32x16_bf16 v[112:127], a[176:179], v[192:195], v[112:127]
    s_add_u32 s20, s50, 57344
    s_and_b32 s20, s20, 0xffff
    s_add_u32 s20, s20, s41
    buffer_load_dwordx4 v[240:243], v2, s[84:87], s20 offen offset:0 sc1
    s_waitcnt vmcnt(11)
    v_mfma_f32_32x32x16_bf16 v[112:127], a[180:183], v[196:199], v[112:127]
    buffer_load_dwordx4 v[244:247], v2, s[84:87], s20 offen offset:1024 sc1
    s_waitcnt vmcnt(11)
    v_mfma_f32_32x32x16_bf16 v[112:127], a[184:187], v[200:203], v[112:127]
    buffer_load_dwordx4 v[248:251], v2, s[84:87], s20 offen offset:2048 sc1
    s_waitcnt vmcnt(11)
    v_mfma_f32_32x32x16_bf16 v[112:127], a[188:191], v[204:207], v[112:127]
    buffer_load_dwordx4 v[252:255], v2, s[84:87], s20 offen offset:3072 sc1
    s_waitcnt vmcnt(11)
    v_mfma_f32_32x32x16_bf16 v[112:127], a[192:195], v[208:211], v[112:127]
    s_add_u32 s20, s50, 61440
    s_and_b32 s20, s20, 0xffff
    s_add_u32 s20, s20, s41
    buffer_load_dwordx4 v[136:139], v2, s[84:87], s20 offen offset:0 sc1
    s_waitcnt vmcnt(11)
    v_mfma_f32_32x32x16_bf16 v[112:127], a[196:199], v[212:215], v[112:127]
    buffer_load_dwordx4 v[140:143], v2, s[84:87], s20 offen offset:1024 sc1
    s_waitcnt vmcnt(11)
    v_mfma_f32_32x32x16_bf16 v[112:127], a[200:203], v[216:219], v[112:127]
    buffer_load_dwordx4 v[144:147], v2, s[84:87], s20 offen offset:2048 sc1
    s_waitcnt vmcnt(11)
    v_mfma_f32_32x32x16_bf16 v[112:127], a[204:207], v[220:223], v[112:127]
    buffer_load_dwordx4 v[148:151], v2, s[84:87], s20 offen offset:3072 sc1
    s_cmp_eq_u32 s46, 1
    s_cbranch_scc1 mega_kernel_x_pfx
    s_waitcnt vmcnt(11)
    v_mfma_f32_32x32x16_bf16 v[112:127], a[208:211], v[224:227], v[112:127]
    s_waitcnt vmcnt(10)
    v_mfma_f32_32x32x16_bf16 v[112:127], a[212:215], v[228:231], v[112:127]
    s_waitcnt vmcnt(9)
    v_mfma_f32_32x32x16_bf16 v[112:127], a[216:219], v[232:235], v[112:127]
    s_waitcnt vmcnt(8)
    v_mfma_f32_32x32x16_bf16 v[112:127], a[220:223], v[236:239], v[112:127]
    s_waitcnt vmcnt(7)
    v_mfma_f32_32x32x16_bf16 v[112:127], a[224:227], v[240:243], v[112:127]
    s_waitcnt vmcnt(6)
    v_mfma_f32_32x32x16_bf16 v[112:127], a[228:231], v[244:247], v[112:127]
    s_waitcnt vmcnt(5)
    v_mfma_f32_32x32x16_bf16 v[112:127], a[232:235], v[248:251], v[112:127]
    s_waitcnt vmcnt(4)
    v_mfma_f32_32x32x16_bf16 v[112:127], a[236:239], v[252:255], v[112:127]
    s_waitcnt vmcnt(3)
    v_mfma_f32_32x32x16_bf16 v[112:127], a[240:243], v[136:139], v[112:127]
    s_waitcnt vmcnt(2)
    v_mfma_f32_32x32x16_bf16 v[112:127], a[244:247], v[140:143], v[112:127]
    s_waitcnt vmcnt(1)
    v_mfma_f32_32x32x16_bf16 v[112:127], a[248:251], v[144:147], v[112:127]
    s_waitcnt vmcnt(0)
    v_mfma_f32_32x32x16_bf16 v[112:127], a[252:255], v[148:151], v[112:127]
    s_branch mega_kernel_x_pfd
mega_kernel_x_pfx:
    s_waitcnt vmcnt(11)
    v_mfma_f32_32x32x16_bf16 v[112:127], a[208:211], v[224:227], v[112:127]
    buffer_load_dwordx4 v[24:27], v2, s[84:87], s26 offen offset:0
    buffer_load_dwordx4 v[28:31], v2, s[84:87], s26 offen offset:2048
    s_waitcnt vmcnt(12)
    v_mfma_f32_32x32x16_bf16 v[112:127], a[212:215], v[228:231], v[112:127]
    buffer_load_dwordx4 v[32:35], v2, s[84:87], s48 offen offset:0
    buffer_load_dwordx4 v[36:39], v2, s[84:87], s48 offen offset:2048
    s_waitcnt vmcnt(13)
    v_mfma_f32_32x32x16_bf16 v[112:127], a[216:219], v[232:235], v[112:127]
    buffer_load_dwordx4 v[40:43], v2, s[84:87], s27 offen offset:0
    buffer_load_dwordx4 v[44:47], v2, s[84:87], s27 offen offset:1024
    s_waitcnt vmcnt(14)
    v_mfma_f32_32x32x16_bf16 v[112:127], a[220:223], v[236:239], v[112:127]
    buffer_load_dwordx4 v[48:51], v2, s[84:87], s27 offen offset:2048
    buffer_load_dwordx4 v[52:55], v2, s[84:87], s27 offen offset:3072
    s_waitcnt vmcnt(15)
    v_mfma_f32_32x32x16_bf16 v[112:127], a[224:227], v[240:243], v[112:127]
    buffer_load_dwordx4 v[56:59], v2, s[84:87], s49 offen offset:0
    buffer_load_dwordx4 v[60:63], v2, s[84:87], s49 offen offset:1024
    s_waitcnt vmcnt(16)
    v_mfma_f32_32x32x16_bf16 v[112:127], a[228:231], v[244:247], v[112:127]
    buffer_load_dwordx4 v[64:67], v2, s[84:87], s49 offen offset:2048
    buffer_load_dwordx4 v[68:71], v2, s[84:87], s49 offen offset:3072
    s_waitcnt vmcnt(17)
    v_mfma_f32_32x32x16_bf16 v[112:127], a[232:235], v[248:251], v[112:127]
    buffer_load_dwordx4 v[72:75], v2, s[84:87], s28 offen offset:0
    buffer_load_dwordx4 v[76:79], v2, s[84:87], s28 offen offset:1024
    s_waitcnt vmcnt(18)
    v_mfma_f32_32x32x16_bf16 v[112:127], a[236:239], v[252:255], v[112:127]
    buffer_load_dwordx4 v[80:83], v2, s[84:87], s28 offen offset:2048
    buffer_load_dwordx4 v[84:87], v2, s[84:87], s28 offen offset:3072
    s_waitcnt vmcnt(19)
    v_mfma_f32_32x32x16_bf16 v[112:127], a[240:243], v[136:139], v[112:127]
    buffer_load_dwordx4 v[88:91], v6, s[84:87], s29 offen offset:0 sc1
    buffer_load_dwordx4 v[92:95], v6, s[84:87], s29 offen offset:64 sc1
    s_waitcnt vmcnt(20)
    v_mfma_f32_32x32x16_bf16 v[112:127], a[244:247], v[140:143], v[112:127]
    buffer_load_dwordx4 v[96:99], v6, s[84:87], s29 offen offset:128 sc1
    buffer_load_dwordx4 v[100:103], v6, s[84:87], s29 offen offset:192 sc1
    s_waitcnt vmcnt(21)
    v_mfma_f32_32x32x16_bf16 v[112:127], a[248:251], v[144:147], v[112:127]
    buffer_load_dwordx2 v[104:105], v7, s[84:87], s29 offen offset:0 sc1
    buffer_load_dwordx2 v[106:107], v7, s[84:87], s29 offen offset:2048 sc1
    s_waitcnt vmcnt(22)
    v_mfma_f32_32x32x16_bf16 v[112:127], a[252:255], v[148:151], v[112:127]
    buffer_load_dwordx2 v[108:109], v7, s[84:87], s29 offen offset:512 sc1
    buffer_load_dwordx2 v[110:111], v7, s[84:87], s29 offen offset:2560 sc1
mega_kernel_x_pfd:
    s_nop 11
    ds_write_b128 v17, v[112:115] offset:0
    ds_write_b128 v17, v[116:119] offset:1024
    ds_write_b128 v17, v[120:123] offset:2048
    ds_write_b128 v17, v[124:127] offset:3072
    s_waitcnt lgkmcnt(0)
    s_barrier
    ds_read_b128 v[112:115], v16 offset:0
    ds_read_b128 v[116:119], v16 offset:4096
    ds_read_b128 v[120:123], v16 offset:8192
    ds_read_b128 v[124:127], v16 offset:12288
    s_waitcnt lgkmcnt(0)
    v_pk_add_f32 v[112:113], v[112:113], v[116:117]
    v_pk_add_f32 v[114:115], v[114:115], v[118:119]
    v_pk_add_f32 v[120:121], v[120:121], v[124:125]
    v_pk_add_f32 v[122:123], v[122:123], v[126:127]
    v_pk_add_f32 v[112:113], v[112:113], v[120:121]
    v_pk_add_f32 v[114:115], v[114:115], v[122:123]
    v_cvt_pk_bf16_f32 v132, v112, v113
    v_cvt_pk_bf16_f32 v133, v114, v115
    buffer_store_dwordx2 v[132:133], v18, s[12:15], s42 offen
    s_branch mega_kernel_x_nxt
mega_kernel_x_half:
    s_add_u32 s20, s50, 0
    s_and_b32 s20, s20, 0xffff
    s_add_u32 s20, s20, s41
    buffer_load_dwordx4 v[136:139], v19, s[84:87], s20 offen offset:0 sc1
    buffer_load_dwordx4 v[140:143], v19, s[84:87], s20 offen offset:2048 sc1
    s_add_u32 s20, s50, 4096
    s_and_b32 s20, s20, 0xffff
    s_add_u32 s20, s20, s41
    buffer_load_dwordx4 v[144:147], v19, s[84:87], s20 offen offset:0 sc1
    buffer_load_dwordx4 v[148:151], v19, s[84:87], s20 offen offset:2048 sc1
    s_add_u32 s20, s50, 8192
    s_and_b32 s20, s20, 0xffff
    s_add_u32 s20, s20, s41
    buffer_load_dwordx4 v[152:155], v19, s[84:87], s20 offen offset:0 sc1
    buffer_load_dwordx4 v[156:159], v19, s[84:87], s20 offen offset:2048 sc1
    s_add_u32 s20, s50, 12288
    s_and_b32 s20, s20, 0xffff
    s_add_u32 s20, s20, s41
    buffer_load_dwordx4 v[160:163], v19, s[84:87], s20 offen offset:0 sc1
    buffer_load_dwordx4 v[164:167], v19, s[84:87], s20 offen offset:2048 sc1
    s_add_u32 s20, s50, 16384
    s_and_b32 s20, s20, 0xffff
    s_add_u32 s20, s20, s41
    buffer_load_dwordx4 v[168:171], v19, s[84:87], s20 offen offset:0 sc1
    buffer_load_dwordx4 v[172:175], v19, s[84:87], s20 offen offset:2048 sc1
    s_add_u32 s20, s50, 20480
    s_and_b32 s20, s20, 0xffff
    s_add_u32 s20, s20, s41
    buffer_load_dwordx4 v[176:179], v19, s[84:87], s20 offen offset:0 sc1
    buffer_load_dwordx4 v[180:183], v19, s[84:87], s20 offen offset:2048 sc1
    s_mov_b32 s46, 0
    s_waitcnt vmcnt(11)
    v_mfma_f32_32x32x16_bf16 v[112:127], a[0:3], v[136:139], 0
    v_mfma_f32_32x32x16_bf16 v[88:103], a[4:7], v[136:139], 0
    s_add_u32 s20, s50, 24576
    s_and_b32 s20, s20, 0xffff
    s_add_u32 s20, s20, s41
    buffer_load_dwordx4 v[184:187], v19, s[84:87], s20 offen offset:0 sc1
    s_waitcnt vmcnt(11)
    v_mfma_f32_32x32x16_bf16 v[112:127], a[8:11], v[140:143], v[112:127]
    v_mfma_f32_32x32x16_bf16 v[88:103], a[12:15], v[140:143], v[88:103]
    buffer_load_dwordx4 v[188:191], v19, s[84:87], s20 offen offset:2048 sc1
    s_waitcnt vmcnt(11)
    v_mfma_f32_32x32x16_bf16 v[112:127], a[16:19], v[144:147], v[112:127]
    v_mfma_f32_32x32x16_bf16 v[88:103], a[20:23], v[144:147], v[88:103]
    s_add_u32 s20, s50, 28672
    s_and_b32 s20, s20, 0xffff
    s_add_u32 s20, s20, s41
    buffer_load_dwordx4 v[192:195], v19, s[84:87], s20 offen offset:0 sc1
    s_waitcnt vmcnt(11)
    v_mfma_f32_32x32x16_bf16 v[112:127], a[24:27], v[148:151], v[112:127]
    v_mfma_f32_32x32x16_bf16 v[88:103], a[28:31], v[148:151], v[88:103]
    buffer_load_dwordx4 v[196:199], v19, s[84:87], s20 offen offset:2048 sc1
    s_waitcnt vmcnt(11)
    v_mfma_f32_32x32x16_bf16 v[112:127], a[32:35], v[152:155], v[112:127]
    v_mfma_f32_32x32x16_bf16 v[88:103], a[36:39], v[152:155], v[88:103]
    s_add_u32 s20, s50, 32768
    s_and_b32 s20, s20, 0xffff
    s_add_u32 s20, s20, s41
    buffer_load_dwordx4 v[200:203], v19, s[84:87], s20 offen offset:0 sc1
    s_waitcnt vmcnt(11)
    v_mfma_f32_32x32x16_bf16 v[112:127], a[40:43], v[156:159], v[112:127]
    v_mfma_f32_32x32x16_bf16 v[88:103], a[44:47], v[156:159], v[88:103]
    buffer_load_dwordx4 v[204:207], v19, s[84:87], s20 offen offset:2048 sc1
    s_waitcnt vmcnt(11)
    v_mfma_f32_32x32x16_bf16 v[112:127], a[48:51], v[160:163], v[112:127]
    v_mfma_f32_32x32x16_bf16 v[88:103], a[52:55], v[160:163], v[88:103]
    s_add_u32 s20, s50, 36864
    s_and_b32 s20, s20, 0xffff
    s_add_u32 s20, s20, s41
    buffer_load_dwordx4 v[208:211], v19, s[84:87], s20 offen offset:0 sc1
    s_waitcnt vmcnt(11)
    v_mfma_f32_32x32x16_bf16 v[112:127], a[56:59], v[164:167], v[112:127]
    v_mfma_f32_32x32x16_bf16 v[88:103], a[60:63], v[164:167], v[88:103]
    buffer_load_dwordx4 v[212:215], v19, s[84:87], s20 offen offset:2048 sc1
    s_waitcnt vmcnt(11)
    v_mfma_f32_32x32x16_bf16 v[112:127], a[64:67], v[168:171], v[112:127]
    v_mfma_f32_32x32x16_bf16 v[88:103], a[68:71], v[168:171], v[88:103]
    s_add_u32 s20, s50, 40960
    s_and_b32 s20, s20, 0xffff
    s_add_u32 s20, s20, s41
    buffer_load_dwordx4 v[216:219], v19, s[84:87], s20 offen offset:0 sc1
    s_waitcnt vmcnt(11)
    v_mfma_f32_32x32x16_bf16 v[112:127], a[72:75], v[172:175], v[112:127]
    v_mfma_f32_32x32x16_bf16 v[88:103], a[76:79], v[172:175], v[88:103]
    buffer_load_dwordx4 v[220:223], v19, s[84:87], s20 offen offset:2048 sc1
    s_waitcnt vmcnt(11)
    v_mfma_f32_32x32x16_bf16 v[112:127], a[80:83], v[176:179], v[112:127]
    v_mfma_f32_32x32x16_bf16 v[88:103], a[84:87], v[176:179], v[88:103]
    s_add_u32 s20, s50, 45056
    s_and_b32 s20, s20, 0xffff
    s_add_u32 s20, s20, s41
    buffer_load_dwordx4 v[224:227], v19, s[84:87], s20 offen offset:0 sc1
    s_waitcnt vmcnt(11)
    v_mfma_f32_32x32x16_bf16 v[112:127], a[88:91], v[180:183], v[112:127]
    v_mfma_f32_32x32x16_bf16 v[88:103], a[92:95], v[180:183], v[88:103]
    buffer_load_dwordx4 v[228:231], v19, s[84:87], s20 offen offset:2048 sc1
    s_waitcnt vmcnt(11)
    v_mfma_f32_32x32x16_bf16 v[112:127], a[96:99], v[184:187], v[112:127]
    v_mfma_f32_32x32x16_bf16 v[88:103], a[100:103], v[184:187], v[88:103]
    s_add_u32 s20, s50, 49152
    s_and_b32 s20, s20, 0xffff
    s_add_u32 s20, s20, s41
    buffer_load_dwordx4 v[232:235], v19, s[84:87], s20 offen offset:0 sc1
    s_waitcnt vmcnt(11)
    v_mfma_f32_32x32x16_bf16 v[112:127], a[104:107], v[188:191], v[112:127]
    v_mfma_f32_32x32x16_bf16 v[88:103], a[108:111], v[188:191], v[88:103]
    buffer_load_dwordx4 v[236:239], v19, s[84:87], s20 offen offset:2048 sc1
    s_waitcnt vmcnt(11)
    v_mfma_f32_32x32x16_bf16 v[112:127], a[112:115], v[192:195], v[112:127]
    v_mfma_f32_32x32x16_bf16 v[88:103], a[116:119], v[192:195], v[88:103]
    s_add_u32 s20, s50, 53248
    s_and_b32 s20, s20, 0xffff
    s_add_u32 s20, s20, s41
    buffer_load_dwordx4 v[240:243], v19, s[84:87], s20 offen offset:0 sc1
    s_waitcnt vmcnt(11)
    v_mfma_f32_32x32x16_bf16 v[112:127], a[120:123], v[196:199], v[112:127]
    v_mfma_f32_32x32x16_bf16 v[88:103], a[124:127], v[196:199], v[88:103]
    buffer_load_dwordx4 v[244:247], v19, s[84:87], s20 offen offset:2048 sc1
    s_waitcnt vmcnt(11)
    v_mfma_f32_32x32x16_bf16 v[112:127], a[128:131], v[200:203], v[112:127]
    v_mfma_f32_32x32x16_bf16 v[88:103], a[132:135], v[200:203], v[88:103]
    s_add_u32 s20, s50, 57344
    s_and_b32 s20, s20, 0xffff
    s_add_u32 s20, s20, s41
    buffer_load_dwordx4 v[248:251], v19, s[84:87], s20 offen offset:0 sc1
    s_waitcnt vmcnt(11)
    v_mfma_f32_32x32x16_bf16 v[112:127], a[136:139], v[204:207], v[112:127]
    v_mfma_f32_32x32x16_bf16 v[88:103], a[140:143], v[204:207], v[88:103]
    buffer_load_dwordx4 v[252:255], v19, s[84:87], s20 offen offset:2048 sc1
    s_waitcnt vmcnt(11)
    v_mfma_f32_32x32x16_bf16 v[112:127], a[144:147], v[208:211], v[112:127]
    v_mfma_f32_32x32x16_bf16 v[88:103], a[148:151], v[208:211], v[88:103]
    s_add_u32 s20, s50, 61440
    s_and_b32 s20, s20, 0xffff
    s_add_u32 s20, s20, s41
    buffer_load_dwordx4 v[136:139], v19, s[84:87], s20 offen offset:0 sc1
    s_waitcnt vmcnt(11)
    v_mfma_f32_32x32x16_bf16 v[112:127], a[152:155], v[212:215], v[112:127]
    v_mfma_f32_32x32x16_bf16 v[88:103], a[156:159], v[212:215], v[88:103]
    buffer_load_dwordx4 v[140:143], v19, s[84:87], s20 offen offset:2048 sc1
    s_waitcnt vmcnt(11)
    v_mfma_f32_32x32x16_bf16 v[112:127], a[160:163], v[216:219], v[112:127]
    v_mfma_f32_32x32x16_bf16 v[88:103], a[164:167], v[216:219], v[88:103]
    s_waitcnt vmcnt(10)
    v_mfma_f32_32x32x16_bf16 v[112:127], a[168:171], v[220:223], v[112:127]
    v_mfma_f32_32x32x16_bf16 v[88:103], a[172:175], v[220:223], v[88:103]
    s_waitcnt vmcnt(9)
    v_mfma_f32_32x32x16_bf16 v[112:127], a[176:179], v[224:227], v[112:127]
    v_mfma_f32_32x32x16_bf16 v[88:103], a[180:183], v[224:227], v[88:103]
    s_waitcnt vmcnt(8)
    v_mfma_f32_32x32x16_bf16 v[112:127], a[184:187], v[228:231], v[112:127]
    v_mfma_f32_32x32x16_bf16 v[88:103], a[188:191], v[228:231], v[88:103]
    s_waitcnt vmcnt(7)
    v_mfma_f32_32x32x16_bf16 v[112:127], a[192:195], v[232:235], v[112:127]
    v_mfma_f32_32x32x16_bf16 v[88:103], a[196:199], v[232:235], v[88:103]
    s_waitcnt vmcnt(6)
    v_mfma_f32_32x32x16_bf16 v[112:127], a[200:203], v[236:239], v[112:127]
    v_mfma_f32_32x32x16_bf16 v[88:103], a[204:207], v[236:239], v[88:103]
    s_waitcnt vmcnt(5)
    v_mfma_f32_32x32x16_bf16 v[112:127], a[208:211], v[240:243], v[112:127]
    v_mfma_f32_32x32x16_bf16 v[88:103], a[212:215], v[240:243], v[88:103]
    s_waitcnt vmcnt(4)
    v_mfma_f32_32x32x16_bf16 v[112:127], a[216:219], v[244:247], v[112:127]
    v_mfma_f32_32x32x16_bf16 v[88:103], a[220:223], v[244:247], v[88:103]
    s_waitcnt vmcnt(3)
    v_mfma_f32_32x32x16_bf16 v[112:127], a[224:227], v[248:251], v[112:127]
    v_mfma_f32_32x32x16_bf16 v[88:103], a[228:231], v[248:251], v[88:103]
    s_waitcnt vmcnt(2)
    v_mfma_f32_32x32x16_bf16 v[112:127], a[232:235], v[252:255], v[112:127]
    v_mfma_f32_32x32x16_bf16 v[88:103], a[236:239], v[252:255], v[88:103]
    s_waitcnt vmcnt(1)
    v_mfma_f32_32x32x16_bf16 v[112:127], a[240:243], v[136:139], v[112:127]
    v_mfma_f32_32x32x16_bf16 v[88:103], a[244:247], v[136:139], v[88:103]
    s_waitcnt vmcnt(0)
    v_mfma_f32_32x32x16_bf16 v[112:127], a[248:251], v[140:143], v[112:127]
    v_mfma_f32_32x32x16_bf16 v[88:103], a[252:255], v[140:143], v[88:103]
    s_cmp_ge_u32 s22, 64
    s_cbranch_scc1 mega_kernel_x_hnp
    s_mov_b32 s46, 2
    buffer_load_dwordx4 v[24:27], v2, s[84:87], s26 offen offset:0
    buffer_load_dwordx4 v[28:31], v2, s[84:87], s26 offen offset:2048
    buffer_load_dwordx4 v[32:35], v2, s[84:87], s48 offen offset:0
    buffer_load_dwordx4 v[36:39], v2, s[84:87], s48 offen offset:2048
    buffer_load_dwordx4 v[40:43], v2, s[84:87], s27 offen offset:0
    buffer_load_dwordx4 v[44:47], v2, s[84:87], s27 offen offset:1024
    buffer_load_dwordx4 v[48:51], v2, s[84:87], s27 offen offset:2048
    buffer_load_dwordx4 v[52:55], v2, s[84:87], s27 offen offset:3072
    buffer_load_dwordx4 v[56:59], v2, s[84:87], s49 offen offset:0
    buffer_load_dwordx4 v[60:63], v2, s[84:87], s49 offen offset:1024
    buffer_load_dwordx4 v[64:67], v2, s[84:87], s49 offen offset:2048
    buffer_load_dwordx4 v[68:71], v2, s[84:87], s49 offen offset:3072
    buffer_load_dwordx4 v[72:75], v2, s[84:87], s28 offen offset:0
    buffer_load_dwordx4 v[76:79], v2, s[84:87], s28 offen offset:1024
    buffer_load_dwordx4 v[80:83], v2, s[84:87], s28 offen offset:2048
    buffer_load_dwordx4 v[84:87], v2, s[84:87], s28 offen offset:3072
mega_kernel_x_hnp:
    s_mov_b32 vcc_lo, 0xffff0000
    s_mov_b32 vcc_hi, 0xffff0000
    s_nop 9
    v_cndmask_b32 v112, v112, v88, vcc
    v_cndmask_b32 v113, v113, v89, vcc
    v_cndmask_b32 v114, v114, v90, vcc
    v_cndmask_b32 v115, v115, v91, vcc
    v_cndmask_b32 v116, v116, v92, vcc
    v_cndmask_b32 v117, v117, v93, vcc
    v_cndmask_b32 v118, v118, v94, vcc
    v_cndmask_b32 v119, v119, v95, vcc
    v_cndmask_b32 v120, v120, v96, vcc
    v_cndmask_b32 v121, v121, v97, vcc
    v_cndmask_b32 v122, v122, v98, vcc
    v_cndmask_b32 v123, v123, v99, vcc
    v_cndmask_b32 v124, v124, v100, vcc
    v_cndmask_b32 v125, v125, v101, vcc
    v_cndmask_b32 v126, v126, v102, vcc
    v_cndmask_b32 v127, v127, v103, vcc
    ds_write_b128 v17, v[112:115] offset:0
    ds_write_b128 v17, v[116:119] offset:1024
    ds_write_b128 v17, v[120:123] offset:2048
    ds_write_b128 v17, v[124:127] offset:3072
    s_waitcnt lgkmcnt(0)
    s_barrier
    s_cmp_ge_u32 s16, 2
    s_cbranch_scc1 mega_kernel_x_nxt
    ds_read_b128 v[112:115], v16 offset:0
    ds_read_b128 v[88:91], v16 offset:256
    ds_read_b128 v[116:119], v16 offset:4096
    ds_read_b128 v[92:95], v16 offset:4352
    ds_read_b128 v[120:123], v16 offset:8192
    ds_read_b128 v[96:99], v16 offset:8448
    ds_read_b128 v[124:127], v16 offset:12288
    ds_read_b128 v[100:103], v16 offset:12544
    s_and_b32 s20, s17, 1
    s_lshl_b32 s20, s20, 16
    s_add_u32 s42, s42, s20
    s_waitcnt lgkmcnt(0)
    v_pk_add_f32 v[112:113], v[112:113], v[88:89]
    v_pk_add_f32 v[114:115], v[114:115], v[90:91]
    v_pk_add_f32 v[116:117], v[116:117], v[92:93]
    v_pk_add_f32 v[118:119], v[118:119], v[94:95]
    v_pk_add_f32 v[120:121], v[120:121], v[96:97]
    v_pk_add_f32 v[122:123], v[122:123], v[98:99]
    v_pk_add_f32 v[124:125], v[124:125], v[100:101]
    v_pk_add_f32 v[126:127], v[126:127], v[102:103]
    v_pk_add_f32 v[112:113], v[112:113], v[116:117]
    v_pk_add_f32 v[114:115], v[114:115], v[118:119]
    v_pk_add_f32 v[120:121], v[120:121], v[124:125]
    v_pk_add_f32 v[122:123], v[122:123], v[126:127]
    v_pk_add_f32 v[112:113], v[112:113], v[120:121]
    v_pk_add_f32 v[114:115], v[114:115], v[122:123]
    v_cvt_pk_bf16_f32 v132, v112, v113
    v_cvt_pk_bf16_f32 v133, v114, v115
    buffer_store_dwordx2 v[132:133], v18, s[12:15], s42 offen
mega_kernel_x_nxt:
    s_cmp_lg_u32 s46, 0
    s_cbranch_scc1 mega_kernel_x_att
    s_cmp_lt_u32 s22, 64
    s_cbranch_scc1 mega_kernel_x_ldq
    s_branch mega_kernel_x_fin
mega_kernel_x_dx:
    buffer_load_dword v3, off, s[88:91], 0 offset:204 sc1
    v_and_b32 v4, 15, v1
    v_lshrrev_b32 v5, 4, v1
    v_lshlrev_b32 v170, 3, v1
    v_and_b32 v168, 1, v4
    v_lshlrev_b32 v168, 4, v168
    v_mov_b32 v169, 0x3f80
    v_lshlrev_b32 v169, v168, v169
    v_lshrrev_b32 v4, 2, v4
    v_cmp_eq_u32 vcc, v4, v5
    v_mov_b32 v168, 0
    s_waitcnt vmcnt(0)
    v_cndmask_b32 v169, 0, v169, vcc
    v_readfirstlane_b32 s20, v3
    s_and_b32 s21, s22, 1
    s_lshl_b32 s21, s21, 20
    s_lshl_b32 s26, s18, 14
    s_add_u32 s26, s26, s21
    s_add_u32 s26, s26, 67108864
    s_lshr_b32 s20, s20, 15
    s_cmp_gt_u32 s20, s100
    s_cselect_b32 s20, 8192, 0
    s_add_u32 s26, s26, s20
    s_bfe_u32 s20, s18, 0x10001
    s_lshl_b32 s20, s20, 12
    s_add_u32 s26, s26, s20
    s_add_u32 s48, s26, 524288
    s_lshr_b32 s20, s16, 1
    s_lshl_b32 s20, s20, 11
    s_xor_b32 s27, s26, 4096
    s_add_u32 s27, s27, s20
    s_add_u32 s49, s27, 524288
    s_lshl_b32 s20, s16, 10
    s_add_u32 s26, s26, s20
    s_add_u32 s48, s48, s20
    v_add_u32 v171, s20, v2
mega_kernel_x_dr:
    buffer_load_dword v3, v13, s[84:87], 0 offen sc1
    s_waitcnt vmcnt(0)
    v_cmp_gt_u32 vcc, s22, v3
    s_cbranch_vccz mega_kernel_x_dp
    s_sleep 2
    s_branch mega_kernel_x_dr
mega_kernel_x_dp:
    buffer_load_dwordx2 v[136:137], v170, s[84:87], s26 offen offset:0 sc1
    buffer_load_dwordx2 v[138:139], v170, s[84:87], s26 offen offset:512 sc1
    buffer_load_dwordx2 v[140:141], v170, s[84:87], s48 offen offset:0 sc1
    buffer_load_dwordx2 v[142:143], v170, s[84:87], s48 offen offset:512 sc1
    s_waitcnt vmcnt(0)
    v_mfma_f32_16x16x16_bf16 v[172:175], v[136:137], v[168:169], 0
    v_mfma_f32_16x16x16_bf16 v[176:179], v[138:139], v[168:169], 0
    v_mfma_f32_16x16x16_bf16 v[172:175], v[140:141], v[168:169], v[172:175]
    v_mfma_f32_16x16x16_bf16 v[176:179], v[142:143], v[168:169], v[176:179]
    v_or3_b32 v3, v136, v138, v140
    v_or_b32 v3, v3, v142
    v_and_b32 v3, 1, v3
    v_cmp_ne_u32 vcc, 0, v3
    s_nop 3
    s_cbranch_vccnz mega_kernel_x_dp
    v_cvt_pk_bf16_f32 v136, v172, v173
    v_cvt_pk_bf16_f32 v137, v174, v175
    v_cvt_pk_bf16_f32 v138, v176, v177
    v_cvt_pk_bf16_f32 v139, v178, v179
    ds_write_b128 v171, v[136:139] offset:20480
    s_waitcnt lgkmcnt(0)
    s_barrier
    ds_read_b128 v[88:91], v2 offset:20480
    ds_read_b128 v[92:95], v2 offset:21504
    ds_read_b128 v[96:99], v2 offset:22528
    ds_read_b128 v[100:103], v2 offset:23552
mega_kernel_x_dv:
    buffer_load_dwordx2 v[104:105], v170, s[84:87], s27 offen offset:0 sc1
    buffer_load_dwordx2 v[106:107], v170, s[84:87], s49 offen offset:0 sc1
    buffer_load_dwordx2 v[108:109], v170, s[84:87], s27 offen offset:1024 sc1
    buffer_load_dwordx2 v[110:111], v170, s[84:87], s49 offen offset:1024 sc1
    s_waitcnt vmcnt(0) lgkmcnt(0)
    v_or3_b32 v3, v104, v106, v108
    v_or_b32 v3, v3, v110
    v_and_b32 v3, 1, v3
    v_cmp_ne_u32 vcc, 0, v3
    s_cbranch_vccnz mega_kernel_x_dv
    s_branch mega_kernel_x_rd
mega_kernel_x_fin:
mega_kernel_cE:
    s_endpgm
.section .rodata,"a"
.p2align 6
.amdhsa_kernel mega_kernel
  .amdhsa_next_free_vgpr 512
  .amdhsa_next_free_sgpr 102
  .amdhsa_accum_offset 256
  .amdhsa_group_segment_fixed_size 0
  .amdhsa_kernarg_size 104
  .amdhsa_user_sgpr_count 2
  .amdhsa_user_sgpr_kernarg_segment_ptr 1
  .amdhsa_system_sgpr_workgroup_id_x 1
.end_amdhsa_kernel
```

```asm
; @launch kernel=mega_kernel grid=(256,1,1) block=(256,1,1) lds=161792
.amdgcn_target "amdgcn-amd-amdhsa--gfx950"
.text
.globl mega_kernel
.p2align 8
.type mega_kernel,@function
mega_kernel:
s_cmp_ge_u32 s2, 256
s_cbranch_scc1 L_exit
s_load_dwordx2 s[84:85], s[0:1], 96
s_load_dwordx2 s[88:89], s[0:1], 88
s_getreg_b32 s93, hwreg(HW_REG_XCC_ID)
s_and_b32 s93, s93, 7
s_lshl_b32 s93, s93, 2
s_lshr_b32 s93, 0x76541302, s93
s_and_b32 s93, s93, 7
v_lshrrev_b32 v1, 6, v0
v_mov_b32 v4, 0
v_readfirstlane_b32 s80, v1
v_mov_b32 v5, 0
v_mov_b32 v6, 0
v_mov_b32 v7, 0
s_mov_b32 s83, 0
s_lshl_b32 s101, s2, 2
s_add_u32 s101, s101, s80
s_lshl_b32 s101, s101, 8
s_add_u32 s101, s101, 230686720
s_waitcnt lgkmcnt(0)
s_mov_b32 s86, 268435456
s_mov_b32 s87, 0x00020000
s_mov_b32 s90, 256
s_mov_b32 s91, 0x00020000
s_mov_b32 s98, s80
s_cmp_lg_u32 s80, 0
s_cbranch_scc1 L_st0
v_mov_b32 v10, 1
s_lshl_b32 s81, s93, 5
s_mov_b64 exec, 1
buffer_atomic_add v10, off, s[88:91], s81 offset:4 sc0
s_lshl_b32 s81, s2, 7
s_add_u32 s81, s81, 71303168
s_mov_b64 exec, 15
v_and_b32 v1, 1, v0
v_lshlrev_b32 v1, 15, v1
v_lshrrev_b32 v2, 1, v0
v_lshl_add_u32 v1, v2, 6, v1
buffer_store_dword v4, v1, s[84:87], s81 offen sc1
s_mov_b64 exec, -1
L_st0:
s_load_dwordx2 s[72:73], s[0:1], 8
v_mov_b32 v4, 0
v_mov_b32 v5, 0
v_mov_b32 v6, 0
v_mov_b32 v7, 0
v_lshlrev_b32 v1, 4, v0
s_lshl_b32 s81, s2, 13
s_add_u32 s81, s81, 67108864
s_add_u32 s79, s81, 4096
buffer_store_dwordx4 v[4:7], v1, s[84:87], s81 offen sc1
buffer_store_dwordx4 v[4:7], v1, s[84:87], s79 offen sc1
s_lshl_b32 s81, s2, 12
s_add_u32 s81, s81, 70254592
buffer_store_dwordx4 v[4:7], v1, s[84:87], s81 offen sc1
s_cmp_ge_u32 s2, 64
s_cbranch_scc1 L_gi
v_bfe_u32 v2, v0, 3, 1
v_lshlrev_b32 v2, 11, v2
v_and_b32 v3, 3, v0
v_lshl_add_u32 v2, v3, 5, v2
v_bfe_u32 v3, v0, 4, 3
v_lshl_add_u32 v2, v3, 2, v2
v_bfe_u32 v3, v0, 2, 1
v_lshl_add_u32 v2, v3, 1, v2
s_lshr_b32 s81, s2, 2
s_lshl_b32 s81, s81, 7
s_and_b32 s79, s2, 3
s_lshl_b32 s79, s79, 12
s_add_u32 s81, s81, s79
s_waitcnt lgkmcnt(0)
s_mov_b32 s74, 16384
s_mov_b32 s75, 0x00020000
buffer_load_ushort v8, v2, s[72:75], s81 offen
v_mov_b32 v9, -1
v_and_b32 v1, 31, v0
v_lshlrev_b32 v1, 1, v1
v_bfe_u32 v3, v0, 5, 2
v_lshl_add_u32 v1, v3, 8, v1
v_lshrrev_b32 v3, 7, v0
v_lshl_add_u32 v1, v3, 14, v1
v_cmp_gt_u32 vcc, 128, v0
s_lshr_b32 s81, s2, 2
s_lshl_b32 s81, s81, 10
s_and_b32 s79, s2, 3
s_lshl_b32 s79, s79, 6
s_add_u32 s81, s81, s79
s_add_u32 s81, s81, 69206016
s_waitcnt vmcnt(0)
v_min_u32 v8, 0xfffe, v8
v_cndmask_b32 v8, v9, v8, vcc
buffer_store_short v8, v1, s[84:87], s81 offen sc1
L_gi:
s_waitcnt lgkmcnt(0)
s_cmp_lg_u32 s80, 0
s_cbranch_scc1 L_st1
s_mov_b64 exec, 1
s_waitcnt vmcnt(4)
ds_write_b32 v4, v10
s_mov_b64 exec, -1
s_waitcnt lgkmcnt(0)
L_st1:
s_barrier
ds_read_b32 v2, v4
s_waitcnt lgkmcnt(0)
v_readfirstlane_b32 s94, v2
s_barrier
s_sub_u32 s81, s93, 2
s_cmp_ge_u32 s81, 2
s_cbranch_scc1 L_nopr
s_cmp_lg_u32 s80, 0
s_cbranch_scc1 L_prd
v_lshlrev_b32 v1, 4, v0
s_and_b32 s81, s2, 127
s_lshl_b32 s81, s81, 14
s_add_u32 s81, s81, 67108864
s_add_u32 s77, s81, 8192
buffer_store_dwordx4 v[4:7], v1, s[84:87], s81 offen sc1
buffer_store_dwordx4 v[4:7], v1, s[84:87], s77 offen sc1
s_waitcnt vmcnt(0)
s_memtime s[70:71]
buffer_store_dwordx4 v[4:7], v1, s[84:87], s81 offen sc1
s_waitcnt vmcnt(0)
s_memtime s[72:73]
buffer_store_dwordx4 v[4:7], v1, s[84:87], s77 offen sc1
s_waitcnt vmcnt(0)
buffer_store_dwordx4 v[4:7], v1, s[84:87], s77 offen sc1
s_waitcnt vmcnt(0)
s_memtime s[74:75]
buffer_store_dwordx4 v[4:7], v1, s[84:87], s81 offen sc1
s_waitcnt vmcnt(0)
s_memtime s[76:77]
s_waitcnt lgkmcnt(0)
s_sub_u32 s76, s76, s74
s_sub_u32 s74, s74, s72
s_sub_u32 s72, s72, s70
s_add_u32 s72, s72, s76
s_cmp_lt_u32 s74, s72
s_cselect_b32 s81, 0x10001, 1
v_mov_b32 v8, s81
s_mov_b64 exec, 1
buffer_atomic_add v8, off, s[88:91], 0 offset:204 sc1
s_mov_b64 exec, -1
L_prd:
s_barrier
L_nopr:
s_mov_b32 s97, 0
s_mov_b32 s100, 64
L_fast:
s_mov_b32 s96, 1
s_mov_b32 s30, s93
s_and_b32 s31, s94, 31
s_cmp_lt_u32 s93, 2
s_cbranch_scc1 L_recf
s_sub_u32 s92, s93, 2
s_lshl_b32 s92, s92, 5
s_add_u32 s92, s92, s31
s_branch L_bulk
L_redo:
s_waitcnt vmcnt(0) lgkmcnt(0)
s_barrier
v_readlane_b32 s100, v36, 2
v_readlane_b32 s81, v36, 3
s_mov_b32 s97, 1
s_nop 2
s_add_u32 s100, s100, s81
s_mov_b32 s95, s94
v_readlane_b32 s81, v36, 0
s_cmp_gt_u32 s93, 0
s_nop 2
s_cselect_b32 s81, s81, 0
s_add_u32 s95, s95, s81
v_readlane_b32 s81, v36, 1
s_cmp_gt_u32 s93, 1
s_nop 2
s_cselect_b32 s81, s81, 0
s_add_u32 s95, s95, s81
v_readlane_b32 s81, v36, 2
s_cmp_gt_u32 s93, 2
s_nop 2
s_cselect_b32 s81, s81, 0
s_add_u32 s95, s95, s81
v_readlane_b32 s81, v36, 3
s_cmp_gt_u32 s93, 3
s_nop 2
s_cselect_b32 s81, s81, 0
s_add_u32 s95, s95, s81
v_readlane_b32 s81, v36, 4
s_cmp_gt_u32 s93, 4
s_nop 2
s_cselect_b32 s81, s81, 0
s_add_u32 s95, s95, s81
v_readlane_b32 s81, v36, 5
s_cmp_gt_u32 s93, 5
s_nop 2
s_cselect_b32 s81, s81, 0
s_add_u32 s95, s95, s81
v_readlane_b32 s81, v36, 6
s_cmp_gt_u32 s93, 6
s_nop 2
s_cselect_b32 s81, s81, 0
s_add_u32 s95, s95, s81
L_slow:
s_mov_b32 s96, 0
s_lshr_b32 s30, s95, 5
s_and_b32 s31, s95, 31
s_cmp_lt_u32 s95, 64
s_cbranch_scc1 L_recs
s_sub_u32 s92, s95, 64
s_branch L_bulk
L_exit:
s_endpgm
L_recf:
s_load_dwordx2 s[4:5], s[0:1], 96
s_load_dwordx2 s[12:13], s[0:1], 88
s_load_dwordx2 s[50:51], s[0:1], 16
s_load_dwordx2 s[52:53], s[0:1], 24
s_load_dwordx2 s[54:55], s[0:1], 32
s_load_dwordx2 s[56:57], s[0:1], 40
s_load_dwordx2 s[58:59], s[0:1], 8
v_lshrrev_b32 v3, 6, v0
v_and_b32 v40, 63, v0
v_readfirstlane_b32 s20, v3
v_lshrrev_b32 v41, 4, v40
v_and_b32 v42, 15, v40
v_lshlrev_b32 v1, 4, v40
s_mov_b32 s49, 0
s_waitcnt lgkmcnt(0)
s_mov_b32 s6, 268435456
s_mov_b32 s7, 0x00020000
s_mov_b32 s14, 256
s_mov_b32 s15, 0x00020000
s_mov_b32 s10, 8388608
s_mov_b32 s11, 0x00020000
s_mov_b32 s26, 0x00030003
s_mov_b32 s27, 0x00030003
s_mov_b32 s28, 0xcccccccc
s_mov_b32 s29, 0xcccccccc
s_mov_b32 s32, 0x33333333
s_mov_b32 s33, 0x33333333
s_mov_b32 s34, 0x3e0293ee
s_lshl_b32 s22, s20, 2
v_xor_b32 v3, s22, v42
v_lshlrev_b32 v3, 4, v3
v_lshl_add_u32 v4, v41, 4, s20
v_lshl_add_u32 v44, v4, 13, v3
s_lshl_b32 s22, s30, 22
s_lshl_b32 s23, s31, 8
s_add_u32 s22, s22, s23
v_add_u32 v44, s22, v44
s_lshr_b32 s22, s20, 1
s_lshl_b32 s22, s22, 5
s_and_b32 s23, s20, 1
s_lshl_b32 s23, s23, 2
s_add_u32 s22, s22, s23
s_lshl_b32 s23, s31, 7
s_add_u32 s22, s22, s23
v_add_u32 v4, s22, v41
v_lshl_add_u32 v45, v4, 11, v3
s_lshl_b32 s22, s30, 10
v_add_u32 v45, s22, v45
s_lshl_b32 s48, s20, 10
s_mov_b32 s8, s50
s_mov_b32 s9, s51
s_add_u32 m0, s48, 0
s_mov_b32 s22, 0
buffer_load_dwordx4 v44, s[8:11], s22 offen  lds
s_add_u32 m0, s48, 4096
s_mov_b32 s22, 32768
buffer_load_dwordx4 v44, s[8:11], s22 offen  lds
s_add_u32 m0, s48, 8192
s_mov_b32 s22, 65536
buffer_load_dwordx4 v44, s[8:11], s22 offen  lds
s_add_u32 m0, s48, 12288
s_mov_b32 s22, 98304
buffer_load_dwordx4 v44, s[8:11], s22 offen  lds
s_add_u32 m0, s48, 16384
s_mov_b32 s22, 524288
buffer_load_dwordx4 v44, s[8:11], s22 offen  lds
s_add_u32 m0, s48, 20480
s_mov_b32 s22, 557056
buffer_load_dwordx4 v44, s[8:11], s22 offen  lds
s_add_u32 m0, s48, 24576
s_mov_b32 s22, 589824
buffer_load_dwordx4 v44, s[8:11], s22 offen  lds
s_add_u32 m0, s48, 28672
s_mov_b32 s22, 622592
buffer_load_dwordx4 v44, s[8:11], s22 offen  lds
s_add_u32 m0, s48, 32768
s_mov_b32 s22, 1048576
buffer_load_dwordx4 v44, s[8:11], s22 offen  lds
s_add_u32 m0, s48, 36864
s_mov_b32 s22, 1081344
buffer_load_dwordx4 v44, s[8:11], s22 offen  lds
s_add_u32 m0, s48, 40960
s_mov_b32 s22, 1114112
buffer_load_dwordx4 v44, s[8:11], s22 offen  lds
s_add_u32 m0, s48, 45056
s_mov_b32 s22, 1146880
buffer_load_dwordx4 v44, s[8:11], s22 offen  lds
s_waitcnt vmcnt(12)
s_barrier
s_or_b32 s81, s97, s98
s_cmp_lg_u32 s81, 0
s_cbranch_scc1 L_h0_1
s_lshl_b32 s81, s93, 5
v_mov_b32 v38, 1
s_mov_b64 exec, 1
buffer_atomic_add v38, off, s[88:91], s81 sc1
s_mov_b64 exec, -1
L_h0_1:
s_add_u32 m0, s48, 49152
s_mov_b32 s22, 1572864
buffer_load_dwordx4 v44, s[8:11], s22 offen  lds
s_add_u32 m0, s48, 53248
s_mov_b32 s22, 1605632
buffer_load_dwordx4 v44, s[8:11], s22 offen  lds
s_add_u32 m0, s48, 57344
s_mov_b32 s22, 1638400
buffer_load_dwordx4 v44, s[8:11], s22 offen  lds
s_add_u32 m0, s48, 61440
s_mov_b32 s22, 1671168
buffer_load_dwordx4 v44, s[8:11], s22 offen  lds
s_add_u32 m0, s48, 65536
s_mov_b32 s22, 2097152
buffer_load_dwordx4 v44, s[8:11], s22 offen  lds
s_add_u32 m0, s48, 69632
s_mov_b32 s22, 2129920
buffer_load_dwordx4 v44, s[8:11], s22 offen  lds
s_add_u32 m0, s48, 73728
s_mov_b32 s22, 2162688
buffer_load_dwordx4 v44, s[8:11], s22 offen  lds
s_add_u32 m0, s48, 77824
s_mov_b32 s22, 2195456
buffer_load_dwordx4 v44, s[8:11], s22 offen  lds
s_add_u32 m0, s48, 81920
s_mov_b32 s22, 2621440
buffer_load_dwordx4 v44, s[8:11], s22 offen  lds
s_add_u32 m0, s48, 86016
s_mov_b32 s22, 2654208
buffer_load_dwordx4 v44, s[8:11], s22 offen  lds
s_add_u32 m0, s48, 90112
s_mov_b32 s22, 2686976
buffer_load_dwordx4 v44, s[8:11], s22 offen  lds
s_add_u32 m0, s48, 94208
s_mov_b32 s22, 2719744
buffer_load_dwordx4 v44, s[8:11], s22 offen  lds
s_add_u32 m0, s48, 98304
s_mov_b32 s22, 3145728
buffer_load_dwordx4 v44, s[8:11], s22 offen  lds
s_add_u32 m0, s48, 102400
s_mov_b32 s22, 3178496
buffer_load_dwordx4 v44, s[8:11], s22 offen  lds
s_add_u32 m0, s48, 106496
s_mov_b32 s22, 3211264
buffer_load_dwordx4 v44, s[8:11], s22 offen  lds
s_add_u32 m0, s48, 110592
s_mov_b32 s22, 3244032
buffer_load_dwordx4 v44, s[8:11], s22 offen  lds
s_add_u32 m0, s48, 114688
s_mov_b32 s22, 3670016
buffer_load_dwordx4 v44, s[8:11], s22 offen  lds
s_add_u32 m0, s48, 118784
s_mov_b32 s22, 3702784
buffer_load_dwordx4 v44, s[8:11], s22 offen  lds
s_add_u32 m0, s48, 122880
s_mov_b32 s22, 3735552
buffer_load_dwordx4 v44, s[8:11], s22 offen  lds
s_add_u32 m0, s48, 126976
s_mov_b32 s22, 3768320
buffer_load_dwordx4 v44, s[8:11], s22 offen  lds
s_lshl_b32 s22, s30, 5
s_add_u32 s22, s22, s31
s_lshl_b32 s38, s22, 14
s_xor_b32 s22, s22, 32
s_lshl_b32 s37, s22, 14
s_add_u32 s38, s38, 67108864
s_add_u32 s37, s37, 67108864
s_lshl_b32 s46, s30, 19
s_add_u32 s46, s46, 70254592
s_mul_i32 s22, s31, 8448
s_add_u32 s47, s46, s22
s_mul_i32 s22, s20, 67584
s_add_u32 s46, s46, s22
s_lshl_b32 s22, s31, 6
s_add_u32 s46, s46, s22
s_add_u32 s61, s46, 33792
s_mul_i32 s22, s20, 2048
s_add_u32 s25, s47, s22
s_lshl_b32 s35, s30, 13
s_add_u32 s35, s35, 69206016
v_lshrrev_b32 v53, 2, v42
v_lshlrev_b32 v53, 1, v53
v_and_b32 v54, 1, v42
v_add_u32 v55, v53, v54
v_mov_b32 v14, 0
v_mov_b32 v15, 0
v_mov_b32 v2, 0x4444
v_mov_b32 v3, 0xeeee
v_cndmask_b32 v2, v2, v3, s[28:29]
s_lshl_b32 s22, s20, 12
v_add_u32 v32, s22, v1
v_add_u32 v33, 0x10000, v32
v_add_u32 v5, 0x10000, v1
v_add_u32 v6, 131072, v1
v_and_b32 v3, 3, v42
v_bfe_u32 v43, v40, 1, 1
v_lshlrev_b32 v7, 13, v43
v_and_b32 v43, 1, v40
v_lshl_add_u32 v7, v43, 7, v7
s_lshl_b32 s22, s31, 8
s_add_u32 s23, s22, 71311360
v_add_u32 v7, s23, v7
s_cmp_lg_u32 s20, 0
s_cbranch_scc1 L_rf_flk
s_lshl_b32 s23, s30, 7
s_add_u32 s22, s22, s23
s_add_u32 s22, s22, 71327744
v_bfrev_b32 v7, 1
v_writelane_b32 v7, s22, 0
L_rf_flk:
v_lshlrev_b32 v11, 3, v40
v_lshlrev_b32 v10, 8, v55
v_lshl_add_u32 v10, v41, 4, v10
v_mul_u32_u24 v8, 8448, v41
v_lshl_add_u32 v8, v3, 4, v8
v_lshrrev_b32 v4, 2, v42
v_mul_u32_u24 v4, 2048, v4
v_add_u32 v8, v4, v8
v_lshrrev_b32 v9, 1, v41
v_lshlrev_b32 v9, 5, v9
v_and_b32 v4, 1, v42
v_lshl_add_u32 v9, v4, 4, v9
v_and_b32 v4, 1, v41
v_lshl_add_u32 v9, v4, 3, v9
s_lshr_b32 s22, s31, 2
s_lshl_b32 s22, s22, 10
s_and_b32 s23, s31, 3
s_lshl_b32 s23, s23, 6
s_add_u32 s22, s22, s23
v_add_u32 v9, s22, v9
v_lshrrev_b32 v4, 2, v42
v_lshlrev_b32 v12, 8, v4
v_lshl_add_u32 v12, v41, 6, v12
v_lshl_add_u32 v12, v3, 4, v12
v_lshlrev_b32 v13, 6, v41
v_lshl_add_u32 v13, v42, 2, v13
v_cmp_eq_u32 vcc, 0, v3
v_mov_b32 v28, 0x3f803f80
v_mov_b32 v29, 0x3f803f80
v_cndmask_b32 v34, 0, 1, vcc
v_mov_b32 v30, 0x3f803f80
v_mov_b32 v31, 0x3f803f80
v_and_b32 v49, 1, v42
v_lshlrev_b32 v49, 4, v49
v_mov_b32 v50, 0x3f80
v_lshlrev_b32 v50, v49, v50
v_lshrrev_b32 v51, 2, v42
v_cmp_eq_u32 vcc, v51, v41
v_mov_b32 v24, v50
v_cndmask_b32 v52, 0, v50, s[28:29]
v_cndmask_b32 v53, 0, v50, s[32:33]
v_cndmask_b32 v16, 0, v52, vcc
v_cndmask_b32 v17, 0, v53, vcc
v_mov_b32 v25, v50
v_mov_b32 v26, v50
v_mov_b32 v27, v50
v_bfe_u32 v60, v40, 3, 1
v_bfe_u32 v49, v40, 2, 1
v_and_b32 v50, 1, v41
v_lshrrev_b32 v51, 1, v41
v_lshlrev_b32 v52, 3, v60
v_lshl_add_u32 v52, v50, 2, v52
v_lshl_add_u32 v53, v51, 4, v52
v_add_u32 v53, v53, v49
v_and_b32 v54, 3, v40
s_lshl_b32 s22, s20, 2
v_add_u32 v55, s22, v54
v_xor_b32 v55, v55, v52
v_lshlrev_b32 v55, 4, v55
v_lshl_add_u32 v46, v53, 8, v55
v_lshlrev_b32 v55, 4, v52
v_lshl_add_u32 v55, v54, 3, v55
v_lshl_add_u32 v47, v53, 8, v55
s_waitcnt vmcnt(28)
s_barrier
v_add_u32 v48, 0, v46
ds_read_b64_tr_b16 a[0:1], v48
ds_read_b64_tr_b16 a[2:3], v48 offset:512
ds_read_b64_tr_b16 a[4:5], v48 offset:8192
ds_read_b64_tr_b16 a[6:7], v48 offset:8704
ds_read_b64_tr_b16 a[8:9], v48 offset:8
ds_read_b64_tr_b16 a[10:11], v48 offset:520
ds_read_b64_tr_b16 a[12:13], v48 offset:8200
ds_read_b64_tr_b16 a[14:15], v48 offset:8712
s_waitcnt lgkmcnt(0)
s_barrier
s_mov_b32 s8, s52
s_mov_b32 s9, s53
s_add_u32 m0, s48, 0
s_mov_b32 s22, 0
buffer_load_dwordx4 v44, s[8:11], s22 offen  lds
s_add_u32 m0, s48, 4096
s_mov_b32 s22, 32768
buffer_load_dwordx4 v44, s[8:11], s22 offen  lds
s_add_u32 m0, s48, 8192
s_mov_b32 s22, 65536
buffer_load_dwordx4 v44, s[8:11], s22 offen  lds
s_add_u32 m0, s48, 12288
s_mov_b32 s22, 98304
buffer_load_dwordx4 v44, s[8:11], s22 offen  lds
s_waitcnt vmcnt(28)
s_barrier
v_add_u32 v48, 16384, v46
ds_read_b64_tr_b16 a[16:17], v48
ds_read_b64_tr_b16 a[18:19], v48 offset:512
ds_read_b64_tr_b16 a[20:21], v48 offset:8192
ds_read_b64_tr_b16 a[22:23], v48 offset:8704
ds_read_b64_tr_b16 a[24:25], v48 offset:8
ds_read_b64_tr_b16 a[26:27], v48 offset:520
ds_read_b64_tr_b16 a[28:29], v48 offset:8200
ds_read_b64_tr_b16 a[30:31], v48 offset:8712
s_waitcnt lgkmcnt(0)
s_barrier
s_add_u32 m0, s48, 16384
s_mov_b32 s22, 524288
buffer_load_dwordx4 v44, s[8:11], s22 offen  lds
s_add_u32 m0, s48, 20480
s_mov_b32 s22, 557056
buffer_load_dwordx4 v44, s[8:11], s22 offen  lds
s_add_u32 m0, s48, 24576
s_mov_b32 s22, 589824
buffer_load_dwordx4 v44, s[8:11], s22 offen  lds
s_add_u32 m0, s48, 28672
s_mov_b32 s22, 622592
buffer_load_dwordx4 v44, s[8:11], s22 offen  lds
s_waitcnt vmcnt(28)
s_barrier
v_add_u32 v48, 32768, v46
ds_read_b64_tr_b16 a[32:33], v48
ds_read_b64_tr_b16 a[34:35], v48 offset:512
ds_read_b64_tr_b16 a[36:37], v48 offset:8192
ds_read_b64_tr_b16 a[38:39], v48 offset:8704
ds_read_b64_tr_b16 a[40:41], v48 offset:8
ds_read_b64_tr_b16 a[42:43], v48 offset:520
ds_read_b64_tr_b16 a[44:45], v48 offset:8200
ds_read_b64_tr_b16 a[46:47], v48 offset:8712
s_waitcnt lgkmcnt(0)
s_barrier
s_add_u32 m0, s48, 32768
s_mov_b32 s22, 1048576
buffer_load_dwordx4 v44, s[8:11], s22 offen  lds
s_add_u32 m0, s48, 36864
s_mov_b32 s22, 1081344
buffer_load_dwordx4 v44, s[8:11], s22 offen  lds
s_add_u32 m0, s48, 40960
s_mov_b32 s22, 1114112
buffer_load_dwordx4 v44, s[8:11], s22 offen  lds
s_add_u32 m0, s48, 45056
s_mov_b32 s22, 1146880
buffer_load_dwordx4 v44, s[8:11], s22 offen  lds
s_waitcnt vmcnt(28)
s_barrier
v_add_u32 v48, 49152, v46
ds_read_b64_tr_b16 a[48:49], v48
ds_read_b64_tr_b16 a[50:51], v48 offset:512
ds_read_b64_tr_b16 a[52:53], v48 offset:8192
ds_read_b64_tr_b16 a[54:55], v48 offset:8704
ds_read_b64_tr_b16 a[56:57], v48 offset:8
ds_read_b64_tr_b16 a[58:59], v48 offset:520
ds_read_b64_tr_b16 a[60:61], v48 offset:8200
ds_read_b64_tr_b16 a[62:63], v48 offset:8712
s_waitcnt lgkmcnt(0)
s_barrier
s_add_u32 m0, s48, 49152
s_mov_b32 s22, 1572864
buffer_load_dwordx4 v44, s[8:11], s22 offen  lds
s_add_u32 m0, s48, 53248
s_mov_b32 s22, 1605632
buffer_load_dwordx4 v44, s[8:11], s22 offen  lds
s_add_u32 m0, s48, 57344
s_mov_b32 s22, 1638400
buffer_load_dwordx4 v44, s[8:11], s22 offen  lds
s_add_u32 m0, s48, 61440
s_mov_b32 s22, 1671168
buffer_load_dwordx4 v44, s[8:11], s22 offen  lds
s_waitcnt vmcnt(28)
s_barrier
v_add_u32 v48, 65536, v46
ds_read_b64_tr_b16 a[64:65], v48
ds_read_b64_tr_b16 a[66:67], v48 offset:512
ds_read_b64_tr_b16 a[68:69], v48 offset:8192
ds_read_b64_tr_b16 a[70:71], v48 offset:8704
ds_read_b64_tr_b16 a[72:73], v48 offset:8
ds_read_b64_tr_b16 a[74:75], v48 offset:520
ds_read_b64_tr_b16 a[76:77], v48 offset:8200
ds_read_b64_tr_b16 a[78:79], v48 offset:8712
s_waitcnt lgkmcnt(0)
s_barrier
s_add_u32 m0, s48, 65536
s_mov_b32 s22, 2097152
buffer_load_dwordx4 v44, s[8:11], s22 offen  lds
s_add_u32 m0, s48, 69632
s_mov_b32 s22, 2129920
buffer_load_dwordx4 v44, s[8:11], s22 offen  lds
s_add_u32 m0, s48, 73728
s_mov_b32 s22, 2162688
buffer_load_dwordx4 v44, s[8:11], s22 offen  lds
s_add_u32 m0, s48, 77824
s_mov_b32 s22, 2195456
buffer_load_dwordx4 v44, s[8:11], s22 offen  lds
s_waitcnt vmcnt(28)
s_barrier
v_add_u32 v48, 81920, v46
ds_read_b64_tr_b16 a[80:81], v48
ds_read_b64_tr_b16 a[82:83], v48 offset:512
ds_read_b64_tr_b16 a[84:85], v48 offset:8192
ds_read_b64_tr_b16 a[86:87], v48 offset:8704
ds_read_b64_tr_b16 a[88:89], v48 offset:8
ds_read_b64_tr_b16 a[90:91], v48 offset:520
ds_read_b64_tr_b16 a[92:93], v48 offset:8200
ds_read_b64_tr_b16 a[94:95], v48 offset:8712
s_waitcnt lgkmcnt(0)
s_barrier
s_add_u32 m0, s48, 81920
s_mov_b32 s22, 2621440
buffer_load_dwordx4 v44, s[8:11], s22 offen  lds
s_add_u32 m0, s48, 86016
s_mov_b32 s22, 2654208
buffer_load_dwordx4 v44, s[8:11], s22 offen  lds
s_add_u32 m0, s48, 90112
s_mov_b32 s22, 2686976
buffer_load_dwordx4 v44, s[8:11], s22 offen  lds
s_add_u32 m0, s48, 94208
s_mov_b32 s22, 2719744
buffer_load_dwordx4 v44, s[8:11], s22 offen  lds
s_waitcnt vmcnt(28)
s_barrier
v_add_u32 v48, 98304, v46
ds_read_b64_tr_b16 a[96:97], v48
ds_read_b64_tr_b16 a[98:99], v48 offset:512
ds_read_b64_tr_b16 a[100:101], v48 offset:8192
ds_read_b64_tr_b16 a[102:103], v48 offset:8704
ds_read_b64_tr_b16 a[104:105], v48 offset:8
ds_read_b64_tr_b16 a[106:107], v48 offset:520
ds_read_b64_tr_b16 a[108:109], v48 offset:8200
ds_read_b64_tr_b16 a[110:111], v48 offset:8712
s_waitcnt lgkmcnt(0)
s_barrier
s_add_u32 m0, s48, 98304
s_mov_b32 s22, 3145728
buffer_load_dwordx4 v44, s[8:11], s22 offen  lds
s_add_u32 m0, s48, 102400
s_mov_b32 s22, 3178496
buffer_load_dwordx4 v44, s[8:11], s22 offen  lds
s_add_u32 m0, s48, 106496
s_mov_b32 s22, 3211264
buffer_load_dwordx4 v44, s[8:11], s22 offen  lds
s_add_u32 m0, s48, 110592
s_mov_b32 s22, 3244032
buffer_load_dwordx4 v44, s[8:11], s22 offen  lds
s_waitcnt vmcnt(28)
s_barrier
v_add_u32 v48, 114688, v46
ds_read_b64_tr_b16 a[112:113], v48
ds_read_b64_tr_b16 a[114:115], v48 offset:512
ds_read_b64_tr_b16 a[116:117], v48 offset:8192
ds_read_b64_tr_b16 a[118:119], v48 offset:8704
ds_read_b64_tr_b16 a[120:121], v48 offset:8
ds_read_b64_tr_b16 a[122:123], v48 offset:520
ds_read_b64_tr_b16 a[124:125], v48 offset:8200
ds_read_b64_tr_b16 a[126:127], v48 offset:8712
s_waitcnt lgkmcnt(0)
s_barrier
s_add_u32 m0, s48, 114688
s_mov_b32 s22, 3670016
buffer_load_dwordx4 v44, s[8:11], s22 offen  lds
s_add_u32 m0, s48, 118784
s_mov_b32 s22, 3702784
buffer_load_dwordx4 v44, s[8:11], s22 offen  lds
s_add_u32 m0, s48, 122880
s_mov_b32 s22, 3735552
buffer_load_dwordx4 v44, s[8:11], s22 offen  lds
s_add_u32 m0, s48, 126976
s_mov_b32 s22, 3768320
buffer_load_dwordx4 v44, s[8:11], s22 offen  lds
s_waitcnt vmcnt(28)
s_barrier
v_add_u32 v48, 0, v46
ds_read_b64_tr_b16 a[128:129], v48
ds_read_b64_tr_b16 a[130:131], v48 offset:512
ds_read_b64_tr_b16 a[132:133], v48 offset:8192
ds_read_b64_tr_b16 a[134:135], v48 offset:8704
ds_read_b64_tr_b16 a[136:137], v48 offset:8
ds_read_b64_tr_b16 a[138:139], v48 offset:520
ds_read_b64_tr_b16 a[140:141], v48 offset:8200
ds_read_b64_tr_b16 a[142:143], v48 offset:8712
s_waitcnt lgkmcnt(0)
s_barrier
s_mov_b32 s8, s56
s_mov_b32 s9, s57
s_add_u32 m0, s48, 0
s_mov_b32 s22, 0
buffer_load_dwordx4 v45, s[8:11], s22 offen  lds
s_add_u32 m0, s48, 4096
s_mov_b32 s22, 16384
buffer_load_dwordx4 v45, s[8:11], s22 offen  lds
s_add_u32 m0, s48, 8192
s_mov_b32 s22, 32768
buffer_load_dwordx4 v45, s[8:11], s22 offen  lds
s_add_u32 m0, s48, 12288
s_mov_b32 s22, 49152
buffer_load_dwordx4 v45, s[8:11], s22 offen  lds
s_waitcnt vmcnt(28)
s_barrier
v_add_u32 v48, 16384, v46
ds_read_b64_tr_b16 a[144:145], v48
ds_read_b64_tr_b16 a[146:147], v48 offset:512
ds_read_b64_tr_b16 a[148:149], v48 offset:8192
ds_read_b64_tr_b16 a[150:151], v48 offset:8704
ds_read_b64_tr_b16 a[152:153], v48 offset:8
ds_read_b64_tr_b16 a[154:155], v48 offset:520
ds_read_b64_tr_b16 a[156:157], v48 offset:8200
ds_read_b64_tr_b16 a[158:159], v48 offset:8712
s_waitcnt lgkmcnt(0)
s_barrier
s_add_u32 m0, s48, 16384
s_mov_b32 s22, 256
buffer_load_dwordx4 v45, s[8:11], s22 offen  lds
s_add_u32 m0, s48, 20480
s_mov_b32 s22, 16640
buffer_load_dwordx4 v45, s[8:11], s22 offen  lds
s_add_u32 m0, s48, 24576
s_mov_b32 s22, 33024
buffer_load_dwordx4 v45, s[8:11], s22 offen  lds
s_add_u32 m0, s48, 28672
s_mov_b32 s22, 49408
buffer_load_dwordx4 v45, s[8:11], s22 offen  lds
s_waitcnt vmcnt(28)
s_barrier
v_add_u32 v48, 32768, v46
ds_read_b64_tr_b16 a[160:161], v48
ds_read_b64_tr_b16 a[162:163], v48 offset:512
ds_read_b64_tr_b16 a[164:165], v48 offset:8192
ds_read_b64_tr_b16 a[166:167], v48 offset:8704
ds_read_b64_tr_b16 a[168:169], v48 offset:8
ds_read_b64_tr_b16 a[170:171], v48 offset:520
ds_read_b64_tr_b16 a[172:173], v48 offset:8200
ds_read_b64_tr_b16 a[174:175], v48 offset:8712
s_waitcnt lgkmcnt(0)
s_barrier
s_add_u32 m0, s48, 32768
s_mov_b32 s22, 512
buffer_load_dwordx4 v45, s[8:11], s22 offen  lds
s_add_u32 m0, s48, 36864
s_mov_b32 s22, 16896
buffer_load_dwordx4 v45, s[8:11], s22 offen  lds
s_add_u32 m0, s48, 40960
s_mov_b32 s22, 33280
buffer_load_dwordx4 v45, s[8:11], s22 offen  lds
s_add_u32 m0, s48, 45056
s_mov_b32 s22, 49664
buffer_load_dwordx4 v45, s[8:11], s22 offen  lds
s_waitcnt vmcnt(28)
s_barrier
v_add_u32 v48, 49152, v46
ds_read_b64_tr_b16 a[176:177], v48
ds_read_b64_tr_b16 a[178:179], v48 offset:512
ds_read_b64_tr_b16 a[180:181], v48 offset:8192
ds_read_b64_tr_b16 a[182:183], v48 offset:8704
ds_read_b64_tr_b16 a[184:185], v48 offset:8
ds_read_b64_tr_b16 a[186:187], v48 offset:520
ds_read_b64_tr_b16 a[188:189], v48 offset:8200
ds_read_b64_tr_b16 a[190:191], v48 offset:8712
s_waitcnt lgkmcnt(0)
s_barrier
s_add_u32 m0, s48, 49152
s_mov_b32 s22, 768
buffer_load_dwordx4 v45, s[8:11], s22 offen  lds
s_add_u32 m0, s48, 53248
s_mov_b32 s22, 17152
buffer_load_dwordx4 v45, s[8:11], s22 offen  lds
s_add_u32 m0, s48, 57344
s_mov_b32 s22, 33536
buffer_load_dwordx4 v45, s[8:11], s22 offen  lds
s_add_u32 m0, s48, 61440
s_mov_b32 s22, 49920
buffer_load_dwordx4 v45, s[8:11], s22 offen  lds
s_waitcnt vmcnt(28)
s_barrier
v_and_b32 v37, 7, v0
v_lshlrev_b32 v37, 5, v37
buffer_load_dword v36, v37, s[88:91], 0 offen sc1
buffer_load_dword v58, off, s[12:15], 0 offset:204 sc1
v_add_u32 v48, 65536, v46
ds_read_b64_tr_b16 a[192:193], v48
ds_read_b64_tr_b16 a[194:195], v48 offset:512
ds_read_b64_tr_b16 a[196:197], v48 offset:8192
ds_read_b64_tr_b16 a[198:199], v48 offset:8704
ds_read_b64_tr_b16 a[200:201], v48 offset:8
ds_read_b64_tr_b16 a[202:203], v48 offset:520
ds_read_b64_tr_b16 a[204:205], v48 offset:8200
ds_read_b64_tr_b16 a[206:207], v48 offset:8712
s_waitcnt lgkmcnt(0)
s_barrier
s_add_u32 m0, s48, 65536
s_mov_b32 s22, 131072
buffer_load_dwordx4 v45, s[8:11], s22 offen  lds
s_add_u32 m0, s48, 69632
s_mov_b32 s22, 147456
buffer_load_dwordx4 v45, s[8:11], s22 offen  lds
s_add_u32 m0, s48, 73728
s_mov_b32 s22, 163840
buffer_load_dwordx4 v45, s[8:11], s22 offen  lds
s_add_u32 m0, s48, 77824
s_mov_b32 s22, 180224
buffer_load_dwordx4 v45, s[8:11], s22 offen  lds
s_waitcnt vmcnt(28)
s_barrier
v_add_u32 v48, 81920, v46
ds_read_b64_tr_b16 a[208:209], v48
ds_read_b64_tr_b16 a[210:211], v48 offset:512
ds_read_b64_tr_b16 a[212:213], v48 offset:8192
ds_read_b64_tr_b16 a[214:215], v48 offset:8704
ds_read_b64_tr_b16 a[216:217], v48 offset:8
ds_read_b64_tr_b16 a[218:219], v48 offset:520
ds_read_b64_tr_b16 a[220:221], v48 offset:8200
ds_read_b64_tr_b16 a[222:223], v48 offset:8712
s_waitcnt lgkmcnt(0)
s_barrier
s_add_u32 m0, s48, 81920
s_mov_b32 s22, 131328
buffer_load_dwordx4 v45, s[8:11], s22 offen  lds
s_add_u32 m0, s48, 86016
s_mov_b32 s22, 147712
buffer_load_dwordx4 v45, s[8:11], s22 offen  lds
s_add_u32 m0, s48, 90112
s_mov_b32 s22, 164096
buffer_load_dwordx4 v45, s[8:11], s22 offen  lds
s_add_u32 m0, s48, 94208
s_mov_b32 s22, 180480
buffer_load_dwordx4 v45, s[8:11], s22 offen  lds
s_waitcnt vmcnt(28)
s_barrier
v_add_u32 v48, 98304, v46
ds_read_b64_tr_b16 a[224:225], v48
ds_read_b64_tr_b16 a[226:227], v48 offset:512
ds_read_b64_tr_b16 a[228:229], v48 offset:8192
ds_read_b64_tr_b16 a[230:231], v48 offset:8704
ds_read_b64_tr_b16 a[232:233], v48 offset:8
ds_read_b64_tr_b16 a[234:235], v48 offset:520
ds_read_b64_tr_b16 a[236:237], v48 offset:8200
ds_read_b64_tr_b16 a[238:239], v48 offset:8712
s_waitcnt lgkmcnt(0)
s_barrier
s_add_u32 m0, s48, 98304
s_mov_b32 s22, 131584
buffer_load_dwordx4 v45, s[8:11], s22 offen  lds
s_add_u32 m0, s48, 102400
s_mov_b32 s22, 147968
buffer_load_dwordx4 v45, s[8:11], s22 offen  lds
s_add_u32 m0, s48, 106496
s_mov_b32 s22, 164352
buffer_load_dwordx4 v45, s[8:11], s22 offen  lds
s_add_u32 m0, s48, 110592
s_mov_b32 s22, 180736
buffer_load_dwordx4 v45, s[8:11], s22 offen  lds
s_waitcnt vmcnt(28)
s_barrier
v_add_u32 v48, 114688, v46
ds_read_b64_tr_b16 a[240:241], v48
ds_read_b64_tr_b16 a[242:243], v48 offset:512
ds_read_b64_tr_b16 a[244:245], v48 offset:8192
ds_read_b64_tr_b16 a[246:247], v48 offset:8704
ds_read_b64_tr_b16 a[248:249], v48 offset:8
ds_read_b64_tr_b16 a[250:251], v48 offset:520
ds_read_b64_tr_b16 a[252:253], v48 offset:8200
ds_read_b64_tr_b16 a[254:255], v48 offset:8712
s_waitcnt lgkmcnt(0)
s_barrier
s_add_u32 m0, s48, 114688
s_mov_b32 s22, 131840
buffer_load_dwordx4 v45, s[8:11], s22 offen  lds
s_add_u32 m0, s48, 118784
s_mov_b32 s22, 148224
buffer_load_dwordx4 v45, s[8:11], s22 offen  lds
s_add_u32 m0, s48, 122880
s_mov_b32 s22, 164608
buffer_load_dwordx4 v45, s[8:11], s22 offen  lds
s_add_u32 m0, s48, 126976
s_mov_b32 s22, 180992
buffer_load_dwordx4 v45, s[8:11], s22 offen  lds
s_waitcnt vmcnt(28)
s_barrier
s_cmp_lg_u32 s20, 0
s_cbranch_scc1 L_rf_wo0
v_xor_b32 v48, 0, v47
v_add_u32 v48, 0, v48
ds_read_b64_tr_b16 v[128:129], v48
ds_read_b64_tr_b16 v[130:131], v48 offset:512
ds_read_b64_tr_b16 v[132:133], v48 offset:8192
ds_read_b64_tr_b16 v[134:135], v48 offset:8704
ds_read_b64_tr_b16 v[144:145], v48 offset:32
ds_read_b64_tr_b16 v[146:147], v48 offset:544
ds_read_b64_tr_b16 v[148:149], v48 offset:8224
ds_read_b64_tr_b16 v[150:151], v48 offset:8736
s_waitcnt lgkmcnt(0)
v_xor_b32 v48, 64, v47
v_add_u32 v48, 0, v48
ds_read_b64_tr_b16 v[160:161], v48
ds_read_b64_tr_b16 v[162:163], v48 offset:512
ds_read_b64_tr_b16 v[164:165], v48 offset:8192
ds_read_b64_tr_b16 v[166:167], v48 offset:8704
ds_read_b64_tr_b16 v[176:177], v48 offset:32
ds_read_b64_tr_b16 v[178:179], v48 offset:544
ds_read_b64_tr_b16 v[180:181], v48 offset:8224
ds_read_b64_tr_b16 v[182:183], v48 offset:8736
s_waitcnt lgkmcnt(0)
v_xor_b32 v48, 128, v47
v_add_u32 v48, 0, v48
ds_read_b64_tr_b16 v[192:193], v48
ds_read_b64_tr_b16 v[194:195], v48 offset:512
ds_read_b64_tr_b16 v[196:197], v48 offset:8192
ds_read_b64_tr_b16 v[198:199], v48 offset:8704
ds_read_b64_tr_b16 v[208:209], v48 offset:32
ds_read_b64_tr_b16 v[210:211], v48 offset:544
ds_read_b64_tr_b16 v[212:213], v48 offset:8224
ds_read_b64_tr_b16 v[214:215], v48 offset:8736
s_waitcnt lgkmcnt(0)
v_xor_b32 v48, 192, v47
v_add_u32 v48, 0, v48
ds_read_b64_tr_b16 v[224:225], v48
ds_read_b64_tr_b16 v[226:227], v48 offset:512
ds_read_b64_tr_b16 v[228:229], v48 offset:8192
ds_read_b64_tr_b16 v[230:231], v48 offset:8704
ds_read_b64_tr_b16 v[240:241], v48 offset:32
ds_read_b64_tr_b16 v[242:243], v48 offset:544
ds_read_b64_tr_b16 v[244:245], v48 offset:8224
ds_read_b64_tr_b16 v[246:247], v48 offset:8736
s_waitcnt lgkmcnt(0)
L_rf_wo0:
s_barrier
s_mov_b32 s8, s54
s_mov_b32 s9, s55
s_add_u32 m0, s48, 0
s_mov_b32 s22, 0
buffer_load_dwordx4 v44, s[8:11], s22 offen  lds
s_add_u32 m0, s48, 4096
s_mov_b32 s22, 32768
buffer_load_dwordx4 v44, s[8:11], s22 offen  lds
s_add_u32 m0, s48, 8192
s_mov_b32 s22, 65536
buffer_load_dwordx4 v44, s[8:11], s22 offen  lds
s_add_u32 m0, s48, 12288
s_mov_b32 s22, 98304
buffer_load_dwordx4 v44, s[8:11], s22 offen  lds
s_waitcnt vmcnt(28)
s_barrier
s_cmp_lg_u32 s20, 1
s_cbranch_scc1 L_rf_wo1
v_xor_b32 v48, 0, v47
v_add_u32 v48, 16384, v48
ds_read_b64_tr_b16 v[128:129], v48
ds_read_b64_tr_b16 v[130:131], v48 offset:512
ds_read_b64_tr_b16 v[132:133], v48 offset:8192
ds_read_b64_tr_b16 v[134:135], v48 offset:8704
ds_read_b64_tr_b16 v[144:145], v48 offset:32
ds_read_b64_tr_b16 v[146:147], v48 offset:544
ds_read_b64_tr_b16 v[148:149], v48 offset:8224
ds_read_b64_tr_b16 v[150:151], v48 offset:8736
s_waitcnt lgkmcnt(0)
v_xor_b32 v48, 64, v47
v_add_u32 v48, 16384, v48
ds_read_b64_tr_b16 v[160:161], v48
ds_read_b64_tr_b16 v[162:163], v48 offset:512
ds_read_b64_tr_b16 v[164:165], v48 offset:8192
ds_read_b64_tr_b16 v[166:167], v48 offset:8704
ds_read_b64_tr_b16 v[176:177], v48 offset:32
ds_read_b64_tr_b16 v[178:179], v48 offset:544
ds_read_b64_tr_b16 v[180:181], v48 offset:8224
ds_read_b64_tr_b16 v[182:183], v48 offset:8736
s_waitcnt lgkmcnt(0)
v_xor_b32 v48, 128, v47
v_add_u32 v48, 16384, v48
ds_read_b64_tr_b16 v[192:193], v48
ds_read_b64_tr_b16 v[194:195], v48 offset:512
ds_read_b64_tr_b16 v[196:197], v48 offset:8192
ds_read_b64_tr_b16 v[198:199], v48 offset:8704
ds_read_b64_tr_b16 v[208:209], v48 offset:32
ds_read_b64_tr_b16 v[210:211], v48 offset:544
ds_read_b64_tr_b16 v[212:213], v48 offset:8224
ds_read_b64_tr_b16 v[214:215], v48 offset:8736
s_waitcnt lgkmcnt(0)
v_xor_b32 v48, 192, v47
v_add_u32 v48, 16384, v48
ds_read_b64_tr_b16 v[224:225], v48
ds_read_b64_tr_b16 v[226:227], v48 offset:512
ds_read_b64_tr_b16 v[228:229], v48 offset:8192
ds_read_b64_tr_b16 v[230:231], v48 offset:8704
ds_read_b64_tr_b16 v[240:241], v48 offset:32
ds_read_b64_tr_b16 v[242:243], v48 offset:544
ds_read_b64_tr_b16 v[244:245], v48 offset:8224
ds_read_b64_tr_b16 v[246:247], v48 offset:8736
s_waitcnt lgkmcnt(0)
L_rf_wo1:
s_barrier
s_add_u32 m0, s48, 16384
s_mov_b32 s22, 524288
buffer_load_dwordx4 v44, s[8:11], s22 offen  lds
s_add_u32 m0, s48, 20480
s_mov_b32 s22, 557056
buffer_load_dwordx4 v44, s[8:11], s22 offen  lds
s_add_u32 m0, s48, 24576
s_mov_b32 s22, 589824
buffer_load_dwordx4 v44, s[8:11], s22 offen  lds
s_add_u32 m0, s48, 28672
s_mov_b32 s22, 622592
buffer_load_dwordx4 v44, s[8:11], s22 offen  lds
s_waitcnt vmcnt(28)
s_barrier
s_cmp_lg_u32 s20, 2
s_cbranch_scc1 L_rf_wo2
v_xor_b32 v48, 0, v47
v_add_u32 v48, 32768, v48
ds_read_b64_tr_b16 v[128:129], v48
ds_read_b64_tr_b16 v[130:131], v48 offset:512
ds_read_b64_tr_b16 v[132:133], v48 offset:8192
ds_read_b64_tr_b16 v[134:135], v48 offset:8704
ds_read_b64_tr_b16 v[144:145], v48 offset:32
ds_read_b64_tr_b16 v[146:147], v48 offset:544
ds_read_b64_tr_b16 v[148:149], v48 offset:8224
ds_read_b64_tr_b16 v[150:151], v48 offset:8736
s_waitcnt lgkmcnt(0)
v_xor_b32 v48, 64, v47
v_add_u32 v48, 32768, v48
ds_read_b64_tr_b16 v[160:161], v48
ds_read_b64_tr_b16 v[162:163], v48 offset:512
ds_read_b64_tr_b16 v[164:165], v48 offset:8192
ds_read_b64_tr_b16 v[166:167], v48 offset:8704
ds_read_b64_tr_b16 v[176:177], v48 offset:32
ds_read_b64_tr_b16 v[178:179], v48 offset:544
ds_read_b64_tr_b16 v[180:181], v48 offset:8224
ds_read_b64_tr_b16 v[182:183], v48 offset:8736
s_waitcnt lgkmcnt(0)
v_xor_b32 v48, 128, v47
v_add_u32 v48, 32768, v48
ds_read_b64_tr_b16 v[192:193], v48
ds_read_b64_tr_b16 v[194:195], v48 offset:512
ds_read_b64_tr_b16 v[196:197], v48 offset:8192
ds_read_b64_tr_b16 v[198:199], v48 offset:8704
ds_read_b64_tr_b16 v[208:209], v48 offset:32
ds_read_b64_tr_b16 v[210:211], v48 offset:544
ds_read_b64_tr_b16 v[212:213], v48 offset:8224
ds_read_b64_tr_b16 v[214:215], v48 offset:8736
s_waitcnt lgkmcnt(0)
v_xor_b32 v48, 192, v47
v_add_u32 v48, 32768, v48
ds_read_b64_tr_b16 v[224:225], v48
ds_read_b64_tr_b16 v[226:227], v48 offset:512
ds_read_b64_tr_b16 v[228:229], v48 offset:8192
ds_read_b64_tr_b16 v[230:231], v48 offset:8704
ds_read_b64_tr_b16 v[240:241], v48 offset:32
ds_read_b64_tr_b16 v[242:243], v48 offset:544
ds_read_b64_tr_b16 v[244:245], v48 offset:8224
ds_read_b64_tr_b16 v[246:247], v48 offset:8736
s_waitcnt lgkmcnt(0)
L_rf_wo2:
s_barrier
s_add_u32 m0, s48, 32768
s_mov_b32 s22, 1048576
buffer_load_dwordx4 v44, s[8:11], s22 offen  lds
s_add_u32 m0, s48, 36864
s_mov_b32 s22, 1081344
buffer_load_dwordx4 v44, s[8:11], s22 offen  lds
s_add_u32 m0, s48, 40960
s_mov_b32 s22, 1114112
buffer_load_dwordx4 v44, s[8:11], s22 offen  lds
s_add_u32 m0, s48, 45056
s_mov_b32 s22, 1146880
buffer_load_dwordx4 v44, s[8:11], s22 offen  lds
s_waitcnt vmcnt(28)
s_barrier
s_cmp_lg_u32 s20, 3
s_cbranch_scc1 L_rf_wo3
v_xor_b32 v48, 0, v47
v_add_u32 v48, 49152, v48
ds_read_b64_tr_b16 v[128:129], v48
ds_read_b64_tr_b16 v[130:131], v48 offset:512
ds_read_b64_tr_b16 v[132:133], v48 offset:8192
ds_read_b64_tr_b16 v[134:135], v48 offset:8704
ds_read_b64_tr_b16 v[144:145], v48 offset:32
ds_read_b64_tr_b16 v[146:147], v48 offset:544
ds_read_b64_tr_b16 v[148:149], v48 offset:8224
ds_read_b64_tr_b16 v[150:151], v48 offset:8736
s_waitcnt lgkmcnt(0)
v_xor_b32 v48, 64, v47
v_add_u32 v48, 49152, v48
ds_read_b64_tr_b16 v[160:161], v48
ds_read_b64_tr_b16 v[162:163], v48 offset:512
ds_read_b64_tr_b16 v[164:165], v48 offset:8192
ds_read_b64_tr_b16 v[166:167], v48 offset:8704
ds_read_b64_tr_b16 v[176:177], v48 offset:32
ds_read_b64_tr_b16 v[178:179], v48 offset:544
ds_read_b64_tr_b16 v[180:181], v48 offset:8224
ds_read_b64_tr_b16 v[182:183], v48 offset:8736
s_waitcnt lgkmcnt(0)
v_xor_b32 v48, 128, v47
v_add_u32 v48, 49152, v48
ds_read_b64_tr_b16 v[192:193], v48
ds_read_b64_tr_b16 v[194:195], v48 offset:512
ds_read_b64_tr_b16 v[196:197], v48 offset:8192
ds_read_b64_tr_b16 v[198:199], v48 offset:8704
ds_read_b64_tr_b16 v[208:209], v48 offset:32
ds_read_b64_tr_b16 v[210:211], v48 offset:544
ds_read_b64_tr_b16 v[212:213], v48 offset:8224
ds_read_b64_tr_b16 v[214:215], v48 offset:8736
s_waitcnt lgkmcnt(0)
v_xor_b32 v48, 192, v47
v_add_u32 v48, 49152, v48
ds_read_b64_tr_b16 v[224:225], v48
ds_read_b64_tr_b16 v[226:227], v48 offset:512
ds_read_b64_tr_b16 v[228:229], v48 offset:8192
ds_read_b64_tr_b16 v[230:231], v48 offset:8704
ds_read_b64_tr_b16 v[240:241], v48 offset:32
ds_read_b64_tr_b16 v[242:243], v48 offset:544
ds_read_b64_tr_b16 v[244:245], v48 offset:8224
ds_read_b64_tr_b16 v[246:247], v48 offset:8736
s_waitcnt lgkmcnt(0)
L_rf_wo3:
s_barrier
s_add_u32 m0, s48, 49152
s_mov_b32 s22, 1572864
buffer_load_dwordx4 v44, s[8:11], s22 offen  lds
s_add_u32 m0, s48, 53248
s_mov_b32 s22, 1605632
buffer_load_dwordx4 v44, s[8:11], s22 offen  lds
s_add_u32 m0, s48, 57344
s_mov_b32 s22, 1638400
buffer_load_dwordx4 v44, s[8:11], s22 offen  lds
s_add_u32 m0, s48, 61440
s_mov_b32 s22, 1671168
buffer_load_dwordx4 v44, s[8:11], s22 offen  lds
s_waitcnt vmcnt(28)
s_barrier
s_cmp_lg_u32 s20, 0
s_cbranch_scc1 L_rf_wo4
v_xor_b32 v48, 0, v47
v_add_u32 v48, 65536, v48
ds_read_b64_tr_b16 v[136:137], v48
ds_read_b64_tr_b16 v[138:139], v48 offset:512
ds_read_b64_tr_b16 v[140:141], v48 offset:8192
ds_read_b64_tr_b16 v[142:143], v48 offset:8704
ds_read_b64_tr_b16 v[152:153], v48 offset:32
ds_read_b64_tr_b16 v[154:155], v48 offset:544
ds_read_b64_tr_b16 v[156:157], v48 offset:8224
ds_read_b64_tr_b16 v[158:159], v48 offset:8736
s_waitcnt lgkmcnt(0)
v_xor_b32 v48, 64, v47
v_add_u32 v48, 65536, v48
ds_read_b64_tr_b16 v[168:169], v48
ds_read_b64_tr_b16 v[170:171], v48 offset:512
ds_read_b64_tr_b16 v[172:173], v48 offset:8192
ds_read_b64_tr_b16 v[174:175], v48 offset:8704
ds_read_b64_tr_b16 v[184:185], v48 offset:32
ds_read_b64_tr_b16 v[186:187], v48 offset:544
ds_read_b64_tr_b16 v[188:189], v48 offset:8224
ds_read_b64_tr_b16 v[190:191], v48 offset:8736
s_waitcnt lgkmcnt(0)
v_xor_b32 v48, 128, v47
v_add_u32 v48, 65536, v48
ds_read_b64_tr_b16 v[200:201], v48
ds_read_b64_tr_b16 v[202:203], v48 offset:512
ds_read_b64_tr_b16 v[204:205], v48 offset:8192
ds_read_b64_tr_b16 v[206:207], v48 offset:8704
ds_read_b64_tr_b16 v[216:217], v48 offset:32
ds_read_b64_tr_b16 v[218:219], v48 offset:544
ds_read_b64_tr_b16 v[220:221], v48 offset:8224
ds_read_b64_tr_b16 v[222:223], v48 offset:8736
s_waitcnt lgkmcnt(0)
v_xor_b32 v48, 192, v47
v_add_u32 v48, 65536, v48
ds_read_b64_tr_b16 v[232:233], v48
ds_read_b64_tr_b16 v[234:235], v48 offset:512
ds_read_b64_tr_b16 v[236:237], v48 offset:8192
ds_read_b64_tr_b16 v[238:239], v48 offset:8704
ds_read_b64_tr_b16 v[248:249], v48 offset:32
ds_read_b64_tr_b16 v[250:251], v48 offset:544
ds_read_b64_tr_b16 v[252:253], v48 offset:8224
ds_read_b64_tr_b16 v[254:255], v48 offset:8736
s_waitcnt lgkmcnt(0)
L_rf_wo4:
s_barrier
s_add_u32 m0, s48, 65536
s_mov_b32 s22, 2097152
buffer_load_dwordx4 v44, s[8:11], s22 offen  lds
s_add_u32 m0, s48, 69632
s_mov_b32 s22, 2129920
buffer_load_dwordx4 v44, s[8:11], s22 offen  lds
s_add_u32 m0, s48, 73728
s_mov_b32 s22, 2162688
buffer_load_dwordx4 v44, s[8:11], s22 offen  lds
s_add_u32 m0, s48, 77824
s_mov_b32 s22, 2195456
buffer_load_dwordx4 v44, s[8:11], s22 offen  lds
s_waitcnt vmcnt(28)
s_barrier
s_cmp_lg_u32 s20, 1
s_cbranch_scc1 L_rf_wo5
v_xor_b32 v48, 0, v47
v_add_u32 v48, 81920, v48
ds_read_b64_tr_b16 v[136:137], v48
ds_read_b64_tr_b16 v[138:139], v48 offset:512
ds_read_b64_tr_b16 v[140:141], v48 offset:8192
ds_read_b64_tr_b16 v[142:143], v48 offset:8704
ds_read_b64_tr_b16 v[152:153], v48 offset:32
ds_read_b64_tr_b16 v[154:155], v48 offset:544
ds_read_b64_tr_b16 v[156:157], v48 offset:8224
ds_read_b64_tr_b16 v[158:159], v48 offset:8736
s_waitcnt lgkmcnt(0)
v_xor_b32 v48, 64, v47
v_add_u32 v48, 81920, v48
ds_read_b64_tr_b16 v[168:169], v48
ds_read_b64_tr_b16 v[170:171], v48 offset:512
ds_read_b64_tr_b16 v[172:173], v48 offset:8192
ds_read_b64_tr_b16 v[174:175], v48 offset:8704
ds_read_b64_tr_b16 v[184:185], v48 offset:32
ds_read_b64_tr_b16 v[186:187], v48 offset:544
ds_read_b64_tr_b16 v[188:189], v48 offset:8224
ds_read_b64_tr_b16 v[190:191], v48 offset:8736
s_waitcnt lgkmcnt(0)
v_xor_b32 v48, 128, v47
v_add_u32 v48, 81920, v48
ds_read_b64_tr_b16 v[200:201], v48
ds_read_b64_tr_b16 v[202:203], v48 offset:512
ds_read_b64_tr_b16 v[204:205], v48 offset:8192
ds_read_b64_tr_b16 v[206:207], v48 offset:8704
ds_read_b64_tr_b16 v[216:217], v48 offset:32
ds_read_b64_tr_b16 v[218:219], v48 offset:544
ds_read_b64_tr_b16 v[220:221], v48 offset:8224
ds_read_b64_tr_b16 v[222:223], v48 offset:8736
s_waitcnt lgkmcnt(0)
v_xor_b32 v48, 192, v47
v_add_u32 v48, 81920, v48
ds_read_b64_tr_b16 v[232:233], v48
ds_read_b64_tr_b16 v[234:235], v48 offset:512
ds_read_b64_tr_b16 v[236:237], v48 offset:8192
ds_read_b64_tr_b16 v[238:239], v48 offset:8704
ds_read_b64_tr_b16 v[248:249], v48 offset:32
ds_read_b64_tr_b16 v[250:251], v48 offset:544
ds_read_b64_tr_b16 v[252:253], v48 offset:8224
ds_read_b64_tr_b16 v[254:255], v48 offset:8736
s_waitcnt lgkmcnt(0)
L_rf_wo5:
s_barrier
s_add_u32 m0, s48, 81920
s_mov_b32 s22, 2621440
buffer_load_dwordx4 v44, s[8:11], s22 offen  lds
s_add_u32 m0, s48, 86016
s_mov_b32 s22, 2654208
buffer_load_dwordx4 v44, s[8:11], s22 offen  lds
s_add_u32 m0, s48, 90112
s_mov_b32 s22, 2686976
buffer_load_dwordx4 v44, s[8:11], s22 offen  lds
s_add_u32 m0, s48, 94208
s_mov_b32 s22, 2719744
buffer_load_dwordx4 v44, s[8:11], s22 offen  lds
s_waitcnt vmcnt(28)
s_barrier
s_cmp_lg_u32 s97, 0
s_cbranch_scc1 L_h2_2_ok
L_h2_2_ev:
v_cmp_ne_u32 vcc, 32, v36
s_cbranch_vccz L_h2_2_ok
s_mov_b32 s78, 0
v_readlane_b32 s81, v36, 0
s_nop 3
s_add_u32 s78, s78, s81
v_readlane_b32 s81, v36, 1
s_nop 3
s_add_u32 s78, s78, s81
v_readlane_b32 s81, v36, 2
s_nop 3
s_add_u32 s78, s78, s81
v_readlane_b32 s81, v36, 3
s_nop 3
s_add_u32 s78, s78, s81
v_readlane_b32 s81, v36, 4
s_nop 3
s_add_u32 s78, s78, s81
v_readlane_b32 s81, v36, 5
s_nop 3
s_add_u32 s78, s78, s81
v_readlane_b32 s81, v36, 6
s_nop 3
s_add_u32 s78, s78, s81
v_readlane_b32 s81, v36, 7
s_nop 3
s_add_u32 s78, s78, s81
s_cmp_eq_u32 s78, 256
s_cbranch_scc1 L_redo
buffer_load_dword v36, v37, s[88:91], 0 offen sc1
s_waitcnt vmcnt(0)
s_branch L_h2_2_ev
L_h2_2_ok:
s_mov_b32 s97, 1
s_cmp_lg_u32 s20, 2
s_cbranch_scc1 L_rf_wo6
v_xor_b32 v48, 0, v47
v_add_u32 v48, 98304, v48
ds_read_b64_tr_b16 v[136:137], v48
ds_read_b64_tr_b16 v[138:139], v48 offset:512
ds_read_b64_tr_b16 v[140:141], v48 offset:8192
ds_read_b64_tr_b16 v[142:143], v48 offset:8704
ds_read_b64_tr_b16 v[152:153], v48 offset:32
ds_read_b64_tr_b16 v[154:155], v48 offset:544
ds_read_b64_tr_b16 v[156:157], v48 offset:8224
ds_read_b64_tr_b16 v[158:159], v48 offset:8736
s_waitcnt lgkmcnt(0)
v_xor_b32 v48, 64, v47
v_add_u32 v48, 98304, v48
ds_read_b64_tr_b16 v[168:169], v48
ds_read_b64_tr_b16 v[170:171], v48 offset:512
ds_read_b64_tr_b16 v[172:173], v48 offset:8192
ds_read_b64_tr_b16 v[174:175], v48 offset:8704
ds_read_b64_tr_b16 v[184:185], v48 offset:32
ds_read_b64_tr_b16 v[186:187], v48 offset:544
ds_read_b64_tr_b16 v[188:189], v48 offset:8224
ds_read_b64_tr_b16 v[190:191], v48 offset:8736
s_waitcnt lgkmcnt(0)
v_xor_b32 v48, 128, v47
v_add_u32 v48, 98304, v48
ds_read_b64_tr_b16 v[200:201], v48
ds_read_b64_tr_b16 v[202:203], v48 offset:512
ds_read_b64_tr_b16 v[204:205], v48 offset:8192
ds_read_b64_tr_b16 v[206:207], v48 offset:8704
ds_read_b64_tr_b16 v[216:217], v48 offset:32
ds_read_b64_tr_b16 v[218:219], v48 offset:544
ds_read_b64_tr_b16 v[220:221], v48 offset:8224
ds_read_b64_tr_b16 v[222:223], v48 offset:8736
s_waitcnt lgkmcnt(0)
v_xor_b32 v48, 192, v47
v_add_u32 v48, 98304, v48
ds_read_b64_tr_b16 v[232:233], v48
ds_read_b64_tr_b16 v[234:235], v48 offset:512
ds_read_b64_tr_b16 v[236:237], v48 offset:8192
ds_read_b64_tr_b16 v[238:239], v48 offset:8704
ds_read_b64_tr_b16 v[248:249], v48 offset:32
ds_read_b64_tr_b16 v[250:251], v48 offset:544
ds_read_b64_tr_b16 v[252:253], v48 offset:8224
ds_read_b64_tr_b16 v[254:255], v48 offset:8736
s_waitcnt lgkmcnt(0)
L_rf_wo6:
s_barrier
s_add_u32 m0, s48, 98304
s_mov_b32 s22, 3145728
buffer_load_dwordx4 v44, s[8:11], s22 offen  lds
s_add_u32 m0, s48, 102400
s_mov_b32 s22, 3178496
buffer_load_dwordx4 v44, s[8:11], s22 offen  lds
s_add_u32 m0, s48, 106496
s_mov_b32 s22, 3211264
buffer_load_dwordx4 v44, s[8:11], s22 offen  lds
s_add_u32 m0, s48, 110592
s_mov_b32 s22, 3244032
buffer_load_dwordx4 v44, s[8:11], s22 offen  lds
s_waitcnt vmcnt(28)
s_barrier
s_cmp_lg_u32 s20, 3
s_cbranch_scc1 L_rf_wo7
v_xor_b32 v48, 0, v47
v_add_u32 v48, 114688, v48
ds_read_b64_tr_b16 v[136:137], v48
ds_read_b64_tr_b16 v[138:139], v48 offset:512
ds_read_b64_tr_b16 v[140:141], v48 offset:8192
ds_read_b64_tr_b16 v[142:143], v48 offset:8704
ds_read_b64_tr_b16 v[152:153], v48 offset:32
ds_read_b64_tr_b16 v[154:155], v48 offset:544
ds_read_b64_tr_b16 v[156:157], v48 offset:8224
ds_read_b64_tr_b16 v[158:159], v48 offset:8736
s_waitcnt lgkmcnt(0)
v_xor_b32 v48, 64, v47
v_add_u32 v48, 114688, v48
ds_read_b64_tr_b16 v[168:169], v48
ds_read_b64_tr_b16 v[170:171], v48 offset:512
ds_read_b64_tr_b16 v[172:173], v48 offset:8192
ds_read_b64_tr_b16 v[174:175], v48 offset:8704
ds_read_b64_tr_b16 v[184:185], v48 offset:32
ds_read_b64_tr_b16 v[186:187], v48 offset:544
ds_read_b64_tr_b16 v[188:189], v48 offset:8224
ds_read_b64_tr_b16 v[190:191], v48 offset:8736
s_waitcnt lgkmcnt(0)
v_xor_b32 v48, 128, v47
v_add_u32 v48, 114688, v48
ds_read_b64_tr_b16 v[200:201], v48
ds_read_b64_tr_b16 v[202:203], v48 offset:512
ds_read_b64_tr_b16 v[204:205], v48 offset:8192
ds_read_b64_tr_b16 v[206:207], v48 offset:8704
ds_read_b64_tr_b16 v[216:217], v48 offset:32
ds_read_b64_tr_b16 v[218:219], v48 offset:544
ds_read_b64_tr_b16 v[220:221], v48 offset:8224
ds_read_b64_tr_b16 v[222:223], v48 offset:8736
s_waitcnt lgkmcnt(0)
v_xor_b32 v48, 192, v47
v_add_u32 v48, 114688, v48
ds_read_b64_tr_b16 v[232:233], v48
ds_read_b64_tr_b16 v[234:235], v48 offset:512
ds_read_b64_tr_b16 v[236:237], v48 offset:8192
ds_read_b64_tr_b16 v[238:239], v48 offset:8704
ds_read_b64_tr_b16 v[248:249], v48 offset:32
ds_read_b64_tr_b16 v[250:251], v48 offset:544
ds_read_b64_tr_b16 v[252:253], v48 offset:8224
ds_read_b64_tr_b16 v[254:255], v48 offset:8736
s_waitcnt lgkmcnt(0)
L_rf_wo7:
s_barrier
s_add_u32 m0, s48, 114688
s_mov_b32 s22, 3670016
buffer_load_dwordx4 v44, s[8:11], s22 offen  lds
s_add_u32 m0, s48, 118784
s_mov_b32 s22, 3702784
buffer_load_dwordx4 v44, s[8:11], s22 offen  lds
s_add_u32 m0, s48, 122880
s_mov_b32 s22, 3735552
buffer_load_dwordx4 v44, s[8:11], s22 offen  lds
s_add_u32 m0, s48, 126976
s_mov_b32 s22, 3768320
buffer_load_dwordx4 v44, s[8:11], s22 offen  lds
s_waitcnt vmcnt(28)
s_barrier
v_add_u32 v48, 0, v46
ds_read_b64_tr_b16 v[64:65], v48
ds_read_b64_tr_b16 v[66:67], v48 offset:512
ds_read_b64_tr_b16 v[68:69], v48 offset:8192
ds_read_b64_tr_b16 v[70:71], v48 offset:8704
ds_read_b64_tr_b16 v[72:73], v48 offset:8
ds_read_b64_tr_b16 v[74:75], v48 offset:520
ds_read_b64_tr_b16 v[76:77], v48 offset:8200
ds_read_b64_tr_b16 v[78:79], v48 offset:8712
s_waitcnt lgkmcnt(0)
s_barrier
ds_write_b128 v32, v[64:67]
ds_write_b128 v32, v[68:71] offset:1024
ds_write_b128 v32, v[72:75] offset:2048
ds_write_b128 v32, v[76:79] offset:3072
s_waitcnt lgkmcnt(0)
s_waitcnt vmcnt(24)
s_barrier
v_add_u32 v48, 16384, v46
ds_read_b64_tr_b16 v[64:65], v48
ds_read_b64_tr_b16 v[66:67], v48 offset:512
ds_read_b64_tr_b16 v[68:69], v48 offset:8192
ds_read_b64_tr_b16 v[70:71], v48 offset:8704
ds_read_b64_tr_b16 v[72:73], v48 offset:8
ds_read_b64_tr_b16 v[74:75], v48 offset:520
ds_read_b64_tr_b16 v[76:77], v48 offset:8200
ds_read_b64_tr_b16 v[78:79], v48 offset:8712
s_waitcnt lgkmcnt(0)
s_barrier
ds_write_b128 v32, v[64:67] offset:16384
ds_write_b128 v32, v[68:71] offset:17408
ds_write_b128 v32, v[72:75] offset:18432
ds_write_b128 v32, v[76:79] offset:19456
s_waitcnt lgkmcnt(0)
s_waitcnt vmcnt(20)
s_barrier
s_getpc_b64 s[16:17]
L_rf_pc0:
s_add_u32 s16, s16, L_rf_w0_entry - L_rf_pc0
s_addc_u32 s17, s17, 0
v_lshlrev_b32 v49, 7, v0
v_min_u32 v49, L_rf_end - L_rf_w0_entry, v49
global_load_dword v50, v49, s[16:17]
v_lshlrev_b32 v49, 7, v40
s_xor_b32 s23, s35, 16384
s_cmp_eq_u32 s20, 1
s_cselect_b32 s22, s35, s47
s_cmp_eq_u32 s20, 2
s_cselect_b32 s22, s23, s22
s_lshl_b32 s23, s31, 13
s_add_u32 s23, s23, 178257920
s_cmp_eq_u32 s20, 3
s_cselect_b32 s22, s23, s22
buffer_load_dword v51, v49, s[4:7], s22 offen sc1
v_lshlrev_b32 v49, 13, v0
v_and_b32 v49, 0x1fffff, v49
s_mov_b32 s22, 67108864
buffer_load_dword v52, v49, s[4:7], s22 offen sc1
buffer_load_dword v57, v7, s[4:7], 0 offen sc1
v_add_u32 v48, 32768, v46
ds_read_b64_tr_b16 v[64:65], v48
ds_read_b64_tr_b16 v[66:67], v48 offset:512
ds_read_b64_tr_b16 v[68:69], v48 offset:8192
ds_read_b64_tr_b16 v[70:71], v48 offset:8704
ds_read_b64_tr_b16 v[72:73], v48 offset:8
ds_read_b64_tr_b16 v[74:75], v48 offset:520
ds_read_b64_tr_b16 v[76:77], v48 offset:8200
ds_read_b64_tr_b16 v[78:79], v48 offset:8712
s_waitcnt lgkmcnt(0)
s_barrier
ds_write_b128 v32, v[64:67] offset:32768
ds_write_b128 v32, v[68:71] offset:33792
ds_write_b128 v32, v[72:75] offset:34816
ds_write_b128 v32, v[76:79] offset:35840
s_waitcnt lgkmcnt(0)
s_waitcnt vmcnt(16)
s_barrier
v_add_u32 v48, 49152, v46
ds_read_b64_tr_b16 v[64:65], v48
ds_read_b64_tr_b16 v[66:67], v48 offset:512
ds_read_b64_tr_b16 v[68:69], v48 offset:8192
ds_read_b64_tr_b16 v[70:71], v48 offset:8704
ds_read_b64_tr_b16 v[72:73], v48 offset:8
ds_read_b64_tr_b16 v[74:75], v48 offset:520
ds_read_b64_tr_b16 v[76:77], v48 offset:8200
ds_read_b64_tr_b16 v[78:79], v48 offset:8712
s_waitcnt lgkmcnt(0)
s_barrier
ds_write_b128 v32, v[64:67] offset:49152
ds_write_b128 v32, v[68:71] offset:50176
ds_write_b128 v32, v[72:75] offset:51200
ds_write_b128 v32, v[76:79] offset:52224
s_waitcnt lgkmcnt(0)
s_waitcnt vmcnt(12)
s_barrier
v_add_u32 v48, 65536, v46
ds_read_b64_tr_b16 v[64:65], v48
ds_read_b64_tr_b16 v[66:67], v48 offset:512
ds_read_b64_tr_b16 v[68:69], v48 offset:8192
ds_read_b64_tr_b16 v[70:71], v48 offset:8704
ds_read_b64_tr_b16 v[72:73], v48 offset:8
ds_read_b64_tr_b16 v[74:75], v48 offset:520
ds_read_b64_tr_b16 v[76:77], v48 offset:8200
ds_read_b64_tr_b16 v[78:79], v48 offset:8712
s_waitcnt lgkmcnt(0)
s_barrier
ds_write_b128 v33, v[64:67]
ds_write_b128 v33, v[68:71] offset:1024
ds_write_b128 v33, v[72:75] offset:2048
ds_write_b128 v33, v[76:79] offset:3072
s_waitcnt lgkmcnt(0)
s_waitcnt vmcnt(8)
s_barrier
v_add_u32 v48, 81920, v46
ds_read_b64_tr_b16 v[64:65], v48
ds_read_b64_tr_b16 v[66:67], v48 offset:512
ds_read_b64_tr_b16 v[68:69], v48 offset:8192
ds_read_b64_tr_b16 v[70:71], v48 offset:8704
ds_read_b64_tr_b16 v[72:73], v48 offset:8
ds_read_b64_tr_b16 v[74:75], v48 offset:520
ds_read_b64_tr_b16 v[76:77], v48 offset:8200
ds_read_b64_tr_b16 v[78:79], v48 offset:8712
s_waitcnt lgkmcnt(0)
s_barrier
ds_write_b128 v33, v[64:67] offset:16384
ds_write_b128 v33, v[68:71] offset:17408
ds_write_b128 v33, v[72:75] offset:18432
ds_write_b128 v33, v[76:79] offset:19456
s_waitcnt lgkmcnt(0)
s_waitcnt vmcnt(4)
s_barrier
v_add_u32 v48, 98304, v46
ds_read_b64_tr_b16 v[64:65], v48
ds_read_b64_tr_b16 v[66:67], v48 offset:512
ds_read_b64_tr_b16 v[68:69], v48 offset:8192
ds_read_b64_tr_b16 v[70:71], v48 offset:8704
ds_read_b64_tr_b16 v[72:73], v48 offset:8
ds_read_b64_tr_b16 v[74:75], v48 offset:520
ds_read_b64_tr_b16 v[76:77], v48 offset:8200
ds_read_b64_tr_b16 v[78:79], v48 offset:8712
s_waitcnt lgkmcnt(0)
s_barrier
ds_write_b128 v33, v[64:67] offset:32768
ds_write_b128 v33, v[68:71] offset:33792
ds_write_b128 v33, v[72:75] offset:34816
ds_write_b128 v33, v[76:79] offset:35840
s_waitcnt lgkmcnt(0)
s_waitcnt vmcnt(0)
s_barrier
v_add_u32 v48, 114688, v46
ds_read_b64_tr_b16 v[64:65], v48
ds_read_b64_tr_b16 v[66:67], v48 offset:512
ds_read_b64_tr_b16 v[68:69], v48 offset:8192
ds_read_b64_tr_b16 v[70:71], v48 offset:8704
ds_read_b64_tr_b16 v[72:73], v48 offset:8
ds_read_b64_tr_b16 v[74:75], v48 offset:520
ds_read_b64_tr_b16 v[76:77], v48 offset:8200
ds_read_b64_tr_b16 v[78:79], v48 offset:8712
s_waitcnt lgkmcnt(0)
s_barrier
ds_write_b128 v33, v[64:67] offset:49152
ds_write_b128 v33, v[68:71] offset:50176
ds_write_b128 v33, v[72:75] offset:51200
ds_write_b128 v33, v[76:79] offset:52224
s_waitcnt lgkmcnt(0)
s_branch L_rf_iw1
L_rf_iw:
buffer_load_dword v58, off, s[12:15], 0 offset:204 sc1
s_waitcnt vmcnt(0)
L_rf_iw1:
v_and_b32 v50, 0xffff, v58
v_readfirstlane_b32 s60, v58
v_cmp_ne_u32 vcc, s100, v50
s_cbranch_vccnz L_rf_iw
s_lshr_b32 s60, s60, 15
s_cmp_gt_u32 s60, s100
s_cselect_b32 s60, 8192, 0
s_bfe_u32 s22, s31, 0x10001
s_lshl_b32 s22, s22, 12
s_add_u32 s22, s22, s60
s_lshl_b32 s23, s20, 10
s_add_u32 s22, s22, s23
s_add_u32 s38, s38, s22
s_add_u32 s37, s37, s22
s_xor_b32 s40, s38, 4096
s_xor_b32 s39, s37, 4096
s_xor_b32 s36, s35, 16384
s_mov_b32 s21, 0
s_cmp_eq_u32 s30, 0
s_mov_b32 s22, 0x33003300
s_cselect_b32 s16, 0x00330033, s22
s_mov_b32 s17, s16
s_cselect_b32 s18, -1, 0
s_not_b32 s19, s18
s_lshl_b32 s22, s31, 13
s_lshl_b32 s23, s20, 11
s_add_u32 s22, s22, s23
s_add_u32 s43, s22, 16777216
s_add_u32 s44, s22, 33554432
s_lshl_b32 s45, s31, 13
s_add_u32 s45, s45, 178257920
s_mul_i32 s48, s20, 5120
s_add_u32 m0, s48, 140288
s_mov_b32 s41, 1
s_mov_b32 s42, 1
v_mov_b32 v0, v34
v_bfrev_b32 v12, 1
v_bfrev_b32 v3, 1
v_cndmask_b32 v10, v3, v10, s[16:17]
v_cndmask_b32 v9, v3, v9, s[26:27]
s_sub_u32 s45, s45, 0
s_lshl_b32 s51, s30, 11
s_add_u32 s51, s51, s45
s_mov_b32 s50, 0
s_cmp_lg_u32 s20, 3
s_cbranch_scc1 L_rf_kv0
v_readlane_b32 s50, v57, 0
v_readlane_b32 s22, v57, 2
v_readlane_b32 s23, v57, 1
v_readlane_b32 s24, v57, 3
s_nop 3
s_min_u32 s50, s50, s22
s_min_u32 s23, s23, s24
s_lshl_b32 s50, s50, 1
s_lshl_b32 s23, s23, 1
s_add_u32 s23, s23, 1
s_min_u32 s50, s50, s23
L_rf_kvb0:
s_add_u32 s22, s21, 1
s_min_u32 s22, s22, 63
s_cmp_gt_u32 s50, s22
s_cbranch_scc1 L_rf_kvd0
buffer_load_dword v48, v7, s[4:7], 0 offen sc1
s_waitcnt vmcnt(0)
v_readlane_b32 s50, v48, 0
v_readlane_b32 s22, v48, 2
v_readlane_b32 s23, v48, 1
v_readlane_b32 s24, v48, 3
s_nop 3
s_min_u32 s50, s50, s22
s_min_u32 s23, s23, s24
s_lshl_b32 s50, s50, 1
s_lshl_b32 s23, s23, 1
s_add_u32 s23, s23, 1
s_min_u32 s50, s50, s23
s_branch L_rf_kvb0
L_rf_kvd0:
L_rf_kv0:
s_barrier
s_cmp_eq_u32 s20, 1
s_cbranch_scc1 L_rf_w1_entry
s_cmp_eq_u32 s20, 2
s_cbranch_scc1 L_rf_w2_entry
s_cmp_eq_u32 s20, 3
s_cbranch_scc1 L_rf_w3_entry
L_rf_w0_entry:
v_mfma_f32_32x32x8_bf16 v[96:111], v[14:15], v[14:15], 0
v_mfma_f32_16x16x16_bf16 v[112:115], v[14:15], v[14:15], 0
v_mfma_f32_16x16x16_bf16 v[116:119], v[14:15], v[14:15], 0
ds_read_b128 v[64:67], v1
ds_read_b128 v[68:71], v1 offset:1024
ds_read_b128 v[72:75], v1 offset:2048
ds_read_b128 v[76:79], v1 offset:3072
ds_read_b128 v[80:83], v1 offset:16384
ds_read_b128 v[84:87], v1 offset:17408
ds_read_b128 v[88:91], v1 offset:18432
ds_read_b128 v[92:95], v1 offset:19456
buffer_load_dwordx4 v[120:123], v1, s[4:7], s44 offen
buffer_load_dwordx4 v[124:127], v1, s[4:7], s44 offen offset:1024
s_add_u32 s44, s44, 262144
L_rf_w0_loop:
s_add_u32 s22, s35, 0
s_waitcnt vmcnt(0)
buffer_load_dwordx4 v[32:35], v1, s[4:7], s22 offen sc1
buffer_load_dwordx4 v[36:39], v1, s[4:7], s22 offen offset:1024 sc1
L_rf_w0_pa:
s_waitcnt vmcnt(1)
ds_write_b128 v6, v[32:35]
s_waitcnt vmcnt(0)
ds_write_b128 v6, v[36:39] offset:1024
v_max3_u32 v3, v32, v34, v36
v_max_u32 v3, v3, v38
v_cmp_eq_u32 vcc, -1, v3
v_smfmac_f32_16x16x64_bf16 v[96:99], v[32:35], a[0:7], v2
buffer_load_dwordx4 v[32:35], v1, s[4:7], s22 offen sc1
v_smfmac_f32_16x16x64_bf16 v[100:103], v[32:35], a[8:15], v2
buffer_load_dwordx4 v[36:39], v1, s[4:7], s22 offen offset:1024 sc1
v_smfmac_f32_16x16x64_bf16 v[104:107], v[32:35], a[128:135], v2
s_cbranch_vccnz L_rf_w0_pafail
s_waitcnt lgkmcnt(0)
s_barrier
ds_read_b128 v[40:43], v6 offset:2048
ds_read_b128 v[44:47], v6 offset:3072
v_smfmac_f32_16x16x64_bf16 v[108:111], v[32:35], a[136:143], v2
ds_read_b128 v[48:51], v6 offset:4096
v_smfmac_f32_16x16x64_bf16 v[96:99], v[36:39], a[16:23], v2
ds_read_b128 v[52:55], v6 offset:5120
v_smfmac_f32_16x16x64_bf16 v[100:103], v[36:39], a[24:31], v2
ds_read_b128 v[56:59], v6 offset:6144
v_smfmac_f32_16x16x64_bf16 v[104:107], v[36:39], a[144:151], v2
ds_read_b128 v[60:63], v6 offset:7168
v_smfmac_f32_16x16x64_bf16 v[108:111], v[36:39], a[152:159], v2
buffer_load_dwordx4 v1, s[4:7], s43 offen lds
s_waitcnt lgkmcnt(5)
v_smfmac_f32_16x16x64_bf16 v[96:99], v[40:43], a[32:39], v2
v_smfmac_f32_16x16x64_bf16 v[104:107], v[40:43], a[160:167], v2
s_waitcnt lgkmcnt(4)
v_smfmac_f32_16x16x64_bf16 v[96:99], v[44:47], a[48:55], v2
v_smfmac_f32_16x16x64_bf16 v[104:107], v[44:47], a[176:183], v2
buffer_load_dwordx4 v1, s[4:7], s43 offen offset:1024 lds
s_waitcnt lgkmcnt(3)
v_smfmac_f32_16x16x64_bf16 v[96:99], v[48:51], a[64:71], v2
v_smfmac_f32_16x16x64_bf16 v[104:107], v[48:51], a[192:199], v2
s_waitcnt lgkmcnt(2)
v_smfmac_f32_16x16x64_bf16 v[96:99], v[52:55], a[80:87], v2
v_smfmac_f32_16x16x64_bf16 v[104:107], v[52:55], a[208:215], v2
v_mov_b32 v4, s21
buffer_store_dword v4, v7, s[4:7], 0 offen sc1
s_waitcnt lgkmcnt(1)
v_smfmac_f32_16x16x64_bf16 v[96:99], v[56:59], a[96:103], v2
v_smfmac_f32_16x16x64_bf16 v[104:107], v[56:59], a[224:231], v2
s_waitcnt lgkmcnt(0)
v_smfmac_f32_16x16x64_bf16 v[96:99], v[60:63], a[112:119], v2
v_smfmac_f32_16x16x64_bf16 v[104:107], v[60:63], a[240:247], v2
v_smfmac_f32_16x16x64_bf16 v[100:103], v[40:43], a[40:47], v2
s_nop 2
v_smfmac_f32_16x16x64_bf16 v[100:103], v[44:47], a[56:63], v2
s_nop 1
v_add_f32 v96, v96, v98
v_smfmac_f32_16x16x64_bf16 v[100:103], v[48:51], a[72:79], v2
v_add_f32 v97, v97, v99
v_add_f32 v104, v104, v106
v_smfmac_f32_16x16x64_bf16 v[100:103], v[52:55], a[88:95], v2
v_add_f32 v105, v105, v107
v_cvt_pk_bf16_f32 v96, v96, v97
v_smfmac_f32_16x16x64_bf16 v[100:103], v[56:59], a[104:111], v2
v_cvt_pk_bf16_f32 v97, v104, v105
v_and_or_b32 v96, v96, -2, s41
v_smfmac_f32_16x16x64_bf16 v[100:103], v[60:63], a[120:127], v2
buffer_store_dwordx2 v[96:97], v11, s[4:7], s37 offen sc1
v_smfmac_f32_16x16x64_bf16 v[108:111], v[40:43], a[168:175], v2
v_smfmac_f32_16x16x64_bf16 v[108:111], v[44:47], a[184:191], v2
v_smfmac_f32_16x16x64_bf16 v[108:111], v[48:51], a[200:207], v2
v_smfmac_f32_16x16x64_bf16 v[108:111], v[52:55], a[216:223], v2
v_smfmac_f32_16x16x64_bf16 v[108:111], v[56:59], a[232:239], v2
s_nop 2
v_add_f32 v100, v100, v102
v_smfmac_f32_16x16x64_bf16 v[108:111], v[60:63], a[248:255], v2
v_add_f32 v101, v101, v103
v_cvt_pk_bf16_f32 v98, v100, v101
v_and_or_b32 v98, v98, -2, s41
s_nop 4
v_pk_add_f32 v[108:109], v[108:109], v[110:111]
v_cvt_pk_bf16_f32 v99, v108, v109
buffer_store_dwordx2 v[98:99], v11, s[4:7], s37 offen offset:512 sc1
v_smfmac_f32_16x16x64_bf16 v[112:115], v[32:35], v[64:71], v2
ds_read_b128 v[64:67], v1 offset:32768
ds_read_b128 v[68:71], v1 offset:33792
v_smfmac_f32_16x16x64_bf16 v[116:119], v[32:35], v[72:79], v2
ds_read_b128 v[72:75], v1 offset:34816
ds_read_b128 v[76:79], v1 offset:35840
v_smfmac_f32_16x16x64_bf16 v[112:115], v[36:39], v[80:87], v2
ds_read_b128 v[80:83], v1 offset:49152
ds_read_b128 v[84:87], v1 offset:50176
v_smfmac_f32_16x16x64_bf16 v[116:119], v[36:39], v[88:95], v2
ds_read_b128 v[88:91], v1 offset:51200
ds_read_b128 v[92:95], v1 offset:52224
s_waitcnt lgkmcnt(6)
v_smfmac_f32_16x16x64_bf16 v[112:115], v[40:43], v[64:71], v2
ds_read_b128 v[64:67], v5
ds_read_b128 v[68:71], v5 offset:1024
s_waitcnt lgkmcnt(6)
v_smfmac_f32_16x16x64_bf16 v[116:119], v[40:43], v[72:79], v2
ds_read_b128 v[72:75], v5 offset:2048
ds_read_b128 v[76:79], v5 offset:3072
s_waitcnt lgkmcnt(6)
v_smfmac_f32_16x16x64_bf16 v[112:115], v[44:47], v[80:87], v2
ds_read_b128 v[80:83], v5 offset:16384
ds_read_b128 v[84:87], v5 offset:17408
s_waitcnt lgkmcnt(6)
v_smfmac_f32_16x16x64_bf16 v[116:119], v[44:47], v[88:95], v2
ds_read_b128 v[88:91], v5 offset:18432
ds_read_b128 v[92:95], v5 offset:19456
s_waitcnt lgkmcnt(6)
v_smfmac_f32_16x16x64_bf16 v[112:115], v[48:51], v[64:71], v2
ds_read_b128 v[64:67], v5 offset:32768
ds_read_b128 v[68:71], v5 offset:33792
s_waitcnt lgkmcnt(6)
v_smfmac_f32_16x16x64_bf16 v[116:119], v[48:51], v[72:79], v2
ds_read_b128 v[72:75], v5 offset:34816
ds_read_b128 v[76:79], v5 offset:35840
s_waitcnt lgkmcnt(6)
v_smfmac_f32_16x16x64_bf16 v[112:115], v[52:55], v[80:87], v2
ds_read_b128 v[80:83], v5 offset:49152
ds_read_b128 v[84:87], v5 offset:50176
s_waitcnt lgkmcnt(6)
v_smfmac_f32_16x16x64_bf16 v[116:119], v[52:55], v[88:95], v2
ds_read_b128 v[88:91], v5 offset:51200
ds_read_b128 v[92:95], v5 offset:52224
s_waitcnt lgkmcnt(6)
v_smfmac_f32_16x16x64_bf16 v[112:115], v[56:59], v[64:71], v2
s_waitcnt lgkmcnt(4)
v_smfmac_f32_16x16x64_bf16 v[116:119], v[56:59], v[72:79], v2
s_waitcnt lgkmcnt(2)
v_smfmac_f32_16x16x64_bf16 v[112:115], v[60:63], v[80:87], v2
s_waitcnt lgkmcnt(0)
v_smfmac_f32_16x16x64_bf16 v[116:119], v[60:63], v[88:95], v2
buffer_load_dwordx2 v[108:109], v11, s[4:7], s38 offen sc1
v_mfma_f32_16x16x16_bf16 v[100:103], v[96:97], v[16:17], 0
v_mfma_f32_16x16x16_bf16 v[104:107], v[98:99], v[16:17], 0
s_nop 4
v_add_f32 v112, v112, v114
v_add_f32 v113, v113, v115
v_add_f32 v114, v116, v118
v_add_f32 v115, v117, v119
v_cvt_pk_bf16_f32 v18, v112, v113
v_cvt_pk_bf16_f32 v19, v114, v115
v_and_or_b32 v18, v18, -2, s41
buffer_load_dwordx2 v[110:111], v11, s[4:7], s38 offen offset:512 sc1
s_barrier
buffer_store_dwordx2 v[18:19], v11, s[4:7], s39 offen sc1
v_mov_b32 v112, v18
v_mov_b32 v114, v19
v_mov_b32 v92, v28
v_mov_b32 v93, 0
s_waitcnt vmcnt(6)
s_barrier
ds_read_b128 v[32:35], v6 offset:9216
ds_read_b128 v[36:39], v6 offset:10240
ds_read_b128 v[40:43], v6 offset:14336
ds_read_b128 v[44:47], v6 offset:15360
ds_read_b128 v[48:51], v6 offset:19456
ds_read_b128 v[52:55], v6 offset:20480
ds_read_b128 v[56:59], v6 offset:24576
ds_read_b128 v[60:63], v6 offset:25600
buffer_load_dwordx2 v[20:21], v11, s[4:7], s38 offen sc1
buffer_load_dwordx2 v[22:23], v11, s[4:7], s38 offen offset:512 sc1
s_waitcnt vmcnt(4)
v_mfma_f32_16x16x16_bf16 v[80:83], v[108:109], v[16:17], v[100:103]
v_and_b32 v3, 1, v108
v_cmp_ne_u32 vcc, s41, v3
s_nop 5
v_cvt_pk_bf16_f32 v64, v80, v81
v_cvt_pk_bf16_f32 v65, v82, v83
s_cbranch_vccnz L_rf_w0_xslow
s_waitcnt vmcnt(3)
v_mfma_f32_16x16x16_bf16 v[84:87], v[110:111], v[16:17], v[104:107]
v_and_b32 v3, 1, v110
v_cmp_ne_u32 vcc, s41, v3
s_nop 5
v_cvt_pk_bf16_f32 v66, v84, v85
v_cvt_pk_bf16_f32 v67, v86, v87
ds_write_b128 v6, v[64:67] offset:8192
s_cbranch_vccnz L_rf_w0_xslow
L_rf_w0_xok:
s_cmp_eq_u32 s21, 63
s_cbranch_scc1 L_rf_w0_last
buffer_load_dwordx2 v[116:117], v11, s[4:7], s40 offen sc1
s_waitcnt lgkmcnt(1)
v_mfma_f32_16x16x32_bf16 v[80:83], v[32:35], v[64:67], 0
s_waitcnt lgkmcnt(0)
s_barrier
ds_read_b128 v[68:71], v6 offset:13312
ds_read_b128 v[72:75], v6 offset:18432
ds_read_b128 v[76:79], v6 offset:23552
v_mfma_f32_16x16x32_bf16 v[84:87], v[36:39], v[64:67], 0
v_mfma_f32_16x16x32_bf16 v[88:91], v[64:67], v[64:67], 0
buffer_load_dwordx2 v[20:21], v11, s[4:7], s40 offen sc1
s_waitcnt lgkmcnt(2)
v_mfma_f32_16x16x32_bf16 v[80:83], v[40:43], v[68:71], v[80:83]
buffer_store_dwordx4 v[64:67], v10, s[4:7], s45 offen sc1
s_waitcnt lgkmcnt(1)
v_mfma_f32_16x16x32_bf16 v[80:83], v[48:51], v[72:75], v[80:83]
s_waitcnt lgkmcnt(0)
v_mfma_f32_16x16x32_bf16 v[80:83], v[56:59], v[76:79], v[80:83]
v_mfma_f32_16x16x32_bf16 v[84:87], v[44:47], v[68:71], v[84:87]
v_mfma_f32_16x16x32_bf16 v[84:87], v[52:55], v[72:75], v[84:87]
buffer_store_dwordx2 v[18:19], v11, s[4:7], s51 offen offset:2048 sc1
v_mfma_f32_16x16x32_bf16 v[84:87], v[60:63], v[76:79], v[84:87]
v_mfma_f32_16x16x32_bf16 v[88:91], v[68:71], v[68:71], v[88:91]
v_mfma_f32_16x16x32_bf16 v[88:91], v[72:75], v[72:75], v[88:91]
v_mfma_f32_16x16x32_bf16 v[88:91], v[76:79], v[76:79], v[88:91]
v_mfma_f32_32x32x4_2b_bf16 v[32:63], v[14:15], v[14:15], 0
s_nop 0
v_max3_f32 v4, v80, v81, v82
s_nop 1
v_max3_f32 v4, v4, v83, v84
v_max3_f32 v4, v4, v85, v86
v_max_f32 v4, v4, v87
v_max3_f32 v90, v4, v88, v89
v_max3_f32 v4, v4, v88, v89
s_nop 1
v_permlane16_swap_b32 v4, v90
v_max_f32 v4, v4, v90
v_max_f32 v90, v4, v90
s_nop 1
v_permlane32_swap_b32 v4, v90
v_max_f32 v4, v4, v90
v_mul_f32 v4, s34, v4
v_pk_fma_f32 v[80:81], v[80:81], s[34:35], v[4:5] op_sel_hi:[1,0,0] neg_lo:[0,0,1] neg_hi:[0,0,1]
v_pk_fma_f32 v[82:83], v[82:83], s[34:35], v[4:5] op_sel_hi:[1,0,0] neg_lo:[0,0,1] neg_hi:[0,0,1]
v_pk_fma_f32 v[84:85], v[84:85], s[34:35], v[4:5] op_sel_hi:[1,0,0] neg_lo:[0,0,1] neg_hi:[0,0,1]
v_pk_fma_f32 v[86:87], v[86:87], s[34:35], v[4:5] op_sel_hi:[1,0,0] neg_lo:[0,0,1] neg_hi:[0,0,1]
v_pk_fma_f32 v[88:89], v[88:89], s[34:35], v[4:5] op_sel_hi:[1,0,0] neg_lo:[0,0,1] neg_hi:[0,0,1]
v_exp_f32 v80, v80
v_exp_f32 v81, v81
v_exp_f32 v82, v82
v_cvt_pk_bf16_f32 v68, v80, v81
v_exp_f32 v83, v83
v_exp_f32 v84, v84
v_cvt_pk_bf16_f32 v69, v82, v83
v_exp_f32 v85, v85
v_exp_f32 v86, v86
v_cvt_pk_bf16_f32 v70, v84, v85
v_exp_f32 v87, v87
v_exp_f32 v88, v88
v_cvt_pk_bf16_f32 v71, v86, v87
v_exp_f32 v89, v89
s_waitcnt vmcnt(3)
v_mfma_f32_16x16x32_bf16 v[76:79], v[28:31], v[68:71], 0
v_and_b32 v3, 1, v116
v_cvt_pk_bf16_f32 v72, v88, v89
v_mfma_f32_16x16x32_bf16 v[100:103], v[120:123], v[68:71], 0
v_cmp_ne_u32 vcc, s41, v3
v_cvt_pk_bf16_f32 v73, v88, v89
v_mfma_f32_16x16x32_bf16 v[104:107], v[124:127], v[68:71], 0
v_mov_b32 v113, v116
v_mov_b32 v115, v117
v_mfma_f32_16x16x16_bf16 v[76:79], v[92:93], v[72:73], v[76:79]
s_cbranch_vccnz L_rf_w0_pv0
L_rf_w0_pv2:
v_mfma_f32_16x16x16_bf16 v[100:103], v[112:113], v[72:73], v[100:103]
v_mfma_f32_16x16x16_bf16 v[104:107], v[114:115], v[72:73], v[104:107]
buffer_load_dwordx4 v[120:123], v1, s[4:7], s44 offen
buffer_load_dwordx4 v[124:127], v1, s[4:7], s44 offen offset:1024
s_nop 2
v_rcp_f32 v76, v76
s_mov_b64 exec, s[28:29]
v_pk_mul_f32 v[100:101], v[100:101], v[76:77] op_sel_hi:[1,0]
v_pk_mul_f32 v[102:103], v[102:103], v[76:77] op_sel_hi:[1,0]
v_pk_mul_f32 v[104:105], v[104:105], v[76:77] op_sel_hi:[1,0]
v_pk_mul_f32 v[106:107], v[106:107], v[76:77] op_sel_hi:[1,0]
v_cvt_pk_bf16_f32 v84, v100, v101
v_cvt_pk_bf16_f32 v85, v102, v103
v_cvt_pk_bf16_f32 v86, v104, v105
v_cvt_pk_bf16_f32 v87, v106, v107
ds_write_b128 v6, v[84:87] offset:28640
s_mov_b64 exec, -1
s_waitcnt lgkmcnt(0)
s_barrier
ds_read_b128 v[68:71], v6 offset:28672
ds_read_b128 v[72:75], v6 offset:29696
s_waitcnt lgkmcnt(1)
v_smfmac_f32_16x16x64_bf16 v[32:35], v[68:71], v[128:135], v2
s_add_u32 s21, s21, 1
s_xor_b32 s38, s38, 1048576
s_xor_b32 s37, s37, 1048576
s_waitcnt lgkmcnt(0)
v_smfmac_f32_16x16x64_bf16 v[32:35], v[72:75], v[136:143], v2
s_xor_b32 s40, s40, 1048576
s_xor_b32 s39, s39, 1048576
s_lshr_b32 s41, s21, 1
v_smfmac_f32_16x16x64_bf16 v[36:39], v[68:71], v[144:151], v2
s_and_b32 s41, s41, 1
s_xor_b32 s41, s41, 1
s_xor_b32 s35, s35, 16384
v_smfmac_f32_16x16x64_bf16 v[36:39], v[72:75], v[152:159], v2
v_add_f32 v32, v32, v34
s_xor_b32 s36, s36, 16384
s_add_u32 s43, s43, 262144
s_add_u32 s44, s44, 262144
v_smfmac_f32_16x16x64_bf16 v[40:43], v[68:71], v[160:167], v2
v_add_f32 v33, v33, v35
v_smfmac_f32_16x16x64_bf16 v[40:43], v[72:75], v[168:175], v2
v_cvt_pk_bf16_f32 v32, v32, v33
v_smfmac_f32_16x16x64_bf16 v[44:47], v[68:71], v[176:183], v2
v_and_or_b32 v32, v32, -2, s42
v_smfmac_f32_16x16x64_bf16 v[44:47], v[72:75], v[184:191], v2
v_add_f32 v36, v36, v38
v_smfmac_f32_16x16x64_bf16 v[48:51], v[68:71], v[192:199], v2
v_add_f32 v37, v37, v39
v_smfmac_f32_16x16x64_bf16 v[48:51], v[72:75], v[200:207], v2
v_cvt_pk_bf16_f32 v33, v36, v37
v_smfmac_f32_16x16x64_bf16 v[52:55], v[68:71], v[208:215], v2
v_add_f32 v40, v40, v42
v_smfmac_f32_16x16x64_bf16 v[52:55], v[72:75], v[216:223], v2
v_add_f32 v41, v41, v43
v_smfmac_f32_16x16x64_bf16 v[56:59], v[68:71], v[224:231], v2
v_cvt_pk_bf16_f32 v34, v40, v41
v_smfmac_f32_16x16x64_bf16 v[56:59], v[72:75], v[232:239], v2
v_add_f32 v44, v44, v46
v_smfmac_f32_16x16x64_bf16 v[60:63], v[68:71], v[240:247], v2
v_add_f32 v45, v45, v47
v_smfmac_f32_16x16x64_bf16 v[60:63], v[72:75], v[248:255], v2
v_cvt_pk_bf16_f32 v35, v44, v45
buffer_store_dwordx4 v[32:35], v8, s[4:7], s46 offen
v_pk_add_f32 v[48:49], v[48:49], v[50:51]
v_cvt_pk_bf16_f32 v48, v48, v49
v_and_or_b32 v48, v48, -2, s42
v_pk_add_f32 v[52:53], v[52:53], v[54:55]
v_cvt_pk_bf16_f32 v49, v52, v53
v_pk_add_f32 v[56:57], v[56:57], v[58:59]
v_cvt_pk_bf16_f32 v50, v56, v57
v_pk_add_f32 v[60:61], v[60:61], v[62:63]
v_cvt_pk_bf16_f32 v51, v60, v61
buffer_store_dwordx4 v[48:51], v8, s[4:7], s61 offen
s_add_u32 s45, s45, 262144
s_add_u32 s51, s51, 262144
v_mfma_f32_32x32x8_bf16 v[96:111], v[14:15], v[14:15], 0
v_mfma_f32_16x16x16_bf16 v[112:115], v[14:15], v[14:15], 0
v_mfma_f32_16x16x16_bf16 v[116:119], v[14:15], v[14:15], 0
ds_read_b128 v[64:67], v1
ds_read_b128 v[68:71], v1 offset:1024
ds_read_b128 v[72:75], v1 offset:2048
ds_read_b128 v[76:79], v1 offset:3072
ds_read_b128 v[80:83], v1 offset:16384
ds_read_b128 v[84:87], v1 offset:17408
ds_read_b128 v[88:91], v1 offset:18432
ds_read_b128 v[92:95], v1 offset:19456
v_mov_b32 v58, -1
v_mov_b32 v59, -1
s_waitcnt vmcnt(0)
L_rf_w0_cgo:
L_rf_w0_pc:
buffer_load_dword v36, v13, s[4:7], s25 offen sc1
buffer_load_dword v37, v13, s[4:7], s25 offen offset:256 sc1
buffer_load_dword v38, v13, s[4:7], s25 offen offset:512 sc1
buffer_load_dword v39, v13, s[4:7], s25 offen offset:768 sc1
buffer_load_dword v40, v13, s[4:7], s25 offen offset:1024 sc1
buffer_load_dword v41, v13, s[4:7], s25 offen offset:1280 sc1
buffer_load_dword v42, v13, s[4:7], s25 offen offset:1536 sc1
buffer_load_dword v43, v13, s[4:7], s25 offen offset:1792 sc1
s_waitcnt vmcnt(4)
v_mfma_f32_16x16x32_bf16 v[52:55], v[36:39], v[24:27], 0
v_bitop3_b32 v3, s42, v36, v37 bitop3:0x7e
v_bitop3_b32 v4, s42, v38, v39 bitop3:0x7e
s_waitcnt vmcnt(2)
v_or_b32 v3, v3, v4
v_bitop3_b32 v4, s42, v40, v41 bitop3:0x7e
s_waitcnt vmcnt(0)
v_mfma_f32_16x16x32_bf16 v[52:55], v[40:43], v[24:27], v[52:55]
v_bitop3_b32 v56, s42, v42, v43 bitop3:0x7e
v_or3_b32 v3, v3, v4, v56
v_and_b32 v3, v0, v3
v_cmp_ne_u32 vcc, 0, v3
s_nop 3
v_cvt_pk_bf16_f32 v56, v52, v53
v_cvt_pk_bf16_f32 v57, v54, v55
v_min_u32 v56, -2, v56
s_cbranch_vccnz L_rf_w0_pc
s_mov_b64 exec, s[26:27]
buffer_store_dwordx2 v[56:57], v9, s[4:7], s35 offen
buffer_store_dwordx2 v[58:59], v9, s[4:7], s36 offen
s_mov_b64 exec, -1
s_xor_b32 s42, s42, 1
s_branch L_rf_w0_loop
L_rf_w0_last:
buffer_store_dwordx4 v[64:67], v10, s[4:7], s45 offen sc1
buffer_store_dwordx2 v[18:19], v11, s[4:7], s51 offen offset:2048 sc1
s_branch L_rf_end
L_rf_w0_pafail:
s_nop 7
v_mov_b32 v96, 0
v_mov_b32 v97, 0
v_mov_b32 v98, 0
v_mov_b32 v99, 0
v_mov_b32 v100, 0
v_mov_b32 v101, 0
v_mov_b32 v102, 0
v_mov_b32 v103, 0
v_mov_b32 v104, 0
v_mov_b32 v105, 0
v_mov_b32 v106, 0
v_mov_b32 v107, 0
s_branch L_rf_w0_pa
L_rf_w0_xslow:
buffer_load_dwordx2 v[108:109], v11, s[4:7], s38 offen sc1
buffer_load_dwordx2 v[110:111], v11, s[4:7], s38 offen offset:512 sc1
s_waitcnt vmcnt(2)
v_bitop3_b32 v3, s41, v20, v22 bitop3:0x7e
v_mfma_f32_16x16x16_bf16 v[80:83], v[20:21], v[16:17], v[100:103]
v_and_b32 v3, 1, v3
v_mfma_f32_16x16x16_bf16 v[84:87], v[22:23], v[16:17], v[104:107]
v_cmp_ne_u32 vcc, 0, v3
s_cbranch_vccz L_rf_w0_xgot
buffer_load_dwordx2 v[20:21], v11, s[4:7], s38 offen sc1
buffer_load_dwordx2 v[22:23], v11, s[4:7], s38 offen offset:512 sc1
s_waitcnt vmcnt(2)
v_bitop3_b32 v3, s41, v108, v110 bitop3:0x7e
v_mfma_f32_16x16x16_bf16 v[80:83], v[108:109], v[16:17], v[100:103]
v_and_b32 v3, 1, v3
v_mfma_f32_16x16x16_bf16 v[84:87], v[110:111], v[16:17], v[104:107]
v_cmp_ne_u32 vcc, 0, v3
s_cbranch_vccz L_rf_w0_xgot
s_branch L_rf_w0_xslow
L_rf_w0_xgot:
s_nop 3
v_cvt_pk_bf16_f32 v64, v80, v81
v_cvt_pk_bf16_f32 v65, v82, v83
v_cvt_pk_bf16_f32 v66, v84, v85
v_cvt_pk_bf16_f32 v67, v86, v87
ds_write_b128 v6, v[64:67] offset:8192
s_branch L_rf_w0_xok
L_rf_w0_pv0:
s_waitcnt vmcnt(2)
s_branch L_rf_w0_pv1
L_rf_w0_pv:
buffer_load_dwordx2 v[20:21], v11, s[4:7], s40 offen sc1
s_waitcnt vmcnt(0)
L_rf_w0_pv1:
v_and_b32 v3, 1, v20
v_cmp_ne_u32 vcc, s41, v3
v_mov_b32 v113, v20
v_mov_b32 v115, v21
s_cbranch_vccnz L_rf_w0_pv
s_branch L_rf_w0_pv2
L_rf_w1_entry:
v_mfma_f32_32x32x8_bf16 v[96:111], v[14:15], v[14:15], 0
v_mfma_f32_16x16x16_bf16 v[112:115], v[14:15], v[14:15], 0
v_mfma_f32_16x16x16_bf16 v[116:119], v[14:15], v[14:15], 0
ds_read_b128 v[64:67], v1 offset:4096
ds_read_b128 v[68:71], v1 offset:5120
ds_read_b128 v[72:75], v1 offset:6144
ds_read_b128 v[76:79], v1 offset:7168
ds_read_b128 v[80:83], v1 offset:20480
ds_read_b128 v[84:87], v1 offset:21504
ds_read_b128 v[88:91], v1 offset:22528
ds_read_b128 v[92:95], v1 offset:23552
buffer_load_dwordx4 v[120:123], v1, s[4:7], s44 offen
buffer_load_dwordx4 v[124:127], v1, s[4:7], s44 offen offset:1024
s_add_u32 s44, s44, 262144
L_rf_w1_loop:
s_add_u32 s22, s35, 2048
s_waitcnt vmcnt(0)
buffer_load_dwordx4 v[40:43], v1, s[4:7], s22 offen sc1
buffer_load_dwordx4 v[44:47], v1, s[4:7], s22 offen offset:1024 sc1
L_rf_w1_pa:
s_waitcnt vmcnt(1)
ds_write_b128 v6, v[40:43] offset:2048
s_waitcnt vmcnt(0)
ds_write_b128 v6, v[44:47] offset:3072
v_max3_u32 v3, v40, v42, v44
v_max_u32 v3, v3, v46
v_cmp_eq_u32 vcc, -1, v3
v_smfmac_f32_16x16x64_bf16 v[96:99], v[40:43], a[32:39], v2
buffer_load_dwordx4 v[40:43], v1, s[4:7], s22 offen sc1
v_smfmac_f32_16x16x64_bf16 v[100:103], v[40:43], a[40:47], v2
buffer_load_dwordx4 v[44:47], v1, s[4:7], s22 offen offset:1024 sc1
v_smfmac_f32_16x16x64_bf16 v[104:107], v[40:43], a[160:167], v2
s_cbranch_vccnz L_rf_w1_pafail
s_waitcnt lgkmcnt(0)
s_barrier
ds_read_b128 v[48:51], v6 offset:4096
ds_read_b128 v[52:55], v6 offset:5120
v_smfmac_f32_16x16x64_bf16 v[108:111], v[40:43], a[168:175], v2
ds_read_b128 v[56:59], v6 offset:6144
v_smfmac_f32_16x16x64_bf16 v[96:99], v[44:47], a[48:55], v2
ds_read_b128 v[60:63], v6 offset:7168
v_smfmac_f32_16x16x64_bf16 v[100:103], v[44:47], a[56:63], v2
ds_read_b128 v[32:35], v6
v_smfmac_f32_16x16x64_bf16 v[104:107], v[44:47], a[176:183], v2
ds_read_b128 v[36:39], v6 offset:1024
v_smfmac_f32_16x16x64_bf16 v[108:111], v[44:47], a[184:191], v2
s_waitcnt lgkmcnt(5)
v_smfmac_f32_16x16x64_bf16 v[96:99], v[48:51], a[64:71], v2
buffer_load_dwordx4 v1, s[4:7], s43 offen lds
v_smfmac_f32_16x16x64_bf16 v[104:107], v[48:51], a[192:199], v2
s_waitcnt lgkmcnt(4)
v_smfmac_f32_16x16x64_bf16 v[96:99], v[52:55], a[80:87], v2
v_smfmac_f32_16x16x64_bf16 v[104:107], v[52:55], a[208:215], v2
s_waitcnt lgkmcnt(3)
v_smfmac_f32_16x16x64_bf16 v[96:99], v[56:59], a[96:103], v2
buffer_load_dwordx4 v1, s[4:7], s43 offen offset:1024 lds
v_smfmac_f32_16x16x64_bf16 v[104:107], v[56:59], a[224:231], v2
s_waitcnt lgkmcnt(2)
v_smfmac_f32_16x16x64_bf16 v[96:99], v[60:63], a[112:119], v2
v_smfmac_f32_16x16x64_bf16 v[104:107], v[60:63], a[240:247], v2
s_waitcnt lgkmcnt(1)
v_smfmac_f32_16x16x64_bf16 v[96:99], v[32:35], a[0:7], v2
v_smfmac_f32_16x16x64_bf16 v[104:107], v[32:35], a[128:135], v2
s_waitcnt lgkmcnt(0)
v_smfmac_f32_16x16x64_bf16 v[96:99], v[36:39], a[16:23], v2
v_smfmac_f32_16x16x64_bf16 v[104:107], v[36:39], a[144:151], v2
v_smfmac_f32_16x16x64_bf16 v[100:103], v[48:51], a[72:79], v2
s_nop 2
v_smfmac_f32_16x16x64_bf16 v[100:103], v[52:55], a[88:95], v2
s_nop 1
v_add_f32 v96, v96, v98
v_smfmac_f32_16x16x64_bf16 v[100:103], v[56:59], a[104:111], v2
v_add_f32 v97, v97, v99
v_add_f32 v104, v104, v106
v_smfmac_f32_16x16x64_bf16 v[100:103], v[60:63], a[120:127], v2
v_add_f32 v105, v105, v107
v_cvt_pk_bf16_f32 v96, v96, v97
v_smfmac_f32_16x16x64_bf16 v[100:103], v[32:35], a[8:15], v2
v_cvt_pk_bf16_f32 v97, v104, v105
v_and_or_b32 v96, v96, -2, s41
v_smfmac_f32_16x16x64_bf16 v[100:103], v[36:39], a[24:31], v2
buffer_store_dwordx2 v[96:97], v11, s[4:7], s37 offen sc1
v_smfmac_f32_16x16x64_bf16 v[108:111], v[48:51], a[200:207], v2
v_smfmac_f32_16x16x64_bf16 v[108:111], v[52:55], a[216:223], v2
v_smfmac_f32_16x16x64_bf16 v[108:111], v[56:59], a[232:239], v2
v_smfmac_f32_16x16x64_bf16 v[108:111], v[60:63], a[248:255], v2
v_smfmac_f32_16x16x64_bf16 v[108:111], v[32:35], a[136:143], v2
s_nop 2
v_add_f32 v100, v100, v102
v_smfmac_f32_16x16x64_bf16 v[108:111], v[36:39], a[152:159], v2
v_add_f32 v101, v101, v103
v_cvt_pk_bf16_f32 v98, v100, v101
v_and_or_b32 v98, v98, -2, s41
s_nop 4
v_pk_add_f32 v[108:109], v[108:109], v[110:111]
v_cvt_pk_bf16_f32 v99, v108, v109
buffer_store_dwordx2 v[98:99], v11, s[4:7], s37 offen offset:512 sc1
v_smfmac_f32_16x16x64_bf16 v[112:115], v[32:35], v[64:71], v2
ds_read_b128 v[64:67], v1 offset:36864
ds_read_b128 v[68:71], v1 offset:37888
v_smfmac_f32_16x16x64_bf16 v[116:119], v[32:35], v[72:79], v2
ds_read_b128 v[72:75], v1 offset:38912
ds_read_b128 v[76:79], v1 offset:39936
v_smfmac_f32_16x16x64_bf16 v[112:115], v[36:39], v[80:87], v2
ds_read_b128 v[80:83], v1 offset:53248
ds_read_b128 v[84:87], v1 offset:54272
v_smfmac_f32_16x16x64_bf16 v[116:119], v[36:39], v[88:95], v2
ds_read_b128 v[88:91], v1 offset:55296
ds_read_b128 v[92:95], v1 offset:56320
s_waitcnt lgkmcnt(6)
v_smfmac_f32_16x16x64_bf16 v[112:115], v[40:43], v[64:71], v2
ds_read_b128 v[64:67], v5 offset:4096
ds_read_b128 v[68:71], v5 offset:5120
s_waitcnt lgkmcnt(6)
v_smfmac_f32_16x16x64_bf16 v[116:119], v[40:43], v[72:79], v2
ds_read_b128 v[72:75], v5 offset:6144
ds_read_b128 v[76:79], v5 offset:7168
s_waitcnt lgkmcnt(6)
v_smfmac_f32_16x16x64_bf16 v[112:115], v[44:47], v[80:87], v2
ds_read_b128 v[80:83], v5 offset:20480
ds_read_b128 v[84:87], v5 offset:21504
s_waitcnt lgkmcnt(6)
v_smfmac_f32_16x16x64_bf16 v[116:119], v[44:47], v[88:95], v2
ds_read_b128 v[88:91], v5 offset:22528
ds_read_b128 v[92:95], v5 offset:23552
s_waitcnt lgkmcnt(6)
v_smfmac_f32_16x16x64_bf16 v[112:115], v[48:51], v[64:71], v2
ds_read_b128 v[64:67], v5 offset:36864
ds_read_b128 v[68:71], v5 offset:37888
s_waitcnt lgkmcnt(6)
v_smfmac_f32_16x16x64_bf16 v[116:119], v[48:51], v[72:79], v2
ds_read_b128 v[72:75], v5 offset:38912
ds_read_b128 v[76:79], v5 offset:39936
s_waitcnt lgkmcnt(6)
v_smfmac_f32_16x16x64_bf16 v[112:115], v[52:55], v[80:87], v2
ds_read_b128 v[80:83], v5 offset:53248
ds_read_b128 v[84:87], v5 offset:54272
s_waitcnt lgkmcnt(6)
v_smfmac_f32_16x16x64_bf16 v[116:119], v[52:55], v[88:95], v2
ds_read_b128 v[88:91], v5 offset:55296
ds_read_b128 v[92:95], v5 offset:56320
s_waitcnt lgkmcnt(6)
v_smfmac_f32_16x16x64_bf16 v[112:115], v[56:59], v[64:71], v2
s_waitcnt lgkmcnt(4)
v_smfmac_f32_16x16x64_bf16 v[116:119], v[56:59], v[72:79], v2
s_waitcnt lgkmcnt(2)
v_smfmac_f32_16x16x64_bf16 v[112:115], v[60:63], v[80:87], v2
s_waitcnt lgkmcnt(0)
v_smfmac_f32_16x16x64_bf16 v[116:119], v[60:63], v[88:95], v2
buffer_load_dwordx2 v[108:109], v11, s[4:7], s38 offen sc1
v_mfma_f32_16x16x16_bf16 v[100:103], v[96:97], v[16:17], 0
v_mfma_f32_16x16x16_bf16 v[104:107], v[98:99], v[16:17], 0
s_nop 4
v_add_f32 v112, v112, v114
v_add_f32 v113, v113, v115
v_add_f32 v114, v116, v118
v_add_f32 v115, v117, v119
v_cvt_pk_bf16_f32 v18, v112, v113
v_cvt_pk_bf16_f32 v19, v114, v115
v_and_or_b32 v18, v18, -2, s41
buffer_load_dwordx2 v[110:111], v11, s[4:7], s38 offen offset:512 sc1
s_barrier
buffer_store_dwordx2 v[18:19], v11, s[4:7], s39 offen sc1
v_mov_b32 v112, v18
v_mov_b32 v114, v19
v_mov_b32 v92, v28
v_mov_b32 v93, 0
s_waitcnt vmcnt(5)
s_barrier
ds_read_b128 v[32:35], v6 offset:14336
ds_read_b128 v[36:39], v6 offset:15360
ds_read_b128 v[40:43], v6 offset:9216
ds_read_b128 v[44:47], v6 offset:10240
ds_read_b128 v[48:51], v6 offset:24576
ds_read_b128 v[52:55], v6 offset:25600
ds_read_b128 v[56:59], v6 offset:19456
ds_read_b128 v[60:63], v6 offset:20480
buffer_load_dwordx2 v[20:21], v11, s[4:7], s38 offen sc1
buffer_load_dwordx2 v[22:23], v11, s[4:7], s38 offen offset:512 sc1
s_waitcnt vmcnt(4)
v_mfma_f32_16x16x16_bf16 v[80:83], v[108:109], v[16:17], v[100:103]
v_and_b32 v3, 1, v108
v_cmp_ne_u32 vcc, s41, v3
s_nop 5
v_cvt_pk_bf16_f32 v64, v80, v81
v_cvt_pk_bf16_f32 v65, v82, v83
s_cbranch_vccnz L_rf_w1_xslow
s_waitcnt vmcnt(3)
v_mfma_f32_16x16x16_bf16 v[84:87], v[110:111], v[16:17], v[104:107]
v_and_b32 v3, 1, v110
v_cmp_ne_u32 vcc, s41, v3
s_nop 5
v_cvt_pk_bf16_f32 v66, v84, v85
v_cvt_pk_bf16_f32 v67, v86, v87
ds_write_b128 v6, v[64:67] offset:13312
s_cbranch_vccnz L_rf_w1_xslow
L_rf_w1_xok:
s_cmp_eq_u32 s21, 63
s_cbranch_scc1 L_rf_w1_last
buffer_load_dwordx2 v[116:117], v11, s[4:7], s40 offen sc1
s_waitcnt lgkmcnt(1)
v_mfma_f32_16x16x32_bf16 v[80:83], v[32:35], v[64:67], 0
s_waitcnt lgkmcnt(0)
s_barrier
ds_read_b128 v[68:71], v6 offset:8192
ds_read_b128 v[72:75], v6 offset:23552
ds_read_b128 v[76:79], v6 offset:18432
v_mfma_f32_16x16x32_bf16 v[84:87], v[36:39], v[64:67], 0
v_mfma_f32_16x16x32_bf16 v[88:91], v[64:67], v[64:67], 0
buffer_load_dwordx2 v[20:21], v11, s[4:7], s40 offen sc1
s_waitcnt lgkmcnt(2)
v_mfma_f32_16x16x32_bf16 v[80:83], v[40:43], v[68:71], v[80:83]
s_waitcnt lgkmcnt(1)
v_mfma_f32_16x16x32_bf16 v[80:83], v[48:51], v[72:75], v[80:83]
buffer_store_dwordx4 v[64:67], v10, s[4:7], s45 offen offset:64 sc1
s_waitcnt lgkmcnt(0)
v_mfma_f32_16x16x32_bf16 v[80:83], v[56:59], v[76:79], v[80:83]
v_mfma_f32_16x16x32_bf16 v[84:87], v[44:47], v[68:71], v[84:87]
v_mfma_f32_16x16x32_bf16 v[84:87], v[52:55], v[72:75], v[84:87]
v_mfma_f32_16x16x32_bf16 v[84:87], v[60:63], v[76:79], v[84:87]
buffer_store_dwordx2 v[18:19], v11, s[4:7], s51 offen offset:2560 sc1
v_mfma_f32_16x16x32_bf16 v[88:91], v[68:71], v[68:71], v[88:91]
v_mfma_f32_16x16x32_bf16 v[88:91], v[72:75], v[72:75], v[88:91]
v_mfma_f32_16x16x32_bf16 v[88:91], v[76:79], v[76:79], v[88:91]
v_mfma_f32_32x32x4_2b_bf16 v[32:63], v[14:15], v[14:15], 0
s_nop 0
v_max3_f32 v4, v80, v81, v82
s_nop 1
v_max3_f32 v4, v4, v83, v84
v_max3_f32 v4, v4, v85, v86
v_max_f32 v4, v4, v87
v_max3_f32 v90, v4, v88, v89
v_max3_f32 v4, v4, v88, v89
s_nop 1
v_permlane16_swap_b32 v4, v90
v_max_f32 v4, v4, v90
v_max_f32 v90, v4, v90
s_nop 1
v_permlane32_swap_b32 v4, v90
v_max_f32 v4, v4, v90
v_mul_f32 v4, s34, v4
v_pk_fma_f32 v[80:81], v[80:81], s[34:35], v[4:5] op_sel_hi:[1,0,0] neg_lo:[0,0,1] neg_hi:[0,0,1]
v_pk_fma_f32 v[82:83], v[82:83], s[34:35], v[4:5] op_sel_hi:[1,0,0] neg_lo:[0,0,1] neg_hi:[0,0,1]
v_pk_fma_f32 v[84:85], v[84:85], s[34:35], v[4:5] op_sel_hi:[1,0,0] neg_lo:[0,0,1] neg_hi:[0,0,1]
v_pk_fma_f32 v[86:87], v[86:87], s[34:35], v[4:5] op_sel_hi:[1,0,0] neg_lo:[0,0,1] neg_hi:[0,0,1]
v_pk_fma_f32 v[88:89], v[88:89], s[34:35], v[4:5] op_sel_hi:[1,0,0] neg_lo:[0,0,1] neg_hi:[0,0,1]
v_exp_f32 v80, v80
v_exp_f32 v81, v81
v_exp_f32 v82, v82
v_cvt_pk_bf16_f32 v68, v80, v81
v_exp_f32 v83, v83
v_exp_f32 v84, v84
v_cvt_pk_bf16_f32 v69, v82, v83
v_exp_f32 v85, v85
v_exp_f32 v86, v86
v_cvt_pk_bf16_f32 v70, v84, v85
v_exp_f32 v87, v87
v_exp_f32 v88, v88
v_cvt_pk_bf16_f32 v71, v86, v87
v_exp_f32 v89, v89
s_waitcnt vmcnt(3)
v_mfma_f32_16x16x32_bf16 v[76:79], v[28:31], v[68:71], 0
v_and_b32 v3, 1, v116
v_cvt_pk_bf16_f32 v72, v88, v89
v_mfma_f32_16x16x32_bf16 v[100:103], v[120:123], v[68:71], 0
v_cmp_ne_u32 vcc, s41, v3
v_cvt_pk_bf16_f32 v73, v88, v89
v_mfma_f32_16x16x32_bf16 v[104:107], v[124:127], v[68:71], 0
v_mov_b32 v113, v116
v_mov_b32 v115, v117
v_mfma_f32_16x16x16_bf16 v[76:79], v[92:93], v[72:73], v[76:79]
s_cbranch_vccnz L_rf_w1_pv0
L_rf_w1_pv2:
v_mfma_f32_16x16x16_bf16 v[100:103], v[112:113], v[72:73], v[100:103]
v_mfma_f32_16x16x16_bf16 v[104:107], v[114:115], v[72:73], v[104:107]
buffer_load_dwordx4 v[120:123], v1, s[4:7], s44 offen
buffer_load_dwordx4 v[124:127], v1, s[4:7], s44 offen offset:1024
s_nop 2
v_rcp_f32 v76, v76
s_mov_b64 exec, s[28:29]
v_pk_mul_f32 v[100:101], v[100:101], v[76:77] op_sel_hi:[1,0]
v_pk_mul_f32 v[102:103], v[102:103], v[76:77] op_sel_hi:[1,0]
v_pk_mul_f32 v[104:105], v[104:105], v[76:77] op_sel_hi:[1,0]
v_pk_mul_f32 v[106:107], v[106:107], v[76:77] op_sel_hi:[1,0]
v_cvt_pk_bf16_f32 v84, v100, v101
v_cvt_pk_bf16_f32 v85, v102, v103
v_cvt_pk_bf16_f32 v86, v104, v105
v_cvt_pk_bf16_f32 v87, v106, v107
ds_write_b128 v6, v[84:87] offset:28672
s_mov_b64 exec, -1
s_waitcnt lgkmcnt(0)
s_barrier
ds_read_b128 v[68:71], v6 offset:28672
ds_read_b128 v[72:75], v6 offset:29696
s_waitcnt lgkmcnt(1)
v_smfmac_f32_16x16x64_bf16 v[32:35], v[68:71], v[128:135], v2
s_add_u32 s21, s21, 1
s_xor_b32 s38, s38, 1048576
s_xor_b32 s37, s37, 1048576
s_waitcnt lgkmcnt(0)
v_smfmac_f32_16x16x64_bf16 v[32:35], v[72:75], v[136:143], v2
s_xor_b32 s40, s40, 1048576
s_xor_b32 s39, s39, 1048576
s_lshr_b32 s41, s21, 1
v_smfmac_f32_16x16x64_bf16 v[36:39], v[68:71], v[144:151], v2
s_and_b32 s41, s41, 1
s_xor_b32 s41, s41, 1
s_xor_b32 s35, s35, 16384
v_smfmac_f32_16x16x64_bf16 v[36:39], v[72:75], v[152:159], v2
v_add_f32 v32, v32, v34
s_xor_b32 s36, s36, 16384
s_add_u32 s43, s43, 262144
s_add_u32 s44, s44, 262144
v_smfmac_f32_16x16x64_bf16 v[40:43], v[68:71], v[160:167], v2
v_add_f32 v33, v33, v35
v_smfmac_f32_16x16x64_bf16 v[40:43], v[72:75], v[168:175], v2
v_cvt_pk_bf16_f32 v32, v32, v33
v_smfmac_f32_16x16x64_bf16 v[44:47], v[68:71], v[176:183], v2
v_and_or_b32 v32, v32, -2, s42
v_smfmac_f32_16x16x64_bf16 v[44:47], v[72:75], v[184:191], v2
v_add_f32 v36, v36, v38
v_smfmac_f32_16x16x64_bf16 v[48:51], v[68:71], v[192:199], v2
v_add_f32 v37, v37, v39
v_smfmac_f32_16x16x64_bf16 v[48:51], v[72:75], v[200:207], v2
v_cvt_pk_bf16_f32 v33, v36, v37
v_smfmac_f32_16x16x64_bf16 v[52:55], v[68:71], v[208:215], v2
v_add_f32 v40, v40, v42
v_smfmac_f32_16x16x64_bf16 v[52:55], v[72:75], v[216:223], v2
v_add_f32 v41, v41, v43
v_smfmac_f32_16x16x64_bf16 v[56:59], v[68:71], v[224:231], v2
v_cvt_pk_bf16_f32 v34, v40, v41
v_smfmac_f32_16x16x64_bf16 v[56:59], v[72:75], v[232:239], v2
v_add_f32 v44, v44, v46
v_smfmac_f32_16x16x64_bf16 v[60:63], v[68:71], v[240:247], v2
v_add_f32 v45, v45, v47
v_smfmac_f32_16x16x64_bf16 v[60:63], v[72:75], v[248:255], v2
v_cvt_pk_bf16_f32 v35, v44, v45
buffer_store_dwordx4 v[32:35], v8, s[4:7], s46 offen
v_pk_add_f32 v[48:49], v[48:49], v[50:51]
v_cvt_pk_bf16_f32 v48, v48, v49
v_and_or_b32 v48, v48, -2, s42
v_pk_add_f32 v[52:53], v[52:53], v[54:55]
v_cvt_pk_bf16_f32 v49, v52, v53
v_pk_add_f32 v[56:57], v[56:57], v[58:59]
v_cvt_pk_bf16_f32 v50, v56, v57
v_pk_add_f32 v[60:61], v[60:61], v[62:63]
v_cvt_pk_bf16_f32 v51, v60, v61
buffer_store_dwordx4 v[48:51], v8, s[4:7], s61 offen
s_add_u32 s45, s45, 262144
s_add_u32 s51, s51, 262144
v_mfma_f32_32x32x8_bf16 v[96:111], v[14:15], v[14:15], 0
v_mfma_f32_16x16x16_bf16 v[112:115], v[14:15], v[14:15], 0
v_mfma_f32_16x16x16_bf16 v[116:119], v[14:15], v[14:15], 0
ds_read_b128 v[64:67], v1 offset:4096
ds_read_b128 v[68:71], v1 offset:5120
ds_read_b128 v[72:75], v1 offset:6144
ds_read_b128 v[76:79], v1 offset:7168
ds_read_b128 v[80:83], v1 offset:20480
ds_read_b128 v[84:87], v1 offset:21504
ds_read_b128 v[88:91], v1 offset:22528
ds_read_b128 v[92:95], v1 offset:23552
v_mov_b32 v58, -1
v_mov_b32 v59, -1
s_waitcnt vmcnt(0)
L_rf_w1_cgo:
L_rf_w1_pc:
buffer_load_dword v36, v13, s[4:7], s25 offen sc1
buffer_load_dword v37, v13, s[4:7], s25 offen offset:256 sc1
buffer_load_dword v38, v13, s[4:7], s25 offen offset:512 sc1
buffer_load_dword v39, v13, s[4:7], s25 offen offset:768 sc1
buffer_load_dword v40, v13, s[4:7], s25 offen offset:1024 sc1
buffer_load_dword v41, v13, s[4:7], s25 offen offset:1280 sc1
buffer_load_dword v42, v13, s[4:7], s25 offen offset:1536 sc1
buffer_load_dword v43, v13, s[4:7], s25 offen offset:1792 sc1
s_waitcnt vmcnt(4)
v_mfma_f32_16x16x32_bf16 v[52:55], v[36:39], v[24:27], 0
v_bitop3_b32 v3, s42, v36, v37 bitop3:0x7e
v_bitop3_b32 v4, s42, v38, v39 bitop3:0x7e
s_waitcnt vmcnt(2)
v_or_b32 v3, v3, v4
v_bitop3_b32 v4, s42, v40, v41 bitop3:0x7e
s_waitcnt vmcnt(0)
v_mfma_f32_16x16x32_bf16 v[52:55], v[40:43], v[24:27], v[52:55]
v_bitop3_b32 v56, s42, v42, v43 bitop3:0x7e
v_or3_b32 v3, v3, v4, v56
v_and_b32 v3, v0, v3
v_cmp_ne_u32 vcc, 0, v3
s_nop 3
v_cvt_pk_bf16_f32 v56, v52, v53
v_cvt_pk_bf16_f32 v57, v54, v55
v_min_u32 v56, -2, v56
s_cbranch_vccnz L_rf_w1_pc
s_mov_b64 exec, s[26:27]
buffer_store_dwordx2 v[56:57], v9, s[4:7], s35 offen offset:256
buffer_store_dwordx2 v[58:59], v9, s[4:7], s36 offen offset:256
s_mov_b64 exec, -1
s_xor_b32 s42, s42, 1
s_branch L_rf_w1_loop
L_rf_w1_last:
buffer_store_dwordx4 v[64:67], v10, s[4:7], s45 offen offset:64 sc1
buffer_store_dwordx2 v[18:19], v11, s[4:7], s51 offen offset:2560 sc1
s_branch L_rf_end
L_rf_w1_pafail:
s_nop 7
v_mov_b32 v96, 0
v_mov_b32 v97, 0
v_mov_b32 v98, 0
v_mov_b32 v99, 0
v_mov_b32 v100, 0
v_mov_b32 v101, 0
v_mov_b32 v102, 0
v_mov_b32 v103, 0
v_mov_b32 v104, 0
v_mov_b32 v105, 0
v_mov_b32 v106, 0
v_mov_b32 v107, 0
s_branch L_rf_w1_pa
L_rf_w1_xslow:
buffer_load_dwordx2 v[108:109], v11, s[4:7], s38 offen sc1
buffer_load_dwordx2 v[110:111], v11, s[4:7], s38 offen offset:512 sc1
s_waitcnt vmcnt(2)
v_bitop3_b32 v3, s41, v20, v22 bitop3:0x7e
v_mfma_f32_16x16x16_bf16 v[80:83], v[20:21], v[16:17], v[100:103]
v_and_b32 v3, 1, v3
v_mfma_f32_16x16x16_bf16 v[84:87], v[22:23], v[16:17], v[104:107]
v_cmp_ne_u32 vcc, 0, v3
s_cbranch_vccz L_rf_w1_xgot
buffer_load_dwordx2 v[20:21], v11, s[4:7], s38 offen sc1
buffer_load_dwordx2 v[22:23], v11, s[4:7], s38 offen offset:512 sc1
s_waitcnt vmcnt(2)
v_bitop3_b32 v3, s41, v108, v110 bitop3:0x7e
v_mfma_f32_16x16x16_bf16 v[80:83], v[108:109], v[16:17], v[100:103]
v_and_b32 v3, 1, v3
v_mfma_f32_16x16x16_bf16 v[84:87], v[110:111], v[16:17], v[104:107]
v_cmp_ne_u32 vcc, 0, v3
s_cbranch_vccz L_rf_w1_xgot
s_branch L_rf_w1_xslow
L_rf_w1_xgot:
s_nop 3
v_cvt_pk_bf16_f32 v64, v80, v81
v_cvt_pk_bf16_f32 v65, v82, v83
v_cvt_pk_bf16_f32 v66, v84, v85
v_cvt_pk_bf16_f32 v67, v86, v87
ds_write_b128 v6, v[64:67] offset:13312
s_branch L_rf_w1_xok
L_rf_w1_pv0:
s_waitcnt vmcnt(2)
s_branch L_rf_w1_pv1
L_rf_w1_pv:
buffer_load_dwordx2 v[20:21], v11, s[4:7], s40 offen sc1
s_waitcnt vmcnt(0)
L_rf_w1_pv1:
v_and_b32 v3, 1, v20
v_cmp_ne_u32 vcc, s41, v3
v_mov_b32 v113, v20
v_mov_b32 v115, v21
s_cbranch_vccnz L_rf_w1_pv
s_branch L_rf_w1_pv2
L_rf_w2_entry:
v_mfma_f32_32x32x8_bf16 v[96:111], v[14:15], v[14:15], 0
v_mfma_f32_16x16x16_bf16 v[112:115], v[14:15], v[14:15], 0
v_mfma_f32_16x16x16_bf16 v[116:119], v[14:15], v[14:15], 0
ds_read_b128 v[64:67], v1 offset:8192
ds_read_b128 v[68:71], v1 offset:9216
ds_read_b128 v[72:75], v1 offset:10240
ds_read_b128 v[76:79], v1 offset:11264
ds_read_b128 v[80:83], v1 offset:24576
ds_read_b128 v[84:87], v1 offset:25600
ds_read_b128 v[88:91], v1 offset:26624
ds_read_b128 v[92:95], v1 offset:27648
buffer_load_dwordx4 v[120:123], v1, s[4:7], s44 offen
buffer_load_dwordx4 v[124:127], v1, s[4:7], s44 offen offset:1024
s_add_u32 s44, s44, 262144
L_rf_w2_loop:
s_add_u32 s22, s35, 4096
s_waitcnt vmcnt(0)
buffer_load_dwordx4 v[48:51], v1, s[4:7], s22 offen sc1
buffer_load_dwordx4 v[52:55], v1, s[4:7], s22 offen offset:1024 sc1
L_rf_w2_pa:
s_waitcnt vmcnt(1)
ds_write_b128 v6, v[48:51] offset:4096
s_waitcnt vmcnt(0)
ds_write_b128 v6, v[52:55] offset:5120
v_max3_u32 v3, v48, v50, v52
v_max_u32 v3, v3, v54
v_cmp_eq_u32 vcc, -1, v3
v_smfmac_f32_16x16x64_bf16 v[96:99], v[48:51], a[64:71], v2
buffer_load_dwordx4 v[48:51], v1, s[4:7], s22 offen sc1
v_smfmac_f32_16x16x64_bf16 v[100:103], v[48:51], a[72:79], v2
buffer_load_dwordx4 v[52:55], v1, s[4:7], s22 offen offset:1024 sc1
v_smfmac_f32_16x16x64_bf16 v[104:107], v[48:51], a[192:199], v2
s_cbranch_vccnz L_rf_w2_pafail
s_waitcnt lgkmcnt(0)
s_barrier
ds_read_b128 v[56:59], v6 offset:6144
ds_read_b128 v[60:63], v6 offset:7168
v_smfmac_f32_16x16x64_bf16 v[108:111], v[48:51], a[200:207], v2
ds_read_b128 v[32:35], v6
v_smfmac_f32_16x16x64_bf16 v[96:99], v[52:55], a[80:87], v2
ds_read_b128 v[36:39], v6 offset:1024
v_smfmac_f32_16x16x64_bf16 v[100:103], v[52:55], a[88:95], v2
ds_read_b128 v[40:43], v6 offset:2048
v_smfmac_f32_16x16x64_bf16 v[104:107], v[52:55], a[208:215], v2
ds_read_b128 v[44:47], v6 offset:3072
v_smfmac_f32_16x16x64_bf16 v[108:111], v[52:55], a[216:223], v2
s_waitcnt lgkmcnt(5)
v_smfmac_f32_16x16x64_bf16 v[96:99], v[56:59], a[96:103], v2
v_smfmac_f32_16x16x64_bf16 v[104:107], v[56:59], a[224:231], v2
buffer_load_dwordx4 v1, s[4:7], s43 offen lds
s_waitcnt lgkmcnt(4)
v_smfmac_f32_16x16x64_bf16 v[96:99], v[60:63], a[112:119], v2
v_smfmac_f32_16x16x64_bf16 v[104:107], v[60:63], a[240:247], v2
s_waitcnt lgkmcnt(3)
v_smfmac_f32_16x16x64_bf16 v[96:99], v[32:35], a[0:7], v2
v_smfmac_f32_16x16x64_bf16 v[104:107], v[32:35], a[128:135], v2
buffer_load_dwordx4 v1, s[4:7], s43 offen offset:1024 lds
s_waitcnt lgkmcnt(2)
v_smfmac_f32_16x16x64_bf16 v[96:99], v[36:39], a[16:23], v2
v_smfmac_f32_16x16x64_bf16 v[104:107], v[36:39], a[144:151], v2
s_waitcnt lgkmcnt(1)
v_smfmac_f32_16x16x64_bf16 v[96:99], v[40:43], a[32:39], v2
v_smfmac_f32_16x16x64_bf16 v[104:107], v[40:43], a[160:167], v2
s_waitcnt lgkmcnt(0)
v_smfmac_f32_16x16x64_bf16 v[96:99], v[44:47], a[48:55], v2
v_smfmac_f32_16x16x64_bf16 v[104:107], v[44:47], a[176:183], v2
v_smfmac_f32_16x16x64_bf16 v[100:103], v[56:59], a[104:111], v2
s_nop 2
v_smfmac_f32_16x16x64_bf16 v[100:103], v[60:63], a[120:127], v2
s_nop 1
v_add_f32 v96, v96, v98
v_smfmac_f32_16x16x64_bf16 v[100:103], v[32:35], a[8:15], v2
v_add_f32 v97, v97, v99
v_add_f32 v104, v104, v106
v_smfmac_f32_16x16x64_bf16 v[100:103], v[36:39], a[24:31], v2
v_add_f32 v105, v105, v107
v_cvt_pk_bf16_f32 v96, v96, v97
v_smfmac_f32_16x16x64_bf16 v[100:103], v[40:43], a[40:47], v2
v_cvt_pk_bf16_f32 v97, v104, v105
v_and_or_b32 v96, v96, -2, s41
v_smfmac_f32_16x16x64_bf16 v[100:103], v[44:47], a[56:63], v2
buffer_store_dwordx2 v[96:97], v11, s[4:7], s37 offen sc1
v_smfmac_f32_16x16x64_bf16 v[108:111], v[56:59], a[232:239], v2
v_smfmac_f32_16x16x64_bf16 v[108:111], v[60:63], a[248:255], v2
v_smfmac_f32_16x16x64_bf16 v[108:111], v[32:35], a[136:143], v2
v_smfmac_f32_16x16x64_bf16 v[108:111], v[36:39], a[152:159], v2
v_smfmac_f32_16x16x64_bf16 v[108:111], v[40:43], a[168:175], v2
s_nop 2
v_add_f32 v100, v100, v102
v_smfmac_f32_16x16x64_bf16 v[108:111], v[44:47], a[184:191], v2
v_add_f32 v101, v101, v103
v_cvt_pk_bf16_f32 v98, v100, v101
v_and_or_b32 v98, v98, -2, s41
s_nop 4
v_pk_add_f32 v[108:109], v[108:109], v[110:111]
v_cvt_pk_bf16_f32 v99, v108, v109
buffer_store_dwordx2 v[98:99], v11, s[4:7], s37 offen offset:512 sc1
v_smfmac_f32_16x16x64_bf16 v[112:115], v[32:35], v[64:71], v2
ds_read_b128 v[64:67], v1 offset:40960
ds_read_b128 v[68:71], v1 offset:41984
v_smfmac_f32_16x16x64_bf16 v[116:119], v[32:35], v[72:79], v2
ds_read_b128 v[72:75], v1 offset:43008
ds_read_b128 v[76:79], v1 offset:44032
v_smfmac_f32_16x16x64_bf16 v[112:115], v[36:39], v[80:87], v2
ds_read_b128 v[80:83], v1 offset:57344
ds_read_b128 v[84:87], v1 offset:58368
v_smfmac_f32_16x16x64_bf16 v[116:119], v[36:39], v[88:95], v2
ds_read_b128 v[88:91], v1 offset:59392
ds_read_b128 v[92:95], v1 offset:60416
s_waitcnt lgkmcnt(6)
v_smfmac_f32_16x16x64_bf16 v[112:115], v[40:43], v[64:71], v2
ds_read_b128 v[64:67], v5 offset:8192
ds_read_b128 v[68:71], v5 offset:9216
s_waitcnt lgkmcnt(6)
v_smfmac_f32_16x16x64_bf16 v[116:119], v[40:43], v[72:79], v2
ds_read_b128 v[72:75], v5 offset:10240
ds_read_b128 v[76:79], v5 offset:11264
s_waitcnt lgkmcnt(6)
v_smfmac_f32_16x16x64_bf16 v[112:115], v[44:47], v[80:87], v2
ds_read_b128 v[80:83], v5 offset:24576
ds_read_b128 v[84:87], v5 offset:25600
s_waitcnt lgkmcnt(6)
v_smfmac_f32_16x16x64_bf16 v[116:119], v[44:47], v[88:95], v2
ds_read_b128 v[88:91], v5 offset:26624
ds_read_b128 v[92:95], v5 offset:27648
s_waitcnt lgkmcnt(6)
v_smfmac_f32_16x16x64_bf16 v[112:115], v[48:51], v[64:71], v2
ds_read_b128 v[64:67], v5 offset:40960
ds_read_b128 v[68:71], v5 offset:41984
s_waitcnt lgkmcnt(6)
v_smfmac_f32_16x16x64_bf16 v[116:119], v[48:51], v[72:79], v2
ds_read_b128 v[72:75], v5 offset:43008
ds_read_b128 v[76:79], v5 offset:44032
s_waitcnt lgkmcnt(6)
v_smfmac_f32_16x16x64_bf16 v[112:115], v[52:55], v[80:87], v2
ds_read_b128 v[80:83], v5 offset:57344
ds_read_b128 v[84:87], v5 offset:58368
s_waitcnt lgkmcnt(6)
v_smfmac_f32_16x16x64_bf16 v[116:119], v[52:55], v[88:95], v2
ds_read_b128 v[88:91], v5 offset:59392
ds_read_b128 v[92:95], v5 offset:60416
s_waitcnt lgkmcnt(6)
v_smfmac_f32_16x16x64_bf16 v[112:115], v[56:59], v[64:71], v2
s_waitcnt lgkmcnt(4)
v_smfmac_f32_16x16x64_bf16 v[116:119], v[56:59], v[72:79], v2
s_waitcnt lgkmcnt(2)
v_smfmac_f32_16x16x64_bf16 v[112:115], v[60:63], v[80:87], v2
s_waitcnt lgkmcnt(0)
v_smfmac_f32_16x16x64_bf16 v[116:119], v[60:63], v[88:95], v2
buffer_load_dwordx2 v[108:109], v11, s[4:7], s38 offen sc1
v_mfma_f32_16x16x16_bf16 v[100:103], v[96:97], v[16:17], 0
v_mfma_f32_16x16x16_bf16 v[104:107], v[98:99], v[16:17], 0
s_nop 4
v_add_f32 v112, v112, v114
v_add_f32 v113, v113, v115
v_add_f32 v114, v116, v118
v_add_f32 v115, v117, v119
v_cvt_pk_bf16_f32 v18, v112, v113
v_cvt_pk_bf16_f32 v19, v114, v115
v_and_or_b32 v18, v18, -2, s41
buffer_load_dwordx2 v[110:111], v11, s[4:7], s38 offen offset:512 sc1
s_barrier
buffer_store_dwordx2 v[18:19], v11, s[4:7], s39 offen sc1
v_mov_b32 v112, v18
v_mov_b32 v114, v19
v_mov_b32 v92, v28
v_mov_b32 v93, 0
s_waitcnt vmcnt(5)
s_barrier
ds_read_b128 v[32:35], v6 offset:19456
ds_read_b128 v[36:39], v6 offset:20480
ds_read_b128 v[40:43], v6 offset:24576
ds_read_b128 v[44:47], v6 offset:25600
ds_read_b128 v[48:51], v6 offset:9216
ds_read_b128 v[52:55], v6 offset:10240
ds_read_b128 v[56:59], v6 offset:14336
ds_read_b128 v[60:63], v6 offset:15360
buffer_load_dwordx2 v[20:21], v11, s[4:7], s38 offen sc1
buffer_load_dwordx2 v[22:23], v11, s[4:7], s38 offen offset:512 sc1
s_waitcnt vmcnt(4)
v_mfma_f32_16x16x16_bf16 v[80:83], v[108:109], v[16:17], v[100:103]
v_and_b32 v3, 1, v108
v_cmp_ne_u32 vcc, s41, v3
s_nop 5
v_cvt_pk_bf16_f32 v64, v80, v81
v_cvt_pk_bf16_f32 v65, v82, v83
s_cbranch_vccnz L_rf_w2_xslow
s_waitcnt vmcnt(3)
v_mfma_f32_16x16x16_bf16 v[84:87], v[110:111], v[16:17], v[104:107]
v_and_b32 v3, 1, v110
v_cmp_ne_u32 vcc, s41, v3
s_nop 5
v_cvt_pk_bf16_f32 v66, v84, v85
v_cvt_pk_bf16_f32 v67, v86, v87
ds_write_b128 v6, v[64:67] offset:18432
s_cbranch_vccnz L_rf_w2_xslow
L_rf_w2_xok:
s_cmp_eq_u32 s21, 63
s_cbranch_scc1 L_rf_w2_last
buffer_load_dwordx2 v[116:117], v11, s[4:7], s40 offen sc1
s_waitcnt lgkmcnt(1)
v_mfma_f32_16x16x32_bf16 v[80:83], v[32:35], v[64:67], 0
s_waitcnt lgkmcnt(0)
s_barrier
ds_read_b128 v[68:71], v6 offset:23552
ds_read_b128 v[72:75], v6 offset:8192
ds_read_b128 v[76:79], v6 offset:13312
v_mfma_f32_16x16x32_bf16 v[84:87], v[36:39], v[64:67], 0
v_mfma_f32_16x16x32_bf16 v[88:91], v[64:67], v[64:67], 0
buffer_load_dwordx2 v[20:21], v11, s[4:7], s40 offen sc1
s_waitcnt lgkmcnt(2)
v_mfma_f32_16x16x32_bf16 v[80:83], v[40:43], v[68:71], v[80:83]
s_waitcnt lgkmcnt(1)
v_mfma_f32_16x16x32_bf16 v[80:83], v[48:51], v[72:75], v[80:83]
s_waitcnt lgkmcnt(0)
v_mfma_f32_16x16x32_bf16 v[80:83], v[56:59], v[76:79], v[80:83]
buffer_store_dwordx4 v[64:67], v10, s[4:7], s45 offen offset:128 sc1
v_mfma_f32_16x16x32_bf16 v[84:87], v[44:47], v[68:71], v[84:87]
v_mfma_f32_16x16x32_bf16 v[84:87], v[52:55], v[72:75], v[84:87]
v_mfma_f32_16x16x32_bf16 v[84:87], v[60:63], v[76:79], v[84:87]
v_mfma_f32_16x16x32_bf16 v[88:91], v[68:71], v[68:71], v[88:91]
buffer_store_dwordx2 v[18:19], v11, s[4:7], s51 offen offset:3072 sc1
v_mfma_f32_16x16x32_bf16 v[88:91], v[72:75], v[72:75], v[88:91]
v_mfma_f32_16x16x32_bf16 v[88:91], v[76:79], v[76:79], v[88:91]
v_mfma_f32_32x32x4_2b_bf16 v[32:63], v[14:15], v[14:15], 0
s_nop 0
v_max3_f32 v4, v80, v81, v82
s_nop 1
v_max3_f32 v4, v4, v83, v84
v_max3_f32 v4, v4, v85, v86
v_max_f32 v4, v4, v87
v_max3_f32 v90, v4, v88, v89
v_max3_f32 v4, v4, v88, v89
s_nop 1
v_permlane16_swap_b32 v4, v90
v_max_f32 v4, v4, v90
v_max_f32 v90, v4, v90
s_nop 1
v_permlane32_swap_b32 v4, v90
v_max_f32 v4, v4, v90
v_mul_f32 v4, s34, v4
v_pk_fma_f32 v[80:81], v[80:81], s[34:35], v[4:5] op_sel_hi:[1,0,0] neg_lo:[0,0,1] neg_hi:[0,0,1]
v_pk_fma_f32 v[82:83], v[82:83], s[34:35], v[4:5] op_sel_hi:[1,0,0] neg_lo:[0,0,1] neg_hi:[0,0,1]
v_pk_fma_f32 v[84:85], v[84:85], s[34:35], v[4:5] op_sel_hi:[1,0,0] neg_lo:[0,0,1] neg_hi:[0,0,1]
v_pk_fma_f32 v[86:87], v[86:87], s[34:35], v[4:5] op_sel_hi:[1,0,0] neg_lo:[0,0,1] neg_hi:[0,0,1]
v_pk_fma_f32 v[88:89], v[88:89], s[34:35], v[4:5] op_sel_hi:[1,0,0] neg_lo:[0,0,1] neg_hi:[0,0,1]
v_exp_f32 v80, v80
v_exp_f32 v81, v81
v_exp_f32 v82, v82
v_cvt_pk_bf16_f32 v68, v80, v81
v_exp_f32 v83, v83
v_exp_f32 v84, v84
v_cvt_pk_bf16_f32 v69, v82, v83
v_exp_f32 v85, v85
v_exp_f32 v86, v86
v_cvt_pk_bf16_f32 v70, v84, v85
v_exp_f32 v87, v87
v_exp_f32 v88, v88
v_cvt_pk_bf16_f32 v71, v86, v87
v_exp_f32 v89, v89
s_waitcnt vmcnt(3)
v_mfma_f32_16x16x32_bf16 v[76:79], v[28:31], v[68:71], 0
v_and_b32 v3, 1, v116
v_cvt_pk_bf16_f32 v72, v88, v89
v_mfma_f32_16x16x32_bf16 v[100:103], v[120:123], v[68:71], 0
v_cmp_ne_u32 vcc, s41, v3
v_cvt_pk_bf16_f32 v73, v88, v89
v_mfma_f32_16x16x32_bf16 v[104:107], v[124:127], v[68:71], 0
v_mov_b32 v113, v116
v_mov_b32 v115, v117
v_mfma_f32_16x16x16_bf16 v[76:79], v[92:93], v[72:73], v[76:79]
s_cbranch_vccnz L_rf_w2_pv0
L_rf_w2_pv2:
v_mfma_f32_16x16x16_bf16 v[100:103], v[112:113], v[72:73], v[100:103]
v_mfma_f32_16x16x16_bf16 v[104:107], v[114:115], v[72:73], v[104:107]
buffer_load_dwordx4 v[120:123], v1, s[4:7], s44 offen
buffer_load_dwordx4 v[124:127], v1, s[4:7], s44 offen offset:1024
s_nop 2
v_rcp_f32 v76, v76
s_mov_b64 exec, s[28:29]
v_pk_mul_f32 v[100:101], v[100:101], v[76:77] op_sel_hi:[1,0]
v_pk_mul_f32 v[102:103], v[102:103], v[76:77] op_sel_hi:[1,0]
v_pk_mul_f32 v[104:105], v[104:105], v[76:77] op_sel_hi:[1,0]
v_pk_mul_f32 v[106:107], v[106:107], v[76:77] op_sel_hi:[1,0]
v_cvt_pk_bf16_f32 v84, v100, v101
v_cvt_pk_bf16_f32 v85, v102, v103
v_cvt_pk_bf16_f32 v86, v104, v105
v_cvt_pk_bf16_f32 v87, v106, v107
ds_write_b128 v6, v[84:87] offset:29664
s_mov_b64 exec, -1
s_waitcnt lgkmcnt(0)
s_barrier
ds_read_b128 v[68:71], v6 offset:28672
ds_read_b128 v[72:75], v6 offset:29696
s_waitcnt lgkmcnt(1)
v_smfmac_f32_16x16x64_bf16 v[32:35], v[68:71], v[128:135], v2
s_add_u32 s21, s21, 1
s_xor_b32 s38, s38, 1048576
s_xor_b32 s37, s37, 1048576
s_waitcnt lgkmcnt(0)
v_smfmac_f32_16x16x64_bf16 v[32:35], v[72:75], v[136:143], v2
s_xor_b32 s40, s40, 1048576
s_xor_b32 s39, s39, 1048576
s_lshr_b32 s41, s21, 1
v_smfmac_f32_16x16x64_bf16 v[36:39], v[68:71], v[144:151], v2
s_and_b32 s41, s41, 1
s_xor_b32 s41, s41, 1
s_xor_b32 s35, s35, 16384
v_smfmac_f32_16x16x64_bf16 v[36:39], v[72:75], v[152:159], v2
v_add_f32 v32, v32, v34
s_xor_b32 s36, s36, 16384
s_add_u32 s43, s43, 262144
s_add_u32 s44, s44, 262144
v_smfmac_f32_16x16x64_bf16 v[40:43], v[68:71], v[160:167], v2
v_add_f32 v33, v33, v35
v_smfmac_f32_16x16x64_bf16 v[40:43], v[72:75], v[168:175], v2
v_cvt_pk_bf16_f32 v32, v32, v33
v_smfmac_f32_16x16x64_bf16 v[44:47], v[68:71], v[176:183], v2
v_and_or_b32 v32, v32, -2, s42
v_smfmac_f32_16x16x64_bf16 v[44:47], v[72:75], v[184:191], v2
v_add_f32 v36, v36, v38
v_smfmac_f32_16x16x64_bf16 v[48:51], v[68:71], v[192:199], v2
v_add_f32 v37, v37, v39
v_smfmac_f32_16x16x64_bf16 v[48:51], v[72:75], v[200:207], v2
v_cvt_pk_bf16_f32 v33, v36, v37
v_smfmac_f32_16x16x64_bf16 v[52:55], v[68:71], v[208:215], v2
v_add_f32 v40, v40, v42
v_smfmac_f32_16x16x64_bf16 v[52:55], v[72:75], v[216:223], v2
v_add_f32 v41, v41, v43
v_smfmac_f32_16x16x64_bf16 v[56:59], v[68:71], v[224:231], v2
v_cvt_pk_bf16_f32 v34, v40, v41
v_smfmac_f32_16x16x64_bf16 v[56:59], v[72:75], v[232:239], v2
v_add_f32 v44, v44, v46
v_smfmac_f32_16x16x64_bf16 v[60:63], v[68:71], v[240:247], v2
v_add_f32 v45, v45, v47
v_smfmac_f32_16x16x64_bf16 v[60:63], v[72:75], v[248:255], v2
v_cvt_pk_bf16_f32 v35, v44, v45
buffer_store_dwordx4 v[32:35], v8, s[4:7], s46 offen
v_pk_add_f32 v[48:49], v[48:49], v[50:51]
v_cvt_pk_bf16_f32 v48, v48, v49
v_and_or_b32 v48, v48, -2, s42
v_pk_add_f32 v[52:53], v[52:53], v[54:55]
v_cvt_pk_bf16_f32 v49, v52, v53
v_pk_add_f32 v[56:57], v[56:57], v[58:59]
v_cvt_pk_bf16_f32 v50, v56, v57
v_pk_add_f32 v[60:61], v[60:61], v[62:63]
v_cvt_pk_bf16_f32 v51, v60, v61
buffer_store_dwordx4 v[48:51], v8, s[4:7], s61 offen
s_add_u32 s45, s45, 262144
s_add_u32 s51, s51, 262144
v_mfma_f32_32x32x8_bf16 v[96:111], v[14:15], v[14:15], 0
v_mfma_f32_16x16x16_bf16 v[112:115], v[14:15], v[14:15], 0
v_mfma_f32_16x16x16_bf16 v[116:119], v[14:15], v[14:15], 0
ds_read_b128 v[64:67], v1 offset:8192
ds_read_b128 v[68:71], v1 offset:9216
ds_read_b128 v[72:75], v1 offset:10240
ds_read_b128 v[76:79], v1 offset:11264
ds_read_b128 v[80:83], v1 offset:24576
ds_read_b128 v[84:87], v1 offset:25600
ds_read_b128 v[88:91], v1 offset:26624
ds_read_b128 v[92:95], v1 offset:27648
v_mov_b32 v58, -1
v_mov_b32 v59, -1
s_waitcnt vmcnt(0)
L_rf_w2_cgo:
L_rf_w2_pc:
buffer_load_dword v36, v13, s[4:7], s25 offen sc1
buffer_load_dword v37, v13, s[4:7], s25 offen offset:256 sc1
buffer_load_dword v38, v13, s[4:7], s25 offen offset:512 sc1
buffer_load_dword v39, v13, s[4:7], s25 offen offset:768 sc1
buffer_load_dword v40, v13, s[4:7], s25 offen offset:1024 sc1
buffer_load_dword v41, v13, s[4:7], s25 offen offset:1280 sc1
buffer_load_dword v42, v13, s[4:7], s25 offen offset:1536 sc1
buffer_load_dword v43, v13, s[4:7], s25 offen offset:1792 sc1
s_waitcnt vmcnt(4)
v_mfma_f32_16x16x32_bf16 v[52:55], v[36:39], v[24:27], 0
v_bitop3_b32 v3, s42, v36, v37 bitop3:0x7e
v_bitop3_b32 v4, s42, v38, v39 bitop3:0x7e
s_waitcnt vmcnt(2)
v_or_b32 v3, v3, v4
v_bitop3_b32 v4, s42, v40, v41 bitop3:0x7e
s_waitcnt vmcnt(0)
v_mfma_f32_16x16x32_bf16 v[52:55], v[40:43], v[24:27], v[52:55]
v_bitop3_b32 v56, s42, v42, v43 bitop3:0x7e
v_or3_b32 v3, v3, v4, v56
v_and_b32 v3, v0, v3
v_cmp_ne_u32 vcc, 0, v3
s_nop 3
v_cvt_pk_bf16_f32 v56, v52, v53
v_cvt_pk_bf16_f32 v57, v54, v55
v_min_u32 v56, -2, v56
s_cbranch_vccnz L_rf_w2_pc
s_mov_b64 exec, s[26:27]
buffer_store_dwordx2 v[56:57], v9, s[4:7], s35 offen offset:512
buffer_store_dwordx2 v[58:59], v9, s[4:7], s36 offen offset:512
s_mov_b64 exec, -1
s_xor_b32 s42, s42, 1
s_branch L_rf_w2_loop
L_rf_w2_last:
buffer_store_dwordx4 v[64:67], v10, s[4:7], s45 offen offset:128 sc1
buffer_store_dwordx2 v[18:19], v11, s[4:7], s51 offen offset:3072 sc1
s_branch L_rf_end
L_rf_w2_pafail:
s_nop 7
v_mov_b32 v96, 0
v_mov_b32 v97, 0
v_mov_b32 v98, 0
v_mov_b32 v99, 0
v_mov_b32 v100, 0
v_mov_b32 v101, 0
v_mov_b32 v102, 0
v_mov_b32 v103, 0
v_mov_b32 v104, 0
v_mov_b32 v105, 0
v_mov_b32 v106, 0
v_mov_b32 v107, 0
s_branch L_rf_w2_pa
L_rf_w2_xslow:
buffer_load_dwordx2 v[108:109], v11, s[4:7], s38 offen sc1
buffer_load_dwordx2 v[110:111], v11, s[4:7], s38 offen offset:512 sc1
s_waitcnt vmcnt(2)
v_bitop3_b32 v3, s41, v20, v22 bitop3:0x7e
v_mfma_f32_16x16x16_bf16 v[80:83], v[20:21], v[16:17], v[100:103]
v_and_b32 v3, 1, v3
v_mfma_f32_16x16x16_bf16 v[84:87], v[22:23], v[16:17], v[104:107]
v_cmp_ne_u32 vcc, 0, v3
s_cbranch_vccz L_rf_w2_xgot
buffer_load_dwordx2 v[20:21], v11, s[4:7], s38 offen sc1
buffer_load_dwordx2 v[22:23], v11, s[4:7], s38 offen offset:512 sc1
s_waitcnt vmcnt(2)
v_bitop3_b32 v3, s41, v108, v110 bitop3:0x7e
v_mfma_f32_16x16x16_bf16 v[80:83], v[108:109], v[16:17], v[100:103]
v_and_b32 v3, 1, v3
v_mfma_f32_16x16x16_bf16 v[84:87], v[110:111], v[16:17], v[104:107]
v_cmp_ne_u32 vcc, 0, v3
s_cbranch_vccz L_rf_w2_xgot
s_branch L_rf_w2_xslow
L_rf_w2_xgot:
s_nop 3
v_cvt_pk_bf16_f32 v64, v80, v81
v_cvt_pk_bf16_f32 v65, v82, v83
v_cvt_pk_bf16_f32 v66, v84, v85
v_cvt_pk_bf16_f32 v67, v86, v87
ds_write_b128 v6, v[64:67] offset:18432
s_branch L_rf_w2_xok
L_rf_w2_pv0:
s_waitcnt vmcnt(2)
s_branch L_rf_w2_pv1
L_rf_w2_pv:
buffer_load_dwordx2 v[20:21], v11, s[4:7], s40 offen sc1
s_waitcnt vmcnt(0)
L_rf_w2_pv1:
v_and_b32 v3, 1, v20
v_cmp_ne_u32 vcc, s41, v3
v_mov_b32 v113, v20
v_mov_b32 v115, v21
s_cbranch_vccnz L_rf_w2_pv
s_branch L_rf_w2_pv2
L_rf_w3_entry:
v_mfma_f32_32x32x8_bf16 v[96:111], v[14:15], v[14:15], 0
v_mfma_f32_16x16x16_bf16 v[112:115], v[14:15], v[14:15], 0
v_mfma_f32_16x16x16_bf16 v[116:119], v[14:15], v[14:15], 0
ds_read_b128 v[64:67], v1 offset:12288
ds_read_b128 v[68:71], v1 offset:13312
ds_read_b128 v[72:75], v1 offset:14336
ds_read_b128 v[76:79], v1 offset:15360
ds_read_b128 v[80:83], v1 offset:28672
ds_read_b128 v[84:87], v1 offset:29696
ds_read_b128 v[88:91], v1 offset:30720
ds_read_b128 v[92:95], v1 offset:31744
buffer_load_dwordx4 v[120:123], v1, s[4:7], s44 offen
buffer_load_dwordx4 v[124:127], v1, s[4:7], s44 offen offset:1024
s_add_u32 s44, s44, 262144
L_rf_w3_loop:
s_add_u32 s22, s35, 6144
s_waitcnt vmcnt(0)
buffer_load_dwordx4 v[56:59], v1, s[4:7], s22 offen sc1
buffer_load_dwordx4 v[60:63], v1, s[4:7], s22 offen offset:1024 sc1
L_rf_w3_pa:
s_waitcnt vmcnt(1)
ds_write_b128 v6, v[56:59] offset:6144
s_waitcnt vmcnt(0)
ds_write_b128 v6, v[60:63] offset:7168
v_max3_u32 v3, v56, v58, v60
v_max_u32 v3, v3, v62
v_cmp_eq_u32 vcc, -1, v3
v_smfmac_f32_16x16x64_bf16 v[96:99], v[56:59], a[96:103], v2
buffer_load_dwordx4 v[56:59], v1, s[4:7], s22 offen sc1
v_smfmac_f32_16x16x64_bf16 v[100:103], v[56:59], a[104:111], v2
buffer_load_dwordx4 v[60:63], v1, s[4:7], s22 offen offset:1024 sc1
v_smfmac_f32_16x16x64_bf16 v[104:107], v[56:59], a[224:231], v2
s_cbranch_vccnz L_rf_w3_pafail
s_waitcnt lgkmcnt(0)
s_barrier
ds_read_b128 v[32:35], v6
ds_read_b128 v[36:39], v6 offset:1024
v_smfmac_f32_16x16x64_bf16 v[108:111], v[56:59], a[232:239], v2
ds_read_b128 v[40:43], v6 offset:2048
v_smfmac_f32_16x16x64_bf16 v[96:99], v[60:63], a[112:119], v2
ds_read_b128 v[44:47], v6 offset:3072
v_smfmac_f32_16x16x64_bf16 v[100:103], v[60:63], a[120:127], v2
ds_read_b128 v[48:51], v6 offset:4096
v_smfmac_f32_16x16x64_bf16 v[104:107], v[60:63], a[240:247], v2
ds_read_b128 v[52:55], v6 offset:5120
v_smfmac_f32_16x16x64_bf16 v[108:111], v[60:63], a[248:255], v2
s_waitcnt lgkmcnt(5)
v_smfmac_f32_16x16x64_bf16 v[96:99], v[32:35], a[0:7], v2
v_smfmac_f32_16x16x64_bf16 v[104:107], v[32:35], a[128:135], v2
s_waitcnt lgkmcnt(4)
v_smfmac_f32_16x16x64_bf16 v[96:99], v[36:39], a[16:23], v2
buffer_load_dwordx4 v1, s[4:7], s43 offen lds
v_smfmac_f32_16x16x64_bf16 v[104:107], v[36:39], a[144:151], v2
s_waitcnt lgkmcnt(3)
v_smfmac_f32_16x16x64_bf16 v[96:99], v[40:43], a[32:39], v2
v_smfmac_f32_16x16x64_bf16 v[104:107], v[40:43], a[160:167], v2
s_waitcnt lgkmcnt(2)
v_smfmac_f32_16x16x64_bf16 v[96:99], v[44:47], a[48:55], v2
buffer_load_dwordx4 v1, s[4:7], s43 offen offset:1024 lds
v_smfmac_f32_16x16x64_bf16 v[104:107], v[44:47], a[176:183], v2
s_waitcnt lgkmcnt(1)
v_smfmac_f32_16x16x64_bf16 v[96:99], v[48:51], a[64:71], v2
v_smfmac_f32_16x16x64_bf16 v[104:107], v[48:51], a[192:199], v2
s_waitcnt lgkmcnt(0)
v_smfmac_f32_16x16x64_bf16 v[96:99], v[52:55], a[80:87], v2
buffer_load_dword v12, v7, s[4:7], 0 offen sc1
v_smfmac_f32_16x16x64_bf16 v[104:107], v[52:55], a[208:215], v2
v_smfmac_f32_16x16x64_bf16 v[100:103], v[32:35], a[8:15], v2
s_nop 2
v_smfmac_f32_16x16x64_bf16 v[100:103], v[36:39], a[24:31], v2
s_nop 1
v_add_f32 v96, v96, v98
v_smfmac_f32_16x16x64_bf16 v[100:103], v[40:43], a[40:47], v2
v_add_f32 v97, v97, v99
v_add_f32 v104, v104, v106
v_smfmac_f32_16x16x64_bf16 v[100:103], v[44:47], a[56:63], v2
v_add_f32 v105, v105, v107
v_cvt_pk_bf16_f32 v96, v96, v97
v_smfmac_f32_16x16x64_bf16 v[100:103], v[48:51], a[72:79], v2
v_cvt_pk_bf16_f32 v97, v104, v105
v_and_or_b32 v96, v96, -2, s41
v_smfmac_f32_16x16x64_bf16 v[100:103], v[52:55], a[88:95], v2
buffer_store_dwordx2 v[96:97], v11, s[4:7], s37 offen sc1
v_smfmac_f32_16x16x64_bf16 v[108:111], v[32:35], a[136:143], v2
v_smfmac_f32_16x16x64_bf16 v[108:111], v[36:39], a[152:159], v2
v_smfmac_f32_16x16x64_bf16 v[108:111], v[40:43], a[168:175], v2
v_smfmac_f32_16x16x64_bf16 v[108:111], v[44:47], a[184:191], v2
v_smfmac_f32_16x16x64_bf16 v[108:111], v[48:51], a[200:207], v2
s_nop 2
v_add_f32 v100, v100, v102
v_smfmac_f32_16x16x64_bf16 v[108:111], v[52:55], a[216:223], v2
v_add_f32 v101, v101, v103
v_cvt_pk_bf16_f32 v98, v100, v101
v_and_or_b32 v98, v98, -2, s41
s_nop 4
v_pk_add_f32 v[108:109], v[108:109], v[110:111]
v_cvt_pk_bf16_f32 v99, v108, v109
buffer_store_dwordx2 v[98:99], v11, s[4:7], s37 offen offset:512 sc1
v_smfmac_f32_16x16x64_bf16 v[112:115], v[32:35], v[64:71], v2
ds_read_b128 v[64:67], v1 offset:45056
ds_read_b128 v[68:71], v1 offset:46080
v_smfmac_f32_16x16x64_bf16 v[116:119], v[32:35], v[72:79], v2
ds_read_b128 v[72:75], v1 offset:47104
ds_read_b128 v[76:79], v1 offset:48128
v_smfmac_f32_16x16x64_bf16 v[112:115], v[36:39], v[80:87], v2
ds_read_b128 v[80:83], v1 offset:61440
ds_read_b128 v[84:87], v1 offset:62464
v_smfmac_f32_16x16x64_bf16 v[116:119], v[36:39], v[88:95], v2
ds_read_b128 v[88:91], v1 offset:63488
ds_read_b128 v[92:95], v1 offset:64512
s_waitcnt lgkmcnt(6)
v_smfmac_f32_16x16x64_bf16 v[112:115], v[40:43], v[64:71], v2
ds_read_b128 v[64:67], v5 offset:12288
ds_read_b128 v[68:71], v5 offset:13312
s_waitcnt lgkmcnt(6)
v_smfmac_f32_16x16x64_bf16 v[116:119], v[40:43], v[72:79], v2
ds_read_b128 v[72:75], v5 offset:14336
ds_read_b128 v[76:79], v5 offset:15360
s_waitcnt lgkmcnt(6)
v_smfmac_f32_16x16x64_bf16 v[112:115], v[44:47], v[80:87], v2
ds_read_b128 v[80:83], v5 offset:28672
ds_read_b128 v[84:87], v5 offset:29696
s_waitcnt lgkmcnt(6)
v_smfmac_f32_16x16x64_bf16 v[116:119], v[44:47], v[88:95], v2
ds_read_b128 v[88:91], v5 offset:30720
ds_read_b128 v[92:95], v5 offset:31744
s_waitcnt lgkmcnt(6)
v_smfmac_f32_16x16x64_bf16 v[112:115], v[48:51], v[64:71], v2
ds_read_b128 v[64:67], v5 offset:45056
ds_read_b128 v[68:71], v5 offset:46080
s_waitcnt lgkmcnt(6)
v_smfmac_f32_16x16x64_bf16 v[116:119], v[48:51], v[72:79], v2
ds_read_b128 v[72:75], v5 offset:47104
ds_read_b128 v[76:79], v5 offset:48128
s_waitcnt lgkmcnt(6)
v_smfmac_f32_16x16x64_bf16 v[112:115], v[52:55], v[80:87], v2
ds_read_b128 v[80:83], v5 offset:61440
ds_read_b128 v[84:87], v5 offset:62464
s_waitcnt lgkmcnt(6)
v_smfmac_f32_16x16x64_bf16 v[116:119], v[52:55], v[88:95], v2
ds_read_b128 v[88:91], v5 offset:63488
ds_read_b128 v[92:95], v5 offset:64512
s_waitcnt lgkmcnt(6)
v_smfmac_f32_16x16x64_bf16 v[112:115], v[56:59], v[64:71], v2
s_waitcnt lgkmcnt(4)
v_smfmac_f32_16x16x64_bf16 v[116:119], v[56:59], v[72:79], v2
s_waitcnt lgkmcnt(2)
v_smfmac_f32_16x16x64_bf16 v[112:115], v[60:63], v[80:87], v2
s_waitcnt lgkmcnt(0)
v_smfmac_f32_16x16x64_bf16 v[116:119], v[60:63], v[88:95], v2
buffer_load_dwordx2 v[108:109], v11, s[4:7], s38 offen sc1
v_mfma_f32_16x16x16_bf16 v[100:103], v[96:97], v[16:17], 0
v_mfma_f32_16x16x16_bf16 v[104:107], v[98:99], v[16:17], 0
s_nop 4
v_add_f32 v112, v112, v114
v_add_f32 v113, v113, v115
v_add_f32 v114, v116, v118
v_add_f32 v115, v117, v119
v_cvt_pk_bf16_f32 v18, v112, v113
v_cvt_pk_bf16_f32 v19, v114, v115
v_and_or_b32 v18, v18, -2, s41
buffer_load_dwordx2 v[110:111], v11, s[4:7], s38 offen offset:512 sc1
s_barrier
buffer_store_dwordx2 v[18:19], v11, s[4:7], s39 offen sc1
v_mov_b32 v112, v18
v_mov_b32 v114, v19
v_mov_b32 v92, v28
v_mov_b32 v93, 0
s_waitcnt vmcnt(6)
s_barrier
ds_read_b128 v[32:35], v6 offset:24576
ds_read_b128 v[36:39], v6 offset:25600
ds_read_b128 v[40:43], v6 offset:19456
ds_read_b128 v[44:47], v6 offset:20480
ds_read_b128 v[48:51], v6 offset:14336
ds_read_b128 v[52:55], v6 offset:15360
ds_read_b128 v[56:59], v6 offset:9216
ds_read_b128 v[60:63], v6 offset:10240
buffer_load_dwordx2 v[20:21], v11, s[4:7], s38 offen sc1
buffer_load_dwordx2 v[22:23], v11, s[4:7], s38 offen offset:512 sc1
s_waitcnt vmcnt(4)
v_mfma_f32_16x16x16_bf16 v[80:83], v[108:109], v[16:17], v[100:103]
v_and_b32 v3, 1, v108
v_cmp_ne_u32 vcc, s41, v3
s_nop 5
v_cvt_pk_bf16_f32 v64, v80, v81
v_cvt_pk_bf16_f32 v65, v82, v83
s_cbranch_vccnz L_rf_w3_xslow
s_waitcnt vmcnt(3)
v_mfma_f32_16x16x16_bf16 v[84:87], v[110:111], v[16:17], v[104:107]
v_and_b32 v3, 1, v110
v_cmp_ne_u32 vcc, s41, v3
s_nop 5
v_cvt_pk_bf16_f32 v66, v84, v85
v_cvt_pk_bf16_f32 v67, v86, v87
ds_write_b128 v6, v[64:67] offset:23552
s_cbranch_vccnz L_rf_w3_xslow
L_rf_w3_xok:
s_cmp_eq_u32 s21, 63
s_cbranch_scc1 L_rf_w3_last
buffer_load_dwordx2 v[116:117], v11, s[4:7], s40 offen sc1
s_waitcnt lgkmcnt(1)
v_mfma_f32_16x16x32_bf16 v[80:83], v[32:35], v[64:67], 0
s_waitcnt lgkmcnt(0)
s_barrier
ds_read_b128 v[68:71], v6 offset:18432
ds_read_b128 v[72:75], v6 offset:13312
ds_read_b128 v[76:79], v6 offset:8192
v_mfma_f32_16x16x32_bf16 v[84:87], v[36:39], v[64:67], 0
v_mfma_f32_16x16x32_bf16 v[88:91], v[64:67], v[64:67], 0
buffer_load_dwordx2 v[20:21], v11, s[4:7], s40 offen sc1
s_waitcnt lgkmcnt(2)
v_mfma_f32_16x16x32_bf16 v[80:83], v[40:43], v[68:71], v[80:83]
s_waitcnt lgkmcnt(1)
v_mfma_f32_16x16x32_bf16 v[80:83], v[48:51], v[72:75], v[80:83]
s_waitcnt lgkmcnt(0)
v_mfma_f32_16x16x32_bf16 v[80:83], v[56:59], v[76:79], v[80:83]
v_mfma_f32_16x16x32_bf16 v[84:87], v[44:47], v[68:71], v[84:87]
buffer_store_dwordx4 v[64:67], v10, s[4:7], s45 offen offset:192 sc1
v_mfma_f32_16x16x32_bf16 v[84:87], v[52:55], v[72:75], v[84:87]
v_mfma_f32_16x16x32_bf16 v[84:87], v[60:63], v[76:79], v[84:87]
v_mfma_f32_16x16x32_bf16 v[88:91], v[68:71], v[68:71], v[88:91]
v_mfma_f32_16x16x32_bf16 v[88:91], v[72:75], v[72:75], v[88:91]
buffer_store_dwordx2 v[18:19], v11, s[4:7], s51 offen offset:3584 sc1
v_mfma_f32_16x16x32_bf16 v[88:91], v[76:79], v[76:79], v[88:91]
v_mfma_f32_32x32x4_2b_bf16 v[32:63], v[14:15], v[14:15], 0
s_nop 0
v_max3_f32 v4, v80, v81, v82
s_nop 1
v_max3_f32 v4, v4, v83, v84
v_max3_f32 v4, v4, v85, v86
v_max_f32 v4, v4, v87
v_max3_f32 v90, v4, v88, v89
v_max3_f32 v4, v4, v88, v89
s_nop 1
v_permlane16_swap_b32 v4, v90
v_max_f32 v4, v4, v90
v_max_f32 v90, v4, v90
s_nop 1
v_permlane32_swap_b32 v4, v90
v_max_f32 v4, v4, v90
v_mul_f32 v4, s34, v4
v_pk_fma_f32 v[80:81], v[80:81], s[34:35], v[4:5] op_sel_hi:[1,0,0] neg_lo:[0,0,1] neg_hi:[0,0,1]
v_pk_fma_f32 v[82:83], v[82:83], s[34:35], v[4:5] op_sel_hi:[1,0,0] neg_lo:[0,0,1] neg_hi:[0,0,1]
v_pk_fma_f32 v[84:85], v[84:85], s[34:35], v[4:5] op_sel_hi:[1,0,0] neg_lo:[0,0,1] neg_hi:[0,0,1]
v_pk_fma_f32 v[86:87], v[86:87], s[34:35], v[4:5] op_sel_hi:[1,0,0] neg_lo:[0,0,1] neg_hi:[0,0,1]
v_pk_fma_f32 v[88:89], v[88:89], s[34:35], v[4:5] op_sel_hi:[1,0,0] neg_lo:[0,0,1] neg_hi:[0,0,1]
v_exp_f32 v80, v80
v_exp_f32 v81, v81
v_exp_f32 v82, v82
v_cvt_pk_bf16_f32 v68, v80, v81
v_exp_f32 v83, v83
v_exp_f32 v84, v84
v_cvt_pk_bf16_f32 v69, v82, v83
v_exp_f32 v85, v85
v_exp_f32 v86, v86
v_cvt_pk_bf16_f32 v70, v84, v85
v_exp_f32 v87, v87
v_exp_f32 v88, v88
v_cvt_pk_bf16_f32 v71, v86, v87
v_exp_f32 v89, v89
s_waitcnt vmcnt(3)
v_mfma_f32_16x16x32_bf16 v[76:79], v[28:31], v[68:71], 0
v_and_b32 v3, 1, v116
v_cvt_pk_bf16_f32 v72, v88, v89
v_mfma_f32_16x16x32_bf16 v[100:103], v[120:123], v[68:71], 0
v_cmp_ne_u32 vcc, s41, v3
v_cvt_pk_bf16_f32 v73, v88, v89
v_mfma_f32_16x16x32_bf16 v[104:107], v[124:127], v[68:71], 0
v_mov_b32 v113, v116
v_mov_b32 v115, v117
v_mfma_f32_16x16x16_bf16 v[76:79], v[92:93], v[72:73], v[76:79]
s_cbranch_vccnz L_rf_w3_pv0
L_rf_w3_pv2:
v_mfma_f32_16x16x16_bf16 v[100:103], v[112:113], v[72:73], v[100:103]
v_mfma_f32_16x16x16_bf16 v[104:107], v[114:115], v[72:73], v[104:107]
buffer_load_dwordx4 v[120:123], v1, s[4:7], s44 offen
buffer_load_dwordx4 v[124:127], v1, s[4:7], s44 offen offset:1024
s_nop 2
v_rcp_f32 v76, v76
s_mov_b64 exec, s[28:29]
v_pk_mul_f32 v[100:101], v[100:101], v[76:77] op_sel_hi:[1,0]
v_pk_mul_f32 v[102:103], v[102:103], v[76:77] op_sel_hi:[1,0]
v_pk_mul_f32 v[104:105], v[104:105], v[76:77] op_sel_hi:[1,0]
v_pk_mul_f32 v[106:107], v[106:107], v[76:77] op_sel_hi:[1,0]
v_cvt_pk_bf16_f32 v84, v100, v101
v_cvt_pk_bf16_f32 v85, v102, v103
v_cvt_pk_bf16_f32 v86, v104, v105
v_cvt_pk_bf16_f32 v87, v106, v107
ds_write_b128 v6, v[84:87] offset:29696
s_mov_b64 exec, -1
s_waitcnt lgkmcnt(0)
s_barrier
ds_read_b128 v[68:71], v6 offset:28672
ds_read_b128 v[72:75], v6 offset:29696
s_waitcnt lgkmcnt(1)
v_smfmac_f32_16x16x64_bf16 v[32:35], v[68:71], v[128:135], v2
s_add_u32 s21, s21, 1
s_xor_b32 s38, s38, 1048576
s_xor_b32 s37, s37, 1048576
s_waitcnt lgkmcnt(0)
v_smfmac_f32_16x16x64_bf16 v[32:35], v[72:75], v[136:143], v2
s_xor_b32 s40, s40, 1048576
s_xor_b32 s39, s39, 1048576
s_lshr_b32 s41, s21, 1
v_smfmac_f32_16x16x64_bf16 v[36:39], v[68:71], v[144:151], v2
s_and_b32 s41, s41, 1
s_xor_b32 s41, s41, 1
s_xor_b32 s35, s35, 16384
v_smfmac_f32_16x16x64_bf16 v[36:39], v[72:75], v[152:159], v2
v_add_f32 v32, v32, v34
s_xor_b32 s36, s36, 16384
s_add_u32 s43, s43, 262144
s_add_u32 s44, s44, 262144
v_smfmac_f32_16x16x64_bf16 v[40:43], v[68:71], v[160:167], v2
v_add_f32 v33, v33, v35
v_smfmac_f32_16x16x64_bf16 v[40:43], v[72:75], v[168:175], v2
v_cvt_pk_bf16_f32 v32, v32, v33
v_smfmac_f32_16x16x64_bf16 v[44:47], v[68:71], v[176:183], v2
v_and_or_b32 v32, v32, -2, s42
v_smfmac_f32_16x16x64_bf16 v[44:47], v[72:75], v[184:191], v2
v_add_f32 v36, v36, v38
v_smfmac_f32_16x16x64_bf16 v[48:51], v[68:71], v[192:199], v2
v_add_f32 v37, v37, v39
v_smfmac_f32_16x16x64_bf16 v[48:51], v[72:75], v[200:207], v2
v_cvt_pk_bf16_f32 v33, v36, v37
v_smfmac_f32_16x16x64_bf16 v[52:55], v[68:71], v[208:215], v2
v_add_f32 v40, v40, v42
v_smfmac_f32_16x16x64_bf16 v[52:55], v[72:75], v[216:223], v2
v_add_f32 v41, v41, v43
v_smfmac_f32_16x16x64_bf16 v[56:59], v[68:71], v[224:231], v2
v_cvt_pk_bf16_f32 v34, v40, v41
v_smfmac_f32_16x16x64_bf16 v[56:59], v[72:75], v[232:239], v2
v_add_f32 v44, v44, v46
v_smfmac_f32_16x16x64_bf16 v[60:63], v[68:71], v[240:247], v2
v_add_f32 v45, v45, v47
v_smfmac_f32_16x16x64_bf16 v[60:63], v[72:75], v[248:255], v2
v_cvt_pk_bf16_f32 v35, v44, v45
buffer_store_dwordx4 v[32:35], v8, s[4:7], s46 offen
v_pk_add_f32 v[48:49], v[48:49], v[50:51]
v_cvt_pk_bf16_f32 v48, v48, v49
v_and_or_b32 v48, v48, -2, s42
v_pk_add_f32 v[52:53], v[52:53], v[54:55]
v_cvt_pk_bf16_f32 v49, v52, v53
v_pk_add_f32 v[56:57], v[56:57], v[58:59]
v_cvt_pk_bf16_f32 v50, v56, v57
v_pk_add_f32 v[60:61], v[60:61], v[62:63]
v_cvt_pk_bf16_f32 v51, v60, v61
buffer_store_dwordx4 v[48:51], v8, s[4:7], s61 offen
s_add_u32 s45, s45, 262144
s_add_u32 s51, s51, 262144
v_mfma_f32_32x32x8_bf16 v[96:111], v[14:15], v[14:15], 0
v_mfma_f32_16x16x16_bf16 v[112:115], v[14:15], v[14:15], 0
v_mfma_f32_16x16x16_bf16 v[116:119], v[14:15], v[14:15], 0
ds_read_b128 v[64:67], v1 offset:12288
ds_read_b128 v[68:71], v1 offset:13312
ds_read_b128 v[72:75], v1 offset:14336
ds_read_b128 v[76:79], v1 offset:15360
ds_read_b128 v[80:83], v1 offset:28672
ds_read_b128 v[84:87], v1 offset:29696
ds_read_b128 v[88:91], v1 offset:30720
ds_read_b128 v[92:95], v1 offset:31744
s_add_u32 s22, s21, 2
s_cmp_gt_u32 s50, s22
s_cbranch_scc1 L_rf_w3_kvs
v_readlane_b32 s50, v12, 0
v_readlane_b32 s22, v12, 2
v_readlane_b32 s23, v12, 1
v_readlane_b32 s24, v12, 3
s_nop 3
s_min_u32 s50, s50, s22
s_min_u32 s23, s23, s24
s_lshl_b32 s50, s50, 1
s_lshl_b32 s23, s23, 1
s_add_u32 s23, s23, 1
s_min_u32 s50, s50, s23
L_rf_kvb1:
s_add_u32 s22, s21, 1
s_min_u32 s22, s22, 63
s_cmp_gt_u32 s50, s22
s_cbranch_scc1 L_rf_kvd1
buffer_load_dword v12, v7, s[4:7], 0 offen sc1
s_waitcnt vmcnt(0)
v_readlane_b32 s50, v12, 0
v_readlane_b32 s22, v12, 2
v_readlane_b32 s23, v12, 1
v_readlane_b32 s24, v12, 3
s_nop 3
s_min_u32 s50, s50, s22
s_min_u32 s23, s23, s24
s_lshl_b32 s50, s50, 1
s_lshl_b32 s23, s23, 1
s_add_u32 s23, s23, 1
s_min_u32 s50, s50, s23
s_branch L_rf_kvb1
L_rf_kvd1:
L_rf_w3_kvs:
v_mov_b32 v58, -1
v_mov_b32 v59, -1
s_waitcnt vmcnt(0)
L_rf_w3_cgo:
L_rf_w3_pc:
buffer_load_dword v36, v13, s[4:7], s25 offen sc1
buffer_load_dword v37, v13, s[4:7], s25 offen offset:256 sc1
buffer_load_dword v38, v13, s[4:7], s25 offen offset:512 sc1
buffer_load_dword v39, v13, s[4:7], s25 offen offset:768 sc1
buffer_load_dword v40, v13, s[4:7], s25 offen offset:1024 sc1
buffer_load_dword v41, v13, s[4:7], s25 offen offset:1280 sc1
buffer_load_dword v42, v13, s[4:7], s25 offen offset:1536 sc1
buffer_load_dword v43, v13, s[4:7], s25 offen offset:1792 sc1
s_waitcnt vmcnt(4)
v_mfma_f32_16x16x32_bf16 v[52:55], v[36:39], v[24:27], 0
v_bitop3_b32 v3, s42, v36, v37 bitop3:0x7e
v_bitop3_b32 v4, s42, v38, v39 bitop3:0x7e
s_waitcnt vmcnt(2)
v_or_b32 v3, v3, v4
v_bitop3_b32 v4, s42, v40, v41 bitop3:0x7e
s_waitcnt vmcnt(0)
v_mfma_f32_16x16x32_bf16 v[52:55], v[40:43], v[24:27], v[52:55]
v_bitop3_b32 v56, s42, v42, v43 bitop3:0x7e
v_or3_b32 v3, v3, v4, v56
v_and_b32 v3, v0, v3
v_cmp_ne_u32 vcc, 0, v3
s_nop 3
v_cvt_pk_bf16_f32 v56, v52, v53
v_cvt_pk_bf16_f32 v57, v54, v55
v_min_u32 v56, -2, v56
s_cbranch_vccnz L_rf_w3_pc
s_mov_b64 exec, s[26:27]
buffer_store_dwordx2 v[56:57], v9, s[4:7], s35 offen offset:768
buffer_store_dwordx2 v[58:59], v9, s[4:7], s36 offen offset:768
s_mov_b64 exec, -1
s_xor_b32 s42, s42, 1
s_branch L_rf_w3_loop
L_rf_w3_last:
buffer_store_dwordx4 v[64:67], v10, s[4:7], s45 offen offset:192 sc1
buffer_store_dwordx2 v[18:19], v11, s[4:7], s51 offen offset:3584 sc1
s_branch L_rf_end
L_rf_w3_pafail:
s_nop 7
v_mov_b32 v96, 0
v_mov_b32 v97, 0
v_mov_b32 v98, 0
v_mov_b32 v99, 0
v_mov_b32 v100, 0
v_mov_b32 v101, 0
v_mov_b32 v102, 0
v_mov_b32 v103, 0
v_mov_b32 v104, 0
v_mov_b32 v105, 0
v_mov_b32 v106, 0
v_mov_b32 v107, 0
s_branch L_rf_w3_pa
L_rf_w3_xslow:
buffer_load_dwordx2 v[108:109], v11, s[4:7], s38 offen sc1
buffer_load_dwordx2 v[110:111], v11, s[4:7], s38 offen offset:512 sc1
s_waitcnt vmcnt(2)
v_bitop3_b32 v3, s41, v20, v22 bitop3:0x7e
v_mfma_f32_16x16x16_bf16 v[80:83], v[20:21], v[16:17], v[100:103]
v_and_b32 v3, 1, v3
v_mfma_f32_16x16x16_bf16 v[84:87], v[22:23], v[16:17], v[104:107]
v_cmp_ne_u32 vcc, 0, v3
s_cbranch_vccz L_rf_w3_xgot
buffer_load_dwordx2 v[20:21], v11, s[4:7], s38 offen sc1
buffer_load_dwordx2 v[22:23], v11, s[4:7], s38 offen offset:512 sc1
s_waitcnt vmcnt(2)
v_bitop3_b32 v3, s41, v108, v110 bitop3:0x7e
v_mfma_f32_16x16x16_bf16 v[80:83], v[108:109], v[16:17], v[100:103]
v_and_b32 v3, 1, v3
v_mfma_f32_16x16x16_bf16 v[84:87], v[110:111], v[16:17], v[104:107]
v_cmp_ne_u32 vcc, 0, v3
s_cbranch_vccz L_rf_w3_xgot
s_branch L_rf_w3_xslow
L_rf_w3_xgot:
s_nop 3
v_cvt_pk_bf16_f32 v64, v80, v81
v_cvt_pk_bf16_f32 v65, v82, v83
v_cvt_pk_bf16_f32 v66, v84, v85
v_cvt_pk_bf16_f32 v67, v86, v87
ds_write_b128 v6, v[64:67] offset:23552
s_branch L_rf_w3_xok
L_rf_w3_pv0:
s_waitcnt vmcnt(2)
s_branch L_rf_w3_pv1
L_rf_w3_pv:
buffer_load_dwordx2 v[20:21], v11, s[4:7], s40 offen sc1
s_waitcnt vmcnt(0)
L_rf_w3_pv1:
v_and_b32 v3, 1, v20
v_cmp_ne_u32 vcc, s41, v3
v_mov_b32 v113, v20
v_mov_b32 v115, v21
s_cbranch_vccnz L_rf_w3_pv
s_branch L_rf_w3_pv2
L_rf_end:
s_mov_b64 exec, -1
v_mov_b32 v3, 64
s_waitcnt vmcnt(0)
s_barrier
s_cmp_lg_u32 s20, 0
s_cbranch_scc1 L_rf_end2
buffer_store_dword v3, v7, s[4:7], 0 offen sc1
L_rf_end2:
s_waitcnt vmcnt(0)
s_endpgm
L_recs:
s_load_dwordx2 s[4:5], s[0:1], 96
s_load_dwordx2 s[12:13], s[0:1], 88
s_load_dwordx2 s[50:51], s[0:1], 16
s_load_dwordx2 s[52:53], s[0:1], 24
s_load_dwordx2 s[54:55], s[0:1], 32
s_load_dwordx2 s[56:57], s[0:1], 40
s_load_dwordx2 s[58:59], s[0:1], 8
v_lshrrev_b32 v3, 6, v0
v_and_b32 v40, 63, v0
v_readfirstlane_b32 s20, v3
v_lshrrev_b32 v41, 4, v40
v_and_b32 v42, 15, v40
v_lshlrev_b32 v1, 4, v40
s_mov_b32 s49, 0
s_waitcnt lgkmcnt(0)
s_mov_b32 s6, 268435456
s_mov_b32 s7, 0x00020000
s_mov_b32 s14, 256
s_mov_b32 s15, 0x00020000
s_mov_b32 s10, 8388608
s_mov_b32 s11, 0x00020000
s_mov_b32 s26, 0x00030003
s_mov_b32 s27, 0x00030003
s_mov_b32 s28, 0xcccccccc
s_mov_b32 s29, 0xcccccccc
s_mov_b32 s32, 0x33333333
s_mov_b32 s33, 0x33333333
s_mov_b32 s34, 0x3e0293ee
s_lshl_b32 s22, s20, 2
v_xor_b32 v3, s22, v42
v_lshlrev_b32 v3, 4, v3
v_lshl_add_u32 v4, v41, 4, s20
v_lshl_add_u32 v44, v4, 13, v3
s_lshl_b32 s22, s30, 22
s_lshl_b32 s23, s31, 8
s_add_u32 s22, s22, s23
v_add_u32 v44, s22, v44
s_lshr_b32 s22, s20, 1
s_lshl_b32 s22, s22, 5
s_and_b32 s23, s20, 1
s_lshl_b32 s23, s23, 2
s_add_u32 s22, s22, s23
s_lshl_b32 s23, s31, 7
s_add_u32 s22, s22, s23
v_add_u32 v4, s22, v41
v_lshl_add_u32 v45, v4, 11, v3
s_lshl_b32 s22, s30, 10
v_add_u32 v45, s22, v45
s_lshl_b32 s48, s20, 10
s_mov_b32 s8, s50
s_mov_b32 s9, s51
s_add_u32 m0, s48, 0
s_mov_b32 s22, 0
buffer_load_dwordx4 v44, s[8:11], s22 offen  lds
s_add_u32 m0, s48, 4096
s_mov_b32 s22, 32768
buffer_load_dwordx4 v44, s[8:11], s22 offen  lds
s_add_u32 m0, s48, 8192
s_mov_b32 s22, 65536
buffer_load_dwordx4 v44, s[8:11], s22 offen  lds
s_add_u32 m0, s48, 12288
s_mov_b32 s22, 98304
buffer_load_dwordx4 v44, s[8:11], s22 offen  lds
s_add_u32 m0, s48, 16384
s_mov_b32 s22, 524288
buffer_load_dwordx4 v44, s[8:11], s22 offen  lds
s_add_u32 m0, s48, 20480
s_mov_b32 s22, 557056
buffer_load_dwordx4 v44, s[8:11], s22 offen  lds
s_add_u32 m0, s48, 24576
s_mov_b32 s22, 589824
buffer_load_dwordx4 v44, s[8:11], s22 offen  lds
s_add_u32 m0, s48, 28672
s_mov_b32 s22, 622592
buffer_load_dwordx4 v44, s[8:11], s22 offen  lds
s_add_u32 m0, s48, 32768
s_mov_b32 s22, 1048576
buffer_load_dwordx4 v44, s[8:11], s22 offen  lds
s_add_u32 m0, s48, 36864
s_mov_b32 s22, 1081344
buffer_load_dwordx4 v44, s[8:11], s22 offen  lds
s_add_u32 m0, s48, 40960
s_mov_b32 s22, 1114112
buffer_load_dwordx4 v44, s[8:11], s22 offen  lds
s_add_u32 m0, s48, 45056
s_mov_b32 s22, 1146880
buffer_load_dwordx4 v44, s[8:11], s22 offen  lds
s_add_u32 m0, s48, 49152
s_mov_b32 s22, 1572864
buffer_load_dwordx4 v44, s[8:11], s22 offen  lds
s_add_u32 m0, s48, 53248
s_mov_b32 s22, 1605632
buffer_load_dwordx4 v44, s[8:11], s22 offen  lds
s_add_u32 m0, s48, 57344
s_mov_b32 s22, 1638400
buffer_load_dwordx4 v44, s[8:11], s22 offen  lds
s_add_u32 m0, s48, 61440
s_mov_b32 s22, 1671168
buffer_load_dwordx4 v44, s[8:11], s22 offen  lds
s_add_u32 m0, s48, 65536
s_mov_b32 s22, 2097152
buffer_load_dwordx4 v44, s[8:11], s22 offen  lds
s_add_u32 m0, s48, 69632
s_mov_b32 s22, 2129920
buffer_load_dwordx4 v44, s[8:11], s22 offen  lds
s_add_u32 m0, s48, 73728
s_mov_b32 s22, 2162688
buffer_load_dwordx4 v44, s[8:11], s22 offen  lds
s_add_u32 m0, s48, 77824
s_mov_b32 s22, 2195456
buffer_load_dwordx4 v44, s[8:11], s22 offen  lds
s_add_u32 m0, s48, 81920
s_mov_b32 s22, 2621440
buffer_load_dwordx4 v44, s[8:11], s22 offen  lds
s_add_u32 m0, s48, 86016
s_mov_b32 s22, 2654208
buffer_load_dwordx4 v44, s[8:11], s22 offen  lds
s_add_u32 m0, s48, 90112
s_mov_b32 s22, 2686976
buffer_load_dwordx4 v44, s[8:11], s22 offen  lds
s_add_u32 m0, s48, 94208
s_mov_b32 s22, 2719744
buffer_load_dwordx4 v44, s[8:11], s22 offen  lds
s_add_u32 m0, s48, 98304
s_mov_b32 s22, 3145728
buffer_load_dwordx4 v44, s[8:11], s22 offen  lds
s_add_u32 m0, s48, 102400
s_mov_b32 s22, 3178496
buffer_load_dwordx4 v44, s[8:11], s22 offen  lds
s_add_u32 m0, s48, 106496
s_mov_b32 s22, 3211264
buffer_load_dwordx4 v44, s[8:11], s22 offen  lds
s_add_u32 m0, s48, 110592
s_mov_b32 s22, 3244032
buffer_load_dwordx4 v44, s[8:11], s22 offen  lds
s_add_u32 m0, s48, 114688
s_mov_b32 s22, 3670016
buffer_load_dwordx4 v44, s[8:11], s22 offen  lds
s_add_u32 m0, s48, 118784
s_mov_b32 s22, 3702784
buffer_load_dwordx4 v44, s[8:11], s22 offen  lds
s_add_u32 m0, s48, 122880
s_mov_b32 s22, 3735552
buffer_load_dwordx4 v44, s[8:11], s22 offen  lds
s_add_u32 m0, s48, 126976
s_mov_b32 s22, 3768320
buffer_load_dwordx4 v44, s[8:11], s22 offen  lds
s_lshl_b32 s22, s30, 5
s_add_u32 s22, s22, s31
s_lshl_b32 s38, s22, 14
s_xor_b32 s22, s22, 32
s_lshl_b32 s37, s22, 14
s_add_u32 s38, s38, 67108864
s_add_u32 s37, s37, 67108864
s_lshl_b32 s46, s30, 19
s_add_u32 s46, s46, 70254592
s_mul_i32 s22, s31, 8448
s_add_u32 s47, s46, s22
s_mul_i32 s22, s20, 67584
s_add_u32 s46, s46, s22
s_lshl_b32 s22, s31, 6
s_add_u32 s46, s46, s22
s_add_u32 s61, s46, 33792
s_mul_i32 s22, s20, 2048
s_add_u32 s25, s47, s22
s_lshl_b32 s35, s30, 13
s_add_u32 s35, s35, 69206016
v_lshrrev_b32 v53, 2, v42
v_lshlrev_b32 v53, 1, v53
v_and_b32 v54, 1, v42
v_add_u32 v55, v53, v54
v_mov_b32 v14, 0
v_mov_b32 v15, 0
v_mov_b32 v2, 0x4444
v_mov_b32 v3, 0xeeee
v_cndmask_b32 v2, v2, v3, s[28:29]
s_lshl_b32 s22, s20, 12
v_add_u32 v32, s22, v1
v_add_u32 v33, 0x10000, v32
v_add_u32 v5, 0x10000, v1
v_add_u32 v6, 131072, v1
v_and_b32 v3, 3, v42
v_bfe_u32 v43, v40, 1, 1
v_lshlrev_b32 v7, 13, v43
v_and_b32 v43, 1, v40
v_lshl_add_u32 v7, v43, 7, v7
s_lshl_b32 s22, s31, 8
s_add_u32 s23, s22, 71311360
v_add_u32 v7, s23, v7
s_cmp_lg_u32 s20, 0
s_cbranch_scc1 L_rs_flk
s_lshl_b32 s23, s30, 7
s_add_u32 s22, s22, s23
s_add_u32 s22, s22, 71327744
v_bfrev_b32 v7, 1
v_writelane_b32 v7, s22, 0
L_rs_flk:
v_lshlrev_b32 v11, 3, v40
v_lshlrev_b32 v10, 8, v55
v_lshl_add_u32 v10, v41, 4, v10
v_mul_u32_u24 v8, 8448, v41
v_lshl_add_u32 v8, v3, 4, v8
v_lshrrev_b32 v4, 2, v42
v_mul_u32_u24 v4, 2048, v4
v_add_u32 v8, v4, v8
v_lshrrev_b32 v9, 1, v41
v_lshlrev_b32 v9, 5, v9
v_and_b32 v4, 1, v42
v_lshl_add_u32 v9, v4, 4, v9
v_and_b32 v4, 1, v41
v_lshl_add_u32 v9, v4, 3, v9
s_lshr_b32 s22, s31, 2
s_lshl_b32 s22, s22, 10
s_and_b32 s23, s31, 3
s_lshl_b32 s23, s23, 6
s_add_u32 s22, s22, s23
v_add_u32 v9, s22, v9
v_lshrrev_b32 v4, 2, v42
v_lshlrev_b32 v12, 8, v4
v_lshl_add_u32 v12, v41, 6, v12
v_lshl_add_u32 v12, v3, 4, v12
v_lshlrev_b32 v13, 6, v41
v_lshl_add_u32 v13, v42, 2, v13
v_cmp_eq_u32 vcc, 0, v3
v_mov_b32 v28, 0x3f803f80
v_mov_b32 v29, 0x3f803f80
v_cndmask_b32 v34, 0, 1, vcc
v_mov_b32 v30, 0x3f803f80
v_mov_b32 v31, 0x3f803f80
v_and_b32 v49, 1, v42
v_lshlrev_b32 v49, 4, v49
v_mov_b32 v50, 0x3f80
v_lshlrev_b32 v50, v49, v50
v_lshrrev_b32 v51, 2, v42
v_cmp_eq_u32 vcc, v51, v41
v_mov_b32 v24, v50
v_cndmask_b32 v52, 0, v50, s[28:29]
v_cndmask_b32 v53, 0, v50, s[32:33]
v_cndmask_b32 v16, 0, v52, vcc
v_cndmask_b32 v17, 0, v53, vcc
v_mov_b32 v25, v50
v_mov_b32 v26, v50
v_mov_b32 v27, v50
v_bfe_u32 v60, v40, 3, 1
v_bfe_u32 v49, v40, 2, 1
v_and_b32 v50, 1, v41
v_lshrrev_b32 v51, 1, v41
v_lshlrev_b32 v52, 3, v60
v_lshl_add_u32 v52, v50, 2, v52
v_lshl_add_u32 v53, v51, 4, v52
v_add_u32 v53, v53, v49
v_and_b32 v54, 3, v40
s_lshl_b32 s22, s20, 2
v_add_u32 v55, s22, v54
v_xor_b32 v55, v55, v52
v_lshlrev_b32 v55, 4, v55
v_lshl_add_u32 v46, v53, 8, v55
v_lshlrev_b32 v55, 4, v52
v_lshl_add_u32 v55, v54, 3, v55
v_lshl_add_u32 v47, v53, 8, v55
s_waitcnt vmcnt(28)
s_barrier
v_add_u32 v48, 0, v46
ds_read_b64_tr_b16 a[0:1], v48
ds_read_b64_tr_b16 a[2:3], v48 offset:512
ds_read_b64_tr_b16 a[4:5], v48 offset:8192
ds_read_b64_tr_b16 a[6:7], v48 offset:8704
ds_read_b64_tr_b16 a[8:9], v48 offset:8
ds_read_b64_tr_b16 a[10:11], v48 offset:520
ds_read_b64_tr_b16 a[12:13], v48 offset:8200
ds_read_b64_tr_b16 a[14:15], v48 offset:8712
s_waitcnt lgkmcnt(0)
s_barrier
s_mov_b32 s8, s52
s_mov_b32 s9, s53
s_add_u32 m0, s48, 0
s_mov_b32 s22, 0
buffer_load_dwordx4 v44, s[8:11], s22 offen  lds
s_add_u32 m0, s48, 4096
s_mov_b32 s22, 32768
buffer_load_dwordx4 v44, s[8:11], s22 offen  lds
s_add_u32 m0, s48, 8192
s_mov_b32 s22, 65536
buffer_load_dwordx4 v44, s[8:11], s22 offen  lds
s_add_u32 m0, s48, 12288
s_mov_b32 s22, 98304
buffer_load_dwordx4 v44, s[8:11], s22 offen  lds
s_waitcnt vmcnt(28)
s_barrier
v_add_u32 v48, 16384, v46
ds_read_b64_tr_b16 a[16:17], v48
ds_read_b64_tr_b16 a[18:19], v48 offset:512
ds_read_b64_tr_b16 a[20:21], v48 offset:8192
ds_read_b64_tr_b16 a[22:23], v48 offset:8704
ds_read_b64_tr_b16 a[24:25], v48 offset:8
ds_read_b64_tr_b16 a[26:27], v48 offset:520
ds_read_b64_tr_b16 a[28:29], v48 offset:8200
ds_read_b64_tr_b16 a[30:31], v48 offset:8712
s_waitcnt lgkmcnt(0)
s_barrier
s_add_u32 m0, s48, 16384
s_mov_b32 s22, 524288
buffer_load_dwordx4 v44, s[8:11], s22 offen  lds
s_add_u32 m0, s48, 20480
s_mov_b32 s22, 557056
buffer_load_dwordx4 v44, s[8:11], s22 offen  lds
s_add_u32 m0, s48, 24576
s_mov_b32 s22, 589824
buffer_load_dwordx4 v44, s[8:11], s22 offen  lds
s_add_u32 m0, s48, 28672
s_mov_b32 s22, 622592
buffer_load_dwordx4 v44, s[8:11], s22 offen  lds
s_waitcnt vmcnt(28)
s_barrier
v_add_u32 v48, 32768, v46
ds_read_b64_tr_b16 a[32:33], v48
ds_read_b64_tr_b16 a[34:35], v48 offset:512
ds_read_b64_tr_b16 a[36:37], v48 offset:8192
ds_read_b64_tr_b16 a[38:39], v48 offset:8704
ds_read_b64_tr_b16 a[40:41], v48 offset:8
ds_read_b64_tr_b16 a[42:43], v48 offset:520
ds_read_b64_tr_b16 a[44:45], v48 offset:8200
ds_read_b64_tr_b16 a[46:47], v48 offset:8712
s_waitcnt lgkmcnt(0)
s_barrier
s_add_u32 m0, s48, 32768
s_mov_b32 s22, 1048576
buffer_load_dwordx4 v44, s[8:11], s22 offen  lds
s_add_u32 m0, s48, 36864
s_mov_b32 s22, 1081344
buffer_load_dwordx4 v44, s[8:11], s22 offen  lds
s_add_u32 m0, s48, 40960
s_mov_b32 s22, 1114112
buffer_load_dwordx4 v44, s[8:11], s22 offen  lds
s_add_u32 m0, s48, 45056
s_mov_b32 s22, 1146880
buffer_load_dwordx4 v44, s[8:11], s22 offen  lds
s_waitcnt vmcnt(28)
s_barrier
v_add_u32 v48, 49152, v46
ds_read_b64_tr_b16 a[48:49], v48
ds_read_b64_tr_b16 a[50:51], v48 offset:512
ds_read_b64_tr_b16 a[52:53], v48 offset:8192
ds_read_b64_tr_b16 a[54:55], v48 offset:8704
ds_read_b64_tr_b16 a[56:57], v48 offset:8
ds_read_b64_tr_b16 a[58:59], v48 offset:520
ds_read_b64_tr_b16 a[60:61], v48 offset:8200
ds_read_b64_tr_b16 a[62:63], v48 offset:8712
s_waitcnt lgkmcnt(0)
s_barrier
s_add_u32 m0, s48, 49152
s_mov_b32 s22, 1572864
buffer_load_dwordx4 v44, s[8:11], s22 offen  lds
s_add_u32 m0, s48, 53248
s_mov_b32 s22, 1605632
buffer_load_dwordx4 v44, s[8:11], s22 offen  lds
s_add_u32 m0, s48, 57344
s_mov_b32 s22, 1638400
buffer_load_dwordx4 v44, s[8:11], s22 offen  lds
s_add_u32 m0, s48, 61440
s_mov_b32 s22, 1671168
buffer_load_dwordx4 v44, s[8:11], s22 offen  lds
s_waitcnt vmcnt(28)
s_barrier
v_add_u32 v48, 65536, v46
ds_read_b64_tr_b16 a[64:65], v48
ds_read_b64_tr_b16 a[66:67], v48 offset:512
ds_read_b64_tr_b16 a[68:69], v48 offset:8192
ds_read_b64_tr_b16 a[70:71], v48 offset:8704
ds_read_b64_tr_b16 a[72:73], v48 offset:8
ds_read_b64_tr_b16 a[74:75], v48 offset:520
ds_read_b64_tr_b16 a[76:77], v48 offset:8200
ds_read_b64_tr_b16 a[78:79], v48 offset:8712
s_waitcnt lgkmcnt(0)
s_barrier
s_add_u32 m0, s48, 65536
s_mov_b32 s22, 2097152
buffer_load_dwordx4 v44, s[8:11], s22 offen  lds
s_add_u32 m0, s48, 69632
s_mov_b32 s22, 2129920
buffer_load_dwordx4 v44, s[8:11], s22 offen  lds
s_add_u32 m0, s48, 73728
s_mov_b32 s22, 2162688
buffer_load_dwordx4 v44, s[8:11], s22 offen  lds
s_add_u32 m0, s48, 77824
s_mov_b32 s22, 2195456
buffer_load_dwordx4 v44, s[8:11], s22 offen  lds
s_waitcnt vmcnt(28)
s_barrier
v_add_u32 v48, 81920, v46
ds_read_b64_tr_b16 a[80:81], v48
ds_read_b64_tr_b16 a[82:83], v48 offset:512
ds_read_b64_tr_b16 a[84:85], v48 offset:8192
ds_read_b64_tr_b16 a[86:87], v48 offset:8704
ds_read_b64_tr_b16 a[88:89], v48 offset:8
ds_read_b64_tr_b16 a[90:91], v48 offset:520
ds_read_b64_tr_b16 a[92:93], v48 offset:8200
ds_read_b64_tr_b16 a[94:95], v48 offset:8712
s_waitcnt lgkmcnt(0)
s_barrier
s_add_u32 m0, s48, 81920
s_mov_b32 s22, 2621440
buffer_load_dwordx4 v44, s[8:11], s22 offen  lds
s_add_u32 m0, s48, 86016
s_mov_b32 s22, 2654208
buffer_load_dwordx4 v44, s[8:11], s22 offen  lds
s_add_u32 m0, s48, 90112
s_mov_b32 s22, 2686976
buffer_load_dwordx4 v44, s[8:11], s22 offen  lds
s_add_u32 m0, s48, 94208
s_mov_b32 s22, 2719744
buffer_load_dwordx4 v44, s[8:11], s22 offen  lds
s_waitcnt vmcnt(28)
s_barrier
v_add_u32 v48, 98304, v46
ds_read_b64_tr_b16 a[96:97], v48
ds_read_b64_tr_b16 a[98:99], v48 offset:512
ds_read_b64_tr_b16 a[100:101], v48 offset:8192
ds_read_b64_tr_b16 a[102:103], v48 offset:8704
ds_read_b64_tr_b16 a[104:105], v48 offset:8
ds_read_b64_tr_b16 a[106:107], v48 offset:520
ds_read_b64_tr_b16 a[108:109], v48 offset:8200
ds_read_b64_tr_b16 a[110:111], v48 offset:8712
s_waitcnt lgkmcnt(0)
s_barrier
s_add_u32 m0, s48, 98304
s_mov_b32 s22, 3145728
buffer_load_dwordx4 v44, s[8:11], s22 offen  lds
s_add_u32 m0, s48, 102400
s_mov_b32 s22, 3178496
buffer_load_dwordx4 v44, s[8:11], s22 offen  lds
s_add_u32 m0, s48, 106496
s_mov_b32 s22, 3211264
buffer_load_dwordx4 v44, s[8:11], s22 offen  lds
s_add_u32 m0, s48, 110592
s_mov_b32 s22, 3244032
buffer_load_dwordx4 v44, s[8:11], s22 offen  lds
s_waitcnt vmcnt(28)
s_barrier
v_add_u32 v48, 114688, v46
ds_read_b64_tr_b16 a[112:113], v48
ds_read_b64_tr_b16 a[114:115], v48 offset:512
ds_read_b64_tr_b16 a[116:117], v48 offset:8192
ds_read_b64_tr_b16 a[118:119], v48 offset:8704
ds_read_b64_tr_b16 a[120:121], v48 offset:8
ds_read_b64_tr_b16 a[122:123], v48 offset:520
ds_read_b64_tr_b16 a[124:125], v48 offset:8200
ds_read_b64_tr_b16 a[126:127], v48 offset:8712
s_waitcnt lgkmcnt(0)
s_barrier
s_add_u32 m0, s48, 114688
s_mov_b32 s22, 3670016
buffer_load_dwordx4 v44, s[8:11], s22 offen  lds
s_add_u32 m0, s48, 118784
s_mov_b32 s22, 3702784
buffer_load_dwordx4 v44, s[8:11], s22 offen  lds
s_add_u32 m0, s48, 122880
s_mov_b32 s22, 3735552
buffer_load_dwordx4 v44, s[8:11], s22 offen  lds
s_add_u32 m0, s48, 126976
s_mov_b32 s22, 3768320
buffer_load_dwordx4 v44, s[8:11], s22 offen  lds
s_waitcnt vmcnt(28)
s_barrier
v_add_u32 v48, 0, v46
ds_read_b64_tr_b16 a[128:129], v48
ds_read_b64_tr_b16 a[130:131], v48 offset:512
ds_read_b64_tr_b16 a[132:133], v48 offset:8192
ds_read_b64_tr_b16 a[134:135], v48 offset:8704
ds_read_b64_tr_b16 a[136:137], v48 offset:8
ds_read_b64_tr_b16 a[138:139], v48 offset:520
ds_read_b64_tr_b16 a[140:141], v48 offset:8200
ds_read_b64_tr_b16 a[142:143], v48 offset:8712
s_waitcnt lgkmcnt(0)
s_barrier
s_mov_b32 s8, s56
s_mov_b32 s9, s57
s_add_u32 m0, s48, 0
s_mov_b32 s22, 0
buffer_load_dwordx4 v45, s[8:11], s22 offen  lds
s_add_u32 m0, s48, 4096
s_mov_b32 s22, 16384
buffer_load_dwordx4 v45, s[8:11], s22 offen  lds
s_add_u32 m0, s48, 8192
s_mov_b32 s22, 32768
buffer_load_dwordx4 v45, s[8:11], s22 offen  lds
s_add_u32 m0, s48, 12288
s_mov_b32 s22, 49152
buffer_load_dwordx4 v45, s[8:11], s22 offen  lds
s_waitcnt vmcnt(28)
s_barrier
v_add_u32 v48, 16384, v46
ds_read_b64_tr_b16 a[144:145], v48
ds_read_b64_tr_b16 a[146:147], v48 offset:512
ds_read_b64_tr_b16 a[148:149], v48 offset:8192
ds_read_b64_tr_b16 a[150:151], v48 offset:8704
ds_read_b64_tr_b16 a[152:153], v48 offset:8
ds_read_b64_tr_b16 a[154:155], v48 offset:520
ds_read_b64_tr_b16 a[156:157], v48 offset:8200
ds_read_b64_tr_b16 a[158:159], v48 offset:8712
s_waitcnt lgkmcnt(0)
s_barrier
s_add_u32 m0, s48, 16384
s_mov_b32 s22, 256
buffer_load_dwordx4 v45, s[8:11], s22 offen  lds
s_add_u32 m0, s48, 20480
s_mov_b32 s22, 16640
buffer_load_dwordx4 v45, s[8:11], s22 offen  lds
s_add_u32 m0, s48, 24576
s_mov_b32 s22, 33024
buffer_load_dwordx4 v45, s[8:11], s22 offen  lds
s_add_u32 m0, s48, 28672
s_mov_b32 s22, 49408
buffer_load_dwordx4 v45, s[8:11], s22 offen  lds
s_waitcnt vmcnt(28)
s_barrier
v_add_u32 v48, 32768, v46
ds_read_b64_tr_b16 a[160:161], v48
ds_read_b64_tr_b16 a[162:163], v48 offset:512
ds_read_b64_tr_b16 a[164:165], v48 offset:8192
ds_read_b64_tr_b16 a[166:167], v48 offset:8704
ds_read_b64_tr_b16 a[168:169], v48 offset:8
ds_read_b64_tr_b16 a[170:171], v48 offset:520
ds_read_b64_tr_b16 a[172:173], v48 offset:8200
ds_read_b64_tr_b16 a[174:175], v48 offset:8712
s_waitcnt lgkmcnt(0)
s_barrier
s_add_u32 m0, s48, 32768
s_mov_b32 s22, 512
buffer_load_dwordx4 v45, s[8:11], s22 offen  lds
s_add_u32 m0, s48, 36864
s_mov_b32 s22, 16896
buffer_load_dwordx4 v45, s[8:11], s22 offen  lds
s_add_u32 m0, s48, 40960
s_mov_b32 s22, 33280
buffer_load_dwordx4 v45, s[8:11], s22 offen  lds
s_add_u32 m0, s48, 45056
s_mov_b32 s22, 49664
buffer_load_dwordx4 v45, s[8:11], s22 offen  lds
s_waitcnt vmcnt(28)
s_barrier
v_add_u32 v48, 49152, v46
ds_read_b64_tr_b16 a[176:177], v48
ds_read_b64_tr_b16 a[178:179], v48 offset:512
ds_read_b64_tr_b16 a[180:181], v48 offset:8192
ds_read_b64_tr_b16 a[182:183], v48 offset:8704
ds_read_b64_tr_b16 a[184:185], v48 offset:8
ds_read_b64_tr_b16 a[186:187], v48 offset:520
ds_read_b64_tr_b16 a[188:189], v48 offset:8200
ds_read_b64_tr_b16 a[190:191], v48 offset:8712
s_waitcnt lgkmcnt(0)
s_barrier
s_add_u32 m0, s48, 49152
s_mov_b32 s22, 768
buffer_load_dwordx4 v45, s[8:11], s22 offen  lds
s_add_u32 m0, s48, 53248
s_mov_b32 s22, 17152
buffer_load_dwordx4 v45, s[8:11], s22 offen  lds
s_add_u32 m0, s48, 57344
s_mov_b32 s22, 33536
buffer_load_dwordx4 v45, s[8:11], s22 offen  lds
s_add_u32 m0, s48, 61440
s_mov_b32 s22, 49920
buffer_load_dwordx4 v45, s[8:11], s22 offen  lds
s_waitcnt vmcnt(28)
s_barrier
v_add_u32 v48, 65536, v46
ds_read_b64_tr_b16 a[192:193], v48
ds_read_b64_tr_b16 a[194:195], v48 offset:512
ds_read_b64_tr_b16 a[196:197], v48 offset:8192
ds_read_b64_tr_b16 a[198:199], v48 offset:8704
ds_read_b64_tr_b16 a[200:201], v48 offset:8
ds_read_b64_tr_b16 a[202:203], v48 offset:520
ds_read_b64_tr_b16 a[204:205], v48 offset:8200
ds_read_b64_tr_b16 a[206:207], v48 offset:8712
s_waitcnt lgkmcnt(0)
s_barrier
s_add_u32 m0, s48, 65536
s_mov_b32 s22, 131072
buffer_load_dwordx4 v45, s[8:11], s22 offen  lds
s_add_u32 m0, s48, 69632
s_mov_b32 s22, 147456
buffer_load_dwordx4 v45, s[8:11], s22 offen  lds
s_add_u32 m0, s48, 73728
s_mov_b32 s22, 163840
buffer_load_dwordx4 v45, s[8:11], s22 offen  lds
s_add_u32 m0, s48, 77824
s_mov_b32 s22, 180224
buffer_load_dwordx4 v45, s[8:11], s22 offen  lds
s_waitcnt vmcnt(28)
s_barrier
v_add_u32 v48, 81920, v46
ds_read_b64_tr_b16 a[208:209], v48
ds_read_b64_tr_b16 a[210:211], v48 offset:512
ds_read_b64_tr_b16 a[212:213], v48 offset:8192
ds_read_b64_tr_b16 a[214:215], v48 offset:8704
ds_read_b64_tr_b16 a[216:217], v48 offset:8
ds_read_b64_tr_b16 a[218:219], v48 offset:520
ds_read_b64_tr_b16 a[220:221], v48 offset:8200
ds_read_b64_tr_b16 a[222:223], v48 offset:8712
s_waitcnt lgkmcnt(0)
s_barrier
s_add_u32 m0, s48, 81920
s_mov_b32 s22, 131328
buffer_load_dwordx4 v45, s[8:11], s22 offen  lds
s_add_u32 m0, s48, 86016
s_mov_b32 s22, 147712
buffer_load_dwordx4 v45, s[8:11], s22 offen  lds
s_add_u32 m0, s48, 90112
s_mov_b32 s22, 164096
buffer_load_dwordx4 v45, s[8:11], s22 offen  lds
s_add_u32 m0, s48, 94208
s_mov_b32 s22, 180480
buffer_load_dwordx4 v45, s[8:11], s22 offen  lds
s_waitcnt vmcnt(28)
s_barrier
v_add_u32 v48, 98304, v46
ds_read_b64_tr_b16 a[224:225], v48
ds_read_b64_tr_b16 a[226:227], v48 offset:512
ds_read_b64_tr_b16 a[228:229], v48 offset:8192
ds_read_b64_tr_b16 a[230:231], v48 offset:8704
ds_read_b64_tr_b16 a[232:233], v48 offset:8
ds_read_b64_tr_b16 a[234:235], v48 offset:520
ds_read_b64_tr_b16 a[236:237], v48 offset:8200
ds_read_b64_tr_b16 a[238:239], v48 offset:8712
s_waitcnt lgkmcnt(0)
s_barrier
s_add_u32 m0, s48, 98304
s_mov_b32 s22, 131584
buffer_load_dwordx4 v45, s[8:11], s22 offen  lds
s_add_u32 m0, s48, 102400
s_mov_b32 s22, 147968
buffer_load_dwordx4 v45, s[8:11], s22 offen  lds
s_add_u32 m0, s48, 106496
s_mov_b32 s22, 164352
buffer_load_dwordx4 v45, s[8:11], s22 offen  lds
s_add_u32 m0, s48, 110592
s_mov_b32 s22, 180736
buffer_load_dwordx4 v45, s[8:11], s22 offen  lds
s_waitcnt vmcnt(28)
s_barrier
v_add_u32 v48, 114688, v46
ds_read_b64_tr_b16 a[240:241], v48
ds_read_b64_tr_b16 a[242:243], v48 offset:512
ds_read_b64_tr_b16 a[244:245], v48 offset:8192
ds_read_b64_tr_b16 a[246:247], v48 offset:8704
ds_read_b64_tr_b16 a[248:249], v48 offset:8
ds_read_b64_tr_b16 a[250:251], v48 offset:520
ds_read_b64_tr_b16 a[252:253], v48 offset:8200
ds_read_b64_tr_b16 a[254:255], v48 offset:8712
s_waitcnt lgkmcnt(0)
s_barrier
s_add_u32 m0, s48, 114688
s_mov_b32 s22, 131840
buffer_load_dwordx4 v45, s[8:11], s22 offen  lds
s_add_u32 m0, s48, 118784
s_mov_b32 s22, 148224
buffer_load_dwordx4 v45, s[8:11], s22 offen  lds
s_add_u32 m0, s48, 122880
s_mov_b32 s22, 164608
buffer_load_dwordx4 v45, s[8:11], s22 offen  lds
s_add_u32 m0, s48, 126976
s_mov_b32 s22, 180992
buffer_load_dwordx4 v45, s[8:11], s22 offen  lds
s_waitcnt vmcnt(28)
s_barrier
s_cmp_lg_u32 s20, 0
s_cbranch_scc1 L_rs_wo0
v_xor_b32 v48, 0, v47
v_add_u32 v48, 0, v48
ds_read_b64_tr_b16 v[128:129], v48
ds_read_b64_tr_b16 v[130:131], v48 offset:512
ds_read_b64_tr_b16 v[132:133], v48 offset:8192
ds_read_b64_tr_b16 v[134:135], v48 offset:8704
ds_read_b64_tr_b16 v[144:145], v48 offset:32
ds_read_b64_tr_b16 v[146:147], v48 offset:544
ds_read_b64_tr_b16 v[148:149], v48 offset:8224
ds_read_b64_tr_b16 v[150:151], v48 offset:8736
s_waitcnt lgkmcnt(0)
v_xor_b32 v48, 64, v47
v_add_u32 v48, 0, v48
ds_read_b64_tr_b16 v[160:161], v48
ds_read_b64_tr_b16 v[162:163], v48 offset:512
ds_read_b64_tr_b16 v[164:165], v48 offset:8192
ds_read_b64_tr_b16 v[166:167], v48 offset:8704
ds_read_b64_tr_b16 v[176:177], v48 offset:32
ds_read_b64_tr_b16 v[178:179], v48 offset:544
ds_read_b64_tr_b16 v[180:181], v48 offset:8224
ds_read_b64_tr_b16 v[182:183], v48 offset:8736
s_waitcnt lgkmcnt(0)
v_xor_b32 v48, 128, v47
v_add_u32 v48, 0, v48
ds_read_b64_tr_b16 v[192:193], v48
ds_read_b64_tr_b16 v[194:195], v48 offset:512
ds_read_b64_tr_b16 v[196:197], v48 offset:8192
ds_read_b64_tr_b16 v[198:199], v48 offset:8704
ds_read_b64_tr_b16 v[208:209], v48 offset:32
ds_read_b64_tr_b16 v[210:211], v48 offset:544
ds_read_b64_tr_b16 v[212:213], v48 offset:8224
ds_read_b64_tr_b16 v[214:215], v48 offset:8736
s_waitcnt lgkmcnt(0)
v_xor_b32 v48, 192, v47
v_add_u32 v48, 0, v48
ds_read_b64_tr_b16 v[224:225], v48
ds_read_b64_tr_b16 v[226:227], v48 offset:512
ds_read_b64_tr_b16 v[228:229], v48 offset:8192
ds_read_b64_tr_b16 v[230:231], v48 offset:8704
ds_read_b64_tr_b16 v[240:241], v48 offset:32
ds_read_b64_tr_b16 v[242:243], v48 offset:544
ds_read_b64_tr_b16 v[244:245], v48 offset:8224
ds_read_b64_tr_b16 v[246:247], v48 offset:8736
s_waitcnt lgkmcnt(0)
L_rs_wo0:
s_barrier
s_mov_b32 s8, s54
s_mov_b32 s9, s55
s_add_u32 m0, s48, 0
s_mov_b32 s22, 0
buffer_load_dwordx4 v44, s[8:11], s22 offen  lds
s_add_u32 m0, s48, 4096
s_mov_b32 s22, 32768
buffer_load_dwordx4 v44, s[8:11], s22 offen  lds
s_add_u32 m0, s48, 8192
s_mov_b32 s22, 65536
buffer_load_dwordx4 v44, s[8:11], s22 offen  lds
s_add_u32 m0, s48, 12288
s_mov_b32 s22, 98304
buffer_load_dwordx4 v44, s[8:11], s22 offen  lds
s_waitcnt vmcnt(28)
s_barrier
s_cmp_lg_u32 s20, 1
s_cbranch_scc1 L_rs_wo1
v_xor_b32 v48, 0, v47
v_add_u32 v48, 16384, v48
ds_read_b64_tr_b16 v[128:129], v48
ds_read_b64_tr_b16 v[130:131], v48 offset:512
ds_read_b64_tr_b16 v[132:133], v48 offset:8192
ds_read_b64_tr_b16 v[134:135], v48 offset:8704
ds_read_b64_tr_b16 v[144:145], v48 offset:32
ds_read_b64_tr_b16 v[146:147], v48 offset:544
ds_read_b64_tr_b16 v[148:149], v48 offset:8224
ds_read_b64_tr_b16 v[150:151], v48 offset:8736
s_waitcnt lgkmcnt(0)
v_xor_b32 v48, 64, v47
v_add_u32 v48, 16384, v48
ds_read_b64_tr_b16 v[160:161], v48
ds_read_b64_tr_b16 v[162:163], v48 offset:512
ds_read_b64_tr_b16 v[164:165], v48 offset:8192
ds_read_b64_tr_b16 v[166:167], v48 offset:8704
ds_read_b64_tr_b16 v[176:177], v48 offset:32
ds_read_b64_tr_b16 v[178:179], v48 offset:544
ds_read_b64_tr_b16 v[180:181], v48 offset:8224
ds_read_b64_tr_b16 v[182:183], v48 offset:8736
s_waitcnt lgkmcnt(0)
v_xor_b32 v48, 128, v47
v_add_u32 v48, 16384, v48
ds_read_b64_tr_b16 v[192:193], v48
ds_read_b64_tr_b16 v[194:195], v48 offset:512
ds_read_b64_tr_b16 v[196:197], v48 offset:8192
ds_read_b64_tr_b16 v[198:199], v48 offset:8704
ds_read_b64_tr_b16 v[208:209], v48 offset:32
ds_read_b64_tr_b16 v[210:211], v48 offset:544
ds_read_b64_tr_b16 v[212:213], v48 offset:8224
ds_read_b64_tr_b16 v[214:215], v48 offset:8736
s_waitcnt lgkmcnt(0)
v_xor_b32 v48, 192, v47
v_add_u32 v48, 16384, v48
ds_read_b64_tr_b16 v[224:225], v48
ds_read_b64_tr_b16 v[226:227], v48 offset:512
ds_read_b64_tr_b16 v[228:229], v48 offset:8192
ds_read_b64_tr_b16 v[230:231], v48 offset:8704
ds_read_b64_tr_b16 v[240:241], v48 offset:32
ds_read_b64_tr_b16 v[242:243], v48 offset:544
ds_read_b64_tr_b16 v[244:245], v48 offset:8224
ds_read_b64_tr_b16 v[246:247], v48 offset:8736
s_waitcnt lgkmcnt(0)
L_rs_wo1:
s_barrier
s_add_u32 m0, s48, 16384
s_mov_b32 s22, 524288
buffer_load_dwordx4 v44, s[8:11], s22 offen  lds
s_add_u32 m0, s48, 20480
s_mov_b32 s22, 557056
buffer_load_dwordx4 v44, s[8:11], s22 offen  lds
s_add_u32 m0, s48, 24576
s_mov_b32 s22, 589824
buffer_load_dwordx4 v44, s[8:11], s22 offen  lds
s_add_u32 m0, s48, 28672
s_mov_b32 s22, 622592
buffer_load_dwordx4 v44, s[8:11], s22 offen  lds
s_waitcnt vmcnt(28)
s_barrier
s_cmp_lg_u32 s20, 2
s_cbranch_scc1 L_rs_wo2
v_xor_b32 v48, 0, v47
v_add_u32 v48, 32768, v48
ds_read_b64_tr_b16 v[128:129], v48
ds_read_b64_tr_b16 v[130:131], v48 offset:512
ds_read_b64_tr_b16 v[132:133], v48 offset:8192
ds_read_b64_tr_b16 v[134:135], v48 offset:8704
ds_read_b64_tr_b16 v[144:145], v48 offset:32
ds_read_b64_tr_b16 v[146:147], v48 offset:544
ds_read_b64_tr_b16 v[148:149], v48 offset:8224
ds_read_b64_tr_b16 v[150:151], v48 offset:8736
s_waitcnt lgkmcnt(0)
v_xor_b32 v48, 64, v47
v_add_u32 v48, 32768, v48
ds_read_b64_tr_b16 v[160:161], v48
ds_read_b64_tr_b16 v[162:163], v48 offset:512
ds_read_b64_tr_b16 v[164:165], v48 offset:8192
ds_read_b64_tr_b16 v[166:167], v48 offset:8704
ds_read_b64_tr_b16 v[176:177], v48 offset:32
ds_read_b64_tr_b16 v[178:179], v48 offset:544
ds_read_b64_tr_b16 v[180:181], v48 offset:8224
ds_read_b64_tr_b16 v[182:183], v48 offset:8736
s_waitcnt lgkmcnt(0)
v_xor_b32 v48, 128, v47
v_add_u32 v48, 32768, v48
ds_read_b64_tr_b16 v[192:193], v48
ds_read_b64_tr_b16 v[194:195], v48 offset:512
ds_read_b64_tr_b16 v[196:197], v48 offset:8192
ds_read_b64_tr_b16 v[198:199], v48 offset:8704
ds_read_b64_tr_b16 v[208:209], v48 offset:32
ds_read_b64_tr_b16 v[210:211], v48 offset:544
ds_read_b64_tr_b16 v[212:213], v48 offset:8224
ds_read_b64_tr_b16 v[214:215], v48 offset:8736
s_waitcnt lgkmcnt(0)
v_xor_b32 v48, 192, v47
v_add_u32 v48, 32768, v48
ds_read_b64_tr_b16 v[224:225], v48
ds_read_b64_tr_b16 v[226:227], v48 offset:512
ds_read_b64_tr_b16 v[228:229], v48 offset:8192
ds_read_b64_tr_b16 v[230:231], v48 offset:8704
ds_read_b64_tr_b16 v[240:241], v48 offset:32
ds_read_b64_tr_b16 v[242:243], v48 offset:544
ds_read_b64_tr_b16 v[244:245], v48 offset:8224
ds_read_b64_tr_b16 v[246:247], v48 offset:8736
s_waitcnt lgkmcnt(0)
L_rs_wo2:
s_barrier
s_add_u32 m0, s48, 32768
s_mov_b32 s22, 1048576
buffer_load_dwordx4 v44, s[8:11], s22 offen  lds
s_add_u32 m0, s48, 36864
s_mov_b32 s22, 1081344
buffer_load_dwordx4 v44, s[8:11], s22 offen  lds
s_add_u32 m0, s48, 40960
s_mov_b32 s22, 1114112
buffer_load_dwordx4 v44, s[8:11], s22 offen  lds
s_add_u32 m0, s48, 45056
s_mov_b32 s22, 1146880
buffer_load_dwordx4 v44, s[8:11], s22 offen  lds
s_waitcnt vmcnt(28)
s_barrier
s_cmp_lg_u32 s20, 3
s_cbranch_scc1 L_rs_wo3
v_xor_b32 v48, 0, v47
v_add_u32 v48, 49152, v48
ds_read_b64_tr_b16 v[128:129], v48
ds_read_b64_tr_b16 v[130:131], v48 offset:512
ds_read_b64_tr_b16 v[132:133], v48 offset:8192
ds_read_b64_tr_b16 v[134:135], v48 offset:8704
ds_read_b64_tr_b16 v[144:145], v48 offset:32
ds_read_b64_tr_b16 v[146:147], v48 offset:544
ds_read_b64_tr_b16 v[148:149], v48 offset:8224
ds_read_b64_tr_b16 v[150:151], v48 offset:8736
s_waitcnt lgkmcnt(0)
v_xor_b32 v48, 64, v47
v_add_u32 v48, 49152, v48
ds_read_b64_tr_b16 v[160:161], v48
ds_read_b64_tr_b16 v[162:163], v48 offset:512
ds_read_b64_tr_b16 v[164:165], v48 offset:8192
ds_read_b64_tr_b16 v[166:167], v48 offset:8704
ds_read_b64_tr_b16 v[176:177], v48 offset:32
ds_read_b64_tr_b16 v[178:179], v48 offset:544
ds_read_b64_tr_b16 v[180:181], v48 offset:8224
ds_read_b64_tr_b16 v[182:183], v48 offset:8736
s_waitcnt lgkmcnt(0)
v_xor_b32 v48, 128, v47
v_add_u32 v48, 49152, v48
ds_read_b64_tr_b16 v[192:193], v48
ds_read_b64_tr_b16 v[194:195], v48 offset:512
ds_read_b64_tr_b16 v[196:197], v48 offset:8192
ds_read_b64_tr_b16 v[198:199], v48 offset:8704
ds_read_b64_tr_b16 v[208:209], v48 offset:32
ds_read_b64_tr_b16 v[210:211], v48 offset:544
ds_read_b64_tr_b16 v[212:213], v48 offset:8224
ds_read_b64_tr_b16 v[214:215], v48 offset:8736
s_waitcnt lgkmcnt(0)
v_xor_b32 v48, 192, v47
v_add_u32 v48, 49152, v48
ds_read_b64_tr_b16 v[224:225], v48
ds_read_b64_tr_b16 v[226:227], v48 offset:512
ds_read_b64_tr_b16 v[228:229], v48 offset:8192
ds_read_b64_tr_b16 v[230:231], v48 offset:8704
ds_read_b64_tr_b16 v[240:241], v48 offset:32
ds_read_b64_tr_b16 v[242:243], v48 offset:544
ds_read_b64_tr_b16 v[244:245], v48 offset:8224
ds_read_b64_tr_b16 v[246:247], v48 offset:8736
s_waitcnt lgkmcnt(0)
L_rs_wo3:
s_barrier
s_add_u32 m0, s48, 49152
s_mov_b32 s22, 1572864
buffer_load_dwordx4 v44, s[8:11], s22 offen  lds
s_add_u32 m0, s48, 53248
s_mov_b32 s22, 1605632
buffer_load_dwordx4 v44, s[8:11], s22 offen  lds
s_add_u32 m0, s48, 57344
s_mov_b32 s22, 1638400
buffer_load_dwordx4 v44, s[8:11], s22 offen  lds
s_add_u32 m0, s48, 61440
s_mov_b32 s22, 1671168
buffer_load_dwordx4 v44, s[8:11], s22 offen  lds
s_waitcnt vmcnt(28)
s_barrier
s_cmp_lg_u32 s20, 0
s_cbranch_scc1 L_rs_wo4
v_xor_b32 v48, 0, v47
v_add_u32 v48, 65536, v48
ds_read_b64_tr_b16 v[136:137], v48
ds_read_b64_tr_b16 v[138:139], v48 offset:512
ds_read_b64_tr_b16 v[140:141], v48 offset:8192
ds_read_b64_tr_b16 v[142:143], v48 offset:8704
ds_read_b64_tr_b16 v[152:153], v48 offset:32
ds_read_b64_tr_b16 v[154:155], v48 offset:544
ds_read_b64_tr_b16 v[156:157], v48 offset:8224
ds_read_b64_tr_b16 v[158:159], v48 offset:8736
s_waitcnt lgkmcnt(0)
v_xor_b32 v48, 64, v47
v_add_u32 v48, 65536, v48
ds_read_b64_tr_b16 v[168:169], v48
ds_read_b64_tr_b16 v[170:171], v48 offset:512
ds_read_b64_tr_b16 v[172:173], v48 offset:8192
ds_read_b64_tr_b16 v[174:175], v48 offset:8704
ds_read_b64_tr_b16 v[184:185], v48 offset:32
ds_read_b64_tr_b16 v[186:187], v48 offset:544
ds_read_b64_tr_b16 v[188:189], v48 offset:8224
ds_read_b64_tr_b16 v[190:191], v48 offset:8736
s_waitcnt lgkmcnt(0)
v_xor_b32 v48, 128, v47
v_add_u32 v48, 65536, v48
ds_read_b64_tr_b16 v[200:201], v48
ds_read_b64_tr_b16 v[202:203], v48 offset:512
ds_read_b64_tr_b16 v[204:205], v48 offset:8192
ds_read_b64_tr_b16 v[206:207], v48 offset:8704
ds_read_b64_tr_b16 v[216:217], v48 offset:32
ds_read_b64_tr_b16 v[218:219], v48 offset:544
ds_read_b64_tr_b16 v[220:221], v48 offset:8224
ds_read_b64_tr_b16 v[222:223], v48 offset:8736
s_waitcnt lgkmcnt(0)
v_xor_b32 v48, 192, v47
v_add_u32 v48, 65536, v48
ds_read_b64_tr_b16 v[232:233], v48
ds_read_b64_tr_b16 v[234:235], v48 offset:512
ds_read_b64_tr_b16 v[236:237], v48 offset:8192
ds_read_b64_tr_b16 v[238:239], v48 offset:8704
ds_read_b64_tr_b16 v[248:249], v48 offset:32
ds_read_b64_tr_b16 v[250:251], v48 offset:544
ds_read_b64_tr_b16 v[252:253], v48 offset:8224
ds_read_b64_tr_b16 v[254:255], v48 offset:8736
s_waitcnt lgkmcnt(0)
L_rs_wo4:
s_barrier
s_add_u32 m0, s48, 65536
s_mov_b32 s22, 2097152
buffer_load_dwordx4 v44, s[8:11], s22 offen  lds
s_add_u32 m0, s48, 69632
s_mov_b32 s22, 2129920
buffer_load_dwordx4 v44, s[8:11], s22 offen  lds
s_add_u32 m0, s48, 73728
s_mov_b32 s22, 2162688
buffer_load_dwordx4 v44, s[8:11], s22 offen  lds
s_add_u32 m0, s48, 77824
s_mov_b32 s22, 2195456
buffer_load_dwordx4 v44, s[8:11], s22 offen  lds
s_waitcnt vmcnt(28)
s_barrier
s_cmp_lg_u32 s20, 1
s_cbranch_scc1 L_rs_wo5
v_xor_b32 v48, 0, v47
v_add_u32 v48, 81920, v48
ds_read_b64_tr_b16 v[136:137], v48
ds_read_b64_tr_b16 v[138:139], v48 offset:512
ds_read_b64_tr_b16 v[140:141], v48 offset:8192
ds_read_b64_tr_b16 v[142:143], v48 offset:8704
ds_read_b64_tr_b16 v[152:153], v48 offset:32
ds_read_b64_tr_b16 v[154:155], v48 offset:544
ds_read_b64_tr_b16 v[156:157], v48 offset:8224
ds_read_b64_tr_b16 v[158:159], v48 offset:8736
s_waitcnt lgkmcnt(0)
v_xor_b32 v48, 64, v47
v_add_u32 v48, 81920, v48
ds_read_b64_tr_b16 v[168:169], v48
ds_read_b64_tr_b16 v[170:171], v48 offset:512
ds_read_b64_tr_b16 v[172:173], v48 offset:8192
ds_read_b64_tr_b16 v[174:175], v48 offset:8704
ds_read_b64_tr_b16 v[184:185], v48 offset:32
ds_read_b64_tr_b16 v[186:187], v48 offset:544
ds_read_b64_tr_b16 v[188:189], v48 offset:8224
ds_read_b64_tr_b16 v[190:191], v48 offset:8736
s_waitcnt lgkmcnt(0)
v_xor_b32 v48, 128, v47
v_add_u32 v48, 81920, v48
ds_read_b64_tr_b16 v[200:201], v48
ds_read_b64_tr_b16 v[202:203], v48 offset:512
ds_read_b64_tr_b16 v[204:205], v48 offset:8192
ds_read_b64_tr_b16 v[206:207], v48 offset:8704
ds_read_b64_tr_b16 v[216:217], v48 offset:32
ds_read_b64_tr_b16 v[218:219], v48 offset:544
ds_read_b64_tr_b16 v[220:221], v48 offset:8224
ds_read_b64_tr_b16 v[222:223], v48 offset:8736
s_waitcnt lgkmcnt(0)
v_xor_b32 v48, 192, v47
v_add_u32 v48, 81920, v48
ds_read_b64_tr_b16 v[232:233], v48
ds_read_b64_tr_b16 v[234:235], v48 offset:512
ds_read_b64_tr_b16 v[236:237], v48 offset:8192
ds_read_b64_tr_b16 v[238:239], v48 offset:8704
ds_read_b64_tr_b16 v[248:249], v48 offset:32
ds_read_b64_tr_b16 v[250:251], v48 offset:544
ds_read_b64_tr_b16 v[252:253], v48 offset:8224
ds_read_b64_tr_b16 v[254:255], v48 offset:8736
s_waitcnt lgkmcnt(0)
L_rs_wo5:
s_barrier
s_add_u32 m0, s48, 81920
s_mov_b32 s22, 2621440
buffer_load_dwordx4 v44, s[8:11], s22 offen  lds
s_add_u32 m0, s48, 86016
s_mov_b32 s22, 2654208
buffer_load_dwordx4 v44, s[8:11], s22 offen  lds
s_add_u32 m0, s48, 90112
s_mov_b32 s22, 2686976
buffer_load_dwordx4 v44, s[8:11], s22 offen  lds
s_add_u32 m0, s48, 94208
s_mov_b32 s22, 2719744
buffer_load_dwordx4 v44, s[8:11], s22 offen  lds
s_waitcnt vmcnt(28)
s_barrier
s_cmp_lg_u32 s20, 2
s_cbranch_scc1 L_rs_wo6
v_xor_b32 v48, 0, v47
v_add_u32 v48, 98304, v48
ds_read_b64_tr_b16 v[136:137], v48
ds_read_b64_tr_b16 v[138:139], v48 offset:512
ds_read_b64_tr_b16 v[140:141], v48 offset:8192
ds_read_b64_tr_b16 v[142:143], v48 offset:8704
ds_read_b64_tr_b16 v[152:153], v48 offset:32
ds_read_b64_tr_b16 v[154:155], v48 offset:544
ds_read_b64_tr_b16 v[156:157], v48 offset:8224
ds_read_b64_tr_b16 v[158:159], v48 offset:8736
s_waitcnt lgkmcnt(0)
v_xor_b32 v48, 64, v47
v_add_u32 v48, 98304, v48
ds_read_b64_tr_b16 v[168:169], v48
ds_read_b64_tr_b16 v[170:171], v48 offset:512
ds_read_b64_tr_b16 v[172:173], v48 offset:8192
ds_read_b64_tr_b16 v[174:175], v48 offset:8704
ds_read_b64_tr_b16 v[184:185], v48 offset:32
ds_read_b64_tr_b16 v[186:187], v48 offset:544
ds_read_b64_tr_b16 v[188:189], v48 offset:8224
ds_read_b64_tr_b16 v[190:191], v48 offset:8736
s_waitcnt lgkmcnt(0)
v_xor_b32 v48, 128, v47
v_add_u32 v48, 98304, v48
ds_read_b64_tr_b16 v[200:201], v48
ds_read_b64_tr_b16 v[202:203], v48 offset:512
ds_read_b64_tr_b16 v[204:205], v48 offset:8192
ds_read_b64_tr_b16 v[206:207], v48 offset:8704
ds_read_b64_tr_b16 v[216:217], v48 offset:32
ds_read_b64_tr_b16 v[218:219], v48 offset:544
ds_read_b64_tr_b16 v[220:221], v48 offset:8224
ds_read_b64_tr_b16 v[222:223], v48 offset:8736
s_waitcnt lgkmcnt(0)
v_xor_b32 v48, 192, v47
v_add_u32 v48, 98304, v48
ds_read_b64_tr_b16 v[232:233], v48
ds_read_b64_tr_b16 v[234:235], v48 offset:512
ds_read_b64_tr_b16 v[236:237], v48 offset:8192
ds_read_b64_tr_b16 v[238:239], v48 offset:8704
ds_read_b64_tr_b16 v[248:249], v48 offset:32
ds_read_b64_tr_b16 v[250:251], v48 offset:544
ds_read_b64_tr_b16 v[252:253], v48 offset:8224
ds_read_b64_tr_b16 v[254:255], v48 offset:8736
s_waitcnt lgkmcnt(0)
L_rs_wo6:
s_barrier
s_add_u32 m0, s48, 98304
s_mov_b32 s22, 3145728
buffer_load_dwordx4 v44, s[8:11], s22 offen  lds
s_add_u32 m0, s48, 102400
s_mov_b32 s22, 3178496
buffer_load_dwordx4 v44, s[8:11], s22 offen  lds
s_add_u32 m0, s48, 106496
s_mov_b32 s22, 3211264
buffer_load_dwordx4 v44, s[8:11], s22 offen  lds
s_add_u32 m0, s48, 110592
s_mov_b32 s22, 3244032
buffer_load_dwordx4 v44, s[8:11], s22 offen  lds
s_waitcnt vmcnt(28)
s_barrier
s_cmp_lg_u32 s20, 3
s_cbranch_scc1 L_rs_wo7
v_xor_b32 v48, 0, v47
v_add_u32 v48, 114688, v48
ds_read_b64_tr_b16 v[136:137], v48
ds_read_b64_tr_b16 v[138:139], v48 offset:512
ds_read_b64_tr_b16 v[140:141], v48 offset:8192
ds_read_b64_tr_b16 v[142:143], v48 offset:8704
ds_read_b64_tr_b16 v[152:153], v48 offset:32
ds_read_b64_tr_b16 v[154:155], v48 offset:544
ds_read_b64_tr_b16 v[156:157], v48 offset:8224
ds_read_b64_tr_b16 v[158:159], v48 offset:8736
s_waitcnt lgkmcnt(0)
v_xor_b32 v48, 64, v47
v_add_u32 v48, 114688, v48
ds_read_b64_tr_b16 v[168:169], v48
ds_read_b64_tr_b16 v[170:171], v48 offset:512
ds_read_b64_tr_b16 v[172:173], v48 offset:8192
ds_read_b64_tr_b16 v[174:175], v48 offset:8704
ds_read_b64_tr_b16 v[184:185], v48 offset:32
ds_read_b64_tr_b16 v[186:187], v48 offset:544
ds_read_b64_tr_b16 v[188:189], v48 offset:8224
ds_read_b64_tr_b16 v[190:191], v48 offset:8736
s_waitcnt lgkmcnt(0)
v_xor_b32 v48, 128, v47
v_add_u32 v48, 114688, v48
ds_read_b64_tr_b16 v[200:201], v48
ds_read_b64_tr_b16 v[202:203], v48 offset:512
ds_read_b64_tr_b16 v[204:205], v48 offset:8192
ds_read_b64_tr_b16 v[206:207], v48 offset:8704
ds_read_b64_tr_b16 v[216:217], v48 offset:32
ds_read_b64_tr_b16 v[218:219], v48 offset:544
ds_read_b64_tr_b16 v[220:221], v48 offset:8224
ds_read_b64_tr_b16 v[222:223], v48 offset:8736
s_waitcnt lgkmcnt(0)
v_xor_b32 v48, 192, v47
v_add_u32 v48, 114688, v48
ds_read_b64_tr_b16 v[232:233], v48
ds_read_b64_tr_b16 v[234:235], v48 offset:512
ds_read_b64_tr_b16 v[236:237], v48 offset:8192
ds_read_b64_tr_b16 v[238:239], v48 offset:8704
ds_read_b64_tr_b16 v[248:249], v48 offset:32
ds_read_b64_tr_b16 v[250:251], v48 offset:544
ds_read_b64_tr_b16 v[252:253], v48 offset:8224
ds_read_b64_tr_b16 v[254:255], v48 offset:8736
s_waitcnt lgkmcnt(0)
L_rs_wo7:
s_barrier
s_add_u32 m0, s48, 114688
s_mov_b32 s22, 3670016
buffer_load_dwordx4 v44, s[8:11], s22 offen  lds
s_add_u32 m0, s48, 118784
s_mov_b32 s22, 3702784
buffer_load_dwordx4 v44, s[8:11], s22 offen  lds
s_add_u32 m0, s48, 122880
s_mov_b32 s22, 3735552
buffer_load_dwordx4 v44, s[8:11], s22 offen  lds
s_add_u32 m0, s48, 126976
s_mov_b32 s22, 3768320
buffer_load_dwordx4 v44, s[8:11], s22 offen  lds
s_waitcnt vmcnt(28)
s_barrier
v_add_u32 v48, 0, v46
ds_read_b64_tr_b16 v[64:65], v48
ds_read_b64_tr_b16 v[66:67], v48 offset:512
ds_read_b64_tr_b16 v[68:69], v48 offset:8192
ds_read_b64_tr_b16 v[70:71], v48 offset:8704
ds_read_b64_tr_b16 v[72:73], v48 offset:8
ds_read_b64_tr_b16 v[74:75], v48 offset:520
ds_read_b64_tr_b16 v[76:77], v48 offset:8200
ds_read_b64_tr_b16 v[78:79], v48 offset:8712
s_waitcnt lgkmcnt(0)
s_barrier
ds_write_b128 v32, v[64:67]
ds_write_b128 v32, v[68:71] offset:1024
ds_write_b128 v32, v[72:75] offset:2048
ds_write_b128 v32, v[76:79] offset:3072
s_waitcnt lgkmcnt(0)
s_waitcnt vmcnt(24)
s_barrier
v_add_u32 v48, 16384, v46
ds_read_b64_tr_b16 v[64:65], v48
ds_read_b64_tr_b16 v[66:67], v48 offset:512
ds_read_b64_tr_b16 v[68:69], v48 offset:8192
ds_read_b64_tr_b16 v[70:71], v48 offset:8704
ds_read_b64_tr_b16 v[72:73], v48 offset:8
ds_read_b64_tr_b16 v[74:75], v48 offset:520
ds_read_b64_tr_b16 v[76:77], v48 offset:8200
ds_read_b64_tr_b16 v[78:79], v48 offset:8712
s_waitcnt lgkmcnt(0)
s_barrier
ds_write_b128 v32, v[64:67] offset:16384
ds_write_b128 v32, v[68:71] offset:17408
ds_write_b128 v32, v[72:75] offset:18432
ds_write_b128 v32, v[76:79] offset:19456
s_waitcnt lgkmcnt(0)
s_waitcnt vmcnt(20)
s_barrier
s_getpc_b64 s[16:17]
L_rs_pc0:
s_add_u32 s16, s16, L_rs_w0_entry - L_rs_pc0
s_addc_u32 s17, s17, 0
v_lshlrev_b32 v49, 7, v0
v_min_u32 v49, L_rs_end - L_rs_w0_entry, v49
global_load_dword v50, v49, s[16:17]
v_lshlrev_b32 v49, 7, v40
s_xor_b32 s23, s35, 16384
s_cmp_eq_u32 s20, 1
s_cselect_b32 s22, s35, s47
s_cmp_eq_u32 s20, 2
s_cselect_b32 s22, s23, s22
s_lshl_b32 s23, s31, 13
s_add_u32 s23, s23, 178257920
s_cmp_eq_u32 s20, 3
s_cselect_b32 s22, s23, s22
buffer_load_dword v51, v49, s[4:7], s22 offen sc1
v_lshlrev_b32 v49, 13, v0
v_and_b32 v49, 0x1fffff, v49
s_mov_b32 s22, 67108864
buffer_load_dword v52, v49, s[4:7], s22 offen sc1
buffer_load_dword v57, v7, s[4:7], 0 offen sc1
v_add_u32 v48, 32768, v46
ds_read_b64_tr_b16 v[64:65], v48
ds_read_b64_tr_b16 v[66:67], v48 offset:512
ds_read_b64_tr_b16 v[68:69], v48 offset:8192
ds_read_b64_tr_b16 v[70:71], v48 offset:8704
ds_read_b64_tr_b16 v[72:73], v48 offset:8
ds_read_b64_tr_b16 v[74:75], v48 offset:520
ds_read_b64_tr_b16 v[76:77], v48 offset:8200
ds_read_b64_tr_b16 v[78:79], v48 offset:8712
s_waitcnt lgkmcnt(0)
s_barrier
ds_write_b128 v32, v[64:67] offset:32768
ds_write_b128 v32, v[68:71] offset:33792
ds_write_b128 v32, v[72:75] offset:34816
ds_write_b128 v32, v[76:79] offset:35840
s_waitcnt lgkmcnt(0)
s_waitcnt vmcnt(16)
s_barrier
v_add_u32 v48, 49152, v46
ds_read_b64_tr_b16 v[64:65], v48
ds_read_b64_tr_b16 v[66:67], v48 offset:512
ds_read_b64_tr_b16 v[68:69], v48 offset:8192
ds_read_b64_tr_b16 v[70:71], v48 offset:8704
ds_read_b64_tr_b16 v[72:73], v48 offset:8
ds_read_b64_tr_b16 v[74:75], v48 offset:520
ds_read_b64_tr_b16 v[76:77], v48 offset:8200
ds_read_b64_tr_b16 v[78:79], v48 offset:8712
s_waitcnt lgkmcnt(0)
s_barrier
ds_write_b128 v32, v[64:67] offset:49152
ds_write_b128 v32, v[68:71] offset:50176
ds_write_b128 v32, v[72:75] offset:51200
ds_write_b128 v32, v[76:79] offset:52224
s_waitcnt lgkmcnt(0)
s_waitcnt vmcnt(12)
s_barrier
v_add_u32 v48, 65536, v46
ds_read_b64_tr_b16 v[64:65], v48
ds_read_b64_tr_b16 v[66:67], v48 offset:512
ds_read_b64_tr_b16 v[68:69], v48 offset:8192
ds_read_b64_tr_b16 v[70:71], v48 offset:8704
ds_read_b64_tr_b16 v[72:73], v48 offset:8
ds_read_b64_tr_b16 v[74:75], v48 offset:520
ds_read_b64_tr_b16 v[76:77], v48 offset:8200
ds_read_b64_tr_b16 v[78:79], v48 offset:8712
s_waitcnt lgkmcnt(0)
s_barrier
ds_write_b128 v33, v[64:67]
ds_write_b128 v33, v[68:71] offset:1024
ds_write_b128 v33, v[72:75] offset:2048
ds_write_b128 v33, v[76:79] offset:3072
s_waitcnt lgkmcnt(0)
s_waitcnt vmcnt(8)
s_barrier
v_add_u32 v48, 81920, v46
ds_read_b64_tr_b16 v[64:65], v48
ds_read_b64_tr_b16 v[66:67], v48 offset:512
ds_read_b64_tr_b16 v[68:69], v48 offset:8192
ds_read_b64_tr_b16 v[70:71], v48 offset:8704
ds_read_b64_tr_b16 v[72:73], v48 offset:8
ds_read_b64_tr_b16 v[74:75], v48 offset:520
ds_read_b64_tr_b16 v[76:77], v48 offset:8200
ds_read_b64_tr_b16 v[78:79], v48 offset:8712
s_waitcnt lgkmcnt(0)
s_barrier
ds_write_b128 v33, v[64:67] offset:16384
ds_write_b128 v33, v[68:71] offset:17408
ds_write_b128 v33, v[72:75] offset:18432
ds_write_b128 v33, v[76:79] offset:19456
s_waitcnt lgkmcnt(0)
s_waitcnt vmcnt(4)
s_barrier
v_add_u32 v48, 98304, v46
ds_read_b64_tr_b16 v[64:65], v48
ds_read_b64_tr_b16 v[66:67], v48 offset:512
ds_read_b64_tr_b16 v[68:69], v48 offset:8192
ds_read_b64_tr_b16 v[70:71], v48 offset:8704
ds_read_b64_tr_b16 v[72:73], v48 offset:8
ds_read_b64_tr_b16 v[74:75], v48 offset:520
ds_read_b64_tr_b16 v[76:77], v48 offset:8200
ds_read_b64_tr_b16 v[78:79], v48 offset:8712
s_waitcnt lgkmcnt(0)
s_barrier
ds_write_b128 v33, v[64:67] offset:32768
ds_write_b128 v33, v[68:71] offset:33792
ds_write_b128 v33, v[72:75] offset:34816
ds_write_b128 v33, v[76:79] offset:35840
s_waitcnt lgkmcnt(0)
s_waitcnt vmcnt(0)
s_barrier
v_add_u32 v48, 114688, v46
ds_read_b64_tr_b16 v[64:65], v48
ds_read_b64_tr_b16 v[66:67], v48 offset:512
ds_read_b64_tr_b16 v[68:69], v48 offset:8192
ds_read_b64_tr_b16 v[70:71], v48 offset:8704
ds_read_b64_tr_b16 v[72:73], v48 offset:8
ds_read_b64_tr_b16 v[74:75], v48 offset:520
ds_read_b64_tr_b16 v[76:77], v48 offset:8200
ds_read_b64_tr_b16 v[78:79], v48 offset:8712
s_waitcnt lgkmcnt(0)
s_barrier
ds_write_b128 v33, v[64:67] offset:49152
ds_write_b128 v33, v[68:71] offset:50176
ds_write_b128 v33, v[72:75] offset:51200
ds_write_b128 v33, v[76:79] offset:52224
s_waitcnt lgkmcnt(0)
L_rs_iw:
buffer_load_dword v58, off, s[12:15], 0 offset:204 sc1
s_waitcnt vmcnt(0)
L_rs_iw1:
v_and_b32 v50, 0xffff, v58
v_readfirstlane_b32 s60, v58
v_cmp_ne_u32 vcc, s100, v50
s_cbranch_vccnz L_rs_iw
s_lshr_b32 s60, s60, 15
s_cmp_gt_u32 s60, s100
s_cselect_b32 s60, 8192, 0
s_bfe_u32 s22, s31, 0x10001
s_lshl_b32 s22, s22, 12
s_add_u32 s22, s22, s60
s_lshl_b32 s23, s20, 10
s_add_u32 s22, s22, s23
s_add_u32 s38, s38, s22
s_add_u32 s37, s37, s22
s_xor_b32 s40, s38, 4096
s_xor_b32 s39, s37, 4096
s_xor_b32 s36, s35, 16384
s_mov_b32 s21, 0
s_cmp_eq_u32 s30, 0
s_mov_b32 s22, 0x33003300
s_cselect_b32 s16, 0x00330033, s22
s_mov_b32 s17, s16
s_cselect_b32 s18, -1, 0
s_not_b32 s19, s18
s_lshl_b32 s22, s31, 13
s_lshl_b32 s23, s20, 11
s_add_u32 s22, s22, s23
s_add_u32 s43, s22, 16777216
s_add_u32 s44, s22, 33554432
s_lshl_b32 s45, s31, 13
s_add_u32 s45, s45, 178257920
s_mul_i32 s48, s20, 5120
s_add_u32 m0, s48, 140288
s_mov_b32 s41, 1
s_mov_b32 s42, 1
v_mov_b32 v0, v34
v_bfrev_b32 v12, 1
v_bfrev_b32 v3, 1
v_cndmask_b32 v10, v3, v10, s[16:17]
v_cndmask_b32 v9, v3, v9, s[26:27]
s_sub_u32 s45, s45, 0
s_lshl_b32 s51, s30, 11
s_add_u32 s51, s51, s45
s_mov_b32 s50, 0
s_cmp_lg_u32 s20, 3
s_cbranch_scc1 L_rs_kv0
v_readlane_b32 s50, v57, 0
v_readlane_b32 s22, v57, 2
v_readlane_b32 s23, v57, 1
v_readlane_b32 s24, v57, 3
s_nop 3
s_min_u32 s50, s50, s22
s_min_u32 s23, s23, s24
s_lshl_b32 s50, s50, 1
s_lshl_b32 s23, s23, 1
s_add_u32 s23, s23, 1
s_min_u32 s50, s50, s23
L_rs_kvb0:
s_add_u32 s22, s21, 1
s_min_u32 s22, s22, 63
s_cmp_gt_u32 s50, s22
s_cbranch_scc1 L_rs_kvd0
buffer_load_dword v48, v7, s[4:7], 0 offen sc1
s_waitcnt vmcnt(0)
v_readlane_b32 s50, v48, 0
v_readlane_b32 s22, v48, 2
v_readlane_b32 s23, v48, 1
v_readlane_b32 s24, v48, 3
s_nop 3
s_min_u32 s50, s50, s22
s_min_u32 s23, s23, s24
s_lshl_b32 s50, s50, 1
s_lshl_b32 s23, s23, 1
s_add_u32 s23, s23, 1
s_min_u32 s50, s50, s23
s_branch L_rs_kvb0
L_rs_kvd0:
L_rs_kv0:
s_barrier
s_cmp_eq_u32 s20, 1
s_cbranch_scc1 L_rs_w1_entry
s_cmp_eq_u32 s20, 2
s_cbranch_scc1 L_rs_w2_entry
s_cmp_eq_u32 s20, 3
s_cbranch_scc1 L_rs_w3_entry
L_rs_w0_entry:
v_mfma_f32_32x32x8_bf16 v[96:111], v[14:15], v[14:15], 0
v_mfma_f32_16x16x16_bf16 v[112:115], v[14:15], v[14:15], 0
v_mfma_f32_16x16x16_bf16 v[116:119], v[14:15], v[14:15], 0
ds_read_b128 v[64:67], v1
ds_read_b128 v[68:71], v1 offset:1024
ds_read_b128 v[72:75], v1 offset:2048
ds_read_b128 v[76:79], v1 offset:3072
ds_read_b128 v[80:83], v1 offset:16384
ds_read_b128 v[84:87], v1 offset:17408
ds_read_b128 v[88:91], v1 offset:18432
ds_read_b128 v[92:95], v1 offset:19456
buffer_load_dwordx4 v[120:123], v1, s[4:7], s44 offen
buffer_load_dwordx4 v[124:127], v1, s[4:7], s44 offen offset:1024
s_add_u32 s44, s44, 262144
L_rs_w0_loop:
s_add_u32 s22, s35, 0
s_waitcnt vmcnt(0)
buffer_load_dwordx4 v[32:35], v1, s[4:7], s22 offen sc1
buffer_load_dwordx4 v[36:39], v1, s[4:7], s22 offen offset:1024 sc1
L_rs_w0_pa:
s_waitcnt vmcnt(1)
ds_write_b128 v6, v[32:35]
s_waitcnt vmcnt(0)
ds_write_b128 v6, v[36:39] offset:1024
v_max3_u32 v3, v32, v34, v36
v_max_u32 v3, v3, v38
v_cmp_eq_u32 vcc, -1, v3
v_smfmac_f32_16x16x64_bf16 v[96:99], v[32:35], a[0:7], v2
buffer_load_dwordx4 v[32:35], v1, s[4:7], s22 offen sc1
v_smfmac_f32_16x16x64_bf16 v[100:103], v[32:35], a[8:15], v2
buffer_load_dwordx4 v[36:39], v1, s[4:7], s22 offen offset:1024 sc1
v_smfmac_f32_16x16x64_bf16 v[104:107], v[32:35], a[128:135], v2
s_cbranch_vccnz L_rs_w0_pafail
s_waitcnt lgkmcnt(0)
s_barrier
ds_read_b128 v[40:43], v6 offset:2048
ds_read_b128 v[44:47], v6 offset:3072
v_smfmac_f32_16x16x64_bf16 v[108:111], v[32:35], a[136:143], v2
ds_read_b128 v[48:51], v6 offset:4096
v_smfmac_f32_16x16x64_bf16 v[96:99], v[36:39], a[16:23], v2
ds_read_b128 v[52:55], v6 offset:5120
v_smfmac_f32_16x16x64_bf16 v[100:103], v[36:39], a[24:31], v2
ds_read_b128 v[56:59], v6 offset:6144
v_smfmac_f32_16x16x64_bf16 v[104:107], v[36:39], a[144:151], v2
ds_read_b128 v[60:63], v6 offset:7168
v_smfmac_f32_16x16x64_bf16 v[108:111], v[36:39], a[152:159], v2
buffer_load_dwordx4 v1, s[4:7], s43 offen lds
s_waitcnt lgkmcnt(5)
v_smfmac_f32_16x16x64_bf16 v[96:99], v[40:43], a[32:39], v2
v_smfmac_f32_16x16x64_bf16 v[104:107], v[40:43], a[160:167], v2
s_waitcnt lgkmcnt(4)
v_smfmac_f32_16x16x64_bf16 v[96:99], v[44:47], a[48:55], v2
v_smfmac_f32_16x16x64_bf16 v[104:107], v[44:47], a[176:183], v2
buffer_load_dwordx4 v1, s[4:7], s43 offen offset:1024 lds
s_waitcnt lgkmcnt(3)
v_smfmac_f32_16x16x64_bf16 v[96:99], v[48:51], a[64:71], v2
v_smfmac_f32_16x16x64_bf16 v[104:107], v[48:51], a[192:199], v2
s_waitcnt lgkmcnt(2)
v_smfmac_f32_16x16x64_bf16 v[96:99], v[52:55], a[80:87], v2
v_smfmac_f32_16x16x64_bf16 v[104:107], v[52:55], a[208:215], v2
v_mov_b32 v4, s21
buffer_store_dword v4, v7, s[4:7], 0 offen sc1
s_waitcnt lgkmcnt(1)
v_smfmac_f32_16x16x64_bf16 v[96:99], v[56:59], a[96:103], v2
v_smfmac_f32_16x16x64_bf16 v[104:107], v[56:59], a[224:231], v2
s_waitcnt lgkmcnt(0)
v_smfmac_f32_16x16x64_bf16 v[96:99], v[60:63], a[112:119], v2
v_smfmac_f32_16x16x64_bf16 v[104:107], v[60:63], a[240:247], v2
v_smfmac_f32_16x16x64_bf16 v[100:103], v[40:43], a[40:47], v2
s_nop 2
v_smfmac_f32_16x16x64_bf16 v[100:103], v[44:47], a[56:63], v2
s_nop 1
v_add_f32 v96, v96, v98
v_smfmac_f32_16x16x64_bf16 v[100:103], v[48:51], a[72:79], v2
v_add_f32 v97, v97, v99
v_add_f32 v104, v104, v106
v_smfmac_f32_16x16x64_bf16 v[100:103], v[52:55], a[88:95], v2
v_add_f32 v105, v105, v107
v_cvt_pk_bf16_f32 v96, v96, v97
v_smfmac_f32_16x16x64_bf16 v[100:103], v[56:59], a[104:111], v2
v_cvt_pk_bf16_f32 v97, v104, v105
v_and_or_b32 v96, v96, -2, s41
v_smfmac_f32_16x16x64_bf16 v[100:103], v[60:63], a[120:127], v2
buffer_store_dwordx2 v[96:97], v11, s[4:7], s37 offen sc1
v_smfmac_f32_16x16x64_bf16 v[108:111], v[40:43], a[168:175], v2
v_smfmac_f32_16x16x64_bf16 v[108:111], v[44:47], a[184:191], v2
v_smfmac_f32_16x16x64_bf16 v[108:111], v[48:51], a[200:207], v2
v_smfmac_f32_16x16x64_bf16 v[108:111], v[52:55], a[216:223], v2
v_smfmac_f32_16x16x64_bf16 v[108:111], v[56:59], a[232:239], v2
s_nop 2
v_add_f32 v100, v100, v102
v_smfmac_f32_16x16x64_bf16 v[108:111], v[60:63], a[248:255], v2
v_add_f32 v101, v101, v103
v_cvt_pk_bf16_f32 v98, v100, v101
v_and_or_b32 v98, v98, -2, s41
s_nop 4
v_pk_add_f32 v[108:109], v[108:109], v[110:111]
v_cvt_pk_bf16_f32 v99, v108, v109
buffer_store_dwordx2 v[98:99], v11, s[4:7], s37 offen offset:512 sc1
v_smfmac_f32_16x16x64_bf16 v[112:115], v[32:35], v[64:71], v2
ds_read_b128 v[64:67], v1 offset:32768
ds_read_b128 v[68:71], v1 offset:33792
v_smfmac_f32_16x16x64_bf16 v[116:119], v[32:35], v[72:79], v2
ds_read_b128 v[72:75], v1 offset:34816
ds_read_b128 v[76:79], v1 offset:35840
v_smfmac_f32_16x16x64_bf16 v[112:115], v[36:39], v[80:87], v2
ds_read_b128 v[80:83], v1 offset:49152
ds_read_b128 v[84:87], v1 offset:50176
v_smfmac_f32_16x16x64_bf16 v[116:119], v[36:39], v[88:95], v2
ds_read_b128 v[88:91], v1 offset:51200
ds_read_b128 v[92:95], v1 offset:52224
s_waitcnt lgkmcnt(6)
v_smfmac_f32_16x16x64_bf16 v[112:115], v[40:43], v[64:71], v2
ds_read_b128 v[64:67], v5
ds_read_b128 v[68:71], v5 offset:1024
s_waitcnt lgkmcnt(6)
v_smfmac_f32_16x16x64_bf16 v[116:119], v[40:43], v[72:79], v2
ds_read_b128 v[72:75], v5 offset:2048
ds_read_b128 v[76:79], v5 offset:3072
s_waitcnt lgkmcnt(6)
v_smfmac_f32_16x16x64_bf16 v[112:115], v[44:47], v[80:87], v2
ds_read_b128 v[80:83], v5 offset:16384
ds_read_b128 v[84:87], v5 offset:17408
s_waitcnt lgkmcnt(6)
v_smfmac_f32_16x16x64_bf16 v[116:119], v[44:47], v[88:95], v2
ds_read_b128 v[88:91], v5 offset:18432
ds_read_b128 v[92:95], v5 offset:19456
s_waitcnt lgkmcnt(6)
v_smfmac_f32_16x16x64_bf16 v[112:115], v[48:51], v[64:71], v2
ds_read_b128 v[64:67], v5 offset:32768
ds_read_b128 v[68:71], v5 offset:33792
s_waitcnt lgkmcnt(6)
v_smfmac_f32_16x16x64_bf16 v[116:119], v[48:51], v[72:79], v2
ds_read_b128 v[72:75], v5 offset:34816
ds_read_b128 v[76:79], v5 offset:35840
s_waitcnt lgkmcnt(6)
v_smfmac_f32_16x16x64_bf16 v[112:115], v[52:55], v[80:87], v2
ds_read_b128 v[80:83], v5 offset:49152
ds_read_b128 v[84:87], v5 offset:50176
s_waitcnt lgkmcnt(6)
v_smfmac_f32_16x16x64_bf16 v[116:119], v[52:55], v[88:95], v2
ds_read_b128 v[88:91], v5 offset:51200
ds_read_b128 v[92:95], v5 offset:52224
s_waitcnt lgkmcnt(6)
v_smfmac_f32_16x16x64_bf16 v[112:115], v[56:59], v[64:71], v2
s_waitcnt lgkmcnt(4)
v_smfmac_f32_16x16x64_bf16 v[116:119], v[56:59], v[72:79], v2
s_waitcnt lgkmcnt(2)
v_smfmac_f32_16x16x64_bf16 v[112:115], v[60:63], v[80:87], v2
s_waitcnt lgkmcnt(0)
v_smfmac_f32_16x16x64_bf16 v[116:119], v[60:63], v[88:95], v2
buffer_load_dwordx2 v[108:109], v11, s[4:7], s38 offen sc1
v_mfma_f32_16x16x16_bf16 v[100:103], v[96:97], v[16:17], 0
v_mfma_f32_16x16x16_bf16 v[104:107], v[98:99], v[16:17], 0
s_nop 4
v_add_f32 v112, v112, v114
v_add_f32 v113, v113, v115
v_add_f32 v114, v116, v118
v_add_f32 v115, v117, v119
v_cvt_pk_bf16_f32 v18, v112, v113
v_cvt_pk_bf16_f32 v19, v114, v115
v_and_or_b32 v18, v18, -2, s41
buffer_load_dwordx2 v[110:111], v11, s[4:7], s38 offen offset:512 sc1
s_barrier
buffer_store_dwordx2 v[18:19], v11, s[4:7], s39 offen sc1
v_mov_b32 v112, v18
v_mov_b32 v114, v19
v_mov_b32 v92, v28
v_mov_b32 v93, 0
s_waitcnt vmcnt(6)
s_barrier
ds_read_b128 v[32:35], v6 offset:9216
ds_read_b128 v[36:39], v6 offset:10240
ds_read_b128 v[40:43], v6 offset:14336
ds_read_b128 v[44:47], v6 offset:15360
ds_read_b128 v[48:51], v6 offset:19456
ds_read_b128 v[52:55], v6 offset:20480
ds_read_b128 v[56:59], v6 offset:24576
ds_read_b128 v[60:63], v6 offset:25600
buffer_load_dwordx2 v[20:21], v11, s[4:7], s38 offen sc1
buffer_load_dwordx2 v[22:23], v11, s[4:7], s38 offen offset:512 sc1
s_waitcnt vmcnt(4)
v_mfma_f32_16x16x16_bf16 v[80:83], v[108:109], v[16:17], v[100:103]
v_and_b32 v3, 1, v108
v_cmp_ne_u32 vcc, s41, v3
s_nop 5
v_cvt_pk_bf16_f32 v64, v80, v81
v_cvt_pk_bf16_f32 v65, v82, v83
s_cbranch_vccnz L_rs_w0_xslow
s_waitcnt vmcnt(3)
v_mfma_f32_16x16x16_bf16 v[84:87], v[110:111], v[16:17], v[104:107]
v_and_b32 v3, 1, v110
v_cmp_ne_u32 vcc, s41, v3
s_nop 5
v_cvt_pk_bf16_f32 v66, v84, v85
v_cvt_pk_bf16_f32 v67, v86, v87
ds_write_b128 v6, v[64:67] offset:8192
s_cbranch_vccnz L_rs_w0_xslow
L_rs_w0_xok:
s_cmp_eq_u32 s21, 63
s_cbranch_scc1 L_rs_w0_last
buffer_load_dwordx2 v[116:117], v11, s[4:7], s40 offen sc1
s_waitcnt lgkmcnt(1)
v_mfma_f32_16x16x32_bf16 v[80:83], v[32:35], v[64:67], 0
s_waitcnt lgkmcnt(0)
s_barrier
ds_read_b128 v[68:71], v6 offset:13312
ds_read_b128 v[72:75], v6 offset:18432
ds_read_b128 v[76:79], v6 offset:23552
v_mfma_f32_16x16x32_bf16 v[84:87], v[36:39], v[64:67], 0
v_mfma_f32_16x16x32_bf16 v[88:91], v[64:67], v[64:67], 0
buffer_load_dwordx2 v[20:21], v11, s[4:7], s40 offen sc1
s_waitcnt lgkmcnt(2)
v_mfma_f32_16x16x32_bf16 v[80:83], v[40:43], v[68:71], v[80:83]
buffer_store_dwordx4 v[64:67], v10, s[4:7], s45 offen sc1
s_waitcnt lgkmcnt(1)
v_mfma_f32_16x16x32_bf16 v[80:83], v[48:51], v[72:75], v[80:83]
s_waitcnt lgkmcnt(0)
v_mfma_f32_16x16x32_bf16 v[80:83], v[56:59], v[76:79], v[80:83]
v_mfma_f32_16x16x32_bf16 v[84:87], v[44:47], v[68:71], v[84:87]
v_mfma_f32_16x16x32_bf16 v[84:87], v[52:55], v[72:75], v[84:87]
buffer_store_dwordx2 v[18:19], v11, s[4:7], s51 offen offset:2048 sc1
v_mfma_f32_16x16x32_bf16 v[84:87], v[60:63], v[76:79], v[84:87]
v_mfma_f32_16x16x32_bf16 v[88:91], v[68:71], v[68:71], v[88:91]
v_mfma_f32_16x16x32_bf16 v[88:91], v[72:75], v[72:75], v[88:91]
v_mfma_f32_16x16x32_bf16 v[88:91], v[76:79], v[76:79], v[88:91]
v_mfma_f32_32x32x4_2b_bf16 v[32:63], v[14:15], v[14:15], 0
s_nop 0
v_max3_f32 v4, v80, v81, v82
s_nop 1
v_max3_f32 v4, v4, v83, v84
v_max3_f32 v4, v4, v85, v86
v_max_f32 v4, v4, v87
v_max3_f32 v90, v4, v88, v89
v_max3_f32 v4, v4, v88, v89
s_nop 1
v_permlane16_swap_b32 v4, v90
v_max_f32 v4, v4, v90
v_max_f32 v90, v4, v90
s_nop 1
v_permlane32_swap_b32 v4, v90
v_max_f32 v4, v4, v90
v_mul_f32 v4, s34, v4
v_pk_fma_f32 v[80:81], v[80:81], s[34:35], v[4:5] op_sel_hi:[1,0,0] neg_lo:[0,0,1] neg_hi:[0,0,1]
v_pk_fma_f32 v[82:83], v[82:83], s[34:35], v[4:5] op_sel_hi:[1,0,0] neg_lo:[0,0,1] neg_hi:[0,0,1]
v_pk_fma_f32 v[84:85], v[84:85], s[34:35], v[4:5] op_sel_hi:[1,0,0] neg_lo:[0,0,1] neg_hi:[0,0,1]
v_pk_fma_f32 v[86:87], v[86:87], s[34:35], v[4:5] op_sel_hi:[1,0,0] neg_lo:[0,0,1] neg_hi:[0,0,1]
v_pk_fma_f32 v[88:89], v[88:89], s[34:35], v[4:5] op_sel_hi:[1,0,0] neg_lo:[0,0,1] neg_hi:[0,0,1]
v_exp_f32 v80, v80
v_exp_f32 v81, v81
v_exp_f32 v82, v82
v_cvt_pk_bf16_f32 v68, v80, v81
v_exp_f32 v83, v83
v_exp_f32 v84, v84
v_cvt_pk_bf16_f32 v69, v82, v83
v_exp_f32 v85, v85
v_exp_f32 v86, v86
v_cvt_pk_bf16_f32 v70, v84, v85
v_exp_f32 v87, v87
v_exp_f32 v88, v88
v_cvt_pk_bf16_f32 v71, v86, v87
v_exp_f32 v89, v89
s_waitcnt vmcnt(3)
v_mfma_f32_16x16x32_bf16 v[76:79], v[28:31], v[68:71], 0
v_and_b32 v3, 1, v116
v_cvt_pk_bf16_f32 v72, v88, v89
v_mfma_f32_16x16x32_bf16 v[100:103], v[120:123], v[68:71], 0
v_cmp_ne_u32 vcc, s41, v3
v_cvt_pk_bf16_f32 v73, v88, v89
v_mfma_f32_16x16x32_bf16 v[104:107], v[124:127], v[68:71], 0
v_mov_b32 v113, v116
v_mov_b32 v115, v117
v_mfma_f32_16x16x16_bf16 v[76:79], v[92:93], v[72:73], v[76:79]
s_cbranch_vccnz L_rs_w0_pv0
L_rs_w0_pv2:
v_mfma_f32_16x16x16_bf16 v[100:103], v[112:113], v[72:73], v[100:103]
v_mfma_f32_16x16x16_bf16 v[104:107], v[114:115], v[72:73], v[104:107]
buffer_load_dwordx4 v[120:123], v1, s[4:7], s44 offen
buffer_load_dwordx4 v[124:127], v1, s[4:7], s44 offen offset:1024
s_nop 2
v_rcp_f32 v76, v76
s_mov_b64 exec, s[28:29]
v_pk_mul_f32 v[100:101], v[100:101], v[76:77] op_sel_hi:[1,0]
v_pk_mul_f32 v[102:103], v[102:103], v[76:77] op_sel_hi:[1,0]
v_pk_mul_f32 v[104:105], v[104:105], v[76:77] op_sel_hi:[1,0]
v_pk_mul_f32 v[106:107], v[106:107], v[76:77] op_sel_hi:[1,0]
v_cvt_pk_bf16_f32 v84, v100, v101
v_cvt_pk_bf16_f32 v85, v102, v103
v_cvt_pk_bf16_f32 v86, v104, v105
v_cvt_pk_bf16_f32 v87, v106, v107
ds_write_b128 v6, v[84:87] offset:28640
s_mov_b64 exec, -1
s_waitcnt lgkmcnt(0)
s_barrier
ds_read_b128 v[68:71], v6 offset:28672
ds_read_b128 v[72:75], v6 offset:29696
s_waitcnt lgkmcnt(1)
v_smfmac_f32_16x16x64_bf16 v[32:35], v[68:71], v[128:135], v2
s_add_u32 s21, s21, 1
s_xor_b32 s38, s38, 1048576
s_xor_b32 s37, s37, 1048576
s_waitcnt lgkmcnt(0)
v_smfmac_f32_16x16x64_bf16 v[32:35], v[72:75], v[136:143], v2
s_xor_b32 s40, s40, 1048576
s_xor_b32 s39, s39, 1048576
s_lshr_b32 s41, s21, 1
v_smfmac_f32_16x16x64_bf16 v[36:39], v[68:71], v[144:151], v2
s_and_b32 s41, s41, 1
s_xor_b32 s41, s41, 1
s_xor_b32 s35, s35, 16384
v_smfmac_f32_16x16x64_bf16 v[36:39], v[72:75], v[152:159], v2
v_add_f32 v32, v32, v34
s_xor_b32 s36, s36, 16384
s_add_u32 s43, s43, 262144
s_add_u32 s44, s44, 262144
v_smfmac_f32_16x16x64_bf16 v[40:43], v[68:71], v[160:167], v2
v_add_f32 v33, v33, v35
v_smfmac_f32_16x16x64_bf16 v[40:43], v[72:75], v[168:175], v2
v_cvt_pk_bf16_f32 v32, v32, v33
v_smfmac_f32_16x16x64_bf16 v[44:47], v[68:71], v[176:183], v2
v_and_or_b32 v32, v32, -2, s42
v_smfmac_f32_16x16x64_bf16 v[44:47], v[72:75], v[184:191], v2
v_add_f32 v36, v36, v38
v_smfmac_f32_16x16x64_bf16 v[48:51], v[68:71], v[192:199], v2
v_add_f32 v37, v37, v39
v_smfmac_f32_16x16x64_bf16 v[48:51], v[72:75], v[200:207], v2
v_cvt_pk_bf16_f32 v33, v36, v37
v_smfmac_f32_16x16x64_bf16 v[52:55], v[68:71], v[208:215], v2
v_add_f32 v40, v40, v42
v_smfmac_f32_16x16x64_bf16 v[52:55], v[72:75], v[216:223], v2
v_add_f32 v41, v41, v43
v_smfmac_f32_16x16x64_bf16 v[56:59], v[68:71], v[224:231], v2
v_cvt_pk_bf16_f32 v34, v40, v41
v_smfmac_f32_16x16x64_bf16 v[56:59], v[72:75], v[232:239], v2
v_add_f32 v44, v44, v46
v_smfmac_f32_16x16x64_bf16 v[60:63], v[68:71], v[240:247], v2
v_add_f32 v45, v45, v47
v_smfmac_f32_16x16x64_bf16 v[60:63], v[72:75], v[248:255], v2
v_cvt_pk_bf16_f32 v35, v44, v45
buffer_store_dwordx4 v[32:35], v8, s[4:7], s46 offen sc1
v_pk_add_f32 v[48:49], v[48:49], v[50:51]
v_cvt_pk_bf16_f32 v48, v48, v49
v_and_or_b32 v48, v48, -2, s42
v_pk_add_f32 v[52:53], v[52:53], v[54:55]
v_cvt_pk_bf16_f32 v49, v52, v53
v_pk_add_f32 v[56:57], v[56:57], v[58:59]
v_cvt_pk_bf16_f32 v50, v56, v57
v_pk_add_f32 v[60:61], v[60:61], v[62:63]
v_cvt_pk_bf16_f32 v51, v60, v61
buffer_store_dwordx4 v[48:51], v8, s[4:7], s61 offen sc1
s_add_u32 s45, s45, 262144
s_add_u32 s51, s51, 262144
v_mfma_f32_32x32x8_bf16 v[96:111], v[14:15], v[14:15], 0
v_mfma_f32_16x16x16_bf16 v[112:115], v[14:15], v[14:15], 0
v_mfma_f32_16x16x16_bf16 v[116:119], v[14:15], v[14:15], 0
ds_read_b128 v[64:67], v1
ds_read_b128 v[68:71], v1 offset:1024
ds_read_b128 v[72:75], v1 offset:2048
ds_read_b128 v[76:79], v1 offset:3072
ds_read_b128 v[80:83], v1 offset:16384
ds_read_b128 v[84:87], v1 offset:17408
ds_read_b128 v[88:91], v1 offset:18432
ds_read_b128 v[92:95], v1 offset:19456
v_mov_b32 v58, -1
v_mov_b32 v59, -1
s_waitcnt vmcnt(0)
L_rs_w0_cgo:
L_rs_w0_pc:
buffer_load_dword v36, v13, s[4:7], s25 offen sc1
buffer_load_dword v37, v13, s[4:7], s25 offen offset:256 sc1
buffer_load_dword v38, v13, s[4:7], s25 offen offset:512 sc1
buffer_load_dword v39, v13, s[4:7], s25 offen offset:768 sc1
buffer_load_dword v40, v13, s[4:7], s25 offen offset:1024 sc1
buffer_load_dword v41, v13, s[4:7], s25 offen offset:1280 sc1
buffer_load_dword v42, v13, s[4:7], s25 offen offset:1536 sc1
buffer_load_dword v43, v13, s[4:7], s25 offen offset:1792 sc1
s_waitcnt vmcnt(4)
v_mfma_f32_16x16x32_bf16 v[52:55], v[36:39], v[24:27], 0
v_bitop3_b32 v3, s42, v36, v37 bitop3:0x7e
v_bitop3_b32 v4, s42, v38, v39 bitop3:0x7e
s_waitcnt vmcnt(2)
v_or_b32 v3, v3, v4
v_bitop3_b32 v4, s42, v40, v41 bitop3:0x7e
s_waitcnt vmcnt(0)
v_mfma_f32_16x16x32_bf16 v[52:55], v[40:43], v[24:27], v[52:55]
v_bitop3_b32 v56, s42, v42, v43 bitop3:0x7e
v_or3_b32 v3, v3, v4, v56
v_and_b32 v3, v0, v3
v_cmp_ne_u32 vcc, 0, v3
s_nop 3
v_cvt_pk_bf16_f32 v56, v52, v53
v_cvt_pk_bf16_f32 v57, v54, v55
v_min_u32 v56, -2, v56
s_cbranch_vccnz L_rs_w0_pc
s_mov_b64 exec, s[26:27]
buffer_store_dwordx2 v[56:57], v9, s[4:7], s35 offen sc1
buffer_store_dwordx2 v[58:59], v9, s[4:7], s36 offen sc1
s_mov_b64 exec, -1
s_xor_b32 s42, s42, 1
s_branch L_rs_w0_loop
L_rs_w0_last:
buffer_store_dwordx4 v[64:67], v10, s[4:7], s45 offen sc1
buffer_store_dwordx2 v[18:19], v11, s[4:7], s51 offen offset:2048 sc1
s_branch L_rs_end
L_rs_w0_pafail:
s_nop 7
v_mov_b32 v96, 0
v_mov_b32 v97, 0
v_mov_b32 v98, 0
v_mov_b32 v99, 0
v_mov_b32 v100, 0
v_mov_b32 v101, 0
v_mov_b32 v102, 0
v_mov_b32 v103, 0
v_mov_b32 v104, 0
v_mov_b32 v105, 0
v_mov_b32 v106, 0
v_mov_b32 v107, 0
s_branch L_rs_w0_pa
L_rs_w0_xslow:
buffer_load_dwordx2 v[108:109], v11, s[4:7], s38 offen sc1
buffer_load_dwordx2 v[110:111], v11, s[4:7], s38 offen offset:512 sc1
s_waitcnt vmcnt(2)
v_bitop3_b32 v3, s41, v20, v22 bitop3:0x7e
v_mfma_f32_16x16x16_bf16 v[80:83], v[20:21], v[16:17], v[100:103]
v_and_b32 v3, 1, v3
v_mfma_f32_16x16x16_bf16 v[84:87], v[22:23], v[16:17], v[104:107]
v_cmp_ne_u32 vcc, 0, v3
s_cbranch_vccz L_rs_w0_xgot
buffer_load_dwordx2 v[20:21], v11, s[4:7], s38 offen sc1
buffer_load_dwordx2 v[22:23], v11, s[4:7], s38 offen offset:512 sc1
s_waitcnt vmcnt(2)
v_bitop3_b32 v3, s41, v108, v110 bitop3:0x7e
v_mfma_f32_16x16x16_bf16 v[80:83], v[108:109], v[16:17], v[100:103]
v_and_b32 v3, 1, v3
v_mfma_f32_16x16x16_bf16 v[84:87], v[110:111], v[16:17], v[104:107]
v_cmp_ne_u32 vcc, 0, v3
s_cbranch_vccz L_rs_w0_xgot
s_branch L_rs_w0_xslow
L_rs_w0_xgot:
s_nop 3
v_cvt_pk_bf16_f32 v64, v80, v81
v_cvt_pk_bf16_f32 v65, v82, v83
v_cvt_pk_bf16_f32 v66, v84, v85
v_cvt_pk_bf16_f32 v67, v86, v87
ds_write_b128 v6, v[64:67] offset:8192
s_branch L_rs_w0_xok
L_rs_w0_pv0:
s_waitcnt vmcnt(2)
s_branch L_rs_w0_pv1
L_rs_w0_pv:
buffer_load_dwordx2 v[20:21], v11, s[4:7], s40 offen sc1
s_waitcnt vmcnt(0)
L_rs_w0_pv1:
v_and_b32 v3, 1, v20
v_cmp_ne_u32 vcc, s41, v3
v_mov_b32 v113, v20
v_mov_b32 v115, v21
s_cbranch_vccnz L_rs_w0_pv
s_branch L_rs_w0_pv2
L_rs_w1_entry:
v_mfma_f32_32x32x8_bf16 v[96:111], v[14:15], v[14:15], 0
v_mfma_f32_16x16x16_bf16 v[112:115], v[14:15], v[14:15], 0
v_mfma_f32_16x16x16_bf16 v[116:119], v[14:15], v[14:15], 0
ds_read_b128 v[64:67], v1 offset:4096
ds_read_b128 v[68:71], v1 offset:5120
ds_read_b128 v[72:75], v1 offset:6144
ds_read_b128 v[76:79], v1 offset:7168
ds_read_b128 v[80:83], v1 offset:20480
ds_read_b128 v[84:87], v1 offset:21504
ds_read_b128 v[88:91], v1 offset:22528
ds_read_b128 v[92:95], v1 offset:23552
buffer_load_dwordx4 v[120:123], v1, s[4:7], s44 offen
buffer_load_dwordx4 v[124:127], v1, s[4:7], s44 offen offset:1024
s_add_u32 s44, s44, 262144
L_rs_w1_loop:
s_add_u32 s22, s35, 2048
s_waitcnt vmcnt(0)
buffer_load_dwordx4 v[40:43], v1, s[4:7], s22 offen sc1
buffer_load_dwordx4 v[44:47], v1, s[4:7], s22 offen offset:1024 sc1
L_rs_w1_pa:
s_waitcnt vmcnt(1)
ds_write_b128 v6, v[40:43] offset:2048
s_waitcnt vmcnt(0)
ds_write_b128 v6, v[44:47] offset:3072
v_max3_u32 v3, v40, v42, v44
v_max_u32 v3, v3, v46
v_cmp_eq_u32 vcc, -1, v3
v_smfmac_f32_16x16x64_bf16 v[96:99], v[40:43], a[32:39], v2
buffer_load_dwordx4 v[40:43], v1, s[4:7], s22 offen sc1
v_smfmac_f32_16x16x64_bf16 v[100:103], v[40:43], a[40:47], v2
buffer_load_dwordx4 v[44:47], v1, s[4:7], s22 offen offset:1024 sc1
v_smfmac_f32_16x16x64_bf16 v[104:107], v[40:43], a[160:167], v2
s_cbranch_vccnz L_rs_w1_pafail
s_waitcnt lgkmcnt(0)
s_barrier
ds_read_b128 v[48:51], v6 offset:4096
ds_read_b128 v[52:55], v6 offset:5120
v_smfmac_f32_16x16x64_bf16 v[108:111], v[40:43], a[168:175], v2
ds_read_b128 v[56:59], v6 offset:6144
v_smfmac_f32_16x16x64_bf16 v[96:99], v[44:47], a[48:55], v2
ds_read_b128 v[60:63], v6 offset:7168
v_smfmac_f32_16x16x64_bf16 v[100:103], v[44:47], a[56:63], v2
ds_read_b128 v[32:35], v6
v_smfmac_f32_16x16x64_bf16 v[104:107], v[44:47], a[176:183], v2
ds_read_b128 v[36:39], v6 offset:1024
v_smfmac_f32_16x16x64_bf16 v[108:111], v[44:47], a[184:191], v2
s_waitcnt lgkmcnt(5)
v_smfmac_f32_16x16x64_bf16 v[96:99], v[48:51], a[64:71], v2
buffer_load_dwordx4 v1, s[4:7], s43 offen lds
v_smfmac_f32_16x16x64_bf16 v[104:107], v[48:51], a[192:199], v2
s_waitcnt lgkmcnt(4)
v_smfmac_f32_16x16x64_bf16 v[96:99], v[52:55], a[80:87], v2
v_smfmac_f32_16x16x64_bf16 v[104:107], v[52:55], a[208:215], v2
s_waitcnt lgkmcnt(3)
v_smfmac_f32_16x16x64_bf16 v[96:99], v[56:59], a[96:103], v2
buffer_load_dwordx4 v1, s[4:7], s43 offen offset:1024 lds
v_smfmac_f32_16x16x64_bf16 v[104:107], v[56:59], a[224:231], v2
s_waitcnt lgkmcnt(2)
v_smfmac_f32_16x16x64_bf16 v[96:99], v[60:63], a[112:119], v2
v_smfmac_f32_16x16x64_bf16 v[104:107], v[60:63], a[240:247], v2
s_waitcnt lgkmcnt(1)
v_smfmac_f32_16x16x64_bf16 v[96:99], v[32:35], a[0:7], v2
v_smfmac_f32_16x16x64_bf16 v[104:107], v[32:35], a[128:135], v2
s_waitcnt lgkmcnt(0)
v_smfmac_f32_16x16x64_bf16 v[96:99], v[36:39], a[16:23], v2
v_smfmac_f32_16x16x64_bf16 v[104:107], v[36:39], a[144:151], v2
v_smfmac_f32_16x16x64_bf16 v[100:103], v[48:51], a[72:79], v2
s_nop 2
v_smfmac_f32_16x16x64_bf16 v[100:103], v[52:55], a[88:95], v2
s_nop 1
v_add_f32 v96, v96, v98
v_smfmac_f32_16x16x64_bf16 v[100:103], v[56:59], a[104:111], v2
v_add_f32 v97, v97, v99
v_add_f32 v104, v104, v106
v_smfmac_f32_16x16x64_bf16 v[100:103], v[60:63], a[120:127], v2
v_add_f32 v105, v105, v107
v_cvt_pk_bf16_f32 v96, v96, v97
v_smfmac_f32_16x16x64_bf16 v[100:103], v[32:35], a[8:15], v2
v_cvt_pk_bf16_f32 v97, v104, v105
v_and_or_b32 v96, v96, -2, s41
v_smfmac_f32_16x16x64_bf16 v[100:103], v[36:39], a[24:31], v2
buffer_store_dwordx2 v[96:97], v11, s[4:7], s37 offen sc1
v_smfmac_f32_16x16x64_bf16 v[108:111], v[48:51], a[200:207], v2
v_smfmac_f32_16x16x64_bf16 v[108:111], v[52:55], a[216:223], v2
v_smfmac_f32_16x16x64_bf16 v[108:111], v[56:59], a[232:239], v2
v_smfmac_f32_16x16x64_bf16 v[108:111], v[60:63], a[248:255], v2
v_smfmac_f32_16x16x64_bf16 v[108:111], v[32:35], a[136:143], v2
s_nop 2
v_add_f32 v100, v100, v102
v_smfmac_f32_16x16x64_bf16 v[108:111], v[36:39], a[152:159], v2
v_add_f32 v101, v101, v103
v_cvt_pk_bf16_f32 v98, v100, v101
v_and_or_b32 v98, v98, -2, s41
s_nop 4
v_pk_add_f32 v[108:109], v[108:109], v[110:111]
v_cvt_pk_bf16_f32 v99, v108, v109
buffer_store_dwordx2 v[98:99], v11, s[4:7], s37 offen offset:512 sc1
v_smfmac_f32_16x16x64_bf16 v[112:115], v[32:35], v[64:71], v2
ds_read_b128 v[64:67], v1 offset:36864
ds_read_b128 v[68:71], v1 offset:37888
v_smfmac_f32_16x16x64_bf16 v[116:119], v[32:35], v[72:79], v2
ds_read_b128 v[72:75], v1 offset:38912
ds_read_b128 v[76:79], v1 offset:39936
v_smfmac_f32_16x16x64_bf16 v[112:115], v[36:39], v[80:87], v2
ds_read_b128 v[80:83], v1 offset:53248
ds_read_b128 v[84:87], v1 offset:54272
v_smfmac_f32_16x16x64_bf16 v[116:119], v[36:39], v[88:95], v2
ds_read_b128 v[88:91], v1 offset:55296
ds_read_b128 v[92:95], v1 offset:56320
s_waitcnt lgkmcnt(6)
v_smfmac_f32_16x16x64_bf16 v[112:115], v[40:43], v[64:71], v2
ds_read_b128 v[64:67], v5 offset:4096
ds_read_b128 v[68:71], v5 offset:5120
s_waitcnt lgkmcnt(6)
v_smfmac_f32_16x16x64_bf16 v[116:119], v[40:43], v[72:79], v2
ds_read_b128 v[72:75], v5 offset:6144
ds_read_b128 v[76:79], v5 offset:7168
s_waitcnt lgkmcnt(6)
v_smfmac_f32_16x16x64_bf16 v[112:115], v[44:47], v[80:87], v2
ds_read_b128 v[80:83], v5 offset:20480
ds_read_b128 v[84:87], v5 offset:21504
s_waitcnt lgkmcnt(6)
v_smfmac_f32_16x16x64_bf16 v[116:119], v[44:47], v[88:95], v2
ds_read_b128 v[88:91], v5 offset:22528
ds_read_b128 v[92:95], v5 offset:23552
s_waitcnt lgkmcnt(6)
v_smfmac_f32_16x16x64_bf16 v[112:115], v[48:51], v[64:71], v2
ds_read_b128 v[64:67], v5 offset:36864
ds_read_b128 v[68:71], v5 offset:37888
s_waitcnt lgkmcnt(6)
v_smfmac_f32_16x16x64_bf16 v[116:119], v[48:51], v[72:79], v2
ds_read_b128 v[72:75], v5 offset:38912
ds_read_b128 v[76:79], v5 offset:39936
s_waitcnt lgkmcnt(6)
v_smfmac_f32_16x16x64_bf16 v[112:115], v[52:55], v[80:87], v2
ds_read_b128 v[80:83], v5 offset:53248
ds_read_b128 v[84:87], v5 offset:54272
s_waitcnt lgkmcnt(6)
v_smfmac_f32_16x16x64_bf16 v[116:119], v[52:55], v[88:95], v2
ds_read_b128 v[88:91], v5 offset:55296
ds_read_b128 v[92:95], v5 offset:56320
s_waitcnt lgkmcnt(6)
v_smfmac_f32_16x16x64_bf16 v[112:115], v[56:59], v[64:71], v2
s_waitcnt lgkmcnt(4)
v_smfmac_f32_16x16x64_bf16 v[116:119], v[56:59], v[72:79], v2
s_waitcnt lgkmcnt(2)
v_smfmac_f32_16x16x64_bf16 v[112:115], v[60:63], v[80:87], v2
s_waitcnt lgkmcnt(0)
v_smfmac_f32_16x16x64_bf16 v[116:119], v[60:63], v[88:95], v2
buffer_load_dwordx2 v[108:109], v11, s[4:7], s38 offen sc1
v_mfma_f32_16x16x16_bf16 v[100:103], v[96:97], v[16:17], 0
v_mfma_f32_16x16x16_bf16 v[104:107], v[98:99], v[16:17], 0
s_nop 4
v_add_f32 v112, v112, v114
v_add_f32 v113, v113, v115
v_add_f32 v114, v116, v118
v_add_f32 v115, v117, v119
v_cvt_pk_bf16_f32 v18, v112, v113
v_cvt_pk_bf16_f32 v19, v114, v115
v_and_or_b32 v18, v18, -2, s41
buffer_load_dwordx2 v[110:111], v11, s[4:7], s38 offen offset:512 sc1
s_barrier
buffer_store_dwordx2 v[18:19], v11, s[4:7], s39 offen sc1
v_mov_b32 v112, v18
v_mov_b32 v114, v19
v_mov_b32 v92, v28
v_mov_b32 v93, 0
s_waitcnt vmcnt(5)
s_barrier
ds_read_b128 v[32:35], v6 offset:14336
ds_read_b128 v[36:39], v6 offset:15360
ds_read_b128 v[40:43], v6 offset:9216
ds_read_b128 v[44:47], v6 offset:10240
ds_read_b128 v[48:51], v6 offset:24576
ds_read_b128 v[52:55], v6 offset:25600
ds_read_b128 v[56:59], v6 offset:19456
ds_read_b128 v[60:63], v6 offset:20480
buffer_load_dwordx2 v[20:21], v11, s[4:7], s38 offen sc1
buffer_load_dwordx2 v[22:23], v11, s[4:7], s38 offen offset:512 sc1
s_waitcnt vmcnt(4)
v_mfma_f32_16x16x16_bf16 v[80:83], v[108:109], v[16:17], v[100:103]
v_and_b32 v3, 1, v108
v_cmp_ne_u32 vcc, s41, v3
s_nop 5
v_cvt_pk_bf16_f32 v64, v80, v81
v_cvt_pk_bf16_f32 v65, v82, v83
s_cbranch_vccnz L_rs_w1_xslow
s_waitcnt vmcnt(3)
v_mfma_f32_16x16x16_bf16 v[84:87], v[110:111], v[16:17], v[104:107]
v_and_b32 v3, 1, v110
v_cmp_ne_u32 vcc, s41, v3
s_nop 5
v_cvt_pk_bf16_f32 v66, v84, v85
v_cvt_pk_bf16_f32 v67, v86, v87
ds_write_b128 v6, v[64:67] offset:13312
s_cbranch_vccnz L_rs_w1_xslow
L_rs_w1_xok:
s_cmp_eq_u32 s21, 63
s_cbranch_scc1 L_rs_w1_last
buffer_load_dwordx2 v[116:117], v11, s[4:7], s40 offen sc1
s_waitcnt lgkmcnt(1)
v_mfma_f32_16x16x32_bf16 v[80:83], v[32:35], v[64:67], 0
s_waitcnt lgkmcnt(0)
s_barrier
ds_read_b128 v[68:71], v6 offset:8192
ds_read_b128 v[72:75], v6 offset:23552
ds_read_b128 v[76:79], v6 offset:18432
v_mfma_f32_16x16x32_bf16 v[84:87], v[36:39], v[64:67], 0
v_mfma_f32_16x16x32_bf16 v[88:91], v[64:67], v[64:67], 0
buffer_load_dwordx2 v[20:21], v11, s[4:7], s40 offen sc1
s_waitcnt lgkmcnt(2)
v_mfma_f32_16x16x32_bf16 v[80:83], v[40:43], v[68:71], v[80:83]
s_waitcnt lgkmcnt(1)
v_mfma_f32_16x16x32_bf16 v[80:83], v[48:51], v[72:75], v[80:83]
buffer_store_dwordx4 v[64:67], v10, s[4:7], s45 offen offset:64 sc1
s_waitcnt lgkmcnt(0)
v_mfma_f32_16x16x32_bf16 v[80:83], v[56:59], v[76:79], v[80:83]
v_mfma_f32_16x16x32_bf16 v[84:87], v[44:47], v[68:71], v[84:87]
v_mfma_f32_16x16x32_bf16 v[84:87], v[52:55], v[72:75], v[84:87]
v_mfma_f32_16x16x32_bf16 v[84:87], v[60:63], v[76:79], v[84:87]
buffer_store_dwordx2 v[18:19], v11, s[4:7], s51 offen offset:2560 sc1
v_mfma_f32_16x16x32_bf16 v[88:91], v[68:71], v[68:71], v[88:91]
v_mfma_f32_16x16x32_bf16 v[88:91], v[72:75], v[72:75], v[88:91]
v_mfma_f32_16x16x32_bf16 v[88:91], v[76:79], v[76:79], v[88:91]
v_mfma_f32_32x32x4_2b_bf16 v[32:63], v[14:15], v[14:15], 0
s_nop 0
v_max3_f32 v4, v80, v81, v82
s_nop 1
v_max3_f32 v4, v4, v83, v84
v_max3_f32 v4, v4, v85, v86
v_max_f32 v4, v4, v87
v_max3_f32 v90, v4, v88, v89
v_max3_f32 v4, v4, v88, v89
s_nop 1
v_permlane16_swap_b32 v4, v90
v_max_f32 v4, v4, v90
v_max_f32 v90, v4, v90
s_nop 1
v_permlane32_swap_b32 v4, v90
v_max_f32 v4, v4, v90
v_mul_f32 v4, s34, v4
v_pk_fma_f32 v[80:81], v[80:81], s[34:35], v[4:5] op_sel_hi:[1,0,0] neg_lo:[0,0,1] neg_hi:[0,0,1]
v_pk_fma_f32 v[82:83], v[82:83], s[34:35], v[4:5] op_sel_hi:[1,0,0] neg_lo:[0,0,1] neg_hi:[0,0,1]
v_pk_fma_f32 v[84:85], v[84:85], s[34:35], v[4:5] op_sel_hi:[1,0,0] neg_lo:[0,0,1] neg_hi:[0,0,1]
v_pk_fma_f32 v[86:87], v[86:87], s[34:35], v[4:5] op_sel_hi:[1,0,0] neg_lo:[0,0,1] neg_hi:[0,0,1]
v_pk_fma_f32 v[88:89], v[88:89], s[34:35], v[4:5] op_sel_hi:[1,0,0] neg_lo:[0,0,1] neg_hi:[0,0,1]
v_exp_f32 v80, v80
v_exp_f32 v81, v81
v_exp_f32 v82, v82
v_cvt_pk_bf16_f32 v68, v80, v81
v_exp_f32 v83, v83
v_exp_f32 v84, v84
v_cvt_pk_bf16_f32 v69, v82, v83
v_exp_f32 v85, v85
v_exp_f32 v86, v86
v_cvt_pk_bf16_f32 v70, v84, v85
v_exp_f32 v87, v87
v_exp_f32 v88, v88
v_cvt_pk_bf16_f32 v71, v86, v87
v_exp_f32 v89, v89
s_waitcnt vmcnt(3)
v_mfma_f32_16x16x32_bf16 v[76:79], v[28:31], v[68:71], 0
v_and_b32 v3, 1, v116
v_cvt_pk_bf16_f32 v72, v88, v89
v_mfma_f32_16x16x32_bf16 v[100:103], v[120:123], v[68:71], 0
v_cmp_ne_u32 vcc, s41, v3
v_cvt_pk_bf16_f32 v73, v88, v89
v_mfma_f32_16x16x32_bf16 v[104:107], v[124:127], v[68:71], 0
v_mov_b32 v113, v116
v_mov_b32 v115, v117
v_mfma_f32_16x16x16_bf16 v[76:79], v[92:93], v[72:73], v[76:79]
s_cbranch_vccnz L_rs_w1_pv0
L_rs_w1_pv2:
v_mfma_f32_16x16x16_bf16 v[100:103], v[112:113], v[72:73], v[100:103]
v_mfma_f32_16x16x16_bf16 v[104:107], v[114:115], v[72:73], v[104:107]
buffer_load_dwordx4 v[120:123], v1, s[4:7], s44 offen
buffer_load_dwordx4 v[124:127], v1, s[4:7], s44 offen offset:1024
s_nop 2
v_rcp_f32 v76, v76
s_mov_b64 exec, s[28:29]
v_pk_mul_f32 v[100:101], v[100:101], v[76:77] op_sel_hi:[1,0]
v_pk_mul_f32 v[102:103], v[102:103], v[76:77] op_sel_hi:[1,0]
v_pk_mul_f32 v[104:105], v[104:105], v[76:77] op_sel_hi:[1,0]
v_pk_mul_f32 v[106:107], v[106:107], v[76:77] op_sel_hi:[1,0]
v_cvt_pk_bf16_f32 v84, v100, v101
v_cvt_pk_bf16_f32 v85, v102, v103
v_cvt_pk_bf16_f32 v86, v104, v105
v_cvt_pk_bf16_f32 v87, v106, v107
ds_write_b128 v6, v[84:87] offset:28672
s_mov_b64 exec, -1
s_waitcnt lgkmcnt(0)
s_barrier
ds_read_b128 v[68:71], v6 offset:28672
ds_read_b128 v[72:75], v6 offset:29696
s_waitcnt lgkmcnt(1)
v_smfmac_f32_16x16x64_bf16 v[32:35], v[68:71], v[128:135], v2
s_add_u32 s21, s21, 1
s_xor_b32 s38, s38, 1048576
s_xor_b32 s37, s37, 1048576
s_waitcnt lgkmcnt(0)
v_smfmac_f32_16x16x64_bf16 v[32:35], v[72:75], v[136:143], v2
s_xor_b32 s40, s40, 1048576
s_xor_b32 s39, s39, 1048576
s_lshr_b32 s41, s21, 1
v_smfmac_f32_16x16x64_bf16 v[36:39], v[68:71], v[144:151], v2
s_and_b32 s41, s41, 1
s_xor_b32 s41, s41, 1
s_xor_b32 s35, s35, 16384
v_smfmac_f32_16x16x64_bf16 v[36:39], v[72:75], v[152:159], v2
v_add_f32 v32, v32, v34
s_xor_b32 s36, s36, 16384
s_add_u32 s43, s43, 262144
s_add_u32 s44, s44, 262144
v_smfmac_f32_16x16x64_bf16 v[40:43], v[68:71], v[160:167], v2
v_add_f32 v33, v33, v35
v_smfmac_f32_16x16x64_bf16 v[40:43], v[72:75], v[168:175], v2
v_cvt_pk_bf16_f32 v32, v32, v33
v_smfmac_f32_16x16x64_bf16 v[44:47], v[68:71], v[176:183], v2
v_and_or_b32 v32, v32, -2, s42
v_smfmac_f32_16x16x64_bf16 v[44:47], v[72:75], v[184:191], v2
v_add_f32 v36, v36, v38
v_smfmac_f32_16x16x64_bf16 v[48:51], v[68:71], v[192:199], v2
v_add_f32 v37, v37, v39
v_smfmac_f32_16x16x64_bf16 v[48:51], v[72:75], v[200:207], v2
v_cvt_pk_bf16_f32 v33, v36, v37
v_smfmac_f32_16x16x64_bf16 v[52:55], v[68:71], v[208:215], v2
v_add_f32 v40, v40, v42
v_smfmac_f32_16x16x64_bf16 v[52:55], v[72:75], v[216:223], v2
v_add_f32 v41, v41, v43
v_smfmac_f32_16x16x64_bf16 v[56:59], v[68:71], v[224:231], v2
v_cvt_pk_bf16_f32 v34, v40, v41
v_smfmac_f32_16x16x64_bf16 v[56:59], v[72:75], v[232:239], v2
v_add_f32 v44, v44, v46
v_smfmac_f32_16x16x64_bf16 v[60:63], v[68:71], v[240:247], v2
v_add_f32 v45, v45, v47
v_smfmac_f32_16x16x64_bf16 v[60:63], v[72:75], v[248:255], v2
v_cvt_pk_bf16_f32 v35, v44, v45
buffer_store_dwordx4 v[32:35], v8, s[4:7], s46 offen sc1
v_pk_add_f32 v[48:49], v[48:49], v[50:51]
v_cvt_pk_bf16_f32 v48, v48, v49
v_and_or_b32 v48, v48, -2, s42
v_pk_add_f32 v[52:53], v[52:53], v[54:55]
v_cvt_pk_bf16_f32 v49, v52, v53
v_pk_add_f32 v[56:57], v[56:57], v[58:59]
v_cvt_pk_bf16_f32 v50, v56, v57
v_pk_add_f32 v[60:61], v[60:61], v[62:63]
v_cvt_pk_bf16_f32 v51, v60, v61
buffer_store_dwordx4 v[48:51], v8, s[4:7], s61 offen sc1
s_add_u32 s45, s45, 262144
s_add_u32 s51, s51, 262144
v_mfma_f32_32x32x8_bf16 v[96:111], v[14:15], v[14:15], 0
v_mfma_f32_16x16x16_bf16 v[112:115], v[14:15], v[14:15], 0
v_mfma_f32_16x16x16_bf16 v[116:119], v[14:15], v[14:15], 0
ds_read_b128 v[64:67], v1 offset:4096
ds_read_b128 v[68:71], v1 offset:5120
ds_read_b128 v[72:75], v1 offset:6144
ds_read_b128 v[76:79], v1 offset:7168
ds_read_b128 v[80:83], v1 offset:20480
ds_read_b128 v[84:87], v1 offset:21504
ds_read_b128 v[88:91], v1 offset:22528
ds_read_b128 v[92:95], v1 offset:23552
v_mov_b32 v58, -1
v_mov_b32 v59, -1
s_waitcnt vmcnt(0)
L_rs_w1_cgo:
L_rs_w1_pc:
buffer_load_dword v36, v13, s[4:7], s25 offen sc1
buffer_load_dword v37, v13, s[4:7], s25 offen offset:256 sc1
buffer_load_dword v38, v13, s[4:7], s25 offen offset:512 sc1
buffer_load_dword v39, v13, s[4:7], s25 offen offset:768 sc1
buffer_load_dword v40, v13, s[4:7], s25 offen offset:1024 sc1
buffer_load_dword v41, v13, s[4:7], s25 offen offset:1280 sc1
buffer_load_dword v42, v13, s[4:7], s25 offen offset:1536 sc1
buffer_load_dword v43, v13, s[4:7], s25 offen offset:1792 sc1
s_waitcnt vmcnt(4)
v_mfma_f32_16x16x32_bf16 v[52:55], v[36:39], v[24:27], 0
v_bitop3_b32 v3, s42, v36, v37 bitop3:0x7e
v_bitop3_b32 v4, s42, v38, v39 bitop3:0x7e
s_waitcnt vmcnt(2)
v_or_b32 v3, v3, v4
v_bitop3_b32 v4, s42, v40, v41 bitop3:0x7e
s_waitcnt vmcnt(0)
v_mfma_f32_16x16x32_bf16 v[52:55], v[40:43], v[24:27], v[52:55]
v_bitop3_b32 v56, s42, v42, v43 bitop3:0x7e
v_or3_b32 v3, v3, v4, v56
v_and_b32 v3, v0, v3
v_cmp_ne_u32 vcc, 0, v3
s_nop 3
v_cvt_pk_bf16_f32 v56, v52, v53
v_cvt_pk_bf16_f32 v57, v54, v55
v_min_u32 v56, -2, v56
s_cbranch_vccnz L_rs_w1_pc
s_mov_b64 exec, s[26:27]
buffer_store_dwordx2 v[56:57], v9, s[4:7], s35 offen offset:256 sc1
buffer_store_dwordx2 v[58:59], v9, s[4:7], s36 offen offset:256 sc1
s_mov_b64 exec, -1
s_xor_b32 s42, s42, 1
s_branch L_rs_w1_loop
L_rs_w1_last:
buffer_store_dwordx4 v[64:67], v10, s[4:7], s45 offen offset:64 sc1
buffer_store_dwordx2 v[18:19], v11, s[4:7], s51 offen offset:2560 sc1
s_branch L_rs_end
L_rs_w1_pafail:
s_nop 7
v_mov_b32 v96, 0
v_mov_b32 v97, 0
v_mov_b32 v98, 0
v_mov_b32 v99, 0
v_mov_b32 v100, 0
v_mov_b32 v101, 0
v_mov_b32 v102, 0
v_mov_b32 v103, 0
v_mov_b32 v104, 0
v_mov_b32 v105, 0
v_mov_b32 v106, 0
v_mov_b32 v107, 0
s_branch L_rs_w1_pa
L_rs_w1_xslow:
buffer_load_dwordx2 v[108:109], v11, s[4:7], s38 offen sc1
buffer_load_dwordx2 v[110:111], v11, s[4:7], s38 offen offset:512 sc1
s_waitcnt vmcnt(2)
v_bitop3_b32 v3, s41, v20, v22 bitop3:0x7e
v_mfma_f32_16x16x16_bf16 v[80:83], v[20:21], v[16:17], v[100:103]
v_and_b32 v3, 1, v3
v_mfma_f32_16x16x16_bf16 v[84:87], v[22:23], v[16:17], v[104:107]
v_cmp_ne_u32 vcc, 0, v3
s_cbranch_vccz L_rs_w1_xgot
buffer_load_dwordx2 v[20:21], v11, s[4:7], s38 offen sc1
buffer_load_dwordx2 v[22:23], v11, s[4:7], s38 offen offset:512 sc1
s_waitcnt vmcnt(2)
v_bitop3_b32 v3, s41, v108, v110 bitop3:0x7e
v_mfma_f32_16x16x16_bf16 v[80:83], v[108:109], v[16:17], v[100:103]
v_and_b32 v3, 1, v3
v_mfma_f32_16x16x16_bf16 v[84:87], v[110:111], v[16:17], v[104:107]
v_cmp_ne_u32 vcc, 0, v3
s_cbranch_vccz L_rs_w1_xgot
s_branch L_rs_w1_xslow
L_rs_w1_xgot:
s_nop 3
v_cvt_pk_bf16_f32 v64, v80, v81
v_cvt_pk_bf16_f32 v65, v82, v83
v_cvt_pk_bf16_f32 v66, v84, v85
v_cvt_pk_bf16_f32 v67, v86, v87
ds_write_b128 v6, v[64:67] offset:13312
s_branch L_rs_w1_xok
L_rs_w1_pv0:
s_waitcnt vmcnt(2)
s_branch L_rs_w1_pv1
L_rs_w1_pv:
buffer_load_dwordx2 v[20:21], v11, s[4:7], s40 offen sc1
s_waitcnt vmcnt(0)
L_rs_w1_pv1:
v_and_b32 v3, 1, v20
v_cmp_ne_u32 vcc, s41, v3
v_mov_b32 v113, v20
v_mov_b32 v115, v21
s_cbranch_vccnz L_rs_w1_pv
s_branch L_rs_w1_pv2
L_rs_w2_entry:
v_mfma_f32_32x32x8_bf16 v[96:111], v[14:15], v[14:15], 0
v_mfma_f32_16x16x16_bf16 v[112:115], v[14:15], v[14:15], 0
v_mfma_f32_16x16x16_bf16 v[116:119], v[14:15], v[14:15], 0
ds_read_b128 v[64:67], v1 offset:8192
ds_read_b128 v[68:71], v1 offset:9216
ds_read_b128 v[72:75], v1 offset:10240
ds_read_b128 v[76:79], v1 offset:11264
ds_read_b128 v[80:83], v1 offset:24576
ds_read_b128 v[84:87], v1 offset:25600
ds_read_b128 v[88:91], v1 offset:26624
ds_read_b128 v[92:95], v1 offset:27648
buffer_load_dwordx4 v[120:123], v1, s[4:7], s44 offen
buffer_load_dwordx4 v[124:127], v1, s[4:7], s44 offen offset:1024
s_add_u32 s44, s44, 262144
L_rs_w2_loop:
s_add_u32 s22, s35, 4096
s_waitcnt vmcnt(0)
buffer_load_dwordx4 v[48:51], v1, s[4:7], s22 offen sc1
buffer_load_dwordx4 v[52:55], v1, s[4:7], s22 offen offset:1024 sc1
L_rs_w2_pa:
s_waitcnt vmcnt(1)
ds_write_b128 v6, v[48:51] offset:4096
s_waitcnt vmcnt(0)
ds_write_b128 v6, v[52:55] offset:5120
v_max3_u32 v3, v48, v50, v52
v_max_u32 v3, v3, v54
v_cmp_eq_u32 vcc, -1, v3
v_smfmac_f32_16x16x64_bf16 v[96:99], v[48:51], a[64:71], v2
buffer_load_dwordx4 v[48:51], v1, s[4:7], s22 offen sc1
v_smfmac_f32_16x16x64_bf16 v[100:103], v[48:51], a[72:79], v2
buffer_load_dwordx4 v[52:55], v1, s[4:7], s22 offen offset:1024 sc1
v_smfmac_f32_16x16x64_bf16 v[104:107], v[48:51], a[192:199], v2
s_cbranch_vccnz L_rs_w2_pafail
s_waitcnt lgkmcnt(0)
s_barrier
ds_read_b128 v[56:59], v6 offset:6144
ds_read_b128 v[60:63], v6 offset:7168
v_smfmac_f32_16x16x64_bf16 v[108:111], v[48:51], a[200:207], v2
ds_read_b128 v[32:35], v6
v_smfmac_f32_16x16x64_bf16 v[96:99], v[52:55], a[80:87], v2
ds_read_b128 v[36:39], v6 offset:1024
v_smfmac_f32_16x16x64_bf16 v[100:103], v[52:55], a[88:95], v2
ds_read_b128 v[40:43], v6 offset:2048
v_smfmac_f32_16x16x64_bf16 v[104:107], v[52:55], a[208:215], v2
ds_read_b128 v[44:47], v6 offset:3072
v_smfmac_f32_16x16x64_bf16 v[108:111], v[52:55], a[216:223], v2
s_waitcnt lgkmcnt(5)
v_smfmac_f32_16x16x64_bf16 v[96:99], v[56:59], a[96:103], v2
v_smfmac_f32_16x16x64_bf16 v[104:107], v[56:59], a[224:231], v2
buffer_load_dwordx4 v1, s[4:7], s43 offen lds
s_waitcnt lgkmcnt(4)
v_smfmac_f32_16x16x64_bf16 v[96:99], v[60:63], a[112:119], v2
v_smfmac_f32_16x16x64_bf16 v[104:107], v[60:63], a[240:247], v2
s_waitcnt lgkmcnt(3)
v_smfmac_f32_16x16x64_bf16 v[96:99], v[32:35], a[0:7], v2
v_smfmac_f32_16x16x64_bf16 v[104:107], v[32:35], a[128:135], v2
buffer_load_dwordx4 v1, s[4:7], s43 offen offset:1024 lds
s_waitcnt lgkmcnt(2)
v_smfmac_f32_16x16x64_bf16 v[96:99], v[36:39], a[16:23], v2
v_smfmac_f32_16x16x64_bf16 v[104:107], v[36:39], a[144:151], v2
s_waitcnt lgkmcnt(1)
v_smfmac_f32_16x16x64_bf16 v[96:99], v[40:43], a[32:39], v2
v_smfmac_f32_16x16x64_bf16 v[104:107], v[40:43], a[160:167], v2
s_waitcnt lgkmcnt(0)
v_smfmac_f32_16x16x64_bf16 v[96:99], v[44:47], a[48:55], v2
v_smfmac_f32_16x16x64_bf16 v[104:107], v[44:47], a[176:183], v2
v_smfmac_f32_16x16x64_bf16 v[100:103], v[56:59], a[104:111], v2
s_nop 2
v_smfmac_f32_16x16x64_bf16 v[100:103], v[60:63], a[120:127], v2
s_nop 1
v_add_f32 v96, v96, v98
v_smfmac_f32_16x16x64_bf16 v[100:103], v[32:35], a[8:15], v2
v_add_f32 v97, v97, v99
v_add_f32 v104, v104, v106
v_smfmac_f32_16x16x64_bf16 v[100:103], v[36:39], a[24:31], v2
v_add_f32 v105, v105, v107
v_cvt_pk_bf16_f32 v96, v96, v97
v_smfmac_f32_16x16x64_bf16 v[100:103], v[40:43], a[40:47], v2
v_cvt_pk_bf16_f32 v97, v104, v105
v_and_or_b32 v96, v96, -2, s41
v_smfmac_f32_16x16x64_bf16 v[100:103], v[44:47], a[56:63], v2
buffer_store_dwordx2 v[96:97], v11, s[4:7], s37 offen sc1
v_smfmac_f32_16x16x64_bf16 v[108:111], v[56:59], a[232:239], v2
v_smfmac_f32_16x16x64_bf16 v[108:111], v[60:63], a[248:255], v2
v_smfmac_f32_16x16x64_bf16 v[108:111], v[32:35], a[136:143], v2
v_smfmac_f32_16x16x64_bf16 v[108:111], v[36:39], a[152:159], v2
v_smfmac_f32_16x16x64_bf16 v[108:111], v[40:43], a[168:175], v2
s_nop 2
v_add_f32 v100, v100, v102
v_smfmac_f32_16x16x64_bf16 v[108:111], v[44:47], a[184:191], v2
v_add_f32 v101, v101, v103
v_cvt_pk_bf16_f32 v98, v100, v101
v_and_or_b32 v98, v98, -2, s41
s_nop 4
v_pk_add_f32 v[108:109], v[108:109], v[110:111]
v_cvt_pk_bf16_f32 v99, v108, v109
buffer_store_dwordx2 v[98:99], v11, s[4:7], s37 offen offset:512 sc1
v_smfmac_f32_16x16x64_bf16 v[112:115], v[32:35], v[64:71], v2
ds_read_b128 v[64:67], v1 offset:40960
ds_read_b128 v[68:71], v1 offset:41984
v_smfmac_f32_16x16x64_bf16 v[116:119], v[32:35], v[72:79], v2
ds_read_b128 v[72:75], v1 offset:43008
ds_read_b128 v[76:79], v1 offset:44032
v_smfmac_f32_16x16x64_bf16 v[112:115], v[36:39], v[80:87], v2
ds_read_b128 v[80:83], v1 offset:57344
ds_read_b128 v[84:87], v1 offset:58368
v_smfmac_f32_16x16x64_bf16 v[116:119], v[36:39], v[88:95], v2
ds_read_b128 v[88:91], v1 offset:59392
ds_read_b128 v[92:95], v1 offset:60416
s_waitcnt lgkmcnt(6)
v_smfmac_f32_16x16x64_bf16 v[112:115], v[40:43], v[64:71], v2
ds_read_b128 v[64:67], v5 offset:8192
ds_read_b128 v[68:71], v5 offset:9216
s_waitcnt lgkmcnt(6)
v_smfmac_f32_16x16x64_bf16 v[116:119], v[40:43], v[72:79], v2
ds_read_b128 v[72:75], v5 offset:10240
ds_read_b128 v[76:79], v5 offset:11264
s_waitcnt lgkmcnt(6)
v_smfmac_f32_16x16x64_bf16 v[112:115], v[44:47], v[80:87], v2
ds_read_b128 v[80:83], v5 offset:24576
ds_read_b128 v[84:87], v5 offset:25600
s_waitcnt lgkmcnt(6)
v_smfmac_f32_16x16x64_bf16 v[116:119], v[44:47], v[88:95], v2
ds_read_b128 v[88:91], v5 offset:26624
ds_read_b128 v[92:95], v5 offset:27648
s_waitcnt lgkmcnt(6)
v_smfmac_f32_16x16x64_bf16 v[112:115], v[48:51], v[64:71], v2
ds_read_b128 v[64:67], v5 offset:40960
ds_read_b128 v[68:71], v5 offset:41984
s_waitcnt lgkmcnt(6)
v_smfmac_f32_16x16x64_bf16 v[116:119], v[48:51], v[72:79], v2
ds_read_b128 v[72:75], v5 offset:43008
ds_read_b128 v[76:79], v5 offset:44032
s_waitcnt lgkmcnt(6)
v_smfmac_f32_16x16x64_bf16 v[112:115], v[52:55], v[80:87], v2
ds_read_b128 v[80:83], v5 offset:57344
ds_read_b128 v[84:87], v5 offset:58368
s_waitcnt lgkmcnt(6)
v_smfmac_f32_16x16x64_bf16 v[116:119], v[52:55], v[88:95], v2
ds_read_b128 v[88:91], v5 offset:59392
ds_read_b128 v[92:95], v5 offset:60416
s_waitcnt lgkmcnt(6)
v_smfmac_f32_16x16x64_bf16 v[112:115], v[56:59], v[64:71], v2
s_waitcnt lgkmcnt(4)
v_smfmac_f32_16x16x64_bf16 v[116:119], v[56:59], v[72:79], v2
s_waitcnt lgkmcnt(2)
v_smfmac_f32_16x16x64_bf16 v[112:115], v[60:63], v[80:87], v2
s_waitcnt lgkmcnt(0)
v_smfmac_f32_16x16x64_bf16 v[116:119], v[60:63], v[88:95], v2
buffer_load_dwordx2 v[108:109], v11, s[4:7], s38 offen sc1
v_mfma_f32_16x16x16_bf16 v[100:103], v[96:97], v[16:17], 0
v_mfma_f32_16x16x16_bf16 v[104:107], v[98:99], v[16:17], 0
s_nop 4
v_add_f32 v112, v112, v114
v_add_f32 v113, v113, v115
v_add_f32 v114, v116, v118
v_add_f32 v115, v117, v119
v_cvt_pk_bf16_f32 v18, v112, v113
v_cvt_pk_bf16_f32 v19, v114, v115
v_and_or_b32 v18, v18, -2, s41
buffer_load_dwordx2 v[110:111], v11, s[4:7], s38 offen offset:512 sc1
s_barrier
buffer_store_dwordx2 v[18:19], v11, s[4:7], s39 offen sc1
v_mov_b32 v112, v18
v_mov_b32 v114, v19
v_mov_b32 v92, v28
v_mov_b32 v93, 0
s_waitcnt vmcnt(5)
s_barrier
ds_read_b128 v[32:35], v6 offset:19456
ds_read_b128 v[36:39], v6 offset:20480
ds_read_b128 v[40:43], v6 offset:24576
ds_read_b128 v[44:47], v6 offset:25600
ds_read_b128 v[48:51], v6 offset:9216
ds_read_b128 v[52:55], v6 offset:10240
ds_read_b128 v[56:59], v6 offset:14336
ds_read_b128 v[60:63], v6 offset:15360
buffer_load_dwordx2 v[20:21], v11, s[4:7], s38 offen sc1
buffer_load_dwordx2 v[22:23], v11, s[4:7], s38 offen offset:512 sc1
s_waitcnt vmcnt(4)
v_mfma_f32_16x16x16_bf16 v[80:83], v[108:109], v[16:17], v[100:103]
v_and_b32 v3, 1, v108
v_cmp_ne_u32 vcc, s41, v3
s_nop 5
v_cvt_pk_bf16_f32 v64, v80, v81
v_cvt_pk_bf16_f32 v65, v82, v83
s_cbranch_vccnz L_rs_w2_xslow
s_waitcnt vmcnt(3)
v_mfma_f32_16x16x16_bf16 v[84:87], v[110:111], v[16:17], v[104:107]
v_and_b32 v3, 1, v110
v_cmp_ne_u32 vcc, s41, v3
s_nop 5
v_cvt_pk_bf16_f32 v66, v84, v85
v_cvt_pk_bf16_f32 v67, v86, v87
ds_write_b128 v6, v[64:67] offset:18432
s_cbranch_vccnz L_rs_w2_xslow
L_rs_w2_xok:
s_cmp_eq_u32 s21, 63
s_cbranch_scc1 L_rs_w2_last
buffer_load_dwordx2 v[116:117], v11, s[4:7], s40 offen sc1
s_waitcnt lgkmcnt(1)
v_mfma_f32_16x16x32_bf16 v[80:83], v[32:35], v[64:67], 0
s_waitcnt lgkmcnt(0)
s_barrier
ds_read_b128 v[68:71], v6 offset:23552
ds_read_b128 v[72:75], v6 offset:8192
ds_read_b128 v[76:79], v6 offset:13312
v_mfma_f32_16x16x32_bf16 v[84:87], v[36:39], v[64:67], 0
v_mfma_f32_16x16x32_bf16 v[88:91], v[64:67], v[64:67], 0
buffer_load_dwordx2 v[20:21], v11, s[4:7], s40 offen sc1
s_waitcnt lgkmcnt(2)
v_mfma_f32_16x16x32_bf16 v[80:83], v[40:43], v[68:71], v[80:83]
s_waitcnt lgkmcnt(1)
v_mfma_f32_16x16x32_bf16 v[80:83], v[48:51], v[72:75], v[80:83]
s_waitcnt lgkmcnt(0)
v_mfma_f32_16x16x32_bf16 v[80:83], v[56:59], v[76:79], v[80:83]
buffer_store_dwordx4 v[64:67], v10, s[4:7], s45 offen offset:128 sc1
v_mfma_f32_16x16x32_bf16 v[84:87], v[44:47], v[68:71], v[84:87]
v_mfma_f32_16x16x32_bf16 v[84:87], v[52:55], v[72:75], v[84:87]
v_mfma_f32_16x16x32_bf16 v[84:87], v[60:63], v[76:79], v[84:87]
v_mfma_f32_16x16x32_bf16 v[88:91], v[68:71], v[68:71], v[88:91]
buffer_store_dwordx2 v[18:19], v11, s[4:7], s51 offen offset:3072 sc1
v_mfma_f32_16x16x32_bf16 v[88:91], v[72:75], v[72:75], v[88:91]
v_mfma_f32_16x16x32_bf16 v[88:91], v[76:79], v[76:79], v[88:91]
v_mfma_f32_32x32x4_2b_bf16 v[32:63], v[14:15], v[14:15], 0
s_nop 0
v_max3_f32 v4, v80, v81, v82
s_nop 1
v_max3_f32 v4, v4, v83, v84
v_max3_f32 v4, v4, v85, v86
v_max_f32 v4, v4, v87
v_max3_f32 v90, v4, v88, v89
v_max3_f32 v4, v4, v88, v89
s_nop 1
v_permlane16_swap_b32 v4, v90
v_max_f32 v4, v4, v90
v_max_f32 v90, v4, v90
s_nop 1
v_permlane32_swap_b32 v4, v90
v_max_f32 v4, v4, v90
v_mul_f32 v4, s34, v4
v_pk_fma_f32 v[80:81], v[80:81], s[34:35], v[4:5] op_sel_hi:[1,0,0] neg_lo:[0,0,1] neg_hi:[0,0,1]
v_pk_fma_f32 v[82:83], v[82:83], s[34:35], v[4:5] op_sel_hi:[1,0,0] neg_lo:[0,0,1] neg_hi:[0,0,1]
v_pk_fma_f32 v[84:85], v[84:85], s[34:35], v[4:5] op_sel_hi:[1,0,0] neg_lo:[0,0,1] neg_hi:[0,0,1]
v_pk_fma_f32 v[86:87], v[86:87], s[34:35], v[4:5] op_sel_hi:[1,0,0] neg_lo:[0,0,1] neg_hi:[0,0,1]
v_pk_fma_f32 v[88:89], v[88:89], s[34:35], v[4:5] op_sel_hi:[1,0,0] neg_lo:[0,0,1] neg_hi:[0,0,1]
v_exp_f32 v80, v80
v_exp_f32 v81, v81
v_exp_f32 v82, v82
v_cvt_pk_bf16_f32 v68, v80, v81
v_exp_f32 v83, v83
v_exp_f32 v84, v84
v_cvt_pk_bf16_f32 v69, v82, v83
v_exp_f32 v85, v85
v_exp_f32 v86, v86
v_cvt_pk_bf16_f32 v70, v84, v85
v_exp_f32 v87, v87
v_exp_f32 v88, v88
v_cvt_pk_bf16_f32 v71, v86, v87
v_exp_f32 v89, v89
s_waitcnt vmcnt(3)
v_mfma_f32_16x16x32_bf16 v[76:79], v[28:31], v[68:71], 0
v_and_b32 v3, 1, v116
v_cvt_pk_bf16_f32 v72, v88, v89
v_mfma_f32_16x16x32_bf16 v[100:103], v[120:123], v[68:71], 0
v_cmp_ne_u32 vcc, s41, v3
v_cvt_pk_bf16_f32 v73, v88, v89
v_mfma_f32_16x16x32_bf16 v[104:107], v[124:127], v[68:71], 0
v_mov_b32 v113, v116
v_mov_b32 v115, v117
v_mfma_f32_16x16x16_bf16 v[76:79], v[92:93], v[72:73], v[76:79]
s_cbranch_vccnz L_rs_w2_pv0
L_rs_w2_pv2:
v_mfma_f32_16x16x16_bf16 v[100:103], v[112:113], v[72:73], v[100:103]
v_mfma_f32_16x16x16_bf16 v[104:107], v[114:115], v[72:73], v[104:107]
buffer_load_dwordx4 v[120:123], v1, s[4:7], s44 offen
buffer_load_dwordx4 v[124:127], v1, s[4:7], s44 offen offset:1024
s_nop 2
v_rcp_f32 v76, v76
s_mov_b64 exec, s[28:29]
v_pk_mul_f32 v[100:101], v[100:101], v[76:77] op_sel_hi:[1,0]
v_pk_mul_f32 v[102:103], v[102:103], v[76:77] op_sel_hi:[1,0]
v_pk_mul_f32 v[104:105], v[104:105], v[76:77] op_sel_hi:[1,0]
v_pk_mul_f32 v[106:107], v[106:107], v[76:77] op_sel_hi:[1,0]
v_cvt_pk_bf16_f32 v84, v100, v101
v_cvt_pk_bf16_f32 v85, v102, v103
v_cvt_pk_bf16_f32 v86, v104, v105
v_cvt_pk_bf16_f32 v87, v106, v107
ds_write_b128 v6, v[84:87] offset:29664
s_mov_b64 exec, -1
s_waitcnt lgkmcnt(0)
s_barrier
ds_read_b128 v[68:71], v6 offset:28672
ds_read_b128 v[72:75], v6 offset:29696
s_waitcnt lgkmcnt(1)
v_smfmac_f32_16x16x64_bf16 v[32:35], v[68:71], v[128:135], v2
s_add_u32 s21, s21, 1
s_xor_b32 s38, s38, 1048576
s_xor_b32 s37, s37, 1048576
s_waitcnt lgkmcnt(0)
v_smfmac_f32_16x16x64_bf16 v[32:35], v[72:75], v[136:143], v2
s_xor_b32 s40, s40, 1048576
s_xor_b32 s39, s39, 1048576
s_lshr_b32 s41, s21, 1
v_smfmac_f32_16x16x64_bf16 v[36:39], v[68:71], v[144:151], v2
s_and_b32 s41, s41, 1
s_xor_b32 s41, s41, 1
s_xor_b32 s35, s35, 16384
v_smfmac_f32_16x16x64_bf16 v[36:39], v[72:75], v[152:159], v2
v_add_f32 v32, v32, v34
s_xor_b32 s36, s36, 16384
s_add_u32 s43, s43, 262144
s_add_u32 s44, s44, 262144
v_smfmac_f32_16x16x64_bf16 v[40:43], v[68:71], v[160:167], v2
v_add_f32 v33, v33, v35
v_smfmac_f32_16x16x64_bf16 v[40:43], v[72:75], v[168:175], v2
v_cvt_pk_bf16_f32 v32, v32, v33
v_smfmac_f32_16x16x64_bf16 v[44:47], v[68:71], v[176:183], v2
v_and_or_b32 v32, v32, -2, s42
v_smfmac_f32_16x16x64_bf16 v[44:47], v[72:75], v[184:191], v2
v_add_f32 v36, v36, v38
v_smfmac_f32_16x16x64_bf16 v[48:51], v[68:71], v[192:199], v2
v_add_f32 v37, v37, v39
v_smfmac_f32_16x16x64_bf16 v[48:51], v[72:75], v[200:207], v2
v_cvt_pk_bf16_f32 v33, v36, v37
v_smfmac_f32_16x16x64_bf16 v[52:55], v[68:71], v[208:215], v2
v_add_f32 v40, v40, v42
v_smfmac_f32_16x16x64_bf16 v[52:55], v[72:75], v[216:223], v2
v_add_f32 v41, v41, v43
v_smfmac_f32_16x16x64_bf16 v[56:59], v[68:71], v[224:231], v2
v_cvt_pk_bf16_f32 v34, v40, v41
v_smfmac_f32_16x16x64_bf16 v[56:59], v[72:75], v[232:239], v2
v_add_f32 v44, v44, v46
v_smfmac_f32_16x16x64_bf16 v[60:63], v[68:71], v[240:247], v2
v_add_f32 v45, v45, v47
v_smfmac_f32_16x16x64_bf16 v[60:63], v[72:75], v[248:255], v2
v_cvt_pk_bf16_f32 v35, v44, v45
buffer_store_dwordx4 v[32:35], v8, s[4:7], s46 offen sc1
v_pk_add_f32 v[48:49], v[48:49], v[50:51]
v_cvt_pk_bf16_f32 v48, v48, v49
v_and_or_b32 v48, v48, -2, s42
v_pk_add_f32 v[52:53], v[52:53], v[54:55]
v_cvt_pk_bf16_f32 v49, v52, v53
v_pk_add_f32 v[56:57], v[56:57], v[58:59]
v_cvt_pk_bf16_f32 v50, v56, v57
v_pk_add_f32 v[60:61], v[60:61], v[62:63]
v_cvt_pk_bf16_f32 v51, v60, v61
buffer_store_dwordx4 v[48:51], v8, s[4:7], s61 offen sc1
s_add_u32 s45, s45, 262144
s_add_u32 s51, s51, 262144
v_mfma_f32_32x32x8_bf16 v[96:111], v[14:15], v[14:15], 0
v_mfma_f32_16x16x16_bf16 v[112:115], v[14:15], v[14:15], 0
v_mfma_f32_16x16x16_bf16 v[116:119], v[14:15], v[14:15], 0
ds_read_b128 v[64:67], v1 offset:8192
ds_read_b128 v[68:71], v1 offset:9216
ds_read_b128 v[72:75], v1 offset:10240
ds_read_b128 v[76:79], v1 offset:11264
ds_read_b128 v[80:83], v1 offset:24576
ds_read_b128 v[84:87], v1 offset:25600
ds_read_b128 v[88:91], v1 offset:26624
ds_read_b128 v[92:95], v1 offset:27648
v_mov_b32 v58, -1
v_mov_b32 v59, -1
s_waitcnt vmcnt(0)
L_rs_w2_cgo:
L_rs_w2_pc:
buffer_load_dword v36, v13, s[4:7], s25 offen sc1
buffer_load_dword v37, v13, s[4:7], s25 offen offset:256 sc1
buffer_load_dword v38, v13, s[4:7], s25 offen offset:512 sc1
buffer_load_dword v39, v13, s[4:7], s25 offen offset:768 sc1
buffer_load_dword v40, v13, s[4:7], s25 offen offset:1024 sc1
buffer_load_dword v41, v13, s[4:7], s25 offen offset:1280 sc1
buffer_load_dword v42, v13, s[4:7], s25 offen offset:1536 sc1
buffer_load_dword v43, v13, s[4:7], s25 offen offset:1792 sc1
s_waitcnt vmcnt(4)
v_mfma_f32_16x16x32_bf16 v[52:55], v[36:39], v[24:27], 0
v_bitop3_b32 v3, s42, v36, v37 bitop3:0x7e
v_bitop3_b32 v4, s42, v38, v39 bitop3:0x7e
s_waitcnt vmcnt(2)
v_or_b32 v3, v3, v4
v_bitop3_b32 v4, s42, v40, v41 bitop3:0x7e
s_waitcnt vmcnt(0)
v_mfma_f32_16x16x32_bf16 v[52:55], v[40:43], v[24:27], v[52:55]
v_bitop3_b32 v56, s42, v42, v43 bitop3:0x7e
v_or3_b32 v3, v3, v4, v56
v_and_b32 v3, v0, v3
v_cmp_ne_u32 vcc, 0, v3
s_nop 3
v_cvt_pk_bf16_f32 v56, v52, v53
v_cvt_pk_bf16_f32 v57, v54, v55
v_min_u32 v56, -2, v56
s_cbranch_vccnz L_rs_w2_pc
s_mov_b64 exec, s[26:27]
buffer_store_dwordx2 v[56:57], v9, s[4:7], s35 offen offset:512 sc1
buffer_store_dwordx2 v[58:59], v9, s[4:7], s36 offen offset:512 sc1
s_mov_b64 exec, -1
s_xor_b32 s42, s42, 1
s_branch L_rs_w2_loop
L_rs_w2_last:
buffer_store_dwordx4 v[64:67], v10, s[4:7], s45 offen offset:128 sc1
buffer_store_dwordx2 v[18:19], v11, s[4:7], s51 offen offset:3072 sc1
s_branch L_rs_end
L_rs_w2_pafail:
s_nop 7
v_mov_b32 v96, 0
v_mov_b32 v97, 0
v_mov_b32 v98, 0
v_mov_b32 v99, 0
v_mov_b32 v100, 0
v_mov_b32 v101, 0
v_mov_b32 v102, 0
v_mov_b32 v103, 0
v_mov_b32 v104, 0
v_mov_b32 v105, 0
v_mov_b32 v106, 0
v_mov_b32 v107, 0
s_branch L_rs_w2_pa
L_rs_w2_xslow:
buffer_load_dwordx2 v[108:109], v11, s[4:7], s38 offen sc1
buffer_load_dwordx2 v[110:111], v11, s[4:7], s38 offen offset:512 sc1
s_waitcnt vmcnt(2)
v_bitop3_b32 v3, s41, v20, v22 bitop3:0x7e
v_mfma_f32_16x16x16_bf16 v[80:83], v[20:21], v[16:17], v[100:103]
v_and_b32 v3, 1, v3
v_mfma_f32_16x16x16_bf16 v[84:87], v[22:23], v[16:17], v[104:107]
v_cmp_ne_u32 vcc, 0, v3
s_cbranch_vccz L_rs_w2_xgot
buffer_load_dwordx2 v[20:21], v11, s[4:7], s38 offen sc1
buffer_load_dwordx2 v[22:23], v11, s[4:7], s38 offen offset:512 sc1
s_waitcnt vmcnt(2)
v_bitop3_b32 v3, s41, v108, v110 bitop3:0x7e
v_mfma_f32_16x16x16_bf16 v[80:83], v[108:109], v[16:17], v[100:103]
v_and_b32 v3, 1, v3
v_mfma_f32_16x16x16_bf16 v[84:87], v[110:111], v[16:17], v[104:107]
v_cmp_ne_u32 vcc, 0, v3
s_cbranch_vccz L_rs_w2_xgot
s_branch L_rs_w2_xslow
L_rs_w2_xgot:
s_nop 3
v_cvt_pk_bf16_f32 v64, v80, v81
v_cvt_pk_bf16_f32 v65, v82, v83
v_cvt_pk_bf16_f32 v66, v84, v85
v_cvt_pk_bf16_f32 v67, v86, v87
ds_write_b128 v6, v[64:67] offset:18432
s_branch L_rs_w2_xok
L_rs_w2_pv0:
s_waitcnt vmcnt(2)
s_branch L_rs_w2_pv1
L_rs_w2_pv:
buffer_load_dwordx2 v[20:21], v11, s[4:7], s40 offen sc1
s_waitcnt vmcnt(0)
L_rs_w2_pv1:
v_and_b32 v3, 1, v20
v_cmp_ne_u32 vcc, s41, v3
v_mov_b32 v113, v20
v_mov_b32 v115, v21
s_cbranch_vccnz L_rs_w2_pv
s_branch L_rs_w2_pv2
L_rs_w3_entry:
v_mfma_f32_32x32x8_bf16 v[96:111], v[14:15], v[14:15], 0
v_mfma_f32_16x16x16_bf16 v[112:115], v[14:15], v[14:15], 0
v_mfma_f32_16x16x16_bf16 v[116:119], v[14:15], v[14:15], 0
ds_read_b128 v[64:67], v1 offset:12288
ds_read_b128 v[68:71], v1 offset:13312
ds_read_b128 v[72:75], v1 offset:14336
ds_read_b128 v[76:79], v1 offset:15360
ds_read_b128 v[80:83], v1 offset:28672
ds_read_b128 v[84:87], v1 offset:29696
ds_read_b128 v[88:91], v1 offset:30720
ds_read_b128 v[92:95], v1 offset:31744
buffer_load_dwordx4 v[120:123], v1, s[4:7], s44 offen
buffer_load_dwordx4 v[124:127], v1, s[4:7], s44 offen offset:1024
s_add_u32 s44, s44, 262144
L_rs_w3_loop:
s_add_u32 s22, s35, 6144
s_waitcnt vmcnt(0)
buffer_load_dwordx4 v[56:59], v1, s[4:7], s22 offen sc1
buffer_load_dwordx4 v[60:63], v1, s[4:7], s22 offen offset:1024 sc1
L_rs_w3_pa:
s_waitcnt vmcnt(1)
ds_write_b128 v6, v[56:59] offset:6144
s_waitcnt vmcnt(0)
ds_write_b128 v6, v[60:63] offset:7168
v_max3_u32 v3, v56, v58, v60
v_max_u32 v3, v3, v62
v_cmp_eq_u32 vcc, -1, v3
v_smfmac_f32_16x16x64_bf16 v[96:99], v[56:59], a[96:103], v2
buffer_load_dwordx4 v[56:59], v1, s[4:7], s22 offen sc1
v_smfmac_f32_16x16x64_bf16 v[100:103], v[56:59], a[104:111], v2
buffer_load_dwordx4 v[60:63], v1, s[4:7], s22 offen offset:1024 sc1
v_smfmac_f32_16x16x64_bf16 v[104:107], v[56:59], a[224:231], v2
s_cbranch_vccnz L_rs_w3_pafail
s_waitcnt lgkmcnt(0)
s_barrier
ds_read_b128 v[32:35], v6
ds_read_b128 v[36:39], v6 offset:1024
v_smfmac_f32_16x16x64_bf16 v[108:111], v[56:59], a[232:239], v2
ds_read_b128 v[40:43], v6 offset:2048
v_smfmac_f32_16x16x64_bf16 v[96:99], v[60:63], a[112:119], v2
ds_read_b128 v[44:47], v6 offset:3072
v_smfmac_f32_16x16x64_bf16 v[100:103], v[60:63], a[120:127], v2
ds_read_b128 v[48:51], v6 offset:4096
v_smfmac_f32_16x16x64_bf16 v[104:107], v[60:63], a[240:247], v2
ds_read_b128 v[52:55], v6 offset:5120
v_smfmac_f32_16x16x64_bf16 v[108:111], v[60:63], a[248:255], v2
s_waitcnt lgkmcnt(5)
v_smfmac_f32_16x16x64_bf16 v[96:99], v[32:35], a[0:7], v2
v_smfmac_f32_16x16x64_bf16 v[104:107], v[32:35], a[128:135], v2
s_waitcnt lgkmcnt(4)
v_smfmac_f32_16x16x64_bf16 v[96:99], v[36:39], a[16:23], v2
buffer_load_dwordx4 v1, s[4:7], s43 offen lds
v_smfmac_f32_16x16x64_bf16 v[104:107], v[36:39], a[144:151], v2
s_waitcnt lgkmcnt(3)
v_smfmac_f32_16x16x64_bf16 v[96:99], v[40:43], a[32:39], v2
v_smfmac_f32_16x16x64_bf16 v[104:107], v[40:43], a[160:167], v2
s_waitcnt lgkmcnt(2)
v_smfmac_f32_16x16x64_bf16 v[96:99], v[44:47], a[48:55], v2
buffer_load_dwordx4 v1, s[4:7], s43 offen offset:1024 lds
v_smfmac_f32_16x16x64_bf16 v[104:107], v[44:47], a[176:183], v2
s_waitcnt lgkmcnt(1)
v_smfmac_f32_16x16x64_bf16 v[96:99], v[48:51], a[64:71], v2
v_smfmac_f32_16x16x64_bf16 v[104:107], v[48:51], a[192:199], v2
s_waitcnt lgkmcnt(0)
v_smfmac_f32_16x16x64_bf16 v[96:99], v[52:55], a[80:87], v2
buffer_load_dword v12, v7, s[4:7], 0 offen sc1
v_smfmac_f32_16x16x64_bf16 v[104:107], v[52:55], a[208:215], v2
v_smfmac_f32_16x16x64_bf16 v[100:103], v[32:35], a[8:15], v2
s_nop 2
v_smfmac_f32_16x16x64_bf16 v[100:103], v[36:39], a[24:31], v2
s_nop 1
v_add_f32 v96, v96, v98
v_smfmac_f32_16x16x64_bf16 v[100:103], v[40:43], a[40:47], v2
v_add_f32 v97, v97, v99
v_add_f32 v104, v104, v106
v_smfmac_f32_16x16x64_bf16 v[100:103], v[44:47], a[56:63], v2
v_add_f32 v105, v105, v107
v_cvt_pk_bf16_f32 v96, v96, v97
v_smfmac_f32_16x16x64_bf16 v[100:103], v[48:51], a[72:79], v2
v_cvt_pk_bf16_f32 v97, v104, v105
v_and_or_b32 v96, v96, -2, s41
v_smfmac_f32_16x16x64_bf16 v[100:103], v[52:55], a[88:95], v2
buffer_store_dwordx2 v[96:97], v11, s[4:7], s37 offen sc1
v_smfmac_f32_16x16x64_bf16 v[108:111], v[32:35], a[136:143], v2
v_smfmac_f32_16x16x64_bf16 v[108:111], v[36:39], a[152:159], v2
v_smfmac_f32_16x16x64_bf16 v[108:111], v[40:43], a[168:175], v2
v_smfmac_f32_16x16x64_bf16 v[108:111], v[44:47], a[184:191], v2
v_smfmac_f32_16x16x64_bf16 v[108:111], v[48:51], a[200:207], v2
s_nop 2
v_add_f32 v100, v100, v102
v_smfmac_f32_16x16x64_bf16 v[108:111], v[52:55], a[216:223], v2
v_add_f32 v101, v101, v103
v_cvt_pk_bf16_f32 v98, v100, v101
v_and_or_b32 v98, v98, -2, s41
s_nop 4
v_pk_add_f32 v[108:109], v[108:109], v[110:111]
v_cvt_pk_bf16_f32 v99, v108, v109
buffer_store_dwordx2 v[98:99], v11, s[4:7], s37 offen offset:512 sc1
v_smfmac_f32_16x16x64_bf16 v[112:115], v[32:35], v[64:71], v2
ds_read_b128 v[64:67], v1 offset:45056
ds_read_b128 v[68:71], v1 offset:46080
v_smfmac_f32_16x16x64_bf16 v[116:119], v[32:35], v[72:79], v2
ds_read_b128 v[72:75], v1 offset:47104
ds_read_b128 v[76:79], v1 offset:48128
v_smfmac_f32_16x16x64_bf16 v[112:115], v[36:39], v[80:87], v2
ds_read_b128 v[80:83], v1 offset:61440
ds_read_b128 v[84:87], v1 offset:62464
v_smfmac_f32_16x16x64_bf16 v[116:119], v[36:39], v[88:95], v2
ds_read_b128 v[88:91], v1 offset:63488
ds_read_b128 v[92:95], v1 offset:64512
s_waitcnt lgkmcnt(6)
v_smfmac_f32_16x16x64_bf16 v[112:115], v[40:43], v[64:71], v2
ds_read_b128 v[64:67], v5 offset:12288
ds_read_b128 v[68:71], v5 offset:13312
s_waitcnt lgkmcnt(6)
v_smfmac_f32_16x16x64_bf16 v[116:119], v[40:43], v[72:79], v2
ds_read_b128 v[72:75], v5 offset:14336
ds_read_b128 v[76:79], v5 offset:15360
s_waitcnt lgkmcnt(6)
v_smfmac_f32_16x16x64_bf16 v[112:115], v[44:47], v[80:87], v2
ds_read_b128 v[80:83], v5 offset:28672
ds_read_b128 v[84:87], v5 offset:29696
s_waitcnt lgkmcnt(6)
v_smfmac_f32_16x16x64_bf16 v[116:119], v[44:47], v[88:95], v2
ds_read_b128 v[88:91], v5 offset:30720
ds_read_b128 v[92:95], v5 offset:31744
s_waitcnt lgkmcnt(6)
v_smfmac_f32_16x16x64_bf16 v[112:115], v[48:51], v[64:71], v2
ds_read_b128 v[64:67], v5 offset:45056
ds_read_b128 v[68:71], v5 offset:46080
s_waitcnt lgkmcnt(6)
v_smfmac_f32_16x16x64_bf16 v[116:119], v[48:51], v[72:79], v2
ds_read_b128 v[72:75], v5 offset:47104
ds_read_b128 v[76:79], v5 offset:48128
s_waitcnt lgkmcnt(6)
v_smfmac_f32_16x16x64_bf16 v[112:115], v[52:55], v[80:87], v2
ds_read_b128 v[80:83], v5 offset:61440
ds_read_b128 v[84:87], v5 offset:62464
s_waitcnt lgkmcnt(6)
v_smfmac_f32_16x16x64_bf16 v[116:119], v[52:55], v[88:95], v2
ds_read_b128 v[88:91], v5 offset:63488
ds_read_b128 v[92:95], v5 offset:64512
s_waitcnt lgkmcnt(6)
v_smfmac_f32_16x16x64_bf16 v[112:115], v[56:59], v[64:71], v2
s_waitcnt lgkmcnt(4)
v_smfmac_f32_16x16x64_bf16 v[116:119], v[56:59], v[72:79], v2
s_waitcnt lgkmcnt(2)
v_smfmac_f32_16x16x64_bf16 v[112:115], v[60:63], v[80:87], v2
s_waitcnt lgkmcnt(0)
v_smfmac_f32_16x16x64_bf16 v[116:119], v[60:63], v[88:95], v2
buffer_load_dwordx2 v[108:109], v11, s[4:7], s38 offen sc1
v_mfma_f32_16x16x16_bf16 v[100:103], v[96:97], v[16:17], 0
v_mfma_f32_16x16x16_bf16 v[104:107], v[98:99], v[16:17], 0
s_nop 4
v_add_f32 v112, v112, v114
v_add_f32 v113, v113, v115
v_add_f32 v114, v116, v118
v_add_f32 v115, v117, v119
v_cvt_pk_bf16_f32 v18, v112, v113
v_cvt_pk_bf16_f32 v19, v114, v115
v_and_or_b32 v18, v18, -2, s41
buffer_load_dwordx2 v[110:111], v11, s[4:7], s38 offen offset:512 sc1
s_barrier
buffer_store_dwordx2 v[18:19], v11, s[4:7], s39 offen sc1
v_mov_b32 v112, v18
v_mov_b32 v114, v19
v_mov_b32 v92, v28
v_mov_b32 v93, 0
s_waitcnt vmcnt(6)
s_barrier
ds_read_b128 v[32:35], v6 offset:24576
ds_read_b128 v[36:39], v6 offset:25600
ds_read_b128 v[40:43], v6 offset:19456
ds_read_b128 v[44:47], v6 offset:20480
ds_read_b128 v[48:51], v6 offset:14336
ds_read_b128 v[52:55], v6 offset:15360
ds_read_b128 v[56:59], v6 offset:9216
ds_read_b128 v[60:63], v6 offset:10240
buffer_load_dwordx2 v[20:21], v11, s[4:7], s38 offen sc1
buffer_load_dwordx2 v[22:23], v11, s[4:7], s38 offen offset:512 sc1
s_waitcnt vmcnt(4)
v_mfma_f32_16x16x16_bf16 v[80:83], v[108:109], v[16:17], v[100:103]
v_and_b32 v3, 1, v108
v_cmp_ne_u32 vcc, s41, v3
s_nop 5
v_cvt_pk_bf16_f32 v64, v80, v81
v_cvt_pk_bf16_f32 v65, v82, v83
s_cbranch_vccnz L_rs_w3_xslow
s_waitcnt vmcnt(3)
v_mfma_f32_16x16x16_bf16 v[84:87], v[110:111], v[16:17], v[104:107]
v_and_b32 v3, 1, v110
v_cmp_ne_u32 vcc, s41, v3
s_nop 5
v_cvt_pk_bf16_f32 v66, v84, v85
v_cvt_pk_bf16_f32 v67, v86, v87
ds_write_b128 v6, v[64:67] offset:23552
s_cbranch_vccnz L_rs_w3_xslow
L_rs_w3_xok:
s_cmp_eq_u32 s21, 63
s_cbranch_scc1 L_rs_w3_last
buffer_load_dwordx2 v[116:117], v11, s[4:7], s40 offen sc1
s_waitcnt lgkmcnt(1)
v_mfma_f32_16x16x32_bf16 v[80:83], v[32:35], v[64:67], 0
s_waitcnt lgkmcnt(0)
s_barrier
ds_read_b128 v[68:71], v6 offset:18432
ds_read_b128 v[72:75], v6 offset:13312
ds_read_b128 v[76:79], v6 offset:8192
v_mfma_f32_16x16x32_bf16 v[84:87], v[36:39], v[64:67], 0
v_mfma_f32_16x16x32_bf16 v[88:91], v[64:67], v[64:67], 0
buffer_load_dwordx2 v[20:21], v11, s[4:7], s40 offen sc1
s_waitcnt lgkmcnt(2)
v_mfma_f32_16x16x32_bf16 v[80:83], v[40:43], v[68:71], v[80:83]
s_waitcnt lgkmcnt(1)
v_mfma_f32_16x16x32_bf16 v[80:83], v[48:51], v[72:75], v[80:83]
s_waitcnt lgkmcnt(0)
v_mfma_f32_16x16x32_bf16 v[80:83], v[56:59], v[76:79], v[80:83]
v_mfma_f32_16x16x32_bf16 v[84:87], v[44:47], v[68:71], v[84:87]
buffer_store_dwordx4 v[64:67], v10, s[4:7], s45 offen offset:192 sc1
v_mfma_f32_16x16x32_bf16 v[84:87], v[52:55], v[72:75], v[84:87]
v_mfma_f32_16x16x32_bf16 v[84:87], v[60:63], v[76:79], v[84:87]
v_mfma_f32_16x16x32_bf16 v[88:91], v[68:71], v[68:71], v[88:91]
v_mfma_f32_16x16x32_bf16 v[88:91], v[72:75], v[72:75], v[88:91]
buffer_store_dwordx2 v[18:19], v11, s[4:7], s51 offen offset:3584 sc1
v_mfma_f32_16x16x32_bf16 v[88:91], v[76:79], v[76:79], v[88:91]
v_mfma_f32_32x32x4_2b_bf16 v[32:63], v[14:15], v[14:15], 0
s_nop 0
v_max3_f32 v4, v80, v81, v82
s_nop 1
v_max3_f32 v4, v4, v83, v84
v_max3_f32 v4, v4, v85, v86
v_max_f32 v4, v4, v87
v_max3_f32 v90, v4, v88, v89
v_max3_f32 v4, v4, v88, v89
s_nop 1
v_permlane16_swap_b32 v4, v90
v_max_f32 v4, v4, v90
v_max_f32 v90, v4, v90
s_nop 1
v_permlane32_swap_b32 v4, v90
v_max_f32 v4, v4, v90
v_mul_f32 v4, s34, v4
v_pk_fma_f32 v[80:81], v[80:81], s[34:35], v[4:5] op_sel_hi:[1,0,0] neg_lo:[0,0,1] neg_hi:[0,0,1]
v_pk_fma_f32 v[82:83], v[82:83], s[34:35], v[4:5] op_sel_hi:[1,0,0] neg_lo:[0,0,1] neg_hi:[0,0,1]
v_pk_fma_f32 v[84:85], v[84:85], s[34:35], v[4:5] op_sel_hi:[1,0,0] neg_lo:[0,0,1] neg_hi:[0,0,1]
v_pk_fma_f32 v[86:87], v[86:87], s[34:35], v[4:5] op_sel_hi:[1,0,0] neg_lo:[0,0,1] neg_hi:[0,0,1]
v_pk_fma_f32 v[88:89], v[88:89], s[34:35], v[4:5] op_sel_hi:[1,0,0] neg_lo:[0,0,1] neg_hi:[0,0,1]
v_exp_f32 v80, v80
v_exp_f32 v81, v81
v_exp_f32 v82, v82
v_cvt_pk_bf16_f32 v68, v80, v81
v_exp_f32 v83, v83
v_exp_f32 v84, v84
v_cvt_pk_bf16_f32 v69, v82, v83
v_exp_f32 v85, v85
v_exp_f32 v86, v86
v_cvt_pk_bf16_f32 v70, v84, v85
v_exp_f32 v87, v87
v_exp_f32 v88, v88
v_cvt_pk_bf16_f32 v71, v86, v87
v_exp_f32 v89, v89
s_waitcnt vmcnt(3)
v_mfma_f32_16x16x32_bf16 v[76:79], v[28:31], v[68:71], 0
v_and_b32 v3, 1, v116
v_cvt_pk_bf16_f32 v72, v88, v89
v_mfma_f32_16x16x32_bf16 v[100:103], v[120:123], v[68:71], 0
v_cmp_ne_u32 vcc, s41, v3
v_cvt_pk_bf16_f32 v73, v88, v89
v_mfma_f32_16x16x32_bf16 v[104:107], v[124:127], v[68:71], 0
v_mov_b32 v113, v116
v_mov_b32 v115, v117
v_mfma_f32_16x16x16_bf16 v[76:79], v[92:93], v[72:73], v[76:79]
s_cbranch_vccnz L_rs_w3_pv0
L_rs_w3_pv2:
v_mfma_f32_16x16x16_bf16 v[100:103], v[112:113], v[72:73], v[100:103]
v_mfma_f32_16x16x16_bf16 v[104:107], v[114:115], v[72:73], v[104:107]
buffer_load_dwordx4 v[120:123], v1, s[4:7], s44 offen
buffer_load_dwordx4 v[124:127], v1, s[4:7], s44 offen offset:1024
s_nop 2
v_rcp_f32 v76, v76
s_mov_b64 exec, s[28:29]
v_pk_mul_f32 v[100:101], v[100:101], v[76:77] op_sel_hi:[1,0]
v_pk_mul_f32 v[102:103], v[102:103], v[76:77] op_sel_hi:[1,0]
v_pk_mul_f32 v[104:105], v[104:105], v[76:77] op_sel_hi:[1,0]
v_pk_mul_f32 v[106:107], v[106:107], v[76:77] op_sel_hi:[1,0]
v_cvt_pk_bf16_f32 v84, v100, v101
v_cvt_pk_bf16_f32 v85, v102, v103
v_cvt_pk_bf16_f32 v86, v104, v105
v_cvt_pk_bf16_f32 v87, v106, v107
ds_write_b128 v6, v[84:87] offset:29696
s_mov_b64 exec, -1
s_waitcnt lgkmcnt(0)
s_barrier
ds_read_b128 v[68:71], v6 offset:28672
ds_read_b128 v[72:75], v6 offset:29696
s_waitcnt lgkmcnt(1)
v_smfmac_f32_16x16x64_bf16 v[32:35], v[68:71], v[128:135], v2
s_add_u32 s21, s21, 1
s_xor_b32 s38, s38, 1048576
s_xor_b32 s37, s37, 1048576
s_waitcnt lgkmcnt(0)
v_smfmac_f32_16x16x64_bf16 v[32:35], v[72:75], v[136:143], v2
s_xor_b32 s40, s40, 1048576
s_xor_b32 s39, s39, 1048576
s_lshr_b32 s41, s21, 1
v_smfmac_f32_16x16x64_bf16 v[36:39], v[68:71], v[144:151], v2
s_and_b32 s41, s41, 1
s_xor_b32 s41, s41, 1
s_xor_b32 s35, s35, 16384
v_smfmac_f32_16x16x64_bf16 v[36:39], v[72:75], v[152:159], v2
v_add_f32 v32, v32, v34
s_xor_b32 s36, s36, 16384
s_add_u32 s43, s43, 262144
s_add_u32 s44, s44, 262144
v_smfmac_f32_16x16x64_bf16 v[40:43], v[68:71], v[160:167], v2
v_add_f32 v33, v33, v35
v_smfmac_f32_16x16x64_bf16 v[40:43], v[72:75], v[168:175], v2
v_cvt_pk_bf16_f32 v32, v32, v33
v_smfmac_f32_16x16x64_bf16 v[44:47], v[68:71], v[176:183], v2
v_and_or_b32 v32, v32, -2, s42
v_smfmac_f32_16x16x64_bf16 v[44:47], v[72:75], v[184:191], v2
v_add_f32 v36, v36, v38
v_smfmac_f32_16x16x64_bf16 v[48:51], v[68:71], v[192:199], v2
v_add_f32 v37, v37, v39
v_smfmac_f32_16x16x64_bf16 v[48:51], v[72:75], v[200:207], v2
v_cvt_pk_bf16_f32 v33, v36, v37
v_smfmac_f32_16x16x64_bf16 v[52:55], v[68:71], v[208:215], v2
v_add_f32 v40, v40, v42
v_smfmac_f32_16x16x64_bf16 v[52:55], v[72:75], v[216:223], v2
v_add_f32 v41, v41, v43
v_smfmac_f32_16x16x64_bf16 v[56:59], v[68:71], v[224:231], v2
v_cvt_pk_bf16_f32 v34, v40, v41
v_smfmac_f32_16x16x64_bf16 v[56:59], v[72:75], v[232:239], v2
v_add_f32 v44, v44, v46
v_smfmac_f32_16x16x64_bf16 v[60:63], v[68:71], v[240:247], v2
v_add_f32 v45, v45, v47
v_smfmac_f32_16x16x64_bf16 v[60:63], v[72:75], v[248:255], v2
v_cvt_pk_bf16_f32 v35, v44, v45
buffer_store_dwordx4 v[32:35], v8, s[4:7], s46 offen sc1
v_pk_add_f32 v[48:49], v[48:49], v[50:51]
v_cvt_pk_bf16_f32 v48, v48, v49
v_and_or_b32 v48, v48, -2, s42
v_pk_add_f32 v[52:53], v[52:53], v[54:55]
v_cvt_pk_bf16_f32 v49, v52, v53
v_pk_add_f32 v[56:57], v[56:57], v[58:59]
v_cvt_pk_bf16_f32 v50, v56, v57
v_pk_add_f32 v[60:61], v[60:61], v[62:63]
v_cvt_pk_bf16_f32 v51, v60, v61
buffer_store_dwordx4 v[48:51], v8, s[4:7], s61 offen sc1
s_add_u32 s45, s45, 262144
s_add_u32 s51, s51, 262144
v_mfma_f32_32x32x8_bf16 v[96:111], v[14:15], v[14:15], 0
v_mfma_f32_16x16x16_bf16 v[112:115], v[14:15], v[14:15], 0
v_mfma_f32_16x16x16_bf16 v[116:119], v[14:15], v[14:15], 0
ds_read_b128 v[64:67], v1 offset:12288
ds_read_b128 v[68:71], v1 offset:13312
ds_read_b128 v[72:75], v1 offset:14336
ds_read_b128 v[76:79], v1 offset:15360
ds_read_b128 v[80:83], v1 offset:28672
ds_read_b128 v[84:87], v1 offset:29696
ds_read_b128 v[88:91], v1 offset:30720
ds_read_b128 v[92:95], v1 offset:31744
s_add_u32 s22, s21, 2
s_cmp_gt_u32 s50, s22
s_cbranch_scc1 L_rs_w3_kvs
v_readlane_b32 s50, v12, 0
v_readlane_b32 s22, v12, 2
v_readlane_b32 s23, v12, 1
v_readlane_b32 s24, v12, 3
s_nop 3
s_min_u32 s50, s50, s22
s_min_u32 s23, s23, s24
s_lshl_b32 s50, s50, 1
s_lshl_b32 s23, s23, 1
s_add_u32 s23, s23, 1
s_min_u32 s50, s50, s23
L_rs_kvb1:
s_add_u32 s22, s21, 1
s_min_u32 s22, s22, 63
s_cmp_gt_u32 s50, s22
s_cbranch_scc1 L_rs_kvd1
buffer_load_dword v12, v7, s[4:7], 0 offen sc1
s_waitcnt vmcnt(0)
v_readlane_b32 s50, v12, 0
v_readlane_b32 s22, v12, 2
v_readlane_b32 s23, v12, 1
v_readlane_b32 s24, v12, 3
s_nop 3
s_min_u32 s50, s50, s22
s_min_u32 s23, s23, s24
s_lshl_b32 s50, s50, 1
s_lshl_b32 s23, s23, 1
s_add_u32 s23, s23, 1
s_min_u32 s50, s50, s23
s_branch L_rs_kvb1
L_rs_kvd1:
L_rs_w3_kvs:
v_mov_b32 v58, -1
v_mov_b32 v59, -1
s_waitcnt vmcnt(0)
L_rs_w3_cgo:
L_rs_w3_pc:
buffer_load_dword v36, v13, s[4:7], s25 offen sc1
buffer_load_dword v37, v13, s[4:7], s25 offen offset:256 sc1
buffer_load_dword v38, v13, s[4:7], s25 offen offset:512 sc1
buffer_load_dword v39, v13, s[4:7], s25 offen offset:768 sc1
buffer_load_dword v40, v13, s[4:7], s25 offen offset:1024 sc1
buffer_load_dword v41, v13, s[4:7], s25 offen offset:1280 sc1
buffer_load_dword v42, v13, s[4:7], s25 offen offset:1536 sc1
buffer_load_dword v43, v13, s[4:7], s25 offen offset:1792 sc1
s_waitcnt vmcnt(4)
v_mfma_f32_16x16x32_bf16 v[52:55], v[36:39], v[24:27], 0
v_bitop3_b32 v3, s42, v36, v37 bitop3:0x7e
v_bitop3_b32 v4, s42, v38, v39 bitop3:0x7e
s_waitcnt vmcnt(2)
v_or_b32 v3, v3, v4
v_bitop3_b32 v4, s42, v40, v41 bitop3:0x7e
s_waitcnt vmcnt(0)
v_mfma_f32_16x16x32_bf16 v[52:55], v[40:43], v[24:27], v[52:55]
v_bitop3_b32 v56, s42, v42, v43 bitop3:0x7e
v_or3_b32 v3, v3, v4, v56
v_and_b32 v3, v0, v3
v_cmp_ne_u32 vcc, 0, v3
s_nop 3
v_cvt_pk_bf16_f32 v56, v52, v53
v_cvt_pk_bf16_f32 v57, v54, v55
v_min_u32 v56, -2, v56
s_cbranch_vccnz L_rs_w3_pc
s_mov_b64 exec, s[26:27]
buffer_store_dwordx2 v[56:57], v9, s[4:7], s35 offen offset:768 sc1
buffer_store_dwordx2 v[58:59], v9, s[4:7], s36 offen offset:768 sc1
s_mov_b64 exec, -1
s_xor_b32 s42, s42, 1
s_branch L_rs_w3_loop
L_rs_w3_last:
buffer_store_dwordx4 v[64:67], v10, s[4:7], s45 offen offset:192 sc1
buffer_store_dwordx2 v[18:19], v11, s[4:7], s51 offen offset:3584 sc1
s_branch L_rs_end
L_rs_w3_pafail:
s_nop 7
v_mov_b32 v96, 0
v_mov_b32 v97, 0
v_mov_b32 v98, 0
v_mov_b32 v99, 0
v_mov_b32 v100, 0
v_mov_b32 v101, 0
v_mov_b32 v102, 0
v_mov_b32 v103, 0
v_mov_b32 v104, 0
v_mov_b32 v105, 0
v_mov_b32 v106, 0
v_mov_b32 v107, 0
s_branch L_rs_w3_pa
L_rs_w3_xslow:
buffer_load_dwordx2 v[108:109], v11, s[4:7], s38 offen sc1
buffer_load_dwordx2 v[110:111], v11, s[4:7], s38 offen offset:512 sc1
s_waitcnt vmcnt(2)
v_bitop3_b32 v3, s41, v20, v22 bitop3:0x7e
v_mfma_f32_16x16x16_bf16 v[80:83], v[20:21], v[16:17], v[100:103]
v_and_b32 v3, 1, v3
v_mfma_f32_16x16x16_bf16 v[84:87], v[22:23], v[16:17], v[104:107]
v_cmp_ne_u32 vcc, 0, v3
s_cbranch_vccz L_rs_w3_xgot
buffer_load_dwordx2 v[20:21], v11, s[4:7], s38 offen sc1
buffer_load_dwordx2 v[22:23], v11, s[4:7], s38 offen offset:512 sc1
s_waitcnt vmcnt(2)
v_bitop3_b32 v3, s41, v108, v110 bitop3:0x7e
v_mfma_f32_16x16x16_bf16 v[80:83], v[108:109], v[16:17], v[100:103]
v_and_b32 v3, 1, v3
v_mfma_f32_16x16x16_bf16 v[84:87], v[110:111], v[16:17], v[104:107]
v_cmp_ne_u32 vcc, 0, v3
s_cbranch_vccz L_rs_w3_xgot
s_branch L_rs_w3_xslow
L_rs_w3_xgot:
s_nop 3
v_cvt_pk_bf16_f32 v64, v80, v81
v_cvt_pk_bf16_f32 v65, v82, v83
v_cvt_pk_bf16_f32 v66, v84, v85
v_cvt_pk_bf16_f32 v67, v86, v87
ds_write_b128 v6, v[64:67] offset:23552
s_branch L_rs_w3_xok
L_rs_w3_pv0:
s_waitcnt vmcnt(2)
s_branch L_rs_w3_pv1
L_rs_w3_pv:
buffer_load_dwordx2 v[20:21], v11, s[4:7], s40 offen sc1
s_waitcnt vmcnt(0)
L_rs_w3_pv1:
v_and_b32 v3, 1, v20
v_cmp_ne_u32 vcc, s41, v3
v_mov_b32 v113, v20
v_mov_b32 v115, v21
s_cbranch_vccnz L_rs_w3_pv
s_branch L_rs_w3_pv2
L_rs_end:
s_mov_b64 exec, -1
v_mov_b32 v3, 64
s_waitcnt vmcnt(0)
s_barrier
s_cmp_lg_u32 s20, 0
s_cbranch_scc1 L_rs_end2
buffer_store_dword v3, v7, s[4:7], 0 offen sc1
L_rs_end2:
s_waitcnt vmcnt(0)
s_endpgm
L_bulk:
s_cmp_lt_u32 s92, 64
s_cbranch_scc1 L_fft
s_mov_b32 s29, 0
L_q_again:
s_load_dwordx2 s[8:9], s[0:1], 0
s_load_dwordx2 s[40:41], s[0:1], 16
s_load_dwordx2 s[42:43], s[0:1], 24
s_load_dwordx2 s[44:45], s[0:1], 32
v_lshrrev_b32 v2, 6, v0
v_and_b32 v1, 63, v0
v_readfirstlane_b32 s16, v2
s_lshr_b32 s17, s92, 6
s_lshr_b32 s20, s29, 5
s_sub_u32 s17, s17, s20
s_bfe_u32 s18, s92, 0x50001
s_and_b32 s19, s92, 1
s_waitcnt lgkmcnt(0)
s_mov_b32 s10, 4194304
s_mov_b32 s11, 0x00020000
s_cmp_eq_u32 s17, 1
s_cselect_b32 s12, s42, s40
s_cselect_b32 s13, s43, s41
s_cmp_eq_u32 s17, 2
s_cselect_b32 s12, s44, s12
s_cselect_b32 s13, s45, s13
s_mov_b32 s14, 8388608
s_mov_b32 s15, 0x00020000
v_lshrrev_b32 v2, 4, v1
v_and_b32 v3, 15, v1
v_lshlrev_b32 v4, 2, v2
v_xor_b32 v4, v4, v3
v_lshlrev_b32 v4, 4, v4
s_lshl_b32 s20, s16, 5
v_add_u32 v11, s20, v2
v_lshl_add_u32 v11, v11, 13, v4
s_lshl_b32 s20, s18, 8
v_add_u32 v11, s20, v11
s_lshl_b32 s22, s16, 13
s_lshl_b32 s27, s19, 23
s_and_b32 s27, s27, 4194304
s_add_u32 m0, s22, 0
s_xor_b32 s20, s27, 0
buffer_load_dwordx4 v11, s[12:15], s20 offen lds
s_add_u32 m0, s22, 1024
s_xor_b32 s20, s27, 32768
buffer_load_dwordx4 v11, s[12:15], s20 offen lds
s_add_u32 m0, s22, 2048
s_xor_b32 s20, s27, 65536
buffer_load_dwordx4 v11, s[12:15], s20 offen lds
s_add_u32 m0, s22, 3072
s_xor_b32 s20, s27, 98304
buffer_load_dwordx4 v11, s[12:15], s20 offen lds
s_add_u32 m0, s22, 4096
s_xor_b32 s20, s27, 131072
buffer_load_dwordx4 v11, s[12:15], s20 offen lds
s_add_u32 m0, s22, 5120
s_xor_b32 s20, s27, 163840
buffer_load_dwordx4 v11, s[12:15], s20 offen lds
s_add_u32 m0, s22, 6144
s_xor_b32 s20, s27, 196608
buffer_load_dwordx4 v11, s[12:15], s20 offen lds
s_add_u32 m0, s22, 7168
s_xor_b32 s20, s27, 229376
buffer_load_dwordx4 v11, s[12:15], s20 offen lds
s_waitcnt vmcnt(8)
s_barrier
s_or_b32 s81, s97, s98
s_cmp_lg_u32 s81, 0
s_cbranch_scc1 L_h0_3
s_lshl_b32 s81, s93, 5
v_mov_b32 v38, 1
s_mov_b64 exec, 1
buffer_atomic_add v38, off, s[88:91], s81 sc1
s_mov_b64 exec, -1
L_h0_3:
s_add_u32 m0, s22, 32768
s_xor_b32 s20, s27, 1048576
buffer_load_dwordx4 v11, s[12:15], s20 offen lds
s_add_u32 m0, s22, 33792
s_xor_b32 s20, s27, 1081344
buffer_load_dwordx4 v11, s[12:15], s20 offen lds
s_add_u32 m0, s22, 34816
s_xor_b32 s20, s27, 1114112
buffer_load_dwordx4 v11, s[12:15], s20 offen lds
s_add_u32 m0, s22, 35840
s_xor_b32 s20, s27, 1146880
buffer_load_dwordx4 v11, s[12:15], s20 offen lds
s_add_u32 m0, s22, 36864
s_xor_b32 s20, s27, 1179648
buffer_load_dwordx4 v11, s[12:15], s20 offen lds
s_add_u32 m0, s22, 37888
s_xor_b32 s20, s27, 1212416
buffer_load_dwordx4 v11, s[12:15], s20 offen lds
s_add_u32 m0, s22, 38912
s_xor_b32 s20, s27, 1245184
buffer_load_dwordx4 v11, s[12:15], s20 offen lds
s_add_u32 m0, s22, 39936
s_xor_b32 s20, s27, 1277952
buffer_load_dwordx4 v11, s[12:15], s20 offen lds
s_add_u32 m0, s22, 65536
s_xor_b32 s20, s27, 2097152
buffer_load_dwordx4 v11, s[12:15], s20 offen lds
s_add_u32 m0, s22, 66560
s_xor_b32 s20, s27, 2129920
buffer_load_dwordx4 v11, s[12:15], s20 offen lds
s_add_u32 m0, s22, 67584
s_xor_b32 s20, s27, 2162688
buffer_load_dwordx4 v11, s[12:15], s20 offen lds
s_add_u32 m0, s22, 68608
s_xor_b32 s20, s27, 2195456
buffer_load_dwordx4 v11, s[12:15], s20 offen lds
s_add_u32 m0, s22, 69632
s_xor_b32 s20, s27, 2228224
buffer_load_dwordx4 v11, s[12:15], s20 offen lds
s_add_u32 m0, s22, 70656
s_xor_b32 s20, s27, 2260992
buffer_load_dwordx4 v11, s[12:15], s20 offen lds
s_add_u32 m0, s22, 71680
s_xor_b32 s20, s27, 2293760
buffer_load_dwordx4 v11, s[12:15], s20 offen lds
s_add_u32 m0, s22, 72704
s_xor_b32 s20, s27, 2326528
buffer_load_dwordx4 v11, s[12:15], s20 offen lds
s_add_u32 m0, s22, 98304
s_xor_b32 s20, s27, 3145728
buffer_load_dwordx4 v11, s[12:15], s20 offen lds
s_add_u32 m0, s22, 99328
s_xor_b32 s20, s27, 3178496
buffer_load_dwordx4 v11, s[12:15], s20 offen lds
s_add_u32 m0, s22, 100352
s_xor_b32 s20, s27, 3211264
buffer_load_dwordx4 v11, s[12:15], s20 offen lds
s_add_u32 m0, s22, 101376
s_xor_b32 s20, s27, 3244032
buffer_load_dwordx4 v11, s[12:15], s20 offen lds
s_add_u32 m0, s22, 102400
s_xor_b32 s20, s27, 3276800
buffer_load_dwordx4 v11, s[12:15], s20 offen lds
s_add_u32 m0, s22, 103424
s_xor_b32 s20, s27, 3309568
buffer_load_dwordx4 v11, s[12:15], s20 offen lds
s_add_u32 m0, s22, 104448
s_xor_b32 s20, s27, 3342336
buffer_load_dwordx4 v11, s[12:15], s20 offen lds
s_add_u32 m0, s22, 105472
s_xor_b32 s20, s27, 3375104
buffer_load_dwordx4 v11, s[12:15], s20 offen lds
v_and_b32 v3, 3, v1
v_bfe_u32 v14, v1, 2, 2
v_xor_b32 v15, s16, v14
v_lshlrev_b32 v15, 6, v15
v_lshl_add_u32 v15, v3, 4, v15
v_lshl_add_u32 v13, v2, 3, v14
v_lshl_add_u32 v12, v13, 8, v15
v_and_b32 v3, 15, v1
s_lshl_b32 s20, s16, 3
v_add_u32 v13, s20, v2
v_add_u32 v13, 0, v13
v_and_b32 v14, 15, v13
v_xor_b32 v14, v14, v3
v_lshlrev_b32 v14, 4, v14
v_lshl_add_u32 v6, v13, 11, v14
v_add_u32 v13, s20, v2
v_add_u32 v13, 4, v13
v_and_b32 v14, 15, v13
v_xor_b32 v14, v14, v3
v_lshlrev_b32 v14, 4, v14
v_lshl_add_u32 v7, v13, 11, v14
v_xor_b32 v14, v2, v3
v_lshlrev_b32 v14, 4, v14
v_lshl_add_u32 v13, v3, 8, v14
v_xor_b32 v16, 0, v13
v_add_u32 v20, 0x10000, v16
v_xor_b32 v17, 64, v13
v_add_u32 v21, 0x10000, v17
v_xor_b32 v18, 128, v13
v_add_u32 v22, 0x10000, v18
v_xor_b32 v19, 192, v13
v_add_u32 v23, 0x10000, v19
v_lshlrev_b32 v8, 4, v1
v_bfrev_b32 v13, 1
s_lshl_b32 s20, s92, 7
s_add_u32 s20, s20, 71303168
v_mov_b32 v14, s20
v_cmp_eq_u32 vcc, 0, v0
s_lshl_b32 s24, s17, 24
s_lshl_b32 s20, s19, 18
v_cndmask_b32 v9, v13, v14, vcc
s_add_u32 s24, s24, s20
s_lshl_b32 s20, s18, 13
s_add_u32 s24, s24, s20
s_lshl_b32 s20, s16, 11
s_add_u32 s24, s24, s20
s_add_u32 s24, s24, 0
s_lshl_b32 s23, s19, 16
s_lshr_b32 s20, s27, 12
s_add_u32 s23, s23, s20
v_mov_b32 v10, s29
s_lshl_b32 s21, s16, 11
s_waitcnt vmcnt(24)
s_barrier
v_add_u32 v13, 0, v12
ds_read_b64_tr_b16 a[0:1], v13
ds_read_b64_tr_b16 a[2:3], v13 offset:1024
ds_read_b64_tr_b16 a[4:5], v13 offset:8
ds_read_b64_tr_b16 a[6:7], v13 offset:1032
ds_read_b64_tr_b16 a[8:9], v13 offset:8192
ds_read_b64_tr_b16 a[10:11], v13 offset:9216
ds_read_b64_tr_b16 a[12:13], v13 offset:8200
ds_read_b64_tr_b16 a[14:15], v13 offset:9224
s_waitcnt lgkmcnt(0)
ds_read_b64_tr_b16 a[16:17], v13 offset:16384
ds_read_b64_tr_b16 a[18:19], v13 offset:17408
ds_read_b64_tr_b16 a[20:21], v13 offset:16392
ds_read_b64_tr_b16 a[22:23], v13 offset:17416
ds_read_b64_tr_b16 a[24:25], v13 offset:24576
ds_read_b64_tr_b16 a[26:27], v13 offset:25600
ds_read_b64_tr_b16 a[28:29], v13 offset:24584
ds_read_b64_tr_b16 a[30:31], v13 offset:25608
s_waitcnt lgkmcnt(0)
s_barrier
s_add_u32 m0, s22, 0
s_xor_b32 s20, s27, 4194304
buffer_load_dwordx4 v11, s[12:15], s20 offen lds
s_add_u32 m0, s22, 1024
s_xor_b32 s20, s27, 4227072
buffer_load_dwordx4 v11, s[12:15], s20 offen lds
s_add_u32 m0, s22, 2048
s_xor_b32 s20, s27, 4259840
buffer_load_dwordx4 v11, s[12:15], s20 offen lds
s_add_u32 m0, s22, 3072
s_xor_b32 s20, s27, 4292608
buffer_load_dwordx4 v11, s[12:15], s20 offen lds
s_add_u32 m0, s22, 4096
s_xor_b32 s20, s27, 4325376
buffer_load_dwordx4 v11, s[12:15], s20 offen lds
s_add_u32 m0, s22, 5120
s_xor_b32 s20, s27, 4358144
buffer_load_dwordx4 v11, s[12:15], s20 offen lds
s_add_u32 m0, s22, 6144
s_xor_b32 s20, s27, 4390912
buffer_load_dwordx4 v11, s[12:15], s20 offen lds
s_add_u32 m0, s22, 7168
s_xor_b32 s20, s27, 4423680
buffer_load_dwordx4 v11, s[12:15], s20 offen lds
s_waitcnt vmcnt(24)
s_barrier
v_add_u32 v13, 32768, v12
ds_read_b64_tr_b16 a[32:33], v13
ds_read_b64_tr_b16 a[34:35], v13 offset:1024
ds_read_b64_tr_b16 a[36:37], v13 offset:8
ds_read_b64_tr_b16 a[38:39], v13 offset:1032
ds_read_b64_tr_b16 a[40:41], v13 offset:8192
ds_read_b64_tr_b16 a[42:43], v13 offset:9216
ds_read_b64_tr_b16 a[44:45], v13 offset:8200
ds_read_b64_tr_b16 a[46:47], v13 offset:9224
s_waitcnt lgkmcnt(0)
ds_read_b64_tr_b16 a[48:49], v13 offset:16384
ds_read_b64_tr_b16 a[50:51], v13 offset:17408
ds_read_b64_tr_b16 a[52:53], v13 offset:16392
ds_read_b64_tr_b16 a[54:55], v13 offset:17416
ds_read_b64_tr_b16 a[56:57], v13 offset:24576
ds_read_b64_tr_b16 a[58:59], v13 offset:25600
ds_read_b64_tr_b16 a[60:61], v13 offset:24584
ds_read_b64_tr_b16 a[62:63], v13 offset:25608
s_waitcnt lgkmcnt(0)
s_barrier
s_add_u32 m0, s22, 32768
s_xor_b32 s20, s27, 5242880
buffer_load_dwordx4 v11, s[12:15], s20 offen lds
s_add_u32 m0, s22, 33792
s_xor_b32 s20, s27, 5275648
buffer_load_dwordx4 v11, s[12:15], s20 offen lds
s_add_u32 m0, s22, 34816
s_xor_b32 s20, s27, 5308416
buffer_load_dwordx4 v11, s[12:15], s20 offen lds
s_add_u32 m0, s22, 35840
s_xor_b32 s20, s27, 5341184
buffer_load_dwordx4 v11, s[12:15], s20 offen lds
s_add_u32 m0, s22, 36864
s_xor_b32 s20, s27, 5373952
buffer_load_dwordx4 v11, s[12:15], s20 offen lds
s_add_u32 m0, s22, 37888
s_xor_b32 s20, s27, 5406720
buffer_load_dwordx4 v11, s[12:15], s20 offen lds
s_add_u32 m0, s22, 38912
s_xor_b32 s20, s27, 5439488
buffer_load_dwordx4 v11, s[12:15], s20 offen lds
s_add_u32 m0, s22, 39936
s_xor_b32 s20, s27, 5472256
buffer_load_dwordx4 v11, s[12:15], s20 offen lds
s_waitcnt vmcnt(24)
s_barrier
v_add_u32 v13, 65536, v12
ds_read_b64_tr_b16 a[64:65], v13
ds_read_b64_tr_b16 a[66:67], v13 offset:1024
ds_read_b64_tr_b16 a[68:69], v13 offset:8
ds_read_b64_tr_b16 a[70:71], v13 offset:1032
ds_read_b64_tr_b16 a[72:73], v13 offset:8192
ds_read_b64_tr_b16 a[74:75], v13 offset:9216
ds_read_b64_tr_b16 a[76:77], v13 offset:8200
ds_read_b64_tr_b16 a[78:79], v13 offset:9224
s_waitcnt lgkmcnt(0)
ds_read_b64_tr_b16 a[80:81], v13 offset:16384
ds_read_b64_tr_b16 a[82:83], v13 offset:17408
ds_read_b64_tr_b16 a[84:85], v13 offset:16392
ds_read_b64_tr_b16 a[86:87], v13 offset:17416
ds_read_b64_tr_b16 a[88:89], v13 offset:24576
ds_read_b64_tr_b16 a[90:91], v13 offset:25600
ds_read_b64_tr_b16 a[92:93], v13 offset:24584
ds_read_b64_tr_b16 a[94:95], v13 offset:25608
s_waitcnt lgkmcnt(0)
s_barrier
s_add_u32 m0, s22, 65536
s_xor_b32 s20, s27, 6291456
buffer_load_dwordx4 v11, s[12:15], s20 offen lds
s_add_u32 m0, s22, 66560
s_xor_b32 s20, s27, 6324224
buffer_load_dwordx4 v11, s[12:15], s20 offen lds
s_add_u32 m0, s22, 67584
s_xor_b32 s20, s27, 6356992
buffer_load_dwordx4 v11, s[12:15], s20 offen lds
s_add_u32 m0, s22, 68608
s_xor_b32 s20, s27, 6389760
buffer_load_dwordx4 v11, s[12:15], s20 offen lds
s_add_u32 m0, s22, 69632
s_xor_b32 s20, s27, 6422528
buffer_load_dwordx4 v11, s[12:15], s20 offen lds
s_add_u32 m0, s22, 70656
s_xor_b32 s20, s27, 6455296
buffer_load_dwordx4 v11, s[12:15], s20 offen lds
s_add_u32 m0, s22, 71680
s_xor_b32 s20, s27, 6488064
buffer_load_dwordx4 v11, s[12:15], s20 offen lds
s_add_u32 m0, s22, 72704
s_xor_b32 s20, s27, 6520832
buffer_load_dwordx4 v11, s[12:15], s20 offen lds
s_waitcnt vmcnt(24)
s_barrier
v_and_b32 v37, 7, v0
v_lshlrev_b32 v37, 5, v37
buffer_load_dword v36, v37, s[88:91], 0 offen sc1
v_add_u32 v13, 98304, v12
ds_read_b64_tr_b16 a[96:97], v13
ds_read_b64_tr_b16 a[98:99], v13 offset:1024
ds_read_b64_tr_b16 a[100:101], v13 offset:8
ds_read_b64_tr_b16 a[102:103], v13 offset:1032
ds_read_b64_tr_b16 a[104:105], v13 offset:8192
ds_read_b64_tr_b16 a[106:107], v13 offset:9216
ds_read_b64_tr_b16 a[108:109], v13 offset:8200
ds_read_b64_tr_b16 a[110:111], v13 offset:9224
s_waitcnt lgkmcnt(0)
ds_read_b64_tr_b16 a[112:113], v13 offset:16384
ds_read_b64_tr_b16 a[114:115], v13 offset:17408
ds_read_b64_tr_b16 a[116:117], v13 offset:16392
ds_read_b64_tr_b16 a[118:119], v13 offset:17416
ds_read_b64_tr_b16 a[120:121], v13 offset:24576
ds_read_b64_tr_b16 a[122:123], v13 offset:25600
ds_read_b64_tr_b16 a[124:125], v13 offset:24584
ds_read_b64_tr_b16 a[126:127], v13 offset:25608
s_waitcnt lgkmcnt(0)
s_barrier
s_add_u32 m0, s22, 98304
s_xor_b32 s20, s27, 7340032
buffer_load_dwordx4 v11, s[12:15], s20 offen lds
s_add_u32 m0, s22, 99328
s_xor_b32 s20, s27, 7372800
buffer_load_dwordx4 v11, s[12:15], s20 offen lds
s_add_u32 m0, s22, 100352
s_xor_b32 s20, s27, 7405568
buffer_load_dwordx4 v11, s[12:15], s20 offen lds
s_add_u32 m0, s22, 101376
s_xor_b32 s20, s27, 7438336
buffer_load_dwordx4 v11, s[12:15], s20 offen lds
s_add_u32 m0, s22, 102400
s_xor_b32 s20, s27, 7471104
buffer_load_dwordx4 v11, s[12:15], s20 offen lds
s_add_u32 m0, s22, 103424
s_xor_b32 s20, s27, 7503872
buffer_load_dwordx4 v11, s[12:15], s20 offen lds
s_add_u32 m0, s22, 104448
s_xor_b32 s20, s27, 7536640
buffer_load_dwordx4 v11, s[12:15], s20 offen lds
s_add_u32 m0, s22, 105472
s_xor_b32 s20, s27, 7569408
buffer_load_dwordx4 v11, s[12:15], s20 offen lds
s_waitcnt vmcnt(24)
s_barrier
v_add_u32 v13, 0, v12
ds_read_b64_tr_b16 a[128:129], v13
ds_read_b64_tr_b16 a[130:131], v13 offset:1024
ds_read_b64_tr_b16 a[132:133], v13 offset:8
ds_read_b64_tr_b16 a[134:135], v13 offset:1032
ds_read_b64_tr_b16 a[136:137], v13 offset:8192
ds_read_b64_tr_b16 a[138:139], v13 offset:9216
ds_read_b64_tr_b16 a[140:141], v13 offset:8200
ds_read_b64_tr_b16 a[142:143], v13 offset:9224
s_waitcnt lgkmcnt(0)
ds_read_b64_tr_b16 a[144:145], v13 offset:16384
ds_read_b64_tr_b16 a[146:147], v13 offset:17408
ds_read_b64_tr_b16 a[148:149], v13 offset:16392
ds_read_b64_tr_b16 a[150:151], v13 offset:17416
ds_read_b64_tr_b16 a[152:153], v13 offset:24576
ds_read_b64_tr_b16 a[154:155], v13 offset:25600
ds_read_b64_tr_b16 a[156:157], v13 offset:24584
ds_read_b64_tr_b16 a[158:159], v13 offset:25608
s_waitcnt lgkmcnt(0)
s_barrier
s_add_u32 m0, s21, 0
s_xor_b32 s20, s23, 0
buffer_load_dwordx4 v6, s[8:11], s20 offen lds
s_add_u32 m0, s21, 1024
s_xor_b32 s20, s23, 0
buffer_load_dwordx4 v7, s[8:11], s20 offen lds
s_add_u32 m0, s21, 8192
s_xor_b32 s20, s23, 256
buffer_load_dwordx4 v6, s[8:11], s20 offen lds
s_add_u32 m0, s21, 9216
s_xor_b32 s20, s23, 256
buffer_load_dwordx4 v7, s[8:11], s20 offen lds
s_add_u32 m0, s21, 16384
s_xor_b32 s20, s23, 512
buffer_load_dwordx4 v6, s[8:11], s20 offen lds
s_add_u32 m0, s21, 17408
s_xor_b32 s20, s23, 512
buffer_load_dwordx4 v7, s[8:11], s20 offen lds
s_add_u32 m0, s21, 24576
s_xor_b32 s20, s23, 768
buffer_load_dwordx4 v6, s[8:11], s20 offen lds
s_add_u32 m0, s21, 25600
s_xor_b32 s20, s23, 768
buffer_load_dwordx4 v7, s[8:11], s20 offen lds
s_waitcnt vmcnt(24)
s_barrier
v_add_u32 v13, 32768, v12
ds_read_b64_tr_b16 a[160:161], v13
ds_read_b64_tr_b16 a[162:163], v13 offset:1024
ds_read_b64_tr_b16 a[164:165], v13 offset:8
ds_read_b64_tr_b16 a[166:167], v13 offset:1032
ds_read_b64_tr_b16 a[168:169], v13 offset:8192
ds_read_b64_tr_b16 a[170:171], v13 offset:9216
ds_read_b64_tr_b16 a[172:173], v13 offset:8200
ds_read_b64_tr_b16 a[174:175], v13 offset:9224
s_waitcnt lgkmcnt(0)
ds_read_b64_tr_b16 a[176:177], v13 offset:16384
ds_read_b64_tr_b16 a[178:179], v13 offset:17408
ds_read_b64_tr_b16 a[180:181], v13 offset:16392
ds_read_b64_tr_b16 a[182:183], v13 offset:17416
ds_read_b64_tr_b16 a[184:185], v13 offset:24576
ds_read_b64_tr_b16 a[186:187], v13 offset:25600
ds_read_b64_tr_b16 a[188:189], v13 offset:24584
ds_read_b64_tr_b16 a[190:191], v13 offset:25608
s_waitcnt lgkmcnt(0)
s_barrier
s_add_u32 m0, s21, 32768
s_xor_b32 s20, s23, 1024
buffer_load_dwordx4 v6, s[8:11], s20 offen lds
s_add_u32 m0, s21, 33792
s_xor_b32 s20, s23, 1024
buffer_load_dwordx4 v7, s[8:11], s20 offen lds
s_add_u32 m0, s21, 40960
s_xor_b32 s20, s23, 1280
buffer_load_dwordx4 v6, s[8:11], s20 offen lds
s_add_u32 m0, s21, 41984
s_xor_b32 s20, s23, 1280
buffer_load_dwordx4 v7, s[8:11], s20 offen lds
s_add_u32 m0, s21, 49152
s_xor_b32 s20, s23, 1536
buffer_load_dwordx4 v6, s[8:11], s20 offen lds
s_add_u32 m0, s21, 50176
s_xor_b32 s20, s23, 1536
buffer_load_dwordx4 v7, s[8:11], s20 offen lds
s_add_u32 m0, s21, 57344
s_xor_b32 s20, s23, 1792
buffer_load_dwordx4 v6, s[8:11], s20 offen lds
s_add_u32 m0, s21, 58368
s_xor_b32 s20, s23, 1792
buffer_load_dwordx4 v7, s[8:11], s20 offen lds
s_waitcnt vmcnt(24)
s_barrier
v_add_u32 v13, 65536, v12
ds_read_b64_tr_b16 a[192:193], v13
ds_read_b64_tr_b16 a[194:195], v13 offset:1024
ds_read_b64_tr_b16 a[196:197], v13 offset:8
ds_read_b64_tr_b16 a[198:199], v13 offset:1032
ds_read_b64_tr_b16 a[200:201], v13 offset:8192
ds_read_b64_tr_b16 a[202:203], v13 offset:9216
ds_read_b64_tr_b16 a[204:205], v13 offset:8200
ds_read_b64_tr_b16 a[206:207], v13 offset:9224
s_waitcnt lgkmcnt(0)
ds_read_b64_tr_b16 a[208:209], v13 offset:16384
ds_read_b64_tr_b16 a[210:211], v13 offset:17408
ds_read_b64_tr_b16 a[212:213], v13 offset:16392
ds_read_b64_tr_b16 a[214:215], v13 offset:17416
ds_read_b64_tr_b16 a[216:217], v13 offset:24576
ds_read_b64_tr_b16 a[218:219], v13 offset:25600
ds_read_b64_tr_b16 a[220:221], v13 offset:24584
ds_read_b64_tr_b16 a[222:223], v13 offset:25608
s_waitcnt lgkmcnt(0)
s_barrier
s_add_u32 s23, s23, 131072
s_add_u32 m0, s21, 65536
s_xor_b32 s20, s23, 0
buffer_load_dwordx4 v6, s[8:11], s20 offen lds
s_add_u32 m0, s21, 66560
s_xor_b32 s20, s23, 0
buffer_load_dwordx4 v7, s[8:11], s20 offen lds
s_add_u32 m0, s21, 73728
s_xor_b32 s20, s23, 256
buffer_load_dwordx4 v6, s[8:11], s20 offen lds
s_add_u32 m0, s21, 74752
s_xor_b32 s20, s23, 256
buffer_load_dwordx4 v7, s[8:11], s20 offen lds
s_add_u32 m0, s21, 81920
s_xor_b32 s20, s23, 512
buffer_load_dwordx4 v6, s[8:11], s20 offen lds
s_add_u32 m0, s21, 82944
s_xor_b32 s20, s23, 512
buffer_load_dwordx4 v7, s[8:11], s20 offen lds
s_add_u32 m0, s21, 90112
s_xor_b32 s20, s23, 768
buffer_load_dwordx4 v6, s[8:11], s20 offen lds
s_add_u32 m0, s21, 91136
s_xor_b32 s20, s23, 768
buffer_load_dwordx4 v7, s[8:11], s20 offen lds
s_waitcnt vmcnt(24)
s_barrier
s_cmp_lg_u32 s97, 0
s_cbranch_scc1 L_h2_4_ok
L_h2_4_ev:
v_cmp_ne_u32 vcc, 32, v36
s_cbranch_vccz L_h2_4_ok
s_mov_b32 s78, 0
v_readlane_b32 s81, v36, 0
s_nop 3
s_add_u32 s78, s78, s81
v_readlane_b32 s81, v36, 1
s_nop 3
s_add_u32 s78, s78, s81
v_readlane_b32 s81, v36, 2
s_nop 3
s_add_u32 s78, s78, s81
v_readlane_b32 s81, v36, 3
s_nop 3
s_add_u32 s78, s78, s81
v_readlane_b32 s81, v36, 4
s_nop 3
s_add_u32 s78, s78, s81
v_readlane_b32 s81, v36, 5
s_nop 3
s_add_u32 s78, s78, s81
v_readlane_b32 s81, v36, 6
s_nop 3
s_add_u32 s78, s78, s81
v_readlane_b32 s81, v36, 7
s_nop 3
s_add_u32 s78, s78, s81
s_cmp_eq_u32 s78, 256
s_cbranch_scc1 L_redo
buffer_load_dword v36, v37, s[88:91], 0 offen sc1
s_waitcnt vmcnt(0)
s_branch L_h2_4_ev
L_h2_4_ok:
s_mov_b32 s97, 1
v_add_u32 v13, 98304, v12
ds_read_b64_tr_b16 a[224:225], v13
ds_read_b64_tr_b16 a[226:227], v13 offset:1024
ds_read_b64_tr_b16 a[228:229], v13 offset:8
ds_read_b64_tr_b16 a[230:231], v13 offset:1032
ds_read_b64_tr_b16 a[232:233], v13 offset:8192
ds_read_b64_tr_b16 a[234:235], v13 offset:9216
ds_read_b64_tr_b16 a[236:237], v13 offset:8200
ds_read_b64_tr_b16 a[238:239], v13 offset:9224
s_waitcnt lgkmcnt(0)
ds_read_b64_tr_b16 a[240:241], v13 offset:16384
ds_read_b64_tr_b16 a[242:243], v13 offset:17408
ds_read_b64_tr_b16 a[244:245], v13 offset:16392
ds_read_b64_tr_b16 a[246:247], v13 offset:17416
ds_read_b64_tr_b16 a[248:249], v13 offset:24576
ds_read_b64_tr_b16 a[250:251], v13 offset:25600
ds_read_b64_tr_b16 a[252:253], v13 offset:24584
ds_read_b64_tr_b16 a[254:255], v13 offset:25608
s_waitcnt lgkmcnt(0)
s_barrier
s_waitcnt vmcnt(16)
s_barrier
s_cmp_eq_u32 s17, 2
s_cbranch_scc1 L_q_v
ds_read_b128 v[32:35], v16
ds_read_b128 v[36:39], v16 offset:4096
ds_read_b128 v[40:43], v17
ds_read_b128 v[44:47], v17 offset:4096
ds_read_b128 v[48:51], v18
ds_read_b128 v[52:55], v18 offset:4096
s_mov_b32 s25, 0
L_q_qk_loop:
s_waitcnt lgkmcnt(5)
v_mfma_f32_16x16x32_bf16 v[64:67], a[0:3], v[32:35], 0
ds_read_b128 v[56:59], v19
v_mfma_f32_16x16x32_bf16 v[68:71], a[4:7], v[32:35], 0
s_waitcnt lgkmcnt(5)
v_mfma_f32_16x16x32_bf16 v[72:75], a[0:3], v[36:39], 0
ds_read_b128 v[60:63], v19 offset:4096
v_mfma_f32_16x16x32_bf16 v[76:79], a[4:7], v[36:39], 0
s_waitcnt lgkmcnt(5)
v_mfma_f32_16x16x32_bf16 v[64:67], a[8:11], v[40:43], v[64:67]
ds_read_b128 v[32:35], v16 offset:8192
v_mfma_f32_16x16x32_bf16 v[68:71], a[12:15], v[40:43], v[68:71]
s_cmp_eq_u32 s25, 0
s_cbranch_scc1 L_q_qk_sk2
s_add_u32 m0, s21, 74752
s_xor_b32 s20, s23, 256
buffer_load_dwordx4 v7, s[8:11], s20 offen lds
L_q_qk_sk2:
s_waitcnt lgkmcnt(5)
v_mfma_f32_16x16x32_bf16 v[72:75], a[8:11], v[44:47], v[72:75]
ds_read_b128 v[36:39], v16 offset:12288
v_mfma_f32_16x16x32_bf16 v[76:79], a[12:15], v[44:47], v[76:79]
s_waitcnt lgkmcnt(5)
v_mfma_f32_16x16x32_bf16 v[64:67], a[16:19], v[48:51], v[64:67]
ds_read_b128 v[40:43], v17 offset:8192
v_mfma_f32_16x16x32_bf16 v[68:71], a[20:23], v[48:51], v[68:71]
s_waitcnt lgkmcnt(5)
v_mfma_f32_16x16x32_bf16 v[72:75], a[16:19], v[52:55], v[72:75]
ds_read_b128 v[44:47], v17 offset:12288
v_mfma_f32_16x16x32_bf16 v[76:79], a[20:23], v[52:55], v[76:79]
s_cmp_eq_u32 s25, 0
s_cbranch_scc1 L_q_qk_sk5
s_add_u32 m0, s21, 81920
s_xor_b32 s20, s23, 512
buffer_load_dwordx4 v6, s[8:11], s20 offen lds
L_q_qk_sk5:
s_waitcnt lgkmcnt(5)
v_mfma_f32_16x16x32_bf16 v[64:67], a[24:27], v[56:59], v[64:67]
ds_read_b128 v[48:51], v18 offset:8192
v_mfma_f32_16x16x32_bf16 v[68:71], a[28:31], v[56:59], v[68:71]
s_waitcnt lgkmcnt(5)
v_mfma_f32_16x16x32_bf16 v[72:75], a[24:27], v[60:63], v[72:75]
ds_read_b128 v[52:55], v18 offset:12288
v_mfma_f32_16x16x32_bf16 v[76:79], a[28:31], v[60:63], v[76:79]
s_waitcnt lgkmcnt(5)
v_mfma_f32_16x16x32_bf16 v[64:67], a[32:35], v[32:35], v[64:67]
ds_read_b128 v[56:59], v19 offset:8192
v_mfma_f32_16x16x32_bf16 v[68:71], a[36:39], v[32:35], v[68:71]
s_cmp_eq_u32 s25, 0
s_cbranch_scc1 L_q_qk_sk8
s_add_u32 m0, s21, 82944
s_xor_b32 s20, s23, 512
buffer_load_dwordx4 v7, s[8:11], s20 offen lds
L_q_qk_sk8:
s_waitcnt lgkmcnt(5)
v_mfma_f32_16x16x32_bf16 v[72:75], a[32:35], v[36:39], v[72:75]
ds_read_b128 v[60:63], v19 offset:12288
v_mfma_f32_16x16x32_bf16 v[76:79], a[36:39], v[36:39], v[76:79]
s_waitcnt lgkmcnt(5)
v_mfma_f32_16x16x32_bf16 v[64:67], a[40:43], v[40:43], v[64:67]
ds_read_b128 v[32:35], v16 offset:16384
v_mfma_f32_16x16x32_bf16 v[68:71], a[44:47], v[40:43], v[68:71]
s_waitcnt lgkmcnt(5)
v_mfma_f32_16x16x32_bf16 v[72:75], a[40:43], v[44:47], v[72:75]
ds_read_b128 v[36:39], v16 offset:20480
v_mfma_f32_16x16x32_bf16 v[76:79], a[44:47], v[44:47], v[76:79]
s_cmp_eq_u32 s25, 0
s_cbranch_scc1 L_q_qk_sk11
s_add_u32 m0, s21, 90112
s_xor_b32 s20, s23, 768
buffer_load_dwordx4 v6, s[8:11], s20 offen lds
L_q_qk_sk11:
s_waitcnt lgkmcnt(5)
v_mfma_f32_16x16x32_bf16 v[64:67], a[48:51], v[48:51], v[64:67]
ds_read_b128 v[40:43], v17 offset:16384
v_mfma_f32_16x16x32_bf16 v[68:71], a[52:55], v[48:51], v[68:71]
s_waitcnt lgkmcnt(5)
v_mfma_f32_16x16x32_bf16 v[72:75], a[48:51], v[52:55], v[72:75]
ds_read_b128 v[44:47], v17 offset:20480
v_mfma_f32_16x16x32_bf16 v[76:79], a[52:55], v[52:55], v[76:79]
s_waitcnt lgkmcnt(5)
v_mfma_f32_16x16x32_bf16 v[64:67], a[56:59], v[56:59], v[64:67]
ds_read_b128 v[48:51], v18 offset:16384
v_mfma_f32_16x16x32_bf16 v[68:71], a[60:63], v[56:59], v[68:71]
s_cmp_eq_u32 s25, 0
s_cbranch_scc1 L_q_qk_sk14
s_add_u32 m0, s21, 91136
s_xor_b32 s20, s23, 768
buffer_load_dwordx4 v7, s[8:11], s20 offen lds
L_q_qk_sk14:
s_waitcnt lgkmcnt(5)
v_mfma_f32_16x16x32_bf16 v[72:75], a[56:59], v[60:63], v[72:75]
ds_read_b128 v[52:55], v18 offset:20480
v_mfma_f32_16x16x32_bf16 v[76:79], a[60:63], v[60:63], v[76:79]
s_cmp_eq_u32 s25, 0
s_cbranch_scc1 L_q_qk_ne0
v_cvt_pk_bf16_f32 v96, v80, v81
v_cvt_pk_bf16_f32 v97, v82, v83
L_q_qk_ne0:
s_waitcnt lgkmcnt(5)
v_mfma_f32_16x16x32_bf16 v[64:67], a[64:67], v[32:35], v[64:67]
ds_read_b128 v[56:59], v19 offset:16384
v_mfma_f32_16x16x32_bf16 v[68:71], a[68:71], v[32:35], v[68:71]
s_cmp_eq_u32 s25, 0
s_cbranch_scc1 L_q_qk_ne1
v_cvt_pk_bf16_f32 v98, v84, v85
v_cvt_pk_bf16_f32 v99, v86, v87
L_q_qk_ne1:
s_waitcnt lgkmcnt(5)
v_mfma_f32_16x16x32_bf16 v[72:75], a[64:67], v[36:39], v[72:75]
ds_read_b128 v[60:63], v19 offset:20480
v_mfma_f32_16x16x32_bf16 v[76:79], a[68:71], v[36:39], v[76:79]
s_cmp_eq_u32 s25, 0
s_cbranch_scc1 L_q_qk_ne2
buffer_store_dwordx4 v[96:99], v8, s[84:87], s24 offen sc1
v_cvt_pk_bf16_f32 v100, v88, v89
L_q_qk_ne2:
s_waitcnt lgkmcnt(5)
v_mfma_f32_16x16x32_bf16 v[64:67], a[72:75], v[40:43], v[64:67]
ds_read_b128 v[32:35], v16 offset:24576
v_mfma_f32_16x16x32_bf16 v[68:71], a[76:79], v[40:43], v[68:71]
s_cmp_eq_u32 s25, 0
s_cbranch_scc1 L_q_qk_ne3
v_cvt_pk_bf16_f32 v101, v90, v91
v_cvt_pk_bf16_f32 v102, v92, v93
L_q_qk_ne3:
s_waitcnt lgkmcnt(5)
v_mfma_f32_16x16x32_bf16 v[72:75], a[72:75], v[44:47], v[72:75]
ds_read_b128 v[36:39], v16 offset:28672
v_mfma_f32_16x16x32_bf16 v[76:79], a[76:79], v[44:47], v[76:79]
s_cmp_eq_u32 s25, 0
s_cbranch_scc1 L_q_qk_ne4
v_cvt_pk_bf16_f32 v103, v94, v95
buffer_store_dwordx4 v[100:103], v8, s[84:87], s24 offen offset:1024 sc1
L_q_qk_ne4:
s_waitcnt lgkmcnt(5)
v_mfma_f32_16x16x32_bf16 v[64:67], a[80:83], v[48:51], v[64:67]
ds_read_b128 v[40:43], v17 offset:24576
v_mfma_f32_16x16x32_bf16 v[68:71], a[84:87], v[48:51], v[68:71]
s_cmp_eq_u32 s25, 0
s_cbranch_scc1 L_q_qk_ne5
s_add_u32 s24, s24, 524288
L_q_qk_ne5:
s_waitcnt lgkmcnt(5)
v_mfma_f32_16x16x32_bf16 v[72:75], a[80:83], v[52:55], v[72:75]
ds_read_b128 v[44:47], v17 offset:28672
v_mfma_f32_16x16x32_bf16 v[76:79], a[84:87], v[52:55], v[76:79]
s_waitcnt lgkmcnt(5)
v_mfma_f32_16x16x32_bf16 v[64:67], a[88:91], v[56:59], v[64:67]
ds_read_b128 v[48:51], v18 offset:24576
v_mfma_f32_16x16x32_bf16 v[68:71], a[92:95], v[56:59], v[68:71]
s_cmp_lg_u32 s25, 2
s_cbranch_scc1 L_q_qk_nx
v_lshlrev_b32 v242, 7, v0
s_mul_i32 s46, s92, 32768
s_sub_u32 s46, s46, 2097152
buffer_load_dword v240, v242, s[8:11], s46 offen
L_q_qk_nx:
s_waitcnt lgkmcnt(5)
v_mfma_f32_16x16x32_bf16 v[72:75], a[88:91], v[60:63], v[72:75]
ds_read_b128 v[52:55], v18 offset:28672
v_mfma_f32_16x16x32_bf16 v[76:79], a[92:95], v[60:63], v[76:79]
s_waitcnt vmcnt(8)
s_barrier
s_waitcnt lgkmcnt(5)
v_mfma_f32_16x16x32_bf16 v[64:67], a[96:99], v[32:35], v[64:67]
ds_read_b128 v[56:59], v19 offset:24576
v_mfma_f32_16x16x32_bf16 v[68:71], a[100:103], v[32:35], v[68:71]
s_waitcnt lgkmcnt(5)
v_mfma_f32_16x16x32_bf16 v[72:75], a[96:99], v[36:39], v[72:75]
ds_read_b128 v[60:63], v19 offset:28672
v_mfma_f32_16x16x32_bf16 v[76:79], a[100:103], v[36:39], v[76:79]
s_add_u32 m0, s21, 98304
s_xor_b32 s20, s23, 1024
buffer_load_dwordx4 v6, s[8:11], s20 offen lds
s_waitcnt lgkmcnt(5)
v_mfma_f32_16x16x32_bf16 v[64:67], a[104:107], v[40:43], v[64:67]
ds_read_b128 v[32:35], v16 offset:32768
v_mfma_f32_16x16x32_bf16 v[68:71], a[108:111], v[40:43], v[68:71]
s_waitcnt lgkmcnt(5)
v_mfma_f32_16x16x32_bf16 v[72:75], a[104:107], v[44:47], v[72:75]
ds_read_b128 v[36:39], v16 offset:36864
v_mfma_f32_16x16x32_bf16 v[76:79], a[108:111], v[44:47], v[76:79]
s_waitcnt lgkmcnt(5)
v_mfma_f32_16x16x32_bf16 v[64:67], a[112:115], v[48:51], v[64:67]
ds_read_b128 v[40:43], v17 offset:32768
v_mfma_f32_16x16x32_bf16 v[68:71], a[116:119], v[48:51], v[68:71]
s_add_u32 m0, s21, 99328
s_xor_b32 s20, s23, 1024
buffer_load_dwordx4 v7, s[8:11], s20 offen lds
s_waitcnt lgkmcnt(5)
v_mfma_f32_16x16x32_bf16 v[72:75], a[112:115], v[52:55], v[72:75]
ds_read_b128 v[44:47], v17 offset:36864
v_mfma_f32_16x16x32_bf16 v[76:79], a[116:119], v[52:55], v[76:79]
s_waitcnt lgkmcnt(5)
v_mfma_f32_16x16x32_bf16 v[64:67], a[120:123], v[56:59], v[64:67]
ds_read_b128 v[48:51], v18 offset:32768
v_mfma_f32_16x16x32_bf16 v[68:71], a[124:127], v[56:59], v[68:71]
s_waitcnt lgkmcnt(5)
v_mfma_f32_16x16x32_bf16 v[72:75], a[120:123], v[60:63], v[72:75]
ds_read_b128 v[52:55], v18 offset:36864
v_mfma_f32_16x16x32_bf16 v[76:79], a[124:127], v[60:63], v[76:79]
s_add_u32 m0, s21, 106496
s_xor_b32 s20, s23, 1280
buffer_load_dwordx4 v6, s[8:11], s20 offen lds
s_waitcnt lgkmcnt(5)
v_mfma_f32_16x16x32_bf16 v[64:67], a[128:131], v[32:35], v[64:67]
ds_read_b128 v[56:59], v19 offset:32768
v_mfma_f32_16x16x32_bf16 v[68:71], a[132:135], v[32:35], v[68:71]
s_waitcnt lgkmcnt(5)
v_mfma_f32_16x16x32_bf16 v[72:75], a[128:131], v[36:39], v[72:75]
ds_read_b128 v[60:63], v19 offset:36864
v_mfma_f32_16x16x32_bf16 v[76:79], a[132:135], v[36:39], v[76:79]
s_waitcnt lgkmcnt(5)
v_mfma_f32_16x16x32_bf16 v[64:67], a[136:139], v[40:43], v[64:67]
ds_read_b128 v[32:35], v16 offset:40960
v_mfma_f32_16x16x32_bf16 v[68:71], a[140:143], v[40:43], v[68:71]
s_add_u32 m0, s21, 107520
s_xor_b32 s20, s23, 1280
buffer_load_dwordx4 v7, s[8:11], s20 offen lds
s_waitcnt lgkmcnt(5)
v_mfma_f32_16x16x32_bf16 v[72:75], a[136:139], v[44:47], v[72:75]
ds_read_b128 v[36:39], v16 offset:45056
v_mfma_f32_16x16x32_bf16 v[76:79], a[140:143], v[44:47], v[76:79]
s_waitcnt lgkmcnt(5)
v_mfma_f32_16x16x32_bf16 v[64:67], a[144:147], v[48:51], v[64:67]
ds_read_b128 v[40:43], v17 offset:40960
v_mfma_f32_16x16x32_bf16 v[68:71], a[148:151], v[48:51], v[68:71]
s_waitcnt lgkmcnt(5)
v_mfma_f32_16x16x32_bf16 v[72:75], a[144:147], v[52:55], v[72:75]
ds_read_b128 v[44:47], v17 offset:45056
v_mfma_f32_16x16x32_bf16 v[76:79], a[148:151], v[52:55], v[76:79]
s_add_u32 m0, s21, 114688
s_xor_b32 s20, s23, 1536
buffer_load_dwordx4 v6, s[8:11], s20 offen lds
s_waitcnt lgkmcnt(5)
v_mfma_f32_16x16x32_bf16 v[64:67], a[152:155], v[56:59], v[64:67]
ds_read_b128 v[48:51], v18 offset:40960
v_mfma_f32_16x16x32_bf16 v[68:71], a[156:159], v[56:59], v[68:71]
s_waitcnt lgkmcnt(5)
v_mfma_f32_16x16x32_bf16 v[72:75], a[152:155], v[60:63], v[72:75]
ds_read_b128 v[52:55], v18 offset:45056
v_mfma_f32_16x16x32_bf16 v[76:79], a[156:159], v[60:63], v[76:79]
s_waitcnt lgkmcnt(5)
v_mfma_f32_16x16x32_bf16 v[64:67], a[160:163], v[32:35], v[64:67]
ds_read_b128 v[56:59], v19 offset:40960
v_mfma_f32_16x16x32_bf16 v[68:71], a[164:167], v[32:35], v[68:71]
s_add_u32 m0, s21, 115712
s_xor_b32 s20, s23, 1536
buffer_load_dwordx4 v7, s[8:11], s20 offen lds
s_waitcnt lgkmcnt(5)
v_mfma_f32_16x16x32_bf16 v[72:75], a[160:163], v[36:39], v[72:75]
ds_read_b128 v[60:63], v19 offset:45056
v_mfma_f32_16x16x32_bf16 v[76:79], a[164:167], v[36:39], v[76:79]
s_waitcnt lgkmcnt(5)
v_mfma_f32_16x16x32_bf16 v[64:67], a[168:171], v[40:43], v[64:67]
ds_read_b128 v[32:35], v16 offset:49152
v_mfma_f32_16x16x32_bf16 v[68:71], a[172:175], v[40:43], v[68:71]
s_waitcnt lgkmcnt(5)
v_mfma_f32_16x16x32_bf16 v[72:75], a[168:171], v[44:47], v[72:75]
ds_read_b128 v[36:39], v16 offset:53248
v_mfma_f32_16x16x32_bf16 v[76:79], a[172:175], v[44:47], v[76:79]
s_add_u32 m0, s21, 122880
s_xor_b32 s20, s23, 1792
buffer_load_dwordx4 v6, s[8:11], s20 offen lds
s_waitcnt lgkmcnt(5)
v_mfma_f32_16x16x32_bf16 v[64:67], a[176:179], v[48:51], v[64:67]
ds_read_b128 v[40:43], v17 offset:49152
v_mfma_f32_16x16x32_bf16 v[68:71], a[180:183], v[48:51], v[68:71]
s_waitcnt lgkmcnt(5)
v_mfma_f32_16x16x32_bf16 v[72:75], a[176:179], v[52:55], v[72:75]
ds_read_b128 v[44:47], v17 offset:53248
v_mfma_f32_16x16x32_bf16 v[76:79], a[180:183], v[52:55], v[76:79]
s_waitcnt lgkmcnt(5)
v_mfma_f32_16x16x32_bf16 v[64:67], a[184:187], v[56:59], v[64:67]
ds_read_b128 v[48:51], v18 offset:49152
v_mfma_f32_16x16x32_bf16 v[68:71], a[188:191], v[56:59], v[68:71]
s_add_u32 m0, s21, 123904
s_xor_b32 s20, s23, 1792
buffer_load_dwordx4 v7, s[8:11], s20 offen lds
s_waitcnt lgkmcnt(5)
v_mfma_f32_16x16x32_bf16 v[72:75], a[184:187], v[60:63], v[72:75]
ds_read_b128 v[52:55], v18 offset:53248
v_mfma_f32_16x16x32_bf16 v[76:79], a[188:191], v[60:63], v[76:79]
s_waitcnt lgkmcnt(5)
v_mfma_f32_16x16x32_bf16 v[64:67], a[192:195], v[32:35], v[64:67]
ds_read_b128 v[56:59], v19 offset:49152
v_mfma_f32_16x16x32_bf16 v[68:71], a[196:199], v[32:35], v[68:71]
s_waitcnt lgkmcnt(5)
v_mfma_f32_16x16x32_bf16 v[72:75], a[192:195], v[36:39], v[72:75]
ds_read_b128 v[60:63], v19 offset:53248
v_mfma_f32_16x16x32_bf16 v[76:79], a[196:199], v[36:39], v[76:79]
s_waitcnt lgkmcnt(5)
v_mfma_f32_16x16x32_bf16 v[64:67], a[200:203], v[40:43], v[64:67]
ds_read_b128 v[32:35], v16 offset:57344
v_mfma_f32_16x16x32_bf16 v[68:71], a[204:207], v[40:43], v[68:71]
s_waitcnt lgkmcnt(5)
v_mfma_f32_16x16x32_bf16 v[72:75], a[200:203], v[44:47], v[72:75]
ds_read_b128 v[36:39], v16 offset:61440
v_mfma_f32_16x16x32_bf16 v[76:79], a[204:207], v[44:47], v[76:79]
s_waitcnt lgkmcnt(5)
v_mfma_f32_16x16x32_bf16 v[64:67], a[208:211], v[48:51], v[64:67]
ds_read_b128 v[40:43], v17 offset:57344
v_mfma_f32_16x16x32_bf16 v[68:71], a[212:215], v[48:51], v[68:71]
s_waitcnt lgkmcnt(5)
v_mfma_f32_16x16x32_bf16 v[72:75], a[208:211], v[52:55], v[72:75]
ds_read_b128 v[44:47], v17 offset:61440
v_mfma_f32_16x16x32_bf16 v[76:79], a[212:215], v[52:55], v[76:79]
s_waitcnt lgkmcnt(5)
v_mfma_f32_16x16x32_bf16 v[64:67], a[216:219], v[56:59], v[64:67]
ds_read_b128 v[48:51], v18 offset:57344
v_mfma_f32_16x16x32_bf16 v[68:71], a[220:223], v[56:59], v[68:71]
s_waitcnt lgkmcnt(5)
v_mfma_f32_16x16x32_bf16 v[72:75], a[216:219], v[60:63], v[72:75]
ds_read_b128 v[52:55], v18 offset:61440
v_mfma_f32_16x16x32_bf16 v[76:79], a[220:223], v[60:63], v[76:79]
s_waitcnt vmcnt(8)
s_barrier
s_waitcnt lgkmcnt(5)
v_mfma_f32_16x16x32_bf16 v[64:67], a[224:227], v[32:35], v[64:67]
ds_read_b128 v[56:59], v19 offset:57344
v_mfma_f32_16x16x32_bf16 v[68:71], a[228:231], v[32:35], v[68:71]
s_waitcnt lgkmcnt(5)
v_mfma_f32_16x16x32_bf16 v[72:75], a[224:227], v[36:39], v[72:75]
ds_read_b128 v[60:63], v19 offset:61440
v_mfma_f32_16x16x32_bf16 v[76:79], a[228:231], v[36:39], v[76:79]
s_add_u32 s23, s23, 131072
s_add_u32 m0, s21, 0
s_xor_b32 s20, s23, 0
buffer_load_dwordx4 v6, s[8:11], s20 offen lds
s_waitcnt lgkmcnt(5)
v_mfma_f32_16x16x32_bf16 v[64:67], a[232:235], v[40:43], v[64:67]
ds_read_b128 v[32:35], v20
v_mfma_f32_16x16x32_bf16 v[68:71], a[236:239], v[40:43], v[68:71]
s_cmp_eq_u32 s25, 0
s_cbranch_scc1 L_q_qk_nf
v_add_u32 v10, 1, v10
buffer_store_dword v10, v9, s[84:87], 0 offen sc1
L_q_qk_nf:
s_waitcnt lgkmcnt(5)
v_mfma_f32_16x16x32_bf16 v[72:75], a[232:235], v[44:47], v[72:75]
ds_read_b128 v[36:39], v20 offset:4096
v_mfma_f32_16x16x32_bf16 v[76:79], a[236:239], v[44:47], v[76:79]
s_waitcnt lgkmcnt(5)
v_mfma_f32_16x16x32_bf16 v[64:67], a[240:243], v[48:51], v[64:67]
ds_read_b128 v[40:43], v21
v_mfma_f32_16x16x32_bf16 v[68:71], a[244:247], v[48:51], v[68:71]
s_add_u32 m0, s21, 1024
s_xor_b32 s20, s23, 0
buffer_load_dwordx4 v7, s[8:11], s20 offen lds
s_waitcnt lgkmcnt(5)
v_mfma_f32_16x16x32_bf16 v[72:75], a[240:243], v[52:55], v[72:75]
ds_read_b128 v[44:47], v21 offset:4096
v_mfma_f32_16x16x32_bf16 v[76:79], a[244:247], v[52:55], v[76:79]
s_waitcnt lgkmcnt(5)
v_mfma_f32_16x16x32_bf16 v[64:67], a[248:251], v[56:59], v[64:67]
ds_read_b128 v[48:51], v22
v_mfma_f32_16x16x32_bf16 v[68:71], a[252:255], v[56:59], v[68:71]
s_waitcnt lgkmcnt(5)
v_mfma_f32_16x16x32_bf16 v[72:75], a[248:251], v[60:63], v[72:75]
ds_read_b128 v[52:55], v22 offset:4096
v_mfma_f32_16x16x32_bf16 v[76:79], a[252:255], v[60:63], v[76:79]
s_add_u32 m0, s21, 8192
s_xor_b32 s20, s23, 256
buffer_load_dwordx4 v6, s[8:11], s20 offen lds
s_waitcnt lgkmcnt(5)
v_mfma_f32_16x16x32_bf16 v[80:83], a[0:3], v[32:35], 0
ds_read_b128 v[56:59], v23
v_mfma_f32_16x16x32_bf16 v[84:87], a[4:7], v[32:35], 0
s_waitcnt lgkmcnt(5)
v_mfma_f32_16x16x32_bf16 v[88:91], a[0:3], v[36:39], 0
ds_read_b128 v[60:63], v23 offset:4096
v_mfma_f32_16x16x32_bf16 v[92:95], a[4:7], v[36:39], 0
s_waitcnt lgkmcnt(5)
v_mfma_f32_16x16x32_bf16 v[80:83], a[8:11], v[40:43], v[80:83]
ds_read_b128 v[32:35], v20 offset:8192
v_mfma_f32_16x16x32_bf16 v[84:87], a[12:15], v[40:43], v[84:87]
s_add_u32 m0, s21, 9216
s_xor_b32 s20, s23, 256
buffer_load_dwordx4 v7, s[8:11], s20 offen lds
s_waitcnt lgkmcnt(5)
v_mfma_f32_16x16x32_bf16 v[88:91], a[8:11], v[44:47], v[88:91]
ds_read_b128 v[36:39], v20 offset:12288
v_mfma_f32_16x16x32_bf16 v[92:95], a[12:15], v[44:47], v[92:95]
s_waitcnt lgkmcnt(5)
v_mfma_f32_16x16x32_bf16 v[80:83], a[16:19], v[48:51], v[80:83]
ds_read_b128 v[40:43], v21 offset:8192
v_mfma_f32_16x16x32_bf16 v[84:87], a[20:23], v[48:51], v[84:87]
s_waitcnt lgkmcnt(5)
v_mfma_f32_16x16x32_bf16 v[88:91], a[16:19], v[52:55], v[88:91]
ds_read_b128 v[44:47], v21 offset:12288
v_mfma_f32_16x16x32_bf16 v[92:95], a[20:23], v[52:55], v[92:95]
s_add_u32 m0, s21, 16384
s_xor_b32 s20, s23, 512
buffer_load_dwordx4 v6, s[8:11], s20 offen lds
s_waitcnt lgkmcnt(5)
v_mfma_f32_16x16x32_bf16 v[80:83], a[24:27], v[56:59], v[80:83]
ds_read_b128 v[48:51], v22 offset:8192
v_mfma_f32_16x16x32_bf16 v[84:87], a[28:31], v[56:59], v[84:87]
s_waitcnt lgkmcnt(5)
v_mfma_f32_16x16x32_bf16 v[88:91], a[24:27], v[60:63], v[88:91]
ds_read_b128 v[52:55], v22 offset:12288
v_mfma_f32_16x16x32_bf16 v[92:95], a[28:31], v[60:63], v[92:95]
s_waitcnt lgkmcnt(5)
v_mfma_f32_16x16x32_bf16 v[80:83], a[32:35], v[32:35], v[80:83]
ds_read_b128 v[56:59], v23 offset:8192
v_mfma_f32_16x16x32_bf16 v[84:87], a[36:39], v[32:35], v[84:87]
s_add_u32 m0, s21, 17408
s_xor_b32 s20, s23, 512
buffer_load_dwordx4 v7, s[8:11], s20 offen lds
s_waitcnt lgkmcnt(5)
v_mfma_f32_16x16x32_bf16 v[88:91], a[32:35], v[36:39], v[88:91]
ds_read_b128 v[60:63], v23 offset:12288
v_mfma_f32_16x16x32_bf16 v[92:95], a[36:39], v[36:39], v[92:95]
s_waitcnt lgkmcnt(5)
v_mfma_f32_16x16x32_bf16 v[80:83], a[40:43], v[40:43], v[80:83]
ds_read_b128 v[32:35], v20 offset:16384
v_mfma_f32_16x16x32_bf16 v[84:87], a[44:47], v[40:43], v[84:87]
s_waitcnt lgkmcnt(5)
v_mfma_f32_16x16x32_bf16 v[88:91], a[40:43], v[44:47], v[88:91]
ds_read_b128 v[36:39], v20 offset:20480
v_mfma_f32_16x16x32_bf16 v[92:95], a[44:47], v[44:47], v[92:95]
s_add_u32 m0, s21, 24576
s_xor_b32 s20, s23, 768
buffer_load_dwordx4 v6, s[8:11], s20 offen lds
s_waitcnt lgkmcnt(5)
v_mfma_f32_16x16x32_bf16 v[80:83], a[48:51], v[48:51], v[80:83]
ds_read_b128 v[40:43], v21 offset:16384
v_mfma_f32_16x16x32_bf16 v[84:87], a[52:55], v[48:51], v[84:87]
s_waitcnt lgkmcnt(5)
v_mfma_f32_16x16x32_bf16 v[88:91], a[48:51], v[52:55], v[88:91]
ds_read_b128 v[44:47], v21 offset:20480
v_mfma_f32_16x16x32_bf16 v[92:95], a[52:55], v[52:55], v[92:95]
s_waitcnt lgkmcnt(5)
v_mfma_f32_16x16x32_bf16 v[80:83], a[56:59], v[56:59], v[80:83]
ds_read_b128 v[48:51], v22 offset:16384
v_mfma_f32_16x16x32_bf16 v[84:87], a[60:63], v[56:59], v[84:87]
s_add_u32 m0, s21, 25600
s_xor_b32 s20, s23, 768
buffer_load_dwordx4 v7, s[8:11], s20 offen lds
s_waitcnt lgkmcnt(5)
v_mfma_f32_16x16x32_bf16 v[88:91], a[56:59], v[60:63], v[88:91]
ds_read_b128 v[52:55], v22 offset:20480
v_mfma_f32_16x16x32_bf16 v[92:95], a[60:63], v[60:63], v[92:95]
v_cvt_pk_bf16_f32 v96, v64, v65
v_cvt_pk_bf16_f32 v97, v66, v67
s_waitcnt lgkmcnt(5)
v_mfma_f32_16x16x32_bf16 v[80:83], a[64:67], v[32:35], v[80:83]
ds_read_b128 v[56:59], v23 offset:16384
v_mfma_f32_16x16x32_bf16 v[84:87], a[68:71], v[32:35], v[84:87]
v_cvt_pk_bf16_f32 v98, v68, v69
v_cvt_pk_bf16_f32 v99, v70, v71
s_waitcnt lgkmcnt(5)
v_mfma_f32_16x16x32_bf16 v[88:91], a[64:67], v[36:39], v[88:91]
ds_read_b128 v[60:63], v23 offset:20480
v_mfma_f32_16x16x32_bf16 v[92:95], a[68:71], v[36:39], v[92:95]
buffer_store_dwordx4 v[96:99], v8, s[84:87], s24 offen sc1
v_cvt_pk_bf16_f32 v100, v72, v73
s_waitcnt lgkmcnt(5)
v_mfma_f32_16x16x32_bf16 v[80:83], a[72:75], v[40:43], v[80:83]
ds_read_b128 v[32:35], v20 offset:24576
v_mfma_f32_16x16x32_bf16 v[84:87], a[76:79], v[40:43], v[84:87]
v_cvt_pk_bf16_f32 v101, v74, v75
v_cvt_pk_bf16_f32 v102, v76, v77
s_waitcnt lgkmcnt(5)
v_mfma_f32_16x16x32_bf16 v[88:91], a[72:75], v[44:47], v[88:91]
ds_read_b128 v[36:39], v20 offset:28672
v_mfma_f32_16x16x32_bf16 v[92:95], a[76:79], v[44:47], v[92:95]
v_cvt_pk_bf16_f32 v103, v78, v79
buffer_store_dwordx4 v[100:103], v8, s[84:87], s24 offen offset:1024 sc1
s_waitcnt lgkmcnt(5)
v_mfma_f32_16x16x32_bf16 v[80:83], a[80:83], v[48:51], v[80:83]
ds_read_b128 v[40:43], v21 offset:24576
v_mfma_f32_16x16x32_bf16 v[84:87], a[84:87], v[48:51], v[84:87]
s_add_u32 s24, s24, 524288
s_waitcnt lgkmcnt(5)
v_mfma_f32_16x16x32_bf16 v[88:91], a[80:83], v[52:55], v[88:91]
ds_read_b128 v[44:47], v21 offset:28672
v_mfma_f32_16x16x32_bf16 v[92:95], a[84:87], v[52:55], v[92:95]
s_waitcnt lgkmcnt(5)
v_mfma_f32_16x16x32_bf16 v[80:83], a[88:91], v[56:59], v[80:83]
ds_read_b128 v[48:51], v22 offset:24576
v_mfma_f32_16x16x32_bf16 v[84:87], a[92:95], v[56:59], v[84:87]
s_waitcnt lgkmcnt(5)
v_mfma_f32_16x16x32_bf16 v[88:91], a[88:91], v[60:63], v[88:91]
ds_read_b128 v[52:55], v22 offset:28672
v_mfma_f32_16x16x32_bf16 v[92:95], a[92:95], v[60:63], v[92:95]
s_waitcnt vmcnt(8)
s_barrier
s_waitcnt lgkmcnt(5)
v_mfma_f32_16x16x32_bf16 v[80:83], a[96:99], v[32:35], v[80:83]
ds_read_b128 v[56:59], v23 offset:24576
v_mfma_f32_16x16x32_bf16 v[84:87], a[100:103], v[32:35], v[84:87]
s_waitcnt lgkmcnt(5)
v_mfma_f32_16x16x32_bf16 v[88:91], a[96:99], v[36:39], v[88:91]
ds_read_b128 v[60:63], v23 offset:28672
v_mfma_f32_16x16x32_bf16 v[92:95], a[100:103], v[36:39], v[92:95]
s_add_u32 m0, s21, 32768
s_xor_b32 s20, s23, 1024
buffer_load_dwordx4 v6, s[8:11], s20 offen lds
s_waitcnt lgkmcnt(5)
v_mfma_f32_16x16x32_bf16 v[80:83], a[104:107], v[40:43], v[80:83]
ds_read_b128 v[32:35], v20 offset:32768
v_mfma_f32_16x16x32_bf16 v[84:87], a[108:111], v[40:43], v[84:87]
s_waitcnt lgkmcnt(5)
v_mfma_f32_16x16x32_bf16 v[88:91], a[104:107], v[44:47], v[88:91]
ds_read_b128 v[36:39], v20 offset:36864
v_mfma_f32_16x16x32_bf16 v[92:95], a[108:111], v[44:47], v[92:95]
s_waitcnt lgkmcnt(5)
v_mfma_f32_16x16x32_bf16 v[80:83], a[112:115], v[48:51], v[80:83]
ds_read_b128 v[40:43], v21 offset:32768
v_mfma_f32_16x16x32_bf16 v[84:87], a[116:119], v[48:51], v[84:87]
s_add_u32 m0, s21, 33792
s_xor_b32 s20, s23, 1024
buffer_load_dwordx4 v7, s[8:11], s20 offen lds
s_waitcnt lgkmcnt(5)
v_mfma_f32_16x16x32_bf16 v[88:91], a[112:115], v[52:55], v[88:91]
ds_read_b128 v[44:47], v21 offset:36864
v_mfma_f32_16x16x32_bf16 v[92:95], a[116:119], v[52:55], v[92:95]
s_waitcnt lgkmcnt(5)
v_mfma_f32_16x16x32_bf16 v[80:83], a[120:123], v[56:59], v[80:83]
ds_read_b128 v[48:51], v22 offset:32768
v_mfma_f32_16x16x32_bf16 v[84:87], a[124:127], v[56:59], v[84:87]
s_waitcnt lgkmcnt(5)
v_mfma_f32_16x16x32_bf16 v[88:91], a[120:123], v[60:63], v[88:91]
ds_read_b128 v[52:55], v22 offset:36864
v_mfma_f32_16x16x32_bf16 v[92:95], a[124:127], v[60:63], v[92:95]
s_add_u32 m0, s21, 40960
s_xor_b32 s20, s23, 1280
buffer_load_dwordx4 v6, s[8:11], s20 offen lds
s_waitcnt lgkmcnt(5)
v_mfma_f32_16x16x32_bf16 v[80:83], a[128:131], v[32:35], v[80:83]
ds_read_b128 v[56:59], v23 offset:32768
v_mfma_f32_16x16x32_bf16 v[84:87], a[132:135], v[32:35], v[84:87]
s_waitcnt lgkmcnt(5)
v_mfma_f32_16x16x32_bf16 v[88:91], a[128:131], v[36:39], v[88:91]
ds_read_b128 v[60:63], v23 offset:36864
v_mfma_f32_16x16x32_bf16 v[92:95], a[132:135], v[36:39], v[92:95]
s_waitcnt lgkmcnt(5)
v_mfma_f32_16x16x32_bf16 v[80:83], a[136:139], v[40:43], v[80:83]
ds_read_b128 v[32:35], v20 offset:40960
v_mfma_f32_16x16x32_bf16 v[84:87], a[140:143], v[40:43], v[84:87]
s_add_u32 m0, s21, 41984
s_xor_b32 s20, s23, 1280
buffer_load_dwordx4 v7, s[8:11], s20 offen lds
s_waitcnt lgkmcnt(5)
v_mfma_f32_16x16x32_bf16 v[88:91], a[136:139], v[44:47], v[88:91]
ds_read_b128 v[36:39], v20 offset:45056
v_mfma_f32_16x16x32_bf16 v[92:95], a[140:143], v[44:47], v[92:95]
s_waitcnt lgkmcnt(5)
v_mfma_f32_16x16x32_bf16 v[80:83], a[144:147], v[48:51], v[80:83]
ds_read_b128 v[40:43], v21 offset:40960
v_mfma_f32_16x16x32_bf16 v[84:87], a[148:151], v[48:51], v[84:87]
s_waitcnt lgkmcnt(5)
v_mfma_f32_16x16x32_bf16 v[88:91], a[144:147], v[52:55], v[88:91]
ds_read_b128 v[44:47], v21 offset:45056
v_mfma_f32_16x16x32_bf16 v[92:95], a[148:151], v[52:55], v[92:95]
s_add_u32 m0, s21, 49152
s_xor_b32 s20, s23, 1536
buffer_load_dwordx4 v6, s[8:11], s20 offen lds
s_waitcnt lgkmcnt(5)
v_mfma_f32_16x16x32_bf16 v[80:83], a[152:155], v[56:59], v[80:83]
ds_read_b128 v[48:51], v22 offset:40960
v_mfma_f32_16x16x32_bf16 v[84:87], a[156:159], v[56:59], v[84:87]
s_waitcnt lgkmcnt(5)
v_mfma_f32_16x16x32_bf16 v[88:91], a[152:155], v[60:63], v[88:91]
ds_read_b128 v[52:55], v22 offset:45056
v_mfma_f32_16x16x32_bf16 v[92:95], a[156:159], v[60:63], v[92:95]
s_waitcnt lgkmcnt(5)
v_mfma_f32_16x16x32_bf16 v[80:83], a[160:163], v[32:35], v[80:83]
ds_read_b128 v[56:59], v23 offset:40960
v_mfma_f32_16x16x32_bf16 v[84:87], a[164:167], v[32:35], v[84:87]
s_add_u32 m0, s21, 50176
s_xor_b32 s20, s23, 1536
buffer_load_dwordx4 v7, s[8:11], s20 offen lds
s_waitcnt lgkmcnt(5)
v_mfma_f32_16x16x32_bf16 v[88:91], a[160:163], v[36:39], v[88:91]
ds_read_b128 v[60:63], v23 offset:45056
v_mfma_f32_16x16x32_bf16 v[92:95], a[164:167], v[36:39], v[92:95]
s_waitcnt lgkmcnt(5)
v_mfma_f32_16x16x32_bf16 v[80:83], a[168:171], v[40:43], v[80:83]
ds_read_b128 v[32:35], v20 offset:49152
v_mfma_f32_16x16x32_bf16 v[84:87], a[172:175], v[40:43], v[84:87]
s_waitcnt lgkmcnt(5)
v_mfma_f32_16x16x32_bf16 v[88:91], a[168:171], v[44:47], v[88:91]
ds_read_b128 v[36:39], v20 offset:53248
v_mfma_f32_16x16x32_bf16 v[92:95], a[172:175], v[44:47], v[92:95]
s_add_u32 m0, s21, 57344
s_xor_b32 s20, s23, 1792
buffer_load_dwordx4 v6, s[8:11], s20 offen lds
s_waitcnt lgkmcnt(5)
v_mfma_f32_16x16x32_bf16 v[80:83], a[176:179], v[48:51], v[80:83]
ds_read_b128 v[40:43], v21 offset:49152
v_mfma_f32_16x16x32_bf16 v[84:87], a[180:183], v[48:51], v[84:87]
s_waitcnt lgkmcnt(5)
v_mfma_f32_16x16x32_bf16 v[88:91], a[176:179], v[52:55], v[88:91]
ds_read_b128 v[44:47], v21 offset:53248
v_mfma_f32_16x16x32_bf16 v[92:95], a[180:183], v[52:55], v[92:95]
s_waitcnt lgkmcnt(5)
v_mfma_f32_16x16x32_bf16 v[80:83], a[184:187], v[56:59], v[80:83]
ds_read_b128 v[48:51], v22 offset:49152
v_mfma_f32_16x16x32_bf16 v[84:87], a[188:191], v[56:59], v[84:87]
s_add_u32 m0, s21, 58368
s_xor_b32 s20, s23, 1792
buffer_load_dwordx4 v7, s[8:11], s20 offen lds
s_waitcnt lgkmcnt(5)
v_mfma_f32_16x16x32_bf16 v[88:91], a[184:187], v[60:63], v[88:91]
ds_read_b128 v[52:55], v22 offset:53248
v_mfma_f32_16x16x32_bf16 v[92:95], a[188:191], v[60:63], v[92:95]
s_waitcnt lgkmcnt(5)
v_mfma_f32_16x16x32_bf16 v[80:83], a[192:195], v[32:35], v[80:83]
ds_read_b128 v[56:59], v23 offset:49152
v_mfma_f32_16x16x32_bf16 v[84:87], a[196:199], v[32:35], v[84:87]
s_waitcnt lgkmcnt(5)
v_mfma_f32_16x16x32_bf16 v[88:91], a[192:195], v[36:39], v[88:91]
ds_read_b128 v[60:63], v23 offset:53248
v_mfma_f32_16x16x32_bf16 v[92:95], a[196:199], v[36:39], v[92:95]
s_waitcnt lgkmcnt(5)
v_mfma_f32_16x16x32_bf16 v[80:83], a[200:203], v[40:43], v[80:83]
ds_read_b128 v[32:35], v20 offset:57344
v_mfma_f32_16x16x32_bf16 v[84:87], a[204:207], v[40:43], v[84:87]
s_waitcnt lgkmcnt(5)
v_mfma_f32_16x16x32_bf16 v[88:91], a[200:203], v[44:47], v[88:91]
ds_read_b128 v[36:39], v20 offset:61440
v_mfma_f32_16x16x32_bf16 v[92:95], a[204:207], v[44:47], v[92:95]
s_waitcnt lgkmcnt(5)
v_mfma_f32_16x16x32_bf16 v[80:83], a[208:211], v[48:51], v[80:83]
ds_read_b128 v[40:43], v21 offset:57344
v_mfma_f32_16x16x32_bf16 v[84:87], a[212:215], v[48:51], v[84:87]
s_waitcnt lgkmcnt(5)
v_mfma_f32_16x16x32_bf16 v[88:91], a[208:211], v[52:55], v[88:91]
ds_read_b128 v[44:47], v21 offset:61440
v_mfma_f32_16x16x32_bf16 v[92:95], a[212:215], v[52:55], v[92:95]
s_waitcnt lgkmcnt(5)
v_mfma_f32_16x16x32_bf16 v[80:83], a[216:219], v[56:59], v[80:83]
ds_read_b128 v[48:51], v22 offset:57344
v_mfma_f32_16x16x32_bf16 v[84:87], a[220:223], v[56:59], v[84:87]
s_waitcnt lgkmcnt(5)
v_mfma_f32_16x16x32_bf16 v[88:91], a[216:219], v[60:63], v[88:91]
ds_read_b128 v[52:55], v22 offset:61440
v_mfma_f32_16x16x32_bf16 v[92:95], a[220:223], v[60:63], v[92:95]
s_waitcnt vmcnt(8)
s_barrier
s_waitcnt lgkmcnt(5)
v_mfma_f32_16x16x32_bf16 v[80:83], a[224:227], v[32:35], v[80:83]
ds_read_b128 v[56:59], v23 offset:57344
v_mfma_f32_16x16x32_bf16 v[84:87], a[228:231], v[32:35], v[84:87]
s_waitcnt lgkmcnt(5)
v_mfma_f32_16x16x32_bf16 v[88:91], a[224:227], v[36:39], v[88:91]
ds_read_b128 v[60:63], v23 offset:61440
v_mfma_f32_16x16x32_bf16 v[92:95], a[228:231], v[36:39], v[92:95]
s_add_u32 s23, s23, 131072
s_add_u32 m0, s21, 65536
s_xor_b32 s20, s23, 0
buffer_load_dwordx4 v6, s[8:11], s20 offen lds
s_waitcnt lgkmcnt(5)
v_mfma_f32_16x16x32_bf16 v[80:83], a[232:235], v[40:43], v[80:83]
ds_read_b128 v[32:35], v16
v_mfma_f32_16x16x32_bf16 v[84:87], a[236:239], v[40:43], v[84:87]
v_add_u32 v10, 1, v10
buffer_store_dword v10, v9, s[84:87], 0 offen sc1
s_waitcnt lgkmcnt(5)
v_mfma_f32_16x16x32_bf16 v[88:91], a[232:235], v[44:47], v[88:91]
ds_read_b128 v[36:39], v16 offset:4096
v_mfma_f32_16x16x32_bf16 v[92:95], a[236:239], v[44:47], v[92:95]
s_waitcnt lgkmcnt(5)
v_mfma_f32_16x16x32_bf16 v[80:83], a[240:243], v[48:51], v[80:83]
ds_read_b128 v[40:43], v17
v_mfma_f32_16x16x32_bf16 v[84:87], a[244:247], v[48:51], v[84:87]
s_add_u32 m0, s21, 66560
s_xor_b32 s20, s23, 0
buffer_load_dwordx4 v7, s[8:11], s20 offen lds
s_waitcnt lgkmcnt(5)
v_mfma_f32_16x16x32_bf16 v[88:91], a[240:243], v[52:55], v[88:91]
ds_read_b128 v[44:47], v17 offset:4096
v_mfma_f32_16x16x32_bf16 v[92:95], a[244:247], v[52:55], v[92:95]
s_waitcnt lgkmcnt(5)
v_mfma_f32_16x16x32_bf16 v[80:83], a[248:251], v[56:59], v[80:83]
ds_read_b128 v[48:51], v18
v_mfma_f32_16x16x32_bf16 v[84:87], a[252:255], v[56:59], v[84:87]
s_waitcnt lgkmcnt(5)
v_mfma_f32_16x16x32_bf16 v[88:91], a[248:251], v[60:63], v[88:91]
ds_read_b128 v[52:55], v18 offset:4096
v_mfma_f32_16x16x32_bf16 v[92:95], a[252:255], v[60:63], v[92:95]
s_add_u32 m0, s21, 73728
s_xor_b32 s20, s23, 256
buffer_load_dwordx4 v6, s[8:11], s20 offen lds
s_add_u32 s25, s25, 1
s_cmp_lt_u32 s25, 16
s_cbranch_scc1 L_q_qk_loop
s_nop 11
v_cvt_pk_bf16_f32 v96, v80, v81
v_cvt_pk_bf16_f32 v97, v82, v83
v_cvt_pk_bf16_f32 v98, v84, v85
v_cvt_pk_bf16_f32 v99, v86, v87
buffer_store_dwordx4 v[96:99], v8, s[84:87], s24 offen sc1
v_cvt_pk_bf16_f32 v100, v88, v89
v_cvt_pk_bf16_f32 v101, v90, v91
v_cvt_pk_bf16_f32 v102, v92, v93
v_cvt_pk_bf16_f32 v103, v94, v95
buffer_store_dwordx4 v[100:103], v8, s[84:87], s24 offen offset:1024 sc1
s_add_u32 s24, s24, 524288
s_waitcnt vmcnt(0) lgkmcnt(0)
s_barrier
v_add_u32 v10, 1, v10
buffer_store_dword v10, v9, s[84:87], 0 offen sc1
s_branch L_q_done
L_q_v:
ds_read_b128 v[32:35], v16
ds_read_b128 v[36:39], v16 offset:4096
ds_read_b128 v[40:43], v17
ds_read_b128 v[44:47], v17 offset:4096
ds_read_b128 v[48:51], v18
ds_read_b128 v[52:55], v18 offset:4096
s_mov_b32 s25, 0
L_q_v_loop:
s_waitcnt lgkmcnt(5)
v_mfma_f32_16x16x32_bf16 v[64:67], v[32:35], a[0:3], 0
ds_read_b128 v[56:59], v19
v_mfma_f32_16x16x32_bf16 v[68:71], v[32:35], a[4:7], 0
s_waitcnt lgkmcnt(5)
v_mfma_f32_16x16x32_bf16 v[72:75], v[36:39], a[0:3], 0
ds_read_b128 v[60:63], v19 offset:4096
v_mfma_f32_16x16x32_bf16 v[76:79], v[36:39], a[4:7], 0
s_waitcnt lgkmcnt(5)
v_mfma_f32_16x16x32_bf16 v[64:67], v[40:43], a[8:11], v[64:67]
ds_read_b128 v[32:35], v16 offset:8192
v_mfma_f32_16x16x32_bf16 v[68:71], v[40:43], a[12:15], v[68:71]
s_cmp_eq_u32 s25, 0
s_cbranch_scc1 L_q_v_sk2
s_add_u32 m0, s21, 74752
s_xor_b32 s20, s23, 256
buffer_load_dwordx4 v7, s[8:11], s20 offen lds
L_q_v_sk2:
s_waitcnt lgkmcnt(5)
v_mfma_f32_16x16x32_bf16 v[72:75], v[44:47], a[8:11], v[72:75]
ds_read_b128 v[36:39], v16 offset:12288
v_mfma_f32_16x16x32_bf16 v[76:79], v[44:47], a[12:15], v[76:79]
s_waitcnt lgkmcnt(5)
v_mfma_f32_16x16x32_bf16 v[64:67], v[48:51], a[16:19], v[64:67]
ds_read_b128 v[40:43], v17 offset:8192
v_mfma_f32_16x16x32_bf16 v[68:71], v[48:51], a[20:23], v[68:71]
s_waitcnt lgkmcnt(5)
v_mfma_f32_16x16x32_bf16 v[72:75], v[52:55], a[16:19], v[72:75]
ds_read_b128 v[44:47], v17 offset:12288
v_mfma_f32_16x16x32_bf16 v[76:79], v[52:55], a[20:23], v[76:79]
s_cmp_eq_u32 s25, 0
s_cbranch_scc1 L_q_v_sk5
s_add_u32 m0, s21, 81920
s_xor_b32 s20, s23, 512
buffer_load_dwordx4 v6, s[8:11], s20 offen lds
L_q_v_sk5:
s_waitcnt lgkmcnt(5)
v_mfma_f32_16x16x32_bf16 v[64:67], v[56:59], a[24:27], v[64:67]
ds_read_b128 v[48:51], v18 offset:8192
v_mfma_f32_16x16x32_bf16 v[68:71], v[56:59], a[28:31], v[68:71]
s_waitcnt lgkmcnt(5)
v_mfma_f32_16x16x32_bf16 v[72:75], v[60:63], a[24:27], v[72:75]
ds_read_b128 v[52:55], v18 offset:12288
v_mfma_f32_16x16x32_bf16 v[76:79], v[60:63], a[28:31], v[76:79]
s_waitcnt lgkmcnt(5)
v_mfma_f32_16x16x32_bf16 v[64:67], v[32:35], a[32:35], v[64:67]
ds_read_b128 v[56:59], v19 offset:8192
v_mfma_f32_16x16x32_bf16 v[68:71], v[32:35], a[36:39], v[68:71]
s_cmp_eq_u32 s25, 0
s_cbranch_scc1 L_q_v_sk8
s_add_u32 m0, s21, 82944
s_xor_b32 s20, s23, 512
buffer_load_dwordx4 v7, s[8:11], s20 offen lds
L_q_v_sk8:
s_waitcnt lgkmcnt(5)
v_mfma_f32_16x16x32_bf16 v[72:75], v[36:39], a[32:35], v[72:75]
ds_read_b128 v[60:63], v19 offset:12288
v_mfma_f32_16x16x32_bf16 v[76:79], v[36:39], a[36:39], v[76:79]
s_waitcnt lgkmcnt(5)
v_mfma_f32_16x16x32_bf16 v[64:67], v[40:43], a[40:43], v[64:67]
ds_read_b128 v[32:35], v16 offset:16384
v_mfma_f32_16x16x32_bf16 v[68:71], v[40:43], a[44:47], v[68:71]
s_waitcnt lgkmcnt(5)
v_mfma_f32_16x16x32_bf16 v[72:75], v[44:47], a[40:43], v[72:75]
ds_read_b128 v[36:39], v16 offset:20480
v_mfma_f32_16x16x32_bf16 v[76:79], v[44:47], a[44:47], v[76:79]
s_cmp_eq_u32 s25, 0
s_cbranch_scc1 L_q_v_sk11
s_add_u32 m0, s21, 90112
s_xor_b32 s20, s23, 768
buffer_load_dwordx4 v6, s[8:11], s20 offen lds
L_q_v_sk11:
s_waitcnt lgkmcnt(5)
v_mfma_f32_16x16x32_bf16 v[64:67], v[48:51], a[48:51], v[64:67]
ds_read_b128 v[40:43], v17 offset:16384
v_mfma_f32_16x16x32_bf16 v[68:71], v[48:51], a[52:55], v[68:71]
s_waitcnt lgkmcnt(5)
v_mfma_f32_16x16x32_bf16 v[72:75], v[52:55], a[48:51], v[72:75]
ds_read_b128 v[44:47], v17 offset:20480
v_mfma_f32_16x16x32_bf16 v[76:79], v[52:55], a[52:55], v[76:79]
s_waitcnt lgkmcnt(5)
v_mfma_f32_16x16x32_bf16 v[64:67], v[56:59], a[56:59], v[64:67]
ds_read_b128 v[48:51], v18 offset:16384
v_mfma_f32_16x16x32_bf16 v[68:71], v[56:59], a[60:63], v[68:71]
s_cmp_eq_u32 s25, 0
s_cbranch_scc1 L_q_v_sk14
s_add_u32 m0, s21, 91136
s_xor_b32 s20, s23, 768
buffer_load_dwordx4 v7, s[8:11], s20 offen lds
L_q_v_sk14:
s_waitcnt lgkmcnt(5)
v_mfma_f32_16x16x32_bf16 v[72:75], v[60:63], a[56:59], v[72:75]
ds_read_b128 v[52:55], v18 offset:20480
v_mfma_f32_16x16x32_bf16 v[76:79], v[60:63], a[60:63], v[76:79]
s_cmp_eq_u32 s25, 0
s_cbranch_scc1 L_q_v_ne0
v_cvt_pk_bf16_f32 v96, v80, v81
v_cvt_pk_bf16_f32 v97, v82, v83
L_q_v_ne0:
s_waitcnt lgkmcnt(5)
v_mfma_f32_16x16x32_bf16 v[64:67], v[32:35], a[64:67], v[64:67]
ds_read_b128 v[56:59], v19 offset:16384
v_mfma_f32_16x16x32_bf16 v[68:71], v[32:35], a[68:71], v[68:71]
s_cmp_eq_u32 s25, 0
s_cbranch_scc1 L_q_v_ne1
v_cvt_pk_bf16_f32 v98, v88, v89
v_cvt_pk_bf16_f32 v99, v90, v91
L_q_v_ne1:
s_waitcnt lgkmcnt(5)
v_mfma_f32_16x16x32_bf16 v[72:75], v[36:39], a[64:67], v[72:75]
ds_read_b128 v[60:63], v19 offset:20480
v_mfma_f32_16x16x32_bf16 v[76:79], v[36:39], a[68:71], v[76:79]
s_cmp_eq_u32 s25, 0
s_cbranch_scc1 L_q_v_ne2
buffer_store_dwordx4 v[96:99], v8, s[84:87], s24 offen sc1
v_cvt_pk_bf16_f32 v100, v84, v85
L_q_v_ne2:
s_waitcnt lgkmcnt(5)
v_mfma_f32_16x16x32_bf16 v[64:67], v[40:43], a[72:75], v[64:67]
ds_read_b128 v[32:35], v16 offset:24576
v_mfma_f32_16x16x32_bf16 v[68:71], v[40:43], a[76:79], v[68:71]
s_cmp_eq_u32 s25, 0
s_cbranch_scc1 L_q_v_ne3
v_cvt_pk_bf16_f32 v101, v86, v87
v_cvt_pk_bf16_f32 v102, v92, v93
L_q_v_ne3:
s_waitcnt lgkmcnt(5)
v_mfma_f32_16x16x32_bf16 v[72:75], v[44:47], a[72:75], v[72:75]
ds_read_b128 v[36:39], v16 offset:28672
v_mfma_f32_16x16x32_bf16 v[76:79], v[44:47], a[76:79], v[76:79]
s_cmp_eq_u32 s25, 0
s_cbranch_scc1 L_q_v_ne4
v_cvt_pk_bf16_f32 v103, v94, v95
buffer_store_dwordx4 v[100:103], v8, s[84:87], s24 offen offset:1024 sc1
L_q_v_ne4:
s_waitcnt lgkmcnt(5)
v_mfma_f32_16x16x32_bf16 v[64:67], v[48:51], a[80:83], v[64:67]
ds_read_b128 v[40:43], v17 offset:24576
v_mfma_f32_16x16x32_bf16 v[68:71], v[48:51], a[84:87], v[68:71]
s_cmp_eq_u32 s25, 0
s_cbranch_scc1 L_q_v_ne5
s_add_u32 s24, s24, 524288
L_q_v_ne5:
s_waitcnt lgkmcnt(5)
v_mfma_f32_16x16x32_bf16 v[72:75], v[52:55], a[80:83], v[72:75]
ds_read_b128 v[44:47], v17 offset:28672
v_mfma_f32_16x16x32_bf16 v[76:79], v[52:55], a[84:87], v[76:79]
s_waitcnt lgkmcnt(5)
v_mfma_f32_16x16x32_bf16 v[64:67], v[56:59], a[88:91], v[64:67]
ds_read_b128 v[48:51], v18 offset:24576
v_mfma_f32_16x16x32_bf16 v[68:71], v[56:59], a[92:95], v[68:71]
s_cmp_lg_u32 s25, 2
s_cbranch_scc1 L_q_v_nx
v_lshlrev_b32 v242, 7, v0
s_mul_i32 s46, s92, 32768
s_sub_u32 s46, s46, 2097152
buffer_load_dword v240, v242, s[8:11], s46 offen
L_q_v_nx:
s_waitcnt lgkmcnt(5)
v_mfma_f32_16x16x32_bf16 v[72:75], v[60:63], a[88:91], v[72:75]
ds_read_b128 v[52:55], v18 offset:28672
v_mfma_f32_16x16x32_bf16 v[76:79], v[60:63], a[92:95], v[76:79]
s_waitcnt vmcnt(8)
s_barrier
s_waitcnt lgkmcnt(5)
v_mfma_f32_16x16x32_bf16 v[64:67], v[32:35], a[96:99], v[64:67]
ds_read_b128 v[56:59], v19 offset:24576
v_mfma_f32_16x16x32_bf16 v[68:71], v[32:35], a[100:103], v[68:71]
s_waitcnt lgkmcnt(5)
v_mfma_f32_16x16x32_bf16 v[72:75], v[36:39], a[96:99], v[72:75]
ds_read_b128 v[60:63], v19 offset:28672
v_mfma_f32_16x16x32_bf16 v[76:79], v[36:39], a[100:103], v[76:79]
s_add_u32 m0, s21, 98304
s_xor_b32 s20, s23, 1024
buffer_load_dwordx4 v6, s[8:11], s20 offen lds
s_waitcnt lgkmcnt(5)
v_mfma_f32_16x16x32_bf16 v[64:67], v[40:43], a[104:107], v[64:67]
ds_read_b128 v[32:35], v16 offset:32768
v_mfma_f32_16x16x32_bf16 v[68:71], v[40:43], a[108:111], v[68:71]
s_waitcnt lgkmcnt(5)
v_mfma_f32_16x16x32_bf16 v[72:75], v[44:47], a[104:107], v[72:75]
ds_read_b128 v[36:39], v16 offset:36864
v_mfma_f32_16x16x32_bf16 v[76:79], v[44:47], a[108:111], v[76:79]
s_waitcnt lgkmcnt(5)
v_mfma_f32_16x16x32_bf16 v[64:67], v[48:51], a[112:115], v[64:67]
ds_read_b128 v[40:43], v17 offset:32768
v_mfma_f32_16x16x32_bf16 v[68:71], v[48:51], a[116:119], v[68:71]
s_add_u32 m0, s21, 99328
s_xor_b32 s20, s23, 1024
buffer_load_dwordx4 v7, s[8:11], s20 offen lds
s_waitcnt lgkmcnt(5)
v_mfma_f32_16x16x32_bf16 v[72:75], v[52:55], a[112:115], v[72:75]
ds_read_b128 v[44:47], v17 offset:36864
v_mfma_f32_16x16x32_bf16 v[76:79], v[52:55], a[116:119], v[76:79]
s_waitcnt lgkmcnt(5)
v_mfma_f32_16x16x32_bf16 v[64:67], v[56:59], a[120:123], v[64:67]
ds_read_b128 v[48:51], v18 offset:32768
v_mfma_f32_16x16x32_bf16 v[68:71], v[56:59], a[124:127], v[68:71]
s_waitcnt lgkmcnt(5)
v_mfma_f32_16x16x32_bf16 v[72:75], v[60:63], a[120:123], v[72:75]
ds_read_b128 v[52:55], v18 offset:36864
v_mfma_f32_16x16x32_bf16 v[76:79], v[60:63], a[124:127], v[76:79]
s_add_u32 m0, s21, 106496
s_xor_b32 s20, s23, 1280
buffer_load_dwordx4 v6, s[8:11], s20 offen lds
s_waitcnt lgkmcnt(5)
v_mfma_f32_16x16x32_bf16 v[64:67], v[32:35], a[128:131], v[64:67]
ds_read_b128 v[56:59], v19 offset:32768
v_mfma_f32_16x16x32_bf16 v[68:71], v[32:35], a[132:135], v[68:71]
s_waitcnt lgkmcnt(5)
v_mfma_f32_16x16x32_bf16 v[72:75], v[36:39], a[128:131], v[72:75]
ds_read_b128 v[60:63], v19 offset:36864
v_mfma_f32_16x16x32_bf16 v[76:79], v[36:39], a[132:135], v[76:79]
s_waitcnt lgkmcnt(5)
v_mfma_f32_16x16x32_bf16 v[64:67], v[40:43], a[136:139], v[64:67]
ds_read_b128 v[32:35], v16 offset:40960
v_mfma_f32_16x16x32_bf16 v[68:71], v[40:43], a[140:143], v[68:71]
s_add_u32 m0, s21, 107520
s_xor_b32 s20, s23, 1280
buffer_load_dwordx4 v7, s[8:11], s20 offen lds
s_waitcnt lgkmcnt(5)
v_mfma_f32_16x16x32_bf16 v[72:75], v[44:47], a[136:139], v[72:75]
ds_read_b128 v[36:39], v16 offset:45056
v_mfma_f32_16x16x32_bf16 v[76:79], v[44:47], a[140:143], v[76:79]
s_waitcnt lgkmcnt(5)
v_mfma_f32_16x16x32_bf16 v[64:67], v[48:51], a[144:147], v[64:67]
ds_read_b128 v[40:43], v17 offset:40960
v_mfma_f32_16x16x32_bf16 v[68:71], v[48:51], a[148:151], v[68:71]
s_waitcnt lgkmcnt(5)
v_mfma_f32_16x16x32_bf16 v[72:75], v[52:55], a[144:147], v[72:75]
ds_read_b128 v[44:47], v17 offset:45056
v_mfma_f32_16x16x32_bf16 v[76:79], v[52:55], a[148:151], v[76:79]
s_add_u32 m0, s21, 114688
s_xor_b32 s20, s23, 1536
buffer_load_dwordx4 v6, s[8:11], s20 offen lds
s_waitcnt lgkmcnt(5)
v_mfma_f32_16x16x32_bf16 v[64:67], v[56:59], a[152:155], v[64:67]
ds_read_b128 v[48:51], v18 offset:40960
v_mfma_f32_16x16x32_bf16 v[68:71], v[56:59], a[156:159], v[68:71]
s_waitcnt lgkmcnt(5)
v_mfma_f32_16x16x32_bf16 v[72:75], v[60:63], a[152:155], v[72:75]
ds_read_b128 v[52:55], v18 offset:45056
v_mfma_f32_16x16x32_bf16 v[76:79], v[60:63], a[156:159], v[76:79]
s_waitcnt lgkmcnt(5)
v_mfma_f32_16x16x32_bf16 v[64:67], v[32:35], a[160:163], v[64:67]
ds_read_b128 v[56:59], v19 offset:40960
v_mfma_f32_16x16x32_bf16 v[68:71], v[32:35], a[164:167], v[68:71]
s_add_u32 m0, s21, 115712
s_xor_b32 s20, s23, 1536
buffer_load_dwordx4 v7, s[8:11], s20 offen lds
s_waitcnt lgkmcnt(5)
v_mfma_f32_16x16x32_bf16 v[72:75], v[36:39], a[160:163], v[72:75]
ds_read_b128 v[60:63], v19 offset:45056
v_mfma_f32_16x16x32_bf16 v[76:79], v[36:39], a[164:167], v[76:79]
s_waitcnt lgkmcnt(5)
v_mfma_f32_16x16x32_bf16 v[64:67], v[40:43], a[168:171], v[64:67]
ds_read_b128 v[32:35], v16 offset:49152
v_mfma_f32_16x16x32_bf16 v[68:71], v[40:43], a[172:175], v[68:71]
s_waitcnt lgkmcnt(5)
v_mfma_f32_16x16x32_bf16 v[72:75], v[44:47], a[168:171], v[72:75]
ds_read_b128 v[36:39], v16 offset:53248
v_mfma_f32_16x16x32_bf16 v[76:79], v[44:47], a[172:175], v[76:79]
s_add_u32 m0, s21, 122880
s_xor_b32 s20, s23, 1792
buffer_load_dwordx4 v6, s[8:11], s20 offen lds
s_waitcnt lgkmcnt(5)
v_mfma_f32_16x16x32_bf16 v[64:67], v[48:51], a[176:179], v[64:67]
ds_read_b128 v[40:43], v17 offset:49152
v_mfma_f32_16x16x32_bf16 v[68:71], v[48:51], a[180:183], v[68:71]
s_waitcnt lgkmcnt(5)
v_mfma_f32_16x16x32_bf16 v[72:75], v[52:55], a[176:179], v[72:75]
ds_read_b128 v[44:47], v17 offset:53248
v_mfma_f32_16x16x32_bf16 v[76:79], v[52:55], a[180:183], v[76:79]
s_waitcnt lgkmcnt(5)
v_mfma_f32_16x16x32_bf16 v[64:67], v[56:59], a[184:187], v[64:67]
ds_read_b128 v[48:51], v18 offset:49152
v_mfma_f32_16x16x32_bf16 v[68:71], v[56:59], a[188:191], v[68:71]
s_add_u32 m0, s21, 123904
s_xor_b32 s20, s23, 1792
buffer_load_dwordx4 v7, s[8:11], s20 offen lds
s_waitcnt lgkmcnt(5)
v_mfma_f32_16x16x32_bf16 v[72:75], v[60:63], a[184:187], v[72:75]
ds_read_b128 v[52:55], v18 offset:53248
v_mfma_f32_16x16x32_bf16 v[76:79], v[60:63], a[188:191], v[76:79]
s_waitcnt lgkmcnt(5)
v_mfma_f32_16x16x32_bf16 v[64:67], v[32:35], a[192:195], v[64:67]
ds_read_b128 v[56:59], v19 offset:49152
v_mfma_f32_16x16x32_bf16 v[68:71], v[32:35], a[196:199], v[68:71]
s_waitcnt lgkmcnt(5)
v_mfma_f32_16x16x32_bf16 v[72:75], v[36:39], a[192:195], v[72:75]
ds_read_b128 v[60:63], v19 offset:53248
v_mfma_f32_16x16x32_bf16 v[76:79], v[36:39], a[196:199], v[76:79]
s_waitcnt lgkmcnt(5)
v_mfma_f32_16x16x32_bf16 v[64:67], v[40:43], a[200:203], v[64:67]
ds_read_b128 v[32:35], v16 offset:57344
v_mfma_f32_16x16x32_bf16 v[68:71], v[40:43], a[204:207], v[68:71]
s_waitcnt lgkmcnt(5)
v_mfma_f32_16x16x32_bf16 v[72:75], v[44:47], a[200:203], v[72:75]
ds_read_b128 v[36:39], v16 offset:61440
v_mfma_f32_16x16x32_bf16 v[76:79], v[44:47], a[204:207], v[76:79]
s_waitcnt lgkmcnt(5)
v_mfma_f32_16x16x32_bf16 v[64:67], v[48:51], a[208:211], v[64:67]
ds_read_b128 v[40:43], v17 offset:57344
v_mfma_f32_16x16x32_bf16 v[68:71], v[48:51], a[212:215], v[68:71]
s_waitcnt lgkmcnt(5)
v_mfma_f32_16x16x32_bf16 v[72:75], v[52:55], a[208:211], v[72:75]
ds_read_b128 v[44:47], v17 offset:61440
v_mfma_f32_16x16x32_bf16 v[76:79], v[52:55], a[212:215], v[76:79]
s_waitcnt lgkmcnt(5)
v_mfma_f32_16x16x32_bf16 v[64:67], v[56:59], a[216:219], v[64:67]
ds_read_b128 v[48:51], v18 offset:57344
v_mfma_f32_16x16x32_bf16 v[68:71], v[56:59], a[220:223], v[68:71]
s_waitcnt lgkmcnt(5)
v_mfma_f32_16x16x32_bf16 v[72:75], v[60:63], a[216:219], v[72:75]
ds_read_b128 v[52:55], v18 offset:61440
v_mfma_f32_16x16x32_bf16 v[76:79], v[60:63], a[220:223], v[76:79]
s_waitcnt vmcnt(8)
s_barrier
s_waitcnt lgkmcnt(5)
v_mfma_f32_16x16x32_bf16 v[64:67], v[32:35], a[224:227], v[64:67]
ds_read_b128 v[56:59], v19 offset:57344
v_mfma_f32_16x16x32_bf16 v[68:71], v[32:35], a[228:231], v[68:71]
s_waitcnt lgkmcnt(5)
v_mfma_f32_16x16x32_bf16 v[72:75], v[36:39], a[224:227], v[72:75]
ds_read_b128 v[60:63], v19 offset:61440
v_mfma_f32_16x16x32_bf16 v[76:79], v[36:39], a[228:231], v[76:79]
s_add_u32 s23, s23, 131072
s_add_u32 m0, s21, 0
s_xor_b32 s20, s23, 0
buffer_load_dwordx4 v6, s[8:11], s20 offen lds
s_waitcnt lgkmcnt(5)
v_mfma_f32_16x16x32_bf16 v[64:67], v[40:43], a[232:235], v[64:67]
ds_read_b128 v[32:35], v20
v_mfma_f32_16x16x32_bf16 v[68:71], v[40:43], a[236:239], v[68:71]
s_cmp_eq_u32 s25, 0
s_cbranch_scc1 L_q_v_nf
v_add_u32 v10, 1, v10
buffer_store_dword v10, v9, s[84:87], 0 offen sc1
L_q_v_nf:
s_waitcnt lgkmcnt(5)
v_mfma_f32_16x16x32_bf16 v[72:75], v[44:47], a[232:235], v[72:75]
ds_read_b128 v[36:39], v20 offset:4096
v_mfma_f32_16x16x32_bf16 v[76:79], v[44:47], a[236:239], v[76:79]
s_waitcnt lgkmcnt(5)
v_mfma_f32_16x16x32_bf16 v[64:67], v[48:51], a[240:243], v[64:67]
ds_read_b128 v[40:43], v21
v_mfma_f32_16x16x32_bf16 v[68:71], v[48:51], a[244:247], v[68:71]
s_add_u32 m0, s21, 1024
s_xor_b32 s20, s23, 0
buffer_load_dwordx4 v7, s[8:11], s20 offen lds
s_waitcnt lgkmcnt(5)
v_mfma_f32_16x16x32_bf16 v[72:75], v[52:55], a[240:243], v[72:75]
ds_read_b128 v[44:47], v21 offset:4096
v_mfma_f32_16x16x32_bf16 v[76:79], v[52:55], a[244:247], v[76:79]
s_waitcnt lgkmcnt(5)
v_mfma_f32_16x16x32_bf16 v[64:67], v[56:59], a[248:251], v[64:67]
ds_read_b128 v[48:51], v22
v_mfma_f32_16x16x32_bf16 v[68:71], v[56:59], a[252:255], v[68:71]
s_waitcnt lgkmcnt(5)
v_mfma_f32_16x16x32_bf16 v[72:75], v[60:63], a[248:251], v[72:75]
ds_read_b128 v[52:55], v22 offset:4096
v_mfma_f32_16x16x32_bf16 v[76:79], v[60:63], a[252:255], v[76:79]
s_add_u32 m0, s21, 8192
s_xor_b32 s20, s23, 256
buffer_load_dwordx4 v6, s[8:11], s20 offen lds
s_waitcnt lgkmcnt(5)
v_mfma_f32_16x16x32_bf16 v[80:83], v[32:35], a[0:3], 0
ds_read_b128 v[56:59], v23
v_mfma_f32_16x16x32_bf16 v[84:87], v[32:35], a[4:7], 0
s_waitcnt lgkmcnt(5)
v_mfma_f32_16x16x32_bf16 v[88:91], v[36:39], a[0:3], 0
ds_read_b128 v[60:63], v23 offset:4096
v_mfma_f32_16x16x32_bf16 v[92:95], v[36:39], a[4:7], 0
s_waitcnt lgkmcnt(5)
v_mfma_f32_16x16x32_bf16 v[80:83], v[40:43], a[8:11], v[80:83]
ds_read_b128 v[32:35], v20 offset:8192
v_mfma_f32_16x16x32_bf16 v[84:87], v[40:43], a[12:15], v[84:87]
s_add_u32 m0, s21, 9216
s_xor_b32 s20, s23, 256
buffer_load_dwordx4 v7, s[8:11], s20 offen lds
s_waitcnt lgkmcnt(5)
v_mfma_f32_16x16x32_bf16 v[88:91], v[44:47], a[8:11], v[88:91]
ds_read_b128 v[36:39], v20 offset:12288
v_mfma_f32_16x16x32_bf16 v[92:95], v[44:47], a[12:15], v[92:95]
s_waitcnt lgkmcnt(5)
v_mfma_f32_16x16x32_bf16 v[80:83], v[48:51], a[16:19], v[80:83]
ds_read_b128 v[40:43], v21 offset:8192
v_mfma_f32_16x16x32_bf16 v[84:87], v[48:51], a[20:23], v[84:87]
s_waitcnt lgkmcnt(5)
v_mfma_f32_16x16x32_bf16 v[88:91], v[52:55], a[16:19], v[88:91]
ds_read_b128 v[44:47], v21 offset:12288
v_mfma_f32_16x16x32_bf16 v[92:95], v[52:55], a[20:23], v[92:95]
s_add_u32 m0, s21, 16384
s_xor_b32 s20, s23, 512
buffer_load_dwordx4 v6, s[8:11], s20 offen lds
s_waitcnt lgkmcnt(5)
v_mfma_f32_16x16x32_bf16 v[80:83], v[56:59], a[24:27], v[80:83]
ds_read_b128 v[48:51], v22 offset:8192
v_mfma_f32_16x16x32_bf16 v[84:87], v[56:59], a[28:31], v[84:87]
s_waitcnt lgkmcnt(5)
v_mfma_f32_16x16x32_bf16 v[88:91], v[60:63], a[24:27], v[88:91]
ds_read_b128 v[52:55], v22 offset:12288
v_mfma_f32_16x16x32_bf16 v[92:95], v[60:63], a[28:31], v[92:95]
s_waitcnt lgkmcnt(5)
v_mfma_f32_16x16x32_bf16 v[80:83], v[32:35], a[32:35], v[80:83]
ds_read_b128 v[56:59], v23 offset:8192
v_mfma_f32_16x16x32_bf16 v[84:87], v[32:35], a[36:39], v[84:87]
s_add_u32 m0, s21, 17408
s_xor_b32 s20, s23, 512
buffer_load_dwordx4 v7, s[8:11], s20 offen lds
s_waitcnt lgkmcnt(5)
v_mfma_f32_16x16x32_bf16 v[88:91], v[36:39], a[32:35], v[88:91]
ds_read_b128 v[60:63], v23 offset:12288
v_mfma_f32_16x16x32_bf16 v[92:95], v[36:39], a[36:39], v[92:95]
s_waitcnt lgkmcnt(5)
v_mfma_f32_16x16x32_bf16 v[80:83], v[40:43], a[40:43], v[80:83]
ds_read_b128 v[32:35], v20 offset:16384
v_mfma_f32_16x16x32_bf16 v[84:87], v[40:43], a[44:47], v[84:87]
s_waitcnt lgkmcnt(5)
v_mfma_f32_16x16x32_bf16 v[88:91], v[44:47], a[40:43], v[88:91]
ds_read_b128 v[36:39], v20 offset:20480
v_mfma_f32_16x16x32_bf16 v[92:95], v[44:47], a[44:47], v[92:95]
s_add_u32 m0, s21, 24576
s_xor_b32 s20, s23, 768
buffer_load_dwordx4 v6, s[8:11], s20 offen lds
s_waitcnt lgkmcnt(5)
v_mfma_f32_16x16x32_bf16 v[80:83], v[48:51], a[48:51], v[80:83]
ds_read_b128 v[40:43], v21 offset:16384
v_mfma_f32_16x16x32_bf16 v[84:87], v[48:51], a[52:55], v[84:87]
s_waitcnt lgkmcnt(5)
v_mfma_f32_16x16x32_bf16 v[88:91], v[52:55], a[48:51], v[88:91]
ds_read_b128 v[44:47], v21 offset:20480
v_mfma_f32_16x16x32_bf16 v[92:95], v[52:55], a[52:55], v[92:95]
s_waitcnt lgkmcnt(5)
v_mfma_f32_16x16x32_bf16 v[80:83], v[56:59], a[56:59], v[80:83]
ds_read_b128 v[48:51], v22 offset:16384
v_mfma_f32_16x16x32_bf16 v[84:87], v[56:59], a[60:63], v[84:87]
s_add_u32 m0, s21, 25600
s_xor_b32 s20, s23, 768
buffer_load_dwordx4 v7, s[8:11], s20 offen lds
s_waitcnt lgkmcnt(5)
v_mfma_f32_16x16x32_bf16 v[88:91], v[60:63], a[56:59], v[88:91]
ds_read_b128 v[52:55], v22 offset:20480
v_mfma_f32_16x16x32_bf16 v[92:95], v[60:63], a[60:63], v[92:95]
v_cvt_pk_bf16_f32 v96, v64, v65
v_cvt_pk_bf16_f32 v97, v66, v67
s_waitcnt lgkmcnt(5)
v_mfma_f32_16x16x32_bf16 v[80:83], v[32:35], a[64:67], v[80:83]
ds_read_b128 v[56:59], v23 offset:16384
v_mfma_f32_16x16x32_bf16 v[84:87], v[32:35], a[68:71], v[84:87]
v_cvt_pk_bf16_f32 v98, v72, v73
v_cvt_pk_bf16_f32 v99, v74, v75
s_waitcnt lgkmcnt(5)
v_mfma_f32_16x16x32_bf16 v[88:91], v[36:39], a[64:67], v[88:91]
ds_read_b128 v[60:63], v23 offset:20480
v_mfma_f32_16x16x32_bf16 v[92:95], v[36:39], a[68:71], v[92:95]
buffer_store_dwordx4 v[96:99], v8, s[84:87], s24 offen sc1
v_cvt_pk_bf16_f32 v100, v68, v69
s_waitcnt lgkmcnt(5)
v_mfma_f32_16x16x32_bf16 v[80:83], v[40:43], a[72:75], v[80:83]
ds_read_b128 v[32:35], v20 offset:24576
v_mfma_f32_16x16x32_bf16 v[84:87], v[40:43], a[76:79], v[84:87]
v_cvt_pk_bf16_f32 v101, v70, v71
v_cvt_pk_bf16_f32 v102, v76, v77
s_waitcnt lgkmcnt(5)
v_mfma_f32_16x16x32_bf16 v[88:91], v[44:47], a[72:75], v[88:91]
ds_read_b128 v[36:39], v20 offset:28672
v_mfma_f32_16x16x32_bf16 v[92:95], v[44:47], a[76:79], v[92:95]
v_cvt_pk_bf16_f32 v103, v78, v79
buffer_store_dwordx4 v[100:103], v8, s[84:87], s24 offen offset:1024 sc1
s_waitcnt lgkmcnt(5)
v_mfma_f32_16x16x32_bf16 v[80:83], v[48:51], a[80:83], v[80:83]
ds_read_b128 v[40:43], v21 offset:24576
v_mfma_f32_16x16x32_bf16 v[84:87], v[48:51], a[84:87], v[84:87]
s_add_u32 s24, s24, 524288
s_waitcnt lgkmcnt(5)
v_mfma_f32_16x16x32_bf16 v[88:91], v[52:55], a[80:83], v[88:91]
ds_read_b128 v[44:47], v21 offset:28672
v_mfma_f32_16x16x32_bf16 v[92:95], v[52:55], a[84:87], v[92:95]
s_waitcnt lgkmcnt(5)
v_mfma_f32_16x16x32_bf16 v[80:83], v[56:59], a[88:91], v[80:83]
ds_read_b128 v[48:51], v22 offset:24576
v_mfma_f32_16x16x32_bf16 v[84:87], v[56:59], a[92:95], v[84:87]
s_waitcnt lgkmcnt(5)
v_mfma_f32_16x16x32_bf16 v[88:91], v[60:63], a[88:91], v[88:91]
ds_read_b128 v[52:55], v22 offset:28672
v_mfma_f32_16x16x32_bf16 v[92:95], v[60:63], a[92:95], v[92:95]
s_waitcnt vmcnt(8)
s_barrier
s_waitcnt lgkmcnt(5)
v_mfma_f32_16x16x32_bf16 v[80:83], v[32:35], a[96:99], v[80:83]
ds_read_b128 v[56:59], v23 offset:24576
v_mfma_f32_16x16x32_bf16 v[84:87], v[32:35], a[100:103], v[84:87]
s_waitcnt lgkmcnt(5)
v_mfma_f32_16x16x32_bf16 v[88:91], v[36:39], a[96:99], v[88:91]
ds_read_b128 v[60:63], v23 offset:28672
v_mfma_f32_16x16x32_bf16 v[92:95], v[36:39], a[100:103], v[92:95]
s_add_u32 m0, s21, 32768
s_xor_b32 s20, s23, 1024
buffer_load_dwordx4 v6, s[8:11], s20 offen lds
s_waitcnt lgkmcnt(5)
v_mfma_f32_16x16x32_bf16 v[80:83], v[40:43], a[104:107], v[80:83]
ds_read_b128 v[32:35], v20 offset:32768
v_mfma_f32_16x16x32_bf16 v[84:87], v[40:43], a[108:111], v[84:87]
s_waitcnt lgkmcnt(5)
v_mfma_f32_16x16x32_bf16 v[88:91], v[44:47], a[104:107], v[88:91]
ds_read_b128 v[36:39], v20 offset:36864
v_mfma_f32_16x16x32_bf16 v[92:95], v[44:47], a[108:111], v[92:95]
s_waitcnt lgkmcnt(5)
v_mfma_f32_16x16x32_bf16 v[80:83], v[48:51], a[112:115], v[80:83]
ds_read_b128 v[40:43], v21 offset:32768
v_mfma_f32_16x16x32_bf16 v[84:87], v[48:51], a[116:119], v[84:87]
s_add_u32 m0, s21, 33792
s_xor_b32 s20, s23, 1024
buffer_load_dwordx4 v7, s[8:11], s20 offen lds
s_waitcnt lgkmcnt(5)
v_mfma_f32_16x16x32_bf16 v[88:91], v[52:55], a[112:115], v[88:91]
ds_read_b128 v[44:47], v21 offset:36864
v_mfma_f32_16x16x32_bf16 v[92:95], v[52:55], a[116:119], v[92:95]
s_waitcnt lgkmcnt(5)
v_mfma_f32_16x16x32_bf16 v[80:83], v[56:59], a[120:123], v[80:83]
ds_read_b128 v[48:51], v22 offset:32768
v_mfma_f32_16x16x32_bf16 v[84:87], v[56:59], a[124:127], v[84:87]
s_waitcnt lgkmcnt(5)
v_mfma_f32_16x16x32_bf16 v[88:91], v[60:63], a[120:123], v[88:91]
ds_read_b128 v[52:55], v22 offset:36864
v_mfma_f32_16x16x32_bf16 v[92:95], v[60:63], a[124:127], v[92:95]
s_add_u32 m0, s21, 40960
s_xor_b32 s20, s23, 1280
buffer_load_dwordx4 v6, s[8:11], s20 offen lds
s_waitcnt lgkmcnt(5)
v_mfma_f32_16x16x32_bf16 v[80:83], v[32:35], a[128:131], v[80:83]
ds_read_b128 v[56:59], v23 offset:32768
v_mfma_f32_16x16x32_bf16 v[84:87], v[32:35], a[132:135], v[84:87]
s_waitcnt lgkmcnt(5)
v_mfma_f32_16x16x32_bf16 v[88:91], v[36:39], a[128:131], v[88:91]
ds_read_b128 v[60:63], v23 offset:36864
v_mfma_f32_16x16x32_bf16 v[92:95], v[36:39], a[132:135], v[92:95]
s_waitcnt lgkmcnt(5)
v_mfma_f32_16x16x32_bf16 v[80:83], v[40:43], a[136:139], v[80:83]
ds_read_b128 v[32:35], v20 offset:40960
v_mfma_f32_16x16x32_bf16 v[84:87], v[40:43], a[140:143], v[84:87]
s_add_u32 m0, s21, 41984
s_xor_b32 s20, s23, 1280
buffer_load_dwordx4 v7, s[8:11], s20 offen lds
s_waitcnt lgkmcnt(5)
v_mfma_f32_16x16x32_bf16 v[88:91], v[44:47], a[136:139], v[88:91]
ds_read_b128 v[36:39], v20 offset:45056
v_mfma_f32_16x16x32_bf16 v[92:95], v[44:47], a[140:143], v[92:95]
s_waitcnt lgkmcnt(5)
v_mfma_f32_16x16x32_bf16 v[80:83], v[48:51], a[144:147], v[80:83]
ds_read_b128 v[40:43], v21 offset:40960
v_mfma_f32_16x16x32_bf16 v[84:87], v[48:51], a[148:151], v[84:87]
s_waitcnt lgkmcnt(5)
v_mfma_f32_16x16x32_bf16 v[88:91], v[52:55], a[144:147], v[88:91]
ds_read_b128 v[44:47], v21 offset:45056
v_mfma_f32_16x16x32_bf16 v[92:95], v[52:55], a[148:151], v[92:95]
s_add_u32 m0, s21, 49152
s_xor_b32 s20, s23, 1536
buffer_load_dwordx4 v6, s[8:11], s20 offen lds
s_waitcnt lgkmcnt(5)
v_mfma_f32_16x16x32_bf16 v[80:83], v[56:59], a[152:155], v[80:83]
ds_read_b128 v[48:51], v22 offset:40960
v_mfma_f32_16x16x32_bf16 v[84:87], v[56:59], a[156:159], v[84:87]
s_waitcnt lgkmcnt(5)
v_mfma_f32_16x16x32_bf16 v[88:91], v[60:63], a[152:155], v[88:91]
ds_read_b128 v[52:55], v22 offset:45056
v_mfma_f32_16x16x32_bf16 v[92:95], v[60:63], a[156:159], v[92:95]
s_waitcnt lgkmcnt(5)
v_mfma_f32_16x16x32_bf16 v[80:83], v[32:35], a[160:163], v[80:83]
ds_read_b128 v[56:59], v23 offset:40960
v_mfma_f32_16x16x32_bf16 v[84:87], v[32:35], a[164:167], v[84:87]
s_add_u32 m0, s21, 50176
s_xor_b32 s20, s23, 1536
buffer_load_dwordx4 v7, s[8:11], s20 offen lds
s_waitcnt lgkmcnt(5)
v_mfma_f32_16x16x32_bf16 v[88:91], v[36:39], a[160:163], v[88:91]
ds_read_b128 v[60:63], v23 offset:45056
v_mfma_f32_16x16x32_bf16 v[92:95], v[36:39], a[164:167], v[92:95]
s_waitcnt lgkmcnt(5)
v_mfma_f32_16x16x32_bf16 v[80:83], v[40:43], a[168:171], v[80:83]
ds_read_b128 v[32:35], v20 offset:49152
v_mfma_f32_16x16x32_bf16 v[84:87], v[40:43], a[172:175], v[84:87]
s_waitcnt lgkmcnt(5)
v_mfma_f32_16x16x32_bf16 v[88:91], v[44:47], a[168:171], v[88:91]
ds_read_b128 v[36:39], v20 offset:53248
v_mfma_f32_16x16x32_bf16 v[92:95], v[44:47], a[172:175], v[92:95]
s_add_u32 m0, s21, 57344
s_xor_b32 s20, s23, 1792
buffer_load_dwordx4 v6, s[8:11], s20 offen lds
s_waitcnt lgkmcnt(5)
v_mfma_f32_16x16x32_bf16 v[80:83], v[48:51], a[176:179], v[80:83]
ds_read_b128 v[40:43], v21 offset:49152
v_mfma_f32_16x16x32_bf16 v[84:87], v[48:51], a[180:183], v[84:87]
s_waitcnt lgkmcnt(5)
v_mfma_f32_16x16x32_bf16 v[88:91], v[52:55], a[176:179], v[88:91]
ds_read_b128 v[44:47], v21 offset:53248
v_mfma_f32_16x16x32_bf16 v[92:95], v[52:55], a[180:183], v[92:95]
s_waitcnt lgkmcnt(5)
v_mfma_f32_16x16x32_bf16 v[80:83], v[56:59], a[184:187], v[80:83]
ds_read_b128 v[48:51], v22 offset:49152
v_mfma_f32_16x16x32_bf16 v[84:87], v[56:59], a[188:191], v[84:87]
s_add_u32 m0, s21, 58368
s_xor_b32 s20, s23, 1792
buffer_load_dwordx4 v7, s[8:11], s20 offen lds
s_waitcnt lgkmcnt(5)
v_mfma_f32_16x16x32_bf16 v[88:91], v[60:63], a[184:187], v[88:91]
ds_read_b128 v[52:55], v22 offset:53248
v_mfma_f32_16x16x32_bf16 v[92:95], v[60:63], a[188:191], v[92:95]
s_waitcnt lgkmcnt(5)
v_mfma_f32_16x16x32_bf16 v[80:83], v[32:35], a[192:195], v[80:83]
ds_read_b128 v[56:59], v23 offset:49152
v_mfma_f32_16x16x32_bf16 v[84:87], v[32:35], a[196:199], v[84:87]
s_waitcnt lgkmcnt(5)
v_mfma_f32_16x16x32_bf16 v[88:91], v[36:39], a[192:195], v[88:91]
ds_read_b128 v[60:63], v23 offset:53248
v_mfma_f32_16x16x32_bf16 v[92:95], v[36:39], a[196:199], v[92:95]
s_waitcnt lgkmcnt(5)
v_mfma_f32_16x16x32_bf16 v[80:83], v[40:43], a[200:203], v[80:83]
ds_read_b128 v[32:35], v20 offset:57344
v_mfma_f32_16x16x32_bf16 v[84:87], v[40:43], a[204:207], v[84:87]
s_waitcnt lgkmcnt(5)
v_mfma_f32_16x16x32_bf16 v[88:91], v[44:47], a[200:203], v[88:91]
ds_read_b128 v[36:39], v20 offset:61440
v_mfma_f32_16x16x32_bf16 v[92:95], v[44:47], a[204:207], v[92:95]
s_waitcnt lgkmcnt(5)
v_mfma_f32_16x16x32_bf16 v[80:83], v[48:51], a[208:211], v[80:83]
ds_read_b128 v[40:43], v21 offset:57344
v_mfma_f32_16x16x32_bf16 v[84:87], v[48:51], a[212:215], v[84:87]
s_waitcnt lgkmcnt(5)
v_mfma_f32_16x16x32_bf16 v[88:91], v[52:55], a[208:211], v[88:91]
ds_read_b128 v[44:47], v21 offset:61440
v_mfma_f32_16x16x32_bf16 v[92:95], v[52:55], a[212:215], v[92:95]
s_waitcnt lgkmcnt(5)
v_mfma_f32_16x16x32_bf16 v[80:83], v[56:59], a[216:219], v[80:83]
ds_read_b128 v[48:51], v22 offset:57344
v_mfma_f32_16x16x32_bf16 v[84:87], v[56:59], a[220:223], v[84:87]
s_waitcnt lgkmcnt(5)
v_mfma_f32_16x16x32_bf16 v[88:91], v[60:63], a[216:219], v[88:91]
ds_read_b128 v[52:55], v22 offset:61440
v_mfma_f32_16x16x32_bf16 v[92:95], v[60:63], a[220:223], v[92:95]
s_waitcnt vmcnt(8)
s_barrier
s_waitcnt lgkmcnt(5)
v_mfma_f32_16x16x32_bf16 v[80:83], v[32:35], a[224:227], v[80:83]
ds_read_b128 v[56:59], v23 offset:57344
v_mfma_f32_16x16x32_bf16 v[84:87], v[32:35], a[228:231], v[84:87]
s_waitcnt lgkmcnt(5)
v_mfma_f32_16x16x32_bf16 v[88:91], v[36:39], a[224:227], v[88:91]
ds_read_b128 v[60:63], v23 offset:61440
v_mfma_f32_16x16x32_bf16 v[92:95], v[36:39], a[228:231], v[92:95]
s_add_u32 s23, s23, 131072
s_add_u32 m0, s21, 65536
s_xor_b32 s20, s23, 0
buffer_load_dwordx4 v6, s[8:11], s20 offen lds
s_waitcnt lgkmcnt(5)
v_mfma_f32_16x16x32_bf16 v[80:83], v[40:43], a[232:235], v[80:83]
ds_read_b128 v[32:35], v16
v_mfma_f32_16x16x32_bf16 v[84:87], v[40:43], a[236:239], v[84:87]
v_add_u32 v10, 1, v10
buffer_store_dword v10, v9, s[84:87], 0 offen sc1
s_waitcnt lgkmcnt(5)
v_mfma_f32_16x16x32_bf16 v[88:91], v[44:47], a[232:235], v[88:91]
ds_read_b128 v[36:39], v16 offset:4096
v_mfma_f32_16x16x32_bf16 v[92:95], v[44:47], a[236:239], v[92:95]
s_waitcnt lgkmcnt(5)
v_mfma_f32_16x16x32_bf16 v[80:83], v[48:51], a[240:243], v[80:83]
ds_read_b128 v[40:43], v17
v_mfma_f32_16x16x32_bf16 v[84:87], v[48:51], a[244:247], v[84:87]
s_add_u32 m0, s21, 66560
s_xor_b32 s20, s23, 0
buffer_load_dwordx4 v7, s[8:11], s20 offen lds
s_waitcnt lgkmcnt(5)
v_mfma_f32_16x16x32_bf16 v[88:91], v[52:55], a[240:243], v[88:91]
ds_read_b128 v[44:47], v17 offset:4096
v_mfma_f32_16x16x32_bf16 v[92:95], v[52:55], a[244:247], v[92:95]
s_waitcnt lgkmcnt(5)
v_mfma_f32_16x16x32_bf16 v[80:83], v[56:59], a[248:251], v[80:83]
ds_read_b128 v[48:51], v18
v_mfma_f32_16x16x32_bf16 v[84:87], v[56:59], a[252:255], v[84:87]
s_waitcnt lgkmcnt(5)
v_mfma_f32_16x16x32_bf16 v[88:91], v[60:63], a[248:251], v[88:91]
ds_read_b128 v[52:55], v18 offset:4096
v_mfma_f32_16x16x32_bf16 v[92:95], v[60:63], a[252:255], v[92:95]
s_add_u32 m0, s21, 73728
s_xor_b32 s20, s23, 256
buffer_load_dwordx4 v6, s[8:11], s20 offen lds
s_add_u32 s25, s25, 1
s_cmp_lt_u32 s25, 16
s_cbranch_scc1 L_q_v_loop
s_nop 11
v_cvt_pk_bf16_f32 v96, v80, v81
v_cvt_pk_bf16_f32 v97, v82, v83
v_cvt_pk_bf16_f32 v98, v88, v89
v_cvt_pk_bf16_f32 v99, v90, v91
buffer_store_dwordx4 v[96:99], v8, s[84:87], s24 offen sc1
v_cvt_pk_bf16_f32 v100, v84, v85
v_cvt_pk_bf16_f32 v101, v86, v87
v_cvt_pk_bf16_f32 v102, v92, v93
v_cvt_pk_bf16_f32 v103, v94, v95
buffer_store_dwordx4 v[100:103], v8, s[84:87], s24 offen offset:1024 sc1
s_add_u32 s24, s24, 524288
s_waitcnt vmcnt(0) lgkmcnt(0)
s_barrier
v_add_u32 v10, 1, v10
buffer_store_dword v10, v9, s[84:87], 0 offen sc1
L_q_done:
s_cmp_lg_u32 s17, 1
s_cbranch_scc1 L_q_end
s_mov_b32 s29, 32
s_branch L_q_again
L_q_end:
s_branch L_wl
L_fft:
s_waitcnt vmcnt(0)
s_barrier
s_or_b32 s81, s97, s98
s_cmp_lg_u32 s81, 0
s_cbranch_scc1 L_h0_5
s_lshl_b32 s81, s93, 5
v_mov_b32 v38, 1
s_mov_b64 exec, 1
buffer_atomic_add v38, off, s[88:91], s81 sc1
s_mov_b64 exec, -1
L_h0_5:
v_and_b32 v37, 7, v0
v_lshlrev_b32 v37, 5, v37
buffer_load_dword v36, v37, s[88:91], 0 offen sc1
s_waitcnt vmcnt(0)
s_cmp_lg_u32 s97, 0
s_cbranch_scc1 L_h2_6_ok
L_h2_6_ev:
v_cmp_ne_u32 vcc, 32, v36
s_cbranch_vccz L_h2_6_ok
s_mov_b32 s78, 0
v_readlane_b32 s81, v36, 0
s_nop 3
s_add_u32 s78, s78, s81
v_readlane_b32 s81, v36, 1
s_nop 3
s_add_u32 s78, s78, s81
v_readlane_b32 s81, v36, 2
s_nop 3
s_add_u32 s78, s78, s81
v_readlane_b32 s81, v36, 3
s_nop 3
s_add_u32 s78, s78, s81
v_readlane_b32 s81, v36, 4
s_nop 3
s_add_u32 s78, s78, s81
v_readlane_b32 s81, v36, 5
s_nop 3
s_add_u32 s78, s78, s81
v_readlane_b32 s81, v36, 6
s_nop 3
s_add_u32 s78, s78, s81
v_readlane_b32 s81, v36, 7
s_nop 3
s_add_u32 s78, s78, s81
s_cmp_eq_u32 s78, 256
s_cbranch_scc1 L_redo
buffer_load_dword v36, v37, s[88:91], 0 offen sc1
s_waitcnt vmcnt(0)
s_branch L_h2_6_ev
L_h2_6_ok:
s_mov_b32 s97, 1
s_mov_b32 s99, s92
L_f2l:
s_load_dwordx2 s[4:5], s[0:1], 64
s_load_dwordx2 s[8:9], s[0:1], 72
s_barrier
v_mul_u32_u24 v1, 1026, v0
v_and_b32 v2, 1, v0
v_lshlrev_b32 v2, 4, v2
v_and_b32 v1, -4, v1
v_lshlrev_b32 v3, 4, v0
s_lshl_b32 s12, s99, 4
s_waitcnt lgkmcnt(0)
s_mov_b32 s6, 2101248
s_mov_b32 s7, 0x00020000
s_mov_b32 s10, 2101248
s_mov_b32 s11, 0x00020000
s_add_u32 s13, s12, 0
buffer_load_dwordx4 v[16:19], v1, s[4:7], s13 offen
buffer_load_dword v20, v1, s[4:7], s13 offen offset:16
s_add_u32 s13, s12, 262656
buffer_load_dwordx4 v[22:25], v1, s[4:7], s13 offen
buffer_load_dword v26, v1, s[4:7], s13 offen offset:16
s_add_u32 s13, s12, 525312
buffer_load_dwordx4 v[28:31], v1, s[4:7], s13 offen
buffer_load_dword v32, v1, s[4:7], s13 offen offset:16
s_add_u32 s13, s12, 787968
buffer_load_dwordx4 v[34:37], v1, s[4:7], s13 offen
buffer_load_dword v38, v1, s[4:7], s13 offen offset:16
s_add_u32 s13, s12, 1050624
buffer_load_dwordx4 v[40:43], v1, s[4:7], s13 offen
buffer_load_dword v44, v1, s[4:7], s13 offen offset:16
s_add_u32 s13, s12, 1313280
buffer_load_dwordx4 v[46:49], v1, s[4:7], s13 offen
buffer_load_dword v50, v1, s[4:7], s13 offen offset:16
s_add_u32 s13, s12, 1575936
buffer_load_dwordx4 v[52:55], v1, s[4:7], s13 offen
buffer_load_dword v56, v1, s[4:7], s13 offen offset:16
s_add_u32 s13, s12, 1838592
buffer_load_dwordx4 v[58:61], v1, s[4:7], s13 offen
buffer_load_dword v62, v1, s[4:7], s13 offen offset:16
s_add_u32 s13, s12, 0
buffer_load_dwordx4 v[64:67], v1, s[8:11], s13 offen
buffer_load_dword v68, v1, s[8:11], s13 offen offset:16
s_add_u32 s13, s12, 262656
buffer_load_dwordx4 v[70:73], v1, s[8:11], s13 offen
buffer_load_dword v74, v1, s[8:11], s13 offen offset:16
s_add_u32 s13, s12, 525312
buffer_load_dwordx4 v[76:79], v1, s[8:11], s13 offen
buffer_load_dword v80, v1, s[8:11], s13 offen offset:16
s_add_u32 s13, s12, 787968
buffer_load_dwordx4 v[82:85], v1, s[8:11], s13 offen
buffer_load_dword v86, v1, s[8:11], s13 offen offset:16
s_add_u32 s13, s12, 1050624
buffer_load_dwordx4 v[88:91], v1, s[8:11], s13 offen
buffer_load_dword v92, v1, s[8:11], s13 offen offset:16
s_add_u32 s13, s12, 1313280
buffer_load_dwordx4 v[94:97], v1, s[8:11], s13 offen
buffer_load_dword v98, v1, s[8:11], s13 offen offset:16
s_add_u32 s13, s12, 1575936
buffer_load_dwordx4 v[100:103], v1, s[8:11], s13 offen
buffer_load_dword v104, v1, s[8:11], s13 offen offset:16
s_add_u32 s13, s12, 1838592
buffer_load_dwordx4 v[106:109], v1, s[8:11], s13 offen
buffer_load_dword v110, v1, s[8:11], s13 offen offset:16
s_waitcnt vmcnt(30)
v_alignbit_b32 v16, v17, v16, v2
v_alignbit_b32 v17, v18, v17, v2
v_alignbit_b32 v18, v19, v18, v2
v_alignbit_b32 v19, v20, v19, v2
ds_write_b128 v3, v[16:19]
s_waitcnt vmcnt(28)
v_alignbit_b32 v22, v23, v22, v2
v_alignbit_b32 v23, v24, v23, v2
v_alignbit_b32 v24, v25, v24, v2
v_alignbit_b32 v25, v26, v25, v2
ds_write_b128 v3, v[22:25] offset:4096
s_waitcnt vmcnt(26)
v_alignbit_b32 v28, v29, v28, v2
v_alignbit_b32 v29, v30, v29, v2
v_alignbit_b32 v30, v31, v30, v2
v_alignbit_b32 v31, v32, v31, v2
ds_write_b128 v3, v[28:31] offset:8192
s_waitcnt vmcnt(24)
v_alignbit_b32 v34, v35, v34, v2
v_alignbit_b32 v35, v36, v35, v2
v_alignbit_b32 v36, v37, v36, v2
v_alignbit_b32 v37, v38, v37, v2
ds_write_b128 v3, v[34:37] offset:12288
s_waitcnt vmcnt(22)
v_alignbit_b32 v40, v41, v40, v2
v_alignbit_b32 v41, v42, v41, v2
v_alignbit_b32 v42, v43, v42, v2
v_alignbit_b32 v43, v44, v43, v2
ds_write_b128 v3, v[40:43] offset:16384
s_waitcnt vmcnt(20)
v_alignbit_b32 v46, v47, v46, v2
v_alignbit_b32 v47, v48, v47, v2
v_alignbit_b32 v48, v49, v48, v2
v_alignbit_b32 v49, v50, v49, v2
ds_write_b128 v3, v[46:49] offset:20480
s_waitcnt vmcnt(18)
v_alignbit_b32 v52, v53, v52, v2
v_alignbit_b32 v53, v54, v53, v2
v_alignbit_b32 v54, v55, v54, v2
v_alignbit_b32 v55, v56, v55, v2
ds_write_b128 v3, v[52:55] offset:24576
s_waitcnt vmcnt(16)
v_alignbit_b32 v58, v59, v58, v2
v_alignbit_b32 v59, v60, v59, v2
v_alignbit_b32 v60, v61, v60, v2
v_alignbit_b32 v61, v62, v61, v2
ds_write_b128 v3, v[58:61] offset:28672
s_waitcnt vmcnt(14)
v_alignbit_b32 v64, v65, v64, v2
v_alignbit_b32 v65, v66, v65, v2
v_alignbit_b32 v66, v67, v66, v2
v_alignbit_b32 v67, v68, v67, v2
ds_write_b128 v3, v[64:67] offset:32768
s_waitcnt vmcnt(12)
v_alignbit_b32 v70, v71, v70, v2
v_alignbit_b32 v71, v72, v71, v2
v_alignbit_b32 v72, v73, v72, v2
v_alignbit_b32 v73, v74, v73, v2
ds_write_b128 v3, v[70:73] offset:36864
s_waitcnt vmcnt(10)
v_alignbit_b32 v76, v77, v76, v2
v_alignbit_b32 v77, v78, v77, v2
v_alignbit_b32 v78, v79, v78, v2
v_alignbit_b32 v79, v80, v79, v2
ds_write_b128 v3, v[76:79] offset:40960
s_waitcnt vmcnt(8)
v_alignbit_b32 v82, v83, v82, v2
v_alignbit_b32 v83, v84, v83, v2
v_alignbit_b32 v84, v85, v84, v2
v_alignbit_b32 v85, v86, v85, v2
ds_write_b128 v3, v[82:85] offset:45056
s_waitcnt vmcnt(6)
v_alignbit_b32 v88, v89, v88, v2
v_alignbit_b32 v89, v90, v89, v2
v_alignbit_b32 v90, v91, v90, v2
v_alignbit_b32 v91, v92, v91, v2
ds_write_b128 v3, v[88:91] offset:49152
s_waitcnt vmcnt(4)
v_alignbit_b32 v94, v95, v94, v2
v_alignbit_b32 v95, v96, v95, v2
v_alignbit_b32 v96, v97, v96, v2
v_alignbit_b32 v97, v98, v97, v2
ds_write_b128 v3, v[94:97] offset:53248
s_waitcnt vmcnt(2)
v_alignbit_b32 v100, v101, v100, v2
v_alignbit_b32 v101, v102, v101, v2
v_alignbit_b32 v102, v103, v102, v2
v_alignbit_b32 v103, v104, v103, v2
ds_write_b128 v3, v[100:103] offset:57344
s_waitcnt vmcnt(0)
v_alignbit_b32 v106, v107, v106, v2
v_alignbit_b32 v107, v108, v107, v2
v_alignbit_b32 v108, v109, v108, v2
v_alignbit_b32 v109, v110, v109, v2
ds_write_b128 v3, v[106:109] offset:61440
v_and_b32 v1, 1, v0
v_bfe_u32 v2, v0, 1, 5
v_lshlrev_b32 v1, 14, v1
v_lshl_add_u32 v1, v2, 4, v1
v_lshrrev_b32 v2, 6, v0
v_lshl_add_u32 v1, v2, 2, v1
s_waitcnt lgkmcnt(0)
s_barrier
ds_read_b32 v160, v1
ds_read_b32 v161, v1 offset:512
ds_read_b32 v162, v1 offset:1024
ds_read_b32 v163, v1 offset:1536
ds_read_b32 v164, v1 offset:2048
ds_read_b32 v165, v1 offset:2560
ds_read_b32 v166, v1 offset:3072
ds_read_b32 v167, v1 offset:3584
s_waitcnt lgkmcnt(6)
ds_read_b32 v168, v1 offset:4096
ds_read_b32 v169, v1 offset:4608
ds_read_b32 v170, v1 offset:5120
ds_read_b32 v171, v1 offset:5632
ds_read_b32 v172, v1 offset:6144
ds_read_b32 v173, v1 offset:6656
ds_read_b32 v174, v1 offset:7168
ds_read_b32 v175, v1 offset:7680
s_waitcnt lgkmcnt(6)
ds_read_b32 v176, v1 offset:8192
ds_read_b32 v177, v1 offset:8704
ds_read_b32 v178, v1 offset:9216
ds_read_b32 v179, v1 offset:9728
ds_read_b32 v180, v1 offset:10240
ds_read_b32 v181, v1 offset:10752
ds_read_b32 v182, v1 offset:11264
ds_read_b32 v183, v1 offset:11776
s_waitcnt lgkmcnt(6)
ds_read_b32 v184, v1 offset:12288
ds_read_b32 v185, v1 offset:12800
ds_read_b32 v186, v1 offset:13312
ds_read_b32 v187, v1 offset:13824
ds_read_b32 v188, v1 offset:14336
ds_read_b32 v189, v1 offset:14848
ds_read_b32 v190, v1 offset:15360
ds_read_b32 v191, v1 offset:15872
s_waitcnt lgkmcnt(6)
ds_read_b32 v192, v1 offset:32768
ds_read_b32 v193, v1 offset:33280
ds_read_b32 v194, v1 offset:33792
ds_read_b32 v195, v1 offset:34304
ds_read_b32 v196, v1 offset:34816
ds_read_b32 v197, v1 offset:35328
ds_read_b32 v198, v1 offset:35840
ds_read_b32 v199, v1 offset:36352
s_waitcnt lgkmcnt(6)
ds_read_b32 v200, v1 offset:36864
ds_read_b32 v201, v1 offset:37376
ds_read_b32 v202, v1 offset:37888
ds_read_b32 v203, v1 offset:38400
ds_read_b32 v204, v1 offset:38912
ds_read_b32 v205, v1 offset:39424
ds_read_b32 v206, v1 offset:39936
ds_read_b32 v207, v1 offset:40448
s_waitcnt lgkmcnt(6)
ds_read_b32 v208, v1 offset:40960
ds_read_b32 v209, v1 offset:41472
ds_read_b32 v210, v1 offset:41984
ds_read_b32 v211, v1 offset:42496
ds_read_b32 v212, v1 offset:43008
ds_read_b32 v213, v1 offset:43520
ds_read_b32 v214, v1 offset:44032
ds_read_b32 v215, v1 offset:44544
s_waitcnt lgkmcnt(6)
ds_read_b32 v216, v1 offset:45056
ds_read_b32 v217, v1 offset:45568
ds_read_b32 v218, v1 offset:46080
ds_read_b32 v219, v1 offset:46592
ds_read_b32 v220, v1 offset:47104
ds_read_b32 v221, v1 offset:47616
ds_read_b32 v222, v1 offset:48128
ds_read_b32 v223, v1 offset:48640
s_waitcnt lgkmcnt(6)
s_waitcnt lgkmcnt(0)
s_cmp_eq_u32 s99, 64
s_cbranch_scc1 L_f2go
s_barrier
s_load_dwordx2 s[4:5], s[0:1], 56
s_mov_b32 s30, 0x3f7b14be
s_mov_b32 s31, 0x3f6c835e
s_mov_b32 s32, 0x3f54db31
s_mov_b32 s33, 0x3f3504f3
s_mov_b32 s34, 0x3f0e39da
s_mov_b32 s35, 0x3ec3ef15
s_mov_b32 s36, 0x3e47c5c2
v_and_b32 v1, 31, v0
v_lshrrev_b32 v2, 5, v0
v_cvt_f32_u32 v3, v1
v_mul_u32_u24 v6, 16896, v2
v_lshl_add_u32 v4, v1, 4, v6
v_mul_u32_u24 v5, 528, v1
v_add_u32 v5, v5, v6
v_mov_b64 v[16:17], 0
v_mov_b64 v[18:19], 0
v_mov_b64 v[20:21], 0
v_mov_b64 v[22:23], 0
v_mov_b64 v[24:25], 0
v_mov_b64 v[26:27], 0
v_mov_b64 v[28:29], 0
v_mov_b64 v[30:31], 0
v_mov_b64 v[32:33], 0
v_mov_b64 v[34:35], 0
v_mov_b64 v[36:37], 0
v_mov_b64 v[38:39], 0
v_mov_b64 v[40:41], 0
v_mov_b64 v[42:43], 0
v_mov_b64 v[44:45], 0
v_mov_b64 v[46:47], 0
v_mov_b64 v[48:49], 0
v_mov_b64 v[50:51], 0
v_mov_b64 v[52:53], 0
v_mov_b64 v[54:55], 0
v_mov_b64 v[56:57], 0
v_mov_b64 v[58:59], 0
v_mov_b64 v[60:61], 0
v_mov_b64 v[62:63], 0
v_mov_b64 v[64:65], 0
v_mov_b64 v[66:67], 0
v_mov_b64 v[68:69], 0
v_mov_b64 v[70:71], 0
v_mov_b64 v[72:73], 0
v_mov_b64 v[74:75], 0
v_mov_b64 v[76:77], 0
v_mov_b64 v[78:79], 0
v_mov_b64 v[80:81], 0
v_mov_b64 v[82:83], 0
v_mov_b64 v[84:85], 0
v_mov_b64 v[86:87], 0
v_mov_b64 v[88:89], 0
v_mov_b64 v[90:91], 0
v_mov_b64 v[92:93], 0
v_mov_b64 v[94:95], 0
v_mov_b64 v[96:97], 0
v_mov_b64 v[98:99], 0
v_mov_b64 v[100:101], 0
v_mov_b64 v[102:103], 0
v_mov_b64 v[104:105], 0
v_mov_b64 v[106:107], 0
v_mov_b64 v[108:109], 0
v_mov_b64 v[110:111], 0
v_mov_b64 v[112:113], 0
v_mov_b64 v[114:115], 0
v_mov_b64 v[116:117], 0
v_mov_b64 v[118:119], 0
v_mov_b64 v[120:121], 0
v_mov_b64 v[122:123], 0
v_mov_b64 v[124:125], 0
v_mov_b64 v[126:127], 0
v_mov_b64 v[128:129], 0
v_mov_b64 v[130:131], 0
v_mov_b64 v[132:133], 0
v_mov_b64 v[134:135], 0
v_mov_b64 v[136:137], 0
v_mov_b64 v[138:139], 0
v_mov_b64 v[140:141], 0
v_mov_b64 v[142:143], 0
v_lshlrev_b32 v7, 11, v2
v_lshl_add_u32 v7, v1, 1, v7
s_lshl_b32 s12, s92, 16
s_add_u32 s13, s12, 16384
s_add_u32 s14, s12, 32768
s_add_u32 s15, s12, 49152
s_waitcnt lgkmcnt(0)
s_mov_b32 s6, 4194304
s_mov_b32 s7, 0x00020000
buffer_load_short_d16_hi v16, v7, s[4:7], s12 offen
buffer_load_short_d16_hi v20, v7, s[4:7], s12 offen offset:64
buffer_load_short_d16_hi v24, v7, s[4:7], s12 offen offset:128
buffer_load_short_d16_hi v28, v7, s[4:7], s12 offen offset:192
buffer_load_short_d16_hi v32, v7, s[4:7], s12 offen offset:256
buffer_load_short_d16_hi v36, v7, s[4:7], s12 offen offset:320
buffer_load_short_d16_hi v40, v7, s[4:7], s12 offen offset:384
buffer_load_short_d16_hi v44, v7, s[4:7], s12 offen offset:448
buffer_load_short_d16_hi v48, v7, s[4:7], s12 offen offset:512
buffer_load_short_d16_hi v52, v7, s[4:7], s12 offen offset:576
buffer_load_short_d16_hi v56, v7, s[4:7], s12 offen offset:640
buffer_load_short_d16_hi v60, v7, s[4:7], s12 offen offset:704
buffer_load_short_d16_hi v64, v7, s[4:7], s12 offen offset:768
buffer_load_short_d16_hi v68, v7, s[4:7], s12 offen offset:832
buffer_load_short_d16_hi v72, v7, s[4:7], s12 offen offset:896
buffer_load_short_d16_hi v76, v7, s[4:7], s12 offen offset:960
buffer_load_short_d16_hi v80, v7, s[4:7], s12 offen offset:1024
buffer_load_short_d16_hi v84, v7, s[4:7], s12 offen offset:1088
buffer_load_short_d16_hi v88, v7, s[4:7], s12 offen offset:1152
buffer_load_short_d16_hi v92, v7, s[4:7], s12 offen offset:1216
buffer_load_short_d16_hi v96, v7, s[4:7], s12 offen offset:1280
buffer_load_short_d16_hi v100, v7, s[4:7], s12 offen offset:1344
buffer_load_short_d16_hi v104, v7, s[4:7], s12 offen offset:1408
buffer_load_short_d16_hi v108, v7, s[4:7], s12 offen offset:1472
buffer_load_short_d16_hi v112, v7, s[4:7], s12 offen offset:1536
buffer_load_short_d16_hi v116, v7, s[4:7], s12 offen offset:1600
buffer_load_short_d16_hi v120, v7, s[4:7], s12 offen offset:1664
buffer_load_short_d16_hi v124, v7, s[4:7], s12 offen offset:1728
buffer_load_short_d16_hi v128, v7, s[4:7], s12 offen offset:1792
buffer_load_short_d16_hi v132, v7, s[4:7], s12 offen offset:1856
buffer_load_short_d16_hi v136, v7, s[4:7], s12 offen offset:1920
buffer_load_short_d16_hi v140, v7, s[4:7], s12 offen offset:1984
buffer_load_short_d16_hi v18, v7, s[4:7], s13 offen
buffer_load_short_d16_hi v22, v7, s[4:7], s13 offen offset:64
buffer_load_short_d16_hi v26, v7, s[4:7], s13 offen offset:128
buffer_load_short_d16_hi v30, v7, s[4:7], s13 offen offset:192
buffer_load_short_d16_hi v34, v7, s[4:7], s13 offen offset:256
buffer_load_short_d16_hi v38, v7, s[4:7], s13 offen offset:320
buffer_load_short_d16_hi v42, v7, s[4:7], s13 offen offset:384
buffer_load_short_d16_hi v46, v7, s[4:7], s13 offen offset:448
buffer_load_short_d16_hi v50, v7, s[4:7], s13 offen offset:512
buffer_load_short_d16_hi v54, v7, s[4:7], s13 offen offset:576
buffer_load_short_d16_hi v58, v7, s[4:7], s13 offen offset:640
buffer_load_short_d16_hi v62, v7, s[4:7], s13 offen offset:704
buffer_load_short_d16_hi v66, v7, s[4:7], s13 offen offset:768
buffer_load_short_d16_hi v70, v7, s[4:7], s13 offen offset:832
buffer_load_short_d16_hi v74, v7, s[4:7], s13 offen offset:896
buffer_load_short_d16_hi v78, v7, s[4:7], s13 offen offset:960
buffer_load_short_d16_hi v82, v7, s[4:7], s13 offen offset:1024
buffer_load_short_d16_hi v86, v7, s[4:7], s13 offen offset:1088
buffer_load_short_d16_hi v90, v7, s[4:7], s13 offen offset:1152
buffer_load_short_d16_hi v94, v7, s[4:7], s13 offen offset:1216
buffer_load_short_d16_hi v98, v7, s[4:7], s13 offen offset:1280
buffer_load_short_d16_hi v102, v7, s[4:7], s13 offen offset:1344
buffer_load_short_d16_hi v106, v7, s[4:7], s13 offen offset:1408
buffer_load_short_d16_hi v110, v7, s[4:7], s13 offen offset:1472
buffer_load_short_d16_hi v114, v7, s[4:7], s13 offen offset:1536
buffer_load_short_d16_hi v118, v7, s[4:7], s13 offen offset:1600
buffer_load_short_d16_hi v122, v7, s[4:7], s13 offen offset:1664
buffer_load_short_d16_hi v126, v7, s[4:7], s13 offen offset:1728
buffer_load_short_d16_hi v130, v7, s[4:7], s13 offen offset:1792
buffer_load_short_d16_hi v134, v7, s[4:7], s13 offen offset:1856
buffer_load_short_d16_hi v138, v7, s[4:7], s13 offen offset:1920
buffer_load_short_d16_hi v142, v7, s[4:7], s13 offen offset:1984
buffer_load_short_d16_hi v17, v7, s[4:7], s14 offen
buffer_load_short_d16_hi v21, v7, s[4:7], s14 offen offset:64
buffer_load_short_d16_hi v25, v7, s[4:7], s14 offen offset:128
buffer_load_short_d16_hi v29, v7, s[4:7], s14 offen offset:192
buffer_load_short_d16_hi v33, v7, s[4:7], s14 offen offset:256
buffer_load_short_d16_hi v37, v7, s[4:7], s14 offen offset:320
buffer_load_short_d16_hi v41, v7, s[4:7], s14 offen offset:384
buffer_load_short_d16_hi v45, v7, s[4:7], s14 offen offset:448
buffer_load_short_d16_hi v49, v7, s[4:7], s14 offen offset:512
buffer_load_short_d16_hi v53, v7, s[4:7], s14 offen offset:576
buffer_load_short_d16_hi v57, v7, s[4:7], s14 offen offset:640
buffer_load_short_d16_hi v61, v7, s[4:7], s14 offen offset:704
buffer_load_short_d16_hi v65, v7, s[4:7], s14 offen offset:768
buffer_load_short_d16_hi v69, v7, s[4:7], s14 offen offset:832
buffer_load_short_d16_hi v73, v7, s[4:7], s14 offen offset:896
buffer_load_short_d16_hi v77, v7, s[4:7], s14 offen offset:960
buffer_load_short_d16_hi v81, v7, s[4:7], s14 offen offset:1024
buffer_load_short_d16_hi v85, v7, s[4:7], s14 offen offset:1088
buffer_load_short_d16_hi v89, v7, s[4:7], s14 offen offset:1152
buffer_load_short_d16_hi v93, v7, s[4:7], s14 offen offset:1216
buffer_load_short_d16_hi v97, v7, s[4:7], s14 offen offset:1280
buffer_load_short_d16_hi v101, v7, s[4:7], s14 offen offset:1344
buffer_load_short_d16_hi v105, v7, s[4:7], s14 offen offset:1408
buffer_load_short_d16_hi v109, v7, s[4:7], s14 offen offset:1472
buffer_load_short_d16_hi v113, v7, s[4:7], s14 offen offset:1536
buffer_load_short_d16_hi v117, v7, s[4:7], s14 offen offset:1600
buffer_load_short_d16_hi v121, v7, s[4:7], s14 offen offset:1664
buffer_load_short_d16_hi v125, v7, s[4:7], s14 offen offset:1728
buffer_load_short_d16_hi v129, v7, s[4:7], s14 offen offset:1792
buffer_load_short_d16_hi v133, v7, s[4:7], s14 offen offset:1856
buffer_load_short_d16_hi v137, v7, s[4:7], s14 offen offset:1920
buffer_load_short_d16_hi v141, v7, s[4:7], s14 offen offset:1984
buffer_load_short_d16_hi v19, v7, s[4:7], s15 offen
buffer_load_short_d16_hi v23, v7, s[4:7], s15 offen offset:64
buffer_load_short_d16_hi v27, v7, s[4:7], s15 offen offset:128
buffer_load_short_d16_hi v31, v7, s[4:7], s15 offen offset:192
buffer_load_short_d16_hi v35, v7, s[4:7], s15 offen offset:256
buffer_load_short_d16_hi v39, v7, s[4:7], s15 offen offset:320
buffer_load_short_d16_hi v43, v7, s[4:7], s15 offen offset:384
buffer_load_short_d16_hi v47, v7, s[4:7], s15 offen offset:448
buffer_load_short_d16_hi v51, v7, s[4:7], s15 offen offset:512
buffer_load_short_d16_hi v55, v7, s[4:7], s15 offen offset:576
buffer_load_short_d16_hi v59, v7, s[4:7], s15 offen offset:640
buffer_load_short_d16_hi v63, v7, s[4:7], s15 offen offset:704
buffer_load_short_d16_hi v67, v7, s[4:7], s15 offen offset:768
buffer_load_short_d16_hi v71, v7, s[4:7], s15 offen offset:832
buffer_load_short_d16_hi v75, v7, s[4:7], s15 offen offset:896
buffer_load_short_d16_hi v79, v7, s[4:7], s15 offen offset:960
buffer_load_short_d16_hi v83, v7, s[4:7], s15 offen offset:1024
buffer_load_short_d16_hi v87, v7, s[4:7], s15 offen offset:1088
buffer_load_short_d16_hi v91, v7, s[4:7], s15 offen offset:1152
buffer_load_short_d16_hi v95, v7, s[4:7], s15 offen offset:1216
buffer_load_short_d16_hi v99, v7, s[4:7], s15 offen offset:1280
buffer_load_short_d16_hi v103, v7, s[4:7], s15 offen offset:1344
buffer_load_short_d16_hi v107, v7, s[4:7], s15 offen offset:1408
buffer_load_short_d16_hi v111, v7, s[4:7], s15 offen offset:1472
buffer_load_short_d16_hi v115, v7, s[4:7], s15 offen offset:1536
buffer_load_short_d16_hi v119, v7, s[4:7], s15 offen offset:1600
buffer_load_short_d16_hi v123, v7, s[4:7], s15 offen offset:1664
buffer_load_short_d16_hi v127, v7, s[4:7], s15 offen offset:1728
buffer_load_short_d16_hi v131, v7, s[4:7], s15 offen offset:1792
buffer_load_short_d16_hi v135, v7, s[4:7], s15 offen offset:1856
buffer_load_short_d16_hi v139, v7, s[4:7], s15 offen offset:1920
buffer_load_short_d16_hi v143, v7, s[4:7], s15 offen offset:1984
s_waitcnt vmcnt(0)
v_pk_add_f32 v[144:145], v[16:17], v[80:81] neg_lo:[0,1] neg_hi:[0,1]
v_pk_add_f32 v[146:147], v[18:19], v[82:83] neg_lo:[0,1] neg_hi:[0,1]
v_pk_add_f32 v[16:17], v[16:17], v[80:81]
v_pk_add_f32 v[18:19], v[18:19], v[82:83]
v_pk_add_f32 v[80:81], v[20:21], v[84:85] neg_lo:[0,1] neg_hi:[0,1]
v_pk_add_f32 v[82:83], v[22:23], v[86:87] neg_lo:[0,1] neg_hi:[0,1]
v_pk_add_f32 v[20:21], v[20:21], v[84:85]
v_pk_add_f32 v[22:23], v[22:23], v[86:87]
v_pk_mul_f32 v[84:85], v[80:81], s[30:31] op_sel_hi:[1,0]
v_pk_mul_f32 v[86:87], v[80:81], s[36:37] op_sel_hi:[1,0] neg_lo:[0,1] neg_hi:[0,1]
v_pk_fma_f32 v[84:85], v[82:83], s[36:37], v[84:85] op_sel_hi:[1,0,1]
v_pk_fma_f32 v[86:87], v[82:83], s[30:31], v[86:87] op_sel_hi:[1,0,1]
v_pk_add_f32 v[80:81], v[24:25], v[88:89] neg_lo:[0,1] neg_hi:[0,1]
v_pk_add_f32 v[82:83], v[26:27], v[90:91] neg_lo:[0,1] neg_hi:[0,1]
v_pk_add_f32 v[24:25], v[24:25], v[88:89]
v_pk_add_f32 v[26:27], v[26:27], v[90:91]
v_pk_mul_f32 v[88:89], v[80:81], s[30:31] op_sel:[0,1]
v_pk_mul_f32 v[90:91], v[80:81], s[34:35] op_sel:[0,1] neg_lo:[0,1] neg_hi:[0,1]
v_pk_fma_f32 v[88:89], v[82:83], s[34:35], v[88:89] op_sel:[0,1,0]
v_pk_fma_f32 v[90:91], v[82:83], s[30:31], v[90:91] op_sel:[0,1,0]
v_pk_add_f32 v[80:81], v[28:29], v[92:93] neg_lo:[0,1] neg_hi:[0,1]
v_pk_add_f32 v[82:83], v[30:31], v[94:95] neg_lo:[0,1] neg_hi:[0,1]
v_pk_add_f32 v[28:29], v[28:29], v[92:93]
v_pk_add_f32 v[30:31], v[30:31], v[94:95]
v_pk_mul_f32 v[92:93], v[80:81], s[32:33] op_sel_hi:[1,0]
v_pk_mul_f32 v[94:95], v[80:81], s[34:35] op_sel_hi:[1,0] neg_lo:[0,1] neg_hi:[0,1]
v_pk_fma_f32 v[92:93], v[82:83], s[34:35], v[92:93] op_sel_hi:[1,0,1]
v_pk_fma_f32 v[94:95], v[82:83], s[32:33], v[94:95] op_sel_hi:[1,0,1]
v_pk_add_f32 v[80:81], v[32:33], v[96:97] neg_lo:[0,1] neg_hi:[0,1]
v_pk_add_f32 v[82:83], v[34:35], v[98:99] neg_lo:[0,1] neg_hi:[0,1]
v_pk_add_f32 v[32:33], v[32:33], v[96:97]
v_pk_add_f32 v[34:35], v[34:35], v[98:99]
v_pk_mul_f32 v[96:97], v[80:81], s[32:33] op_sel:[0,1]
v_pk_mul_f32 v[98:99], v[80:81], s[32:33] op_sel:[0,1] neg_lo:[0,1] neg_hi:[0,1]
v_pk_fma_f32 v[96:97], v[82:83], s[32:33], v[96:97] op_sel:[0,1,0]
v_pk_fma_f32 v[98:99], v[82:83], s[32:33], v[98:99] op_sel:[0,1,0]
v_pk_add_f32 v[80:81], v[36:37], v[100:101] neg_lo:[0,1] neg_hi:[0,1]
v_pk_add_f32 v[82:83], v[38:39], v[102:103] neg_lo:[0,1] neg_hi:[0,1]
v_pk_add_f32 v[36:37], v[36:37], v[100:101]
v_pk_add_f32 v[38:39], v[38:39], v[102:103]
v_pk_mul_f32 v[100:101], v[80:81], s[34:35] op_sel_hi:[1,0]
v_pk_mul_f32 v[102:103], v[80:81], s[32:33] op_sel_hi:[1,0] neg_lo:[0,1] neg_hi:[0,1]
v_pk_fma_f32 v[100:101], v[82:83], s[32:33], v[100:101] op_sel_hi:[1,0,1]
v_pk_fma_f32 v[102:103], v[82:83], s[34:35], v[102:103] op_sel_hi:[1,0,1]
v_pk_add_f32 v[80:81], v[40:41], v[104:105] neg_lo:[0,1] neg_hi:[0,1]
v_pk_add_f32 v[82:83], v[42:43], v[106:107] neg_lo:[0,1] neg_hi:[0,1]
v_pk_add_f32 v[40:41], v[40:41], v[104:105]
v_pk_add_f32 v[42:43], v[42:43], v[106:107]
v_pk_mul_f32 v[104:105], v[80:81], s[34:35] op_sel:[0,1]
v_pk_mul_f32 v[106:107], v[80:81], s[30:31] op_sel:[0,1] neg_lo:[0,1] neg_hi:[0,1]
v_pk_fma_f32 v[104:105], v[82:83], s[30:31], v[104:105] op_sel:[0,1,0]
v_pk_fma_f32 v[106:107], v[82:83], s[34:35], v[106:107] op_sel:[0,1,0]
v_pk_add_f32 v[80:81], v[44:45], v[108:109] neg_lo:[0,1] neg_hi:[0,1]
v_pk_add_f32 v[82:83], v[46:47], v[110:111] neg_lo:[0,1] neg_hi:[0,1]
v_pk_add_f32 v[44:45], v[44:45], v[108:109]
v_pk_add_f32 v[46:47], v[46:47], v[110:111]
v_pk_mul_f32 v[108:109], v[80:81], s[36:37] op_sel_hi:[1,0]
v_pk_mul_f32 v[110:111], v[80:81], s[30:31] op_sel_hi:[1,0] neg_lo:[0,1] neg_hi:[0,1]
v_pk_fma_f32 v[108:109], v[82:83], s[30:31], v[108:109] op_sel_hi:[1,0,1]
v_pk_fma_f32 v[110:111], v[82:83], s[36:37], v[110:111] op_sel_hi:[1,0,1]
v_pk_add_f32 v[80:81], v[50:51], v[114:115] neg_lo:[0,1] neg_hi:[0,1]
v_pk_add_f32 v[82:83], v[112:113], v[48:49] neg_lo:[0,1] neg_hi:[0,1]
v_pk_add_f32 v[48:49], v[48:49], v[112:113]
v_pk_add_f32 v[50:51], v[50:51], v[114:115]
v_pk_add_f32 v[112:113], v[52:53], v[116:117] neg_lo:[0,1] neg_hi:[0,1]
v_pk_add_f32 v[114:115], v[54:55], v[118:119] neg_lo:[0,1] neg_hi:[0,1]
v_pk_add_f32 v[52:53], v[52:53], v[116:117]
v_pk_add_f32 v[54:55], v[54:55], v[118:119]
v_pk_mul_f32 v[116:117], v[112:113], s[36:37] op_sel_hi:[1,0] neg_lo:[0,1] neg_hi:[0,1]
v_pk_mul_f32 v[118:119], v[112:113], s[30:31] op_sel_hi:[1,0] neg_lo:[0,1] neg_hi:[0,1]
v_pk_fma_f32 v[116:117], v[114:115], s[30:31], v[116:117] op_sel_hi:[1,0,1]
v_pk_fma_f32 v[118:119], v[114:115], s[36:37], v[118:119] op_sel_hi:[1,0,1] neg_lo:[0,1,0] neg_hi:[0,1,0]
v_pk_add_f32 v[112:113], v[56:57], v[120:121] neg_lo:[0,1] neg_hi:[0,1]
v_pk_add_f32 v[114:115], v[58:59], v[122:123] neg_lo:[0,1] neg_hi:[0,1]
v_pk_add_f32 v[56:57], v[56:57], v[120:121]
v_pk_add_f32 v[58:59], v[58:59], v[122:123]
v_pk_mul_f32 v[120:121], v[112:113], s[34:35] op_sel:[0,1] neg_lo:[0,1] neg_hi:[0,1]
v_pk_mul_f32 v[122:123], v[112:113], s[30:31] op_sel:[0,1] neg_lo:[0,1] neg_hi:[0,1]
v_pk_fma_f32 v[120:121], v[114:115], s[30:31], v[120:121] op_sel:[0,1,0]
v_pk_fma_f32 v[122:123], v[114:115], s[34:35], v[122:123] op_sel:[0,1,0] neg_lo:[0,1,0] neg_hi:[0,1,0]
v_pk_add_f32 v[112:113], v[60:61], v[124:125] neg_lo:[0,1] neg_hi:[0,1]
v_pk_add_f32 v[114:115], v[62:63], v[126:127] neg_lo:[0,1] neg_hi:[0,1]
v_pk_add_f32 v[60:61], v[60:61], v[124:125]
v_pk_add_f32 v[62:63], v[62:63], v[126:127]
v_pk_mul_f32 v[124:125], v[112:113], s[34:35] op_sel_hi:[1,0] neg_lo:[0,1] neg_hi:[0,1]
v_pk_mul_f32 v[126:127], v[112:113], s[32:33] op_sel_hi:[1,0] neg_lo:[0,1] neg_hi:[0,1]
v_pk_fma_f32 v[124:125], v[114:115], s[32:33], v[124:125] op_sel_hi:[1,0,1]
v_pk_fma_f32 v[126:127], v[114:115], s[34:35], v[126:127] op_sel_hi:[1,0,1] neg_lo:[0,1,0] neg_hi:[0,1,0]
v_pk_add_f32 v[112:113], v[64:65], v[128:129] neg_lo:[0,1] neg_hi:[0,1]
v_pk_add_f32 v[114:115], v[66:67], v[130:131] neg_lo:[0,1] neg_hi:[0,1]
v_pk_add_f32 v[64:65], v[64:65], v[128:129]
v_pk_add_f32 v[66:67], v[66:67], v[130:131]
v_pk_mul_f32 v[128:129], v[112:113], s[32:33] op_sel:[0,1] neg_lo:[0,1] neg_hi:[0,1]
v_pk_mul_f32 v[130:131], v[112:113], s[32:33] op_sel:[0,1] neg_lo:[0,1] neg_hi:[0,1]
v_pk_fma_f32 v[128:129], v[114:115], s[32:33], v[128:129] op_sel:[0,1,0]
v_pk_fma_f32 v[130:131], v[114:115], s[32:33], v[130:131] op_sel:[0,1,0] neg_lo:[0,1,0] neg_hi:[0,1,0]
v_pk_add_f32 v[112:113], v[68:69], v[132:133] neg_lo:[0,1] neg_hi:[0,1]
v_pk_add_f32 v[114:115], v[70:71], v[134:135] neg_lo:[0,1] neg_hi:[0,1]
v_pk_add_f32 v[68:69], v[68:69], v[132:133]
v_pk_add_f32 v[70:71], v[70:71], v[134:135]
v_pk_mul_f32 v[132:133], v[112:113], s[32:33] op_sel_hi:[1,0] neg_lo:[0,1] neg_hi:[0,1]
v_pk_mul_f32 v[134:135], v[112:113], s[34:35] op_sel_hi:[1,0] neg_lo:[0,1] neg_hi:[0,1]
v_pk_fma_f32 v[132:133], v[114:115], s[34:35], v[132:133] op_sel_hi:[1,0,1]
v_pk_fma_f32 v[134:135], v[114:115], s[32:33], v[134:135] op_sel_hi:[1,0,1] neg_lo:[0,1,0] neg_hi:[0,1,0]
v_pk_add_f32 v[112:113], v[72:73], v[136:137] neg_lo:[0,1] neg_hi:[0,1]
v_pk_add_f32 v[114:115], v[74:75], v[138:139] neg_lo:[0,1] neg_hi:[0,1]
v_pk_add_f32 v[72:73], v[72:73], v[136:137]
v_pk_add_f32 v[74:75], v[74:75], v[138:139]
v_pk_mul_f32 v[136:137], v[112:113], s[30:31] op_sel:[0,1] neg_lo:[0,1] neg_hi:[0,1]
v_pk_mul_f32 v[138:139], v[112:113], s[34:35] op_sel:[0,1] neg_lo:[0,1] neg_hi:[0,1]
v_pk_fma_f32 v[136:137], v[114:115], s[34:35], v[136:137] op_sel:[0,1,0]
v_pk_fma_f32 v[138:139], v[114:115], s[30:31], v[138:139] op_sel:[0,1,0] neg_lo:[0,1,0] neg_hi:[0,1,0]
v_pk_add_f32 v[112:113], v[76:77], v[140:141] neg_lo:[0,1] neg_hi:[0,1]
v_pk_add_f32 v[114:115], v[78:79], v[142:143] neg_lo:[0,1] neg_hi:[0,1]
v_pk_add_f32 v[76:77], v[76:77], v[140:141]
v_pk_add_f32 v[78:79], v[78:79], v[142:143]
v_pk_mul_f32 v[140:141], v[112:113], s[30:31] op_sel_hi:[1,0] neg_lo:[0,1] neg_hi:[0,1]
v_pk_mul_f32 v[142:143], v[112:113], s[36:37] op_sel_hi:[1,0] neg_lo:[0,1] neg_hi:[0,1]
v_pk_fma_f32 v[140:141], v[114:115], s[36:37], v[140:141] op_sel_hi:[1,0,1]
v_pk_fma_f32 v[142:143], v[114:115], s[30:31], v[142:143] op_sel_hi:[1,0,1] neg_lo:[0,1,0] neg_hi:[0,1,0]
v_pk_add_f32 v[112:113], v[16:17], v[48:49] neg_lo:[0,1] neg_hi:[0,1]
v_pk_add_f32 v[114:115], v[18:19], v[50:51] neg_lo:[0,1] neg_hi:[0,1]
v_pk_add_f32 v[16:17], v[16:17], v[48:49]
v_pk_add_f32 v[18:19], v[18:19], v[50:51]
v_pk_add_f32 v[48:49], v[20:21], v[52:53] neg_lo:[0,1] neg_hi:[0,1]
v_pk_add_f32 v[50:51], v[22:23], v[54:55] neg_lo:[0,1] neg_hi:[0,1]
v_pk_add_f32 v[20:21], v[20:21], v[52:53]
v_pk_add_f32 v[22:23], v[22:23], v[54:55]
v_pk_mul_f32 v[52:53], v[48:49], s[30:31] op_sel:[0,1]
v_pk_mul_f32 v[54:55], v[48:49], s[34:35] op_sel:[0,1] neg_lo:[0,1] neg_hi:[0,1]
v_pk_fma_f32 v[52:53], v[50:51], s[34:35], v[52:53] op_sel:[0,1,0]
v_pk_fma_f32 v[54:55], v[50:51], s[30:31], v[54:55] op_sel:[0,1,0]
v_pk_add_f32 v[48:49], v[24:25], v[56:57] neg_lo:[0,1] neg_hi:[0,1]
v_pk_add_f32 v[50:51], v[26:27], v[58:59] neg_lo:[0,1] neg_hi:[0,1]
v_pk_add_f32 v[24:25], v[24:25], v[56:57]
v_pk_add_f32 v[26:27], v[26:27], v[58:59]
v_pk_mul_f32 v[56:57], v[48:49], s[32:33] op_sel:[0,1]
v_pk_mul_f32 v[58:59], v[48:49], s[32:33] op_sel:[0,1] neg_lo:[0,1] neg_hi:[0,1]
v_pk_fma_f32 v[56:57], v[50:51], s[32:33], v[56:57] op_sel:[0,1,0]
v_pk_fma_f32 v[58:59], v[50:51], s[32:33], v[58:59] op_sel:[0,1,0]
v_pk_add_f32 v[48:49], v[28:29], v[60:61] neg_lo:[0,1] neg_hi:[0,1]
v_pk_add_f32 v[50:51], v[30:31], v[62:63] neg_lo:[0,1] neg_hi:[0,1]
v_pk_add_f32 v[28:29], v[28:29], v[60:61]
v_pk_add_f32 v[30:31], v[30:31], v[62:63]
v_pk_mul_f32 v[60:61], v[48:49], s[34:35] op_sel:[0,1]
v_pk_mul_f32 v[62:63], v[48:49], s[30:31] op_sel:[0,1] neg_lo:[0,1] neg_hi:[0,1]
v_pk_fma_f32 v[60:61], v[50:51], s[30:31], v[60:61] op_sel:[0,1,0]
v_pk_fma_f32 v[62:63], v[50:51], s[34:35], v[62:63] op_sel:[0,1,0]
v_pk_add_f32 v[48:49], v[34:35], v[66:67] neg_lo:[0,1] neg_hi:[0,1]
v_pk_add_f32 v[50:51], v[64:65], v[32:33] neg_lo:[0,1] neg_hi:[0,1]
v_pk_add_f32 v[32:33], v[32:33], v[64:65]
v_pk_add_f32 v[34:35], v[34:35], v[66:67]
v_pk_add_f32 v[64:65], v[36:37], v[68:69] neg_lo:[0,1] neg_hi:[0,1]
v_pk_add_f32 v[66:67], v[38:39], v[70:71] neg_lo:[0,1] neg_hi:[0,1]
v_pk_add_f32 v[36:37], v[36:37], v[68:69]
v_pk_add_f32 v[38:39], v[38:39], v[70:71]
v_pk_mul_f32 v[68:69], v[64:65], s[34:35] op_sel:[0,1] neg_lo:[0,1] neg_hi:[0,1]
v_pk_mul_f32 v[70:71], v[64:65], s[30:31] op_sel:[0,1] neg_lo:[0,1] neg_hi:[0,1]
v_pk_fma_f32 v[68:69], v[66:67], s[30:31], v[68:69] op_sel:[0,1,0]
v_pk_fma_f32 v[70:71], v[66:67], s[34:35], v[70:71] op_sel:[0,1,0] neg_lo:[0,1,0] neg_hi:[0,1,0]
v_pk_add_f32 v[64:65], v[40:41], v[72:73] neg_lo:[0,1] neg_hi:[0,1]
v_pk_add_f32 v[66:67], v[42:43], v[74:75] neg_lo:[0,1] neg_hi:[0,1]
v_pk_add_f32 v[40:41], v[40:41], v[72:73]
v_pk_add_f32 v[42:43], v[42:43], v[74:75]
v_pk_mul_f32 v[72:73], v[64:65], s[32:33] op_sel:[0,1] neg_lo:[0,1] neg_hi:[0,1]
v_pk_mul_f32 v[74:75], v[64:65], s[32:33] op_sel:[0,1] neg_lo:[0,1] neg_hi:[0,1]
v_pk_fma_f32 v[72:73], v[66:67], s[32:33], v[72:73] op_sel:[0,1,0]
v_pk_fma_f32 v[74:75], v[66:67], s[32:33], v[74:75] op_sel:[0,1,0] neg_lo:[0,1,0] neg_hi:[0,1,0]
v_pk_add_f32 v[64:65], v[44:45], v[76:77] neg_lo:[0,1] neg_hi:[0,1]
v_pk_add_f32 v[66:67], v[46:47], v[78:79] neg_lo:[0,1] neg_hi:[0,1]
v_pk_add_f32 v[44:45], v[44:45], v[76:77]
v_pk_add_f32 v[46:47], v[46:47], v[78:79]
v_pk_mul_f32 v[76:77], v[64:65], s[30:31] op_sel:[0,1] neg_lo:[0,1] neg_hi:[0,1]
v_pk_mul_f32 v[78:79], v[64:65], s[34:35] op_sel:[0,1] neg_lo:[0,1] neg_hi:[0,1]
v_pk_fma_f32 v[76:77], v[66:67], s[34:35], v[76:77] op_sel:[0,1,0]
v_pk_fma_f32 v[78:79], v[66:67], s[30:31], v[78:79] op_sel:[0,1,0] neg_lo:[0,1,0] neg_hi:[0,1,0]
v_pk_add_f32 v[64:65], v[144:145], v[80:81] neg_lo:[0,1] neg_hi:[0,1]
v_pk_add_f32 v[66:67], v[146:147], v[82:83] neg_lo:[0,1] neg_hi:[0,1]
v_pk_add_f32 v[144:145], v[144:145], v[80:81]
v_pk_add_f32 v[146:147], v[146:147], v[82:83]
v_pk_add_f32 v[80:81], v[84:85], v[116:117] neg_lo:[0,1] neg_hi:[0,1]
v_pk_add_f32 v[82:83], v[86:87], v[118:119] neg_lo:[0,1] neg_hi:[0,1]
v_pk_add_f32 v[84:85], v[84:85], v[116:117]
v_pk_add_f32 v[86:87], v[86:87], v[118:119]
v_pk_mul_f32 v[116:117], v[80:81], s[30:31] op_sel:[0,1]
v_pk_mul_f32 v[118:119], v[80:81], s[34:35] op_sel:[0,1] neg_lo:[0,1] neg_hi:[0,1]
v_pk_fma_f32 v[116:117], v[82:83], s[34:35], v[116:117] op_sel:[0,1,0]
v_pk_fma_f32 v[118:119], v[82:83], s[30:31], v[118:119] op_sel:[0,1,0]
v_pk_add_f32 v[80:81], v[88:89], v[120:121] neg_lo:[0,1] neg_hi:[0,1]
v_pk_add_f32 v[82:83], v[90:91], v[122:123] neg_lo:[0,1] neg_hi:[0,1]
v_pk_add_f32 v[88:89], v[88:89], v[120:121]
v_pk_add_f32 v[90:91], v[90:91], v[122:123]
v_pk_mul_f32 v[120:121], v[80:81], s[32:33] op_sel:[0,1]
v_pk_mul_f32 v[122:123], v[80:81], s[32:33] op_sel:[0,1] neg_lo:[0,1] neg_hi:[0,1]
v_pk_fma_f32 v[120:121], v[82:83], s[32:33], v[120:121] op_sel:[0,1,0]
v_pk_fma_f32 v[122:123], v[82:83], s[32:33], v[122:123] op_sel:[0,1,0]
v_pk_add_f32 v[80:81], v[92:93], v[124:125] neg_lo:[0,1] neg_hi:[0,1]
v_pk_add_f32 v[82:83], v[94:95], v[126:127] neg_lo:[0,1] neg_hi:[0,1]
v_pk_add_f32 v[92:93], v[92:93], v[124:125]
v_pk_add_f32 v[94:95], v[94:95], v[126:127]
v_pk_mul_f32 v[124:125], v[80:81], s[34:35] op_sel:[0,1]
v_pk_mul_f32 v[126:127], v[80:81], s[30:31] op_sel:[0,1] neg_lo:[0,1] neg_hi:[0,1]
v_pk_fma_f32 v[124:125], v[82:83], s[30:31], v[124:125] op_sel:[0,1,0]
v_pk_fma_f32 v[126:127], v[82:83], s[34:35], v[126:127] op_sel:[0,1,0]
v_pk_add_f32 v[80:81], v[98:99], v[130:131] neg_lo:[0,1] neg_hi:[0,1]
v_pk_add_f32 v[82:83], v[128:129], v[96:97] neg_lo:[0,1] neg_hi:[0,1]
v_pk_add_f32 v[96:97], v[96:97], v[128:129]
v_pk_add_f32 v[98:99], v[98:99], v[130:131]
v_pk_add_f32 v[128:129], v[100:101], v[132:133] neg_lo:[0,1] neg_hi:[0,1]
v_pk_add_f32 v[130:131], v[102:103], v[134:135] neg_lo:[0,1] neg_hi:[0,1]
v_pk_add_f32 v[100:101], v[100:101], v[132:133]
v_pk_add_f32 v[102:103], v[102:103], v[134:135]
v_pk_mul_f32 v[132:133], v[128:129], s[34:35] op_sel:[0,1] neg_lo:[0,1] neg_hi:[0,1]
v_pk_mul_f32 v[134:135], v[128:129], s[30:31] op_sel:[0,1] neg_lo:[0,1] neg_hi:[0,1]
v_pk_fma_f32 v[132:133], v[130:131], s[30:31], v[132:133] op_sel:[0,1,0]
v_pk_fma_f32 v[134:135], v[130:131], s[34:35], v[134:135] op_sel:[0,1,0] neg_lo:[0,1,0] neg_hi:[0,1,0]
v_pk_add_f32 v[128:129], v[104:105], v[136:137] neg_lo:[0,1] neg_hi:[0,1]
v_pk_add_f32 v[130:131], v[106:107], v[138:139] neg_lo:[0,1] neg_hi:[0,1]
v_pk_add_f32 v[104:105], v[104:105], v[136:137]
v_pk_add_f32 v[106:107], v[106:107], v[138:139]
v_pk_mul_f32 v[136:137], v[128:129], s[32:33] op_sel:[0,1] neg_lo:[0,1] neg_hi:[0,1]
v_pk_mul_f32 v[138:139], v[128:129], s[32:33] op_sel:[0,1] neg_lo:[0,1] neg_hi:[0,1]
v_pk_fma_f32 v[136:137], v[130:131], s[32:33], v[136:137] op_sel:[0,1,0]
v_pk_fma_f32 v[138:139], v[130:131], s[32:33], v[138:139] op_sel:[0,1,0] neg_lo:[0,1,0] neg_hi:[0,1,0]
v_pk_add_f32 v[128:129], v[108:109], v[140:141] neg_lo:[0,1] neg_hi:[0,1]
v_pk_add_f32 v[130:131], v[110:111], v[142:143] neg_lo:[0,1] neg_hi:[0,1]
v_pk_add_f32 v[108:109], v[108:109], v[140:141]
v_pk_add_f32 v[110:111], v[110:111], v[142:143]
v_pk_mul_f32 v[140:141], v[128:129], s[30:31] op_sel:[0,1] neg_lo:[0,1] neg_hi:[0,1]
v_pk_mul_f32 v[142:143], v[128:129], s[34:35] op_sel:[0,1] neg_lo:[0,1] neg_hi:[0,1]
v_pk_fma_f32 v[140:141], v[130:131], s[34:35], v[140:141] op_sel:[0,1,0]
v_pk_fma_f32 v[142:143], v[130:131], s[30:31], v[142:143] op_sel:[0,1,0] neg_lo:[0,1,0] neg_hi:[0,1,0]
v_pk_add_f32 v[128:129], v[16:17], v[32:33] neg_lo:[0,1] neg_hi:[0,1]
v_pk_add_f32 v[130:131], v[18:19], v[34:35] neg_lo:[0,1] neg_hi:[0,1]
v_pk_add_f32 v[16:17], v[16:17], v[32:33]
v_pk_add_f32 v[18:19], v[18:19], v[34:35]
v_pk_add_f32 v[32:33], v[20:21], v[36:37] neg_lo:[0,1] neg_hi:[0,1]
v_pk_add_f32 v[34:35], v[22:23], v[38:39] neg_lo:[0,1] neg_hi:[0,1]
v_pk_add_f32 v[20:21], v[20:21], v[36:37]
v_pk_add_f32 v[22:23], v[22:23], v[38:39]
v_pk_mul_f32 v[36:37], v[32:33], s[32:33] op_sel:[0,1]
v_pk_mul_f32 v[38:39], v[32:33], s[32:33] op_sel:[0,1] neg_lo:[0,1] neg_hi:[0,1]
v_pk_fma_f32 v[36:37], v[34:35], s[32:33], v[36:37] op_sel:[0,1,0]
v_pk_fma_f32 v[38:39], v[34:35], s[32:33], v[38:39] op_sel:[0,1,0]
v_pk_add_f32 v[32:33], v[26:27], v[42:43] neg_lo:[0,1] neg_hi:[0,1]
v_pk_add_f32 v[34:35], v[40:41], v[24:25] neg_lo:[0,1] neg_hi:[0,1]
v_pk_add_f32 v[24:25], v[24:25], v[40:41]
v_pk_add_f32 v[26:27], v[26:27], v[42:43]
v_pk_add_f32 v[40:41], v[28:29], v[44:45] neg_lo:[0,1] neg_hi:[0,1]
v_pk_add_f32 v[42:43], v[30:31], v[46:47] neg_lo:[0,1] neg_hi:[0,1]
v_pk_add_f32 v[28:29], v[28:29], v[44:45]
v_pk_add_f32 v[30:31], v[30:31], v[46:47]
v_pk_mul_f32 v[44:45], v[40:41], s[32:33] op_sel:[0,1] neg_lo:[0,1] neg_hi:[0,1]
v_pk_mul_f32 v[46:47], v[40:41], s[32:33] op_sel:[0,1] neg_lo:[0,1] neg_hi:[0,1]
v_pk_fma_f32 v[44:45], v[42:43], s[32:33], v[44:45] op_sel:[0,1,0]
v_pk_fma_f32 v[46:47], v[42:43], s[32:33], v[46:47] op_sel:[0,1,0] neg_lo:[0,1,0] neg_hi:[0,1,0]
v_pk_add_f32 v[40:41], v[112:113], v[48:49] neg_lo:[0,1] neg_hi:[0,1]
v_pk_add_f32 v[42:43], v[114:115], v[50:51] neg_lo:[0,1] neg_hi:[0,1]
v_pk_add_f32 v[112:113], v[112:113], v[48:49]
v_pk_add_f32 v[114:115], v[114:115], v[50:51]
v_pk_add_f32 v[48:49], v[52:53], v[68:69] neg_lo:[0,1] neg_hi:[0,1]
v_pk_add_f32 v[50:51], v[54:55], v[70:71] neg_lo:[0,1] neg_hi:[0,1]
v_pk_add_f32 v[52:53], v[52:53], v[68:69]
v_pk_add_f32 v[54:55], v[54:55], v[70:71]
v_pk_mul_f32 v[68:69], v[48:49], s[32:33] op_sel:[0,1]
v_pk_mul_f32 v[70:71], v[48:49], s[32:33] op_sel:[0,1] neg_lo:[0,1] neg_hi:[0,1]
v_pk_fma_f32 v[68:69], v[50:51], s[32:33], v[68:69] op_sel:[0,1,0]
v_pk_fma_f32 v[70:71], v[50:51], s[32:33], v[70:71] op_sel:[0,1,0]
v_pk_add_f32 v[48:49], v[58:59], v[74:75] neg_lo:[0,1] neg_hi:[0,1]
v_pk_add_f32 v[50:51], v[72:73], v[56:57] neg_lo:[0,1] neg_hi:[0,1]
v_pk_add_f32 v[56:57], v[56:57], v[72:73]
v_pk_add_f32 v[58:59], v[58:59], v[74:75]
v_pk_add_f32 v[72:73], v[60:61], v[76:77] neg_lo:[0,1] neg_hi:[0,1]
v_pk_add_f32 v[74:75], v[62:63], v[78:79] neg_lo:[0,1] neg_hi:[0,1]
v_pk_add_f32 v[60:61], v[60:61], v[76:77]
v_pk_add_f32 v[62:63], v[62:63], v[78:79]
v_pk_mul_f32 v[76:77], v[72:73], s[32:33] op_sel:[0,1] neg_lo:[0,1] neg_hi:[0,1]
v_pk_mul_f32 v[78:79], v[72:73], s[32:33] op_sel:[0,1] neg_lo:[0,1] neg_hi:[0,1]
v_pk_fma_f32 v[76:77], v[74:75], s[32:33], v[76:77] op_sel:[0,1,0]
v_pk_fma_f32 v[78:79], v[74:75], s[32:33], v[78:79] op_sel:[0,1,0] neg_lo:[0,1,0] neg_hi:[0,1,0]
v_pk_add_f32 v[72:73], v[144:145], v[96:97] neg_lo:[0,1] neg_hi:[0,1]
v_pk_add_f32 v[74:75], v[146:147], v[98:99] neg_lo:[0,1] neg_hi:[0,1]
v_pk_add_f32 v[144:145], v[144:145], v[96:97]
v_pk_add_f32 v[146:147], v[146:147], v[98:99]
v_pk_add_f32 v[96:97], v[84:85], v[100:101] neg_lo:[0,1] neg_hi:[0,1]
v_pk_add_f32 v[98:99], v[86:87], v[102:103] neg_lo:[0,1] neg_hi:[0,1]
v_pk_add_f32 v[84:85], v[84:85], v[100:101]
v_pk_add_f32 v[86:87], v[86:87], v[102:103]
v_pk_mul_f32 v[100:101], v[96:97], s[32:33] op_sel:[0,1]
v_pk_mul_f32 v[102:103], v[96:97], s[32:33] op_sel:[0,1] neg_lo:[0,1] neg_hi:[0,1]
v_pk_fma_f32 v[100:101], v[98:99], s[32:33], v[100:101] op_sel:[0,1,0]
v_pk_fma_f32 v[102:103], v[98:99], s[32:33], v[102:103] op_sel:[0,1,0]
v_pk_add_f32 v[96:97], v[90:91], v[106:107] neg_lo:[0,1] neg_hi:[0,1]
v_pk_add_f32 v[98:99], v[104:105], v[88:89] neg_lo:[0,1] neg_hi:[0,1]
v_pk_add_f32 v[88:89], v[88:89], v[104:105]
v_pk_add_f32 v[90:91], v[90:91], v[106:107]
v_pk_add_f32 v[104:105], v[92:93], v[108:109] neg_lo:[0,1] neg_hi:[0,1]
v_pk_add_f32 v[106:107], v[94:95], v[110:111] neg_lo:[0,1] neg_hi:[0,1]
v_pk_add_f32 v[92:93], v[92:93], v[108:109]
v_pk_add_f32 v[94:95], v[94:95], v[110:111]
v_pk_mul_f32 v[108:109], v[104:105], s[32:33] op_sel:[0,1] neg_lo:[0,1] neg_hi:[0,1]
v_pk_mul_f32 v[110:111], v[104:105], s[32:33] op_sel:[0,1] neg_lo:[0,1] neg_hi:[0,1]
v_pk_fma_f32 v[108:109], v[106:107], s[32:33], v[108:109] op_sel:[0,1,0]
v_pk_fma_f32 v[110:111], v[106:107], s[32:33], v[110:111] op_sel:[0,1,0] neg_lo:[0,1,0] neg_hi:[0,1,0]
v_pk_add_f32 v[104:105], v[64:65], v[80:81] neg_lo:[0,1] neg_hi:[0,1]
v_pk_add_f32 v[106:107], v[66:67], v[82:83] neg_lo:[0,1] neg_hi:[0,1]
v_pk_add_f32 v[64:65], v[64:65], v[80:81]
v_pk_add_f32 v[66:67], v[66:67], v[82:83]
v_pk_add_f32 v[80:81], v[116:117], v[132:133] neg_lo:[0,1] neg_hi:[0,1]
v_pk_add_f32 v[82:83], v[118:119], v[134:135] neg_lo:[0,1] neg_hi:[0,1]
v_pk_add_f32 v[116:117], v[116:117], v[132:133]
v_pk_add_f32 v[118:119], v[118:119], v[134:135]
v_pk_mul_f32 v[132:133], v[80:81], s[32:33] op_sel:[0,1]
v_pk_mul_f32 v[134:135], v[80:81], s[32:33] op_sel:[0,1] neg_lo:[0,1] neg_hi:[0,1]
v_pk_fma_f32 v[132:133], v[82:83], s[32:33], v[132:133] op_sel:[0,1,0]
v_pk_fma_f32 v[134:135], v[82:83], s[32:33], v[134:135] op_sel:[0,1,0]
v_pk_add_f32 v[80:81], v[122:123], v[138:139] neg_lo:[0,1] neg_hi:[0,1]
v_pk_add_f32 v[82:83], v[136:137], v[120:121] neg_lo:[0,1] neg_hi:[0,1]
v_pk_add_f32 v[120:121], v[120:121], v[136:137]
v_pk_add_f32 v[122:123], v[122:123], v[138:139]
v_pk_add_f32 v[136:137], v[124:125], v[140:141] neg_lo:[0,1] neg_hi:[0,1]
v_pk_add_f32 v[138:139], v[126:127], v[142:143] neg_lo:[0,1] neg_hi:[0,1]
v_pk_add_f32 v[124:125], v[124:125], v[140:141]
v_pk_add_f32 v[126:127], v[126:127], v[142:143]
v_pk_mul_f32 v[140:141], v[136:137], s[32:33] op_sel:[0,1] neg_lo:[0,1] neg_hi:[0,1]
v_pk_mul_f32 v[142:143], v[136:137], s[32:33] op_sel:[0,1] neg_lo:[0,1] neg_hi:[0,1]
v_pk_fma_f32 v[140:141], v[138:139], s[32:33], v[140:141] op_sel:[0,1,0]
v_pk_fma_f32 v[142:143], v[138:139], s[32:33], v[142:143] op_sel:[0,1,0] neg_lo:[0,1,0] neg_hi:[0,1,0]
v_pk_add_f32 v[136:137], v[16:17], v[24:25] neg_lo:[0,1] neg_hi:[0,1]
v_pk_add_f32 v[138:139], v[18:19], v[26:27] neg_lo:[0,1] neg_hi:[0,1]
v_pk_add_f32 v[16:17], v[16:17], v[24:25]
v_pk_add_f32 v[18:19], v[18:19], v[26:27]
v_pk_add_f32 v[24:25], v[22:23], v[30:31] neg_lo:[0,1] neg_hi:[0,1]
v_pk_add_f32 v[26:27], v[28:29], v[20:21] neg_lo:[0,1] neg_hi:[0,1]
v_pk_add_f32 v[20:21], v[20:21], v[28:29]
v_pk_add_f32 v[22:23], v[22:23], v[30:31]
v_pk_add_f32 v[28:29], v[128:129], v[32:33] neg_lo:[0,1] neg_hi:[0,1]
v_pk_add_f32 v[30:31], v[130:131], v[34:35] neg_lo:[0,1] neg_hi:[0,1]
v_pk_add_f32 v[128:129], v[128:129], v[32:33]
v_pk_add_f32 v[130:131], v[130:131], v[34:35]
v_pk_add_f32 v[32:33], v[38:39], v[46:47] neg_lo:[0,1] neg_hi:[0,1]
v_pk_add_f32 v[34:35], v[44:45], v[36:37] neg_lo:[0,1] neg_hi:[0,1]
v_pk_add_f32 v[36:37], v[36:37], v[44:45]
v_pk_add_f32 v[38:39], v[38:39], v[46:47]
v_pk_add_f32 v[44:45], v[112:113], v[56:57] neg_lo:[0,1] neg_hi:[0,1]
v_pk_add_f32 v[46:47], v[114:115], v[58:59] neg_lo:[0,1] neg_hi:[0,1]
v_pk_add_f32 v[112:113], v[112:113], v[56:57]
v_pk_add_f32 v[114:115], v[114:115], v[58:59]
v_pk_add_f32 v[56:57], v[54:55], v[62:63] neg_lo:[0,1] neg_hi:[0,1]
v_pk_add_f32 v[58:59], v[60:61], v[52:53] neg_lo:[0,1] neg_hi:[0,1]
v_pk_add_f32 v[52:53], v[52:53], v[60:61]
v_pk_add_f32 v[54:55], v[54:55], v[62:63]
v_pk_add_f32 v[60:61], v[40:41], v[48:49] neg_lo:[0,1] neg_hi:[0,1]
v_pk_add_f32 v[62:63], v[42:43], v[50:51] neg_lo:[0,1] neg_hi:[0,1]
v_pk_add_f32 v[40:41], v[40:41], v[48:49]
v_pk_add_f32 v[42:43], v[42:43], v[50:51]
v_pk_add_f32 v[48:49], v[70:71], v[78:79] neg_lo:[0,1] neg_hi:[0,1]
v_pk_add_f32 v[50:51], v[76:77], v[68:69] neg_lo:[0,1] neg_hi:[0,1]
v_pk_add_f32 v[68:69], v[68:69], v[76:77]
v_pk_add_f32 v[70:71], v[70:71], v[78:79]
v_pk_add_f32 v[76:77], v[144:145], v[88:89] neg_lo:[0,1] neg_hi:[0,1]
v_pk_add_f32 v[78:79], v[146:147], v[90:91] neg_lo:[0,1] neg_hi:[0,1]
v_pk_add_f32 v[144:145], v[144:145], v[88:89]
v_pk_add_f32 v[146:147], v[146:147], v[90:91]
v_pk_add_f32 v[88:89], v[86:87], v[94:95] neg_lo:[0,1] neg_hi:[0,1]
v_pk_add_f32 v[90:91], v[92:93], v[84:85] neg_lo:[0,1] neg_hi:[0,1]
v_pk_add_f32 v[84:85], v[84:85], v[92:93]
v_pk_add_f32 v[86:87], v[86:87], v[94:95]
v_pk_add_f32 v[92:93], v[72:73], v[96:97] neg_lo:[0,1] neg_hi:[0,1]
v_pk_add_f32 v[94:95], v[74:75], v[98:99] neg_lo:[0,1] neg_hi:[0,1]
v_pk_add_f32 v[72:73], v[72:73], v[96:97]
v_pk_add_f32 v[74:75], v[74:75], v[98:99]
v_pk_add_f32 v[96:97], v[102:103], v[110:111] neg_lo:[0,1] neg_hi:[0,1]
v_pk_add_f32 v[98:99], v[108:109], v[100:101] neg_lo:[0,1] neg_hi:[0,1]
v_pk_add_f32 v[100:101], v[100:101], v[108:109]
v_pk_add_f32 v[102:103], v[102:103], v[110:111]
v_pk_add_f32 v[108:109], v[64:65], v[120:121] neg_lo:[0,1] neg_hi:[0,1]
v_pk_add_f32 v[110:111], v[66:67], v[122:123] neg_lo:[0,1] neg_hi:[0,1]
v_pk_add_f32 v[64:65], v[64:65], v[120:121]
v_pk_add_f32 v[66:67], v[66:67], v[122:123]
v_pk_add_f32 v[120:121], v[118:119], v[126:127] neg_lo:[0,1] neg_hi:[0,1]
v_pk_add_f32 v[122:123], v[124:125], v[116:117] neg_lo:[0,1] neg_hi:[0,1]
v_pk_add_f32 v[116:117], v[116:117], v[124:125]
v_pk_add_f32 v[118:119], v[118:119], v[126:127]
v_pk_add_f32 v[124:125], v[104:105], v[80:81] neg_lo:[0,1] neg_hi:[0,1]
v_pk_add_f32 v[126:127], v[106:107], v[82:83] neg_lo:[0,1] neg_hi:[0,1]
v_pk_add_f32 v[104:105], v[104:105], v[80:81]
v_pk_add_f32 v[106:107], v[106:107], v[82:83]
v_pk_add_f32 v[80:81], v[134:135], v[142:143] neg_lo:[0,1] neg_hi:[0,1]
v_pk_add_f32 v[82:83], v[140:141], v[132:133] neg_lo:[0,1] neg_hi:[0,1]
v_pk_add_f32 v[132:133], v[132:133], v[140:141]
v_pk_add_f32 v[134:135], v[134:135], v[142:143]
v_pk_add_f32 v[140:141], v[16:17], v[20:21] neg_lo:[0,1] neg_hi:[0,1]
v_pk_add_f32 v[142:143], v[18:19], v[22:23] neg_lo:[0,1] neg_hi:[0,1]
v_pk_add_f32 v[16:17], v[16:17], v[20:21]
v_pk_add_f32 v[18:19], v[18:19], v[22:23]
v_pk_add_f32 v[20:21], v[136:137], v[24:25] neg_lo:[0,1] neg_hi:[0,1]
v_pk_add_f32 v[22:23], v[138:139], v[26:27] neg_lo:[0,1] neg_hi:[0,1]
v_pk_add_f32 v[136:137], v[136:137], v[24:25]
v_pk_add_f32 v[138:139], v[138:139], v[26:27]
v_pk_add_f32 v[24:25], v[128:129], v[36:37] neg_lo:[0,1] neg_hi:[0,1]
v_pk_add_f32 v[26:27], v[130:131], v[38:39] neg_lo:[0,1] neg_hi:[0,1]
v_pk_add_f32 v[128:129], v[128:129], v[36:37]
v_pk_add_f32 v[130:131], v[130:131], v[38:39]
v_pk_add_f32 v[36:37], v[28:29], v[32:33] neg_lo:[0,1] neg_hi:[0,1]
v_pk_add_f32 v[38:39], v[30:31], v[34:35] neg_lo:[0,1] neg_hi:[0,1]
v_pk_add_f32 v[28:29], v[28:29], v[32:33]
v_pk_add_f32 v[30:31], v[30:31], v[34:35]
v_pk_add_f32 v[32:33], v[112:113], v[52:53] neg_lo:[0,1] neg_hi:[0,1]
v_pk_add_f32 v[34:35], v[114:115], v[54:55] neg_lo:[0,1] neg_hi:[0,1]
v_pk_add_f32 v[112:113], v[112:113], v[52:53]
v_pk_add_f32 v[114:115], v[114:115], v[54:55]
v_pk_add_f32 v[52:53], v[44:45], v[56:57] neg_lo:[0,1] neg_hi:[0,1]
v_pk_add_f32 v[54:55], v[46:47], v[58:59] neg_lo:[0,1] neg_hi:[0,1]
v_pk_add_f32 v[44:45], v[44:45], v[56:57]
v_pk_add_f32 v[46:47], v[46:47], v[58:59]
v_pk_add_f32 v[56:57], v[40:41], v[68:69] neg_lo:[0,1] neg_hi:[0,1]
v_pk_add_f32 v[58:59], v[42:43], v[70:71] neg_lo:[0,1] neg_hi:[0,1]
v_pk_add_f32 v[40:41], v[40:41], v[68:69]
v_pk_add_f32 v[42:43], v[42:43], v[70:71]
v_pk_add_f32 v[68:69], v[60:61], v[48:49] neg_lo:[0,1] neg_hi:[0,1]
v_pk_add_f32 v[70:71], v[62:63], v[50:51] neg_lo:[0,1] neg_hi:[0,1]
v_pk_add_f32 v[60:61], v[60:61], v[48:49]
v_pk_add_f32 v[62:63], v[62:63], v[50:51]
v_pk_add_f32 v[48:49], v[144:145], v[84:85] neg_lo:[0,1] neg_hi:[0,1]
v_pk_add_f32 v[50:51], v[146:147], v[86:87] neg_lo:[0,1] neg_hi:[0,1]
v_pk_add_f32 v[144:145], v[144:145], v[84:85]
v_pk_add_f32 v[146:147], v[146:147], v[86:87]
v_pk_add_f32 v[84:85], v[76:77], v[88:89] neg_lo:[0,1] neg_hi:[0,1]
v_pk_add_f32 v[86:87], v[78:79], v[90:91] neg_lo:[0,1] neg_hi:[0,1]
v_pk_add_f32 v[76:77], v[76:77], v[88:89]
v_pk_add_f32 v[78:79], v[78:79], v[90:91]
v_pk_add_f32 v[88:89], v[72:73], v[100:101] neg_lo:[0,1] neg_hi:[0,1]
v_pk_add_f32 v[90:91], v[74:75], v[102:103] neg_lo:[0,1] neg_hi:[0,1]
v_pk_add_f32 v[72:73], v[72:73], v[100:101]
v_pk_add_f32 v[74:75], v[74:75], v[102:103]
v_pk_add_f32 v[100:101], v[92:93], v[96:97] neg_lo:[0,1] neg_hi:[0,1]
v_pk_add_f32 v[102:103], v[94:95], v[98:99] neg_lo:[0,1] neg_hi:[0,1]
v_pk_add_f32 v[92:93], v[92:93], v[96:97]
v_pk_add_f32 v[94:95], v[94:95], v[98:99]
v_pk_add_f32 v[96:97], v[64:65], v[116:117] neg_lo:[0,1] neg_hi:[0,1]
v_pk_add_f32 v[98:99], v[66:67], v[118:119] neg_lo:[0,1] neg_hi:[0,1]
v_pk_add_f32 v[64:65], v[64:65], v[116:117]
v_pk_add_f32 v[66:67], v[66:67], v[118:119]
v_pk_add_f32 v[116:117], v[108:109], v[120:121] neg_lo:[0,1] neg_hi:[0,1]
v_pk_add_f32 v[118:119], v[110:111], v[122:123] neg_lo:[0,1] neg_hi:[0,1]
v_pk_add_f32 v[108:109], v[108:109], v[120:121]
v_pk_add_f32 v[110:111], v[110:111], v[122:123]
v_pk_add_f32 v[120:121], v[104:105], v[132:133] neg_lo:[0,1] neg_hi:[0,1]
v_pk_add_f32 v[122:123], v[106:107], v[134:135] neg_lo:[0,1] neg_hi:[0,1]
v_pk_add_f32 v[104:105], v[104:105], v[132:133]
v_pk_add_f32 v[106:107], v[106:107], v[134:135]
v_pk_add_f32 v[132:133], v[124:125], v[80:81] neg_lo:[0,1] neg_hi:[0,1]
v_pk_add_f32 v[134:135], v[126:127], v[82:83] neg_lo:[0,1] neg_hi:[0,1]
v_pk_add_f32 v[124:125], v[124:125], v[80:81]
v_pk_add_f32 v[126:127], v[126:127], v[82:83]
v_mul_f32 v151, 0xba800000, v3
v_cos_f32 v150, v151
v_sin_f32 v151, v151
v_mul_f32 v149, 0xbb000000, v3
v_cos_f32 v148, v149
v_sin_f32 v149, v149
v_pk_mul_f32 v[80:81], v[144:145], v[150:151] op_sel_hi:[1,0]
v_pk_fma_f32 v[80:81], v[146:147], v[150:151], v[80:81] op_sel:[0,1,0] neg_lo:[1,0,0] neg_hi:[1,0,0]
v_pk_mul_f32 v[146:147], v[146:147], v[150:151] op_sel_hi:[1,0]
v_pk_fma_f32 v[146:147], v[144:145], v[150:151], v[146:147] op_sel:[0,1,0]
v_mul_f32 v151, 0xbb400000, v3
v_cos_f32 v150, v151
v_sin_f32 v151, v151
v_pk_mul_f32 v[144:145], v[112:113], v[148:149] op_sel_hi:[1,0]
v_pk_fma_f32 v[144:145], v[114:115], v[148:149], v[144:145] op_sel:[0,1,0] neg_lo:[1,0,0] neg_hi:[1,0,0]
v_pk_mul_f32 v[114:115], v[114:115], v[148:149] op_sel_hi:[1,0]
v_pk_fma_f32 v[114:115], v[112:113], v[148:149], v[114:115] op_sel:[0,1,0]
v_mul_f32 v149, 0xbb800000, v3
v_cos_f32 v148, v149
v_sin_f32 v149, v149
v_pk_mul_f32 v[112:113], v[64:65], v[150:151] op_sel_hi:[1,0]
v_pk_fma_f32 v[112:113], v[66:67], v[150:151], v[112:113] op_sel:[0,1,0] neg_lo:[1,0,0] neg_hi:[1,0,0]
v_pk_mul_f32 v[66:67], v[66:67], v[150:151] op_sel_hi:[1,0]
v_pk_fma_f32 v[66:67], v[64:65], v[150:151], v[66:67] op_sel:[0,1,0]
v_mul_f32 v151, 0xbba00000, v3
v_cos_f32 v150, v151
v_sin_f32 v151, v151
v_pk_mul_f32 v[64:65], v[128:129], v[148:149] op_sel_hi:[1,0]
v_pk_fma_f32 v[64:65], v[130:131], v[148:149], v[64:65] op_sel:[0,1,0] neg_lo:[1,0,0] neg_hi:[1,0,0]
v_pk_mul_f32 v[130:131], v[130:131], v[148:149] op_sel_hi:[1,0]
v_pk_fma_f32 v[130:131], v[128:129], v[148:149], v[130:131] op_sel:[0,1,0]
v_mul_f32 v149, 0xbbc00000, v3
v_cos_f32 v148, v149
v_sin_f32 v149, v149
v_pk_mul_f32 v[128:129], v[72:73], v[150:151] op_sel_hi:[1,0]
v_pk_fma_f32 v[128:129], v[74:75], v[150:151], v[128:129] op_sel:[0,1,0] neg_lo:[1,0,0] neg_hi:[1,0,0]
v_pk_mul_f32 v[74:75], v[74:75], v[150:151] op_sel_hi:[1,0]
v_pk_fma_f32 v[74:75], v[72:73], v[150:151], v[74:75] op_sel:[0,1,0]
v_mul_f32 v151, 0xbbe00000, v3
v_cos_f32 v150, v151
v_sin_f32 v151, v151
v_pk_mul_f32 v[72:73], v[40:41], v[148:149] op_sel_hi:[1,0]
v_pk_fma_f32 v[72:73], v[42:43], v[148:149], v[72:73] op_sel:[0,1,0] neg_lo:[1,0,0] neg_hi:[1,0,0]
v_pk_mul_f32 v[42:43], v[42:43], v[148:149] op_sel_hi:[1,0]
v_pk_fma_f32 v[42:43], v[40:41], v[148:149], v[42:43] op_sel:[0,1,0]
v_mul_f32 v149, 0xbc000000, v3
v_cos_f32 v148, v149
v_sin_f32 v149, v149
v_pk_mul_f32 v[40:41], v[104:105], v[150:151] op_sel_hi:[1,0]
v_pk_fma_f32 v[40:41], v[106:107], v[150:151], v[40:41] op_sel:[0,1,0] neg_lo:[1,0,0] neg_hi:[1,0,0]
v_pk_mul_f32 v[106:107], v[106:107], v[150:151] op_sel_hi:[1,0]
v_pk_fma_f32 v[106:107], v[104:105], v[150:151], v[106:107] op_sel:[0,1,0]
v_mul_f32 v151, 0xbc100000, v3
v_cos_f32 v150, v151
v_sin_f32 v151, v151
v_pk_mul_f32 v[104:105], v[136:137], v[148:149] op_sel_hi:[1,0]
v_pk_fma_f32 v[104:105], v[138:139], v[148:149], v[104:105] op_sel:[0,1,0] neg_lo:[1,0,0] neg_hi:[1,0,0]
v_pk_mul_f32 v[138:139], v[138:139], v[148:149] op_sel_hi:[1,0]
v_pk_fma_f32 v[138:139], v[136:137], v[148:149], v[138:139] op_sel:[0,1,0]
v_mul_f32 v149, 0xbc200000, v3
v_cos_f32 v148, v149
v_sin_f32 v149, v149
v_pk_mul_f32 v[136:137], v[76:77], v[150:151] op_sel_hi:[1,0]
v_pk_fma_f32 v[136:137], v[78:79], v[150:151], v[136:137] op_sel:[0,1,0] neg_lo:[1,0,0] neg_hi:[1,0,0]
v_pk_mul_f32 v[78:79], v[78:79], v[150:151] op_sel_hi:[1,0]
v_pk_fma_f32 v[78:79], v[76:77], v[150:151], v[78:79] op_sel:[0,1,0]
v_mul_f32 v151, 0xbc300000, v3
v_cos_f32 v150, v151
v_sin_f32 v151, v151
v_pk_mul_f32 v[76:77], v[44:45], v[148:149] op_sel_hi:[1,0]
v_pk_fma_f32 v[76:77], v[46:47], v[148:149], v[76:77] op_sel:[0,1,0] neg_lo:[1,0,0] neg_hi:[1,0,0]
v_pk_mul_f32 v[46:47], v[46:47], v[148:149] op_sel_hi:[1,0]
v_pk_fma_f32 v[46:47], v[44:45], v[148:149], v[46:47] op_sel:[0,1,0]
v_mul_f32 v149, 0xbc400000, v3
v_cos_f32 v148, v149
v_sin_f32 v149, v149
v_pk_mul_f32 v[44:45], v[108:109], v[150:151] op_sel_hi:[1,0]
v_pk_fma_f32 v[44:45], v[110:111], v[150:151], v[44:45] op_sel:[0,1,0] neg_lo:[1,0,0] neg_hi:[1,0,0]
v_pk_mul_f32 v[110:111], v[110:111], v[150:151] op_sel_hi:[1,0]
v_pk_fma_f32 v[110:111], v[108:109], v[150:151], v[110:111] op_sel:[0,1,0]
v_mul_f32 v151, 0xbc500000, v3
v_cos_f32 v150, v151
v_sin_f32 v151, v151
v_pk_mul_f32 v[108:109], v[28:29], v[148:149] op_sel_hi:[1,0]
v_pk_fma_f32 v[108:109], v[30:31], v[148:149], v[108:109] op_sel:[0,1,0] neg_lo:[1,0,0] neg_hi:[1,0,0]
v_pk_mul_f32 v[30:31], v[30:31], v[148:149] op_sel_hi:[1,0]
v_pk_fma_f32 v[30:31], v[28:29], v[148:149], v[30:31] op_sel:[0,1,0]
v_mul_f32 v149, 0xbc600000, v3
v_cos_f32 v148, v149
v_sin_f32 v149, v149
v_pk_mul_f32 v[28:29], v[92:93], v[150:151] op_sel_hi:[1,0]
v_pk_fma_f32 v[28:29], v[94:95], v[150:151], v[28:29] op_sel:[0,1,0] neg_lo:[1,0,0] neg_hi:[1,0,0]
v_pk_mul_f32 v[94:95], v[94:95], v[150:151] op_sel_hi:[1,0]
v_pk_fma_f32 v[94:95], v[92:93], v[150:151], v[94:95] op_sel:[0,1,0]
v_mul_f32 v151, 0xbc700000, v3
v_cos_f32 v150, v151
v_sin_f32 v151, v151
v_pk_mul_f32 v[92:93], v[60:61], v[148:149] op_sel_hi:[1,0]
v_pk_fma_f32 v[92:93], v[62:63], v[148:149], v[92:93] op_sel:[0,1,0] neg_lo:[1,0,0] neg_hi:[1,0,0]
v_pk_mul_f32 v[62:63], v[62:63], v[148:149] op_sel_hi:[1,0]
v_pk_fma_f32 v[62:63], v[60:61], v[148:149], v[62:63] op_sel:[0,1,0]
v_mul_f32 v149, 0xbc800000, v3
v_cos_f32 v148, v149
v_sin_f32 v149, v149
v_pk_mul_f32 v[60:61], v[124:125], v[150:151] op_sel_hi:[1,0]
v_pk_fma_f32 v[60:61], v[126:127], v[150:151], v[60:61] op_sel:[0,1,0] neg_lo:[1,0,0] neg_hi:[1,0,0]
v_pk_mul_f32 v[126:127], v[126:127], v[150:151] op_sel_hi:[1,0]
v_pk_fma_f32 v[126:127], v[124:125], v[150:151], v[126:127] op_sel:[0,1,0]
v_mul_f32 v151, 0xbc880000, v3
v_cos_f32 v150, v151
v_sin_f32 v151, v151
v_pk_mul_f32 v[124:125], v[140:141], v[148:149] op_sel_hi:[1,0]
v_pk_fma_f32 v[124:125], v[142:143], v[148:149], v[124:125] op_sel:[0,1,0] neg_lo:[1,0,0] neg_hi:[1,0,0]
v_pk_mul_f32 v[142:143], v[142:143], v[148:149] op_sel_hi:[1,0]
v_pk_fma_f32 v[142:143], v[140:141], v[148:149], v[142:143] op_sel:[0,1,0]
v_mul_f32 v149, 0xbc900000, v3
v_cos_f32 v148, v149
v_sin_f32 v149, v149
v_pk_mul_f32 v[140:141], v[48:49], v[150:151] op_sel_hi:[1,0]
v_pk_fma_f32 v[140:141], v[50:51], v[150:151], v[140:141] op_sel:[0,1,0] neg_lo:[1,0,0] neg_hi:[1,0,0]
v_pk_mul_f32 v[50:51], v[50:51], v[150:151] op_sel_hi:[1,0]
v_pk_fma_f32 v[50:51], v[48:49], v[150:151], v[50:51] op_sel:[0,1,0]
v_mul_f32 v151, 0xbc980000, v3
v_cos_f32 v150, v151
v_sin_f32 v151, v151
v_pk_mul_f32 v[48:49], v[32:33], v[148:149] op_sel_hi:[1,0]
v_pk_fma_f32 v[48:49], v[34:35], v[148:149], v[48:49] op_sel:[0,1,0] neg_lo:[1,0,0] neg_hi:[1,0,0]
v_pk_mul_f32 v[34:35], v[34:35], v[148:149] op_sel_hi:[1,0]
v_pk_fma_f32 v[34:35], v[32:33], v[148:149], v[34:35] op_sel:[0,1,0]
v_mul_f32 v149, 0xbca00000, v3
v_cos_f32 v148, v149
v_sin_f32 v149, v149
v_pk_mul_f32 v[32:33], v[96:97], v[150:151] op_sel_hi:[1,0]
v_pk_fma_f32 v[32:33], v[98:99], v[150:151], v[32:33] op_sel:[0,1,0] neg_lo:[1,0,0] neg_hi:[1,0,0]
v_pk_mul_f32 v[98:99], v[98:99], v[150:151] op_sel_hi:[1,0]
v_pk_fma_f32 v[98:99], v[96:97], v[150:151], v[98:99] op_sel:[0,1,0]
v_mul_f32 v151, 0xbca80000, v3
v_cos_f32 v150, v151
v_sin_f32 v151, v151
v_pk_mul_f32 v[96:97], v[24:25], v[148:149] op_sel_hi:[1,0]
v_pk_fma_f32 v[96:97], v[26:27], v[148:149], v[96:97] op_sel:[0,1,0] neg_lo:[1,0,0] neg_hi:[1,0,0]
v_pk_mul_f32 v[26:27], v[26:27], v[148:149] op_sel_hi:[1,0]
v_pk_fma_f32 v[26:27], v[24:25], v[148:149], v[26:27] op_sel:[0,1,0]
v_mul_f32 v149, 0xbcb00000, v3
v_cos_f32 v148, v149
v_sin_f32 v149, v149
v_pk_mul_f32 v[24:25], v[88:89], v[150:151] op_sel_hi:[1,0]
v_pk_fma_f32 v[24:25], v[90:91], v[150:151], v[24:25] op_sel:[0,1,0] neg_lo:[1,0,0] neg_hi:[1,0,0]
v_pk_mul_f32 v[90:91], v[90:91], v[150:151] op_sel_hi:[1,0]
v_pk_fma_f32 v[90:91], v[88:89], v[150:151], v[90:91] op_sel:[0,1,0]
v_mul_f32 v151, 0xbcb80000, v3
v_cos_f32 v150, v151
v_sin_f32 v151, v151
v_pk_mul_f32 v[88:89], v[56:57], v[148:149] op_sel_hi:[1,0]
v_pk_fma_f32 v[88:89], v[58:59], v[148:149], v[88:89] op_sel:[0,1,0] neg_lo:[1,0,0] neg_hi:[1,0,0]
v_pk_mul_f32 v[58:59], v[58:59], v[148:149] op_sel_hi:[1,0]
v_pk_fma_f32 v[58:59], v[56:57], v[148:149], v[58:59] op_sel:[0,1,0]
v_mul_f32 v149, 0xbcc00000, v3
v_cos_f32 v148, v149
v_sin_f32 v149, v149
v_pk_mul_f32 v[56:57], v[120:121], v[150:151] op_sel_hi:[1,0]
v_pk_fma_f32 v[56:57], v[122:123], v[150:151], v[56:57] op_sel:[0,1,0] neg_lo:[1,0,0] neg_hi:[1,0,0]
v_pk_mul_f32 v[122:123], v[122:123], v[150:151] op_sel_hi:[1,0]
v_pk_fma_f32 v[122:123], v[120:121], v[150:151], v[122:123] op_sel:[0,1,0]
v_mul_f32 v151, 0xbcc80000, v3
v_cos_f32 v150, v151
v_sin_f32 v151, v151
v_pk_mul_f32 v[120:121], v[20:21], v[148:149] op_sel_hi:[1,0]
v_pk_fma_f32 v[120:121], v[22:23], v[148:149], v[120:121] op_sel:[0,1,0] neg_lo:[1,0,0] neg_hi:[1,0,0]
v_pk_mul_f32 v[22:23], v[22:23], v[148:149] op_sel_hi:[1,0]
v_pk_fma_f32 v[22:23], v[20:21], v[148:149], v[22:23] op_sel:[0,1,0]
v_mul_f32 v149, 0xbcd00000, v3
v_cos_f32 v148, v149
v_sin_f32 v149, v149
v_pk_mul_f32 v[20:21], v[84:85], v[150:151] op_sel_hi:[1,0]
v_pk_fma_f32 v[20:21], v[86:87], v[150:151], v[20:21] op_sel:[0,1,0] neg_lo:[1,0,0] neg_hi:[1,0,0]
v_pk_mul_f32 v[86:87], v[86:87], v[150:151] op_sel_hi:[1,0]
v_pk_fma_f32 v[86:87], v[84:85], v[150:151], v[86:87] op_sel:[0,1,0]
v_mul_f32 v151, 0xbcd80000, v3
v_cos_f32 v150, v151
v_sin_f32 v151, v151
v_pk_mul_f32 v[84:85], v[52:53], v[148:149] op_sel_hi:[1,0]
v_pk_fma_f32 v[84:85], v[54:55], v[148:149], v[84:85] op_sel:[0,1,0] neg_lo:[1,0,0] neg_hi:[1,0,0]
v_pk_mul_f32 v[54:55], v[54:55], v[148:149] op_sel_hi:[1,0]
v_pk_fma_f32 v[54:55], v[52:53], v[148:149], v[54:55] op_sel:[0,1,0]
v_mul_f32 v149, 0xbce00000, v3
v_cos_f32 v148, v149
v_sin_f32 v149, v149
v_pk_mul_f32 v[52:53], v[116:117], v[150:151] op_sel_hi:[1,0]
v_pk_fma_f32 v[52:53], v[118:119], v[150:151], v[52:53] op_sel:[0,1,0] neg_lo:[1,0,0] neg_hi:[1,0,0]
v_pk_mul_f32 v[118:119], v[118:119], v[150:151] op_sel_hi:[1,0]
v_pk_fma_f32 v[118:119], v[116:117], v[150:151], v[118:119] op_sel:[0,1,0]
v_mul_f32 v151, 0xbce80000, v3
v_cos_f32 v150, v151
v_sin_f32 v151, v151
v_pk_mul_f32 v[116:117], v[36:37], v[148:149] op_sel_hi:[1,0]
v_pk_fma_f32 v[116:117], v[38:39], v[148:149], v[116:117] op_sel:[0,1,0] neg_lo:[1,0,0] neg_hi:[1,0,0]
v_pk_mul_f32 v[38:39], v[38:39], v[148:149] op_sel_hi:[1,0]
v_pk_fma_f32 v[38:39], v[36:37], v[148:149], v[38:39] op_sel:[0,1,0]
v_mul_f32 v149, 0xbcf00000, v3
v_cos_f32 v148, v149
v_sin_f32 v149, v149
v_pk_mul_f32 v[36:37], v[100:101], v[150:151] op_sel_hi:[1,0]
v_pk_fma_f32 v[36:37], v[102:103], v[150:151], v[36:37] op_sel:[0,1,0] neg_lo:[1,0,0] neg_hi:[1,0,0]
v_pk_mul_f32 v[102:103], v[102:103], v[150:151] op_sel_hi:[1,0]
v_pk_fma_f32 v[102:103], v[100:101], v[150:151], v[102:103] op_sel:[0,1,0]
v_mul_f32 v151, 0xbcf80000, v3
v_cos_f32 v150, v151
v_sin_f32 v151, v151
v_pk_mul_f32 v[100:101], v[68:69], v[148:149] op_sel_hi:[1,0]
v_pk_fma_f32 v[100:101], v[70:71], v[148:149], v[100:101] op_sel:[0,1,0] neg_lo:[1,0,0] neg_hi:[1,0,0]
v_pk_mul_f32 v[70:71], v[70:71], v[148:149] op_sel_hi:[1,0]
v_pk_fma_f32 v[70:71], v[68:69], v[148:149], v[70:71] op_sel:[0,1,0]
s_nop 0
v_pk_mul_f32 v[68:69], v[132:133], v[150:151] op_sel_hi:[1,0]
v_pk_fma_f32 v[68:69], v[134:135], v[150:151], v[68:69] op_sel:[0,1,0] neg_lo:[1,0,0] neg_hi:[1,0,0]
v_pk_mul_f32 v[134:135], v[134:135], v[150:151] op_sel_hi:[1,0]
v_pk_fma_f32 v[134:135], v[132:133], v[150:151], v[134:135] op_sel:[0,1,0]
ds_write_b64 v4, v[16:17]
ds_write_b64 v4, v[18:19] offset:8
ds_write_b64 v4, v[80:81] offset:528
ds_write_b64 v4, v[146:147] offset:536
ds_write_b64 v4, v[144:145] offset:1056
ds_write_b64 v4, v[114:115] offset:1064
ds_write_b64 v4, v[112:113] offset:1584
ds_write_b64 v4, v[66:67] offset:1592
ds_write_b64 v4, v[64:65] offset:2112
ds_write_b64 v4, v[130:131] offset:2120
ds_write_b64 v4, v[128:129] offset:2640
ds_write_b64 v4, v[74:75] offset:2648
ds_write_b64 v4, v[72:73] offset:3168
ds_write_b64 v4, v[42:43] offset:3176
ds_write_b64 v4, v[40:41] offset:3696
ds_write_b64 v4, v[106:107] offset:3704
ds_write_b64 v4, v[104:105] offset:4224
ds_write_b64 v4, v[138:139] offset:4232
ds_write_b64 v4, v[136:137] offset:4752
ds_write_b64 v4, v[78:79] offset:4760
ds_write_b64 v4, v[76:77] offset:5280
ds_write_b64 v4, v[46:47] offset:5288
ds_write_b64 v4, v[44:45] offset:5808
ds_write_b64 v4, v[110:111] offset:5816
ds_write_b64 v4, v[108:109] offset:6336
ds_write_b64 v4, v[30:31] offset:6344
ds_write_b64 v4, v[28:29] offset:6864
ds_write_b64 v4, v[94:95] offset:6872
ds_write_b64 v4, v[92:93] offset:7392
ds_write_b64 v4, v[62:63] offset:7400
ds_write_b64 v4, v[60:61] offset:7920
ds_write_b64 v4, v[126:127] offset:7928
ds_write_b64 v4, v[124:125] offset:8448
ds_write_b64 v4, v[142:143] offset:8456
ds_write_b64 v4, v[140:141] offset:8976
ds_write_b64 v4, v[50:51] offset:8984
ds_write_b64 v4, v[48:49] offset:9504
ds_write_b64 v4, v[34:35] offset:9512
ds_write_b64 v4, v[32:33] offset:10032
ds_write_b64 v4, v[98:99] offset:10040
ds_write_b64 v4, v[96:97] offset:10560
ds_write_b64 v4, v[26:27] offset:10568
ds_write_b64 v4, v[24:25] offset:11088
ds_write_b64 v4, v[90:91] offset:11096
ds_write_b64 v4, v[88:89] offset:11616
ds_write_b64 v4, v[58:59] offset:11624
ds_write_b64 v4, v[56:57] offset:12144
ds_write_b64 v4, v[122:123] offset:12152
ds_write_b64 v4, v[120:121] offset:12672
ds_write_b64 v4, v[22:23] offset:12680
ds_write_b64 v4, v[20:21] offset:13200
ds_write_b64 v4, v[86:87] offset:13208
ds_write_b64 v4, v[84:85] offset:13728
ds_write_b64 v4, v[54:55] offset:13736
ds_write_b64 v4, v[52:53] offset:14256
ds_write_b64 v4, v[118:119] offset:14264
ds_write_b64 v4, v[116:117] offset:14784
ds_write_b64 v4, v[38:39] offset:14792
ds_write_b64 v4, v[36:37] offset:15312
ds_write_b64 v4, v[102:103] offset:15320
ds_write_b64 v4, v[100:101] offset:15840
ds_write_b64 v4, v[70:71] offset:15848
ds_write_b64 v4, v[68:69] offset:16368
ds_write_b64 v4, v[134:135] offset:16376
s_waitcnt lgkmcnt(0)
ds_read_b128 v[16:19], v5
ds_read_b128 v[20:23], v5 offset:16
ds_read_b128 v[24:27], v5 offset:32
ds_read_b128 v[28:31], v5 offset:48
ds_read_b128 v[32:35], v5 offset:64
ds_read_b128 v[36:39], v5 offset:80
ds_read_b128 v[40:43], v5 offset:96
ds_read_b128 v[44:47], v5 offset:112
ds_read_b128 v[48:51], v5 offset:128
ds_read_b128 v[52:55], v5 offset:144
ds_read_b128 v[56:59], v5 offset:160
ds_read_b128 v[60:63], v5 offset:176
s_waitcnt lgkmcnt(4)
ds_read_b128 v[64:67], v5 offset:192
ds_read_b128 v[68:71], v5 offset:208
ds_read_b128 v[72:75], v5 offset:224
ds_read_b128 v[76:79], v5 offset:240
ds_read_b128 v[80:83], v5 offset:256
ds_read_b128 v[84:87], v5 offset:272
ds_read_b128 v[88:91], v5 offset:288
ds_read_b128 v[92:95], v5 offset:304
ds_read_b128 v[96:99], v5 offset:320
ds_read_b128 v[100:103], v5 offset:336
ds_read_b128 v[104:107], v5 offset:352
ds_read_b128 v[108:111], v5 offset:368
s_waitcnt lgkmcnt(4)
ds_read_b128 v[112:115], v5 offset:384
ds_read_b128 v[116:119], v5 offset:400
ds_read_b128 v[120:123], v5 offset:416
ds_read_b128 v[124:127], v5 offset:432
ds_read_b128 v[128:131], v5 offset:448
ds_read_b128 v[132:135], v5 offset:464
ds_read_b128 v[136:139], v5 offset:480
ds_read_b128 v[140:143], v5 offset:496
s_waitcnt lgkmcnt(0)
v_pk_add_f32 v[144:145], v[16:17], v[80:81] neg_lo:[0,1] neg_hi:[0,1]
v_pk_add_f32 v[146:147], v[18:19], v[82:83] neg_lo:[0,1] neg_hi:[0,1]
v_pk_add_f32 v[16:17], v[16:17], v[80:81]
v_pk_add_f32 v[18:19], v[18:19], v[82:83]
v_pk_add_f32 v[80:81], v[20:21], v[84:85] neg_lo:[0,1] neg_hi:[0,1]
v_pk_add_f32 v[82:83], v[22:23], v[86:87] neg_lo:[0,1] neg_hi:[0,1]
v_pk_add_f32 v[20:21], v[20:21], v[84:85]
v_pk_add_f32 v[22:23], v[22:23], v[86:87]
v_pk_mul_f32 v[84:85], v[80:81], s[30:31] op_sel_hi:[1,0]
v_pk_mul_f32 v[86:87], v[80:81], s[36:37] op_sel_hi:[1,0] neg_lo:[0,1] neg_hi:[0,1]
v_pk_fma_f32 v[84:85], v[82:83], s[36:37], v[84:85] op_sel_hi:[1,0,1]
v_pk_fma_f32 v[86:87], v[82:83], s[30:31], v[86:87] op_sel_hi:[1,0,1]
v_pk_add_f32 v[80:81], v[24:25], v[88:89] neg_lo:[0,1] neg_hi:[0,1]
v_pk_add_f32 v[82:83], v[26:27], v[90:91] neg_lo:[0,1] neg_hi:[0,1]
v_pk_add_f32 v[24:25], v[24:25], v[88:89]
v_pk_add_f32 v[26:27], v[26:27], v[90:91]
v_pk_mul_f32 v[88:89], v[80:81], s[30:31] op_sel:[0,1]
v_pk_mul_f32 v[90:91], v[80:81], s[34:35] op_sel:[0,1] neg_lo:[0,1] neg_hi:[0,1]
v_pk_fma_f32 v[88:89], v[82:83], s[34:35], v[88:89] op_sel:[0,1,0]
v_pk_fma_f32 v[90:91], v[82:83], s[30:31], v[90:91] op_sel:[0,1,0]
v_pk_add_f32 v[80:81], v[28:29], v[92:93] neg_lo:[0,1] neg_hi:[0,1]
v_pk_add_f32 v[82:83], v[30:31], v[94:95] neg_lo:[0,1] neg_hi:[0,1]
v_pk_add_f32 v[28:29], v[28:29], v[92:93]
v_pk_add_f32 v[30:31], v[30:31], v[94:95]
v_pk_mul_f32 v[92:93], v[80:81], s[32:33] op_sel_hi:[1,0]
v_pk_mul_f32 v[94:95], v[80:81], s[34:35] op_sel_hi:[1,0] neg_lo:[0,1] neg_hi:[0,1]
v_pk_fma_f32 v[92:93], v[82:83], s[34:35], v[92:93] op_sel_hi:[1,0,1]
v_pk_fma_f32 v[94:95], v[82:83], s[32:33], v[94:95] op_sel_hi:[1,0,1]
v_pk_add_f32 v[80:81], v[32:33], v[96:97] neg_lo:[0,1] neg_hi:[0,1]
v_pk_add_f32 v[82:83], v[34:35], v[98:99] neg_lo:[0,1] neg_hi:[0,1]
v_pk_add_f32 v[32:33], v[32:33], v[96:97]
v_pk_add_f32 v[34:35], v[34:35], v[98:99]
v_pk_mul_f32 v[96:97], v[80:81], s[32:33] op_sel:[0,1]
v_pk_mul_f32 v[98:99], v[80:81], s[32:33] op_sel:[0,1] neg_lo:[0,1] neg_hi:[0,1]
v_pk_fma_f32 v[96:97], v[82:83], s[32:33], v[96:97] op_sel:[0,1,0]
v_pk_fma_f32 v[98:99], v[82:83], s[32:33], v[98:99] op_sel:[0,1,0]
v_pk_add_f32 v[80:81], v[36:37], v[100:101] neg_lo:[0,1] neg_hi:[0,1]
v_pk_add_f32 v[82:83], v[38:39], v[102:103] neg_lo:[0,1] neg_hi:[0,1]
v_pk_add_f32 v[36:37], v[36:37], v[100:101]
v_pk_add_f32 v[38:39], v[38:39], v[102:103]
v_pk_mul_f32 v[100:101], v[80:81], s[34:35] op_sel_hi:[1,0]
v_pk_mul_f32 v[102:103], v[80:81], s[32:33] op_sel_hi:[1,0] neg_lo:[0,1] neg_hi:[0,1]
v_pk_fma_f32 v[100:101], v[82:83], s[32:33], v[100:101] op_sel_hi:[1,0,1]
v_pk_fma_f32 v[102:103], v[82:83], s[34:35], v[102:103] op_sel_hi:[1,0,1]
v_pk_add_f32 v[80:81], v[40:41], v[104:105] neg_lo:[0,1] neg_hi:[0,1]
v_pk_add_f32 v[82:83], v[42:43], v[106:107] neg_lo:[0,1] neg_hi:[0,1]
v_pk_add_f32 v[40:41], v[40:41], v[104:105]
v_pk_add_f32 v[42:43], v[42:43], v[106:107]
v_pk_mul_f32 v[104:105], v[80:81], s[34:35] op_sel:[0,1]
v_pk_mul_f32 v[106:107], v[80:81], s[30:31] op_sel:[0,1] neg_lo:[0,1] neg_hi:[0,1]
v_pk_fma_f32 v[104:105], v[82:83], s[30:31], v[104:105] op_sel:[0,1,0]
v_pk_fma_f32 v[106:107], v[82:83], s[34:35], v[106:107] op_sel:[0,1,0]
v_pk_add_f32 v[80:81], v[44:45], v[108:109] neg_lo:[0,1] neg_hi:[0,1]
v_pk_add_f32 v[82:83], v[46:47], v[110:111] neg_lo:[0,1] neg_hi:[0,1]
v_pk_add_f32 v[44:45], v[44:45], v[108:109]
v_pk_add_f32 v[46:47], v[46:47], v[110:111]
v_pk_mul_f32 v[108:109], v[80:81], s[36:37] op_sel_hi:[1,0]
v_pk_mul_f32 v[110:111], v[80:81], s[30:31] op_sel_hi:[1,0] neg_lo:[0,1] neg_hi:[0,1]
v_pk_fma_f32 v[108:109], v[82:83], s[30:31], v[108:109] op_sel_hi:[1,0,1]
v_pk_fma_f32 v[110:111], v[82:83], s[36:37], v[110:111] op_sel_hi:[1,0,1]
v_pk_add_f32 v[80:81], v[50:51], v[114:115] neg_lo:[0,1] neg_hi:[0,1]
v_pk_add_f32 v[82:83], v[112:113], v[48:49] neg_lo:[0,1] neg_hi:[0,1]
v_pk_add_f32 v[48:49], v[48:49], v[112:113]
v_pk_add_f32 v[50:51], v[50:51], v[114:115]
v_pk_add_f32 v[112:113], v[52:53], v[116:117] neg_lo:[0,1] neg_hi:[0,1]
v_pk_add_f32 v[114:115], v[54:55], v[118:119] neg_lo:[0,1] neg_hi:[0,1]
v_pk_add_f32 v[52:53], v[52:53], v[116:117]
v_pk_add_f32 v[54:55], v[54:55], v[118:119]
v_pk_mul_f32 v[116:117], v[112:113], s[36:37] op_sel_hi:[1,0] neg_lo:[0,1] neg_hi:[0,1]
v_pk_mul_f32 v[118:119], v[112:113], s[30:31] op_sel_hi:[1,0] neg_lo:[0,1] neg_hi:[0,1]
v_pk_fma_f32 v[116:117], v[114:115], s[30:31], v[116:117] op_sel_hi:[1,0,1]
v_pk_fma_f32 v[118:119], v[114:115], s[36:37], v[118:119] op_sel_hi:[1,0,1] neg_lo:[0,1,0] neg_hi:[0,1,0]
v_pk_add_f32 v[112:113], v[56:57], v[120:121] neg_lo:[0,1] neg_hi:[0,1]
v_pk_add_f32 v[114:115], v[58:59], v[122:123] neg_lo:[0,1] neg_hi:[0,1]
v_pk_add_f32 v[56:57], v[56:57], v[120:121]
v_pk_add_f32 v[58:59], v[58:59], v[122:123]
v_pk_mul_f32 v[120:121], v[112:113], s[34:35] op_sel:[0,1] neg_lo:[0,1] neg_hi:[0,1]
v_pk_mul_f32 v[122:123], v[112:113], s[30:31] op_sel:[0,1] neg_lo:[0,1] neg_hi:[0,1]
v_pk_fma_f32 v[120:121], v[114:115], s[30:31], v[120:121] op_sel:[0,1,0]
v_pk_fma_f32 v[122:123], v[114:115], s[34:35], v[122:123] op_sel:[0,1,0] neg_lo:[0,1,0] neg_hi:[0,1,0]
v_pk_add_f32 v[112:113], v[60:61], v[124:125] neg_lo:[0,1] neg_hi:[0,1]
v_pk_add_f32 v[114:115], v[62:63], v[126:127] neg_lo:[0,1] neg_hi:[0,1]
v_pk_add_f32 v[60:61], v[60:61], v[124:125]
v_pk_add_f32 v[62:63], v[62:63], v[126:127]
v_pk_mul_f32 v[124:125], v[112:113], s[34:35] op_sel_hi:[1,0] neg_lo:[0,1] neg_hi:[0,1]
v_pk_mul_f32 v[126:127], v[112:113], s[32:33] op_sel_hi:[1,0] neg_lo:[0,1] neg_hi:[0,1]
v_pk_fma_f32 v[124:125], v[114:115], s[32:33], v[124:125] op_sel_hi:[1,0,1]
v_pk_fma_f32 v[126:127], v[114:115], s[34:35], v[126:127] op_sel_hi:[1,0,1] neg_lo:[0,1,0] neg_hi:[0,1,0]
v_pk_add_f32 v[112:113], v[64:65], v[128:129] neg_lo:[0,1] neg_hi:[0,1]
v_pk_add_f32 v[114:115], v[66:67], v[130:131] neg_lo:[0,1] neg_hi:[0,1]
v_pk_add_f32 v[64:65], v[64:65], v[128:129]
v_pk_add_f32 v[66:67], v[66:67], v[130:131]
v_pk_mul_f32 v[128:129], v[112:113], s[32:33] op_sel:[0,1] neg_lo:[0,1] neg_hi:[0,1]
v_pk_mul_f32 v[130:131], v[112:113], s[32:33] op_sel:[0,1] neg_lo:[0,1] neg_hi:[0,1]
v_pk_fma_f32 v[128:129], v[114:115], s[32:33], v[128:129] op_sel:[0,1,0]
v_pk_fma_f32 v[130:131], v[114:115], s[32:33], v[130:131] op_sel:[0,1,0] neg_lo:[0,1,0] neg_hi:[0,1,0]
v_pk_add_f32 v[112:113], v[68:69], v[132:133] neg_lo:[0,1] neg_hi:[0,1]
v_pk_add_f32 v[114:115], v[70:71], v[134:135] neg_lo:[0,1] neg_hi:[0,1]
v_pk_add_f32 v[68:69], v[68:69], v[132:133]
v_pk_add_f32 v[70:71], v[70:71], v[134:135]
v_pk_mul_f32 v[132:133], v[112:113], s[32:33] op_sel_hi:[1,0] neg_lo:[0,1] neg_hi:[0,1]
v_pk_mul_f32 v[134:135], v[112:113], s[34:35] op_sel_hi:[1,0] neg_lo:[0,1] neg_hi:[0,1]
v_pk_fma_f32 v[132:133], v[114:115], s[34:35], v[132:133] op_sel_hi:[1,0,1]
v_pk_fma_f32 v[134:135], v[114:115], s[32:33], v[134:135] op_sel_hi:[1,0,1] neg_lo:[0,1,0] neg_hi:[0,1,0]
v_pk_add_f32 v[112:113], v[72:73], v[136:137] neg_lo:[0,1] neg_hi:[0,1]
v_pk_add_f32 v[114:115], v[74:75], v[138:139] neg_lo:[0,1] neg_hi:[0,1]
v_pk_add_f32 v[72:73], v[72:73], v[136:137]
v_pk_add_f32 v[74:75], v[74:75], v[138:139]
v_pk_mul_f32 v[136:137], v[112:113], s[30:31] op_sel:[0,1] neg_lo:[0,1] neg_hi:[0,1]
v_pk_mul_f32 v[138:139], v[112:113], s[34:35] op_sel:[0,1] neg_lo:[0,1] neg_hi:[0,1]
v_pk_fma_f32 v[136:137], v[114:115], s[34:35], v[136:137] op_sel:[0,1,0]
v_pk_fma_f32 v[138:139], v[114:115], s[30:31], v[138:139] op_sel:[0,1,0] neg_lo:[0,1,0] neg_hi:[0,1,0]
v_pk_add_f32 v[112:113], v[76:77], v[140:141] neg_lo:[0,1] neg_hi:[0,1]
v_pk_add_f32 v[114:115], v[78:79], v[142:143] neg_lo:[0,1] neg_hi:[0,1]
v_pk_add_f32 v[76:77], v[76:77], v[140:141]
v_pk_add_f32 v[78:79], v[78:79], v[142:143]
v_pk_mul_f32 v[140:141], v[112:113], s[30:31] op_sel_hi:[1,0] neg_lo:[0,1] neg_hi:[0,1]
v_pk_mul_f32 v[142:143], v[112:113], s[36:37] op_sel_hi:[1,0] neg_lo:[0,1] neg_hi:[0,1]
v_pk_fma_f32 v[140:141], v[114:115], s[36:37], v[140:141] op_sel_hi:[1,0,1]
v_pk_fma_f32 v[142:143], v[114:115], s[30:31], v[142:143] op_sel_hi:[1,0,1] neg_lo:[0,1,0] neg_hi:[0,1,0]
v_pk_add_f32 v[112:113], v[16:17], v[48:49] neg_lo:[0,1] neg_hi:[0,1]
v_pk_add_f32 v[114:115], v[18:19], v[50:51] neg_lo:[0,1] neg_hi:[0,1]
v_pk_add_f32 v[16:17], v[16:17], v[48:49]
v_pk_add_f32 v[18:19], v[18:19], v[50:51]
v_pk_add_f32 v[48:49], v[20:21], v[52:53] neg_lo:[0,1] neg_hi:[0,1]
v_pk_add_f32 v[50:51], v[22:23], v[54:55] neg_lo:[0,1] neg_hi:[0,1]
v_pk_add_f32 v[20:21], v[20:21], v[52:53]
v_pk_add_f32 v[22:23], v[22:23], v[54:55]
v_pk_mul_f32 v[52:53], v[48:49], s[30:31] op_sel:[0,1]
v_pk_mul_f32 v[54:55], v[48:49], s[34:35] op_sel:[0,1] neg_lo:[0,1] neg_hi:[0,1]
v_pk_fma_f32 v[52:53], v[50:51], s[34:35], v[52:53] op_sel:[0,1,0]
v_pk_fma_f32 v[54:55], v[50:51], s[30:31], v[54:55] op_sel:[0,1,0]
v_pk_add_f32 v[48:49], v[24:25], v[56:57] neg_lo:[0,1] neg_hi:[0,1]
v_pk_add_f32 v[50:51], v[26:27], v[58:59] neg_lo:[0,1] neg_hi:[0,1]
v_pk_add_f32 v[24:25], v[24:25], v[56:57]
v_pk_add_f32 v[26:27], v[26:27], v[58:59]
v_pk_mul_f32 v[56:57], v[48:49], s[32:33] op_sel:[0,1]
v_pk_mul_f32 v[58:59], v[48:49], s[32:33] op_sel:[0,1] neg_lo:[0,1] neg_hi:[0,1]
v_pk_fma_f32 v[56:57], v[50:51], s[32:33], v[56:57] op_sel:[0,1,0]
v_pk_fma_f32 v[58:59], v[50:51], s[32:33], v[58:59] op_sel:[0,1,0]
v_pk_add_f32 v[48:49], v[28:29], v[60:61] neg_lo:[0,1] neg_hi:[0,1]
v_pk_add_f32 v[50:51], v[30:31], v[62:63] neg_lo:[0,1] neg_hi:[0,1]
v_pk_add_f32 v[28:29], v[28:29], v[60:61]
v_pk_add_f32 v[30:31], v[30:31], v[62:63]
v_pk_mul_f32 v[60:61], v[48:49], s[34:35] op_sel:[0,1]
v_pk_mul_f32 v[62:63], v[48:49], s[30:31] op_sel:[0,1] neg_lo:[0,1] neg_hi:[0,1]
v_pk_fma_f32 v[60:61], v[50:51], s[30:31], v[60:61] op_sel:[0,1,0]
v_pk_fma_f32 v[62:63], v[50:51], s[34:35], v[62:63] op_sel:[0,1,0]
v_pk_add_f32 v[48:49], v[34:35], v[66:67] neg_lo:[0,1] neg_hi:[0,1]
v_pk_add_f32 v[50:51], v[64:65], v[32:33] neg_lo:[0,1] neg_hi:[0,1]
v_pk_add_f32 v[32:33], v[32:33], v[64:65]
v_pk_add_f32 v[34:35], v[34:35], v[66:67]
v_pk_add_f32 v[64:65], v[36:37], v[68:69] neg_lo:[0,1] neg_hi:[0,1]
v_pk_add_f32 v[66:67], v[38:39], v[70:71] neg_lo:[0,1] neg_hi:[0,1]
v_pk_add_f32 v[36:37], v[36:37], v[68:69]
v_pk_add_f32 v[38:39], v[38:39], v[70:71]
v_pk_mul_f32 v[68:69], v[64:65], s[34:35] op_sel:[0,1] neg_lo:[0,1] neg_hi:[0,1]
v_pk_mul_f32 v[70:71], v[64:65], s[30:31] op_sel:[0,1] neg_lo:[0,1] neg_hi:[0,1]
v_pk_fma_f32 v[68:69], v[66:67], s[30:31], v[68:69] op_sel:[0,1,0]
v_pk_fma_f32 v[70:71], v[66:67], s[34:35], v[70:71] op_sel:[0,1,0] neg_lo:[0,1,0] neg_hi:[0,1,0]
v_pk_add_f32 v[64:65], v[40:41], v[72:73] neg_lo:[0,1] neg_hi:[0,1]
v_pk_add_f32 v[66:67], v[42:43], v[74:75] neg_lo:[0,1] neg_hi:[0,1]
v_pk_add_f32 v[40:41], v[40:41], v[72:73]
v_pk_add_f32 v[42:43], v[42:43], v[74:75]
v_pk_mul_f32 v[72:73], v[64:65], s[32:33] op_sel:[0,1] neg_lo:[0,1] neg_hi:[0,1]
v_pk_mul_f32 v[74:75], v[64:65], s[32:33] op_sel:[0,1] neg_lo:[0,1] neg_hi:[0,1]
v_pk_fma_f32 v[72:73], v[66:67], s[32:33], v[72:73] op_sel:[0,1,0]
v_pk_fma_f32 v[74:75], v[66:67], s[32:33], v[74:75] op_sel:[0,1,0] neg_lo:[0,1,0] neg_hi:[0,1,0]
v_pk_add_f32 v[64:65], v[44:45], v[76:77] neg_lo:[0,1] neg_hi:[0,1]
v_pk_add_f32 v[66:67], v[46:47], v[78:79] neg_lo:[0,1] neg_hi:[0,1]
v_pk_add_f32 v[44:45], v[44:45], v[76:77]
v_pk_add_f32 v[46:47], v[46:47], v[78:79]
v_pk_mul_f32 v[76:77], v[64:65], s[30:31] op_sel:[0,1] neg_lo:[0,1] neg_hi:[0,1]
v_pk_mul_f32 v[78:79], v[64:65], s[34:35] op_sel:[0,1] neg_lo:[0,1] neg_hi:[0,1]
v_pk_fma_f32 v[76:77], v[66:67], s[34:35], v[76:77] op_sel:[0,1,0]
v_pk_fma_f32 v[78:79], v[66:67], s[30:31], v[78:79] op_sel:[0,1,0] neg_lo:[0,1,0] neg_hi:[0,1,0]
v_pk_add_f32 v[64:65], v[144:145], v[80:81] neg_lo:[0,1] neg_hi:[0,1]
v_pk_add_f32 v[66:67], v[146:147], v[82:83] neg_lo:[0,1] neg_hi:[0,1]
v_pk_add_f32 v[144:145], v[144:145], v[80:81]
v_pk_add_f32 v[146:147], v[146:147], v[82:83]
v_pk_add_f32 v[80:81], v[84:85], v[116:117] neg_lo:[0,1] neg_hi:[0,1]
v_pk_add_f32 v[82:83], v[86:87], v[118:119] neg_lo:[0,1] neg_hi:[0,1]
v_pk_add_f32 v[84:85], v[84:85], v[116:117]
v_pk_add_f32 v[86:87], v[86:87], v[118:119]
v_pk_mul_f32 v[116:117], v[80:81], s[30:31] op_sel:[0,1]
v_pk_mul_f32 v[118:119], v[80:81], s[34:35] op_sel:[0,1] neg_lo:[0,1] neg_hi:[0,1]
v_pk_fma_f32 v[116:117], v[82:83], s[34:35], v[116:117] op_sel:[0,1,0]
v_pk_fma_f32 v[118:119], v[82:83], s[30:31], v[118:119] op_sel:[0,1,0]
v_pk_add_f32 v[80:81], v[88:89], v[120:121] neg_lo:[0,1] neg_hi:[0,1]
v_pk_add_f32 v[82:83], v[90:91], v[122:123] neg_lo:[0,1] neg_hi:[0,1]
v_pk_add_f32 v[88:89], v[88:89], v[120:121]
v_pk_add_f32 v[90:91], v[90:91], v[122:123]
v_pk_mul_f32 v[120:121], v[80:81], s[32:33] op_sel:[0,1]
v_pk_mul_f32 v[122:123], v[80:81], s[32:33] op_sel:[0,1] neg_lo:[0,1] neg_hi:[0,1]
v_pk_fma_f32 v[120:121], v[82:83], s[32:33], v[120:121] op_sel:[0,1,0]
v_pk_fma_f32 v[122:123], v[82:83], s[32:33], v[122:123] op_sel:[0,1,0]
v_pk_add_f32 v[80:81], v[92:93], v[124:125] neg_lo:[0,1] neg_hi:[0,1]
v_pk_add_f32 v[82:83], v[94:95], v[126:127] neg_lo:[0,1] neg_hi:[0,1]
v_pk_add_f32 v[92:93], v[92:93], v[124:125]
v_pk_add_f32 v[94:95], v[94:95], v[126:127]
v_pk_mul_f32 v[124:125], v[80:81], s[34:35] op_sel:[0,1]
v_pk_mul_f32 v[126:127], v[80:81], s[30:31] op_sel:[0,1] neg_lo:[0,1] neg_hi:[0,1]
v_pk_fma_f32 v[124:125], v[82:83], s[30:31], v[124:125] op_sel:[0,1,0]
v_pk_fma_f32 v[126:127], v[82:83], s[34:35], v[126:127] op_sel:[0,1,0]
v_pk_add_f32 v[80:81], v[98:99], v[130:131] neg_lo:[0,1] neg_hi:[0,1]
v_pk_add_f32 v[82:83], v[128:129], v[96:97] neg_lo:[0,1] neg_hi:[0,1]
v_pk_add_f32 v[96:97], v[96:97], v[128:129]
v_pk_add_f32 v[98:99], v[98:99], v[130:131]
v_pk_add_f32 v[128:129], v[100:101], v[132:133] neg_lo:[0,1] neg_hi:[0,1]
v_pk_add_f32 v[130:131], v[102:103], v[134:135] neg_lo:[0,1] neg_hi:[0,1]
v_pk_add_f32 v[100:101], v[100:101], v[132:133]
v_pk_add_f32 v[102:103], v[102:103], v[134:135]
v_pk_mul_f32 v[132:133], v[128:129], s[34:35] op_sel:[0,1] neg_lo:[0,1] neg_hi:[0,1]
v_pk_mul_f32 v[134:135], v[128:129], s[30:31] op_sel:[0,1] neg_lo:[0,1] neg_hi:[0,1]
v_pk_fma_f32 v[132:133], v[130:131], s[30:31], v[132:133] op_sel:[0,1,0]
v_pk_fma_f32 v[134:135], v[130:131], s[34:35], v[134:135] op_sel:[0,1,0] neg_lo:[0,1,0] neg_hi:[0,1,0]
v_pk_add_f32 v[128:129], v[104:105], v[136:137] neg_lo:[0,1] neg_hi:[0,1]
v_pk_add_f32 v[130:131], v[106:107], v[138:139] neg_lo:[0,1] neg_hi:[0,1]
v_pk_add_f32 v[104:105], v[104:105], v[136:137]
v_pk_add_f32 v[106:107], v[106:107], v[138:139]
v_pk_mul_f32 v[136:137], v[128:129], s[32:33] op_sel:[0,1] neg_lo:[0,1] neg_hi:[0,1]
v_pk_mul_f32 v[138:139], v[128:129], s[32:33] op_sel:[0,1] neg_lo:[0,1] neg_hi:[0,1]
v_pk_fma_f32 v[136:137], v[130:131], s[32:33], v[136:137] op_sel:[0,1,0]
v_pk_fma_f32 v[138:139], v[130:131], s[32:33], v[138:139] op_sel:[0,1,0] neg_lo:[0,1,0] neg_hi:[0,1,0]
v_pk_add_f32 v[128:129], v[108:109], v[140:141] neg_lo:[0,1] neg_hi:[0,1]
v_pk_add_f32 v[130:131], v[110:111], v[142:143] neg_lo:[0,1] neg_hi:[0,1]
v_pk_add_f32 v[108:109], v[108:109], v[140:141]
v_pk_add_f32 v[110:111], v[110:111], v[142:143]
v_pk_mul_f32 v[140:141], v[128:129], s[30:31] op_sel:[0,1] neg_lo:[0,1] neg_hi:[0,1]
v_pk_mul_f32 v[142:143], v[128:129], s[34:35] op_sel:[0,1] neg_lo:[0,1] neg_hi:[0,1]
v_pk_fma_f32 v[140:141], v[130:131], s[34:35], v[140:141] op_sel:[0,1,0]
v_pk_fma_f32 v[142:143], v[130:131], s[30:31], v[142:143] op_sel:[0,1,0] neg_lo:[0,1,0] neg_hi:[0,1,0]
v_pk_add_f32 v[128:129], v[16:17], v[32:33] neg_lo:[0,1] neg_hi:[0,1]
v_pk_add_f32 v[130:131], v[18:19], v[34:35] neg_lo:[0,1] neg_hi:[0,1]
v_pk_add_f32 v[16:17], v[16:17], v[32:33]
v_pk_add_f32 v[18:19], v[18:19], v[34:35]
v_pk_add_f32 v[32:33], v[20:21], v[36:37] neg_lo:[0,1] neg_hi:[0,1]
v_pk_add_f32 v[34:35], v[22:23], v[38:39] neg_lo:[0,1] neg_hi:[0,1]
v_pk_add_f32 v[20:21], v[20:21], v[36:37]
v_pk_add_f32 v[22:23], v[22:23], v[38:39]
v_pk_mul_f32 v[36:37], v[32:33], s[32:33] op_sel:[0,1]
v_pk_mul_f32 v[38:39], v[32:33], s[32:33] op_sel:[0,1] neg_lo:[0,1] neg_hi:[0,1]
v_pk_fma_f32 v[36:37], v[34:35], s[32:33], v[36:37] op_sel:[0,1,0]
v_pk_fma_f32 v[38:39], v[34:35], s[32:33], v[38:39] op_sel:[0,1,0]
v_pk_add_f32 v[32:33], v[26:27], v[42:43] neg_lo:[0,1] neg_hi:[0,1]
v_pk_add_f32 v[34:35], v[40:41], v[24:25] neg_lo:[0,1] neg_hi:[0,1]
v_pk_add_f32 v[24:25], v[24:25], v[40:41]
v_pk_add_f32 v[26:27], v[26:27], v[42:43]
v_pk_add_f32 v[40:41], v[28:29], v[44:45] neg_lo:[0,1] neg_hi:[0,1]
v_pk_add_f32 v[42:43], v[30:31], v[46:47] neg_lo:[0,1] neg_hi:[0,1]
v_pk_add_f32 v[28:29], v[28:29], v[44:45]
v_pk_add_f32 v[30:31], v[30:31], v[46:47]
v_pk_mul_f32 v[44:45], v[40:41], s[32:33] op_sel:[0,1] neg_lo:[0,1] neg_hi:[0,1]
v_pk_mul_f32 v[46:47], v[40:41], s[32:33] op_sel:[0,1] neg_lo:[0,1] neg_hi:[0,1]
v_pk_fma_f32 v[44:45], v[42:43], s[32:33], v[44:45] op_sel:[0,1,0]
v_pk_fma_f32 v[46:47], v[42:43], s[32:33], v[46:47] op_sel:[0,1,0] neg_lo:[0,1,0] neg_hi:[0,1,0]
v_pk_add_f32 v[40:41], v[112:113], v[48:49] neg_lo:[0,1] neg_hi:[0,1]
v_pk_add_f32 v[42:43], v[114:115], v[50:51] neg_lo:[0,1] neg_hi:[0,1]
v_pk_add_f32 v[112:113], v[112:113], v[48:49]
v_pk_add_f32 v[114:115], v[114:115], v[50:51]
v_pk_add_f32 v[48:49], v[52:53], v[68:69] neg_lo:[0,1] neg_hi:[0,1]
v_pk_add_f32 v[50:51], v[54:55], v[70:71] neg_lo:[0,1] neg_hi:[0,1]
v_pk_add_f32 v[52:53], v[52:53], v[68:69]
v_pk_add_f32 v[54:55], v[54:55], v[70:71]
v_pk_mul_f32 v[68:69], v[48:49], s[32:33] op_sel:[0,1]
v_pk_mul_f32 v[70:71], v[48:49], s[32:33] op_sel:[0,1] neg_lo:[0,1] neg_hi:[0,1]
v_pk_fma_f32 v[68:69], v[50:51], s[32:33], v[68:69] op_sel:[0,1,0]
v_pk_fma_f32 v[70:71], v[50:51], s[32:33], v[70:71] op_sel:[0,1,0]
v_pk_add_f32 v[48:49], v[58:59], v[74:75] neg_lo:[0,1] neg_hi:[0,1]
v_pk_add_f32 v[50:51], v[72:73], v[56:57] neg_lo:[0,1] neg_hi:[0,1]
v_pk_add_f32 v[56:57], v[56:57], v[72:73]
v_pk_add_f32 v[58:59], v[58:59], v[74:75]
v_pk_add_f32 v[72:73], v[60:61], v[76:77] neg_lo:[0,1] neg_hi:[0,1]
v_pk_add_f32 v[74:75], v[62:63], v[78:79] neg_lo:[0,1] neg_hi:[0,1]
v_pk_add_f32 v[60:61], v[60:61], v[76:77]
v_pk_add_f32 v[62:63], v[62:63], v[78:79]
v_pk_mul_f32 v[76:77], v[72:73], s[32:33] op_sel:[0,1] neg_lo:[0,1] neg_hi:[0,1]
v_pk_mul_f32 v[78:79], v[72:73], s[32:33] op_sel:[0,1] neg_lo:[0,1] neg_hi:[0,1]
v_pk_fma_f32 v[76:77], v[74:75], s[32:33], v[76:77] op_sel:[0,1,0]
v_pk_fma_f32 v[78:79], v[74:75], s[32:33], v[78:79] op_sel:[0,1,0] neg_lo:[0,1,0] neg_hi:[0,1,0]
v_pk_add_f32 v[72:73], v[144:145], v[96:97] neg_lo:[0,1] neg_hi:[0,1]
v_pk_add_f32 v[74:75], v[146:147], v[98:99] neg_lo:[0,1] neg_hi:[0,1]
v_pk_add_f32 v[144:145], v[144:145], v[96:97]
v_pk_add_f32 v[146:147], v[146:147], v[98:99]
v_pk_add_f32 v[96:97], v[84:85], v[100:101] neg_lo:[0,1] neg_hi:[0,1]
v_pk_add_f32 v[98:99], v[86:87], v[102:103] neg_lo:[0,1] neg_hi:[0,1]
v_pk_add_f32 v[84:85], v[84:85], v[100:101]
v_pk_add_f32 v[86:87], v[86:87], v[102:103]
v_pk_mul_f32 v[100:101], v[96:97], s[32:33] op_sel:[0,1]
v_pk_mul_f32 v[102:103], v[96:97], s[32:33] op_sel:[0,1] neg_lo:[0,1] neg_hi:[0,1]
v_pk_fma_f32 v[100:101], v[98:99], s[32:33], v[100:101] op_sel:[0,1,0]
v_pk_fma_f32 v[102:103], v[98:99], s[32:33], v[102:103] op_sel:[0,1,0]
v_pk_add_f32 v[96:97], v[90:91], v[106:107] neg_lo:[0,1] neg_hi:[0,1]
v_pk_add_f32 v[98:99], v[104:105], v[88:89] neg_lo:[0,1] neg_hi:[0,1]
v_pk_add_f32 v[88:89], v[88:89], v[104:105]
v_pk_add_f32 v[90:91], v[90:91], v[106:107]
v_pk_add_f32 v[104:105], v[92:93], v[108:109] neg_lo:[0,1] neg_hi:[0,1]
v_pk_add_f32 v[106:107], v[94:95], v[110:111] neg_lo:[0,1] neg_hi:[0,1]
v_pk_add_f32 v[92:93], v[92:93], v[108:109]
v_pk_add_f32 v[94:95], v[94:95], v[110:111]
v_pk_mul_f32 v[108:109], v[104:105], s[32:33] op_sel:[0,1] neg_lo:[0,1] neg_hi:[0,1]
v_pk_mul_f32 v[110:111], v[104:105], s[32:33] op_sel:[0,1] neg_lo:[0,1] neg_hi:[0,1]
v_pk_fma_f32 v[108:109], v[106:107], s[32:33], v[108:109] op_sel:[0,1,0]
v_pk_fma_f32 v[110:111], v[106:107], s[32:33], v[110:111] op_sel:[0,1,0] neg_lo:[0,1,0] neg_hi:[0,1,0]
v_pk_add_f32 v[104:105], v[64:65], v[80:81] neg_lo:[0,1] neg_hi:[0,1]
v_pk_add_f32 v[106:107], v[66:67], v[82:83] neg_lo:[0,1] neg_hi:[0,1]
v_pk_add_f32 v[64:65], v[64:65], v[80:81]
v_pk_add_f32 v[66:67], v[66:67], v[82:83]
v_pk_add_f32 v[80:81], v[116:117], v[132:133] neg_lo:[0,1] neg_hi:[0,1]
v_pk_add_f32 v[82:83], v[118:119], v[134:135] neg_lo:[0,1] neg_hi:[0,1]
v_pk_add_f32 v[116:117], v[116:117], v[132:133]
v_pk_add_f32 v[118:119], v[118:119], v[134:135]
v_pk_mul_f32 v[132:133], v[80:81], s[32:33] op_sel:[0,1]
v_pk_mul_f32 v[134:135], v[80:81], s[32:33] op_sel:[0,1] neg_lo:[0,1] neg_hi:[0,1]
v_pk_fma_f32 v[132:133], v[82:83], s[32:33], v[132:133] op_sel:[0,1,0]
v_pk_fma_f32 v[134:135], v[82:83], s[32:33], v[134:135] op_sel:[0,1,0]
v_pk_add_f32 v[80:81], v[122:123], v[138:139] neg_lo:[0,1] neg_hi:[0,1]
v_pk_add_f32 v[82:83], v[136:137], v[120:121] neg_lo:[0,1] neg_hi:[0,1]
v_pk_add_f32 v[120:121], v[120:121], v[136:137]
v_pk_add_f32 v[122:123], v[122:123], v[138:139]
v_pk_add_f32 v[136:137], v[124:125], v[140:141] neg_lo:[0,1] neg_hi:[0,1]
v_pk_add_f32 v[138:139], v[126:127], v[142:143] neg_lo:[0,1] neg_hi:[0,1]
v_pk_add_f32 v[124:125], v[124:125], v[140:141]
v_pk_add_f32 v[126:127], v[126:127], v[142:143]
v_pk_mul_f32 v[140:141], v[136:137], s[32:33] op_sel:[0,1] neg_lo:[0,1] neg_hi:[0,1]
v_pk_mul_f32 v[142:143], v[136:137], s[32:33] op_sel:[0,1] neg_lo:[0,1] neg_hi:[0,1]
v_pk_fma_f32 v[140:141], v[138:139], s[32:33], v[140:141] op_sel:[0,1,0]
v_pk_fma_f32 v[142:143], v[138:139], s[32:33], v[142:143] op_sel:[0,1,0] neg_lo:[0,1,0] neg_hi:[0,1,0]
v_pk_add_f32 v[136:137], v[16:17], v[24:25] neg_lo:[0,1] neg_hi:[0,1]
v_pk_add_f32 v[138:139], v[18:19], v[26:27] neg_lo:[0,1] neg_hi:[0,1]
v_pk_add_f32 v[16:17], v[16:17], v[24:25]
v_pk_add_f32 v[18:19], v[18:19], v[26:27]
v_pk_add_f32 v[24:25], v[22:23], v[30:31] neg_lo:[0,1] neg_hi:[0,1]
v_pk_add_f32 v[26:27], v[28:29], v[20:21] neg_lo:[0,1] neg_hi:[0,1]
v_pk_add_f32 v[20:21], v[20:21], v[28:29]
v_pk_add_f32 v[22:23], v[22:23], v[30:31]
v_pk_add_f32 v[28:29], v[128:129], v[32:33] neg_lo:[0,1] neg_hi:[0,1]
v_pk_add_f32 v[30:31], v[130:131], v[34:35] neg_lo:[0,1] neg_hi:[0,1]
v_pk_add_f32 v[128:129], v[128:129], v[32:33]
v_pk_add_f32 v[130:131], v[130:131], v[34:35]
v_pk_add_f32 v[32:33], v[38:39], v[46:47] neg_lo:[0,1] neg_hi:[0,1]
v_pk_add_f32 v[34:35], v[44:45], v[36:37] neg_lo:[0,1] neg_hi:[0,1]
v_pk_add_f32 v[36:37], v[36:37], v[44:45]
v_pk_add_f32 v[38:39], v[38:39], v[46:47]
v_pk_add_f32 v[44:45], v[112:113], v[56:57] neg_lo:[0,1] neg_hi:[0,1]
v_pk_add_f32 v[46:47], v[114:115], v[58:59] neg_lo:[0,1] neg_hi:[0,1]
v_pk_add_f32 v[112:113], v[112:113], v[56:57]
v_pk_add_f32 v[114:115], v[114:115], v[58:59]
v_pk_add_f32 v[56:57], v[54:55], v[62:63] neg_lo:[0,1] neg_hi:[0,1]
v_pk_add_f32 v[58:59], v[60:61], v[52:53] neg_lo:[0,1] neg_hi:[0,1]
v_pk_add_f32 v[52:53], v[52:53], v[60:61]
v_pk_add_f32 v[54:55], v[54:55], v[62:63]
v_pk_add_f32 v[60:61], v[40:41], v[48:49] neg_lo:[0,1] neg_hi:[0,1]
v_pk_add_f32 v[62:63], v[42:43], v[50:51] neg_lo:[0,1] neg_hi:[0,1]
v_pk_add_f32 v[40:41], v[40:41], v[48:49]
v_pk_add_f32 v[42:43], v[42:43], v[50:51]
v_pk_add_f32 v[48:49], v[70:71], v[78:79] neg_lo:[0,1] neg_hi:[0,1]
v_pk_add_f32 v[50:51], v[76:77], v[68:69] neg_lo:[0,1] neg_hi:[0,1]
v_pk_add_f32 v[68:69], v[68:69], v[76:77]
v_pk_add_f32 v[70:71], v[70:71], v[78:79]
v_pk_add_f32 v[76:77], v[144:145], v[88:89] neg_lo:[0,1] neg_hi:[0,1]
v_pk_add_f32 v[78:79], v[146:147], v[90:91] neg_lo:[0,1] neg_hi:[0,1]
v_pk_add_f32 v[144:145], v[144:145], v[88:89]
v_pk_add_f32 v[146:147], v[146:147], v[90:91]
v_pk_add_f32 v[88:89], v[86:87], v[94:95] neg_lo:[0,1] neg_hi:[0,1]
v_pk_add_f32 v[90:91], v[92:93], v[84:85] neg_lo:[0,1] neg_hi:[0,1]
v_pk_add_f32 v[84:85], v[84:85], v[92:93]
v_pk_add_f32 v[86:87], v[86:87], v[94:95]
v_pk_add_f32 v[92:93], v[72:73], v[96:97] neg_lo:[0,1] neg_hi:[0,1]
v_pk_add_f32 v[94:95], v[74:75], v[98:99] neg_lo:[0,1] neg_hi:[0,1]
v_pk_add_f32 v[72:73], v[72:73], v[96:97]
v_pk_add_f32 v[74:75], v[74:75], v[98:99]
v_pk_add_f32 v[96:97], v[102:103], v[110:111] neg_lo:[0,1] neg_hi:[0,1]
v_pk_add_f32 v[98:99], v[108:109], v[100:101] neg_lo:[0,1] neg_hi:[0,1]
v_pk_add_f32 v[100:101], v[100:101], v[108:109]
v_pk_add_f32 v[102:103], v[102:103], v[110:111]
v_pk_add_f32 v[108:109], v[64:65], v[120:121] neg_lo:[0,1] neg_hi:[0,1]
v_pk_add_f32 v[110:111], v[66:67], v[122:123] neg_lo:[0,1] neg_hi:[0,1]
v_pk_add_f32 v[64:65], v[64:65], v[120:121]
v_pk_add_f32 v[66:67], v[66:67], v[122:123]
v_pk_add_f32 v[120:121], v[118:119], v[126:127] neg_lo:[0,1] neg_hi:[0,1]
v_pk_add_f32 v[122:123], v[124:125], v[116:117] neg_lo:[0,1] neg_hi:[0,1]
v_pk_add_f32 v[116:117], v[116:117], v[124:125]
v_pk_add_f32 v[118:119], v[118:119], v[126:127]
v_pk_add_f32 v[124:125], v[104:105], v[80:81] neg_lo:[0,1] neg_hi:[0,1]
v_pk_add_f32 v[126:127], v[106:107], v[82:83] neg_lo:[0,1] neg_hi:[0,1]
v_pk_add_f32 v[104:105], v[104:105], v[80:81]
v_pk_add_f32 v[106:107], v[106:107], v[82:83]
v_pk_add_f32 v[80:81], v[134:135], v[142:143] neg_lo:[0,1] neg_hi:[0,1]
v_pk_add_f32 v[82:83], v[140:141], v[132:133] neg_lo:[0,1] neg_hi:[0,1]
v_pk_add_f32 v[132:133], v[132:133], v[140:141]
v_pk_add_f32 v[134:135], v[134:135], v[142:143]
v_pk_add_f32 v[140:141], v[16:17], v[20:21] neg_lo:[0,1] neg_hi:[0,1]
v_pk_add_f32 v[142:143], v[18:19], v[22:23] neg_lo:[0,1] neg_hi:[0,1]
v_pk_add_f32 v[16:17], v[16:17], v[20:21]
v_pk_add_f32 v[18:19], v[18:19], v[22:23]
v_pk_add_f32 v[20:21], v[136:137], v[24:25] neg_lo:[0,1] neg_hi:[0,1]
v_pk_add_f32 v[22:23], v[138:139], v[26:27] neg_lo:[0,1] neg_hi:[0,1]
v_pk_add_f32 v[136:137], v[136:137], v[24:25]
v_pk_add_f32 v[138:139], v[138:139], v[26:27]
v_pk_add_f32 v[24:25], v[128:129], v[36:37] neg_lo:[0,1] neg_hi:[0,1]
v_pk_add_f32 v[26:27], v[130:131], v[38:39] neg_lo:[0,1] neg_hi:[0,1]
v_pk_add_f32 v[128:129], v[128:129], v[36:37]
v_pk_add_f32 v[130:131], v[130:131], v[38:39]
v_pk_add_f32 v[36:37], v[28:29], v[32:33] neg_lo:[0,1] neg_hi:[0,1]
v_pk_add_f32 v[38:39], v[30:31], v[34:35] neg_lo:[0,1] neg_hi:[0,1]
v_pk_add_f32 v[28:29], v[28:29], v[32:33]
v_pk_add_f32 v[30:31], v[30:31], v[34:35]
v_pk_add_f32 v[32:33], v[112:113], v[52:53] neg_lo:[0,1] neg_hi:[0,1]
v_pk_add_f32 v[34:35], v[114:115], v[54:55] neg_lo:[0,1] neg_hi:[0,1]
v_pk_add_f32 v[112:113], v[112:113], v[52:53]
v_pk_add_f32 v[114:115], v[114:115], v[54:55]
v_pk_add_f32 v[52:53], v[44:45], v[56:57] neg_lo:[0,1] neg_hi:[0,1]
v_pk_add_f32 v[54:55], v[46:47], v[58:59] neg_lo:[0,1] neg_hi:[0,1]
v_pk_add_f32 v[44:45], v[44:45], v[56:57]
v_pk_add_f32 v[46:47], v[46:47], v[58:59]
v_pk_add_f32 v[56:57], v[40:41], v[68:69] neg_lo:[0,1] neg_hi:[0,1]
v_pk_add_f32 v[58:59], v[42:43], v[70:71] neg_lo:[0,1] neg_hi:[0,1]
v_pk_add_f32 v[40:41], v[40:41], v[68:69]
v_pk_add_f32 v[42:43], v[42:43], v[70:71]
v_pk_add_f32 v[68:69], v[60:61], v[48:49] neg_lo:[0,1] neg_hi:[0,1]
v_pk_add_f32 v[70:71], v[62:63], v[50:51] neg_lo:[0,1] neg_hi:[0,1]
v_pk_add_f32 v[60:61], v[60:61], v[48:49]
v_pk_add_f32 v[62:63], v[62:63], v[50:51]
v_pk_add_f32 v[48:49], v[144:145], v[84:85] neg_lo:[0,1] neg_hi:[0,1]
v_pk_add_f32 v[50:51], v[146:147], v[86:87] neg_lo:[0,1] neg_hi:[0,1]
v_pk_add_f32 v[144:145], v[144:145], v[84:85]
v_pk_add_f32 v[146:147], v[146:147], v[86:87]
v_pk_add_f32 v[84:85], v[76:77], v[88:89] neg_lo:[0,1] neg_hi:[0,1]
v_pk_add_f32 v[86:87], v[78:79], v[90:91] neg_lo:[0,1] neg_hi:[0,1]
v_pk_add_f32 v[76:77], v[76:77], v[88:89]
v_pk_add_f32 v[78:79], v[78:79], v[90:91]
v_pk_add_f32 v[88:89], v[72:73], v[100:101] neg_lo:[0,1] neg_hi:[0,1]
v_pk_add_f32 v[90:91], v[74:75], v[102:103] neg_lo:[0,1] neg_hi:[0,1]
v_pk_add_f32 v[72:73], v[72:73], v[100:101]
v_pk_add_f32 v[74:75], v[74:75], v[102:103]
v_pk_add_f32 v[100:101], v[92:93], v[96:97] neg_lo:[0,1] neg_hi:[0,1]
v_pk_add_f32 v[102:103], v[94:95], v[98:99] neg_lo:[0,1] neg_hi:[0,1]
v_pk_add_f32 v[92:93], v[92:93], v[96:97]
v_pk_add_f32 v[94:95], v[94:95], v[98:99]
v_pk_add_f32 v[96:97], v[64:65], v[116:117] neg_lo:[0,1] neg_hi:[0,1]
v_pk_add_f32 v[98:99], v[66:67], v[118:119] neg_lo:[0,1] neg_hi:[0,1]
v_pk_add_f32 v[64:65], v[64:65], v[116:117]
v_pk_add_f32 v[66:67], v[66:67], v[118:119]
v_pk_add_f32 v[116:117], v[108:109], v[120:121] neg_lo:[0,1] neg_hi:[0,1]
v_pk_add_f32 v[118:119], v[110:111], v[122:123] neg_lo:[0,1] neg_hi:[0,1]
v_pk_add_f32 v[108:109], v[108:109], v[120:121]
v_pk_add_f32 v[110:111], v[110:111], v[122:123]
v_pk_add_f32 v[120:121], v[104:105], v[132:133] neg_lo:[0,1] neg_hi:[0,1]
v_pk_add_f32 v[122:123], v[106:107], v[134:135] neg_lo:[0,1] neg_hi:[0,1]
v_pk_add_f32 v[104:105], v[104:105], v[132:133]
v_pk_add_f32 v[106:107], v[106:107], v[134:135]
v_pk_add_f32 v[132:133], v[124:125], v[80:81] neg_lo:[0,1] neg_hi:[0,1]
v_pk_add_f32 v[134:135], v[126:127], v[82:83] neg_lo:[0,1] neg_hi:[0,1]
v_pk_add_f32 v[124:125], v[124:125], v[80:81]
v_pk_add_f32 v[126:127], v[126:127], v[82:83]
ds_write_b64 v4, v[16:17]
ds_write_b64 v4, v[18:19] offset:8
ds_write_b64 v4, v[144:145] offset:512
ds_write_b64 v4, v[146:147] offset:520
ds_write_b64 v4, v[112:113] offset:1024
ds_write_b64 v4, v[114:115] offset:1032
ds_write_b64 v4, v[64:65] offset:1536
ds_write_b64 v4, v[66:67] offset:1544
ds_write_b64 v4, v[128:129] offset:2048
ds_write_b64 v4, v[130:131] offset:2056
ds_write_b64 v4, v[72:73] offset:2560
ds_write_b64 v4, v[74:75] offset:2568
ds_write_b64 v4, v[40:41] offset:3072
ds_write_b64 v4, v[42:43] offset:3080
ds_write_b64 v4, v[104:105] offset:3584
ds_write_b64 v4, v[106:107] offset:3592
ds_write_b64 v4, v[136:137] offset:4096
ds_write_b64 v4, v[138:139] offset:4104
ds_write_b64 v4, v[76:77] offset:4608
ds_write_b64 v4, v[78:79] offset:4616
ds_write_b64 v4, v[44:45] offset:5120
ds_write_b64 v4, v[46:47] offset:5128
ds_write_b64 v4, v[108:109] offset:5632
ds_write_b64 v4, v[110:111] offset:5640
ds_write_b64 v4, v[28:29] offset:6144
ds_write_b64 v4, v[30:31] offset:6152
ds_write_b64 v4, v[92:93] offset:6656
ds_write_b64 v4, v[94:95] offset:6664
ds_write_b64 v4, v[60:61] offset:7168
ds_write_b64 v4, v[62:63] offset:7176
ds_write_b64 v4, v[124:125] offset:7680
ds_write_b64 v4, v[126:127] offset:7688
ds_write_b64 v4, v[140:141] offset:8192
ds_write_b64 v4, v[142:143] offset:8200
ds_write_b64 v4, v[48:49] offset:8704
ds_write_b64 v4, v[50:51] offset:8712
ds_write_b64 v4, v[32:33] offset:9216
ds_write_b64 v4, v[34:35] offset:9224
ds_write_b64 v4, v[96:97] offset:9728
ds_write_b64 v4, v[98:99] offset:9736
ds_write_b64 v4, v[24:25] offset:10240
ds_write_b64 v4, v[26:27] offset:10248
ds_write_b64 v4, v[88:89] offset:10752
ds_write_b64 v4, v[90:91] offset:10760
ds_write_b64 v4, v[56:57] offset:11264
ds_write_b64 v4, v[58:59] offset:11272
ds_write_b64 v4, v[120:121] offset:11776
ds_write_b64 v4, v[122:123] offset:11784
ds_write_b64 v4, v[20:21] offset:12288
ds_write_b64 v4, v[22:23] offset:12296
ds_write_b64 v4, v[84:85] offset:12800
ds_write_b64 v4, v[86:87] offset:12808
ds_write_b64 v4, v[52:53] offset:13312
ds_write_b64 v4, v[54:55] offset:13320
ds_write_b64 v4, v[116:117] offset:13824
ds_write_b64 v4, v[118:119] offset:13832
ds_write_b64 v4, v[36:37] offset:14336
ds_write_b64 v4, v[38:39] offset:14344
ds_write_b64 v4, v[100:101] offset:14848
ds_write_b64 v4, v[102:103] offset:14856
ds_write_b64 v4, v[68:69] offset:15360
ds_write_b64 v4, v[70:71] offset:15368
ds_write_b64 v4, v[132:133] offset:15872
ds_write_b64 v4, v[134:135] offset:15880
s_waitcnt lgkmcnt(0)
s_barrier
v_and_b32 v5, 7, v0
v_lshrrev_b32 v1, 3, v0
v_mul_u32_u24 v6, 16896, v5
v_lshl_add_u32 v4, v1, 5, v6
v_lshlrev_b32 v5, 4, v5
v_lshl_add_u32 v5, v1, 15, v5
v_lshlrev_b32 v1, 1, v1
s_lshl_b32 s12, s92, 9
s_add_u32 s12, s12, 96468992
v_sub_u32 v7, 1024, v1
v_add_u32 v8, -1, v7
v_and_b32 v7, 1023, v7
v_lshl_add_u32 v7, v7, 4, v6
v_lshl_add_u32 v8, v8, 4, v6
ds_read_b128 v[16:19], v4
ds_read_b128 v[20:23], v4 offset:16
ds_read_b128 v[24:27], v7
ds_read_b128 v[28:31], v8
v_sub_u32 v7, 960, v1
v_add_u32 v8, -1, v7
v_and_b32 v7, 1023, v7
v_lshl_add_u32 v7, v7, 4, v6
v_lshl_add_u32 v8, v8, 4, v6
ds_read_b128 v[32:35], v4 offset:1024
ds_read_b128 v[36:39], v4 offset:1040
ds_read_b128 v[40:43], v7
ds_read_b128 v[44:47], v8
s_waitcnt lgkmcnt(4)
v_add_f32 v48, v16, v24
v_sub_f32 v50, v18, v26
v_add_f32 v52, v18, v26
v_sub_f32 v54, v24, v16
v_add_f32 v49, v20, v28
v_sub_f32 v51, v22, v30
v_add_f32 v53, v22, v30
v_sub_f32 v55, v28, v20
v_add_f32 v56, v17, v25
v_sub_f32 v58, v19, v27
v_add_f32 v60, v19, v27
v_sub_f32 v62, v25, v17
v_add_f32 v57, v21, v29
v_sub_f32 v59, v23, v31
v_add_f32 v61, v23, v31
v_sub_f32 v63, v29, v21
s_add_u32 s13, s12, 0
buffer_store_dwordx4 v[48:51], v5, s[84:87], s13 offen sc1
buffer_store_dwordx4 v[52:55], v5, s[84:87], s13 offen offset:128 sc1
buffer_store_dwordx4 v[56:59], v5, s[84:87], s13 offen offset:256 sc1
buffer_store_dwordx4 v[60:63], v5, s[84:87], s13 offen offset:384 sc1
v_sub_u32 v7, 896, v1
v_add_u32 v8, -1, v7
v_and_b32 v7, 1023, v7
v_lshl_add_u32 v7, v7, 4, v6
v_lshl_add_u32 v8, v8, 4, v6
ds_read_b128 v[16:19], v4 offset:2048
ds_read_b128 v[20:23], v4 offset:2064
ds_read_b128 v[24:27], v7
ds_read_b128 v[28:31], v8
s_waitcnt lgkmcnt(4)
v_add_f32 v64, v32, v40
v_sub_f32 v66, v34, v42
v_add_f32 v68, v34, v42
v_sub_f32 v70, v40, v32
v_add_f32 v65, v36, v44
v_sub_f32 v67, v38, v46
v_add_f32 v69, v38, v46
v_sub_f32 v71, v44, v36
v_add_f32 v72, v33, v41
v_sub_f32 v74, v35, v43
v_add_f32 v76, v35, v43
v_sub_f32 v78, v41, v33
v_add_f32 v73, v37, v45
v_sub_f32 v75, v39, v47
v_add_f32 v77, v39, v47
v_sub_f32 v79, v45, v37
s_add_u32 s13, s12, 1048576
buffer_store_dwordx4 v[64:67], v5, s[84:87], s13 offen sc1
buffer_store_dwordx4 v[68:71], v5, s[84:87], s13 offen offset:128 sc1
buffer_store_dwordx4 v[72:75], v5, s[84:87], s13 offen offset:256 sc1
buffer_store_dwordx4 v[76:79], v5, s[84:87], s13 offen offset:384 sc1
v_sub_u32 v7, 832, v1
v_add_u32 v8, -1, v7
v_and_b32 v7, 1023, v7
v_lshl_add_u32 v7, v7, 4, v6
v_lshl_add_u32 v8, v8, 4, v6
ds_read_b128 v[32:35], v4 offset:3072
ds_read_b128 v[36:39], v4 offset:3088
ds_read_b128 v[40:43], v7
ds_read_b128 v[44:47], v8
s_waitcnt lgkmcnt(4)
v_add_f32 v48, v16, v24
v_sub_f32 v50, v18, v26
v_add_f32 v52, v18, v26
v_sub_f32 v54, v24, v16
v_add_f32 v49, v20, v28
v_sub_f32 v51, v22, v30
v_add_f32 v53, v22, v30
v_sub_f32 v55, v28, v20
v_add_f32 v56, v17, v25
v_sub_f32 v58, v19, v27
v_add_f32 v60, v19, v27
v_sub_f32 v62, v25, v17
v_add_f32 v57, v21, v29
v_sub_f32 v59, v23, v31
v_add_f32 v61, v23, v31
v_sub_f32 v63, v29, v21
s_add_u32 s13, s12, 2097152
buffer_store_dwordx4 v[48:51], v5, s[84:87], s13 offen sc1
buffer_store_dwordx4 v[52:55], v5, s[84:87], s13 offen offset:128 sc1
buffer_store_dwordx4 v[56:59], v5, s[84:87], s13 offen offset:256 sc1
buffer_store_dwordx4 v[60:63], v5, s[84:87], s13 offen offset:384 sc1
v_sub_u32 v7, 768, v1
v_add_u32 v8, -1, v7
v_and_b32 v7, 1023, v7
v_lshl_add_u32 v7, v7, 4, v6
v_lshl_add_u32 v8, v8, 4, v6
ds_read_b128 v[16:19], v4 offset:4096
ds_read_b128 v[20:23], v4 offset:4112
ds_read_b128 v[24:27], v7
ds_read_b128 v[28:31], v8
s_waitcnt lgkmcnt(4)
v_add_f32 v64, v32, v40
v_sub_f32 v66, v34, v42
v_add_f32 v68, v34, v42
v_sub_f32 v70, v40, v32
v_add_f32 v65, v36, v44
v_sub_f32 v67, v38, v46
v_add_f32 v69, v38, v46
v_sub_f32 v71, v44, v36
v_add_f32 v72, v33, v41
v_sub_f32 v74, v35, v43
v_add_f32 v76, v35, v43
v_sub_f32 v78, v41, v33
v_add_f32 v73, v37, v45
v_sub_f32 v75, v39, v47
v_add_f32 v77, v39, v47
v_sub_f32 v79, v45, v37
s_add_u32 s13, s12, 3145728
buffer_store_dwordx4 v[64:67], v5, s[84:87], s13 offen sc1
buffer_store_dwordx4 v[68:71], v5, s[84:87], s13 offen offset:128 sc1
buffer_store_dwordx4 v[72:75], v5, s[84:87], s13 offen offset:256 sc1
buffer_store_dwordx4 v[76:79], v5, s[84:87], s13 offen offset:384 sc1
v_sub_u32 v7, 704, v1
v_add_u32 v8, -1, v7
v_and_b32 v7, 1023, v7
v_lshl_add_u32 v7, v7, 4, v6
v_lshl_add_u32 v8, v8, 4, v6
ds_read_b128 v[32:35], v4 offset:5120
ds_read_b128 v[36:39], v4 offset:5136
ds_read_b128 v[40:43], v7
ds_read_b128 v[44:47], v8
s_waitcnt lgkmcnt(4)
v_add_f32 v48, v16, v24
v_sub_f32 v50, v18, v26
v_add_f32 v52, v18, v26
v_sub_f32 v54, v24, v16
v_add_f32 v49, v20, v28
v_sub_f32 v51, v22, v30
v_add_f32 v53, v22, v30
v_sub_f32 v55, v28, v20
v_add_f32 v56, v17, v25
v_sub_f32 v58, v19, v27
v_add_f32 v60, v19, v27
v_sub_f32 v62, v25, v17
v_add_f32 v57, v21, v29
v_sub_f32 v59, v23, v31
v_add_f32 v61, v23, v31
v_sub_f32 v63, v29, v21
s_add_u32 s13, s12, 4194304
buffer_store_dwordx4 v[48:51], v5, s[84:87], s13 offen sc1
buffer_store_dwordx4 v[52:55], v5, s[84:87], s13 offen offset:128 sc1
buffer_store_dwordx4 v[56:59], v5, s[84:87], s13 offen offset:256 sc1
buffer_store_dwordx4 v[60:63], v5, s[84:87], s13 offen offset:384 sc1
v_sub_u32 v7, 640, v1
v_add_u32 v8, -1, v7
v_and_b32 v7, 1023, v7
v_lshl_add_u32 v7, v7, 4, v6
v_lshl_add_u32 v8, v8, 4, v6
ds_read_b128 v[16:19], v4 offset:6144
ds_read_b128 v[20:23], v4 offset:6160
ds_read_b128 v[24:27], v7
ds_read_b128 v[28:31], v8
s_waitcnt lgkmcnt(4)
v_add_f32 v64, v32, v40
v_sub_f32 v66, v34, v42
v_add_f32 v68, v34, v42
v_sub_f32 v70, v40, v32
v_add_f32 v65, v36, v44
v_sub_f32 v67, v38, v46
v_add_f32 v69, v38, v46
v_sub_f32 v71, v44, v36
v_add_f32 v72, v33, v41
v_sub_f32 v74, v35, v43
v_add_f32 v76, v35, v43
v_sub_f32 v78, v41, v33
v_add_f32 v73, v37, v45
v_sub_f32 v75, v39, v47
v_add_f32 v77, v39, v47
v_sub_f32 v79, v45, v37
s_add_u32 s13, s12, 5242880
buffer_store_dwordx4 v[64:67], v5, s[84:87], s13 offen sc1
buffer_store_dwordx4 v[68:71], v5, s[84:87], s13 offen offset:128 sc1
buffer_store_dwordx4 v[72:75], v5, s[84:87], s13 offen offset:256 sc1
buffer_store_dwordx4 v[76:79], v5, s[84:87], s13 offen offset:384 sc1
v_sub_u32 v7, 576, v1
v_add_u32 v8, -1, v7
v_and_b32 v7, 1023, v7
v_lshl_add_u32 v7, v7, 4, v6
v_lshl_add_u32 v8, v8, 4, v6
ds_read_b128 v[32:35], v4 offset:7168
ds_read_b128 v[36:39], v4 offset:7184
ds_read_b128 v[40:43], v7
ds_read_b128 v[44:47], v8
s_waitcnt lgkmcnt(4)
v_add_f32 v48, v16, v24
v_sub_f32 v50, v18, v26
v_add_f32 v52, v18, v26
v_sub_f32 v54, v24, v16
v_add_f32 v49, v20, v28
v_sub_f32 v51, v22, v30
v_add_f32 v53, v22, v30
v_sub_f32 v55, v28, v20
v_add_f32 v56, v17, v25
v_sub_f32 v58, v19, v27
v_add_f32 v60, v19, v27
v_sub_f32 v62, v25, v17
v_add_f32 v57, v21, v29
v_sub_f32 v59, v23, v31
v_add_f32 v61, v23, v31
v_sub_f32 v63, v29, v21
s_add_u32 s13, s12, 6291456
buffer_store_dwordx4 v[48:51], v5, s[84:87], s13 offen sc1
buffer_store_dwordx4 v[52:55], v5, s[84:87], s13 offen offset:128 sc1
buffer_store_dwordx4 v[56:59], v5, s[84:87], s13 offen offset:256 sc1
buffer_store_dwordx4 v[60:63], v5, s[84:87], s13 offen offset:384 sc1
v_sub_u32 v7, 512, v1
v_add_u32 v8, -1, v7
v_and_b32 v7, 1023, v7
v_lshl_add_u32 v7, v7, 4, v6
v_lshl_add_u32 v8, v8, 4, v6
ds_read_b128 v[16:19], v4 offset:8192
ds_read_b128 v[20:23], v4 offset:8208
ds_read_b128 v[24:27], v7
ds_read_b128 v[28:31], v8
s_waitcnt lgkmcnt(4)
v_add_f32 v64, v32, v40
v_sub_f32 v66, v34, v42
v_add_f32 v68, v34, v42
v_sub_f32 v70, v40, v32
v_add_f32 v65, v36, v44
v_sub_f32 v67, v38, v46
v_add_f32 v69, v38, v46
v_sub_f32 v71, v44, v36
v_add_f32 v72, v33, v41
v_sub_f32 v74, v35, v43
v_add_f32 v76, v35, v43
v_sub_f32 v78, v41, v33
v_add_f32 v73, v37, v45
v_sub_f32 v75, v39, v47
v_add_f32 v77, v39, v47
v_sub_f32 v79, v45, v37
s_add_u32 s13, s12, 7340032
buffer_store_dwordx4 v[64:67], v5, s[84:87], s13 offen sc1
buffer_store_dwordx4 v[68:71], v5, s[84:87], s13 offen offset:128 sc1
buffer_store_dwordx4 v[72:75], v5, s[84:87], s13 offen offset:256 sc1
buffer_store_dwordx4 v[76:79], v5, s[84:87], s13 offen offset:384 sc1
s_waitcnt lgkmcnt(0)
v_add_f32 v48, v16, v24
v_sub_f32 v50, v18, v26
v_add_f32 v52, v18, v26
v_sub_f32 v54, v24, v16
v_add_f32 v49, v20, v28
v_sub_f32 v51, v22, v30
v_add_f32 v53, v22, v30
v_sub_f32 v55, v28, v20
v_add_f32 v56, v17, v25
v_sub_f32 v58, v19, v27
v_add_f32 v60, v19, v27
v_sub_f32 v62, v25, v17
v_add_f32 v57, v21, v29
v_sub_f32 v59, v23, v31
v_add_f32 v61, v23, v31
v_sub_f32 v63, v29, v21
s_add_u32 s13, s12, 8388608
v_cmp_eq_u32 vcc, 0, v1
s_and_saveexec_b64 s[14:15], vcc
s_cbranch_execz L_f1r_e
buffer_store_dwordx4 v[48:51], v5, s[84:87], s13 offen sc1
buffer_store_dwordx4 v[52:55], v5, s[84:87], s13 offen offset:128 sc1
buffer_store_dwordx4 v[56:59], v5, s[84:87], s13 offen offset:256 sc1
buffer_store_dwordx4 v[60:63], v5, s[84:87], s13 offen offset:384 sc1
L_f1r_e:
s_mov_b64 exec, -1
s_waitcnt vmcnt(0)
s_barrier
s_cmp_lg_u32 s98, 0
s_cbranch_scc1 L_sg_7
v_mov_b32 v2, 1
s_mov_b32 s81, 71360512
s_mov_b64 exec, 1
buffer_atomic_add v2, off, s[84:87], s81 sc1
s_mov_b64 exec, -1
L_sg_7:
s_cmp_lg_u32 s98, 0
s_cbranch_scc1 L_wf1d
s_mov_b32 s81, 71360512
L_wf1:
buffer_load_dword v120, off, s[84:87], s81 sc1
s_waitcnt vmcnt(0)
v_cmp_ne_u32 vcc, 64, v120
s_cbranch_vccz L_wf1d
s_sleep 6
s_branch L_wf1
L_wf1d:
L_f2go:
s_barrier
s_mov_b32 s30, 0x3f7b14be
s_mov_b32 s31, 0x3f6c835e
s_mov_b32 s32, 0x3f54db31
s_mov_b32 s33, 0x3f3504f3
s_mov_b32 s34, 0x3f0e39da
s_mov_b32 s35, 0x3ec3ef15
s_mov_b32 s36, 0x3e47c5c2
v_lshrrev_b32 v5, 6, v0
v_and_b32 v1, 63, v0
v_readfirstlane_b32 s12, v5
s_lshl_b32 s13, s99, 2
s_add_u32 s13, s13, s12
s_cmp_ge_u32 s13, 257
s_cbranch_scc1 L_f2_end
v_cvt_f32_u32 v2, v1
s_lshl_b32 s15, s13, 15
s_add_u32 s15, s15, 96468992
v_lshlrev_b32 v10, 4, v1
s_add_u32 s16, s15, 0
buffer_load_dwordx4 v[16:19], v10, s[84:87], s16 offen
buffer_load_dwordx4 v[20:23], v10, s[84:87], s16 offen offset:1024
buffer_load_dwordx4 v[24:27], v10, s[84:87], s16 offen offset:2048
buffer_load_dwordx4 v[28:31], v10, s[84:87], s16 offen offset:3072
s_add_u32 s16, s15, 4096
buffer_load_dwordx4 v[32:35], v10, s[84:87], s16 offen
buffer_load_dwordx4 v[36:39], v10, s[84:87], s16 offen offset:1024
buffer_load_dwordx4 v[40:43], v10, s[84:87], s16 offen offset:2048
buffer_load_dwordx4 v[44:47], v10, s[84:87], s16 offen offset:3072
s_add_u32 s16, s15, 8192
buffer_load_dwordx4 v[48:51], v10, s[84:87], s16 offen
buffer_load_dwordx4 v[52:55], v10, s[84:87], s16 offen offset:1024
buffer_load_dwordx4 v[56:59], v10, s[84:87], s16 offen offset:2048
buffer_load_dwordx4 v[60:63], v10, s[84:87], s16 offen offset:3072
s_add_u32 s16, s15, 12288
buffer_load_dwordx4 v[64:67], v10, s[84:87], s16 offen
buffer_load_dwordx4 v[68:71], v10, s[84:87], s16 offen offset:1024
buffer_load_dwordx4 v[72:75], v10, s[84:87], s16 offen offset:2048
buffer_load_dwordx4 v[76:79], v10, s[84:87], s16 offen offset:3072
s_add_u32 s16, s15, 16384
buffer_load_dwordx4 v[80:83], v10, s[84:87], s16 offen
buffer_load_dwordx4 v[84:87], v10, s[84:87], s16 offen offset:1024
buffer_load_dwordx4 v[88:91], v10, s[84:87], s16 offen offset:2048
buffer_load_dwordx4 v[92:95], v10, s[84:87], s16 offen offset:3072
s_add_u32 s16, s15, 20480
buffer_load_dwordx4 v[96:99], v10, s[84:87], s16 offen
buffer_load_dwordx4 v[100:103], v10, s[84:87], s16 offen offset:1024
buffer_load_dwordx4 v[104:107], v10, s[84:87], s16 offen offset:2048
buffer_load_dwordx4 v[108:111], v10, s[84:87], s16 offen offset:3072
s_add_u32 s16, s15, 24576
buffer_load_dwordx4 v[112:115], v10, s[84:87], s16 offen
buffer_load_dwordx4 v[116:119], v10, s[84:87], s16 offen offset:1024
buffer_load_dwordx4 v[120:123], v10, s[84:87], s16 offen offset:2048
buffer_load_dwordx4 v[124:127], v10, s[84:87], s16 offen offset:3072
s_add_u32 s16, s15, 28672
buffer_load_dwordx4 v[128:131], v10, s[84:87], s16 offen
buffer_load_dwordx4 v[132:135], v10, s[84:87], s16 offen offset:1024
buffer_load_dwordx4 v[136:139], v10, s[84:87], s16 offen offset:2048
buffer_load_dwordx4 v[140:143], v10, s[84:87], s16 offen offset:3072
s_mul_i32 s17, s12, 33792
v_add_u32 v3, s17, v10
v_and_b32 v7, 1, v1
v_lshrrev_b32 v6, 1, v1
v_cvt_f32_u32 v8, v6
v_cvt_f32_u32 v9, v7
v_mul_u32_u24 v4, 1056, v6
v_lshl_add_u32 v4, v7, 4, v4
v_add_u32 v4, s17, v4
v_mov_b32 v14, 1.0
v_fma_f32 v14, v9, -2.0, v14
s_waitcnt vmcnt(0)
v_pk_add_f32 v[144:145], v[16:17], v[80:81] neg_lo:[0,1] neg_hi:[0,1]
v_pk_add_f32 v[146:147], v[18:19], v[82:83] neg_lo:[0,1] neg_hi:[0,1]
v_pk_add_f32 v[16:17], v[16:17], v[80:81]
v_pk_add_f32 v[18:19], v[18:19], v[82:83]
v_pk_add_f32 v[80:81], v[20:21], v[84:85] neg_lo:[0,1] neg_hi:[0,1]
v_pk_add_f32 v[82:83], v[22:23], v[86:87] neg_lo:[0,1] neg_hi:[0,1]
v_pk_add_f32 v[20:21], v[20:21], v[84:85]
v_pk_add_f32 v[22:23], v[22:23], v[86:87]
v_pk_mul_f32 v[84:85], v[80:81], s[30:31] op_sel_hi:[1,0]
v_pk_mul_f32 v[86:87], v[80:81], s[36:37] op_sel_hi:[1,0] neg_lo:[0,1] neg_hi:[0,1]
v_pk_fma_f32 v[84:85], v[82:83], s[36:37], v[84:85] op_sel_hi:[1,0,1]
v_pk_fma_f32 v[86:87], v[82:83], s[30:31], v[86:87] op_sel_hi:[1,0,1]
v_pk_add_f32 v[80:81], v[24:25], v[88:89] neg_lo:[0,1] neg_hi:[0,1]
v_pk_add_f32 v[82:83], v[26:27], v[90:91] neg_lo:[0,1] neg_hi:[0,1]
v_pk_add_f32 v[24:25], v[24:25], v[88:89]
v_pk_add_f32 v[26:27], v[26:27], v[90:91]
v_pk_mul_f32 v[88:89], v[80:81], s[30:31] op_sel:[0,1]
v_pk_mul_f32 v[90:91], v[80:81], s[34:35] op_sel:[0,1] neg_lo:[0,1] neg_hi:[0,1]
v_pk_fma_f32 v[88:89], v[82:83], s[34:35], v[88:89] op_sel:[0,1,0]
v_pk_fma_f32 v[90:91], v[82:83], s[30:31], v[90:91] op_sel:[0,1,0]
v_pk_add_f32 v[80:81], v[28:29], v[92:93] neg_lo:[0,1] neg_hi:[0,1]
v_pk_add_f32 v[82:83], v[30:31], v[94:95] neg_lo:[0,1] neg_hi:[0,1]
v_pk_add_f32 v[28:29], v[28:29], v[92:93]
v_pk_add_f32 v[30:31], v[30:31], v[94:95]
v_pk_mul_f32 v[92:93], v[80:81], s[32:33] op_sel_hi:[1,0]
v_pk_mul_f32 v[94:95], v[80:81], s[34:35] op_sel_hi:[1,0] neg_lo:[0,1] neg_hi:[0,1]
v_pk_fma_f32 v[92:93], v[82:83], s[34:35], v[92:93] op_sel_hi:[1,0,1]
v_pk_fma_f32 v[94:95], v[82:83], s[32:33], v[94:95] op_sel_hi:[1,0,1]
v_pk_add_f32 v[80:81], v[32:33], v[96:97] neg_lo:[0,1] neg_hi:[0,1]
v_pk_add_f32 v[82:83], v[34:35], v[98:99] neg_lo:[0,1] neg_hi:[0,1]
v_pk_add_f32 v[32:33], v[32:33], v[96:97]
v_pk_add_f32 v[34:35], v[34:35], v[98:99]
v_pk_mul_f32 v[96:97], v[80:81], s[32:33] op_sel:[0,1]
v_pk_mul_f32 v[98:99], v[80:81], s[32:33] op_sel:[0,1] neg_lo:[0,1] neg_hi:[0,1]
v_pk_fma_f32 v[96:97], v[82:83], s[32:33], v[96:97] op_sel:[0,1,0]
v_pk_fma_f32 v[98:99], v[82:83], s[32:33], v[98:99] op_sel:[0,1,0]
v_pk_add_f32 v[80:81], v[36:37], v[100:101] neg_lo:[0,1] neg_hi:[0,1]
v_pk_add_f32 v[82:83], v[38:39], v[102:103] neg_lo:[0,1] neg_hi:[0,1]
v_pk_add_f32 v[36:37], v[36:37], v[100:101]
v_pk_add_f32 v[38:39], v[38:39], v[102:103]
v_pk_mul_f32 v[100:101], v[80:81], s[34:35] op_sel_hi:[1,0]
v_pk_mul_f32 v[102:103], v[80:81], s[32:33] op_sel_hi:[1,0] neg_lo:[0,1] neg_hi:[0,1]
v_pk_fma_f32 v[100:101], v[82:83], s[32:33], v[100:101] op_sel_hi:[1,0,1]
v_pk_fma_f32 v[102:103], v[82:83], s[34:35], v[102:103] op_sel_hi:[1,0,1]
v_pk_add_f32 v[80:81], v[40:41], v[104:105] neg_lo:[0,1] neg_hi:[0,1]
v_pk_add_f32 v[82:83], v[42:43], v[106:107] neg_lo:[0,1] neg_hi:[0,1]
v_pk_add_f32 v[40:41], v[40:41], v[104:105]
v_pk_add_f32 v[42:43], v[42:43], v[106:107]
v_pk_mul_f32 v[104:105], v[80:81], s[34:35] op_sel:[0,1]
v_pk_mul_f32 v[106:107], v[80:81], s[30:31] op_sel:[0,1] neg_lo:[0,1] neg_hi:[0,1]
v_pk_fma_f32 v[104:105], v[82:83], s[30:31], v[104:105] op_sel:[0,1,0]
v_pk_fma_f32 v[106:107], v[82:83], s[34:35], v[106:107] op_sel:[0,1,0]
v_pk_add_f32 v[80:81], v[44:45], v[108:109] neg_lo:[0,1] neg_hi:[0,1]
v_pk_add_f32 v[82:83], v[46:47], v[110:111] neg_lo:[0,1] neg_hi:[0,1]
v_pk_add_f32 v[44:45], v[44:45], v[108:109]
v_pk_add_f32 v[46:47], v[46:47], v[110:111]
v_pk_mul_f32 v[108:109], v[80:81], s[36:37] op_sel_hi:[1,0]
v_pk_mul_f32 v[110:111], v[80:81], s[30:31] op_sel_hi:[1,0] neg_lo:[0,1] neg_hi:[0,1]
v_pk_fma_f32 v[108:109], v[82:83], s[30:31], v[108:109] op_sel_hi:[1,0,1]
v_pk_fma_f32 v[110:111], v[82:83], s[36:37], v[110:111] op_sel_hi:[1,0,1]
v_pk_add_f32 v[80:81], v[50:51], v[114:115] neg_lo:[0,1] neg_hi:[0,1]
v_pk_add_f32 v[82:83], v[112:113], v[48:49] neg_lo:[0,1] neg_hi:[0,1]
v_pk_add_f32 v[48:49], v[48:49], v[112:113]
v_pk_add_f32 v[50:51], v[50:51], v[114:115]
v_pk_add_f32 v[112:113], v[52:53], v[116:117] neg_lo:[0,1] neg_hi:[0,1]
v_pk_add_f32 v[114:115], v[54:55], v[118:119] neg_lo:[0,1] neg_hi:[0,1]
v_pk_add_f32 v[52:53], v[52:53], v[116:117]
v_pk_add_f32 v[54:55], v[54:55], v[118:119]
v_pk_mul_f32 v[116:117], v[112:113], s[36:37] op_sel_hi:[1,0] neg_lo:[0,1] neg_hi:[0,1]
v_pk_mul_f32 v[118:119], v[112:113], s[30:31] op_sel_hi:[1,0] neg_lo:[0,1] neg_hi:[0,1]
v_pk_fma_f32 v[116:117], v[114:115], s[30:31], v[116:117] op_sel_hi:[1,0,1]
v_pk_fma_f32 v[118:119], v[114:115], s[36:37], v[118:119] op_sel_hi:[1,0,1] neg_lo:[0,1,0] neg_hi:[0,1,0]
v_pk_add_f32 v[112:113], v[56:57], v[120:121] neg_lo:[0,1] neg_hi:[0,1]
v_pk_add_f32 v[114:115], v[58:59], v[122:123] neg_lo:[0,1] neg_hi:[0,1]
v_pk_add_f32 v[56:57], v[56:57], v[120:121]
v_pk_add_f32 v[58:59], v[58:59], v[122:123]
v_pk_mul_f32 v[120:121], v[112:113], s[34:35] op_sel:[0,1] neg_lo:[0,1] neg_hi:[0,1]
v_pk_mul_f32 v[122:123], v[112:113], s[30:31] op_sel:[0,1] neg_lo:[0,1] neg_hi:[0,1]
v_pk_fma_f32 v[120:121], v[114:115], s[30:31], v[120:121] op_sel:[0,1,0]
v_pk_fma_f32 v[122:123], v[114:115], s[34:35], v[122:123] op_sel:[0,1,0] neg_lo:[0,1,0] neg_hi:[0,1,0]
v_pk_add_f32 v[112:113], v[60:61], v[124:125] neg_lo:[0,1] neg_hi:[0,1]
v_pk_add_f32 v[114:115], v[62:63], v[126:127] neg_lo:[0,1] neg_hi:[0,1]
v_pk_add_f32 v[60:61], v[60:61], v[124:125]
v_pk_add_f32 v[62:63], v[62:63], v[126:127]
v_pk_mul_f32 v[124:125], v[112:113], s[34:35] op_sel_hi:[1,0] neg_lo:[0,1] neg_hi:[0,1]
v_pk_mul_f32 v[126:127], v[112:113], s[32:33] op_sel_hi:[1,0] neg_lo:[0,1] neg_hi:[0,1]
v_pk_fma_f32 v[124:125], v[114:115], s[32:33], v[124:125] op_sel_hi:[1,0,1]
v_pk_fma_f32 v[126:127], v[114:115], s[34:35], v[126:127] op_sel_hi:[1,0,1] neg_lo:[0,1,0] neg_hi:[0,1,0]
v_pk_add_f32 v[112:113], v[64:65], v[128:129] neg_lo:[0,1] neg_hi:[0,1]
v_pk_add_f32 v[114:115], v[66:67], v[130:131] neg_lo:[0,1] neg_hi:[0,1]
v_pk_add_f32 v[64:65], v[64:65], v[128:129]
v_pk_add_f32 v[66:67], v[66:67], v[130:131]
v_pk_mul_f32 v[128:129], v[112:113], s[32:33] op_sel:[0,1] neg_lo:[0,1] neg_hi:[0,1]
v_pk_mul_f32 v[130:131], v[112:113], s[32:33] op_sel:[0,1] neg_lo:[0,1] neg_hi:[0,1]
v_pk_fma_f32 v[128:129], v[114:115], s[32:33], v[128:129] op_sel:[0,1,0]
v_pk_fma_f32 v[130:131], v[114:115], s[32:33], v[130:131] op_sel:[0,1,0] neg_lo:[0,1,0] neg_hi:[0,1,0]
v_pk_add_f32 v[112:113], v[68:69], v[132:133] neg_lo:[0,1] neg_hi:[0,1]
v_pk_add_f32 v[114:115], v[70:71], v[134:135] neg_lo:[0,1] neg_hi:[0,1]
v_pk_add_f32 v[68:69], v[68:69], v[132:133]
v_pk_add_f32 v[70:71], v[70:71], v[134:135]
v_pk_mul_f32 v[132:133], v[112:113], s[32:33] op_sel_hi:[1,0] neg_lo:[0,1] neg_hi:[0,1]
v_pk_mul_f32 v[134:135], v[112:113], s[34:35] op_sel_hi:[1,0] neg_lo:[0,1] neg_hi:[0,1]
v_pk_fma_f32 v[132:133], v[114:115], s[34:35], v[132:133] op_sel_hi:[1,0,1]
v_pk_fma_f32 v[134:135], v[114:115], s[32:33], v[134:135] op_sel_hi:[1,0,1] neg_lo:[0,1,0] neg_hi:[0,1,0]
v_pk_add_f32 v[112:113], v[72:73], v[136:137] neg_lo:[0,1] neg_hi:[0,1]
v_pk_add_f32 v[114:115], v[74:75], v[138:139] neg_lo:[0,1] neg_hi:[0,1]
v_pk_add_f32 v[72:73], v[72:73], v[136:137]
v_pk_add_f32 v[74:75], v[74:75], v[138:139]
v_pk_mul_f32 v[136:137], v[112:113], s[30:31] op_sel:[0,1] neg_lo:[0,1] neg_hi:[0,1]
v_pk_mul_f32 v[138:139], v[112:113], s[34:35] op_sel:[0,1] neg_lo:[0,1] neg_hi:[0,1]
v_pk_fma_f32 v[136:137], v[114:115], s[34:35], v[136:137] op_sel:[0,1,0]
v_pk_fma_f32 v[138:139], v[114:115], s[30:31], v[138:139] op_sel:[0,1,0] neg_lo:[0,1,0] neg_hi:[0,1,0]
v_pk_add_f32 v[112:113], v[76:77], v[140:141] neg_lo:[0,1] neg_hi:[0,1]
v_pk_add_f32 v[114:115], v[78:79], v[142:143] neg_lo:[0,1] neg_hi:[0,1]
v_pk_add_f32 v[76:77], v[76:77], v[140:141]
v_pk_add_f32 v[78:79], v[78:79], v[142:143]
v_pk_mul_f32 v[140:141], v[112:113], s[30:31] op_sel_hi:[1,0] neg_lo:[0,1] neg_hi:[0,1]
v_pk_mul_f32 v[142:143], v[112:113], s[36:37] op_sel_hi:[1,0] neg_lo:[0,1] neg_hi:[0,1]
v_pk_fma_f32 v[140:141], v[114:115], s[36:37], v[140:141] op_sel_hi:[1,0,1]
v_pk_fma_f32 v[142:143], v[114:115], s[30:31], v[142:143] op_sel_hi:[1,0,1] neg_lo:[0,1,0] neg_hi:[0,1,0]
v_pk_add_f32 v[112:113], v[16:17], v[48:49] neg_lo:[0,1] neg_hi:[0,1]
v_pk_add_f32 v[114:115], v[18:19], v[50:51] neg_lo:[0,1] neg_hi:[0,1]
v_pk_add_f32 v[16:17], v[16:17], v[48:49]
v_pk_add_f32 v[18:19], v[18:19], v[50:51]
v_pk_add_f32 v[48:49], v[20:21], v[52:53] neg_lo:[0,1] neg_hi:[0,1]
v_pk_add_f32 v[50:51], v[22:23], v[54:55] neg_lo:[0,1] neg_hi:[0,1]
v_pk_add_f32 v[20:21], v[20:21], v[52:53]
v_pk_add_f32 v[22:23], v[22:23], v[54:55]
v_pk_mul_f32 v[52:53], v[48:49], s[30:31] op_sel:[0,1]
v_pk_mul_f32 v[54:55], v[48:49], s[34:35] op_sel:[0,1] neg_lo:[0,1] neg_hi:[0,1]
v_pk_fma_f32 v[52:53], v[50:51], s[34:35], v[52:53] op_sel:[0,1,0]
v_pk_fma_f32 v[54:55], v[50:51], s[30:31], v[54:55] op_sel:[0,1,0]
v_pk_add_f32 v[48:49], v[24:25], v[56:57] neg_lo:[0,1] neg_hi:[0,1]
v_pk_add_f32 v[50:51], v[26:27], v[58:59] neg_lo:[0,1] neg_hi:[0,1]
v_pk_add_f32 v[24:25], v[24:25], v[56:57]
v_pk_add_f32 v[26:27], v[26:27], v[58:59]
v_pk_mul_f32 v[56:57], v[48:49], s[32:33] op_sel:[0,1]
v_pk_mul_f32 v[58:59], v[48:49], s[32:33] op_sel:[0,1] neg_lo:[0,1] neg_hi:[0,1]
v_pk_fma_f32 v[56:57], v[50:51], s[32:33], v[56:57] op_sel:[0,1,0]
v_pk_fma_f32 v[58:59], v[50:51], s[32:33], v[58:59] op_sel:[0,1,0]
v_pk_add_f32 v[48:49], v[28:29], v[60:61] neg_lo:[0,1] neg_hi:[0,1]
v_pk_add_f32 v[50:51], v[30:31], v[62:63] neg_lo:[0,1] neg_hi:[0,1]
v_pk_add_f32 v[28:29], v[28:29], v[60:61]
v_pk_add_f32 v[30:31], v[30:31], v[62:63]
v_pk_mul_f32 v[60:61], v[48:49], s[34:35] op_sel:[0,1]
v_pk_mul_f32 v[62:63], v[48:49], s[30:31] op_sel:[0,1] neg_lo:[0,1] neg_hi:[0,1]
v_pk_fma_f32 v[60:61], v[50:51], s[30:31], v[60:61] op_sel:[0,1,0]
v_pk_fma_f32 v[62:63], v[50:51], s[34:35], v[62:63] op_sel:[0,1,0]
v_pk_add_f32 v[48:49], v[34:35], v[66:67] neg_lo:[0,1] neg_hi:[0,1]
v_pk_add_f32 v[50:51], v[64:65], v[32:33] neg_lo:[0,1] neg_hi:[0,1]
v_pk_add_f32 v[32:33], v[32:33], v[64:65]
v_pk_add_f32 v[34:35], v[34:35], v[66:67]
v_pk_add_f32 v[64:65], v[36:37], v[68:69] neg_lo:[0,1] neg_hi:[0,1]
v_pk_add_f32 v[66:67], v[38:39], v[70:71] neg_lo:[0,1] neg_hi:[0,1]
v_pk_add_f32 v[36:37], v[36:37], v[68:69]
v_pk_add_f32 v[38:39], v[38:39], v[70:71]
v_pk_mul_f32 v[68:69], v[64:65], s[34:35] op_sel:[0,1] neg_lo:[0,1] neg_hi:[0,1]
v_pk_mul_f32 v[70:71], v[64:65], s[30:31] op_sel:[0,1] neg_lo:[0,1] neg_hi:[0,1]
v_pk_fma_f32 v[68:69], v[66:67], s[30:31], v[68:69] op_sel:[0,1,0]
v_pk_fma_f32 v[70:71], v[66:67], s[34:35], v[70:71] op_sel:[0,1,0] neg_lo:[0,1,0] neg_hi:[0,1,0]
v_pk_add_f32 v[64:65], v[40:41], v[72:73] neg_lo:[0,1] neg_hi:[0,1]
v_pk_add_f32 v[66:67], v[42:43], v[74:75] neg_lo:[0,1] neg_hi:[0,1]
v_pk_add_f32 v[40:41], v[40:41], v[72:73]
v_pk_add_f32 v[42:43], v[42:43], v[74:75]
v_pk_mul_f32 v[72:73], v[64:65], s[32:33] op_sel:[0,1] neg_lo:[0,1] neg_hi:[0,1]
v_pk_mul_f32 v[74:75], v[64:65], s[32:33] op_sel:[0,1] neg_lo:[0,1] neg_hi:[0,1]
v_pk_fma_f32 v[72:73], v[66:67], s[32:33], v[72:73] op_sel:[0,1,0]
v_pk_fma_f32 v[74:75], v[66:67], s[32:33], v[74:75] op_sel:[0,1,0] neg_lo:[0,1,0] neg_hi:[0,1,0]
v_pk_add_f32 v[64:65], v[44:45], v[76:77] neg_lo:[0,1] neg_hi:[0,1]
v_pk_add_f32 v[66:67], v[46:47], v[78:79] neg_lo:[0,1] neg_hi:[0,1]
v_pk_add_f32 v[44:45], v[44:45], v[76:77]
v_pk_add_f32 v[46:47], v[46:47], v[78:79]
v_pk_mul_f32 v[76:77], v[64:65], s[30:31] op_sel:[0,1] neg_lo:[0,1] neg_hi:[0,1]
v_pk_mul_f32 v[78:79], v[64:65], s[34:35] op_sel:[0,1] neg_lo:[0,1] neg_hi:[0,1]
v_pk_fma_f32 v[76:77], v[66:67], s[34:35], v[76:77] op_sel:[0,1,0]
v_pk_fma_f32 v[78:79], v[66:67], s[30:31], v[78:79] op_sel:[0,1,0] neg_lo:[0,1,0] neg_hi:[0,1,0]
v_pk_add_f32 v[64:65], v[144:145], v[80:81] neg_lo:[0,1] neg_hi:[0,1]
v_pk_add_f32 v[66:67], v[146:147], v[82:83] neg_lo:[0,1] neg_hi:[0,1]
v_pk_add_f32 v[144:145], v[144:145], v[80:81]
v_pk_add_f32 v[146:147], v[146:147], v[82:83]
v_pk_add_f32 v[80:81], v[84:85], v[116:117] neg_lo:[0,1] neg_hi:[0,1]
v_pk_add_f32 v[82:83], v[86:87], v[118:119] neg_lo:[0,1] neg_hi:[0,1]
v_pk_add_f32 v[84:85], v[84:85], v[116:117]
v_pk_add_f32 v[86:87], v[86:87], v[118:119]
v_pk_mul_f32 v[116:117], v[80:81], s[30:31] op_sel:[0,1]
v_pk_mul_f32 v[118:119], v[80:81], s[34:35] op_sel:[0,1] neg_lo:[0,1] neg_hi:[0,1]
v_pk_fma_f32 v[116:117], v[82:83], s[34:35], v[116:117] op_sel:[0,1,0]
v_pk_fma_f32 v[118:119], v[82:83], s[30:31], v[118:119] op_sel:[0,1,0]
v_pk_add_f32 v[80:81], v[88:89], v[120:121] neg_lo:[0,1] neg_hi:[0,1]
v_pk_add_f32 v[82:83], v[90:91], v[122:123] neg_lo:[0,1] neg_hi:[0,1]
v_pk_add_f32 v[88:89], v[88:89], v[120:121]
v_pk_add_f32 v[90:91], v[90:91], v[122:123]
v_pk_mul_f32 v[120:121], v[80:81], s[32:33] op_sel:[0,1]
v_pk_mul_f32 v[122:123], v[80:81], s[32:33] op_sel:[0,1] neg_lo:[0,1] neg_hi:[0,1]
v_pk_fma_f32 v[120:121], v[82:83], s[32:33], v[120:121] op_sel:[0,1,0]
v_pk_fma_f32 v[122:123], v[82:83], s[32:33], v[122:123] op_sel:[0,1,0]
v_pk_add_f32 v[80:81], v[92:93], v[124:125] neg_lo:[0,1] neg_hi:[0,1]
v_pk_add_f32 v[82:83], v[94:95], v[126:127] neg_lo:[0,1] neg_hi:[0,1]
v_pk_add_f32 v[92:93], v[92:93], v[124:125]
v_pk_add_f32 v[94:95], v[94:95], v[126:127]
v_pk_mul_f32 v[124:125], v[80:81], s[34:35] op_sel:[0,1]
v_pk_mul_f32 v[126:127], v[80:81], s[30:31] op_sel:[0,1] neg_lo:[0,1] neg_hi:[0,1]
v_pk_fma_f32 v[124:125], v[82:83], s[30:31], v[124:125] op_sel:[0,1,0]
v_pk_fma_f32 v[126:127], v[82:83], s[34:35], v[126:127] op_sel:[0,1,0]
v_pk_add_f32 v[80:81], v[98:99], v[130:131] neg_lo:[0,1] neg_hi:[0,1]
v_pk_add_f32 v[82:83], v[128:129], v[96:97] neg_lo:[0,1] neg_hi:[0,1]
v_pk_add_f32 v[96:97], v[96:97], v[128:129]
v_pk_add_f32 v[98:99], v[98:99], v[130:131]
v_pk_add_f32 v[128:129], v[100:101], v[132:133] neg_lo:[0,1] neg_hi:[0,1]
v_pk_add_f32 v[130:131], v[102:103], v[134:135] neg_lo:[0,1] neg_hi:[0,1]
v_pk_add_f32 v[100:101], v[100:101], v[132:133]
v_pk_add_f32 v[102:103], v[102:103], v[134:135]
v_pk_mul_f32 v[132:133], v[128:129], s[34:35] op_sel:[0,1] neg_lo:[0,1] neg_hi:[0,1]
v_pk_mul_f32 v[134:135], v[128:129], s[30:31] op_sel:[0,1] neg_lo:[0,1] neg_hi:[0,1]
v_pk_fma_f32 v[132:133], v[130:131], s[30:31], v[132:133] op_sel:[0,1,0]
v_pk_fma_f32 v[134:135], v[130:131], s[34:35], v[134:135] op_sel:[0,1,0] neg_lo:[0,1,0] neg_hi:[0,1,0]
v_pk_add_f32 v[128:129], v[104:105], v[136:137] neg_lo:[0,1] neg_hi:[0,1]
v_pk_add_f32 v[130:131], v[106:107], v[138:139] neg_lo:[0,1] neg_hi:[0,1]
v_pk_add_f32 v[104:105], v[104:105], v[136:137]
v_pk_add_f32 v[106:107], v[106:107], v[138:139]
v_pk_mul_f32 v[136:137], v[128:129], s[32:33] op_sel:[0,1] neg_lo:[0,1] neg_hi:[0,1]
v_pk_mul_f32 v[138:139], v[128:129], s[32:33] op_sel:[0,1] neg_lo:[0,1] neg_hi:[0,1]
v_pk_fma_f32 v[136:137], v[130:131], s[32:33], v[136:137] op_sel:[0,1,0]
v_pk_fma_f32 v[138:139], v[130:131], s[32:33], v[138:139] op_sel:[0,1,0] neg_lo:[0,1,0] neg_hi:[0,1,0]
v_pk_add_f32 v[128:129], v[108:109], v[140:141] neg_lo:[0,1] neg_hi:[0,1]
v_pk_add_f32 v[130:131], v[110:111], v[142:143] neg_lo:[0,1] neg_hi:[0,1]
v_pk_add_f32 v[108:109], v[108:109], v[140:141]
v_pk_add_f32 v[110:111], v[110:111], v[142:143]
v_pk_mul_f32 v[140:141], v[128:129], s[30:31] op_sel:[0,1] neg_lo:[0,1] neg_hi:[0,1]
v_pk_mul_f32 v[142:143], v[128:129], s[34:35] op_sel:[0,1] neg_lo:[0,1] neg_hi:[0,1]
v_pk_fma_f32 v[140:141], v[130:131], s[34:35], v[140:141] op_sel:[0,1,0]
v_pk_fma_f32 v[142:143], v[130:131], s[30:31], v[142:143] op_sel:[0,1,0] neg_lo:[0,1,0] neg_hi:[0,1,0]
v_pk_add_f32 v[128:129], v[16:17], v[32:33] neg_lo:[0,1] neg_hi:[0,1]
v_pk_add_f32 v[130:131], v[18:19], v[34:35] neg_lo:[0,1] neg_hi:[0,1]
v_pk_add_f32 v[16:17], v[16:17], v[32:33]
v_pk_add_f32 v[18:19], v[18:19], v[34:35]
v_pk_add_f32 v[32:33], v[20:21], v[36:37] neg_lo:[0,1] neg_hi:[0,1]
v_pk_add_f32 v[34:35], v[22:23], v[38:39] neg_lo:[0,1] neg_hi:[0,1]
v_pk_add_f32 v[20:21], v[20:21], v[36:37]
v_pk_add_f32 v[22:23], v[22:23], v[38:39]
v_pk_mul_f32 v[36:37], v[32:33], s[32:33] op_sel:[0,1]
v_pk_mul_f32 v[38:39], v[32:33], s[32:33] op_sel:[0,1] neg_lo:[0,1] neg_hi:[0,1]
v_pk_fma_f32 v[36:37], v[34:35], s[32:33], v[36:37] op_sel:[0,1,0]
v_pk_fma_f32 v[38:39], v[34:35], s[32:33], v[38:39] op_sel:[0,1,0]
v_pk_add_f32 v[32:33], v[26:27], v[42:43] neg_lo:[0,1] neg_hi:[0,1]
v_pk_add_f32 v[34:35], v[40:41], v[24:25] neg_lo:[0,1] neg_hi:[0,1]
v_pk_add_f32 v[24:25], v[24:25], v[40:41]
v_pk_add_f32 v[26:27], v[26:27], v[42:43]
v_pk_add_f32 v[40:41], v[28:29], v[44:45] neg_lo:[0,1] neg_hi:[0,1]
v_pk_add_f32 v[42:43], v[30:31], v[46:47] neg_lo:[0,1] neg_hi:[0,1]
v_pk_add_f32 v[28:29], v[28:29], v[44:45]
v_pk_add_f32 v[30:31], v[30:31], v[46:47]
v_pk_mul_f32 v[44:45], v[40:41], s[32:33] op_sel:[0,1] neg_lo:[0,1] neg_hi:[0,1]
v_pk_mul_f32 v[46:47], v[40:41], s[32:33] op_sel:[0,1] neg_lo:[0,1] neg_hi:[0,1]
v_pk_fma_f32 v[44:45], v[42:43], s[32:33], v[44:45] op_sel:[0,1,0]
v_pk_fma_f32 v[46:47], v[42:43], s[32:33], v[46:47] op_sel:[0,1,0] neg_lo:[0,1,0] neg_hi:[0,1,0]
v_pk_add_f32 v[40:41], v[112:113], v[48:49] neg_lo:[0,1] neg_hi:[0,1]
v_pk_add_f32 v[42:43], v[114:115], v[50:51] neg_lo:[0,1] neg_hi:[0,1]
v_pk_add_f32 v[112:113], v[112:113], v[48:49]
v_pk_add_f32 v[114:115], v[114:115], v[50:51]
v_pk_add_f32 v[48:49], v[52:53], v[68:69] neg_lo:[0,1] neg_hi:[0,1]
v_pk_add_f32 v[50:51], v[54:55], v[70:71] neg_lo:[0,1] neg_hi:[0,1]
v_pk_add_f32 v[52:53], v[52:53], v[68:69]
v_pk_add_f32 v[54:55], v[54:55], v[70:71]
v_pk_mul_f32 v[68:69], v[48:49], s[32:33] op_sel:[0,1]
v_pk_mul_f32 v[70:71], v[48:49], s[32:33] op_sel:[0,1] neg_lo:[0,1] neg_hi:[0,1]
v_pk_fma_f32 v[68:69], v[50:51], s[32:33], v[68:69] op_sel:[0,1,0]
v_pk_fma_f32 v[70:71], v[50:51], s[32:33], v[70:71] op_sel:[0,1,0]
v_pk_add_f32 v[48:49], v[58:59], v[74:75] neg_lo:[0,1] neg_hi:[0,1]
v_pk_add_f32 v[50:51], v[72:73], v[56:57] neg_lo:[0,1] neg_hi:[0,1]
v_pk_add_f32 v[56:57], v[56:57], v[72:73]
v_pk_add_f32 v[58:59], v[58:59], v[74:75]
v_pk_add_f32 v[72:73], v[60:61], v[76:77] neg_lo:[0,1] neg_hi:[0,1]
v_pk_add_f32 v[74:75], v[62:63], v[78:79] neg_lo:[0,1] neg_hi:[0,1]
v_pk_add_f32 v[60:61], v[60:61], v[76:77]
v_pk_add_f32 v[62:63], v[62:63], v[78:79]
v_pk_mul_f32 v[76:77], v[72:73], s[32:33] op_sel:[0,1] neg_lo:[0,1] neg_hi:[0,1]
v_pk_mul_f32 v[78:79], v[72:73], s[32:33] op_sel:[0,1] neg_lo:[0,1] neg_hi:[0,1]
v_pk_fma_f32 v[76:77], v[74:75], s[32:33], v[76:77] op_sel:[0,1,0]
v_pk_fma_f32 v[78:79], v[74:75], s[32:33], v[78:79] op_sel:[0,1,0] neg_lo:[0,1,0] neg_hi:[0,1,0]
v_pk_add_f32 v[72:73], v[144:145], v[96:97] neg_lo:[0,1] neg_hi:[0,1]
v_pk_add_f32 v[74:75], v[146:147], v[98:99] neg_lo:[0,1] neg_hi:[0,1]
v_pk_add_f32 v[144:145], v[144:145], v[96:97]
v_pk_add_f32 v[146:147], v[146:147], v[98:99]
v_pk_add_f32 v[96:97], v[84:85], v[100:101] neg_lo:[0,1] neg_hi:[0,1]
v_pk_add_f32 v[98:99], v[86:87], v[102:103] neg_lo:[0,1] neg_hi:[0,1]
v_pk_add_f32 v[84:85], v[84:85], v[100:101]
v_pk_add_f32 v[86:87], v[86:87], v[102:103]
v_pk_mul_f32 v[100:101], v[96:97], s[32:33] op_sel:[0,1]
v_pk_mul_f32 v[102:103], v[96:97], s[32:33] op_sel:[0,1] neg_lo:[0,1] neg_hi:[0,1]
v_pk_fma_f32 v[100:101], v[98:99], s[32:33], v[100:101] op_sel:[0,1,0]
v_pk_fma_f32 v[102:103], v[98:99], s[32:33], v[102:103] op_sel:[0,1,0]
v_pk_add_f32 v[96:97], v[90:91], v[106:107] neg_lo:[0,1] neg_hi:[0,1]
v_pk_add_f32 v[98:99], v[104:105], v[88:89] neg_lo:[0,1] neg_hi:[0,1]
v_pk_add_f32 v[88:89], v[88:89], v[104:105]
v_pk_add_f32 v[90:91], v[90:91], v[106:107]
v_pk_add_f32 v[104:105], v[92:93], v[108:109] neg_lo:[0,1] neg_hi:[0,1]
v_pk_add_f32 v[106:107], v[94:95], v[110:111] neg_lo:[0,1] neg_hi:[0,1]
v_pk_add_f32 v[92:93], v[92:93], v[108:109]
v_pk_add_f32 v[94:95], v[94:95], v[110:111]
v_pk_mul_f32 v[108:109], v[104:105], s[32:33] op_sel:[0,1] neg_lo:[0,1] neg_hi:[0,1]
v_pk_mul_f32 v[110:111], v[104:105], s[32:33] op_sel:[0,1] neg_lo:[0,1] neg_hi:[0,1]
v_pk_fma_f32 v[108:109], v[106:107], s[32:33], v[108:109] op_sel:[0,1,0]
v_pk_fma_f32 v[110:111], v[106:107], s[32:33], v[110:111] op_sel:[0,1,0] neg_lo:[0,1,0] neg_hi:[0,1,0]
v_pk_add_f32 v[104:105], v[64:65], v[80:81] neg_lo:[0,1] neg_hi:[0,1]
v_pk_add_f32 v[106:107], v[66:67], v[82:83] neg_lo:[0,1] neg_hi:[0,1]
v_pk_add_f32 v[64:65], v[64:65], v[80:81]
v_pk_add_f32 v[66:67], v[66:67], v[82:83]
v_pk_add_f32 v[80:81], v[116:117], v[132:133] neg_lo:[0,1] neg_hi:[0,1]
v_pk_add_f32 v[82:83], v[118:119], v[134:135] neg_lo:[0,1] neg_hi:[0,1]
v_pk_add_f32 v[116:117], v[116:117], v[132:133]
v_pk_add_f32 v[118:119], v[118:119], v[134:135]
v_pk_mul_f32 v[132:133], v[80:81], s[32:33] op_sel:[0,1]
v_pk_mul_f32 v[134:135], v[80:81], s[32:33] op_sel:[0,1] neg_lo:[0,1] neg_hi:[0,1]
v_pk_fma_f32 v[132:133], v[82:83], s[32:33], v[132:133] op_sel:[0,1,0]
v_pk_fma_f32 v[134:135], v[82:83], s[32:33], v[134:135] op_sel:[0,1,0]
v_pk_add_f32 v[80:81], v[122:123], v[138:139] neg_lo:[0,1] neg_hi:[0,1]
v_pk_add_f32 v[82:83], v[136:137], v[120:121] neg_lo:[0,1] neg_hi:[0,1]
v_pk_add_f32 v[120:121], v[120:121], v[136:137]
v_pk_add_f32 v[122:123], v[122:123], v[138:139]
v_pk_add_f32 v[136:137], v[124:125], v[140:141] neg_lo:[0,1] neg_hi:[0,1]
v_pk_add_f32 v[138:139], v[126:127], v[142:143] neg_lo:[0,1] neg_hi:[0,1]
v_pk_add_f32 v[124:125], v[124:125], v[140:141]
v_pk_add_f32 v[126:127], v[126:127], v[142:143]
v_pk_mul_f32 v[140:141], v[136:137], s[32:33] op_sel:[0,1] neg_lo:[0,1] neg_hi:[0,1]
v_pk_mul_f32 v[142:143], v[136:137], s[32:33] op_sel:[0,1] neg_lo:[0,1] neg_hi:[0,1]
v_pk_fma_f32 v[140:141], v[138:139], s[32:33], v[140:141] op_sel:[0,1,0]
v_pk_fma_f32 v[142:143], v[138:139], s[32:33], v[142:143] op_sel:[0,1,0] neg_lo:[0,1,0] neg_hi:[0,1,0]
v_pk_add_f32 v[136:137], v[16:17], v[24:25] neg_lo:[0,1] neg_hi:[0,1]
v_pk_add_f32 v[138:139], v[18:19], v[26:27] neg_lo:[0,1] neg_hi:[0,1]
v_pk_add_f32 v[16:17], v[16:17], v[24:25]
v_pk_add_f32 v[18:19], v[18:19], v[26:27]
v_pk_add_f32 v[24:25], v[22:23], v[30:31] neg_lo:[0,1] neg_hi:[0,1]
v_pk_add_f32 v[26:27], v[28:29], v[20:21] neg_lo:[0,1] neg_hi:[0,1]
v_pk_add_f32 v[20:21], v[20:21], v[28:29]
v_pk_add_f32 v[22:23], v[22:23], v[30:31]
v_pk_add_f32 v[28:29], v[128:129], v[32:33] neg_lo:[0,1] neg_hi:[0,1]
v_pk_add_f32 v[30:31], v[130:131], v[34:35] neg_lo:[0,1] neg_hi:[0,1]
v_pk_add_f32 v[128:129], v[128:129], v[32:33]
v_pk_add_f32 v[130:131], v[130:131], v[34:35]
v_pk_add_f32 v[32:33], v[38:39], v[46:47] neg_lo:[0,1] neg_hi:[0,1]
v_pk_add_f32 v[34:35], v[44:45], v[36:37] neg_lo:[0,1] neg_hi:[0,1]
v_pk_add_f32 v[36:37], v[36:37], v[44:45]
v_pk_add_f32 v[38:39], v[38:39], v[46:47]
v_pk_add_f32 v[44:45], v[112:113], v[56:57] neg_lo:[0,1] neg_hi:[0,1]
v_pk_add_f32 v[46:47], v[114:115], v[58:59] neg_lo:[0,1] neg_hi:[0,1]
v_pk_add_f32 v[112:113], v[112:113], v[56:57]
v_pk_add_f32 v[114:115], v[114:115], v[58:59]
v_pk_add_f32 v[56:57], v[54:55], v[62:63] neg_lo:[0,1] neg_hi:[0,1]
v_pk_add_f32 v[58:59], v[60:61], v[52:53] neg_lo:[0,1] neg_hi:[0,1]
v_pk_add_f32 v[52:53], v[52:53], v[60:61]
v_pk_add_f32 v[54:55], v[54:55], v[62:63]
v_pk_add_f32 v[60:61], v[40:41], v[48:49] neg_lo:[0,1] neg_hi:[0,1]
v_pk_add_f32 v[62:63], v[42:43], v[50:51] neg_lo:[0,1] neg_hi:[0,1]
v_pk_add_f32 v[40:41], v[40:41], v[48:49]
v_pk_add_f32 v[42:43], v[42:43], v[50:51]
v_pk_add_f32 v[48:49], v[70:71], v[78:79] neg_lo:[0,1] neg_hi:[0,1]
v_pk_add_f32 v[50:51], v[76:77], v[68:69] neg_lo:[0,1] neg_hi:[0,1]
v_pk_add_f32 v[68:69], v[68:69], v[76:77]
v_pk_add_f32 v[70:71], v[70:71], v[78:79]
v_pk_add_f32 v[76:77], v[144:145], v[88:89] neg_lo:[0,1] neg_hi:[0,1]
v_pk_add_f32 v[78:79], v[146:147], v[90:91] neg_lo:[0,1] neg_hi:[0,1]
v_pk_add_f32 v[144:145], v[144:145], v[88:89]
v_pk_add_f32 v[146:147], v[146:147], v[90:91]
v_pk_add_f32 v[88:89], v[86:87], v[94:95] neg_lo:[0,1] neg_hi:[0,1]
v_pk_add_f32 v[90:91], v[92:93], v[84:85] neg_lo:[0,1] neg_hi:[0,1]
v_pk_add_f32 v[84:85], v[84:85], v[92:93]
v_pk_add_f32 v[86:87], v[86:87], v[94:95]
v_pk_add_f32 v[92:93], v[72:73], v[96:97] neg_lo:[0,1] neg_hi:[0,1]
v_pk_add_f32 v[94:95], v[74:75], v[98:99] neg_lo:[0,1] neg_hi:[0,1]
v_pk_add_f32 v[72:73], v[72:73], v[96:97]
v_pk_add_f32 v[74:75], v[74:75], v[98:99]
v_pk_add_f32 v[96:97], v[102:103], v[110:111] neg_lo:[0,1] neg_hi:[0,1]
v_pk_add_f32 v[98:99], v[108:109], v[100:101] neg_lo:[0,1] neg_hi:[0,1]
v_pk_add_f32 v[100:101], v[100:101], v[108:109]
v_pk_add_f32 v[102:103], v[102:103], v[110:111]
v_pk_add_f32 v[108:109], v[64:65], v[120:121] neg_lo:[0,1] neg_hi:[0,1]
v_pk_add_f32 v[110:111], v[66:67], v[122:123] neg_lo:[0,1] neg_hi:[0,1]
v_pk_add_f32 v[64:65], v[64:65], v[120:121]
v_pk_add_f32 v[66:67], v[66:67], v[122:123]
v_pk_add_f32 v[120:121], v[118:119], v[126:127] neg_lo:[0,1] neg_hi:[0,1]
v_pk_add_f32 v[122:123], v[124:125], v[116:117] neg_lo:[0,1] neg_hi:[0,1]
v_pk_add_f32 v[116:117], v[116:117], v[124:125]
v_pk_add_f32 v[118:119], v[118:119], v[126:127]
v_pk_add_f32 v[124:125], v[104:105], v[80:81] neg_lo:[0,1] neg_hi:[0,1]
v_pk_add_f32 v[126:127], v[106:107], v[82:83] neg_lo:[0,1] neg_hi:[0,1]
v_pk_add_f32 v[104:105], v[104:105], v[80:81]
v_pk_add_f32 v[106:107], v[106:107], v[82:83]
v_pk_add_f32 v[80:81], v[134:135], v[142:143] neg_lo:[0,1] neg_hi:[0,1]
v_pk_add_f32 v[82:83], v[140:141], v[132:133] neg_lo:[0,1] neg_hi:[0,1]
v_pk_add_f32 v[132:133], v[132:133], v[140:141]
v_pk_add_f32 v[134:135], v[134:135], v[142:143]
v_pk_add_f32 v[140:141], v[16:17], v[20:21] neg_lo:[0,1] neg_hi:[0,1]
v_pk_add_f32 v[142:143], v[18:19], v[22:23] neg_lo:[0,1] neg_hi:[0,1]
v_pk_add_f32 v[16:17], v[16:17], v[20:21]
v_pk_add_f32 v[18:19], v[18:19], v[22:23]
v_pk_add_f32 v[20:21], v[136:137], v[24:25] neg_lo:[0,1] neg_hi:[0,1]
v_pk_add_f32 v[22:23], v[138:139], v[26:27] neg_lo:[0,1] neg_hi:[0,1]
v_pk_add_f32 v[136:137], v[136:137], v[24:25]
v_pk_add_f32 v[138:139], v[138:139], v[26:27]
v_pk_add_f32 v[24:25], v[128:129], v[36:37] neg_lo:[0,1] neg_hi:[0,1]
v_pk_add_f32 v[26:27], v[130:131], v[38:39] neg_lo:[0,1] neg_hi:[0,1]
v_pk_add_f32 v[128:129], v[128:129], v[36:37]
v_pk_add_f32 v[130:131], v[130:131], v[38:39]
v_pk_add_f32 v[36:37], v[28:29], v[32:33] neg_lo:[0,1] neg_hi:[0,1]
v_pk_add_f32 v[38:39], v[30:31], v[34:35] neg_lo:[0,1] neg_hi:[0,1]
v_pk_add_f32 v[28:29], v[28:29], v[32:33]
v_pk_add_f32 v[30:31], v[30:31], v[34:35]
v_pk_add_f32 v[32:33], v[112:113], v[52:53] neg_lo:[0,1] neg_hi:[0,1]
v_pk_add_f32 v[34:35], v[114:115], v[54:55] neg_lo:[0,1] neg_hi:[0,1]
v_pk_add_f32 v[112:113], v[112:113], v[52:53]
v_pk_add_f32 v[114:115], v[114:115], v[54:55]
v_pk_add_f32 v[52:53], v[44:45], v[56:57] neg_lo:[0,1] neg_hi:[0,1]
v_pk_add_f32 v[54:55], v[46:47], v[58:59] neg_lo:[0,1] neg_hi:[0,1]
v_pk_add_f32 v[44:45], v[44:45], v[56:57]
v_pk_add_f32 v[46:47], v[46:47], v[58:59]
v_pk_add_f32 v[56:57], v[40:41], v[68:69] neg_lo:[0,1] neg_hi:[0,1]
v_pk_add_f32 v[58:59], v[42:43], v[70:71] neg_lo:[0,1] neg_hi:[0,1]
v_pk_add_f32 v[40:41], v[40:41], v[68:69]
v_pk_add_f32 v[42:43], v[42:43], v[70:71]
v_pk_add_f32 v[68:69], v[60:61], v[48:49] neg_lo:[0,1] neg_hi:[0,1]
v_pk_add_f32 v[70:71], v[62:63], v[50:51] neg_lo:[0,1] neg_hi:[0,1]
v_pk_add_f32 v[60:61], v[60:61], v[48:49]
v_pk_add_f32 v[62:63], v[62:63], v[50:51]
v_pk_add_f32 v[48:49], v[144:145], v[84:85] neg_lo:[0,1] neg_hi:[0,1]
v_pk_add_f32 v[50:51], v[146:147], v[86:87] neg_lo:[0,1] neg_hi:[0,1]
v_pk_add_f32 v[144:145], v[144:145], v[84:85]
v_pk_add_f32 v[146:147], v[146:147], v[86:87]
v_pk_add_f32 v[84:85], v[76:77], v[88:89] neg_lo:[0,1] neg_hi:[0,1]
v_pk_add_f32 v[86:87], v[78:79], v[90:91] neg_lo:[0,1] neg_hi:[0,1]
v_pk_add_f32 v[76:77], v[76:77], v[88:89]
v_pk_add_f32 v[78:79], v[78:79], v[90:91]
v_pk_add_f32 v[88:89], v[72:73], v[100:101] neg_lo:[0,1] neg_hi:[0,1]
v_pk_add_f32 v[90:91], v[74:75], v[102:103] neg_lo:[0,1] neg_hi:[0,1]
v_pk_add_f32 v[72:73], v[72:73], v[100:101]
v_pk_add_f32 v[74:75], v[74:75], v[102:103]
v_pk_add_f32 v[100:101], v[92:93], v[96:97] neg_lo:[0,1] neg_hi:[0,1]
v_pk_add_f32 v[102:103], v[94:95], v[98:99] neg_lo:[0,1] neg_hi:[0,1]
v_pk_add_f32 v[92:93], v[92:93], v[96:97]
v_pk_add_f32 v[94:95], v[94:95], v[98:99]
v_pk_add_f32 v[96:97], v[64:65], v[116:117] neg_lo:[0,1] neg_hi:[0,1]
v_pk_add_f32 v[98:99], v[66:67], v[118:119] neg_lo:[0,1] neg_hi:[0,1]
v_pk_add_f32 v[64:65], v[64:65], v[116:117]
v_pk_add_f32 v[66:67], v[66:67], v[118:119]
v_pk_add_f32 v[116:117], v[108:109], v[120:121] neg_lo:[0,1] neg_hi:[0,1]
v_pk_add_f32 v[118:119], v[110:111], v[122:123] neg_lo:[0,1] neg_hi:[0,1]
v_pk_add_f32 v[108:109], v[108:109], v[120:121]
v_pk_add_f32 v[110:111], v[110:111], v[122:123]
v_pk_add_f32 v[120:121], v[104:105], v[132:133] neg_lo:[0,1] neg_hi:[0,1]
v_pk_add_f32 v[122:123], v[106:107], v[134:135] neg_lo:[0,1] neg_hi:[0,1]
v_pk_add_f32 v[104:105], v[104:105], v[132:133]
v_pk_add_f32 v[106:107], v[106:107], v[134:135]
v_pk_add_f32 v[132:133], v[124:125], v[80:81] neg_lo:[0,1] neg_hi:[0,1]
v_pk_add_f32 v[134:135], v[126:127], v[82:83] neg_lo:[0,1] neg_hi:[0,1]
v_pk_add_f32 v[124:125], v[124:125], v[80:81]
v_pk_add_f32 v[126:127], v[126:127], v[82:83]
v_mul_f32 v151, 0xba000000, v2
v_cos_f32 v150, v151
v_sin_f32 v151, v151
v_mul_f32 v149, 0xba800000, v2
v_cos_f32 v148, v149
v_sin_f32 v149, v149
v_pk_mul_f32 v[80:81], v[144:145], v[150:151] op_sel_hi:[1,0]
v_pk_fma_f32 v[80:81], v[146:147], v[150:151], v[80:81] op_sel:[0,1,0] neg_lo:[1,0,0] neg_hi:[1,0,0]
v_pk_mul_f32 v[146:147], v[146:147], v[150:151] op_sel_hi:[1,0]
v_pk_fma_f32 v[146:147], v[144:145], v[150:151], v[146:147] op_sel:[0,1,0]
v_mul_f32 v151, 0xbac00000, v2
v_cos_f32 v150, v151
v_sin_f32 v151, v151
v_pk_mul_f32 v[144:145], v[112:113], v[148:149] op_sel_hi:[1,0]
v_pk_fma_f32 v[144:145], v[114:115], v[148:149], v[144:145] op_sel:[0,1,0] neg_lo:[1,0,0] neg_hi:[1,0,0]
v_pk_mul_f32 v[114:115], v[114:115], v[148:149] op_sel_hi:[1,0]
v_pk_fma_f32 v[114:115], v[112:113], v[148:149], v[114:115] op_sel:[0,1,0]
v_mul_f32 v149, 0xbb000000, v2
v_cos_f32 v148, v149
v_sin_f32 v149, v149
v_pk_mul_f32 v[112:113], v[64:65], v[150:151] op_sel_hi:[1,0]
v_pk_fma_f32 v[112:113], v[66:67], v[150:151], v[112:113] op_sel:[0,1,0] neg_lo:[1,0,0] neg_hi:[1,0,0]
v_pk_mul_f32 v[66:67], v[66:67], v[150:151] op_sel_hi:[1,0]
v_pk_fma_f32 v[66:67], v[64:65], v[150:151], v[66:67] op_sel:[0,1,0]
v_mul_f32 v151, 0xbb200000, v2
v_cos_f32 v150, v151
v_sin_f32 v151, v151
v_pk_mul_f32 v[64:65], v[128:129], v[148:149] op_sel_hi:[1,0]
v_pk_fma_f32 v[64:65], v[130:131], v[148:149], v[64:65] op_sel:[0,1,0] neg_lo:[1,0,0] neg_hi:[1,0,0]
v_pk_mul_f32 v[130:131], v[130:131], v[148:149] op_sel_hi:[1,0]
v_pk_fma_f32 v[130:131], v[128:129], v[148:149], v[130:131] op_sel:[0,1,0]
v_mul_f32 v149, 0xbb400000, v2
v_cos_f32 v148, v149
v_sin_f32 v149, v149
v_pk_mul_f32 v[128:129], v[72:73], v[150:151] op_sel_hi:[1,0]
v_pk_fma_f32 v[128:129], v[74:75], v[150:151], v[128:129] op_sel:[0,1,0] neg_lo:[1,0,0] neg_hi:[1,0,0]
v_pk_mul_f32 v[74:75], v[74:75], v[150:151] op_sel_hi:[1,0]
v_pk_fma_f32 v[74:75], v[72:73], v[150:151], v[74:75] op_sel:[0,1,0]
v_mul_f32 v151, 0xbb600000, v2
v_cos_f32 v150, v151
v_sin_f32 v151, v151
v_pk_mul_f32 v[72:73], v[40:41], v[148:149] op_sel_hi:[1,0]
v_pk_fma_f32 v[72:73], v[42:43], v[148:149], v[72:73] op_sel:[0,1,0] neg_lo:[1,0,0] neg_hi:[1,0,0]
v_pk_mul_f32 v[42:43], v[42:43], v[148:149] op_sel_hi:[1,0]
v_pk_fma_f32 v[42:43], v[40:41], v[148:149], v[42:43] op_sel:[0,1,0]
v_mul_f32 v149, 0xbb800000, v2
v_cos_f32 v148, v149
v_sin_f32 v149, v149
v_pk_mul_f32 v[40:41], v[104:105], v[150:151] op_sel_hi:[1,0]
v_pk_fma_f32 v[40:41], v[106:107], v[150:151], v[40:41] op_sel:[0,1,0] neg_lo:[1,0,0] neg_hi:[1,0,0]
v_pk_mul_f32 v[106:107], v[106:107], v[150:151] op_sel_hi:[1,0]
v_pk_fma_f32 v[106:107], v[104:105], v[150:151], v[106:107] op_sel:[0,1,0]
v_mul_f32 v151, 0xbb900000, v2
v_cos_f32 v150, v151
v_sin_f32 v151, v151
v_pk_mul_f32 v[104:105], v[136:137], v[148:149] op_sel_hi:[1,0]
v_pk_fma_f32 v[104:105], v[138:139], v[148:149], v[104:105] op_sel:[0,1,0] neg_lo:[1,0,0] neg_hi:[1,0,0]
v_pk_mul_f32 v[138:139], v[138:139], v[148:149] op_sel_hi:[1,0]
v_pk_fma_f32 v[138:139], v[136:137], v[148:149], v[138:139] op_sel:[0,1,0]
v_mul_f32 v149, 0xbba00000, v2
v_cos_f32 v148, v149
v_sin_f32 v149, v149
v_pk_mul_f32 v[136:137], v[76:77], v[150:151] op_sel_hi:[1,0]
v_pk_fma_f32 v[136:137], v[78:79], v[150:151], v[136:137] op_sel:[0,1,0] neg_lo:[1,0,0] neg_hi:[1,0,0]
v_pk_mul_f32 v[78:79], v[78:79], v[150:151] op_sel_hi:[1,0]
v_pk_fma_f32 v[78:79], v[76:77], v[150:151], v[78:79] op_sel:[0,1,0]
v_mul_f32 v151, 0xbbb00000, v2
v_cos_f32 v150, v151
v_sin_f32 v151, v151
v_pk_mul_f32 v[76:77], v[44:45], v[148:149] op_sel_hi:[1,0]
v_pk_fma_f32 v[76:77], v[46:47], v[148:149], v[76:77] op_sel:[0,1,0] neg_lo:[1,0,0] neg_hi:[1,0,0]
v_pk_mul_f32 v[46:47], v[46:47], v[148:149] op_sel_hi:[1,0]
v_pk_fma_f32 v[46:47], v[44:45], v[148:149], v[46:47] op_sel:[0,1,0]
v_mul_f32 v149, 0xbbc00000, v2
v_cos_f32 v148, v149
v_sin_f32 v149, v149
v_pk_mul_f32 v[44:45], v[108:109], v[150:151] op_sel_hi:[1,0]
v_pk_fma_f32 v[44:45], v[110:111], v[150:151], v[44:45] op_sel:[0,1,0] neg_lo:[1,0,0] neg_hi:[1,0,0]
v_pk_mul_f32 v[110:111], v[110:111], v[150:151] op_sel_hi:[1,0]
v_pk_fma_f32 v[110:111], v[108:109], v[150:151], v[110:111] op_sel:[0,1,0]
v_mul_f32 v151, 0xbbd00000, v2
v_cos_f32 v150, v151
v_sin_f32 v151, v151
v_pk_mul_f32 v[108:109], v[28:29], v[148:149] op_sel_hi:[1,0]
v_pk_fma_f32 v[108:109], v[30:31], v[148:149], v[108:109] op_sel:[0,1,0] neg_lo:[1,0,0] neg_hi:[1,0,0]
v_pk_mul_f32 v[30:31], v[30:31], v[148:149] op_sel_hi:[1,0]
v_pk_fma_f32 v[30:31], v[28:29], v[148:149], v[30:31] op_sel:[0,1,0]
v_mul_f32 v149, 0xbbe00000, v2
v_cos_f32 v148, v149
v_sin_f32 v149, v149
v_pk_mul_f32 v[28:29], v[92:93], v[150:151] op_sel_hi:[1,0]
v_pk_fma_f32 v[28:29], v[94:95], v[150:151], v[28:29] op_sel:[0,1,0] neg_lo:[1,0,0] neg_hi:[1,0,0]
v_pk_mul_f32 v[94:95], v[94:95], v[150:151] op_sel_hi:[1,0]
v_pk_fma_f32 v[94:95], v[92:93], v[150:151], v[94:95] op_sel:[0,1,0]
v_mul_f32 v151, 0xbbf00000, v2
v_cos_f32 v150, v151
v_sin_f32 v151, v151
v_pk_mul_f32 v[92:93], v[60:61], v[148:149] op_sel_hi:[1,0]
v_pk_fma_f32 v[92:93], v[62:63], v[148:149], v[92:93] op_sel:[0,1,0] neg_lo:[1,0,0] neg_hi:[1,0,0]
v_pk_mul_f32 v[62:63], v[62:63], v[148:149] op_sel_hi:[1,0]
v_pk_fma_f32 v[62:63], v[60:61], v[148:149], v[62:63] op_sel:[0,1,0]
v_mul_f32 v149, 0xbc000000, v2
v_cos_f32 v148, v149
v_sin_f32 v149, v149
v_pk_mul_f32 v[60:61], v[124:125], v[150:151] op_sel_hi:[1,0]
v_pk_fma_f32 v[60:61], v[126:127], v[150:151], v[60:61] op_sel:[0,1,0] neg_lo:[1,0,0] neg_hi:[1,0,0]
v_pk_mul_f32 v[126:127], v[126:127], v[150:151] op_sel_hi:[1,0]
v_pk_fma_f32 v[126:127], v[124:125], v[150:151], v[126:127] op_sel:[0,1,0]
v_mul_f32 v151, 0xbc080000, v2
v_cos_f32 v150, v151
v_sin_f32 v151, v151
v_pk_mul_f32 v[124:125], v[140:141], v[148:149] op_sel_hi:[1,0]
v_pk_fma_f32 v[124:125], v[142:143], v[148:149], v[124:125] op_sel:[0,1,0] neg_lo:[1,0,0] neg_hi:[1,0,0]
v_pk_mul_f32 v[142:143], v[142:143], v[148:149] op_sel_hi:[1,0]
v_pk_fma_f32 v[142:143], v[140:141], v[148:149], v[142:143] op_sel:[0,1,0]
v_mul_f32 v149, 0xbc100000, v2
v_cos_f32 v148, v149
v_sin_f32 v149, v149
v_pk_mul_f32 v[140:141], v[48:49], v[150:151] op_sel_hi:[1,0]
v_pk_fma_f32 v[140:141], v[50:51], v[150:151], v[140:141] op_sel:[0,1,0] neg_lo:[1,0,0] neg_hi:[1,0,0]
v_pk_mul_f32 v[50:51], v[50:51], v[150:151] op_sel_hi:[1,0]
v_pk_fma_f32 v[50:51], v[48:49], v[150:151], v[50:51] op_sel:[0,1,0]
v_mul_f32 v151, 0xbc180000, v2
v_cos_f32 v150, v151
v_sin_f32 v151, v151
v_pk_mul_f32 v[48:49], v[32:33], v[148:149] op_sel_hi:[1,0]
v_pk_fma_f32 v[48:49], v[34:35], v[148:149], v[48:49] op_sel:[0,1,0] neg_lo:[1,0,0] neg_hi:[1,0,0]
v_pk_mul_f32 v[34:35], v[34:35], v[148:149] op_sel_hi:[1,0]
v_pk_fma_f32 v[34:35], v[32:33], v[148:149], v[34:35] op_sel:[0,1,0]
v_mul_f32 v149, 0xbc200000, v2
v_cos_f32 v148, v149
v_sin_f32 v149, v149
v_pk_mul_f32 v[32:33], v[96:97], v[150:151] op_sel_hi:[1,0]
v_pk_fma_f32 v[32:33], v[98:99], v[150:151], v[32:33] op_sel:[0,1,0] neg_lo:[1,0,0] neg_hi:[1,0,0]
v_pk_mul_f32 v[98:99], v[98:99], v[150:151] op_sel_hi:[1,0]
v_pk_fma_f32 v[98:99], v[96:97], v[150:151], v[98:99] op_sel:[0,1,0]
v_mul_f32 v151, 0xbc280000, v2
v_cos_f32 v150, v151
v_sin_f32 v151, v151
v_pk_mul_f32 v[96:97], v[24:25], v[148:149] op_sel_hi:[1,0]
v_pk_fma_f32 v[96:97], v[26:27], v[148:149], v[96:97] op_sel:[0,1,0] neg_lo:[1,0,0] neg_hi:[1,0,0]
v_pk_mul_f32 v[26:27], v[26:27], v[148:149] op_sel_hi:[1,0]
v_pk_fma_f32 v[26:27], v[24:25], v[148:149], v[26:27] op_sel:[0,1,0]
v_mul_f32 v149, 0xbc300000, v2
v_cos_f32 v148, v149
v_sin_f32 v149, v149
v_pk_mul_f32 v[24:25], v[88:89], v[150:151] op_sel_hi:[1,0]
v_pk_fma_f32 v[24:25], v[90:91], v[150:151], v[24:25] op_sel:[0,1,0] neg_lo:[1,0,0] neg_hi:[1,0,0]
v_pk_mul_f32 v[90:91], v[90:91], v[150:151] op_sel_hi:[1,0]
v_pk_fma_f32 v[90:91], v[88:89], v[150:151], v[90:91] op_sel:[0,1,0]
v_mul_f32 v151, 0xbc380000, v2
v_cos_f32 v150, v151
v_sin_f32 v151, v151
v_pk_mul_f32 v[88:89], v[56:57], v[148:149] op_sel_hi:[1,0]
v_pk_fma_f32 v[88:89], v[58:59], v[148:149], v[88:89] op_sel:[0,1,0] neg_lo:[1,0,0] neg_hi:[1,0,0]
v_pk_mul_f32 v[58:59], v[58:59], v[148:149] op_sel_hi:[1,0]
v_pk_fma_f32 v[58:59], v[56:57], v[148:149], v[58:59] op_sel:[0,1,0]
v_mul_f32 v149, 0xbc400000, v2
v_cos_f32 v148, v149
v_sin_f32 v149, v149
v_pk_mul_f32 v[56:57], v[120:121], v[150:151] op_sel_hi:[1,0]
v_pk_fma_f32 v[56:57], v[122:123], v[150:151], v[56:57] op_sel:[0,1,0] neg_lo:[1,0,0] neg_hi:[1,0,0]
v_pk_mul_f32 v[122:123], v[122:123], v[150:151] op_sel_hi:[1,0]
v_pk_fma_f32 v[122:123], v[120:121], v[150:151], v[122:123] op_sel:[0,1,0]
v_mul_f32 v151, 0xbc480000, v2
v_cos_f32 v150, v151
v_sin_f32 v151, v151
v_pk_mul_f32 v[120:121], v[20:21], v[148:149] op_sel_hi:[1,0]
v_pk_fma_f32 v[120:121], v[22:23], v[148:149], v[120:121] op_sel:[0,1,0] neg_lo:[1,0,0] neg_hi:[1,0,0]
v_pk_mul_f32 v[22:23], v[22:23], v[148:149] op_sel_hi:[1,0]
v_pk_fma_f32 v[22:23], v[20:21], v[148:149], v[22:23] op_sel:[0,1,0]
v_mul_f32 v149, 0xbc500000, v2
v_cos_f32 v148, v149
v_sin_f32 v149, v149
v_pk_mul_f32 v[20:21], v[84:85], v[150:151] op_sel_hi:[1,0]
v_pk_fma_f32 v[20:21], v[86:87], v[150:151], v[20:21] op_sel:[0,1,0] neg_lo:[1,0,0] neg_hi:[1,0,0]
v_pk_mul_f32 v[86:87], v[86:87], v[150:151] op_sel_hi:[1,0]
v_pk_fma_f32 v[86:87], v[84:85], v[150:151], v[86:87] op_sel:[0,1,0]
v_mul_f32 v151, 0xbc580000, v2
v_cos_f32 v150, v151
v_sin_f32 v151, v151
v_pk_mul_f32 v[84:85], v[52:53], v[148:149] op_sel_hi:[1,0]
v_pk_fma_f32 v[84:85], v[54:55], v[148:149], v[84:85] op_sel:[0,1,0] neg_lo:[1,0,0] neg_hi:[1,0,0]
v_pk_mul_f32 v[54:55], v[54:55], v[148:149] op_sel_hi:[1,0]
v_pk_fma_f32 v[54:55], v[52:53], v[148:149], v[54:55] op_sel:[0,1,0]
v_mul_f32 v149, 0xbc600000, v2
v_cos_f32 v148, v149
v_sin_f32 v149, v149
v_pk_mul_f32 v[52:53], v[116:117], v[150:151] op_sel_hi:[1,0]
v_pk_fma_f32 v[52:53], v[118:119], v[150:151], v[52:53] op_sel:[0,1,0] neg_lo:[1,0,0] neg_hi:[1,0,0]
v_pk_mul_f32 v[118:119], v[118:119], v[150:151] op_sel_hi:[1,0]
v_pk_fma_f32 v[118:119], v[116:117], v[150:151], v[118:119] op_sel:[0,1,0]
v_mul_f32 v151, 0xbc680000, v2
v_cos_f32 v150, v151
v_sin_f32 v151, v151
v_pk_mul_f32 v[116:117], v[36:37], v[148:149] op_sel_hi:[1,0]
v_pk_fma_f32 v[116:117], v[38:39], v[148:149], v[116:117] op_sel:[0,1,0] neg_lo:[1,0,0] neg_hi:[1,0,0]
v_pk_mul_f32 v[38:39], v[38:39], v[148:149] op_sel_hi:[1,0]
v_pk_fma_f32 v[38:39], v[36:37], v[148:149], v[38:39] op_sel:[0,1,0]
v_mul_f32 v149, 0xbc700000, v2
v_cos_f32 v148, v149
v_sin_f32 v149, v149
v_pk_mul_f32 v[36:37], v[100:101], v[150:151] op_sel_hi:[1,0]
v_pk_fma_f32 v[36:37], v[102:103], v[150:151], v[36:37] op_sel:[0,1,0] neg_lo:[1,0,0] neg_hi:[1,0,0]
v_pk_mul_f32 v[102:103], v[102:103], v[150:151] op_sel_hi:[1,0]
v_pk_fma_f32 v[102:103], v[100:101], v[150:151], v[102:103] op_sel:[0,1,0]
v_mul_f32 v151, 0xbc780000, v2
v_cos_f32 v150, v151
v_sin_f32 v151, v151
v_pk_mul_f32 v[100:101], v[68:69], v[148:149] op_sel_hi:[1,0]
v_pk_fma_f32 v[100:101], v[70:71], v[148:149], v[100:101] op_sel:[0,1,0] neg_lo:[1,0,0] neg_hi:[1,0,0]
v_pk_mul_f32 v[70:71], v[70:71], v[148:149] op_sel_hi:[1,0]
v_pk_fma_f32 v[70:71], v[68:69], v[148:149], v[70:71] op_sel:[0,1,0]
s_nop 0
v_pk_mul_f32 v[68:69], v[132:133], v[150:151] op_sel_hi:[1,0]
v_pk_fma_f32 v[68:69], v[134:135], v[150:151], v[68:69] op_sel:[0,1,0] neg_lo:[1,0,0] neg_hi:[1,0,0]
v_pk_mul_f32 v[134:135], v[134:135], v[150:151] op_sel_hi:[1,0]
v_pk_fma_f32 v[134:135], v[132:133], v[150:151], v[134:135] op_sel:[0,1,0]
ds_write_b64 v3, v[16:17]
ds_write_b64 v3, v[18:19] offset:8
ds_write_b64 v3, v[80:81] offset:1056
ds_write_b64 v3, v[146:147] offset:1064
ds_write_b64 v3, v[144:145] offset:2112
ds_write_b64 v3, v[114:115] offset:2120
ds_write_b64 v3, v[112:113] offset:3168
ds_write_b64 v3, v[66:67] offset:3176
ds_write_b64 v3, v[64:65] offset:4224
ds_write_b64 v3, v[130:131] offset:4232
ds_write_b64 v3, v[128:129] offset:5280
ds_write_b64 v3, v[74:75] offset:5288
ds_write_b64 v3, v[72:73] offset:6336
ds_write_b64 v3, v[42:43] offset:6344
ds_write_b64 v3, v[40:41] offset:7392
ds_write_b64 v3, v[106:107] offset:7400
ds_write_b64 v3, v[104:105] offset:8448
ds_write_b64 v3, v[138:139] offset:8456
ds_write_b64 v3, v[136:137] offset:9504
ds_write_b64 v3, v[78:79] offset:9512
ds_write_b64 v3, v[76:77] offset:10560
ds_write_b64 v3, v[46:47] offset:10568
ds_write_b64 v3, v[44:45] offset:11616
ds_write_b64 v3, v[110:111] offset:11624
ds_write_b64 v3, v[108:109] offset:12672
ds_write_b64 v3, v[30:31] offset:12680
ds_write_b64 v3, v[28:29] offset:13728
ds_write_b64 v3, v[94:95] offset:13736
ds_write_b64 v3, v[92:93] offset:14784
ds_write_b64 v3, v[62:63] offset:14792
ds_write_b64 v3, v[60:61] offset:15840
ds_write_b64 v3, v[126:127] offset:15848
ds_write_b64 v3, v[124:125] offset:16896
ds_write_b64 v3, v[142:143] offset:16904
ds_write_b64 v3, v[140:141] offset:17952
ds_write_b64 v3, v[50:51] offset:17960
ds_write_b64 v3, v[48:49] offset:19008
ds_write_b64 v3, v[34:35] offset:19016
ds_write_b64 v3, v[32:33] offset:20064
ds_write_b64 v3, v[98:99] offset:20072
ds_write_b64 v3, v[96:97] offset:21120
ds_write_b64 v3, v[26:27] offset:21128
ds_write_b64 v3, v[24:25] offset:22176
ds_write_b64 v3, v[90:91] offset:22184
ds_write_b64 v3, v[88:89] offset:23232
ds_write_b64 v3, v[58:59] offset:23240
ds_write_b64 v3, v[56:57] offset:24288
ds_write_b64 v3, v[122:123] offset:24296
ds_write_b64 v3, v[120:121] offset:25344
ds_write_b64 v3, v[22:23] offset:25352
ds_write_b64 v3, v[20:21] offset:26400
ds_write_b64 v3, v[86:87] offset:26408
ds_write_b64 v3, v[84:85] offset:27456
ds_write_b64 v3, v[54:55] offset:27464
ds_write_b64 v3, v[52:53] offset:28512
ds_write_b64 v3, v[118:119] offset:28520
ds_write_b64 v3, v[116:117] offset:29568
ds_write_b64 v3, v[38:39] offset:29576
ds_write_b64 v3, v[36:37] offset:30624
ds_write_b64 v3, v[102:103] offset:30632
ds_write_b64 v3, v[100:101] offset:31680
ds_write_b64 v3, v[70:71] offset:31688
ds_write_b64 v3, v[68:69] offset:32736
ds_write_b64 v3, v[134:135] offset:32744
s_waitcnt lgkmcnt(0)
ds_read_b128 v[16:19], v4
ds_read_b128 v[20:23], v4 offset:32
ds_read_b128 v[24:27], v4 offset:64
ds_read_b128 v[28:31], v4 offset:96
ds_read_b128 v[32:35], v4 offset:128
ds_read_b128 v[36:39], v4 offset:160
ds_read_b128 v[40:43], v4 offset:192
ds_read_b128 v[44:47], v4 offset:224
ds_read_b128 v[48:51], v4 offset:256
ds_read_b128 v[52:55], v4 offset:288
ds_read_b128 v[56:59], v4 offset:320
ds_read_b128 v[60:63], v4 offset:352
s_waitcnt lgkmcnt(4)
ds_read_b128 v[64:67], v4 offset:384
ds_read_b128 v[68:71], v4 offset:416
ds_read_b128 v[72:75], v4 offset:448
ds_read_b128 v[76:79], v4 offset:480
ds_read_b128 v[80:83], v4 offset:512
ds_read_b128 v[84:87], v4 offset:544
ds_read_b128 v[88:91], v4 offset:576
ds_read_b128 v[92:95], v4 offset:608
ds_read_b128 v[96:99], v4 offset:640
ds_read_b128 v[100:103], v4 offset:672
ds_read_b128 v[104:107], v4 offset:704
ds_read_b128 v[108:111], v4 offset:736
s_waitcnt lgkmcnt(4)
ds_read_b128 v[112:115], v4 offset:768
ds_read_b128 v[116:119], v4 offset:800
ds_read_b128 v[120:123], v4 offset:832
ds_read_b128 v[124:127], v4 offset:864
ds_read_b128 v[128:131], v4 offset:896
ds_read_b128 v[132:135], v4 offset:928
ds_read_b128 v[136:139], v4 offset:960
ds_read_b128 v[140:143], v4 offset:992
s_waitcnt lgkmcnt(0)
v_pk_add_f32 v[144:145], v[16:17], v[80:81] neg_lo:[0,1] neg_hi:[0,1]
v_pk_add_f32 v[146:147], v[18:19], v[82:83] neg_lo:[0,1] neg_hi:[0,1]
v_pk_add_f32 v[16:17], v[16:17], v[80:81]
v_pk_add_f32 v[18:19], v[18:19], v[82:83]
v_pk_add_f32 v[80:81], v[20:21], v[84:85] neg_lo:[0,1] neg_hi:[0,1]
v_pk_add_f32 v[82:83], v[22:23], v[86:87] neg_lo:[0,1] neg_hi:[0,1]
v_pk_add_f32 v[20:21], v[20:21], v[84:85]
v_pk_add_f32 v[22:23], v[22:23], v[86:87]
v_pk_mul_f32 v[84:85], v[80:81], s[30:31] op_sel_hi:[1,0]
v_pk_mul_f32 v[86:87], v[80:81], s[36:37] op_sel_hi:[1,0] neg_lo:[0,1] neg_hi:[0,1]
v_pk_fma_f32 v[84:85], v[82:83], s[36:37], v[84:85] op_sel_hi:[1,0,1]
v_pk_fma_f32 v[86:87], v[82:83], s[30:31], v[86:87] op_sel_hi:[1,0,1]
v_pk_add_f32 v[80:81], v[24:25], v[88:89] neg_lo:[0,1] neg_hi:[0,1]
v_pk_add_f32 v[82:83], v[26:27], v[90:91] neg_lo:[0,1] neg_hi:[0,1]
v_pk_add_f32 v[24:25], v[24:25], v[88:89]
v_pk_add_f32 v[26:27], v[26:27], v[90:91]
v_pk_mul_f32 v[88:89], v[80:81], s[30:31] op_sel:[0,1]
v_pk_mul_f32 v[90:91], v[80:81], s[34:35] op_sel:[0,1] neg_lo:[0,1] neg_hi:[0,1]
v_pk_fma_f32 v[88:89], v[82:83], s[34:35], v[88:89] op_sel:[0,1,0]
v_pk_fma_f32 v[90:91], v[82:83], s[30:31], v[90:91] op_sel:[0,1,0]
v_pk_add_f32 v[80:81], v[28:29], v[92:93] neg_lo:[0,1] neg_hi:[0,1]
v_pk_add_f32 v[82:83], v[30:31], v[94:95] neg_lo:[0,1] neg_hi:[0,1]
v_pk_add_f32 v[28:29], v[28:29], v[92:93]
v_pk_add_f32 v[30:31], v[30:31], v[94:95]
v_pk_mul_f32 v[92:93], v[80:81], s[32:33] op_sel_hi:[1,0]
v_pk_mul_f32 v[94:95], v[80:81], s[34:35] op_sel_hi:[1,0] neg_lo:[0,1] neg_hi:[0,1]
v_pk_fma_f32 v[92:93], v[82:83], s[34:35], v[92:93] op_sel_hi:[1,0,1]
v_pk_fma_f32 v[94:95], v[82:83], s[32:33], v[94:95] op_sel_hi:[1,0,1]
v_pk_add_f32 v[80:81], v[32:33], v[96:97] neg_lo:[0,1] neg_hi:[0,1]
v_pk_add_f32 v[82:83], v[34:35], v[98:99] neg_lo:[0,1] neg_hi:[0,1]
v_pk_add_f32 v[32:33], v[32:33], v[96:97]
v_pk_add_f32 v[34:35], v[34:35], v[98:99]
v_pk_mul_f32 v[96:97], v[80:81], s[32:33] op_sel:[0,1]
v_pk_mul_f32 v[98:99], v[80:81], s[32:33] op_sel:[0,1] neg_lo:[0,1] neg_hi:[0,1]
v_pk_fma_f32 v[96:97], v[82:83], s[32:33], v[96:97] op_sel:[0,1,0]
v_pk_fma_f32 v[98:99], v[82:83], s[32:33], v[98:99] op_sel:[0,1,0]
v_pk_add_f32 v[80:81], v[36:37], v[100:101] neg_lo:[0,1] neg_hi:[0,1]
v_pk_add_f32 v[82:83], v[38:39], v[102:103] neg_lo:[0,1] neg_hi:[0,1]
v_pk_add_f32 v[36:37], v[36:37], v[100:101]
v_pk_add_f32 v[38:39], v[38:39], v[102:103]
v_pk_mul_f32 v[100:101], v[80:81], s[34:35] op_sel_hi:[1,0]
v_pk_mul_f32 v[102:103], v[80:81], s[32:33] op_sel_hi:[1,0] neg_lo:[0,1] neg_hi:[0,1]
v_pk_fma_f32 v[100:101], v[82:83], s[32:33], v[100:101] op_sel_hi:[1,0,1]
v_pk_fma_f32 v[102:103], v[82:83], s[34:35], v[102:103] op_sel_hi:[1,0,1]
v_pk_add_f32 v[80:81], v[40:41], v[104:105] neg_lo:[0,1] neg_hi:[0,1]
v_pk_add_f32 v[82:83], v[42:43], v[106:107] neg_lo:[0,1] neg_hi:[0,1]
v_pk_add_f32 v[40:41], v[40:41], v[104:105]
v_pk_add_f32 v[42:43], v[42:43], v[106:107]
v_pk_mul_f32 v[104:105], v[80:81], s[34:35] op_sel:[0,1]
v_pk_mul_f32 v[106:107], v[80:81], s[30:31] op_sel:[0,1] neg_lo:[0,1] neg_hi:[0,1]
v_pk_fma_f32 v[104:105], v[82:83], s[30:31], v[104:105] op_sel:[0,1,0]
v_pk_fma_f32 v[106:107], v[82:83], s[34:35], v[106:107] op_sel:[0,1,0]
v_pk_add_f32 v[80:81], v[44:45], v[108:109] neg_lo:[0,1] neg_hi:[0,1]
v_pk_add_f32 v[82:83], v[46:47], v[110:111] neg_lo:[0,1] neg_hi:[0,1]
v_pk_add_f32 v[44:45], v[44:45], v[108:109]
v_pk_add_f32 v[46:47], v[46:47], v[110:111]
v_pk_mul_f32 v[108:109], v[80:81], s[36:37] op_sel_hi:[1,0]
v_pk_mul_f32 v[110:111], v[80:81], s[30:31] op_sel_hi:[1,0] neg_lo:[0,1] neg_hi:[0,1]
v_pk_fma_f32 v[108:109], v[82:83], s[30:31], v[108:109] op_sel_hi:[1,0,1]
v_pk_fma_f32 v[110:111], v[82:83], s[36:37], v[110:111] op_sel_hi:[1,0,1]
v_pk_add_f32 v[80:81], v[50:51], v[114:115] neg_lo:[0,1] neg_hi:[0,1]
v_pk_add_f32 v[82:83], v[112:113], v[48:49] neg_lo:[0,1] neg_hi:[0,1]
v_pk_add_f32 v[48:49], v[48:49], v[112:113]
v_pk_add_f32 v[50:51], v[50:51], v[114:115]
v_pk_add_f32 v[112:113], v[52:53], v[116:117] neg_lo:[0,1] neg_hi:[0,1]
v_pk_add_f32 v[114:115], v[54:55], v[118:119] neg_lo:[0,1] neg_hi:[0,1]
v_pk_add_f32 v[52:53], v[52:53], v[116:117]
v_pk_add_f32 v[54:55], v[54:55], v[118:119]
v_pk_mul_f32 v[116:117], v[112:113], s[36:37] op_sel_hi:[1,0] neg_lo:[0,1] neg_hi:[0,1]
v_pk_mul_f32 v[118:119], v[112:113], s[30:31] op_sel_hi:[1,0] neg_lo:[0,1] neg_hi:[0,1]
v_pk_fma_f32 v[116:117], v[114:115], s[30:31], v[116:117] op_sel_hi:[1,0,1]
v_pk_fma_f32 v[118:119], v[114:115], s[36:37], v[118:119] op_sel_hi:[1,0,1] neg_lo:[0,1,0] neg_hi:[0,1,0]
v_pk_add_f32 v[112:113], v[56:57], v[120:121] neg_lo:[0,1] neg_hi:[0,1]
v_pk_add_f32 v[114:115], v[58:59], v[122:123] neg_lo:[0,1] neg_hi:[0,1]
v_pk_add_f32 v[56:57], v[56:57], v[120:121]
v_pk_add_f32 v[58:59], v[58:59], v[122:123]
v_pk_mul_f32 v[120:121], v[112:113], s[34:35] op_sel:[0,1] neg_lo:[0,1] neg_hi:[0,1]
v_pk_mul_f32 v[122:123], v[112:113], s[30:31] op_sel:[0,1] neg_lo:[0,1] neg_hi:[0,1]
v_pk_fma_f32 v[120:121], v[114:115], s[30:31], v[120:121] op_sel:[0,1,0]
v_pk_fma_f32 v[122:123], v[114:115], s[34:35], v[122:123] op_sel:[0,1,0] neg_lo:[0,1,0] neg_hi:[0,1,0]
v_pk_add_f32 v[112:113], v[60:61], v[124:125] neg_lo:[0,1] neg_hi:[0,1]
v_pk_add_f32 v[114:115], v[62:63], v[126:127] neg_lo:[0,1] neg_hi:[0,1]
v_pk_add_f32 v[60:61], v[60:61], v[124:125]
v_pk_add_f32 v[62:63], v[62:63], v[126:127]
v_pk_mul_f32 v[124:125], v[112:113], s[34:35] op_sel_hi:[1,0] neg_lo:[0,1] neg_hi:[0,1]
v_pk_mul_f32 v[126:127], v[112:113], s[32:33] op_sel_hi:[1,0] neg_lo:[0,1] neg_hi:[0,1]
v_pk_fma_f32 v[124:125], v[114:115], s[32:33], v[124:125] op_sel_hi:[1,0,1]
v_pk_fma_f32 v[126:127], v[114:115], s[34:35], v[126:127] op_sel_hi:[1,0,1] neg_lo:[0,1,0] neg_hi:[0,1,0]
v_pk_add_f32 v[112:113], v[64:65], v[128:129] neg_lo:[0,1] neg_hi:[0,1]
v_pk_add_f32 v[114:115], v[66:67], v[130:131] neg_lo:[0,1] neg_hi:[0,1]
v_pk_add_f32 v[64:65], v[64:65], v[128:129]
v_pk_add_f32 v[66:67], v[66:67], v[130:131]
v_pk_mul_f32 v[128:129], v[112:113], s[32:33] op_sel:[0,1] neg_lo:[0,1] neg_hi:[0,1]
v_pk_mul_f32 v[130:131], v[112:113], s[32:33] op_sel:[0,1] neg_lo:[0,1] neg_hi:[0,1]
v_pk_fma_f32 v[128:129], v[114:115], s[32:33], v[128:129] op_sel:[0,1,0]
v_pk_fma_f32 v[130:131], v[114:115], s[32:33], v[130:131] op_sel:[0,1,0] neg_lo:[0,1,0] neg_hi:[0,1,0]
v_pk_add_f32 v[112:113], v[68:69], v[132:133] neg_lo:[0,1] neg_hi:[0,1]
v_pk_add_f32 v[114:115], v[70:71], v[134:135] neg_lo:[0,1] neg_hi:[0,1]
v_pk_add_f32 v[68:69], v[68:69], v[132:133]
v_pk_add_f32 v[70:71], v[70:71], v[134:135]
v_pk_mul_f32 v[132:133], v[112:113], s[32:33] op_sel_hi:[1,0] neg_lo:[0,1] neg_hi:[0,1]
v_pk_mul_f32 v[134:135], v[112:113], s[34:35] op_sel_hi:[1,0] neg_lo:[0,1] neg_hi:[0,1]
v_pk_fma_f32 v[132:133], v[114:115], s[34:35], v[132:133] op_sel_hi:[1,0,1]
v_pk_fma_f32 v[134:135], v[114:115], s[32:33], v[134:135] op_sel_hi:[1,0,1] neg_lo:[0,1,0] neg_hi:[0,1,0]
v_pk_add_f32 v[112:113], v[72:73], v[136:137] neg_lo:[0,1] neg_hi:[0,1]
v_pk_add_f32 v[114:115], v[74:75], v[138:139] neg_lo:[0,1] neg_hi:[0,1]
v_pk_add_f32 v[72:73], v[72:73], v[136:137]
v_pk_add_f32 v[74:75], v[74:75], v[138:139]
v_pk_mul_f32 v[136:137], v[112:113], s[30:31] op_sel:[0,1] neg_lo:[0,1] neg_hi:[0,1]
v_pk_mul_f32 v[138:139], v[112:113], s[34:35] op_sel:[0,1] neg_lo:[0,1] neg_hi:[0,1]
v_pk_fma_f32 v[136:137], v[114:115], s[34:35], v[136:137] op_sel:[0,1,0]
v_pk_fma_f32 v[138:139], v[114:115], s[30:31], v[138:139] op_sel:[0,1,0] neg_lo:[0,1,0] neg_hi:[0,1,0]
v_pk_add_f32 v[112:113], v[76:77], v[140:141] neg_lo:[0,1] neg_hi:[0,1]
v_pk_add_f32 v[114:115], v[78:79], v[142:143] neg_lo:[0,1] neg_hi:[0,1]
v_pk_add_f32 v[76:77], v[76:77], v[140:141]
v_pk_add_f32 v[78:79], v[78:79], v[142:143]
v_pk_mul_f32 v[140:141], v[112:113], s[30:31] op_sel_hi:[1,0] neg_lo:[0,1] neg_hi:[0,1]
v_pk_mul_f32 v[142:143], v[112:113], s[36:37] op_sel_hi:[1,0] neg_lo:[0,1] neg_hi:[0,1]
v_pk_fma_f32 v[140:141], v[114:115], s[36:37], v[140:141] op_sel_hi:[1,0,1]
v_pk_fma_f32 v[142:143], v[114:115], s[30:31], v[142:143] op_sel_hi:[1,0,1] neg_lo:[0,1,0] neg_hi:[0,1,0]
v_pk_add_f32 v[112:113], v[16:17], v[48:49] neg_lo:[0,1] neg_hi:[0,1]
v_pk_add_f32 v[114:115], v[18:19], v[50:51] neg_lo:[0,1] neg_hi:[0,1]
v_pk_add_f32 v[16:17], v[16:17], v[48:49]
v_pk_add_f32 v[18:19], v[18:19], v[50:51]
v_pk_add_f32 v[48:49], v[20:21], v[52:53] neg_lo:[0,1] neg_hi:[0,1]
v_pk_add_f32 v[50:51], v[22:23], v[54:55] neg_lo:[0,1] neg_hi:[0,1]
v_pk_add_f32 v[20:21], v[20:21], v[52:53]
v_pk_add_f32 v[22:23], v[22:23], v[54:55]
v_pk_mul_f32 v[52:53], v[48:49], s[30:31] op_sel:[0,1]
v_pk_mul_f32 v[54:55], v[48:49], s[34:35] op_sel:[0,1] neg_lo:[0,1] neg_hi:[0,1]
v_pk_fma_f32 v[52:53], v[50:51], s[34:35], v[52:53] op_sel:[0,1,0]
v_pk_fma_f32 v[54:55], v[50:51], s[30:31], v[54:55] op_sel:[0,1,0]
v_pk_add_f32 v[48:49], v[24:25], v[56:57] neg_lo:[0,1] neg_hi:[0,1]
v_pk_add_f32 v[50:51], v[26:27], v[58:59] neg_lo:[0,1] neg_hi:[0,1]
v_pk_add_f32 v[24:25], v[24:25], v[56:57]
v_pk_add_f32 v[26:27], v[26:27], v[58:59]
v_pk_mul_f32 v[56:57], v[48:49], s[32:33] op_sel:[0,1]
v_pk_mul_f32 v[58:59], v[48:49], s[32:33] op_sel:[0,1] neg_lo:[0,1] neg_hi:[0,1]
v_pk_fma_f32 v[56:57], v[50:51], s[32:33], v[56:57] op_sel:[0,1,0]
v_pk_fma_f32 v[58:59], v[50:51], s[32:33], v[58:59] op_sel:[0,1,0]
v_pk_add_f32 v[48:49], v[28:29], v[60:61] neg_lo:[0,1] neg_hi:[0,1]
v_pk_add_f32 v[50:51], v[30:31], v[62:63] neg_lo:[0,1] neg_hi:[0,1]
v_pk_add_f32 v[28:29], v[28:29], v[60:61]
v_pk_add_f32 v[30:31], v[30:31], v[62:63]
v_pk_mul_f32 v[60:61], v[48:49], s[34:35] op_sel:[0,1]
v_pk_mul_f32 v[62:63], v[48:49], s[30:31] op_sel:[0,1] neg_lo:[0,1] neg_hi:[0,1]
v_pk_fma_f32 v[60:61], v[50:51], s[30:31], v[60:61] op_sel:[0,1,0]
v_pk_fma_f32 v[62:63], v[50:51], s[34:35], v[62:63] op_sel:[0,1,0]
v_pk_add_f32 v[48:49], v[34:35], v[66:67] neg_lo:[0,1] neg_hi:[0,1]
v_pk_add_f32 v[50:51], v[64:65], v[32:33] neg_lo:[0,1] neg_hi:[0,1]
v_pk_add_f32 v[32:33], v[32:33], v[64:65]
v_pk_add_f32 v[34:35], v[34:35], v[66:67]
v_pk_add_f32 v[64:65], v[36:37], v[68:69] neg_lo:[0,1] neg_hi:[0,1]
v_pk_add_f32 v[66:67], v[38:39], v[70:71] neg_lo:[0,1] neg_hi:[0,1]
v_pk_add_f32 v[36:37], v[36:37], v[68:69]
v_pk_add_f32 v[38:39], v[38:39], v[70:71]
v_pk_mul_f32 v[68:69], v[64:65], s[34:35] op_sel:[0,1] neg_lo:[0,1] neg_hi:[0,1]
v_pk_mul_f32 v[70:71], v[64:65], s[30:31] op_sel:[0,1] neg_lo:[0,1] neg_hi:[0,1]
v_pk_fma_f32 v[68:69], v[66:67], s[30:31], v[68:69] op_sel:[0,1,0]
v_pk_fma_f32 v[70:71], v[66:67], s[34:35], v[70:71] op_sel:[0,1,0] neg_lo:[0,1,0] neg_hi:[0,1,0]
v_pk_add_f32 v[64:65], v[40:41], v[72:73] neg_lo:[0,1] neg_hi:[0,1]
v_pk_add_f32 v[66:67], v[42:43], v[74:75] neg_lo:[0,1] neg_hi:[0,1]
v_pk_add_f32 v[40:41], v[40:41], v[72:73]
v_pk_add_f32 v[42:43], v[42:43], v[74:75]
v_pk_mul_f32 v[72:73], v[64:65], s[32:33] op_sel:[0,1] neg_lo:[0,1] neg_hi:[0,1]
v_pk_mul_f32 v[74:75], v[64:65], s[32:33] op_sel:[0,1] neg_lo:[0,1] neg_hi:[0,1]
v_pk_fma_f32 v[72:73], v[66:67], s[32:33], v[72:73] op_sel:[0,1,0]
v_pk_fma_f32 v[74:75], v[66:67], s[32:33], v[74:75] op_sel:[0,1,0] neg_lo:[0,1,0] neg_hi:[0,1,0]
v_pk_add_f32 v[64:65], v[44:45], v[76:77] neg_lo:[0,1] neg_hi:[0,1]
v_pk_add_f32 v[66:67], v[46:47], v[78:79] neg_lo:[0,1] neg_hi:[0,1]
v_pk_add_f32 v[44:45], v[44:45], v[76:77]
v_pk_add_f32 v[46:47], v[46:47], v[78:79]
v_pk_mul_f32 v[76:77], v[64:65], s[30:31] op_sel:[0,1] neg_lo:[0,1] neg_hi:[0,1]
v_pk_mul_f32 v[78:79], v[64:65], s[34:35] op_sel:[0,1] neg_lo:[0,1] neg_hi:[0,1]
v_pk_fma_f32 v[76:77], v[66:67], s[34:35], v[76:77] op_sel:[0,1,0]
v_pk_fma_f32 v[78:79], v[66:67], s[30:31], v[78:79] op_sel:[0,1,0] neg_lo:[0,1,0] neg_hi:[0,1,0]
v_pk_add_f32 v[64:65], v[144:145], v[80:81] neg_lo:[0,1] neg_hi:[0,1]
v_pk_add_f32 v[66:67], v[146:147], v[82:83] neg_lo:[0,1] neg_hi:[0,1]
v_pk_add_f32 v[144:145], v[144:145], v[80:81]
v_pk_add_f32 v[146:147], v[146:147], v[82:83]
v_pk_add_f32 v[80:81], v[84:85], v[116:117] neg_lo:[0,1] neg_hi:[0,1]
v_pk_add_f32 v[82:83], v[86:87], v[118:119] neg_lo:[0,1] neg_hi:[0,1]
v_pk_add_f32 v[84:85], v[84:85], v[116:117]
v_pk_add_f32 v[86:87], v[86:87], v[118:119]
v_pk_mul_f32 v[116:117], v[80:81], s[30:31] op_sel:[0,1]
v_pk_mul_f32 v[118:119], v[80:81], s[34:35] op_sel:[0,1] neg_lo:[0,1] neg_hi:[0,1]
v_pk_fma_f32 v[116:117], v[82:83], s[34:35], v[116:117] op_sel:[0,1,0]
v_pk_fma_f32 v[118:119], v[82:83], s[30:31], v[118:119] op_sel:[0,1,0]
v_pk_add_f32 v[80:81], v[88:89], v[120:121] neg_lo:[0,1] neg_hi:[0,1]
v_pk_add_f32 v[82:83], v[90:91], v[122:123] neg_lo:[0,1] neg_hi:[0,1]
v_pk_add_f32 v[88:89], v[88:89], v[120:121]
v_pk_add_f32 v[90:91], v[90:91], v[122:123]
v_pk_mul_f32 v[120:121], v[80:81], s[32:33] op_sel:[0,1]
v_pk_mul_f32 v[122:123], v[80:81], s[32:33] op_sel:[0,1] neg_lo:[0,1] neg_hi:[0,1]
v_pk_fma_f32 v[120:121], v[82:83], s[32:33], v[120:121] op_sel:[0,1,0]
v_pk_fma_f32 v[122:123], v[82:83], s[32:33], v[122:123] op_sel:[0,1,0]
v_pk_add_f32 v[80:81], v[92:93], v[124:125] neg_lo:[0,1] neg_hi:[0,1]
v_pk_add_f32 v[82:83], v[94:95], v[126:127] neg_lo:[0,1] neg_hi:[0,1]
v_pk_add_f32 v[92:93], v[92:93], v[124:125]
v_pk_add_f32 v[94:95], v[94:95], v[126:127]
v_pk_mul_f32 v[124:125], v[80:81], s[34:35] op_sel:[0,1]
v_pk_mul_f32 v[126:127], v[80:81], s[30:31] op_sel:[0,1] neg_lo:[0,1] neg_hi:[0,1]
v_pk_fma_f32 v[124:125], v[82:83], s[30:31], v[124:125] op_sel:[0,1,0]
v_pk_fma_f32 v[126:127], v[82:83], s[34:35], v[126:127] op_sel:[0,1,0]
v_pk_add_f32 v[80:81], v[98:99], v[130:131] neg_lo:[0,1] neg_hi:[0,1]
v_pk_add_f32 v[82:83], v[128:129], v[96:97] neg_lo:[0,1] neg_hi:[0,1]
v_pk_add_f32 v[96:97], v[96:97], v[128:129]
v_pk_add_f32 v[98:99], v[98:99], v[130:131]
v_pk_add_f32 v[128:129], v[100:101], v[132:133] neg_lo:[0,1] neg_hi:[0,1]
v_pk_add_f32 v[130:131], v[102:103], v[134:135] neg_lo:[0,1] neg_hi:[0,1]
v_pk_add_f32 v[100:101], v[100:101], v[132:133]
v_pk_add_f32 v[102:103], v[102:103], v[134:135]
v_pk_mul_f32 v[132:133], v[128:129], s[34:35] op_sel:[0,1] neg_lo:[0,1] neg_hi:[0,1]
v_pk_mul_f32 v[134:135], v[128:129], s[30:31] op_sel:[0,1] neg_lo:[0,1] neg_hi:[0,1]
v_pk_fma_f32 v[132:133], v[130:131], s[30:31], v[132:133] op_sel:[0,1,0]
v_pk_fma_f32 v[134:135], v[130:131], s[34:35], v[134:135] op_sel:[0,1,0] neg_lo:[0,1,0] neg_hi:[0,1,0]
v_pk_add_f32 v[128:129], v[104:105], v[136:137] neg_lo:[0,1] neg_hi:[0,1]
v_pk_add_f32 v[130:131], v[106:107], v[138:139] neg_lo:[0,1] neg_hi:[0,1]
v_pk_add_f32 v[104:105], v[104:105], v[136:137]
v_pk_add_f32 v[106:107], v[106:107], v[138:139]
v_pk_mul_f32 v[136:137], v[128:129], s[32:33] op_sel:[0,1] neg_lo:[0,1] neg_hi:[0,1]
v_pk_mul_f32 v[138:139], v[128:129], s[32:33] op_sel:[0,1] neg_lo:[0,1] neg_hi:[0,1]
v_pk_fma_f32 v[136:137], v[130:131], s[32:33], v[136:137] op_sel:[0,1,0]
v_pk_fma_f32 v[138:139], v[130:131], s[32:33], v[138:139] op_sel:[0,1,0] neg_lo:[0,1,0] neg_hi:[0,1,0]
v_pk_add_f32 v[128:129], v[108:109], v[140:141] neg_lo:[0,1] neg_hi:[0,1]
v_pk_add_f32 v[130:131], v[110:111], v[142:143] neg_lo:[0,1] neg_hi:[0,1]
v_pk_add_f32 v[108:109], v[108:109], v[140:141]
v_pk_add_f32 v[110:111], v[110:111], v[142:143]
v_pk_mul_f32 v[140:141], v[128:129], s[30:31] op_sel:[0,1] neg_lo:[0,1] neg_hi:[0,1]
v_pk_mul_f32 v[142:143], v[128:129], s[34:35] op_sel:[0,1] neg_lo:[0,1] neg_hi:[0,1]
v_pk_fma_f32 v[140:141], v[130:131], s[34:35], v[140:141] op_sel:[0,1,0]
v_pk_fma_f32 v[142:143], v[130:131], s[30:31], v[142:143] op_sel:[0,1,0] neg_lo:[0,1,0] neg_hi:[0,1,0]
v_pk_add_f32 v[128:129], v[16:17], v[32:33] neg_lo:[0,1] neg_hi:[0,1]
v_pk_add_f32 v[130:131], v[18:19], v[34:35] neg_lo:[0,1] neg_hi:[0,1]
v_pk_add_f32 v[16:17], v[16:17], v[32:33]
v_pk_add_f32 v[18:19], v[18:19], v[34:35]
v_pk_add_f32 v[32:33], v[20:21], v[36:37] neg_lo:[0,1] neg_hi:[0,1]
v_pk_add_f32 v[34:35], v[22:23], v[38:39] neg_lo:[0,1] neg_hi:[0,1]
v_pk_add_f32 v[20:21], v[20:21], v[36:37]
v_pk_add_f32 v[22:23], v[22:23], v[38:39]
v_pk_mul_f32 v[36:37], v[32:33], s[32:33] op_sel:[0,1]
v_pk_mul_f32 v[38:39], v[32:33], s[32:33] op_sel:[0,1] neg_lo:[0,1] neg_hi:[0,1]
v_pk_fma_f32 v[36:37], v[34:35], s[32:33], v[36:37] op_sel:[0,1,0]
v_pk_fma_f32 v[38:39], v[34:35], s[32:33], v[38:39] op_sel:[0,1,0]
v_pk_add_f32 v[32:33], v[26:27], v[42:43] neg_lo:[0,1] neg_hi:[0,1]
v_pk_add_f32 v[34:35], v[40:41], v[24:25] neg_lo:[0,1] neg_hi:[0,1]
v_pk_add_f32 v[24:25], v[24:25], v[40:41]
v_pk_add_f32 v[26:27], v[26:27], v[42:43]
v_pk_add_f32 v[40:41], v[28:29], v[44:45] neg_lo:[0,1] neg_hi:[0,1]
v_pk_add_f32 v[42:43], v[30:31], v[46:47] neg_lo:[0,1] neg_hi:[0,1]
v_pk_add_f32 v[28:29], v[28:29], v[44:45]
v_pk_add_f32 v[30:31], v[30:31], v[46:47]
v_pk_mul_f32 v[44:45], v[40:41], s[32:33] op_sel:[0,1] neg_lo:[0,1] neg_hi:[0,1]
v_pk_mul_f32 v[46:47], v[40:41], s[32:33] op_sel:[0,1] neg_lo:[0,1] neg_hi:[0,1]
v_pk_fma_f32 v[44:45], v[42:43], s[32:33], v[44:45] op_sel:[0,1,0]
v_pk_fma_f32 v[46:47], v[42:43], s[32:33], v[46:47] op_sel:[0,1,0] neg_lo:[0,1,0] neg_hi:[0,1,0]
v_pk_add_f32 v[40:41], v[112:113], v[48:49] neg_lo:[0,1] neg_hi:[0,1]
v_pk_add_f32 v[42:43], v[114:115], v[50:51] neg_lo:[0,1] neg_hi:[0,1]
v_pk_add_f32 v[112:113], v[112:113], v[48:49]
v_pk_add_f32 v[114:115], v[114:115], v[50:51]
v_pk_add_f32 v[48:49], v[52:53], v[68:69] neg_lo:[0,1] neg_hi:[0,1]
v_pk_add_f32 v[50:51], v[54:55], v[70:71] neg_lo:[0,1] neg_hi:[0,1]
v_pk_add_f32 v[52:53], v[52:53], v[68:69]
v_pk_add_f32 v[54:55], v[54:55], v[70:71]
v_pk_mul_f32 v[68:69], v[48:49], s[32:33] op_sel:[0,1]
v_pk_mul_f32 v[70:71], v[48:49], s[32:33] op_sel:[0,1] neg_lo:[0,1] neg_hi:[0,1]
v_pk_fma_f32 v[68:69], v[50:51], s[32:33], v[68:69] op_sel:[0,1,0]
v_pk_fma_f32 v[70:71], v[50:51], s[32:33], v[70:71] op_sel:[0,1,0]
v_pk_add_f32 v[48:49], v[58:59], v[74:75] neg_lo:[0,1] neg_hi:[0,1]
v_pk_add_f32 v[50:51], v[72:73], v[56:57] neg_lo:[0,1] neg_hi:[0,1]
v_pk_add_f32 v[56:57], v[56:57], v[72:73]
v_pk_add_f32 v[58:59], v[58:59], v[74:75]
v_pk_add_f32 v[72:73], v[60:61], v[76:77] neg_lo:[0,1] neg_hi:[0,1]
v_pk_add_f32 v[74:75], v[62:63], v[78:79] neg_lo:[0,1] neg_hi:[0,1]
v_pk_add_f32 v[60:61], v[60:61], v[76:77]
v_pk_add_f32 v[62:63], v[62:63], v[78:79]
v_pk_mul_f32 v[76:77], v[72:73], s[32:33] op_sel:[0,1] neg_lo:[0,1] neg_hi:[0,1]
v_pk_mul_f32 v[78:79], v[72:73], s[32:33] op_sel:[0,1] neg_lo:[0,1] neg_hi:[0,1]
v_pk_fma_f32 v[76:77], v[74:75], s[32:33], v[76:77] op_sel:[0,1,0]
v_pk_fma_f32 v[78:79], v[74:75], s[32:33], v[78:79] op_sel:[0,1,0] neg_lo:[0,1,0] neg_hi:[0,1,0]
v_pk_add_f32 v[72:73], v[144:145], v[96:97] neg_lo:[0,1] neg_hi:[0,1]
v_pk_add_f32 v[74:75], v[146:147], v[98:99] neg_lo:[0,1] neg_hi:[0,1]
v_pk_add_f32 v[144:145], v[144:145], v[96:97]
v_pk_add_f32 v[146:147], v[146:147], v[98:99]
v_pk_add_f32 v[96:97], v[84:85], v[100:101] neg_lo:[0,1] neg_hi:[0,1]
v_pk_add_f32 v[98:99], v[86:87], v[102:103] neg_lo:[0,1] neg_hi:[0,1]
v_pk_add_f32 v[84:85], v[84:85], v[100:101]
v_pk_add_f32 v[86:87], v[86:87], v[102:103]
v_pk_mul_f32 v[100:101], v[96:97], s[32:33] op_sel:[0,1]
v_pk_mul_f32 v[102:103], v[96:97], s[32:33] op_sel:[0,1] neg_lo:[0,1] neg_hi:[0,1]
v_pk_fma_f32 v[100:101], v[98:99], s[32:33], v[100:101] op_sel:[0,1,0]
v_pk_fma_f32 v[102:103], v[98:99], s[32:33], v[102:103] op_sel:[0,1,0]
v_pk_add_f32 v[96:97], v[90:91], v[106:107] neg_lo:[0,1] neg_hi:[0,1]
v_pk_add_f32 v[98:99], v[104:105], v[88:89] neg_lo:[0,1] neg_hi:[0,1]
v_pk_add_f32 v[88:89], v[88:89], v[104:105]
v_pk_add_f32 v[90:91], v[90:91], v[106:107]
v_pk_add_f32 v[104:105], v[92:93], v[108:109] neg_lo:[0,1] neg_hi:[0,1]
v_pk_add_f32 v[106:107], v[94:95], v[110:111] neg_lo:[0,1] neg_hi:[0,1]
v_pk_add_f32 v[92:93], v[92:93], v[108:109]
v_pk_add_f32 v[94:95], v[94:95], v[110:111]
v_pk_mul_f32 v[108:109], v[104:105], s[32:33] op_sel:[0,1] neg_lo:[0,1] neg_hi:[0,1]
v_pk_mul_f32 v[110:111], v[104:105], s[32:33] op_sel:[0,1] neg_lo:[0,1] neg_hi:[0,1]
v_pk_fma_f32 v[108:109], v[106:107], s[32:33], v[108:109] op_sel:[0,1,0]
v_pk_fma_f32 v[110:111], v[106:107], s[32:33], v[110:111] op_sel:[0,1,0] neg_lo:[0,1,0] neg_hi:[0,1,0]
v_pk_add_f32 v[104:105], v[64:65], v[80:81] neg_lo:[0,1] neg_hi:[0,1]
v_pk_add_f32 v[106:107], v[66:67], v[82:83] neg_lo:[0,1] neg_hi:[0,1]
v_pk_add_f32 v[64:65], v[64:65], v[80:81]
v_pk_add_f32 v[66:67], v[66:67], v[82:83]
v_pk_add_f32 v[80:81], v[116:117], v[132:133] neg_lo:[0,1] neg_hi:[0,1]
v_pk_add_f32 v[82:83], v[118:119], v[134:135] neg_lo:[0,1] neg_hi:[0,1]
v_pk_add_f32 v[116:117], v[116:117], v[132:133]
v_pk_add_f32 v[118:119], v[118:119], v[134:135]
v_pk_mul_f32 v[132:133], v[80:81], s[32:33] op_sel:[0,1]
v_pk_mul_f32 v[134:135], v[80:81], s[32:33] op_sel:[0,1] neg_lo:[0,1] neg_hi:[0,1]
v_pk_fma_f32 v[132:133], v[82:83], s[32:33], v[132:133] op_sel:[0,1,0]
v_pk_fma_f32 v[134:135], v[82:83], s[32:33], v[134:135] op_sel:[0,1,0]
v_pk_add_f32 v[80:81], v[122:123], v[138:139] neg_lo:[0,1] neg_hi:[0,1]
v_pk_add_f32 v[82:83], v[136:137], v[120:121] neg_lo:[0,1] neg_hi:[0,1]
v_pk_add_f32 v[120:121], v[120:121], v[136:137]
v_pk_add_f32 v[122:123], v[122:123], v[138:139]
v_pk_add_f32 v[136:137], v[124:125], v[140:141] neg_lo:[0,1] neg_hi:[0,1]
v_pk_add_f32 v[138:139], v[126:127], v[142:143] neg_lo:[0,1] neg_hi:[0,1]
v_pk_add_f32 v[124:125], v[124:125], v[140:141]
v_pk_add_f32 v[126:127], v[126:127], v[142:143]
v_pk_mul_f32 v[140:141], v[136:137], s[32:33] op_sel:[0,1] neg_lo:[0,1] neg_hi:[0,1]
v_pk_mul_f32 v[142:143], v[136:137], s[32:33] op_sel:[0,1] neg_lo:[0,1] neg_hi:[0,1]
v_pk_fma_f32 v[140:141], v[138:139], s[32:33], v[140:141] op_sel:[0,1,0]
v_pk_fma_f32 v[142:143], v[138:139], s[32:33], v[142:143] op_sel:[0,1,0] neg_lo:[0,1,0] neg_hi:[0,1,0]
v_pk_add_f32 v[136:137], v[16:17], v[24:25] neg_lo:[0,1] neg_hi:[0,1]
v_pk_add_f32 v[138:139], v[18:19], v[26:27] neg_lo:[0,1] neg_hi:[0,1]
v_pk_add_f32 v[16:17], v[16:17], v[24:25]
v_pk_add_f32 v[18:19], v[18:19], v[26:27]
v_pk_add_f32 v[24:25], v[22:23], v[30:31] neg_lo:[0,1] neg_hi:[0,1]
v_pk_add_f32 v[26:27], v[28:29], v[20:21] neg_lo:[0,1] neg_hi:[0,1]
v_pk_add_f32 v[20:21], v[20:21], v[28:29]
v_pk_add_f32 v[22:23], v[22:23], v[30:31]
v_pk_add_f32 v[28:29], v[128:129], v[32:33] neg_lo:[0,1] neg_hi:[0,1]
v_pk_add_f32 v[30:31], v[130:131], v[34:35] neg_lo:[0,1] neg_hi:[0,1]
v_pk_add_f32 v[128:129], v[128:129], v[32:33]
v_pk_add_f32 v[130:131], v[130:131], v[34:35]
v_pk_add_f32 v[32:33], v[38:39], v[46:47] neg_lo:[0,1] neg_hi:[0,1]
v_pk_add_f32 v[34:35], v[44:45], v[36:37] neg_lo:[0,1] neg_hi:[0,1]
v_pk_add_f32 v[36:37], v[36:37], v[44:45]
v_pk_add_f32 v[38:39], v[38:39], v[46:47]
v_pk_add_f32 v[44:45], v[112:113], v[56:57] neg_lo:[0,1] neg_hi:[0,1]
v_pk_add_f32 v[46:47], v[114:115], v[58:59] neg_lo:[0,1] neg_hi:[0,1]
v_pk_add_f32 v[112:113], v[112:113], v[56:57]
v_pk_add_f32 v[114:115], v[114:115], v[58:59]
v_pk_add_f32 v[56:57], v[54:55], v[62:63] neg_lo:[0,1] neg_hi:[0,1]
v_pk_add_f32 v[58:59], v[60:61], v[52:53] neg_lo:[0,1] neg_hi:[0,1]
v_pk_add_f32 v[52:53], v[52:53], v[60:61]
v_pk_add_f32 v[54:55], v[54:55], v[62:63]
v_pk_add_f32 v[60:61], v[40:41], v[48:49] neg_lo:[0,1] neg_hi:[0,1]
v_pk_add_f32 v[62:63], v[42:43], v[50:51] neg_lo:[0,1] neg_hi:[0,1]
v_pk_add_f32 v[40:41], v[40:41], v[48:49]
v_pk_add_f32 v[42:43], v[42:43], v[50:51]
v_pk_add_f32 v[48:49], v[70:71], v[78:79] neg_lo:[0,1] neg_hi:[0,1]
v_pk_add_f32 v[50:51], v[76:77], v[68:69] neg_lo:[0,1] neg_hi:[0,1]
v_pk_add_f32 v[68:69], v[68:69], v[76:77]
v_pk_add_f32 v[70:71], v[70:71], v[78:79]
v_pk_add_f32 v[76:77], v[144:145], v[88:89] neg_lo:[0,1] neg_hi:[0,1]
v_pk_add_f32 v[78:79], v[146:147], v[90:91] neg_lo:[0,1] neg_hi:[0,1]
v_pk_add_f32 v[144:145], v[144:145], v[88:89]
v_pk_add_f32 v[146:147], v[146:147], v[90:91]
v_pk_add_f32 v[88:89], v[86:87], v[94:95] neg_lo:[0,1] neg_hi:[0,1]
v_pk_add_f32 v[90:91], v[92:93], v[84:85] neg_lo:[0,1] neg_hi:[0,1]
v_pk_add_f32 v[84:85], v[84:85], v[92:93]
v_pk_add_f32 v[86:87], v[86:87], v[94:95]
v_pk_add_f32 v[92:93], v[72:73], v[96:97] neg_lo:[0,1] neg_hi:[0,1]
v_pk_add_f32 v[94:95], v[74:75], v[98:99] neg_lo:[0,1] neg_hi:[0,1]
v_pk_add_f32 v[72:73], v[72:73], v[96:97]
v_pk_add_f32 v[74:75], v[74:75], v[98:99]
v_pk_add_f32 v[96:97], v[102:103], v[110:111] neg_lo:[0,1] neg_hi:[0,1]
v_pk_add_f32 v[98:99], v[108:109], v[100:101] neg_lo:[0,1] neg_hi:[0,1]
v_pk_add_f32 v[100:101], v[100:101], v[108:109]
v_pk_add_f32 v[102:103], v[102:103], v[110:111]
v_pk_add_f32 v[108:109], v[64:65], v[120:121] neg_lo:[0,1] neg_hi:[0,1]
v_pk_add_f32 v[110:111], v[66:67], v[122:123] neg_lo:[0,1] neg_hi:[0,1]
v_pk_add_f32 v[64:65], v[64:65], v[120:121]
v_pk_add_f32 v[66:67], v[66:67], v[122:123]
v_pk_add_f32 v[120:121], v[118:119], v[126:127] neg_lo:[0,1] neg_hi:[0,1]
v_pk_add_f32 v[122:123], v[124:125], v[116:117] neg_lo:[0,1] neg_hi:[0,1]
v_pk_add_f32 v[116:117], v[116:117], v[124:125]
v_pk_add_f32 v[118:119], v[118:119], v[126:127]
v_pk_add_f32 v[124:125], v[104:105], v[80:81] neg_lo:[0,1] neg_hi:[0,1]
v_pk_add_f32 v[126:127], v[106:107], v[82:83] neg_lo:[0,1] neg_hi:[0,1]
v_pk_add_f32 v[104:105], v[104:105], v[80:81]
v_pk_add_f32 v[106:107], v[106:107], v[82:83]
v_pk_add_f32 v[80:81], v[134:135], v[142:143] neg_lo:[0,1] neg_hi:[0,1]
v_pk_add_f32 v[82:83], v[140:141], v[132:133] neg_lo:[0,1] neg_hi:[0,1]
v_pk_add_f32 v[132:133], v[132:133], v[140:141]
v_pk_add_f32 v[134:135], v[134:135], v[142:143]
v_pk_add_f32 v[140:141], v[16:17], v[20:21] neg_lo:[0,1] neg_hi:[0,1]
v_pk_add_f32 v[142:143], v[18:19], v[22:23] neg_lo:[0,1] neg_hi:[0,1]
v_pk_add_f32 v[16:17], v[16:17], v[20:21]
v_pk_add_f32 v[18:19], v[18:19], v[22:23]
v_pk_add_f32 v[20:21], v[136:137], v[24:25] neg_lo:[0,1] neg_hi:[0,1]
v_pk_add_f32 v[22:23], v[138:139], v[26:27] neg_lo:[0,1] neg_hi:[0,1]
v_pk_add_f32 v[136:137], v[136:137], v[24:25]
v_pk_add_f32 v[138:139], v[138:139], v[26:27]
v_pk_add_f32 v[24:25], v[128:129], v[36:37] neg_lo:[0,1] neg_hi:[0,1]
v_pk_add_f32 v[26:27], v[130:131], v[38:39] neg_lo:[0,1] neg_hi:[0,1]
v_pk_add_f32 v[128:129], v[128:129], v[36:37]
v_pk_add_f32 v[130:131], v[130:131], v[38:39]
v_pk_add_f32 v[36:37], v[28:29], v[32:33] neg_lo:[0,1] neg_hi:[0,1]
v_pk_add_f32 v[38:39], v[30:31], v[34:35] neg_lo:[0,1] neg_hi:[0,1]
v_pk_add_f32 v[28:29], v[28:29], v[32:33]
v_pk_add_f32 v[30:31], v[30:31], v[34:35]
v_pk_add_f32 v[32:33], v[112:113], v[52:53] neg_lo:[0,1] neg_hi:[0,1]
v_pk_add_f32 v[34:35], v[114:115], v[54:55] neg_lo:[0,1] neg_hi:[0,1]
v_pk_add_f32 v[112:113], v[112:113], v[52:53]
v_pk_add_f32 v[114:115], v[114:115], v[54:55]
v_pk_add_f32 v[52:53], v[44:45], v[56:57] neg_lo:[0,1] neg_hi:[0,1]
v_pk_add_f32 v[54:55], v[46:47], v[58:59] neg_lo:[0,1] neg_hi:[0,1]
v_pk_add_f32 v[44:45], v[44:45], v[56:57]
v_pk_add_f32 v[46:47], v[46:47], v[58:59]
v_pk_add_f32 v[56:57], v[40:41], v[68:69] neg_lo:[0,1] neg_hi:[0,1]
v_pk_add_f32 v[58:59], v[42:43], v[70:71] neg_lo:[0,1] neg_hi:[0,1]
v_pk_add_f32 v[40:41], v[40:41], v[68:69]
v_pk_add_f32 v[42:43], v[42:43], v[70:71]
v_pk_add_f32 v[68:69], v[60:61], v[48:49] neg_lo:[0,1] neg_hi:[0,1]
v_pk_add_f32 v[70:71], v[62:63], v[50:51] neg_lo:[0,1] neg_hi:[0,1]
v_pk_add_f32 v[60:61], v[60:61], v[48:49]
v_pk_add_f32 v[62:63], v[62:63], v[50:51]
v_pk_add_f32 v[48:49], v[144:145], v[84:85] neg_lo:[0,1] neg_hi:[0,1]
v_pk_add_f32 v[50:51], v[146:147], v[86:87] neg_lo:[0,1] neg_hi:[0,1]
v_pk_add_f32 v[144:145], v[144:145], v[84:85]
v_pk_add_f32 v[146:147], v[146:147], v[86:87]
v_pk_add_f32 v[84:85], v[76:77], v[88:89] neg_lo:[0,1] neg_hi:[0,1]
v_pk_add_f32 v[86:87], v[78:79], v[90:91] neg_lo:[0,1] neg_hi:[0,1]
v_pk_add_f32 v[76:77], v[76:77], v[88:89]
v_pk_add_f32 v[78:79], v[78:79], v[90:91]
v_pk_add_f32 v[88:89], v[72:73], v[100:101] neg_lo:[0,1] neg_hi:[0,1]
v_pk_add_f32 v[90:91], v[74:75], v[102:103] neg_lo:[0,1] neg_hi:[0,1]
v_pk_add_f32 v[72:73], v[72:73], v[100:101]
v_pk_add_f32 v[74:75], v[74:75], v[102:103]
v_pk_add_f32 v[100:101], v[92:93], v[96:97] neg_lo:[0,1] neg_hi:[0,1]
v_pk_add_f32 v[102:103], v[94:95], v[98:99] neg_lo:[0,1] neg_hi:[0,1]
v_pk_add_f32 v[92:93], v[92:93], v[96:97]
v_pk_add_f32 v[94:95], v[94:95], v[98:99]
v_pk_add_f32 v[96:97], v[64:65], v[116:117] neg_lo:[0,1] neg_hi:[0,1]
v_pk_add_f32 v[98:99], v[66:67], v[118:119] neg_lo:[0,1] neg_hi:[0,1]
v_pk_add_f32 v[64:65], v[64:65], v[116:117]
v_pk_add_f32 v[66:67], v[66:67], v[118:119]
v_pk_add_f32 v[116:117], v[108:109], v[120:121] neg_lo:[0,1] neg_hi:[0,1]
v_pk_add_f32 v[118:119], v[110:111], v[122:123] neg_lo:[0,1] neg_hi:[0,1]
v_pk_add_f32 v[108:109], v[108:109], v[120:121]
v_pk_add_f32 v[110:111], v[110:111], v[122:123]
v_pk_add_f32 v[120:121], v[104:105], v[132:133] neg_lo:[0,1] neg_hi:[0,1]
v_pk_add_f32 v[122:123], v[106:107], v[134:135] neg_lo:[0,1] neg_hi:[0,1]
v_pk_add_f32 v[104:105], v[104:105], v[132:133]
v_pk_add_f32 v[106:107], v[106:107], v[134:135]
v_pk_add_f32 v[132:133], v[124:125], v[80:81] neg_lo:[0,1] neg_hi:[0,1]
v_pk_add_f32 v[134:135], v[126:127], v[82:83] neg_lo:[0,1] neg_hi:[0,1]
v_pk_add_f32 v[124:125], v[124:125], v[80:81]
v_pk_add_f32 v[126:127], v[126:127], v[82:83]
v_mul_f32 v151, 0xbc800000, v9
v_cos_f32 v150, v151
v_sin_f32 v151, v151
v_mul_f32 v149, 0xbd000000, v9
v_cos_f32 v148, v149
v_sin_f32 v149, v149
v_pk_mul_f32 v[80:81], v[144:145], v[150:151] op_sel_hi:[1,0]
v_pk_fma_f32 v[80:81], v[146:147], v[150:151], v[80:81] op_sel:[0,1,0] neg_lo:[1,0,0] neg_hi:[1,0,0]
v_pk_mul_f32 v[146:147], v[146:147], v[150:151] op_sel_hi:[1,0]
v_pk_fma_f32 v[146:147], v[144:145], v[150:151], v[146:147] op_sel:[0,1,0]
v_mul_f32 v151, 0xbd400000, v9
v_cos_f32 v150, v151
v_sin_f32 v151, v151
v_pk_mul_f32 v[144:145], v[112:113], v[148:149] op_sel_hi:[1,0]
v_pk_fma_f32 v[144:145], v[114:115], v[148:149], v[144:145] op_sel:[0,1,0] neg_lo:[1,0,0] neg_hi:[1,0,0]
v_pk_mul_f32 v[114:115], v[114:115], v[148:149] op_sel_hi:[1,0]
v_pk_fma_f32 v[114:115], v[112:113], v[148:149], v[114:115] op_sel:[0,1,0]
v_mul_f32 v149, 0xbd800000, v9
v_cos_f32 v148, v149
v_sin_f32 v149, v149
v_pk_mul_f32 v[112:113], v[64:65], v[150:151] op_sel_hi:[1,0]
v_pk_fma_f32 v[112:113], v[66:67], v[150:151], v[112:113] op_sel:[0,1,0] neg_lo:[1,0,0] neg_hi:[1,0,0]
v_pk_mul_f32 v[66:67], v[66:67], v[150:151] op_sel_hi:[1,0]
v_pk_fma_f32 v[66:67], v[64:65], v[150:151], v[66:67] op_sel:[0,1,0]
v_mul_f32 v151, 0xbda00000, v9
v_cos_f32 v150, v151
v_sin_f32 v151, v151
v_pk_mul_f32 v[64:65], v[128:129], v[148:149] op_sel_hi:[1,0]
v_pk_fma_f32 v[64:65], v[130:131], v[148:149], v[64:65] op_sel:[0,1,0] neg_lo:[1,0,0] neg_hi:[1,0,0]
v_pk_mul_f32 v[130:131], v[130:131], v[148:149] op_sel_hi:[1,0]
v_pk_fma_f32 v[130:131], v[128:129], v[148:149], v[130:131] op_sel:[0,1,0]
v_mul_f32 v149, 0xbdc00000, v9
v_cos_f32 v148, v149
v_sin_f32 v149, v149
v_pk_mul_f32 v[128:129], v[72:73], v[150:151] op_sel_hi:[1,0]
v_pk_fma_f32 v[128:129], v[74:75], v[150:151], v[128:129] op_sel:[0,1,0] neg_lo:[1,0,0] neg_hi:[1,0,0]
v_pk_mul_f32 v[74:75], v[74:75], v[150:151] op_sel_hi:[1,0]
v_pk_fma_f32 v[74:75], v[72:73], v[150:151], v[74:75] op_sel:[0,1,0]
v_mul_f32 v151, 0xbde00000, v9
v_cos_f32 v150, v151
v_sin_f32 v151, v151
v_pk_mul_f32 v[72:73], v[40:41], v[148:149] op_sel_hi:[1,0]
v_pk_fma_f32 v[72:73], v[42:43], v[148:149], v[72:73] op_sel:[0,1,0] neg_lo:[1,0,0] neg_hi:[1,0,0]
v_pk_mul_f32 v[42:43], v[42:43], v[148:149] op_sel_hi:[1,0]
v_pk_fma_f32 v[42:43], v[40:41], v[148:149], v[42:43] op_sel:[0,1,0]
v_mul_f32 v149, 0xbe000000, v9
v_cos_f32 v148, v149
v_sin_f32 v149, v149
v_pk_mul_f32 v[40:41], v[104:105], v[150:151] op_sel_hi:[1,0]
v_pk_fma_f32 v[40:41], v[106:107], v[150:151], v[40:41] op_sel:[0,1,0] neg_lo:[1,0,0] neg_hi:[1,0,0]
v_pk_mul_f32 v[106:107], v[106:107], v[150:151] op_sel_hi:[1,0]
v_pk_fma_f32 v[106:107], v[104:105], v[150:151], v[106:107] op_sel:[0,1,0]
v_mul_f32 v151, 0xbe100000, v9
v_cos_f32 v150, v151
v_sin_f32 v151, v151
v_pk_mul_f32 v[104:105], v[136:137], v[148:149] op_sel_hi:[1,0]
v_pk_fma_f32 v[104:105], v[138:139], v[148:149], v[104:105] op_sel:[0,1,0] neg_lo:[1,0,0] neg_hi:[1,0,0]
v_pk_mul_f32 v[138:139], v[138:139], v[148:149] op_sel_hi:[1,0]
v_pk_fma_f32 v[138:139], v[136:137], v[148:149], v[138:139] op_sel:[0,1,0]
v_mul_f32 v149, 0xbe200000, v9
v_cos_f32 v148, v149
v_sin_f32 v149, v149
v_pk_mul_f32 v[136:137], v[76:77], v[150:151] op_sel_hi:[1,0]
v_pk_fma_f32 v[136:137], v[78:79], v[150:151], v[136:137] op_sel:[0,1,0] neg_lo:[1,0,0] neg_hi:[1,0,0]
v_pk_mul_f32 v[78:79], v[78:79], v[150:151] op_sel_hi:[1,0]
v_pk_fma_f32 v[78:79], v[76:77], v[150:151], v[78:79] op_sel:[0,1,0]
v_mul_f32 v151, 0xbe300000, v9
v_cos_f32 v150, v151
v_sin_f32 v151, v151
v_pk_mul_f32 v[76:77], v[44:45], v[148:149] op_sel_hi:[1,0]
v_pk_fma_f32 v[76:77], v[46:47], v[148:149], v[76:77] op_sel:[0,1,0] neg_lo:[1,0,0] neg_hi:[1,0,0]
v_pk_mul_f32 v[46:47], v[46:47], v[148:149] op_sel_hi:[1,0]
v_pk_fma_f32 v[46:47], v[44:45], v[148:149], v[46:47] op_sel:[0,1,0]
v_mul_f32 v149, 0xbe400000, v9
v_cos_f32 v148, v149
v_sin_f32 v149, v149
v_pk_mul_f32 v[44:45], v[108:109], v[150:151] op_sel_hi:[1,0]
v_pk_fma_f32 v[44:45], v[110:111], v[150:151], v[44:45] op_sel:[0,1,0] neg_lo:[1,0,0] neg_hi:[1,0,0]
v_pk_mul_f32 v[110:111], v[110:111], v[150:151] op_sel_hi:[1,0]
v_pk_fma_f32 v[110:111], v[108:109], v[150:151], v[110:111] op_sel:[0,1,0]
v_mul_f32 v151, 0xbe500000, v9
v_cos_f32 v150, v151
v_sin_f32 v151, v151
v_pk_mul_f32 v[108:109], v[28:29], v[148:149] op_sel_hi:[1,0]
v_pk_fma_f32 v[108:109], v[30:31], v[148:149], v[108:109] op_sel:[0,1,0] neg_lo:[1,0,0] neg_hi:[1,0,0]
v_pk_mul_f32 v[30:31], v[30:31], v[148:149] op_sel_hi:[1,0]
v_pk_fma_f32 v[30:31], v[28:29], v[148:149], v[30:31] op_sel:[0,1,0]
v_mul_f32 v149, 0xbe600000, v9
v_cos_f32 v148, v149
v_sin_f32 v149, v149
v_pk_mul_f32 v[28:29], v[92:93], v[150:151] op_sel_hi:[1,0]
v_pk_fma_f32 v[28:29], v[94:95], v[150:151], v[28:29] op_sel:[0,1,0] neg_lo:[1,0,0] neg_hi:[1,0,0]
v_pk_mul_f32 v[94:95], v[94:95], v[150:151] op_sel_hi:[1,0]
v_pk_fma_f32 v[94:95], v[92:93], v[150:151], v[94:95] op_sel:[0,1,0]
v_mul_f32 v151, 0xbe700000, v9
v_cos_f32 v150, v151
v_sin_f32 v151, v151
v_pk_mul_f32 v[92:93], v[60:61], v[148:149] op_sel_hi:[1,0]
v_pk_fma_f32 v[92:93], v[62:63], v[148:149], v[92:93] op_sel:[0,1,0] neg_lo:[1,0,0] neg_hi:[1,0,0]
v_pk_mul_f32 v[62:63], v[62:63], v[148:149] op_sel_hi:[1,0]
v_pk_fma_f32 v[62:63], v[60:61], v[148:149], v[62:63] op_sel:[0,1,0]
v_mul_f32 v149, 0xbe800000, v9
v_cos_f32 v148, v149
v_sin_f32 v149, v149
v_pk_mul_f32 v[60:61], v[124:125], v[150:151] op_sel_hi:[1,0]
v_pk_fma_f32 v[60:61], v[126:127], v[150:151], v[60:61] op_sel:[0,1,0] neg_lo:[1,0,0] neg_hi:[1,0,0]
v_pk_mul_f32 v[126:127], v[126:127], v[150:151] op_sel_hi:[1,0]
v_pk_fma_f32 v[126:127], v[124:125], v[150:151], v[126:127] op_sel:[0,1,0]
v_mul_f32 v151, 0xbe880000, v9
v_cos_f32 v150, v151
v_sin_f32 v151, v151
v_pk_mul_f32 v[124:125], v[140:141], v[148:149] op_sel_hi:[1,0]
v_pk_fma_f32 v[124:125], v[142:143], v[148:149], v[124:125] op_sel:[0,1,0] neg_lo:[1,0,0] neg_hi:[1,0,0]
v_pk_mul_f32 v[142:143], v[142:143], v[148:149] op_sel_hi:[1,0]
v_pk_fma_f32 v[142:143], v[140:141], v[148:149], v[142:143] op_sel:[0,1,0]
v_mul_f32 v149, 0xbe900000, v9
v_cos_f32 v148, v149
v_sin_f32 v149, v149
v_pk_mul_f32 v[140:141], v[48:49], v[150:151] op_sel_hi:[1,0]
v_pk_fma_f32 v[140:141], v[50:51], v[150:151], v[140:141] op_sel:[0,1,0] neg_lo:[1,0,0] neg_hi:[1,0,0]
v_pk_mul_f32 v[50:51], v[50:51], v[150:151] op_sel_hi:[1,0]
v_pk_fma_f32 v[50:51], v[48:49], v[150:151], v[50:51] op_sel:[0,1,0]
v_mul_f32 v151, 0xbe980000, v9
v_cos_f32 v150, v151
v_sin_f32 v151, v151
v_pk_mul_f32 v[48:49], v[32:33], v[148:149] op_sel_hi:[1,0]
v_pk_fma_f32 v[48:49], v[34:35], v[148:149], v[48:49] op_sel:[0,1,0] neg_lo:[1,0,0] neg_hi:[1,0,0]
v_pk_mul_f32 v[34:35], v[34:35], v[148:149] op_sel_hi:[1,0]
v_pk_fma_f32 v[34:35], v[32:33], v[148:149], v[34:35] op_sel:[0,1,0]
v_mul_f32 v149, 0xbea00000, v9
v_cos_f32 v148, v149
v_sin_f32 v149, v149
v_pk_mul_f32 v[32:33], v[96:97], v[150:151] op_sel_hi:[1,0]
v_pk_fma_f32 v[32:33], v[98:99], v[150:151], v[32:33] op_sel:[0,1,0] neg_lo:[1,0,0] neg_hi:[1,0,0]
v_pk_mul_f32 v[98:99], v[98:99], v[150:151] op_sel_hi:[1,0]
v_pk_fma_f32 v[98:99], v[96:97], v[150:151], v[98:99] op_sel:[0,1,0]
v_mul_f32 v151, 0xbea80000, v9
v_cos_f32 v150, v151
v_sin_f32 v151, v151
v_pk_mul_f32 v[96:97], v[24:25], v[148:149] op_sel_hi:[1,0]
v_pk_fma_f32 v[96:97], v[26:27], v[148:149], v[96:97] op_sel:[0,1,0] neg_lo:[1,0,0] neg_hi:[1,0,0]
v_pk_mul_f32 v[26:27], v[26:27], v[148:149] op_sel_hi:[1,0]
v_pk_fma_f32 v[26:27], v[24:25], v[148:149], v[26:27] op_sel:[0,1,0]
v_mul_f32 v149, 0xbeb00000, v9
v_cos_f32 v148, v149
v_sin_f32 v149, v149
v_pk_mul_f32 v[24:25], v[88:89], v[150:151] op_sel_hi:[1,0]
v_pk_fma_f32 v[24:25], v[90:91], v[150:151], v[24:25] op_sel:[0,1,0] neg_lo:[1,0,0] neg_hi:[1,0,0]
v_pk_mul_f32 v[90:91], v[90:91], v[150:151] op_sel_hi:[1,0]
v_pk_fma_f32 v[90:91], v[88:89], v[150:151], v[90:91] op_sel:[0,1,0]
v_mul_f32 v151, 0xbeb80000, v9
v_cos_f32 v150, v151
v_sin_f32 v151, v151
v_pk_mul_f32 v[88:89], v[56:57], v[148:149] op_sel_hi:[1,0]
v_pk_fma_f32 v[88:89], v[58:59], v[148:149], v[88:89] op_sel:[0,1,0] neg_lo:[1,0,0] neg_hi:[1,0,0]
v_pk_mul_f32 v[58:59], v[58:59], v[148:149] op_sel_hi:[1,0]
v_pk_fma_f32 v[58:59], v[56:57], v[148:149], v[58:59] op_sel:[0,1,0]
v_mul_f32 v149, 0xbec00000, v9
v_cos_f32 v148, v149
v_sin_f32 v149, v149
v_pk_mul_f32 v[56:57], v[120:121], v[150:151] op_sel_hi:[1,0]
v_pk_fma_f32 v[56:57], v[122:123], v[150:151], v[56:57] op_sel:[0,1,0] neg_lo:[1,0,0] neg_hi:[1,0,0]
v_pk_mul_f32 v[122:123], v[122:123], v[150:151] op_sel_hi:[1,0]
v_pk_fma_f32 v[122:123], v[120:121], v[150:151], v[122:123] op_sel:[0,1,0]
v_mul_f32 v151, 0xbec80000, v9
v_cos_f32 v150, v151
v_sin_f32 v151, v151
v_pk_mul_f32 v[120:121], v[20:21], v[148:149] op_sel_hi:[1,0]
v_pk_fma_f32 v[120:121], v[22:23], v[148:149], v[120:121] op_sel:[0,1,0] neg_lo:[1,0,0] neg_hi:[1,0,0]
v_pk_mul_f32 v[22:23], v[22:23], v[148:149] op_sel_hi:[1,0]
v_pk_fma_f32 v[22:23], v[20:21], v[148:149], v[22:23] op_sel:[0,1,0]
v_mul_f32 v149, 0xbed00000, v9
v_cos_f32 v148, v149
v_sin_f32 v149, v149
v_pk_mul_f32 v[20:21], v[84:85], v[150:151] op_sel_hi:[1,0]
v_pk_fma_f32 v[20:21], v[86:87], v[150:151], v[20:21] op_sel:[0,1,0] neg_lo:[1,0,0] neg_hi:[1,0,0]
v_pk_mul_f32 v[86:87], v[86:87], v[150:151] op_sel_hi:[1,0]
v_pk_fma_f32 v[86:87], v[84:85], v[150:151], v[86:87] op_sel:[0,1,0]
v_mul_f32 v151, 0xbed80000, v9
v_cos_f32 v150, v151
v_sin_f32 v151, v151
v_pk_mul_f32 v[84:85], v[52:53], v[148:149] op_sel_hi:[1,0]
v_pk_fma_f32 v[84:85], v[54:55], v[148:149], v[84:85] op_sel:[0,1,0] neg_lo:[1,0,0] neg_hi:[1,0,0]
v_pk_mul_f32 v[54:55], v[54:55], v[148:149] op_sel_hi:[1,0]
v_pk_fma_f32 v[54:55], v[52:53], v[148:149], v[54:55] op_sel:[0,1,0]
v_mul_f32 v149, 0xbee00000, v9
v_cos_f32 v148, v149
v_sin_f32 v149, v149
v_pk_mul_f32 v[52:53], v[116:117], v[150:151] op_sel_hi:[1,0]
v_pk_fma_f32 v[52:53], v[118:119], v[150:151], v[52:53] op_sel:[0,1,0] neg_lo:[1,0,0] neg_hi:[1,0,0]
v_pk_mul_f32 v[118:119], v[118:119], v[150:151] op_sel_hi:[1,0]
v_pk_fma_f32 v[118:119], v[116:117], v[150:151], v[118:119] op_sel:[0,1,0]
v_mul_f32 v151, 0xbee80000, v9
v_cos_f32 v150, v151
v_sin_f32 v151, v151
v_pk_mul_f32 v[116:117], v[36:37], v[148:149] op_sel_hi:[1,0]
v_pk_fma_f32 v[116:117], v[38:39], v[148:149], v[116:117] op_sel:[0,1,0] neg_lo:[1,0,0] neg_hi:[1,0,0]
v_pk_mul_f32 v[38:39], v[38:39], v[148:149] op_sel_hi:[1,0]
v_pk_fma_f32 v[38:39], v[36:37], v[148:149], v[38:39] op_sel:[0,1,0]
v_mul_f32 v149, 0xbef00000, v9
v_cos_f32 v148, v149
v_sin_f32 v149, v149
v_pk_mul_f32 v[36:37], v[100:101], v[150:151] op_sel_hi:[1,0]
v_pk_fma_f32 v[36:37], v[102:103], v[150:151], v[36:37] op_sel:[0,1,0] neg_lo:[1,0,0] neg_hi:[1,0,0]
v_pk_mul_f32 v[102:103], v[102:103], v[150:151] op_sel_hi:[1,0]
v_pk_fma_f32 v[102:103], v[100:101], v[150:151], v[102:103] op_sel:[0,1,0]
v_mul_f32 v151, 0xbef80000, v9
v_cos_f32 v150, v151
v_sin_f32 v151, v151
v_pk_mul_f32 v[100:101], v[68:69], v[148:149] op_sel_hi:[1,0]
v_pk_fma_f32 v[100:101], v[70:71], v[148:149], v[100:101] op_sel:[0,1,0] neg_lo:[1,0,0] neg_hi:[1,0,0]
v_pk_mul_f32 v[70:71], v[70:71], v[148:149] op_sel_hi:[1,0]
v_pk_fma_f32 v[70:71], v[68:69], v[148:149], v[70:71] op_sel:[0,1,0]
s_nop 0
v_pk_mul_f32 v[68:69], v[132:133], v[150:151] op_sel_hi:[1,0]
v_pk_fma_f32 v[68:69], v[134:135], v[150:151], v[68:69] op_sel:[0,1,0] neg_lo:[1,0,0] neg_hi:[1,0,0]
v_pk_mul_f32 v[134:135], v[134:135], v[150:151] op_sel_hi:[1,0]
v_pk_fma_f32 v[134:135], v[132:133], v[150:151], v[134:135] op_sel:[0,1,0]
s_nop 1
v_mov_b32_dpp v132, v16 quad_perm:[1,0,3,2] row_mask:0xf bank_mask:0xf
v_mov_b32_dpp v133, v17 quad_perm:[1,0,3,2] row_mask:0xf bank_mask:0xf
v_pk_fma_f32 v[16:17], v[16:17], v[14:15], v[132:133] op_sel_hi:[1,0,1]
v_mov_b32_dpp v82, v18 quad_perm:[1,0,3,2] row_mask:0xf bank_mask:0xf
v_mov_b32_dpp v83, v19 quad_perm:[1,0,3,2] row_mask:0xf bank_mask:0xf
v_pk_fma_f32 v[18:19], v[18:19], v[14:15], v[82:83] op_sel_hi:[1,0,1]
v_mov_b32_dpp v132, v80 quad_perm:[1,0,3,2] row_mask:0xf bank_mask:0xf
v_mov_b32_dpp v133, v81 quad_perm:[1,0,3,2] row_mask:0xf bank_mask:0xf
v_pk_fma_f32 v[80:81], v[80:81], v[14:15], v[132:133] op_sel_hi:[1,0,1]
v_mov_b32_dpp v82, v146 quad_perm:[1,0,3,2] row_mask:0xf bank_mask:0xf
v_mov_b32_dpp v83, v147 quad_perm:[1,0,3,2] row_mask:0xf bank_mask:0xf
v_pk_fma_f32 v[146:147], v[146:147], v[14:15], v[82:83] op_sel_hi:[1,0,1]
v_mov_b32_dpp v132, v144 quad_perm:[1,0,3,2] row_mask:0xf bank_mask:0xf
v_mov_b32_dpp v133, v145 quad_perm:[1,0,3,2] row_mask:0xf bank_mask:0xf
v_pk_fma_f32 v[144:145], v[144:145], v[14:15], v[132:133] op_sel_hi:[1,0,1]
v_mov_b32_dpp v82, v114 quad_perm:[1,0,3,2] row_mask:0xf bank_mask:0xf
v_mov_b32_dpp v83, v115 quad_perm:[1,0,3,2] row_mask:0xf bank_mask:0xf
v_pk_fma_f32 v[114:115], v[114:115], v[14:15], v[82:83] op_sel_hi:[1,0,1]
v_mov_b32_dpp v132, v112 quad_perm:[1,0,3,2] row_mask:0xf bank_mask:0xf
v_mov_b32_dpp v133, v113 quad_perm:[1,0,3,2] row_mask:0xf bank_mask:0xf
v_pk_fma_f32 v[112:113], v[112:113], v[14:15], v[132:133] op_sel_hi:[1,0,1]
v_mov_b32_dpp v82, v66 quad_perm:[1,0,3,2] row_mask:0xf bank_mask:0xf
v_mov_b32_dpp v83, v67 quad_perm:[1,0,3,2] row_mask:0xf bank_mask:0xf
v_pk_fma_f32 v[66:67], v[66:67], v[14:15], v[82:83] op_sel_hi:[1,0,1]
v_mov_b32_dpp v132, v64 quad_perm:[1,0,3,2] row_mask:0xf bank_mask:0xf
v_mov_b32_dpp v133, v65 quad_perm:[1,0,3,2] row_mask:0xf bank_mask:0xf
v_pk_fma_f32 v[64:65], v[64:65], v[14:15], v[132:133] op_sel_hi:[1,0,1]
v_mov_b32_dpp v82, v130 quad_perm:[1,0,3,2] row_mask:0xf bank_mask:0xf
v_mov_b32_dpp v83, v131 quad_perm:[1,0,3,2] row_mask:0xf bank_mask:0xf
v_pk_fma_f32 v[130:131], v[130:131], v[14:15], v[82:83] op_sel_hi:[1,0,1]
v_mov_b32_dpp v132, v128 quad_perm:[1,0,3,2] row_mask:0xf bank_mask:0xf
v_mov_b32_dpp v133, v129 quad_perm:[1,0,3,2] row_mask:0xf bank_mask:0xf
v_pk_fma_f32 v[128:129], v[128:129], v[14:15], v[132:133] op_sel_hi:[1,0,1]
v_mov_b32_dpp v82, v74 quad_perm:[1,0,3,2] row_mask:0xf bank_mask:0xf
v_mov_b32_dpp v83, v75 quad_perm:[1,0,3,2] row_mask:0xf bank_mask:0xf
v_pk_fma_f32 v[74:75], v[74:75], v[14:15], v[82:83] op_sel_hi:[1,0,1]
v_mov_b32_dpp v132, v72 quad_perm:[1,0,3,2] row_mask:0xf bank_mask:0xf
v_mov_b32_dpp v133, v73 quad_perm:[1,0,3,2] row_mask:0xf bank_mask:0xf
v_pk_fma_f32 v[72:73], v[72:73], v[14:15], v[132:133] op_sel_hi:[1,0,1]
v_mov_b32_dpp v82, v42 quad_perm:[1,0,3,2] row_mask:0xf bank_mask:0xf
v_mov_b32_dpp v83, v43 quad_perm:[1,0,3,2] row_mask:0xf bank_mask:0xf
v_pk_fma_f32 v[42:43], v[42:43], v[14:15], v[82:83] op_sel_hi:[1,0,1]
v_mov_b32_dpp v132, v40 quad_perm:[1,0,3,2] row_mask:0xf bank_mask:0xf
v_mov_b32_dpp v133, v41 quad_perm:[1,0,3,2] row_mask:0xf bank_mask:0xf
v_pk_fma_f32 v[40:41], v[40:41], v[14:15], v[132:133] op_sel_hi:[1,0,1]
v_mov_b32_dpp v82, v106 quad_perm:[1,0,3,2] row_mask:0xf bank_mask:0xf
v_mov_b32_dpp v83, v107 quad_perm:[1,0,3,2] row_mask:0xf bank_mask:0xf
v_pk_fma_f32 v[106:107], v[106:107], v[14:15], v[82:83] op_sel_hi:[1,0,1]
v_mov_b32_dpp v132, v104 quad_perm:[1,0,3,2] row_mask:0xf bank_mask:0xf
v_mov_b32_dpp v133, v105 quad_perm:[1,0,3,2] row_mask:0xf bank_mask:0xf
v_pk_fma_f32 v[104:105], v[104:105], v[14:15], v[132:133] op_sel_hi:[1,0,1]
v_mov_b32_dpp v82, v138 quad_perm:[1,0,3,2] row_mask:0xf bank_mask:0xf
v_mov_b32_dpp v83, v139 quad_perm:[1,0,3,2] row_mask:0xf bank_mask:0xf
v_pk_fma_f32 v[138:139], v[138:139], v[14:15], v[82:83] op_sel_hi:[1,0,1]
v_mov_b32_dpp v132, v136 quad_perm:[1,0,3,2] row_mask:0xf bank_mask:0xf
v_mov_b32_dpp v133, v137 quad_perm:[1,0,3,2] row_mask:0xf bank_mask:0xf
v_pk_fma_f32 v[136:137], v[136:137], v[14:15], v[132:133] op_sel_hi:[1,0,1]
v_mov_b32_dpp v82, v78 quad_perm:[1,0,3,2] row_mask:0xf bank_mask:0xf
v_mov_b32_dpp v83, v79 quad_perm:[1,0,3,2] row_mask:0xf bank_mask:0xf
v_pk_fma_f32 v[78:79], v[78:79], v[14:15], v[82:83] op_sel_hi:[1,0,1]
v_mov_b32_dpp v132, v76 quad_perm:[1,0,3,2] row_mask:0xf bank_mask:0xf
v_mov_b32_dpp v133, v77 quad_perm:[1,0,3,2] row_mask:0xf bank_mask:0xf
v_pk_fma_f32 v[76:77], v[76:77], v[14:15], v[132:133] op_sel_hi:[1,0,1]
v_mov_b32_dpp v82, v46 quad_perm:[1,0,3,2] row_mask:0xf bank_mask:0xf
v_mov_b32_dpp v83, v47 quad_perm:[1,0,3,2] row_mask:0xf bank_mask:0xf
v_pk_fma_f32 v[46:47], v[46:47], v[14:15], v[82:83] op_sel_hi:[1,0,1]
v_mov_b32_dpp v132, v44 quad_perm:[1,0,3,2] row_mask:0xf bank_mask:0xf
v_mov_b32_dpp v133, v45 quad_perm:[1,0,3,2] row_mask:0xf bank_mask:0xf
v_pk_fma_f32 v[44:45], v[44:45], v[14:15], v[132:133] op_sel_hi:[1,0,1]
v_mov_b32_dpp v82, v110 quad_perm:[1,0,3,2] row_mask:0xf bank_mask:0xf
v_mov_b32_dpp v83, v111 quad_perm:[1,0,3,2] row_mask:0xf bank_mask:0xf
v_pk_fma_f32 v[110:111], v[110:111], v[14:15], v[82:83] op_sel_hi:[1,0,1]
v_mov_b32_dpp v132, v108 quad_perm:[1,0,3,2] row_mask:0xf bank_mask:0xf
v_mov_b32_dpp v133, v109 quad_perm:[1,0,3,2] row_mask:0xf bank_mask:0xf
v_pk_fma_f32 v[108:109], v[108:109], v[14:15], v[132:133] op_sel_hi:[1,0,1]
v_mov_b32_dpp v82, v30 quad_perm:[1,0,3,2] row_mask:0xf bank_mask:0xf
v_mov_b32_dpp v83, v31 quad_perm:[1,0,3,2] row_mask:0xf bank_mask:0xf
v_pk_fma_f32 v[30:31], v[30:31], v[14:15], v[82:83] op_sel_hi:[1,0,1]
v_mov_b32_dpp v132, v28 quad_perm:[1,0,3,2] row_mask:0xf bank_mask:0xf
v_mov_b32_dpp v133, v29 quad_perm:[1,0,3,2] row_mask:0xf bank_mask:0xf
v_pk_fma_f32 v[28:29], v[28:29], v[14:15], v[132:133] op_sel_hi:[1,0,1]
v_mov_b32_dpp v82, v94 quad_perm:[1,0,3,2] row_mask:0xf bank_mask:0xf
v_mov_b32_dpp v83, v95 quad_perm:[1,0,3,2] row_mask:0xf bank_mask:0xf
v_pk_fma_f32 v[94:95], v[94:95], v[14:15], v[82:83] op_sel_hi:[1,0,1]
v_mov_b32_dpp v132, v92 quad_perm:[1,0,3,2] row_mask:0xf bank_mask:0xf
v_mov_b32_dpp v133, v93 quad_perm:[1,0,3,2] row_mask:0xf bank_mask:0xf
v_pk_fma_f32 v[92:93], v[92:93], v[14:15], v[132:133] op_sel_hi:[1,0,1]
v_mov_b32_dpp v82, v62 quad_perm:[1,0,3,2] row_mask:0xf bank_mask:0xf
v_mov_b32_dpp v83, v63 quad_perm:[1,0,3,2] row_mask:0xf bank_mask:0xf
v_pk_fma_f32 v[62:63], v[62:63], v[14:15], v[82:83] op_sel_hi:[1,0,1]
v_mov_b32_dpp v132, v60 quad_perm:[1,0,3,2] row_mask:0xf bank_mask:0xf
v_mov_b32_dpp v133, v61 quad_perm:[1,0,3,2] row_mask:0xf bank_mask:0xf
v_pk_fma_f32 v[60:61], v[60:61], v[14:15], v[132:133] op_sel_hi:[1,0,1]
v_mov_b32_dpp v82, v126 quad_perm:[1,0,3,2] row_mask:0xf bank_mask:0xf
v_mov_b32_dpp v83, v127 quad_perm:[1,0,3,2] row_mask:0xf bank_mask:0xf
v_pk_fma_f32 v[126:127], v[126:127], v[14:15], v[82:83] op_sel_hi:[1,0,1]
v_mov_b32_dpp v132, v124 quad_perm:[1,0,3,2] row_mask:0xf bank_mask:0xf
v_mov_b32_dpp v133, v125 quad_perm:[1,0,3,2] row_mask:0xf bank_mask:0xf
v_pk_fma_f32 v[124:125], v[124:125], v[14:15], v[132:133] op_sel_hi:[1,0,1]
v_mov_b32_dpp v82, v142 quad_perm:[1,0,3,2] row_mask:0xf bank_mask:0xf
v_mov_b32_dpp v83, v143 quad_perm:[1,0,3,2] row_mask:0xf bank_mask:0xf
v_pk_fma_f32 v[142:143], v[142:143], v[14:15], v[82:83] op_sel_hi:[1,0,1]
v_mov_b32_dpp v132, v140 quad_perm:[1,0,3,2] row_mask:0xf bank_mask:0xf
v_mov_b32_dpp v133, v141 quad_perm:[1,0,3,2] row_mask:0xf bank_mask:0xf
v_pk_fma_f32 v[140:141], v[140:141], v[14:15], v[132:133] op_sel_hi:[1,0,1]
v_mov_b32_dpp v82, v50 quad_perm:[1,0,3,2] row_mask:0xf bank_mask:0xf
v_mov_b32_dpp v83, v51 quad_perm:[1,0,3,2] row_mask:0xf bank_mask:0xf
v_pk_fma_f32 v[50:51], v[50:51], v[14:15], v[82:83] op_sel_hi:[1,0,1]
v_mov_b32_dpp v132, v48 quad_perm:[1,0,3,2] row_mask:0xf bank_mask:0xf
v_mov_b32_dpp v133, v49 quad_perm:[1,0,3,2] row_mask:0xf bank_mask:0xf
v_pk_fma_f32 v[48:49], v[48:49], v[14:15], v[132:133] op_sel_hi:[1,0,1]
v_mov_b32_dpp v82, v34 quad_perm:[1,0,3,2] row_mask:0xf bank_mask:0xf
v_mov_b32_dpp v83, v35 quad_perm:[1,0,3,2] row_mask:0xf bank_mask:0xf
v_pk_fma_f32 v[34:35], v[34:35], v[14:15], v[82:83] op_sel_hi:[1,0,1]
v_mov_b32_dpp v132, v32 quad_perm:[1,0,3,2] row_mask:0xf bank_mask:0xf
v_mov_b32_dpp v133, v33 quad_perm:[1,0,3,2] row_mask:0xf bank_mask:0xf
v_pk_fma_f32 v[32:33], v[32:33], v[14:15], v[132:133] op_sel_hi:[1,0,1]
v_mov_b32_dpp v82, v98 quad_perm:[1,0,3,2] row_mask:0xf bank_mask:0xf
v_mov_b32_dpp v83, v99 quad_perm:[1,0,3,2] row_mask:0xf bank_mask:0xf
v_pk_fma_f32 v[98:99], v[98:99], v[14:15], v[82:83] op_sel_hi:[1,0,1]
v_mov_b32_dpp v132, v96 quad_perm:[1,0,3,2] row_mask:0xf bank_mask:0xf
v_mov_b32_dpp v133, v97 quad_perm:[1,0,3,2] row_mask:0xf bank_mask:0xf
v_pk_fma_f32 v[96:97], v[96:97], v[14:15], v[132:133] op_sel_hi:[1,0,1]
v_mov_b32_dpp v82, v26 quad_perm:[1,0,3,2] row_mask:0xf bank_mask:0xf
v_mov_b32_dpp v83, v27 quad_perm:[1,0,3,2] row_mask:0xf bank_mask:0xf
v_pk_fma_f32 v[26:27], v[26:27], v[14:15], v[82:83] op_sel_hi:[1,0,1]
v_mov_b32_dpp v132, v24 quad_perm:[1,0,3,2] row_mask:0xf bank_mask:0xf
v_mov_b32_dpp v133, v25 quad_perm:[1,0,3,2] row_mask:0xf bank_mask:0xf
v_pk_fma_f32 v[24:25], v[24:25], v[14:15], v[132:133] op_sel_hi:[1,0,1]
v_mov_b32_dpp v82, v90 quad_perm:[1,0,3,2] row_mask:0xf bank_mask:0xf
v_mov_b32_dpp v83, v91 quad_perm:[1,0,3,2] row_mask:0xf bank_mask:0xf
v_pk_fma_f32 v[90:91], v[90:91], v[14:15], v[82:83] op_sel_hi:[1,0,1]
v_mov_b32_dpp v132, v88 quad_perm:[1,0,3,2] row_mask:0xf bank_mask:0xf
v_mov_b32_dpp v133, v89 quad_perm:[1,0,3,2] row_mask:0xf bank_mask:0xf
v_pk_fma_f32 v[88:89], v[88:89], v[14:15], v[132:133] op_sel_hi:[1,0,1]
v_mov_b32_dpp v82, v58 quad_perm:[1,0,3,2] row_mask:0xf bank_mask:0xf
v_mov_b32_dpp v83, v59 quad_perm:[1,0,3,2] row_mask:0xf bank_mask:0xf
v_pk_fma_f32 v[58:59], v[58:59], v[14:15], v[82:83] op_sel_hi:[1,0,1]
v_mov_b32_dpp v132, v56 quad_perm:[1,0,3,2] row_mask:0xf bank_mask:0xf
v_mov_b32_dpp v133, v57 quad_perm:[1,0,3,2] row_mask:0xf bank_mask:0xf
v_pk_fma_f32 v[56:57], v[56:57], v[14:15], v[132:133] op_sel_hi:[1,0,1]
v_mov_b32_dpp v82, v122 quad_perm:[1,0,3,2] row_mask:0xf bank_mask:0xf
v_mov_b32_dpp v83, v123 quad_perm:[1,0,3,2] row_mask:0xf bank_mask:0xf
v_pk_fma_f32 v[122:123], v[122:123], v[14:15], v[82:83] op_sel_hi:[1,0,1]
v_mov_b32_dpp v132, v120 quad_perm:[1,0,3,2] row_mask:0xf bank_mask:0xf
v_mov_b32_dpp v133, v121 quad_perm:[1,0,3,2] row_mask:0xf bank_mask:0xf
v_pk_fma_f32 v[120:121], v[120:121], v[14:15], v[132:133] op_sel_hi:[1,0,1]
v_mov_b32_dpp v82, v22 quad_perm:[1,0,3,2] row_mask:0xf bank_mask:0xf
v_mov_b32_dpp v83, v23 quad_perm:[1,0,3,2] row_mask:0xf bank_mask:0xf
v_pk_fma_f32 v[22:23], v[22:23], v[14:15], v[82:83] op_sel_hi:[1,0,1]
v_mov_b32_dpp v132, v20 quad_perm:[1,0,3,2] row_mask:0xf bank_mask:0xf
v_mov_b32_dpp v133, v21 quad_perm:[1,0,3,2] row_mask:0xf bank_mask:0xf
v_pk_fma_f32 v[20:21], v[20:21], v[14:15], v[132:133] op_sel_hi:[1,0,1]
v_mov_b32_dpp v82, v86 quad_perm:[1,0,3,2] row_mask:0xf bank_mask:0xf
v_mov_b32_dpp v83, v87 quad_perm:[1,0,3,2] row_mask:0xf bank_mask:0xf
v_pk_fma_f32 v[86:87], v[86:87], v[14:15], v[82:83] op_sel_hi:[1,0,1]
v_mov_b32_dpp v132, v84 quad_perm:[1,0,3,2] row_mask:0xf bank_mask:0xf
v_mov_b32_dpp v133, v85 quad_perm:[1,0,3,2] row_mask:0xf bank_mask:0xf
v_pk_fma_f32 v[84:85], v[84:85], v[14:15], v[132:133] op_sel_hi:[1,0,1]
v_mov_b32_dpp v82, v54 quad_perm:[1,0,3,2] row_mask:0xf bank_mask:0xf
v_mov_b32_dpp v83, v55 quad_perm:[1,0,3,2] row_mask:0xf bank_mask:0xf
v_pk_fma_f32 v[54:55], v[54:55], v[14:15], v[82:83] op_sel_hi:[1,0,1]
v_mov_b32_dpp v132, v52 quad_perm:[1,0,3,2] row_mask:0xf bank_mask:0xf
v_mov_b32_dpp v133, v53 quad_perm:[1,0,3,2] row_mask:0xf bank_mask:0xf
v_pk_fma_f32 v[52:53], v[52:53], v[14:15], v[132:133] op_sel_hi:[1,0,1]
v_mov_b32_dpp v82, v118 quad_perm:[1,0,3,2] row_mask:0xf bank_mask:0xf
v_mov_b32_dpp v83, v119 quad_perm:[1,0,3,2] row_mask:0xf bank_mask:0xf
v_pk_fma_f32 v[118:119], v[118:119], v[14:15], v[82:83] op_sel_hi:[1,0,1]
v_mov_b32_dpp v132, v116 quad_perm:[1,0,3,2] row_mask:0xf bank_mask:0xf
v_mov_b32_dpp v133, v117 quad_perm:[1,0,3,2] row_mask:0xf bank_mask:0xf
v_pk_fma_f32 v[116:117], v[116:117], v[14:15], v[132:133] op_sel_hi:[1,0,1]
v_mov_b32_dpp v82, v38 quad_perm:[1,0,3,2] row_mask:0xf bank_mask:0xf
v_mov_b32_dpp v83, v39 quad_perm:[1,0,3,2] row_mask:0xf bank_mask:0xf
v_pk_fma_f32 v[38:39], v[38:39], v[14:15], v[82:83] op_sel_hi:[1,0,1]
v_mov_b32_dpp v132, v36 quad_perm:[1,0,3,2] row_mask:0xf bank_mask:0xf
v_mov_b32_dpp v133, v37 quad_perm:[1,0,3,2] row_mask:0xf bank_mask:0xf
v_pk_fma_f32 v[36:37], v[36:37], v[14:15], v[132:133] op_sel_hi:[1,0,1]
v_mov_b32_dpp v82, v102 quad_perm:[1,0,3,2] row_mask:0xf bank_mask:0xf
v_mov_b32_dpp v83, v103 quad_perm:[1,0,3,2] row_mask:0xf bank_mask:0xf
v_pk_fma_f32 v[102:103], v[102:103], v[14:15], v[82:83] op_sel_hi:[1,0,1]
v_mov_b32_dpp v132, v100 quad_perm:[1,0,3,2] row_mask:0xf bank_mask:0xf
v_mov_b32_dpp v133, v101 quad_perm:[1,0,3,2] row_mask:0xf bank_mask:0xf
v_pk_fma_f32 v[100:101], v[100:101], v[14:15], v[132:133] op_sel_hi:[1,0,1]
v_mov_b32_dpp v82, v70 quad_perm:[1,0,3,2] row_mask:0xf bank_mask:0xf
v_mov_b32_dpp v83, v71 quad_perm:[1,0,3,2] row_mask:0xf bank_mask:0xf
v_pk_fma_f32 v[70:71], v[70:71], v[14:15], v[82:83] op_sel_hi:[1,0,1]
v_mov_b32_dpp v132, v68 quad_perm:[1,0,3,2] row_mask:0xf bank_mask:0xf
v_mov_b32_dpp v133, v69 quad_perm:[1,0,3,2] row_mask:0xf bank_mask:0xf
v_pk_fma_f32 v[68:69], v[68:69], v[14:15], v[132:133] op_sel_hi:[1,0,1]
v_mov_b32_dpp v82, v134 quad_perm:[1,0,3,2] row_mask:0xf bank_mask:0xf
v_mov_b32_dpp v83, v135 quad_perm:[1,0,3,2] row_mask:0xf bank_mask:0xf
v_pk_fma_f32 v[134:135], v[134:135], v[14:15], v[82:83] op_sel_hi:[1,0,1]
v_lshlrev_b32 v82, 16, v160
v_and_b32 v83, 0xffff0000, v160
v_lshlrev_b32 v148, 16, v192
v_and_b32 v149, 0xffff0000, v192
v_pk_mul_f32 v[132:133], v[16:17], v[82:83]
v_pk_fma_f32 v[132:133], v[18:19], v[148:149], v[132:133] neg_lo:[1,0,0] neg_hi:[1,0,0]
v_pk_mul_f32 v[18:19], v[18:19], v[82:83]
v_pk_fma_f32 v[18:19], v[16:17], v[148:149], v[18:19]
v_lshlrev_b32 v82, 16, v161
v_and_b32 v83, 0xffff0000, v161
v_lshlrev_b32 v148, 16, v193
v_and_b32 v149, 0xffff0000, v193
v_pk_mul_f32 v[16:17], v[80:81], v[82:83]
v_pk_fma_f32 v[16:17], v[146:147], v[148:149], v[16:17] neg_lo:[1,0,0] neg_hi:[1,0,0]
v_pk_mul_f32 v[146:147], v[146:147], v[82:83]
v_pk_fma_f32 v[146:147], v[80:81], v[148:149], v[146:147]
v_lshlrev_b32 v82, 16, v162
v_and_b32 v83, 0xffff0000, v162
v_lshlrev_b32 v148, 16, v194
v_and_b32 v149, 0xffff0000, v194
v_pk_mul_f32 v[80:81], v[144:145], v[82:83]
v_pk_fma_f32 v[80:81], v[114:115], v[148:149], v[80:81] neg_lo:[1,0,0] neg_hi:[1,0,0]
v_pk_mul_f32 v[114:115], v[114:115], v[82:83]
v_pk_fma_f32 v[114:115], v[144:145], v[148:149], v[114:115]
v_lshlrev_b32 v82, 16, v163
v_and_b32 v83, 0xffff0000, v163
v_lshlrev_b32 v148, 16, v195
v_and_b32 v149, 0xffff0000, v195
v_pk_mul_f32 v[144:145], v[112:113], v[82:83]
v_pk_fma_f32 v[144:145], v[66:67], v[148:149], v[144:145] neg_lo:[1,0,0] neg_hi:[1,0,0]
v_pk_mul_f32 v[66:67], v[66:67], v[82:83]
v_pk_fma_f32 v[66:67], v[112:113], v[148:149], v[66:67]
v_lshlrev_b32 v82, 16, v164
v_and_b32 v83, 0xffff0000, v164
v_lshlrev_b32 v148, 16, v196
v_and_b32 v149, 0xffff0000, v196
v_pk_mul_f32 v[112:113], v[64:65], v[82:83]
v_pk_fma_f32 v[112:113], v[130:131], v[148:149], v[112:113] neg_lo:[1,0,0] neg_hi:[1,0,0]
v_pk_mul_f32 v[130:131], v[130:131], v[82:83]
v_pk_fma_f32 v[130:131], v[64:65], v[148:149], v[130:131]
v_lshlrev_b32 v82, 16, v165
v_and_b32 v83, 0xffff0000, v165
v_lshlrev_b32 v148, 16, v197
v_and_b32 v149, 0xffff0000, v197
v_pk_mul_f32 v[64:65], v[128:129], v[82:83]
v_pk_fma_f32 v[64:65], v[74:75], v[148:149], v[64:65] neg_lo:[1,0,0] neg_hi:[1,0,0]
v_pk_mul_f32 v[74:75], v[74:75], v[82:83]
v_pk_fma_f32 v[74:75], v[128:129], v[148:149], v[74:75]
v_lshlrev_b32 v82, 16, v166
v_and_b32 v83, 0xffff0000, v166
v_lshlrev_b32 v148, 16, v198
v_and_b32 v149, 0xffff0000, v198
v_pk_mul_f32 v[128:129], v[72:73], v[82:83]
v_pk_fma_f32 v[128:129], v[42:43], v[148:149], v[128:129] neg_lo:[1,0,0] neg_hi:[1,0,0]
v_pk_mul_f32 v[42:43], v[42:43], v[82:83]
v_pk_fma_f32 v[42:43], v[72:73], v[148:149], v[42:43]
v_lshlrev_b32 v82, 16, v167
v_and_b32 v83, 0xffff0000, v167
v_lshlrev_b32 v148, 16, v199
v_and_b32 v149, 0xffff0000, v199
v_pk_mul_f32 v[72:73], v[40:41], v[82:83]
v_pk_fma_f32 v[72:73], v[106:107], v[148:149], v[72:73] neg_lo:[1,0,0] neg_hi:[1,0,0]
v_pk_mul_f32 v[106:107], v[106:107], v[82:83]
v_pk_fma_f32 v[106:107], v[40:41], v[148:149], v[106:107]
v_lshlrev_b32 v82, 16, v168
v_and_b32 v83, 0xffff0000, v168
v_lshlrev_b32 v148, 16, v200
v_and_b32 v149, 0xffff0000, v200
v_pk_mul_f32 v[40:41], v[104:105], v[82:83]
v_pk_fma_f32 v[40:41], v[138:139], v[148:149], v[40:41] neg_lo:[1,0,0] neg_hi:[1,0,0]
v_pk_mul_f32 v[138:139], v[138:139], v[82:83]
v_pk_fma_f32 v[138:139], v[104:105], v[148:149], v[138:139]
v_lshlrev_b32 v82, 16, v169
v_and_b32 v83, 0xffff0000, v169
v_lshlrev_b32 v148, 16, v201
v_and_b32 v149, 0xffff0000, v201
v_pk_mul_f32 v[104:105], v[136:137], v[82:83]
v_pk_fma_f32 v[104:105], v[78:79], v[148:149], v[104:105] neg_lo:[1,0,0] neg_hi:[1,0,0]
v_pk_mul_f32 v[78:79], v[78:79], v[82:83]
v_pk_fma_f32 v[78:79], v[136:137], v[148:149], v[78:79]
v_lshlrev_b32 v82, 16, v170
v_and_b32 v83, 0xffff0000, v170
v_lshlrev_b32 v148, 16, v202
v_and_b32 v149, 0xffff0000, v202
v_pk_mul_f32 v[136:137], v[76:77], v[82:83]
v_pk_fma_f32 v[136:137], v[46:47], v[148:149], v[136:137] neg_lo:[1,0,0] neg_hi:[1,0,0]
v_pk_mul_f32 v[46:47], v[46:47], v[82:83]
v_pk_fma_f32 v[46:47], v[76:77], v[148:149], v[46:47]
v_lshlrev_b32 v82, 16, v171
v_and_b32 v83, 0xffff0000, v171
v_lshlrev_b32 v148, 16, v203
v_and_b32 v149, 0xffff0000, v203
v_pk_mul_f32 v[76:77], v[44:45], v[82:83]
v_pk_fma_f32 v[76:77], v[110:111], v[148:149], v[76:77] neg_lo:[1,0,0] neg_hi:[1,0,0]
v_pk_mul_f32 v[110:111], v[110:111], v[82:83]
v_pk_fma_f32 v[110:111], v[44:45], v[148:149], v[110:111]
v_lshlrev_b32 v82, 16, v172
v_and_b32 v83, 0xffff0000, v172
v_lshlrev_b32 v148, 16, v204
v_and_b32 v149, 0xffff0000, v204
v_pk_mul_f32 v[44:45], v[108:109], v[82:83]
v_pk_fma_f32 v[44:45], v[30:31], v[148:149], v[44:45] neg_lo:[1,0,0] neg_hi:[1,0,0]
v_pk_mul_f32 v[30:31], v[30:31], v[82:83]
v_pk_fma_f32 v[30:31], v[108:109], v[148:149], v[30:31]
v_lshlrev_b32 v82, 16, v173
v_and_b32 v83, 0xffff0000, v173
v_lshlrev_b32 v148, 16, v205
v_and_b32 v149, 0xffff0000, v205
v_pk_mul_f32 v[108:109], v[28:29], v[82:83]
v_pk_fma_f32 v[108:109], v[94:95], v[148:149], v[108:109] neg_lo:[1,0,0] neg_hi:[1,0,0]
v_pk_mul_f32 v[94:95], v[94:95], v[82:83]
v_pk_fma_f32 v[94:95], v[28:29], v[148:149], v[94:95]
v_lshlrev_b32 v82, 16, v174
v_and_b32 v83, 0xffff0000, v174
v_lshlrev_b32 v148, 16, v206
v_and_b32 v149, 0xffff0000, v206
v_pk_mul_f32 v[28:29], v[92:93], v[82:83]
v_pk_fma_f32 v[28:29], v[62:63], v[148:149], v[28:29] neg_lo:[1,0,0] neg_hi:[1,0,0]
v_pk_mul_f32 v[62:63], v[62:63], v[82:83]
v_pk_fma_f32 v[62:63], v[92:93], v[148:149], v[62:63]
v_lshlrev_b32 v82, 16, v175
v_and_b32 v83, 0xffff0000, v175
v_lshlrev_b32 v148, 16, v207
v_and_b32 v149, 0xffff0000, v207
v_pk_mul_f32 v[92:93], v[60:61], v[82:83]
v_pk_fma_f32 v[92:93], v[126:127], v[148:149], v[92:93] neg_lo:[1,0,0] neg_hi:[1,0,0]
v_pk_mul_f32 v[126:127], v[126:127], v[82:83]
v_pk_fma_f32 v[126:127], v[60:61], v[148:149], v[126:127]
v_lshlrev_b32 v82, 16, v176
v_and_b32 v83, 0xffff0000, v176
v_lshlrev_b32 v148, 16, v208
v_and_b32 v149, 0xffff0000, v208
v_pk_mul_f32 v[60:61], v[124:125], v[82:83]
v_pk_fma_f32 v[60:61], v[142:143], v[148:149], v[60:61] neg_lo:[1,0,0] neg_hi:[1,0,0]
v_pk_mul_f32 v[142:143], v[142:143], v[82:83]
v_pk_fma_f32 v[142:143], v[124:125], v[148:149], v[142:143]
v_lshlrev_b32 v82, 16, v177
v_and_b32 v83, 0xffff0000, v177
v_lshlrev_b32 v148, 16, v209
v_and_b32 v149, 0xffff0000, v209
v_pk_mul_f32 v[124:125], v[140:141], v[82:83]
v_pk_fma_f32 v[124:125], v[50:51], v[148:149], v[124:125] neg_lo:[1,0,0] neg_hi:[1,0,0]
v_pk_mul_f32 v[50:51], v[50:51], v[82:83]
v_pk_fma_f32 v[50:51], v[140:141], v[148:149], v[50:51]
v_lshlrev_b32 v82, 16, v178
v_and_b32 v83, 0xffff0000, v178
v_lshlrev_b32 v148, 16, v210
v_and_b32 v149, 0xffff0000, v210
v_pk_mul_f32 v[140:141], v[48:49], v[82:83]
v_pk_fma_f32 v[140:141], v[34:35], v[148:149], v[140:141] neg_lo:[1,0,0] neg_hi:[1,0,0]
v_pk_mul_f32 v[34:35], v[34:35], v[82:83]
v_pk_fma_f32 v[34:35], v[48:49], v[148:149], v[34:35]
v_lshlrev_b32 v82, 16, v179
v_and_b32 v83, 0xffff0000, v179
v_lshlrev_b32 v148, 16, v211
v_and_b32 v149, 0xffff0000, v211
v_pk_mul_f32 v[48:49], v[32:33], v[82:83]
v_pk_fma_f32 v[48:49], v[98:99], v[148:149], v[48:49] neg_lo:[1,0,0] neg_hi:[1,0,0]
v_pk_mul_f32 v[98:99], v[98:99], v[82:83]
v_pk_fma_f32 v[98:99], v[32:33], v[148:149], v[98:99]
v_lshlrev_b32 v82, 16, v180
v_and_b32 v83, 0xffff0000, v180
v_lshlrev_b32 v148, 16, v212
v_and_b32 v149, 0xffff0000, v212
v_pk_mul_f32 v[32:33], v[96:97], v[82:83]
v_pk_fma_f32 v[32:33], v[26:27], v[148:149], v[32:33] neg_lo:[1,0,0] neg_hi:[1,0,0]
v_pk_mul_f32 v[26:27], v[26:27], v[82:83]
v_pk_fma_f32 v[26:27], v[96:97], v[148:149], v[26:27]
v_lshlrev_b32 v82, 16, v181
v_and_b32 v83, 0xffff0000, v181
v_lshlrev_b32 v148, 16, v213
v_and_b32 v149, 0xffff0000, v213
v_pk_mul_f32 v[96:97], v[24:25], v[82:83]
v_pk_fma_f32 v[96:97], v[90:91], v[148:149], v[96:97] neg_lo:[1,0,0] neg_hi:[1,0,0]
v_pk_mul_f32 v[90:91], v[90:91], v[82:83]
v_pk_fma_f32 v[90:91], v[24:25], v[148:149], v[90:91]
v_lshlrev_b32 v82, 16, v182
v_and_b32 v83, 0xffff0000, v182
v_lshlrev_b32 v148, 16, v214
v_and_b32 v149, 0xffff0000, v214
v_pk_mul_f32 v[24:25], v[88:89], v[82:83]
v_pk_fma_f32 v[24:25], v[58:59], v[148:149], v[24:25] neg_lo:[1,0,0] neg_hi:[1,0,0]
v_pk_mul_f32 v[58:59], v[58:59], v[82:83]
v_pk_fma_f32 v[58:59], v[88:89], v[148:149], v[58:59]
v_lshlrev_b32 v82, 16, v183
v_and_b32 v83, 0xffff0000, v183
v_lshlrev_b32 v148, 16, v215
v_and_b32 v149, 0xffff0000, v215
v_pk_mul_f32 v[88:89], v[56:57], v[82:83]
v_pk_fma_f32 v[88:89], v[122:123], v[148:149], v[88:89] neg_lo:[1,0,0] neg_hi:[1,0,0]
v_pk_mul_f32 v[122:123], v[122:123], v[82:83]
v_pk_fma_f32 v[122:123], v[56:57], v[148:149], v[122:123]
v_lshlrev_b32 v82, 16, v184
v_and_b32 v83, 0xffff0000, v184
v_lshlrev_b32 v148, 16, v216
v_and_b32 v149, 0xffff0000, v216
v_pk_mul_f32 v[56:57], v[120:121], v[82:83]
v_pk_fma_f32 v[56:57], v[22:23], v[148:149], v[56:57] neg_lo:[1,0,0] neg_hi:[1,0,0]
v_pk_mul_f32 v[22:23], v[22:23], v[82:83]
v_pk_fma_f32 v[22:23], v[120:121], v[148:149], v[22:23]
v_lshlrev_b32 v82, 16, v185
v_and_b32 v83, 0xffff0000, v185
v_lshlrev_b32 v148, 16, v217
v_and_b32 v149, 0xffff0000, v217
v_pk_mul_f32 v[120:121], v[20:21], v[82:83]
v_pk_fma_f32 v[120:121], v[86:87], v[148:149], v[120:121] neg_lo:[1,0,0] neg_hi:[1,0,0]
v_pk_mul_f32 v[86:87], v[86:87], v[82:83]
v_pk_fma_f32 v[86:87], v[20:21], v[148:149], v[86:87]
v_lshlrev_b32 v82, 16, v186
v_and_b32 v83, 0xffff0000, v186
v_lshlrev_b32 v148, 16, v218
v_and_b32 v149, 0xffff0000, v218
v_pk_mul_f32 v[20:21], v[84:85], v[82:83]
v_pk_fma_f32 v[20:21], v[54:55], v[148:149], v[20:21] neg_lo:[1,0,0] neg_hi:[1,0,0]
v_pk_mul_f32 v[54:55], v[54:55], v[82:83]
v_pk_fma_f32 v[54:55], v[84:85], v[148:149], v[54:55]
v_lshlrev_b32 v82, 16, v187
v_and_b32 v83, 0xffff0000, v187
v_lshlrev_b32 v148, 16, v219
v_and_b32 v149, 0xffff0000, v219
v_pk_mul_f32 v[84:85], v[52:53], v[82:83]
v_pk_fma_f32 v[84:85], v[118:119], v[148:149], v[84:85] neg_lo:[1,0,0] neg_hi:[1,0,0]
v_pk_mul_f32 v[118:119], v[118:119], v[82:83]
v_pk_fma_f32 v[118:119], v[52:53], v[148:149], v[118:119]
v_lshlrev_b32 v82, 16, v188
v_and_b32 v83, 0xffff0000, v188
v_lshlrev_b32 v148, 16, v220
v_and_b32 v149, 0xffff0000, v220
v_pk_mul_f32 v[52:53], v[116:117], v[82:83]
v_pk_fma_f32 v[52:53], v[38:39], v[148:149], v[52:53] neg_lo:[1,0,0] neg_hi:[1,0,0]
v_pk_mul_f32 v[38:39], v[38:39], v[82:83]
v_pk_fma_f32 v[38:39], v[116:117], v[148:149], v[38:39]
v_lshlrev_b32 v82, 16, v189
v_and_b32 v83, 0xffff0000, v189
v_lshlrev_b32 v148, 16, v221
v_and_b32 v149, 0xffff0000, v221
v_pk_mul_f32 v[116:117], v[36:37], v[82:83]
v_pk_fma_f32 v[116:117], v[102:103], v[148:149], v[116:117] neg_lo:[1,0,0] neg_hi:[1,0,0]
v_pk_mul_f32 v[102:103], v[102:103], v[82:83]
v_pk_fma_f32 v[102:103], v[36:37], v[148:149], v[102:103]
v_lshlrev_b32 v82, 16, v190
v_and_b32 v83, 0xffff0000, v190
v_lshlrev_b32 v148, 16, v222
v_and_b32 v149, 0xffff0000, v222
v_pk_mul_f32 v[36:37], v[100:101], v[82:83]
v_pk_fma_f32 v[36:37], v[70:71], v[148:149], v[36:37] neg_lo:[1,0,0] neg_hi:[1,0,0]
v_pk_mul_f32 v[70:71], v[70:71], v[82:83]
v_pk_fma_f32 v[70:71], v[100:101], v[148:149], v[70:71]
v_lshlrev_b32 v82, 16, v191
v_and_b32 v83, 0xffff0000, v191
v_lshlrev_b32 v148, 16, v223
v_and_b32 v149, 0xffff0000, v223
v_pk_mul_f32 v[100:101], v[68:69], v[82:83]
v_pk_fma_f32 v[100:101], v[134:135], v[148:149], v[100:101] neg_lo:[1,0,0] neg_hi:[1,0,0]
v_pk_mul_f32 v[134:135], v[134:135], v[82:83]
v_pk_fma_f32 v[134:135], v[68:69], v[148:149], v[134:135]
s_nop 1
v_mov_b32_dpp v68, v132 quad_perm:[1,0,3,2] row_mask:0xf bank_mask:0xf
v_mov_b32_dpp v69, v133 quad_perm:[1,0,3,2] row_mask:0xf bank_mask:0xf
v_pk_fma_f32 v[132:133], v[132:133], v[14:15], v[68:69] op_sel_hi:[1,0,1]
v_mov_b32_dpp v82, v18 quad_perm:[1,0,3,2] row_mask:0xf bank_mask:0xf
v_mov_b32_dpp v83, v19 quad_perm:[1,0,3,2] row_mask:0xf bank_mask:0xf
v_pk_fma_f32 v[18:19], v[18:19], v[14:15], v[82:83] op_sel_hi:[1,0,1]
v_mov_b32_dpp v68, v16 quad_perm:[1,0,3,2] row_mask:0xf bank_mask:0xf
v_mov_b32_dpp v69, v17 quad_perm:[1,0,3,2] row_mask:0xf bank_mask:0xf
v_pk_fma_f32 v[16:17], v[16:17], v[14:15], v[68:69] op_sel_hi:[1,0,1]
v_mov_b32_dpp v82, v146 quad_perm:[1,0,3,2] row_mask:0xf bank_mask:0xf
v_mov_b32_dpp v83, v147 quad_perm:[1,0,3,2] row_mask:0xf bank_mask:0xf
v_pk_fma_f32 v[146:147], v[146:147], v[14:15], v[82:83] op_sel_hi:[1,0,1]
v_mov_b32_dpp v68, v80 quad_perm:[1,0,3,2] row_mask:0xf bank_mask:0xf
v_mov_b32_dpp v69, v81 quad_perm:[1,0,3,2] row_mask:0xf bank_mask:0xf
v_pk_fma_f32 v[80:81], v[80:81], v[14:15], v[68:69] op_sel_hi:[1,0,1]
v_mov_b32_dpp v82, v114 quad_perm:[1,0,3,2] row_mask:0xf bank_mask:0xf
v_mov_b32_dpp v83, v115 quad_perm:[1,0,3,2] row_mask:0xf bank_mask:0xf
v_pk_fma_f32 v[114:115], v[114:115], v[14:15], v[82:83] op_sel_hi:[1,0,1]
v_mov_b32_dpp v68, v144 quad_perm:[1,0,3,2] row_mask:0xf bank_mask:0xf
v_mov_b32_dpp v69, v145 quad_perm:[1,0,3,2] row_mask:0xf bank_mask:0xf
v_pk_fma_f32 v[144:145], v[144:145], v[14:15], v[68:69] op_sel_hi:[1,0,1]
v_mov_b32_dpp v82, v66 quad_perm:[1,0,3,2] row_mask:0xf bank_mask:0xf
v_mov_b32_dpp v83, v67 quad_perm:[1,0,3,2] row_mask:0xf bank_mask:0xf
v_pk_fma_f32 v[66:67], v[66:67], v[14:15], v[82:83] op_sel_hi:[1,0,1]
v_mov_b32_dpp v68, v112 quad_perm:[1,0,3,2] row_mask:0xf bank_mask:0xf
v_mov_b32_dpp v69, v113 quad_perm:[1,0,3,2] row_mask:0xf bank_mask:0xf
v_pk_fma_f32 v[112:113], v[112:113], v[14:15], v[68:69] op_sel_hi:[1,0,1]
v_mov_b32_dpp v82, v130 quad_perm:[1,0,3,2] row_mask:0xf bank_mask:0xf
v_mov_b32_dpp v83, v131 quad_perm:[1,0,3,2] row_mask:0xf bank_mask:0xf
v_pk_fma_f32 v[130:131], v[130:131], v[14:15], v[82:83] op_sel_hi:[1,0,1]
v_mov_b32_dpp v68, v64 quad_perm:[1,0,3,2] row_mask:0xf bank_mask:0xf
v_mov_b32_dpp v69, v65 quad_perm:[1,0,3,2] row_mask:0xf bank_mask:0xf
v_pk_fma_f32 v[64:65], v[64:65], v[14:15], v[68:69] op_sel_hi:[1,0,1]
v_mov_b32_dpp v82, v74 quad_perm:[1,0,3,2] row_mask:0xf bank_mask:0xf
v_mov_b32_dpp v83, v75 quad_perm:[1,0,3,2] row_mask:0xf bank_mask:0xf
v_pk_fma_f32 v[74:75], v[74:75], v[14:15], v[82:83] op_sel_hi:[1,0,1]
v_mov_b32_dpp v68, v128 quad_perm:[1,0,3,2] row_mask:0xf bank_mask:0xf
v_mov_b32_dpp v69, v129 quad_perm:[1,0,3,2] row_mask:0xf bank_mask:0xf
v_pk_fma_f32 v[128:129], v[128:129], v[14:15], v[68:69] op_sel_hi:[1,0,1]
v_mov_b32_dpp v82, v42 quad_perm:[1,0,3,2] row_mask:0xf bank_mask:0xf
v_mov_b32_dpp v83, v43 quad_perm:[1,0,3,2] row_mask:0xf bank_mask:0xf
v_pk_fma_f32 v[42:43], v[42:43], v[14:15], v[82:83] op_sel_hi:[1,0,1]
v_mov_b32_dpp v68, v72 quad_perm:[1,0,3,2] row_mask:0xf bank_mask:0xf
v_mov_b32_dpp v69, v73 quad_perm:[1,0,3,2] row_mask:0xf bank_mask:0xf
v_pk_fma_f32 v[72:73], v[72:73], v[14:15], v[68:69] op_sel_hi:[1,0,1]
v_mov_b32_dpp v82, v106 quad_perm:[1,0,3,2] row_mask:0xf bank_mask:0xf
v_mov_b32_dpp v83, v107 quad_perm:[1,0,3,2] row_mask:0xf bank_mask:0xf
v_pk_fma_f32 v[106:107], v[106:107], v[14:15], v[82:83] op_sel_hi:[1,0,1]
v_mov_b32_dpp v68, v40 quad_perm:[1,0,3,2] row_mask:0xf bank_mask:0xf
v_mov_b32_dpp v69, v41 quad_perm:[1,0,3,2] row_mask:0xf bank_mask:0xf
v_pk_fma_f32 v[40:41], v[40:41], v[14:15], v[68:69] op_sel_hi:[1,0,1]
v_mov_b32_dpp v82, v138 quad_perm:[1,0,3,2] row_mask:0xf bank_mask:0xf
v_mov_b32_dpp v83, v139 quad_perm:[1,0,3,2] row_mask:0xf bank_mask:0xf
v_pk_fma_f32 v[138:139], v[138:139], v[14:15], v[82:83] op_sel_hi:[1,0,1]
v_mov_b32_dpp v68, v104 quad_perm:[1,0,3,2] row_mask:0xf bank_mask:0xf
v_mov_b32_dpp v69, v105 quad_perm:[1,0,3,2] row_mask:0xf bank_mask:0xf
v_pk_fma_f32 v[104:105], v[104:105], v[14:15], v[68:69] op_sel_hi:[1,0,1]
v_mov_b32_dpp v82, v78 quad_perm:[1,0,3,2] row_mask:0xf bank_mask:0xf
v_mov_b32_dpp v83, v79 quad_perm:[1,0,3,2] row_mask:0xf bank_mask:0xf
v_pk_fma_f32 v[78:79], v[78:79], v[14:15], v[82:83] op_sel_hi:[1,0,1]
v_mov_b32_dpp v68, v136 quad_perm:[1,0,3,2] row_mask:0xf bank_mask:0xf
v_mov_b32_dpp v69, v137 quad_perm:[1,0,3,2] row_mask:0xf bank_mask:0xf
v_pk_fma_f32 v[136:137], v[136:137], v[14:15], v[68:69] op_sel_hi:[1,0,1]
v_mov_b32_dpp v82, v46 quad_perm:[1,0,3,2] row_mask:0xf bank_mask:0xf
v_mov_b32_dpp v83, v47 quad_perm:[1,0,3,2] row_mask:0xf bank_mask:0xf
v_pk_fma_f32 v[46:47], v[46:47], v[14:15], v[82:83] op_sel_hi:[1,0,1]
v_mov_b32_dpp v68, v76 quad_perm:[1,0,3,2] row_mask:0xf bank_mask:0xf
v_mov_b32_dpp v69, v77 quad_perm:[1,0,3,2] row_mask:0xf bank_mask:0xf
v_pk_fma_f32 v[76:77], v[76:77], v[14:15], v[68:69] op_sel_hi:[1,0,1]
v_mov_b32_dpp v82, v110 quad_perm:[1,0,3,2] row_mask:0xf bank_mask:0xf
v_mov_b32_dpp v83, v111 quad_perm:[1,0,3,2] row_mask:0xf bank_mask:0xf
v_pk_fma_f32 v[110:111], v[110:111], v[14:15], v[82:83] op_sel_hi:[1,0,1]
v_mov_b32_dpp v68, v44 quad_perm:[1,0,3,2] row_mask:0xf bank_mask:0xf
v_mov_b32_dpp v69, v45 quad_perm:[1,0,3,2] row_mask:0xf bank_mask:0xf
v_pk_fma_f32 v[44:45], v[44:45], v[14:15], v[68:69] op_sel_hi:[1,0,1]
v_mov_b32_dpp v82, v30 quad_perm:[1,0,3,2] row_mask:0xf bank_mask:0xf
v_mov_b32_dpp v83, v31 quad_perm:[1,0,3,2] row_mask:0xf bank_mask:0xf
v_pk_fma_f32 v[30:31], v[30:31], v[14:15], v[82:83] op_sel_hi:[1,0,1]
v_mov_b32_dpp v68, v108 quad_perm:[1,0,3,2] row_mask:0xf bank_mask:0xf
v_mov_b32_dpp v69, v109 quad_perm:[1,0,3,2] row_mask:0xf bank_mask:0xf
v_pk_fma_f32 v[108:109], v[108:109], v[14:15], v[68:69] op_sel_hi:[1,0,1]
v_mov_b32_dpp v82, v94 quad_perm:[1,0,3,2] row_mask:0xf bank_mask:0xf
v_mov_b32_dpp v83, v95 quad_perm:[1,0,3,2] row_mask:0xf bank_mask:0xf
v_pk_fma_f32 v[94:95], v[94:95], v[14:15], v[82:83] op_sel_hi:[1,0,1]
v_mov_b32_dpp v68, v28 quad_perm:[1,0,3,2] row_mask:0xf bank_mask:0xf
v_mov_b32_dpp v69, v29 quad_perm:[1,0,3,2] row_mask:0xf bank_mask:0xf
v_pk_fma_f32 v[28:29], v[28:29], v[14:15], v[68:69] op_sel_hi:[1,0,1]
v_mov_b32_dpp v82, v62 quad_perm:[1,0,3,2] row_mask:0xf bank_mask:0xf
v_mov_b32_dpp v83, v63 quad_perm:[1,0,3,2] row_mask:0xf bank_mask:0xf
v_pk_fma_f32 v[62:63], v[62:63], v[14:15], v[82:83] op_sel_hi:[1,0,1]
v_mov_b32_dpp v68, v92 quad_perm:[1,0,3,2] row_mask:0xf bank_mask:0xf
v_mov_b32_dpp v69, v93 quad_perm:[1,0,3,2] row_mask:0xf bank_mask:0xf
v_pk_fma_f32 v[92:93], v[92:93], v[14:15], v[68:69] op_sel_hi:[1,0,1]
v_mov_b32_dpp v82, v126 quad_perm:[1,0,3,2] row_mask:0xf bank_mask:0xf
v_mov_b32_dpp v83, v127 quad_perm:[1,0,3,2] row_mask:0xf bank_mask:0xf
v_pk_fma_f32 v[126:127], v[126:127], v[14:15], v[82:83] op_sel_hi:[1,0,1]
v_mov_b32_dpp v68, v60 quad_perm:[1,0,3,2] row_mask:0xf bank_mask:0xf
v_mov_b32_dpp v69, v61 quad_perm:[1,0,3,2] row_mask:0xf bank_mask:0xf
v_pk_fma_f32 v[60:61], v[60:61], v[14:15], v[68:69] op_sel_hi:[1,0,1]
v_mov_b32_dpp v82, v142 quad_perm:[1,0,3,2] row_mask:0xf bank_mask:0xf
v_mov_b32_dpp v83, v143 quad_perm:[1,0,3,2] row_mask:0xf bank_mask:0xf
v_pk_fma_f32 v[142:143], v[142:143], v[14:15], v[82:83] op_sel_hi:[1,0,1]
v_mov_b32_dpp v68, v124 quad_perm:[1,0,3,2] row_mask:0xf bank_mask:0xf
v_mov_b32_dpp v69, v125 quad_perm:[1,0,3,2] row_mask:0xf bank_mask:0xf
v_pk_fma_f32 v[124:125], v[124:125], v[14:15], v[68:69] op_sel_hi:[1,0,1]
v_mov_b32_dpp v82, v50 quad_perm:[1,0,3,2] row_mask:0xf bank_mask:0xf
v_mov_b32_dpp v83, v51 quad_perm:[1,0,3,2] row_mask:0xf bank_mask:0xf
v_pk_fma_f32 v[50:51], v[50:51], v[14:15], v[82:83] op_sel_hi:[1,0,1]
v_mov_b32_dpp v68, v140 quad_perm:[1,0,3,2] row_mask:0xf bank_mask:0xf
v_mov_b32_dpp v69, v141 quad_perm:[1,0,3,2] row_mask:0xf bank_mask:0xf
v_pk_fma_f32 v[140:141], v[140:141], v[14:15], v[68:69] op_sel_hi:[1,0,1]
v_mov_b32_dpp v82, v34 quad_perm:[1,0,3,2] row_mask:0xf bank_mask:0xf
v_mov_b32_dpp v83, v35 quad_perm:[1,0,3,2] row_mask:0xf bank_mask:0xf
v_pk_fma_f32 v[34:35], v[34:35], v[14:15], v[82:83] op_sel_hi:[1,0,1]
v_mov_b32_dpp v68, v48 quad_perm:[1,0,3,2] row_mask:0xf bank_mask:0xf
v_mov_b32_dpp v69, v49 quad_perm:[1,0,3,2] row_mask:0xf bank_mask:0xf
v_pk_fma_f32 v[48:49], v[48:49], v[14:15], v[68:69] op_sel_hi:[1,0,1]
v_mov_b32_dpp v82, v98 quad_perm:[1,0,3,2] row_mask:0xf bank_mask:0xf
v_mov_b32_dpp v83, v99 quad_perm:[1,0,3,2] row_mask:0xf bank_mask:0xf
v_pk_fma_f32 v[98:99], v[98:99], v[14:15], v[82:83] op_sel_hi:[1,0,1]
v_mov_b32_dpp v68, v32 quad_perm:[1,0,3,2] row_mask:0xf bank_mask:0xf
v_mov_b32_dpp v69, v33 quad_perm:[1,0,3,2] row_mask:0xf bank_mask:0xf
v_pk_fma_f32 v[32:33], v[32:33], v[14:15], v[68:69] op_sel_hi:[1,0,1]
v_mov_b32_dpp v82, v26 quad_perm:[1,0,3,2] row_mask:0xf bank_mask:0xf
v_mov_b32_dpp v83, v27 quad_perm:[1,0,3,2] row_mask:0xf bank_mask:0xf
v_pk_fma_f32 v[26:27], v[26:27], v[14:15], v[82:83] op_sel_hi:[1,0,1]
v_mov_b32_dpp v68, v96 quad_perm:[1,0,3,2] row_mask:0xf bank_mask:0xf
v_mov_b32_dpp v69, v97 quad_perm:[1,0,3,2] row_mask:0xf bank_mask:0xf
v_pk_fma_f32 v[96:97], v[96:97], v[14:15], v[68:69] op_sel_hi:[1,0,1]
v_mov_b32_dpp v82, v90 quad_perm:[1,0,3,2] row_mask:0xf bank_mask:0xf
v_mov_b32_dpp v83, v91 quad_perm:[1,0,3,2] row_mask:0xf bank_mask:0xf
v_pk_fma_f32 v[90:91], v[90:91], v[14:15], v[82:83] op_sel_hi:[1,0,1]
v_mov_b32_dpp v68, v24 quad_perm:[1,0,3,2] row_mask:0xf bank_mask:0xf
v_mov_b32_dpp v69, v25 quad_perm:[1,0,3,2] row_mask:0xf bank_mask:0xf
v_pk_fma_f32 v[24:25], v[24:25], v[14:15], v[68:69] op_sel_hi:[1,0,1]
v_mov_b32_dpp v82, v58 quad_perm:[1,0,3,2] row_mask:0xf bank_mask:0xf
v_mov_b32_dpp v83, v59 quad_perm:[1,0,3,2] row_mask:0xf bank_mask:0xf
v_pk_fma_f32 v[58:59], v[58:59], v[14:15], v[82:83] op_sel_hi:[1,0,1]
v_mov_b32_dpp v68, v88 quad_perm:[1,0,3,2] row_mask:0xf bank_mask:0xf
v_mov_b32_dpp v69, v89 quad_perm:[1,0,3,2] row_mask:0xf bank_mask:0xf
v_pk_fma_f32 v[88:89], v[88:89], v[14:15], v[68:69] op_sel_hi:[1,0,1]
v_mov_b32_dpp v82, v122 quad_perm:[1,0,3,2] row_mask:0xf bank_mask:0xf
v_mov_b32_dpp v83, v123 quad_perm:[1,0,3,2] row_mask:0xf bank_mask:0xf
v_pk_fma_f32 v[122:123], v[122:123], v[14:15], v[82:83] op_sel_hi:[1,0,1]
v_mov_b32_dpp v68, v56 quad_perm:[1,0,3,2] row_mask:0xf bank_mask:0xf
v_mov_b32_dpp v69, v57 quad_perm:[1,0,3,2] row_mask:0xf bank_mask:0xf
v_pk_fma_f32 v[56:57], v[56:57], v[14:15], v[68:69] op_sel_hi:[1,0,1]
v_mov_b32_dpp v82, v22 quad_perm:[1,0,3,2] row_mask:0xf bank_mask:0xf
v_mov_b32_dpp v83, v23 quad_perm:[1,0,3,2] row_mask:0xf bank_mask:0xf
v_pk_fma_f32 v[22:23], v[22:23], v[14:15], v[82:83] op_sel_hi:[1,0,1]
v_mov_b32_dpp v68, v120 quad_perm:[1,0,3,2] row_mask:0xf bank_mask:0xf
v_mov_b32_dpp v69, v121 quad_perm:[1,0,3,2] row_mask:0xf bank_mask:0xf
v_pk_fma_f32 v[120:121], v[120:121], v[14:15], v[68:69] op_sel_hi:[1,0,1]
v_mov_b32_dpp v82, v86 quad_perm:[1,0,3,2] row_mask:0xf bank_mask:0xf
v_mov_b32_dpp v83, v87 quad_perm:[1,0,3,2] row_mask:0xf bank_mask:0xf
v_pk_fma_f32 v[86:87], v[86:87], v[14:15], v[82:83] op_sel_hi:[1,0,1]
v_mov_b32_dpp v68, v20 quad_perm:[1,0,3,2] row_mask:0xf bank_mask:0xf
v_mov_b32_dpp v69, v21 quad_perm:[1,0,3,2] row_mask:0xf bank_mask:0xf
v_pk_fma_f32 v[20:21], v[20:21], v[14:15], v[68:69] op_sel_hi:[1,0,1]
v_mov_b32_dpp v82, v54 quad_perm:[1,0,3,2] row_mask:0xf bank_mask:0xf
v_mov_b32_dpp v83, v55 quad_perm:[1,0,3,2] row_mask:0xf bank_mask:0xf
v_pk_fma_f32 v[54:55], v[54:55], v[14:15], v[82:83] op_sel_hi:[1,0,1]
v_mov_b32_dpp v68, v84 quad_perm:[1,0,3,2] row_mask:0xf bank_mask:0xf
v_mov_b32_dpp v69, v85 quad_perm:[1,0,3,2] row_mask:0xf bank_mask:0xf
v_pk_fma_f32 v[84:85], v[84:85], v[14:15], v[68:69] op_sel_hi:[1,0,1]
v_mov_b32_dpp v82, v118 quad_perm:[1,0,3,2] row_mask:0xf bank_mask:0xf
v_mov_b32_dpp v83, v119 quad_perm:[1,0,3,2] row_mask:0xf bank_mask:0xf
v_pk_fma_f32 v[118:119], v[118:119], v[14:15], v[82:83] op_sel_hi:[1,0,1]
v_mov_b32_dpp v68, v52 quad_perm:[1,0,3,2] row_mask:0xf bank_mask:0xf
v_mov_b32_dpp v69, v53 quad_perm:[1,0,3,2] row_mask:0xf bank_mask:0xf
v_pk_fma_f32 v[52:53], v[52:53], v[14:15], v[68:69] op_sel_hi:[1,0,1]
v_mov_b32_dpp v82, v38 quad_perm:[1,0,3,2] row_mask:0xf bank_mask:0xf
v_mov_b32_dpp v83, v39 quad_perm:[1,0,3,2] row_mask:0xf bank_mask:0xf
v_pk_fma_f32 v[38:39], v[38:39], v[14:15], v[82:83] op_sel_hi:[1,0,1]
v_mov_b32_dpp v68, v116 quad_perm:[1,0,3,2] row_mask:0xf bank_mask:0xf
v_mov_b32_dpp v69, v117 quad_perm:[1,0,3,2] row_mask:0xf bank_mask:0xf
v_pk_fma_f32 v[116:117], v[116:117], v[14:15], v[68:69] op_sel_hi:[1,0,1]
v_mov_b32_dpp v82, v102 quad_perm:[1,0,3,2] row_mask:0xf bank_mask:0xf
v_mov_b32_dpp v83, v103 quad_perm:[1,0,3,2] row_mask:0xf bank_mask:0xf
v_pk_fma_f32 v[102:103], v[102:103], v[14:15], v[82:83] op_sel_hi:[1,0,1]
v_mov_b32_dpp v68, v36 quad_perm:[1,0,3,2] row_mask:0xf bank_mask:0xf
v_mov_b32_dpp v69, v37 quad_perm:[1,0,3,2] row_mask:0xf bank_mask:0xf
v_pk_fma_f32 v[36:37], v[36:37], v[14:15], v[68:69] op_sel_hi:[1,0,1]
v_mov_b32_dpp v82, v70 quad_perm:[1,0,3,2] row_mask:0xf bank_mask:0xf
v_mov_b32_dpp v83, v71 quad_perm:[1,0,3,2] row_mask:0xf bank_mask:0xf
v_pk_fma_f32 v[70:71], v[70:71], v[14:15], v[82:83] op_sel_hi:[1,0,1]
v_mov_b32_dpp v68, v100 quad_perm:[1,0,3,2] row_mask:0xf bank_mask:0xf
v_mov_b32_dpp v69, v101 quad_perm:[1,0,3,2] row_mask:0xf bank_mask:0xf
v_pk_fma_f32 v[100:101], v[100:101], v[14:15], v[68:69] op_sel_hi:[1,0,1]
v_mov_b32_dpp v82, v134 quad_perm:[1,0,3,2] row_mask:0xf bank_mask:0xf
v_mov_b32_dpp v83, v135 quad_perm:[1,0,3,2] row_mask:0xf bank_mask:0xf
v_pk_fma_f32 v[134:135], v[134:135], v[14:15], v[82:83] op_sel_hi:[1,0,1]
v_mul_f32 v151, 0x3c800000, v9
v_cos_f32 v150, v151
v_sin_f32 v151, v151
v_mul_f32 v149, 0x3d000000, v9
v_cos_f32 v148, v149
v_sin_f32 v149, v149
v_pk_mul_f32 v[68:69], v[16:17], v[150:151] op_sel_hi:[1,0]
v_pk_fma_f32 v[68:69], v[146:147], v[150:151], v[68:69] op_sel:[0,1,0] neg_lo:[1,0,0] neg_hi:[1,0,0]
v_pk_mul_f32 v[146:147], v[146:147], v[150:151] op_sel_hi:[1,0]
v_pk_fma_f32 v[146:147], v[16:17], v[150:151], v[146:147] op_sel:[0,1,0]
v_mul_f32 v151, 0x3d400000, v9
v_cos_f32 v150, v151
v_sin_f32 v151, v151
v_pk_mul_f32 v[16:17], v[80:81], v[148:149] op_sel_hi:[1,0]
v_pk_fma_f32 v[16:17], v[114:115], v[148:149], v[16:17] op_sel:[0,1,0] neg_lo:[1,0,0] neg_hi:[1,0,0]
v_pk_mul_f32 v[114:115], v[114:115], v[148:149] op_sel_hi:[1,0]
v_pk_fma_f32 v[114:115], v[80:81], v[148:149], v[114:115] op_sel:[0,1,0]
v_mul_f32 v149, 0x3d800000, v9
v_cos_f32 v148, v149
v_sin_f32 v149, v149
v_pk_mul_f32 v[80:81], v[144:145], v[150:151] op_sel_hi:[1,0]
v_pk_fma_f32 v[80:81], v[66:67], v[150:151], v[80:81] op_sel:[0,1,0] neg_lo:[1,0,0] neg_hi:[1,0,0]
v_pk_mul_f32 v[66:67], v[66:67], v[150:151] op_sel_hi:[1,0]
v_pk_fma_f32 v[66:67], v[144:145], v[150:151], v[66:67] op_sel:[0,1,0]
v_mul_f32 v151, 0x3da00000, v9
v_cos_f32 v150, v151
v_sin_f32 v151, v151
v_pk_mul_f32 v[144:145], v[112:113], v[148:149] op_sel_hi:[1,0]
v_pk_fma_f32 v[144:145], v[130:131], v[148:149], v[144:145] op_sel:[0,1,0] neg_lo:[1,0,0] neg_hi:[1,0,0]
v_pk_mul_f32 v[130:131], v[130:131], v[148:149] op_sel_hi:[1,0]
v_pk_fma_f32 v[130:131], v[112:113], v[148:149], v[130:131] op_sel:[0,1,0]
v_mul_f32 v149, 0x3dc00000, v9
v_cos_f32 v148, v149
v_sin_f32 v149, v149
v_pk_mul_f32 v[112:113], v[64:65], v[150:151] op_sel_hi:[1,0]
v_pk_fma_f32 v[112:113], v[74:75], v[150:151], v[112:113] op_sel:[0,1,0] neg_lo:[1,0,0] neg_hi:[1,0,0]
v_pk_mul_f32 v[74:75], v[74:75], v[150:151] op_sel_hi:[1,0]
v_pk_fma_f32 v[74:75], v[64:65], v[150:151], v[74:75] op_sel:[0,1,0]
v_mul_f32 v151, 0x3de00000, v9
v_cos_f32 v150, v151
v_sin_f32 v151, v151
v_pk_mul_f32 v[64:65], v[128:129], v[148:149] op_sel_hi:[1,0]
v_pk_fma_f32 v[64:65], v[42:43], v[148:149], v[64:65] op_sel:[0,1,0] neg_lo:[1,0,0] neg_hi:[1,0,0]
v_pk_mul_f32 v[42:43], v[42:43], v[148:149] op_sel_hi:[1,0]
v_pk_fma_f32 v[42:43], v[128:129], v[148:149], v[42:43] op_sel:[0,1,0]
v_mul_f32 v149, 0x3e000000, v9
v_cos_f32 v148, v149
v_sin_f32 v149, v149
v_pk_mul_f32 v[128:129], v[72:73], v[150:151] op_sel_hi:[1,0]
v_pk_fma_f32 v[128:129], v[106:107], v[150:151], v[128:129] op_sel:[0,1,0] neg_lo:[1,0,0] neg_hi:[1,0,0]
v_pk_mul_f32 v[106:107], v[106:107], v[150:151] op_sel_hi:[1,0]
v_pk_fma_f32 v[106:107], v[72:73], v[150:151], v[106:107] op_sel:[0,1,0]
v_mul_f32 v151, 0x3e100000, v9
v_cos_f32 v150, v151
v_sin_f32 v151, v151
v_pk_mul_f32 v[72:73], v[40:41], v[148:149] op_sel_hi:[1,0]
v_pk_fma_f32 v[72:73], v[138:139], v[148:149], v[72:73] op_sel:[0,1,0] neg_lo:[1,0,0] neg_hi:[1,0,0]
v_pk_mul_f32 v[138:139], v[138:139], v[148:149] op_sel_hi:[1,0]
v_pk_fma_f32 v[138:139], v[40:41], v[148:149], v[138:139] op_sel:[0,1,0]
v_mul_f32 v149, 0x3e200000, v9
v_cos_f32 v148, v149
v_sin_f32 v149, v149
v_pk_mul_f32 v[40:41], v[104:105], v[150:151] op_sel_hi:[1,0]
v_pk_fma_f32 v[40:41], v[78:79], v[150:151], v[40:41] op_sel:[0,1,0] neg_lo:[1,0,0] neg_hi:[1,0,0]
v_pk_mul_f32 v[78:79], v[78:79], v[150:151] op_sel_hi:[1,0]
v_pk_fma_f32 v[78:79], v[104:105], v[150:151], v[78:79] op_sel:[0,1,0]
v_mul_f32 v151, 0x3e300000, v9
v_cos_f32 v150, v151
v_sin_f32 v151, v151
v_pk_mul_f32 v[104:105], v[136:137], v[148:149] op_sel_hi:[1,0]
v_pk_fma_f32 v[104:105], v[46:47], v[148:149], v[104:105] op_sel:[0,1,0] neg_lo:[1,0,0] neg_hi:[1,0,0]
v_pk_mul_f32 v[46:47], v[46:47], v[148:149] op_sel_hi:[1,0]
v_pk_fma_f32 v[46:47], v[136:137], v[148:149], v[46:47] op_sel:[0,1,0]
v_mul_f32 v149, 0x3e400000, v9
v_cos_f32 v148, v149
v_sin_f32 v149, v149
v_pk_mul_f32 v[136:137], v[76:77], v[150:151] op_sel_hi:[1,0]
v_pk_fma_f32 v[136:137], v[110:111], v[150:151], v[136:137] op_sel:[0,1,0] neg_lo:[1,0,0] neg_hi:[1,0,0]
v_pk_mul_f32 v[110:111], v[110:111], v[150:151] op_sel_hi:[1,0]
v_pk_fma_f32 v[110:111], v[76:77], v[150:151], v[110:111] op_sel:[0,1,0]
v_mul_f32 v151, 0x3e500000, v9
v_cos_f32 v150, v151
v_sin_f32 v151, v151
v_pk_mul_f32 v[76:77], v[44:45], v[148:149] op_sel_hi:[1,0]
v_pk_fma_f32 v[76:77], v[30:31], v[148:149], v[76:77] op_sel:[0,1,0] neg_lo:[1,0,0] neg_hi:[1,0,0]
v_pk_mul_f32 v[30:31], v[30:31], v[148:149] op_sel_hi:[1,0]
v_pk_fma_f32 v[30:31], v[44:45], v[148:149], v[30:31] op_sel:[0,1,0]
v_mul_f32 v149, 0x3e600000, v9
v_cos_f32 v148, v149
v_sin_f32 v149, v149
v_pk_mul_f32 v[44:45], v[108:109], v[150:151] op_sel_hi:[1,0]
v_pk_fma_f32 v[44:45], v[94:95], v[150:151], v[44:45] op_sel:[0,1,0] neg_lo:[1,0,0] neg_hi:[1,0,0]
v_pk_mul_f32 v[94:95], v[94:95], v[150:151] op_sel_hi:[1,0]
v_pk_fma_f32 v[94:95], v[108:109], v[150:151], v[94:95] op_sel:[0,1,0]
v_mul_f32 v151, 0x3e700000, v9
v_cos_f32 v150, v151
v_sin_f32 v151, v151
v_pk_mul_f32 v[108:109], v[28:29], v[148:149] op_sel_hi:[1,0]
v_pk_fma_f32 v[108:109], v[62:63], v[148:149], v[108:109] op_sel:[0,1,0] neg_lo:[1,0,0] neg_hi:[1,0,0]
v_pk_mul_f32 v[62:63], v[62:63], v[148:149] op_sel_hi:[1,0]
v_pk_fma_f32 v[62:63], v[28:29], v[148:149], v[62:63] op_sel:[0,1,0]
v_mul_f32 v149, 0x3e800000, v9
v_cos_f32 v148, v149
v_sin_f32 v149, v149
v_pk_mul_f32 v[28:29], v[92:93], v[150:151] op_sel_hi:[1,0]
v_pk_fma_f32 v[28:29], v[126:127], v[150:151], v[28:29] op_sel:[0,1,0] neg_lo:[1,0,0] neg_hi:[1,0,0]
v_pk_mul_f32 v[126:127], v[126:127], v[150:151] op_sel_hi:[1,0]
v_pk_fma_f32 v[126:127], v[92:93], v[150:151], v[126:127] op_sel:[0,1,0]
v_mul_f32 v151, 0x3e880000, v9
v_cos_f32 v150, v151
v_sin_f32 v151, v151
v_pk_mul_f32 v[92:93], v[60:61], v[148:149] op_sel_hi:[1,0]
v_pk_fma_f32 v[92:93], v[142:143], v[148:149], v[92:93] op_sel:[0,1,0] neg_lo:[1,0,0] neg_hi:[1,0,0]
v_pk_mul_f32 v[142:143], v[142:143], v[148:149] op_sel_hi:[1,0]
v_pk_fma_f32 v[142:143], v[60:61], v[148:149], v[142:143] op_sel:[0,1,0]
v_mul_f32 v149, 0x3e900000, v9
v_cos_f32 v148, v149
v_sin_f32 v149, v149
v_pk_mul_f32 v[60:61], v[124:125], v[150:151] op_sel_hi:[1,0]
v_pk_fma_f32 v[60:61], v[50:51], v[150:151], v[60:61] op_sel:[0,1,0] neg_lo:[1,0,0] neg_hi:[1,0,0]
v_pk_mul_f32 v[50:51], v[50:51], v[150:151] op_sel_hi:[1,0]
v_pk_fma_f32 v[50:51], v[124:125], v[150:151], v[50:51] op_sel:[0,1,0]
v_mul_f32 v151, 0x3e980000, v9
v_cos_f32 v150, v151
v_sin_f32 v151, v151
v_pk_mul_f32 v[124:125], v[140:141], v[148:149] op_sel_hi:[1,0]
v_pk_fma_f32 v[124:125], v[34:35], v[148:149], v[124:125] op_sel:[0,1,0] neg_lo:[1,0,0] neg_hi:[1,0,0]
v_pk_mul_f32 v[34:35], v[34:35], v[148:149] op_sel_hi:[1,0]
v_pk_fma_f32 v[34:35], v[140:141], v[148:149], v[34:35] op_sel:[0,1,0]
v_mul_f32 v149, 0x3ea00000, v9
v_cos_f32 v148, v149
v_sin_f32 v149, v149
v_pk_mul_f32 v[140:141], v[48:49], v[150:151] op_sel_hi:[1,0]
v_pk_fma_f32 v[140:141], v[98:99], v[150:151], v[140:141] op_sel:[0,1,0] neg_lo:[1,0,0] neg_hi:[1,0,0]
v_pk_mul_f32 v[98:99], v[98:99], v[150:151] op_sel_hi:[1,0]
v_pk_fma_f32 v[98:99], v[48:49], v[150:151], v[98:99] op_sel:[0,1,0]
v_mul_f32 v151, 0x3ea80000, v9
v_cos_f32 v150, v151
v_sin_f32 v151, v151
v_pk_mul_f32 v[48:49], v[32:33], v[148:149] op_sel_hi:[1,0]
v_pk_fma_f32 v[48:49], v[26:27], v[148:149], v[48:49] op_sel:[0,1,0] neg_lo:[1,0,0] neg_hi:[1,0,0]
v_pk_mul_f32 v[26:27], v[26:27], v[148:149] op_sel_hi:[1,0]
v_pk_fma_f32 v[26:27], v[32:33], v[148:149], v[26:27] op_sel:[0,1,0]
v_mul_f32 v149, 0x3eb00000, v9
v_cos_f32 v148, v149
v_sin_f32 v149, v149
v_pk_mul_f32 v[32:33], v[96:97], v[150:151] op_sel_hi:[1,0]
v_pk_fma_f32 v[32:33], v[90:91], v[150:151], v[32:33] op_sel:[0,1,0] neg_lo:[1,0,0] neg_hi:[1,0,0]
v_pk_mul_f32 v[90:91], v[90:91], v[150:151] op_sel_hi:[1,0]
v_pk_fma_f32 v[90:91], v[96:97], v[150:151], v[90:91] op_sel:[0,1,0]
v_mul_f32 v151, 0x3eb80000, v9
v_cos_f32 v150, v151
v_sin_f32 v151, v151
v_pk_mul_f32 v[96:97], v[24:25], v[148:149] op_sel_hi:[1,0]
v_pk_fma_f32 v[96:97], v[58:59], v[148:149], v[96:97] op_sel:[0,1,0] neg_lo:[1,0,0] neg_hi:[1,0,0]
v_pk_mul_f32 v[58:59], v[58:59], v[148:149] op_sel_hi:[1,0]
v_pk_fma_f32 v[58:59], v[24:25], v[148:149], v[58:59] op_sel:[0,1,0]
v_mul_f32 v149, 0x3ec00000, v9
v_cos_f32 v148, v149
v_sin_f32 v149, v149
v_pk_mul_f32 v[24:25], v[88:89], v[150:151] op_sel_hi:[1,0]
v_pk_fma_f32 v[24:25], v[122:123], v[150:151], v[24:25] op_sel:[0,1,0] neg_lo:[1,0,0] neg_hi:[1,0,0]
v_pk_mul_f32 v[122:123], v[122:123], v[150:151] op_sel_hi:[1,0]
v_pk_fma_f32 v[122:123], v[88:89], v[150:151], v[122:123] op_sel:[0,1,0]
v_mul_f32 v151, 0x3ec80000, v9
v_cos_f32 v150, v151
v_sin_f32 v151, v151
v_pk_mul_f32 v[88:89], v[56:57], v[148:149] op_sel_hi:[1,0]
v_pk_fma_f32 v[88:89], v[22:23], v[148:149], v[88:89] op_sel:[0,1,0] neg_lo:[1,0,0] neg_hi:[1,0,0]
v_pk_mul_f32 v[22:23], v[22:23], v[148:149] op_sel_hi:[1,0]
v_pk_fma_f32 v[22:23], v[56:57], v[148:149], v[22:23] op_sel:[0,1,0]
v_mul_f32 v149, 0x3ed00000, v9
v_cos_f32 v148, v149
v_sin_f32 v149, v149
v_pk_mul_f32 v[56:57], v[120:121], v[150:151] op_sel_hi:[1,0]
v_pk_fma_f32 v[56:57], v[86:87], v[150:151], v[56:57] op_sel:[0,1,0] neg_lo:[1,0,0] neg_hi:[1,0,0]
v_pk_mul_f32 v[86:87], v[86:87], v[150:151] op_sel_hi:[1,0]
v_pk_fma_f32 v[86:87], v[120:121], v[150:151], v[86:87] op_sel:[0,1,0]
v_mul_f32 v151, 0x3ed80000, v9
v_cos_f32 v150, v151
v_sin_f32 v151, v151
v_pk_mul_f32 v[120:121], v[20:21], v[148:149] op_sel_hi:[1,0]
v_pk_fma_f32 v[120:121], v[54:55], v[148:149], v[120:121] op_sel:[0,1,0] neg_lo:[1,0,0] neg_hi:[1,0,0]
v_pk_mul_f32 v[54:55], v[54:55], v[148:149] op_sel_hi:[1,0]
v_pk_fma_f32 v[54:55], v[20:21], v[148:149], v[54:55] op_sel:[0,1,0]
v_mul_f32 v149, 0x3ee00000, v9
v_cos_f32 v148, v149
v_sin_f32 v149, v149
v_pk_mul_f32 v[20:21], v[84:85], v[150:151] op_sel_hi:[1,0]
v_pk_fma_f32 v[20:21], v[118:119], v[150:151], v[20:21] op_sel:[0,1,0] neg_lo:[1,0,0] neg_hi:[1,0,0]
v_pk_mul_f32 v[118:119], v[118:119], v[150:151] op_sel_hi:[1,0]
v_pk_fma_f32 v[118:119], v[84:85], v[150:151], v[118:119] op_sel:[0,1,0]
v_mul_f32 v151, 0x3ee80000, v9
v_cos_f32 v150, v151
v_sin_f32 v151, v151
v_pk_mul_f32 v[84:85], v[52:53], v[148:149] op_sel_hi:[1,0]
v_pk_fma_f32 v[84:85], v[38:39], v[148:149], v[84:85] op_sel:[0,1,0] neg_lo:[1,0,0] neg_hi:[1,0,0]
v_pk_mul_f32 v[38:39], v[38:39], v[148:149] op_sel_hi:[1,0]
v_pk_fma_f32 v[38:39], v[52:53], v[148:149], v[38:39] op_sel:[0,1,0]
v_mul_f32 v149, 0x3ef00000, v9
v_cos_f32 v148, v149
v_sin_f32 v149, v149
v_pk_mul_f32 v[52:53], v[116:117], v[150:151] op_sel_hi:[1,0]
v_pk_fma_f32 v[52:53], v[102:103], v[150:151], v[52:53] op_sel:[0,1,0] neg_lo:[1,0,0] neg_hi:[1,0,0]
v_pk_mul_f32 v[102:103], v[102:103], v[150:151] op_sel_hi:[1,0]
v_pk_fma_f32 v[102:103], v[116:117], v[150:151], v[102:103] op_sel:[0,1,0]
v_mul_f32 v151, 0x3ef80000, v9
v_cos_f32 v150, v151
v_sin_f32 v151, v151
v_pk_mul_f32 v[116:117], v[36:37], v[148:149] op_sel_hi:[1,0]
v_pk_fma_f32 v[116:117], v[70:71], v[148:149], v[116:117] op_sel:[0,1,0] neg_lo:[1,0,0] neg_hi:[1,0,0]
v_pk_mul_f32 v[70:71], v[70:71], v[148:149] op_sel_hi:[1,0]
v_pk_fma_f32 v[70:71], v[36:37], v[148:149], v[70:71] op_sel:[0,1,0]
s_nop 0
v_pk_mul_f32 v[36:37], v[100:101], v[150:151] op_sel_hi:[1,0]
v_pk_fma_f32 v[36:37], v[134:135], v[150:151], v[36:37] op_sel:[0,1,0] neg_lo:[1,0,0] neg_hi:[1,0,0]
v_pk_mul_f32 v[134:135], v[134:135], v[150:151] op_sel_hi:[1,0]
v_pk_fma_f32 v[134:135], v[100:101], v[150:151], v[134:135] op_sel:[0,1,0]
v_pk_add_f32 v[100:101], v[132:133], v[92:93] neg_lo:[0,1] neg_hi:[0,1]
v_pk_add_f32 v[82:83], v[18:19], v[142:143] neg_lo:[0,1] neg_hi:[0,1]
v_pk_add_f32 v[132:133], v[132:133], v[92:93]
v_pk_add_f32 v[18:19], v[18:19], v[142:143]
v_pk_add_f32 v[92:93], v[68:69], v[60:61] neg_lo:[0,1] neg_hi:[0,1]
v_pk_add_f32 v[142:143], v[146:147], v[50:51] neg_lo:[0,1] neg_hi:[0,1]
v_pk_add_f32 v[68:69], v[68:69], v[60:61]
v_pk_add_f32 v[146:147], v[146:147], v[50:51]
v_pk_mul_f32 v[60:61], v[92:93], s[30:31] op_sel_hi:[1,0]
v_pk_mul_f32 v[50:51], v[92:93], s[36:37] op_sel_hi:[1,0]
v_pk_fma_f32 v[60:61], v[142:143], s[36:37], v[60:61] op_sel_hi:[1,0,1] neg_lo:[0,1,0] neg_hi:[0,1,0]
v_pk_fma_f32 v[50:51], v[142:143], s[30:31], v[50:51] op_sel_hi:[1,0,1]
v_pk_add_f32 v[92:93], v[16:17], v[124:125] neg_lo:[0,1] neg_hi:[0,1]
v_pk_add_f32 v[142:143], v[114:115], v[34:35] neg_lo:[0,1] neg_hi:[0,1]
v_pk_add_f32 v[16:17], v[16:17], v[124:125]
v_pk_add_f32 v[114:115], v[114:115], v[34:35]
v_pk_mul_f32 v[124:125], v[92:93], s[30:31] op_sel:[0,1]
v_pk_mul_f32 v[34:35], v[92:93], s[34:35] op_sel:[0,1]
v_pk_fma_f32 v[124:125], v[142:143], s[34:35], v[124:125] op_sel:[0,1,0] neg_lo:[0,1,0] neg_hi:[0,1,0]
v_pk_fma_f32 v[34:35], v[142:143], s[30:31], v[34:35] op_sel:[0,1,0]
v_pk_add_f32 v[92:93], v[80:81], v[140:141] neg_lo:[0,1] neg_hi:[0,1]
v_pk_add_f32 v[142:143], v[66:67], v[98:99] neg_lo:[0,1] neg_hi:[0,1]
v_pk_add_f32 v[80:81], v[80:81], v[140:141]
v_pk_add_f32 v[66:67], v[66:67], v[98:99]
v_pk_mul_f32 v[140:141], v[92:93], s[32:33] op_sel_hi:[1,0]
v_pk_mul_f32 v[98:99], v[92:93], s[34:35] op_sel_hi:[1,0]
v_pk_fma_f32 v[140:141], v[142:143], s[34:35], v[140:141] op_sel_hi:[1,0,1] neg_lo:[0,1,0] neg_hi:[0,1,0]
v_pk_fma_f32 v[98:99], v[142:143], s[32:33], v[98:99] op_sel_hi:[1,0,1]
v_pk_add_f32 v[92:93], v[144:145], v[48:49] neg_lo:[0,1] neg_hi:[0,1]
v_pk_add_f32 v[142:143], v[130:131], v[26:27] neg_lo:[0,1] neg_hi:[0,1]
v_pk_add_f32 v[144:145], v[144:145], v[48:49]
v_pk_add_f32 v[130:131], v[130:131], v[26:27]
v_pk_mul_f32 v[48:49], v[92:93], s[32:33] op_sel:[0,1]
v_pk_mul_f32 v[26:27], v[92:93], s[32:33] op_sel:[0,1]
v_pk_fma_f32 v[48:49], v[142:143], s[32:33], v[48:49] op_sel:[0,1,0] neg_lo:[0,1,0] neg_hi:[0,1,0]
v_pk_fma_f32 v[26:27], v[142:143], s[32:33], v[26:27] op_sel:[0,1,0]
v_pk_add_f32 v[92:93], v[112:113], v[32:33] neg_lo:[0,1] neg_hi:[0,1]
v_pk_add_f32 v[142:143], v[74:75], v[90:91] neg_lo:[0,1] neg_hi:[0,1]
v_pk_add_f32 v[112:113], v[112:113], v[32:33]
v_pk_add_f32 v[74:75], v[74:75], v[90:91]
v_pk_mul_f32 v[32:33], v[92:93], s[34:35] op_sel_hi:[1,0]
v_pk_mul_f32 v[90:91], v[92:93], s[32:33] op_sel_hi:[1,0]
v_pk_fma_f32 v[32:33], v[142:143], s[32:33], v[32:33] op_sel_hi:[1,0,1] neg_lo:[0,1,0] neg_hi:[0,1,0]
v_pk_fma_f32 v[90:91], v[142:143], s[34:35], v[90:91] op_sel_hi:[1,0,1]
v_pk_add_f32 v[92:93], v[64:65], v[96:97] neg_lo:[0,1] neg_hi:[0,1]
v_pk_add_f32 v[142:143], v[42:43], v[58:59] neg_lo:[0,1] neg_hi:[0,1]
v_pk_add_f32 v[64:65], v[64:65], v[96:97]
v_pk_add_f32 v[42:43], v[42:43], v[58:59]
v_pk_mul_f32 v[96:97], v[92:93], s[34:35] op_sel:[0,1]
v_pk_mul_f32 v[58:59], v[92:93], s[30:31] op_sel:[0,1]
v_pk_fma_f32 v[96:97], v[142:143], s[30:31], v[96:97] op_sel:[0,1,0] neg_lo:[0,1,0] neg_hi:[0,1,0]
v_pk_fma_f32 v[58:59], v[142:143], s[34:35], v[58:59] op_sel:[0,1,0]
v_pk_add_f32 v[92:93], v[128:129], v[24:25] neg_lo:[0,1] neg_hi:[0,1]
v_pk_add_f32 v[142:143], v[106:107], v[122:123] neg_lo:[0,1] neg_hi:[0,1]
v_pk_add_f32 v[128:129], v[128:129], v[24:25]
v_pk_add_f32 v[106:107], v[106:107], v[122:123]
v_pk_mul_f32 v[24:25], v[92:93], s[36:37] op_sel_hi:[1,0]
v_pk_mul_f32 v[122:123], v[92:93], s[30:31] op_sel_hi:[1,0]
v_pk_fma_f32 v[24:25], v[142:143], s[30:31], v[24:25] op_sel_hi:[1,0,1] neg_lo:[0,1,0] neg_hi:[0,1,0]
v_pk_fma_f32 v[122:123], v[142:143], s[36:37], v[122:123] op_sel_hi:[1,0,1]
v_pk_add_f32 v[92:93], v[22:23], v[138:139] neg_lo:[0,1] neg_hi:[0,1]
v_pk_add_f32 v[142:143], v[72:73], v[88:89] neg_lo:[0,1] neg_hi:[0,1]
v_pk_add_f32 v[72:73], v[72:73], v[88:89]
v_pk_add_f32 v[138:139], v[138:139], v[22:23]
v_pk_add_f32 v[88:89], v[40:41], v[56:57] neg_lo:[0,1] neg_hi:[0,1]
v_pk_add_f32 v[22:23], v[78:79], v[86:87] neg_lo:[0,1] neg_hi:[0,1]
v_pk_add_f32 v[40:41], v[40:41], v[56:57]
v_pk_add_f32 v[78:79], v[78:79], v[86:87]
v_pk_mul_f32 v[56:57], v[88:89], s[36:37] op_sel_hi:[1,0] neg_lo:[0,1] neg_hi:[0,1]
v_pk_mul_f32 v[86:87], v[88:89], s[30:31] op_sel_hi:[1,0]
v_pk_fma_f32 v[56:57], v[22:23], s[30:31], v[56:57] op_sel_hi:[1,0,1] neg_lo:[0,1,0] neg_hi:[0,1,0]
v_pk_fma_f32 v[86:87], v[22:23], s[36:37], v[86:87] op_sel_hi:[1,0,1] neg_lo:[0,1,0] neg_hi:[0,1,0]
v_pk_add_f32 v[88:89], v[104:105], v[120:121] neg_lo:[0,1] neg_hi:[0,1]
v_pk_add_f32 v[22:23], v[46:47], v[54:55] neg_lo:[0,1] neg_hi:[0,1]
v_pk_add_f32 v[104:105], v[104:105], v[120:121]
v_pk_add_f32 v[46:47], v[46:47], v[54:55]
v_pk_mul_f32 v[120:121], v[88:89], s[34:35] op_sel:[0,1] neg_lo:[0,1] neg_hi:[0,1]
v_pk_mul_f32 v[54:55], v[88:89], s[30:31] op_sel:[0,1]
v_pk_fma_f32 v[120:121], v[22:23], s[30:31], v[120:121] op_sel:[0,1,0] neg_lo:[0,1,0] neg_hi:[0,1,0]
v_pk_fma_f32 v[54:55], v[22:23], s[34:35], v[54:55] op_sel:[0,1,0] neg_lo:[0,1,0] neg_hi:[0,1,0]
v_pk_add_f32 v[88:89], v[136:137], v[20:21] neg_lo:[0,1] neg_hi:[0,1]
v_pk_add_f32 v[22:23], v[110:111], v[118:119] neg_lo:[0,1] neg_hi:[0,1]
v_pk_add_f32 v[136:137], v[136:137], v[20:21]
v_pk_add_f32 v[110:111], v[110:111], v[118:119]
v_pk_mul_f32 v[20:21], v[88:89], s[34:35] op_sel_hi:[1,0] neg_lo:[0,1] neg_hi:[0,1]
v_pk_mul_f32 v[118:119], v[88:89], s[32:33] op_sel_hi:[1,0]
v_pk_fma_f32 v[20:21], v[22:23], s[32:33], v[20:21] op_sel_hi:[1,0,1] neg_lo:[0,1,0] neg_hi:[0,1,0]
v_pk_fma_f32 v[118:119], v[22:23], s[34:35], v[118:119] op_sel_hi:[1,0,1] neg_lo:[0,1,0] neg_hi:[0,1,0]
v_pk_add_f32 v[88:89], v[76:77], v[84:85] neg_lo:[0,1] neg_hi:[0,1]
v_pk_add_f32 v[22:23], v[30:31], v[38:39] neg_lo:[0,1] neg_hi:[0,1]
v_pk_add_f32 v[76:77], v[76:77], v[84:85]
v_pk_add_f32 v[30:31], v[30:31], v[38:39]
v_pk_mul_f32 v[84:85], v[88:89], s[32:33] op_sel:[0,1] neg_lo:[0,1] neg_hi:[0,1]
v_pk_mul_f32 v[38:39], v[88:89], s[32:33] op_sel:[0,1]
v_pk_fma_f32 v[84:85], v[22:23], s[32:33], v[84:85] op_sel:[0,1,0] neg_lo:[0,1,0] neg_hi:[0,1,0]
v_pk_fma_f32 v[38:39], v[22:23], s[32:33], v[38:39] op_sel:[0,1,0] neg_lo:[0,1,0] neg_hi:[0,1,0]
v_pk_add_f32 v[88:89], v[44:45], v[52:53] neg_lo:[0,1] neg_hi:[0,1]
v_pk_add_f32 v[22:23], v[94:95], v[102:103] neg_lo:[0,1] neg_hi:[0,1]
v_pk_add_f32 v[44:45], v[44:45], v[52:53]
v_pk_add_f32 v[94:95], v[94:95], v[102:103]
v_pk_mul_f32 v[52:53], v[88:89], s[32:33] op_sel_hi:[1,0] neg_lo:[0,1] neg_hi:[0,1]
v_pk_mul_f32 v[102:103], v[88:89], s[34:35] op_sel_hi:[1,0]
v_pk_fma_f32 v[52:53], v[22:23], s[34:35], v[52:53] op_sel_hi:[1,0,1] neg_lo:[0,1,0] neg_hi:[0,1,0]
v_pk_fma_f32 v[102:103], v[22:23], s[32:33], v[102:103] op_sel_hi:[1,0,1] neg_lo:[0,1,0] neg_hi:[0,1,0]
v_pk_add_f32 v[88:89], v[108:109], v[116:117] neg_lo:[0,1] neg_hi:[0,1]
v_pk_add_f32 v[22:23], v[62:63], v[70:71] neg_lo:[0,1] neg_hi:[0,1]
v_pk_add_f32 v[108:109], v[108:109], v[116:117]
v_pk_add_f32 v[62:63], v[62:63], v[70:71]
v_pk_mul_f32 v[116:117], v[88:89], s[30:31] op_sel:[0,1] neg_lo:[0,1] neg_hi:[0,1]
v_pk_mul_f32 v[70:71], v[88:89], s[34:35] op_sel:[0,1]
v_pk_fma_f32 v[116:117], v[22:23], s[34:35], v[116:117] op_sel:[0,1,0] neg_lo:[0,1,0] neg_hi:[0,1,0]
v_pk_fma_f32 v[70:71], v[22:23], s[30:31], v[70:71] op_sel:[0,1,0] neg_lo:[0,1,0] neg_hi:[0,1,0]
v_pk_add_f32 v[88:89], v[28:29], v[36:37] neg_lo:[0,1] neg_hi:[0,1]
v_pk_add_f32 v[22:23], v[126:127], v[134:135] neg_lo:[0,1] neg_hi:[0,1]
v_pk_add_f32 v[28:29], v[28:29], v[36:37]
v_pk_add_f32 v[126:127], v[126:127], v[134:135]
v_pk_mul_f32 v[36:37], v[88:89], s[30:31] op_sel_hi:[1,0] neg_lo:[0,1] neg_hi:[0,1]
v_pk_mul_f32 v[134:135], v[88:89], s[36:37] op_sel_hi:[1,0]
v_pk_fma_f32 v[36:37], v[22:23], s[36:37], v[36:37] op_sel_hi:[1,0,1] neg_lo:[0,1,0] neg_hi:[0,1,0]
v_pk_fma_f32 v[134:135], v[22:23], s[30:31], v[134:135] op_sel_hi:[1,0,1] neg_lo:[0,1,0] neg_hi:[0,1,0]
v_pk_add_f32 v[88:89], v[132:133], v[72:73] neg_lo:[0,1] neg_hi:[0,1]
v_pk_add_f32 v[22:23], v[18:19], v[138:139] neg_lo:[0,1] neg_hi:[0,1]
v_pk_add_f32 v[132:133], v[132:133], v[72:73]
v_pk_add_f32 v[18:19], v[18:19], v[138:139]
v_pk_add_f32 v[72:73], v[68:69], v[40:41] neg_lo:[0,1] neg_hi:[0,1]
v_pk_add_f32 v[138:139], v[146:147], v[78:79] neg_lo:[0,1] neg_hi:[0,1]
v_pk_add_f32 v[68:69], v[68:69], v[40:41]
v_pk_add_f32 v[146:147], v[146:147], v[78:79]
v_pk_mul_f32 v[40:41], v[72:73], s[30:31] op_sel:[0,1]
v_pk_mul_f32 v[78:79], v[72:73], s[34:35] op_sel:[0,1]
v_pk_fma_f32 v[40:41], v[138:139], s[34:35], v[40:41] op_sel:[0,1,0] neg_lo:[0,1,0] neg_hi:[0,1,0]
v_pk_fma_f32 v[78:79], v[138:139], s[30:31], v[78:79] op_sel:[0,1,0]
v_pk_add_f32 v[72:73], v[16:17], v[104:105] neg_lo:[0,1] neg_hi:[0,1]
v_pk_add_f32 v[138:139], v[114:115], v[46:47] neg_lo:[0,1] neg_hi:[0,1]
v_pk_add_f32 v[16:17], v[16:17], v[104:105]
v_pk_add_f32 v[114:115], v[114:115], v[46:47]
v_pk_mul_f32 v[104:105], v[72:73], s[32:33] op_sel:[0,1]
v_pk_mul_f32 v[46:47], v[72:73], s[32:33] op_sel:[0,1]
v_pk_fma_f32 v[104:105], v[138:139], s[32:33], v[104:105] op_sel:[0,1,0] neg_lo:[0,1,0] neg_hi:[0,1,0]
v_pk_fma_f32 v[46:47], v[138:139], s[32:33], v[46:47] op_sel:[0,1,0]
v_pk_add_f32 v[72:73], v[80:81], v[136:137] neg_lo:[0,1] neg_hi:[0,1]
v_pk_add_f32 v[138:139], v[66:67], v[110:111] neg_lo:[0,1] neg_hi:[0,1]
v_pk_add_f32 v[80:81], v[80:81], v[136:137]
v_pk_add_f32 v[66:67], v[66:67], v[110:111]
v_pk_mul_f32 v[136:137], v[72:73], s[34:35] op_sel:[0,1]
v_pk_mul_f32 v[110:111], v[72:73], s[30:31] op_sel:[0,1]
v_pk_fma_f32 v[136:137], v[138:139], s[30:31], v[136:137] op_sel:[0,1,0] neg_lo:[0,1,0] neg_hi:[0,1,0]
v_pk_fma_f32 v[110:111], v[138:139], s[34:35], v[110:111] op_sel:[0,1,0]
v_pk_add_f32 v[72:73], v[30:31], v[130:131] neg_lo:[0,1] neg_hi:[0,1]
v_pk_add_f32 v[138:139], v[144:145], v[76:77] neg_lo:[0,1] neg_hi:[0,1]
v_pk_add_f32 v[144:145], v[144:145], v[76:77]
v_pk_add_f32 v[130:131], v[130:131], v[30:31]
v_pk_add_f32 v[76:77], v[112:113], v[44:45] neg_lo:[0,1] neg_hi:[0,1]
v_pk_add_f32 v[30:31], v[74:75], v[94:95] neg_lo:[0,1] neg_hi:[0,1]
v_pk_add_f32 v[112:113], v[112:113], v[44:45]
v_pk_add_f32 v[74:75], v[74:75], v[94:95]
v_pk_mul_f32 v[44:45], v[76:77], s[34:35] op_sel:[0,1] neg_lo:[0,1] neg_hi:[0,1]
v_pk_mul_f32 v[94:95], v[76:77], s[30:31] op_sel:[0,1]
v_pk_fma_f32 v[44:45], v[30:31], s[30:31], v[44:45] op_sel:[0,1,0] neg_lo:[0,1,0] neg_hi:[0,1,0]
v_pk_fma_f32 v[94:95], v[30:31], s[34:35], v[94:95] op_sel:[0,1,0] neg_lo:[0,1,0] neg_hi:[0,1,0]
v_pk_add_f32 v[76:77], v[64:65], v[108:109] neg_lo:[0,1] neg_hi:[0,1]
v_pk_add_f32 v[30:31], v[42:43], v[62:63] neg_lo:[0,1] neg_hi:[0,1]
v_pk_add_f32 v[64:65], v[64:65], v[108:109]
v_pk_add_f32 v[42:43], v[42:43], v[62:63]
v_pk_mul_f32 v[108:109], v[76:77], s[32:33] op_sel:[0,1] neg_lo:[0,1] neg_hi:[0,1]
v_pk_mul_f32 v[62:63], v[76:77], s[32:33] op_sel:[0,1]
v_pk_fma_f32 v[108:109], v[30:31], s[32:33], v[108:109] op_sel:[0,1,0] neg_lo:[0,1,0] neg_hi:[0,1,0]
v_pk_fma_f32 v[62:63], v[30:31], s[32:33], v[62:63] op_sel:[0,1,0] neg_lo:[0,1,0] neg_hi:[0,1,0]
v_pk_add_f32 v[76:77], v[128:129], v[28:29] neg_lo:[0,1] neg_hi:[0,1]
v_pk_add_f32 v[30:31], v[106:107], v[126:127] neg_lo:[0,1] neg_hi:[0,1]
v_pk_add_f32 v[128:129], v[128:129], v[28:29]
v_pk_add_f32 v[106:107], v[106:107], v[126:127]
v_pk_mul_f32 v[28:29], v[76:77], s[30:31] op_sel:[0,1] neg_lo:[0,1] neg_hi:[0,1]
v_pk_mul_f32 v[126:127], v[76:77], s[34:35] op_sel:[0,1]
v_pk_fma_f32 v[28:29], v[30:31], s[34:35], v[28:29] op_sel:[0,1,0] neg_lo:[0,1,0] neg_hi:[0,1,0]
v_pk_fma_f32 v[126:127], v[30:31], s[30:31], v[126:127] op_sel:[0,1,0] neg_lo:[0,1,0] neg_hi:[0,1,0]
v_pk_add_f32 v[76:77], v[100:101], v[92:93] neg_lo:[0,1] neg_hi:[0,1]
v_pk_add_f32 v[30:31], v[82:83], v[142:143] neg_lo:[0,1] neg_hi:[0,1]
v_pk_add_f32 v[100:101], v[100:101], v[92:93]
v_pk_add_f32 v[82:83], v[82:83], v[142:143]
v_pk_add_f32 v[92:93], v[60:61], v[56:57] neg_lo:[0,1] neg_hi:[0,1]
v_pk_add_f32 v[142:143], v[50:51], v[86:87] neg_lo:[0,1] neg_hi:[0,1]
v_pk_add_f32 v[60:61], v[60:61], v[56:57]
v_pk_add_f32 v[50:51], v[50:51], v[86:87]
v_pk_mul_f32 v[56:57], v[92:93], s[30:31] op_sel:[0,1]
v_pk_mul_f32 v[86:87], v[92:93], s[34:35] op_sel:[0,1]
v_pk_fma_f32 v[56:57], v[142:143], s[34:35], v[56:57] op_sel:[0,1,0] neg_lo:[0,1,0] neg_hi:[0,1,0]
v_pk_fma_f32 v[86:87], v[142:143], s[30:31], v[86:87] op_sel:[0,1,0]
v_pk_add_f32 v[92:93], v[124:125], v[120:121] neg_lo:[0,1] neg_hi:[0,1]
v_pk_add_f32 v[142:143], v[34:35], v[54:55] neg_lo:[0,1] neg_hi:[0,1]
v_pk_add_f32 v[124:125], v[124:125], v[120:121]
v_pk_add_f32 v[34:35], v[34:35], v[54:55]
v_pk_mul_f32 v[120:121], v[92:93], s[32:33] op_sel:[0,1]
v_pk_mul_f32 v[54:55], v[92:93], s[32:33] op_sel:[0,1]
v_pk_fma_f32 v[120:121], v[142:143], s[32:33], v[120:121] op_sel:[0,1,0] neg_lo:[0,1,0] neg_hi:[0,1,0]
v_pk_fma_f32 v[54:55], v[142:143], s[32:33], v[54:55] op_sel:[0,1,0]
v_pk_add_f32 v[92:93], v[140:141], v[20:21] neg_lo:[0,1] neg_hi:[0,1]
v_pk_add_f32 v[142:143], v[98:99], v[118:119] neg_lo:[0,1] neg_hi:[0,1]
v_pk_add_f32 v[140:141], v[140:141], v[20:21]
v_pk_add_f32 v[98:99], v[98:99], v[118:119]
v_pk_mul_f32 v[20:21], v[92:93], s[34:35] op_sel:[0,1]
v_pk_mul_f32 v[118:119], v[92:93], s[30:31] op_sel:[0,1]
v_pk_fma_f32 v[20:21], v[142:143], s[30:31], v[20:21] op_sel:[0,1,0] neg_lo:[0,1,0] neg_hi:[0,1,0]
v_pk_fma_f32 v[118:119], v[142:143], s[34:35], v[118:119] op_sel:[0,1,0]
v_pk_add_f32 v[92:93], v[38:39], v[26:27] neg_lo:[0,1] neg_hi:[0,1]
v_pk_add_f32 v[142:143], v[48:49], v[84:85] neg_lo:[0,1] neg_hi:[0,1]
v_pk_add_f32 v[48:49], v[48:49], v[84:85]
v_pk_add_f32 v[26:27], v[26:27], v[38:39]
v_pk_add_f32 v[84:85], v[32:33], v[52:53] neg_lo:[0,1] neg_hi:[0,1]
v_pk_add_f32 v[38:39], v[90:91], v[102:103] neg_lo:[0,1] neg_hi:[0,1]
v_pk_add_f32 v[32:33], v[32:33], v[52:53]
v_pk_add_f32 v[90:91], v[90:91], v[102:103]
v_pk_mul_f32 v[52:53], v[84:85], s[34:35] op_sel:[0,1] neg_lo:[0,1] neg_hi:[0,1]
v_pk_mul_f32 v[102:103], v[84:85], s[30:31] op_sel:[0,1]
v_pk_fma_f32 v[52:53], v[38:39], s[30:31], v[52:53] op_sel:[0,1,0] neg_lo:[0,1,0] neg_hi:[0,1,0]
v_pk_fma_f32 v[102:103], v[38:39], s[34:35], v[102:103] op_sel:[0,1,0] neg_lo:[0,1,0] neg_hi:[0,1,0]
v_pk_add_f32 v[84:85], v[96:97], v[116:117] neg_lo:[0,1] neg_hi:[0,1]
v_pk_add_f32 v[38:39], v[58:59], v[70:71] neg_lo:[0,1] neg_hi:[0,1]
v_pk_add_f32 v[96:97], v[96:97], v[116:117]
v_pk_add_f32 v[58:59], v[58:59], v[70:71]
v_pk_mul_f32 v[116:117], v[84:85], s[32:33] op_sel:[0,1] neg_lo:[0,1] neg_hi:[0,1]
v_pk_mul_f32 v[70:71], v[84:85], s[32:33] op_sel:[0,1]
v_pk_fma_f32 v[116:117], v[38:39], s[32:33], v[116:117] op_sel:[0,1,0] neg_lo:[0,1,0] neg_hi:[0,1,0]
v_pk_fma_f32 v[70:71], v[38:39], s[32:33], v[70:71] op_sel:[0,1,0] neg_lo:[0,1,0] neg_hi:[0,1,0]
v_pk_add_f32 v[84:85], v[24:25], v[36:37] neg_lo:[0,1] neg_hi:[0,1]
v_pk_add_f32 v[38:39], v[122:123], v[134:135] neg_lo:[0,1] neg_hi:[0,1]
v_pk_add_f32 v[24:25], v[24:25], v[36:37]
v_pk_add_f32 v[122:123], v[122:123], v[134:135]
v_pk_mul_f32 v[36:37], v[84:85], s[30:31] op_sel:[0,1] neg_lo:[0,1] neg_hi:[0,1]
v_pk_mul_f32 v[134:135], v[84:85], s[34:35] op_sel:[0,1]
v_pk_fma_f32 v[36:37], v[38:39], s[34:35], v[36:37] op_sel:[0,1,0] neg_lo:[0,1,0] neg_hi:[0,1,0]
v_pk_fma_f32 v[134:135], v[38:39], s[30:31], v[134:135] op_sel:[0,1,0] neg_lo:[0,1,0] neg_hi:[0,1,0]
v_pk_add_f32 v[84:85], v[132:133], v[144:145] neg_lo:[0,1] neg_hi:[0,1]
v_pk_add_f32 v[38:39], v[18:19], v[130:131] neg_lo:[0,1] neg_hi:[0,1]
v_pk_add_f32 v[132:133], v[132:133], v[144:145]
v_pk_add_f32 v[18:19], v[18:19], v[130:131]
v_pk_add_f32 v[144:145], v[68:69], v[112:113] neg_lo:[0,1] neg_hi:[0,1]
v_pk_add_f32 v[130:131], v[146:147], v[74:75] neg_lo:[0,1] neg_hi:[0,1]
v_pk_add_f32 v[68:69], v[68:69], v[112:113]
v_pk_add_f32 v[146:147], v[146:147], v[74:75]
v_pk_mul_f32 v[112:113], v[144:145], s[32:33] op_sel:[0,1]
v_pk_mul_f32 v[74:75], v[144:145], s[32:33] op_sel:[0,1]
v_pk_fma_f32 v[112:113], v[130:131], s[32:33], v[112:113] op_sel:[0,1,0] neg_lo:[0,1,0] neg_hi:[0,1,0]
v_pk_fma_f32 v[74:75], v[130:131], s[32:33], v[74:75] op_sel:[0,1,0]
v_pk_add_f32 v[144:145], v[42:43], v[114:115] neg_lo:[0,1] neg_hi:[0,1]
v_pk_add_f32 v[130:131], v[16:17], v[64:65] neg_lo:[0,1] neg_hi:[0,1]
v_pk_add_f32 v[16:17], v[16:17], v[64:65]
v_pk_add_f32 v[114:115], v[114:115], v[42:43]
v_pk_add_f32 v[64:65], v[80:81], v[128:129] neg_lo:[0,1] neg_hi:[0,1]
v_pk_add_f32 v[42:43], v[66:67], v[106:107] neg_lo:[0,1] neg_hi:[0,1]
v_pk_add_f32 v[80:81], v[80:81], v[128:129]
v_pk_add_f32 v[66:67], v[66:67], v[106:107]
v_pk_mul_f32 v[128:129], v[64:65], s[32:33] op_sel:[0,1] neg_lo:[0,1] neg_hi:[0,1]
v_pk_mul_f32 v[106:107], v[64:65], s[32:33] op_sel:[0,1]
v_pk_fma_f32 v[128:129], v[42:43], s[32:33], v[128:129] op_sel:[0,1,0] neg_lo:[0,1,0] neg_hi:[0,1,0]
v_pk_fma_f32 v[106:107], v[42:43], s[32:33], v[106:107] op_sel:[0,1,0] neg_lo:[0,1,0] neg_hi:[0,1,0]
v_pk_add_f32 v[64:65], v[88:89], v[72:73] neg_lo:[0,1] neg_hi:[0,1]
v_pk_add_f32 v[42:43], v[22:23], v[138:139] neg_lo:[0,1] neg_hi:[0,1]
v_pk_add_f32 v[88:89], v[88:89], v[72:73]
v_pk_add_f32 v[22:23], v[22:23], v[138:139]
v_pk_add_f32 v[72:73], v[40:41], v[44:45] neg_lo:[0,1] neg_hi:[0,1]
v_pk_add_f32 v[138:139], v[78:79], v[94:95] neg_lo:[0,1] neg_hi:[0,1]
v_pk_add_f32 v[40:41], v[40:41], v[44:45]
v_pk_add_f32 v[78:79], v[78:79], v[94:95]
v_pk_mul_f32 v[44:45], v[72:73], s[32:33] op_sel:[0,1]
v_pk_mul_f32 v[94:95], v[72:73], s[32:33] op_sel:[0,1]
v_pk_fma_f32 v[44:45], v[138:139], s[32:33], v[44:45] op_sel:[0,1,0] neg_lo:[0,1,0] neg_hi:[0,1,0]
v_pk_fma_f32 v[94:95], v[138:139], s[32:33], v[94:95] op_sel:[0,1,0]
v_pk_add_f32 v[72:73], v[62:63], v[46:47] neg_lo:[0,1] neg_hi:[0,1]
v_pk_add_f32 v[138:139], v[104:105], v[108:109] neg_lo:[0,1] neg_hi:[0,1]
v_pk_add_f32 v[104:105], v[104:105], v[108:109]
v_pk_add_f32 v[46:47], v[46:47], v[62:63]
v_pk_add_f32 v[108:109], v[136:137], v[28:29] neg_lo:[0,1] neg_hi:[0,1]
v_pk_add_f32 v[62:63], v[110:111], v[126:127] neg_lo:[0,1] neg_hi:[0,1]
v_pk_add_f32 v[136:137], v[136:137], v[28:29]
v_pk_add_f32 v[110:111], v[110:111], v[126:127]
v_pk_mul_f32 v[28:29], v[108:109], s[32:33] op_sel:[0,1] neg_lo:[0,1] neg_hi:[0,1]
v_pk_mul_f32 v[126:127], v[108:109], s[32:33] op_sel:[0,1]
v_pk_fma_f32 v[28:29], v[62:63], s[32:33], v[28:29] op_sel:[0,1,0] neg_lo:[0,1,0] neg_hi:[0,1,0]
v_pk_fma_f32 v[126:127], v[62:63], s[32:33], v[126:127] op_sel:[0,1,0] neg_lo:[0,1,0] neg_hi:[0,1,0]
v_pk_add_f32 v[108:109], v[100:101], v[48:49] neg_lo:[0,1] neg_hi:[0,1]
v_pk_add_f32 v[62:63], v[82:83], v[26:27] neg_lo:[0,1] neg_hi:[0,1]
v_pk_add_f32 v[100:101], v[100:101], v[48:49]
v_pk_add_f32 v[82:83], v[82:83], v[26:27]
v_pk_add_f32 v[48:49], v[60:61], v[32:33] neg_lo:[0,1] neg_hi:[0,1]
v_pk_add_f32 v[26:27], v[50:51], v[90:91] neg_lo:[0,1] neg_hi:[0,1]
v_pk_add_f32 v[60:61], v[60:61], v[32:33]
v_pk_add_f32 v[50:51], v[50:51], v[90:91]
v_pk_mul_f32 v[32:33], v[48:49], s[32:33] op_sel:[0,1]
v_pk_mul_f32 v[90:91], v[48:49], s[32:33] op_sel:[0,1]
v_pk_fma_f32 v[32:33], v[26:27], s[32:33], v[32:33] op_sel:[0,1,0] neg_lo:[0,1,0] neg_hi:[0,1,0]
v_pk_fma_f32 v[90:91], v[26:27], s[32:33], v[90:91] op_sel:[0,1,0]
v_pk_add_f32 v[48:49], v[58:59], v[34:35] neg_lo:[0,1] neg_hi:[0,1]
v_pk_add_f32 v[26:27], v[124:125], v[96:97] neg_lo:[0,1] neg_hi:[0,1]
v_pk_add_f32 v[124:125], v[124:125], v[96:97]
v_pk_add_f32 v[34:35], v[34:35], v[58:59]
v_pk_add_f32 v[96:97], v[140:141], v[24:25] neg_lo:[0,1] neg_hi:[0,1]
v_pk_add_f32 v[58:59], v[98:99], v[122:123] neg_lo:[0,1] neg_hi:[0,1]
v_pk_add_f32 v[140:141], v[140:141], v[24:25]
v_pk_add_f32 v[98:99], v[98:99], v[122:123]
v_pk_mul_f32 v[24:25], v[96:97], s[32:33] op_sel:[0,1] neg_lo:[0,1] neg_hi:[0,1]
v_pk_mul_f32 v[122:123], v[96:97], s[32:33] op_sel:[0,1]
v_pk_fma_f32 v[24:25], v[58:59], s[32:33], v[24:25] op_sel:[0,1,0] neg_lo:[0,1,0] neg_hi:[0,1,0]
v_pk_fma_f32 v[122:123], v[58:59], s[32:33], v[122:123] op_sel:[0,1,0] neg_lo:[0,1,0] neg_hi:[0,1,0]
v_pk_add_f32 v[96:97], v[76:77], v[92:93] neg_lo:[0,1] neg_hi:[0,1]
v_pk_add_f32 v[58:59], v[30:31], v[142:143] neg_lo:[0,1] neg_hi:[0,1]
v_pk_add_f32 v[76:77], v[76:77], v[92:93]
v_pk_add_f32 v[30:31], v[30:31], v[142:143]
v_pk_add_f32 v[92:93], v[56:57], v[52:53] neg_lo:[0,1] neg_hi:[0,1]
v_pk_add_f32 v[142:143], v[86:87], v[102:103] neg_lo:[0,1] neg_hi:[0,1]
v_pk_add_f32 v[56:57], v[56:57], v[52:53]
v_pk_add_f32 v[86:87], v[86:87], v[102:103]
v_pk_mul_f32 v[52:53], v[92:93], s[32:33] op_sel:[0,1]
v_pk_mul_f32 v[102:103], v[92:93], s[32:33] op_sel:[0,1]
v_pk_fma_f32 v[52:53], v[142:143], s[32:33], v[52:53] op_sel:[0,1,0] neg_lo:[0,1,0] neg_hi:[0,1,0]
v_pk_fma_f32 v[102:103], v[142:143], s[32:33], v[102:103] op_sel:[0,1,0]
v_pk_add_f32 v[92:93], v[70:71], v[54:55] neg_lo:[0,1] neg_hi:[0,1]
v_pk_add_f32 v[142:143], v[120:121], v[116:117] neg_lo:[0,1] neg_hi:[0,1]
v_pk_add_f32 v[120:121], v[120:121], v[116:117]
v_pk_add_f32 v[54:55], v[54:55], v[70:71]
v_pk_add_f32 v[116:117], v[20:21], v[36:37] neg_lo:[0,1] neg_hi:[0,1]
v_pk_add_f32 v[70:71], v[118:119], v[134:135] neg_lo:[0,1] neg_hi:[0,1]
v_pk_add_f32 v[20:21], v[20:21], v[36:37]
v_pk_add_f32 v[118:119], v[118:119], v[134:135]
v_pk_mul_f32 v[36:37], v[116:117], s[32:33] op_sel:[0,1] neg_lo:[0,1] neg_hi:[0,1]
v_pk_mul_f32 v[134:135], v[116:117], s[32:33] op_sel:[0,1]
v_pk_fma_f32 v[36:37], v[70:71], s[32:33], v[36:37] op_sel:[0,1,0] neg_lo:[0,1,0] neg_hi:[0,1,0]
v_pk_fma_f32 v[134:135], v[70:71], s[32:33], v[134:135] op_sel:[0,1,0] neg_lo:[0,1,0] neg_hi:[0,1,0]
v_pk_add_f32 v[116:117], v[132:133], v[16:17] neg_lo:[0,1] neg_hi:[0,1]
v_pk_add_f32 v[70:71], v[18:19], v[114:115] neg_lo:[0,1] neg_hi:[0,1]
v_pk_add_f32 v[132:133], v[132:133], v[16:17]
v_pk_add_f32 v[18:19], v[18:19], v[114:115]
v_pk_add_f32 v[16:17], v[66:67], v[146:147] neg_lo:[0,1] neg_hi:[0,1]
v_pk_add_f32 v[114:115], v[68:69], v[80:81] neg_lo:[0,1] neg_hi:[0,1]
v_pk_add_f32 v[68:69], v[68:69], v[80:81]
v_pk_add_f32 v[146:147], v[146:147], v[66:67]
v_pk_add_f32 v[80:81], v[84:85], v[144:145] neg_lo:[0,1] neg_hi:[0,1]
v_pk_add_f32 v[66:67], v[38:39], v[130:131] neg_lo:[0,1] neg_hi:[0,1]
v_pk_add_f32 v[84:85], v[84:85], v[144:145]
v_pk_add_f32 v[38:39], v[38:39], v[130:131]
v_pk_add_f32 v[144:145], v[106:107], v[74:75] neg_lo:[0,1] neg_hi:[0,1]
v_pk_add_f32 v[130:131], v[112:113], v[128:129] neg_lo:[0,1] neg_hi:[0,1]
v_pk_add_f32 v[112:113], v[112:113], v[128:129]
v_pk_add_f32 v[74:75], v[74:75], v[106:107]
v_pk_add_f32 v[128:129], v[88:89], v[104:105] neg_lo:[0,1] neg_hi:[0,1]
v_pk_add_f32 v[106:107], v[22:23], v[46:47] neg_lo:[0,1] neg_hi:[0,1]
v_pk_add_f32 v[88:89], v[88:89], v[104:105]
v_pk_add_f32 v[22:23], v[22:23], v[46:47]
v_pk_add_f32 v[104:105], v[110:111], v[78:79] neg_lo:[0,1] neg_hi:[0,1]
v_pk_add_f32 v[46:47], v[40:41], v[136:137] neg_lo:[0,1] neg_hi:[0,1]
v_pk_add_f32 v[40:41], v[40:41], v[136:137]
v_pk_add_f32 v[78:79], v[78:79], v[110:111]
v_pk_add_f32 v[136:137], v[64:65], v[72:73] neg_lo:[0,1] neg_hi:[0,1]
v_pk_add_f32 v[110:111], v[42:43], v[138:139] neg_lo:[0,1] neg_hi:[0,1]
v_pk_add_f32 v[64:65], v[64:65], v[72:73]
v_pk_add_f32 v[42:43], v[42:43], v[138:139]
v_pk_add_f32 v[72:73], v[126:127], v[94:95] neg_lo:[0,1] neg_hi:[0,1]
v_pk_add_f32 v[138:139], v[44:45], v[28:29] neg_lo:[0,1] neg_hi:[0,1]
v_pk_add_f32 v[44:45], v[44:45], v[28:29]
v_pk_add_f32 v[94:95], v[94:95], v[126:127]
v_pk_add_f32 v[28:29], v[100:101], v[124:125] neg_lo:[0,1] neg_hi:[0,1]
v_pk_add_f32 v[126:127], v[82:83], v[34:35] neg_lo:[0,1] neg_hi:[0,1]
v_pk_add_f32 v[100:101], v[100:101], v[124:125]
v_pk_add_f32 v[82:83], v[82:83], v[34:35]
v_pk_add_f32 v[124:125], v[98:99], v[50:51] neg_lo:[0,1] neg_hi:[0,1]
v_pk_add_f32 v[34:35], v[60:61], v[140:141] neg_lo:[0,1] neg_hi:[0,1]
v_pk_add_f32 v[60:61], v[60:61], v[140:141]
v_pk_add_f32 v[50:51], v[50:51], v[98:99]
v_pk_add_f32 v[140:141], v[108:109], v[48:49] neg_lo:[0,1] neg_hi:[0,1]
v_pk_add_f32 v[98:99], v[62:63], v[26:27] neg_lo:[0,1] neg_hi:[0,1]
v_pk_add_f32 v[108:109], v[108:109], v[48:49]
v_pk_add_f32 v[62:63], v[62:63], v[26:27]
v_pk_add_f32 v[48:49], v[122:123], v[90:91] neg_lo:[0,1] neg_hi:[0,1]
v_pk_add_f32 v[26:27], v[32:33], v[24:25] neg_lo:[0,1] neg_hi:[0,1]
v_pk_add_f32 v[32:33], v[32:33], v[24:25]
v_pk_add_f32 v[90:91], v[90:91], v[122:123]
v_pk_add_f32 v[24:25], v[76:77], v[120:121] neg_lo:[0,1] neg_hi:[0,1]
v_pk_add_f32 v[122:123], v[30:31], v[54:55] neg_lo:[0,1] neg_hi:[0,1]
v_pk_add_f32 v[76:77], v[76:77], v[120:121]
v_pk_add_f32 v[30:31], v[30:31], v[54:55]
v_pk_add_f32 v[120:121], v[118:119], v[86:87] neg_lo:[0,1] neg_hi:[0,1]
v_pk_add_f32 v[54:55], v[56:57], v[20:21] neg_lo:[0,1] neg_hi:[0,1]
v_pk_add_f32 v[56:57], v[56:57], v[20:21]
v_pk_add_f32 v[86:87], v[86:87], v[118:119]
v_pk_add_f32 v[20:21], v[96:97], v[92:93] neg_lo:[0,1] neg_hi:[0,1]
v_pk_add_f32 v[118:119], v[58:59], v[142:143] neg_lo:[0,1] neg_hi:[0,1]
v_pk_add_f32 v[96:97], v[96:97], v[92:93]
v_pk_add_f32 v[58:59], v[58:59], v[142:143]
v_pk_add_f32 v[92:93], v[134:135], v[102:103] neg_lo:[0,1] neg_hi:[0,1]
v_pk_add_f32 v[142:143], v[52:53], v[36:37] neg_lo:[0,1] neg_hi:[0,1]
v_pk_add_f32 v[52:53], v[52:53], v[36:37]
v_pk_add_f32 v[102:103], v[102:103], v[134:135]
v_pk_add_f32 v[36:37], v[132:133], v[68:69] neg_lo:[0,1] neg_hi:[0,1]
v_pk_add_f32 v[134:135], v[18:19], v[146:147] neg_lo:[0,1] neg_hi:[0,1]
v_pk_add_f32 v[132:133], v[132:133], v[68:69]
v_pk_add_f32 v[18:19], v[18:19], v[146:147]
v_pk_add_f32 v[68:69], v[116:117], v[16:17] neg_lo:[0,1] neg_hi:[0,1]
v_pk_add_f32 v[146:147], v[70:71], v[114:115] neg_lo:[0,1] neg_hi:[0,1]
v_pk_add_f32 v[116:117], v[116:117], v[16:17]
v_pk_add_f32 v[70:71], v[70:71], v[114:115]
v_pk_add_f32 v[16:17], v[84:85], v[112:113] neg_lo:[0,1] neg_hi:[0,1]
v_pk_add_f32 v[114:115], v[38:39], v[74:75] neg_lo:[0,1] neg_hi:[0,1]
v_pk_add_f32 v[84:85], v[84:85], v[112:113]
v_pk_add_f32 v[38:39], v[38:39], v[74:75]
v_pk_add_f32 v[112:113], v[80:81], v[144:145] neg_lo:[0,1] neg_hi:[0,1]
v_pk_add_f32 v[74:75], v[66:67], v[130:131] neg_lo:[0,1] neg_hi:[0,1]
v_pk_add_f32 v[80:81], v[80:81], v[144:145]
v_pk_add_f32 v[66:67], v[66:67], v[130:131]
v_pk_add_f32 v[144:145], v[88:89], v[40:41] neg_lo:[0,1] neg_hi:[0,1]
v_pk_add_f32 v[130:131], v[22:23], v[78:79] neg_lo:[0,1] neg_hi:[0,1]
v_pk_add_f32 v[88:89], v[88:89], v[40:41]
v_pk_add_f32 v[22:23], v[22:23], v[78:79]
v_pk_add_f32 v[40:41], v[128:129], v[104:105] neg_lo:[0,1] neg_hi:[0,1]
v_pk_add_f32 v[78:79], v[106:107], v[46:47] neg_lo:[0,1] neg_hi:[0,1]
v_pk_add_f32 v[128:129], v[128:129], v[104:105]
v_pk_add_f32 v[106:107], v[106:107], v[46:47]
v_pk_add_f32 v[104:105], v[64:65], v[44:45] neg_lo:[0,1] neg_hi:[0,1]
v_pk_add_f32 v[46:47], v[42:43], v[94:95] neg_lo:[0,1] neg_hi:[0,1]
v_pk_add_f32 v[64:65], v[64:65], v[44:45]
v_pk_add_f32 v[42:43], v[42:43], v[94:95]
v_pk_add_f32 v[44:45], v[136:137], v[72:73] neg_lo:[0,1] neg_hi:[0,1]
v_pk_add_f32 v[94:95], v[110:111], v[138:139] neg_lo:[0,1] neg_hi:[0,1]
v_pk_add_f32 v[136:137], v[136:137], v[72:73]
v_pk_add_f32 v[110:111], v[110:111], v[138:139]
v_pk_add_f32 v[72:73], v[100:101], v[60:61] neg_lo:[0,1] neg_hi:[0,1]
v_pk_add_f32 v[138:139], v[82:83], v[50:51] neg_lo:[0,1] neg_hi:[0,1]
v_pk_add_f32 v[100:101], v[100:101], v[60:61]
v_pk_add_f32 v[82:83], v[82:83], v[50:51]
v_pk_add_f32 v[60:61], v[28:29], v[124:125] neg_lo:[0,1] neg_hi:[0,1]
v_pk_add_f32 v[50:51], v[126:127], v[34:35] neg_lo:[0,1] neg_hi:[0,1]
v_pk_add_f32 v[28:29], v[28:29], v[124:125]
v_pk_add_f32 v[126:127], v[126:127], v[34:35]
v_pk_add_f32 v[124:125], v[108:109], v[32:33] neg_lo:[0,1] neg_hi:[0,1]
v_pk_add_f32 v[34:35], v[62:63], v[90:91] neg_lo:[0,1] neg_hi:[0,1]
v_pk_add_f32 v[108:109], v[108:109], v[32:33]
v_pk_add_f32 v[62:63], v[62:63], v[90:91]
v_pk_add_f32 v[32:33], v[140:141], v[48:49] neg_lo:[0,1] neg_hi:[0,1]
v_pk_add_f32 v[90:91], v[98:99], v[26:27] neg_lo:[0,1] neg_hi:[0,1]
v_pk_add_f32 v[140:141], v[140:141], v[48:49]
v_pk_add_f32 v[98:99], v[98:99], v[26:27]
v_pk_add_f32 v[48:49], v[76:77], v[56:57] neg_lo:[0,1] neg_hi:[0,1]
v_pk_add_f32 v[26:27], v[30:31], v[86:87] neg_lo:[0,1] neg_hi:[0,1]
v_pk_add_f32 v[76:77], v[76:77], v[56:57]
v_pk_add_f32 v[30:31], v[30:31], v[86:87]
v_pk_add_f32 v[56:57], v[24:25], v[120:121] neg_lo:[0,1] neg_hi:[0,1]
v_pk_add_f32 v[86:87], v[122:123], v[54:55] neg_lo:[0,1] neg_hi:[0,1]
v_pk_add_f32 v[24:25], v[24:25], v[120:121]
v_pk_add_f32 v[122:123], v[122:123], v[54:55]
v_pk_add_f32 v[120:121], v[96:97], v[52:53] neg_lo:[0,1] neg_hi:[0,1]
v_pk_add_f32 v[54:55], v[58:59], v[102:103] neg_lo:[0,1] neg_hi:[0,1]
v_pk_add_f32 v[96:97], v[96:97], v[52:53]
v_pk_add_f32 v[58:59], v[58:59], v[102:103]
v_pk_add_f32 v[52:53], v[20:21], v[92:93] neg_lo:[0,1] neg_hi:[0,1]
v_pk_add_f32 v[102:103], v[118:119], v[142:143] neg_lo:[0,1] neg_hi:[0,1]
v_pk_add_f32 v[20:21], v[20:21], v[92:93]
v_pk_add_f32 v[118:119], v[118:119], v[142:143]
v_mul_f32 v12, v9, v8
v_mul_f32 v12, 0x3a000000, v12
v_fmamk_f32 v149, v8, 0x00000000, v12
v_cos_f32 v148, v149
v_sin_f32 v149, v149
v_fmamk_f32 v151, v8, 0x3a800000, v12
v_cos_f32 v150, v151
v_sin_f32 v151, v151
v_pk_mul_f32 v[92:93], v[132:133], v[148:149] op_sel_hi:[1,0]
v_pk_fma_f32 v[92:93], v[18:19], v[148:149], v[92:93] op_sel:[0,1,0] neg_lo:[1,0,0] neg_hi:[1,0,0]
v_pk_mul_f32 v[18:19], v[18:19], v[148:149] op_sel_hi:[1,0]
v_pk_fma_f32 v[18:19], v[132:133], v[148:149], v[18:19] op_sel:[0,1,0]
v_fmamk_f32 v149, v8, 0x3b000000, v12
v_cos_f32 v148, v149
v_sin_f32 v149, v149
v_pk_mul_f32 v[132:133], v[100:101], v[150:151] op_sel_hi:[1,0]
v_pk_fma_f32 v[132:133], v[82:83], v[150:151], v[132:133] op_sel:[0,1,0] neg_lo:[1,0,0] neg_hi:[1,0,0]
v_pk_mul_f32 v[82:83], v[82:83], v[150:151] op_sel_hi:[1,0]
v_pk_fma_f32 v[82:83], v[100:101], v[150:151], v[82:83] op_sel:[0,1,0]
v_fmamk_f32 v151, v8, 0x3b400000, v12
v_cos_f32 v150, v151
v_sin_f32 v151, v151
v_pk_mul_f32 v[100:101], v[88:89], v[148:149] op_sel_hi:[1,0]
v_pk_fma_f32 v[100:101], v[22:23], v[148:149], v[100:101] op_sel:[0,1,0] neg_lo:[1,0,0] neg_hi:[1,0,0]
v_pk_mul_f32 v[22:23], v[22:23], v[148:149] op_sel_hi:[1,0]
v_pk_fma_f32 v[22:23], v[88:89], v[148:149], v[22:23] op_sel:[0,1,0]
v_fmamk_f32 v149, v8, 0x3b800000, v12
v_cos_f32 v148, v149
v_sin_f32 v149, v149
v_pk_mul_f32 v[88:89], v[76:77], v[150:151] op_sel_hi:[1,0]
v_pk_fma_f32 v[88:89], v[30:31], v[150:151], v[88:89] op_sel:[0,1,0] neg_lo:[1,0,0] neg_hi:[1,0,0]
v_pk_mul_f32 v[30:31], v[30:31], v[150:151] op_sel_hi:[1,0]
v_pk_fma_f32 v[30:31], v[76:77], v[150:151], v[30:31] op_sel:[0,1,0]
v_fmamk_f32 v151, v8, 0x3ba00000, v12
v_cos_f32 v150, v151
v_sin_f32 v151, v151
v_pk_mul_f32 v[76:77], v[84:85], v[148:149] op_sel_hi:[1,0]
v_pk_fma_f32 v[76:77], v[38:39], v[148:149], v[76:77] op_sel:[0,1,0] neg_lo:[1,0,0] neg_hi:[1,0,0]
v_pk_mul_f32 v[38:39], v[38:39], v[148:149] op_sel_hi:[1,0]
v_pk_fma_f32 v[38:39], v[84:85], v[148:149], v[38:39] op_sel:[0,1,0]
v_fmamk_f32 v149, v8, 0x3bc00000, v12
v_cos_f32 v148, v149
v_sin_f32 v149, v149
v_pk_mul_f32 v[84:85], v[108:109], v[150:151] op_sel_hi:[1,0]
v_pk_fma_f32 v[84:85], v[62:63], v[150:151], v[84:85] op_sel:[0,1,0] neg_lo:[1,0,0] neg_hi:[1,0,0]
v_pk_mul_f32 v[62:63], v[62:63], v[150:151] op_sel_hi:[1,0]
v_pk_fma_f32 v[62:63], v[108:109], v[150:151], v[62:63] op_sel:[0,1,0]
v_fmamk_f32 v151, v8, 0x3be00000, v12
v_cos_f32 v150, v151
v_sin_f32 v151, v151
v_pk_mul_f32 v[108:109], v[64:65], v[148:149] op_sel_hi:[1,0]
v_pk_fma_f32 v[108:109], v[42:43], v[148:149], v[108:109] op_sel:[0,1,0] neg_lo:[1,0,0] neg_hi:[1,0,0]
v_pk_mul_f32 v[42:43], v[42:43], v[148:149] op_sel_hi:[1,0]
v_pk_fma_f32 v[42:43], v[64:65], v[148:149], v[42:43] op_sel:[0,1,0]
v_fmamk_f32 v149, v8, 0x3c000000, v12
v_cos_f32 v148, v149
v_sin_f32 v149, v149
v_pk_mul_f32 v[64:65], v[96:97], v[150:151] op_sel_hi:[1,0]
v_pk_fma_f32 v[64:65], v[58:59], v[150:151], v[64:65] op_sel:[0,1,0] neg_lo:[1,0,0] neg_hi:[1,0,0]
v_pk_mul_f32 v[58:59], v[58:59], v[150:151] op_sel_hi:[1,0]
v_pk_fma_f32 v[58:59], v[96:97], v[150:151], v[58:59] op_sel:[0,1,0]
v_fmamk_f32 v151, v8, 0x3c100000, v12
v_cos_f32 v150, v151
v_sin_f32 v151, v151
v_pk_mul_f32 v[96:97], v[116:117], v[148:149] op_sel_hi:[1,0]
v_pk_fma_f32 v[96:97], v[70:71], v[148:149], v[96:97] op_sel:[0,1,0] neg_lo:[1,0,0] neg_hi:[1,0,0]
v_pk_mul_f32 v[70:71], v[70:71], v[148:149] op_sel_hi:[1,0]
v_pk_fma_f32 v[70:71], v[116:117], v[148:149], v[70:71] op_sel:[0,1,0]
v_fmamk_f32 v149, v8, 0x3c200000, v12
v_cos_f32 v148, v149
v_sin_f32 v149, v149
v_pk_mul_f32 v[116:117], v[28:29], v[150:151] op_sel_hi:[1,0]
v_pk_fma_f32 v[116:117], v[126:127], v[150:151], v[116:117] op_sel:[0,1,0] neg_lo:[1,0,0] neg_hi:[1,0,0]
v_pk_mul_f32 v[126:127], v[126:127], v[150:151] op_sel_hi:[1,0]
v_pk_fma_f32 v[126:127], v[28:29], v[150:151], v[126:127] op_sel:[0,1,0]
v_fmamk_f32 v151, v8, 0x3c300000, v12
v_cos_f32 v150, v151
v_sin_f32 v151, v151
v_pk_mul_f32 v[28:29], v[128:129], v[148:149] op_sel_hi:[1,0]
v_pk_fma_f32 v[28:29], v[106:107], v[148:149], v[28:29] op_sel:[0,1,0] neg_lo:[1,0,0] neg_hi:[1,0,0]
v_pk_mul_f32 v[106:107], v[106:107], v[148:149] op_sel_hi:[1,0]
v_pk_fma_f32 v[106:107], v[128:129], v[148:149], v[106:107] op_sel:[0,1,0]
v_fmamk_f32 v149, v8, 0x3c400000, v12
v_cos_f32 v148, v149
v_sin_f32 v149, v149
v_pk_mul_f32 v[128:129], v[24:25], v[150:151] op_sel_hi:[1,0]
v_pk_fma_f32 v[128:129], v[122:123], v[150:151], v[128:129] op_sel:[0,1,0] neg_lo:[1,0,0] neg_hi:[1,0,0]
v_pk_mul_f32 v[122:123], v[122:123], v[150:151] op_sel_hi:[1,0]
v_pk_fma_f32 v[122:123], v[24:25], v[150:151], v[122:123] op_sel:[0,1,0]
v_fmamk_f32 v151, v8, 0x3c500000, v12
v_cos_f32 v150, v151
v_sin_f32 v151, v151
v_pk_mul_f32 v[24:25], v[80:81], v[148:149] op_sel_hi:[1,0]
v_pk_fma_f32 v[24:25], v[66:67], v[148:149], v[24:25] op_sel:[0,1,0] neg_lo:[1,0,0] neg_hi:[1,0,0]
v_pk_mul_f32 v[66:67], v[66:67], v[148:149] op_sel_hi:[1,0]
v_pk_fma_f32 v[66:67], v[80:81], v[148:149], v[66:67] op_sel:[0,1,0]
v_fmamk_f32 v149, v8, 0x3c600000, v12
v_cos_f32 v148, v149
v_sin_f32 v149, v149
v_pk_mul_f32 v[80:81], v[140:141], v[150:151] op_sel_hi:[1,0]
v_pk_fma_f32 v[80:81], v[98:99], v[150:151], v[80:81] op_sel:[0,1,0] neg_lo:[1,0,0] neg_hi:[1,0,0]
v_pk_mul_f32 v[98:99], v[98:99], v[150:151] op_sel_hi:[1,0]
v_pk_fma_f32 v[98:99], v[140:141], v[150:151], v[98:99] op_sel:[0,1,0]
v_fmamk_f32 v151, v8, 0x3c700000, v12
v_cos_f32 v150, v151
v_sin_f32 v151, v151
v_pk_mul_f32 v[140:141], v[136:137], v[148:149] op_sel_hi:[1,0]
v_pk_fma_f32 v[140:141], v[110:111], v[148:149], v[140:141] op_sel:[0,1,0] neg_lo:[1,0,0] neg_hi:[1,0,0]
v_pk_mul_f32 v[110:111], v[110:111], v[148:149] op_sel_hi:[1,0]
v_pk_fma_f32 v[110:111], v[136:137], v[148:149], v[110:111] op_sel:[0,1,0]
v_fmamk_f32 v149, v8, 0x3c800000, v12
v_cos_f32 v148, v149
v_sin_f32 v149, v149
v_pk_mul_f32 v[136:137], v[20:21], v[150:151] op_sel_hi:[1,0]
v_pk_fma_f32 v[136:137], v[118:119], v[150:151], v[136:137] op_sel:[0,1,0] neg_lo:[1,0,0] neg_hi:[1,0,0]
v_pk_mul_f32 v[118:119], v[118:119], v[150:151] op_sel_hi:[1,0]
v_pk_fma_f32 v[118:119], v[20:21], v[150:151], v[118:119] op_sel:[0,1,0]
v_fmamk_f32 v151, v8, 0x3c880000, v12
v_cos_f32 v150, v151
v_sin_f32 v151, v151
v_pk_mul_f32 v[20:21], v[36:37], v[148:149] op_sel_hi:[1,0]
v_pk_fma_f32 v[20:21], v[134:135], v[148:149], v[20:21] op_sel:[0,1,0] neg_lo:[1,0,0] neg_hi:[1,0,0]
v_pk_mul_f32 v[134:135], v[134:135], v[148:149] op_sel_hi:[1,0]
v_pk_fma_f32 v[134:135], v[36:37], v[148:149], v[134:135] op_sel:[0,1,0]
v_fmamk_f32 v149, v8, 0x3c900000, v12
v_cos_f32 v148, v149
v_sin_f32 v149, v149
v_pk_mul_f32 v[36:37], v[72:73], v[150:151] op_sel_hi:[1,0]
v_pk_fma_f32 v[36:37], v[138:139], v[150:151], v[36:37] op_sel:[0,1,0] neg_lo:[1,0,0] neg_hi:[1,0,0]
v_pk_mul_f32 v[138:139], v[138:139], v[150:151] op_sel_hi:[1,0]
v_pk_fma_f32 v[138:139], v[72:73], v[150:151], v[138:139] op_sel:[0,1,0]
v_fmamk_f32 v151, v8, 0x3c980000, v12
v_cos_f32 v150, v151
v_sin_f32 v151, v151
v_pk_mul_f32 v[72:73], v[144:145], v[148:149] op_sel_hi:[1,0]
v_pk_fma_f32 v[72:73], v[130:131], v[148:149], v[72:73] op_sel:[0,1,0] neg_lo:[1,0,0] neg_hi:[1,0,0]
v_pk_mul_f32 v[130:131], v[130:131], v[148:149] op_sel_hi:[1,0]
v_pk_fma_f32 v[130:131], v[144:145], v[148:149], v[130:131] op_sel:[0,1,0]
v_fmamk_f32 v149, v8, 0x3ca00000, v12
v_cos_f32 v148, v149
v_sin_f32 v149, v149
v_pk_mul_f32 v[144:145], v[48:49], v[150:151] op_sel_hi:[1,0]
v_pk_fma_f32 v[144:145], v[26:27], v[150:151], v[144:145] op_sel:[0,1,0] neg_lo:[1,0,0] neg_hi:[1,0,0]
v_pk_mul_f32 v[26:27], v[26:27], v[150:151] op_sel_hi:[1,0]
v_pk_fma_f32 v[26:27], v[48:49], v[150:151], v[26:27] op_sel:[0,1,0]
v_fmamk_f32 v151, v8, 0x3ca80000, v12
v_cos_f32 v150, v151
v_sin_f32 v151, v151
v_pk_mul_f32 v[48:49], v[16:17], v[148:149] op_sel_hi:[1,0]
v_pk_fma_f32 v[48:49], v[114:115], v[148:149], v[48:49] op_sel:[0,1,0] neg_lo:[1,0,0] neg_hi:[1,0,0]
v_pk_mul_f32 v[114:115], v[114:115], v[148:149] op_sel_hi:[1,0]
v_pk_fma_f32 v[114:115], v[16:17], v[148:149], v[114:115] op_sel:[0,1,0]
v_fmamk_f32 v149, v8, 0x3cb00000, v12
v_cos_f32 v148, v149
v_sin_f32 v149, v149
v_pk_mul_f32 v[16:17], v[124:125], v[150:151] op_sel_hi:[1,0]
v_pk_fma_f32 v[16:17], v[34:35], v[150:151], v[16:17] op_sel:[0,1,0] neg_lo:[1,0,0] neg_hi:[1,0,0]
v_pk_mul_f32 v[34:35], v[34:35], v[150:151] op_sel_hi:[1,0]
v_pk_fma_f32 v[34:35], v[124:125], v[150:151], v[34:35] op_sel:[0,1,0]
v_fmamk_f32 v151, v8, 0x3cb80000, v12
v_cos_f32 v150, v151
v_sin_f32 v151, v151
v_pk_mul_f32 v[124:125], v[104:105], v[148:149] op_sel_hi:[1,0]
v_pk_fma_f32 v[124:125], v[46:47], v[148:149], v[124:125] op_sel:[0,1,0] neg_lo:[1,0,0] neg_hi:[1,0,0]
v_pk_mul_f32 v[46:47], v[46:47], v[148:149] op_sel_hi:[1,0]
v_pk_fma_f32 v[46:47], v[104:105], v[148:149], v[46:47] op_sel:[0,1,0]
v_fmamk_f32 v149, v8, 0x3cc00000, v12
v_cos_f32 v148, v149
v_sin_f32 v149, v149
v_pk_mul_f32 v[104:105], v[120:121], v[150:151] op_sel_hi:[1,0]
v_pk_fma_f32 v[104:105], v[54:55], v[150:151], v[104:105] op_sel:[0,1,0] neg_lo:[1,0,0] neg_hi:[1,0,0]
v_pk_mul_f32 v[54:55], v[54:55], v[150:151] op_sel_hi:[1,0]
v_pk_fma_f32 v[54:55], v[120:121], v[150:151], v[54:55] op_sel:[0,1,0]
v_fmamk_f32 v151, v8, 0x3cc80000, v12
v_cos_f32 v150, v151
v_sin_f32 v151, v151
v_pk_mul_f32 v[120:121], v[68:69], v[148:149] op_sel_hi:[1,0]
v_pk_fma_f32 v[120:121], v[146:147], v[148:149], v[120:121] op_sel:[0,1,0] neg_lo:[1,0,0] neg_hi:[1,0,0]
v_pk_mul_f32 v[146:147], v[146:147], v[148:149] op_sel_hi:[1,0]
v_pk_fma_f32 v[146:147], v[68:69], v[148:149], v[146:147] op_sel:[0,1,0]
v_fmamk_f32 v149, v8, 0x3cd00000, v12
v_cos_f32 v148, v149
v_sin_f32 v149, v149
v_pk_mul_f32 v[68:69], v[60:61], v[150:151] op_sel_hi:[1,0]
v_pk_fma_f32 v[68:69], v[50:51], v[150:151], v[68:69] op_sel:[0,1,0] neg_lo:[1,0,0] neg_hi:[1,0,0]
v_pk_mul_f32 v[50:51], v[50:51], v[150:151] op_sel_hi:[1,0]
v_pk_fma_f32 v[50:51], v[60:61], v[150:151], v[50:51] op_sel:[0,1,0]
v_fmamk_f32 v151, v8, 0x3cd80000, v12
v_cos_f32 v150, v151
v_sin_f32 v151, v151
v_pk_mul_f32 v[60:61], v[40:41], v[148:149] op_sel_hi:[1,0]
v_pk_fma_f32 v[60:61], v[78:79], v[148:149], v[60:61] op_sel:[0,1,0] neg_lo:[1,0,0] neg_hi:[1,0,0]
v_pk_mul_f32 v[78:79], v[78:79], v[148:149] op_sel_hi:[1,0]
v_pk_fma_f32 v[78:79], v[40:41], v[148:149], v[78:79] op_sel:[0,1,0]
v_fmamk_f32 v149, v8, 0x3ce00000, v12
v_cos_f32 v148, v149
v_sin_f32 v149, v149
v_pk_mul_f32 v[40:41], v[56:57], v[150:151] op_sel_hi:[1,0]
v_pk_fma_f32 v[40:41], v[86:87], v[150:151], v[40:41] op_sel:[0,1,0] neg_lo:[1,0,0] neg_hi:[1,0,0]
v_pk_mul_f32 v[86:87], v[86:87], v[150:151] op_sel_hi:[1,0]
v_pk_fma_f32 v[86:87], v[56:57], v[150:151], v[86:87] op_sel:[0,1,0]
v_fmamk_f32 v151, v8, 0x3ce80000, v12
v_cos_f32 v150, v151
v_sin_f32 v151, v151
v_pk_mul_f32 v[56:57], v[112:113], v[148:149] op_sel_hi:[1,0]
v_pk_fma_f32 v[56:57], v[74:75], v[148:149], v[56:57] op_sel:[0,1,0] neg_lo:[1,0,0] neg_hi:[1,0,0]
v_pk_mul_f32 v[74:75], v[74:75], v[148:149] op_sel_hi:[1,0]
v_pk_fma_f32 v[74:75], v[112:113], v[148:149], v[74:75] op_sel:[0,1,0]
v_fmamk_f32 v149, v8, 0x3cf00000, v12
v_cos_f32 v148, v149
v_sin_f32 v149, v149
v_pk_mul_f32 v[112:113], v[32:33], v[150:151] op_sel_hi:[1,0]
v_pk_fma_f32 v[112:113], v[90:91], v[150:151], v[112:113] op_sel:[0,1,0] neg_lo:[1,0,0] neg_hi:[1,0,0]
v_pk_mul_f32 v[90:91], v[90:91], v[150:151] op_sel_hi:[1,0]
v_pk_fma_f32 v[90:91], v[32:33], v[150:151], v[90:91] op_sel:[0,1,0]
v_fmamk_f32 v151, v8, 0x3cf80000, v12
v_cos_f32 v150, v151
v_sin_f32 v151, v151
v_pk_mul_f32 v[32:33], v[44:45], v[148:149] op_sel_hi:[1,0]
v_pk_fma_f32 v[32:33], v[94:95], v[148:149], v[32:33] op_sel:[0,1,0] neg_lo:[1,0,0] neg_hi:[1,0,0]
v_pk_mul_f32 v[94:95], v[94:95], v[148:149] op_sel_hi:[1,0]
v_pk_fma_f32 v[94:95], v[44:45], v[148:149], v[94:95] op_sel:[0,1,0]
s_nop 0
v_pk_mul_f32 v[44:45], v[52:53], v[150:151] op_sel_hi:[1,0]
v_pk_fma_f32 v[44:45], v[102:103], v[150:151], v[44:45] op_sel:[0,1,0] neg_lo:[1,0,0] neg_hi:[1,0,0]
v_pk_mul_f32 v[102:103], v[102:103], v[150:151] op_sel_hi:[1,0]
v_pk_fma_f32 v[102:103], v[52:53], v[150:151], v[102:103] op_sel:[0,1,0]
ds_write_b64 v4, v[92:93]
ds_write_b64 v4, v[18:19] offset:8
ds_write_b64 v4, v[132:133] offset:32
ds_write_b64 v4, v[82:83] offset:40
ds_write_b64 v4, v[100:101] offset:64
ds_write_b64 v4, v[22:23] offset:72
ds_write_b64 v4, v[88:89] offset:96
ds_write_b64 v4, v[30:31] offset:104
ds_write_b64 v4, v[76:77] offset:128
ds_write_b64 v4, v[38:39] offset:136
ds_write_b64 v4, v[84:85] offset:160
ds_write_b64 v4, v[62:63] offset:168
ds_write_b64 v4, v[108:109] offset:192
ds_write_b64 v4, v[42:43] offset:200
ds_write_b64 v4, v[64:65] offset:224
ds_write_b64 v4, v[58:59] offset:232
ds_write_b64 v4, v[96:97] offset:256
ds_write_b64 v4, v[70:71] offset:264
ds_write_b64 v4, v[116:117] offset:288
ds_write_b64 v4, v[126:127] offset:296
ds_write_b64 v4, v[28:29] offset:320
ds_write_b64 v4, v[106:107] offset:328
ds_write_b64 v4, v[128:129] offset:352
ds_write_b64 v4, v[122:123] offset:360
ds_write_b64 v4, v[24:25] offset:384
ds_write_b64 v4, v[66:67] offset:392
ds_write_b64 v4, v[80:81] offset:416
ds_write_b64 v4, v[98:99] offset:424
ds_write_b64 v4, v[140:141] offset:448
ds_write_b64 v4, v[110:111] offset:456
ds_write_b64 v4, v[136:137] offset:480
ds_write_b64 v4, v[118:119] offset:488
ds_write_b64 v4, v[20:21] offset:512
ds_write_b64 v4, v[134:135] offset:520
ds_write_b64 v4, v[36:37] offset:544
ds_write_b64 v4, v[138:139] offset:552
ds_write_b64 v4, v[72:73] offset:576
ds_write_b64 v4, v[130:131] offset:584
ds_write_b64 v4, v[144:145] offset:608
ds_write_b64 v4, v[26:27] offset:616
ds_write_b64 v4, v[48:49] offset:640
ds_write_b64 v4, v[114:115] offset:648
ds_write_b64 v4, v[16:17] offset:672
ds_write_b64 v4, v[34:35] offset:680
ds_write_b64 v4, v[124:125] offset:704
ds_write_b64 v4, v[46:47] offset:712
ds_write_b64 v4, v[104:105] offset:736
ds_write_b64 v4, v[54:55] offset:744
ds_write_b64 v4, v[120:121] offset:768
ds_write_b64 v4, v[146:147] offset:776
ds_write_b64 v4, v[68:69] offset:800
ds_write_b64 v4, v[50:51] offset:808
ds_write_b64 v4, v[60:61] offset:832
ds_write_b64 v4, v[78:79] offset:840
ds_write_b64 v4, v[40:41] offset:864
ds_write_b64 v4, v[86:87] offset:872
ds_write_b64 v4, v[56:57] offset:896
ds_write_b64 v4, v[74:75] offset:904
ds_write_b64 v4, v[112:113] offset:928
ds_write_b64 v4, v[90:91] offset:936
ds_write_b64 v4, v[32:33] offset:960
ds_write_b64 v4, v[94:95] offset:968
ds_write_b64 v4, v[44:45] offset:992
ds_write_b64 v4, v[102:103] offset:1000
s_waitcnt lgkmcnt(0)
ds_read_b128 v[16:19], v3
ds_read_b128 v[20:23], v3 offset:1056
ds_read_b128 v[24:27], v3 offset:2112
ds_read_b128 v[28:31], v3 offset:3168
ds_read_b128 v[32:35], v3 offset:4224
ds_read_b128 v[36:39], v3 offset:5280
ds_read_b128 v[40:43], v3 offset:6336
ds_read_b128 v[44:47], v3 offset:7392
ds_read_b128 v[48:51], v3 offset:8448
ds_read_b128 v[52:55], v3 offset:9504
ds_read_b128 v[56:59], v3 offset:10560
ds_read_b128 v[60:63], v3 offset:11616
s_waitcnt lgkmcnt(4)
ds_read_b128 v[64:67], v3 offset:12672
ds_read_b128 v[68:71], v3 offset:13728
ds_read_b128 v[72:75], v3 offset:14784
ds_read_b128 v[76:79], v3 offset:15840
ds_read_b128 v[80:83], v3 offset:16896
ds_read_b128 v[84:87], v3 offset:17952
ds_read_b128 v[88:91], v3 offset:19008
ds_read_b128 v[92:95], v3 offset:20064
ds_read_b128 v[96:99], v3 offset:21120
ds_read_b128 v[100:103], v3 offset:22176
ds_read_b128 v[104:107], v3 offset:23232
ds_read_b128 v[108:111], v3 offset:24288
s_waitcnt lgkmcnt(4)
ds_read_b128 v[112:115], v3 offset:25344
ds_read_b128 v[116:119], v3 offset:26400
ds_read_b128 v[120:123], v3 offset:27456
ds_read_b128 v[124:127], v3 offset:28512
ds_read_b128 v[128:131], v3 offset:29568
ds_read_b128 v[132:135], v3 offset:30624
ds_read_b128 v[136:139], v3 offset:31680
ds_read_b128 v[140:143], v3 offset:32736
s_waitcnt lgkmcnt(0)
v_pk_add_f32 v[144:145], v[16:17], v[80:81] neg_lo:[0,1] neg_hi:[0,1]
v_pk_add_f32 v[146:147], v[18:19], v[82:83] neg_lo:[0,1] neg_hi:[0,1]
v_pk_add_f32 v[16:17], v[16:17], v[80:81]
v_pk_add_f32 v[18:19], v[18:19], v[82:83]
v_pk_add_f32 v[80:81], v[20:21], v[84:85] neg_lo:[0,1] neg_hi:[0,1]
v_pk_add_f32 v[82:83], v[22:23], v[86:87] neg_lo:[0,1] neg_hi:[0,1]
v_pk_add_f32 v[20:21], v[20:21], v[84:85]
v_pk_add_f32 v[22:23], v[22:23], v[86:87]
v_pk_mul_f32 v[84:85], v[80:81], s[30:31] op_sel_hi:[1,0]
v_pk_mul_f32 v[86:87], v[80:81], s[36:37] op_sel_hi:[1,0]
v_pk_fma_f32 v[84:85], v[82:83], s[36:37], v[84:85] op_sel_hi:[1,0,1] neg_lo:[0,1,0] neg_hi:[0,1,0]
v_pk_fma_f32 v[86:87], v[82:83], s[30:31], v[86:87] op_sel_hi:[1,0,1]
v_pk_add_f32 v[80:81], v[24:25], v[88:89] neg_lo:[0,1] neg_hi:[0,1]
v_pk_add_f32 v[82:83], v[26:27], v[90:91] neg_lo:[0,1] neg_hi:[0,1]
v_pk_add_f32 v[24:25], v[24:25], v[88:89]
v_pk_add_f32 v[26:27], v[26:27], v[90:91]
v_pk_mul_f32 v[88:89], v[80:81], s[30:31] op_sel:[0,1]
v_pk_mul_f32 v[90:91], v[80:81], s[34:35] op_sel:[0,1]
v_pk_fma_f32 v[88:89], v[82:83], s[34:35], v[88:89] op_sel:[0,1,0] neg_lo:[0,1,0] neg_hi:[0,1,0]
v_pk_fma_f32 v[90:91], v[82:83], s[30:31], v[90:91] op_sel:[0,1,0]
v_pk_add_f32 v[80:81], v[28:29], v[92:93] neg_lo:[0,1] neg_hi:[0,1]
v_pk_add_f32 v[82:83], v[30:31], v[94:95] neg_lo:[0,1] neg_hi:[0,1]
v_pk_add_f32 v[28:29], v[28:29], v[92:93]
v_pk_add_f32 v[30:31], v[30:31], v[94:95]
v_pk_mul_f32 v[92:93], v[80:81], s[32:33] op_sel_hi:[1,0]
v_pk_mul_f32 v[94:95], v[80:81], s[34:35] op_sel_hi:[1,0]
v_pk_fma_f32 v[92:93], v[82:83], s[34:35], v[92:93] op_sel_hi:[1,0,1] neg_lo:[0,1,0] neg_hi:[0,1,0]
v_pk_fma_f32 v[94:95], v[82:83], s[32:33], v[94:95] op_sel_hi:[1,0,1]
v_pk_add_f32 v[80:81], v[32:33], v[96:97] neg_lo:[0,1] neg_hi:[0,1]
v_pk_add_f32 v[82:83], v[34:35], v[98:99] neg_lo:[0,1] neg_hi:[0,1]
v_pk_add_f32 v[32:33], v[32:33], v[96:97]
v_pk_add_f32 v[34:35], v[34:35], v[98:99]
v_pk_mul_f32 v[96:97], v[80:81], s[32:33] op_sel:[0,1]
v_pk_mul_f32 v[98:99], v[80:81], s[32:33] op_sel:[0,1]
v_pk_fma_f32 v[96:97], v[82:83], s[32:33], v[96:97] op_sel:[0,1,0] neg_lo:[0,1,0] neg_hi:[0,1,0]
v_pk_fma_f32 v[98:99], v[82:83], s[32:33], v[98:99] op_sel:[0,1,0]
v_pk_add_f32 v[80:81], v[36:37], v[100:101] neg_lo:[0,1] neg_hi:[0,1]
v_pk_add_f32 v[82:83], v[38:39], v[102:103] neg_lo:[0,1] neg_hi:[0,1]
v_pk_add_f32 v[36:37], v[36:37], v[100:101]
v_pk_add_f32 v[38:39], v[38:39], v[102:103]
v_pk_mul_f32 v[100:101], v[80:81], s[34:35] op_sel_hi:[1,0]
v_pk_mul_f32 v[102:103], v[80:81], s[32:33] op_sel_hi:[1,0]
v_pk_fma_f32 v[100:101], v[82:83], s[32:33], v[100:101] op_sel_hi:[1,0,1] neg_lo:[0,1,0] neg_hi:[0,1,0]
v_pk_fma_f32 v[102:103], v[82:83], s[34:35], v[102:103] op_sel_hi:[1,0,1]
v_pk_add_f32 v[80:81], v[40:41], v[104:105] neg_lo:[0,1] neg_hi:[0,1]
v_pk_add_f32 v[82:83], v[42:43], v[106:107] neg_lo:[0,1] neg_hi:[0,1]
v_pk_add_f32 v[40:41], v[40:41], v[104:105]
v_pk_add_f32 v[42:43], v[42:43], v[106:107]
v_pk_mul_f32 v[104:105], v[80:81], s[34:35] op_sel:[0,1]
v_pk_mul_f32 v[106:107], v[80:81], s[30:31] op_sel:[0,1]
v_pk_fma_f32 v[104:105], v[82:83], s[30:31], v[104:105] op_sel:[0,1,0] neg_lo:[0,1,0] neg_hi:[0,1,0]
v_pk_fma_f32 v[106:107], v[82:83], s[34:35], v[106:107] op_sel:[0,1,0]
v_pk_add_f32 v[80:81], v[44:45], v[108:109] neg_lo:[0,1] neg_hi:[0,1]
v_pk_add_f32 v[82:83], v[46:47], v[110:111] neg_lo:[0,1] neg_hi:[0,1]
v_pk_add_f32 v[44:45], v[44:45], v[108:109]
v_pk_add_f32 v[46:47], v[46:47], v[110:111]
v_pk_mul_f32 v[108:109], v[80:81], s[36:37] op_sel_hi:[1,0]
v_pk_mul_f32 v[110:111], v[80:81], s[30:31] op_sel_hi:[1,0]
v_pk_fma_f32 v[108:109], v[82:83], s[30:31], v[108:109] op_sel_hi:[1,0,1] neg_lo:[0,1,0] neg_hi:[0,1,0]
v_pk_fma_f32 v[110:111], v[82:83], s[36:37], v[110:111] op_sel_hi:[1,0,1]
v_pk_add_f32 v[80:81], v[114:115], v[50:51] neg_lo:[0,1] neg_hi:[0,1]
v_pk_add_f32 v[82:83], v[48:49], v[112:113] neg_lo:[0,1] neg_hi:[0,1]
v_pk_add_f32 v[48:49], v[48:49], v[112:113]
v_pk_add_f32 v[50:51], v[50:51], v[114:115]
v_pk_add_f32 v[112:113], v[52:53], v[116:117] neg_lo:[0,1] neg_hi:[0,1]
v_pk_add_f32 v[114:115], v[54:55], v[118:119] neg_lo:[0,1] neg_hi:[0,1]
v_pk_add_f32 v[52:53], v[52:53], v[116:117]
v_pk_add_f32 v[54:55], v[54:55], v[118:119]
v_pk_mul_f32 v[116:117], v[112:113], s[36:37] op_sel_hi:[1,0] neg_lo:[0,1] neg_hi:[0,1]
v_pk_mul_f32 v[118:119], v[112:113], s[30:31] op_sel_hi:[1,0]
v_pk_fma_f32 v[116:117], v[114:115], s[30:31], v[116:117] op_sel_hi:[1,0,1] neg_lo:[0,1,0] neg_hi:[0,1,0]
v_pk_fma_f32 v[118:119], v[114:115], s[36:37], v[118:119] op_sel_hi:[1,0,1] neg_lo:[0,1,0] neg_hi:[0,1,0]
v_pk_add_f32 v[112:113], v[56:57], v[120:121] neg_lo:[0,1] neg_hi:[0,1]
v_pk_add_f32 v[114:115], v[58:59], v[122:123] neg_lo:[0,1] neg_hi:[0,1]
v_pk_add_f32 v[56:57], v[56:57], v[120:121]
v_pk_add_f32 v[58:59], v[58:59], v[122:123]
v_pk_mul_f32 v[120:121], v[112:113], s[34:35] op_sel:[0,1] neg_lo:[0,1] neg_hi:[0,1]
v_pk_mul_f32 v[122:123], v[112:113], s[30:31] op_sel:[0,1]
v_pk_fma_f32 v[120:121], v[114:115], s[30:31], v[120:121] op_sel:[0,1,0] neg_lo:[0,1,0] neg_hi:[0,1,0]
v_pk_fma_f32 v[122:123], v[114:115], s[34:35], v[122:123] op_sel:[0,1,0] neg_lo:[0,1,0] neg_hi:[0,1,0]
v_pk_add_f32 v[112:113], v[60:61], v[124:125] neg_lo:[0,1] neg_hi:[0,1]
v_pk_add_f32 v[114:115], v[62:63], v[126:127] neg_lo:[0,1] neg_hi:[0,1]
v_pk_add_f32 v[60:61], v[60:61], v[124:125]
v_pk_add_f32 v[62:63], v[62:63], v[126:127]
v_pk_mul_f32 v[124:125], v[112:113], s[34:35] op_sel_hi:[1,0] neg_lo:[0,1] neg_hi:[0,1]
v_pk_mul_f32 v[126:127], v[112:113], s[32:33] op_sel_hi:[1,0]
v_pk_fma_f32 v[124:125], v[114:115], s[32:33], v[124:125] op_sel_hi:[1,0,1] neg_lo:[0,1,0] neg_hi:[0,1,0]
v_pk_fma_f32 v[126:127], v[114:115], s[34:35], v[126:127] op_sel_hi:[1,0,1] neg_lo:[0,1,0] neg_hi:[0,1,0]
v_pk_add_f32 v[112:113], v[64:65], v[128:129] neg_lo:[0,1] neg_hi:[0,1]
v_pk_add_f32 v[114:115], v[66:67], v[130:131] neg_lo:[0,1] neg_hi:[0,1]
v_pk_add_f32 v[64:65], v[64:65], v[128:129]
v_pk_add_f32 v[66:67], v[66:67], v[130:131]
v_pk_mul_f32 v[128:129], v[112:113], s[32:33] op_sel:[0,1] neg_lo:[0,1] neg_hi:[0,1]
v_pk_mul_f32 v[130:131], v[112:113], s[32:33] op_sel:[0,1]
v_pk_fma_f32 v[128:129], v[114:115], s[32:33], v[128:129] op_sel:[0,1,0] neg_lo:[0,1,0] neg_hi:[0,1,0]
v_pk_fma_f32 v[130:131], v[114:115], s[32:33], v[130:131] op_sel:[0,1,0] neg_lo:[0,1,0] neg_hi:[0,1,0]
v_pk_add_f32 v[112:113], v[68:69], v[132:133] neg_lo:[0,1] neg_hi:[0,1]
v_pk_add_f32 v[114:115], v[70:71], v[134:135] neg_lo:[0,1] neg_hi:[0,1]
v_pk_add_f32 v[68:69], v[68:69], v[132:133]
v_pk_add_f32 v[70:71], v[70:71], v[134:135]
v_pk_mul_f32 v[132:133], v[112:113], s[32:33] op_sel_hi:[1,0] neg_lo:[0,1] neg_hi:[0,1]
v_pk_mul_f32 v[134:135], v[112:113], s[34:35] op_sel_hi:[1,0]
v_pk_fma_f32 v[132:133], v[114:115], s[34:35], v[132:133] op_sel_hi:[1,0,1] neg_lo:[0,1,0] neg_hi:[0,1,0]
v_pk_fma_f32 v[134:135], v[114:115], s[32:33], v[134:135] op_sel_hi:[1,0,1] neg_lo:[0,1,0] neg_hi:[0,1,0]
v_pk_add_f32 v[112:113], v[72:73], v[136:137] neg_lo:[0,1] neg_hi:[0,1]
v_pk_add_f32 v[114:115], v[74:75], v[138:139] neg_lo:[0,1] neg_hi:[0,1]
v_pk_add_f32 v[72:73], v[72:73], v[136:137]
v_pk_add_f32 v[74:75], v[74:75], v[138:139]
v_pk_mul_f32 v[136:137], v[112:113], s[30:31] op_sel:[0,1] neg_lo:[0,1] neg_hi:[0,1]
v_pk_mul_f32 v[138:139], v[112:113], s[34:35] op_sel:[0,1]
v_pk_fma_f32 v[136:137], v[114:115], s[34:35], v[136:137] op_sel:[0,1,0] neg_lo:[0,1,0] neg_hi:[0,1,0]
v_pk_fma_f32 v[138:139], v[114:115], s[30:31], v[138:139] op_sel:[0,1,0] neg_lo:[0,1,0] neg_hi:[0,1,0]
v_pk_add_f32 v[112:113], v[76:77], v[140:141] neg_lo:[0,1] neg_hi:[0,1]
v_pk_add_f32 v[114:115], v[78:79], v[142:143] neg_lo:[0,1] neg_hi:[0,1]
v_pk_add_f32 v[76:77], v[76:77], v[140:141]
v_pk_add_f32 v[78:79], v[78:79], v[142:143]
v_pk_mul_f32 v[140:141], v[112:113], s[30:31] op_sel_hi:[1,0] neg_lo:[0,1] neg_hi:[0,1]
v_pk_mul_f32 v[142:143], v[112:113], s[36:37] op_sel_hi:[1,0]
v_pk_fma_f32 v[140:141], v[114:115], s[36:37], v[140:141] op_sel_hi:[1,0,1] neg_lo:[0,1,0] neg_hi:[0,1,0]
v_pk_fma_f32 v[142:143], v[114:115], s[30:31], v[142:143] op_sel_hi:[1,0,1] neg_lo:[0,1,0] neg_hi:[0,1,0]
v_pk_add_f32 v[112:113], v[16:17], v[48:49] neg_lo:[0,1] neg_hi:[0,1]
v_pk_add_f32 v[114:115], v[18:19], v[50:51] neg_lo:[0,1] neg_hi:[0,1]
v_pk_add_f32 v[16:17], v[16:17], v[48:49]
v_pk_add_f32 v[18:19], v[18:19], v[50:51]
v_pk_add_f32 v[48:49], v[20:21], v[52:53] neg_lo:[0,1] neg_hi:[0,1]
v_pk_add_f32 v[50:51], v[22:23], v[54:55] neg_lo:[0,1] neg_hi:[0,1]
v_pk_add_f32 v[20:21], v[20:21], v[52:53]
v_pk_add_f32 v[22:23], v[22:23], v[54:55]
v_pk_mul_f32 v[52:53], v[48:49], s[30:31] op_sel:[0,1]
v_pk_mul_f32 v[54:55], v[48:49], s[34:35] op_sel:[0,1]
v_pk_fma_f32 v[52:53], v[50:51], s[34:35], v[52:53] op_sel:[0,1,0] neg_lo:[0,1,0] neg_hi:[0,1,0]
v_pk_fma_f32 v[54:55], v[50:51], s[30:31], v[54:55] op_sel:[0,1,0]
v_pk_add_f32 v[48:49], v[24:25], v[56:57] neg_lo:[0,1] neg_hi:[0,1]
v_pk_add_f32 v[50:51], v[26:27], v[58:59] neg_lo:[0,1] neg_hi:[0,1]
v_pk_add_f32 v[24:25], v[24:25], v[56:57]
v_pk_add_f32 v[26:27], v[26:27], v[58:59]
v_pk_mul_f32 v[56:57], v[48:49], s[32:33] op_sel:[0,1]
v_pk_mul_f32 v[58:59], v[48:49], s[32:33] op_sel:[0,1]
v_pk_fma_f32 v[56:57], v[50:51], s[32:33], v[56:57] op_sel:[0,1,0] neg_lo:[0,1,0] neg_hi:[0,1,0]
v_pk_fma_f32 v[58:59], v[50:51], s[32:33], v[58:59] op_sel:[0,1,0]
v_pk_add_f32 v[48:49], v[28:29], v[60:61] neg_lo:[0,1] neg_hi:[0,1]
v_pk_add_f32 v[50:51], v[30:31], v[62:63] neg_lo:[0,1] neg_hi:[0,1]
v_pk_add_f32 v[28:29], v[28:29], v[60:61]
v_pk_add_f32 v[30:31], v[30:31], v[62:63]
v_pk_mul_f32 v[60:61], v[48:49], s[34:35] op_sel:[0,1]
v_pk_mul_f32 v[62:63], v[48:49], s[30:31] op_sel:[0,1]
v_pk_fma_f32 v[60:61], v[50:51], s[30:31], v[60:61] op_sel:[0,1,0] neg_lo:[0,1,0] neg_hi:[0,1,0]
v_pk_fma_f32 v[62:63], v[50:51], s[34:35], v[62:63] op_sel:[0,1,0]
v_pk_add_f32 v[48:49], v[66:67], v[34:35] neg_lo:[0,1] neg_hi:[0,1]
v_pk_add_f32 v[50:51], v[32:33], v[64:65] neg_lo:[0,1] neg_hi:[0,1]
v_pk_add_f32 v[32:33], v[32:33], v[64:65]
v_pk_add_f32 v[34:35], v[34:35], v[66:67]
v_pk_add_f32 v[64:65], v[36:37], v[68:69] neg_lo:[0,1] neg_hi:[0,1]
v_pk_add_f32 v[66:67], v[38:39], v[70:71] neg_lo:[0,1] neg_hi:[0,1]
v_pk_add_f32 v[36:37], v[36:37], v[68:69]
v_pk_add_f32 v[38:39], v[38:39], v[70:71]
v_pk_mul_f32 v[68:69], v[64:65], s[34:35] op_sel:[0,1] neg_lo:[0,1] neg_hi:[0,1]
v_pk_mul_f32 v[70:71], v[64:65], s[30:31] op_sel:[0,1]
v_pk_fma_f32 v[68:69], v[66:67], s[30:31], v[68:69] op_sel:[0,1,0] neg_lo:[0,1,0] neg_hi:[0,1,0]
v_pk_fma_f32 v[70:71], v[66:67], s[34:35], v[70:71] op_sel:[0,1,0] neg_lo:[0,1,0] neg_hi:[0,1,0]
v_pk_add_f32 v[64:65], v[40:41], v[72:73] neg_lo:[0,1] neg_hi:[0,1]
v_pk_add_f32 v[66:67], v[42:43], v[74:75] neg_lo:[0,1] neg_hi:[0,1]
v_pk_add_f32 v[40:41], v[40:41], v[72:73]
v_pk_add_f32 v[42:43], v[42:43], v[74:75]
v_pk_mul_f32 v[72:73], v[64:65], s[32:33] op_sel:[0,1] neg_lo:[0,1] neg_hi:[0,1]
v_pk_mul_f32 v[74:75], v[64:65], s[32:33] op_sel:[0,1]
v_pk_fma_f32 v[72:73], v[66:67], s[32:33], v[72:73] op_sel:[0,1,0] neg_lo:[0,1,0] neg_hi:[0,1,0]
v_pk_fma_f32 v[74:75], v[66:67], s[32:33], v[74:75] op_sel:[0,1,0] neg_lo:[0,1,0] neg_hi:[0,1,0]
v_pk_add_f32 v[64:65], v[44:45], v[76:77] neg_lo:[0,1] neg_hi:[0,1]
v_pk_add_f32 v[66:67], v[46:47], v[78:79] neg_lo:[0,1] neg_hi:[0,1]
v_pk_add_f32 v[44:45], v[44:45], v[76:77]
v_pk_add_f32 v[46:47], v[46:47], v[78:79]
v_pk_mul_f32 v[76:77], v[64:65], s[30:31] op_sel:[0,1] neg_lo:[0,1] neg_hi:[0,1]
v_pk_mul_f32 v[78:79], v[64:65], s[34:35] op_sel:[0,1]
v_pk_fma_f32 v[76:77], v[66:67], s[34:35], v[76:77] op_sel:[0,1,0] neg_lo:[0,1,0] neg_hi:[0,1,0]
v_pk_fma_f32 v[78:79], v[66:67], s[30:31], v[78:79] op_sel:[0,1,0] neg_lo:[0,1,0] neg_hi:[0,1,0]
v_pk_add_f32 v[64:65], v[144:145], v[80:81] neg_lo:[0,1] neg_hi:[0,1]
v_pk_add_f32 v[66:67], v[146:147], v[82:83] neg_lo:[0,1] neg_hi:[0,1]
v_pk_add_f32 v[144:145], v[144:145], v[80:81]
v_pk_add_f32 v[146:147], v[146:147], v[82:83]
v_pk_add_f32 v[80:81], v[84:85], v[116:117] neg_lo:[0,1] neg_hi:[0,1]
v_pk_add_f32 v[82:83], v[86:87], v[118:119] neg_lo:[0,1] neg_hi:[0,1]
v_pk_add_f32 v[84:85], v[84:85], v[116:117]
v_pk_add_f32 v[86:87], v[86:87], v[118:119]
v_pk_mul_f32 v[116:117], v[80:81], s[30:31] op_sel:[0,1]
v_pk_mul_f32 v[118:119], v[80:81], s[34:35] op_sel:[0,1]
v_pk_fma_f32 v[116:117], v[82:83], s[34:35], v[116:117] op_sel:[0,1,0] neg_lo:[0,1,0] neg_hi:[0,1,0]
v_pk_fma_f32 v[118:119], v[82:83], s[30:31], v[118:119] op_sel:[0,1,0]
v_pk_add_f32 v[80:81], v[88:89], v[120:121] neg_lo:[0,1] neg_hi:[0,1]
v_pk_add_f32 v[82:83], v[90:91], v[122:123] neg_lo:[0,1] neg_hi:[0,1]
v_pk_add_f32 v[88:89], v[88:89], v[120:121]
v_pk_add_f32 v[90:91], v[90:91], v[122:123]
v_pk_mul_f32 v[120:121], v[80:81], s[32:33] op_sel:[0,1]
v_pk_mul_f32 v[122:123], v[80:81], s[32:33] op_sel:[0,1]
v_pk_fma_f32 v[120:121], v[82:83], s[32:33], v[120:121] op_sel:[0,1,0] neg_lo:[0,1,0] neg_hi:[0,1,0]
v_pk_fma_f32 v[122:123], v[82:83], s[32:33], v[122:123] op_sel:[0,1,0]
v_pk_add_f32 v[80:81], v[92:93], v[124:125] neg_lo:[0,1] neg_hi:[0,1]
v_pk_add_f32 v[82:83], v[94:95], v[126:127] neg_lo:[0,1] neg_hi:[0,1]
v_pk_add_f32 v[92:93], v[92:93], v[124:125]
v_pk_add_f32 v[94:95], v[94:95], v[126:127]
v_pk_mul_f32 v[124:125], v[80:81], s[34:35] op_sel:[0,1]
v_pk_mul_f32 v[126:127], v[80:81], s[30:31] op_sel:[0,1]
v_pk_fma_f32 v[124:125], v[82:83], s[30:31], v[124:125] op_sel:[0,1,0] neg_lo:[0,1,0] neg_hi:[0,1,0]
v_pk_fma_f32 v[126:127], v[82:83], s[34:35], v[126:127] op_sel:[0,1,0]
v_pk_add_f32 v[80:81], v[130:131], v[98:99] neg_lo:[0,1] neg_hi:[0,1]
v_pk_add_f32 v[82:83], v[96:97], v[128:129] neg_lo:[0,1] neg_hi:[0,1]
v_pk_add_f32 v[96:97], v[96:97], v[128:129]
v_pk_add_f32 v[98:99], v[98:99], v[130:131]
v_pk_add_f32 v[128:129], v[100:101], v[132:133] neg_lo:[0,1] neg_hi:[0,1]
v_pk_add_f32 v[130:131], v[102:103], v[134:135] neg_lo:[0,1] neg_hi:[0,1]
v_pk_add_f32 v[100:101], v[100:101], v[132:133]
v_pk_add_f32 v[102:103], v[102:103], v[134:135]
v_pk_mul_f32 v[132:133], v[128:129], s[34:35] op_sel:[0,1] neg_lo:[0,1] neg_hi:[0,1]
v_pk_mul_f32 v[134:135], v[128:129], s[30:31] op_sel:[0,1]
v_pk_fma_f32 v[132:133], v[130:131], s[30:31], v[132:133] op_sel:[0,1,0] neg_lo:[0,1,0] neg_hi:[0,1,0]
v_pk_fma_f32 v[134:135], v[130:131], s[34:35], v[134:135] op_sel:[0,1,0] neg_lo:[0,1,0] neg_hi:[0,1,0]
v_pk_add_f32 v[128:129], v[104:105], v[136:137] neg_lo:[0,1] neg_hi:[0,1]
v_pk_add_f32 v[130:131], v[106:107], v[138:139] neg_lo:[0,1] neg_hi:[0,1]
v_pk_add_f32 v[104:105], v[104:105], v[136:137]
v_pk_add_f32 v[106:107], v[106:107], v[138:139]
v_pk_mul_f32 v[136:137], v[128:129], s[32:33] op_sel:[0,1] neg_lo:[0,1] neg_hi:[0,1]
v_pk_mul_f32 v[138:139], v[128:129], s[32:33] op_sel:[0,1]
v_pk_fma_f32 v[136:137], v[130:131], s[32:33], v[136:137] op_sel:[0,1,0] neg_lo:[0,1,0] neg_hi:[0,1,0]
v_pk_fma_f32 v[138:139], v[130:131], s[32:33], v[138:139] op_sel:[0,1,0] neg_lo:[0,1,0] neg_hi:[0,1,0]
v_pk_add_f32 v[128:129], v[108:109], v[140:141] neg_lo:[0,1] neg_hi:[0,1]
v_pk_add_f32 v[130:131], v[110:111], v[142:143] neg_lo:[0,1] neg_hi:[0,1]
v_pk_add_f32 v[108:109], v[108:109], v[140:141]
v_pk_add_f32 v[110:111], v[110:111], v[142:143]
v_pk_mul_f32 v[140:141], v[128:129], s[30:31] op_sel:[0,1] neg_lo:[0,1] neg_hi:[0,1]
v_pk_mul_f32 v[142:143], v[128:129], s[34:35] op_sel:[0,1]
v_pk_fma_f32 v[140:141], v[130:131], s[34:35], v[140:141] op_sel:[0,1,0] neg_lo:[0,1,0] neg_hi:[0,1,0]
v_pk_fma_f32 v[142:143], v[130:131], s[30:31], v[142:143] op_sel:[0,1,0] neg_lo:[0,1,0] neg_hi:[0,1,0]
v_pk_add_f32 v[128:129], v[16:17], v[32:33] neg_lo:[0,1] neg_hi:[0,1]
v_pk_add_f32 v[130:131], v[18:19], v[34:35] neg_lo:[0,1] neg_hi:[0,1]
v_pk_add_f32 v[16:17], v[16:17], v[32:33]
v_pk_add_f32 v[18:19], v[18:19], v[34:35]
v_pk_add_f32 v[32:33], v[20:21], v[36:37] neg_lo:[0,1] neg_hi:[0,1]
v_pk_add_f32 v[34:35], v[22:23], v[38:39] neg_lo:[0,1] neg_hi:[0,1]
v_pk_add_f32 v[20:21], v[20:21], v[36:37]
v_pk_add_f32 v[22:23], v[22:23], v[38:39]
v_pk_mul_f32 v[36:37], v[32:33], s[32:33] op_sel:[0,1]
v_pk_mul_f32 v[38:39], v[32:33], s[32:33] op_sel:[0,1]
v_pk_fma_f32 v[36:37], v[34:35], s[32:33], v[36:37] op_sel:[0,1,0] neg_lo:[0,1,0] neg_hi:[0,1,0]
v_pk_fma_f32 v[38:39], v[34:35], s[32:33], v[38:39] op_sel:[0,1,0]
v_pk_add_f32 v[32:33], v[42:43], v[26:27] neg_lo:[0,1] neg_hi:[0,1]
v_pk_add_f32 v[34:35], v[24:25], v[40:41] neg_lo:[0,1] neg_hi:[0,1]
v_pk_add_f32 v[24:25], v[24:25], v[40:41]
v_pk_add_f32 v[26:27], v[26:27], v[42:43]
v_pk_add_f32 v[40:41], v[28:29], v[44:45] neg_lo:[0,1] neg_hi:[0,1]
v_pk_add_f32 v[42:43], v[30:31], v[46:47] neg_lo:[0,1] neg_hi:[0,1]
v_pk_add_f32 v[28:29], v[28:29], v[44:45]
v_pk_add_f32 v[30:31], v[30:31], v[46:47]
v_pk_mul_f32 v[44:45], v[40:41], s[32:33] op_sel:[0,1] neg_lo:[0,1] neg_hi:[0,1]
v_pk_mul_f32 v[46:47], v[40:41], s[32:33] op_sel:[0,1]
v_pk_fma_f32 v[44:45], v[42:43], s[32:33], v[44:45] op_sel:[0,1,0] neg_lo:[0,1,0] neg_hi:[0,1,0]
v_pk_fma_f32 v[46:47], v[42:43], s[32:33], v[46:47] op_sel:[0,1,0] neg_lo:[0,1,0] neg_hi:[0,1,0]
v_pk_add_f32 v[40:41], v[112:113], v[48:49] neg_lo:[0,1] neg_hi:[0,1]
v_pk_add_f32 v[42:43], v[114:115], v[50:51] neg_lo:[0,1] neg_hi:[0,1]
v_pk_add_f32 v[112:113], v[112:113], v[48:49]
v_pk_add_f32 v[114:115], v[114:115], v[50:51]
v_pk_add_f32 v[48:49], v[52:53], v[68:69] neg_lo:[0,1] neg_hi:[0,1]
v_pk_add_f32 v[50:51], v[54:55], v[70:71] neg_lo:[0,1] neg_hi:[0,1]
v_pk_add_f32 v[52:53], v[52:53], v[68:69]
v_pk_add_f32 v[54:55], v[54:55], v[70:71]
v_pk_mul_f32 v[68:69], v[48:49], s[32:33] op_sel:[0,1]
v_pk_mul_f32 v[70:71], v[48:49], s[32:33] op_sel:[0,1]
v_pk_fma_f32 v[68:69], v[50:51], s[32:33], v[68:69] op_sel:[0,1,0] neg_lo:[0,1,0] neg_hi:[0,1,0]
v_pk_fma_f32 v[70:71], v[50:51], s[32:33], v[70:71] op_sel:[0,1,0]
v_pk_add_f32 v[48:49], v[74:75], v[58:59] neg_lo:[0,1] neg_hi:[0,1]
v_pk_add_f32 v[50:51], v[56:57], v[72:73] neg_lo:[0,1] neg_hi:[0,1]
v_pk_add_f32 v[56:57], v[56:57], v[72:73]
v_pk_add_f32 v[58:59], v[58:59], v[74:75]
v_pk_add_f32 v[72:73], v[60:61], v[76:77] neg_lo:[0,1] neg_hi:[0,1]
v_pk_add_f32 v[74:75], v[62:63], v[78:79] neg_lo:[0,1] neg_hi:[0,1]
v_pk_add_f32 v[60:61], v[60:61], v[76:77]
v_pk_add_f32 v[62:63], v[62:63], v[78:79]
v_pk_mul_f32 v[76:77], v[72:73], s[32:33] op_sel:[0,1] neg_lo:[0,1] neg_hi:[0,1]
v_pk_mul_f32 v[78:79], v[72:73], s[32:33] op_sel:[0,1]
v_pk_fma_f32 v[76:77], v[74:75], s[32:33], v[76:77] op_sel:[0,1,0] neg_lo:[0,1,0] neg_hi:[0,1,0]
v_pk_fma_f32 v[78:79], v[74:75], s[32:33], v[78:79] op_sel:[0,1,0] neg_lo:[0,1,0] neg_hi:[0,1,0]
v_pk_add_f32 v[72:73], v[144:145], v[96:97] neg_lo:[0,1] neg_hi:[0,1]
v_pk_add_f32 v[74:75], v[146:147], v[98:99] neg_lo:[0,1] neg_hi:[0,1]
v_pk_add_f32 v[144:145], v[144:145], v[96:97]
v_pk_add_f32 v[146:147], v[146:147], v[98:99]
v_pk_add_f32 v[96:97], v[84:85], v[100:101] neg_lo:[0,1] neg_hi:[0,1]
v_pk_add_f32 v[98:99], v[86:87], v[102:103] neg_lo:[0,1] neg_hi:[0,1]
v_pk_add_f32 v[84:85], v[84:85], v[100:101]
v_pk_add_f32 v[86:87], v[86:87], v[102:103]
v_pk_mul_f32 v[100:101], v[96:97], s[32:33] op_sel:[0,1]
v_pk_mul_f32 v[102:103], v[96:97], s[32:33] op_sel:[0,1]
v_pk_fma_f32 v[100:101], v[98:99], s[32:33], v[100:101] op_sel:[0,1,0] neg_lo:[0,1,0] neg_hi:[0,1,0]
v_pk_fma_f32 v[102:103], v[98:99], s[32:33], v[102:103] op_sel:[0,1,0]
v_pk_add_f32 v[96:97], v[106:107], v[90:91] neg_lo:[0,1] neg_hi:[0,1]
v_pk_add_f32 v[98:99], v[88:89], v[104:105] neg_lo:[0,1] neg_hi:[0,1]
v_pk_add_f32 v[88:89], v[88:89], v[104:105]
v_pk_add_f32 v[90:91], v[90:91], v[106:107]
v_pk_add_f32 v[104:105], v[92:93], v[108:109] neg_lo:[0,1] neg_hi:[0,1]
v_pk_add_f32 v[106:107], v[94:95], v[110:111] neg_lo:[0,1] neg_hi:[0,1]
v_pk_add_f32 v[92:93], v[92:93], v[108:109]
v_pk_add_f32 v[94:95], v[94:95], v[110:111]
v_pk_mul_f32 v[108:109], v[104:105], s[32:33] op_sel:[0,1] neg_lo:[0,1] neg_hi:[0,1]
v_pk_mul_f32 v[110:111], v[104:105], s[32:33] op_sel:[0,1]
v_pk_fma_f32 v[108:109], v[106:107], s[32:33], v[108:109] op_sel:[0,1,0] neg_lo:[0,1,0] neg_hi:[0,1,0]
v_pk_fma_f32 v[110:111], v[106:107], s[32:33], v[110:111] op_sel:[0,1,0] neg_lo:[0,1,0] neg_hi:[0,1,0]
v_pk_add_f32 v[104:105], v[64:65], v[80:81] neg_lo:[0,1] neg_hi:[0,1]
v_pk_add_f32 v[106:107], v[66:67], v[82:83] neg_lo:[0,1] neg_hi:[0,1]
v_pk_add_f32 v[64:65], v[64:65], v[80:81]
v_pk_add_f32 v[66:67], v[66:67], v[82:83]
v_pk_add_f32 v[80:81], v[116:117], v[132:133] neg_lo:[0,1] neg_hi:[0,1]
v_pk_add_f32 v[82:83], v[118:119], v[134:135] neg_lo:[0,1] neg_hi:[0,1]
v_pk_add_f32 v[116:117], v[116:117], v[132:133]
v_pk_add_f32 v[118:119], v[118:119], v[134:135]
v_pk_mul_f32 v[132:133], v[80:81], s[32:33] op_sel:[0,1]
v_pk_mul_f32 v[134:135], v[80:81], s[32:33] op_sel:[0,1]
v_pk_fma_f32 v[132:133], v[82:83], s[32:33], v[132:133] op_sel:[0,1,0] neg_lo:[0,1,0] neg_hi:[0,1,0]
v_pk_fma_f32 v[134:135], v[82:83], s[32:33], v[134:135] op_sel:[0,1,0]
v_pk_add_f32 v[80:81], v[138:139], v[122:123] neg_lo:[0,1] neg_hi:[0,1]
v_pk_add_f32 v[82:83], v[120:121], v[136:137] neg_lo:[0,1] neg_hi:[0,1]
v_pk_add_f32 v[120:121], v[120:121], v[136:137]
v_pk_add_f32 v[122:123], v[122:123], v[138:139]
v_pk_add_f32 v[136:137], v[124:125], v[140:141] neg_lo:[0,1] neg_hi:[0,1]
v_pk_add_f32 v[138:139], v[126:127], v[142:143] neg_lo:[0,1] neg_hi:[0,1]
v_pk_add_f32 v[124:125], v[124:125], v[140:141]
v_pk_add_f32 v[126:127], v[126:127], v[142:143]
v_pk_mul_f32 v[140:141], v[136:137], s[32:33] op_sel:[0,1] neg_lo:[0,1] neg_hi:[0,1]
v_pk_mul_f32 v[142:143], v[136:137], s[32:33] op_sel:[0,1]
v_pk_fma_f32 v[140:141], v[138:139], s[32:33], v[140:141] op_sel:[0,1,0] neg_lo:[0,1,0] neg_hi:[0,1,0]
v_pk_fma_f32 v[142:143], v[138:139], s[32:33], v[142:143] op_sel:[0,1,0] neg_lo:[0,1,0] neg_hi:[0,1,0]
v_pk_add_f32 v[136:137], v[16:17], v[24:25] neg_lo:[0,1] neg_hi:[0,1]
v_pk_add_f32 v[138:139], v[18:19], v[26:27] neg_lo:[0,1] neg_hi:[0,1]
v_pk_add_f32 v[16:17], v[16:17], v[24:25]
v_pk_add_f32 v[18:19], v[18:19], v[26:27]
v_pk_add_f32 v[24:25], v[30:31], v[22:23] neg_lo:[0,1] neg_hi:[0,1]
v_pk_add_f32 v[26:27], v[20:21], v[28:29] neg_lo:[0,1] neg_hi:[0,1]
v_pk_add_f32 v[20:21], v[20:21], v[28:29]
v_pk_add_f32 v[22:23], v[22:23], v[30:31]
v_pk_add_f32 v[28:29], v[128:129], v[32:33] neg_lo:[0,1] neg_hi:[0,1]
v_pk_add_f32 v[30:31], v[130:131], v[34:35] neg_lo:[0,1] neg_hi:[0,1]
v_pk_add_f32 v[128:129], v[128:129], v[32:33]
v_pk_add_f32 v[130:131], v[130:131], v[34:35]
v_pk_add_f32 v[32:33], v[46:47], v[38:39] neg_lo:[0,1] neg_hi:[0,1]
v_pk_add_f32 v[34:35], v[36:37], v[44:45] neg_lo:[0,1] neg_hi:[0,1]
v_pk_add_f32 v[36:37], v[36:37], v[44:45]
v_pk_add_f32 v[38:39], v[38:39], v[46:47]
v_pk_add_f32 v[44:45], v[112:113], v[56:57] neg_lo:[0,1] neg_hi:[0,1]
v_pk_add_f32 v[46:47], v[114:115], v[58:59] neg_lo:[0,1] neg_hi:[0,1]
v_pk_add_f32 v[112:113], v[112:113], v[56:57]
v_pk_add_f32 v[114:115], v[114:115], v[58:59]
v_pk_add_f32 v[56:57], v[62:63], v[54:55] neg_lo:[0,1] neg_hi:[0,1]
v_pk_add_f32 v[58:59], v[52:53], v[60:61] neg_lo:[0,1] neg_hi:[0,1]
v_pk_add_f32 v[52:53], v[52:53], v[60:61]
v_pk_add_f32 v[54:55], v[54:55], v[62:63]
v_pk_add_f32 v[60:61], v[40:41], v[48:49] neg_lo:[0,1] neg_hi:[0,1]
v_pk_add_f32 v[62:63], v[42:43], v[50:51] neg_lo:[0,1] neg_hi:[0,1]
v_pk_add_f32 v[40:41], v[40:41], v[48:49]
v_pk_add_f32 v[42:43], v[42:43], v[50:51]
v_pk_add_f32 v[48:49], v[78:79], v[70:71] neg_lo:[0,1] neg_hi:[0,1]
v_pk_add_f32 v[50:51], v[68:69], v[76:77] neg_lo:[0,1] neg_hi:[0,1]
v_pk_add_f32 v[68:69], v[68:69], v[76:77]
v_pk_add_f32 v[70:71], v[70:71], v[78:79]
v_pk_add_f32 v[76:77], v[144:145], v[88:89] neg_lo:[0,1] neg_hi:[0,1]
v_pk_add_f32 v[78:79], v[146:147], v[90:91] neg_lo:[0,1] neg_hi:[0,1]
v_pk_add_f32 v[144:145], v[144:145], v[88:89]
v_pk_add_f32 v[146:147], v[146:147], v[90:91]
v_pk_add_f32 v[88:89], v[94:95], v[86:87] neg_lo:[0,1] neg_hi:[0,1]
v_pk_add_f32 v[90:91], v[84:85], v[92:93] neg_lo:[0,1] neg_hi:[0,1]
v_pk_add_f32 v[84:85], v[84:85], v[92:93]
v_pk_add_f32 v[86:87], v[86:87], v[94:95]
v_pk_add_f32 v[92:93], v[72:73], v[96:97] neg_lo:[0,1] neg_hi:[0,1]
v_pk_add_f32 v[94:95], v[74:75], v[98:99] neg_lo:[0,1] neg_hi:[0,1]
v_pk_add_f32 v[72:73], v[72:73], v[96:97]
v_pk_add_f32 v[74:75], v[74:75], v[98:99]
v_pk_add_f32 v[96:97], v[110:111], v[102:103] neg_lo:[0,1] neg_hi:[0,1]
v_pk_add_f32 v[98:99], v[100:101], v[108:109] neg_lo:[0,1] neg_hi:[0,1]
v_pk_add_f32 v[100:101], v[100:101], v[108:109]
v_pk_add_f32 v[102:103], v[102:103], v[110:111]
v_pk_add_f32 v[108:109], v[64:65], v[120:121] neg_lo:[0,1] neg_hi:[0,1]
v_pk_add_f32 v[110:111], v[66:67], v[122:123] neg_lo:[0,1] neg_hi:[0,1]
v_pk_add_f32 v[64:65], v[64:65], v[120:121]
v_pk_add_f32 v[66:67], v[66:67], v[122:123]
v_pk_add_f32 v[120:121], v[126:127], v[118:119] neg_lo:[0,1] neg_hi:[0,1]
v_pk_add_f32 v[122:123], v[116:117], v[124:125] neg_lo:[0,1] neg_hi:[0,1]
v_pk_add_f32 v[116:117], v[116:117], v[124:125]
v_pk_add_f32 v[118:119], v[118:119], v[126:127]
v_pk_add_f32 v[124:125], v[104:105], v[80:81] neg_lo:[0,1] neg_hi:[0,1]
v_pk_add_f32 v[126:127], v[106:107], v[82:83] neg_lo:[0,1] neg_hi:[0,1]
v_pk_add_f32 v[104:105], v[104:105], v[80:81]
v_pk_add_f32 v[106:107], v[106:107], v[82:83]
v_pk_add_f32 v[80:81], v[142:143], v[134:135] neg_lo:[0,1] neg_hi:[0,1]
v_pk_add_f32 v[82:83], v[132:133], v[140:141] neg_lo:[0,1] neg_hi:[0,1]
v_pk_add_f32 v[132:133], v[132:133], v[140:141]
v_pk_add_f32 v[134:135], v[134:135], v[142:143]
v_pk_add_f32 v[140:141], v[16:17], v[20:21] neg_lo:[0,1] neg_hi:[0,1]
v_pk_add_f32 v[142:143], v[18:19], v[22:23] neg_lo:[0,1] neg_hi:[0,1]
v_pk_add_f32 v[16:17], v[16:17], v[20:21]
v_pk_add_f32 v[18:19], v[18:19], v[22:23]
v_pk_add_f32 v[20:21], v[136:137], v[24:25] neg_lo:[0,1] neg_hi:[0,1]
v_pk_add_f32 v[22:23], v[138:139], v[26:27] neg_lo:[0,1] neg_hi:[0,1]
v_pk_add_f32 v[136:137], v[136:137], v[24:25]
v_pk_add_f32 v[138:139], v[138:139], v[26:27]
v_pk_add_f32 v[24:25], v[128:129], v[36:37] neg_lo:[0,1] neg_hi:[0,1]
v_pk_add_f32 v[26:27], v[130:131], v[38:39] neg_lo:[0,1] neg_hi:[0,1]
v_pk_add_f32 v[128:129], v[128:129], v[36:37]
v_pk_add_f32 v[130:131], v[130:131], v[38:39]
v_pk_add_f32 v[36:37], v[28:29], v[32:33] neg_lo:[0,1] neg_hi:[0,1]
v_pk_add_f32 v[38:39], v[30:31], v[34:35] neg_lo:[0,1] neg_hi:[0,1]
v_pk_add_f32 v[28:29], v[28:29], v[32:33]
v_pk_add_f32 v[30:31], v[30:31], v[34:35]
v_pk_add_f32 v[32:33], v[112:113], v[52:53] neg_lo:[0,1] neg_hi:[0,1]
v_pk_add_f32 v[34:35], v[114:115], v[54:55] neg_lo:[0,1] neg_hi:[0,1]
v_pk_add_f32 v[112:113], v[112:113], v[52:53]
v_pk_add_f32 v[114:115], v[114:115], v[54:55]
v_pk_add_f32 v[52:53], v[44:45], v[56:57] neg_lo:[0,1] neg_hi:[0,1]
v_pk_add_f32 v[54:55], v[46:47], v[58:59] neg_lo:[0,1] neg_hi:[0,1]
v_pk_add_f32 v[44:45], v[44:45], v[56:57]
v_pk_add_f32 v[46:47], v[46:47], v[58:59]
v_pk_add_f32 v[56:57], v[40:41], v[68:69] neg_lo:[0,1] neg_hi:[0,1]
v_pk_add_f32 v[58:59], v[42:43], v[70:71] neg_lo:[0,1] neg_hi:[0,1]
v_pk_add_f32 v[40:41], v[40:41], v[68:69]
v_pk_add_f32 v[42:43], v[42:43], v[70:71]
v_pk_add_f32 v[68:69], v[60:61], v[48:49] neg_lo:[0,1] neg_hi:[0,1]
v_pk_add_f32 v[70:71], v[62:63], v[50:51] neg_lo:[0,1] neg_hi:[0,1]
v_pk_add_f32 v[60:61], v[60:61], v[48:49]
v_pk_add_f32 v[62:63], v[62:63], v[50:51]
v_pk_add_f32 v[48:49], v[144:145], v[84:85] neg_lo:[0,1] neg_hi:[0,1]
v_pk_add_f32 v[50:51], v[146:147], v[86:87] neg_lo:[0,1] neg_hi:[0,1]
v_pk_add_f32 v[144:145], v[144:145], v[84:85]
v_pk_add_f32 v[146:147], v[146:147], v[86:87]
v_pk_add_f32 v[84:85], v[76:77], v[88:89] neg_lo:[0,1] neg_hi:[0,1]
v_pk_add_f32 v[86:87], v[78:79], v[90:91] neg_lo:[0,1] neg_hi:[0,1]
v_pk_add_f32 v[76:77], v[76:77], v[88:89]
v_pk_add_f32 v[78:79], v[78:79], v[90:91]
v_pk_add_f32 v[88:89], v[72:73], v[100:101] neg_lo:[0,1] neg_hi:[0,1]
v_pk_add_f32 v[90:91], v[74:75], v[102:103] neg_lo:[0,1] neg_hi:[0,1]
v_pk_add_f32 v[72:73], v[72:73], v[100:101]
v_pk_add_f32 v[74:75], v[74:75], v[102:103]
v_pk_add_f32 v[100:101], v[92:93], v[96:97] neg_lo:[0,1] neg_hi:[0,1]
v_pk_add_f32 v[102:103], v[94:95], v[98:99] neg_lo:[0,1] neg_hi:[0,1]
v_pk_add_f32 v[92:93], v[92:93], v[96:97]
v_pk_add_f32 v[94:95], v[94:95], v[98:99]
v_pk_add_f32 v[96:97], v[64:65], v[116:117] neg_lo:[0,1] neg_hi:[0,1]
v_pk_add_f32 v[98:99], v[66:67], v[118:119] neg_lo:[0,1] neg_hi:[0,1]
v_pk_add_f32 v[64:65], v[64:65], v[116:117]
v_pk_add_f32 v[66:67], v[66:67], v[118:119]
v_pk_add_f32 v[116:117], v[108:109], v[120:121] neg_lo:[0,1] neg_hi:[0,1]
v_pk_add_f32 v[118:119], v[110:111], v[122:123] neg_lo:[0,1] neg_hi:[0,1]
v_pk_add_f32 v[108:109], v[108:109], v[120:121]
v_pk_add_f32 v[110:111], v[110:111], v[122:123]
v_pk_add_f32 v[120:121], v[104:105], v[132:133] neg_lo:[0,1] neg_hi:[0,1]
v_pk_add_f32 v[122:123], v[106:107], v[134:135] neg_lo:[0,1] neg_hi:[0,1]
v_pk_add_f32 v[104:105], v[104:105], v[132:133]
v_pk_add_f32 v[106:107], v[106:107], v[134:135]
v_pk_add_f32 v[132:133], v[124:125], v[80:81] neg_lo:[0,1] neg_hi:[0,1]
v_pk_add_f32 v[134:135], v[126:127], v[82:83] neg_lo:[0,1] neg_hi:[0,1]
v_pk_add_f32 v[124:125], v[124:125], v[80:81]
v_pk_add_f32 v[126:127], v[126:127], v[82:83]
s_mov_b32 s20, 0x34800000
v_pk_mul_f32 v[160:161], v[16:17], s[20:21] op_sel_hi:[1,0]
v_pk_mul_f32 v[162:163], v[18:19], s[20:21] op_sel_hi:[1,0]
s_add_u32 s16, s15, 0
buffer_store_dwordx4 v[160:163], v10, s[84:87], s16 offen sc1
v_pk_mul_f32 v[164:165], v[144:145], s[20:21] op_sel_hi:[1,0]
v_pk_mul_f32 v[166:167], v[146:147], s[20:21] op_sel_hi:[1,0]
buffer_store_dwordx4 v[164:167], v10, s[84:87], s16 offen offset:1024 sc1
v_pk_mul_f32 v[168:169], v[112:113], s[20:21] op_sel_hi:[1,0]
v_pk_mul_f32 v[170:171], v[114:115], s[20:21] op_sel_hi:[1,0]
buffer_store_dwordx4 v[168:171], v10, s[84:87], s16 offen offset:2048 sc1
v_pk_mul_f32 v[172:173], v[64:65], s[20:21] op_sel_hi:[1,0]
v_pk_mul_f32 v[174:175], v[66:67], s[20:21] op_sel_hi:[1,0]
buffer_store_dwordx4 v[172:175], v10, s[84:87], s16 offen offset:3072 sc1
v_pk_mul_f32 v[176:177], v[128:129], s[20:21] op_sel_hi:[1,0]
v_pk_mul_f32 v[178:179], v[130:131], s[20:21] op_sel_hi:[1,0]
s_add_u32 s16, s15, 4096
buffer_store_dwordx4 v[176:179], v10, s[84:87], s16 offen sc1
v_pk_mul_f32 v[180:181], v[72:73], s[20:21] op_sel_hi:[1,0]
v_pk_mul_f32 v[182:183], v[74:75], s[20:21] op_sel_hi:[1,0]
buffer_store_dwordx4 v[180:183], v10, s[84:87], s16 offen offset:1024 sc1
v_pk_mul_f32 v[184:185], v[40:41], s[20:21] op_sel_hi:[1,0]
v_pk_mul_f32 v[186:187], v[42:43], s[20:21] op_sel_hi:[1,0]
buffer_store_dwordx4 v[184:187], v10, s[84:87], s16 offen offset:2048 sc1
v_pk_mul_f32 v[188:189], v[104:105], s[20:21] op_sel_hi:[1,0]
v_pk_mul_f32 v[190:191], v[106:107], s[20:21] op_sel_hi:[1,0]
buffer_store_dwordx4 v[188:191], v10, s[84:87], s16 offen offset:3072 sc1
v_pk_mul_f32 v[160:161], v[136:137], s[20:21] op_sel_hi:[1,0]
v_pk_mul_f32 v[162:163], v[138:139], s[20:21] op_sel_hi:[1,0]
s_add_u32 s16, s15, 8192
buffer_store_dwordx4 v[160:163], v10, s[84:87], s16 offen sc1
v_pk_mul_f32 v[164:165], v[76:77], s[20:21] op_sel_hi:[1,0]
v_pk_mul_f32 v[166:167], v[78:79], s[20:21] op_sel_hi:[1,0]
buffer_store_dwordx4 v[164:167], v10, s[84:87], s16 offen offset:1024 sc1
v_pk_mul_f32 v[168:169], v[44:45], s[20:21] op_sel_hi:[1,0]
v_pk_mul_f32 v[170:171], v[46:47], s[20:21] op_sel_hi:[1,0]
buffer_store_dwordx4 v[168:171], v10, s[84:87], s16 offen offset:2048 sc1
v_pk_mul_f32 v[172:173], v[108:109], s[20:21] op_sel_hi:[1,0]
v_pk_mul_f32 v[174:175], v[110:111], s[20:21] op_sel_hi:[1,0]
buffer_store_dwordx4 v[172:175], v10, s[84:87], s16 offen offset:3072 sc1
v_pk_mul_f32 v[176:177], v[28:29], s[20:21] op_sel_hi:[1,0]
v_pk_mul_f32 v[178:179], v[30:31], s[20:21] op_sel_hi:[1,0]
s_add_u32 s16, s15, 12288
buffer_store_dwordx4 v[176:179], v10, s[84:87], s16 offen sc1
v_pk_mul_f32 v[180:181], v[92:93], s[20:21] op_sel_hi:[1,0]
v_pk_mul_f32 v[182:183], v[94:95], s[20:21] op_sel_hi:[1,0]
buffer_store_dwordx4 v[180:183], v10, s[84:87], s16 offen offset:1024 sc1
v_pk_mul_f32 v[184:185], v[60:61], s[20:21] op_sel_hi:[1,0]
v_pk_mul_f32 v[186:187], v[62:63], s[20:21] op_sel_hi:[1,0]
buffer_store_dwordx4 v[184:187], v10, s[84:87], s16 offen offset:2048 sc1
v_pk_mul_f32 v[188:189], v[124:125], s[20:21] op_sel_hi:[1,0]
v_pk_mul_f32 v[190:191], v[126:127], s[20:21] op_sel_hi:[1,0]
buffer_store_dwordx4 v[188:191], v10, s[84:87], s16 offen offset:3072 sc1
v_pk_mul_f32 v[160:161], v[140:141], s[20:21] op_sel_hi:[1,0]
v_pk_mul_f32 v[162:163], v[142:143], s[20:21] op_sel_hi:[1,0]
s_add_u32 s16, s15, 16384
buffer_store_dwordx4 v[160:163], v10, s[84:87], s16 offen sc1
v_pk_mul_f32 v[164:165], v[48:49], s[20:21] op_sel_hi:[1,0]
v_pk_mul_f32 v[166:167], v[50:51], s[20:21] op_sel_hi:[1,0]
buffer_store_dwordx4 v[164:167], v10, s[84:87], s16 offen offset:1024 sc1
v_pk_mul_f32 v[168:169], v[32:33], s[20:21] op_sel_hi:[1,0]
v_pk_mul_f32 v[170:171], v[34:35], s[20:21] op_sel_hi:[1,0]
buffer_store_dwordx4 v[168:171], v10, s[84:87], s16 offen offset:2048 sc1
v_pk_mul_f32 v[172:173], v[96:97], s[20:21] op_sel_hi:[1,0]
v_pk_mul_f32 v[174:175], v[98:99], s[20:21] op_sel_hi:[1,0]
buffer_store_dwordx4 v[172:175], v10, s[84:87], s16 offen offset:3072 sc1
v_pk_mul_f32 v[176:177], v[24:25], s[20:21] op_sel_hi:[1,0]
v_pk_mul_f32 v[178:179], v[26:27], s[20:21] op_sel_hi:[1,0]
s_add_u32 s16, s15, 20480
buffer_store_dwordx4 v[176:179], v10, s[84:87], s16 offen sc1
v_pk_mul_f32 v[180:181], v[88:89], s[20:21] op_sel_hi:[1,0]
v_pk_mul_f32 v[182:183], v[90:91], s[20:21] op_sel_hi:[1,0]
buffer_store_dwordx4 v[180:183], v10, s[84:87], s16 offen offset:1024 sc1
v_pk_mul_f32 v[184:185], v[56:57], s[20:21] op_sel_hi:[1,0]
v_pk_mul_f32 v[186:187], v[58:59], s[20:21] op_sel_hi:[1,0]
buffer_store_dwordx4 v[184:187], v10, s[84:87], s16 offen offset:2048 sc1
v_pk_mul_f32 v[188:189], v[120:121], s[20:21] op_sel_hi:[1,0]
v_pk_mul_f32 v[190:191], v[122:123], s[20:21] op_sel_hi:[1,0]
buffer_store_dwordx4 v[188:191], v10, s[84:87], s16 offen offset:3072 sc1
v_pk_mul_f32 v[160:161], v[20:21], s[20:21] op_sel_hi:[1,0]
v_pk_mul_f32 v[162:163], v[22:23], s[20:21] op_sel_hi:[1,0]
s_add_u32 s16, s15, 24576
buffer_store_dwordx4 v[160:163], v10, s[84:87], s16 offen sc1
v_pk_mul_f32 v[164:165], v[84:85], s[20:21] op_sel_hi:[1,0]
v_pk_mul_f32 v[166:167], v[86:87], s[20:21] op_sel_hi:[1,0]
buffer_store_dwordx4 v[164:167], v10, s[84:87], s16 offen offset:1024 sc1
v_pk_mul_f32 v[168:169], v[52:53], s[20:21] op_sel_hi:[1,0]
v_pk_mul_f32 v[170:171], v[54:55], s[20:21] op_sel_hi:[1,0]
buffer_store_dwordx4 v[168:171], v10, s[84:87], s16 offen offset:2048 sc1
v_pk_mul_f32 v[172:173], v[116:117], s[20:21] op_sel_hi:[1,0]
v_pk_mul_f32 v[174:175], v[118:119], s[20:21] op_sel_hi:[1,0]
buffer_store_dwordx4 v[172:175], v10, s[84:87], s16 offen offset:3072 sc1
v_pk_mul_f32 v[176:177], v[36:37], s[20:21] op_sel_hi:[1,0]
v_pk_mul_f32 v[178:179], v[38:39], s[20:21] op_sel_hi:[1,0]
s_add_u32 s16, s15, 28672
buffer_store_dwordx4 v[176:179], v10, s[84:87], s16 offen sc1
v_pk_mul_f32 v[180:181], v[100:101], s[20:21] op_sel_hi:[1,0]
v_pk_mul_f32 v[182:183], v[102:103], s[20:21] op_sel_hi:[1,0]
buffer_store_dwordx4 v[180:183], v10, s[84:87], s16 offen offset:1024 sc1
v_pk_mul_f32 v[184:185], v[68:69], s[20:21] op_sel_hi:[1,0]
v_pk_mul_f32 v[186:187], v[70:71], s[20:21] op_sel_hi:[1,0]
buffer_store_dwordx4 v[184:187], v10, s[84:87], s16 offen offset:2048 sc1
v_pk_mul_f32 v[188:189], v[132:133], s[20:21] op_sel_hi:[1,0]
v_pk_mul_f32 v[190:191], v[134:135], s[20:21] op_sel_hi:[1,0]
buffer_store_dwordx4 v[188:191], v10, s[84:87], s16 offen offset:3072 sc1
L_f2_end:
s_add_u32 s99, s99, 64
s_cmp_eq_u32 s99, 64
s_cbranch_scc1 L_f2l
s_waitcnt vmcnt(0)
s_barrier
s_cmp_lg_u32 s98, 0
s_cbranch_scc1 L_sg_8
v_mov_b32 v2, 1
s_mov_b32 s81, 71360768
s_mov_b64 exec, 1
buffer_atomic_add v2, off, s[84:87], s81 sc1
s_mov_b64 exec, -1
L_sg_8:
s_cmp_lg_u32 s98, 0
s_cbranch_scc1 L_wf2d
s_mov_b32 s81, 71360768
L_wf2:
buffer_load_dword v120, off, s[84:87], s81 sc1
s_waitcnt vmcnt(0)
v_cmp_ne_u32 vcc, 64, v120
s_cbranch_vccz L_wf2d
s_sleep 6
s_branch L_wf2
L_wf2d:
s_barrier
s_load_dwordx2 s[4:5], s[0:1], 80
s_mov_b32 s30, 0x3f7b14be
s_mov_b32 s31, 0x3f6c835e
s_mov_b32 s32, 0x3f54db31
s_mov_b32 s33, 0x3f3504f3
s_mov_b32 s34, 0x3f0e39da
s_mov_b32 s35, 0x3ec3ef15
s_mov_b32 s36, 0x3e47c5c2
v_and_b32 v5, 7, v0
v_lshrrev_b32 v1, 3, v0
v_mul_u32_u24 v6, 16896, v5
v_lshl_add_u32 v4, v1, 5, v6
v_lshlrev_b32 v5, 4, v5
v_lshl_add_u32 v5, v1, 15, v5
v_lshlrev_b32 v1, 1, v1
s_lshl_b32 s12, s92, 9
s_add_u32 s12, s12, 96468992
s_add_u32 s13, s12, 0
buffer_load_dwordx4 v[48:51], v5, s[84:87], s13 offen
buffer_load_dwordx4 v[52:55], v5, s[84:87], s13 offen offset:128
buffer_load_dwordx4 v[56:59], v5, s[84:87], s13 offen offset:256
buffer_load_dwordx4 v[60:63], v5, s[84:87], s13 offen offset:384
s_add_u32 s13, s12, 1048576
buffer_load_dwordx4 v[64:67], v5, s[84:87], s13 offen
buffer_load_dwordx4 v[68:71], v5, s[84:87], s13 offen offset:128
buffer_load_dwordx4 v[72:75], v5, s[84:87], s13 offen offset:256
buffer_load_dwordx4 v[76:79], v5, s[84:87], s13 offen offset:384
s_add_u32 s13, s12, 2097152
buffer_load_dwordx4 v[80:83], v5, s[84:87], s13 offen
buffer_load_dwordx4 v[84:87], v5, s[84:87], s13 offen offset:128
buffer_load_dwordx4 v[88:91], v5, s[84:87], s13 offen offset:256
buffer_load_dwordx4 v[92:95], v5, s[84:87], s13 offen offset:384
s_add_u32 s13, s12, 3145728
buffer_load_dwordx4 v[96:99], v5, s[84:87], s13 offen
buffer_load_dwordx4 v[100:103], v5, s[84:87], s13 offen offset:128
buffer_load_dwordx4 v[104:107], v5, s[84:87], s13 offen offset:256
buffer_load_dwordx4 v[108:111], v5, s[84:87], s13 offen offset:384
s_add_u32 s13, s12, 4194304
buffer_load_dwordx4 v[112:115], v5, s[84:87], s13 offen
buffer_load_dwordx4 v[116:119], v5, s[84:87], s13 offen offset:128
buffer_load_dwordx4 v[120:123], v5, s[84:87], s13 offen offset:256
buffer_load_dwordx4 v[124:127], v5, s[84:87], s13 offen offset:384
s_add_u32 s13, s12, 5242880
buffer_load_dwordx4 v[128:131], v5, s[84:87], s13 offen
buffer_load_dwordx4 v[132:135], v5, s[84:87], s13 offen offset:128
buffer_load_dwordx4 v[136:139], v5, s[84:87], s13 offen offset:256
buffer_load_dwordx4 v[140:143], v5, s[84:87], s13 offen offset:384
s_add_u32 s13, s12, 6291456
buffer_load_dwordx4 v[144:147], v5, s[84:87], s13 offen
buffer_load_dwordx4 v[148:151], v5, s[84:87], s13 offen offset:128
buffer_load_dwordx4 v[152:155], v5, s[84:87], s13 offen offset:256
buffer_load_dwordx4 v[156:159], v5, s[84:87], s13 offen offset:384
s_add_u32 s13, s12, 7340032
buffer_load_dwordx4 v[160:163], v5, s[84:87], s13 offen
buffer_load_dwordx4 v[164:167], v5, s[84:87], s13 offen offset:128
buffer_load_dwordx4 v[168:171], v5, s[84:87], s13 offen offset:256
buffer_load_dwordx4 v[172:175], v5, s[84:87], s13 offen offset:384
s_add_u32 s13, s12, 8388608
buffer_load_dwordx4 v[176:179], v5, s[84:87], s13 offen
buffer_load_dwordx4 v[180:183], v5, s[84:87], s13 offen offset:128
buffer_load_dwordx4 v[184:187], v5, s[84:87], s13 offen offset:256
buffer_load_dwordx4 v[188:191], v5, s[84:87], s13 offen offset:384
v_cmp_eq_u32 vcc, 0, v1
s_waitcnt lgkmcnt(0)
s_mov_b32 s6, 8388608
s_mov_b32 s7, 0x00020000
v_sub_u32 v7, 1024, v1
v_add_u32 v8, -1, v7
v_and_b32 v7, 1023, v7
v_lshl_add_u32 v7, v7, 4, v6
v_lshl_add_u32 v8, v8, 4, v6
s_waitcnt vmcnt(32)
v_cndmask_b32 v50, v50, 0, vcc
v_cndmask_b32 v54, v54, 0, vcc
v_cndmask_b32 v58, v58, 0, vcc
v_cndmask_b32 v62, v62, 0, vcc
v_sub_f32 v16, v48, v54
v_add_f32 v18, v50, v52
v_add_f32 v24, v48, v54
v_sub_f32 v26, v52, v50
v_sub_f32 v17, v56, v62
v_add_f32 v19, v58, v60
v_add_f32 v25, v56, v62
v_sub_f32 v27, v60, v58
v_sub_f32 v20, v49, v55
v_add_f32 v22, v51, v53
v_add_f32 v28, v49, v55
v_sub_f32 v30, v53, v51
v_sub_f32 v21, v57, v63
v_add_f32 v23, v59, v61
v_add_f32 v29, v57, v63
v_sub_f32 v31, v61, v59
ds_write_b128 v4, v[16:19]
ds_write_b128 v4, v[20:23] offset:16
ds_write_b128 v7, v[24:27]
ds_write_b128 v8, v[28:31]
v_sub_u32 v7, 960, v1
v_add_u32 v8, -1, v7
v_and_b32 v7, 1023, v7
v_lshl_add_u32 v7, v7, 4, v6
v_lshl_add_u32 v8, v8, 4, v6
s_waitcnt vmcnt(28)
v_sub_f32 v32, v64, v70
v_add_f32 v34, v66, v68
v_add_f32 v40, v64, v70
v_sub_f32 v42, v68, v66
v_sub_f32 v33, v72, v78
v_add_f32 v35, v74, v76
v_add_f32 v41, v72, v78
v_sub_f32 v43, v76, v74
v_sub_f32 v36, v65, v71
v_add_f32 v38, v67, v69
v_add_f32 v44, v65, v71
v_sub_f32 v46, v69, v67
v_sub_f32 v37, v73, v79
v_add_f32 v39, v75, v77
v_add_f32 v45, v73, v79
v_sub_f32 v47, v77, v75
ds_write_b128 v4, v[32:35] offset:1024
ds_write_b128 v4, v[36:39] offset:1040
ds_write_b128 v7, v[40:43]
ds_write_b128 v8, v[44:47]
v_sub_u32 v7, 896, v1
v_add_u32 v8, -1, v7
v_and_b32 v7, 1023, v7
v_lshl_add_u32 v7, v7, 4, v6
v_lshl_add_u32 v8, v8, 4, v6
s_waitcnt vmcnt(24)
s_waitcnt lgkmcnt(4)
v_sub_f32 v16, v80, v86
v_add_f32 v18, v82, v84
v_add_f32 v24, v80, v86
v_sub_f32 v26, v84, v82
v_sub_f32 v17, v88, v94
v_add_f32 v19, v90, v92
v_add_f32 v25, v88, v94
v_sub_f32 v27, v92, v90
v_sub_f32 v20, v81, v87
v_add_f32 v22, v83, v85
v_add_f32 v28, v81, v87
v_sub_f32 v30, v85, v83
v_sub_f32 v21, v89, v95
v_add_f32 v23, v91, v93
v_add_f32 v29, v89, v95
v_sub_f32 v31, v93, v91
ds_write_b128 v4, v[16:19] offset:2048
ds_write_b128 v4, v[20:23] offset:2064
ds_write_b128 v7, v[24:27]
ds_write_b128 v8, v[28:31]
v_sub_u32 v7, 832, v1
v_add_u32 v8, -1, v7
v_and_b32 v7, 1023, v7
v_lshl_add_u32 v7, v7, 4, v6
v_lshl_add_u32 v8, v8, 4, v6
s_waitcnt vmcnt(20)
s_waitcnt lgkmcnt(4)
v_sub_f32 v32, v96, v102
v_add_f32 v34, v98, v100
v_add_f32 v40, v96, v102
v_sub_f32 v42, v100, v98
v_sub_f32 v33, v104, v110
v_add_f32 v35, v106, v108
v_add_f32 v41, v104, v110
v_sub_f32 v43, v108, v106
v_sub_f32 v36, v97, v103
v_add_f32 v38, v99, v101
v_add_f32 v44, v97, v103
v_sub_f32 v46, v101, v99
v_sub_f32 v37, v105, v111
v_add_f32 v39, v107, v109
v_add_f32 v45, v105, v111
v_sub_f32 v47, v109, v107
ds_write_b128 v4, v[32:35] offset:3072
ds_write_b128 v4, v[36:39] offset:3088
ds_write_b128 v7, v[40:43]
ds_write_b128 v8, v[44:47]
v_sub_u32 v7, 768, v1
v_add_u32 v8, -1, v7
v_and_b32 v7, 1023, v7
v_lshl_add_u32 v7, v7, 4, v6
v_lshl_add_u32 v8, v8, 4, v6
s_waitcnt vmcnt(16)
s_waitcnt lgkmcnt(4)
v_sub_f32 v16, v112, v118
v_add_f32 v18, v114, v116
v_add_f32 v24, v112, v118
v_sub_f32 v26, v116, v114
v_sub_f32 v17, v120, v126
v_add_f32 v19, v122, v124
v_add_f32 v25, v120, v126
v_sub_f32 v27, v124, v122
v_sub_f32 v20, v113, v119
v_add_f32 v22, v115, v117
v_add_f32 v28, v113, v119
v_sub_f32 v30, v117, v115
v_sub_f32 v21, v121, v127
v_add_f32 v23, v123, v125
v_add_f32 v29, v121, v127
v_sub_f32 v31, v125, v123
ds_write_b128 v4, v[16:19] offset:4096
ds_write_b128 v4, v[20:23] offset:4112
ds_write_b128 v7, v[24:27]
ds_write_b128 v8, v[28:31]
v_sub_u32 v7, 704, v1
v_add_u32 v8, -1, v7
v_and_b32 v7, 1023, v7
v_lshl_add_u32 v7, v7, 4, v6
v_lshl_add_u32 v8, v8, 4, v6
s_waitcnt vmcnt(12)
s_waitcnt lgkmcnt(4)
v_sub_f32 v32, v128, v134
v_add_f32 v34, v130, v132
v_add_f32 v40, v128, v134
v_sub_f32 v42, v132, v130
v_sub_f32 v33, v136, v142
v_add_f32 v35, v138, v140
v_add_f32 v41, v136, v142
v_sub_f32 v43, v140, v138
v_sub_f32 v36, v129, v135
v_add_f32 v38, v131, v133
v_add_f32 v44, v129, v135
v_sub_f32 v46, v133, v131
v_sub_f32 v37, v137, v143
v_add_f32 v39, v139, v141
v_add_f32 v45, v137, v143
v_sub_f32 v47, v141, v139
ds_write_b128 v4, v[32:35] offset:5120
ds_write_b128 v4, v[36:39] offset:5136
ds_write_b128 v7, v[40:43]
ds_write_b128 v8, v[44:47]
v_sub_u32 v7, 640, v1
v_add_u32 v8, -1, v7
v_and_b32 v7, 1023, v7
v_lshl_add_u32 v7, v7, 4, v6
v_lshl_add_u32 v8, v8, 4, v6
s_waitcnt vmcnt(8)
s_waitcnt lgkmcnt(4)
v_sub_f32 v16, v144, v150
v_add_f32 v18, v146, v148
v_add_f32 v24, v144, v150
v_sub_f32 v26, v148, v146
v_sub_f32 v17, v152, v158
v_add_f32 v19, v154, v156
v_add_f32 v25, v152, v158
v_sub_f32 v27, v156, v154
v_sub_f32 v20, v145, v151
v_add_f32 v22, v147, v149
v_add_f32 v28, v145, v151
v_sub_f32 v30, v149, v147
v_sub_f32 v21, v153, v159
v_add_f32 v23, v155, v157
v_add_f32 v29, v153, v159
v_sub_f32 v31, v157, v155
ds_write_b128 v4, v[16:19] offset:6144
ds_write_b128 v4, v[20:23] offset:6160
ds_write_b128 v7, v[24:27]
ds_write_b128 v8, v[28:31]
v_sub_u32 v7, 576, v1
v_add_u32 v8, -1, v7
v_and_b32 v7, 1023, v7
v_lshl_add_u32 v7, v7, 4, v6
v_lshl_add_u32 v8, v8, 4, v6
s_waitcnt vmcnt(4)
s_waitcnt lgkmcnt(4)
v_sub_f32 v32, v160, v166
v_add_f32 v34, v162, v164
v_add_f32 v40, v160, v166
v_sub_f32 v42, v164, v162
v_sub_f32 v33, v168, v174
v_add_f32 v35, v170, v172
v_add_f32 v41, v168, v174
v_sub_f32 v43, v172, v170
v_sub_f32 v36, v161, v167
v_add_f32 v38, v163, v165
v_add_f32 v44, v161, v167
v_sub_f32 v46, v165, v163
v_sub_f32 v37, v169, v175
v_add_f32 v39, v171, v173
v_add_f32 v45, v169, v175
v_sub_f32 v47, v173, v171
ds_write_b128 v4, v[32:35] offset:7168
ds_write_b128 v4, v[36:39] offset:7184
ds_write_b128 v7, v[40:43]
ds_write_b128 v8, v[44:47]
v_sub_u32 v7, 512, v1
v_add_u32 v8, -1, v7
v_and_b32 v7, 1023, v7
v_lshl_add_u32 v7, v7, 4, v6
v_lshl_add_u32 v8, v8, 4, v6
s_waitcnt vmcnt(0)
v_cndmask_b32 v178, v178, 0, vcc
v_cndmask_b32 v182, v182, 0, vcc
v_cndmask_b32 v186, v186, 0, vcc
v_cndmask_b32 v190, v190, 0, vcc
s_waitcnt lgkmcnt(4)
v_sub_f32 v16, v176, v182
v_add_f32 v18, v178, v180
v_add_f32 v24, v176, v182
v_sub_f32 v26, v180, v178
v_sub_f32 v17, v184, v190
v_add_f32 v19, v186, v188
v_add_f32 v25, v184, v190
v_sub_f32 v27, v188, v186
s_and_saveexec_b64 s[14:15], vcc
ds_write_b128 v4, v[16:19] offset:8192
s_mov_b64 exec, s[14:15]
s_waitcnt lgkmcnt(0)
s_barrier
v_and_b32 v1, 31, v0
v_lshrrev_b32 v2, 5, v0
v_cvt_f32_u32 v3, v1
v_mul_u32_u24 v6, 16896, v2
v_lshl_add_u32 v4, v1, 4, v6
v_mul_u32_u24 v5, 528, v1
v_add_u32 v5, v5, v6
ds_read_b128 v[16:19], v4
ds_read_b128 v[20:23], v4 offset:512
ds_read_b128 v[24:27], v4 offset:1024
ds_read_b128 v[28:31], v4 offset:1536
ds_read_b128 v[32:35], v4 offset:2048
ds_read_b128 v[36:39], v4 offset:2560
ds_read_b128 v[40:43], v4 offset:3072
ds_read_b128 v[44:47], v4 offset:3584
ds_read_b128 v[48:51], v4 offset:4096
ds_read_b128 v[52:55], v4 offset:4608
ds_read_b128 v[56:59], v4 offset:5120
ds_read_b128 v[60:63], v4 offset:5632
s_waitcnt lgkmcnt(4)
ds_read_b128 v[64:67], v4 offset:6144
ds_read_b128 v[68:71], v4 offset:6656
ds_read_b128 v[72:75], v4 offset:7168
ds_read_b128 v[76:79], v4 offset:7680
ds_read_b128 v[80:83], v4 offset:8192
ds_read_b128 v[84:87], v4 offset:8704
ds_read_b128 v[88:91], v4 offset:9216
ds_read_b128 v[92:95], v4 offset:9728
ds_read_b128 v[96:99], v4 offset:10240
ds_read_b128 v[100:103], v4 offset:10752
ds_read_b128 v[104:107], v4 offset:11264
ds_read_b128 v[108:111], v4 offset:11776
s_waitcnt lgkmcnt(4)
ds_read_b128 v[112:115], v4 offset:12288
ds_read_b128 v[116:119], v4 offset:12800
ds_read_b128 v[120:123], v4 offset:13312
ds_read_b128 v[124:127], v4 offset:13824
ds_read_b128 v[128:131], v4 offset:14336
ds_read_b128 v[132:135], v4 offset:14848
ds_read_b128 v[136:139], v4 offset:15360
ds_read_b128 v[140:143], v4 offset:15872
s_waitcnt lgkmcnt(0)
v_pk_add_f32 v[144:145], v[16:17], v[80:81] neg_lo:[0,1] neg_hi:[0,1]
v_pk_add_f32 v[146:147], v[18:19], v[82:83] neg_lo:[0,1] neg_hi:[0,1]
v_pk_add_f32 v[16:17], v[16:17], v[80:81]
v_pk_add_f32 v[18:19], v[18:19], v[82:83]
v_pk_add_f32 v[80:81], v[20:21], v[84:85] neg_lo:[0,1] neg_hi:[0,1]
v_pk_add_f32 v[82:83], v[22:23], v[86:87] neg_lo:[0,1] neg_hi:[0,1]
v_pk_add_f32 v[20:21], v[20:21], v[84:85]
v_pk_add_f32 v[22:23], v[22:23], v[86:87]
v_pk_mul_f32 v[84:85], v[80:81], s[30:31] op_sel_hi:[1,0]
v_pk_mul_f32 v[86:87], v[80:81], s[36:37] op_sel_hi:[1,0]
v_pk_fma_f32 v[84:85], v[82:83], s[36:37], v[84:85] op_sel_hi:[1,0,1] neg_lo:[0,1,0] neg_hi:[0,1,0]
v_pk_fma_f32 v[86:87], v[82:83], s[30:31], v[86:87] op_sel_hi:[1,0,1]
v_pk_add_f32 v[80:81], v[24:25], v[88:89] neg_lo:[0,1] neg_hi:[0,1]
v_pk_add_f32 v[82:83], v[26:27], v[90:91] neg_lo:[0,1] neg_hi:[0,1]
v_pk_add_f32 v[24:25], v[24:25], v[88:89]
v_pk_add_f32 v[26:27], v[26:27], v[90:91]
v_pk_mul_f32 v[88:89], v[80:81], s[30:31] op_sel:[0,1]
v_pk_mul_f32 v[90:91], v[80:81], s[34:35] op_sel:[0,1]
v_pk_fma_f32 v[88:89], v[82:83], s[34:35], v[88:89] op_sel:[0,1,0] neg_lo:[0,1,0] neg_hi:[0,1,0]
v_pk_fma_f32 v[90:91], v[82:83], s[30:31], v[90:91] op_sel:[0,1,0]
v_pk_add_f32 v[80:81], v[28:29], v[92:93] neg_lo:[0,1] neg_hi:[0,1]
v_pk_add_f32 v[82:83], v[30:31], v[94:95] neg_lo:[0,1] neg_hi:[0,1]
v_pk_add_f32 v[28:29], v[28:29], v[92:93]
v_pk_add_f32 v[30:31], v[30:31], v[94:95]
v_pk_mul_f32 v[92:93], v[80:81], s[32:33] op_sel_hi:[1,0]
v_pk_mul_f32 v[94:95], v[80:81], s[34:35] op_sel_hi:[1,0]
v_pk_fma_f32 v[92:93], v[82:83], s[34:35], v[92:93] op_sel_hi:[1,0,1] neg_lo:[0,1,0] neg_hi:[0,1,0]
v_pk_fma_f32 v[94:95], v[82:83], s[32:33], v[94:95] op_sel_hi:[1,0,1]
v_pk_add_f32 v[80:81], v[32:33], v[96:97] neg_lo:[0,1] neg_hi:[0,1]
v_pk_add_f32 v[82:83], v[34:35], v[98:99] neg_lo:[0,1] neg_hi:[0,1]
v_pk_add_f32 v[32:33], v[32:33], v[96:97]
v_pk_add_f32 v[34:35], v[34:35], v[98:99]
v_pk_mul_f32 v[96:97], v[80:81], s[32:33] op_sel:[0,1]
v_pk_mul_f32 v[98:99], v[80:81], s[32:33] op_sel:[0,1]
v_pk_fma_f32 v[96:97], v[82:83], s[32:33], v[96:97] op_sel:[0,1,0] neg_lo:[0,1,0] neg_hi:[0,1,0]
v_pk_fma_f32 v[98:99], v[82:83], s[32:33], v[98:99] op_sel:[0,1,0]
v_pk_add_f32 v[80:81], v[36:37], v[100:101] neg_lo:[0,1] neg_hi:[0,1]
v_pk_add_f32 v[82:83], v[38:39], v[102:103] neg_lo:[0,1] neg_hi:[0,1]
v_pk_add_f32 v[36:37], v[36:37], v[100:101]
v_pk_add_f32 v[38:39], v[38:39], v[102:103]
v_pk_mul_f32 v[100:101], v[80:81], s[34:35] op_sel_hi:[1,0]
v_pk_mul_f32 v[102:103], v[80:81], s[32:33] op_sel_hi:[1,0]
v_pk_fma_f32 v[100:101], v[82:83], s[32:33], v[100:101] op_sel_hi:[1,0,1] neg_lo:[0,1,0] neg_hi:[0,1,0]
v_pk_fma_f32 v[102:103], v[82:83], s[34:35], v[102:103] op_sel_hi:[1,0,1]
v_pk_add_f32 v[80:81], v[40:41], v[104:105] neg_lo:[0,1] neg_hi:[0,1]
v_pk_add_f32 v[82:83], v[42:43], v[106:107] neg_lo:[0,1] neg_hi:[0,1]
v_pk_add_f32 v[40:41], v[40:41], v[104:105]
v_pk_add_f32 v[42:43], v[42:43], v[106:107]
v_pk_mul_f32 v[104:105], v[80:81], s[34:35] op_sel:[0,1]
v_pk_mul_f32 v[106:107], v[80:81], s[30:31] op_sel:[0,1]
v_pk_fma_f32 v[104:105], v[82:83], s[30:31], v[104:105] op_sel:[0,1,0] neg_lo:[0,1,0] neg_hi:[0,1,0]
v_pk_fma_f32 v[106:107], v[82:83], s[34:35], v[106:107] op_sel:[0,1,0]
v_pk_add_f32 v[80:81], v[44:45], v[108:109] neg_lo:[0,1] neg_hi:[0,1]
v_pk_add_f32 v[82:83], v[46:47], v[110:111] neg_lo:[0,1] neg_hi:[0,1]
v_pk_add_f32 v[44:45], v[44:45], v[108:109]
v_pk_add_f32 v[46:47], v[46:47], v[110:111]
v_pk_mul_f32 v[108:109], v[80:81], s[36:37] op_sel_hi:[1,0]
v_pk_mul_f32 v[110:111], v[80:81], s[30:31] op_sel_hi:[1,0]
v_pk_fma_f32 v[108:109], v[82:83], s[30:31], v[108:109] op_sel_hi:[1,0,1] neg_lo:[0,1,0] neg_hi:[0,1,0]
v_pk_fma_f32 v[110:111], v[82:83], s[36:37], v[110:111] op_sel_hi:[1,0,1]
v_pk_add_f32 v[80:81], v[114:115], v[50:51] neg_lo:[0,1] neg_hi:[0,1]
v_pk_add_f32 v[82:83], v[48:49], v[112:113] neg_lo:[0,1] neg_hi:[0,1]
v_pk_add_f32 v[48:49], v[48:49], v[112:113]
v_pk_add_f32 v[50:51], v[50:51], v[114:115]
v_pk_add_f32 v[112:113], v[52:53], v[116:117] neg_lo:[0,1] neg_hi:[0,1]
v_pk_add_f32 v[114:115], v[54:55], v[118:119] neg_lo:[0,1] neg_hi:[0,1]
v_pk_add_f32 v[52:53], v[52:53], v[116:117]
v_pk_add_f32 v[54:55], v[54:55], v[118:119]
v_pk_mul_f32 v[116:117], v[112:113], s[36:37] op_sel_hi:[1,0] neg_lo:[0,1] neg_hi:[0,1]
v_pk_mul_f32 v[118:119], v[112:113], s[30:31] op_sel_hi:[1,0]
v_pk_fma_f32 v[116:117], v[114:115], s[30:31], v[116:117] op_sel_hi:[1,0,1] neg_lo:[0,1,0] neg_hi:[0,1,0]
v_pk_fma_f32 v[118:119], v[114:115], s[36:37], v[118:119] op_sel_hi:[1,0,1] neg_lo:[0,1,0] neg_hi:[0,1,0]
v_pk_add_f32 v[112:113], v[56:57], v[120:121] neg_lo:[0,1] neg_hi:[0,1]
v_pk_add_f32 v[114:115], v[58:59], v[122:123] neg_lo:[0,1] neg_hi:[0,1]
v_pk_add_f32 v[56:57], v[56:57], v[120:121]
v_pk_add_f32 v[58:59], v[58:59], v[122:123]
v_pk_mul_f32 v[120:121], v[112:113], s[34:35] op_sel:[0,1] neg_lo:[0,1] neg_hi:[0,1]
v_pk_mul_f32 v[122:123], v[112:113], s[30:31] op_sel:[0,1]
v_pk_fma_f32 v[120:121], v[114:115], s[30:31], v[120:121] op_sel:[0,1,0] neg_lo:[0,1,0] neg_hi:[0,1,0]
v_pk_fma_f32 v[122:123], v[114:115], s[34:35], v[122:123] op_sel:[0,1,0] neg_lo:[0,1,0] neg_hi:[0,1,0]
v_pk_add_f32 v[112:113], v[60:61], v[124:125] neg_lo:[0,1] neg_hi:[0,1]
v_pk_add_f32 v[114:115], v[62:63], v[126:127] neg_lo:[0,1] neg_hi:[0,1]
v_pk_add_f32 v[60:61], v[60:61], v[124:125]
v_pk_add_f32 v[62:63], v[62:63], v[126:127]
v_pk_mul_f32 v[124:125], v[112:113], s[34:35] op_sel_hi:[1,0] neg_lo:[0,1] neg_hi:[0,1]
v_pk_mul_f32 v[126:127], v[112:113], s[32:33] op_sel_hi:[1,0]
v_pk_fma_f32 v[124:125], v[114:115], s[32:33], v[124:125] op_sel_hi:[1,0,1] neg_lo:[0,1,0] neg_hi:[0,1,0]
v_pk_fma_f32 v[126:127], v[114:115], s[34:35], v[126:127] op_sel_hi:[1,0,1] neg_lo:[0,1,0] neg_hi:[0,1,0]
v_pk_add_f32 v[112:113], v[64:65], v[128:129] neg_lo:[0,1] neg_hi:[0,1]
v_pk_add_f32 v[114:115], v[66:67], v[130:131] neg_lo:[0,1] neg_hi:[0,1]
v_pk_add_f32 v[64:65], v[64:65], v[128:129]
v_pk_add_f32 v[66:67], v[66:67], v[130:131]
v_pk_mul_f32 v[128:129], v[112:113], s[32:33] op_sel:[0,1] neg_lo:[0,1] neg_hi:[0,1]
v_pk_mul_f32 v[130:131], v[112:113], s[32:33] op_sel:[0,1]
v_pk_fma_f32 v[128:129], v[114:115], s[32:33], v[128:129] op_sel:[0,1,0] neg_lo:[0,1,0] neg_hi:[0,1,0]
v_pk_fma_f32 v[130:131], v[114:115], s[32:33], v[130:131] op_sel:[0,1,0] neg_lo:[0,1,0] neg_hi:[0,1,0]
v_pk_add_f32 v[112:113], v[68:69], v[132:133] neg_lo:[0,1] neg_hi:[0,1]
v_pk_add_f32 v[114:115], v[70:71], v[134:135] neg_lo:[0,1] neg_hi:[0,1]
v_pk_add_f32 v[68:69], v[68:69], v[132:133]
v_pk_add_f32 v[70:71], v[70:71], v[134:135]
v_pk_mul_f32 v[132:133], v[112:113], s[32:33] op_sel_hi:[1,0] neg_lo:[0,1] neg_hi:[0,1]
v_pk_mul_f32 v[134:135], v[112:113], s[34:35] op_sel_hi:[1,0]
v_pk_fma_f32 v[132:133], v[114:115], s[34:35], v[132:133] op_sel_hi:[1,0,1] neg_lo:[0,1,0] neg_hi:[0,1,0]
v_pk_fma_f32 v[134:135], v[114:115], s[32:33], v[134:135] op_sel_hi:[1,0,1] neg_lo:[0,1,0] neg_hi:[0,1,0]
v_pk_add_f32 v[112:113], v[72:73], v[136:137] neg_lo:[0,1] neg_hi:[0,1]
v_pk_add_f32 v[114:115], v[74:75], v[138:139] neg_lo:[0,1] neg_hi:[0,1]
v_pk_add_f32 v[72:73], v[72:73], v[136:137]
v_pk_add_f32 v[74:75], v[74:75], v[138:139]
v_pk_mul_f32 v[136:137], v[112:113], s[30:31] op_sel:[0,1] neg_lo:[0,1] neg_hi:[0,1]
v_pk_mul_f32 v[138:139], v[112:113], s[34:35] op_sel:[0,1]
v_pk_fma_f32 v[136:137], v[114:115], s[34:35], v[136:137] op_sel:[0,1,0] neg_lo:[0,1,0] neg_hi:[0,1,0]
v_pk_fma_f32 v[138:139], v[114:115], s[30:31], v[138:139] op_sel:[0,1,0] neg_lo:[0,1,0] neg_hi:[0,1,0]
v_pk_add_f32 v[112:113], v[76:77], v[140:141] neg_lo:[0,1] neg_hi:[0,1]
v_pk_add_f32 v[114:115], v[78:79], v[142:143] neg_lo:[0,1] neg_hi:[0,1]
v_pk_add_f32 v[76:77], v[76:77], v[140:141]
v_pk_add_f32 v[78:79], v[78:79], v[142:143]
v_pk_mul_f32 v[140:141], v[112:113], s[30:31] op_sel_hi:[1,0] neg_lo:[0,1] neg_hi:[0,1]
v_pk_mul_f32 v[142:143], v[112:113], s[36:37] op_sel_hi:[1,0]
v_pk_fma_f32 v[140:141], v[114:115], s[36:37], v[140:141] op_sel_hi:[1,0,1] neg_lo:[0,1,0] neg_hi:[0,1,0]
v_pk_fma_f32 v[142:143], v[114:115], s[30:31], v[142:143] op_sel_hi:[1,0,1] neg_lo:[0,1,0] neg_hi:[0,1,0]
v_pk_add_f32 v[112:113], v[16:17], v[48:49] neg_lo:[0,1] neg_hi:[0,1]
v_pk_add_f32 v[114:115], v[18:19], v[50:51] neg_lo:[0,1] neg_hi:[0,1]
v_pk_add_f32 v[16:17], v[16:17], v[48:49]
v_pk_add_f32 v[18:19], v[18:19], v[50:51]
v_pk_add_f32 v[48:49], v[20:21], v[52:53] neg_lo:[0,1] neg_hi:[0,1]
v_pk_add_f32 v[50:51], v[22:23], v[54:55] neg_lo:[0,1] neg_hi:[0,1]
v_pk_add_f32 v[20:21], v[20:21], v[52:53]
v_pk_add_f32 v[22:23], v[22:23], v[54:55]
v_pk_mul_f32 v[52:53], v[48:49], s[30:31] op_sel:[0,1]
v_pk_mul_f32 v[54:55], v[48:49], s[34:35] op_sel:[0,1]
v_pk_fma_f32 v[52:53], v[50:51], s[34:35], v[52:53] op_sel:[0,1,0] neg_lo:[0,1,0] neg_hi:[0,1,0]
v_pk_fma_f32 v[54:55], v[50:51], s[30:31], v[54:55] op_sel:[0,1,0]
v_pk_add_f32 v[48:49], v[24:25], v[56:57] neg_lo:[0,1] neg_hi:[0,1]
v_pk_add_f32 v[50:51], v[26:27], v[58:59] neg_lo:[0,1] neg_hi:[0,1]
v_pk_add_f32 v[24:25], v[24:25], v[56:57]
v_pk_add_f32 v[26:27], v[26:27], v[58:59]
v_pk_mul_f32 v[56:57], v[48:49], s[32:33] op_sel:[0,1]
v_pk_mul_f32 v[58:59], v[48:49], s[32:33] op_sel:[0,1]
v_pk_fma_f32 v[56:57], v[50:51], s[32:33], v[56:57] op_sel:[0,1,0] neg_lo:[0,1,0] neg_hi:[0,1,0]
v_pk_fma_f32 v[58:59], v[50:51], s[32:33], v[58:59] op_sel:[0,1,0]
v_pk_add_f32 v[48:49], v[28:29], v[60:61] neg_lo:[0,1] neg_hi:[0,1]
v_pk_add_f32 v[50:51], v[30:31], v[62:63] neg_lo:[0,1] neg_hi:[0,1]
v_pk_add_f32 v[28:29], v[28:29], v[60:61]
v_pk_add_f32 v[30:31], v[30:31], v[62:63]
v_pk_mul_f32 v[60:61], v[48:49], s[34:35] op_sel:[0,1]
v_pk_mul_f32 v[62:63], v[48:49], s[30:31] op_sel:[0,1]
v_pk_fma_f32 v[60:61], v[50:51], s[30:31], v[60:61] op_sel:[0,1,0] neg_lo:[0,1,0] neg_hi:[0,1,0]
v_pk_fma_f32 v[62:63], v[50:51], s[34:35], v[62:63] op_sel:[0,1,0]
v_pk_add_f32 v[48:49], v[66:67], v[34:35] neg_lo:[0,1] neg_hi:[0,1]
v_pk_add_f32 v[50:51], v[32:33], v[64:65] neg_lo:[0,1] neg_hi:[0,1]
v_pk_add_f32 v[32:33], v[32:33], v[64:65]
v_pk_add_f32 v[34:35], v[34:35], v[66:67]
v_pk_add_f32 v[64:65], v[36:37], v[68:69] neg_lo:[0,1] neg_hi:[0,1]
v_pk_add_f32 v[66:67], v[38:39], v[70:71] neg_lo:[0,1] neg_hi:[0,1]
v_pk_add_f32 v[36:37], v[36:37], v[68:69]
v_pk_add_f32 v[38:39], v[38:39], v[70:71]
v_pk_mul_f32 v[68:69], v[64:65], s[34:35] op_sel:[0,1] neg_lo:[0,1] neg_hi:[0,1]
v_pk_mul_f32 v[70:71], v[64:65], s[30:31] op_sel:[0,1]
v_pk_fma_f32 v[68:69], v[66:67], s[30:31], v[68:69] op_sel:[0,1,0] neg_lo:[0,1,0] neg_hi:[0,1,0]
v_pk_fma_f32 v[70:71], v[66:67], s[34:35], v[70:71] op_sel:[0,1,0] neg_lo:[0,1,0] neg_hi:[0,1,0]
v_pk_add_f32 v[64:65], v[40:41], v[72:73] neg_lo:[0,1] neg_hi:[0,1]
v_pk_add_f32 v[66:67], v[42:43], v[74:75] neg_lo:[0,1] neg_hi:[0,1]
v_pk_add_f32 v[40:41], v[40:41], v[72:73]
v_pk_add_f32 v[42:43], v[42:43], v[74:75]
v_pk_mul_f32 v[72:73], v[64:65], s[32:33] op_sel:[0,1] neg_lo:[0,1] neg_hi:[0,1]
v_pk_mul_f32 v[74:75], v[64:65], s[32:33] op_sel:[0,1]
v_pk_fma_f32 v[72:73], v[66:67], s[32:33], v[72:73] op_sel:[0,1,0] neg_lo:[0,1,0] neg_hi:[0,1,0]
v_pk_fma_f32 v[74:75], v[66:67], s[32:33], v[74:75] op_sel:[0,1,0] neg_lo:[0,1,0] neg_hi:[0,1,0]
v_pk_add_f32 v[64:65], v[44:45], v[76:77] neg_lo:[0,1] neg_hi:[0,1]
v_pk_add_f32 v[66:67], v[46:47], v[78:79] neg_lo:[0,1] neg_hi:[0,1]
v_pk_add_f32 v[44:45], v[44:45], v[76:77]
v_pk_add_f32 v[46:47], v[46:47], v[78:79]
v_pk_mul_f32 v[76:77], v[64:65], s[30:31] op_sel:[0,1] neg_lo:[0,1] neg_hi:[0,1]
v_pk_mul_f32 v[78:79], v[64:65], s[34:35] op_sel:[0,1]
v_pk_fma_f32 v[76:77], v[66:67], s[34:35], v[76:77] op_sel:[0,1,0] neg_lo:[0,1,0] neg_hi:[0,1,0]
v_pk_fma_f32 v[78:79], v[66:67], s[30:31], v[78:79] op_sel:[0,1,0] neg_lo:[0,1,0] neg_hi:[0,1,0]
v_pk_add_f32 v[64:65], v[144:145], v[80:81] neg_lo:[0,1] neg_hi:[0,1]
v_pk_add_f32 v[66:67], v[146:147], v[82:83] neg_lo:[0,1] neg_hi:[0,1]
v_pk_add_f32 v[144:145], v[144:145], v[80:81]
v_pk_add_f32 v[146:147], v[146:147], v[82:83]
v_pk_add_f32 v[80:81], v[84:85], v[116:117] neg_lo:[0,1] neg_hi:[0,1]
v_pk_add_f32 v[82:83], v[86:87], v[118:119] neg_lo:[0,1] neg_hi:[0,1]
v_pk_add_f32 v[84:85], v[84:85], v[116:117]
v_pk_add_f32 v[86:87], v[86:87], v[118:119]
v_pk_mul_f32 v[116:117], v[80:81], s[30:31] op_sel:[0,1]
v_pk_mul_f32 v[118:119], v[80:81], s[34:35] op_sel:[0,1]
v_pk_fma_f32 v[116:117], v[82:83], s[34:35], v[116:117] op_sel:[0,1,0] neg_lo:[0,1,0] neg_hi:[0,1,0]
v_pk_fma_f32 v[118:119], v[82:83], s[30:31], v[118:119] op_sel:[0,1,0]
v_pk_add_f32 v[80:81], v[88:89], v[120:121] neg_lo:[0,1] neg_hi:[0,1]
v_pk_add_f32 v[82:83], v[90:91], v[122:123] neg_lo:[0,1] neg_hi:[0,1]
v_pk_add_f32 v[88:89], v[88:89], v[120:121]
v_pk_add_f32 v[90:91], v[90:91], v[122:123]
v_pk_mul_f32 v[120:121], v[80:81], s[32:33] op_sel:[0,1]
v_pk_mul_f32 v[122:123], v[80:81], s[32:33] op_sel:[0,1]
v_pk_fma_f32 v[120:121], v[82:83], s[32:33], v[120:121] op_sel:[0,1,0] neg_lo:[0,1,0] neg_hi:[0,1,0]
v_pk_fma_f32 v[122:123], v[82:83], s[32:33], v[122:123] op_sel:[0,1,0]
v_pk_add_f32 v[80:81], v[92:93], v[124:125] neg_lo:[0,1] neg_hi:[0,1]
v_pk_add_f32 v[82:83], v[94:95], v[126:127] neg_lo:[0,1] neg_hi:[0,1]
v_pk_add_f32 v[92:93], v[92:93], v[124:125]
v_pk_add_f32 v[94:95], v[94:95], v[126:127]
v_pk_mul_f32 v[124:125], v[80:81], s[34:35] op_sel:[0,1]
v_pk_mul_f32 v[126:127], v[80:81], s[30:31] op_sel:[0,1]
v_pk_fma_f32 v[124:125], v[82:83], s[30:31], v[124:125] op_sel:[0,1,0] neg_lo:[0,1,0] neg_hi:[0,1,0]
v_pk_fma_f32 v[126:127], v[82:83], s[34:35], v[126:127] op_sel:[0,1,0]
v_pk_add_f32 v[80:81], v[130:131], v[98:99] neg_lo:[0,1] neg_hi:[0,1]
v_pk_add_f32 v[82:83], v[96:97], v[128:129] neg_lo:[0,1] neg_hi:[0,1]
v_pk_add_f32 v[96:97], v[96:97], v[128:129]
v_pk_add_f32 v[98:99], v[98:99], v[130:131]
v_pk_add_f32 v[128:129], v[100:101], v[132:133] neg_lo:[0,1] neg_hi:[0,1]
v_pk_add_f32 v[130:131], v[102:103], v[134:135] neg_lo:[0,1] neg_hi:[0,1]
v_pk_add_f32 v[100:101], v[100:101], v[132:133]
v_pk_add_f32 v[102:103], v[102:103], v[134:135]
v_pk_mul_f32 v[132:133], v[128:129], s[34:35] op_sel:[0,1] neg_lo:[0,1] neg_hi:[0,1]
v_pk_mul_f32 v[134:135], v[128:129], s[30:31] op_sel:[0,1]
v_pk_fma_f32 v[132:133], v[130:131], s[30:31], v[132:133] op_sel:[0,1,0] neg_lo:[0,1,0] neg_hi:[0,1,0]
v_pk_fma_f32 v[134:135], v[130:131], s[34:35], v[134:135] op_sel:[0,1,0] neg_lo:[0,1,0] neg_hi:[0,1,0]
v_pk_add_f32 v[128:129], v[104:105], v[136:137] neg_lo:[0,1] neg_hi:[0,1]
v_pk_add_f32 v[130:131], v[106:107], v[138:139] neg_lo:[0,1] neg_hi:[0,1]
v_pk_add_f32 v[104:105], v[104:105], v[136:137]
v_pk_add_f32 v[106:107], v[106:107], v[138:139]
v_pk_mul_f32 v[136:137], v[128:129], s[32:33] op_sel:[0,1] neg_lo:[0,1] neg_hi:[0,1]
v_pk_mul_f32 v[138:139], v[128:129], s[32:33] op_sel:[0,1]
v_pk_fma_f32 v[136:137], v[130:131], s[32:33], v[136:137] op_sel:[0,1,0] neg_lo:[0,1,0] neg_hi:[0,1,0]
v_pk_fma_f32 v[138:139], v[130:131], s[32:33], v[138:139] op_sel:[0,1,0] neg_lo:[0,1,0] neg_hi:[0,1,0]
v_pk_add_f32 v[128:129], v[108:109], v[140:141] neg_lo:[0,1] neg_hi:[0,1]
v_pk_add_f32 v[130:131], v[110:111], v[142:143] neg_lo:[0,1] neg_hi:[0,1]
v_pk_add_f32 v[108:109], v[108:109], v[140:141]
v_pk_add_f32 v[110:111], v[110:111], v[142:143]
v_pk_mul_f32 v[140:141], v[128:129], s[30:31] op_sel:[0,1] neg_lo:[0,1] neg_hi:[0,1]
v_pk_mul_f32 v[142:143], v[128:129], s[34:35] op_sel:[0,1]
v_pk_fma_f32 v[140:141], v[130:131], s[34:35], v[140:141] op_sel:[0,1,0] neg_lo:[0,1,0] neg_hi:[0,1,0]
v_pk_fma_f32 v[142:143], v[130:131], s[30:31], v[142:143] op_sel:[0,1,0] neg_lo:[0,1,0] neg_hi:[0,1,0]
v_pk_add_f32 v[128:129], v[16:17], v[32:33] neg_lo:[0,1] neg_hi:[0,1]
v_pk_add_f32 v[130:131], v[18:19], v[34:35] neg_lo:[0,1] neg_hi:[0,1]
v_pk_add_f32 v[16:17], v[16:17], v[32:33]
v_pk_add_f32 v[18:19], v[18:19], v[34:35]
v_pk_add_f32 v[32:33], v[20:21], v[36:37] neg_lo:[0,1] neg_hi:[0,1]
v_pk_add_f32 v[34:35], v[22:23], v[38:39] neg_lo:[0,1] neg_hi:[0,1]
v_pk_add_f32 v[20:21], v[20:21], v[36:37]
v_pk_add_f32 v[22:23], v[22:23], v[38:39]
v_pk_mul_f32 v[36:37], v[32:33], s[32:33] op_sel:[0,1]
v_pk_mul_f32 v[38:39], v[32:33], s[32:33] op_sel:[0,1]
v_pk_fma_f32 v[36:37], v[34:35], s[32:33], v[36:37] op_sel:[0,1,0] neg_lo:[0,1,0] neg_hi:[0,1,0]
v_pk_fma_f32 v[38:39], v[34:35], s[32:33], v[38:39] op_sel:[0,1,0]
v_pk_add_f32 v[32:33], v[42:43], v[26:27] neg_lo:[0,1] neg_hi:[0,1]
v_pk_add_f32 v[34:35], v[24:25], v[40:41] neg_lo:[0,1] neg_hi:[0,1]
v_pk_add_f32 v[24:25], v[24:25], v[40:41]
v_pk_add_f32 v[26:27], v[26:27], v[42:43]
v_pk_add_f32 v[40:41], v[28:29], v[44:45] neg_lo:[0,1] neg_hi:[0,1]
v_pk_add_f32 v[42:43], v[30:31], v[46:47] neg_lo:[0,1] neg_hi:[0,1]
v_pk_add_f32 v[28:29], v[28:29], v[44:45]
v_pk_add_f32 v[30:31], v[30:31], v[46:47]
v_pk_mul_f32 v[44:45], v[40:41], s[32:33] op_sel:[0,1] neg_lo:[0,1] neg_hi:[0,1]
v_pk_mul_f32 v[46:47], v[40:41], s[32:33] op_sel:[0,1]
v_pk_fma_f32 v[44:45], v[42:43], s[32:33], v[44:45] op_sel:[0,1,0] neg_lo:[0,1,0] neg_hi:[0,1,0]
v_pk_fma_f32 v[46:47], v[42:43], s[32:33], v[46:47] op_sel:[0,1,0] neg_lo:[0,1,0] neg_hi:[0,1,0]
v_pk_add_f32 v[40:41], v[112:113], v[48:49] neg_lo:[0,1] neg_hi:[0,1]
v_pk_add_f32 v[42:43], v[114:115], v[50:51] neg_lo:[0,1] neg_hi:[0,1]
v_pk_add_f32 v[112:113], v[112:113], v[48:49]
v_pk_add_f32 v[114:115], v[114:115], v[50:51]
v_pk_add_f32 v[48:49], v[52:53], v[68:69] neg_lo:[0,1] neg_hi:[0,1]
v_pk_add_f32 v[50:51], v[54:55], v[70:71] neg_lo:[0,1] neg_hi:[0,1]
v_pk_add_f32 v[52:53], v[52:53], v[68:69]
v_pk_add_f32 v[54:55], v[54:55], v[70:71]
v_pk_mul_f32 v[68:69], v[48:49], s[32:33] op_sel:[0,1]
v_pk_mul_f32 v[70:71], v[48:49], s[32:33] op_sel:[0,1]
v_pk_fma_f32 v[68:69], v[50:51], s[32:33], v[68:69] op_sel:[0,1,0] neg_lo:[0,1,0] neg_hi:[0,1,0]
v_pk_fma_f32 v[70:71], v[50:51], s[32:33], v[70:71] op_sel:[0,1,0]
v_pk_add_f32 v[48:49], v[74:75], v[58:59] neg_lo:[0,1] neg_hi:[0,1]
v_pk_add_f32 v[50:51], v[56:57], v[72:73] neg_lo:[0,1] neg_hi:[0,1]
v_pk_add_f32 v[56:57], v[56:57], v[72:73]
v_pk_add_f32 v[58:59], v[58:59], v[74:75]
v_pk_add_f32 v[72:73], v[60:61], v[76:77] neg_lo:[0,1] neg_hi:[0,1]
v_pk_add_f32 v[74:75], v[62:63], v[78:79] neg_lo:[0,1] neg_hi:[0,1]
v_pk_add_f32 v[60:61], v[60:61], v[76:77]
v_pk_add_f32 v[62:63], v[62:63], v[78:79]
v_pk_mul_f32 v[76:77], v[72:73], s[32:33] op_sel:[0,1] neg_lo:[0,1] neg_hi:[0,1]
v_pk_mul_f32 v[78:79], v[72:73], s[32:33] op_sel:[0,1]
v_pk_fma_f32 v[76:77], v[74:75], s[32:33], v[76:77] op_sel:[0,1,0] neg_lo:[0,1,0] neg_hi:[0,1,0]
v_pk_fma_f32 v[78:79], v[74:75], s[32:33], v[78:79] op_sel:[0,1,0] neg_lo:[0,1,0] neg_hi:[0,1,0]
v_pk_add_f32 v[72:73], v[144:145], v[96:97] neg_lo:[0,1] neg_hi:[0,1]
v_pk_add_f32 v[74:75], v[146:147], v[98:99] neg_lo:[0,1] neg_hi:[0,1]
v_pk_add_f32 v[144:145], v[144:145], v[96:97]
v_pk_add_f32 v[146:147], v[146:147], v[98:99]
v_pk_add_f32 v[96:97], v[84:85], v[100:101] neg_lo:[0,1] neg_hi:[0,1]
v_pk_add_f32 v[98:99], v[86:87], v[102:103] neg_lo:[0,1] neg_hi:[0,1]
v_pk_add_f32 v[84:85], v[84:85], v[100:101]
v_pk_add_f32 v[86:87], v[86:87], v[102:103]
v_pk_mul_f32 v[100:101], v[96:97], s[32:33] op_sel:[0,1]
v_pk_mul_f32 v[102:103], v[96:97], s[32:33] op_sel:[0,1]
v_pk_fma_f32 v[100:101], v[98:99], s[32:33], v[100:101] op_sel:[0,1,0] neg_lo:[0,1,0] neg_hi:[0,1,0]
v_pk_fma_f32 v[102:103], v[98:99], s[32:33], v[102:103] op_sel:[0,1,0]
v_pk_add_f32 v[96:97], v[106:107], v[90:91] neg_lo:[0,1] neg_hi:[0,1]
v_pk_add_f32 v[98:99], v[88:89], v[104:105] neg_lo:[0,1] neg_hi:[0,1]
v_pk_add_f32 v[88:89], v[88:89], v[104:105]
v_pk_add_f32 v[90:91], v[90:91], v[106:107]
v_pk_add_f32 v[104:105], v[92:93], v[108:109] neg_lo:[0,1] neg_hi:[0,1]
v_pk_add_f32 v[106:107], v[94:95], v[110:111] neg_lo:[0,1] neg_hi:[0,1]
v_pk_add_f32 v[92:93], v[92:93], v[108:109]
v_pk_add_f32 v[94:95], v[94:95], v[110:111]
v_pk_mul_f32 v[108:109], v[104:105], s[32:33] op_sel:[0,1] neg_lo:[0,1] neg_hi:[0,1]
v_pk_mul_f32 v[110:111], v[104:105], s[32:33] op_sel:[0,1]
v_pk_fma_f32 v[108:109], v[106:107], s[32:33], v[108:109] op_sel:[0,1,0] neg_lo:[0,1,0] neg_hi:[0,1,0]
v_pk_fma_f32 v[110:111], v[106:107], s[32:33], v[110:111] op_sel:[0,1,0] neg_lo:[0,1,0] neg_hi:[0,1,0]
v_pk_add_f32 v[104:105], v[64:65], v[80:81] neg_lo:[0,1] neg_hi:[0,1]
v_pk_add_f32 v[106:107], v[66:67], v[82:83] neg_lo:[0,1] neg_hi:[0,1]
v_pk_add_f32 v[64:65], v[64:65], v[80:81]
v_pk_add_f32 v[66:67], v[66:67], v[82:83]
v_pk_add_f32 v[80:81], v[116:117], v[132:133] neg_lo:[0,1] neg_hi:[0,1]
v_pk_add_f32 v[82:83], v[118:119], v[134:135] neg_lo:[0,1] neg_hi:[0,1]
v_pk_add_f32 v[116:117], v[116:117], v[132:133]
v_pk_add_f32 v[118:119], v[118:119], v[134:135]
v_pk_mul_f32 v[132:133], v[80:81], s[32:33] op_sel:[0,1]
v_pk_mul_f32 v[134:135], v[80:81], s[32:33] op_sel:[0,1]
v_pk_fma_f32 v[132:133], v[82:83], s[32:33], v[132:133] op_sel:[0,1,0] neg_lo:[0,1,0] neg_hi:[0,1,0]
v_pk_fma_f32 v[134:135], v[82:83], s[32:33], v[134:135] op_sel:[0,1,0]
v_pk_add_f32 v[80:81], v[138:139], v[122:123] neg_lo:[0,1] neg_hi:[0,1]
v_pk_add_f32 v[82:83], v[120:121], v[136:137] neg_lo:[0,1] neg_hi:[0,1]
v_pk_add_f32 v[120:121], v[120:121], v[136:137]
v_pk_add_f32 v[122:123], v[122:123], v[138:139]
v_pk_add_f32 v[136:137], v[124:125], v[140:141] neg_lo:[0,1] neg_hi:[0,1]
v_pk_add_f32 v[138:139], v[126:127], v[142:143] neg_lo:[0,1] neg_hi:[0,1]
v_pk_add_f32 v[124:125], v[124:125], v[140:141]
v_pk_add_f32 v[126:127], v[126:127], v[142:143]
v_pk_mul_f32 v[140:141], v[136:137], s[32:33] op_sel:[0,1] neg_lo:[0,1] neg_hi:[0,1]
v_pk_mul_f32 v[142:143], v[136:137], s[32:33] op_sel:[0,1]
v_pk_fma_f32 v[140:141], v[138:139], s[32:33], v[140:141] op_sel:[0,1,0] neg_lo:[0,1,0] neg_hi:[0,1,0]
v_pk_fma_f32 v[142:143], v[138:139], s[32:33], v[142:143] op_sel:[0,1,0] neg_lo:[0,1,0] neg_hi:[0,1,0]
v_pk_add_f32 v[136:137], v[16:17], v[24:25] neg_lo:[0,1] neg_hi:[0,1]
v_pk_add_f32 v[138:139], v[18:19], v[26:27] neg_lo:[0,1] neg_hi:[0,1]
v_pk_add_f32 v[16:17], v[16:17], v[24:25]
v_pk_add_f32 v[18:19], v[18:19], v[26:27]
v_pk_add_f32 v[24:25], v[30:31], v[22:23] neg_lo:[0,1] neg_hi:[0,1]
v_pk_add_f32 v[26:27], v[20:21], v[28:29] neg_lo:[0,1] neg_hi:[0,1]
v_pk_add_f32 v[20:21], v[20:21], v[28:29]
v_pk_add_f32 v[22:23], v[22:23], v[30:31]
v_pk_add_f32 v[28:29], v[128:129], v[32:33] neg_lo:[0,1] neg_hi:[0,1]
v_pk_add_f32 v[30:31], v[130:131], v[34:35] neg_lo:[0,1] neg_hi:[0,1]
v_pk_add_f32 v[128:129], v[128:129], v[32:33]
v_pk_add_f32 v[130:131], v[130:131], v[34:35]
v_pk_add_f32 v[32:33], v[46:47], v[38:39] neg_lo:[0,1] neg_hi:[0,1]
v_pk_add_f32 v[34:35], v[36:37], v[44:45] neg_lo:[0,1] neg_hi:[0,1]
v_pk_add_f32 v[36:37], v[36:37], v[44:45]
v_pk_add_f32 v[38:39], v[38:39], v[46:47]
v_pk_add_f32 v[44:45], v[112:113], v[56:57] neg_lo:[0,1] neg_hi:[0,1]
v_pk_add_f32 v[46:47], v[114:115], v[58:59] neg_lo:[0,1] neg_hi:[0,1]
v_pk_add_f32 v[112:113], v[112:113], v[56:57]
v_pk_add_f32 v[114:115], v[114:115], v[58:59]
v_pk_add_f32 v[56:57], v[62:63], v[54:55] neg_lo:[0,1] neg_hi:[0,1]
v_pk_add_f32 v[58:59], v[52:53], v[60:61] neg_lo:[0,1] neg_hi:[0,1]
v_pk_add_f32 v[52:53], v[52:53], v[60:61]
v_pk_add_f32 v[54:55], v[54:55], v[62:63]
v_pk_add_f32 v[60:61], v[40:41], v[48:49] neg_lo:[0,1] neg_hi:[0,1]
v_pk_add_f32 v[62:63], v[42:43], v[50:51] neg_lo:[0,1] neg_hi:[0,1]
v_pk_add_f32 v[40:41], v[40:41], v[48:49]
v_pk_add_f32 v[42:43], v[42:43], v[50:51]
v_pk_add_f32 v[48:49], v[78:79], v[70:71] neg_lo:[0,1] neg_hi:[0,1]
v_pk_add_f32 v[50:51], v[68:69], v[76:77] neg_lo:[0,1] neg_hi:[0,1]
v_pk_add_f32 v[68:69], v[68:69], v[76:77]
v_pk_add_f32 v[70:71], v[70:71], v[78:79]
v_pk_add_f32 v[76:77], v[144:145], v[88:89] neg_lo:[0,1] neg_hi:[0,1]
v_pk_add_f32 v[78:79], v[146:147], v[90:91] neg_lo:[0,1] neg_hi:[0,1]
v_pk_add_f32 v[144:145], v[144:145], v[88:89]
v_pk_add_f32 v[146:147], v[146:147], v[90:91]
v_pk_add_f32 v[88:89], v[94:95], v[86:87] neg_lo:[0,1] neg_hi:[0,1]
v_pk_add_f32 v[90:91], v[84:85], v[92:93] neg_lo:[0,1] neg_hi:[0,1]
v_pk_add_f32 v[84:85], v[84:85], v[92:93]
v_pk_add_f32 v[86:87], v[86:87], v[94:95]
v_pk_add_f32 v[92:93], v[72:73], v[96:97] neg_lo:[0,1] neg_hi:[0,1]
v_pk_add_f32 v[94:95], v[74:75], v[98:99] neg_lo:[0,1] neg_hi:[0,1]
v_pk_add_f32 v[72:73], v[72:73], v[96:97]
v_pk_add_f32 v[74:75], v[74:75], v[98:99]
v_pk_add_f32 v[96:97], v[110:111], v[102:103] neg_lo:[0,1] neg_hi:[0,1]
v_pk_add_f32 v[98:99], v[100:101], v[108:109] neg_lo:[0,1] neg_hi:[0,1]
v_pk_add_f32 v[100:101], v[100:101], v[108:109]
v_pk_add_f32 v[102:103], v[102:103], v[110:111]
v_pk_add_f32 v[108:109], v[64:65], v[120:121] neg_lo:[0,1] neg_hi:[0,1]
v_pk_add_f32 v[110:111], v[66:67], v[122:123] neg_lo:[0,1] neg_hi:[0,1]
v_pk_add_f32 v[64:65], v[64:65], v[120:121]
v_pk_add_f32 v[66:67], v[66:67], v[122:123]
v_pk_add_f32 v[120:121], v[126:127], v[118:119] neg_lo:[0,1] neg_hi:[0,1]
v_pk_add_f32 v[122:123], v[116:117], v[124:125] neg_lo:[0,1] neg_hi:[0,1]
v_pk_add_f32 v[116:117], v[116:117], v[124:125]
v_pk_add_f32 v[118:119], v[118:119], v[126:127]
v_pk_add_f32 v[124:125], v[104:105], v[80:81] neg_lo:[0,1] neg_hi:[0,1]
v_pk_add_f32 v[126:127], v[106:107], v[82:83] neg_lo:[0,1] neg_hi:[0,1]
v_pk_add_f32 v[104:105], v[104:105], v[80:81]
v_pk_add_f32 v[106:107], v[106:107], v[82:83]
v_pk_add_f32 v[80:81], v[142:143], v[134:135] neg_lo:[0,1] neg_hi:[0,1]
v_pk_add_f32 v[82:83], v[132:133], v[140:141] neg_lo:[0,1] neg_hi:[0,1]
v_pk_add_f32 v[132:133], v[132:133], v[140:141]
v_pk_add_f32 v[134:135], v[134:135], v[142:143]
v_pk_add_f32 v[140:141], v[16:17], v[20:21] neg_lo:[0,1] neg_hi:[0,1]
v_pk_add_f32 v[142:143], v[18:19], v[22:23] neg_lo:[0,1] neg_hi:[0,1]
v_pk_add_f32 v[16:17], v[16:17], v[20:21]
v_pk_add_f32 v[18:19], v[18:19], v[22:23]
v_pk_add_f32 v[20:21], v[136:137], v[24:25] neg_lo:[0,1] neg_hi:[0,1]
v_pk_add_f32 v[22:23], v[138:139], v[26:27] neg_lo:[0,1] neg_hi:[0,1]
v_pk_add_f32 v[136:137], v[136:137], v[24:25]
v_pk_add_f32 v[138:139], v[138:139], v[26:27]
v_pk_add_f32 v[24:25], v[128:129], v[36:37] neg_lo:[0,1] neg_hi:[0,1]
v_pk_add_f32 v[26:27], v[130:131], v[38:39] neg_lo:[0,1] neg_hi:[0,1]
v_pk_add_f32 v[128:129], v[128:129], v[36:37]
v_pk_add_f32 v[130:131], v[130:131], v[38:39]
v_pk_add_f32 v[36:37], v[28:29], v[32:33] neg_lo:[0,1] neg_hi:[0,1]
v_pk_add_f32 v[38:39], v[30:31], v[34:35] neg_lo:[0,1] neg_hi:[0,1]
v_pk_add_f32 v[28:29], v[28:29], v[32:33]
v_pk_add_f32 v[30:31], v[30:31], v[34:35]
v_pk_add_f32 v[32:33], v[112:113], v[52:53] neg_lo:[0,1] neg_hi:[0,1]
v_pk_add_f32 v[34:35], v[114:115], v[54:55] neg_lo:[0,1] neg_hi:[0,1]
v_pk_add_f32 v[112:113], v[112:113], v[52:53]
v_pk_add_f32 v[114:115], v[114:115], v[54:55]
v_pk_add_f32 v[52:53], v[44:45], v[56:57] neg_lo:[0,1] neg_hi:[0,1]
v_pk_add_f32 v[54:55], v[46:47], v[58:59] neg_lo:[0,1] neg_hi:[0,1]
v_pk_add_f32 v[44:45], v[44:45], v[56:57]
v_pk_add_f32 v[46:47], v[46:47], v[58:59]
v_pk_add_f32 v[56:57], v[40:41], v[68:69] neg_lo:[0,1] neg_hi:[0,1]
v_pk_add_f32 v[58:59], v[42:43], v[70:71] neg_lo:[0,1] neg_hi:[0,1]
v_pk_add_f32 v[40:41], v[40:41], v[68:69]
v_pk_add_f32 v[42:43], v[42:43], v[70:71]
v_pk_add_f32 v[68:69], v[60:61], v[48:49] neg_lo:[0,1] neg_hi:[0,1]
v_pk_add_f32 v[70:71], v[62:63], v[50:51] neg_lo:[0,1] neg_hi:[0,1]
v_pk_add_f32 v[60:61], v[60:61], v[48:49]
v_pk_add_f32 v[62:63], v[62:63], v[50:51]
v_pk_add_f32 v[48:49], v[144:145], v[84:85] neg_lo:[0,1] neg_hi:[0,1]
v_pk_add_f32 v[50:51], v[146:147], v[86:87] neg_lo:[0,1] neg_hi:[0,1]
v_pk_add_f32 v[144:145], v[144:145], v[84:85]
v_pk_add_f32 v[146:147], v[146:147], v[86:87]
v_pk_add_f32 v[84:85], v[76:77], v[88:89] neg_lo:[0,1] neg_hi:[0,1]
v_pk_add_f32 v[86:87], v[78:79], v[90:91] neg_lo:[0,1] neg_hi:[0,1]
v_pk_add_f32 v[76:77], v[76:77], v[88:89]
v_pk_add_f32 v[78:79], v[78:79], v[90:91]
v_pk_add_f32 v[88:89], v[72:73], v[100:101] neg_lo:[0,1] neg_hi:[0,1]
v_pk_add_f32 v[90:91], v[74:75], v[102:103] neg_lo:[0,1] neg_hi:[0,1]
v_pk_add_f32 v[72:73], v[72:73], v[100:101]
v_pk_add_f32 v[74:75], v[74:75], v[102:103]
v_pk_add_f32 v[100:101], v[92:93], v[96:97] neg_lo:[0,1] neg_hi:[0,1]
v_pk_add_f32 v[102:103], v[94:95], v[98:99] neg_lo:[0,1] neg_hi:[0,1]
v_pk_add_f32 v[92:93], v[92:93], v[96:97]
v_pk_add_f32 v[94:95], v[94:95], v[98:99]
v_pk_add_f32 v[96:97], v[64:65], v[116:117] neg_lo:[0,1] neg_hi:[0,1]
v_pk_add_f32 v[98:99], v[66:67], v[118:119] neg_lo:[0,1] neg_hi:[0,1]
v_pk_add_f32 v[64:65], v[64:65], v[116:117]
v_pk_add_f32 v[66:67], v[66:67], v[118:119]
v_pk_add_f32 v[116:117], v[108:109], v[120:121] neg_lo:[0,1] neg_hi:[0,1]
v_pk_add_f32 v[118:119], v[110:111], v[122:123] neg_lo:[0,1] neg_hi:[0,1]
v_pk_add_f32 v[108:109], v[108:109], v[120:121]
v_pk_add_f32 v[110:111], v[110:111], v[122:123]
v_pk_add_f32 v[120:121], v[104:105], v[132:133] neg_lo:[0,1] neg_hi:[0,1]
v_pk_add_f32 v[122:123], v[106:107], v[134:135] neg_lo:[0,1] neg_hi:[0,1]
v_pk_add_f32 v[104:105], v[104:105], v[132:133]
v_pk_add_f32 v[106:107], v[106:107], v[134:135]
v_pk_add_f32 v[132:133], v[124:125], v[80:81] neg_lo:[0,1] neg_hi:[0,1]
v_pk_add_f32 v[134:135], v[126:127], v[82:83] neg_lo:[0,1] neg_hi:[0,1]
v_pk_add_f32 v[124:125], v[124:125], v[80:81]
v_pk_add_f32 v[126:127], v[126:127], v[82:83]
v_mul_f32 v151, 0x3a800000, v3
v_cos_f32 v150, v151
v_sin_f32 v151, v151
v_mul_f32 v149, 0x3b000000, v3
v_cos_f32 v148, v149
v_sin_f32 v149, v149
v_pk_mul_f32 v[80:81], v[144:145], v[150:151] op_sel_hi:[1,0]
v_pk_fma_f32 v[80:81], v[146:147], v[150:151], v[80:81] op_sel:[0,1,0] neg_lo:[1,0,0] neg_hi:[1,0,0]
v_pk_mul_f32 v[146:147], v[146:147], v[150:151] op_sel_hi:[1,0]
v_pk_fma_f32 v[146:147], v[144:145], v[150:151], v[146:147] op_sel:[0,1,0]
v_mul_f32 v151, 0x3b400000, v3
v_cos_f32 v150, v151
v_sin_f32 v151, v151
v_pk_mul_f32 v[144:145], v[112:113], v[148:149] op_sel_hi:[1,0]
v_pk_fma_f32 v[144:145], v[114:115], v[148:149], v[144:145] op_sel:[0,1,0] neg_lo:[1,0,0] neg_hi:[1,0,0]
v_pk_mul_f32 v[114:115], v[114:115], v[148:149] op_sel_hi:[1,0]
v_pk_fma_f32 v[114:115], v[112:113], v[148:149], v[114:115] op_sel:[0,1,0]
v_mul_f32 v149, 0x3b800000, v3
v_cos_f32 v148, v149
v_sin_f32 v149, v149
v_pk_mul_f32 v[112:113], v[64:65], v[150:151] op_sel_hi:[1,0]
v_pk_fma_f32 v[112:113], v[66:67], v[150:151], v[112:113] op_sel:[0,1,0] neg_lo:[1,0,0] neg_hi:[1,0,0]
v_pk_mul_f32 v[66:67], v[66:67], v[150:151] op_sel_hi:[1,0]
v_pk_fma_f32 v[66:67], v[64:65], v[150:151], v[66:67] op_sel:[0,1,0]
v_mul_f32 v151, 0x3ba00000, v3
v_cos_f32 v150, v151
v_sin_f32 v151, v151
v_pk_mul_f32 v[64:65], v[128:129], v[148:149] op_sel_hi:[1,0]
v_pk_fma_f32 v[64:65], v[130:131], v[148:149], v[64:65] op_sel:[0,1,0] neg_lo:[1,0,0] neg_hi:[1,0,0]
v_pk_mul_f32 v[130:131], v[130:131], v[148:149] op_sel_hi:[1,0]
v_pk_fma_f32 v[130:131], v[128:129], v[148:149], v[130:131] op_sel:[0,1,0]
v_mul_f32 v149, 0x3bc00000, v3
v_cos_f32 v148, v149
v_sin_f32 v149, v149
v_pk_mul_f32 v[128:129], v[72:73], v[150:151] op_sel_hi:[1,0]
v_pk_fma_f32 v[128:129], v[74:75], v[150:151], v[128:129] op_sel:[0,1,0] neg_lo:[1,0,0] neg_hi:[1,0,0]
v_pk_mul_f32 v[74:75], v[74:75], v[150:151] op_sel_hi:[1,0]
v_pk_fma_f32 v[74:75], v[72:73], v[150:151], v[74:75] op_sel:[0,1,0]
v_mul_f32 v151, 0x3be00000, v3
v_cos_f32 v150, v151
v_sin_f32 v151, v151
v_pk_mul_f32 v[72:73], v[40:41], v[148:149] op_sel_hi:[1,0]
v_pk_fma_f32 v[72:73], v[42:43], v[148:149], v[72:73] op_sel:[0,1,0] neg_lo:[1,0,0] neg_hi:[1,0,0]
v_pk_mul_f32 v[42:43], v[42:43], v[148:149] op_sel_hi:[1,0]
v_pk_fma_f32 v[42:43], v[40:41], v[148:149], v[42:43] op_sel:[0,1,0]
v_mul_f32 v149, 0x3c000000, v3
v_cos_f32 v148, v149
v_sin_f32 v149, v149
v_pk_mul_f32 v[40:41], v[104:105], v[150:151] op_sel_hi:[1,0]
v_pk_fma_f32 v[40:41], v[106:107], v[150:151], v[40:41] op_sel:[0,1,0] neg_lo:[1,0,0] neg_hi:[1,0,0]
v_pk_mul_f32 v[106:107], v[106:107], v[150:151] op_sel_hi:[1,0]
v_pk_fma_f32 v[106:107], v[104:105], v[150:151], v[106:107] op_sel:[0,1,0]
v_mul_f32 v151, 0x3c100000, v3
v_cos_f32 v150, v151
v_sin_f32 v151, v151
v_pk_mul_f32 v[104:105], v[136:137], v[148:149] op_sel_hi:[1,0]
v_pk_fma_f32 v[104:105], v[138:139], v[148:149], v[104:105] op_sel:[0,1,0] neg_lo:[1,0,0] neg_hi:[1,0,0]
v_pk_mul_f32 v[138:139], v[138:139], v[148:149] op_sel_hi:[1,0]
v_pk_fma_f32 v[138:139], v[136:137], v[148:149], v[138:139] op_sel:[0,1,0]
v_mul_f32 v149, 0x3c200000, v3
v_cos_f32 v148, v149
v_sin_f32 v149, v149
v_pk_mul_f32 v[136:137], v[76:77], v[150:151] op_sel_hi:[1,0]
v_pk_fma_f32 v[136:137], v[78:79], v[150:151], v[136:137] op_sel:[0,1,0] neg_lo:[1,0,0] neg_hi:[1,0,0]
v_pk_mul_f32 v[78:79], v[78:79], v[150:151] op_sel_hi:[1,0]
v_pk_fma_f32 v[78:79], v[76:77], v[150:151], v[78:79] op_sel:[0,1,0]
v_mul_f32 v151, 0x3c300000, v3
v_cos_f32 v150, v151
v_sin_f32 v151, v151
v_pk_mul_f32 v[76:77], v[44:45], v[148:149] op_sel_hi:[1,0]
v_pk_fma_f32 v[76:77], v[46:47], v[148:149], v[76:77] op_sel:[0,1,0] neg_lo:[1,0,0] neg_hi:[1,0,0]
v_pk_mul_f32 v[46:47], v[46:47], v[148:149] op_sel_hi:[1,0]
v_pk_fma_f32 v[46:47], v[44:45], v[148:149], v[46:47] op_sel:[0,1,0]
v_mul_f32 v149, 0x3c400000, v3
v_cos_f32 v148, v149
v_sin_f32 v149, v149
v_pk_mul_f32 v[44:45], v[108:109], v[150:151] op_sel_hi:[1,0]
v_pk_fma_f32 v[44:45], v[110:111], v[150:151], v[44:45] op_sel:[0,1,0] neg_lo:[1,0,0] neg_hi:[1,0,0]
v_pk_mul_f32 v[110:111], v[110:111], v[150:151] op_sel_hi:[1,0]
v_pk_fma_f32 v[110:111], v[108:109], v[150:151], v[110:111] op_sel:[0,1,0]
v_mul_f32 v151, 0x3c500000, v3
v_cos_f32 v150, v151
v_sin_f32 v151, v151
v_pk_mul_f32 v[108:109], v[28:29], v[148:149] op_sel_hi:[1,0]
v_pk_fma_f32 v[108:109], v[30:31], v[148:149], v[108:109] op_sel:[0,1,0] neg_lo:[1,0,0] neg_hi:[1,0,0]
v_pk_mul_f32 v[30:31], v[30:31], v[148:149] op_sel_hi:[1,0]
v_pk_fma_f32 v[30:31], v[28:29], v[148:149], v[30:31] op_sel:[0,1,0]
v_mul_f32 v149, 0x3c600000, v3
v_cos_f32 v148, v149
v_sin_f32 v149, v149
v_pk_mul_f32 v[28:29], v[92:93], v[150:151] op_sel_hi:[1,0]
v_pk_fma_f32 v[28:29], v[94:95], v[150:151], v[28:29] op_sel:[0,1,0] neg_lo:[1,0,0] neg_hi:[1,0,0]
v_pk_mul_f32 v[94:95], v[94:95], v[150:151] op_sel_hi:[1,0]
v_pk_fma_f32 v[94:95], v[92:93], v[150:151], v[94:95] op_sel:[0,1,0]
v_mul_f32 v151, 0x3c700000, v3
v_cos_f32 v150, v151
v_sin_f32 v151, v151
v_pk_mul_f32 v[92:93], v[60:61], v[148:149] op_sel_hi:[1,0]
v_pk_fma_f32 v[92:93], v[62:63], v[148:149], v[92:93] op_sel:[0,1,0] neg_lo:[1,0,0] neg_hi:[1,0,0]
v_pk_mul_f32 v[62:63], v[62:63], v[148:149] op_sel_hi:[1,0]
v_pk_fma_f32 v[62:63], v[60:61], v[148:149], v[62:63] op_sel:[0,1,0]
v_mul_f32 v149, 0x3c800000, v3
v_cos_f32 v148, v149
v_sin_f32 v149, v149
v_pk_mul_f32 v[60:61], v[124:125], v[150:151] op_sel_hi:[1,0]
v_pk_fma_f32 v[60:61], v[126:127], v[150:151], v[60:61] op_sel:[0,1,0] neg_lo:[1,0,0] neg_hi:[1,0,0]
v_pk_mul_f32 v[126:127], v[126:127], v[150:151] op_sel_hi:[1,0]
v_pk_fma_f32 v[126:127], v[124:125], v[150:151], v[126:127] op_sel:[0,1,0]
v_mul_f32 v151, 0x3c880000, v3
v_cos_f32 v150, v151
v_sin_f32 v151, v151
v_pk_mul_f32 v[124:125], v[140:141], v[148:149] op_sel_hi:[1,0]
v_pk_fma_f32 v[124:125], v[142:143], v[148:149], v[124:125] op_sel:[0,1,0] neg_lo:[1,0,0] neg_hi:[1,0,0]
v_pk_mul_f32 v[142:143], v[142:143], v[148:149] op_sel_hi:[1,0]
v_pk_fma_f32 v[142:143], v[140:141], v[148:149], v[142:143] op_sel:[0,1,0]
v_mul_f32 v149, 0x3c900000, v3
v_cos_f32 v148, v149
v_sin_f32 v149, v149
v_pk_mul_f32 v[140:141], v[48:49], v[150:151] op_sel_hi:[1,0]
v_pk_fma_f32 v[140:141], v[50:51], v[150:151], v[140:141] op_sel:[0,1,0] neg_lo:[1,0,0] neg_hi:[1,0,0]
v_pk_mul_f32 v[50:51], v[50:51], v[150:151] op_sel_hi:[1,0]
v_pk_fma_f32 v[50:51], v[48:49], v[150:151], v[50:51] op_sel:[0,1,0]
v_mul_f32 v151, 0x3c980000, v3
v_cos_f32 v150, v151
v_sin_f32 v151, v151
v_pk_mul_f32 v[48:49], v[32:33], v[148:149] op_sel_hi:[1,0]
v_pk_fma_f32 v[48:49], v[34:35], v[148:149], v[48:49] op_sel:[0,1,0] neg_lo:[1,0,0] neg_hi:[1,0,0]
v_pk_mul_f32 v[34:35], v[34:35], v[148:149] op_sel_hi:[1,0]
v_pk_fma_f32 v[34:35], v[32:33], v[148:149], v[34:35] op_sel:[0,1,0]
v_mul_f32 v149, 0x3ca00000, v3
v_cos_f32 v148, v149
v_sin_f32 v149, v149
v_pk_mul_f32 v[32:33], v[96:97], v[150:151] op_sel_hi:[1,0]
v_pk_fma_f32 v[32:33], v[98:99], v[150:151], v[32:33] op_sel:[0,1,0] neg_lo:[1,0,0] neg_hi:[1,0,0]
v_pk_mul_f32 v[98:99], v[98:99], v[150:151] op_sel_hi:[1,0]
v_pk_fma_f32 v[98:99], v[96:97], v[150:151], v[98:99] op_sel:[0,1,0]
v_mul_f32 v151, 0x3ca80000, v3
v_cos_f32 v150, v151
v_sin_f32 v151, v151
v_pk_mul_f32 v[96:97], v[24:25], v[148:149] op_sel_hi:[1,0]
v_pk_fma_f32 v[96:97], v[26:27], v[148:149], v[96:97] op_sel:[0,1,0] neg_lo:[1,0,0] neg_hi:[1,0,0]
v_pk_mul_f32 v[26:27], v[26:27], v[148:149] op_sel_hi:[1,0]
v_pk_fma_f32 v[26:27], v[24:25], v[148:149], v[26:27] op_sel:[0,1,0]
v_mul_f32 v149, 0x3cb00000, v3
v_cos_f32 v148, v149
v_sin_f32 v149, v149
v_pk_mul_f32 v[24:25], v[88:89], v[150:151] op_sel_hi:[1,0]
v_pk_fma_f32 v[24:25], v[90:91], v[150:151], v[24:25] op_sel:[0,1,0] neg_lo:[1,0,0] neg_hi:[1,0,0]
v_pk_mul_f32 v[90:91], v[90:91], v[150:151] op_sel_hi:[1,0]
v_pk_fma_f32 v[90:91], v[88:89], v[150:151], v[90:91] op_sel:[0,1,0]
v_mul_f32 v151, 0x3cb80000, v3
v_cos_f32 v150, v151
v_sin_f32 v151, v151
v_pk_mul_f32 v[88:89], v[56:57], v[148:149] op_sel_hi:[1,0]
v_pk_fma_f32 v[88:89], v[58:59], v[148:149], v[88:89] op_sel:[0,1,0] neg_lo:[1,0,0] neg_hi:[1,0,0]
v_pk_mul_f32 v[58:59], v[58:59], v[148:149] op_sel_hi:[1,0]
v_pk_fma_f32 v[58:59], v[56:57], v[148:149], v[58:59] op_sel:[0,1,0]
v_mul_f32 v149, 0x3cc00000, v3
v_cos_f32 v148, v149
v_sin_f32 v149, v149
v_pk_mul_f32 v[56:57], v[120:121], v[150:151] op_sel_hi:[1,0]
v_pk_fma_f32 v[56:57], v[122:123], v[150:151], v[56:57] op_sel:[0,1,0] neg_lo:[1,0,0] neg_hi:[1,0,0]
v_pk_mul_f32 v[122:123], v[122:123], v[150:151] op_sel_hi:[1,0]
v_pk_fma_f32 v[122:123], v[120:121], v[150:151], v[122:123] op_sel:[0,1,0]
v_mul_f32 v151, 0x3cc80000, v3
v_cos_f32 v150, v151
v_sin_f32 v151, v151
v_pk_mul_f32 v[120:121], v[20:21], v[148:149] op_sel_hi:[1,0]
v_pk_fma_f32 v[120:121], v[22:23], v[148:149], v[120:121] op_sel:[0,1,0] neg_lo:[1,0,0] neg_hi:[1,0,0]
v_pk_mul_f32 v[22:23], v[22:23], v[148:149] op_sel_hi:[1,0]
v_pk_fma_f32 v[22:23], v[20:21], v[148:149], v[22:23] op_sel:[0,1,0]
v_mul_f32 v149, 0x3cd00000, v3
v_cos_f32 v148, v149
v_sin_f32 v149, v149
v_pk_mul_f32 v[20:21], v[84:85], v[150:151] op_sel_hi:[1,0]
v_pk_fma_f32 v[20:21], v[86:87], v[150:151], v[20:21] op_sel:[0,1,0] neg_lo:[1,0,0] neg_hi:[1,0,0]
v_pk_mul_f32 v[86:87], v[86:87], v[150:151] op_sel_hi:[1,0]
v_pk_fma_f32 v[86:87], v[84:85], v[150:151], v[86:87] op_sel:[0,1,0]
v_mul_f32 v151, 0x3cd80000, v3
v_cos_f32 v150, v151
v_sin_f32 v151, v151
v_pk_mul_f32 v[84:85], v[52:53], v[148:149] op_sel_hi:[1,0]
v_pk_fma_f32 v[84:85], v[54:55], v[148:149], v[84:85] op_sel:[0,1,0] neg_lo:[1,0,0] neg_hi:[1,0,0]
v_pk_mul_f32 v[54:55], v[54:55], v[148:149] op_sel_hi:[1,0]
v_pk_fma_f32 v[54:55], v[52:53], v[148:149], v[54:55] op_sel:[0,1,0]
v_mul_f32 v149, 0x3ce00000, v3
v_cos_f32 v148, v149
v_sin_f32 v149, v149
v_pk_mul_f32 v[52:53], v[116:117], v[150:151] op_sel_hi:[1,0]
v_pk_fma_f32 v[52:53], v[118:119], v[150:151], v[52:53] op_sel:[0,1,0] neg_lo:[1,0,0] neg_hi:[1,0,0]
v_pk_mul_f32 v[118:119], v[118:119], v[150:151] op_sel_hi:[1,0]
v_pk_fma_f32 v[118:119], v[116:117], v[150:151], v[118:119] op_sel:[0,1,0]
v_mul_f32 v151, 0x3ce80000, v3
v_cos_f32 v150, v151
v_sin_f32 v151, v151
v_pk_mul_f32 v[116:117], v[36:37], v[148:149] op_sel_hi:[1,0]
v_pk_fma_f32 v[116:117], v[38:39], v[148:149], v[116:117] op_sel:[0,1,0] neg_lo:[1,0,0] neg_hi:[1,0,0]
v_pk_mul_f32 v[38:39], v[38:39], v[148:149] op_sel_hi:[1,0]
v_pk_fma_f32 v[38:39], v[36:37], v[148:149], v[38:39] op_sel:[0,1,0]
v_mul_f32 v149, 0x3cf00000, v3
v_cos_f32 v148, v149
v_sin_f32 v149, v149
v_pk_mul_f32 v[36:37], v[100:101], v[150:151] op_sel_hi:[1,0]
v_pk_fma_f32 v[36:37], v[102:103], v[150:151], v[36:37] op_sel:[0,1,0] neg_lo:[1,0,0] neg_hi:[1,0,0]
v_pk_mul_f32 v[102:103], v[102:103], v[150:151] op_sel_hi:[1,0]
v_pk_fma_f32 v[102:103], v[100:101], v[150:151], v[102:103] op_sel:[0,1,0]
v_mul_f32 v151, 0x3cf80000, v3
v_cos_f32 v150, v151
v_sin_f32 v151, v151
v_pk_mul_f32 v[100:101], v[68:69], v[148:149] op_sel_hi:[1,0]
v_pk_fma_f32 v[100:101], v[70:71], v[148:149], v[100:101] op_sel:[0,1,0] neg_lo:[1,0,0] neg_hi:[1,0,0]
v_pk_mul_f32 v[70:71], v[70:71], v[148:149] op_sel_hi:[1,0]
v_pk_fma_f32 v[70:71], v[68:69], v[148:149], v[70:71] op_sel:[0,1,0]
s_nop 0
v_pk_mul_f32 v[68:69], v[132:133], v[150:151] op_sel_hi:[1,0]
v_pk_fma_f32 v[68:69], v[134:135], v[150:151], v[68:69] op_sel:[0,1,0] neg_lo:[1,0,0] neg_hi:[1,0,0]
v_pk_mul_f32 v[134:135], v[134:135], v[150:151] op_sel_hi:[1,0]
v_pk_fma_f32 v[134:135], v[132:133], v[150:151], v[134:135] op_sel:[0,1,0]
ds_write_b64 v4, v[16:17]
ds_write_b64 v4, v[18:19] offset:8
ds_write_b64 v4, v[80:81] offset:528
ds_write_b64 v4, v[146:147] offset:536
ds_write_b64 v4, v[144:145] offset:1056
ds_write_b64 v4, v[114:115] offset:1064
ds_write_b64 v4, v[112:113] offset:1584
ds_write_b64 v4, v[66:67] offset:1592
ds_write_b64 v4, v[64:65] offset:2112
ds_write_b64 v4, v[130:131] offset:2120
ds_write_b64 v4, v[128:129] offset:2640
ds_write_b64 v4, v[74:75] offset:2648
ds_write_b64 v4, v[72:73] offset:3168
ds_write_b64 v4, v[42:43] offset:3176
ds_write_b64 v4, v[40:41] offset:3696
ds_write_b64 v4, v[106:107] offset:3704
ds_write_b64 v4, v[104:105] offset:4224
ds_write_b64 v4, v[138:139] offset:4232
ds_write_b64 v4, v[136:137] offset:4752
ds_write_b64 v4, v[78:79] offset:4760
ds_write_b64 v4, v[76:77] offset:5280
ds_write_b64 v4, v[46:47] offset:5288
ds_write_b64 v4, v[44:45] offset:5808
ds_write_b64 v4, v[110:111] offset:5816
ds_write_b64 v4, v[108:109] offset:6336
ds_write_b64 v4, v[30:31] offset:6344
ds_write_b64 v4, v[28:29] offset:6864
ds_write_b64 v4, v[94:95] offset:6872
ds_write_b64 v4, v[92:93] offset:7392
ds_write_b64 v4, v[62:63] offset:7400
ds_write_b64 v4, v[60:61] offset:7920
ds_write_b64 v4, v[126:127] offset:7928
ds_write_b64 v4, v[124:125] offset:8448
ds_write_b64 v4, v[142:143] offset:8456
ds_write_b64 v4, v[140:141] offset:8976
ds_write_b64 v4, v[50:51] offset:8984
ds_write_b64 v4, v[48:49] offset:9504
ds_write_b64 v4, v[34:35] offset:9512
ds_write_b64 v4, v[32:33] offset:10032
ds_write_b64 v4, v[98:99] offset:10040
ds_write_b64 v4, v[96:97] offset:10560
ds_write_b64 v4, v[26:27] offset:10568
ds_write_b64 v4, v[24:25] offset:11088
ds_write_b64 v4, v[90:91] offset:11096
ds_write_b64 v4, v[88:89] offset:11616
ds_write_b64 v4, v[58:59] offset:11624
ds_write_b64 v4, v[56:57] offset:12144
ds_write_b64 v4, v[122:123] offset:12152
ds_write_b64 v4, v[120:121] offset:12672
ds_write_b64 v4, v[22:23] offset:12680
ds_write_b64 v4, v[20:21] offset:13200
ds_write_b64 v4, v[86:87] offset:13208
ds_write_b64 v4, v[84:85] offset:13728
ds_write_b64 v4, v[54:55] offset:13736
ds_write_b64 v4, v[52:53] offset:14256
ds_write_b64 v4, v[118:119] offset:14264
ds_write_b64 v4, v[116:117] offset:14784
ds_write_b64 v4, v[38:39] offset:14792
ds_write_b64 v4, v[36:37] offset:15312
ds_write_b64 v4, v[102:103] offset:15320
ds_write_b64 v4, v[100:101] offset:15840
ds_write_b64 v4, v[70:71] offset:15848
ds_write_b64 v4, v[68:69] offset:16368
ds_write_b64 v4, v[134:135] offset:16376
s_waitcnt lgkmcnt(0)
ds_read_b128 v[16:19], v5
ds_read_b128 v[20:23], v5 offset:16
ds_read_b128 v[24:27], v5 offset:32
ds_read_b128 v[28:31], v5 offset:48
ds_read_b128 v[32:35], v5 offset:64
ds_read_b128 v[36:39], v5 offset:80
ds_read_b128 v[40:43], v5 offset:96
ds_read_b128 v[44:47], v5 offset:112
ds_read_b128 v[48:51], v5 offset:128
ds_read_b128 v[52:55], v5 offset:144
ds_read_b128 v[56:59], v5 offset:160
ds_read_b128 v[60:63], v5 offset:176
s_waitcnt lgkmcnt(4)
ds_read_b128 v[64:67], v5 offset:192
ds_read_b128 v[68:71], v5 offset:208
ds_read_b128 v[72:75], v5 offset:224
ds_read_b128 v[76:79], v5 offset:240
ds_read_b128 v[80:83], v5 offset:256
ds_read_b128 v[84:87], v5 offset:272
ds_read_b128 v[88:91], v5 offset:288
ds_read_b128 v[92:95], v5 offset:304
ds_read_b128 v[96:99], v5 offset:320
ds_read_b128 v[100:103], v5 offset:336
ds_read_b128 v[104:107], v5 offset:352
ds_read_b128 v[108:111], v5 offset:368
s_waitcnt lgkmcnt(4)
ds_read_b128 v[112:115], v5 offset:384
ds_read_b128 v[116:119], v5 offset:400
ds_read_b128 v[120:123], v5 offset:416
ds_read_b128 v[124:127], v5 offset:432
ds_read_b128 v[128:131], v5 offset:448
ds_read_b128 v[132:135], v5 offset:464
ds_read_b128 v[136:139], v5 offset:480
ds_read_b128 v[140:143], v5 offset:496
s_waitcnt lgkmcnt(0)
v_pk_add_f32 v[144:145], v[16:17], v[80:81] neg_lo:[0,1] neg_hi:[0,1]
v_pk_add_f32 v[146:147], v[18:19], v[82:83] neg_lo:[0,1] neg_hi:[0,1]
v_pk_add_f32 v[16:17], v[16:17], v[80:81]
v_pk_add_f32 v[18:19], v[18:19], v[82:83]
v_pk_add_f32 v[80:81], v[20:21], v[84:85] neg_lo:[0,1] neg_hi:[0,1]
v_pk_add_f32 v[82:83], v[22:23], v[86:87] neg_lo:[0,1] neg_hi:[0,1]
v_pk_add_f32 v[20:21], v[20:21], v[84:85]
v_pk_add_f32 v[22:23], v[22:23], v[86:87]
v_pk_mul_f32 v[84:85], v[80:81], s[30:31] op_sel_hi:[1,0]
v_pk_mul_f32 v[86:87], v[80:81], s[36:37] op_sel_hi:[1,0]
v_pk_fma_f32 v[84:85], v[82:83], s[36:37], v[84:85] op_sel_hi:[1,0,1] neg_lo:[0,1,0] neg_hi:[0,1,0]
v_pk_fma_f32 v[86:87], v[82:83], s[30:31], v[86:87] op_sel_hi:[1,0,1]
v_pk_add_f32 v[80:81], v[24:25], v[88:89] neg_lo:[0,1] neg_hi:[0,1]
v_pk_add_f32 v[82:83], v[26:27], v[90:91] neg_lo:[0,1] neg_hi:[0,1]
v_pk_add_f32 v[24:25], v[24:25], v[88:89]
v_pk_add_f32 v[26:27], v[26:27], v[90:91]
v_pk_mul_f32 v[88:89], v[80:81], s[30:31] op_sel:[0,1]
v_pk_mul_f32 v[90:91], v[80:81], s[34:35] op_sel:[0,1]
v_pk_fma_f32 v[88:89], v[82:83], s[34:35], v[88:89] op_sel:[0,1,0] neg_lo:[0,1,0] neg_hi:[0,1,0]
v_pk_fma_f32 v[90:91], v[82:83], s[30:31], v[90:91] op_sel:[0,1,0]
v_pk_add_f32 v[80:81], v[28:29], v[92:93] neg_lo:[0,1] neg_hi:[0,1]
v_pk_add_f32 v[82:83], v[30:31], v[94:95] neg_lo:[0,1] neg_hi:[0,1]
v_pk_add_f32 v[28:29], v[28:29], v[92:93]
v_pk_add_f32 v[30:31], v[30:31], v[94:95]
v_pk_mul_f32 v[92:93], v[80:81], s[32:33] op_sel_hi:[1,0]
v_pk_mul_f32 v[94:95], v[80:81], s[34:35] op_sel_hi:[1,0]
v_pk_fma_f32 v[92:93], v[82:83], s[34:35], v[92:93] op_sel_hi:[1,0,1] neg_lo:[0,1,0] neg_hi:[0,1,0]
v_pk_fma_f32 v[94:95], v[82:83], s[32:33], v[94:95] op_sel_hi:[1,0,1]
v_pk_add_f32 v[80:81], v[32:33], v[96:97] neg_lo:[0,1] neg_hi:[0,1]
v_pk_add_f32 v[82:83], v[34:35], v[98:99] neg_lo:[0,1] neg_hi:[0,1]
v_pk_add_f32 v[32:33], v[32:33], v[96:97]
v_pk_add_f32 v[34:35], v[34:35], v[98:99]
v_pk_mul_f32 v[96:97], v[80:81], s[32:33] op_sel:[0,1]
v_pk_mul_f32 v[98:99], v[80:81], s[32:33] op_sel:[0,1]
v_pk_fma_f32 v[96:97], v[82:83], s[32:33], v[96:97] op_sel:[0,1,0] neg_lo:[0,1,0] neg_hi:[0,1,0]
v_pk_fma_f32 v[98:99], v[82:83], s[32:33], v[98:99] op_sel:[0,1,0]
v_pk_add_f32 v[80:81], v[36:37], v[100:101] neg_lo:[0,1] neg_hi:[0,1]
v_pk_add_f32 v[82:83], v[38:39], v[102:103] neg_lo:[0,1] neg_hi:[0,1]
v_pk_add_f32 v[36:37], v[36:37], v[100:101]
v_pk_add_f32 v[38:39], v[38:39], v[102:103]
v_pk_mul_f32 v[100:101], v[80:81], s[34:35] op_sel_hi:[1,0]
v_pk_mul_f32 v[102:103], v[80:81], s[32:33] op_sel_hi:[1,0]
v_pk_fma_f32 v[100:101], v[82:83], s[32:33], v[100:101] op_sel_hi:[1,0,1] neg_lo:[0,1,0] neg_hi:[0,1,0]
v_pk_fma_f32 v[102:103], v[82:83], s[34:35], v[102:103] op_sel_hi:[1,0,1]
v_pk_add_f32 v[80:81], v[40:41], v[104:105] neg_lo:[0,1] neg_hi:[0,1]
v_pk_add_f32 v[82:83], v[42:43], v[106:107] neg_lo:[0,1] neg_hi:[0,1]
v_pk_add_f32 v[40:41], v[40:41], v[104:105]
v_pk_add_f32 v[42:43], v[42:43], v[106:107]
v_pk_mul_f32 v[104:105], v[80:81], s[34:35] op_sel:[0,1]
v_pk_mul_f32 v[106:107], v[80:81], s[30:31] op_sel:[0,1]
v_pk_fma_f32 v[104:105], v[82:83], s[30:31], v[104:105] op_sel:[0,1,0] neg_lo:[0,1,0] neg_hi:[0,1,0]
v_pk_fma_f32 v[106:107], v[82:83], s[34:35], v[106:107] op_sel:[0,1,0]
v_pk_add_f32 v[80:81], v[44:45], v[108:109] neg_lo:[0,1] neg_hi:[0,1]
v_pk_add_f32 v[82:83], v[46:47], v[110:111] neg_lo:[0,1] neg_hi:[0,1]
v_pk_add_f32 v[44:45], v[44:45], v[108:109]
v_pk_add_f32 v[46:47], v[46:47], v[110:111]
v_pk_mul_f32 v[108:109], v[80:81], s[36:37] op_sel_hi:[1,0]
v_pk_mul_f32 v[110:111], v[80:81], s[30:31] op_sel_hi:[1,0]
v_pk_fma_f32 v[108:109], v[82:83], s[30:31], v[108:109] op_sel_hi:[1,0,1] neg_lo:[0,1,0] neg_hi:[0,1,0]
v_pk_fma_f32 v[110:111], v[82:83], s[36:37], v[110:111] op_sel_hi:[1,0,1]
v_pk_add_f32 v[80:81], v[114:115], v[50:51] neg_lo:[0,1] neg_hi:[0,1]
v_pk_add_f32 v[82:83], v[48:49], v[112:113] neg_lo:[0,1] neg_hi:[0,1]
v_pk_add_f32 v[48:49], v[48:49], v[112:113]
v_pk_add_f32 v[50:51], v[50:51], v[114:115]
v_pk_add_f32 v[112:113], v[52:53], v[116:117] neg_lo:[0,1] neg_hi:[0,1]
v_pk_add_f32 v[114:115], v[54:55], v[118:119] neg_lo:[0,1] neg_hi:[0,1]
v_pk_add_f32 v[52:53], v[52:53], v[116:117]
v_pk_add_f32 v[54:55], v[54:55], v[118:119]
v_pk_mul_f32 v[116:117], v[112:113], s[36:37] op_sel_hi:[1,0] neg_lo:[0,1] neg_hi:[0,1]
v_pk_mul_f32 v[118:119], v[112:113], s[30:31] op_sel_hi:[1,0]
v_pk_fma_f32 v[116:117], v[114:115], s[30:31], v[116:117] op_sel_hi:[1,0,1] neg_lo:[0,1,0] neg_hi:[0,1,0]
v_pk_fma_f32 v[118:119], v[114:115], s[36:37], v[118:119] op_sel_hi:[1,0,1] neg_lo:[0,1,0] neg_hi:[0,1,0]
v_pk_add_f32 v[112:113], v[56:57], v[120:121] neg_lo:[0,1] neg_hi:[0,1]
v_pk_add_f32 v[114:115], v[58:59], v[122:123] neg_lo:[0,1] neg_hi:[0,1]
v_pk_add_f32 v[56:57], v[56:57], v[120:121]
v_pk_add_f32 v[58:59], v[58:59], v[122:123]
v_pk_mul_f32 v[120:121], v[112:113], s[34:35] op_sel:[0,1] neg_lo:[0,1] neg_hi:[0,1]
v_pk_mul_f32 v[122:123], v[112:113], s[30:31] op_sel:[0,1]
v_pk_fma_f32 v[120:121], v[114:115], s[30:31], v[120:121] op_sel:[0,1,0] neg_lo:[0,1,0] neg_hi:[0,1,0]
v_pk_fma_f32 v[122:123], v[114:115], s[34:35], v[122:123] op_sel:[0,1,0] neg_lo:[0,1,0] neg_hi:[0,1,0]
v_pk_add_f32 v[112:113], v[60:61], v[124:125] neg_lo:[0,1] neg_hi:[0,1]
v_pk_add_f32 v[114:115], v[62:63], v[126:127] neg_lo:[0,1] neg_hi:[0,1]
v_pk_add_f32 v[60:61], v[60:61], v[124:125]
v_pk_add_f32 v[62:63], v[62:63], v[126:127]
v_pk_mul_f32 v[124:125], v[112:113], s[34:35] op_sel_hi:[1,0] neg_lo:[0,1] neg_hi:[0,1]
v_pk_mul_f32 v[126:127], v[112:113], s[32:33] op_sel_hi:[1,0]
v_pk_fma_f32 v[124:125], v[114:115], s[32:33], v[124:125] op_sel_hi:[1,0,1] neg_lo:[0,1,0] neg_hi:[0,1,0]
v_pk_fma_f32 v[126:127], v[114:115], s[34:35], v[126:127] op_sel_hi:[1,0,1] neg_lo:[0,1,0] neg_hi:[0,1,0]
v_pk_add_f32 v[112:113], v[64:65], v[128:129] neg_lo:[0,1] neg_hi:[0,1]
v_pk_add_f32 v[114:115], v[66:67], v[130:131] neg_lo:[0,1] neg_hi:[0,1]
v_pk_add_f32 v[64:65], v[64:65], v[128:129]
v_pk_add_f32 v[66:67], v[66:67], v[130:131]
v_pk_mul_f32 v[128:129], v[112:113], s[32:33] op_sel:[0,1] neg_lo:[0,1] neg_hi:[0,1]
v_pk_mul_f32 v[130:131], v[112:113], s[32:33] op_sel:[0,1]
v_pk_fma_f32 v[128:129], v[114:115], s[32:33], v[128:129] op_sel:[0,1,0] neg_lo:[0,1,0] neg_hi:[0,1,0]
v_pk_fma_f32 v[130:131], v[114:115], s[32:33], v[130:131] op_sel:[0,1,0] neg_lo:[0,1,0] neg_hi:[0,1,0]
v_pk_add_f32 v[112:113], v[68:69], v[132:133] neg_lo:[0,1] neg_hi:[0,1]
v_pk_add_f32 v[114:115], v[70:71], v[134:135] neg_lo:[0,1] neg_hi:[0,1]
v_pk_add_f32 v[68:69], v[68:69], v[132:133]
v_pk_add_f32 v[70:71], v[70:71], v[134:135]
v_pk_mul_f32 v[132:133], v[112:113], s[32:33] op_sel_hi:[1,0] neg_lo:[0,1] neg_hi:[0,1]
v_pk_mul_f32 v[134:135], v[112:113], s[34:35] op_sel_hi:[1,0]
v_pk_fma_f32 v[132:133], v[114:115], s[34:35], v[132:133] op_sel_hi:[1,0,1] neg_lo:[0,1,0] neg_hi:[0,1,0]
v_pk_fma_f32 v[134:135], v[114:115], s[32:33], v[134:135] op_sel_hi:[1,0,1] neg_lo:[0,1,0] neg_hi:[0,1,0]
v_pk_add_f32 v[112:113], v[72:73], v[136:137] neg_lo:[0,1] neg_hi:[0,1]
v_pk_add_f32 v[114:115], v[74:75], v[138:139] neg_lo:[0,1] neg_hi:[0,1]
v_pk_add_f32 v[72:73], v[72:73], v[136:137]
v_pk_add_f32 v[74:75], v[74:75], v[138:139]
v_pk_mul_f32 v[136:137], v[112:113], s[30:31] op_sel:[0,1] neg_lo:[0,1] neg_hi:[0,1]
v_pk_mul_f32 v[138:139], v[112:113], s[34:35] op_sel:[0,1]
v_pk_fma_f32 v[136:137], v[114:115], s[34:35], v[136:137] op_sel:[0,1,0] neg_lo:[0,1,0] neg_hi:[0,1,0]
v_pk_fma_f32 v[138:139], v[114:115], s[30:31], v[138:139] op_sel:[0,1,0] neg_lo:[0,1,0] neg_hi:[0,1,0]
v_pk_add_f32 v[112:113], v[76:77], v[140:141] neg_lo:[0,1] neg_hi:[0,1]
v_pk_add_f32 v[114:115], v[78:79], v[142:143] neg_lo:[0,1] neg_hi:[0,1]
v_pk_add_f32 v[76:77], v[76:77], v[140:141]
v_pk_add_f32 v[78:79], v[78:79], v[142:143]
v_pk_mul_f32 v[140:141], v[112:113], s[30:31] op_sel_hi:[1,0] neg_lo:[0,1] neg_hi:[0,1]
v_pk_mul_f32 v[142:143], v[112:113], s[36:37] op_sel_hi:[1,0]
v_pk_fma_f32 v[140:141], v[114:115], s[36:37], v[140:141] op_sel_hi:[1,0,1] neg_lo:[0,1,0] neg_hi:[0,1,0]
v_pk_fma_f32 v[142:143], v[114:115], s[30:31], v[142:143] op_sel_hi:[1,0,1] neg_lo:[0,1,0] neg_hi:[0,1,0]
v_pk_add_f32 v[112:113], v[16:17], v[48:49] neg_lo:[0,1] neg_hi:[0,1]
v_pk_add_f32 v[114:115], v[18:19], v[50:51] neg_lo:[0,1] neg_hi:[0,1]
v_pk_add_f32 v[16:17], v[16:17], v[48:49]
v_pk_add_f32 v[18:19], v[18:19], v[50:51]
v_pk_add_f32 v[48:49], v[20:21], v[52:53] neg_lo:[0,1] neg_hi:[0,1]
v_pk_add_f32 v[50:51], v[22:23], v[54:55] neg_lo:[0,1] neg_hi:[0,1]
v_pk_add_f32 v[20:21], v[20:21], v[52:53]
v_pk_add_f32 v[22:23], v[22:23], v[54:55]
v_pk_mul_f32 v[52:53], v[48:49], s[30:31] op_sel:[0,1]
v_pk_mul_f32 v[54:55], v[48:49], s[34:35] op_sel:[0,1]
v_pk_fma_f32 v[52:53], v[50:51], s[34:35], v[52:53] op_sel:[0,1,0] neg_lo:[0,1,0] neg_hi:[0,1,0]
v_pk_fma_f32 v[54:55], v[50:51], s[30:31], v[54:55] op_sel:[0,1,0]
v_pk_add_f32 v[48:49], v[24:25], v[56:57] neg_lo:[0,1] neg_hi:[0,1]
v_pk_add_f32 v[50:51], v[26:27], v[58:59] neg_lo:[0,1] neg_hi:[0,1]
v_pk_add_f32 v[24:25], v[24:25], v[56:57]
v_pk_add_f32 v[26:27], v[26:27], v[58:59]
v_pk_mul_f32 v[56:57], v[48:49], s[32:33] op_sel:[0,1]
v_pk_mul_f32 v[58:59], v[48:49], s[32:33] op_sel:[0,1]
v_pk_fma_f32 v[56:57], v[50:51], s[32:33], v[56:57] op_sel:[0,1,0] neg_lo:[0,1,0] neg_hi:[0,1,0]
v_pk_fma_f32 v[58:59], v[50:51], s[32:33], v[58:59] op_sel:[0,1,0]
v_pk_add_f32 v[48:49], v[28:29], v[60:61] neg_lo:[0,1] neg_hi:[0,1]
v_pk_add_f32 v[50:51], v[30:31], v[62:63] neg_lo:[0,1] neg_hi:[0,1]
v_pk_add_f32 v[28:29], v[28:29], v[60:61]
v_pk_add_f32 v[30:31], v[30:31], v[62:63]
v_pk_mul_f32 v[60:61], v[48:49], s[34:35] op_sel:[0,1]
v_pk_mul_f32 v[62:63], v[48:49], s[30:31] op_sel:[0,1]
v_pk_fma_f32 v[60:61], v[50:51], s[30:31], v[60:61] op_sel:[0,1,0] neg_lo:[0,1,0] neg_hi:[0,1,0]
v_pk_fma_f32 v[62:63], v[50:51], s[34:35], v[62:63] op_sel:[0,1,0]
v_pk_add_f32 v[48:49], v[66:67], v[34:35] neg_lo:[0,1] neg_hi:[0,1]
v_pk_add_f32 v[50:51], v[32:33], v[64:65] neg_lo:[0,1] neg_hi:[0,1]
v_pk_add_f32 v[32:33], v[32:33], v[64:65]
v_pk_add_f32 v[34:35], v[34:35], v[66:67]
v_pk_add_f32 v[64:65], v[36:37], v[68:69] neg_lo:[0,1] neg_hi:[0,1]
v_pk_add_f32 v[66:67], v[38:39], v[70:71] neg_lo:[0,1] neg_hi:[0,1]
v_pk_add_f32 v[36:37], v[36:37], v[68:69]
v_pk_add_f32 v[38:39], v[38:39], v[70:71]
v_pk_mul_f32 v[68:69], v[64:65], s[34:35] op_sel:[0,1] neg_lo:[0,1] neg_hi:[0,1]
v_pk_mul_f32 v[70:71], v[64:65], s[30:31] op_sel:[0,1]
v_pk_fma_f32 v[68:69], v[66:67], s[30:31], v[68:69] op_sel:[0,1,0] neg_lo:[0,1,0] neg_hi:[0,1,0]
v_pk_fma_f32 v[70:71], v[66:67], s[34:35], v[70:71] op_sel:[0,1,0] neg_lo:[0,1,0] neg_hi:[0,1,0]
v_pk_add_f32 v[64:65], v[40:41], v[72:73] neg_lo:[0,1] neg_hi:[0,1]
v_pk_add_f32 v[66:67], v[42:43], v[74:75] neg_lo:[0,1] neg_hi:[0,1]
v_pk_add_f32 v[40:41], v[40:41], v[72:73]
v_pk_add_f32 v[42:43], v[42:43], v[74:75]
v_pk_mul_f32 v[72:73], v[64:65], s[32:33] op_sel:[0,1] neg_lo:[0,1] neg_hi:[0,1]
v_pk_mul_f32 v[74:75], v[64:65], s[32:33] op_sel:[0,1]
v_pk_fma_f32 v[72:73], v[66:67], s[32:33], v[72:73] op_sel:[0,1,0] neg_lo:[0,1,0] neg_hi:[0,1,0]
v_pk_fma_f32 v[74:75], v[66:67], s[32:33], v[74:75] op_sel:[0,1,0] neg_lo:[0,1,0] neg_hi:[0,1,0]
v_pk_add_f32 v[64:65], v[44:45], v[76:77] neg_lo:[0,1] neg_hi:[0,1]
v_pk_add_f32 v[66:67], v[46:47], v[78:79] neg_lo:[0,1] neg_hi:[0,1]
v_pk_add_f32 v[44:45], v[44:45], v[76:77]
v_pk_add_f32 v[46:47], v[46:47], v[78:79]
v_pk_mul_f32 v[76:77], v[64:65], s[30:31] op_sel:[0,1] neg_lo:[0,1] neg_hi:[0,1]
v_pk_mul_f32 v[78:79], v[64:65], s[34:35] op_sel:[0,1]
v_pk_fma_f32 v[76:77], v[66:67], s[34:35], v[76:77] op_sel:[0,1,0] neg_lo:[0,1,0] neg_hi:[0,1,0]
v_pk_fma_f32 v[78:79], v[66:67], s[30:31], v[78:79] op_sel:[0,1,0] neg_lo:[0,1,0] neg_hi:[0,1,0]
v_pk_add_f32 v[64:65], v[144:145], v[80:81] neg_lo:[0,1] neg_hi:[0,1]
v_pk_add_f32 v[66:67], v[146:147], v[82:83] neg_lo:[0,1] neg_hi:[0,1]
v_pk_add_f32 v[144:145], v[144:145], v[80:81]
v_pk_add_f32 v[146:147], v[146:147], v[82:83]
v_pk_add_f32 v[80:81], v[84:85], v[116:117] neg_lo:[0,1] neg_hi:[0,1]
v_pk_add_f32 v[82:83], v[86:87], v[118:119] neg_lo:[0,1] neg_hi:[0,1]
v_pk_add_f32 v[84:85], v[84:85], v[116:117]
v_pk_add_f32 v[86:87], v[86:87], v[118:119]
v_pk_mul_f32 v[116:117], v[80:81], s[30:31] op_sel:[0,1]
v_pk_mul_f32 v[118:119], v[80:81], s[34:35] op_sel:[0,1]
v_pk_fma_f32 v[116:117], v[82:83], s[34:35], v[116:117] op_sel:[0,1,0] neg_lo:[0,1,0] neg_hi:[0,1,0]
v_pk_fma_f32 v[118:119], v[82:83], s[30:31], v[118:119] op_sel:[0,1,0]
v_pk_add_f32 v[80:81], v[88:89], v[120:121] neg_lo:[0,1] neg_hi:[0,1]
v_pk_add_f32 v[82:83], v[90:91], v[122:123] neg_lo:[0,1] neg_hi:[0,1]
v_pk_add_f32 v[88:89], v[88:89], v[120:121]
v_pk_add_f32 v[90:91], v[90:91], v[122:123]
v_pk_mul_f32 v[120:121], v[80:81], s[32:33] op_sel:[0,1]
v_pk_mul_f32 v[122:123], v[80:81], s[32:33] op_sel:[0,1]
v_pk_fma_f32 v[120:121], v[82:83], s[32:33], v[120:121] op_sel:[0,1,0] neg_lo:[0,1,0] neg_hi:[0,1,0]
v_pk_fma_f32 v[122:123], v[82:83], s[32:33], v[122:123] op_sel:[0,1,0]
v_pk_add_f32 v[80:81], v[92:93], v[124:125] neg_lo:[0,1] neg_hi:[0,1]
v_pk_add_f32 v[82:83], v[94:95], v[126:127] neg_lo:[0,1] neg_hi:[0,1]
v_pk_add_f32 v[92:93], v[92:93], v[124:125]
v_pk_add_f32 v[94:95], v[94:95], v[126:127]
v_pk_mul_f32 v[124:125], v[80:81], s[34:35] op_sel:[0,1]
v_pk_mul_f32 v[126:127], v[80:81], s[30:31] op_sel:[0,1]
v_pk_fma_f32 v[124:125], v[82:83], s[30:31], v[124:125] op_sel:[0,1,0] neg_lo:[0,1,0] neg_hi:[0,1,0]
v_pk_fma_f32 v[126:127], v[82:83], s[34:35], v[126:127] op_sel:[0,1,0]
v_pk_add_f32 v[80:81], v[130:131], v[98:99] neg_lo:[0,1] neg_hi:[0,1]
v_pk_add_f32 v[82:83], v[96:97], v[128:129] neg_lo:[0,1] neg_hi:[0,1]
v_pk_add_f32 v[96:97], v[96:97], v[128:129]
v_pk_add_f32 v[98:99], v[98:99], v[130:131]
v_pk_add_f32 v[128:129], v[100:101], v[132:133] neg_lo:[0,1] neg_hi:[0,1]
v_pk_add_f32 v[130:131], v[102:103], v[134:135] neg_lo:[0,1] neg_hi:[0,1]
v_pk_add_f32 v[100:101], v[100:101], v[132:133]
v_pk_add_f32 v[102:103], v[102:103], v[134:135]
v_pk_mul_f32 v[132:133], v[128:129], s[34:35] op_sel:[0,1] neg_lo:[0,1] neg_hi:[0,1]
v_pk_mul_f32 v[134:135], v[128:129], s[30:31] op_sel:[0,1]
v_pk_fma_f32 v[132:133], v[130:131], s[30:31], v[132:133] op_sel:[0,1,0] neg_lo:[0,1,0] neg_hi:[0,1,0]
v_pk_fma_f32 v[134:135], v[130:131], s[34:35], v[134:135] op_sel:[0,1,0] neg_lo:[0,1,0] neg_hi:[0,1,0]
v_pk_add_f32 v[128:129], v[104:105], v[136:137] neg_lo:[0,1] neg_hi:[0,1]
v_pk_add_f32 v[130:131], v[106:107], v[138:139] neg_lo:[0,1] neg_hi:[0,1]
v_pk_add_f32 v[104:105], v[104:105], v[136:137]
v_pk_add_f32 v[106:107], v[106:107], v[138:139]
v_pk_mul_f32 v[136:137], v[128:129], s[32:33] op_sel:[0,1] neg_lo:[0,1] neg_hi:[0,1]
v_pk_mul_f32 v[138:139], v[128:129], s[32:33] op_sel:[0,1]
v_pk_fma_f32 v[136:137], v[130:131], s[32:33], v[136:137] op_sel:[0,1,0] neg_lo:[0,1,0] neg_hi:[0,1,0]
v_pk_fma_f32 v[138:139], v[130:131], s[32:33], v[138:139] op_sel:[0,1,0] neg_lo:[0,1,0] neg_hi:[0,1,0]
v_pk_add_f32 v[128:129], v[108:109], v[140:141] neg_lo:[0,1] neg_hi:[0,1]
v_pk_add_f32 v[130:131], v[110:111], v[142:143] neg_lo:[0,1] neg_hi:[0,1]
v_pk_add_f32 v[108:109], v[108:109], v[140:141]
v_pk_add_f32 v[110:111], v[110:111], v[142:143]
v_pk_mul_f32 v[140:141], v[128:129], s[30:31] op_sel:[0,1] neg_lo:[0,1] neg_hi:[0,1]
v_pk_mul_f32 v[142:143], v[128:129], s[34:35] op_sel:[0,1]
v_pk_fma_f32 v[140:141], v[130:131], s[34:35], v[140:141] op_sel:[0,1,0] neg_lo:[0,1,0] neg_hi:[0,1,0]
v_pk_fma_f32 v[142:143], v[130:131], s[30:31], v[142:143] op_sel:[0,1,0] neg_lo:[0,1,0] neg_hi:[0,1,0]
v_pk_add_f32 v[128:129], v[16:17], v[32:33] neg_lo:[0,1] neg_hi:[0,1]
v_pk_add_f32 v[130:131], v[18:19], v[34:35] neg_lo:[0,1] neg_hi:[0,1]
v_pk_add_f32 v[16:17], v[16:17], v[32:33]
v_pk_add_f32 v[18:19], v[18:19], v[34:35]
v_pk_add_f32 v[32:33], v[20:21], v[36:37] neg_lo:[0,1] neg_hi:[0,1]
v_pk_add_f32 v[34:35], v[22:23], v[38:39] neg_lo:[0,1] neg_hi:[0,1]
v_pk_add_f32 v[20:21], v[20:21], v[36:37]
v_pk_add_f32 v[22:23], v[22:23], v[38:39]
v_pk_mul_f32 v[36:37], v[32:33], s[32:33] op_sel:[0,1]
v_pk_mul_f32 v[38:39], v[32:33], s[32:33] op_sel:[0,1]
v_pk_fma_f32 v[36:37], v[34:35], s[32:33], v[36:37] op_sel:[0,1,0] neg_lo:[0,1,0] neg_hi:[0,1,0]
v_pk_fma_f32 v[38:39], v[34:35], s[32:33], v[38:39] op_sel:[0,1,0]
v_pk_add_f32 v[32:33], v[42:43], v[26:27] neg_lo:[0,1] neg_hi:[0,1]
v_pk_add_f32 v[34:35], v[24:25], v[40:41] neg_lo:[0,1] neg_hi:[0,1]
v_pk_add_f32 v[24:25], v[24:25], v[40:41]
v_pk_add_f32 v[26:27], v[26:27], v[42:43]
v_pk_add_f32 v[40:41], v[28:29], v[44:45] neg_lo:[0,1] neg_hi:[0,1]
v_pk_add_f32 v[42:43], v[30:31], v[46:47] neg_lo:[0,1] neg_hi:[0,1]
v_pk_add_f32 v[28:29], v[28:29], v[44:45]
v_pk_add_f32 v[30:31], v[30:31], v[46:47]
v_pk_mul_f32 v[44:45], v[40:41], s[32:33] op_sel:[0,1] neg_lo:[0,1] neg_hi:[0,1]
v_pk_mul_f32 v[46:47], v[40:41], s[32:33] op_sel:[0,1]
v_pk_fma_f32 v[44:45], v[42:43], s[32:33], v[44:45] op_sel:[0,1,0] neg_lo:[0,1,0] neg_hi:[0,1,0]
v_pk_fma_f32 v[46:47], v[42:43], s[32:33], v[46:47] op_sel:[0,1,0] neg_lo:[0,1,0] neg_hi:[0,1,0]
v_pk_add_f32 v[40:41], v[112:113], v[48:49] neg_lo:[0,1] neg_hi:[0,1]
v_pk_add_f32 v[42:43], v[114:115], v[50:51] neg_lo:[0,1] neg_hi:[0,1]
v_pk_add_f32 v[112:113], v[112:113], v[48:49]
v_pk_add_f32 v[114:115], v[114:115], v[50:51]
v_pk_add_f32 v[48:49], v[52:53], v[68:69] neg_lo:[0,1] neg_hi:[0,1]
v_pk_add_f32 v[50:51], v[54:55], v[70:71] neg_lo:[0,1] neg_hi:[0,1]
v_pk_add_f32 v[52:53], v[52:53], v[68:69]
v_pk_add_f32 v[54:55], v[54:55], v[70:71]
v_pk_mul_f32 v[68:69], v[48:49], s[32:33] op_sel:[0,1]
v_pk_mul_f32 v[70:71], v[48:49], s[32:33] op_sel:[0,1]
v_pk_fma_f32 v[68:69], v[50:51], s[32:33], v[68:69] op_sel:[0,1,0] neg_lo:[0,1,0] neg_hi:[0,1,0]
v_pk_fma_f32 v[70:71], v[50:51], s[32:33], v[70:71] op_sel:[0,1,0]
v_pk_add_f32 v[48:49], v[74:75], v[58:59] neg_lo:[0,1] neg_hi:[0,1]
v_pk_add_f32 v[50:51], v[56:57], v[72:73] neg_lo:[0,1] neg_hi:[0,1]
v_pk_add_f32 v[56:57], v[56:57], v[72:73]
v_pk_add_f32 v[58:59], v[58:59], v[74:75]
v_pk_add_f32 v[72:73], v[60:61], v[76:77] neg_lo:[0,1] neg_hi:[0,1]
v_pk_add_f32 v[74:75], v[62:63], v[78:79] neg_lo:[0,1] neg_hi:[0,1]
v_pk_add_f32 v[60:61], v[60:61], v[76:77]
v_pk_add_f32 v[62:63], v[62:63], v[78:79]
v_pk_mul_f32 v[76:77], v[72:73], s[32:33] op_sel:[0,1] neg_lo:[0,1] neg_hi:[0,1]
v_pk_mul_f32 v[78:79], v[72:73], s[32:33] op_sel:[0,1]
v_pk_fma_f32 v[76:77], v[74:75], s[32:33], v[76:77] op_sel:[0,1,0] neg_lo:[0,1,0] neg_hi:[0,1,0]
v_pk_fma_f32 v[78:79], v[74:75], s[32:33], v[78:79] op_sel:[0,1,0] neg_lo:[0,1,0] neg_hi:[0,1,0]
v_pk_add_f32 v[72:73], v[144:145], v[96:97] neg_lo:[0,1] neg_hi:[0,1]
v_pk_add_f32 v[74:75], v[146:147], v[98:99] neg_lo:[0,1] neg_hi:[0,1]
v_pk_add_f32 v[144:145], v[144:145], v[96:97]
v_pk_add_f32 v[146:147], v[146:147], v[98:99]
v_pk_add_f32 v[96:97], v[84:85], v[100:101] neg_lo:[0,1] neg_hi:[0,1]
v_pk_add_f32 v[98:99], v[86:87], v[102:103] neg_lo:[0,1] neg_hi:[0,1]
v_pk_add_f32 v[84:85], v[84:85], v[100:101]
v_pk_add_f32 v[86:87], v[86:87], v[102:103]
v_pk_mul_f32 v[100:101], v[96:97], s[32:33] op_sel:[0,1]
v_pk_mul_f32 v[102:103], v[96:97], s[32:33] op_sel:[0,1]
v_pk_fma_f32 v[100:101], v[98:99], s[32:33], v[100:101] op_sel:[0,1,0] neg_lo:[0,1,0] neg_hi:[0,1,0]
v_pk_fma_f32 v[102:103], v[98:99], s[32:33], v[102:103] op_sel:[0,1,0]
v_pk_add_f32 v[96:97], v[106:107], v[90:91] neg_lo:[0,1] neg_hi:[0,1]
v_pk_add_f32 v[98:99], v[88:89], v[104:105] neg_lo:[0,1] neg_hi:[0,1]
v_pk_add_f32 v[88:89], v[88:89], v[104:105]
v_pk_add_f32 v[90:91], v[90:91], v[106:107]
v_pk_add_f32 v[104:105], v[92:93], v[108:109] neg_lo:[0,1] neg_hi:[0,1]
v_pk_add_f32 v[106:107], v[94:95], v[110:111] neg_lo:[0,1] neg_hi:[0,1]
v_pk_add_f32 v[92:93], v[92:93], v[108:109]
v_pk_add_f32 v[94:95], v[94:95], v[110:111]
v_pk_mul_f32 v[108:109], v[104:105], s[32:33] op_sel:[0,1] neg_lo:[0,1] neg_hi:[0,1]
v_pk_mul_f32 v[110:111], v[104:105], s[32:33] op_sel:[0,1]
v_pk_fma_f32 v[108:109], v[106:107], s[32:33], v[108:109] op_sel:[0,1,0] neg_lo:[0,1,0] neg_hi:[0,1,0]
v_pk_fma_f32 v[110:111], v[106:107], s[32:33], v[110:111] op_sel:[0,1,0] neg_lo:[0,1,0] neg_hi:[0,1,0]
v_pk_add_f32 v[104:105], v[64:65], v[80:81] neg_lo:[0,1] neg_hi:[0,1]
v_pk_add_f32 v[106:107], v[66:67], v[82:83] neg_lo:[0,1] neg_hi:[0,1]
v_pk_add_f32 v[64:65], v[64:65], v[80:81]
v_pk_add_f32 v[66:67], v[66:67], v[82:83]
v_pk_add_f32 v[80:81], v[116:117], v[132:133] neg_lo:[0,1] neg_hi:[0,1]
v_pk_add_f32 v[82:83], v[118:119], v[134:135] neg_lo:[0,1] neg_hi:[0,1]
v_pk_add_f32 v[116:117], v[116:117], v[132:133]
v_pk_add_f32 v[118:119], v[118:119], v[134:135]
v_pk_mul_f32 v[132:133], v[80:81], s[32:33] op_sel:[0,1]
v_pk_mul_f32 v[134:135], v[80:81], s[32:33] op_sel:[0,1]
v_pk_fma_f32 v[132:133], v[82:83], s[32:33], v[132:133] op_sel:[0,1,0] neg_lo:[0,1,0] neg_hi:[0,1,0]
v_pk_fma_f32 v[134:135], v[82:83], s[32:33], v[134:135] op_sel:[0,1,0]
v_pk_add_f32 v[80:81], v[138:139], v[122:123] neg_lo:[0,1] neg_hi:[0,1]
v_pk_add_f32 v[82:83], v[120:121], v[136:137] neg_lo:[0,1] neg_hi:[0,1]
v_pk_add_f32 v[120:121], v[120:121], v[136:137]
v_pk_add_f32 v[122:123], v[122:123], v[138:139]
v_pk_add_f32 v[136:137], v[124:125], v[140:141] neg_lo:[0,1] neg_hi:[0,1]
v_pk_add_f32 v[138:139], v[126:127], v[142:143] neg_lo:[0,1] neg_hi:[0,1]
v_pk_add_f32 v[124:125], v[124:125], v[140:141]
v_pk_add_f32 v[126:127], v[126:127], v[142:143]
v_pk_mul_f32 v[140:141], v[136:137], s[32:33] op_sel:[0,1] neg_lo:[0,1] neg_hi:[0,1]
v_pk_mul_f32 v[142:143], v[136:137], s[32:33] op_sel:[0,1]
v_pk_fma_f32 v[140:141], v[138:139], s[32:33], v[140:141] op_sel:[0,1,0] neg_lo:[0,1,0] neg_hi:[0,1,0]
v_pk_fma_f32 v[142:143], v[138:139], s[32:33], v[142:143] op_sel:[0,1,0] neg_lo:[0,1,0] neg_hi:[0,1,0]
v_pk_add_f32 v[136:137], v[16:17], v[24:25] neg_lo:[0,1] neg_hi:[0,1]
v_pk_add_f32 v[138:139], v[18:19], v[26:27] neg_lo:[0,1] neg_hi:[0,1]
v_pk_add_f32 v[16:17], v[16:17], v[24:25]
v_pk_add_f32 v[18:19], v[18:19], v[26:27]
v_pk_add_f32 v[24:25], v[30:31], v[22:23] neg_lo:[0,1] neg_hi:[0,1]
v_pk_add_f32 v[26:27], v[20:21], v[28:29] neg_lo:[0,1] neg_hi:[0,1]
v_pk_add_f32 v[20:21], v[20:21], v[28:29]
v_pk_add_f32 v[22:23], v[22:23], v[30:31]
v_pk_add_f32 v[28:29], v[128:129], v[32:33] neg_lo:[0,1] neg_hi:[0,1]
v_pk_add_f32 v[30:31], v[130:131], v[34:35] neg_lo:[0,1] neg_hi:[0,1]
v_pk_add_f32 v[128:129], v[128:129], v[32:33]
v_pk_add_f32 v[130:131], v[130:131], v[34:35]
v_pk_add_f32 v[32:33], v[46:47], v[38:39] neg_lo:[0,1] neg_hi:[0,1]
v_pk_add_f32 v[34:35], v[36:37], v[44:45] neg_lo:[0,1] neg_hi:[0,1]
v_pk_add_f32 v[36:37], v[36:37], v[44:45]
v_pk_add_f32 v[38:39], v[38:39], v[46:47]
v_pk_add_f32 v[44:45], v[112:113], v[56:57] neg_lo:[0,1] neg_hi:[0,1]
v_pk_add_f32 v[46:47], v[114:115], v[58:59] neg_lo:[0,1] neg_hi:[0,1]
v_pk_add_f32 v[112:113], v[112:113], v[56:57]
v_pk_add_f32 v[114:115], v[114:115], v[58:59]
v_pk_add_f32 v[56:57], v[62:63], v[54:55] neg_lo:[0,1] neg_hi:[0,1]
v_pk_add_f32 v[58:59], v[52:53], v[60:61] neg_lo:[0,1] neg_hi:[0,1]
v_pk_add_f32 v[52:53], v[52:53], v[60:61]
v_pk_add_f32 v[54:55], v[54:55], v[62:63]
v_pk_add_f32 v[60:61], v[40:41], v[48:49] neg_lo:[0,1] neg_hi:[0,1]
v_pk_add_f32 v[62:63], v[42:43], v[50:51] neg_lo:[0,1] neg_hi:[0,1]
v_pk_add_f32 v[40:41], v[40:41], v[48:49]
v_pk_add_f32 v[42:43], v[42:43], v[50:51]
v_pk_add_f32 v[48:49], v[78:79], v[70:71] neg_lo:[0,1] neg_hi:[0,1]
v_pk_add_f32 v[50:51], v[68:69], v[76:77] neg_lo:[0,1] neg_hi:[0,1]
v_pk_add_f32 v[68:69], v[68:69], v[76:77]
v_pk_add_f32 v[70:71], v[70:71], v[78:79]
v_pk_add_f32 v[76:77], v[144:145], v[88:89] neg_lo:[0,1] neg_hi:[0,1]
v_pk_add_f32 v[78:79], v[146:147], v[90:91] neg_lo:[0,1] neg_hi:[0,1]
v_pk_add_f32 v[144:145], v[144:145], v[88:89]
v_pk_add_f32 v[146:147], v[146:147], v[90:91]
v_pk_add_f32 v[88:89], v[94:95], v[86:87] neg_lo:[0,1] neg_hi:[0,1]
v_pk_add_f32 v[90:91], v[84:85], v[92:93] neg_lo:[0,1] neg_hi:[0,1]
v_pk_add_f32 v[84:85], v[84:85], v[92:93]
v_pk_add_f32 v[86:87], v[86:87], v[94:95]
v_pk_add_f32 v[92:93], v[72:73], v[96:97] neg_lo:[0,1] neg_hi:[0,1]
v_pk_add_f32 v[94:95], v[74:75], v[98:99] neg_lo:[0,1] neg_hi:[0,1]
v_pk_add_f32 v[72:73], v[72:73], v[96:97]
v_pk_add_f32 v[74:75], v[74:75], v[98:99]
v_pk_add_f32 v[96:97], v[110:111], v[102:103] neg_lo:[0,1] neg_hi:[0,1]
v_pk_add_f32 v[98:99], v[100:101], v[108:109] neg_lo:[0,1] neg_hi:[0,1]
v_pk_add_f32 v[100:101], v[100:101], v[108:109]
v_pk_add_f32 v[102:103], v[102:103], v[110:111]
v_pk_add_f32 v[108:109], v[64:65], v[120:121] neg_lo:[0,1] neg_hi:[0,1]
v_pk_add_f32 v[110:111], v[66:67], v[122:123] neg_lo:[0,1] neg_hi:[0,1]
v_pk_add_f32 v[64:65], v[64:65], v[120:121]
v_pk_add_f32 v[66:67], v[66:67], v[122:123]
v_pk_add_f32 v[120:121], v[126:127], v[118:119] neg_lo:[0,1] neg_hi:[0,1]
v_pk_add_f32 v[122:123], v[116:117], v[124:125] neg_lo:[0,1] neg_hi:[0,1]
v_pk_add_f32 v[116:117], v[116:117], v[124:125]
v_pk_add_f32 v[118:119], v[118:119], v[126:127]
v_pk_add_f32 v[124:125], v[104:105], v[80:81] neg_lo:[0,1] neg_hi:[0,1]
v_pk_add_f32 v[126:127], v[106:107], v[82:83] neg_lo:[0,1] neg_hi:[0,1]
v_pk_add_f32 v[104:105], v[104:105], v[80:81]
v_pk_add_f32 v[106:107], v[106:107], v[82:83]
v_pk_add_f32 v[80:81], v[142:143], v[134:135] neg_lo:[0,1] neg_hi:[0,1]
v_pk_add_f32 v[82:83], v[132:133], v[140:141] neg_lo:[0,1] neg_hi:[0,1]
v_pk_add_f32 v[132:133], v[132:133], v[140:141]
v_pk_add_f32 v[134:135], v[134:135], v[142:143]
v_pk_add_f32 v[140:141], v[16:17], v[20:21] neg_lo:[0,1] neg_hi:[0,1]
v_pk_add_f32 v[142:143], v[18:19], v[22:23] neg_lo:[0,1] neg_hi:[0,1]
v_pk_add_f32 v[16:17], v[16:17], v[20:21]
v_pk_add_f32 v[18:19], v[18:19], v[22:23]
v_pk_add_f32 v[20:21], v[136:137], v[24:25] neg_lo:[0,1] neg_hi:[0,1]
v_pk_add_f32 v[22:23], v[138:139], v[26:27] neg_lo:[0,1] neg_hi:[0,1]
v_pk_add_f32 v[136:137], v[136:137], v[24:25]
v_pk_add_f32 v[138:139], v[138:139], v[26:27]
v_pk_add_f32 v[24:25], v[128:129], v[36:37] neg_lo:[0,1] neg_hi:[0,1]
v_pk_add_f32 v[26:27], v[130:131], v[38:39] neg_lo:[0,1] neg_hi:[0,1]
v_pk_add_f32 v[128:129], v[128:129], v[36:37]
v_pk_add_f32 v[130:131], v[130:131], v[38:39]
v_pk_add_f32 v[36:37], v[28:29], v[32:33] neg_lo:[0,1] neg_hi:[0,1]
v_pk_add_f32 v[38:39], v[30:31], v[34:35] neg_lo:[0,1] neg_hi:[0,1]
v_pk_add_f32 v[28:29], v[28:29], v[32:33]
v_pk_add_f32 v[30:31], v[30:31], v[34:35]
v_pk_add_f32 v[32:33], v[112:113], v[52:53] neg_lo:[0,1] neg_hi:[0,1]
v_pk_add_f32 v[34:35], v[114:115], v[54:55] neg_lo:[0,1] neg_hi:[0,1]
v_pk_add_f32 v[112:113], v[112:113], v[52:53]
v_pk_add_f32 v[114:115], v[114:115], v[54:55]
v_pk_add_f32 v[52:53], v[44:45], v[56:57] neg_lo:[0,1] neg_hi:[0,1]
v_pk_add_f32 v[54:55], v[46:47], v[58:59] neg_lo:[0,1] neg_hi:[0,1]
v_pk_add_f32 v[44:45], v[44:45], v[56:57]
v_pk_add_f32 v[46:47], v[46:47], v[58:59]
v_pk_add_f32 v[56:57], v[40:41], v[68:69] neg_lo:[0,1] neg_hi:[0,1]
v_pk_add_f32 v[58:59], v[42:43], v[70:71] neg_lo:[0,1] neg_hi:[0,1]
v_pk_add_f32 v[40:41], v[40:41], v[68:69]
v_pk_add_f32 v[42:43], v[42:43], v[70:71]
v_pk_add_f32 v[68:69], v[60:61], v[48:49] neg_lo:[0,1] neg_hi:[0,1]
v_pk_add_f32 v[70:71], v[62:63], v[50:51] neg_lo:[0,1] neg_hi:[0,1]
v_pk_add_f32 v[60:61], v[60:61], v[48:49]
v_pk_add_f32 v[62:63], v[62:63], v[50:51]
v_pk_add_f32 v[48:49], v[144:145], v[84:85] neg_lo:[0,1] neg_hi:[0,1]
v_pk_add_f32 v[50:51], v[146:147], v[86:87] neg_lo:[0,1] neg_hi:[0,1]
v_pk_add_f32 v[144:145], v[144:145], v[84:85]
v_pk_add_f32 v[146:147], v[146:147], v[86:87]
v_pk_add_f32 v[84:85], v[76:77], v[88:89] neg_lo:[0,1] neg_hi:[0,1]
v_pk_add_f32 v[86:87], v[78:79], v[90:91] neg_lo:[0,1] neg_hi:[0,1]
v_pk_add_f32 v[76:77], v[76:77], v[88:89]
v_pk_add_f32 v[78:79], v[78:79], v[90:91]
v_pk_add_f32 v[88:89], v[72:73], v[100:101] neg_lo:[0,1] neg_hi:[0,1]
v_pk_add_f32 v[90:91], v[74:75], v[102:103] neg_lo:[0,1] neg_hi:[0,1]
v_pk_add_f32 v[72:73], v[72:73], v[100:101]
v_pk_add_f32 v[74:75], v[74:75], v[102:103]
v_pk_add_f32 v[100:101], v[92:93], v[96:97] neg_lo:[0,1] neg_hi:[0,1]
v_pk_add_f32 v[102:103], v[94:95], v[98:99] neg_lo:[0,1] neg_hi:[0,1]
v_pk_add_f32 v[92:93], v[92:93], v[96:97]
v_pk_add_f32 v[94:95], v[94:95], v[98:99]
v_pk_add_f32 v[96:97], v[64:65], v[116:117] neg_lo:[0,1] neg_hi:[0,1]
v_pk_add_f32 v[98:99], v[66:67], v[118:119] neg_lo:[0,1] neg_hi:[0,1]
v_pk_add_f32 v[64:65], v[64:65], v[116:117]
v_pk_add_f32 v[66:67], v[66:67], v[118:119]
v_pk_add_f32 v[116:117], v[108:109], v[120:121] neg_lo:[0,1] neg_hi:[0,1]
v_pk_add_f32 v[118:119], v[110:111], v[122:123] neg_lo:[0,1] neg_hi:[0,1]
v_pk_add_f32 v[108:109], v[108:109], v[120:121]
v_pk_add_f32 v[110:111], v[110:111], v[122:123]
v_pk_add_f32 v[120:121], v[104:105], v[132:133] neg_lo:[0,1] neg_hi:[0,1]
v_pk_add_f32 v[122:123], v[106:107], v[134:135] neg_lo:[0,1] neg_hi:[0,1]
v_pk_add_f32 v[104:105], v[104:105], v[132:133]
v_pk_add_f32 v[106:107], v[106:107], v[134:135]
v_pk_add_f32 v[132:133], v[124:125], v[80:81] neg_lo:[0,1] neg_hi:[0,1]
v_pk_add_f32 v[134:135], v[126:127], v[82:83] neg_lo:[0,1] neg_hi:[0,1]
v_pk_add_f32 v[124:125], v[124:125], v[80:81]
v_pk_add_f32 v[126:127], v[126:127], v[82:83]
v_lshl_add_u32 v7, v1, 3, v6
ds_write_b64 v7, v[16:17]
ds_write_b64 v7, v[18:19] offset:8192
ds_write_b64 v7, v[144:145] offset:256
ds_write_b64 v7, v[146:147] offset:8448
ds_write_b64 v7, v[112:113] offset:512
ds_write_b64 v7, v[114:115] offset:8704
ds_write_b64 v7, v[64:65] offset:768
ds_write_b64 v7, v[66:67] offset:8960
ds_write_b64 v7, v[128:129] offset:1024
ds_write_b64 v7, v[130:131] offset:9216
ds_write_b64 v7, v[72:73] offset:1280
ds_write_b64 v7, v[74:75] offset:9472
ds_write_b64 v7, v[40:41] offset:1536
ds_write_b64 v7, v[42:43] offset:9728
ds_write_b64 v7, v[104:105] offset:1792
ds_write_b64 v7, v[106:107] offset:9984
ds_write_b64 v7, v[136:137] offset:2048
ds_write_b64 v7, v[138:139] offset:10240
ds_write_b64 v7, v[76:77] offset:2304
ds_write_b64 v7, v[78:79] offset:10496
ds_write_b64 v7, v[44:45] offset:2560
ds_write_b64 v7, v[46:47] offset:10752
ds_write_b64 v7, v[108:109] offset:2816
ds_write_b64 v7, v[110:111] offset:11008
ds_write_b64 v7, v[28:29] offset:3072
ds_write_b64 v7, v[30:31] offset:11264
ds_write_b64 v7, v[92:93] offset:3328
ds_write_b64 v7, v[94:95] offset:11520
ds_write_b64 v7, v[60:61] offset:3584
ds_write_b64 v7, v[62:63] offset:11776
ds_write_b64 v7, v[124:125] offset:3840
ds_write_b64 v7, v[126:127] offset:12032
ds_write_b64 v7, v[140:141] offset:4096
ds_write_b64 v7, v[142:143] offset:12288
ds_write_b64 v7, v[48:49] offset:4352
ds_write_b64 v7, v[50:51] offset:12544
ds_write_b64 v7, v[32:33] offset:4608
ds_write_b64 v7, v[34:35] offset:12800
ds_write_b64 v7, v[96:97] offset:4864
ds_write_b64 v7, v[98:99] offset:13056
ds_write_b64 v7, v[24:25] offset:5120
ds_write_b64 v7, v[26:27] offset:13312
ds_write_b64 v7, v[88:89] offset:5376
ds_write_b64 v7, v[90:91] offset:13568
ds_write_b64 v7, v[56:57] offset:5632
ds_write_b64 v7, v[58:59] offset:13824
ds_write_b64 v7, v[120:121] offset:5888
ds_write_b64 v7, v[122:123] offset:14080
ds_write_b64 v7, v[20:21] offset:6144
ds_write_b64 v7, v[22:23] offset:14336
ds_write_b64 v7, v[84:85] offset:6400
ds_write_b64 v7, v[86:87] offset:14592
ds_write_b64 v7, v[52:53] offset:6656
ds_write_b64 v7, v[54:55] offset:14848
ds_write_b64 v7, v[116:117] offset:6912
ds_write_b64 v7, v[118:119] offset:15104
ds_write_b64 v7, v[36:37] offset:7168
ds_write_b64 v7, v[38:39] offset:15360
ds_write_b64 v7, v[100:101] offset:7424
ds_write_b64 v7, v[102:103] offset:15616
ds_write_b64 v7, v[68:69] offset:7680
ds_write_b64 v7, v[70:71] offset:15872
ds_write_b64 v7, v[132:133] offset:7936
ds_write_b64 v7, v[134:135] offset:16128
s_waitcnt lgkmcnt(0)
s_barrier
v_and_b32 v1, 127, v0
v_lshrrev_b32 v2, 7, v0
v_lshlrev_b32 v3, 6, v1
v_lshl_add_u32 v3, v2, 13, v3
v_add_u32 v4, 67584, v3
v_lshlrev_b32 v5, 4, v1
v_lshl_add_u32 v5, v2, 15, v5
s_lshl_b32 s12, s92, 17
ds_read_b128 v[16:19], v3
ds_read_b128 v[20:23], v3 offset:16
ds_read_b128 v[24:27], v3 offset:32
ds_read_b128 v[28:31], v3 offset:48
ds_read_b128 v[32:35], v3 offset:16896
ds_read_b128 v[36:39], v3 offset:16912
ds_read_b128 v[40:43], v3 offset:16928
ds_read_b128 v[44:47], v3 offset:16944
s_waitcnt lgkmcnt(4)
v_cvt_pk_bf16_f32 v48, v16, v18
v_cvt_pk_bf16_f32 v49, v20, v22
v_cvt_pk_bf16_f32 v50, v24, v26
v_cvt_pk_bf16_f32 v51, v28, v30
v_cvt_pk_bf16_f32 v52, v17, v19
v_cvt_pk_bf16_f32 v53, v21, v23
v_cvt_pk_bf16_f32 v54, v25, v27
v_cvt_pk_bf16_f32 v55, v29, v31
s_add_u32 s13, s12, 0
buffer_store_dwordx4 v[48:51], v5, s[4:7], s13 offen offset:2048
s_add_u32 s13, s12, 65536
buffer_store_dwordx4 v[52:55], v5, s[4:7], s13 offen offset:2048
ds_read_b128 v[16:19], v3 offset:33792
ds_read_b128 v[20:23], v3 offset:33808
ds_read_b128 v[24:27], v3 offset:33824
ds_read_b128 v[28:31], v3 offset:33840
s_waitcnt lgkmcnt(4)
v_cvt_pk_bf16_f32 v56, v32, v34
v_cvt_pk_bf16_f32 v57, v36, v38
v_cvt_pk_bf16_f32 v58, v40, v42
v_cvt_pk_bf16_f32 v59, v44, v46
v_cvt_pk_bf16_f32 v60, v33, v35
v_cvt_pk_bf16_f32 v61, v37, v39
v_cvt_pk_bf16_f32 v62, v41, v43
v_cvt_pk_bf16_f32 v63, v45, v47
s_add_u32 s13, s12, 4096
buffer_store_dwordx4 v[56:59], v5, s[4:7], s13 offen offset:2048
s_add_u32 s13, s12, 69632
buffer_store_dwordx4 v[60:63], v5, s[4:7], s13 offen offset:2048
ds_read_b128 v[32:35], v3 offset:50688
ds_read_b128 v[36:39], v3 offset:50704
ds_read_b128 v[40:43], v3 offset:50720
ds_read_b128 v[44:47], v3 offset:50736
s_waitcnt lgkmcnt(4)
v_cvt_pk_bf16_f32 v48, v16, v18
v_cvt_pk_bf16_f32 v49, v20, v22
v_cvt_pk_bf16_f32 v50, v24, v26
v_cvt_pk_bf16_f32 v51, v28, v30
v_cvt_pk_bf16_f32 v52, v17, v19
v_cvt_pk_bf16_f32 v53, v21, v23
v_cvt_pk_bf16_f32 v54, v25, v27
v_cvt_pk_bf16_f32 v55, v29, v31
s_add_u32 s13, s12, 8192
buffer_store_dwordx4 v[48:51], v5, s[4:7], s13 offen offset:2048
s_add_u32 s13, s12, 73728
buffer_store_dwordx4 v[52:55], v5, s[4:7], s13 offen offset:2048
ds_read_b128 v[16:19], v4
ds_read_b128 v[20:23], v4 offset:16
ds_read_b128 v[24:27], v4 offset:32
ds_read_b128 v[28:31], v4 offset:48
s_waitcnt lgkmcnt(4)
v_cvt_pk_bf16_f32 v56, v32, v34
v_cvt_pk_bf16_f32 v57, v36, v38
v_cvt_pk_bf16_f32 v58, v40, v42
v_cvt_pk_bf16_f32 v59, v44, v46
v_cvt_pk_bf16_f32 v60, v33, v35
v_cvt_pk_bf16_f32 v61, v37, v39
v_cvt_pk_bf16_f32 v62, v41, v43
v_cvt_pk_bf16_f32 v63, v45, v47
s_add_u32 s13, s12, 12288
buffer_store_dwordx4 v[56:59], v5, s[4:7], s13 offen offset:2048
s_add_u32 s13, s12, 77824
buffer_store_dwordx4 v[60:63], v5, s[4:7], s13 offen offset:2048
ds_read_b128 v[32:35], v4 offset:16896
ds_read_b128 v[36:39], v4 offset:16912
ds_read_b128 v[40:43], v4 offset:16928
ds_read_b128 v[44:47], v4 offset:16944
s_waitcnt lgkmcnt(4)
v_cvt_pk_bf16_f32 v48, v16, v18
v_cvt_pk_bf16_f32 v49, v20, v22
v_cvt_pk_bf16_f32 v50, v24, v26
v_cvt_pk_bf16_f32 v51, v28, v30
v_cvt_pk_bf16_f32 v52, v17, v19
v_cvt_pk_bf16_f32 v53, v21, v23
v_cvt_pk_bf16_f32 v54, v25, v27
v_cvt_pk_bf16_f32 v55, v29, v31
s_add_u32 s13, s12, 16384
buffer_store_dwordx4 v[48:51], v5, s[4:7], s13 offen offset:2048
s_add_u32 s13, s12, 81920
buffer_store_dwordx4 v[52:55], v5, s[4:7], s13 offen offset:2048
ds_read_b128 v[16:19], v4 offset:33792
ds_read_b128 v[20:23], v4 offset:33808
ds_read_b128 v[24:27], v4 offset:33824
ds_read_b128 v[28:31], v4 offset:33840
s_waitcnt lgkmcnt(4)
v_cvt_pk_bf16_f32 v56, v32, v34
v_cvt_pk_bf16_f32 v57, v36, v38
v_cvt_pk_bf16_f32 v58, v40, v42
v_cvt_pk_bf16_f32 v59, v44, v46
v_cvt_pk_bf16_f32 v60, v33, v35
v_cvt_pk_bf16_f32 v61, v37, v39
v_cvt_pk_bf16_f32 v62, v41, v43
v_cvt_pk_bf16_f32 v63, v45, v47
s_add_u32 s13, s12, 20480
buffer_store_dwordx4 v[56:59], v5, s[4:7], s13 offen offset:2048
s_add_u32 s13, s12, 86016
buffer_store_dwordx4 v[60:63], v5, s[4:7], s13 offen offset:2048
ds_read_b128 v[32:35], v4 offset:50688
ds_read_b128 v[36:39], v4 offset:50704
ds_read_b128 v[40:43], v4 offset:50720
ds_read_b128 v[44:47], v4 offset:50736
s_waitcnt lgkmcnt(4)
v_cvt_pk_bf16_f32 v48, v16, v18
v_cvt_pk_bf16_f32 v49, v20, v22
v_cvt_pk_bf16_f32 v50, v24, v26
v_cvt_pk_bf16_f32 v51, v28, v30
v_cvt_pk_bf16_f32 v52, v17, v19
v_cvt_pk_bf16_f32 v53, v21, v23
v_cvt_pk_bf16_f32 v54, v25, v27
v_cvt_pk_bf16_f32 v55, v29, v31
s_add_u32 s13, s12, 24576
buffer_store_dwordx4 v[48:51], v5, s[4:7], s13 offen offset:2048
s_add_u32 s13, s12, 90112
buffer_store_dwordx4 v[52:55], v5, s[4:7], s13 offen offset:2048
s_waitcnt lgkmcnt(0)
v_cvt_pk_bf16_f32 v56, v32, v34
v_cvt_pk_bf16_f32 v57, v36, v38
v_cvt_pk_bf16_f32 v58, v40, v42
v_cvt_pk_bf16_f32 v59, v44, v46
v_cvt_pk_bf16_f32 v60, v33, v35
v_cvt_pk_bf16_f32 v61, v37, v39
v_cvt_pk_bf16_f32 v62, v41, v43
v_cvt_pk_bf16_f32 v63, v45, v47
s_add_u32 s13, s12, 28672
buffer_store_dwordx4 v[56:59], v5, s[4:7], s13 offen offset:2048
s_add_u32 s13, s12, 94208
buffer_store_dwordx4 v[60:63], v5, s[4:7], s13 offen offset:2048
s_waitcnt vmcnt(0) lgkmcnt(0)
s_barrier
s_lshr_b32 s81, s92, 5
s_cmp_lg_u32 s81, 0
s_cbranch_scc1 L_nx0
s_endpgm
L_nx0:
s_lshr_b32 s81, s92, 5
s_cmp_lg_u32 s81, 1
s_cbranch_scc1 L_nx1
s_endpgm
L_nx1:
L_wl:
s_load_dwordx2 s[52:53], s[0:1], 40
v_and_b32 v202, 63, v0
v_lshrrev_b32 v200, 3, v202
v_lshlrev_b32 v200, 11, v200
v_and_b32 v203, 7, v202
v_lshl_add_u32 v200, v203, 4, v200
s_and_b32 s56, s92, 1
s_lshl_b32 s56, s56, 2
s_add_u32 s56, s56, s98
s_lshl_b32 s56, s56, 20
s_bfe_u32 s58, s92, 0x40001
s_lshl_b32 s57, s58, 7
s_add_u32 s56, s56, s57
v_add_u32 v200, s56, v200
s_lshl_b32 s56, s98, 15
s_lshl_b32 s57, s58, 12
v_lshrrev_b32 v201, 5, v202
v_bfe_u32 v204, v202, 2, 2
v_lshl_add_u32 v201, v201, 3, v204
v_lshlrev_b32 v201, 7, v201
v_bfe_u32 v204, v202, 4, 1
v_lshl_add_u32 v201, v204, 5, v201
v_and_b32 v203, 3, v202
v_lshl_add_u32 v201, v203, 3, v201
v_add_u32 v201, s56, v201
s_waitcnt lgkmcnt(0)
s_mov_b32 s54, 8388608
s_mov_b32 s55, 0x00020000
s_add_u32 m0, s56, 0
s_add_u32 s58, s57, 0
s_and_b32 s58, s58, 0x7fff
s_lshl_b32 s58, s58, 5
buffer_load_dwordx4 v200, s[52:55], s58 offen lds
s_add_u32 m0, s56, 1024
s_add_u32 s58, s57, 512
s_and_b32 s58, s58, 0x7fff
s_lshl_b32 s58, s58, 5
buffer_load_dwordx4 v200, s[52:55], s58 offen lds
s_add_u32 m0, s56, 2048
s_add_u32 s58, s57, 1024
s_and_b32 s58, s58, 0x7fff
s_lshl_b32 s58, s58, 5
buffer_load_dwordx4 v200, s[52:55], s58 offen lds
s_add_u32 m0, s56, 3072
s_add_u32 s58, s57, 1536
s_and_b32 s58, s58, 0x7fff
s_lshl_b32 s58, s58, 5
buffer_load_dwordx4 v200, s[52:55], s58 offen lds
s_waitcnt vmcnt(0)
ds_read_b64_tr_b16 a[0:1], v201
ds_read_b64_tr_b16 a[2:3], v201 offset:512
ds_read_b64_tr_b16 a[4:5], v201 offset:64
ds_read_b64_tr_b16 a[6:7], v201 offset:576
ds_read_b64_tr_b16 a[8:9], v201 offset:2048
ds_read_b64_tr_b16 a[10:11], v201 offset:2560
ds_read_b64_tr_b16 a[12:13], v201 offset:2112
ds_read_b64_tr_b16 a[14:15], v201 offset:2624
s_waitcnt lgkmcnt(0)
s_add_u32 m0, s56, 4096
s_add_u32 s58, s57, 2048
s_and_b32 s58, s58, 0x7fff
s_lshl_b32 s58, s58, 5
buffer_load_dwordx4 v200, s[52:55], s58 offen lds
s_add_u32 m0, s56, 5120
s_add_u32 s58, s57, 2560
s_and_b32 s58, s58, 0x7fff
s_lshl_b32 s58, s58, 5
buffer_load_dwordx4 v200, s[52:55], s58 offen lds
s_add_u32 m0, s56, 6144
s_add_u32 s58, s57, 3072
s_and_b32 s58, s58, 0x7fff
s_lshl_b32 s58, s58, 5
buffer_load_dwordx4 v200, s[52:55], s58 offen lds
s_add_u32 m0, s56, 7168
s_add_u32 s58, s57, 3584
s_and_b32 s58, s58, 0x7fff
s_lshl_b32 s58, s58, 5
buffer_load_dwordx4 v200, s[52:55], s58 offen lds
s_waitcnt vmcnt(0)
ds_read_b64_tr_b16 a[16:17], v201 offset:4096
ds_read_b64_tr_b16 a[18:19], v201 offset:4608
ds_read_b64_tr_b16 a[20:21], v201 offset:4160
ds_read_b64_tr_b16 a[22:23], v201 offset:4672
ds_read_b64_tr_b16 a[24:25], v201 offset:6144
ds_read_b64_tr_b16 a[26:27], v201 offset:6656
ds_read_b64_tr_b16 a[28:29], v201 offset:6208
ds_read_b64_tr_b16 a[30:31], v201 offset:6720
s_waitcnt lgkmcnt(0)
s_add_u32 m0, s56, 8192
s_add_u32 s58, s57, 4096
s_and_b32 s58, s58, 0x7fff
s_lshl_b32 s58, s58, 5
buffer_load_dwordx4 v200, s[52:55], s58 offen lds
s_add_u32 m0, s56, 9216
s_add_u32 s58, s57, 4608
s_and_b32 s58, s58, 0x7fff
s_lshl_b32 s58, s58, 5
buffer_load_dwordx4 v200, s[52:55], s58 offen lds
s_add_u32 m0, s56, 10240
s_add_u32 s58, s57, 5120
s_and_b32 s58, s58, 0x7fff
s_lshl_b32 s58, s58, 5
buffer_load_dwordx4 v200, s[52:55], s58 offen lds
s_add_u32 m0, s56, 11264
s_add_u32 s58, s57, 5632
s_and_b32 s58, s58, 0x7fff
s_lshl_b32 s58, s58, 5
buffer_load_dwordx4 v200, s[52:55], s58 offen lds
s_waitcnt vmcnt(0)
ds_read_b64_tr_b16 a[32:33], v201 offset:8192
ds_read_b64_tr_b16 a[34:35], v201 offset:8704
ds_read_b64_tr_b16 a[36:37], v201 offset:8256
ds_read_b64_tr_b16 a[38:39], v201 offset:8768
ds_read_b64_tr_b16 a[40:41], v201 offset:10240
ds_read_b64_tr_b16 a[42:43], v201 offset:10752
ds_read_b64_tr_b16 a[44:45], v201 offset:10304
ds_read_b64_tr_b16 a[46:47], v201 offset:10816
s_waitcnt lgkmcnt(0)
s_add_u32 m0, s56, 12288
s_add_u32 s58, s57, 6144
s_and_b32 s58, s58, 0x7fff
s_lshl_b32 s58, s58, 5
buffer_load_dwordx4 v200, s[52:55], s58 offen lds
s_add_u32 m0, s56, 13312
s_add_u32 s58, s57, 6656
s_and_b32 s58, s58, 0x7fff
s_lshl_b32 s58, s58, 5
buffer_load_dwordx4 v200, s[52:55], s58 offen lds
s_add_u32 m0, s56, 14336
s_add_u32 s58, s57, 7168
s_and_b32 s58, s58, 0x7fff
s_lshl_b32 s58, s58, 5
buffer_load_dwordx4 v200, s[52:55], s58 offen lds
s_add_u32 m0, s56, 15360
s_add_u32 s58, s57, 7680
s_and_b32 s58, s58, 0x7fff
s_lshl_b32 s58, s58, 5
buffer_load_dwordx4 v200, s[52:55], s58 offen lds
s_waitcnt vmcnt(0)
ds_read_b64_tr_b16 a[48:49], v201 offset:12288
ds_read_b64_tr_b16 a[50:51], v201 offset:12800
ds_read_b64_tr_b16 a[52:53], v201 offset:12352
ds_read_b64_tr_b16 a[54:55], v201 offset:12864
ds_read_b64_tr_b16 a[56:57], v201 offset:14336
ds_read_b64_tr_b16 a[58:59], v201 offset:14848
ds_read_b64_tr_b16 a[60:61], v201 offset:14400
ds_read_b64_tr_b16 a[62:63], v201 offset:14912
s_waitcnt lgkmcnt(0)
s_add_u32 m0, s56, 16384
s_add_u32 s58, s57, 8192
s_and_b32 s58, s58, 0x7fff
s_lshl_b32 s58, s58, 5
buffer_load_dwordx4 v200, s[52:55], s58 offen lds
s_add_u32 m0, s56, 17408
s_add_u32 s58, s57, 8704
s_and_b32 s58, s58, 0x7fff
s_lshl_b32 s58, s58, 5
buffer_load_dwordx4 v200, s[52:55], s58 offen lds
s_add_u32 m0, s56, 18432
s_add_u32 s58, s57, 9216
s_and_b32 s58, s58, 0x7fff
s_lshl_b32 s58, s58, 5
buffer_load_dwordx4 v200, s[52:55], s58 offen lds
s_add_u32 m0, s56, 19456
s_add_u32 s58, s57, 9728
s_and_b32 s58, s58, 0x7fff
s_lshl_b32 s58, s58, 5
buffer_load_dwordx4 v200, s[52:55], s58 offen lds
s_waitcnt vmcnt(0)
ds_read_b64_tr_b16 a[64:65], v201 offset:16384
ds_read_b64_tr_b16 a[66:67], v201 offset:16896
ds_read_b64_tr_b16 a[68:69], v201 offset:16448
ds_read_b64_tr_b16 a[70:71], v201 offset:16960
ds_read_b64_tr_b16 a[72:73], v201 offset:18432
ds_read_b64_tr_b16 a[74:75], v201 offset:18944
ds_read_b64_tr_b16 a[76:77], v201 offset:18496
ds_read_b64_tr_b16 a[78:79], v201 offset:19008
s_waitcnt lgkmcnt(0)
s_add_u32 m0, s56, 20480
s_add_u32 s58, s57, 10240
s_and_b32 s58, s58, 0x7fff
s_lshl_b32 s58, s58, 5
buffer_load_dwordx4 v200, s[52:55], s58 offen lds
s_add_u32 m0, s56, 21504
s_add_u32 s58, s57, 10752
s_and_b32 s58, s58, 0x7fff
s_lshl_b32 s58, s58, 5
buffer_load_dwordx4 v200, s[52:55], s58 offen lds
s_add_u32 m0, s56, 22528
s_add_u32 s58, s57, 11264
s_and_b32 s58, s58, 0x7fff
s_lshl_b32 s58, s58, 5
buffer_load_dwordx4 v200, s[52:55], s58 offen lds
s_add_u32 m0, s56, 23552
s_add_u32 s58, s57, 11776
s_and_b32 s58, s58, 0x7fff
s_lshl_b32 s58, s58, 5
buffer_load_dwordx4 v200, s[52:55], s58 offen lds
s_waitcnt vmcnt(0)
ds_read_b64_tr_b16 a[80:81], v201 offset:20480
ds_read_b64_tr_b16 a[82:83], v201 offset:20992
ds_read_b64_tr_b16 a[84:85], v201 offset:20544
ds_read_b64_tr_b16 a[86:87], v201 offset:21056
ds_read_b64_tr_b16 a[88:89], v201 offset:22528
ds_read_b64_tr_b16 a[90:91], v201 offset:23040
ds_read_b64_tr_b16 a[92:93], v201 offset:22592
ds_read_b64_tr_b16 a[94:95], v201 offset:23104
s_waitcnt lgkmcnt(0)
s_add_u32 m0, s56, 24576
s_add_u32 s58, s57, 12288
s_and_b32 s58, s58, 0x7fff
s_lshl_b32 s58, s58, 5
buffer_load_dwordx4 v200, s[52:55], s58 offen lds
s_add_u32 m0, s56, 25600
s_add_u32 s58, s57, 12800
s_and_b32 s58, s58, 0x7fff
s_lshl_b32 s58, s58, 5
buffer_load_dwordx4 v200, s[52:55], s58 offen lds
s_add_u32 m0, s56, 26624
s_add_u32 s58, s57, 13312
s_and_b32 s58, s58, 0x7fff
s_lshl_b32 s58, s58, 5
buffer_load_dwordx4 v200, s[52:55], s58 offen lds
s_add_u32 m0, s56, 27648
s_add_u32 s58, s57, 13824
s_and_b32 s58, s58, 0x7fff
s_lshl_b32 s58, s58, 5
buffer_load_dwordx4 v200, s[52:55], s58 offen lds
s_waitcnt vmcnt(0)
ds_read_b64_tr_b16 a[96:97], v201 offset:24576
ds_read_b64_tr_b16 a[98:99], v201 offset:25088
ds_read_b64_tr_b16 a[100:101], v201 offset:24640
ds_read_b64_tr_b16 a[102:103], v201 offset:25152
ds_read_b64_tr_b16 a[104:105], v201 offset:26624
ds_read_b64_tr_b16 a[106:107], v201 offset:27136
ds_read_b64_tr_b16 a[108:109], v201 offset:26688
ds_read_b64_tr_b16 a[110:111], v201 offset:27200
s_waitcnt lgkmcnt(0)
s_add_u32 m0, s56, 28672
s_add_u32 s58, s57, 14336
s_and_b32 s58, s58, 0x7fff
s_lshl_b32 s58, s58, 5
buffer_load_dwordx4 v200, s[52:55], s58 offen lds
s_add_u32 m0, s56, 29696
s_add_u32 s58, s57, 14848
s_and_b32 s58, s58, 0x7fff
s_lshl_b32 s58, s58, 5
buffer_load_dwordx4 v200, s[52:55], s58 offen lds
s_add_u32 m0, s56, 30720
s_add_u32 s58, s57, 15360
s_and_b32 s58, s58, 0x7fff
s_lshl_b32 s58, s58, 5
buffer_load_dwordx4 v200, s[52:55], s58 offen lds
s_add_u32 m0, s56, 31744
s_add_u32 s58, s57, 15872
s_and_b32 s58, s58, 0x7fff
s_lshl_b32 s58, s58, 5
buffer_load_dwordx4 v200, s[52:55], s58 offen lds
s_waitcnt vmcnt(0)
ds_read_b64_tr_b16 a[112:113], v201 offset:28672
ds_read_b64_tr_b16 a[114:115], v201 offset:29184
ds_read_b64_tr_b16 a[116:117], v201 offset:28736
ds_read_b64_tr_b16 a[118:119], v201 offset:29248
ds_read_b64_tr_b16 a[120:121], v201 offset:30720
ds_read_b64_tr_b16 a[122:123], v201 offset:31232
ds_read_b64_tr_b16 a[124:125], v201 offset:30784
ds_read_b64_tr_b16 a[126:127], v201 offset:31296
s_waitcnt lgkmcnt(0)
s_add_u32 m0, s56, 0
s_add_u32 s58, s57, 16384
s_and_b32 s58, s58, 0x7fff
s_lshl_b32 s58, s58, 5
buffer_load_dwordx4 v200, s[52:55], s58 offen lds
s_add_u32 m0, s56, 1024
s_add_u32 s58, s57, 16896
s_and_b32 s58, s58, 0x7fff
s_lshl_b32 s58, s58, 5
buffer_load_dwordx4 v200, s[52:55], s58 offen lds
s_add_u32 m0, s56, 2048
s_add_u32 s58, s57, 17408
s_and_b32 s58, s58, 0x7fff
s_lshl_b32 s58, s58, 5
buffer_load_dwordx4 v200, s[52:55], s58 offen lds
s_add_u32 m0, s56, 3072
s_add_u32 s58, s57, 17920
s_and_b32 s58, s58, 0x7fff
s_lshl_b32 s58, s58, 5
buffer_load_dwordx4 v200, s[52:55], s58 offen lds
s_waitcnt vmcnt(0)
ds_read_b64_tr_b16 a[128:129], v201
ds_read_b64_tr_b16 a[130:131], v201 offset:512
ds_read_b64_tr_b16 a[132:133], v201 offset:64
ds_read_b64_tr_b16 a[134:135], v201 offset:576
ds_read_b64_tr_b16 a[136:137], v201 offset:2048
ds_read_b64_tr_b16 a[138:139], v201 offset:2560
ds_read_b64_tr_b16 a[140:141], v201 offset:2112
ds_read_b64_tr_b16 a[142:143], v201 offset:2624
s_waitcnt lgkmcnt(0)
s_add_u32 m0, s56, 4096
s_add_u32 s58, s57, 18432
s_and_b32 s58, s58, 0x7fff
s_lshl_b32 s58, s58, 5
buffer_load_dwordx4 v200, s[52:55], s58 offen lds
s_add_u32 m0, s56, 5120
s_add_u32 s58, s57, 18944
s_and_b32 s58, s58, 0x7fff
s_lshl_b32 s58, s58, 5
buffer_load_dwordx4 v200, s[52:55], s58 offen lds
s_add_u32 m0, s56, 6144
s_add_u32 s58, s57, 19456
s_and_b32 s58, s58, 0x7fff
s_lshl_b32 s58, s58, 5
buffer_load_dwordx4 v200, s[52:55], s58 offen lds
s_add_u32 m0, s56, 7168
s_add_u32 s58, s57, 19968
s_and_b32 s58, s58, 0x7fff
s_lshl_b32 s58, s58, 5
buffer_load_dwordx4 v200, s[52:55], s58 offen lds
s_waitcnt vmcnt(0)
ds_read_b64_tr_b16 a[144:145], v201 offset:4096
ds_read_b64_tr_b16 a[146:147], v201 offset:4608
ds_read_b64_tr_b16 a[148:149], v201 offset:4160
ds_read_b64_tr_b16 a[150:151], v201 offset:4672
ds_read_b64_tr_b16 a[152:153], v201 offset:6144
ds_read_b64_tr_b16 a[154:155], v201 offset:6656
ds_read_b64_tr_b16 a[156:157], v201 offset:6208
ds_read_b64_tr_b16 a[158:159], v201 offset:6720
s_waitcnt lgkmcnt(0)
s_add_u32 m0, s56, 8192
s_add_u32 s58, s57, 20480
s_and_b32 s58, s58, 0x7fff
s_lshl_b32 s58, s58, 5
buffer_load_dwordx4 v200, s[52:55], s58 offen lds
s_add_u32 m0, s56, 9216
s_add_u32 s58, s57, 20992
s_and_b32 s58, s58, 0x7fff
s_lshl_b32 s58, s58, 5
buffer_load_dwordx4 v200, s[52:55], s58 offen lds
s_add_u32 m0, s56, 10240
s_add_u32 s58, s57, 21504
s_and_b32 s58, s58, 0x7fff
s_lshl_b32 s58, s58, 5
buffer_load_dwordx4 v200, s[52:55], s58 offen lds
s_add_u32 m0, s56, 11264
s_add_u32 s58, s57, 22016
s_and_b32 s58, s58, 0x7fff
s_lshl_b32 s58, s58, 5
buffer_load_dwordx4 v200, s[52:55], s58 offen lds
s_waitcnt vmcnt(0)
ds_read_b64_tr_b16 a[160:161], v201 offset:8192
ds_read_b64_tr_b16 a[162:163], v201 offset:8704
ds_read_b64_tr_b16 a[164:165], v201 offset:8256
ds_read_b64_tr_b16 a[166:167], v201 offset:8768
ds_read_b64_tr_b16 a[168:169], v201 offset:10240
ds_read_b64_tr_b16 a[170:171], v201 offset:10752
ds_read_b64_tr_b16 a[172:173], v201 offset:10304
ds_read_b64_tr_b16 a[174:175], v201 offset:10816
s_waitcnt lgkmcnt(0)
s_add_u32 m0, s56, 12288
s_add_u32 s58, s57, 22528
s_and_b32 s58, s58, 0x7fff
s_lshl_b32 s58, s58, 5
buffer_load_dwordx4 v200, s[52:55], s58 offen lds
s_add_u32 m0, s56, 13312
s_add_u32 s58, s57, 23040
s_and_b32 s58, s58, 0x7fff
s_lshl_b32 s58, s58, 5
buffer_load_dwordx4 v200, s[52:55], s58 offen lds
s_add_u32 m0, s56, 14336
s_add_u32 s58, s57, 23552
s_and_b32 s58, s58, 0x7fff
s_lshl_b32 s58, s58, 5
buffer_load_dwordx4 v200, s[52:55], s58 offen lds
s_add_u32 m0, s56, 15360
s_add_u32 s58, s57, 24064
s_and_b32 s58, s58, 0x7fff
s_lshl_b32 s58, s58, 5
buffer_load_dwordx4 v200, s[52:55], s58 offen lds
s_waitcnt vmcnt(0)
ds_read_b64_tr_b16 a[176:177], v201 offset:12288
ds_read_b64_tr_b16 a[178:179], v201 offset:12800
ds_read_b64_tr_b16 a[180:181], v201 offset:12352
ds_read_b64_tr_b16 a[182:183], v201 offset:12864
ds_read_b64_tr_b16 a[184:185], v201 offset:14336
ds_read_b64_tr_b16 a[186:187], v201 offset:14848
ds_read_b64_tr_b16 a[188:189], v201 offset:14400
ds_read_b64_tr_b16 a[190:191], v201 offset:14912
s_waitcnt lgkmcnt(0)
s_add_u32 m0, s56, 16384
s_add_u32 s58, s57, 24576
s_and_b32 s58, s58, 0x7fff
s_lshl_b32 s58, s58, 5
buffer_load_dwordx4 v200, s[52:55], s58 offen lds
s_add_u32 m0, s56, 17408
s_add_u32 s58, s57, 25088
s_and_b32 s58, s58, 0x7fff
s_lshl_b32 s58, s58, 5
buffer_load_dwordx4 v200, s[52:55], s58 offen lds
s_add_u32 m0, s56, 18432
s_add_u32 s58, s57, 25600
s_and_b32 s58, s58, 0x7fff
s_lshl_b32 s58, s58, 5
buffer_load_dwordx4 v200, s[52:55], s58 offen lds
s_add_u32 m0, s56, 19456
s_add_u32 s58, s57, 26112
s_and_b32 s58, s58, 0x7fff
s_lshl_b32 s58, s58, 5
buffer_load_dwordx4 v200, s[52:55], s58 offen lds
s_waitcnt vmcnt(0)
ds_read_b64_tr_b16 a[192:193], v201 offset:16384
ds_read_b64_tr_b16 a[194:195], v201 offset:16896
ds_read_b64_tr_b16 a[196:197], v201 offset:16448
ds_read_b64_tr_b16 a[198:199], v201 offset:16960
ds_read_b64_tr_b16 a[200:201], v201 offset:18432
ds_read_b64_tr_b16 a[202:203], v201 offset:18944
ds_read_b64_tr_b16 a[204:205], v201 offset:18496
ds_read_b64_tr_b16 a[206:207], v201 offset:19008
s_waitcnt lgkmcnt(0)
s_add_u32 m0, s56, 20480
s_add_u32 s58, s57, 26624
s_and_b32 s58, s58, 0x7fff
s_lshl_b32 s58, s58, 5
buffer_load_dwordx4 v200, s[52:55], s58 offen lds
s_add_u32 m0, s56, 21504
s_add_u32 s58, s57, 27136
s_and_b32 s58, s58, 0x7fff
s_lshl_b32 s58, s58, 5
buffer_load_dwordx4 v200, s[52:55], s58 offen lds
s_add_u32 m0, s56, 22528
s_add_u32 s58, s57, 27648
s_and_b32 s58, s58, 0x7fff
s_lshl_b32 s58, s58, 5
buffer_load_dwordx4 v200, s[52:55], s58 offen lds
s_add_u32 m0, s56, 23552
s_add_u32 s58, s57, 28160
s_and_b32 s58, s58, 0x7fff
s_lshl_b32 s58, s58, 5
buffer_load_dwordx4 v200, s[52:55], s58 offen lds
s_waitcnt vmcnt(0)
ds_read_b64_tr_b16 a[208:209], v201 offset:20480
ds_read_b64_tr_b16 a[210:211], v201 offset:20992
ds_read_b64_tr_b16 a[212:213], v201 offset:20544
ds_read_b64_tr_b16 a[214:215], v201 offset:21056
ds_read_b64_tr_b16 a[216:217], v201 offset:22528
ds_read_b64_tr_b16 a[218:219], v201 offset:23040
ds_read_b64_tr_b16 a[220:221], v201 offset:22592
ds_read_b64_tr_b16 a[222:223], v201 offset:23104
s_waitcnt lgkmcnt(0)
s_add_u32 m0, s56, 24576
s_add_u32 s58, s57, 28672
s_and_b32 s58, s58, 0x7fff
s_lshl_b32 s58, s58, 5
buffer_load_dwordx4 v200, s[52:55], s58 offen lds
s_add_u32 m0, s56, 25600
s_add_u32 s58, s57, 29184
s_and_b32 s58, s58, 0x7fff
s_lshl_b32 s58, s58, 5
buffer_load_dwordx4 v200, s[52:55], s58 offen lds
s_add_u32 m0, s56, 26624
s_add_u32 s58, s57, 29696
s_and_b32 s58, s58, 0x7fff
s_lshl_b32 s58, s58, 5
buffer_load_dwordx4 v200, s[52:55], s58 offen lds
s_add_u32 m0, s56, 27648
s_add_u32 s58, s57, 30208
s_and_b32 s58, s58, 0x7fff
s_lshl_b32 s58, s58, 5
buffer_load_dwordx4 v200, s[52:55], s58 offen lds
s_waitcnt vmcnt(0)
ds_read_b64_tr_b16 a[224:225], v201 offset:24576
ds_read_b64_tr_b16 a[226:227], v201 offset:25088
ds_read_b64_tr_b16 a[228:229], v201 offset:24640
ds_read_b64_tr_b16 a[230:231], v201 offset:25152
ds_read_b64_tr_b16 a[232:233], v201 offset:26624
ds_read_b64_tr_b16 a[234:235], v201 offset:27136
ds_read_b64_tr_b16 a[236:237], v201 offset:26688
ds_read_b64_tr_b16 a[238:239], v201 offset:27200
s_waitcnt lgkmcnt(0)
s_add_u32 m0, s56, 28672
s_add_u32 s58, s57, 30720
s_and_b32 s58, s58, 0x7fff
s_lshl_b32 s58, s58, 5
buffer_load_dwordx4 v200, s[52:55], s58 offen lds
s_add_u32 m0, s56, 29696
s_add_u32 s58, s57, 31232
s_and_b32 s58, s58, 0x7fff
s_lshl_b32 s58, s58, 5
buffer_load_dwordx4 v200, s[52:55], s58 offen lds
s_add_u32 m0, s56, 30720
s_add_u32 s58, s57, 31744
s_and_b32 s58, s58, 0x7fff
s_lshl_b32 s58, s58, 5
buffer_load_dwordx4 v200, s[52:55], s58 offen lds
s_add_u32 m0, s56, 31744
s_add_u32 s58, s57, 32256
s_and_b32 s58, s58, 0x7fff
s_lshl_b32 s58, s58, 5
buffer_load_dwordx4 v200, s[52:55], s58 offen lds
s_waitcnt vmcnt(0)
ds_read_b64_tr_b16 a[240:241], v201 offset:28672
ds_read_b64_tr_b16 a[242:243], v201 offset:29184
ds_read_b64_tr_b16 a[244:245], v201 offset:28736
ds_read_b64_tr_b16 a[246:247], v201 offset:29248
ds_read_b64_tr_b16 a[248:249], v201 offset:30720
ds_read_b64_tr_b16 a[250:251], v201 offset:31232
ds_read_b64_tr_b16 a[252:253], v201 offset:30784
ds_read_b64_tr_b16 a[254:255], v201 offset:31296
s_waitcnt lgkmcnt(0)
s_load_dwordx2 s[12:13], s[0:1], 80
v_lshrrev_b32 v3, 6, v0
v_and_b32 v1, 63, v0
v_readfirstlane_b32 s16, v3
s_lshr_b32 s17, s92, 5
s_and_b32 s18, s92, 31
v_lshlrev_b32 v2, 4, v1
v_lshlrev_b32 v19, 4, v0
v_lshlrev_b32 v7, 3, v1
s_waitcnt lgkmcnt(0)
s_mov_b32 s14, 8388608
s_mov_b32 s15, 0x00020000
s_mov_b32 s24, 0x3e0293ee
s_mov_b64 s[60:61], 0
s_lshr_b32 s50, s18, 1
s_lshl_b32 s50, s50, 12
s_mov_b32 s47, 0
s_lshl_b32 s20, s17, 3
s_add_u32 s20, s20, s16
s_lshl_b32 s20, s20, 18
s_lshl_b32 s21, s18, 13
s_add_u32 s20, s20, s21
s_add_u32 s20, s20, 50331648
v_lshlrev_b32 v26, 7, v1
buffer_load_dword v28, v26, s[84:87], s20 offen sc1
buffer_load_dword v30, v26, s[84:87], s20 offen offset:64 sc1
s_add_u32 s20, s20, 1048576
buffer_load_dword v29, v26, s[84:87], s20 offen sc1
buffer_load_dword v31, v26, s[84:87], s20 offen offset:64 sc1
s_lshl_b32 s20, s92, 15
s_add_u32 s20, s20, 75497472
v_lshlrev_b32 v26, 7, v0
buffer_load_dword v32, v26, s[84:87], s20 offen sc1
buffer_load_dword v33, v26, s[84:87], s20 offen offset:64 sc1
v_and_b32 v4, 15, v1
v_lshrrev_b32 v5, 4, v1
v_lshrrev_b32 v3, 2, v4
v_lshlrev_b32 v3, 1, v3
v_and_b32 v26, 1, v4
v_add_u32 v3, v3, v26
v_lshlrev_b32 v6, 8, v3
v_lshl_add_u32 v6, v5, 4, v6
v_lshlrev_b32 v8, 9, v5
v_lshl_add_u32 v8, v4, 4, v8
v_lshlrev_b32 v26, 2, v5
v_sub_u32 v248, v4, v26
s_and_b32 s21, s16, 1
s_lshl_b32 s21, s21, 4
v_add_u32 v9, s21, v248
v_add_u32 v10, -16, v9
v_mov_b32 v11, 0xff7fffff
v_mov_b32 v20, 0x3f803f80
v_mov_b32 v21, 0x3f803f80
v_mov_b32 v22, 0x3f803f80
v_mov_b32 v23, 0x3f803f80
v_bfe_u32 v26, v1, 1, 2
v_min_u32 v26, 2, v26
s_lshl_b32 s20, s18, 8
s_add_u32 s20, s20, 71303168
v_lshlrev_b32 v12, 13, v26
v_and_b32 v26, 1, v1
v_lshl_add_u32 v12, v26, 7, v12
v_add_u32 v12, s20, v12
v_lshlrev_b32 v13, 7, v26
s_add_u32 s43, s20, 24576
v_add_u32 v13, s43, v13
s_lshl_b32 s21, s21, 3
s_add_u32 s20, s20, s21
s_add_u32 s20, s20, 8192
v_mov_b32 v249, s20
s_mov_b32 vcc_lo, 0xcccccccc
s_mov_b32 vcc_hi, 0xcccccccc
v_cndmask_b32 v249, v13, v249, vcc
v_and_b32 v26, 3, v1
s_and_b32 s20, s18, 1
s_lshl_b32 s20, s20, 2
s_add_u32 s20, s20, s16
s_lshl_b32 s20, s20, 2
s_lshl_b32 s21, s17, 5
s_add_u32 s20, s20, s21
v_add_u32 v26, s20, v26
v_lshlrev_b32 v14, 7, v26
v_add_u32 v14, 71335936, v14
v_bfrev_b32 v26, 1
s_lshl_b32 s20, s92, 7
s_add_u32 s20, s20, 71335936
v_mov_b32 v27, s20
s_xor_b32 s20, s20, 128
v_mov_b32 v251, s20
v_cmp_eq_u32 vcc, 0, v0
s_mul_i32 s20, s16, 8704
v_lshrrev_b32 v17, 5, v1
v_lshl_add_u32 v17, v17, 5, v2
v_add_u32 v17, s20, v17
v_cndmask_b32 v15, v26, v27, vcc
v_lshrrev_b32 v26, 3, v0
v_and_b32 v27, 7, v0
v_mul_u32_u24 v16, 544, v27
v_lshl_add_u32 v16, v26, 4, v16
s_and_b32 s20, s18, 1
s_mul_i32 s20, s20, 4352
s_xor_b32 s21, s20, 4352
v_add_u32 v252, s21, v16
v_add_u32 v16, s20, v16
v_lshlrev_b32 v18, 12, v26
v_and_b32 v27, 7, v0
v_lshl_add_u32 v18, v27, 3, v18
s_lshl_b32 s20, s18, 6
v_add_u32 v18, s20, v18
s_barrier
s_cmp_eq_u32 s17, 0
s_cselect_b32 s60, 0x0, s60
s_cselect_b32 s61, 0x0, s61
s_cmp_eq_u32 s17, 1
s_cselect_b32 s60, 0x0, s60
s_cselect_b32 s61, 0x0, s61
s_cmp_eq_u32 s17, 2
s_cselect_b32 s60, 0x0, s60
s_cselect_b32 s61, 0x89200100, s61
s_cmp_eq_u32 s17, 3
s_cselect_b32 s60, 0x0, s60
s_cselect_b32 s61, 0x12401000, s61
s_cmp_eq_u32 s17, 4
s_cselect_b32 s60, 0x1010101, s60
s_cselect_b32 s61, 0x20010001, s61
s_cmp_eq_u32 s17, 5
s_cselect_b32 s60, 0x10101010, s60
s_cselect_b32 s61, 0x44900010, s61
s_ff1_i32_b64 s22, s[60:61]
s_cmp_ge_u32 s22, 64
s_cbranch_scc1 L_x_fin
L_x_gp:
buffer_load_dword v3, v12, s[84:87], 0 offen sc1
s_waitcnt vmcnt(0)
v_cmp_gt_u32 vcc, 32, v3
s_and_b32 vcc_lo, vcc_lo, 252
s_cbranch_scc0 L_x_gk
s_sleep 8
s_branch L_x_gp
L_x_gk:
L_x_job:
s_cmp_ge_u32 s22, 52
s_cbranch_scc1 L_x_single
s_add_u32 s43, s22, s16
s_lshl_b32 s26, s43, 18
s_lshl_b32 s20, s18, 13
s_add_u32 s26, s26, s20
s_lshr_b32 s20, s43, 1
s_add_u32 s20, s20, 32
v_mov_b32 v250, s43
v_mov_b32 v3, s20
s_mov_b32 vcc_lo, 0xcccccccc
s_mov_b32 vcc_hi, 0xcccccccc
v_cndmask_b32 v250, v250, v3, vcc
L_x_btop:
buffer_load_dword v3, v249, s[84:87], 0 offen sc1
s_waitcnt vmcnt(0)
v_cmp_ge_u32 vcc, v250, v3
s_cbranch_vccz L_x_bk
s_sleep 8
s_branch L_x_btop
L_x_bk:
s_add_u32 s21, s26, 0
buffer_load_dwordx4 v[24:27], v2, s[84:87], s21 offen
buffer_load_dwordx4 v[28:31], v2, s[84:87], s21 offen offset:1024
buffer_load_dwordx4 v[32:35], v2, s[84:87], s21 offen offset:2048
buffer_load_dwordx4 v[36:39], v2, s[84:87], s21 offen offset:3072
s_add_u32 s21, s26, 4096
buffer_load_dwordx4 v[40:43], v2, s[84:87], s21 offen
buffer_load_dwordx4 v[44:47], v2, s[84:87], s21 offen offset:1024
buffer_load_dwordx4 v[48:51], v2, s[84:87], s21 offen offset:2048
buffer_load_dwordx4 v[52:55], v2, s[84:87], s21 offen offset:3072
s_add_u32 s21, s26, 16777216
buffer_load_dwordx4 v[56:59], v2, s[84:87], s21 offen
buffer_load_dwordx4 v[60:63], v2, s[84:87], s21 offen offset:1024
buffer_load_dwordx4 v[64:67], v2, s[84:87], s21 offen offset:2048
buffer_load_dwordx4 v[68:71], v2, s[84:87], s21 offen offset:3072
s_add_u32 s21, s26, 16781312
buffer_load_dwordx4 v[72:75], v2, s[84:87], s21 offen
buffer_load_dwordx4 v[76:79], v2, s[84:87], s21 offen offset:1024
buffer_load_dwordx4 v[80:83], v2, s[84:87], s21 offen offset:2048
buffer_load_dwordx4 v[84:87], v2, s[84:87], s21 offen offset:3072
s_add_u32 s21, s26, 33554432
buffer_load_dwordx4 v[88:91], v2, s[84:87], s21 offen
buffer_load_dwordx4 v[92:95], v2, s[84:87], s21 offen offset:1024
buffer_load_dwordx4 v[96:99], v2, s[84:87], s21 offen offset:2048
buffer_load_dwordx4 v[100:103], v2, s[84:87], s21 offen offset:3072
s_add_u32 s21, s26, 33558528
buffer_load_dwordx4 v[104:107], v2, s[84:87], s21 offen
buffer_load_dwordx4 v[108:111], v2, s[84:87], s21 offen offset:1024
buffer_load_dwordx4 v[112:115], v2, s[84:87], s21 offen offset:2048
buffer_load_dwordx4 v[116:119], v2, s[84:87], s21 offen offset:3072
s_add_u32 s21, s26, 178257920
buffer_load_dwordx4 v[120:123], v6, s[84:87], s21 offen sc1
buffer_load_dwordx4 v[124:127], v6, s[84:87], s21 offen offset:64 sc1
buffer_load_dwordx4 v[128:131], v6, s[84:87], s21 offen offset:128 sc1
buffer_load_dwordx4 v[132:135], v6, s[84:87], s21 offen offset:192 sc1
s_add_u32 s21, s26, 178259968
buffer_load_dwordx2 v[136:137], v7, s[84:87], s21 offen sc1
buffer_load_dwordx2 v[138:139], v7, s[84:87], s21 offen offset:2048 sc1
buffer_load_dwordx2 v[140:141], v7, s[84:87], s21 offen offset:512 sc1
buffer_load_dwordx2 v[142:143], v7, s[84:87], s21 offen offset:2560 sc1
buffer_load_dwordx2 v[144:145], v7, s[84:87], s21 offen offset:1024 sc1
buffer_load_dwordx2 v[146:147], v7, s[84:87], s21 offen offset:3072 sc1
buffer_load_dwordx2 v[148:149], v7, s[84:87], s21 offen offset:1536 sc1
buffer_load_dwordx2 v[150:151], v7, s[84:87], s21 offen offset:3584 sc1
L_x_batt:
s_lshl_b32 s40, s17, 3
s_add_u32 s40, s40, s47
s_add_u32 s40, s40, s16
s_lshl_b32 s40, s40, 18
s_add_u32 s40, s40, 50331648
s_lshl_b32 s20, s18, 13
s_add_u32 s40, s40, s20
v_mov_b32 v218, v20
v_mov_b32 v219, 0
s_add_u32 s27, s40, 4096
s_mov_b32 s8, 4
s_waitcnt vmcnt(0)
v_swap_b32 v137, v138
v_swap_b32 v141, v142
v_swap_b32 v145, v146
v_swap_b32 v149, v150
v_mfma_f32_16x16x32_bf16 v[200:203], v[56:59], v[24:27], 0
v_mfma_f32_16x16x32_bf16 v[208:211], v[120:123], v[24:27], 0
v_mfma_f32_16x16x32_bf16 v[200:203], v[64:67], v[32:35], v[200:203]
v_mfma_f32_16x16x32_bf16 v[208:211], v[124:127], v[32:35], v[208:211]
v_mfma_f32_16x16x32_bf16 v[200:203], v[72:75], v[40:43], v[200:203]
v_mfma_f32_16x16x32_bf16 v[208:211], v[128:131], v[40:43], v[208:211]
v_mfma_f32_16x16x32_bf16 v[200:203], v[80:83], v[48:51], v[200:203]
v_mfma_f32_16x16x32_bf16 v[208:211], v[132:135], v[48:51], v[208:211]
s_nop 5
v_cmp_gt_i32 vcc, 0, v248
s_nop 1
v_cndmask_b32 v200, v200, v11, vcc
v_cmp_gt_i32 vcc, 1, v248
s_nop 1
v_cndmask_b32 v201, v201, v11, vcc
v_cmp_gt_i32 vcc, 2, v248
s_nop 1
v_cndmask_b32 v202, v202, v11, vcc
v_cmp_gt_i32 vcc, 3, v248
s_nop 1
v_cndmask_b32 v203, v203, v11, vcc
v_max3_f32 v4, v200, v201, v202
v_max3_f32 v4, v4, v203, v208
v_max_f32 v3, v4, v209
v_max_f32 v4, v4, v209
s_nop 1
v_permlane16_swap_b32 v4, v3
v_max_f32 v4, v4, v3
v_max_f32 v3, v4, v3
s_nop 1
v_permlane32_swap_b32 v4, v3
v_max_f32 v4, v4, v3
v_mul_f32 v4, s24, v4
v_fma_f32 v200, v200, s24, -v4
v_fma_f32 v201, v201, s24, -v4
v_fma_f32 v202, v202, s24, -v4
v_fma_f32 v203, v203, s24, -v4
v_fma_f32 v208, v208, s24, -v4
v_fma_f32 v209, v209, s24, -v4
v_exp_f32 v200, v200
v_exp_f32 v201, v201
v_exp_f32 v202, v202
v_exp_f32 v203, v203
v_exp_f32 v208, v208
v_exp_f32 v209, v209
s_nop 0
v_cvt_pk_bf16_f32 v212, v200, v201
v_cvt_pk_bf16_f32 v213, v202, v203
v_mov_b32 v214, 0
v_mov_b32 v215, 0
v_cvt_pk_bf16_f32 v216, v208, v209
v_cvt_pk_bf16_f32 v217, v208, v209
v_mfma_f32_16x16x32_bf16 v[220:223], v[20:23], v[212:215], 0
v_mfma_f32_16x16x32_bf16 v[152:155], v[88:91], v[212:215], 0
v_mfma_f32_16x16x32_bf16 v[156:159], v[92:95], v[212:215], 0
v_mfma_f32_16x16x32_bf16 v[160:163], v[96:99], v[212:215], 0
v_mfma_f32_16x16x32_bf16 v[164:167], v[100:103], v[212:215], 0
v_mfma_f32_16x16x32_bf16 v[168:171], v[104:107], v[212:215], 0
v_mfma_f32_16x16x32_bf16 v[172:175], v[108:111], v[212:215], 0
v_mfma_f32_16x16x32_bf16 v[176:179], v[112:115], v[212:215], 0
v_mfma_f32_16x16x32_bf16 v[180:183], v[116:119], v[212:215], 0
v_mfma_f32_16x16x16_bf16 v[220:223], v[218:219], v[216:217], v[220:223]
v_mfma_f32_16x16x16_bf16 v[152:155], v[136:137], v[216:217], v[152:155]
v_mfma_f32_16x16x16_bf16 v[156:159], v[138:139], v[216:217], v[156:159]
v_mfma_f32_16x16x16_bf16 v[160:163], v[140:141], v[216:217], v[160:163]
v_mfma_f32_16x16x16_bf16 v[164:167], v[142:143], v[216:217], v[164:167]
v_mfma_f32_16x16x16_bf16 v[168:171], v[144:145], v[216:217], v[168:171]
v_mfma_f32_16x16x16_bf16 v[172:175], v[146:147], v[216:217], v[172:175]
v_mfma_f32_16x16x16_bf16 v[176:179], v[148:149], v[216:217], v[176:179]
v_mfma_f32_16x16x16_bf16 v[180:183], v[150:151], v[216:217], v[180:183]
v_rcp_f32 v220, v220
s_nop 1
v_pk_mul_f32 v[152:153], v[152:153], v[220:221] op_sel_hi:[1,0]
v_pk_mul_f32 v[154:155], v[154:155], v[220:221] op_sel_hi:[1,0]
v_pk_mul_f32 v[156:157], v[156:157], v[220:221] op_sel_hi:[1,0]
v_pk_mul_f32 v[158:159], v[158:159], v[220:221] op_sel_hi:[1,0]
v_pk_mul_f32 v[160:161], v[160:161], v[220:221] op_sel_hi:[1,0]
v_pk_mul_f32 v[162:163], v[162:163], v[220:221] op_sel_hi:[1,0]
v_pk_mul_f32 v[164:165], v[164:165], v[220:221] op_sel_hi:[1,0]
v_pk_mul_f32 v[166:167], v[166:167], v[220:221] op_sel_hi:[1,0]
v_pk_mul_f32 v[168:169], v[168:169], v[220:221] op_sel_hi:[1,0]
v_pk_mul_f32 v[170:171], v[170:171], v[220:221] op_sel_hi:[1,0]
v_pk_mul_f32 v[172:173], v[172:173], v[220:221] op_sel_hi:[1,0]
v_pk_mul_f32 v[174:175], v[174:175], v[220:221] op_sel_hi:[1,0]
v_pk_mul_f32 v[176:177], v[176:177], v[220:221] op_sel_hi:[1,0]
v_pk_mul_f32 v[178:179], v[178:179], v[220:221] op_sel_hi:[1,0]
v_pk_mul_f32 v[180:181], v[180:181], v[220:221] op_sel_hi:[1,0]
v_pk_mul_f32 v[182:183], v[182:183], v[220:221] op_sel_hi:[1,0]
v_cvt_pk_bf16_f32 v184, v152, v153
v_cvt_pk_bf16_f32 v185, v154, v155
v_cvt_pk_bf16_f32 v186, v156, v157
v_cvt_pk_bf16_f32 v187, v158, v159
v_cvt_pk_bf16_f32 v188, v160, v161
v_cvt_pk_bf16_f32 v189, v162, v163
v_cvt_pk_bf16_f32 v190, v164, v165
v_cvt_pk_bf16_f32 v191, v166, v167
v_cvt_pk_bf16_f32 v192, v168, v169
v_cvt_pk_bf16_f32 v193, v170, v171
v_cvt_pk_bf16_f32 v194, v172, v173
v_cvt_pk_bf16_f32 v195, v174, v175
v_cvt_pk_bf16_f32 v196, v176, v177
v_cvt_pk_bf16_f32 v197, v178, v179
v_cvt_pk_bf16_f32 v198, v180, v181
v_cvt_pk_bf16_f32 v199, v182, v183
s_cmp_eq_u32 s96, 1
s_cbranch_scc1 L_x_st_9f
buffer_store_dwordx4 v[184:187], v8, s[84:87], s40 offen sc1
buffer_store_dwordx4 v[188:191], v8, s[84:87], s40 offen offset:2048 sc1
buffer_store_dwordx4 v[192:195], v8, s[84:87], s27 offen sc1
buffer_store_dwordx4 v[196:199], v8, s[84:87], s27 offen offset:2048 sc1
s_branch L_x_st_9d
L_x_st_9f:
buffer_store_dwordx4 v[184:187], v8, s[84:87], s40 offen
buffer_store_dwordx4 v[188:191], v8, s[84:87], s40 offen offset:2048
buffer_store_dwordx4 v[192:195], v8, s[84:87], s27 offen
buffer_store_dwordx4 v[196:199], v8, s[84:87], s27 offen offset:2048
L_x_st_9d:
v_mfma_f32_16x16x32_bf16 v[200:203], v[56:59], v[28:31], 0
v_mfma_f32_16x16x32_bf16 v[204:207], v[60:63], v[28:31], 0
v_mfma_f32_16x16x32_bf16 v[208:211], v[120:123], v[28:31], 0
v_mfma_f32_16x16x32_bf16 v[200:203], v[64:67], v[36:39], v[200:203]
v_mfma_f32_16x16x32_bf16 v[204:207], v[68:71], v[36:39], v[204:207]
v_mfma_f32_16x16x32_bf16 v[208:211], v[124:127], v[36:39], v[208:211]
v_mfma_f32_16x16x32_bf16 v[200:203], v[72:75], v[44:47], v[200:203]
v_mfma_f32_16x16x32_bf16 v[204:207], v[76:79], v[44:47], v[204:207]
v_mfma_f32_16x16x32_bf16 v[208:211], v[128:131], v[44:47], v[208:211]
v_mfma_f32_16x16x32_bf16 v[200:203], v[80:83], v[52:55], v[200:203]
v_mfma_f32_16x16x32_bf16 v[204:207], v[84:87], v[52:55], v[204:207]
v_mfma_f32_16x16x32_bf16 v[208:211], v[132:135], v[52:55], v[208:211]
s_nop 5
v_cmp_gt_i32 vcc, 0, v248
s_nop 1
v_cndmask_b32 v204, v204, v11, vcc
v_cmp_gt_i32 vcc, 1, v248
s_nop 1
v_cndmask_b32 v205, v205, v11, vcc
v_cmp_gt_i32 vcc, 2, v248
s_nop 1
v_cndmask_b32 v206, v206, v11, vcc
v_cmp_gt_i32 vcc, 3, v248
s_nop 1
v_cndmask_b32 v207, v207, v11, vcc
v_max3_f32 v4, v200, v201, v202
v_max3_f32 v4, v4, v203, v204
v_max3_f32 v4, v4, v205, v206
v_max3_f32 v4, v4, v207, v208
v_max_f32 v3, v4, v209
v_max_f32 v4, v4, v209
s_nop 1
v_permlane16_swap_b32 v4, v3
v_max_f32 v4, v4, v3
v_max_f32 v3, v4, v3
s_nop 1
v_permlane32_swap_b32 v4, v3
v_max_f32 v4, v4, v3
v_mul_f32 v4, s24, v4
v_fma_f32 v200, v200, s24, -v4
v_fma_f32 v201, v201, s24, -v4
v_fma_f32 v202, v202, s24, -v4
v_fma_f32 v203, v203, s24, -v4
v_fma_f32 v204, v204, s24, -v4
v_fma_f32 v205, v205, s24, -v4
v_fma_f32 v206, v206, s24, -v4
v_fma_f32 v207, v207, s24, -v4
v_fma_f32 v208, v208, s24, -v4
v_fma_f32 v209, v209, s24, -v4
v_exp_f32 v200, v200
v_exp_f32 v201, v201
v_exp_f32 v202, v202
v_exp_f32 v203, v203
v_exp_f32 v204, v204
v_exp_f32 v205, v205
v_exp_f32 v206, v206
v_exp_f32 v207, v207
v_exp_f32 v208, v208
v_exp_f32 v209, v209
s_nop 0
v_cvt_pk_bf16_f32 v212, v200, v201
v_cvt_pk_bf16_f32 v213, v202, v203
v_cvt_pk_bf16_f32 v214, v204, v205
v_cvt_pk_bf16_f32 v215, v206, v207
v_cvt_pk_bf16_f32 v216, v208, v209
v_cvt_pk_bf16_f32 v217, v208, v209
v_mfma_f32_16x16x32_bf16 v[220:223], v[20:23], v[212:215], 0
v_mfma_f32_16x16x32_bf16 v[152:155], v[88:91], v[212:215], 0
v_mfma_f32_16x16x32_bf16 v[156:159], v[92:95], v[212:215], 0
v_mfma_f32_16x16x32_bf16 v[160:163], v[96:99], v[212:215], 0
v_mfma_f32_16x16x32_bf16 v[164:167], v[100:103], v[212:215], 0
v_mfma_f32_16x16x32_bf16 v[168:171], v[104:107], v[212:215], 0
v_mfma_f32_16x16x32_bf16 v[172:175], v[108:111], v[212:215], 0
v_mfma_f32_16x16x32_bf16 v[176:179], v[112:115], v[212:215], 0
v_mfma_f32_16x16x32_bf16 v[180:183], v[116:119], v[212:215], 0
v_mfma_f32_16x16x16_bf16 v[220:223], v[218:219], v[216:217], v[220:223]
v_mfma_f32_16x16x16_bf16 v[152:155], v[136:137], v[216:217], v[152:155]
v_mfma_f32_16x16x16_bf16 v[156:159], v[138:139], v[216:217], v[156:159]
v_mfma_f32_16x16x16_bf16 v[160:163], v[140:141], v[216:217], v[160:163]
v_mfma_f32_16x16x16_bf16 v[164:167], v[142:143], v[216:217], v[164:167]
v_mfma_f32_16x16x16_bf16 v[168:171], v[144:145], v[216:217], v[168:171]
v_mfma_f32_16x16x16_bf16 v[172:175], v[146:147], v[216:217], v[172:175]
v_mfma_f32_16x16x16_bf16 v[176:179], v[148:149], v[216:217], v[176:179]
v_mfma_f32_16x16x16_bf16 v[180:183], v[150:151], v[216:217], v[180:183]
v_rcp_f32 v220, v220
s_nop 1
v_pk_mul_f32 v[152:153], v[152:153], v[220:221] op_sel_hi:[1,0]
v_pk_mul_f32 v[154:155], v[154:155], v[220:221] op_sel_hi:[1,0]
v_pk_mul_f32 v[156:157], v[156:157], v[220:221] op_sel_hi:[1,0]
v_pk_mul_f32 v[158:159], v[158:159], v[220:221] op_sel_hi:[1,0]
v_pk_mul_f32 v[160:161], v[160:161], v[220:221] op_sel_hi:[1,0]
v_pk_mul_f32 v[162:163], v[162:163], v[220:221] op_sel_hi:[1,0]
v_pk_mul_f32 v[164:165], v[164:165], v[220:221] op_sel_hi:[1,0]
v_pk_mul_f32 v[166:167], v[166:167], v[220:221] op_sel_hi:[1,0]
v_pk_mul_f32 v[168:169], v[168:169], v[220:221] op_sel_hi:[1,0]
v_pk_mul_f32 v[170:171], v[170:171], v[220:221] op_sel_hi:[1,0]
v_pk_mul_f32 v[172:173], v[172:173], v[220:221] op_sel_hi:[1,0]
v_pk_mul_f32 v[174:175], v[174:175], v[220:221] op_sel_hi:[1,0]
v_pk_mul_f32 v[176:177], v[176:177], v[220:221] op_sel_hi:[1,0]
v_pk_mul_f32 v[178:179], v[178:179], v[220:221] op_sel_hi:[1,0]
v_pk_mul_f32 v[180:181], v[180:181], v[220:221] op_sel_hi:[1,0]
v_pk_mul_f32 v[182:183], v[182:183], v[220:221] op_sel_hi:[1,0]
v_cvt_pk_bf16_f32 v184, v152, v153
v_cvt_pk_bf16_f32 v185, v154, v155
v_cvt_pk_bf16_f32 v186, v156, v157
v_cvt_pk_bf16_f32 v187, v158, v159
v_cvt_pk_bf16_f32 v188, v160, v161
v_cvt_pk_bf16_f32 v189, v162, v163
v_cvt_pk_bf16_f32 v190, v164, v165
v_cvt_pk_bf16_f32 v191, v166, v167
v_cvt_pk_bf16_f32 v192, v168, v169
v_cvt_pk_bf16_f32 v193, v170, v171
v_cvt_pk_bf16_f32 v194, v172, v173
v_cvt_pk_bf16_f32 v195, v174, v175
v_cvt_pk_bf16_f32 v196, v176, v177
v_cvt_pk_bf16_f32 v197, v178, v179
v_cvt_pk_bf16_f32 v198, v180, v181
v_cvt_pk_bf16_f32 v199, v182, v183
s_cmp_eq_u32 s96, 1
s_cbranch_scc1 L_x_st_10f
buffer_store_dwordx4 v[184:187], v8, s[84:87], s40 offen offset:256 sc1
buffer_store_dwordx4 v[188:191], v8, s[84:87], s40 offen offset:2304 sc1
buffer_store_dwordx4 v[192:195], v8, s[84:87], s27 offen offset:256 sc1
buffer_store_dwordx4 v[196:199], v8, s[84:87], s27 offen offset:2304 sc1
s_branch L_x_st_10d
L_x_st_10f:
buffer_store_dwordx4 v[184:187], v8, s[84:87], s40 offen offset:256
buffer_store_dwordx4 v[188:191], v8, s[84:87], s40 offen offset:2304
buffer_store_dwordx4 v[192:195], v8, s[84:87], s27 offen offset:256
buffer_store_dwordx4 v[196:199], v8, s[84:87], s27 offen offset:2304
L_x_st_10d:
s_branch L_x_pub
L_x_single:
L_x_gq:
buffer_load_dword v3, v12, s[84:87], 0 offen sc1
s_waitcnt vmcnt(0)
v_cmp_ne_u32 vcc, 64, v3
s_and_b32 vcc_lo, vcc_lo, 0xc
s_cbranch_scc0 L_x_gqd
s_sleep 8
s_branch L_x_gq
L_x_gqd:
s_lshl_b32 s27, s22, 18
s_lshl_b32 s20, s18, 13
s_add_u32 s27, s27, s20
s_add_u32 s29, s27, 178257920
s_and_b32 s20, s16, 1
s_lshl_b32 s20, s20, 10
s_add_u32 s26, s27, s20
s_add_u32 s26, s26, 0
s_lshr_b32 s20, s16, 1
s_lshl_b32 s20, s20, 12
s_add_u32 s28, s27, s20
s_add_u32 s28, s28, 33554432
s_add_u32 s27, s27, 16777216
s_add_u32 s48, s26, 4096
s_add_u32 s49, s27, 4096
buffer_load_dwordx4 v[24:27], v2, s[84:87], s26 offen
buffer_load_dwordx4 v[28:31], v2, s[84:87], s26 offen offset:2048
buffer_load_dwordx4 v[32:35], v2, s[84:87], s48 offen
buffer_load_dwordx4 v[36:39], v2, s[84:87], s48 offen offset:2048
buffer_load_dwordx4 v[56:59], v2, s[84:87], s27 offen
buffer_load_dwordx4 v[60:63], v2, s[84:87], s27 offen offset:1024
buffer_load_dwordx4 v[64:67], v2, s[84:87], s27 offen offset:2048
buffer_load_dwordx4 v[68:71], v2, s[84:87], s27 offen offset:3072
buffer_load_dwordx4 v[72:75], v2, s[84:87], s49 offen
buffer_load_dwordx4 v[76:79], v2, s[84:87], s49 offen offset:1024
buffer_load_dwordx4 v[80:83], v2, s[84:87], s49 offen offset:2048
buffer_load_dwordx4 v[84:87], v2, s[84:87], s49 offen offset:3072
buffer_load_dwordx4 v[88:91], v2, s[84:87], s28 offen
buffer_load_dwordx4 v[92:95], v2, s[84:87], s28 offen offset:1024
buffer_load_dwordx4 v[96:99], v2, s[84:87], s28 offen offset:2048
buffer_load_dwordx4 v[100:103], v2, s[84:87], s28 offen offset:3072
s_lshl_b32 s40, s17, 3
s_add_u32 s40, s40, s47
s_lshl_b32 s40, s40, 18
s_add_u32 s40, s40, 50331648
s_lshl_b32 s20, s18, 13
s_add_u32 s40, s40, s20
v_mov_b32 v218, v20
v_mov_b32 v219, 0
s_lshr_b32 s20, s16, 1
s_lshl_b32 s21, s20, 12
s_add_u32 s40, s40, s21
s_lshl_b32 s20, s20, 10
s_add_u32 s28, s29, s20
s_add_u32 s28, s28, 2048
s_and_b32 s20, s16, 1
s_lshl_b32 s20, s20, 8
s_add_u32 s40, s40, s20
s_mov_b32 s8, 1
s_waitcnt vmcnt(0)
v_mfma_f32_16x16x32_bf16 v[200:203], v[56:59], v[24:27], 0
v_mfma_f32_16x16x32_bf16 v[204:207], v[60:63], v[24:27], 0
v_mfma_f32_16x16x32_bf16 v[200:203], v[64:67], v[28:31], v[200:203]
v_mfma_f32_16x16x32_bf16 v[204:207], v[68:71], v[28:31], v[204:207]
v_mfma_f32_16x16x32_bf16 v[200:203], v[72:75], v[32:35], v[200:203]
v_mfma_f32_16x16x32_bf16 v[204:207], v[76:79], v[32:35], v[204:207]
v_mfma_f32_16x16x32_bf16 v[200:203], v[80:83], v[36:39], v[200:203]
v_mfma_f32_16x16x32_bf16 v[204:207], v[84:87], v[36:39], v[204:207]
s_nop 5
v_cmp_gt_i32 vcc, 0, v9
s_nop 1
v_cndmask_b32 v200, v200, v11, vcc
v_cmp_gt_i32 vcc, 1, v9
s_nop 1
v_cndmask_b32 v201, v201, v11, vcc
v_cmp_gt_i32 vcc, 2, v9
s_nop 1
v_cndmask_b32 v202, v202, v11, vcc
v_cmp_gt_i32 vcc, 3, v9
s_nop 1
v_cndmask_b32 v203, v203, v11, vcc
v_cmp_gt_i32 vcc, 0, v10
s_nop 1
v_cndmask_b32 v204, v204, v11, vcc
v_cmp_gt_i32 vcc, 1, v10
s_nop 1
v_cndmask_b32 v205, v205, v11, vcc
v_cmp_gt_i32 vcc, 2, v10
s_nop 1
v_cndmask_b32 v206, v206, v11, vcc
v_cmp_gt_i32 vcc, 3, v10
s_nop 1
v_cndmask_b32 v207, v207, v11, vcc
s_cmp_ge_u32 s22, 63
s_cbranch_scc1 L_x_dx
L_x_rp:
buffer_load_dword v3, v13, s[84:87], 0 offen sc1
s_waitcnt vmcnt(0)
v_cmp_ge_u32 vcc, s22, v3
s_cbranch_vccz L_x_rk
s_sleep 2
s_branch L_x_rp
L_x_rk:
buffer_load_dwordx4 v[120:123], v6, s[84:87], s29 offen sc1
buffer_load_dwordx4 v[124:127], v6, s[84:87], s29 offen offset:64 sc1
buffer_load_dwordx4 v[128:131], v6, s[84:87], s29 offen offset:128 sc1
buffer_load_dwordx4 v[132:135], v6, s[84:87], s29 offen offset:192 sc1
buffer_load_dwordx2 v[136:137], v7, s[84:87], s28 offen sc1
buffer_load_dwordx2 v[138:139], v7, s[84:87], s28 offen offset:2048 sc1
buffer_load_dwordx2 v[140:141], v7, s[84:87], s28 offen offset:512 sc1
buffer_load_dwordx2 v[142:143], v7, s[84:87], s28 offen offset:2560 sc1
L_x_rd:
s_waitcnt vmcnt(7)
v_mfma_f32_16x16x32_bf16 v[208:211], v[120:123], v[24:27], 0
s_waitcnt vmcnt(6)
v_mfma_f32_16x16x32_bf16 v[208:211], v[124:127], v[28:31], v[208:211]
s_waitcnt vmcnt(5)
v_mfma_f32_16x16x32_bf16 v[208:211], v[128:131], v[32:35], v[208:211]
s_waitcnt vmcnt(4)
v_mfma_f32_16x16x32_bf16 v[208:211], v[132:135], v[36:39], v[208:211]
s_waitcnt vmcnt(0)
v_swap_b32 v137, v138
v_swap_b32 v141, v142
s_nop 1
v_max3_f32 v4, v200, v201, v202
v_max3_f32 v4, v4, v203, v204
v_max3_f32 v4, v4, v205, v206
v_max3_f32 v4, v4, v207, v208
v_max_f32 v3, v4, v209
v_max_f32 v4, v4, v209
s_nop 1
v_permlane16_swap_b32 v4, v3
v_max_f32 v4, v4, v3
v_max_f32 v3, v4, v3
s_nop 1
v_permlane32_swap_b32 v4, v3
v_max_f32 v4, v4, v3
v_mul_f32 v4, s24, v4
v_fma_f32 v200, v200, s24, -v4
v_fma_f32 v201, v201, s24, -v4
v_fma_f32 v202, v202, s24, -v4
v_fma_f32 v203, v203, s24, -v4
v_fma_f32 v204, v204, s24, -v4
v_fma_f32 v205, v205, s24, -v4
v_fma_f32 v206, v206, s24, -v4
v_fma_f32 v207, v207, s24, -v4
v_fma_f32 v208, v208, s24, -v4
v_fma_f32 v209, v209, s24, -v4
v_exp_f32 v200, v200
v_exp_f32 v201, v201
v_exp_f32 v202, v202
v_exp_f32 v203, v203
v_exp_f32 v204, v204
v_exp_f32 v205, v205
v_exp_f32 v206, v206
v_exp_f32 v207, v207
v_exp_f32 v208, v208
v_exp_f32 v209, v209
s_nop 0
v_cvt_pk_bf16_f32 v212, v200, v201
v_cvt_pk_bf16_f32 v213, v202, v203
v_cvt_pk_bf16_f32 v214, v204, v205
v_cvt_pk_bf16_f32 v215, v206, v207
v_cvt_pk_bf16_f32 v216, v208, v209
v_cvt_pk_bf16_f32 v217, v208, v209
v_mfma_f32_16x16x32_bf16 v[220:223], v[20:23], v[212:215], 0
v_mfma_f32_16x16x32_bf16 v[152:155], v[88:91], v[212:215], 0
v_mfma_f32_16x16x32_bf16 v[156:159], v[92:95], v[212:215], 0
v_mfma_f32_16x16x32_bf16 v[160:163], v[96:99], v[212:215], 0
v_mfma_f32_16x16x32_bf16 v[164:167], v[100:103], v[212:215], 0
s_nop 1
v_mfma_f32_16x16x16_bf16 v[220:223], v[218:219], v[216:217], v[220:223]
v_mfma_f32_16x16x16_bf16 v[152:155], v[136:137], v[216:217], v[152:155]
v_mfma_f32_16x16x16_bf16 v[156:159], v[138:139], v[216:217], v[156:159]
v_mfma_f32_16x16x16_bf16 v[160:163], v[140:141], v[216:217], v[160:163]
v_mfma_f32_16x16x16_bf16 v[164:167], v[142:143], v[216:217], v[164:167]
s_nop 3
v_rcp_f32 v220, v220
s_nop 1
v_pk_mul_f32 v[152:153], v[152:153], v[220:221] op_sel_hi:[1,0]
v_pk_mul_f32 v[154:155], v[154:155], v[220:221] op_sel_hi:[1,0]
v_pk_mul_f32 v[156:157], v[156:157], v[220:221] op_sel_hi:[1,0]
v_pk_mul_f32 v[158:159], v[158:159], v[220:221] op_sel_hi:[1,0]
v_pk_mul_f32 v[160:161], v[160:161], v[220:221] op_sel_hi:[1,0]
v_pk_mul_f32 v[162:163], v[162:163], v[220:221] op_sel_hi:[1,0]
v_pk_mul_f32 v[164:165], v[164:165], v[220:221] op_sel_hi:[1,0]
v_pk_mul_f32 v[166:167], v[166:167], v[220:221] op_sel_hi:[1,0]
v_cvt_pk_bf16_f32 v184, v152, v153
v_cvt_pk_bf16_f32 v185, v154, v155
v_cvt_pk_bf16_f32 v186, v156, v157
v_cvt_pk_bf16_f32 v187, v158, v159
v_cvt_pk_bf16_f32 v188, v160, v161
v_cvt_pk_bf16_f32 v189, v162, v163
v_cvt_pk_bf16_f32 v190, v164, v165
v_cvt_pk_bf16_f32 v191, v166, v167
s_cmp_eq_u32 s96, 1
s_cbranch_scc1 L_x_st_11f
buffer_store_dwordx4 v[184:187], v8, s[84:87], s40 offen sc1
buffer_store_dwordx4 v[188:191], v8, s[84:87], s40 offen offset:2048 sc1
s_branch L_x_st_11d
L_x_st_11f:
buffer_store_dwordx4 v[184:187], v8, s[84:87], s40 offen
buffer_store_dwordx4 v[188:191], v8, s[84:87], s40 offen offset:2048
L_x_st_11d:
L_x_pub:
s_add_u32 s45, s22, s8
v_mov_b32 v4, s45
s_waitcnt vmcnt(0)
s_barrier
s_cmp_eq_u32 s96, 1
s_cbranch_scc1 L_x_st_12f
buffer_store_dword v4, v15, s[84:87], 0 offen sc1
s_branch L_x_st_12d
L_x_st_12f:
buffer_store_dword v4, v15, s[84:87], 0 offen
L_x_st_12d:
s_lshl_b32 s41, s17, 3
s_add_u32 s41, s41, s47
s_lshl_b32 s41, s41, 3
s_and_b32 s20, s18, 1
s_lshl_b32 s20, s20, 2
s_add_u32 s41, s41, s20
s_add_u32 s41, s41, s16
s_lshl_b32 s41, s41, 15
s_add_u32 s41, s41, 50331648
s_lshl_b32 s10, s92, 3
s_add_u32 s10, s10, s47
s_lshl_b32 s10, s10, 12
s_add_u32 s10, s10, 75497472
s_xor_b32 s9, s10, 32768
s_lshl_b32 s42, s22, 17
s_xor_b32 s47, s47, 4
s_bitset0_b64 s[60:61], s22
s_ff1_i32_b64 s22, s[60:61]
s_min_u32 s22, s22, 64
s_mov_b32 s51, 0
s_add_u32 s43, s22, s16
s_lshl_b32 s26, s43, 18
s_lshl_b32 s20, s18, 13
s_add_u32 s26, s26, s20
s_lshr_b32 s20, s43, 1
s_add_u32 s20, s20, 32
v_mov_b32 v250, s43
v_mov_b32 v3, s20
s_mov_b32 vcc_lo, 0xcccccccc
s_mov_b32 vcc_hi, 0xcccccccc
v_cndmask_b32 v250, v250, v3, vcc
s_cmp_ge_u32 s22, 52
s_cbranch_scc1 L_x_xp
buffer_load_dword v5, v249, s[84:87], 0 offen sc1
L_x_xp:
buffer_load_dword v3, v14, s[84:87], 0 offen sc1
s_waitcnt vmcnt(0)
v_cmp_gt_u32 vcc, s45, v3
s_cbranch_vccnz L_x_xp
v_cmp_ge_u32 vcc, v250, v5
s_cmp_eq_u64 vcc, 0
s_cselect_b32 s46, 1, 0
s_cmp_lt_u32 s22, 52
s_cselect_b32 s46, s46, 0
s_cmp_eq_u32 s46, 1
s_cselect_b32 s26, s26, 0x80000000
s_cmp_eq_u32 s8, 1
s_cbranch_scc1 L_x_f1
s_add_u32 s20, s50, 0
s_and_b32 s20, s20, 0x7fff
s_add_u32 s20, s20, s41
buffer_load_dwordx4 v[152:155], v2, s[84:87], s20 offen sc1
buffer_load_dwordx4 v[156:159], v2, s[84:87], s20 offen offset:1024 sc1
buffer_load_dwordx4 v[160:163], v2, s[84:87], s20 offen offset:2048 sc1
buffer_load_dwordx4 v[164:167], v2, s[84:87], s20 offen offset:3072 sc1
s_add_u32 s20, s50, 4096
s_and_b32 s20, s20, 0x7fff
s_add_u32 s20, s20, s41
buffer_load_dwordx4 v[168:171], v2, s[84:87], s20 offen sc1
buffer_load_dwordx4 v[172:175], v2, s[84:87], s20 offen offset:1024 sc1
buffer_load_dwordx4 v[176:179], v2, s[84:87], s20 offen offset:2048 sc1
buffer_load_dwordx4 v[180:183], v2, s[84:87], s20 offen offset:3072 sc1
s_add_u32 s20, s50, 8192
s_and_b32 s20, s20, 0x7fff
s_add_u32 s20, s20, s41
buffer_load_dwordx4 v[184:187], v2, s[84:87], s20 offen sc1
buffer_load_dwordx4 v[188:191], v2, s[84:87], s20 offen offset:1024 sc1
s_waitcnt vmcnt(9)
v_mfma_f32_32x32x16_bf16 v[200:215], a[0:3], v[152:155], 0
v_mfma_f32_32x32x16_bf16 v[216:231], a[4:7], v[152:155], 0
buffer_load_dwordx4 v[192:195], v2, s[84:87], s20 offen offset:2048 sc1
s_waitcnt vmcnt(9)
v_mfma_f32_32x32x16_bf16 v[200:215], a[8:11], v[156:159], v[200:215]
v_mfma_f32_32x32x16_bf16 v[216:231], a[12:15], v[156:159], v[216:231]
buffer_load_dwordx4 v[196:199], v2, s[84:87], s20 offen offset:3072 sc1
s_add_u32 s21, s26, 0
buffer_load_dwordx4 v[24:27], v2, s[84:87], s21 offen
s_waitcnt vmcnt(10)
v_mfma_f32_32x32x16_bf16 v[200:215], a[16:19], v[160:163], v[200:215]
v_mfma_f32_32x32x16_bf16 v[216:231], a[20:23], v[160:163], v[216:231]
s_add_u32 s20, s50, 12288
s_and_b32 s20, s20, 0x7fff
s_add_u32 s20, s20, s41
buffer_load_dwordx4 v[152:155], v2, s[84:87], s20 offen sc1
s_waitcnt vmcnt(10)
v_mfma_f32_32x32x16_bf16 v[200:215], a[24:27], v[164:167], v[200:215]
v_mfma_f32_32x32x16_bf16 v[216:231], a[28:31], v[164:167], v[216:231]
buffer_load_dwordx4 v[156:159], v2, s[84:87], s20 offen offset:1024 sc1
s_waitcnt vmcnt(10)
v_mfma_f32_32x32x16_bf16 v[200:215], a[32:35], v[168:171], v[200:215]
v_mfma_f32_32x32x16_bf16 v[216:231], a[36:39], v[168:171], v[216:231]
buffer_load_dwordx4 v[160:163], v2, s[84:87], s20 offen offset:2048 sc1
buffer_load_dwordx4 v[28:31], v2, s[84:87], s21 offen offset:1024
s_waitcnt vmcnt(11)
v_mfma_f32_32x32x16_bf16 v[200:215], a[40:43], v[172:175], v[200:215]
v_mfma_f32_32x32x16_bf16 v[216:231], a[44:47], v[172:175], v[216:231]
buffer_load_dwordx4 v[164:167], v2, s[84:87], s20 offen offset:3072 sc1
s_waitcnt vmcnt(11)
v_mfma_f32_32x32x16_bf16 v[200:215], a[48:51], v[176:179], v[200:215]
v_mfma_f32_32x32x16_bf16 v[216:231], a[52:55], v[176:179], v[216:231]
s_add_u32 s20, s50, 16384
s_and_b32 s20, s20, 0x7fff
s_add_u32 s20, s20, s41
buffer_load_dwordx4 v[168:171], v2, s[84:87], s20 offen sc1
s_waitcnt vmcnt(11)
v_mfma_f32_32x32x16_bf16 v[200:215], a[56:59], v[180:183], v[200:215]
v_mfma_f32_32x32x16_bf16 v[216:231], a[60:63], v[180:183], v[216:231]
buffer_load_dwordx4 v[172:175], v2, s[84:87], s20 offen offset:1024 sc1
buffer_load_dwordx4 v[32:35], v2, s[84:87], s21 offen offset:2048
s_waitcnt vmcnt(12)
v_mfma_f32_32x32x16_bf16 v[200:215], a[64:67], v[184:187], v[200:215]
v_mfma_f32_32x32x16_bf16 v[216:231], a[68:71], v[184:187], v[216:231]
buffer_load_dwordx4 v[176:179], v2, s[84:87], s20 offen offset:2048 sc1
s_waitcnt vmcnt(12)
v_mfma_f32_32x32x16_bf16 v[200:215], a[72:75], v[188:191], v[200:215]
v_mfma_f32_32x32x16_bf16 v[216:231], a[76:79], v[188:191], v[216:231]
buffer_load_dwordx4 v[180:183], v2, s[84:87], s20 offen offset:3072 sc1
s_waitcnt vmcnt(12)
v_mfma_f32_32x32x16_bf16 v[200:215], a[80:83], v[192:195], v[200:215]
v_mfma_f32_32x32x16_bf16 v[216:231], a[84:87], v[192:195], v[216:231]
s_add_u32 s20, s50, 20480
s_and_b32 s20, s20, 0x7fff
s_add_u32 s20, s20, s41
buffer_load_dwordx4 v[184:187], v2, s[84:87], s20 offen sc1
buffer_load_dwordx4 v[36:39], v2, s[84:87], s21 offen offset:3072
s_waitcnt vmcnt(13)
v_mfma_f32_32x32x16_bf16 v[200:215], a[88:91], v[196:199], v[200:215]
v_mfma_f32_32x32x16_bf16 v[216:231], a[92:95], v[196:199], v[216:231]
buffer_load_dwordx4 v[188:191], v2, s[84:87], s20 offen offset:1024 sc1
s_waitcnt vmcnt(12)
v_mfma_f32_32x32x16_bf16 v[200:215], a[96:99], v[152:155], v[200:215]
v_mfma_f32_32x32x16_bf16 v[216:231], a[100:103], v[152:155], v[216:231]
buffer_load_dwordx4 v[192:195], v2, s[84:87], s20 offen offset:2048 sc1
s_waitcnt vmcnt(12)
v_mfma_f32_32x32x16_bf16 v[200:215], a[104:107], v[156:159], v[200:215]
v_mfma_f32_32x32x16_bf16 v[216:231], a[108:111], v[156:159], v[216:231]
buffer_load_dwordx4 v[196:199], v2, s[84:87], s20 offen offset:3072 sc1
s_add_u32 s21, s26, 4096
buffer_load_dwordx4 v[40:43], v2, s[84:87], s21 offen
s_waitcnt vmcnt(13)
v_mfma_f32_32x32x16_bf16 v[200:215], a[112:115], v[160:163], v[200:215]
v_mfma_f32_32x32x16_bf16 v[216:231], a[116:119], v[160:163], v[216:231]
s_add_u32 s20, s50, 24576
s_and_b32 s20, s20, 0x7fff
s_add_u32 s20, s20, s41
buffer_load_dwordx4 v[152:155], v2, s[84:87], s20 offen sc1
s_waitcnt vmcnt(12)
v_mfma_f32_32x32x16_bf16 v[200:215], a[120:123], v[164:167], v[200:215]
v_mfma_f32_32x32x16_bf16 v[216:231], a[124:127], v[164:167], v[216:231]
buffer_load_dwordx4 v[156:159], v2, s[84:87], s20 offen offset:1024 sc1
s_waitcnt vmcnt(12)
v_mfma_f32_32x32x16_bf16 v[200:215], a[128:131], v[168:171], v[200:215]
v_mfma_f32_32x32x16_bf16 v[216:231], a[132:135], v[168:171], v[216:231]
buffer_load_dwordx4 v[160:163], v2, s[84:87], s20 offen offset:2048 sc1
buffer_load_dwordx4 v[44:47], v2, s[84:87], s21 offen offset:1024
s_waitcnt vmcnt(13)
v_mfma_f32_32x32x16_bf16 v[200:215], a[136:139], v[172:175], v[200:215]
v_mfma_f32_32x32x16_bf16 v[216:231], a[140:143], v[172:175], v[216:231]
buffer_load_dwordx4 v[164:167], v2, s[84:87], s20 offen offset:3072 sc1
s_waitcnt vmcnt(12)
v_mfma_f32_32x32x16_bf16 v[200:215], a[144:147], v[176:179], v[200:215]
v_mfma_f32_32x32x16_bf16 v[216:231], a[148:151], v[176:179], v[216:231]
s_add_u32 s20, s50, 28672
s_and_b32 s20, s20, 0x7fff
s_add_u32 s20, s20, s41
buffer_load_dwordx4 v[168:171], v2, s[84:87], s20 offen sc1
s_waitcnt vmcnt(12)
v_mfma_f32_32x32x16_bf16 v[200:215], a[152:155], v[180:183], v[200:215]
v_mfma_f32_32x32x16_bf16 v[216:231], a[156:159], v[180:183], v[216:231]
buffer_load_dwordx4 v[172:175], v2, s[84:87], s20 offen offset:1024 sc1
buffer_load_dwordx4 v[48:51], v2, s[84:87], s21 offen offset:2048
s_waitcnt vmcnt(13)
v_mfma_f32_32x32x16_bf16 v[200:215], a[160:163], v[184:187], v[200:215]
v_mfma_f32_32x32x16_bf16 v[216:231], a[164:167], v[184:187], v[216:231]
buffer_load_dwordx4 v[176:179], v2, s[84:87], s20 offen offset:2048 sc1
s_waitcnt vmcnt(12)
v_mfma_f32_32x32x16_bf16 v[200:215], a[168:171], v[188:191], v[200:215]
v_mfma_f32_32x32x16_bf16 v[216:231], a[172:175], v[188:191], v[216:231]
buffer_load_dwordx4 v[180:183], v2, s[84:87], s20 offen offset:3072 sc1
s_waitcnt vmcnt(12)
v_mfma_f32_32x32x16_bf16 v[200:215], a[176:179], v[192:195], v[200:215]
v_mfma_f32_32x32x16_bf16 v[216:231], a[180:183], v[192:195], v[216:231]
s_add_u32 s41, s41, 262144
s_add_u32 s20, s50, 0
s_and_b32 s20, s20, 0x7fff
s_add_u32 s20, s20, s41
buffer_load_dwordx4 v[184:187], v2, s[84:87], s20 offen sc1
buffer_load_dwordx4 v[52:55], v2, s[84:87], s21 offen offset:3072
s_waitcnt vmcnt(13)
v_mfma_f32_32x32x16_bf16 v[200:215], a[184:187], v[196:199], v[200:215]
v_mfma_f32_32x32x16_bf16 v[216:231], a[188:191], v[196:199], v[216:231]
buffer_load_dwordx4 v[188:191], v2, s[84:87], s20 offen offset:1024 sc1
s_waitcnt vmcnt(12)
v_mfma_f32_32x32x16_bf16 v[200:215], a[192:195], v[152:155], v[200:215]
v_mfma_f32_32x32x16_bf16 v[216:231], a[196:199], v[152:155], v[216:231]
buffer_load_dwordx4 v[192:195], v2, s[84:87], s20 offen offset:2048 sc1
s_waitcnt vmcnt(12)
v_mfma_f32_32x32x16_bf16 v[200:215], a[200:203], v[156:159], v[200:215]
v_mfma_f32_32x32x16_bf16 v[216:231], a[204:207], v[156:159], v[216:231]
buffer_load_dwordx4 v[196:199], v2, s[84:87], s20 offen offset:3072 sc1
s_add_u32 s21, s26, 16777216
buffer_load_dwordx4 v[56:59], v2, s[84:87], s21 offen
s_waitcnt vmcnt(13)
v_mfma_f32_32x32x16_bf16 v[200:215], a[208:211], v[160:163], v[200:215]
v_mfma_f32_32x32x16_bf16 v[216:231], a[212:215], v[160:163], v[216:231]
s_add_u32 s20, s50, 4096
s_and_b32 s20, s20, 0x7fff
s_add_u32 s20, s20, s41
buffer_load_dwordx4 v[152:155], v2, s[84:87], s20 offen sc1
s_waitcnt vmcnt(12)
v_mfma_f32_32x32x16_bf16 v[200:215], a[216:219], v[164:167], v[200:215]
v_mfma_f32_32x32x16_bf16 v[216:231], a[220:223], v[164:167], v[216:231]
buffer_load_dwordx4 v[156:159], v2, s[84:87], s20 offen offset:1024 sc1
s_waitcnt vmcnt(12)
v_mfma_f32_32x32x16_bf16 v[200:215], a[224:227], v[168:171], v[200:215]
v_mfma_f32_32x32x16_bf16 v[216:231], a[228:231], v[168:171], v[216:231]
buffer_load_dwordx4 v[160:163], v2, s[84:87], s20 offen offset:2048 sc1
buffer_load_dwordx4 v[60:63], v2, s[84:87], s21 offen offset:1024
s_waitcnt vmcnt(13)
v_mfma_f32_32x32x16_bf16 v[200:215], a[232:235], v[172:175], v[200:215]
v_mfma_f32_32x32x16_bf16 v[216:231], a[236:239], v[172:175], v[216:231]
buffer_load_dwordx4 v[164:167], v2, s[84:87], s20 offen offset:3072 sc1
s_waitcnt vmcnt(12)
v_mfma_f32_32x32x16_bf16 v[200:215], a[240:243], v[176:179], v[200:215]
v_mfma_f32_32x32x16_bf16 v[216:231], a[244:247], v[176:179], v[216:231]
s_add_u32 s20, s50, 8192
s_and_b32 s20, s20, 0x7fff
s_add_u32 s20, s20, s41
buffer_load_dwordx4 v[168:171], v2, s[84:87], s20 offen sc1
s_waitcnt vmcnt(12)
v_mfma_f32_32x32x16_bf16 v[200:215], a[248:251], v[180:183], v[200:215]
v_mfma_f32_32x32x16_bf16 v[216:231], a[252:255], v[180:183], v[216:231]
buffer_load_dwordx4 v[172:175], v2, s[84:87], s20 offen offset:1024 sc1
buffer_load_dwordx4 v[64:67], v2, s[84:87], s21 offen offset:2048
s_nop 11
ds_write_b128 v17, v[200:203]
ds_write_b128 v17, v[204:207] offset:1088
ds_write_b128 v17, v[208:211] offset:2176
ds_write_b128 v17, v[212:215] offset:3264
ds_write_b128 v17, v[216:219] offset:4352
ds_write_b128 v17, v[220:223] offset:5440
ds_write_b128 v17, v[224:227] offset:6528
ds_write_b128 v17, v[228:231] offset:7616
s_waitcnt vmcnt(13)
s_waitcnt lgkmcnt(0)
v_mfma_f32_32x32x16_bf16 v[200:215], a[0:3], v[184:187], 0
v_mfma_f32_32x32x16_bf16 v[216:231], a[4:7], v[184:187], 0
buffer_load_dwordx4 v[176:179], v2, s[84:87], s20 offen offset:2048 sc1
s_waitcnt vmcnt(12)
v_mfma_f32_32x32x16_bf16 v[200:215], a[8:11], v[188:191], v[200:215]
v_mfma_f32_32x32x16_bf16 v[216:231], a[12:15], v[188:191], v[216:231]
buffer_load_dwordx4 v[180:183], v2, s[84:87], s20 offen offset:3072 sc1
s_waitcnt vmcnt(12)
v_mfma_f32_32x32x16_bf16 v[200:215], a[16:19], v[192:195], v[200:215]
v_mfma_f32_32x32x16_bf16 v[216:231], a[20:23], v[192:195], v[216:231]
s_add_u32 s20, s50, 12288
s_and_b32 s20, s20, 0x7fff
s_add_u32 s20, s20, s41
buffer_load_dwordx4 v[184:187], v2, s[84:87], s20 offen sc1
buffer_load_dwordx4 v[68:71], v2, s[84:87], s21 offen offset:3072
s_waitcnt vmcnt(13)
v_mfma_f32_32x32x16_bf16 v[200:215], a[24:27], v[196:199], v[200:215]
v_mfma_f32_32x32x16_bf16 v[216:231], a[28:31], v[196:199], v[216:231]
buffer_load_dwordx4 v[188:191], v2, s[84:87], s20 offen offset:1024 sc1
s_waitcnt vmcnt(12)
v_mfma_f32_32x32x16_bf16 v[200:215], a[32:35], v[152:155], v[200:215]
v_mfma_f32_32x32x16_bf16 v[216:231], a[36:39], v[152:155], v[216:231]
buffer_load_dwordx4 v[192:195], v2, s[84:87], s20 offen offset:2048 sc1
s_waitcnt vmcnt(12)
v_mfma_f32_32x32x16_bf16 v[200:215], a[40:43], v[156:159], v[200:215]
v_mfma_f32_32x32x16_bf16 v[216:231], a[44:47], v[156:159], v[216:231]
buffer_load_dwordx4 v[196:199], v2, s[84:87], s20 offen offset:3072 sc1
s_add_u32 s21, s26, 16781312
buffer_load_dwordx4 v[72:75], v2, s[84:87], s21 offen
s_waitcnt vmcnt(13)
v_mfma_f32_32x32x16_bf16 v[200:215], a[48:51], v[160:163], v[200:215]
v_mfma_f32_32x32x16_bf16 v[216:231], a[52:55], v[160:163], v[216:231]
s_add_u32 s20, s50, 16384
s_and_b32 s20, s20, 0x7fff
s_add_u32 s20, s20, s41
buffer_load_dwordx4 v[152:155], v2, s[84:87], s20 offen sc1
s_waitcnt vmcnt(12)
v_mfma_f32_32x32x16_bf16 v[200:215], a[56:59], v[164:167], v[200:215]
v_mfma_f32_32x32x16_bf16 v[216:231], a[60:63], v[164:167], v[216:231]
buffer_load_dwordx4 v[156:159], v2, s[84:87], s20 offen offset:1024 sc1
s_waitcnt vmcnt(12)
v_mfma_f32_32x32x16_bf16 v[200:215], a[64:67], v[168:171], v[200:215]
v_mfma_f32_32x32x16_bf16 v[216:231], a[68:71], v[168:171], v[216:231]
buffer_load_dwordx4 v[160:163], v2, s[84:87], s20 offen offset:2048 sc1
buffer_load_dwordx4 v[76:79], v2, s[84:87], s21 offen offset:1024
s_waitcnt vmcnt(13)
v_mfma_f32_32x32x16_bf16 v[200:215], a[72:75], v[172:175], v[200:215]
v_mfma_f32_32x32x16_bf16 v[216:231], a[76:79], v[172:175], v[216:231]
buffer_load_dwordx4 v[164:167], v2, s[84:87], s20 offen offset:3072 sc1
s_waitcnt vmcnt(12)
v_mfma_f32_32x32x16_bf16 v[200:215], a[80:83], v[176:179], v[200:215]
v_mfma_f32_32x32x16_bf16 v[216:231], a[84:87], v[176:179], v[216:231]
s_add_u32 s20, s50, 20480
s_and_b32 s20, s20, 0x7fff
s_add_u32 s20, s20, s41
buffer_load_dwordx4 v[168:171], v2, s[84:87], s20 offen sc1
s_waitcnt vmcnt(12)
v_mfma_f32_32x32x16_bf16 v[200:215], a[88:91], v[180:183], v[200:215]
v_mfma_f32_32x32x16_bf16 v[216:231], a[92:95], v[180:183], v[216:231]
buffer_load_dwordx4 v[172:175], v2, s[84:87], s20 offen offset:1024 sc1
buffer_load_dwordx4 v[80:83], v2, s[84:87], s21 offen offset:2048
s_waitcnt vmcnt(13)
v_mfma_f32_32x32x16_bf16 v[200:215], a[96:99], v[184:187], v[200:215]
v_mfma_f32_32x32x16_bf16 v[216:231], a[100:103], v[184:187], v[216:231]
buffer_load_dwordx4 v[176:179], v2, s[84:87], s20 offen offset:2048 sc1
s_waitcnt vmcnt(12)
v_mfma_f32_32x32x16_bf16 v[200:215], a[104:107], v[188:191], v[200:215]
v_mfma_f32_32x32x16_bf16 v[216:231], a[108:111], v[188:191], v[216:231]
buffer_load_dwordx4 v[180:183], v2, s[84:87], s20 offen offset:3072 sc1
s_waitcnt vmcnt(12)
v_mfma_f32_32x32x16_bf16 v[200:215], a[112:115], v[192:195], v[200:215]
v_mfma_f32_32x32x16_bf16 v[216:231], a[116:119], v[192:195], v[216:231]
s_add_u32 s20, s50, 24576
s_and_b32 s20, s20, 0x7fff
s_add_u32 s20, s20, s41
buffer_load_dwordx4 v[184:187], v2, s[84:87], s20 offen sc1
buffer_load_dwordx4 v[84:87], v2, s[84:87], s21 offen offset:3072
s_waitcnt vmcnt(13)
v_mfma_f32_32x32x16_bf16 v[200:215], a[120:123], v[196:199], v[200:215]
v_mfma_f32_32x32x16_bf16 v[216:231], a[124:127], v[196:199], v[216:231]
buffer_load_dwordx4 v[188:191], v2, s[84:87], s20 offen offset:1024 sc1
s_waitcnt vmcnt(12)
v_mfma_f32_32x32x16_bf16 v[200:215], a[128:131], v[152:155], v[200:215]
v_mfma_f32_32x32x16_bf16 v[216:231], a[132:135], v[152:155], v[216:231]
buffer_load_dwordx4 v[192:195], v2, s[84:87], s20 offen offset:2048 sc1
s_waitcnt vmcnt(12)
v_mfma_f32_32x32x16_bf16 v[200:215], a[136:139], v[156:159], v[200:215]
v_mfma_f32_32x32x16_bf16 v[216:231], a[140:143], v[156:159], v[216:231]
buffer_load_dwordx4 v[196:199], v2, s[84:87], s20 offen offset:3072 sc1
s_add_u32 s21, s26, 33554432
buffer_load_dwordx4 v[88:91], v2, s[84:87], s21 offen
s_waitcnt vmcnt(13)
v_mfma_f32_32x32x16_bf16 v[200:215], a[144:147], v[160:163], v[200:215]
v_mfma_f32_32x32x16_bf16 v[216:231], a[148:151], v[160:163], v[216:231]
s_add_u32 s20, s50, 28672
s_and_b32 s20, s20, 0x7fff
s_add_u32 s20, s20, s41
buffer_load_dwordx4 v[152:155], v2, s[84:87], s20 offen sc1
s_waitcnt vmcnt(12)
v_mfma_f32_32x32x16_bf16 v[200:215], a[152:155], v[164:167], v[200:215]
v_mfma_f32_32x32x16_bf16 v[216:231], a[156:159], v[164:167], v[216:231]
buffer_load_dwordx4 v[156:159], v2, s[84:87], s20 offen offset:1024 sc1
s_waitcnt vmcnt(12)
v_mfma_f32_32x32x16_bf16 v[200:215], a[160:163], v[168:171], v[200:215]
v_mfma_f32_32x32x16_bf16 v[216:231], a[164:167], v[168:171], v[216:231]
buffer_load_dwordx4 v[160:163], v2, s[84:87], s20 offen offset:2048 sc1
buffer_load_dwordx4 v[92:95], v2, s[84:87], s21 offen offset:1024
s_waitcnt vmcnt(13)
v_mfma_f32_32x32x16_bf16 v[200:215], a[168:171], v[172:175], v[200:215]
v_mfma_f32_32x32x16_bf16 v[216:231], a[172:175], v[172:175], v[216:231]
buffer_load_dwordx4 v[164:167], v2, s[84:87], s20 offen offset:3072 sc1
s_waitcnt vmcnt(12)
v_mfma_f32_32x32x16_bf16 v[200:215], a[176:179], v[176:179], v[200:215]
v_mfma_f32_32x32x16_bf16 v[216:231], a[180:183], v[176:179], v[216:231]
s_add_u32 s41, s41, 262144
s_add_u32 s20, s50, 0
s_and_b32 s20, s20, 0x7fff
s_add_u32 s20, s20, s41
buffer_load_dwordx4 v[168:171], v2, s[84:87], s20 offen sc1
s_waitcnt vmcnt(12)
v_mfma_f32_32x32x16_bf16 v[200:215], a[184:187], v[180:183], v[200:215]
v_mfma_f32_32x32x16_bf16 v[216:231], a[188:191], v[180:183], v[216:231]
buffer_load_dwordx4 v[172:175], v2, s[84:87], s20 offen offset:1024 sc1
buffer_load_dwordx4 v[96:99], v2, s[84:87], s21 offen offset:2048
s_waitcnt vmcnt(13)
v_mfma_f32_32x32x16_bf16 v[200:215], a[192:195], v[184:187], v[200:215]
v_mfma_f32_32x32x16_bf16 v[216:231], a[196:199], v[184:187], v[216:231]
buffer_load_dwordx4 v[176:179], v2, s[84:87], s20 offen offset:2048 sc1
s_waitcnt vmcnt(12)
v_mfma_f32_32x32x16_bf16 v[200:215], a[200:203], v[188:191], v[200:215]
v_mfma_f32_32x32x16_bf16 v[216:231], a[204:207], v[188:191], v[216:231]
buffer_load_dwordx4 v[180:183], v2, s[84:87], s20 offen offset:3072 sc1
s_waitcnt vmcnt(12)
v_mfma_f32_32x32x16_bf16 v[200:215], a[208:211], v[192:195], v[200:215]
v_mfma_f32_32x32x16_bf16 v[216:231], a[212:215], v[192:195], v[216:231]
s_add_u32 s20, s50, 4096
s_and_b32 s20, s20, 0x7fff
s_add_u32 s20, s20, s41
buffer_load_dwordx4 v[184:187], v2, s[84:87], s20 offen sc1
buffer_load_dwordx4 v[100:103], v2, s[84:87], s21 offen offset:3072
s_waitcnt vmcnt(13)
v_mfma_f32_32x32x16_bf16 v[200:215], a[216:219], v[196:199], v[200:215]
v_mfma_f32_32x32x16_bf16 v[216:231], a[220:223], v[196:199], v[216:231]
buffer_load_dwordx4 v[188:191], v2, s[84:87], s20 offen offset:1024 sc1
s_waitcnt vmcnt(12)
v_mfma_f32_32x32x16_bf16 v[200:215], a[224:227], v[152:155], v[200:215]
v_mfma_f32_32x32x16_bf16 v[216:231], a[228:231], v[152:155], v[216:231]
buffer_load_dwordx4 v[192:195], v2, s[84:87], s20 offen offset:2048 sc1
s_waitcnt vmcnt(12)
v_mfma_f32_32x32x16_bf16 v[200:215], a[232:235], v[156:159], v[200:215]
v_mfma_f32_32x32x16_bf16 v[216:231], a[236:239], v[156:159], v[216:231]
buffer_load_dwordx4 v[196:199], v2, s[84:87], s20 offen offset:3072 sc1
s_add_u32 s21, s26, 33558528
buffer_load_dwordx4 v[104:107], v2, s[84:87], s21 offen
s_waitcnt vmcnt(13)
v_mfma_f32_32x32x16_bf16 v[200:215], a[240:243], v[160:163], v[200:215]
v_mfma_f32_32x32x16_bf16 v[216:231], a[244:247], v[160:163], v[216:231]
s_add_u32 s20, s50, 8192
s_and_b32 s20, s20, 0x7fff
s_add_u32 s20, s20, s41
buffer_load_dwordx4 v[152:155], v2, s[84:87], s20 offen sc1
s_waitcnt vmcnt(12)
v_mfma_f32_32x32x16_bf16 v[200:215], a[248:251], v[164:167], v[200:215]
v_mfma_f32_32x32x16_bf16 v[216:231], a[252:255], v[164:167], v[216:231]
buffer_load_dwordx4 v[156:159], v2, s[84:87], s20 offen offset:1024 sc1
s_nop 11
ds_write_b128 v17, v[200:203] offset:34816
ds_write_b128 v17, v[204:207] offset:35904
ds_write_b128 v17, v[208:211] offset:36992
ds_write_b128 v17, v[212:215] offset:38080
ds_write_b128 v17, v[216:219] offset:39168
ds_write_b128 v17, v[220:223] offset:40256
ds_write_b128 v17, v[224:227] offset:41344
ds_write_b128 v17, v[228:231] offset:42432
s_waitcnt vmcnt(12)
s_waitcnt lgkmcnt(0)
v_mfma_f32_32x32x16_bf16 v[200:215], a[0:3], v[168:171], 0
v_mfma_f32_32x32x16_bf16 v[216:231], a[4:7], v[168:171], 0
buffer_load_dwordx4 v[160:163], v2, s[84:87], s20 offen offset:2048 sc1
buffer_load_dwordx4 v[108:111], v2, s[84:87], s21 offen offset:1024
s_waitcnt vmcnt(13)
v_mfma_f32_32x32x16_bf16 v[200:215], a[8:11], v[172:175], v[200:215]
v_mfma_f32_32x32x16_bf16 v[216:231], a[12:15], v[172:175], v[216:231]
buffer_load_dwordx4 v[164:167], v2, s[84:87], s20 offen offset:3072 sc1
s_waitcnt vmcnt(12)
v_mfma_f32_32x32x16_bf16 v[200:215], a[16:19], v[176:179], v[200:215]
v_mfma_f32_32x32x16_bf16 v[216:231], a[20:23], v[176:179], v[216:231]
s_add_u32 s20, s50, 12288
s_and_b32 s20, s20, 0x7fff
s_add_u32 s20, s20, s41
buffer_load_dwordx4 v[168:171], v2, s[84:87], s20 offen sc1
s_waitcnt vmcnt(12)
v_mfma_f32_32x32x16_bf16 v[200:215], a[24:27], v[180:183], v[200:215]
v_mfma_f32_32x32x16_bf16 v[216:231], a[28:31], v[180:183], v[216:231]
buffer_load_dwordx4 v[172:175], v2, s[84:87], s20 offen offset:1024 sc1
buffer_load_dwordx4 v[112:115], v2, s[84:87], s21 offen offset:2048
s_waitcnt vmcnt(13)
v_mfma_f32_32x32x16_bf16 v[200:215], a[32:35], v[184:187], v[200:215]
v_mfma_f32_32x32x16_bf16 v[216:231], a[36:39], v[184:187], v[216:231]
buffer_load_dwordx4 v[176:179], v2, s[84:87], s20 offen offset:2048 sc1
s_waitcnt vmcnt(12)
v_mfma_f32_32x32x16_bf16 v[200:215], a[40:43], v[188:191], v[200:215]
v_mfma_f32_32x32x16_bf16 v[216:231], a[44:47], v[188:191], v[216:231]
buffer_load_dwordx4 v[180:183], v2, s[84:87], s20 offen offset:3072 sc1
s_waitcnt vmcnt(12)
v_mfma_f32_32x32x16_bf16 v[200:215], a[48:51], v[192:195], v[200:215]
v_mfma_f32_32x32x16_bf16 v[216:231], a[52:55], v[192:195], v[216:231]
s_add_u32 s20, s50, 16384
s_and_b32 s20, s20, 0x7fff
s_add_u32 s20, s20, s41
buffer_load_dwordx4 v[184:187], v2, s[84:87], s20 offen sc1
buffer_load_dwordx4 v[116:119], v2, s[84:87], s21 offen offset:3072
s_waitcnt vmcnt(13)
v_mfma_f32_32x32x16_bf16 v[200:215], a[56:59], v[196:199], v[200:215]
v_mfma_f32_32x32x16_bf16 v[216:231], a[60:63], v[196:199], v[216:231]
buffer_load_dwordx4 v[188:191], v2, s[84:87], s20 offen offset:1024 sc1
s_waitcnt vmcnt(12)
v_mfma_f32_32x32x16_bf16 v[200:215], a[64:67], v[152:155], v[200:215]
v_mfma_f32_32x32x16_bf16 v[216:231], a[68:71], v[152:155], v[216:231]
buffer_load_dwordx4 v[192:195], v2, s[84:87], s20 offen offset:2048 sc1
s_waitcnt vmcnt(12)
v_mfma_f32_32x32x16_bf16 v[200:215], a[72:75], v[156:159], v[200:215]
v_mfma_f32_32x32x16_bf16 v[216:231], a[76:79], v[156:159], v[216:231]
buffer_load_dwordx4 v[196:199], v2, s[84:87], s20 offen offset:3072 sc1
s_add_u32 s21, s26, 178257920
buffer_load_dwordx4 v[120:123], v6, s[84:87], s21 offen sc1
s_waitcnt vmcnt(13)
v_mfma_f32_32x32x16_bf16 v[200:215], a[80:83], v[160:163], v[200:215]
v_mfma_f32_32x32x16_bf16 v[216:231], a[84:87], v[160:163], v[216:231]
s_add_u32 s20, s50, 20480
s_and_b32 s20, s20, 0x7fff
s_add_u32 s20, s20, s41
buffer_load_dwordx4 v[152:155], v2, s[84:87], s20 offen sc1
s_waitcnt vmcnt(12)
v_mfma_f32_32x32x16_bf16 v[200:215], a[88:91], v[164:167], v[200:215]
v_mfma_f32_32x32x16_bf16 v[216:231], a[92:95], v[164:167], v[216:231]
buffer_load_dwordx4 v[156:159], v2, s[84:87], s20 offen offset:1024 sc1
s_waitcnt vmcnt(12)
v_mfma_f32_32x32x16_bf16 v[200:215], a[96:99], v[168:171], v[200:215]
v_mfma_f32_32x32x16_bf16 v[216:231], a[100:103], v[168:171], v[216:231]
buffer_load_dwordx4 v[160:163], v2, s[84:87], s20 offen offset:2048 sc1
buffer_load_dwordx4 v[124:127], v6, s[84:87], s21 offen offset:64 sc1
s_waitcnt vmcnt(13)
v_mfma_f32_32x32x16_bf16 v[200:215], a[104:107], v[172:175], v[200:215]
v_mfma_f32_32x32x16_bf16 v[216:231], a[108:111], v[172:175], v[216:231]
buffer_load_dwordx4 v[164:167], v2, s[84:87], s20 offen offset:3072 sc1
s_waitcnt vmcnt(12)
v_mfma_f32_32x32x16_bf16 v[200:215], a[112:115], v[176:179], v[200:215]
v_mfma_f32_32x32x16_bf16 v[216:231], a[116:119], v[176:179], v[216:231]
s_add_u32 s20, s50, 24576
s_and_b32 s20, s20, 0x7fff
s_add_u32 s20, s20, s41
buffer_load_dwordx4 v[168:171], v2, s[84:87], s20 offen sc1
s_waitcnt vmcnt(12)
v_mfma_f32_32x32x16_bf16 v[200:215], a[120:123], v[180:183], v[200:215]
v_mfma_f32_32x32x16_bf16 v[216:231], a[124:127], v[180:183], v[216:231]
buffer_load_dwordx4 v[172:175], v2, s[84:87], s20 offen offset:1024 sc1
buffer_load_dwordx4 v[128:131], v6, s[84:87], s21 offen offset:128 sc1
s_waitcnt vmcnt(13)
v_mfma_f32_32x32x16_bf16 v[200:215], a[128:131], v[184:187], v[200:215]
v_mfma_f32_32x32x16_bf16 v[216:231], a[132:135], v[184:187], v[216:231]
buffer_load_dwordx4 v[176:179], v2, s[84:87], s20 offen offset:2048 sc1
s_waitcnt vmcnt(12)
v_mfma_f32_32x32x16_bf16 v[200:215], a[136:139], v[188:191], v[200:215]
v_mfma_f32_32x32x16_bf16 v[216:231], a[140:143], v[188:191], v[216:231]
buffer_load_dwordx4 v[180:183], v2, s[84:87], s20 offen offset:3072 sc1
s_waitcnt vmcnt(12)
v_mfma_f32_32x32x16_bf16 v[200:215], a[144:147], v[192:195], v[200:215]
v_mfma_f32_32x32x16_bf16 v[216:231], a[148:151], v[192:195], v[216:231]
s_add_u32 s20, s50, 28672
s_and_b32 s20, s20, 0x7fff
s_add_u32 s20, s20, s41
buffer_load_dwordx4 v[184:187], v2, s[84:87], s20 offen sc1
buffer_load_dwordx4 v[132:135], v6, s[84:87], s21 offen offset:192 sc1
s_waitcnt vmcnt(13)
v_mfma_f32_32x32x16_bf16 v[200:215], a[152:155], v[196:199], v[200:215]
v_mfma_f32_32x32x16_bf16 v[216:231], a[156:159], v[196:199], v[216:231]
buffer_load_dwordx4 v[188:191], v2, s[84:87], s20 offen offset:1024 sc1
s_waitcnt vmcnt(12)
v_mfma_f32_32x32x16_bf16 v[200:215], a[160:163], v[152:155], v[200:215]
v_mfma_f32_32x32x16_bf16 v[216:231], a[164:167], v[152:155], v[216:231]
buffer_load_dwordx4 v[192:195], v2, s[84:87], s20 offen offset:2048 sc1
s_waitcnt vmcnt(12)
v_mfma_f32_32x32x16_bf16 v[200:215], a[168:171], v[156:159], v[200:215]
v_mfma_f32_32x32x16_bf16 v[216:231], a[172:175], v[156:159], v[216:231]
buffer_load_dwordx4 v[196:199], v2, s[84:87], s20 offen offset:3072 sc1
s_add_u32 s21, s26, 178259968
buffer_load_dwordx2 v[136:137], v7, s[84:87], s21 offen sc1
s_waitcnt vmcnt(13)
v_mfma_f32_32x32x16_bf16 v[200:215], a[176:179], v[160:163], v[200:215]
v_mfma_f32_32x32x16_bf16 v[216:231], a[180:183], v[160:163], v[216:231]
s_add_u32 s41, s41, 262144
s_add_u32 s20, s50, 0
s_and_b32 s20, s20, 0x7fff
s_add_u32 s20, s20, s41
buffer_load_dwordx4 v[152:155], v2, s[84:87], s20 offen sc1
s_waitcnt vmcnt(12)
v_mfma_f32_32x32x16_bf16 v[200:215], a[184:187], v[164:167], v[200:215]
v_mfma_f32_32x32x16_bf16 v[216:231], a[188:191], v[164:167], v[216:231]
buffer_load_dwordx4 v[156:159], v2, s[84:87], s20 offen offset:1024 sc1
s_waitcnt vmcnt(12)
v_mfma_f32_32x32x16_bf16 v[200:215], a[192:195], v[168:171], v[200:215]
v_mfma_f32_32x32x16_bf16 v[216:231], a[196:199], v[168:171], v[216:231]
buffer_load_dwordx4 v[160:163], v2, s[84:87], s20 offen offset:2048 sc1
buffer_load_dwordx2 v[138:139], v7, s[84:87], s21 offen offset:2048 sc1
s_waitcnt vmcnt(13)
v_mfma_f32_32x32x16_bf16 v[200:215], a[200:203], v[172:175], v[200:215]
v_mfma_f32_32x32x16_bf16 v[216:231], a[204:207], v[172:175], v[216:231]
buffer_load_dwordx4 v[164:167], v2, s[84:87], s20 offen offset:3072 sc1
s_waitcnt vmcnt(12)
v_mfma_f32_32x32x16_bf16 v[200:215], a[208:211], v[176:179], v[200:215]
v_mfma_f32_32x32x16_bf16 v[216:231], a[212:215], v[176:179], v[216:231]
s_add_u32 s20, s50, 4096
s_and_b32 s20, s20, 0x7fff
s_add_u32 s20, s20, s41
buffer_load_dwordx4 v[168:171], v2, s[84:87], s20 offen sc1
s_waitcnt vmcnt(12)
v_mfma_f32_32x32x16_bf16 v[200:215], a[216:219], v[180:183], v[200:215]
v_mfma_f32_32x32x16_bf16 v[216:231], a[220:223], v[180:183], v[216:231]
buffer_load_dwordx4 v[172:175], v2, s[84:87], s20 offen offset:1024 sc1
buffer_load_dwordx2 v[140:141], v7, s[84:87], s21 offen offset:512 sc1
s_waitcnt vmcnt(13)
v_mfma_f32_32x32x16_bf16 v[200:215], a[224:227], v[184:187], v[200:215]
v_mfma_f32_32x32x16_bf16 v[216:231], a[228:231], v[184:187], v[216:231]
buffer_load_dwordx4 v[176:179], v2, s[84:87], s20 offen offset:2048 sc1
s_waitcnt vmcnt(12)
v_mfma_f32_32x32x16_bf16 v[200:215], a[232:235], v[188:191], v[200:215]
v_mfma_f32_32x32x16_bf16 v[216:231], a[236:239], v[188:191], v[216:231]
buffer_load_dwordx4 v[180:183], v2, s[84:87], s20 offen offset:3072 sc1
s_waitcnt vmcnt(12)
v_mfma_f32_32x32x16_bf16 v[200:215], a[240:243], v[192:195], v[200:215]
v_mfma_f32_32x32x16_bf16 v[216:231], a[244:247], v[192:195], v[216:231]
s_add_u32 s20, s50, 8192
s_and_b32 s20, s20, 0x7fff
s_add_u32 s20, s20, s41
buffer_load_dwordx4 v[184:187], v2, s[84:87], s20 offen sc1
buffer_load_dwordx2 v[142:143], v7, s[84:87], s21 offen offset:2560 sc1
s_waitcnt vmcnt(13)
v_mfma_f32_32x32x16_bf16 v[200:215], a[248:251], v[196:199], v[200:215]
v_mfma_f32_32x32x16_bf16 v[216:231], a[252:255], v[196:199], v[216:231]
buffer_load_dwordx4 v[188:191], v2, s[84:87], s20 offen offset:1024 sc1
v_add_u32 v5, 69632, v17
s_nop 11
ds_write_b128 v5, v[200:203]
ds_write_b128 v5, v[204:207] offset:1088
ds_write_b128 v5, v[208:211] offset:2176
ds_write_b128 v5, v[212:215] offset:3264
ds_write_b128 v5, v[216:219] offset:4352
ds_write_b128 v5, v[220:223] offset:5440
ds_write_b128 v5, v[224:227] offset:6528
ds_write_b128 v5, v[228:231] offset:7616
s_waitcnt vmcnt(12)
s_waitcnt lgkmcnt(0)
v_mfma_f32_32x32x16_bf16 v[200:215], a[0:3], v[152:155], 0
v_mfma_f32_32x32x16_bf16 v[216:231], a[4:7], v[152:155], 0
buffer_load_dwordx4 v[192:195], v2, s[84:87], s20 offen offset:2048 sc1
s_waitcnt vmcnt(12)
v_mfma_f32_32x32x16_bf16 v[200:215], a[8:11], v[156:159], v[200:215]
v_mfma_f32_32x32x16_bf16 v[216:231], a[12:15], v[156:159], v[216:231]
buffer_load_dwordx4 v[196:199], v2, s[84:87], s20 offen offset:3072 sc1
buffer_load_dwordx2 v[144:145], v7, s[84:87], s21 offen offset:1024 sc1
s_waitcnt vmcnt(13)
v_mfma_f32_32x32x16_bf16 v[200:215], a[16:19], v[160:163], v[200:215]
v_mfma_f32_32x32x16_bf16 v[216:231], a[20:23], v[160:163], v[216:231]
s_add_u32 s20, s50, 12288
s_and_b32 s20, s20, 0x7fff
s_add_u32 s20, s20, s41
buffer_load_dwordx4 v[152:155], v2, s[84:87], s20 offen sc1
s_waitcnt vmcnt(12)
v_mfma_f32_32x32x16_bf16 v[200:215], a[24:27], v[164:167], v[200:215]
v_mfma_f32_32x32x16_bf16 v[216:231], a[28:31], v[164:167], v[216:231]
buffer_load_dwordx4 v[156:159], v2, s[84:87], s20 offen offset:1024 sc1
s_waitcnt vmcnt(12)
v_mfma_f32_32x32x16_bf16 v[200:215], a[32:35], v[168:171], v[200:215]
v_mfma_f32_32x32x16_bf16 v[216:231], a[36:39], v[168:171], v[216:231]
buffer_load_dwordx4 v[160:163], v2, s[84:87], s20 offen offset:2048 sc1
buffer_load_dwordx2 v[146:147], v7, s[84:87], s21 offen offset:3072 sc1
s_waitcnt vmcnt(13)
v_mfma_f32_32x32x16_bf16 v[200:215], a[40:43], v[172:175], v[200:215]
v_mfma_f32_32x32x16_bf16 v[216:231], a[44:47], v[172:175], v[216:231]
buffer_load_dwordx4 v[164:167], v2, s[84:87], s20 offen offset:3072 sc1
s_waitcnt vmcnt(12)
v_mfma_f32_32x32x16_bf16 v[200:215], a[48:51], v[176:179], v[200:215]
v_mfma_f32_32x32x16_bf16 v[216:231], a[52:55], v[176:179], v[216:231]
s_add_u32 s20, s50, 16384
s_and_b32 s20, s20, 0x7fff
s_add_u32 s20, s20, s41
buffer_load_dwordx4 v[168:171], v2, s[84:87], s20 offen sc1
s_waitcnt vmcnt(12)
v_mfma_f32_32x32x16_bf16 v[200:215], a[56:59], v[180:183], v[200:215]
v_mfma_f32_32x32x16_bf16 v[216:231], a[60:63], v[180:183], v[216:231]
buffer_load_dwordx4 v[172:175], v2, s[84:87], s20 offen offset:1024 sc1
buffer_load_dwordx2 v[148:149], v7, s[84:87], s21 offen offset:1536 sc1
s_waitcnt vmcnt(13)
v_mfma_f32_32x32x16_bf16 v[200:215], a[64:67], v[184:187], v[200:215]
v_mfma_f32_32x32x16_bf16 v[216:231], a[68:71], v[184:187], v[216:231]
buffer_load_dwordx4 v[176:179], v2, s[84:87], s20 offen offset:2048 sc1
s_waitcnt vmcnt(12)
v_mfma_f32_32x32x16_bf16 v[200:215], a[72:75], v[188:191], v[200:215]
v_mfma_f32_32x32x16_bf16 v[216:231], a[76:79], v[188:191], v[216:231]
buffer_load_dwordx4 v[180:183], v2, s[84:87], s20 offen offset:3072 sc1
s_waitcnt vmcnt(12)
v_mfma_f32_32x32x16_bf16 v[200:215], a[80:83], v[192:195], v[200:215]
v_mfma_f32_32x32x16_bf16 v[216:231], a[84:87], v[192:195], v[216:231]
s_add_u32 s20, s50, 20480
s_and_b32 s20, s20, 0x7fff
s_add_u32 s20, s20, s41
buffer_load_dwordx4 v[184:187], v2, s[84:87], s20 offen sc1
buffer_load_dwordx2 v[150:151], v7, s[84:87], s21 offen offset:3584 sc1
s_waitcnt vmcnt(13)
v_mfma_f32_32x32x16_bf16 v[200:215], a[88:91], v[196:199], v[200:215]
v_mfma_f32_32x32x16_bf16 v[216:231], a[92:95], v[196:199], v[216:231]
buffer_load_dwordx4 v[188:191], v2, s[84:87], s20 offen offset:1024 sc1
s_waitcnt vmcnt(12)
v_mfma_f32_32x32x16_bf16 v[200:215], a[96:99], v[152:155], v[200:215]
v_mfma_f32_32x32x16_bf16 v[216:231], a[100:103], v[152:155], v[216:231]
buffer_load_dwordx4 v[192:195], v2, s[84:87], s20 offen offset:2048 sc1
s_waitcnt vmcnt(12)
v_mfma_f32_32x32x16_bf16 v[200:215], a[104:107], v[156:159], v[200:215]
v_mfma_f32_32x32x16_bf16 v[216:231], a[108:111], v[156:159], v[216:231]
buffer_load_dwordx4 v[196:199], v2, s[84:87], s20 offen offset:3072 sc1
s_waitcnt vmcnt(12)
v_mfma_f32_32x32x16_bf16 v[200:215], a[112:115], v[160:163], v[200:215]
v_mfma_f32_32x32x16_bf16 v[216:231], a[116:119], v[160:163], v[216:231]
s_add_u32 s20, s50, 24576
s_and_b32 s20, s20, 0x7fff
s_add_u32 s20, s20, s41
buffer_load_dwordx4 v[152:155], v2, s[84:87], s20 offen sc1
s_waitcnt vmcnt(11)
v_mfma_f32_32x32x16_bf16 v[200:215], a[120:123], v[164:167], v[200:215]
v_mfma_f32_32x32x16_bf16 v[216:231], a[124:127], v[164:167], v[216:231]
buffer_load_dwordx4 v[156:159], v2, s[84:87], s20 offen offset:1024 sc1
s_waitcnt vmcnt(11)
v_mfma_f32_32x32x16_bf16 v[200:215], a[128:131], v[168:171], v[200:215]
v_mfma_f32_32x32x16_bf16 v[216:231], a[132:135], v[168:171], v[216:231]
buffer_load_dwordx4 v[160:163], v2, s[84:87], s20 offen offset:2048 sc1
s_waitcnt vmcnt(11)
v_mfma_f32_32x32x16_bf16 v[200:215], a[136:139], v[172:175], v[200:215]
v_mfma_f32_32x32x16_bf16 v[216:231], a[140:143], v[172:175], v[216:231]
buffer_load_dwordx4 v[164:167], v2, s[84:87], s20 offen offset:3072 sc1
s_waitcnt vmcnt(10)
v_mfma_f32_32x32x16_bf16 v[200:215], a[144:147], v[176:179], v[200:215]
v_mfma_f32_32x32x16_bf16 v[216:231], a[148:151], v[176:179], v[216:231]
s_add_u32 s20, s50, 28672
s_and_b32 s20, s20, 0x7fff
s_add_u32 s20, s20, s41
buffer_load_dwordx4 v[168:171], v2, s[84:87], s20 offen sc1
s_waitcnt vmcnt(10)
v_mfma_f32_32x32x16_bf16 v[200:215], a[152:155], v[180:183], v[200:215]
v_mfma_f32_32x32x16_bf16 v[216:231], a[156:159], v[180:183], v[216:231]
buffer_load_dwordx4 v[172:175], v2, s[84:87], s20 offen offset:1024 sc1
s_waitcnt vmcnt(10)
v_mfma_f32_32x32x16_bf16 v[200:215], a[160:163], v[184:187], v[200:215]
v_mfma_f32_32x32x16_bf16 v[216:231], a[164:167], v[184:187], v[216:231]
buffer_load_dwordx4 v[176:179], v2, s[84:87], s20 offen offset:2048 sc1
s_waitcnt vmcnt(9)
v_mfma_f32_32x32x16_bf16 v[200:215], a[168:171], v[188:191], v[200:215]
v_mfma_f32_32x32x16_bf16 v[216:231], a[172:175], v[188:191], v[216:231]
buffer_load_dwordx4 v[180:183], v2, s[84:87], s20 offen offset:3072 sc1
s_waitcnt vmcnt(9)
v_mfma_f32_32x32x16_bf16 v[200:215], a[176:179], v[192:195], v[200:215]
v_mfma_f32_32x32x16_bf16 v[216:231], a[180:183], v[192:195], v[216:231]
s_waitcnt vmcnt(8)
v_mfma_f32_32x32x16_bf16 v[200:215], a[184:187], v[196:199], v[200:215]
v_mfma_f32_32x32x16_bf16 v[216:231], a[188:191], v[196:199], v[216:231]
s_waitcnt vmcnt(7)
v_mfma_f32_32x32x16_bf16 v[200:215], a[192:195], v[152:155], v[200:215]
v_mfma_f32_32x32x16_bf16 v[216:231], a[196:199], v[152:155], v[216:231]
s_waitcnt vmcnt(6)
v_mfma_f32_32x32x16_bf16 v[200:215], a[200:203], v[156:159], v[200:215]
v_mfma_f32_32x32x16_bf16 v[216:231], a[204:207], v[156:159], v[216:231]
s_waitcnt vmcnt(5)
v_mfma_f32_32x32x16_bf16 v[200:215], a[208:211], v[160:163], v[200:215]
v_mfma_f32_32x32x16_bf16 v[216:231], a[212:215], v[160:163], v[216:231]
s_waitcnt vmcnt(4)
v_mfma_f32_32x32x16_bf16 v[200:215], a[216:219], v[164:167], v[200:215]
v_mfma_f32_32x32x16_bf16 v[216:231], a[220:223], v[164:167], v[216:231]
s_waitcnt vmcnt(3)
v_mfma_f32_32x32x16_bf16 v[200:215], a[224:227], v[168:171], v[200:215]
v_mfma_f32_32x32x16_bf16 v[216:231], a[228:231], v[168:171], v[216:231]
s_waitcnt vmcnt(2)
v_mfma_f32_32x32x16_bf16 v[200:215], a[232:235], v[172:175], v[200:215]
v_mfma_f32_32x32x16_bf16 v[216:231], a[236:239], v[172:175], v[216:231]
s_waitcnt vmcnt(1)
v_mfma_f32_32x32x16_bf16 v[200:215], a[240:243], v[176:179], v[200:215]
v_mfma_f32_32x32x16_bf16 v[216:231], a[244:247], v[176:179], v[216:231]
s_waitcnt vmcnt(0)
v_mfma_f32_32x32x16_bf16 v[200:215], a[248:251], v[180:183], v[200:215]
v_mfma_f32_32x32x16_bf16 v[216:231], a[252:255], v[180:183], v[216:231]
s_nop 11
ds_write_b128 v5, v[200:203] offset:34816
ds_write_b128 v5, v[204:207] offset:35904
ds_write_b128 v5, v[208:211] offset:36992
ds_write_b128 v5, v[212:215] offset:38080
ds_write_b128 v5, v[216:219] offset:39168
ds_write_b128 v5, v[220:223] offset:40256
ds_write_b128 v5, v[224:227] offset:41344
ds_write_b128 v5, v[228:231] offset:42432
v_mov_b32 v3, v252
v_mov_b32 v4, s45
s_waitcnt lgkmcnt(0)
v_mov_b32 v5, v16
s_barrier
ds_read_b128 v[152:155], v3
ds_read_b128 v[156:159], v3 offset:8704
ds_read_b128 v[160:163], v3 offset:17408
ds_read_b128 v[164:167], v3 offset:26112
ds_read_b128 v[168:171], v3 offset:34816
ds_read_b128 v[172:175], v3 offset:43520
ds_read_b128 v[176:179], v3 offset:52224
ds_read_b128 v[180:183], v3 offset:60928
v_add_u32 v3, 69632, v3
ds_read_b128 v[184:187], v3
ds_read_b128 v[188:191], v3 offset:8704
ds_read_b128 v[192:195], v3 offset:17408
ds_read_b128 v[196:199], v3 offset:26112
s_waitcnt lgkmcnt(8)
v_pk_add_f32 v[152:153], v[152:153], v[156:157]
v_pk_add_f32 v[154:155], v[154:155], v[158:159]
v_pk_add_f32 v[160:161], v[160:161], v[164:165]
v_pk_add_f32 v[162:163], v[162:163], v[166:167]
v_pk_add_f32 v[152:153], v[152:153], v[160:161]
v_pk_add_f32 v[154:155], v[154:155], v[162:163]
ds_read_b128 v[200:203], v3 offset:34816
ds_read_b128 v[204:207], v3 offset:43520
ds_read_b128 v[208:211], v3 offset:52224
ds_read_b128 v[212:215], v3 offset:60928
s_waitcnt lgkmcnt(8)
v_pk_add_f32 v[168:169], v[168:169], v[172:173]
v_pk_add_f32 v[170:171], v[170:171], v[174:175]
v_pk_add_f32 v[176:177], v[176:177], v[180:181]
v_pk_add_f32 v[178:179], v[178:179], v[182:183]
v_pk_add_f32 v[168:169], v[168:169], v[176:177]
v_pk_add_f32 v[170:171], v[170:171], v[178:179]
s_waitcnt lgkmcnt(4)
v_pk_add_f32 v[184:185], v[184:185], v[188:189]
v_pk_add_f32 v[186:187], v[186:187], v[190:191]
v_pk_add_f32 v[192:193], v[192:193], v[196:197]
v_pk_add_f32 v[194:195], v[194:195], v[198:199]
v_pk_add_f32 v[184:185], v[184:185], v[192:193]
v_pk_add_f32 v[186:187], v[186:187], v[194:195]
s_waitcnt lgkmcnt(0)
v_pk_add_f32 v[200:201], v[200:201], v[204:205]
v_pk_add_f32 v[202:203], v[202:203], v[206:207]
v_pk_add_f32 v[208:209], v[208:209], v[212:213]
v_pk_add_f32 v[210:211], v[210:211], v[214:215]
v_pk_add_f32 v[200:201], v[200:201], v[208:209]
v_pk_add_f32 v[202:203], v[202:203], v[210:211]
s_add_u32 s48, s9, 0
s_add_u32 s49, s9, 4096
s_add_u32 s27, s9, 8192
s_add_u32 s28, s9, 12288
s_cmp_eq_u32 s96, 1
s_cbranch_scc1 L_x_st_13f
buffer_store_dwordx4 v[152:155], v19, s[84:87], s48 offen sc1
buffer_store_dwordx4 v[168:171], v19, s[84:87], s49 offen sc1
buffer_store_dwordx4 v[184:187], v19, s[84:87], s27 offen sc1
buffer_store_dwordx4 v[200:203], v19, s[84:87], s28 offen sc1
s_branch L_x_st_13d
L_x_st_13f:
buffer_store_dwordx4 v[152:155], v19, s[84:87], s48 offen
buffer_store_dwordx4 v[168:171], v19, s[84:87], s49 offen
buffer_store_dwordx4 v[184:187], v19, s[84:87], s27 offen
buffer_store_dwordx4 v[200:203], v19, s[84:87], s28 offen
L_x_st_13d:
ds_read_b128 v[216:219], v5
ds_read_b128 v[220:223], v5 offset:8704
ds_read_b128 v[224:227], v5 offset:17408
ds_read_b128 v[228:231], v5 offset:26112
s_waitcnt lgkmcnt(0)
v_pk_add_f32 v[216:217], v[216:217], v[220:221]
v_pk_add_f32 v[218:219], v[218:219], v[222:223]
v_pk_add_f32 v[224:225], v[224:225], v[228:229]
v_pk_add_f32 v[226:227], v[226:227], v[230:231]
v_pk_add_f32 v[232:233], v[216:217], v[224:225]
v_pk_add_f32 v[234:235], v[218:219], v[226:227]
ds_read_b128 v[216:219], v5 offset:34816
ds_read_b128 v[220:223], v5 offset:43520
ds_read_b128 v[224:227], v5 offset:52224
ds_read_b128 v[228:231], v5 offset:60928
s_waitcnt lgkmcnt(0)
v_pk_add_f32 v[216:217], v[216:217], v[220:221]
v_pk_add_f32 v[218:219], v[218:219], v[222:223]
v_pk_add_f32 v[224:225], v[224:225], v[228:229]
v_pk_add_f32 v[226:227], v[226:227], v[230:231]
v_pk_add_f32 v[236:237], v[216:217], v[224:225]
v_pk_add_f32 v[238:239], v[218:219], v[226:227]
v_add_u32 v5, 69632, v5
ds_read_b128 v[216:219], v5
ds_read_b128 v[220:223], v5 offset:8704
ds_read_b128 v[224:227], v5 offset:17408
ds_read_b128 v[228:231], v5 offset:26112
s_waitcnt lgkmcnt(0)
v_pk_add_f32 v[216:217], v[216:217], v[220:221]
v_pk_add_f32 v[218:219], v[218:219], v[222:223]
v_pk_add_f32 v[224:225], v[224:225], v[228:229]
v_pk_add_f32 v[226:227], v[226:227], v[230:231]
v_pk_add_f32 v[240:241], v[216:217], v[224:225]
v_pk_add_f32 v[242:243], v[218:219], v[226:227]
ds_read_b128 v[216:219], v5 offset:34816
ds_read_b128 v[220:223], v5 offset:43520
ds_read_b128 v[224:227], v5 offset:52224
ds_read_b128 v[228:231], v5 offset:60928
s_waitcnt lgkmcnt(0)
v_pk_add_f32 v[216:217], v[216:217], v[220:221]
v_pk_add_f32 v[218:219], v[218:219], v[222:223]
v_pk_add_f32 v[224:225], v[224:225], v[228:229]
v_pk_add_f32 v[226:227], v[226:227], v[230:231]
v_pk_add_f32 v[244:245], v[216:217], v[224:225]
v_pk_add_f32 v[246:247], v[218:219], v[226:227]
s_waitcnt vmcnt(0)
s_barrier
s_cmp_eq_u32 s96, 1
s_cbranch_scc1 L_x_st_14f
buffer_store_dword v4, v15, s[84:87], 0 offen offset:64 sc1
s_branch L_x_st_14d
L_x_st_14f:
buffer_store_dword v4, v15, s[84:87], 0 offen offset:64
L_x_st_14d:
L_x_pfa:
buffer_load_dword v3, v251, s[84:87], 0 offen offset:64 sc1
s_waitcnt vmcnt(0)
v_cmp_gt_u32 vcc, s45, v3
s_cbranch_vccnz L_x_pfa
buffer_load_dwordx4 v[216:219], v19, s[84:87], s10 offen sc1
s_add_u32 s10, s10, 4096
buffer_load_dwordx4 v[220:223], v19, s[84:87], s10 offen sc1
s_add_u32 s10, s10, 4096
buffer_load_dwordx4 v[224:227], v19, s[84:87], s10 offen sc1
s_add_u32 s10, s10, 4096
buffer_load_dwordx4 v[228:231], v19, s[84:87], s10 offen sc1
s_waitcnt vmcnt(3)
v_pk_add_f32 v[216:217], v[216:217], v[232:233]
v_pk_add_f32 v[218:219], v[218:219], v[234:235]
v_cvt_pk_bf16_f32 v216, v216, v217
v_cvt_pk_bf16_f32 v217, v218, v219
buffer_store_dwordx2 v[216:217], v18, s[12:15], s42 offen
s_add_u32 s42, s42, 131072
s_waitcnt vmcnt(3)
v_pk_add_f32 v[220:221], v[220:221], v[236:237]
v_pk_add_f32 v[222:223], v[222:223], v[238:239]
v_cvt_pk_bf16_f32 v220, v220, v221
v_cvt_pk_bf16_f32 v221, v222, v223
buffer_store_dwordx2 v[220:221], v18, s[12:15], s42 offen
s_add_u32 s42, s42, 131072
s_waitcnt vmcnt(3)
v_pk_add_f32 v[224:225], v[224:225], v[240:241]
v_pk_add_f32 v[226:227], v[226:227], v[242:243]
v_cvt_pk_bf16_f32 v224, v224, v225
v_cvt_pk_bf16_f32 v225, v226, v227
buffer_store_dwordx2 v[224:225], v18, s[12:15], s42 offen
s_add_u32 s42, s42, 131072
s_waitcnt vmcnt(3)
v_pk_add_f32 v[228:229], v[228:229], v[244:245]
v_pk_add_f32 v[230:231], v[230:231], v[246:247]
v_cvt_pk_bf16_f32 v228, v228, v229
v_cvt_pk_bf16_f32 v229, v230, v231
buffer_store_dwordx2 v[228:229], v18, s[12:15], s42 offen
s_add_u32 s42, s42, 131072
s_branch L_x_f2
L_x_f1:
s_add_u32 s20, s50, 0
s_and_b32 s20, s20, 0x7fff
s_add_u32 s20, s20, s41
buffer_load_dwordx4 v[152:155], v2, s[84:87], s20 offen sc1
buffer_load_dwordx4 v[156:159], v2, s[84:87], s20 offen offset:1024 sc1
buffer_load_dwordx4 v[160:163], v2, s[84:87], s20 offen offset:2048 sc1
buffer_load_dwordx4 v[164:167], v2, s[84:87], s20 offen offset:3072 sc1
s_add_u32 s20, s50, 4096
s_and_b32 s20, s20, 0x7fff
s_add_u32 s20, s20, s41
buffer_load_dwordx4 v[168:171], v2, s[84:87], s20 offen sc1
buffer_load_dwordx4 v[172:175], v2, s[84:87], s20 offen offset:1024 sc1
buffer_load_dwordx4 v[176:179], v2, s[84:87], s20 offen offset:2048 sc1
buffer_load_dwordx4 v[180:183], v2, s[84:87], s20 offen offset:3072 sc1
s_add_u32 s20, s50, 8192
s_and_b32 s20, s20, 0x7fff
s_add_u32 s20, s20, s41
buffer_load_dwordx4 v[184:187], v2, s[84:87], s20 offen sc1
buffer_load_dwordx4 v[188:191], v2, s[84:87], s20 offen offset:1024 sc1
s_waitcnt vmcnt(9)
v_mfma_f32_32x32x16_bf16 v[200:215], a[0:3], v[152:155], 0
v_mfma_f32_32x32x16_bf16 v[216:231], a[4:7], v[152:155], 0
buffer_load_dwordx4 v[192:195], v2, s[84:87], s20 offen offset:2048 sc1
s_waitcnt vmcnt(9)
v_mfma_f32_32x32x16_bf16 v[200:215], a[8:11], v[156:159], v[200:215]
v_mfma_f32_32x32x16_bf16 v[216:231], a[12:15], v[156:159], v[216:231]
buffer_load_dwordx4 v[196:199], v2, s[84:87], s20 offen offset:3072 sc1
s_waitcnt vmcnt(9)
v_mfma_f32_32x32x16_bf16 v[200:215], a[16:19], v[160:163], v[200:215]
v_mfma_f32_32x32x16_bf16 v[216:231], a[20:23], v[160:163], v[216:231]
s_add_u32 s20, s50, 12288
s_and_b32 s20, s20, 0x7fff
s_add_u32 s20, s20, s41
buffer_load_dwordx4 v[152:155], v2, s[84:87], s20 offen sc1
s_waitcnt vmcnt(9)
v_mfma_f32_32x32x16_bf16 v[200:215], a[24:27], v[164:167], v[200:215]
v_mfma_f32_32x32x16_bf16 v[216:231], a[28:31], v[164:167], v[216:231]
buffer_load_dwordx4 v[156:159], v2, s[84:87], s20 offen offset:1024 sc1
s_waitcnt vmcnt(9)
v_mfma_f32_32x32x16_bf16 v[200:215], a[32:35], v[168:171], v[200:215]
v_mfma_f32_32x32x16_bf16 v[216:231], a[36:39], v[168:171], v[216:231]
buffer_load_dwordx4 v[160:163], v2, s[84:87], s20 offen offset:2048 sc1
s_waitcnt vmcnt(9)
v_mfma_f32_32x32x16_bf16 v[200:215], a[40:43], v[172:175], v[200:215]
v_mfma_f32_32x32x16_bf16 v[216:231], a[44:47], v[172:175], v[216:231]
buffer_load_dwordx4 v[164:167], v2, s[84:87], s20 offen offset:3072 sc1
s_waitcnt vmcnt(9)
v_mfma_f32_32x32x16_bf16 v[200:215], a[48:51], v[176:179], v[200:215]
v_mfma_f32_32x32x16_bf16 v[216:231], a[52:55], v[176:179], v[216:231]
s_add_u32 s20, s50, 16384
s_and_b32 s20, s20, 0x7fff
s_add_u32 s20, s20, s41
buffer_load_dwordx4 v[168:171], v2, s[84:87], s20 offen sc1
s_waitcnt vmcnt(9)
v_mfma_f32_32x32x16_bf16 v[200:215], a[56:59], v[180:183], v[200:215]
v_mfma_f32_32x32x16_bf16 v[216:231], a[60:63], v[180:183], v[216:231]
buffer_load_dwordx4 v[172:175], v2, s[84:87], s20 offen offset:1024 sc1
s_waitcnt vmcnt(9)
v_mfma_f32_32x32x16_bf16 v[200:215], a[64:67], v[184:187], v[200:215]
v_mfma_f32_32x32x16_bf16 v[216:231], a[68:71], v[184:187], v[216:231]
buffer_load_dwordx4 v[176:179], v2, s[84:87], s20 offen offset:2048 sc1
s_waitcnt vmcnt(9)
v_mfma_f32_32x32x16_bf16 v[200:215], a[72:75], v[188:191], v[200:215]
v_mfma_f32_32x32x16_bf16 v[216:231], a[76:79], v[188:191], v[216:231]
buffer_load_dwordx4 v[180:183], v2, s[84:87], s20 offen offset:3072 sc1
s_waitcnt vmcnt(9)
v_mfma_f32_32x32x16_bf16 v[200:215], a[80:83], v[192:195], v[200:215]
v_mfma_f32_32x32x16_bf16 v[216:231], a[84:87], v[192:195], v[216:231]
s_add_u32 s20, s50, 20480
s_and_b32 s20, s20, 0x7fff
s_add_u32 s20, s20, s41
buffer_load_dwordx4 v[184:187], v2, s[84:87], s20 offen sc1
s_waitcnt vmcnt(9)
v_mfma_f32_32x32x16_bf16 v[200:215], a[88:91], v[196:199], v[200:215]
v_mfma_f32_32x32x16_bf16 v[216:231], a[92:95], v[196:199], v[216:231]
buffer_load_dwordx4 v[188:191], v2, s[84:87], s20 offen offset:1024 sc1
s_waitcnt vmcnt(9)
v_mfma_f32_32x32x16_bf16 v[200:215], a[96:99], v[152:155], v[200:215]
v_mfma_f32_32x32x16_bf16 v[216:231], a[100:103], v[152:155], v[216:231]
buffer_load_dwordx4 v[192:195], v2, s[84:87], s20 offen offset:2048 sc1
s_waitcnt vmcnt(9)
v_mfma_f32_32x32x16_bf16 v[200:215], a[104:107], v[156:159], v[200:215]
v_mfma_f32_32x32x16_bf16 v[216:231], a[108:111], v[156:159], v[216:231]
buffer_load_dwordx4 v[196:199], v2, s[84:87], s20 offen offset:3072 sc1
s_waitcnt vmcnt(9)
v_mfma_f32_32x32x16_bf16 v[200:215], a[112:115], v[160:163], v[200:215]
v_mfma_f32_32x32x16_bf16 v[216:231], a[116:119], v[160:163], v[216:231]
s_add_u32 s20, s50, 24576
s_and_b32 s20, s20, 0x7fff
s_add_u32 s20, s20, s41
buffer_load_dwordx4 v[152:155], v2, s[84:87], s20 offen sc1
s_waitcnt vmcnt(9)
v_mfma_f32_32x32x16_bf16 v[200:215], a[120:123], v[164:167], v[200:215]
v_mfma_f32_32x32x16_bf16 v[216:231], a[124:127], v[164:167], v[216:231]
buffer_load_dwordx4 v[156:159], v2, s[84:87], s20 offen offset:1024 sc1
s_waitcnt vmcnt(9)
v_mfma_f32_32x32x16_bf16 v[200:215], a[128:131], v[168:171], v[200:215]
v_mfma_f32_32x32x16_bf16 v[216:231], a[132:135], v[168:171], v[216:231]
buffer_load_dwordx4 v[160:163], v2, s[84:87], s20 offen offset:2048 sc1
s_waitcnt vmcnt(9)
v_mfma_f32_32x32x16_bf16 v[200:215], a[136:139], v[172:175], v[200:215]
v_mfma_f32_32x32x16_bf16 v[216:231], a[140:143], v[172:175], v[216:231]
buffer_load_dwordx4 v[164:167], v2, s[84:87], s20 offen offset:3072 sc1
s_waitcnt vmcnt(9)
v_mfma_f32_32x32x16_bf16 v[200:215], a[144:147], v[176:179], v[200:215]
v_mfma_f32_32x32x16_bf16 v[216:231], a[148:151], v[176:179], v[216:231]
s_add_u32 s20, s50, 28672
s_and_b32 s20, s20, 0x7fff
s_add_u32 s20, s20, s41
buffer_load_dwordx4 v[168:171], v2, s[84:87], s20 offen sc1
s_waitcnt vmcnt(9)
v_mfma_f32_32x32x16_bf16 v[200:215], a[152:155], v[180:183], v[200:215]
v_mfma_f32_32x32x16_bf16 v[216:231], a[156:159], v[180:183], v[216:231]
buffer_load_dwordx4 v[172:175], v2, s[84:87], s20 offen offset:1024 sc1
s_waitcnt vmcnt(9)
v_mfma_f32_32x32x16_bf16 v[200:215], a[160:163], v[184:187], v[200:215]
v_mfma_f32_32x32x16_bf16 v[216:231], a[164:167], v[184:187], v[216:231]
buffer_load_dwordx4 v[176:179], v2, s[84:87], s20 offen offset:2048 sc1
s_waitcnt vmcnt(9)
v_mfma_f32_32x32x16_bf16 v[200:215], a[168:171], v[188:191], v[200:215]
v_mfma_f32_32x32x16_bf16 v[216:231], a[172:175], v[188:191], v[216:231]
buffer_load_dwordx4 v[180:183], v2, s[84:87], s20 offen offset:3072 sc1
s_waitcnt vmcnt(9)
v_mfma_f32_32x32x16_bf16 v[200:215], a[176:179], v[192:195], v[200:215]
v_mfma_f32_32x32x16_bf16 v[216:231], a[180:183], v[192:195], v[216:231]
s_waitcnt vmcnt(8)
v_mfma_f32_32x32x16_bf16 v[200:215], a[184:187], v[196:199], v[200:215]
v_mfma_f32_32x32x16_bf16 v[216:231], a[188:191], v[196:199], v[216:231]
s_waitcnt vmcnt(7)
v_mfma_f32_32x32x16_bf16 v[200:215], a[192:195], v[152:155], v[200:215]
v_mfma_f32_32x32x16_bf16 v[216:231], a[196:199], v[152:155], v[216:231]
s_waitcnt vmcnt(6)
v_mfma_f32_32x32x16_bf16 v[200:215], a[200:203], v[156:159], v[200:215]
v_mfma_f32_32x32x16_bf16 v[216:231], a[204:207], v[156:159], v[216:231]
s_waitcnt vmcnt(5)
v_mfma_f32_32x32x16_bf16 v[200:215], a[208:211], v[160:163], v[200:215]
v_mfma_f32_32x32x16_bf16 v[216:231], a[212:215], v[160:163], v[216:231]
s_waitcnt vmcnt(4)
v_mfma_f32_32x32x16_bf16 v[200:215], a[216:219], v[164:167], v[200:215]
v_mfma_f32_32x32x16_bf16 v[216:231], a[220:223], v[164:167], v[216:231]
s_waitcnt vmcnt(3)
v_mfma_f32_32x32x16_bf16 v[200:215], a[224:227], v[168:171], v[200:215]
v_mfma_f32_32x32x16_bf16 v[216:231], a[228:231], v[168:171], v[216:231]
s_waitcnt vmcnt(2)
v_mfma_f32_32x32x16_bf16 v[200:215], a[232:235], v[172:175], v[200:215]
v_mfma_f32_32x32x16_bf16 v[216:231], a[236:239], v[172:175], v[216:231]
s_waitcnt vmcnt(1)
v_mfma_f32_32x32x16_bf16 v[200:215], a[240:243], v[176:179], v[200:215]
v_mfma_f32_32x32x16_bf16 v[216:231], a[244:247], v[176:179], v[216:231]
s_waitcnt vmcnt(0)
v_mfma_f32_32x32x16_bf16 v[200:215], a[248:251], v[180:183], v[200:215]
v_mfma_f32_32x32x16_bf16 v[216:231], a[252:255], v[180:183], v[216:231]
s_nop 11
ds_write_b128 v17, v[200:203]
ds_write_b128 v17, v[204:207] offset:1088
ds_write_b128 v17, v[208:211] offset:2176
ds_write_b128 v17, v[212:215] offset:3264
ds_write_b128 v17, v[216:219] offset:4352
ds_write_b128 v17, v[220:223] offset:5440
ds_write_b128 v17, v[224:227] offset:6528
ds_write_b128 v17, v[228:231] offset:7616
v_mov_b32 v3, v252
v_mov_b32 v4, s45
s_waitcnt lgkmcnt(0)
v_mov_b32 v5, v16
s_barrier
ds_read_b128 v[152:155], v3
ds_read_b128 v[156:159], v3 offset:8704
ds_read_b128 v[160:163], v3 offset:17408
ds_read_b128 v[164:167], v3 offset:26112
s_waitcnt lgkmcnt(0)
v_pk_add_f32 v[152:153], v[152:153], v[156:157]
v_pk_add_f32 v[154:155], v[154:155], v[158:159]
v_pk_add_f32 v[160:161], v[160:161], v[164:165]
v_pk_add_f32 v[162:163], v[162:163], v[166:167]
v_pk_add_f32 v[152:153], v[152:153], v[160:161]
v_pk_add_f32 v[154:155], v[154:155], v[162:163]
s_add_u32 s48, s9, 0
s_cmp_eq_u32 s96, 1
s_cbranch_scc1 L_x_st_15f
buffer_store_dwordx4 v[152:155], v19, s[84:87], s48 offen sc1
s_branch L_x_st_15d
L_x_st_15f:
buffer_store_dwordx4 v[152:155], v19, s[84:87], s48 offen
L_x_st_15d:
ds_read_b128 v[216:219], v5
ds_read_b128 v[220:223], v5 offset:8704
ds_read_b128 v[224:227], v5 offset:17408
ds_read_b128 v[228:231], v5 offset:26112
s_waitcnt lgkmcnt(0)
v_pk_add_f32 v[216:217], v[216:217], v[220:221]
v_pk_add_f32 v[218:219], v[218:219], v[222:223]
v_pk_add_f32 v[224:225], v[224:225], v[228:229]
v_pk_add_f32 v[226:227], v[226:227], v[230:231]
v_pk_add_f32 v[232:233], v[216:217], v[224:225]
v_pk_add_f32 v[234:235], v[218:219], v[226:227]
s_waitcnt vmcnt(0)
s_barrier
s_cmp_eq_u32 s96, 1
s_cbranch_scc1 L_x_st_16f
buffer_store_dword v4, v15, s[84:87], 0 offen offset:64 sc1
s_branch L_x_st_16d
L_x_st_16f:
buffer_store_dword v4, v15, s[84:87], 0 offen offset:64
L_x_st_16d:
L_x_pfb:
buffer_load_dword v3, v251, s[84:87], 0 offen offset:64 sc1
s_waitcnt vmcnt(0)
v_cmp_gt_u32 vcc, s45, v3
s_cbranch_vccnz L_x_pfb
buffer_load_dwordx4 v[216:219], v19, s[84:87], s10 offen sc1
s_waitcnt vmcnt(0)
v_pk_add_f32 v[216:217], v[216:217], v[232:233]
v_pk_add_f32 v[218:219], v[218:219], v[234:235]
v_cvt_pk_bf16_f32 v216, v216, v217
v_cvt_pk_bf16_f32 v217, v218, v219
buffer_store_dwordx2 v[216:217], v18, s[12:15], s42 offen
s_add_u32 s42, s42, 131072
L_x_f2:
s_cmp_eq_u32 s46, 1
s_cbranch_scc1 L_x_batt
s_cmp_lt_u32 s22, 64
s_cbranch_scc1 L_x_job
s_branch L_x_fin
L_x_dx:
buffer_load_dword v3, off, s[88:91], 0 offset:204 sc1
v_and_b32 v4, 15, v1
v_lshrrev_b32 v5, 4, v1
v_and_b32 v160, 1, v4
v_lshlrev_b32 v160, 4, v160
v_mov_b32 v161, 0x3f80
v_lshlrev_b32 v161, v160, v161
v_lshrrev_b32 v4, 2, v4
v_cmp_eq_u32 vcc, v4, v5
v_mov_b32 v160, 0
s_waitcnt vmcnt(0)
v_cndmask_b32 v161, 0, v161, vcc
v_readfirstlane_b32 s20, v3
s_and_b32 s21, s22, 1
s_lshl_b32 s21, s21, 20
s_lshl_b32 s26, s18, 14
s_add_u32 s26, s26, s21
s_add_u32 s26, s26, 67108864
s_lshr_b32 s20, s20, 15
s_cmp_gt_u32 s20, s100
s_cselect_b32 s20, 8192, 0
s_add_u32 s26, s26, s20
s_bfe_u32 s20, s18, 0x10001
s_lshl_b32 s20, s20, 12
s_add_u32 s26, s26, s20
s_add_u32 s48, s26, 524288
s_lshr_b32 s20, s16, 1
s_lshl_b32 s20, s20, 11
s_xor_b32 s27, s26, 4096
s_add_u32 s27, s27, s20
s_add_u32 s49, s27, 524288
s_lshl_b32 s20, s16, 10
s_add_u32 s26, s26, s20
s_add_u32 s48, s48, s20
v_add_u32 v162, s20, v2
L_x_dr:
buffer_load_dword v3, v13, s[84:87], 0 offen sc1
s_waitcnt vmcnt(0)
v_cmp_gt_u32 vcc, s22, v3
s_cbranch_vccz L_x_dp
s_sleep 2
s_branch L_x_dr
L_x_dp:
buffer_load_dwordx2 v[152:153], v7, s[84:87], s26 offen sc1
buffer_load_dwordx2 v[154:155], v7, s[84:87], s26 offen offset:512 sc1
buffer_load_dwordx2 v[156:157], v7, s[84:87], s48 offen sc1
buffer_load_dwordx2 v[158:159], v7, s[84:87], s48 offen offset:512 sc1
s_waitcnt vmcnt(0)
v_mfma_f32_16x16x16_bf16 v[164:167], v[152:153], v[160:161], 0
v_mfma_f32_16x16x16_bf16 v[168:171], v[154:155], v[160:161], 0
v_mfma_f32_16x16x16_bf16 v[164:167], v[156:157], v[160:161], v[164:167]
v_mfma_f32_16x16x16_bf16 v[168:171], v[158:159], v[160:161], v[168:171]
v_or3_b32 v3, v152, v154, v156
v_or_b32 v3, v3, v158
v_and_b32 v3, 1, v3
v_cmp_ne_u32 vcc, 0, v3
s_nop 3
s_cbranch_vccnz L_x_dp
v_cvt_pk_bf16_f32 v152, v164, v165
v_cvt_pk_bf16_f32 v153, v166, v167
v_cvt_pk_bf16_f32 v154, v168, v169
v_cvt_pk_bf16_f32 v155, v170, v171
ds_write_b128 v162, v[152:155] offset:40960
s_waitcnt lgkmcnt(0)
s_barrier
ds_read_b128 v[120:123], v2 offset:40960
ds_read_b128 v[124:127], v2 offset:41984
ds_read_b128 v[128:131], v2 offset:43008
ds_read_b128 v[132:135], v2 offset:44032
L_x_dv:
buffer_load_dwordx2 v[136:137], v7, s[84:87], s27 offen sc1
buffer_load_dwordx2 v[138:139], v7, s[84:87], s49 offen sc1
buffer_load_dwordx2 v[140:141], v7, s[84:87], s27 offen offset:1024 sc1
buffer_load_dwordx2 v[142:143], v7, s[84:87], s49 offen offset:1024 sc1
s_waitcnt vmcnt(0) lgkmcnt(0)
v_or3_b32 v3, v136, v138, v140
v_or_b32 v3, v3, v142
v_and_b32 v3, 1, v3
v_cmp_ne_u32 vcc, 0, v3
s_cbranch_vccnz L_x_dv
s_branch L_x_rd
L_x_fin:
s_endpgm
.section .rodata,"a"
.p2align 6
.amdhsa_kernel mega_kernel
  .amdhsa_next_free_vgpr 512
  .amdhsa_next_free_sgpr 102
  .amdhsa_accum_offset 256
  .amdhsa_group_segment_fixed_size 0
  .amdhsa_kernarg_size 104
  .amdhsa_user_sgpr_count 2
  .amdhsa_user_sgpr_kernarg_segment_ptr 1
  .amdhsa_system_sgpr_workgroup_id_x 1
.end_amdhsa_kernel
```

```asm
; @launch kernel=mega_kernel grid=(256,1,1) block=(256,1,1) lds=161792
.amdgcn_target "amdgcn-amd-amdhsa--gfx950"
.text
.globl mega_kernel
.p2align 8
.type mega_kernel,@function
mega_kernel:
s_cmp_ge_u32 s2, 256
s_cbranch_scc1 L_exit
s_load_dwordx2 s[84:85], s[0:1], 96
s_load_dwordx2 s[88:89], s[0:1], 88
s_getreg_b32 s93, hwreg(HW_REG_XCC_ID)
s_and_b32 s93, s93, 7
s_lshl_b32 s93, s93, 2
s_lshr_b32 s93, 0x76541302, s93
s_and_b32 s93, s93, 7
v_lshrrev_b32 v1, 6, v0
v_mov_b32 v4, 0
v_readfirstlane_b32 s80, v1
v_mov_b32 v5, 0
v_mov_b32 v6, 0
v_mov_b32 v7, 0
s_mov_b32 s83, 0
s_lshl_b32 s101, s2, 2
s_add_u32 s101, s101, s80
s_lshl_b32 s101, s101, 8
s_add_u32 s101, s101, 230686720
s_waitcnt lgkmcnt(0)
s_mov_b32 s86, 268435456
s_mov_b32 s87, 0x00020000
s_mov_b32 s90, 256
s_mov_b32 s91, 0x00020000
s_mov_b32 s98, s80
s_cmp_lg_u32 s80, 0
s_cbranch_scc1 L_st0
v_mov_b32 v10, 1
s_lshl_b32 s81, s93, 5
s_mov_b64 exec, 1
buffer_atomic_add v10, off, s[88:91], s81 offset:4 sc0
s_lshl_b32 s81, s2, 7
s_add_u32 s81, s81, 71303168
s_mov_b64 exec, 15
v_and_b32 v1, 1, v0
v_lshlrev_b32 v1, 15, v1
v_lshrrev_b32 v2, 1, v0
v_lshl_add_u32 v1, v2, 6, v1
buffer_store_dword v4, v1, s[84:87], s81 offen sc1
s_mov_b64 exec, -1
L_st0:
s_load_dwordx2 s[72:73], s[0:1], 8
v_mov_b32 v4, 0
v_mov_b32 v5, 0
v_mov_b32 v6, 0
v_mov_b32 v7, 0
v_lshlrev_b32 v1, 4, v0
s_lshl_b32 s81, s2, 13
s_add_u32 s81, s81, 67108864
s_add_u32 s79, s81, 4096
buffer_store_dwordx4 v[4:7], v1, s[84:87], s81 offen sc1
buffer_store_dwordx4 v[4:7], v1, s[84:87], s79 offen sc1
s_lshl_b32 s81, s2, 12
s_add_u32 s81, s81, 70254592
buffer_store_dwordx4 v[4:7], v1, s[84:87], s81 offen sc1
s_cmp_ge_u32 s2, 64
s_cbranch_scc1 L_gi
v_bfe_u32 v2, v0, 3, 1
v_lshlrev_b32 v2, 11, v2
v_and_b32 v3, 3, v0
v_lshl_add_u32 v2, v3, 5, v2
v_bfe_u32 v3, v0, 4, 3
v_lshl_add_u32 v2, v3, 2, v2
v_bfe_u32 v3, v0, 2, 1
v_lshl_add_u32 v2, v3, 1, v2
s_lshr_b32 s81, s2, 2
s_lshl_b32 s81, s81, 7
s_and_b32 s79, s2, 3
s_lshl_b32 s79, s79, 12
s_add_u32 s81, s81, s79
s_waitcnt lgkmcnt(0)
s_mov_b32 s74, 16384
s_mov_b32 s75, 0x00020000
buffer_load_ushort v8, v2, s[72:75], s81 offen
v_mov_b32 v9, -1
v_and_b32 v1, 31, v0
v_lshlrev_b32 v1, 1, v1
v_bfe_u32 v3, v0, 5, 2
v_lshl_add_u32 v1, v3, 8, v1
v_lshrrev_b32 v3, 7, v0
v_lshl_add_u32 v1, v3, 14, v1
v_cmp_gt_u32 vcc, 128, v0
s_lshr_b32 s81, s2, 2
s_lshl_b32 s81, s81, 10
s_and_b32 s79, s2, 3
s_lshl_b32 s79, s79, 6
s_add_u32 s81, s81, s79
s_add_u32 s81, s81, 69206016
s_waitcnt vmcnt(0)
v_min_u32 v8, 0xfffe, v8
v_cndmask_b32 v8, v9, v8, vcc
buffer_store_short v8, v1, s[84:87], s81 offen sc1
L_gi:
s_waitcnt lgkmcnt(0)
s_cmp_lg_u32 s80, 0
s_cbranch_scc1 L_st1
s_mov_b64 exec, 1
s_waitcnt vmcnt(4)
ds_write_b32 v4, v10
s_mov_b64 exec, -1
s_waitcnt lgkmcnt(0)
L_st1:
s_barrier
ds_read_b32 v2, v4
s_waitcnt lgkmcnt(0)
v_readfirstlane_b32 s94, v2
s_barrier
s_sub_u32 s81, s93, 2
s_cmp_ge_u32 s81, 2
s_cbranch_scc1 L_nopr
s_cmp_lg_u32 s80, 0
s_cbranch_scc1 L_prd
v_lshlrev_b32 v1, 4, v0
s_and_b32 s81, s2, 127
s_lshl_b32 s81, s81, 14
s_add_u32 s81, s81, 67108864
s_add_u32 s77, s81, 8192
buffer_store_dwordx4 v[4:7], v1, s[84:87], s81 offen sc1
buffer_store_dwordx4 v[4:7], v1, s[84:87], s77 offen sc1
s_waitcnt vmcnt(0)
s_memtime s[70:71]
buffer_store_dwordx4 v[4:7], v1, s[84:87], s81 offen sc1
s_waitcnt vmcnt(0)
s_memtime s[72:73]
buffer_store_dwordx4 v[4:7], v1, s[84:87], s77 offen sc1
s_waitcnt vmcnt(0)
buffer_store_dwordx4 v[4:7], v1, s[84:87], s77 offen sc1
s_waitcnt vmcnt(0)
s_memtime s[74:75]
buffer_store_dwordx4 v[4:7], v1, s[84:87], s81 offen sc1
s_waitcnt vmcnt(0)
s_memtime s[76:77]
s_waitcnt lgkmcnt(0)
s_sub_u32 s76, s76, s74
s_sub_u32 s74, s74, s72
s_sub_u32 s72, s72, s70
s_add_u32 s72, s72, s76
s_cmp_lt_u32 s74, s72
s_cselect_b32 s81, 0x10001, 1
v_mov_b32 v8, s81
s_mov_b64 exec, 1
buffer_atomic_add v8, off, s[88:91], 0 offset:204 sc1
s_mov_b64 exec, -1
L_prd:
s_barrier
L_nopr:
s_mov_b32 s97, 0
s_mov_b32 s100, 64
L_fast:
s_mov_b32 s96, 1
s_mov_b32 s30, s93
s_and_b32 s31, s94, 31
s_cmp_lt_u32 s93, 2
s_cbranch_scc1 L_recf
s_sub_u32 s92, s93, 2
s_lshl_b32 s92, s92, 5
s_add_u32 s92, s92, s31
s_branch L_bulk
L_redo:
s_waitcnt vmcnt(0) lgkmcnt(0)
s_barrier
v_readlane_b32 s100, v36, 2
v_readlane_b32 s81, v36, 3
s_mov_b32 s97, 1
s_nop 2
s_add_u32 s100, s100, s81
s_mov_b32 s95, s94
v_readlane_b32 s81, v36, 0
s_cmp_gt_u32 s93, 0
s_nop 2
s_cselect_b32 s81, s81, 0
s_add_u32 s95, s95, s81
v_readlane_b32 s81, v36, 1
s_cmp_gt_u32 s93, 1
s_nop 2
s_cselect_b32 s81, s81, 0
s_add_u32 s95, s95, s81
v_readlane_b32 s81, v36, 2
s_cmp_gt_u32 s93, 2
s_nop 2
s_cselect_b32 s81, s81, 0
s_add_u32 s95, s95, s81
v_readlane_b32 s81, v36, 3
s_cmp_gt_u32 s93, 3
s_nop 2
s_cselect_b32 s81, s81, 0
s_add_u32 s95, s95, s81
v_readlane_b32 s81, v36, 4
s_cmp_gt_u32 s93, 4
s_nop 2
s_cselect_b32 s81, s81, 0
s_add_u32 s95, s95, s81
v_readlane_b32 s81, v36, 5
s_cmp_gt_u32 s93, 5
s_nop 2
s_cselect_b32 s81, s81, 0
s_add_u32 s95, s95, s81
v_readlane_b32 s81, v36, 6
s_cmp_gt_u32 s93, 6
s_nop 2
s_cselect_b32 s81, s81, 0
s_add_u32 s95, s95, s81
L_slow:
s_mov_b32 s96, 0
s_lshr_b32 s30, s95, 5
s_and_b32 s31, s95, 31
s_cmp_lt_u32 s95, 64
s_cbranch_scc1 L_recs
s_sub_u32 s92, s95, 64
s_branch L_bulk
L_exit:
s_endpgm
L_recf:
s_load_dwordx2 s[4:5], s[0:1], 96
s_load_dwordx2 s[12:13], s[0:1], 88
s_load_dwordx2 s[50:51], s[0:1], 16
s_load_dwordx2 s[52:53], s[0:1], 24
s_load_dwordx2 s[54:55], s[0:1], 32
s_load_dwordx2 s[56:57], s[0:1], 40
s_load_dwordx2 s[58:59], s[0:1], 8
v_lshrrev_b32 v3, 6, v0
v_and_b32 v40, 63, v0
v_readfirstlane_b32 s20, v3
v_lshrrev_b32 v41, 4, v40
v_and_b32 v42, 15, v40
v_lshlrev_b32 v1, 4, v40
s_mov_b32 s49, 0
s_waitcnt lgkmcnt(0)
s_mov_b32 s6, 268435456
s_mov_b32 s7, 0x00020000
s_mov_b32 s14, 256
s_mov_b32 s15, 0x00020000
s_mov_b32 s10, 8388608
s_mov_b32 s11, 0x00020000
s_mov_b32 s26, 0x00030003
s_mov_b32 s27, 0x00030003
s_mov_b32 s28, 0xcccccccc
s_mov_b32 s29, 0xcccccccc
s_mov_b32 s32, 0x33333333
s_mov_b32 s33, 0x33333333
s_mov_b32 s34, 0x3e0293ee
s_lshl_b32 s22, s20, 2
v_xor_b32 v3, s22, v42
v_lshlrev_b32 v3, 4, v3
v_lshl_add_u32 v4, v41, 4, s20
v_lshl_add_u32 v44, v4, 13, v3
s_lshl_b32 s22, s30, 22
s_lshl_b32 s23, s31, 8
s_add_u32 s22, s22, s23
v_add_u32 v44, s22, v44
s_lshr_b32 s22, s20, 1
s_lshl_b32 s22, s22, 5
s_and_b32 s23, s20, 1
s_lshl_b32 s23, s23, 2
s_add_u32 s22, s22, s23
s_lshl_b32 s23, s31, 7
s_add_u32 s22, s22, s23
v_add_u32 v4, s22, v41
v_lshl_add_u32 v45, v4, 11, v3
s_lshl_b32 s22, s30, 10
v_add_u32 v45, s22, v45
s_lshl_b32 s48, s20, 10
s_mov_b32 s8, s50
s_mov_b32 s9, s51
s_add_u32 m0, s48, 0
s_mov_b32 s22, 0
buffer_load_dwordx4 v44, s[8:11], s22 offen  lds
s_add_u32 m0, s48, 4096
s_mov_b32 s22, 32768
buffer_load_dwordx4 v44, s[8:11], s22 offen  lds
s_add_u32 m0, s48, 8192
s_mov_b32 s22, 65536
buffer_load_dwordx4 v44, s[8:11], s22 offen  lds
s_add_u32 m0, s48, 12288
s_mov_b32 s22, 98304
buffer_load_dwordx4 v44, s[8:11], s22 offen  lds
s_add_u32 m0, s48, 16384
s_mov_b32 s22, 524288
buffer_load_dwordx4 v44, s[8:11], s22 offen  lds
s_add_u32 m0, s48, 20480
s_mov_b32 s22, 557056
buffer_load_dwordx4 v44, s[8:11], s22 offen  lds
s_add_u32 m0, s48, 24576
s_mov_b32 s22, 589824
buffer_load_dwordx4 v44, s[8:11], s22 offen  lds
s_add_u32 m0, s48, 28672
s_mov_b32 s22, 622592
buffer_load_dwordx4 v44, s[8:11], s22 offen  lds
s_add_u32 m0, s48, 32768
s_mov_b32 s22, 1048576
buffer_load_dwordx4 v44, s[8:11], s22 offen  lds
s_add_u32 m0, s48, 36864
s_mov_b32 s22, 1081344
buffer_load_dwordx4 v44, s[8:11], s22 offen  lds
s_add_u32 m0, s48, 40960
s_mov_b32 s22, 1114112
buffer_load_dwordx4 v44, s[8:11], s22 offen  lds
s_add_u32 m0, s48, 45056
s_mov_b32 s22, 1146880
buffer_load_dwordx4 v44, s[8:11], s22 offen  lds
s_waitcnt vmcnt(12)
s_barrier
s_or_b32 s81, s97, s98
s_cmp_lg_u32 s81, 0
s_cbranch_scc1 L_h0_1
s_lshl_b32 s81, s93, 5
v_mov_b32 v38, 1
s_mov_b64 exec, 1
buffer_atomic_add v38, off, s[88:91], s81 sc1
s_mov_b64 exec, -1
L_h0_1:
s_add_u32 m0, s48, 49152
s_mov_b32 s22, 1572864
buffer_load_dwordx4 v44, s[8:11], s22 offen  lds
s_add_u32 m0, s48, 53248
s_mov_b32 s22, 1605632
buffer_load_dwordx4 v44, s[8:11], s22 offen  lds
s_add_u32 m0, s48, 57344
s_mov_b32 s22, 1638400
buffer_load_dwordx4 v44, s[8:11], s22 offen  lds
s_add_u32 m0, s48, 61440
s_mov_b32 s22, 1671168
buffer_load_dwordx4 v44, s[8:11], s22 offen  lds
s_add_u32 m0, s48, 65536
s_mov_b32 s22, 2097152
buffer_load_dwordx4 v44, s[8:11], s22 offen  lds
s_add_u32 m0, s48, 69632
s_mov_b32 s22, 2129920
buffer_load_dwordx4 v44, s[8:11], s22 offen  lds
s_add_u32 m0, s48, 73728
s_mov_b32 s22, 2162688
buffer_load_dwordx4 v44, s[8:11], s22 offen  lds
s_add_u32 m0, s48, 77824
s_mov_b32 s22, 2195456
buffer_load_dwordx4 v44, s[8:11], s22 offen  lds
s_add_u32 m0, s48, 81920
s_mov_b32 s22, 2621440
buffer_load_dwordx4 v44, s[8:11], s22 offen  lds
s_add_u32 m0, s48, 86016
s_mov_b32 s22, 2654208
buffer_load_dwordx4 v44, s[8:11], s22 offen  lds
s_add_u32 m0, s48, 90112
s_mov_b32 s22, 2686976
buffer_load_dwordx4 v44, s[8:11], s22 offen  lds
s_add_u32 m0, s48, 94208
s_mov_b32 s22, 2719744
buffer_load_dwordx4 v44, s[8:11], s22 offen  lds
s_add_u32 m0, s48, 98304
s_mov_b32 s22, 3145728
buffer_load_dwordx4 v44, s[8:11], s22 offen  lds
s_add_u32 m0, s48, 102400
s_mov_b32 s22, 3178496
buffer_load_dwordx4 v44, s[8:11], s22 offen  lds
s_add_u32 m0, s48, 106496
s_mov_b32 s22, 3211264
buffer_load_dwordx4 v44, s[8:11], s22 offen  lds
s_add_u32 m0, s48, 110592
s_mov_b32 s22, 3244032
buffer_load_dwordx4 v44, s[8:11], s22 offen  lds
s_add_u32 m0, s48, 114688
s_mov_b32 s22, 3670016
buffer_load_dwordx4 v44, s[8:11], s22 offen  lds
s_add_u32 m0, s48, 118784
s_mov_b32 s22, 3702784
buffer_load_dwordx4 v44, s[8:11], s22 offen  lds
s_add_u32 m0, s48, 122880
s_mov_b32 s22, 3735552
buffer_load_dwordx4 v44, s[8:11], s22 offen  lds
s_add_u32 m0, s48, 126976
s_mov_b32 s22, 3768320
buffer_load_dwordx4 v44, s[8:11], s22 offen  lds
s_lshl_b32 s22, s30, 5
s_add_u32 s22, s22, s31
s_lshl_b32 s38, s22, 14
s_xor_b32 s22, s22, 32
s_lshl_b32 s37, s22, 14
s_add_u32 s38, s38, 67108864
s_add_u32 s37, s37, 67108864
s_lshl_b32 s46, s30, 19
s_add_u32 s46, s46, 70254592
s_mul_i32 s22, s31, 8448
s_add_u32 s47, s46, s22
s_mul_i32 s22, s20, 67584
s_add_u32 s46, s46, s22
s_lshl_b32 s22, s31, 6
s_add_u32 s46, s46, s22
s_add_u32 s61, s46, 33792
s_mul_i32 s22, s20, 2048
s_add_u32 s25, s47, s22
s_lshl_b32 s35, s30, 13
s_add_u32 s35, s35, 69206016
v_lshrrev_b32 v53, 2, v42
v_lshlrev_b32 v53, 1, v53
v_and_b32 v54, 1, v42
v_add_u32 v55, v53, v54
v_mov_b32 v14, 0
v_mov_b32 v15, 0
v_mov_b32 v2, 0x4444
v_mov_b32 v3, 0xeeee
v_cndmask_b32 v2, v2, v3, s[28:29]
s_lshl_b32 s22, s20, 12
v_add_u32 v32, s22, v1
v_add_u32 v33, 0x10000, v32
v_add_u32 v5, 0x10000, v1
v_add_u32 v6, 131072, v1
v_and_b32 v3, 3, v42
v_bfe_u32 v43, v40, 1, 1
v_lshlrev_b32 v7, 13, v43
v_and_b32 v43, 1, v40
v_lshl_add_u32 v7, v43, 7, v7
s_lshl_b32 s22, s31, 8
s_add_u32 s23, s22, 71311360
v_add_u32 v7, s23, v7
s_cmp_lg_u32 s20, 0
s_cbranch_scc1 L_rf_flk
s_lshl_b32 s23, s30, 7
s_add_u32 s22, s22, s23
s_add_u32 s22, s22, 71327744
v_bfrev_b32 v7, 1
v_writelane_b32 v7, s22, 0
L_rf_flk:
v_lshlrev_b32 v11, 3, v40
v_lshlrev_b32 v10, 8, v55
v_lshl_add_u32 v10, v41, 4, v10
v_mul_u32_u24 v8, 8448, v41
v_lshl_add_u32 v8, v3, 4, v8
v_lshrrev_b32 v4, 2, v42
v_mul_u32_u24 v4, 2048, v4
v_add_u32 v8, v4, v8
v_lshrrev_b32 v9, 1, v41
v_lshlrev_b32 v9, 5, v9
v_and_b32 v4, 1, v42
v_lshl_add_u32 v9, v4, 4, v9
v_and_b32 v4, 1, v41
v_lshl_add_u32 v9, v4, 3, v9
s_lshr_b32 s22, s31, 2
s_lshl_b32 s22, s22, 10
s_and_b32 s23, s31, 3
s_lshl_b32 s23, s23, 6
s_add_u32 s22, s22, s23
v_add_u32 v9, s22, v9
v_lshrrev_b32 v4, 2, v42
v_lshlrev_b32 v12, 8, v4
v_lshl_add_u32 v12, v41, 6, v12
v_lshl_add_u32 v12, v3, 4, v12
v_lshlrev_b32 v13, 6, v41
v_lshl_add_u32 v13, v42, 2, v13
v_cmp_eq_u32 vcc, 0, v3
v_mov_b32 v28, 0x3f803f80
v_mov_b32 v29, 0x3f803f80
v_cndmask_b32 v34, 0, 1, vcc
v_mov_b32 v30, 0x3f803f80
v_mov_b32 v31, 0x3f803f80
v_and_b32 v49, 1, v42
v_lshlrev_b32 v49, 4, v49
v_mov_b32 v50, 0x3f80
v_lshlrev_b32 v50, v49, v50
v_lshrrev_b32 v51, 2, v42
v_cmp_eq_u32 vcc, v51, v41
v_mov_b32 v24, v50
v_cndmask_b32 v52, 0, v50, s[28:29]
v_cndmask_b32 v53, 0, v50, s[32:33]
v_cndmask_b32 v16, 0, v52, vcc
v_cndmask_b32 v17, 0, v53, vcc
v_mov_b32 v25, v50
v_mov_b32 v26, v50
v_mov_b32 v27, v50
v_bfe_u32 v60, v40, 3, 1
v_bfe_u32 v49, v40, 2, 1
v_and_b32 v50, 1, v41
v_lshrrev_b32 v51, 1, v41
v_lshlrev_b32 v52, 3, v60
v_lshl_add_u32 v52, v50, 2, v52
v_lshl_add_u32 v53, v51, 4, v52
v_add_u32 v53, v53, v49
v_and_b32 v54, 3, v40
s_lshl_b32 s22, s20, 2
v_add_u32 v55, s22, v54
v_xor_b32 v55, v55, v52
v_lshlrev_b32 v55, 4, v55
v_lshl_add_u32 v46, v53, 8, v55
v_lshlrev_b32 v55, 4, v52
v_lshl_add_u32 v55, v54, 3, v55
v_lshl_add_u32 v47, v53, 8, v55
s_waitcnt vmcnt(28)
s_barrier
v_add_u32 v48, 0, v46
ds_read_b64_tr_b16 a[0:1], v48
ds_read_b64_tr_b16 a[2:3], v48 offset:512
ds_read_b64_tr_b16 a[4:5], v48 offset:8192
ds_read_b64_tr_b16 a[6:7], v48 offset:8704
ds_read_b64_tr_b16 a[8:9], v48 offset:8
ds_read_b64_tr_b16 a[10:11], v48 offset:520
ds_read_b64_tr_b16 a[12:13], v48 offset:8200
ds_read_b64_tr_b16 a[14:15], v48 offset:8712
s_waitcnt lgkmcnt(0)
s_barrier
s_mov_b32 s8, s52
s_mov_b32 s9, s53
s_add_u32 m0, s48, 0
s_mov_b32 s22, 0
buffer_load_dwordx4 v44, s[8:11], s22 offen  lds
s_add_u32 m0, s48, 4096
s_mov_b32 s22, 32768
buffer_load_dwordx4 v44, s[8:11], s22 offen  lds
s_add_u32 m0, s48, 8192
s_mov_b32 s22, 65536
buffer_load_dwordx4 v44, s[8:11], s22 offen  lds
s_add_u32 m0, s48, 12288
s_mov_b32 s22, 98304
buffer_load_dwordx4 v44, s[8:11], s22 offen  lds
s_waitcnt vmcnt(28)
s_barrier
v_add_u32 v48, 16384, v46
ds_read_b64_tr_b16 a[16:17], v48
ds_read_b64_tr_b16 a[18:19], v48 offset:512
ds_read_b64_tr_b16 a[20:21], v48 offset:8192
ds_read_b64_tr_b16 a[22:23], v48 offset:8704
ds_read_b64_tr_b16 a[24:25], v48 offset:8
ds_read_b64_tr_b16 a[26:27], v48 offset:520
ds_read_b64_tr_b16 a[28:29], v48 offset:8200
ds_read_b64_tr_b16 a[30:31], v48 offset:8712
s_waitcnt lgkmcnt(0)
s_barrier
s_add_u32 m0, s48, 16384
s_mov_b32 s22, 524288
buffer_load_dwordx4 v44, s[8:11], s22 offen  lds
s_add_u32 m0, s48, 20480
s_mov_b32 s22, 557056
buffer_load_dwordx4 v44, s[8:11], s22 offen  lds
s_add_u32 m0, s48, 24576
s_mov_b32 s22, 589824
buffer_load_dwordx4 v44, s[8:11], s22 offen  lds
s_add_u32 m0, s48, 28672
s_mov_b32 s22, 622592
buffer_load_dwordx4 v44, s[8:11], s22 offen  lds
s_waitcnt vmcnt(28)
s_barrier
v_add_u32 v48, 32768, v46
ds_read_b64_tr_b16 a[32:33], v48
ds_read_b64_tr_b16 a[34:35], v48 offset:512
ds_read_b64_tr_b16 a[36:37], v48 offset:8192
ds_read_b64_tr_b16 a[38:39], v48 offset:8704
ds_read_b64_tr_b16 a[40:41], v48 offset:8
ds_read_b64_tr_b16 a[42:43], v48 offset:520
ds_read_b64_tr_b16 a[44:45], v48 offset:8200
ds_read_b64_tr_b16 a[46:47], v48 offset:8712
s_waitcnt lgkmcnt(0)
s_barrier
s_add_u32 m0, s48, 32768
s_mov_b32 s22, 1048576
buffer_load_dwordx4 v44, s[8:11], s22 offen  lds
s_add_u32 m0, s48, 36864
s_mov_b32 s22, 1081344
buffer_load_dwordx4 v44, s[8:11], s22 offen  lds
s_add_u32 m0, s48, 40960
s_mov_b32 s22, 1114112
buffer_load_dwordx4 v44, s[8:11], s22 offen  lds
s_add_u32 m0, s48, 45056
s_mov_b32 s22, 1146880
buffer_load_dwordx4 v44, s[8:11], s22 offen  lds
s_waitcnt vmcnt(28)
s_barrier
v_add_u32 v48, 49152, v46
ds_read_b64_tr_b16 a[48:49], v48
ds_read_b64_tr_b16 a[50:51], v48 offset:512
ds_read_b64_tr_b16 a[52:53], v48 offset:8192
ds_read_b64_tr_b16 a[54:55], v48 offset:8704
ds_read_b64_tr_b16 a[56:57], v48 offset:8
ds_read_b64_tr_b16 a[58:59], v48 offset:520
ds_read_b64_tr_b16 a[60:61], v48 offset:8200
ds_read_b64_tr_b16 a[62:63], v48 offset:8712
s_waitcnt lgkmcnt(0)
s_barrier
s_add_u32 m0, s48, 49152
s_mov_b32 s22, 1572864
buffer_load_dwordx4 v44, s[8:11], s22 offen  lds
s_add_u32 m0, s48, 53248
s_mov_b32 s22, 1605632
buffer_load_dwordx4 v44, s[8:11], s22 offen  lds
s_add_u32 m0, s48, 57344
s_mov_b32 s22, 1638400
buffer_load_dwordx4 v44, s[8:11], s22 offen  lds
s_add_u32 m0, s48, 61440
s_mov_b32 s22, 1671168
buffer_load_dwordx4 v44, s[8:11], s22 offen  lds
s_waitcnt vmcnt(28)
s_barrier
v_add_u32 v48, 65536, v46
ds_read_b64_tr_b16 a[64:65], v48
ds_read_b64_tr_b16 a[66:67], v48 offset:512
ds_read_b64_tr_b16 a[68:69], v48 offset:8192
ds_read_b64_tr_b16 a[70:71], v48 offset:8704
ds_read_b64_tr_b16 a[72:73], v48 offset:8
ds_read_b64_tr_b16 a[74:75], v48 offset:520
ds_read_b64_tr_b16 a[76:77], v48 offset:8200
ds_read_b64_tr_b16 a[78:79], v48 offset:8712
s_waitcnt lgkmcnt(0)
s_barrier
s_add_u32 m0, s48, 65536
s_mov_b32 s22, 2097152
buffer_load_dwordx4 v44, s[8:11], s22 offen  lds
s_add_u32 m0, s48, 69632
s_mov_b32 s22, 2129920
buffer_load_dwordx4 v44, s[8:11], s22 offen  lds
s_add_u32 m0, s48, 73728
s_mov_b32 s22, 2162688
buffer_load_dwordx4 v44, s[8:11], s22 offen  lds
s_add_u32 m0, s48, 77824
s_mov_b32 s22, 2195456
buffer_load_dwordx4 v44, s[8:11], s22 offen  lds
s_waitcnt vmcnt(28)
s_barrier
v_add_u32 v48, 81920, v46
ds_read_b64_tr_b16 a[80:81], v48
ds_read_b64_tr_b16 a[82:83], v48 offset:512
ds_read_b64_tr_b16 a[84:85], v48 offset:8192
ds_read_b64_tr_b16 a[86:87], v48 offset:8704
ds_read_b64_tr_b16 a[88:89], v48 offset:8
ds_read_b64_tr_b16 a[90:91], v48 offset:520
ds_read_b64_tr_b16 a[92:93], v48 offset:8200
ds_read_b64_tr_b16 a[94:95], v48 offset:8712
s_waitcnt lgkmcnt(0)
s_barrier
s_add_u32 m0, s48, 81920
s_mov_b32 s22, 2621440
buffer_load_dwordx4 v44, s[8:11], s22 offen  lds
s_add_u32 m0, s48, 86016
s_mov_b32 s22, 2654208
buffer_load_dwordx4 v44, s[8:11], s22 offen  lds
s_add_u32 m0, s48, 90112
s_mov_b32 s22, 2686976
buffer_load_dwordx4 v44, s[8:11], s22 offen  lds
s_add_u32 m0, s48, 94208
s_mov_b32 s22, 2719744
buffer_load_dwordx4 v44, s[8:11], s22 offen  lds
s_waitcnt vmcnt(28)
s_barrier
v_add_u32 v48, 98304, v46
ds_read_b64_tr_b16 a[96:97], v48
ds_read_b64_tr_b16 a[98:99], v48 offset:512
ds_read_b64_tr_b16 a[100:101], v48 offset:8192
ds_read_b64_tr_b16 a[102:103], v48 offset:8704
ds_read_b64_tr_b16 a[104:105], v48 offset:8
ds_read_b64_tr_b16 a[106:107], v48 offset:520
ds_read_b64_tr_b16 a[108:109], v48 offset:8200
ds_read_b64_tr_b16 a[110:111], v48 offset:8712
s_waitcnt lgkmcnt(0)
s_barrier
s_add_u32 m0, s48, 98304
s_mov_b32 s22, 3145728
buffer_load_dwordx4 v44, s[8:11], s22 offen  lds
s_add_u32 m0, s48, 102400
s_mov_b32 s22, 3178496
buffer_load_dwordx4 v44, s[8:11], s22 offen  lds
s_add_u32 m0, s48, 106496
s_mov_b32 s22, 3211264
buffer_load_dwordx4 v44, s[8:11], s22 offen  lds
s_add_u32 m0, s48, 110592
s_mov_b32 s22, 3244032
buffer_load_dwordx4 v44, s[8:11], s22 offen  lds
s_waitcnt vmcnt(28)
s_barrier
v_add_u32 v48, 114688, v46
ds_read_b64_tr_b16 a[112:113], v48
ds_read_b64_tr_b16 a[114:115], v48 offset:512
ds_read_b64_tr_b16 a[116:117], v48 offset:8192
ds_read_b64_tr_b16 a[118:119], v48 offset:8704
ds_read_b64_tr_b16 a[120:121], v48 offset:8
ds_read_b64_tr_b16 a[122:123], v48 offset:520
ds_read_b64_tr_b16 a[124:125], v48 offset:8200
ds_read_b64_tr_b16 a[126:127], v48 offset:8712
s_waitcnt lgkmcnt(0)
s_barrier
s_add_u32 m0, s48, 114688
s_mov_b32 s22, 3670016
buffer_load_dwordx4 v44, s[8:11], s22 offen  lds
s_add_u32 m0, s48, 118784
s_mov_b32 s22, 3702784
buffer_load_dwordx4 v44, s[8:11], s22 offen  lds
s_add_u32 m0, s48, 122880
s_mov_b32 s22, 3735552
buffer_load_dwordx4 v44, s[8:11], s22 offen  lds
s_add_u32 m0, s48, 126976
s_mov_b32 s22, 3768320
buffer_load_dwordx4 v44, s[8:11], s22 offen  lds
s_waitcnt vmcnt(28)
s_barrier
v_add_u32 v48, 0, v46
ds_read_b64_tr_b16 a[128:129], v48
ds_read_b64_tr_b16 a[130:131], v48 offset:512
ds_read_b64_tr_b16 a[132:133], v48 offset:8192
ds_read_b64_tr_b16 a[134:135], v48 offset:8704
ds_read_b64_tr_b16 a[136:137], v48 offset:8
ds_read_b64_tr_b16 a[138:139], v48 offset:520
ds_read_b64_tr_b16 a[140:141], v48 offset:8200
ds_read_b64_tr_b16 a[142:143], v48 offset:8712
s_waitcnt lgkmcnt(0)
s_barrier
s_mov_b32 s8, s56
s_mov_b32 s9, s57
s_add_u32 m0, s48, 0
s_mov_b32 s22, 0
buffer_load_dwordx4 v45, s[8:11], s22 offen  lds
s_add_u32 m0, s48, 4096
s_mov_b32 s22, 16384
buffer_load_dwordx4 v45, s[8:11], s22 offen  lds
s_add_u32 m0, s48, 8192
s_mov_b32 s22, 32768
buffer_load_dwordx4 v45, s[8:11], s22 offen  lds
s_add_u32 m0, s48, 12288
s_mov_b32 s22, 49152
buffer_load_dwordx4 v45, s[8:11], s22 offen  lds
s_waitcnt vmcnt(28)
s_barrier
v_add_u32 v48, 16384, v46
ds_read_b64_tr_b16 a[144:145], v48
ds_read_b64_tr_b16 a[146:147], v48 offset:512
ds_read_b64_tr_b16 a[148:149], v48 offset:8192
ds_read_b64_tr_b16 a[150:151], v48 offset:8704
ds_read_b64_tr_b16 a[152:153], v48 offset:8
ds_read_b64_tr_b16 a[154:155], v48 offset:520
ds_read_b64_tr_b16 a[156:157], v48 offset:8200
ds_read_b64_tr_b16 a[158:159], v48 offset:8712
s_waitcnt lgkmcnt(0)
s_barrier
s_add_u32 m0, s48, 16384
s_mov_b32 s22, 256
buffer_load_dwordx4 v45, s[8:11], s22 offen  lds
s_add_u32 m0, s48, 20480
s_mov_b32 s22, 16640
buffer_load_dwordx4 v45, s[8:11], s22 offen  lds
s_add_u32 m0, s48, 24576
s_mov_b32 s22, 33024
buffer_load_dwordx4 v45, s[8:11], s22 offen  lds
s_add_u32 m0, s48, 28672
s_mov_b32 s22, 49408
buffer_load_dwordx4 v45, s[8:11], s22 offen  lds
s_waitcnt vmcnt(28)
s_barrier
v_add_u32 v48, 32768, v46
ds_read_b64_tr_b16 a[160:161], v48
ds_read_b64_tr_b16 a[162:163], v48 offset:512
ds_read_b64_tr_b16 a[164:165], v48 offset:8192
ds_read_b64_tr_b16 a[166:167], v48 offset:8704
ds_read_b64_tr_b16 a[168:169], v48 offset:8
ds_read_b64_tr_b16 a[170:171], v48 offset:520
ds_read_b64_tr_b16 a[172:173], v48 offset:8200
ds_read_b64_tr_b16 a[174:175], v48 offset:8712
s_waitcnt lgkmcnt(0)
s_barrier
s_add_u32 m0, s48, 32768
s_mov_b32 s22, 512
buffer_load_dwordx4 v45, s[8:11], s22 offen  lds
s_add_u32 m0, s48, 36864
s_mov_b32 s22, 16896
buffer_load_dwordx4 v45, s[8:11], s22 offen  lds
s_add_u32 m0, s48, 40960
s_mov_b32 s22, 33280
buffer_load_dwordx4 v45, s[8:11], s22 offen  lds
s_add_u32 m0, s48, 45056
s_mov_b32 s22, 49664
buffer_load_dwordx4 v45, s[8:11], s22 offen  lds
s_waitcnt vmcnt(28)
s_barrier
v_add_u32 v48, 49152, v46
ds_read_b64_tr_b16 a[176:177], v48
ds_read_b64_tr_b16 a[178:179], v48 offset:512
ds_read_b64_tr_b16 a[180:181], v48 offset:8192
ds_read_b64_tr_b16 a[182:183], v48 offset:8704
ds_read_b64_tr_b16 a[184:185], v48 offset:8
ds_read_b64_tr_b16 a[186:187], v48 offset:520
ds_read_b64_tr_b16 a[188:189], v48 offset:8200
ds_read_b64_tr_b16 a[190:191], v48 offset:8712
s_waitcnt lgkmcnt(0)
s_barrier
s_add_u32 m0, s48, 49152
s_mov_b32 s22, 768
buffer_load_dwordx4 v45, s[8:11], s22 offen  lds
s_add_u32 m0, s48, 53248
s_mov_b32 s22, 17152
buffer_load_dwordx4 v45, s[8:11], s22 offen  lds
s_add_u32 m0, s48, 57344
s_mov_b32 s22, 33536
buffer_load_dwordx4 v45, s[8:11], s22 offen  lds
s_add_u32 m0, s48, 61440
s_mov_b32 s22, 49920
buffer_load_dwordx4 v45, s[8:11], s22 offen  lds
s_waitcnt vmcnt(28)
s_barrier
v_and_b32 v37, 7, v0
v_lshlrev_b32 v37, 5, v37
buffer_load_dword v36, v37, s[88:91], 0 offen sc1
buffer_load_dword v58, off, s[12:15], 0 offset:204 sc1
v_add_u32 v48, 65536, v46
ds_read_b64_tr_b16 a[192:193], v48
ds_read_b64_tr_b16 a[194:195], v48 offset:512
ds_read_b64_tr_b16 a[196:197], v48 offset:8192
ds_read_b64_tr_b16 a[198:199], v48 offset:8704
ds_read_b64_tr_b16 a[200:201], v48 offset:8
ds_read_b64_tr_b16 a[202:203], v48 offset:520
ds_read_b64_tr_b16 a[204:205], v48 offset:8200
ds_read_b64_tr_b16 a[206:207], v48 offset:8712
s_waitcnt lgkmcnt(0)
s_barrier
s_add_u32 m0, s48, 65536
s_mov_b32 s22, 131072
buffer_load_dwordx4 v45, s[8:11], s22 offen  lds
s_add_u32 m0, s48, 69632
s_mov_b32 s22, 147456
buffer_load_dwordx4 v45, s[8:11], s22 offen  lds
s_add_u32 m0, s48, 73728
s_mov_b32 s22, 163840
buffer_load_dwordx4 v45, s[8:11], s22 offen  lds
s_add_u32 m0, s48, 77824
s_mov_b32 s22, 180224
buffer_load_dwordx4 v45, s[8:11], s22 offen  lds
s_waitcnt vmcnt(28)
s_barrier
v_add_u32 v48, 81920, v46
ds_read_b64_tr_b16 a[208:209], v48
ds_read_b64_tr_b16 a[210:211], v48 offset:512
ds_read_b64_tr_b16 a[212:213], v48 offset:8192
ds_read_b64_tr_b16 a[214:215], v48 offset:8704
ds_read_b64_tr_b16 a[216:217], v48 offset:8
ds_read_b64_tr_b16 a[218:219], v48 offset:520
ds_read_b64_tr_b16 a[220:221], v48 offset:8200
ds_read_b64_tr_b16 a[222:223], v48 offset:8712
s_waitcnt lgkmcnt(0)
s_barrier
s_add_u32 m0, s48, 81920
s_mov_b32 s22, 131328
buffer_load_dwordx4 v45, s[8:11], s22 offen  lds
s_add_u32 m0, s48, 86016
s_mov_b32 s22, 147712
buffer_load_dwordx4 v45, s[8:11], s22 offen  lds
s_add_u32 m0, s48, 90112
s_mov_b32 s22, 164096
buffer_load_dwordx4 v45, s[8:11], s22 offen  lds
s_add_u32 m0, s48, 94208
s_mov_b32 s22, 180480
buffer_load_dwordx4 v45, s[8:11], s22 offen  lds
s_waitcnt vmcnt(28)
s_barrier
v_add_u32 v48, 98304, v46
ds_read_b64_tr_b16 a[224:225], v48
ds_read_b64_tr_b16 a[226:227], v48 offset:512
ds_read_b64_tr_b16 a[228:229], v48 offset:8192
ds_read_b64_tr_b16 a[230:231], v48 offset:8704
ds_read_b64_tr_b16 a[232:233], v48 offset:8
ds_read_b64_tr_b16 a[234:235], v48 offset:520
ds_read_b64_tr_b16 a[236:237], v48 offset:8200
ds_read_b64_tr_b16 a[238:239], v48 offset:8712
s_waitcnt lgkmcnt(0)
s_barrier
s_add_u32 m0, s48, 98304
s_mov_b32 s22, 131584
buffer_load_dwordx4 v45, s[8:11], s22 offen  lds
s_add_u32 m0, s48, 102400
s_mov_b32 s22, 147968
buffer_load_dwordx4 v45, s[8:11], s22 offen  lds
s_add_u32 m0, s48, 106496
s_mov_b32 s22, 164352
buffer_load_dwordx4 v45, s[8:11], s22 offen  lds
s_add_u32 m0, s48, 110592
s_mov_b32 s22, 180736
buffer_load_dwordx4 v45, s[8:11], s22 offen  lds
s_waitcnt vmcnt(28)
s_barrier
v_add_u32 v48, 114688, v46
ds_read_b64_tr_b16 a[240:241], v48
ds_read_b64_tr_b16 a[242:243], v48 offset:512
ds_read_b64_tr_b16 a[244:245], v48 offset:8192
ds_read_b64_tr_b16 a[246:247], v48 offset:8704
ds_read_b64_tr_b16 a[248:249], v48 offset:8
ds_read_b64_tr_b16 a[250:251], v48 offset:520
ds_read_b64_tr_b16 a[252:253], v48 offset:8200
ds_read_b64_tr_b16 a[254:255], v48 offset:8712
s_waitcnt lgkmcnt(0)
s_barrier
s_add_u32 m0, s48, 114688
s_mov_b32 s22, 131840
buffer_load_dwordx4 v45, s[8:11], s22 offen  lds
s_add_u32 m0, s48, 118784
s_mov_b32 s22, 148224
buffer_load_dwordx4 v45, s[8:11], s22 offen  lds
s_add_u32 m0, s48, 122880
s_mov_b32 s22, 164608
buffer_load_dwordx4 v45, s[8:11], s22 offen  lds
s_add_u32 m0, s48, 126976
s_mov_b32 s22, 180992
buffer_load_dwordx4 v45, s[8:11], s22 offen  lds
s_waitcnt vmcnt(28)
s_barrier
s_cmp_lg_u32 s20, 0
s_cbranch_scc1 L_rf_wo0
v_xor_b32 v48, 0, v47
v_add_u32 v48, 0, v48
ds_read_b64_tr_b16 v[128:129], v48
ds_read_b64_tr_b16 v[130:131], v48 offset:512
ds_read_b64_tr_b16 v[132:133], v48 offset:8192
ds_read_b64_tr_b16 v[134:135], v48 offset:8704
ds_read_b64_tr_b16 v[144:145], v48 offset:32
ds_read_b64_tr_b16 v[146:147], v48 offset:544
ds_read_b64_tr_b16 v[148:149], v48 offset:8224
ds_read_b64_tr_b16 v[150:151], v48 offset:8736
s_waitcnt lgkmcnt(0)
v_xor_b32 v48, 64, v47
v_add_u32 v48, 0, v48
ds_read_b64_tr_b16 v[160:161], v48
ds_read_b64_tr_b16 v[162:163], v48 offset:512
ds_read_b64_tr_b16 v[164:165], v48 offset:8192
ds_read_b64_tr_b16 v[166:167], v48 offset:8704
ds_read_b64_tr_b16 v[176:177], v48 offset:32
ds_read_b64_tr_b16 v[178:179], v48 offset:544
ds_read_b64_tr_b16 v[180:181], v48 offset:8224
ds_read_b64_tr_b16 v[182:183], v48 offset:8736
s_waitcnt lgkmcnt(0)
v_xor_b32 v48, 128, v47
v_add_u32 v48, 0, v48
ds_read_b64_tr_b16 v[192:193], v48
ds_read_b64_tr_b16 v[194:195], v48 offset:512
ds_read_b64_tr_b16 v[196:197], v48 offset:8192
ds_read_b64_tr_b16 v[198:199], v48 offset:8704
ds_read_b64_tr_b16 v[208:209], v48 offset:32
ds_read_b64_tr_b16 v[210:211], v48 offset:544
ds_read_b64_tr_b16 v[212:213], v48 offset:8224
ds_read_b64_tr_b16 v[214:215], v48 offset:8736
s_waitcnt lgkmcnt(0)
v_xor_b32 v48, 192, v47
v_add_u32 v48, 0, v48
ds_read_b64_tr_b16 v[224:225], v48
ds_read_b64_tr_b16 v[226:227], v48 offset:512
ds_read_b64_tr_b16 v[228:229], v48 offset:8192
ds_read_b64_tr_b16 v[230:231], v48 offset:8704
ds_read_b64_tr_b16 v[240:241], v48 offset:32
ds_read_b64_tr_b16 v[242:243], v48 offset:544
ds_read_b64_tr_b16 v[244:245], v48 offset:8224
ds_read_b64_tr_b16 v[246:247], v48 offset:8736
s_waitcnt lgkmcnt(0)
L_rf_wo0:
s_barrier
s_mov_b32 s8, s54
s_mov_b32 s9, s55
s_add_u32 m0, s48, 0
s_mov_b32 s22, 0
buffer_load_dwordx4 v44, s[8:11], s22 offen  lds
s_add_u32 m0, s48, 4096
s_mov_b32 s22, 32768
buffer_load_dwordx4 v44, s[8:11], s22 offen  lds
s_add_u32 m0, s48, 8192
s_mov_b32 s22, 65536
buffer_load_dwordx4 v44, s[8:11], s22 offen  lds
s_add_u32 m0, s48, 12288
s_mov_b32 s22, 98304
buffer_load_dwordx4 v44, s[8:11], s22 offen  lds
s_waitcnt vmcnt(28)
s_barrier
s_cmp_lg_u32 s20, 1
s_cbranch_scc1 L_rf_wo1
v_xor_b32 v48, 0, v47
v_add_u32 v48, 16384, v48
ds_read_b64_tr_b16 v[128:129], v48
ds_read_b64_tr_b16 v[130:131], v48 offset:512
ds_read_b64_tr_b16 v[132:133], v48 offset:8192
ds_read_b64_tr_b16 v[134:135], v48 offset:8704
ds_read_b64_tr_b16 v[144:145], v48 offset:32
ds_read_b64_tr_b16 v[146:147], v48 offset:544
ds_read_b64_tr_b16 v[148:149], v48 offset:8224
ds_read_b64_tr_b16 v[150:151], v48 offset:8736
s_waitcnt lgkmcnt(0)
v_xor_b32 v48, 64, v47
v_add_u32 v48, 16384, v48
ds_read_b64_tr_b16 v[160:161], v48
ds_read_b64_tr_b16 v[162:163], v48 offset:512
ds_read_b64_tr_b16 v[164:165], v48 offset:8192
ds_read_b64_tr_b16 v[166:167], v48 offset:8704
ds_read_b64_tr_b16 v[176:177], v48 offset:32
ds_read_b64_tr_b16 v[178:179], v48 offset:544
ds_read_b64_tr_b16 v[180:181], v48 offset:8224
ds_read_b64_tr_b16 v[182:183], v48 offset:8736
s_waitcnt lgkmcnt(0)
v_xor_b32 v48, 128, v47
v_add_u32 v48, 16384, v48
ds_read_b64_tr_b16 v[192:193], v48
ds_read_b64_tr_b16 v[194:195], v48 offset:512
ds_read_b64_tr_b16 v[196:197], v48 offset:8192
ds_read_b64_tr_b16 v[198:199], v48 offset:8704
ds_read_b64_tr_b16 v[208:209], v48 offset:32
ds_read_b64_tr_b16 v[210:211], v48 offset:544
ds_read_b64_tr_b16 v[212:213], v48 offset:8224
ds_read_b64_tr_b16 v[214:215], v48 offset:8736
s_waitcnt lgkmcnt(0)
v_xor_b32 v48, 192, v47
v_add_u32 v48, 16384, v48
ds_read_b64_tr_b16 v[224:225], v48
ds_read_b64_tr_b16 v[226:227], v48 offset:512
ds_read_b64_tr_b16 v[228:229], v48 offset:8192
ds_read_b64_tr_b16 v[230:231], v48 offset:8704
ds_read_b64_tr_b16 v[240:241], v48 offset:32
ds_read_b64_tr_b16 v[242:243], v48 offset:544
ds_read_b64_tr_b16 v[244:245], v48 offset:8224
ds_read_b64_tr_b16 v[246:247], v48 offset:8736
s_waitcnt lgkmcnt(0)
L_rf_wo1:
s_barrier
s_add_u32 m0, s48, 16384
s_mov_b32 s22, 524288
buffer_load_dwordx4 v44, s[8:11], s22 offen  lds
s_add_u32 m0, s48, 20480
s_mov_b32 s22, 557056
buffer_load_dwordx4 v44, s[8:11], s22 offen  lds
s_add_u32 m0, s48, 24576
s_mov_b32 s22, 589824
buffer_load_dwordx4 v44, s[8:11], s22 offen  lds
s_add_u32 m0, s48, 28672
s_mov_b32 s22, 622592
buffer_load_dwordx4 v44, s[8:11], s22 offen  lds
s_waitcnt vmcnt(28)
s_barrier
s_cmp_lg_u32 s20, 2
s_cbranch_scc1 L_rf_wo2
v_xor_b32 v48, 0, v47
v_add_u32 v48, 32768, v48
ds_read_b64_tr_b16 v[128:129], v48
ds_read_b64_tr_b16 v[130:131], v48 offset:512
ds_read_b64_tr_b16 v[132:133], v48 offset:8192
ds_read_b64_tr_b16 v[134:135], v48 offset:8704
ds_read_b64_tr_b16 v[144:145], v48 offset:32
ds_read_b64_tr_b16 v[146:147], v48 offset:544
ds_read_b64_tr_b16 v[148:149], v48 offset:8224
ds_read_b64_tr_b16 v[150:151], v48 offset:8736
s_waitcnt lgkmcnt(0)
v_xor_b32 v48, 64, v47
v_add_u32 v48, 32768, v48
ds_read_b64_tr_b16 v[160:161], v48
ds_read_b64_tr_b16 v[162:163], v48 offset:512
ds_read_b64_tr_b16 v[164:165], v48 offset:8192
ds_read_b64_tr_b16 v[166:167], v48 offset:8704
ds_read_b64_tr_b16 v[176:177], v48 offset:32
ds_read_b64_tr_b16 v[178:179], v48 offset:544
ds_read_b64_tr_b16 v[180:181], v48 offset:8224
ds_read_b64_tr_b16 v[182:183], v48 offset:8736
s_waitcnt lgkmcnt(0)
v_xor_b32 v48, 128, v47
v_add_u32 v48, 32768, v48
ds_read_b64_tr_b16 v[192:193], v48
ds_read_b64_tr_b16 v[194:195], v48 offset:512
ds_read_b64_tr_b16 v[196:197], v48 offset:8192
ds_read_b64_tr_b16 v[198:199], v48 offset:8704
ds_read_b64_tr_b16 v[208:209], v48 offset:32
ds_read_b64_tr_b16 v[210:211], v48 offset:544
ds_read_b64_tr_b16 v[212:213], v48 offset:8224
ds_read_b64_tr_b16 v[214:215], v48 offset:8736
s_waitcnt lgkmcnt(0)
v_xor_b32 v48, 192, v47
v_add_u32 v48, 32768, v48
ds_read_b64_tr_b16 v[224:225], v48
ds_read_b64_tr_b16 v[226:227], v48 offset:512
ds_read_b64_tr_b16 v[228:229], v48 offset:8192
ds_read_b64_tr_b16 v[230:231], v48 offset:8704
ds_read_b64_tr_b16 v[240:241], v48 offset:32
ds_read_b64_tr_b16 v[242:243], v48 offset:544
ds_read_b64_tr_b16 v[244:245], v48 offset:8224
ds_read_b64_tr_b16 v[246:247], v48 offset:8736
s_waitcnt lgkmcnt(0)
L_rf_wo2:
s_barrier
s_add_u32 m0, s48, 32768
s_mov_b32 s22, 1048576
buffer_load_dwordx4 v44, s[8:11], s22 offen  lds
s_add_u32 m0, s48, 36864
s_mov_b32 s22, 1081344
buffer_load_dwordx4 v44, s[8:11], s22 offen  lds
s_add_u32 m0, s48, 40960
s_mov_b32 s22, 1114112
buffer_load_dwordx4 v44, s[8:11], s22 offen  lds
s_add_u32 m0, s48, 45056
s_mov_b32 s22, 1146880
buffer_load_dwordx4 v44, s[8:11], s22 offen  lds
s_waitcnt vmcnt(28)
s_barrier
s_cmp_lg_u32 s20, 3
s_cbranch_scc1 L_rf_wo3
v_xor_b32 v48, 0, v47
v_add_u32 v48, 49152, v48
ds_read_b64_tr_b16 v[128:129], v48
ds_read_b64_tr_b16 v[130:131], v48 offset:512
ds_read_b64_tr_b16 v[132:133], v48 offset:8192
ds_read_b64_tr_b16 v[134:135], v48 offset:8704
ds_read_b64_tr_b16 v[144:145], v48 offset:32
ds_read_b64_tr_b16 v[146:147], v48 offset:544
ds_read_b64_tr_b16 v[148:149], v48 offset:8224
ds_read_b64_tr_b16 v[150:151], v48 offset:8736
s_waitcnt lgkmcnt(0)
v_xor_b32 v48, 64, v47
v_add_u32 v48, 49152, v48
ds_read_b64_tr_b16 v[160:161], v48
ds_read_b64_tr_b16 v[162:163], v48 offset:512
ds_read_b64_tr_b16 v[164:165], v48 offset:8192
ds_read_b64_tr_b16 v[166:167], v48 offset:8704
ds_read_b64_tr_b16 v[176:177], v48 offset:32
ds_read_b64_tr_b16 v[178:179], v48 offset:544
ds_read_b64_tr_b16 v[180:181], v48 offset:8224
ds_read_b64_tr_b16 v[182:183], v48 offset:8736
s_waitcnt lgkmcnt(0)
v_xor_b32 v48, 128, v47
v_add_u32 v48, 49152, v48
ds_read_b64_tr_b16 v[192:193], v48
ds_read_b64_tr_b16 v[194:195], v48 offset:512
ds_read_b64_tr_b16 v[196:197], v48 offset:8192
ds_read_b64_tr_b16 v[198:199], v48 offset:8704
ds_read_b64_tr_b16 v[208:209], v48 offset:32
ds_read_b64_tr_b16 v[210:211], v48 offset:544
ds_read_b64_tr_b16 v[212:213], v48 offset:8224
ds_read_b64_tr_b16 v[214:215], v48 offset:8736
s_waitcnt lgkmcnt(0)
v_xor_b32 v48, 192, v47
v_add_u32 v48, 49152, v48
ds_read_b64_tr_b16 v[224:225], v48
ds_read_b64_tr_b16 v[226:227], v48 offset:512
ds_read_b64_tr_b16 v[228:229], v48 offset:8192
ds_read_b64_tr_b16 v[230:231], v48 offset:8704
ds_read_b64_tr_b16 v[240:241], v48 offset:32
ds_read_b64_tr_b16 v[242:243], v48 offset:544
ds_read_b64_tr_b16 v[244:245], v48 offset:8224
ds_read_b64_tr_b16 v[246:247], v48 offset:8736
s_waitcnt lgkmcnt(0)
L_rf_wo3:
s_barrier
s_add_u32 m0, s48, 49152
s_mov_b32 s22, 1572864
buffer_load_dwordx4 v44, s[8:11], s22 offen  lds
s_add_u32 m0, s48, 53248
s_mov_b32 s22, 1605632
buffer_load_dwordx4 v44, s[8:11], s22 offen  lds
s_add_u32 m0, s48, 57344
s_mov_b32 s22, 1638400
buffer_load_dwordx4 v44, s[8:11], s22 offen  lds
s_add_u32 m0, s48, 61440
s_mov_b32 s22, 1671168
buffer_load_dwordx4 v44, s[8:11], s22 offen  lds
s_waitcnt vmcnt(28)
s_barrier
s_cmp_lg_u32 s20, 0
s_cbranch_scc1 L_rf_wo4
v_xor_b32 v48, 0, v47
v_add_u32 v48, 65536, v48
ds_read_b64_tr_b16 v[136:137], v48
ds_read_b64_tr_b16 v[138:139], v48 offset:512
ds_read_b64_tr_b16 v[140:141], v48 offset:8192
ds_read_b64_tr_b16 v[142:143], v48 offset:8704
ds_read_b64_tr_b16 v[152:153], v48 offset:32
ds_read_b64_tr_b16 v[154:155], v48 offset:544
ds_read_b64_tr_b16 v[156:157], v48 offset:8224
ds_read_b64_tr_b16 v[158:159], v48 offset:8736
s_waitcnt lgkmcnt(0)
v_xor_b32 v48, 64, v47
v_add_u32 v48, 65536, v48
ds_read_b64_tr_b16 v[168:169], v48
ds_read_b64_tr_b16 v[170:171], v48 offset:512
ds_read_b64_tr_b16 v[172:173], v48 offset:8192
ds_read_b64_tr_b16 v[174:175], v48 offset:8704
ds_read_b64_tr_b16 v[184:185], v48 offset:32
ds_read_b64_tr_b16 v[186:187], v48 offset:544
ds_read_b64_tr_b16 v[188:189], v48 offset:8224
ds_read_b64_tr_b16 v[190:191], v48 offset:8736
s_waitcnt lgkmcnt(0)
v_xor_b32 v48, 128, v47
v_add_u32 v48, 65536, v48
ds_read_b64_tr_b16 v[200:201], v48
ds_read_b64_tr_b16 v[202:203], v48 offset:512
ds_read_b64_tr_b16 v[204:205], v48 offset:8192
ds_read_b64_tr_b16 v[206:207], v48 offset:8704
ds_read_b64_tr_b16 v[216:217], v48 offset:32
ds_read_b64_tr_b16 v[218:219], v48 offset:544
ds_read_b64_tr_b16 v[220:221], v48 offset:8224
ds_read_b64_tr_b16 v[222:223], v48 offset:8736
s_waitcnt lgkmcnt(0)
v_xor_b32 v48, 192, v47
v_add_u32 v48, 65536, v48
ds_read_b64_tr_b16 v[232:233], v48
ds_read_b64_tr_b16 v[234:235], v48 offset:512
ds_read_b64_tr_b16 v[236:237], v48 offset:8192
ds_read_b64_tr_b16 v[238:239], v48 offset:8704
ds_read_b64_tr_b16 v[248:249], v48 offset:32
ds_read_b64_tr_b16 v[250:251], v48 offset:544
ds_read_b64_tr_b16 v[252:253], v48 offset:8224
ds_read_b64_tr_b16 v[254:255], v48 offset:8736
s_waitcnt lgkmcnt(0)
L_rf_wo4:
s_barrier
s_add_u32 m0, s48, 65536
s_mov_b32 s22, 2097152
buffer_load_dwordx4 v44, s[8:11], s22 offen  lds
s_add_u32 m0, s48, 69632
s_mov_b32 s22, 2129920
buffer_load_dwordx4 v44, s[8:11], s22 offen  lds
s_add_u32 m0, s48, 73728
s_mov_b32 s22, 2162688
buffer_load_dwordx4 v44, s[8:11], s22 offen  lds
s_add_u32 m0, s48, 77824
s_mov_b32 s22, 2195456
buffer_load_dwordx4 v44, s[8:11], s22 offen  lds
s_waitcnt vmcnt(28)
s_barrier
s_cmp_lg_u32 s20, 1
s_cbranch_scc1 L_rf_wo5
v_xor_b32 v48, 0, v47
v_add_u32 v48, 81920, v48
ds_read_b64_tr_b16 v[136:137], v48
ds_read_b64_tr_b16 v[138:139], v48 offset:512
ds_read_b64_tr_b16 v[140:141], v48 offset:8192
ds_read_b64_tr_b16 v[142:143], v48 offset:8704
ds_read_b64_tr_b16 v[152:153], v48 offset:32
ds_read_b64_tr_b16 v[154:155], v48 offset:544
ds_read_b64_tr_b16 v[156:157], v48 offset:8224
ds_read_b64_tr_b16 v[158:159], v48 offset:8736
s_waitcnt lgkmcnt(0)
v_xor_b32 v48, 64, v47
v_add_u32 v48, 81920, v48
ds_read_b64_tr_b16 v[168:169], v48
ds_read_b64_tr_b16 v[170:171], v48 offset:512
ds_read_b64_tr_b16 v[172:173], v48 offset:8192
ds_read_b64_tr_b16 v[174:175], v48 offset:8704
ds_read_b64_tr_b16 v[184:185], v48 offset:32
ds_read_b64_tr_b16 v[186:187], v48 offset:544
ds_read_b64_tr_b16 v[188:189], v48 offset:8224
ds_read_b64_tr_b16 v[190:191], v48 offset:8736
s_waitcnt lgkmcnt(0)
v_xor_b32 v48, 128, v47
v_add_u32 v48, 81920, v48
ds_read_b64_tr_b16 v[200:201], v48
ds_read_b64_tr_b16 v[202:203], v48 offset:512
ds_read_b64_tr_b16 v[204:205], v48 offset:8192
ds_read_b64_tr_b16 v[206:207], v48 offset:8704
ds_read_b64_tr_b16 v[216:217], v48 offset:32
ds_read_b64_tr_b16 v[218:219], v48 offset:544
ds_read_b64_tr_b16 v[220:221], v48 offset:8224
ds_read_b64_tr_b16 v[222:223], v48 offset:8736
s_waitcnt lgkmcnt(0)
v_xor_b32 v48, 192, v47
v_add_u32 v48, 81920, v48
ds_read_b64_tr_b16 v[232:233], v48
ds_read_b64_tr_b16 v[234:235], v48 offset:512
ds_read_b64_tr_b16 v[236:237], v48 offset:8192
ds_read_b64_tr_b16 v[238:239], v48 offset:8704
ds_read_b64_tr_b16 v[248:249], v48 offset:32
ds_read_b64_tr_b16 v[250:251], v48 offset:544
ds_read_b64_tr_b16 v[252:253], v48 offset:8224
ds_read_b64_tr_b16 v[254:255], v48 offset:8736
s_waitcnt lgkmcnt(0)
L_rf_wo5:
s_barrier
s_add_u32 m0, s48, 81920
s_mov_b32 s22, 2621440
buffer_load_dwordx4 v44, s[8:11], s22 offen  lds
s_add_u32 m0, s48, 86016
s_mov_b32 s22, 2654208
buffer_load_dwordx4 v44, s[8:11], s22 offen  lds
s_add_u32 m0, s48, 90112
s_mov_b32 s22, 2686976
buffer_load_dwordx4 v44, s[8:11], s22 offen  lds
s_add_u32 m0, s48, 94208
s_mov_b32 s22, 2719744
buffer_load_dwordx4 v44, s[8:11], s22 offen  lds
s_waitcnt vmcnt(28)
s_barrier
s_cmp_lg_u32 s97, 0
s_cbranch_scc1 L_h2_2_ok
L_h2_2_ev:
v_cmp_ne_u32 vcc, 32, v36
s_cbranch_vccz L_h2_2_ok
s_mov_b32 s78, 0
v_readlane_b32 s81, v36, 0
s_nop 3
s_add_u32 s78, s78, s81
v_readlane_b32 s81, v36, 1
s_nop 3
s_add_u32 s78, s78, s81
v_readlane_b32 s81, v36, 2
s_nop 3
s_add_u32 s78, s78, s81
v_readlane_b32 s81, v36, 3
s_nop 3
s_add_u32 s78, s78, s81
v_readlane_b32 s81, v36, 4
s_nop 3
s_add_u32 s78, s78, s81
v_readlane_b32 s81, v36, 5
s_nop 3
s_add_u32 s78, s78, s81
v_readlane_b32 s81, v36, 6
s_nop 3
s_add_u32 s78, s78, s81
v_readlane_b32 s81, v36, 7
s_nop 3
s_add_u32 s78, s78, s81
s_cmp_eq_u32 s78, 256
s_cbranch_scc1 L_redo
buffer_load_dword v36, v37, s[88:91], 0 offen sc1
s_waitcnt vmcnt(0)
s_branch L_h2_2_ev
L_h2_2_ok:
s_mov_b32 s97, 1
s_cmp_lg_u32 s20, 2
s_cbranch_scc1 L_rf_wo6
v_xor_b32 v48, 0, v47
v_add_u32 v48, 98304, v48
ds_read_b64_tr_b16 v[136:137], v48
ds_read_b64_tr_b16 v[138:139], v48 offset:512
ds_read_b64_tr_b16 v[140:141], v48 offset:8192
ds_read_b64_tr_b16 v[142:143], v48 offset:8704
ds_read_b64_tr_b16 v[152:153], v48 offset:32
ds_read_b64_tr_b16 v[154:155], v48 offset:544
ds_read_b64_tr_b16 v[156:157], v48 offset:8224
ds_read_b64_tr_b16 v[158:159], v48 offset:8736
s_waitcnt lgkmcnt(0)
v_xor_b32 v48, 64, v47
v_add_u32 v48, 98304, v48
ds_read_b64_tr_b16 v[168:169], v48
ds_read_b64_tr_b16 v[170:171], v48 offset:512
ds_read_b64_tr_b16 v[172:173], v48 offset:8192
ds_read_b64_tr_b16 v[174:175], v48 offset:8704
ds_read_b64_tr_b16 v[184:185], v48 offset:32
ds_read_b64_tr_b16 v[186:187], v48 offset:544
ds_read_b64_tr_b16 v[188:189], v48 offset:8224
ds_read_b64_tr_b16 v[190:191], v48 offset:8736
s_waitcnt lgkmcnt(0)
v_xor_b32 v48, 128, v47
v_add_u32 v48, 98304, v48
ds_read_b64_tr_b16 v[200:201], v48
ds_read_b64_tr_b16 v[202:203], v48 offset:512
ds_read_b64_tr_b16 v[204:205], v48 offset:8192
ds_read_b64_tr_b16 v[206:207], v48 offset:8704
ds_read_b64_tr_b16 v[216:217], v48 offset:32
ds_read_b64_tr_b16 v[218:219], v48 offset:544
ds_read_b64_tr_b16 v[220:221], v48 offset:8224
ds_read_b64_tr_b16 v[222:223], v48 offset:8736
s_waitcnt lgkmcnt(0)
v_xor_b32 v48, 192, v47
v_add_u32 v48, 98304, v48
ds_read_b64_tr_b16 v[232:233], v48
ds_read_b64_tr_b16 v[234:235], v48 offset:512
ds_read_b64_tr_b16 v[236:237], v48 offset:8192
ds_read_b64_tr_b16 v[238:239], v48 offset:8704
ds_read_b64_tr_b16 v[248:249], v48 offset:32
ds_read_b64_tr_b16 v[250:251], v48 offset:544
ds_read_b64_tr_b16 v[252:253], v48 offset:8224
ds_read_b64_tr_b16 v[254:255], v48 offset:8736
s_waitcnt lgkmcnt(0)
L_rf_wo6:
s_barrier
s_add_u32 m0, s48, 98304
s_mov_b32 s22, 3145728
buffer_load_dwordx4 v44, s[8:11], s22 offen  lds
s_add_u32 m0, s48, 102400
s_mov_b32 s22, 3178496
buffer_load_dwordx4 v44, s[8:11], s22 offen  lds
s_add_u32 m0, s48, 106496
s_mov_b32 s22, 3211264
buffer_load_dwordx4 v44, s[8:11], s22 offen  lds
s_add_u32 m0, s48, 110592
s_mov_b32 s22, 3244032
buffer_load_dwordx4 v44, s[8:11], s22 offen  lds
s_waitcnt vmcnt(28)
s_barrier
s_cmp_lg_u32 s20, 3
s_cbranch_scc1 L_rf_wo7
v_xor_b32 v48, 0, v47
v_add_u32 v48, 114688, v48
ds_read_b64_tr_b16 v[136:137], v48
ds_read_b64_tr_b16 v[138:139], v48 offset:512
ds_read_b64_tr_b16 v[140:141], v48 offset:8192
ds_read_b64_tr_b16 v[142:143], v48 offset:8704
ds_read_b64_tr_b16 v[152:153], v48 offset:32
ds_read_b64_tr_b16 v[154:155], v48 offset:544
ds_read_b64_tr_b16 v[156:157], v48 offset:8224
ds_read_b64_tr_b16 v[158:159], v48 offset:8736
s_waitcnt lgkmcnt(0)
v_xor_b32 v48, 64, v47
v_add_u32 v48, 114688, v48
ds_read_b64_tr_b16 v[168:169], v48
ds_read_b64_tr_b16 v[170:171], v48 offset:512
ds_read_b64_tr_b16 v[172:173], v48 offset:8192
ds_read_b64_tr_b16 v[174:175], v48 offset:8704
ds_read_b64_tr_b16 v[184:185], v48 offset:32
ds_read_b64_tr_b16 v[186:187], v48 offset:544
ds_read_b64_tr_b16 v[188:189], v48 offset:8224
ds_read_b64_tr_b16 v[190:191], v48 offset:8736
s_waitcnt lgkmcnt(0)
v_xor_b32 v48, 128, v47
v_add_u32 v48, 114688, v48
ds_read_b64_tr_b16 v[200:201], v48
ds_read_b64_tr_b16 v[202:203], v48 offset:512
ds_read_b64_tr_b16 v[204:205], v48 offset:8192
ds_read_b64_tr_b16 v[206:207], v48 offset:8704
ds_read_b64_tr_b16 v[216:217], v48 offset:32
ds_read_b64_tr_b16 v[218:219], v48 offset:544
ds_read_b64_tr_b16 v[220:221], v48 offset:8224
ds_read_b64_tr_b16 v[222:223], v48 offset:8736
s_waitcnt lgkmcnt(0)
v_xor_b32 v48, 192, v47
v_add_u32 v48, 114688, v48
ds_read_b64_tr_b16 v[232:233], v48
ds_read_b64_tr_b16 v[234:235], v48 offset:512
ds_read_b64_tr_b16 v[236:237], v48 offset:8192
ds_read_b64_tr_b16 v[238:239], v48 offset:8704
ds_read_b64_tr_b16 v[248:249], v48 offset:32
ds_read_b64_tr_b16 v[250:251], v48 offset:544
ds_read_b64_tr_b16 v[252:253], v48 offset:8224
ds_read_b64_tr_b16 v[254:255], v48 offset:8736
s_waitcnt lgkmcnt(0)
L_rf_wo7:
s_barrier
s_add_u32 m0, s48, 114688
s_mov_b32 s22, 3670016
buffer_load_dwordx4 v44, s[8:11], s22 offen  lds
s_add_u32 m0, s48, 118784
s_mov_b32 s22, 3702784
buffer_load_dwordx4 v44, s[8:11], s22 offen  lds
s_add_u32 m0, s48, 122880
s_mov_b32 s22, 3735552
buffer_load_dwordx4 v44, s[8:11], s22 offen  lds
s_add_u32 m0, s48, 126976
s_mov_b32 s22, 3768320
buffer_load_dwordx4 v44, s[8:11], s22 offen  lds
s_waitcnt vmcnt(28)
s_barrier
v_add_u32 v48, 0, v46
ds_read_b64_tr_b16 v[64:65], v48
ds_read_b64_tr_b16 v[66:67], v48 offset:512
ds_read_b64_tr_b16 v[68:69], v48 offset:8192
ds_read_b64_tr_b16 v[70:71], v48 offset:8704
ds_read_b64_tr_b16 v[72:73], v48 offset:8
ds_read_b64_tr_b16 v[74:75], v48 offset:520
ds_read_b64_tr_b16 v[76:77], v48 offset:8200
ds_read_b64_tr_b16 v[78:79], v48 offset:8712
s_waitcnt lgkmcnt(0)
s_barrier
ds_write_b128 v32, v[64:67]
ds_write_b128 v32, v[68:71] offset:1024
ds_write_b128 v32, v[72:75] offset:2048
ds_write_b128 v32, v[76:79] offset:3072
s_waitcnt lgkmcnt(0)
s_waitcnt vmcnt(24)
s_barrier
v_add_u32 v48, 16384, v46
ds_read_b64_tr_b16 v[64:65], v48
ds_read_b64_tr_b16 v[66:67], v48 offset:512
ds_read_b64_tr_b16 v[68:69], v48 offset:8192
ds_read_b64_tr_b16 v[70:71], v48 offset:8704
ds_read_b64_tr_b16 v[72:73], v48 offset:8
ds_read_b64_tr_b16 v[74:75], v48 offset:520
ds_read_b64_tr_b16 v[76:77], v48 offset:8200
ds_read_b64_tr_b16 v[78:79], v48 offset:8712
s_waitcnt lgkmcnt(0)
s_barrier
ds_write_b128 v32, v[64:67] offset:16384
ds_write_b128 v32, v[68:71] offset:17408
ds_write_b128 v32, v[72:75] offset:18432
ds_write_b128 v32, v[76:79] offset:19456
s_waitcnt lgkmcnt(0)
s_waitcnt vmcnt(20)
s_barrier
s_getpc_b64 s[16:17]
L_rf_pc0:
s_add_u32 s16, s16, L_rf_w0_entry - L_rf_pc0
s_addc_u32 s17, s17, 0
v_lshlrev_b32 v49, 7, v0
v_min_u32 v49, L_rf_end - L_rf_w0_entry, v49
global_load_dword v50, v49, s[16:17]
v_lshlrev_b32 v49, 7, v40
s_xor_b32 s23, s35, 16384
s_cmp_eq_u32 s20, 1
s_cselect_b32 s22, s35, s47
s_cmp_eq_u32 s20, 2
s_cselect_b32 s22, s23, s22
s_lshl_b32 s23, s31, 13
s_add_u32 s23, s23, 178257920
s_cmp_eq_u32 s20, 3
s_cselect_b32 s22, s23, s22
buffer_load_dword v51, v49, s[4:7], s22 offen sc1
v_lshlrev_b32 v49, 13, v0
v_and_b32 v49, 0x1fffff, v49
s_mov_b32 s22, 67108864
buffer_load_dword v52, v49, s[4:7], s22 offen sc1
buffer_load_dword v57, v7, s[4:7], 0 offen sc1
v_add_u32 v48, 32768, v46
ds_read_b64_tr_b16 v[64:65], v48
ds_read_b64_tr_b16 v[66:67], v48 offset:512
ds_read_b64_tr_b16 v[68:69], v48 offset:8192
ds_read_b64_tr_b16 v[70:71], v48 offset:8704
ds_read_b64_tr_b16 v[72:73], v48 offset:8
ds_read_b64_tr_b16 v[74:75], v48 offset:520
ds_read_b64_tr_b16 v[76:77], v48 offset:8200
ds_read_b64_tr_b16 v[78:79], v48 offset:8712
s_waitcnt lgkmcnt(0)
s_barrier
ds_write_b128 v32, v[64:67] offset:32768
ds_write_b128 v32, v[68:71] offset:33792
ds_write_b128 v32, v[72:75] offset:34816
ds_write_b128 v32, v[76:79] offset:35840
s_waitcnt lgkmcnt(0)
s_waitcnt vmcnt(16)
s_barrier
v_add_u32 v48, 49152, v46
ds_read_b64_tr_b16 v[64:65], v48
ds_read_b64_tr_b16 v[66:67], v48 offset:512
ds_read_b64_tr_b16 v[68:69], v48 offset:8192
ds_read_b64_tr_b16 v[70:71], v48 offset:8704
ds_read_b64_tr_b16 v[72:73], v48 offset:8
ds_read_b64_tr_b16 v[74:75], v48 offset:520
ds_read_b64_tr_b16 v[76:77], v48 offset:8200
ds_read_b64_tr_b16 v[78:79], v48 offset:8712
s_waitcnt lgkmcnt(0)
s_barrier
ds_write_b128 v32, v[64:67] offset:49152
ds_write_b128 v32, v[68:71] offset:50176
ds_write_b128 v32, v[72:75] offset:51200
ds_write_b128 v32, v[76:79] offset:52224
s_waitcnt lgkmcnt(0)
s_waitcnt vmcnt(12)
s_barrier
v_add_u32 v48, 65536, v46
ds_read_b64_tr_b16 v[64:65], v48
ds_read_b64_tr_b16 v[66:67], v48 offset:512
ds_read_b64_tr_b16 v[68:69], v48 offset:8192
ds_read_b64_tr_b16 v[70:71], v48 offset:8704
ds_read_b64_tr_b16 v[72:73], v48 offset:8
ds_read_b64_tr_b16 v[74:75], v48 offset:520
ds_read_b64_tr_b16 v[76:77], v48 offset:8200
ds_read_b64_tr_b16 v[78:79], v48 offset:8712
s_waitcnt lgkmcnt(0)
s_barrier
ds_write_b128 v33, v[64:67]
ds_write_b128 v33, v[68:71] offset:1024
ds_write_b128 v33, v[72:75] offset:2048
ds_write_b128 v33, v[76:79] offset:3072
s_waitcnt lgkmcnt(0)
s_waitcnt vmcnt(8)
s_barrier
v_add_u32 v48, 81920, v46
ds_read_b64_tr_b16 v[64:65], v48
ds_read_b64_tr_b16 v[66:67], v48 offset:512
ds_read_b64_tr_b16 v[68:69], v48 offset:8192
ds_read_b64_tr_b16 v[70:71], v48 offset:8704
ds_read_b64_tr_b16 v[72:73], v48 offset:8
ds_read_b64_tr_b16 v[74:75], v48 offset:520
ds_read_b64_tr_b16 v[76:77], v48 offset:8200
ds_read_b64_tr_b16 v[78:79], v48 offset:8712
s_waitcnt lgkmcnt(0)
s_barrier
ds_write_b128 v33, v[64:67] offset:16384
ds_write_b128 v33, v[68:71] offset:17408
ds_write_b128 v33, v[72:75] offset:18432
ds_write_b128 v33, v[76:79] offset:19456
s_waitcnt lgkmcnt(0)
s_waitcnt vmcnt(4)
s_barrier
v_add_u32 v48, 98304, v46
ds_read_b64_tr_b16 v[64:65], v48
ds_read_b64_tr_b16 v[66:67], v48 offset:512
ds_read_b64_tr_b16 v[68:69], v48 offset:8192
ds_read_b64_tr_b16 v[70:71], v48 offset:8704
ds_read_b64_tr_b16 v[72:73], v48 offset:8
ds_read_b64_tr_b16 v[74:75], v48 offset:520
ds_read_b64_tr_b16 v[76:77], v48 offset:8200
ds_read_b64_tr_b16 v[78:79], v48 offset:8712
s_waitcnt lgkmcnt(0)
s_barrier
ds_write_b128 v33, v[64:67] offset:32768
ds_write_b128 v33, v[68:71] offset:33792
ds_write_b128 v33, v[72:75] offset:34816
ds_write_b128 v33, v[76:79] offset:35840
s_waitcnt lgkmcnt(0)
s_waitcnt vmcnt(0)
s_barrier
v_add_u32 v48, 114688, v46
ds_read_b64_tr_b16 v[64:65], v48
ds_read_b64_tr_b16 v[66:67], v48 offset:512
ds_read_b64_tr_b16 v[68:69], v48 offset:8192
ds_read_b64_tr_b16 v[70:71], v48 offset:8704
ds_read_b64_tr_b16 v[72:73], v48 offset:8
ds_read_b64_tr_b16 v[74:75], v48 offset:520
ds_read_b64_tr_b16 v[76:77], v48 offset:8200
ds_read_b64_tr_b16 v[78:79], v48 offset:8712
s_waitcnt lgkmcnt(0)
s_barrier
ds_write_b128 v33, v[64:67] offset:49152
ds_write_b128 v33, v[68:71] offset:50176
ds_write_b128 v33, v[72:75] offset:51200
ds_write_b128 v33, v[76:79] offset:52224
s_waitcnt lgkmcnt(0)
s_branch L_rf_iw1
L_rf_iw:
buffer_load_dword v58, off, s[12:15], 0 offset:204 sc1
s_waitcnt vmcnt(0)
L_rf_iw1:
v_and_b32 v50, 0xffff, v58
v_readfirstlane_b32 s60, v58
v_cmp_ne_u32 vcc, s100, v50
s_cbranch_vccnz L_rf_iw
s_lshr_b32 s60, s60, 15
s_cmp_gt_u32 s60, s100
s_cselect_b32 s60, 8192, 0
s_bfe_u32 s22, s31, 0x10001
s_lshl_b32 s22, s22, 12
s_add_u32 s22, s22, s60
s_lshl_b32 s23, s20, 10
s_add_u32 s22, s22, s23
s_add_u32 s38, s38, s22
s_add_u32 s37, s37, s22
s_xor_b32 s40, s38, 4096
s_xor_b32 s39, s37, 4096
s_xor_b32 s36, s35, 16384
s_mov_b32 s21, 0
s_cmp_eq_u32 s30, 0
s_mov_b32 s22, 0x33003300
s_cselect_b32 s16, 0x00330033, s22
s_mov_b32 s17, s16
s_cselect_b32 s18, -1, 0
s_not_b32 s19, s18
s_lshl_b32 s22, s31, 13
s_lshl_b32 s23, s20, 11
s_add_u32 s22, s22, s23
s_add_u32 s43, s22, 16777216
s_add_u32 s44, s22, 33554432
s_lshl_b32 s45, s31, 13
s_add_u32 s45, s45, 178257920
s_mul_i32 s48, s20, 5120
s_add_u32 m0, s48, 140288
s_mov_b32 s41, 1
s_mov_b32 s42, 1
v_mov_b32 v0, v34
v_bfrev_b32 v12, 1
v_bfrev_b32 v3, 1
v_cndmask_b32 v10, v3, v10, s[16:17]
v_cndmask_b32 v9, v3, v9, s[26:27]
s_sub_u32 s45, s45, 0
s_lshl_b32 s51, s30, 11
s_add_u32 s51, s51, s45
s_mov_b32 s50, 0
s_cmp_lg_u32 s20, 3
s_cbranch_scc1 L_rf_kv0
v_readlane_b32 s50, v57, 0
v_readlane_b32 s22, v57, 2
v_readlane_b32 s23, v57, 1
v_readlane_b32 s24, v57, 3
s_nop 3
s_min_u32 s50, s50, s22
s_min_u32 s23, s23, s24
s_lshl_b32 s50, s50, 1
s_lshl_b32 s23, s23, 1
s_add_u32 s23, s23, 1
s_min_u32 s50, s50, s23
L_rf_kvb0:
s_add_u32 s22, s21, 1
s_min_u32 s22, s22, 63
s_cmp_gt_u32 s50, s22
s_cbranch_scc1 L_rf_kvd0
buffer_load_dword v48, v7, s[4:7], 0 offen sc1
s_waitcnt vmcnt(0)
v_readlane_b32 s50, v48, 0
v_readlane_b32 s22, v48, 2
v_readlane_b32 s23, v48, 1
v_readlane_b32 s24, v48, 3
s_nop 3
s_min_u32 s50, s50, s22
s_min_u32 s23, s23, s24
s_lshl_b32 s50, s50, 1
s_lshl_b32 s23, s23, 1
s_add_u32 s23, s23, 1
s_min_u32 s50, s50, s23
s_branch L_rf_kvb0
L_rf_kvd0:
L_rf_kv0:
s_barrier
s_cmp_eq_u32 s20, 1
s_cbranch_scc1 L_rf_w1_entry
s_cmp_eq_u32 s20, 2
s_cbranch_scc1 L_rf_w2_entry
s_cmp_eq_u32 s20, 3
s_cbranch_scc1 L_rf_w3_entry
L_rf_w0_entry:
v_mfma_f32_32x32x8_bf16 v[96:111], v[14:15], v[14:15], 0
v_mfma_f32_16x16x16_bf16 v[112:115], v[14:15], v[14:15], 0
v_mfma_f32_16x16x16_bf16 v[116:119], v[14:15], v[14:15], 0
ds_read_b128 v[64:67], v1
ds_read_b128 v[68:71], v1 offset:1024
ds_read_b128 v[72:75], v1 offset:2048
ds_read_b128 v[76:79], v1 offset:3072
ds_read_b128 v[80:83], v1 offset:16384
ds_read_b128 v[84:87], v1 offset:17408
ds_read_b128 v[88:91], v1 offset:18432
ds_read_b128 v[92:95], v1 offset:19456
buffer_load_dwordx4 v[120:123], v1, s[4:7], s44 offen
buffer_load_dwordx4 v[124:127], v1, s[4:7], s44 offen offset:1024
s_add_u32 s44, s44, 262144
L_rf_w0_loop:
s_add_u32 s22, s35, 0
s_waitcnt vmcnt(0)
buffer_load_dwordx4 v[32:35], v1, s[4:7], s22 offen sc1
buffer_load_dwordx4 v[36:39], v1, s[4:7], s22 offen offset:1024 sc1
L_rf_w0_pa:
s_waitcnt vmcnt(1)
ds_write_b128 v6, v[32:35]
s_waitcnt vmcnt(0)
ds_write_b128 v6, v[36:39] offset:1024
v_max3_u32 v3, v32, v34, v36
v_max_u32 v3, v3, v38
v_cmp_eq_u32 vcc, -1, v3
v_smfmac_f32_16x16x64_bf16 v[96:99], v[32:35], a[0:7], v2
buffer_load_dwordx4 v[32:35], v1, s[4:7], s22 offen sc1
v_smfmac_f32_16x16x64_bf16 v[100:103], v[32:35], a[8:15], v2
buffer_load_dwordx4 v[36:39], v1, s[4:7], s22 offen offset:1024 sc1
v_smfmac_f32_16x16x64_bf16 v[104:107], v[32:35], a[128:135], v2
s_cbranch_vccnz L_rf_w0_pafail
s_waitcnt lgkmcnt(0)
s_barrier
ds_read_b128 v[40:43], v6 offset:2048
ds_read_b128 v[44:47], v6 offset:3072
v_smfmac_f32_16x16x64_bf16 v[108:111], v[32:35], a[136:143], v2
ds_read_b128 v[48:51], v6 offset:4096
v_smfmac_f32_16x16x64_bf16 v[96:99], v[36:39], a[16:23], v2
ds_read_b128 v[52:55], v6 offset:5120
v_smfmac_f32_16x16x64_bf16 v[100:103], v[36:39], a[24:31], v2
ds_read_b128 v[56:59], v6 offset:6144
v_smfmac_f32_16x16x64_bf16 v[104:107], v[36:39], a[144:151], v2
ds_read_b128 v[60:63], v6 offset:7168
v_smfmac_f32_16x16x64_bf16 v[108:111], v[36:39], a[152:159], v2
buffer_load_dwordx4 v1, s[4:7], s43 offen lds
s_waitcnt lgkmcnt(5)
v_smfmac_f32_16x16x64_bf16 v[96:99], v[40:43], a[32:39], v2
v_smfmac_f32_16x16x64_bf16 v[104:107], v[40:43], a[160:167], v2
s_waitcnt lgkmcnt(4)
v_smfmac_f32_16x16x64_bf16 v[96:99], v[44:47], a[48:55], v2
v_smfmac_f32_16x16x64_bf16 v[104:107], v[44:47], a[176:183], v2
buffer_load_dwordx4 v1, s[4:7], s43 offen offset:1024 lds
s_waitcnt lgkmcnt(3)
v_smfmac_f32_16x16x64_bf16 v[96:99], v[48:51], a[64:71], v2
v_smfmac_f32_16x16x64_bf16 v[104:107], v[48:51], a[192:199], v2
s_waitcnt lgkmcnt(2)
v_smfmac_f32_16x16x64_bf16 v[96:99], v[52:55], a[80:87], v2
v_smfmac_f32_16x16x64_bf16 v[104:107], v[52:55], a[208:215], v2
v_mov_b32 v4, s21
buffer_store_dword v4, v7, s[4:7], 0 offen sc1
s_waitcnt lgkmcnt(1)
v_smfmac_f32_16x16x64_bf16 v[96:99], v[56:59], a[96:103], v2
v_smfmac_f32_16x16x64_bf16 v[104:107], v[56:59], a[224:231], v2
s_waitcnt lgkmcnt(0)
v_smfmac_f32_16x16x64_bf16 v[96:99], v[60:63], a[112:119], v2
v_smfmac_f32_16x16x64_bf16 v[104:107], v[60:63], a[240:247], v2
v_smfmac_f32_16x16x64_bf16 v[100:103], v[40:43], a[40:47], v2
s_nop 2
v_smfmac_f32_16x16x64_bf16 v[100:103], v[44:47], a[56:63], v2
s_nop 1
v_add_f32 v96, v96, v98
v_smfmac_f32_16x16x64_bf16 v[100:103], v[48:51], a[72:79], v2
v_add_f32 v97, v97, v99
v_add_f32 v104, v104, v106
v_smfmac_f32_16x16x64_bf16 v[100:103], v[52:55], a[88:95], v2
v_add_f32 v105, v105, v107
v_cvt_pk_bf16_f32 v96, v96, v97
v_smfmac_f32_16x16x64_bf16 v[100:103], v[56:59], a[104:111], v2
v_cvt_pk_bf16_f32 v97, v104, v105
v_and_or_b32 v96, v96, -2, s41
v_smfmac_f32_16x16x64_bf16 v[100:103], v[60:63], a[120:127], v2
buffer_store_dwordx2 v[96:97], v11, s[4:7], s37 offen sc1
v_smfmac_f32_16x16x64_bf16 v[108:111], v[40:43], a[168:175], v2
v_smfmac_f32_16x16x64_bf16 v[108:111], v[44:47], a[184:191], v2
v_smfmac_f32_16x16x64_bf16 v[108:111], v[48:51], a[200:207], v2
v_smfmac_f32_16x16x64_bf16 v[108:111], v[52:55], a[216:223], v2
v_smfmac_f32_16x16x64_bf16 v[108:111], v[56:59], a[232:239], v2
s_nop 2
v_add_f32 v100, v100, v102
v_smfmac_f32_16x16x64_bf16 v[108:111], v[60:63], a[248:255], v2
v_add_f32 v101, v101, v103
v_cvt_pk_bf16_f32 v98, v100, v101
v_and_or_b32 v98, v98, -2, s41
s_nop 4
v_pk_add_f32 v[108:109], v[108:109], v[110:111]
v_cvt_pk_bf16_f32 v99, v108, v109
buffer_store_dwordx2 v[98:99], v11, s[4:7], s37 offen offset:512 sc1
v_smfmac_f32_16x16x64_bf16 v[112:115], v[32:35], v[64:71], v2
ds_read_b128 v[64:67], v1 offset:32768
ds_read_b128 v[68:71], v1 offset:33792
v_smfmac_f32_16x16x64_bf16 v[116:119], v[32:35], v[72:79], v2
ds_read_b128 v[72:75], v1 offset:34816
ds_read_b128 v[76:79], v1 offset:35840
v_smfmac_f32_16x16x64_bf16 v[112:115], v[36:39], v[80:87], v2
ds_read_b128 v[80:83], v1 offset:49152
ds_read_b128 v[84:87], v1 offset:50176
v_smfmac_f32_16x16x64_bf16 v[116:119], v[36:39], v[88:95], v2
ds_read_b128 v[88:91], v1 offset:51200
ds_read_b128 v[92:95], v1 offset:52224
s_waitcnt lgkmcnt(6)
v_smfmac_f32_16x16x64_bf16 v[112:115], v[40:43], v[64:71], v2
ds_read_b128 v[64:67], v5
ds_read_b128 v[68:71], v5 offset:1024
s_waitcnt lgkmcnt(6)
v_smfmac_f32_16x16x64_bf16 v[116:119], v[40:43], v[72:79], v2
ds_read_b128 v[72:75], v5 offset:2048
ds_read_b128 v[76:79], v5 offset:3072
s_waitcnt lgkmcnt(6)
v_smfmac_f32_16x16x64_bf16 v[112:115], v[44:47], v[80:87], v2
ds_read_b128 v[80:83], v5 offset:16384
ds_read_b128 v[84:87], v5 offset:17408
s_waitcnt lgkmcnt(6)
v_smfmac_f32_16x16x64_bf16 v[116:119], v[44:47], v[88:95], v2
ds_read_b128 v[88:91], v5 offset:18432
ds_read_b128 v[92:95], v5 offset:19456
s_waitcnt lgkmcnt(6)
v_smfmac_f32_16x16x64_bf16 v[112:115], v[48:51], v[64:71], v2
ds_read_b128 v[64:67], v5 offset:32768
ds_read_b128 v[68:71], v5 offset:33792
s_waitcnt lgkmcnt(6)
v_smfmac_f32_16x16x64_bf16 v[116:119], v[48:51], v[72:79], v2
ds_read_b128 v[72:75], v5 offset:34816
ds_read_b128 v[76:79], v5 offset:35840
s_waitcnt lgkmcnt(6)
v_smfmac_f32_16x16x64_bf16 v[112:115], v[52:55], v[80:87], v2
ds_read_b128 v[80:83], v5 offset:49152
ds_read_b128 v[84:87], v5 offset:50176
s_waitcnt lgkmcnt(6)
v_smfmac_f32_16x16x64_bf16 v[116:119], v[52:55], v[88:95], v2
ds_read_b128 v[88:91], v5 offset:51200
ds_read_b128 v[92:95], v5 offset:52224
s_waitcnt lgkmcnt(6)
v_smfmac_f32_16x16x64_bf16 v[112:115], v[56:59], v[64:71], v2
s_waitcnt lgkmcnt(4)
v_smfmac_f32_16x16x64_bf16 v[116:119], v[56:59], v[72:79], v2
s_waitcnt lgkmcnt(2)
v_smfmac_f32_16x16x64_bf16 v[112:115], v[60:63], v[80:87], v2
s_waitcnt lgkmcnt(0)
v_smfmac_f32_16x16x64_bf16 v[116:119], v[60:63], v[88:95], v2
buffer_load_dwordx2 v[108:109], v11, s[4:7], s38 offen sc1
v_mfma_f32_16x16x16_bf16 v[100:103], v[96:97], v[16:17], 0
v_mfma_f32_16x16x16_bf16 v[104:107], v[98:99], v[16:17], 0
s_nop 4
v_add_f32 v112, v112, v114
v_add_f32 v113, v113, v115
v_add_f32 v114, v116, v118
v_add_f32 v115, v117, v119
v_cvt_pk_bf16_f32 v18, v112, v113
v_cvt_pk_bf16_f32 v19, v114, v115
v_and_or_b32 v18, v18, -2, s41
buffer_load_dwordx2 v[110:111], v11, s[4:7], s38 offen offset:512 sc1
s_barrier
buffer_store_dwordx2 v[18:19], v11, s[4:7], s39 offen sc1
v_mov_b32 v112, v18
v_mov_b32 v114, v19
v_mov_b32 v92, v28
v_mov_b32 v93, 0
s_waitcnt vmcnt(6)
s_barrier
ds_read_b128 v[32:35], v6 offset:9216
ds_read_b128 v[36:39], v6 offset:10240
ds_read_b128 v[40:43], v6 offset:14336
ds_read_b128 v[44:47], v6 offset:15360
ds_read_b128 v[48:51], v6 offset:19456
ds_read_b128 v[52:55], v6 offset:20480
ds_read_b128 v[56:59], v6 offset:24576
ds_read_b128 v[60:63], v6 offset:25600
buffer_load_dwordx2 v[20:21], v11, s[4:7], s38 offen sc1
buffer_load_dwordx2 v[22:23], v11, s[4:7], s38 offen offset:512 sc1
s_waitcnt vmcnt(4)
v_mfma_f32_16x16x16_bf16 v[80:83], v[108:109], v[16:17], v[100:103]
v_and_b32 v3, 1, v108
v_cmp_ne_u32 vcc, s41, v3
s_nop 5
v_cvt_pk_bf16_f32 v64, v80, v81
v_cvt_pk_bf16_f32 v65, v82, v83
s_cbranch_vccnz L_rf_w0_xslow
s_waitcnt vmcnt(3)
v_mfma_f32_16x16x16_bf16 v[84:87], v[110:111], v[16:17], v[104:107]
v_and_b32 v3, 1, v110
v_cmp_ne_u32 vcc, s41, v3
s_nop 5
v_cvt_pk_bf16_f32 v66, v84, v85
v_cvt_pk_bf16_f32 v67, v86, v87
ds_write_b128 v6, v[64:67] offset:8192
s_cbranch_vccnz L_rf_w0_xslow
L_rf_w0_xok:
s_cmp_eq_u32 s21, 63
s_cbranch_scc1 L_rf_w0_last
buffer_load_dwordx2 v[116:117], v11, s[4:7], s40 offen sc1
s_waitcnt lgkmcnt(1)
v_mfma_f32_16x16x32_bf16 v[80:83], v[32:35], v[64:67], 0
s_waitcnt lgkmcnt(0)
s_barrier
ds_read_b128 v[68:71], v6 offset:13312
ds_read_b128 v[72:75], v6 offset:18432
ds_read_b128 v[76:79], v6 offset:23552
v_mfma_f32_16x16x32_bf16 v[84:87], v[36:39], v[64:67], 0
v_mfma_f32_16x16x32_bf16 v[88:91], v[64:67], v[64:67], 0
buffer_load_dwordx2 v[20:21], v11, s[4:7], s40 offen sc1
s_waitcnt lgkmcnt(2)
v_mfma_f32_16x16x32_bf16 v[80:83], v[40:43], v[68:71], v[80:83]
buffer_store_dwordx4 v[64:67], v10, s[4:7], s45 offen sc1
s_waitcnt lgkmcnt(1)
v_mfma_f32_16x16x32_bf16 v[80:83], v[48:51], v[72:75], v[80:83]
s_waitcnt lgkmcnt(0)
v_mfma_f32_16x16x32_bf16 v[80:83], v[56:59], v[76:79], v[80:83]
v_mfma_f32_16x16x32_bf16 v[84:87], v[44:47], v[68:71], v[84:87]
v_mfma_f32_16x16x32_bf16 v[84:87], v[52:55], v[72:75], v[84:87]
buffer_store_dwordx2 v[18:19], v11, s[4:7], s51 offen offset:2048 sc1
v_mfma_f32_16x16x32_bf16 v[84:87], v[60:63], v[76:79], v[84:87]
v_mfma_f32_16x16x32_bf16 v[88:91], v[68:71], v[68:71], v[88:91]
v_mfma_f32_16x16x32_bf16 v[88:91], v[72:75], v[72:75], v[88:91]
v_mfma_f32_16x16x32_bf16 v[88:91], v[76:79], v[76:79], v[88:91]
v_mfma_f32_32x32x4_2b_bf16 v[32:63], v[14:15], v[14:15], 0
s_nop 0
v_max3_f32 v4, v80, v81, v82
s_nop 1
v_max3_f32 v4, v4, v83, v84
v_max3_f32 v4, v4, v85, v86
v_max_f32 v4, v4, v87
v_max3_f32 v90, v4, v88, v89
v_max3_f32 v4, v4, v88, v89
s_nop 1
v_permlane16_swap_b32 v4, v90
v_max_f32 v4, v4, v90
v_max_f32 v90, v4, v90
s_nop 1
v_permlane32_swap_b32 v4, v90
v_max_f32 v4, v4, v90
v_mul_f32 v4, s34, v4
v_pk_fma_f32 v[80:81], v[80:81], s[34:35], v[4:5] op_sel_hi:[1,0,0] neg_lo:[0,0,1] neg_hi:[0,0,1]
v_pk_fma_f32 v[82:83], v[82:83], s[34:35], v[4:5] op_sel_hi:[1,0,0] neg_lo:[0,0,1] neg_hi:[0,0,1]
v_pk_fma_f32 v[84:85], v[84:85], s[34:35], v[4:5] op_sel_hi:[1,0,0] neg_lo:[0,0,1] neg_hi:[0,0,1]
v_pk_fma_f32 v[86:87], v[86:87], s[34:35], v[4:5] op_sel_hi:[1,0,0] neg_lo:[0,0,1] neg_hi:[0,0,1]
v_pk_fma_f32 v[88:89], v[88:89], s[34:35], v[4:5] op_sel_hi:[1,0,0] neg_lo:[0,0,1] neg_hi:[0,0,1]
v_exp_f32 v80, v80
v_exp_f32 v81, v81
v_exp_f32 v82, v82
v_cvt_pk_bf16_f32 v68, v80, v81
v_exp_f32 v83, v83
v_exp_f32 v84, v84
v_cvt_pk_bf16_f32 v69, v82, v83
v_exp_f32 v85, v85
v_exp_f32 v86, v86
v_cvt_pk_bf16_f32 v70, v84, v85
v_exp_f32 v87, v87
v_exp_f32 v88, v88
v_cvt_pk_bf16_f32 v71, v86, v87
v_exp_f32 v89, v89
s_waitcnt vmcnt(3)
v_mfma_f32_16x16x32_bf16 v[76:79], v[28:31], v[68:71], 0
v_and_b32 v3, 1, v116
v_cvt_pk_bf16_f32 v72, v88, v89
v_mfma_f32_16x16x32_bf16 v[100:103], v[120:123], v[68:71], 0
v_cmp_ne_u32 vcc, s41, v3
v_cvt_pk_bf16_f32 v73, v88, v89
v_mfma_f32_16x16x32_bf16 v[104:107], v[124:127], v[68:71], 0
v_mov_b32 v113, v116
v_mov_b32 v115, v117
v_mfma_f32_16x16x16_bf16 v[76:79], v[92:93], v[72:73], v[76:79]
s_cbranch_vccnz L_rf_w0_pv0
L_rf_w0_pv2:
v_mfma_f32_16x16x16_bf16 v[100:103], v[112:113], v[72:73], v[100:103]
v_mfma_f32_16x16x16_bf16 v[104:107], v[114:115], v[72:73], v[104:107]
buffer_load_dwordx4 v[120:123], v1, s[4:7], s44 offen
buffer_load_dwordx4 v[124:127], v1, s[4:7], s44 offen offset:1024
s_nop 2
v_rcp_f32 v76, v76
s_mov_b64 exec, s[28:29]
v_pk_mul_f32 v[100:101], v[100:101], v[76:77] op_sel_hi:[1,0]
v_pk_mul_f32 v[102:103], v[102:103], v[76:77] op_sel_hi:[1,0]
v_pk_mul_f32 v[104:105], v[104:105], v[76:77] op_sel_hi:[1,0]
v_pk_mul_f32 v[106:107], v[106:107], v[76:77] op_sel_hi:[1,0]
v_cvt_pk_bf16_f32 v84, v100, v101
v_cvt_pk_bf16_f32 v85, v102, v103
v_cvt_pk_bf16_f32 v86, v104, v105
v_cvt_pk_bf16_f32 v87, v106, v107
ds_write_b128 v6, v[84:87] offset:28640
s_mov_b64 exec, -1
s_waitcnt lgkmcnt(0)
s_barrier
ds_read_b128 v[68:71], v6 offset:28672
ds_read_b128 v[72:75], v6 offset:29696
s_waitcnt lgkmcnt(1)
v_smfmac_f32_16x16x64_bf16 v[32:35], v[68:71], v[128:135], v2
s_add_u32 s21, s21, 1
s_xor_b32 s38, s38, 1048576
s_xor_b32 s37, s37, 1048576
s_waitcnt lgkmcnt(0)
v_smfmac_f32_16x16x64_bf16 v[32:35], v[72:75], v[136:143], v2
s_xor_b32 s40, s40, 1048576
s_xor_b32 s39, s39, 1048576
s_lshr_b32 s41, s21, 1
v_smfmac_f32_16x16x64_bf16 v[36:39], v[68:71], v[144:151], v2
s_and_b32 s41, s41, 1
s_xor_b32 s41, s41, 1
s_xor_b32 s35, s35, 16384
v_smfmac_f32_16x16x64_bf16 v[36:39], v[72:75], v[152:159], v2
v_add_f32 v32, v32, v34
s_xor_b32 s36, s36, 16384
s_add_u32 s43, s43, 262144
s_add_u32 s44, s44, 262144
v_smfmac_f32_16x16x64_bf16 v[40:43], v[68:71], v[160:167], v2
v_add_f32 v33, v33, v35
v_smfmac_f32_16x16x64_bf16 v[40:43], v[72:75], v[168:175], v2
v_cvt_pk_bf16_f32 v32, v32, v33
v_smfmac_f32_16x16x64_bf16 v[44:47], v[68:71], v[176:183], v2
v_and_or_b32 v32, v32, -2, s42
v_smfmac_f32_16x16x64_bf16 v[44:47], v[72:75], v[184:191], v2
v_add_f32 v36, v36, v38
v_smfmac_f32_16x16x64_bf16 v[48:51], v[68:71], v[192:199], v2
v_add_f32 v37, v37, v39
v_smfmac_f32_16x16x64_bf16 v[48:51], v[72:75], v[200:207], v2
v_cvt_pk_bf16_f32 v33, v36, v37
v_smfmac_f32_16x16x64_bf16 v[52:55], v[68:71], v[208:215], v2
v_add_f32 v40, v40, v42
v_smfmac_f32_16x16x64_bf16 v[52:55], v[72:75], v[216:223], v2
v_add_f32 v41, v41, v43
v_smfmac_f32_16x16x64_bf16 v[56:59], v[68:71], v[224:231], v2
v_cvt_pk_bf16_f32 v34, v40, v41
v_smfmac_f32_16x16x64_bf16 v[56:59], v[72:75], v[232:239], v2
v_add_f32 v44, v44, v46
v_smfmac_f32_16x16x64_bf16 v[60:63], v[68:71], v[240:247], v2
v_add_f32 v45, v45, v47
v_smfmac_f32_16x16x64_bf16 v[60:63], v[72:75], v[248:255], v2
v_cvt_pk_bf16_f32 v35, v44, v45
buffer_store_dwordx4 v[32:35], v8, s[4:7], s46 offen
v_pk_add_f32 v[48:49], v[48:49], v[50:51]
v_cvt_pk_bf16_f32 v48, v48, v49
v_and_or_b32 v48, v48, -2, s42
v_pk_add_f32 v[52:53], v[52:53], v[54:55]
v_cvt_pk_bf16_f32 v49, v52, v53
v_pk_add_f32 v[56:57], v[56:57], v[58:59]
v_cvt_pk_bf16_f32 v50, v56, v57
v_pk_add_f32 v[60:61], v[60:61], v[62:63]
v_cvt_pk_bf16_f32 v51, v60, v61
buffer_store_dwordx4 v[48:51], v8, s[4:7], s61 offen
s_add_u32 s45, s45, 262144
s_add_u32 s51, s51, 262144
v_mfma_f32_32x32x8_bf16 v[96:111], v[14:15], v[14:15], 0
v_mfma_f32_16x16x16_bf16 v[112:115], v[14:15], v[14:15], 0
v_mfma_f32_16x16x16_bf16 v[116:119], v[14:15], v[14:15], 0
ds_read_b128 v[64:67], v1
ds_read_b128 v[68:71], v1 offset:1024
ds_read_b128 v[72:75], v1 offset:2048
ds_read_b128 v[76:79], v1 offset:3072
ds_read_b128 v[80:83], v1 offset:16384
ds_read_b128 v[84:87], v1 offset:17408
ds_read_b128 v[88:91], v1 offset:18432
ds_read_b128 v[92:95], v1 offset:19456
v_mov_b32 v58, -1
v_mov_b32 v59, -1
s_waitcnt vmcnt(0)
L_rf_w0_cgo:
L_rf_w0_pc:
buffer_load_dword v36, v13, s[4:7], s25 offen sc1
buffer_load_dword v37, v13, s[4:7], s25 offen offset:256 sc1
buffer_load_dword v38, v13, s[4:7], s25 offen offset:512 sc1
buffer_load_dword v39, v13, s[4:7], s25 offen offset:768 sc1
buffer_load_dword v40, v13, s[4:7], s25 offen offset:1024 sc1
buffer_load_dword v41, v13, s[4:7], s25 offen offset:1280 sc1
buffer_load_dword v42, v13, s[4:7], s25 offen offset:1536 sc1
buffer_load_dword v43, v13, s[4:7], s25 offen offset:1792 sc1
s_waitcnt vmcnt(4)
v_mfma_f32_16x16x32_bf16 v[52:55], v[36:39], v[24:27], 0
v_bitop3_b32 v3, s42, v36, v37 bitop3:0x7e
v_bitop3_b32 v4, s42, v38, v39 bitop3:0x7e
s_waitcnt vmcnt(2)
v_or_b32 v3, v3, v4
v_bitop3_b32 v4, s42, v40, v41 bitop3:0x7e
s_waitcnt vmcnt(0)
v_mfma_f32_16x16x32_bf16 v[52:55], v[40:43], v[24:27], v[52:55]
v_bitop3_b32 v56, s42, v42, v43 bitop3:0x7e
v_or3_b32 v3, v3, v4, v56
v_and_b32 v3, v0, v3
v_cmp_ne_u32 vcc, 0, v3
s_nop 3
v_cvt_pk_bf16_f32 v56, v52, v53
v_cvt_pk_bf16_f32 v57, v54, v55
v_min_u32 v56, -2, v56
s_cbranch_vccnz L_rf_w0_pc
s_mov_b64 exec, s[26:27]
buffer_store_dwordx2 v[56:57], v9, s[4:7], s35 offen
buffer_store_dwordx2 v[58:59], v9, s[4:7], s36 offen
s_mov_b64 exec, -1
s_xor_b32 s42, s42, 1
s_branch L_rf_w0_loop
L_rf_w0_last:
buffer_store_dwordx4 v[64:67], v10, s[4:7], s45 offen sc1
buffer_store_dwordx2 v[18:19], v11, s[4:7], s51 offen offset:2048 sc1
s_branch L_rf_end
L_rf_w0_pafail:
s_nop 7
v_mov_b32 v96, 0
v_mov_b32 v97, 0
v_mov_b32 v98, 0
v_mov_b32 v99, 0
v_mov_b32 v100, 0
v_mov_b32 v101, 0
v_mov_b32 v102, 0
v_mov_b32 v103, 0
v_mov_b32 v104, 0
v_mov_b32 v105, 0
v_mov_b32 v106, 0
v_mov_b32 v107, 0
s_branch L_rf_w0_pa
L_rf_w0_xslow:
buffer_load_dwordx2 v[108:109], v11, s[4:7], s38 offen sc1
buffer_load_dwordx2 v[110:111], v11, s[4:7], s38 offen offset:512 sc1
s_waitcnt vmcnt(2)
v_bitop3_b32 v3, s41, v20, v22 bitop3:0x7e
v_mfma_f32_16x16x16_bf16 v[80:83], v[20:21], v[16:17], v[100:103]
v_and_b32 v3, 1, v3
v_mfma_f32_16x16x16_bf16 v[84:87], v[22:23], v[16:17], v[104:107]
v_cmp_ne_u32 vcc, 0, v3
s_cbranch_vccz L_rf_w0_xgot
buffer_load_dwordx2 v[20:21], v11, s[4:7], s38 offen sc1
buffer_load_dwordx2 v[22:23], v11, s[4:7], s38 offen offset:512 sc1
s_waitcnt vmcnt(2)
v_bitop3_b32 v3, s41, v108, v110 bitop3:0x7e
v_mfma_f32_16x16x16_bf16 v[80:83], v[108:109], v[16:17], v[100:103]
v_and_b32 v3, 1, v3
v_mfma_f32_16x16x16_bf16 v[84:87], v[110:111], v[16:17], v[104:107]
v_cmp_ne_u32 vcc, 0, v3
s_cbranch_vccz L_rf_w0_xgot
s_branch L_rf_w0_xslow
L_rf_w0_xgot:
s_nop 3
v_cvt_pk_bf16_f32 v64, v80, v81
v_cvt_pk_bf16_f32 v65, v82, v83
v_cvt_pk_bf16_f32 v66, v84, v85
v_cvt_pk_bf16_f32 v67, v86, v87
ds_write_b128 v6, v[64:67] offset:8192
s_branch L_rf_w0_xok
L_rf_w0_pv0:
s_waitcnt vmcnt(2)
s_branch L_rf_w0_pv1
L_rf_w0_pv:
buffer_load_dwordx2 v[20:21], v11, s[4:7], s40 offen sc1
s_waitcnt vmcnt(0)
L_rf_w0_pv1:
v_and_b32 v3, 1, v20
v_cmp_ne_u32 vcc, s41, v3
v_mov_b32 v113, v20
v_mov_b32 v115, v21
s_cbranch_vccnz L_rf_w0_pv
s_branch L_rf_w0_pv2
L_rf_w1_entry:
v_mfma_f32_32x32x8_bf16 v[96:111], v[14:15], v[14:15], 0
v_mfma_f32_16x16x16_bf16 v[112:115], v[14:15], v[14:15], 0
v_mfma_f32_16x16x16_bf16 v[116:119], v[14:15], v[14:15], 0
ds_read_b128 v[64:67], v1 offset:4096
ds_read_b128 v[68:71], v1 offset:5120
ds_read_b128 v[72:75], v1 offset:6144
ds_read_b128 v[76:79], v1 offset:7168
ds_read_b128 v[80:83], v1 offset:20480
ds_read_b128 v[84:87], v1 offset:21504
ds_read_b128 v[88:91], v1 offset:22528
ds_read_b128 v[92:95], v1 offset:23552
buffer_load_dwordx4 v[120:123], v1, s[4:7], s44 offen
buffer_load_dwordx4 v[124:127], v1, s[4:7], s44 offen offset:1024
s_add_u32 s44, s44, 262144
L_rf_w1_loop:
s_add_u32 s22, s35, 2048
s_waitcnt vmcnt(0)
buffer_load_dwordx4 v[40:43], v1, s[4:7], s22 offen sc1
buffer_load_dwordx4 v[44:47], v1, s[4:7], s22 offen offset:1024 sc1
L_rf_w1_pa:
s_waitcnt vmcnt(1)
ds_write_b128 v6, v[40:43] offset:2048
s_waitcnt vmcnt(0)
ds_write_b128 v6, v[44:47] offset:3072
v_max3_u32 v3, v40, v42, v44
v_max_u32 v3, v3, v46
v_cmp_eq_u32 vcc, -1, v3
v_smfmac_f32_16x16x64_bf16 v[96:99], v[40:43], a[32:39], v2
buffer_load_dwordx4 v[40:43], v1, s[4:7], s22 offen sc1
v_smfmac_f32_16x16x64_bf16 v[100:103], v[40:43], a[40:47], v2
buffer_load_dwordx4 v[44:47], v1, s[4:7], s22 offen offset:1024 sc1
v_smfmac_f32_16x16x64_bf16 v[104:107], v[40:43], a[160:167], v2
s_cbranch_vccnz L_rf_w1_pafail
s_waitcnt lgkmcnt(0)
s_barrier
ds_read_b128 v[48:51], v6 offset:4096
ds_read_b128 v[52:55], v6 offset:5120
v_smfmac_f32_16x16x64_bf16 v[108:111], v[40:43], a[168:175], v2
ds_read_b128 v[56:59], v6 offset:6144
v_smfmac_f32_16x16x64_bf16 v[96:99], v[44:47], a[48:55], v2
ds_read_b128 v[60:63], v6 offset:7168
v_smfmac_f32_16x16x64_bf16 v[100:103], v[44:47], a[56:63], v2
ds_read_b128 v[32:35], v6
v_smfmac_f32_16x16x64_bf16 v[104:107], v[44:47], a[176:183], v2
ds_read_b128 v[36:39], v6 offset:1024
v_smfmac_f32_16x16x64_bf16 v[108:111], v[44:47], a[184:191], v2
s_waitcnt lgkmcnt(5)
v_smfmac_f32_16x16x64_bf16 v[96:99], v[48:51], a[64:71], v2
buffer_load_dwordx4 v1, s[4:7], s43 offen lds
v_smfmac_f32_16x16x64_bf16 v[104:107], v[48:51], a[192:199], v2
s_waitcnt lgkmcnt(4)
v_smfmac_f32_16x16x64_bf16 v[96:99], v[52:55], a[80:87], v2
v_smfmac_f32_16x16x64_bf16 v[104:107], v[52:55], a[208:215], v2
s_waitcnt lgkmcnt(3)
v_smfmac_f32_16x16x64_bf16 v[96:99], v[56:59], a[96:103], v2
buffer_load_dwordx4 v1, s[4:7], s43 offen offset:1024 lds
v_smfmac_f32_16x16x64_bf16 v[104:107], v[56:59], a[224:231], v2
s_waitcnt lgkmcnt(2)
v_smfmac_f32_16x16x64_bf16 v[96:99], v[60:63], a[112:119], v2
v_smfmac_f32_16x16x64_bf16 v[104:107], v[60:63], a[240:247], v2
s_waitcnt lgkmcnt(1)
v_smfmac_f32_16x16x64_bf16 v[96:99], v[32:35], a[0:7], v2
v_smfmac_f32_16x16x64_bf16 v[104:107], v[32:35], a[128:135], v2
s_waitcnt lgkmcnt(0)
v_smfmac_f32_16x16x64_bf16 v[96:99], v[36:39], a[16:23], v2
v_smfmac_f32_16x16x64_bf16 v[104:107], v[36:39], a[144:151], v2
v_smfmac_f32_16x16x64_bf16 v[100:103], v[48:51], a[72:79], v2
s_nop 2
v_smfmac_f32_16x16x64_bf16 v[100:103], v[52:55], a[88:95], v2
s_nop 1
v_add_f32 v96, v96, v98
v_smfmac_f32_16x16x64_bf16 v[100:103], v[56:59], a[104:111], v2
v_add_f32 v97, v97, v99
v_add_f32 v104, v104, v106
v_smfmac_f32_16x16x64_bf16 v[100:103], v[60:63], a[120:127], v2
v_add_f32 v105, v105, v107
v_cvt_pk_bf16_f32 v96, v96, v97
v_smfmac_f32_16x16x64_bf16 v[100:103], v[32:35], a[8:15], v2
v_cvt_pk_bf16_f32 v97, v104, v105
v_and_or_b32 v96, v96, -2, s41
v_smfmac_f32_16x16x64_bf16 v[100:103], v[36:39], a[24:31], v2
buffer_store_dwordx2 v[96:97], v11, s[4:7], s37 offen sc1
v_smfmac_f32_16x16x64_bf16 v[108:111], v[48:51], a[200:207], v2
v_smfmac_f32_16x16x64_bf16 v[108:111], v[52:55], a[216:223], v2
v_smfmac_f32_16x16x64_bf16 v[108:111], v[56:59], a[232:239], v2
v_smfmac_f32_16x16x64_bf16 v[108:111], v[60:63], a[248:255], v2
v_smfmac_f32_16x16x64_bf16 v[108:111], v[32:35], a[136:143], v2
s_nop 2
v_add_f32 v100, v100, v102
v_smfmac_f32_16x16x64_bf16 v[108:111], v[36:39], a[152:159], v2
v_add_f32 v101, v101, v103
v_cvt_pk_bf16_f32 v98, v100, v101
v_and_or_b32 v98, v98, -2, s41
s_nop 4
v_pk_add_f32 v[108:109], v[108:109], v[110:111]
v_cvt_pk_bf16_f32 v99, v108, v109
buffer_store_dwordx2 v[98:99], v11, s[4:7], s37 offen offset:512 sc1
v_smfmac_f32_16x16x64_bf16 v[112:115], v[32:35], v[64:71], v2
ds_read_b128 v[64:67], v1 offset:36864
ds_read_b128 v[68:71], v1 offset:37888
v_smfmac_f32_16x16x64_bf16 v[116:119], v[32:35], v[72:79], v2
ds_read_b128 v[72:75], v1 offset:38912
ds_read_b128 v[76:79], v1 offset:39936
v_smfmac_f32_16x16x64_bf16 v[112:115], v[36:39], v[80:87], v2
ds_read_b128 v[80:83], v1 offset:53248
ds_read_b128 v[84:87], v1 offset:54272
v_smfmac_f32_16x16x64_bf16 v[116:119], v[36:39], v[88:95], v2
ds_read_b128 v[88:91], v1 offset:55296
ds_read_b128 v[92:95], v1 offset:56320
s_waitcnt lgkmcnt(6)
v_smfmac_f32_16x16x64_bf16 v[112:115], v[40:43], v[64:71], v2
ds_read_b128 v[64:67], v5 offset:4096
ds_read_b128 v[68:71], v5 offset:5120
s_waitcnt lgkmcnt(6)
v_smfmac_f32_16x16x64_bf16 v[116:119], v[40:43], v[72:79], v2
ds_read_b128 v[72:75], v5 offset:6144
ds_read_b128 v[76:79], v5 offset:7168
s_waitcnt lgkmcnt(6)
v_smfmac_f32_16x16x64_bf16 v[112:115], v[44:47], v[80:87], v2
ds_read_b128 v[80:83], v5 offset:20480
ds_read_b128 v[84:87], v5 offset:21504
s_waitcnt lgkmcnt(6)
v_smfmac_f32_16x16x64_bf16 v[116:119], v[44:47], v[88:95], v2
ds_read_b128 v[88:91], v5 offset:22528
ds_read_b128 v[92:95], v5 offset:23552
s_waitcnt lgkmcnt(6)
v_smfmac_f32_16x16x64_bf16 v[112:115], v[48:51], v[64:71], v2
ds_read_b128 v[64:67], v5 offset:36864
ds_read_b128 v[68:71], v5 offset:37888
s_waitcnt lgkmcnt(6)
v_smfmac_f32_16x16x64_bf16 v[116:119], v[48:51], v[72:79], v2
ds_read_b128 v[72:75], v5 offset:38912
ds_read_b128 v[76:79], v5 offset:39936
s_waitcnt lgkmcnt(6)
v_smfmac_f32_16x16x64_bf16 v[112:115], v[52:55], v[80:87], v2
ds_read_b128 v[80:83], v5 offset:53248
ds_read_b128 v[84:87], v5 offset:54272
s_waitcnt lgkmcnt(6)
v_smfmac_f32_16x16x64_bf16 v[116:119], v[52:55], v[88:95], v2
ds_read_b128 v[88:91], v5 offset:55296
ds_read_b128 v[92:95], v5 offset:56320
s_waitcnt lgkmcnt(6)
v_smfmac_f32_16x16x64_bf16 v[112:115], v[56:59], v[64:71], v2
s_waitcnt lgkmcnt(4)
v_smfmac_f32_16x16x64_bf16 v[116:119], v[56:59], v[72:79], v2
s_waitcnt lgkmcnt(2)
v_smfmac_f32_16x16x64_bf16 v[112:115], v[60:63], v[80:87], v2
s_waitcnt lgkmcnt(0)
v_smfmac_f32_16x16x64_bf16 v[116:119], v[60:63], v[88:95], v2
buffer_load_dwordx2 v[108:109], v11, s[4:7], s38 offen sc1
v_mfma_f32_16x16x16_bf16 v[100:103], v[96:97], v[16:17], 0
v_mfma_f32_16x16x16_bf16 v[104:107], v[98:99], v[16:17], 0
s_nop 4
v_add_f32 v112, v112, v114
v_add_f32 v113, v113, v115
v_add_f32 v114, v116, v118
v_add_f32 v115, v117, v119
v_cvt_pk_bf16_f32 v18, v112, v113
v_cvt_pk_bf16_f32 v19, v114, v115
v_and_or_b32 v18, v18, -2, s41
buffer_load_dwordx2 v[110:111], v11, s[4:7], s38 offen offset:512 sc1
s_barrier
buffer_store_dwordx2 v[18:19], v11, s[4:7], s39 offen sc1
v_mov_b32 v112, v18
v_mov_b32 v114, v19
v_mov_b32 v92, v28
v_mov_b32 v93, 0
s_waitcnt vmcnt(5)
s_barrier
ds_read_b128 v[32:35], v6 offset:14336
ds_read_b128 v[36:39], v6 offset:15360
ds_read_b128 v[40:43], v6 offset:9216
ds_read_b128 v[44:47], v6 offset:10240
ds_read_b128 v[48:51], v6 offset:24576
ds_read_b128 v[52:55], v6 offset:25600
ds_read_b128 v[56:59], v6 offset:19456
ds_read_b128 v[60:63], v6 offset:20480
buffer_load_dwordx2 v[20:21], v11, s[4:7], s38 offen sc1
buffer_load_dwordx2 v[22:23], v11, s[4:7], s38 offen offset:512 sc1
s_waitcnt vmcnt(4)
v_mfma_f32_16x16x16_bf16 v[80:83], v[108:109], v[16:17], v[100:103]
v_and_b32 v3, 1, v108
v_cmp_ne_u32 vcc, s41, v3
s_nop 5
v_cvt_pk_bf16_f32 v64, v80, v81
v_cvt_pk_bf16_f32 v65, v82, v83
s_cbranch_vccnz L_rf_w1_xslow
s_waitcnt vmcnt(3)
v_mfma_f32_16x16x16_bf16 v[84:87], v[110:111], v[16:17], v[104:107]
v_and_b32 v3, 1, v110
v_cmp_ne_u32 vcc, s41, v3
s_nop 5
v_cvt_pk_bf16_f32 v66, v84, v85
v_cvt_pk_bf16_f32 v67, v86, v87
ds_write_b128 v6, v[64:67] offset:13312
s_cbranch_vccnz L_rf_w1_xslow
L_rf_w1_xok:
s_cmp_eq_u32 s21, 63
s_cbranch_scc1 L_rf_w1_last
buffer_load_dwordx2 v[116:117], v11, s[4:7], s40 offen sc1
s_waitcnt lgkmcnt(1)
v_mfma_f32_16x16x32_bf16 v[80:83], v[32:35], v[64:67], 0
s_waitcnt lgkmcnt(0)
s_barrier
ds_read_b128 v[68:71], v6 offset:8192
ds_read_b128 v[72:75], v6 offset:23552
ds_read_b128 v[76:79], v6 offset:18432
v_mfma_f32_16x16x32_bf16 v[84:87], v[36:39], v[64:67], 0
v_mfma_f32_16x16x32_bf16 v[88:91], v[64:67], v[64:67], 0
buffer_load_dwordx2 v[20:21], v11, s[4:7], s40 offen sc1
s_waitcnt lgkmcnt(2)
v_mfma_f32_16x16x32_bf16 v[80:83], v[40:43], v[68:71], v[80:83]
s_waitcnt lgkmcnt(1)
v_mfma_f32_16x16x32_bf16 v[80:83], v[48:51], v[72:75], v[80:83]
buffer_store_dwordx4 v[64:67], v10, s[4:7], s45 offen offset:64 sc1
s_waitcnt lgkmcnt(0)
v_mfma_f32_16x16x32_bf16 v[80:83], v[56:59], v[76:79], v[80:83]
v_mfma_f32_16x16x32_bf16 v[84:87], v[44:47], v[68:71], v[84:87]
v_mfma_f32_16x16x32_bf16 v[84:87], v[52:55], v[72:75], v[84:87]
v_mfma_f32_16x16x32_bf16 v[84:87], v[60:63], v[76:79], v[84:87]
buffer_store_dwordx2 v[18:19], v11, s[4:7], s51 offen offset:2560 sc1
v_mfma_f32_16x16x32_bf16 v[88:91], v[68:71], v[68:71], v[88:91]
v_mfma_f32_16x16x32_bf16 v[88:91], v[72:75], v[72:75], v[88:91]
v_mfma_f32_16x16x32_bf16 v[88:91], v[76:79], v[76:79], v[88:91]
v_mfma_f32_32x32x4_2b_bf16 v[32:63], v[14:15], v[14:15], 0
s_nop 0
v_max3_f32 v4, v80, v81, v82
s_nop 1
v_max3_f32 v4, v4, v83, v84
v_max3_f32 v4, v4, v85, v86
v_max_f32 v4, v4, v87
v_max3_f32 v90, v4, v88, v89
v_max3_f32 v4, v4, v88, v89
s_nop 1
v_permlane16_swap_b32 v4, v90
v_max_f32 v4, v4, v90
v_max_f32 v90, v4, v90
s_nop 1
v_permlane32_swap_b32 v4, v90
v_max_f32 v4, v4, v90
v_mul_f32 v4, s34, v4
v_pk_fma_f32 v[80:81], v[80:81], s[34:35], v[4:5] op_sel_hi:[1,0,0] neg_lo:[0,0,1] neg_hi:[0,0,1]
v_pk_fma_f32 v[82:83], v[82:83], s[34:35], v[4:5] op_sel_hi:[1,0,0] neg_lo:[0,0,1] neg_hi:[0,0,1]
v_pk_fma_f32 v[84:85], v[84:85], s[34:35], v[4:5] op_sel_hi:[1,0,0] neg_lo:[0,0,1] neg_hi:[0,0,1]
v_pk_fma_f32 v[86:87], v[86:87], s[34:35], v[4:5] op_sel_hi:[1,0,0] neg_lo:[0,0,1] neg_hi:[0,0,1]
v_pk_fma_f32 v[88:89], v[88:89], s[34:35], v[4:5] op_sel_hi:[1,0,0] neg_lo:[0,0,1] neg_hi:[0,0,1]
v_exp_f32 v80, v80
v_exp_f32 v81, v81
v_exp_f32 v82, v82
v_cvt_pk_bf16_f32 v68, v80, v81
v_exp_f32 v83, v83
v_exp_f32 v84, v84
v_cvt_pk_bf16_f32 v69, v82, v83
v_exp_f32 v85, v85
v_exp_f32 v86, v86
v_cvt_pk_bf16_f32 v70, v84, v85
v_exp_f32 v87, v87
v_exp_f32 v88, v88
v_cvt_pk_bf16_f32 v71, v86, v87
v_exp_f32 v89, v89
s_waitcnt vmcnt(3)
v_mfma_f32_16x16x32_bf16 v[76:79], v[28:31], v[68:71], 0
v_and_b32 v3, 1, v116
v_cvt_pk_bf16_f32 v72, v88, v89
v_mfma_f32_16x16x32_bf16 v[100:103], v[120:123], v[68:71], 0
v_cmp_ne_u32 vcc, s41, v3
v_cvt_pk_bf16_f32 v73, v88, v89
v_mfma_f32_16x16x32_bf16 v[104:107], v[124:127], v[68:71], 0
v_mov_b32 v113, v116
v_mov_b32 v115, v117
v_mfma_f32_16x16x16_bf16 v[76:79], v[92:93], v[72:73], v[76:79]
s_cbranch_vccnz L_rf_w1_pv0
L_rf_w1_pv2:
v_mfma_f32_16x16x16_bf16 v[100:103], v[112:113], v[72:73], v[100:103]
v_mfma_f32_16x16x16_bf16 v[104:107], v[114:115], v[72:73], v[104:107]
buffer_load_dwordx4 v[120:123], v1, s[4:7], s44 offen
buffer_load_dwordx4 v[124:127], v1, s[4:7], s44 offen offset:1024
s_nop 2
v_rcp_f32 v76, v76
s_mov_b64 exec, s[28:29]
v_pk_mul_f32 v[100:101], v[100:101], v[76:77] op_sel_hi:[1,0]
v_pk_mul_f32 v[102:103], v[102:103], v[76:77] op_sel_hi:[1,0]
v_pk_mul_f32 v[104:105], v[104:105], v[76:77] op_sel_hi:[1,0]
v_pk_mul_f32 v[106:107], v[106:107], v[76:77] op_sel_hi:[1,0]
v_cvt_pk_bf16_f32 v84, v100, v101
v_cvt_pk_bf16_f32 v85, v102, v103
v_cvt_pk_bf16_f32 v86, v104, v105
v_cvt_pk_bf16_f32 v87, v106, v107
ds_write_b128 v6, v[84:87] offset:28672
s_mov_b64 exec, -1
s_waitcnt lgkmcnt(0)
s_barrier
ds_read_b128 v[68:71], v6 offset:28672
ds_read_b128 v[72:75], v6 offset:29696
s_waitcnt lgkmcnt(1)
v_smfmac_f32_16x16x64_bf16 v[32:35], v[68:71], v[128:135], v2
s_add_u32 s21, s21, 1
s_xor_b32 s38, s38, 1048576
s_xor_b32 s37, s37, 1048576
s_waitcnt lgkmcnt(0)
v_smfmac_f32_16x16x64_bf16 v[32:35], v[72:75], v[136:143], v2
s_xor_b32 s40, s40, 1048576
s_xor_b32 s39, s39, 1048576
s_lshr_b32 s41, s21, 1
v_smfmac_f32_16x16x64_bf16 v[36:39], v[68:71], v[144:151], v2
s_and_b32 s41, s41, 1
s_xor_b32 s41, s41, 1
s_xor_b32 s35, s35, 16384
v_smfmac_f32_16x16x64_bf16 v[36:39], v[72:75], v[152:159], v2
v_add_f32 v32, v32, v34
s_xor_b32 s36, s36, 16384
s_add_u32 s43, s43, 262144
s_add_u32 s44, s44, 262144
v_smfmac_f32_16x16x64_bf16 v[40:43], v[68:71], v[160:167], v2
v_add_f32 v33, v33, v35
v_smfmac_f32_16x16x64_bf16 v[40:43], v[72:75], v[168:175], v2
v_cvt_pk_bf16_f32 v32, v32, v33
v_smfmac_f32_16x16x64_bf16 v[44:47], v[68:71], v[176:183], v2
v_and_or_b32 v32, v32, -2, s42
v_smfmac_f32_16x16x64_bf16 v[44:47], v[72:75], v[184:191], v2
v_add_f32 v36, v36, v38
v_smfmac_f32_16x16x64_bf16 v[48:51], v[68:71], v[192:199], v2
v_add_f32 v37, v37, v39
v_smfmac_f32_16x16x64_bf16 v[48:51], v[72:75], v[200:207], v2
v_cvt_pk_bf16_f32 v33, v36, v37
v_smfmac_f32_16x16x64_bf16 v[52:55], v[68:71], v[208:215], v2
v_add_f32 v40, v40, v42
v_smfmac_f32_16x16x64_bf16 v[52:55], v[72:75], v[216:223], v2
v_add_f32 v41, v41, v43
v_smfmac_f32_16x16x64_bf16 v[56:59], v[68:71], v[224:231], v2
v_cvt_pk_bf16_f32 v34, v40, v41
v_smfmac_f32_16x16x64_bf16 v[56:59], v[72:75], v[232:239], v2
v_add_f32 v44, v44, v46
v_smfmac_f32_16x16x64_bf16 v[60:63], v[68:71], v[240:247], v2
v_add_f32 v45, v45, v47
v_smfmac_f32_16x16x64_bf16 v[60:63], v[72:75], v[248:255], v2
v_cvt_pk_bf16_f32 v35, v44, v45
buffer_store_dwordx4 v[32:35], v8, s[4:7], s46 offen
v_pk_add_f32 v[48:49], v[48:49], v[50:51]
v_cvt_pk_bf16_f32 v48, v48, v49
v_and_or_b32 v48, v48, -2, s42
v_pk_add_f32 v[52:53], v[52:53], v[54:55]
v_cvt_pk_bf16_f32 v49, v52, v53
v_pk_add_f32 v[56:57], v[56:57], v[58:59]
v_cvt_pk_bf16_f32 v50, v56, v57
v_pk_add_f32 v[60:61], v[60:61], v[62:63]
v_cvt_pk_bf16_f32 v51, v60, v61
buffer_store_dwordx4 v[48:51], v8, s[4:7], s61 offen
s_add_u32 s45, s45, 262144
s_add_u32 s51, s51, 262144
v_mfma_f32_32x32x8_bf16 v[96:111], v[14:15], v[14:15], 0
v_mfma_f32_16x16x16_bf16 v[112:115], v[14:15], v[14:15], 0
v_mfma_f32_16x16x16_bf16 v[116:119], v[14:15], v[14:15], 0
ds_read_b128 v[64:67], v1 offset:4096
ds_read_b128 v[68:71], v1 offset:5120
ds_read_b128 v[72:75], v1 offset:6144
ds_read_b128 v[76:79], v1 offset:7168
ds_read_b128 v[80:83], v1 offset:20480
ds_read_b128 v[84:87], v1 offset:21504
ds_read_b128 v[88:91], v1 offset:22528
ds_read_b128 v[92:95], v1 offset:23552
v_mov_b32 v58, -1
v_mov_b32 v59, -1
s_waitcnt vmcnt(0)
L_rf_w1_cgo:
L_rf_w1_pc:
buffer_load_dword v36, v13, s[4:7], s25 offen sc1
buffer_load_dword v37, v13, s[4:7], s25 offen offset:256 sc1
buffer_load_dword v38, v13, s[4:7], s25 offen offset:512 sc1
buffer_load_dword v39, v13, s[4:7], s25 offen offset:768 sc1
buffer_load_dword v40, v13, s[4:7], s25 offen offset:1024 sc1
buffer_load_dword v41, v13, s[4:7], s25 offen offset:1280 sc1
buffer_load_dword v42, v13, s[4:7], s25 offen offset:1536 sc1
buffer_load_dword v43, v13, s[4:7], s25 offen offset:1792 sc1
s_waitcnt vmcnt(4)
v_mfma_f32_16x16x32_bf16 v[52:55], v[36:39], v[24:27], 0
v_bitop3_b32 v3, s42, v36, v37 bitop3:0x7e
v_bitop3_b32 v4, s42, v38, v39 bitop3:0x7e
s_waitcnt vmcnt(2)
v_or_b32 v3, v3, v4
v_bitop3_b32 v4, s42, v40, v41 bitop3:0x7e
s_waitcnt vmcnt(0)
v_mfma_f32_16x16x32_bf16 v[52:55], v[40:43], v[24:27], v[52:55]
v_bitop3_b32 v56, s42, v42, v43 bitop3:0x7e
v_or3_b32 v3, v3, v4, v56
v_and_b32 v3, v0, v3
v_cmp_ne_u32 vcc, 0, v3
s_nop 3
v_cvt_pk_bf16_f32 v56, v52, v53
v_cvt_pk_bf16_f32 v57, v54, v55
v_min_u32 v56, -2, v56
s_cbranch_vccnz L_rf_w1_pc
s_mov_b64 exec, s[26:27]
buffer_store_dwordx2 v[56:57], v9, s[4:7], s35 offen offset:256
buffer_store_dwordx2 v[58:59], v9, s[4:7], s36 offen offset:256
s_mov_b64 exec, -1
s_xor_b32 s42, s42, 1
s_branch L_rf_w1_loop
L_rf_w1_last:
buffer_store_dwordx4 v[64:67], v10, s[4:7], s45 offen offset:64 sc1
buffer_store_dwordx2 v[18:19], v11, s[4:7], s51 offen offset:2560 sc1
s_branch L_rf_end
L_rf_w1_pafail:
s_nop 7
v_mov_b32 v96, 0
v_mov_b32 v97, 0
v_mov_b32 v98, 0
v_mov_b32 v99, 0
v_mov_b32 v100, 0
v_mov_b32 v101, 0
v_mov_b32 v102, 0
v_mov_b32 v103, 0
v_mov_b32 v104, 0
v_mov_b32 v105, 0
v_mov_b32 v106, 0
v_mov_b32 v107, 0
s_branch L_rf_w1_pa
L_rf_w1_xslow:
buffer_load_dwordx2 v[108:109], v11, s[4:7], s38 offen sc1
buffer_load_dwordx2 v[110:111], v11, s[4:7], s38 offen offset:512 sc1
s_waitcnt vmcnt(2)
v_bitop3_b32 v3, s41, v20, v22 bitop3:0x7e
v_mfma_f32_16x16x16_bf16 v[80:83], v[20:21], v[16:17], v[100:103]
v_and_b32 v3, 1, v3
v_mfma_f32_16x16x16_bf16 v[84:87], v[22:23], v[16:17], v[104:107]
v_cmp_ne_u32 vcc, 0, v3
s_cbranch_vccz L_rf_w1_xgot
buffer_load_dwordx2 v[20:21], v11, s[4:7], s38 offen sc1
buffer_load_dwordx2 v[22:23], v11, s[4:7], s38 offen offset:512 sc1
s_waitcnt vmcnt(2)
v_bitop3_b32 v3, s41, v108, v110 bitop3:0x7e
v_mfma_f32_16x16x16_bf16 v[80:83], v[108:109], v[16:17], v[100:103]
v_and_b32 v3, 1, v3
v_mfma_f32_16x16x16_bf16 v[84:87], v[110:111], v[16:17], v[104:107]
v_cmp_ne_u32 vcc, 0, v3
s_cbranch_vccz L_rf_w1_xgot
s_branch L_rf_w1_xslow
L_rf_w1_xgot:
s_nop 3
v_cvt_pk_bf16_f32 v64, v80, v81
v_cvt_pk_bf16_f32 v65, v82, v83
v_cvt_pk_bf16_f32 v66, v84, v85
v_cvt_pk_bf16_f32 v67, v86, v87
ds_write_b128 v6, v[64:67] offset:13312
s_branch L_rf_w1_xok
L_rf_w1_pv0:
s_waitcnt vmcnt(2)
s_branch L_rf_w1_pv1
L_rf_w1_pv:
buffer_load_dwordx2 v[20:21], v11, s[4:7], s40 offen sc1
s_waitcnt vmcnt(0)
L_rf_w1_pv1:
v_and_b32 v3, 1, v20
v_cmp_ne_u32 vcc, s41, v3
v_mov_b32 v113, v20
v_mov_b32 v115, v21
s_cbranch_vccnz L_rf_w1_pv
s_branch L_rf_w1_pv2
L_rf_w2_entry:
v_mfma_f32_32x32x8_bf16 v[96:111], v[14:15], v[14:15], 0
v_mfma_f32_16x16x16_bf16 v[112:115], v[14:15], v[14:15], 0
v_mfma_f32_16x16x16_bf16 v[116:119], v[14:15], v[14:15], 0
ds_read_b128 v[64:67], v1 offset:8192
ds_read_b128 v[68:71], v1 offset:9216
ds_read_b128 v[72:75], v1 offset:10240
ds_read_b128 v[76:79], v1 offset:11264
ds_read_b128 v[80:83], v1 offset:24576
ds_read_b128 v[84:87], v1 offset:25600
ds_read_b128 v[88:91], v1 offset:26624
ds_read_b128 v[92:95], v1 offset:27648
buffer_load_dwordx4 v[120:123], v1, s[4:7], s44 offen
buffer_load_dwordx4 v[124:127], v1, s[4:7], s44 offen offset:1024
s_add_u32 s44, s44, 262144
L_rf_w2_loop:
s_add_u32 s22, s35, 4096
s_waitcnt vmcnt(0)
buffer_load_dwordx4 v[48:51], v1, s[4:7], s22 offen sc1
buffer_load_dwordx4 v[52:55], v1, s[4:7], s22 offen offset:1024 sc1
L_rf_w2_pa:
s_waitcnt vmcnt(1)
ds_write_b128 v6, v[48:51] offset:4096
s_waitcnt vmcnt(0)
ds_write_b128 v6, v[52:55] offset:5120
v_max3_u32 v3, v48, v50, v52
v_max_u32 v3, v3, v54
v_cmp_eq_u32 vcc, -1, v3
v_smfmac_f32_16x16x64_bf16 v[96:99], v[48:51], a[64:71], v2
buffer_load_dwordx4 v[48:51], v1, s[4:7], s22 offen sc1
v_smfmac_f32_16x16x64_bf16 v[100:103], v[48:51], a[72:79], v2
buffer_load_dwordx4 v[52:55], v1, s[4:7], s22 offen offset:1024 sc1
v_smfmac_f32_16x16x64_bf16 v[104:107], v[48:51], a[192:199], v2
s_cbranch_vccnz L_rf_w2_pafail
s_waitcnt lgkmcnt(0)
s_barrier
ds_read_b128 v[56:59], v6 offset:6144
ds_read_b128 v[60:63], v6 offset:7168
v_smfmac_f32_16x16x64_bf16 v[108:111], v[48:51], a[200:207], v2
ds_read_b128 v[32:35], v6
v_smfmac_f32_16x16x64_bf16 v[96:99], v[52:55], a[80:87], v2
ds_read_b128 v[36:39], v6 offset:1024
v_smfmac_f32_16x16x64_bf16 v[100:103], v[52:55], a[88:95], v2
ds_read_b128 v[40:43], v6 offset:2048
v_smfmac_f32_16x16x64_bf16 v[104:107], v[52:55], a[208:215], v2
ds_read_b128 v[44:47], v6 offset:3072
v_smfmac_f32_16x16x64_bf16 v[108:111], v[52:55], a[216:223], v2
s_waitcnt lgkmcnt(5)
v_smfmac_f32_16x16x64_bf16 v[96:99], v[56:59], a[96:103], v2
v_smfmac_f32_16x16x64_bf16 v[104:107], v[56:59], a[224:231], v2
buffer_load_dwordx4 v1, s[4:7], s43 offen lds
s_waitcnt lgkmcnt(4)
v_smfmac_f32_16x16x64_bf16 v[96:99], v[60:63], a[112:119], v2
v_smfmac_f32_16x16x64_bf16 v[104:107], v[60:63], a[240:247], v2
s_waitcnt lgkmcnt(3)
v_smfmac_f32_16x16x64_bf16 v[96:99], v[32:35], a[0:7], v2
v_smfmac_f32_16x16x64_bf16 v[104:107], v[32:35], a[128:135], v2
buffer_load_dwordx4 v1, s[4:7], s43 offen offset:1024 lds
s_waitcnt lgkmcnt(2)
v_smfmac_f32_16x16x64_bf16 v[96:99], v[36:39], a[16:23], v2
v_smfmac_f32_16x16x64_bf16 v[104:107], v[36:39], a[144:151], v2
s_waitcnt lgkmcnt(1)
v_smfmac_f32_16x16x64_bf16 v[96:99], v[40:43], a[32:39], v2
v_smfmac_f32_16x16x64_bf16 v[104:107], v[40:43], a[160:167], v2
s_waitcnt lgkmcnt(0)
v_smfmac_f32_16x16x64_bf16 v[96:99], v[44:47], a[48:55], v2
v_smfmac_f32_16x16x64_bf16 v[104:107], v[44:47], a[176:183], v2
v_smfmac_f32_16x16x64_bf16 v[100:103], v[56:59], a[104:111], v2
s_nop 2
v_smfmac_f32_16x16x64_bf16 v[100:103], v[60:63], a[120:127], v2
s_nop 1
v_add_f32 v96, v96, v98
v_smfmac_f32_16x16x64_bf16 v[100:103], v[32:35], a[8:15], v2
v_add_f32 v97, v97, v99
v_add_f32 v104, v104, v106
v_smfmac_f32_16x16x64_bf16 v[100:103], v[36:39], a[24:31], v2
v_add_f32 v105, v105, v107
v_cvt_pk_bf16_f32 v96, v96, v97
v_smfmac_f32_16x16x64_bf16 v[100:103], v[40:43], a[40:47], v2
v_cvt_pk_bf16_f32 v97, v104, v105
v_and_or_b32 v96, v96, -2, s41
v_smfmac_f32_16x16x64_bf16 v[100:103], v[44:47], a[56:63], v2
buffer_store_dwordx2 v[96:97], v11, s[4:7], s37 offen sc1
v_smfmac_f32_16x16x64_bf16 v[108:111], v[56:59], a[232:239], v2
v_smfmac_f32_16x16x64_bf16 v[108:111], v[60:63], a[248:255], v2
v_smfmac_f32_16x16x64_bf16 v[108:111], v[32:35], a[136:143], v2
v_smfmac_f32_16x16x64_bf16 v[108:111], v[36:39], a[152:159], v2
v_smfmac_f32_16x16x64_bf16 v[108:111], v[40:43], a[168:175], v2
s_nop 2
v_add_f32 v100, v100, v102
v_smfmac_f32_16x16x64_bf16 v[108:111], v[44:47], a[184:191], v2
v_add_f32 v101, v101, v103
v_cvt_pk_bf16_f32 v98, v100, v101
v_and_or_b32 v98, v98, -2, s41
s_nop 4
v_pk_add_f32 v[108:109], v[108:109], v[110:111]
v_cvt_pk_bf16_f32 v99, v108, v109
buffer_store_dwordx2 v[98:99], v11, s[4:7], s37 offen offset:512 sc1
v_smfmac_f32_16x16x64_bf16 v[112:115], v[32:35], v[64:71], v2
ds_read_b128 v[64:67], v1 offset:40960
ds_read_b128 v[68:71], v1 offset:41984
v_smfmac_f32_16x16x64_bf16 v[116:119], v[32:35], v[72:79], v2
ds_read_b128 v[72:75], v1 offset:43008
ds_read_b128 v[76:79], v1 offset:44032
v_smfmac_f32_16x16x64_bf16 v[112:115], v[36:39], v[80:87], v2
ds_read_b128 v[80:83], v1 offset:57344
ds_read_b128 v[84:87], v1 offset:58368
v_smfmac_f32_16x16x64_bf16 v[116:119], v[36:39], v[88:95], v2
ds_read_b128 v[88:91], v1 offset:59392
ds_read_b128 v[92:95], v1 offset:60416
s_waitcnt lgkmcnt(6)
v_smfmac_f32_16x16x64_bf16 v[112:115], v[40:43], v[64:71], v2
ds_read_b128 v[64:67], v5 offset:8192
ds_read_b128 v[68:71], v5 offset:9216
s_waitcnt lgkmcnt(6)
v_smfmac_f32_16x16x64_bf16 v[116:119], v[40:43], v[72:79], v2
ds_read_b128 v[72:75], v5 offset:10240
ds_read_b128 v[76:79], v5 offset:11264
s_waitcnt lgkmcnt(6)
v_smfmac_f32_16x16x64_bf16 v[112:115], v[44:47], v[80:87], v2
ds_read_b128 v[80:83], v5 offset:24576
ds_read_b128 v[84:87], v5 offset:25600
s_waitcnt lgkmcnt(6)
v_smfmac_f32_16x16x64_bf16 v[116:119], v[44:47], v[88:95], v2
ds_read_b128 v[88:91], v5 offset:26624
ds_read_b128 v[92:95], v5 offset:27648
s_waitcnt lgkmcnt(6)
v_smfmac_f32_16x16x64_bf16 v[112:115], v[48:51], v[64:71], v2
ds_read_b128 v[64:67], v5 offset:40960
ds_read_b128 v[68:71], v5 offset:41984
s_waitcnt lgkmcnt(6)
v_smfmac_f32_16x16x64_bf16 v[116:119], v[48:51], v[72:79], v2
ds_read_b128 v[72:75], v5 offset:43008
ds_read_b128 v[76:79], v5 offset:44032
s_waitcnt lgkmcnt(6)
v_smfmac_f32_16x16x64_bf16 v[112:115], v[52:55], v[80:87], v2
ds_read_b128 v[80:83], v5 offset:57344
ds_read_b128 v[84:87], v5 offset:58368
s_waitcnt lgkmcnt(6)
v_smfmac_f32_16x16x64_bf16 v[116:119], v[52:55], v[88:95], v2
ds_read_b128 v[88:91], v5 offset:59392
ds_read_b128 v[92:95], v5 offset:60416
s_waitcnt lgkmcnt(6)
v_smfmac_f32_16x16x64_bf16 v[112:115], v[56:59], v[64:71], v2
s_waitcnt lgkmcnt(4)
v_smfmac_f32_16x16x64_bf16 v[116:119], v[56:59], v[72:79], v2
s_waitcnt lgkmcnt(2)
v_smfmac_f32_16x16x64_bf16 v[112:115], v[60:63], v[80:87], v2
s_waitcnt lgkmcnt(0)
v_smfmac_f32_16x16x64_bf16 v[116:119], v[60:63], v[88:95], v2
buffer_load_dwordx2 v[108:109], v11, s[4:7], s38 offen sc1
v_mfma_f32_16x16x16_bf16 v[100:103], v[96:97], v[16:17], 0
v_mfma_f32_16x16x16_bf16 v[104:107], v[98:99], v[16:17], 0
s_nop 4
v_add_f32 v112, v112, v114
v_add_f32 v113, v113, v115
v_add_f32 v114, v116, v118
v_add_f32 v115, v117, v119
v_cvt_pk_bf16_f32 v18, v112, v113
v_cvt_pk_bf16_f32 v19, v114, v115
v_and_or_b32 v18, v18, -2, s41
buffer_load_dwordx2 v[110:111], v11, s[4:7], s38 offen offset:512 sc1
s_barrier
buffer_store_dwordx2 v[18:19], v11, s[4:7], s39 offen sc1
v_mov_b32 v112, v18
v_mov_b32 v114, v19
v_mov_b32 v92, v28
v_mov_b32 v93, 0
s_waitcnt vmcnt(5)
s_barrier
ds_read_b128 v[32:35], v6 offset:19456
ds_read_b128 v[36:39], v6 offset:20480
ds_read_b128 v[40:43], v6 offset:24576
ds_read_b128 v[44:47], v6 offset:25600
ds_read_b128 v[48:51], v6 offset:9216
ds_read_b128 v[52:55], v6 offset:10240
ds_read_b128 v[56:59], v6 offset:14336
ds_read_b128 v[60:63], v6 offset:15360
buffer_load_dwordx2 v[20:21], v11, s[4:7], s38 offen sc1
buffer_load_dwordx2 v[22:23], v11, s[4:7], s38 offen offset:512 sc1
s_waitcnt vmcnt(4)
v_mfma_f32_16x16x16_bf16 v[80:83], v[108:109], v[16:17], v[100:103]
v_and_b32 v3, 1, v108
v_cmp_ne_u32 vcc, s41, v3
s_nop 5
v_cvt_pk_bf16_f32 v64, v80, v81
v_cvt_pk_bf16_f32 v65, v82, v83
s_cbranch_vccnz L_rf_w2_xslow
s_waitcnt vmcnt(3)
v_mfma_f32_16x16x16_bf16 v[84:87], v[110:111], v[16:17], v[104:107]
v_and_b32 v3, 1, v110
v_cmp_ne_u32 vcc, s41, v3
s_nop 5
v_cvt_pk_bf16_f32 v66, v84, v85
v_cvt_pk_bf16_f32 v67, v86, v87
ds_write_b128 v6, v[64:67] offset:18432
s_cbranch_vccnz L_rf_w2_xslow
L_rf_w2_xok:
s_cmp_eq_u32 s21, 63
s_cbranch_scc1 L_rf_w2_last
buffer_load_dwordx2 v[116:117], v11, s[4:7], s40 offen sc1
s_waitcnt lgkmcnt(1)
v_mfma_f32_16x16x32_bf16 v[80:83], v[32:35], v[64:67], 0
s_waitcnt lgkmcnt(0)
s_barrier
ds_read_b128 v[68:71], v6 offset:23552
ds_read_b128 v[72:75], v6 offset:8192
ds_read_b128 v[76:79], v6 offset:13312
v_mfma_f32_16x16x32_bf16 v[84:87], v[36:39], v[64:67], 0
v_mfma_f32_16x16x32_bf16 v[88:91], v[64:67], v[64:67], 0
buffer_load_dwordx2 v[20:21], v11, s[4:7], s40 offen sc1
s_waitcnt lgkmcnt(2)
v_mfma_f32_16x16x32_bf16 v[80:83], v[40:43], v[68:71], v[80:83]
s_waitcnt lgkmcnt(1)
v_mfma_f32_16x16x32_bf16 v[80:83], v[48:51], v[72:75], v[80:83]
s_waitcnt lgkmcnt(0)
v_mfma_f32_16x16x32_bf16 v[80:83], v[56:59], v[76:79], v[80:83]
buffer_store_dwordx4 v[64:67], v10, s[4:7], s45 offen offset:128 sc1
v_mfma_f32_16x16x32_bf16 v[84:87], v[44:47], v[68:71], v[84:87]
v_mfma_f32_16x16x32_bf16 v[84:87], v[52:55], v[72:75], v[84:87]
v_mfma_f32_16x16x32_bf16 v[84:87], v[60:63], v[76:79], v[84:87]
v_mfma_f32_16x16x32_bf16 v[88:91], v[68:71], v[68:71], v[88:91]
buffer_store_dwordx2 v[18:19], v11, s[4:7], s51 offen offset:3072 sc1
v_mfma_f32_16x16x32_bf16 v[88:91], v[72:75], v[72:75], v[88:91]
v_mfma_f32_16x16x32_bf16 v[88:91], v[76:79], v[76:79], v[88:91]
v_mfma_f32_32x32x4_2b_bf16 v[32:63], v[14:15], v[14:15], 0
s_nop 0
v_max3_f32 v4, v80, v81, v82
s_nop 1
v_max3_f32 v4, v4, v83, v84
v_max3_f32 v4, v4, v85, v86
v_max_f32 v4, v4, v87
v_max3_f32 v90, v4, v88, v89
v_max3_f32 v4, v4, v88, v89
s_nop 1
v_permlane16_swap_b32 v4, v90
v_max_f32 v4, v4, v90
v_max_f32 v90, v4, v90
s_nop 1
v_permlane32_swap_b32 v4, v90
v_max_f32 v4, v4, v90
v_mul_f32 v4, s34, v4
v_pk_fma_f32 v[80:81], v[80:81], s[34:35], v[4:5] op_sel_hi:[1,0,0] neg_lo:[0,0,1] neg_hi:[0,0,1]
v_pk_fma_f32 v[82:83], v[82:83], s[34:35], v[4:5] op_sel_hi:[1,0,0] neg_lo:[0,0,1] neg_hi:[0,0,1]
v_pk_fma_f32 v[84:85], v[84:85], s[34:35], v[4:5] op_sel_hi:[1,0,0] neg_lo:[0,0,1] neg_hi:[0,0,1]
v_pk_fma_f32 v[86:87], v[86:87], s[34:35], v[4:5] op_sel_hi:[1,0,0] neg_lo:[0,0,1] neg_hi:[0,0,1]
v_pk_fma_f32 v[88:89], v[88:89], s[34:35], v[4:5] op_sel_hi:[1,0,0] neg_lo:[0,0,1] neg_hi:[0,0,1]
v_exp_f32 v80, v80
v_exp_f32 v81, v81
v_exp_f32 v82, v82
v_cvt_pk_bf16_f32 v68, v80, v81
v_exp_f32 v83, v83
v_exp_f32 v84, v84
v_cvt_pk_bf16_f32 v69, v82, v83
v_exp_f32 v85, v85
v_exp_f32 v86, v86
v_cvt_pk_bf16_f32 v70, v84, v85
v_exp_f32 v87, v87
v_exp_f32 v88, v88
v_cvt_pk_bf16_f32 v71, v86, v87
v_exp_f32 v89, v89
s_waitcnt vmcnt(3)
v_mfma_f32_16x16x32_bf16 v[76:79], v[28:31], v[68:71], 0
v_and_b32 v3, 1, v116
v_cvt_pk_bf16_f32 v72, v88, v89
v_mfma_f32_16x16x32_bf16 v[100:103], v[120:123], v[68:71], 0
v_cmp_ne_u32 vcc, s41, v3
v_cvt_pk_bf16_f32 v73, v88, v89
v_mfma_f32_16x16x32_bf16 v[104:107], v[124:127], v[68:71], 0
v_mov_b32 v113, v116
v_mov_b32 v115, v117
v_mfma_f32_16x16x16_bf16 v[76:79], v[92:93], v[72:73], v[76:79]
s_cbranch_vccnz L_rf_w2_pv0
L_rf_w2_pv2:
v_mfma_f32_16x16x16_bf16 v[100:103], v[112:113], v[72:73], v[100:103]
v_mfma_f32_16x16x16_bf16 v[104:107], v[114:115], v[72:73], v[104:107]
buffer_load_dwordx4 v[120:123], v1, s[4:7], s44 offen
buffer_load_dwordx4 v[124:127], v1, s[4:7], s44 offen offset:1024
s_nop 2
v_rcp_f32 v76, v76
s_mov_b64 exec, s[28:29]
v_pk_mul_f32 v[100:101], v[100:101], v[76:77] op_sel_hi:[1,0]
v_pk_mul_f32 v[102:103], v[102:103], v[76:77] op_sel_hi:[1,0]
v_pk_mul_f32 v[104:105], v[104:105], v[76:77] op_sel_hi:[1,0]
v_pk_mul_f32 v[106:107], v[106:107], v[76:77] op_sel_hi:[1,0]
v_cvt_pk_bf16_f32 v84, v100, v101
v_cvt_pk_bf16_f32 v85, v102, v103
v_cvt_pk_bf16_f32 v86, v104, v105
v_cvt_pk_bf16_f32 v87, v106, v107
ds_write_b128 v6, v[84:87] offset:29664
s_mov_b64 exec, -1
s_waitcnt lgkmcnt(0)
s_barrier
ds_read_b128 v[68:71], v6 offset:28672
ds_read_b128 v[72:75], v6 offset:29696
s_waitcnt lgkmcnt(1)
v_smfmac_f32_16x16x64_bf16 v[32:35], v[68:71], v[128:135], v2
s_add_u32 s21, s21, 1
s_xor_b32 s38, s38, 1048576
s_xor_b32 s37, s37, 1048576
s_waitcnt lgkmcnt(0)
v_smfmac_f32_16x16x64_bf16 v[32:35], v[72:75], v[136:143], v2
s_xor_b32 s40, s40, 1048576
s_xor_b32 s39, s39, 1048576
s_lshr_b32 s41, s21, 1
v_smfmac_f32_16x16x64_bf16 v[36:39], v[68:71], v[144:151], v2
s_and_b32 s41, s41, 1
s_xor_b32 s41, s41, 1
s_xor_b32 s35, s35, 16384
v_smfmac_f32_16x16x64_bf16 v[36:39], v[72:75], v[152:159], v2
v_add_f32 v32, v32, v34
s_xor_b32 s36, s36, 16384
s_add_u32 s43, s43, 262144
s_add_u32 s44, s44, 262144
v_smfmac_f32_16x16x64_bf16 v[40:43], v[68:71], v[160:167], v2
v_add_f32 v33, v33, v35
v_smfmac_f32_16x16x64_bf16 v[40:43], v[72:75], v[168:175], v2
v_cvt_pk_bf16_f32 v32, v32, v33
v_smfmac_f32_16x16x64_bf16 v[44:47], v[68:71], v[176:183], v2
v_and_or_b32 v32, v32, -2, s42
v_smfmac_f32_16x16x64_bf16 v[44:47], v[72:75], v[184:191], v2
v_add_f32 v36, v36, v38
v_smfmac_f32_16x16x64_bf16 v[48:51], v[68:71], v[192:199], v2
v_add_f32 v37, v37, v39
v_smfmac_f32_16x16x64_bf16 v[48:51], v[72:75], v[200:207], v2
v_cvt_pk_bf16_f32 v33, v36, v37
v_smfmac_f32_16x16x64_bf16 v[52:55], v[68:71], v[208:215], v2
v_add_f32 v40, v40, v42
v_smfmac_f32_16x16x64_bf16 v[52:55], v[72:75], v[216:223], v2
v_add_f32 v41, v41, v43
v_smfmac_f32_16x16x64_bf16 v[56:59], v[68:71], v[224:231], v2
v_cvt_pk_bf16_f32 v34, v40, v41
v_smfmac_f32_16x16x64_bf16 v[56:59], v[72:75], v[232:239], v2
v_add_f32 v44, v44, v46
v_smfmac_f32_16x16x64_bf16 v[60:63], v[68:71], v[240:247], v2
v_add_f32 v45, v45, v47
v_smfmac_f32_16x16x64_bf16 v[60:63], v[72:75], v[248:255], v2
v_cvt_pk_bf16_f32 v35, v44, v45
buffer_store_dwordx4 v[32:35], v8, s[4:7], s46 offen
v_pk_add_f32 v[48:49], v[48:49], v[50:51]
v_cvt_pk_bf16_f32 v48, v48, v49
v_and_or_b32 v48, v48, -2, s42
v_pk_add_f32 v[52:53], v[52:53], v[54:55]
v_cvt_pk_bf16_f32 v49, v52, v53
v_pk_add_f32 v[56:57], v[56:57], v[58:59]
v_cvt_pk_bf16_f32 v50, v56, v57
v_pk_add_f32 v[60:61], v[60:61], v[62:63]
v_cvt_pk_bf16_f32 v51, v60, v61
buffer_store_dwordx4 v[48:51], v8, s[4:7], s61 offen
s_add_u32 s45, s45, 262144
s_add_u32 s51, s51, 262144
v_mfma_f32_32x32x8_bf16 v[96:111], v[14:15], v[14:15], 0
v_mfma_f32_16x16x16_bf16 v[112:115], v[14:15], v[14:15], 0
v_mfma_f32_16x16x16_bf16 v[116:119], v[14:15], v[14:15], 0
ds_read_b128 v[64:67], v1 offset:8192
ds_read_b128 v[68:71], v1 offset:9216
ds_read_b128 v[72:75], v1 offset:10240
ds_read_b128 v[76:79], v1 offset:11264
ds_read_b128 v[80:83], v1 offset:24576
ds_read_b128 v[84:87], v1 offset:25600
ds_read_b128 v[88:91], v1 offset:26624
ds_read_b128 v[92:95], v1 offset:27648
v_mov_b32 v58, -1
v_mov_b32 v59, -1
s_waitcnt vmcnt(0)
L_rf_w2_cgo:
L_rf_w2_pc:
buffer_load_dword v36, v13, s[4:7], s25 offen sc1
buffer_load_dword v37, v13, s[4:7], s25 offen offset:256 sc1
buffer_load_dword v38, v13, s[4:7], s25 offen offset:512 sc1
buffer_load_dword v39, v13, s[4:7], s25 offen offset:768 sc1
buffer_load_dword v40, v13, s[4:7], s25 offen offset:1024 sc1
buffer_load_dword v41, v13, s[4:7], s25 offen offset:1280 sc1
buffer_load_dword v42, v13, s[4:7], s25 offen offset:1536 sc1
buffer_load_dword v43, v13, s[4:7], s25 offen offset:1792 sc1
s_waitcnt vmcnt(4)
v_mfma_f32_16x16x32_bf16 v[52:55], v[36:39], v[24:27], 0
v_bitop3_b32 v3, s42, v36, v37 bitop3:0x7e
v_bitop3_b32 v4, s42, v38, v39 bitop3:0x7e
s_waitcnt vmcnt(2)
v_or_b32 v3, v3, v4
v_bitop3_b32 v4, s42, v40, v41 bitop3:0x7e
s_waitcnt vmcnt(0)
v_mfma_f32_16x16x32_bf16 v[52:55], v[40:43], v[24:27], v[52:55]
v_bitop3_b32 v56, s42, v42, v43 bitop3:0x7e
v_or3_b32 v3, v3, v4, v56
v_and_b32 v3, v0, v3
v_cmp_ne_u32 vcc, 0, v3
s_nop 3
v_cvt_pk_bf16_f32 v56, v52, v53
v_cvt_pk_bf16_f32 v57, v54, v55
v_min_u32 v56, -2, v56
s_cbranch_vccnz L_rf_w2_pc
s_mov_b64 exec, s[26:27]
buffer_store_dwordx2 v[56:57], v9, s[4:7], s35 offen offset:512
buffer_store_dwordx2 v[58:59], v9, s[4:7], s36 offen offset:512
s_mov_b64 exec, -1
s_xor_b32 s42, s42, 1
s_branch L_rf_w2_loop
L_rf_w2_last:
buffer_store_dwordx4 v[64:67], v10, s[4:7], s45 offen offset:128 sc1
buffer_store_dwordx2 v[18:19], v11, s[4:7], s51 offen offset:3072 sc1
s_branch L_rf_end
L_rf_w2_pafail:
s_nop 7
v_mov_b32 v96, 0
v_mov_b32 v97, 0
v_mov_b32 v98, 0
v_mov_b32 v99, 0
v_mov_b32 v100, 0
v_mov_b32 v101, 0
v_mov_b32 v102, 0
v_mov_b32 v103, 0
v_mov_b32 v104, 0
v_mov_b32 v105, 0
v_mov_b32 v106, 0
v_mov_b32 v107, 0
s_branch L_rf_w2_pa
L_rf_w2_xslow:
buffer_load_dwordx2 v[108:109], v11, s[4:7], s38 offen sc1
buffer_load_dwordx2 v[110:111], v11, s[4:7], s38 offen offset:512 sc1
s_waitcnt vmcnt(2)
v_bitop3_b32 v3, s41, v20, v22 bitop3:0x7e
v_mfma_f32_16x16x16_bf16 v[80:83], v[20:21], v[16:17], v[100:103]
v_and_b32 v3, 1, v3
v_mfma_f32_16x16x16_bf16 v[84:87], v[22:23], v[16:17], v[104:107]
v_cmp_ne_u32 vcc, 0, v3
s_cbranch_vccz L_rf_w2_xgot
buffer_load_dwordx2 v[20:21], v11, s[4:7], s38 offen sc1
buffer_load_dwordx2 v[22:23], v11, s[4:7], s38 offen offset:512 sc1
s_waitcnt vmcnt(2)
v_bitop3_b32 v3, s41, v108, v110 bitop3:0x7e
v_mfma_f32_16x16x16_bf16 v[80:83], v[108:109], v[16:17], v[100:103]
v_and_b32 v3, 1, v3
v_mfma_f32_16x16x16_bf16 v[84:87], v[110:111], v[16:17], v[104:107]
v_cmp_ne_u32 vcc, 0, v3
s_cbranch_vccz L_rf_w2_xgot
s_branch L_rf_w2_xslow
L_rf_w2_xgot:
s_nop 3
v_cvt_pk_bf16_f32 v64, v80, v81
v_cvt_pk_bf16_f32 v65, v82, v83
v_cvt_pk_bf16_f32 v66, v84, v85
v_cvt_pk_bf16_f32 v67, v86, v87
ds_write_b128 v6, v[64:67] offset:18432
s_branch L_rf_w2_xok
L_rf_w2_pv0:
s_waitcnt vmcnt(2)
s_branch L_rf_w2_pv1
L_rf_w2_pv:
buffer_load_dwordx2 v[20:21], v11, s[4:7], s40 offen sc1
s_waitcnt vmcnt(0)
L_rf_w2_pv1:
v_and_b32 v3, 1, v20
v_cmp_ne_u32 vcc, s41, v3
v_mov_b32 v113, v20
v_mov_b32 v115, v21
s_cbranch_vccnz L_rf_w2_pv
s_branch L_rf_w2_pv2
L_rf_w3_entry:
v_mfma_f32_32x32x8_bf16 v[96:111], v[14:15], v[14:15], 0
v_mfma_f32_16x16x16_bf16 v[112:115], v[14:15], v[14:15], 0
v_mfma_f32_16x16x16_bf16 v[116:119], v[14:15], v[14:15], 0
ds_read_b128 v[64:67], v1 offset:12288
ds_read_b128 v[68:71], v1 offset:13312
ds_read_b128 v[72:75], v1 offset:14336
ds_read_b128 v[76:79], v1 offset:15360
ds_read_b128 v[80:83], v1 offset:28672
ds_read_b128 v[84:87], v1 offset:29696
ds_read_b128 v[88:91], v1 offset:30720
ds_read_b128 v[92:95], v1 offset:31744
buffer_load_dwordx4 v[120:123], v1, s[4:7], s44 offen
buffer_load_dwordx4 v[124:127], v1, s[4:7], s44 offen offset:1024
s_add_u32 s44, s44, 262144
L_rf_w3_loop:
s_add_u32 s22, s35, 6144
s_waitcnt vmcnt(0)
buffer_load_dwordx4 v[56:59], v1, s[4:7], s22 offen sc1
buffer_load_dwordx4 v[60:63], v1, s[4:7], s22 offen offset:1024 sc1
L_rf_w3_pa:
s_waitcnt vmcnt(1)
ds_write_b128 v6, v[56:59] offset:6144
s_waitcnt vmcnt(0)
ds_write_b128 v6, v[60:63] offset:7168
v_max3_u32 v3, v56, v58, v60
v_max_u32 v3, v3, v62
v_cmp_eq_u32 vcc, -1, v3
v_smfmac_f32_16x16x64_bf16 v[96:99], v[56:59], a[96:103], v2
buffer_load_dwordx4 v[56:59], v1, s[4:7], s22 offen sc1
v_smfmac_f32_16x16x64_bf16 v[100:103], v[56:59], a[104:111], v2
buffer_load_dwordx4 v[60:63], v1, s[4:7], s22 offen offset:1024 sc1
v_smfmac_f32_16x16x64_bf16 v[104:107], v[56:59], a[224:231], v2
s_cbranch_vccnz L_rf_w3_pafail
s_waitcnt lgkmcnt(0)
s_barrier
ds_read_b128 v[32:35], v6
ds_read_b128 v[36:39], v6 offset:1024
v_smfmac_f32_16x16x64_bf16 v[108:111], v[56:59], a[232:239], v2
ds_read_b128 v[40:43], v6 offset:2048
v_smfmac_f32_16x16x64_bf16 v[96:99], v[60:63], a[112:119], v2
ds_read_b128 v[44:47], v6 offset:3072
v_smfmac_f32_16x16x64_bf16 v[100:103], v[60:63], a[120:127], v2
ds_read_b128 v[48:51], v6 offset:4096
v_smfmac_f32_16x16x64_bf16 v[104:107], v[60:63], a[240:247], v2
ds_read_b128 v[52:55], v6 offset:5120
v_smfmac_f32_16x16x64_bf16 v[108:111], v[60:63], a[248:255], v2
s_waitcnt lgkmcnt(5)
v_smfmac_f32_16x16x64_bf16 v[96:99], v[32:35], a[0:7], v2
v_smfmac_f32_16x16x64_bf16 v[104:107], v[32:35], a[128:135], v2
s_waitcnt lgkmcnt(4)
v_smfmac_f32_16x16x64_bf16 v[96:99], v[36:39], a[16:23], v2
buffer_load_dwordx4 v1, s[4:7], s43 offen lds
v_smfmac_f32_16x16x64_bf16 v[104:107], v[36:39], a[144:151], v2
s_waitcnt lgkmcnt(3)
v_smfmac_f32_16x16x64_bf16 v[96:99], v[40:43], a[32:39], v2
v_smfmac_f32_16x16x64_bf16 v[104:107], v[40:43], a[160:167], v2
s_waitcnt lgkmcnt(2)
v_smfmac_f32_16x16x64_bf16 v[96:99], v[44:47], a[48:55], v2
buffer_load_dwordx4 v1, s[4:7], s43 offen offset:1024 lds
v_smfmac_f32_16x16x64_bf16 v[104:107], v[44:47], a[176:183], v2
s_waitcnt lgkmcnt(1)
v_smfmac_f32_16x16x64_bf16 v[96:99], v[48:51], a[64:71], v2
v_smfmac_f32_16x16x64_bf16 v[104:107], v[48:51], a[192:199], v2
s_waitcnt lgkmcnt(0)
v_smfmac_f32_16x16x64_bf16 v[96:99], v[52:55], a[80:87], v2
buffer_load_dword v12, v7, s[4:7], 0 offen sc1
v_smfmac_f32_16x16x64_bf16 v[104:107], v[52:55], a[208:215], v2
v_smfmac_f32_16x16x64_bf16 v[100:103], v[32:35], a[8:15], v2
s_nop 2
v_smfmac_f32_16x16x64_bf16 v[100:103], v[36:39], a[24:31], v2
s_nop 1
v_add_f32 v96, v96, v98
v_smfmac_f32_16x16x64_bf16 v[100:103], v[40:43], a[40:47], v2
v_add_f32 v97, v97, v99
v_add_f32 v104, v104, v106
v_smfmac_f32_16x16x64_bf16 v[100:103], v[44:47], a[56:63], v2
v_add_f32 v105, v105, v107
v_cvt_pk_bf16_f32 v96, v96, v97
v_smfmac_f32_16x16x64_bf16 v[100:103], v[48:51], a[72:79], v2
v_cvt_pk_bf16_f32 v97, v104, v105
v_and_or_b32 v96, v96, -2, s41
v_smfmac_f32_16x16x64_bf16 v[100:103], v[52:55], a[88:95], v2
buffer_store_dwordx2 v[96:97], v11, s[4:7], s37 offen sc1
v_smfmac_f32_16x16x64_bf16 v[108:111], v[32:35], a[136:143], v2
v_smfmac_f32_16x16x64_bf16 v[108:111], v[36:39], a[152:159], v2
v_smfmac_f32_16x16x64_bf16 v[108:111], v[40:43], a[168:175], v2
v_smfmac_f32_16x16x64_bf16 v[108:111], v[44:47], a[184:191], v2
v_smfmac_f32_16x16x64_bf16 v[108:111], v[48:51], a[200:207], v2
s_nop 2
v_add_f32 v100, v100, v102
v_smfmac_f32_16x16x64_bf16 v[108:111], v[52:55], a[216:223], v2
v_add_f32 v101, v101, v103
v_cvt_pk_bf16_f32 v98, v100, v101
v_and_or_b32 v98, v98, -2, s41
s_nop 4
v_pk_add_f32 v[108:109], v[108:109], v[110:111]
v_cvt_pk_bf16_f32 v99, v108, v109
buffer_store_dwordx2 v[98:99], v11, s[4:7], s37 offen offset:512 sc1
v_smfmac_f32_16x16x64_bf16 v[112:115], v[32:35], v[64:71], v2
ds_read_b128 v[64:67], v1 offset:45056
ds_read_b128 v[68:71], v1 offset:46080
v_smfmac_f32_16x16x64_bf16 v[116:119], v[32:35], v[72:79], v2
ds_read_b128 v[72:75], v1 offset:47104
ds_read_b128 v[76:79], v1 offset:48128
v_smfmac_f32_16x16x64_bf16 v[112:115], v[36:39], v[80:87], v2
ds_read_b128 v[80:83], v1 offset:61440
ds_read_b128 v[84:87], v1 offset:62464
v_smfmac_f32_16x16x64_bf16 v[116:119], v[36:39], v[88:95], v2
ds_read_b128 v[88:91], v1 offset:63488
ds_read_b128 v[92:95], v1 offset:64512
s_waitcnt lgkmcnt(6)
v_smfmac_f32_16x16x64_bf16 v[112:115], v[40:43], v[64:71], v2
ds_read_b128 v[64:67], v5 offset:12288
ds_read_b128 v[68:71], v5 offset:13312
s_waitcnt lgkmcnt(6)
v_smfmac_f32_16x16x64_bf16 v[116:119], v[40:43], v[72:79], v2
ds_read_b128 v[72:75], v5 offset:14336
ds_read_b128 v[76:79], v5 offset:15360
s_waitcnt lgkmcnt(6)
v_smfmac_f32_16x16x64_bf16 v[112:115], v[44:47], v[80:87], v2
ds_read_b128 v[80:83], v5 offset:28672
ds_read_b128 v[84:87], v5 offset:29696
s_waitcnt lgkmcnt(6)
v_smfmac_f32_16x16x64_bf16 v[116:119], v[44:47], v[88:95], v2
ds_read_b128 v[88:91], v5 offset:30720
ds_read_b128 v[92:95], v5 offset:31744
s_waitcnt lgkmcnt(6)
v_smfmac_f32_16x16x64_bf16 v[112:115], v[48:51], v[64:71], v2
ds_read_b128 v[64:67], v5 offset:45056
ds_read_b128 v[68:71], v5 offset:46080
s_waitcnt lgkmcnt(6)
v_smfmac_f32_16x16x64_bf16 v[116:119], v[48:51], v[72:79], v2
ds_read_b128 v[72:75], v5 offset:47104
ds_read_b128 v[76:79], v5 offset:48128
s_waitcnt lgkmcnt(6)
v_smfmac_f32_16x16x64_bf16 v[112:115], v[52:55], v[80:87], v2
ds_read_b128 v[80:83], v5 offset:61440
ds_read_b128 v[84:87], v5 offset:62464
s_waitcnt lgkmcnt(6)
v_smfmac_f32_16x16x64_bf16 v[116:119], v[52:55], v[88:95], v2
ds_read_b128 v[88:91], v5 offset:63488
ds_read_b128 v[92:95], v5 offset:64512
s_waitcnt lgkmcnt(6)
v_smfmac_f32_16x16x64_bf16 v[112:115], v[56:59], v[64:71], v2
s_waitcnt lgkmcnt(4)
v_smfmac_f32_16x16x64_bf16 v[116:119], v[56:59], v[72:79], v2
s_waitcnt lgkmcnt(2)
v_smfmac_f32_16x16x64_bf16 v[112:115], v[60:63], v[80:87], v2
s_waitcnt lgkmcnt(0)
v_smfmac_f32_16x16x64_bf16 v[116:119], v[60:63], v[88:95], v2
buffer_load_dwordx2 v[108:109], v11, s[4:7], s38 offen sc1
v_mfma_f32_16x16x16_bf16 v[100:103], v[96:97], v[16:17], 0
v_mfma_f32_16x16x16_bf16 v[104:107], v[98:99], v[16:17], 0
s_nop 4
v_add_f32 v112, v112, v114
v_add_f32 v113, v113, v115
v_add_f32 v114, v116, v118
v_add_f32 v115, v117, v119
v_cvt_pk_bf16_f32 v18, v112, v113
v_cvt_pk_bf16_f32 v19, v114, v115
v_and_or_b32 v18, v18, -2, s41
buffer_load_dwordx2 v[110:111], v11, s[4:7], s38 offen offset:512 sc1
s_barrier
buffer_store_dwordx2 v[18:19], v11, s[4:7], s39 offen sc1
v_mov_b32 v112, v18
v_mov_b32 v114, v19
v_mov_b32 v92, v28
v_mov_b32 v93, 0
s_waitcnt vmcnt(6)
s_barrier
ds_read_b128 v[32:35], v6 offset:24576
ds_read_b128 v[36:39], v6 offset:25600
ds_read_b128 v[40:43], v6 offset:19456
ds_read_b128 v[44:47], v6 offset:20480
ds_read_b128 v[48:51], v6 offset:14336
ds_read_b128 v[52:55], v6 offset:15360
ds_read_b128 v[56:59], v6 offset:9216
ds_read_b128 v[60:63], v6 offset:10240
buffer_load_dwordx2 v[20:21], v11, s[4:7], s38 offen sc1
buffer_load_dwordx2 v[22:23], v11, s[4:7], s38 offen offset:512 sc1
s_waitcnt vmcnt(4)
v_mfma_f32_16x16x16_bf16 v[80:83], v[108:109], v[16:17], v[100:103]
v_and_b32 v3, 1, v108
v_cmp_ne_u32 vcc, s41, v3
s_nop 5
v_cvt_pk_bf16_f32 v64, v80, v81
v_cvt_pk_bf16_f32 v65, v82, v83
s_cbranch_vccnz L_rf_w3_xslow
s_waitcnt vmcnt(3)
v_mfma_f32_16x16x16_bf16 v[84:87], v[110:111], v[16:17], v[104:107]
v_and_b32 v3, 1, v110
v_cmp_ne_u32 vcc, s41, v3
s_nop 5
v_cvt_pk_bf16_f32 v66, v84, v85
v_cvt_pk_bf16_f32 v67, v86, v87
ds_write_b128 v6, v[64:67] offset:23552
s_cbranch_vccnz L_rf_w3_xslow
L_rf_w3_xok:
s_cmp_eq_u32 s21, 63
s_cbranch_scc1 L_rf_w3_last
buffer_load_dwordx2 v[116:117], v11, s[4:7], s40 offen sc1
s_waitcnt lgkmcnt(1)
v_mfma_f32_16x16x32_bf16 v[80:83], v[32:35], v[64:67], 0
s_waitcnt lgkmcnt(0)
s_barrier
ds_read_b128 v[68:71], v6 offset:18432
ds_read_b128 v[72:75], v6 offset:13312
ds_read_b128 v[76:79], v6 offset:8192
v_mfma_f32_16x16x32_bf16 v[84:87], v[36:39], v[64:67], 0
v_mfma_f32_16x16x32_bf16 v[88:91], v[64:67], v[64:67], 0
buffer_load_dwordx2 v[20:21], v11, s[4:7], s40 offen sc1
s_waitcnt lgkmcnt(2)
v_mfma_f32_16x16x32_bf16 v[80:83], v[40:43], v[68:71], v[80:83]
s_waitcnt lgkmcnt(1)
v_mfma_f32_16x16x32_bf16 v[80:83], v[48:51], v[72:75], v[80:83]
s_waitcnt lgkmcnt(0)
v_mfma_f32_16x16x32_bf16 v[80:83], v[56:59], v[76:79], v[80:83]
v_mfma_f32_16x16x32_bf16 v[84:87], v[44:47], v[68:71], v[84:87]
buffer_store_dwordx4 v[64:67], v10, s[4:7], s45 offen offset:192 sc1
v_mfma_f32_16x16x32_bf16 v[84:87], v[52:55], v[72:75], v[84:87]
v_mfma_f32_16x16x32_bf16 v[84:87], v[60:63], v[76:79], v[84:87]
v_mfma_f32_16x16x32_bf16 v[88:91], v[68:71], v[68:71], v[88:91]
v_mfma_f32_16x16x32_bf16 v[88:91], v[72:75], v[72:75], v[88:91]
buffer_store_dwordx2 v[18:19], v11, s[4:7], s51 offen offset:3584 sc1
v_mfma_f32_16x16x32_bf16 v[88:91], v[76:79], v[76:79], v[88:91]
v_mfma_f32_32x32x4_2b_bf16 v[32:63], v[14:15], v[14:15], 0
s_nop 0
v_max3_f32 v4, v80, v81, v82
s_nop 1
v_max3_f32 v4, v4, v83, v84
v_max3_f32 v4, v4, v85, v86
v_max_f32 v4, v4, v87
v_max3_f32 v90, v4, v88, v89
v_max3_f32 v4, v4, v88, v89
s_nop 1
v_permlane16_swap_b32 v4, v90
v_max_f32 v4, v4, v90
v_max_f32 v90, v4, v90
s_nop 1
v_permlane32_swap_b32 v4, v90
v_max_f32 v4, v4, v90
v_mul_f32 v4, s34, v4
v_pk_fma_f32 v[80:81], v[80:81], s[34:35], v[4:5] op_sel_hi:[1,0,0] neg_lo:[0,0,1] neg_hi:[0,0,1]
v_pk_fma_f32 v[82:83], v[82:83], s[34:35], v[4:5] op_sel_hi:[1,0,0] neg_lo:[0,0,1] neg_hi:[0,0,1]
v_pk_fma_f32 v[84:85], v[84:85], s[34:35], v[4:5] op_sel_hi:[1,0,0] neg_lo:[0,0,1] neg_hi:[0,0,1]
v_pk_fma_f32 v[86:87], v[86:87], s[34:35], v[4:5] op_sel_hi:[1,0,0] neg_lo:[0,0,1] neg_hi:[0,0,1]
v_pk_fma_f32 v[88:89], v[88:89], s[34:35], v[4:5] op_sel_hi:[1,0,0] neg_lo:[0,0,1] neg_hi:[0,0,1]
v_exp_f32 v80, v80
v_exp_f32 v81, v81
v_exp_f32 v82, v82
v_cvt_pk_bf16_f32 v68, v80, v81
v_exp_f32 v83, v83
v_exp_f32 v84, v84
v_cvt_pk_bf16_f32 v69, v82, v83
v_exp_f32 v85, v85
v_exp_f32 v86, v86
v_cvt_pk_bf16_f32 v70, v84, v85
v_exp_f32 v87, v87
v_exp_f32 v88, v88
v_cvt_pk_bf16_f32 v71, v86, v87
v_exp_f32 v89, v89
s_waitcnt vmcnt(3)
v_mfma_f32_16x16x32_bf16 v[76:79], v[28:31], v[68:71], 0
v_and_b32 v3, 1, v116
v_cvt_pk_bf16_f32 v72, v88, v89
v_mfma_f32_16x16x32_bf16 v[100:103], v[120:123], v[68:71], 0
v_cmp_ne_u32 vcc, s41, v3
v_cvt_pk_bf16_f32 v73, v88, v89
v_mfma_f32_16x16x32_bf16 v[104:107], v[124:127], v[68:71], 0
v_mov_b32 v113, v116
v_mov_b32 v115, v117
v_mfma_f32_16x16x16_bf16 v[76:79], v[92:93], v[72:73], v[76:79]
s_cbranch_vccnz L_rf_w3_pv0
L_rf_w3_pv2:
v_mfma_f32_16x16x16_bf16 v[100:103], v[112:113], v[72:73], v[100:103]
v_mfma_f32_16x16x16_bf16 v[104:107], v[114:115], v[72:73], v[104:107]
buffer_load_dwordx4 v[120:123], v1, s[4:7], s44 offen
buffer_load_dwordx4 v[124:127], v1, s[4:7], s44 offen offset:1024
s_nop 2
v_rcp_f32 v76, v76
s_mov_b64 exec, s[28:29]
v_pk_mul_f32 v[100:101], v[100:101], v[76:77] op_sel_hi:[1,0]
v_pk_mul_f32 v[102:103], v[102:103], v[76:77] op_sel_hi:[1,0]
v_pk_mul_f32 v[104:105], v[104:105], v[76:77] op_sel_hi:[1,0]
v_pk_mul_f32 v[106:107], v[106:107], v[76:77] op_sel_hi:[1,0]
v_cvt_pk_bf16_f32 v84, v100, v101
v_cvt_pk_bf16_f32 v85, v102, v103
v_cvt_pk_bf16_f32 v86, v104, v105
v_cvt_pk_bf16_f32 v87, v106, v107
ds_write_b128 v6, v[84:87] offset:29696
s_mov_b64 exec, -1
s_waitcnt lgkmcnt(0)
s_barrier
ds_read_b128 v[68:71], v6 offset:28672
ds_read_b128 v[72:75], v6 offset:29696
s_waitcnt lgkmcnt(1)
v_smfmac_f32_16x16x64_bf16 v[32:35], v[68:71], v[128:135], v2
s_add_u32 s21, s21, 1
s_xor_b32 s38, s38, 1048576
s_xor_b32 s37, s37, 1048576
s_waitcnt lgkmcnt(0)
v_smfmac_f32_16x16x64_bf16 v[32:35], v[72:75], v[136:143], v2
s_xor_b32 s40, s40, 1048576
s_xor_b32 s39, s39, 1048576
s_lshr_b32 s41, s21, 1
v_smfmac_f32_16x16x64_bf16 v[36:39], v[68:71], v[144:151], v2
s_and_b32 s41, s41, 1
s_xor_b32 s41, s41, 1
s_xor_b32 s35, s35, 16384
v_smfmac_f32_16x16x64_bf16 v[36:39], v[72:75], v[152:159], v2
v_add_f32 v32, v32, v34
s_xor_b32 s36, s36, 16384
s_add_u32 s43, s43, 262144
s_add_u32 s44, s44, 262144
v_smfmac_f32_16x16x64_bf16 v[40:43], v[68:71], v[160:167], v2
v_add_f32 v33, v33, v35
v_smfmac_f32_16x16x64_bf16 v[40:43], v[72:75], v[168:175], v2
v_cvt_pk_bf16_f32 v32, v32, v33
v_smfmac_f32_16x16x64_bf16 v[44:47], v[68:71], v[176:183], v2
v_and_or_b32 v32, v32, -2, s42
v_smfmac_f32_16x16x64_bf16 v[44:47], v[72:75], v[184:191], v2
v_add_f32 v36, v36, v38
v_smfmac_f32_16x16x64_bf16 v[48:51], v[68:71], v[192:199], v2
v_add_f32 v37, v37, v39
v_smfmac_f32_16x16x64_bf16 v[48:51], v[72:75], v[200:207], v2
v_cvt_pk_bf16_f32 v33, v36, v37
v_smfmac_f32_16x16x64_bf16 v[52:55], v[68:71], v[208:215], v2
v_add_f32 v40, v40, v42
v_smfmac_f32_16x16x64_bf16 v[52:55], v[72:75], v[216:223], v2
v_add_f32 v41, v41, v43
v_smfmac_f32_16x16x64_bf16 v[56:59], v[68:71], v[224:231], v2
v_cvt_pk_bf16_f32 v34, v40, v41
v_smfmac_f32_16x16x64_bf16 v[56:59], v[72:75], v[232:239], v2
v_add_f32 v44, v44, v46
v_smfmac_f32_16x16x64_bf16 v[60:63], v[68:71], v[240:247], v2
v_add_f32 v45, v45, v47
v_smfmac_f32_16x16x64_bf16 v[60:63], v[72:75], v[248:255], v2
v_cvt_pk_bf16_f32 v35, v44, v45
buffer_store_dwordx4 v[32:35], v8, s[4:7], s46 offen
v_pk_add_f32 v[48:49], v[48:49], v[50:51]
v_cvt_pk_bf16_f32 v48, v48, v49
v_and_or_b32 v48, v48, -2, s42
v_pk_add_f32 v[52:53], v[52:53], v[54:55]
v_cvt_pk_bf16_f32 v49, v52, v53
v_pk_add_f32 v[56:57], v[56:57], v[58:59]
v_cvt_pk_bf16_f32 v50, v56, v57
v_pk_add_f32 v[60:61], v[60:61], v[62:63]
v_cvt_pk_bf16_f32 v51, v60, v61
buffer_store_dwordx4 v[48:51], v8, s[4:7], s61 offen
s_add_u32 s45, s45, 262144
s_add_u32 s51, s51, 262144
v_mfma_f32_32x32x8_bf16 v[96:111], v[14:15], v[14:15], 0
v_mfma_f32_16x16x16_bf16 v[112:115], v[14:15], v[14:15], 0
v_mfma_f32_16x16x16_bf16 v[116:119], v[14:15], v[14:15], 0
ds_read_b128 v[64:67], v1 offset:12288
ds_read_b128 v[68:71], v1 offset:13312
ds_read_b128 v[72:75], v1 offset:14336
ds_read_b128 v[76:79], v1 offset:15360
ds_read_b128 v[80:83], v1 offset:28672
ds_read_b128 v[84:87], v1 offset:29696
ds_read_b128 v[88:91], v1 offset:30720
ds_read_b128 v[92:95], v1 offset:31744
s_add_u32 s22, s21, 2
s_cmp_gt_u32 s50, s22
s_cbranch_scc1 L_rf_w3_kvs
v_readlane_b32 s50, v12, 0
v_readlane_b32 s22, v12, 2
v_readlane_b32 s23, v12, 1
v_readlane_b32 s24, v12, 3
s_nop 3
s_min_u32 s50, s50, s22
s_min_u32 s23, s23, s24
s_lshl_b32 s50, s50, 1
s_lshl_b32 s23, s23, 1
s_add_u32 s23, s23, 1
s_min_u32 s50, s50, s23
L_rf_kvb1:
s_add_u32 s22, s21, 1
s_min_u32 s22, s22, 63
s_cmp_gt_u32 s50, s22
s_cbranch_scc1 L_rf_kvd1
buffer_load_dword v12, v7, s[4:7], 0 offen sc1
s_waitcnt vmcnt(0)
v_readlane_b32 s50, v12, 0
v_readlane_b32 s22, v12, 2
v_readlane_b32 s23, v12, 1
v_readlane_b32 s24, v12, 3
s_nop 3
s_min_u32 s50, s50, s22
s_min_u32 s23, s23, s24
s_lshl_b32 s50, s50, 1
s_lshl_b32 s23, s23, 1
s_add_u32 s23, s23, 1
s_min_u32 s50, s50, s23
s_branch L_rf_kvb1
L_rf_kvd1:
L_rf_w3_kvs:
v_mov_b32 v58, -1
v_mov_b32 v59, -1
s_waitcnt vmcnt(0)
L_rf_w3_cgo:
L_rf_w3_pc:
buffer_load_dword v36, v13, s[4:7], s25 offen sc1
buffer_load_dword v37, v13, s[4:7], s25 offen offset:256 sc1
buffer_load_dword v38, v13, s[4:7], s25 offen offset:512 sc1
buffer_load_dword v39, v13, s[4:7], s25 offen offset:768 sc1
buffer_load_dword v40, v13, s[4:7], s25 offen offset:1024 sc1
buffer_load_dword v41, v13, s[4:7], s25 offen offset:1280 sc1
buffer_load_dword v42, v13, s[4:7], s25 offen offset:1536 sc1
buffer_load_dword v43, v13, s[4:7], s25 offen offset:1792 sc1
s_waitcnt vmcnt(4)
v_mfma_f32_16x16x32_bf16 v[52:55], v[36:39], v[24:27], 0
v_bitop3_b32 v3, s42, v36, v37 bitop3:0x7e
v_bitop3_b32 v4, s42, v38, v39 bitop3:0x7e
s_waitcnt vmcnt(2)
v_or_b32 v3, v3, v4
v_bitop3_b32 v4, s42, v40, v41 bitop3:0x7e
s_waitcnt vmcnt(0)
v_mfma_f32_16x16x32_bf16 v[52:55], v[40:43], v[24:27], v[52:55]
v_bitop3_b32 v56, s42, v42, v43 bitop3:0x7e
v_or3_b32 v3, v3, v4, v56
v_and_b32 v3, v0, v3
v_cmp_ne_u32 vcc, 0, v3
s_nop 3
v_cvt_pk_bf16_f32 v56, v52, v53
v_cvt_pk_bf16_f32 v57, v54, v55
v_min_u32 v56, -2, v56
s_cbranch_vccnz L_rf_w3_pc
s_mov_b64 exec, s[26:27]
buffer_store_dwordx2 v[56:57], v9, s[4:7], s35 offen offset:768
buffer_store_dwordx2 v[58:59], v9, s[4:7], s36 offen offset:768
s_mov_b64 exec, -1
s_xor_b32 s42, s42, 1
s_branch L_rf_w3_loop
L_rf_w3_last:
buffer_store_dwordx4 v[64:67], v10, s[4:7], s45 offen offset:192 sc1
buffer_store_dwordx2 v[18:19], v11, s[4:7], s51 offen offset:3584 sc1
s_branch L_rf_end
L_rf_w3_pafail:
s_nop 7
v_mov_b32 v96, 0
v_mov_b32 v97, 0
v_mov_b32 v98, 0
v_mov_b32 v99, 0
v_mov_b32 v100, 0
v_mov_b32 v101, 0
v_mov_b32 v102, 0
v_mov_b32 v103, 0
v_mov_b32 v104, 0
v_mov_b32 v105, 0
v_mov_b32 v106, 0
v_mov_b32 v107, 0
s_branch L_rf_w3_pa
L_rf_w3_xslow:
buffer_load_dwordx2 v[108:109], v11, s[4:7], s38 offen sc1
buffer_load_dwordx2 v[110:111], v11, s[4:7], s38 offen offset:512 sc1
s_waitcnt vmcnt(2)
v_bitop3_b32 v3, s41, v20, v22 bitop3:0x7e
v_mfma_f32_16x16x16_bf16 v[80:83], v[20:21], v[16:17], v[100:103]
v_and_b32 v3, 1, v3
v_mfma_f32_16x16x16_bf16 v[84:87], v[22:23], v[16:17], v[104:107]
v_cmp_ne_u32 vcc, 0, v3
s_cbranch_vccz L_rf_w3_xgot
buffer_load_dwordx2 v[20:21], v11, s[4:7], s38 offen sc1
buffer_load_dwordx2 v[22:23], v11, s[4:7], s38 offen offset:512 sc1
s_waitcnt vmcnt(2)
v_bitop3_b32 v3, s41, v108, v110 bitop3:0x7e
v_mfma_f32_16x16x16_bf16 v[80:83], v[108:109], v[16:17], v[100:103]
v_and_b32 v3, 1, v3
v_mfma_f32_16x16x16_bf16 v[84:87], v[110:111], v[16:17], v[104:107]
v_cmp_ne_u32 vcc, 0, v3
s_cbranch_vccz L_rf_w3_xgot
s_branch L_rf_w3_xslow
L_rf_w3_xgot:
s_nop 3
v_cvt_pk_bf16_f32 v64, v80, v81
v_cvt_pk_bf16_f32 v65, v82, v83
v_cvt_pk_bf16_f32 v66, v84, v85
v_cvt_pk_bf16_f32 v67, v86, v87
ds_write_b128 v6, v[64:67] offset:23552
s_branch L_rf_w3_xok
L_rf_w3_pv0:
s_waitcnt vmcnt(2)
s_branch L_rf_w3_pv1
L_rf_w3_pv:
buffer_load_dwordx2 v[20:21], v11, s[4:7], s40 offen sc1
s_waitcnt vmcnt(0)
L_rf_w3_pv1:
v_and_b32 v3, 1, v20
v_cmp_ne_u32 vcc, s41, v3
v_mov_b32 v113, v20
v_mov_b32 v115, v21
s_cbranch_vccnz L_rf_w3_pv
s_branch L_rf_w3_pv2
L_rf_end:
s_mov_b64 exec, -1
v_mov_b32 v3, 64
s_waitcnt vmcnt(0)
s_barrier
s_cmp_lg_u32 s20, 0
s_cbranch_scc1 L_rf_end2
buffer_store_dword v3, v7, s[4:7], 0 offen sc1
L_rf_end2:
s_waitcnt vmcnt(0)
s_endpgm
L_recs:
s_load_dwordx2 s[4:5], s[0:1], 96
s_load_dwordx2 s[12:13], s[0:1], 88
s_load_dwordx2 s[50:51], s[0:1], 16
s_load_dwordx2 s[52:53], s[0:1], 24
s_load_dwordx2 s[54:55], s[0:1], 32
s_load_dwordx2 s[56:57], s[0:1], 40
s_load_dwordx2 s[58:59], s[0:1], 8
v_lshrrev_b32 v3, 6, v0
v_and_b32 v40, 63, v0
v_readfirstlane_b32 s20, v3
v_lshrrev_b32 v41, 4, v40
v_and_b32 v42, 15, v40
v_lshlrev_b32 v1, 4, v40
s_mov_b32 s49, 0
s_waitcnt lgkmcnt(0)
s_mov_b32 s6, 268435456
s_mov_b32 s7, 0x00020000
s_mov_b32 s14, 256
s_mov_b32 s15, 0x00020000
s_mov_b32 s10, 8388608
s_mov_b32 s11, 0x00020000
s_mov_b32 s26, 0x00030003
s_mov_b32 s27, 0x00030003
s_mov_b32 s28, 0xcccccccc
s_mov_b32 s29, 0xcccccccc
s_mov_b32 s32, 0x33333333
s_mov_b32 s33, 0x33333333
s_mov_b32 s34, 0x3e0293ee
s_lshl_b32 s22, s20, 2
v_xor_b32 v3, s22, v42
v_lshlrev_b32 v3, 4, v3
v_lshl_add_u32 v4, v41, 4, s20
v_lshl_add_u32 v44, v4, 13, v3
s_lshl_b32 s22, s30, 22
s_lshl_b32 s23, s31, 8
s_add_u32 s22, s22, s23
v_add_u32 v44, s22, v44
s_lshr_b32 s22, s20, 1
s_lshl_b32 s22, s22, 5
s_and_b32 s23, s20, 1
s_lshl_b32 s23, s23, 2
s_add_u32 s22, s22, s23
s_lshl_b32 s23, s31, 7
s_add_u32 s22, s22, s23
v_add_u32 v4, s22, v41
v_lshl_add_u32 v45, v4, 11, v3
s_lshl_b32 s22, s30, 10
v_add_u32 v45, s22, v45
s_lshl_b32 s48, s20, 10
s_mov_b32 s8, s50
s_mov_b32 s9, s51
s_add_u32 m0, s48, 0
s_mov_b32 s22, 0
buffer_load_dwordx4 v44, s[8:11], s22 offen  lds
s_add_u32 m0, s48, 4096
s_mov_b32 s22, 32768
buffer_load_dwordx4 v44, s[8:11], s22 offen  lds
s_add_u32 m0, s48, 8192
s_mov_b32 s22, 65536
buffer_load_dwordx4 v44, s[8:11], s22 offen  lds
s_add_u32 m0, s48, 12288
s_mov_b32 s22, 98304
buffer_load_dwordx4 v44, s[8:11], s22 offen  lds
s_add_u32 m0, s48, 16384
s_mov_b32 s22, 524288
buffer_load_dwordx4 v44, s[8:11], s22 offen  lds
s_add_u32 m0, s48, 20480
s_mov_b32 s22, 557056
buffer_load_dwordx4 v44, s[8:11], s22 offen  lds
s_add_u32 m0, s48, 24576
s_mov_b32 s22, 589824
buffer_load_dwordx4 v44, s[8:11], s22 offen  lds
s_add_u32 m0, s48, 28672
s_mov_b32 s22, 622592
buffer_load_dwordx4 v44, s[8:11], s22 offen  lds
s_add_u32 m0, s48, 32768
s_mov_b32 s22, 1048576
buffer_load_dwordx4 v44, s[8:11], s22 offen  lds
s_add_u32 m0, s48, 36864
s_mov_b32 s22, 1081344
buffer_load_dwordx4 v44, s[8:11], s22 offen  lds
s_add_u32 m0, s48, 40960
s_mov_b32 s22, 1114112
buffer_load_dwordx4 v44, s[8:11], s22 offen  lds
s_add_u32 m0, s48, 45056
s_mov_b32 s22, 1146880
buffer_load_dwordx4 v44, s[8:11], s22 offen  lds
s_add_u32 m0, s48, 49152
s_mov_b32 s22, 1572864
buffer_load_dwordx4 v44, s[8:11], s22 offen  lds
s_add_u32 m0, s48, 53248
s_mov_b32 s22, 1605632
buffer_load_dwordx4 v44, s[8:11], s22 offen  lds
s_add_u32 m0, s48, 57344
s_mov_b32 s22, 1638400
buffer_load_dwordx4 v44, s[8:11], s22 offen  lds
s_add_u32 m0, s48, 61440
s_mov_b32 s22, 1671168
buffer_load_dwordx4 v44, s[8:11], s22 offen  lds
s_add_u32 m0, s48, 65536
s_mov_b32 s22, 2097152
buffer_load_dwordx4 v44, s[8:11], s22 offen  lds
s_add_u32 m0, s48, 69632
s_mov_b32 s22, 2129920
buffer_load_dwordx4 v44, s[8:11], s22 offen  lds
s_add_u32 m0, s48, 73728
s_mov_b32 s22, 2162688
buffer_load_dwordx4 v44, s[8:11], s22 offen  lds
s_add_u32 m0, s48, 77824
s_mov_b32 s22, 2195456
buffer_load_dwordx4 v44, s[8:11], s22 offen  lds
s_add_u32 m0, s48, 81920
s_mov_b32 s22, 2621440
buffer_load_dwordx4 v44, s[8:11], s22 offen  lds
s_add_u32 m0, s48, 86016
s_mov_b32 s22, 2654208
buffer_load_dwordx4 v44, s[8:11], s22 offen  lds
s_add_u32 m0, s48, 90112
s_mov_b32 s22, 2686976
buffer_load_dwordx4 v44, s[8:11], s22 offen  lds
s_add_u32 m0, s48, 94208
s_mov_b32 s22, 2719744
buffer_load_dwordx4 v44, s[8:11], s22 offen  lds
s_add_u32 m0, s48, 98304
s_mov_b32 s22, 3145728
buffer_load_dwordx4 v44, s[8:11], s22 offen  lds
s_add_u32 m0, s48, 102400
s_mov_b32 s22, 3178496
buffer_load_dwordx4 v44, s[8:11], s22 offen  lds
s_add_u32 m0, s48, 106496
s_mov_b32 s22, 3211264
buffer_load_dwordx4 v44, s[8:11], s22 offen  lds
s_add_u32 m0, s48, 110592
s_mov_b32 s22, 3244032
buffer_load_dwordx4 v44, s[8:11], s22 offen  lds
s_add_u32 m0, s48, 114688
s_mov_b32 s22, 3670016
buffer_load_dwordx4 v44, s[8:11], s22 offen  lds
s_add_u32 m0, s48, 118784
s_mov_b32 s22, 3702784
buffer_load_dwordx4 v44, s[8:11], s22 offen  lds
s_add_u32 m0, s48, 122880
s_mov_b32 s22, 3735552
buffer_load_dwordx4 v44, s[8:11], s22 offen  lds
s_add_u32 m0, s48, 126976
s_mov_b32 s22, 3768320
buffer_load_dwordx4 v44, s[8:11], s22 offen  lds
s_lshl_b32 s22, s30, 5
s_add_u32 s22, s22, s31
s_lshl_b32 s38, s22, 14
s_xor_b32 s22, s22, 32
s_lshl_b32 s37, s22, 14
s_add_u32 s38, s38, 67108864
s_add_u32 s37, s37, 67108864
s_lshl_b32 s46, s30, 19
s_add_u32 s46, s46, 70254592
s_mul_i32 s22, s31, 8448
s_add_u32 s47, s46, s22
s_mul_i32 s22, s20, 67584
s_add_u32 s46, s46, s22
s_lshl_b32 s22, s31, 6
s_add_u32 s46, s46, s22
s_add_u32 s61, s46, 33792
s_mul_i32 s22, s20, 2048
s_add_u32 s25, s47, s22
s_lshl_b32 s35, s30, 13
s_add_u32 s35, s35, 69206016
v_lshrrev_b32 v53, 2, v42
v_lshlrev_b32 v53, 1, v53
v_and_b32 v54, 1, v42
v_add_u32 v55, v53, v54
v_mov_b32 v14, 0
v_mov_b32 v15, 0
v_mov_b32 v2, 0x4444
v_mov_b32 v3, 0xeeee
v_cndmask_b32 v2, v2, v3, s[28:29]
s_lshl_b32 s22, s20, 12
v_add_u32 v32, s22, v1
v_add_u32 v33, 0x10000, v32
v_add_u32 v5, 0x10000, v1
v_add_u32 v6, 131072, v1
v_and_b32 v3, 3, v42
v_bfe_u32 v43, v40, 1, 1
v_lshlrev_b32 v7, 13, v43
v_and_b32 v43, 1, v40
v_lshl_add_u32 v7, v43, 7, v7
s_lshl_b32 s22, s31, 8
s_add_u32 s23, s22, 71311360
v_add_u32 v7, s23, v7
s_cmp_lg_u32 s20, 0
s_cbranch_scc1 L_rs_flk
s_lshl_b32 s23, s30, 7
s_add_u32 s22, s22, s23
s_add_u32 s22, s22, 71327744
v_bfrev_b32 v7, 1
v_writelane_b32 v7, s22, 0
L_rs_flk:
v_lshlrev_b32 v11, 3, v40
v_lshlrev_b32 v10, 8, v55
v_lshl_add_u32 v10, v41, 4, v10
v_mul_u32_u24 v8, 8448, v41
v_lshl_add_u32 v8, v3, 4, v8
v_lshrrev_b32 v4, 2, v42
v_mul_u32_u24 v4, 2048, v4
v_add_u32 v8, v4, v8
v_lshrrev_b32 v9, 1, v41
v_lshlrev_b32 v9, 5, v9
v_and_b32 v4, 1, v42
v_lshl_add_u32 v9, v4, 4, v9
v_and_b32 v4, 1, v41
v_lshl_add_u32 v9, v4, 3, v9
s_lshr_b32 s22, s31, 2
s_lshl_b32 s22, s22, 10
s_and_b32 s23, s31, 3
s_lshl_b32 s23, s23, 6
s_add_u32 s22, s22, s23
v_add_u32 v9, s22, v9
v_lshrrev_b32 v4, 2, v42
v_lshlrev_b32 v12, 8, v4
v_lshl_add_u32 v12, v41, 6, v12
v_lshl_add_u32 v12, v3, 4, v12
v_lshlrev_b32 v13, 6, v41
v_lshl_add_u32 v13, v42, 2, v13
v_cmp_eq_u32 vcc, 0, v3
v_mov_b32 v28, 0x3f803f80
v_mov_b32 v29, 0x3f803f80
v_cndmask_b32 v34, 0, 1, vcc
v_mov_b32 v30, 0x3f803f80
v_mov_b32 v31, 0x3f803f80
v_and_b32 v49, 1, v42
v_lshlrev_b32 v49, 4, v49
v_mov_b32 v50, 0x3f80
v_lshlrev_b32 v50, v49, v50
v_lshrrev_b32 v51, 2, v42
v_cmp_eq_u32 vcc, v51, v41
v_mov_b32 v24, v50
v_cndmask_b32 v52, 0, v50, s[28:29]
v_cndmask_b32 v53, 0, v50, s[32:33]
v_cndmask_b32 v16, 0, v52, vcc
v_cndmask_b32 v17, 0, v53, vcc
v_mov_b32 v25, v50
v_mov_b32 v26, v50
v_mov_b32 v27, v50
v_bfe_u32 v60, v40, 3, 1
v_bfe_u32 v49, v40, 2, 1
v_and_b32 v50, 1, v41
v_lshrrev_b32 v51, 1, v41
v_lshlrev_b32 v52, 3, v60
v_lshl_add_u32 v52, v50, 2, v52
v_lshl_add_u32 v53, v51, 4, v52
v_add_u32 v53, v53, v49
v_and_b32 v54, 3, v40
s_lshl_b32 s22, s20, 2
v_add_u32 v55, s22, v54
v_xor_b32 v55, v55, v52
v_lshlrev_b32 v55, 4, v55
v_lshl_add_u32 v46, v53, 8, v55
v_lshlrev_b32 v55, 4, v52
v_lshl_add_u32 v55, v54, 3, v55
v_lshl_add_u32 v47, v53, 8, v55
s_waitcnt vmcnt(28)
s_barrier
v_add_u32 v48, 0, v46
ds_read_b64_tr_b16 a[0:1], v48
ds_read_b64_tr_b16 a[2:3], v48 offset:512
ds_read_b64_tr_b16 a[4:5], v48 offset:8192
ds_read_b64_tr_b16 a[6:7], v48 offset:8704
ds_read_b64_tr_b16 a[8:9], v48 offset:8
ds_read_b64_tr_b16 a[10:11], v48 offset:520
ds_read_b64_tr_b16 a[12:13], v48 offset:8200
ds_read_b64_tr_b16 a[14:15], v48 offset:8712
s_waitcnt lgkmcnt(0)
s_barrier
s_mov_b32 s8, s52
s_mov_b32 s9, s53
s_add_u32 m0, s48, 0
s_mov_b32 s22, 0
buffer_load_dwordx4 v44, s[8:11], s22 offen  lds
s_add_u32 m0, s48, 4096
s_mov_b32 s22, 32768
buffer_load_dwordx4 v44, s[8:11], s22 offen  lds
s_add_u32 m0, s48, 8192
s_mov_b32 s22, 65536
buffer_load_dwordx4 v44, s[8:11], s22 offen  lds
s_add_u32 m0, s48, 12288
s_mov_b32 s22, 98304
buffer_load_dwordx4 v44, s[8:11], s22 offen  lds
s_waitcnt vmcnt(28)
s_barrier
v_add_u32 v48, 16384, v46
ds_read_b64_tr_b16 a[16:17], v48
ds_read_b64_tr_b16 a[18:19], v48 offset:512
ds_read_b64_tr_b16 a[20:21], v48 offset:8192
ds_read_b64_tr_b16 a[22:23], v48 offset:8704
ds_read_b64_tr_b16 a[24:25], v48 offset:8
ds_read_b64_tr_b16 a[26:27], v48 offset:520
ds_read_b64_tr_b16 a[28:29], v48 offset:8200
ds_read_b64_tr_b16 a[30:31], v48 offset:8712
s_waitcnt lgkmcnt(0)
s_barrier
s_add_u32 m0, s48, 16384
s_mov_b32 s22, 524288
buffer_load_dwordx4 v44, s[8:11], s22 offen  lds
s_add_u32 m0, s48, 20480
s_mov_b32 s22, 557056
buffer_load_dwordx4 v44, s[8:11], s22 offen  lds
s_add_u32 m0, s48, 24576
s_mov_b32 s22, 589824
buffer_load_dwordx4 v44, s[8:11], s22 offen  lds
s_add_u32 m0, s48, 28672
s_mov_b32 s22, 622592
buffer_load_dwordx4 v44, s[8:11], s22 offen  lds
s_waitcnt vmcnt(28)
s_barrier
v_add_u32 v48, 32768, v46
ds_read_b64_tr_b16 a[32:33], v48
ds_read_b64_tr_b16 a[34:35], v48 offset:512
ds_read_b64_tr_b16 a[36:37], v48 offset:8192
ds_read_b64_tr_b16 a[38:39], v48 offset:8704
ds_read_b64_tr_b16 a[40:41], v48 offset:8
ds_read_b64_tr_b16 a[42:43], v48 offset:520
ds_read_b64_tr_b16 a[44:45], v48 offset:8200
ds_read_b64_tr_b16 a[46:47], v48 offset:8712
s_waitcnt lgkmcnt(0)
s_barrier
s_add_u32 m0, s48, 32768
s_mov_b32 s22, 1048576
buffer_load_dwordx4 v44, s[8:11], s22 offen  lds
s_add_u32 m0, s48, 36864
s_mov_b32 s22, 1081344
buffer_load_dwordx4 v44, s[8:11], s22 offen  lds
s_add_u32 m0, s48, 40960
s_mov_b32 s22, 1114112
buffer_load_dwordx4 v44, s[8:11], s22 offen  lds
s_add_u32 m0, s48, 45056
s_mov_b32 s22, 1146880
buffer_load_dwordx4 v44, s[8:11], s22 offen  lds
s_waitcnt vmcnt(28)
s_barrier
v_add_u32 v48, 49152, v46
ds_read_b64_tr_b16 a[48:49], v48
ds_read_b64_tr_b16 a[50:51], v48 offset:512
ds_read_b64_tr_b16 a[52:53], v48 offset:8192
ds_read_b64_tr_b16 a[54:55], v48 offset:8704
ds_read_b64_tr_b16 a[56:57], v48 offset:8
ds_read_b64_tr_b16 a[58:59], v48 offset:520
ds_read_b64_tr_b16 a[60:61], v48 offset:8200
ds_read_b64_tr_b16 a[62:63], v48 offset:8712
s_waitcnt lgkmcnt(0)
s_barrier
s_add_u32 m0, s48, 49152
s_mov_b32 s22, 1572864
buffer_load_dwordx4 v44, s[8:11], s22 offen  lds
s_add_u32 m0, s48, 53248
s_mov_b32 s22, 1605632
buffer_load_dwordx4 v44, s[8:11], s22 offen  lds
s_add_u32 m0, s48, 57344
s_mov_b32 s22, 1638400
buffer_load_dwordx4 v44, s[8:11], s22 offen  lds
s_add_u32 m0, s48, 61440
s_mov_b32 s22, 1671168
buffer_load_dwordx4 v44, s[8:11], s22 offen  lds
s_waitcnt vmcnt(28)
s_barrier
v_add_u32 v48, 65536, v46
ds_read_b64_tr_b16 a[64:65], v48
ds_read_b64_tr_b16 a[66:67], v48 offset:512
ds_read_b64_tr_b16 a[68:69], v48 offset:8192
ds_read_b64_tr_b16 a[70:71], v48 offset:8704
ds_read_b64_tr_b16 a[72:73], v48 offset:8
ds_read_b64_tr_b16 a[74:75], v48 offset:520
ds_read_b64_tr_b16 a[76:77], v48 offset:8200
ds_read_b64_tr_b16 a[78:79], v48 offset:8712
s_waitcnt lgkmcnt(0)
s_barrier
s_add_u32 m0, s48, 65536
s_mov_b32 s22, 2097152
buffer_load_dwordx4 v44, s[8:11], s22 offen  lds
s_add_u32 m0, s48, 69632
s_mov_b32 s22, 2129920
buffer_load_dwordx4 v44, s[8:11], s22 offen  lds
s_add_u32 m0, s48, 73728
s_mov_b32 s22, 2162688
buffer_load_dwordx4 v44, s[8:11], s22 offen  lds
s_add_u32 m0, s48, 77824
s_mov_b32 s22, 2195456
buffer_load_dwordx4 v44, s[8:11], s22 offen  lds
s_waitcnt vmcnt(28)
s_barrier
v_add_u32 v48, 81920, v46
ds_read_b64_tr_b16 a[80:81], v48
ds_read_b64_tr_b16 a[82:83], v48 offset:512
ds_read_b64_tr_b16 a[84:85], v48 offset:8192
ds_read_b64_tr_b16 a[86:87], v48 offset:8704
ds_read_b64_tr_b16 a[88:89], v48 offset:8
ds_read_b64_tr_b16 a[90:91], v48 offset:520
ds_read_b64_tr_b16 a[92:93], v48 offset:8200
ds_read_b64_tr_b16 a[94:95], v48 offset:8712
s_waitcnt lgkmcnt(0)
s_barrier
s_add_u32 m0, s48, 81920
s_mov_b32 s22, 2621440
buffer_load_dwordx4 v44, s[8:11], s22 offen  lds
s_add_u32 m0, s48, 86016
s_mov_b32 s22, 2654208
buffer_load_dwordx4 v44, s[8:11], s22 offen  lds
s_add_u32 m0, s48, 90112
s_mov_b32 s22, 2686976
buffer_load_dwordx4 v44, s[8:11], s22 offen  lds
s_add_u32 m0, s48, 94208
s_mov_b32 s22, 2719744
buffer_load_dwordx4 v44, s[8:11], s22 offen  lds
s_waitcnt vmcnt(28)
s_barrier
v_add_u32 v48, 98304, v46
ds_read_b64_tr_b16 a[96:97], v48
ds_read_b64_tr_b16 a[98:99], v48 offset:512
ds_read_b64_tr_b16 a[100:101], v48 offset:8192
ds_read_b64_tr_b16 a[102:103], v48 offset:8704
ds_read_b64_tr_b16 a[104:105], v48 offset:8
ds_read_b64_tr_b16 a[106:107], v48 offset:520
ds_read_b64_tr_b16 a[108:109], v48 offset:8200
ds_read_b64_tr_b16 a[110:111], v48 offset:8712
s_waitcnt lgkmcnt(0)
s_barrier
s_add_u32 m0, s48, 98304
s_mov_b32 s22, 3145728
buffer_load_dwordx4 v44, s[8:11], s22 offen  lds
s_add_u32 m0, s48, 102400
s_mov_b32 s22, 3178496
buffer_load_dwordx4 v44, s[8:11], s22 offen  lds
s_add_u32 m0, s48, 106496
s_mov_b32 s22, 3211264
buffer_load_dwordx4 v44, s[8:11], s22 offen  lds
s_add_u32 m0, s48, 110592
s_mov_b32 s22, 3244032
buffer_load_dwordx4 v44, s[8:11], s22 offen  lds
s_waitcnt vmcnt(28)
s_barrier
v_add_u32 v48, 114688, v46
ds_read_b64_tr_b16 a[112:113], v48
ds_read_b64_tr_b16 a[114:115], v48 offset:512
ds_read_b64_tr_b16 a[116:117], v48 offset:8192
ds_read_b64_tr_b16 a[118:119], v48 offset:8704
ds_read_b64_tr_b16 a[120:121], v48 offset:8
ds_read_b64_tr_b16 a[122:123], v48 offset:520
ds_read_b64_tr_b16 a[124:125], v48 offset:8200
ds_read_b64_tr_b16 a[126:127], v48 offset:8712
s_waitcnt lgkmcnt(0)
s_barrier
s_add_u32 m0, s48, 114688
s_mov_b32 s22, 3670016
buffer_load_dwordx4 v44, s[8:11], s22 offen  lds
s_add_u32 m0, s48, 118784
s_mov_b32 s22, 3702784
buffer_load_dwordx4 v44, s[8:11], s22 offen  lds
s_add_u32 m0, s48, 122880
s_mov_b32 s22, 3735552
buffer_load_dwordx4 v44, s[8:11], s22 offen  lds
s_add_u32 m0, s48, 126976
s_mov_b32 s22, 3768320
buffer_load_dwordx4 v44, s[8:11], s22 offen  lds
s_waitcnt vmcnt(28)
s_barrier
v_add_u32 v48, 0, v46
ds_read_b64_tr_b16 a[128:129], v48
ds_read_b64_tr_b16 a[130:131], v48 offset:512
ds_read_b64_tr_b16 a[132:133], v48 offset:8192
ds_read_b64_tr_b16 a[134:135], v48 offset:8704
ds_read_b64_tr_b16 a[136:137], v48 offset:8
ds_read_b64_tr_b16 a[138:139], v48 offset:520
ds_read_b64_tr_b16 a[140:141], v48 offset:8200
ds_read_b64_tr_b16 a[142:143], v48 offset:8712
s_waitcnt lgkmcnt(0)
s_barrier
s_mov_b32 s8, s56
s_mov_b32 s9, s57
s_add_u32 m0, s48, 0
s_mov_b32 s22, 0
buffer_load_dwordx4 v45, s[8:11], s22 offen  lds
s_add_u32 m0, s48, 4096
s_mov_b32 s22, 16384
buffer_load_dwordx4 v45, s[8:11], s22 offen  lds
s_add_u32 m0, s48, 8192
s_mov_b32 s22, 32768
buffer_load_dwordx4 v45, s[8:11], s22 offen  lds
s_add_u32 m0, s48, 12288
s_mov_b32 s22, 49152
buffer_load_dwordx4 v45, s[8:11], s22 offen  lds
s_waitcnt vmcnt(28)
s_barrier
v_add_u32 v48, 16384, v46
ds_read_b64_tr_b16 a[144:145], v48
ds_read_b64_tr_b16 a[146:147], v48 offset:512
ds_read_b64_tr_b16 a[148:149], v48 offset:8192
ds_read_b64_tr_b16 a[150:151], v48 offset:8704
ds_read_b64_tr_b16 a[152:153], v48 offset:8
ds_read_b64_tr_b16 a[154:155], v48 offset:520
ds_read_b64_tr_b16 a[156:157], v48 offset:8200
ds_read_b64_tr_b16 a[158:159], v48 offset:8712
s_waitcnt lgkmcnt(0)
s_barrier
s_add_u32 m0, s48, 16384
s_mov_b32 s22, 256
buffer_load_dwordx4 v45, s[8:11], s22 offen  lds
s_add_u32 m0, s48, 20480
s_mov_b32 s22, 16640
buffer_load_dwordx4 v45, s[8:11], s22 offen  lds
s_add_u32 m0, s48, 24576
s_mov_b32 s22, 33024
buffer_load_dwordx4 v45, s[8:11], s22 offen  lds
s_add_u32 m0, s48, 28672
s_mov_b32 s22, 49408
buffer_load_dwordx4 v45, s[8:11], s22 offen  lds
s_waitcnt vmcnt(28)
s_barrier
v_add_u32 v48, 32768, v46
ds_read_b64_tr_b16 a[160:161], v48
ds_read_b64_tr_b16 a[162:163], v48 offset:512
ds_read_b64_tr_b16 a[164:165], v48 offset:8192
ds_read_b64_tr_b16 a[166:167], v48 offset:8704
ds_read_b64_tr_b16 a[168:169], v48 offset:8
ds_read_b64_tr_b16 a[170:171], v48 offset:520
ds_read_b64_tr_b16 a[172:173], v48 offset:8200
ds_read_b64_tr_b16 a[174:175], v48 offset:8712
s_waitcnt lgkmcnt(0)
s_barrier
s_add_u32 m0, s48, 32768
s_mov_b32 s22, 512
buffer_load_dwordx4 v45, s[8:11], s22 offen  lds
s_add_u32 m0, s48, 36864
s_mov_b32 s22, 16896
buffer_load_dwordx4 v45, s[8:11], s22 offen  lds
s_add_u32 m0, s48, 40960
s_mov_b32 s22, 33280
buffer_load_dwordx4 v45, s[8:11], s22 offen  lds
s_add_u32 m0, s48, 45056
s_mov_b32 s22, 49664
buffer_load_dwordx4 v45, s[8:11], s22 offen  lds
s_waitcnt vmcnt(28)
s_barrier
v_add_u32 v48, 49152, v46
ds_read_b64_tr_b16 a[176:177], v48
ds_read_b64_tr_b16 a[178:179], v48 offset:512
ds_read_b64_tr_b16 a[180:181], v48 offset:8192
ds_read_b64_tr_b16 a[182:183], v48 offset:8704
ds_read_b64_tr_b16 a[184:185], v48 offset:8
ds_read_b64_tr_b16 a[186:187], v48 offset:520
ds_read_b64_tr_b16 a[188:189], v48 offset:8200
ds_read_b64_tr_b16 a[190:191], v48 offset:8712
s_waitcnt lgkmcnt(0)
s_barrier
s_add_u32 m0, s48, 49152
s_mov_b32 s22, 768
buffer_load_dwordx4 v45, s[8:11], s22 offen  lds
s_add_u32 m0, s48, 53248
s_mov_b32 s22, 17152
buffer_load_dwordx4 v45, s[8:11], s22 offen  lds
s_add_u32 m0, s48, 57344
s_mov_b32 s22, 33536
buffer_load_dwordx4 v45, s[8:11], s22 offen  lds
s_add_u32 m0, s48, 61440
s_mov_b32 s22, 49920
buffer_load_dwordx4 v45, s[8:11], s22 offen  lds
s_waitcnt vmcnt(28)
s_barrier
v_add_u32 v48, 65536, v46
ds_read_b64_tr_b16 a[192:193], v48
ds_read_b64_tr_b16 a[194:195], v48 offset:512
ds_read_b64_tr_b16 a[196:197], v48 offset:8192
ds_read_b64_tr_b16 a[198:199], v48 offset:8704
ds_read_b64_tr_b16 a[200:201], v48 offset:8
ds_read_b64_tr_b16 a[202:203], v48 offset:520
ds_read_b64_tr_b16 a[204:205], v48 offset:8200
ds_read_b64_tr_b16 a[206:207], v48 offset:8712
s_waitcnt lgkmcnt(0)
s_barrier
s_add_u32 m0, s48, 65536
s_mov_b32 s22, 131072
buffer_load_dwordx4 v45, s[8:11], s22 offen  lds
s_add_u32 m0, s48, 69632
s_mov_b32 s22, 147456
buffer_load_dwordx4 v45, s[8:11], s22 offen  lds
s_add_u32 m0, s48, 73728
s_mov_b32 s22, 163840
buffer_load_dwordx4 v45, s[8:11], s22 offen  lds
s_add_u32 m0, s48, 77824
s_mov_b32 s22, 180224
buffer_load_dwordx4 v45, s[8:11], s22 offen  lds
s_waitcnt vmcnt(28)
s_barrier
v_add_u32 v48, 81920, v46
ds_read_b64_tr_b16 a[208:209], v48
ds_read_b64_tr_b16 a[210:211], v48 offset:512
ds_read_b64_tr_b16 a[212:213], v48 offset:8192
ds_read_b64_tr_b16 a[214:215], v48 offset:8704
ds_read_b64_tr_b16 a[216:217], v48 offset:8
ds_read_b64_tr_b16 a[218:219], v48 offset:520
ds_read_b64_tr_b16 a[220:221], v48 offset:8200
ds_read_b64_tr_b16 a[222:223], v48 offset:8712
s_waitcnt lgkmcnt(0)
s_barrier
s_add_u32 m0, s48, 81920
s_mov_b32 s22, 131328
buffer_load_dwordx4 v45, s[8:11], s22 offen  lds
s_add_u32 m0, s48, 86016
s_mov_b32 s22, 147712
buffer_load_dwordx4 v45, s[8:11], s22 offen  lds
s_add_u32 m0, s48, 90112
s_mov_b32 s22, 164096
buffer_load_dwordx4 v45, s[8:11], s22 offen  lds
s_add_u32 m0, s48, 94208
s_mov_b32 s22, 180480
buffer_load_dwordx4 v45, s[8:11], s22 offen  lds
s_waitcnt vmcnt(28)
s_barrier
v_add_u32 v48, 98304, v46
ds_read_b64_tr_b16 a[224:225], v48
ds_read_b64_tr_b16 a[226:227], v48 offset:512
ds_read_b64_tr_b16 a[228:229], v48 offset:8192
ds_read_b64_tr_b16 a[230:231], v48 offset:8704
ds_read_b64_tr_b16 a[232:233], v48 offset:8
ds_read_b64_tr_b16 a[234:235], v48 offset:520
ds_read_b64_tr_b16 a[236:237], v48 offset:8200
ds_read_b64_tr_b16 a[238:239], v48 offset:8712
s_waitcnt lgkmcnt(0)
s_barrier
s_add_u32 m0, s48, 98304
s_mov_b32 s22, 131584
buffer_load_dwordx4 v45, s[8:11], s22 offen  lds
s_add_u32 m0, s48, 102400
s_mov_b32 s22, 147968
buffer_load_dwordx4 v45, s[8:11], s22 offen  lds
s_add_u32 m0, s48, 106496
s_mov_b32 s22, 164352
buffer_load_dwordx4 v45, s[8:11], s22 offen  lds
s_add_u32 m0, s48, 110592
s_mov_b32 s22, 180736
buffer_load_dwordx4 v45, s[8:11], s22 offen  lds
s_waitcnt vmcnt(28)
s_barrier
v_add_u32 v48, 114688, v46
ds_read_b64_tr_b16 a[240:241], v48
ds_read_b64_tr_b16 a[242:243], v48 offset:512
ds_read_b64_tr_b16 a[244:245], v48 offset:8192
ds_read_b64_tr_b16 a[246:247], v48 offset:8704
ds_read_b64_tr_b16 a[248:249], v48 offset:8
ds_read_b64_tr_b16 a[250:251], v48 offset:520
ds_read_b64_tr_b16 a[252:253], v48 offset:8200
ds_read_b64_tr_b16 a[254:255], v48 offset:8712
s_waitcnt lgkmcnt(0)
s_barrier
s_add_u32 m0, s48, 114688
s_mov_b32 s22, 131840
buffer_load_dwordx4 v45, s[8:11], s22 offen  lds
s_add_u32 m0, s48, 118784
s_mov_b32 s22, 148224
buffer_load_dwordx4 v45, s[8:11], s22 offen  lds
s_add_u32 m0, s48, 122880
s_mov_b32 s22, 164608
buffer_load_dwordx4 v45, s[8:11], s22 offen  lds
s_add_u32 m0, s48, 126976
s_mov_b32 s22, 180992
buffer_load_dwordx4 v45, s[8:11], s22 offen  lds
s_waitcnt vmcnt(28)
s_barrier
s_cmp_lg_u32 s20, 0
s_cbranch_scc1 L_rs_wo0
v_xor_b32 v48, 0, v47
v_add_u32 v48, 0, v48
ds_read_b64_tr_b16 v[128:129], v48
ds_read_b64_tr_b16 v[130:131], v48 offset:512
ds_read_b64_tr_b16 v[132:133], v48 offset:8192
ds_read_b64_tr_b16 v[134:135], v48 offset:8704
ds_read_b64_tr_b16 v[144:145], v48 offset:32
ds_read_b64_tr_b16 v[146:147], v48 offset:544
ds_read_b64_tr_b16 v[148:149], v48 offset:8224
ds_read_b64_tr_b16 v[150:151], v48 offset:8736
s_waitcnt lgkmcnt(0)
v_xor_b32 v48, 64, v47
v_add_u32 v48, 0, v48
ds_read_b64_tr_b16 v[160:161], v48
ds_read_b64_tr_b16 v[162:163], v48 offset:512
ds_read_b64_tr_b16 v[164:165], v48 offset:8192
ds_read_b64_tr_b16 v[166:167], v48 offset:8704
ds_read_b64_tr_b16 v[176:177], v48 offset:32
ds_read_b64_tr_b16 v[178:179], v48 offset:544
ds_read_b64_tr_b16 v[180:181], v48 offset:8224
ds_read_b64_tr_b16 v[182:183], v48 offset:8736
s_waitcnt lgkmcnt(0)
v_xor_b32 v48, 128, v47
v_add_u32 v48, 0, v48
ds_read_b64_tr_b16 v[192:193], v48
ds_read_b64_tr_b16 v[194:195], v48 offset:512
ds_read_b64_tr_b16 v[196:197], v48 offset:8192
ds_read_b64_tr_b16 v[198:199], v48 offset:8704
ds_read_b64_tr_b16 v[208:209], v48 offset:32
ds_read_b64_tr_b16 v[210:211], v48 offset:544
ds_read_b64_tr_b16 v[212:213], v48 offset:8224
ds_read_b64_tr_b16 v[214:215], v48 offset:8736
s_waitcnt lgkmcnt(0)
v_xor_b32 v48, 192, v47
v_add_u32 v48, 0, v48
ds_read_b64_tr_b16 v[224:225], v48
ds_read_b64_tr_b16 v[226:227], v48 offset:512
ds_read_b64_tr_b16 v[228:229], v48 offset:8192
ds_read_b64_tr_b16 v[230:231], v48 offset:8704
ds_read_b64_tr_b16 v[240:241], v48 offset:32
ds_read_b64_tr_b16 v[242:243], v48 offset:544
ds_read_b64_tr_b16 v[244:245], v48 offset:8224
ds_read_b64_tr_b16 v[246:247], v48 offset:8736
s_waitcnt lgkmcnt(0)
L_rs_wo0:
s_barrier
s_mov_b32 s8, s54
s_mov_b32 s9, s55
s_add_u32 m0, s48, 0
s_mov_b32 s22, 0
buffer_load_dwordx4 v44, s[8:11], s22 offen  lds
s_add_u32 m0, s48, 4096
s_mov_b32 s22, 32768
buffer_load_dwordx4 v44, s[8:11], s22 offen  lds
s_add_u32 m0, s48, 8192
s_mov_b32 s22, 65536
buffer_load_dwordx4 v44, s[8:11], s22 offen  lds
s_add_u32 m0, s48, 12288
s_mov_b32 s22, 98304
buffer_load_dwordx4 v44, s[8:11], s22 offen  lds
s_waitcnt vmcnt(28)
s_barrier
s_cmp_lg_u32 s20, 1
s_cbranch_scc1 L_rs_wo1
v_xor_b32 v48, 0, v47
v_add_u32 v48, 16384, v48
ds_read_b64_tr_b16 v[128:129], v48
ds_read_b64_tr_b16 v[130:131], v48 offset:512
ds_read_b64_tr_b16 v[132:133], v48 offset:8192
ds_read_b64_tr_b16 v[134:135], v48 offset:8704
ds_read_b64_tr_b16 v[144:145], v48 offset:32
ds_read_b64_tr_b16 v[146:147], v48 offset:544
ds_read_b64_tr_b16 v[148:149], v48 offset:8224
ds_read_b64_tr_b16 v[150:151], v48 offset:8736
s_waitcnt lgkmcnt(0)
v_xor_b32 v48, 64, v47
v_add_u32 v48, 16384, v48
ds_read_b64_tr_b16 v[160:161], v48
ds_read_b64_tr_b16 v[162:163], v48 offset:512
ds_read_b64_tr_b16 v[164:165], v48 offset:8192
ds_read_b64_tr_b16 v[166:167], v48 offset:8704
ds_read_b64_tr_b16 v[176:177], v48 offset:32
ds_read_b64_tr_b16 v[178:179], v48 offset:544
ds_read_b64_tr_b16 v[180:181], v48 offset:8224
ds_read_b64_tr_b16 v[182:183], v48 offset:8736
s_waitcnt lgkmcnt(0)
v_xor_b32 v48, 128, v47
v_add_u32 v48, 16384, v48
ds_read_b64_tr_b16 v[192:193], v48
ds_read_b64_tr_b16 v[194:195], v48 offset:512
ds_read_b64_tr_b16 v[196:197], v48 offset:8192
ds_read_b64_tr_b16 v[198:199], v48 offset:8704
ds_read_b64_tr_b16 v[208:209], v48 offset:32
ds_read_b64_tr_b16 v[210:211], v48 offset:544
ds_read_b64_tr_b16 v[212:213], v48 offset:8224
ds_read_b64_tr_b16 v[214:215], v48 offset:8736
s_waitcnt lgkmcnt(0)
v_xor_b32 v48, 192, v47
v_add_u32 v48, 16384, v48
ds_read_b64_tr_b16 v[224:225], v48
ds_read_b64_tr_b16 v[226:227], v48 offset:512
ds_read_b64_tr_b16 v[228:229], v48 offset:8192
ds_read_b64_tr_b16 v[230:231], v48 offset:8704
ds_read_b64_tr_b16 v[240:241], v48 offset:32
ds_read_b64_tr_b16 v[242:243], v48 offset:544
ds_read_b64_tr_b16 v[244:245], v48 offset:8224
ds_read_b64_tr_b16 v[246:247], v48 offset:8736
s_waitcnt lgkmcnt(0)
L_rs_wo1:
s_barrier
s_add_u32 m0, s48, 16384
s_mov_b32 s22, 524288
buffer_load_dwordx4 v44, s[8:11], s22 offen  lds
s_add_u32 m0, s48, 20480
s_mov_b32 s22, 557056
buffer_load_dwordx4 v44, s[8:11], s22 offen  lds
s_add_u32 m0, s48, 24576
s_mov_b32 s22, 589824
buffer_load_dwordx4 v44, s[8:11], s22 offen  lds
s_add_u32 m0, s48, 28672
s_mov_b32 s22, 622592
buffer_load_dwordx4 v44, s[8:11], s22 offen  lds
s_waitcnt vmcnt(28)
s_barrier
s_cmp_lg_u32 s20, 2
s_cbranch_scc1 L_rs_wo2
v_xor_b32 v48, 0, v47
v_add_u32 v48, 32768, v48
ds_read_b64_tr_b16 v[128:129], v48
ds_read_b64_tr_b16 v[130:131], v48 offset:512
ds_read_b64_tr_b16 v[132:133], v48 offset:8192
ds_read_b64_tr_b16 v[134:135], v48 offset:8704
ds_read_b64_tr_b16 v[144:145], v48 offset:32
ds_read_b64_tr_b16 v[146:147], v48 offset:544
ds_read_b64_tr_b16 v[148:149], v48 offset:8224
ds_read_b64_tr_b16 v[150:151], v48 offset:8736
s_waitcnt lgkmcnt(0)
v_xor_b32 v48, 64, v47
v_add_u32 v48, 32768, v48
ds_read_b64_tr_b16 v[160:161], v48
ds_read_b64_tr_b16 v[162:163], v48 offset:512
ds_read_b64_tr_b16 v[164:165], v48 offset:8192
ds_read_b64_tr_b16 v[166:167], v48 offset:8704
ds_read_b64_tr_b16 v[176:177], v48 offset:32
ds_read_b64_tr_b16 v[178:179], v48 offset:544
ds_read_b64_tr_b16 v[180:181], v48 offset:8224
ds_read_b64_tr_b16 v[182:183], v48 offset:8736
s_waitcnt lgkmcnt(0)
v_xor_b32 v48, 128, v47
v_add_u32 v48, 32768, v48
ds_read_b64_tr_b16 v[192:193], v48
ds_read_b64_tr_b16 v[194:195], v48 offset:512
ds_read_b64_tr_b16 v[196:197], v48 offset:8192
ds_read_b64_tr_b16 v[198:199], v48 offset:8704
ds_read_b64_tr_b16 v[208:209], v48 offset:32
ds_read_b64_tr_b16 v[210:211], v48 offset:544
ds_read_b64_tr_b16 v[212:213], v48 offset:8224
ds_read_b64_tr_b16 v[214:215], v48 offset:8736
s_waitcnt lgkmcnt(0)
v_xor_b32 v48, 192, v47
v_add_u32 v48, 32768, v48
ds_read_b64_tr_b16 v[224:225], v48
ds_read_b64_tr_b16 v[226:227], v48 offset:512
ds_read_b64_tr_b16 v[228:229], v48 offset:8192
ds_read_b64_tr_b16 v[230:231], v48 offset:8704
ds_read_b64_tr_b16 v[240:241], v48 offset:32
ds_read_b64_tr_b16 v[242:243], v48 offset:544
ds_read_b64_tr_b16 v[244:245], v48 offset:8224
ds_read_b64_tr_b16 v[246:247], v48 offset:8736
s_waitcnt lgkmcnt(0)
L_rs_wo2:
s_barrier
s_add_u32 m0, s48, 32768
s_mov_b32 s22, 1048576
buffer_load_dwordx4 v44, s[8:11], s22 offen  lds
s_add_u32 m0, s48, 36864
s_mov_b32 s22, 1081344
buffer_load_dwordx4 v44, s[8:11], s22 offen  lds
s_add_u32 m0, s48, 40960
s_mov_b32 s22, 1114112
buffer_load_dwordx4 v44, s[8:11], s22 offen  lds
s_add_u32 m0, s48, 45056
s_mov_b32 s22, 1146880
buffer_load_dwordx4 v44, s[8:11], s22 offen  lds
s_waitcnt vmcnt(28)
s_barrier
s_cmp_lg_u32 s20, 3
s_cbranch_scc1 L_rs_wo3
v_xor_b32 v48, 0, v47
v_add_u32 v48, 49152, v48
ds_read_b64_tr_b16 v[128:129], v48
ds_read_b64_tr_b16 v[130:131], v48 offset:512
ds_read_b64_tr_b16 v[132:133], v48 offset:8192
ds_read_b64_tr_b16 v[134:135], v48 offset:8704
ds_read_b64_tr_b16 v[144:145], v48 offset:32
ds_read_b64_tr_b16 v[146:147], v48 offset:544
ds_read_b64_tr_b16 v[148:149], v48 offset:8224
ds_read_b64_tr_b16 v[150:151], v48 offset:8736
s_waitcnt lgkmcnt(0)
v_xor_b32 v48, 64, v47
v_add_u32 v48, 49152, v48
ds_read_b64_tr_b16 v[160:161], v48
ds_read_b64_tr_b16 v[162:163], v48 offset:512
ds_read_b64_tr_b16 v[164:165], v48 offset:8192
ds_read_b64_tr_b16 v[166:167], v48 offset:8704
ds_read_b64_tr_b16 v[176:177], v48 offset:32
ds_read_b64_tr_b16 v[178:179], v48 offset:544
ds_read_b64_tr_b16 v[180:181], v48 offset:8224
ds_read_b64_tr_b16 v[182:183], v48 offset:8736
s_waitcnt lgkmcnt(0)
v_xor_b32 v48, 128, v47
v_add_u32 v48, 49152, v48
ds_read_b64_tr_b16 v[192:193], v48
ds_read_b64_tr_b16 v[194:195], v48 offset:512
ds_read_b64_tr_b16 v[196:197], v48 offset:8192
ds_read_b64_tr_b16 v[198:199], v48 offset:8704
ds_read_b64_tr_b16 v[208:209], v48 offset:32
ds_read_b64_tr_b16 v[210:211], v48 offset:544
ds_read_b64_tr_b16 v[212:213], v48 offset:8224
ds_read_b64_tr_b16 v[214:215], v48 offset:8736
s_waitcnt lgkmcnt(0)
v_xor_b32 v48, 192, v47
v_add_u32 v48, 49152, v48
ds_read_b64_tr_b16 v[224:225], v48
ds_read_b64_tr_b16 v[226:227], v48 offset:512
ds_read_b64_tr_b16 v[228:229], v48 offset:8192
ds_read_b64_tr_b16 v[230:231], v48 offset:8704
ds_read_b64_tr_b16 v[240:241], v48 offset:32
ds_read_b64_tr_b16 v[242:243], v48 offset:544
ds_read_b64_tr_b16 v[244:245], v48 offset:8224
ds_read_b64_tr_b16 v[246:247], v48 offset:8736
s_waitcnt lgkmcnt(0)
L_rs_wo3:
s_barrier
s_add_u32 m0, s48, 49152
s_mov_b32 s22, 1572864
buffer_load_dwordx4 v44, s[8:11], s22 offen  lds
s_add_u32 m0, s48, 53248
s_mov_b32 s22, 1605632
buffer_load_dwordx4 v44, s[8:11], s22 offen  lds
s_add_u32 m0, s48, 57344
s_mov_b32 s22, 1638400
buffer_load_dwordx4 v44, s[8:11], s22 offen  lds
s_add_u32 m0, s48, 61440
s_mov_b32 s22, 1671168
buffer_load_dwordx4 v44, s[8:11], s22 offen  lds
s_waitcnt vmcnt(28)
s_barrier
s_cmp_lg_u32 s20, 0
s_cbranch_scc1 L_rs_wo4
v_xor_b32 v48, 0, v47
v_add_u32 v48, 65536, v48
ds_read_b64_tr_b16 v[136:137], v48
ds_read_b64_tr_b16 v[138:139], v48 offset:512
ds_read_b64_tr_b16 v[140:141], v48 offset:8192
ds_read_b64_tr_b16 v[142:143], v48 offset:8704
ds_read_b64_tr_b16 v[152:153], v48 offset:32
ds_read_b64_tr_b16 v[154:155], v48 offset:544
ds_read_b64_tr_b16 v[156:157], v48 offset:8224
ds_read_b64_tr_b16 v[158:159], v48 offset:8736
s_waitcnt lgkmcnt(0)
v_xor_b32 v48, 64, v47
v_add_u32 v48, 65536, v48
ds_read_b64_tr_b16 v[168:169], v48
ds_read_b64_tr_b16 v[170:171], v48 offset:512
ds_read_b64_tr_b16 v[172:173], v48 offset:8192
ds_read_b64_tr_b16 v[174:175], v48 offset:8704
ds_read_b64_tr_b16 v[184:185], v48 offset:32
ds_read_b64_tr_b16 v[186:187], v48 offset:544
ds_read_b64_tr_b16 v[188:189], v48 offset:8224
ds_read_b64_tr_b16 v[190:191], v48 offset:8736
s_waitcnt lgkmcnt(0)
v_xor_b32 v48, 128, v47
v_add_u32 v48, 65536, v48
ds_read_b64_tr_b16 v[200:201], v48
ds_read_b64_tr_b16 v[202:203], v48 offset:512
ds_read_b64_tr_b16 v[204:205], v48 offset:8192
ds_read_b64_tr_b16 v[206:207], v48 offset:8704
ds_read_b64_tr_b16 v[216:217], v48 offset:32
ds_read_b64_tr_b16 v[218:219], v48 offset:544
ds_read_b64_tr_b16 v[220:221], v48 offset:8224
ds_read_b64_tr_b16 v[222:223], v48 offset:8736
s_waitcnt lgkmcnt(0)
v_xor_b32 v48, 192, v47
v_add_u32 v48, 65536, v48
ds_read_b64_tr_b16 v[232:233], v48
ds_read_b64_tr_b16 v[234:235], v48 offset:512
ds_read_b64_tr_b16 v[236:237], v48 offset:8192
ds_read_b64_tr_b16 v[238:239], v48 offset:8704
ds_read_b64_tr_b16 v[248:249], v48 offset:32
ds_read_b64_tr_b16 v[250:251], v48 offset:544
ds_read_b64_tr_b16 v[252:253], v48 offset:8224
ds_read_b64_tr_b16 v[254:255], v48 offset:8736
s_waitcnt lgkmcnt(0)
L_rs_wo4:
s_barrier
s_add_u32 m0, s48, 65536
s_mov_b32 s22, 2097152
buffer_load_dwordx4 v44, s[8:11], s22 offen  lds
s_add_u32 m0, s48, 69632
s_mov_b32 s22, 2129920
buffer_load_dwordx4 v44, s[8:11], s22 offen  lds
s_add_u32 m0, s48, 73728
s_mov_b32 s22, 2162688
buffer_load_dwordx4 v44, s[8:11], s22 offen  lds
s_add_u32 m0, s48, 77824
s_mov_b32 s22, 2195456
buffer_load_dwordx4 v44, s[8:11], s22 offen  lds
s_waitcnt vmcnt(28)
s_barrier
s_cmp_lg_u32 s20, 1
s_cbranch_scc1 L_rs_wo5
v_xor_b32 v48, 0, v47
v_add_u32 v48, 81920, v48
ds_read_b64_tr_b16 v[136:137], v48
ds_read_b64_tr_b16 v[138:139], v48 offset:512
ds_read_b64_tr_b16 v[140:141], v48 offset:8192
ds_read_b64_tr_b16 v[142:143], v48 offset:8704
ds_read_b64_tr_b16 v[152:153], v48 offset:32
ds_read_b64_tr_b16 v[154:155], v48 offset:544
ds_read_b64_tr_b16 v[156:157], v48 offset:8224
ds_read_b64_tr_b16 v[158:159], v48 offset:8736
s_waitcnt lgkmcnt(0)
v_xor_b32 v48, 64, v47
v_add_u32 v48, 81920, v48
ds_read_b64_tr_b16 v[168:169], v48
ds_read_b64_tr_b16 v[170:171], v48 offset:512
ds_read_b64_tr_b16 v[172:173], v48 offset:8192
ds_read_b64_tr_b16 v[174:175], v48 offset:8704
ds_read_b64_tr_b16 v[184:185], v48 offset:32
ds_read_b64_tr_b16 v[186:187], v48 offset:544
ds_read_b64_tr_b16 v[188:189], v48 offset:8224
ds_read_b64_tr_b16 v[190:191], v48 offset:8736
s_waitcnt lgkmcnt(0)
v_xor_b32 v48, 128, v47
v_add_u32 v48, 81920, v48
ds_read_b64_tr_b16 v[200:201], v48
ds_read_b64_tr_b16 v[202:203], v48 offset:512
ds_read_b64_tr_b16 v[204:205], v48 offset:8192
ds_read_b64_tr_b16 v[206:207], v48 offset:8704
ds_read_b64_tr_b16 v[216:217], v48 offset:32
ds_read_b64_tr_b16 v[218:219], v48 offset:544
ds_read_b64_tr_b16 v[220:221], v48 offset:8224
ds_read_b64_tr_b16 v[222:223], v48 offset:8736
s_waitcnt lgkmcnt(0)
v_xor_b32 v48, 192, v47
v_add_u32 v48, 81920, v48
ds_read_b64_tr_b16 v[232:233], v48
ds_read_b64_tr_b16 v[234:235], v48 offset:512
ds_read_b64_tr_b16 v[236:237], v48 offset:8192
ds_read_b64_tr_b16 v[238:239], v48 offset:8704
ds_read_b64_tr_b16 v[248:249], v48 offset:32
ds_read_b64_tr_b16 v[250:251], v48 offset:544
ds_read_b64_tr_b16 v[252:253], v48 offset:8224
ds_read_b64_tr_b16 v[254:255], v48 offset:8736
s_waitcnt lgkmcnt(0)
L_rs_wo5:
s_barrier
s_add_u32 m0, s48, 81920
s_mov_b32 s22, 2621440
buffer_load_dwordx4 v44, s[8:11], s22 offen  lds
s_add_u32 m0, s48, 86016
s_mov_b32 s22, 2654208
buffer_load_dwordx4 v44, s[8:11], s22 offen  lds
s_add_u32 m0, s48, 90112
s_mov_b32 s22, 2686976
buffer_load_dwordx4 v44, s[8:11], s22 offen  lds
s_add_u32 m0, s48, 94208
s_mov_b32 s22, 2719744
buffer_load_dwordx4 v44, s[8:11], s22 offen  lds
s_waitcnt vmcnt(28)
s_barrier
s_cmp_lg_u32 s20, 2
s_cbranch_scc1 L_rs_wo6
v_xor_b32 v48, 0, v47
v_add_u32 v48, 98304, v48
ds_read_b64_tr_b16 v[136:137], v48
ds_read_b64_tr_b16 v[138:139], v48 offset:512
ds_read_b64_tr_b16 v[140:141], v48 offset:8192
ds_read_b64_tr_b16 v[142:143], v48 offset:8704
ds_read_b64_tr_b16 v[152:153], v48 offset:32
ds_read_b64_tr_b16 v[154:155], v48 offset:544
ds_read_b64_tr_b16 v[156:157], v48 offset:8224
ds_read_b64_tr_b16 v[158:159], v48 offset:8736
s_waitcnt lgkmcnt(0)
v_xor_b32 v48, 64, v47
v_add_u32 v48, 98304, v48
ds_read_b64_tr_b16 v[168:169], v48
ds_read_b64_tr_b16 v[170:171], v48 offset:512
ds_read_b64_tr_b16 v[172:173], v48 offset:8192
ds_read_b64_tr_b16 v[174:175], v48 offset:8704
ds_read_b64_tr_b16 v[184:185], v48 offset:32
ds_read_b64_tr_b16 v[186:187], v48 offset:544
ds_read_b64_tr_b16 v[188:189], v48 offset:8224
ds_read_b64_tr_b16 v[190:191], v48 offset:8736
s_waitcnt lgkmcnt(0)
v_xor_b32 v48, 128, v47
v_add_u32 v48, 98304, v48
ds_read_b64_tr_b16 v[200:201], v48
ds_read_b64_tr_b16 v[202:203], v48 offset:512
ds_read_b64_tr_b16 v[204:205], v48 offset:8192
ds_read_b64_tr_b16 v[206:207], v48 offset:8704
ds_read_b64_tr_b16 v[216:217], v48 offset:32
ds_read_b64_tr_b16 v[218:219], v48 offset:544
ds_read_b64_tr_b16 v[220:221], v48 offset:8224
ds_read_b64_tr_b16 v[222:223], v48 offset:8736
s_waitcnt lgkmcnt(0)
v_xor_b32 v48, 192, v47
v_add_u32 v48, 98304, v48
ds_read_b64_tr_b16 v[232:233], v48
ds_read_b64_tr_b16 v[234:235], v48 offset:512
ds_read_b64_tr_b16 v[236:237], v48 offset:8192
ds_read_b64_tr_b16 v[238:239], v48 offset:8704
ds_read_b64_tr_b16 v[248:249], v48 offset:32
ds_read_b64_tr_b16 v[250:251], v48 offset:544
ds_read_b64_tr_b16 v[252:253], v48 offset:8224
ds_read_b64_tr_b16 v[254:255], v48 offset:8736
s_waitcnt lgkmcnt(0)
L_rs_wo6:
s_barrier
s_add_u32 m0, s48, 98304
s_mov_b32 s22, 3145728
buffer_load_dwordx4 v44, s[8:11], s22 offen  lds
s_add_u32 m0, s48, 102400
s_mov_b32 s22, 3178496
buffer_load_dwordx4 v44, s[8:11], s22 offen  lds
s_add_u32 m0, s48, 106496
s_mov_b32 s22, 3211264
buffer_load_dwordx4 v44, s[8:11], s22 offen  lds
s_add_u32 m0, s48, 110592
s_mov_b32 s22, 3244032
buffer_load_dwordx4 v44, s[8:11], s22 offen  lds
s_waitcnt vmcnt(28)
s_barrier
s_cmp_lg_u32 s20, 3
s_cbranch_scc1 L_rs_wo7
v_xor_b32 v48, 0, v47
v_add_u32 v48, 114688, v48
ds_read_b64_tr_b16 v[136:137], v48
ds_read_b64_tr_b16 v[138:139], v48 offset:512
ds_read_b64_tr_b16 v[140:141], v48 offset:8192
ds_read_b64_tr_b16 v[142:143], v48 offset:8704
ds_read_b64_tr_b16 v[152:153], v48 offset:32
ds_read_b64_tr_b16 v[154:155], v48 offset:544
ds_read_b64_tr_b16 v[156:157], v48 offset:8224
ds_read_b64_tr_b16 v[158:159], v48 offset:8736
s_waitcnt lgkmcnt(0)
v_xor_b32 v48, 64, v47
v_add_u32 v48, 114688, v48
ds_read_b64_tr_b16 v[168:169], v48
ds_read_b64_tr_b16 v[170:171], v48 offset:512
ds_read_b64_tr_b16 v[172:173], v48 offset:8192
ds_read_b64_tr_b16 v[174:175], v48 offset:8704
ds_read_b64_tr_b16 v[184:185], v48 offset:32
ds_read_b64_tr_b16 v[186:187], v48 offset:544
ds_read_b64_tr_b16 v[188:189], v48 offset:8224
ds_read_b64_tr_b16 v[190:191], v48 offset:8736
s_waitcnt lgkmcnt(0)
v_xor_b32 v48, 128, v47
v_add_u32 v48, 114688, v48
ds_read_b64_tr_b16 v[200:201], v48
ds_read_b64_tr_b16 v[202:203], v48 offset:512
ds_read_b64_tr_b16 v[204:205], v48 offset:8192
ds_read_b64_tr_b16 v[206:207], v48 offset:8704
ds_read_b64_tr_b16 v[216:217], v48 offset:32
ds_read_b64_tr_b16 v[218:219], v48 offset:544
ds_read_b64_tr_b16 v[220:221], v48 offset:8224
ds_read_b64_tr_b16 v[222:223], v48 offset:8736
s_waitcnt lgkmcnt(0)
v_xor_b32 v48, 192, v47
v_add_u32 v48, 114688, v48
ds_read_b64_tr_b16 v[232:233], v48
ds_read_b64_tr_b16 v[234:235], v48 offset:512
ds_read_b64_tr_b16 v[236:237], v48 offset:8192
ds_read_b64_tr_b16 v[238:239], v48 offset:8704
ds_read_b64_tr_b16 v[248:249], v48 offset:32
ds_read_b64_tr_b16 v[250:251], v48 offset:544
ds_read_b64_tr_b16 v[252:253], v48 offset:8224
ds_read_b64_tr_b16 v[254:255], v48 offset:8736
s_waitcnt lgkmcnt(0)
L_rs_wo7:
s_barrier
s_add_u32 m0, s48, 114688
s_mov_b32 s22, 3670016
buffer_load_dwordx4 v44, s[8:11], s22 offen  lds
s_add_u32 m0, s48, 118784
s_mov_b32 s22, 3702784
buffer_load_dwordx4 v44, s[8:11], s22 offen  lds
s_add_u32 m0, s48, 122880
s_mov_b32 s22, 3735552
buffer_load_dwordx4 v44, s[8:11], s22 offen  lds
s_add_u32 m0, s48, 126976
s_mov_b32 s22, 3768320
buffer_load_dwordx4 v44, s[8:11], s22 offen  lds
s_waitcnt vmcnt(28)
s_barrier
v_add_u32 v48, 0, v46
ds_read_b64_tr_b16 v[64:65], v48
ds_read_b64_tr_b16 v[66:67], v48 offset:512
ds_read_b64_tr_b16 v[68:69], v48 offset:8192
ds_read_b64_tr_b16 v[70:71], v48 offset:8704
ds_read_b64_tr_b16 v[72:73], v48 offset:8
ds_read_b64_tr_b16 v[74:75], v48 offset:520
ds_read_b64_tr_b16 v[76:77], v48 offset:8200
ds_read_b64_tr_b16 v[78:79], v48 offset:8712
s_waitcnt lgkmcnt(0)
s_barrier
ds_write_b128 v32, v[64:67]
ds_write_b128 v32, v[68:71] offset:1024
ds_write_b128 v32, v[72:75] offset:2048
ds_write_b128 v32, v[76:79] offset:3072
s_waitcnt lgkmcnt(0)
s_waitcnt vmcnt(24)
s_barrier
v_add_u32 v48, 16384, v46
ds_read_b64_tr_b16 v[64:65], v48
ds_read_b64_tr_b16 v[66:67], v48 offset:512
ds_read_b64_tr_b16 v[68:69], v48 offset:8192
ds_read_b64_tr_b16 v[70:71], v48 offset:8704
ds_read_b64_tr_b16 v[72:73], v48 offset:8
ds_read_b64_tr_b16 v[74:75], v48 offset:520
ds_read_b64_tr_b16 v[76:77], v48 offset:8200
ds_read_b64_tr_b16 v[78:79], v48 offset:8712
s_waitcnt lgkmcnt(0)
s_barrier
ds_write_b128 v32, v[64:67] offset:16384
ds_write_b128 v32, v[68:71] offset:17408
ds_write_b128 v32, v[72:75] offset:18432
ds_write_b128 v32, v[76:79] offset:19456
s_waitcnt lgkmcnt(0)
s_waitcnt vmcnt(20)
s_barrier
s_getpc_b64 s[16:17]
L_rs_pc0:
s_add_u32 s16, s16, L_rs_w0_entry - L_rs_pc0
s_addc_u32 s17, s17, 0
v_lshlrev_b32 v49, 7, v0
v_min_u32 v49, L_rs_end - L_rs_w0_entry, v49
global_load_dword v50, v49, s[16:17]
v_lshlrev_b32 v49, 7, v40
s_xor_b32 s23, s35, 16384
s_cmp_eq_u32 s20, 1
s_cselect_b32 s22, s35, s47
s_cmp_eq_u32 s20, 2
s_cselect_b32 s22, s23, s22
s_lshl_b32 s23, s31, 13
s_add_u32 s23, s23, 178257920
s_cmp_eq_u32 s20, 3
s_cselect_b32 s22, s23, s22
buffer_load_dword v51, v49, s[4:7], s22 offen sc1
v_lshlrev_b32 v49, 13, v0
v_and_b32 v49, 0x1fffff, v49
s_mov_b32 s22, 67108864
buffer_load_dword v52, v49, s[4:7], s22 offen sc1
buffer_load_dword v57, v7, s[4:7], 0 offen sc1
v_add_u32 v48, 32768, v46
ds_read_b64_tr_b16 v[64:65], v48
ds_read_b64_tr_b16 v[66:67], v48 offset:512
ds_read_b64_tr_b16 v[68:69], v48 offset:8192
ds_read_b64_tr_b16 v[70:71], v48 offset:8704
ds_read_b64_tr_b16 v[72:73], v48 offset:8
ds_read_b64_tr_b16 v[74:75], v48 offset:520
ds_read_b64_tr_b16 v[76:77], v48 offset:8200
ds_read_b64_tr_b16 v[78:79], v48 offset:8712
s_waitcnt lgkmcnt(0)
s_barrier
ds_write_b128 v32, v[64:67] offset:32768
ds_write_b128 v32, v[68:71] offset:33792
ds_write_b128 v32, v[72:75] offset:34816
ds_write_b128 v32, v[76:79] offset:35840
s_waitcnt lgkmcnt(0)
s_waitcnt vmcnt(16)
s_barrier
v_add_u32 v48, 49152, v46
ds_read_b64_tr_b16 v[64:65], v48
ds_read_b64_tr_b16 v[66:67], v48 offset:512
ds_read_b64_tr_b16 v[68:69], v48 offset:8192
ds_read_b64_tr_b16 v[70:71], v48 offset:8704
ds_read_b64_tr_b16 v[72:73], v48 offset:8
ds_read_b64_tr_b16 v[74:75], v48 offset:520
ds_read_b64_tr_b16 v[76:77], v48 offset:8200
ds_read_b64_tr_b16 v[78:79], v48 offset:8712
s_waitcnt lgkmcnt(0)
s_barrier
ds_write_b128 v32, v[64:67] offset:49152
ds_write_b128 v32, v[68:71] offset:50176
ds_write_b128 v32, v[72:75] offset:51200
ds_write_b128 v32, v[76:79] offset:52224
s_waitcnt lgkmcnt(0)
s_waitcnt vmcnt(12)
s_barrier
v_add_u32 v48, 65536, v46
ds_read_b64_tr_b16 v[64:65], v48
ds_read_b64_tr_b16 v[66:67], v48 offset:512
ds_read_b64_tr_b16 v[68:69], v48 offset:8192
ds_read_b64_tr_b16 v[70:71], v48 offset:8704
ds_read_b64_tr_b16 v[72:73], v48 offset:8
ds_read_b64_tr_b16 v[74:75], v48 offset:520
ds_read_b64_tr_b16 v[76:77], v48 offset:8200
ds_read_b64_tr_b16 v[78:79], v48 offset:8712
s_waitcnt lgkmcnt(0)
s_barrier
ds_write_b128 v33, v[64:67]
ds_write_b128 v33, v[68:71] offset:1024
ds_write_b128 v33, v[72:75] offset:2048
ds_write_b128 v33, v[76:79] offset:3072
s_waitcnt lgkmcnt(0)
s_waitcnt vmcnt(8)
s_barrier
v_add_u32 v48, 81920, v46
ds_read_b64_tr_b16 v[64:65], v48
ds_read_b64_tr_b16 v[66:67], v48 offset:512
ds_read_b64_tr_b16 v[68:69], v48 offset:8192
ds_read_b64_tr_b16 v[70:71], v48 offset:8704
ds_read_b64_tr_b16 v[72:73], v48 offset:8
ds_read_b64_tr_b16 v[74:75], v48 offset:520
ds_read_b64_tr_b16 v[76:77], v48 offset:8200
ds_read_b64_tr_b16 v[78:79], v48 offset:8712
s_waitcnt lgkmcnt(0)
s_barrier
ds_write_b128 v33, v[64:67] offset:16384
ds_write_b128 v33, v[68:71] offset:17408
ds_write_b128 v33, v[72:75] offset:18432
ds_write_b128 v33, v[76:79] offset:19456
s_waitcnt lgkmcnt(0)
s_waitcnt vmcnt(4)
s_barrier
v_add_u32 v48, 98304, v46
ds_read_b64_tr_b16 v[64:65], v48
ds_read_b64_tr_b16 v[66:67], v48 offset:512
ds_read_b64_tr_b16 v[68:69], v48 offset:8192
ds_read_b64_tr_b16 v[70:71], v48 offset:8704
ds_read_b64_tr_b16 v[72:73], v48 offset:8
ds_read_b64_tr_b16 v[74:75], v48 offset:520
ds_read_b64_tr_b16 v[76:77], v48 offset:8200
ds_read_b64_tr_b16 v[78:79], v48 offset:8712
s_waitcnt lgkmcnt(0)
s_barrier
ds_write_b128 v33, v[64:67] offset:32768
ds_write_b128 v33, v[68:71] offset:33792
ds_write_b128 v33, v[72:75] offset:34816
ds_write_b128 v33, v[76:79] offset:35840
s_waitcnt lgkmcnt(0)
s_waitcnt vmcnt(0)
s_barrier
v_add_u32 v48, 114688, v46
ds_read_b64_tr_b16 v[64:65], v48
ds_read_b64_tr_b16 v[66:67], v48 offset:512
ds_read_b64_tr_b16 v[68:69], v48 offset:8192
ds_read_b64_tr_b16 v[70:71], v48 offset:8704
ds_read_b64_tr_b16 v[72:73], v48 offset:8
ds_read_b64_tr_b16 v[74:75], v48 offset:520
ds_read_b64_tr_b16 v[76:77], v48 offset:8200
ds_read_b64_tr_b16 v[78:79], v48 offset:8712
s_waitcnt lgkmcnt(0)
s_barrier
ds_write_b128 v33, v[64:67] offset:49152
ds_write_b128 v33, v[68:71] offset:50176
ds_write_b128 v33, v[72:75] offset:51200
ds_write_b128 v33, v[76:79] offset:52224
s_waitcnt lgkmcnt(0)
L_rs_iw:
buffer_load_dword v58, off, s[12:15], 0 offset:204 sc1
s_waitcnt vmcnt(0)
L_rs_iw1:
v_and_b32 v50, 0xffff, v58
v_readfirstlane_b32 s60, v58
v_cmp_ne_u32 vcc, s100, v50
s_cbranch_vccnz L_rs_iw
s_lshr_b32 s60, s60, 15
s_cmp_gt_u32 s60, s100
s_cselect_b32 s60, 8192, 0
s_bfe_u32 s22, s31, 0x10001
s_lshl_b32 s22, s22, 12
s_add_u32 s22, s22, s60
s_lshl_b32 s23, s20, 10
s_add_u32 s22, s22, s23
s_add_u32 s38, s38, s22
s_add_u32 s37, s37, s22
s_xor_b32 s40, s38, 4096
s_xor_b32 s39, s37, 4096
s_xor_b32 s36, s35, 16384
s_mov_b32 s21, 0
s_cmp_eq_u32 s30, 0
s_mov_b32 s22, 0x33003300
s_cselect_b32 s16, 0x00330033, s22
s_mov_b32 s17, s16
s_cselect_b32 s18, -1, 0
s_not_b32 s19, s18
s_lshl_b32 s22, s31, 13
s_lshl_b32 s23, s20, 11
s_add_u32 s22, s22, s23
s_add_u32 s43, s22, 16777216
s_add_u32 s44, s22, 33554432
s_lshl_b32 s45, s31, 13
s_add_u32 s45, s45, 178257920
s_mul_i32 s48, s20, 5120
s_add_u32 m0, s48, 140288
s_mov_b32 s41, 1
s_mov_b32 s42, 1
v_mov_b32 v0, v34
v_bfrev_b32 v12, 1
v_bfrev_b32 v3, 1
v_cndmask_b32 v10, v3, v10, s[16:17]
v_cndmask_b32 v9, v3, v9, s[26:27]
s_sub_u32 s45, s45, 0
s_lshl_b32 s51, s30, 11
s_add_u32 s51, s51, s45
s_mov_b32 s50, 0
s_cmp_lg_u32 s20, 3
s_cbranch_scc1 L_rs_kv0
v_readlane_b32 s50, v57, 0
v_readlane_b32 s22, v57, 2
v_readlane_b32 s23, v57, 1
v_readlane_b32 s24, v57, 3
s_nop 3
s_min_u32 s50, s50, s22
s_min_u32 s23, s23, s24
s_lshl_b32 s50, s50, 1
s_lshl_b32 s23, s23, 1
s_add_u32 s23, s23, 1
s_min_u32 s50, s50, s23
L_rs_kvb0:
s_add_u32 s22, s21, 1
s_min_u32 s22, s22, 63
s_cmp_gt_u32 s50, s22
s_cbranch_scc1 L_rs_kvd0
buffer_load_dword v48, v7, s[4:7], 0 offen sc1
s_waitcnt vmcnt(0)
v_readlane_b32 s50, v48, 0
v_readlane_b32 s22, v48, 2
v_readlane_b32 s23, v48, 1
v_readlane_b32 s24, v48, 3
s_nop 3
s_min_u32 s50, s50, s22
s_min_u32 s23, s23, s24
s_lshl_b32 s50, s50, 1
s_lshl_b32 s23, s23, 1
s_add_u32 s23, s23, 1
s_min_u32 s50, s50, s23
s_branch L_rs_kvb0
L_rs_kvd0:
L_rs_kv0:
s_barrier
s_cmp_eq_u32 s20, 1
s_cbranch_scc1 L_rs_w1_entry
s_cmp_eq_u32 s20, 2
s_cbranch_scc1 L_rs_w2_entry
s_cmp_eq_u32 s20, 3
s_cbranch_scc1 L_rs_w3_entry
L_rs_w0_entry:
v_mfma_f32_32x32x8_bf16 v[96:111], v[14:15], v[14:15], 0
v_mfma_f32_16x16x16_bf16 v[112:115], v[14:15], v[14:15], 0
v_mfma_f32_16x16x16_bf16 v[116:119], v[14:15], v[14:15], 0
ds_read_b128 v[64:67], v1
ds_read_b128 v[68:71], v1 offset:1024
ds_read_b128 v[72:75], v1 offset:2048
ds_read_b128 v[76:79], v1 offset:3072
ds_read_b128 v[80:83], v1 offset:16384
ds_read_b128 v[84:87], v1 offset:17408
ds_read_b128 v[88:91], v1 offset:18432
ds_read_b128 v[92:95], v1 offset:19456
buffer_load_dwordx4 v[120:123], v1, s[4:7], s44 offen
buffer_load_dwordx4 v[124:127], v1, s[4:7], s44 offen offset:1024
s_add_u32 s44, s44, 262144
L_rs_w0_loop:
s_add_u32 s22, s35, 0
s_waitcnt vmcnt(0)
buffer_load_dwordx4 v[32:35], v1, s[4:7], s22 offen sc1
buffer_load_dwordx4 v[36:39], v1, s[4:7], s22 offen offset:1024 sc1
L_rs_w0_pa:
s_waitcnt vmcnt(1)
ds_write_b128 v6, v[32:35]
s_waitcnt vmcnt(0)
ds_write_b128 v6, v[36:39] offset:1024
v_max3_u32 v3, v32, v34, v36
v_max_u32 v3, v3, v38
v_cmp_eq_u32 vcc, -1, v3
v_smfmac_f32_16x16x64_bf16 v[96:99], v[32:35], a[0:7], v2
buffer_load_dwordx4 v[32:35], v1, s[4:7], s22 offen sc1
v_smfmac_f32_16x16x64_bf16 v[100:103], v[32:35], a[8:15], v2
buffer_load_dwordx4 v[36:39], v1, s[4:7], s22 offen offset:1024 sc1
v_smfmac_f32_16x16x64_bf16 v[104:107], v[32:35], a[128:135], v2
s_cbranch_vccnz L_rs_w0_pafail
s_waitcnt lgkmcnt(0)
s_barrier
ds_read_b128 v[40:43], v6 offset:2048
ds_read_b128 v[44:47], v6 offset:3072
v_smfmac_f32_16x16x64_bf16 v[108:111], v[32:35], a[136:143], v2
ds_read_b128 v[48:51], v6 offset:4096
v_smfmac_f32_16x16x64_bf16 v[96:99], v[36:39], a[16:23], v2
ds_read_b128 v[52:55], v6 offset:5120
v_smfmac_f32_16x16x64_bf16 v[100:103], v[36:39], a[24:31], v2
ds_read_b128 v[56:59], v6 offset:6144
v_smfmac_f32_16x16x64_bf16 v[104:107], v[36:39], a[144:151], v2
ds_read_b128 v[60:63], v6 offset:7168
v_smfmac_f32_16x16x64_bf16 v[108:111], v[36:39], a[152:159], v2
buffer_load_dwordx4 v1, s[4:7], s43 offen lds
s_waitcnt lgkmcnt(5)
v_smfmac_f32_16x16x64_bf16 v[96:99], v[40:43], a[32:39], v2
v_smfmac_f32_16x16x64_bf16 v[104:107], v[40:43], a[160:167], v2
s_waitcnt lgkmcnt(4)
v_smfmac_f32_16x16x64_bf16 v[96:99], v[44:47], a[48:55], v2
v_smfmac_f32_16x16x64_bf16 v[104:107], v[44:47], a[176:183], v2
buffer_load_dwordx4 v1, s[4:7], s43 offen offset:1024 lds
s_waitcnt lgkmcnt(3)
v_smfmac_f32_16x16x64_bf16 v[96:99], v[48:51], a[64:71], v2
v_smfmac_f32_16x16x64_bf16 v[104:107], v[48:51], a[192:199], v2
s_waitcnt lgkmcnt(2)
v_smfmac_f32_16x16x64_bf16 v[96:99], v[52:55], a[80:87], v2
v_smfmac_f32_16x16x64_bf16 v[104:107], v[52:55], a[208:215], v2
v_mov_b32 v4, s21
buffer_store_dword v4, v7, s[4:7], 0 offen sc1
s_waitcnt lgkmcnt(1)
v_smfmac_f32_16x16x64_bf16 v[96:99], v[56:59], a[96:103], v2
v_smfmac_f32_16x16x64_bf16 v[104:107], v[56:59], a[224:231], v2
s_waitcnt lgkmcnt(0)
v_smfmac_f32_16x16x64_bf16 v[96:99], v[60:63], a[112:119], v2
v_smfmac_f32_16x16x64_bf16 v[104:107], v[60:63], a[240:247], v2
v_smfmac_f32_16x16x64_bf16 v[100:103], v[40:43], a[40:47], v2
s_nop 2
v_smfmac_f32_16x16x64_bf16 v[100:103], v[44:47], a[56:63], v2
s_nop 1
v_add_f32 v96, v96, v98
v_smfmac_f32_16x16x64_bf16 v[100:103], v[48:51], a[72:79], v2
v_add_f32 v97, v97, v99
v_add_f32 v104, v104, v106
v_smfmac_f32_16x16x64_bf16 v[100:103], v[52:55], a[88:95], v2
v_add_f32 v105, v105, v107
v_cvt_pk_bf16_f32 v96, v96, v97
v_smfmac_f32_16x16x64_bf16 v[100:103], v[56:59], a[104:111], v2
v_cvt_pk_bf16_f32 v97, v104, v105
v_and_or_b32 v96, v96, -2, s41
v_smfmac_f32_16x16x64_bf16 v[100:103], v[60:63], a[120:127], v2
buffer_store_dwordx2 v[96:97], v11, s[4:7], s37 offen sc1
v_smfmac_f32_16x16x64_bf16 v[108:111], v[40:43], a[168:175], v2
v_smfmac_f32_16x16x64_bf16 v[108:111], v[44:47], a[184:191], v2
v_smfmac_f32_16x16x64_bf16 v[108:111], v[48:51], a[200:207], v2
v_smfmac_f32_16x16x64_bf16 v[108:111], v[52:55], a[216:223], v2
v_smfmac_f32_16x16x64_bf16 v[108:111], v[56:59], a[232:239], v2
s_nop 2
v_add_f32 v100, v100, v102
v_smfmac_f32_16x16x64_bf16 v[108:111], v[60:63], a[248:255], v2
v_add_f32 v101, v101, v103
v_cvt_pk_bf16_f32 v98, v100, v101
v_and_or_b32 v98, v98, -2, s41
s_nop 4
v_pk_add_f32 v[108:109], v[108:109], v[110:111]
v_cvt_pk_bf16_f32 v99, v108, v109
buffer_store_dwordx2 v[98:99], v11, s[4:7], s37 offen offset:512 sc1
v_smfmac_f32_16x16x64_bf16 v[112:115], v[32:35], v[64:71], v2
ds_read_b128 v[64:67], v1 offset:32768
ds_read_b128 v[68:71], v1 offset:33792
v_smfmac_f32_16x16x64_bf16 v[116:119], v[32:35], v[72:79], v2
ds_read_b128 v[72:75], v1 offset:34816
ds_read_b128 v[76:79], v1 offset:35840
v_smfmac_f32_16x16x64_bf16 v[112:115], v[36:39], v[80:87], v2
ds_read_b128 v[80:83], v1 offset:49152
ds_read_b128 v[84:87], v1 offset:50176
v_smfmac_f32_16x16x64_bf16 v[116:119], v[36:39], v[88:95], v2
ds_read_b128 v[88:91], v1 offset:51200
ds_read_b128 v[92:95], v1 offset:52224
s_waitcnt lgkmcnt(6)
v_smfmac_f32_16x16x64_bf16 v[112:115], v[40:43], v[64:71], v2
ds_read_b128 v[64:67], v5
ds_read_b128 v[68:71], v5 offset:1024
s_waitcnt lgkmcnt(6)
v_smfmac_f32_16x16x64_bf16 v[116:119], v[40:43], v[72:79], v2
ds_read_b128 v[72:75], v5 offset:2048
ds_read_b128 v[76:79], v5 offset:3072
s_waitcnt lgkmcnt(6)
v_smfmac_f32_16x16x64_bf16 v[112:115], v[44:47], v[80:87], v2
ds_read_b128 v[80:83], v5 offset:16384
ds_read_b128 v[84:87], v5 offset:17408
s_waitcnt lgkmcnt(6)
v_smfmac_f32_16x16x64_bf16 v[116:119], v[44:47], v[88:95], v2
ds_read_b128 v[88:91], v5 offset:18432
ds_read_b128 v[92:95], v5 offset:19456
s_waitcnt lgkmcnt(6)
v_smfmac_f32_16x16x64_bf16 v[112:115], v[48:51], v[64:71], v2
ds_read_b128 v[64:67], v5 offset:32768
ds_read_b128 v[68:71], v5 offset:33792
s_waitcnt lgkmcnt(6)
v_smfmac_f32_16x16x64_bf16 v[116:119], v[48:51], v[72:79], v2
ds_read_b128 v[72:75], v5 offset:34816
ds_read_b128 v[76:79], v5 offset:35840
s_waitcnt lgkmcnt(6)
v_smfmac_f32_16x16x64_bf16 v[112:115], v[52:55], v[80:87], v2
ds_read_b128 v[80:83], v5 offset:49152
ds_read_b128 v[84:87], v5 offset:50176
s_waitcnt lgkmcnt(6)
v_smfmac_f32_16x16x64_bf16 v[116:119], v[52:55], v[88:95], v2
ds_read_b128 v[88:91], v5 offset:51200
ds_read_b128 v[92:95], v5 offset:52224
s_waitcnt lgkmcnt(6)
v_smfmac_f32_16x16x64_bf16 v[112:115], v[56:59], v[64:71], v2
s_waitcnt lgkmcnt(4)
v_smfmac_f32_16x16x64_bf16 v[116:119], v[56:59], v[72:79], v2
s_waitcnt lgkmcnt(2)
v_smfmac_f32_16x16x64_bf16 v[112:115], v[60:63], v[80:87], v2
s_waitcnt lgkmcnt(0)
v_smfmac_f32_16x16x64_bf16 v[116:119], v[60:63], v[88:95], v2
buffer_load_dwordx2 v[108:109], v11, s[4:7], s38 offen sc1
v_mfma_f32_16x16x16_bf16 v[100:103], v[96:97], v[16:17], 0
v_mfma_f32_16x16x16_bf16 v[104:107], v[98:99], v[16:17], 0
s_nop 4
v_add_f32 v112, v112, v114
v_add_f32 v113, v113, v115
v_add_f32 v114, v116, v118
v_add_f32 v115, v117, v119
v_cvt_pk_bf16_f32 v18, v112, v113
v_cvt_pk_bf16_f32 v19, v114, v115
v_and_or_b32 v18, v18, -2, s41
buffer_load_dwordx2 v[110:111], v11, s[4:7], s38 offen offset:512 sc1
s_barrier
buffer_store_dwordx2 v[18:19], v11, s[4:7], s39 offen sc1
v_mov_b32 v112, v18
v_mov_b32 v114, v19
v_mov_b32 v92, v28
v_mov_b32 v93, 0
s_waitcnt vmcnt(6)
s_barrier
ds_read_b128 v[32:35], v6 offset:9216
ds_read_b128 v[36:39], v6 offset:10240
ds_read_b128 v[40:43], v6 offset:14336
ds_read_b128 v[44:47], v6 offset:15360
ds_read_b128 v[48:51], v6 offset:19456
ds_read_b128 v[52:55], v6 offset:20480
ds_read_b128 v[56:59], v6 offset:24576
ds_read_b128 v[60:63], v6 offset:25600
buffer_load_dwordx2 v[20:21], v11, s[4:7], s38 offen sc1
buffer_load_dwordx2 v[22:23], v11, s[4:7], s38 offen offset:512 sc1
s_waitcnt vmcnt(4)
v_mfma_f32_16x16x16_bf16 v[80:83], v[108:109], v[16:17], v[100:103]
v_and_b32 v3, 1, v108
v_cmp_ne_u32 vcc, s41, v3
s_nop 5
v_cvt_pk_bf16_f32 v64, v80, v81
v_cvt_pk_bf16_f32 v65, v82, v83
s_cbranch_vccnz L_rs_w0_xslow
s_waitcnt vmcnt(3)
v_mfma_f32_16x16x16_bf16 v[84:87], v[110:111], v[16:17], v[104:107]
v_and_b32 v3, 1, v110
v_cmp_ne_u32 vcc, s41, v3
s_nop 5
v_cvt_pk_bf16_f32 v66, v84, v85
v_cvt_pk_bf16_f32 v67, v86, v87
ds_write_b128 v6, v[64:67] offset:8192
s_cbranch_vccnz L_rs_w0_xslow
L_rs_w0_xok:
s_cmp_eq_u32 s21, 63
s_cbranch_scc1 L_rs_w0_last
buffer_load_dwordx2 v[116:117], v11, s[4:7], s40 offen sc1
s_waitcnt lgkmcnt(1)
v_mfma_f32_16x16x32_bf16 v[80:83], v[32:35], v[64:67], 0
s_waitcnt lgkmcnt(0)
s_barrier
ds_read_b128 v[68:71], v6 offset:13312
ds_read_b128 v[72:75], v6 offset:18432
ds_read_b128 v[76:79], v6 offset:23552
v_mfma_f32_16x16x32_bf16 v[84:87], v[36:39], v[64:67], 0
v_mfma_f32_16x16x32_bf16 v[88:91], v[64:67], v[64:67], 0
buffer_load_dwordx2 v[20:21], v11, s[4:7], s40 offen sc1
s_waitcnt lgkmcnt(2)
v_mfma_f32_16x16x32_bf16 v[80:83], v[40:43], v[68:71], v[80:83]
buffer_store_dwordx4 v[64:67], v10, s[4:7], s45 offen sc1
s_waitcnt lgkmcnt(1)
v_mfma_f32_16x16x32_bf16 v[80:83], v[48:51], v[72:75], v[80:83]
s_waitcnt lgkmcnt(0)
v_mfma_f32_16x16x32_bf16 v[80:83], v[56:59], v[76:79], v[80:83]
v_mfma_f32_16x16x32_bf16 v[84:87], v[44:47], v[68:71], v[84:87]
v_mfma_f32_16x16x32_bf16 v[84:87], v[52:55], v[72:75], v[84:87]
buffer_store_dwordx2 v[18:19], v11, s[4:7], s51 offen offset:2048 sc1
v_mfma_f32_16x16x32_bf16 v[84:87], v[60:63], v[76:79], v[84:87]
v_mfma_f32_16x16x32_bf16 v[88:91], v[68:71], v[68:71], v[88:91]
v_mfma_f32_16x16x32_bf16 v[88:91], v[72:75], v[72:75], v[88:91]
v_mfma_f32_16x16x32_bf16 v[88:91], v[76:79], v[76:79], v[88:91]
v_mfma_f32_32x32x4_2b_bf16 v[32:63], v[14:15], v[14:15], 0
s_nop 0
v_max3_f32 v4, v80, v81, v82
s_nop 1
v_max3_f32 v4, v4, v83, v84
v_max3_f32 v4, v4, v85, v86
v_max_f32 v4, v4, v87
v_max3_f32 v90, v4, v88, v89
v_max3_f32 v4, v4, v88, v89
s_nop 1
v_permlane16_swap_b32 v4, v90
v_max_f32 v4, v4, v90
v_max_f32 v90, v4, v90
s_nop 1
v_permlane32_swap_b32 v4, v90
v_max_f32 v4, v4, v90
v_mul_f32 v4, s34, v4
v_pk_fma_f32 v[80:81], v[80:81], s[34:35], v[4:5] op_sel_hi:[1,0,0] neg_lo:[0,0,1] neg_hi:[0,0,1]
v_pk_fma_f32 v[82:83], v[82:83], s[34:35], v[4:5] op_sel_hi:[1,0,0] neg_lo:[0,0,1] neg_hi:[0,0,1]
v_pk_fma_f32 v[84:85], v[84:85], s[34:35], v[4:5] op_sel_hi:[1,0,0] neg_lo:[0,0,1] neg_hi:[0,0,1]
v_pk_fma_f32 v[86:87], v[86:87], s[34:35], v[4:5] op_sel_hi:[1,0,0] neg_lo:[0,0,1] neg_hi:[0,0,1]
v_pk_fma_f32 v[88:89], v[88:89], s[34:35], v[4:5] op_sel_hi:[1,0,0] neg_lo:[0,0,1] neg_hi:[0,0,1]
v_exp_f32 v80, v80
v_exp_f32 v81, v81
v_exp_f32 v82, v82
v_cvt_pk_bf16_f32 v68, v80, v81
v_exp_f32 v83, v83
v_exp_f32 v84, v84
v_cvt_pk_bf16_f32 v69, v82, v83
v_exp_f32 v85, v85
v_exp_f32 v86, v86
v_cvt_pk_bf16_f32 v70, v84, v85
v_exp_f32 v87, v87
v_exp_f32 v88, v88
v_cvt_pk_bf16_f32 v71, v86, v87
v_exp_f32 v89, v89
s_waitcnt vmcnt(3)
v_mfma_f32_16x16x32_bf16 v[76:79], v[28:31], v[68:71], 0
v_and_b32 v3, 1, v116
v_cvt_pk_bf16_f32 v72, v88, v89
v_mfma_f32_16x16x32_bf16 v[100:103], v[120:123], v[68:71], 0
v_cmp_ne_u32 vcc, s41, v3
v_cvt_pk_bf16_f32 v73, v88, v89
v_mfma_f32_16x16x32_bf16 v[104:107], v[124:127], v[68:71], 0
v_mov_b32 v113, v116
v_mov_b32 v115, v117
v_mfma_f32_16x16x16_bf16 v[76:79], v[92:93], v[72:73], v[76:79]
s_cbranch_vccnz L_rs_w0_pv0
L_rs_w0_pv2:
v_mfma_f32_16x16x16_bf16 v[100:103], v[112:113], v[72:73], v[100:103]
v_mfma_f32_16x16x16_bf16 v[104:107], v[114:115], v[72:73], v[104:107]
buffer_load_dwordx4 v[120:123], v1, s[4:7], s44 offen
buffer_load_dwordx4 v[124:127], v1, s[4:7], s44 offen offset:1024
s_nop 2
v_rcp_f32 v76, v76
s_mov_b64 exec, s[28:29]
v_pk_mul_f32 v[100:101], v[100:101], v[76:77] op_sel_hi:[1,0]
v_pk_mul_f32 v[102:103], v[102:103], v[76:77] op_sel_hi:[1,0]
v_pk_mul_f32 v[104:105], v[104:105], v[76:77] op_sel_hi:[1,0]
v_pk_mul_f32 v[106:107], v[106:107], v[76:77] op_sel_hi:[1,0]
v_cvt_pk_bf16_f32 v84, v100, v101
v_cvt_pk_bf16_f32 v85, v102, v103
v_cvt_pk_bf16_f32 v86, v104, v105
v_cvt_pk_bf16_f32 v87, v106, v107
ds_write_b128 v6, v[84:87] offset:28640
s_mov_b64 exec, -1
s_waitcnt lgkmcnt(0)
s_barrier
ds_read_b128 v[68:71], v6 offset:28672
ds_read_b128 v[72:75], v6 offset:29696
s_waitcnt lgkmcnt(1)
v_smfmac_f32_16x16x64_bf16 v[32:35], v[68:71], v[128:135], v2
s_add_u32 s21, s21, 1
s_xor_b32 s38, s38, 1048576
s_xor_b32 s37, s37, 1048576
s_waitcnt lgkmcnt(0)
v_smfmac_f32_16x16x64_bf16 v[32:35], v[72:75], v[136:143], v2
s_xor_b32 s40, s40, 1048576
s_xor_b32 s39, s39, 1048576
s_lshr_b32 s41, s21, 1
v_smfmac_f32_16x16x64_bf16 v[36:39], v[68:71], v[144:151], v2
s_and_b32 s41, s41, 1
s_xor_b32 s41, s41, 1
s_xor_b32 s35, s35, 16384
v_smfmac_f32_16x16x64_bf16 v[36:39], v[72:75], v[152:159], v2
v_add_f32 v32, v32, v34
s_xor_b32 s36, s36, 16384
s_add_u32 s43, s43, 262144
s_add_u32 s44, s44, 262144
v_smfmac_f32_16x16x64_bf16 v[40:43], v[68:71], v[160:167], v2
v_add_f32 v33, v33, v35
v_smfmac_f32_16x16x64_bf16 v[40:43], v[72:75], v[168:175], v2
v_cvt_pk_bf16_f32 v32, v32, v33
v_smfmac_f32_16x16x64_bf16 v[44:47], v[68:71], v[176:183], v2
v_and_or_b32 v32, v32, -2, s42
v_smfmac_f32_16x16x64_bf16 v[44:47], v[72:75], v[184:191], v2
v_add_f32 v36, v36, v38
v_smfmac_f32_16x16x64_bf16 v[48:51], v[68:71], v[192:199], v2
v_add_f32 v37, v37, v39
v_smfmac_f32_16x16x64_bf16 v[48:51], v[72:75], v[200:207], v2
v_cvt_pk_bf16_f32 v33, v36, v37
v_smfmac_f32_16x16x64_bf16 v[52:55], v[68:71], v[208:215], v2
v_add_f32 v40, v40, v42
v_smfmac_f32_16x16x64_bf16 v[52:55], v[72:75], v[216:223], v2
v_add_f32 v41, v41, v43
v_smfmac_f32_16x16x64_bf16 v[56:59], v[68:71], v[224:231], v2
v_cvt_pk_bf16_f32 v34, v40, v41
v_smfmac_f32_16x16x64_bf16 v[56:59], v[72:75], v[232:239], v2
v_add_f32 v44, v44, v46
v_smfmac_f32_16x16x64_bf16 v[60:63], v[68:71], v[240:247], v2
v_add_f32 v45, v45, v47
v_smfmac_f32_16x16x64_bf16 v[60:63], v[72:75], v[248:255], v2
v_cvt_pk_bf16_f32 v35, v44, v45
buffer_store_dwordx4 v[32:35], v8, s[4:7], s46 offen sc1
v_pk_add_f32 v[48:49], v[48:49], v[50:51]
v_cvt_pk_bf16_f32 v48, v48, v49
v_and_or_b32 v48, v48, -2, s42
v_pk_add_f32 v[52:53], v[52:53], v[54:55]
v_cvt_pk_bf16_f32 v49, v52, v53
v_pk_add_f32 v[56:57], v[56:57], v[58:59]
v_cvt_pk_bf16_f32 v50, v56, v57
v_pk_add_f32 v[60:61], v[60:61], v[62:63]
v_cvt_pk_bf16_f32 v51, v60, v61
buffer_store_dwordx4 v[48:51], v8, s[4:7], s61 offen sc1
s_add_u32 s45, s45, 262144
s_add_u32 s51, s51, 262144
v_mfma_f32_32x32x8_bf16 v[96:111], v[14:15], v[14:15], 0
v_mfma_f32_16x16x16_bf16 v[112:115], v[14:15], v[14:15], 0
v_mfma_f32_16x16x16_bf16 v[116:119], v[14:15], v[14:15], 0
ds_read_b128 v[64:67], v1
ds_read_b128 v[68:71], v1 offset:1024
ds_read_b128 v[72:75], v1 offset:2048
ds_read_b128 v[76:79], v1 offset:3072
ds_read_b128 v[80:83], v1 offset:16384
ds_read_b128 v[84:87], v1 offset:17408
ds_read_b128 v[88:91], v1 offset:18432
ds_read_b128 v[92:95], v1 offset:19456
v_mov_b32 v58, -1
v_mov_b32 v59, -1
s_waitcnt vmcnt(0)
L_rs_w0_cgo:
L_rs_w0_pc:
buffer_load_dword v36, v13, s[4:7], s25 offen sc1
buffer_load_dword v37, v13, s[4:7], s25 offen offset:256 sc1
buffer_load_dword v38, v13, s[4:7], s25 offen offset:512 sc1
buffer_load_dword v39, v13, s[4:7], s25 offen offset:768 sc1
buffer_load_dword v40, v13, s[4:7], s25 offen offset:1024 sc1
buffer_load_dword v41, v13, s[4:7], s25 offen offset:1280 sc1
buffer_load_dword v42, v13, s[4:7], s25 offen offset:1536 sc1
buffer_load_dword v43, v13, s[4:7], s25 offen offset:1792 sc1
s_waitcnt vmcnt(4)
v_mfma_f32_16x16x32_bf16 v[52:55], v[36:39], v[24:27], 0
v_bitop3_b32 v3, s42, v36, v37 bitop3:0x7e
v_bitop3_b32 v4, s42, v38, v39 bitop3:0x7e
s_waitcnt vmcnt(2)
v_or_b32 v3, v3, v4
v_bitop3_b32 v4, s42, v40, v41 bitop3:0x7e
s_waitcnt vmcnt(0)
v_mfma_f32_16x16x32_bf16 v[52:55], v[40:43], v[24:27], v[52:55]
v_bitop3_b32 v56, s42, v42, v43 bitop3:0x7e
v_or3_b32 v3, v3, v4, v56
v_and_b32 v3, v0, v3
v_cmp_ne_u32 vcc, 0, v3
s_nop 3
v_cvt_pk_bf16_f32 v56, v52, v53
v_cvt_pk_bf16_f32 v57, v54, v55
v_min_u32 v56, -2, v56
s_cbranch_vccnz L_rs_w0_pc
s_mov_b64 exec, s[26:27]
buffer_store_dwordx2 v[56:57], v9, s[4:7], s35 offen sc1
buffer_store_dwordx2 v[58:59], v9, s[4:7], s36 offen sc1
s_mov_b64 exec, -1
s_xor_b32 s42, s42, 1
s_branch L_rs_w0_loop
L_rs_w0_last:
buffer_store_dwordx4 v[64:67], v10, s[4:7], s45 offen sc1
buffer_store_dwordx2 v[18:19], v11, s[4:7], s51 offen offset:2048 sc1
s_branch L_rs_end
L_rs_w0_pafail:
s_nop 7
v_mov_b32 v96, 0
v_mov_b32 v97, 0
v_mov_b32 v98, 0
v_mov_b32 v99, 0
v_mov_b32 v100, 0
v_mov_b32 v101, 0
v_mov_b32 v102, 0
v_mov_b32 v103, 0
v_mov_b32 v104, 0
v_mov_b32 v105, 0
v_mov_b32 v106, 0
v_mov_b32 v107, 0
s_branch L_rs_w0_pa
L_rs_w0_xslow:
buffer_load_dwordx2 v[108:109], v11, s[4:7], s38 offen sc1
buffer_load_dwordx2 v[110:111], v11, s[4:7], s38 offen offset:512 sc1
s_waitcnt vmcnt(2)
v_bitop3_b32 v3, s41, v20, v22 bitop3:0x7e
v_mfma_f32_16x16x16_bf16 v[80:83], v[20:21], v[16:17], v[100:103]
v_and_b32 v3, 1, v3
v_mfma_f32_16x16x16_bf16 v[84:87], v[22:23], v[16:17], v[104:107]
v_cmp_ne_u32 vcc, 0, v3
s_cbranch_vccz L_rs_w0_xgot
buffer_load_dwordx2 v[20:21], v11, s[4:7], s38 offen sc1
buffer_load_dwordx2 v[22:23], v11, s[4:7], s38 offen offset:512 sc1
s_waitcnt vmcnt(2)
v_bitop3_b32 v3, s41, v108, v110 bitop3:0x7e
v_mfma_f32_16x16x16_bf16 v[80:83], v[108:109], v[16:17], v[100:103]
v_and_b32 v3, 1, v3
v_mfma_f32_16x16x16_bf16 v[84:87], v[110:111], v[16:17], v[104:107]
v_cmp_ne_u32 vcc, 0, v3
s_cbranch_vccz L_rs_w0_xgot
s_branch L_rs_w0_xslow
L_rs_w0_xgot:
s_nop 3
v_cvt_pk_bf16_f32 v64, v80, v81
v_cvt_pk_bf16_f32 v65, v82, v83
v_cvt_pk_bf16_f32 v66, v84, v85
v_cvt_pk_bf16_f32 v67, v86, v87
ds_write_b128 v6, v[64:67] offset:8192
s_branch L_rs_w0_xok
L_rs_w0_pv0:
s_waitcnt vmcnt(2)
s_branch L_rs_w0_pv1
L_rs_w0_pv:
buffer_load_dwordx2 v[20:21], v11, s[4:7], s40 offen sc1
s_waitcnt vmcnt(0)
L_rs_w0_pv1:
v_and_b32 v3, 1, v20
v_cmp_ne_u32 vcc, s41, v3
v_mov_b32 v113, v20
v_mov_b32 v115, v21
s_cbranch_vccnz L_rs_w0_pv
s_branch L_rs_w0_pv2
L_rs_w1_entry:
v_mfma_f32_32x32x8_bf16 v[96:111], v[14:15], v[14:15], 0
v_mfma_f32_16x16x16_bf16 v[112:115], v[14:15], v[14:15], 0
v_mfma_f32_16x16x16_bf16 v[116:119], v[14:15], v[14:15], 0
ds_read_b128 v[64:67], v1 offset:4096
ds_read_b128 v[68:71], v1 offset:5120
ds_read_b128 v[72:75], v1 offset:6144
ds_read_b128 v[76:79], v1 offset:7168
ds_read_b128 v[80:83], v1 offset:20480
ds_read_b128 v[84:87], v1 offset:21504
ds_read_b128 v[88:91], v1 offset:22528
ds_read_b128 v[92:95], v1 offset:23552
buffer_load_dwordx4 v[120:123], v1, s[4:7], s44 offen
buffer_load_dwordx4 v[124:127], v1, s[4:7], s44 offen offset:1024
s_add_u32 s44, s44, 262144
L_rs_w1_loop:
s_add_u32 s22, s35, 2048
s_waitcnt vmcnt(0)
buffer_load_dwordx4 v[40:43], v1, s[4:7], s22 offen sc1
buffer_load_dwordx4 v[44:47], v1, s[4:7], s22 offen offset:1024 sc1
L_rs_w1_pa:
s_waitcnt vmcnt(1)
ds_write_b128 v6, v[40:43] offset:2048
s_waitcnt vmcnt(0)
ds_write_b128 v6, v[44:47] offset:3072
v_max3_u32 v3, v40, v42, v44
v_max_u32 v3, v3, v46
v_cmp_eq_u32 vcc, -1, v3
v_smfmac_f32_16x16x64_bf16 v[96:99], v[40:43], a[32:39], v2
buffer_load_dwordx4 v[40:43], v1, s[4:7], s22 offen sc1
v_smfmac_f32_16x16x64_bf16 v[100:103], v[40:43], a[40:47], v2
buffer_load_dwordx4 v[44:47], v1, s[4:7], s22 offen offset:1024 sc1
v_smfmac_f32_16x16x64_bf16 v[104:107], v[40:43], a[160:167], v2
s_cbranch_vccnz L_rs_w1_pafail
s_waitcnt lgkmcnt(0)
s_barrier
ds_read_b128 v[48:51], v6 offset:4096
ds_read_b128 v[52:55], v6 offset:5120
v_smfmac_f32_16x16x64_bf16 v[108:111], v[40:43], a[168:175], v2
ds_read_b128 v[56:59], v6 offset:6144
v_smfmac_f32_16x16x64_bf16 v[96:99], v[44:47], a[48:55], v2
ds_read_b128 v[60:63], v6 offset:7168
v_smfmac_f32_16x16x64_bf16 v[100:103], v[44:47], a[56:63], v2
ds_read_b128 v[32:35], v6
v_smfmac_f32_16x16x64_bf16 v[104:107], v[44:47], a[176:183], v2
ds_read_b128 v[36:39], v6 offset:1024
v_smfmac_f32_16x16x64_bf16 v[108:111], v[44:47], a[184:191], v2
s_waitcnt lgkmcnt(5)
v_smfmac_f32_16x16x64_bf16 v[96:99], v[48:51], a[64:71], v2
buffer_load_dwordx4 v1, s[4:7], s43 offen lds
v_smfmac_f32_16x16x64_bf16 v[104:107], v[48:51], a[192:199], v2
s_waitcnt lgkmcnt(4)
v_smfmac_f32_16x16x64_bf16 v[96:99], v[52:55], a[80:87], v2
v_smfmac_f32_16x16x64_bf16 v[104:107], v[52:55], a[208:215], v2
s_waitcnt lgkmcnt(3)
v_smfmac_f32_16x16x64_bf16 v[96:99], v[56:59], a[96:103], v2
buffer_load_dwordx4 v1, s[4:7], s43 offen offset:1024 lds
v_smfmac_f32_16x16x64_bf16 v[104:107], v[56:59], a[224:231], v2
s_waitcnt lgkmcnt(2)
v_smfmac_f32_16x16x64_bf16 v[96:99], v[60:63], a[112:119], v2
v_smfmac_f32_16x16x64_bf16 v[104:107], v[60:63], a[240:247], v2
s_waitcnt lgkmcnt(1)
v_smfmac_f32_16x16x64_bf16 v[96:99], v[32:35], a[0:7], v2
v_smfmac_f32_16x16x64_bf16 v[104:107], v[32:35], a[128:135], v2
s_waitcnt lgkmcnt(0)
v_smfmac_f32_16x16x64_bf16 v[96:99], v[36:39], a[16:23], v2
v_smfmac_f32_16x16x64_bf16 v[104:107], v[36:39], a[144:151], v2
v_smfmac_f32_16x16x64_bf16 v[100:103], v[48:51], a[72:79], v2
s_nop 2
v_smfmac_f32_16x16x64_bf16 v[100:103], v[52:55], a[88:95], v2
s_nop 1
v_add_f32 v96, v96, v98
v_smfmac_f32_16x16x64_bf16 v[100:103], v[56:59], a[104:111], v2
v_add_f32 v97, v97, v99
v_add_f32 v104, v104, v106
v_smfmac_f32_16x16x64_bf16 v[100:103], v[60:63], a[120:127], v2
v_add_f32 v105, v105, v107
v_cvt_pk_bf16_f32 v96, v96, v97
v_smfmac_f32_16x16x64_bf16 v[100:103], v[32:35], a[8:15], v2
v_cvt_pk_bf16_f32 v97, v104, v105
v_and_or_b32 v96, v96, -2, s41
v_smfmac_f32_16x16x64_bf16 v[100:103], v[36:39], a[24:31], v2
buffer_store_dwordx2 v[96:97], v11, s[4:7], s37 offen sc1
v_smfmac_f32_16x16x64_bf16 v[108:111], v[48:51], a[200:207], v2
v_smfmac_f32_16x16x64_bf16 v[108:111], v[52:55], a[216:223], v2
v_smfmac_f32_16x16x64_bf16 v[108:111], v[56:59], a[232:239], v2
v_smfmac_f32_16x16x64_bf16 v[108:111], v[60:63], a[248:255], v2
v_smfmac_f32_16x16x64_bf16 v[108:111], v[32:35], a[136:143], v2
s_nop 2
v_add_f32 v100, v100, v102
v_smfmac_f32_16x16x64_bf16 v[108:111], v[36:39], a[152:159], v2
v_add_f32 v101, v101, v103
v_cvt_pk_bf16_f32 v98, v100, v101
v_and_or_b32 v98, v98, -2, s41
s_nop 4
v_pk_add_f32 v[108:109], v[108:109], v[110:111]
v_cvt_pk_bf16_f32 v99, v108, v109
buffer_store_dwordx2 v[98:99], v11, s[4:7], s37 offen offset:512 sc1
v_smfmac_f32_16x16x64_bf16 v[112:115], v[32:35], v[64:71], v2
ds_read_b128 v[64:67], v1 offset:36864
ds_read_b128 v[68:71], v1 offset:37888
v_smfmac_f32_16x16x64_bf16 v[116:119], v[32:35], v[72:79], v2
ds_read_b128 v[72:75], v1 offset:38912
ds_read_b128 v[76:79], v1 offset:39936
v_smfmac_f32_16x16x64_bf16 v[112:115], v[36:39], v[80:87], v2
ds_read_b128 v[80:83], v1 offset:53248
ds_read_b128 v[84:87], v1 offset:54272
v_smfmac_f32_16x16x64_bf16 v[116:119], v[36:39], v[88:95], v2
ds_read_b128 v[88:91], v1 offset:55296
ds_read_b128 v[92:95], v1 offset:56320
s_waitcnt lgkmcnt(6)
v_smfmac_f32_16x16x64_bf16 v[112:115], v[40:43], v[64:71], v2
ds_read_b128 v[64:67], v5 offset:4096
ds_read_b128 v[68:71], v5 offset:5120
s_waitcnt lgkmcnt(6)
v_smfmac_f32_16x16x64_bf16 v[116:119], v[40:43], v[72:79], v2
ds_read_b128 v[72:75], v5 offset:6144
ds_read_b128 v[76:79], v5 offset:7168
s_waitcnt lgkmcnt(6)
v_smfmac_f32_16x16x64_bf16 v[112:115], v[44:47], v[80:87], v2
ds_read_b128 v[80:83], v5 offset:20480
ds_read_b128 v[84:87], v5 offset:21504
s_waitcnt lgkmcnt(6)
v_smfmac_f32_16x16x64_bf16 v[116:119], v[44:47], v[88:95], v2
ds_read_b128 v[88:91], v5 offset:22528
ds_read_b128 v[92:95], v5 offset:23552
s_waitcnt lgkmcnt(6)
v_smfmac_f32_16x16x64_bf16 v[112:115], v[48:51], v[64:71], v2
ds_read_b128 v[64:67], v5 offset:36864
ds_read_b128 v[68:71], v5 offset:37888
s_waitcnt lgkmcnt(6)
v_smfmac_f32_16x16x64_bf16 v[116:119], v[48:51], v[72:79], v2
ds_read_b128 v[72:75], v5 offset:38912
ds_read_b128 v[76:79], v5 offset:39936
s_waitcnt lgkmcnt(6)
v_smfmac_f32_16x16x64_bf16 v[112:115], v[52:55], v[80:87], v2
ds_read_b128 v[80:83], v5 offset:53248
ds_read_b128 v[84:87], v5 offset:54272
s_waitcnt lgkmcnt(6)
v_smfmac_f32_16x16x64_bf16 v[116:119], v[52:55], v[88:95], v2
ds_read_b128 v[88:91], v5 offset:55296
ds_read_b128 v[92:95], v5 offset:56320
s_waitcnt lgkmcnt(6)
v_smfmac_f32_16x16x64_bf16 v[112:115], v[56:59], v[64:71], v2
s_waitcnt lgkmcnt(4)
v_smfmac_f32_16x16x64_bf16 v[116:119], v[56:59], v[72:79], v2
s_waitcnt lgkmcnt(2)
v_smfmac_f32_16x16x64_bf16 v[112:115], v[60:63], v[80:87], v2
s_waitcnt lgkmcnt(0)
v_smfmac_f32_16x16x64_bf16 v[116:119], v[60:63], v[88:95], v2
buffer_load_dwordx2 v[108:109], v11, s[4:7], s38 offen sc1
v_mfma_f32_16x16x16_bf16 v[100:103], v[96:97], v[16:17], 0
v_mfma_f32_16x16x16_bf16 v[104:107], v[98:99], v[16:17], 0
s_nop 4
v_add_f32 v112, v112, v114
v_add_f32 v113, v113, v115
v_add_f32 v114, v116, v118
v_add_f32 v115, v117, v119
v_cvt_pk_bf16_f32 v18, v112, v113
v_cvt_pk_bf16_f32 v19, v114, v115
v_and_or_b32 v18, v18, -2, s41
buffer_load_dwordx2 v[110:111], v11, s[4:7], s38 offen offset:512 sc1
s_barrier
buffer_store_dwordx2 v[18:19], v11, s[4:7], s39 offen sc1
v_mov_b32 v112, v18
v_mov_b32 v114, v19
v_mov_b32 v92, v28
v_mov_b32 v93, 0
s_waitcnt vmcnt(5)
s_barrier
ds_read_b128 v[32:35], v6 offset:14336
ds_read_b128 v[36:39], v6 offset:15360
ds_read_b128 v[40:43], v6 offset:9216
ds_read_b128 v[44:47], v6 offset:10240
ds_read_b128 v[48:51], v6 offset:24576
ds_read_b128 v[52:55], v6 offset:25600
ds_read_b128 v[56:59], v6 offset:19456
ds_read_b128 v[60:63], v6 offset:20480
buffer_load_dwordx2 v[20:21], v11, s[4:7], s38 offen sc1
buffer_load_dwordx2 v[22:23], v11, s[4:7], s38 offen offset:512 sc1
s_waitcnt vmcnt(4)
v_mfma_f32_16x16x16_bf16 v[80:83], v[108:109], v[16:17], v[100:103]
v_and_b32 v3, 1, v108
v_cmp_ne_u32 vcc, s41, v3
s_nop 5
v_cvt_pk_bf16_f32 v64, v80, v81
v_cvt_pk_bf16_f32 v65, v82, v83
s_cbranch_vccnz L_rs_w1_xslow
s_waitcnt vmcnt(3)
v_mfma_f32_16x16x16_bf16 v[84:87], v[110:111], v[16:17], v[104:107]
v_and_b32 v3, 1, v110
v_cmp_ne_u32 vcc, s41, v3
s_nop 5
v_cvt_pk_bf16_f32 v66, v84, v85
v_cvt_pk_bf16_f32 v67, v86, v87
ds_write_b128 v6, v[64:67] offset:13312
s_cbranch_vccnz L_rs_w1_xslow
L_rs_w1_xok:
s_cmp_eq_u32 s21, 63
s_cbranch_scc1 L_rs_w1_last
buffer_load_dwordx2 v[116:117], v11, s[4:7], s40 offen sc1
s_waitcnt lgkmcnt(1)
v_mfma_f32_16x16x32_bf16 v[80:83], v[32:35], v[64:67], 0
s_waitcnt lgkmcnt(0)
s_barrier
ds_read_b128 v[68:71], v6 offset:8192
ds_read_b128 v[72:75], v6 offset:23552
ds_read_b128 v[76:79], v6 offset:18432
v_mfma_f32_16x16x32_bf16 v[84:87], v[36:39], v[64:67], 0
v_mfma_f32_16x16x32_bf16 v[88:91], v[64:67], v[64:67], 0
buffer_load_dwordx2 v[20:21], v11, s[4:7], s40 offen sc1
s_waitcnt lgkmcnt(2)
v_mfma_f32_16x16x32_bf16 v[80:83], v[40:43], v[68:71], v[80:83]
s_waitcnt lgkmcnt(1)
v_mfma_f32_16x16x32_bf16 v[80:83], v[48:51], v[72:75], v[80:83]
buffer_store_dwordx4 v[64:67], v10, s[4:7], s45 offen offset:64 sc1
s_waitcnt lgkmcnt(0)
v_mfma_f32_16x16x32_bf16 v[80:83], v[56:59], v[76:79], v[80:83]
v_mfma_f32_16x16x32_bf16 v[84:87], v[44:47], v[68:71], v[84:87]
v_mfma_f32_16x16x32_bf16 v[84:87], v[52:55], v[72:75], v[84:87]
v_mfma_f32_16x16x32_bf16 v[84:87], v[60:63], v[76:79], v[84:87]
buffer_store_dwordx2 v[18:19], v11, s[4:7], s51 offen offset:2560 sc1
v_mfma_f32_16x16x32_bf16 v[88:91], v[68:71], v[68:71], v[88:91]
v_mfma_f32_16x16x32_bf16 v[88:91], v[72:75], v[72:75], v[88:91]
v_mfma_f32_16x16x32_bf16 v[88:91], v[76:79], v[76:79], v[88:91]
v_mfma_f32_32x32x4_2b_bf16 v[32:63], v[14:15], v[14:15], 0
s_nop 0
v_max3_f32 v4, v80, v81, v82
s_nop 1
v_max3_f32 v4, v4, v83, v84
v_max3_f32 v4, v4, v85, v86
v_max_f32 v4, v4, v87
v_max3_f32 v90, v4, v88, v89
v_max3_f32 v4, v4, v88, v89
s_nop 1
v_permlane16_swap_b32 v4, v90
v_max_f32 v4, v4, v90
v_max_f32 v90, v4, v90
s_nop 1
v_permlane32_swap_b32 v4, v90
v_max_f32 v4, v4, v90
v_mul_f32 v4, s34, v4
v_pk_fma_f32 v[80:81], v[80:81], s[34:35], v[4:5] op_sel_hi:[1,0,0] neg_lo:[0,0,1] neg_hi:[0,0,1]
v_pk_fma_f32 v[82:83], v[82:83], s[34:35], v[4:5] op_sel_hi:[1,0,0] neg_lo:[0,0,1] neg_hi:[0,0,1]
v_pk_fma_f32 v[84:85], v[84:85], s[34:35], v[4:5] op_sel_hi:[1,0,0] neg_lo:[0,0,1] neg_hi:[0,0,1]
v_pk_fma_f32 v[86:87], v[86:87], s[34:35], v[4:5] op_sel_hi:[1,0,0] neg_lo:[0,0,1] neg_hi:[0,0,1]
v_pk_fma_f32 v[88:89], v[88:89], s[34:35], v[4:5] op_sel_hi:[1,0,0] neg_lo:[0,0,1] neg_hi:[0,0,1]
v_exp_f32 v80, v80
v_exp_f32 v81, v81
v_exp_f32 v82, v82
v_cvt_pk_bf16_f32 v68, v80, v81
v_exp_f32 v83, v83
v_exp_f32 v84, v84
v_cvt_pk_bf16_f32 v69, v82, v83
v_exp_f32 v85, v85
v_exp_f32 v86, v86
v_cvt_pk_bf16_f32 v70, v84, v85
v_exp_f32 v87, v87
v_exp_f32 v88, v88
v_cvt_pk_bf16_f32 v71, v86, v87
v_exp_f32 v89, v89
s_waitcnt vmcnt(3)
v_mfma_f32_16x16x32_bf16 v[76:79], v[28:31], v[68:71], 0
v_and_b32 v3, 1, v116
v_cvt_pk_bf16_f32 v72, v88, v89
v_mfma_f32_16x16x32_bf16 v[100:103], v[120:123], v[68:71], 0
v_cmp_ne_u32 vcc, s41, v3
v_cvt_pk_bf16_f32 v73, v88, v89
v_mfma_f32_16x16x32_bf16 v[104:107], v[124:127], v[68:71], 0
v_mov_b32 v113, v116
v_mov_b32 v115, v117
v_mfma_f32_16x16x16_bf16 v[76:79], v[92:93], v[72:73], v[76:79]
s_cbranch_vccnz L_rs_w1_pv0
L_rs_w1_pv2:
v_mfma_f32_16x16x16_bf16 v[100:103], v[112:113], v[72:73], v[100:103]
v_mfma_f32_16x16x16_bf16 v[104:107], v[114:115], v[72:73], v[104:107]
buffer_load_dwordx4 v[120:123], v1, s[4:7], s44 offen
buffer_load_dwordx4 v[124:127], v1, s[4:7], s44 offen offset:1024
s_nop 2
v_rcp_f32 v76, v76
s_mov_b64 exec, s[28:29]
v_pk_mul_f32 v[100:101], v[100:101], v[76:77] op_sel_hi:[1,0]
v_pk_mul_f32 v[102:103], v[102:103], v[76:77] op_sel_hi:[1,0]
v_pk_mul_f32 v[104:105], v[104:105], v[76:77] op_sel_hi:[1,0]
v_pk_mul_f32 v[106:107], v[106:107], v[76:77] op_sel_hi:[1,0]
v_cvt_pk_bf16_f32 v84, v100, v101
v_cvt_pk_bf16_f32 v85, v102, v103
v_cvt_pk_bf16_f32 v86, v104, v105
v_cvt_pk_bf16_f32 v87, v106, v107
ds_write_b128 v6, v[84:87] offset:28672
s_mov_b64 exec, -1
s_waitcnt lgkmcnt(0)
s_barrier
ds_read_b128 v[68:71], v6 offset:28672
ds_read_b128 v[72:75], v6 offset:29696
s_waitcnt lgkmcnt(1)
v_smfmac_f32_16x16x64_bf16 v[32:35], v[68:71], v[128:135], v2
s_add_u32 s21, s21, 1
s_xor_b32 s38, s38, 1048576
s_xor_b32 s37, s37, 1048576
s_waitcnt lgkmcnt(0)
v_smfmac_f32_16x16x64_bf16 v[32:35], v[72:75], v[136:143], v2
s_xor_b32 s40, s40, 1048576
s_xor_b32 s39, s39, 1048576
s_lshr_b32 s41, s21, 1
v_smfmac_f32_16x16x64_bf16 v[36:39], v[68:71], v[144:151], v2
s_and_b32 s41, s41, 1
s_xor_b32 s41, s41, 1
s_xor_b32 s35, s35, 16384
v_smfmac_f32_16x16x64_bf16 v[36:39], v[72:75], v[152:159], v2
v_add_f32 v32, v32, v34
s_xor_b32 s36, s36, 16384
s_add_u32 s43, s43, 262144
s_add_u32 s44, s44, 262144
v_smfmac_f32_16x16x64_bf16 v[40:43], v[68:71], v[160:167], v2
v_add_f32 v33, v33, v35
v_smfmac_f32_16x16x64_bf16 v[40:43], v[72:75], v[168:175], v2
v_cvt_pk_bf16_f32 v32, v32, v33
v_smfmac_f32_16x16x64_bf16 v[44:47], v[68:71], v[176:183], v2
v_and_or_b32 v32, v32, -2, s42
v_smfmac_f32_16x16x64_bf16 v[44:47], v[72:75], v[184:191], v2
v_add_f32 v36, v36, v38
v_smfmac_f32_16x16x64_bf16 v[48:51], v[68:71], v[192:199], v2
v_add_f32 v37, v37, v39
v_smfmac_f32_16x16x64_bf16 v[48:51], v[72:75], v[200:207], v2
v_cvt_pk_bf16_f32 v33, v36, v37
v_smfmac_f32_16x16x64_bf16 v[52:55], v[68:71], v[208:215], v2
v_add_f32 v40, v40, v42
v_smfmac_f32_16x16x64_bf16 v[52:55], v[72:75], v[216:223], v2
v_add_f32 v41, v41, v43
v_smfmac_f32_16x16x64_bf16 v[56:59], v[68:71], v[224:231], v2
v_cvt_pk_bf16_f32 v34, v40, v41
v_smfmac_f32_16x16x64_bf16 v[56:59], v[72:75], v[232:239], v2
v_add_f32 v44, v44, v46
v_smfmac_f32_16x16x64_bf16 v[60:63], v[68:71], v[240:247], v2
v_add_f32 v45, v45, v47
v_smfmac_f32_16x16x64_bf16 v[60:63], v[72:75], v[248:255], v2
v_cvt_pk_bf16_f32 v35, v44, v45
buffer_store_dwordx4 v[32:35], v8, s[4:7], s46 offen sc1
v_pk_add_f32 v[48:49], v[48:49], v[50:51]
v_cvt_pk_bf16_f32 v48, v48, v49
v_and_or_b32 v48, v48, -2, s42
v_pk_add_f32 v[52:53], v[52:53], v[54:55]
v_cvt_pk_bf16_f32 v49, v52, v53
v_pk_add_f32 v[56:57], v[56:57], v[58:59]
v_cvt_pk_bf16_f32 v50, v56, v57
v_pk_add_f32 v[60:61], v[60:61], v[62:63]
v_cvt_pk_bf16_f32 v51, v60, v61
buffer_store_dwordx4 v[48:51], v8, s[4:7], s61 offen sc1
s_add_u32 s45, s45, 262144
s_add_u32 s51, s51, 262144
v_mfma_f32_32x32x8_bf16 v[96:111], v[14:15], v[14:15], 0
v_mfma_f32_16x16x16_bf16 v[112:115], v[14:15], v[14:15], 0
v_mfma_f32_16x16x16_bf16 v[116:119], v[14:15], v[14:15], 0
ds_read_b128 v[64:67], v1 offset:4096
ds_read_b128 v[68:71], v1 offset:5120
ds_read_b128 v[72:75], v1 offset:6144
ds_read_b128 v[76:79], v1 offset:7168
ds_read_b128 v[80:83], v1 offset:20480
ds_read_b128 v[84:87], v1 offset:21504
ds_read_b128 v[88:91], v1 offset:22528
ds_read_b128 v[92:95], v1 offset:23552
v_mov_b32 v58, -1
v_mov_b32 v59, -1
s_waitcnt vmcnt(0)
L_rs_w1_cgo:
L_rs_w1_pc:
buffer_load_dword v36, v13, s[4:7], s25 offen sc1
buffer_load_dword v37, v13, s[4:7], s25 offen offset:256 sc1
buffer_load_dword v38, v13, s[4:7], s25 offen offset:512 sc1
buffer_load_dword v39, v13, s[4:7], s25 offen offset:768 sc1
buffer_load_dword v40, v13, s[4:7], s25 offen offset:1024 sc1
buffer_load_dword v41, v13, s[4:7], s25 offen offset:1280 sc1
buffer_load_dword v42, v13, s[4:7], s25 offen offset:1536 sc1
buffer_load_dword v43, v13, s[4:7], s25 offen offset:1792 sc1
s_waitcnt vmcnt(4)
v_mfma_f32_16x16x32_bf16 v[52:55], v[36:39], v[24:27], 0
v_bitop3_b32 v3, s42, v36, v37 bitop3:0x7e
v_bitop3_b32 v4, s42, v38, v39 bitop3:0x7e
s_waitcnt vmcnt(2)
v_or_b32 v3, v3, v4
v_bitop3_b32 v4, s42, v40, v41 bitop3:0x7e
s_waitcnt vmcnt(0)
v_mfma_f32_16x16x32_bf16 v[52:55], v[40:43], v[24:27], v[52:55]
v_bitop3_b32 v56, s42, v42, v43 bitop3:0x7e
v_or3_b32 v3, v3, v4, v56
v_and_b32 v3, v0, v3
v_cmp_ne_u32 vcc, 0, v3
s_nop 3
v_cvt_pk_bf16_f32 v56, v52, v53
v_cvt_pk_bf16_f32 v57, v54, v55
v_min_u32 v56, -2, v56
s_cbranch_vccnz L_rs_w1_pc
s_mov_b64 exec, s[26:27]
buffer_store_dwordx2 v[56:57], v9, s[4:7], s35 offen offset:256 sc1
buffer_store_dwordx2 v[58:59], v9, s[4:7], s36 offen offset:256 sc1
s_mov_b64 exec, -1
s_xor_b32 s42, s42, 1
s_branch L_rs_w1_loop
L_rs_w1_last:
buffer_store_dwordx4 v[64:67], v10, s[4:7], s45 offen offset:64 sc1
buffer_store_dwordx2 v[18:19], v11, s[4:7], s51 offen offset:2560 sc1
s_branch L_rs_end
L_rs_w1_pafail:
s_nop 7
v_mov_b32 v96, 0
v_mov_b32 v97, 0
v_mov_b32 v98, 0
v_mov_b32 v99, 0
v_mov_b32 v100, 0
v_mov_b32 v101, 0
v_mov_b32 v102, 0
v_mov_b32 v103, 0
v_mov_b32 v104, 0
v_mov_b32 v105, 0
v_mov_b32 v106, 0
v_mov_b32 v107, 0
s_branch L_rs_w1_pa
L_rs_w1_xslow:
buffer_load_dwordx2 v[108:109], v11, s[4:7], s38 offen sc1
buffer_load_dwordx2 v[110:111], v11, s[4:7], s38 offen offset:512 sc1
s_waitcnt vmcnt(2)
v_bitop3_b32 v3, s41, v20, v22 bitop3:0x7e
v_mfma_f32_16x16x16_bf16 v[80:83], v[20:21], v[16:17], v[100:103]
v_and_b32 v3, 1, v3
v_mfma_f32_16x16x16_bf16 v[84:87], v[22:23], v[16:17], v[104:107]
v_cmp_ne_u32 vcc, 0, v3
s_cbranch_vccz L_rs_w1_xgot
buffer_load_dwordx2 v[20:21], v11, s[4:7], s38 offen sc1
buffer_load_dwordx2 v[22:23], v11, s[4:7], s38 offen offset:512 sc1
s_waitcnt vmcnt(2)
v_bitop3_b32 v3, s41, v108, v110 bitop3:0x7e
v_mfma_f32_16x16x16_bf16 v[80:83], v[108:109], v[16:17], v[100:103]
v_and_b32 v3, 1, v3
v_mfma_f32_16x16x16_bf16 v[84:87], v[110:111], v[16:17], v[104:107]
v_cmp_ne_u32 vcc, 0, v3
s_cbranch_vccz L_rs_w1_xgot
s_branch L_rs_w1_xslow
L_rs_w1_xgot:
s_nop 3
v_cvt_pk_bf16_f32 v64, v80, v81
v_cvt_pk_bf16_f32 v65, v82, v83
v_cvt_pk_bf16_f32 v66, v84, v85
v_cvt_pk_bf16_f32 v67, v86, v87
ds_write_b128 v6, v[64:67] offset:13312
s_branch L_rs_w1_xok
L_rs_w1_pv0:
s_waitcnt vmcnt(2)
s_branch L_rs_w1_pv1
L_rs_w1_pv:
buffer_load_dwordx2 v[20:21], v11, s[4:7], s40 offen sc1
s_waitcnt vmcnt(0)
L_rs_w1_pv1:
v_and_b32 v3, 1, v20
v_cmp_ne_u32 vcc, s41, v3
v_mov_b32 v113, v20
v_mov_b32 v115, v21
s_cbranch_vccnz L_rs_w1_pv
s_branch L_rs_w1_pv2
L_rs_w2_entry:
v_mfma_f32_32x32x8_bf16 v[96:111], v[14:15], v[14:15], 0
v_mfma_f32_16x16x16_bf16 v[112:115], v[14:15], v[14:15], 0
v_mfma_f32_16x16x16_bf16 v[116:119], v[14:15], v[14:15], 0
ds_read_b128 v[64:67], v1 offset:8192
ds_read_b128 v[68:71], v1 offset:9216
ds_read_b128 v[72:75], v1 offset:10240
ds_read_b128 v[76:79], v1 offset:11264
ds_read_b128 v[80:83], v1 offset:24576
ds_read_b128 v[84:87], v1 offset:25600
ds_read_b128 v[88:91], v1 offset:26624
ds_read_b128 v[92:95], v1 offset:27648
buffer_load_dwordx4 v[120:123], v1, s[4:7], s44 offen
buffer_load_dwordx4 v[124:127], v1, s[4:7], s44 offen offset:1024
s_add_u32 s44, s44, 262144
L_rs_w2_loop:
s_add_u32 s22, s35, 4096
s_waitcnt vmcnt(0)
buffer_load_dwordx4 v[48:51], v1, s[4:7], s22 offen sc1
buffer_load_dwordx4 v[52:55], v1, s[4:7], s22 offen offset:1024 sc1
L_rs_w2_pa:
s_waitcnt vmcnt(1)
ds_write_b128 v6, v[48:51] offset:4096
s_waitcnt vmcnt(0)
ds_write_b128 v6, v[52:55] offset:5120
v_max3_u32 v3, v48, v50, v52
v_max_u32 v3, v3, v54
v_cmp_eq_u32 vcc, -1, v3
v_smfmac_f32_16x16x64_bf16 v[96:99], v[48:51], a[64:71], v2
buffer_load_dwordx4 v[48:51], v1, s[4:7], s22 offen sc1
v_smfmac_f32_16x16x64_bf16 v[100:103], v[48:51], a[72:79], v2
buffer_load_dwordx4 v[52:55], v1, s[4:7], s22 offen offset:1024 sc1
v_smfmac_f32_16x16x64_bf16 v[104:107], v[48:51], a[192:199], v2
s_cbranch_vccnz L_rs_w2_pafail
s_waitcnt lgkmcnt(0)
s_barrier
ds_read_b128 v[56:59], v6 offset:6144
ds_read_b128 v[60:63], v6 offset:7168
v_smfmac_f32_16x16x64_bf16 v[108:111], v[48:51], a[200:207], v2
ds_read_b128 v[32:35], v6
v_smfmac_f32_16x16x64_bf16 v[96:99], v[52:55], a[80:87], v2
ds_read_b128 v[36:39], v6 offset:1024
v_smfmac_f32_16x16x64_bf16 v[100:103], v[52:55], a[88:95], v2
ds_read_b128 v[40:43], v6 offset:2048
v_smfmac_f32_16x16x64_bf16 v[104:107], v[52:55], a[208:215], v2
ds_read_b128 v[44:47], v6 offset:3072
v_smfmac_f32_16x16x64_bf16 v[108:111], v[52:55], a[216:223], v2
s_waitcnt lgkmcnt(5)
v_smfmac_f32_16x16x64_bf16 v[96:99], v[56:59], a[96:103], v2
v_smfmac_f32_16x16x64_bf16 v[104:107], v[56:59], a[224:231], v2
buffer_load_dwordx4 v1, s[4:7], s43 offen lds
s_waitcnt lgkmcnt(4)
v_smfmac_f32_16x16x64_bf16 v[96:99], v[60:63], a[112:119], v2
v_smfmac_f32_16x16x64_bf16 v[104:107], v[60:63], a[240:247], v2
s_waitcnt lgkmcnt(3)
v_smfmac_f32_16x16x64_bf16 v[96:99], v[32:35], a[0:7], v2
v_smfmac_f32_16x16x64_bf16 v[104:107], v[32:35], a[128:135], v2
buffer_load_dwordx4 v1, s[4:7], s43 offen offset:1024 lds
s_waitcnt lgkmcnt(2)
v_smfmac_f32_16x16x64_bf16 v[96:99], v[36:39], a[16:23], v2
v_smfmac_f32_16x16x64_bf16 v[104:107], v[36:39], a[144:151], v2
s_waitcnt lgkmcnt(1)
v_smfmac_f32_16x16x64_bf16 v[96:99], v[40:43], a[32:39], v2
v_smfmac_f32_16x16x64_bf16 v[104:107], v[40:43], a[160:167], v2
s_waitcnt lgkmcnt(0)
v_smfmac_f32_16x16x64_bf16 v[96:99], v[44:47], a[48:55], v2
v_smfmac_f32_16x16x64_bf16 v[104:107], v[44:47], a[176:183], v2
v_smfmac_f32_16x16x64_bf16 v[100:103], v[56:59], a[104:111], v2
s_nop 2
v_smfmac_f32_16x16x64_bf16 v[100:103], v[60:63], a[120:127], v2
s_nop 1
v_add_f32 v96, v96, v98
v_smfmac_f32_16x16x64_bf16 v[100:103], v[32:35], a[8:15], v2
v_add_f32 v97, v97, v99
v_add_f32 v104, v104, v106
v_smfmac_f32_16x16x64_bf16 v[100:103], v[36:39], a[24:31], v2
v_add_f32 v105, v105, v107
v_cvt_pk_bf16_f32 v96, v96, v97
v_smfmac_f32_16x16x64_bf16 v[100:103], v[40:43], a[40:47], v2
v_cvt_pk_bf16_f32 v97, v104, v105
v_and_or_b32 v96, v96, -2, s41
v_smfmac_f32_16x16x64_bf16 v[100:103], v[44:47], a[56:63], v2
buffer_store_dwordx2 v[96:97], v11, s[4:7], s37 offen sc1
v_smfmac_f32_16x16x64_bf16 v[108:111], v[56:59], a[232:239], v2
v_smfmac_f32_16x16x64_bf16 v[108:111], v[60:63], a[248:255], v2
v_smfmac_f32_16x16x64_bf16 v[108:111], v[32:35], a[136:143], v2
v_smfmac_f32_16x16x64_bf16 v[108:111], v[36:39], a[152:159], v2
v_smfmac_f32_16x16x64_bf16 v[108:111], v[40:43], a[168:175], v2
s_nop 2
v_add_f32 v100, v100, v102
v_smfmac_f32_16x16x64_bf16 v[108:111], v[44:47], a[184:191], v2
v_add_f32 v101, v101, v103
v_cvt_pk_bf16_f32 v98, v100, v101
v_and_or_b32 v98, v98, -2, s41
s_nop 4
v_pk_add_f32 v[108:109], v[108:109], v[110:111]
v_cvt_pk_bf16_f32 v99, v108, v109
buffer_store_dwordx2 v[98:99], v11, s[4:7], s37 offen offset:512 sc1
v_smfmac_f32_16x16x64_bf16 v[112:115], v[32:35], v[64:71], v2
ds_read_b128 v[64:67], v1 offset:40960
ds_read_b128 v[68:71], v1 offset:41984
v_smfmac_f32_16x16x64_bf16 v[116:119], v[32:35], v[72:79], v2
ds_read_b128 v[72:75], v1 offset:43008
ds_read_b128 v[76:79], v1 offset:44032
v_smfmac_f32_16x16x64_bf16 v[112:115], v[36:39], v[80:87], v2
ds_read_b128 v[80:83], v1 offset:57344
ds_read_b128 v[84:87], v1 offset:58368
v_smfmac_f32_16x16x64_bf16 v[116:119], v[36:39], v[88:95], v2
ds_read_b128 v[88:91], v1 offset:59392
ds_read_b128 v[92:95], v1 offset:60416
s_waitcnt lgkmcnt(6)
v_smfmac_f32_16x16x64_bf16 v[112:115], v[40:43], v[64:71], v2
ds_read_b128 v[64:67], v5 offset:8192
ds_read_b128 v[68:71], v5 offset:9216
s_waitcnt lgkmcnt(6)
v_smfmac_f32_16x16x64_bf16 v[116:119], v[40:43], v[72:79], v2
ds_read_b128 v[72:75], v5 offset:10240
ds_read_b128 v[76:79], v5 offset:11264
s_waitcnt lgkmcnt(6)
v_smfmac_f32_16x16x64_bf16 v[112:115], v[44:47], v[80:87], v2
ds_read_b128 v[80:83], v5 offset:24576
ds_read_b128 v[84:87], v5 offset:25600
s_waitcnt lgkmcnt(6)
v_smfmac_f32_16x16x64_bf16 v[116:119], v[44:47], v[88:95], v2
ds_read_b128 v[88:91], v5 offset:26624
ds_read_b128 v[92:95], v5 offset:27648
s_waitcnt lgkmcnt(6)
v_smfmac_f32_16x16x64_bf16 v[112:115], v[48:51], v[64:71], v2
ds_read_b128 v[64:67], v5 offset:40960
ds_read_b128 v[68:71], v5 offset:41984
s_waitcnt lgkmcnt(6)
v_smfmac_f32_16x16x64_bf16 v[116:119], v[48:51], v[72:79], v2
ds_read_b128 v[72:75], v5 offset:43008
ds_read_b128 v[76:79], v5 offset:44032
s_waitcnt lgkmcnt(6)
v_smfmac_f32_16x16x64_bf16 v[112:115], v[52:55], v[80:87], v2
ds_read_b128 v[80:83], v5 offset:57344
ds_read_b128 v[84:87], v5 offset:58368
s_waitcnt lgkmcnt(6)
v_smfmac_f32_16x16x64_bf16 v[116:119], v[52:55], v[88:95], v2
ds_read_b128 v[88:91], v5 offset:59392
ds_read_b128 v[92:95], v5 offset:60416
s_waitcnt lgkmcnt(6)
v_smfmac_f32_16x16x64_bf16 v[112:115], v[56:59], v[64:71], v2
s_waitcnt lgkmcnt(4)
v_smfmac_f32_16x16x64_bf16 v[116:119], v[56:59], v[72:79], v2
s_waitcnt lgkmcnt(2)
v_smfmac_f32_16x16x64_bf16 v[112:115], v[60:63], v[80:87], v2
s_waitcnt lgkmcnt(0)
v_smfmac_f32_16x16x64_bf16 v[116:119], v[60:63], v[88:95], v2
buffer_load_dwordx2 v[108:109], v11, s[4:7], s38 offen sc1
v_mfma_f32_16x16x16_bf16 v[100:103], v[96:97], v[16:17], 0
v_mfma_f32_16x16x16_bf16 v[104:107], v[98:99], v[16:17], 0
s_nop 4
v_add_f32 v112, v112, v114
v_add_f32 v113, v113, v115
v_add_f32 v114, v116, v118
v_add_f32 v115, v117, v119
v_cvt_pk_bf16_f32 v18, v112, v113
v_cvt_pk_bf16_f32 v19, v114, v115
v_and_or_b32 v18, v18, -2, s41
buffer_load_dwordx2 v[110:111], v11, s[4:7], s38 offen offset:512 sc1
s_barrier
buffer_store_dwordx2 v[18:19], v11, s[4:7], s39 offen sc1
v_mov_b32 v112, v18
v_mov_b32 v114, v19
v_mov_b32 v92, v28
v_mov_b32 v93, 0
s_waitcnt vmcnt(5)
s_barrier
ds_read_b128 v[32:35], v6 offset:19456
ds_read_b128 v[36:39], v6 offset:20480
ds_read_b128 v[40:43], v6 offset:24576
ds_read_b128 v[44:47], v6 offset:25600
ds_read_b128 v[48:51], v6 offset:9216
ds_read_b128 v[52:55], v6 offset:10240
ds_read_b128 v[56:59], v6 offset:14336
ds_read_b128 v[60:63], v6 offset:15360
buffer_load_dwordx2 v[20:21], v11, s[4:7], s38 offen sc1
buffer_load_dwordx2 v[22:23], v11, s[4:7], s38 offen offset:512 sc1
s_waitcnt vmcnt(4)
v_mfma_f32_16x16x16_bf16 v[80:83], v[108:109], v[16:17], v[100:103]
v_and_b32 v3, 1, v108
v_cmp_ne_u32 vcc, s41, v3
s_nop 5
v_cvt_pk_bf16_f32 v64, v80, v81
v_cvt_pk_bf16_f32 v65, v82, v83
s_cbranch_vccnz L_rs_w2_xslow
s_waitcnt vmcnt(3)
v_mfma_f32_16x16x16_bf16 v[84:87], v[110:111], v[16:17], v[104:107]
v_and_b32 v3, 1, v110
v_cmp_ne_u32 vcc, s41, v3
s_nop 5
v_cvt_pk_bf16_f32 v66, v84, v85
v_cvt_pk_bf16_f32 v67, v86, v87
ds_write_b128 v6, v[64:67] offset:18432
s_cbranch_vccnz L_rs_w2_xslow
L_rs_w2_xok:
s_cmp_eq_u32 s21, 63
s_cbranch_scc1 L_rs_w2_last
buffer_load_dwordx2 v[116:117], v11, s[4:7], s40 offen sc1
s_waitcnt lgkmcnt(1)
v_mfma_f32_16x16x32_bf16 v[80:83], v[32:35], v[64:67], 0
s_waitcnt lgkmcnt(0)
s_barrier
ds_read_b128 v[68:71], v6 offset:23552
ds_read_b128 v[72:75], v6 offset:8192
ds_read_b128 v[76:79], v6 offset:13312
v_mfma_f32_16x16x32_bf16 v[84:87], v[36:39], v[64:67], 0
v_mfma_f32_16x16x32_bf16 v[88:91], v[64:67], v[64:67], 0
buffer_load_dwordx2 v[20:21], v11, s[4:7], s40 offen sc1
s_waitcnt lgkmcnt(2)
v_mfma_f32_16x16x32_bf16 v[80:83], v[40:43], v[68:71], v[80:83]
s_waitcnt lgkmcnt(1)
v_mfma_f32_16x16x32_bf16 v[80:83], v[48:51], v[72:75], v[80:83]
s_waitcnt lgkmcnt(0)
v_mfma_f32_16x16x32_bf16 v[80:83], v[56:59], v[76:79], v[80:83]
buffer_store_dwordx4 v[64:67], v10, s[4:7], s45 offen offset:128 sc1
v_mfma_f32_16x16x32_bf16 v[84:87], v[44:47], v[68:71], v[84:87]
v_mfma_f32_16x16x32_bf16 v[84:87], v[52:55], v[72:75], v[84:87]
v_mfma_f32_16x16x32_bf16 v[84:87], v[60:63], v[76:79], v[84:87]
v_mfma_f32_16x16x32_bf16 v[88:91], v[68:71], v[68:71], v[88:91]
buffer_store_dwordx2 v[18:19], v11, s[4:7], s51 offen offset:3072 sc1
v_mfma_f32_16x16x32_bf16 v[88:91], v[72:75], v[72:75], v[88:91]
v_mfma_f32_16x16x32_bf16 v[88:91], v[76:79], v[76:79], v[88:91]
v_mfma_f32_32x32x4_2b_bf16 v[32:63], v[14:15], v[14:15], 0
s_nop 0
v_max3_f32 v4, v80, v81, v82
s_nop 1
v_max3_f32 v4, v4, v83, v84
v_max3_f32 v4, v4, v85, v86
v_max_f32 v4, v4, v87
v_max3_f32 v90, v4, v88, v89
v_max3_f32 v4, v4, v88, v89
s_nop 1
v_permlane16_swap_b32 v4, v90
v_max_f32 v4, v4, v90
v_max_f32 v90, v4, v90
s_nop 1
v_permlane32_swap_b32 v4, v90
v_max_f32 v4, v4, v90
v_mul_f32 v4, s34, v4
v_pk_fma_f32 v[80:81], v[80:81], s[34:35], v[4:5] op_sel_hi:[1,0,0] neg_lo:[0,0,1] neg_hi:[0,0,1]
v_pk_fma_f32 v[82:83], v[82:83], s[34:35], v[4:5] op_sel_hi:[1,0,0] neg_lo:[0,0,1] neg_hi:[0,0,1]
v_pk_fma_f32 v[84:85], v[84:85], s[34:35], v[4:5] op_sel_hi:[1,0,0] neg_lo:[0,0,1] neg_hi:[0,0,1]
v_pk_fma_f32 v[86:87], v[86:87], s[34:35], v[4:5] op_sel_hi:[1,0,0] neg_lo:[0,0,1] neg_hi:[0,0,1]
v_pk_fma_f32 v[88:89], v[88:89], s[34:35], v[4:5] op_sel_hi:[1,0,0] neg_lo:[0,0,1] neg_hi:[0,0,1]
v_exp_f32 v80, v80
v_exp_f32 v81, v81
v_exp_f32 v82, v82
v_cvt_pk_bf16_f32 v68, v80, v81
v_exp_f32 v83, v83
v_exp_f32 v84, v84
v_cvt_pk_bf16_f32 v69, v82, v83
v_exp_f32 v85, v85
v_exp_f32 v86, v86
v_cvt_pk_bf16_f32 v70, v84, v85
v_exp_f32 v87, v87
v_exp_f32 v88, v88
v_cvt_pk_bf16_f32 v71, v86, v87
v_exp_f32 v89, v89
s_waitcnt vmcnt(3)
v_mfma_f32_16x16x32_bf16 v[76:79], v[28:31], v[68:71], 0
v_and_b32 v3, 1, v116
v_cvt_pk_bf16_f32 v72, v88, v89
v_mfma_f32_16x16x32_bf16 v[100:103], v[120:123], v[68:71], 0
v_cmp_ne_u32 vcc, s41, v3
v_cvt_pk_bf16_f32 v73, v88, v89
v_mfma_f32_16x16x32_bf16 v[104:107], v[124:127], v[68:71], 0
v_mov_b32 v113, v116
v_mov_b32 v115, v117
v_mfma_f32_16x16x16_bf16 v[76:79], v[92:93], v[72:73], v[76:79]
s_cbranch_vccnz L_rs_w2_pv0
L_rs_w2_pv2:
v_mfma_f32_16x16x16_bf16 v[100:103], v[112:113], v[72:73], v[100:103]
v_mfma_f32_16x16x16_bf16 v[104:107], v[114:115], v[72:73], v[104:107]
buffer_load_dwordx4 v[120:123], v1, s[4:7], s44 offen
buffer_load_dwordx4 v[124:127], v1, s[4:7], s44 offen offset:1024
s_nop 2
v_rcp_f32 v76, v76
s_mov_b64 exec, s[28:29]
v_pk_mul_f32 v[100:101], v[100:101], v[76:77] op_sel_hi:[1,0]
v_pk_mul_f32 v[102:103], v[102:103], v[76:77] op_sel_hi:[1,0]
v_pk_mul_f32 v[104:105], v[104:105], v[76:77] op_sel_hi:[1,0]
v_pk_mul_f32 v[106:107], v[106:107], v[76:77] op_sel_hi:[1,0]
v_cvt_pk_bf16_f32 v84, v100, v101
v_cvt_pk_bf16_f32 v85, v102, v103
v_cvt_pk_bf16_f32 v86, v104, v105
v_cvt_pk_bf16_f32 v87, v106, v107
ds_write_b128 v6, v[84:87] offset:29664
s_mov_b64 exec, -1
s_waitcnt lgkmcnt(0)
s_barrier
ds_read_b128 v[68:71], v6 offset:28672
ds_read_b128 v[72:75], v6 offset:29696
s_waitcnt lgkmcnt(1)
v_smfmac_f32_16x16x64_bf16 v[32:35], v[68:71], v[128:135], v2
s_add_u32 s21, s21, 1
s_xor_b32 s38, s38, 1048576
s_xor_b32 s37, s37, 1048576
s_waitcnt lgkmcnt(0)
v_smfmac_f32_16x16x64_bf16 v[32:35], v[72:75], v[136:143], v2
s_xor_b32 s40, s40, 1048576
s_xor_b32 s39, s39, 1048576
s_lshr_b32 s41, s21, 1
v_smfmac_f32_16x16x64_bf16 v[36:39], v[68:71], v[144:151], v2
s_and_b32 s41, s41, 1
s_xor_b32 s41, s41, 1
s_xor_b32 s35, s35, 16384
v_smfmac_f32_16x16x64_bf16 v[36:39], v[72:75], v[152:159], v2
v_add_f32 v32, v32, v34
s_xor_b32 s36, s36, 16384
s_add_u32 s43, s43, 262144
s_add_u32 s44, s44, 262144
v_smfmac_f32_16x16x64_bf16 v[40:43], v[68:71], v[160:167], v2
v_add_f32 v33, v33, v35
v_smfmac_f32_16x16x64_bf16 v[40:43], v[72:75], v[168:175], v2
v_cvt_pk_bf16_f32 v32, v32, v33
v_smfmac_f32_16x16x64_bf16 v[44:47], v[68:71], v[176:183], v2
v_and_or_b32 v32, v32, -2, s42
v_smfmac_f32_16x16x64_bf16 v[44:47], v[72:75], v[184:191], v2
v_add_f32 v36, v36, v38
v_smfmac_f32_16x16x64_bf16 v[48:51], v[68:71], v[192:199], v2
v_add_f32 v37, v37, v39
v_smfmac_f32_16x16x64_bf16 v[48:51], v[72:75], v[200:207], v2
v_cvt_pk_bf16_f32 v33, v36, v37
v_smfmac_f32_16x16x64_bf16 v[52:55], v[68:71], v[208:215], v2
v_add_f32 v40, v40, v42
v_smfmac_f32_16x16x64_bf16 v[52:55], v[72:75], v[216:223], v2
v_add_f32 v41, v41, v43
v_smfmac_f32_16x16x64_bf16 v[56:59], v[68:71], v[224:231], v2
v_cvt_pk_bf16_f32 v34, v40, v41
v_smfmac_f32_16x16x64_bf16 v[56:59], v[72:75], v[232:239], v2
v_add_f32 v44, v44, v46
v_smfmac_f32_16x16x64_bf16 v[60:63], v[68:71], v[240:247], v2
v_add_f32 v45, v45, v47
v_smfmac_f32_16x16x64_bf16 v[60:63], v[72:75], v[248:255], v2
v_cvt_pk_bf16_f32 v35, v44, v45
buffer_store_dwordx4 v[32:35], v8, s[4:7], s46 offen sc1
v_pk_add_f32 v[48:49], v[48:49], v[50:51]
v_cvt_pk_bf16_f32 v48, v48, v49
v_and_or_b32 v48, v48, -2, s42
v_pk_add_f32 v[52:53], v[52:53], v[54:55]
v_cvt_pk_bf16_f32 v49, v52, v53
v_pk_add_f32 v[56:57], v[56:57], v[58:59]
v_cvt_pk_bf16_f32 v50, v56, v57
v_pk_add_f32 v[60:61], v[60:61], v[62:63]
v_cvt_pk_bf16_f32 v51, v60, v61
buffer_store_dwordx4 v[48:51], v8, s[4:7], s61 offen sc1
s_add_u32 s45, s45, 262144
s_add_u32 s51, s51, 262144
v_mfma_f32_32x32x8_bf16 v[96:111], v[14:15], v[14:15], 0
v_mfma_f32_16x16x16_bf16 v[112:115], v[14:15], v[14:15], 0
v_mfma_f32_16x16x16_bf16 v[116:119], v[14:15], v[14:15], 0
ds_read_b128 v[64:67], v1 offset:8192
ds_read_b128 v[68:71], v1 offset:9216
ds_read_b128 v[72:75], v1 offset:10240
ds_read_b128 v[76:79], v1 offset:11264
ds_read_b128 v[80:83], v1 offset:24576
ds_read_b128 v[84:87], v1 offset:25600
ds_read_b128 v[88:91], v1 offset:26624
ds_read_b128 v[92:95], v1 offset:27648
v_mov_b32 v58, -1
v_mov_b32 v59, -1
s_waitcnt vmcnt(0)
L_rs_w2_cgo:
L_rs_w2_pc:
buffer_load_dword v36, v13, s[4:7], s25 offen sc1
buffer_load_dword v37, v13, s[4:7], s25 offen offset:256 sc1
buffer_load_dword v38, v13, s[4:7], s25 offen offset:512 sc1
buffer_load_dword v39, v13, s[4:7], s25 offen offset:768 sc1
buffer_load_dword v40, v13, s[4:7], s25 offen offset:1024 sc1
buffer_load_dword v41, v13, s[4:7], s25 offen offset:1280 sc1
buffer_load_dword v42, v13, s[4:7], s25 offen offset:1536 sc1
buffer_load_dword v43, v13, s[4:7], s25 offen offset:1792 sc1
s_waitcnt vmcnt(4)
v_mfma_f32_16x16x32_bf16 v[52:55], v[36:39], v[24:27], 0
v_bitop3_b32 v3, s42, v36, v37 bitop3:0x7e
v_bitop3_b32 v4, s42, v38, v39 bitop3:0x7e
s_waitcnt vmcnt(2)
v_or_b32 v3, v3, v4
v_bitop3_b32 v4, s42, v40, v41 bitop3:0x7e
s_waitcnt vmcnt(0)
v_mfma_f32_16x16x32_bf16 v[52:55], v[40:43], v[24:27], v[52:55]
v_bitop3_b32 v56, s42, v42, v43 bitop3:0x7e
v_or3_b32 v3, v3, v4, v56
v_and_b32 v3, v0, v3
v_cmp_ne_u32 vcc, 0, v3
s_nop 3
v_cvt_pk_bf16_f32 v56, v52, v53
v_cvt_pk_bf16_f32 v57, v54, v55
v_min_u32 v56, -2, v56
s_cbranch_vccnz L_rs_w2_pc
s_mov_b64 exec, s[26:27]
buffer_store_dwordx2 v[56:57], v9, s[4:7], s35 offen offset:512 sc1
buffer_store_dwordx2 v[58:59], v9, s[4:7], s36 offen offset:512 sc1
s_mov_b64 exec, -1
s_xor_b32 s42, s42, 1
s_branch L_rs_w2_loop
L_rs_w2_last:
buffer_store_dwordx4 v[64:67], v10, s[4:7], s45 offen offset:128 sc1
buffer_store_dwordx2 v[18:19], v11, s[4:7], s51 offen offset:3072 sc1
s_branch L_rs_end
L_rs_w2_pafail:
s_nop 7
v_mov_b32 v96, 0
v_mov_b32 v97, 0
v_mov_b32 v98, 0
v_mov_b32 v99, 0
v_mov_b32 v100, 0
v_mov_b32 v101, 0
v_mov_b32 v102, 0
v_mov_b32 v103, 0
v_mov_b32 v104, 0
v_mov_b32 v105, 0
v_mov_b32 v106, 0
v_mov_b32 v107, 0
s_branch L_rs_w2_pa
L_rs_w2_xslow:
buffer_load_dwordx2 v[108:109], v11, s[4:7], s38 offen sc1
buffer_load_dwordx2 v[110:111], v11, s[4:7], s38 offen offset:512 sc1
s_waitcnt vmcnt(2)
v_bitop3_b32 v3, s41, v20, v22 bitop3:0x7e
v_mfma_f32_16x16x16_bf16 v[80:83], v[20:21], v[16:17], v[100:103]
v_and_b32 v3, 1, v3
v_mfma_f32_16x16x16_bf16 v[84:87], v[22:23], v[16:17], v[104:107]
v_cmp_ne_u32 vcc, 0, v3
s_cbranch_vccz L_rs_w2_xgot
buffer_load_dwordx2 v[20:21], v11, s[4:7], s38 offen sc1
buffer_load_dwordx2 v[22:23], v11, s[4:7], s38 offen offset:512 sc1
s_waitcnt vmcnt(2)
v_bitop3_b32 v3, s41, v108, v110 bitop3:0x7e
v_mfma_f32_16x16x16_bf16 v[80:83], v[108:109], v[16:17], v[100:103]
v_and_b32 v3, 1, v3
v_mfma_f32_16x16x16_bf16 v[84:87], v[110:111], v[16:17], v[104:107]
v_cmp_ne_u32 vcc, 0, v3
s_cbranch_vccz L_rs_w2_xgot
s_branch L_rs_w2_xslow
L_rs_w2_xgot:
s_nop 3
v_cvt_pk_bf16_f32 v64, v80, v81
v_cvt_pk_bf16_f32 v65, v82, v83
v_cvt_pk_bf16_f32 v66, v84, v85
v_cvt_pk_bf16_f32 v67, v86, v87
ds_write_b128 v6, v[64:67] offset:18432
s_branch L_rs_w2_xok
L_rs_w2_pv0:
s_waitcnt vmcnt(2)
s_branch L_rs_w2_pv1
L_rs_w2_pv:
buffer_load_dwordx2 v[20:21], v11, s[4:7], s40 offen sc1
s_waitcnt vmcnt(0)
L_rs_w2_pv1:
v_and_b32 v3, 1, v20
v_cmp_ne_u32 vcc, s41, v3
v_mov_b32 v113, v20
v_mov_b32 v115, v21
s_cbranch_vccnz L_rs_w2_pv
s_branch L_rs_w2_pv2
L_rs_w3_entry:
v_mfma_f32_32x32x8_bf16 v[96:111], v[14:15], v[14:15], 0
v_mfma_f32_16x16x16_bf16 v[112:115], v[14:15], v[14:15], 0
v_mfma_f32_16x16x16_bf16 v[116:119], v[14:15], v[14:15], 0
ds_read_b128 v[64:67], v1 offset:12288
ds_read_b128 v[68:71], v1 offset:13312
ds_read_b128 v[72:75], v1 offset:14336
ds_read_b128 v[76:79], v1 offset:15360
ds_read_b128 v[80:83], v1 offset:28672
ds_read_b128 v[84:87], v1 offset:29696
ds_read_b128 v[88:91], v1 offset:30720
ds_read_b128 v[92:95], v1 offset:31744
buffer_load_dwordx4 v[120:123], v1, s[4:7], s44 offen
buffer_load_dwordx4 v[124:127], v1, s[4:7], s44 offen offset:1024
s_add_u32 s44, s44, 262144
L_rs_w3_loop:
s_add_u32 s22, s35, 6144
s_waitcnt vmcnt(0)
buffer_load_dwordx4 v[56:59], v1, s[4:7], s22 offen sc1
buffer_load_dwordx4 v[60:63], v1, s[4:7], s22 offen offset:1024 sc1
L_rs_w3_pa:
s_waitcnt vmcnt(1)
ds_write_b128 v6, v[56:59] offset:6144
s_waitcnt vmcnt(0)
ds_write_b128 v6, v[60:63] offset:7168
v_max3_u32 v3, v56, v58, v60
v_max_u32 v3, v3, v62
v_cmp_eq_u32 vcc, -1, v3
v_smfmac_f32_16x16x64_bf16 v[96:99], v[56:59], a[96:103], v2
buffer_load_dwordx4 v[56:59], v1, s[4:7], s22 offen sc1
v_smfmac_f32_16x16x64_bf16 v[100:103], v[56:59], a[104:111], v2
buffer_load_dwordx4 v[60:63], v1, s[4:7], s22 offen offset:1024 sc1
v_smfmac_f32_16x16x64_bf16 v[104:107], v[56:59], a[224:231], v2
s_cbranch_vccnz L_rs_w3_pafail
s_waitcnt lgkmcnt(0)
s_barrier
ds_read_b128 v[32:35], v6
ds_read_b128 v[36:39], v6 offset:1024
v_smfmac_f32_16x16x64_bf16 v[108:111], v[56:59], a[232:239], v2
ds_read_b128 v[40:43], v6 offset:2048
v_smfmac_f32_16x16x64_bf16 v[96:99], v[60:63], a[112:119], v2
ds_read_b128 v[44:47], v6 offset:3072
v_smfmac_f32_16x16x64_bf16 v[100:103], v[60:63], a[120:127], v2
ds_read_b128 v[48:51], v6 offset:4096
v_smfmac_f32_16x16x64_bf16 v[104:107], v[60:63], a[240:247], v2
ds_read_b128 v[52:55], v6 offset:5120
v_smfmac_f32_16x16x64_bf16 v[108:111], v[60:63], a[248:255], v2
s_waitcnt lgkmcnt(5)
v_smfmac_f32_16x16x64_bf16 v[96:99], v[32:35], a[0:7], v2
v_smfmac_f32_16x16x64_bf16 v[104:107], v[32:35], a[128:135], v2
s_waitcnt lgkmcnt(4)
v_smfmac_f32_16x16x64_bf16 v[96:99], v[36:39], a[16:23], v2
buffer_load_dwordx4 v1, s[4:7], s43 offen lds
v_smfmac_f32_16x16x64_bf16 v[104:107], v[36:39], a[144:151], v2
s_waitcnt lgkmcnt(3)
v_smfmac_f32_16x16x64_bf16 v[96:99], v[40:43], a[32:39], v2
v_smfmac_f32_16x16x64_bf16 v[104:107], v[40:43], a[160:167], v2
s_waitcnt lgkmcnt(2)
v_smfmac_f32_16x16x64_bf16 v[96:99], v[44:47], a[48:55], v2
buffer_load_dwordx4 v1, s[4:7], s43 offen offset:1024 lds
v_smfmac_f32_16x16x64_bf16 v[104:107], v[44:47], a[176:183], v2
s_waitcnt lgkmcnt(1)
v_smfmac_f32_16x16x64_bf16 v[96:99], v[48:51], a[64:71], v2
v_smfmac_f32_16x16x64_bf16 v[104:107], v[48:51], a[192:199], v2
s_waitcnt lgkmcnt(0)
v_smfmac_f32_16x16x64_bf16 v[96:99], v[52:55], a[80:87], v2
buffer_load_dword v12, v7, s[4:7], 0 offen sc1
v_smfmac_f32_16x16x64_bf16 v[104:107], v[52:55], a[208:215], v2
v_smfmac_f32_16x16x64_bf16 v[100:103], v[32:35], a[8:15], v2
s_nop 2
v_smfmac_f32_16x16x64_bf16 v[100:103], v[36:39], a[24:31], v2
s_nop 1
v_add_f32 v96, v96, v98
v_smfmac_f32_16x16x64_bf16 v[100:103], v[40:43], a[40:47], v2
v_add_f32 v97, v97, v99
v_add_f32 v104, v104, v106
v_smfmac_f32_16x16x64_bf16 v[100:103], v[44:47], a[56:63], v2
v_add_f32 v105, v105, v107
v_cvt_pk_bf16_f32 v96, v96, v97
v_smfmac_f32_16x16x64_bf16 v[100:103], v[48:51], a[72:79], v2
v_cvt_pk_bf16_f32 v97, v104, v105
v_and_or_b32 v96, v96, -2, s41
v_smfmac_f32_16x16x64_bf16 v[100:103], v[52:55], a[88:95], v2
buffer_store_dwordx2 v[96:97], v11, s[4:7], s37 offen sc1
v_smfmac_f32_16x16x64_bf16 v[108:111], v[32:35], a[136:143], v2
v_smfmac_f32_16x16x64_bf16 v[108:111], v[36:39], a[152:159], v2
v_smfmac_f32_16x16x64_bf16 v[108:111], v[40:43], a[168:175], v2
v_smfmac_f32_16x16x64_bf16 v[108:111], v[44:47], a[184:191], v2
v_smfmac_f32_16x16x64_bf16 v[108:111], v[48:51], a[200:207], v2
s_nop 2
v_add_f32 v100, v100, v102
v_smfmac_f32_16x16x64_bf16 v[108:111], v[52:55], a[216:223], v2
v_add_f32 v101, v101, v103
v_cvt_pk_bf16_f32 v98, v100, v101
v_and_or_b32 v98, v98, -2, s41
s_nop 4
v_pk_add_f32 v[108:109], v[108:109], v[110:111]
v_cvt_pk_bf16_f32 v99, v108, v109
buffer_store_dwordx2 v[98:99], v11, s[4:7], s37 offen offset:512 sc1
v_smfmac_f32_16x16x64_bf16 v[112:115], v[32:35], v[64:71], v2
ds_read_b128 v[64:67], v1 offset:45056
ds_read_b128 v[68:71], v1 offset:46080
v_smfmac_f32_16x16x64_bf16 v[116:119], v[32:35], v[72:79], v2
ds_read_b128 v[72:75], v1 offset:47104
ds_read_b128 v[76:79], v1 offset:48128
v_smfmac_f32_16x16x64_bf16 v[112:115], v[36:39], v[80:87], v2
ds_read_b128 v[80:83], v1 offset:61440
ds_read_b128 v[84:87], v1 offset:62464
v_smfmac_f32_16x16x64_bf16 v[116:119], v[36:39], v[88:95], v2
ds_read_b128 v[88:91], v1 offset:63488
ds_read_b128 v[92:95], v1 offset:64512
s_waitcnt lgkmcnt(6)
v_smfmac_f32_16x16x64_bf16 v[112:115], v[40:43], v[64:71], v2
ds_read_b128 v[64:67], v5 offset:12288
ds_read_b128 v[68:71], v5 offset:13312
s_waitcnt lgkmcnt(6)
v_smfmac_f32_16x16x64_bf16 v[116:119], v[40:43], v[72:79], v2
ds_read_b128 v[72:75], v5 offset:14336
ds_read_b128 v[76:79], v5 offset:15360
s_waitcnt lgkmcnt(6)
v_smfmac_f32_16x16x64_bf16 v[112:115], v[44:47], v[80:87], v2
ds_read_b128 v[80:83], v5 offset:28672
ds_read_b128 v[84:87], v5 offset:29696
s_waitcnt lgkmcnt(6)
v_smfmac_f32_16x16x64_bf16 v[116:119], v[44:47], v[88:95], v2
ds_read_b128 v[88:91], v5 offset:30720
ds_read_b128 v[92:95], v5 offset:31744
s_waitcnt lgkmcnt(6)
v_smfmac_f32_16x16x64_bf16 v[112:115], v[48:51], v[64:71], v2
ds_read_b128 v[64:67], v5 offset:45056
ds_read_b128 v[68:71], v5 offset:46080
s_waitcnt lgkmcnt(6)
v_smfmac_f32_16x16x64_bf16 v[116:119], v[48:51], v[72:79], v2
ds_read_b128 v[72:75], v5 offset:47104
ds_read_b128 v[76:79], v5 offset:48128
s_waitcnt lgkmcnt(6)
v_smfmac_f32_16x16x64_bf16 v[112:115], v[52:55], v[80:87], v2
ds_read_b128 v[80:83], v5 offset:61440
ds_read_b128 v[84:87], v5 offset:62464
s_waitcnt lgkmcnt(6)
v_smfmac_f32_16x16x64_bf16 v[116:119], v[52:55], v[88:95], v2
ds_read_b128 v[88:91], v5 offset:63488
ds_read_b128 v[92:95], v5 offset:64512
s_waitcnt lgkmcnt(6)
v_smfmac_f32_16x16x64_bf16 v[112:115], v[56:59], v[64:71], v2
s_waitcnt lgkmcnt(4)
v_smfmac_f32_16x16x64_bf16 v[116:119], v[56:59], v[72:79], v2
s_waitcnt lgkmcnt(2)
v_smfmac_f32_16x16x64_bf16 v[112:115], v[60:63], v[80:87], v2
s_waitcnt lgkmcnt(0)
v_smfmac_f32_16x16x64_bf16 v[116:119], v[60:63], v[88:95], v2
buffer_load_dwordx2 v[108:109], v11, s[4:7], s38 offen sc1
v_mfma_f32_16x16x16_bf16 v[100:103], v[96:97], v[16:17], 0
v_mfma_f32_16x16x16_bf16 v[104:107], v[98:99], v[16:17], 0
s_nop 4
v_add_f32 v112, v112, v114
v_add_f32 v113, v113, v115
v_add_f32 v114, v116, v118
v_add_f32 v115, v117, v119
v_cvt_pk_bf16_f32 v18, v112, v113
v_cvt_pk_bf16_f32 v19, v114, v115
v_and_or_b32 v18, v18, -2, s41
buffer_load_dwordx2 v[110:111], v11, s[4:7], s38 offen offset:512 sc1
s_barrier
buffer_store_dwordx2 v[18:19], v11, s[4:7], s39 offen sc1
v_mov_b32 v112, v18
v_mov_b32 v114, v19
v_mov_b32 v92, v28
v_mov_b32 v93, 0
s_waitcnt vmcnt(6)
s_barrier
ds_read_b128 v[32:35], v6 offset:24576
ds_read_b128 v[36:39], v6 offset:25600
ds_read_b128 v[40:43], v6 offset:19456
ds_read_b128 v[44:47], v6 offset:20480
ds_read_b128 v[48:51], v6 offset:14336
ds_read_b128 v[52:55], v6 offset:15360
ds_read_b128 v[56:59], v6 offset:9216
ds_read_b128 v[60:63], v6 offset:10240
buffer_load_dwordx2 v[20:21], v11, s[4:7], s38 offen sc1
buffer_load_dwordx2 v[22:23], v11, s[4:7], s38 offen offset:512 sc1
s_waitcnt vmcnt(4)
v_mfma_f32_16x16x16_bf16 v[80:83], v[108:109], v[16:17], v[100:103]
v_and_b32 v3, 1, v108
v_cmp_ne_u32 vcc, s41, v3
s_nop 5
v_cvt_pk_bf16_f32 v64, v80, v81
v_cvt_pk_bf16_f32 v65, v82, v83
s_cbranch_vccnz L_rs_w3_xslow
s_waitcnt vmcnt(3)
v_mfma_f32_16x16x16_bf16 v[84:87], v[110:111], v[16:17], v[104:107]
v_and_b32 v3, 1, v110
v_cmp_ne_u32 vcc, s41, v3
s_nop 5
v_cvt_pk_bf16_f32 v66, v84, v85
v_cvt_pk_bf16_f32 v67, v86, v87
ds_write_b128 v6, v[64:67] offset:23552
s_cbranch_vccnz L_rs_w3_xslow
L_rs_w3_xok:
s_cmp_eq_u32 s21, 63
s_cbranch_scc1 L_rs_w3_last
buffer_load_dwordx2 v[116:117], v11, s[4:7], s40 offen sc1
s_waitcnt lgkmcnt(1)
v_mfma_f32_16x16x32_bf16 v[80:83], v[32:35], v[64:67], 0
s_waitcnt lgkmcnt(0)
s_barrier
ds_read_b128 v[68:71], v6 offset:18432
ds_read_b128 v[72:75], v6 offset:13312
ds_read_b128 v[76:79], v6 offset:8192
v_mfma_f32_16x16x32_bf16 v[84:87], v[36:39], v[64:67], 0
v_mfma_f32_16x16x32_bf16 v[88:91], v[64:67], v[64:67], 0
buffer_load_dwordx2 v[20:21], v11, s[4:7], s40 offen sc1
s_waitcnt lgkmcnt(2)
v_mfma_f32_16x16x32_bf16 v[80:83], v[40:43], v[68:71], v[80:83]
s_waitcnt lgkmcnt(1)
v_mfma_f32_16x16x32_bf16 v[80:83], v[48:51], v[72:75], v[80:83]
s_waitcnt lgkmcnt(0)
v_mfma_f32_16x16x32_bf16 v[80:83], v[56:59], v[76:79], v[80:83]
v_mfma_f32_16x16x32_bf16 v[84:87], v[44:47], v[68:71], v[84:87]
buffer_store_dwordx4 v[64:67], v10, s[4:7], s45 offen offset:192 sc1
v_mfma_f32_16x16x32_bf16 v[84:87], v[52:55], v[72:75], v[84:87]
v_mfma_f32_16x16x32_bf16 v[84:87], v[60:63], v[76:79], v[84:87]
v_mfma_f32_16x16x32_bf16 v[88:91], v[68:71], v[68:71], v[88:91]
v_mfma_f32_16x16x32_bf16 v[88:91], v[72:75], v[72:75], v[88:91]
buffer_store_dwordx2 v[18:19], v11, s[4:7], s51 offen offset:3584 sc1
v_mfma_f32_16x16x32_bf16 v[88:91], v[76:79], v[76:79], v[88:91]
v_mfma_f32_32x32x4_2b_bf16 v[32:63], v[14:15], v[14:15], 0
s_nop 0
v_max3_f32 v4, v80, v81, v82
s_nop 1
v_max3_f32 v4, v4, v83, v84
v_max3_f32 v4, v4, v85, v86
v_max_f32 v4, v4, v87
v_max3_f32 v90, v4, v88, v89
v_max3_f32 v4, v4, v88, v89
s_nop 1
v_permlane16_swap_b32 v4, v90
v_max_f32 v4, v4, v90
v_max_f32 v90, v4, v90
s_nop 1
v_permlane32_swap_b32 v4, v90
v_max_f32 v4, v4, v90
v_mul_f32 v4, s34, v4
v_pk_fma_f32 v[80:81], v[80:81], s[34:35], v[4:5] op_sel_hi:[1,0,0] neg_lo:[0,0,1] neg_hi:[0,0,1]
v_pk_fma_f32 v[82:83], v[82:83], s[34:35], v[4:5] op_sel_hi:[1,0,0] neg_lo:[0,0,1] neg_hi:[0,0,1]
v_pk_fma_f32 v[84:85], v[84:85], s[34:35], v[4:5] op_sel_hi:[1,0,0] neg_lo:[0,0,1] neg_hi:[0,0,1]
v_pk_fma_f32 v[86:87], v[86:87], s[34:35], v[4:5] op_sel_hi:[1,0,0] neg_lo:[0,0,1] neg_hi:[0,0,1]
v_pk_fma_f32 v[88:89], v[88:89], s[34:35], v[4:5] op_sel_hi:[1,0,0] neg_lo:[0,0,1] neg_hi:[0,0,1]
v_exp_f32 v80, v80
v_exp_f32 v81, v81
v_exp_f32 v82, v82
v_cvt_pk_bf16_f32 v68, v80, v81
v_exp_f32 v83, v83
v_exp_f32 v84, v84
v_cvt_pk_bf16_f32 v69, v82, v83
v_exp_f32 v85, v85
v_exp_f32 v86, v86
v_cvt_pk_bf16_f32 v70, v84, v85
v_exp_f32 v87, v87
v_exp_f32 v88, v88
v_cvt_pk_bf16_f32 v71, v86, v87
v_exp_f32 v89, v89
s_waitcnt vmcnt(3)
v_mfma_f32_16x16x32_bf16 v[76:79], v[28:31], v[68:71], 0
v_and_b32 v3, 1, v116
v_cvt_pk_bf16_f32 v72, v88, v89
v_mfma_f32_16x16x32_bf16 v[100:103], v[120:123], v[68:71], 0
v_cmp_ne_u32 vcc, s41, v3
v_cvt_pk_bf16_f32 v73, v88, v89
v_mfma_f32_16x16x32_bf16 v[104:107], v[124:127], v[68:71], 0
v_mov_b32 v113, v116
v_mov_b32 v115, v117
v_mfma_f32_16x16x16_bf16 v[76:79], v[92:93], v[72:73], v[76:79]
s_cbranch_vccnz L_rs_w3_pv0
L_rs_w3_pv2:
v_mfma_f32_16x16x16_bf16 v[100:103], v[112:113], v[72:73], v[100:103]
v_mfma_f32_16x16x16_bf16 v[104:107], v[114:115], v[72:73], v[104:107]
buffer_load_dwordx4 v[120:123], v1, s[4:7], s44 offen
buffer_load_dwordx4 v[124:127], v1, s[4:7], s44 offen offset:1024
s_nop 2
v_rcp_f32 v76, v76
s_mov_b64 exec, s[28:29]
v_pk_mul_f32 v[100:101], v[100:101], v[76:77] op_sel_hi:[1,0]
v_pk_mul_f32 v[102:103], v[102:103], v[76:77] op_sel_hi:[1,0]
v_pk_mul_f32 v[104:105], v[104:105], v[76:77] op_sel_hi:[1,0]
v_pk_mul_f32 v[106:107], v[106:107], v[76:77] op_sel_hi:[1,0]
v_cvt_pk_bf16_f32 v84, v100, v101
v_cvt_pk_bf16_f32 v85, v102, v103
v_cvt_pk_bf16_f32 v86, v104, v105
v_cvt_pk_bf16_f32 v87, v106, v107
ds_write_b128 v6, v[84:87] offset:29696
s_mov_b64 exec, -1
s_waitcnt lgkmcnt(0)
s_barrier
ds_read_b128 v[68:71], v6 offset:28672
ds_read_b128 v[72:75], v6 offset:29696
s_waitcnt lgkmcnt(1)
v_smfmac_f32_16x16x64_bf16 v[32:35], v[68:71], v[128:135], v2
s_add_u32 s21, s21, 1
s_xor_b32 s38, s38, 1048576
s_xor_b32 s37, s37, 1048576
s_waitcnt lgkmcnt(0)
v_smfmac_f32_16x16x64_bf16 v[32:35], v[72:75], v[136:143], v2
s_xor_b32 s40, s40, 1048576
s_xor_b32 s39, s39, 1048576
s_lshr_b32 s41, s21, 1
v_smfmac_f32_16x16x64_bf16 v[36:39], v[68:71], v[144:151], v2
s_and_b32 s41, s41, 1
s_xor_b32 s41, s41, 1
s_xor_b32 s35, s35, 16384
v_smfmac_f32_16x16x64_bf16 v[36:39], v[72:75], v[152:159], v2
v_add_f32 v32, v32, v34
s_xor_b32 s36, s36, 16384
s_add_u32 s43, s43, 262144
s_add_u32 s44, s44, 262144
v_smfmac_f32_16x16x64_bf16 v[40:43], v[68:71], v[160:167], v2
v_add_f32 v33, v33, v35
v_smfmac_f32_16x16x64_bf16 v[40:43], v[72:75], v[168:175], v2
v_cvt_pk_bf16_f32 v32, v32, v33
v_smfmac_f32_16x16x64_bf16 v[44:47], v[68:71], v[176:183], v2
v_and_or_b32 v32, v32, -2, s42
v_smfmac_f32_16x16x64_bf16 v[44:47], v[72:75], v[184:191], v2
v_add_f32 v36, v36, v38
v_smfmac_f32_16x16x64_bf16 v[48:51], v[68:71], v[192:199], v2
v_add_f32 v37, v37, v39
v_smfmac_f32_16x16x64_bf16 v[48:51], v[72:75], v[200:207], v2
v_cvt_pk_bf16_f32 v33, v36, v37
v_smfmac_f32_16x16x64_bf16 v[52:55], v[68:71], v[208:215], v2
v_add_f32 v40, v40, v42
v_smfmac_f32_16x16x64_bf16 v[52:55], v[72:75], v[216:223], v2
v_add_f32 v41, v41, v43
v_smfmac_f32_16x16x64_bf16 v[56:59], v[68:71], v[224:231], v2
v_cvt_pk_bf16_f32 v34, v40, v41
v_smfmac_f32_16x16x64_bf16 v[56:59], v[72:75], v[232:239], v2
v_add_f32 v44, v44, v46
v_smfmac_f32_16x16x64_bf16 v[60:63], v[68:71], v[240:247], v2
v_add_f32 v45, v45, v47
v_smfmac_f32_16x16x64_bf16 v[60:63], v[72:75], v[248:255], v2
v_cvt_pk_bf16_f32 v35, v44, v45
buffer_store_dwordx4 v[32:35], v8, s[4:7], s46 offen sc1
v_pk_add_f32 v[48:49], v[48:49], v[50:51]
v_cvt_pk_bf16_f32 v48, v48, v49
v_and_or_b32 v48, v48, -2, s42
v_pk_add_f32 v[52:53], v[52:53], v[54:55]
v_cvt_pk_bf16_f32 v49, v52, v53
v_pk_add_f32 v[56:57], v[56:57], v[58:59]
v_cvt_pk_bf16_f32 v50, v56, v57
v_pk_add_f32 v[60:61], v[60:61], v[62:63]
v_cvt_pk_bf16_f32 v51, v60, v61
buffer_store_dwordx4 v[48:51], v8, s[4:7], s61 offen sc1
s_add_u32 s45, s45, 262144
s_add_u32 s51, s51, 262144
v_mfma_f32_32x32x8_bf16 v[96:111], v[14:15], v[14:15], 0
v_mfma_f32_16x16x16_bf16 v[112:115], v[14:15], v[14:15], 0
v_mfma_f32_16x16x16_bf16 v[116:119], v[14:15], v[14:15], 0
ds_read_b128 v[64:67], v1 offset:12288
ds_read_b128 v[68:71], v1 offset:13312
ds_read_b128 v[72:75], v1 offset:14336
ds_read_b128 v[76:79], v1 offset:15360
ds_read_b128 v[80:83], v1 offset:28672
ds_read_b128 v[84:87], v1 offset:29696
ds_read_b128 v[88:91], v1 offset:30720
ds_read_b128 v[92:95], v1 offset:31744
s_add_u32 s22, s21, 2
s_cmp_gt_u32 s50, s22
s_cbranch_scc1 L_rs_w3_kvs
v_readlane_b32 s50, v12, 0
v_readlane_b32 s22, v12, 2
v_readlane_b32 s23, v12, 1
v_readlane_b32 s24, v12, 3
s_nop 3
s_min_u32 s50, s50, s22
s_min_u32 s23, s23, s24
s_lshl_b32 s50, s50, 1
s_lshl_b32 s23, s23, 1
s_add_u32 s23, s23, 1
s_min_u32 s50, s50, s23
L_rs_kvb1:
s_add_u32 s22, s21, 1
s_min_u32 s22, s22, 63
s_cmp_gt_u32 s50, s22
s_cbranch_scc1 L_rs_kvd1
buffer_load_dword v12, v7, s[4:7], 0 offen sc1
s_waitcnt vmcnt(0)
v_readlane_b32 s50, v12, 0
v_readlane_b32 s22, v12, 2
v_readlane_b32 s23, v12, 1
v_readlane_b32 s24, v12, 3
s_nop 3
s_min_u32 s50, s50, s22
s_min_u32 s23, s23, s24
s_lshl_b32 s50, s50, 1
s_lshl_b32 s23, s23, 1
s_add_u32 s23, s23, 1
s_min_u32 s50, s50, s23
s_branch L_rs_kvb1
L_rs_kvd1:
L_rs_w3_kvs:
v_mov_b32 v58, -1
v_mov_b32 v59, -1
s_waitcnt vmcnt(0)
L_rs_w3_cgo:
L_rs_w3_pc:
buffer_load_dword v36, v13, s[4:7], s25 offen sc1
buffer_load_dword v37, v13, s[4:7], s25 offen offset:256 sc1
buffer_load_dword v38, v13, s[4:7], s25 offen offset:512 sc1
buffer_load_dword v39, v13, s[4:7], s25 offen offset:768 sc1
buffer_load_dword v40, v13, s[4:7], s25 offen offset:1024 sc1
buffer_load_dword v41, v13, s[4:7], s25 offen offset:1280 sc1
buffer_load_dword v42, v13, s[4:7], s25 offen offset:1536 sc1
buffer_load_dword v43, v13, s[4:7], s25 offen offset:1792 sc1
s_waitcnt vmcnt(4)
v_mfma_f32_16x16x32_bf16 v[52:55], v[36:39], v[24:27], 0
v_bitop3_b32 v3, s42, v36, v37 bitop3:0x7e
v_bitop3_b32 v4, s42, v38, v39 bitop3:0x7e
s_waitcnt vmcnt(2)
v_or_b32 v3, v3, v4
v_bitop3_b32 v4, s42, v40, v41 bitop3:0x7e
s_waitcnt vmcnt(0)
v_mfma_f32_16x16x32_bf16 v[52:55], v[40:43], v[24:27], v[52:55]
v_bitop3_b32 v56, s42, v42, v43 bitop3:0x7e
v_or3_b32 v3, v3, v4, v56
v_and_b32 v3, v0, v3
v_cmp_ne_u32 vcc, 0, v3
s_nop 3
v_cvt_pk_bf16_f32 v56, v52, v53
v_cvt_pk_bf16_f32 v57, v54, v55
v_min_u32 v56, -2, v56
s_cbranch_vccnz L_rs_w3_pc
s_mov_b64 exec, s[26:27]
buffer_store_dwordx2 v[56:57], v9, s[4:7], s35 offen offset:768 sc1
buffer_store_dwordx2 v[58:59], v9, s[4:7], s36 offen offset:768 sc1
s_mov_b64 exec, -1
s_xor_b32 s42, s42, 1
s_branch L_rs_w3_loop
L_rs_w3_last:
buffer_store_dwordx4 v[64:67], v10, s[4:7], s45 offen offset:192 sc1
buffer_store_dwordx2 v[18:19], v11, s[4:7], s51 offen offset:3584 sc1
s_branch L_rs_end
L_rs_w3_pafail:
s_nop 7
v_mov_b32 v96, 0
v_mov_b32 v97, 0
v_mov_b32 v98, 0
v_mov_b32 v99, 0
v_mov_b32 v100, 0
v_mov_b32 v101, 0
v_mov_b32 v102, 0
v_mov_b32 v103, 0
v_mov_b32 v104, 0
v_mov_b32 v105, 0
v_mov_b32 v106, 0
v_mov_b32 v107, 0
s_branch L_rs_w3_pa
L_rs_w3_xslow:
buffer_load_dwordx2 v[108:109], v11, s[4:7], s38 offen sc1
buffer_load_dwordx2 v[110:111], v11, s[4:7], s38 offen offset:512 sc1
s_waitcnt vmcnt(2)
v_bitop3_b32 v3, s41, v20, v22 bitop3:0x7e
v_mfma_f32_16x16x16_bf16 v[80:83], v[20:21], v[16:17], v[100:103]
v_and_b32 v3, 1, v3
v_mfma_f32_16x16x16_bf16 v[84:87], v[22:23], v[16:17], v[104:107]
v_cmp_ne_u32 vcc, 0, v3
s_cbranch_vccz L_rs_w3_xgot
buffer_load_dwordx2 v[20:21], v11, s[4:7], s38 offen sc1
buffer_load_dwordx2 v[22:23], v11, s[4:7], s38 offen offset:512 sc1
s_waitcnt vmcnt(2)
v_bitop3_b32 v3, s41, v108, v110 bitop3:0x7e
v_mfma_f32_16x16x16_bf16 v[80:83], v[108:109], v[16:17], v[100:103]
v_and_b32 v3, 1, v3
v_mfma_f32_16x16x16_bf16 v[84:87], v[110:111], v[16:17], v[104:107]
v_cmp_ne_u32 vcc, 0, v3
s_cbranch_vccz L_rs_w3_xgot
s_branch L_rs_w3_xslow
L_rs_w3_xgot:
s_nop 3
v_cvt_pk_bf16_f32 v64, v80, v81
v_cvt_pk_bf16_f32 v65, v82, v83
v_cvt_pk_bf16_f32 v66, v84, v85
v_cvt_pk_bf16_f32 v67, v86, v87
ds_write_b128 v6, v[64:67] offset:23552
s_branch L_rs_w3_xok
L_rs_w3_pv0:
s_waitcnt vmcnt(2)
s_branch L_rs_w3_pv1
L_rs_w3_pv:
buffer_load_dwordx2 v[20:21], v11, s[4:7], s40 offen sc1
s_waitcnt vmcnt(0)
L_rs_w3_pv1:
v_and_b32 v3, 1, v20
v_cmp_ne_u32 vcc, s41, v3
v_mov_b32 v113, v20
v_mov_b32 v115, v21
s_cbranch_vccnz L_rs_w3_pv
s_branch L_rs_w3_pv2
L_rs_end:
s_mov_b64 exec, -1
v_mov_b32 v3, 64
s_waitcnt vmcnt(0)
s_barrier
s_cmp_lg_u32 s20, 0
s_cbranch_scc1 L_rs_end2
buffer_store_dword v3, v7, s[4:7], 0 offen sc1
L_rs_end2:
s_waitcnt vmcnt(0)
s_endpgm
L_bulk:
s_cmp_lt_u32 s92, 64
s_cbranch_scc1 L_fft
s_mov_b32 s29, 0
L_q_again:
s_load_dwordx2 s[8:9], s[0:1], 0
s_load_dwordx2 s[40:41], s[0:1], 16
s_load_dwordx2 s[42:43], s[0:1], 24
s_load_dwordx2 s[44:45], s[0:1], 32
v_lshrrev_b32 v2, 6, v0
v_and_b32 v1, 63, v0
v_readfirstlane_b32 s16, v2
s_lshr_b32 s17, s92, 6
s_lshr_b32 s20, s29, 5
s_sub_u32 s17, s17, s20
s_bfe_u32 s18, s92, 0x50001
s_and_b32 s19, s92, 1
s_waitcnt lgkmcnt(0)
s_mov_b32 s10, 4194304
s_mov_b32 s11, 0x00020000
s_cmp_eq_u32 s17, 1
s_cselect_b32 s12, s42, s40
s_cselect_b32 s13, s43, s41
s_cmp_eq_u32 s17, 2
s_cselect_b32 s12, s44, s12
s_cselect_b32 s13, s45, s13
s_mov_b32 s14, 8388608
s_mov_b32 s15, 0x00020000
v_lshrrev_b32 v2, 4, v1
v_and_b32 v3, 15, v1
v_lshlrev_b32 v4, 2, v2
v_xor_b32 v4, v4, v3
v_lshlrev_b32 v4, 4, v4
s_lshl_b32 s20, s16, 5
v_add_u32 v11, s20, v2
v_lshl_add_u32 v11, v11, 13, v4
s_lshl_b32 s20, s18, 8
v_add_u32 v11, s20, v11
s_lshl_b32 s22, s16, 13
s_lshl_b32 s27, s19, 23
s_and_b32 s27, s27, 4194304
s_add_u32 m0, s22, 0
s_xor_b32 s20, s27, 0
buffer_load_dwordx4 v11, s[12:15], s20 offen lds
s_add_u32 m0, s22, 1024
s_xor_b32 s20, s27, 32768
buffer_load_dwordx4 v11, s[12:15], s20 offen lds
s_add_u32 m0, s22, 2048
s_xor_b32 s20, s27, 65536
buffer_load_dwordx4 v11, s[12:15], s20 offen lds
s_add_u32 m0, s22, 3072
s_xor_b32 s20, s27, 98304
buffer_load_dwordx4 v11, s[12:15], s20 offen lds
s_add_u32 m0, s22, 4096
s_xor_b32 s20, s27, 131072
buffer_load_dwordx4 v11, s[12:15], s20 offen lds
s_add_u32 m0, s22, 5120
s_xor_b32 s20, s27, 163840
buffer_load_dwordx4 v11, s[12:15], s20 offen lds
s_add_u32 m0, s22, 6144
s_xor_b32 s20, s27, 196608
buffer_load_dwordx4 v11, s[12:15], s20 offen lds
s_add_u32 m0, s22, 7168
s_xor_b32 s20, s27, 229376
buffer_load_dwordx4 v11, s[12:15], s20 offen lds
s_waitcnt vmcnt(8)
s_barrier
s_or_b32 s81, s97, s98
s_cmp_lg_u32 s81, 0
s_cbranch_scc1 L_h0_3
s_lshl_b32 s81, s93, 5
v_mov_b32 v38, 1
s_mov_b64 exec, 1
buffer_atomic_add v38, off, s[88:91], s81 sc1
s_mov_b64 exec, -1
L_h0_3:
s_add_u32 m0, s22, 32768
s_xor_b32 s20, s27, 1048576
buffer_load_dwordx4 v11, s[12:15], s20 offen lds
s_add_u32 m0, s22, 33792
s_xor_b32 s20, s27, 1081344
buffer_load_dwordx4 v11, s[12:15], s20 offen lds
s_add_u32 m0, s22, 34816
s_xor_b32 s20, s27, 1114112
buffer_load_dwordx4 v11, s[12:15], s20 offen lds
s_add_u32 m0, s22, 35840
s_xor_b32 s20, s27, 1146880
buffer_load_dwordx4 v11, s[12:15], s20 offen lds
s_add_u32 m0, s22, 36864
s_xor_b32 s20, s27, 1179648
buffer_load_dwordx4 v11, s[12:15], s20 offen lds
s_add_u32 m0, s22, 37888
s_xor_b32 s20, s27, 1212416
buffer_load_dwordx4 v11, s[12:15], s20 offen lds
s_add_u32 m0, s22, 38912
s_xor_b32 s20, s27, 1245184
buffer_load_dwordx4 v11, s[12:15], s20 offen lds
s_add_u32 m0, s22, 39936
s_xor_b32 s20, s27, 1277952
buffer_load_dwordx4 v11, s[12:15], s20 offen lds
s_add_u32 m0, s22, 65536
s_xor_b32 s20, s27, 2097152
buffer_load_dwordx4 v11, s[12:15], s20 offen lds
s_add_u32 m0, s22, 66560
s_xor_b32 s20, s27, 2129920
buffer_load_dwordx4 v11, s[12:15], s20 offen lds
s_add_u32 m0, s22, 67584
s_xor_b32 s20, s27, 2162688
buffer_load_dwordx4 v11, s[12:15], s20 offen lds
s_add_u32 m0, s22, 68608
s_xor_b32 s20, s27, 2195456
buffer_load_dwordx4 v11, s[12:15], s20 offen lds
s_add_u32 m0, s22, 69632
s_xor_b32 s20, s27, 2228224
buffer_load_dwordx4 v11, s[12:15], s20 offen lds
s_add_u32 m0, s22, 70656
s_xor_b32 s20, s27, 2260992
buffer_load_dwordx4 v11, s[12:15], s20 offen lds
s_add_u32 m0, s22, 71680
s_xor_b32 s20, s27, 2293760
buffer_load_dwordx4 v11, s[12:15], s20 offen lds
s_add_u32 m0, s22, 72704
s_xor_b32 s20, s27, 2326528
buffer_load_dwordx4 v11, s[12:15], s20 offen lds
s_add_u32 m0, s22, 98304
s_xor_b32 s20, s27, 3145728
buffer_load_dwordx4 v11, s[12:15], s20 offen lds
s_add_u32 m0, s22, 99328
s_xor_b32 s20, s27, 3178496
buffer_load_dwordx4 v11, s[12:15], s20 offen lds
s_add_u32 m0, s22, 100352
s_xor_b32 s20, s27, 3211264
buffer_load_dwordx4 v11, s[12:15], s20 offen lds
s_add_u32 m0, s22, 101376
s_xor_b32 s20, s27, 3244032
buffer_load_dwordx4 v11, s[12:15], s20 offen lds
s_add_u32 m0, s22, 102400
s_xor_b32 s20, s27, 3276800
buffer_load_dwordx4 v11, s[12:15], s20 offen lds
s_add_u32 m0, s22, 103424
s_xor_b32 s20, s27, 3309568
buffer_load_dwordx4 v11, s[12:15], s20 offen lds
s_add_u32 m0, s22, 104448
s_xor_b32 s20, s27, 3342336
buffer_load_dwordx4 v11, s[12:15], s20 offen lds
s_add_u32 m0, s22, 105472
s_xor_b32 s20, s27, 3375104
buffer_load_dwordx4 v11, s[12:15], s20 offen lds
v_and_b32 v3, 3, v1
v_bfe_u32 v14, v1, 2, 2
v_xor_b32 v15, s16, v14
v_lshlrev_b32 v15, 6, v15
v_lshl_add_u32 v15, v3, 4, v15
v_lshl_add_u32 v13, v2, 3, v14
v_lshl_add_u32 v12, v13, 8, v15
v_and_b32 v3, 15, v1
s_lshl_b32 s20, s16, 3
v_add_u32 v13, s20, v2
v_add_u32 v13, 0, v13
v_and_b32 v14, 15, v13
v_xor_b32 v14, v14, v3
v_lshlrev_b32 v14, 4, v14
v_lshl_add_u32 v6, v13, 11, v14
v_add_u32 v13, s20, v2
v_add_u32 v13, 4, v13
v_and_b32 v14, 15, v13
v_xor_b32 v14, v14, v3
v_lshlrev_b32 v14, 4, v14
v_lshl_add_u32 v7, v13, 11, v14
v_xor_b32 v14, v2, v3
v_lshlrev_b32 v14, 4, v14
v_lshl_add_u32 v13, v3, 8, v14
v_xor_b32 v16, 0, v13
v_add_u32 v20, 0x10000, v16
v_xor_b32 v17, 64, v13
v_add_u32 v21, 0x10000, v17
v_xor_b32 v18, 128, v13
v_add_u32 v22, 0x10000, v18
v_xor_b32 v19, 192, v13
v_add_u32 v23, 0x10000, v19
v_lshlrev_b32 v8, 4, v1
v_bfrev_b32 v13, 1
s_lshl_b32 s20, s92, 7
s_add_u32 s20, s20, 71303168
v_mov_b32 v14, s20
v_cmp_eq_u32 vcc, 0, v0
s_lshl_b32 s24, s17, 24
s_lshl_b32 s20, s19, 18
v_cndmask_b32 v9, v13, v14, vcc
s_add_u32 s24, s24, s20
s_lshl_b32 s20, s18, 13
s_add_u32 s24, s24, s20
s_lshl_b32 s20, s16, 11
s_add_u32 s24, s24, s20
s_add_u32 s24, s24, 0
s_lshl_b32 s23, s19, 16
s_lshr_b32 s20, s27, 12
s_add_u32 s23, s23, s20
v_mov_b32 v10, s29
s_lshl_b32 s21, s16, 11
s_waitcnt vmcnt(24)
s_barrier
v_add_u32 v13, 0, v12
ds_read_b64_tr_b16 a[0:1], v13
ds_read_b64_tr_b16 a[2:3], v13 offset:1024
ds_read_b64_tr_b16 a[4:5], v13 offset:8
ds_read_b64_tr_b16 a[6:7], v13 offset:1032
ds_read_b64_tr_b16 a[8:9], v13 offset:8192
ds_read_b64_tr_b16 a[10:11], v13 offset:9216
ds_read_b64_tr_b16 a[12:13], v13 offset:8200
ds_read_b64_tr_b16 a[14:15], v13 offset:9224
s_waitcnt lgkmcnt(0)
ds_read_b64_tr_b16 a[16:17], v13 offset:16384
ds_read_b64_tr_b16 a[18:19], v13 offset:17408
ds_read_b64_tr_b16 a[20:21], v13 offset:16392
ds_read_b64_tr_b16 a[22:23], v13 offset:17416
ds_read_b64_tr_b16 a[24:25], v13 offset:24576
ds_read_b64_tr_b16 a[26:27], v13 offset:25600
ds_read_b64_tr_b16 a[28:29], v13 offset:24584
ds_read_b64_tr_b16 a[30:31], v13 offset:25608
s_waitcnt lgkmcnt(0)
s_barrier
s_add_u32 m0, s22, 0
s_xor_b32 s20, s27, 4194304
buffer_load_dwordx4 v11, s[12:15], s20 offen lds
s_add_u32 m0, s22, 1024
s_xor_b32 s20, s27, 4227072
buffer_load_dwordx4 v11, s[12:15], s20 offen lds
s_add_u32 m0, s22, 2048
s_xor_b32 s20, s27, 4259840
buffer_load_dwordx4 v11, s[12:15], s20 offen lds
s_add_u32 m0, s22, 3072
s_xor_b32 s20, s27, 4292608
buffer_load_dwordx4 v11, s[12:15], s20 offen lds
s_add_u32 m0, s22, 4096
s_xor_b32 s20, s27, 4325376
buffer_load_dwordx4 v11, s[12:15], s20 offen lds
s_add_u32 m0, s22, 5120
s_xor_b32 s20, s27, 4358144
buffer_load_dwordx4 v11, s[12:15], s20 offen lds
s_add_u32 m0, s22, 6144
s_xor_b32 s20, s27, 4390912
buffer_load_dwordx4 v11, s[12:15], s20 offen lds
s_add_u32 m0, s22, 7168
s_xor_b32 s20, s27, 4423680
buffer_load_dwordx4 v11, s[12:15], s20 offen lds
s_waitcnt vmcnt(24)
s_barrier
v_add_u32 v13, 32768, v12
ds_read_b64_tr_b16 a[32:33], v13
ds_read_b64_tr_b16 a[34:35], v13 offset:1024
ds_read_b64_tr_b16 a[36:37], v13 offset:8
ds_read_b64_tr_b16 a[38:39], v13 offset:1032
ds_read_b64_tr_b16 a[40:41], v13 offset:8192
ds_read_b64_tr_b16 a[42:43], v13 offset:9216
ds_read_b64_tr_b16 a[44:45], v13 offset:8200
ds_read_b64_tr_b16 a[46:47], v13 offset:9224
s_waitcnt lgkmcnt(0)
ds_read_b64_tr_b16 a[48:49], v13 offset:16384
ds_read_b64_tr_b16 a[50:51], v13 offset:17408
ds_read_b64_tr_b16 a[52:53], v13 offset:16392
ds_read_b64_tr_b16 a[54:55], v13 offset:17416
ds_read_b64_tr_b16 a[56:57], v13 offset:24576
ds_read_b64_tr_b16 a[58:59], v13 offset:25600
ds_read_b64_tr_b16 a[60:61], v13 offset:24584
ds_read_b64_tr_b16 a[62:63], v13 offset:25608
s_waitcnt lgkmcnt(0)
s_barrier
s_add_u32 m0, s22, 32768
s_xor_b32 s20, s27, 5242880
buffer_load_dwordx4 v11, s[12:15], s20 offen lds
s_add_u32 m0, s22, 33792
s_xor_b32 s20, s27, 5275648
buffer_load_dwordx4 v11, s[12:15], s20 offen lds
s_add_u32 m0, s22, 34816
s_xor_b32 s20, s27, 5308416
buffer_load_dwordx4 v11, s[12:15], s20 offen lds
s_add_u32 m0, s22, 35840
s_xor_b32 s20, s27, 5341184
buffer_load_dwordx4 v11, s[12:15], s20 offen lds
s_add_u32 m0, s22, 36864
s_xor_b32 s20, s27, 5373952
buffer_load_dwordx4 v11, s[12:15], s20 offen lds
s_add_u32 m0, s22, 37888
s_xor_b32 s20, s27, 5406720
buffer_load_dwordx4 v11, s[12:15], s20 offen lds
s_add_u32 m0, s22, 38912
s_xor_b32 s20, s27, 5439488
buffer_load_dwordx4 v11, s[12:15], s20 offen lds
s_add_u32 m0, s22, 39936
s_xor_b32 s20, s27, 5472256
buffer_load_dwordx4 v11, s[12:15], s20 offen lds
s_waitcnt vmcnt(24)
s_barrier
v_add_u32 v13, 65536, v12
ds_read_b64_tr_b16 a[64:65], v13
ds_read_b64_tr_b16 a[66:67], v13 offset:1024
ds_read_b64_tr_b16 a[68:69], v13 offset:8
ds_read_b64_tr_b16 a[70:71], v13 offset:1032
ds_read_b64_tr_b16 a[72:73], v13 offset:8192
ds_read_b64_tr_b16 a[74:75], v13 offset:9216
ds_read_b64_tr_b16 a[76:77], v13 offset:8200
ds_read_b64_tr_b16 a[78:79], v13 offset:9224
s_waitcnt lgkmcnt(0)
ds_read_b64_tr_b16 a[80:81], v13 offset:16384
ds_read_b64_tr_b16 a[82:83], v13 offset:17408
ds_read_b64_tr_b16 a[84:85], v13 offset:16392
ds_read_b64_tr_b16 a[86:87], v13 offset:17416
ds_read_b64_tr_b16 a[88:89], v13 offset:24576
ds_read_b64_tr_b16 a[90:91], v13 offset:25600
ds_read_b64_tr_b16 a[92:93], v13 offset:24584
ds_read_b64_tr_b16 a[94:95], v13 offset:25608
s_waitcnt lgkmcnt(0)
s_barrier
s_add_u32 m0, s22, 65536
s_xor_b32 s20, s27, 6291456
buffer_load_dwordx4 v11, s[12:15], s20 offen lds
s_add_u32 m0, s22, 66560
s_xor_b32 s20, s27, 6324224
buffer_load_dwordx4 v11, s[12:15], s20 offen lds
s_add_u32 m0, s22, 67584
s_xor_b32 s20, s27, 6356992
buffer_load_dwordx4 v11, s[12:15], s20 offen lds
s_add_u32 m0, s22, 68608
s_xor_b32 s20, s27, 6389760
buffer_load_dwordx4 v11, s[12:15], s20 offen lds
s_add_u32 m0, s22, 69632
s_xor_b32 s20, s27, 6422528
buffer_load_dwordx4 v11, s[12:15], s20 offen lds
s_add_u32 m0, s22, 70656
s_xor_b32 s20, s27, 6455296
buffer_load_dwordx4 v11, s[12:15], s20 offen lds
s_add_u32 m0, s22, 71680
s_xor_b32 s20, s27, 6488064
buffer_load_dwordx4 v11, s[12:15], s20 offen lds
s_add_u32 m0, s22, 72704
s_xor_b32 s20, s27, 6520832
buffer_load_dwordx4 v11, s[12:15], s20 offen lds
s_waitcnt vmcnt(24)
s_barrier
v_and_b32 v37, 7, v0
v_lshlrev_b32 v37, 5, v37
buffer_load_dword v36, v37, s[88:91], 0 offen sc1
v_add_u32 v13, 98304, v12
ds_read_b64_tr_b16 a[96:97], v13
ds_read_b64_tr_b16 a[98:99], v13 offset:1024
ds_read_b64_tr_b16 a[100:101], v13 offset:8
ds_read_b64_tr_b16 a[102:103], v13 offset:1032
ds_read_b64_tr_b16 a[104:105], v13 offset:8192
ds_read_b64_tr_b16 a[106:107], v13 offset:9216
ds_read_b64_tr_b16 a[108:109], v13 offset:8200
ds_read_b64_tr_b16 a[110:111], v13 offset:9224
s_waitcnt lgkmcnt(0)
ds_read_b64_tr_b16 a[112:113], v13 offset:16384
ds_read_b64_tr_b16 a[114:115], v13 offset:17408
ds_read_b64_tr_b16 a[116:117], v13 offset:16392
ds_read_b64_tr_b16 a[118:119], v13 offset:17416
ds_read_b64_tr_b16 a[120:121], v13 offset:24576
ds_read_b64_tr_b16 a[122:123], v13 offset:25600
ds_read_b64_tr_b16 a[124:125], v13 offset:24584
ds_read_b64_tr_b16 a[126:127], v13 offset:25608
s_waitcnt lgkmcnt(0)
s_barrier
s_add_u32 m0, s22, 98304
s_xor_b32 s20, s27, 7340032
buffer_load_dwordx4 v11, s[12:15], s20 offen lds
s_add_u32 m0, s22, 99328
s_xor_b32 s20, s27, 7372800
buffer_load_dwordx4 v11, s[12:15], s20 offen lds
s_add_u32 m0, s22, 100352
s_xor_b32 s20, s27, 7405568
buffer_load_dwordx4 v11, s[12:15], s20 offen lds
s_add_u32 m0, s22, 101376
s_xor_b32 s20, s27, 7438336
buffer_load_dwordx4 v11, s[12:15], s20 offen lds
s_add_u32 m0, s22, 102400
s_xor_b32 s20, s27, 7471104
buffer_load_dwordx4 v11, s[12:15], s20 offen lds
s_add_u32 m0, s22, 103424
s_xor_b32 s20, s27, 7503872
buffer_load_dwordx4 v11, s[12:15], s20 offen lds
s_add_u32 m0, s22, 104448
s_xor_b32 s20, s27, 7536640
buffer_load_dwordx4 v11, s[12:15], s20 offen lds
s_add_u32 m0, s22, 105472
s_xor_b32 s20, s27, 7569408
buffer_load_dwordx4 v11, s[12:15], s20 offen lds
s_waitcnt vmcnt(24)
s_barrier
v_add_u32 v13, 0, v12
ds_read_b64_tr_b16 a[128:129], v13
ds_read_b64_tr_b16 a[130:131], v13 offset:1024
ds_read_b64_tr_b16 a[132:133], v13 offset:8
ds_read_b64_tr_b16 a[134:135], v13 offset:1032
ds_read_b64_tr_b16 a[136:137], v13 offset:8192
ds_read_b64_tr_b16 a[138:139], v13 offset:9216
ds_read_b64_tr_b16 a[140:141], v13 offset:8200
ds_read_b64_tr_b16 a[142:143], v13 offset:9224
s_waitcnt lgkmcnt(0)
ds_read_b64_tr_b16 a[144:145], v13 offset:16384
ds_read_b64_tr_b16 a[146:147], v13 offset:17408
ds_read_b64_tr_b16 a[148:149], v13 offset:16392
ds_read_b64_tr_b16 a[150:151], v13 offset:17416
ds_read_b64_tr_b16 a[152:153], v13 offset:24576
ds_read_b64_tr_b16 a[154:155], v13 offset:25600
ds_read_b64_tr_b16 a[156:157], v13 offset:24584
ds_read_b64_tr_b16 a[158:159], v13 offset:25608
s_waitcnt lgkmcnt(0)
s_barrier
s_add_u32 m0, s21, 0
s_xor_b32 s20, s23, 0
buffer_load_dwordx4 v6, s[8:11], s20 offen lds
s_add_u32 m0, s21, 1024
s_xor_b32 s20, s23, 0
buffer_load_dwordx4 v7, s[8:11], s20 offen lds
s_add_u32 m0, s21, 8192
s_xor_b32 s20, s23, 256
buffer_load_dwordx4 v6, s[8:11], s20 offen lds
s_add_u32 m0, s21, 9216
s_xor_b32 s20, s23, 256
buffer_load_dwordx4 v7, s[8:11], s20 offen lds
s_add_u32 m0, s21, 16384
s_xor_b32 s20, s23, 512
buffer_load_dwordx4 v6, s[8:11], s20 offen lds
s_add_u32 m0, s21, 17408
s_xor_b32 s20, s23, 512
buffer_load_dwordx4 v7, s[8:11], s20 offen lds
s_add_u32 m0, s21, 24576
s_xor_b32 s20, s23, 768
buffer_load_dwordx4 v6, s[8:11], s20 offen lds
s_add_u32 m0, s21, 25600
s_xor_b32 s20, s23, 768
buffer_load_dwordx4 v7, s[8:11], s20 offen lds
s_waitcnt vmcnt(24)
s_barrier
v_add_u32 v13, 32768, v12
ds_read_b64_tr_b16 a[160:161], v13
ds_read_b64_tr_b16 a[162:163], v13 offset:1024
ds_read_b64_tr_b16 a[164:165], v13 offset:8
ds_read_b64_tr_b16 a[166:167], v13 offset:1032
ds_read_b64_tr_b16 a[168:169], v13 offset:8192
ds_read_b64_tr_b16 a[170:171], v13 offset:9216
ds_read_b64_tr_b16 a[172:173], v13 offset:8200
ds_read_b64_tr_b16 a[174:175], v13 offset:9224
s_waitcnt lgkmcnt(0)
ds_read_b64_tr_b16 a[176:177], v13 offset:16384
ds_read_b64_tr_b16 a[178:179], v13 offset:17408
ds_read_b64_tr_b16 a[180:181], v13 offset:16392
ds_read_b64_tr_b16 a[182:183], v13 offset:17416
ds_read_b64_tr_b16 a[184:185], v13 offset:24576
ds_read_b64_tr_b16 a[186:187], v13 offset:25600
ds_read_b64_tr_b16 a[188:189], v13 offset:24584
ds_read_b64_tr_b16 a[190:191], v13 offset:25608
s_waitcnt lgkmcnt(0)
s_barrier
s_add_u32 m0, s21, 32768
s_xor_b32 s20, s23, 1024
buffer_load_dwordx4 v6, s[8:11], s20 offen lds
s_add_u32 m0, s21, 33792
s_xor_b32 s20, s23, 1024
buffer_load_dwordx4 v7, s[8:11], s20 offen lds
s_add_u32 m0, s21, 40960
s_xor_b32 s20, s23, 1280
buffer_load_dwordx4 v6, s[8:11], s20 offen lds
s_add_u32 m0, s21, 41984
s_xor_b32 s20, s23, 1280
buffer_load_dwordx4 v7, s[8:11], s20 offen lds
s_add_u32 m0, s21, 49152
s_xor_b32 s20, s23, 1536
buffer_load_dwordx4 v6, s[8:11], s20 offen lds
s_add_u32 m0, s21, 50176
s_xor_b32 s20, s23, 1536
buffer_load_dwordx4 v7, s[8:11], s20 offen lds
s_add_u32 m0, s21, 57344
s_xor_b32 s20, s23, 1792
buffer_load_dwordx4 v6, s[8:11], s20 offen lds
s_add_u32 m0, s21, 58368
s_xor_b32 s20, s23, 1792
buffer_load_dwordx4 v7, s[8:11], s20 offen lds
s_waitcnt vmcnt(24)
s_barrier
v_add_u32 v13, 65536, v12
ds_read_b64_tr_b16 a[192:193], v13
ds_read_b64_tr_b16 a[194:195], v13 offset:1024
ds_read_b64_tr_b16 a[196:197], v13 offset:8
ds_read_b64_tr_b16 a[198:199], v13 offset:1032
ds_read_b64_tr_b16 a[200:201], v13 offset:8192
ds_read_b64_tr_b16 a[202:203], v13 offset:9216
ds_read_b64_tr_b16 a[204:205], v13 offset:8200
ds_read_b64_tr_b16 a[206:207], v13 offset:9224
s_waitcnt lgkmcnt(0)
ds_read_b64_tr_b16 a[208:209], v13 offset:16384
ds_read_b64_tr_b16 a[210:211], v13 offset:17408
ds_read_b64_tr_b16 a[212:213], v13 offset:16392
ds_read_b64_tr_b16 a[214:215], v13 offset:17416
ds_read_b64_tr_b16 a[216:217], v13 offset:24576
ds_read_b64_tr_b16 a[218:219], v13 offset:25600
ds_read_b64_tr_b16 a[220:221], v13 offset:24584
ds_read_b64_tr_b16 a[222:223], v13 offset:25608
s_waitcnt lgkmcnt(0)
s_barrier
s_add_u32 s23, s23, 131072
s_add_u32 m0, s21, 65536
s_xor_b32 s20, s23, 0
buffer_load_dwordx4 v6, s[8:11], s20 offen lds
s_add_u32 m0, s21, 66560
s_xor_b32 s20, s23, 0
buffer_load_dwordx4 v7, s[8:11], s20 offen lds
s_add_u32 m0, s21, 73728
s_xor_b32 s20, s23, 256
buffer_load_dwordx4 v6, s[8:11], s20 offen lds
s_add_u32 m0, s21, 74752
s_xor_b32 s20, s23, 256
buffer_load_dwordx4 v7, s[8:11], s20 offen lds
s_add_u32 m0, s21, 81920
s_xor_b32 s20, s23, 512
buffer_load_dwordx4 v6, s[8:11], s20 offen lds
s_add_u32 m0, s21, 82944
s_xor_b32 s20, s23, 512
buffer_load_dwordx4 v7, s[8:11], s20 offen lds
s_add_u32 m0, s21, 90112
s_xor_b32 s20, s23, 768
buffer_load_dwordx4 v6, s[8:11], s20 offen lds
s_add_u32 m0, s21, 91136
s_xor_b32 s20, s23, 768
buffer_load_dwordx4 v7, s[8:11], s20 offen lds
s_waitcnt vmcnt(24)
s_barrier
s_cmp_lg_u32 s97, 0
s_cbranch_scc1 L_h2_4_ok
L_h2_4_ev:
v_cmp_ne_u32 vcc, 32, v36
s_cbranch_vccz L_h2_4_ok
s_mov_b32 s78, 0
v_readlane_b32 s81, v36, 0
s_nop 3
s_add_u32 s78, s78, s81
v_readlane_b32 s81, v36, 1
s_nop 3
s_add_u32 s78, s78, s81
v_readlane_b32 s81, v36, 2
s_nop 3
s_add_u32 s78, s78, s81
v_readlane_b32 s81, v36, 3
s_nop 3
s_add_u32 s78, s78, s81
v_readlane_b32 s81, v36, 4
s_nop 3
s_add_u32 s78, s78, s81
v_readlane_b32 s81, v36, 5
s_nop 3
s_add_u32 s78, s78, s81
v_readlane_b32 s81, v36, 6
s_nop 3
s_add_u32 s78, s78, s81
v_readlane_b32 s81, v36, 7
s_nop 3
s_add_u32 s78, s78, s81
s_cmp_eq_u32 s78, 256
s_cbranch_scc1 L_redo
buffer_load_dword v36, v37, s[88:91], 0 offen sc1
s_waitcnt vmcnt(0)
s_branch L_h2_4_ev
L_h2_4_ok:
s_mov_b32 s97, 1
v_add_u32 v13, 98304, v12
ds_read_b64_tr_b16 a[224:225], v13
ds_read_b64_tr_b16 a[226:227], v13 offset:1024
ds_read_b64_tr_b16 a[228:229], v13 offset:8
ds_read_b64_tr_b16 a[230:231], v13 offset:1032
ds_read_b64_tr_b16 a[232:233], v13 offset:8192
ds_read_b64_tr_b16 a[234:235], v13 offset:9216
ds_read_b64_tr_b16 a[236:237], v13 offset:8200
ds_read_b64_tr_b16 a[238:239], v13 offset:9224
s_waitcnt lgkmcnt(0)
ds_read_b64_tr_b16 a[240:241], v13 offset:16384
ds_read_b64_tr_b16 a[242:243], v13 offset:17408
ds_read_b64_tr_b16 a[244:245], v13 offset:16392
ds_read_b64_tr_b16 a[246:247], v13 offset:17416
ds_read_b64_tr_b16 a[248:249], v13 offset:24576
ds_read_b64_tr_b16 a[250:251], v13 offset:25600
ds_read_b64_tr_b16 a[252:253], v13 offset:24584
ds_read_b64_tr_b16 a[254:255], v13 offset:25608
s_waitcnt lgkmcnt(0)
s_barrier
s_waitcnt vmcnt(16)
s_barrier
s_cmp_eq_u32 s17, 2
s_cbranch_scc1 L_q_v
ds_read_b128 v[32:35], v16
ds_read_b128 v[36:39], v16 offset:4096
ds_read_b128 v[40:43], v17
ds_read_b128 v[44:47], v17 offset:4096
ds_read_b128 v[48:51], v18
ds_read_b128 v[52:55], v18 offset:4096
s_mov_b32 s25, 0
L_q_qk_loop:
s_waitcnt lgkmcnt(5)
v_mfma_f32_16x16x32_bf16 v[64:67], a[0:3], v[32:35], 0
ds_read_b128 v[56:59], v19
v_mfma_f32_16x16x32_bf16 v[68:71], a[4:7], v[32:35], 0
s_waitcnt lgkmcnt(5)
v_mfma_f32_16x16x32_bf16 v[72:75], a[0:3], v[36:39], 0
ds_read_b128 v[60:63], v19 offset:4096
v_mfma_f32_16x16x32_bf16 v[76:79], a[4:7], v[36:39], 0
s_waitcnt lgkmcnt(5)
v_mfma_f32_16x16x32_bf16 v[64:67], a[8:11], v[40:43], v[64:67]
ds_read_b128 v[32:35], v16 offset:8192
v_mfma_f32_16x16x32_bf16 v[68:71], a[12:15], v[40:43], v[68:71]
s_cmp_eq_u32 s25, 0
s_cbranch_scc1 L_q_qk_sk2
s_add_u32 m0, s21, 74752
s_xor_b32 s20, s23, 256
buffer_load_dwordx4 v7, s[8:11], s20 offen lds
L_q_qk_sk2:
s_waitcnt lgkmcnt(5)
v_mfma_f32_16x16x32_bf16 v[72:75], a[8:11], v[44:47], v[72:75]
ds_read_b128 v[36:39], v16 offset:12288
v_mfma_f32_16x16x32_bf16 v[76:79], a[12:15], v[44:47], v[76:79]
s_waitcnt lgkmcnt(5)
v_mfma_f32_16x16x32_bf16 v[64:67], a[16:19], v[48:51], v[64:67]
ds_read_b128 v[40:43], v17 offset:8192
v_mfma_f32_16x16x32_bf16 v[68:71], a[20:23], v[48:51], v[68:71]
s_waitcnt lgkmcnt(5)
v_mfma_f32_16x16x32_bf16 v[72:75], a[16:19], v[52:55], v[72:75]
ds_read_b128 v[44:47], v17 offset:12288
v_mfma_f32_16x16x32_bf16 v[76:79], a[20:23], v[52:55], v[76:79]
s_cmp_eq_u32 s25, 0
s_cbranch_scc1 L_q_qk_sk5
s_add_u32 m0, s21, 81920
s_xor_b32 s20, s23, 512
buffer_load_dwordx4 v6, s[8:11], s20 offen lds
L_q_qk_sk5:
s_waitcnt lgkmcnt(5)
v_mfma_f32_16x16x32_bf16 v[64:67], a[24:27], v[56:59], v[64:67]
ds_read_b128 v[48:51], v18 offset:8192
v_mfma_f32_16x16x32_bf16 v[68:71], a[28:31], v[56:59], v[68:71]
s_waitcnt lgkmcnt(5)
v_mfma_f32_16x16x32_bf16 v[72:75], a[24:27], v[60:63], v[72:75]
ds_read_b128 v[52:55], v18 offset:12288
v_mfma_f32_16x16x32_bf16 v[76:79], a[28:31], v[60:63], v[76:79]
s_waitcnt lgkmcnt(5)
v_mfma_f32_16x16x32_bf16 v[64:67], a[32:35], v[32:35], v[64:67]
ds_read_b128 v[56:59], v19 offset:8192
v_mfma_f32_16x16x32_bf16 v[68:71], a[36:39], v[32:35], v[68:71]
s_cmp_eq_u32 s25, 0
s_cbranch_scc1 L_q_qk_sk8
s_add_u32 m0, s21, 82944
s_xor_b32 s20, s23, 512
buffer_load_dwordx4 v7, s[8:11], s20 offen lds
L_q_qk_sk8:
s_waitcnt lgkmcnt(5)
v_mfma_f32_16x16x32_bf16 v[72:75], a[32:35], v[36:39], v[72:75]
ds_read_b128 v[60:63], v19 offset:12288
v_mfma_f32_16x16x32_bf16 v[76:79], a[36:39], v[36:39], v[76:79]
s_waitcnt lgkmcnt(5)
v_mfma_f32_16x16x32_bf16 v[64:67], a[40:43], v[40:43], v[64:67]
ds_read_b128 v[32:35], v16 offset:16384
v_mfma_f32_16x16x32_bf16 v[68:71], a[44:47], v[40:43], v[68:71]
s_waitcnt lgkmcnt(5)
v_mfma_f32_16x16x32_bf16 v[72:75], a[40:43], v[44:47], v[72:75]
ds_read_b128 v[36:39], v16 offset:20480
v_mfma_f32_16x16x32_bf16 v[76:79], a[44:47], v[44:47], v[76:79]
s_cmp_eq_u32 s25, 0
s_cbranch_scc1 L_q_qk_sk11
s_add_u32 m0, s21, 90112
s_xor_b32 s20, s23, 768
buffer_load_dwordx4 v6, s[8:11], s20 offen lds
L_q_qk_sk11:
s_waitcnt lgkmcnt(5)
v_mfma_f32_16x16x32_bf16 v[64:67], a[48:51], v[48:51], v[64:67]
ds_read_b128 v[40:43], v17 offset:16384
v_mfma_f32_16x16x32_bf16 v[68:71], a[52:55], v[48:51], v[68:71]
s_waitcnt lgkmcnt(5)
v_mfma_f32_16x16x32_bf16 v[72:75], a[48:51], v[52:55], v[72:75]
ds_read_b128 v[44:47], v17 offset:20480
v_mfma_f32_16x16x32_bf16 v[76:79], a[52:55], v[52:55], v[76:79]
s_waitcnt lgkmcnt(5)
v_mfma_f32_16x16x32_bf16 v[64:67], a[56:59], v[56:59], v[64:67]
ds_read_b128 v[48:51], v18 offset:16384
v_mfma_f32_16x16x32_bf16 v[68:71], a[60:63], v[56:59], v[68:71]
s_cmp_eq_u32 s25, 0
s_cbranch_scc1 L_q_qk_sk14
s_add_u32 m0, s21, 91136
s_xor_b32 s20, s23, 768
buffer_load_dwordx4 v7, s[8:11], s20 offen lds
L_q_qk_sk14:
s_waitcnt lgkmcnt(5)
v_mfma_f32_16x16x32_bf16 v[72:75], a[56:59], v[60:63], v[72:75]
ds_read_b128 v[52:55], v18 offset:20480
v_mfma_f32_16x16x32_bf16 v[76:79], a[60:63], v[60:63], v[76:79]
s_cmp_eq_u32 s25, 0
s_cbranch_scc1 L_q_qk_ne0
v_cvt_pk_bf16_f32 v96, v80, v81
v_cvt_pk_bf16_f32 v97, v82, v83
L_q_qk_ne0:
s_waitcnt lgkmcnt(5)
v_mfma_f32_16x16x32_bf16 v[64:67], a[64:67], v[32:35], v[64:67]
ds_read_b128 v[56:59], v19 offset:16384
v_mfma_f32_16x16x32_bf16 v[68:71], a[68:71], v[32:35], v[68:71]
s_cmp_eq_u32 s25, 0
s_cbranch_scc1 L_q_qk_ne1
v_cvt_pk_bf16_f32 v98, v84, v85
v_cvt_pk_bf16_f32 v99, v86, v87
L_q_qk_ne1:
s_waitcnt lgkmcnt(5)
v_mfma_f32_16x16x32_bf16 v[72:75], a[64:67], v[36:39], v[72:75]
ds_read_b128 v[60:63], v19 offset:20480
v_mfma_f32_16x16x32_bf16 v[76:79], a[68:71], v[36:39], v[76:79]
s_cmp_eq_u32 s25, 0
s_cbranch_scc1 L_q_qk_ne2
buffer_store_dwordx4 v[96:99], v8, s[84:87], s24 offen sc1
v_cvt_pk_bf16_f32 v100, v88, v89
L_q_qk_ne2:
s_waitcnt lgkmcnt(5)
v_mfma_f32_16x16x32_bf16 v[64:67], a[72:75], v[40:43], v[64:67]
ds_read_b128 v[32:35], v16 offset:24576
v_mfma_f32_16x16x32_bf16 v[68:71], a[76:79], v[40:43], v[68:71]
s_cmp_eq_u32 s25, 0
s_cbranch_scc1 L_q_qk_ne3
v_cvt_pk_bf16_f32 v101, v90, v91
v_cvt_pk_bf16_f32 v102, v92, v93
L_q_qk_ne3:
s_waitcnt lgkmcnt(5)
v_mfma_f32_16x16x32_bf16 v[72:75], a[72:75], v[44:47], v[72:75]
ds_read_b128 v[36:39], v16 offset:28672
v_mfma_f32_16x16x32_bf16 v[76:79], a[76:79], v[44:47], v[76:79]
s_cmp_eq_u32 s25, 0
s_cbranch_scc1 L_q_qk_ne4
v_cvt_pk_bf16_f32 v103, v94, v95
buffer_store_dwordx4 v[100:103], v8, s[84:87], s24 offen offset:1024 sc1
L_q_qk_ne4:
s_waitcnt lgkmcnt(5)
v_mfma_f32_16x16x32_bf16 v[64:67], a[80:83], v[48:51], v[64:67]
ds_read_b128 v[40:43], v17 offset:24576
v_mfma_f32_16x16x32_bf16 v[68:71], a[84:87], v[48:51], v[68:71]
s_cmp_eq_u32 s25, 0
s_cbranch_scc1 L_q_qk_ne5
s_add_u32 s24, s24, 524288
L_q_qk_ne5:
s_waitcnt lgkmcnt(5)
v_mfma_f32_16x16x32_bf16 v[72:75], a[80:83], v[52:55], v[72:75]
ds_read_b128 v[44:47], v17 offset:28672
v_mfma_f32_16x16x32_bf16 v[76:79], a[84:87], v[52:55], v[76:79]
s_waitcnt lgkmcnt(5)
v_mfma_f32_16x16x32_bf16 v[64:67], a[88:91], v[56:59], v[64:67]
ds_read_b128 v[48:51], v18 offset:24576
v_mfma_f32_16x16x32_bf16 v[68:71], a[92:95], v[56:59], v[68:71]
s_cmp_lg_u32 s25, 2
s_cbranch_scc1 L_q_qk_nx
v_lshlrev_b32 v242, 7, v0
s_mul_i32 s46, s92, 32768
s_sub_u32 s46, s46, 2097152
buffer_load_dword v240, v242, s[8:11], s46 offen
L_q_qk_nx:
s_waitcnt lgkmcnt(5)
v_mfma_f32_16x16x32_bf16 v[72:75], a[88:91], v[60:63], v[72:75]
ds_read_b128 v[52:55], v18 offset:28672
v_mfma_f32_16x16x32_bf16 v[76:79], a[92:95], v[60:63], v[76:79]
s_waitcnt vmcnt(8)
s_barrier
s_waitcnt lgkmcnt(5)
v_mfma_f32_16x16x32_bf16 v[64:67], a[96:99], v[32:35], v[64:67]
ds_read_b128 v[56:59], v19 offset:24576
v_mfma_f32_16x16x32_bf16 v[68:71], a[100:103], v[32:35], v[68:71]
s_waitcnt lgkmcnt(5)
v_mfma_f32_16x16x32_bf16 v[72:75], a[96:99], v[36:39], v[72:75]
ds_read_b128 v[60:63], v19 offset:28672
v_mfma_f32_16x16x32_bf16 v[76:79], a[100:103], v[36:39], v[76:79]
s_add_u32 m0, s21, 98304
s_xor_b32 s20, s23, 1024
buffer_load_dwordx4 v6, s[8:11], s20 offen lds
s_waitcnt lgkmcnt(5)
v_mfma_f32_16x16x32_bf16 v[64:67], a[104:107], v[40:43], v[64:67]
ds_read_b128 v[32:35], v16 offset:32768
v_mfma_f32_16x16x32_bf16 v[68:71], a[108:111], v[40:43], v[68:71]
s_waitcnt lgkmcnt(5)
v_mfma_f32_16x16x32_bf16 v[72:75], a[104:107], v[44:47], v[72:75]
ds_read_b128 v[36:39], v16 offset:36864
v_mfma_f32_16x16x32_bf16 v[76:79], a[108:111], v[44:47], v[76:79]
s_waitcnt lgkmcnt(5)
v_mfma_f32_16x16x32_bf16 v[64:67], a[112:115], v[48:51], v[64:67]
ds_read_b128 v[40:43], v17 offset:32768
v_mfma_f32_16x16x32_bf16 v[68:71], a[116:119], v[48:51], v[68:71]
s_add_u32 m0, s21, 99328
s_xor_b32 s20, s23, 1024
buffer_load_dwordx4 v7, s[8:11], s20 offen lds
s_waitcnt lgkmcnt(5)
v_mfma_f32_16x16x32_bf16 v[72:75], a[112:115], v[52:55], v[72:75]
ds_read_b128 v[44:47], v17 offset:36864
v_mfma_f32_16x16x32_bf16 v[76:79], a[116:119], v[52:55], v[76:79]
s_waitcnt lgkmcnt(5)
v_mfma_f32_16x16x32_bf16 v[64:67], a[120:123], v[56:59], v[64:67]
ds_read_b128 v[48:51], v18 offset:32768
v_mfma_f32_16x16x32_bf16 v[68:71], a[124:127], v[56:59], v[68:71]
s_waitcnt lgkmcnt(5)
v_mfma_f32_16x16x32_bf16 v[72:75], a[120:123], v[60:63], v[72:75]
ds_read_b128 v[52:55], v18 offset:36864
v_mfma_f32_16x16x32_bf16 v[76:79], a[124:127], v[60:63], v[76:79]
s_add_u32 m0, s21, 106496
s_xor_b32 s20, s23, 1280
buffer_load_dwordx4 v6, s[8:11], s20 offen lds
s_waitcnt lgkmcnt(5)
v_mfma_f32_16x16x32_bf16 v[64:67], a[128:131], v[32:35], v[64:67]
ds_read_b128 v[56:59], v19 offset:32768
v_mfma_f32_16x16x32_bf16 v[68:71], a[132:135], v[32:35], v[68:71]
s_waitcnt lgkmcnt(5)
v_mfma_f32_16x16x32_bf16 v[72:75], a[128:131], v[36:39], v[72:75]
ds_read_b128 v[60:63], v19 offset:36864
v_mfma_f32_16x16x32_bf16 v[76:79], a[132:135], v[36:39], v[76:79]
s_waitcnt lgkmcnt(5)
v_mfma_f32_16x16x32_bf16 v[64:67], a[136:139], v[40:43], v[64:67]
ds_read_b128 v[32:35], v16 offset:40960
v_mfma_f32_16x16x32_bf16 v[68:71], a[140:143], v[40:43], v[68:71]
s_add_u32 m0, s21, 107520
s_xor_b32 s20, s23, 1280
buffer_load_dwordx4 v7, s[8:11], s20 offen lds
s_waitcnt lgkmcnt(5)
v_mfma_f32_16x16x32_bf16 v[72:75], a[136:139], v[44:47], v[72:75]
ds_read_b128 v[36:39], v16 offset:45056
v_mfma_f32_16x16x32_bf16 v[76:79], a[140:143], v[44:47], v[76:79]
s_waitcnt lgkmcnt(5)
v_mfma_f32_16x16x32_bf16 v[64:67], a[144:147], v[48:51], v[64:67]
ds_read_b128 v[40:43], v17 offset:40960
v_mfma_f32_16x16x32_bf16 v[68:71], a[148:151], v[48:51], v[68:71]
s_waitcnt lgkmcnt(5)
v_mfma_f32_16x16x32_bf16 v[72:75], a[144:147], v[52:55], v[72:75]
ds_read_b128 v[44:47], v17 offset:45056
v_mfma_f32_16x16x32_bf16 v[76:79], a[148:151], v[52:55], v[76:79]
s_add_u32 m0, s21, 114688
s_xor_b32 s20, s23, 1536
buffer_load_dwordx4 v6, s[8:11], s20 offen lds
s_waitcnt lgkmcnt(5)
v_mfma_f32_16x16x32_bf16 v[64:67], a[152:155], v[56:59], v[64:67]
ds_read_b128 v[48:51], v18 offset:40960
v_mfma_f32_16x16x32_bf16 v[68:71], a[156:159], v[56:59], v[68:71]
s_waitcnt lgkmcnt(5)
v_mfma_f32_16x16x32_bf16 v[72:75], a[152:155], v[60:63], v[72:75]
ds_read_b128 v[52:55], v18 offset:45056
v_mfma_f32_16x16x32_bf16 v[76:79], a[156:159], v[60:63], v[76:79]
s_waitcnt lgkmcnt(5)
v_mfma_f32_16x16x32_bf16 v[64:67], a[160:163], v[32:35], v[64:67]
ds_read_b128 v[56:59], v19 offset:40960
v_mfma_f32_16x16x32_bf16 v[68:71], a[164:167], v[32:35], v[68:71]
s_add_u32 m0, s21, 115712
s_xor_b32 s20, s23, 1536
buffer_load_dwordx4 v7, s[8:11], s20 offen lds
s_waitcnt lgkmcnt(5)
v_mfma_f32_16x16x32_bf16 v[72:75], a[160:163], v[36:39], v[72:75]
ds_read_b128 v[60:63], v19 offset:45056
v_mfma_f32_16x16x32_bf16 v[76:79], a[164:167], v[36:39], v[76:79]
s_waitcnt lgkmcnt(5)
v_mfma_f32_16x16x32_bf16 v[64:67], a[168:171], v[40:43], v[64:67]
ds_read_b128 v[32:35], v16 offset:49152
v_mfma_f32_16x16x32_bf16 v[68:71], a[172:175], v[40:43], v[68:71]
s_waitcnt lgkmcnt(5)
v_mfma_f32_16x16x32_bf16 v[72:75], a[168:171], v[44:47], v[72:75]
ds_read_b128 v[36:39], v16 offset:53248
v_mfma_f32_16x16x32_bf16 v[76:79], a[172:175], v[44:47], v[76:79]
s_add_u32 m0, s21, 122880
s_xor_b32 s20, s23, 1792
buffer_load_dwordx4 v6, s[8:11], s20 offen lds
s_waitcnt lgkmcnt(5)
v_mfma_f32_16x16x32_bf16 v[64:67], a[176:179], v[48:51], v[64:67]
ds_read_b128 v[40:43], v17 offset:49152
v_mfma_f32_16x16x32_bf16 v[68:71], a[180:183], v[48:51], v[68:71]
s_waitcnt lgkmcnt(5)
v_mfma_f32_16x16x32_bf16 v[72:75], a[176:179], v[52:55], v[72:75]
ds_read_b128 v[44:47], v17 offset:53248
v_mfma_f32_16x16x32_bf16 v[76:79], a[180:183], v[52:55], v[76:79]
s_waitcnt lgkmcnt(5)
v_mfma_f32_16x16x32_bf16 v[64:67], a[184:187], v[56:59], v[64:67]
ds_read_b128 v[48:51], v18 offset:49152
v_mfma_f32_16x16x32_bf16 v[68:71], a[188:191], v[56:59], v[68:71]
s_add_u32 m0, s21, 123904
s_xor_b32 s20, s23, 1792
buffer_load_dwordx4 v7, s[8:11], s20 offen lds
s_waitcnt lgkmcnt(5)
v_mfma_f32_16x16x32_bf16 v[72:75], a[184:187], v[60:63], v[72:75]
ds_read_b128 v[52:55], v18 offset:53248
v_mfma_f32_16x16x32_bf16 v[76:79], a[188:191], v[60:63], v[76:79]
s_waitcnt lgkmcnt(5)
v_mfma_f32_16x16x32_bf16 v[64:67], a[192:195], v[32:35], v[64:67]
ds_read_b128 v[56:59], v19 offset:49152
v_mfma_f32_16x16x32_bf16 v[68:71], a[196:199], v[32:35], v[68:71]
s_waitcnt lgkmcnt(5)
v_mfma_f32_16x16x32_bf16 v[72:75], a[192:195], v[36:39], v[72:75]
ds_read_b128 v[60:63], v19 offset:53248
v_mfma_f32_16x16x32_bf16 v[76:79], a[196:199], v[36:39], v[76:79]
s_waitcnt lgkmcnt(5)
v_mfma_f32_16x16x32_bf16 v[64:67], a[200:203], v[40:43], v[64:67]
ds_read_b128 v[32:35], v16 offset:57344
v_mfma_f32_16x16x32_bf16 v[68:71], a[204:207], v[40:43], v[68:71]
s_waitcnt lgkmcnt(5)
v_mfma_f32_16x16x32_bf16 v[72:75], a[200:203], v[44:47], v[72:75]
ds_read_b128 v[36:39], v16 offset:61440
v_mfma_f32_16x16x32_bf16 v[76:79], a[204:207], v[44:47], v[76:79]
s_waitcnt lgkmcnt(5)
v_mfma_f32_16x16x32_bf16 v[64:67], a[208:211], v[48:51], v[64:67]
ds_read_b128 v[40:43], v17 offset:57344
v_mfma_f32_16x16x32_bf16 v[68:71], a[212:215], v[48:51], v[68:71]
s_waitcnt lgkmcnt(5)
v_mfma_f32_16x16x32_bf16 v[72:75], a[208:211], v[52:55], v[72:75]
ds_read_b128 v[44:47], v17 offset:61440
v_mfma_f32_16x16x32_bf16 v[76:79], a[212:215], v[52:55], v[76:79]
s_waitcnt lgkmcnt(5)
v_mfma_f32_16x16x32_bf16 v[64:67], a[216:219], v[56:59], v[64:67]
ds_read_b128 v[48:51], v18 offset:57344
v_mfma_f32_16x16x32_bf16 v[68:71], a[220:223], v[56:59], v[68:71]
s_waitcnt lgkmcnt(5)
v_mfma_f32_16x16x32_bf16 v[72:75], a[216:219], v[60:63], v[72:75]
ds_read_b128 v[52:55], v18 offset:61440
v_mfma_f32_16x16x32_bf16 v[76:79], a[220:223], v[60:63], v[76:79]
s_waitcnt vmcnt(8)
s_barrier
s_waitcnt lgkmcnt(5)
v_mfma_f32_16x16x32_bf16 v[64:67], a[224:227], v[32:35], v[64:67]
ds_read_b128 v[56:59], v19 offset:57344
v_mfma_f32_16x16x32_bf16 v[68:71], a[228:231], v[32:35], v[68:71]
s_waitcnt lgkmcnt(5)
v_mfma_f32_16x16x32_bf16 v[72:75], a[224:227], v[36:39], v[72:75]
ds_read_b128 v[60:63], v19 offset:61440
v_mfma_f32_16x16x32_bf16 v[76:79], a[228:231], v[36:39], v[76:79]
s_add_u32 s23, s23, 131072
s_add_u32 m0, s21, 0
s_xor_b32 s20, s23, 0
buffer_load_dwordx4 v6, s[8:11], s20 offen lds
s_waitcnt lgkmcnt(5)
v_mfma_f32_16x16x32_bf16 v[64:67], a[232:235], v[40:43], v[64:67]
ds_read_b128 v[32:35], v20
v_mfma_f32_16x16x32_bf16 v[68:71], a[236:239], v[40:43], v[68:71]
s_cmp_eq_u32 s25, 0
s_cbranch_scc1 L_q_qk_nf
v_add_u32 v10, 1, v10
buffer_store_dword v10, v9, s[84:87], 0 offen sc1
L_q_qk_nf:
s_waitcnt lgkmcnt(5)
v_mfma_f32_16x16x32_bf16 v[72:75], a[232:235], v[44:47], v[72:75]
ds_read_b128 v[36:39], v20 offset:4096
v_mfma_f32_16x16x32_bf16 v[76:79], a[236:239], v[44:47], v[76:79]
s_waitcnt lgkmcnt(5)
v_mfma_f32_16x16x32_bf16 v[64:67], a[240:243], v[48:51], v[64:67]
ds_read_b128 v[40:43], v21
v_mfma_f32_16x16x32_bf16 v[68:71], a[244:247], v[48:51], v[68:71]
s_add_u32 m0, s21, 1024
s_xor_b32 s20, s23, 0
buffer_load_dwordx4 v7, s[8:11], s20 offen lds
s_waitcnt lgkmcnt(5)
v_mfma_f32_16x16x32_bf16 v[72:75], a[240:243], v[52:55], v[72:75]
ds_read_b128 v[44:47], v21 offset:4096
v_mfma_f32_16x16x32_bf16 v[76:79], a[244:247], v[52:55], v[76:79]
s_waitcnt lgkmcnt(5)
v_mfma_f32_16x16x32_bf16 v[64:67], a[248:251], v[56:59], v[64:67]
ds_read_b128 v[48:51], v22
v_mfma_f32_16x16x32_bf16 v[68:71], a[252:255], v[56:59], v[68:71]
s_waitcnt lgkmcnt(5)
v_mfma_f32_16x16x32_bf16 v[72:75], a[248:251], v[60:63], v[72:75]
ds_read_b128 v[52:55], v22 offset:4096
v_mfma_f32_16x16x32_bf16 v[76:79], a[252:255], v[60:63], v[76:79]
s_add_u32 m0, s21, 8192
s_xor_b32 s20, s23, 256
buffer_load_dwordx4 v6, s[8:11], s20 offen lds
s_waitcnt lgkmcnt(5)
v_mfma_f32_16x16x32_bf16 v[80:83], a[0:3], v[32:35], 0
ds_read_b128 v[56:59], v23
v_mfma_f32_16x16x32_bf16 v[84:87], a[4:7], v[32:35], 0
s_waitcnt lgkmcnt(5)
v_mfma_f32_16x16x32_bf16 v[88:91], a[0:3], v[36:39], 0
ds_read_b128 v[60:63], v23 offset:4096
v_mfma_f32_16x16x32_bf16 v[92:95], a[4:7], v[36:39], 0
s_waitcnt lgkmcnt(5)
v_mfma_f32_16x16x32_bf16 v[80:83], a[8:11], v[40:43], v[80:83]
ds_read_b128 v[32:35], v20 offset:8192
v_mfma_f32_16x16x32_bf16 v[84:87], a[12:15], v[40:43], v[84:87]
s_add_u32 m0, s21, 9216
s_xor_b32 s20, s23, 256
buffer_load_dwordx4 v7, s[8:11], s20 offen lds
s_waitcnt lgkmcnt(5)
v_mfma_f32_16x16x32_bf16 v[88:91], a[8:11], v[44:47], v[88:91]
ds_read_b128 v[36:39], v20 offset:12288
v_mfma_f32_16x16x32_bf16 v[92:95], a[12:15], v[44:47], v[92:95]
s_waitcnt lgkmcnt(5)
v_mfma_f32_16x16x32_bf16 v[80:83], a[16:19], v[48:51], v[80:83]
ds_read_b128 v[40:43], v21 offset:8192
v_mfma_f32_16x16x32_bf16 v[84:87], a[20:23], v[48:51], v[84:87]
s_waitcnt lgkmcnt(5)
v_mfma_f32_16x16x32_bf16 v[88:91], a[16:19], v[52:55], v[88:91]
ds_read_b128 v[44:47], v21 offset:12288
v_mfma_f32_16x16x32_bf16 v[92:95], a[20:23], v[52:55], v[92:95]
s_add_u32 m0, s21, 16384
s_xor_b32 s20, s23, 512
buffer_load_dwordx4 v6, s[8:11], s20 offen lds
s_waitcnt lgkmcnt(5)
v_mfma_f32_16x16x32_bf16 v[80:83], a[24:27], v[56:59], v[80:83]
ds_read_b128 v[48:51], v22 offset:8192
v_mfma_f32_16x16x32_bf16 v[84:87], a[28:31], v[56:59], v[84:87]
s_waitcnt lgkmcnt(5)
v_mfma_f32_16x16x32_bf16 v[88:91], a[24:27], v[60:63], v[88:91]
ds_read_b128 v[52:55], v22 offset:12288
v_mfma_f32_16x16x32_bf16 v[92:95], a[28:31], v[60:63], v[92:95]
s_waitcnt lgkmcnt(5)
v_mfma_f32_16x16x32_bf16 v[80:83], a[32:35], v[32:35], v[80:83]
ds_read_b128 v[56:59], v23 offset:8192
v_mfma_f32_16x16x32_bf16 v[84:87], a[36:39], v[32:35], v[84:87]
s_add_u32 m0, s21, 17408
s_xor_b32 s20, s23, 512
buffer_load_dwordx4 v7, s[8:11], s20 offen lds
s_waitcnt lgkmcnt(5)
v_mfma_f32_16x16x32_bf16 v[88:91], a[32:35], v[36:39], v[88:91]
ds_read_b128 v[60:63], v23 offset:12288
v_mfma_f32_16x16x32_bf16 v[92:95], a[36:39], v[36:39], v[92:95]
s_waitcnt lgkmcnt(5)
v_mfma_f32_16x16x32_bf16 v[80:83], a[40:43], v[40:43], v[80:83]
ds_read_b128 v[32:35], v20 offset:16384
v_mfma_f32_16x16x32_bf16 v[84:87], a[44:47], v[40:43], v[84:87]
s_waitcnt lgkmcnt(5)
v_mfma_f32_16x16x32_bf16 v[88:91], a[40:43], v[44:47], v[88:91]
ds_read_b128 v[36:39], v20 offset:20480
v_mfma_f32_16x16x32_bf16 v[92:95], a[44:47], v[44:47], v[92:95]
s_add_u32 m0, s21, 24576
s_xor_b32 s20, s23, 768
buffer_load_dwordx4 v6, s[8:11], s20 offen lds
s_waitcnt lgkmcnt(5)
v_mfma_f32_16x16x32_bf16 v[80:83], a[48:51], v[48:51], v[80:83]
ds_read_b128 v[40:43], v21 offset:16384
v_mfma_f32_16x16x32_bf16 v[84:87], a[52:55], v[48:51], v[84:87]
s_waitcnt lgkmcnt(5)
v_mfma_f32_16x16x32_bf16 v[88:91], a[48:51], v[52:55], v[88:91]
ds_read_b128 v[44:47], v21 offset:20480
v_mfma_f32_16x16x32_bf16 v[92:95], a[52:55], v[52:55], v[92:95]
s_waitcnt lgkmcnt(5)
v_mfma_f32_16x16x32_bf16 v[80:83], a[56:59], v[56:59], v[80:83]
ds_read_b128 v[48:51], v22 offset:16384
v_mfma_f32_16x16x32_bf16 v[84:87], a[60:63], v[56:59], v[84:87]
s_add_u32 m0, s21, 25600
s_xor_b32 s20, s23, 768
buffer_load_dwordx4 v7, s[8:11], s20 offen lds
s_waitcnt lgkmcnt(5)
v_mfma_f32_16x16x32_bf16 v[88:91], a[56:59], v[60:63], v[88:91]
ds_read_b128 v[52:55], v22 offset:20480
v_mfma_f32_16x16x32_bf16 v[92:95], a[60:63], v[60:63], v[92:95]
v_cvt_pk_bf16_f32 v96, v64, v65
v_cvt_pk_bf16_f32 v97, v66, v67
s_waitcnt lgkmcnt(5)
v_mfma_f32_16x16x32_bf16 v[80:83], a[64:67], v[32:35], v[80:83]
ds_read_b128 v[56:59], v23 offset:16384
v_mfma_f32_16x16x32_bf16 v[84:87], a[68:71], v[32:35], v[84:87]
v_cvt_pk_bf16_f32 v98, v68, v69
v_cvt_pk_bf16_f32 v99, v70, v71
s_waitcnt lgkmcnt(5)
v_mfma_f32_16x16x32_bf16 v[88:91], a[64:67], v[36:39], v[88:91]
ds_read_b128 v[60:63], v23 offset:20480
v_mfma_f32_16x16x32_bf16 v[92:95], a[68:71], v[36:39], v[92:95]
buffer_store_dwordx4 v[96:99], v8, s[84:87], s24 offen sc1
v_cvt_pk_bf16_f32 v100, v72, v73
s_waitcnt lgkmcnt(5)
v_mfma_f32_16x16x32_bf16 v[80:83], a[72:75], v[40:43], v[80:83]
ds_read_b128 v[32:35], v20 offset:24576
v_mfma_f32_16x16x32_bf16 v[84:87], a[76:79], v[40:43], v[84:87]
v_cvt_pk_bf16_f32 v101, v74, v75
v_cvt_pk_bf16_f32 v102, v76, v77
s_waitcnt lgkmcnt(5)
v_mfma_f32_16x16x32_bf16 v[88:91], a[72:75], v[44:47], v[88:91]
ds_read_b128 v[36:39], v20 offset:28672
v_mfma_f32_16x16x32_bf16 v[92:95], a[76:79], v[44:47], v[92:95]
v_cvt_pk_bf16_f32 v103, v78, v79
buffer_store_dwordx4 v[100:103], v8, s[84:87], s24 offen offset:1024 sc1
s_waitcnt lgkmcnt(5)
v_mfma_f32_16x16x32_bf16 v[80:83], a[80:83], v[48:51], v[80:83]
ds_read_b128 v[40:43], v21 offset:24576
v_mfma_f32_16x16x32_bf16 v[84:87], a[84:87], v[48:51], v[84:87]
s_add_u32 s24, s24, 524288
s_waitcnt lgkmcnt(5)
v_mfma_f32_16x16x32_bf16 v[88:91], a[80:83], v[52:55], v[88:91]
ds_read_b128 v[44:47], v21 offset:28672
v_mfma_f32_16x16x32_bf16 v[92:95], a[84:87], v[52:55], v[92:95]
s_waitcnt lgkmcnt(5)
v_mfma_f32_16x16x32_bf16 v[80:83], a[88:91], v[56:59], v[80:83]
ds_read_b128 v[48:51], v22 offset:24576
v_mfma_f32_16x16x32_bf16 v[84:87], a[92:95], v[56:59], v[84:87]
s_waitcnt lgkmcnt(5)
v_mfma_f32_16x16x32_bf16 v[88:91], a[88:91], v[60:63], v[88:91]
ds_read_b128 v[52:55], v22 offset:28672
v_mfma_f32_16x16x32_bf16 v[92:95], a[92:95], v[60:63], v[92:95]
s_waitcnt vmcnt(8)
s_barrier
s_waitcnt lgkmcnt(5)
v_mfma_f32_16x16x32_bf16 v[80:83], a[96:99], v[32:35], v[80:83]
ds_read_b128 v[56:59], v23 offset:24576
v_mfma_f32_16x16x32_bf16 v[84:87], a[100:103], v[32:35], v[84:87]
s_waitcnt lgkmcnt(5)
v_mfma_f32_16x16x32_bf16 v[88:91], a[96:99], v[36:39], v[88:91]
ds_read_b128 v[60:63], v23 offset:28672
v_mfma_f32_16x16x32_bf16 v[92:95], a[100:103], v[36:39], v[92:95]
s_add_u32 m0, s21, 32768
s_xor_b32 s20, s23, 1024
buffer_load_dwordx4 v6, s[8:11], s20 offen lds
s_waitcnt lgkmcnt(5)
v_mfma_f32_16x16x32_bf16 v[80:83], a[104:107], v[40:43], v[80:83]
ds_read_b128 v[32:35], v20 offset:32768
v_mfma_f32_16x16x32_bf16 v[84:87], a[108:111], v[40:43], v[84:87]
s_waitcnt lgkmcnt(5)
v_mfma_f32_16x16x32_bf16 v[88:91], a[104:107], v[44:47], v[88:91]
ds_read_b128 v[36:39], v20 offset:36864
v_mfma_f32_16x16x32_bf16 v[92:95], a[108:111], v[44:47], v[92:95]
s_waitcnt lgkmcnt(5)
v_mfma_f32_16x16x32_bf16 v[80:83], a[112:115], v[48:51], v[80:83]
ds_read_b128 v[40:43], v21 offset:32768
v_mfma_f32_16x16x32_bf16 v[84:87], a[116:119], v[48:51], v[84:87]
s_add_u32 m0, s21, 33792
s_xor_b32 s20, s23, 1024
buffer_load_dwordx4 v7, s[8:11], s20 offen lds
s_waitcnt lgkmcnt(5)
v_mfma_f32_16x16x32_bf16 v[88:91], a[112:115], v[52:55], v[88:91]
ds_read_b128 v[44:47], v21 offset:36864
v_mfma_f32_16x16x32_bf16 v[92:95], a[116:119], v[52:55], v[92:95]
s_waitcnt lgkmcnt(5)
v_mfma_f32_16x16x32_bf16 v[80:83], a[120:123], v[56:59], v[80:83]
ds_read_b128 v[48:51], v22 offset:32768
v_mfma_f32_16x16x32_bf16 v[84:87], a[124:127], v[56:59], v[84:87]
s_waitcnt lgkmcnt(5)
v_mfma_f32_16x16x32_bf16 v[88:91], a[120:123], v[60:63], v[88:91]
ds_read_b128 v[52:55], v22 offset:36864
v_mfma_f32_16x16x32_bf16 v[92:95], a[124:127], v[60:63], v[92:95]
s_add_u32 m0, s21, 40960
s_xor_b32 s20, s23, 1280
buffer_load_dwordx4 v6, s[8:11], s20 offen lds
s_waitcnt lgkmcnt(5)
v_mfma_f32_16x16x32_bf16 v[80:83], a[128:131], v[32:35], v[80:83]
ds_read_b128 v[56:59], v23 offset:32768
v_mfma_f32_16x16x32_bf16 v[84:87], a[132:135], v[32:35], v[84:87]
s_waitcnt lgkmcnt(5)
v_mfma_f32_16x16x32_bf16 v[88:91], a[128:131], v[36:39], v[88:91]
ds_read_b128 v[60:63], v23 offset:36864
v_mfma_f32_16x16x32_bf16 v[92:95], a[132:135], v[36:39], v[92:95]
s_waitcnt lgkmcnt(5)
v_mfma_f32_16x16x32_bf16 v[80:83], a[136:139], v[40:43], v[80:83]
ds_read_b128 v[32:35], v20 offset:40960
v_mfma_f32_16x16x32_bf16 v[84:87], a[140:143], v[40:43], v[84:87]
s_add_u32 m0, s21, 41984
s_xor_b32 s20, s23, 1280
buffer_load_dwordx4 v7, s[8:11], s20 offen lds
s_waitcnt lgkmcnt(5)
v_mfma_f32_16x16x32_bf16 v[88:91], a[136:139], v[44:47], v[88:91]
ds_read_b128 v[36:39], v20 offset:45056
v_mfma_f32_16x16x32_bf16 v[92:95], a[140:143], v[44:47], v[92:95]
s_waitcnt lgkmcnt(5)
v_mfma_f32_16x16x32_bf16 v[80:83], a[144:147], v[48:51], v[80:83]
ds_read_b128 v[40:43], v21 offset:40960
v_mfma_f32_16x16x32_bf16 v[84:87], a[148:151], v[48:51], v[84:87]
s_waitcnt lgkmcnt(5)
v_mfma_f32_16x16x32_bf16 v[88:91], a[144:147], v[52:55], v[88:91]
ds_read_b128 v[44:47], v21 offset:45056
v_mfma_f32_16x16x32_bf16 v[92:95], a[148:151], v[52:55], v[92:95]
s_add_u32 m0, s21, 49152
s_xor_b32 s20, s23, 1536
buffer_load_dwordx4 v6, s[8:11], s20 offen lds
s_waitcnt lgkmcnt(5)
v_mfma_f32_16x16x32_bf16 v[80:83], a[152:155], v[56:59], v[80:83]
ds_read_b128 v[48:51], v22 offset:40960
v_mfma_f32_16x16x32_bf16 v[84:87], a[156:159], v[56:59], v[84:87]
s_waitcnt lgkmcnt(5)
v_mfma_f32_16x16x32_bf16 v[88:91], a[152:155], v[60:63], v[88:91]
ds_read_b128 v[52:55], v22 offset:45056
v_mfma_f32_16x16x32_bf16 v[92:95], a[156:159], v[60:63], v[92:95]
s_waitcnt lgkmcnt(5)
v_mfma_f32_16x16x32_bf16 v[80:83], a[160:163], v[32:35], v[80:83]
ds_read_b128 v[56:59], v23 offset:40960
v_mfma_f32_16x16x32_bf16 v[84:87], a[164:167], v[32:35], v[84:87]
s_add_u32 m0, s21, 50176
s_xor_b32 s20, s23, 1536
buffer_load_dwordx4 v7, s[8:11], s20 offen lds
s_waitcnt lgkmcnt(5)
v_mfma_f32_16x16x32_bf16 v[88:91], a[160:163], v[36:39], v[88:91]
ds_read_b128 v[60:63], v23 offset:45056
v_mfma_f32_16x16x32_bf16 v[92:95], a[164:167], v[36:39], v[92:95]
s_waitcnt lgkmcnt(5)
v_mfma_f32_16x16x32_bf16 v[80:83], a[168:171], v[40:43], v[80:83]
ds_read_b128 v[32:35], v20 offset:49152
v_mfma_f32_16x16x32_bf16 v[84:87], a[172:175], v[40:43], v[84:87]
s_waitcnt lgkmcnt(5)
v_mfma_f32_16x16x32_bf16 v[88:91], a[168:171], v[44:47], v[88:91]
ds_read_b128 v[36:39], v20 offset:53248
v_mfma_f32_16x16x32_bf16 v[92:95], a[172:175], v[44:47], v[92:95]
s_add_u32 m0, s21, 57344
s_xor_b32 s20, s23, 1792
buffer_load_dwordx4 v6, s[8:11], s20 offen lds
s_waitcnt lgkmcnt(5)
v_mfma_f32_16x16x32_bf16 v[80:83], a[176:179], v[48:51], v[80:83]
ds_read_b128 v[40:43], v21 offset:49152
v_mfma_f32_16x16x32_bf16 v[84:87], a[180:183], v[48:51], v[84:87]
s_waitcnt lgkmcnt(5)
v_mfma_f32_16x16x32_bf16 v[88:91], a[176:179], v[52:55], v[88:91]
ds_read_b128 v[44:47], v21 offset:53248
v_mfma_f32_16x16x32_bf16 v[92:95], a[180:183], v[52:55], v[92:95]
s_waitcnt lgkmcnt(5)
v_mfma_f32_16x16x32_bf16 v[80:83], a[184:187], v[56:59], v[80:83]
ds_read_b128 v[48:51], v22 offset:49152
v_mfma_f32_16x16x32_bf16 v[84:87], a[188:191], v[56:59], v[84:87]
s_add_u32 m0, s21, 58368
s_xor_b32 s20, s23, 1792
buffer_load_dwordx4 v7, s[8:11], s20 offen lds
s_waitcnt lgkmcnt(5)
v_mfma_f32_16x16x32_bf16 v[88:91], a[184:187], v[60:63], v[88:91]
ds_read_b128 v[52:55], v22 offset:53248
v_mfma_f32_16x16x32_bf16 v[92:95], a[188:191], v[60:63], v[92:95]
s_waitcnt lgkmcnt(5)
v_mfma_f32_16x16x32_bf16 v[80:83], a[192:195], v[32:35], v[80:83]
ds_read_b128 v[56:59], v23 offset:49152
v_mfma_f32_16x16x32_bf16 v[84:87], a[196:199], v[32:35], v[84:87]
s_waitcnt lgkmcnt(5)
v_mfma_f32_16x16x32_bf16 v[88:91], a[192:195], v[36:39], v[88:91]
ds_read_b128 v[60:63], v23 offset:53248
v_mfma_f32_16x16x32_bf16 v[92:95], a[196:199], v[36:39], v[92:95]
s_waitcnt lgkmcnt(5)
v_mfma_f32_16x16x32_bf16 v[80:83], a[200:203], v[40:43], v[80:83]
ds_read_b128 v[32:35], v20 offset:57344
v_mfma_f32_16x16x32_bf16 v[84:87], a[204:207], v[40:43], v[84:87]
s_waitcnt lgkmcnt(5)
v_mfma_f32_16x16x32_bf16 v[88:91], a[200:203], v[44:47], v[88:91]
ds_read_b128 v[36:39], v20 offset:61440
v_mfma_f32_16x16x32_bf16 v[92:95], a[204:207], v[44:47], v[92:95]
s_waitcnt lgkmcnt(5)
v_mfma_f32_16x16x32_bf16 v[80:83], a[208:211], v[48:51], v[80:83]
ds_read_b128 v[40:43], v21 offset:57344
v_mfma_f32_16x16x32_bf16 v[84:87], a[212:215], v[48:51], v[84:87]
s_waitcnt lgkmcnt(5)
v_mfma_f32_16x16x32_bf16 v[88:91], a[208:211], v[52:55], v[88:91]
ds_read_b128 v[44:47], v21 offset:61440
v_mfma_f32_16x16x32_bf16 v[92:95], a[212:215], v[52:55], v[92:95]
s_waitcnt lgkmcnt(5)
v_mfma_f32_16x16x32_bf16 v[80:83], a[216:219], v[56:59], v[80:83]
ds_read_b128 v[48:51], v22 offset:57344
v_mfma_f32_16x16x32_bf16 v[84:87], a[220:223], v[56:59], v[84:87]
s_waitcnt lgkmcnt(5)
v_mfma_f32_16x16x32_bf16 v[88:91], a[216:219], v[60:63], v[88:91]
ds_read_b128 v[52:55], v22 offset:61440
v_mfma_f32_16x16x32_bf16 v[92:95], a[220:223], v[60:63], v[92:95]
s_waitcnt vmcnt(8)
s_barrier
s_waitcnt lgkmcnt(5)
v_mfma_f32_16x16x32_bf16 v[80:83], a[224:227], v[32:35], v[80:83]
ds_read_b128 v[56:59], v23 offset:57344
v_mfma_f32_16x16x32_bf16 v[84:87], a[228:231], v[32:35], v[84:87]
s_waitcnt lgkmcnt(5)
v_mfma_f32_16x16x32_bf16 v[88:91], a[224:227], v[36:39], v[88:91]
ds_read_b128 v[60:63], v23 offset:61440
v_mfma_f32_16x16x32_bf16 v[92:95], a[228:231], v[36:39], v[92:95]
s_add_u32 s23, s23, 131072
s_add_u32 m0, s21, 65536
s_xor_b32 s20, s23, 0
buffer_load_dwordx4 v6, s[8:11], s20 offen lds
s_waitcnt lgkmcnt(5)
v_mfma_f32_16x16x32_bf16 v[80:83], a[232:235], v[40:43], v[80:83]
ds_read_b128 v[32:35], v16
v_mfma_f32_16x16x32_bf16 v[84:87], a[236:239], v[40:43], v[84:87]
v_add_u32 v10, 1, v10
buffer_store_dword v10, v9, s[84:87], 0 offen sc1
s_waitcnt lgkmcnt(5)
v_mfma_f32_16x16x32_bf16 v[88:91], a[232:235], v[44:47], v[88:91]
ds_read_b128 v[36:39], v16 offset:4096
v_mfma_f32_16x16x32_bf16 v[92:95], a[236:239], v[44:47], v[92:95]
s_waitcnt lgkmcnt(5)
v_mfma_f32_16x16x32_bf16 v[80:83], a[240:243], v[48:51], v[80:83]
ds_read_b128 v[40:43], v17
v_mfma_f32_16x16x32_bf16 v[84:87], a[244:247], v[48:51], v[84:87]
s_add_u32 m0, s21, 66560
s_xor_b32 s20, s23, 0
buffer_load_dwordx4 v7, s[8:11], s20 offen lds
s_waitcnt lgkmcnt(5)
v_mfma_f32_16x16x32_bf16 v[88:91], a[240:243], v[52:55], v[88:91]
ds_read_b128 v[44:47], v17 offset:4096
v_mfma_f32_16x16x32_bf16 v[92:95], a[244:247], v[52:55], v[92:95]
s_waitcnt lgkmcnt(5)
v_mfma_f32_16x16x32_bf16 v[80:83], a[248:251], v[56:59], v[80:83]
ds_read_b128 v[48:51], v18
v_mfma_f32_16x16x32_bf16 v[84:87], a[252:255], v[56:59], v[84:87]
s_waitcnt lgkmcnt(5)
v_mfma_f32_16x16x32_bf16 v[88:91], a[248:251], v[60:63], v[88:91]
ds_read_b128 v[52:55], v18 offset:4096
v_mfma_f32_16x16x32_bf16 v[92:95], a[252:255], v[60:63], v[92:95]
s_add_u32 m0, s21, 73728
s_xor_b32 s20, s23, 256
buffer_load_dwordx4 v6, s[8:11], s20 offen lds
s_add_u32 s25, s25, 1
s_cmp_lt_u32 s25, 16
s_cbranch_scc1 L_q_qk_loop
s_nop 11
v_cvt_pk_bf16_f32 v96, v80, v81
v_cvt_pk_bf16_f32 v97, v82, v83
v_cvt_pk_bf16_f32 v98, v84, v85
v_cvt_pk_bf16_f32 v99, v86, v87
buffer_store_dwordx4 v[96:99], v8, s[84:87], s24 offen sc1
v_cvt_pk_bf16_f32 v100, v88, v89
v_cvt_pk_bf16_f32 v101, v90, v91
v_cvt_pk_bf16_f32 v102, v92, v93
v_cvt_pk_bf16_f32 v103, v94, v95
buffer_store_dwordx4 v[100:103], v8, s[84:87], s24 offen offset:1024 sc1
s_add_u32 s24, s24, 524288
s_waitcnt vmcnt(0) lgkmcnt(0)
s_barrier
v_add_u32 v10, 1, v10
buffer_store_dword v10, v9, s[84:87], 0 offen sc1
s_branch L_q_done
L_q_v:
ds_read_b128 v[32:35], v16
ds_read_b128 v[36:39], v16 offset:4096
ds_read_b128 v[40:43], v17
ds_read_b128 v[44:47], v17 offset:4096
ds_read_b128 v[48:51], v18
ds_read_b128 v[52:55], v18 offset:4096
s_mov_b32 s25, 0
L_q_v_loop:
s_waitcnt lgkmcnt(5)
v_mfma_f32_16x16x32_bf16 v[64:67], v[32:35], a[0:3], 0
ds_read_b128 v[56:59], v19
v_mfma_f32_16x16x32_bf16 v[68:71], v[32:35], a[4:7], 0
s_waitcnt lgkmcnt(5)
v_mfma_f32_16x16x32_bf16 v[72:75], v[36:39], a[0:3], 0
ds_read_b128 v[60:63], v19 offset:4096
v_mfma_f32_16x16x32_bf16 v[76:79], v[36:39], a[4:7], 0
s_waitcnt lgkmcnt(5)
v_mfma_f32_16x16x32_bf16 v[64:67], v[40:43], a[8:11], v[64:67]
ds_read_b128 v[32:35], v16 offset:8192
v_mfma_f32_16x16x32_bf16 v[68:71], v[40:43], a[12:15], v[68:71]
s_cmp_eq_u32 s25, 0
s_cbranch_scc1 L_q_v_sk2
s_add_u32 m0, s21, 74752
s_xor_b32 s20, s23, 256
buffer_load_dwordx4 v7, s[8:11], s20 offen lds
L_q_v_sk2:
s_waitcnt lgkmcnt(5)
v_mfma_f32_16x16x32_bf16 v[72:75], v[44:47], a[8:11], v[72:75]
ds_read_b128 v[36:39], v16 offset:12288
v_mfma_f32_16x16x32_bf16 v[76:79], v[44:47], a[12:15], v[76:79]
s_waitcnt lgkmcnt(5)
v_mfma_f32_16x16x32_bf16 v[64:67], v[48:51], a[16:19], v[64:67]
ds_read_b128 v[40:43], v17 offset:8192
v_mfma_f32_16x16x32_bf16 v[68:71], v[48:51], a[20:23], v[68:71]
s_waitcnt lgkmcnt(5)
v_mfma_f32_16x16x32_bf16 v[72:75], v[52:55], a[16:19], v[72:75]
ds_read_b128 v[44:47], v17 offset:12288
v_mfma_f32_16x16x32_bf16 v[76:79], v[52:55], a[20:23], v[76:79]
s_cmp_eq_u32 s25, 0
s_cbranch_scc1 L_q_v_sk5
s_add_u32 m0, s21, 81920
s_xor_b32 s20, s23, 512
buffer_load_dwordx4 v6, s[8:11], s20 offen lds
L_q_v_sk5:
s_waitcnt lgkmcnt(5)
v_mfma_f32_16x16x32_bf16 v[64:67], v[56:59], a[24:27], v[64:67]
ds_read_b128 v[48:51], v18 offset:8192
v_mfma_f32_16x16x32_bf16 v[68:71], v[56:59], a[28:31], v[68:71]
s_waitcnt lgkmcnt(5)
v_mfma_f32_16x16x32_bf16 v[72:75], v[60:63], a[24:27], v[72:75]
ds_read_b128 v[52:55], v18 offset:12288
v_mfma_f32_16x16x32_bf16 v[76:79], v[60:63], a[28:31], v[76:79]
s_waitcnt lgkmcnt(5)
v_mfma_f32_16x16x32_bf16 v[64:67], v[32:35], a[32:35], v[64:67]
ds_read_b128 v[56:59], v19 offset:8192
v_mfma_f32_16x16x32_bf16 v[68:71], v[32:35], a[36:39], v[68:71]
s_cmp_eq_u32 s25, 0
s_cbranch_scc1 L_q_v_sk8
s_add_u32 m0, s21, 82944
s_xor_b32 s20, s23, 512
buffer_load_dwordx4 v7, s[8:11], s20 offen lds
L_q_v_sk8:
s_waitcnt lgkmcnt(5)
v_mfma_f32_16x16x32_bf16 v[72:75], v[36:39], a[32:35], v[72:75]
ds_read_b128 v[60:63], v19 offset:12288
v_mfma_f32_16x16x32_bf16 v[76:79], v[36:39], a[36:39], v[76:79]
s_waitcnt lgkmcnt(5)
v_mfma_f32_16x16x32_bf16 v[64:67], v[40:43], a[40:43], v[64:67]
ds_read_b128 v[32:35], v16 offset:16384
v_mfma_f32_16x16x32_bf16 v[68:71], v[40:43], a[44:47], v[68:71]
s_waitcnt lgkmcnt(5)
v_mfma_f32_16x16x32_bf16 v[72:75], v[44:47], a[40:43], v[72:75]
ds_read_b128 v[36:39], v16 offset:20480
v_mfma_f32_16x16x32_bf16 v[76:79], v[44:47], a[44:47], v[76:79]
s_cmp_eq_u32 s25, 0
s_cbranch_scc1 L_q_v_sk11
s_add_u32 m0, s21, 90112
s_xor_b32 s20, s23, 768
buffer_load_dwordx4 v6, s[8:11], s20 offen lds
L_q_v_sk11:
s_waitcnt lgkmcnt(5)
v_mfma_f32_16x16x32_bf16 v[64:67], v[48:51], a[48:51], v[64:67]
ds_read_b128 v[40:43], v17 offset:16384
v_mfma_f32_16x16x32_bf16 v[68:71], v[48:51], a[52:55], v[68:71]
s_waitcnt lgkmcnt(5)
v_mfma_f32_16x16x32_bf16 v[72:75], v[52:55], a[48:51], v[72:75]
ds_read_b128 v[44:47], v17 offset:20480
v_mfma_f32_16x16x32_bf16 v[76:79], v[52:55], a[52:55], v[76:79]
s_waitcnt lgkmcnt(5)
v_mfma_f32_16x16x32_bf16 v[64:67], v[56:59], a[56:59], v[64:67]
ds_read_b128 v[48:51], v18 offset:16384
v_mfma_f32_16x16x32_bf16 v[68:71], v[56:59], a[60:63], v[68:71]
s_cmp_eq_u32 s25, 0
s_cbranch_scc1 L_q_v_sk14
s_add_u32 m0, s21, 91136
s_xor_b32 s20, s23, 768
buffer_load_dwordx4 v7, s[8:11], s20 offen lds
L_q_v_sk14:
s_waitcnt lgkmcnt(5)
v_mfma_f32_16x16x32_bf16 v[72:75], v[60:63], a[56:59], v[72:75]
ds_read_b128 v[52:55], v18 offset:20480
v_mfma_f32_16x16x32_bf16 v[76:79], v[60:63], a[60:63], v[76:79]
s_cmp_eq_u32 s25, 0
s_cbranch_scc1 L_q_v_ne0
v_cvt_pk_bf16_f32 v96, v80, v81
v_cvt_pk_bf16_f32 v97, v82, v83
L_q_v_ne0:
s_waitcnt lgkmcnt(5)
v_mfma_f32_16x16x32_bf16 v[64:67], v[32:35], a[64:67], v[64:67]
ds_read_b128 v[56:59], v19 offset:16384
v_mfma_f32_16x16x32_bf16 v[68:71], v[32:35], a[68:71], v[68:71]
s_cmp_eq_u32 s25, 0
s_cbranch_scc1 L_q_v_ne1
v_cvt_pk_bf16_f32 v98, v88, v89
v_cvt_pk_bf16_f32 v99, v90, v91
L_q_v_ne1:
s_waitcnt lgkmcnt(5)
v_mfma_f32_16x16x32_bf16 v[72:75], v[36:39], a[64:67], v[72:75]
ds_read_b128 v[60:63], v19 offset:20480
v_mfma_f32_16x16x32_bf16 v[76:79], v[36:39], a[68:71], v[76:79]
s_cmp_eq_u32 s25, 0
s_cbranch_scc1 L_q_v_ne2
buffer_store_dwordx4 v[96:99], v8, s[84:87], s24 offen sc1
v_cvt_pk_bf16_f32 v100, v84, v85
L_q_v_ne2:
s_waitcnt lgkmcnt(5)
v_mfma_f32_16x16x32_bf16 v[64:67], v[40:43], a[72:75], v[64:67]
ds_read_b128 v[32:35], v16 offset:24576
v_mfma_f32_16x16x32_bf16 v[68:71], v[40:43], a[76:79], v[68:71]
s_cmp_eq_u32 s25, 0
s_cbranch_scc1 L_q_v_ne3
v_cvt_pk_bf16_f32 v101, v86, v87
v_cvt_pk_bf16_f32 v102, v92, v93
L_q_v_ne3:
s_waitcnt lgkmcnt(5)
v_mfma_f32_16x16x32_bf16 v[72:75], v[44:47], a[72:75], v[72:75]
ds_read_b128 v[36:39], v16 offset:28672
v_mfma_f32_16x16x32_bf16 v[76:79], v[44:47], a[76:79], v[76:79]
s_cmp_eq_u32 s25, 0
s_cbranch_scc1 L_q_v_ne4
v_cvt_pk_bf16_f32 v103, v94, v95
buffer_store_dwordx4 v[100:103], v8, s[84:87], s24 offen offset:1024 sc1
L_q_v_ne4:
s_waitcnt lgkmcnt(5)
v_mfma_f32_16x16x32_bf16 v[64:67], v[48:51], a[80:83], v[64:67]
ds_read_b128 v[40:43], v17 offset:24576
v_mfma_f32_16x16x32_bf16 v[68:71], v[48:51], a[84:87], v[68:71]
s_cmp_eq_u32 s25, 0
s_cbranch_scc1 L_q_v_ne5
s_add_u32 s24, s24, 524288
L_q_v_ne5:
s_waitcnt lgkmcnt(5)
v_mfma_f32_16x16x32_bf16 v[72:75], v[52:55], a[80:83], v[72:75]
ds_read_b128 v[44:47], v17 offset:28672
v_mfma_f32_16x16x32_bf16 v[76:79], v[52:55], a[84:87], v[76:79]
s_waitcnt lgkmcnt(5)
v_mfma_f32_16x16x32_bf16 v[64:67], v[56:59], a[88:91], v[64:67]
ds_read_b128 v[48:51], v18 offset:24576
v_mfma_f32_16x16x32_bf16 v[68:71], v[56:59], a[92:95], v[68:71]
s_cmp_lg_u32 s25, 2
s_cbranch_scc1 L_q_v_nx
v_lshlrev_b32 v242, 7, v0
s_mul_i32 s46, s92, 32768
s_sub_u32 s46, s46, 2097152
buffer_load_dword v240, v242, s[8:11], s46 offen
L_q_v_nx:
s_waitcnt lgkmcnt(5)
v_mfma_f32_16x16x32_bf16 v[72:75], v[60:63], a[88:91], v[72:75]
ds_read_b128 v[52:55], v18 offset:28672
v_mfma_f32_16x16x32_bf16 v[76:79], v[60:63], a[92:95], v[76:79]
s_waitcnt vmcnt(8)
s_barrier
s_waitcnt lgkmcnt(5)
v_mfma_f32_16x16x32_bf16 v[64:67], v[32:35], a[96:99], v[64:67]
ds_read_b128 v[56:59], v19 offset:24576
v_mfma_f32_16x16x32_bf16 v[68:71], v[32:35], a[100:103], v[68:71]
s_waitcnt lgkmcnt(5)
v_mfma_f32_16x16x32_bf16 v[72:75], v[36:39], a[96:99], v[72:75]
ds_read_b128 v[60:63], v19 offset:28672
v_mfma_f32_16x16x32_bf16 v[76:79], v[36:39], a[100:103], v[76:79]
s_add_u32 m0, s21, 98304
s_xor_b32 s20, s23, 1024
buffer_load_dwordx4 v6, s[8:11], s20 offen lds
s_waitcnt lgkmcnt(5)
v_mfma_f32_16x16x32_bf16 v[64:67], v[40:43], a[104:107], v[64:67]
ds_read_b128 v[32:35], v16 offset:32768
v_mfma_f32_16x16x32_bf16 v[68:71], v[40:43], a[108:111], v[68:71]
s_waitcnt lgkmcnt(5)
v_mfma_f32_16x16x32_bf16 v[72:75], v[44:47], a[104:107], v[72:75]
ds_read_b128 v[36:39], v16 offset:36864
v_mfma_f32_16x16x32_bf16 v[76:79], v[44:47], a[108:111], v[76:79]
s_waitcnt lgkmcnt(5)
v_mfma_f32_16x16x32_bf16 v[64:67], v[48:51], a[112:115], v[64:67]
ds_read_b128 v[40:43], v17 offset:32768
v_mfma_f32_16x16x32_bf16 v[68:71], v[48:51], a[116:119], v[68:71]
s_add_u32 m0, s21, 99328
s_xor_b32 s20, s23, 1024
buffer_load_dwordx4 v7, s[8:11], s20 offen lds
s_waitcnt lgkmcnt(5)
v_mfma_f32_16x16x32_bf16 v[72:75], v[52:55], a[112:115], v[72:75]
ds_read_b128 v[44:47], v17 offset:36864
v_mfma_f32_16x16x32_bf16 v[76:79], v[52:55], a[116:119], v[76:79]
s_waitcnt lgkmcnt(5)
v_mfma_f32_16x16x32_bf16 v[64:67], v[56:59], a[120:123], v[64:67]
ds_read_b128 v[48:51], v18 offset:32768
v_mfma_f32_16x16x32_bf16 v[68:71], v[56:59], a[124:127], v[68:71]
s_waitcnt lgkmcnt(5)
v_mfma_f32_16x16x32_bf16 v[72:75], v[60:63], a[120:123], v[72:75]
ds_read_b128 v[52:55], v18 offset:36864
v_mfma_f32_16x16x32_bf16 v[76:79], v[60:63], a[124:127], v[76:79]
s_add_u32 m0, s21, 106496
s_xor_b32 s20, s23, 1280
buffer_load_dwordx4 v6, s[8:11], s20 offen lds
s_waitcnt lgkmcnt(5)
v_mfma_f32_16x16x32_bf16 v[64:67], v[32:35], a[128:131], v[64:67]
ds_read_b128 v[56:59], v19 offset:32768
v_mfma_f32_16x16x32_bf16 v[68:71], v[32:35], a[132:135], v[68:71]
s_waitcnt lgkmcnt(5)
v_mfma_f32_16x16x32_bf16 v[72:75], v[36:39], a[128:131], v[72:75]
ds_read_b128 v[60:63], v19 offset:36864
v_mfma_f32_16x16x32_bf16 v[76:79], v[36:39], a[132:135], v[76:79]
s_waitcnt lgkmcnt(5)
v_mfma_f32_16x16x32_bf16 v[64:67], v[40:43], a[136:139], v[64:67]
ds_read_b128 v[32:35], v16 offset:40960
v_mfma_f32_16x16x32_bf16 v[68:71], v[40:43], a[140:143], v[68:71]
s_add_u32 m0, s21, 107520
s_xor_b32 s20, s23, 1280
buffer_load_dwordx4 v7, s[8:11], s20 offen lds
s_waitcnt lgkmcnt(5)
v_mfma_f32_16x16x32_bf16 v[72:75], v[44:47], a[136:139], v[72:75]
ds_read_b128 v[36:39], v16 offset:45056
v_mfma_f32_16x16x32_bf16 v[76:79], v[44:47], a[140:143], v[76:79]
s_waitcnt lgkmcnt(5)
v_mfma_f32_16x16x32_bf16 v[64:67], v[48:51], a[144:147], v[64:67]
ds_read_b128 v[40:43], v17 offset:40960
v_mfma_f32_16x16x32_bf16 v[68:71], v[48:51], a[148:151], v[68:71]
s_waitcnt lgkmcnt(5)
v_mfma_f32_16x16x32_bf16 v[72:75], v[52:55], a[144:147], v[72:75]
ds_read_b128 v[44:47], v17 offset:45056
v_mfma_f32_16x16x32_bf16 v[76:79], v[52:55], a[148:151], v[76:79]
s_add_u32 m0, s21, 114688
s_xor_b32 s20, s23, 1536
buffer_load_dwordx4 v6, s[8:11], s20 offen lds
s_waitcnt lgkmcnt(5)
v_mfma_f32_16x16x32_bf16 v[64:67], v[56:59], a[152:155], v[64:67]
ds_read_b128 v[48:51], v18 offset:40960
v_mfma_f32_16x16x32_bf16 v[68:71], v[56:59], a[156:159], v[68:71]
s_waitcnt lgkmcnt(5)
v_mfma_f32_16x16x32_bf16 v[72:75], v[60:63], a[152:155], v[72:75]
ds_read_b128 v[52:55], v18 offset:45056
v_mfma_f32_16x16x32_bf16 v[76:79], v[60:63], a[156:159], v[76:79]
s_waitcnt lgkmcnt(5)
v_mfma_f32_16x16x32_bf16 v[64:67], v[32:35], a[160:163], v[64:67]
ds_read_b128 v[56:59], v19 offset:40960
v_mfma_f32_16x16x32_bf16 v[68:71], v[32:35], a[164:167], v[68:71]
s_add_u32 m0, s21, 115712
s_xor_b32 s20, s23, 1536
buffer_load_dwordx4 v7, s[8:11], s20 offen lds
s_waitcnt lgkmcnt(5)
v_mfma_f32_16x16x32_bf16 v[72:75], v[36:39], a[160:163], v[72:75]
ds_read_b128 v[60:63], v19 offset:45056
v_mfma_f32_16x16x32_bf16 v[76:79], v[36:39], a[164:167], v[76:79]
s_waitcnt lgkmcnt(5)
v_mfma_f32_16x16x32_bf16 v[64:67], v[40:43], a[168:171], v[64:67]
ds_read_b128 v[32:35], v16 offset:49152
v_mfma_f32_16x16x32_bf16 v[68:71], v[40:43], a[172:175], v[68:71]
s_waitcnt lgkmcnt(5)
v_mfma_f32_16x16x32_bf16 v[72:75], v[44:47], a[168:171], v[72:75]
ds_read_b128 v[36:39], v16 offset:53248
v_mfma_f32_16x16x32_bf16 v[76:79], v[44:47], a[172:175], v[76:79]
s_add_u32 m0, s21, 122880
s_xor_b32 s20, s23, 1792
buffer_load_dwordx4 v6, s[8:11], s20 offen lds
s_waitcnt lgkmcnt(5)
v_mfma_f32_16x16x32_bf16 v[64:67], v[48:51], a[176:179], v[64:67]
ds_read_b128 v[40:43], v17 offset:49152
v_mfma_f32_16x16x32_bf16 v[68:71], v[48:51], a[180:183], v[68:71]
s_waitcnt lgkmcnt(5)
v_mfma_f32_16x16x32_bf16 v[72:75], v[52:55], a[176:179], v[72:75]
ds_read_b128 v[44:47], v17 offset:53248
v_mfma_f32_16x16x32_bf16 v[76:79], v[52:55], a[180:183], v[76:79]
s_waitcnt lgkmcnt(5)
v_mfma_f32_16x16x32_bf16 v[64:67], v[56:59], a[184:187], v[64:67]
ds_read_b128 v[48:51], v18 offset:49152
v_mfma_f32_16x16x32_bf16 v[68:71], v[56:59], a[188:191], v[68:71]
s_add_u32 m0, s21, 123904
s_xor_b32 s20, s23, 1792
buffer_load_dwordx4 v7, s[8:11], s20 offen lds
s_waitcnt lgkmcnt(5)
v_mfma_f32_16x16x32_bf16 v[72:75], v[60:63], a[184:187], v[72:75]
ds_read_b128 v[52:55], v18 offset:53248
v_mfma_f32_16x16x32_bf16 v[76:79], v[60:63], a[188:191], v[76:79]
s_waitcnt lgkmcnt(5)
v_mfma_f32_16x16x32_bf16 v[64:67], v[32:35], a[192:195], v[64:67]
ds_read_b128 v[56:59], v19 offset:49152
v_mfma_f32_16x16x32_bf16 v[68:71], v[32:35], a[196:199], v[68:71]
s_waitcnt lgkmcnt(5)
v_mfma_f32_16x16x32_bf16 v[72:75], v[36:39], a[192:195], v[72:75]
ds_read_b128 v[60:63], v19 offset:53248
v_mfma_f32_16x16x32_bf16 v[76:79], v[36:39], a[196:199], v[76:79]
s_waitcnt lgkmcnt(5)
v_mfma_f32_16x16x32_bf16 v[64:67], v[40:43], a[200:203], v[64:67]
ds_read_b128 v[32:35], v16 offset:57344
v_mfma_f32_16x16x32_bf16 v[68:71], v[40:43], a[204:207], v[68:71]
s_waitcnt lgkmcnt(5)
v_mfma_f32_16x16x32_bf16 v[72:75], v[44:47], a[200:203], v[72:75]
ds_read_b128 v[36:39], v16 offset:61440
v_mfma_f32_16x16x32_bf16 v[76:79], v[44:47], a[204:207], v[76:79]
s_waitcnt lgkmcnt(5)
v_mfma_f32_16x16x32_bf16 v[64:67], v[48:51], a[208:211], v[64:67]
ds_read_b128 v[40:43], v17 offset:57344
v_mfma_f32_16x16x32_bf16 v[68:71], v[48:51], a[212:215], v[68:71]
s_waitcnt lgkmcnt(5)
v_mfma_f32_16x16x32_bf16 v[72:75], v[52:55], a[208:211], v[72:75]
ds_read_b128 v[44:47], v17 offset:61440
v_mfma_f32_16x16x32_bf16 v[76:79], v[52:55], a[212:215], v[76:79]
s_waitcnt lgkmcnt(5)
v_mfma_f32_16x16x32_bf16 v[64:67], v[56:59], a[216:219], v[64:67]
ds_read_b128 v[48:51], v18 offset:57344
v_mfma_f32_16x16x32_bf16 v[68:71], v[56:59], a[220:223], v[68:71]
s_waitcnt lgkmcnt(5)
v_mfma_f32_16x16x32_bf16 v[72:75], v[60:63], a[216:219], v[72:75]
ds_read_b128 v[52:55], v18 offset:61440
v_mfma_f32_16x16x32_bf16 v[76:79], v[60:63], a[220:223], v[76:79]
s_waitcnt vmcnt(8)
s_barrier
s_waitcnt lgkmcnt(5)
v_mfma_f32_16x16x32_bf16 v[64:67], v[32:35], a[224:227], v[64:67]
ds_read_b128 v[56:59], v19 offset:57344
v_mfma_f32_16x16x32_bf16 v[68:71], v[32:35], a[228:231], v[68:71]
s_waitcnt lgkmcnt(5)
v_mfma_f32_16x16x32_bf16 v[72:75], v[36:39], a[224:227], v[72:75]
ds_read_b128 v[60:63], v19 offset:61440
v_mfma_f32_16x16x32_bf16 v[76:79], v[36:39], a[228:231], v[76:79]
s_add_u32 s23, s23, 131072
s_add_u32 m0, s21, 0
s_xor_b32 s20, s23, 0
buffer_load_dwordx4 v6, s[8:11], s20 offen lds
s_waitcnt lgkmcnt(5)
v_mfma_f32_16x16x32_bf16 v[64:67], v[40:43], a[232:235], v[64:67]
ds_read_b128 v[32:35], v20
v_mfma_f32_16x16x32_bf16 v[68:71], v[40:43], a[236:239], v[68:71]
s_cmp_eq_u32 s25, 0
s_cbranch_scc1 L_q_v_nf
v_add_u32 v10, 1, v10
buffer_store_dword v10, v9, s[84:87], 0 offen sc1
L_q_v_nf:
s_waitcnt lgkmcnt(5)
v_mfma_f32_16x16x32_bf16 v[72:75], v[44:47], a[232:235], v[72:75]
ds_read_b128 v[36:39], v20 offset:4096
v_mfma_f32_16x16x32_bf16 v[76:79], v[44:47], a[236:239], v[76:79]
s_waitcnt lgkmcnt(5)
v_mfma_f32_16x16x32_bf16 v[64:67], v[48:51], a[240:243], v[64:67]
ds_read_b128 v[40:43], v21
v_mfma_f32_16x16x32_bf16 v[68:71], v[48:51], a[244:247], v[68:71]
s_add_u32 m0, s21, 1024
s_xor_b32 s20, s23, 0
buffer_load_dwordx4 v7, s[8:11], s20 offen lds
s_waitcnt lgkmcnt(5)
v_mfma_f32_16x16x32_bf16 v[72:75], v[52:55], a[240:243], v[72:75]
ds_read_b128 v[44:47], v21 offset:4096
v_mfma_f32_16x16x32_bf16 v[76:79], v[52:55], a[244:247], v[76:79]
s_waitcnt lgkmcnt(5)
v_mfma_f32_16x16x32_bf16 v[64:67], v[56:59], a[248:251], v[64:67]
ds_read_b128 v[48:51], v22
v_mfma_f32_16x16x32_bf16 v[68:71], v[56:59], a[252:255], v[68:71]
s_waitcnt lgkmcnt(5)
v_mfma_f32_16x16x32_bf16 v[72:75], v[60:63], a[248:251], v[72:75]
ds_read_b128 v[52:55], v22 offset:4096
v_mfma_f32_16x16x32_bf16 v[76:79], v[60:63], a[252:255], v[76:79]
s_add_u32 m0, s21, 8192
s_xor_b32 s20, s23, 256
buffer_load_dwordx4 v6, s[8:11], s20 offen lds
s_waitcnt lgkmcnt(5)
v_mfma_f32_16x16x32_bf16 v[80:83], v[32:35], a[0:3], 0
ds_read_b128 v[56:59], v23
v_mfma_f32_16x16x32_bf16 v[84:87], v[32:35], a[4:7], 0
s_waitcnt lgkmcnt(5)
v_mfma_f32_16x16x32_bf16 v[88:91], v[36:39], a[0:3], 0
ds_read_b128 v[60:63], v23 offset:4096
v_mfma_f32_16x16x32_bf16 v[92:95], v[36:39], a[4:7], 0
s_waitcnt lgkmcnt(5)
v_mfma_f32_16x16x32_bf16 v[80:83], v[40:43], a[8:11], v[80:83]
ds_read_b128 v[32:35], v20 offset:8192
v_mfma_f32_16x16x32_bf16 v[84:87], v[40:43], a[12:15], v[84:87]
s_add_u32 m0, s21, 9216
s_xor_b32 s20, s23, 256
buffer_load_dwordx4 v7, s[8:11], s20 offen lds
s_waitcnt lgkmcnt(5)
v_mfma_f32_16x16x32_bf16 v[88:91], v[44:47], a[8:11], v[88:91]
ds_read_b128 v[36:39], v20 offset:12288
v_mfma_f32_16x16x32_bf16 v[92:95], v[44:47], a[12:15], v[92:95]
s_waitcnt lgkmcnt(5)
v_mfma_f32_16x16x32_bf16 v[80:83], v[48:51], a[16:19], v[80:83]
ds_read_b128 v[40:43], v21 offset:8192
v_mfma_f32_16x16x32_bf16 v[84:87], v[48:51], a[20:23], v[84:87]
s_waitcnt lgkmcnt(5)
v_mfma_f32_16x16x32_bf16 v[88:91], v[52:55], a[16:19], v[88:91]
ds_read_b128 v[44:47], v21 offset:12288
v_mfma_f32_16x16x32_bf16 v[92:95], v[52:55], a[20:23], v[92:95]
s_add_u32 m0, s21, 16384
s_xor_b32 s20, s23, 512
buffer_load_dwordx4 v6, s[8:11], s20 offen lds
s_waitcnt lgkmcnt(5)
v_mfma_f32_16x16x32_bf16 v[80:83], v[56:59], a[24:27], v[80:83]
ds_read_b128 v[48:51], v22 offset:8192
v_mfma_f32_16x16x32_bf16 v[84:87], v[56:59], a[28:31], v[84:87]
s_waitcnt lgkmcnt(5)
v_mfma_f32_16x16x32_bf16 v[88:91], v[60:63], a[24:27], v[88:91]
ds_read_b128 v[52:55], v22 offset:12288
v_mfma_f32_16x16x32_bf16 v[92:95], v[60:63], a[28:31], v[92:95]
s_waitcnt lgkmcnt(5)
v_mfma_f32_16x16x32_bf16 v[80:83], v[32:35], a[32:35], v[80:83]
ds_read_b128 v[56:59], v23 offset:8192
v_mfma_f32_16x16x32_bf16 v[84:87], v[32:35], a[36:39], v[84:87]
s_add_u32 m0, s21, 17408
s_xor_b32 s20, s23, 512
buffer_load_dwordx4 v7, s[8:11], s20 offen lds
s_waitcnt lgkmcnt(5)
v_mfma_f32_16x16x32_bf16 v[88:91], v[36:39], a[32:35], v[88:91]
ds_read_b128 v[60:63], v23 offset:12288
v_mfma_f32_16x16x32_bf16 v[92:95], v[36:39], a[36:39], v[92:95]
s_waitcnt lgkmcnt(5)
v_mfma_f32_16x16x32_bf16 v[80:83], v[40:43], a[40:43], v[80:83]
ds_read_b128 v[32:35], v20 offset:16384
v_mfma_f32_16x16x32_bf16 v[84:87], v[40:43], a[44:47], v[84:87]
s_waitcnt lgkmcnt(5)
v_mfma_f32_16x16x32_bf16 v[88:91], v[44:47], a[40:43], v[88:91]
ds_read_b128 v[36:39], v20 offset:20480
v_mfma_f32_16x16x32_bf16 v[92:95], v[44:47], a[44:47], v[92:95]
s_add_u32 m0, s21, 24576
s_xor_b32 s20, s23, 768
buffer_load_dwordx4 v6, s[8:11], s20 offen lds
s_waitcnt lgkmcnt(5)
v_mfma_f32_16x16x32_bf16 v[80:83], v[48:51], a[48:51], v[80:83]
ds_read_b128 v[40:43], v21 offset:16384
v_mfma_f32_16x16x32_bf16 v[84:87], v[48:51], a[52:55], v[84:87]
s_waitcnt lgkmcnt(5)
v_mfma_f32_16x16x32_bf16 v[88:91], v[52:55], a[48:51], v[88:91]
ds_read_b128 v[44:47], v21 offset:20480
v_mfma_f32_16x16x32_bf16 v[92:95], v[52:55], a[52:55], v[92:95]
s_waitcnt lgkmcnt(5)
v_mfma_f32_16x16x32_bf16 v[80:83], v[56:59], a[56:59], v[80:83]
ds_read_b128 v[48:51], v22 offset:16384
v_mfma_f32_16x16x32_bf16 v[84:87], v[56:59], a[60:63], v[84:87]
s_add_u32 m0, s21, 25600
s_xor_b32 s20, s23, 768
buffer_load_dwordx4 v7, s[8:11], s20 offen lds
s_waitcnt lgkmcnt(5)
v_mfma_f32_16x16x32_bf16 v[88:91], v[60:63], a[56:59], v[88:91]
ds_read_b128 v[52:55], v22 offset:20480
v_mfma_f32_16x16x32_bf16 v[92:95], v[60:63], a[60:63], v[92:95]
v_cvt_pk_bf16_f32 v96, v64, v65
v_cvt_pk_bf16_f32 v97, v66, v67
s_waitcnt lgkmcnt(5)
v_mfma_f32_16x16x32_bf16 v[80:83], v[32:35], a[64:67], v[80:83]
ds_read_b128 v[56:59], v23 offset:16384
v_mfma_f32_16x16x32_bf16 v[84:87], v[32:35], a[68:71], v[84:87]
v_cvt_pk_bf16_f32 v98, v72, v73
v_cvt_pk_bf16_f32 v99, v74, v75
s_waitcnt lgkmcnt(5)
v_mfma_f32_16x16x32_bf16 v[88:91], v[36:39], a[64:67], v[88:91]
ds_read_b128 v[60:63], v23 offset:20480
v_mfma_f32_16x16x32_bf16 v[92:95], v[36:39], a[68:71], v[92:95]
buffer_store_dwordx4 v[96:99], v8, s[84:87], s24 offen sc1
v_cvt_pk_bf16_f32 v100, v68, v69
s_waitcnt lgkmcnt(5)
v_mfma_f32_16x16x32_bf16 v[80:83], v[40:43], a[72:75], v[80:83]
ds_read_b128 v[32:35], v20 offset:24576
v_mfma_f32_16x16x32_bf16 v[84:87], v[40:43], a[76:79], v[84:87]
v_cvt_pk_bf16_f32 v101, v70, v71
v_cvt_pk_bf16_f32 v102, v76, v77
s_waitcnt lgkmcnt(5)
v_mfma_f32_16x16x32_bf16 v[88:91], v[44:47], a[72:75], v[88:91]
ds_read_b128 v[36:39], v20 offset:28672
v_mfma_f32_16x16x32_bf16 v[92:95], v[44:47], a[76:79], v[92:95]
v_cvt_pk_bf16_f32 v103, v78, v79
buffer_store_dwordx4 v[100:103], v8, s[84:87], s24 offen offset:1024 sc1
s_waitcnt lgkmcnt(5)
v_mfma_f32_16x16x32_bf16 v[80:83], v[48:51], a[80:83], v[80:83]
ds_read_b128 v[40:43], v21 offset:24576
v_mfma_f32_16x16x32_bf16 v[84:87], v[48:51], a[84:87], v[84:87]
s_add_u32 s24, s24, 524288
s_waitcnt lgkmcnt(5)
v_mfma_f32_16x16x32_bf16 v[88:91], v[52:55], a[80:83], v[88:91]
ds_read_b128 v[44:47], v21 offset:28672
v_mfma_f32_16x16x32_bf16 v[92:95], v[52:55], a[84:87], v[92:95]
s_waitcnt lgkmcnt(5)
v_mfma_f32_16x16x32_bf16 v[80:83], v[56:59], a[88:91], v[80:83]
ds_read_b128 v[48:51], v22 offset:24576
v_mfma_f32_16x16x32_bf16 v[84:87], v[56:59], a[92:95], v[84:87]
s_waitcnt lgkmcnt(5)
v_mfma_f32_16x16x32_bf16 v[88:91], v[60:63], a[88:91], v[88:91]
ds_read_b128 v[52:55], v22 offset:28672
v_mfma_f32_16x16x32_bf16 v[92:95], v[60:63], a[92:95], v[92:95]
s_waitcnt vmcnt(8)
s_barrier
s_waitcnt lgkmcnt(5)
v_mfma_f32_16x16x32_bf16 v[80:83], v[32:35], a[96:99], v[80:83]
ds_read_b128 v[56:59], v23 offset:24576
v_mfma_f32_16x16x32_bf16 v[84:87], v[32:35], a[100:103], v[84:87]
s_waitcnt lgkmcnt(5)
v_mfma_f32_16x16x32_bf16 v[88:91], v[36:39], a[96:99], v[88:91]
ds_read_b128 v[60:63], v23 offset:28672
v_mfma_f32_16x16x32_bf16 v[92:95], v[36:39], a[100:103], v[92:95]
s_add_u32 m0, s21, 32768
s_xor_b32 s20, s23, 1024
buffer_load_dwordx4 v6, s[8:11], s20 offen lds
s_waitcnt lgkmcnt(5)
v_mfma_f32_16x16x32_bf16 v[80:83], v[40:43], a[104:107], v[80:83]
ds_read_b128 v[32:35], v20 offset:32768
v_mfma_f32_16x16x32_bf16 v[84:87], v[40:43], a[108:111], v[84:87]
s_waitcnt lgkmcnt(5)
v_mfma_f32_16x16x32_bf16 v[88:91], v[44:47], a[104:107], v[88:91]
ds_read_b128 v[36:39], v20 offset:36864
v_mfma_f32_16x16x32_bf16 v[92:95], v[44:47], a[108:111], v[92:95]
s_waitcnt lgkmcnt(5)
v_mfma_f32_16x16x32_bf16 v[80:83], v[48:51], a[112:115], v[80:83]
ds_read_b128 v[40:43], v21 offset:32768
v_mfma_f32_16x16x32_bf16 v[84:87], v[48:51], a[116:119], v[84:87]
s_add_u32 m0, s21, 33792
s_xor_b32 s20, s23, 1024
buffer_load_dwordx4 v7, s[8:11], s20 offen lds
s_waitcnt lgkmcnt(5)
v_mfma_f32_16x16x32_bf16 v[88:91], v[52:55], a[112:115], v[88:91]
ds_read_b128 v[44:47], v21 offset:36864
v_mfma_f32_16x16x32_bf16 v[92:95], v[52:55], a[116:119], v[92:95]
s_waitcnt lgkmcnt(5)
v_mfma_f32_16x16x32_bf16 v[80:83], v[56:59], a[120:123], v[80:83]
ds_read_b128 v[48:51], v22 offset:32768
v_mfma_f32_16x16x32_bf16 v[84:87], v[56:59], a[124:127], v[84:87]
s_waitcnt lgkmcnt(5)
v_mfma_f32_16x16x32_bf16 v[88:91], v[60:63], a[120:123], v[88:91]
ds_read_b128 v[52:55], v22 offset:36864
v_mfma_f32_16x16x32_bf16 v[92:95], v[60:63], a[124:127], v[92:95]
s_add_u32 m0, s21, 40960
s_xor_b32 s20, s23, 1280
buffer_load_dwordx4 v6, s[8:11], s20 offen lds
s_waitcnt lgkmcnt(5)
v_mfma_f32_16x16x32_bf16 v[80:83], v[32:35], a[128:131], v[80:83]
ds_read_b128 v[56:59], v23 offset:32768
v_mfma_f32_16x16x32_bf16 v[84:87], v[32:35], a[132:135], v[84:87]
s_waitcnt lgkmcnt(5)
v_mfma_f32_16x16x32_bf16 v[88:91], v[36:39], a[128:131], v[88:91]
ds_read_b128 v[60:63], v23 offset:36864
v_mfma_f32_16x16x32_bf16 v[92:95], v[36:39], a[132:135], v[92:95]
s_waitcnt lgkmcnt(5)
v_mfma_f32_16x16x32_bf16 v[80:83], v[40:43], a[136:139], v[80:83]
ds_read_b128 v[32:35], v20 offset:40960
v_mfma_f32_16x16x32_bf16 v[84:87], v[40:43], a[140:143], v[84:87]
s_add_u32 m0, s21, 41984
s_xor_b32 s20, s23, 1280
buffer_load_dwordx4 v7, s[8:11], s20 offen lds
s_waitcnt lgkmcnt(5)
v_mfma_f32_16x16x32_bf16 v[88:91], v[44:47], a[136:139], v[88:91]
ds_read_b128 v[36:39], v20 offset:45056
v_mfma_f32_16x16x32_bf16 v[92:95], v[44:47], a[140:143], v[92:95]
s_waitcnt lgkmcnt(5)
v_mfma_f32_16x16x32_bf16 v[80:83], v[48:51], a[144:147], v[80:83]
ds_read_b128 v[40:43], v21 offset:40960
v_mfma_f32_16x16x32_bf16 v[84:87], v[48:51], a[148:151], v[84:87]
s_waitcnt lgkmcnt(5)
v_mfma_f32_16x16x32_bf16 v[88:91], v[52:55], a[144:147], v[88:91]
ds_read_b128 v[44:47], v21 offset:45056
v_mfma_f32_16x16x32_bf16 v[92:95], v[52:55], a[148:151], v[92:95]
s_add_u32 m0, s21, 49152
s_xor_b32 s20, s23, 1536
buffer_load_dwordx4 v6, s[8:11], s20 offen lds
s_waitcnt lgkmcnt(5)
v_mfma_f32_16x16x32_bf16 v[80:83], v[56:59], a[152:155], v[80:83]
ds_read_b128 v[48:51], v22 offset:40960
v_mfma_f32_16x16x32_bf16 v[84:87], v[56:59], a[156:159], v[84:87]
s_waitcnt lgkmcnt(5)
v_mfma_f32_16x16x32_bf16 v[88:91], v[60:63], a[152:155], v[88:91]
ds_read_b128 v[52:55], v22 offset:45056
v_mfma_f32_16x16x32_bf16 v[92:95], v[60:63], a[156:159], v[92:95]
s_waitcnt lgkmcnt(5)
v_mfma_f32_16x16x32_bf16 v[80:83], v[32:35], a[160:163], v[80:83]
ds_read_b128 v[56:59], v23 offset:40960
v_mfma_f32_16x16x32_bf16 v[84:87], v[32:35], a[164:167], v[84:87]
s_add_u32 m0, s21, 50176
s_xor_b32 s20, s23, 1536
buffer_load_dwordx4 v7, s[8:11], s20 offen lds
s_waitcnt lgkmcnt(5)
v_mfma_f32_16x16x32_bf16 v[88:91], v[36:39], a[160:163], v[88:91]
ds_read_b128 v[60:63], v23 offset:45056
v_mfma_f32_16x16x32_bf16 v[92:95], v[36:39], a[164:167], v[92:95]
s_waitcnt lgkmcnt(5)
v_mfma_f32_16x16x32_bf16 v[80:83], v[40:43], a[168:171], v[80:83]
ds_read_b128 v[32:35], v20 offset:49152
v_mfma_f32_16x16x32_bf16 v[84:87], v[40:43], a[172:175], v[84:87]
s_waitcnt lgkmcnt(5)
v_mfma_f32_16x16x32_bf16 v[88:91], v[44:47], a[168:171], v[88:91]
ds_read_b128 v[36:39], v20 offset:53248
v_mfma_f32_16x16x32_bf16 v[92:95], v[44:47], a[172:175], v[92:95]
s_add_u32 m0, s21, 57344
s_xor_b32 s20, s23, 1792
buffer_load_dwordx4 v6, s[8:11], s20 offen lds
s_waitcnt lgkmcnt(5)
v_mfma_f32_16x16x32_bf16 v[80:83], v[48:51], a[176:179], v[80:83]
ds_read_b128 v[40:43], v21 offset:49152
v_mfma_f32_16x16x32_bf16 v[84:87], v[48:51], a[180:183], v[84:87]
s_waitcnt lgkmcnt(5)
v_mfma_f32_16x16x32_bf16 v[88:91], v[52:55], a[176:179], v[88:91]
ds_read_b128 v[44:47], v21 offset:53248
v_mfma_f32_16x16x32_bf16 v[92:95], v[52:55], a[180:183], v[92:95]
s_waitcnt lgkmcnt(5)
v_mfma_f32_16x16x32_bf16 v[80:83], v[56:59], a[184:187], v[80:83]
ds_read_b128 v[48:51], v22 offset:49152
v_mfma_f32_16x16x32_bf16 v[84:87], v[56:59], a[188:191], v[84:87]
s_add_u32 m0, s21, 58368
s_xor_b32 s20, s23, 1792
buffer_load_dwordx4 v7, s[8:11], s20 offen lds
s_waitcnt lgkmcnt(5)
v_mfma_f32_16x16x32_bf16 v[88:91], v[60:63], a[184:187], v[88:91]
ds_read_b128 v[52:55], v22 offset:53248
v_mfma_f32_16x16x32_bf16 v[92:95], v[60:63], a[188:191], v[92:95]
s_waitcnt lgkmcnt(5)
v_mfma_f32_16x16x32_bf16 v[80:83], v[32:35], a[192:195], v[80:83]
ds_read_b128 v[56:59], v23 offset:49152
v_mfma_f32_16x16x32_bf16 v[84:87], v[32:35], a[196:199], v[84:87]
s_waitcnt lgkmcnt(5)
v_mfma_f32_16x16x32_bf16 v[88:91], v[36:39], a[192:195], v[88:91]
ds_read_b128 v[60:63], v23 offset:53248
v_mfma_f32_16x16x32_bf16 v[92:95], v[36:39], a[196:199], v[92:95]
s_waitcnt lgkmcnt(5)
v_mfma_f32_16x16x32_bf16 v[80:83], v[40:43], a[200:203], v[80:83]
ds_read_b128 v[32:35], v20 offset:57344
v_mfma_f32_16x16x32_bf16 v[84:87], v[40:43], a[204:207], v[84:87]
s_waitcnt lgkmcnt(5)
v_mfma_f32_16x16x32_bf16 v[88:91], v[44:47], a[200:203], v[88:91]
ds_read_b128 v[36:39], v20 offset:61440
v_mfma_f32_16x16x32_bf16 v[92:95], v[44:47], a[204:207], v[92:95]
s_waitcnt lgkmcnt(5)
v_mfma_f32_16x16x32_bf16 v[80:83], v[48:51], a[208:211], v[80:83]
ds_read_b128 v[40:43], v21 offset:57344
v_mfma_f32_16x16x32_bf16 v[84:87], v[48:51], a[212:215], v[84:87]
s_waitcnt lgkmcnt(5)
v_mfma_f32_16x16x32_bf16 v[88:91], v[52:55], a[208:211], v[88:91]
ds_read_b128 v[44:47], v21 offset:61440
v_mfma_f32_16x16x32_bf16 v[92:95], v[52:55], a[212:215], v[92:95]
s_waitcnt lgkmcnt(5)
v_mfma_f32_16x16x32_bf16 v[80:83], v[56:59], a[216:219], v[80:83]
ds_read_b128 v[48:51], v22 offset:57344
v_mfma_f32_16x16x32_bf16 v[84:87], v[56:59], a[220:223], v[84:87]
s_waitcnt lgkmcnt(5)
v_mfma_f32_16x16x32_bf16 v[88:91], v[60:63], a[216:219], v[88:91]
ds_read_b128 v[52:55], v22 offset:61440
v_mfma_f32_16x16x32_bf16 v[92:95], v[60:63], a[220:223], v[92:95]
s_waitcnt vmcnt(8)
s_barrier
s_waitcnt lgkmcnt(5)
v_mfma_f32_16x16x32_bf16 v[80:83], v[32:35], a[224:227], v[80:83]
ds_read_b128 v[56:59], v23 offset:57344
v_mfma_f32_16x16x32_bf16 v[84:87], v[32:35], a[228:231], v[84:87]
s_waitcnt lgkmcnt(5)
v_mfma_f32_16x16x32_bf16 v[88:91], v[36:39], a[224:227], v[88:91]
ds_read_b128 v[60:63], v23 offset:61440
v_mfma_f32_16x16x32_bf16 v[92:95], v[36:39], a[228:231], v[92:95]
s_add_u32 s23, s23, 131072
s_add_u32 m0, s21, 65536
s_xor_b32 s20, s23, 0
buffer_load_dwordx4 v6, s[8:11], s20 offen lds
s_waitcnt lgkmcnt(5)
v_mfma_f32_16x16x32_bf16 v[80:83], v[40:43], a[232:235], v[80:83]
ds_read_b128 v[32:35], v16
v_mfma_f32_16x16x32_bf16 v[84:87], v[40:43], a[236:239], v[84:87]
v_add_u32 v10, 1, v10
buffer_store_dword v10, v9, s[84:87], 0 offen sc1
s_waitcnt lgkmcnt(5)
v_mfma_f32_16x16x32_bf16 v[88:91], v[44:47], a[232:235], v[88:91]
ds_read_b128 v[36:39], v16 offset:4096
v_mfma_f32_16x16x32_bf16 v[92:95], v[44:47], a[236:239], v[92:95]
s_waitcnt lgkmcnt(5)
v_mfma_f32_16x16x32_bf16 v[80:83], v[48:51], a[240:243], v[80:83]
ds_read_b128 v[40:43], v17
v_mfma_f32_16x16x32_bf16 v[84:87], v[48:51], a[244:247], v[84:87]
s_add_u32 m0, s21, 66560
s_xor_b32 s20, s23, 0
buffer_load_dwordx4 v7, s[8:11], s20 offen lds
s_waitcnt lgkmcnt(5)
v_mfma_f32_16x16x32_bf16 v[88:91], v[52:55], a[240:243], v[88:91]
ds_read_b128 v[44:47], v17 offset:4096
v_mfma_f32_16x16x32_bf16 v[92:95], v[52:55], a[244:247], v[92:95]
s_waitcnt lgkmcnt(5)
v_mfma_f32_16x16x32_bf16 v[80:83], v[56:59], a[248:251], v[80:83]
ds_read_b128 v[48:51], v18
v_mfma_f32_16x16x32_bf16 v[84:87], v[56:59], a[252:255], v[84:87]
s_waitcnt lgkmcnt(5)
v_mfma_f32_16x16x32_bf16 v[88:91], v[60:63], a[248:251], v[88:91]
ds_read_b128 v[52:55], v18 offset:4096
v_mfma_f32_16x16x32_bf16 v[92:95], v[60:63], a[252:255], v[92:95]
s_add_u32 m0, s21, 73728
s_xor_b32 s20, s23, 256
buffer_load_dwordx4 v6, s[8:11], s20 offen lds
s_add_u32 s25, s25, 1
s_cmp_lt_u32 s25, 16
s_cbranch_scc1 L_q_v_loop
s_nop 11
v_cvt_pk_bf16_f32 v96, v80, v81
v_cvt_pk_bf16_f32 v97, v82, v83
v_cvt_pk_bf16_f32 v98, v88, v89
v_cvt_pk_bf16_f32 v99, v90, v91
buffer_store_dwordx4 v[96:99], v8, s[84:87], s24 offen sc1
v_cvt_pk_bf16_f32 v100, v84, v85
v_cvt_pk_bf16_f32 v101, v86, v87
v_cvt_pk_bf16_f32 v102, v92, v93
v_cvt_pk_bf16_f32 v103, v94, v95
buffer_store_dwordx4 v[100:103], v8, s[84:87], s24 offen offset:1024 sc1
s_add_u32 s24, s24, 524288
s_waitcnt vmcnt(0) lgkmcnt(0)
s_barrier
v_add_u32 v10, 1, v10
buffer_store_dword v10, v9, s[84:87], 0 offen sc1
L_q_done:
s_cmp_lg_u32 s17, 1
s_cbranch_scc1 L_q_end
s_mov_b32 s29, 32
s_branch L_q_again
L_q_end:
s_branch L_wl
L_fft:
s_waitcnt vmcnt(0)
s_barrier
s_or_b32 s81, s97, s98
s_cmp_lg_u32 s81, 0
s_cbranch_scc1 L_h0_5
s_lshl_b32 s81, s93, 5
v_mov_b32 v38, 1
s_mov_b64 exec, 1
buffer_atomic_add v38, off, s[88:91], s81 sc1
s_mov_b64 exec, -1
L_h0_5:
v_and_b32 v37, 7, v0
v_lshlrev_b32 v37, 5, v37
buffer_load_dword v36, v37, s[88:91], 0 offen sc1
s_waitcnt vmcnt(0)
s_cmp_lg_u32 s97, 0
s_cbranch_scc1 L_h2_6_ok
L_h2_6_ev:
v_cmp_ne_u32 vcc, 32, v36
s_cbranch_vccz L_h2_6_ok
s_mov_b32 s78, 0
v_readlane_b32 s81, v36, 0
s_nop 3
s_add_u32 s78, s78, s81
v_readlane_b32 s81, v36, 1
s_nop 3
s_add_u32 s78, s78, s81
v_readlane_b32 s81, v36, 2
s_nop 3
s_add_u32 s78, s78, s81
v_readlane_b32 s81, v36, 3
s_nop 3
s_add_u32 s78, s78, s81
v_readlane_b32 s81, v36, 4
s_nop 3
s_add_u32 s78, s78, s81
v_readlane_b32 s81, v36, 5
s_nop 3
s_add_u32 s78, s78, s81
v_readlane_b32 s81, v36, 6
s_nop 3
s_add_u32 s78, s78, s81
v_readlane_b32 s81, v36, 7
s_nop 3
s_add_u32 s78, s78, s81
s_cmp_eq_u32 s78, 256
s_cbranch_scc1 L_redo
buffer_load_dword v36, v37, s[88:91], 0 offen sc1
s_waitcnt vmcnt(0)
s_branch L_h2_6_ev
L_h2_6_ok:
s_mov_b32 s97, 1
s_mov_b32 s99, s92
L_f2l:
s_load_dwordx2 s[4:5], s[0:1], 64
s_load_dwordx2 s[8:9], s[0:1], 72
s_barrier
v_mul_u32_u24 v1, 1026, v0
v_and_b32 v2, 1, v0
v_lshlrev_b32 v2, 4, v2
v_and_b32 v1, -4, v1
v_lshlrev_b32 v3, 4, v0
s_lshl_b32 s12, s99, 4
s_waitcnt lgkmcnt(0)
s_mov_b32 s6, 2101248
s_mov_b32 s7, 0x00020000
s_mov_b32 s10, 2101248
s_mov_b32 s11, 0x00020000
s_add_u32 s13, s12, 0
buffer_load_dwordx4 v[16:19], v1, s[4:7], s13 offen
buffer_load_dword v20, v1, s[4:7], s13 offen offset:16
s_add_u32 s13, s12, 262656
buffer_load_dwordx4 v[22:25], v1, s[4:7], s13 offen
buffer_load_dword v26, v1, s[4:7], s13 offen offset:16
s_add_u32 s13, s12, 525312
buffer_load_dwordx4 v[28:31], v1, s[4:7], s13 offen
buffer_load_dword v32, v1, s[4:7], s13 offen offset:16
s_add_u32 s13, s12, 787968
buffer_load_dwordx4 v[34:37], v1, s[4:7], s13 offen
buffer_load_dword v38, v1, s[4:7], s13 offen offset:16
s_add_u32 s13, s12, 1050624
buffer_load_dwordx4 v[40:43], v1, s[4:7], s13 offen
buffer_load_dword v44, v1, s[4:7], s13 offen offset:16
s_add_u32 s13, s12, 1313280
buffer_load_dwordx4 v[46:49], v1, s[4:7], s13 offen
buffer_load_dword v50, v1, s[4:7], s13 offen offset:16
s_add_u32 s13, s12, 1575936
buffer_load_dwordx4 v[52:55], v1, s[4:7], s13 offen
buffer_load_dword v56, v1, s[4:7], s13 offen offset:16
s_add_u32 s13, s12, 1838592
buffer_load_dwordx4 v[58:61], v1, s[4:7], s13 offen
buffer_load_dword v62, v1, s[4:7], s13 offen offset:16
s_add_u32 s13, s12, 0
buffer_load_dwordx4 v[64:67], v1, s[8:11], s13 offen
buffer_load_dword v68, v1, s[8:11], s13 offen offset:16
s_add_u32 s13, s12, 262656
buffer_load_dwordx4 v[70:73], v1, s[8:11], s13 offen
buffer_load_dword v74, v1, s[8:11], s13 offen offset:16
s_add_u32 s13, s12, 525312
buffer_load_dwordx4 v[76:79], v1, s[8:11], s13 offen
buffer_load_dword v80, v1, s[8:11], s13 offen offset:16
s_add_u32 s13, s12, 787968
buffer_load_dwordx4 v[82:85], v1, s[8:11], s13 offen
buffer_load_dword v86, v1, s[8:11], s13 offen offset:16
s_add_u32 s13, s12, 1050624
buffer_load_dwordx4 v[88:91], v1, s[8:11], s13 offen
buffer_load_dword v92, v1, s[8:11], s13 offen offset:16
s_add_u32 s13, s12, 1313280
buffer_load_dwordx4 v[94:97], v1, s[8:11], s13 offen
buffer_load_dword v98, v1, s[8:11], s13 offen offset:16
s_add_u32 s13, s12, 1575936
buffer_load_dwordx4 v[100:103], v1, s[8:11], s13 offen
buffer_load_dword v104, v1, s[8:11], s13 offen offset:16
s_add_u32 s13, s12, 1838592
buffer_load_dwordx4 v[106:109], v1, s[8:11], s13 offen
buffer_load_dword v110, v1, s[8:11], s13 offen offset:16
s_waitcnt vmcnt(30)
v_alignbit_b32 v16, v17, v16, v2
v_alignbit_b32 v17, v18, v17, v2
v_alignbit_b32 v18, v19, v18, v2
v_alignbit_b32 v19, v20, v19, v2
ds_write_b128 v3, v[16:19]
s_waitcnt vmcnt(28)
v_alignbit_b32 v22, v23, v22, v2
v_alignbit_b32 v23, v24, v23, v2
v_alignbit_b32 v24, v25, v24, v2
v_alignbit_b32 v25, v26, v25, v2
ds_write_b128 v3, v[22:25] offset:4096
s_waitcnt vmcnt(26)
v_alignbit_b32 v28, v29, v28, v2
v_alignbit_b32 v29, v30, v29, v2
v_alignbit_b32 v30, v31, v30, v2
v_alignbit_b32 v31, v32, v31, v2
ds_write_b128 v3, v[28:31] offset:8192
s_waitcnt vmcnt(24)
v_alignbit_b32 v34, v35, v34, v2
v_alignbit_b32 v35, v36, v35, v2
v_alignbit_b32 v36, v37, v36, v2
v_alignbit_b32 v37, v38, v37, v2
ds_write_b128 v3, v[34:37] offset:12288
s_waitcnt vmcnt(22)
v_alignbit_b32 v40, v41, v40, v2
v_alignbit_b32 v41, v42, v41, v2
v_alignbit_b32 v42, v43, v42, v2
v_alignbit_b32 v43, v44, v43, v2
ds_write_b128 v3, v[40:43] offset:16384
s_waitcnt vmcnt(20)
v_alignbit_b32 v46, v47, v46, v2
v_alignbit_b32 v47, v48, v47, v2
v_alignbit_b32 v48, v49, v48, v2
v_alignbit_b32 v49, v50, v49, v2
ds_write_b128 v3, v[46:49] offset:20480
s_waitcnt vmcnt(18)
v_alignbit_b32 v52, v53, v52, v2
v_alignbit_b32 v53, v54, v53, v2
v_alignbit_b32 v54, v55, v54, v2
v_alignbit_b32 v55, v56, v55, v2
ds_write_b128 v3, v[52:55] offset:24576
s_waitcnt vmcnt(16)
v_alignbit_b32 v58, v59, v58, v2
v_alignbit_b32 v59, v60, v59, v2
v_alignbit_b32 v60, v61, v60, v2
v_alignbit_b32 v61, v62, v61, v2
ds_write_b128 v3, v[58:61] offset:28672
s_waitcnt vmcnt(14)
v_alignbit_b32 v64, v65, v64, v2
v_alignbit_b32 v65, v66, v65, v2
v_alignbit_b32 v66, v67, v66, v2
v_alignbit_b32 v67, v68, v67, v2
ds_write_b128 v3, v[64:67] offset:32768
s_waitcnt vmcnt(12)
v_alignbit_b32 v70, v71, v70, v2
v_alignbit_b32 v71, v72, v71, v2
v_alignbit_b32 v72, v73, v72, v2
v_alignbit_b32 v73, v74, v73, v2
ds_write_b128 v3, v[70:73] offset:36864
s_waitcnt vmcnt(10)
v_alignbit_b32 v76, v77, v76, v2
v_alignbit_b32 v77, v78, v77, v2
v_alignbit_b32 v78, v79, v78, v2
v_alignbit_b32 v79, v80, v79, v2
ds_write_b128 v3, v[76:79] offset:40960
s_waitcnt vmcnt(8)
v_alignbit_b32 v82, v83, v82, v2
v_alignbit_b32 v83, v84, v83, v2
v_alignbit_b32 v84, v85, v84, v2
v_alignbit_b32 v85, v86, v85, v2
ds_write_b128 v3, v[82:85] offset:45056
s_waitcnt vmcnt(6)
v_alignbit_b32 v88, v89, v88, v2
v_alignbit_b32 v89, v90, v89, v2
v_alignbit_b32 v90, v91, v90, v2
v_alignbit_b32 v91, v92, v91, v2
ds_write_b128 v3, v[88:91] offset:49152
s_waitcnt vmcnt(4)
v_alignbit_b32 v94, v95, v94, v2
v_alignbit_b32 v95, v96, v95, v2
v_alignbit_b32 v96, v97, v96, v2
v_alignbit_b32 v97, v98, v97, v2
ds_write_b128 v3, v[94:97] offset:53248
s_waitcnt vmcnt(2)
v_alignbit_b32 v100, v101, v100, v2
v_alignbit_b32 v101, v102, v101, v2
v_alignbit_b32 v102, v103, v102, v2
v_alignbit_b32 v103, v104, v103, v2
ds_write_b128 v3, v[100:103] offset:57344
s_waitcnt vmcnt(0)
v_alignbit_b32 v106, v107, v106, v2
v_alignbit_b32 v107, v108, v107, v2
v_alignbit_b32 v108, v109, v108, v2
v_alignbit_b32 v109, v110, v109, v2
ds_write_b128 v3, v[106:109] offset:61440
v_and_b32 v1, 1, v0
v_bfe_u32 v2, v0, 1, 5
v_lshlrev_b32 v1, 14, v1
v_lshl_add_u32 v1, v2, 4, v1
v_lshrrev_b32 v2, 6, v0
v_lshl_add_u32 v1, v2, 2, v1
s_waitcnt lgkmcnt(0)
s_barrier
ds_read_b32 v160, v1
ds_read_b32 v161, v1 offset:512
ds_read_b32 v162, v1 offset:1024
ds_read_b32 v163, v1 offset:1536
ds_read_b32 v164, v1 offset:2048
ds_read_b32 v165, v1 offset:2560
ds_read_b32 v166, v1 offset:3072
ds_read_b32 v167, v1 offset:3584
s_waitcnt lgkmcnt(6)
ds_read_b32 v168, v1 offset:4096
ds_read_b32 v169, v1 offset:4608
ds_read_b32 v170, v1 offset:5120
ds_read_b32 v171, v1 offset:5632
ds_read_b32 v172, v1 offset:6144
ds_read_b32 v173, v1 offset:6656
ds_read_b32 v174, v1 offset:7168
ds_read_b32 v175, v1 offset:7680
s_waitcnt lgkmcnt(6)
ds_read_b32 v176, v1 offset:8192
ds_read_b32 v177, v1 offset:8704
ds_read_b32 v178, v1 offset:9216
ds_read_b32 v179, v1 offset:9728
ds_read_b32 v180, v1 offset:10240
ds_read_b32 v181, v1 offset:10752
ds_read_b32 v182, v1 offset:11264
ds_read_b32 v183, v1 offset:11776
s_waitcnt lgkmcnt(6)
ds_read_b32 v184, v1 offset:12288
ds_read_b32 v185, v1 offset:12800
ds_read_b32 v186, v1 offset:13312
ds_read_b32 v187, v1 offset:13824
ds_read_b32 v188, v1 offset:14336
ds_read_b32 v189, v1 offset:14848
ds_read_b32 v190, v1 offset:15360
ds_read_b32 v191, v1 offset:15872
s_waitcnt lgkmcnt(6)
ds_read_b32 v192, v1 offset:32768
ds_read_b32 v193, v1 offset:33280
ds_read_b32 v194, v1 offset:33792
ds_read_b32 v195, v1 offset:34304
ds_read_b32 v196, v1 offset:34816
ds_read_b32 v197, v1 offset:35328
ds_read_b32 v198, v1 offset:35840
ds_read_b32 v199, v1 offset:36352
s_waitcnt lgkmcnt(6)
ds_read_b32 v200, v1 offset:36864
ds_read_b32 v201, v1 offset:37376
ds_read_b32 v202, v1 offset:37888
ds_read_b32 v203, v1 offset:38400
ds_read_b32 v204, v1 offset:38912
ds_read_b32 v205, v1 offset:39424
ds_read_b32 v206, v1 offset:39936
ds_read_b32 v207, v1 offset:40448
s_waitcnt lgkmcnt(6)
ds_read_b32 v208, v1 offset:40960
ds_read_b32 v209, v1 offset:41472
ds_read_b32 v210, v1 offset:41984
ds_read_b32 v211, v1 offset:42496
ds_read_b32 v212, v1 offset:43008
ds_read_b32 v213, v1 offset:43520
ds_read_b32 v214, v1 offset:44032
ds_read_b32 v215, v1 offset:44544
s_waitcnt lgkmcnt(6)
ds_read_b32 v216, v1 offset:45056
ds_read_b32 v217, v1 offset:45568
ds_read_b32 v218, v1 offset:46080
ds_read_b32 v219, v1 offset:46592
ds_read_b32 v220, v1 offset:47104
ds_read_b32 v221, v1 offset:47616
ds_read_b32 v222, v1 offset:48128
ds_read_b32 v223, v1 offset:48640
s_waitcnt lgkmcnt(6)
s_waitcnt lgkmcnt(0)
s_cmp_eq_u32 s99, 64
s_cbranch_scc1 L_f2go
s_barrier
s_load_dwordx2 s[4:5], s[0:1], 56
s_mov_b32 s30, 0x3f7b14be
s_mov_b32 s31, 0x3f6c835e
s_mov_b32 s32, 0x3f54db31
s_mov_b32 s33, 0x3f3504f3
s_mov_b32 s34, 0x3f0e39da
s_mov_b32 s35, 0x3ec3ef15
s_mov_b32 s36, 0x3e47c5c2
v_and_b32 v1, 31, v0
v_lshrrev_b32 v2, 5, v0
v_cvt_f32_u32 v3, v1
v_mul_u32_u24 v6, 16896, v2
v_lshl_add_u32 v4, v1, 4, v6
v_mul_u32_u24 v5, 528, v1
v_add_u32 v5, v5, v6
v_mov_b64 v[16:17], 0
v_mov_b64 v[18:19], 0
v_mov_b64 v[20:21], 0
v_mov_b64 v[22:23], 0
v_mov_b64 v[24:25], 0
v_mov_b64 v[26:27], 0
v_mov_b64 v[28:29], 0
v_mov_b64 v[30:31], 0
v_mov_b64 v[32:33], 0
v_mov_b64 v[34:35], 0
v_mov_b64 v[36:37], 0
v_mov_b64 v[38:39], 0
v_mov_b64 v[40:41], 0
v_mov_b64 v[42:43], 0
v_mov_b64 v[44:45], 0
v_mov_b64 v[46:47], 0
v_mov_b64 v[48:49], 0
v_mov_b64 v[50:51], 0
v_mov_b64 v[52:53], 0
v_mov_b64 v[54:55], 0
v_mov_b64 v[56:57], 0
v_mov_b64 v[58:59], 0
v_mov_b64 v[60:61], 0
v_mov_b64 v[62:63], 0
v_mov_b64 v[64:65], 0
v_mov_b64 v[66:67], 0
v_mov_b64 v[68:69], 0
v_mov_b64 v[70:71], 0
v_mov_b64 v[72:73], 0
v_mov_b64 v[74:75], 0
v_mov_b64 v[76:77], 0
v_mov_b64 v[78:79], 0
v_mov_b64 v[80:81], 0
v_mov_b64 v[82:83], 0
v_mov_b64 v[84:85], 0
v_mov_b64 v[86:87], 0
v_mov_b64 v[88:89], 0
v_mov_b64 v[90:91], 0
v_mov_b64 v[92:93], 0
v_mov_b64 v[94:95], 0
v_mov_b64 v[96:97], 0
v_mov_b64 v[98:99], 0
v_mov_b64 v[100:101], 0
v_mov_b64 v[102:103], 0
v_mov_b64 v[104:105], 0
v_mov_b64 v[106:107], 0
v_mov_b64 v[108:109], 0
v_mov_b64 v[110:111], 0
v_mov_b64 v[112:113], 0
v_mov_b64 v[114:115], 0
v_mov_b64 v[116:117], 0
v_mov_b64 v[118:119], 0
v_mov_b64 v[120:121], 0
v_mov_b64 v[122:123], 0
v_mov_b64 v[124:125], 0
v_mov_b64 v[126:127], 0
v_mov_b64 v[128:129], 0
v_mov_b64 v[130:131], 0
v_mov_b64 v[132:133], 0
v_mov_b64 v[134:135], 0
v_mov_b64 v[136:137], 0
v_mov_b64 v[138:139], 0
v_mov_b64 v[140:141], 0
v_mov_b64 v[142:143], 0
v_lshlrev_b32 v7, 11, v2
v_lshl_add_u32 v7, v1, 1, v7
s_lshl_b32 s12, s92, 16
s_add_u32 s13, s12, 16384
s_add_u32 s14, s12, 32768
s_add_u32 s15, s12, 49152
s_waitcnt lgkmcnt(0)
s_mov_b32 s6, 4194304
s_mov_b32 s7, 0x00020000
buffer_load_short_d16_hi v16, v7, s[4:7], s12 offen
buffer_load_short_d16_hi v20, v7, s[4:7], s12 offen offset:64
buffer_load_short_d16_hi v24, v7, s[4:7], s12 offen offset:128
buffer_load_short_d16_hi v28, v7, s[4:7], s12 offen offset:192
buffer_load_short_d16_hi v32, v7, s[4:7], s12 offen offset:256
buffer_load_short_d16_hi v36, v7, s[4:7], s12 offen offset:320
buffer_load_short_d16_hi v40, v7, s[4:7], s12 offen offset:384
buffer_load_short_d16_hi v44, v7, s[4:7], s12 offen offset:448
buffer_load_short_d16_hi v48, v7, s[4:7], s12 offen offset:512
buffer_load_short_d16_hi v52, v7, s[4:7], s12 offen offset:576
buffer_load_short_d16_hi v56, v7, s[4:7], s12 offen offset:640
buffer_load_short_d16_hi v60, v7, s[4:7], s12 offen offset:704
buffer_load_short_d16_hi v64, v7, s[4:7], s12 offen offset:768
buffer_load_short_d16_hi v68, v7, s[4:7], s12 offen offset:832
buffer_load_short_d16_hi v72, v7, s[4:7], s12 offen offset:896
buffer_load_short_d16_hi v76, v7, s[4:7], s12 offen offset:960
buffer_load_short_d16_hi v80, v7, s[4:7], s12 offen offset:1024
buffer_load_short_d16_hi v84, v7, s[4:7], s12 offen offset:1088
buffer_load_short_d16_hi v88, v7, s[4:7], s12 offen offset:1152
buffer_load_short_d16_hi v92, v7, s[4:7], s12 offen offset:1216
buffer_load_short_d16_hi v96, v7, s[4:7], s12 offen offset:1280
buffer_load_short_d16_hi v100, v7, s[4:7], s12 offen offset:1344
buffer_load_short_d16_hi v104, v7, s[4:7], s12 offen offset:1408
buffer_load_short_d16_hi v108, v7, s[4:7], s12 offen offset:1472
buffer_load_short_d16_hi v112, v7, s[4:7], s12 offen offset:1536
buffer_load_short_d16_hi v116, v7, s[4:7], s12 offen offset:1600
buffer_load_short_d16_hi v120, v7, s[4:7], s12 offen offset:1664
buffer_load_short_d16_hi v124, v7, s[4:7], s12 offen offset:1728
buffer_load_short_d16_hi v128, v7, s[4:7], s12 offen offset:1792
buffer_load_short_d16_hi v132, v7, s[4:7], s12 offen offset:1856
buffer_load_short_d16_hi v136, v7, s[4:7], s12 offen offset:1920
buffer_load_short_d16_hi v140, v7, s[4:7], s12 offen offset:1984
buffer_load_short_d16_hi v18, v7, s[4:7], s13 offen
buffer_load_short_d16_hi v22, v7, s[4:7], s13 offen offset:64
buffer_load_short_d16_hi v26, v7, s[4:7], s13 offen offset:128
buffer_load_short_d16_hi v30, v7, s[4:7], s13 offen offset:192
buffer_load_short_d16_hi v34, v7, s[4:7], s13 offen offset:256
buffer_load_short_d16_hi v38, v7, s[4:7], s13 offen offset:320
buffer_load_short_d16_hi v42, v7, s[4:7], s13 offen offset:384
buffer_load_short_d16_hi v46, v7, s[4:7], s13 offen offset:448
buffer_load_short_d16_hi v50, v7, s[4:7], s13 offen offset:512
buffer_load_short_d16_hi v54, v7, s[4:7], s13 offen offset:576
buffer_load_short_d16_hi v58, v7, s[4:7], s13 offen offset:640
buffer_load_short_d16_hi v62, v7, s[4:7], s13 offen offset:704
buffer_load_short_d16_hi v66, v7, s[4:7], s13 offen offset:768
buffer_load_short_d16_hi v70, v7, s[4:7], s13 offen offset:832
buffer_load_short_d16_hi v74, v7, s[4:7], s13 offen offset:896
buffer_load_short_d16_hi v78, v7, s[4:7], s13 offen offset:960
buffer_load_short_d16_hi v82, v7, s[4:7], s13 offen offset:1024
buffer_load_short_d16_hi v86, v7, s[4:7], s13 offen offset:1088
buffer_load_short_d16_hi v90, v7, s[4:7], s13 offen offset:1152
buffer_load_short_d16_hi v94, v7, s[4:7], s13 offen offset:1216
buffer_load_short_d16_hi v98, v7, s[4:7], s13 offen offset:1280
buffer_load_short_d16_hi v102, v7, s[4:7], s13 offen offset:1344
buffer_load_short_d16_hi v106, v7, s[4:7], s13 offen offset:1408
buffer_load_short_d16_hi v110, v7, s[4:7], s13 offen offset:1472
buffer_load_short_d16_hi v114, v7, s[4:7], s13 offen offset:1536
buffer_load_short_d16_hi v118, v7, s[4:7], s13 offen offset:1600
buffer_load_short_d16_hi v122, v7, s[4:7], s13 offen offset:1664
buffer_load_short_d16_hi v126, v7, s[4:7], s13 offen offset:1728
buffer_load_short_d16_hi v130, v7, s[4:7], s13 offen offset:1792
buffer_load_short_d16_hi v134, v7, s[4:7], s13 offen offset:1856
buffer_load_short_d16_hi v138, v7, s[4:7], s13 offen offset:1920
buffer_load_short_d16_hi v142, v7, s[4:7], s13 offen offset:1984
buffer_load_short_d16_hi v17, v7, s[4:7], s14 offen
buffer_load_short_d16_hi v21, v7, s[4:7], s14 offen offset:64
buffer_load_short_d16_hi v25, v7, s[4:7], s14 offen offset:128
buffer_load_short_d16_hi v29, v7, s[4:7], s14 offen offset:192
buffer_load_short_d16_hi v33, v7, s[4:7], s14 offen offset:256
buffer_load_short_d16_hi v37, v7, s[4:7], s14 offen offset:320
buffer_load_short_d16_hi v41, v7, s[4:7], s14 offen offset:384
buffer_load_short_d16_hi v45, v7, s[4:7], s14 offen offset:448
buffer_load_short_d16_hi v49, v7, s[4:7], s14 offen offset:512
buffer_load_short_d16_hi v53, v7, s[4:7], s14 offen offset:576
buffer_load_short_d16_hi v57, v7, s[4:7], s14 offen offset:640
buffer_load_short_d16_hi v61, v7, s[4:7], s14 offen offset:704
buffer_load_short_d16_hi v65, v7, s[4:7], s14 offen offset:768
buffer_load_short_d16_hi v69, v7, s[4:7], s14 offen offset:832
buffer_load_short_d16_hi v73, v7, s[4:7], s14 offen offset:896
buffer_load_short_d16_hi v77, v7, s[4:7], s14 offen offset:960
buffer_load_short_d16_hi v81, v7, s[4:7], s14 offen offset:1024
buffer_load_short_d16_hi v85, v7, s[4:7], s14 offen offset:1088
buffer_load_short_d16_hi v89, v7, s[4:7], s14 offen offset:1152
buffer_load_short_d16_hi v93, v7, s[4:7], s14 offen offset:1216
buffer_load_short_d16_hi v97, v7, s[4:7], s14 offen offset:1280
buffer_load_short_d16_hi v101, v7, s[4:7], s14 offen offset:1344
buffer_load_short_d16_hi v105, v7, s[4:7], s14 offen offset:1408
buffer_load_short_d16_hi v109, v7, s[4:7], s14 offen offset:1472
buffer_load_short_d16_hi v113, v7, s[4:7], s14 offen offset:1536
buffer_load_short_d16_hi v117, v7, s[4:7], s14 offen offset:1600
buffer_load_short_d16_hi v121, v7, s[4:7], s14 offen offset:1664
buffer_load_short_d16_hi v125, v7, s[4:7], s14 offen offset:1728
buffer_load_short_d16_hi v129, v7, s[4:7], s14 offen offset:1792
buffer_load_short_d16_hi v133, v7, s[4:7], s14 offen offset:1856
buffer_load_short_d16_hi v137, v7, s[4:7], s14 offen offset:1920
buffer_load_short_d16_hi v141, v7, s[4:7], s14 offen offset:1984
buffer_load_short_d16_hi v19, v7, s[4:7], s15 offen
buffer_load_short_d16_hi v23, v7, s[4:7], s15 offen offset:64
buffer_load_short_d16_hi v27, v7, s[4:7], s15 offen offset:128
buffer_load_short_d16_hi v31, v7, s[4:7], s15 offen offset:192
buffer_load_short_d16_hi v35, v7, s[4:7], s15 offen offset:256
buffer_load_short_d16_hi v39, v7, s[4:7], s15 offen offset:320
buffer_load_short_d16_hi v43, v7, s[4:7], s15 offen offset:384
buffer_load_short_d16_hi v47, v7, s[4:7], s15 offen offset:448
buffer_load_short_d16_hi v51, v7, s[4:7], s15 offen offset:512
buffer_load_short_d16_hi v55, v7, s[4:7], s15 offen offset:576
buffer_load_short_d16_hi v59, v7, s[4:7], s15 offen offset:640
buffer_load_short_d16_hi v63, v7, s[4:7], s15 offen offset:704
buffer_load_short_d16_hi v67, v7, s[4:7], s15 offen offset:768
buffer_load_short_d16_hi v71, v7, s[4:7], s15 offen offset:832
buffer_load_short_d16_hi v75, v7, s[4:7], s15 offen offset:896
buffer_load_short_d16_hi v79, v7, s[4:7], s15 offen offset:960
buffer_load_short_d16_hi v83, v7, s[4:7], s15 offen offset:1024
buffer_load_short_d16_hi v87, v7, s[4:7], s15 offen offset:1088
buffer_load_short_d16_hi v91, v7, s[4:7], s15 offen offset:1152
buffer_load_short_d16_hi v95, v7, s[4:7], s15 offen offset:1216
buffer_load_short_d16_hi v99, v7, s[4:7], s15 offen offset:1280
buffer_load_short_d16_hi v103, v7, s[4:7], s15 offen offset:1344
buffer_load_short_d16_hi v107, v7, s[4:7], s15 offen offset:1408
buffer_load_short_d16_hi v111, v7, s[4:7], s15 offen offset:1472
buffer_load_short_d16_hi v115, v7, s[4:7], s15 offen offset:1536
buffer_load_short_d16_hi v119, v7, s[4:7], s15 offen offset:1600
buffer_load_short_d16_hi v123, v7, s[4:7], s15 offen offset:1664
buffer_load_short_d16_hi v127, v7, s[4:7], s15 offen offset:1728
buffer_load_short_d16_hi v131, v7, s[4:7], s15 offen offset:1792
buffer_load_short_d16_hi v135, v7, s[4:7], s15 offen offset:1856
buffer_load_short_d16_hi v139, v7, s[4:7], s15 offen offset:1920
buffer_load_short_d16_hi v143, v7, s[4:7], s15 offen offset:1984
s_waitcnt vmcnt(0)
v_pk_add_f32 v[144:145], v[16:17], v[80:81] neg_lo:[0,1] neg_hi:[0,1]
v_pk_add_f32 v[146:147], v[18:19], v[82:83] neg_lo:[0,1] neg_hi:[0,1]
v_pk_add_f32 v[16:17], v[16:17], v[80:81]
v_pk_add_f32 v[18:19], v[18:19], v[82:83]
v_pk_add_f32 v[80:81], v[20:21], v[84:85] neg_lo:[0,1] neg_hi:[0,1]
v_pk_add_f32 v[82:83], v[22:23], v[86:87] neg_lo:[0,1] neg_hi:[0,1]
v_pk_add_f32 v[20:21], v[20:21], v[84:85]
v_pk_add_f32 v[22:23], v[22:23], v[86:87]
v_pk_mul_f32 v[84:85], v[80:81], s[30:31] op_sel_hi:[1,0]
v_pk_mul_f32 v[86:87], v[80:81], s[36:37] op_sel_hi:[1,0] neg_lo:[0,1] neg_hi:[0,1]
v_pk_fma_f32 v[84:85], v[82:83], s[36:37], v[84:85] op_sel_hi:[1,0,1]
v_pk_fma_f32 v[86:87], v[82:83], s[30:31], v[86:87] op_sel_hi:[1,0,1]
v_pk_add_f32 v[80:81], v[24:25], v[88:89] neg_lo:[0,1] neg_hi:[0,1]
v_pk_add_f32 v[82:83], v[26:27], v[90:91] neg_lo:[0,1] neg_hi:[0,1]
v_pk_add_f32 v[24:25], v[24:25], v[88:89]
v_pk_add_f32 v[26:27], v[26:27], v[90:91]
v_pk_mul_f32 v[88:89], v[80:81], s[30:31] op_sel:[0,1]
v_pk_mul_f32 v[90:91], v[80:81], s[34:35] op_sel:[0,1] neg_lo:[0,1] neg_hi:[0,1]
v_pk_fma_f32 v[88:89], v[82:83], s[34:35], v[88:89] op_sel:[0,1,0]
v_pk_fma_f32 v[90:91], v[82:83], s[30:31], v[90:91] op_sel:[0,1,0]
v_pk_add_f32 v[80:81], v[28:29], v[92:93] neg_lo:[0,1] neg_hi:[0,1]
v_pk_add_f32 v[82:83], v[30:31], v[94:95] neg_lo:[0,1] neg_hi:[0,1]
v_pk_add_f32 v[28:29], v[28:29], v[92:93]
v_pk_add_f32 v[30:31], v[30:31], v[94:95]
v_pk_mul_f32 v[92:93], v[80:81], s[32:33] op_sel_hi:[1,0]
v_pk_mul_f32 v[94:95], v[80:81], s[34:35] op_sel_hi:[1,0] neg_lo:[0,1] neg_hi:[0,1]
v_pk_fma_f32 v[92:93], v[82:83], s[34:35], v[92:93] op_sel_hi:[1,0,1]
v_pk_fma_f32 v[94:95], v[82:83], s[32:33], v[94:95] op_sel_hi:[1,0,1]
v_pk_add_f32 v[80:81], v[32:33], v[96:97] neg_lo:[0,1] neg_hi:[0,1]
v_pk_add_f32 v[82:83], v[34:35], v[98:99] neg_lo:[0,1] neg_hi:[0,1]
v_pk_add_f32 v[32:33], v[32:33], v[96:97]
v_pk_add_f32 v[34:35], v[34:35], v[98:99]
v_pk_mul_f32 v[96:97], v[80:81], s[32:33] op_sel:[0,1]
v_pk_mul_f32 v[98:99], v[80:81], s[32:33] op_sel:[0,1] neg_lo:[0,1] neg_hi:[0,1]
v_pk_fma_f32 v[96:97], v[82:83], s[32:33], v[96:97] op_sel:[0,1,0]
v_pk_fma_f32 v[98:99], v[82:83], s[32:33], v[98:99] op_sel:[0,1,0]
v_pk_add_f32 v[80:81], v[36:37], v[100:101] neg_lo:[0,1] neg_hi:[0,1]
v_pk_add_f32 v[82:83], v[38:39], v[102:103] neg_lo:[0,1] neg_hi:[0,1]
v_pk_add_f32 v[36:37], v[36:37], v[100:101]
v_pk_add_f32 v[38:39], v[38:39], v[102:103]
v_pk_mul_f32 v[100:101], v[80:81], s[34:35] op_sel_hi:[1,0]
v_pk_mul_f32 v[102:103], v[80:81], s[32:33] op_sel_hi:[1,0] neg_lo:[0,1] neg_hi:[0,1]
v_pk_fma_f32 v[100:101], v[82:83], s[32:33], v[100:101] op_sel_hi:[1,0,1]
v_pk_fma_f32 v[102:103], v[82:83], s[34:35], v[102:103] op_sel_hi:[1,0,1]
v_pk_add_f32 v[80:81], v[40:41], v[104:105] neg_lo:[0,1] neg_hi:[0,1]
v_pk_add_f32 v[82:83], v[42:43], v[106:107] neg_lo:[0,1] neg_hi:[0,1]
v_pk_add_f32 v[40:41], v[40:41], v[104:105]
v_pk_add_f32 v[42:43], v[42:43], v[106:107]
v_pk_mul_f32 v[104:105], v[80:81], s[34:35] op_sel:[0,1]
v_pk_mul_f32 v[106:107], v[80:81], s[30:31] op_sel:[0,1] neg_lo:[0,1] neg_hi:[0,1]
v_pk_fma_f32 v[104:105], v[82:83], s[30:31], v[104:105] op_sel:[0,1,0]
v_pk_fma_f32 v[106:107], v[82:83], s[34:35], v[106:107] op_sel:[0,1,0]
v_pk_add_f32 v[80:81], v[44:45], v[108:109] neg_lo:[0,1] neg_hi:[0,1]
v_pk_add_f32 v[82:83], v[46:47], v[110:111] neg_lo:[0,1] neg_hi:[0,1]
v_pk_add_f32 v[44:45], v[44:45], v[108:109]
v_pk_add_f32 v[46:47], v[46:47], v[110:111]
v_pk_mul_f32 v[108:109], v[80:81], s[36:37] op_sel_hi:[1,0]
v_pk_mul_f32 v[110:111], v[80:81], s[30:31] op_sel_hi:[1,0] neg_lo:[0,1] neg_hi:[0,1]
v_pk_fma_f32 v[108:109], v[82:83], s[30:31], v[108:109] op_sel_hi:[1,0,1]
v_pk_fma_f32 v[110:111], v[82:83], s[36:37], v[110:111] op_sel_hi:[1,0,1]
v_pk_add_f32 v[80:81], v[50:51], v[114:115] neg_lo:[0,1] neg_hi:[0,1]
v_pk_add_f32 v[82:83], v[112:113], v[48:49] neg_lo:[0,1] neg_hi:[0,1]
v_pk_add_f32 v[48:49], v[48:49], v[112:113]
v_pk_add_f32 v[50:51], v[50:51], v[114:115]
v_pk_add_f32 v[112:113], v[52:53], v[116:117] neg_lo:[0,1] neg_hi:[0,1]
v_pk_add_f32 v[114:115], v[54:55], v[118:119] neg_lo:[0,1] neg_hi:[0,1]
v_pk_add_f32 v[52:53], v[52:53], v[116:117]
v_pk_add_f32 v[54:55], v[54:55], v[118:119]
v_pk_mul_f32 v[116:117], v[112:113], s[36:37] op_sel_hi:[1,0] neg_lo:[0,1] neg_hi:[0,1]
v_pk_mul_f32 v[118:119], v[112:113], s[30:31] op_sel_hi:[1,0] neg_lo:[0,1] neg_hi:[0,1]
v_pk_fma_f32 v[116:117], v[114:115], s[30:31], v[116:117] op_sel_hi:[1,0,1]
v_pk_fma_f32 v[118:119], v[114:115], s[36:37], v[118:119] op_sel_hi:[1,0,1] neg_lo:[0,1,0] neg_hi:[0,1,0]
v_pk_add_f32 v[112:113], v[56:57], v[120:121] neg_lo:[0,1] neg_hi:[0,1]
v_pk_add_f32 v[114:115], v[58:59], v[122:123] neg_lo:[0,1] neg_hi:[0,1]
v_pk_add_f32 v[56:57], v[56:57], v[120:121]
v_pk_add_f32 v[58:59], v[58:59], v[122:123]
v_pk_mul_f32 v[120:121], v[112:113], s[34:35] op_sel:[0,1] neg_lo:[0,1] neg_hi:[0,1]
v_pk_mul_f32 v[122:123], v[112:113], s[30:31] op_sel:[0,1] neg_lo:[0,1] neg_hi:[0,1]
v_pk_fma_f32 v[120:121], v[114:115], s[30:31], v[120:121] op_sel:[0,1,0]
v_pk_fma_f32 v[122:123], v[114:115], s[34:35], v[122:123] op_sel:[0,1,0] neg_lo:[0,1,0] neg_hi:[0,1,0]
v_pk_add_f32 v[112:113], v[60:61], v[124:125] neg_lo:[0,1] neg_hi:[0,1]
v_pk_add_f32 v[114:115], v[62:63], v[126:127] neg_lo:[0,1] neg_hi:[0,1]
v_pk_add_f32 v[60:61], v[60:61], v[124:125]
v_pk_add_f32 v[62:63], v[62:63], v[126:127]
v_pk_mul_f32 v[124:125], v[112:113], s[34:35] op_sel_hi:[1,0] neg_lo:[0,1] neg_hi:[0,1]
v_pk_mul_f32 v[126:127], v[112:113], s[32:33] op_sel_hi:[1,0] neg_lo:[0,1] neg_hi:[0,1]
v_pk_fma_f32 v[124:125], v[114:115], s[32:33], v[124:125] op_sel_hi:[1,0,1]
v_pk_fma_f32 v[126:127], v[114:115], s[34:35], v[126:127] op_sel_hi:[1,0,1] neg_lo:[0,1,0] neg_hi:[0,1,0]
v_pk_add_f32 v[112:113], v[64:65], v[128:129] neg_lo:[0,1] neg_hi:[0,1]
v_pk_add_f32 v[114:115], v[66:67], v[130:131] neg_lo:[0,1] neg_hi:[0,1]
v_pk_add_f32 v[64:65], v[64:65], v[128:129]
v_pk_add_f32 v[66:67], v[66:67], v[130:131]
v_pk_mul_f32 v[128:129], v[112:113], s[32:33] op_sel:[0,1] neg_lo:[0,1] neg_hi:[0,1]
v_pk_mul_f32 v[130:131], v[112:113], s[32:33] op_sel:[0,1] neg_lo:[0,1] neg_hi:[0,1]
v_pk_fma_f32 v[128:129], v[114:115], s[32:33], v[128:129] op_sel:[0,1,0]
v_pk_fma_f32 v[130:131], v[114:115], s[32:33], v[130:131] op_sel:[0,1,0] neg_lo:[0,1,0] neg_hi:[0,1,0]
v_pk_add_f32 v[112:113], v[68:69], v[132:133] neg_lo:[0,1] neg_hi:[0,1]
v_pk_add_f32 v[114:115], v[70:71], v[134:135] neg_lo:[0,1] neg_hi:[0,1]
v_pk_add_f32 v[68:69], v[68:69], v[132:133]
v_pk_add_f32 v[70:71], v[70:71], v[134:135]
v_pk_mul_f32 v[132:133], v[112:113], s[32:33] op_sel_hi:[1,0] neg_lo:[0,1] neg_hi:[0,1]
v_pk_mul_f32 v[134:135], v[112:113], s[34:35] op_sel_hi:[1,0] neg_lo:[0,1] neg_hi:[0,1]
v_pk_fma_f32 v[132:133], v[114:115], s[34:35], v[132:133] op_sel_hi:[1,0,1]
v_pk_fma_f32 v[134:135], v[114:115], s[32:33], v[134:135] op_sel_hi:[1,0,1] neg_lo:[0,1,0] neg_hi:[0,1,0]
v_pk_add_f32 v[112:113], v[72:73], v[136:137] neg_lo:[0,1] neg_hi:[0,1]
v_pk_add_f32 v[114:115], v[74:75], v[138:139] neg_lo:[0,1] neg_hi:[0,1]
v_pk_add_f32 v[72:73], v[72:73], v[136:137]
v_pk_add_f32 v[74:75], v[74:75], v[138:139]
v_pk_mul_f32 v[136:137], v[112:113], s[30:31] op_sel:[0,1] neg_lo:[0,1] neg_hi:[0,1]
v_pk_mul_f32 v[138:139], v[112:113], s[34:35] op_sel:[0,1] neg_lo:[0,1] neg_hi:[0,1]
v_pk_fma_f32 v[136:137], v[114:115], s[34:35], v[136:137] op_sel:[0,1,0]
v_pk_fma_f32 v[138:139], v[114:115], s[30:31], v[138:139] op_sel:[0,1,0] neg_lo:[0,1,0] neg_hi:[0,1,0]
v_pk_add_f32 v[112:113], v[76:77], v[140:141] neg_lo:[0,1] neg_hi:[0,1]
v_pk_add_f32 v[114:115], v[78:79], v[142:143] neg_lo:[0,1] neg_hi:[0,1]
v_pk_add_f32 v[76:77], v[76:77], v[140:141]
v_pk_add_f32 v[78:79], v[78:79], v[142:143]
v_pk_mul_f32 v[140:141], v[112:113], s[30:31] op_sel_hi:[1,0] neg_lo:[0,1] neg_hi:[0,1]
v_pk_mul_f32 v[142:143], v[112:113], s[36:37] op_sel_hi:[1,0] neg_lo:[0,1] neg_hi:[0,1]
v_pk_fma_f32 v[140:141], v[114:115], s[36:37], v[140:141] op_sel_hi:[1,0,1]
v_pk_fma_f32 v[142:143], v[114:115], s[30:31], v[142:143] op_sel_hi:[1,0,1] neg_lo:[0,1,0] neg_hi:[0,1,0]
v_pk_add_f32 v[112:113], v[16:17], v[48:49] neg_lo:[0,1] neg_hi:[0,1]
v_pk_add_f32 v[114:115], v[18:19], v[50:51] neg_lo:[0,1] neg_hi:[0,1]
v_pk_add_f32 v[16:17], v[16:17], v[48:49]
v_pk_add_f32 v[18:19], v[18:19], v[50:51]
v_pk_add_f32 v[48:49], v[20:21], v[52:53] neg_lo:[0,1] neg_hi:[0,1]
v_pk_add_f32 v[50:51], v[22:23], v[54:55] neg_lo:[0,1] neg_hi:[0,1]
v_pk_add_f32 v[20:21], v[20:21], v[52:53]
v_pk_add_f32 v[22:23], v[22:23], v[54:55]
v_pk_mul_f32 v[52:53], v[48:49], s[30:31] op_sel:[0,1]
v_pk_mul_f32 v[54:55], v[48:49], s[34:35] op_sel:[0,1] neg_lo:[0,1] neg_hi:[0,1]
v_pk_fma_f32 v[52:53], v[50:51], s[34:35], v[52:53] op_sel:[0,1,0]
v_pk_fma_f32 v[54:55], v[50:51], s[30:31], v[54:55] op_sel:[0,1,0]
v_pk_add_f32 v[48:49], v[24:25], v[56:57] neg_lo:[0,1] neg_hi:[0,1]
v_pk_add_f32 v[50:51], v[26:27], v[58:59] neg_lo:[0,1] neg_hi:[0,1]
v_pk_add_f32 v[24:25], v[24:25], v[56:57]
v_pk_add_f32 v[26:27], v[26:27], v[58:59]
v_pk_mul_f32 v[56:57], v[48:49], s[32:33] op_sel:[0,1]
v_pk_mul_f32 v[58:59], v[48:49], s[32:33] op_sel:[0,1] neg_lo:[0,1] neg_hi:[0,1]
v_pk_fma_f32 v[56:57], v[50:51], s[32:33], v[56:57] op_sel:[0,1,0]
v_pk_fma_f32 v[58:59], v[50:51], s[32:33], v[58:59] op_sel:[0,1,0]
v_pk_add_f32 v[48:49], v[28:29], v[60:61] neg_lo:[0,1] neg_hi:[0,1]
v_pk_add_f32 v[50:51], v[30:31], v[62:63] neg_lo:[0,1] neg_hi:[0,1]
v_pk_add_f32 v[28:29], v[28:29], v[60:61]
v_pk_add_f32 v[30:31], v[30:31], v[62:63]
v_pk_mul_f32 v[60:61], v[48:49], s[34:35] op_sel:[0,1]
v_pk_mul_f32 v[62:63], v[48:49], s[30:31] op_sel:[0,1] neg_lo:[0,1] neg_hi:[0,1]
v_pk_fma_f32 v[60:61], v[50:51], s[30:31], v[60:61] op_sel:[0,1,0]
v_pk_fma_f32 v[62:63], v[50:51], s[34:35], v[62:63] op_sel:[0,1,0]
v_pk_add_f32 v[48:49], v[34:35], v[66:67] neg_lo:[0,1] neg_hi:[0,1]
v_pk_add_f32 v[50:51], v[64:65], v[32:33] neg_lo:[0,1] neg_hi:[0,1]
v_pk_add_f32 v[32:33], v[32:33], v[64:65]
v_pk_add_f32 v[34:35], v[34:35], v[66:67]
v_pk_add_f32 v[64:65], v[36:37], v[68:69] neg_lo:[0,1] neg_hi:[0,1]
v_pk_add_f32 v[66:67], v[38:39], v[70:71] neg_lo:[0,1] neg_hi:[0,1]
v_pk_add_f32 v[36:37], v[36:37], v[68:69]
v_pk_add_f32 v[38:39], v[38:39], v[70:71]
v_pk_mul_f32 v[68:69], v[64:65], s[34:35] op_sel:[0,1] neg_lo:[0,1] neg_hi:[0,1]
v_pk_mul_f32 v[70:71], v[64:65], s[30:31] op_sel:[0,1] neg_lo:[0,1] neg_hi:[0,1]
v_pk_fma_f32 v[68:69], v[66:67], s[30:31], v[68:69] op_sel:[0,1,0]
v_pk_fma_f32 v[70:71], v[66:67], s[34:35], v[70:71] op_sel:[0,1,0] neg_lo:[0,1,0] neg_hi:[0,1,0]
v_pk_add_f32 v[64:65], v[40:41], v[72:73] neg_lo:[0,1] neg_hi:[0,1]
v_pk_add_f32 v[66:67], v[42:43], v[74:75] neg_lo:[0,1] neg_hi:[0,1]
v_pk_add_f32 v[40:41], v[40:41], v[72:73]
v_pk_add_f32 v[42:43], v[42:43], v[74:75]
v_pk_mul_f32 v[72:73], v[64:65], s[32:33] op_sel:[0,1] neg_lo:[0,1] neg_hi:[0,1]
v_pk_mul_f32 v[74:75], v[64:65], s[32:33] op_sel:[0,1] neg_lo:[0,1] neg_hi:[0,1]
v_pk_fma_f32 v[72:73], v[66:67], s[32:33], v[72:73] op_sel:[0,1,0]
v_pk_fma_f32 v[74:75], v[66:67], s[32:33], v[74:75] op_sel:[0,1,0] neg_lo:[0,1,0] neg_hi:[0,1,0]
v_pk_add_f32 v[64:65], v[44:45], v[76:77] neg_lo:[0,1] neg_hi:[0,1]
v_pk_add_f32 v[66:67], v[46:47], v[78:79] neg_lo:[0,1] neg_hi:[0,1]
v_pk_add_f32 v[44:45], v[44:45], v[76:77]
v_pk_add_f32 v[46:47], v[46:47], v[78:79]
v_pk_mul_f32 v[76:77], v[64:65], s[30:31] op_sel:[0,1] neg_lo:[0,1] neg_hi:[0,1]
v_pk_mul_f32 v[78:79], v[64:65], s[34:35] op_sel:[0,1] neg_lo:[0,1] neg_hi:[0,1]
v_pk_fma_f32 v[76:77], v[66:67], s[34:35], v[76:77] op_sel:[0,1,0]
v_pk_fma_f32 v[78:79], v[66:67], s[30:31], v[78:79] op_sel:[0,1,0] neg_lo:[0,1,0] neg_hi:[0,1,0]
v_pk_add_f32 v[64:65], v[144:145], v[80:81] neg_lo:[0,1] neg_hi:[0,1]
v_pk_add_f32 v[66:67], v[146:147], v[82:83] neg_lo:[0,1] neg_hi:[0,1]
v_pk_add_f32 v[144:145], v[144:145], v[80:81]
v_pk_add_f32 v[146:147], v[146:147], v[82:83]
v_pk_add_f32 v[80:81], v[84:85], v[116:117] neg_lo:[0,1] neg_hi:[0,1]
v_pk_add_f32 v[82:83], v[86:87], v[118:119] neg_lo:[0,1] neg_hi:[0,1]
v_pk_add_f32 v[84:85], v[84:85], v[116:117]
v_pk_add_f32 v[86:87], v[86:87], v[118:119]
v_pk_mul_f32 v[116:117], v[80:81], s[30:31] op_sel:[0,1]
v_pk_mul_f32 v[118:119], v[80:81], s[34:35] op_sel:[0,1] neg_lo:[0,1] neg_hi:[0,1]
v_pk_fma_f32 v[116:117], v[82:83], s[34:35], v[116:117] op_sel:[0,1,0]
v_pk_fma_f32 v[118:119], v[82:83], s[30:31], v[118:119] op_sel:[0,1,0]
v_pk_add_f32 v[80:81], v[88:89], v[120:121] neg_lo:[0,1] neg_hi:[0,1]
v_pk_add_f32 v[82:83], v[90:91], v[122:123] neg_lo:[0,1] neg_hi:[0,1]
v_pk_add_f32 v[88:89], v[88:89], v[120:121]
v_pk_add_f32 v[90:91], v[90:91], v[122:123]
v_pk_mul_f32 v[120:121], v[80:81], s[32:33] op_sel:[0,1]
v_pk_mul_f32 v[122:123], v[80:81], s[32:33] op_sel:[0,1] neg_lo:[0,1] neg_hi:[0,1]
v_pk_fma_f32 v[120:121], v[82:83], s[32:33], v[120:121] op_sel:[0,1,0]
v_pk_fma_f32 v[122:123], v[82:83], s[32:33], v[122:123] op_sel:[0,1,0]
v_pk_add_f32 v[80:81], v[92:93], v[124:125] neg_lo:[0,1] neg_hi:[0,1]
v_pk_add_f32 v[82:83], v[94:95], v[126:127] neg_lo:[0,1] neg_hi:[0,1]
v_pk_add_f32 v[92:93], v[92:93], v[124:125]
v_pk_add_f32 v[94:95], v[94:95], v[126:127]
v_pk_mul_f32 v[124:125], v[80:81], s[34:35] op_sel:[0,1]
v_pk_mul_f32 v[126:127], v[80:81], s[30:31] op_sel:[0,1] neg_lo:[0,1] neg_hi:[0,1]
v_pk_fma_f32 v[124:125], v[82:83], s[30:31], v[124:125] op_sel:[0,1,0]
v_pk_fma_f32 v[126:127], v[82:83], s[34:35], v[126:127] op_sel:[0,1,0]
v_pk_add_f32 v[80:81], v[98:99], v[130:131] neg_lo:[0,1] neg_hi:[0,1]
v_pk_add_f32 v[82:83], v[128:129], v[96:97] neg_lo:[0,1] neg_hi:[0,1]
v_pk_add_f32 v[96:97], v[96:97], v[128:129]
v_pk_add_f32 v[98:99], v[98:99], v[130:131]
v_pk_add_f32 v[128:129], v[100:101], v[132:133] neg_lo:[0,1] neg_hi:[0,1]
v_pk_add_f32 v[130:131], v[102:103], v[134:135] neg_lo:[0,1] neg_hi:[0,1]
v_pk_add_f32 v[100:101], v[100:101], v[132:133]
v_pk_add_f32 v[102:103], v[102:103], v[134:135]
v_pk_mul_f32 v[132:133], v[128:129], s[34:35] op_sel:[0,1] neg_lo:[0,1] neg_hi:[0,1]
v_pk_mul_f32 v[134:135], v[128:129], s[30:31] op_sel:[0,1] neg_lo:[0,1] neg_hi:[0,1]
v_pk_fma_f32 v[132:133], v[130:131], s[30:31], v[132:133] op_sel:[0,1,0]
v_pk_fma_f32 v[134:135], v[130:131], s[34:35], v[134:135] op_sel:[0,1,0] neg_lo:[0,1,0] neg_hi:[0,1,0]
v_pk_add_f32 v[128:129], v[104:105], v[136:137] neg_lo:[0,1] neg_hi:[0,1]
v_pk_add_f32 v[130:131], v[106:107], v[138:139] neg_lo:[0,1] neg_hi:[0,1]
v_pk_add_f32 v[104:105], v[104:105], v[136:137]
v_pk_add_f32 v[106:107], v[106:107], v[138:139]
v_pk_mul_f32 v[136:137], v[128:129], s[32:33] op_sel:[0,1] neg_lo:[0,1] neg_hi:[0,1]
v_pk_mul_f32 v[138:139], v[128:129], s[32:33] op_sel:[0,1] neg_lo:[0,1] neg_hi:[0,1]
v_pk_fma_f32 v[136:137], v[130:131], s[32:33], v[136:137] op_sel:[0,1,0]
v_pk_fma_f32 v[138:139], v[130:131], s[32:33], v[138:139] op_sel:[0,1,0] neg_lo:[0,1,0] neg_hi:[0,1,0]
v_pk_add_f32 v[128:129], v[108:109], v[140:141] neg_lo:[0,1] neg_hi:[0,1]
v_pk_add_f32 v[130:131], v[110:111], v[142:143] neg_lo:[0,1] neg_hi:[0,1]
v_pk_add_f32 v[108:109], v[108:109], v[140:141]
v_pk_add_f32 v[110:111], v[110:111], v[142:143]
v_pk_mul_f32 v[140:141], v[128:129], s[30:31] op_sel:[0,1] neg_lo:[0,1] neg_hi:[0,1]
v_pk_mul_f32 v[142:143], v[128:129], s[34:35] op_sel:[0,1] neg_lo:[0,1] neg_hi:[0,1]
v_pk_fma_f32 v[140:141], v[130:131], s[34:35], v[140:141] op_sel:[0,1,0]
v_pk_fma_f32 v[142:143], v[130:131], s[30:31], v[142:143] op_sel:[0,1,0] neg_lo:[0,1,0] neg_hi:[0,1,0]
v_pk_add_f32 v[128:129], v[16:17], v[32:33] neg_lo:[0,1] neg_hi:[0,1]
v_pk_add_f32 v[130:131], v[18:19], v[34:35] neg_lo:[0,1] neg_hi:[0,1]
v_pk_add_f32 v[16:17], v[16:17], v[32:33]
v_pk_add_f32 v[18:19], v[18:19], v[34:35]
v_pk_add_f32 v[32:33], v[20:21], v[36:37] neg_lo:[0,1] neg_hi:[0,1]
v_pk_add_f32 v[34:35], v[22:23], v[38:39] neg_lo:[0,1] neg_hi:[0,1]
v_pk_add_f32 v[20:21], v[20:21], v[36:37]
v_pk_add_f32 v[22:23], v[22:23], v[38:39]
v_pk_mul_f32 v[36:37], v[32:33], s[32:33] op_sel:[0,1]
v_pk_mul_f32 v[38:39], v[32:33], s[32:33] op_sel:[0,1] neg_lo:[0,1] neg_hi:[0,1]
v_pk_fma_f32 v[36:37], v[34:35], s[32:33], v[36:37] op_sel:[0,1,0]
v_pk_fma_f32 v[38:39], v[34:35], s[32:33], v[38:39] op_sel:[0,1,0]
v_pk_add_f32 v[32:33], v[26:27], v[42:43] neg_lo:[0,1] neg_hi:[0,1]
v_pk_add_f32 v[34:35], v[40:41], v[24:25] neg_lo:[0,1] neg_hi:[0,1]
v_pk_add_f32 v[24:25], v[24:25], v[40:41]
v_pk_add_f32 v[26:27], v[26:27], v[42:43]
v_pk_add_f32 v[40:41], v[28:29], v[44:45] neg_lo:[0,1] neg_hi:[0,1]
v_pk_add_f32 v[42:43], v[30:31], v[46:47] neg_lo:[0,1] neg_hi:[0,1]
v_pk_add_f32 v[28:29], v[28:29], v[44:45]
v_pk_add_f32 v[30:31], v[30:31], v[46:47]
v_pk_mul_f32 v[44:45], v[40:41], s[32:33] op_sel:[0,1] neg_lo:[0,1] neg_hi:[0,1]
v_pk_mul_f32 v[46:47], v[40:41], s[32:33] op_sel:[0,1] neg_lo:[0,1] neg_hi:[0,1]
v_pk_fma_f32 v[44:45], v[42:43], s[32:33], v[44:45] op_sel:[0,1,0]
v_pk_fma_f32 v[46:47], v[42:43], s[32:33], v[46:47] op_sel:[0,1,0] neg_lo:[0,1,0] neg_hi:[0,1,0]
v_pk_add_f32 v[40:41], v[112:113], v[48:49] neg_lo:[0,1] neg_hi:[0,1]
v_pk_add_f32 v[42:43], v[114:115], v[50:51] neg_lo:[0,1] neg_hi:[0,1]
v_pk_add_f32 v[112:113], v[112:113], v[48:49]
v_pk_add_f32 v[114:115], v[114:115], v[50:51]
v_pk_add_f32 v[48:49], v[52:53], v[68:69] neg_lo:[0,1] neg_hi:[0,1]
v_pk_add_f32 v[50:51], v[54:55], v[70:71] neg_lo:[0,1] neg_hi:[0,1]
v_pk_add_f32 v[52:53], v[52:53], v[68:69]
v_pk_add_f32 v[54:55], v[54:55], v[70:71]
v_pk_mul_f32 v[68:69], v[48:49], s[32:33] op_sel:[0,1]
v_pk_mul_f32 v[70:71], v[48:49], s[32:33] op_sel:[0,1] neg_lo:[0,1] neg_hi:[0,1]
v_pk_fma_f32 v[68:69], v[50:51], s[32:33], v[68:69] op_sel:[0,1,0]
v_pk_fma_f32 v[70:71], v[50:51], s[32:33], v[70:71] op_sel:[0,1,0]
v_pk_add_f32 v[48:49], v[58:59], v[74:75] neg_lo:[0,1] neg_hi:[0,1]
v_pk_add_f32 v[50:51], v[72:73], v[56:57] neg_lo:[0,1] neg_hi:[0,1]
v_pk_add_f32 v[56:57], v[56:57], v[72:73]
v_pk_add_f32 v[58:59], v[58:59], v[74:75]
v_pk_add_f32 v[72:73], v[60:61], v[76:77] neg_lo:[0,1] neg_hi:[0,1]
v_pk_add_f32 v[74:75], v[62:63], v[78:79] neg_lo:[0,1] neg_hi:[0,1]
v_pk_add_f32 v[60:61], v[60:61], v[76:77]
v_pk_add_f32 v[62:63], v[62:63], v[78:79]
v_pk_mul_f32 v[76:77], v[72:73], s[32:33] op_sel:[0,1] neg_lo:[0,1] neg_hi:[0,1]
v_pk_mul_f32 v[78:79], v[72:73], s[32:33] op_sel:[0,1] neg_lo:[0,1] neg_hi:[0,1]
v_pk_fma_f32 v[76:77], v[74:75], s[32:33], v[76:77] op_sel:[0,1,0]
v_pk_fma_f32 v[78:79], v[74:75], s[32:33], v[78:79] op_sel:[0,1,0] neg_lo:[0,1,0] neg_hi:[0,1,0]
v_pk_add_f32 v[72:73], v[144:145], v[96:97] neg_lo:[0,1] neg_hi:[0,1]
v_pk_add_f32 v[74:75], v[146:147], v[98:99] neg_lo:[0,1] neg_hi:[0,1]
v_pk_add_f32 v[144:145], v[144:145], v[96:97]
v_pk_add_f32 v[146:147], v[146:147], v[98:99]
v_pk_add_f32 v[96:97], v[84:85], v[100:101] neg_lo:[0,1] neg_hi:[0,1]
v_pk_add_f32 v[98:99], v[86:87], v[102:103] neg_lo:[0,1] neg_hi:[0,1]
v_pk_add_f32 v[84:85], v[84:85], v[100:101]
v_pk_add_f32 v[86:87], v[86:87], v[102:103]
v_pk_mul_f32 v[100:101], v[96:97], s[32:33] op_sel:[0,1]
v_pk_mul_f32 v[102:103], v[96:97], s[32:33] op_sel:[0,1] neg_lo:[0,1] neg_hi:[0,1]
v_pk_fma_f32 v[100:101], v[98:99], s[32:33], v[100:101] op_sel:[0,1,0]
v_pk_fma_f32 v[102:103], v[98:99], s[32:33], v[102:103] op_sel:[0,1,0]
v_pk_add_f32 v[96:97], v[90:91], v[106:107] neg_lo:[0,1] neg_hi:[0,1]
v_pk_add_f32 v[98:99], v[104:105], v[88:89] neg_lo:[0,1] neg_hi:[0,1]
v_pk_add_f32 v[88:89], v[88:89], v[104:105]
v_pk_add_f32 v[90:91], v[90:91], v[106:107]
v_pk_add_f32 v[104:105], v[92:93], v[108:109] neg_lo:[0,1] neg_hi:[0,1]
v_pk_add_f32 v[106:107], v[94:95], v[110:111] neg_lo:[0,1] neg_hi:[0,1]
v_pk_add_f32 v[92:93], v[92:93], v[108:109]
v_pk_add_f32 v[94:95], v[94:95], v[110:111]
v_pk_mul_f32 v[108:109], v[104:105], s[32:33] op_sel:[0,1] neg_lo:[0,1] neg_hi:[0,1]
v_pk_mul_f32 v[110:111], v[104:105], s[32:33] op_sel:[0,1] neg_lo:[0,1] neg_hi:[0,1]
v_pk_fma_f32 v[108:109], v[106:107], s[32:33], v[108:109] op_sel:[0,1,0]
v_pk_fma_f32 v[110:111], v[106:107], s[32:33], v[110:111] op_sel:[0,1,0] neg_lo:[0,1,0] neg_hi:[0,1,0]
v_pk_add_f32 v[104:105], v[64:65], v[80:81] neg_lo:[0,1] neg_hi:[0,1]
v_pk_add_f32 v[106:107], v[66:67], v[82:83] neg_lo:[0,1] neg_hi:[0,1]
v_pk_add_f32 v[64:65], v[64:65], v[80:81]
v_pk_add_f32 v[66:67], v[66:67], v[82:83]
v_pk_add_f32 v[80:81], v[116:117], v[132:133] neg_lo:[0,1] neg_hi:[0,1]
v_pk_add_f32 v[82:83], v[118:119], v[134:135] neg_lo:[0,1] neg_hi:[0,1]
v_pk_add_f32 v[116:117], v[116:117], v[132:133]
v_pk_add_f32 v[118:119], v[118:119], v[134:135]
v_pk_mul_f32 v[132:133], v[80:81], s[32:33] op_sel:[0,1]
v_pk_mul_f32 v[134:135], v[80:81], s[32:33] op_sel:[0,1] neg_lo:[0,1] neg_hi:[0,1]
v_pk_fma_f32 v[132:133], v[82:83], s[32:33], v[132:133] op_sel:[0,1,0]
v_pk_fma_f32 v[134:135], v[82:83], s[32:33], v[134:135] op_sel:[0,1,0]
v_pk_add_f32 v[80:81], v[122:123], v[138:139] neg_lo:[0,1] neg_hi:[0,1]
v_pk_add_f32 v[82:83], v[136:137], v[120:121] neg_lo:[0,1] neg_hi:[0,1]
v_pk_add_f32 v[120:121], v[120:121], v[136:137]
v_pk_add_f32 v[122:123], v[122:123], v[138:139]
v_pk_add_f32 v[136:137], v[124:125], v[140:141] neg_lo:[0,1] neg_hi:[0,1]
v_pk_add_f32 v[138:139], v[126:127], v[142:143] neg_lo:[0,1] neg_hi:[0,1]
v_pk_add_f32 v[124:125], v[124:125], v[140:141]
v_pk_add_f32 v[126:127], v[126:127], v[142:143]
v_pk_mul_f32 v[140:141], v[136:137], s[32:33] op_sel:[0,1] neg_lo:[0,1] neg_hi:[0,1]
v_pk_mul_f32 v[142:143], v[136:137], s[32:33] op_sel:[0,1] neg_lo:[0,1] neg_hi:[0,1]
v_pk_fma_f32 v[140:141], v[138:139], s[32:33], v[140:141] op_sel:[0,1,0]
v_pk_fma_f32 v[142:143], v[138:139], s[32:33], v[142:143] op_sel:[0,1,0] neg_lo:[0,1,0] neg_hi:[0,1,0]
v_pk_add_f32 v[136:137], v[16:17], v[24:25] neg_lo:[0,1] neg_hi:[0,1]
v_pk_add_f32 v[138:139], v[18:19], v[26:27] neg_lo:[0,1] neg_hi:[0,1]
v_pk_add_f32 v[16:17], v[16:17], v[24:25]
v_pk_add_f32 v[18:19], v[18:19], v[26:27]
v_pk_add_f32 v[24:25], v[22:23], v[30:31] neg_lo:[0,1] neg_hi:[0,1]
v_pk_add_f32 v[26:27], v[28:29], v[20:21] neg_lo:[0,1] neg_hi:[0,1]
v_pk_add_f32 v[20:21], v[20:21], v[28:29]
v_pk_add_f32 v[22:23], v[22:23], v[30:31]
v_pk_add_f32 v[28:29], v[128:129], v[32:33] neg_lo:[0,1] neg_hi:[0,1]
v_pk_add_f32 v[30:31], v[130:131], v[34:35] neg_lo:[0,1] neg_hi:[0,1]
v_pk_add_f32 v[128:129], v[128:129], v[32:33]
v_pk_add_f32 v[130:131], v[130:131], v[34:35]
v_pk_add_f32 v[32:33], v[38:39], v[46:47] neg_lo:[0,1] neg_hi:[0,1]
v_pk_add_f32 v[34:35], v[44:45], v[36:37] neg_lo:[0,1] neg_hi:[0,1]
v_pk_add_f32 v[36:37], v[36:37], v[44:45]
v_pk_add_f32 v[38:39], v[38:39], v[46:47]
v_pk_add_f32 v[44:45], v[112:113], v[56:57] neg_lo:[0,1] neg_hi:[0,1]
v_pk_add_f32 v[46:47], v[114:115], v[58:59] neg_lo:[0,1] neg_hi:[0,1]
v_pk_add_f32 v[112:113], v[112:113], v[56:57]
v_pk_add_f32 v[114:115], v[114:115], v[58:59]
v_pk_add_f32 v[56:57], v[54:55], v[62:63] neg_lo:[0,1] neg_hi:[0,1]
v_pk_add_f32 v[58:59], v[60:61], v[52:53] neg_lo:[0,1] neg_hi:[0,1]
v_pk_add_f32 v[52:53], v[52:53], v[60:61]
v_pk_add_f32 v[54:55], v[54:55], v[62:63]
v_pk_add_f32 v[60:61], v[40:41], v[48:49] neg_lo:[0,1] neg_hi:[0,1]
v_pk_add_f32 v[62:63], v[42:43], v[50:51] neg_lo:[0,1] neg_hi:[0,1]
v_pk_add_f32 v[40:41], v[40:41], v[48:49]
v_pk_add_f32 v[42:43], v[42:43], v[50:51]
v_pk_add_f32 v[48:49], v[70:71], v[78:79] neg_lo:[0,1] neg_hi:[0,1]
v_pk_add_f32 v[50:51], v[76:77], v[68:69] neg_lo:[0,1] neg_hi:[0,1]
v_pk_add_f32 v[68:69], v[68:69], v[76:77]
v_pk_add_f32 v[70:71], v[70:71], v[78:79]
v_pk_add_f32 v[76:77], v[144:145], v[88:89] neg_lo:[0,1] neg_hi:[0,1]
v_pk_add_f32 v[78:79], v[146:147], v[90:91] neg_lo:[0,1] neg_hi:[0,1]
v_pk_add_f32 v[144:145], v[144:145], v[88:89]
v_pk_add_f32 v[146:147], v[146:147], v[90:91]
v_pk_add_f32 v[88:89], v[86:87], v[94:95] neg_lo:[0,1] neg_hi:[0,1]
v_pk_add_f32 v[90:91], v[92:93], v[84:85] neg_lo:[0,1] neg_hi:[0,1]
v_pk_add_f32 v[84:85], v[84:85], v[92:93]
v_pk_add_f32 v[86:87], v[86:87], v[94:95]
v_pk_add_f32 v[92:93], v[72:73], v[96:97] neg_lo:[0,1] neg_hi:[0,1]
v_pk_add_f32 v[94:95], v[74:75], v[98:99] neg_lo:[0,1] neg_hi:[0,1]
v_pk_add_f32 v[72:73], v[72:73], v[96:97]
v_pk_add_f32 v[74:75], v[74:75], v[98:99]
v_pk_add_f32 v[96:97], v[102:103], v[110:111] neg_lo:[0,1] neg_hi:[0,1]
v_pk_add_f32 v[98:99], v[108:109], v[100:101] neg_lo:[0,1] neg_hi:[0,1]
v_pk_add_f32 v[100:101], v[100:101], v[108:109]
v_pk_add_f32 v[102:103], v[102:103], v[110:111]
v_pk_add_f32 v[108:109], v[64:65], v[120:121] neg_lo:[0,1] neg_hi:[0,1]
v_pk_add_f32 v[110:111], v[66:67], v[122:123] neg_lo:[0,1] neg_hi:[0,1]
v_pk_add_f32 v[64:65], v[64:65], v[120:121]
v_pk_add_f32 v[66:67], v[66:67], v[122:123]
v_pk_add_f32 v[120:121], v[118:119], v[126:127] neg_lo:[0,1] neg_hi:[0,1]
v_pk_add_f32 v[122:123], v[124:125], v[116:117] neg_lo:[0,1] neg_hi:[0,1]
v_pk_add_f32 v[116:117], v[116:117], v[124:125]
v_pk_add_f32 v[118:119], v[118:119], v[126:127]
v_pk_add_f32 v[124:125], v[104:105], v[80:81] neg_lo:[0,1] neg_hi:[0,1]
v_pk_add_f32 v[126:127], v[106:107], v[82:83] neg_lo:[0,1] neg_hi:[0,1]
v_pk_add_f32 v[104:105], v[104:105], v[80:81]
v_pk_add_f32 v[106:107], v[106:107], v[82:83]
v_pk_add_f32 v[80:81], v[134:135], v[142:143] neg_lo:[0,1] neg_hi:[0,1]
v_pk_add_f32 v[82:83], v[140:141], v[132:133] neg_lo:[0,1] neg_hi:[0,1]
v_pk_add_f32 v[132:133], v[132:133], v[140:141]
v_pk_add_f32 v[134:135], v[134:135], v[142:143]
v_pk_add_f32 v[140:141], v[16:17], v[20:21] neg_lo:[0,1] neg_hi:[0,1]
v_pk_add_f32 v[142:143], v[18:19], v[22:23] neg_lo:[0,1] neg_hi:[0,1]
v_pk_add_f32 v[16:17], v[16:17], v[20:21]
v_pk_add_f32 v[18:19], v[18:19], v[22:23]
v_pk_add_f32 v[20:21], v[136:137], v[24:25] neg_lo:[0,1] neg_hi:[0,1]
v_pk_add_f32 v[22:23], v[138:139], v[26:27] neg_lo:[0,1] neg_hi:[0,1]
v_pk_add_f32 v[136:137], v[136:137], v[24:25]
v_pk_add_f32 v[138:139], v[138:139], v[26:27]
v_pk_add_f32 v[24:25], v[128:129], v[36:37] neg_lo:[0,1] neg_hi:[0,1]
v_pk_add_f32 v[26:27], v[130:131], v[38:39] neg_lo:[0,1] neg_hi:[0,1]
v_pk_add_f32 v[128:129], v[128:129], v[36:37]
v_pk_add_f32 v[130:131], v[130:131], v[38:39]
v_pk_add_f32 v[36:37], v[28:29], v[32:33] neg_lo:[0,1] neg_hi:[0,1]
v_pk_add_f32 v[38:39], v[30:31], v[34:35] neg_lo:[0,1] neg_hi:[0,1]
v_pk_add_f32 v[28:29], v[28:29], v[32:33]
v_pk_add_f32 v[30:31], v[30:31], v[34:35]
v_pk_add_f32 v[32:33], v[112:113], v[52:53] neg_lo:[0,1] neg_hi:[0,1]
v_pk_add_f32 v[34:35], v[114:115], v[54:55] neg_lo:[0,1] neg_hi:[0,1]
v_pk_add_f32 v[112:113], v[112:113], v[52:53]
v_pk_add_f32 v[114:115], v[114:115], v[54:55]
v_pk_add_f32 v[52:53], v[44:45], v[56:57] neg_lo:[0,1] neg_hi:[0,1]
v_pk_add_f32 v[54:55], v[46:47], v[58:59] neg_lo:[0,1] neg_hi:[0,1]
v_pk_add_f32 v[44:45], v[44:45], v[56:57]
v_pk_add_f32 v[46:47], v[46:47], v[58:59]
v_pk_add_f32 v[56:57], v[40:41], v[68:69] neg_lo:[0,1] neg_hi:[0,1]
v_pk_add_f32 v[58:59], v[42:43], v[70:71] neg_lo:[0,1] neg_hi:[0,1]
v_pk_add_f32 v[40:41], v[40:41], v[68:69]
v_pk_add_f32 v[42:43], v[42:43], v[70:71]
v_pk_add_f32 v[68:69], v[60:61], v[48:49] neg_lo:[0,1] neg_hi:[0,1]
v_pk_add_f32 v[70:71], v[62:63], v[50:51] neg_lo:[0,1] neg_hi:[0,1]
v_pk_add_f32 v[60:61], v[60:61], v[48:49]
v_pk_add_f32 v[62:63], v[62:63], v[50:51]
v_pk_add_f32 v[48:49], v[144:145], v[84:85] neg_lo:[0,1] neg_hi:[0,1]
v_pk_add_f32 v[50:51], v[146:147], v[86:87] neg_lo:[0,1] neg_hi:[0,1]
v_pk_add_f32 v[144:145], v[144:145], v[84:85]
v_pk_add_f32 v[146:147], v[146:147], v[86:87]
v_pk_add_f32 v[84:85], v[76:77], v[88:89] neg_lo:[0,1] neg_hi:[0,1]
v_pk_add_f32 v[86:87], v[78:79], v[90:91] neg_lo:[0,1] neg_hi:[0,1]
v_pk_add_f32 v[76:77], v[76:77], v[88:89]
v_pk_add_f32 v[78:79], v[78:79], v[90:91]
v_pk_add_f32 v[88:89], v[72:73], v[100:101] neg_lo:[0,1] neg_hi:[0,1]
v_pk_add_f32 v[90:91], v[74:75], v[102:103] neg_lo:[0,1] neg_hi:[0,1]
v_pk_add_f32 v[72:73], v[72:73], v[100:101]
v_pk_add_f32 v[74:75], v[74:75], v[102:103]
v_pk_add_f32 v[100:101], v[92:93], v[96:97] neg_lo:[0,1] neg_hi:[0,1]
v_pk_add_f32 v[102:103], v[94:95], v[98:99] neg_lo:[0,1] neg_hi:[0,1]
v_pk_add_f32 v[92:93], v[92:93], v[96:97]
v_pk_add_f32 v[94:95], v[94:95], v[98:99]
v_pk_add_f32 v[96:97], v[64:65], v[116:117] neg_lo:[0,1] neg_hi:[0,1]
v_pk_add_f32 v[98:99], v[66:67], v[118:119] neg_lo:[0,1] neg_hi:[0,1]
v_pk_add_f32 v[64:65], v[64:65], v[116:117]
v_pk_add_f32 v[66:67], v[66:67], v[118:119]
v_pk_add_f32 v[116:117], v[108:109], v[120:121] neg_lo:[0,1] neg_hi:[0,1]
v_pk_add_f32 v[118:119], v[110:111], v[122:123] neg_lo:[0,1] neg_hi:[0,1]
v_pk_add_f32 v[108:109], v[108:109], v[120:121]
v_pk_add_f32 v[110:111], v[110:111], v[122:123]
v_pk_add_f32 v[120:121], v[104:105], v[132:133] neg_lo:[0,1] neg_hi:[0,1]
v_pk_add_f32 v[122:123], v[106:107], v[134:135] neg_lo:[0,1] neg_hi:[0,1]
v_pk_add_f32 v[104:105], v[104:105], v[132:133]
v_pk_add_f32 v[106:107], v[106:107], v[134:135]
v_pk_add_f32 v[132:133], v[124:125], v[80:81] neg_lo:[0,1] neg_hi:[0,1]
v_pk_add_f32 v[134:135], v[126:127], v[82:83] neg_lo:[0,1] neg_hi:[0,1]
v_pk_add_f32 v[124:125], v[124:125], v[80:81]
v_pk_add_f32 v[126:127], v[126:127], v[82:83]
v_mul_f32 v151, 0xba800000, v3
v_cos_f32 v150, v151
v_sin_f32 v151, v151
v_mul_f32 v149, 0xbb000000, v3
v_cos_f32 v148, v149
v_sin_f32 v149, v149
v_pk_mul_f32 v[80:81], v[144:145], v[150:151] op_sel_hi:[1,0]
v_pk_fma_f32 v[80:81], v[146:147], v[150:151], v[80:81] op_sel:[0,1,0] neg_lo:[1,0,0] neg_hi:[1,0,0]
v_pk_mul_f32 v[146:147], v[146:147], v[150:151] op_sel_hi:[1,0]
v_pk_fma_f32 v[146:147], v[144:145], v[150:151], v[146:147] op_sel:[0,1,0]
v_mul_f32 v151, 0xbb400000, v3
v_cos_f32 v150, v151
v_sin_f32 v151, v151
v_pk_mul_f32 v[144:145], v[112:113], v[148:149] op_sel_hi:[1,0]
v_pk_fma_f32 v[144:145], v[114:115], v[148:149], v[144:145] op_sel:[0,1,0] neg_lo:[1,0,0] neg_hi:[1,0,0]
v_pk_mul_f32 v[114:115], v[114:115], v[148:149] op_sel_hi:[1,0]
v_pk_fma_f32 v[114:115], v[112:113], v[148:149], v[114:115] op_sel:[0,1,0]
v_mul_f32 v149, 0xbb800000, v3
v_cos_f32 v148, v149
v_sin_f32 v149, v149
v_pk_mul_f32 v[112:113], v[64:65], v[150:151] op_sel_hi:[1,0]
v_pk_fma_f32 v[112:113], v[66:67], v[150:151], v[112:113] op_sel:[0,1,0] neg_lo:[1,0,0] neg_hi:[1,0,0]
v_pk_mul_f32 v[66:67], v[66:67], v[150:151] op_sel_hi:[1,0]
v_pk_fma_f32 v[66:67], v[64:65], v[150:151], v[66:67] op_sel:[0,1,0]
v_mul_f32 v151, 0xbba00000, v3
v_cos_f32 v150, v151
v_sin_f32 v151, v151
v_pk_mul_f32 v[64:65], v[128:129], v[148:149] op_sel_hi:[1,0]
v_pk_fma_f32 v[64:65], v[130:131], v[148:149], v[64:65] op_sel:[0,1,0] neg_lo:[1,0,0] neg_hi:[1,0,0]
v_pk_mul_f32 v[130:131], v[130:131], v[148:149] op_sel_hi:[1,0]
v_pk_fma_f32 v[130:131], v[128:129], v[148:149], v[130:131] op_sel:[0,1,0]
v_mul_f32 v149, 0xbbc00000, v3
v_cos_f32 v148, v149
v_sin_f32 v149, v149
v_pk_mul_f32 v[128:129], v[72:73], v[150:151] op_sel_hi:[1,0]
v_pk_fma_f32 v[128:129], v[74:75], v[150:151], v[128:129] op_sel:[0,1,0] neg_lo:[1,0,0] neg_hi:[1,0,0]
v_pk_mul_f32 v[74:75], v[74:75], v[150:151] op_sel_hi:[1,0]
v_pk_fma_f32 v[74:75], v[72:73], v[150:151], v[74:75] op_sel:[0,1,0]
v_mul_f32 v151, 0xbbe00000, v3
v_cos_f32 v150, v151
v_sin_f32 v151, v151
v_pk_mul_f32 v[72:73], v[40:41], v[148:149] op_sel_hi:[1,0]
v_pk_fma_f32 v[72:73], v[42:43], v[148:149], v[72:73] op_sel:[0,1,0] neg_lo:[1,0,0] neg_hi:[1,0,0]
v_pk_mul_f32 v[42:43], v[42:43], v[148:149] op_sel_hi:[1,0]
v_pk_fma_f32 v[42:43], v[40:41], v[148:149], v[42:43] op_sel:[0,1,0]
v_mul_f32 v149, 0xbc000000, v3
v_cos_f32 v148, v149
v_sin_f32 v149, v149
v_pk_mul_f32 v[40:41], v[104:105], v[150:151] op_sel_hi:[1,0]
v_pk_fma_f32 v[40:41], v[106:107], v[150:151], v[40:41] op_sel:[0,1,0] neg_lo:[1,0,0] neg_hi:[1,0,0]
v_pk_mul_f32 v[106:107], v[106:107], v[150:151] op_sel_hi:[1,0]
v_pk_fma_f32 v[106:107], v[104:105], v[150:151], v[106:107] op_sel:[0,1,0]
v_mul_f32 v151, 0xbc100000, v3
v_cos_f32 v150, v151
v_sin_f32 v151, v151
v_pk_mul_f32 v[104:105], v[136:137], v[148:149] op_sel_hi:[1,0]
v_pk_fma_f32 v[104:105], v[138:139], v[148:149], v[104:105] op_sel:[0,1,0] neg_lo:[1,0,0] neg_hi:[1,0,0]
v_pk_mul_f32 v[138:139], v[138:139], v[148:149] op_sel_hi:[1,0]
v_pk_fma_f32 v[138:139], v[136:137], v[148:149], v[138:139] op_sel:[0,1,0]
v_mul_f32 v149, 0xbc200000, v3
v_cos_f32 v148, v149
v_sin_f32 v149, v149
v_pk_mul_f32 v[136:137], v[76:77], v[150:151] op_sel_hi:[1,0]
v_pk_fma_f32 v[136:137], v[78:79], v[150:151], v[136:137] op_sel:[0,1,0] neg_lo:[1,0,0] neg_hi:[1,0,0]
v_pk_mul_f32 v[78:79], v[78:79], v[150:151] op_sel_hi:[1,0]
v_pk_fma_f32 v[78:79], v[76:77], v[150:151], v[78:79] op_sel:[0,1,0]
v_mul_f32 v151, 0xbc300000, v3
v_cos_f32 v150, v151
v_sin_f32 v151, v151
v_pk_mul_f32 v[76:77], v[44:45], v[148:149] op_sel_hi:[1,0]
v_pk_fma_f32 v[76:77], v[46:47], v[148:149], v[76:77] op_sel:[0,1,0] neg_lo:[1,0,0] neg_hi:[1,0,0]
v_pk_mul_f32 v[46:47], v[46:47], v[148:149] op_sel_hi:[1,0]
v_pk_fma_f32 v[46:47], v[44:45], v[148:149], v[46:47] op_sel:[0,1,0]
v_mul_f32 v149, 0xbc400000, v3
v_cos_f32 v148, v149
v_sin_f32 v149, v149
v_pk_mul_f32 v[44:45], v[108:109], v[150:151] op_sel_hi:[1,0]
v_pk_fma_f32 v[44:45], v[110:111], v[150:151], v[44:45] op_sel:[0,1,0] neg_lo:[1,0,0] neg_hi:[1,0,0]
v_pk_mul_f32 v[110:111], v[110:111], v[150:151] op_sel_hi:[1,0]
v_pk_fma_f32 v[110:111], v[108:109], v[150:151], v[110:111] op_sel:[0,1,0]
v_mul_f32 v151, 0xbc500000, v3
v_cos_f32 v150, v151
v_sin_f32 v151, v151
v_pk_mul_f32 v[108:109], v[28:29], v[148:149] op_sel_hi:[1,0]
v_pk_fma_f32 v[108:109], v[30:31], v[148:149], v[108:109] op_sel:[0,1,0] neg_lo:[1,0,0] neg_hi:[1,0,0]
v_pk_mul_f32 v[30:31], v[30:31], v[148:149] op_sel_hi:[1,0]
v_pk_fma_f32 v[30:31], v[28:29], v[148:149], v[30:31] op_sel:[0,1,0]
v_mul_f32 v149, 0xbc600000, v3
v_cos_f32 v148, v149
v_sin_f32 v149, v149
v_pk_mul_f32 v[28:29], v[92:93], v[150:151] op_sel_hi:[1,0]
v_pk_fma_f32 v[28:29], v[94:95], v[150:151], v[28:29] op_sel:[0,1,0] neg_lo:[1,0,0] neg_hi:[1,0,0]
v_pk_mul_f32 v[94:95], v[94:95], v[150:151] op_sel_hi:[1,0]
v_pk_fma_f32 v[94:95], v[92:93], v[150:151], v[94:95] op_sel:[0,1,0]
v_mul_f32 v151, 0xbc700000, v3
v_cos_f32 v150, v151
v_sin_f32 v151, v151
v_pk_mul_f32 v[92:93], v[60:61], v[148:149] op_sel_hi:[1,0]
v_pk_fma_f32 v[92:93], v[62:63], v[148:149], v[92:93] op_sel:[0,1,0] neg_lo:[1,0,0] neg_hi:[1,0,0]
v_pk_mul_f32 v[62:63], v[62:63], v[148:149] op_sel_hi:[1,0]
v_pk_fma_f32 v[62:63], v[60:61], v[148:149], v[62:63] op_sel:[0,1,0]
v_mul_f32 v149, 0xbc800000, v3
v_cos_f32 v148, v149
v_sin_f32 v149, v149
v_pk_mul_f32 v[60:61], v[124:125], v[150:151] op_sel_hi:[1,0]
v_pk_fma_f32 v[60:61], v[126:127], v[150:151], v[60:61] op_sel:[0,1,0] neg_lo:[1,0,0] neg_hi:[1,0,0]
v_pk_mul_f32 v[126:127], v[126:127], v[150:151] op_sel_hi:[1,0]
v_pk_fma_f32 v[126:127], v[124:125], v[150:151], v[126:127] op_sel:[0,1,0]
v_mul_f32 v151, 0xbc880000, v3
v_cos_f32 v150, v151
v_sin_f32 v151, v151
v_pk_mul_f32 v[124:125], v[140:141], v[148:149] op_sel_hi:[1,0]
v_pk_fma_f32 v[124:125], v[142:143], v[148:149], v[124:125] op_sel:[0,1,0] neg_lo:[1,0,0] neg_hi:[1,0,0]
v_pk_mul_f32 v[142:143], v[142:143], v[148:149] op_sel_hi:[1,0]
v_pk_fma_f32 v[142:143], v[140:141], v[148:149], v[142:143] op_sel:[0,1,0]
v_mul_f32 v149, 0xbc900000, v3
v_cos_f32 v148, v149
v_sin_f32 v149, v149
v_pk_mul_f32 v[140:141], v[48:49], v[150:151] op_sel_hi:[1,0]
v_pk_fma_f32 v[140:141], v[50:51], v[150:151], v[140:141] op_sel:[0,1,0] neg_lo:[1,0,0] neg_hi:[1,0,0]
v_pk_mul_f32 v[50:51], v[50:51], v[150:151] op_sel_hi:[1,0]
v_pk_fma_f32 v[50:51], v[48:49], v[150:151], v[50:51] op_sel:[0,1,0]
v_mul_f32 v151, 0xbc980000, v3
v_cos_f32 v150, v151
v_sin_f32 v151, v151
v_pk_mul_f32 v[48:49], v[32:33], v[148:149] op_sel_hi:[1,0]
v_pk_fma_f32 v[48:49], v[34:35], v[148:149], v[48:49] op_sel:[0,1,0] neg_lo:[1,0,0] neg_hi:[1,0,0]
v_pk_mul_f32 v[34:35], v[34:35], v[148:149] op_sel_hi:[1,0]
v_pk_fma_f32 v[34:35], v[32:33], v[148:149], v[34:35] op_sel:[0,1,0]
v_mul_f32 v149, 0xbca00000, v3
v_cos_f32 v148, v149
v_sin_f32 v149, v149
v_pk_mul_f32 v[32:33], v[96:97], v[150:151] op_sel_hi:[1,0]
v_pk_fma_f32 v[32:33], v[98:99], v[150:151], v[32:33] op_sel:[0,1,0] neg_lo:[1,0,0] neg_hi:[1,0,0]
v_pk_mul_f32 v[98:99], v[98:99], v[150:151] op_sel_hi:[1,0]
v_pk_fma_f32 v[98:99], v[96:97], v[150:151], v[98:99] op_sel:[0,1,0]
v_mul_f32 v151, 0xbca80000, v3
v_cos_f32 v150, v151
v_sin_f32 v151, v151
v_pk_mul_f32 v[96:97], v[24:25], v[148:149] op_sel_hi:[1,0]
v_pk_fma_f32 v[96:97], v[26:27], v[148:149], v[96:97] op_sel:[0,1,0] neg_lo:[1,0,0] neg_hi:[1,0,0]
v_pk_mul_f32 v[26:27], v[26:27], v[148:149] op_sel_hi:[1,0]
v_pk_fma_f32 v[26:27], v[24:25], v[148:149], v[26:27] op_sel:[0,1,0]
v_mul_f32 v149, 0xbcb00000, v3
v_cos_f32 v148, v149
v_sin_f32 v149, v149
v_pk_mul_f32 v[24:25], v[88:89], v[150:151] op_sel_hi:[1,0]
v_pk_fma_f32 v[24:25], v[90:91], v[150:151], v[24:25] op_sel:[0,1,0] neg_lo:[1,0,0] neg_hi:[1,0,0]
v_pk_mul_f32 v[90:91], v[90:91], v[150:151] op_sel_hi:[1,0]
v_pk_fma_f32 v[90:91], v[88:89], v[150:151], v[90:91] op_sel:[0,1,0]
v_mul_f32 v151, 0xbcb80000, v3
v_cos_f32 v150, v151
v_sin_f32 v151, v151
v_pk_mul_f32 v[88:89], v[56:57], v[148:149] op_sel_hi:[1,0]
v_pk_fma_f32 v[88:89], v[58:59], v[148:149], v[88:89] op_sel:[0,1,0] neg_lo:[1,0,0] neg_hi:[1,0,0]
v_pk_mul_f32 v[58:59], v[58:59], v[148:149] op_sel_hi:[1,0]
v_pk_fma_f32 v[58:59], v[56:57], v[148:149], v[58:59] op_sel:[0,1,0]
v_mul_f32 v149, 0xbcc00000, v3
v_cos_f32 v148, v149
v_sin_f32 v149, v149
v_pk_mul_f32 v[56:57], v[120:121], v[150:151] op_sel_hi:[1,0]
v_pk_fma_f32 v[56:57], v[122:123], v[150:151], v[56:57] op_sel:[0,1,0] neg_lo:[1,0,0] neg_hi:[1,0,0]
v_pk_mul_f32 v[122:123], v[122:123], v[150:151] op_sel_hi:[1,0]
v_pk_fma_f32 v[122:123], v[120:121], v[150:151], v[122:123] op_sel:[0,1,0]
v_mul_f32 v151, 0xbcc80000, v3
v_cos_f32 v150, v151
v_sin_f32 v151, v151
v_pk_mul_f32 v[120:121], v[20:21], v[148:149] op_sel_hi:[1,0]
v_pk_fma_f32 v[120:121], v[22:23], v[148:149], v[120:121] op_sel:[0,1,0] neg_lo:[1,0,0] neg_hi:[1,0,0]
v_pk_mul_f32 v[22:23], v[22:23], v[148:149] op_sel_hi:[1,0]
v_pk_fma_f32 v[22:23], v[20:21], v[148:149], v[22:23] op_sel:[0,1,0]
v_mul_f32 v149, 0xbcd00000, v3
v_cos_f32 v148, v149
v_sin_f32 v149, v149
v_pk_mul_f32 v[20:21], v[84:85], v[150:151] op_sel_hi:[1,0]
v_pk_fma_f32 v[20:21], v[86:87], v[150:151], v[20:21] op_sel:[0,1,0] neg_lo:[1,0,0] neg_hi:[1,0,0]
v_pk_mul_f32 v[86:87], v[86:87], v[150:151] op_sel_hi:[1,0]
v_pk_fma_f32 v[86:87], v[84:85], v[150:151], v[86:87] op_sel:[0,1,0]
v_mul_f32 v151, 0xbcd80000, v3
v_cos_f32 v150, v151
v_sin_f32 v151, v151
v_pk_mul_f32 v[84:85], v[52:53], v[148:149] op_sel_hi:[1,0]
v_pk_fma_f32 v[84:85], v[54:55], v[148:149], v[84:85] op_sel:[0,1,0] neg_lo:[1,0,0] neg_hi:[1,0,0]
v_pk_mul_f32 v[54:55], v[54:55], v[148:149] op_sel_hi:[1,0]
v_pk_fma_f32 v[54:55], v[52:53], v[148:149], v[54:55] op_sel:[0,1,0]
v_mul_f32 v149, 0xbce00000, v3
v_cos_f32 v148, v149
v_sin_f32 v149, v149
v_pk_mul_f32 v[52:53], v[116:117], v[150:151] op_sel_hi:[1,0]
v_pk_fma_f32 v[52:53], v[118:119], v[150:151], v[52:53] op_sel:[0,1,0] neg_lo:[1,0,0] neg_hi:[1,0,0]
v_pk_mul_f32 v[118:119], v[118:119], v[150:151] op_sel_hi:[1,0]
v_pk_fma_f32 v[118:119], v[116:117], v[150:151], v[118:119] op_sel:[0,1,0]
v_mul_f32 v151, 0xbce80000, v3
v_cos_f32 v150, v151
v_sin_f32 v151, v151
v_pk_mul_f32 v[116:117], v[36:37], v[148:149] op_sel_hi:[1,0]
v_pk_fma_f32 v[116:117], v[38:39], v[148:149], v[116:117] op_sel:[0,1,0] neg_lo:[1,0,0] neg_hi:[1,0,0]
v_pk_mul_f32 v[38:39], v[38:39], v[148:149] op_sel_hi:[1,0]
v_pk_fma_f32 v[38:39], v[36:37], v[148:149], v[38:39] op_sel:[0,1,0]
v_mul_f32 v149, 0xbcf00000, v3
v_cos_f32 v148, v149
v_sin_f32 v149, v149
v_pk_mul_f32 v[36:37], v[100:101], v[150:151] op_sel_hi:[1,0]
v_pk_fma_f32 v[36:37], v[102:103], v[150:151], v[36:37] op_sel:[0,1,0] neg_lo:[1,0,0] neg_hi:[1,0,0]
v_pk_mul_f32 v[102:103], v[102:103], v[150:151] op_sel_hi:[1,0]
v_pk_fma_f32 v[102:103], v[100:101], v[150:151], v[102:103] op_sel:[0,1,0]
v_mul_f32 v151, 0xbcf80000, v3
v_cos_f32 v150, v151
v_sin_f32 v151, v151
v_pk_mul_f32 v[100:101], v[68:69], v[148:149] op_sel_hi:[1,0]
v_pk_fma_f32 v[100:101], v[70:71], v[148:149], v[100:101] op_sel:[0,1,0] neg_lo:[1,0,0] neg_hi:[1,0,0]
v_pk_mul_f32 v[70:71], v[70:71], v[148:149] op_sel_hi:[1,0]
v_pk_fma_f32 v[70:71], v[68:69], v[148:149], v[70:71] op_sel:[0,1,0]
s_nop 0
v_pk_mul_f32 v[68:69], v[132:133], v[150:151] op_sel_hi:[1,0]
v_pk_fma_f32 v[68:69], v[134:135], v[150:151], v[68:69] op_sel:[0,1,0] neg_lo:[1,0,0] neg_hi:[1,0,0]
v_pk_mul_f32 v[134:135], v[134:135], v[150:151] op_sel_hi:[1,0]
v_pk_fma_f32 v[134:135], v[132:133], v[150:151], v[134:135] op_sel:[0,1,0]
ds_write_b64 v4, v[16:17]
ds_write_b64 v4, v[18:19] offset:8
ds_write_b64 v4, v[80:81] offset:528
ds_write_b64 v4, v[146:147] offset:536
ds_write_b64 v4, v[144:145] offset:1056
ds_write_b64 v4, v[114:115] offset:1064
ds_write_b64 v4, v[112:113] offset:1584
ds_write_b64 v4, v[66:67] offset:1592
ds_write_b64 v4, v[64:65] offset:2112
ds_write_b64 v4, v[130:131] offset:2120
ds_write_b64 v4, v[128:129] offset:2640
ds_write_b64 v4, v[74:75] offset:2648
ds_write_b64 v4, v[72:73] offset:3168
ds_write_b64 v4, v[42:43] offset:3176
ds_write_b64 v4, v[40:41] offset:3696
ds_write_b64 v4, v[106:107] offset:3704
ds_write_b64 v4, v[104:105] offset:4224
ds_write_b64 v4, v[138:139] offset:4232
ds_write_b64 v4, v[136:137] offset:4752
ds_write_b64 v4, v[78:79] offset:4760
ds_write_b64 v4, v[76:77] offset:5280
ds_write_b64 v4, v[46:47] offset:5288
ds_write_b64 v4, v[44:45] offset:5808
ds_write_b64 v4, v[110:111] offset:5816
ds_write_b64 v4, v[108:109] offset:6336
ds_write_b64 v4, v[30:31] offset:6344
ds_write_b64 v4, v[28:29] offset:6864
ds_write_b64 v4, v[94:95] offset:6872
ds_write_b64 v4, v[92:93] offset:7392
ds_write_b64 v4, v[62:63] offset:7400
ds_write_b64 v4, v[60:61] offset:7920
ds_write_b64 v4, v[126:127] offset:7928
ds_write_b64 v4, v[124:125] offset:8448
ds_write_b64 v4, v[142:143] offset:8456
ds_write_b64 v4, v[140:141] offset:8976
ds_write_b64 v4, v[50:51] offset:8984
ds_write_b64 v4, v[48:49] offset:9504
ds_write_b64 v4, v[34:35] offset:9512
ds_write_b64 v4, v[32:33] offset:10032
ds_write_b64 v4, v[98:99] offset:10040
ds_write_b64 v4, v[96:97] offset:10560
ds_write_b64 v4, v[26:27] offset:10568
ds_write_b64 v4, v[24:25] offset:11088
ds_write_b64 v4, v[90:91] offset:11096
ds_write_b64 v4, v[88:89] offset:11616
ds_write_b64 v4, v[58:59] offset:11624
ds_write_b64 v4, v[56:57] offset:12144
ds_write_b64 v4, v[122:123] offset:12152
ds_write_b64 v4, v[120:121] offset:12672
ds_write_b64 v4, v[22:23] offset:12680
ds_write_b64 v4, v[20:21] offset:13200
ds_write_b64 v4, v[86:87] offset:13208
ds_write_b64 v4, v[84:85] offset:13728
ds_write_b64 v4, v[54:55] offset:13736
ds_write_b64 v4, v[52:53] offset:14256
ds_write_b64 v4, v[118:119] offset:14264
ds_write_b64 v4, v[116:117] offset:14784
ds_write_b64 v4, v[38:39] offset:14792
ds_write_b64 v4, v[36:37] offset:15312
ds_write_b64 v4, v[102:103] offset:15320
ds_write_b64 v4, v[100:101] offset:15840
ds_write_b64 v4, v[70:71] offset:15848
ds_write_b64 v4, v[68:69] offset:16368
ds_write_b64 v4, v[134:135] offset:16376
s_waitcnt lgkmcnt(0)
ds_read_b128 v[16:19], v5
ds_read_b128 v[20:23], v5 offset:16
ds_read_b128 v[24:27], v5 offset:32
ds_read_b128 v[28:31], v5 offset:48
ds_read_b128 v[32:35], v5 offset:64
ds_read_b128 v[36:39], v5 offset:80
ds_read_b128 v[40:43], v5 offset:96
ds_read_b128 v[44:47], v5 offset:112
ds_read_b128 v[48:51], v5 offset:128
ds_read_b128 v[52:55], v5 offset:144
ds_read_b128 v[56:59], v5 offset:160
ds_read_b128 v[60:63], v5 offset:176
s_waitcnt lgkmcnt(4)
ds_read_b128 v[64:67], v5 offset:192
ds_read_b128 v[68:71], v5 offset:208
ds_read_b128 v[72:75], v5 offset:224
ds_read_b128 v[76:79], v5 offset:240
ds_read_b128 v[80:83], v5 offset:256
ds_read_b128 v[84:87], v5 offset:272
ds_read_b128 v[88:91], v5 offset:288
ds_read_b128 v[92:95], v5 offset:304
ds_read_b128 v[96:99], v5 offset:320
ds_read_b128 v[100:103], v5 offset:336
ds_read_b128 v[104:107], v5 offset:352
ds_read_b128 v[108:111], v5 offset:368
s_waitcnt lgkmcnt(4)
ds_read_b128 v[112:115], v5 offset:384
ds_read_b128 v[116:119], v5 offset:400
ds_read_b128 v[120:123], v5 offset:416
ds_read_b128 v[124:127], v5 offset:432
ds_read_b128 v[128:131], v5 offset:448
ds_read_b128 v[132:135], v5 offset:464
ds_read_b128 v[136:139], v5 offset:480
ds_read_b128 v[140:143], v5 offset:496
s_waitcnt lgkmcnt(0)
v_pk_add_f32 v[144:145], v[16:17], v[80:81] neg_lo:[0,1] neg_hi:[0,1]
v_pk_add_f32 v[146:147], v[18:19], v[82:83] neg_lo:[0,1] neg_hi:[0,1]
v_pk_add_f32 v[16:17], v[16:17], v[80:81]
v_pk_add_f32 v[18:19], v[18:19], v[82:83]
v_pk_add_f32 v[80:81], v[20:21], v[84:85] neg_lo:[0,1] neg_hi:[0,1]
v_pk_add_f32 v[82:83], v[22:23], v[86:87] neg_lo:[0,1] neg_hi:[0,1]
v_pk_add_f32 v[20:21], v[20:21], v[84:85]
v_pk_add_f32 v[22:23], v[22:23], v[86:87]
v_pk_mul_f32 v[84:85], v[80:81], s[30:31] op_sel_hi:[1,0]
v_pk_mul_f32 v[86:87], v[80:81], s[36:37] op_sel_hi:[1,0] neg_lo:[0,1] neg_hi:[0,1]
v_pk_fma_f32 v[84:85], v[82:83], s[36:37], v[84:85] op_sel_hi:[1,0,1]
v_pk_fma_f32 v[86:87], v[82:83], s[30:31], v[86:87] op_sel_hi:[1,0,1]
v_pk_add_f32 v[80:81], v[24:25], v[88:89] neg_lo:[0,1] neg_hi:[0,1]
v_pk_add_f32 v[82:83], v[26:27], v[90:91] neg_lo:[0,1] neg_hi:[0,1]
v_pk_add_f32 v[24:25], v[24:25], v[88:89]
v_pk_add_f32 v[26:27], v[26:27], v[90:91]
v_pk_mul_f32 v[88:89], v[80:81], s[30:31] op_sel:[0,1]
v_pk_mul_f32 v[90:91], v[80:81], s[34:35] op_sel:[0,1] neg_lo:[0,1] neg_hi:[0,1]
v_pk_fma_f32 v[88:89], v[82:83], s[34:35], v[88:89] op_sel:[0,1,0]
v_pk_fma_f32 v[90:91], v[82:83], s[30:31], v[90:91] op_sel:[0,1,0]
v_pk_add_f32 v[80:81], v[28:29], v[92:93] neg_lo:[0,1] neg_hi:[0,1]
v_pk_add_f32 v[82:83], v[30:31], v[94:95] neg_lo:[0,1] neg_hi:[0,1]
v_pk_add_f32 v[28:29], v[28:29], v[92:93]
v_pk_add_f32 v[30:31], v[30:31], v[94:95]
v_pk_mul_f32 v[92:93], v[80:81], s[32:33] op_sel_hi:[1,0]
v_pk_mul_f32 v[94:95], v[80:81], s[34:35] op_sel_hi:[1,0] neg_lo:[0,1] neg_hi:[0,1]
v_pk_fma_f32 v[92:93], v[82:83], s[34:35], v[92:93] op_sel_hi:[1,0,1]
v_pk_fma_f32 v[94:95], v[82:83], s[32:33], v[94:95] op_sel_hi:[1,0,1]
v_pk_add_f32 v[80:81], v[32:33], v[96:97] neg_lo:[0,1] neg_hi:[0,1]
v_pk_add_f32 v[82:83], v[34:35], v[98:99] neg_lo:[0,1] neg_hi:[0,1]
v_pk_add_f32 v[32:33], v[32:33], v[96:97]
v_pk_add_f32 v[34:35], v[34:35], v[98:99]
v_pk_mul_f32 v[96:97], v[80:81], s[32:33] op_sel:[0,1]
v_pk_mul_f32 v[98:99], v[80:81], s[32:33] op_sel:[0,1] neg_lo:[0,1] neg_hi:[0,1]
v_pk_fma_f32 v[96:97], v[82:83], s[32:33], v[96:97] op_sel:[0,1,0]
v_pk_fma_f32 v[98:99], v[82:83], s[32:33], v[98:99] op_sel:[0,1,0]
v_pk_add_f32 v[80:81], v[36:37], v[100:101] neg_lo:[0,1] neg_hi:[0,1]
v_pk_add_f32 v[82:83], v[38:39], v[102:103] neg_lo:[0,1] neg_hi:[0,1]
v_pk_add_f32 v[36:37], v[36:37], v[100:101]
v_pk_add_f32 v[38:39], v[38:39], v[102:103]
v_pk_mul_f32 v[100:101], v[80:81], s[34:35] op_sel_hi:[1,0]
v_pk_mul_f32 v[102:103], v[80:81], s[32:33] op_sel_hi:[1,0] neg_lo:[0,1] neg_hi:[0,1]
v_pk_fma_f32 v[100:101], v[82:83], s[32:33], v[100:101] op_sel_hi:[1,0,1]
v_pk_fma_f32 v[102:103], v[82:83], s[34:35], v[102:103] op_sel_hi:[1,0,1]
v_pk_add_f32 v[80:81], v[40:41], v[104:105] neg_lo:[0,1] neg_hi:[0,1]
v_pk_add_f32 v[82:83], v[42:43], v[106:107] neg_lo:[0,1] neg_hi:[0,1]
v_pk_add_f32 v[40:41], v[40:41], v[104:105]
v_pk_add_f32 v[42:43], v[42:43], v[106:107]
v_pk_mul_f32 v[104:105], v[80:81], s[34:35] op_sel:[0,1]
v_pk_mul_f32 v[106:107], v[80:81], s[30:31] op_sel:[0,1] neg_lo:[0,1] neg_hi:[0,1]
v_pk_fma_f32 v[104:105], v[82:83], s[30:31], v[104:105] op_sel:[0,1,0]
v_pk_fma_f32 v[106:107], v[82:83], s[34:35], v[106:107] op_sel:[0,1,0]
v_pk_add_f32 v[80:81], v[44:45], v[108:109] neg_lo:[0,1] neg_hi:[0,1]
v_pk_add_f32 v[82:83], v[46:47], v[110:111] neg_lo:[0,1] neg_hi:[0,1]
v_pk_add_f32 v[44:45], v[44:45], v[108:109]
v_pk_add_f32 v[46:47], v[46:47], v[110:111]
v_pk_mul_f32 v[108:109], v[80:81], s[36:37] op_sel_hi:[1,0]
v_pk_mul_f32 v[110:111], v[80:81], s[30:31] op_sel_hi:[1,0] neg_lo:[0,1] neg_hi:[0,1]
v_pk_fma_f32 v[108:109], v[82:83], s[30:31], v[108:109] op_sel_hi:[1,0,1]
v_pk_fma_f32 v[110:111], v[82:83], s[36:37], v[110:111] op_sel_hi:[1,0,1]
v_pk_add_f32 v[80:81], v[50:51], v[114:115] neg_lo:[0,1] neg_hi:[0,1]
v_pk_add_f32 v[82:83], v[112:113], v[48:49] neg_lo:[0,1] neg_hi:[0,1]
v_pk_add_f32 v[48:49], v[48:49], v[112:113]
v_pk_add_f32 v[50:51], v[50:51], v[114:115]
v_pk_add_f32 v[112:113], v[52:53], v[116:117] neg_lo:[0,1] neg_hi:[0,1]
v_pk_add_f32 v[114:115], v[54:55], v[118:119] neg_lo:[0,1] neg_hi:[0,1]
v_pk_add_f32 v[52:53], v[52:53], v[116:117]
v_pk_add_f32 v[54:55], v[54:55], v[118:119]
v_pk_mul_f32 v[116:117], v[112:113], s[36:37] op_sel_hi:[1,0] neg_lo:[0,1] neg_hi:[0,1]
v_pk_mul_f32 v[118:119], v[112:113], s[30:31] op_sel_hi:[1,0] neg_lo:[0,1] neg_hi:[0,1]
v_pk_fma_f32 v[116:117], v[114:115], s[30:31], v[116:117] op_sel_hi:[1,0,1]
v_pk_fma_f32 v[118:119], v[114:115], s[36:37], v[118:119] op_sel_hi:[1,0,1] neg_lo:[0,1,0] neg_hi:[0,1,0]
v_pk_add_f32 v[112:113], v[56:57], v[120:121] neg_lo:[0,1] neg_hi:[0,1]
v_pk_add_f32 v[114:115], v[58:59], v[122:123] neg_lo:[0,1] neg_hi:[0,1]
v_pk_add_f32 v[56:57], v[56:57], v[120:121]
v_pk_add_f32 v[58:59], v[58:59], v[122:123]
v_pk_mul_f32 v[120:121], v[112:113], s[34:35] op_sel:[0,1] neg_lo:[0,1] neg_hi:[0,1]
v_pk_mul_f32 v[122:123], v[112:113], s[30:31] op_sel:[0,1] neg_lo:[0,1] neg_hi:[0,1]
v_pk_fma_f32 v[120:121], v[114:115], s[30:31], v[120:121] op_sel:[0,1,0]
v_pk_fma_f32 v[122:123], v[114:115], s[34:35], v[122:123] op_sel:[0,1,0] neg_lo:[0,1,0] neg_hi:[0,1,0]
v_pk_add_f32 v[112:113], v[60:61], v[124:125] neg_lo:[0,1] neg_hi:[0,1]
v_pk_add_f32 v[114:115], v[62:63], v[126:127] neg_lo:[0,1] neg_hi:[0,1]
v_pk_add_f32 v[60:61], v[60:61], v[124:125]
v_pk_add_f32 v[62:63], v[62:63], v[126:127]
v_pk_mul_f32 v[124:125], v[112:113], s[34:35] op_sel_hi:[1,0] neg_lo:[0,1] neg_hi:[0,1]
v_pk_mul_f32 v[126:127], v[112:113], s[32:33] op_sel_hi:[1,0] neg_lo:[0,1] neg_hi:[0,1]
v_pk_fma_f32 v[124:125], v[114:115], s[32:33], v[124:125] op_sel_hi:[1,0,1]
v_pk_fma_f32 v[126:127], v[114:115], s[34:35], v[126:127] op_sel_hi:[1,0,1] neg_lo:[0,1,0] neg_hi:[0,1,0]
v_pk_add_f32 v[112:113], v[64:65], v[128:129] neg_lo:[0,1] neg_hi:[0,1]
v_pk_add_f32 v[114:115], v[66:67], v[130:131] neg_lo:[0,1] neg_hi:[0,1]
v_pk_add_f32 v[64:65], v[64:65], v[128:129]
v_pk_add_f32 v[66:67], v[66:67], v[130:131]
v_pk_mul_f32 v[128:129], v[112:113], s[32:33] op_sel:[0,1] neg_lo:[0,1] neg_hi:[0,1]
v_pk_mul_f32 v[130:131], v[112:113], s[32:33] op_sel:[0,1] neg_lo:[0,1] neg_hi:[0,1]
v_pk_fma_f32 v[128:129], v[114:115], s[32:33], v[128:129] op_sel:[0,1,0]
v_pk_fma_f32 v[130:131], v[114:115], s[32:33], v[130:131] op_sel:[0,1,0] neg_lo:[0,1,0] neg_hi:[0,1,0]
v_pk_add_f32 v[112:113], v[68:69], v[132:133] neg_lo:[0,1] neg_hi:[0,1]
v_pk_add_f32 v[114:115], v[70:71], v[134:135] neg_lo:[0,1] neg_hi:[0,1]
v_pk_add_f32 v[68:69], v[68:69], v[132:133]
v_pk_add_f32 v[70:71], v[70:71], v[134:135]
v_pk_mul_f32 v[132:133], v[112:113], s[32:33] op_sel_hi:[1,0] neg_lo:[0,1] neg_hi:[0,1]
v_pk_mul_f32 v[134:135], v[112:113], s[34:35] op_sel_hi:[1,0] neg_lo:[0,1] neg_hi:[0,1]
v_pk_fma_f32 v[132:133], v[114:115], s[34:35], v[132:133] op_sel_hi:[1,0,1]
v_pk_fma_f32 v[134:135], v[114:115], s[32:33], v[134:135] op_sel_hi:[1,0,1] neg_lo:[0,1,0] neg_hi:[0,1,0]
v_pk_add_f32 v[112:113], v[72:73], v[136:137] neg_lo:[0,1] neg_hi:[0,1]
v_pk_add_f32 v[114:115], v[74:75], v[138:139] neg_lo:[0,1] neg_hi:[0,1]
v_pk_add_f32 v[72:73], v[72:73], v[136:137]
v_pk_add_f32 v[74:75], v[74:75], v[138:139]
v_pk_mul_f32 v[136:137], v[112:113], s[30:31] op_sel:[0,1] neg_lo:[0,1] neg_hi:[0,1]
v_pk_mul_f32 v[138:139], v[112:113], s[34:35] op_sel:[0,1] neg_lo:[0,1] neg_hi:[0,1]
v_pk_fma_f32 v[136:137], v[114:115], s[34:35], v[136:137] op_sel:[0,1,0]
v_pk_fma_f32 v[138:139], v[114:115], s[30:31], v[138:139] op_sel:[0,1,0] neg_lo:[0,1,0] neg_hi:[0,1,0]
v_pk_add_f32 v[112:113], v[76:77], v[140:141] neg_lo:[0,1] neg_hi:[0,1]
v_pk_add_f32 v[114:115], v[78:79], v[142:143] neg_lo:[0,1] neg_hi:[0,1]
v_pk_add_f32 v[76:77], v[76:77], v[140:141]
v_pk_add_f32 v[78:79], v[78:79], v[142:143]
v_pk_mul_f32 v[140:141], v[112:113], s[30:31] op_sel_hi:[1,0] neg_lo:[0,1] neg_hi:[0,1]
v_pk_mul_f32 v[142:143], v[112:113], s[36:37] op_sel_hi:[1,0] neg_lo:[0,1] neg_hi:[0,1]
v_pk_fma_f32 v[140:141], v[114:115], s[36:37], v[140:141] op_sel_hi:[1,0,1]
v_pk_fma_f32 v[142:143], v[114:115], s[30:31], v[142:143] op_sel_hi:[1,0,1] neg_lo:[0,1,0] neg_hi:[0,1,0]
v_pk_add_f32 v[112:113], v[16:17], v[48:49] neg_lo:[0,1] neg_hi:[0,1]
v_pk_add_f32 v[114:115], v[18:19], v[50:51] neg_lo:[0,1] neg_hi:[0,1]
v_pk_add_f32 v[16:17], v[16:17], v[48:49]
v_pk_add_f32 v[18:19], v[18:19], v[50:51]
v_pk_add_f32 v[48:49], v[20:21], v[52:53] neg_lo:[0,1] neg_hi:[0,1]
v_pk_add_f32 v[50:51], v[22:23], v[54:55] neg_lo:[0,1] neg_hi:[0,1]
v_pk_add_f32 v[20:21], v[20:21], v[52:53]
v_pk_add_f32 v[22:23], v[22:23], v[54:55]
v_pk_mul_f32 v[52:53], v[48:49], s[30:31] op_sel:[0,1]
v_pk_mul_f32 v[54:55], v[48:49], s[34:35] op_sel:[0,1] neg_lo:[0,1] neg_hi:[0,1]
v_pk_fma_f32 v[52:53], v[50:51], s[34:35], v[52:53] op_sel:[0,1,0]
v_pk_fma_f32 v[54:55], v[50:51], s[30:31], v[54:55] op_sel:[0,1,0]
v_pk_add_f32 v[48:49], v[24:25], v[56:57] neg_lo:[0,1] neg_hi:[0,1]
v_pk_add_f32 v[50:51], v[26:27], v[58:59] neg_lo:[0,1] neg_hi:[0,1]
v_pk_add_f32 v[24:25], v[24:25], v[56:57]
v_pk_add_f32 v[26:27], v[26:27], v[58:59]
v_pk_mul_f32 v[56:57], v[48:49], s[32:33] op_sel:[0,1]
v_pk_mul_f32 v[58:59], v[48:49], s[32:33] op_sel:[0,1] neg_lo:[0,1] neg_hi:[0,1]
v_pk_fma_f32 v[56:57], v[50:51], s[32:33], v[56:57] op_sel:[0,1,0]
v_pk_fma_f32 v[58:59], v[50:51], s[32:33], v[58:59] op_sel:[0,1,0]
v_pk_add_f32 v[48:49], v[28:29], v[60:61] neg_lo:[0,1] neg_hi:[0,1]
v_pk_add_f32 v[50:51], v[30:31], v[62:63] neg_lo:[0,1] neg_hi:[0,1]
v_pk_add_f32 v[28:29], v[28:29], v[60:61]
v_pk_add_f32 v[30:31], v[30:31], v[62:63]
v_pk_mul_f32 v[60:61], v[48:49], s[34:35] op_sel:[0,1]
v_pk_mul_f32 v[62:63], v[48:49], s[30:31] op_sel:[0,1] neg_lo:[0,1] neg_hi:[0,1]
v_pk_fma_f32 v[60:61], v[50:51], s[30:31], v[60:61] op_sel:[0,1,0]
v_pk_fma_f32 v[62:63], v[50:51], s[34:35], v[62:63] op_sel:[0,1,0]
v_pk_add_f32 v[48:49], v[34:35], v[66:67] neg_lo:[0,1] neg_hi:[0,1]
v_pk_add_f32 v[50:51], v[64:65], v[32:33] neg_lo:[0,1] neg_hi:[0,1]
v_pk_add_f32 v[32:33], v[32:33], v[64:65]
v_pk_add_f32 v[34:35], v[34:35], v[66:67]
v_pk_add_f32 v[64:65], v[36:37], v[68:69] neg_lo:[0,1] neg_hi:[0,1]
v_pk_add_f32 v[66:67], v[38:39], v[70:71] neg_lo:[0,1] neg_hi:[0,1]
v_pk_add_f32 v[36:37], v[36:37], v[68:69]
v_pk_add_f32 v[38:39], v[38:39], v[70:71]
v_pk_mul_f32 v[68:69], v[64:65], s[34:35] op_sel:[0,1] neg_lo:[0,1] neg_hi:[0,1]
v_pk_mul_f32 v[70:71], v[64:65], s[30:31] op_sel:[0,1] neg_lo:[0,1] neg_hi:[0,1]
v_pk_fma_f32 v[68:69], v[66:67], s[30:31], v[68:69] op_sel:[0,1,0]
v_pk_fma_f32 v[70:71], v[66:67], s[34:35], v[70:71] op_sel:[0,1,0] neg_lo:[0,1,0] neg_hi:[0,1,0]
v_pk_add_f32 v[64:65], v[40:41], v[72:73] neg_lo:[0,1] neg_hi:[0,1]
v_pk_add_f32 v[66:67], v[42:43], v[74:75] neg_lo:[0,1] neg_hi:[0,1]
v_pk_add_f32 v[40:41], v[40:41], v[72:73]
v_pk_add_f32 v[42:43], v[42:43], v[74:75]
v_pk_mul_f32 v[72:73], v[64:65], s[32:33] op_sel:[0,1] neg_lo:[0,1] neg_hi:[0,1]
v_pk_mul_f32 v[74:75], v[64:65], s[32:33] op_sel:[0,1] neg_lo:[0,1] neg_hi:[0,1]
v_pk_fma_f32 v[72:73], v[66:67], s[32:33], v[72:73] op_sel:[0,1,0]
v_pk_fma_f32 v[74:75], v[66:67], s[32:33], v[74:75] op_sel:[0,1,0] neg_lo:[0,1,0] neg_hi:[0,1,0]
v_pk_add_f32 v[64:65], v[44:45], v[76:77] neg_lo:[0,1] neg_hi:[0,1]
v_pk_add_f32 v[66:67], v[46:47], v[78:79] neg_lo:[0,1] neg_hi:[0,1]
v_pk_add_f32 v[44:45], v[44:45], v[76:77]
v_pk_add_f32 v[46:47], v[46:47], v[78:79]
v_pk_mul_f32 v[76:77], v[64:65], s[30:31] op_sel:[0,1] neg_lo:[0,1] neg_hi:[0,1]
v_pk_mul_f32 v[78:79], v[64:65], s[34:35] op_sel:[0,1] neg_lo:[0,1] neg_hi:[0,1]
v_pk_fma_f32 v[76:77], v[66:67], s[34:35], v[76:77] op_sel:[0,1,0]
v_pk_fma_f32 v[78:79], v[66:67], s[30:31], v[78:79] op_sel:[0,1,0] neg_lo:[0,1,0] neg_hi:[0,1,0]
v_pk_add_f32 v[64:65], v[144:145], v[80:81] neg_lo:[0,1] neg_hi:[0,1]
v_pk_add_f32 v[66:67], v[146:147], v[82:83] neg_lo:[0,1] neg_hi:[0,1]
v_pk_add_f32 v[144:145], v[144:145], v[80:81]
v_pk_add_f32 v[146:147], v[146:147], v[82:83]
v_pk_add_f32 v[80:81], v[84:85], v[116:117] neg_lo:[0,1] neg_hi:[0,1]
v_pk_add_f32 v[82:83], v[86:87], v[118:119] neg_lo:[0,1] neg_hi:[0,1]
v_pk_add_f32 v[84:85], v[84:85], v[116:117]
v_pk_add_f32 v[86:87], v[86:87], v[118:119]
v_pk_mul_f32 v[116:117], v[80:81], s[30:31] op_sel:[0,1]
v_pk_mul_f32 v[118:119], v[80:81], s[34:35] op_sel:[0,1] neg_lo:[0,1] neg_hi:[0,1]
v_pk_fma_f32 v[116:117], v[82:83], s[34:35], v[116:117] op_sel:[0,1,0]
v_pk_fma_f32 v[118:119], v[82:83], s[30:31], v[118:119] op_sel:[0,1,0]
v_pk_add_f32 v[80:81], v[88:89], v[120:121] neg_lo:[0,1] neg_hi:[0,1]
v_pk_add_f32 v[82:83], v[90:91], v[122:123] neg_lo:[0,1] neg_hi:[0,1]
v_pk_add_f32 v[88:89], v[88:89], v[120:121]
v_pk_add_f32 v[90:91], v[90:91], v[122:123]
v_pk_mul_f32 v[120:121], v[80:81], s[32:33] op_sel:[0,1]
v_pk_mul_f32 v[122:123], v[80:81], s[32:33] op_sel:[0,1] neg_lo:[0,1] neg_hi:[0,1]
v_pk_fma_f32 v[120:121], v[82:83], s[32:33], v[120:121] op_sel:[0,1,0]
v_pk_fma_f32 v[122:123], v[82:83], s[32:33], v[122:123] op_sel:[0,1,0]
v_pk_add_f32 v[80:81], v[92:93], v[124:125] neg_lo:[0,1] neg_hi:[0,1]
v_pk_add_f32 v[82:83], v[94:95], v[126:127] neg_lo:[0,1] neg_hi:[0,1]
v_pk_add_f32 v[92:93], v[92:93], v[124:125]
v_pk_add_f32 v[94:95], v[94:95], v[126:127]
v_pk_mul_f32 v[124:125], v[80:81], s[34:35] op_sel:[0,1]
v_pk_mul_f32 v[126:127], v[80:81], s[30:31] op_sel:[0,1] neg_lo:[0,1] neg_hi:[0,1]
v_pk_fma_f32 v[124:125], v[82:83], s[30:31], v[124:125] op_sel:[0,1,0]
v_pk_fma_f32 v[126:127], v[82:83], s[34:35], v[126:127] op_sel:[0,1,0]
v_pk_add_f32 v[80:81], v[98:99], v[130:131] neg_lo:[0,1] neg_hi:[0,1]
v_pk_add_f32 v[82:83], v[128:129], v[96:97] neg_lo:[0,1] neg_hi:[0,1]
v_pk_add_f32 v[96:97], v[96:97], v[128:129]
v_pk_add_f32 v[98:99], v[98:99], v[130:131]
v_pk_add_f32 v[128:129], v[100:101], v[132:133] neg_lo:[0,1] neg_hi:[0,1]
v_pk_add_f32 v[130:131], v[102:103], v[134:135] neg_lo:[0,1] neg_hi:[0,1]
v_pk_add_f32 v[100:101], v[100:101], v[132:133]
v_pk_add_f32 v[102:103], v[102:103], v[134:135]
v_pk_mul_f32 v[132:133], v[128:129], s[34:35] op_sel:[0,1] neg_lo:[0,1] neg_hi:[0,1]
v_pk_mul_f32 v[134:135], v[128:129], s[30:31] op_sel:[0,1] neg_lo:[0,1] neg_hi:[0,1]
v_pk_fma_f32 v[132:133], v[130:131], s[30:31], v[132:133] op_sel:[0,1,0]
v_pk_fma_f32 v[134:135], v[130:131], s[34:35], v[134:135] op_sel:[0,1,0] neg_lo:[0,1,0] neg_hi:[0,1,0]
v_pk_add_f32 v[128:129], v[104:105], v[136:137] neg_lo:[0,1] neg_hi:[0,1]
v_pk_add_f32 v[130:131], v[106:107], v[138:139] neg_lo:[0,1] neg_hi:[0,1]
v_pk_add_f32 v[104:105], v[104:105], v[136:137]
v_pk_add_f32 v[106:107], v[106:107], v[138:139]
v_pk_mul_f32 v[136:137], v[128:129], s[32:33] op_sel:[0,1] neg_lo:[0,1] neg_hi:[0,1]
v_pk_mul_f32 v[138:139], v[128:129], s[32:33] op_sel:[0,1] neg_lo:[0,1] neg_hi:[0,1]
v_pk_fma_f32 v[136:137], v[130:131], s[32:33], v[136:137] op_sel:[0,1,0]
v_pk_fma_f32 v[138:139], v[130:131], s[32:33], v[138:139] op_sel:[0,1,0] neg_lo:[0,1,0] neg_hi:[0,1,0]
v_pk_add_f32 v[128:129], v[108:109], v[140:141] neg_lo:[0,1] neg_hi:[0,1]
v_pk_add_f32 v[130:131], v[110:111], v[142:143] neg_lo:[0,1] neg_hi:[0,1]
v_pk_add_f32 v[108:109], v[108:109], v[140:141]
v_pk_add_f32 v[110:111], v[110:111], v[142:143]
v_pk_mul_f32 v[140:141], v[128:129], s[30:31] op_sel:[0,1] neg_lo:[0,1] neg_hi:[0,1]
v_pk_mul_f32 v[142:143], v[128:129], s[34:35] op_sel:[0,1] neg_lo:[0,1] neg_hi:[0,1]
v_pk_fma_f32 v[140:141], v[130:131], s[34:35], v[140:141] op_sel:[0,1,0]
v_pk_fma_f32 v[142:143], v[130:131], s[30:31], v[142:143] op_sel:[0,1,0] neg_lo:[0,1,0] neg_hi:[0,1,0]
v_pk_add_f32 v[128:129], v[16:17], v[32:33] neg_lo:[0,1] neg_hi:[0,1]
v_pk_add_f32 v[130:131], v[18:19], v[34:35] neg_lo:[0,1] neg_hi:[0,1]
v_pk_add_f32 v[16:17], v[16:17], v[32:33]
v_pk_add_f32 v[18:19], v[18:19], v[34:35]
v_pk_add_f32 v[32:33], v[20:21], v[36:37] neg_lo:[0,1] neg_hi:[0,1]
v_pk_add_f32 v[34:35], v[22:23], v[38:39] neg_lo:[0,1] neg_hi:[0,1]
v_pk_add_f32 v[20:21], v[20:21], v[36:37]
v_pk_add_f32 v[22:23], v[22:23], v[38:39]
v_pk_mul_f32 v[36:37], v[32:33], s[32:33] op_sel:[0,1]
v_pk_mul_f32 v[38:39], v[32:33], s[32:33] op_sel:[0,1] neg_lo:[0,1] neg_hi:[0,1]
v_pk_fma_f32 v[36:37], v[34:35], s[32:33], v[36:37] op_sel:[0,1,0]
v_pk_fma_f32 v[38:39], v[34:35], s[32:33], v[38:39] op_sel:[0,1,0]
v_pk_add_f32 v[32:33], v[26:27], v[42:43] neg_lo:[0,1] neg_hi:[0,1]
v_pk_add_f32 v[34:35], v[40:41], v[24:25] neg_lo:[0,1] neg_hi:[0,1]
v_pk_add_f32 v[24:25], v[24:25], v[40:41]
v_pk_add_f32 v[26:27], v[26:27], v[42:43]
v_pk_add_f32 v[40:41], v[28:29], v[44:45] neg_lo:[0,1] neg_hi:[0,1]
v_pk_add_f32 v[42:43], v[30:31], v[46:47] neg_lo:[0,1] neg_hi:[0,1]
v_pk_add_f32 v[28:29], v[28:29], v[44:45]
v_pk_add_f32 v[30:31], v[30:31], v[46:47]
v_pk_mul_f32 v[44:45], v[40:41], s[32:33] op_sel:[0,1] neg_lo:[0,1] neg_hi:[0,1]
v_pk_mul_f32 v[46:47], v[40:41], s[32:33] op_sel:[0,1] neg_lo:[0,1] neg_hi:[0,1]
v_pk_fma_f32 v[44:45], v[42:43], s[32:33], v[44:45] op_sel:[0,1,0]
v_pk_fma_f32 v[46:47], v[42:43], s[32:33], v[46:47] op_sel:[0,1,0] neg_lo:[0,1,0] neg_hi:[0,1,0]
v_pk_add_f32 v[40:41], v[112:113], v[48:49] neg_lo:[0,1] neg_hi:[0,1]
v_pk_add_f32 v[42:43], v[114:115], v[50:51] neg_lo:[0,1] neg_hi:[0,1]
v_pk_add_f32 v[112:113], v[112:113], v[48:49]
v_pk_add_f32 v[114:115], v[114:115], v[50:51]
v_pk_add_f32 v[48:49], v[52:53], v[68:69] neg_lo:[0,1] neg_hi:[0,1]
v_pk_add_f32 v[50:51], v[54:55], v[70:71] neg_lo:[0,1] neg_hi:[0,1]
v_pk_add_f32 v[52:53], v[52:53], v[68:69]
v_pk_add_f32 v[54:55], v[54:55], v[70:71]
v_pk_mul_f32 v[68:69], v[48:49], s[32:33] op_sel:[0,1]
v_pk_mul_f32 v[70:71], v[48:49], s[32:33] op_sel:[0,1] neg_lo:[0,1] neg_hi:[0,1]
v_pk_fma_f32 v[68:69], v[50:51], s[32:33], v[68:69] op_sel:[0,1,0]
v_pk_fma_f32 v[70:71], v[50:51], s[32:33], v[70:71] op_sel:[0,1,0]
v_pk_add_f32 v[48:49], v[58:59], v[74:75] neg_lo:[0,1] neg_hi:[0,1]
v_pk_add_f32 v[50:51], v[72:73], v[56:57] neg_lo:[0,1] neg_hi:[0,1]
v_pk_add_f32 v[56:57], v[56:57], v[72:73]
v_pk_add_f32 v[58:59], v[58:59], v[74:75]
v_pk_add_f32 v[72:73], v[60:61], v[76:77] neg_lo:[0,1] neg_hi:[0,1]
v_pk_add_f32 v[74:75], v[62:63], v[78:79] neg_lo:[0,1] neg_hi:[0,1]
v_pk_add_f32 v[60:61], v[60:61], v[76:77]
v_pk_add_f32 v[62:63], v[62:63], v[78:79]
v_pk_mul_f32 v[76:77], v[72:73], s[32:33] op_sel:[0,1] neg_lo:[0,1] neg_hi:[0,1]
v_pk_mul_f32 v[78:79], v[72:73], s[32:33] op_sel:[0,1] neg_lo:[0,1] neg_hi:[0,1]
v_pk_fma_f32 v[76:77], v[74:75], s[32:33], v[76:77] op_sel:[0,1,0]
v_pk_fma_f32 v[78:79], v[74:75], s[32:33], v[78:79] op_sel:[0,1,0] neg_lo:[0,1,0] neg_hi:[0,1,0]
v_pk_add_f32 v[72:73], v[144:145], v[96:97] neg_lo:[0,1] neg_hi:[0,1]
v_pk_add_f32 v[74:75], v[146:147], v[98:99] neg_lo:[0,1] neg_hi:[0,1]
v_pk_add_f32 v[144:145], v[144:145], v[96:97]
v_pk_add_f32 v[146:147], v[146:147], v[98:99]
v_pk_add_f32 v[96:97], v[84:85], v[100:101] neg_lo:[0,1] neg_hi:[0,1]
v_pk_add_f32 v[98:99], v[86:87], v[102:103] neg_lo:[0,1] neg_hi:[0,1]
v_pk_add_f32 v[84:85], v[84:85], v[100:101]
v_pk_add_f32 v[86:87], v[86:87], v[102:103]
v_pk_mul_f32 v[100:101], v[96:97], s[32:33] op_sel:[0,1]
v_pk_mul_f32 v[102:103], v[96:97], s[32:33] op_sel:[0,1] neg_lo:[0,1] neg_hi:[0,1]
v_pk_fma_f32 v[100:101], v[98:99], s[32:33], v[100:101] op_sel:[0,1,0]
v_pk_fma_f32 v[102:103], v[98:99], s[32:33], v[102:103] op_sel:[0,1,0]
v_pk_add_f32 v[96:97], v[90:91], v[106:107] neg_lo:[0,1] neg_hi:[0,1]
v_pk_add_f32 v[98:99], v[104:105], v[88:89] neg_lo:[0,1] neg_hi:[0,1]
v_pk_add_f32 v[88:89], v[88:89], v[104:105]
v_pk_add_f32 v[90:91], v[90:91], v[106:107]
v_pk_add_f32 v[104:105], v[92:93], v[108:109] neg_lo:[0,1] neg_hi:[0,1]
v_pk_add_f32 v[106:107], v[94:95], v[110:111] neg_lo:[0,1] neg_hi:[0,1]
v_pk_add_f32 v[92:93], v[92:93], v[108:109]
v_pk_add_f32 v[94:95], v[94:95], v[110:111]
v_pk_mul_f32 v[108:109], v[104:105], s[32:33] op_sel:[0,1] neg_lo:[0,1] neg_hi:[0,1]
v_pk_mul_f32 v[110:111], v[104:105], s[32:33] op_sel:[0,1] neg_lo:[0,1] neg_hi:[0,1]
v_pk_fma_f32 v[108:109], v[106:107], s[32:33], v[108:109] op_sel:[0,1,0]
v_pk_fma_f32 v[110:111], v[106:107], s[32:33], v[110:111] op_sel:[0,1,0] neg_lo:[0,1,0] neg_hi:[0,1,0]
v_pk_add_f32 v[104:105], v[64:65], v[80:81] neg_lo:[0,1] neg_hi:[0,1]
v_pk_add_f32 v[106:107], v[66:67], v[82:83] neg_lo:[0,1] neg_hi:[0,1]
v_pk_add_f32 v[64:65], v[64:65], v[80:81]
v_pk_add_f32 v[66:67], v[66:67], v[82:83]
v_pk_add_f32 v[80:81], v[116:117], v[132:133] neg_lo:[0,1] neg_hi:[0,1]
v_pk_add_f32 v[82:83], v[118:119], v[134:135] neg_lo:[0,1] neg_hi:[0,1]
v_pk_add_f32 v[116:117], v[116:117], v[132:133]
v_pk_add_f32 v[118:119], v[118:119], v[134:135]
v_pk_mul_f32 v[132:133], v[80:81], s[32:33] op_sel:[0,1]
v_pk_mul_f32 v[134:135], v[80:81], s[32:33] op_sel:[0,1] neg_lo:[0,1] neg_hi:[0,1]
v_pk_fma_f32 v[132:133], v[82:83], s[32:33], v[132:133] op_sel:[0,1,0]
v_pk_fma_f32 v[134:135], v[82:83], s[32:33], v[134:135] op_sel:[0,1,0]
v_pk_add_f32 v[80:81], v[122:123], v[138:139] neg_lo:[0,1] neg_hi:[0,1]
v_pk_add_f32 v[82:83], v[136:137], v[120:121] neg_lo:[0,1] neg_hi:[0,1]
v_pk_add_f32 v[120:121], v[120:121], v[136:137]
v_pk_add_f32 v[122:123], v[122:123], v[138:139]
v_pk_add_f32 v[136:137], v[124:125], v[140:141] neg_lo:[0,1] neg_hi:[0,1]
v_pk_add_f32 v[138:139], v[126:127], v[142:143] neg_lo:[0,1] neg_hi:[0,1]
v_pk_add_f32 v[124:125], v[124:125], v[140:141]
v_pk_add_f32 v[126:127], v[126:127], v[142:143]
v_pk_mul_f32 v[140:141], v[136:137], s[32:33] op_sel:[0,1] neg_lo:[0,1] neg_hi:[0,1]
v_pk_mul_f32 v[142:143], v[136:137], s[32:33] op_sel:[0,1] neg_lo:[0,1] neg_hi:[0,1]
v_pk_fma_f32 v[140:141], v[138:139], s[32:33], v[140:141] op_sel:[0,1,0]
v_pk_fma_f32 v[142:143], v[138:139], s[32:33], v[142:143] op_sel:[0,1,0] neg_lo:[0,1,0] neg_hi:[0,1,0]
v_pk_add_f32 v[136:137], v[16:17], v[24:25] neg_lo:[0,1] neg_hi:[0,1]
v_pk_add_f32 v[138:139], v[18:19], v[26:27] neg_lo:[0,1] neg_hi:[0,1]
v_pk_add_f32 v[16:17], v[16:17], v[24:25]
v_pk_add_f32 v[18:19], v[18:19], v[26:27]
v_pk_add_f32 v[24:25], v[22:23], v[30:31] neg_lo:[0,1] neg_hi:[0,1]
v_pk_add_f32 v[26:27], v[28:29], v[20:21] neg_lo:[0,1] neg_hi:[0,1]
v_pk_add_f32 v[20:21], v[20:21], v[28:29]
v_pk_add_f32 v[22:23], v[22:23], v[30:31]
v_pk_add_f32 v[28:29], v[128:129], v[32:33] neg_lo:[0,1] neg_hi:[0,1]
v_pk_add_f32 v[30:31], v[130:131], v[34:35] neg_lo:[0,1] neg_hi:[0,1]
v_pk_add_f32 v[128:129], v[128:129], v[32:33]
v_pk_add_f32 v[130:131], v[130:131], v[34:35]
v_pk_add_f32 v[32:33], v[38:39], v[46:47] neg_lo:[0,1] neg_hi:[0,1]
v_pk_add_f32 v[34:35], v[44:45], v[36:37] neg_lo:[0,1] neg_hi:[0,1]
v_pk_add_f32 v[36:37], v[36:37], v[44:45]
v_pk_add_f32 v[38:39], v[38:39], v[46:47]
v_pk_add_f32 v[44:45], v[112:113], v[56:57] neg_lo:[0,1] neg_hi:[0,1]
v_pk_add_f32 v[46:47], v[114:115], v[58:59] neg_lo:[0,1] neg_hi:[0,1]
v_pk_add_f32 v[112:113], v[112:113], v[56:57]
v_pk_add_f32 v[114:115], v[114:115], v[58:59]
v_pk_add_f32 v[56:57], v[54:55], v[62:63] neg_lo:[0,1] neg_hi:[0,1]
v_pk_add_f32 v[58:59], v[60:61], v[52:53] neg_lo:[0,1] neg_hi:[0,1]
v_pk_add_f32 v[52:53], v[52:53], v[60:61]
v_pk_add_f32 v[54:55], v[54:55], v[62:63]
v_pk_add_f32 v[60:61], v[40:41], v[48:49] neg_lo:[0,1] neg_hi:[0,1]
v_pk_add_f32 v[62:63], v[42:43], v[50:51] neg_lo:[0,1] neg_hi:[0,1]
v_pk_add_f32 v[40:41], v[40:41], v[48:49]
v_pk_add_f32 v[42:43], v[42:43], v[50:51]
v_pk_add_f32 v[48:49], v[70:71], v[78:79] neg_lo:[0,1] neg_hi:[0,1]
v_pk_add_f32 v[50:51], v[76:77], v[68:69] neg_lo:[0,1] neg_hi:[0,1]
v_pk_add_f32 v[68:69], v[68:69], v[76:77]
v_pk_add_f32 v[70:71], v[70:71], v[78:79]
v_pk_add_f32 v[76:77], v[144:145], v[88:89] neg_lo:[0,1] neg_hi:[0,1]
v_pk_add_f32 v[78:79], v[146:147], v[90:91] neg_lo:[0,1] neg_hi:[0,1]
v_pk_add_f32 v[144:145], v[144:145], v[88:89]
v_pk_add_f32 v[146:147], v[146:147], v[90:91]
v_pk_add_f32 v[88:89], v[86:87], v[94:95] neg_lo:[0,1] neg_hi:[0,1]
v_pk_add_f32 v[90:91], v[92:93], v[84:85] neg_lo:[0,1] neg_hi:[0,1]
v_pk_add_f32 v[84:85], v[84:85], v[92:93]
v_pk_add_f32 v[86:87], v[86:87], v[94:95]
v_pk_add_f32 v[92:93], v[72:73], v[96:97] neg_lo:[0,1] neg_hi:[0,1]
v_pk_add_f32 v[94:95], v[74:75], v[98:99] neg_lo:[0,1] neg_hi:[0,1]
v_pk_add_f32 v[72:73], v[72:73], v[96:97]
v_pk_add_f32 v[74:75], v[74:75], v[98:99]
v_pk_add_f32 v[96:97], v[102:103], v[110:111] neg_lo:[0,1] neg_hi:[0,1]
v_pk_add_f32 v[98:99], v[108:109], v[100:101] neg_lo:[0,1] neg_hi:[0,1]
v_pk_add_f32 v[100:101], v[100:101], v[108:109]
v_pk_add_f32 v[102:103], v[102:103], v[110:111]
v_pk_add_f32 v[108:109], v[64:65], v[120:121] neg_lo:[0,1] neg_hi:[0,1]
v_pk_add_f32 v[110:111], v[66:67], v[122:123] neg_lo:[0,1] neg_hi:[0,1]
v_pk_add_f32 v[64:65], v[64:65], v[120:121]
v_pk_add_f32 v[66:67], v[66:67], v[122:123]
v_pk_add_f32 v[120:121], v[118:119], v[126:127] neg_lo:[0,1] neg_hi:[0,1]
v_pk_add_f32 v[122:123], v[124:125], v[116:117] neg_lo:[0,1] neg_hi:[0,1]
v_pk_add_f32 v[116:117], v[116:117], v[124:125]
v_pk_add_f32 v[118:119], v[118:119], v[126:127]
v_pk_add_f32 v[124:125], v[104:105], v[80:81] neg_lo:[0,1] neg_hi:[0,1]
v_pk_add_f32 v[126:127], v[106:107], v[82:83] neg_lo:[0,1] neg_hi:[0,1]
v_pk_add_f32 v[104:105], v[104:105], v[80:81]
v_pk_add_f32 v[106:107], v[106:107], v[82:83]
v_pk_add_f32 v[80:81], v[134:135], v[142:143] neg_lo:[0,1] neg_hi:[0,1]
v_pk_add_f32 v[82:83], v[140:141], v[132:133] neg_lo:[0,1] neg_hi:[0,1]
v_pk_add_f32 v[132:133], v[132:133], v[140:141]
v_pk_add_f32 v[134:135], v[134:135], v[142:143]
v_pk_add_f32 v[140:141], v[16:17], v[20:21] neg_lo:[0,1] neg_hi:[0,1]
v_pk_add_f32 v[142:143], v[18:19], v[22:23] neg_lo:[0,1] neg_hi:[0,1]
v_pk_add_f32 v[16:17], v[16:17], v[20:21]
v_pk_add_f32 v[18:19], v[18:19], v[22:23]
v_pk_add_f32 v[20:21], v[136:137], v[24:25] neg_lo:[0,1] neg_hi:[0,1]
v_pk_add_f32 v[22:23], v[138:139], v[26:27] neg_lo:[0,1] neg_hi:[0,1]
v_pk_add_f32 v[136:137], v[136:137], v[24:25]
v_pk_add_f32 v[138:139], v[138:139], v[26:27]
v_pk_add_f32 v[24:25], v[128:129], v[36:37] neg_lo:[0,1] neg_hi:[0,1]
v_pk_add_f32 v[26:27], v[130:131], v[38:39] neg_lo:[0,1] neg_hi:[0,1]
v_pk_add_f32 v[128:129], v[128:129], v[36:37]
v_pk_add_f32 v[130:131], v[130:131], v[38:39]
v_pk_add_f32 v[36:37], v[28:29], v[32:33] neg_lo:[0,1] neg_hi:[0,1]
v_pk_add_f32 v[38:39], v[30:31], v[34:35] neg_lo:[0,1] neg_hi:[0,1]
v_pk_add_f32 v[28:29], v[28:29], v[32:33]
v_pk_add_f32 v[30:31], v[30:31], v[34:35]
v_pk_add_f32 v[32:33], v[112:113], v[52:53] neg_lo:[0,1] neg_hi:[0,1]
v_pk_add_f32 v[34:35], v[114:115], v[54:55] neg_lo:[0,1] neg_hi:[0,1]
v_pk_add_f32 v[112:113], v[112:113], v[52:53]
v_pk_add_f32 v[114:115], v[114:115], v[54:55]
v_pk_add_f32 v[52:53], v[44:45], v[56:57] neg_lo:[0,1] neg_hi:[0,1]
v_pk_add_f32 v[54:55], v[46:47], v[58:59] neg_lo:[0,1] neg_hi:[0,1]
v_pk_add_f32 v[44:45], v[44:45], v[56:57]
v_pk_add_f32 v[46:47], v[46:47], v[58:59]
v_pk_add_f32 v[56:57], v[40:41], v[68:69] neg_lo:[0,1] neg_hi:[0,1]
v_pk_add_f32 v[58:59], v[42:43], v[70:71] neg_lo:[0,1] neg_hi:[0,1]
v_pk_add_f32 v[40:41], v[40:41], v[68:69]
v_pk_add_f32 v[42:43], v[42:43], v[70:71]
v_pk_add_f32 v[68:69], v[60:61], v[48:49] neg_lo:[0,1] neg_hi:[0,1]
v_pk_add_f32 v[70:71], v[62:63], v[50:51] neg_lo:[0,1] neg_hi:[0,1]
v_pk_add_f32 v[60:61], v[60:61], v[48:49]
v_pk_add_f32 v[62:63], v[62:63], v[50:51]
v_pk_add_f32 v[48:49], v[144:145], v[84:85] neg_lo:[0,1] neg_hi:[0,1]
v_pk_add_f32 v[50:51], v[146:147], v[86:87] neg_lo:[0,1] neg_hi:[0,1]
v_pk_add_f32 v[144:145], v[144:145], v[84:85]
v_pk_add_f32 v[146:147], v[146:147], v[86:87]
v_pk_add_f32 v[84:85], v[76:77], v[88:89] neg_lo:[0,1] neg_hi:[0,1]
v_pk_add_f32 v[86:87], v[78:79], v[90:91] neg_lo:[0,1] neg_hi:[0,1]
v_pk_add_f32 v[76:77], v[76:77], v[88:89]
v_pk_add_f32 v[78:79], v[78:79], v[90:91]
v_pk_add_f32 v[88:89], v[72:73], v[100:101] neg_lo:[0,1] neg_hi:[0,1]
v_pk_add_f32 v[90:91], v[74:75], v[102:103] neg_lo:[0,1] neg_hi:[0,1]
v_pk_add_f32 v[72:73], v[72:73], v[100:101]
v_pk_add_f32 v[74:75], v[74:75], v[102:103]
v_pk_add_f32 v[100:101], v[92:93], v[96:97] neg_lo:[0,1] neg_hi:[0,1]
v_pk_add_f32 v[102:103], v[94:95], v[98:99] neg_lo:[0,1] neg_hi:[0,1]
v_pk_add_f32 v[92:93], v[92:93], v[96:97]
v_pk_add_f32 v[94:95], v[94:95], v[98:99]
v_pk_add_f32 v[96:97], v[64:65], v[116:117] neg_lo:[0,1] neg_hi:[0,1]
v_pk_add_f32 v[98:99], v[66:67], v[118:119] neg_lo:[0,1] neg_hi:[0,1]
v_pk_add_f32 v[64:65], v[64:65], v[116:117]
v_pk_add_f32 v[66:67], v[66:67], v[118:119]
v_pk_add_f32 v[116:117], v[108:109], v[120:121] neg_lo:[0,1] neg_hi:[0,1]
v_pk_add_f32 v[118:119], v[110:111], v[122:123] neg_lo:[0,1] neg_hi:[0,1]
v_pk_add_f32 v[108:109], v[108:109], v[120:121]
v_pk_add_f32 v[110:111], v[110:111], v[122:123]
v_pk_add_f32 v[120:121], v[104:105], v[132:133] neg_lo:[0,1] neg_hi:[0,1]
v_pk_add_f32 v[122:123], v[106:107], v[134:135] neg_lo:[0,1] neg_hi:[0,1]
v_pk_add_f32 v[104:105], v[104:105], v[132:133]
v_pk_add_f32 v[106:107], v[106:107], v[134:135]
v_pk_add_f32 v[132:133], v[124:125], v[80:81] neg_lo:[0,1] neg_hi:[0,1]
v_pk_add_f32 v[134:135], v[126:127], v[82:83] neg_lo:[0,1] neg_hi:[0,1]
v_pk_add_f32 v[124:125], v[124:125], v[80:81]
v_pk_add_f32 v[126:127], v[126:127], v[82:83]
ds_write_b64 v4, v[16:17]
ds_write_b64 v4, v[18:19] offset:8
ds_write_b64 v4, v[144:145] offset:512
ds_write_b64 v4, v[146:147] offset:520
ds_write_b64 v4, v[112:113] offset:1024
ds_write_b64 v4, v[114:115] offset:1032
ds_write_b64 v4, v[64:65] offset:1536
ds_write_b64 v4, v[66:67] offset:1544
ds_write_b64 v4, v[128:129] offset:2048
ds_write_b64 v4, v[130:131] offset:2056
ds_write_b64 v4, v[72:73] offset:2560
ds_write_b64 v4, v[74:75] offset:2568
ds_write_b64 v4, v[40:41] offset:3072
ds_write_b64 v4, v[42:43] offset:3080
ds_write_b64 v4, v[104:105] offset:3584
ds_write_b64 v4, v[106:107] offset:3592
ds_write_b64 v4, v[136:137] offset:4096
ds_write_b64 v4, v[138:139] offset:4104
ds_write_b64 v4, v[76:77] offset:4608
ds_write_b64 v4, v[78:79] offset:4616
ds_write_b64 v4, v[44:45] offset:5120
ds_write_b64 v4, v[46:47] offset:5128
ds_write_b64 v4, v[108:109] offset:5632
ds_write_b64 v4, v[110:111] offset:5640
ds_write_b64 v4, v[28:29] offset:6144
ds_write_b64 v4, v[30:31] offset:6152
ds_write_b64 v4, v[92:93] offset:6656
ds_write_b64 v4, v[94:95] offset:6664
ds_write_b64 v4, v[60:61] offset:7168
ds_write_b64 v4, v[62:63] offset:7176
ds_write_b64 v4, v[124:125] offset:7680
ds_write_b64 v4, v[126:127] offset:7688
ds_write_b64 v4, v[140:141] offset:8192
ds_write_b64 v4, v[142:143] offset:8200
ds_write_b64 v4, v[48:49] offset:8704
ds_write_b64 v4, v[50:51] offset:8712
ds_write_b64 v4, v[32:33] offset:9216
ds_write_b64 v4, v[34:35] offset:9224
ds_write_b64 v4, v[96:97] offset:9728
ds_write_b64 v4, v[98:99] offset:9736
ds_write_b64 v4, v[24:25] offset:10240
ds_write_b64 v4, v[26:27] offset:10248
ds_write_b64 v4, v[88:89] offset:10752
ds_write_b64 v4, v[90:91] offset:10760
ds_write_b64 v4, v[56:57] offset:11264
ds_write_b64 v4, v[58:59] offset:11272
ds_write_b64 v4, v[120:121] offset:11776
ds_write_b64 v4, v[122:123] offset:11784
ds_write_b64 v4, v[20:21] offset:12288
ds_write_b64 v4, v[22:23] offset:12296
ds_write_b64 v4, v[84:85] offset:12800
ds_write_b64 v4, v[86:87] offset:12808
ds_write_b64 v4, v[52:53] offset:13312
ds_write_b64 v4, v[54:55] offset:13320
ds_write_b64 v4, v[116:117] offset:13824
ds_write_b64 v4, v[118:119] offset:13832
ds_write_b64 v4, v[36:37] offset:14336
ds_write_b64 v4, v[38:39] offset:14344
ds_write_b64 v4, v[100:101] offset:14848
ds_write_b64 v4, v[102:103] offset:14856
ds_write_b64 v4, v[68:69] offset:15360
ds_write_b64 v4, v[70:71] offset:15368
ds_write_b64 v4, v[132:133] offset:15872
ds_write_b64 v4, v[134:135] offset:15880
s_waitcnt lgkmcnt(0)
s_barrier
v_and_b32 v5, 7, v0
v_lshrrev_b32 v1, 3, v0
v_mul_u32_u24 v6, 16896, v5
v_lshl_add_u32 v4, v1, 5, v6
v_lshlrev_b32 v5, 4, v5
v_lshl_add_u32 v5, v1, 15, v5
v_lshlrev_b32 v1, 1, v1
s_lshl_b32 s12, s92, 9
s_add_u32 s12, s12, 96468992
v_sub_u32 v7, 1024, v1
v_add_u32 v8, -1, v7
v_and_b32 v7, 1023, v7
v_lshl_add_u32 v7, v7, 4, v6
v_lshl_add_u32 v8, v8, 4, v6
ds_read_b128 v[16:19], v4
ds_read_b128 v[20:23], v4 offset:16
ds_read_b128 v[24:27], v7
ds_read_b128 v[28:31], v8
v_sub_u32 v7, 960, v1
v_add_u32 v8, -1, v7
v_and_b32 v7, 1023, v7
v_lshl_add_u32 v7, v7, 4, v6
v_lshl_add_u32 v8, v8, 4, v6
ds_read_b128 v[32:35], v4 offset:1024
ds_read_b128 v[36:39], v4 offset:1040
ds_read_b128 v[40:43], v7
ds_read_b128 v[44:47], v8
s_waitcnt lgkmcnt(4)
v_add_f32 v48, v16, v24
v_sub_f32 v50, v18, v26
v_add_f32 v52, v18, v26
v_sub_f32 v54, v24, v16
v_add_f32 v49, v20, v28
v_sub_f32 v51, v22, v30
v_add_f32 v53, v22, v30
v_sub_f32 v55, v28, v20
v_add_f32 v56, v17, v25
v_sub_f32 v58, v19, v27
v_add_f32 v60, v19, v27
v_sub_f32 v62, v25, v17
v_add_f32 v57, v21, v29
v_sub_f32 v59, v23, v31
v_add_f32 v61, v23, v31
v_sub_f32 v63, v29, v21
s_add_u32 s13, s12, 0
buffer_store_dwordx4 v[48:51], v5, s[84:87], s13 offen sc1
buffer_store_dwordx4 v[52:55], v5, s[84:87], s13 offen offset:128 sc1
buffer_store_dwordx4 v[56:59], v5, s[84:87], s13 offen offset:256 sc1
buffer_store_dwordx4 v[60:63], v5, s[84:87], s13 offen offset:384 sc1
v_sub_u32 v7, 896, v1
v_add_u32 v8, -1, v7
v_and_b32 v7, 1023, v7
v_lshl_add_u32 v7, v7, 4, v6
v_lshl_add_u32 v8, v8, 4, v6
ds_read_b128 v[16:19], v4 offset:2048
ds_read_b128 v[20:23], v4 offset:2064
ds_read_b128 v[24:27], v7
ds_read_b128 v[28:31], v8
s_waitcnt lgkmcnt(4)
v_add_f32 v64, v32, v40
v_sub_f32 v66, v34, v42
v_add_f32 v68, v34, v42
v_sub_f32 v70, v40, v32
v_add_f32 v65, v36, v44
v_sub_f32 v67, v38, v46
v_add_f32 v69, v38, v46
v_sub_f32 v71, v44, v36
v_add_f32 v72, v33, v41
v_sub_f32 v74, v35, v43
v_add_f32 v76, v35, v43
v_sub_f32 v78, v41, v33
v_add_f32 v73, v37, v45
v_sub_f32 v75, v39, v47
v_add_f32 v77, v39, v47
v_sub_f32 v79, v45, v37
s_add_u32 s13, s12, 1048576
buffer_store_dwordx4 v[64:67], v5, s[84:87], s13 offen sc1
buffer_store_dwordx4 v[68:71], v5, s[84:87], s13 offen offset:128 sc1
buffer_store_dwordx4 v[72:75], v5, s[84:87], s13 offen offset:256 sc1
buffer_store_dwordx4 v[76:79], v5, s[84:87], s13 offen offset:384 sc1
v_sub_u32 v7, 832, v1
v_add_u32 v8, -1, v7
v_and_b32 v7, 1023, v7
v_lshl_add_u32 v7, v7, 4, v6
v_lshl_add_u32 v8, v8, 4, v6
ds_read_b128 v[32:35], v4 offset:3072
ds_read_b128 v[36:39], v4 offset:3088
ds_read_b128 v[40:43], v7
ds_read_b128 v[44:47], v8
s_waitcnt lgkmcnt(4)
v_add_f32 v48, v16, v24
v_sub_f32 v50, v18, v26
v_add_f32 v52, v18, v26
v_sub_f32 v54, v24, v16
v_add_f32 v49, v20, v28
v_sub_f32 v51, v22, v30
v_add_f32 v53, v22, v30
v_sub_f32 v55, v28, v20
v_add_f32 v56, v17, v25
v_sub_f32 v58, v19, v27
v_add_f32 v60, v19, v27
v_sub_f32 v62, v25, v17
v_add_f32 v57, v21, v29
v_sub_f32 v59, v23, v31
v_add_f32 v61, v23, v31
v_sub_f32 v63, v29, v21
s_add_u32 s13, s12, 2097152
buffer_store_dwordx4 v[48:51], v5, s[84:87], s13 offen sc1
buffer_store_dwordx4 v[52:55], v5, s[84:87], s13 offen offset:128 sc1
buffer_store_dwordx4 v[56:59], v5, s[84:87], s13 offen offset:256 sc1
buffer_store_dwordx4 v[60:63], v5, s[84:87], s13 offen offset:384 sc1
v_sub_u32 v7, 768, v1
v_add_u32 v8, -1, v7
v_and_b32 v7, 1023, v7
v_lshl_add_u32 v7, v7, 4, v6
v_lshl_add_u32 v8, v8, 4, v6
ds_read_b128 v[16:19], v4 offset:4096
ds_read_b128 v[20:23], v4 offset:4112
ds_read_b128 v[24:27], v7
ds_read_b128 v[28:31], v8
s_waitcnt lgkmcnt(4)
v_add_f32 v64, v32, v40
v_sub_f32 v66, v34, v42
v_add_f32 v68, v34, v42
v_sub_f32 v70, v40, v32
v_add_f32 v65, v36, v44
v_sub_f32 v67, v38, v46
v_add_f32 v69, v38, v46
v_sub_f32 v71, v44, v36
v_add_f32 v72, v33, v41
v_sub_f32 v74, v35, v43
v_add_f32 v76, v35, v43
v_sub_f32 v78, v41, v33
v_add_f32 v73, v37, v45
v_sub_f32 v75, v39, v47
v_add_f32 v77, v39, v47
v_sub_f32 v79, v45, v37
s_add_u32 s13, s12, 3145728
buffer_store_dwordx4 v[64:67], v5, s[84:87], s13 offen sc1
buffer_store_dwordx4 v[68:71], v5, s[84:87], s13 offen offset:128 sc1
buffer_store_dwordx4 v[72:75], v5, s[84:87], s13 offen offset:256 sc1
buffer_store_dwordx4 v[76:79], v5, s[84:87], s13 offen offset:384 sc1
v_sub_u32 v7, 704, v1
v_add_u32 v8, -1, v7
v_and_b32 v7, 1023, v7
v_lshl_add_u32 v7, v7, 4, v6
v_lshl_add_u32 v8, v8, 4, v6
ds_read_b128 v[32:35], v4 offset:5120
ds_read_b128 v[36:39], v4 offset:5136
ds_read_b128 v[40:43], v7
ds_read_b128 v[44:47], v8
s_waitcnt lgkmcnt(4)
v_add_f32 v48, v16, v24
v_sub_f32 v50, v18, v26
v_add_f32 v52, v18, v26
v_sub_f32 v54, v24, v16
v_add_f32 v49, v20, v28
v_sub_f32 v51, v22, v30
v_add_f32 v53, v22, v30
v_sub_f32 v55, v28, v20
v_add_f32 v56, v17, v25
v_sub_f32 v58, v19, v27
v_add_f32 v60, v19, v27
v_sub_f32 v62, v25, v17
v_add_f32 v57, v21, v29
v_sub_f32 v59, v23, v31
v_add_f32 v61, v23, v31
v_sub_f32 v63, v29, v21
s_add_u32 s13, s12, 4194304
buffer_store_dwordx4 v[48:51], v5, s[84:87], s13 offen sc1
buffer_store_dwordx4 v[52:55], v5, s[84:87], s13 offen offset:128 sc1
buffer_store_dwordx4 v[56:59], v5, s[84:87], s13 offen offset:256 sc1
buffer_store_dwordx4 v[60:63], v5, s[84:87], s13 offen offset:384 sc1
v_sub_u32 v7, 640, v1
v_add_u32 v8, -1, v7
v_and_b32 v7, 1023, v7
v_lshl_add_u32 v7, v7, 4, v6
v_lshl_add_u32 v8, v8, 4, v6
ds_read_b128 v[16:19], v4 offset:6144
ds_read_b128 v[20:23], v4 offset:6160
ds_read_b128 v[24:27], v7
ds_read_b128 v[28:31], v8
s_waitcnt lgkmcnt(4)
v_add_f32 v64, v32, v40
v_sub_f32 v66, v34, v42
v_add_f32 v68, v34, v42
v_sub_f32 v70, v40, v32
v_add_f32 v65, v36, v44
v_sub_f32 v67, v38, v46
v_add_f32 v69, v38, v46
v_sub_f32 v71, v44, v36
v_add_f32 v72, v33, v41
v_sub_f32 v74, v35, v43
v_add_f32 v76, v35, v43
v_sub_f32 v78, v41, v33
v_add_f32 v73, v37, v45
v_sub_f32 v75, v39, v47
v_add_f32 v77, v39, v47
v_sub_f32 v79, v45, v37
s_add_u32 s13, s12, 5242880
buffer_store_dwordx4 v[64:67], v5, s[84:87], s13 offen sc1
buffer_store_dwordx4 v[68:71], v5, s[84:87], s13 offen offset:128 sc1
buffer_store_dwordx4 v[72:75], v5, s[84:87], s13 offen offset:256 sc1
buffer_store_dwordx4 v[76:79], v5, s[84:87], s13 offen offset:384 sc1
v_sub_u32 v7, 576, v1
v_add_u32 v8, -1, v7
v_and_b32 v7, 1023, v7
v_lshl_add_u32 v7, v7, 4, v6
v_lshl_add_u32 v8, v8, 4, v6
ds_read_b128 v[32:35], v4 offset:7168
ds_read_b128 v[36:39], v4 offset:7184
ds_read_b128 v[40:43], v7
ds_read_b128 v[44:47], v8
s_waitcnt lgkmcnt(4)
v_add_f32 v48, v16, v24
v_sub_f32 v50, v18, v26
v_add_f32 v52, v18, v26
v_sub_f32 v54, v24, v16
v_add_f32 v49, v20, v28
v_sub_f32 v51, v22, v30
v_add_f32 v53, v22, v30
v_sub_f32 v55, v28, v20
v_add_f32 v56, v17, v25
v_sub_f32 v58, v19, v27
v_add_f32 v60, v19, v27
v_sub_f32 v62, v25, v17
v_add_f32 v57, v21, v29
v_sub_f32 v59, v23, v31
v_add_f32 v61, v23, v31
v_sub_f32 v63, v29, v21
s_add_u32 s13, s12, 6291456
buffer_store_dwordx4 v[48:51], v5, s[84:87], s13 offen sc1
buffer_store_dwordx4 v[52:55], v5, s[84:87], s13 offen offset:128 sc1
buffer_store_dwordx4 v[56:59], v5, s[84:87], s13 offen offset:256 sc1
buffer_store_dwordx4 v[60:63], v5, s[84:87], s13 offen offset:384 sc1
v_sub_u32 v7, 512, v1
v_add_u32 v8, -1, v7
v_and_b32 v7, 1023, v7
v_lshl_add_u32 v7, v7, 4, v6
v_lshl_add_u32 v8, v8, 4, v6
ds_read_b128 v[16:19], v4 offset:8192
ds_read_b128 v[20:23], v4 offset:8208
ds_read_b128 v[24:27], v7
ds_read_b128 v[28:31], v8
s_waitcnt lgkmcnt(4)
v_add_f32 v64, v32, v40
v_sub_f32 v66, v34, v42
v_add_f32 v68, v34, v42
v_sub_f32 v70, v40, v32
v_add_f32 v65, v36, v44
v_sub_f32 v67, v38, v46
v_add_f32 v69, v38, v46
v_sub_f32 v71, v44, v36
v_add_f32 v72, v33, v41
v_sub_f32 v74, v35, v43
v_add_f32 v76, v35, v43
v_sub_f32 v78, v41, v33
v_add_f32 v73, v37, v45
v_sub_f32 v75, v39, v47
v_add_f32 v77, v39, v47
v_sub_f32 v79, v45, v37
s_add_u32 s13, s12, 7340032
buffer_store_dwordx4 v[64:67], v5, s[84:87], s13 offen sc1
buffer_store_dwordx4 v[68:71], v5, s[84:87], s13 offen offset:128 sc1
buffer_store_dwordx4 v[72:75], v5, s[84:87], s13 offen offset:256 sc1
buffer_store_dwordx4 v[76:79], v5, s[84:87], s13 offen offset:384 sc1
s_waitcnt lgkmcnt(0)
v_add_f32 v48, v16, v24
v_sub_f32 v50, v18, v26
v_add_f32 v52, v18, v26
v_sub_f32 v54, v24, v16
v_add_f32 v49, v20, v28
v_sub_f32 v51, v22, v30
v_add_f32 v53, v22, v30
v_sub_f32 v55, v28, v20
v_add_f32 v56, v17, v25
v_sub_f32 v58, v19, v27
v_add_f32 v60, v19, v27
v_sub_f32 v62, v25, v17
v_add_f32 v57, v21, v29
v_sub_f32 v59, v23, v31
v_add_f32 v61, v23, v31
v_sub_f32 v63, v29, v21
s_add_u32 s13, s12, 8388608
v_cmp_eq_u32 vcc, 0, v1
s_and_saveexec_b64 s[14:15], vcc
s_cbranch_execz L_f1r_e
buffer_store_dwordx4 v[48:51], v5, s[84:87], s13 offen sc1
buffer_store_dwordx4 v[52:55], v5, s[84:87], s13 offen offset:128 sc1
buffer_store_dwordx4 v[56:59], v5, s[84:87], s13 offen offset:256 sc1
buffer_store_dwordx4 v[60:63], v5, s[84:87], s13 offen offset:384 sc1
L_f1r_e:
s_mov_b64 exec, -1
s_waitcnt vmcnt(0)
s_barrier
s_cmp_lg_u32 s98, 0
s_cbranch_scc1 L_sg_7
v_mov_b32 v2, 1
s_mov_b32 s81, 71360512
s_mov_b64 exec, 1
buffer_atomic_add v2, off, s[84:87], s81 sc1
s_mov_b64 exec, -1
L_sg_7:
s_cmp_lg_u32 s98, 0
s_cbranch_scc1 L_wf1d
s_mov_b32 s81, 71360512
L_wf1:
buffer_load_dword v120, off, s[84:87], s81 sc1
s_waitcnt vmcnt(0)
v_cmp_ne_u32 vcc, 64, v120
s_cbranch_vccz L_wf1d
s_sleep 6
s_branch L_wf1
L_wf1d:
L_f2go:
s_barrier
s_mov_b32 s30, 0x3f7b14be
s_mov_b32 s31, 0x3f6c835e
s_mov_b32 s32, 0x3f54db31
s_mov_b32 s33, 0x3f3504f3
s_mov_b32 s34, 0x3f0e39da
s_mov_b32 s35, 0x3ec3ef15
s_mov_b32 s36, 0x3e47c5c2
v_lshrrev_b32 v5, 6, v0
v_and_b32 v1, 63, v0
v_readfirstlane_b32 s12, v5
s_lshl_b32 s13, s99, 2
s_add_u32 s13, s13, s12
s_cmp_ge_u32 s13, 257
s_cbranch_scc1 L_f2_end
v_cvt_f32_u32 v2, v1
s_lshl_b32 s15, s13, 15
s_add_u32 s15, s15, 96468992
v_lshlrev_b32 v10, 4, v1
s_add_u32 s16, s15, 0
buffer_load_dwordx4 v[16:19], v10, s[84:87], s16 offen
buffer_load_dwordx4 v[20:23], v10, s[84:87], s16 offen offset:1024
buffer_load_dwordx4 v[24:27], v10, s[84:87], s16 offen offset:2048
buffer_load_dwordx4 v[28:31], v10, s[84:87], s16 offen offset:3072
s_add_u32 s16, s15, 4096
buffer_load_dwordx4 v[32:35], v10, s[84:87], s16 offen
buffer_load_dwordx4 v[36:39], v10, s[84:87], s16 offen offset:1024
buffer_load_dwordx4 v[40:43], v10, s[84:87], s16 offen offset:2048
buffer_load_dwordx4 v[44:47], v10, s[84:87], s16 offen offset:3072
s_add_u32 s16, s15, 8192
buffer_load_dwordx4 v[48:51], v10, s[84:87], s16 offen
buffer_load_dwordx4 v[52:55], v10, s[84:87], s16 offen offset:1024
buffer_load_dwordx4 v[56:59], v10, s[84:87], s16 offen offset:2048
buffer_load_dwordx4 v[60:63], v10, s[84:87], s16 offen offset:3072
s_add_u32 s16, s15, 12288
buffer_load_dwordx4 v[64:67], v10, s[84:87], s16 offen
buffer_load_dwordx4 v[68:71], v10, s[84:87], s16 offen offset:1024
buffer_load_dwordx4 v[72:75], v10, s[84:87], s16 offen offset:2048
buffer_load_dwordx4 v[76:79], v10, s[84:87], s16 offen offset:3072
s_add_u32 s16, s15, 16384
buffer_load_dwordx4 v[80:83], v10, s[84:87], s16 offen
buffer_load_dwordx4 v[84:87], v10, s[84:87], s16 offen offset:1024
buffer_load_dwordx4 v[88:91], v10, s[84:87], s16 offen offset:2048
buffer_load_dwordx4 v[92:95], v10, s[84:87], s16 offen offset:3072
s_add_u32 s16, s15, 20480
buffer_load_dwordx4 v[96:99], v10, s[84:87], s16 offen
buffer_load_dwordx4 v[100:103], v10, s[84:87], s16 offen offset:1024
buffer_load_dwordx4 v[104:107], v10, s[84:87], s16 offen offset:2048
buffer_load_dwordx4 v[108:111], v10, s[84:87], s16 offen offset:3072
s_add_u32 s16, s15, 24576
buffer_load_dwordx4 v[112:115], v10, s[84:87], s16 offen
buffer_load_dwordx4 v[116:119], v10, s[84:87], s16 offen offset:1024
buffer_load_dwordx4 v[120:123], v10, s[84:87], s16 offen offset:2048
buffer_load_dwordx4 v[124:127], v10, s[84:87], s16 offen offset:3072
s_add_u32 s16, s15, 28672
buffer_load_dwordx4 v[128:131], v10, s[84:87], s16 offen
buffer_load_dwordx4 v[132:135], v10, s[84:87], s16 offen offset:1024
buffer_load_dwordx4 v[136:139], v10, s[84:87], s16 offen offset:2048
buffer_load_dwordx4 v[140:143], v10, s[84:87], s16 offen offset:3072
s_mul_i32 s17, s12, 33792
v_add_u32 v3, s17, v10
v_and_b32 v7, 1, v1
v_lshrrev_b32 v6, 1, v1
v_cvt_f32_u32 v8, v6
v_cvt_f32_u32 v9, v7
v_mul_u32_u24 v4, 1056, v6
v_lshl_add_u32 v4, v7, 4, v4
v_add_u32 v4, s17, v4
v_mov_b32 v14, 1.0
v_fma_f32 v14, v9, -2.0, v14
s_waitcnt vmcnt(0)
v_pk_add_f32 v[144:145], v[16:17], v[80:81] neg_lo:[0,1] neg_hi:[0,1]
v_pk_add_f32 v[146:147], v[18:19], v[82:83] neg_lo:[0,1] neg_hi:[0,1]
v_pk_add_f32 v[16:17], v[16:17], v[80:81]
v_pk_add_f32 v[18:19], v[18:19], v[82:83]
v_pk_add_f32 v[80:81], v[20:21], v[84:85] neg_lo:[0,1] neg_hi:[0,1]
v_pk_add_f32 v[82:83], v[22:23], v[86:87] neg_lo:[0,1] neg_hi:[0,1]
v_pk_add_f32 v[20:21], v[20:21], v[84:85]
v_pk_add_f32 v[22:23], v[22:23], v[86:87]
v_pk_mul_f32 v[84:85], v[80:81], s[30:31] op_sel_hi:[1,0]
v_pk_mul_f32 v[86:87], v[80:81], s[36:37] op_sel_hi:[1,0] neg_lo:[0,1] neg_hi:[0,1]
v_pk_fma_f32 v[84:85], v[82:83], s[36:37], v[84:85] op_sel_hi:[1,0,1]
v_pk_fma_f32 v[86:87], v[82:83], s[30:31], v[86:87] op_sel_hi:[1,0,1]
v_pk_add_f32 v[80:81], v[24:25], v[88:89] neg_lo:[0,1] neg_hi:[0,1]
v_pk_add_f32 v[82:83], v[26:27], v[90:91] neg_lo:[0,1] neg_hi:[0,1]
v_pk_add_f32 v[24:25], v[24:25], v[88:89]
v_pk_add_f32 v[26:27], v[26:27], v[90:91]
v_pk_mul_f32 v[88:89], v[80:81], s[30:31] op_sel:[0,1]
v_pk_mul_f32 v[90:91], v[80:81], s[34:35] op_sel:[0,1] neg_lo:[0,1] neg_hi:[0,1]
v_pk_fma_f32 v[88:89], v[82:83], s[34:35], v[88:89] op_sel:[0,1,0]
v_pk_fma_f32 v[90:91], v[82:83], s[30:31], v[90:91] op_sel:[0,1,0]
v_pk_add_f32 v[80:81], v[28:29], v[92:93] neg_lo:[0,1] neg_hi:[0,1]
v_pk_add_f32 v[82:83], v[30:31], v[94:95] neg_lo:[0,1] neg_hi:[0,1]
v_pk_add_f32 v[28:29], v[28:29], v[92:93]
v_pk_add_f32 v[30:31], v[30:31], v[94:95]
v_pk_mul_f32 v[92:93], v[80:81], s[32:33] op_sel_hi:[1,0]
v_pk_mul_f32 v[94:95], v[80:81], s[34:35] op_sel_hi:[1,0] neg_lo:[0,1] neg_hi:[0,1]
v_pk_fma_f32 v[92:93], v[82:83], s[34:35], v[92:93] op_sel_hi:[1,0,1]
v_pk_fma_f32 v[94:95], v[82:83], s[32:33], v[94:95] op_sel_hi:[1,0,1]
v_pk_add_f32 v[80:81], v[32:33], v[96:97] neg_lo:[0,1] neg_hi:[0,1]
v_pk_add_f32 v[82:83], v[34:35], v[98:99] neg_lo:[0,1] neg_hi:[0,1]
v_pk_add_f32 v[32:33], v[32:33], v[96:97]
v_pk_add_f32 v[34:35], v[34:35], v[98:99]
v_pk_mul_f32 v[96:97], v[80:81], s[32:33] op_sel:[0,1]
v_pk_mul_f32 v[98:99], v[80:81], s[32:33] op_sel:[0,1] neg_lo:[0,1] neg_hi:[0,1]
v_pk_fma_f32 v[96:97], v[82:83], s[32:33], v[96:97] op_sel:[0,1,0]
v_pk_fma_f32 v[98:99], v[82:83], s[32:33], v[98:99] op_sel:[0,1,0]
v_pk_add_f32 v[80:81], v[36:37], v[100:101] neg_lo:[0,1] neg_hi:[0,1]
v_pk_add_f32 v[82:83], v[38:39], v[102:103] neg_lo:[0,1] neg_hi:[0,1]
v_pk_add_f32 v[36:37], v[36:37], v[100:101]
v_pk_add_f32 v[38:39], v[38:39], v[102:103]
v_pk_mul_f32 v[100:101], v[80:81], s[34:35] op_sel_hi:[1,0]
v_pk_mul_f32 v[102:103], v[80:81], s[32:33] op_sel_hi:[1,0] neg_lo:[0,1] neg_hi:[0,1]
v_pk_fma_f32 v[100:101], v[82:83], s[32:33], v[100:101] op_sel_hi:[1,0,1]
v_pk_fma_f32 v[102:103], v[82:83], s[34:35], v[102:103] op_sel_hi:[1,0,1]
v_pk_add_f32 v[80:81], v[40:41], v[104:105] neg_lo:[0,1] neg_hi:[0,1]
v_pk_add_f32 v[82:83], v[42:43], v[106:107] neg_lo:[0,1] neg_hi:[0,1]
v_pk_add_f32 v[40:41], v[40:41], v[104:105]
v_pk_add_f32 v[42:43], v[42:43], v[106:107]
v_pk_mul_f32 v[104:105], v[80:81], s[34:35] op_sel:[0,1]
v_pk_mul_f32 v[106:107], v[80:81], s[30:31] op_sel:[0,1] neg_lo:[0,1] neg_hi:[0,1]
v_pk_fma_f32 v[104:105], v[82:83], s[30:31], v[104:105] op_sel:[0,1,0]
v_pk_fma_f32 v[106:107], v[82:83], s[34:35], v[106:107] op_sel:[0,1,0]
v_pk_add_f32 v[80:81], v[44:45], v[108:109] neg_lo:[0,1] neg_hi:[0,1]
v_pk_add_f32 v[82:83], v[46:47], v[110:111] neg_lo:[0,1] neg_hi:[0,1]
v_pk_add_f32 v[44:45], v[44:45], v[108:109]
v_pk_add_f32 v[46:47], v[46:47], v[110:111]
v_pk_mul_f32 v[108:109], v[80:81], s[36:37] op_sel_hi:[1,0]
v_pk_mul_f32 v[110:111], v[80:81], s[30:31] op_sel_hi:[1,0] neg_lo:[0,1] neg_hi:[0,1]
v_pk_fma_f32 v[108:109], v[82:83], s[30:31], v[108:109] op_sel_hi:[1,0,1]
v_pk_fma_f32 v[110:111], v[82:83], s[36:37], v[110:111] op_sel_hi:[1,0,1]
v_pk_add_f32 v[80:81], v[50:51], v[114:115] neg_lo:[0,1] neg_hi:[0,1]
v_pk_add_f32 v[82:83], v[112:113], v[48:49] neg_lo:[0,1] neg_hi:[0,1]
v_pk_add_f32 v[48:49], v[48:49], v[112:113]
v_pk_add_f32 v[50:51], v[50:51], v[114:115]
v_pk_add_f32 v[112:113], v[52:53], v[116:117] neg_lo:[0,1] neg_hi:[0,1]
v_pk_add_f32 v[114:115], v[54:55], v[118:119] neg_lo:[0,1] neg_hi:[0,1]
v_pk_add_f32 v[52:53], v[52:53], v[116:117]
v_pk_add_f32 v[54:55], v[54:55], v[118:119]
v_pk_mul_f32 v[116:117], v[112:113], s[36:37] op_sel_hi:[1,0] neg_lo:[0,1] neg_hi:[0,1]
v_pk_mul_f32 v[118:119], v[112:113], s[30:31] op_sel_hi:[1,0] neg_lo:[0,1] neg_hi:[0,1]
v_pk_fma_f32 v[116:117], v[114:115], s[30:31], v[116:117] op_sel_hi:[1,0,1]
v_pk_fma_f32 v[118:119], v[114:115], s[36:37], v[118:119] op_sel_hi:[1,0,1] neg_lo:[0,1,0] neg_hi:[0,1,0]
v_pk_add_f32 v[112:113], v[56:57], v[120:121] neg_lo:[0,1] neg_hi:[0,1]
v_pk_add_f32 v[114:115], v[58:59], v[122:123] neg_lo:[0,1] neg_hi:[0,1]
v_pk_add_f32 v[56:57], v[56:57], v[120:121]
v_pk_add_f32 v[58:59], v[58:59], v[122:123]
v_pk_mul_f32 v[120:121], v[112:113], s[34:35] op_sel:[0,1] neg_lo:[0,1] neg_hi:[0,1]
v_pk_mul_f32 v[122:123], v[112:113], s[30:31] op_sel:[0,1] neg_lo:[0,1] neg_hi:[0,1]
v_pk_fma_f32 v[120:121], v[114:115], s[30:31], v[120:121] op_sel:[0,1,0]
v_pk_fma_f32 v[122:123], v[114:115], s[34:35], v[122:123] op_sel:[0,1,0] neg_lo:[0,1,0] neg_hi:[0,1,0]
v_pk_add_f32 v[112:113], v[60:61], v[124:125] neg_lo:[0,1] neg_hi:[0,1]
v_pk_add_f32 v[114:115], v[62:63], v[126:127] neg_lo:[0,1] neg_hi:[0,1]
v_pk_add_f32 v[60:61], v[60:61], v[124:125]
v_pk_add_f32 v[62:63], v[62:63], v[126:127]
v_pk_mul_f32 v[124:125], v[112:113], s[34:35] op_sel_hi:[1,0] neg_lo:[0,1] neg_hi:[0,1]
v_pk_mul_f32 v[126:127], v[112:113], s[32:33] op_sel_hi:[1,0] neg_lo:[0,1] neg_hi:[0,1]
v_pk_fma_f32 v[124:125], v[114:115], s[32:33], v[124:125] op_sel_hi:[1,0,1]
v_pk_fma_f32 v[126:127], v[114:115], s[34:35], v[126:127] op_sel_hi:[1,0,1] neg_lo:[0,1,0] neg_hi:[0,1,0]
v_pk_add_f32 v[112:113], v[64:65], v[128:129] neg_lo:[0,1] neg_hi:[0,1]
v_pk_add_f32 v[114:115], v[66:67], v[130:131] neg_lo:[0,1] neg_hi:[0,1]
v_pk_add_f32 v[64:65], v[64:65], v[128:129]
v_pk_add_f32 v[66:67], v[66:67], v[130:131]
v_pk_mul_f32 v[128:129], v[112:113], s[32:33] op_sel:[0,1] neg_lo:[0,1] neg_hi:[0,1]
v_pk_mul_f32 v[130:131], v[112:113], s[32:33] op_sel:[0,1] neg_lo:[0,1] neg_hi:[0,1]
v_pk_fma_f32 v[128:129], v[114:115], s[32:33], v[128:129] op_sel:[0,1,0]
v_pk_fma_f32 v[130:131], v[114:115], s[32:33], v[130:131] op_sel:[0,1,0] neg_lo:[0,1,0] neg_hi:[0,1,0]
v_pk_add_f32 v[112:113], v[68:69], v[132:133] neg_lo:[0,1] neg_hi:[0,1]
v_pk_add_f32 v[114:115], v[70:71], v[134:135] neg_lo:[0,1] neg_hi:[0,1]
v_pk_add_f32 v[68:69], v[68:69], v[132:133]
v_pk_add_f32 v[70:71], v[70:71], v[134:135]
v_pk_mul_f32 v[132:133], v[112:113], s[32:33] op_sel_hi:[1,0] neg_lo:[0,1] neg_hi:[0,1]
v_pk_mul_f32 v[134:135], v[112:113], s[34:35] op_sel_hi:[1,0] neg_lo:[0,1] neg_hi:[0,1]
v_pk_fma_f32 v[132:133], v[114:115], s[34:35], v[132:133] op_sel_hi:[1,0,1]
v_pk_fma_f32 v[134:135], v[114:115], s[32:33], v[134:135] op_sel_hi:[1,0,1] neg_lo:[0,1,0] neg_hi:[0,1,0]
v_pk_add_f32 v[112:113], v[72:73], v[136:137] neg_lo:[0,1] neg_hi:[0,1]
v_pk_add_f32 v[114:115], v[74:75], v[138:139] neg_lo:[0,1] neg_hi:[0,1]
v_pk_add_f32 v[72:73], v[72:73], v[136:137]
v_pk_add_f32 v[74:75], v[74:75], v[138:139]
v_pk_mul_f32 v[136:137], v[112:113], s[30:31] op_sel:[0,1] neg_lo:[0,1] neg_hi:[0,1]
v_pk_mul_f32 v[138:139], v[112:113], s[34:35] op_sel:[0,1] neg_lo:[0,1] neg_hi:[0,1]
v_pk_fma_f32 v[136:137], v[114:115], s[34:35], v[136:137] op_sel:[0,1,0]
v_pk_fma_f32 v[138:139], v[114:115], s[30:31], v[138:139] op_sel:[0,1,0] neg_lo:[0,1,0] neg_hi:[0,1,0]
v_pk_add_f32 v[112:113], v[76:77], v[140:141] neg_lo:[0,1] neg_hi:[0,1]
v_pk_add_f32 v[114:115], v[78:79], v[142:143] neg_lo:[0,1] neg_hi:[0,1]
v_pk_add_f32 v[76:77], v[76:77], v[140:141]
v_pk_add_f32 v[78:79], v[78:79], v[142:143]
v_pk_mul_f32 v[140:141], v[112:113], s[30:31] op_sel_hi:[1,0] neg_lo:[0,1] neg_hi:[0,1]
v_pk_mul_f32 v[142:143], v[112:113], s[36:37] op_sel_hi:[1,0] neg_lo:[0,1] neg_hi:[0,1]
v_pk_fma_f32 v[140:141], v[114:115], s[36:37], v[140:141] op_sel_hi:[1,0,1]
v_pk_fma_f32 v[142:143], v[114:115], s[30:31], v[142:143] op_sel_hi:[1,0,1] neg_lo:[0,1,0] neg_hi:[0,1,0]
v_pk_add_f32 v[112:113], v[16:17], v[48:49] neg_lo:[0,1] neg_hi:[0,1]
v_pk_add_f32 v[114:115], v[18:19], v[50:51] neg_lo:[0,1] neg_hi:[0,1]
v_pk_add_f32 v[16:17], v[16:17], v[48:49]
v_pk_add_f32 v[18:19], v[18:19], v[50:51]
v_pk_add_f32 v[48:49], v[20:21], v[52:53] neg_lo:[0,1] neg_hi:[0,1]
v_pk_add_f32 v[50:51], v[22:23], v[54:55] neg_lo:[0,1] neg_hi:[0,1]
v_pk_add_f32 v[20:21], v[20:21], v[52:53]
v_pk_add_f32 v[22:23], v[22:23], v[54:55]
v_pk_mul_f32 v[52:53], v[48:49], s[30:31] op_sel:[0,1]
v_pk_mul_f32 v[54:55], v[48:49], s[34:35] op_sel:[0,1] neg_lo:[0,1] neg_hi:[0,1]
v_pk_fma_f32 v[52:53], v[50:51], s[34:35], v[52:53] op_sel:[0,1,0]
v_pk_fma_f32 v[54:55], v[50:51], s[30:31], v[54:55] op_sel:[0,1,0]
v_pk_add_f32 v[48:49], v[24:25], v[56:57] neg_lo:[0,1] neg_hi:[0,1]
v_pk_add_f32 v[50:51], v[26:27], v[58:59] neg_lo:[0,1] neg_hi:[0,1]
v_pk_add_f32 v[24:25], v[24:25], v[56:57]
v_pk_add_f32 v[26:27], v[26:27], v[58:59]
v_pk_mul_f32 v[56:57], v[48:49], s[32:33] op_sel:[0,1]
v_pk_mul_f32 v[58:59], v[48:49], s[32:33] op_sel:[0,1] neg_lo:[0,1] neg_hi:[0,1]
v_pk_fma_f32 v[56:57], v[50:51], s[32:33], v[56:57] op_sel:[0,1,0]
v_pk_fma_f32 v[58:59], v[50:51], s[32:33], v[58:59] op_sel:[0,1,0]
v_pk_add_f32 v[48:49], v[28:29], v[60:61] neg_lo:[0,1] neg_hi:[0,1]
v_pk_add_f32 v[50:51], v[30:31], v[62:63] neg_lo:[0,1] neg_hi:[0,1]
v_pk_add_f32 v[28:29], v[28:29], v[60:61]
v_pk_add_f32 v[30:31], v[30:31], v[62:63]
v_pk_mul_f32 v[60:61], v[48:49], s[34:35] op_sel:[0,1]
v_pk_mul_f32 v[62:63], v[48:49], s[30:31] op_sel:[0,1] neg_lo:[0,1] neg_hi:[0,1]
v_pk_fma_f32 v[60:61], v[50:51], s[30:31], v[60:61] op_sel:[0,1,0]
v_pk_fma_f32 v[62:63], v[50:51], s[34:35], v[62:63] op_sel:[0,1,0]
v_pk_add_f32 v[48:49], v[34:35], v[66:67] neg_lo:[0,1] neg_hi:[0,1]
v_pk_add_f32 v[50:51], v[64:65], v[32:33] neg_lo:[0,1] neg_hi:[0,1]
v_pk_add_f32 v[32:33], v[32:33], v[64:65]
v_pk_add_f32 v[34:35], v[34:35], v[66:67]
v_pk_add_f32 v[64:65], v[36:37], v[68:69] neg_lo:[0,1] neg_hi:[0,1]
v_pk_add_f32 v[66:67], v[38:39], v[70:71] neg_lo:[0,1] neg_hi:[0,1]
v_pk_add_f32 v[36:37], v[36:37], v[68:69]
v_pk_add_f32 v[38:39], v[38:39], v[70:71]
v_pk_mul_f32 v[68:69], v[64:65], s[34:35] op_sel:[0,1] neg_lo:[0,1] neg_hi:[0,1]
v_pk_mul_f32 v[70:71], v[64:65], s[30:31] op_sel:[0,1] neg_lo:[0,1] neg_hi:[0,1]
v_pk_fma_f32 v[68:69], v[66:67], s[30:31], v[68:69] op_sel:[0,1,0]
v_pk_fma_f32 v[70:71], v[66:67], s[34:35], v[70:71] op_sel:[0,1,0] neg_lo:[0,1,0] neg_hi:[0,1,0]
v_pk_add_f32 v[64:65], v[40:41], v[72:73] neg_lo:[0,1] neg_hi:[0,1]
v_pk_add_f32 v[66:67], v[42:43], v[74:75] neg_lo:[0,1] neg_hi:[0,1]
v_pk_add_f32 v[40:41], v[40:41], v[72:73]
v_pk_add_f32 v[42:43], v[42:43], v[74:75]
v_pk_mul_f32 v[72:73], v[64:65], s[32:33] op_sel:[0,1] neg_lo:[0,1] neg_hi:[0,1]
v_pk_mul_f32 v[74:75], v[64:65], s[32:33] op_sel:[0,1] neg_lo:[0,1] neg_hi:[0,1]
v_pk_fma_f32 v[72:73], v[66:67], s[32:33], v[72:73] op_sel:[0,1,0]
v_pk_fma_f32 v[74:75], v[66:67], s[32:33], v[74:75] op_sel:[0,1,0] neg_lo:[0,1,0] neg_hi:[0,1,0]
v_pk_add_f32 v[64:65], v[44:45], v[76:77] neg_lo:[0,1] neg_hi:[0,1]
v_pk_add_f32 v[66:67], v[46:47], v[78:79] neg_lo:[0,1] neg_hi:[0,1]
v_pk_add_f32 v[44:45], v[44:45], v[76:77]
v_pk_add_f32 v[46:47], v[46:47], v[78:79]
v_pk_mul_f32 v[76:77], v[64:65], s[30:31] op_sel:[0,1] neg_lo:[0,1] neg_hi:[0,1]
v_pk_mul_f32 v[78:79], v[64:65], s[34:35] op_sel:[0,1] neg_lo:[0,1] neg_hi:[0,1]
v_pk_fma_f32 v[76:77], v[66:67], s[34:35], v[76:77] op_sel:[0,1,0]
v_pk_fma_f32 v[78:79], v[66:67], s[30:31], v[78:79] op_sel:[0,1,0] neg_lo:[0,1,0] neg_hi:[0,1,0]
v_pk_add_f32 v[64:65], v[144:145], v[80:81] neg_lo:[0,1] neg_hi:[0,1]
v_pk_add_f32 v[66:67], v[146:147], v[82:83] neg_lo:[0,1] neg_hi:[0,1]
v_pk_add_f32 v[144:145], v[144:145], v[80:81]
v_pk_add_f32 v[146:147], v[146:147], v[82:83]
v_pk_add_f32 v[80:81], v[84:85], v[116:117] neg_lo:[0,1] neg_hi:[0,1]
v_pk_add_f32 v[82:83], v[86:87], v[118:119] neg_lo:[0,1] neg_hi:[0,1]
v_pk_add_f32 v[84:85], v[84:85], v[116:117]
v_pk_add_f32 v[86:87], v[86:87], v[118:119]
v_pk_mul_f32 v[116:117], v[80:81], s[30:31] op_sel:[0,1]
v_pk_mul_f32 v[118:119], v[80:81], s[34:35] op_sel:[0,1] neg_lo:[0,1] neg_hi:[0,1]
v_pk_fma_f32 v[116:117], v[82:83], s[34:35], v[116:117] op_sel:[0,1,0]
v_pk_fma_f32 v[118:119], v[82:83], s[30:31], v[118:119] op_sel:[0,1,0]
v_pk_add_f32 v[80:81], v[88:89], v[120:121] neg_lo:[0,1] neg_hi:[0,1]
v_pk_add_f32 v[82:83], v[90:91], v[122:123] neg_lo:[0,1] neg_hi:[0,1]
v_pk_add_f32 v[88:89], v[88:89], v[120:121]
v_pk_add_f32 v[90:91], v[90:91], v[122:123]
v_pk_mul_f32 v[120:121], v[80:81], s[32:33] op_sel:[0,1]
v_pk_mul_f32 v[122:123], v[80:81], s[32:33] op_sel:[0,1] neg_lo:[0,1] neg_hi:[0,1]
v_pk_fma_f32 v[120:121], v[82:83], s[32:33], v[120:121] op_sel:[0,1,0]
v_pk_fma_f32 v[122:123], v[82:83], s[32:33], v[122:123] op_sel:[0,1,0]
v_pk_add_f32 v[80:81], v[92:93], v[124:125] neg_lo:[0,1] neg_hi:[0,1]
v_pk_add_f32 v[82:83], v[94:95], v[126:127] neg_lo:[0,1] neg_hi:[0,1]
v_pk_add_f32 v[92:93], v[92:93], v[124:125]
v_pk_add_f32 v[94:95], v[94:95], v[126:127]
v_pk_mul_f32 v[124:125], v[80:81], s[34:35] op_sel:[0,1]
v_pk_mul_f32 v[126:127], v[80:81], s[30:31] op_sel:[0,1] neg_lo:[0,1] neg_hi:[0,1]
v_pk_fma_f32 v[124:125], v[82:83], s[30:31], v[124:125] op_sel:[0,1,0]
v_pk_fma_f32 v[126:127], v[82:83], s[34:35], v[126:127] op_sel:[0,1,0]
v_pk_add_f32 v[80:81], v[98:99], v[130:131] neg_lo:[0,1] neg_hi:[0,1]
v_pk_add_f32 v[82:83], v[128:129], v[96:97] neg_lo:[0,1] neg_hi:[0,1]
v_pk_add_f32 v[96:97], v[96:97], v[128:129]
v_pk_add_f32 v[98:99], v[98:99], v[130:131]
v_pk_add_f32 v[128:129], v[100:101], v[132:133] neg_lo:[0,1] neg_hi:[0,1]
v_pk_add_f32 v[130:131], v[102:103], v[134:135] neg_lo:[0,1] neg_hi:[0,1]
v_pk_add_f32 v[100:101], v[100:101], v[132:133]
v_pk_add_f32 v[102:103], v[102:103], v[134:135]
v_pk_mul_f32 v[132:133], v[128:129], s[34:35] op_sel:[0,1] neg_lo:[0,1] neg_hi:[0,1]
v_pk_mul_f32 v[134:135], v[128:129], s[30:31] op_sel:[0,1] neg_lo:[0,1] neg_hi:[0,1]
v_pk_fma_f32 v[132:133], v[130:131], s[30:31], v[132:133] op_sel:[0,1,0]
v_pk_fma_f32 v[134:135], v[130:131], s[34:35], v[134:135] op_sel:[0,1,0] neg_lo:[0,1,0] neg_hi:[0,1,0]
v_pk_add_f32 v[128:129], v[104:105], v[136:137] neg_lo:[0,1] neg_hi:[0,1]
v_pk_add_f32 v[130:131], v[106:107], v[138:139] neg_lo:[0,1] neg_hi:[0,1]
v_pk_add_f32 v[104:105], v[104:105], v[136:137]
v_pk_add_f32 v[106:107], v[106:107], v[138:139]
v_pk_mul_f32 v[136:137], v[128:129], s[32:33] op_sel:[0,1] neg_lo:[0,1] neg_hi:[0,1]
v_pk_mul_f32 v[138:139], v[128:129], s[32:33] op_sel:[0,1] neg_lo:[0,1] neg_hi:[0,1]
v_pk_fma_f32 v[136:137], v[130:131], s[32:33], v[136:137] op_sel:[0,1,0]
v_pk_fma_f32 v[138:139], v[130:131], s[32:33], v[138:139] op_sel:[0,1,0] neg_lo:[0,1,0] neg_hi:[0,1,0]
v_pk_add_f32 v[128:129], v[108:109], v[140:141] neg_lo:[0,1] neg_hi:[0,1]
v_pk_add_f32 v[130:131], v[110:111], v[142:143] neg_lo:[0,1] neg_hi:[0,1]
v_pk_add_f32 v[108:109], v[108:109], v[140:141]
v_pk_add_f32 v[110:111], v[110:111], v[142:143]
v_pk_mul_f32 v[140:141], v[128:129], s[30:31] op_sel:[0,1] neg_lo:[0,1] neg_hi:[0,1]
v_pk_mul_f32 v[142:143], v[128:129], s[34:35] op_sel:[0,1] neg_lo:[0,1] neg_hi:[0,1]
v_pk_fma_f32 v[140:141], v[130:131], s[34:35], v[140:141] op_sel:[0,1,0]
v_pk_fma_f32 v[142:143], v[130:131], s[30:31], v[142:143] op_sel:[0,1,0] neg_lo:[0,1,0] neg_hi:[0,1,0]
v_pk_add_f32 v[128:129], v[16:17], v[32:33] neg_lo:[0,1] neg_hi:[0,1]
v_pk_add_f32 v[130:131], v[18:19], v[34:35] neg_lo:[0,1] neg_hi:[0,1]
v_pk_add_f32 v[16:17], v[16:17], v[32:33]
v_pk_add_f32 v[18:19], v[18:19], v[34:35]
v_pk_add_f32 v[32:33], v[20:21], v[36:37] neg_lo:[0,1] neg_hi:[0,1]
v_pk_add_f32 v[34:35], v[22:23], v[38:39] neg_lo:[0,1] neg_hi:[0,1]
v_pk_add_f32 v[20:21], v[20:21], v[36:37]
v_pk_add_f32 v[22:23], v[22:23], v[38:39]
v_pk_mul_f32 v[36:37], v[32:33], s[32:33] op_sel:[0,1]
v_pk_mul_f32 v[38:39], v[32:33], s[32:33] op_sel:[0,1] neg_lo:[0,1] neg_hi:[0,1]
v_pk_fma_f32 v[36:37], v[34:35], s[32:33], v[36:37] op_sel:[0,1,0]
v_pk_fma_f32 v[38:39], v[34:35], s[32:33], v[38:39] op_sel:[0,1,0]
v_pk_add_f32 v[32:33], v[26:27], v[42:43] neg_lo:[0,1] neg_hi:[0,1]
v_pk_add_f32 v[34:35], v[40:41], v[24:25] neg_lo:[0,1] neg_hi:[0,1]
v_pk_add_f32 v[24:25], v[24:25], v[40:41]
v_pk_add_f32 v[26:27], v[26:27], v[42:43]
v_pk_add_f32 v[40:41], v[28:29], v[44:45] neg_lo:[0,1] neg_hi:[0,1]
v_pk_add_f32 v[42:43], v[30:31], v[46:47] neg_lo:[0,1] neg_hi:[0,1]
v_pk_add_f32 v[28:29], v[28:29], v[44:45]
v_pk_add_f32 v[30:31], v[30:31], v[46:47]
v_pk_mul_f32 v[44:45], v[40:41], s[32:33] op_sel:[0,1] neg_lo:[0,1] neg_hi:[0,1]
v_pk_mul_f32 v[46:47], v[40:41], s[32:33] op_sel:[0,1] neg_lo:[0,1] neg_hi:[0,1]
v_pk_fma_f32 v[44:45], v[42:43], s[32:33], v[44:45] op_sel:[0,1,0]
v_pk_fma_f32 v[46:47], v[42:43], s[32:33], v[46:47] op_sel:[0,1,0] neg_lo:[0,1,0] neg_hi:[0,1,0]
v_pk_add_f32 v[40:41], v[112:113], v[48:49] neg_lo:[0,1] neg_hi:[0,1]
v_pk_add_f32 v[42:43], v[114:115], v[50:51] neg_lo:[0,1] neg_hi:[0,1]
v_pk_add_f32 v[112:113], v[112:113], v[48:49]
v_pk_add_f32 v[114:115], v[114:115], v[50:51]
v_pk_add_f32 v[48:49], v[52:53], v[68:69] neg_lo:[0,1] neg_hi:[0,1]
v_pk_add_f32 v[50:51], v[54:55], v[70:71] neg_lo:[0,1] neg_hi:[0,1]
v_pk_add_f32 v[52:53], v[52:53], v[68:69]
v_pk_add_f32 v[54:55], v[54:55], v[70:71]
v_pk_mul_f32 v[68:69], v[48:49], s[32:33] op_sel:[0,1]
v_pk_mul_f32 v[70:71], v[48:49], s[32:33] op_sel:[0,1] neg_lo:[0,1] neg_hi:[0,1]
v_pk_fma_f32 v[68:69], v[50:51], s[32:33], v[68:69] op_sel:[0,1,0]
v_pk_fma_f32 v[70:71], v[50:51], s[32:33], v[70:71] op_sel:[0,1,0]
v_pk_add_f32 v[48:49], v[58:59], v[74:75] neg_lo:[0,1] neg_hi:[0,1]
v_pk_add_f32 v[50:51], v[72:73], v[56:57] neg_lo:[0,1] neg_hi:[0,1]
v_pk_add_f32 v[56:57], v[56:57], v[72:73]
v_pk_add_f32 v[58:59], v[58:59], v[74:75]
v_pk_add_f32 v[72:73], v[60:61], v[76:77] neg_lo:[0,1] neg_hi:[0,1]
v_pk_add_f32 v[74:75], v[62:63], v[78:79] neg_lo:[0,1] neg_hi:[0,1]
v_pk_add_f32 v[60:61], v[60:61], v[76:77]
v_pk_add_f32 v[62:63], v[62:63], v[78:79]
v_pk_mul_f32 v[76:77], v[72:73], s[32:33] op_sel:[0,1] neg_lo:[0,1] neg_hi:[0,1]
v_pk_mul_f32 v[78:79], v[72:73], s[32:33] op_sel:[0,1] neg_lo:[0,1] neg_hi:[0,1]
v_pk_fma_f32 v[76:77], v[74:75], s[32:33], v[76:77] op_sel:[0,1,0]
v_pk_fma_f32 v[78:79], v[74:75], s[32:33], v[78:79] op_sel:[0,1,0] neg_lo:[0,1,0] neg_hi:[0,1,0]
v_pk_add_f32 v[72:73], v[144:145], v[96:97] neg_lo:[0,1] neg_hi:[0,1]
v_pk_add_f32 v[74:75], v[146:147], v[98:99] neg_lo:[0,1] neg_hi:[0,1]
v_pk_add_f32 v[144:145], v[144:145], v[96:97]
v_pk_add_f32 v[146:147], v[146:147], v[98:99]
v_pk_add_f32 v[96:97], v[84:85], v[100:101] neg_lo:[0,1] neg_hi:[0,1]
v_pk_add_f32 v[98:99], v[86:87], v[102:103] neg_lo:[0,1] neg_hi:[0,1]
v_pk_add_f32 v[84:85], v[84:85], v[100:101]
v_pk_add_f32 v[86:87], v[86:87], v[102:103]
v_pk_mul_f32 v[100:101], v[96:97], s[32:33] op_sel:[0,1]
v_pk_mul_f32 v[102:103], v[96:97], s[32:33] op_sel:[0,1] neg_lo:[0,1] neg_hi:[0,1]
v_pk_fma_f32 v[100:101], v[98:99], s[32:33], v[100:101] op_sel:[0,1,0]
v_pk_fma_f32 v[102:103], v[98:99], s[32:33], v[102:103] op_sel:[0,1,0]
v_pk_add_f32 v[96:97], v[90:91], v[106:107] neg_lo:[0,1] neg_hi:[0,1]
v_pk_add_f32 v[98:99], v[104:105], v[88:89] neg_lo:[0,1] neg_hi:[0,1]
v_pk_add_f32 v[88:89], v[88:89], v[104:105]
v_pk_add_f32 v[90:91], v[90:91], v[106:107]
v_pk_add_f32 v[104:105], v[92:93], v[108:109] neg_lo:[0,1] neg_hi:[0,1]
v_pk_add_f32 v[106:107], v[94:95], v[110:111] neg_lo:[0,1] neg_hi:[0,1]
v_pk_add_f32 v[92:93], v[92:93], v[108:109]
v_pk_add_f32 v[94:95], v[94:95], v[110:111]
v_pk_mul_f32 v[108:109], v[104:105], s[32:33] op_sel:[0,1] neg_lo:[0,1] neg_hi:[0,1]
v_pk_mul_f32 v[110:111], v[104:105], s[32:33] op_sel:[0,1] neg_lo:[0,1] neg_hi:[0,1]
v_pk_fma_f32 v[108:109], v[106:107], s[32:33], v[108:109] op_sel:[0,1,0]
v_pk_fma_f32 v[110:111], v[106:107], s[32:33], v[110:111] op_sel:[0,1,0] neg_lo:[0,1,0] neg_hi:[0,1,0]
v_pk_add_f32 v[104:105], v[64:65], v[80:81] neg_lo:[0,1] neg_hi:[0,1]
v_pk_add_f32 v[106:107], v[66:67], v[82:83] neg_lo:[0,1] neg_hi:[0,1]
v_pk_add_f32 v[64:65], v[64:65], v[80:81]
v_pk_add_f32 v[66:67], v[66:67], v[82:83]
v_pk_add_f32 v[80:81], v[116:117], v[132:133] neg_lo:[0,1] neg_hi:[0,1]
v_pk_add_f32 v[82:83], v[118:119], v[134:135] neg_lo:[0,1] neg_hi:[0,1]
v_pk_add_f32 v[116:117], v[116:117], v[132:133]
v_pk_add_f32 v[118:119], v[118:119], v[134:135]
v_pk_mul_f32 v[132:133], v[80:81], s[32:33] op_sel:[0,1]
v_pk_mul_f32 v[134:135], v[80:81], s[32:33] op_sel:[0,1] neg_lo:[0,1] neg_hi:[0,1]
v_pk_fma_f32 v[132:133], v[82:83], s[32:33], v[132:133] op_sel:[0,1,0]
v_pk_fma_f32 v[134:135], v[82:83], s[32:33], v[134:135] op_sel:[0,1,0]
v_pk_add_f32 v[80:81], v[122:123], v[138:139] neg_lo:[0,1] neg_hi:[0,1]
v_pk_add_f32 v[82:83], v[136:137], v[120:121] neg_lo:[0,1] neg_hi:[0,1]
v_pk_add_f32 v[120:121], v[120:121], v[136:137]
v_pk_add_f32 v[122:123], v[122:123], v[138:139]
v_pk_add_f32 v[136:137], v[124:125], v[140:141] neg_lo:[0,1] neg_hi:[0,1]
v_pk_add_f32 v[138:139], v[126:127], v[142:143] neg_lo:[0,1] neg_hi:[0,1]
v_pk_add_f32 v[124:125], v[124:125], v[140:141]
v_pk_add_f32 v[126:127], v[126:127], v[142:143]
v_pk_mul_f32 v[140:141], v[136:137], s[32:33] op_sel:[0,1] neg_lo:[0,1] neg_hi:[0,1]
v_pk_mul_f32 v[142:143], v[136:137], s[32:33] op_sel:[0,1] neg_lo:[0,1] neg_hi:[0,1]
v_pk_fma_f32 v[140:141], v[138:139], s[32:33], v[140:141] op_sel:[0,1,0]
v_pk_fma_f32 v[142:143], v[138:139], s[32:33], v[142:143] op_sel:[0,1,0] neg_lo:[0,1,0] neg_hi:[0,1,0]
v_pk_add_f32 v[136:137], v[16:17], v[24:25] neg_lo:[0,1] neg_hi:[0,1]
v_pk_add_f32 v[138:139], v[18:19], v[26:27] neg_lo:[0,1] neg_hi:[0,1]
v_pk_add_f32 v[16:17], v[16:17], v[24:25]
v_pk_add_f32 v[18:19], v[18:19], v[26:27]
v_pk_add_f32 v[24:25], v[22:23], v[30:31] neg_lo:[0,1] neg_hi:[0,1]
v_pk_add_f32 v[26:27], v[28:29], v[20:21] neg_lo:[0,1] neg_hi:[0,1]
v_pk_add_f32 v[20:21], v[20:21], v[28:29]
v_pk_add_f32 v[22:23], v[22:23], v[30:31]
v_pk_add_f32 v[28:29], v[128:129], v[32:33] neg_lo:[0,1] neg_hi:[0,1]
v_pk_add_f32 v[30:31], v[130:131], v[34:35] neg_lo:[0,1] neg_hi:[0,1]
v_pk_add_f32 v[128:129], v[128:129], v[32:33]
v_pk_add_f32 v[130:131], v[130:131], v[34:35]
v_pk_add_f32 v[32:33], v[38:39], v[46:47] neg_lo:[0,1] neg_hi:[0,1]
v_pk_add_f32 v[34:35], v[44:45], v[36:37] neg_lo:[0,1] neg_hi:[0,1]
v_pk_add_f32 v[36:37], v[36:37], v[44:45]
v_pk_add_f32 v[38:39], v[38:39], v[46:47]
v_pk_add_f32 v[44:45], v[112:113], v[56:57] neg_lo:[0,1] neg_hi:[0,1]
v_pk_add_f32 v[46:47], v[114:115], v[58:59] neg_lo:[0,1] neg_hi:[0,1]
v_pk_add_f32 v[112:113], v[112:113], v[56:57]
v_pk_add_f32 v[114:115], v[114:115], v[58:59]
v_pk_add_f32 v[56:57], v[54:55], v[62:63] neg_lo:[0,1] neg_hi:[0,1]
v_pk_add_f32 v[58:59], v[60:61], v[52:53] neg_lo:[0,1] neg_hi:[0,1]
v_pk_add_f32 v[52:53], v[52:53], v[60:61]
v_pk_add_f32 v[54:55], v[54:55], v[62:63]
v_pk_add_f32 v[60:61], v[40:41], v[48:49] neg_lo:[0,1] neg_hi:[0,1]
v_pk_add_f32 v[62:63], v[42:43], v[50:51] neg_lo:[0,1] neg_hi:[0,1]
v_pk_add_f32 v[40:41], v[40:41], v[48:49]
v_pk_add_f32 v[42:43], v[42:43], v[50:51]
v_pk_add_f32 v[48:49], v[70:71], v[78:79] neg_lo:[0,1] neg_hi:[0,1]
v_pk_add_f32 v[50:51], v[76:77], v[68:69] neg_lo:[0,1] neg_hi:[0,1]
v_pk_add_f32 v[68:69], v[68:69], v[76:77]
v_pk_add_f32 v[70:71], v[70:71], v[78:79]
v_pk_add_f32 v[76:77], v[144:145], v[88:89] neg_lo:[0,1] neg_hi:[0,1]
v_pk_add_f32 v[78:79], v[146:147], v[90:91] neg_lo:[0,1] neg_hi:[0,1]
v_pk_add_f32 v[144:145], v[144:145], v[88:89]
v_pk_add_f32 v[146:147], v[146:147], v[90:91]
v_pk_add_f32 v[88:89], v[86:87], v[94:95] neg_lo:[0,1] neg_hi:[0,1]
v_pk_add_f32 v[90:91], v[92:93], v[84:85] neg_lo:[0,1] neg_hi:[0,1]
v_pk_add_f32 v[84:85], v[84:85], v[92:93]
v_pk_add_f32 v[86:87], v[86:87], v[94:95]
v_pk_add_f32 v[92:93], v[72:73], v[96:97] neg_lo:[0,1] neg_hi:[0,1]
v_pk_add_f32 v[94:95], v[74:75], v[98:99] neg_lo:[0,1] neg_hi:[0,1]
v_pk_add_f32 v[72:73], v[72:73], v[96:97]
v_pk_add_f32 v[74:75], v[74:75], v[98:99]
v_pk_add_f32 v[96:97], v[102:103], v[110:111] neg_lo:[0,1] neg_hi:[0,1]
v_pk_add_f32 v[98:99], v[108:109], v[100:101] neg_lo:[0,1] neg_hi:[0,1]
v_pk_add_f32 v[100:101], v[100:101], v[108:109]
v_pk_add_f32 v[102:103], v[102:103], v[110:111]
v_pk_add_f32 v[108:109], v[64:65], v[120:121] neg_lo:[0,1] neg_hi:[0,1]
v_pk_add_f32 v[110:111], v[66:67], v[122:123] neg_lo:[0,1] neg_hi:[0,1]
v_pk_add_f32 v[64:65], v[64:65], v[120:121]
v_pk_add_f32 v[66:67], v[66:67], v[122:123]
v_pk_add_f32 v[120:121], v[118:119], v[126:127] neg_lo:[0,1] neg_hi:[0,1]
v_pk_add_f32 v[122:123], v[124:125], v[116:117] neg_lo:[0,1] neg_hi:[0,1]
v_pk_add_f32 v[116:117], v[116:117], v[124:125]
v_pk_add_f32 v[118:119], v[118:119], v[126:127]
v_pk_add_f32 v[124:125], v[104:105], v[80:81] neg_lo:[0,1] neg_hi:[0,1]
v_pk_add_f32 v[126:127], v[106:107], v[82:83] neg_lo:[0,1] neg_hi:[0,1]
v_pk_add_f32 v[104:105], v[104:105], v[80:81]
v_pk_add_f32 v[106:107], v[106:107], v[82:83]
v_pk_add_f32 v[80:81], v[134:135], v[142:143] neg_lo:[0,1] neg_hi:[0,1]
v_pk_add_f32 v[82:83], v[140:141], v[132:133] neg_lo:[0,1] neg_hi:[0,1]
v_pk_add_f32 v[132:133], v[132:133], v[140:141]
v_pk_add_f32 v[134:135], v[134:135], v[142:143]
v_pk_add_f32 v[140:141], v[16:17], v[20:21] neg_lo:[0,1] neg_hi:[0,1]
v_pk_add_f32 v[142:143], v[18:19], v[22:23] neg_lo:[0,1] neg_hi:[0,1]
v_pk_add_f32 v[16:17], v[16:17], v[20:21]
v_pk_add_f32 v[18:19], v[18:19], v[22:23]
v_pk_add_f32 v[20:21], v[136:137], v[24:25] neg_lo:[0,1] neg_hi:[0,1]
v_pk_add_f32 v[22:23], v[138:139], v[26:27] neg_lo:[0,1] neg_hi:[0,1]
v_pk_add_f32 v[136:137], v[136:137], v[24:25]
v_pk_add_f32 v[138:139], v[138:139], v[26:27]
v_pk_add_f32 v[24:25], v[128:129], v[36:37] neg_lo:[0,1] neg_hi:[0,1]
v_pk_add_f32 v[26:27], v[130:131], v[38:39] neg_lo:[0,1] neg_hi:[0,1]
v_pk_add_f32 v[128:129], v[128:129], v[36:37]
v_pk_add_f32 v[130:131], v[130:131], v[38:39]
v_pk_add_f32 v[36:37], v[28:29], v[32:33] neg_lo:[0,1] neg_hi:[0,1]
v_pk_add_f32 v[38:39], v[30:31], v[34:35] neg_lo:[0,1] neg_hi:[0,1]
v_pk_add_f32 v[28:29], v[28:29], v[32:33]
v_pk_add_f32 v[30:31], v[30:31], v[34:35]
v_pk_add_f32 v[32:33], v[112:113], v[52:53] neg_lo:[0,1] neg_hi:[0,1]
v_pk_add_f32 v[34:35], v[114:115], v[54:55] neg_lo:[0,1] neg_hi:[0,1]
v_pk_add_f32 v[112:113], v[112:113], v[52:53]
v_pk_add_f32 v[114:115], v[114:115], v[54:55]
v_pk_add_f32 v[52:53], v[44:45], v[56:57] neg_lo:[0,1] neg_hi:[0,1]
v_pk_add_f32 v[54:55], v[46:47], v[58:59] neg_lo:[0,1] neg_hi:[0,1]
v_pk_add_f32 v[44:45], v[44:45], v[56:57]
v_pk_add_f32 v[46:47], v[46:47], v[58:59]
v_pk_add_f32 v[56:57], v[40:41], v[68:69] neg_lo:[0,1] neg_hi:[0,1]
v_pk_add_f32 v[58:59], v[42:43], v[70:71] neg_lo:[0,1] neg_hi:[0,1]
v_pk_add_f32 v[40:41], v[40:41], v[68:69]
v_pk_add_f32 v[42:43], v[42:43], v[70:71]
v_pk_add_f32 v[68:69], v[60:61], v[48:49] neg_lo:[0,1] neg_hi:[0,1]
v_pk_add_f32 v[70:71], v[62:63], v[50:51] neg_lo:[0,1] neg_hi:[0,1]
v_pk_add_f32 v[60:61], v[60:61], v[48:49]
v_pk_add_f32 v[62:63], v[62:63], v[50:51]
v_pk_add_f32 v[48:49], v[144:145], v[84:85] neg_lo:[0,1] neg_hi:[0,1]
v_pk_add_f32 v[50:51], v[146:147], v[86:87] neg_lo:[0,1] neg_hi:[0,1]
v_pk_add_f32 v[144:145], v[144:145], v[84:85]
v_pk_add_f32 v[146:147], v[146:147], v[86:87]
v_pk_add_f32 v[84:85], v[76:77], v[88:89] neg_lo:[0,1] neg_hi:[0,1]
v_pk_add_f32 v[86:87], v[78:79], v[90:91] neg_lo:[0,1] neg_hi:[0,1]
v_pk_add_f32 v[76:77], v[76:77], v[88:89]
v_pk_add_f32 v[78:79], v[78:79], v[90:91]
v_pk_add_f32 v[88:89], v[72:73], v[100:101] neg_lo:[0,1] neg_hi:[0,1]
v_pk_add_f32 v[90:91], v[74:75], v[102:103] neg_lo:[0,1] neg_hi:[0,1]
v_pk_add_f32 v[72:73], v[72:73], v[100:101]
v_pk_add_f32 v[74:75], v[74:75], v[102:103]
v_pk_add_f32 v[100:101], v[92:93], v[96:97] neg_lo:[0,1] neg_hi:[0,1]
v_pk_add_f32 v[102:103], v[94:95], v[98:99] neg_lo:[0,1] neg_hi:[0,1]
v_pk_add_f32 v[92:93], v[92:93], v[96:97]
v_pk_add_f32 v[94:95], v[94:95], v[98:99]
v_pk_add_f32 v[96:97], v[64:65], v[116:117] neg_lo:[0,1] neg_hi:[0,1]
v_pk_add_f32 v[98:99], v[66:67], v[118:119] neg_lo:[0,1] neg_hi:[0,1]
v_pk_add_f32 v[64:65], v[64:65], v[116:117]
v_pk_add_f32 v[66:67], v[66:67], v[118:119]
v_pk_add_f32 v[116:117], v[108:109], v[120:121] neg_lo:[0,1] neg_hi:[0,1]
v_pk_add_f32 v[118:119], v[110:111], v[122:123] neg_lo:[0,1] neg_hi:[0,1]
v_pk_add_f32 v[108:109], v[108:109], v[120:121]
v_pk_add_f32 v[110:111], v[110:111], v[122:123]
v_pk_add_f32 v[120:121], v[104:105], v[132:133] neg_lo:[0,1] neg_hi:[0,1]
v_pk_add_f32 v[122:123], v[106:107], v[134:135] neg_lo:[0,1] neg_hi:[0,1]
v_pk_add_f32 v[104:105], v[104:105], v[132:133]
v_pk_add_f32 v[106:107], v[106:107], v[134:135]
v_pk_add_f32 v[132:133], v[124:125], v[80:81] neg_lo:[0,1] neg_hi:[0,1]
v_pk_add_f32 v[134:135], v[126:127], v[82:83] neg_lo:[0,1] neg_hi:[0,1]
v_pk_add_f32 v[124:125], v[124:125], v[80:81]
v_pk_add_f32 v[126:127], v[126:127], v[82:83]
v_mul_f32 v151, 0xba000000, v2
v_cos_f32 v150, v151
v_sin_f32 v151, v151
v_mul_f32 v149, 0xba800000, v2
v_cos_f32 v148, v149
v_sin_f32 v149, v149
v_pk_mul_f32 v[80:81], v[144:145], v[150:151] op_sel_hi:[1,0]
v_pk_fma_f32 v[80:81], v[146:147], v[150:151], v[80:81] op_sel:[0,1,0] neg_lo:[1,0,0] neg_hi:[1,0,0]
v_pk_mul_f32 v[146:147], v[146:147], v[150:151] op_sel_hi:[1,0]
v_pk_fma_f32 v[146:147], v[144:145], v[150:151], v[146:147] op_sel:[0,1,0]
v_mul_f32 v151, 0xbac00000, v2
v_cos_f32 v150, v151
v_sin_f32 v151, v151
v_pk_mul_f32 v[144:145], v[112:113], v[148:149] op_sel_hi:[1,0]
v_pk_fma_f32 v[144:145], v[114:115], v[148:149], v[144:145] op_sel:[0,1,0] neg_lo:[1,0,0] neg_hi:[1,0,0]
v_pk_mul_f32 v[114:115], v[114:115], v[148:149] op_sel_hi:[1,0]
v_pk_fma_f32 v[114:115], v[112:113], v[148:149], v[114:115] op_sel:[0,1,0]
v_mul_f32 v149, 0xbb000000, v2
v_cos_f32 v148, v149
v_sin_f32 v149, v149
v_pk_mul_f32 v[112:113], v[64:65], v[150:151] op_sel_hi:[1,0]
v_pk_fma_f32 v[112:113], v[66:67], v[150:151], v[112:113] op_sel:[0,1,0] neg_lo:[1,0,0] neg_hi:[1,0,0]
v_pk_mul_f32 v[66:67], v[66:67], v[150:151] op_sel_hi:[1,0]
v_pk_fma_f32 v[66:67], v[64:65], v[150:151], v[66:67] op_sel:[0,1,0]
v_mul_f32 v151, 0xbb200000, v2
v_cos_f32 v150, v151
v_sin_f32 v151, v151
v_pk_mul_f32 v[64:65], v[128:129], v[148:149] op_sel_hi:[1,0]
v_pk_fma_f32 v[64:65], v[130:131], v[148:149], v[64:65] op_sel:[0,1,0] neg_lo:[1,0,0] neg_hi:[1,0,0]
v_pk_mul_f32 v[130:131], v[130:131], v[148:149] op_sel_hi:[1,0]
v_pk_fma_f32 v[130:131], v[128:129], v[148:149], v[130:131] op_sel:[0,1,0]
v_mul_f32 v149, 0xbb400000, v2
v_cos_f32 v148, v149
v_sin_f32 v149, v149
v_pk_mul_f32 v[128:129], v[72:73], v[150:151] op_sel_hi:[1,0]
v_pk_fma_f32 v[128:129], v[74:75], v[150:151], v[128:129] op_sel:[0,1,0] neg_lo:[1,0,0] neg_hi:[1,0,0]
v_pk_mul_f32 v[74:75], v[74:75], v[150:151] op_sel_hi:[1,0]
v_pk_fma_f32 v[74:75], v[72:73], v[150:151], v[74:75] op_sel:[0,1,0]
v_mul_f32 v151, 0xbb600000, v2
v_cos_f32 v150, v151
v_sin_f32 v151, v151
v_pk_mul_f32 v[72:73], v[40:41], v[148:149] op_sel_hi:[1,0]
v_pk_fma_f32 v[72:73], v[42:43], v[148:149], v[72:73] op_sel:[0,1,0] neg_lo:[1,0,0] neg_hi:[1,0,0]
v_pk_mul_f32 v[42:43], v[42:43], v[148:149] op_sel_hi:[1,0]
v_pk_fma_f32 v[42:43], v[40:41], v[148:149], v[42:43] op_sel:[0,1,0]
v_mul_f32 v149, 0xbb800000, v2
v_cos_f32 v148, v149
v_sin_f32 v149, v149
v_pk_mul_f32 v[40:41], v[104:105], v[150:151] op_sel_hi:[1,0]
v_pk_fma_f32 v[40:41], v[106:107], v[150:151], v[40:41] op_sel:[0,1,0] neg_lo:[1,0,0] neg_hi:[1,0,0]
v_pk_mul_f32 v[106:107], v[106:107], v[150:151] op_sel_hi:[1,0]
v_pk_fma_f32 v[106:107], v[104:105], v[150:151], v[106:107] op_sel:[0,1,0]
v_mul_f32 v151, 0xbb900000, v2
v_cos_f32 v150, v151
v_sin_f32 v151, v151
v_pk_mul_f32 v[104:105], v[136:137], v[148:149] op_sel_hi:[1,0]
v_pk_fma_f32 v[104:105], v[138:139], v[148:149], v[104:105] op_sel:[0,1,0] neg_lo:[1,0,0] neg_hi:[1,0,0]
v_pk_mul_f32 v[138:139], v[138:139], v[148:149] op_sel_hi:[1,0]
v_pk_fma_f32 v[138:139], v[136:137], v[148:149], v[138:139] op_sel:[0,1,0]
v_mul_f32 v149, 0xbba00000, v2
v_cos_f32 v148, v149
v_sin_f32 v149, v149
v_pk_mul_f32 v[136:137], v[76:77], v[150:151] op_sel_hi:[1,0]
v_pk_fma_f32 v[136:137], v[78:79], v[150:151], v[136:137] op_sel:[0,1,0] neg_lo:[1,0,0] neg_hi:[1,0,0]
v_pk_mul_f32 v[78:79], v[78:79], v[150:151] op_sel_hi:[1,0]
v_pk_fma_f32 v[78:79], v[76:77], v[150:151], v[78:79] op_sel:[0,1,0]
v_mul_f32 v151, 0xbbb00000, v2
v_cos_f32 v150, v151
v_sin_f32 v151, v151
v_pk_mul_f32 v[76:77], v[44:45], v[148:149] op_sel_hi:[1,0]
v_pk_fma_f32 v[76:77], v[46:47], v[148:149], v[76:77] op_sel:[0,1,0] neg_lo:[1,0,0] neg_hi:[1,0,0]
v_pk_mul_f32 v[46:47], v[46:47], v[148:149] op_sel_hi:[1,0]
v_pk_fma_f32 v[46:47], v[44:45], v[148:149], v[46:47] op_sel:[0,1,0]
v_mul_f32 v149, 0xbbc00000, v2
v_cos_f32 v148, v149
v_sin_f32 v149, v149
v_pk_mul_f32 v[44:45], v[108:109], v[150:151] op_sel_hi:[1,0]
v_pk_fma_f32 v[44:45], v[110:111], v[150:151], v[44:45] op_sel:[0,1,0] neg_lo:[1,0,0] neg_hi:[1,0,0]
v_pk_mul_f32 v[110:111], v[110:111], v[150:151] op_sel_hi:[1,0]
v_pk_fma_f32 v[110:111], v[108:109], v[150:151], v[110:111] op_sel:[0,1,0]
v_mul_f32 v151, 0xbbd00000, v2
v_cos_f32 v150, v151
v_sin_f32 v151, v151
v_pk_mul_f32 v[108:109], v[28:29], v[148:149] op_sel_hi:[1,0]
v_pk_fma_f32 v[108:109], v[30:31], v[148:149], v[108:109] op_sel:[0,1,0] neg_lo:[1,0,0] neg_hi:[1,0,0]
v_pk_mul_f32 v[30:31], v[30:31], v[148:149] op_sel_hi:[1,0]
v_pk_fma_f32 v[30:31], v[28:29], v[148:149], v[30:31] op_sel:[0,1,0]
v_mul_f32 v149, 0xbbe00000, v2
v_cos_f32 v148, v149
v_sin_f32 v149, v149
v_pk_mul_f32 v[28:29], v[92:93], v[150:151] op_sel_hi:[1,0]
v_pk_fma_f32 v[28:29], v[94:95], v[150:151], v[28:29] op_sel:[0,1,0] neg_lo:[1,0,0] neg_hi:[1,0,0]
v_pk_mul_f32 v[94:95], v[94:95], v[150:151] op_sel_hi:[1,0]
v_pk_fma_f32 v[94:95], v[92:93], v[150:151], v[94:95] op_sel:[0,1,0]
v_mul_f32 v151, 0xbbf00000, v2
v_cos_f32 v150, v151
v_sin_f32 v151, v151
v_pk_mul_f32 v[92:93], v[60:61], v[148:149] op_sel_hi:[1,0]
v_pk_fma_f32 v[92:93], v[62:63], v[148:149], v[92:93] op_sel:[0,1,0] neg_lo:[1,0,0] neg_hi:[1,0,0]
v_pk_mul_f32 v[62:63], v[62:63], v[148:149] op_sel_hi:[1,0]
v_pk_fma_f32 v[62:63], v[60:61], v[148:149], v[62:63] op_sel:[0,1,0]
v_mul_f32 v149, 0xbc000000, v2
v_cos_f32 v148, v149
v_sin_f32 v149, v149
v_pk_mul_f32 v[60:61], v[124:125], v[150:151] op_sel_hi:[1,0]
v_pk_fma_f32 v[60:61], v[126:127], v[150:151], v[60:61] op_sel:[0,1,0] neg_lo:[1,0,0] neg_hi:[1,0,0]
v_pk_mul_f32 v[126:127], v[126:127], v[150:151] op_sel_hi:[1,0]
v_pk_fma_f32 v[126:127], v[124:125], v[150:151], v[126:127] op_sel:[0,1,0]
v_mul_f32 v151, 0xbc080000, v2
v_cos_f32 v150, v151
v_sin_f32 v151, v151
v_pk_mul_f32 v[124:125], v[140:141], v[148:149] op_sel_hi:[1,0]
v_pk_fma_f32 v[124:125], v[142:143], v[148:149], v[124:125] op_sel:[0,1,0] neg_lo:[1,0,0] neg_hi:[1,0,0]
v_pk_mul_f32 v[142:143], v[142:143], v[148:149] op_sel_hi:[1,0]
v_pk_fma_f32 v[142:143], v[140:141], v[148:149], v[142:143] op_sel:[0,1,0]
v_mul_f32 v149, 0xbc100000, v2
v_cos_f32 v148, v149
v_sin_f32 v149, v149
v_pk_mul_f32 v[140:141], v[48:49], v[150:151] op_sel_hi:[1,0]
v_pk_fma_f32 v[140:141], v[50:51], v[150:151], v[140:141] op_sel:[0,1,0] neg_lo:[1,0,0] neg_hi:[1,0,0]
v_pk_mul_f32 v[50:51], v[50:51], v[150:151] op_sel_hi:[1,0]
v_pk_fma_f32 v[50:51], v[48:49], v[150:151], v[50:51] op_sel:[0,1,0]
v_mul_f32 v151, 0xbc180000, v2
v_cos_f32 v150, v151
v_sin_f32 v151, v151
v_pk_mul_f32 v[48:49], v[32:33], v[148:149] op_sel_hi:[1,0]
v_pk_fma_f32 v[48:49], v[34:35], v[148:149], v[48:49] op_sel:[0,1,0] neg_lo:[1,0,0] neg_hi:[1,0,0]
v_pk_mul_f32 v[34:35], v[34:35], v[148:149] op_sel_hi:[1,0]
v_pk_fma_f32 v[34:35], v[32:33], v[148:149], v[34:35] op_sel:[0,1,0]
v_mul_f32 v149, 0xbc200000, v2
v_cos_f32 v148, v149
v_sin_f32 v149, v149
v_pk_mul_f32 v[32:33], v[96:97], v[150:151] op_sel_hi:[1,0]
v_pk_fma_f32 v[32:33], v[98:99], v[150:151], v[32:33] op_sel:[0,1,0] neg_lo:[1,0,0] neg_hi:[1,0,0]
v_pk_mul_f32 v[98:99], v[98:99], v[150:151] op_sel_hi:[1,0]
v_pk_fma_f32 v[98:99], v[96:97], v[150:151], v[98:99] op_sel:[0,1,0]
v_mul_f32 v151, 0xbc280000, v2
v_cos_f32 v150, v151
v_sin_f32 v151, v151
v_pk_mul_f32 v[96:97], v[24:25], v[148:149] op_sel_hi:[1,0]
v_pk_fma_f32 v[96:97], v[26:27], v[148:149], v[96:97] op_sel:[0,1,0] neg_lo:[1,0,0] neg_hi:[1,0,0]
v_pk_mul_f32 v[26:27], v[26:27], v[148:149] op_sel_hi:[1,0]
v_pk_fma_f32 v[26:27], v[24:25], v[148:149], v[26:27] op_sel:[0,1,0]
v_mul_f32 v149, 0xbc300000, v2
v_cos_f32 v148, v149
v_sin_f32 v149, v149
v_pk_mul_f32 v[24:25], v[88:89], v[150:151] op_sel_hi:[1,0]
v_pk_fma_f32 v[24:25], v[90:91], v[150:151], v[24:25] op_sel:[0,1,0] neg_lo:[1,0,0] neg_hi:[1,0,0]
v_pk_mul_f32 v[90:91], v[90:91], v[150:151] op_sel_hi:[1,0]
v_pk_fma_f32 v[90:91], v[88:89], v[150:151], v[90:91] op_sel:[0,1,0]
v_mul_f32 v151, 0xbc380000, v2
v_cos_f32 v150, v151
v_sin_f32 v151, v151
v_pk_mul_f32 v[88:89], v[56:57], v[148:149] op_sel_hi:[1,0]
v_pk_fma_f32 v[88:89], v[58:59], v[148:149], v[88:89] op_sel:[0,1,0] neg_lo:[1,0,0] neg_hi:[1,0,0]
v_pk_mul_f32 v[58:59], v[58:59], v[148:149] op_sel_hi:[1,0]
v_pk_fma_f32 v[58:59], v[56:57], v[148:149], v[58:59] op_sel:[0,1,0]
v_mul_f32 v149, 0xbc400000, v2
v_cos_f32 v148, v149
v_sin_f32 v149, v149
v_pk_mul_f32 v[56:57], v[120:121], v[150:151] op_sel_hi:[1,0]
v_pk_fma_f32 v[56:57], v[122:123], v[150:151], v[56:57] op_sel:[0,1,0] neg_lo:[1,0,0] neg_hi:[1,0,0]
v_pk_mul_f32 v[122:123], v[122:123], v[150:151] op_sel_hi:[1,0]
v_pk_fma_f32 v[122:123], v[120:121], v[150:151], v[122:123] op_sel:[0,1,0]
v_mul_f32 v151, 0xbc480000, v2
v_cos_f32 v150, v151
v_sin_f32 v151, v151
v_pk_mul_f32 v[120:121], v[20:21], v[148:149] op_sel_hi:[1,0]
v_pk_fma_f32 v[120:121], v[22:23], v[148:149], v[120:121] op_sel:[0,1,0] neg_lo:[1,0,0] neg_hi:[1,0,0]
v_pk_mul_f32 v[22:23], v[22:23], v[148:149] op_sel_hi:[1,0]
v_pk_fma_f32 v[22:23], v[20:21], v[148:149], v[22:23] op_sel:[0,1,0]
v_mul_f32 v149, 0xbc500000, v2
v_cos_f32 v148, v149
v_sin_f32 v149, v149
v_pk_mul_f32 v[20:21], v[84:85], v[150:151] op_sel_hi:[1,0]
v_pk_fma_f32 v[20:21], v[86:87], v[150:151], v[20:21] op_sel:[0,1,0] neg_lo:[1,0,0] neg_hi:[1,0,0]
v_pk_mul_f32 v[86:87], v[86:87], v[150:151] op_sel_hi:[1,0]
v_pk_fma_f32 v[86:87], v[84:85], v[150:151], v[86:87] op_sel:[0,1,0]
v_mul_f32 v151, 0xbc580000, v2
v_cos_f32 v150, v151
v_sin_f32 v151, v151
v_pk_mul_f32 v[84:85], v[52:53], v[148:149] op_sel_hi:[1,0]
v_pk_fma_f32 v[84:85], v[54:55], v[148:149], v[84:85] op_sel:[0,1,0] neg_lo:[1,0,0] neg_hi:[1,0,0]
v_pk_mul_f32 v[54:55], v[54:55], v[148:149] op_sel_hi:[1,0]
v_pk_fma_f32 v[54:55], v[52:53], v[148:149], v[54:55] op_sel:[0,1,0]
v_mul_f32 v149, 0xbc600000, v2
v_cos_f32 v148, v149
v_sin_f32 v149, v149
v_pk_mul_f32 v[52:53], v[116:117], v[150:151] op_sel_hi:[1,0]
v_pk_fma_f32 v[52:53], v[118:119], v[150:151], v[52:53] op_sel:[0,1,0] neg_lo:[1,0,0] neg_hi:[1,0,0]
v_pk_mul_f32 v[118:119], v[118:119], v[150:151] op_sel_hi:[1,0]
v_pk_fma_f32 v[118:119], v[116:117], v[150:151], v[118:119] op_sel:[0,1,0]
v_mul_f32 v151, 0xbc680000, v2
v_cos_f32 v150, v151
v_sin_f32 v151, v151
v_pk_mul_f32 v[116:117], v[36:37], v[148:149] op_sel_hi:[1,0]
v_pk_fma_f32 v[116:117], v[38:39], v[148:149], v[116:117] op_sel:[0,1,0] neg_lo:[1,0,0] neg_hi:[1,0,0]
v_pk_mul_f32 v[38:39], v[38:39], v[148:149] op_sel_hi:[1,0]
v_pk_fma_f32 v[38:39], v[36:37], v[148:149], v[38:39] op_sel:[0,1,0]
v_mul_f32 v149, 0xbc700000, v2
v_cos_f32 v148, v149
v_sin_f32 v149, v149
v_pk_mul_f32 v[36:37], v[100:101], v[150:151] op_sel_hi:[1,0]
v_pk_fma_f32 v[36:37], v[102:103], v[150:151], v[36:37] op_sel:[0,1,0] neg_lo:[1,0,0] neg_hi:[1,0,0]
v_pk_mul_f32 v[102:103], v[102:103], v[150:151] op_sel_hi:[1,0]
v_pk_fma_f32 v[102:103], v[100:101], v[150:151], v[102:103] op_sel:[0,1,0]
v_mul_f32 v151, 0xbc780000, v2
v_cos_f32 v150, v151
v_sin_f32 v151, v151
v_pk_mul_f32 v[100:101], v[68:69], v[148:149] op_sel_hi:[1,0]
v_pk_fma_f32 v[100:101], v[70:71], v[148:149], v[100:101] op_sel:[0,1,0] neg_lo:[1,0,0] neg_hi:[1,0,0]
v_pk_mul_f32 v[70:71], v[70:71], v[148:149] op_sel_hi:[1,0]
v_pk_fma_f32 v[70:71], v[68:69], v[148:149], v[70:71] op_sel:[0,1,0]
s_nop 0
v_pk_mul_f32 v[68:69], v[132:133], v[150:151] op_sel_hi:[1,0]
v_pk_fma_f32 v[68:69], v[134:135], v[150:151], v[68:69] op_sel:[0,1,0] neg_lo:[1,0,0] neg_hi:[1,0,0]
v_pk_mul_f32 v[134:135], v[134:135], v[150:151] op_sel_hi:[1,0]
v_pk_fma_f32 v[134:135], v[132:133], v[150:151], v[134:135] op_sel:[0,1,0]
ds_write_b64 v3, v[16:17]
ds_write_b64 v3, v[18:19] offset:8
ds_write_b64 v3, v[80:81] offset:1056
ds_write_b64 v3, v[146:147] offset:1064
ds_write_b64 v3, v[144:145] offset:2112
ds_write_b64 v3, v[114:115] offset:2120
ds_write_b64 v3, v[112:113] offset:3168
ds_write_b64 v3, v[66:67] offset:3176
ds_write_b64 v3, v[64:65] offset:4224
ds_write_b64 v3, v[130:131] offset:4232
ds_write_b64 v3, v[128:129] offset:5280
ds_write_b64 v3, v[74:75] offset:5288
ds_write_b64 v3, v[72:73] offset:6336
ds_write_b64 v3, v[42:43] offset:6344
ds_write_b64 v3, v[40:41] offset:7392
ds_write_b64 v3, v[106:107] offset:7400
ds_write_b64 v3, v[104:105] offset:8448
ds_write_b64 v3, v[138:139] offset:8456
ds_write_b64 v3, v[136:137] offset:9504
ds_write_b64 v3, v[78:79] offset:9512
ds_write_b64 v3, v[76:77] offset:10560
ds_write_b64 v3, v[46:47] offset:10568
ds_write_b64 v3, v[44:45] offset:11616
ds_write_b64 v3, v[110:111] offset:11624
ds_write_b64 v3, v[108:109] offset:12672
ds_write_b64 v3, v[30:31] offset:12680
ds_write_b64 v3, v[28:29] offset:13728
ds_write_b64 v3, v[94:95] offset:13736
ds_write_b64 v3, v[92:93] offset:14784
ds_write_b64 v3, v[62:63] offset:14792
ds_write_b64 v3, v[60:61] offset:15840
ds_write_b64 v3, v[126:127] offset:15848
ds_write_b64 v3, v[124:125] offset:16896
ds_write_b64 v3, v[142:143] offset:16904
ds_write_b64 v3, v[140:141] offset:17952
ds_write_b64 v3, v[50:51] offset:17960
ds_write_b64 v3, v[48:49] offset:19008
ds_write_b64 v3, v[34:35] offset:19016
ds_write_b64 v3, v[32:33] offset:20064
ds_write_b64 v3, v[98:99] offset:20072
ds_write_b64 v3, v[96:97] offset:21120
ds_write_b64 v3, v[26:27] offset:21128
ds_write_b64 v3, v[24:25] offset:22176
ds_write_b64 v3, v[90:91] offset:22184
ds_write_b64 v3, v[88:89] offset:23232
ds_write_b64 v3, v[58:59] offset:23240
ds_write_b64 v3, v[56:57] offset:24288
ds_write_b64 v3, v[122:123] offset:24296
ds_write_b64 v3, v[120:121] offset:25344
ds_write_b64 v3, v[22:23] offset:25352
ds_write_b64 v3, v[20:21] offset:26400
ds_write_b64 v3, v[86:87] offset:26408
ds_write_b64 v3, v[84:85] offset:27456
ds_write_b64 v3, v[54:55] offset:27464
ds_write_b64 v3, v[52:53] offset:28512
ds_write_b64 v3, v[118:119] offset:28520
ds_write_b64 v3, v[116:117] offset:29568
ds_write_b64 v3, v[38:39] offset:29576
ds_write_b64 v3, v[36:37] offset:30624
ds_write_b64 v3, v[102:103] offset:30632
ds_write_b64 v3, v[100:101] offset:31680
ds_write_b64 v3, v[70:71] offset:31688
ds_write_b64 v3, v[68:69] offset:32736
ds_write_b64 v3, v[134:135] offset:32744
s_waitcnt lgkmcnt(0)
ds_read_b128 v[16:19], v4
ds_read_b128 v[20:23], v4 offset:32
ds_read_b128 v[24:27], v4 offset:64
ds_read_b128 v[28:31], v4 offset:96
ds_read_b128 v[32:35], v4 offset:128
ds_read_b128 v[36:39], v4 offset:160
ds_read_b128 v[40:43], v4 offset:192
ds_read_b128 v[44:47], v4 offset:224
ds_read_b128 v[48:51], v4 offset:256
ds_read_b128 v[52:55], v4 offset:288
ds_read_b128 v[56:59], v4 offset:320
ds_read_b128 v[60:63], v4 offset:352
s_waitcnt lgkmcnt(4)
ds_read_b128 v[64:67], v4 offset:384
ds_read_b128 v[68:71], v4 offset:416
ds_read_b128 v[72:75], v4 offset:448
ds_read_b128 v[76:79], v4 offset:480
ds_read_b128 v[80:83], v4 offset:512
ds_read_b128 v[84:87], v4 offset:544
ds_read_b128 v[88:91], v4 offset:576
ds_read_b128 v[92:95], v4 offset:608
ds_read_b128 v[96:99], v4 offset:640
ds_read_b128 v[100:103], v4 offset:672
ds_read_b128 v[104:107], v4 offset:704
ds_read_b128 v[108:111], v4 offset:736
s_waitcnt lgkmcnt(4)
ds_read_b128 v[112:115], v4 offset:768
ds_read_b128 v[116:119], v4 offset:800
ds_read_b128 v[120:123], v4 offset:832
ds_read_b128 v[124:127], v4 offset:864
ds_read_b128 v[128:131], v4 offset:896
ds_read_b128 v[132:135], v4 offset:928
ds_read_b128 v[136:139], v4 offset:960
ds_read_b128 v[140:143], v4 offset:992
s_waitcnt lgkmcnt(0)
v_pk_add_f32 v[144:145], v[16:17], v[80:81] neg_lo:[0,1] neg_hi:[0,1]
v_pk_add_f32 v[146:147], v[18:19], v[82:83] neg_lo:[0,1] neg_hi:[0,1]
v_pk_add_f32 v[16:17], v[16:17], v[80:81]
v_pk_add_f32 v[18:19], v[18:19], v[82:83]
v_pk_add_f32 v[80:81], v[20:21], v[84:85] neg_lo:[0,1] neg_hi:[0,1]
v_pk_add_f32 v[82:83], v[22:23], v[86:87] neg_lo:[0,1] neg_hi:[0,1]
v_pk_add_f32 v[20:21], v[20:21], v[84:85]
v_pk_add_f32 v[22:23], v[22:23], v[86:87]
v_pk_mul_f32 v[84:85], v[80:81], s[30:31] op_sel_hi:[1,0]
v_pk_mul_f32 v[86:87], v[80:81], s[36:37] op_sel_hi:[1,0] neg_lo:[0,1] neg_hi:[0,1]
v_pk_fma_f32 v[84:85], v[82:83], s[36:37], v[84:85] op_sel_hi:[1,0,1]
v_pk_fma_f32 v[86:87], v[82:83], s[30:31], v[86:87] op_sel_hi:[1,0,1]
v_pk_add_f32 v[80:81], v[24:25], v[88:89] neg_lo:[0,1] neg_hi:[0,1]
v_pk_add_f32 v[82:83], v[26:27], v[90:91] neg_lo:[0,1] neg_hi:[0,1]
v_pk_add_f32 v[24:25], v[24:25], v[88:89]
v_pk_add_f32 v[26:27], v[26:27], v[90:91]
v_pk_mul_f32 v[88:89], v[80:81], s[30:31] op_sel:[0,1]
v_pk_mul_f32 v[90:91], v[80:81], s[34:35] op_sel:[0,1] neg_lo:[0,1] neg_hi:[0,1]
v_pk_fma_f32 v[88:89], v[82:83], s[34:35], v[88:89] op_sel:[0,1,0]
v_pk_fma_f32 v[90:91], v[82:83], s[30:31], v[90:91] op_sel:[0,1,0]
v_pk_add_f32 v[80:81], v[28:29], v[92:93] neg_lo:[0,1] neg_hi:[0,1]
v_pk_add_f32 v[82:83], v[30:31], v[94:95] neg_lo:[0,1] neg_hi:[0,1]
v_pk_add_f32 v[28:29], v[28:29], v[92:93]
v_pk_add_f32 v[30:31], v[30:31], v[94:95]
v_pk_mul_f32 v[92:93], v[80:81], s[32:33] op_sel_hi:[1,0]
v_pk_mul_f32 v[94:95], v[80:81], s[34:35] op_sel_hi:[1,0] neg_lo:[0,1] neg_hi:[0,1]
v_pk_fma_f32 v[92:93], v[82:83], s[34:35], v[92:93] op_sel_hi:[1,0,1]
v_pk_fma_f32 v[94:95], v[82:83], s[32:33], v[94:95] op_sel_hi:[1,0,1]
v_pk_add_f32 v[80:81], v[32:33], v[96:97] neg_lo:[0,1] neg_hi:[0,1]
v_pk_add_f32 v[82:83], v[34:35], v[98:99] neg_lo:[0,1] neg_hi:[0,1]
v_pk_add_f32 v[32:33], v[32:33], v[96:97]
v_pk_add_f32 v[34:35], v[34:35], v[98:99]
v_pk_mul_f32 v[96:97], v[80:81], s[32:33] op_sel:[0,1]
v_pk_mul_f32 v[98:99], v[80:81], s[32:33] op_sel:[0,1] neg_lo:[0,1] neg_hi:[0,1]
v_pk_fma_f32 v[96:97], v[82:83], s[32:33], v[96:97] op_sel:[0,1,0]
v_pk_fma_f32 v[98:99], v[82:83], s[32:33], v[98:99] op_sel:[0,1,0]
v_pk_add_f32 v[80:81], v[36:37], v[100:101] neg_lo:[0,1] neg_hi:[0,1]
v_pk_add_f32 v[82:83], v[38:39], v[102:103] neg_lo:[0,1] neg_hi:[0,1]
v_pk_add_f32 v[36:37], v[36:37], v[100:101]
v_pk_add_f32 v[38:39], v[38:39], v[102:103]
v_pk_mul_f32 v[100:101], v[80:81], s[34:35] op_sel_hi:[1,0]
v_pk_mul_f32 v[102:103], v[80:81], s[32:33] op_sel_hi:[1,0] neg_lo:[0,1] neg_hi:[0,1]
v_pk_fma_f32 v[100:101], v[82:83], s[32:33], v[100:101] op_sel_hi:[1,0,1]
v_pk_fma_f32 v[102:103], v[82:83], s[34:35], v[102:103] op_sel_hi:[1,0,1]
v_pk_add_f32 v[80:81], v[40:41], v[104:105] neg_lo:[0,1] neg_hi:[0,1]
v_pk_add_f32 v[82:83], v[42:43], v[106:107] neg_lo:[0,1] neg_hi:[0,1]
v_pk_add_f32 v[40:41], v[40:41], v[104:105]
v_pk_add_f32 v[42:43], v[42:43], v[106:107]
v_pk_mul_f32 v[104:105], v[80:81], s[34:35] op_sel:[0,1]
v_pk_mul_f32 v[106:107], v[80:81], s[30:31] op_sel:[0,1] neg_lo:[0,1] neg_hi:[0,1]
v_pk_fma_f32 v[104:105], v[82:83], s[30:31], v[104:105] op_sel:[0,1,0]
v_pk_fma_f32 v[106:107], v[82:83], s[34:35], v[106:107] op_sel:[0,1,0]
v_pk_add_f32 v[80:81], v[44:45], v[108:109] neg_lo:[0,1] neg_hi:[0,1]
v_pk_add_f32 v[82:83], v[46:47], v[110:111] neg_lo:[0,1] neg_hi:[0,1]
v_pk_add_f32 v[44:45], v[44:45], v[108:109]
v_pk_add_f32 v[46:47], v[46:47], v[110:111]
v_pk_mul_f32 v[108:109], v[80:81], s[36:37] op_sel_hi:[1,0]
v_pk_mul_f32 v[110:111], v[80:81], s[30:31] op_sel_hi:[1,0] neg_lo:[0,1] neg_hi:[0,1]
v_pk_fma_f32 v[108:109], v[82:83], s[30:31], v[108:109] op_sel_hi:[1,0,1]
v_pk_fma_f32 v[110:111], v[82:83], s[36:37], v[110:111] op_sel_hi:[1,0,1]
v_pk_add_f32 v[80:81], v[50:51], v[114:115] neg_lo:[0,1] neg_hi:[0,1]
v_pk_add_f32 v[82:83], v[112:113], v[48:49] neg_lo:[0,1] neg_hi:[0,1]
v_pk_add_f32 v[48:49], v[48:49], v[112:113]
v_pk_add_f32 v[50:51], v[50:51], v[114:115]
v_pk_add_f32 v[112:113], v[52:53], v[116:117] neg_lo:[0,1] neg_hi:[0,1]
v_pk_add_f32 v[114:115], v[54:55], v[118:119] neg_lo:[0,1] neg_hi:[0,1]
v_pk_add_f32 v[52:53], v[52:53], v[116:117]
v_pk_add_f32 v[54:55], v[54:55], v[118:119]
v_pk_mul_f32 v[116:117], v[112:113], s[36:37] op_sel_hi:[1,0] neg_lo:[0,1] neg_hi:[0,1]
v_pk_mul_f32 v[118:119], v[112:113], s[30:31] op_sel_hi:[1,0] neg_lo:[0,1] neg_hi:[0,1]
v_pk_fma_f32 v[116:117], v[114:115], s[30:31], v[116:117] op_sel_hi:[1,0,1]
v_pk_fma_f32 v[118:119], v[114:115], s[36:37], v[118:119] op_sel_hi:[1,0,1] neg_lo:[0,1,0] neg_hi:[0,1,0]
v_pk_add_f32 v[112:113], v[56:57], v[120:121] neg_lo:[0,1] neg_hi:[0,1]
v_pk_add_f32 v[114:115], v[58:59], v[122:123] neg_lo:[0,1] neg_hi:[0,1]
v_pk_add_f32 v[56:57], v[56:57], v[120:121]
v_pk_add_f32 v[58:59], v[58:59], v[122:123]
v_pk_mul_f32 v[120:121], v[112:113], s[34:35] op_sel:[0,1] neg_lo:[0,1] neg_hi:[0,1]
v_pk_mul_f32 v[122:123], v[112:113], s[30:31] op_sel:[0,1] neg_lo:[0,1] neg_hi:[0,1]
v_pk_fma_f32 v[120:121], v[114:115], s[30:31], v[120:121] op_sel:[0,1,0]
v_pk_fma_f32 v[122:123], v[114:115], s[34:35], v[122:123] op_sel:[0,1,0] neg_lo:[0,1,0] neg_hi:[0,1,0]
v_pk_add_f32 v[112:113], v[60:61], v[124:125] neg_lo:[0,1] neg_hi:[0,1]
v_pk_add_f32 v[114:115], v[62:63], v[126:127] neg_lo:[0,1] neg_hi:[0,1]
v_pk_add_f32 v[60:61], v[60:61], v[124:125]
v_pk_add_f32 v[62:63], v[62:63], v[126:127]
v_pk_mul_f32 v[124:125], v[112:113], s[34:35] op_sel_hi:[1,0] neg_lo:[0,1] neg_hi:[0,1]
v_pk_mul_f32 v[126:127], v[112:113], s[32:33] op_sel_hi:[1,0] neg_lo:[0,1] neg_hi:[0,1]
v_pk_fma_f32 v[124:125], v[114:115], s[32:33], v[124:125] op_sel_hi:[1,0,1]
v_pk_fma_f32 v[126:127], v[114:115], s[34:35], v[126:127] op_sel_hi:[1,0,1] neg_lo:[0,1,0] neg_hi:[0,1,0]
v_pk_add_f32 v[112:113], v[64:65], v[128:129] neg_lo:[0,1] neg_hi:[0,1]
v_pk_add_f32 v[114:115], v[66:67], v[130:131] neg_lo:[0,1] neg_hi:[0,1]
v_pk_add_f32 v[64:65], v[64:65], v[128:129]
v_pk_add_f32 v[66:67], v[66:67], v[130:131]
v_pk_mul_f32 v[128:129], v[112:113], s[32:33] op_sel:[0,1] neg_lo:[0,1] neg_hi:[0,1]
v_pk_mul_f32 v[130:131], v[112:113], s[32:33] op_sel:[0,1] neg_lo:[0,1] neg_hi:[0,1]
v_pk_fma_f32 v[128:129], v[114:115], s[32:33], v[128:129] op_sel:[0,1,0]
v_pk_fma_f32 v[130:131], v[114:115], s[32:33], v[130:131] op_sel:[0,1,0] neg_lo:[0,1,0] neg_hi:[0,1,0]
v_pk_add_f32 v[112:113], v[68:69], v[132:133] neg_lo:[0,1] neg_hi:[0,1]
v_pk_add_f32 v[114:115], v[70:71], v[134:135] neg_lo:[0,1] neg_hi:[0,1]
v_pk_add_f32 v[68:69], v[68:69], v[132:133]
v_pk_add_f32 v[70:71], v[70:71], v[134:135]
v_pk_mul_f32 v[132:133], v[112:113], s[32:33] op_sel_hi:[1,0] neg_lo:[0,1] neg_hi:[0,1]
v_pk_mul_f32 v[134:135], v[112:113], s[34:35] op_sel_hi:[1,0] neg_lo:[0,1] neg_hi:[0,1]
v_pk_fma_f32 v[132:133], v[114:115], s[34:35], v[132:133] op_sel_hi:[1,0,1]
v_pk_fma_f32 v[134:135], v[114:115], s[32:33], v[134:135] op_sel_hi:[1,0,1] neg_lo:[0,1,0] neg_hi:[0,1,0]
v_pk_add_f32 v[112:113], v[72:73], v[136:137] neg_lo:[0,1] neg_hi:[0,1]
v_pk_add_f32 v[114:115], v[74:75], v[138:139] neg_lo:[0,1] neg_hi:[0,1]
v_pk_add_f32 v[72:73], v[72:73], v[136:137]
v_pk_add_f32 v[74:75], v[74:75], v[138:139]
v_pk_mul_f32 v[136:137], v[112:113], s[30:31] op_sel:[0,1] neg_lo:[0,1] neg_hi:[0,1]
v_pk_mul_f32 v[138:139], v[112:113], s[34:35] op_sel:[0,1] neg_lo:[0,1] neg_hi:[0,1]
v_pk_fma_f32 v[136:137], v[114:115], s[34:35], v[136:137] op_sel:[0,1,0]
v_pk_fma_f32 v[138:139], v[114:115], s[30:31], v[138:139] op_sel:[0,1,0] neg_lo:[0,1,0] neg_hi:[0,1,0]
v_pk_add_f32 v[112:113], v[76:77], v[140:141] neg_lo:[0,1] neg_hi:[0,1]
v_pk_add_f32 v[114:115], v[78:79], v[142:143] neg_lo:[0,1] neg_hi:[0,1]
v_pk_add_f32 v[76:77], v[76:77], v[140:141]
v_pk_add_f32 v[78:79], v[78:79], v[142:143]
v_pk_mul_f32 v[140:141], v[112:113], s[30:31] op_sel_hi:[1,0] neg_lo:[0,1] neg_hi:[0,1]
v_pk_mul_f32 v[142:143], v[112:113], s[36:37] op_sel_hi:[1,0] neg_lo:[0,1] neg_hi:[0,1]
v_pk_fma_f32 v[140:141], v[114:115], s[36:37], v[140:141] op_sel_hi:[1,0,1]
v_pk_fma_f32 v[142:143], v[114:115], s[30:31], v[142:143] op_sel_hi:[1,0,1] neg_lo:[0,1,0] neg_hi:[0,1,0]
v_pk_add_f32 v[112:113], v[16:17], v[48:49] neg_lo:[0,1] neg_hi:[0,1]
v_pk_add_f32 v[114:115], v[18:19], v[50:51] neg_lo:[0,1] neg_hi:[0,1]
v_pk_add_f32 v[16:17], v[16:17], v[48:49]
v_pk_add_f32 v[18:19], v[18:19], v[50:51]
v_pk_add_f32 v[48:49], v[20:21], v[52:53] neg_lo:[0,1] neg_hi:[0,1]
v_pk_add_f32 v[50:51], v[22:23], v[54:55] neg_lo:[0,1] neg_hi:[0,1]
v_pk_add_f32 v[20:21], v[20:21], v[52:53]
v_pk_add_f32 v[22:23], v[22:23], v[54:55]
v_pk_mul_f32 v[52:53], v[48:49], s[30:31] op_sel:[0,1]
v_pk_mul_f32 v[54:55], v[48:49], s[34:35] op_sel:[0,1] neg_lo:[0,1] neg_hi:[0,1]
v_pk_fma_f32 v[52:53], v[50:51], s[34:35], v[52:53] op_sel:[0,1,0]
v_pk_fma_f32 v[54:55], v[50:51], s[30:31], v[54:55] op_sel:[0,1,0]
v_pk_add_f32 v[48:49], v[24:25], v[56:57] neg_lo:[0,1] neg_hi:[0,1]
v_pk_add_f32 v[50:51], v[26:27], v[58:59] neg_lo:[0,1] neg_hi:[0,1]
v_pk_add_f32 v[24:25], v[24:25], v[56:57]
v_pk_add_f32 v[26:27], v[26:27], v[58:59]
v_pk_mul_f32 v[56:57], v[48:49], s[32:33] op_sel:[0,1]
v_pk_mul_f32 v[58:59], v[48:49], s[32:33] op_sel:[0,1] neg_lo:[0,1] neg_hi:[0,1]
v_pk_fma_f32 v[56:57], v[50:51], s[32:33], v[56:57] op_sel:[0,1,0]
v_pk_fma_f32 v[58:59], v[50:51], s[32:33], v[58:59] op_sel:[0,1,0]
v_pk_add_f32 v[48:49], v[28:29], v[60:61] neg_lo:[0,1] neg_hi:[0,1]
v_pk_add_f32 v[50:51], v[30:31], v[62:63] neg_lo:[0,1] neg_hi:[0,1]
v_pk_add_f32 v[28:29], v[28:29], v[60:61]
v_pk_add_f32 v[30:31], v[30:31], v[62:63]
v_pk_mul_f32 v[60:61], v[48:49], s[34:35] op_sel:[0,1]
v_pk_mul_f32 v[62:63], v[48:49], s[30:31] op_sel:[0,1] neg_lo:[0,1] neg_hi:[0,1]
v_pk_fma_f32 v[60:61], v[50:51], s[30:31], v[60:61] op_sel:[0,1,0]
v_pk_fma_f32 v[62:63], v[50:51], s[34:35], v[62:63] op_sel:[0,1,0]
v_pk_add_f32 v[48:49], v[34:35], v[66:67] neg_lo:[0,1] neg_hi:[0,1]
v_pk_add_f32 v[50:51], v[64:65], v[32:33] neg_lo:[0,1] neg_hi:[0,1]
v_pk_add_f32 v[32:33], v[32:33], v[64:65]
v_pk_add_f32 v[34:35], v[34:35], v[66:67]
v_pk_add_f32 v[64:65], v[36:37], v[68:69] neg_lo:[0,1] neg_hi:[0,1]
v_pk_add_f32 v[66:67], v[38:39], v[70:71] neg_lo:[0,1] neg_hi:[0,1]
v_pk_add_f32 v[36:37], v[36:37], v[68:69]
v_pk_add_f32 v[38:39], v[38:39], v[70:71]
v_pk_mul_f32 v[68:69], v[64:65], s[34:35] op_sel:[0,1] neg_lo:[0,1] neg_hi:[0,1]
v_pk_mul_f32 v[70:71], v[64:65], s[30:31] op_sel:[0,1] neg_lo:[0,1] neg_hi:[0,1]
v_pk_fma_f32 v[68:69], v[66:67], s[30:31], v[68:69] op_sel:[0,1,0]
v_pk_fma_f32 v[70:71], v[66:67], s[34:35], v[70:71] op_sel:[0,1,0] neg_lo:[0,1,0] neg_hi:[0,1,0]
v_pk_add_f32 v[64:65], v[40:41], v[72:73] neg_lo:[0,1] neg_hi:[0,1]
v_pk_add_f32 v[66:67], v[42:43], v[74:75] neg_lo:[0,1] neg_hi:[0,1]
v_pk_add_f32 v[40:41], v[40:41], v[72:73]
v_pk_add_f32 v[42:43], v[42:43], v[74:75]
v_pk_mul_f32 v[72:73], v[64:65], s[32:33] op_sel:[0,1] neg_lo:[0,1] neg_hi:[0,1]
v_pk_mul_f32 v[74:75], v[64:65], s[32:33] op_sel:[0,1] neg_lo:[0,1] neg_hi:[0,1]
v_pk_fma_f32 v[72:73], v[66:67], s[32:33], v[72:73] op_sel:[0,1,0]
v_pk_fma_f32 v[74:75], v[66:67], s[32:33], v[74:75] op_sel:[0,1,0] neg_lo:[0,1,0] neg_hi:[0,1,0]
v_pk_add_f32 v[64:65], v[44:45], v[76:77] neg_lo:[0,1] neg_hi:[0,1]
v_pk_add_f32 v[66:67], v[46:47], v[78:79] neg_lo:[0,1] neg_hi:[0,1]
v_pk_add_f32 v[44:45], v[44:45], v[76:77]
v_pk_add_f32 v[46:47], v[46:47], v[78:79]
v_pk_mul_f32 v[76:77], v[64:65], s[30:31] op_sel:[0,1] neg_lo:[0,1] neg_hi:[0,1]
v_pk_mul_f32 v[78:79], v[64:65], s[34:35] op_sel:[0,1] neg_lo:[0,1] neg_hi:[0,1]
v_pk_fma_f32 v[76:77], v[66:67], s[34:35], v[76:77] op_sel:[0,1,0]
v_pk_fma_f32 v[78:79], v[66:67], s[30:31], v[78:79] op_sel:[0,1,0] neg_lo:[0,1,0] neg_hi:[0,1,0]
v_pk_add_f32 v[64:65], v[144:145], v[80:81] neg_lo:[0,1] neg_hi:[0,1]
v_pk_add_f32 v[66:67], v[146:147], v[82:83] neg_lo:[0,1] neg_hi:[0,1]
v_pk_add_f32 v[144:145], v[144:145], v[80:81]
v_pk_add_f32 v[146:147], v[146:147], v[82:83]
v_pk_add_f32 v[80:81], v[84:85], v[116:117] neg_lo:[0,1] neg_hi:[0,1]
v_pk_add_f32 v[82:83], v[86:87], v[118:119] neg_lo:[0,1] neg_hi:[0,1]
v_pk_add_f32 v[84:85], v[84:85], v[116:117]
v_pk_add_f32 v[86:87], v[86:87], v[118:119]
v_pk_mul_f32 v[116:117], v[80:81], s[30:31] op_sel:[0,1]
v_pk_mul_f32 v[118:119], v[80:81], s[34:35] op_sel:[0,1] neg_lo:[0,1] neg_hi:[0,1]
v_pk_fma_f32 v[116:117], v[82:83], s[34:35], v[116:117] op_sel:[0,1,0]
v_pk_fma_f32 v[118:119], v[82:83], s[30:31], v[118:119] op_sel:[0,1,0]
v_pk_add_f32 v[80:81], v[88:89], v[120:121] neg_lo:[0,1] neg_hi:[0,1]
v_pk_add_f32 v[82:83], v[90:91], v[122:123] neg_lo:[0,1] neg_hi:[0,1]
v_pk_add_f32 v[88:89], v[88:89], v[120:121]
v_pk_add_f32 v[90:91], v[90:91], v[122:123]
v_pk_mul_f32 v[120:121], v[80:81], s[32:33] op_sel:[0,1]
v_pk_mul_f32 v[122:123], v[80:81], s[32:33] op_sel:[0,1] neg_lo:[0,1] neg_hi:[0,1]
v_pk_fma_f32 v[120:121], v[82:83], s[32:33], v[120:121] op_sel:[0,1,0]
v_pk_fma_f32 v[122:123], v[82:83], s[32:33], v[122:123] op_sel:[0,1,0]
v_pk_add_f32 v[80:81], v[92:93], v[124:125] neg_lo:[0,1] neg_hi:[0,1]
v_pk_add_f32 v[82:83], v[94:95], v[126:127] neg_lo:[0,1] neg_hi:[0,1]
v_pk_add_f32 v[92:93], v[92:93], v[124:125]
v_pk_add_f32 v[94:95], v[94:95], v[126:127]
v_pk_mul_f32 v[124:125], v[80:81], s[34:35] op_sel:[0,1]
v_pk_mul_f32 v[126:127], v[80:81], s[30:31] op_sel:[0,1] neg_lo:[0,1] neg_hi:[0,1]
v_pk_fma_f32 v[124:125], v[82:83], s[30:31], v[124:125] op_sel:[0,1,0]
v_pk_fma_f32 v[126:127], v[82:83], s[34:35], v[126:127] op_sel:[0,1,0]
v_pk_add_f32 v[80:81], v[98:99], v[130:131] neg_lo:[0,1] neg_hi:[0,1]
v_pk_add_f32 v[82:83], v[128:129], v[96:97] neg_lo:[0,1] neg_hi:[0,1]
v_pk_add_f32 v[96:97], v[96:97], v[128:129]
v_pk_add_f32 v[98:99], v[98:99], v[130:131]
v_pk_add_f32 v[128:129], v[100:101], v[132:133] neg_lo:[0,1] neg_hi:[0,1]
v_pk_add_f32 v[130:131], v[102:103], v[134:135] neg_lo:[0,1] neg_hi:[0,1]
v_pk_add_f32 v[100:101], v[100:101], v[132:133]
v_pk_add_f32 v[102:103], v[102:103], v[134:135]
v_pk_mul_f32 v[132:133], v[128:129], s[34:35] op_sel:[0,1] neg_lo:[0,1] neg_hi:[0,1]
v_pk_mul_f32 v[134:135], v[128:129], s[30:31] op_sel:[0,1] neg_lo:[0,1] neg_hi:[0,1]
v_pk_fma_f32 v[132:133], v[130:131], s[30:31], v[132:133] op_sel:[0,1,0]
v_pk_fma_f32 v[134:135], v[130:131], s[34:35], v[134:135] op_sel:[0,1,0] neg_lo:[0,1,0] neg_hi:[0,1,0]
v_pk_add_f32 v[128:129], v[104:105], v[136:137] neg_lo:[0,1] neg_hi:[0,1]
v_pk_add_f32 v[130:131], v[106:107], v[138:139] neg_lo:[0,1] neg_hi:[0,1]
v_pk_add_f32 v[104:105], v[104:105], v[136:137]
v_pk_add_f32 v[106:107], v[106:107], v[138:139]
v_pk_mul_f32 v[136:137], v[128:129], s[32:33] op_sel:[0,1] neg_lo:[0,1] neg_hi:[0,1]
v_pk_mul_f32 v[138:139], v[128:129], s[32:33] op_sel:[0,1] neg_lo:[0,1] neg_hi:[0,1]
v_pk_fma_f32 v[136:137], v[130:131], s[32:33], v[136:137] op_sel:[0,1,0]
v_pk_fma_f32 v[138:139], v[130:131], s[32:33], v[138:139] op_sel:[0,1,0] neg_lo:[0,1,0] neg_hi:[0,1,0]
v_pk_add_f32 v[128:129], v[108:109], v[140:141] neg_lo:[0,1] neg_hi:[0,1]
v_pk_add_f32 v[130:131], v[110:111], v[142:143] neg_lo:[0,1] neg_hi:[0,1]
v_pk_add_f32 v[108:109], v[108:109], v[140:141]
v_pk_add_f32 v[110:111], v[110:111], v[142:143]
v_pk_mul_f32 v[140:141], v[128:129], s[30:31] op_sel:[0,1] neg_lo:[0,1] neg_hi:[0,1]
v_pk_mul_f32 v[142:143], v[128:129], s[34:35] op_sel:[0,1] neg_lo:[0,1] neg_hi:[0,1]
v_pk_fma_f32 v[140:141], v[130:131], s[34:35], v[140:141] op_sel:[0,1,0]
v_pk_fma_f32 v[142:143], v[130:131], s[30:31], v[142:143] op_sel:[0,1,0] neg_lo:[0,1,0] neg_hi:[0,1,0]
v_pk_add_f32 v[128:129], v[16:17], v[32:33] neg_lo:[0,1] neg_hi:[0,1]
v_pk_add_f32 v[130:131], v[18:19], v[34:35] neg_lo:[0,1] neg_hi:[0,1]
v_pk_add_f32 v[16:17], v[16:17], v[32:33]
v_pk_add_f32 v[18:19], v[18:19], v[34:35]
v_pk_add_f32 v[32:33], v[20:21], v[36:37] neg_lo:[0,1] neg_hi:[0,1]
v_pk_add_f32 v[34:35], v[22:23], v[38:39] neg_lo:[0,1] neg_hi:[0,1]
v_pk_add_f32 v[20:21], v[20:21], v[36:37]
v_pk_add_f32 v[22:23], v[22:23], v[38:39]
v_pk_mul_f32 v[36:37], v[32:33], s[32:33] op_sel:[0,1]
v_pk_mul_f32 v[38:39], v[32:33], s[32:33] op_sel:[0,1] neg_lo:[0,1] neg_hi:[0,1]
v_pk_fma_f32 v[36:37], v[34:35], s[32:33], v[36:37] op_sel:[0,1,0]
v_pk_fma_f32 v[38:39], v[34:35], s[32:33], v[38:39] op_sel:[0,1,0]
v_pk_add_f32 v[32:33], v[26:27], v[42:43] neg_lo:[0,1] neg_hi:[0,1]
v_pk_add_f32 v[34:35], v[40:41], v[24:25] neg_lo:[0,1] neg_hi:[0,1]
v_pk_add_f32 v[24:25], v[24:25], v[40:41]
v_pk_add_f32 v[26:27], v[26:27], v[42:43]
v_pk_add_f32 v[40:41], v[28:29], v[44:45] neg_lo:[0,1] neg_hi:[0,1]
v_pk_add_f32 v[42:43], v[30:31], v[46:47] neg_lo:[0,1] neg_hi:[0,1]
v_pk_add_f32 v[28:29], v[28:29], v[44:45]
v_pk_add_f32 v[30:31], v[30:31], v[46:47]
v_pk_mul_f32 v[44:45], v[40:41], s[32:33] op_sel:[0,1] neg_lo:[0,1] neg_hi:[0,1]
v_pk_mul_f32 v[46:47], v[40:41], s[32:33] op_sel:[0,1] neg_lo:[0,1] neg_hi:[0,1]
v_pk_fma_f32 v[44:45], v[42:43], s[32:33], v[44:45] op_sel:[0,1,0]
v_pk_fma_f32 v[46:47], v[42:43], s[32:33], v[46:47] op_sel:[0,1,0] neg_lo:[0,1,0] neg_hi:[0,1,0]
v_pk_add_f32 v[40:41], v[112:113], v[48:49] neg_lo:[0,1] neg_hi:[0,1]
v_pk_add_f32 v[42:43], v[114:115], v[50:51] neg_lo:[0,1] neg_hi:[0,1]
v_pk_add_f32 v[112:113], v[112:113], v[48:49]
v_pk_add_f32 v[114:115], v[114:115], v[50:51]
v_pk_add_f32 v[48:49], v[52:53], v[68:69] neg_lo:[0,1] neg_hi:[0,1]
v_pk_add_f32 v[50:51], v[54:55], v[70:71] neg_lo:[0,1] neg_hi:[0,1]
v_pk_add_f32 v[52:53], v[52:53], v[68:69]
v_pk_add_f32 v[54:55], v[54:55], v[70:71]
v_pk_mul_f32 v[68:69], v[48:49], s[32:33] op_sel:[0,1]
v_pk_mul_f32 v[70:71], v[48:49], s[32:33] op_sel:[0,1] neg_lo:[0,1] neg_hi:[0,1]
v_pk_fma_f32 v[68:69], v[50:51], s[32:33], v[68:69] op_sel:[0,1,0]
v_pk_fma_f32 v[70:71], v[50:51], s[32:33], v[70:71] op_sel:[0,1,0]
v_pk_add_f32 v[48:49], v[58:59], v[74:75] neg_lo:[0,1] neg_hi:[0,1]
v_pk_add_f32 v[50:51], v[72:73], v[56:57] neg_lo:[0,1] neg_hi:[0,1]
v_pk_add_f32 v[56:57], v[56:57], v[72:73]
v_pk_add_f32 v[58:59], v[58:59], v[74:75]
v_pk_add_f32 v[72:73], v[60:61], v[76:77] neg_lo:[0,1] neg_hi:[0,1]
v_pk_add_f32 v[74:75], v[62:63], v[78:79] neg_lo:[0,1] neg_hi:[0,1]
v_pk_add_f32 v[60:61], v[60:61], v[76:77]
v_pk_add_f32 v[62:63], v[62:63], v[78:79]
v_pk_mul_f32 v[76:77], v[72:73], s[32:33] op_sel:[0,1] neg_lo:[0,1] neg_hi:[0,1]
v_pk_mul_f32 v[78:79], v[72:73], s[32:33] op_sel:[0,1] neg_lo:[0,1] neg_hi:[0,1]
v_pk_fma_f32 v[76:77], v[74:75], s[32:33], v[76:77] op_sel:[0,1,0]
v_pk_fma_f32 v[78:79], v[74:75], s[32:33], v[78:79] op_sel:[0,1,0] neg_lo:[0,1,0] neg_hi:[0,1,0]
v_pk_add_f32 v[72:73], v[144:145], v[96:97] neg_lo:[0,1] neg_hi:[0,1]
v_pk_add_f32 v[74:75], v[146:147], v[98:99] neg_lo:[0,1] neg_hi:[0,1]
v_pk_add_f32 v[144:145], v[144:145], v[96:97]
v_pk_add_f32 v[146:147], v[146:147], v[98:99]
v_pk_add_f32 v[96:97], v[84:85], v[100:101] neg_lo:[0,1] neg_hi:[0,1]
v_pk_add_f32 v[98:99], v[86:87], v[102:103] neg_lo:[0,1] neg_hi:[0,1]
v_pk_add_f32 v[84:85], v[84:85], v[100:101]
v_pk_add_f32 v[86:87], v[86:87], v[102:103]
v_pk_mul_f32 v[100:101], v[96:97], s[32:33] op_sel:[0,1]
v_pk_mul_f32 v[102:103], v[96:97], s[32:33] op_sel:[0,1] neg_lo:[0,1] neg_hi:[0,1]
v_pk_fma_f32 v[100:101], v[98:99], s[32:33], v[100:101] op_sel:[0,1,0]
v_pk_fma_f32 v[102:103], v[98:99], s[32:33], v[102:103] op_sel:[0,1,0]
v_pk_add_f32 v[96:97], v[90:91], v[106:107] neg_lo:[0,1] neg_hi:[0,1]
v_pk_add_f32 v[98:99], v[104:105], v[88:89] neg_lo:[0,1] neg_hi:[0,1]
v_pk_add_f32 v[88:89], v[88:89], v[104:105]
v_pk_add_f32 v[90:91], v[90:91], v[106:107]
v_pk_add_f32 v[104:105], v[92:93], v[108:109] neg_lo:[0,1] neg_hi:[0,1]
v_pk_add_f32 v[106:107], v[94:95], v[110:111] neg_lo:[0,1] neg_hi:[0,1]
v_pk_add_f32 v[92:93], v[92:93], v[108:109]
v_pk_add_f32 v[94:95], v[94:95], v[110:111]
v_pk_mul_f32 v[108:109], v[104:105], s[32:33] op_sel:[0,1] neg_lo:[0,1] neg_hi:[0,1]
v_pk_mul_f32 v[110:111], v[104:105], s[32:33] op_sel:[0,1] neg_lo:[0,1] neg_hi:[0,1]
v_pk_fma_f32 v[108:109], v[106:107], s[32:33], v[108:109] op_sel:[0,1,0]
v_pk_fma_f32 v[110:111], v[106:107], s[32:33], v[110:111] op_sel:[0,1,0] neg_lo:[0,1,0] neg_hi:[0,1,0]
v_pk_add_f32 v[104:105], v[64:65], v[80:81] neg_lo:[0,1] neg_hi:[0,1]
v_pk_add_f32 v[106:107], v[66:67], v[82:83] neg_lo:[0,1] neg_hi:[0,1]
v_pk_add_f32 v[64:65], v[64:65], v[80:81]
v_pk_add_f32 v[66:67], v[66:67], v[82:83]
v_pk_add_f32 v[80:81], v[116:117], v[132:133] neg_lo:[0,1] neg_hi:[0,1]
v_pk_add_f32 v[82:83], v[118:119], v[134:135] neg_lo:[0,1] neg_hi:[0,1]
v_pk_add_f32 v[116:117], v[116:117], v[132:133]
v_pk_add_f32 v[118:119], v[118:119], v[134:135]
v_pk_mul_f32 v[132:133], v[80:81], s[32:33] op_sel:[0,1]
v_pk_mul_f32 v[134:135], v[80:81], s[32:33] op_sel:[0,1] neg_lo:[0,1] neg_hi:[0,1]
v_pk_fma_f32 v[132:133], v[82:83], s[32:33], v[132:133] op_sel:[0,1,0]
v_pk_fma_f32 v[134:135], v[82:83], s[32:33], v[134:135] op_sel:[0,1,0]
v_pk_add_f32 v[80:81], v[122:123], v[138:139] neg_lo:[0,1] neg_hi:[0,1]
v_pk_add_f32 v[82:83], v[136:137], v[120:121] neg_lo:[0,1] neg_hi:[0,1]
v_pk_add_f32 v[120:121], v[120:121], v[136:137]
v_pk_add_f32 v[122:123], v[122:123], v[138:139]
v_pk_add_f32 v[136:137], v[124:125], v[140:141] neg_lo:[0,1] neg_hi:[0,1]
v_pk_add_f32 v[138:139], v[126:127], v[142:143] neg_lo:[0,1] neg_hi:[0,1]
v_pk_add_f32 v[124:125], v[124:125], v[140:141]
v_pk_add_f32 v[126:127], v[126:127], v[142:143]
v_pk_mul_f32 v[140:141], v[136:137], s[32:33] op_sel:[0,1] neg_lo:[0,1] neg_hi:[0,1]
v_pk_mul_f32 v[142:143], v[136:137], s[32:33] op_sel:[0,1] neg_lo:[0,1] neg_hi:[0,1]
v_pk_fma_f32 v[140:141], v[138:139], s[32:33], v[140:141] op_sel:[0,1,0]
v_pk_fma_f32 v[142:143], v[138:139], s[32:33], v[142:143] op_sel:[0,1,0] neg_lo:[0,1,0] neg_hi:[0,1,0]
v_pk_add_f32 v[136:137], v[16:17], v[24:25] neg_lo:[0,1] neg_hi:[0,1]
v_pk_add_f32 v[138:139], v[18:19], v[26:27] neg_lo:[0,1] neg_hi:[0,1]
v_pk_add_f32 v[16:17], v[16:17], v[24:25]
v_pk_add_f32 v[18:19], v[18:19], v[26:27]
v_pk_add_f32 v[24:25], v[22:23], v[30:31] neg_lo:[0,1] neg_hi:[0,1]
v_pk_add_f32 v[26:27], v[28:29], v[20:21] neg_lo:[0,1] neg_hi:[0,1]
v_pk_add_f32 v[20:21], v[20:21], v[28:29]
v_pk_add_f32 v[22:23], v[22:23], v[30:31]
v_pk_add_f32 v[28:29], v[128:129], v[32:33] neg_lo:[0,1] neg_hi:[0,1]
v_pk_add_f32 v[30:31], v[130:131], v[34:35] neg_lo:[0,1] neg_hi:[0,1]
v_pk_add_f32 v[128:129], v[128:129], v[32:33]
v_pk_add_f32 v[130:131], v[130:131], v[34:35]
v_pk_add_f32 v[32:33], v[38:39], v[46:47] neg_lo:[0,1] neg_hi:[0,1]
v_pk_add_f32 v[34:35], v[44:45], v[36:37] neg_lo:[0,1] neg_hi:[0,1]
v_pk_add_f32 v[36:37], v[36:37], v[44:45]
v_pk_add_f32 v[38:39], v[38:39], v[46:47]
v_pk_add_f32 v[44:45], v[112:113], v[56:57] neg_lo:[0,1] neg_hi:[0,1]
v_pk_add_f32 v[46:47], v[114:115], v[58:59] neg_lo:[0,1] neg_hi:[0,1]
v_pk_add_f32 v[112:113], v[112:113], v[56:57]
v_pk_add_f32 v[114:115], v[114:115], v[58:59]
v_pk_add_f32 v[56:57], v[54:55], v[62:63] neg_lo:[0,1] neg_hi:[0,1]
v_pk_add_f32 v[58:59], v[60:61], v[52:53] neg_lo:[0,1] neg_hi:[0,1]
v_pk_add_f32 v[52:53], v[52:53], v[60:61]
v_pk_add_f32 v[54:55], v[54:55], v[62:63]
v_pk_add_f32 v[60:61], v[40:41], v[48:49] neg_lo:[0,1] neg_hi:[0,1]
v_pk_add_f32 v[62:63], v[42:43], v[50:51] neg_lo:[0,1] neg_hi:[0,1]
v_pk_add_f32 v[40:41], v[40:41], v[48:49]
v_pk_add_f32 v[42:43], v[42:43], v[50:51]
v_pk_add_f32 v[48:49], v[70:71], v[78:79] neg_lo:[0,1] neg_hi:[0,1]
v_pk_add_f32 v[50:51], v[76:77], v[68:69] neg_lo:[0,1] neg_hi:[0,1]
v_pk_add_f32 v[68:69], v[68:69], v[76:77]
v_pk_add_f32 v[70:71], v[70:71], v[78:79]
v_pk_add_f32 v[76:77], v[144:145], v[88:89] neg_lo:[0,1] neg_hi:[0,1]
v_pk_add_f32 v[78:79], v[146:147], v[90:91] neg_lo:[0,1] neg_hi:[0,1]
v_pk_add_f32 v[144:145], v[144:145], v[88:89]
v_pk_add_f32 v[146:147], v[146:147], v[90:91]
v_pk_add_f32 v[88:89], v[86:87], v[94:95] neg_lo:[0,1] neg_hi:[0,1]
v_pk_add_f32 v[90:91], v[92:93], v[84:85] neg_lo:[0,1] neg_hi:[0,1]
v_pk_add_f32 v[84:85], v[84:85], v[92:93]
v_pk_add_f32 v[86:87], v[86:87], v[94:95]
v_pk_add_f32 v[92:93], v[72:73], v[96:97] neg_lo:[0,1] neg_hi:[0,1]
v_pk_add_f32 v[94:95], v[74:75], v[98:99] neg_lo:[0,1] neg_hi:[0,1]
v_pk_add_f32 v[72:73], v[72:73], v[96:97]
v_pk_add_f32 v[74:75], v[74:75], v[98:99]
v_pk_add_f32 v[96:97], v[102:103], v[110:111] neg_lo:[0,1] neg_hi:[0,1]
v_pk_add_f32 v[98:99], v[108:109], v[100:101] neg_lo:[0,1] neg_hi:[0,1]
v_pk_add_f32 v[100:101], v[100:101], v[108:109]
v_pk_add_f32 v[102:103], v[102:103], v[110:111]
v_pk_add_f32 v[108:109], v[64:65], v[120:121] neg_lo:[0,1] neg_hi:[0,1]
v_pk_add_f32 v[110:111], v[66:67], v[122:123] neg_lo:[0,1] neg_hi:[0,1]
v_pk_add_f32 v[64:65], v[64:65], v[120:121]
v_pk_add_f32 v[66:67], v[66:67], v[122:123]
v_pk_add_f32 v[120:121], v[118:119], v[126:127] neg_lo:[0,1] neg_hi:[0,1]
v_pk_add_f32 v[122:123], v[124:125], v[116:117] neg_lo:[0,1] neg_hi:[0,1]
v_pk_add_f32 v[116:117], v[116:117], v[124:125]
v_pk_add_f32 v[118:119], v[118:119], v[126:127]
v_pk_add_f32 v[124:125], v[104:105], v[80:81] neg_lo:[0,1] neg_hi:[0,1]
v_pk_add_f32 v[126:127], v[106:107], v[82:83] neg_lo:[0,1] neg_hi:[0,1]
v_pk_add_f32 v[104:105], v[104:105], v[80:81]
v_pk_add_f32 v[106:107], v[106:107], v[82:83]
v_pk_add_f32 v[80:81], v[134:135], v[142:143] neg_lo:[0,1] neg_hi:[0,1]
v_pk_add_f32 v[82:83], v[140:141], v[132:133] neg_lo:[0,1] neg_hi:[0,1]
v_pk_add_f32 v[132:133], v[132:133], v[140:141]
v_pk_add_f32 v[134:135], v[134:135], v[142:143]
v_pk_add_f32 v[140:141], v[16:17], v[20:21] neg_lo:[0,1] neg_hi:[0,1]
v_pk_add_f32 v[142:143], v[18:19], v[22:23] neg_lo:[0,1] neg_hi:[0,1]
v_pk_add_f32 v[16:17], v[16:17], v[20:21]
v_pk_add_f32 v[18:19], v[18:19], v[22:23]
v_pk_add_f32 v[20:21], v[136:137], v[24:25] neg_lo:[0,1] neg_hi:[0,1]
v_pk_add_f32 v[22:23], v[138:139], v[26:27] neg_lo:[0,1] neg_hi:[0,1]
v_pk_add_f32 v[136:137], v[136:137], v[24:25]
v_pk_add_f32 v[138:139], v[138:139], v[26:27]
v_pk_add_f32 v[24:25], v[128:129], v[36:37] neg_lo:[0,1] neg_hi:[0,1]
v_pk_add_f32 v[26:27], v[130:131], v[38:39] neg_lo:[0,1] neg_hi:[0,1]
v_pk_add_f32 v[128:129], v[128:129], v[36:37]
v_pk_add_f32 v[130:131], v[130:131], v[38:39]
v_pk_add_f32 v[36:37], v[28:29], v[32:33] neg_lo:[0,1] neg_hi:[0,1]
v_pk_add_f32 v[38:39], v[30:31], v[34:35] neg_lo:[0,1] neg_hi:[0,1]
v_pk_add_f32 v[28:29], v[28:29], v[32:33]
v_pk_add_f32 v[30:31], v[30:31], v[34:35]
v_pk_add_f32 v[32:33], v[112:113], v[52:53] neg_lo:[0,1] neg_hi:[0,1]
v_pk_add_f32 v[34:35], v[114:115], v[54:55] neg_lo:[0,1] neg_hi:[0,1]
v_pk_add_f32 v[112:113], v[112:113], v[52:53]
v_pk_add_f32 v[114:115], v[114:115], v[54:55]
v_pk_add_f32 v[52:53], v[44:45], v[56:57] neg_lo:[0,1] neg_hi:[0,1]
v_pk_add_f32 v[54:55], v[46:47], v[58:59] neg_lo:[0,1] neg_hi:[0,1]
v_pk_add_f32 v[44:45], v[44:45], v[56:57]
v_pk_add_f32 v[46:47], v[46:47], v[58:59]
v_pk_add_f32 v[56:57], v[40:41], v[68:69] neg_lo:[0,1] neg_hi:[0,1]
v_pk_add_f32 v[58:59], v[42:43], v[70:71] neg_lo:[0,1] neg_hi:[0,1]
v_pk_add_f32 v[40:41], v[40:41], v[68:69]
v_pk_add_f32 v[42:43], v[42:43], v[70:71]
v_pk_add_f32 v[68:69], v[60:61], v[48:49] neg_lo:[0,1] neg_hi:[0,1]
v_pk_add_f32 v[70:71], v[62:63], v[50:51] neg_lo:[0,1] neg_hi:[0,1]
v_pk_add_f32 v[60:61], v[60:61], v[48:49]
v_pk_add_f32 v[62:63], v[62:63], v[50:51]
v_pk_add_f32 v[48:49], v[144:145], v[84:85] neg_lo:[0,1] neg_hi:[0,1]
v_pk_add_f32 v[50:51], v[146:147], v[86:87] neg_lo:[0,1] neg_hi:[0,1]
v_pk_add_f32 v[144:145], v[144:145], v[84:85]
v_pk_add_f32 v[146:147], v[146:147], v[86:87]
v_pk_add_f32 v[84:85], v[76:77], v[88:89] neg_lo:[0,1] neg_hi:[0,1]
v_pk_add_f32 v[86:87], v[78:79], v[90:91] neg_lo:[0,1] neg_hi:[0,1]
v_pk_add_f32 v[76:77], v[76:77], v[88:89]
v_pk_add_f32 v[78:79], v[78:79], v[90:91]
v_pk_add_f32 v[88:89], v[72:73], v[100:101] neg_lo:[0,1] neg_hi:[0,1]
v_pk_add_f32 v[90:91], v[74:75], v[102:103] neg_lo:[0,1] neg_hi:[0,1]
v_pk_add_f32 v[72:73], v[72:73], v[100:101]
v_pk_add_f32 v[74:75], v[74:75], v[102:103]
v_pk_add_f32 v[100:101], v[92:93], v[96:97] neg_lo:[0,1] neg_hi:[0,1]
v_pk_add_f32 v[102:103], v[94:95], v[98:99] neg_lo:[0,1] neg_hi:[0,1]
v_pk_add_f32 v[92:93], v[92:93], v[96:97]
v_pk_add_f32 v[94:95], v[94:95], v[98:99]
v_pk_add_f32 v[96:97], v[64:65], v[116:117] neg_lo:[0,1] neg_hi:[0,1]
v_pk_add_f32 v[98:99], v[66:67], v[118:119] neg_lo:[0,1] neg_hi:[0,1]
v_pk_add_f32 v[64:65], v[64:65], v[116:117]
v_pk_add_f32 v[66:67], v[66:67], v[118:119]
v_pk_add_f32 v[116:117], v[108:109], v[120:121] neg_lo:[0,1] neg_hi:[0,1]
v_pk_add_f32 v[118:119], v[110:111], v[122:123] neg_lo:[0,1] neg_hi:[0,1]
v_pk_add_f32 v[108:109], v[108:109], v[120:121]
v_pk_add_f32 v[110:111], v[110:111], v[122:123]
v_pk_add_f32 v[120:121], v[104:105], v[132:133] neg_lo:[0,1] neg_hi:[0,1]
v_pk_add_f32 v[122:123], v[106:107], v[134:135] neg_lo:[0,1] neg_hi:[0,1]
v_pk_add_f32 v[104:105], v[104:105], v[132:133]
v_pk_add_f32 v[106:107], v[106:107], v[134:135]
v_pk_add_f32 v[132:133], v[124:125], v[80:81] neg_lo:[0,1] neg_hi:[0,1]
v_pk_add_f32 v[134:135], v[126:127], v[82:83] neg_lo:[0,1] neg_hi:[0,1]
v_pk_add_f32 v[124:125], v[124:125], v[80:81]
v_pk_add_f32 v[126:127], v[126:127], v[82:83]
v_mul_f32 v151, 0xbc800000, v9
v_cos_f32 v150, v151
v_sin_f32 v151, v151
v_mul_f32 v149, 0xbd000000, v9
v_cos_f32 v148, v149
v_sin_f32 v149, v149
v_pk_mul_f32 v[80:81], v[144:145], v[150:151] op_sel_hi:[1,0]
v_pk_fma_f32 v[80:81], v[146:147], v[150:151], v[80:81] op_sel:[0,1,0] neg_lo:[1,0,0] neg_hi:[1,0,0]
v_pk_mul_f32 v[146:147], v[146:147], v[150:151] op_sel_hi:[1,0]
v_pk_fma_f32 v[146:147], v[144:145], v[150:151], v[146:147] op_sel:[0,1,0]
v_mul_f32 v151, 0xbd400000, v9
v_cos_f32 v150, v151
v_sin_f32 v151, v151
v_pk_mul_f32 v[144:145], v[112:113], v[148:149] op_sel_hi:[1,0]
v_pk_fma_f32 v[144:145], v[114:115], v[148:149], v[144:145] op_sel:[0,1,0] neg_lo:[1,0,0] neg_hi:[1,0,0]
v_pk_mul_f32 v[114:115], v[114:115], v[148:149] op_sel_hi:[1,0]
v_pk_fma_f32 v[114:115], v[112:113], v[148:149], v[114:115] op_sel:[0,1,0]
v_mul_f32 v149, 0xbd800000, v9
v_cos_f32 v148, v149
v_sin_f32 v149, v149
v_pk_mul_f32 v[112:113], v[64:65], v[150:151] op_sel_hi:[1,0]
v_pk_fma_f32 v[112:113], v[66:67], v[150:151], v[112:113] op_sel:[0,1,0] neg_lo:[1,0,0] neg_hi:[1,0,0]
v_pk_mul_f32 v[66:67], v[66:67], v[150:151] op_sel_hi:[1,0]
v_pk_fma_f32 v[66:67], v[64:65], v[150:151], v[66:67] op_sel:[0,1,0]
v_mul_f32 v151, 0xbda00000, v9
v_cos_f32 v150, v151
v_sin_f32 v151, v151
v_pk_mul_f32 v[64:65], v[128:129], v[148:149] op_sel_hi:[1,0]
v_pk_fma_f32 v[64:65], v[130:131], v[148:149], v[64:65] op_sel:[0,1,0] neg_lo:[1,0,0] neg_hi:[1,0,0]
v_pk_mul_f32 v[130:131], v[130:131], v[148:149] op_sel_hi:[1,0]
v_pk_fma_f32 v[130:131], v[128:129], v[148:149], v[130:131] op_sel:[0,1,0]
v_mul_f32 v149, 0xbdc00000, v9
v_cos_f32 v148, v149
v_sin_f32 v149, v149
v_pk_mul_f32 v[128:129], v[72:73], v[150:151] op_sel_hi:[1,0]
v_pk_fma_f32 v[128:129], v[74:75], v[150:151], v[128:129] op_sel:[0,1,0] neg_lo:[1,0,0] neg_hi:[1,0,0]
v_pk_mul_f32 v[74:75], v[74:75], v[150:151] op_sel_hi:[1,0]
v_pk_fma_f32 v[74:75], v[72:73], v[150:151], v[74:75] op_sel:[0,1,0]
v_mul_f32 v151, 0xbde00000, v9
v_cos_f32 v150, v151
v_sin_f32 v151, v151
v_pk_mul_f32 v[72:73], v[40:41], v[148:149] op_sel_hi:[1,0]
v_pk_fma_f32 v[72:73], v[42:43], v[148:149], v[72:73] op_sel:[0,1,0] neg_lo:[1,0,0] neg_hi:[1,0,0]
v_pk_mul_f32 v[42:43], v[42:43], v[148:149] op_sel_hi:[1,0]
v_pk_fma_f32 v[42:43], v[40:41], v[148:149], v[42:43] op_sel:[0,1,0]
v_mul_f32 v149, 0xbe000000, v9
v_cos_f32 v148, v149
v_sin_f32 v149, v149
v_pk_mul_f32 v[40:41], v[104:105], v[150:151] op_sel_hi:[1,0]
v_pk_fma_f32 v[40:41], v[106:107], v[150:151], v[40:41] op_sel:[0,1,0] neg_lo:[1,0,0] neg_hi:[1,0,0]
v_pk_mul_f32 v[106:107], v[106:107], v[150:151] op_sel_hi:[1,0]
v_pk_fma_f32 v[106:107], v[104:105], v[150:151], v[106:107] op_sel:[0,1,0]
v_mul_f32 v151, 0xbe100000, v9
v_cos_f32 v150, v151
v_sin_f32 v151, v151
v_pk_mul_f32 v[104:105], v[136:137], v[148:149] op_sel_hi:[1,0]
v_pk_fma_f32 v[104:105], v[138:139], v[148:149], v[104:105] op_sel:[0,1,0] neg_lo:[1,0,0] neg_hi:[1,0,0]
v_pk_mul_f32 v[138:139], v[138:139], v[148:149] op_sel_hi:[1,0]
v_pk_fma_f32 v[138:139], v[136:137], v[148:149], v[138:139] op_sel:[0,1,0]
v_mul_f32 v149, 0xbe200000, v9
v_cos_f32 v148, v149
v_sin_f32 v149, v149
v_pk_mul_f32 v[136:137], v[76:77], v[150:151] op_sel_hi:[1,0]
v_pk_fma_f32 v[136:137], v[78:79], v[150:151], v[136:137] op_sel:[0,1,0] neg_lo:[1,0,0] neg_hi:[1,0,0]
v_pk_mul_f32 v[78:79], v[78:79], v[150:151] op_sel_hi:[1,0]
v_pk_fma_f32 v[78:79], v[76:77], v[150:151], v[78:79] op_sel:[0,1,0]
v_mul_f32 v151, 0xbe300000, v9
v_cos_f32 v150, v151
v_sin_f32 v151, v151
v_pk_mul_f32 v[76:77], v[44:45], v[148:149] op_sel_hi:[1,0]
v_pk_fma_f32 v[76:77], v[46:47], v[148:149], v[76:77] op_sel:[0,1,0] neg_lo:[1,0,0] neg_hi:[1,0,0]
v_pk_mul_f32 v[46:47], v[46:47], v[148:149] op_sel_hi:[1,0]
v_pk_fma_f32 v[46:47], v[44:45], v[148:149], v[46:47] op_sel:[0,1,0]
v_mul_f32 v149, 0xbe400000, v9
v_cos_f32 v148, v149
v_sin_f32 v149, v149
v_pk_mul_f32 v[44:45], v[108:109], v[150:151] op_sel_hi:[1,0]
v_pk_fma_f32 v[44:45], v[110:111], v[150:151], v[44:45] op_sel:[0,1,0] neg_lo:[1,0,0] neg_hi:[1,0,0]
v_pk_mul_f32 v[110:111], v[110:111], v[150:151] op_sel_hi:[1,0]
v_pk_fma_f32 v[110:111], v[108:109], v[150:151], v[110:111] op_sel:[0,1,0]
v_mul_f32 v151, 0xbe500000, v9
v_cos_f32 v150, v151
v_sin_f32 v151, v151
v_pk_mul_f32 v[108:109], v[28:29], v[148:149] op_sel_hi:[1,0]
v_pk_fma_f32 v[108:109], v[30:31], v[148:149], v[108:109] op_sel:[0,1,0] neg_lo:[1,0,0] neg_hi:[1,0,0]
v_pk_mul_f32 v[30:31], v[30:31], v[148:149] op_sel_hi:[1,0]
v_pk_fma_f32 v[30:31], v[28:29], v[148:149], v[30:31] op_sel:[0,1,0]
v_mul_f32 v149, 0xbe600000, v9
v_cos_f32 v148, v149
v_sin_f32 v149, v149
v_pk_mul_f32 v[28:29], v[92:93], v[150:151] op_sel_hi:[1,0]
v_pk_fma_f32 v[28:29], v[94:95], v[150:151], v[28:29] op_sel:[0,1,0] neg_lo:[1,0,0] neg_hi:[1,0,0]
v_pk_mul_f32 v[94:95], v[94:95], v[150:151] op_sel_hi:[1,0]
v_pk_fma_f32 v[94:95], v[92:93], v[150:151], v[94:95] op_sel:[0,1,0]
v_mul_f32 v151, 0xbe700000, v9
v_cos_f32 v150, v151
v_sin_f32 v151, v151
v_pk_mul_f32 v[92:93], v[60:61], v[148:149] op_sel_hi:[1,0]
v_pk_fma_f32 v[92:93], v[62:63], v[148:149], v[92:93] op_sel:[0,1,0] neg_lo:[1,0,0] neg_hi:[1,0,0]
v_pk_mul_f32 v[62:63], v[62:63], v[148:149] op_sel_hi:[1,0]
v_pk_fma_f32 v[62:63], v[60:61], v[148:149], v[62:63] op_sel:[0,1,0]
v_mul_f32 v149, 0xbe800000, v9
v_cos_f32 v148, v149
v_sin_f32 v149, v149
v_pk_mul_f32 v[60:61], v[124:125], v[150:151] op_sel_hi:[1,0]
v_pk_fma_f32 v[60:61], v[126:127], v[150:151], v[60:61] op_sel:[0,1,0] neg_lo:[1,0,0] neg_hi:[1,0,0]
v_pk_mul_f32 v[126:127], v[126:127], v[150:151] op_sel_hi:[1,0]
v_pk_fma_f32 v[126:127], v[124:125], v[150:151], v[126:127] op_sel:[0,1,0]
v_mul_f32 v151, 0xbe880000, v9
v_cos_f32 v150, v151
v_sin_f32 v151, v151
v_pk_mul_f32 v[124:125], v[140:141], v[148:149] op_sel_hi:[1,0]
v_pk_fma_f32 v[124:125], v[142:143], v[148:149], v[124:125] op_sel:[0,1,0] neg_lo:[1,0,0] neg_hi:[1,0,0]
v_pk_mul_f32 v[142:143], v[142:143], v[148:149] op_sel_hi:[1,0]
v_pk_fma_f32 v[142:143], v[140:141], v[148:149], v[142:143] op_sel:[0,1,0]
v_mul_f32 v149, 0xbe900000, v9
v_cos_f32 v148, v149
v_sin_f32 v149, v149
v_pk_mul_f32 v[140:141], v[48:49], v[150:151] op_sel_hi:[1,0]
v_pk_fma_f32 v[140:141], v[50:51], v[150:151], v[140:141] op_sel:[0,1,0] neg_lo:[1,0,0] neg_hi:[1,0,0]
v_pk_mul_f32 v[50:51], v[50:51], v[150:151] op_sel_hi:[1,0]
v_pk_fma_f32 v[50:51], v[48:49], v[150:151], v[50:51] op_sel:[0,1,0]
v_mul_f32 v151, 0xbe980000, v9
v_cos_f32 v150, v151
v_sin_f32 v151, v151
v_pk_mul_f32 v[48:49], v[32:33], v[148:149] op_sel_hi:[1,0]
v_pk_fma_f32 v[48:49], v[34:35], v[148:149], v[48:49] op_sel:[0,1,0] neg_lo:[1,0,0] neg_hi:[1,0,0]
v_pk_mul_f32 v[34:35], v[34:35], v[148:149] op_sel_hi:[1,0]
v_pk_fma_f32 v[34:35], v[32:33], v[148:149], v[34:35] op_sel:[0,1,0]
v_mul_f32 v149, 0xbea00000, v9
v_cos_f32 v148, v149
v_sin_f32 v149, v149
v_pk_mul_f32 v[32:33], v[96:97], v[150:151] op_sel_hi:[1,0]
v_pk_fma_f32 v[32:33], v[98:99], v[150:151], v[32:33] op_sel:[0,1,0] neg_lo:[1,0,0] neg_hi:[1,0,0]
v_pk_mul_f32 v[98:99], v[98:99], v[150:151] op_sel_hi:[1,0]
v_pk_fma_f32 v[98:99], v[96:97], v[150:151], v[98:99] op_sel:[0,1,0]
v_mul_f32 v151, 0xbea80000, v9
v_cos_f32 v150, v151
v_sin_f32 v151, v151
v_pk_mul_f32 v[96:97], v[24:25], v[148:149] op_sel_hi:[1,0]
v_pk_fma_f32 v[96:97], v[26:27], v[148:149], v[96:97] op_sel:[0,1,0] neg_lo:[1,0,0] neg_hi:[1,0,0]
v_pk_mul_f32 v[26:27], v[26:27], v[148:149] op_sel_hi:[1,0]
v_pk_fma_f32 v[26:27], v[24:25], v[148:149], v[26:27] op_sel:[0,1,0]
v_mul_f32 v149, 0xbeb00000, v9
v_cos_f32 v148, v149
v_sin_f32 v149, v149
v_pk_mul_f32 v[24:25], v[88:89], v[150:151] op_sel_hi:[1,0]
v_pk_fma_f32 v[24:25], v[90:91], v[150:151], v[24:25] op_sel:[0,1,0] neg_lo:[1,0,0] neg_hi:[1,0,0]
v_pk_mul_f32 v[90:91], v[90:91], v[150:151] op_sel_hi:[1,0]
v_pk_fma_f32 v[90:91], v[88:89], v[150:151], v[90:91] op_sel:[0,1,0]
v_mul_f32 v151, 0xbeb80000, v9
v_cos_f32 v150, v151
v_sin_f32 v151, v151
v_pk_mul_f32 v[88:89], v[56:57], v[148:149] op_sel_hi:[1,0]
v_pk_fma_f32 v[88:89], v[58:59], v[148:149], v[88:89] op_sel:[0,1,0] neg_lo:[1,0,0] neg_hi:[1,0,0]
v_pk_mul_f32 v[58:59], v[58:59], v[148:149] op_sel_hi:[1,0]
v_pk_fma_f32 v[58:59], v[56:57], v[148:149], v[58:59] op_sel:[0,1,0]
v_mul_f32 v149, 0xbec00000, v9
v_cos_f32 v148, v149
v_sin_f32 v149, v149
v_pk_mul_f32 v[56:57], v[120:121], v[150:151] op_sel_hi:[1,0]
v_pk_fma_f32 v[56:57], v[122:123], v[150:151], v[56:57] op_sel:[0,1,0] neg_lo:[1,0,0] neg_hi:[1,0,0]
v_pk_mul_f32 v[122:123], v[122:123], v[150:151] op_sel_hi:[1,0]
v_pk_fma_f32 v[122:123], v[120:121], v[150:151], v[122:123] op_sel:[0,1,0]
v_mul_f32 v151, 0xbec80000, v9
v_cos_f32 v150, v151
v_sin_f32 v151, v151
v_pk_mul_f32 v[120:121], v[20:21], v[148:149] op_sel_hi:[1,0]
v_pk_fma_f32 v[120:121], v[22:23], v[148:149], v[120:121] op_sel:[0,1,0] neg_lo:[1,0,0] neg_hi:[1,0,0]
v_pk_mul_f32 v[22:23], v[22:23], v[148:149] op_sel_hi:[1,0]
v_pk_fma_f32 v[22:23], v[20:21], v[148:149], v[22:23] op_sel:[0,1,0]
v_mul_f32 v149, 0xbed00000, v9
v_cos_f32 v148, v149
v_sin_f32 v149, v149
v_pk_mul_f32 v[20:21], v[84:85], v[150:151] op_sel_hi:[1,0]
v_pk_fma_f32 v[20:21], v[86:87], v[150:151], v[20:21] op_sel:[0,1,0] neg_lo:[1,0,0] neg_hi:[1,0,0]
v_pk_mul_f32 v[86:87], v[86:87], v[150:151] op_sel_hi:[1,0]
v_pk_fma_f32 v[86:87], v[84:85], v[150:151], v[86:87] op_sel:[0,1,0]
v_mul_f32 v151, 0xbed80000, v9
v_cos_f32 v150, v151
v_sin_f32 v151, v151
v_pk_mul_f32 v[84:85], v[52:53], v[148:149] op_sel_hi:[1,0]
v_pk_fma_f32 v[84:85], v[54:55], v[148:149], v[84:85] op_sel:[0,1,0] neg_lo:[1,0,0] neg_hi:[1,0,0]
v_pk_mul_f32 v[54:55], v[54:55], v[148:149] op_sel_hi:[1,0]
v_pk_fma_f32 v[54:55], v[52:53], v[148:149], v[54:55] op_sel:[0,1,0]
v_mul_f32 v149, 0xbee00000, v9
v_cos_f32 v148, v149
v_sin_f32 v149, v149
v_pk_mul_f32 v[52:53], v[116:117], v[150:151] op_sel_hi:[1,0]
v_pk_fma_f32 v[52:53], v[118:119], v[150:151], v[52:53] op_sel:[0,1,0] neg_lo:[1,0,0] neg_hi:[1,0,0]
v_pk_mul_f32 v[118:119], v[118:119], v[150:151] op_sel_hi:[1,0]
v_pk_fma_f32 v[118:119], v[116:117], v[150:151], v[118:119] op_sel:[0,1,0]
v_mul_f32 v151, 0xbee80000, v9
v_cos_f32 v150, v151
v_sin_f32 v151, v151
v_pk_mul_f32 v[116:117], v[36:37], v[148:149] op_sel_hi:[1,0]
v_pk_fma_f32 v[116:117], v[38:39], v[148:149], v[116:117] op_sel:[0,1,0] neg_lo:[1,0,0] neg_hi:[1,0,0]
v_pk_mul_f32 v[38:39], v[38:39], v[148:149] op_sel_hi:[1,0]
v_pk_fma_f32 v[38:39], v[36:37], v[148:149], v[38:39] op_sel:[0,1,0]
v_mul_f32 v149, 0xbef00000, v9
v_cos_f32 v148, v149
v_sin_f32 v149, v149
v_pk_mul_f32 v[36:37], v[100:101], v[150:151] op_sel_hi:[1,0]
v_pk_fma_f32 v[36:37], v[102:103], v[150:151], v[36:37] op_sel:[0,1,0] neg_lo:[1,0,0] neg_hi:[1,0,0]
v_pk_mul_f32 v[102:103], v[102:103], v[150:151] op_sel_hi:[1,0]
v_pk_fma_f32 v[102:103], v[100:101], v[150:151], v[102:103] op_sel:[0,1,0]
v_mul_f32 v151, 0xbef80000, v9
v_cos_f32 v150, v151
v_sin_f32 v151, v151
v_pk_mul_f32 v[100:101], v[68:69], v[148:149] op_sel_hi:[1,0]
v_pk_fma_f32 v[100:101], v[70:71], v[148:149], v[100:101] op_sel:[0,1,0] neg_lo:[1,0,0] neg_hi:[1,0,0]
v_pk_mul_f32 v[70:71], v[70:71], v[148:149] op_sel_hi:[1,0]
v_pk_fma_f32 v[70:71], v[68:69], v[148:149], v[70:71] op_sel:[0,1,0]
s_nop 0
v_pk_mul_f32 v[68:69], v[132:133], v[150:151] op_sel_hi:[1,0]
v_pk_fma_f32 v[68:69], v[134:135], v[150:151], v[68:69] op_sel:[0,1,0] neg_lo:[1,0,0] neg_hi:[1,0,0]
v_pk_mul_f32 v[134:135], v[134:135], v[150:151] op_sel_hi:[1,0]
v_pk_fma_f32 v[134:135], v[132:133], v[150:151], v[134:135] op_sel:[0,1,0]
s_nop 1
v_mov_b32_dpp v132, v16 quad_perm:[1,0,3,2] row_mask:0xf bank_mask:0xf
v_mov_b32_dpp v133, v17 quad_perm:[1,0,3,2] row_mask:0xf bank_mask:0xf
v_pk_fma_f32 v[16:17], v[16:17], v[14:15], v[132:133] op_sel_hi:[1,0,1]
v_mov_b32_dpp v82, v18 quad_perm:[1,0,3,2] row_mask:0xf bank_mask:0xf
v_mov_b32_dpp v83, v19 quad_perm:[1,0,3,2] row_mask:0xf bank_mask:0xf
v_pk_fma_f32 v[18:19], v[18:19], v[14:15], v[82:83] op_sel_hi:[1,0,1]
v_mov_b32_dpp v132, v80 quad_perm:[1,0,3,2] row_mask:0xf bank_mask:0xf
v_mov_b32_dpp v133, v81 quad_perm:[1,0,3,2] row_mask:0xf bank_mask:0xf
v_pk_fma_f32 v[80:81], v[80:81], v[14:15], v[132:133] op_sel_hi:[1,0,1]
v_mov_b32_dpp v82, v146 quad_perm:[1,0,3,2] row_mask:0xf bank_mask:0xf
v_mov_b32_dpp v83, v147 quad_perm:[1,0,3,2] row_mask:0xf bank_mask:0xf
v_pk_fma_f32 v[146:147], v[146:147], v[14:15], v[82:83] op_sel_hi:[1,0,1]
v_mov_b32_dpp v132, v144 quad_perm:[1,0,3,2] row_mask:0xf bank_mask:0xf
v_mov_b32_dpp v133, v145 quad_perm:[1,0,3,2] row_mask:0xf bank_mask:0xf
v_pk_fma_f32 v[144:145], v[144:145], v[14:15], v[132:133] op_sel_hi:[1,0,1]
v_mov_b32_dpp v82, v114 quad_perm:[1,0,3,2] row_mask:0xf bank_mask:0xf
v_mov_b32_dpp v83, v115 quad_perm:[1,0,3,2] row_mask:0xf bank_mask:0xf
v_pk_fma_f32 v[114:115], v[114:115], v[14:15], v[82:83] op_sel_hi:[1,0,1]
v_mov_b32_dpp v132, v112 quad_perm:[1,0,3,2] row_mask:0xf bank_mask:0xf
v_mov_b32_dpp v133, v113 quad_perm:[1,0,3,2] row_mask:0xf bank_mask:0xf
v_pk_fma_f32 v[112:113], v[112:113], v[14:15], v[132:133] op_sel_hi:[1,0,1]
v_mov_b32_dpp v82, v66 quad_perm:[1,0,3,2] row_mask:0xf bank_mask:0xf
v_mov_b32_dpp v83, v67 quad_perm:[1,0,3,2] row_mask:0xf bank_mask:0xf
v_pk_fma_f32 v[66:67], v[66:67], v[14:15], v[82:83] op_sel_hi:[1,0,1]
v_mov_b32_dpp v132, v64 quad_perm:[1,0,3,2] row_mask:0xf bank_mask:0xf
v_mov_b32_dpp v133, v65 quad_perm:[1,0,3,2] row_mask:0xf bank_mask:0xf
v_pk_fma_f32 v[64:65], v[64:65], v[14:15], v[132:133] op_sel_hi:[1,0,1]
v_mov_b32_dpp v82, v130 quad_perm:[1,0,3,2] row_mask:0xf bank_mask:0xf
v_mov_b32_dpp v83, v131 quad_perm:[1,0,3,2] row_mask:0xf bank_mask:0xf
v_pk_fma_f32 v[130:131], v[130:131], v[14:15], v[82:83] op_sel_hi:[1,0,1]
v_mov_b32_dpp v132, v128 quad_perm:[1,0,3,2] row_mask:0xf bank_mask:0xf
v_mov_b32_dpp v133, v129 quad_perm:[1,0,3,2] row_mask:0xf bank_mask:0xf
v_pk_fma_f32 v[128:129], v[128:129], v[14:15], v[132:133] op_sel_hi:[1,0,1]
v_mov_b32_dpp v82, v74 quad_perm:[1,0,3,2] row_mask:0xf bank_mask:0xf
v_mov_b32_dpp v83, v75 quad_perm:[1,0,3,2] row_mask:0xf bank_mask:0xf
v_pk_fma_f32 v[74:75], v[74:75], v[14:15], v[82:83] op_sel_hi:[1,0,1]
v_mov_b32_dpp v132, v72 quad_perm:[1,0,3,2] row_mask:0xf bank_mask:0xf
v_mov_b32_dpp v133, v73 quad_perm:[1,0,3,2] row_mask:0xf bank_mask:0xf
v_pk_fma_f32 v[72:73], v[72:73], v[14:15], v[132:133] op_sel_hi:[1,0,1]
v_mov_b32_dpp v82, v42 quad_perm:[1,0,3,2] row_mask:0xf bank_mask:0xf
v_mov_b32_dpp v83, v43 quad_perm:[1,0,3,2] row_mask:0xf bank_mask:0xf
v_pk_fma_f32 v[42:43], v[42:43], v[14:15], v[82:83] op_sel_hi:[1,0,1]
v_mov_b32_dpp v132, v40 quad_perm:[1,0,3,2] row_mask:0xf bank_mask:0xf
v_mov_b32_dpp v133, v41 quad_perm:[1,0,3,2] row_mask:0xf bank_mask:0xf
v_pk_fma_f32 v[40:41], v[40:41], v[14:15], v[132:133] op_sel_hi:[1,0,1]
v_mov_b32_dpp v82, v106 quad_perm:[1,0,3,2] row_mask:0xf bank_mask:0xf
v_mov_b32_dpp v83, v107 quad_perm:[1,0,3,2] row_mask:0xf bank_mask:0xf
v_pk_fma_f32 v[106:107], v[106:107], v[14:15], v[82:83] op_sel_hi:[1,0,1]
v_mov_b32_dpp v132, v104 quad_perm:[1,0,3,2] row_mask:0xf bank_mask:0xf
v_mov_b32_dpp v133, v105 quad_perm:[1,0,3,2] row_mask:0xf bank_mask:0xf
v_pk_fma_f32 v[104:105], v[104:105], v[14:15], v[132:133] op_sel_hi:[1,0,1]
v_mov_b32_dpp v82, v138 quad_perm:[1,0,3,2] row_mask:0xf bank_mask:0xf
v_mov_b32_dpp v83, v139 quad_perm:[1,0,3,2] row_mask:0xf bank_mask:0xf
v_pk_fma_f32 v[138:139], v[138:139], v[14:15], v[82:83] op_sel_hi:[1,0,1]
v_mov_b32_dpp v132, v136 quad_perm:[1,0,3,2] row_mask:0xf bank_mask:0xf
v_mov_b32_dpp v133, v137 quad_perm:[1,0,3,2] row_mask:0xf bank_mask:0xf
v_pk_fma_f32 v[136:137], v[136:137], v[14:15], v[132:133] op_sel_hi:[1,0,1]
v_mov_b32_dpp v82, v78 quad_perm:[1,0,3,2] row_mask:0xf bank_mask:0xf
v_mov_b32_dpp v83, v79 quad_perm:[1,0,3,2] row_mask:0xf bank_mask:0xf
v_pk_fma_f32 v[78:79], v[78:79], v[14:15], v[82:83] op_sel_hi:[1,0,1]
v_mov_b32_dpp v132, v76 quad_perm:[1,0,3,2] row_mask:0xf bank_mask:0xf
v_mov_b32_dpp v133, v77 quad_perm:[1,0,3,2] row_mask:0xf bank_mask:0xf
v_pk_fma_f32 v[76:77], v[76:77], v[14:15], v[132:133] op_sel_hi:[1,0,1]
v_mov_b32_dpp v82, v46 quad_perm:[1,0,3,2] row_mask:0xf bank_mask:0xf
v_mov_b32_dpp v83, v47 quad_perm:[1,0,3,2] row_mask:0xf bank_mask:0xf
v_pk_fma_f32 v[46:47], v[46:47], v[14:15], v[82:83] op_sel_hi:[1,0,1]
v_mov_b32_dpp v132, v44 quad_perm:[1,0,3,2] row_mask:0xf bank_mask:0xf
v_mov_b32_dpp v133, v45 quad_perm:[1,0,3,2] row_mask:0xf bank_mask:0xf
v_pk_fma_f32 v[44:45], v[44:45], v[14:15], v[132:133] op_sel_hi:[1,0,1]
v_mov_b32_dpp v82, v110 quad_perm:[1,0,3,2] row_mask:0xf bank_mask:0xf
v_mov_b32_dpp v83, v111 quad_perm:[1,0,3,2] row_mask:0xf bank_mask:0xf
v_pk_fma_f32 v[110:111], v[110:111], v[14:15], v[82:83] op_sel_hi:[1,0,1]
v_mov_b32_dpp v132, v108 quad_perm:[1,0,3,2] row_mask:0xf bank_mask:0xf
v_mov_b32_dpp v133, v109 quad_perm:[1,0,3,2] row_mask:0xf bank_mask:0xf
v_pk_fma_f32 v[108:109], v[108:109], v[14:15], v[132:133] op_sel_hi:[1,0,1]
v_mov_b32_dpp v82, v30 quad_perm:[1,0,3,2] row_mask:0xf bank_mask:0xf
v_mov_b32_dpp v83, v31 quad_perm:[1,0,3,2] row_mask:0xf bank_mask:0xf
v_pk_fma_f32 v[30:31], v[30:31], v[14:15], v[82:83] op_sel_hi:[1,0,1]
v_mov_b32_dpp v132, v28 quad_perm:[1,0,3,2] row_mask:0xf bank_mask:0xf
v_mov_b32_dpp v133, v29 quad_perm:[1,0,3,2] row_mask:0xf bank_mask:0xf
v_pk_fma_f32 v[28:29], v[28:29], v[14:15], v[132:133] op_sel_hi:[1,0,1]
v_mov_b32_dpp v82, v94 quad_perm:[1,0,3,2] row_mask:0xf bank_mask:0xf
v_mov_b32_dpp v83, v95 quad_perm:[1,0,3,2] row_mask:0xf bank_mask:0xf
v_pk_fma_f32 v[94:95], v[94:95], v[14:15], v[82:83] op_sel_hi:[1,0,1]
v_mov_b32_dpp v132, v92 quad_perm:[1,0,3,2] row_mask:0xf bank_mask:0xf
v_mov_b32_dpp v133, v93 quad_perm:[1,0,3,2] row_mask:0xf bank_mask:0xf
v_pk_fma_f32 v[92:93], v[92:93], v[14:15], v[132:133] op_sel_hi:[1,0,1]
v_mov_b32_dpp v82, v62 quad_perm:[1,0,3,2] row_mask:0xf bank_mask:0xf
v_mov_b32_dpp v83, v63 quad_perm:[1,0,3,2] row_mask:0xf bank_mask:0xf
v_pk_fma_f32 v[62:63], v[62:63], v[14:15], v[82:83] op_sel_hi:[1,0,1]
v_mov_b32_dpp v132, v60 quad_perm:[1,0,3,2] row_mask:0xf bank_mask:0xf
v_mov_b32_dpp v133, v61 quad_perm:[1,0,3,2] row_mask:0xf bank_mask:0xf
v_pk_fma_f32 v[60:61], v[60:61], v[14:15], v[132:133] op_sel_hi:[1,0,1]
v_mov_b32_dpp v82, v126 quad_perm:[1,0,3,2] row_mask:0xf bank_mask:0xf
v_mov_b32_dpp v83, v127 quad_perm:[1,0,3,2] row_mask:0xf bank_mask:0xf
v_pk_fma_f32 v[126:127], v[126:127], v[14:15], v[82:83] op_sel_hi:[1,0,1]
v_mov_b32_dpp v132, v124 quad_perm:[1,0,3,2] row_mask:0xf bank_mask:0xf
v_mov_b32_dpp v133, v125 quad_perm:[1,0,3,2] row_mask:0xf bank_mask:0xf
v_pk_fma_f32 v[124:125], v[124:125], v[14:15], v[132:133] op_sel_hi:[1,0,1]
v_mov_b32_dpp v82, v142 quad_perm:[1,0,3,2] row_mask:0xf bank_mask:0xf
v_mov_b32_dpp v83, v143 quad_perm:[1,0,3,2] row_mask:0xf bank_mask:0xf
v_pk_fma_f32 v[142:143], v[142:143], v[14:15], v[82:83] op_sel_hi:[1,0,1]
v_mov_b32_dpp v132, v140 quad_perm:[1,0,3,2] row_mask:0xf bank_mask:0xf
v_mov_b32_dpp v133, v141 quad_perm:[1,0,3,2] row_mask:0xf bank_mask:0xf
v_pk_fma_f32 v[140:141], v[140:141], v[14:15], v[132:133] op_sel_hi:[1,0,1]
v_mov_b32_dpp v82, v50 quad_perm:[1,0,3,2] row_mask:0xf bank_mask:0xf
v_mov_b32_dpp v83, v51 quad_perm:[1,0,3,2] row_mask:0xf bank_mask:0xf
v_pk_fma_f32 v[50:51], v[50:51], v[14:15], v[82:83] op_sel_hi:[1,0,1]
v_mov_b32_dpp v132, v48 quad_perm:[1,0,3,2] row_mask:0xf bank_mask:0xf
v_mov_b32_dpp v133, v49 quad_perm:[1,0,3,2] row_mask:0xf bank_mask:0xf
v_pk_fma_f32 v[48:49], v[48:49], v[14:15], v[132:133] op_sel_hi:[1,0,1]
v_mov_b32_dpp v82, v34 quad_perm:[1,0,3,2] row_mask:0xf bank_mask:0xf
v_mov_b32_dpp v83, v35 quad_perm:[1,0,3,2] row_mask:0xf bank_mask:0xf
v_pk_fma_f32 v[34:35], v[34:35], v[14:15], v[82:83] op_sel_hi:[1,0,1]
v_mov_b32_dpp v132, v32 quad_perm:[1,0,3,2] row_mask:0xf bank_mask:0xf
v_mov_b32_dpp v133, v33 quad_perm:[1,0,3,2] row_mask:0xf bank_mask:0xf
v_pk_fma_f32 v[32:33], v[32:33], v[14:15], v[132:133] op_sel_hi:[1,0,1]
v_mov_b32_dpp v82, v98 quad_perm:[1,0,3,2] row_mask:0xf bank_mask:0xf
v_mov_b32_dpp v83, v99 quad_perm:[1,0,3,2] row_mask:0xf bank_mask:0xf
v_pk_fma_f32 v[98:99], v[98:99], v[14:15], v[82:83] op_sel_hi:[1,0,1]
v_mov_b32_dpp v132, v96 quad_perm:[1,0,3,2] row_mask:0xf bank_mask:0xf
v_mov_b32_dpp v133, v97 quad_perm:[1,0,3,2] row_mask:0xf bank_mask:0xf
v_pk_fma_f32 v[96:97], v[96:97], v[14:15], v[132:133] op_sel_hi:[1,0,1]
v_mov_b32_dpp v82, v26 quad_perm:[1,0,3,2] row_mask:0xf bank_mask:0xf
v_mov_b32_dpp v83, v27 quad_perm:[1,0,3,2] row_mask:0xf bank_mask:0xf
v_pk_fma_f32 v[26:27], v[26:27], v[14:15], v[82:83] op_sel_hi:[1,0,1]
v_mov_b32_dpp v132, v24 quad_perm:[1,0,3,2] row_mask:0xf bank_mask:0xf
v_mov_b32_dpp v133, v25 quad_perm:[1,0,3,2] row_mask:0xf bank_mask:0xf
v_pk_fma_f32 v[24:25], v[24:25], v[14:15], v[132:133] op_sel_hi:[1,0,1]
v_mov_b32_dpp v82, v90 quad_perm:[1,0,3,2] row_mask:0xf bank_mask:0xf
v_mov_b32_dpp v83, v91 quad_perm:[1,0,3,2] row_mask:0xf bank_mask:0xf
v_pk_fma_f32 v[90:91], v[90:91], v[14:15], v[82:83] op_sel_hi:[1,0,1]
v_mov_b32_dpp v132, v88 quad_perm:[1,0,3,2] row_mask:0xf bank_mask:0xf
v_mov_b32_dpp v133, v89 quad_perm:[1,0,3,2] row_mask:0xf bank_mask:0xf
v_pk_fma_f32 v[88:89], v[88:89], v[14:15], v[132:133] op_sel_hi:[1,0,1]
v_mov_b32_dpp v82, v58 quad_perm:[1,0,3,2] row_mask:0xf bank_mask:0xf
v_mov_b32_dpp v83, v59 quad_perm:[1,0,3,2] row_mask:0xf bank_mask:0xf
v_pk_fma_f32 v[58:59], v[58:59], v[14:15], v[82:83] op_sel_hi:[1,0,1]
v_mov_b32_dpp v132, v56 quad_perm:[1,0,3,2] row_mask:0xf bank_mask:0xf
v_mov_b32_dpp v133, v57 quad_perm:[1,0,3,2] row_mask:0xf bank_mask:0xf
v_pk_fma_f32 v[56:57], v[56:57], v[14:15], v[132:133] op_sel_hi:[1,0,1]
v_mov_b32_dpp v82, v122 quad_perm:[1,0,3,2] row_mask:0xf bank_mask:0xf
v_mov_b32_dpp v83, v123 quad_perm:[1,0,3,2] row_mask:0xf bank_mask:0xf
v_pk_fma_f32 v[122:123], v[122:123], v[14:15], v[82:83] op_sel_hi:[1,0,1]
v_mov_b32_dpp v132, v120 quad_perm:[1,0,3,2] row_mask:0xf bank_mask:0xf
v_mov_b32_dpp v133, v121 quad_perm:[1,0,3,2] row_mask:0xf bank_mask:0xf
v_pk_fma_f32 v[120:121], v[120:121], v[14:15], v[132:133] op_sel_hi:[1,0,1]
v_mov_b32_dpp v82, v22 quad_perm:[1,0,3,2] row_mask:0xf bank_mask:0xf
v_mov_b32_dpp v83, v23 quad_perm:[1,0,3,2] row_mask:0xf bank_mask:0xf
v_pk_fma_f32 v[22:23], v[22:23], v[14:15], v[82:83] op_sel_hi:[1,0,1]
v_mov_b32_dpp v132, v20 quad_perm:[1,0,3,2] row_mask:0xf bank_mask:0xf
v_mov_b32_dpp v133, v21 quad_perm:[1,0,3,2] row_mask:0xf bank_mask:0xf
v_pk_fma_f32 v[20:21], v[20:21], v[14:15], v[132:133] op_sel_hi:[1,0,1]
v_mov_b32_dpp v82, v86 quad_perm:[1,0,3,2] row_mask:0xf bank_mask:0xf
v_mov_b32_dpp v83, v87 quad_perm:[1,0,3,2] row_mask:0xf bank_mask:0xf
v_pk_fma_f32 v[86:87], v[86:87], v[14:15], v[82:83] op_sel_hi:[1,0,1]
v_mov_b32_dpp v132, v84 quad_perm:[1,0,3,2] row_mask:0xf bank_mask:0xf
v_mov_b32_dpp v133, v85 quad_perm:[1,0,3,2] row_mask:0xf bank_mask:0xf
v_pk_fma_f32 v[84:85], v[84:85], v[14:15], v[132:133] op_sel_hi:[1,0,1]
v_mov_b32_dpp v82, v54 quad_perm:[1,0,3,2] row_mask:0xf bank_mask:0xf
v_mov_b32_dpp v83, v55 quad_perm:[1,0,3,2] row_mask:0xf bank_mask:0xf
v_pk_fma_f32 v[54:55], v[54:55], v[14:15], v[82:83] op_sel_hi:[1,0,1]
v_mov_b32_dpp v132, v52 quad_perm:[1,0,3,2] row_mask:0xf bank_mask:0xf
v_mov_b32_dpp v133, v53 quad_perm:[1,0,3,2] row_mask:0xf bank_mask:0xf
v_pk_fma_f32 v[52:53], v[52:53], v[14:15], v[132:133] op_sel_hi:[1,0,1]
v_mov_b32_dpp v82, v118 quad_perm:[1,0,3,2] row_mask:0xf bank_mask:0xf
v_mov_b32_dpp v83, v119 quad_perm:[1,0,3,2] row_mask:0xf bank_mask:0xf
v_pk_fma_f32 v[118:119], v[118:119], v[14:15], v[82:83] op_sel_hi:[1,0,1]
v_mov_b32_dpp v132, v116 quad_perm:[1,0,3,2] row_mask:0xf bank_mask:0xf
v_mov_b32_dpp v133, v117 quad_perm:[1,0,3,2] row_mask:0xf bank_mask:0xf
v_pk_fma_f32 v[116:117], v[116:117], v[14:15], v[132:133] op_sel_hi:[1,0,1]
v_mov_b32_dpp v82, v38 quad_perm:[1,0,3,2] row_mask:0xf bank_mask:0xf
v_mov_b32_dpp v83, v39 quad_perm:[1,0,3,2] row_mask:0xf bank_mask:0xf
v_pk_fma_f32 v[38:39], v[38:39], v[14:15], v[82:83] op_sel_hi:[1,0,1]
v_mov_b32_dpp v132, v36 quad_perm:[1,0,3,2] row_mask:0xf bank_mask:0xf
v_mov_b32_dpp v133, v37 quad_perm:[1,0,3,2] row_mask:0xf bank_mask:0xf
v_pk_fma_f32 v[36:37], v[36:37], v[14:15], v[132:133] op_sel_hi:[1,0,1]
v_mov_b32_dpp v82, v102 quad_perm:[1,0,3,2] row_mask:0xf bank_mask:0xf
v_mov_b32_dpp v83, v103 quad_perm:[1,0,3,2] row_mask:0xf bank_mask:0xf
v_pk_fma_f32 v[102:103], v[102:103], v[14:15], v[82:83] op_sel_hi:[1,0,1]
v_mov_b32_dpp v132, v100 quad_perm:[1,0,3,2] row_mask:0xf bank_mask:0xf
v_mov_b32_dpp v133, v101 quad_perm:[1,0,3,2] row_mask:0xf bank_mask:0xf
v_pk_fma_f32 v[100:101], v[100:101], v[14:15], v[132:133] op_sel_hi:[1,0,1]
v_mov_b32_dpp v82, v70 quad_perm:[1,0,3,2] row_mask:0xf bank_mask:0xf
v_mov_b32_dpp v83, v71 quad_perm:[1,0,3,2] row_mask:0xf bank_mask:0xf
v_pk_fma_f32 v[70:71], v[70:71], v[14:15], v[82:83] op_sel_hi:[1,0,1]
v_mov_b32_dpp v132, v68 quad_perm:[1,0,3,2] row_mask:0xf bank_mask:0xf
v_mov_b32_dpp v133, v69 quad_perm:[1,0,3,2] row_mask:0xf bank_mask:0xf
v_pk_fma_f32 v[68:69], v[68:69], v[14:15], v[132:133] op_sel_hi:[1,0,1]
v_mov_b32_dpp v82, v134 quad_perm:[1,0,3,2] row_mask:0xf bank_mask:0xf
v_mov_b32_dpp v83, v135 quad_perm:[1,0,3,2] row_mask:0xf bank_mask:0xf
v_pk_fma_f32 v[134:135], v[134:135], v[14:15], v[82:83] op_sel_hi:[1,0,1]
v_lshlrev_b32 v82, 16, v160
v_and_b32 v83, 0xffff0000, v160
v_lshlrev_b32 v148, 16, v192
v_and_b32 v149, 0xffff0000, v192
v_pk_mul_f32 v[132:133], v[16:17], v[82:83]
v_pk_fma_f32 v[132:133], v[18:19], v[148:149], v[132:133] neg_lo:[1,0,0] neg_hi:[1,0,0]
v_pk_mul_f32 v[18:19], v[18:19], v[82:83]
v_pk_fma_f32 v[18:19], v[16:17], v[148:149], v[18:19]
v_lshlrev_b32 v82, 16, v161
v_and_b32 v83, 0xffff0000, v161
v_lshlrev_b32 v148, 16, v193
v_and_b32 v149, 0xffff0000, v193
v_pk_mul_f32 v[16:17], v[80:81], v[82:83]
v_pk_fma_f32 v[16:17], v[146:147], v[148:149], v[16:17] neg_lo:[1,0,0] neg_hi:[1,0,0]
v_pk_mul_f32 v[146:147], v[146:147], v[82:83]
v_pk_fma_f32 v[146:147], v[80:81], v[148:149], v[146:147]
v_lshlrev_b32 v82, 16, v162
v_and_b32 v83, 0xffff0000, v162
v_lshlrev_b32 v148, 16, v194
v_and_b32 v149, 0xffff0000, v194
v_pk_mul_f32 v[80:81], v[144:145], v[82:83]
v_pk_fma_f32 v[80:81], v[114:115], v[148:149], v[80:81] neg_lo:[1,0,0] neg_hi:[1,0,0]
v_pk_mul_f32 v[114:115], v[114:115], v[82:83]
v_pk_fma_f32 v[114:115], v[144:145], v[148:149], v[114:115]
v_lshlrev_b32 v82, 16, v163
v_and_b32 v83, 0xffff0000, v163
v_lshlrev_b32 v148, 16, v195
v_and_b32 v149, 0xffff0000, v195
v_pk_mul_f32 v[144:145], v[112:113], v[82:83]
v_pk_fma_f32 v[144:145], v[66:67], v[148:149], v[144:145] neg_lo:[1,0,0] neg_hi:[1,0,0]
v_pk_mul_f32 v[66:67], v[66:67], v[82:83]
v_pk_fma_f32 v[66:67], v[112:113], v[148:149], v[66:67]
v_lshlrev_b32 v82, 16, v164
v_and_b32 v83, 0xffff0000, v164
v_lshlrev_b32 v148, 16, v196
v_and_b32 v149, 0xffff0000, v196
v_pk_mul_f32 v[112:113], v[64:65], v[82:83]
v_pk_fma_f32 v[112:113], v[130:131], v[148:149], v[112:113] neg_lo:[1,0,0] neg_hi:[1,0,0]
v_pk_mul_f32 v[130:131], v[130:131], v[82:83]
v_pk_fma_f32 v[130:131], v[64:65], v[148:149], v[130:131]
v_lshlrev_b32 v82, 16, v165
v_and_b32 v83, 0xffff0000, v165
v_lshlrev_b32 v148, 16, v197
v_and_b32 v149, 0xffff0000, v197
v_pk_mul_f32 v[64:65], v[128:129], v[82:83]
v_pk_fma_f32 v[64:65], v[74:75], v[148:149], v[64:65] neg_lo:[1,0,0] neg_hi:[1,0,0]
v_pk_mul_f32 v[74:75], v[74:75], v[82:83]
v_pk_fma_f32 v[74:75], v[128:129], v[148:149], v[74:75]
v_lshlrev_b32 v82, 16, v166
v_and_b32 v83, 0xffff0000, v166
v_lshlrev_b32 v148, 16, v198
v_and_b32 v149, 0xffff0000, v198
v_pk_mul_f32 v[128:129], v[72:73], v[82:83]
v_pk_fma_f32 v[128:129], v[42:43], v[148:149], v[128:129] neg_lo:[1,0,0] neg_hi:[1,0,0]
v_pk_mul_f32 v[42:43], v[42:43], v[82:83]
v_pk_fma_f32 v[42:43], v[72:73], v[148:149], v[42:43]
v_lshlrev_b32 v82, 16, v167
v_and_b32 v83, 0xffff0000, v167
v_lshlrev_b32 v148, 16, v199
v_and_b32 v149, 0xffff0000, v199
v_pk_mul_f32 v[72:73], v[40:41], v[82:83]
v_pk_fma_f32 v[72:73], v[106:107], v[148:149], v[72:73] neg_lo:[1,0,0] neg_hi:[1,0,0]
v_pk_mul_f32 v[106:107], v[106:107], v[82:83]
v_pk_fma_f32 v[106:107], v[40:41], v[148:149], v[106:107]
v_lshlrev_b32 v82, 16, v168
v_and_b32 v83, 0xffff0000, v168
v_lshlrev_b32 v148, 16, v200
v_and_b32 v149, 0xffff0000, v200
v_pk_mul_f32 v[40:41], v[104:105], v[82:83]
v_pk_fma_f32 v[40:41], v[138:139], v[148:149], v[40:41] neg_lo:[1,0,0] neg_hi:[1,0,0]
v_pk_mul_f32 v[138:139], v[138:139], v[82:83]
v_pk_fma_f32 v[138:139], v[104:105], v[148:149], v[138:139]
v_lshlrev_b32 v82, 16, v169
v_and_b32 v83, 0xffff0000, v169
v_lshlrev_b32 v148, 16, v201
v_and_b32 v149, 0xffff0000, v201
v_pk_mul_f32 v[104:105], v[136:137], v[82:83]
v_pk_fma_f32 v[104:105], v[78:79], v[148:149], v[104:105] neg_lo:[1,0,0] neg_hi:[1,0,0]
v_pk_mul_f32 v[78:79], v[78:79], v[82:83]
v_pk_fma_f32 v[78:79], v[136:137], v[148:149], v[78:79]
v_lshlrev_b32 v82, 16, v170
v_and_b32 v83, 0xffff0000, v170
v_lshlrev_b32 v148, 16, v202
v_and_b32 v149, 0xffff0000, v202
v_pk_mul_f32 v[136:137], v[76:77], v[82:83]
v_pk_fma_f32 v[136:137], v[46:47], v[148:149], v[136:137] neg_lo:[1,0,0] neg_hi:[1,0,0]
v_pk_mul_f32 v[46:47], v[46:47], v[82:83]
v_pk_fma_f32 v[46:47], v[76:77], v[148:149], v[46:47]
v_lshlrev_b32 v82, 16, v171
v_and_b32 v83, 0xffff0000, v171
v_lshlrev_b32 v148, 16, v203
v_and_b32 v149, 0xffff0000, v203
v_pk_mul_f32 v[76:77], v[44:45], v[82:83]
v_pk_fma_f32 v[76:77], v[110:111], v[148:149], v[76:77] neg_lo:[1,0,0] neg_hi:[1,0,0]
v_pk_mul_f32 v[110:111], v[110:111], v[82:83]
v_pk_fma_f32 v[110:111], v[44:45], v[148:149], v[110:111]
v_lshlrev_b32 v82, 16, v172
v_and_b32 v83, 0xffff0000, v172
v_lshlrev_b32 v148, 16, v204
v_and_b32 v149, 0xffff0000, v204
v_pk_mul_f32 v[44:45], v[108:109], v[82:83]
v_pk_fma_f32 v[44:45], v[30:31], v[148:149], v[44:45] neg_lo:[1,0,0] neg_hi:[1,0,0]
v_pk_mul_f32 v[30:31], v[30:31], v[82:83]
v_pk_fma_f32 v[30:31], v[108:109], v[148:149], v[30:31]
v_lshlrev_b32 v82, 16, v173
v_and_b32 v83, 0xffff0000, v173
v_lshlrev_b32 v148, 16, v205
v_and_b32 v149, 0xffff0000, v205
v_pk_mul_f32 v[108:109], v[28:29], v[82:83]
v_pk_fma_f32 v[108:109], v[94:95], v[148:149], v[108:109] neg_lo:[1,0,0] neg_hi:[1,0,0]
v_pk_mul_f32 v[94:95], v[94:95], v[82:83]
v_pk_fma_f32 v[94:95], v[28:29], v[148:149], v[94:95]
v_lshlrev_b32 v82, 16, v174
v_and_b32 v83, 0xffff0000, v174
v_lshlrev_b32 v148, 16, v206
v_and_b32 v149, 0xffff0000, v206
v_pk_mul_f32 v[28:29], v[92:93], v[82:83]
v_pk_fma_f32 v[28:29], v[62:63], v[148:149], v[28:29] neg_lo:[1,0,0] neg_hi:[1,0,0]
v_pk_mul_f32 v[62:63], v[62:63], v[82:83]
v_pk_fma_f32 v[62:63], v[92:93], v[148:149], v[62:63]
v_lshlrev_b32 v82, 16, v175
v_and_b32 v83, 0xffff0000, v175
v_lshlrev_b32 v148, 16, v207
v_and_b32 v149, 0xffff0000, v207
v_pk_mul_f32 v[92:93], v[60:61], v[82:83]
v_pk_fma_f32 v[92:93], v[126:127], v[148:149], v[92:93] neg_lo:[1,0,0] neg_hi:[1,0,0]
v_pk_mul_f32 v[126:127], v[126:127], v[82:83]
v_pk_fma_f32 v[126:127], v[60:61], v[148:149], v[126:127]
v_lshlrev_b32 v82, 16, v176
v_and_b32 v83, 0xffff0000, v176
v_lshlrev_b32 v148, 16, v208
v_and_b32 v149, 0xffff0000, v208
v_pk_mul_f32 v[60:61], v[124:125], v[82:83]
v_pk_fma_f32 v[60:61], v[142:143], v[148:149], v[60:61] neg_lo:[1,0,0] neg_hi:[1,0,0]
v_pk_mul_f32 v[142:143], v[142:143], v[82:83]
v_pk_fma_f32 v[142:143], v[124:125], v[148:149], v[142:143]
v_lshlrev_b32 v82, 16, v177
v_and_b32 v83, 0xffff0000, v177
v_lshlrev_b32 v148, 16, v209
v_and_b32 v149, 0xffff0000, v209
v_pk_mul_f32 v[124:125], v[140:141], v[82:83]
v_pk_fma_f32 v[124:125], v[50:51], v[148:149], v[124:125] neg_lo:[1,0,0] neg_hi:[1,0,0]
v_pk_mul_f32 v[50:51], v[50:51], v[82:83]
v_pk_fma_f32 v[50:51], v[140:141], v[148:149], v[50:51]
v_lshlrev_b32 v82, 16, v178
v_and_b32 v83, 0xffff0000, v178
v_lshlrev_b32 v148, 16, v210
v_and_b32 v149, 0xffff0000, v210
v_pk_mul_f32 v[140:141], v[48:49], v[82:83]
v_pk_fma_f32 v[140:141], v[34:35], v[148:149], v[140:141] neg_lo:[1,0,0] neg_hi:[1,0,0]
v_pk_mul_f32 v[34:35], v[34:35], v[82:83]
v_pk_fma_f32 v[34:35], v[48:49], v[148:149], v[34:35]
v_lshlrev_b32 v82, 16, v179
v_and_b32 v83, 0xffff0000, v179
v_lshlrev_b32 v148, 16, v211
v_and_b32 v149, 0xffff0000, v211
v_pk_mul_f32 v[48:49], v[32:33], v[82:83]
v_pk_fma_f32 v[48:49], v[98:99], v[148:149], v[48:49] neg_lo:[1,0,0] neg_hi:[1,0,0]
v_pk_mul_f32 v[98:99], v[98:99], v[82:83]
v_pk_fma_f32 v[98:99], v[32:33], v[148:149], v[98:99]
v_lshlrev_b32 v82, 16, v180
v_and_b32 v83, 0xffff0000, v180
v_lshlrev_b32 v148, 16, v212
v_and_b32 v149, 0xffff0000, v212
v_pk_mul_f32 v[32:33], v[96:97], v[82:83]
v_pk_fma_f32 v[32:33], v[26:27], v[148:149], v[32:33] neg_lo:[1,0,0] neg_hi:[1,0,0]
v_pk_mul_f32 v[26:27], v[26:27], v[82:83]
v_pk_fma_f32 v[26:27], v[96:97], v[148:149], v[26:27]
v_lshlrev_b32 v82, 16, v181
v_and_b32 v83, 0xffff0000, v181
v_lshlrev_b32 v148, 16, v213
v_and_b32 v149, 0xffff0000, v213
v_pk_mul_f32 v[96:97], v[24:25], v[82:83]
v_pk_fma_f32 v[96:97], v[90:91], v[148:149], v[96:97] neg_lo:[1,0,0] neg_hi:[1,0,0]
v_pk_mul_f32 v[90:91], v[90:91], v[82:83]
v_pk_fma_f32 v[90:91], v[24:25], v[148:149], v[90:91]
v_lshlrev_b32 v82, 16, v182
v_and_b32 v83, 0xffff0000, v182
v_lshlrev_b32 v148, 16, v214
v_and_b32 v149, 0xffff0000, v214
v_pk_mul_f32 v[24:25], v[88:89], v[82:83]
v_pk_fma_f32 v[24:25], v[58:59], v[148:149], v[24:25] neg_lo:[1,0,0] neg_hi:[1,0,0]
v_pk_mul_f32 v[58:59], v[58:59], v[82:83]
v_pk_fma_f32 v[58:59], v[88:89], v[148:149], v[58:59]
v_lshlrev_b32 v82, 16, v183
v_and_b32 v83, 0xffff0000, v183
v_lshlrev_b32 v148, 16, v215
v_and_b32 v149, 0xffff0000, v215
v_pk_mul_f32 v[88:89], v[56:57], v[82:83]
v_pk_fma_f32 v[88:89], v[122:123], v[148:149], v[88:89] neg_lo:[1,0,0] neg_hi:[1,0,0]
v_pk_mul_f32 v[122:123], v[122:123], v[82:83]
v_pk_fma_f32 v[122:123], v[56:57], v[148:149], v[122:123]
v_lshlrev_b32 v82, 16, v184
v_and_b32 v83, 0xffff0000, v184
v_lshlrev_b32 v148, 16, v216
v_and_b32 v149, 0xffff0000, v216
v_pk_mul_f32 v[56:57], v[120:121], v[82:83]
v_pk_fma_f32 v[56:57], v[22:23], v[148:149], v[56:57] neg_lo:[1,0,0] neg_hi:[1,0,0]
v_pk_mul_f32 v[22:23], v[22:23], v[82:83]
v_pk_fma_f32 v[22:23], v[120:121], v[148:149], v[22:23]
v_lshlrev_b32 v82, 16, v185
v_and_b32 v83, 0xffff0000, v185
v_lshlrev_b32 v148, 16, v217
v_and_b32 v149, 0xffff0000, v217
v_pk_mul_f32 v[120:121], v[20:21], v[82:83]
v_pk_fma_f32 v[120:121], v[86:87], v[148:149], v[120:121] neg_lo:[1,0,0] neg_hi:[1,0,0]
v_pk_mul_f32 v[86:87], v[86:87], v[82:83]
v_pk_fma_f32 v[86:87], v[20:21], v[148:149], v[86:87]
v_lshlrev_b32 v82, 16, v186
v_and_b32 v83, 0xffff0000, v186
v_lshlrev_b32 v148, 16, v218
v_and_b32 v149, 0xffff0000, v218
v_pk_mul_f32 v[20:21], v[84:85], v[82:83]
v_pk_fma_f32 v[20:21], v[54:55], v[148:149], v[20:21] neg_lo:[1,0,0] neg_hi:[1,0,0]
v_pk_mul_f32 v[54:55], v[54:55], v[82:83]
v_pk_fma_f32 v[54:55], v[84:85], v[148:149], v[54:55]
v_lshlrev_b32 v82, 16, v187
v_and_b32 v83, 0xffff0000, v187
v_lshlrev_b32 v148, 16, v219
v_and_b32 v149, 0xffff0000, v219
v_pk_mul_f32 v[84:85], v[52:53], v[82:83]
v_pk_fma_f32 v[84:85], v[118:119], v[148:149], v[84:85] neg_lo:[1,0,0] neg_hi:[1,0,0]
v_pk_mul_f32 v[118:119], v[118:119], v[82:83]
v_pk_fma_f32 v[118:119], v[52:53], v[148:149], v[118:119]
v_lshlrev_b32 v82, 16, v188
v_and_b32 v83, 0xffff0000, v188
v_lshlrev_b32 v148, 16, v220
v_and_b32 v149, 0xffff0000, v220
v_pk_mul_f32 v[52:53], v[116:117], v[82:83]
v_pk_fma_f32 v[52:53], v[38:39], v[148:149], v[52:53] neg_lo:[1,0,0] neg_hi:[1,0,0]
v_pk_mul_f32 v[38:39], v[38:39], v[82:83]
v_pk_fma_f32 v[38:39], v[116:117], v[148:149], v[38:39]
v_lshlrev_b32 v82, 16, v189
v_and_b32 v83, 0xffff0000, v189
v_lshlrev_b32 v148, 16, v221
v_and_b32 v149, 0xffff0000, v221
v_pk_mul_f32 v[116:117], v[36:37], v[82:83]
v_pk_fma_f32 v[116:117], v[102:103], v[148:149], v[116:117] neg_lo:[1,0,0] neg_hi:[1,0,0]
v_pk_mul_f32 v[102:103], v[102:103], v[82:83]
v_pk_fma_f32 v[102:103], v[36:37], v[148:149], v[102:103]
v_lshlrev_b32 v82, 16, v190
v_and_b32 v83, 0xffff0000, v190
v_lshlrev_b32 v148, 16, v222
v_and_b32 v149, 0xffff0000, v222
v_pk_mul_f32 v[36:37], v[100:101], v[82:83]
v_pk_fma_f32 v[36:37], v[70:71], v[148:149], v[36:37] neg_lo:[1,0,0] neg_hi:[1,0,0]
v_pk_mul_f32 v[70:71], v[70:71], v[82:83]
v_pk_fma_f32 v[70:71], v[100:101], v[148:149], v[70:71]
v_lshlrev_b32 v82, 16, v191
v_and_b32 v83, 0xffff0000, v191
v_lshlrev_b32 v148, 16, v223
v_and_b32 v149, 0xffff0000, v223
v_pk_mul_f32 v[100:101], v[68:69], v[82:83]
v_pk_fma_f32 v[100:101], v[134:135], v[148:149], v[100:101] neg_lo:[1,0,0] neg_hi:[1,0,0]
v_pk_mul_f32 v[134:135], v[134:135], v[82:83]
v_pk_fma_f32 v[134:135], v[68:69], v[148:149], v[134:135]
s_nop 1
v_mov_b32_dpp v68, v132 quad_perm:[1,0,3,2] row_mask:0xf bank_mask:0xf
v_mov_b32_dpp v69, v133 quad_perm:[1,0,3,2] row_mask:0xf bank_mask:0xf
v_pk_fma_f32 v[132:133], v[132:133], v[14:15], v[68:69] op_sel_hi:[1,0,1]
v_mov_b32_dpp v82, v18 quad_perm:[1,0,3,2] row_mask:0xf bank_mask:0xf
v_mov_b32_dpp v83, v19 quad_perm:[1,0,3,2] row_mask:0xf bank_mask:0xf
v_pk_fma_f32 v[18:19], v[18:19], v[14:15], v[82:83] op_sel_hi:[1,0,1]
v_mov_b32_dpp v68, v16 quad_perm:[1,0,3,2] row_mask:0xf bank_mask:0xf
v_mov_b32_dpp v69, v17 quad_perm:[1,0,3,2] row_mask:0xf bank_mask:0xf
v_pk_fma_f32 v[16:17], v[16:17], v[14:15], v[68:69] op_sel_hi:[1,0,1]
v_mov_b32_dpp v82, v146 quad_perm:[1,0,3,2] row_mask:0xf bank_mask:0xf
v_mov_b32_dpp v83, v147 quad_perm:[1,0,3,2] row_mask:0xf bank_mask:0xf
v_pk_fma_f32 v[146:147], v[146:147], v[14:15], v[82:83] op_sel_hi:[1,0,1]
v_mov_b32_dpp v68, v80 quad_perm:[1,0,3,2] row_mask:0xf bank_mask:0xf
v_mov_b32_dpp v69, v81 quad_perm:[1,0,3,2] row_mask:0xf bank_mask:0xf
v_pk_fma_f32 v[80:81], v[80:81], v[14:15], v[68:69] op_sel_hi:[1,0,1]
v_mov_b32_dpp v82, v114 quad_perm:[1,0,3,2] row_mask:0xf bank_mask:0xf
v_mov_b32_dpp v83, v115 quad_perm:[1,0,3,2] row_mask:0xf bank_mask:0xf
v_pk_fma_f32 v[114:115], v[114:115], v[14:15], v[82:83] op_sel_hi:[1,0,1]
v_mov_b32_dpp v68, v144 quad_perm:[1,0,3,2] row_mask:0xf bank_mask:0xf
v_mov_b32_dpp v69, v145 quad_perm:[1,0,3,2] row_mask:0xf bank_mask:0xf
v_pk_fma_f32 v[144:145], v[144:145], v[14:15], v[68:69] op_sel_hi:[1,0,1]
v_mov_b32_dpp v82, v66 quad_perm:[1,0,3,2] row_mask:0xf bank_mask:0xf
v_mov_b32_dpp v83, v67 quad_perm:[1,0,3,2] row_mask:0xf bank_mask:0xf
v_pk_fma_f32 v[66:67], v[66:67], v[14:15], v[82:83] op_sel_hi:[1,0,1]
v_mov_b32_dpp v68, v112 quad_perm:[1,0,3,2] row_mask:0xf bank_mask:0xf
v_mov_b32_dpp v69, v113 quad_perm:[1,0,3,2] row_mask:0xf bank_mask:0xf
v_pk_fma_f32 v[112:113], v[112:113], v[14:15], v[68:69] op_sel_hi:[1,0,1]
v_mov_b32_dpp v82, v130 quad_perm:[1,0,3,2] row_mask:0xf bank_mask:0xf
v_mov_b32_dpp v83, v131 quad_perm:[1,0,3,2] row_mask:0xf bank_mask:0xf
v_pk_fma_f32 v[130:131], v[130:131], v[14:15], v[82:83] op_sel_hi:[1,0,1]
v_mov_b32_dpp v68, v64 quad_perm:[1,0,3,2] row_mask:0xf bank_mask:0xf
v_mov_b32_dpp v69, v65 quad_perm:[1,0,3,2] row_mask:0xf bank_mask:0xf
v_pk_fma_f32 v[64:65], v[64:65], v[14:15], v[68:69] op_sel_hi:[1,0,1]
v_mov_b32_dpp v82, v74 quad_perm:[1,0,3,2] row_mask:0xf bank_mask:0xf
v_mov_b32_dpp v83, v75 quad_perm:[1,0,3,2] row_mask:0xf bank_mask:0xf
v_pk_fma_f32 v[74:75], v[74:75], v[14:15], v[82:83] op_sel_hi:[1,0,1]
v_mov_b32_dpp v68, v128 quad_perm:[1,0,3,2] row_mask:0xf bank_mask:0xf
v_mov_b32_dpp v69, v129 quad_perm:[1,0,3,2] row_mask:0xf bank_mask:0xf
v_pk_fma_f32 v[128:129], v[128:129], v[14:15], v[68:69] op_sel_hi:[1,0,1]
v_mov_b32_dpp v82, v42 quad_perm:[1,0,3,2] row_mask:0xf bank_mask:0xf
v_mov_b32_dpp v83, v43 quad_perm:[1,0,3,2] row_mask:0xf bank_mask:0xf
v_pk_fma_f32 v[42:43], v[42:43], v[14:15], v[82:83] op_sel_hi:[1,0,1]
v_mov_b32_dpp v68, v72 quad_perm:[1,0,3,2] row_mask:0xf bank_mask:0xf
v_mov_b32_dpp v69, v73 quad_perm:[1,0,3,2] row_mask:0xf bank_mask:0xf
v_pk_fma_f32 v[72:73], v[72:73], v[14:15], v[68:69] op_sel_hi:[1,0,1]
v_mov_b32_dpp v82, v106 quad_perm:[1,0,3,2] row_mask:0xf bank_mask:0xf
v_mov_b32_dpp v83, v107 quad_perm:[1,0,3,2] row_mask:0xf bank_mask:0xf
v_pk_fma_f32 v[106:107], v[106:107], v[14:15], v[82:83] op_sel_hi:[1,0,1]
v_mov_b32_dpp v68, v40 quad_perm:[1,0,3,2] row_mask:0xf bank_mask:0xf
v_mov_b32_dpp v69, v41 quad_perm:[1,0,3,2] row_mask:0xf bank_mask:0xf
v_pk_fma_f32 v[40:41], v[40:41], v[14:15], v[68:69] op_sel_hi:[1,0,1]
v_mov_b32_dpp v82, v138 quad_perm:[1,0,3,2] row_mask:0xf bank_mask:0xf
v_mov_b32_dpp v83, v139 quad_perm:[1,0,3,2] row_mask:0xf bank_mask:0xf
v_pk_fma_f32 v[138:139], v[138:139], v[14:15], v[82:83] op_sel_hi:[1,0,1]
v_mov_b32_dpp v68, v104 quad_perm:[1,0,3,2] row_mask:0xf bank_mask:0xf
v_mov_b32_dpp v69, v105 quad_perm:[1,0,3,2] row_mask:0xf bank_mask:0xf
v_pk_fma_f32 v[104:105], v[104:105], v[14:15], v[68:69] op_sel_hi:[1,0,1]
v_mov_b32_dpp v82, v78 quad_perm:[1,0,3,2] row_mask:0xf bank_mask:0xf
v_mov_b32_dpp v83, v79 quad_perm:[1,0,3,2] row_mask:0xf bank_mask:0xf
v_pk_fma_f32 v[78:79], v[78:79], v[14:15], v[82:83] op_sel_hi:[1,0,1]
v_mov_b32_dpp v68, v136 quad_perm:[1,0,3,2] row_mask:0xf bank_mask:0xf
v_mov_b32_dpp v69, v137 quad_perm:[1,0,3,2] row_mask:0xf bank_mask:0xf
v_pk_fma_f32 v[136:137], v[136:137], v[14:15], v[68:69] op_sel_hi:[1,0,1]
v_mov_b32_dpp v82, v46 quad_perm:[1,0,3,2] row_mask:0xf bank_mask:0xf
v_mov_b32_dpp v83, v47 quad_perm:[1,0,3,2] row_mask:0xf bank_mask:0xf
v_pk_fma_f32 v[46:47], v[46:47], v[14:15], v[82:83] op_sel_hi:[1,0,1]
v_mov_b32_dpp v68, v76 quad_perm:[1,0,3,2] row_mask:0xf bank_mask:0xf
v_mov_b32_dpp v69, v77 quad_perm:[1,0,3,2] row_mask:0xf bank_mask:0xf
v_pk_fma_f32 v[76:77], v[76:77], v[14:15], v[68:69] op_sel_hi:[1,0,1]
v_mov_b32_dpp v82, v110 quad_perm:[1,0,3,2] row_mask:0xf bank_mask:0xf
v_mov_b32_dpp v83, v111 quad_perm:[1,0,3,2] row_mask:0xf bank_mask:0xf
v_pk_fma_f32 v[110:111], v[110:111], v[14:15], v[82:83] op_sel_hi:[1,0,1]
v_mov_b32_dpp v68, v44 quad_perm:[1,0,3,2] row_mask:0xf bank_mask:0xf
v_mov_b32_dpp v69, v45 quad_perm:[1,0,3,2] row_mask:0xf bank_mask:0xf
v_pk_fma_f32 v[44:45], v[44:45], v[14:15], v[68:69] op_sel_hi:[1,0,1]
v_mov_b32_dpp v82, v30 quad_perm:[1,0,3,2] row_mask:0xf bank_mask:0xf
v_mov_b32_dpp v83, v31 quad_perm:[1,0,3,2] row_mask:0xf bank_mask:0xf
v_pk_fma_f32 v[30:31], v[30:31], v[14:15], v[82:83] op_sel_hi:[1,0,1]
v_mov_b32_dpp v68, v108 quad_perm:[1,0,3,2] row_mask:0xf bank_mask:0xf
v_mov_b32_dpp v69, v109 quad_perm:[1,0,3,2] row_mask:0xf bank_mask:0xf
v_pk_fma_f32 v[108:109], v[108:109], v[14:15], v[68:69] op_sel_hi:[1,0,1]
v_mov_b32_dpp v82, v94 quad_perm:[1,0,3,2] row_mask:0xf bank_mask:0xf
v_mov_b32_dpp v83, v95 quad_perm:[1,0,3,2] row_mask:0xf bank_mask:0xf
v_pk_fma_f32 v[94:95], v[94:95], v[14:15], v[82:83] op_sel_hi:[1,0,1]
v_mov_b32_dpp v68, v28 quad_perm:[1,0,3,2] row_mask:0xf bank_mask:0xf
v_mov_b32_dpp v69, v29 quad_perm:[1,0,3,2] row_mask:0xf bank_mask:0xf
v_pk_fma_f32 v[28:29], v[28:29], v[14:15], v[68:69] op_sel_hi:[1,0,1]
v_mov_b32_dpp v82, v62 quad_perm:[1,0,3,2] row_mask:0xf bank_mask:0xf
v_mov_b32_dpp v83, v63 quad_perm:[1,0,3,2] row_mask:0xf bank_mask:0xf
v_pk_fma_f32 v[62:63], v[62:63], v[14:15], v[82:83] op_sel_hi:[1,0,1]
v_mov_b32_dpp v68, v92 quad_perm:[1,0,3,2] row_mask:0xf bank_mask:0xf
v_mov_b32_dpp v69, v93 quad_perm:[1,0,3,2] row_mask:0xf bank_mask:0xf
v_pk_fma_f32 v[92:93], v[92:93], v[14:15], v[68:69] op_sel_hi:[1,0,1]
v_mov_b32_dpp v82, v126 quad_perm:[1,0,3,2] row_mask:0xf bank_mask:0xf
v_mov_b32_dpp v83, v127 quad_perm:[1,0,3,2] row_mask:0xf bank_mask:0xf
v_pk_fma_f32 v[126:127], v[126:127], v[14:15], v[82:83] op_sel_hi:[1,0,1]
v_mov_b32_dpp v68, v60 quad_perm:[1,0,3,2] row_mask:0xf bank_mask:0xf
v_mov_b32_dpp v69, v61 quad_perm:[1,0,3,2] row_mask:0xf bank_mask:0xf
v_pk_fma_f32 v[60:61], v[60:61], v[14:15], v[68:69] op_sel_hi:[1,0,1]
v_mov_b32_dpp v82, v142 quad_perm:[1,0,3,2] row_mask:0xf bank_mask:0xf
v_mov_b32_dpp v83, v143 quad_perm:[1,0,3,2] row_mask:0xf bank_mask:0xf
v_pk_fma_f32 v[142:143], v[142:143], v[14:15], v[82:83] op_sel_hi:[1,0,1]
v_mov_b32_dpp v68, v124 quad_perm:[1,0,3,2] row_mask:0xf bank_mask:0xf
v_mov_b32_dpp v69, v125 quad_perm:[1,0,3,2] row_mask:0xf bank_mask:0xf
v_pk_fma_f32 v[124:125], v[124:125], v[14:15], v[68:69] op_sel_hi:[1,0,1]
v_mov_b32_dpp v82, v50 quad_perm:[1,0,3,2] row_mask:0xf bank_mask:0xf
v_mov_b32_dpp v83, v51 quad_perm:[1,0,3,2] row_mask:0xf bank_mask:0xf
v_pk_fma_f32 v[50:51], v[50:51], v[14:15], v[82:83] op_sel_hi:[1,0,1]
v_mov_b32_dpp v68, v140 quad_perm:[1,0,3,2] row_mask:0xf bank_mask:0xf
v_mov_b32_dpp v69, v141 quad_perm:[1,0,3,2] row_mask:0xf bank_mask:0xf
v_pk_fma_f32 v[140:141], v[140:141], v[14:15], v[68:69] op_sel_hi:[1,0,1]
v_mov_b32_dpp v82, v34 quad_perm:[1,0,3,2] row_mask:0xf bank_mask:0xf
v_mov_b32_dpp v83, v35 quad_perm:[1,0,3,2] row_mask:0xf bank_mask:0xf
v_pk_fma_f32 v[34:35], v[34:35], v[14:15], v[82:83] op_sel_hi:[1,0,1]
v_mov_b32_dpp v68, v48 quad_perm:[1,0,3,2] row_mask:0xf bank_mask:0xf
v_mov_b32_dpp v69, v49 quad_perm:[1,0,3,2] row_mask:0xf bank_mask:0xf
v_pk_fma_f32 v[48:49], v[48:49], v[14:15], v[68:69] op_sel_hi:[1,0,1]
v_mov_b32_dpp v82, v98 quad_perm:[1,0,3,2] row_mask:0xf bank_mask:0xf
v_mov_b32_dpp v83, v99 quad_perm:[1,0,3,2] row_mask:0xf bank_mask:0xf
v_pk_fma_f32 v[98:99], v[98:99], v[14:15], v[82:83] op_sel_hi:[1,0,1]
v_mov_b32_dpp v68, v32 quad_perm:[1,0,3,2] row_mask:0xf bank_mask:0xf
v_mov_b32_dpp v69, v33 quad_perm:[1,0,3,2] row_mask:0xf bank_mask:0xf
v_pk_fma_f32 v[32:33], v[32:33], v[14:15], v[68:69] op_sel_hi:[1,0,1]
v_mov_b32_dpp v82, v26 quad_perm:[1,0,3,2] row_mask:0xf bank_mask:0xf
v_mov_b32_dpp v83, v27 quad_perm:[1,0,3,2] row_mask:0xf bank_mask:0xf
v_pk_fma_f32 v[26:27], v[26:27], v[14:15], v[82:83] op_sel_hi:[1,0,1]
v_mov_b32_dpp v68, v96 quad_perm:[1,0,3,2] row_mask:0xf bank_mask:0xf
v_mov_b32_dpp v69, v97 quad_perm:[1,0,3,2] row_mask:0xf bank_mask:0xf
v_pk_fma_f32 v[96:97], v[96:97], v[14:15], v[68:69] op_sel_hi:[1,0,1]
v_mov_b32_dpp v82, v90 quad_perm:[1,0,3,2] row_mask:0xf bank_mask:0xf
v_mov_b32_dpp v83, v91 quad_perm:[1,0,3,2] row_mask:0xf bank_mask:0xf
v_pk_fma_f32 v[90:91], v[90:91], v[14:15], v[82:83] op_sel_hi:[1,0,1]
v_mov_b32_dpp v68, v24 quad_perm:[1,0,3,2] row_mask:0xf bank_mask:0xf
v_mov_b32_dpp v69, v25 quad_perm:[1,0,3,2] row_mask:0xf bank_mask:0xf
v_pk_fma_f32 v[24:25], v[24:25], v[14:15], v[68:69] op_sel_hi:[1,0,1]
v_mov_b32_dpp v82, v58 quad_perm:[1,0,3,2] row_mask:0xf bank_mask:0xf
v_mov_b32_dpp v83, v59 quad_perm:[1,0,3,2] row_mask:0xf bank_mask:0xf
v_pk_fma_f32 v[58:59], v[58:59], v[14:15], v[82:83] op_sel_hi:[1,0,1]
v_mov_b32_dpp v68, v88 quad_perm:[1,0,3,2] row_mask:0xf bank_mask:0xf
v_mov_b32_dpp v69, v89 quad_perm:[1,0,3,2] row_mask:0xf bank_mask:0xf
v_pk_fma_f32 v[88:89], v[88:89], v[14:15], v[68:69] op_sel_hi:[1,0,1]
v_mov_b32_dpp v82, v122 quad_perm:[1,0,3,2] row_mask:0xf bank_mask:0xf
v_mov_b32_dpp v83, v123 quad_perm:[1,0,3,2] row_mask:0xf bank_mask:0xf
v_pk_fma_f32 v[122:123], v[122:123], v[14:15], v[82:83] op_sel_hi:[1,0,1]
v_mov_b32_dpp v68, v56 quad_perm:[1,0,3,2] row_mask:0xf bank_mask:0xf
v_mov_b32_dpp v69, v57 quad_perm:[1,0,3,2] row_mask:0xf bank_mask:0xf
v_pk_fma_f32 v[56:57], v[56:57], v[14:15], v[68:69] op_sel_hi:[1,0,1]
v_mov_b32_dpp v82, v22 quad_perm:[1,0,3,2] row_mask:0xf bank_mask:0xf
v_mov_b32_dpp v83, v23 quad_perm:[1,0,3,2] row_mask:0xf bank_mask:0xf
v_pk_fma_f32 v[22:23], v[22:23], v[14:15], v[82:83] op_sel_hi:[1,0,1]
v_mov_b32_dpp v68, v120 quad_perm:[1,0,3,2] row_mask:0xf bank_mask:0xf
v_mov_b32_dpp v69, v121 quad_perm:[1,0,3,2] row_mask:0xf bank_mask:0xf
v_pk_fma_f32 v[120:121], v[120:121], v[14:15], v[68:69] op_sel_hi:[1,0,1]
v_mov_b32_dpp v82, v86 quad_perm:[1,0,3,2] row_mask:0xf bank_mask:0xf
v_mov_b32_dpp v83, v87 quad_perm:[1,0,3,2] row_mask:0xf bank_mask:0xf
v_pk_fma_f32 v[86:87], v[86:87], v[14:15], v[82:83] op_sel_hi:[1,0,1]
v_mov_b32_dpp v68, v20 quad_perm:[1,0,3,2] row_mask:0xf bank_mask:0xf
v_mov_b32_dpp v69, v21 quad_perm:[1,0,3,2] row_mask:0xf bank_mask:0xf
v_pk_fma_f32 v[20:21], v[20:21], v[14:15], v[68:69] op_sel_hi:[1,0,1]
v_mov_b32_dpp v82, v54 quad_perm:[1,0,3,2] row_mask:0xf bank_mask:0xf
v_mov_b32_dpp v83, v55 quad_perm:[1,0,3,2] row_mask:0xf bank_mask:0xf
v_pk_fma_f32 v[54:55], v[54:55], v[14:15], v[82:83] op_sel_hi:[1,0,1]
v_mov_b32_dpp v68, v84 quad_perm:[1,0,3,2] row_mask:0xf bank_mask:0xf
v_mov_b32_dpp v69, v85 quad_perm:[1,0,3,2] row_mask:0xf bank_mask:0xf
v_pk_fma_f32 v[84:85], v[84:85], v[14:15], v[68:69] op_sel_hi:[1,0,1]
v_mov_b32_dpp v82, v118 quad_perm:[1,0,3,2] row_mask:0xf bank_mask:0xf
v_mov_b32_dpp v83, v119 quad_perm:[1,0,3,2] row_mask:0xf bank_mask:0xf
v_pk_fma_f32 v[118:119], v[118:119], v[14:15], v[82:83] op_sel_hi:[1,0,1]
v_mov_b32_dpp v68, v52 quad_perm:[1,0,3,2] row_mask:0xf bank_mask:0xf
v_mov_b32_dpp v69, v53 quad_perm:[1,0,3,2] row_mask:0xf bank_mask:0xf
v_pk_fma_f32 v[52:53], v[52:53], v[14:15], v[68:69] op_sel_hi:[1,0,1]
v_mov_b32_dpp v82, v38 quad_perm:[1,0,3,2] row_mask:0xf bank_mask:0xf
v_mov_b32_dpp v83, v39 quad_perm:[1,0,3,2] row_mask:0xf bank_mask:0xf
v_pk_fma_f32 v[38:39], v[38:39], v[14:15], v[82:83] op_sel_hi:[1,0,1]
v_mov_b32_dpp v68, v116 quad_perm:[1,0,3,2] row_mask:0xf bank_mask:0xf
v_mov_b32_dpp v69, v117 quad_perm:[1,0,3,2] row_mask:0xf bank_mask:0xf
v_pk_fma_f32 v[116:117], v[116:117], v[14:15], v[68:69] op_sel_hi:[1,0,1]
v_mov_b32_dpp v82, v102 quad_perm:[1,0,3,2] row_mask:0xf bank_mask:0xf
v_mov_b32_dpp v83, v103 quad_perm:[1,0,3,2] row_mask:0xf bank_mask:0xf
v_pk_fma_f32 v[102:103], v[102:103], v[14:15], v[82:83] op_sel_hi:[1,0,1]
v_mov_b32_dpp v68, v36 quad_perm:[1,0,3,2] row_mask:0xf bank_mask:0xf
v_mov_b32_dpp v69, v37 quad_perm:[1,0,3,2] row_mask:0xf bank_mask:0xf
v_pk_fma_f32 v[36:37], v[36:37], v[14:15], v[68:69] op_sel_hi:[1,0,1]
v_mov_b32_dpp v82, v70 quad_perm:[1,0,3,2] row_mask:0xf bank_mask:0xf
v_mov_b32_dpp v83, v71 quad_perm:[1,0,3,2] row_mask:0xf bank_mask:0xf
v_pk_fma_f32 v[70:71], v[70:71], v[14:15], v[82:83] op_sel_hi:[1,0,1]
v_mov_b32_dpp v68, v100 quad_perm:[1,0,3,2] row_mask:0xf bank_mask:0xf
v_mov_b32_dpp v69, v101 quad_perm:[1,0,3,2] row_mask:0xf bank_mask:0xf
v_pk_fma_f32 v[100:101], v[100:101], v[14:15], v[68:69] op_sel_hi:[1,0,1]
v_mov_b32_dpp v82, v134 quad_perm:[1,0,3,2] row_mask:0xf bank_mask:0xf
v_mov_b32_dpp v83, v135 quad_perm:[1,0,3,2] row_mask:0xf bank_mask:0xf
v_pk_fma_f32 v[134:135], v[134:135], v[14:15], v[82:83] op_sel_hi:[1,0,1]
v_mul_f32 v151, 0x3c800000, v9
v_cos_f32 v150, v151
v_sin_f32 v151, v151
v_mul_f32 v149, 0x3d000000, v9
v_cos_f32 v148, v149
v_sin_f32 v149, v149
v_pk_mul_f32 v[68:69], v[16:17], v[150:151] op_sel_hi:[1,0]
v_pk_fma_f32 v[68:69], v[146:147], v[150:151], v[68:69] op_sel:[0,1,0] neg_lo:[1,0,0] neg_hi:[1,0,0]
v_pk_mul_f32 v[146:147], v[146:147], v[150:151] op_sel_hi:[1,0]
v_pk_fma_f32 v[146:147], v[16:17], v[150:151], v[146:147] op_sel:[0,1,0]
v_mul_f32 v151, 0x3d400000, v9
v_cos_f32 v150, v151
v_sin_f32 v151, v151
v_pk_mul_f32 v[16:17], v[80:81], v[148:149] op_sel_hi:[1,0]
v_pk_fma_f32 v[16:17], v[114:115], v[148:149], v[16:17] op_sel:[0,1,0] neg_lo:[1,0,0] neg_hi:[1,0,0]
v_pk_mul_f32 v[114:115], v[114:115], v[148:149] op_sel_hi:[1,0]
v_pk_fma_f32 v[114:115], v[80:81], v[148:149], v[114:115] op_sel:[0,1,0]
v_mul_f32 v149, 0x3d800000, v9
v_cos_f32 v148, v149
v_sin_f32 v149, v149
v_pk_mul_f32 v[80:81], v[144:145], v[150:151] op_sel_hi:[1,0]
v_pk_fma_f32 v[80:81], v[66:67], v[150:151], v[80:81] op_sel:[0,1,0] neg_lo:[1,0,0] neg_hi:[1,0,0]
v_pk_mul_f32 v[66:67], v[66:67], v[150:151] op_sel_hi:[1,0]
v_pk_fma_f32 v[66:67], v[144:145], v[150:151], v[66:67] op_sel:[0,1,0]
v_mul_f32 v151, 0x3da00000, v9
v_cos_f32 v150, v151
v_sin_f32 v151, v151
v_pk_mul_f32 v[144:145], v[112:113], v[148:149] op_sel_hi:[1,0]
v_pk_fma_f32 v[144:145], v[130:131], v[148:149], v[144:145] op_sel:[0,1,0] neg_lo:[1,0,0] neg_hi:[1,0,0]
v_pk_mul_f32 v[130:131], v[130:131], v[148:149] op_sel_hi:[1,0]
v_pk_fma_f32 v[130:131], v[112:113], v[148:149], v[130:131] op_sel:[0,1,0]
v_mul_f32 v149, 0x3dc00000, v9
v_cos_f32 v148, v149
v_sin_f32 v149, v149
v_pk_mul_f32 v[112:113], v[64:65], v[150:151] op_sel_hi:[1,0]
v_pk_fma_f32 v[112:113], v[74:75], v[150:151], v[112:113] op_sel:[0,1,0] neg_lo:[1,0,0] neg_hi:[1,0,0]
v_pk_mul_f32 v[74:75], v[74:75], v[150:151] op_sel_hi:[1,0]
v_pk_fma_f32 v[74:75], v[64:65], v[150:151], v[74:75] op_sel:[0,1,0]
v_mul_f32 v151, 0x3de00000, v9
v_cos_f32 v150, v151
v_sin_f32 v151, v151
v_pk_mul_f32 v[64:65], v[128:129], v[148:149] op_sel_hi:[1,0]
v_pk_fma_f32 v[64:65], v[42:43], v[148:149], v[64:65] op_sel:[0,1,0] neg_lo:[1,0,0] neg_hi:[1,0,0]
v_pk_mul_f32 v[42:43], v[42:43], v[148:149] op_sel_hi:[1,0]
v_pk_fma_f32 v[42:43], v[128:129], v[148:149], v[42:43] op_sel:[0,1,0]
v_mul_f32 v149, 0x3e000000, v9
v_cos_f32 v148, v149
v_sin_f32 v149, v149
v_pk_mul_f32 v[128:129], v[72:73], v[150:151] op_sel_hi:[1,0]
v_pk_fma_f32 v[128:129], v[106:107], v[150:151], v[128:129] op_sel:[0,1,0] neg_lo:[1,0,0] neg_hi:[1,0,0]
v_pk_mul_f32 v[106:107], v[106:107], v[150:151] op_sel_hi:[1,0]
v_pk_fma_f32 v[106:107], v[72:73], v[150:151], v[106:107] op_sel:[0,1,0]
v_mul_f32 v151, 0x3e100000, v9
v_cos_f32 v150, v151
v_sin_f32 v151, v151
v_pk_mul_f32 v[72:73], v[40:41], v[148:149] op_sel_hi:[1,0]
v_pk_fma_f32 v[72:73], v[138:139], v[148:149], v[72:73] op_sel:[0,1,0] neg_lo:[1,0,0] neg_hi:[1,0,0]
v_pk_mul_f32 v[138:139], v[138:139], v[148:149] op_sel_hi:[1,0]
v_pk_fma_f32 v[138:139], v[40:41], v[148:149], v[138:139] op_sel:[0,1,0]
v_mul_f32 v149, 0x3e200000, v9
v_cos_f32 v148, v149
v_sin_f32 v149, v149
v_pk_mul_f32 v[40:41], v[104:105], v[150:151] op_sel_hi:[1,0]
v_pk_fma_f32 v[40:41], v[78:79], v[150:151], v[40:41] op_sel:[0,1,0] neg_lo:[1,0,0] neg_hi:[1,0,0]
v_pk_mul_f32 v[78:79], v[78:79], v[150:151] op_sel_hi:[1,0]
v_pk_fma_f32 v[78:79], v[104:105], v[150:151], v[78:79] op_sel:[0,1,0]
v_mul_f32 v151, 0x3e300000, v9
v_cos_f32 v150, v151
v_sin_f32 v151, v151
v_pk_mul_f32 v[104:105], v[136:137], v[148:149] op_sel_hi:[1,0]
v_pk_fma_f32 v[104:105], v[46:47], v[148:149], v[104:105] op_sel:[0,1,0] neg_lo:[1,0,0] neg_hi:[1,0,0]
v_pk_mul_f32 v[46:47], v[46:47], v[148:149] op_sel_hi:[1,0]
v_pk_fma_f32 v[46:47], v[136:137], v[148:149], v[46:47] op_sel:[0,1,0]
v_mul_f32 v149, 0x3e400000, v9
v_cos_f32 v148, v149
v_sin_f32 v149, v149
v_pk_mul_f32 v[136:137], v[76:77], v[150:151] op_sel_hi:[1,0]
v_pk_fma_f32 v[136:137], v[110:111], v[150:151], v[136:137] op_sel:[0,1,0] neg_lo:[1,0,0] neg_hi:[1,0,0]
v_pk_mul_f32 v[110:111], v[110:111], v[150:151] op_sel_hi:[1,0]
v_pk_fma_f32 v[110:111], v[76:77], v[150:151], v[110:111] op_sel:[0,1,0]
v_mul_f32 v151, 0x3e500000, v9
v_cos_f32 v150, v151
v_sin_f32 v151, v151
v_pk_mul_f32 v[76:77], v[44:45], v[148:149] op_sel_hi:[1,0]
v_pk_fma_f32 v[76:77], v[30:31], v[148:149], v[76:77] op_sel:[0,1,0] neg_lo:[1,0,0] neg_hi:[1,0,0]
v_pk_mul_f32 v[30:31], v[30:31], v[148:149] op_sel_hi:[1,0]
v_pk_fma_f32 v[30:31], v[44:45], v[148:149], v[30:31] op_sel:[0,1,0]
v_mul_f32 v149, 0x3e600000, v9
v_cos_f32 v148, v149
v_sin_f32 v149, v149
v_pk_mul_f32 v[44:45], v[108:109], v[150:151] op_sel_hi:[1,0]
v_pk_fma_f32 v[44:45], v[94:95], v[150:151], v[44:45] op_sel:[0,1,0] neg_lo:[1,0,0] neg_hi:[1,0,0]
v_pk_mul_f32 v[94:95], v[94:95], v[150:151] op_sel_hi:[1,0]
v_pk_fma_f32 v[94:95], v[108:109], v[150:151], v[94:95] op_sel:[0,1,0]
v_mul_f32 v151, 0x3e700000, v9
v_cos_f32 v150, v151
v_sin_f32 v151, v151
v_pk_mul_f32 v[108:109], v[28:29], v[148:149] op_sel_hi:[1,0]
v_pk_fma_f32 v[108:109], v[62:63], v[148:149], v[108:109] op_sel:[0,1,0] neg_lo:[1,0,0] neg_hi:[1,0,0]
v_pk_mul_f32 v[62:63], v[62:63], v[148:149] op_sel_hi:[1,0]
v_pk_fma_f32 v[62:63], v[28:29], v[148:149], v[62:63] op_sel:[0,1,0]
v_mul_f32 v149, 0x3e800000, v9
v_cos_f32 v148, v149
v_sin_f32 v149, v149
v_pk_mul_f32 v[28:29], v[92:93], v[150:151] op_sel_hi:[1,0]
v_pk_fma_f32 v[28:29], v[126:127], v[150:151], v[28:29] op_sel:[0,1,0] neg_lo:[1,0,0] neg_hi:[1,0,0]
v_pk_mul_f32 v[126:127], v[126:127], v[150:151] op_sel_hi:[1,0]
v_pk_fma_f32 v[126:127], v[92:93], v[150:151], v[126:127] op_sel:[0,1,0]
v_mul_f32 v151, 0x3e880000, v9
v_cos_f32 v150, v151
v_sin_f32 v151, v151
v_pk_mul_f32 v[92:93], v[60:61], v[148:149] op_sel_hi:[1,0]
v_pk_fma_f32 v[92:93], v[142:143], v[148:149], v[92:93] op_sel:[0,1,0] neg_lo:[1,0,0] neg_hi:[1,0,0]
v_pk_mul_f32 v[142:143], v[142:143], v[148:149] op_sel_hi:[1,0]
v_pk_fma_f32 v[142:143], v[60:61], v[148:149], v[142:143] op_sel:[0,1,0]
v_mul_f32 v149, 0x3e900000, v9
v_cos_f32 v148, v149
v_sin_f32 v149, v149
v_pk_mul_f32 v[60:61], v[124:125], v[150:151] op_sel_hi:[1,0]
v_pk_fma_f32 v[60:61], v[50:51], v[150:151], v[60:61] op_sel:[0,1,0] neg_lo:[1,0,0] neg_hi:[1,0,0]
v_pk_mul_f32 v[50:51], v[50:51], v[150:151] op_sel_hi:[1,0]
v_pk_fma_f32 v[50:51], v[124:125], v[150:151], v[50:51] op_sel:[0,1,0]
v_mul_f32 v151, 0x3e980000, v9
v_cos_f32 v150, v151
v_sin_f32 v151, v151
v_pk_mul_f32 v[124:125], v[140:141], v[148:149] op_sel_hi:[1,0]
v_pk_fma_f32 v[124:125], v[34:35], v[148:149], v[124:125] op_sel:[0,1,0] neg_lo:[1,0,0] neg_hi:[1,0,0]
v_pk_mul_f32 v[34:35], v[34:35], v[148:149] op_sel_hi:[1,0]
v_pk_fma_f32 v[34:35], v[140:141], v[148:149], v[34:35] op_sel:[0,1,0]
v_mul_f32 v149, 0x3ea00000, v9
v_cos_f32 v148, v149
v_sin_f32 v149, v149
v_pk_mul_f32 v[140:141], v[48:49], v[150:151] op_sel_hi:[1,0]
v_pk_fma_f32 v[140:141], v[98:99], v[150:151], v[140:141] op_sel:[0,1,0] neg_lo:[1,0,0] neg_hi:[1,0,0]
v_pk_mul_f32 v[98:99], v[98:99], v[150:151] op_sel_hi:[1,0]
v_pk_fma_f32 v[98:99], v[48:49], v[150:151], v[98:99] op_sel:[0,1,0]
v_mul_f32 v151, 0x3ea80000, v9
v_cos_f32 v150, v151
v_sin_f32 v151, v151
v_pk_mul_f32 v[48:49], v[32:33], v[148:149] op_sel_hi:[1,0]
v_pk_fma_f32 v[48:49], v[26:27], v[148:149], v[48:49] op_sel:[0,1,0] neg_lo:[1,0,0] neg_hi:[1,0,0]
v_pk_mul_f32 v[26:27], v[26:27], v[148:149] op_sel_hi:[1,0]
v_pk_fma_f32 v[26:27], v[32:33], v[148:149], v[26:27] op_sel:[0,1,0]
v_mul_f32 v149, 0x3eb00000, v9
v_cos_f32 v148, v149
v_sin_f32 v149, v149
v_pk_mul_f32 v[32:33], v[96:97], v[150:151] op_sel_hi:[1,0]
v_pk_fma_f32 v[32:33], v[90:91], v[150:151], v[32:33] op_sel:[0,1,0] neg_lo:[1,0,0] neg_hi:[1,0,0]
v_pk_mul_f32 v[90:91], v[90:91], v[150:151] op_sel_hi:[1,0]
v_pk_fma_f32 v[90:91], v[96:97], v[150:151], v[90:91] op_sel:[0,1,0]
v_mul_f32 v151, 0x3eb80000, v9
v_cos_f32 v150, v151
v_sin_f32 v151, v151
v_pk_mul_f32 v[96:97], v[24:25], v[148:149] op_sel_hi:[1,0]
v_pk_fma_f32 v[96:97], v[58:59], v[148:149], v[96:97] op_sel:[0,1,0] neg_lo:[1,0,0] neg_hi:[1,0,0]
v_pk_mul_f32 v[58:59], v[58:59], v[148:149] op_sel_hi:[1,0]
v_pk_fma_f32 v[58:59], v[24:25], v[148:149], v[58:59] op_sel:[0,1,0]
v_mul_f32 v149, 0x3ec00000, v9
v_cos_f32 v148, v149
v_sin_f32 v149, v149
v_pk_mul_f32 v[24:25], v[88:89], v[150:151] op_sel_hi:[1,0]
v_pk_fma_f32 v[24:25], v[122:123], v[150:151], v[24:25] op_sel:[0,1,0] neg_lo:[1,0,0] neg_hi:[1,0,0]
v_pk_mul_f32 v[122:123], v[122:123], v[150:151] op_sel_hi:[1,0]
v_pk_fma_f32 v[122:123], v[88:89], v[150:151], v[122:123] op_sel:[0,1,0]
v_mul_f32 v151, 0x3ec80000, v9
v_cos_f32 v150, v151
v_sin_f32 v151, v151
v_pk_mul_f32 v[88:89], v[56:57], v[148:149] op_sel_hi:[1,0]
v_pk_fma_f32 v[88:89], v[22:23], v[148:149], v[88:89] op_sel:[0,1,0] neg_lo:[1,0,0] neg_hi:[1,0,0]
v_pk_mul_f32 v[22:23], v[22:23], v[148:149] op_sel_hi:[1,0]
v_pk_fma_f32 v[22:23], v[56:57], v[148:149], v[22:23] op_sel:[0,1,0]
v_mul_f32 v149, 0x3ed00000, v9
v_cos_f32 v148, v149
v_sin_f32 v149, v149
v_pk_mul_f32 v[56:57], v[120:121], v[150:151] op_sel_hi:[1,0]
v_pk_fma_f32 v[56:57], v[86:87], v[150:151], v[56:57] op_sel:[0,1,0] neg_lo:[1,0,0] neg_hi:[1,0,0]
v_pk_mul_f32 v[86:87], v[86:87], v[150:151] op_sel_hi:[1,0]
v_pk_fma_f32 v[86:87], v[120:121], v[150:151], v[86:87] op_sel:[0,1,0]
v_mul_f32 v151, 0x3ed80000, v9
v_cos_f32 v150, v151
v_sin_f32 v151, v151
v_pk_mul_f32 v[120:121], v[20:21], v[148:149] op_sel_hi:[1,0]
v_pk_fma_f32 v[120:121], v[54:55], v[148:149], v[120:121] op_sel:[0,1,0] neg_lo:[1,0,0] neg_hi:[1,0,0]
v_pk_mul_f32 v[54:55], v[54:55], v[148:149] op_sel_hi:[1,0]
v_pk_fma_f32 v[54:55], v[20:21], v[148:149], v[54:55] op_sel:[0,1,0]
v_mul_f32 v149, 0x3ee00000, v9
v_cos_f32 v148, v149
v_sin_f32 v149, v149
v_pk_mul_f32 v[20:21], v[84:85], v[150:151] op_sel_hi:[1,0]
v_pk_fma_f32 v[20:21], v[118:119], v[150:151], v[20:21] op_sel:[0,1,0] neg_lo:[1,0,0] neg_hi:[1,0,0]
v_pk_mul_f32 v[118:119], v[118:119], v[150:151] op_sel_hi:[1,0]
v_pk_fma_f32 v[118:119], v[84:85], v[150:151], v[118:119] op_sel:[0,1,0]
v_mul_f32 v151, 0x3ee80000, v9
v_cos_f32 v150, v151
v_sin_f32 v151, v151
v_pk_mul_f32 v[84:85], v[52:53], v[148:149] op_sel_hi:[1,0]
v_pk_fma_f32 v[84:85], v[38:39], v[148:149], v[84:85] op_sel:[0,1,0] neg_lo:[1,0,0] neg_hi:[1,0,0]
v_pk_mul_f32 v[38:39], v[38:39], v[148:149] op_sel_hi:[1,0]
v_pk_fma_f32 v[38:39], v[52:53], v[148:149], v[38:39] op_sel:[0,1,0]
v_mul_f32 v149, 0x3ef00000, v9
v_cos_f32 v148, v149
v_sin_f32 v149, v149
v_pk_mul_f32 v[52:53], v[116:117], v[150:151] op_sel_hi:[1,0]
v_pk_fma_f32 v[52:53], v[102:103], v[150:151], v[52:53] op_sel:[0,1,0] neg_lo:[1,0,0] neg_hi:[1,0,0]
v_pk_mul_f32 v[102:103], v[102:103], v[150:151] op_sel_hi:[1,0]
v_pk_fma_f32 v[102:103], v[116:117], v[150:151], v[102:103] op_sel:[0,1,0]
v_mul_f32 v151, 0x3ef80000, v9
v_cos_f32 v150, v151
v_sin_f32 v151, v151
v_pk_mul_f32 v[116:117], v[36:37], v[148:149] op_sel_hi:[1,0]
v_pk_fma_f32 v[116:117], v[70:71], v[148:149], v[116:117] op_sel:[0,1,0] neg_lo:[1,0,0] neg_hi:[1,0,0]
v_pk_mul_f32 v[70:71], v[70:71], v[148:149] op_sel_hi:[1,0]
v_pk_fma_f32 v[70:71], v[36:37], v[148:149], v[70:71] op_sel:[0,1,0]
s_nop 0
v_pk_mul_f32 v[36:37], v[100:101], v[150:151] op_sel_hi:[1,0]
v_pk_fma_f32 v[36:37], v[134:135], v[150:151], v[36:37] op_sel:[0,1,0] neg_lo:[1,0,0] neg_hi:[1,0,0]
v_pk_mul_f32 v[134:135], v[134:135], v[150:151] op_sel_hi:[1,0]
v_pk_fma_f32 v[134:135], v[100:101], v[150:151], v[134:135] op_sel:[0,1,0]
v_pk_add_f32 v[100:101], v[132:133], v[92:93] neg_lo:[0,1] neg_hi:[0,1]
v_pk_add_f32 v[82:83], v[18:19], v[142:143] neg_lo:[0,1] neg_hi:[0,1]
v_pk_add_f32 v[132:133], v[132:133], v[92:93]
v_pk_add_f32 v[18:19], v[18:19], v[142:143]
v_pk_add_f32 v[92:93], v[68:69], v[60:61] neg_lo:[0,1] neg_hi:[0,1]
v_pk_add_f32 v[142:143], v[146:147], v[50:51] neg_lo:[0,1] neg_hi:[0,1]
v_pk_add_f32 v[68:69], v[68:69], v[60:61]
v_pk_add_f32 v[146:147], v[146:147], v[50:51]
v_pk_mul_f32 v[60:61], v[92:93], s[30:31] op_sel_hi:[1,0]
v_pk_mul_f32 v[50:51], v[92:93], s[36:37] op_sel_hi:[1,0]
v_pk_fma_f32 v[60:61], v[142:143], s[36:37], v[60:61] op_sel_hi:[1,0,1] neg_lo:[0,1,0] neg_hi:[0,1,0]
v_pk_fma_f32 v[50:51], v[142:143], s[30:31], v[50:51] op_sel_hi:[1,0,1]
v_pk_add_f32 v[92:93], v[16:17], v[124:125] neg_lo:[0,1] neg_hi:[0,1]
v_pk_add_f32 v[142:143], v[114:115], v[34:35] neg_lo:[0,1] neg_hi:[0,1]
v_pk_add_f32 v[16:17], v[16:17], v[124:125]
v_pk_add_f32 v[114:115], v[114:115], v[34:35]
v_pk_mul_f32 v[124:125], v[92:93], s[30:31] op_sel:[0,1]
v_pk_mul_f32 v[34:35], v[92:93], s[34:35] op_sel:[0,1]
v_pk_fma_f32 v[124:125], v[142:143], s[34:35], v[124:125] op_sel:[0,1,0] neg_lo:[0,1,0] neg_hi:[0,1,0]
v_pk_fma_f32 v[34:35], v[142:143], s[30:31], v[34:35] op_sel:[0,1,0]
v_pk_add_f32 v[92:93], v[80:81], v[140:141] neg_lo:[0,1] neg_hi:[0,1]
v_pk_add_f32 v[142:143], v[66:67], v[98:99] neg_lo:[0,1] neg_hi:[0,1]
v_pk_add_f32 v[80:81], v[80:81], v[140:141]
v_pk_add_f32 v[66:67], v[66:67], v[98:99]
v_pk_mul_f32 v[140:141], v[92:93], s[32:33] op_sel_hi:[1,0]
v_pk_mul_f32 v[98:99], v[92:93], s[34:35] op_sel_hi:[1,0]
v_pk_fma_f32 v[140:141], v[142:143], s[34:35], v[140:141] op_sel_hi:[1,0,1] neg_lo:[0,1,0] neg_hi:[0,1,0]
v_pk_fma_f32 v[98:99], v[142:143], s[32:33], v[98:99] op_sel_hi:[1,0,1]
v_pk_add_f32 v[92:93], v[144:145], v[48:49] neg_lo:[0,1] neg_hi:[0,1]
v_pk_add_f32 v[142:143], v[130:131], v[26:27] neg_lo:[0,1] neg_hi:[0,1]
v_pk_add_f32 v[144:145], v[144:145], v[48:49]
v_pk_add_f32 v[130:131], v[130:131], v[26:27]
v_pk_mul_f32 v[48:49], v[92:93], s[32:33] op_sel:[0,1]
v_pk_mul_f32 v[26:27], v[92:93], s[32:33] op_sel:[0,1]
v_pk_fma_f32 v[48:49], v[142:143], s[32:33], v[48:49] op_sel:[0,1,0] neg_lo:[0,1,0] neg_hi:[0,1,0]
v_pk_fma_f32 v[26:27], v[142:143], s[32:33], v[26:27] op_sel:[0,1,0]
v_pk_add_f32 v[92:93], v[112:113], v[32:33] neg_lo:[0,1] neg_hi:[0,1]
v_pk_add_f32 v[142:143], v[74:75], v[90:91] neg_lo:[0,1] neg_hi:[0,1]
v_pk_add_f32 v[112:113], v[112:113], v[32:33]
v_pk_add_f32 v[74:75], v[74:75], v[90:91]
v_pk_mul_f32 v[32:33], v[92:93], s[34:35] op_sel_hi:[1,0]
v_pk_mul_f32 v[90:91], v[92:93], s[32:33] op_sel_hi:[1,0]
v_pk_fma_f32 v[32:33], v[142:143], s[32:33], v[32:33] op_sel_hi:[1,0,1] neg_lo:[0,1,0] neg_hi:[0,1,0]
v_pk_fma_f32 v[90:91], v[142:143], s[34:35], v[90:91] op_sel_hi:[1,0,1]
v_pk_add_f32 v[92:93], v[64:65], v[96:97] neg_lo:[0,1] neg_hi:[0,1]
v_pk_add_f32 v[142:143], v[42:43], v[58:59] neg_lo:[0,1] neg_hi:[0,1]
v_pk_add_f32 v[64:65], v[64:65], v[96:97]
v_pk_add_f32 v[42:43], v[42:43], v[58:59]
v_pk_mul_f32 v[96:97], v[92:93], s[34:35] op_sel:[0,1]
v_pk_mul_f32 v[58:59], v[92:93], s[30:31] op_sel:[0,1]
v_pk_fma_f32 v[96:97], v[142:143], s[30:31], v[96:97] op_sel:[0,1,0] neg_lo:[0,1,0] neg_hi:[0,1,0]
v_pk_fma_f32 v[58:59], v[142:143], s[34:35], v[58:59] op_sel:[0,1,0]
v_pk_add_f32 v[92:93], v[128:129], v[24:25] neg_lo:[0,1] neg_hi:[0,1]
v_pk_add_f32 v[142:143], v[106:107], v[122:123] neg_lo:[0,1] neg_hi:[0,1]
v_pk_add_f32 v[128:129], v[128:129], v[24:25]
v_pk_add_f32 v[106:107], v[106:107], v[122:123]
v_pk_mul_f32 v[24:25], v[92:93], s[36:37] op_sel_hi:[1,0]
v_pk_mul_f32 v[122:123], v[92:93], s[30:31] op_sel_hi:[1,0]
v_pk_fma_f32 v[24:25], v[142:143], s[30:31], v[24:25] op_sel_hi:[1,0,1] neg_lo:[0,1,0] neg_hi:[0,1,0]
v_pk_fma_f32 v[122:123], v[142:143], s[36:37], v[122:123] op_sel_hi:[1,0,1]
v_pk_add_f32 v[92:93], v[22:23], v[138:139] neg_lo:[0,1] neg_hi:[0,1]
v_pk_add_f32 v[142:143], v[72:73], v[88:89] neg_lo:[0,1] neg_hi:[0,1]
v_pk_add_f32 v[72:73], v[72:73], v[88:89]
v_pk_add_f32 v[138:139], v[138:139], v[22:23]
v_pk_add_f32 v[88:89], v[40:41], v[56:57] neg_lo:[0,1] neg_hi:[0,1]
v_pk_add_f32 v[22:23], v[78:79], v[86:87] neg_lo:[0,1] neg_hi:[0,1]
v_pk_add_f32 v[40:41], v[40:41], v[56:57]
v_pk_add_f32 v[78:79], v[78:79], v[86:87]
v_pk_mul_f32 v[56:57], v[88:89], s[36:37] op_sel_hi:[1,0] neg_lo:[0,1] neg_hi:[0,1]
v_pk_mul_f32 v[86:87], v[88:89], s[30:31] op_sel_hi:[1,0]
v_pk_fma_f32 v[56:57], v[22:23], s[30:31], v[56:57] op_sel_hi:[1,0,1] neg_lo:[0,1,0] neg_hi:[0,1,0]
v_pk_fma_f32 v[86:87], v[22:23], s[36:37], v[86:87] op_sel_hi:[1,0,1] neg_lo:[0,1,0] neg_hi:[0,1,0]
v_pk_add_f32 v[88:89], v[104:105], v[120:121] neg_lo:[0,1] neg_hi:[0,1]
v_pk_add_f32 v[22:23], v[46:47], v[54:55] neg_lo:[0,1] neg_hi:[0,1]
v_pk_add_f32 v[104:105], v[104:105], v[120:121]
v_pk_add_f32 v[46:47], v[46:47], v[54:55]
v_pk_mul_f32 v[120:121], v[88:89], s[34:35] op_sel:[0,1] neg_lo:[0,1] neg_hi:[0,1]
v_pk_mul_f32 v[54:55], v[88:89], s[30:31] op_sel:[0,1]
v_pk_fma_f32 v[120:121], v[22:23], s[30:31], v[120:121] op_sel:[0,1,0] neg_lo:[0,1,0] neg_hi:[0,1,0]
v_pk_fma_f32 v[54:55], v[22:23], s[34:35], v[54:55] op_sel:[0,1,0] neg_lo:[0,1,0] neg_hi:[0,1,0]
v_pk_add_f32 v[88:89], v[136:137], v[20:21] neg_lo:[0,1] neg_hi:[0,1]
v_pk_add_f32 v[22:23], v[110:111], v[118:119] neg_lo:[0,1] neg_hi:[0,1]
v_pk_add_f32 v[136:137], v[136:137], v[20:21]
v_pk_add_f32 v[110:111], v[110:111], v[118:119]
v_pk_mul_f32 v[20:21], v[88:89], s[34:35] op_sel_hi:[1,0] neg_lo:[0,1] neg_hi:[0,1]
v_pk_mul_f32 v[118:119], v[88:89], s[32:33] op_sel_hi:[1,0]
v_pk_fma_f32 v[20:21], v[22:23], s[32:33], v[20:21] op_sel_hi:[1,0,1] neg_lo:[0,1,0] neg_hi:[0,1,0]
v_pk_fma_f32 v[118:119], v[22:23], s[34:35], v[118:119] op_sel_hi:[1,0,1] neg_lo:[0,1,0] neg_hi:[0,1,0]
v_pk_add_f32 v[88:89], v[76:77], v[84:85] neg_lo:[0,1] neg_hi:[0,1]
v_pk_add_f32 v[22:23], v[30:31], v[38:39] neg_lo:[0,1] neg_hi:[0,1]
v_pk_add_f32 v[76:77], v[76:77], v[84:85]
v_pk_add_f32 v[30:31], v[30:31], v[38:39]
v_pk_mul_f32 v[84:85], v[88:89], s[32:33] op_sel:[0,1] neg_lo:[0,1] neg_hi:[0,1]
v_pk_mul_f32 v[38:39], v[88:89], s[32:33] op_sel:[0,1]
v_pk_fma_f32 v[84:85], v[22:23], s[32:33], v[84:85] op_sel:[0,1,0] neg_lo:[0,1,0] neg_hi:[0,1,0]
v_pk_fma_f32 v[38:39], v[22:23], s[32:33], v[38:39] op_sel:[0,1,0] neg_lo:[0,1,0] neg_hi:[0,1,0]
v_pk_add_f32 v[88:89], v[44:45], v[52:53] neg_lo:[0,1] neg_hi:[0,1]
v_pk_add_f32 v[22:23], v[94:95], v[102:103] neg_lo:[0,1] neg_hi:[0,1]
v_pk_add_f32 v[44:45], v[44:45], v[52:53]
v_pk_add_f32 v[94:95], v[94:95], v[102:103]
v_pk_mul_f32 v[52:53], v[88:89], s[32:33] op_sel_hi:[1,0] neg_lo:[0,1] neg_hi:[0,1]
v_pk_mul_f32 v[102:103], v[88:89], s[34:35] op_sel_hi:[1,0]
v_pk_fma_f32 v[52:53], v[22:23], s[34:35], v[52:53] op_sel_hi:[1,0,1] neg_lo:[0,1,0] neg_hi:[0,1,0]
v_pk_fma_f32 v[102:103], v[22:23], s[32:33], v[102:103] op_sel_hi:[1,0,1] neg_lo:[0,1,0] neg_hi:[0,1,0]
v_pk_add_f32 v[88:89], v[108:109], v[116:117] neg_lo:[0,1] neg_hi:[0,1]
v_pk_add_f32 v[22:23], v[62:63], v[70:71] neg_lo:[0,1] neg_hi:[0,1]
v_pk_add_f32 v[108:109], v[108:109], v[116:117]
v_pk_add_f32 v[62:63], v[62:63], v[70:71]
v_pk_mul_f32 v[116:117], v[88:89], s[30:31] op_sel:[0,1] neg_lo:[0,1] neg_hi:[0,1]
v_pk_mul_f32 v[70:71], v[88:89], s[34:35] op_sel:[0,1]
v_pk_fma_f32 v[116:117], v[22:23], s[34:35], v[116:117] op_sel:[0,1,0] neg_lo:[0,1,0] neg_hi:[0,1,0]
v_pk_fma_f32 v[70:71], v[22:23], s[30:31], v[70:71] op_sel:[0,1,0] neg_lo:[0,1,0] neg_hi:[0,1,0]
v_pk_add_f32 v[88:89], v[28:29], v[36:37] neg_lo:[0,1] neg_hi:[0,1]
v_pk_add_f32 v[22:23], v[126:127], v[134:135] neg_lo:[0,1] neg_hi:[0,1]
v_pk_add_f32 v[28:29], v[28:29], v[36:37]
v_pk_add_f32 v[126:127], v[126:127], v[134:135]
v_pk_mul_f32 v[36:37], v[88:89], s[30:31] op_sel_hi:[1,0] neg_lo:[0,1] neg_hi:[0,1]
v_pk_mul_f32 v[134:135], v[88:89], s[36:37] op_sel_hi:[1,0]
v_pk_fma_f32 v[36:37], v[22:23], s[36:37], v[36:37] op_sel_hi:[1,0,1] neg_lo:[0,1,0] neg_hi:[0,1,0]
v_pk_fma_f32 v[134:135], v[22:23], s[30:31], v[134:135] op_sel_hi:[1,0,1] neg_lo:[0,1,0] neg_hi:[0,1,0]
v_pk_add_f32 v[88:89], v[132:133], v[72:73] neg_lo:[0,1] neg_hi:[0,1]
v_pk_add_f32 v[22:23], v[18:19], v[138:139] neg_lo:[0,1] neg_hi:[0,1]
v_pk_add_f32 v[132:133], v[132:133], v[72:73]
v_pk_add_f32 v[18:19], v[18:19], v[138:139]
v_pk_add_f32 v[72:73], v[68:69], v[40:41] neg_lo:[0,1] neg_hi:[0,1]
v_pk_add_f32 v[138:139], v[146:147], v[78:79] neg_lo:[0,1] neg_hi:[0,1]
v_pk_add_f32 v[68:69], v[68:69], v[40:41]
v_pk_add_f32 v[146:147], v[146:147], v[78:79]
v_pk_mul_f32 v[40:41], v[72:73], s[30:31] op_sel:[0,1]
v_pk_mul_f32 v[78:79], v[72:73], s[34:35] op_sel:[0,1]
v_pk_fma_f32 v[40:41], v[138:139], s[34:35], v[40:41] op_sel:[0,1,0] neg_lo:[0,1,0] neg_hi:[0,1,0]
v_pk_fma_f32 v[78:79], v[138:139], s[30:31], v[78:79] op_sel:[0,1,0]
v_pk_add_f32 v[72:73], v[16:17], v[104:105] neg_lo:[0,1] neg_hi:[0,1]
v_pk_add_f32 v[138:139], v[114:115], v[46:47] neg_lo:[0,1] neg_hi:[0,1]
v_pk_add_f32 v[16:17], v[16:17], v[104:105]
v_pk_add_f32 v[114:115], v[114:115], v[46:47]
v_pk_mul_f32 v[104:105], v[72:73], s[32:33] op_sel:[0,1]
v_pk_mul_f32 v[46:47], v[72:73], s[32:33] op_sel:[0,1]
v_pk_fma_f32 v[104:105], v[138:139], s[32:33], v[104:105] op_sel:[0,1,0] neg_lo:[0,1,0] neg_hi:[0,1,0]
v_pk_fma_f32 v[46:47], v[138:139], s[32:33], v[46:47] op_sel:[0,1,0]
v_pk_add_f32 v[72:73], v[80:81], v[136:137] neg_lo:[0,1] neg_hi:[0,1]
v_pk_add_f32 v[138:139], v[66:67], v[110:111] neg_lo:[0,1] neg_hi:[0,1]
v_pk_add_f32 v[80:81], v[80:81], v[136:137]
v_pk_add_f32 v[66:67], v[66:67], v[110:111]
v_pk_mul_f32 v[136:137], v[72:73], s[34:35] op_sel:[0,1]
v_pk_mul_f32 v[110:111], v[72:73], s[30:31] op_sel:[0,1]
v_pk_fma_f32 v[136:137], v[138:139], s[30:31], v[136:137] op_sel:[0,1,0] neg_lo:[0,1,0] neg_hi:[0,1,0]
v_pk_fma_f32 v[110:111], v[138:139], s[34:35], v[110:111] op_sel:[0,1,0]
v_pk_add_f32 v[72:73], v[30:31], v[130:131] neg_lo:[0,1] neg_hi:[0,1]
v_pk_add_f32 v[138:139], v[144:145], v[76:77] neg_lo:[0,1] neg_hi:[0,1]
v_pk_add_f32 v[144:145], v[144:145], v[76:77]
v_pk_add_f32 v[130:131], v[130:131], v[30:31]
v_pk_add_f32 v[76:77], v[112:113], v[44:45] neg_lo:[0,1] neg_hi:[0,1]
v_pk_add_f32 v[30:31], v[74:75], v[94:95] neg_lo:[0,1] neg_hi:[0,1]
v_pk_add_f32 v[112:113], v[112:113], v[44:45]
v_pk_add_f32 v[74:75], v[74:75], v[94:95]
v_pk_mul_f32 v[44:45], v[76:77], s[34:35] op_sel:[0,1] neg_lo:[0,1] neg_hi:[0,1]
v_pk_mul_f32 v[94:95], v[76:77], s[30:31] op_sel:[0,1]
v_pk_fma_f32 v[44:45], v[30:31], s[30:31], v[44:45] op_sel:[0,1,0] neg_lo:[0,1,0] neg_hi:[0,1,0]
v_pk_fma_f32 v[94:95], v[30:31], s[34:35], v[94:95] op_sel:[0,1,0] neg_lo:[0,1,0] neg_hi:[0,1,0]
v_pk_add_f32 v[76:77], v[64:65], v[108:109] neg_lo:[0,1] neg_hi:[0,1]
v_pk_add_f32 v[30:31], v[42:43], v[62:63] neg_lo:[0,1] neg_hi:[0,1]
v_pk_add_f32 v[64:65], v[64:65], v[108:109]
v_pk_add_f32 v[42:43], v[42:43], v[62:63]
v_pk_mul_f32 v[108:109], v[76:77], s[32:33] op_sel:[0,1] neg_lo:[0,1] neg_hi:[0,1]
v_pk_mul_f32 v[62:63], v[76:77], s[32:33] op_sel:[0,1]
v_pk_fma_f32 v[108:109], v[30:31], s[32:33], v[108:109] op_sel:[0,1,0] neg_lo:[0,1,0] neg_hi:[0,1,0]
v_pk_fma_f32 v[62:63], v[30:31], s[32:33], v[62:63] op_sel:[0,1,0] neg_lo:[0,1,0] neg_hi:[0,1,0]
v_pk_add_f32 v[76:77], v[128:129], v[28:29] neg_lo:[0,1] neg_hi:[0,1]
v_pk_add_f32 v[30:31], v[106:107], v[126:127] neg_lo:[0,1] neg_hi:[0,1]
v_pk_add_f32 v[128:129], v[128:129], v[28:29]
v_pk_add_f32 v[106:107], v[106:107], v[126:127]
v_pk_mul_f32 v[28:29], v[76:77], s[30:31] op_sel:[0,1] neg_lo:[0,1] neg_hi:[0,1]
v_pk_mul_f32 v[126:127], v[76:77], s[34:35] op_sel:[0,1]
v_pk_fma_f32 v[28:29], v[30:31], s[34:35], v[28:29] op_sel:[0,1,0] neg_lo:[0,1,0] neg_hi:[0,1,0]
v_pk_fma_f32 v[126:127], v[30:31], s[30:31], v[126:127] op_sel:[0,1,0] neg_lo:[0,1,0] neg_hi:[0,1,0]
v_pk_add_f32 v[76:77], v[100:101], v[92:93] neg_lo:[0,1] neg_hi:[0,1]
v_pk_add_f32 v[30:31], v[82:83], v[142:143] neg_lo:[0,1] neg_hi:[0,1]
v_pk_add_f32 v[100:101], v[100:101], v[92:93]
v_pk_add_f32 v[82:83], v[82:83], v[142:143]
v_pk_add_f32 v[92:93], v[60:61], v[56:57] neg_lo:[0,1] neg_hi:[0,1]
v_pk_add_f32 v[142:143], v[50:51], v[86:87] neg_lo:[0,1] neg_hi:[0,1]
v_pk_add_f32 v[60:61], v[60:61], v[56:57]
v_pk_add_f32 v[50:51], v[50:51], v[86:87]
v_pk_mul_f32 v[56:57], v[92:93], s[30:31] op_sel:[0,1]
v_pk_mul_f32 v[86:87], v[92:93], s[34:35] op_sel:[0,1]
v_pk_fma_f32 v[56:57], v[142:143], s[34:35], v[56:57] op_sel:[0,1,0] neg_lo:[0,1,0] neg_hi:[0,1,0]
v_pk_fma_f32 v[86:87], v[142:143], s[30:31], v[86:87] op_sel:[0,1,0]
v_pk_add_f32 v[92:93], v[124:125], v[120:121] neg_lo:[0,1] neg_hi:[0,1]
v_pk_add_f32 v[142:143], v[34:35], v[54:55] neg_lo:[0,1] neg_hi:[0,1]
v_pk_add_f32 v[124:125], v[124:125], v[120:121]
v_pk_add_f32 v[34:35], v[34:35], v[54:55]
v_pk_mul_f32 v[120:121], v[92:93], s[32:33] op_sel:[0,1]
v_pk_mul_f32 v[54:55], v[92:93], s[32:33] op_sel:[0,1]
v_pk_fma_f32 v[120:121], v[142:143], s[32:33], v[120:121] op_sel:[0,1,0] neg_lo:[0,1,0] neg_hi:[0,1,0]
v_pk_fma_f32 v[54:55], v[142:143], s[32:33], v[54:55] op_sel:[0,1,0]
v_pk_add_f32 v[92:93], v[140:141], v[20:21] neg_lo:[0,1] neg_hi:[0,1]
v_pk_add_f32 v[142:143], v[98:99], v[118:119] neg_lo:[0,1] neg_hi:[0,1]
v_pk_add_f32 v[140:141], v[140:141], v[20:21]
v_pk_add_f32 v[98:99], v[98:99], v[118:119]
v_pk_mul_f32 v[20:21], v[92:93], s[34:35] op_sel:[0,1]
v_pk_mul_f32 v[118:119], v[92:93], s[30:31] op_sel:[0,1]
v_pk_fma_f32 v[20:21], v[142:143], s[30:31], v[20:21] op_sel:[0,1,0] neg_lo:[0,1,0] neg_hi:[0,1,0]
v_pk_fma_f32 v[118:119], v[142:143], s[34:35], v[118:119] op_sel:[0,1,0]
v_pk_add_f32 v[92:93], v[38:39], v[26:27] neg_lo:[0,1] neg_hi:[0,1]
v_pk_add_f32 v[142:143], v[48:49], v[84:85] neg_lo:[0,1] neg_hi:[0,1]
v_pk_add_f32 v[48:49], v[48:49], v[84:85]
v_pk_add_f32 v[26:27], v[26:27], v[38:39]
v_pk_add_f32 v[84:85], v[32:33], v[52:53] neg_lo:[0,1] neg_hi:[0,1]
v_pk_add_f32 v[38:39], v[90:91], v[102:103] neg_lo:[0,1] neg_hi:[0,1]
v_pk_add_f32 v[32:33], v[32:33], v[52:53]
v_pk_add_f32 v[90:91], v[90:91], v[102:103]
v_pk_mul_f32 v[52:53], v[84:85], s[34:35] op_sel:[0,1] neg_lo:[0,1] neg_hi:[0,1]
v_pk_mul_f32 v[102:103], v[84:85], s[30:31] op_sel:[0,1]
v_pk_fma_f32 v[52:53], v[38:39], s[30:31], v[52:53] op_sel:[0,1,0] neg_lo:[0,1,0] neg_hi:[0,1,0]
v_pk_fma_f32 v[102:103], v[38:39], s[34:35], v[102:103] op_sel:[0,1,0] neg_lo:[0,1,0] neg_hi:[0,1,0]
v_pk_add_f32 v[84:85], v[96:97], v[116:117] neg_lo:[0,1] neg_hi:[0,1]
v_pk_add_f32 v[38:39], v[58:59], v[70:71] neg_lo:[0,1] neg_hi:[0,1]
v_pk_add_f32 v[96:97], v[96:97], v[116:117]
v_pk_add_f32 v[58:59], v[58:59], v[70:71]
v_pk_mul_f32 v[116:117], v[84:85], s[32:33] op_sel:[0,1] neg_lo:[0,1] neg_hi:[0,1]
v_pk_mul_f32 v[70:71], v[84:85], s[32:33] op_sel:[0,1]
v_pk_fma_f32 v[116:117], v[38:39], s[32:33], v[116:117] op_sel:[0,1,0] neg_lo:[0,1,0] neg_hi:[0,1,0]
v_pk_fma_f32 v[70:71], v[38:39], s[32:33], v[70:71] op_sel:[0,1,0] neg_lo:[0,1,0] neg_hi:[0,1,0]
v_pk_add_f32 v[84:85], v[24:25], v[36:37] neg_lo:[0,1] neg_hi:[0,1]
v_pk_add_f32 v[38:39], v[122:123], v[134:135] neg_lo:[0,1] neg_hi:[0,1]
v_pk_add_f32 v[24:25], v[24:25], v[36:37]
v_pk_add_f32 v[122:123], v[122:123], v[134:135]
v_pk_mul_f32 v[36:37], v[84:85], s[30:31] op_sel:[0,1] neg_lo:[0,1] neg_hi:[0,1]
v_pk_mul_f32 v[134:135], v[84:85], s[34:35] op_sel:[0,1]
v_pk_fma_f32 v[36:37], v[38:39], s[34:35], v[36:37] op_sel:[0,1,0] neg_lo:[0,1,0] neg_hi:[0,1,0]
v_pk_fma_f32 v[134:135], v[38:39], s[30:31], v[134:135] op_sel:[0,1,0] neg_lo:[0,1,0] neg_hi:[0,1,0]
v_pk_add_f32 v[84:85], v[132:133], v[144:145] neg_lo:[0,1] neg_hi:[0,1]
v_pk_add_f32 v[38:39], v[18:19], v[130:131] neg_lo:[0,1] neg_hi:[0,1]
v_pk_add_f32 v[132:133], v[132:133], v[144:145]
v_pk_add_f32 v[18:19], v[18:19], v[130:131]
v_pk_add_f32 v[144:145], v[68:69], v[112:113] neg_lo:[0,1] neg_hi:[0,1]
v_pk_add_f32 v[130:131], v[146:147], v[74:75] neg_lo:[0,1] neg_hi:[0,1]
v_pk_add_f32 v[68:69], v[68:69], v[112:113]
v_pk_add_f32 v[146:147], v[146:147], v[74:75]
v_pk_mul_f32 v[112:113], v[144:145], s[32:33] op_sel:[0,1]
v_pk_mul_f32 v[74:75], v[144:145], s[32:33] op_sel:[0,1]
v_pk_fma_f32 v[112:113], v[130:131], s[32:33], v[112:113] op_sel:[0,1,0] neg_lo:[0,1,0] neg_hi:[0,1,0]
v_pk_fma_f32 v[74:75], v[130:131], s[32:33], v[74:75] op_sel:[0,1,0]
v_pk_add_f32 v[144:145], v[42:43], v[114:115] neg_lo:[0,1] neg_hi:[0,1]
v_pk_add_f32 v[130:131], v[16:17], v[64:65] neg_lo:[0,1] neg_hi:[0,1]
v_pk_add_f32 v[16:17], v[16:17], v[64:65]
v_pk_add_f32 v[114:115], v[114:115], v[42:43]
v_pk_add_f32 v[64:65], v[80:81], v[128:129] neg_lo:[0,1] neg_hi:[0,1]
v_pk_add_f32 v[42:43], v[66:67], v[106:107] neg_lo:[0,1] neg_hi:[0,1]
v_pk_add_f32 v[80:81], v[80:81], v[128:129]
v_pk_add_f32 v[66:67], v[66:67], v[106:107]
v_pk_mul_f32 v[128:129], v[64:65], s[32:33] op_sel:[0,1] neg_lo:[0,1] neg_hi:[0,1]
v_pk_mul_f32 v[106:107], v[64:65], s[32:33] op_sel:[0,1]
v_pk_fma_f32 v[128:129], v[42:43], s[32:33], v[128:129] op_sel:[0,1,0] neg_lo:[0,1,0] neg_hi:[0,1,0]
v_pk_fma_f32 v[106:107], v[42:43], s[32:33], v[106:107] op_sel:[0,1,0] neg_lo:[0,1,0] neg_hi:[0,1,0]
v_pk_add_f32 v[64:65], v[88:89], v[72:73] neg_lo:[0,1] neg_hi:[0,1]
v_pk_add_f32 v[42:43], v[22:23], v[138:139] neg_lo:[0,1] neg_hi:[0,1]
v_pk_add_f32 v[88:89], v[88:89], v[72:73]
v_pk_add_f32 v[22:23], v[22:23], v[138:139]
v_pk_add_f32 v[72:73], v[40:41], v[44:45] neg_lo:[0,1] neg_hi:[0,1]
v_pk_add_f32 v[138:139], v[78:79], v[94:95] neg_lo:[0,1] neg_hi:[0,1]
v_pk_add_f32 v[40:41], v[40:41], v[44:45]
v_pk_add_f32 v[78:79], v[78:79], v[94:95]
v_pk_mul_f32 v[44:45], v[72:73], s[32:33] op_sel:[0,1]
v_pk_mul_f32 v[94:95], v[72:73], s[32:33] op_sel:[0,1]
v_pk_fma_f32 v[44:45], v[138:139], s[32:33], v[44:45] op_sel:[0,1,0] neg_lo:[0,1,0] neg_hi:[0,1,0]
v_pk_fma_f32 v[94:95], v[138:139], s[32:33], v[94:95] op_sel:[0,1,0]
v_pk_add_f32 v[72:73], v[62:63], v[46:47] neg_lo:[0,1] neg_hi:[0,1]
v_pk_add_f32 v[138:139], v[104:105], v[108:109] neg_lo:[0,1] neg_hi:[0,1]
v_pk_add_f32 v[104:105], v[104:105], v[108:109]
v_pk_add_f32 v[46:47], v[46:47], v[62:63]
v_pk_add_f32 v[108:109], v[136:137], v[28:29] neg_lo:[0,1] neg_hi:[0,1]
v_pk_add_f32 v[62:63], v[110:111], v[126:127] neg_lo:[0,1] neg_hi:[0,1]
v_pk_add_f32 v[136:137], v[136:137], v[28:29]
v_pk_add_f32 v[110:111], v[110:111], v[126:127]
v_pk_mul_f32 v[28:29], v[108:109], s[32:33] op_sel:[0,1] neg_lo:[0,1] neg_hi:[0,1]
v_pk_mul_f32 v[126:127], v[108:109], s[32:33] op_sel:[0,1]
v_pk_fma_f32 v[28:29], v[62:63], s[32:33], v[28:29] op_sel:[0,1,0] neg_lo:[0,1,0] neg_hi:[0,1,0]
v_pk_fma_f32 v[126:127], v[62:63], s[32:33], v[126:127] op_sel:[0,1,0] neg_lo:[0,1,0] neg_hi:[0,1,0]
v_pk_add_f32 v[108:109], v[100:101], v[48:49] neg_lo:[0,1] neg_hi:[0,1]
v_pk_add_f32 v[62:63], v[82:83], v[26:27] neg_lo:[0,1] neg_hi:[0,1]
v_pk_add_f32 v[100:101], v[100:101], v[48:49]
v_pk_add_f32 v[82:83], v[82:83], v[26:27]
v_pk_add_f32 v[48:49], v[60:61], v[32:33] neg_lo:[0,1] neg_hi:[0,1]
v_pk_add_f32 v[26:27], v[50:51], v[90:91] neg_lo:[0,1] neg_hi:[0,1]
v_pk_add_f32 v[60:61], v[60:61], v[32:33]
v_pk_add_f32 v[50:51], v[50:51], v[90:91]
v_pk_mul_f32 v[32:33], v[48:49], s[32:33] op_sel:[0,1]
v_pk_mul_f32 v[90:91], v[48:49], s[32:33] op_sel:[0,1]
v_pk_fma_f32 v[32:33], v[26:27], s[32:33], v[32:33] op_sel:[0,1,0] neg_lo:[0,1,0] neg_hi:[0,1,0]
v_pk_fma_f32 v[90:91], v[26:27], s[32:33], v[90:91] op_sel:[0,1,0]
v_pk_add_f32 v[48:49], v[58:59], v[34:35] neg_lo:[0,1] neg_hi:[0,1]
v_pk_add_f32 v[26:27], v[124:125], v[96:97] neg_lo:[0,1] neg_hi:[0,1]
v_pk_add_f32 v[124:125], v[124:125], v[96:97]
v_pk_add_f32 v[34:35], v[34:35], v[58:59]
v_pk_add_f32 v[96:97], v[140:141], v[24:25] neg_lo:[0,1] neg_hi:[0,1]
v_pk_add_f32 v[58:59], v[98:99], v[122:123] neg_lo:[0,1] neg_hi:[0,1]
v_pk_add_f32 v[140:141], v[140:141], v[24:25]
v_pk_add_f32 v[98:99], v[98:99], v[122:123]
v_pk_mul_f32 v[24:25], v[96:97], s[32:33] op_sel:[0,1] neg_lo:[0,1] neg_hi:[0,1]
v_pk_mul_f32 v[122:123], v[96:97], s[32:33] op_sel:[0,1]
v_pk_fma_f32 v[24:25], v[58:59], s[32:33], v[24:25] op_sel:[0,1,0] neg_lo:[0,1,0] neg_hi:[0,1,0]
v_pk_fma_f32 v[122:123], v[58:59], s[32:33], v[122:123] op_sel:[0,1,0] neg_lo:[0,1,0] neg_hi:[0,1,0]
v_pk_add_f32 v[96:97], v[76:77], v[92:93] neg_lo:[0,1] neg_hi:[0,1]
v_pk_add_f32 v[58:59], v[30:31], v[142:143] neg_lo:[0,1] neg_hi:[0,1]
v_pk_add_f32 v[76:77], v[76:77], v[92:93]
v_pk_add_f32 v[30:31], v[30:31], v[142:143]
v_pk_add_f32 v[92:93], v[56:57], v[52:53] neg_lo:[0,1] neg_hi:[0,1]
v_pk_add_f32 v[142:143], v[86:87], v[102:103] neg_lo:[0,1] neg_hi:[0,1]
v_pk_add_f32 v[56:57], v[56:57], v[52:53]
v_pk_add_f32 v[86:87], v[86:87], v[102:103]
v_pk_mul_f32 v[52:53], v[92:93], s[32:33] op_sel:[0,1]
v_pk_mul_f32 v[102:103], v[92:93], s[32:33] op_sel:[0,1]
v_pk_fma_f32 v[52:53], v[142:143], s[32:33], v[52:53] op_sel:[0,1,0] neg_lo:[0,1,0] neg_hi:[0,1,0]
v_pk_fma_f32 v[102:103], v[142:143], s[32:33], v[102:103] op_sel:[0,1,0]
v_pk_add_f32 v[92:93], v[70:71], v[54:55] neg_lo:[0,1] neg_hi:[0,1]
v_pk_add_f32 v[142:143], v[120:121], v[116:117] neg_lo:[0,1] neg_hi:[0,1]
v_pk_add_f32 v[120:121], v[120:121], v[116:117]
v_pk_add_f32 v[54:55], v[54:55], v[70:71]
v_pk_add_f32 v[116:117], v[20:21], v[36:37] neg_lo:[0,1] neg_hi:[0,1]
v_pk_add_f32 v[70:71], v[118:119], v[134:135] neg_lo:[0,1] neg_hi:[0,1]
v_pk_add_f32 v[20:21], v[20:21], v[36:37]
v_pk_add_f32 v[118:119], v[118:119], v[134:135]
v_pk_mul_f32 v[36:37], v[116:117], s[32:33] op_sel:[0,1] neg_lo:[0,1] neg_hi:[0,1]
v_pk_mul_f32 v[134:135], v[116:117], s[32:33] op_sel:[0,1]
v_pk_fma_f32 v[36:37], v[70:71], s[32:33], v[36:37] op_sel:[0,1,0] neg_lo:[0,1,0] neg_hi:[0,1,0]
v_pk_fma_f32 v[134:135], v[70:71], s[32:33], v[134:135] op_sel:[0,1,0] neg_lo:[0,1,0] neg_hi:[0,1,0]
v_pk_add_f32 v[116:117], v[132:133], v[16:17] neg_lo:[0,1] neg_hi:[0,1]
v_pk_add_f32 v[70:71], v[18:19], v[114:115] neg_lo:[0,1] neg_hi:[0,1]
v_pk_add_f32 v[132:133], v[132:133], v[16:17]
v_pk_add_f32 v[18:19], v[18:19], v[114:115]
v_pk_add_f32 v[16:17], v[66:67], v[146:147] neg_lo:[0,1] neg_hi:[0,1]
v_pk_add_f32 v[114:115], v[68:69], v[80:81] neg_lo:[0,1] neg_hi:[0,1]
v_pk_add_f32 v[68:69], v[68:69], v[80:81]
v_pk_add_f32 v[146:147], v[146:147], v[66:67]
v_pk_add_f32 v[80:81], v[84:85], v[144:145] neg_lo:[0,1] neg_hi:[0,1]
v_pk_add_f32 v[66:67], v[38:39], v[130:131] neg_lo:[0,1] neg_hi:[0,1]
v_pk_add_f32 v[84:85], v[84:85], v[144:145]
v_pk_add_f32 v[38:39], v[38:39], v[130:131]
v_pk_add_f32 v[144:145], v[106:107], v[74:75] neg_lo:[0,1] neg_hi:[0,1]
v_pk_add_f32 v[130:131], v[112:113], v[128:129] neg_lo:[0,1] neg_hi:[0,1]
v_pk_add_f32 v[112:113], v[112:113], v[128:129]
v_pk_add_f32 v[74:75], v[74:75], v[106:107]
v_pk_add_f32 v[128:129], v[88:89], v[104:105] neg_lo:[0,1] neg_hi:[0,1]
v_pk_add_f32 v[106:107], v[22:23], v[46:47] neg_lo:[0,1] neg_hi:[0,1]
v_pk_add_f32 v[88:89], v[88:89], v[104:105]
v_pk_add_f32 v[22:23], v[22:23], v[46:47]
v_pk_add_f32 v[104:105], v[110:111], v[78:79] neg_lo:[0,1] neg_hi:[0,1]
v_pk_add_f32 v[46:47], v[40:41], v[136:137] neg_lo:[0,1] neg_hi:[0,1]
v_pk_add_f32 v[40:41], v[40:41], v[136:137]
v_pk_add_f32 v[78:79], v[78:79], v[110:111]
v_pk_add_f32 v[136:137], v[64:65], v[72:73] neg_lo:[0,1] neg_hi:[0,1]
v_pk_add_f32 v[110:111], v[42:43], v[138:139] neg_lo:[0,1] neg_hi:[0,1]
v_pk_add_f32 v[64:65], v[64:65], v[72:73]
v_pk_add_f32 v[42:43], v[42:43], v[138:139]
v_pk_add_f32 v[72:73], v[126:127], v[94:95] neg_lo:[0,1] neg_hi:[0,1]
v_pk_add_f32 v[138:139], v[44:45], v[28:29] neg_lo:[0,1] neg_hi:[0,1]
v_pk_add_f32 v[44:45], v[44:45], v[28:29]
v_pk_add_f32 v[94:95], v[94:95], v[126:127]
v_pk_add_f32 v[28:29], v[100:101], v[124:125] neg_lo:[0,1] neg_hi:[0,1]
v_pk_add_f32 v[126:127], v[82:83], v[34:35] neg_lo:[0,1] neg_hi:[0,1]
v_pk_add_f32 v[100:101], v[100:101], v[124:125]
v_pk_add_f32 v[82:83], v[82:83], v[34:35]
v_pk_add_f32 v[124:125], v[98:99], v[50:51] neg_lo:[0,1] neg_hi:[0,1]
v_pk_add_f32 v[34:35], v[60:61], v[140:141] neg_lo:[0,1] neg_hi:[0,1]
v_pk_add_f32 v[60:61], v[60:61], v[140:141]
v_pk_add_f32 v[50:51], v[50:51], v[98:99]
v_pk_add_f32 v[140:141], v[108:109], v[48:49] neg_lo:[0,1] neg_hi:[0,1]
v_pk_add_f32 v[98:99], v[62:63], v[26:27] neg_lo:[0,1] neg_hi:[0,1]
v_pk_add_f32 v[108:109], v[108:109], v[48:49]
v_pk_add_f32 v[62:63], v[62:63], v[26:27]
v_pk_add_f32 v[48:49], v[122:123], v[90:91] neg_lo:[0,1] neg_hi:[0,1]
v_pk_add_f32 v[26:27], v[32:33], v[24:25] neg_lo:[0,1] neg_hi:[0,1]
v_pk_add_f32 v[32:33], v[32:33], v[24:25]
v_pk_add_f32 v[90:91], v[90:91], v[122:123]
v_pk_add_f32 v[24:25], v[76:77], v[120:121] neg_lo:[0,1] neg_hi:[0,1]
v_pk_add_f32 v[122:123], v[30:31], v[54:55] neg_lo:[0,1] neg_hi:[0,1]
v_pk_add_f32 v[76:77], v[76:77], v[120:121]
v_pk_add_f32 v[30:31], v[30:31], v[54:55]
v_pk_add_f32 v[120:121], v[118:119], v[86:87] neg_lo:[0,1] neg_hi:[0,1]
v_pk_add_f32 v[54:55], v[56:57], v[20:21] neg_lo:[0,1] neg_hi:[0,1]
v_pk_add_f32 v[56:57], v[56:57], v[20:21]
v_pk_add_f32 v[86:87], v[86:87], v[118:119]
v_pk_add_f32 v[20:21], v[96:97], v[92:93] neg_lo:[0,1] neg_hi:[0,1]
v_pk_add_f32 v[118:119], v[58:59], v[142:143] neg_lo:[0,1] neg_hi:[0,1]
v_pk_add_f32 v[96:97], v[96:97], v[92:93]
v_pk_add_f32 v[58:59], v[58:59], v[142:143]
v_pk_add_f32 v[92:93], v[134:135], v[102:103] neg_lo:[0,1] neg_hi:[0,1]
v_pk_add_f32 v[142:143], v[52:53], v[36:37] neg_lo:[0,1] neg_hi:[0,1]
v_pk_add_f32 v[52:53], v[52:53], v[36:37]
v_pk_add_f32 v[102:103], v[102:103], v[134:135]
v_pk_add_f32 v[36:37], v[132:133], v[68:69] neg_lo:[0,1] neg_hi:[0,1]
v_pk_add_f32 v[134:135], v[18:19], v[146:147] neg_lo:[0,1] neg_hi:[0,1]
v_pk_add_f32 v[132:133], v[132:133], v[68:69]
v_pk_add_f32 v[18:19], v[18:19], v[146:147]
v_pk_add_f32 v[68:69], v[116:117], v[16:17] neg_lo:[0,1] neg_hi:[0,1]
v_pk_add_f32 v[146:147], v[70:71], v[114:115] neg_lo:[0,1] neg_hi:[0,1]
v_pk_add_f32 v[116:117], v[116:117], v[16:17]
v_pk_add_f32 v[70:71], v[70:71], v[114:115]
v_pk_add_f32 v[16:17], v[84:85], v[112:113] neg_lo:[0,1] neg_hi:[0,1]
v_pk_add_f32 v[114:115], v[38:39], v[74:75] neg_lo:[0,1] neg_hi:[0,1]
v_pk_add_f32 v[84:85], v[84:85], v[112:113]
v_pk_add_f32 v[38:39], v[38:39], v[74:75]
v_pk_add_f32 v[112:113], v[80:81], v[144:145] neg_lo:[0,1] neg_hi:[0,1]
v_pk_add_f32 v[74:75], v[66:67], v[130:131] neg_lo:[0,1] neg_hi:[0,1]
v_pk_add_f32 v[80:81], v[80:81], v[144:145]
v_pk_add_f32 v[66:67], v[66:67], v[130:131]
v_pk_add_f32 v[144:145], v[88:89], v[40:41] neg_lo:[0,1] neg_hi:[0,1]
v_pk_add_f32 v[130:131], v[22:23], v[78:79] neg_lo:[0,1] neg_hi:[0,1]
v_pk_add_f32 v[88:89], v[88:89], v[40:41]
v_pk_add_f32 v[22:23], v[22:23], v[78:79]
v_pk_add_f32 v[40:41], v[128:129], v[104:105] neg_lo:[0,1] neg_hi:[0,1]
v_pk_add_f32 v[78:79], v[106:107], v[46:47] neg_lo:[0,1] neg_hi:[0,1]
v_pk_add_f32 v[128:129], v[128:129], v[104:105]
v_pk_add_f32 v[106:107], v[106:107], v[46:47]
v_pk_add_f32 v[104:105], v[64:65], v[44:45] neg_lo:[0,1] neg_hi:[0,1]
v_pk_add_f32 v[46:47], v[42:43], v[94:95] neg_lo:[0,1] neg_hi:[0,1]
v_pk_add_f32 v[64:65], v[64:65], v[44:45]
v_pk_add_f32 v[42:43], v[42:43], v[94:95]
v_pk_add_f32 v[44:45], v[136:137], v[72:73] neg_lo:[0,1] neg_hi:[0,1]
v_pk_add_f32 v[94:95], v[110:111], v[138:139] neg_lo:[0,1] neg_hi:[0,1]
v_pk_add_f32 v[136:137], v[136:137], v[72:73]
v_pk_add_f32 v[110:111], v[110:111], v[138:139]
v_pk_add_f32 v[72:73], v[100:101], v[60:61] neg_lo:[0,1] neg_hi:[0,1]
v_pk_add_f32 v[138:139], v[82:83], v[50:51] neg_lo:[0,1] neg_hi:[0,1]
v_pk_add_f32 v[100:101], v[100:101], v[60:61]
v_pk_add_f32 v[82:83], v[82:83], v[50:51]
v_pk_add_f32 v[60:61], v[28:29], v[124:125] neg_lo:[0,1] neg_hi:[0,1]
v_pk_add_f32 v[50:51], v[126:127], v[34:35] neg_lo:[0,1] neg_hi:[0,1]
v_pk_add_f32 v[28:29], v[28:29], v[124:125]
v_pk_add_f32 v[126:127], v[126:127], v[34:35]
v_pk_add_f32 v[124:125], v[108:109], v[32:33] neg_lo:[0,1] neg_hi:[0,1]
v_pk_add_f32 v[34:35], v[62:63], v[90:91] neg_lo:[0,1] neg_hi:[0,1]
v_pk_add_f32 v[108:109], v[108:109], v[32:33]
v_pk_add_f32 v[62:63], v[62:63], v[90:91]
v_pk_add_f32 v[32:33], v[140:141], v[48:49] neg_lo:[0,1] neg_hi:[0,1]
v_pk_add_f32 v[90:91], v[98:99], v[26:27] neg_lo:[0,1] neg_hi:[0,1]
v_pk_add_f32 v[140:141], v[140:141], v[48:49]
v_pk_add_f32 v[98:99], v[98:99], v[26:27]
v_pk_add_f32 v[48:49], v[76:77], v[56:57] neg_lo:[0,1] neg_hi:[0,1]
v_pk_add_f32 v[26:27], v[30:31], v[86:87] neg_lo:[0,1] neg_hi:[0,1]
v_pk_add_f32 v[76:77], v[76:77], v[56:57]
v_pk_add_f32 v[30:31], v[30:31], v[86:87]
v_pk_add_f32 v[56:57], v[24:25], v[120:121] neg_lo:[0,1] neg_hi:[0,1]
v_pk_add_f32 v[86:87], v[122:123], v[54:55] neg_lo:[0,1] neg_hi:[0,1]
v_pk_add_f32 v[24:25], v[24:25], v[120:121]
v_pk_add_f32 v[122:123], v[122:123], v[54:55]
v_pk_add_f32 v[120:121], v[96:97], v[52:53] neg_lo:[0,1] neg_hi:[0,1]
v_pk_add_f32 v[54:55], v[58:59], v[102:103] neg_lo:[0,1] neg_hi:[0,1]
v_pk_add_f32 v[96:97], v[96:97], v[52:53]
v_pk_add_f32 v[58:59], v[58:59], v[102:103]
v_pk_add_f32 v[52:53], v[20:21], v[92:93] neg_lo:[0,1] neg_hi:[0,1]
v_pk_add_f32 v[102:103], v[118:119], v[142:143] neg_lo:[0,1] neg_hi:[0,1]
v_pk_add_f32 v[20:21], v[20:21], v[92:93]
v_pk_add_f32 v[118:119], v[118:119], v[142:143]
v_mul_f32 v12, v9, v8
v_mul_f32 v12, 0x3a000000, v12
v_fmamk_f32 v149, v8, 0x00000000, v12
v_cos_f32 v148, v149
v_sin_f32 v149, v149
v_fmamk_f32 v151, v8, 0x3a800000, v12
v_cos_f32 v150, v151
v_sin_f32 v151, v151
v_pk_mul_f32 v[92:93], v[132:133], v[148:149] op_sel_hi:[1,0]
v_pk_fma_f32 v[92:93], v[18:19], v[148:149], v[92:93] op_sel:[0,1,0] neg_lo:[1,0,0] neg_hi:[1,0,0]
v_pk_mul_f32 v[18:19], v[18:19], v[148:149] op_sel_hi:[1,0]
v_pk_fma_f32 v[18:19], v[132:133], v[148:149], v[18:19] op_sel:[0,1,0]
v_fmamk_f32 v149, v8, 0x3b000000, v12
v_cos_f32 v148, v149
v_sin_f32 v149, v149
v_pk_mul_f32 v[132:133], v[100:101], v[150:151] op_sel_hi:[1,0]
v_pk_fma_f32 v[132:133], v[82:83], v[150:151], v[132:133] op_sel:[0,1,0] neg_lo:[1,0,0] neg_hi:[1,0,0]
v_pk_mul_f32 v[82:83], v[82:83], v[150:151] op_sel_hi:[1,0]
v_pk_fma_f32 v[82:83], v[100:101], v[150:151], v[82:83] op_sel:[0,1,0]
v_fmamk_f32 v151, v8, 0x3b400000, v12
v_cos_f32 v150, v151
v_sin_f32 v151, v151
v_pk_mul_f32 v[100:101], v[88:89], v[148:149] op_sel_hi:[1,0]
v_pk_fma_f32 v[100:101], v[22:23], v[148:149], v[100:101] op_sel:[0,1,0] neg_lo:[1,0,0] neg_hi:[1,0,0]
v_pk_mul_f32 v[22:23], v[22:23], v[148:149] op_sel_hi:[1,0]
v_pk_fma_f32 v[22:23], v[88:89], v[148:149], v[22:23] op_sel:[0,1,0]
v_fmamk_f32 v149, v8, 0x3b800000, v12
v_cos_f32 v148, v149
v_sin_f32 v149, v149
v_pk_mul_f32 v[88:89], v[76:77], v[150:151] op_sel_hi:[1,0]
v_pk_fma_f32 v[88:89], v[30:31], v[150:151], v[88:89] op_sel:[0,1,0] neg_lo:[1,0,0] neg_hi:[1,0,0]
v_pk_mul_f32 v[30:31], v[30:31], v[150:151] op_sel_hi:[1,0]
v_pk_fma_f32 v[30:31], v[76:77], v[150:151], v[30:31] op_sel:[0,1,0]
v_fmamk_f32 v151, v8, 0x3ba00000, v12
v_cos_f32 v150, v151
v_sin_f32 v151, v151
v_pk_mul_f32 v[76:77], v[84:85], v[148:149] op_sel_hi:[1,0]
v_pk_fma_f32 v[76:77], v[38:39], v[148:149], v[76:77] op_sel:[0,1,0] neg_lo:[1,0,0] neg_hi:[1,0,0]
v_pk_mul_f32 v[38:39], v[38:39], v[148:149] op_sel_hi:[1,0]
v_pk_fma_f32 v[38:39], v[84:85], v[148:149], v[38:39] op_sel:[0,1,0]
v_fmamk_f32 v149, v8, 0x3bc00000, v12
v_cos_f32 v148, v149
v_sin_f32 v149, v149
v_pk_mul_f32 v[84:85], v[108:109], v[150:151] op_sel_hi:[1,0]
v_pk_fma_f32 v[84:85], v[62:63], v[150:151], v[84:85] op_sel:[0,1,0] neg_lo:[1,0,0] neg_hi:[1,0,0]
v_pk_mul_f32 v[62:63], v[62:63], v[150:151] op_sel_hi:[1,0]
v_pk_fma_f32 v[62:63], v[108:109], v[150:151], v[62:63] op_sel:[0,1,0]
v_fmamk_f32 v151, v8, 0x3be00000, v12
v_cos_f32 v150, v151
v_sin_f32 v151, v151
v_pk_mul_f32 v[108:109], v[64:65], v[148:149] op_sel_hi:[1,0]
v_pk_fma_f32 v[108:109], v[42:43], v[148:149], v[108:109] op_sel:[0,1,0] neg_lo:[1,0,0] neg_hi:[1,0,0]
v_pk_mul_f32 v[42:43], v[42:43], v[148:149] op_sel_hi:[1,0]
v_pk_fma_f32 v[42:43], v[64:65], v[148:149], v[42:43] op_sel:[0,1,0]
v_fmamk_f32 v149, v8, 0x3c000000, v12
v_cos_f32 v148, v149
v_sin_f32 v149, v149
v_pk_mul_f32 v[64:65], v[96:97], v[150:151] op_sel_hi:[1,0]
v_pk_fma_f32 v[64:65], v[58:59], v[150:151], v[64:65] op_sel:[0,1,0] neg_lo:[1,0,0] neg_hi:[1,0,0]
v_pk_mul_f32 v[58:59], v[58:59], v[150:151] op_sel_hi:[1,0]
v_pk_fma_f32 v[58:59], v[96:97], v[150:151], v[58:59] op_sel:[0,1,0]
v_fmamk_f32 v151, v8, 0x3c100000, v12
v_cos_f32 v150, v151
v_sin_f32 v151, v151
v_pk_mul_f32 v[96:97], v[116:117], v[148:149] op_sel_hi:[1,0]
v_pk_fma_f32 v[96:97], v[70:71], v[148:149], v[96:97] op_sel:[0,1,0] neg_lo:[1,0,0] neg_hi:[1,0,0]
v_pk_mul_f32 v[70:71], v[70:71], v[148:149] op_sel_hi:[1,0]
v_pk_fma_f32 v[70:71], v[116:117], v[148:149], v[70:71] op_sel:[0,1,0]
v_fmamk_f32 v149, v8, 0x3c200000, v12
v_cos_f32 v148, v149
v_sin_f32 v149, v149
v_pk_mul_f32 v[116:117], v[28:29], v[150:151] op_sel_hi:[1,0]
v_pk_fma_f32 v[116:117], v[126:127], v[150:151], v[116:117] op_sel:[0,1,0] neg_lo:[1,0,0] neg_hi:[1,0,0]
v_pk_mul_f32 v[126:127], v[126:127], v[150:151] op_sel_hi:[1,0]
v_pk_fma_f32 v[126:127], v[28:29], v[150:151], v[126:127] op_sel:[0,1,0]
v_fmamk_f32 v151, v8, 0x3c300000, v12
v_cos_f32 v150, v151
v_sin_f32 v151, v151
v_pk_mul_f32 v[28:29], v[128:129], v[148:149] op_sel_hi:[1,0]
v_pk_fma_f32 v[28:29], v[106:107], v[148:149], v[28:29] op_sel:[0,1,0] neg_lo:[1,0,0] neg_hi:[1,0,0]
v_pk_mul_f32 v[106:107], v[106:107], v[148:149] op_sel_hi:[1,0]
v_pk_fma_f32 v[106:107], v[128:129], v[148:149], v[106:107] op_sel:[0,1,0]
v_fmamk_f32 v149, v8, 0x3c400000, v12
v_cos_f32 v148, v149
v_sin_f32 v149, v149
v_pk_mul_f32 v[128:129], v[24:25], v[150:151] op_sel_hi:[1,0]
v_pk_fma_f32 v[128:129], v[122:123], v[150:151], v[128:129] op_sel:[0,1,0] neg_lo:[1,0,0] neg_hi:[1,0,0]
v_pk_mul_f32 v[122:123], v[122:123], v[150:151] op_sel_hi:[1,0]
v_pk_fma_f32 v[122:123], v[24:25], v[150:151], v[122:123] op_sel:[0,1,0]
v_fmamk_f32 v151, v8, 0x3c500000, v12
v_cos_f32 v150, v151
v_sin_f32 v151, v151
v_pk_mul_f32 v[24:25], v[80:81], v[148:149] op_sel_hi:[1,0]
v_pk_fma_f32 v[24:25], v[66:67], v[148:149], v[24:25] op_sel:[0,1,0] neg_lo:[1,0,0] neg_hi:[1,0,0]
v_pk_mul_f32 v[66:67], v[66:67], v[148:149] op_sel_hi:[1,0]
v_pk_fma_f32 v[66:67], v[80:81], v[148:149], v[66:67] op_sel:[0,1,0]
v_fmamk_f32 v149, v8, 0x3c600000, v12
v_cos_f32 v148, v149
v_sin_f32 v149, v149
v_pk_mul_f32 v[80:81], v[140:141], v[150:151] op_sel_hi:[1,0]
v_pk_fma_f32 v[80:81], v[98:99], v[150:151], v[80:81] op_sel:[0,1,0] neg_lo:[1,0,0] neg_hi:[1,0,0]
v_pk_mul_f32 v[98:99], v[98:99], v[150:151] op_sel_hi:[1,0]
v_pk_fma_f32 v[98:99], v[140:141], v[150:151], v[98:99] op_sel:[0,1,0]
v_fmamk_f32 v151, v8, 0x3c700000, v12
v_cos_f32 v150, v151
v_sin_f32 v151, v151
v_pk_mul_f32 v[140:141], v[136:137], v[148:149] op_sel_hi:[1,0]
v_pk_fma_f32 v[140:141], v[110:111], v[148:149], v[140:141] op_sel:[0,1,0] neg_lo:[1,0,0] neg_hi:[1,0,0]
v_pk_mul_f32 v[110:111], v[110:111], v[148:149] op_sel_hi:[1,0]
v_pk_fma_f32 v[110:111], v[136:137], v[148:149], v[110:111] op_sel:[0,1,0]
v_fmamk_f32 v149, v8, 0x3c800000, v12
v_cos_f32 v148, v149
v_sin_f32 v149, v149
v_pk_mul_f32 v[136:137], v[20:21], v[150:151] op_sel_hi:[1,0]
v_pk_fma_f32 v[136:137], v[118:119], v[150:151], v[136:137] op_sel:[0,1,0] neg_lo:[1,0,0] neg_hi:[1,0,0]
v_pk_mul_f32 v[118:119], v[118:119], v[150:151] op_sel_hi:[1,0]
v_pk_fma_f32 v[118:119], v[20:21], v[150:151], v[118:119] op_sel:[0,1,0]
v_fmamk_f32 v151, v8, 0x3c880000, v12
v_cos_f32 v150, v151
v_sin_f32 v151, v151
v_pk_mul_f32 v[20:21], v[36:37], v[148:149] op_sel_hi:[1,0]
v_pk_fma_f32 v[20:21], v[134:135], v[148:149], v[20:21] op_sel:[0,1,0] neg_lo:[1,0,0] neg_hi:[1,0,0]
v_pk_mul_f32 v[134:135], v[134:135], v[148:149] op_sel_hi:[1,0]
v_pk_fma_f32 v[134:135], v[36:37], v[148:149], v[134:135] op_sel:[0,1,0]
v_fmamk_f32 v149, v8, 0x3c900000, v12
v_cos_f32 v148, v149
v_sin_f32 v149, v149
v_pk_mul_f32 v[36:37], v[72:73], v[150:151] op_sel_hi:[1,0]
v_pk_fma_f32 v[36:37], v[138:139], v[150:151], v[36:37] op_sel:[0,1,0] neg_lo:[1,0,0] neg_hi:[1,0,0]
v_pk_mul_f32 v[138:139], v[138:139], v[150:151] op_sel_hi:[1,0]
v_pk_fma_f32 v[138:139], v[72:73], v[150:151], v[138:139] op_sel:[0,1,0]
v_fmamk_f32 v151, v8, 0x3c980000, v12
v_cos_f32 v150, v151
v_sin_f32 v151, v151
v_pk_mul_f32 v[72:73], v[144:145], v[148:149] op_sel_hi:[1,0]
v_pk_fma_f32 v[72:73], v[130:131], v[148:149], v[72:73] op_sel:[0,1,0] neg_lo:[1,0,0] neg_hi:[1,0,0]
v_pk_mul_f32 v[130:131], v[130:131], v[148:149] op_sel_hi:[1,0]
v_pk_fma_f32 v[130:131], v[144:145], v[148:149], v[130:131] op_sel:[0,1,0]
v_fmamk_f32 v149, v8, 0x3ca00000, v12
v_cos_f32 v148, v149
v_sin_f32 v149, v149
v_pk_mul_f32 v[144:145], v[48:49], v[150:151] op_sel_hi:[1,0]
v_pk_fma_f32 v[144:145], v[26:27], v[150:151], v[144:145] op_sel:[0,1,0] neg_lo:[1,0,0] neg_hi:[1,0,0]
v_pk_mul_f32 v[26:27], v[26:27], v[150:151] op_sel_hi:[1,0]
v_pk_fma_f32 v[26:27], v[48:49], v[150:151], v[26:27] op_sel:[0,1,0]
v_fmamk_f32 v151, v8, 0x3ca80000, v12
v_cos_f32 v150, v151
v_sin_f32 v151, v151
v_pk_mul_f32 v[48:49], v[16:17], v[148:149] op_sel_hi:[1,0]
v_pk_fma_f32 v[48:49], v[114:115], v[148:149], v[48:49] op_sel:[0,1,0] neg_lo:[1,0,0] neg_hi:[1,0,0]
v_pk_mul_f32 v[114:115], v[114:115], v[148:149] op_sel_hi:[1,0]
v_pk_fma_f32 v[114:115], v[16:17], v[148:149], v[114:115] op_sel:[0,1,0]
v_fmamk_f32 v149, v8, 0x3cb00000, v12
v_cos_f32 v148, v149
v_sin_f32 v149, v149
v_pk_mul_f32 v[16:17], v[124:125], v[150:151] op_sel_hi:[1,0]
v_pk_fma_f32 v[16:17], v[34:35], v[150:151], v[16:17] op_sel:[0,1,0] neg_lo:[1,0,0] neg_hi:[1,0,0]
v_pk_mul_f32 v[34:35], v[34:35], v[150:151] op_sel_hi:[1,0]
v_pk_fma_f32 v[34:35], v[124:125], v[150:151], v[34:35] op_sel:[0,1,0]
v_fmamk_f32 v151, v8, 0x3cb80000, v12
v_cos_f32 v150, v151
v_sin_f32 v151, v151
v_pk_mul_f32 v[124:125], v[104:105], v[148:149] op_sel_hi:[1,0]
v_pk_fma_f32 v[124:125], v[46:47], v[148:149], v[124:125] op_sel:[0,1,0] neg_lo:[1,0,0] neg_hi:[1,0,0]
v_pk_mul_f32 v[46:47], v[46:47], v[148:149] op_sel_hi:[1,0]
v_pk_fma_f32 v[46:47], v[104:105], v[148:149], v[46:47] op_sel:[0,1,0]
v_fmamk_f32 v149, v8, 0x3cc00000, v12
v_cos_f32 v148, v149
v_sin_f32 v149, v149
v_pk_mul_f32 v[104:105], v[120:121], v[150:151] op_sel_hi:[1,0]
v_pk_fma_f32 v[104:105], v[54:55], v[150:151], v[104:105] op_sel:[0,1,0] neg_lo:[1,0,0] neg_hi:[1,0,0]
v_pk_mul_f32 v[54:55], v[54:55], v[150:151] op_sel_hi:[1,0]
v_pk_fma_f32 v[54:55], v[120:121], v[150:151], v[54:55] op_sel:[0,1,0]
v_fmamk_f32 v151, v8, 0x3cc80000, v12
v_cos_f32 v150, v151
v_sin_f32 v151, v151
v_pk_mul_f32 v[120:121], v[68:69], v[148:149] op_sel_hi:[1,0]
v_pk_fma_f32 v[120:121], v[146:147], v[148:149], v[120:121] op_sel:[0,1,0] neg_lo:[1,0,0] neg_hi:[1,0,0]
v_pk_mul_f32 v[146:147], v[146:147], v[148:149] op_sel_hi:[1,0]
v_pk_fma_f32 v[146:147], v[68:69], v[148:149], v[146:147] op_sel:[0,1,0]
v_fmamk_f32 v149, v8, 0x3cd00000, v12
v_cos_f32 v148, v149
v_sin_f32 v149, v149
v_pk_mul_f32 v[68:69], v[60:61], v[150:151] op_sel_hi:[1,0]
v_pk_fma_f32 v[68:69], v[50:51], v[150:151], v[68:69] op_sel:[0,1,0] neg_lo:[1,0,0] neg_hi:[1,0,0]
v_pk_mul_f32 v[50:51], v[50:51], v[150:151] op_sel_hi:[1,0]
v_pk_fma_f32 v[50:51], v[60:61], v[150:151], v[50:51] op_sel:[0,1,0]
v_fmamk_f32 v151, v8, 0x3cd80000, v12
v_cos_f32 v150, v151
v_sin_f32 v151, v151
v_pk_mul_f32 v[60:61], v[40:41], v[148:149] op_sel_hi:[1,0]
v_pk_fma_f32 v[60:61], v[78:79], v[148:149], v[60:61] op_sel:[0,1,0] neg_lo:[1,0,0] neg_hi:[1,0,0]
v_pk_mul_f32 v[78:79], v[78:79], v[148:149] op_sel_hi:[1,0]
v_pk_fma_f32 v[78:79], v[40:41], v[148:149], v[78:79] op_sel:[0,1,0]
v_fmamk_f32 v149, v8, 0x3ce00000, v12
v_cos_f32 v148, v149
v_sin_f32 v149, v149
v_pk_mul_f32 v[40:41], v[56:57], v[150:151] op_sel_hi:[1,0]
v_pk_fma_f32 v[40:41], v[86:87], v[150:151], v[40:41] op_sel:[0,1,0] neg_lo:[1,0,0] neg_hi:[1,0,0]
v_pk_mul_f32 v[86:87], v[86:87], v[150:151] op_sel_hi:[1,0]
v_pk_fma_f32 v[86:87], v[56:57], v[150:151], v[86:87] op_sel:[0,1,0]
v_fmamk_f32 v151, v8, 0x3ce80000, v12
v_cos_f32 v150, v151
v_sin_f32 v151, v151
v_pk_mul_f32 v[56:57], v[112:113], v[148:149] op_sel_hi:[1,0]
v_pk_fma_f32 v[56:57], v[74:75], v[148:149], v[56:57] op_sel:[0,1,0] neg_lo:[1,0,0] neg_hi:[1,0,0]
v_pk_mul_f32 v[74:75], v[74:75], v[148:149] op_sel_hi:[1,0]
v_pk_fma_f32 v[74:75], v[112:113], v[148:149], v[74:75] op_sel:[0,1,0]
v_fmamk_f32 v149, v8, 0x3cf00000, v12
v_cos_f32 v148, v149
v_sin_f32 v149, v149
v_pk_mul_f32 v[112:113], v[32:33], v[150:151] op_sel_hi:[1,0]
v_pk_fma_f32 v[112:113], v[90:91], v[150:151], v[112:113] op_sel:[0,1,0] neg_lo:[1,0,0] neg_hi:[1,0,0]
v_pk_mul_f32 v[90:91], v[90:91], v[150:151] op_sel_hi:[1,0]
v_pk_fma_f32 v[90:91], v[32:33], v[150:151], v[90:91] op_sel:[0,1,0]
v_fmamk_f32 v151, v8, 0x3cf80000, v12
v_cos_f32 v150, v151
v_sin_f32 v151, v151
v_pk_mul_f32 v[32:33], v[44:45], v[148:149] op_sel_hi:[1,0]
v_pk_fma_f32 v[32:33], v[94:95], v[148:149], v[32:33] op_sel:[0,1,0] neg_lo:[1,0,0] neg_hi:[1,0,0]
v_pk_mul_f32 v[94:95], v[94:95], v[148:149] op_sel_hi:[1,0]
v_pk_fma_f32 v[94:95], v[44:45], v[148:149], v[94:95] op_sel:[0,1,0]
s_nop 0
v_pk_mul_f32 v[44:45], v[52:53], v[150:151] op_sel_hi:[1,0]
v_pk_fma_f32 v[44:45], v[102:103], v[150:151], v[44:45] op_sel:[0,1,0] neg_lo:[1,0,0] neg_hi:[1,0,0]
v_pk_mul_f32 v[102:103], v[102:103], v[150:151] op_sel_hi:[1,0]
v_pk_fma_f32 v[102:103], v[52:53], v[150:151], v[102:103] op_sel:[0,1,0]
ds_write_b64 v4, v[92:93]
ds_write_b64 v4, v[18:19] offset:8
ds_write_b64 v4, v[132:133] offset:32
ds_write_b64 v4, v[82:83] offset:40
ds_write_b64 v4, v[100:101] offset:64
ds_write_b64 v4, v[22:23] offset:72
ds_write_b64 v4, v[88:89] offset:96
ds_write_b64 v4, v[30:31] offset:104
ds_write_b64 v4, v[76:77] offset:128
ds_write_b64 v4, v[38:39] offset:136
ds_write_b64 v4, v[84:85] offset:160
ds_write_b64 v4, v[62:63] offset:168
ds_write_b64 v4, v[108:109] offset:192
ds_write_b64 v4, v[42:43] offset:200
ds_write_b64 v4, v[64:65] offset:224
ds_write_b64 v4, v[58:59] offset:232
ds_write_b64 v4, v[96:97] offset:256
ds_write_b64 v4, v[70:71] offset:264
ds_write_b64 v4, v[116:117] offset:288
ds_write_b64 v4, v[126:127] offset:296
ds_write_b64 v4, v[28:29] offset:320
ds_write_b64 v4, v[106:107] offset:328
ds_write_b64 v4, v[128:129] offset:352
ds_write_b64 v4, v[122:123] offset:360
ds_write_b64 v4, v[24:25] offset:384
ds_write_b64 v4, v[66:67] offset:392
ds_write_b64 v4, v[80:81] offset:416
ds_write_b64 v4, v[98:99] offset:424
ds_write_b64 v4, v[140:141] offset:448
ds_write_b64 v4, v[110:111] offset:456
ds_write_b64 v4, v[136:137] offset:480
ds_write_b64 v4, v[118:119] offset:488
ds_write_b64 v4, v[20:21] offset:512
ds_write_b64 v4, v[134:135] offset:520
ds_write_b64 v4, v[36:37] offset:544
ds_write_b64 v4, v[138:139] offset:552
ds_write_b64 v4, v[72:73] offset:576
ds_write_b64 v4, v[130:131] offset:584
ds_write_b64 v4, v[144:145] offset:608
ds_write_b64 v4, v[26:27] offset:616
ds_write_b64 v4, v[48:49] offset:640
ds_write_b64 v4, v[114:115] offset:648
ds_write_b64 v4, v[16:17] offset:672
ds_write_b64 v4, v[34:35] offset:680
ds_write_b64 v4, v[124:125] offset:704
ds_write_b64 v4, v[46:47] offset:712
ds_write_b64 v4, v[104:105] offset:736
ds_write_b64 v4, v[54:55] offset:744
ds_write_b64 v4, v[120:121] offset:768
ds_write_b64 v4, v[146:147] offset:776
ds_write_b64 v4, v[68:69] offset:800
ds_write_b64 v4, v[50:51] offset:808
ds_write_b64 v4, v[60:61] offset:832
ds_write_b64 v4, v[78:79] offset:840
ds_write_b64 v4, v[40:41] offset:864
ds_write_b64 v4, v[86:87] offset:872
ds_write_b64 v4, v[56:57] offset:896
ds_write_b64 v4, v[74:75] offset:904
ds_write_b64 v4, v[112:113] offset:928
ds_write_b64 v4, v[90:91] offset:936
ds_write_b64 v4, v[32:33] offset:960
ds_write_b64 v4, v[94:95] offset:968
ds_write_b64 v4, v[44:45] offset:992
ds_write_b64 v4, v[102:103] offset:1000
s_waitcnt lgkmcnt(0)
ds_read_b128 v[16:19], v3
ds_read_b128 v[20:23], v3 offset:1056
ds_read_b128 v[24:27], v3 offset:2112
ds_read_b128 v[28:31], v3 offset:3168
ds_read_b128 v[32:35], v3 offset:4224
ds_read_b128 v[36:39], v3 offset:5280
ds_read_b128 v[40:43], v3 offset:6336
ds_read_b128 v[44:47], v3 offset:7392
ds_read_b128 v[48:51], v3 offset:8448
ds_read_b128 v[52:55], v3 offset:9504
ds_read_b128 v[56:59], v3 offset:10560
ds_read_b128 v[60:63], v3 offset:11616
s_waitcnt lgkmcnt(4)
ds_read_b128 v[64:67], v3 offset:12672
ds_read_b128 v[68:71], v3 offset:13728
ds_read_b128 v[72:75], v3 offset:14784
ds_read_b128 v[76:79], v3 offset:15840
ds_read_b128 v[80:83], v3 offset:16896
ds_read_b128 v[84:87], v3 offset:17952
ds_read_b128 v[88:91], v3 offset:19008
ds_read_b128 v[92:95], v3 offset:20064
ds_read_b128 v[96:99], v3 offset:21120
ds_read_b128 v[100:103], v3 offset:22176
ds_read_b128 v[104:107], v3 offset:23232
ds_read_b128 v[108:111], v3 offset:24288
s_waitcnt lgkmcnt(4)
ds_read_b128 v[112:115], v3 offset:25344
ds_read_b128 v[116:119], v3 offset:26400
ds_read_b128 v[120:123], v3 offset:27456
ds_read_b128 v[124:127], v3 offset:28512
ds_read_b128 v[128:131], v3 offset:29568
ds_read_b128 v[132:135], v3 offset:30624
ds_read_b128 v[136:139], v3 offset:31680
ds_read_b128 v[140:143], v3 offset:32736
s_waitcnt lgkmcnt(0)
v_pk_add_f32 v[144:145], v[16:17], v[80:81] neg_lo:[0,1] neg_hi:[0,1]
v_pk_add_f32 v[146:147], v[18:19], v[82:83] neg_lo:[0,1] neg_hi:[0,1]
v_pk_add_f32 v[16:17], v[16:17], v[80:81]
v_pk_add_f32 v[18:19], v[18:19], v[82:83]
v_pk_add_f32 v[80:81], v[20:21], v[84:85] neg_lo:[0,1] neg_hi:[0,1]
v_pk_add_f32 v[82:83], v[22:23], v[86:87] neg_lo:[0,1] neg_hi:[0,1]
v_pk_add_f32 v[20:21], v[20:21], v[84:85]
v_pk_add_f32 v[22:23], v[22:23], v[86:87]
v_pk_mul_f32 v[84:85], v[80:81], s[30:31] op_sel_hi:[1,0]
v_pk_mul_f32 v[86:87], v[80:81], s[36:37] op_sel_hi:[1,0]
v_pk_fma_f32 v[84:85], v[82:83], s[36:37], v[84:85] op_sel_hi:[1,0,1] neg_lo:[0,1,0] neg_hi:[0,1,0]
v_pk_fma_f32 v[86:87], v[82:83], s[30:31], v[86:87] op_sel_hi:[1,0,1]
v_pk_add_f32 v[80:81], v[24:25], v[88:89] neg_lo:[0,1] neg_hi:[0,1]
v_pk_add_f32 v[82:83], v[26:27], v[90:91] neg_lo:[0,1] neg_hi:[0,1]
v_pk_add_f32 v[24:25], v[24:25], v[88:89]
v_pk_add_f32 v[26:27], v[26:27], v[90:91]
v_pk_mul_f32 v[88:89], v[80:81], s[30:31] op_sel:[0,1]
v_pk_mul_f32 v[90:91], v[80:81], s[34:35] op_sel:[0,1]
v_pk_fma_f32 v[88:89], v[82:83], s[34:35], v[88:89] op_sel:[0,1,0] neg_lo:[0,1,0] neg_hi:[0,1,0]
v_pk_fma_f32 v[90:91], v[82:83], s[30:31], v[90:91] op_sel:[0,1,0]
v_pk_add_f32 v[80:81], v[28:29], v[92:93] neg_lo:[0,1] neg_hi:[0,1]
v_pk_add_f32 v[82:83], v[30:31], v[94:95] neg_lo:[0,1] neg_hi:[0,1]
v_pk_add_f32 v[28:29], v[28:29], v[92:93]
v_pk_add_f32 v[30:31], v[30:31], v[94:95]
v_pk_mul_f32 v[92:93], v[80:81], s[32:33] op_sel_hi:[1,0]
v_pk_mul_f32 v[94:95], v[80:81], s[34:35] op_sel_hi:[1,0]
v_pk_fma_f32 v[92:93], v[82:83], s[34:35], v[92:93] op_sel_hi:[1,0,1] neg_lo:[0,1,0] neg_hi:[0,1,0]
v_pk_fma_f32 v[94:95], v[82:83], s[32:33], v[94:95] op_sel_hi:[1,0,1]
v_pk_add_f32 v[80:81], v[32:33], v[96:97] neg_lo:[0,1] neg_hi:[0,1]
v_pk_add_f32 v[82:83], v[34:35], v[98:99] neg_lo:[0,1] neg_hi:[0,1]
v_pk_add_f32 v[32:33], v[32:33], v[96:97]
v_pk_add_f32 v[34:35], v[34:35], v[98:99]
v_pk_mul_f32 v[96:97], v[80:81], s[32:33] op_sel:[0,1]
v_pk_mul_f32 v[98:99], v[80:81], s[32:33] op_sel:[0,1]
v_pk_fma_f32 v[96:97], v[82:83], s[32:33], v[96:97] op_sel:[0,1,0] neg_lo:[0,1,0] neg_hi:[0,1,0]
v_pk_fma_f32 v[98:99], v[82:83], s[32:33], v[98:99] op_sel:[0,1,0]
v_pk_add_f32 v[80:81], v[36:37], v[100:101] neg_lo:[0,1] neg_hi:[0,1]
v_pk_add_f32 v[82:83], v[38:39], v[102:103] neg_lo:[0,1] neg_hi:[0,1]
v_pk_add_f32 v[36:37], v[36:37], v[100:101]
v_pk_add_f32 v[38:39], v[38:39], v[102:103]
v_pk_mul_f32 v[100:101], v[80:81], s[34:35] op_sel_hi:[1,0]
v_pk_mul_f32 v[102:103], v[80:81], s[32:33] op_sel_hi:[1,0]
v_pk_fma_f32 v[100:101], v[82:83], s[32:33], v[100:101] op_sel_hi:[1,0,1] neg_lo:[0,1,0] neg_hi:[0,1,0]
v_pk_fma_f32 v[102:103], v[82:83], s[34:35], v[102:103] op_sel_hi:[1,0,1]
v_pk_add_f32 v[80:81], v[40:41], v[104:105] neg_lo:[0,1] neg_hi:[0,1]
v_pk_add_f32 v[82:83], v[42:43], v[106:107] neg_lo:[0,1] neg_hi:[0,1]
v_pk_add_f32 v[40:41], v[40:41], v[104:105]
v_pk_add_f32 v[42:43], v[42:43], v[106:107]
v_pk_mul_f32 v[104:105], v[80:81], s[34:35] op_sel:[0,1]
v_pk_mul_f32 v[106:107], v[80:81], s[30:31] op_sel:[0,1]
v_pk_fma_f32 v[104:105], v[82:83], s[30:31], v[104:105] op_sel:[0,1,0] neg_lo:[0,1,0] neg_hi:[0,1,0]
v_pk_fma_f32 v[106:107], v[82:83], s[34:35], v[106:107] op_sel:[0,1,0]
v_pk_add_f32 v[80:81], v[44:45], v[108:109] neg_lo:[0,1] neg_hi:[0,1]
v_pk_add_f32 v[82:83], v[46:47], v[110:111] neg_lo:[0,1] neg_hi:[0,1]
v_pk_add_f32 v[44:45], v[44:45], v[108:109]
v_pk_add_f32 v[46:47], v[46:47], v[110:111]
v_pk_mul_f32 v[108:109], v[80:81], s[36:37] op_sel_hi:[1,0]
v_pk_mul_f32 v[110:111], v[80:81], s[30:31] op_sel_hi:[1,0]
v_pk_fma_f32 v[108:109], v[82:83], s[30:31], v[108:109] op_sel_hi:[1,0,1] neg_lo:[0,1,0] neg_hi:[0,1,0]
v_pk_fma_f32 v[110:111], v[82:83], s[36:37], v[110:111] op_sel_hi:[1,0,1]
v_pk_add_f32 v[80:81], v[114:115], v[50:51] neg_lo:[0,1] neg_hi:[0,1]
v_pk_add_f32 v[82:83], v[48:49], v[112:113] neg_lo:[0,1] neg_hi:[0,1]
v_pk_add_f32 v[48:49], v[48:49], v[112:113]
v_pk_add_f32 v[50:51], v[50:51], v[114:115]
v_pk_add_f32 v[112:113], v[52:53], v[116:117] neg_lo:[0,1] neg_hi:[0,1]
v_pk_add_f32 v[114:115], v[54:55], v[118:119] neg_lo:[0,1] neg_hi:[0,1]
v_pk_add_f32 v[52:53], v[52:53], v[116:117]
v_pk_add_f32 v[54:55], v[54:55], v[118:119]
v_pk_mul_f32 v[116:117], v[112:113], s[36:37] op_sel_hi:[1,0] neg_lo:[0,1] neg_hi:[0,1]
v_pk_mul_f32 v[118:119], v[112:113], s[30:31] op_sel_hi:[1,0]
v_pk_fma_f32 v[116:117], v[114:115], s[30:31], v[116:117] op_sel_hi:[1,0,1] neg_lo:[0,1,0] neg_hi:[0,1,0]
v_pk_fma_f32 v[118:119], v[114:115], s[36:37], v[118:119] op_sel_hi:[1,0,1] neg_lo:[0,1,0] neg_hi:[0,1,0]
v_pk_add_f32 v[112:113], v[56:57], v[120:121] neg_lo:[0,1] neg_hi:[0,1]
v_pk_add_f32 v[114:115], v[58:59], v[122:123] neg_lo:[0,1] neg_hi:[0,1]
v_pk_add_f32 v[56:57], v[56:57], v[120:121]
v_pk_add_f32 v[58:59], v[58:59], v[122:123]
v_pk_mul_f32 v[120:121], v[112:113], s[34:35] op_sel:[0,1] neg_lo:[0,1] neg_hi:[0,1]
v_pk_mul_f32 v[122:123], v[112:113], s[30:31] op_sel:[0,1]
v_pk_fma_f32 v[120:121], v[114:115], s[30:31], v[120:121] op_sel:[0,1,0] neg_lo:[0,1,0] neg_hi:[0,1,0]
v_pk_fma_f32 v[122:123], v[114:115], s[34:35], v[122:123] op_sel:[0,1,0] neg_lo:[0,1,0] neg_hi:[0,1,0]
v_pk_add_f32 v[112:113], v[60:61], v[124:125] neg_lo:[0,1] neg_hi:[0,1]
v_pk_add_f32 v[114:115], v[62:63], v[126:127] neg_lo:[0,1] neg_hi:[0,1]
v_pk_add_f32 v[60:61], v[60:61], v[124:125]
v_pk_add_f32 v[62:63], v[62:63], v[126:127]
v_pk_mul_f32 v[124:125], v[112:113], s[34:35] op_sel_hi:[1,0] neg_lo:[0,1] neg_hi:[0,1]
v_pk_mul_f32 v[126:127], v[112:113], s[32:33] op_sel_hi:[1,0]
v_pk_fma_f32 v[124:125], v[114:115], s[32:33], v[124:125] op_sel_hi:[1,0,1] neg_lo:[0,1,0] neg_hi:[0,1,0]
v_pk_fma_f32 v[126:127], v[114:115], s[34:35], v[126:127] op_sel_hi:[1,0,1] neg_lo:[0,1,0] neg_hi:[0,1,0]
v_pk_add_f32 v[112:113], v[64:65], v[128:129] neg_lo:[0,1] neg_hi:[0,1]
v_pk_add_f32 v[114:115], v[66:67], v[130:131] neg_lo:[0,1] neg_hi:[0,1]
v_pk_add_f32 v[64:65], v[64:65], v[128:129]
v_pk_add_f32 v[66:67], v[66:67], v[130:131]
v_pk_mul_f32 v[128:129], v[112:113], s[32:33] op_sel:[0,1] neg_lo:[0,1] neg_hi:[0,1]
v_pk_mul_f32 v[130:131], v[112:113], s[32:33] op_sel:[0,1]
v_pk_fma_f32 v[128:129], v[114:115], s[32:33], v[128:129] op_sel:[0,1,0] neg_lo:[0,1,0] neg_hi:[0,1,0]
v_pk_fma_f32 v[130:131], v[114:115], s[32:33], v[130:131] op_sel:[0,1,0] neg_lo:[0,1,0] neg_hi:[0,1,0]
v_pk_add_f32 v[112:113], v[68:69], v[132:133] neg_lo:[0,1] neg_hi:[0,1]
v_pk_add_f32 v[114:115], v[70:71], v[134:135] neg_lo:[0,1] neg_hi:[0,1]
v_pk_add_f32 v[68:69], v[68:69], v[132:133]
v_pk_add_f32 v[70:71], v[70:71], v[134:135]
v_pk_mul_f32 v[132:133], v[112:113], s[32:33] op_sel_hi:[1,0] neg_lo:[0,1] neg_hi:[0,1]
v_pk_mul_f32 v[134:135], v[112:113], s[34:35] op_sel_hi:[1,0]
v_pk_fma_f32 v[132:133], v[114:115], s[34:35], v[132:133] op_sel_hi:[1,0,1] neg_lo:[0,1,0] neg_hi:[0,1,0]
v_pk_fma_f32 v[134:135], v[114:115], s[32:33], v[134:135] op_sel_hi:[1,0,1] neg_lo:[0,1,0] neg_hi:[0,1,0]
v_pk_add_f32 v[112:113], v[72:73], v[136:137] neg_lo:[0,1] neg_hi:[0,1]
v_pk_add_f32 v[114:115], v[74:75], v[138:139] neg_lo:[0,1] neg_hi:[0,1]
v_pk_add_f32 v[72:73], v[72:73], v[136:137]
v_pk_add_f32 v[74:75], v[74:75], v[138:139]
v_pk_mul_f32 v[136:137], v[112:113], s[30:31] op_sel:[0,1] neg_lo:[0,1] neg_hi:[0,1]
v_pk_mul_f32 v[138:139], v[112:113], s[34:35] op_sel:[0,1]
v_pk_fma_f32 v[136:137], v[114:115], s[34:35], v[136:137] op_sel:[0,1,0] neg_lo:[0,1,0] neg_hi:[0,1,0]
v_pk_fma_f32 v[138:139], v[114:115], s[30:31], v[138:139] op_sel:[0,1,0] neg_lo:[0,1,0] neg_hi:[0,1,0]
v_pk_add_f32 v[112:113], v[76:77], v[140:141] neg_lo:[0,1] neg_hi:[0,1]
v_pk_add_f32 v[114:115], v[78:79], v[142:143] neg_lo:[0,1] neg_hi:[0,1]
v_pk_add_f32 v[76:77], v[76:77], v[140:141]
v_pk_add_f32 v[78:79], v[78:79], v[142:143]
v_pk_mul_f32 v[140:141], v[112:113], s[30:31] op_sel_hi:[1,0] neg_lo:[0,1] neg_hi:[0,1]
v_pk_mul_f32 v[142:143], v[112:113], s[36:37] op_sel_hi:[1,0]
v_pk_fma_f32 v[140:141], v[114:115], s[36:37], v[140:141] op_sel_hi:[1,0,1] neg_lo:[0,1,0] neg_hi:[0,1,0]
v_pk_fma_f32 v[142:143], v[114:115], s[30:31], v[142:143] op_sel_hi:[1,0,1] neg_lo:[0,1,0] neg_hi:[0,1,0]
v_pk_add_f32 v[112:113], v[16:17], v[48:49] neg_lo:[0,1] neg_hi:[0,1]
v_pk_add_f32 v[114:115], v[18:19], v[50:51] neg_lo:[0,1] neg_hi:[0,1]
v_pk_add_f32 v[16:17], v[16:17], v[48:49]
v_pk_add_f32 v[18:19], v[18:19], v[50:51]
v_pk_add_f32 v[48:49], v[20:21], v[52:53] neg_lo:[0,1] neg_hi:[0,1]
v_pk_add_f32 v[50:51], v[22:23], v[54:55] neg_lo:[0,1] neg_hi:[0,1]
v_pk_add_f32 v[20:21], v[20:21], v[52:53]
v_pk_add_f32 v[22:23], v[22:23], v[54:55]
v_pk_mul_f32 v[52:53], v[48:49], s[30:31] op_sel:[0,1]
v_pk_mul_f32 v[54:55], v[48:49], s[34:35] op_sel:[0,1]
v_pk_fma_f32 v[52:53], v[50:51], s[34:35], v[52:53] op_sel:[0,1,0] neg_lo:[0,1,0] neg_hi:[0,1,0]
v_pk_fma_f32 v[54:55], v[50:51], s[30:31], v[54:55] op_sel:[0,1,0]
v_pk_add_f32 v[48:49], v[24:25], v[56:57] neg_lo:[0,1] neg_hi:[0,1]
v_pk_add_f32 v[50:51], v[26:27], v[58:59] neg_lo:[0,1] neg_hi:[0,1]
v_pk_add_f32 v[24:25], v[24:25], v[56:57]
v_pk_add_f32 v[26:27], v[26:27], v[58:59]
v_pk_mul_f32 v[56:57], v[48:49], s[32:33] op_sel:[0,1]
v_pk_mul_f32 v[58:59], v[48:49], s[32:33] op_sel:[0,1]
v_pk_fma_f32 v[56:57], v[50:51], s[32:33], v[56:57] op_sel:[0,1,0] neg_lo:[0,1,0] neg_hi:[0,1,0]
v_pk_fma_f32 v[58:59], v[50:51], s[32:33], v[58:59] op_sel:[0,1,0]
v_pk_add_f32 v[48:49], v[28:29], v[60:61] neg_lo:[0,1] neg_hi:[0,1]
v_pk_add_f32 v[50:51], v[30:31], v[62:63] neg_lo:[0,1] neg_hi:[0,1]
v_pk_add_f32 v[28:29], v[28:29], v[60:61]
v_pk_add_f32 v[30:31], v[30:31], v[62:63]
v_pk_mul_f32 v[60:61], v[48:49], s[34:35] op_sel:[0,1]
v_pk_mul_f32 v[62:63], v[48:49], s[30:31] op_sel:[0,1]
v_pk_fma_f32 v[60:61], v[50:51], s[30:31], v[60:61] op_sel:[0,1,0] neg_lo:[0,1,0] neg_hi:[0,1,0]
v_pk_fma_f32 v[62:63], v[50:51], s[34:35], v[62:63] op_sel:[0,1,0]
v_pk_add_f32 v[48:49], v[66:67], v[34:35] neg_lo:[0,1] neg_hi:[0,1]
v_pk_add_f32 v[50:51], v[32:33], v[64:65] neg_lo:[0,1] neg_hi:[0,1]
v_pk_add_f32 v[32:33], v[32:33], v[64:65]
v_pk_add_f32 v[34:35], v[34:35], v[66:67]
v_pk_add_f32 v[64:65], v[36:37], v[68:69] neg_lo:[0,1] neg_hi:[0,1]
v_pk_add_f32 v[66:67], v[38:39], v[70:71] neg_lo:[0,1] neg_hi:[0,1]
v_pk_add_f32 v[36:37], v[36:37], v[68:69]
v_pk_add_f32 v[38:39], v[38:39], v[70:71]
v_pk_mul_f32 v[68:69], v[64:65], s[34:35] op_sel:[0,1] neg_lo:[0,1] neg_hi:[0,1]
v_pk_mul_f32 v[70:71], v[64:65], s[30:31] op_sel:[0,1]
v_pk_fma_f32 v[68:69], v[66:67], s[30:31], v[68:69] op_sel:[0,1,0] neg_lo:[0,1,0] neg_hi:[0,1,0]
v_pk_fma_f32 v[70:71], v[66:67], s[34:35], v[70:71] op_sel:[0,1,0] neg_lo:[0,1,0] neg_hi:[0,1,0]
v_pk_add_f32 v[64:65], v[40:41], v[72:73] neg_lo:[0,1] neg_hi:[0,1]
v_pk_add_f32 v[66:67], v[42:43], v[74:75] neg_lo:[0,1] neg_hi:[0,1]
v_pk_add_f32 v[40:41], v[40:41], v[72:73]
v_pk_add_f32 v[42:43], v[42:43], v[74:75]
v_pk_mul_f32 v[72:73], v[64:65], s[32:33] op_sel:[0,1] neg_lo:[0,1] neg_hi:[0,1]
v_pk_mul_f32 v[74:75], v[64:65], s[32:33] op_sel:[0,1]
v_pk_fma_f32 v[72:73], v[66:67], s[32:33], v[72:73] op_sel:[0,1,0] neg_lo:[0,1,0] neg_hi:[0,1,0]
v_pk_fma_f32 v[74:75], v[66:67], s[32:33], v[74:75] op_sel:[0,1,0] neg_lo:[0,1,0] neg_hi:[0,1,0]
v_pk_add_f32 v[64:65], v[44:45], v[76:77] neg_lo:[0,1] neg_hi:[0,1]
v_pk_add_f32 v[66:67], v[46:47], v[78:79] neg_lo:[0,1] neg_hi:[0,1]
v_pk_add_f32 v[44:45], v[44:45], v[76:77]
v_pk_add_f32 v[46:47], v[46:47], v[78:79]
v_pk_mul_f32 v[76:77], v[64:65], s[30:31] op_sel:[0,1] neg_lo:[0,1] neg_hi:[0,1]
v_pk_mul_f32 v[78:79], v[64:65], s[34:35] op_sel:[0,1]
v_pk_fma_f32 v[76:77], v[66:67], s[34:35], v[76:77] op_sel:[0,1,0] neg_lo:[0,1,0] neg_hi:[0,1,0]
v_pk_fma_f32 v[78:79], v[66:67], s[30:31], v[78:79] op_sel:[0,1,0] neg_lo:[0,1,0] neg_hi:[0,1,0]
v_pk_add_f32 v[64:65], v[144:145], v[80:81] neg_lo:[0,1] neg_hi:[0,1]
v_pk_add_f32 v[66:67], v[146:147], v[82:83] neg_lo:[0,1] neg_hi:[0,1]
v_pk_add_f32 v[144:145], v[144:145], v[80:81]
v_pk_add_f32 v[146:147], v[146:147], v[82:83]
v_pk_add_f32 v[80:81], v[84:85], v[116:117] neg_lo:[0,1] neg_hi:[0,1]
v_pk_add_f32 v[82:83], v[86:87], v[118:119] neg_lo:[0,1] neg_hi:[0,1]
v_pk_add_f32 v[84:85], v[84:85], v[116:117]
v_pk_add_f32 v[86:87], v[86:87], v[118:119]
v_pk_mul_f32 v[116:117], v[80:81], s[30:31] op_sel:[0,1]
v_pk_mul_f32 v[118:119], v[80:81], s[34:35] op_sel:[0,1]
v_pk_fma_f32 v[116:117], v[82:83], s[34:35], v[116:117] op_sel:[0,1,0] neg_lo:[0,1,0] neg_hi:[0,1,0]
v_pk_fma_f32 v[118:119], v[82:83], s[30:31], v[118:119] op_sel:[0,1,0]
v_pk_add_f32 v[80:81], v[88:89], v[120:121] neg_lo:[0,1] neg_hi:[0,1]
v_pk_add_f32 v[82:83], v[90:91], v[122:123] neg_lo:[0,1] neg_hi:[0,1]
v_pk_add_f32 v[88:89], v[88:89], v[120:121]
v_pk_add_f32 v[90:91], v[90:91], v[122:123]
v_pk_mul_f32 v[120:121], v[80:81], s[32:33] op_sel:[0,1]
v_pk_mul_f32 v[122:123], v[80:81], s[32:33] op_sel:[0,1]
v_pk_fma_f32 v[120:121], v[82:83], s[32:33], v[120:121] op_sel:[0,1,0] neg_lo:[0,1,0] neg_hi:[0,1,0]
v_pk_fma_f32 v[122:123], v[82:83], s[32:33], v[122:123] op_sel:[0,1,0]
v_pk_add_f32 v[80:81], v[92:93], v[124:125] neg_lo:[0,1] neg_hi:[0,1]
v_pk_add_f32 v[82:83], v[94:95], v[126:127] neg_lo:[0,1] neg_hi:[0,1]
v_pk_add_f32 v[92:93], v[92:93], v[124:125]
v_pk_add_f32 v[94:95], v[94:95], v[126:127]
v_pk_mul_f32 v[124:125], v[80:81], s[34:35] op_sel:[0,1]
v_pk_mul_f32 v[126:127], v[80:81], s[30:31] op_sel:[0,1]
v_pk_fma_f32 v[124:125], v[82:83], s[30:31], v[124:125] op_sel:[0,1,0] neg_lo:[0,1,0] neg_hi:[0,1,0]
v_pk_fma_f32 v[126:127], v[82:83], s[34:35], v[126:127] op_sel:[0,1,0]
v_pk_add_f32 v[80:81], v[130:131], v[98:99] neg_lo:[0,1] neg_hi:[0,1]
v_pk_add_f32 v[82:83], v[96:97], v[128:129] neg_lo:[0,1] neg_hi:[0,1]
v_pk_add_f32 v[96:97], v[96:97], v[128:129]
v_pk_add_f32 v[98:99], v[98:99], v[130:131]
v_pk_add_f32 v[128:129], v[100:101], v[132:133] neg_lo:[0,1] neg_hi:[0,1]
v_pk_add_f32 v[130:131], v[102:103], v[134:135] neg_lo:[0,1] neg_hi:[0,1]
v_pk_add_f32 v[100:101], v[100:101], v[132:133]
v_pk_add_f32 v[102:103], v[102:103], v[134:135]
v_pk_mul_f32 v[132:133], v[128:129], s[34:35] op_sel:[0,1] neg_lo:[0,1] neg_hi:[0,1]
v_pk_mul_f32 v[134:135], v[128:129], s[30:31] op_sel:[0,1]
v_pk_fma_f32 v[132:133], v[130:131], s[30:31], v[132:133] op_sel:[0,1,0] neg_lo:[0,1,0] neg_hi:[0,1,0]
v_pk_fma_f32 v[134:135], v[130:131], s[34:35], v[134:135] op_sel:[0,1,0] neg_lo:[0,1,0] neg_hi:[0,1,0]
v_pk_add_f32 v[128:129], v[104:105], v[136:137] neg_lo:[0,1] neg_hi:[0,1]
v_pk_add_f32 v[130:131], v[106:107], v[138:139] neg_lo:[0,1] neg_hi:[0,1]
v_pk_add_f32 v[104:105], v[104:105], v[136:137]
v_pk_add_f32 v[106:107], v[106:107], v[138:139]
v_pk_mul_f32 v[136:137], v[128:129], s[32:33] op_sel:[0,1] neg_lo:[0,1] neg_hi:[0,1]
v_pk_mul_f32 v[138:139], v[128:129], s[32:33] op_sel:[0,1]
v_pk_fma_f32 v[136:137], v[130:131], s[32:33], v[136:137] op_sel:[0,1,0] neg_lo:[0,1,0] neg_hi:[0,1,0]
v_pk_fma_f32 v[138:139], v[130:131], s[32:33], v[138:139] op_sel:[0,1,0] neg_lo:[0,1,0] neg_hi:[0,1,0]
v_pk_add_f32 v[128:129], v[108:109], v[140:141] neg_lo:[0,1] neg_hi:[0,1]
v_pk_add_f32 v[130:131], v[110:111], v[142:143] neg_lo:[0,1] neg_hi:[0,1]
v_pk_add_f32 v[108:109], v[108:109], v[140:141]
v_pk_add_f32 v[110:111], v[110:111], v[142:143]
v_pk_mul_f32 v[140:141], v[128:129], s[30:31] op_sel:[0,1] neg_lo:[0,1] neg_hi:[0,1]
v_pk_mul_f32 v[142:143], v[128:129], s[34:35] op_sel:[0,1]
v_pk_fma_f32 v[140:141], v[130:131], s[34:35], v[140:141] op_sel:[0,1,0] neg_lo:[0,1,0] neg_hi:[0,1,0]
v_pk_fma_f32 v[142:143], v[130:131], s[30:31], v[142:143] op_sel:[0,1,0] neg_lo:[0,1,0] neg_hi:[0,1,0]
v_pk_add_f32 v[128:129], v[16:17], v[32:33] neg_lo:[0,1] neg_hi:[0,1]
v_pk_add_f32 v[130:131], v[18:19], v[34:35] neg_lo:[0,1] neg_hi:[0,1]
v_pk_add_f32 v[16:17], v[16:17], v[32:33]
v_pk_add_f32 v[18:19], v[18:19], v[34:35]
v_pk_add_f32 v[32:33], v[20:21], v[36:37] neg_lo:[0,1] neg_hi:[0,1]
v_pk_add_f32 v[34:35], v[22:23], v[38:39] neg_lo:[0,1] neg_hi:[0,1]
v_pk_add_f32 v[20:21], v[20:21], v[36:37]
v_pk_add_f32 v[22:23], v[22:23], v[38:39]
v_pk_mul_f32 v[36:37], v[32:33], s[32:33] op_sel:[0,1]
v_pk_mul_f32 v[38:39], v[32:33], s[32:33] op_sel:[0,1]
v_pk_fma_f32 v[36:37], v[34:35], s[32:33], v[36:37] op_sel:[0,1,0] neg_lo:[0,1,0] neg_hi:[0,1,0]
v_pk_fma_f32 v[38:39], v[34:35], s[32:33], v[38:39] op_sel:[0,1,0]
v_pk_add_f32 v[32:33], v[42:43], v[26:27] neg_lo:[0,1] neg_hi:[0,1]
v_pk_add_f32 v[34:35], v[24:25], v[40:41] neg_lo:[0,1] neg_hi:[0,1]
v_pk_add_f32 v[24:25], v[24:25], v[40:41]
v_pk_add_f32 v[26:27], v[26:27], v[42:43]
v_pk_add_f32 v[40:41], v[28:29], v[44:45] neg_lo:[0,1] neg_hi:[0,1]
v_pk_add_f32 v[42:43], v[30:31], v[46:47] neg_lo:[0,1] neg_hi:[0,1]
v_pk_add_f32 v[28:29], v[28:29], v[44:45]
v_pk_add_f32 v[30:31], v[30:31], v[46:47]
v_pk_mul_f32 v[44:45], v[40:41], s[32:33] op_sel:[0,1] neg_lo:[0,1] neg_hi:[0,1]
v_pk_mul_f32 v[46:47], v[40:41], s[32:33] op_sel:[0,1]
v_pk_fma_f32 v[44:45], v[42:43], s[32:33], v[44:45] op_sel:[0,1,0] neg_lo:[0,1,0] neg_hi:[0,1,0]
v_pk_fma_f32 v[46:47], v[42:43], s[32:33], v[46:47] op_sel:[0,1,0] neg_lo:[0,1,0] neg_hi:[0,1,0]
v_pk_add_f32 v[40:41], v[112:113], v[48:49] neg_lo:[0,1] neg_hi:[0,1]
v_pk_add_f32 v[42:43], v[114:115], v[50:51] neg_lo:[0,1] neg_hi:[0,1]
v_pk_add_f32 v[112:113], v[112:113], v[48:49]
v_pk_add_f32 v[114:115], v[114:115], v[50:51]
v_pk_add_f32 v[48:49], v[52:53], v[68:69] neg_lo:[0,1] neg_hi:[0,1]
v_pk_add_f32 v[50:51], v[54:55], v[70:71] neg_lo:[0,1] neg_hi:[0,1]
v_pk_add_f32 v[52:53], v[52:53], v[68:69]
v_pk_add_f32 v[54:55], v[54:55], v[70:71]
v_pk_mul_f32 v[68:69], v[48:49], s[32:33] op_sel:[0,1]
v_pk_mul_f32 v[70:71], v[48:49], s[32:33] op_sel:[0,1]
v_pk_fma_f32 v[68:69], v[50:51], s[32:33], v[68:69] op_sel:[0,1,0] neg_lo:[0,1,0] neg_hi:[0,1,0]
v_pk_fma_f32 v[70:71], v[50:51], s[32:33], v[70:71] op_sel:[0,1,0]
v_pk_add_f32 v[48:49], v[74:75], v[58:59] neg_lo:[0,1] neg_hi:[0,1]
v_pk_add_f32 v[50:51], v[56:57], v[72:73] neg_lo:[0,1] neg_hi:[0,1]
v_pk_add_f32 v[56:57], v[56:57], v[72:73]
v_pk_add_f32 v[58:59], v[58:59], v[74:75]
v_pk_add_f32 v[72:73], v[60:61], v[76:77] neg_lo:[0,1] neg_hi:[0,1]
v_pk_add_f32 v[74:75], v[62:63], v[78:79] neg_lo:[0,1] neg_hi:[0,1]
v_pk_add_f32 v[60:61], v[60:61], v[76:77]
v_pk_add_f32 v[62:63], v[62:63], v[78:79]
v_pk_mul_f32 v[76:77], v[72:73], s[32:33] op_sel:[0,1] neg_lo:[0,1] neg_hi:[0,1]
v_pk_mul_f32 v[78:79], v[72:73], s[32:33] op_sel:[0,1]
v_pk_fma_f32 v[76:77], v[74:75], s[32:33], v[76:77] op_sel:[0,1,0] neg_lo:[0,1,0] neg_hi:[0,1,0]
v_pk_fma_f32 v[78:79], v[74:75], s[32:33], v[78:79] op_sel:[0,1,0] neg_lo:[0,1,0] neg_hi:[0,1,0]
v_pk_add_f32 v[72:73], v[144:145], v[96:97] neg_lo:[0,1] neg_hi:[0,1]
v_pk_add_f32 v[74:75], v[146:147], v[98:99] neg_lo:[0,1] neg_hi:[0,1]
v_pk_add_f32 v[144:145], v[144:145], v[96:97]
v_pk_add_f32 v[146:147], v[146:147], v[98:99]
v_pk_add_f32 v[96:97], v[84:85], v[100:101] neg_lo:[0,1] neg_hi:[0,1]
v_pk_add_f32 v[98:99], v[86:87], v[102:103] neg_lo:[0,1] neg_hi:[0,1]
v_pk_add_f32 v[84:85], v[84:85], v[100:101]
v_pk_add_f32 v[86:87], v[86:87], v[102:103]
v_pk_mul_f32 v[100:101], v[96:97], s[32:33] op_sel:[0,1]
v_pk_mul_f32 v[102:103], v[96:97], s[32:33] op_sel:[0,1]
v_pk_fma_f32 v[100:101], v[98:99], s[32:33], v[100:101] op_sel:[0,1,0] neg_lo:[0,1,0] neg_hi:[0,1,0]
v_pk_fma_f32 v[102:103], v[98:99], s[32:33], v[102:103] op_sel:[0,1,0]
v_pk_add_f32 v[96:97], v[106:107], v[90:91] neg_lo:[0,1] neg_hi:[0,1]
v_pk_add_f32 v[98:99], v[88:89], v[104:105] neg_lo:[0,1] neg_hi:[0,1]
v_pk_add_f32 v[88:89], v[88:89], v[104:105]
v_pk_add_f32 v[90:91], v[90:91], v[106:107]
v_pk_add_f32 v[104:105], v[92:93], v[108:109] neg_lo:[0,1] neg_hi:[0,1]
v_pk_add_f32 v[106:107], v[94:95], v[110:111] neg_lo:[0,1] neg_hi:[0,1]
v_pk_add_f32 v[92:93], v[92:93], v[108:109]
v_pk_add_f32 v[94:95], v[94:95], v[110:111]
v_pk_mul_f32 v[108:109], v[104:105], s[32:33] op_sel:[0,1] neg_lo:[0,1] neg_hi:[0,1]
v_pk_mul_f32 v[110:111], v[104:105], s[32:33] op_sel:[0,1]
v_pk_fma_f32 v[108:109], v[106:107], s[32:33], v[108:109] op_sel:[0,1,0] neg_lo:[0,1,0] neg_hi:[0,1,0]
v_pk_fma_f32 v[110:111], v[106:107], s[32:33], v[110:111] op_sel:[0,1,0] neg_lo:[0,1,0] neg_hi:[0,1,0]
v_pk_add_f32 v[104:105], v[64:65], v[80:81] neg_lo:[0,1] neg_hi:[0,1]
v_pk_add_f32 v[106:107], v[66:67], v[82:83] neg_lo:[0,1] neg_hi:[0,1]
v_pk_add_f32 v[64:65], v[64:65], v[80:81]
v_pk_add_f32 v[66:67], v[66:67], v[82:83]
v_pk_add_f32 v[80:81], v[116:117], v[132:133] neg_lo:[0,1] neg_hi:[0,1]
v_pk_add_f32 v[82:83], v[118:119], v[134:135] neg_lo:[0,1] neg_hi:[0,1]
v_pk_add_f32 v[116:117], v[116:117], v[132:133]
v_pk_add_f32 v[118:119], v[118:119], v[134:135]
v_pk_mul_f32 v[132:133], v[80:81], s[32:33] op_sel:[0,1]
v_pk_mul_f32 v[134:135], v[80:81], s[32:33] op_sel:[0,1]
v_pk_fma_f32 v[132:133], v[82:83], s[32:33], v[132:133] op_sel:[0,1,0] neg_lo:[0,1,0] neg_hi:[0,1,0]
v_pk_fma_f32 v[134:135], v[82:83], s[32:33], v[134:135] op_sel:[0,1,0]
v_pk_add_f32 v[80:81], v[138:139], v[122:123] neg_lo:[0,1] neg_hi:[0,1]
v_pk_add_f32 v[82:83], v[120:121], v[136:137] neg_lo:[0,1] neg_hi:[0,1]
v_pk_add_f32 v[120:121], v[120:121], v[136:137]
v_pk_add_f32 v[122:123], v[122:123], v[138:139]
v_pk_add_f32 v[136:137], v[124:125], v[140:141] neg_lo:[0,1] neg_hi:[0,1]
v_pk_add_f32 v[138:139], v[126:127], v[142:143] neg_lo:[0,1] neg_hi:[0,1]
v_pk_add_f32 v[124:125], v[124:125], v[140:141]
v_pk_add_f32 v[126:127], v[126:127], v[142:143]
v_pk_mul_f32 v[140:141], v[136:137], s[32:33] op_sel:[0,1] neg_lo:[0,1] neg_hi:[0,1]
v_pk_mul_f32 v[142:143], v[136:137], s[32:33] op_sel:[0,1]
v_pk_fma_f32 v[140:141], v[138:139], s[32:33], v[140:141] op_sel:[0,1,0] neg_lo:[0,1,0] neg_hi:[0,1,0]
v_pk_fma_f32 v[142:143], v[138:139], s[32:33], v[142:143] op_sel:[0,1,0] neg_lo:[0,1,0] neg_hi:[0,1,0]
v_pk_add_f32 v[136:137], v[16:17], v[24:25] neg_lo:[0,1] neg_hi:[0,1]
v_pk_add_f32 v[138:139], v[18:19], v[26:27] neg_lo:[0,1] neg_hi:[0,1]
v_pk_add_f32 v[16:17], v[16:17], v[24:25]
v_pk_add_f32 v[18:19], v[18:19], v[26:27]
v_pk_add_f32 v[24:25], v[30:31], v[22:23] neg_lo:[0,1] neg_hi:[0,1]
v_pk_add_f32 v[26:27], v[20:21], v[28:29] neg_lo:[0,1] neg_hi:[0,1]
v_pk_add_f32 v[20:21], v[20:21], v[28:29]
v_pk_add_f32 v[22:23], v[22:23], v[30:31]
v_pk_add_f32 v[28:29], v[128:129], v[32:33] neg_lo:[0,1] neg_hi:[0,1]
v_pk_add_f32 v[30:31], v[130:131], v[34:35] neg_lo:[0,1] neg_hi:[0,1]
v_pk_add_f32 v[128:129], v[128:129], v[32:33]
v_pk_add_f32 v[130:131], v[130:131], v[34:35]
v_pk_add_f32 v[32:33], v[46:47], v[38:39] neg_lo:[0,1] neg_hi:[0,1]
v_pk_add_f32 v[34:35], v[36:37], v[44:45] neg_lo:[0,1] neg_hi:[0,1]
v_pk_add_f32 v[36:37], v[36:37], v[44:45]
v_pk_add_f32 v[38:39], v[38:39], v[46:47]
v_pk_add_f32 v[44:45], v[112:113], v[56:57] neg_lo:[0,1] neg_hi:[0,1]
v_pk_add_f32 v[46:47], v[114:115], v[58:59] neg_lo:[0,1] neg_hi:[0,1]
v_pk_add_f32 v[112:113], v[112:113], v[56:57]
v_pk_add_f32 v[114:115], v[114:115], v[58:59]
v_pk_add_f32 v[56:57], v[62:63], v[54:55] neg_lo:[0,1] neg_hi:[0,1]
v_pk_add_f32 v[58:59], v[52:53], v[60:61] neg_lo:[0,1] neg_hi:[0,1]
v_pk_add_f32 v[52:53], v[52:53], v[60:61]
v_pk_add_f32 v[54:55], v[54:55], v[62:63]
v_pk_add_f32 v[60:61], v[40:41], v[48:49] neg_lo:[0,1] neg_hi:[0,1]
v_pk_add_f32 v[62:63], v[42:43], v[50:51] neg_lo:[0,1] neg_hi:[0,1]
v_pk_add_f32 v[40:41], v[40:41], v[48:49]
v_pk_add_f32 v[42:43], v[42:43], v[50:51]
v_pk_add_f32 v[48:49], v[78:79], v[70:71] neg_lo:[0,1] neg_hi:[0,1]
v_pk_add_f32 v[50:51], v[68:69], v[76:77] neg_lo:[0,1] neg_hi:[0,1]
v_pk_add_f32 v[68:69], v[68:69], v[76:77]
v_pk_add_f32 v[70:71], v[70:71], v[78:79]
v_pk_add_f32 v[76:77], v[144:145], v[88:89] neg_lo:[0,1] neg_hi:[0,1]
v_pk_add_f32 v[78:79], v[146:147], v[90:91] neg_lo:[0,1] neg_hi:[0,1]
v_pk_add_f32 v[144:145], v[144:145], v[88:89]
v_pk_add_f32 v[146:147], v[146:147], v[90:91]
v_pk_add_f32 v[88:89], v[94:95], v[86:87] neg_lo:[0,1] neg_hi:[0,1]
v_pk_add_f32 v[90:91], v[84:85], v[92:93] neg_lo:[0,1] neg_hi:[0,1]
v_pk_add_f32 v[84:85], v[84:85], v[92:93]
v_pk_add_f32 v[86:87], v[86:87], v[94:95]
v_pk_add_f32 v[92:93], v[72:73], v[96:97] neg_lo:[0,1] neg_hi:[0,1]
v_pk_add_f32 v[94:95], v[74:75], v[98:99] neg_lo:[0,1] neg_hi:[0,1]
v_pk_add_f32 v[72:73], v[72:73], v[96:97]
v_pk_add_f32 v[74:75], v[74:75], v[98:99]
v_pk_add_f32 v[96:97], v[110:111], v[102:103] neg_lo:[0,1] neg_hi:[0,1]
v_pk_add_f32 v[98:99], v[100:101], v[108:109] neg_lo:[0,1] neg_hi:[0,1]
v_pk_add_f32 v[100:101], v[100:101], v[108:109]
v_pk_add_f32 v[102:103], v[102:103], v[110:111]
v_pk_add_f32 v[108:109], v[64:65], v[120:121] neg_lo:[0,1] neg_hi:[0,1]
v_pk_add_f32 v[110:111], v[66:67], v[122:123] neg_lo:[0,1] neg_hi:[0,1]
v_pk_add_f32 v[64:65], v[64:65], v[120:121]
v_pk_add_f32 v[66:67], v[66:67], v[122:123]
v_pk_add_f32 v[120:121], v[126:127], v[118:119] neg_lo:[0,1] neg_hi:[0,1]
v_pk_add_f32 v[122:123], v[116:117], v[124:125] neg_lo:[0,1] neg_hi:[0,1]
v_pk_add_f32 v[116:117], v[116:117], v[124:125]
v_pk_add_f32 v[118:119], v[118:119], v[126:127]
v_pk_add_f32 v[124:125], v[104:105], v[80:81] neg_lo:[0,1] neg_hi:[0,1]
v_pk_add_f32 v[126:127], v[106:107], v[82:83] neg_lo:[0,1] neg_hi:[0,1]
v_pk_add_f32 v[104:105], v[104:105], v[80:81]
v_pk_add_f32 v[106:107], v[106:107], v[82:83]
v_pk_add_f32 v[80:81], v[142:143], v[134:135] neg_lo:[0,1] neg_hi:[0,1]
v_pk_add_f32 v[82:83], v[132:133], v[140:141] neg_lo:[0,1] neg_hi:[0,1]
v_pk_add_f32 v[132:133], v[132:133], v[140:141]
v_pk_add_f32 v[134:135], v[134:135], v[142:143]
v_pk_add_f32 v[140:141], v[16:17], v[20:21] neg_lo:[0,1] neg_hi:[0,1]
v_pk_add_f32 v[142:143], v[18:19], v[22:23] neg_lo:[0,1] neg_hi:[0,1]
v_pk_add_f32 v[16:17], v[16:17], v[20:21]
v_pk_add_f32 v[18:19], v[18:19], v[22:23]
v_pk_add_f32 v[20:21], v[136:137], v[24:25] neg_lo:[0,1] neg_hi:[0,1]
v_pk_add_f32 v[22:23], v[138:139], v[26:27] neg_lo:[0,1] neg_hi:[0,1]
v_pk_add_f32 v[136:137], v[136:137], v[24:25]
v_pk_add_f32 v[138:139], v[138:139], v[26:27]
v_pk_add_f32 v[24:25], v[128:129], v[36:37] neg_lo:[0,1] neg_hi:[0,1]
v_pk_add_f32 v[26:27], v[130:131], v[38:39] neg_lo:[0,1] neg_hi:[0,1]
v_pk_add_f32 v[128:129], v[128:129], v[36:37]
v_pk_add_f32 v[130:131], v[130:131], v[38:39]
v_pk_add_f32 v[36:37], v[28:29], v[32:33] neg_lo:[0,1] neg_hi:[0,1]
v_pk_add_f32 v[38:39], v[30:31], v[34:35] neg_lo:[0,1] neg_hi:[0,1]
v_pk_add_f32 v[28:29], v[28:29], v[32:33]
v_pk_add_f32 v[30:31], v[30:31], v[34:35]
v_pk_add_f32 v[32:33], v[112:113], v[52:53] neg_lo:[0,1] neg_hi:[0,1]
v_pk_add_f32 v[34:35], v[114:115], v[54:55] neg_lo:[0,1] neg_hi:[0,1]
v_pk_add_f32 v[112:113], v[112:113], v[52:53]
v_pk_add_f32 v[114:115], v[114:115], v[54:55]
v_pk_add_f32 v[52:53], v[44:45], v[56:57] neg_lo:[0,1] neg_hi:[0,1]
v_pk_add_f32 v[54:55], v[46:47], v[58:59] neg_lo:[0,1] neg_hi:[0,1]
v_pk_add_f32 v[44:45], v[44:45], v[56:57]
v_pk_add_f32 v[46:47], v[46:47], v[58:59]
v_pk_add_f32 v[56:57], v[40:41], v[68:69] neg_lo:[0,1] neg_hi:[0,1]
v_pk_add_f32 v[58:59], v[42:43], v[70:71] neg_lo:[0,1] neg_hi:[0,1]
v_pk_add_f32 v[40:41], v[40:41], v[68:69]
v_pk_add_f32 v[42:43], v[42:43], v[70:71]
v_pk_add_f32 v[68:69], v[60:61], v[48:49] neg_lo:[0,1] neg_hi:[0,1]
v_pk_add_f32 v[70:71], v[62:63], v[50:51] neg_lo:[0,1] neg_hi:[0,1]
v_pk_add_f32 v[60:61], v[60:61], v[48:49]
v_pk_add_f32 v[62:63], v[62:63], v[50:51]
v_pk_add_f32 v[48:49], v[144:145], v[84:85] neg_lo:[0,1] neg_hi:[0,1]
v_pk_add_f32 v[50:51], v[146:147], v[86:87] neg_lo:[0,1] neg_hi:[0,1]
v_pk_add_f32 v[144:145], v[144:145], v[84:85]
v_pk_add_f32 v[146:147], v[146:147], v[86:87]
v_pk_add_f32 v[84:85], v[76:77], v[88:89] neg_lo:[0,1] neg_hi:[0,1]
v_pk_add_f32 v[86:87], v[78:79], v[90:91] neg_lo:[0,1] neg_hi:[0,1]
v_pk_add_f32 v[76:77], v[76:77], v[88:89]
v_pk_add_f32 v[78:79], v[78:79], v[90:91]
v_pk_add_f32 v[88:89], v[72:73], v[100:101] neg_lo:[0,1] neg_hi:[0,1]
v_pk_add_f32 v[90:91], v[74:75], v[102:103] neg_lo:[0,1] neg_hi:[0,1]
v_pk_add_f32 v[72:73], v[72:73], v[100:101]
v_pk_add_f32 v[74:75], v[74:75], v[102:103]
v_pk_add_f32 v[100:101], v[92:93], v[96:97] neg_lo:[0,1] neg_hi:[0,1]
v_pk_add_f32 v[102:103], v[94:95], v[98:99] neg_lo:[0,1] neg_hi:[0,1]
v_pk_add_f32 v[92:93], v[92:93], v[96:97]
v_pk_add_f32 v[94:95], v[94:95], v[98:99]
v_pk_add_f32 v[96:97], v[64:65], v[116:117] neg_lo:[0,1] neg_hi:[0,1]
v_pk_add_f32 v[98:99], v[66:67], v[118:119] neg_lo:[0,1] neg_hi:[0,1]
v_pk_add_f32 v[64:65], v[64:65], v[116:117]
v_pk_add_f32 v[66:67], v[66:67], v[118:119]
v_pk_add_f32 v[116:117], v[108:109], v[120:121] neg_lo:[0,1] neg_hi:[0,1]
v_pk_add_f32 v[118:119], v[110:111], v[122:123] neg_lo:[0,1] neg_hi:[0,1]
v_pk_add_f32 v[108:109], v[108:109], v[120:121]
v_pk_add_f32 v[110:111], v[110:111], v[122:123]
v_pk_add_f32 v[120:121], v[104:105], v[132:133] neg_lo:[0,1] neg_hi:[0,1]
v_pk_add_f32 v[122:123], v[106:107], v[134:135] neg_lo:[0,1] neg_hi:[0,1]
v_pk_add_f32 v[104:105], v[104:105], v[132:133]
v_pk_add_f32 v[106:107], v[106:107], v[134:135]
v_pk_add_f32 v[132:133], v[124:125], v[80:81] neg_lo:[0,1] neg_hi:[0,1]
v_pk_add_f32 v[134:135], v[126:127], v[82:83] neg_lo:[0,1] neg_hi:[0,1]
v_pk_add_f32 v[124:125], v[124:125], v[80:81]
v_pk_add_f32 v[126:127], v[126:127], v[82:83]
s_mov_b32 s20, 0x34800000
v_pk_mul_f32 v[160:161], v[16:17], s[20:21] op_sel_hi:[1,0]
v_pk_mul_f32 v[162:163], v[18:19], s[20:21] op_sel_hi:[1,0]
s_add_u32 s16, s15, 0
buffer_store_dwordx4 v[160:163], v10, s[84:87], s16 offen sc1
v_pk_mul_f32 v[164:165], v[144:145], s[20:21] op_sel_hi:[1,0]
v_pk_mul_f32 v[166:167], v[146:147], s[20:21] op_sel_hi:[1,0]
buffer_store_dwordx4 v[164:167], v10, s[84:87], s16 offen offset:1024 sc1
v_pk_mul_f32 v[168:169], v[112:113], s[20:21] op_sel_hi:[1,0]
v_pk_mul_f32 v[170:171], v[114:115], s[20:21] op_sel_hi:[1,0]
buffer_store_dwordx4 v[168:171], v10, s[84:87], s16 offen offset:2048 sc1
v_pk_mul_f32 v[172:173], v[64:65], s[20:21] op_sel_hi:[1,0]
v_pk_mul_f32 v[174:175], v[66:67], s[20:21] op_sel_hi:[1,0]
buffer_store_dwordx4 v[172:175], v10, s[84:87], s16 offen offset:3072 sc1
v_pk_mul_f32 v[176:177], v[128:129], s[20:21] op_sel_hi:[1,0]
v_pk_mul_f32 v[178:179], v[130:131], s[20:21] op_sel_hi:[1,0]
s_add_u32 s16, s15, 4096
buffer_store_dwordx4 v[176:179], v10, s[84:87], s16 offen sc1
v_pk_mul_f32 v[180:181], v[72:73], s[20:21] op_sel_hi:[1,0]
v_pk_mul_f32 v[182:183], v[74:75], s[20:21] op_sel_hi:[1,0]
buffer_store_dwordx4 v[180:183], v10, s[84:87], s16 offen offset:1024 sc1
v_pk_mul_f32 v[184:185], v[40:41], s[20:21] op_sel_hi:[1,0]
v_pk_mul_f32 v[186:187], v[42:43], s[20:21] op_sel_hi:[1,0]
buffer_store_dwordx4 v[184:187], v10, s[84:87], s16 offen offset:2048 sc1
v_pk_mul_f32 v[188:189], v[104:105], s[20:21] op_sel_hi:[1,0]
v_pk_mul_f32 v[190:191], v[106:107], s[20:21] op_sel_hi:[1,0]
buffer_store_dwordx4 v[188:191], v10, s[84:87], s16 offen offset:3072 sc1
v_pk_mul_f32 v[160:161], v[136:137], s[20:21] op_sel_hi:[1,0]
v_pk_mul_f32 v[162:163], v[138:139], s[20:21] op_sel_hi:[1,0]
s_add_u32 s16, s15, 8192
buffer_store_dwordx4 v[160:163], v10, s[84:87], s16 offen sc1
v_pk_mul_f32 v[164:165], v[76:77], s[20:21] op_sel_hi:[1,0]
v_pk_mul_f32 v[166:167], v[78:79], s[20:21] op_sel_hi:[1,0]
buffer_store_dwordx4 v[164:167], v10, s[84:87], s16 offen offset:1024 sc1
v_pk_mul_f32 v[168:169], v[44:45], s[20:21] op_sel_hi:[1,0]
v_pk_mul_f32 v[170:171], v[46:47], s[20:21] op_sel_hi:[1,0]
buffer_store_dwordx4 v[168:171], v10, s[84:87], s16 offen offset:2048 sc1
v_pk_mul_f32 v[172:173], v[108:109], s[20:21] op_sel_hi:[1,0]
v_pk_mul_f32 v[174:175], v[110:111], s[20:21] op_sel_hi:[1,0]
buffer_store_dwordx4 v[172:175], v10, s[84:87], s16 offen offset:3072 sc1
v_pk_mul_f32 v[176:177], v[28:29], s[20:21] op_sel_hi:[1,0]
v_pk_mul_f32 v[178:179], v[30:31], s[20:21] op_sel_hi:[1,0]
s_add_u32 s16, s15, 12288
buffer_store_dwordx4 v[176:179], v10, s[84:87], s16 offen sc1
v_pk_mul_f32 v[180:181], v[92:93], s[20:21] op_sel_hi:[1,0]
v_pk_mul_f32 v[182:183], v[94:95], s[20:21] op_sel_hi:[1,0]
buffer_store_dwordx4 v[180:183], v10, s[84:87], s16 offen offset:1024 sc1
v_pk_mul_f32 v[184:185], v[60:61], s[20:21] op_sel_hi:[1,0]
v_pk_mul_f32 v[186:187], v[62:63], s[20:21] op_sel_hi:[1,0]
buffer_store_dwordx4 v[184:187], v10, s[84:87], s16 offen offset:2048 sc1
v_pk_mul_f32 v[188:189], v[124:125], s[20:21] op_sel_hi:[1,0]
v_pk_mul_f32 v[190:191], v[126:127], s[20:21] op_sel_hi:[1,0]
buffer_store_dwordx4 v[188:191], v10, s[84:87], s16 offen offset:3072 sc1
v_pk_mul_f32 v[160:161], v[140:141], s[20:21] op_sel_hi:[1,0]
v_pk_mul_f32 v[162:163], v[142:143], s[20:21] op_sel_hi:[1,0]
s_add_u32 s16, s15, 16384
buffer_store_dwordx4 v[160:163], v10, s[84:87], s16 offen sc1
v_pk_mul_f32 v[164:165], v[48:49], s[20:21] op_sel_hi:[1,0]
v_pk_mul_f32 v[166:167], v[50:51], s[20:21] op_sel_hi:[1,0]
buffer_store_dwordx4 v[164:167], v10, s[84:87], s16 offen offset:1024 sc1
v_pk_mul_f32 v[168:169], v[32:33], s[20:21] op_sel_hi:[1,0]
v_pk_mul_f32 v[170:171], v[34:35], s[20:21] op_sel_hi:[1,0]
buffer_store_dwordx4 v[168:171], v10, s[84:87], s16 offen offset:2048 sc1
v_pk_mul_f32 v[172:173], v[96:97], s[20:21] op_sel_hi:[1,0]
v_pk_mul_f32 v[174:175], v[98:99], s[20:21] op_sel_hi:[1,0]
buffer_store_dwordx4 v[172:175], v10, s[84:87], s16 offen offset:3072 sc1
v_pk_mul_f32 v[176:177], v[24:25], s[20:21] op_sel_hi:[1,0]
v_pk_mul_f32 v[178:179], v[26:27], s[20:21] op_sel_hi:[1,0]
s_add_u32 s16, s15, 20480
buffer_store_dwordx4 v[176:179], v10, s[84:87], s16 offen sc1
v_pk_mul_f32 v[180:181], v[88:89], s[20:21] op_sel_hi:[1,0]
v_pk_mul_f32 v[182:183], v[90:91], s[20:21] op_sel_hi:[1,0]
buffer_store_dwordx4 v[180:183], v10, s[84:87], s16 offen offset:1024 sc1
v_pk_mul_f32 v[184:185], v[56:57], s[20:21] op_sel_hi:[1,0]
v_pk_mul_f32 v[186:187], v[58:59], s[20:21] op_sel_hi:[1,0]
buffer_store_dwordx4 v[184:187], v10, s[84:87], s16 offen offset:2048 sc1
v_pk_mul_f32 v[188:189], v[120:121], s[20:21] op_sel_hi:[1,0]
v_pk_mul_f32 v[190:191], v[122:123], s[20:21] op_sel_hi:[1,0]
buffer_store_dwordx4 v[188:191], v10, s[84:87], s16 offen offset:3072 sc1
v_pk_mul_f32 v[160:161], v[20:21], s[20:21] op_sel_hi:[1,0]
v_pk_mul_f32 v[162:163], v[22:23], s[20:21] op_sel_hi:[1,0]
s_add_u32 s16, s15, 24576
buffer_store_dwordx4 v[160:163], v10, s[84:87], s16 offen sc1
v_pk_mul_f32 v[164:165], v[84:85], s[20:21] op_sel_hi:[1,0]
v_pk_mul_f32 v[166:167], v[86:87], s[20:21] op_sel_hi:[1,0]
buffer_store_dwordx4 v[164:167], v10, s[84:87], s16 offen offset:1024 sc1
v_pk_mul_f32 v[168:169], v[52:53], s[20:21] op_sel_hi:[1,0]
v_pk_mul_f32 v[170:171], v[54:55], s[20:21] op_sel_hi:[1,0]
buffer_store_dwordx4 v[168:171], v10, s[84:87], s16 offen offset:2048 sc1
v_pk_mul_f32 v[172:173], v[116:117], s[20:21] op_sel_hi:[1,0]
v_pk_mul_f32 v[174:175], v[118:119], s[20:21] op_sel_hi:[1,0]
buffer_store_dwordx4 v[172:175], v10, s[84:87], s16 offen offset:3072 sc1
v_pk_mul_f32 v[176:177], v[36:37], s[20:21] op_sel_hi:[1,0]
v_pk_mul_f32 v[178:179], v[38:39], s[20:21] op_sel_hi:[1,0]
s_add_u32 s16, s15, 28672
buffer_store_dwordx4 v[176:179], v10, s[84:87], s16 offen sc1
v_pk_mul_f32 v[180:181], v[100:101], s[20:21] op_sel_hi:[1,0]
v_pk_mul_f32 v[182:183], v[102:103], s[20:21] op_sel_hi:[1,0]
buffer_store_dwordx4 v[180:183], v10, s[84:87], s16 offen offset:1024 sc1
v_pk_mul_f32 v[184:185], v[68:69], s[20:21] op_sel_hi:[1,0]
v_pk_mul_f32 v[186:187], v[70:71], s[20:21] op_sel_hi:[1,0]
buffer_store_dwordx4 v[184:187], v10, s[84:87], s16 offen offset:2048 sc1
v_pk_mul_f32 v[188:189], v[132:133], s[20:21] op_sel_hi:[1,0]
v_pk_mul_f32 v[190:191], v[134:135], s[20:21] op_sel_hi:[1,0]
buffer_store_dwordx4 v[188:191], v10, s[84:87], s16 offen offset:3072 sc1
L_f2_end:
s_add_u32 s99, s99, 64
s_cmp_eq_u32 s99, 64
s_cbranch_scc1 L_f2l
s_waitcnt vmcnt(0)
s_barrier
s_cmp_lg_u32 s98, 0
s_cbranch_scc1 L_sg_8
v_mov_b32 v2, 1
s_mov_b32 s81, 71360768
s_mov_b64 exec, 1
buffer_atomic_add v2, off, s[84:87], s81 sc1
s_mov_b64 exec, -1
L_sg_8:
s_cmp_lg_u32 s98, 0
s_cbranch_scc1 L_wf2d
s_mov_b32 s81, 71360768
L_wf2:
buffer_load_dword v120, off, s[84:87], s81 sc1
s_waitcnt vmcnt(0)
v_cmp_ne_u32 vcc, 64, v120
s_cbranch_vccz L_wf2d
s_sleep 6
s_branch L_wf2
L_wf2d:
s_barrier
s_load_dwordx2 s[4:5], s[0:1], 80
s_mov_b32 s30, 0x3f7b14be
s_mov_b32 s31, 0x3f6c835e
s_mov_b32 s32, 0x3f54db31
s_mov_b32 s33, 0x3f3504f3
s_mov_b32 s34, 0x3f0e39da
s_mov_b32 s35, 0x3ec3ef15
s_mov_b32 s36, 0x3e47c5c2
v_and_b32 v5, 7, v0
v_lshrrev_b32 v1, 3, v0
v_mul_u32_u24 v6, 16896, v5
v_lshl_add_u32 v4, v1, 5, v6
v_lshlrev_b32 v5, 4, v5
v_lshl_add_u32 v5, v1, 15, v5
v_lshlrev_b32 v1, 1, v1
s_lshl_b32 s12, s92, 9
s_add_u32 s12, s12, 96468992
s_add_u32 s13, s12, 0
buffer_load_dwordx4 v[48:51], v5, s[84:87], s13 offen
buffer_load_dwordx4 v[52:55], v5, s[84:87], s13 offen offset:128
buffer_load_dwordx4 v[56:59], v5, s[84:87], s13 offen offset:256
buffer_load_dwordx4 v[60:63], v5, s[84:87], s13 offen offset:384
s_add_u32 s13, s12, 1048576
buffer_load_dwordx4 v[64:67], v5, s[84:87], s13 offen
buffer_load_dwordx4 v[68:71], v5, s[84:87], s13 offen offset:128
buffer_load_dwordx4 v[72:75], v5, s[84:87], s13 offen offset:256
buffer_load_dwordx4 v[76:79], v5, s[84:87], s13 offen offset:384
s_add_u32 s13, s12, 2097152
buffer_load_dwordx4 v[80:83], v5, s[84:87], s13 offen
buffer_load_dwordx4 v[84:87], v5, s[84:87], s13 offen offset:128
buffer_load_dwordx4 v[88:91], v5, s[84:87], s13 offen offset:256
buffer_load_dwordx4 v[92:95], v5, s[84:87], s13 offen offset:384
s_add_u32 s13, s12, 3145728
buffer_load_dwordx4 v[96:99], v5, s[84:87], s13 offen
buffer_load_dwordx4 v[100:103], v5, s[84:87], s13 offen offset:128
buffer_load_dwordx4 v[104:107], v5, s[84:87], s13 offen offset:256
buffer_load_dwordx4 v[108:111], v5, s[84:87], s13 offen offset:384
s_add_u32 s13, s12, 4194304
buffer_load_dwordx4 v[112:115], v5, s[84:87], s13 offen
buffer_load_dwordx4 v[116:119], v5, s[84:87], s13 offen offset:128
buffer_load_dwordx4 v[120:123], v5, s[84:87], s13 offen offset:256
buffer_load_dwordx4 v[124:127], v5, s[84:87], s13 offen offset:384
s_add_u32 s13, s12, 5242880
buffer_load_dwordx4 v[128:131], v5, s[84:87], s13 offen
buffer_load_dwordx4 v[132:135], v5, s[84:87], s13 offen offset:128
buffer_load_dwordx4 v[136:139], v5, s[84:87], s13 offen offset:256
buffer_load_dwordx4 v[140:143], v5, s[84:87], s13 offen offset:384
s_add_u32 s13, s12, 6291456
buffer_load_dwordx4 v[144:147], v5, s[84:87], s13 offen
buffer_load_dwordx4 v[148:151], v5, s[84:87], s13 offen offset:128
buffer_load_dwordx4 v[152:155], v5, s[84:87], s13 offen offset:256
buffer_load_dwordx4 v[156:159], v5, s[84:87], s13 offen offset:384
s_add_u32 s13, s12, 7340032
buffer_load_dwordx4 v[160:163], v5, s[84:87], s13 offen
buffer_load_dwordx4 v[164:167], v5, s[84:87], s13 offen offset:128
buffer_load_dwordx4 v[168:171], v5, s[84:87], s13 offen offset:256
buffer_load_dwordx4 v[172:175], v5, s[84:87], s13 offen offset:384
s_add_u32 s13, s12, 8388608
buffer_load_dwordx4 v[176:179], v5, s[84:87], s13 offen
buffer_load_dwordx4 v[180:183], v5, s[84:87], s13 offen offset:128
buffer_load_dwordx4 v[184:187], v5, s[84:87], s13 offen offset:256
buffer_load_dwordx4 v[188:191], v5, s[84:87], s13 offen offset:384
v_cmp_eq_u32 vcc, 0, v1
s_waitcnt lgkmcnt(0)
s_mov_b32 s6, 8388608
s_mov_b32 s7, 0x00020000
v_sub_u32 v7, 1024, v1
v_add_u32 v8, -1, v7
v_and_b32 v7, 1023, v7
v_lshl_add_u32 v7, v7, 4, v6
v_lshl_add_u32 v8, v8, 4, v6
s_waitcnt vmcnt(32)
v_cndmask_b32 v50, v50, 0, vcc
v_cndmask_b32 v54, v54, 0, vcc
v_cndmask_b32 v58, v58, 0, vcc
v_cndmask_b32 v62, v62, 0, vcc
v_sub_f32 v16, v48, v54
v_add_f32 v18, v50, v52
v_add_f32 v24, v48, v54
v_sub_f32 v26, v52, v50
v_sub_f32 v17, v56, v62
v_add_f32 v19, v58, v60
v_add_f32 v25, v56, v62
v_sub_f32 v27, v60, v58
v_sub_f32 v20, v49, v55
v_add_f32 v22, v51, v53
v_add_f32 v28, v49, v55
v_sub_f32 v30, v53, v51
v_sub_f32 v21, v57, v63
v_add_f32 v23, v59, v61
v_add_f32 v29, v57, v63
v_sub_f32 v31, v61, v59
ds_write_b128 v4, v[16:19]
ds_write_b128 v4, v[20:23] offset:16
ds_write_b128 v7, v[24:27]
ds_write_b128 v8, v[28:31]
v_sub_u32 v7, 960, v1
v_add_u32 v8, -1, v7
v_and_b32 v7, 1023, v7
v_lshl_add_u32 v7, v7, 4, v6
v_lshl_add_u32 v8, v8, 4, v6
s_waitcnt vmcnt(28)
v_sub_f32 v32, v64, v70
v_add_f32 v34, v66, v68
v_add_f32 v40, v64, v70
v_sub_f32 v42, v68, v66
v_sub_f32 v33, v72, v78
v_add_f32 v35, v74, v76
v_add_f32 v41, v72, v78
v_sub_f32 v43, v76, v74
v_sub_f32 v36, v65, v71
v_add_f32 v38, v67, v69
v_add_f32 v44, v65, v71
v_sub_f32 v46, v69, v67
v_sub_f32 v37, v73, v79
v_add_f32 v39, v75, v77
v_add_f32 v45, v73, v79
v_sub_f32 v47, v77, v75
ds_write_b128 v4, v[32:35] offset:1024
ds_write_b128 v4, v[36:39] offset:1040
ds_write_b128 v7, v[40:43]
ds_write_b128 v8, v[44:47]
v_sub_u32 v7, 896, v1
v_add_u32 v8, -1, v7
v_and_b32 v7, 1023, v7
v_lshl_add_u32 v7, v7, 4, v6
v_lshl_add_u32 v8, v8, 4, v6
s_waitcnt vmcnt(24)
s_waitcnt lgkmcnt(4)
v_sub_f32 v16, v80, v86
v_add_f32 v18, v82, v84
v_add_f32 v24, v80, v86
v_sub_f32 v26, v84, v82
v_sub_f32 v17, v88, v94
v_add_f32 v19, v90, v92
v_add_f32 v25, v88, v94
v_sub_f32 v27, v92, v90
v_sub_f32 v20, v81, v87
v_add_f32 v22, v83, v85
v_add_f32 v28, v81, v87
v_sub_f32 v30, v85, v83
v_sub_f32 v21, v89, v95
v_add_f32 v23, v91, v93
v_add_f32 v29, v89, v95
v_sub_f32 v31, v93, v91
ds_write_b128 v4, v[16:19] offset:2048
ds_write_b128 v4, v[20:23] offset:2064
ds_write_b128 v7, v[24:27]
ds_write_b128 v8, v[28:31]
v_sub_u32 v7, 832, v1
v_add_u32 v8, -1, v7
v_and_b32 v7, 1023, v7
v_lshl_add_u32 v7, v7, 4, v6
v_lshl_add_u32 v8, v8, 4, v6
s_waitcnt vmcnt(20)
s_waitcnt lgkmcnt(4)
v_sub_f32 v32, v96, v102
v_add_f32 v34, v98, v100
v_add_f32 v40, v96, v102
v_sub_f32 v42, v100, v98
v_sub_f32 v33, v104, v110
v_add_f32 v35, v106, v108
v_add_f32 v41, v104, v110
v_sub_f32 v43, v108, v106
v_sub_f32 v36, v97, v103
v_add_f32 v38, v99, v101
v_add_f32 v44, v97, v103
v_sub_f32 v46, v101, v99
v_sub_f32 v37, v105, v111
v_add_f32 v39, v107, v109
v_add_f32 v45, v105, v111
v_sub_f32 v47, v109, v107
ds_write_b128 v4, v[32:35] offset:3072
ds_write_b128 v4, v[36:39] offset:3088
ds_write_b128 v7, v[40:43]
ds_write_b128 v8, v[44:47]
v_sub_u32 v7, 768, v1
v_add_u32 v8, -1, v7
v_and_b32 v7, 1023, v7
v_lshl_add_u32 v7, v7, 4, v6
v_lshl_add_u32 v8, v8, 4, v6
s_waitcnt vmcnt(16)
s_waitcnt lgkmcnt(4)
v_sub_f32 v16, v112, v118
v_add_f32 v18, v114, v116
v_add_f32 v24, v112, v118
v_sub_f32 v26, v116, v114
v_sub_f32 v17, v120, v126
v_add_f32 v19, v122, v124
v_add_f32 v25, v120, v126
v_sub_f32 v27, v124, v122
v_sub_f32 v20, v113, v119
v_add_f32 v22, v115, v117
v_add_f32 v28, v113, v119
v_sub_f32 v30, v117, v115
v_sub_f32 v21, v121, v127
v_add_f32 v23, v123, v125
v_add_f32 v29, v121, v127
v_sub_f32 v31, v125, v123
ds_write_b128 v4, v[16:19] offset:4096
ds_write_b128 v4, v[20:23] offset:4112
ds_write_b128 v7, v[24:27]
ds_write_b128 v8, v[28:31]
v_sub_u32 v7, 704, v1
v_add_u32 v8, -1, v7
v_and_b32 v7, 1023, v7
v_lshl_add_u32 v7, v7, 4, v6
v_lshl_add_u32 v8, v8, 4, v6
s_waitcnt vmcnt(12)
s_waitcnt lgkmcnt(4)
v_sub_f32 v32, v128, v134
v_add_f32 v34, v130, v132
v_add_f32 v40, v128, v134
v_sub_f32 v42, v132, v130
v_sub_f32 v33, v136, v142
v_add_f32 v35, v138, v140
v_add_f32 v41, v136, v142
v_sub_f32 v43, v140, v138
v_sub_f32 v36, v129, v135
v_add_f32 v38, v131, v133
v_add_f32 v44, v129, v135
v_sub_f32 v46, v133, v131
v_sub_f32 v37, v137, v143
v_add_f32 v39, v139, v141
v_add_f32 v45, v137, v143
v_sub_f32 v47, v141, v139
ds_write_b128 v4, v[32:35] offset:5120
ds_write_b128 v4, v[36:39] offset:5136
ds_write_b128 v7, v[40:43]
ds_write_b128 v8, v[44:47]
v_sub_u32 v7, 640, v1
v_add_u32 v8, -1, v7
v_and_b32 v7, 1023, v7
v_lshl_add_u32 v7, v7, 4, v6
v_lshl_add_u32 v8, v8, 4, v6
s_waitcnt vmcnt(8)
s_waitcnt lgkmcnt(4)
v_sub_f32 v16, v144, v150
v_add_f32 v18, v146, v148
v_add_f32 v24, v144, v150
v_sub_f32 v26, v148, v146
v_sub_f32 v17, v152, v158
v_add_f32 v19, v154, v156
v_add_f32 v25, v152, v158
v_sub_f32 v27, v156, v154
v_sub_f32 v20, v145, v151
v_add_f32 v22, v147, v149
v_add_f32 v28, v145, v151
v_sub_f32 v30, v149, v147
v_sub_f32 v21, v153, v159
v_add_f32 v23, v155, v157
v_add_f32 v29, v153, v159
v_sub_f32 v31, v157, v155
ds_write_b128 v4, v[16:19] offset:6144
ds_write_b128 v4, v[20:23] offset:6160
ds_write_b128 v7, v[24:27]
ds_write_b128 v8, v[28:31]
v_sub_u32 v7, 576, v1
v_add_u32 v8, -1, v7
v_and_b32 v7, 1023, v7
v_lshl_add_u32 v7, v7, 4, v6
v_lshl_add_u32 v8, v8, 4, v6
s_waitcnt vmcnt(4)
s_waitcnt lgkmcnt(4)
v_sub_f32 v32, v160, v166
v_add_f32 v34, v162, v164
v_add_f32 v40, v160, v166
v_sub_f32 v42, v164, v162
v_sub_f32 v33, v168, v174
v_add_f32 v35, v170, v172
v_add_f32 v41, v168, v174
v_sub_f32 v43, v172, v170
v_sub_f32 v36, v161, v167
v_add_f32 v38, v163, v165
v_add_f32 v44, v161, v167
v_sub_f32 v46, v165, v163
v_sub_f32 v37, v169, v175
v_add_f32 v39, v171, v173
v_add_f32 v45, v169, v175
v_sub_f32 v47, v173, v171
ds_write_b128 v4, v[32:35] offset:7168
ds_write_b128 v4, v[36:39] offset:7184
ds_write_b128 v7, v[40:43]
ds_write_b128 v8, v[44:47]
v_sub_u32 v7, 512, v1
v_add_u32 v8, -1, v7
v_and_b32 v7, 1023, v7
v_lshl_add_u32 v7, v7, 4, v6
v_lshl_add_u32 v8, v8, 4, v6
s_waitcnt vmcnt(0)
v_cndmask_b32 v178, v178, 0, vcc
v_cndmask_b32 v182, v182, 0, vcc
v_cndmask_b32 v186, v186, 0, vcc
v_cndmask_b32 v190, v190, 0, vcc
s_waitcnt lgkmcnt(4)
v_sub_f32 v16, v176, v182
v_add_f32 v18, v178, v180
v_add_f32 v24, v176, v182
v_sub_f32 v26, v180, v178
v_sub_f32 v17, v184, v190
v_add_f32 v19, v186, v188
v_add_f32 v25, v184, v190
v_sub_f32 v27, v188, v186
s_and_saveexec_b64 s[14:15], vcc
ds_write_b128 v4, v[16:19] offset:8192
s_mov_b64 exec, s[14:15]
s_waitcnt lgkmcnt(0)
s_barrier
v_and_b32 v1, 31, v0
v_lshrrev_b32 v2, 5, v0
v_cvt_f32_u32 v3, v1
v_mul_u32_u24 v6, 16896, v2
v_lshl_add_u32 v4, v1, 4, v6
v_mul_u32_u24 v5, 528, v1
v_add_u32 v5, v5, v6
ds_read_b128 v[16:19], v4
ds_read_b128 v[20:23], v4 offset:512
ds_read_b128 v[24:27], v4 offset:1024
ds_read_b128 v[28:31], v4 offset:1536
ds_read_b128 v[32:35], v4 offset:2048
ds_read_b128 v[36:39], v4 offset:2560
ds_read_b128 v[40:43], v4 offset:3072
ds_read_b128 v[44:47], v4 offset:3584
ds_read_b128 v[48:51], v4 offset:4096
ds_read_b128 v[52:55], v4 offset:4608
ds_read_b128 v[56:59], v4 offset:5120
ds_read_b128 v[60:63], v4 offset:5632
s_waitcnt lgkmcnt(4)
ds_read_b128 v[64:67], v4 offset:6144
ds_read_b128 v[68:71], v4 offset:6656
ds_read_b128 v[72:75], v4 offset:7168
ds_read_b128 v[76:79], v4 offset:7680
ds_read_b128 v[80:83], v4 offset:8192
ds_read_b128 v[84:87], v4 offset:8704
ds_read_b128 v[88:91], v4 offset:9216
ds_read_b128 v[92:95], v4 offset:9728
ds_read_b128 v[96:99], v4 offset:10240
ds_read_b128 v[100:103], v4 offset:10752
ds_read_b128 v[104:107], v4 offset:11264
ds_read_b128 v[108:111], v4 offset:11776
s_waitcnt lgkmcnt(4)
ds_read_b128 v[112:115], v4 offset:12288
ds_read_b128 v[116:119], v4 offset:12800
ds_read_b128 v[120:123], v4 offset:13312
ds_read_b128 v[124:127], v4 offset:13824
ds_read_b128 v[128:131], v4 offset:14336
ds_read_b128 v[132:135], v4 offset:14848
ds_read_b128 v[136:139], v4 offset:15360
ds_read_b128 v[140:143], v4 offset:15872
s_waitcnt lgkmcnt(0)
v_pk_add_f32 v[144:145], v[16:17], v[80:81] neg_lo:[0,1] neg_hi:[0,1]
v_pk_add_f32 v[146:147], v[18:19], v[82:83] neg_lo:[0,1] neg_hi:[0,1]
v_pk_add_f32 v[16:17], v[16:17], v[80:81]
v_pk_add_f32 v[18:19], v[18:19], v[82:83]
v_pk_add_f32 v[80:81], v[20:21], v[84:85] neg_lo:[0,1] neg_hi:[0,1]
v_pk_add_f32 v[82:83], v[22:23], v[86:87] neg_lo:[0,1] neg_hi:[0,1]
v_pk_add_f32 v[20:21], v[20:21], v[84:85]
v_pk_add_f32 v[22:23], v[22:23], v[86:87]
v_pk_mul_f32 v[84:85], v[80:81], s[30:31] op_sel_hi:[1,0]
v_pk_mul_f32 v[86:87], v[80:81], s[36:37] op_sel_hi:[1,0]
v_pk_fma_f32 v[84:85], v[82:83], s[36:37], v[84:85] op_sel_hi:[1,0,1] neg_lo:[0,1,0] neg_hi:[0,1,0]
v_pk_fma_f32 v[86:87], v[82:83], s[30:31], v[86:87] op_sel_hi:[1,0,1]
v_pk_add_f32 v[80:81], v[24:25], v[88:89] neg_lo:[0,1] neg_hi:[0,1]
v_pk_add_f32 v[82:83], v[26:27], v[90:91] neg_lo:[0,1] neg_hi:[0,1]
v_pk_add_f32 v[24:25], v[24:25], v[88:89]
v_pk_add_f32 v[26:27], v[26:27], v[90:91]
v_pk_mul_f32 v[88:89], v[80:81], s[30:31] op_sel:[0,1]
v_pk_mul_f32 v[90:91], v[80:81], s[34:35] op_sel:[0,1]
v_pk_fma_f32 v[88:89], v[82:83], s[34:35], v[88:89] op_sel:[0,1,0] neg_lo:[0,1,0] neg_hi:[0,1,0]
v_pk_fma_f32 v[90:91], v[82:83], s[30:31], v[90:91] op_sel:[0,1,0]
v_pk_add_f32 v[80:81], v[28:29], v[92:93] neg_lo:[0,1] neg_hi:[0,1]
v_pk_add_f32 v[82:83], v[30:31], v[94:95] neg_lo:[0,1] neg_hi:[0,1]
v_pk_add_f32 v[28:29], v[28:29], v[92:93]
v_pk_add_f32 v[30:31], v[30:31], v[94:95]
v_pk_mul_f32 v[92:93], v[80:81], s[32:33] op_sel_hi:[1,0]
v_pk_mul_f32 v[94:95], v[80:81], s[34:35] op_sel_hi:[1,0]
v_pk_fma_f32 v[92:93], v[82:83], s[34:35], v[92:93] op_sel_hi:[1,0,1] neg_lo:[0,1,0] neg_hi:[0,1,0]
v_pk_fma_f32 v[94:95], v[82:83], s[32:33], v[94:95] op_sel_hi:[1,0,1]
v_pk_add_f32 v[80:81], v[32:33], v[96:97] neg_lo:[0,1] neg_hi:[0,1]
v_pk_add_f32 v[82:83], v[34:35], v[98:99] neg_lo:[0,1] neg_hi:[0,1]
v_pk_add_f32 v[32:33], v[32:33], v[96:97]
v_pk_add_f32 v[34:35], v[34:35], v[98:99]
v_pk_mul_f32 v[96:97], v[80:81], s[32:33] op_sel:[0,1]
v_pk_mul_f32 v[98:99], v[80:81], s[32:33] op_sel:[0,1]
v_pk_fma_f32 v[96:97], v[82:83], s[32:33], v[96:97] op_sel:[0,1,0] neg_lo:[0,1,0] neg_hi:[0,1,0]
v_pk_fma_f32 v[98:99], v[82:83], s[32:33], v[98:99] op_sel:[0,1,0]
v_pk_add_f32 v[80:81], v[36:37], v[100:101] neg_lo:[0,1] neg_hi:[0,1]
v_pk_add_f32 v[82:83], v[38:39], v[102:103] neg_lo:[0,1] neg_hi:[0,1]
v_pk_add_f32 v[36:37], v[36:37], v[100:101]
v_pk_add_f32 v[38:39], v[38:39], v[102:103]
v_pk_mul_f32 v[100:101], v[80:81], s[34:35] op_sel_hi:[1,0]
v_pk_mul_f32 v[102:103], v[80:81], s[32:33] op_sel_hi:[1,0]
v_pk_fma_f32 v[100:101], v[82:83], s[32:33], v[100:101] op_sel_hi:[1,0,1] neg_lo:[0,1,0] neg_hi:[0,1,0]
v_pk_fma_f32 v[102:103], v[82:83], s[34:35], v[102:103] op_sel_hi:[1,0,1]
v_pk_add_f32 v[80:81], v[40:41], v[104:105] neg_lo:[0,1] neg_hi:[0,1]
v_pk_add_f32 v[82:83], v[42:43], v[106:107] neg_lo:[0,1] neg_hi:[0,1]
v_pk_add_f32 v[40:41], v[40:41], v[104:105]
v_pk_add_f32 v[42:43], v[42:43], v[106:107]
v_pk_mul_f32 v[104:105], v[80:81], s[34:35] op_sel:[0,1]
v_pk_mul_f32 v[106:107], v[80:81], s[30:31] op_sel:[0,1]
v_pk_fma_f32 v[104:105], v[82:83], s[30:31], v[104:105] op_sel:[0,1,0] neg_lo:[0,1,0] neg_hi:[0,1,0]
v_pk_fma_f32 v[106:107], v[82:83], s[34:35], v[106:107] op_sel:[0,1,0]
v_pk_add_f32 v[80:81], v[44:45], v[108:109] neg_lo:[0,1] neg_hi:[0,1]
v_pk_add_f32 v[82:83], v[46:47], v[110:111] neg_lo:[0,1] neg_hi:[0,1]
v_pk_add_f32 v[44:45], v[44:45], v[108:109]
v_pk_add_f32 v[46:47], v[46:47], v[110:111]
v_pk_mul_f32 v[108:109], v[80:81], s[36:37] op_sel_hi:[1,0]
v_pk_mul_f32 v[110:111], v[80:81], s[30:31] op_sel_hi:[1,0]
v_pk_fma_f32 v[108:109], v[82:83], s[30:31], v[108:109] op_sel_hi:[1,0,1] neg_lo:[0,1,0] neg_hi:[0,1,0]
v_pk_fma_f32 v[110:111], v[82:83], s[36:37], v[110:111] op_sel_hi:[1,0,1]
v_pk_add_f32 v[80:81], v[114:115], v[50:51] neg_lo:[0,1] neg_hi:[0,1]
v_pk_add_f32 v[82:83], v[48:49], v[112:113] neg_lo:[0,1] neg_hi:[0,1]
v_pk_add_f32 v[48:49], v[48:49], v[112:113]
v_pk_add_f32 v[50:51], v[50:51], v[114:115]
v_pk_add_f32 v[112:113], v[52:53], v[116:117] neg_lo:[0,1] neg_hi:[0,1]
v_pk_add_f32 v[114:115], v[54:55], v[118:119] neg_lo:[0,1] neg_hi:[0,1]
v_pk_add_f32 v[52:53], v[52:53], v[116:117]
v_pk_add_f32 v[54:55], v[54:55], v[118:119]
v_pk_mul_f32 v[116:117], v[112:113], s[36:37] op_sel_hi:[1,0] neg_lo:[0,1] neg_hi:[0,1]
v_pk_mul_f32 v[118:119], v[112:113], s[30:31] op_sel_hi:[1,0]
v_pk_fma_f32 v[116:117], v[114:115], s[30:31], v[116:117] op_sel_hi:[1,0,1] neg_lo:[0,1,0] neg_hi:[0,1,0]
v_pk_fma_f32 v[118:119], v[114:115], s[36:37], v[118:119] op_sel_hi:[1,0,1] neg_lo:[0,1,0] neg_hi:[0,1,0]
v_pk_add_f32 v[112:113], v[56:57], v[120:121] neg_lo:[0,1] neg_hi:[0,1]
v_pk_add_f32 v[114:115], v[58:59], v[122:123] neg_lo:[0,1] neg_hi:[0,1]
v_pk_add_f32 v[56:57], v[56:57], v[120:121]
v_pk_add_f32 v[58:59], v[58:59], v[122:123]
v_pk_mul_f32 v[120:121], v[112:113], s[34:35] op_sel:[0,1] neg_lo:[0,1] neg_hi:[0,1]
v_pk_mul_f32 v[122:123], v[112:113], s[30:31] op_sel:[0,1]
v_pk_fma_f32 v[120:121], v[114:115], s[30:31], v[120:121] op_sel:[0,1,0] neg_lo:[0,1,0] neg_hi:[0,1,0]
v_pk_fma_f32 v[122:123], v[114:115], s[34:35], v[122:123] op_sel:[0,1,0] neg_lo:[0,1,0] neg_hi:[0,1,0]
v_pk_add_f32 v[112:113], v[60:61], v[124:125] neg_lo:[0,1] neg_hi:[0,1]
v_pk_add_f32 v[114:115], v[62:63], v[126:127] neg_lo:[0,1] neg_hi:[0,1]
v_pk_add_f32 v[60:61], v[60:61], v[124:125]
v_pk_add_f32 v[62:63], v[62:63], v[126:127]
v_pk_mul_f32 v[124:125], v[112:113], s[34:35] op_sel_hi:[1,0] neg_lo:[0,1] neg_hi:[0,1]
v_pk_mul_f32 v[126:127], v[112:113], s[32:33] op_sel_hi:[1,0]
v_pk_fma_f32 v[124:125], v[114:115], s[32:33], v[124:125] op_sel_hi:[1,0,1] neg_lo:[0,1,0] neg_hi:[0,1,0]
v_pk_fma_f32 v[126:127], v[114:115], s[34:35], v[126:127] op_sel_hi:[1,0,1] neg_lo:[0,1,0] neg_hi:[0,1,0]
v_pk_add_f32 v[112:113], v[64:65], v[128:129] neg_lo:[0,1] neg_hi:[0,1]
v_pk_add_f32 v[114:115], v[66:67], v[130:131] neg_lo:[0,1] neg_hi:[0,1]
v_pk_add_f32 v[64:65], v[64:65], v[128:129]
v_pk_add_f32 v[66:67], v[66:67], v[130:131]
v_pk_mul_f32 v[128:129], v[112:113], s[32:33] op_sel:[0,1] neg_lo:[0,1] neg_hi:[0,1]
v_pk_mul_f32 v[130:131], v[112:113], s[32:33] op_sel:[0,1]
v_pk_fma_f32 v[128:129], v[114:115], s[32:33], v[128:129] op_sel:[0,1,0] neg_lo:[0,1,0] neg_hi:[0,1,0]
v_pk_fma_f32 v[130:131], v[114:115], s[32:33], v[130:131] op_sel:[0,1,0] neg_lo:[0,1,0] neg_hi:[0,1,0]
v_pk_add_f32 v[112:113], v[68:69], v[132:133] neg_lo:[0,1] neg_hi:[0,1]
v_pk_add_f32 v[114:115], v[70:71], v[134:135] neg_lo:[0,1] neg_hi:[0,1]
v_pk_add_f32 v[68:69], v[68:69], v[132:133]
v_pk_add_f32 v[70:71], v[70:71], v[134:135]
v_pk_mul_f32 v[132:133], v[112:113], s[32:33] op_sel_hi:[1,0] neg_lo:[0,1] neg_hi:[0,1]
v_pk_mul_f32 v[134:135], v[112:113], s[34:35] op_sel_hi:[1,0]
v_pk_fma_f32 v[132:133], v[114:115], s[34:35], v[132:133] op_sel_hi:[1,0,1] neg_lo:[0,1,0] neg_hi:[0,1,0]
v_pk_fma_f32 v[134:135], v[114:115], s[32:33], v[134:135] op_sel_hi:[1,0,1] neg_lo:[0,1,0] neg_hi:[0,1,0]
v_pk_add_f32 v[112:113], v[72:73], v[136:137] neg_lo:[0,1] neg_hi:[0,1]
v_pk_add_f32 v[114:115], v[74:75], v[138:139] neg_lo:[0,1] neg_hi:[0,1]
v_pk_add_f32 v[72:73], v[72:73], v[136:137]
v_pk_add_f32 v[74:75], v[74:75], v[138:139]
v_pk_mul_f32 v[136:137], v[112:113], s[30:31] op_sel:[0,1] neg_lo:[0,1] neg_hi:[0,1]
v_pk_mul_f32 v[138:139], v[112:113], s[34:35] op_sel:[0,1]
v_pk_fma_f32 v[136:137], v[114:115], s[34:35], v[136:137] op_sel:[0,1,0] neg_lo:[0,1,0] neg_hi:[0,1,0]
v_pk_fma_f32 v[138:139], v[114:115], s[30:31], v[138:139] op_sel:[0,1,0] neg_lo:[0,1,0] neg_hi:[0,1,0]
v_pk_add_f32 v[112:113], v[76:77], v[140:141] neg_lo:[0,1] neg_hi:[0,1]
v_pk_add_f32 v[114:115], v[78:79], v[142:143] neg_lo:[0,1] neg_hi:[0,1]
v_pk_add_f32 v[76:77], v[76:77], v[140:141]
v_pk_add_f32 v[78:79], v[78:79], v[142:143]
v_pk_mul_f32 v[140:141], v[112:113], s[30:31] op_sel_hi:[1,0] neg_lo:[0,1] neg_hi:[0,1]
v_pk_mul_f32 v[142:143], v[112:113], s[36:37] op_sel_hi:[1,0]
v_pk_fma_f32 v[140:141], v[114:115], s[36:37], v[140:141] op_sel_hi:[1,0,1] neg_lo:[0,1,0] neg_hi:[0,1,0]
v_pk_fma_f32 v[142:143], v[114:115], s[30:31], v[142:143] op_sel_hi:[1,0,1] neg_lo:[0,1,0] neg_hi:[0,1,0]
v_pk_add_f32 v[112:113], v[16:17], v[48:49] neg_lo:[0,1] neg_hi:[0,1]
v_pk_add_f32 v[114:115], v[18:19], v[50:51] neg_lo:[0,1] neg_hi:[0,1]
v_pk_add_f32 v[16:17], v[16:17], v[48:49]
v_pk_add_f32 v[18:19], v[18:19], v[50:51]
v_pk_add_f32 v[48:49], v[20:21], v[52:53] neg_lo:[0,1] neg_hi:[0,1]
v_pk_add_f32 v[50:51], v[22:23], v[54:55] neg_lo:[0,1] neg_hi:[0,1]
v_pk_add_f32 v[20:21], v[20:21], v[52:53]
v_pk_add_f32 v[22:23], v[22:23], v[54:55]
v_pk_mul_f32 v[52:53], v[48:49], s[30:31] op_sel:[0,1]
v_pk_mul_f32 v[54:55], v[48:49], s[34:35] op_sel:[0,1]
v_pk_fma_f32 v[52:53], v[50:51], s[34:35], v[52:53] op_sel:[0,1,0] neg_lo:[0,1,0] neg_hi:[0,1,0]
v_pk_fma_f32 v[54:55], v[50:51], s[30:31], v[54:55] op_sel:[0,1,0]
v_pk_add_f32 v[48:49], v[24:25], v[56:57] neg_lo:[0,1] neg_hi:[0,1]
v_pk_add_f32 v[50:51], v[26:27], v[58:59] neg_lo:[0,1] neg_hi:[0,1]
v_pk_add_f32 v[24:25], v[24:25], v[56:57]
v_pk_add_f32 v[26:27], v[26:27], v[58:59]
v_pk_mul_f32 v[56:57], v[48:49], s[32:33] op_sel:[0,1]
v_pk_mul_f32 v[58:59], v[48:49], s[32:33] op_sel:[0,1]
v_pk_fma_f32 v[56:57], v[50:51], s[32:33], v[56:57] op_sel:[0,1,0] neg_lo:[0,1,0] neg_hi:[0,1,0]
v_pk_fma_f32 v[58:59], v[50:51], s[32:33], v[58:59] op_sel:[0,1,0]
v_pk_add_f32 v[48:49], v[28:29], v[60:61] neg_lo:[0,1] neg_hi:[0,1]
v_pk_add_f32 v[50:51], v[30:31], v[62:63] neg_lo:[0,1] neg_hi:[0,1]
v_pk_add_f32 v[28:29], v[28:29], v[60:61]
v_pk_add_f32 v[30:31], v[30:31], v[62:63]
v_pk_mul_f32 v[60:61], v[48:49], s[34:35] op_sel:[0,1]
v_pk_mul_f32 v[62:63], v[48:49], s[30:31] op_sel:[0,1]
v_pk_fma_f32 v[60:61], v[50:51], s[30:31], v[60:61] op_sel:[0,1,0] neg_lo:[0,1,0] neg_hi:[0,1,0]
v_pk_fma_f32 v[62:63], v[50:51], s[34:35], v[62:63] op_sel:[0,1,0]
v_pk_add_f32 v[48:49], v[66:67], v[34:35] neg_lo:[0,1] neg_hi:[0,1]
v_pk_add_f32 v[50:51], v[32:33], v[64:65] neg_lo:[0,1] neg_hi:[0,1]
v_pk_add_f32 v[32:33], v[32:33], v[64:65]
v_pk_add_f32 v[34:35], v[34:35], v[66:67]
v_pk_add_f32 v[64:65], v[36:37], v[68:69] neg_lo:[0,1] neg_hi:[0,1]
v_pk_add_f32 v[66:67], v[38:39], v[70:71] neg_lo:[0,1] neg_hi:[0,1]
v_pk_add_f32 v[36:37], v[36:37], v[68:69]
v_pk_add_f32 v[38:39], v[38:39], v[70:71]
v_pk_mul_f32 v[68:69], v[64:65], s[34:35] op_sel:[0,1] neg_lo:[0,1] neg_hi:[0,1]
v_pk_mul_f32 v[70:71], v[64:65], s[30:31] op_sel:[0,1]
v_pk_fma_f32 v[68:69], v[66:67], s[30:31], v[68:69] op_sel:[0,1,0] neg_lo:[0,1,0] neg_hi:[0,1,0]
v_pk_fma_f32 v[70:71], v[66:67], s[34:35], v[70:71] op_sel:[0,1,0] neg_lo:[0,1,0] neg_hi:[0,1,0]
v_pk_add_f32 v[64:65], v[40:41], v[72:73] neg_lo:[0,1] neg_hi:[0,1]
v_pk_add_f32 v[66:67], v[42:43], v[74:75] neg_lo:[0,1] neg_hi:[0,1]
v_pk_add_f32 v[40:41], v[40:41], v[72:73]
v_pk_add_f32 v[42:43], v[42:43], v[74:75]
v_pk_mul_f32 v[72:73], v[64:65], s[32:33] op_sel:[0,1] neg_lo:[0,1] neg_hi:[0,1]
v_pk_mul_f32 v[74:75], v[64:65], s[32:33] op_sel:[0,1]
v_pk_fma_f32 v[72:73], v[66:67], s[32:33], v[72:73] op_sel:[0,1,0] neg_lo:[0,1,0] neg_hi:[0,1,0]
v_pk_fma_f32 v[74:75], v[66:67], s[32:33], v[74:75] op_sel:[0,1,0] neg_lo:[0,1,0] neg_hi:[0,1,0]
v_pk_add_f32 v[64:65], v[44:45], v[76:77] neg_lo:[0,1] neg_hi:[0,1]
v_pk_add_f32 v[66:67], v[46:47], v[78:79] neg_lo:[0,1] neg_hi:[0,1]
v_pk_add_f32 v[44:45], v[44:45], v[76:77]
v_pk_add_f32 v[46:47], v[46:47], v[78:79]
v_pk_mul_f32 v[76:77], v[64:65], s[30:31] op_sel:[0,1] neg_lo:[0,1] neg_hi:[0,1]
v_pk_mul_f32 v[78:79], v[64:65], s[34:35] op_sel:[0,1]
v_pk_fma_f32 v[76:77], v[66:67], s[34:35], v[76:77] op_sel:[0,1,0] neg_lo:[0,1,0] neg_hi:[0,1,0]
v_pk_fma_f32 v[78:79], v[66:67], s[30:31], v[78:79] op_sel:[0,1,0] neg_lo:[0,1,0] neg_hi:[0,1,0]
v_pk_add_f32 v[64:65], v[144:145], v[80:81] neg_lo:[0,1] neg_hi:[0,1]
v_pk_add_f32 v[66:67], v[146:147], v[82:83] neg_lo:[0,1] neg_hi:[0,1]
v_pk_add_f32 v[144:145], v[144:145], v[80:81]
v_pk_add_f32 v[146:147], v[146:147], v[82:83]
v_pk_add_f32 v[80:81], v[84:85], v[116:117] neg_lo:[0,1] neg_hi:[0,1]
v_pk_add_f32 v[82:83], v[86:87], v[118:119] neg_lo:[0,1] neg_hi:[0,1]
v_pk_add_f32 v[84:85], v[84:85], v[116:117]
v_pk_add_f32 v[86:87], v[86:87], v[118:119]
v_pk_mul_f32 v[116:117], v[80:81], s[30:31] op_sel:[0,1]
v_pk_mul_f32 v[118:119], v[80:81], s[34:35] op_sel:[0,1]
v_pk_fma_f32 v[116:117], v[82:83], s[34:35], v[116:117] op_sel:[0,1,0] neg_lo:[0,1,0] neg_hi:[0,1,0]
v_pk_fma_f32 v[118:119], v[82:83], s[30:31], v[118:119] op_sel:[0,1,0]
v_pk_add_f32 v[80:81], v[88:89], v[120:121] neg_lo:[0,1] neg_hi:[0,1]
v_pk_add_f32 v[82:83], v[90:91], v[122:123] neg_lo:[0,1] neg_hi:[0,1]
v_pk_add_f32 v[88:89], v[88:89], v[120:121]
v_pk_add_f32 v[90:91], v[90:91], v[122:123]
v_pk_mul_f32 v[120:121], v[80:81], s[32:33] op_sel:[0,1]
v_pk_mul_f32 v[122:123], v[80:81], s[32:33] op_sel:[0,1]
v_pk_fma_f32 v[120:121], v[82:83], s[32:33], v[120:121] op_sel:[0,1,0] neg_lo:[0,1,0] neg_hi:[0,1,0]
v_pk_fma_f32 v[122:123], v[82:83], s[32:33], v[122:123] op_sel:[0,1,0]
v_pk_add_f32 v[80:81], v[92:93], v[124:125] neg_lo:[0,1] neg_hi:[0,1]
v_pk_add_f32 v[82:83], v[94:95], v[126:127] neg_lo:[0,1] neg_hi:[0,1]
v_pk_add_f32 v[92:93], v[92:93], v[124:125]
v_pk_add_f32 v[94:95], v[94:95], v[126:127]
v_pk_mul_f32 v[124:125], v[80:81], s[34:35] op_sel:[0,1]
v_pk_mul_f32 v[126:127], v[80:81], s[30:31] op_sel:[0,1]
v_pk_fma_f32 v[124:125], v[82:83], s[30:31], v[124:125] op_sel:[0,1,0] neg_lo:[0,1,0] neg_hi:[0,1,0]
v_pk_fma_f32 v[126:127], v[82:83], s[34:35], v[126:127] op_sel:[0,1,0]
v_pk_add_f32 v[80:81], v[130:131], v[98:99] neg_lo:[0,1] neg_hi:[0,1]
v_pk_add_f32 v[82:83], v[96:97], v[128:129] neg_lo:[0,1] neg_hi:[0,1]
v_pk_add_f32 v[96:97], v[96:97], v[128:129]
v_pk_add_f32 v[98:99], v[98:99], v[130:131]
v_pk_add_f32 v[128:129], v[100:101], v[132:133] neg_lo:[0,1] neg_hi:[0,1]
v_pk_add_f32 v[130:131], v[102:103], v[134:135] neg_lo:[0,1] neg_hi:[0,1]
v_pk_add_f32 v[100:101], v[100:101], v[132:133]
v_pk_add_f32 v[102:103], v[102:103], v[134:135]
v_pk_mul_f32 v[132:133], v[128:129], s[34:35] op_sel:[0,1] neg_lo:[0,1] neg_hi:[0,1]
v_pk_mul_f32 v[134:135], v[128:129], s[30:31] op_sel:[0,1]
v_pk_fma_f32 v[132:133], v[130:131], s[30:31], v[132:133] op_sel:[0,1,0] neg_lo:[0,1,0] neg_hi:[0,1,0]
v_pk_fma_f32 v[134:135], v[130:131], s[34:35], v[134:135] op_sel:[0,1,0] neg_lo:[0,1,0] neg_hi:[0,1,0]
v_pk_add_f32 v[128:129], v[104:105], v[136:137] neg_lo:[0,1] neg_hi:[0,1]
v_pk_add_f32 v[130:131], v[106:107], v[138:139] neg_lo:[0,1] neg_hi:[0,1]
v_pk_add_f32 v[104:105], v[104:105], v[136:137]
v_pk_add_f32 v[106:107], v[106:107], v[138:139]
v_pk_mul_f32 v[136:137], v[128:129], s[32:33] op_sel:[0,1] neg_lo:[0,1] neg_hi:[0,1]
v_pk_mul_f32 v[138:139], v[128:129], s[32:33] op_sel:[0,1]
v_pk_fma_f32 v[136:137], v[130:131], s[32:33], v[136:137] op_sel:[0,1,0] neg_lo:[0,1,0] neg_hi:[0,1,0]
v_pk_fma_f32 v[138:139], v[130:131], s[32:33], v[138:139] op_sel:[0,1,0] neg_lo:[0,1,0] neg_hi:[0,1,0]
v_pk_add_f32 v[128:129], v[108:109], v[140:141] neg_lo:[0,1] neg_hi:[0,1]
v_pk_add_f32 v[130:131], v[110:111], v[142:143] neg_lo:[0,1] neg_hi:[0,1]
v_pk_add_f32 v[108:109], v[108:109], v[140:141]
v_pk_add_f32 v[110:111], v[110:111], v[142:143]
v_pk_mul_f32 v[140:141], v[128:129], s[30:31] op_sel:[0,1] neg_lo:[0,1] neg_hi:[0,1]
v_pk_mul_f32 v[142:143], v[128:129], s[34:35] op_sel:[0,1]
v_pk_fma_f32 v[140:141], v[130:131], s[34:35], v[140:141] op_sel:[0,1,0] neg_lo:[0,1,0] neg_hi:[0,1,0]
v_pk_fma_f32 v[142:143], v[130:131], s[30:31], v[142:143] op_sel:[0,1,0] neg_lo:[0,1,0] neg_hi:[0,1,0]
v_pk_add_f32 v[128:129], v[16:17], v[32:33] neg_lo:[0,1] neg_hi:[0,1]
v_pk_add_f32 v[130:131], v[18:19], v[34:35] neg_lo:[0,1] neg_hi:[0,1]
v_pk_add_f32 v[16:17], v[16:17], v[32:33]
v_pk_add_f32 v[18:19], v[18:19], v[34:35]
v_pk_add_f32 v[32:33], v[20:21], v[36:37] neg_lo:[0,1] neg_hi:[0,1]
v_pk_add_f32 v[34:35], v[22:23], v[38:39] neg_lo:[0,1] neg_hi:[0,1]
v_pk_add_f32 v[20:21], v[20:21], v[36:37]
v_pk_add_f32 v[22:23], v[22:23], v[38:39]
v_pk_mul_f32 v[36:37], v[32:33], s[32:33] op_sel:[0,1]
v_pk_mul_f32 v[38:39], v[32:33], s[32:33] op_sel:[0,1]
v_pk_fma_f32 v[36:37], v[34:35], s[32:33], v[36:37] op_sel:[0,1,0] neg_lo:[0,1,0] neg_hi:[0,1,0]
v_pk_fma_f32 v[38:39], v[34:35], s[32:33], v[38:39] op_sel:[0,1,0]
v_pk_add_f32 v[32:33], v[42:43], v[26:27] neg_lo:[0,1] neg_hi:[0,1]
v_pk_add_f32 v[34:35], v[24:25], v[40:41] neg_lo:[0,1] neg_hi:[0,1]
v_pk_add_f32 v[24:25], v[24:25], v[40:41]
v_pk_add_f32 v[26:27], v[26:27], v[42:43]
v_pk_add_f32 v[40:41], v[28:29], v[44:45] neg_lo:[0,1] neg_hi:[0,1]
v_pk_add_f32 v[42:43], v[30:31], v[46:47] neg_lo:[0,1] neg_hi:[0,1]
v_pk_add_f32 v[28:29], v[28:29], v[44:45]
v_pk_add_f32 v[30:31], v[30:31], v[46:47]
v_pk_mul_f32 v[44:45], v[40:41], s[32:33] op_sel:[0,1] neg_lo:[0,1] neg_hi:[0,1]
v_pk_mul_f32 v[46:47], v[40:41], s[32:33] op_sel:[0,1]
v_pk_fma_f32 v[44:45], v[42:43], s[32:33], v[44:45] op_sel:[0,1,0] neg_lo:[0,1,0] neg_hi:[0,1,0]
v_pk_fma_f32 v[46:47], v[42:43], s[32:33], v[46:47] op_sel:[0,1,0] neg_lo:[0,1,0] neg_hi:[0,1,0]
v_pk_add_f32 v[40:41], v[112:113], v[48:49] neg_lo:[0,1] neg_hi:[0,1]
v_pk_add_f32 v[42:43], v[114:115], v[50:51] neg_lo:[0,1] neg_hi:[0,1]
v_pk_add_f32 v[112:113], v[112:113], v[48:49]
v_pk_add_f32 v[114:115], v[114:115], v[50:51]
v_pk_add_f32 v[48:49], v[52:53], v[68:69] neg_lo:[0,1] neg_hi:[0,1]
v_pk_add_f32 v[50:51], v[54:55], v[70:71] neg_lo:[0,1] neg_hi:[0,1]
v_pk_add_f32 v[52:53], v[52:53], v[68:69]
v_pk_add_f32 v[54:55], v[54:55], v[70:71]
v_pk_mul_f32 v[68:69], v[48:49], s[32:33] op_sel:[0,1]
v_pk_mul_f32 v[70:71], v[48:49], s[32:33] op_sel:[0,1]
v_pk_fma_f32 v[68:69], v[50:51], s[32:33], v[68:69] op_sel:[0,1,0] neg_lo:[0,1,0] neg_hi:[0,1,0]
v_pk_fma_f32 v[70:71], v[50:51], s[32:33], v[70:71] op_sel:[0,1,0]
v_pk_add_f32 v[48:49], v[74:75], v[58:59] neg_lo:[0,1] neg_hi:[0,1]
v_pk_add_f32 v[50:51], v[56:57], v[72:73] neg_lo:[0,1] neg_hi:[0,1]
v_pk_add_f32 v[56:57], v[56:57], v[72:73]
v_pk_add_f32 v[58:59], v[58:59], v[74:75]
v_pk_add_f32 v[72:73], v[60:61], v[76:77] neg_lo:[0,1] neg_hi:[0,1]
v_pk_add_f32 v[74:75], v[62:63], v[78:79] neg_lo:[0,1] neg_hi:[0,1]
v_pk_add_f32 v[60:61], v[60:61], v[76:77]
v_pk_add_f32 v[62:63], v[62:63], v[78:79]
v_pk_mul_f32 v[76:77], v[72:73], s[32:33] op_sel:[0,1] neg_lo:[0,1] neg_hi:[0,1]
v_pk_mul_f32 v[78:79], v[72:73], s[32:33] op_sel:[0,1]
v_pk_fma_f32 v[76:77], v[74:75], s[32:33], v[76:77] op_sel:[0,1,0] neg_lo:[0,1,0] neg_hi:[0,1,0]
v_pk_fma_f32 v[78:79], v[74:75], s[32:33], v[78:79] op_sel:[0,1,0] neg_lo:[0,1,0] neg_hi:[0,1,0]
v_pk_add_f32 v[72:73], v[144:145], v[96:97] neg_lo:[0,1] neg_hi:[0,1]
v_pk_add_f32 v[74:75], v[146:147], v[98:99] neg_lo:[0,1] neg_hi:[0,1]
v_pk_add_f32 v[144:145], v[144:145], v[96:97]
v_pk_add_f32 v[146:147], v[146:147], v[98:99]
v_pk_add_f32 v[96:97], v[84:85], v[100:101] neg_lo:[0,1] neg_hi:[0,1]
v_pk_add_f32 v[98:99], v[86:87], v[102:103] neg_lo:[0,1] neg_hi:[0,1]
v_pk_add_f32 v[84:85], v[84:85], v[100:101]
v_pk_add_f32 v[86:87], v[86:87], v[102:103]
v_pk_mul_f32 v[100:101], v[96:97], s[32:33] op_sel:[0,1]
v_pk_mul_f32 v[102:103], v[96:97], s[32:33] op_sel:[0,1]
v_pk_fma_f32 v[100:101], v[98:99], s[32:33], v[100:101] op_sel:[0,1,0] neg_lo:[0,1,0] neg_hi:[0,1,0]
v_pk_fma_f32 v[102:103], v[98:99], s[32:33], v[102:103] op_sel:[0,1,0]
v_pk_add_f32 v[96:97], v[106:107], v[90:91] neg_lo:[0,1] neg_hi:[0,1]
v_pk_add_f32 v[98:99], v[88:89], v[104:105] neg_lo:[0,1] neg_hi:[0,1]
v_pk_add_f32 v[88:89], v[88:89], v[104:105]
v_pk_add_f32 v[90:91], v[90:91], v[106:107]
v_pk_add_f32 v[104:105], v[92:93], v[108:109] neg_lo:[0,1] neg_hi:[0,1]
v_pk_add_f32 v[106:107], v[94:95], v[110:111] neg_lo:[0,1] neg_hi:[0,1]
v_pk_add_f32 v[92:93], v[92:93], v[108:109]
v_pk_add_f32 v[94:95], v[94:95], v[110:111]
v_pk_mul_f32 v[108:109], v[104:105], s[32:33] op_sel:[0,1] neg_lo:[0,1] neg_hi:[0,1]
v_pk_mul_f32 v[110:111], v[104:105], s[32:33] op_sel:[0,1]
v_pk_fma_f32 v[108:109], v[106:107], s[32:33], v[108:109] op_sel:[0,1,0] neg_lo:[0,1,0] neg_hi:[0,1,0]
v_pk_fma_f32 v[110:111], v[106:107], s[32:33], v[110:111] op_sel:[0,1,0] neg_lo:[0,1,0] neg_hi:[0,1,0]
v_pk_add_f32 v[104:105], v[64:65], v[80:81] neg_lo:[0,1] neg_hi:[0,1]
v_pk_add_f32 v[106:107], v[66:67], v[82:83] neg_lo:[0,1] neg_hi:[0,1]
v_pk_add_f32 v[64:65], v[64:65], v[80:81]
v_pk_add_f32 v[66:67], v[66:67], v[82:83]
v_pk_add_f32 v[80:81], v[116:117], v[132:133] neg_lo:[0,1] neg_hi:[0,1]
v_pk_add_f32 v[82:83], v[118:119], v[134:135] neg_lo:[0,1] neg_hi:[0,1]
v_pk_add_f32 v[116:117], v[116:117], v[132:133]
v_pk_add_f32 v[118:119], v[118:119], v[134:135]
v_pk_mul_f32 v[132:133], v[80:81], s[32:33] op_sel:[0,1]
v_pk_mul_f32 v[134:135], v[80:81], s[32:33] op_sel:[0,1]
v_pk_fma_f32 v[132:133], v[82:83], s[32:33], v[132:133] op_sel:[0,1,0] neg_lo:[0,1,0] neg_hi:[0,1,0]
v_pk_fma_f32 v[134:135], v[82:83], s[32:33], v[134:135] op_sel:[0,1,0]
v_pk_add_f32 v[80:81], v[138:139], v[122:123] neg_lo:[0,1] neg_hi:[0,1]
v_pk_add_f32 v[82:83], v[120:121], v[136:137] neg_lo:[0,1] neg_hi:[0,1]
v_pk_add_f32 v[120:121], v[120:121], v[136:137]
v_pk_add_f32 v[122:123], v[122:123], v[138:139]
v_pk_add_f32 v[136:137], v[124:125], v[140:141] neg_lo:[0,1] neg_hi:[0,1]
v_pk_add_f32 v[138:139], v[126:127], v[142:143] neg_lo:[0,1] neg_hi:[0,1]
v_pk_add_f32 v[124:125], v[124:125], v[140:141]
v_pk_add_f32 v[126:127], v[126:127], v[142:143]
v_pk_mul_f32 v[140:141], v[136:137], s[32:33] op_sel:[0,1] neg_lo:[0,1] neg_hi:[0,1]
v_pk_mul_f32 v[142:143], v[136:137], s[32:33] op_sel:[0,1]
v_pk_fma_f32 v[140:141], v[138:139], s[32:33], v[140:141] op_sel:[0,1,0] neg_lo:[0,1,0] neg_hi:[0,1,0]
v_pk_fma_f32 v[142:143], v[138:139], s[32:33], v[142:143] op_sel:[0,1,0] neg_lo:[0,1,0] neg_hi:[0,1,0]
v_pk_add_f32 v[136:137], v[16:17], v[24:25] neg_lo:[0,1] neg_hi:[0,1]
v_pk_add_f32 v[138:139], v[18:19], v[26:27] neg_lo:[0,1] neg_hi:[0,1]
v_pk_add_f32 v[16:17], v[16:17], v[24:25]
v_pk_add_f32 v[18:19], v[18:19], v[26:27]
v_pk_add_f32 v[24:25], v[30:31], v[22:23] neg_lo:[0,1] neg_hi:[0,1]
v_pk_add_f32 v[26:27], v[20:21], v[28:29] neg_lo:[0,1] neg_hi:[0,1]
v_pk_add_f32 v[20:21], v[20:21], v[28:29]
v_pk_add_f32 v[22:23], v[22:23], v[30:31]
v_pk_add_f32 v[28:29], v[128:129], v[32:33] neg_lo:[0,1] neg_hi:[0,1]
v_pk_add_f32 v[30:31], v[130:131], v[34:35] neg_lo:[0,1] neg_hi:[0,1]
v_pk_add_f32 v[128:129], v[128:129], v[32:33]
v_pk_add_f32 v[130:131], v[130:131], v[34:35]
v_pk_add_f32 v[32:33], v[46:47], v[38:39] neg_lo:[0,1] neg_hi:[0,1]
v_pk_add_f32 v[34:35], v[36:37], v[44:45] neg_lo:[0,1] neg_hi:[0,1]
v_pk_add_f32 v[36:37], v[36:37], v[44:45]
v_pk_add_f32 v[38:39], v[38:39], v[46:47]
v_pk_add_f32 v[44:45], v[112:113], v[56:57] neg_lo:[0,1] neg_hi:[0,1]
v_pk_add_f32 v[46:47], v[114:115], v[58:59] neg_lo:[0,1] neg_hi:[0,1]
v_pk_add_f32 v[112:113], v[112:113], v[56:57]
v_pk_add_f32 v[114:115], v[114:115], v[58:59]
v_pk_add_f32 v[56:57], v[62:63], v[54:55] neg_lo:[0,1] neg_hi:[0,1]
v_pk_add_f32 v[58:59], v[52:53], v[60:61] neg_lo:[0,1] neg_hi:[0,1]
v_pk_add_f32 v[52:53], v[52:53], v[60:61]
v_pk_add_f32 v[54:55], v[54:55], v[62:63]
v_pk_add_f32 v[60:61], v[40:41], v[48:49] neg_lo:[0,1] neg_hi:[0,1]
v_pk_add_f32 v[62:63], v[42:43], v[50:51] neg_lo:[0,1] neg_hi:[0,1]
v_pk_add_f32 v[40:41], v[40:41], v[48:49]
v_pk_add_f32 v[42:43], v[42:43], v[50:51]
v_pk_add_f32 v[48:49], v[78:79], v[70:71] neg_lo:[0,1] neg_hi:[0,1]
v_pk_add_f32 v[50:51], v[68:69], v[76:77] neg_lo:[0,1] neg_hi:[0,1]
v_pk_add_f32 v[68:69], v[68:69], v[76:77]
v_pk_add_f32 v[70:71], v[70:71], v[78:79]
v_pk_add_f32 v[76:77], v[144:145], v[88:89] neg_lo:[0,1] neg_hi:[0,1]
v_pk_add_f32 v[78:79], v[146:147], v[90:91] neg_lo:[0,1] neg_hi:[0,1]
v_pk_add_f32 v[144:145], v[144:145], v[88:89]
v_pk_add_f32 v[146:147], v[146:147], v[90:91]
v_pk_add_f32 v[88:89], v[94:95], v[86:87] neg_lo:[0,1] neg_hi:[0,1]
v_pk_add_f32 v[90:91], v[84:85], v[92:93] neg_lo:[0,1] neg_hi:[0,1]
v_pk_add_f32 v[84:85], v[84:85], v[92:93]
v_pk_add_f32 v[86:87], v[86:87], v[94:95]
v_pk_add_f32 v[92:93], v[72:73], v[96:97] neg_lo:[0,1] neg_hi:[0,1]
v_pk_add_f32 v[94:95], v[74:75], v[98:99] neg_lo:[0,1] neg_hi:[0,1]
v_pk_add_f32 v[72:73], v[72:73], v[96:97]
v_pk_add_f32 v[74:75], v[74:75], v[98:99]
v_pk_add_f32 v[96:97], v[110:111], v[102:103] neg_lo:[0,1] neg_hi:[0,1]
v_pk_add_f32 v[98:99], v[100:101], v[108:109] neg_lo:[0,1] neg_hi:[0,1]
v_pk_add_f32 v[100:101], v[100:101], v[108:109]
v_pk_add_f32 v[102:103], v[102:103], v[110:111]
v_pk_add_f32 v[108:109], v[64:65], v[120:121] neg_lo:[0,1] neg_hi:[0,1]
v_pk_add_f32 v[110:111], v[66:67], v[122:123] neg_lo:[0,1] neg_hi:[0,1]
v_pk_add_f32 v[64:65], v[64:65], v[120:121]
v_pk_add_f32 v[66:67], v[66:67], v[122:123]
v_pk_add_f32 v[120:121], v[126:127], v[118:119] neg_lo:[0,1] neg_hi:[0,1]
v_pk_add_f32 v[122:123], v[116:117], v[124:125] neg_lo:[0,1] neg_hi:[0,1]
v_pk_add_f32 v[116:117], v[116:117], v[124:125]
v_pk_add_f32 v[118:119], v[118:119], v[126:127]
v_pk_add_f32 v[124:125], v[104:105], v[80:81] neg_lo:[0,1] neg_hi:[0,1]
v_pk_add_f32 v[126:127], v[106:107], v[82:83] neg_lo:[0,1] neg_hi:[0,1]
v_pk_add_f32 v[104:105], v[104:105], v[80:81]
v_pk_add_f32 v[106:107], v[106:107], v[82:83]
v_pk_add_f32 v[80:81], v[142:143], v[134:135] neg_lo:[0,1] neg_hi:[0,1]
v_pk_add_f32 v[82:83], v[132:133], v[140:141] neg_lo:[0,1] neg_hi:[0,1]
v_pk_add_f32 v[132:133], v[132:133], v[140:141]
v_pk_add_f32 v[134:135], v[134:135], v[142:143]
v_pk_add_f32 v[140:141], v[16:17], v[20:21] neg_lo:[0,1] neg_hi:[0,1]
v_pk_add_f32 v[142:143], v[18:19], v[22:23] neg_lo:[0,1] neg_hi:[0,1]
v_pk_add_f32 v[16:17], v[16:17], v[20:21]
v_pk_add_f32 v[18:19], v[18:19], v[22:23]
v_pk_add_f32 v[20:21], v[136:137], v[24:25] neg_lo:[0,1] neg_hi:[0,1]
v_pk_add_f32 v[22:23], v[138:139], v[26:27] neg_lo:[0,1] neg_hi:[0,1]
v_pk_add_f32 v[136:137], v[136:137], v[24:25]
v_pk_add_f32 v[138:139], v[138:139], v[26:27]
v_pk_add_f32 v[24:25], v[128:129], v[36:37] neg_lo:[0,1] neg_hi:[0,1]
v_pk_add_f32 v[26:27], v[130:131], v[38:39] neg_lo:[0,1] neg_hi:[0,1]
v_pk_add_f32 v[128:129], v[128:129], v[36:37]
v_pk_add_f32 v[130:131], v[130:131], v[38:39]
v_pk_add_f32 v[36:37], v[28:29], v[32:33] neg_lo:[0,1] neg_hi:[0,1]
v_pk_add_f32 v[38:39], v[30:31], v[34:35] neg_lo:[0,1] neg_hi:[0,1]
v_pk_add_f32 v[28:29], v[28:29], v[32:33]
v_pk_add_f32 v[30:31], v[30:31], v[34:35]
v_pk_add_f32 v[32:33], v[112:113], v[52:53] neg_lo:[0,1] neg_hi:[0,1]
v_pk_add_f32 v[34:35], v[114:115], v[54:55] neg_lo:[0,1] neg_hi:[0,1]
v_pk_add_f32 v[112:113], v[112:113], v[52:53]
v_pk_add_f32 v[114:115], v[114:115], v[54:55]
v_pk_add_f32 v[52:53], v[44:45], v[56:57] neg_lo:[0,1] neg_hi:[0,1]
v_pk_add_f32 v[54:55], v[46:47], v[58:59] neg_lo:[0,1] neg_hi:[0,1]
v_pk_add_f32 v[44:45], v[44:45], v[56:57]
v_pk_add_f32 v[46:47], v[46:47], v[58:59]
v_pk_add_f32 v[56:57], v[40:41], v[68:69] neg_lo:[0,1] neg_hi:[0,1]
v_pk_add_f32 v[58:59], v[42:43], v[70:71] neg_lo:[0,1] neg_hi:[0,1]
v_pk_add_f32 v[40:41], v[40:41], v[68:69]
v_pk_add_f32 v[42:43], v[42:43], v[70:71]
v_pk_add_f32 v[68:69], v[60:61], v[48:49] neg_lo:[0,1] neg_hi:[0,1]
v_pk_add_f32 v[70:71], v[62:63], v[50:51] neg_lo:[0,1] neg_hi:[0,1]
v_pk_add_f32 v[60:61], v[60:61], v[48:49]
v_pk_add_f32 v[62:63], v[62:63], v[50:51]
v_pk_add_f32 v[48:49], v[144:145], v[84:85] neg_lo:[0,1] neg_hi:[0,1]
v_pk_add_f32 v[50:51], v[146:147], v[86:87] neg_lo:[0,1] neg_hi:[0,1]
v_pk_add_f32 v[144:145], v[144:145], v[84:85]
v_pk_add_f32 v[146:147], v[146:147], v[86:87]
v_pk_add_f32 v[84:85], v[76:77], v[88:89] neg_lo:[0,1] neg_hi:[0,1]
v_pk_add_f32 v[86:87], v[78:79], v[90:91] neg_lo:[0,1] neg_hi:[0,1]
v_pk_add_f32 v[76:77], v[76:77], v[88:89]
v_pk_add_f32 v[78:79], v[78:79], v[90:91]
v_pk_add_f32 v[88:89], v[72:73], v[100:101] neg_lo:[0,1] neg_hi:[0,1]
v_pk_add_f32 v[90:91], v[74:75], v[102:103] neg_lo:[0,1] neg_hi:[0,1]
v_pk_add_f32 v[72:73], v[72:73], v[100:101]
v_pk_add_f32 v[74:75], v[74:75], v[102:103]
v_pk_add_f32 v[100:101], v[92:93], v[96:97] neg_lo:[0,1] neg_hi:[0,1]
v_pk_add_f32 v[102:103], v[94:95], v[98:99] neg_lo:[0,1] neg_hi:[0,1]
v_pk_add_f32 v[92:93], v[92:93], v[96:97]
v_pk_add_f32 v[94:95], v[94:95], v[98:99]
v_pk_add_f32 v[96:97], v[64:65], v[116:117] neg_lo:[0,1] neg_hi:[0,1]
v_pk_add_f32 v[98:99], v[66:67], v[118:119] neg_lo:[0,1] neg_hi:[0,1]
v_pk_add_f32 v[64:65], v[64:65], v[116:117]
v_pk_add_f32 v[66:67], v[66:67], v[118:119]
v_pk_add_f32 v[116:117], v[108:109], v[120:121] neg_lo:[0,1] neg_hi:[0,1]
v_pk_add_f32 v[118:119], v[110:111], v[122:123] neg_lo:[0,1] neg_hi:[0,1]
v_pk_add_f32 v[108:109], v[108:109], v[120:121]
v_pk_add_f32 v[110:111], v[110:111], v[122:123]
v_pk_add_f32 v[120:121], v[104:105], v[132:133] neg_lo:[0,1] neg_hi:[0,1]
v_pk_add_f32 v[122:123], v[106:107], v[134:135] neg_lo:[0,1] neg_hi:[0,1]
v_pk_add_f32 v[104:105], v[104:105], v[132:133]
v_pk_add_f32 v[106:107], v[106:107], v[134:135]
v_pk_add_f32 v[132:133], v[124:125], v[80:81] neg_lo:[0,1] neg_hi:[0,1]
v_pk_add_f32 v[134:135], v[126:127], v[82:83] neg_lo:[0,1] neg_hi:[0,1]
v_pk_add_f32 v[124:125], v[124:125], v[80:81]
v_pk_add_f32 v[126:127], v[126:127], v[82:83]
v_mul_f32 v151, 0x3a800000, v3
v_cos_f32 v150, v151
v_sin_f32 v151, v151
v_mul_f32 v149, 0x3b000000, v3
v_cos_f32 v148, v149
v_sin_f32 v149, v149
v_pk_mul_f32 v[80:81], v[144:145], v[150:151] op_sel_hi:[1,0]
v_pk_fma_f32 v[80:81], v[146:147], v[150:151], v[80:81] op_sel:[0,1,0] neg_lo:[1,0,0] neg_hi:[1,0,0]
v_pk_mul_f32 v[146:147], v[146:147], v[150:151] op_sel_hi:[1,0]
v_pk_fma_f32 v[146:147], v[144:145], v[150:151], v[146:147] op_sel:[0,1,0]
v_mul_f32 v151, 0x3b400000, v3
v_cos_f32 v150, v151
v_sin_f32 v151, v151
v_pk_mul_f32 v[144:145], v[112:113], v[148:149] op_sel_hi:[1,0]
v_pk_fma_f32 v[144:145], v[114:115], v[148:149], v[144:145] op_sel:[0,1,0] neg_lo:[1,0,0] neg_hi:[1,0,0]
v_pk_mul_f32 v[114:115], v[114:115], v[148:149] op_sel_hi:[1,0]
v_pk_fma_f32 v[114:115], v[112:113], v[148:149], v[114:115] op_sel:[0,1,0]
v_mul_f32 v149, 0x3b800000, v3
v_cos_f32 v148, v149
v_sin_f32 v149, v149
v_pk_mul_f32 v[112:113], v[64:65], v[150:151] op_sel_hi:[1,0]
v_pk_fma_f32 v[112:113], v[66:67], v[150:151], v[112:113] op_sel:[0,1,0] neg_lo:[1,0,0] neg_hi:[1,0,0]
v_pk_mul_f32 v[66:67], v[66:67], v[150:151] op_sel_hi:[1,0]
v_pk_fma_f32 v[66:67], v[64:65], v[150:151], v[66:67] op_sel:[0,1,0]
v_mul_f32 v151, 0x3ba00000, v3
v_cos_f32 v150, v151
v_sin_f32 v151, v151
v_pk_mul_f32 v[64:65], v[128:129], v[148:149] op_sel_hi:[1,0]
v_pk_fma_f32 v[64:65], v[130:131], v[148:149], v[64:65] op_sel:[0,1,0] neg_lo:[1,0,0] neg_hi:[1,0,0]
v_pk_mul_f32 v[130:131], v[130:131], v[148:149] op_sel_hi:[1,0]
v_pk_fma_f32 v[130:131], v[128:129], v[148:149], v[130:131] op_sel:[0,1,0]
v_mul_f32 v149, 0x3bc00000, v3
v_cos_f32 v148, v149
v_sin_f32 v149, v149
v_pk_mul_f32 v[128:129], v[72:73], v[150:151] op_sel_hi:[1,0]
v_pk_fma_f32 v[128:129], v[74:75], v[150:151], v[128:129] op_sel:[0,1,0] neg_lo:[1,0,0] neg_hi:[1,0,0]
v_pk_mul_f32 v[74:75], v[74:75], v[150:151] op_sel_hi:[1,0]
v_pk_fma_f32 v[74:75], v[72:73], v[150:151], v[74:75] op_sel:[0,1,0]
v_mul_f32 v151, 0x3be00000, v3
v_cos_f32 v150, v151
v_sin_f32 v151, v151
v_pk_mul_f32 v[72:73], v[40:41], v[148:149] op_sel_hi:[1,0]
v_pk_fma_f32 v[72:73], v[42:43], v[148:149], v[72:73] op_sel:[0,1,0] neg_lo:[1,0,0] neg_hi:[1,0,0]
v_pk_mul_f32 v[42:43], v[42:43], v[148:149] op_sel_hi:[1,0]
v_pk_fma_f32 v[42:43], v[40:41], v[148:149], v[42:43] op_sel:[0,1,0]
v_mul_f32 v149, 0x3c000000, v3
v_cos_f32 v148, v149
v_sin_f32 v149, v149
v_pk_mul_f32 v[40:41], v[104:105], v[150:151] op_sel_hi:[1,0]
v_pk_fma_f32 v[40:41], v[106:107], v[150:151], v[40:41] op_sel:[0,1,0] neg_lo:[1,0,0] neg_hi:[1,0,0]
v_pk_mul_f32 v[106:107], v[106:107], v[150:151] op_sel_hi:[1,0]
v_pk_fma_f32 v[106:107], v[104:105], v[150:151], v[106:107] op_sel:[0,1,0]
v_mul_f32 v151, 0x3c100000, v3
v_cos_f32 v150, v151
v_sin_f32 v151, v151
v_pk_mul_f32 v[104:105], v[136:137], v[148:149] op_sel_hi:[1,0]
v_pk_fma_f32 v[104:105], v[138:139], v[148:149], v[104:105] op_sel:[0,1,0] neg_lo:[1,0,0] neg_hi:[1,0,0]
v_pk_mul_f32 v[138:139], v[138:139], v[148:149] op_sel_hi:[1,0]
v_pk_fma_f32 v[138:139], v[136:137], v[148:149], v[138:139] op_sel:[0,1,0]
v_mul_f32 v149, 0x3c200000, v3
v_cos_f32 v148, v149
v_sin_f32 v149, v149
v_pk_mul_f32 v[136:137], v[76:77], v[150:151] op_sel_hi:[1,0]
v_pk_fma_f32 v[136:137], v[78:79], v[150:151], v[136:137] op_sel:[0,1,0] neg_lo:[1,0,0] neg_hi:[1,0,0]
v_pk_mul_f32 v[78:79], v[78:79], v[150:151] op_sel_hi:[1,0]
v_pk_fma_f32 v[78:79], v[76:77], v[150:151], v[78:79] op_sel:[0,1,0]
v_mul_f32 v151, 0x3c300000, v3
v_cos_f32 v150, v151
v_sin_f32 v151, v151
v_pk_mul_f32 v[76:77], v[44:45], v[148:149] op_sel_hi:[1,0]
v_pk_fma_f32 v[76:77], v[46:47], v[148:149], v[76:77] op_sel:[0,1,0] neg_lo:[1,0,0] neg_hi:[1,0,0]
v_pk_mul_f32 v[46:47], v[46:47], v[148:149] op_sel_hi:[1,0]
v_pk_fma_f32 v[46:47], v[44:45], v[148:149], v[46:47] op_sel:[0,1,0]
v_mul_f32 v149, 0x3c400000, v3
v_cos_f32 v148, v149
v_sin_f32 v149, v149
v_pk_mul_f32 v[44:45], v[108:109], v[150:151] op_sel_hi:[1,0]
v_pk_fma_f32 v[44:45], v[110:111], v[150:151], v[44:45] op_sel:[0,1,0] neg_lo:[1,0,0] neg_hi:[1,0,0]
v_pk_mul_f32 v[110:111], v[110:111], v[150:151] op_sel_hi:[1,0]
v_pk_fma_f32 v[110:111], v[108:109], v[150:151], v[110:111] op_sel:[0,1,0]
v_mul_f32 v151, 0x3c500000, v3
v_cos_f32 v150, v151
v_sin_f32 v151, v151
v_pk_mul_f32 v[108:109], v[28:29], v[148:149] op_sel_hi:[1,0]
v_pk_fma_f32 v[108:109], v[30:31], v[148:149], v[108:109] op_sel:[0,1,0] neg_lo:[1,0,0] neg_hi:[1,0,0]
v_pk_mul_f32 v[30:31], v[30:31], v[148:149] op_sel_hi:[1,0]
v_pk_fma_f32 v[30:31], v[28:29], v[148:149], v[30:31] op_sel:[0,1,0]
v_mul_f32 v149, 0x3c600000, v3
v_cos_f32 v148, v149
v_sin_f32 v149, v149
v_pk_mul_f32 v[28:29], v[92:93], v[150:151] op_sel_hi:[1,0]
v_pk_fma_f32 v[28:29], v[94:95], v[150:151], v[28:29] op_sel:[0,1,0] neg_lo:[1,0,0] neg_hi:[1,0,0]
v_pk_mul_f32 v[94:95], v[94:95], v[150:151] op_sel_hi:[1,0]
v_pk_fma_f32 v[94:95], v[92:93], v[150:151], v[94:95] op_sel:[0,1,0]
v_mul_f32 v151, 0x3c700000, v3
v_cos_f32 v150, v151
v_sin_f32 v151, v151
v_pk_mul_f32 v[92:93], v[60:61], v[148:149] op_sel_hi:[1,0]
v_pk_fma_f32 v[92:93], v[62:63], v[148:149], v[92:93] op_sel:[0,1,0] neg_lo:[1,0,0] neg_hi:[1,0,0]
v_pk_mul_f32 v[62:63], v[62:63], v[148:149] op_sel_hi:[1,0]
v_pk_fma_f32 v[62:63], v[60:61], v[148:149], v[62:63] op_sel:[0,1,0]
v_mul_f32 v149, 0x3c800000, v3
v_cos_f32 v148, v149
v_sin_f32 v149, v149
v_pk_mul_f32 v[60:61], v[124:125], v[150:151] op_sel_hi:[1,0]
v_pk_fma_f32 v[60:61], v[126:127], v[150:151], v[60:61] op_sel:[0,1,0] neg_lo:[1,0,0] neg_hi:[1,0,0]
v_pk_mul_f32 v[126:127], v[126:127], v[150:151] op_sel_hi:[1,0]
v_pk_fma_f32 v[126:127], v[124:125], v[150:151], v[126:127] op_sel:[0,1,0]
v_mul_f32 v151, 0x3c880000, v3
v_cos_f32 v150, v151
v_sin_f32 v151, v151
v_pk_mul_f32 v[124:125], v[140:141], v[148:149] op_sel_hi:[1,0]
v_pk_fma_f32 v[124:125], v[142:143], v[148:149], v[124:125] op_sel:[0,1,0] neg_lo:[1,0,0] neg_hi:[1,0,0]
v_pk_mul_f32 v[142:143], v[142:143], v[148:149] op_sel_hi:[1,0]
v_pk_fma_f32 v[142:143], v[140:141], v[148:149], v[142:143] op_sel:[0,1,0]
v_mul_f32 v149, 0x3c900000, v3
v_cos_f32 v148, v149
v_sin_f32 v149, v149
v_pk_mul_f32 v[140:141], v[48:49], v[150:151] op_sel_hi:[1,0]
v_pk_fma_f32 v[140:141], v[50:51], v[150:151], v[140:141] op_sel:[0,1,0] neg_lo:[1,0,0] neg_hi:[1,0,0]
v_pk_mul_f32 v[50:51], v[50:51], v[150:151] op_sel_hi:[1,0]
v_pk_fma_f32 v[50:51], v[48:49], v[150:151], v[50:51] op_sel:[0,1,0]
v_mul_f32 v151, 0x3c980000, v3
v_cos_f32 v150, v151
v_sin_f32 v151, v151
v_pk_mul_f32 v[48:49], v[32:33], v[148:149] op_sel_hi:[1,0]
v_pk_fma_f32 v[48:49], v[34:35], v[148:149], v[48:49] op_sel:[0,1,0] neg_lo:[1,0,0] neg_hi:[1,0,0]
v_pk_mul_f32 v[34:35], v[34:35], v[148:149] op_sel_hi:[1,0]
v_pk_fma_f32 v[34:35], v[32:33], v[148:149], v[34:35] op_sel:[0,1,0]
v_mul_f32 v149, 0x3ca00000, v3
v_cos_f32 v148, v149
v_sin_f32 v149, v149
v_pk_mul_f32 v[32:33], v[96:97], v[150:151] op_sel_hi:[1,0]
v_pk_fma_f32 v[32:33], v[98:99], v[150:151], v[32:33] op_sel:[0,1,0] neg_lo:[1,0,0] neg_hi:[1,0,0]
v_pk_mul_f32 v[98:99], v[98:99], v[150:151] op_sel_hi:[1,0]
v_pk_fma_f32 v[98:99], v[96:97], v[150:151], v[98:99] op_sel:[0,1,0]
v_mul_f32 v151, 0x3ca80000, v3
v_cos_f32 v150, v151
v_sin_f32 v151, v151
v_pk_mul_f32 v[96:97], v[24:25], v[148:149] op_sel_hi:[1,0]
v_pk_fma_f32 v[96:97], v[26:27], v[148:149], v[96:97] op_sel:[0,1,0] neg_lo:[1,0,0] neg_hi:[1,0,0]
v_pk_mul_f32 v[26:27], v[26:27], v[148:149] op_sel_hi:[1,0]
v_pk_fma_f32 v[26:27], v[24:25], v[148:149], v[26:27] op_sel:[0,1,0]
v_mul_f32 v149, 0x3cb00000, v3
v_cos_f32 v148, v149
v_sin_f32 v149, v149
v_pk_mul_f32 v[24:25], v[88:89], v[150:151] op_sel_hi:[1,0]
v_pk_fma_f32 v[24:25], v[90:91], v[150:151], v[24:25] op_sel:[0,1,0] neg_lo:[1,0,0] neg_hi:[1,0,0]
v_pk_mul_f32 v[90:91], v[90:91], v[150:151] op_sel_hi:[1,0]
v_pk_fma_f32 v[90:91], v[88:89], v[150:151], v[90:91] op_sel:[0,1,0]
v_mul_f32 v151, 0x3cb80000, v3
v_cos_f32 v150, v151
v_sin_f32 v151, v151
v_pk_mul_f32 v[88:89], v[56:57], v[148:149] op_sel_hi:[1,0]
v_pk_fma_f32 v[88:89], v[58:59], v[148:149], v[88:89] op_sel:[0,1,0] neg_lo:[1,0,0] neg_hi:[1,0,0]
v_pk_mul_f32 v[58:59], v[58:59], v[148:149] op_sel_hi:[1,0]
v_pk_fma_f32 v[58:59], v[56:57], v[148:149], v[58:59] op_sel:[0,1,0]
v_mul_f32 v149, 0x3cc00000, v3
v_cos_f32 v148, v149
v_sin_f32 v149, v149
v_pk_mul_f32 v[56:57], v[120:121], v[150:151] op_sel_hi:[1,0]
v_pk_fma_f32 v[56:57], v[122:123], v[150:151], v[56:57] op_sel:[0,1,0] neg_lo:[1,0,0] neg_hi:[1,0,0]
v_pk_mul_f32 v[122:123], v[122:123], v[150:151] op_sel_hi:[1,0]
v_pk_fma_f32 v[122:123], v[120:121], v[150:151], v[122:123] op_sel:[0,1,0]
v_mul_f32 v151, 0x3cc80000, v3
v_cos_f32 v150, v151
v_sin_f32 v151, v151
v_pk_mul_f32 v[120:121], v[20:21], v[148:149] op_sel_hi:[1,0]
v_pk_fma_f32 v[120:121], v[22:23], v[148:149], v[120:121] op_sel:[0,1,0] neg_lo:[1,0,0] neg_hi:[1,0,0]
v_pk_mul_f32 v[22:23], v[22:23], v[148:149] op_sel_hi:[1,0]
v_pk_fma_f32 v[22:23], v[20:21], v[148:149], v[22:23] op_sel:[0,1,0]
v_mul_f32 v149, 0x3cd00000, v3
v_cos_f32 v148, v149
v_sin_f32 v149, v149
v_pk_mul_f32 v[20:21], v[84:85], v[150:151] op_sel_hi:[1,0]
v_pk_fma_f32 v[20:21], v[86:87], v[150:151], v[20:21] op_sel:[0,1,0] neg_lo:[1,0,0] neg_hi:[1,0,0]
v_pk_mul_f32 v[86:87], v[86:87], v[150:151] op_sel_hi:[1,0]
v_pk_fma_f32 v[86:87], v[84:85], v[150:151], v[86:87] op_sel:[0,1,0]
v_mul_f32 v151, 0x3cd80000, v3
v_cos_f32 v150, v151
v_sin_f32 v151, v151
v_pk_mul_f32 v[84:85], v[52:53], v[148:149] op_sel_hi:[1,0]
v_pk_fma_f32 v[84:85], v[54:55], v[148:149], v[84:85] op_sel:[0,1,0] neg_lo:[1,0,0] neg_hi:[1,0,0]
v_pk_mul_f32 v[54:55], v[54:55], v[148:149] op_sel_hi:[1,0]
v_pk_fma_f32 v[54:55], v[52:53], v[148:149], v[54:55] op_sel:[0,1,0]
v_mul_f32 v149, 0x3ce00000, v3
v_cos_f32 v148, v149
v_sin_f32 v149, v149
v_pk_mul_f32 v[52:53], v[116:117], v[150:151] op_sel_hi:[1,0]
v_pk_fma_f32 v[52:53], v[118:119], v[150:151], v[52:53] op_sel:[0,1,0] neg_lo:[1,0,0] neg_hi:[1,0,0]
v_pk_mul_f32 v[118:119], v[118:119], v[150:151] op_sel_hi:[1,0]
v_pk_fma_f32 v[118:119], v[116:117], v[150:151], v[118:119] op_sel:[0,1,0]
v_mul_f32 v151, 0x3ce80000, v3
v_cos_f32 v150, v151
v_sin_f32 v151, v151
v_pk_mul_f32 v[116:117], v[36:37], v[148:149] op_sel_hi:[1,0]
v_pk_fma_f32 v[116:117], v[38:39], v[148:149], v[116:117] op_sel:[0,1,0] neg_lo:[1,0,0] neg_hi:[1,0,0]
v_pk_mul_f32 v[38:39], v[38:39], v[148:149] op_sel_hi:[1,0]
v_pk_fma_f32 v[38:39], v[36:37], v[148:149], v[38:39] op_sel:[0,1,0]
v_mul_f32 v149, 0x3cf00000, v3
v_cos_f32 v148, v149
v_sin_f32 v149, v149
v_pk_mul_f32 v[36:37], v[100:101], v[150:151] op_sel_hi:[1,0]
v_pk_fma_f32 v[36:37], v[102:103], v[150:151], v[36:37] op_sel:[0,1,0] neg_lo:[1,0,0] neg_hi:[1,0,0]
v_pk_mul_f32 v[102:103], v[102:103], v[150:151] op_sel_hi:[1,0]
v_pk_fma_f32 v[102:103], v[100:101], v[150:151], v[102:103] op_sel:[0,1,0]
v_mul_f32 v151, 0x3cf80000, v3
v_cos_f32 v150, v151
v_sin_f32 v151, v151
v_pk_mul_f32 v[100:101], v[68:69], v[148:149] op_sel_hi:[1,0]
v_pk_fma_f32 v[100:101], v[70:71], v[148:149], v[100:101] op_sel:[0,1,0] neg_lo:[1,0,0] neg_hi:[1,0,0]
v_pk_mul_f32 v[70:71], v[70:71], v[148:149] op_sel_hi:[1,0]
v_pk_fma_f32 v[70:71], v[68:69], v[148:149], v[70:71] op_sel:[0,1,0]
s_nop 0
v_pk_mul_f32 v[68:69], v[132:133], v[150:151] op_sel_hi:[1,0]
v_pk_fma_f32 v[68:69], v[134:135], v[150:151], v[68:69] op_sel:[0,1,0] neg_lo:[1,0,0] neg_hi:[1,0,0]
v_pk_mul_f32 v[134:135], v[134:135], v[150:151] op_sel_hi:[1,0]
v_pk_fma_f32 v[134:135], v[132:133], v[150:151], v[134:135] op_sel:[0,1,0]
ds_write_b64 v4, v[16:17]
ds_write_b64 v4, v[18:19] offset:8
ds_write_b64 v4, v[80:81] offset:528
ds_write_b64 v4, v[146:147] offset:536
ds_write_b64 v4, v[144:145] offset:1056
ds_write_b64 v4, v[114:115] offset:1064
ds_write_b64 v4, v[112:113] offset:1584
ds_write_b64 v4, v[66:67] offset:1592
ds_write_b64 v4, v[64:65] offset:2112
ds_write_b64 v4, v[130:131] offset:2120
ds_write_b64 v4, v[128:129] offset:2640
ds_write_b64 v4, v[74:75] offset:2648
ds_write_b64 v4, v[72:73] offset:3168
ds_write_b64 v4, v[42:43] offset:3176
ds_write_b64 v4, v[40:41] offset:3696
ds_write_b64 v4, v[106:107] offset:3704
ds_write_b64 v4, v[104:105] offset:4224
ds_write_b64 v4, v[138:139] offset:4232
ds_write_b64 v4, v[136:137] offset:4752
ds_write_b64 v4, v[78:79] offset:4760
ds_write_b64 v4, v[76:77] offset:5280
ds_write_b64 v4, v[46:47] offset:5288
ds_write_b64 v4, v[44:45] offset:5808
ds_write_b64 v4, v[110:111] offset:5816
ds_write_b64 v4, v[108:109] offset:6336
ds_write_b64 v4, v[30:31] offset:6344
ds_write_b64 v4, v[28:29] offset:6864
ds_write_b64 v4, v[94:95] offset:6872
ds_write_b64 v4, v[92:93] offset:7392
ds_write_b64 v4, v[62:63] offset:7400
ds_write_b64 v4, v[60:61] offset:7920
ds_write_b64 v4, v[126:127] offset:7928
ds_write_b64 v4, v[124:125] offset:8448
ds_write_b64 v4, v[142:143] offset:8456
ds_write_b64 v4, v[140:141] offset:8976
ds_write_b64 v4, v[50:51] offset:8984
ds_write_b64 v4, v[48:49] offset:9504
ds_write_b64 v4, v[34:35] offset:9512
ds_write_b64 v4, v[32:33] offset:10032
ds_write_b64 v4, v[98:99] offset:10040
ds_write_b64 v4, v[96:97] offset:10560
ds_write_b64 v4, v[26:27] offset:10568
ds_write_b64 v4, v[24:25] offset:11088
ds_write_b64 v4, v[90:91] offset:11096
ds_write_b64 v4, v[88:89] offset:11616
ds_write_b64 v4, v[58:59] offset:11624
ds_write_b64 v4, v[56:57] offset:12144
ds_write_b64 v4, v[122:123] offset:12152
ds_write_b64 v4, v[120:121] offset:12672
ds_write_b64 v4, v[22:23] offset:12680
ds_write_b64 v4, v[20:21] offset:13200
ds_write_b64 v4, v[86:87] offset:13208
ds_write_b64 v4, v[84:85] offset:13728
ds_write_b64 v4, v[54:55] offset:13736
ds_write_b64 v4, v[52:53] offset:14256
ds_write_b64 v4, v[118:119] offset:14264
ds_write_b64 v4, v[116:117] offset:14784
ds_write_b64 v4, v[38:39] offset:14792
ds_write_b64 v4, v[36:37] offset:15312
ds_write_b64 v4, v[102:103] offset:15320
ds_write_b64 v4, v[100:101] offset:15840
ds_write_b64 v4, v[70:71] offset:15848
ds_write_b64 v4, v[68:69] offset:16368
ds_write_b64 v4, v[134:135] offset:16376
s_waitcnt lgkmcnt(0)
ds_read_b128 v[16:19], v5
ds_read_b128 v[20:23], v5 offset:16
ds_read_b128 v[24:27], v5 offset:32
ds_read_b128 v[28:31], v5 offset:48
ds_read_b128 v[32:35], v5 offset:64
ds_read_b128 v[36:39], v5 offset:80
ds_read_b128 v[40:43], v5 offset:96
ds_read_b128 v[44:47], v5 offset:112
ds_read_b128 v[48:51], v5 offset:128
ds_read_b128 v[52:55], v5 offset:144
ds_read_b128 v[56:59], v5 offset:160
ds_read_b128 v[60:63], v5 offset:176
s_waitcnt lgkmcnt(4)
ds_read_b128 v[64:67], v5 offset:192
ds_read_b128 v[68:71], v5 offset:208
ds_read_b128 v[72:75], v5 offset:224
ds_read_b128 v[76:79], v5 offset:240
ds_read_b128 v[80:83], v5 offset:256
ds_read_b128 v[84:87], v5 offset:272
ds_read_b128 v[88:91], v5 offset:288
ds_read_b128 v[92:95], v5 offset:304
ds_read_b128 v[96:99], v5 offset:320
ds_read_b128 v[100:103], v5 offset:336
ds_read_b128 v[104:107], v5 offset:352
ds_read_b128 v[108:111], v5 offset:368
s_waitcnt lgkmcnt(4)
ds_read_b128 v[112:115], v5 offset:384
ds_read_b128 v[116:119], v5 offset:400
ds_read_b128 v[120:123], v5 offset:416
ds_read_b128 v[124:127], v5 offset:432
ds_read_b128 v[128:131], v5 offset:448
ds_read_b128 v[132:135], v5 offset:464
ds_read_b128 v[136:139], v5 offset:480
ds_read_b128 v[140:143], v5 offset:496
s_waitcnt lgkmcnt(0)
v_pk_add_f32 v[144:145], v[16:17], v[80:81] neg_lo:[0,1] neg_hi:[0,1]
v_pk_add_f32 v[146:147], v[18:19], v[82:83] neg_lo:[0,1] neg_hi:[0,1]
v_pk_add_f32 v[16:17], v[16:17], v[80:81]
v_pk_add_f32 v[18:19], v[18:19], v[82:83]
v_pk_add_f32 v[80:81], v[20:21], v[84:85] neg_lo:[0,1] neg_hi:[0,1]
v_pk_add_f32 v[82:83], v[22:23], v[86:87] neg_lo:[0,1] neg_hi:[0,1]
v_pk_add_f32 v[20:21], v[20:21], v[84:85]
v_pk_add_f32 v[22:23], v[22:23], v[86:87]
v_pk_mul_f32 v[84:85], v[80:81], s[30:31] op_sel_hi:[1,0]
v_pk_mul_f32 v[86:87], v[80:81], s[36:37] op_sel_hi:[1,0]
v_pk_fma_f32 v[84:85], v[82:83], s[36:37], v[84:85] op_sel_hi:[1,0,1] neg_lo:[0,1,0] neg_hi:[0,1,0]
v_pk_fma_f32 v[86:87], v[82:83], s[30:31], v[86:87] op_sel_hi:[1,0,1]
v_pk_add_f32 v[80:81], v[24:25], v[88:89] neg_lo:[0,1] neg_hi:[0,1]
v_pk_add_f32 v[82:83], v[26:27], v[90:91] neg_lo:[0,1] neg_hi:[0,1]
v_pk_add_f32 v[24:25], v[24:25], v[88:89]
v_pk_add_f32 v[26:27], v[26:27], v[90:91]
v_pk_mul_f32 v[88:89], v[80:81], s[30:31] op_sel:[0,1]
v_pk_mul_f32 v[90:91], v[80:81], s[34:35] op_sel:[0,1]
v_pk_fma_f32 v[88:89], v[82:83], s[34:35], v[88:89] op_sel:[0,1,0] neg_lo:[0,1,0] neg_hi:[0,1,0]
v_pk_fma_f32 v[90:91], v[82:83], s[30:31], v[90:91] op_sel:[0,1,0]
v_pk_add_f32 v[80:81], v[28:29], v[92:93] neg_lo:[0,1] neg_hi:[0,1]
v_pk_add_f32 v[82:83], v[30:31], v[94:95] neg_lo:[0,1] neg_hi:[0,1]
v_pk_add_f32 v[28:29], v[28:29], v[92:93]
v_pk_add_f32 v[30:31], v[30:31], v[94:95]
v_pk_mul_f32 v[92:93], v[80:81], s[32:33] op_sel_hi:[1,0]
v_pk_mul_f32 v[94:95], v[80:81], s[34:35] op_sel_hi:[1,0]
v_pk_fma_f32 v[92:93], v[82:83], s[34:35], v[92:93] op_sel_hi:[1,0,1] neg_lo:[0,1,0] neg_hi:[0,1,0]
v_pk_fma_f32 v[94:95], v[82:83], s[32:33], v[94:95] op_sel_hi:[1,0,1]
v_pk_add_f32 v[80:81], v[32:33], v[96:97] neg_lo:[0,1] neg_hi:[0,1]
v_pk_add_f32 v[82:83], v[34:35], v[98:99] neg_lo:[0,1] neg_hi:[0,1]
v_pk_add_f32 v[32:33], v[32:33], v[96:97]
v_pk_add_f32 v[34:35], v[34:35], v[98:99]
v_pk_mul_f32 v[96:97], v[80:81], s[32:33] op_sel:[0,1]
v_pk_mul_f32 v[98:99], v[80:81], s[32:33] op_sel:[0,1]
v_pk_fma_f32 v[96:97], v[82:83], s[32:33], v[96:97] op_sel:[0,1,0] neg_lo:[0,1,0] neg_hi:[0,1,0]
v_pk_fma_f32 v[98:99], v[82:83], s[32:33], v[98:99] op_sel:[0,1,0]
v_pk_add_f32 v[80:81], v[36:37], v[100:101] neg_lo:[0,1] neg_hi:[0,1]
v_pk_add_f32 v[82:83], v[38:39], v[102:103] neg_lo:[0,1] neg_hi:[0,1]
v_pk_add_f32 v[36:37], v[36:37], v[100:101]
v_pk_add_f32 v[38:39], v[38:39], v[102:103]
v_pk_mul_f32 v[100:101], v[80:81], s[34:35] op_sel_hi:[1,0]
v_pk_mul_f32 v[102:103], v[80:81], s[32:33] op_sel_hi:[1,0]
v_pk_fma_f32 v[100:101], v[82:83], s[32:33], v[100:101] op_sel_hi:[1,0,1] neg_lo:[0,1,0] neg_hi:[0,1,0]
v_pk_fma_f32 v[102:103], v[82:83], s[34:35], v[102:103] op_sel_hi:[1,0,1]
v_pk_add_f32 v[80:81], v[40:41], v[104:105] neg_lo:[0,1] neg_hi:[0,1]
v_pk_add_f32 v[82:83], v[42:43], v[106:107] neg_lo:[0,1] neg_hi:[0,1]
v_pk_add_f32 v[40:41], v[40:41], v[104:105]
v_pk_add_f32 v[42:43], v[42:43], v[106:107]
v_pk_mul_f32 v[104:105], v[80:81], s[34:35] op_sel:[0,1]
v_pk_mul_f32 v[106:107], v[80:81], s[30:31] op_sel:[0,1]
v_pk_fma_f32 v[104:105], v[82:83], s[30:31], v[104:105] op_sel:[0,1,0] neg_lo:[0,1,0] neg_hi:[0,1,0]
v_pk_fma_f32 v[106:107], v[82:83], s[34:35], v[106:107] op_sel:[0,1,0]
v_pk_add_f32 v[80:81], v[44:45], v[108:109] neg_lo:[0,1] neg_hi:[0,1]
v_pk_add_f32 v[82:83], v[46:47], v[110:111] neg_lo:[0,1] neg_hi:[0,1]
v_pk_add_f32 v[44:45], v[44:45], v[108:109]
v_pk_add_f32 v[46:47], v[46:47], v[110:111]
v_pk_mul_f32 v[108:109], v[80:81], s[36:37] op_sel_hi:[1,0]
v_pk_mul_f32 v[110:111], v[80:81], s[30:31] op_sel_hi:[1,0]
v_pk_fma_f32 v[108:109], v[82:83], s[30:31], v[108:109] op_sel_hi:[1,0,1] neg_lo:[0,1,0] neg_hi:[0,1,0]
v_pk_fma_f32 v[110:111], v[82:83], s[36:37], v[110:111] op_sel_hi:[1,0,1]
v_pk_add_f32 v[80:81], v[114:115], v[50:51] neg_lo:[0,1] neg_hi:[0,1]
v_pk_add_f32 v[82:83], v[48:49], v[112:113] neg_lo:[0,1] neg_hi:[0,1]
v_pk_add_f32 v[48:49], v[48:49], v[112:113]
v_pk_add_f32 v[50:51], v[50:51], v[114:115]
v_pk_add_f32 v[112:113], v[52:53], v[116:117] neg_lo:[0,1] neg_hi:[0,1]
v_pk_add_f32 v[114:115], v[54:55], v[118:119] neg_lo:[0,1] neg_hi:[0,1]
v_pk_add_f32 v[52:53], v[52:53], v[116:117]
v_pk_add_f32 v[54:55], v[54:55], v[118:119]
v_pk_mul_f32 v[116:117], v[112:113], s[36:37] op_sel_hi:[1,0] neg_lo:[0,1] neg_hi:[0,1]
v_pk_mul_f32 v[118:119], v[112:113], s[30:31] op_sel_hi:[1,0]
v_pk_fma_f32 v[116:117], v[114:115], s[30:31], v[116:117] op_sel_hi:[1,0,1] neg_lo:[0,1,0] neg_hi:[0,1,0]
v_pk_fma_f32 v[118:119], v[114:115], s[36:37], v[118:119] op_sel_hi:[1,0,1] neg_lo:[0,1,0] neg_hi:[0,1,0]
v_pk_add_f32 v[112:113], v[56:57], v[120:121] neg_lo:[0,1] neg_hi:[0,1]
v_pk_add_f32 v[114:115], v[58:59], v[122:123] neg_lo:[0,1] neg_hi:[0,1]
v_pk_add_f32 v[56:57], v[56:57], v[120:121]
v_pk_add_f32 v[58:59], v[58:59], v[122:123]
v_pk_mul_f32 v[120:121], v[112:113], s[34:35] op_sel:[0,1] neg_lo:[0,1] neg_hi:[0,1]
v_pk_mul_f32 v[122:123], v[112:113], s[30:31] op_sel:[0,1]
v_pk_fma_f32 v[120:121], v[114:115], s[30:31], v[120:121] op_sel:[0,1,0] neg_lo:[0,1,0] neg_hi:[0,1,0]
v_pk_fma_f32 v[122:123], v[114:115], s[34:35], v[122:123] op_sel:[0,1,0] neg_lo:[0,1,0] neg_hi:[0,1,0]
v_pk_add_f32 v[112:113], v[60:61], v[124:125] neg_lo:[0,1] neg_hi:[0,1]
v_pk_add_f32 v[114:115], v[62:63], v[126:127] neg_lo:[0,1] neg_hi:[0,1]
v_pk_add_f32 v[60:61], v[60:61], v[124:125]
v_pk_add_f32 v[62:63], v[62:63], v[126:127]
v_pk_mul_f32 v[124:125], v[112:113], s[34:35] op_sel_hi:[1,0] neg_lo:[0,1] neg_hi:[0,1]
v_pk_mul_f32 v[126:127], v[112:113], s[32:33] op_sel_hi:[1,0]
v_pk_fma_f32 v[124:125], v[114:115], s[32:33], v[124:125] op_sel_hi:[1,0,1] neg_lo:[0,1,0] neg_hi:[0,1,0]
v_pk_fma_f32 v[126:127], v[114:115], s[34:35], v[126:127] op_sel_hi:[1,0,1] neg_lo:[0,1,0] neg_hi:[0,1,0]
v_pk_add_f32 v[112:113], v[64:65], v[128:129] neg_lo:[0,1] neg_hi:[0,1]
v_pk_add_f32 v[114:115], v[66:67], v[130:131] neg_lo:[0,1] neg_hi:[0,1]
v_pk_add_f32 v[64:65], v[64:65], v[128:129]
v_pk_add_f32 v[66:67], v[66:67], v[130:131]
v_pk_mul_f32 v[128:129], v[112:113], s[32:33] op_sel:[0,1] neg_lo:[0,1] neg_hi:[0,1]
v_pk_mul_f32 v[130:131], v[112:113], s[32:33] op_sel:[0,1]
v_pk_fma_f32 v[128:129], v[114:115], s[32:33], v[128:129] op_sel:[0,1,0] neg_lo:[0,1,0] neg_hi:[0,1,0]
v_pk_fma_f32 v[130:131], v[114:115], s[32:33], v[130:131] op_sel:[0,1,0] neg_lo:[0,1,0] neg_hi:[0,1,0]
v_pk_add_f32 v[112:113], v[68:69], v[132:133] neg_lo:[0,1] neg_hi:[0,1]
v_pk_add_f32 v[114:115], v[70:71], v[134:135] neg_lo:[0,1] neg_hi:[0,1]
v_pk_add_f32 v[68:69], v[68:69], v[132:133]
v_pk_add_f32 v[70:71], v[70:71], v[134:135]
v_pk_mul_f32 v[132:133], v[112:113], s[32:33] op_sel_hi:[1,0] neg_lo:[0,1] neg_hi:[0,1]
v_pk_mul_f32 v[134:135], v[112:113], s[34:35] op_sel_hi:[1,0]
v_pk_fma_f32 v[132:133], v[114:115], s[34:35], v[132:133] op_sel_hi:[1,0,1] neg_lo:[0,1,0] neg_hi:[0,1,0]
v_pk_fma_f32 v[134:135], v[114:115], s[32:33], v[134:135] op_sel_hi:[1,0,1] neg_lo:[0,1,0] neg_hi:[0,1,0]
v_pk_add_f32 v[112:113], v[72:73], v[136:137] neg_lo:[0,1] neg_hi:[0,1]
v_pk_add_f32 v[114:115], v[74:75], v[138:139] neg_lo:[0,1] neg_hi:[0,1]
v_pk_add_f32 v[72:73], v[72:73], v[136:137]
v_pk_add_f32 v[74:75], v[74:75], v[138:139]
v_pk_mul_f32 v[136:137], v[112:113], s[30:31] op_sel:[0,1] neg_lo:[0,1] neg_hi:[0,1]
v_pk_mul_f32 v[138:139], v[112:113], s[34:35] op_sel:[0,1]
v_pk_fma_f32 v[136:137], v[114:115], s[34:35], v[136:137] op_sel:[0,1,0] neg_lo:[0,1,0] neg_hi:[0,1,0]
v_pk_fma_f32 v[138:139], v[114:115], s[30:31], v[138:139] op_sel:[0,1,0] neg_lo:[0,1,0] neg_hi:[0,1,0]
v_pk_add_f32 v[112:113], v[76:77], v[140:141] neg_lo:[0,1] neg_hi:[0,1]
v_pk_add_f32 v[114:115], v[78:79], v[142:143] neg_lo:[0,1] neg_hi:[0,1]
v_pk_add_f32 v[76:77], v[76:77], v[140:141]
v_pk_add_f32 v[78:79], v[78:79], v[142:143]
v_pk_mul_f32 v[140:141], v[112:113], s[30:31] op_sel_hi:[1,0] neg_lo:[0,1] neg_hi:[0,1]
v_pk_mul_f32 v[142:143], v[112:113], s[36:37] op_sel_hi:[1,0]
v_pk_fma_f32 v[140:141], v[114:115], s[36:37], v[140:141] op_sel_hi:[1,0,1] neg_lo:[0,1,0] neg_hi:[0,1,0]
v_pk_fma_f32 v[142:143], v[114:115], s[30:31], v[142:143] op_sel_hi:[1,0,1] neg_lo:[0,1,0] neg_hi:[0,1,0]
v_pk_add_f32 v[112:113], v[16:17], v[48:49] neg_lo:[0,1] neg_hi:[0,1]
v_pk_add_f32 v[114:115], v[18:19], v[50:51] neg_lo:[0,1] neg_hi:[0,1]
v_pk_add_f32 v[16:17], v[16:17], v[48:49]
v_pk_add_f32 v[18:19], v[18:19], v[50:51]
v_pk_add_f32 v[48:49], v[20:21], v[52:53] neg_lo:[0,1] neg_hi:[0,1]
v_pk_add_f32 v[50:51], v[22:23], v[54:55] neg_lo:[0,1] neg_hi:[0,1]
v_pk_add_f32 v[20:21], v[20:21], v[52:53]
v_pk_add_f32 v[22:23], v[22:23], v[54:55]
v_pk_mul_f32 v[52:53], v[48:49], s[30:31] op_sel:[0,1]
v_pk_mul_f32 v[54:55], v[48:49], s[34:35] op_sel:[0,1]
v_pk_fma_f32 v[52:53], v[50:51], s[34:35], v[52:53] op_sel:[0,1,0] neg_lo:[0,1,0] neg_hi:[0,1,0]
v_pk_fma_f32 v[54:55], v[50:51], s[30:31], v[54:55] op_sel:[0,1,0]
v_pk_add_f32 v[48:49], v[24:25], v[56:57] neg_lo:[0,1] neg_hi:[0,1]
v_pk_add_f32 v[50:51], v[26:27], v[58:59] neg_lo:[0,1] neg_hi:[0,1]
v_pk_add_f32 v[24:25], v[24:25], v[56:57]
v_pk_add_f32 v[26:27], v[26:27], v[58:59]
v_pk_mul_f32 v[56:57], v[48:49], s[32:33] op_sel:[0,1]
v_pk_mul_f32 v[58:59], v[48:49], s[32:33] op_sel:[0,1]
v_pk_fma_f32 v[56:57], v[50:51], s[32:33], v[56:57] op_sel:[0,1,0] neg_lo:[0,1,0] neg_hi:[0,1,0]
v_pk_fma_f32 v[58:59], v[50:51], s[32:33], v[58:59] op_sel:[0,1,0]
v_pk_add_f32 v[48:49], v[28:29], v[60:61] neg_lo:[0,1] neg_hi:[0,1]
v_pk_add_f32 v[50:51], v[30:31], v[62:63] neg_lo:[0,1] neg_hi:[0,1]
v_pk_add_f32 v[28:29], v[28:29], v[60:61]
v_pk_add_f32 v[30:31], v[30:31], v[62:63]
v_pk_mul_f32 v[60:61], v[48:49], s[34:35] op_sel:[0,1]
v_pk_mul_f32 v[62:63], v[48:49], s[30:31] op_sel:[0,1]
v_pk_fma_f32 v[60:61], v[50:51], s[30:31], v[60:61] op_sel:[0,1,0] neg_lo:[0,1,0] neg_hi:[0,1,0]
v_pk_fma_f32 v[62:63], v[50:51], s[34:35], v[62:63] op_sel:[0,1,0]
v_pk_add_f32 v[48:49], v[66:67], v[34:35] neg_lo:[0,1] neg_hi:[0,1]
v_pk_add_f32 v[50:51], v[32:33], v[64:65] neg_lo:[0,1] neg_hi:[0,1]
v_pk_add_f32 v[32:33], v[32:33], v[64:65]
v_pk_add_f32 v[34:35], v[34:35], v[66:67]
v_pk_add_f32 v[64:65], v[36:37], v[68:69] neg_lo:[0,1] neg_hi:[0,1]
v_pk_add_f32 v[66:67], v[38:39], v[70:71] neg_lo:[0,1] neg_hi:[0,1]
v_pk_add_f32 v[36:37], v[36:37], v[68:69]
v_pk_add_f32 v[38:39], v[38:39], v[70:71]
v_pk_mul_f32 v[68:69], v[64:65], s[34:35] op_sel:[0,1] neg_lo:[0,1] neg_hi:[0,1]
v_pk_mul_f32 v[70:71], v[64:65], s[30:31] op_sel:[0,1]
v_pk_fma_f32 v[68:69], v[66:67], s[30:31], v[68:69] op_sel:[0,1,0] neg_lo:[0,1,0] neg_hi:[0,1,0]
v_pk_fma_f32 v[70:71], v[66:67], s[34:35], v[70:71] op_sel:[0,1,0] neg_lo:[0,1,0] neg_hi:[0,1,0]
v_pk_add_f32 v[64:65], v[40:41], v[72:73] neg_lo:[0,1] neg_hi:[0,1]
v_pk_add_f32 v[66:67], v[42:43], v[74:75] neg_lo:[0,1] neg_hi:[0,1]
v_pk_add_f32 v[40:41], v[40:41], v[72:73]
v_pk_add_f32 v[42:43], v[42:43], v[74:75]
v_pk_mul_f32 v[72:73], v[64:65], s[32:33] op_sel:[0,1] neg_lo:[0,1] neg_hi:[0,1]
v_pk_mul_f32 v[74:75], v[64:65], s[32:33] op_sel:[0,1]
v_pk_fma_f32 v[72:73], v[66:67], s[32:33], v[72:73] op_sel:[0,1,0] neg_lo:[0,1,0] neg_hi:[0,1,0]
v_pk_fma_f32 v[74:75], v[66:67], s[32:33], v[74:75] op_sel:[0,1,0] neg_lo:[0,1,0] neg_hi:[0,1,0]
v_pk_add_f32 v[64:65], v[44:45], v[76:77] neg_lo:[0,1] neg_hi:[0,1]
v_pk_add_f32 v[66:67], v[46:47], v[78:79] neg_lo:[0,1] neg_hi:[0,1]
v_pk_add_f32 v[44:45], v[44:45], v[76:77]
v_pk_add_f32 v[46:47], v[46:47], v[78:79]
v_pk_mul_f32 v[76:77], v[64:65], s[30:31] op_sel:[0,1] neg_lo:[0,1] neg_hi:[0,1]
v_pk_mul_f32 v[78:79], v[64:65], s[34:35] op_sel:[0,1]
v_pk_fma_f32 v[76:77], v[66:67], s[34:35], v[76:77] op_sel:[0,1,0] neg_lo:[0,1,0] neg_hi:[0,1,0]
v_pk_fma_f32 v[78:79], v[66:67], s[30:31], v[78:79] op_sel:[0,1,0] neg_lo:[0,1,0] neg_hi:[0,1,0]
v_pk_add_f32 v[64:65], v[144:145], v[80:81] neg_lo:[0,1] neg_hi:[0,1]
v_pk_add_f32 v[66:67], v[146:147], v[82:83] neg_lo:[0,1] neg_hi:[0,1]
v_pk_add_f32 v[144:145], v[144:145], v[80:81]
v_pk_add_f32 v[146:147], v[146:147], v[82:83]
v_pk_add_f32 v[80:81], v[84:85], v[116:117] neg_lo:[0,1] neg_hi:[0,1]
v_pk_add_f32 v[82:83], v[86:87], v[118:119] neg_lo:[0,1] neg_hi:[0,1]
v_pk_add_f32 v[84:85], v[84:85], v[116:117]
v_pk_add_f32 v[86:87], v[86:87], v[118:119]
v_pk_mul_f32 v[116:117], v[80:81], s[30:31] op_sel:[0,1]
v_pk_mul_f32 v[118:119], v[80:81], s[34:35] op_sel:[0,1]
v_pk_fma_f32 v[116:117], v[82:83], s[34:35], v[116:117] op_sel:[0,1,0] neg_lo:[0,1,0] neg_hi:[0,1,0]
v_pk_fma_f32 v[118:119], v[82:83], s[30:31], v[118:119] op_sel:[0,1,0]
v_pk_add_f32 v[80:81], v[88:89], v[120:121] neg_lo:[0,1] neg_hi:[0,1]
v_pk_add_f32 v[82:83], v[90:91], v[122:123] neg_lo:[0,1] neg_hi:[0,1]
v_pk_add_f32 v[88:89], v[88:89], v[120:121]
v_pk_add_f32 v[90:91], v[90:91], v[122:123]
v_pk_mul_f32 v[120:121], v[80:81], s[32:33] op_sel:[0,1]
v_pk_mul_f32 v[122:123], v[80:81], s[32:33] op_sel:[0,1]
v_pk_fma_f32 v[120:121], v[82:83], s[32:33], v[120:121] op_sel:[0,1,0] neg_lo:[0,1,0] neg_hi:[0,1,0]
v_pk_fma_f32 v[122:123], v[82:83], s[32:33], v[122:123] op_sel:[0,1,0]
v_pk_add_f32 v[80:81], v[92:93], v[124:125] neg_lo:[0,1] neg_hi:[0,1]
v_pk_add_f32 v[82:83], v[94:95], v[126:127] neg_lo:[0,1] neg_hi:[0,1]
v_pk_add_f32 v[92:93], v[92:93], v[124:125]
v_pk_add_f32 v[94:95], v[94:95], v[126:127]
v_pk_mul_f32 v[124:125], v[80:81], s[34:35] op_sel:[0,1]
v_pk_mul_f32 v[126:127], v[80:81], s[30:31] op_sel:[0,1]
v_pk_fma_f32 v[124:125], v[82:83], s[30:31], v[124:125] op_sel:[0,1,0] neg_lo:[0,1,0] neg_hi:[0,1,0]
v_pk_fma_f32 v[126:127], v[82:83], s[34:35], v[126:127] op_sel:[0,1,0]
v_pk_add_f32 v[80:81], v[130:131], v[98:99] neg_lo:[0,1] neg_hi:[0,1]
v_pk_add_f32 v[82:83], v[96:97], v[128:129] neg_lo:[0,1] neg_hi:[0,1]
v_pk_add_f32 v[96:97], v[96:97], v[128:129]
v_pk_add_f32 v[98:99], v[98:99], v[130:131]
v_pk_add_f32 v[128:129], v[100:101], v[132:133] neg_lo:[0,1] neg_hi:[0,1]
v_pk_add_f32 v[130:131], v[102:103], v[134:135] neg_lo:[0,1] neg_hi:[0,1]
v_pk_add_f32 v[100:101], v[100:101], v[132:133]
v_pk_add_f32 v[102:103], v[102:103], v[134:135]
v_pk_mul_f32 v[132:133], v[128:129], s[34:35] op_sel:[0,1] neg_lo:[0,1] neg_hi:[0,1]
v_pk_mul_f32 v[134:135], v[128:129], s[30:31] op_sel:[0,1]
v_pk_fma_f32 v[132:133], v[130:131], s[30:31], v[132:133] op_sel:[0,1,0] neg_lo:[0,1,0] neg_hi:[0,1,0]
v_pk_fma_f32 v[134:135], v[130:131], s[34:35], v[134:135] op_sel:[0,1,0] neg_lo:[0,1,0] neg_hi:[0,1,0]
v_pk_add_f32 v[128:129], v[104:105], v[136:137] neg_lo:[0,1] neg_hi:[0,1]
v_pk_add_f32 v[130:131], v[106:107], v[138:139] neg_lo:[0,1] neg_hi:[0,1]
v_pk_add_f32 v[104:105], v[104:105], v[136:137]
v_pk_add_f32 v[106:107], v[106:107], v[138:139]
v_pk_mul_f32 v[136:137], v[128:129], s[32:33] op_sel:[0,1] neg_lo:[0,1] neg_hi:[0,1]
v_pk_mul_f32 v[138:139], v[128:129], s[32:33] op_sel:[0,1]
v_pk_fma_f32 v[136:137], v[130:131], s[32:33], v[136:137] op_sel:[0,1,0] neg_lo:[0,1,0] neg_hi:[0,1,0]
v_pk_fma_f32 v[138:139], v[130:131], s[32:33], v[138:139] op_sel:[0,1,0] neg_lo:[0,1,0] neg_hi:[0,1,0]
v_pk_add_f32 v[128:129], v[108:109], v[140:141] neg_lo:[0,1] neg_hi:[0,1]
v_pk_add_f32 v[130:131], v[110:111], v[142:143] neg_lo:[0,1] neg_hi:[0,1]
v_pk_add_f32 v[108:109], v[108:109], v[140:141]
v_pk_add_f32 v[110:111], v[110:111], v[142:143]
v_pk_mul_f32 v[140:141], v[128:129], s[30:31] op_sel:[0,1] neg_lo:[0,1] neg_hi:[0,1]
v_pk_mul_f32 v[142:143], v[128:129], s[34:35] op_sel:[0,1]
v_pk_fma_f32 v[140:141], v[130:131], s[34:35], v[140:141] op_sel:[0,1,0] neg_lo:[0,1,0] neg_hi:[0,1,0]
v_pk_fma_f32 v[142:143], v[130:131], s[30:31], v[142:143] op_sel:[0,1,0] neg_lo:[0,1,0] neg_hi:[0,1,0]
v_pk_add_f32 v[128:129], v[16:17], v[32:33] neg_lo:[0,1] neg_hi:[0,1]
v_pk_add_f32 v[130:131], v[18:19], v[34:35] neg_lo:[0,1] neg_hi:[0,1]
v_pk_add_f32 v[16:17], v[16:17], v[32:33]
v_pk_add_f32 v[18:19], v[18:19], v[34:35]
v_pk_add_f32 v[32:33], v[20:21], v[36:37] neg_lo:[0,1] neg_hi:[0,1]
v_pk_add_f32 v[34:35], v[22:23], v[38:39] neg_lo:[0,1] neg_hi:[0,1]
v_pk_add_f32 v[20:21], v[20:21], v[36:37]
v_pk_add_f32 v[22:23], v[22:23], v[38:39]
v_pk_mul_f32 v[36:37], v[32:33], s[32:33] op_sel:[0,1]
v_pk_mul_f32 v[38:39], v[32:33], s[32:33] op_sel:[0,1]
v_pk_fma_f32 v[36:37], v[34:35], s[32:33], v[36:37] op_sel:[0,1,0] neg_lo:[0,1,0] neg_hi:[0,1,0]
v_pk_fma_f32 v[38:39], v[34:35], s[32:33], v[38:39] op_sel:[0,1,0]
v_pk_add_f32 v[32:33], v[42:43], v[26:27] neg_lo:[0,1] neg_hi:[0,1]
v_pk_add_f32 v[34:35], v[24:25], v[40:41] neg_lo:[0,1] neg_hi:[0,1]
v_pk_add_f32 v[24:25], v[24:25], v[40:41]
v_pk_add_f32 v[26:27], v[26:27], v[42:43]
v_pk_add_f32 v[40:41], v[28:29], v[44:45] neg_lo:[0,1] neg_hi:[0,1]
v_pk_add_f32 v[42:43], v[30:31], v[46:47] neg_lo:[0,1] neg_hi:[0,1]
v_pk_add_f32 v[28:29], v[28:29], v[44:45]
v_pk_add_f32 v[30:31], v[30:31], v[46:47]
v_pk_mul_f32 v[44:45], v[40:41], s[32:33] op_sel:[0,1] neg_lo:[0,1] neg_hi:[0,1]
v_pk_mul_f32 v[46:47], v[40:41], s[32:33] op_sel:[0,1]
v_pk_fma_f32 v[44:45], v[42:43], s[32:33], v[44:45] op_sel:[0,1,0] neg_lo:[0,1,0] neg_hi:[0,1,0]
v_pk_fma_f32 v[46:47], v[42:43], s[32:33], v[46:47] op_sel:[0,1,0] neg_lo:[0,1,0] neg_hi:[0,1,0]
v_pk_add_f32 v[40:41], v[112:113], v[48:49] neg_lo:[0,1] neg_hi:[0,1]
v_pk_add_f32 v[42:43], v[114:115], v[50:51] neg_lo:[0,1] neg_hi:[0,1]
v_pk_add_f32 v[112:113], v[112:113], v[48:49]
v_pk_add_f32 v[114:115], v[114:115], v[50:51]
v_pk_add_f32 v[48:49], v[52:53], v[68:69] neg_lo:[0,1] neg_hi:[0,1]
v_pk_add_f32 v[50:51], v[54:55], v[70:71] neg_lo:[0,1] neg_hi:[0,1]
v_pk_add_f32 v[52:53], v[52:53], v[68:69]
v_pk_add_f32 v[54:55], v[54:55], v[70:71]
v_pk_mul_f32 v[68:69], v[48:49], s[32:33] op_sel:[0,1]
v_pk_mul_f32 v[70:71], v[48:49], s[32:33] op_sel:[0,1]
v_pk_fma_f32 v[68:69], v[50:51], s[32:33], v[68:69] op_sel:[0,1,0] neg_lo:[0,1,0] neg_hi:[0,1,0]
v_pk_fma_f32 v[70:71], v[50:51], s[32:33], v[70:71] op_sel:[0,1,0]
v_pk_add_f32 v[48:49], v[74:75], v[58:59] neg_lo:[0,1] neg_hi:[0,1]
v_pk_add_f32 v[50:51], v[56:57], v[72:73] neg_lo:[0,1] neg_hi:[0,1]
v_pk_add_f32 v[56:57], v[56:57], v[72:73]
v_pk_add_f32 v[58:59], v[58:59], v[74:75]
v_pk_add_f32 v[72:73], v[60:61], v[76:77] neg_lo:[0,1] neg_hi:[0,1]
v_pk_add_f32 v[74:75], v[62:63], v[78:79] neg_lo:[0,1] neg_hi:[0,1]
v_pk_add_f32 v[60:61], v[60:61], v[76:77]
v_pk_add_f32 v[62:63], v[62:63], v[78:79]
v_pk_mul_f32 v[76:77], v[72:73], s[32:33] op_sel:[0,1] neg_lo:[0,1] neg_hi:[0,1]
v_pk_mul_f32 v[78:79], v[72:73], s[32:33] op_sel:[0,1]
v_pk_fma_f32 v[76:77], v[74:75], s[32:33], v[76:77] op_sel:[0,1,0] neg_lo:[0,1,0] neg_hi:[0,1,0]
v_pk_fma_f32 v[78:79], v[74:75], s[32:33], v[78:79] op_sel:[0,1,0] neg_lo:[0,1,0] neg_hi:[0,1,0]
v_pk_add_f32 v[72:73], v[144:145], v[96:97] neg_lo:[0,1] neg_hi:[0,1]
v_pk_add_f32 v[74:75], v[146:147], v[98:99] neg_lo:[0,1] neg_hi:[0,1]
v_pk_add_f32 v[144:145], v[144:145], v[96:97]
v_pk_add_f32 v[146:147], v[146:147], v[98:99]
v_pk_add_f32 v[96:97], v[84:85], v[100:101] neg_lo:[0,1] neg_hi:[0,1]
v_pk_add_f32 v[98:99], v[86:87], v[102:103] neg_lo:[0,1] neg_hi:[0,1]
v_pk_add_f32 v[84:85], v[84:85], v[100:101]
v_pk_add_f32 v[86:87], v[86:87], v[102:103]
v_pk_mul_f32 v[100:101], v[96:97], s[32:33] op_sel:[0,1]
v_pk_mul_f32 v[102:103], v[96:97], s[32:33] op_sel:[0,1]
v_pk_fma_f32 v[100:101], v[98:99], s[32:33], v[100:101] op_sel:[0,1,0] neg_lo:[0,1,0] neg_hi:[0,1,0]
v_pk_fma_f32 v[102:103], v[98:99], s[32:33], v[102:103] op_sel:[0,1,0]
v_pk_add_f32 v[96:97], v[106:107], v[90:91] neg_lo:[0,1] neg_hi:[0,1]
v_pk_add_f32 v[98:99], v[88:89], v[104:105] neg_lo:[0,1] neg_hi:[0,1]
v_pk_add_f32 v[88:89], v[88:89], v[104:105]
v_pk_add_f32 v[90:91], v[90:91], v[106:107]
v_pk_add_f32 v[104:105], v[92:93], v[108:109] neg_lo:[0,1] neg_hi:[0,1]
v_pk_add_f32 v[106:107], v[94:95], v[110:111] neg_lo:[0,1] neg_hi:[0,1]
v_pk_add_f32 v[92:93], v[92:93], v[108:109]
v_pk_add_f32 v[94:95], v[94:95], v[110:111]
v_pk_mul_f32 v[108:109], v[104:105], s[32:33] op_sel:[0,1] neg_lo:[0,1] neg_hi:[0,1]
v_pk_mul_f32 v[110:111], v[104:105], s[32:33] op_sel:[0,1]
v_pk_fma_f32 v[108:109], v[106:107], s[32:33], v[108:109] op_sel:[0,1,0] neg_lo:[0,1,0] neg_hi:[0,1,0]
v_pk_fma_f32 v[110:111], v[106:107], s[32:33], v[110:111] op_sel:[0,1,0] neg_lo:[0,1,0] neg_hi:[0,1,0]
v_pk_add_f32 v[104:105], v[64:65], v[80:81] neg_lo:[0,1] neg_hi:[0,1]
v_pk_add_f32 v[106:107], v[66:67], v[82:83] neg_lo:[0,1] neg_hi:[0,1]
v_pk_add_f32 v[64:65], v[64:65], v[80:81]
v_pk_add_f32 v[66:67], v[66:67], v[82:83]
v_pk_add_f32 v[80:81], v[116:117], v[132:133] neg_lo:[0,1] neg_hi:[0,1]
v_pk_add_f32 v[82:83], v[118:119], v[134:135] neg_lo:[0,1] neg_hi:[0,1]
v_pk_add_f32 v[116:117], v[116:117], v[132:133]
v_pk_add_f32 v[118:119], v[118:119], v[134:135]
v_pk_mul_f32 v[132:133], v[80:81], s[32:33] op_sel:[0,1]
v_pk_mul_f32 v[134:135], v[80:81], s[32:33] op_sel:[0,1]
v_pk_fma_f32 v[132:133], v[82:83], s[32:33], v[132:133] op_sel:[0,1,0] neg_lo:[0,1,0] neg_hi:[0,1,0]
v_pk_fma_f32 v[134:135], v[82:83], s[32:33], v[134:135] op_sel:[0,1,0]
v_pk_add_f32 v[80:81], v[138:139], v[122:123] neg_lo:[0,1] neg_hi:[0,1]
v_pk_add_f32 v[82:83], v[120:121], v[136:137] neg_lo:[0,1] neg_hi:[0,1]
v_pk_add_f32 v[120:121], v[120:121], v[136:137]
v_pk_add_f32 v[122:123], v[122:123], v[138:139]
v_pk_add_f32 v[136:137], v[124:125], v[140:141] neg_lo:[0,1] neg_hi:[0,1]
v_pk_add_f32 v[138:139], v[126:127], v[142:143] neg_lo:[0,1] neg_hi:[0,1]
v_pk_add_f32 v[124:125], v[124:125], v[140:141]
v_pk_add_f32 v[126:127], v[126:127], v[142:143]
v_pk_mul_f32 v[140:141], v[136:137], s[32:33] op_sel:[0,1] neg_lo:[0,1] neg_hi:[0,1]
v_pk_mul_f32 v[142:143], v[136:137], s[32:33] op_sel:[0,1]
v_pk_fma_f32 v[140:141], v[138:139], s[32:33], v[140:141] op_sel:[0,1,0] neg_lo:[0,1,0] neg_hi:[0,1,0]
v_pk_fma_f32 v[142:143], v[138:139], s[32:33], v[142:143] op_sel:[0,1,0] neg_lo:[0,1,0] neg_hi:[0,1,0]
v_pk_add_f32 v[136:137], v[16:17], v[24:25] neg_lo:[0,1] neg_hi:[0,1]
v_pk_add_f32 v[138:139], v[18:19], v[26:27] neg_lo:[0,1] neg_hi:[0,1]
v_pk_add_f32 v[16:17], v[16:17], v[24:25]
v_pk_add_f32 v[18:19], v[18:19], v[26:27]
v_pk_add_f32 v[24:25], v[30:31], v[22:23] neg_lo:[0,1] neg_hi:[0,1]
v_pk_add_f32 v[26:27], v[20:21], v[28:29] neg_lo:[0,1] neg_hi:[0,1]
v_pk_add_f32 v[20:21], v[20:21], v[28:29]
v_pk_add_f32 v[22:23], v[22:23], v[30:31]
v_pk_add_f32 v[28:29], v[128:129], v[32:33] neg_lo:[0,1] neg_hi:[0,1]
v_pk_add_f32 v[30:31], v[130:131], v[34:35] neg_lo:[0,1] neg_hi:[0,1]
v_pk_add_f32 v[128:129], v[128:129], v[32:33]
v_pk_add_f32 v[130:131], v[130:131], v[34:35]
v_pk_add_f32 v[32:33], v[46:47], v[38:39] neg_lo:[0,1] neg_hi:[0,1]
v_pk_add_f32 v[34:35], v[36:37], v[44:45] neg_lo:[0,1] neg_hi:[0,1]
v_pk_add_f32 v[36:37], v[36:37], v[44:45]
v_pk_add_f32 v[38:39], v[38:39], v[46:47]
v_pk_add_f32 v[44:45], v[112:113], v[56:57] neg_lo:[0,1] neg_hi:[0,1]
v_pk_add_f32 v[46:47], v[114:115], v[58:59] neg_lo:[0,1] neg_hi:[0,1]
v_pk_add_f32 v[112:113], v[112:113], v[56:57]
v_pk_add_f32 v[114:115], v[114:115], v[58:59]
v_pk_add_f32 v[56:57], v[62:63], v[54:55] neg_lo:[0,1] neg_hi:[0,1]
v_pk_add_f32 v[58:59], v[52:53], v[60:61] neg_lo:[0,1] neg_hi:[0,1]
v_pk_add_f32 v[52:53], v[52:53], v[60:61]
v_pk_add_f32 v[54:55], v[54:55], v[62:63]
v_pk_add_f32 v[60:61], v[40:41], v[48:49] neg_lo:[0,1] neg_hi:[0,1]
v_pk_add_f32 v[62:63], v[42:43], v[50:51] neg_lo:[0,1] neg_hi:[0,1]
v_pk_add_f32 v[40:41], v[40:41], v[48:49]
v_pk_add_f32 v[42:43], v[42:43], v[50:51]
v_pk_add_f32 v[48:49], v[78:79], v[70:71] neg_lo:[0,1] neg_hi:[0,1]
v_pk_add_f32 v[50:51], v[68:69], v[76:77] neg_lo:[0,1] neg_hi:[0,1]
v_pk_add_f32 v[68:69], v[68:69], v[76:77]
v_pk_add_f32 v[70:71], v[70:71], v[78:79]
v_pk_add_f32 v[76:77], v[144:145], v[88:89] neg_lo:[0,1] neg_hi:[0,1]
v_pk_add_f32 v[78:79], v[146:147], v[90:91] neg_lo:[0,1] neg_hi:[0,1]
v_pk_add_f32 v[144:145], v[144:145], v[88:89]
v_pk_add_f32 v[146:147], v[146:147], v[90:91]
v_pk_add_f32 v[88:89], v[94:95], v[86:87] neg_lo:[0,1] neg_hi:[0,1]
v_pk_add_f32 v[90:91], v[84:85], v[92:93] neg_lo:[0,1] neg_hi:[0,1]
v_pk_add_f32 v[84:85], v[84:85], v[92:93]
v_pk_add_f32 v[86:87], v[86:87], v[94:95]
v_pk_add_f32 v[92:93], v[72:73], v[96:97] neg_lo:[0,1] neg_hi:[0,1]
v_pk_add_f32 v[94:95], v[74:75], v[98:99] neg_lo:[0,1] neg_hi:[0,1]
v_pk_add_f32 v[72:73], v[72:73], v[96:97]
v_pk_add_f32 v[74:75], v[74:75], v[98:99]
v_pk_add_f32 v[96:97], v[110:111], v[102:103] neg_lo:[0,1] neg_hi:[0,1]
v_pk_add_f32 v[98:99], v[100:101], v[108:109] neg_lo:[0,1] neg_hi:[0,1]
v_pk_add_f32 v[100:101], v[100:101], v[108:109]
v_pk_add_f32 v[102:103], v[102:103], v[110:111]
v_pk_add_f32 v[108:109], v[64:65], v[120:121] neg_lo:[0,1] neg_hi:[0,1]
v_pk_add_f32 v[110:111], v[66:67], v[122:123] neg_lo:[0,1] neg_hi:[0,1]
v_pk_add_f32 v[64:65], v[64:65], v[120:121]
v_pk_add_f32 v[66:67], v[66:67], v[122:123]
v_pk_add_f32 v[120:121], v[126:127], v[118:119] neg_lo:[0,1] neg_hi:[0,1]
v_pk_add_f32 v[122:123], v[116:117], v[124:125] neg_lo:[0,1] neg_hi:[0,1]
v_pk_add_f32 v[116:117], v[116:117], v[124:125]
v_pk_add_f32 v[118:119], v[118:119], v[126:127]
v_pk_add_f32 v[124:125], v[104:105], v[80:81] neg_lo:[0,1] neg_hi:[0,1]
v_pk_add_f32 v[126:127], v[106:107], v[82:83] neg_lo:[0,1] neg_hi:[0,1]
v_pk_add_f32 v[104:105], v[104:105], v[80:81]
v_pk_add_f32 v[106:107], v[106:107], v[82:83]
v_pk_add_f32 v[80:81], v[142:143], v[134:135] neg_lo:[0,1] neg_hi:[0,1]
v_pk_add_f32 v[82:83], v[132:133], v[140:141] neg_lo:[0,1] neg_hi:[0,1]
v_pk_add_f32 v[132:133], v[132:133], v[140:141]
v_pk_add_f32 v[134:135], v[134:135], v[142:143]
v_pk_add_f32 v[140:141], v[16:17], v[20:21] neg_lo:[0,1] neg_hi:[0,1]
v_pk_add_f32 v[142:143], v[18:19], v[22:23] neg_lo:[0,1] neg_hi:[0,1]
v_pk_add_f32 v[16:17], v[16:17], v[20:21]
v_pk_add_f32 v[18:19], v[18:19], v[22:23]
v_pk_add_f32 v[20:21], v[136:137], v[24:25] neg_lo:[0,1] neg_hi:[0,1]
v_pk_add_f32 v[22:23], v[138:139], v[26:27] neg_lo:[0,1] neg_hi:[0,1]
v_pk_add_f32 v[136:137], v[136:137], v[24:25]
v_pk_add_f32 v[138:139], v[138:139], v[26:27]
v_pk_add_f32 v[24:25], v[128:129], v[36:37] neg_lo:[0,1] neg_hi:[0,1]
v_pk_add_f32 v[26:27], v[130:131], v[38:39] neg_lo:[0,1] neg_hi:[0,1]
v_pk_add_f32 v[128:129], v[128:129], v[36:37]
v_pk_add_f32 v[130:131], v[130:131], v[38:39]
v_pk_add_f32 v[36:37], v[28:29], v[32:33] neg_lo:[0,1] neg_hi:[0,1]
v_pk_add_f32 v[38:39], v[30:31], v[34:35] neg_lo:[0,1] neg_hi:[0,1]
v_pk_add_f32 v[28:29], v[28:29], v[32:33]
v_pk_add_f32 v[30:31], v[30:31], v[34:35]
v_pk_add_f32 v[32:33], v[112:113], v[52:53] neg_lo:[0,1] neg_hi:[0,1]
v_pk_add_f32 v[34:35], v[114:115], v[54:55] neg_lo:[0,1] neg_hi:[0,1]
v_pk_add_f32 v[112:113], v[112:113], v[52:53]
v_pk_add_f32 v[114:115], v[114:115], v[54:55]
v_pk_add_f32 v[52:53], v[44:45], v[56:57] neg_lo:[0,1] neg_hi:[0,1]
v_pk_add_f32 v[54:55], v[46:47], v[58:59] neg_lo:[0,1] neg_hi:[0,1]
v_pk_add_f32 v[44:45], v[44:45], v[56:57]
v_pk_add_f32 v[46:47], v[46:47], v[58:59]
v_pk_add_f32 v[56:57], v[40:41], v[68:69] neg_lo:[0,1] neg_hi:[0,1]
v_pk_add_f32 v[58:59], v[42:43], v[70:71] neg_lo:[0,1] neg_hi:[0,1]
v_pk_add_f32 v[40:41], v[40:41], v[68:69]
v_pk_add_f32 v[42:43], v[42:43], v[70:71]
v_pk_add_f32 v[68:69], v[60:61], v[48:49] neg_lo:[0,1] neg_hi:[0,1]
v_pk_add_f32 v[70:71], v[62:63], v[50:51] neg_lo:[0,1] neg_hi:[0,1]
v_pk_add_f32 v[60:61], v[60:61], v[48:49]
v_pk_add_f32 v[62:63], v[62:63], v[50:51]
v_pk_add_f32 v[48:49], v[144:145], v[84:85] neg_lo:[0,1] neg_hi:[0,1]
v_pk_add_f32 v[50:51], v[146:147], v[86:87] neg_lo:[0,1] neg_hi:[0,1]
v_pk_add_f32 v[144:145], v[144:145], v[84:85]
v_pk_add_f32 v[146:147], v[146:147], v[86:87]
v_pk_add_f32 v[84:85], v[76:77], v[88:89] neg_lo:[0,1] neg_hi:[0,1]
v_pk_add_f32 v[86:87], v[78:79], v[90:91] neg_lo:[0,1] neg_hi:[0,1]
v_pk_add_f32 v[76:77], v[76:77], v[88:89]
v_pk_add_f32 v[78:79], v[78:79], v[90:91]
v_pk_add_f32 v[88:89], v[72:73], v[100:101] neg_lo:[0,1] neg_hi:[0,1]
v_pk_add_f32 v[90:91], v[74:75], v[102:103] neg_lo:[0,1] neg_hi:[0,1]
v_pk_add_f32 v[72:73], v[72:73], v[100:101]
v_pk_add_f32 v[74:75], v[74:75], v[102:103]
v_pk_add_f32 v[100:101], v[92:93], v[96:97] neg_lo:[0,1] neg_hi:[0,1]
v_pk_add_f32 v[102:103], v[94:95], v[98:99] neg_lo:[0,1] neg_hi:[0,1]
v_pk_add_f32 v[92:93], v[92:93], v[96:97]
v_pk_add_f32 v[94:95], v[94:95], v[98:99]
v_pk_add_f32 v[96:97], v[64:65], v[116:117] neg_lo:[0,1] neg_hi:[0,1]
v_pk_add_f32 v[98:99], v[66:67], v[118:119] neg_lo:[0,1] neg_hi:[0,1]
v_pk_add_f32 v[64:65], v[64:65], v[116:117]
v_pk_add_f32 v[66:67], v[66:67], v[118:119]
v_pk_add_f32 v[116:117], v[108:109], v[120:121] neg_lo:[0,1] neg_hi:[0,1]
v_pk_add_f32 v[118:119], v[110:111], v[122:123] neg_lo:[0,1] neg_hi:[0,1]
v_pk_add_f32 v[108:109], v[108:109], v[120:121]
v_pk_add_f32 v[110:111], v[110:111], v[122:123]
v_pk_add_f32 v[120:121], v[104:105], v[132:133] neg_lo:[0,1] neg_hi:[0,1]
v_pk_add_f32 v[122:123], v[106:107], v[134:135] neg_lo:[0,1] neg_hi:[0,1]
v_pk_add_f32 v[104:105], v[104:105], v[132:133]
v_pk_add_f32 v[106:107], v[106:107], v[134:135]
v_pk_add_f32 v[132:133], v[124:125], v[80:81] neg_lo:[0,1] neg_hi:[0,1]
v_pk_add_f32 v[134:135], v[126:127], v[82:83] neg_lo:[0,1] neg_hi:[0,1]
v_pk_add_f32 v[124:125], v[124:125], v[80:81]
v_pk_add_f32 v[126:127], v[126:127], v[82:83]
v_lshl_add_u32 v7, v1, 3, v6
ds_write_b64 v7, v[16:17]
ds_write_b64 v7, v[18:19] offset:8192
ds_write_b64 v7, v[144:145] offset:256
ds_write_b64 v7, v[146:147] offset:8448
ds_write_b64 v7, v[112:113] offset:512
ds_write_b64 v7, v[114:115] offset:8704
ds_write_b64 v7, v[64:65] offset:768
ds_write_b64 v7, v[66:67] offset:8960
ds_write_b64 v7, v[128:129] offset:1024
ds_write_b64 v7, v[130:131] offset:9216
ds_write_b64 v7, v[72:73] offset:1280
ds_write_b64 v7, v[74:75] offset:9472
ds_write_b64 v7, v[40:41] offset:1536
ds_write_b64 v7, v[42:43] offset:9728
ds_write_b64 v7, v[104:105] offset:1792
ds_write_b64 v7, v[106:107] offset:9984
ds_write_b64 v7, v[136:137] offset:2048
ds_write_b64 v7, v[138:139] offset:10240
ds_write_b64 v7, v[76:77] offset:2304
ds_write_b64 v7, v[78:79] offset:10496
ds_write_b64 v7, v[44:45] offset:2560
ds_write_b64 v7, v[46:47] offset:10752
ds_write_b64 v7, v[108:109] offset:2816
ds_write_b64 v7, v[110:111] offset:11008
ds_write_b64 v7, v[28:29] offset:3072
ds_write_b64 v7, v[30:31] offset:11264
ds_write_b64 v7, v[92:93] offset:3328
ds_write_b64 v7, v[94:95] offset:11520
ds_write_b64 v7, v[60:61] offset:3584
ds_write_b64 v7, v[62:63] offset:11776
ds_write_b64 v7, v[124:125] offset:3840
ds_write_b64 v7, v[126:127] offset:12032
ds_write_b64 v7, v[140:141] offset:4096
ds_write_b64 v7, v[142:143] offset:12288
ds_write_b64 v7, v[48:49] offset:4352
ds_write_b64 v7, v[50:51] offset:12544
ds_write_b64 v7, v[32:33] offset:4608
ds_write_b64 v7, v[34:35] offset:12800
ds_write_b64 v7, v[96:97] offset:4864
ds_write_b64 v7, v[98:99] offset:13056
ds_write_b64 v7, v[24:25] offset:5120
ds_write_b64 v7, v[26:27] offset:13312
ds_write_b64 v7, v[88:89] offset:5376
ds_write_b64 v7, v[90:91] offset:13568
ds_write_b64 v7, v[56:57] offset:5632
ds_write_b64 v7, v[58:59] offset:13824
ds_write_b64 v7, v[120:121] offset:5888
ds_write_b64 v7, v[122:123] offset:14080
ds_write_b64 v7, v[20:21] offset:6144
ds_write_b64 v7, v[22:23] offset:14336
ds_write_b64 v7, v[84:85] offset:6400
ds_write_b64 v7, v[86:87] offset:14592
ds_write_b64 v7, v[52:53] offset:6656
ds_write_b64 v7, v[54:55] offset:14848
ds_write_b64 v7, v[116:117] offset:6912
ds_write_b64 v7, v[118:119] offset:15104
ds_write_b64 v7, v[36:37] offset:7168
ds_write_b64 v7, v[38:39] offset:15360
ds_write_b64 v7, v[100:101] offset:7424
ds_write_b64 v7, v[102:103] offset:15616
ds_write_b64 v7, v[68:69] offset:7680
ds_write_b64 v7, v[70:71] offset:15872
ds_write_b64 v7, v[132:133] offset:7936
ds_write_b64 v7, v[134:135] offset:16128
s_waitcnt lgkmcnt(0)
s_barrier
v_and_b32 v1, 127, v0
v_lshrrev_b32 v2, 7, v0
v_lshlrev_b32 v3, 6, v1
v_lshl_add_u32 v3, v2, 13, v3
v_add_u32 v4, 67584, v3
v_lshlrev_b32 v5, 4, v1
v_lshl_add_u32 v5, v2, 15, v5
s_lshl_b32 s12, s92, 17
ds_read_b128 v[16:19], v3
ds_read_b128 v[20:23], v3 offset:16
ds_read_b128 v[24:27], v3 offset:32
ds_read_b128 v[28:31], v3 offset:48
ds_read_b128 v[32:35], v3 offset:16896
ds_read_b128 v[36:39], v3 offset:16912
ds_read_b128 v[40:43], v3 offset:16928
ds_read_b128 v[44:47], v3 offset:16944
s_waitcnt lgkmcnt(4)
v_cvt_pk_bf16_f32 v48, v16, v18
v_cvt_pk_bf16_f32 v49, v20, v22
v_cvt_pk_bf16_f32 v50, v24, v26
v_cvt_pk_bf16_f32 v51, v28, v30
v_cvt_pk_bf16_f32 v52, v17, v19
v_cvt_pk_bf16_f32 v53, v21, v23
v_cvt_pk_bf16_f32 v54, v25, v27
v_cvt_pk_bf16_f32 v55, v29, v31
s_add_u32 s13, s12, 0
buffer_store_dwordx4 v[48:51], v5, s[4:7], s13 offen offset:2048
s_add_u32 s13, s12, 65536
buffer_store_dwordx4 v[52:55], v5, s[4:7], s13 offen offset:2048
ds_read_b128 v[16:19], v3 offset:33792
ds_read_b128 v[20:23], v3 offset:33808
ds_read_b128 v[24:27], v3 offset:33824
ds_read_b128 v[28:31], v3 offset:33840
s_waitcnt lgkmcnt(4)
v_cvt_pk_bf16_f32 v56, v32, v34
v_cvt_pk_bf16_f32 v57, v36, v38
v_cvt_pk_bf16_f32 v58, v40, v42
v_cvt_pk_bf16_f32 v59, v44, v46
v_cvt_pk_bf16_f32 v60, v33, v35
v_cvt_pk_bf16_f32 v61, v37, v39
v_cvt_pk_bf16_f32 v62, v41, v43
v_cvt_pk_bf16_f32 v63, v45, v47
s_add_u32 s13, s12, 4096
buffer_store_dwordx4 v[56:59], v5, s[4:7], s13 offen offset:2048
s_add_u32 s13, s12, 69632
buffer_store_dwordx4 v[60:63], v5, s[4:7], s13 offen offset:2048
ds_read_b128 v[32:35], v3 offset:50688
ds_read_b128 v[36:39], v3 offset:50704
ds_read_b128 v[40:43], v3 offset:50720
ds_read_b128 v[44:47], v3 offset:50736
s_waitcnt lgkmcnt(4)
v_cvt_pk_bf16_f32 v48, v16, v18
v_cvt_pk_bf16_f32 v49, v20, v22
v_cvt_pk_bf16_f32 v50, v24, v26
v_cvt_pk_bf16_f32 v51, v28, v30
v_cvt_pk_bf16_f32 v52, v17, v19
v_cvt_pk_bf16_f32 v53, v21, v23
v_cvt_pk_bf16_f32 v54, v25, v27
v_cvt_pk_bf16_f32 v55, v29, v31
s_add_u32 s13, s12, 8192
buffer_store_dwordx4 v[48:51], v5, s[4:7], s13 offen offset:2048
s_add_u32 s13, s12, 73728
buffer_store_dwordx4 v[52:55], v5, s[4:7], s13 offen offset:2048
ds_read_b128 v[16:19], v4
ds_read_b128 v[20:23], v4 offset:16
ds_read_b128 v[24:27], v4 offset:32
ds_read_b128 v[28:31], v4 offset:48
s_waitcnt lgkmcnt(4)
v_cvt_pk_bf16_f32 v56, v32, v34
v_cvt_pk_bf16_f32 v57, v36, v38
v_cvt_pk_bf16_f32 v58, v40, v42
v_cvt_pk_bf16_f32 v59, v44, v46
v_cvt_pk_bf16_f32 v60, v33, v35
v_cvt_pk_bf16_f32 v61, v37, v39
v_cvt_pk_bf16_f32 v62, v41, v43
v_cvt_pk_bf16_f32 v63, v45, v47
s_add_u32 s13, s12, 12288
buffer_store_dwordx4 v[56:59], v5, s[4:7], s13 offen offset:2048
s_add_u32 s13, s12, 77824
buffer_store_dwordx4 v[60:63], v5, s[4:7], s13 offen offset:2048
ds_read_b128 v[32:35], v4 offset:16896
ds_read_b128 v[36:39], v4 offset:16912
ds_read_b128 v[40:43], v4 offset:16928
ds_read_b128 v[44:47], v4 offset:16944
s_waitcnt lgkmcnt(4)
v_cvt_pk_bf16_f32 v48, v16, v18
v_cvt_pk_bf16_f32 v49, v20, v22
v_cvt_pk_bf16_f32 v50, v24, v26
v_cvt_pk_bf16_f32 v51, v28, v30
v_cvt_pk_bf16_f32 v52, v17, v19
v_cvt_pk_bf16_f32 v53, v21, v23
v_cvt_pk_bf16_f32 v54, v25, v27
v_cvt_pk_bf16_f32 v55, v29, v31
s_add_u32 s13, s12, 16384
buffer_store_dwordx4 v[48:51], v5, s[4:7], s13 offen offset:2048
s_add_u32 s13, s12, 81920
buffer_store_dwordx4 v[52:55], v5, s[4:7], s13 offen offset:2048
ds_read_b128 v[16:19], v4 offset:33792
ds_read_b128 v[20:23], v4 offset:33808
ds_read_b128 v[24:27], v4 offset:33824
ds_read_b128 v[28:31], v4 offset:33840
s_waitcnt lgkmcnt(4)
v_cvt_pk_bf16_f32 v56, v32, v34
v_cvt_pk_bf16_f32 v57, v36, v38
v_cvt_pk_bf16_f32 v58, v40, v42
v_cvt_pk_bf16_f32 v59, v44, v46
v_cvt_pk_bf16_f32 v60, v33, v35
v_cvt_pk_bf16_f32 v61, v37, v39
v_cvt_pk_bf16_f32 v62, v41, v43
v_cvt_pk_bf16_f32 v63, v45, v47
s_add_u32 s13, s12, 20480
buffer_store_dwordx4 v[56:59], v5, s[4:7], s13 offen offset:2048
s_add_u32 s13, s12, 86016
buffer_store_dwordx4 v[60:63], v5, s[4:7], s13 offen offset:2048
ds_read_b128 v[32:35], v4 offset:50688
ds_read_b128 v[36:39], v4 offset:50704
ds_read_b128 v[40:43], v4 offset:50720
ds_read_b128 v[44:47], v4 offset:50736
s_waitcnt lgkmcnt(4)
v_cvt_pk_bf16_f32 v48, v16, v18
v_cvt_pk_bf16_f32 v49, v20, v22
v_cvt_pk_bf16_f32 v50, v24, v26
v_cvt_pk_bf16_f32 v51, v28, v30
v_cvt_pk_bf16_f32 v52, v17, v19
v_cvt_pk_bf16_f32 v53, v21, v23
v_cvt_pk_bf16_f32 v54, v25, v27
v_cvt_pk_bf16_f32 v55, v29, v31
s_add_u32 s13, s12, 24576
buffer_store_dwordx4 v[48:51], v5, s[4:7], s13 offen offset:2048
s_add_u32 s13, s12, 90112
buffer_store_dwordx4 v[52:55], v5, s[4:7], s13 offen offset:2048
s_waitcnt lgkmcnt(0)
v_cvt_pk_bf16_f32 v56, v32, v34
v_cvt_pk_bf16_f32 v57, v36, v38
v_cvt_pk_bf16_f32 v58, v40, v42
v_cvt_pk_bf16_f32 v59, v44, v46
v_cvt_pk_bf16_f32 v60, v33, v35
v_cvt_pk_bf16_f32 v61, v37, v39
v_cvt_pk_bf16_f32 v62, v41, v43
v_cvt_pk_bf16_f32 v63, v45, v47
s_add_u32 s13, s12, 28672
buffer_store_dwordx4 v[56:59], v5, s[4:7], s13 offen offset:2048
s_add_u32 s13, s12, 94208
buffer_store_dwordx4 v[60:63], v5, s[4:7], s13 offen offset:2048
s_waitcnt vmcnt(0) lgkmcnt(0)
s_barrier
s_lshr_b32 s81, s92, 5
s_cmp_lg_u32 s81, 0
s_cbranch_scc1 L_nx0
s_endpgm
L_nx0:
s_lshr_b32 s81, s92, 5
s_cmp_lg_u32 s81, 1
s_cbranch_scc1 L_nx1
s_endpgm
L_nx1:
L_wl:
s_load_dwordx2 s[52:53], s[0:1], 40
v_and_b32 v202, 63, v0
v_lshrrev_b32 v200, 3, v202
v_lshlrev_b32 v200, 11, v200
v_and_b32 v203, 7, v202
v_lshl_add_u32 v200, v203, 4, v200
s_and_b32 s56, s92, 1
s_lshl_b32 s56, s56, 2
s_add_u32 s56, s56, s98
s_lshl_b32 s56, s56, 20
s_bfe_u32 s58, s92, 0x40001
s_lshl_b32 s57, s58, 7
s_add_u32 s56, s56, s57
v_add_u32 v200, s56, v200
s_lshl_b32 s56, s98, 15
s_lshl_b32 s57, s58, 12
v_lshrrev_b32 v201, 5, v202
v_bfe_u32 v204, v202, 2, 2
v_lshl_add_u32 v201, v201, 3, v204
v_lshlrev_b32 v201, 7, v201
v_bfe_u32 v204, v202, 4, 1
v_lshl_add_u32 v201, v204, 5, v201
v_and_b32 v203, 3, v202
v_lshl_add_u32 v201, v203, 3, v201
v_add_u32 v201, s56, v201
s_waitcnt lgkmcnt(0)
s_mov_b32 s54, 8388608
s_mov_b32 s55, 0x00020000
s_add_u32 m0, s56, 0
s_add_u32 s58, s57, 0
s_and_b32 s58, s58, 0x7fff
s_lshl_b32 s58, s58, 5
buffer_load_dwordx4 v200, s[52:55], s58 offen lds
s_add_u32 m0, s56, 1024
s_add_u32 s58, s57, 512
s_and_b32 s58, s58, 0x7fff
s_lshl_b32 s58, s58, 5
buffer_load_dwordx4 v200, s[52:55], s58 offen lds
s_add_u32 m0, s56, 2048
s_add_u32 s58, s57, 1024
s_and_b32 s58, s58, 0x7fff
s_lshl_b32 s58, s58, 5
buffer_load_dwordx4 v200, s[52:55], s58 offen lds
s_add_u32 m0, s56, 3072
s_add_u32 s58, s57, 1536
s_and_b32 s58, s58, 0x7fff
s_lshl_b32 s58, s58, 5
buffer_load_dwordx4 v200, s[52:55], s58 offen lds
s_waitcnt vmcnt(0)
ds_read_b64_tr_b16 a[0:1], v201
ds_read_b64_tr_b16 a[2:3], v201 offset:512
ds_read_b64_tr_b16 a[4:5], v201 offset:64
ds_read_b64_tr_b16 a[6:7], v201 offset:576
ds_read_b64_tr_b16 a[8:9], v201 offset:2048
ds_read_b64_tr_b16 a[10:11], v201 offset:2560
ds_read_b64_tr_b16 a[12:13], v201 offset:2112
ds_read_b64_tr_b16 a[14:15], v201 offset:2624
s_waitcnt lgkmcnt(0)
s_add_u32 m0, s56, 4096
s_add_u32 s58, s57, 2048
s_and_b32 s58, s58, 0x7fff
s_lshl_b32 s58, s58, 5
buffer_load_dwordx4 v200, s[52:55], s58 offen lds
s_add_u32 m0, s56, 5120
s_add_u32 s58, s57, 2560
s_and_b32 s58, s58, 0x7fff
s_lshl_b32 s58, s58, 5
buffer_load_dwordx4 v200, s[52:55], s58 offen lds
s_add_u32 m0, s56, 6144
s_add_u32 s58, s57, 3072
s_and_b32 s58, s58, 0x7fff
s_lshl_b32 s58, s58, 5
buffer_load_dwordx4 v200, s[52:55], s58 offen lds
s_add_u32 m0, s56, 7168
s_add_u32 s58, s57, 3584
s_and_b32 s58, s58, 0x7fff
s_lshl_b32 s58, s58, 5
buffer_load_dwordx4 v200, s[52:55], s58 offen lds
s_waitcnt vmcnt(0)
ds_read_b64_tr_b16 a[16:17], v201 offset:4096
ds_read_b64_tr_b16 a[18:19], v201 offset:4608
ds_read_b64_tr_b16 a[20:21], v201 offset:4160
ds_read_b64_tr_b16 a[22:23], v201 offset:4672
ds_read_b64_tr_b16 a[24:25], v201 offset:6144
ds_read_b64_tr_b16 a[26:27], v201 offset:6656
ds_read_b64_tr_b16 a[28:29], v201 offset:6208
ds_read_b64_tr_b16 a[30:31], v201 offset:6720
s_waitcnt lgkmcnt(0)
s_add_u32 m0, s56, 8192
s_add_u32 s58, s57, 4096
s_and_b32 s58, s58, 0x7fff
s_lshl_b32 s58, s58, 5
buffer_load_dwordx4 v200, s[52:55], s58 offen lds
s_add_u32 m0, s56, 9216
s_add_u32 s58, s57, 4608
s_and_b32 s58, s58, 0x7fff
s_lshl_b32 s58, s58, 5
buffer_load_dwordx4 v200, s[52:55], s58 offen lds
s_add_u32 m0, s56, 10240
s_add_u32 s58, s57, 5120
s_and_b32 s58, s58, 0x7fff
s_lshl_b32 s58, s58, 5
buffer_load_dwordx4 v200, s[52:55], s58 offen lds
s_add_u32 m0, s56, 11264
s_add_u32 s58, s57, 5632
s_and_b32 s58, s58, 0x7fff
s_lshl_b32 s58, s58, 5
buffer_load_dwordx4 v200, s[52:55], s58 offen lds
s_waitcnt vmcnt(0)
ds_read_b64_tr_b16 a[32:33], v201 offset:8192
ds_read_b64_tr_b16 a[34:35], v201 offset:8704
ds_read_b64_tr_b16 a[36:37], v201 offset:8256
ds_read_b64_tr_b16 a[38:39], v201 offset:8768
ds_read_b64_tr_b16 a[40:41], v201 offset:10240
ds_read_b64_tr_b16 a[42:43], v201 offset:10752
ds_read_b64_tr_b16 a[44:45], v201 offset:10304
ds_read_b64_tr_b16 a[46:47], v201 offset:10816
s_waitcnt lgkmcnt(0)
s_add_u32 m0, s56, 12288
s_add_u32 s58, s57, 6144
s_and_b32 s58, s58, 0x7fff
s_lshl_b32 s58, s58, 5
buffer_load_dwordx4 v200, s[52:55], s58 offen lds
s_add_u32 m0, s56, 13312
s_add_u32 s58, s57, 6656
s_and_b32 s58, s58, 0x7fff
s_lshl_b32 s58, s58, 5
buffer_load_dwordx4 v200, s[52:55], s58 offen lds
s_add_u32 m0, s56, 14336
s_add_u32 s58, s57, 7168
s_and_b32 s58, s58, 0x7fff
s_lshl_b32 s58, s58, 5
buffer_load_dwordx4 v200, s[52:55], s58 offen lds
s_add_u32 m0, s56, 15360
s_add_u32 s58, s57, 7680
s_and_b32 s58, s58, 0x7fff
s_lshl_b32 s58, s58, 5
buffer_load_dwordx4 v200, s[52:55], s58 offen lds
s_waitcnt vmcnt(0)
ds_read_b64_tr_b16 a[48:49], v201 offset:12288
ds_read_b64_tr_b16 a[50:51], v201 offset:12800
ds_read_b64_tr_b16 a[52:53], v201 offset:12352
ds_read_b64_tr_b16 a[54:55], v201 offset:12864
ds_read_b64_tr_b16 a[56:57], v201 offset:14336
ds_read_b64_tr_b16 a[58:59], v201 offset:14848
ds_read_b64_tr_b16 a[60:61], v201 offset:14400
ds_read_b64_tr_b16 a[62:63], v201 offset:14912
s_waitcnt lgkmcnt(0)
s_add_u32 m0, s56, 16384
s_add_u32 s58, s57, 8192
s_and_b32 s58, s58, 0x7fff
s_lshl_b32 s58, s58, 5
buffer_load_dwordx4 v200, s[52:55], s58 offen lds
s_add_u32 m0, s56, 17408
s_add_u32 s58, s57, 8704
s_and_b32 s58, s58, 0x7fff
s_lshl_b32 s58, s58, 5
buffer_load_dwordx4 v200, s[52:55], s58 offen lds
s_add_u32 m0, s56, 18432
s_add_u32 s58, s57, 9216
s_and_b32 s58, s58, 0x7fff
s_lshl_b32 s58, s58, 5
buffer_load_dwordx4 v200, s[52:55], s58 offen lds
s_add_u32 m0, s56, 19456
s_add_u32 s58, s57, 9728
s_and_b32 s58, s58, 0x7fff
s_lshl_b32 s58, s58, 5
buffer_load_dwordx4 v200, s[52:55], s58 offen lds
s_waitcnt vmcnt(0)
ds_read_b64_tr_b16 a[64:65], v201 offset:16384
ds_read_b64_tr_b16 a[66:67], v201 offset:16896
ds_read_b64_tr_b16 a[68:69], v201 offset:16448
ds_read_b64_tr_b16 a[70:71], v201 offset:16960
ds_read_b64_tr_b16 a[72:73], v201 offset:18432
ds_read_b64_tr_b16 a[74:75], v201 offset:18944
ds_read_b64_tr_b16 a[76:77], v201 offset:18496
ds_read_b64_tr_b16 a[78:79], v201 offset:19008
s_waitcnt lgkmcnt(0)
s_add_u32 m0, s56, 20480
s_add_u32 s58, s57, 10240
s_and_b32 s58, s58, 0x7fff
s_lshl_b32 s58, s58, 5
buffer_load_dwordx4 v200, s[52:55], s58 offen lds
s_add_u32 m0, s56, 21504
s_add_u32 s58, s57, 10752
s_and_b32 s58, s58, 0x7fff
s_lshl_b32 s58, s58, 5
buffer_load_dwordx4 v200, s[52:55], s58 offen lds
s_add_u32 m0, s56, 22528
s_add_u32 s58, s57, 11264
s_and_b32 s58, s58, 0x7fff
s_lshl_b32 s58, s58, 5
buffer_load_dwordx4 v200, s[52:55], s58 offen lds
s_add_u32 m0, s56, 23552
s_add_u32 s58, s57, 11776
s_and_b32 s58, s58, 0x7fff
s_lshl_b32 s58, s58, 5
buffer_load_dwordx4 v200, s[52:55], s58 offen lds
s_waitcnt vmcnt(0)
ds_read_b64_tr_b16 a[80:81], v201 offset:20480
ds_read_b64_tr_b16 a[82:83], v201 offset:20992
ds_read_b64_tr_b16 a[84:85], v201 offset:20544
ds_read_b64_tr_b16 a[86:87], v201 offset:21056
ds_read_b64_tr_b16 a[88:89], v201 offset:22528
ds_read_b64_tr_b16 a[90:91], v201 offset:23040
ds_read_b64_tr_b16 a[92:93], v201 offset:22592
ds_read_b64_tr_b16 a[94:95], v201 offset:23104
s_waitcnt lgkmcnt(0)
s_add_u32 m0, s56, 24576
s_add_u32 s58, s57, 12288
s_and_b32 s58, s58, 0x7fff
s_lshl_b32 s58, s58, 5
buffer_load_dwordx4 v200, s[52:55], s58 offen lds
s_add_u32 m0, s56, 25600
s_add_u32 s58, s57, 12800
s_and_b32 s58, s58, 0x7fff
s_lshl_b32 s58, s58, 5
buffer_load_dwordx4 v200, s[52:55], s58 offen lds
s_add_u32 m0, s56, 26624
s_add_u32 s58, s57, 13312
s_and_b32 s58, s58, 0x7fff
s_lshl_b32 s58, s58, 5
buffer_load_dwordx4 v200, s[52:55], s58 offen lds
s_add_u32 m0, s56, 27648
s_add_u32 s58, s57, 13824
s_and_b32 s58, s58, 0x7fff
s_lshl_b32 s58, s58, 5
buffer_load_dwordx4 v200, s[52:55], s58 offen lds
s_waitcnt vmcnt(0)
ds_read_b64_tr_b16 a[96:97], v201 offset:24576
ds_read_b64_tr_b16 a[98:99], v201 offset:25088
ds_read_b64_tr_b16 a[100:101], v201 offset:24640
ds_read_b64_tr_b16 a[102:103], v201 offset:25152
ds_read_b64_tr_b16 a[104:105], v201 offset:26624
ds_read_b64_tr_b16 a[106:107], v201 offset:27136
ds_read_b64_tr_b16 a[108:109], v201 offset:26688
ds_read_b64_tr_b16 a[110:111], v201 offset:27200
s_waitcnt lgkmcnt(0)
s_add_u32 m0, s56, 28672
s_add_u32 s58, s57, 14336
s_and_b32 s58, s58, 0x7fff
s_lshl_b32 s58, s58, 5
buffer_load_dwordx4 v200, s[52:55], s58 offen lds
s_add_u32 m0, s56, 29696
s_add_u32 s58, s57, 14848
s_and_b32 s58, s58, 0x7fff
s_lshl_b32 s58, s58, 5
buffer_load_dwordx4 v200, s[52:55], s58 offen lds
s_add_u32 m0, s56, 30720
s_add_u32 s58, s57, 15360
s_and_b32 s58, s58, 0x7fff
s_lshl_b32 s58, s58, 5
buffer_load_dwordx4 v200, s[52:55], s58 offen lds
s_add_u32 m0, s56, 31744
s_add_u32 s58, s57, 15872
s_and_b32 s58, s58, 0x7fff
s_lshl_b32 s58, s58, 5
buffer_load_dwordx4 v200, s[52:55], s58 offen lds
s_waitcnt vmcnt(0)
ds_read_b64_tr_b16 a[112:113], v201 offset:28672
ds_read_b64_tr_b16 a[114:115], v201 offset:29184
ds_read_b64_tr_b16 a[116:117], v201 offset:28736
ds_read_b64_tr_b16 a[118:119], v201 offset:29248
ds_read_b64_tr_b16 a[120:121], v201 offset:30720
ds_read_b64_tr_b16 a[122:123], v201 offset:31232
ds_read_b64_tr_b16 a[124:125], v201 offset:30784
ds_read_b64_tr_b16 a[126:127], v201 offset:31296
s_waitcnt lgkmcnt(0)
s_add_u32 m0, s56, 0
s_add_u32 s58, s57, 16384
s_and_b32 s58, s58, 0x7fff
s_lshl_b32 s58, s58, 5
buffer_load_dwordx4 v200, s[52:55], s58 offen lds
s_add_u32 m0, s56, 1024
s_add_u32 s58, s57, 16896
s_and_b32 s58, s58, 0x7fff
s_lshl_b32 s58, s58, 5
buffer_load_dwordx4 v200, s[52:55], s58 offen lds
s_add_u32 m0, s56, 2048
s_add_u32 s58, s57, 17408
s_and_b32 s58, s58, 0x7fff
s_lshl_b32 s58, s58, 5
buffer_load_dwordx4 v200, s[52:55], s58 offen lds
s_add_u32 m0, s56, 3072
s_add_u32 s58, s57, 17920
s_and_b32 s58, s58, 0x7fff
s_lshl_b32 s58, s58, 5
buffer_load_dwordx4 v200, s[52:55], s58 offen lds
s_waitcnt vmcnt(0)
ds_read_b64_tr_b16 a[128:129], v201
ds_read_b64_tr_b16 a[130:131], v201 offset:512
ds_read_b64_tr_b16 a[132:133], v201 offset:64
ds_read_b64_tr_b16 a[134:135], v201 offset:576
ds_read_b64_tr_b16 a[136:137], v201 offset:2048
ds_read_b64_tr_b16 a[138:139], v201 offset:2560
ds_read_b64_tr_b16 a[140:141], v201 offset:2112
ds_read_b64_tr_b16 a[142:143], v201 offset:2624
s_waitcnt lgkmcnt(0)
s_add_u32 m0, s56, 4096
s_add_u32 s58, s57, 18432
s_and_b32 s58, s58, 0x7fff
s_lshl_b32 s58, s58, 5
buffer_load_dwordx4 v200, s[52:55], s58 offen lds
s_add_u32 m0, s56, 5120
s_add_u32 s58, s57, 18944
s_and_b32 s58, s58, 0x7fff
s_lshl_b32 s58, s58, 5
buffer_load_dwordx4 v200, s[52:55], s58 offen lds
s_add_u32 m0, s56, 6144
s_add_u32 s58, s57, 19456
s_and_b32 s58, s58, 0x7fff
s_lshl_b32 s58, s58, 5
buffer_load_dwordx4 v200, s[52:55], s58 offen lds
s_add_u32 m0, s56, 7168
s_add_u32 s58, s57, 19968
s_and_b32 s58, s58, 0x7fff
s_lshl_b32 s58, s58, 5
buffer_load_dwordx4 v200, s[52:55], s58 offen lds
s_waitcnt vmcnt(0)
ds_read_b64_tr_b16 a[144:145], v201 offset:4096
ds_read_b64_tr_b16 a[146:147], v201 offset:4608
ds_read_b64_tr_b16 a[148:149], v201 offset:4160
ds_read_b64_tr_b16 a[150:151], v201 offset:4672
ds_read_b64_tr_b16 a[152:153], v201 offset:6144
ds_read_b64_tr_b16 a[154:155], v201 offset:6656
ds_read_b64_tr_b16 a[156:157], v201 offset:6208
ds_read_b64_tr_b16 a[158:159], v201 offset:6720
s_waitcnt lgkmcnt(0)
s_add_u32 m0, s56, 8192
s_add_u32 s58, s57, 20480
s_and_b32 s58, s58, 0x7fff
s_lshl_b32 s58, s58, 5
buffer_load_dwordx4 v200, s[52:55], s58 offen lds
s_add_u32 m0, s56, 9216
s_add_u32 s58, s57, 20992
s_and_b32 s58, s58, 0x7fff
s_lshl_b32 s58, s58, 5
buffer_load_dwordx4 v200, s[52:55], s58 offen lds
s_add_u32 m0, s56, 10240
s_add_u32 s58, s57, 21504
s_and_b32 s58, s58, 0x7fff
s_lshl_b32 s58, s58, 5
buffer_load_dwordx4 v200, s[52:55], s58 offen lds
s_add_u32 m0, s56, 11264
s_add_u32 s58, s57, 22016
s_and_b32 s58, s58, 0x7fff
s_lshl_b32 s58, s58, 5
buffer_load_dwordx4 v200, s[52:55], s58 offen lds
s_waitcnt vmcnt(0)
ds_read_b64_tr_b16 a[160:161], v201 offset:8192
ds_read_b64_tr_b16 a[162:163], v201 offset:8704
ds_read_b64_tr_b16 a[164:165], v201 offset:8256
ds_read_b64_tr_b16 a[166:167], v201 offset:8768
ds_read_b64_tr_b16 a[168:169], v201 offset:10240
ds_read_b64_tr_b16 a[170:171], v201 offset:10752
ds_read_b64_tr_b16 a[172:173], v201 offset:10304
ds_read_b64_tr_b16 a[174:175], v201 offset:10816
s_waitcnt lgkmcnt(0)
s_add_u32 m0, s56, 12288
s_add_u32 s58, s57, 22528
s_and_b32 s58, s58, 0x7fff
s_lshl_b32 s58, s58, 5
buffer_load_dwordx4 v200, s[52:55], s58 offen lds
s_add_u32 m0, s56, 13312
s_add_u32 s58, s57, 23040
s_and_b32 s58, s58, 0x7fff
s_lshl_b32 s58, s58, 5
buffer_load_dwordx4 v200, s[52:55], s58 offen lds
s_add_u32 m0, s56, 14336
s_add_u32 s58, s57, 23552
s_and_b32 s58, s58, 0x7fff
s_lshl_b32 s58, s58, 5
buffer_load_dwordx4 v200, s[52:55], s58 offen lds
s_add_u32 m0, s56, 15360
s_add_u32 s58, s57, 24064
s_and_b32 s58, s58, 0x7fff
s_lshl_b32 s58, s58, 5
buffer_load_dwordx4 v200, s[52:55], s58 offen lds
s_waitcnt vmcnt(0)
ds_read_b64_tr_b16 a[176:177], v201 offset:12288
ds_read_b64_tr_b16 a[178:179], v201 offset:12800
ds_read_b64_tr_b16 a[180:181], v201 offset:12352
ds_read_b64_tr_b16 a[182:183], v201 offset:12864
ds_read_b64_tr_b16 a[184:185], v201 offset:14336
ds_read_b64_tr_b16 a[186:187], v201 offset:14848
ds_read_b64_tr_b16 a[188:189], v201 offset:14400
ds_read_b64_tr_b16 a[190:191], v201 offset:14912
s_waitcnt lgkmcnt(0)
s_add_u32 m0, s56, 16384
s_add_u32 s58, s57, 24576
s_and_b32 s58, s58, 0x7fff
s_lshl_b32 s58, s58, 5
buffer_load_dwordx4 v200, s[52:55], s58 offen lds
s_add_u32 m0, s56, 17408
s_add_u32 s58, s57, 25088
s_and_b32 s58, s58, 0x7fff
s_lshl_b32 s58, s58, 5
buffer_load_dwordx4 v200, s[52:55], s58 offen lds
s_add_u32 m0, s56, 18432
s_add_u32 s58, s57, 25600
s_and_b32 s58, s58, 0x7fff
s_lshl_b32 s58, s58, 5
buffer_load_dwordx4 v200, s[52:55], s58 offen lds
s_add_u32 m0, s56, 19456
s_add_u32 s58, s57, 26112
s_and_b32 s58, s58, 0x7fff
s_lshl_b32 s58, s58, 5
buffer_load_dwordx4 v200, s[52:55], s58 offen lds
s_waitcnt vmcnt(0)
ds_read_b64_tr_b16 a[192:193], v201 offset:16384
ds_read_b64_tr_b16 a[194:195], v201 offset:16896
ds_read_b64_tr_b16 a[196:197], v201 offset:16448
ds_read_b64_tr_b16 a[198:199], v201 offset:16960
ds_read_b64_tr_b16 a[200:201], v201 offset:18432
ds_read_b64_tr_b16 a[202:203], v201 offset:18944
ds_read_b64_tr_b16 a[204:205], v201 offset:18496
ds_read_b64_tr_b16 a[206:207], v201 offset:19008
s_waitcnt lgkmcnt(0)
s_add_u32 m0, s56, 20480
s_add_u32 s58, s57, 26624
s_and_b32 s58, s58, 0x7fff
s_lshl_b32 s58, s58, 5
buffer_load_dwordx4 v200, s[52:55], s58 offen lds
s_add_u32 m0, s56, 21504
s_add_u32 s58, s57, 27136
s_and_b32 s58, s58, 0x7fff
s_lshl_b32 s58, s58, 5
buffer_load_dwordx4 v200, s[52:55], s58 offen lds
s_add_u32 m0, s56, 22528
s_add_u32 s58, s57, 27648
s_and_b32 s58, s58, 0x7fff
s_lshl_b32 s58, s58, 5
buffer_load_dwordx4 v200, s[52:55], s58 offen lds
s_add_u32 m0, s56, 23552
s_add_u32 s58, s57, 28160
s_and_b32 s58, s58, 0x7fff
s_lshl_b32 s58, s58, 5
buffer_load_dwordx4 v200, s[52:55], s58 offen lds
s_waitcnt vmcnt(0)
ds_read_b64_tr_b16 a[208:209], v201 offset:20480
ds_read_b64_tr_b16 a[210:211], v201 offset:20992
ds_read_b64_tr_b16 a[212:213], v201 offset:20544
ds_read_b64_tr_b16 a[214:215], v201 offset:21056
ds_read_b64_tr_b16 a[216:217], v201 offset:22528
ds_read_b64_tr_b16 a[218:219], v201 offset:23040
ds_read_b64_tr_b16 a[220:221], v201 offset:22592
ds_read_b64_tr_b16 a[222:223], v201 offset:23104
s_waitcnt lgkmcnt(0)
s_add_u32 m0, s56, 24576
s_add_u32 s58, s57, 28672
s_and_b32 s58, s58, 0x7fff
s_lshl_b32 s58, s58, 5
buffer_load_dwordx4 v200, s[52:55], s58 offen lds
s_add_u32 m0, s56, 25600
s_add_u32 s58, s57, 29184
s_and_b32 s58, s58, 0x7fff
s_lshl_b32 s58, s58, 5
buffer_load_dwordx4 v200, s[52:55], s58 offen lds
s_add_u32 m0, s56, 26624
s_add_u32 s58, s57, 29696
s_and_b32 s58, s58, 0x7fff
s_lshl_b32 s58, s58, 5
buffer_load_dwordx4 v200, s[52:55], s58 offen lds
s_add_u32 m0, s56, 27648
s_add_u32 s58, s57, 30208
s_and_b32 s58, s58, 0x7fff
s_lshl_b32 s58, s58, 5
buffer_load_dwordx4 v200, s[52:55], s58 offen lds
s_waitcnt vmcnt(0)
ds_read_b64_tr_b16 a[224:225], v201 offset:24576
ds_read_b64_tr_b16 a[226:227], v201 offset:25088
ds_read_b64_tr_b16 a[228:229], v201 offset:24640
ds_read_b64_tr_b16 a[230:231], v201 offset:25152
ds_read_b64_tr_b16 a[232:233], v201 offset:26624
ds_read_b64_tr_b16 a[234:235], v201 offset:27136
ds_read_b64_tr_b16 a[236:237], v201 offset:26688
ds_read_b64_tr_b16 a[238:239], v201 offset:27200
s_waitcnt lgkmcnt(0)
s_add_u32 m0, s56, 28672
s_add_u32 s58, s57, 30720
s_and_b32 s58, s58, 0x7fff
s_lshl_b32 s58, s58, 5
buffer_load_dwordx4 v200, s[52:55], s58 offen lds
s_add_u32 m0, s56, 29696
s_add_u32 s58, s57, 31232
s_and_b32 s58, s58, 0x7fff
s_lshl_b32 s58, s58, 5
buffer_load_dwordx4 v200, s[52:55], s58 offen lds
s_add_u32 m0, s56, 30720
s_add_u32 s58, s57, 31744
s_and_b32 s58, s58, 0x7fff
s_lshl_b32 s58, s58, 5
buffer_load_dwordx4 v200, s[52:55], s58 offen lds
s_add_u32 m0, s56, 31744
s_add_u32 s58, s57, 32256
s_and_b32 s58, s58, 0x7fff
s_lshl_b32 s58, s58, 5
buffer_load_dwordx4 v200, s[52:55], s58 offen lds
s_waitcnt vmcnt(0)
ds_read_b64_tr_b16 a[240:241], v201 offset:28672
ds_read_b64_tr_b16 a[242:243], v201 offset:29184
ds_read_b64_tr_b16 a[244:245], v201 offset:28736
ds_read_b64_tr_b16 a[246:247], v201 offset:29248
ds_read_b64_tr_b16 a[248:249], v201 offset:30720
ds_read_b64_tr_b16 a[250:251], v201 offset:31232
ds_read_b64_tr_b16 a[252:253], v201 offset:30784
ds_read_b64_tr_b16 a[254:255], v201 offset:31296
s_waitcnt lgkmcnt(0)
s_load_dwordx2 s[12:13], s[0:1], 80
v_lshrrev_b32 v3, 6, v0
v_and_b32 v1, 63, v0
v_readfirstlane_b32 s16, v3
s_lshr_b32 s17, s92, 5
s_and_b32 s18, s92, 31
v_lshlrev_b32 v2, 4, v1
v_lshlrev_b32 v19, 4, v0
v_lshlrev_b32 v7, 3, v1
s_waitcnt lgkmcnt(0)
s_mov_b32 s14, 8388608
s_mov_b32 s15, 0x00020000
s_mov_b32 s24, 0x3e0293ee
s_mov_b64 s[60:61], 0
s_lshr_b32 s50, s18, 1
s_lshl_b32 s50, s50, 12
s_mov_b32 s47, 0
s_mov_b32 s51, 0
s_lshl_b32 s20, s17, 3
s_add_u32 s20, s20, s16
s_lshl_b32 s20, s20, 18
s_lshl_b32 s21, s18, 13
s_add_u32 s20, s20, s21
s_add_u32 s20, s20, 50331648
v_lshlrev_b32 v26, 7, v1
buffer_load_dword v28, v26, s[84:87], s20 offen sc1
buffer_load_dword v30, v26, s[84:87], s20 offen offset:64 sc1
s_add_u32 s20, s20, 1048576
buffer_load_dword v29, v26, s[84:87], s20 offen sc1
buffer_load_dword v31, v26, s[84:87], s20 offen offset:64 sc1
s_lshl_b32 s20, s92, 15
s_add_u32 s20, s20, 75497472
v_lshlrev_b32 v26, 7, v0
buffer_load_dword v32, v26, s[84:87], s20 offen sc1
buffer_load_dword v33, v26, s[84:87], s20 offen offset:64 sc1
v_and_b32 v4, 15, v1
v_lshrrev_b32 v5, 4, v1
v_lshrrev_b32 v3, 2, v4
v_lshlrev_b32 v3, 1, v3
v_and_b32 v26, 1, v4
v_add_u32 v3, v3, v26
v_lshlrev_b32 v6, 8, v3
v_lshl_add_u32 v6, v5, 4, v6
v_lshlrev_b32 v8, 9, v5
v_lshl_add_u32 v8, v4, 4, v8
v_lshlrev_b32 v26, 2, v5
v_sub_u32 v248, v4, v26
s_and_b32 s21, s16, 1
s_lshl_b32 s21, s21, 4
v_add_u32 v9, s21, v248
v_add_u32 v10, -16, v9
v_mov_b32 v11, 0xff7fffff
v_mov_b32 v20, 0x3f803f80
v_mov_b32 v21, 0x3f803f80
v_mov_b32 v22, 0x3f803f80
v_mov_b32 v23, 0x3f803f80
v_bfe_u32 v26, v1, 1, 2
v_min_u32 v26, 2, v26
s_lshl_b32 s20, s18, 8
s_add_u32 s20, s20, 71303168
v_lshlrev_b32 v12, 13, v26
v_and_b32 v26, 1, v1
v_lshl_add_u32 v12, v26, 7, v12
v_add_u32 v12, s20, v12
v_lshlrev_b32 v13, 7, v26
s_add_u32 s43, s20, 24576
v_add_u32 v13, s43, v13
s_lshl_b32 s21, s21, 3
s_add_u32 s20, s20, s21
s_add_u32 s20, s20, 8192
v_mov_b32 v249, s20
s_mov_b32 vcc_lo, 0xcccccccc
s_mov_b32 vcc_hi, 0xcccccccc
v_cndmask_b32 v249, v13, v249, vcc
v_and_b32 v26, 3, v1
s_and_b32 s20, s18, 1
s_lshl_b32 s20, s20, 2
s_add_u32 s20, s20, s16
s_lshl_b32 s20, s20, 2
s_lshl_b32 s21, s17, 5
s_add_u32 s20, s20, s21
v_add_u32 v26, s20, v26
v_lshlrev_b32 v14, 7, v26
v_add_u32 v14, 71335936, v14
v_bfrev_b32 v26, 1
s_lshl_b32 s20, s92, 7
s_add_u32 s20, s20, 71335936
v_mov_b32 v27, s20
s_xor_b32 s20, s20, 128
v_mov_b32 v251, s20
v_cmp_eq_u32 vcc, 0, v0
s_mul_i32 s20, s16, 8704
v_lshrrev_b32 v17, 5, v1
v_lshl_add_u32 v17, v17, 5, v2
v_add_u32 v17, s20, v17
v_cndmask_b32 v15, v26, v27, vcc
v_lshrrev_b32 v26, 3, v0
v_and_b32 v27, 7, v0
v_mul_u32_u24 v16, 544, v27
v_lshl_add_u32 v16, v26, 4, v16
s_and_b32 s20, s18, 1
s_mul_i32 s20, s20, 4352
s_xor_b32 s21, s20, 4352
v_add_u32 v252, s21, v16
v_add_u32 v16, s20, v16
v_lshlrev_b32 v18, 12, v26
v_and_b32 v27, 7, v0
v_lshl_add_u32 v18, v27, 3, v18
s_lshl_b32 s20, s18, 6
v_add_u32 v18, s20, v18
s_barrier
s_cmp_eq_u32 s17, 0
s_cselect_b32 s60, 0x0, s60
s_cselect_b32 s61, 0x0, s61
s_cmp_eq_u32 s17, 1
s_cselect_b32 s60, 0x0, s60
s_cselect_b32 s61, 0x0, s61
s_cmp_eq_u32 s17, 2
s_cselect_b32 s60, 0x0, s60
s_cselect_b32 s61, 0x45000100, s61
s_cmp_eq_u32 s17, 3
s_cselect_b32 s60, 0x0, s60
s_cselect_b32 s61, 0x8a001000, s61
s_cmp_eq_u32 s17, 4
s_cselect_b32 s60, 0x1010101, s60
s_cselect_b32 s61, 0x10010001, s61
s_cmp_eq_u32 s17, 5
s_cselect_b32 s60, 0x10101010, s60
s_cselect_b32 s61, 0x20100010, s61
s_ff1_i32_b64 s22, s[60:61]
s_cmp_ge_u32 s22, 64
s_cbranch_scc1 L_x_fin
L_x_gp:
buffer_load_dword v3, v12, s[84:87], 0 offen sc1
s_waitcnt vmcnt(0)
v_cmp_gt_u32 vcc, 32, v3
s_and_b32 vcc_lo, vcc_lo, 252
s_cbranch_scc0 L_x_gk
s_sleep 8
s_branch L_x_gp
L_x_gk:
L_x_job:
s_cmp_ge_u32 s22, 56
s_cbranch_scc1 L_x_single
s_add_u32 s43, s22, s16
s_lshl_b32 s26, s43, 18
s_lshl_b32 s20, s18, 13
s_add_u32 s26, s26, s20
s_lshr_b32 s20, s43, 1
s_add_u32 s20, s20, 32
v_mov_b32 v250, s43
v_mov_b32 v3, s20
s_mov_b32 vcc_lo, 0xcccccccc
s_mov_b32 vcc_hi, 0xcccccccc
v_cndmask_b32 v250, v250, v3, vcc
L_x_btop:
buffer_load_dword v3, v249, s[84:87], 0 offen sc1
s_waitcnt vmcnt(0)
v_cmp_ge_u32 vcc, v250, v3
s_cbranch_vccz L_x_bk
s_sleep 8
s_branch L_x_btop
L_x_bk:
s_add_u32 s21, s26, 0
buffer_load_dwordx4 v[24:27], v2, s[84:87], s21 offen
buffer_load_dwordx4 v[28:31], v2, s[84:87], s21 offen offset:1024
buffer_load_dwordx4 v[32:35], v2, s[84:87], s21 offen offset:2048
buffer_load_dwordx4 v[36:39], v2, s[84:87], s21 offen offset:3072
s_add_u32 s21, s26, 4096
buffer_load_dwordx4 v[40:43], v2, s[84:87], s21 offen
buffer_load_dwordx4 v[44:47], v2, s[84:87], s21 offen offset:1024
buffer_load_dwordx4 v[48:51], v2, s[84:87], s21 offen offset:2048
buffer_load_dwordx4 v[52:55], v2, s[84:87], s21 offen offset:3072
s_add_u32 s21, s26, 16777216
buffer_load_dwordx4 v[56:59], v2, s[84:87], s21 offen
buffer_load_dwordx4 v[60:63], v2, s[84:87], s21 offen offset:1024
buffer_load_dwordx4 v[64:67], v2, s[84:87], s21 offen offset:2048
buffer_load_dwordx4 v[68:71], v2, s[84:87], s21 offen offset:3072
s_add_u32 s21, s26, 16781312
buffer_load_dwordx4 v[72:75], v2, s[84:87], s21 offen
buffer_load_dwordx4 v[76:79], v2, s[84:87], s21 offen offset:1024
buffer_load_dwordx4 v[80:83], v2, s[84:87], s21 offen offset:2048
buffer_load_dwordx4 v[84:87], v2, s[84:87], s21 offen offset:3072
s_add_u32 s21, s26, 33554432
buffer_load_dwordx4 v[88:91], v2, s[84:87], s21 offen
buffer_load_dwordx4 v[92:95], v2, s[84:87], s21 offen offset:1024
buffer_load_dwordx4 v[96:99], v2, s[84:87], s21 offen offset:2048
buffer_load_dwordx4 v[100:103], v2, s[84:87], s21 offen offset:3072
s_add_u32 s21, s26, 33558528
buffer_load_dwordx4 v[104:107], v2, s[84:87], s21 offen
buffer_load_dwordx4 v[108:111], v2, s[84:87], s21 offen offset:1024
buffer_load_dwordx4 v[112:115], v2, s[84:87], s21 offen offset:2048
buffer_load_dwordx4 v[116:119], v2, s[84:87], s21 offen offset:3072
s_add_u32 s21, s26, 178257920
buffer_load_dwordx4 v[120:123], v6, s[84:87], s21 offen sc1
buffer_load_dwordx4 v[124:127], v6, s[84:87], s21 offen offset:64 sc1
buffer_load_dwordx4 v[128:131], v6, s[84:87], s21 offen offset:128 sc1
buffer_load_dwordx4 v[132:135], v6, s[84:87], s21 offen offset:192 sc1
s_add_u32 s21, s26, 178259968
buffer_load_dwordx2 v[136:137], v7, s[84:87], s21 offen sc1
buffer_load_dwordx2 v[138:139], v7, s[84:87], s21 offen offset:2048 sc1
buffer_load_dwordx2 v[140:141], v7, s[84:87], s21 offen offset:512 sc1
buffer_load_dwordx2 v[142:143], v7, s[84:87], s21 offen offset:2560 sc1
buffer_load_dwordx2 v[144:145], v7, s[84:87], s21 offen offset:1024 sc1
buffer_load_dwordx2 v[146:147], v7, s[84:87], s21 offen offset:3072 sc1
buffer_load_dwordx2 v[148:149], v7, s[84:87], s21 offen offset:1536 sc1
buffer_load_dwordx2 v[150:151], v7, s[84:87], s21 offen offset:3584 sc1
L_x_batt:
s_lshl_b32 s40, s17, 3
s_add_u32 s40, s40, s47
s_add_u32 s40, s40, s16
s_lshl_b32 s40, s40, 18
s_add_u32 s40, s40, 50331648
s_lshl_b32 s20, s18, 13
s_add_u32 s40, s40, s20
v_mov_b32 v218, v20
v_mov_b32 v219, 0
s_add_u32 s27, s40, 4096
s_mov_b32 s8, 4
s_waitcnt vmcnt(0)
v_swap_b32 v137, v138
v_swap_b32 v141, v142
v_swap_b32 v145, v146
v_swap_b32 v149, v150
v_mfma_f32_16x16x32_bf16 v[200:203], v[56:59], v[24:27], 0
v_mfma_f32_16x16x32_bf16 v[208:211], v[120:123], v[24:27], 0
v_mfma_f32_16x16x32_bf16 v[200:203], v[64:67], v[32:35], v[200:203]
v_mfma_f32_16x16x32_bf16 v[208:211], v[124:127], v[32:35], v[208:211]
v_mfma_f32_16x16x32_bf16 v[200:203], v[72:75], v[40:43], v[200:203]
v_mfma_f32_16x16x32_bf16 v[208:211], v[128:131], v[40:43], v[208:211]
v_mfma_f32_16x16x32_bf16 v[200:203], v[80:83], v[48:51], v[200:203]
v_mfma_f32_16x16x32_bf16 v[208:211], v[132:135], v[48:51], v[208:211]
s_nop 5
v_cmp_gt_i32 vcc, 0, v248
s_nop 1
v_cndmask_b32 v200, v200, v11, vcc
v_cmp_gt_i32 vcc, 1, v248
s_nop 1
v_cndmask_b32 v201, v201, v11, vcc
v_cmp_gt_i32 vcc, 2, v248
s_nop 1
v_cndmask_b32 v202, v202, v11, vcc
v_cmp_gt_i32 vcc, 3, v248
s_nop 1
v_cndmask_b32 v203, v203, v11, vcc
v_max3_f32 v4, v200, v201, v202
v_max3_f32 v4, v4, v203, v208
v_max_f32 v3, v4, v209
v_max_f32 v4, v4, v209
s_nop 1
v_permlane16_swap_b32 v4, v3
v_max_f32 v4, v4, v3
v_max_f32 v3, v4, v3
s_nop 1
v_permlane32_swap_b32 v4, v3
v_max_f32 v4, v4, v3
v_mul_f32 v4, s24, v4
v_fma_f32 v200, v200, s24, -v4
v_fma_f32 v201, v201, s24, -v4
v_fma_f32 v202, v202, s24, -v4
v_fma_f32 v203, v203, s24, -v4
v_fma_f32 v208, v208, s24, -v4
v_fma_f32 v209, v209, s24, -v4
v_exp_f32 v200, v200
v_exp_f32 v201, v201
v_exp_f32 v202, v202
v_exp_f32 v203, v203
v_exp_f32 v208, v208
v_exp_f32 v209, v209
s_nop 0
v_cvt_pk_bf16_f32 v212, v200, v201
v_cvt_pk_bf16_f32 v213, v202, v203
v_mov_b32 v214, 0
v_mov_b32 v215, 0
v_cvt_pk_bf16_f32 v216, v208, v209
v_cvt_pk_bf16_f32 v217, v208, v209
v_mfma_f32_16x16x32_bf16 v[220:223], v[20:23], v[212:215], 0
v_mfma_f32_16x16x32_bf16 v[152:155], v[88:91], v[212:215], 0
v_mfma_f32_16x16x32_bf16 v[156:159], v[92:95], v[212:215], 0
v_mfma_f32_16x16x32_bf16 v[160:163], v[96:99], v[212:215], 0
v_mfma_f32_16x16x32_bf16 v[164:167], v[100:103], v[212:215], 0
v_mfma_f32_16x16x32_bf16 v[168:171], v[104:107], v[212:215], 0
v_mfma_f32_16x16x32_bf16 v[172:175], v[108:111], v[212:215], 0
v_mfma_f32_16x16x32_bf16 v[176:179], v[112:115], v[212:215], 0
v_mfma_f32_16x16x32_bf16 v[180:183], v[116:119], v[212:215], 0
v_mfma_f32_16x16x16_bf16 v[220:223], v[218:219], v[216:217], v[220:223]
v_mfma_f32_16x16x16_bf16 v[152:155], v[136:137], v[216:217], v[152:155]
v_mfma_f32_16x16x16_bf16 v[156:159], v[138:139], v[216:217], v[156:159]
v_mfma_f32_16x16x16_bf16 v[160:163], v[140:141], v[216:217], v[160:163]
v_mfma_f32_16x16x16_bf16 v[164:167], v[142:143], v[216:217], v[164:167]
v_mfma_f32_16x16x16_bf16 v[168:171], v[144:145], v[216:217], v[168:171]
v_mfma_f32_16x16x16_bf16 v[172:175], v[146:147], v[216:217], v[172:175]
v_mfma_f32_16x16x16_bf16 v[176:179], v[148:149], v[216:217], v[176:179]
v_mfma_f32_16x16x16_bf16 v[180:183], v[150:151], v[216:217], v[180:183]
v_rcp_f32 v220, v220
s_nop 1
v_pk_mul_f32 v[152:153], v[152:153], v[220:221] op_sel_hi:[1,0]
v_pk_mul_f32 v[154:155], v[154:155], v[220:221] op_sel_hi:[1,0]
v_pk_mul_f32 v[156:157], v[156:157], v[220:221] op_sel_hi:[1,0]
v_pk_mul_f32 v[158:159], v[158:159], v[220:221] op_sel_hi:[1,0]
v_pk_mul_f32 v[160:161], v[160:161], v[220:221] op_sel_hi:[1,0]
v_pk_mul_f32 v[162:163], v[162:163], v[220:221] op_sel_hi:[1,0]
v_pk_mul_f32 v[164:165], v[164:165], v[220:221] op_sel_hi:[1,0]
v_pk_mul_f32 v[166:167], v[166:167], v[220:221] op_sel_hi:[1,0]
v_pk_mul_f32 v[168:169], v[168:169], v[220:221] op_sel_hi:[1,0]
v_pk_mul_f32 v[170:171], v[170:171], v[220:221] op_sel_hi:[1,0]
v_pk_mul_f32 v[172:173], v[172:173], v[220:221] op_sel_hi:[1,0]
v_pk_mul_f32 v[174:175], v[174:175], v[220:221] op_sel_hi:[1,0]
v_pk_mul_f32 v[176:177], v[176:177], v[220:221] op_sel_hi:[1,0]
v_pk_mul_f32 v[178:179], v[178:179], v[220:221] op_sel_hi:[1,0]
v_pk_mul_f32 v[180:181], v[180:181], v[220:221] op_sel_hi:[1,0]
v_pk_mul_f32 v[182:183], v[182:183], v[220:221] op_sel_hi:[1,0]
v_cvt_pk_bf16_f32 v184, v152, v153
v_cvt_pk_bf16_f32 v185, v154, v155
v_cvt_pk_bf16_f32 v186, v156, v157
v_cvt_pk_bf16_f32 v187, v158, v159
v_cvt_pk_bf16_f32 v188, v160, v161
v_cvt_pk_bf16_f32 v189, v162, v163
v_cvt_pk_bf16_f32 v190, v164, v165
v_cvt_pk_bf16_f32 v191, v166, v167
v_cvt_pk_bf16_f32 v192, v168, v169
v_cvt_pk_bf16_f32 v193, v170, v171
v_cvt_pk_bf16_f32 v194, v172, v173
v_cvt_pk_bf16_f32 v195, v174, v175
v_cvt_pk_bf16_f32 v196, v176, v177
v_cvt_pk_bf16_f32 v197, v178, v179
v_cvt_pk_bf16_f32 v198, v180, v181
v_cvt_pk_bf16_f32 v199, v182, v183
s_cmp_eq_u32 s96, 1
s_cbranch_scc1 L_x_st_9f
buffer_store_dwordx4 v[184:187], v8, s[84:87], s40 offen sc1
buffer_store_dwordx4 v[188:191], v8, s[84:87], s40 offen offset:2048 sc1
buffer_store_dwordx4 v[192:195], v8, s[84:87], s27 offen sc1
buffer_store_dwordx4 v[196:199], v8, s[84:87], s27 offen offset:2048 sc1
s_branch L_x_st_9d
L_x_st_9f:
buffer_store_dwordx4 v[184:187], v8, s[84:87], s40 offen
buffer_store_dwordx4 v[188:191], v8, s[84:87], s40 offen offset:2048
buffer_store_dwordx4 v[192:195], v8, s[84:87], s27 offen
buffer_store_dwordx4 v[196:199], v8, s[84:87], s27 offen offset:2048
L_x_st_9d:
v_mfma_f32_16x16x32_bf16 v[200:203], v[56:59], v[28:31], 0
v_mfma_f32_16x16x32_bf16 v[204:207], v[60:63], v[28:31], 0
v_mfma_f32_16x16x32_bf16 v[208:211], v[120:123], v[28:31], 0
v_mfma_f32_16x16x32_bf16 v[200:203], v[64:67], v[36:39], v[200:203]
v_mfma_f32_16x16x32_bf16 v[204:207], v[68:71], v[36:39], v[204:207]
v_mfma_f32_16x16x32_bf16 v[208:211], v[124:127], v[36:39], v[208:211]
v_mfma_f32_16x16x32_bf16 v[200:203], v[72:75], v[44:47], v[200:203]
v_mfma_f32_16x16x32_bf16 v[204:207], v[76:79], v[44:47], v[204:207]
v_mfma_f32_16x16x32_bf16 v[208:211], v[128:131], v[44:47], v[208:211]
v_mfma_f32_16x16x32_bf16 v[200:203], v[80:83], v[52:55], v[200:203]
v_mfma_f32_16x16x32_bf16 v[204:207], v[84:87], v[52:55], v[204:207]
v_mfma_f32_16x16x32_bf16 v[208:211], v[132:135], v[52:55], v[208:211]
s_nop 5
v_cmp_gt_i32 vcc, 0, v248
s_nop 1
v_cndmask_b32 v204, v204, v11, vcc
v_cmp_gt_i32 vcc, 1, v248
s_nop 1
v_cndmask_b32 v205, v205, v11, vcc
v_cmp_gt_i32 vcc, 2, v248
s_nop 1
v_cndmask_b32 v206, v206, v11, vcc
v_cmp_gt_i32 vcc, 3, v248
s_nop 1
v_cndmask_b32 v207, v207, v11, vcc
v_max3_f32 v4, v200, v201, v202
v_max3_f32 v4, v4, v203, v204
v_max3_f32 v4, v4, v205, v206
v_max3_f32 v4, v4, v207, v208
v_max_f32 v3, v4, v209
v_max_f32 v4, v4, v209
s_nop 1
v_permlane16_swap_b32 v4, v3
v_max_f32 v4, v4, v3
v_max_f32 v3, v4, v3
s_nop 1
v_permlane32_swap_b32 v4, v3
v_max_f32 v4, v4, v3
v_mul_f32 v4, s24, v4
v_fma_f32 v200, v200, s24, -v4
v_fma_f32 v201, v201, s24, -v4
v_fma_f32 v202, v202, s24, -v4
v_fma_f32 v203, v203, s24, -v4
v_fma_f32 v204, v204, s24, -v4
v_fma_f32 v205, v205, s24, -v4
v_fma_f32 v206, v206, s24, -v4
v_fma_f32 v207, v207, s24, -v4
v_fma_f32 v208, v208, s24, -v4
v_fma_f32 v209, v209, s24, -v4
v_exp_f32 v200, v200
v_exp_f32 v201, v201
v_exp_f32 v202, v202
v_exp_f32 v203, v203
v_exp_f32 v204, v204
v_exp_f32 v205, v205
v_exp_f32 v206, v206
v_exp_f32 v207, v207
v_exp_f32 v208, v208
v_exp_f32 v209, v209
s_nop 0
v_cvt_pk_bf16_f32 v212, v200, v201
v_cvt_pk_bf16_f32 v213, v202, v203
v_cvt_pk_bf16_f32 v214, v204, v205
v_cvt_pk_bf16_f32 v215, v206, v207
v_cvt_pk_bf16_f32 v216, v208, v209
v_cvt_pk_bf16_f32 v217, v208, v209
v_mfma_f32_16x16x32_bf16 v[220:223], v[20:23], v[212:215], 0
v_mfma_f32_16x16x32_bf16 v[152:155], v[88:91], v[212:215], 0
v_mfma_f32_16x16x32_bf16 v[156:159], v[92:95], v[212:215], 0
v_mfma_f32_16x16x32_bf16 v[160:163], v[96:99], v[212:215], 0
v_mfma_f32_16x16x32_bf16 v[164:167], v[100:103], v[212:215], 0
v_mfma_f32_16x16x32_bf16 v[168:171], v[104:107], v[212:215], 0
v_mfma_f32_16x16x32_bf16 v[172:175], v[108:111], v[212:215], 0
v_mfma_f32_16x16x32_bf16 v[176:179], v[112:115], v[212:215], 0
v_mfma_f32_16x16x32_bf16 v[180:183], v[116:119], v[212:215], 0
v_mfma_f32_16x16x16_bf16 v[220:223], v[218:219], v[216:217], v[220:223]
v_mfma_f32_16x16x16_bf16 v[152:155], v[136:137], v[216:217], v[152:155]
v_mfma_f32_16x16x16_bf16 v[156:159], v[138:139], v[216:217], v[156:159]
v_mfma_f32_16x16x16_bf16 v[160:163], v[140:141], v[216:217], v[160:163]
v_mfma_f32_16x16x16_bf16 v[164:167], v[142:143], v[216:217], v[164:167]
v_mfma_f32_16x16x16_bf16 v[168:171], v[144:145], v[216:217], v[168:171]
v_mfma_f32_16x16x16_bf16 v[172:175], v[146:147], v[216:217], v[172:175]
v_mfma_f32_16x16x16_bf16 v[176:179], v[148:149], v[216:217], v[176:179]
v_mfma_f32_16x16x16_bf16 v[180:183], v[150:151], v[216:217], v[180:183]
v_rcp_f32 v220, v220
s_nop 1
v_pk_mul_f32 v[152:153], v[152:153], v[220:221] op_sel_hi:[1,0]
v_pk_mul_f32 v[154:155], v[154:155], v[220:221] op_sel_hi:[1,0]
v_pk_mul_f32 v[156:157], v[156:157], v[220:221] op_sel_hi:[1,0]
v_pk_mul_f32 v[158:159], v[158:159], v[220:221] op_sel_hi:[1,0]
v_pk_mul_f32 v[160:161], v[160:161], v[220:221] op_sel_hi:[1,0]
v_pk_mul_f32 v[162:163], v[162:163], v[220:221] op_sel_hi:[1,0]
v_pk_mul_f32 v[164:165], v[164:165], v[220:221] op_sel_hi:[1,0]
v_pk_mul_f32 v[166:167], v[166:167], v[220:221] op_sel_hi:[1,0]
v_pk_mul_f32 v[168:169], v[168:169], v[220:221] op_sel_hi:[1,0]
v_pk_mul_f32 v[170:171], v[170:171], v[220:221] op_sel_hi:[1,0]
v_pk_mul_f32 v[172:173], v[172:173], v[220:221] op_sel_hi:[1,0]
v_pk_mul_f32 v[174:175], v[174:175], v[220:221] op_sel_hi:[1,0]
v_pk_mul_f32 v[176:177], v[176:177], v[220:221] op_sel_hi:[1,0]
v_pk_mul_f32 v[178:179], v[178:179], v[220:221] op_sel_hi:[1,0]
v_pk_mul_f32 v[180:181], v[180:181], v[220:221] op_sel_hi:[1,0]
v_pk_mul_f32 v[182:183], v[182:183], v[220:221] op_sel_hi:[1,0]
v_cvt_pk_bf16_f32 v184, v152, v153
v_cvt_pk_bf16_f32 v185, v154, v155
v_cvt_pk_bf16_f32 v186, v156, v157
v_cvt_pk_bf16_f32 v187, v158, v159
v_cvt_pk_bf16_f32 v188, v160, v161
v_cvt_pk_bf16_f32 v189, v162, v163
v_cvt_pk_bf16_f32 v190, v164, v165
v_cvt_pk_bf16_f32 v191, v166, v167
v_cvt_pk_bf16_f32 v192, v168, v169
v_cvt_pk_bf16_f32 v193, v170, v171
v_cvt_pk_bf16_f32 v194, v172, v173
v_cvt_pk_bf16_f32 v195, v174, v175
v_cvt_pk_bf16_f32 v196, v176, v177
v_cvt_pk_bf16_f32 v197, v178, v179
v_cvt_pk_bf16_f32 v198, v180, v181
v_cvt_pk_bf16_f32 v199, v182, v183
s_cmp_eq_u32 s96, 1
s_cbranch_scc1 L_x_st_10f
buffer_store_dwordx4 v[184:187], v8, s[84:87], s40 offen offset:256 sc1
buffer_store_dwordx4 v[188:191], v8, s[84:87], s40 offen offset:2304 sc1
buffer_store_dwordx4 v[192:195], v8, s[84:87], s27 offen offset:256 sc1
buffer_store_dwordx4 v[196:199], v8, s[84:87], s27 offen offset:2304 sc1
s_branch L_x_st_10d
L_x_st_10f:
buffer_store_dwordx4 v[184:187], v8, s[84:87], s40 offen offset:256
buffer_store_dwordx4 v[188:191], v8, s[84:87], s40 offen offset:2304
buffer_store_dwordx4 v[192:195], v8, s[84:87], s27 offen offset:256
buffer_store_dwordx4 v[196:199], v8, s[84:87], s27 offen offset:2304
L_x_st_10d:
s_branch L_x_pub
L_x_single:
s_cmp_eq_u32 s51, 1
s_cbranch_scc1 L_x_gqd
L_x_gq:
buffer_load_dword v3, v12, s[84:87], 0 offen sc1
s_waitcnt vmcnt(0)
v_cmp_ne_u32 vcc, 64, v3
s_and_b32 vcc_lo, vcc_lo, 0xc
s_cbranch_scc0 L_x_gqd
s_sleep 8
s_branch L_x_gq
L_x_gqd:
s_mov_b32 s51, 1
s_lshl_b32 s27, s22, 18
s_lshl_b32 s20, s18, 13
s_add_u32 s27, s27, s20
s_add_u32 s29, s27, 178257920
s_and_b32 s20, s16, 1
s_lshl_b32 s20, s20, 10
s_add_u32 s26, s27, s20
s_add_u32 s26, s26, 0
s_lshr_b32 s20, s16, 1
s_lshl_b32 s20, s20, 12
s_add_u32 s28, s27, s20
s_add_u32 s28, s28, 33554432
s_add_u32 s27, s27, 16777216
s_add_u32 s48, s26, 4096
s_add_u32 s49, s27, 4096
buffer_load_dwordx4 v[24:27], v2, s[84:87], s26 offen
buffer_load_dwordx4 v[28:31], v2, s[84:87], s26 offen offset:2048
buffer_load_dwordx4 v[32:35], v2, s[84:87], s48 offen
buffer_load_dwordx4 v[36:39], v2, s[84:87], s48 offen offset:2048
buffer_load_dwordx4 v[56:59], v2, s[84:87], s27 offen
buffer_load_dwordx4 v[60:63], v2, s[84:87], s27 offen offset:1024
buffer_load_dwordx4 v[64:67], v2, s[84:87], s27 offen offset:2048
buffer_load_dwordx4 v[68:71], v2, s[84:87], s27 offen offset:3072
buffer_load_dwordx4 v[72:75], v2, s[84:87], s49 offen
buffer_load_dwordx4 v[76:79], v2, s[84:87], s49 offen offset:1024
buffer_load_dwordx4 v[80:83], v2, s[84:87], s49 offen offset:2048
buffer_load_dwordx4 v[84:87], v2, s[84:87], s49 offen offset:3072
buffer_load_dwordx4 v[88:91], v2, s[84:87], s28 offen
buffer_load_dwordx4 v[92:95], v2, s[84:87], s28 offen offset:1024
buffer_load_dwordx4 v[96:99], v2, s[84:87], s28 offen offset:2048
buffer_load_dwordx4 v[100:103], v2, s[84:87], s28 offen offset:3072
L_x_satt:
s_lshl_b32 s40, s17, 3
s_add_u32 s40, s40, s47
s_lshl_b32 s40, s40, 18
s_add_u32 s40, s40, 50331648
s_lshl_b32 s20, s18, 13
s_add_u32 s40, s40, s20
v_mov_b32 v218, v20
v_mov_b32 v219, 0
s_lshr_b32 s20, s16, 1
s_lshl_b32 s21, s20, 12
s_add_u32 s40, s40, s21
s_lshl_b32 s20, s20, 10
s_add_u32 s28, s29, s20
s_add_u32 s28, s28, 2048
s_and_b32 s20, s16, 1
s_lshl_b32 s20, s20, 8
s_add_u32 s40, s40, s20
s_mov_b32 s8, 1
s_waitcnt vmcnt(0)
v_mfma_f32_16x16x32_bf16 v[200:203], v[56:59], v[24:27], 0
v_mfma_f32_16x16x32_bf16 v[204:207], v[60:63], v[24:27], 0
v_mfma_f32_16x16x32_bf16 v[200:203], v[64:67], v[28:31], v[200:203]
v_mfma_f32_16x16x32_bf16 v[204:207], v[68:71], v[28:31], v[204:207]
v_mfma_f32_16x16x32_bf16 v[200:203], v[72:75], v[32:35], v[200:203]
v_mfma_f32_16x16x32_bf16 v[204:207], v[76:79], v[32:35], v[204:207]
v_mfma_f32_16x16x32_bf16 v[200:203], v[80:83], v[36:39], v[200:203]
v_mfma_f32_16x16x32_bf16 v[204:207], v[84:87], v[36:39], v[204:207]
s_nop 5
v_cmp_gt_i32 vcc, 0, v9
s_nop 1
v_cndmask_b32 v200, v200, v11, vcc
v_cmp_gt_i32 vcc, 1, v9
s_nop 1
v_cndmask_b32 v201, v201, v11, vcc
v_cmp_gt_i32 vcc, 2, v9
s_nop 1
v_cndmask_b32 v202, v202, v11, vcc
v_cmp_gt_i32 vcc, 3, v9
s_nop 1
v_cndmask_b32 v203, v203, v11, vcc
v_cmp_gt_i32 vcc, 0, v10
s_nop 1
v_cndmask_b32 v204, v204, v11, vcc
v_cmp_gt_i32 vcc, 1, v10
s_nop 1
v_cndmask_b32 v205, v205, v11, vcc
v_cmp_gt_i32 vcc, 2, v10
s_nop 1
v_cndmask_b32 v206, v206, v11, vcc
v_cmp_gt_i32 vcc, 3, v10
s_nop 1
v_cndmask_b32 v207, v207, v11, vcc
s_cmp_ge_u32 s22, 63
s_cbranch_scc1 L_x_dx
L_x_rp:
buffer_load_dword v3, v13, s[84:87], 0 offen sc1
s_waitcnt vmcnt(0)
v_cmp_ge_u32 vcc, s22, v3
s_cbranch_vccz L_x_rk
s_sleep 2
s_branch L_x_rp
L_x_rk:
buffer_load_dwordx4 v[120:123], v6, s[84:87], s29 offen sc1
buffer_load_dwordx4 v[124:127], v6, s[84:87], s29 offen offset:64 sc1
buffer_load_dwordx4 v[128:131], v6, s[84:87], s29 offen offset:128 sc1
buffer_load_dwordx4 v[132:135], v6, s[84:87], s29 offen offset:192 sc1
buffer_load_dwordx2 v[136:137], v7, s[84:87], s28 offen sc1
buffer_load_dwordx2 v[138:139], v7, s[84:87], s28 offen offset:2048 sc1
buffer_load_dwordx2 v[140:141], v7, s[84:87], s28 offen offset:512 sc1
buffer_load_dwordx2 v[142:143], v7, s[84:87], s28 offen offset:2560 sc1
L_x_rd:
s_waitcnt vmcnt(7)
v_mfma_f32_16x16x32_bf16 v[208:211], v[120:123], v[24:27], 0
s_waitcnt vmcnt(6)
v_mfma_f32_16x16x32_bf16 v[208:211], v[124:127], v[28:31], v[208:211]
s_waitcnt vmcnt(5)
v_mfma_f32_16x16x32_bf16 v[208:211], v[128:131], v[32:35], v[208:211]
s_waitcnt vmcnt(4)
v_mfma_f32_16x16x32_bf16 v[208:211], v[132:135], v[36:39], v[208:211]
s_waitcnt vmcnt(0)
v_swap_b32 v137, v138
v_swap_b32 v141, v142
s_nop 1
v_max3_f32 v4, v200, v201, v202
v_max3_f32 v4, v4, v203, v204
v_max3_f32 v4, v4, v205, v206
v_max3_f32 v4, v4, v207, v208
v_max_f32 v3, v4, v209
v_max_f32 v4, v4, v209
s_nop 1
v_permlane16_swap_b32 v4, v3
v_max_f32 v4, v4, v3
v_max_f32 v3, v4, v3
s_nop 1
v_permlane32_swap_b32 v4, v3
v_max_f32 v4, v4, v3
v_mul_f32 v4, s24, v4
v_fma_f32 v200, v200, s24, -v4
v_fma_f32 v201, v201, s24, -v4
v_fma_f32 v202, v202, s24, -v4
v_fma_f32 v203, v203, s24, -v4
v_fma_f32 v204, v204, s24, -v4
v_fma_f32 v205, v205, s24, -v4
v_fma_f32 v206, v206, s24, -v4
v_fma_f32 v207, v207, s24, -v4
v_fma_f32 v208, v208, s24, -v4
v_fma_f32 v209, v209, s24, -v4
v_exp_f32 v200, v200
v_exp_f32 v201, v201
v_exp_f32 v202, v202
v_exp_f32 v203, v203
v_exp_f32 v204, v204
v_exp_f32 v205, v205
v_exp_f32 v206, v206
v_exp_f32 v207, v207
v_exp_f32 v208, v208
v_exp_f32 v209, v209
s_nop 0
v_cvt_pk_bf16_f32 v212, v200, v201
v_cvt_pk_bf16_f32 v213, v202, v203
v_cvt_pk_bf16_f32 v214, v204, v205
v_cvt_pk_bf16_f32 v215, v206, v207
v_cvt_pk_bf16_f32 v216, v208, v209
v_cvt_pk_bf16_f32 v217, v208, v209
v_mfma_f32_16x16x32_bf16 v[220:223], v[20:23], v[212:215], 0
v_mfma_f32_16x16x32_bf16 v[152:155], v[88:91], v[212:215], 0
v_mfma_f32_16x16x32_bf16 v[156:159], v[92:95], v[212:215], 0
v_mfma_f32_16x16x32_bf16 v[160:163], v[96:99], v[212:215], 0
v_mfma_f32_16x16x32_bf16 v[164:167], v[100:103], v[212:215], 0
s_nop 1
v_mfma_f32_16x16x16_bf16 v[220:223], v[218:219], v[216:217], v[220:223]
v_mfma_f32_16x16x16_bf16 v[152:155], v[136:137], v[216:217], v[152:155]
v_mfma_f32_16x16x16_bf16 v[156:159], v[138:139], v[216:217], v[156:159]
v_mfma_f32_16x16x16_bf16 v[160:163], v[140:141], v[216:217], v[160:163]
v_mfma_f32_16x16x16_bf16 v[164:167], v[142:143], v[216:217], v[164:167]
s_nop 3
v_rcp_f32 v220, v220
s_nop 1
v_pk_mul_f32 v[152:153], v[152:153], v[220:221] op_sel_hi:[1,0]
v_pk_mul_f32 v[154:155], v[154:155], v[220:221] op_sel_hi:[1,0]
v_pk_mul_f32 v[156:157], v[156:157], v[220:221] op_sel_hi:[1,0]
v_pk_mul_f32 v[158:159], v[158:159], v[220:221] op_sel_hi:[1,0]
v_pk_mul_f32 v[160:161], v[160:161], v[220:221] op_sel_hi:[1,0]
v_pk_mul_f32 v[162:163], v[162:163], v[220:221] op_sel_hi:[1,0]
v_pk_mul_f32 v[164:165], v[164:165], v[220:221] op_sel_hi:[1,0]
v_pk_mul_f32 v[166:167], v[166:167], v[220:221] op_sel_hi:[1,0]
v_cvt_pk_bf16_f32 v184, v152, v153
v_cvt_pk_bf16_f32 v185, v154, v155
v_cvt_pk_bf16_f32 v186, v156, v157
v_cvt_pk_bf16_f32 v187, v158, v159
v_cvt_pk_bf16_f32 v188, v160, v161
v_cvt_pk_bf16_f32 v189, v162, v163
v_cvt_pk_bf16_f32 v190, v164, v165
v_cvt_pk_bf16_f32 v191, v166, v167
s_cmp_eq_u32 s96, 1
s_cbranch_scc1 L_x_st_11f
buffer_store_dwordx4 v[184:187], v8, s[84:87], s40 offen sc1
buffer_store_dwordx4 v[188:191], v8, s[84:87], s40 offen offset:2048 sc1
s_branch L_x_st_11d
L_x_st_11f:
buffer_store_dwordx4 v[184:187], v8, s[84:87], s40 offen
buffer_store_dwordx4 v[188:191], v8, s[84:87], s40 offen offset:2048
L_x_st_11d:
L_x_pub:
s_add_u32 s45, s22, s8
v_mov_b32 v4, s45
s_waitcnt vmcnt(0)
s_barrier
s_cmp_eq_u32 s96, 1
s_cbranch_scc1 L_x_st_12f
buffer_store_dword v4, v15, s[84:87], 0 offen sc1
s_branch L_x_st_12d
L_x_st_12f:
buffer_store_dword v4, v15, s[84:87], 0 offen
L_x_st_12d:
s_lshl_b32 s41, s17, 3
s_add_u32 s41, s41, s47
s_lshl_b32 s41, s41, 3
s_and_b32 s20, s18, 1
s_lshl_b32 s20, s20, 2
s_add_u32 s41, s41, s20
s_add_u32 s41, s41, s16
s_lshl_b32 s41, s41, 15
s_add_u32 s41, s41, 50331648
s_lshl_b32 s10, s92, 3
s_add_u32 s10, s10, s47
s_lshl_b32 s10, s10, 12
s_add_u32 s10, s10, 75497472
s_xor_b32 s9, s10, 32768
s_lshl_b32 s42, s22, 17
s_xor_b32 s47, s47, 4
s_bitset0_b64 s[60:61], s22
s_ff1_i32_b64 s22, s[60:61]
s_min_u32 s22, s22, 64
s_add_u32 s43, s22, s16
s_lshl_b32 s26, s43, 18
s_lshl_b32 s20, s18, 13
s_add_u32 s26, s26, s20
s_lshr_b32 s20, s43, 1
s_add_u32 s20, s20, 32
v_mov_b32 v250, s43
v_mov_b32 v3, s20
s_mov_b32 vcc_lo, 0xcccccccc
s_mov_b32 vcc_hi, 0xcccccccc
v_cndmask_b32 v250, v250, v3, vcc
s_cmp_ge_u32 s22, 64
s_cbranch_scc1 L_x_xp
buffer_load_dword v5, v249, s[84:87], 0 offen sc1
buffer_load_dword v4, v12, s[84:87], 0 offen sc1
L_x_xp:
buffer_load_dword v3, v14, s[84:87], 0 offen sc1
s_waitcnt vmcnt(0)
v_cmp_gt_u32 vcc, s45, v3
s_cbranch_vccnz L_x_xp
v_cmp_ne_u32 vcc, 64, v4
s_and_b32 vcc_lo, vcc_lo, 0xc
s_cselect_b32 s51, s51, 1
v_cmp_ge_u32 vcc, v250, v5
s_cmp_eq_u64 vcc, 0
s_cselect_b32 s46, 1, 0
s_cmp_lt_u32 s22, 56
s_cselect_b32 s46, s46, 0
s_cmp_eq_u32 s46, 1
s_cselect_b32 s26, s26, 0x80000000
s_cmp_eq_u32 s8, 1
s_cbranch_scc1 L_x_f1
s_add_u32 s20, s50, 0
s_and_b32 s20, s20, 0x7fff
s_add_u32 s20, s20, s41
buffer_load_dwordx4 v[152:155], v2, s[84:87], s20 offen sc1
buffer_load_dwordx4 v[156:159], v2, s[84:87], s20 offen offset:1024 sc1
buffer_load_dwordx4 v[160:163], v2, s[84:87], s20 offen offset:2048 sc1
buffer_load_dwordx4 v[164:167], v2, s[84:87], s20 offen offset:3072 sc1
s_add_u32 s20, s50, 4096
s_and_b32 s20, s20, 0x7fff
s_add_u32 s20, s20, s41
buffer_load_dwordx4 v[168:171], v2, s[84:87], s20 offen sc1
buffer_load_dwordx4 v[172:175], v2, s[84:87], s20 offen offset:1024 sc1
buffer_load_dwordx4 v[176:179], v2, s[84:87], s20 offen offset:2048 sc1
buffer_load_dwordx4 v[180:183], v2, s[84:87], s20 offen offset:3072 sc1
s_add_u32 s20, s50, 8192
s_and_b32 s20, s20, 0x7fff
s_add_u32 s20, s20, s41
buffer_load_dwordx4 v[184:187], v2, s[84:87], s20 offen sc1
buffer_load_dwordx4 v[188:191], v2, s[84:87], s20 offen offset:1024 sc1
s_waitcnt vmcnt(9)
v_mfma_f32_32x32x16_bf16 v[200:215], a[0:3], v[152:155], 0
v_mfma_f32_32x32x16_bf16 v[216:231], a[4:7], v[152:155], 0
buffer_load_dwordx4 v[192:195], v2, s[84:87], s20 offen offset:2048 sc1
s_waitcnt vmcnt(9)
v_mfma_f32_32x32x16_bf16 v[200:215], a[8:11], v[156:159], v[200:215]
v_mfma_f32_32x32x16_bf16 v[216:231], a[12:15], v[156:159], v[216:231]
buffer_load_dwordx4 v[196:199], v2, s[84:87], s20 offen offset:3072 sc1
s_add_u32 s21, s26, 0
buffer_load_dwordx4 v[24:27], v2, s[84:87], s21 offen
s_waitcnt vmcnt(10)
v_mfma_f32_32x32x16_bf16 v[200:215], a[16:19], v[160:163], v[200:215]
v_mfma_f32_32x32x16_bf16 v[216:231], a[20:23], v[160:163], v[216:231]
s_add_u32 s20, s50, 12288
s_and_b32 s20, s20, 0x7fff
s_add_u32 s20, s20, s41
buffer_load_dwordx4 v[152:155], v2, s[84:87], s20 offen sc1
s_waitcnt vmcnt(10)
v_mfma_f32_32x32x16_bf16 v[200:215], a[24:27], v[164:167], v[200:215]
v_mfma_f32_32x32x16_bf16 v[216:231], a[28:31], v[164:167], v[216:231]
buffer_load_dwordx4 v[156:159], v2, s[84:87], s20 offen offset:1024 sc1
s_waitcnt vmcnt(10)
v_mfma_f32_32x32x16_bf16 v[200:215], a[32:35], v[168:171], v[200:215]
v_mfma_f32_32x32x16_bf16 v[216:231], a[36:39], v[168:171], v[216:231]
buffer_load_dwordx4 v[160:163], v2, s[84:87], s20 offen offset:2048 sc1
buffer_load_dwordx4 v[28:31], v2, s[84:87], s21 offen offset:1024
s_waitcnt vmcnt(11)
v_mfma_f32_32x32x16_bf16 v[200:215], a[40:43], v[172:175], v[200:215]
v_mfma_f32_32x32x16_bf16 v[216:231], a[44:47], v[172:175], v[216:231]
buffer_load_dwordx4 v[164:167], v2, s[84:87], s20 offen offset:3072 sc1
s_waitcnt vmcnt(11)
v_mfma_f32_32x32x16_bf16 v[200:215], a[48:51], v[176:179], v[200:215]
v_mfma_f32_32x32x16_bf16 v[216:231], a[52:55], v[176:179], v[216:231]
s_add_u32 s20, s50, 16384
s_and_b32 s20, s20, 0x7fff
s_add_u32 s20, s20, s41
buffer_load_dwordx4 v[168:171], v2, s[84:87], s20 offen sc1
s_waitcnt vmcnt(11)
v_mfma_f32_32x32x16_bf16 v[200:215], a[56:59], v[180:183], v[200:215]
v_mfma_f32_32x32x16_bf16 v[216:231], a[60:63], v[180:183], v[216:231]
buffer_load_dwordx4 v[172:175], v2, s[84:87], s20 offen offset:1024 sc1
buffer_load_dwordx4 v[32:35], v2, s[84:87], s21 offen offset:2048
s_waitcnt vmcnt(12)
v_mfma_f32_32x32x16_bf16 v[200:215], a[64:67], v[184:187], v[200:215]
v_mfma_f32_32x32x16_bf16 v[216:231], a[68:71], v[184:187], v[216:231]
buffer_load_dwordx4 v[176:179], v2, s[84:87], s20 offen offset:2048 sc1
s_waitcnt vmcnt(12)
v_mfma_f32_32x32x16_bf16 v[200:215], a[72:75], v[188:191], v[200:215]
v_mfma_f32_32x32x16_bf16 v[216:231], a[76:79], v[188:191], v[216:231]
buffer_load_dwordx4 v[180:183], v2, s[84:87], s20 offen offset:3072 sc1
s_waitcnt vmcnt(12)
v_mfma_f32_32x32x16_bf16 v[200:215], a[80:83], v[192:195], v[200:215]
v_mfma_f32_32x32x16_bf16 v[216:231], a[84:87], v[192:195], v[216:231]
s_add_u32 s20, s50, 20480
s_and_b32 s20, s20, 0x7fff
s_add_u32 s20, s20, s41
buffer_load_dwordx4 v[184:187], v2, s[84:87], s20 offen sc1
buffer_load_dwordx4 v[36:39], v2, s[84:87], s21 offen offset:3072
s_waitcnt vmcnt(13)
v_mfma_f32_32x32x16_bf16 v[200:215], a[88:91], v[196:199], v[200:215]
v_mfma_f32_32x32x16_bf16 v[216:231], a[92:95], v[196:199], v[216:231]
buffer_load_dwordx4 v[188:191], v2, s[84:87], s20 offen offset:1024 sc1
s_waitcnt vmcnt(12)
v_mfma_f32_32x32x16_bf16 v[200:215], a[96:99], v[152:155], v[200:215]
v_mfma_f32_32x32x16_bf16 v[216:231], a[100:103], v[152:155], v[216:231]
buffer_load_dwordx4 v[192:195], v2, s[84:87], s20 offen offset:2048 sc1
s_waitcnt vmcnt(12)
v_mfma_f32_32x32x16_bf16 v[200:215], a[104:107], v[156:159], v[200:215]
v_mfma_f32_32x32x16_bf16 v[216:231], a[108:111], v[156:159], v[216:231]
buffer_load_dwordx4 v[196:199], v2, s[84:87], s20 offen offset:3072 sc1
s_add_u32 s21, s26, 4096
buffer_load_dwordx4 v[40:43], v2, s[84:87], s21 offen
s_waitcnt vmcnt(13)
v_mfma_f32_32x32x16_bf16 v[200:215], a[112:115], v[160:163], v[200:215]
v_mfma_f32_32x32x16_bf16 v[216:231], a[116:119], v[160:163], v[216:231]
s_add_u32 s20, s50, 24576
s_and_b32 s20, s20, 0x7fff
s_add_u32 s20, s20, s41
buffer_load_dwordx4 v[152:155], v2, s[84:87], s20 offen sc1
s_waitcnt vmcnt(12)
v_mfma_f32_32x32x16_bf16 v[200:215], a[120:123], v[164:167], v[200:215]
v_mfma_f32_32x32x16_bf16 v[216:231], a[124:127], v[164:167], v[216:231]
buffer_load_dwordx4 v[156:159], v2, s[84:87], s20 offen offset:1024 sc1
s_waitcnt vmcnt(12)
v_mfma_f32_32x32x16_bf16 v[200:215], a[128:131], v[168:171], v[200:215]
v_mfma_f32_32x32x16_bf16 v[216:231], a[132:135], v[168:171], v[216:231]
buffer_load_dwordx4 v[160:163], v2, s[84:87], s20 offen offset:2048 sc1
buffer_load_dwordx4 v[44:47], v2, s[84:87], s21 offen offset:1024
s_waitcnt vmcnt(13)
v_mfma_f32_32x32x16_bf16 v[200:215], a[136:139], v[172:175], v[200:215]
v_mfma_f32_32x32x16_bf16 v[216:231], a[140:143], v[172:175], v[216:231]
buffer_load_dwordx4 v[164:167], v2, s[84:87], s20 offen offset:3072 sc1
s_waitcnt vmcnt(12)
v_mfma_f32_32x32x16_bf16 v[200:215], a[144:147], v[176:179], v[200:215]
v_mfma_f32_32x32x16_bf16 v[216:231], a[148:151], v[176:179], v[216:231]
s_add_u32 s20, s50, 28672
s_and_b32 s20, s20, 0x7fff
s_add_u32 s20, s20, s41
buffer_load_dwordx4 v[168:171], v2, s[84:87], s20 offen sc1
s_waitcnt vmcnt(12)
v_mfma_f32_32x32x16_bf16 v[200:215], a[152:155], v[180:183], v[200:215]
v_mfma_f32_32x32x16_bf16 v[216:231], a[156:159], v[180:183], v[216:231]
buffer_load_dwordx4 v[172:175], v2, s[84:87], s20 offen offset:1024 sc1
buffer_load_dwordx4 v[48:51], v2, s[84:87], s21 offen offset:2048
s_waitcnt vmcnt(13)
v_mfma_f32_32x32x16_bf16 v[200:215], a[160:163], v[184:187], v[200:215]
v_mfma_f32_32x32x16_bf16 v[216:231], a[164:167], v[184:187], v[216:231]
buffer_load_dwordx4 v[176:179], v2, s[84:87], s20 offen offset:2048 sc1
s_waitcnt vmcnt(12)
v_mfma_f32_32x32x16_bf16 v[200:215], a[168:171], v[188:191], v[200:215]
v_mfma_f32_32x32x16_bf16 v[216:231], a[172:175], v[188:191], v[216:231]
buffer_load_dwordx4 v[180:183], v2, s[84:87], s20 offen offset:3072 sc1
s_waitcnt vmcnt(12)
v_mfma_f32_32x32x16_bf16 v[200:215], a[176:179], v[192:195], v[200:215]
v_mfma_f32_32x32x16_bf16 v[216:231], a[180:183], v[192:195], v[216:231]
s_add_u32 s41, s41, 262144
s_add_u32 s20, s50, 0
s_and_b32 s20, s20, 0x7fff
s_add_u32 s20, s20, s41
buffer_load_dwordx4 v[184:187], v2, s[84:87], s20 offen sc1
buffer_load_dwordx4 v[52:55], v2, s[84:87], s21 offen offset:3072
s_waitcnt vmcnt(13)
v_mfma_f32_32x32x16_bf16 v[200:215], a[184:187], v[196:199], v[200:215]
v_mfma_f32_32x32x16_bf16 v[216:231], a[188:191], v[196:199], v[216:231]
buffer_load_dwordx4 v[188:191], v2, s[84:87], s20 offen offset:1024 sc1
s_waitcnt vmcnt(12)
v_mfma_f32_32x32x16_bf16 v[200:215], a[192:195], v[152:155], v[200:215]
v_mfma_f32_32x32x16_bf16 v[216:231], a[196:199], v[152:155], v[216:231]
buffer_load_dwordx4 v[192:195], v2, s[84:87], s20 offen offset:2048 sc1
s_waitcnt vmcnt(12)
v_mfma_f32_32x32x16_bf16 v[200:215], a[200:203], v[156:159], v[200:215]
v_mfma_f32_32x32x16_bf16 v[216:231], a[204:207], v[156:159], v[216:231]
buffer_load_dwordx4 v[196:199], v2, s[84:87], s20 offen offset:3072 sc1
s_add_u32 s21, s26, 16777216
buffer_load_dwordx4 v[56:59], v2, s[84:87], s21 offen
s_waitcnt vmcnt(13)
v_mfma_f32_32x32x16_bf16 v[200:215], a[208:211], v[160:163], v[200:215]
v_mfma_f32_32x32x16_bf16 v[216:231], a[212:215], v[160:163], v[216:231]
s_add_u32 s20, s50, 4096
s_and_b32 s20, s20, 0x7fff
s_add_u32 s20, s20, s41
buffer_load_dwordx4 v[152:155], v2, s[84:87], s20 offen sc1
s_waitcnt vmcnt(12)
v_mfma_f32_32x32x16_bf16 v[200:215], a[216:219], v[164:167], v[200:215]
v_mfma_f32_32x32x16_bf16 v[216:231], a[220:223], v[164:167], v[216:231]
buffer_load_dwordx4 v[156:159], v2, s[84:87], s20 offen offset:1024 sc1
s_waitcnt vmcnt(12)
v_mfma_f32_32x32x16_bf16 v[200:215], a[224:227], v[168:171], v[200:215]
v_mfma_f32_32x32x16_bf16 v[216:231], a[228:231], v[168:171], v[216:231]
buffer_load_dwordx4 v[160:163], v2, s[84:87], s20 offen offset:2048 sc1
buffer_load_dwordx4 v[60:63], v2, s[84:87], s21 offen offset:1024
s_waitcnt vmcnt(13)
v_mfma_f32_32x32x16_bf16 v[200:215], a[232:235], v[172:175], v[200:215]
v_mfma_f32_32x32x16_bf16 v[216:231], a[236:239], v[172:175], v[216:231]
buffer_load_dwordx4 v[164:167], v2, s[84:87], s20 offen offset:3072 sc1
s_waitcnt vmcnt(12)
v_mfma_f32_32x32x16_bf16 v[200:215], a[240:243], v[176:179], v[200:215]
v_mfma_f32_32x32x16_bf16 v[216:231], a[244:247], v[176:179], v[216:231]
s_add_u32 s20, s50, 8192
s_and_b32 s20, s20, 0x7fff
s_add_u32 s20, s20, s41
buffer_load_dwordx4 v[168:171], v2, s[84:87], s20 offen sc1
s_waitcnt vmcnt(12)
v_mfma_f32_32x32x16_bf16 v[200:215], a[248:251], v[180:183], v[200:215]
v_mfma_f32_32x32x16_bf16 v[216:231], a[252:255], v[180:183], v[216:231]
buffer_load_dwordx4 v[172:175], v2, s[84:87], s20 offen offset:1024 sc1
buffer_load_dwordx4 v[64:67], v2, s[84:87], s21 offen offset:2048
s_nop 11
ds_write_b128 v17, v[200:203]
ds_write_b128 v17, v[204:207] offset:1088
ds_write_b128 v17, v[208:211] offset:2176
ds_write_b128 v17, v[212:215] offset:3264
ds_write_b128 v17, v[216:219] offset:4352
ds_write_b128 v17, v[220:223] offset:5440
ds_write_b128 v17, v[224:227] offset:6528
ds_write_b128 v17, v[228:231] offset:7616
s_waitcnt vmcnt(13)
s_waitcnt lgkmcnt(0)
v_mfma_f32_32x32x16_bf16 v[200:215], a[0:3], v[184:187], 0
v_mfma_f32_32x32x16_bf16 v[216:231], a[4:7], v[184:187], 0
buffer_load_dwordx4 v[176:179], v2, s[84:87], s20 offen offset:2048 sc1
s_waitcnt vmcnt(12)
v_mfma_f32_32x32x16_bf16 v[200:215], a[8:11], v[188:191], v[200:215]
v_mfma_f32_32x32x16_bf16 v[216:231], a[12:15], v[188:191], v[216:231]
buffer_load_dwordx4 v[180:183], v2, s[84:87], s20 offen offset:3072 sc1
s_waitcnt vmcnt(12)
v_mfma_f32_32x32x16_bf16 v[200:215], a[16:19], v[192:195], v[200:215]
v_mfma_f32_32x32x16_bf16 v[216:231], a[20:23], v[192:195], v[216:231]
s_add_u32 s20, s50, 12288
s_and_b32 s20, s20, 0x7fff
s_add_u32 s20, s20, s41
buffer_load_dwordx4 v[184:187], v2, s[84:87], s20 offen sc1
buffer_load_dwordx4 v[68:71], v2, s[84:87], s21 offen offset:3072
s_waitcnt vmcnt(13)
v_mfma_f32_32x32x16_bf16 v[200:215], a[24:27], v[196:199], v[200:215]
v_mfma_f32_32x32x16_bf16 v[216:231], a[28:31], v[196:199], v[216:231]
buffer_load_dwordx4 v[188:191], v2, s[84:87], s20 offen offset:1024 sc1
s_waitcnt vmcnt(12)
v_mfma_f32_32x32x16_bf16 v[200:215], a[32:35], v[152:155], v[200:215]
v_mfma_f32_32x32x16_bf16 v[216:231], a[36:39], v[152:155], v[216:231]
buffer_load_dwordx4 v[192:195], v2, s[84:87], s20 offen offset:2048 sc1
s_waitcnt vmcnt(12)
v_mfma_f32_32x32x16_bf16 v[200:215], a[40:43], v[156:159], v[200:215]
v_mfma_f32_32x32x16_bf16 v[216:231], a[44:47], v[156:159], v[216:231]
buffer_load_dwordx4 v[196:199], v2, s[84:87], s20 offen offset:3072 sc1
s_add_u32 s21, s26, 16781312
buffer_load_dwordx4 v[72:75], v2, s[84:87], s21 offen
s_waitcnt vmcnt(13)
v_mfma_f32_32x32x16_bf16 v[200:215], a[48:51], v[160:163], v[200:215]
v_mfma_f32_32x32x16_bf16 v[216:231], a[52:55], v[160:163], v[216:231]
s_add_u32 s20, s50, 16384
s_and_b32 s20, s20, 0x7fff
s_add_u32 s20, s20, s41
buffer_load_dwordx4 v[152:155], v2, s[84:87], s20 offen sc1
s_waitcnt vmcnt(12)
v_mfma_f32_32x32x16_bf16 v[200:215], a[56:59], v[164:167], v[200:215]
v_mfma_f32_32x32x16_bf16 v[216:231], a[60:63], v[164:167], v[216:231]
buffer_load_dwordx4 v[156:159], v2, s[84:87], s20 offen offset:1024 sc1
s_waitcnt vmcnt(12)
v_mfma_f32_32x32x16_bf16 v[200:215], a[64:67], v[168:171], v[200:215]
v_mfma_f32_32x32x16_bf16 v[216:231], a[68:71], v[168:171], v[216:231]
buffer_load_dwordx4 v[160:163], v2, s[84:87], s20 offen offset:2048 sc1
buffer_load_dwordx4 v[76:79], v2, s[84:87], s21 offen offset:1024
s_waitcnt vmcnt(13)
v_mfma_f32_32x32x16_bf16 v[200:215], a[72:75], v[172:175], v[200:215]
v_mfma_f32_32x32x16_bf16 v[216:231], a[76:79], v[172:175], v[216:231]
buffer_load_dwordx4 v[164:167], v2, s[84:87], s20 offen offset:3072 sc1
s_waitcnt vmcnt(12)
v_mfma_f32_32x32x16_bf16 v[200:215], a[80:83], v[176:179], v[200:215]
v_mfma_f32_32x32x16_bf16 v[216:231], a[84:87], v[176:179], v[216:231]
s_add_u32 s20, s50, 20480
s_and_b32 s20, s20, 0x7fff
s_add_u32 s20, s20, s41
buffer_load_dwordx4 v[168:171], v2, s[84:87], s20 offen sc1
s_waitcnt vmcnt(12)
v_mfma_f32_32x32x16_bf16 v[200:215], a[88:91], v[180:183], v[200:215]
v_mfma_f32_32x32x16_bf16 v[216:231], a[92:95], v[180:183], v[216:231]
buffer_load_dwordx4 v[172:175], v2, s[84:87], s20 offen offset:1024 sc1
buffer_load_dwordx4 v[80:83], v2, s[84:87], s21 offen offset:2048
s_waitcnt vmcnt(13)
v_mfma_f32_32x32x16_bf16 v[200:215], a[96:99], v[184:187], v[200:215]
v_mfma_f32_32x32x16_bf16 v[216:231], a[100:103], v[184:187], v[216:231]
buffer_load_dwordx4 v[176:179], v2, s[84:87], s20 offen offset:2048 sc1
s_waitcnt vmcnt(12)
v_mfma_f32_32x32x16_bf16 v[200:215], a[104:107], v[188:191], v[200:215]
v_mfma_f32_32x32x16_bf16 v[216:231], a[108:111], v[188:191], v[216:231]
buffer_load_dwordx4 v[180:183], v2, s[84:87], s20 offen offset:3072 sc1
s_waitcnt vmcnt(12)
v_mfma_f32_32x32x16_bf16 v[200:215], a[112:115], v[192:195], v[200:215]
v_mfma_f32_32x32x16_bf16 v[216:231], a[116:119], v[192:195], v[216:231]
s_add_u32 s20, s50, 24576
s_and_b32 s20, s20, 0x7fff
s_add_u32 s20, s20, s41
buffer_load_dwordx4 v[184:187], v2, s[84:87], s20 offen sc1
buffer_load_dwordx4 v[84:87], v2, s[84:87], s21 offen offset:3072
s_waitcnt vmcnt(13)
v_mfma_f32_32x32x16_bf16 v[200:215], a[120:123], v[196:199], v[200:215]
v_mfma_f32_32x32x16_bf16 v[216:231], a[124:127], v[196:199], v[216:231]
buffer_load_dwordx4 v[188:191], v2, s[84:87], s20 offen offset:1024 sc1
s_waitcnt vmcnt(12)
v_mfma_f32_32x32x16_bf16 v[200:215], a[128:131], v[152:155], v[200:215]
v_mfma_f32_32x32x16_bf16 v[216:231], a[132:135], v[152:155], v[216:231]
buffer_load_dwordx4 v[192:195], v2, s[84:87], s20 offen offset:2048 sc1
s_waitcnt vmcnt(12)
v_mfma_f32_32x32x16_bf16 v[200:215], a[136:139], v[156:159], v[200:215]
v_mfma_f32_32x32x16_bf16 v[216:231], a[140:143], v[156:159], v[216:231]
buffer_load_dwordx4 v[196:199], v2, s[84:87], s20 offen offset:3072 sc1
s_add_u32 s21, s26, 33554432
buffer_load_dwordx4 v[88:91], v2, s[84:87], s21 offen
s_waitcnt vmcnt(13)
v_mfma_f32_32x32x16_bf16 v[200:215], a[144:147], v[160:163], v[200:215]
v_mfma_f32_32x32x16_bf16 v[216:231], a[148:151], v[160:163], v[216:231]
s_add_u32 s20, s50, 28672
s_and_b32 s20, s20, 0x7fff
s_add_u32 s20, s20, s41
buffer_load_dwordx4 v[152:155], v2, s[84:87], s20 offen sc1
s_waitcnt vmcnt(12)
v_mfma_f32_32x32x16_bf16 v[200:215], a[152:155], v[164:167], v[200:215]
v_mfma_f32_32x32x16_bf16 v[216:231], a[156:159], v[164:167], v[216:231]
buffer_load_dwordx4 v[156:159], v2, s[84:87], s20 offen offset:1024 sc1
s_waitcnt vmcnt(12)
v_mfma_f32_32x32x16_bf16 v[200:215], a[160:163], v[168:171], v[200:215]
v_mfma_f32_32x32x16_bf16 v[216:231], a[164:167], v[168:171], v[216:231]
buffer_load_dwordx4 v[160:163], v2, s[84:87], s20 offen offset:2048 sc1
buffer_load_dwordx4 v[92:95], v2, s[84:87], s21 offen offset:1024
s_waitcnt vmcnt(13)
v_mfma_f32_32x32x16_bf16 v[200:215], a[168:171], v[172:175], v[200:215]
v_mfma_f32_32x32x16_bf16 v[216:231], a[172:175], v[172:175], v[216:231]
buffer_load_dwordx4 v[164:167], v2, s[84:87], s20 offen offset:3072 sc1
s_waitcnt vmcnt(12)
v_mfma_f32_32x32x16_bf16 v[200:215], a[176:179], v[176:179], v[200:215]
v_mfma_f32_32x32x16_bf16 v[216:231], a[180:183], v[176:179], v[216:231]
s_add_u32 s41, s41, 262144
s_add_u32 s20, s50, 0
s_and_b32 s20, s20, 0x7fff
s_add_u32 s20, s20, s41
buffer_load_dwordx4 v[168:171], v2, s[84:87], s20 offen sc1
s_waitcnt vmcnt(12)
v_mfma_f32_32x32x16_bf16 v[200:215], a[184:187], v[180:183], v[200:215]
v_mfma_f32_32x32x16_bf16 v[216:231], a[188:191], v[180:183], v[216:231]
buffer_load_dwordx4 v[172:175], v2, s[84:87], s20 offen offset:1024 sc1
buffer_load_dwordx4 v[96:99], v2, s[84:87], s21 offen offset:2048
s_waitcnt vmcnt(13)
v_mfma_f32_32x32x16_bf16 v[200:215], a[192:195], v[184:187], v[200:215]
v_mfma_f32_32x32x16_bf16 v[216:231], a[196:199], v[184:187], v[216:231]
buffer_load_dwordx4 v[176:179], v2, s[84:87], s20 offen offset:2048 sc1
s_waitcnt vmcnt(12)
v_mfma_f32_32x32x16_bf16 v[200:215], a[200:203], v[188:191], v[200:215]
v_mfma_f32_32x32x16_bf16 v[216:231], a[204:207], v[188:191], v[216:231]
buffer_load_dwordx4 v[180:183], v2, s[84:87], s20 offen offset:3072 sc1
s_waitcnt vmcnt(12)
v_mfma_f32_32x32x16_bf16 v[200:215], a[208:211], v[192:195], v[200:215]
v_mfma_f32_32x32x16_bf16 v[216:231], a[212:215], v[192:195], v[216:231]
s_add_u32 s20, s50, 4096
s_and_b32 s20, s20, 0x7fff
s_add_u32 s20, s20, s41
buffer_load_dwordx4 v[184:187], v2, s[84:87], s20 offen sc1
buffer_load_dwordx4 v[100:103], v2, s[84:87], s21 offen offset:3072
s_waitcnt vmcnt(13)
v_mfma_f32_32x32x16_bf16 v[200:215], a[216:219], v[196:199], v[200:215]
v_mfma_f32_32x32x16_bf16 v[216:231], a[220:223], v[196:199], v[216:231]
buffer_load_dwordx4 v[188:191], v2, s[84:87], s20 offen offset:1024 sc1
s_waitcnt vmcnt(12)
v_mfma_f32_32x32x16_bf16 v[200:215], a[224:227], v[152:155], v[200:215]
v_mfma_f32_32x32x16_bf16 v[216:231], a[228:231], v[152:155], v[216:231]
buffer_load_dwordx4 v[192:195], v2, s[84:87], s20 offen offset:2048 sc1
s_waitcnt vmcnt(12)
v_mfma_f32_32x32x16_bf16 v[200:215], a[232:235], v[156:159], v[200:215]
v_mfma_f32_32x32x16_bf16 v[216:231], a[236:239], v[156:159], v[216:231]
buffer_load_dwordx4 v[196:199], v2, s[84:87], s20 offen offset:3072 sc1
s_add_u32 s21, s26, 33558528
buffer_load_dwordx4 v[104:107], v2, s[84:87], s21 offen
s_waitcnt vmcnt(13)
v_mfma_f32_32x32x16_bf16 v[200:215], a[240:243], v[160:163], v[200:215]
v_mfma_f32_32x32x16_bf16 v[216:231], a[244:247], v[160:163], v[216:231]
s_add_u32 s20, s50, 8192
s_and_b32 s20, s20, 0x7fff
s_add_u32 s20, s20, s41
buffer_load_dwordx4 v[152:155], v2, s[84:87], s20 offen sc1
s_waitcnt vmcnt(12)
v_mfma_f32_32x32x16_bf16 v[200:215], a[248:251], v[164:167], v[200:215]
v_mfma_f32_32x32x16_bf16 v[216:231], a[252:255], v[164:167], v[216:231]
buffer_load_dwordx4 v[156:159], v2, s[84:87], s20 offen offset:1024 sc1
s_nop 11
ds_write_b128 v17, v[200:203] offset:34816
ds_write_b128 v17, v[204:207] offset:35904
ds_write_b128 v17, v[208:211] offset:36992
ds_write_b128 v17, v[212:215] offset:38080
ds_write_b128 v17, v[216:219] offset:39168
ds_write_b128 v17, v[220:223] offset:40256
ds_write_b128 v17, v[224:227] offset:41344
ds_write_b128 v17, v[228:231] offset:42432
s_waitcnt vmcnt(12)
s_waitcnt lgkmcnt(0)
v_mfma_f32_32x32x16_bf16 v[200:215], a[0:3], v[168:171], 0
v_mfma_f32_32x32x16_bf16 v[216:231], a[4:7], v[168:171], 0
buffer_load_dwordx4 v[160:163], v2, s[84:87], s20 offen offset:2048 sc1
buffer_load_dwordx4 v[108:111], v2, s[84:87], s21 offen offset:1024
s_waitcnt vmcnt(13)
v_mfma_f32_32x32x16_bf16 v[200:215], a[8:11], v[172:175], v[200:215]
v_mfma_f32_32x32x16_bf16 v[216:231], a[12:15], v[172:175], v[216:231]
buffer_load_dwordx4 v[164:167], v2, s[84:87], s20 offen offset:3072 sc1
s_waitcnt vmcnt(12)
v_mfma_f32_32x32x16_bf16 v[200:215], a[16:19], v[176:179], v[200:215]
v_mfma_f32_32x32x16_bf16 v[216:231], a[20:23], v[176:179], v[216:231]
s_add_u32 s20, s50, 12288
s_and_b32 s20, s20, 0x7fff
s_add_u32 s20, s20, s41
buffer_load_dwordx4 v[168:171], v2, s[84:87], s20 offen sc1
s_waitcnt vmcnt(12)
v_mfma_f32_32x32x16_bf16 v[200:215], a[24:27], v[180:183], v[200:215]
v_mfma_f32_32x32x16_bf16 v[216:231], a[28:31], v[180:183], v[216:231]
buffer_load_dwordx4 v[172:175], v2, s[84:87], s20 offen offset:1024 sc1
buffer_load_dwordx4 v[112:115], v2, s[84:87], s21 offen offset:2048
s_waitcnt vmcnt(13)
v_mfma_f32_32x32x16_bf16 v[200:215], a[32:35], v[184:187], v[200:215]
v_mfma_f32_32x32x16_bf16 v[216:231], a[36:39], v[184:187], v[216:231]
buffer_load_dwordx4 v[176:179], v2, s[84:87], s20 offen offset:2048 sc1
s_waitcnt vmcnt(12)
v_mfma_f32_32x32x16_bf16 v[200:215], a[40:43], v[188:191], v[200:215]
v_mfma_f32_32x32x16_bf16 v[216:231], a[44:47], v[188:191], v[216:231]
buffer_load_dwordx4 v[180:183], v2, s[84:87], s20 offen offset:3072 sc1
s_waitcnt vmcnt(12)
v_mfma_f32_32x32x16_bf16 v[200:215], a[48:51], v[192:195], v[200:215]
v_mfma_f32_32x32x16_bf16 v[216:231], a[52:55], v[192:195], v[216:231]
s_add_u32 s20, s50, 16384
s_and_b32 s20, s20, 0x7fff
s_add_u32 s20, s20, s41
buffer_load_dwordx4 v[184:187], v2, s[84:87], s20 offen sc1
buffer_load_dwordx4 v[116:119], v2, s[84:87], s21 offen offset:3072
s_waitcnt vmcnt(13)
v_mfma_f32_32x32x16_bf16 v[200:215], a[56:59], v[196:199], v[200:215]
v_mfma_f32_32x32x16_bf16 v[216:231], a[60:63], v[196:199], v[216:231]
buffer_load_dwordx4 v[188:191], v2, s[84:87], s20 offen offset:1024 sc1
s_waitcnt vmcnt(12)
v_mfma_f32_32x32x16_bf16 v[200:215], a[64:67], v[152:155], v[200:215]
v_mfma_f32_32x32x16_bf16 v[216:231], a[68:71], v[152:155], v[216:231]
buffer_load_dwordx4 v[192:195], v2, s[84:87], s20 offen offset:2048 sc1
s_waitcnt vmcnt(12)
v_mfma_f32_32x32x16_bf16 v[200:215], a[72:75], v[156:159], v[200:215]
v_mfma_f32_32x32x16_bf16 v[216:231], a[76:79], v[156:159], v[216:231]
buffer_load_dwordx4 v[196:199], v2, s[84:87], s20 offen offset:3072 sc1
s_add_u32 s21, s26, 178257920
buffer_load_dwordx4 v[120:123], v6, s[84:87], s21 offen sc1
s_waitcnt vmcnt(13)
v_mfma_f32_32x32x16_bf16 v[200:215], a[80:83], v[160:163], v[200:215]
v_mfma_f32_32x32x16_bf16 v[216:231], a[84:87], v[160:163], v[216:231]
s_add_u32 s20, s50, 20480
s_and_b32 s20, s20, 0x7fff
s_add_u32 s20, s20, s41
buffer_load_dwordx4 v[152:155], v2, s[84:87], s20 offen sc1
s_waitcnt vmcnt(12)
v_mfma_f32_32x32x16_bf16 v[200:215], a[88:91], v[164:167], v[200:215]
v_mfma_f32_32x32x16_bf16 v[216:231], a[92:95], v[164:167], v[216:231]
buffer_load_dwordx4 v[156:159], v2, s[84:87], s20 offen offset:1024 sc1
s_waitcnt vmcnt(12)
v_mfma_f32_32x32x16_bf16 v[200:215], a[96:99], v[168:171], v[200:215]
v_mfma_f32_32x32x16_bf16 v[216:231], a[100:103], v[168:171], v[216:231]
buffer_load_dwordx4 v[160:163], v2, s[84:87], s20 offen offset:2048 sc1
buffer_load_dwordx4 v[124:127], v6, s[84:87], s21 offen offset:64 sc1
s_waitcnt vmcnt(13)
v_mfma_f32_32x32x16_bf16 v[200:215], a[104:107], v[172:175], v[200:215]
v_mfma_f32_32x32x16_bf16 v[216:231], a[108:111], v[172:175], v[216:231]
buffer_load_dwordx4 v[164:167], v2, s[84:87], s20 offen offset:3072 sc1
s_waitcnt vmcnt(12)
v_mfma_f32_32x32x16_bf16 v[200:215], a[112:115], v[176:179], v[200:215]
v_mfma_f32_32x32x16_bf16 v[216:231], a[116:119], v[176:179], v[216:231]
s_add_u32 s20, s50, 24576
s_and_b32 s20, s20, 0x7fff
s_add_u32 s20, s20, s41
buffer_load_dwordx4 v[168:171], v2, s[84:87], s20 offen sc1
s_waitcnt vmcnt(12)
v_mfma_f32_32x32x16_bf16 v[200:215], a[120:123], v[180:183], v[200:215]
v_mfma_f32_32x32x16_bf16 v[216:231], a[124:127], v[180:183], v[216:231]
buffer_load_dwordx4 v[172:175], v2, s[84:87], s20 offen offset:1024 sc1
buffer_load_dwordx4 v[128:131], v6, s[84:87], s21 offen offset:128 sc1
s_waitcnt vmcnt(13)
v_mfma_f32_32x32x16_bf16 v[200:215], a[128:131], v[184:187], v[200:215]
v_mfma_f32_32x32x16_bf16 v[216:231], a[132:135], v[184:187], v[216:231]
buffer_load_dwordx4 v[176:179], v2, s[84:87], s20 offen offset:2048 sc1
s_waitcnt vmcnt(12)
v_mfma_f32_32x32x16_bf16 v[200:215], a[136:139], v[188:191], v[200:215]
v_mfma_f32_32x32x16_bf16 v[216:231], a[140:143], v[188:191], v[216:231]
buffer_load_dwordx4 v[180:183], v2, s[84:87], s20 offen offset:3072 sc1
s_waitcnt vmcnt(12)
v_mfma_f32_32x32x16_bf16 v[200:215], a[144:147], v[192:195], v[200:215]
v_mfma_f32_32x32x16_bf16 v[216:231], a[148:151], v[192:195], v[216:231]
s_add_u32 s20, s50, 28672
s_and_b32 s20, s20, 0x7fff
s_add_u32 s20, s20, s41
buffer_load_dwordx4 v[184:187], v2, s[84:87], s20 offen sc1
buffer_load_dwordx4 v[132:135], v6, s[84:87], s21 offen offset:192 sc1
s_waitcnt vmcnt(13)
v_mfma_f32_32x32x16_bf16 v[200:215], a[152:155], v[196:199], v[200:215]
v_mfma_f32_32x32x16_bf16 v[216:231], a[156:159], v[196:199], v[216:231]
buffer_load_dwordx4 v[188:191], v2, s[84:87], s20 offen offset:1024 sc1
s_waitcnt vmcnt(12)
v_mfma_f32_32x32x16_bf16 v[200:215], a[160:163], v[152:155], v[200:215]
v_mfma_f32_32x32x16_bf16 v[216:231], a[164:167], v[152:155], v[216:231]
buffer_load_dwordx4 v[192:195], v2, s[84:87], s20 offen offset:2048 sc1
s_waitcnt vmcnt(12)
v_mfma_f32_32x32x16_bf16 v[200:215], a[168:171], v[156:159], v[200:215]
v_mfma_f32_32x32x16_bf16 v[216:231], a[172:175], v[156:159], v[216:231]
buffer_load_dwordx4 v[196:199], v2, s[84:87], s20 offen offset:3072 sc1
s_add_u32 s21, s26, 178259968
buffer_load_dwordx2 v[136:137], v7, s[84:87], s21 offen sc1
s_waitcnt vmcnt(13)
v_mfma_f32_32x32x16_bf16 v[200:215], a[176:179], v[160:163], v[200:215]
v_mfma_f32_32x32x16_bf16 v[216:231], a[180:183], v[160:163], v[216:231]
s_add_u32 s41, s41, 262144
s_add_u32 s20, s50, 0
s_and_b32 s20, s20, 0x7fff
s_add_u32 s20, s20, s41
buffer_load_dwordx4 v[152:155], v2, s[84:87], s20 offen sc1
s_waitcnt vmcnt(12)
v_mfma_f32_32x32x16_bf16 v[200:215], a[184:187], v[164:167], v[200:215]
v_mfma_f32_32x32x16_bf16 v[216:231], a[188:191], v[164:167], v[216:231]
buffer_load_dwordx4 v[156:159], v2, s[84:87], s20 offen offset:1024 sc1
s_waitcnt vmcnt(12)
v_mfma_f32_32x32x16_bf16 v[200:215], a[192:195], v[168:171], v[200:215]
v_mfma_f32_32x32x16_bf16 v[216:231], a[196:199], v[168:171], v[216:231]
buffer_load_dwordx4 v[160:163], v2, s[84:87], s20 offen offset:2048 sc1
buffer_load_dwordx2 v[138:139], v7, s[84:87], s21 offen offset:2048 sc1
s_waitcnt vmcnt(13)
v_mfma_f32_32x32x16_bf16 v[200:215], a[200:203], v[172:175], v[200:215]
v_mfma_f32_32x32x16_bf16 v[216:231], a[204:207], v[172:175], v[216:231]
buffer_load_dwordx4 v[164:167], v2, s[84:87], s20 offen offset:3072 sc1
s_waitcnt vmcnt(12)
v_mfma_f32_32x32x16_bf16 v[200:215], a[208:211], v[176:179], v[200:215]
v_mfma_f32_32x32x16_bf16 v[216:231], a[212:215], v[176:179], v[216:231]
s_add_u32 s20, s50, 4096
s_and_b32 s20, s20, 0x7fff
s_add_u32 s20, s20, s41
buffer_load_dwordx4 v[168:171], v2, s[84:87], s20 offen sc1
s_waitcnt vmcnt(12)
v_mfma_f32_32x32x16_bf16 v[200:215], a[216:219], v[180:183], v[200:215]
v_mfma_f32_32x32x16_bf16 v[216:231], a[220:223], v[180:183], v[216:231]
buffer_load_dwordx4 v[172:175], v2, s[84:87], s20 offen offset:1024 sc1
buffer_load_dwordx2 v[140:141], v7, s[84:87], s21 offen offset:512 sc1
s_waitcnt vmcnt(13)
v_mfma_f32_32x32x16_bf16 v[200:215], a[224:227], v[184:187], v[200:215]
v_mfma_f32_32x32x16_bf16 v[216:231], a[228:231], v[184:187], v[216:231]
buffer_load_dwordx4 v[176:179], v2, s[84:87], s20 offen offset:2048 sc1
s_waitcnt vmcnt(12)
v_mfma_f32_32x32x16_bf16 v[200:215], a[232:235], v[188:191], v[200:215]
v_mfma_f32_32x32x16_bf16 v[216:231], a[236:239], v[188:191], v[216:231]
buffer_load_dwordx4 v[180:183], v2, s[84:87], s20 offen offset:3072 sc1
s_waitcnt vmcnt(12)
v_mfma_f32_32x32x16_bf16 v[200:215], a[240:243], v[192:195], v[200:215]
v_mfma_f32_32x32x16_bf16 v[216:231], a[244:247], v[192:195], v[216:231]
s_add_u32 s20, s50, 8192
s_and_b32 s20, s20, 0x7fff
s_add_u32 s20, s20, s41
buffer_load_dwordx4 v[184:187], v2, s[84:87], s20 offen sc1
buffer_load_dwordx2 v[142:143], v7, s[84:87], s21 offen offset:2560 sc1
s_waitcnt vmcnt(13)
v_mfma_f32_32x32x16_bf16 v[200:215], a[248:251], v[196:199], v[200:215]
v_mfma_f32_32x32x16_bf16 v[216:231], a[252:255], v[196:199], v[216:231]
buffer_load_dwordx4 v[188:191], v2, s[84:87], s20 offen offset:1024 sc1
v_add_u32 v5, 69632, v17
s_nop 11
ds_write_b128 v5, v[200:203]
ds_write_b128 v5, v[204:207] offset:1088
ds_write_b128 v5, v[208:211] offset:2176
ds_write_b128 v5, v[212:215] offset:3264
ds_write_b128 v5, v[216:219] offset:4352
ds_write_b128 v5, v[220:223] offset:5440
ds_write_b128 v5, v[224:227] offset:6528
ds_write_b128 v5, v[228:231] offset:7616
s_waitcnt vmcnt(12)
s_waitcnt lgkmcnt(0)
v_mfma_f32_32x32x16_bf16 v[200:215], a[0:3], v[152:155], 0
v_mfma_f32_32x32x16_bf16 v[216:231], a[4:7], v[152:155], 0
buffer_load_dwordx4 v[192:195], v2, s[84:87], s20 offen offset:2048 sc1
s_waitcnt vmcnt(12)
v_mfma_f32_32x32x16_bf16 v[200:215], a[8:11], v[156:159], v[200:215]
v_mfma_f32_32x32x16_bf16 v[216:231], a[12:15], v[156:159], v[216:231]
buffer_load_dwordx4 v[196:199], v2, s[84:87], s20 offen offset:3072 sc1
buffer_load_dwordx2 v[144:145], v7, s[84:87], s21 offen offset:1024 sc1
s_waitcnt vmcnt(13)
v_mfma_f32_32x32x16_bf16 v[200:215], a[16:19], v[160:163], v[200:215]
v_mfma_f32_32x32x16_bf16 v[216:231], a[20:23], v[160:163], v[216:231]
s_add_u32 s20, s50, 12288
s_and_b32 s20, s20, 0x7fff
s_add_u32 s20, s20, s41
buffer_load_dwordx4 v[152:155], v2, s[84:87], s20 offen sc1
s_waitcnt vmcnt(12)
v_mfma_f32_32x32x16_bf16 v[200:215], a[24:27], v[164:167], v[200:215]
v_mfma_f32_32x32x16_bf16 v[216:231], a[28:31], v[164:167], v[216:231]
buffer_load_dwordx4 v[156:159], v2, s[84:87], s20 offen offset:1024 sc1
s_waitcnt vmcnt(12)
v_mfma_f32_32x32x16_bf16 v[200:215], a[32:35], v[168:171], v[200:215]
v_mfma_f32_32x32x16_bf16 v[216:231], a[36:39], v[168:171], v[216:231]
buffer_load_dwordx4 v[160:163], v2, s[84:87], s20 offen offset:2048 sc1
buffer_load_dwordx2 v[146:147], v7, s[84:87], s21 offen offset:3072 sc1
s_waitcnt vmcnt(13)
v_mfma_f32_32x32x16_bf16 v[200:215], a[40:43], v[172:175], v[200:215]
v_mfma_f32_32x32x16_bf16 v[216:231], a[44:47], v[172:175], v[216:231]
buffer_load_dwordx4 v[164:167], v2, s[84:87], s20 offen offset:3072 sc1
s_waitcnt vmcnt(12)
v_mfma_f32_32x32x16_bf16 v[200:215], a[48:51], v[176:179], v[200:215]
v_mfma_f32_32x32x16_bf16 v[216:231], a[52:55], v[176:179], v[216:231]
s_add_u32 s20, s50, 16384
s_and_b32 s20, s20, 0x7fff
s_add_u32 s20, s20, s41
buffer_load_dwordx4 v[168:171], v2, s[84:87], s20 offen sc1
s_waitcnt vmcnt(12)
v_mfma_f32_32x32x16_bf16 v[200:215], a[56:59], v[180:183], v[200:215]
v_mfma_f32_32x32x16_bf16 v[216:231], a[60:63], v[180:183], v[216:231]
buffer_load_dwordx4 v[172:175], v2, s[84:87], s20 offen offset:1024 sc1
buffer_load_dwordx2 v[148:149], v7, s[84:87], s21 offen offset:1536 sc1
s_waitcnt vmcnt(13)
v_mfma_f32_32x32x16_bf16 v[200:215], a[64:67], v[184:187], v[200:215]
v_mfma_f32_32x32x16_bf16 v[216:231], a[68:71], v[184:187], v[216:231]
buffer_load_dwordx4 v[176:179], v2, s[84:87], s20 offen offset:2048 sc1
s_waitcnt vmcnt(12)
v_mfma_f32_32x32x16_bf16 v[200:215], a[72:75], v[188:191], v[200:215]
v_mfma_f32_32x32x16_bf16 v[216:231], a[76:79], v[188:191], v[216:231]
buffer_load_dwordx4 v[180:183], v2, s[84:87], s20 offen offset:3072 sc1
s_waitcnt vmcnt(12)
v_mfma_f32_32x32x16_bf16 v[200:215], a[80:83], v[192:195], v[200:215]
v_mfma_f32_32x32x16_bf16 v[216:231], a[84:87], v[192:195], v[216:231]
s_add_u32 s20, s50, 20480
s_and_b32 s20, s20, 0x7fff
s_add_u32 s20, s20, s41
buffer_load_dwordx4 v[184:187], v2, s[84:87], s20 offen sc1
buffer_load_dwordx2 v[150:151], v7, s[84:87], s21 offen offset:3584 sc1
s_waitcnt vmcnt(13)
v_mfma_f32_32x32x16_bf16 v[200:215], a[88:91], v[196:199], v[200:215]
v_mfma_f32_32x32x16_bf16 v[216:231], a[92:95], v[196:199], v[216:231]
buffer_load_dwordx4 v[188:191], v2, s[84:87], s20 offen offset:1024 sc1
s_waitcnt vmcnt(12)
v_mfma_f32_32x32x16_bf16 v[200:215], a[96:99], v[152:155], v[200:215]
v_mfma_f32_32x32x16_bf16 v[216:231], a[100:103], v[152:155], v[216:231]
buffer_load_dwordx4 v[192:195], v2, s[84:87], s20 offen offset:2048 sc1
s_waitcnt vmcnt(12)
v_mfma_f32_32x32x16_bf16 v[200:215], a[104:107], v[156:159], v[200:215]
v_mfma_f32_32x32x16_bf16 v[216:231], a[108:111], v[156:159], v[216:231]
buffer_load_dwordx4 v[196:199], v2, s[84:87], s20 offen offset:3072 sc1
s_waitcnt vmcnt(12)
v_mfma_f32_32x32x16_bf16 v[200:215], a[112:115], v[160:163], v[200:215]
v_mfma_f32_32x32x16_bf16 v[216:231], a[116:119], v[160:163], v[216:231]
s_add_u32 s20, s50, 24576
s_and_b32 s20, s20, 0x7fff
s_add_u32 s20, s20, s41
buffer_load_dwordx4 v[152:155], v2, s[84:87], s20 offen sc1
s_waitcnt vmcnt(11)
v_mfma_f32_32x32x16_bf16 v[200:215], a[120:123], v[164:167], v[200:215]
v_mfma_f32_32x32x16_bf16 v[216:231], a[124:127], v[164:167], v[216:231]
buffer_load_dwordx4 v[156:159], v2, s[84:87], s20 offen offset:1024 sc1
s_waitcnt vmcnt(11)
v_mfma_f32_32x32x16_bf16 v[200:215], a[128:131], v[168:171], v[200:215]
v_mfma_f32_32x32x16_bf16 v[216:231], a[132:135], v[168:171], v[216:231]
buffer_load_dwordx4 v[160:163], v2, s[84:87], s20 offen offset:2048 sc1
s_waitcnt vmcnt(11)
v_mfma_f32_32x32x16_bf16 v[200:215], a[136:139], v[172:175], v[200:215]
v_mfma_f32_32x32x16_bf16 v[216:231], a[140:143], v[172:175], v[216:231]
buffer_load_dwordx4 v[164:167], v2, s[84:87], s20 offen offset:3072 sc1
s_waitcnt vmcnt(10)
v_mfma_f32_32x32x16_bf16 v[200:215], a[144:147], v[176:179], v[200:215]
v_mfma_f32_32x32x16_bf16 v[216:231], a[148:151], v[176:179], v[216:231]
s_add_u32 s20, s50, 28672
s_and_b32 s20, s20, 0x7fff
s_add_u32 s20, s20, s41
buffer_load_dwordx4 v[168:171], v2, s[84:87], s20 offen sc1
s_waitcnt vmcnt(10)
v_mfma_f32_32x32x16_bf16 v[200:215], a[152:155], v[180:183], v[200:215]
v_mfma_f32_32x32x16_bf16 v[216:231], a[156:159], v[180:183], v[216:231]
buffer_load_dwordx4 v[172:175], v2, s[84:87], s20 offen offset:1024 sc1
s_waitcnt vmcnt(10)
v_mfma_f32_32x32x16_bf16 v[200:215], a[160:163], v[184:187], v[200:215]
v_mfma_f32_32x32x16_bf16 v[216:231], a[164:167], v[184:187], v[216:231]
buffer_load_dwordx4 v[176:179], v2, s[84:87], s20 offen offset:2048 sc1
s_waitcnt vmcnt(9)
v_mfma_f32_32x32x16_bf16 v[200:215], a[168:171], v[188:191], v[200:215]
v_mfma_f32_32x32x16_bf16 v[216:231], a[172:175], v[188:191], v[216:231]
buffer_load_dwordx4 v[180:183], v2, s[84:87], s20 offen offset:3072 sc1
s_waitcnt vmcnt(9)
v_mfma_f32_32x32x16_bf16 v[200:215], a[176:179], v[192:195], v[200:215]
v_mfma_f32_32x32x16_bf16 v[216:231], a[180:183], v[192:195], v[216:231]
s_waitcnt vmcnt(8)
v_mfma_f32_32x32x16_bf16 v[200:215], a[184:187], v[196:199], v[200:215]
v_mfma_f32_32x32x16_bf16 v[216:231], a[188:191], v[196:199], v[216:231]
s_waitcnt vmcnt(7)
v_mfma_f32_32x32x16_bf16 v[200:215], a[192:195], v[152:155], v[200:215]
v_mfma_f32_32x32x16_bf16 v[216:231], a[196:199], v[152:155], v[216:231]
s_waitcnt vmcnt(6)
v_mfma_f32_32x32x16_bf16 v[200:215], a[200:203], v[156:159], v[200:215]
v_mfma_f32_32x32x16_bf16 v[216:231], a[204:207], v[156:159], v[216:231]
s_waitcnt vmcnt(5)
v_mfma_f32_32x32x16_bf16 v[200:215], a[208:211], v[160:163], v[200:215]
v_mfma_f32_32x32x16_bf16 v[216:231], a[212:215], v[160:163], v[216:231]
s_waitcnt vmcnt(4)
v_mfma_f32_32x32x16_bf16 v[200:215], a[216:219], v[164:167], v[200:215]
v_mfma_f32_32x32x16_bf16 v[216:231], a[220:223], v[164:167], v[216:231]
s_waitcnt vmcnt(3)
v_mfma_f32_32x32x16_bf16 v[200:215], a[224:227], v[168:171], v[200:215]
v_mfma_f32_32x32x16_bf16 v[216:231], a[228:231], v[168:171], v[216:231]
s_waitcnt vmcnt(2)
v_mfma_f32_32x32x16_bf16 v[200:215], a[232:235], v[172:175], v[200:215]
v_mfma_f32_32x32x16_bf16 v[216:231], a[236:239], v[172:175], v[216:231]
s_waitcnt vmcnt(1)
v_mfma_f32_32x32x16_bf16 v[200:215], a[240:243], v[176:179], v[200:215]
v_mfma_f32_32x32x16_bf16 v[216:231], a[244:247], v[176:179], v[216:231]
s_waitcnt vmcnt(0)
v_mfma_f32_32x32x16_bf16 v[200:215], a[248:251], v[180:183], v[200:215]
v_mfma_f32_32x32x16_bf16 v[216:231], a[252:255], v[180:183], v[216:231]
s_nop 11
ds_write_b128 v5, v[200:203] offset:34816
ds_write_b128 v5, v[204:207] offset:35904
ds_write_b128 v5, v[208:211] offset:36992
ds_write_b128 v5, v[212:215] offset:38080
ds_write_b128 v5, v[216:219] offset:39168
ds_write_b128 v5, v[220:223] offset:40256
ds_write_b128 v5, v[224:227] offset:41344
ds_write_b128 v5, v[228:231] offset:42432
s_sub_u32 s20, s22, 56
s_cmp_lt_u32 s20, 8
s_cselect_b32 s20, s51, 0
s_cmp_eq_u32 s20, 1
s_cbranch_scc0 L_x_sp_13
s_mov_b32 s46, 2
s_lshl_b32 s27, s22, 18
s_lshl_b32 s20, s18, 13
s_add_u32 s27, s27, s20
s_add_u32 s29, s27, 178257920
s_and_b32 s20, s16, 1
s_lshl_b32 s20, s20, 10
s_add_u32 s26, s27, s20
s_add_u32 s26, s26, 0
s_lshr_b32 s20, s16, 1
s_lshl_b32 s20, s20, 12
s_add_u32 s28, s27, s20
s_add_u32 s28, s28, 33554432
s_add_u32 s27, s27, 16777216
s_add_u32 s48, s26, 4096
s_add_u32 s49, s27, 4096
buffer_load_dwordx4 v[24:27], v2, s[84:87], s26 offen
buffer_load_dwordx4 v[28:31], v2, s[84:87], s26 offen offset:2048
buffer_load_dwordx4 v[32:35], v2, s[84:87], s48 offen
buffer_load_dwordx4 v[36:39], v2, s[84:87], s48 offen offset:2048
buffer_load_dwordx4 v[56:59], v2, s[84:87], s27 offen
buffer_load_dwordx4 v[60:63], v2, s[84:87], s27 offen offset:1024
buffer_load_dwordx4 v[64:67], v2, s[84:87], s27 offen offset:2048
buffer_load_dwordx4 v[68:71], v2, s[84:87], s27 offen offset:3072
buffer_load_dwordx4 v[72:75], v2, s[84:87], s49 offen
buffer_load_dwordx4 v[76:79], v2, s[84:87], s49 offen offset:1024
buffer_load_dwordx4 v[80:83], v2, s[84:87], s49 offen offset:2048
buffer_load_dwordx4 v[84:87], v2, s[84:87], s49 offen offset:3072
buffer_load_dwordx4 v[88:91], v2, s[84:87], s28 offen
buffer_load_dwordx4 v[92:95], v2, s[84:87], s28 offen offset:1024
buffer_load_dwordx4 v[96:99], v2, s[84:87], s28 offen offset:2048
buffer_load_dwordx4 v[100:103], v2, s[84:87], s28 offen offset:3072
L_x_sp_13:
v_mov_b32 v3, v252
v_mov_b32 v4, s45
s_waitcnt lgkmcnt(0)
v_mov_b32 v5, v16
s_barrier
ds_read_b128 v[152:155], v3
ds_read_b128 v[156:159], v3 offset:8704
ds_read_b128 v[160:163], v3 offset:17408
ds_read_b128 v[164:167], v3 offset:26112
ds_read_b128 v[168:171], v3 offset:34816
ds_read_b128 v[172:175], v3 offset:43520
ds_read_b128 v[176:179], v3 offset:52224
ds_read_b128 v[180:183], v3 offset:60928
v_add_u32 v3, 69632, v3
ds_read_b128 v[184:187], v3
ds_read_b128 v[188:191], v3 offset:8704
ds_read_b128 v[192:195], v3 offset:17408
ds_read_b128 v[196:199], v3 offset:26112
s_waitcnt lgkmcnt(8)
v_pk_add_f32 v[152:153], v[152:153], v[156:157]
v_pk_add_f32 v[154:155], v[154:155], v[158:159]
v_pk_add_f32 v[160:161], v[160:161], v[164:165]
v_pk_add_f32 v[162:163], v[162:163], v[166:167]
v_pk_add_f32 v[152:153], v[152:153], v[160:161]
v_pk_add_f32 v[154:155], v[154:155], v[162:163]
ds_read_b128 v[200:203], v3 offset:34816
ds_read_b128 v[204:207], v3 offset:43520
ds_read_b128 v[208:211], v3 offset:52224
ds_read_b128 v[212:215], v3 offset:60928
s_waitcnt lgkmcnt(8)
v_pk_add_f32 v[168:169], v[168:169], v[172:173]
v_pk_add_f32 v[170:171], v[170:171], v[174:175]
v_pk_add_f32 v[176:177], v[176:177], v[180:181]
v_pk_add_f32 v[178:179], v[178:179], v[182:183]
v_pk_add_f32 v[168:169], v[168:169], v[176:177]
v_pk_add_f32 v[170:171], v[170:171], v[178:179]
s_waitcnt lgkmcnt(4)
v_pk_add_f32 v[184:185], v[184:185], v[188:189]
v_pk_add_f32 v[186:187], v[186:187], v[190:191]
v_pk_add_f32 v[192:193], v[192:193], v[196:197]
v_pk_add_f32 v[194:195], v[194:195], v[198:199]
v_pk_add_f32 v[184:185], v[184:185], v[192:193]
v_pk_add_f32 v[186:187], v[186:187], v[194:195]
s_waitcnt lgkmcnt(0)
v_pk_add_f32 v[200:201], v[200:201], v[204:205]
v_pk_add_f32 v[202:203], v[202:203], v[206:207]
v_pk_add_f32 v[208:209], v[208:209], v[212:213]
v_pk_add_f32 v[210:211], v[210:211], v[214:215]
v_pk_add_f32 v[200:201], v[200:201], v[208:209]
v_pk_add_f32 v[202:203], v[202:203], v[210:211]
s_add_u32 s48, s9, 0
s_add_u32 s49, s9, 4096
s_add_u32 s27, s9, 8192
s_add_u32 s28, s9, 12288
s_cmp_eq_u32 s96, 1
s_cbranch_scc1 L_x_st_14f
buffer_store_dwordx4 v[152:155], v19, s[84:87], s48 offen sc1
buffer_store_dwordx4 v[168:171], v19, s[84:87], s49 offen sc1
buffer_store_dwordx4 v[184:187], v19, s[84:87], s27 offen sc1
buffer_store_dwordx4 v[200:203], v19, s[84:87], s28 offen sc1
s_branch L_x_st_14d
L_x_st_14f:
buffer_store_dwordx4 v[152:155], v19, s[84:87], s48 offen
buffer_store_dwordx4 v[168:171], v19, s[84:87], s49 offen
buffer_store_dwordx4 v[184:187], v19, s[84:87], s27 offen
buffer_store_dwordx4 v[200:203], v19, s[84:87], s28 offen
L_x_st_14d:
ds_read_b128 v[216:219], v5
ds_read_b128 v[220:223], v5 offset:8704
ds_read_b128 v[224:227], v5 offset:17408
ds_read_b128 v[228:231], v5 offset:26112
s_waitcnt lgkmcnt(0)
v_pk_add_f32 v[216:217], v[216:217], v[220:221]
v_pk_add_f32 v[218:219], v[218:219], v[222:223]
v_pk_add_f32 v[224:225], v[224:225], v[228:229]
v_pk_add_f32 v[226:227], v[226:227], v[230:231]
v_pk_add_f32 v[232:233], v[216:217], v[224:225]
v_pk_add_f32 v[234:235], v[218:219], v[226:227]
ds_read_b128 v[216:219], v5 offset:34816
ds_read_b128 v[220:223], v5 offset:43520
ds_read_b128 v[224:227], v5 offset:52224
ds_read_b128 v[228:231], v5 offset:60928
s_waitcnt lgkmcnt(0)
v_pk_add_f32 v[216:217], v[216:217], v[220:221]
v_pk_add_f32 v[218:219], v[218:219], v[222:223]
v_pk_add_f32 v[224:225], v[224:225], v[228:229]
v_pk_add_f32 v[226:227], v[226:227], v[230:231]
v_pk_add_f32 v[236:237], v[216:217], v[224:225]
v_pk_add_f32 v[238:239], v[218:219], v[226:227]
v_add_u32 v5, 69632, v5
ds_read_b128 v[216:219], v5
ds_read_b128 v[220:223], v5 offset:8704
ds_read_b128 v[224:227], v5 offset:17408
ds_read_b128 v[228:231], v5 offset:26112
s_waitcnt lgkmcnt(0)
v_pk_add_f32 v[216:217], v[216:217], v[220:221]
v_pk_add_f32 v[218:219], v[218:219], v[222:223]
v_pk_add_f32 v[224:225], v[224:225], v[228:229]
v_pk_add_f32 v[226:227], v[226:227], v[230:231]
v_pk_add_f32 v[240:241], v[216:217], v[224:225]
v_pk_add_f32 v[242:243], v[218:219], v[226:227]
ds_read_b128 v[216:219], v5 offset:34816
ds_read_b128 v[220:223], v5 offset:43520
ds_read_b128 v[224:227], v5 offset:52224
ds_read_b128 v[228:231], v5 offset:60928
s_waitcnt lgkmcnt(0)
v_pk_add_f32 v[216:217], v[216:217], v[220:221]
v_pk_add_f32 v[218:219], v[218:219], v[222:223]
v_pk_add_f32 v[224:225], v[224:225], v[228:229]
v_pk_add_f32 v[226:227], v[226:227], v[230:231]
v_pk_add_f32 v[244:245], v[216:217], v[224:225]
v_pk_add_f32 v[246:247], v[218:219], v[226:227]
s_waitcnt vmcnt(0)
s_barrier
s_cmp_eq_u32 s96, 1
s_cbranch_scc1 L_x_st_15f
buffer_store_dword v4, v15, s[84:87], 0 offen offset:64 sc1
s_branch L_x_st_15d
L_x_st_15f:
buffer_store_dword v4, v15, s[84:87], 0 offen offset:64
L_x_st_15d:
L_x_pfa:
buffer_load_dword v3, v251, s[84:87], 0 offen offset:64 sc1
s_waitcnt vmcnt(0)
v_cmp_gt_u32 vcc, s45, v3
s_cbranch_vccnz L_x_pfa
buffer_load_dwordx4 v[216:219], v19, s[84:87], s10 offen sc1
s_add_u32 s10, s10, 4096
buffer_load_dwordx4 v[220:223], v19, s[84:87], s10 offen sc1
s_add_u32 s10, s10, 4096
buffer_load_dwordx4 v[224:227], v19, s[84:87], s10 offen sc1
s_add_u32 s10, s10, 4096
buffer_load_dwordx4 v[228:231], v19, s[84:87], s10 offen sc1
s_waitcnt vmcnt(3)
v_pk_add_f32 v[216:217], v[216:217], v[232:233]
v_pk_add_f32 v[218:219], v[218:219], v[234:235]
v_cvt_pk_bf16_f32 v216, v216, v217
v_cvt_pk_bf16_f32 v217, v218, v219
buffer_store_dwordx2 v[216:217], v18, s[12:15], s42 offen
s_add_u32 s42, s42, 131072
s_waitcnt vmcnt(3)
v_pk_add_f32 v[220:221], v[220:221], v[236:237]
v_pk_add_f32 v[222:223], v[222:223], v[238:239]
v_cvt_pk_bf16_f32 v220, v220, v221
v_cvt_pk_bf16_f32 v221, v222, v223
buffer_store_dwordx2 v[220:221], v18, s[12:15], s42 offen
s_add_u32 s42, s42, 131072
s_waitcnt vmcnt(3)
v_pk_add_f32 v[224:225], v[224:225], v[240:241]
v_pk_add_f32 v[226:227], v[226:227], v[242:243]
v_cvt_pk_bf16_f32 v224, v224, v225
v_cvt_pk_bf16_f32 v225, v226, v227
buffer_store_dwordx2 v[224:225], v18, s[12:15], s42 offen
s_add_u32 s42, s42, 131072
s_waitcnt vmcnt(3)
v_pk_add_f32 v[228:229], v[228:229], v[244:245]
v_pk_add_f32 v[230:231], v[230:231], v[246:247]
v_cvt_pk_bf16_f32 v228, v228, v229
v_cvt_pk_bf16_f32 v229, v230, v231
buffer_store_dwordx2 v[228:229], v18, s[12:15], s42 offen
s_add_u32 s42, s42, 131072
s_branch L_x_f2
L_x_f1:
s_add_u32 s20, s50, 0
s_and_b32 s20, s20, 0x7fff
s_add_u32 s20, s20, s41
buffer_load_dwordx4 v[152:155], v2, s[84:87], s20 offen sc1
buffer_load_dwordx4 v[156:159], v2, s[84:87], s20 offen offset:1024 sc1
buffer_load_dwordx4 v[160:163], v2, s[84:87], s20 offen offset:2048 sc1
buffer_load_dwordx4 v[164:167], v2, s[84:87], s20 offen offset:3072 sc1
s_add_u32 s20, s50, 4096
s_and_b32 s20, s20, 0x7fff
s_add_u32 s20, s20, s41
buffer_load_dwordx4 v[168:171], v2, s[84:87], s20 offen sc1
buffer_load_dwordx4 v[172:175], v2, s[84:87], s20 offen offset:1024 sc1
buffer_load_dwordx4 v[176:179], v2, s[84:87], s20 offen offset:2048 sc1
buffer_load_dwordx4 v[180:183], v2, s[84:87], s20 offen offset:3072 sc1
s_add_u32 s20, s50, 8192
s_and_b32 s20, s20, 0x7fff
s_add_u32 s20, s20, s41
buffer_load_dwordx4 v[184:187], v2, s[84:87], s20 offen sc1
buffer_load_dwordx4 v[188:191], v2, s[84:87], s20 offen offset:1024 sc1
s_waitcnt vmcnt(9)
v_mfma_f32_32x32x16_bf16 v[200:215], a[0:3], v[152:155], 0
v_mfma_f32_32x32x16_bf16 v[216:231], a[4:7], v[152:155], 0
buffer_load_dwordx4 v[192:195], v2, s[84:87], s20 offen offset:2048 sc1
s_waitcnt vmcnt(9)
v_mfma_f32_32x32x16_bf16 v[200:215], a[8:11], v[156:159], v[200:215]
v_mfma_f32_32x32x16_bf16 v[216:231], a[12:15], v[156:159], v[216:231]
buffer_load_dwordx4 v[196:199], v2, s[84:87], s20 offen offset:3072 sc1
s_waitcnt vmcnt(9)
v_mfma_f32_32x32x16_bf16 v[200:215], a[16:19], v[160:163], v[200:215]
v_mfma_f32_32x32x16_bf16 v[216:231], a[20:23], v[160:163], v[216:231]
s_add_u32 s20, s50, 12288
s_and_b32 s20, s20, 0x7fff
s_add_u32 s20, s20, s41
buffer_load_dwordx4 v[152:155], v2, s[84:87], s20 offen sc1
s_waitcnt vmcnt(9)
v_mfma_f32_32x32x16_bf16 v[200:215], a[24:27], v[164:167], v[200:215]
v_mfma_f32_32x32x16_bf16 v[216:231], a[28:31], v[164:167], v[216:231]
buffer_load_dwordx4 v[156:159], v2, s[84:87], s20 offen offset:1024 sc1
s_waitcnt vmcnt(9)
v_mfma_f32_32x32x16_bf16 v[200:215], a[32:35], v[168:171], v[200:215]
v_mfma_f32_32x32x16_bf16 v[216:231], a[36:39], v[168:171], v[216:231]
buffer_load_dwordx4 v[160:163], v2, s[84:87], s20 offen offset:2048 sc1
s_waitcnt vmcnt(9)
v_mfma_f32_32x32x16_bf16 v[200:215], a[40:43], v[172:175], v[200:215]
v_mfma_f32_32x32x16_bf16 v[216:231], a[44:47], v[172:175], v[216:231]
buffer_load_dwordx4 v[164:167], v2, s[84:87], s20 offen offset:3072 sc1
s_waitcnt vmcnt(9)
v_mfma_f32_32x32x16_bf16 v[200:215], a[48:51], v[176:179], v[200:215]
v_mfma_f32_32x32x16_bf16 v[216:231], a[52:55], v[176:179], v[216:231]
s_add_u32 s20, s50, 16384
s_and_b32 s20, s20, 0x7fff
s_add_u32 s20, s20, s41
buffer_load_dwordx4 v[168:171], v2, s[84:87], s20 offen sc1
s_waitcnt vmcnt(9)
v_mfma_f32_32x32x16_bf16 v[200:215], a[56:59], v[180:183], v[200:215]
v_mfma_f32_32x32x16_bf16 v[216:231], a[60:63], v[180:183], v[216:231]
buffer_load_dwordx4 v[172:175], v2, s[84:87], s20 offen offset:1024 sc1
s_waitcnt vmcnt(9)
v_mfma_f32_32x32x16_bf16 v[200:215], a[64:67], v[184:187], v[200:215]
v_mfma_f32_32x32x16_bf16 v[216:231], a[68:71], v[184:187], v[216:231]
buffer_load_dwordx4 v[176:179], v2, s[84:87], s20 offen offset:2048 sc1
s_waitcnt vmcnt(9)
v_mfma_f32_32x32x16_bf16 v[200:215], a[72:75], v[188:191], v[200:215]
v_mfma_f32_32x32x16_bf16 v[216:231], a[76:79], v[188:191], v[216:231]
buffer_load_dwordx4 v[180:183], v2, s[84:87], s20 offen offset:3072 sc1
s_waitcnt vmcnt(9)
v_mfma_f32_32x32x16_bf16 v[200:215], a[80:83], v[192:195], v[200:215]
v_mfma_f32_32x32x16_bf16 v[216:231], a[84:87], v[192:195], v[216:231]
s_add_u32 s20, s50, 20480
s_and_b32 s20, s20, 0x7fff
s_add_u32 s20, s20, s41
buffer_load_dwordx4 v[184:187], v2, s[84:87], s20 offen sc1
s_waitcnt vmcnt(9)
v_mfma_f32_32x32x16_bf16 v[200:215], a[88:91], v[196:199], v[200:215]
v_mfma_f32_32x32x16_bf16 v[216:231], a[92:95], v[196:199], v[216:231]
buffer_load_dwordx4 v[188:191], v2, s[84:87], s20 offen offset:1024 sc1
s_waitcnt vmcnt(9)
v_mfma_f32_32x32x16_bf16 v[200:215], a[96:99], v[152:155], v[200:215]
v_mfma_f32_32x32x16_bf16 v[216:231], a[100:103], v[152:155], v[216:231]
buffer_load_dwordx4 v[192:195], v2, s[84:87], s20 offen offset:2048 sc1
s_waitcnt vmcnt(9)
v_mfma_f32_32x32x16_bf16 v[200:215], a[104:107], v[156:159], v[200:215]
v_mfma_f32_32x32x16_bf16 v[216:231], a[108:111], v[156:159], v[216:231]
buffer_load_dwordx4 v[196:199], v2, s[84:87], s20 offen offset:3072 sc1
s_waitcnt vmcnt(9)
v_mfma_f32_32x32x16_bf16 v[200:215], a[112:115], v[160:163], v[200:215]
v_mfma_f32_32x32x16_bf16 v[216:231], a[116:119], v[160:163], v[216:231]
s_add_u32 s20, s50, 24576
s_and_b32 s20, s20, 0x7fff
s_add_u32 s20, s20, s41
buffer_load_dwordx4 v[152:155], v2, s[84:87], s20 offen sc1
s_waitcnt vmcnt(9)
v_mfma_f32_32x32x16_bf16 v[200:215], a[120:123], v[164:167], v[200:215]
v_mfma_f32_32x32x16_bf16 v[216:231], a[124:127], v[164:167], v[216:231]
buffer_load_dwordx4 v[156:159], v2, s[84:87], s20 offen offset:1024 sc1
s_waitcnt vmcnt(9)
v_mfma_f32_32x32x16_bf16 v[200:215], a[128:131], v[168:171], v[200:215]
v_mfma_f32_32x32x16_bf16 v[216:231], a[132:135], v[168:171], v[216:231]
buffer_load_dwordx4 v[160:163], v2, s[84:87], s20 offen offset:2048 sc1
s_waitcnt vmcnt(9)
v_mfma_f32_32x32x16_bf16 v[200:215], a[136:139], v[172:175], v[200:215]
v_mfma_f32_32x32x16_bf16 v[216:231], a[140:143], v[172:175], v[216:231]
buffer_load_dwordx4 v[164:167], v2, s[84:87], s20 offen offset:3072 sc1
s_waitcnt vmcnt(9)
v_mfma_f32_32x32x16_bf16 v[200:215], a[144:147], v[176:179], v[200:215]
v_mfma_f32_32x32x16_bf16 v[216:231], a[148:151], v[176:179], v[216:231]
s_add_u32 s20, s50, 28672
s_and_b32 s20, s20, 0x7fff
s_add_u32 s20, s20, s41
buffer_load_dwordx4 v[168:171], v2, s[84:87], s20 offen sc1
s_waitcnt vmcnt(9)
v_mfma_f32_32x32x16_bf16 v[200:215], a[152:155], v[180:183], v[200:215]
v_mfma_f32_32x32x16_bf16 v[216:231], a[156:159], v[180:183], v[216:231]
buffer_load_dwordx4 v[172:175], v2, s[84:87], s20 offen offset:1024 sc1
s_waitcnt vmcnt(9)
v_mfma_f32_32x32x16_bf16 v[200:215], a[160:163], v[184:187], v[200:215]
v_mfma_f32_32x32x16_bf16 v[216:231], a[164:167], v[184:187], v[216:231]
buffer_load_dwordx4 v[176:179], v2, s[84:87], s20 offen offset:2048 sc1
s_waitcnt vmcnt(9)
v_mfma_f32_32x32x16_bf16 v[200:215], a[168:171], v[188:191], v[200:215]
v_mfma_f32_32x32x16_bf16 v[216:231], a[172:175], v[188:191], v[216:231]
buffer_load_dwordx4 v[180:183], v2, s[84:87], s20 offen offset:3072 sc1
s_waitcnt vmcnt(9)
v_mfma_f32_32x32x16_bf16 v[200:215], a[176:179], v[192:195], v[200:215]
v_mfma_f32_32x32x16_bf16 v[216:231], a[180:183], v[192:195], v[216:231]
s_waitcnt vmcnt(8)
v_mfma_f32_32x32x16_bf16 v[200:215], a[184:187], v[196:199], v[200:215]
v_mfma_f32_32x32x16_bf16 v[216:231], a[188:191], v[196:199], v[216:231]
s_waitcnt vmcnt(7)
v_mfma_f32_32x32x16_bf16 v[200:215], a[192:195], v[152:155], v[200:215]
v_mfma_f32_32x32x16_bf16 v[216:231], a[196:199], v[152:155], v[216:231]
s_waitcnt vmcnt(6)
v_mfma_f32_32x32x16_bf16 v[200:215], a[200:203], v[156:159], v[200:215]
v_mfma_f32_32x32x16_bf16 v[216:231], a[204:207], v[156:159], v[216:231]
s_waitcnt vmcnt(5)
v_mfma_f32_32x32x16_bf16 v[200:215], a[208:211], v[160:163], v[200:215]
v_mfma_f32_32x32x16_bf16 v[216:231], a[212:215], v[160:163], v[216:231]
s_waitcnt vmcnt(4)
v_mfma_f32_32x32x16_bf16 v[200:215], a[216:219], v[164:167], v[200:215]
v_mfma_f32_32x32x16_bf16 v[216:231], a[220:223], v[164:167], v[216:231]
s_waitcnt vmcnt(3)
v_mfma_f32_32x32x16_bf16 v[200:215], a[224:227], v[168:171], v[200:215]
v_mfma_f32_32x32x16_bf16 v[216:231], a[228:231], v[168:171], v[216:231]
s_waitcnt vmcnt(2)
v_mfma_f32_32x32x16_bf16 v[200:215], a[232:235], v[172:175], v[200:215]
v_mfma_f32_32x32x16_bf16 v[216:231], a[236:239], v[172:175], v[216:231]
s_waitcnt vmcnt(1)
v_mfma_f32_32x32x16_bf16 v[200:215], a[240:243], v[176:179], v[200:215]
v_mfma_f32_32x32x16_bf16 v[216:231], a[244:247], v[176:179], v[216:231]
s_waitcnt vmcnt(0)
v_mfma_f32_32x32x16_bf16 v[200:215], a[248:251], v[180:183], v[200:215]
v_mfma_f32_32x32x16_bf16 v[216:231], a[252:255], v[180:183], v[216:231]
s_nop 11
ds_write_b128 v17, v[200:203]
ds_write_b128 v17, v[204:207] offset:1088
ds_write_b128 v17, v[208:211] offset:2176
ds_write_b128 v17, v[212:215] offset:3264
ds_write_b128 v17, v[216:219] offset:4352
ds_write_b128 v17, v[220:223] offset:5440
ds_write_b128 v17, v[224:227] offset:6528
ds_write_b128 v17, v[228:231] offset:7616
s_sub_u32 s20, s22, 56
s_cmp_lt_u32 s20, 8
s_cselect_b32 s20, s51, 0
s_cmp_eq_u32 s20, 1
s_cbranch_scc0 L_x_sp_16
s_mov_b32 s46, 2
s_lshl_b32 s27, s22, 18
s_lshl_b32 s20, s18, 13
s_add_u32 s27, s27, s20
s_add_u32 s29, s27, 178257920
s_and_b32 s20, s16, 1
s_lshl_b32 s20, s20, 10
s_add_u32 s26, s27, s20
s_add_u32 s26, s26, 0
s_lshr_b32 s20, s16, 1
s_lshl_b32 s20, s20, 12
s_add_u32 s28, s27, s20
s_add_u32 s28, s28, 33554432
s_add_u32 s27, s27, 16777216
s_add_u32 s48, s26, 4096
s_add_u32 s49, s27, 4096
buffer_load_dwordx4 v[24:27], v2, s[84:87], s26 offen
buffer_load_dwordx4 v[28:31], v2, s[84:87], s26 offen offset:2048
buffer_load_dwordx4 v[32:35], v2, s[84:87], s48 offen
buffer_load_dwordx4 v[36:39], v2, s[84:87], s48 offen offset:2048
buffer_load_dwordx4 v[56:59], v2, s[84:87], s27 offen
buffer_load_dwordx4 v[60:63], v2, s[84:87], s27 offen offset:1024
buffer_load_dwordx4 v[64:67], v2, s[84:87], s27 offen offset:2048
buffer_load_dwordx4 v[68:71], v2, s[84:87], s27 offen offset:3072
buffer_load_dwordx4 v[72:75], v2, s[84:87], s49 offen
buffer_load_dwordx4 v[76:79], v2, s[84:87], s49 offen offset:1024
buffer_load_dwordx4 v[80:83], v2, s[84:87], s49 offen offset:2048
buffer_load_dwordx4 v[84:87], v2, s[84:87], s49 offen offset:3072
buffer_load_dwordx4 v[88:91], v2, s[84:87], s28 offen
buffer_load_dwordx4 v[92:95], v2, s[84:87], s28 offen offset:1024
buffer_load_dwordx4 v[96:99], v2, s[84:87], s28 offen offset:2048
buffer_load_dwordx4 v[100:103], v2, s[84:87], s28 offen offset:3072
L_x_sp_16:
v_mov_b32 v3, v252
v_mov_b32 v4, s45
s_waitcnt lgkmcnt(0)
v_mov_b32 v5, v16
s_barrier
ds_read_b128 v[152:155], v3
ds_read_b128 v[156:159], v3 offset:8704
ds_read_b128 v[160:163], v3 offset:17408
ds_read_b128 v[164:167], v3 offset:26112
s_waitcnt lgkmcnt(0)
v_pk_add_f32 v[152:153], v[152:153], v[156:157]
v_pk_add_f32 v[154:155], v[154:155], v[158:159]
v_pk_add_f32 v[160:161], v[160:161], v[164:165]
v_pk_add_f32 v[162:163], v[162:163], v[166:167]
v_pk_add_f32 v[152:153], v[152:153], v[160:161]
v_pk_add_f32 v[154:155], v[154:155], v[162:163]
s_add_u32 s48, s9, 0
s_cmp_eq_u32 s96, 1
s_cbranch_scc1 L_x_st_17f
buffer_store_dwordx4 v[152:155], v19, s[84:87], s48 offen sc1
s_branch L_x_st_17d
L_x_st_17f:
buffer_store_dwordx4 v[152:155], v19, s[84:87], s48 offen
L_x_st_17d:
ds_read_b128 v[216:219], v5
ds_read_b128 v[220:223], v5 offset:8704
ds_read_b128 v[224:227], v5 offset:17408
ds_read_b128 v[228:231], v5 offset:26112
s_waitcnt lgkmcnt(0)
v_pk_add_f32 v[216:217], v[216:217], v[220:221]
v_pk_add_f32 v[218:219], v[218:219], v[222:223]
v_pk_add_f32 v[224:225], v[224:225], v[228:229]
v_pk_add_f32 v[226:227], v[226:227], v[230:231]
v_pk_add_f32 v[232:233], v[216:217], v[224:225]
v_pk_add_f32 v[234:235], v[218:219], v[226:227]
s_waitcnt vmcnt(0)
s_barrier
s_cmp_eq_u32 s96, 1
s_cbranch_scc1 L_x_st_18f
buffer_store_dword v4, v15, s[84:87], 0 offen offset:64 sc1
s_branch L_x_st_18d
L_x_st_18f:
buffer_store_dword v4, v15, s[84:87], 0 offen offset:64
L_x_st_18d:
L_x_pfb:
buffer_load_dword v3, v251, s[84:87], 0 offen offset:64 sc1
s_waitcnt vmcnt(0)
v_cmp_gt_u32 vcc, s45, v3
s_cbranch_vccnz L_x_pfb
buffer_load_dwordx4 v[216:219], v19, s[84:87], s10 offen sc1
s_waitcnt vmcnt(0)
v_pk_add_f32 v[216:217], v[216:217], v[232:233]
v_pk_add_f32 v[218:219], v[218:219], v[234:235]
v_cvt_pk_bf16_f32 v216, v216, v217
v_cvt_pk_bf16_f32 v217, v218, v219
buffer_store_dwordx2 v[216:217], v18, s[12:15], s42 offen
s_add_u32 s42, s42, 131072
L_x_f2:
s_cmp_eq_u32 s46, 1
s_cbranch_scc1 L_x_batt
s_cmp_eq_u32 s46, 2
s_cbranch_scc1 L_x_satt
s_cmp_lt_u32 s22, 64
s_cbranch_scc1 L_x_job
s_branch L_x_fin
L_x_dx:
buffer_load_dword v3, off, s[88:91], 0 offset:204 sc1
v_and_b32 v4, 15, v1
v_lshrrev_b32 v5, 4, v1
v_and_b32 v160, 1, v4
v_lshlrev_b32 v160, 4, v160
v_mov_b32 v161, 0x3f80
v_lshlrev_b32 v161, v160, v161
v_lshrrev_b32 v4, 2, v4
v_cmp_eq_u32 vcc, v4, v5
v_mov_b32 v160, 0
s_waitcnt vmcnt(0)
v_cndmask_b32 v161, 0, v161, vcc
v_readfirstlane_b32 s20, v3
s_and_b32 s21, s22, 1
s_lshl_b32 s21, s21, 20
s_lshl_b32 s26, s18, 14
s_add_u32 s26, s26, s21
s_add_u32 s26, s26, 67108864
s_lshr_b32 s20, s20, 15
s_cmp_gt_u32 s20, s100
s_cselect_b32 s20, 8192, 0
s_add_u32 s26, s26, s20
s_bfe_u32 s20, s18, 0x10001
s_lshl_b32 s20, s20, 12
s_add_u32 s26, s26, s20
s_add_u32 s48, s26, 524288
s_lshr_b32 s20, s16, 1
s_lshl_b32 s20, s20, 11
s_xor_b32 s27, s26, 4096
s_add_u32 s27, s27, s20
s_add_u32 s49, s27, 524288
s_lshl_b32 s20, s16, 10
s_add_u32 s26, s26, s20
s_add_u32 s48, s48, s20
v_add_u32 v162, s20, v2
L_x_dr:
buffer_load_dword v3, v13, s[84:87], 0 offen sc1
s_waitcnt vmcnt(0)
v_cmp_gt_u32 vcc, s22, v3
s_cbranch_vccz L_x_dp
s_sleep 2
s_branch L_x_dr
L_x_dp:
buffer_load_dwordx2 v[152:153], v7, s[84:87], s26 offen sc1
buffer_load_dwordx2 v[154:155], v7, s[84:87], s26 offen offset:512 sc1
buffer_load_dwordx2 v[156:157], v7, s[84:87], s48 offen sc1
buffer_load_dwordx2 v[158:159], v7, s[84:87], s48 offen offset:512 sc1
s_waitcnt vmcnt(0)
v_mfma_f32_16x16x16_bf16 v[164:167], v[152:153], v[160:161], 0
v_mfma_f32_16x16x16_bf16 v[168:171], v[154:155], v[160:161], 0
v_mfma_f32_16x16x16_bf16 v[164:167], v[156:157], v[160:161], v[164:167]
v_mfma_f32_16x16x16_bf16 v[168:171], v[158:159], v[160:161], v[168:171]
v_or3_b32 v3, v152, v154, v156
v_or_b32 v3, v3, v158
v_and_b32 v3, 1, v3
v_cmp_ne_u32 vcc, 0, v3
s_nop 3
s_cbranch_vccnz L_x_dp
v_cvt_pk_bf16_f32 v152, v164, v165
v_cvt_pk_bf16_f32 v153, v166, v167
v_cvt_pk_bf16_f32 v154, v168, v169
v_cvt_pk_bf16_f32 v155, v170, v171
ds_write_b128 v162, v[152:155] offset:40960
s_waitcnt lgkmcnt(0)
s_barrier
ds_read_b128 v[120:123], v2 offset:40960
ds_read_b128 v[124:127], v2 offset:41984
ds_read_b128 v[128:131], v2 offset:43008
ds_read_b128 v[132:135], v2 offset:44032
L_x_dv:
buffer_load_dwordx2 v[136:137], v7, s[84:87], s27 offen sc1
buffer_load_dwordx2 v[138:139], v7, s[84:87], s49 offen sc1
buffer_load_dwordx2 v[140:141], v7, s[84:87], s27 offen offset:1024 sc1
buffer_load_dwordx2 v[142:143], v7, s[84:87], s49 offen offset:1024 sc1
s_waitcnt vmcnt(0) lgkmcnt(0)
v_or3_b32 v3, v136, v138, v140
v_or_b32 v3, v3, v142
v_and_b32 v3, 1, v3
v_cmp_ne_u32 vcc, 0, v3
s_cbranch_vccnz L_x_dv
s_branch L_x_rd
L_x_fin:
s_endpgm
.section .rodata,"a"
.p2align 6
.amdhsa_kernel mega_kernel
  .amdhsa_next_free_vgpr 512
  .amdhsa_next_free_sgpr 102
  .amdhsa_accum_offset 256
  .amdhsa_group_segment_fixed_size 0
  .amdhsa_kernarg_size 104
  .amdhsa_user_sgpr_count 2
  .amdhsa_user_sgpr_kernarg_segment_ptr 1
  .amdhsa_system_sgpr_workgroup_id_x 1
.end_amdhsa_kernel
```

```asm
; @launch kernel=mega_kernel grid=(256,1,1) block=(256,1,1) lds=161792
.amdgcn_target "amdgcn-amd-amdhsa--gfx950"
.text
.globl mega_kernel
.p2align 8
.type mega_kernel,@function
mega_kernel:
s_cmp_ge_u32 s2, 256
s_cbranch_scc1 L_exit
s_load_dwordx2 s[84:85], s[0:1], 96
s_load_dwordx2 s[88:89], s[0:1], 88
s_getreg_b32 s93, hwreg(HW_REG_XCC_ID)
s_and_b32 s93, s93, 7
s_lshl_b32 s93, s93, 2
s_lshr_b32 s93, 0x76541302, s93
s_and_b32 s93, s93, 7
v_lshrrev_b32 v1, 6, v0
v_mov_b32 v4, 0
v_readfirstlane_b32 s80, v1
v_mov_b32 v5, 0
v_mov_b32 v6, 0
v_mov_b32 v7, 0
s_mov_b32 s83, 0
s_lshl_b32 s101, s2, 2
s_add_u32 s101, s101, s80
s_lshl_b32 s101, s101, 8
s_add_u32 s101, s101, 230686720
s_waitcnt lgkmcnt(0)
s_mov_b32 s86, 268435456
s_mov_b32 s87, 0x00020000
s_mov_b32 s90, 256
s_mov_b32 s91, 0x00020000
s_mov_b32 s98, s80
s_cmp_lg_u32 s80, 0
s_cbranch_scc1 L_st0
v_mov_b32 v10, 1
s_lshl_b32 s81, s93, 5
s_mov_b64 exec, 1
buffer_atomic_add v10, off, s[88:91], s81 offset:4 sc0
s_lshl_b32 s81, s2, 7
s_add_u32 s81, s81, 71303168
s_mov_b64 exec, 15
v_and_b32 v1, 1, v0
v_lshlrev_b32 v1, 15, v1
v_lshrrev_b32 v2, 1, v0
v_lshl_add_u32 v1, v2, 6, v1
buffer_store_dword v4, v1, s[84:87], s81 offen sc1
s_mov_b64 exec, -1
L_st0:
v_mov_b32 v4, 0
v_mov_b32 v5, 0
v_mov_b32 v6, 0
v_mov_b32 v7, 0
v_lshlrev_b32 v1, 4, v0
s_lshl_b32 s81, s2, 13
s_add_u32 s81, s81, 67108864
s_add_u32 s79, s81, 4096
buffer_store_dwordx4 v[4:7], v1, s[84:87], s81 offen sc1
buffer_store_dwordx4 v[4:7], v1, s[84:87], s79 offen sc1
s_lshl_b32 s81, s2, 12
s_add_u32 s81, s81, 70254592
buffer_store_dwordx4 v[4:7], v1, s[84:87], s81 offen sc1
v_mov_b32 v9, -1
v_lshlrev_b32 v1, 2, v0
s_lshl_b32 s81, s2, 7
s_add_u32 s81, s81, 69206016
v_cmp_gt_u32 vcc, 32, v0
v_bfrev_b32 v2, 1
s_nop 0
v_cndmask_b32 v1, v2, v1, vcc
buffer_store_dword v9, v1, s[84:87], s81 offen sc1
s_cmp_lg_u32 s80, 0
s_cbranch_scc1 L_st1
s_mov_b64 exec, 1
s_waitcnt vmcnt(5)
ds_write_b32 v4, v10
s_mov_b64 exec, -1
s_waitcnt lgkmcnt(0)
L_st1:
s_barrier
ds_read_b32 v2, v4
s_waitcnt lgkmcnt(0)
v_readfirstlane_b32 s94, v2
s_barrier
s_sub_u32 s81, s93, 2
s_cmp_ge_u32 s81, 2
s_cbranch_scc1 L_nopr
s_cmp_lg_u32 s80, 0
s_cbranch_scc1 L_prd
v_lshlrev_b32 v1, 4, v0
s_and_b32 s81, s2, 127
s_lshl_b32 s81, s81, 14
s_add_u32 s81, s81, 67108864
s_add_u32 s77, s81, 8192
buffer_store_dwordx4 v[4:7], v1, s[84:87], s81 offen sc1
buffer_store_dwordx4 v[4:7], v1, s[84:87], s77 offen sc1
s_waitcnt vmcnt(0)
s_memtime s[70:71]
buffer_store_dwordx4 v[4:7], v1, s[84:87], s81 offen sc1
s_waitcnt vmcnt(0)
s_memtime s[72:73]
buffer_store_dwordx4 v[4:7], v1, s[84:87], s77 offen sc1
s_waitcnt vmcnt(0)
buffer_store_dwordx4 v[4:7], v1, s[84:87], s77 offen sc1
s_waitcnt vmcnt(0)
s_memtime s[74:75]
buffer_store_dwordx4 v[4:7], v1, s[84:87], s81 offen sc1
s_waitcnt vmcnt(0)
s_memtime s[76:77]
s_waitcnt lgkmcnt(0)
s_sub_u32 s76, s76, s74
s_sub_u32 s74, s74, s72
s_sub_u32 s72, s72, s70
s_add_u32 s72, s72, s76
s_cmp_lt_u32 s74, s72
s_cselect_b32 s81, 0x10001, 1
v_mov_b32 v8, s81
s_mov_b64 exec, 1
buffer_atomic_add v8, off, s[88:91], 0 offset:204 sc1
s_mov_b64 exec, -1
L_prd:
s_barrier
L_nopr:
s_mov_b32 s97, 0
s_mov_b32 s100, 64
L_fast:
s_mov_b32 s96, 1
s_mov_b32 s30, s93
s_and_b32 s31, s94, 31
s_cmp_lt_u32 s93, 2
s_cbranch_scc1 L_recf
s_sub_u32 s92, s93, 2
s_lshl_b32 s92, s92, 5
s_add_u32 s92, s92, s31
s_branch L_bulk
L_redo:
s_waitcnt vmcnt(0) lgkmcnt(0)
s_barrier
v_readlane_b32 s100, v36, 2
v_readlane_b32 s81, v36, 3
s_mov_b32 s97, 1
s_nop 2
s_add_u32 s100, s100, s81
s_mov_b32 s95, s94
v_readlane_b32 s81, v36, 0
s_cmp_gt_u32 s93, 0
s_nop 2
s_cselect_b32 s81, s81, 0
s_add_u32 s95, s95, s81
v_readlane_b32 s81, v36, 1
s_cmp_gt_u32 s93, 1
s_nop 2
s_cselect_b32 s81, s81, 0
s_add_u32 s95, s95, s81
v_readlane_b32 s81, v36, 2
s_cmp_gt_u32 s93, 2
s_nop 2
s_cselect_b32 s81, s81, 0
s_add_u32 s95, s95, s81
v_readlane_b32 s81, v36, 3
s_cmp_gt_u32 s93, 3
s_nop 2
s_cselect_b32 s81, s81, 0
s_add_u32 s95, s95, s81
v_readlane_b32 s81, v36, 4
s_cmp_gt_u32 s93, 4
s_nop 2
s_cselect_b32 s81, s81, 0
s_add_u32 s95, s95, s81
v_readlane_b32 s81, v36, 5
s_cmp_gt_u32 s93, 5
s_nop 2
s_cselect_b32 s81, s81, 0
s_add_u32 s95, s95, s81
v_readlane_b32 s81, v36, 6
s_cmp_gt_u32 s93, 6
s_nop 2
s_cselect_b32 s81, s81, 0
s_add_u32 s95, s95, s81
L_slow:
s_mov_b32 s96, 0
s_lshr_b32 s30, s95, 5
s_and_b32 s31, s95, 31
s_cmp_lt_u32 s95, 64
s_cbranch_scc1 L_recs
s_sub_u32 s92, s95, 64
s_branch L_bulk
L_exit:
s_endpgm
L_recf:
s_load_dwordx2 s[4:5], s[0:1], 96
s_load_dwordx2 s[12:13], s[0:1], 88
s_load_dwordx2 s[50:51], s[0:1], 16
s_load_dwordx2 s[52:53], s[0:1], 24
s_load_dwordx2 s[54:55], s[0:1], 32
s_load_dwordx2 s[56:57], s[0:1], 40
s_load_dwordx2 s[58:59], s[0:1], 8
v_lshrrev_b32 v3, 6, v0
v_and_b32 v40, 63, v0
v_readfirstlane_b32 s20, v3
v_lshrrev_b32 v41, 4, v40
v_and_b32 v42, 15, v40
v_lshlrev_b32 v1, 4, v40
s_mov_b32 s49, 0
s_waitcnt lgkmcnt(0)
s_mov_b32 s6, 268435456
s_mov_b32 s7, 0x00020000
s_mov_b32 s14, 256
s_mov_b32 s15, 0x00020000
s_mov_b32 s10, 8388608
s_mov_b32 s11, 0x00020000
s_mov_b32 s26, 0x00030003
s_mov_b32 s27, 0x00030003
s_mov_b32 s28, 0xcccccccc
s_mov_b32 s29, 0xcccccccc
s_mov_b32 s32, 0x33333333
s_mov_b32 s33, 0x33333333
s_mov_b32 s34, 0x3e0293ee
s_lshl_b32 s22, s20, 2
v_xor_b32 v3, s22, v42
v_lshlrev_b32 v3, 4, v3
v_lshl_add_u32 v4, v41, 4, s20
v_lshl_add_u32 v44, v4, 13, v3
s_lshl_b32 s22, s30, 22
s_lshl_b32 s23, s31, 8
s_add_u32 s22, s22, s23
v_add_u32 v44, s22, v44
s_and_b32 s23, s20, 1
s_lshl_b32 s23, s23, 7
v_xor_b32 v45, s23, v1
s_lshl_b32 s22, s31, 18
s_lshl_b32 s23, s20, 13
s_add_u32 s22, s22, s23
s_lshl_b32 s23, s30, 10
s_add_u32 s22, s22, s23
v_add_u32 v45, s22, v45
v_xor_b32 v61, 32, v45
v_xor_b32 v62, 64, v45
v_xor_b32 v63, 96, v45
s_lshl_b32 s43, s20, 12
s_lshl_b32 s48, s20, 10
s_mov_b32 s8, s50
s_mov_b32 s9, s51
s_add_u32 m0, s48, 0
s_mov_b32 s22, 0
buffer_load_dwordx4 v44, s[8:11], s22 offen  lds
s_add_u32 m0, s48, 4096
s_mov_b32 s22, 32768
buffer_load_dwordx4 v44, s[8:11], s22 offen  lds
s_add_u32 m0, s48, 8192
s_mov_b32 s22, 65536
buffer_load_dwordx4 v44, s[8:11], s22 offen  lds
s_add_u32 m0, s48, 12288
s_mov_b32 s22, 98304
buffer_load_dwordx4 v44, s[8:11], s22 offen  lds
s_add_u32 m0, s48, 16384
s_mov_b32 s22, 524288
buffer_load_dwordx4 v44, s[8:11], s22 offen  lds
s_add_u32 m0, s48, 20480
s_mov_b32 s22, 557056
buffer_load_dwordx4 v44, s[8:11], s22 offen  lds
s_add_u32 m0, s48, 24576
s_mov_b32 s22, 589824
buffer_load_dwordx4 v44, s[8:11], s22 offen  lds
s_add_u32 m0, s48, 28672
s_mov_b32 s22, 622592
buffer_load_dwordx4 v44, s[8:11], s22 offen  lds
s_add_u32 m0, s48, 32768
s_mov_b32 s22, 1048576
buffer_load_dwordx4 v44, s[8:11], s22 offen  lds
s_add_u32 m0, s48, 36864
s_mov_b32 s22, 1081344
buffer_load_dwordx4 v44, s[8:11], s22 offen  lds
s_add_u32 m0, s48, 40960
s_mov_b32 s22, 1114112
buffer_load_dwordx4 v44, s[8:11], s22 offen  lds
s_add_u32 m0, s48, 45056
s_mov_b32 s22, 1146880
buffer_load_dwordx4 v44, s[8:11], s22 offen  lds
s_waitcnt vmcnt(12)
s_barrier
s_or_b32 s81, s97, s98
s_cmp_lg_u32 s81, 0
s_cbranch_scc1 L_h0_1
s_lshl_b32 s81, s93, 5
v_mov_b32 v38, 1
s_mov_b64 exec, 1
buffer_atomic_add v38, off, s[88:91], s81 sc1
s_mov_b64 exec, -1
L_h0_1:
s_add_u32 m0, s48, 49152
s_mov_b32 s22, 1572864
buffer_load_dwordx4 v44, s[8:11], s22 offen  lds
s_add_u32 m0, s48, 53248
s_mov_b32 s22, 1605632
buffer_load_dwordx4 v44, s[8:11], s22 offen  lds
s_add_u32 m0, s48, 57344
s_mov_b32 s22, 1638400
buffer_load_dwordx4 v44, s[8:11], s22 offen  lds
s_add_u32 m0, s48, 61440
s_mov_b32 s22, 1671168
buffer_load_dwordx4 v44, s[8:11], s22 offen  lds
s_add_u32 m0, s48, 65536
s_mov_b32 s22, 2097152
buffer_load_dwordx4 v44, s[8:11], s22 offen  lds
s_add_u32 m0, s48, 69632
s_mov_b32 s22, 2129920
buffer_load_dwordx4 v44, s[8:11], s22 offen  lds
s_add_u32 m0, s48, 73728
s_mov_b32 s22, 2162688
buffer_load_dwordx4 v44, s[8:11], s22 offen  lds
s_add_u32 m0, s48, 77824
s_mov_b32 s22, 2195456
buffer_load_dwordx4 v44, s[8:11], s22 offen  lds
s_add_u32 m0, s48, 81920
s_mov_b32 s22, 2621440
buffer_load_dwordx4 v44, s[8:11], s22 offen  lds
s_add_u32 m0, s48, 86016
s_mov_b32 s22, 2654208
buffer_load_dwordx4 v44, s[8:11], s22 offen  lds
s_add_u32 m0, s48, 90112
s_mov_b32 s22, 2686976
buffer_load_dwordx4 v44, s[8:11], s22 offen  lds
s_add_u32 m0, s48, 94208
s_mov_b32 s22, 2719744
buffer_load_dwordx4 v44, s[8:11], s22 offen  lds
s_add_u32 m0, s48, 98304
s_mov_b32 s22, 3145728
buffer_load_dwordx4 v44, s[8:11], s22 offen  lds
s_add_u32 m0, s48, 102400
s_mov_b32 s22, 3178496
buffer_load_dwordx4 v44, s[8:11], s22 offen  lds
s_add_u32 m0, s48, 106496
s_mov_b32 s22, 3211264
buffer_load_dwordx4 v44, s[8:11], s22 offen  lds
s_add_u32 m0, s48, 110592
s_mov_b32 s22, 3244032
buffer_load_dwordx4 v44, s[8:11], s22 offen  lds
s_add_u32 m0, s48, 114688
s_mov_b32 s22, 3670016
buffer_load_dwordx4 v44, s[8:11], s22 offen  lds
s_add_u32 m0, s48, 118784
s_mov_b32 s22, 3702784
buffer_load_dwordx4 v44, s[8:11], s22 offen  lds
s_add_u32 m0, s48, 122880
s_mov_b32 s22, 3735552
buffer_load_dwordx4 v44, s[8:11], s22 offen  lds
s_add_u32 m0, s48, 126976
s_mov_b32 s22, 3768320
buffer_load_dwordx4 v44, s[8:11], s22 offen  lds
s_lshl_b32 s22, s30, 5
s_add_u32 s22, s22, s31
s_lshl_b32 s38, s22, 14
s_xor_b32 s22, s22, 32
s_lshl_b32 s37, s22, 14
s_add_u32 s38, s38, 67108864
s_add_u32 s37, s37, 67108864
s_lshl_b32 s46, s30, 19
s_add_u32 s46, s46, 70254592
s_mul_i32 s22, s31, 8448
s_add_u32 s47, s46, s22
s_mul_i32 s22, s20, 67584
s_add_u32 s46, s46, s22
s_lshl_b32 s22, s31, 6
s_add_u32 s46, s46, s22
s_add_u32 s61, s46, 33792
s_mul_i32 s22, s20, 2048
s_add_u32 s25, s47, s22
s_lshl_b32 s35, s30, 13
s_add_u32 s35, s35, 69206016
v_lshrrev_b32 v53, 2, v42
v_lshlrev_b32 v53, 1, v53
v_and_b32 v54, 1, v42
v_add_u32 v55, v53, v54
v_mov_b32 v14, 0
v_mov_b32 v15, 0
v_mov_b32 v2, 0x4444
v_mov_b32 v3, 0xeeee
v_cndmask_b32 v2, v2, v3, s[28:29]
s_lshl_b32 s22, s20, 12
v_add_u32 v32, s22, v1
v_add_u32 v33, 0x10000, v32
v_add_u32 v5, 0x10000, v1
v_add_u32 v6, 131072, v1
v_and_b32 v3, 3, v42
v_bfe_u32 v43, v40, 1, 1
v_lshlrev_b32 v7, 13, v43
v_and_b32 v43, 1, v40
v_lshl_add_u32 v7, v43, 7, v7
s_lshl_b32 s22, s31, 8
s_add_u32 s23, s22, 71311360
v_add_u32 v7, s23, v7
s_cmp_lg_u32 s20, 0
s_cbranch_scc1 L_rf_flk
s_lshl_b32 s23, s30, 7
s_add_u32 s22, s22, s23
s_add_u32 s22, s22, 71327744
v_bfrev_b32 v7, 1
v_writelane_b32 v7, s22, 0
L_rf_flk:
v_lshlrev_b32 v11, 3, v40
v_lshlrev_b32 v10, 8, v55
v_lshl_add_u32 v10, v41, 4, v10
v_mul_u32_u24 v8, 8448, v41
v_lshl_add_u32 v8, v3, 4, v8
v_lshrrev_b32 v4, 2, v42
v_mul_u32_u24 v4, 2048, v4
v_add_u32 v8, v4, v8
v_lshrrev_b32 v9, 1, v41
v_lshlrev_b32 v9, 5, v9
v_and_b32 v4, 1, v42
v_lshl_add_u32 v9, v4, 4, v9
v_and_b32 v4, 1, v41
v_lshl_add_u32 v9, v4, 3, v9
s_lshr_b32 s22, s31, 2
s_lshl_b32 s22, s22, 10
s_and_b32 s23, s31, 3
s_lshl_b32 s23, s23, 6
s_add_u32 s22, s22, s23
v_add_u32 v9, s22, v9
v_lshrrev_b32 v4, 2, v42
v_lshlrev_b32 v12, 8, v4
v_lshl_add_u32 v12, v41, 6, v12
v_lshl_add_u32 v12, v3, 4, v12
v_lshlrev_b32 v13, 6, v41
v_lshl_add_u32 v13, v42, 2, v13
v_cmp_eq_u32 vcc, 0, v3
v_mov_b32 v28, 0x3f803f80
v_mov_b32 v29, 0x3f803f80
v_cndmask_b32 v34, 0, 1, vcc
v_mov_b32 v30, 0x3f803f80
v_mov_b32 v31, 0x3f803f80
v_and_b32 v49, 1, v42
v_lshlrev_b32 v49, 4, v49
v_mov_b32 v50, 0x3f80
v_lshlrev_b32 v50, v49, v50
v_lshrrev_b32 v51, 2, v42
v_cmp_eq_u32 vcc, v51, v41
v_mov_b32 v24, v50
v_cndmask_b32 v52, 0, v50, s[28:29]
v_cndmask_b32 v53, 0, v50, s[32:33]
v_cndmask_b32 v16, 0, v52, vcc
v_cndmask_b32 v17, 0, v53, vcc
v_mov_b32 v25, v50
v_mov_b32 v26, v50
v_mov_b32 v27, v50
v_bfe_u32 v60, v40, 3, 1
v_bfe_u32 v49, v40, 2, 1
v_and_b32 v50, 1, v41
v_lshrrev_b32 v51, 1, v41
v_lshlrev_b32 v52, 3, v60
v_lshl_add_u32 v52, v50, 2, v52
v_lshl_add_u32 v53, v51, 4, v52
v_add_u32 v53, v53, v49
v_and_b32 v54, 3, v40
s_lshl_b32 s22, s20, 2
v_add_u32 v55, s22, v54
v_xor_b32 v55, v55, v52
v_lshlrev_b32 v55, 4, v55
v_lshl_add_u32 v46, v53, 8, v55
v_lshrrev_b32 v55, 2, v40
v_lshlrev_b32 v47, 10, v55
v_and_b32 v55, 7, v55
v_lshl_add_u32 v47, v55, 5, v47
v_lshl_add_u32 v47, v54, 3, v47
s_lshl_b32 s22, s20, 8
v_add_u32 v47, s22, v47
s_waitcnt vmcnt(28) lgkmcnt(0)
s_barrier
v_add_u32 v48, 0, v46
ds_read_b64_tr_b16 a[0:1], v48
ds_read_b64_tr_b16 a[2:3], v48 offset:512
ds_read_b64_tr_b16 a[4:5], v48 offset:8192
ds_read_b64_tr_b16 a[6:7], v48 offset:8704
ds_read_b64_tr_b16 a[8:9], v48 offset:8
ds_read_b64_tr_b16 a[10:11], v48 offset:520
ds_read_b64_tr_b16 a[12:13], v48 offset:8200
ds_read_b64_tr_b16 a[14:15], v48 offset:8712
s_waitcnt vmcnt(24) lgkmcnt(0)
s_barrier
s_mov_b32 s8, s52
s_mov_b32 s9, s53
s_add_u32 m0, s48, 0
s_mov_b32 s22, 0
buffer_load_dwordx4 v44, s[8:11], s22 offen  lds
s_add_u32 m0, s48, 4096
s_mov_b32 s22, 32768
buffer_load_dwordx4 v44, s[8:11], s22 offen  lds
s_add_u32 m0, s48, 8192
s_mov_b32 s22, 65536
buffer_load_dwordx4 v44, s[8:11], s22 offen  lds
s_add_u32 m0, s48, 12288
s_mov_b32 s22, 98304
buffer_load_dwordx4 v44, s[8:11], s22 offen  lds
v_add_u32 v48, 16384, v46
ds_read_b64_tr_b16 a[16:17], v48
ds_read_b64_tr_b16 a[18:19], v48 offset:512
ds_read_b64_tr_b16 a[20:21], v48 offset:8192
ds_read_b64_tr_b16 a[22:23], v48 offset:8704
ds_read_b64_tr_b16 a[24:25], v48 offset:8
ds_read_b64_tr_b16 a[26:27], v48 offset:520
ds_read_b64_tr_b16 a[28:29], v48 offset:8200
ds_read_b64_tr_b16 a[30:31], v48 offset:8712
s_waitcnt vmcnt(24) lgkmcnt(0)
s_barrier
s_add_u32 m0, s48, 16384
s_mov_b32 s22, 524288
buffer_load_dwordx4 v44, s[8:11], s22 offen  lds
s_add_u32 m0, s48, 20480
s_mov_b32 s22, 557056
buffer_load_dwordx4 v44, s[8:11], s22 offen  lds
s_add_u32 m0, s48, 24576
s_mov_b32 s22, 589824
buffer_load_dwordx4 v44, s[8:11], s22 offen  lds
s_add_u32 m0, s48, 28672
s_mov_b32 s22, 622592
buffer_load_dwordx4 v44, s[8:11], s22 offen  lds
v_add_u32 v48, 32768, v46
ds_read_b64_tr_b16 a[32:33], v48
ds_read_b64_tr_b16 a[34:35], v48 offset:512
ds_read_b64_tr_b16 a[36:37], v48 offset:8192
ds_read_b64_tr_b16 a[38:39], v48 offset:8704
ds_read_b64_tr_b16 a[40:41], v48 offset:8
ds_read_b64_tr_b16 a[42:43], v48 offset:520
ds_read_b64_tr_b16 a[44:45], v48 offset:8200
ds_read_b64_tr_b16 a[46:47], v48 offset:8712
s_waitcnt vmcnt(24) lgkmcnt(0)
s_barrier
s_add_u32 m0, s48, 32768
s_mov_b32 s22, 1048576
buffer_load_dwordx4 v44, s[8:11], s22 offen  lds
s_add_u32 m0, s48, 36864
s_mov_b32 s22, 1081344
buffer_load_dwordx4 v44, s[8:11], s22 offen  lds
s_add_u32 m0, s48, 40960
s_mov_b32 s22, 1114112
buffer_load_dwordx4 v44, s[8:11], s22 offen  lds
s_add_u32 m0, s48, 45056
s_mov_b32 s22, 1146880
buffer_load_dwordx4 v44, s[8:11], s22 offen  lds
v_add_u32 v48, 49152, v46
ds_read_b64_tr_b16 a[48:49], v48
ds_read_b64_tr_b16 a[50:51], v48 offset:512
ds_read_b64_tr_b16 a[52:53], v48 offset:8192
ds_read_b64_tr_b16 a[54:55], v48 offset:8704
ds_read_b64_tr_b16 a[56:57], v48 offset:8
ds_read_b64_tr_b16 a[58:59], v48 offset:520
ds_read_b64_tr_b16 a[60:61], v48 offset:8200
ds_read_b64_tr_b16 a[62:63], v48 offset:8712
s_waitcnt vmcnt(24) lgkmcnt(0)
s_barrier
s_add_u32 m0, s48, 49152
s_mov_b32 s22, 1572864
buffer_load_dwordx4 v44, s[8:11], s22 offen  lds
s_add_u32 m0, s48, 53248
s_mov_b32 s22, 1605632
buffer_load_dwordx4 v44, s[8:11], s22 offen  lds
s_add_u32 m0, s48, 57344
s_mov_b32 s22, 1638400
buffer_load_dwordx4 v44, s[8:11], s22 offen  lds
s_add_u32 m0, s48, 61440
s_mov_b32 s22, 1671168
buffer_load_dwordx4 v44, s[8:11], s22 offen  lds
v_add_u32 v48, 65536, v46
ds_read_b64_tr_b16 a[64:65], v48
ds_read_b64_tr_b16 a[66:67], v48 offset:512
ds_read_b64_tr_b16 a[68:69], v48 offset:8192
ds_read_b64_tr_b16 a[70:71], v48 offset:8704
ds_read_b64_tr_b16 a[72:73], v48 offset:8
ds_read_b64_tr_b16 a[74:75], v48 offset:520
ds_read_b64_tr_b16 a[76:77], v48 offset:8200
ds_read_b64_tr_b16 a[78:79], v48 offset:8712
s_waitcnt vmcnt(24) lgkmcnt(0)
s_barrier
s_add_u32 m0, s48, 65536
s_mov_b32 s22, 2097152
buffer_load_dwordx4 v44, s[8:11], s22 offen  lds
s_add_u32 m0, s48, 69632
s_mov_b32 s22, 2129920
buffer_load_dwordx4 v44, s[8:11], s22 offen  lds
s_add_u32 m0, s48, 73728
s_mov_b32 s22, 2162688
buffer_load_dwordx4 v44, s[8:11], s22 offen  lds
s_add_u32 m0, s48, 77824
s_mov_b32 s22, 2195456
buffer_load_dwordx4 v44, s[8:11], s22 offen  lds
v_add_u32 v48, 81920, v46
ds_read_b64_tr_b16 a[80:81], v48
ds_read_b64_tr_b16 a[82:83], v48 offset:512
ds_read_b64_tr_b16 a[84:85], v48 offset:8192
ds_read_b64_tr_b16 a[86:87], v48 offset:8704
ds_read_b64_tr_b16 a[88:89], v48 offset:8
ds_read_b64_tr_b16 a[90:91], v48 offset:520
ds_read_b64_tr_b16 a[92:93], v48 offset:8200
ds_read_b64_tr_b16 a[94:95], v48 offset:8712
s_waitcnt vmcnt(24) lgkmcnt(0)
s_barrier
s_add_u32 m0, s48, 81920
s_mov_b32 s22, 2621440
buffer_load_dwordx4 v44, s[8:11], s22 offen  lds
s_add_u32 m0, s48, 86016
s_mov_b32 s22, 2654208
buffer_load_dwordx4 v44, s[8:11], s22 offen  lds
s_add_u32 m0, s48, 90112
s_mov_b32 s22, 2686976
buffer_load_dwordx4 v44, s[8:11], s22 offen  lds
s_add_u32 m0, s48, 94208
s_mov_b32 s22, 2719744
buffer_load_dwordx4 v44, s[8:11], s22 offen  lds
v_add_u32 v48, 98304, v46
ds_read_b64_tr_b16 a[96:97], v48
ds_read_b64_tr_b16 a[98:99], v48 offset:512
ds_read_b64_tr_b16 a[100:101], v48 offset:8192
ds_read_b64_tr_b16 a[102:103], v48 offset:8704
ds_read_b64_tr_b16 a[104:105], v48 offset:8
ds_read_b64_tr_b16 a[106:107], v48 offset:520
ds_read_b64_tr_b16 a[108:109], v48 offset:8200
ds_read_b64_tr_b16 a[110:111], v48 offset:8712
s_waitcnt vmcnt(24) lgkmcnt(0)
s_barrier
s_add_u32 m0, s48, 98304
s_mov_b32 s22, 3145728
buffer_load_dwordx4 v44, s[8:11], s22 offen  lds
s_add_u32 m0, s48, 102400
s_mov_b32 s22, 3178496
buffer_load_dwordx4 v44, s[8:11], s22 offen  lds
s_add_u32 m0, s48, 106496
s_mov_b32 s22, 3211264
buffer_load_dwordx4 v44, s[8:11], s22 offen  lds
s_add_u32 m0, s48, 110592
s_mov_b32 s22, 3244032
buffer_load_dwordx4 v44, s[8:11], s22 offen  lds
v_add_u32 v48, 114688, v46
ds_read_b64_tr_b16 a[112:113], v48
ds_read_b64_tr_b16 a[114:115], v48 offset:512
ds_read_b64_tr_b16 a[116:117], v48 offset:8192
ds_read_b64_tr_b16 a[118:119], v48 offset:8704
ds_read_b64_tr_b16 a[120:121], v48 offset:8
ds_read_b64_tr_b16 a[122:123], v48 offset:520
ds_read_b64_tr_b16 a[124:125], v48 offset:8200
ds_read_b64_tr_b16 a[126:127], v48 offset:8712
s_waitcnt vmcnt(24) lgkmcnt(0)
s_barrier
s_add_u32 m0, s48, 114688
s_mov_b32 s22, 3670016
buffer_load_dwordx4 v44, s[8:11], s22 offen  lds
s_add_u32 m0, s48, 118784
s_mov_b32 s22, 3702784
buffer_load_dwordx4 v44, s[8:11], s22 offen  lds
s_add_u32 m0, s48, 122880
s_mov_b32 s22, 3735552
buffer_load_dwordx4 v44, s[8:11], s22 offen  lds
s_add_u32 m0, s48, 126976
s_mov_b32 s22, 3768320
buffer_load_dwordx4 v44, s[8:11], s22 offen  lds
v_add_u32 v48, 0, v46
ds_read_b64_tr_b16 a[128:129], v48
ds_read_b64_tr_b16 a[130:131], v48 offset:512
ds_read_b64_tr_b16 a[132:133], v48 offset:8192
ds_read_b64_tr_b16 a[134:135], v48 offset:8704
ds_read_b64_tr_b16 a[136:137], v48 offset:8
ds_read_b64_tr_b16 a[138:139], v48 offset:520
ds_read_b64_tr_b16 a[140:141], v48 offset:8200
ds_read_b64_tr_b16 a[142:143], v48 offset:8712
s_waitcnt vmcnt(24) lgkmcnt(0)
s_barrier
s_mov_b32 s8, s56
s_mov_b32 s9, s57
s_add_u32 m0, s43, 0
s_mov_b32 s22, 0
buffer_load_dwordx4 v45, s[8:11], s22 offen  lds
s_add_u32 m0, s43, 1024
s_mov_b32 s22, 2048
buffer_load_dwordx4 v61, s[8:11], s22 offen  lds
s_add_u32 m0, s43, 2048
s_mov_b32 s22, 65536
buffer_load_dwordx4 v62, s[8:11], s22 offen  lds
s_add_u32 m0, s43, 3072
s_mov_b32 s22, 67584
buffer_load_dwordx4 v63, s[8:11], s22 offen  lds
v_add_u32 v48, 16384, v46
ds_read_b64_tr_b16 a[144:145], v48
ds_read_b64_tr_b16 a[146:147], v48 offset:512
ds_read_b64_tr_b16 a[148:149], v48 offset:8192
ds_read_b64_tr_b16 a[150:151], v48 offset:8704
ds_read_b64_tr_b16 a[152:153], v48 offset:8
ds_read_b64_tr_b16 a[154:155], v48 offset:520
ds_read_b64_tr_b16 a[156:157], v48 offset:8200
ds_read_b64_tr_b16 a[158:159], v48 offset:8712
s_waitcnt vmcnt(24) lgkmcnt(0)
s_barrier
s_add_u32 m0, s43, 16384
s_mov_b32 s22, 4096
buffer_load_dwordx4 v45, s[8:11], s22 offen  lds
s_add_u32 m0, s43, 17408
s_mov_b32 s22, 6144
buffer_load_dwordx4 v61, s[8:11], s22 offen  lds
s_add_u32 m0, s43, 18432
s_mov_b32 s22, 69632
buffer_load_dwordx4 v62, s[8:11], s22 offen  lds
s_add_u32 m0, s43, 19456
s_mov_b32 s22, 71680
buffer_load_dwordx4 v63, s[8:11], s22 offen  lds
v_add_u32 v48, 32768, v46
ds_read_b64_tr_b16 a[160:161], v48
ds_read_b64_tr_b16 a[162:163], v48 offset:512
ds_read_b64_tr_b16 a[164:165], v48 offset:8192
ds_read_b64_tr_b16 a[166:167], v48 offset:8704
ds_read_b64_tr_b16 a[168:169], v48 offset:8
ds_read_b64_tr_b16 a[170:171], v48 offset:520
ds_read_b64_tr_b16 a[172:173], v48 offset:8200
ds_read_b64_tr_b16 a[174:175], v48 offset:8712
s_waitcnt vmcnt(24) lgkmcnt(0)
s_barrier
s_add_u32 m0, s43, 32768
s_mov_b32 s22, 32768
buffer_load_dwordx4 v45, s[8:11], s22 offen  lds
s_add_u32 m0, s43, 33792
s_mov_b32 s22, 34816
buffer_load_dwordx4 v61, s[8:11], s22 offen  lds
s_add_u32 m0, s43, 34816
s_mov_b32 s22, 98304
buffer_load_dwordx4 v62, s[8:11], s22 offen  lds
s_add_u32 m0, s43, 35840
s_mov_b32 s22, 100352
buffer_load_dwordx4 v63, s[8:11], s22 offen  lds
v_add_u32 v48, 49152, v46
ds_read_b64_tr_b16 a[176:177], v48
ds_read_b64_tr_b16 a[178:179], v48 offset:512
ds_read_b64_tr_b16 a[180:181], v48 offset:8192
ds_read_b64_tr_b16 a[182:183], v48 offset:8704
ds_read_b64_tr_b16 a[184:185], v48 offset:8
ds_read_b64_tr_b16 a[186:187], v48 offset:520
ds_read_b64_tr_b16 a[188:189], v48 offset:8200
ds_read_b64_tr_b16 a[190:191], v48 offset:8712
s_waitcnt vmcnt(24) lgkmcnt(0)
s_barrier
s_add_u32 m0, s43, 49152
s_mov_b32 s22, 36864
buffer_load_dwordx4 v45, s[8:11], s22 offen  lds
s_add_u32 m0, s43, 50176
s_mov_b32 s22, 38912
buffer_load_dwordx4 v61, s[8:11], s22 offen  lds
s_add_u32 m0, s43, 51200
s_mov_b32 s22, 102400
buffer_load_dwordx4 v62, s[8:11], s22 offen  lds
s_add_u32 m0, s43, 52224
s_mov_b32 s22, 104448
buffer_load_dwordx4 v63, s[8:11], s22 offen  lds
v_and_b32 v37, 7, v0
v_lshlrev_b32 v37, 5, v37
buffer_load_dword v36, v37, s[88:91], 0 offen sc1
buffer_load_dword v58, off, s[12:15], 0 offset:204 sc1
v_add_u32 v48, 65536, v46
ds_read_b64_tr_b16 a[192:193], v48
ds_read_b64_tr_b16 a[194:195], v48 offset:512
ds_read_b64_tr_b16 a[196:197], v48 offset:8192
ds_read_b64_tr_b16 a[198:199], v48 offset:8704
ds_read_b64_tr_b16 a[200:201], v48 offset:8
ds_read_b64_tr_b16 a[202:203], v48 offset:520
ds_read_b64_tr_b16 a[204:205], v48 offset:8200
ds_read_b64_tr_b16 a[206:207], v48 offset:8712
s_waitcnt vmcnt(24) lgkmcnt(0)
s_barrier
s_add_u32 m0, s43, 65536
s_mov_b32 s22, 131072
buffer_load_dwordx4 v45, s[8:11], s22 offen  lds
s_add_u32 m0, s43, 66560
s_mov_b32 s22, 133120
buffer_load_dwordx4 v61, s[8:11], s22 offen  lds
s_add_u32 m0, s43, 67584
s_mov_b32 s22, 196608
buffer_load_dwordx4 v62, s[8:11], s22 offen  lds
s_add_u32 m0, s43, 68608
s_mov_b32 s22, 198656
buffer_load_dwordx4 v63, s[8:11], s22 offen  lds
v_add_u32 v48, 81920, v46
ds_read_b64_tr_b16 a[208:209], v48
ds_read_b64_tr_b16 a[210:211], v48 offset:512
ds_read_b64_tr_b16 a[212:213], v48 offset:8192
ds_read_b64_tr_b16 a[214:215], v48 offset:8704
ds_read_b64_tr_b16 a[216:217], v48 offset:8
ds_read_b64_tr_b16 a[218:219], v48 offset:520
ds_read_b64_tr_b16 a[220:221], v48 offset:8200
ds_read_b64_tr_b16 a[222:223], v48 offset:8712
s_waitcnt vmcnt(24) lgkmcnt(0)
s_barrier
s_add_u32 m0, s43, 81920
s_mov_b32 s22, 135168
buffer_load_dwordx4 v45, s[8:11], s22 offen  lds
s_add_u32 m0, s43, 82944
s_mov_b32 s22, 137216
buffer_load_dwordx4 v61, s[8:11], s22 offen  lds
s_add_u32 m0, s43, 83968
s_mov_b32 s22, 200704
buffer_load_dwordx4 v62, s[8:11], s22 offen  lds
s_add_u32 m0, s43, 84992
s_mov_b32 s22, 202752
buffer_load_dwordx4 v63, s[8:11], s22 offen  lds
v_add_u32 v48, 98304, v46
ds_read_b64_tr_b16 a[224:225], v48
ds_read_b64_tr_b16 a[226:227], v48 offset:512
ds_read_b64_tr_b16 a[228:229], v48 offset:8192
ds_read_b64_tr_b16 a[230:231], v48 offset:8704
ds_read_b64_tr_b16 a[232:233], v48 offset:8
ds_read_b64_tr_b16 a[234:235], v48 offset:520
ds_read_b64_tr_b16 a[236:237], v48 offset:8200
ds_read_b64_tr_b16 a[238:239], v48 offset:8712
s_waitcnt vmcnt(24) lgkmcnt(0)
s_barrier
s_add_u32 m0, s43, 98304
s_mov_b32 s22, 163840
buffer_load_dwordx4 v45, s[8:11], s22 offen  lds
s_add_u32 m0, s43, 99328
s_mov_b32 s22, 165888
buffer_load_dwordx4 v61, s[8:11], s22 offen  lds
s_add_u32 m0, s43, 100352
s_mov_b32 s22, 229376
buffer_load_dwordx4 v62, s[8:11], s22 offen  lds
s_add_u32 m0, s43, 101376
s_mov_b32 s22, 231424
buffer_load_dwordx4 v63, s[8:11], s22 offen  lds
v_add_u32 v48, 114688, v46
ds_read_b64_tr_b16 a[240:241], v48
ds_read_b64_tr_b16 a[242:243], v48 offset:512
ds_read_b64_tr_b16 a[244:245], v48 offset:8192
ds_read_b64_tr_b16 a[246:247], v48 offset:8704
ds_read_b64_tr_b16 a[248:249], v48 offset:8
ds_read_b64_tr_b16 a[250:251], v48 offset:520
ds_read_b64_tr_b16 a[252:253], v48 offset:8200
ds_read_b64_tr_b16 a[254:255], v48 offset:8712
s_waitcnt vmcnt(24) lgkmcnt(0)
s_barrier
s_add_u32 m0, s43, 114688
s_mov_b32 s22, 167936
buffer_load_dwordx4 v45, s[8:11], s22 offen  lds
s_add_u32 m0, s43, 115712
s_mov_b32 s22, 169984
buffer_load_dwordx4 v61, s[8:11], s22 offen  lds
s_add_u32 m0, s43, 116736
s_mov_b32 s22, 233472
buffer_load_dwordx4 v62, s[8:11], s22 offen  lds
s_add_u32 m0, s43, 117760
s_mov_b32 s22, 235520
buffer_load_dwordx4 v63, s[8:11], s22 offen  lds
v_add_u32 v48, 0, v47
v_xor_b32 v59, 0, v48
ds_read_b64_tr_b16 v[128:129], v59
v_xor_b32 v59, 32, v48
ds_read_b64_tr_b16 v[144:145], v59
v_xor_b32 v59, 64, v48
ds_read_b64_tr_b16 v[160:161], v59
v_xor_b32 v59, 96, v48
ds_read_b64_tr_b16 v[176:177], v59
v_xor_b32 v59, 128, v48
ds_read_b64_tr_b16 v[192:193], v59
v_xor_b32 v59, 160, v48
ds_read_b64_tr_b16 v[208:209], v59
v_xor_b32 v59, 192, v48
ds_read_b64_tr_b16 v[224:225], v59
v_xor_b32 v59, 224, v48
ds_read_b64_tr_b16 v[240:241], v59
s_waitcnt vmcnt(24) lgkmcnt(0)
s_barrier
s_mov_b32 s8, s54
s_mov_b32 s9, s55
s_add_u32 m0, s48, 0
s_mov_b32 s22, 0
buffer_load_dwordx4 v44, s[8:11], s22 offen  lds
s_add_u32 m0, s48, 4096
s_mov_b32 s22, 32768
buffer_load_dwordx4 v44, s[8:11], s22 offen  lds
s_add_u32 m0, s48, 8192
s_mov_b32 s22, 65536
buffer_load_dwordx4 v44, s[8:11], s22 offen  lds
s_add_u32 m0, s48, 12288
s_mov_b32 s22, 98304
buffer_load_dwordx4 v44, s[8:11], s22 offen  lds
v_add_u32 v48, 16384, v47
v_xor_b32 v59, 0, v48
ds_read_b64_tr_b16 v[130:131], v59
v_xor_b32 v59, 32, v48
ds_read_b64_tr_b16 v[146:147], v59
v_xor_b32 v59, 64, v48
ds_read_b64_tr_b16 v[162:163], v59
v_xor_b32 v59, 96, v48
ds_read_b64_tr_b16 v[178:179], v59
v_xor_b32 v59, 128, v48
ds_read_b64_tr_b16 v[194:195], v59
v_xor_b32 v59, 160, v48
ds_read_b64_tr_b16 v[210:211], v59
v_xor_b32 v59, 192, v48
ds_read_b64_tr_b16 v[226:227], v59
v_xor_b32 v59, 224, v48
ds_read_b64_tr_b16 v[242:243], v59
s_waitcnt vmcnt(24) lgkmcnt(0)
s_barrier
s_add_u32 m0, s48, 16384
s_mov_b32 s22, 524288
buffer_load_dwordx4 v44, s[8:11], s22 offen  lds
s_add_u32 m0, s48, 20480
s_mov_b32 s22, 557056
buffer_load_dwordx4 v44, s[8:11], s22 offen  lds
s_add_u32 m0, s48, 24576
s_mov_b32 s22, 589824
buffer_load_dwordx4 v44, s[8:11], s22 offen  lds
s_add_u32 m0, s48, 28672
s_mov_b32 s22, 622592
buffer_load_dwordx4 v44, s[8:11], s22 offen  lds
v_add_u32 v48, 32768, v47
v_xor_b32 v59, 0, v48
ds_read_b64_tr_b16 v[132:133], v59
v_xor_b32 v59, 32, v48
ds_read_b64_tr_b16 v[148:149], v59
v_xor_b32 v59, 64, v48
ds_read_b64_tr_b16 v[164:165], v59
v_xor_b32 v59, 96, v48
ds_read_b64_tr_b16 v[180:181], v59
v_xor_b32 v59, 128, v48
ds_read_b64_tr_b16 v[196:197], v59
v_xor_b32 v59, 160, v48
ds_read_b64_tr_b16 v[212:213], v59
v_xor_b32 v59, 192, v48
ds_read_b64_tr_b16 v[228:229], v59
v_xor_b32 v59, 224, v48
ds_read_b64_tr_b16 v[244:245], v59
s_waitcnt vmcnt(24) lgkmcnt(0)
s_barrier
s_add_u32 m0, s48, 32768
s_mov_b32 s22, 1048576
buffer_load_dwordx4 v44, s[8:11], s22 offen  lds
s_add_u32 m0, s48, 36864
s_mov_b32 s22, 1081344
buffer_load_dwordx4 v44, s[8:11], s22 offen  lds
s_add_u32 m0, s48, 40960
s_mov_b32 s22, 1114112
buffer_load_dwordx4 v44, s[8:11], s22 offen  lds
s_add_u32 m0, s48, 45056
s_mov_b32 s22, 1146880
buffer_load_dwordx4 v44, s[8:11], s22 offen  lds
v_add_u32 v48, 49152, v47
v_xor_b32 v59, 0, v48
ds_read_b64_tr_b16 v[134:135], v59
v_xor_b32 v59, 32, v48
ds_read_b64_tr_b16 v[150:151], v59
v_xor_b32 v59, 64, v48
ds_read_b64_tr_b16 v[166:167], v59
v_xor_b32 v59, 96, v48
ds_read_b64_tr_b16 v[182:183], v59
v_xor_b32 v59, 128, v48
ds_read_b64_tr_b16 v[198:199], v59
v_xor_b32 v59, 160, v48
ds_read_b64_tr_b16 v[214:215], v59
v_xor_b32 v59, 192, v48
ds_read_b64_tr_b16 v[230:231], v59
v_xor_b32 v59, 224, v48
ds_read_b64_tr_b16 v[246:247], v59
s_waitcnt vmcnt(24) lgkmcnt(0)
s_barrier
s_add_u32 m0, s48, 49152
s_mov_b32 s22, 1572864
buffer_load_dwordx4 v44, s[8:11], s22 offen  lds
s_add_u32 m0, s48, 53248
s_mov_b32 s22, 1605632
buffer_load_dwordx4 v44, s[8:11], s22 offen  lds
s_add_u32 m0, s48, 57344
s_mov_b32 s22, 1638400
buffer_load_dwordx4 v44, s[8:11], s22 offen  lds
s_add_u32 m0, s48, 61440
s_mov_b32 s22, 1671168
buffer_load_dwordx4 v44, s[8:11], s22 offen  lds
v_add_u32 v48, 65536, v47
v_xor_b32 v59, 0, v48
ds_read_b64_tr_b16 v[136:137], v59
v_xor_b32 v59, 32, v48
ds_read_b64_tr_b16 v[152:153], v59
v_xor_b32 v59, 64, v48
ds_read_b64_tr_b16 v[168:169], v59
v_xor_b32 v59, 96, v48
ds_read_b64_tr_b16 v[184:185], v59
v_xor_b32 v59, 128, v48
ds_read_b64_tr_b16 v[200:201], v59
v_xor_b32 v59, 160, v48
ds_read_b64_tr_b16 v[216:217], v59
v_xor_b32 v59, 192, v48
ds_read_b64_tr_b16 v[232:233], v59
v_xor_b32 v59, 224, v48
ds_read_b64_tr_b16 v[248:249], v59
s_waitcnt vmcnt(24) lgkmcnt(0)
s_barrier
s_add_u32 m0, s48, 65536
s_mov_b32 s22, 2097152
buffer_load_dwordx4 v44, s[8:11], s22 offen  lds
s_add_u32 m0, s48, 69632
s_mov_b32 s22, 2129920
buffer_load_dwordx4 v44, s[8:11], s22 offen  lds
s_add_u32 m0, s48, 73728
s_mov_b32 s22, 2162688
buffer_load_dwordx4 v44, s[8:11], s22 offen  lds
s_add_u32 m0, s48, 77824
s_mov_b32 s22, 2195456
buffer_load_dwordx4 v44, s[8:11], s22 offen  lds
v_add_u32 v48, 81920, v47
v_xor_b32 v59, 0, v48
ds_read_b64_tr_b16 v[138:139], v59
v_xor_b32 v59, 32, v48
ds_read_b64_tr_b16 v[154:155], v59
v_xor_b32 v59, 64, v48
ds_read_b64_tr_b16 v[170:171], v59
v_xor_b32 v59, 96, v48
ds_read_b64_tr_b16 v[186:187], v59
v_xor_b32 v59, 128, v48
ds_read_b64_tr_b16 v[202:203], v59
v_xor_b32 v59, 160, v48
ds_read_b64_tr_b16 v[218:219], v59
v_xor_b32 v59, 192, v48
ds_read_b64_tr_b16 v[234:235], v59
v_xor_b32 v59, 224, v48
ds_read_b64_tr_b16 v[250:251], v59
s_waitcnt vmcnt(24) lgkmcnt(0)
s_barrier
s_add_u32 m0, s48, 81920
s_mov_b32 s22, 2621440
buffer_load_dwordx4 v44, s[8:11], s22 offen  lds
s_add_u32 m0, s48, 86016
s_mov_b32 s22, 2654208
buffer_load_dwordx4 v44, s[8:11], s22 offen  lds
s_add_u32 m0, s48, 90112
s_mov_b32 s22, 2686976
buffer_load_dwordx4 v44, s[8:11], s22 offen  lds
s_add_u32 m0, s48, 94208
s_mov_b32 s22, 2719744
buffer_load_dwordx4 v44, s[8:11], s22 offen  lds
s_cmp_lg_u32 s97, 0
s_cbranch_scc1 L_h2_2_ok
L_h2_2_ev:
v_cmp_ne_u32 vcc, 32, v36
s_cbranch_vccz L_h2_2_ok
s_mov_b32 s78, 0
v_readlane_b32 s81, v36, 0
s_nop 3
s_add_u32 s78, s78, s81
v_readlane_b32 s81, v36, 1
s_nop 3
s_add_u32 s78, s78, s81
v_readlane_b32 s81, v36, 2
s_nop 3
s_add_u32 s78, s78, s81
v_readlane_b32 s81, v36, 3
s_nop 3
s_add_u32 s78, s78, s81
v_readlane_b32 s81, v36, 4
s_nop 3
s_add_u32 s78, s78, s81
v_readlane_b32 s81, v36, 5
s_nop 3
s_add_u32 s78, s78, s81
v_readlane_b32 s81, v36, 6
s_nop 3
s_add_u32 s78, s78, s81
v_readlane_b32 s81, v36, 7
s_nop 3
s_add_u32 s78, s78, s81
s_cmp_eq_u32 s78, 256
s_cbranch_scc1 L_redo
buffer_load_dword v36, v37, s[88:91], 0 offen sc1
s_waitcnt vmcnt(0)
s_branch L_h2_2_ev
L_h2_2_ok:
s_mov_b32 s97, 1
v_add_u32 v48, 98304, v47
v_xor_b32 v59, 0, v48
ds_read_b64_tr_b16 v[140:141], v59
v_xor_b32 v59, 32, v48
ds_read_b64_tr_b16 v[156:157], v59
v_xor_b32 v59, 64, v48
ds_read_b64_tr_b16 v[172:173], v59
v_xor_b32 v59, 96, v48
ds_read_b64_tr_b16 v[188:189], v59
v_xor_b32 v59, 128, v48
ds_read_b64_tr_b16 v[204:205], v59
v_xor_b32 v59, 160, v48
ds_read_b64_tr_b16 v[220:221], v59
v_xor_b32 v59, 192, v48
ds_read_b64_tr_b16 v[236:237], v59
v_xor_b32 v59, 224, v48
ds_read_b64_tr_b16 v[252:253], v59
s_waitcnt vmcnt(24) lgkmcnt(0)
s_barrier
s_add_u32 m0, s48, 98304
s_mov_b32 s22, 3145728
buffer_load_dwordx4 v44, s[8:11], s22 offen  lds
s_add_u32 m0, s48, 102400
s_mov_b32 s22, 3178496
buffer_load_dwordx4 v44, s[8:11], s22 offen  lds
s_add_u32 m0, s48, 106496
s_mov_b32 s22, 3211264
buffer_load_dwordx4 v44, s[8:11], s22 offen  lds
s_add_u32 m0, s48, 110592
s_mov_b32 s22, 3244032
buffer_load_dwordx4 v44, s[8:11], s22 offen  lds
v_add_u32 v48, 114688, v47
v_xor_b32 v59, 0, v48
ds_read_b64_tr_b16 v[142:143], v59
v_xor_b32 v59, 32, v48
ds_read_b64_tr_b16 v[158:159], v59
v_xor_b32 v59, 64, v48
ds_read_b64_tr_b16 v[174:175], v59
v_xor_b32 v59, 96, v48
ds_read_b64_tr_b16 v[190:191], v59
v_xor_b32 v59, 128, v48
ds_read_b64_tr_b16 v[206:207], v59
v_xor_b32 v59, 160, v48
ds_read_b64_tr_b16 v[222:223], v59
v_xor_b32 v59, 192, v48
ds_read_b64_tr_b16 v[238:239], v59
v_xor_b32 v59, 224, v48
ds_read_b64_tr_b16 v[254:255], v59
s_waitcnt vmcnt(24) lgkmcnt(0)
s_barrier
s_add_u32 m0, s48, 114688
s_mov_b32 s22, 3670016
buffer_load_dwordx4 v44, s[8:11], s22 offen  lds
s_add_u32 m0, s48, 118784
s_mov_b32 s22, 3702784
buffer_load_dwordx4 v44, s[8:11], s22 offen  lds
s_add_u32 m0, s48, 122880
s_mov_b32 s22, 3735552
buffer_load_dwordx4 v44, s[8:11], s22 offen  lds
s_add_u32 m0, s48, 126976
s_mov_b32 s22, 3768320
buffer_load_dwordx4 v44, s[8:11], s22 offen  lds
v_add_u32 v48, 0, v46
ds_read_b64_tr_b16 v[64:65], v48
ds_read_b64_tr_b16 v[66:67], v48 offset:512
ds_read_b64_tr_b16 v[68:69], v48 offset:8192
ds_read_b64_tr_b16 v[70:71], v48 offset:8704
ds_read_b64_tr_b16 v[72:73], v48 offset:8
ds_read_b64_tr_b16 v[74:75], v48 offset:520
ds_read_b64_tr_b16 v[76:77], v48 offset:8200
ds_read_b64_tr_b16 v[78:79], v48 offset:8712
s_waitcnt vmcnt(24) lgkmcnt(0)
s_barrier
ds_write_b128 v32, v[64:67]
ds_write_b128 v32, v[68:71] offset:1024
ds_write_b128 v32, v[72:75] offset:2048
ds_write_b128 v32, v[76:79] offset:3072
v_add_u32 v48, 16384, v46
ds_read_b64_tr_b16 v[80:81], v48
ds_read_b64_tr_b16 v[82:83], v48 offset:512
ds_read_b64_tr_b16 v[84:85], v48 offset:8192
ds_read_b64_tr_b16 v[86:87], v48 offset:8704
ds_read_b64_tr_b16 v[88:89], v48 offset:8
ds_read_b64_tr_b16 v[90:91], v48 offset:520
ds_read_b64_tr_b16 v[92:93], v48 offset:8200
ds_read_b64_tr_b16 v[94:95], v48 offset:8712
s_waitcnt vmcnt(20) lgkmcnt(0)
s_barrier
ds_write_b128 v32, v[80:83] offset:16384
ds_write_b128 v32, v[84:87] offset:17408
ds_write_b128 v32, v[88:91] offset:18432
ds_write_b128 v32, v[92:95] offset:19456
s_getpc_b64 s[16:17]
L_rf_pc0:
s_add_u32 s16, s16, L_rf_w0_entry - L_rf_pc0
s_addc_u32 s17, s17, 0
v_lshlrev_b32 v49, 7, v0
v_min_u32 v49, L_rf_end - L_rf_w0_entry, v49
global_load_dword v50, v49, s[16:17]
v_lshlrev_b32 v49, 7, v40
s_xor_b32 s23, s35, 16384
s_cmp_eq_u32 s20, 1
s_cselect_b32 s22, s35, s47
s_cmp_eq_u32 s20, 2
s_cselect_b32 s22, s23, s22
s_lshl_b32 s23, s31, 13
s_add_u32 s23, s23, 178257920
s_cmp_eq_u32 s20, 3
s_cselect_b32 s22, s23, s22
buffer_load_dword v51, v49, s[4:7], s22 offen sc1
v_lshlrev_b32 v49, 13, v0
v_and_b32 v49, 0x1fffff, v49
s_mov_b32 s22, 67108864
buffer_load_dword v52, v49, s[4:7], s22 offen sc1
buffer_load_dword v57, v7, s[4:7], 0 offen sc1
v_add_u32 v48, 32768, v46
ds_read_b64_tr_b16 v[64:65], v48
ds_read_b64_tr_b16 v[66:67], v48 offset:512
ds_read_b64_tr_b16 v[68:69], v48 offset:8192
ds_read_b64_tr_b16 v[70:71], v48 offset:8704
ds_read_b64_tr_b16 v[72:73], v48 offset:8
ds_read_b64_tr_b16 v[74:75], v48 offset:520
ds_read_b64_tr_b16 v[76:77], v48 offset:8200
ds_read_b64_tr_b16 v[78:79], v48 offset:8712
s_waitcnt vmcnt(16) lgkmcnt(0)
s_barrier
ds_write_b128 v32, v[64:67] offset:32768
ds_write_b128 v32, v[68:71] offset:33792
ds_write_b128 v32, v[72:75] offset:34816
ds_write_b128 v32, v[76:79] offset:35840
v_add_u32 v48, 49152, v46
ds_read_b64_tr_b16 v[80:81], v48
ds_read_b64_tr_b16 v[82:83], v48 offset:512
ds_read_b64_tr_b16 v[84:85], v48 offset:8192
ds_read_b64_tr_b16 v[86:87], v48 offset:8704
ds_read_b64_tr_b16 v[88:89], v48 offset:8
ds_read_b64_tr_b16 v[90:91], v48 offset:520
ds_read_b64_tr_b16 v[92:93], v48 offset:8200
ds_read_b64_tr_b16 v[94:95], v48 offset:8712
s_waitcnt vmcnt(12) lgkmcnt(0)
s_barrier
ds_write_b128 v32, v[80:83] offset:49152
ds_write_b128 v32, v[84:87] offset:50176
ds_write_b128 v32, v[88:91] offset:51200
ds_write_b128 v32, v[92:95] offset:52224
v_add_u32 v48, 65536, v46
ds_read_b64_tr_b16 v[64:65], v48
ds_read_b64_tr_b16 v[66:67], v48 offset:512
ds_read_b64_tr_b16 v[68:69], v48 offset:8192
ds_read_b64_tr_b16 v[70:71], v48 offset:8704
ds_read_b64_tr_b16 v[72:73], v48 offset:8
ds_read_b64_tr_b16 v[74:75], v48 offset:520
ds_read_b64_tr_b16 v[76:77], v48 offset:8200
ds_read_b64_tr_b16 v[78:79], v48 offset:8712
s_waitcnt vmcnt(8) lgkmcnt(0)
s_barrier
ds_write_b128 v33, v[64:67]
ds_write_b128 v33, v[68:71] offset:1024
ds_write_b128 v33, v[72:75] offset:2048
ds_write_b128 v33, v[76:79] offset:3072
v_add_u32 v48, 81920, v46
ds_read_b64_tr_b16 v[80:81], v48
ds_read_b64_tr_b16 v[82:83], v48 offset:512
ds_read_b64_tr_b16 v[84:85], v48 offset:8192
ds_read_b64_tr_b16 v[86:87], v48 offset:8704
ds_read_b64_tr_b16 v[88:89], v48 offset:8
ds_read_b64_tr_b16 v[90:91], v48 offset:520
ds_read_b64_tr_b16 v[92:93], v48 offset:8200
ds_read_b64_tr_b16 v[94:95], v48 offset:8712
s_waitcnt vmcnt(4) lgkmcnt(0)
s_barrier
ds_write_b128 v33, v[80:83] offset:16384
ds_write_b128 v33, v[84:87] offset:17408
ds_write_b128 v33, v[88:91] offset:18432
ds_write_b128 v33, v[92:95] offset:19456
v_add_u32 v48, 98304, v46
ds_read_b64_tr_b16 v[64:65], v48
ds_read_b64_tr_b16 v[66:67], v48 offset:512
ds_read_b64_tr_b16 v[68:69], v48 offset:8192
ds_read_b64_tr_b16 v[70:71], v48 offset:8704
ds_read_b64_tr_b16 v[72:73], v48 offset:8
ds_read_b64_tr_b16 v[74:75], v48 offset:520
ds_read_b64_tr_b16 v[76:77], v48 offset:8200
ds_read_b64_tr_b16 v[78:79], v48 offset:8712
s_waitcnt vmcnt(0) lgkmcnt(0)
s_barrier
ds_write_b128 v33, v[64:67] offset:32768
ds_write_b128 v33, v[68:71] offset:33792
ds_write_b128 v33, v[72:75] offset:34816
ds_write_b128 v33, v[76:79] offset:35840
v_add_u32 v48, 114688, v46
ds_read_b64_tr_b16 v[80:81], v48
ds_read_b64_tr_b16 v[82:83], v48 offset:512
ds_read_b64_tr_b16 v[84:85], v48 offset:8192
ds_read_b64_tr_b16 v[86:87], v48 offset:8704
ds_read_b64_tr_b16 v[88:89], v48 offset:8
ds_read_b64_tr_b16 v[90:91], v48 offset:520
ds_read_b64_tr_b16 v[92:93], v48 offset:8200
ds_read_b64_tr_b16 v[94:95], v48 offset:8712
s_waitcnt lgkmcnt(0)
s_barrier
ds_write_b128 v33, v[80:83] offset:49152
ds_write_b128 v33, v[84:87] offset:50176
ds_write_b128 v33, v[88:91] offset:51200
ds_write_b128 v33, v[92:95] offset:52224
s_waitcnt lgkmcnt(0)
s_branch L_rf_iw1
L_rf_iw:
buffer_load_dword v58, off, s[12:15], 0 offset:204 sc1
s_waitcnt vmcnt(0)
L_rf_iw1:
v_and_b32 v50, 0xffff, v58
v_readfirstlane_b32 s60, v58
v_cmp_ne_u32 vcc, s100, v50
s_cbranch_vccnz L_rf_iw
s_lshr_b32 s60, s60, 15
s_cmp_gt_u32 s60, s100
s_cselect_b32 s60, 8192, 0
s_bfe_u32 s22, s31, 0x10001
s_lshl_b32 s22, s22, 12
s_add_u32 s22, s22, s60
s_lshl_b32 s23, s20, 10
s_add_u32 s22, s22, s23
s_add_u32 s38, s38, s22
s_add_u32 s37, s37, s22
s_xor_b32 s40, s38, 4096
s_xor_b32 s39, s37, 4096
s_xor_b32 s36, s35, 16384
s_mov_b32 s21, 0
s_cmp_eq_u32 s30, 0
s_mov_b32 s22, 0x33003300
s_cselect_b32 s16, 0x00330033, s22
s_mov_b32 s17, s16
s_cselect_b32 s18, -1, 0
s_not_b32 s19, s18
s_lshl_b32 s22, s31, 13
s_lshl_b32 s23, s20, 11
s_add_u32 s22, s22, s23
s_add_u32 s43, s22, 16777216
s_add_u32 s44, s22, 33554432
s_lshl_b32 s45, s31, 13
s_add_u32 s45, s45, 178257920
s_mul_i32 s48, s20, 5120
s_add_u32 m0, s48, 140288
s_mov_b32 s41, 1
s_mov_b32 s42, 1
v_mov_b32 v0, v34
v_bfrev_b32 v12, 1
v_bfrev_b32 v3, 1
v_cndmask_b32 v10, v3, v10, s[16:17]
v_cndmask_b32 v9, v3, v9, s[26:27]
s_sub_u32 s45, s45, 0
s_lshl_b32 s51, s30, 11
s_add_u32 s51, s51, s45
s_mov_b32 s50, 0
s_cmp_lg_u32 s20, 3
s_cbranch_scc1 L_rf_kv0
v_readlane_b32 s50, v57, 0
v_readlane_b32 s22, v57, 2
v_readlane_b32 s23, v57, 1
v_readlane_b32 s24, v57, 3
s_nop 3
s_min_u32 s50, s50, s22
s_min_u32 s23, s23, s24
s_lshl_b32 s50, s50, 1
s_lshl_b32 s23, s23, 1
s_add_u32 s23, s23, 1
s_min_u32 s50, s50, s23
L_rf_kvb0:
s_add_u32 s22, s21, 1
s_min_u32 s22, s22, 63
s_cmp_gt_u32 s50, s22
s_cbranch_scc1 L_rf_kvd0
buffer_load_dword v48, v7, s[4:7], 0 offen sc1
s_waitcnt vmcnt(0)
v_readlane_b32 s50, v48, 0
v_readlane_b32 s22, v48, 2
v_readlane_b32 s23, v48, 1
v_readlane_b32 s24, v48, 3
s_nop 3
s_min_u32 s50, s50, s22
s_min_u32 s23, s23, s24
s_lshl_b32 s50, s50, 1
s_lshl_b32 s23, s23, 1
s_add_u32 s23, s23, 1
s_min_u32 s50, s50, s23
s_branch L_rf_kvb0
L_rf_kvd0:
L_rf_kv0:
s_barrier
s_cmp_eq_u32 s20, 1
s_cbranch_scc1 L_rf_w1_entry
s_cmp_eq_u32 s20, 2
s_cbranch_scc1 L_rf_w2_entry
s_cmp_eq_u32 s20, 3
s_cbranch_scc1 L_rf_w3_entry
L_rf_w0_entry:
v_mfma_f32_32x32x8_bf16 v[96:111], v[14:15], v[14:15], 0
v_mfma_f32_16x16x16_bf16 v[112:115], v[14:15], v[14:15], 0
v_mfma_f32_16x16x16_bf16 v[116:119], v[14:15], v[14:15], 0
ds_read_b128 v[64:67], v1
ds_read_b128 v[68:71], v1 offset:1024
ds_read_b128 v[72:75], v1 offset:2048
ds_read_b128 v[76:79], v1 offset:3072
ds_read_b128 v[80:83], v1 offset:16384
ds_read_b128 v[84:87], v1 offset:17408
ds_read_b128 v[88:91], v1 offset:18432
ds_read_b128 v[92:95], v1 offset:19456
buffer_load_dwordx4 v[120:123], v1, s[4:7], s44 offen sc1
buffer_load_dwordx4 v[124:127], v1, s[4:7], s44 offen offset:1024 sc1
s_add_u32 s44, s44, 262144
L_rf_w0_loop:
s_add_u32 s22, s35, 0
s_waitcnt vmcnt(0)
buffer_load_dwordx4 v[32:35], v1, s[4:7], s22 offen sc1
buffer_load_dwordx4 v[36:39], v1, s[4:7], s22 offen offset:1024 sc1
L_rf_w0_pa:
s_waitcnt vmcnt(1)
ds_write_b128 v6, v[32:35]
s_waitcnt vmcnt(0)
ds_write_b128 v6, v[36:39] offset:1024
v_max3_u32 v3, v32, v34, v36
v_max_u32 v3, v3, v38
v_cmp_eq_u32 vcc, -1, v3
v_smfmac_f32_16x16x64_bf16 v[96:99], v[32:35], a[0:7], v2
buffer_load_dwordx4 v[32:35], v1, s[4:7], s22 offen sc1
v_smfmac_f32_16x16x64_bf16 v[100:103], v[32:35], a[8:15], v2
buffer_load_dwordx4 v[36:39], v1, s[4:7], s22 offen offset:1024 sc1
v_smfmac_f32_16x16x64_bf16 v[104:107], v[32:35], a[128:135], v2
s_cbranch_vccnz L_rf_w0_pafail
s_waitcnt lgkmcnt(0)
s_barrier
ds_read_b128 v[40:43], v6 offset:2048
ds_read_b128 v[44:47], v6 offset:3072
v_smfmac_f32_16x16x64_bf16 v[108:111], v[32:35], a[136:143], v2
ds_read_b128 v[48:51], v6 offset:4096
v_smfmac_f32_16x16x64_bf16 v[96:99], v[36:39], a[16:23], v2
ds_read_b128 v[52:55], v6 offset:5120
v_smfmac_f32_16x16x64_bf16 v[100:103], v[36:39], a[24:31], v2
ds_read_b128 v[56:59], v6 offset:6144
v_smfmac_f32_16x16x64_bf16 v[104:107], v[36:39], a[144:151], v2
ds_read_b128 v[60:63], v6 offset:7168
v_smfmac_f32_16x16x64_bf16 v[108:111], v[36:39], a[152:159], v2
buffer_load_dwordx4 v1, s[4:7], s43 offen sc1 lds
s_waitcnt lgkmcnt(5)
v_smfmac_f32_16x16x64_bf16 v[96:99], v[40:43], a[32:39], v2
v_smfmac_f32_16x16x64_bf16 v[104:107], v[40:43], a[160:167], v2
s_waitcnt lgkmcnt(4)
v_smfmac_f32_16x16x64_bf16 v[96:99], v[44:47], a[48:55], v2
v_smfmac_f32_16x16x64_bf16 v[104:107], v[44:47], a[176:183], v2
buffer_load_dwordx4 v1, s[4:7], s43 offen offset:1024 sc1 lds
s_waitcnt lgkmcnt(3)
v_smfmac_f32_16x16x64_bf16 v[96:99], v[48:51], a[64:71], v2
v_smfmac_f32_16x16x64_bf16 v[104:107], v[48:51], a[192:199], v2
s_waitcnt lgkmcnt(2)
v_smfmac_f32_16x16x64_bf16 v[96:99], v[52:55], a[80:87], v2
v_smfmac_f32_16x16x64_bf16 v[104:107], v[52:55], a[208:215], v2
v_mov_b32 v4, s21
buffer_store_dword v4, v7, s[4:7], 0 offen sc1
s_waitcnt lgkmcnt(1)
v_smfmac_f32_16x16x64_bf16 v[96:99], v[56:59], a[96:103], v2
v_smfmac_f32_16x16x64_bf16 v[104:107], v[56:59], a[224:231], v2
s_waitcnt lgkmcnt(0)
v_smfmac_f32_16x16x64_bf16 v[96:99], v[60:63], a[112:119], v2
v_smfmac_f32_16x16x64_bf16 v[104:107], v[60:63], a[240:247], v2
v_smfmac_f32_16x16x64_bf16 v[100:103], v[40:43], a[40:47], v2
s_nop 2
v_smfmac_f32_16x16x64_bf16 v[100:103], v[44:47], a[56:63], v2
s_nop 1
v_add_f32 v96, v96, v98
v_smfmac_f32_16x16x64_bf16 v[100:103], v[48:51], a[72:79], v2
v_add_f32 v97, v97, v99
v_add_f32 v104, v104, v106
v_smfmac_f32_16x16x64_bf16 v[100:103], v[52:55], a[88:95], v2
v_add_f32 v105, v105, v107
v_cvt_pk_bf16_f32 v96, v96, v97
v_smfmac_f32_16x16x64_bf16 v[100:103], v[56:59], a[104:111], v2
v_cvt_pk_bf16_f32 v97, v104, v105
v_and_or_b32 v96, v96, -2, s41
v_smfmac_f32_16x16x64_bf16 v[100:103], v[60:63], a[120:127], v2
buffer_store_dwordx2 v[96:97], v11, s[4:7], s37 offen sc1
v_smfmac_f32_16x16x64_bf16 v[108:111], v[40:43], a[168:175], v2
v_smfmac_f32_16x16x64_bf16 v[108:111], v[44:47], a[184:191], v2
v_smfmac_f32_16x16x64_bf16 v[108:111], v[48:51], a[200:207], v2
v_smfmac_f32_16x16x64_bf16 v[108:111], v[52:55], a[216:223], v2
v_smfmac_f32_16x16x64_bf16 v[108:111], v[56:59], a[232:239], v2
s_nop 2
v_add_f32 v100, v100, v102
v_smfmac_f32_16x16x64_bf16 v[108:111], v[60:63], a[248:255], v2
v_add_f32 v101, v101, v103
v_cvt_pk_bf16_f32 v98, v100, v101
v_and_or_b32 v98, v98, -2, s41
s_nop 4
v_pk_add_f32 v[108:109], v[108:109], v[110:111]
v_cvt_pk_bf16_f32 v99, v108, v109
buffer_store_dwordx2 v[98:99], v11, s[4:7], s37 offen offset:512 sc1
v_smfmac_f32_16x16x64_bf16 v[112:115], v[32:35], v[64:71], v2
ds_read_b128 v[64:67], v1 offset:32768
ds_read_b128 v[68:71], v1 offset:33792
v_smfmac_f32_16x16x64_bf16 v[116:119], v[32:35], v[72:79], v2
ds_read_b128 v[72:75], v1 offset:34816
ds_read_b128 v[76:79], v1 offset:35840
v_smfmac_f32_16x16x64_bf16 v[112:115], v[36:39], v[80:87], v2
ds_read_b128 v[80:83], v1 offset:49152
ds_read_b128 v[84:87], v1 offset:50176
v_smfmac_f32_16x16x64_bf16 v[116:119], v[36:39], v[88:95], v2
ds_read_b128 v[88:91], v1 offset:51200
ds_read_b128 v[92:95], v1 offset:52224
s_waitcnt lgkmcnt(6)
v_smfmac_f32_16x16x64_bf16 v[112:115], v[40:43], v[64:71], v2
ds_read_b128 v[64:67], v5
ds_read_b128 v[68:71], v5 offset:1024
s_waitcnt lgkmcnt(6)
v_smfmac_f32_16x16x64_bf16 v[116:119], v[40:43], v[72:79], v2
ds_read_b128 v[72:75], v5 offset:2048
ds_read_b128 v[76:79], v5 offset:3072
s_waitcnt lgkmcnt(6)
v_smfmac_f32_16x16x64_bf16 v[112:115], v[44:47], v[80:87], v2
ds_read_b128 v[80:83], v5 offset:16384
ds_read_b128 v[84:87], v5 offset:17408
s_waitcnt lgkmcnt(6)
v_smfmac_f32_16x16x64_bf16 v[116:119], v[44:47], v[88:95], v2
ds_read_b128 v[88:91], v5 offset:18432
ds_read_b128 v[92:95], v5 offset:19456
s_waitcnt lgkmcnt(6)
v_smfmac_f32_16x16x64_bf16 v[112:115], v[48:51], v[64:71], v2
ds_read_b128 v[64:67], v5 offset:32768
ds_read_b128 v[68:71], v5 offset:33792
s_waitcnt lgkmcnt(6)
v_smfmac_f32_16x16x64_bf16 v[116:119], v[48:51], v[72:79], v2
ds_read_b128 v[72:75], v5 offset:34816
ds_read_b128 v[76:79], v5 offset:35840
s_waitcnt lgkmcnt(6)
v_smfmac_f32_16x16x64_bf16 v[112:115], v[52:55], v[80:87], v2
ds_read_b128 v[80:83], v5 offset:49152
ds_read_b128 v[84:87], v5 offset:50176
s_waitcnt lgkmcnt(6)
v_smfmac_f32_16x16x64_bf16 v[116:119], v[52:55], v[88:95], v2
ds_read_b128 v[88:91], v5 offset:51200
ds_read_b128 v[92:95], v5 offset:52224
s_waitcnt lgkmcnt(6)
v_smfmac_f32_16x16x64_bf16 v[112:115], v[56:59], v[64:71], v2
s_waitcnt lgkmcnt(4)
v_smfmac_f32_16x16x64_bf16 v[116:119], v[56:59], v[72:79], v2
s_waitcnt lgkmcnt(2)
v_smfmac_f32_16x16x64_bf16 v[112:115], v[60:63], v[80:87], v2
s_waitcnt lgkmcnt(0)
v_smfmac_f32_16x16x64_bf16 v[116:119], v[60:63], v[88:95], v2
buffer_load_dwordx2 v[108:109], v11, s[4:7], s38 offen sc1
v_mfma_f32_16x16x16_bf16 v[100:103], v[96:97], v[16:17], 0
v_mfma_f32_16x16x16_bf16 v[104:107], v[98:99], v[16:17], 0
s_nop 4
v_add_f32 v112, v112, v114
v_add_f32 v113, v113, v115
v_add_f32 v114, v116, v118
v_add_f32 v115, v117, v119
v_cvt_pk_bf16_f32 v18, v112, v113
v_cvt_pk_bf16_f32 v19, v114, v115
v_and_or_b32 v18, v18, -2, s41
buffer_load_dwordx2 v[110:111], v11, s[4:7], s38 offen offset:512 sc1
s_barrier
buffer_store_dwordx2 v[18:19], v11, s[4:7], s39 offen sc1
v_mov_b32 v112, v18
v_mov_b32 v114, v19
v_mov_b32 v92, v28
v_mov_b32 v93, 0
s_waitcnt vmcnt(6)
s_barrier
ds_read_b128 v[32:35], v6 offset:9216
ds_read_b128 v[36:39], v6 offset:10240
ds_read_b128 v[40:43], v6 offset:14336
ds_read_b128 v[44:47], v6 offset:15360
ds_read_b128 v[48:51], v6 offset:19456
ds_read_b128 v[52:55], v6 offset:20480
ds_read_b128 v[56:59], v6 offset:24576
ds_read_b128 v[60:63], v6 offset:25600
buffer_load_dwordx2 v[20:21], v11, s[4:7], s38 offen sc1
buffer_load_dwordx2 v[22:23], v11, s[4:7], s38 offen offset:512 sc1
s_waitcnt vmcnt(4)
v_mfma_f32_16x16x16_bf16 v[80:83], v[108:109], v[16:17], v[100:103]
v_and_b32 v3, 1, v108
v_cmp_ne_u32 vcc, s41, v3
s_nop 5
v_cvt_pk_bf16_f32 v64, v80, v81
v_cvt_pk_bf16_f32 v65, v82, v83
s_cbranch_vccnz L_rf_w0_xslow
s_waitcnt vmcnt(3)
v_mfma_f32_16x16x16_bf16 v[84:87], v[110:111], v[16:17], v[104:107]
v_and_b32 v3, 1, v110
v_cmp_ne_u32 vcc, s41, v3
s_nop 5
v_cvt_pk_bf16_f32 v66, v84, v85
v_cvt_pk_bf16_f32 v67, v86, v87
ds_write_b128 v6, v[64:67] offset:8192
s_cbranch_vccnz L_rf_w0_xslow
L_rf_w0_xok:
s_cmp_eq_u32 s21, 63
s_cbranch_scc1 L_rf_w0_last
buffer_load_dwordx2 v[116:117], v11, s[4:7], s40 offen sc1
s_waitcnt lgkmcnt(1)
v_mfma_f32_16x16x32_bf16 v[80:83], v[32:35], v[64:67], 0
s_waitcnt lgkmcnt(0)
s_barrier
ds_read_b128 v[68:71], v6 offset:13312
ds_read_b128 v[72:75], v6 offset:18432
ds_read_b128 v[76:79], v6 offset:23552
v_mfma_f32_16x16x32_bf16 v[84:87], v[36:39], v[64:67], 0
v_mfma_f32_16x16x32_bf16 v[88:91], v[64:67], v[64:67], 0
buffer_load_dwordx2 v[20:21], v11, s[4:7], s40 offen sc1
s_waitcnt lgkmcnt(2)
v_mfma_f32_16x16x32_bf16 v[80:83], v[40:43], v[68:71], v[80:83]
buffer_store_dwordx4 v[64:67], v10, s[4:7], s45 offen sc1
s_waitcnt lgkmcnt(1)
v_mfma_f32_16x16x32_bf16 v[80:83], v[48:51], v[72:75], v[80:83]
s_waitcnt lgkmcnt(0)
v_mfma_f32_16x16x32_bf16 v[80:83], v[56:59], v[76:79], v[80:83]
v_mfma_f32_16x16x32_bf16 v[84:87], v[44:47], v[68:71], v[84:87]
v_mfma_f32_16x16x32_bf16 v[84:87], v[52:55], v[72:75], v[84:87]
buffer_store_dwordx2 v[18:19], v11, s[4:7], s51 offen offset:2048 sc1
v_mfma_f32_16x16x32_bf16 v[84:87], v[60:63], v[76:79], v[84:87]
v_mfma_f32_16x16x32_bf16 v[88:91], v[68:71], v[68:71], v[88:91]
v_mfma_f32_16x16x32_bf16 v[88:91], v[72:75], v[72:75], v[88:91]
v_mfma_f32_16x16x32_bf16 v[88:91], v[76:79], v[76:79], v[88:91]
v_mfma_f32_32x32x4_2b_bf16 v[32:63], v[14:15], v[14:15], 0
s_nop 0
v_max3_f32 v4, v80, v81, v82
s_nop 1
v_max3_f32 v4, v4, v83, v84
v_max3_f32 v4, v4, v85, v86
v_max_f32 v4, v4, v87
v_max3_f32 v90, v4, v88, v89
v_max3_f32 v4, v4, v88, v89
s_nop 1
v_permlane16_swap_b32 v4, v90
v_max_f32 v4, v4, v90
v_max_f32 v90, v4, v90
s_nop 1
v_permlane32_swap_b32 v4, v90
v_max_f32 v4, v4, v90
v_mul_f32 v4, s34, v4
v_pk_fma_f32 v[80:81], v[80:81], s[34:35], v[4:5] op_sel_hi:[1,0,0] neg_lo:[0,0,1] neg_hi:[0,0,1]
v_pk_fma_f32 v[82:83], v[82:83], s[34:35], v[4:5] op_sel_hi:[1,0,0] neg_lo:[0,0,1] neg_hi:[0,0,1]
v_pk_fma_f32 v[84:85], v[84:85], s[34:35], v[4:5] op_sel_hi:[1,0,0] neg_lo:[0,0,1] neg_hi:[0,0,1]
v_pk_fma_f32 v[86:87], v[86:87], s[34:35], v[4:5] op_sel_hi:[1,0,0] neg_lo:[0,0,1] neg_hi:[0,0,1]
v_pk_fma_f32 v[88:89], v[88:89], s[34:35], v[4:5] op_sel_hi:[1,0,0] neg_lo:[0,0,1] neg_hi:[0,0,1]
v_exp_f32 v80, v80
v_exp_f32 v81, v81
v_exp_f32 v82, v82
v_cvt_pk_bf16_f32 v68, v80, v81
v_exp_f32 v83, v83
v_exp_f32 v84, v84
v_cvt_pk_bf16_f32 v69, v82, v83
v_exp_f32 v85, v85
v_exp_f32 v86, v86
v_cvt_pk_bf16_f32 v70, v84, v85
v_exp_f32 v87, v87
v_exp_f32 v88, v88
v_cvt_pk_bf16_f32 v71, v86, v87
v_exp_f32 v89, v89
s_waitcnt vmcnt(3)
v_mfma_f32_16x16x32_bf16 v[76:79], v[28:31], v[68:71], 0
v_and_b32 v3, 1, v116
v_cvt_pk_bf16_f32 v72, v88, v89
v_mfma_f32_16x16x32_bf16 v[100:103], v[120:123], v[68:71], 0
v_cmp_ne_u32 vcc, s41, v3
v_cvt_pk_bf16_f32 v73, v88, v89
v_mfma_f32_16x16x32_bf16 v[104:107], v[124:127], v[68:71], 0
v_mov_b32 v113, v116
v_mov_b32 v115, v117
v_mfma_f32_16x16x16_bf16 v[76:79], v[92:93], v[72:73], v[76:79]
s_cbranch_vccnz L_rf_w0_pv0
L_rf_w0_pv2:
v_mfma_f32_16x16x16_bf16 v[100:103], v[112:113], v[72:73], v[100:103]
v_mfma_f32_16x16x16_bf16 v[104:107], v[114:115], v[72:73], v[104:107]
buffer_load_dwordx4 v[120:123], v1, s[4:7], s44 offen sc1
buffer_load_dwordx4 v[124:127], v1, s[4:7], s44 offen offset:1024 sc1
s_nop 2
v_rcp_f32 v76, v76
s_mov_b64 exec, s[28:29]
v_pk_mul_f32 v[100:101], v[100:101], v[76:77] op_sel_hi:[1,0]
v_pk_mul_f32 v[102:103], v[102:103], v[76:77] op_sel_hi:[1,0]
v_pk_mul_f32 v[104:105], v[104:105], v[76:77] op_sel_hi:[1,0]
v_pk_mul_f32 v[106:107], v[106:107], v[76:77] op_sel_hi:[1,0]
v_cvt_pk_bf16_f32 v84, v100, v101
v_cvt_pk_bf16_f32 v85, v102, v103
v_cvt_pk_bf16_f32 v86, v104, v105
v_cvt_pk_bf16_f32 v87, v106, v107
ds_write_b128 v6, v[84:87] offset:28640
s_mov_b64 exec, -1
s_waitcnt lgkmcnt(0)
s_barrier
ds_read_b128 v[68:71], v6 offset:28672
ds_read_b128 v[72:75], v6 offset:29696
s_waitcnt lgkmcnt(1)
v_smfmac_f32_16x16x64_bf16 v[32:35], v[68:71], v[128:135], v2
s_add_u32 s21, s21, 1
s_xor_b32 s38, s38, 1048576
s_xor_b32 s37, s37, 1048576
s_waitcnt lgkmcnt(0)
v_smfmac_f32_16x16x64_bf16 v[32:35], v[72:75], v[136:143], v2
s_xor_b32 s40, s40, 1048576
s_xor_b32 s39, s39, 1048576
s_lshr_b32 s41, s21, 1
v_smfmac_f32_16x16x64_bf16 v[36:39], v[68:71], v[144:151], v2
s_and_b32 s41, s41, 1
s_xor_b32 s41, s41, 1
s_xor_b32 s35, s35, 16384
v_smfmac_f32_16x16x64_bf16 v[36:39], v[72:75], v[152:159], v2
v_add_f32 v32, v32, v34
s_xor_b32 s36, s36, 16384
s_add_u32 s43, s43, 262144
s_add_u32 s44, s44, 262144
v_smfmac_f32_16x16x64_bf16 v[40:43], v[68:71], v[160:167], v2
v_add_f32 v33, v33, v35
v_smfmac_f32_16x16x64_bf16 v[40:43], v[72:75], v[168:175], v2
v_cvt_pk_bf16_f32 v32, v32, v33
v_smfmac_f32_16x16x64_bf16 v[44:47], v[68:71], v[176:183], v2
v_and_or_b32 v32, v32, -2, s42
v_smfmac_f32_16x16x64_bf16 v[44:47], v[72:75], v[184:191], v2
v_add_f32 v36, v36, v38
v_smfmac_f32_16x16x64_bf16 v[48:51], v[68:71], v[192:199], v2
v_add_f32 v37, v37, v39
v_smfmac_f32_16x16x64_bf16 v[48:51], v[72:75], v[200:207], v2
v_cvt_pk_bf16_f32 v33, v36, v37
v_smfmac_f32_16x16x64_bf16 v[52:55], v[68:71], v[208:215], v2
v_add_f32 v40, v40, v42
v_smfmac_f32_16x16x64_bf16 v[52:55], v[72:75], v[216:223], v2
v_add_f32 v41, v41, v43
v_smfmac_f32_16x16x64_bf16 v[56:59], v[68:71], v[224:231], v2
v_cvt_pk_bf16_f32 v34, v40, v41
v_smfmac_f32_16x16x64_bf16 v[56:59], v[72:75], v[232:239], v2
v_add_f32 v44, v44, v46
v_smfmac_f32_16x16x64_bf16 v[60:63], v[68:71], v[240:247], v2
v_add_f32 v45, v45, v47
v_smfmac_f32_16x16x64_bf16 v[60:63], v[72:75], v[248:255], v2
v_cvt_pk_bf16_f32 v35, v44, v45
buffer_store_dwordx4 v[32:35], v8, s[4:7], s46 offen
v_pk_add_f32 v[48:49], v[48:49], v[50:51]
v_cvt_pk_bf16_f32 v48, v48, v49
v_and_or_b32 v48, v48, -2, s42
v_pk_add_f32 v[52:53], v[52:53], v[54:55]
v_cvt_pk_bf16_f32 v49, v52, v53
v_pk_add_f32 v[56:57], v[56:57], v[58:59]
v_cvt_pk_bf16_f32 v50, v56, v57
v_pk_add_f32 v[60:61], v[60:61], v[62:63]
v_cvt_pk_bf16_f32 v51, v60, v61
buffer_store_dwordx4 v[48:51], v8, s[4:7], s61 offen
s_add_u32 s45, s45, 262144
s_add_u32 s51, s51, 262144
v_mfma_f32_32x32x8_bf16 v[96:111], v[14:15], v[14:15], 0
v_mfma_f32_16x16x16_bf16 v[112:115], v[14:15], v[14:15], 0
v_mfma_f32_16x16x16_bf16 v[116:119], v[14:15], v[14:15], 0
ds_read_b128 v[64:67], v1
ds_read_b128 v[68:71], v1 offset:1024
ds_read_b128 v[72:75], v1 offset:2048
ds_read_b128 v[76:79], v1 offset:3072
ds_read_b128 v[80:83], v1 offset:16384
ds_read_b128 v[84:87], v1 offset:17408
ds_read_b128 v[88:91], v1 offset:18432
ds_read_b128 v[92:95], v1 offset:19456
v_mov_b32 v58, -1
v_mov_b32 v59, -1
s_waitcnt vmcnt(0)
L_rf_w0_cgo:
L_rf_w0_pc:
buffer_load_dword v36, v13, s[4:7], s25 offen sc1
buffer_load_dword v37, v13, s[4:7], s25 offen offset:256 sc1
buffer_load_dword v38, v13, s[4:7], s25 offen offset:512 sc1
buffer_load_dword v39, v13, s[4:7], s25 offen offset:768 sc1
buffer_load_dword v40, v13, s[4:7], s25 offen offset:1024 sc1
buffer_load_dword v41, v13, s[4:7], s25 offen offset:1280 sc1
buffer_load_dword v42, v13, s[4:7], s25 offen offset:1536 sc1
buffer_load_dword v43, v13, s[4:7], s25 offen offset:1792 sc1
s_waitcnt vmcnt(4)
v_mfma_f32_16x16x32_bf16 v[52:55], v[36:39], v[24:27], 0
v_bitop3_b32 v3, s42, v36, v37 bitop3:0x7e
v_bitop3_b32 v4, s42, v38, v39 bitop3:0x7e
s_waitcnt vmcnt(2)
v_or_b32 v3, v3, v4
v_bitop3_b32 v4, s42, v40, v41 bitop3:0x7e
s_waitcnt vmcnt(0)
v_mfma_f32_16x16x32_bf16 v[52:55], v[40:43], v[24:27], v[52:55]
v_bitop3_b32 v56, s42, v42, v43 bitop3:0x7e
v_or3_b32 v3, v3, v4, v56
v_and_b32 v3, v0, v3
v_cmp_ne_u32 vcc, 0, v3
s_nop 3
v_cvt_pk_bf16_f32 v56, v52, v53
v_cvt_pk_bf16_f32 v57, v54, v55
v_min_u32 v56, -2, v56
s_cbranch_vccnz L_rf_w0_pc
s_mov_b64 exec, s[26:27]
buffer_store_dwordx2 v[56:57], v9, s[4:7], s35 offen
buffer_store_dwordx2 v[58:59], v9, s[4:7], s36 offen
s_mov_b64 exec, -1
s_xor_b32 s42, s42, 1
s_branch L_rf_w0_loop
L_rf_w0_last:
buffer_store_dwordx4 v[64:67], v10, s[4:7], s45 offen sc1
buffer_store_dwordx2 v[18:19], v11, s[4:7], s51 offen offset:2048 sc1
s_branch L_rf_end
L_rf_w0_pafail:
s_nop 7
v_mov_b32 v96, 0
v_mov_b32 v97, 0
v_mov_b32 v98, 0
v_mov_b32 v99, 0
v_mov_b32 v100, 0
v_mov_b32 v101, 0
v_mov_b32 v102, 0
v_mov_b32 v103, 0
v_mov_b32 v104, 0
v_mov_b32 v105, 0
v_mov_b32 v106, 0
v_mov_b32 v107, 0
s_branch L_rf_w0_pa
L_rf_w0_xslow:
buffer_load_dwordx2 v[108:109], v11, s[4:7], s38 offen sc1
buffer_load_dwordx2 v[110:111], v11, s[4:7], s38 offen offset:512 sc1
s_waitcnt vmcnt(2)
v_bitop3_b32 v3, s41, v20, v22 bitop3:0x7e
v_mfma_f32_16x16x16_bf16 v[80:83], v[20:21], v[16:17], v[100:103]
v_and_b32 v3, 1, v3
v_mfma_f32_16x16x16_bf16 v[84:87], v[22:23], v[16:17], v[104:107]
v_cmp_ne_u32 vcc, 0, v3
s_cbranch_vccz L_rf_w0_xgot
buffer_load_dwordx2 v[20:21], v11, s[4:7], s38 offen sc1
buffer_load_dwordx2 v[22:23], v11, s[4:7], s38 offen offset:512 sc1
s_waitcnt vmcnt(2)
v_bitop3_b32 v3, s41, v108, v110 bitop3:0x7e
v_mfma_f32_16x16x16_bf16 v[80:83], v[108:109], v[16:17], v[100:103]
v_and_b32 v3, 1, v3
v_mfma_f32_16x16x16_bf16 v[84:87], v[110:111], v[16:17], v[104:107]
v_cmp_ne_u32 vcc, 0, v3
s_cbranch_vccz L_rf_w0_xgot
s_branch L_rf_w0_xslow
L_rf_w0_xgot:
s_nop 3
v_cvt_pk_bf16_f32 v64, v80, v81
v_cvt_pk_bf16_f32 v65, v82, v83
v_cvt_pk_bf16_f32 v66, v84, v85
v_cvt_pk_bf16_f32 v67, v86, v87
ds_write_b128 v6, v[64:67] offset:8192
s_branch L_rf_w0_xok
L_rf_w0_pv0:
s_waitcnt vmcnt(2)
s_branch L_rf_w0_pv1
L_rf_w0_pv:
buffer_load_dwordx2 v[20:21], v11, s[4:7], s40 offen sc1
s_waitcnt vmcnt(0)
L_rf_w0_pv1:
v_and_b32 v3, 1, v20
v_cmp_ne_u32 vcc, s41, v3
v_mov_b32 v113, v20
v_mov_b32 v115, v21
s_cbranch_vccnz L_rf_w0_pv
s_branch L_rf_w0_pv2
L_rf_w1_entry:
v_mfma_f32_32x32x8_bf16 v[96:111], v[14:15], v[14:15], 0
v_mfma_f32_16x16x16_bf16 v[112:115], v[14:15], v[14:15], 0
v_mfma_f32_16x16x16_bf16 v[116:119], v[14:15], v[14:15], 0
ds_read_b128 v[64:67], v1 offset:4096
ds_read_b128 v[68:71], v1 offset:5120
ds_read_b128 v[72:75], v1 offset:6144
ds_read_b128 v[76:79], v1 offset:7168
ds_read_b128 v[80:83], v1 offset:20480
ds_read_b128 v[84:87], v1 offset:21504
ds_read_b128 v[88:91], v1 offset:22528
ds_read_b128 v[92:95], v1 offset:23552
buffer_load_dwordx4 v[120:123], v1, s[4:7], s44 offen sc1
buffer_load_dwordx4 v[124:127], v1, s[4:7], s44 offen offset:1024 sc1
s_add_u32 s44, s44, 262144
L_rf_w1_loop:
s_add_u32 s22, s35, 2048
s_waitcnt vmcnt(0)
buffer_load_dwordx4 v[40:43], v1, s[4:7], s22 offen sc1
buffer_load_dwordx4 v[44:47], v1, s[4:7], s22 offen offset:1024 sc1
L_rf_w1_pa:
s_waitcnt vmcnt(1)
ds_write_b128 v6, v[40:43] offset:2048
s_waitcnt vmcnt(0)
ds_write_b128 v6, v[44:47] offset:3072
v_max3_u32 v3, v40, v42, v44
v_max_u32 v3, v3, v46
v_cmp_eq_u32 vcc, -1, v3
v_smfmac_f32_16x16x64_bf16 v[96:99], v[40:43], a[32:39], v2
buffer_load_dwordx4 v[40:43], v1, s[4:7], s22 offen sc1
v_smfmac_f32_16x16x64_bf16 v[100:103], v[40:43], a[40:47], v2
buffer_load_dwordx4 v[44:47], v1, s[4:7], s22 offen offset:1024 sc1
v_smfmac_f32_16x16x64_bf16 v[104:107], v[40:43], a[160:167], v2
s_cbranch_vccnz L_rf_w1_pafail
s_waitcnt lgkmcnt(0)
s_barrier
ds_read_b128 v[48:51], v6 offset:4096
ds_read_b128 v[52:55], v6 offset:5120
v_smfmac_f32_16x16x64_bf16 v[108:111], v[40:43], a[168:175], v2
ds_read_b128 v[56:59], v6 offset:6144
v_smfmac_f32_16x16x64_bf16 v[96:99], v[44:47], a[48:55], v2
ds_read_b128 v[60:63], v6 offset:7168
v_smfmac_f32_16x16x64_bf16 v[100:103], v[44:47], a[56:63], v2
ds_read_b128 v[32:35], v6
v_smfmac_f32_16x16x64_bf16 v[104:107], v[44:47], a[176:183], v2
ds_read_b128 v[36:39], v6 offset:1024
v_smfmac_f32_16x16x64_bf16 v[108:111], v[44:47], a[184:191], v2
s_waitcnt lgkmcnt(5)
v_smfmac_f32_16x16x64_bf16 v[96:99], v[48:51], a[64:71], v2
buffer_load_dwordx4 v1, s[4:7], s43 offen sc1 lds
v_smfmac_f32_16x16x64_bf16 v[104:107], v[48:51], a[192:199], v2
s_waitcnt lgkmcnt(4)
v_smfmac_f32_16x16x64_bf16 v[96:99], v[52:55], a[80:87], v2
v_smfmac_f32_16x16x64_bf16 v[104:107], v[52:55], a[208:215], v2
s_waitcnt lgkmcnt(3)
v_smfmac_f32_16x16x64_bf16 v[96:99], v[56:59], a[96:103], v2
buffer_load_dwordx4 v1, s[4:7], s43 offen offset:1024 sc1 lds
v_smfmac_f32_16x16x64_bf16 v[104:107], v[56:59], a[224:231], v2
s_waitcnt lgkmcnt(2)
v_smfmac_f32_16x16x64_bf16 v[96:99], v[60:63], a[112:119], v2
v_smfmac_f32_16x16x64_bf16 v[104:107], v[60:63], a[240:247], v2
s_waitcnt lgkmcnt(1)
v_smfmac_f32_16x16x64_bf16 v[96:99], v[32:35], a[0:7], v2
v_smfmac_f32_16x16x64_bf16 v[104:107], v[32:35], a[128:135], v2
s_waitcnt lgkmcnt(0)
v_smfmac_f32_16x16x64_bf16 v[96:99], v[36:39], a[16:23], v2
v_smfmac_f32_16x16x64_bf16 v[104:107], v[36:39], a[144:151], v2
v_smfmac_f32_16x16x64_bf16 v[100:103], v[48:51], a[72:79], v2
s_nop 2
v_smfmac_f32_16x16x64_bf16 v[100:103], v[52:55], a[88:95], v2
s_nop 1
v_add_f32 v96, v96, v98
v_smfmac_f32_16x16x64_bf16 v[100:103], v[56:59], a[104:111], v2
v_add_f32 v97, v97, v99
v_add_f32 v104, v104, v106
v_smfmac_f32_16x16x64_bf16 v[100:103], v[60:63], a[120:127], v2
v_add_f32 v105, v105, v107
v_cvt_pk_bf16_f32 v96, v96, v97
v_smfmac_f32_16x16x64_bf16 v[100:103], v[32:35], a[8:15], v2
v_cvt_pk_bf16_f32 v97, v104, v105
v_and_or_b32 v96, v96, -2, s41
v_smfmac_f32_16x16x64_bf16 v[100:103], v[36:39], a[24:31], v2
buffer_store_dwordx2 v[96:97], v11, s[4:7], s37 offen sc1
v_smfmac_f32_16x16x64_bf16 v[108:111], v[48:51], a[200:207], v2
v_smfmac_f32_16x16x64_bf16 v[108:111], v[52:55], a[216:223], v2
v_smfmac_f32_16x16x64_bf16 v[108:111], v[56:59], a[232:239], v2
v_smfmac_f32_16x16x64_bf16 v[108:111], v[60:63], a[248:255], v2
v_smfmac_f32_16x16x64_bf16 v[108:111], v[32:35], a[136:143], v2
s_nop 2
v_add_f32 v100, v100, v102
v_smfmac_f32_16x16x64_bf16 v[108:111], v[36:39], a[152:159], v2
v_add_f32 v101, v101, v103
v_cvt_pk_bf16_f32 v98, v100, v101
v_and_or_b32 v98, v98, -2, s41
s_nop 4
v_pk_add_f32 v[108:109], v[108:109], v[110:111]
v_cvt_pk_bf16_f32 v99, v108, v109
buffer_store_dwordx2 v[98:99], v11, s[4:7], s37 offen offset:512 sc1
v_smfmac_f32_16x16x64_bf16 v[112:115], v[32:35], v[64:71], v2
ds_read_b128 v[64:67], v1 offset:36864
ds_read_b128 v[68:71], v1 offset:37888
v_smfmac_f32_16x16x64_bf16 v[116:119], v[32:35], v[72:79], v2
ds_read_b128 v[72:75], v1 offset:38912
ds_read_b128 v[76:79], v1 offset:39936
v_smfmac_f32_16x16x64_bf16 v[112:115], v[36:39], v[80:87], v2
ds_read_b128 v[80:83], v1 offset:53248
ds_read_b128 v[84:87], v1 offset:54272
v_smfmac_f32_16x16x64_bf16 v[116:119], v[36:39], v[88:95], v2
ds_read_b128 v[88:91], v1 offset:55296
ds_read_b128 v[92:95], v1 offset:56320
s_waitcnt lgkmcnt(6)
v_smfmac_f32_16x16x64_bf16 v[112:115], v[40:43], v[64:71], v2
ds_read_b128 v[64:67], v5 offset:4096
ds_read_b128 v[68:71], v5 offset:5120
s_waitcnt lgkmcnt(6)
v_smfmac_f32_16x16x64_bf16 v[116:119], v[40:43], v[72:79], v2
ds_read_b128 v[72:75], v5 offset:6144
ds_read_b128 v[76:79], v5 offset:7168
s_waitcnt lgkmcnt(6)
v_smfmac_f32_16x16x64_bf16 v[112:115], v[44:47], v[80:87], v2
ds_read_b128 v[80:83], v5 offset:20480
ds_read_b128 v[84:87], v5 offset:21504
s_waitcnt lgkmcnt(6)
v_smfmac_f32_16x16x64_bf16 v[116:119], v[44:47], v[88:95], v2
ds_read_b128 v[88:91], v5 offset:22528
ds_read_b128 v[92:95], v5 offset:23552
s_waitcnt lgkmcnt(6)
v_smfmac_f32_16x16x64_bf16 v[112:115], v[48:51], v[64:71], v2
ds_read_b128 v[64:67], v5 offset:36864
ds_read_b128 v[68:71], v5 offset:37888
s_waitcnt lgkmcnt(6)
v_smfmac_f32_16x16x64_bf16 v[116:119], v[48:51], v[72:79], v2
ds_read_b128 v[72:75], v5 offset:38912
ds_read_b128 v[76:79], v5 offset:39936
s_waitcnt lgkmcnt(6)
v_smfmac_f32_16x16x64_bf16 v[112:115], v[52:55], v[80:87], v2
ds_read_b128 v[80:83], v5 offset:53248
ds_read_b128 v[84:87], v5 offset:54272
s_waitcnt lgkmcnt(6)
v_smfmac_f32_16x16x64_bf16 v[116:119], v[52:55], v[88:95], v2
ds_read_b128 v[88:91], v5 offset:55296
ds_read_b128 v[92:95], v5 offset:56320
s_waitcnt lgkmcnt(6)
v_smfmac_f32_16x16x64_bf16 v[112:115], v[56:59], v[64:71], v2
s_waitcnt lgkmcnt(4)
v_smfmac_f32_16x16x64_bf16 v[116:119], v[56:59], v[72:79], v2
s_waitcnt lgkmcnt(2)
v_smfmac_f32_16x16x64_bf16 v[112:115], v[60:63], v[80:87], v2
s_waitcnt lgkmcnt(0)
v_smfmac_f32_16x16x64_bf16 v[116:119], v[60:63], v[88:95], v2
buffer_load_dwordx2 v[108:109], v11, s[4:7], s38 offen sc1
v_mfma_f32_16x16x16_bf16 v[100:103], v[96:97], v[16:17], 0
v_mfma_f32_16x16x16_bf16 v[104:107], v[98:99], v[16:17], 0
s_nop 4
v_add_f32 v112, v112, v114
v_add_f32 v113, v113, v115
v_add_f32 v114, v116, v118
v_add_f32 v115, v117, v119
v_cvt_pk_bf16_f32 v18, v112, v113
v_cvt_pk_bf16_f32 v19, v114, v115
v_and_or_b32 v18, v18, -2, s41
buffer_load_dwordx2 v[110:111], v11, s[4:7], s38 offen offset:512 sc1
s_barrier
buffer_store_dwordx2 v[18:19], v11, s[4:7], s39 offen sc1
v_mov_b32 v112, v18
v_mov_b32 v114, v19
v_mov_b32 v92, v28
v_mov_b32 v93, 0
s_waitcnt vmcnt(5)
s_barrier
ds_read_b128 v[32:35], v6 offset:14336
ds_read_b128 v[36:39], v6 offset:15360
ds_read_b128 v[40:43], v6 offset:9216
ds_read_b128 v[44:47], v6 offset:10240
ds_read_b128 v[48:51], v6 offset:24576
ds_read_b128 v[52:55], v6 offset:25600
ds_read_b128 v[56:59], v6 offset:19456
ds_read_b128 v[60:63], v6 offset:20480
buffer_load_dwordx2 v[20:21], v11, s[4:7], s38 offen sc1
buffer_load_dwordx2 v[22:23], v11, s[4:7], s38 offen offset:512 sc1
s_waitcnt vmcnt(4)
v_mfma_f32_16x16x16_bf16 v[80:83], v[108:109], v[16:17], v[100:103]
v_and_b32 v3, 1, v108
v_cmp_ne_u32 vcc, s41, v3
s_nop 5
v_cvt_pk_bf16_f32 v64, v80, v81
v_cvt_pk_bf16_f32 v65, v82, v83
s_cbranch_vccnz L_rf_w1_xslow
s_waitcnt vmcnt(3)
v_mfma_f32_16x16x16_bf16 v[84:87], v[110:111], v[16:17], v[104:107]
v_and_b32 v3, 1, v110
v_cmp_ne_u32 vcc, s41, v3
s_nop 5
v_cvt_pk_bf16_f32 v66, v84, v85
v_cvt_pk_bf16_f32 v67, v86, v87
ds_write_b128 v6, v[64:67] offset:13312
s_cbranch_vccnz L_rf_w1_xslow
L_rf_w1_xok:
s_cmp_eq_u32 s21, 63
s_cbranch_scc1 L_rf_w1_last
buffer_load_dwordx2 v[116:117], v11, s[4:7], s40 offen sc1
s_waitcnt lgkmcnt(1)
v_mfma_f32_16x16x32_bf16 v[80:83], v[32:35], v[64:67], 0
s_waitcnt lgkmcnt(0)
s_barrier
ds_read_b128 v[68:71], v6 offset:8192
ds_read_b128 v[72:75], v6 offset:23552
ds_read_b128 v[76:79], v6 offset:18432
v_mfma_f32_16x16x32_bf16 v[84:87], v[36:39], v[64:67], 0
v_mfma_f32_16x16x32_bf16 v[88:91], v[64:67], v[64:67], 0
buffer_load_dwordx2 v[20:21], v11, s[4:7], s40 offen sc1
s_waitcnt lgkmcnt(2)
v_mfma_f32_16x16x32_bf16 v[80:83], v[40:43], v[68:71], v[80:83]
s_waitcnt lgkmcnt(1)
v_mfma_f32_16x16x32_bf16 v[80:83], v[48:51], v[72:75], v[80:83]
buffer_store_dwordx4 v[64:67], v10, s[4:7], s45 offen offset:64 sc1
s_waitcnt lgkmcnt(0)
v_mfma_f32_16x16x32_bf16 v[80:83], v[56:59], v[76:79], v[80:83]
v_mfma_f32_16x16x32_bf16 v[84:87], v[44:47], v[68:71], v[84:87]
v_mfma_f32_16x16x32_bf16 v[84:87], v[52:55], v[72:75], v[84:87]
v_mfma_f32_16x16x32_bf16 v[84:87], v[60:63], v[76:79], v[84:87]
buffer_store_dwordx2 v[18:19], v11, s[4:7], s51 offen offset:2560 sc1
v_mfma_f32_16x16x32_bf16 v[88:91], v[68:71], v[68:71], v[88:91]
v_mfma_f32_16x16x32_bf16 v[88:91], v[72:75], v[72:75], v[88:91]
v_mfma_f32_16x16x32_bf16 v[88:91], v[76:79], v[76:79], v[88:91]
v_mfma_f32_32x32x4_2b_bf16 v[32:63], v[14:15], v[14:15], 0
s_nop 0
v_max3_f32 v4, v80, v81, v82
s_nop 1
v_max3_f32 v4, v4, v83, v84
v_max3_f32 v4, v4, v85, v86
v_max_f32 v4, v4, v87
v_max3_f32 v90, v4, v88, v89
v_max3_f32 v4, v4, v88, v89
s_nop 1
v_permlane16_swap_b32 v4, v90
v_max_f32 v4, v4, v90
v_max_f32 v90, v4, v90
s_nop 1
v_permlane32_swap_b32 v4, v90
v_max_f32 v4, v4, v90
v_mul_f32 v4, s34, v4
v_pk_fma_f32 v[80:81], v[80:81], s[34:35], v[4:5] op_sel_hi:[1,0,0] neg_lo:[0,0,1] neg_hi:[0,0,1]
v_pk_fma_f32 v[82:83], v[82:83], s[34:35], v[4:5] op_sel_hi:[1,0,0] neg_lo:[0,0,1] neg_hi:[0,0,1]
v_pk_fma_f32 v[84:85], v[84:85], s[34:35], v[4:5] op_sel_hi:[1,0,0] neg_lo:[0,0,1] neg_hi:[0,0,1]
v_pk_fma_f32 v[86:87], v[86:87], s[34:35], v[4:5] op_sel_hi:[1,0,0] neg_lo:[0,0,1] neg_hi:[0,0,1]
v_pk_fma_f32 v[88:89], v[88:89], s[34:35], v[4:5] op_sel_hi:[1,0,0] neg_lo:[0,0,1] neg_hi:[0,0,1]
v_exp_f32 v80, v80
v_exp_f32 v81, v81
v_exp_f32 v82, v82
v_cvt_pk_bf16_f32 v68, v80, v81
v_exp_f32 v83, v83
v_exp_f32 v84, v84
v_cvt_pk_bf16_f32 v69, v82, v83
v_exp_f32 v85, v85
v_exp_f32 v86, v86
v_cvt_pk_bf16_f32 v70, v84, v85
v_exp_f32 v87, v87
v_exp_f32 v88, v88
v_cvt_pk_bf16_f32 v71, v86, v87
v_exp_f32 v89, v89
s_waitcnt vmcnt(3)
v_mfma_f32_16x16x32_bf16 v[76:79], v[28:31], v[68:71], 0
v_and_b32 v3, 1, v116
v_cvt_pk_bf16_f32 v72, v88, v89
v_mfma_f32_16x16x32_bf16 v[100:103], v[120:123], v[68:71], 0
v_cmp_ne_u32 vcc, s41, v3
v_cvt_pk_bf16_f32 v73, v88, v89
v_mfma_f32_16x16x32_bf16 v[104:107], v[124:127], v[68:71], 0
v_mov_b32 v113, v116
v_mov_b32 v115, v117
v_mfma_f32_16x16x16_bf16 v[76:79], v[92:93], v[72:73], v[76:79]
s_cbranch_vccnz L_rf_w1_pv0
L_rf_w1_pv2:
v_mfma_f32_16x16x16_bf16 v[100:103], v[112:113], v[72:73], v[100:103]
v_mfma_f32_16x16x16_bf16 v[104:107], v[114:115], v[72:73], v[104:107]
buffer_load_dwordx4 v[120:123], v1, s[4:7], s44 offen sc1
buffer_load_dwordx4 v[124:127], v1, s[4:7], s44 offen offset:1024 sc1
s_nop 2
v_rcp_f32 v76, v76
s_mov_b64 exec, s[28:29]
v_pk_mul_f32 v[100:101], v[100:101], v[76:77] op_sel_hi:[1,0]
v_pk_mul_f32 v[102:103], v[102:103], v[76:77] op_sel_hi:[1,0]
v_pk_mul_f32 v[104:105], v[104:105], v[76:77] op_sel_hi:[1,0]
v_pk_mul_f32 v[106:107], v[106:107], v[76:77] op_sel_hi:[1,0]
v_cvt_pk_bf16_f32 v84, v100, v101
v_cvt_pk_bf16_f32 v85, v102, v103
v_cvt_pk_bf16_f32 v86, v104, v105
v_cvt_pk_bf16_f32 v87, v106, v107
ds_write_b128 v6, v[84:87] offset:28672
s_mov_b64 exec, -1
s_waitcnt lgkmcnt(0)
s_barrier
ds_read_b128 v[68:71], v6 offset:28672
ds_read_b128 v[72:75], v6 offset:29696
s_waitcnt lgkmcnt(1)
v_smfmac_f32_16x16x64_bf16 v[32:35], v[68:71], v[128:135], v2
s_add_u32 s21, s21, 1
s_xor_b32 s38, s38, 1048576
s_xor_b32 s37, s37, 1048576
s_waitcnt lgkmcnt(0)
v_smfmac_f32_16x16x64_bf16 v[32:35], v[72:75], v[136:143], v2
s_xor_b32 s40, s40, 1048576
s_xor_b32 s39, s39, 1048576
s_lshr_b32 s41, s21, 1
v_smfmac_f32_16x16x64_bf16 v[36:39], v[68:71], v[144:151], v2
s_and_b32 s41, s41, 1
s_xor_b32 s41, s41, 1
s_xor_b32 s35, s35, 16384
v_smfmac_f32_16x16x64_bf16 v[36:39], v[72:75], v[152:159], v2
v_add_f32 v32, v32, v34
s_xor_b32 s36, s36, 16384
s_add_u32 s43, s43, 262144
s_add_u32 s44, s44, 262144
v_smfmac_f32_16x16x64_bf16 v[40:43], v[68:71], v[160:167], v2
v_add_f32 v33, v33, v35
v_smfmac_f32_16x16x64_bf16 v[40:43], v[72:75], v[168:175], v2
v_cvt_pk_bf16_f32 v32, v32, v33
v_smfmac_f32_16x16x64_bf16 v[44:47], v[68:71], v[176:183], v2
v_and_or_b32 v32, v32, -2, s42
v_smfmac_f32_16x16x64_bf16 v[44:47], v[72:75], v[184:191], v2
v_add_f32 v36, v36, v38
v_smfmac_f32_16x16x64_bf16 v[48:51], v[68:71], v[192:199], v2
v_add_f32 v37, v37, v39
v_smfmac_f32_16x16x64_bf16 v[48:51], v[72:75], v[200:207], v2
v_cvt_pk_bf16_f32 v33, v36, v37
v_smfmac_f32_16x16x64_bf16 v[52:55], v[68:71], v[208:215], v2
v_add_f32 v40, v40, v42
v_smfmac_f32_16x16x64_bf16 v[52:55], v[72:75], v[216:223], v2
v_add_f32 v41, v41, v43
v_smfmac_f32_16x16x64_bf16 v[56:59], v[68:71], v[224:231], v2
v_cvt_pk_bf16_f32 v34, v40, v41
v_smfmac_f32_16x16x64_bf16 v[56:59], v[72:75], v[232:239], v2
v_add_f32 v44, v44, v46
v_smfmac_f32_16x16x64_bf16 v[60:63], v[68:71], v[240:247], v2
v_add_f32 v45, v45, v47
v_smfmac_f32_16x16x64_bf16 v[60:63], v[72:75], v[248:255], v2
v_cvt_pk_bf16_f32 v35, v44, v45
buffer_store_dwordx4 v[32:35], v8, s[4:7], s46 offen
v_pk_add_f32 v[48:49], v[48:49], v[50:51]
v_cvt_pk_bf16_f32 v48, v48, v49
v_and_or_b32 v48, v48, -2, s42
v_pk_add_f32 v[52:53], v[52:53], v[54:55]
v_cvt_pk_bf16_f32 v49, v52, v53
v_pk_add_f32 v[56:57], v[56:57], v[58:59]
v_cvt_pk_bf16_f32 v50, v56, v57
v_pk_add_f32 v[60:61], v[60:61], v[62:63]
v_cvt_pk_bf16_f32 v51, v60, v61
buffer_store_dwordx4 v[48:51], v8, s[4:7], s61 offen
s_add_u32 s45, s45, 262144
s_add_u32 s51, s51, 262144
v_mfma_f32_32x32x8_bf16 v[96:111], v[14:15], v[14:15], 0
v_mfma_f32_16x16x16_bf16 v[112:115], v[14:15], v[14:15], 0
v_mfma_f32_16x16x16_bf16 v[116:119], v[14:15], v[14:15], 0
ds_read_b128 v[64:67], v1 offset:4096
ds_read_b128 v[68:71], v1 offset:5120
ds_read_b128 v[72:75], v1 offset:6144
ds_read_b128 v[76:79], v1 offset:7168
ds_read_b128 v[80:83], v1 offset:20480
ds_read_b128 v[84:87], v1 offset:21504
ds_read_b128 v[88:91], v1 offset:22528
ds_read_b128 v[92:95], v1 offset:23552
v_mov_b32 v58, -1
v_mov_b32 v59, -1
s_waitcnt vmcnt(0)
L_rf_w1_cgo:
L_rf_w1_pc:
buffer_load_dword v36, v13, s[4:7], s25 offen sc1
buffer_load_dword v37, v13, s[4:7], s25 offen offset:256 sc1
buffer_load_dword v38, v13, s[4:7], s25 offen offset:512 sc1
buffer_load_dword v39, v13, s[4:7], s25 offen offset:768 sc1
buffer_load_dword v40, v13, s[4:7], s25 offen offset:1024 sc1
buffer_load_dword v41, v13, s[4:7], s25 offen offset:1280 sc1
buffer_load_dword v42, v13, s[4:7], s25 offen offset:1536 sc1
buffer_load_dword v43, v13, s[4:7], s25 offen offset:1792 sc1
s_waitcnt vmcnt(4)
v_mfma_f32_16x16x32_bf16 v[52:55], v[36:39], v[24:27], 0
v_bitop3_b32 v3, s42, v36, v37 bitop3:0x7e
v_bitop3_b32 v4, s42, v38, v39 bitop3:0x7e
s_waitcnt vmcnt(2)
v_or_b32 v3, v3, v4
v_bitop3_b32 v4, s42, v40, v41 bitop3:0x7e
s_waitcnt vmcnt(0)
v_mfma_f32_16x16x32_bf16 v[52:55], v[40:43], v[24:27], v[52:55]
v_bitop3_b32 v56, s42, v42, v43 bitop3:0x7e
v_or3_b32 v3, v3, v4, v56
v_and_b32 v3, v0, v3
v_cmp_ne_u32 vcc, 0, v3
s_nop 3
v_cvt_pk_bf16_f32 v56, v52, v53
v_cvt_pk_bf16_f32 v57, v54, v55
v_min_u32 v56, -2, v56
s_cbranch_vccnz L_rf_w1_pc
s_mov_b64 exec, s[26:27]
buffer_store_dwordx2 v[56:57], v9, s[4:7], s35 offen offset:256
buffer_store_dwordx2 v[58:59], v9, s[4:7], s36 offen offset:256
s_mov_b64 exec, -1
s_xor_b32 s42, s42, 1
s_branch L_rf_w1_loop
L_rf_w1_last:
buffer_store_dwordx4 v[64:67], v10, s[4:7], s45 offen offset:64 sc1
buffer_store_dwordx2 v[18:19], v11, s[4:7], s51 offen offset:2560 sc1
s_branch L_rf_end
L_rf_w1_pafail:
s_nop 7
v_mov_b32 v96, 0
v_mov_b32 v97, 0
v_mov_b32 v98, 0
v_mov_b32 v99, 0
v_mov_b32 v100, 0
v_mov_b32 v101, 0
v_mov_b32 v102, 0
v_mov_b32 v103, 0
v_mov_b32 v104, 0
v_mov_b32 v105, 0
v_mov_b32 v106, 0
v_mov_b32 v107, 0
s_branch L_rf_w1_pa
L_rf_w1_xslow:
buffer_load_dwordx2 v[108:109], v11, s[4:7], s38 offen sc1
buffer_load_dwordx2 v[110:111], v11, s[4:7], s38 offen offset:512 sc1
s_waitcnt vmcnt(2)
v_bitop3_b32 v3, s41, v20, v22 bitop3:0x7e
v_mfma_f32_16x16x16_bf16 v[80:83], v[20:21], v[16:17], v[100:103]
v_and_b32 v3, 1, v3
v_mfma_f32_16x16x16_bf16 v[84:87], v[22:23], v[16:17], v[104:107]
v_cmp_ne_u32 vcc, 0, v3
s_cbranch_vccz L_rf_w1_xgot
buffer_load_dwordx2 v[20:21], v11, s[4:7], s38 offen sc1
buffer_load_dwordx2 v[22:23], v11, s[4:7], s38 offen offset:512 sc1
s_waitcnt vmcnt(2)
v_bitop3_b32 v3, s41, v108, v110 bitop3:0x7e
v_mfma_f32_16x16x16_bf16 v[80:83], v[108:109], v[16:17], v[100:103]
v_and_b32 v3, 1, v3
v_mfma_f32_16x16x16_bf16 v[84:87], v[110:111], v[16:17], v[104:107]
v_cmp_ne_u32 vcc, 0, v3
s_cbranch_vccz L_rf_w1_xgot
s_branch L_rf_w1_xslow
L_rf_w1_xgot:
s_nop 3
v_cvt_pk_bf16_f32 v64, v80, v81
v_cvt_pk_bf16_f32 v65, v82, v83
v_cvt_pk_bf16_f32 v66, v84, v85
v_cvt_pk_bf16_f32 v67, v86, v87
ds_write_b128 v6, v[64:67] offset:13312
s_branch L_rf_w1_xok
L_rf_w1_pv0:
s_waitcnt vmcnt(2)
s_branch L_rf_w1_pv1
L_rf_w1_pv:
buffer_load_dwordx2 v[20:21], v11, s[4:7], s40 offen sc1
s_waitcnt vmcnt(0)
L_rf_w1_pv1:
v_and_b32 v3, 1, v20
v_cmp_ne_u32 vcc, s41, v3
v_mov_b32 v113, v20
v_mov_b32 v115, v21
s_cbranch_vccnz L_rf_w1_pv
s_branch L_rf_w1_pv2
L_rf_w2_entry:
v_mfma_f32_32x32x8_bf16 v[96:111], v[14:15], v[14:15], 0
v_mfma_f32_16x16x16_bf16 v[112:115], v[14:15], v[14:15], 0
v_mfma_f32_16x16x16_bf16 v[116:119], v[14:15], v[14:15], 0
ds_read_b128 v[64:67], v1 offset:8192
ds_read_b128 v[68:71], v1 offset:9216
ds_read_b128 v[72:75], v1 offset:10240
ds_read_b128 v[76:79], v1 offset:11264
ds_read_b128 v[80:83], v1 offset:24576
ds_read_b128 v[84:87], v1 offset:25600
ds_read_b128 v[88:91], v1 offset:26624
ds_read_b128 v[92:95], v1 offset:27648
buffer_load_dwordx4 v[120:123], v1, s[4:7], s44 offen sc1
buffer_load_dwordx4 v[124:127], v1, s[4:7], s44 offen offset:1024 sc1
s_add_u32 s44, s44, 262144
L_rf_w2_loop:
s_add_u32 s22, s35, 4096
s_waitcnt vmcnt(0)
buffer_load_dwordx4 v[48:51], v1, s[4:7], s22 offen sc1
buffer_load_dwordx4 v[52:55], v1, s[4:7], s22 offen offset:1024 sc1
L_rf_w2_pa:
s_waitcnt vmcnt(1)
ds_write_b128 v6, v[48:51] offset:4096
s_waitcnt vmcnt(0)
ds_write_b128 v6, v[52:55] offset:5120
v_max3_u32 v3, v48, v50, v52
v_max_u32 v3, v3, v54
v_cmp_eq_u32 vcc, -1, v3
v_smfmac_f32_16x16x64_bf16 v[96:99], v[48:51], a[64:71], v2
buffer_load_dwordx4 v[48:51], v1, s[4:7], s22 offen sc1
v_smfmac_f32_16x16x64_bf16 v[100:103], v[48:51], a[72:79], v2
buffer_load_dwordx4 v[52:55], v1, s[4:7], s22 offen offset:1024 sc1
v_smfmac_f32_16x16x64_bf16 v[104:107], v[48:51], a[192:199], v2
s_cbranch_vccnz L_rf_w2_pafail
s_waitcnt lgkmcnt(0)
s_barrier
ds_read_b128 v[56:59], v6 offset:6144
ds_read_b128 v[60:63], v6 offset:7168
v_smfmac_f32_16x16x64_bf16 v[108:111], v[48:51], a[200:207], v2
ds_read_b128 v[32:35], v6
v_smfmac_f32_16x16x64_bf16 v[96:99], v[52:55], a[80:87], v2
ds_read_b128 v[36:39], v6 offset:1024
v_smfmac_f32_16x16x64_bf16 v[100:103], v[52:55], a[88:95], v2
ds_read_b128 v[40:43], v6 offset:2048
v_smfmac_f32_16x16x64_bf16 v[104:107], v[52:55], a[208:215], v2
ds_read_b128 v[44:47], v6 offset:3072
v_smfmac_f32_16x16x64_bf16 v[108:111], v[52:55], a[216:223], v2
s_waitcnt lgkmcnt(5)
v_smfmac_f32_16x16x64_bf16 v[96:99], v[56:59], a[96:103], v2
v_smfmac_f32_16x16x64_bf16 v[104:107], v[56:59], a[224:231], v2
buffer_load_dwordx4 v1, s[4:7], s43 offen sc1 lds
s_waitcnt lgkmcnt(4)
v_smfmac_f32_16x16x64_bf16 v[96:99], v[60:63], a[112:119], v2
v_smfmac_f32_16x16x64_bf16 v[104:107], v[60:63], a[240:247], v2
s_waitcnt lgkmcnt(3)
v_smfmac_f32_16x16x64_bf16 v[96:99], v[32:35], a[0:7], v2
v_smfmac_f32_16x16x64_bf16 v[104:107], v[32:35], a[128:135], v2
buffer_load_dwordx4 v1, s[4:7], s43 offen offset:1024 sc1 lds
s_waitcnt lgkmcnt(2)
v_smfmac_f32_16x16x64_bf16 v[96:99], v[36:39], a[16:23], v2
v_smfmac_f32_16x16x64_bf16 v[104:107], v[36:39], a[144:151], v2
s_waitcnt lgkmcnt(1)
v_smfmac_f32_16x16x64_bf16 v[96:99], v[40:43], a[32:39], v2
v_smfmac_f32_16x16x64_bf16 v[104:107], v[40:43], a[160:167], v2
s_waitcnt lgkmcnt(0)
v_smfmac_f32_16x16x64_bf16 v[96:99], v[44:47], a[48:55], v2
v_smfmac_f32_16x16x64_bf16 v[104:107], v[44:47], a[176:183], v2
v_smfmac_f32_16x16x64_bf16 v[100:103], v[56:59], a[104:111], v2
s_nop 2
v_smfmac_f32_16x16x64_bf16 v[100:103], v[60:63], a[120:127], v2
s_nop 1
v_add_f32 v96, v96, v98
v_smfmac_f32_16x16x64_bf16 v[100:103], v[32:35], a[8:15], v2
v_add_f32 v97, v97, v99
v_add_f32 v104, v104, v106
v_smfmac_f32_16x16x64_bf16 v[100:103], v[36:39], a[24:31], v2
v_add_f32 v105, v105, v107
v_cvt_pk_bf16_f32 v96, v96, v97
v_smfmac_f32_16x16x64_bf16 v[100:103], v[40:43], a[40:47], v2
v_cvt_pk_bf16_f32 v97, v104, v105
v_and_or_b32 v96, v96, -2, s41
v_smfmac_f32_16x16x64_bf16 v[100:103], v[44:47], a[56:63], v2
buffer_store_dwordx2 v[96:97], v11, s[4:7], s37 offen sc1
v_smfmac_f32_16x16x64_bf16 v[108:111], v[56:59], a[232:239], v2
v_smfmac_f32_16x16x64_bf16 v[108:111], v[60:63], a[248:255], v2
v_smfmac_f32_16x16x64_bf16 v[108:111], v[32:35], a[136:143], v2
v_smfmac_f32_16x16x64_bf16 v[108:111], v[36:39], a[152:159], v2
v_smfmac_f32_16x16x64_bf16 v[108:111], v[40:43], a[168:175], v2
s_nop 2
v_add_f32 v100, v100, v102
v_smfmac_f32_16x16x64_bf16 v[108:111], v[44:47], a[184:191], v2
v_add_f32 v101, v101, v103
v_cvt_pk_bf16_f32 v98, v100, v101
v_and_or_b32 v98, v98, -2, s41
s_nop 4
v_pk_add_f32 v[108:109], v[108:109], v[110:111]
v_cvt_pk_bf16_f32 v99, v108, v109
buffer_store_dwordx2 v[98:99], v11, s[4:7], s37 offen offset:512 sc1
v_smfmac_f32_16x16x64_bf16 v[112:115], v[32:35], v[64:71], v2
ds_read_b128 v[64:67], v1 offset:40960
ds_read_b128 v[68:71], v1 offset:41984
v_smfmac_f32_16x16x64_bf16 v[116:119], v[32:35], v[72:79], v2
ds_read_b128 v[72:75], v1 offset:43008
ds_read_b128 v[76:79], v1 offset:44032
v_smfmac_f32_16x16x64_bf16 v[112:115], v[36:39], v[80:87], v2
ds_read_b128 v[80:83], v1 offset:57344
ds_read_b128 v[84:87], v1 offset:58368
v_smfmac_f32_16x16x64_bf16 v[116:119], v[36:39], v[88:95], v2
ds_read_b128 v[88:91], v1 offset:59392
ds_read_b128 v[92:95], v1 offset:60416
s_waitcnt lgkmcnt(6)
v_smfmac_f32_16x16x64_bf16 v[112:115], v[40:43], v[64:71], v2
ds_read_b128 v[64:67], v5 offset:8192
ds_read_b128 v[68:71], v5 offset:9216
s_waitcnt lgkmcnt(6)
v_smfmac_f32_16x16x64_bf16 v[116:119], v[40:43], v[72:79], v2
ds_read_b128 v[72:75], v5 offset:10240
ds_read_b128 v[76:79], v5 offset:11264
s_waitcnt lgkmcnt(6)
v_smfmac_f32_16x16x64_bf16 v[112:115], v[44:47], v[80:87], v2
ds_read_b128 v[80:83], v5 offset:24576
ds_read_b128 v[84:87], v5 offset:25600
s_waitcnt lgkmcnt(6)
v_smfmac_f32_16x16x64_bf16 v[116:119], v[44:47], v[88:95], v2
ds_read_b128 v[88:91], v5 offset:26624
ds_read_b128 v[92:95], v5 offset:27648
s_waitcnt lgkmcnt(6)
v_smfmac_f32_16x16x64_bf16 v[112:115], v[48:51], v[64:71], v2
ds_read_b128 v[64:67], v5 offset:40960
ds_read_b128 v[68:71], v5 offset:41984
s_waitcnt lgkmcnt(6)
v_smfmac_f32_16x16x64_bf16 v[116:119], v[48:51], v[72:79], v2
ds_read_b128 v[72:75], v5 offset:43008
ds_read_b128 v[76:79], v5 offset:44032
s_waitcnt lgkmcnt(6)
v_smfmac_f32_16x16x64_bf16 v[112:115], v[52:55], v[80:87], v2
ds_read_b128 v[80:83], v5 offset:57344
ds_read_b128 v[84:87], v5 offset:58368
s_waitcnt lgkmcnt(6)
v_smfmac_f32_16x16x64_bf16 v[116:119], v[52:55], v[88:95], v2
ds_read_b128 v[88:91], v5 offset:59392
ds_read_b128 v[92:95], v5 offset:60416
s_waitcnt lgkmcnt(6)
v_smfmac_f32_16x16x64_bf16 v[112:115], v[56:59], v[64:71], v2
s_waitcnt lgkmcnt(4)
v_smfmac_f32_16x16x64_bf16 v[116:119], v[56:59], v[72:79], v2
s_waitcnt lgkmcnt(2)
v_smfmac_f32_16x16x64_bf16 v[112:115], v[60:63], v[80:87], v2
s_waitcnt lgkmcnt(0)
v_smfmac_f32_16x16x64_bf16 v[116:119], v[60:63], v[88:95], v2
buffer_load_dwordx2 v[108:109], v11, s[4:7], s38 offen sc1
v_mfma_f32_16x16x16_bf16 v[100:103], v[96:97], v[16:17], 0
v_mfma_f32_16x16x16_bf16 v[104:107], v[98:99], v[16:17], 0
s_nop 4
v_add_f32 v112, v112, v114
v_add_f32 v113, v113, v115
v_add_f32 v114, v116, v118
v_add_f32 v115, v117, v119
v_cvt_pk_bf16_f32 v18, v112, v113
v_cvt_pk_bf16_f32 v19, v114, v115
v_and_or_b32 v18, v18, -2, s41
buffer_load_dwordx2 v[110:111], v11, s[4:7], s38 offen offset:512 sc1
s_barrier
buffer_store_dwordx2 v[18:19], v11, s[4:7], s39 offen sc1
v_mov_b32 v112, v18
v_mov_b32 v114, v19
v_mov_b32 v92, v28
v_mov_b32 v93, 0
s_waitcnt vmcnt(5)
s_barrier
ds_read_b128 v[32:35], v6 offset:19456
ds_read_b128 v[36:39], v6 offset:20480
ds_read_b128 v[40:43], v6 offset:24576
ds_read_b128 v[44:47], v6 offset:25600
ds_read_b128 v[48:51], v6 offset:9216
ds_read_b128 v[52:55], v6 offset:10240
ds_read_b128 v[56:59], v6 offset:14336
ds_read_b128 v[60:63], v6 offset:15360
buffer_load_dwordx2 v[20:21], v11, s[4:7], s38 offen sc1
buffer_load_dwordx2 v[22:23], v11, s[4:7], s38 offen offset:512 sc1
s_waitcnt vmcnt(4)
v_mfma_f32_16x16x16_bf16 v[80:83], v[108:109], v[16:17], v[100:103]
v_and_b32 v3, 1, v108
v_cmp_ne_u32 vcc, s41, v3
s_nop 5
v_cvt_pk_bf16_f32 v64, v80, v81
v_cvt_pk_bf16_f32 v65, v82, v83
s_cbranch_vccnz L_rf_w2_xslow
s_waitcnt vmcnt(3)
v_mfma_f32_16x16x16_bf16 v[84:87], v[110:111], v[16:17], v[104:107]
v_and_b32 v3, 1, v110
v_cmp_ne_u32 vcc, s41, v3
s_nop 5
v_cvt_pk_bf16_f32 v66, v84, v85
v_cvt_pk_bf16_f32 v67, v86, v87
ds_write_b128 v6, v[64:67] offset:18432
s_cbranch_vccnz L_rf_w2_xslow
L_rf_w2_xok:
s_cmp_eq_u32 s21, 63
s_cbranch_scc1 L_rf_w2_last
buffer_load_dwordx2 v[116:117], v11, s[4:7], s40 offen sc1
s_waitcnt lgkmcnt(1)
v_mfma_f32_16x16x32_bf16 v[80:83], v[32:35], v[64:67], 0
s_waitcnt lgkmcnt(0)
s_barrier
ds_read_b128 v[68:71], v6 offset:23552
ds_read_b128 v[72:75], v6 offset:8192
ds_read_b128 v[76:79], v6 offset:13312
v_mfma_f32_16x16x32_bf16 v[84:87], v[36:39], v[64:67], 0
v_mfma_f32_16x16x32_bf16 v[88:91], v[64:67], v[64:67], 0
buffer_load_dwordx2 v[20:21], v11, s[4:7], s40 offen sc1
s_waitcnt lgkmcnt(2)
v_mfma_f32_16x16x32_bf16 v[80:83], v[40:43], v[68:71], v[80:83]
s_waitcnt lgkmcnt(1)
v_mfma_f32_16x16x32_bf16 v[80:83], v[48:51], v[72:75], v[80:83]
s_waitcnt lgkmcnt(0)
v_mfma_f32_16x16x32_bf16 v[80:83], v[56:59], v[76:79], v[80:83]
buffer_store_dwordx4 v[64:67], v10, s[4:7], s45 offen offset:128 sc1
v_mfma_f32_16x16x32_bf16 v[84:87], v[44:47], v[68:71], v[84:87]
v_mfma_f32_16x16x32_bf16 v[84:87], v[52:55], v[72:75], v[84:87]
v_mfma_f32_16x16x32_bf16 v[84:87], v[60:63], v[76:79], v[84:87]
v_mfma_f32_16x16x32_bf16 v[88:91], v[68:71], v[68:71], v[88:91]
buffer_store_dwordx2 v[18:19], v11, s[4:7], s51 offen offset:3072 sc1
v_mfma_f32_16x16x32_bf16 v[88:91], v[72:75], v[72:75], v[88:91]
v_mfma_f32_16x16x32_bf16 v[88:91], v[76:79], v[76:79], v[88:91]
v_mfma_f32_32x32x4_2b_bf16 v[32:63], v[14:15], v[14:15], 0
s_nop 0
v_max3_f32 v4, v80, v81, v82
s_nop 1
v_max3_f32 v4, v4, v83, v84
v_max3_f32 v4, v4, v85, v86
v_max_f32 v4, v4, v87
v_max3_f32 v90, v4, v88, v89
v_max3_f32 v4, v4, v88, v89
s_nop 1
v_permlane16_swap_b32 v4, v90
v_max_f32 v4, v4, v90
v_max_f32 v90, v4, v90
s_nop 1
v_permlane32_swap_b32 v4, v90
v_max_f32 v4, v4, v90
v_mul_f32 v4, s34, v4
v_pk_fma_f32 v[80:81], v[80:81], s[34:35], v[4:5] op_sel_hi:[1,0,0] neg_lo:[0,0,1] neg_hi:[0,0,1]
v_pk_fma_f32 v[82:83], v[82:83], s[34:35], v[4:5] op_sel_hi:[1,0,0] neg_lo:[0,0,1] neg_hi:[0,0,1]
v_pk_fma_f32 v[84:85], v[84:85], s[34:35], v[4:5] op_sel_hi:[1,0,0] neg_lo:[0,0,1] neg_hi:[0,0,1]
v_pk_fma_f32 v[86:87], v[86:87], s[34:35], v[4:5] op_sel_hi:[1,0,0] neg_lo:[0,0,1] neg_hi:[0,0,1]
v_pk_fma_f32 v[88:89], v[88:89], s[34:35], v[4:5] op_sel_hi:[1,0,0] neg_lo:[0,0,1] neg_hi:[0,0,1]
v_exp_f32 v80, v80
v_exp_f32 v81, v81
v_exp_f32 v82, v82
v_cvt_pk_bf16_f32 v68, v80, v81
v_exp_f32 v83, v83
v_exp_f32 v84, v84
v_cvt_pk_bf16_f32 v69, v82, v83
v_exp_f32 v85, v85
v_exp_f32 v86, v86
v_cvt_pk_bf16_f32 v70, v84, v85
v_exp_f32 v87, v87
v_exp_f32 v88, v88
v_cvt_pk_bf16_f32 v71, v86, v87
v_exp_f32 v89, v89
s_waitcnt vmcnt(3)
v_mfma_f32_16x16x32_bf16 v[76:79], v[28:31], v[68:71], 0
v_and_b32 v3, 1, v116
v_cvt_pk_bf16_f32 v72, v88, v89
v_mfma_f32_16x16x32_bf16 v[100:103], v[120:123], v[68:71], 0
v_cmp_ne_u32 vcc, s41, v3
v_cvt_pk_bf16_f32 v73, v88, v89
v_mfma_f32_16x16x32_bf16 v[104:107], v[124:127], v[68:71], 0
v_mov_b32 v113, v116
v_mov_b32 v115, v117
v_mfma_f32_16x16x16_bf16 v[76:79], v[92:93], v[72:73], v[76:79]
s_cbranch_vccnz L_rf_w2_pv0
L_rf_w2_pv2:
v_mfma_f32_16x16x16_bf16 v[100:103], v[112:113], v[72:73], v[100:103]
v_mfma_f32_16x16x16_bf16 v[104:107], v[114:115], v[72:73], v[104:107]
buffer_load_dwordx4 v[120:123], v1, s[4:7], s44 offen sc1
buffer_load_dwordx4 v[124:127], v1, s[4:7], s44 offen offset:1024 sc1
s_nop 2
v_rcp_f32 v76, v76
s_mov_b64 exec, s[28:29]
v_pk_mul_f32 v[100:101], v[100:101], v[76:77] op_sel_hi:[1,0]
v_pk_mul_f32 v[102:103], v[102:103], v[76:77] op_sel_hi:[1,0]
v_pk_mul_f32 v[104:105], v[104:105], v[76:77] op_sel_hi:[1,0]
v_pk_mul_f32 v[106:107], v[106:107], v[76:77] op_sel_hi:[1,0]
v_cvt_pk_bf16_f32 v84, v100, v101
v_cvt_pk_bf16_f32 v85, v102, v103
v_cvt_pk_bf16_f32 v86, v104, v105
v_cvt_pk_bf16_f32 v87, v106, v107
ds_write_b128 v6, v[84:87] offset:29664
s_mov_b64 exec, -1
s_waitcnt lgkmcnt(0)
s_barrier
ds_read_b128 v[68:71], v6 offset:28672
ds_read_b128 v[72:75], v6 offset:29696
s_waitcnt lgkmcnt(1)
v_smfmac_f32_16x16x64_bf16 v[32:35], v[68:71], v[128:135], v2
s_add_u32 s21, s21, 1
s_xor_b32 s38, s38, 1048576
s_xor_b32 s37, s37, 1048576
s_waitcnt lgkmcnt(0)
v_smfmac_f32_16x16x64_bf16 v[32:35], v[72:75], v[136:143], v2
s_xor_b32 s40, s40, 1048576
s_xor_b32 s39, s39, 1048576
s_lshr_b32 s41, s21, 1
v_smfmac_f32_16x16x64_bf16 v[36:39], v[68:71], v[144:151], v2
s_and_b32 s41, s41, 1
s_xor_b32 s41, s41, 1
s_xor_b32 s35, s35, 16384
v_smfmac_f32_16x16x64_bf16 v[36:39], v[72:75], v[152:159], v2
v_add_f32 v32, v32, v34
s_xor_b32 s36, s36, 16384
s_add_u32 s43, s43, 262144
s_add_u32 s44, s44, 262144
v_smfmac_f32_16x16x64_bf16 v[40:43], v[68:71], v[160:167], v2
v_add_f32 v33, v33, v35
v_smfmac_f32_16x16x64_bf16 v[40:43], v[72:75], v[168:175], v2
v_cvt_pk_bf16_f32 v32, v32, v33
v_smfmac_f32_16x16x64_bf16 v[44:47], v[68:71], v[176:183], v2
v_and_or_b32 v32, v32, -2, s42
v_smfmac_f32_16x16x64_bf16 v[44:47], v[72:75], v[184:191], v2
v_add_f32 v36, v36, v38
v_smfmac_f32_16x16x64_bf16 v[48:51], v[68:71], v[192:199], v2
v_add_f32 v37, v37, v39
v_smfmac_f32_16x16x64_bf16 v[48:51], v[72:75], v[200:207], v2
v_cvt_pk_bf16_f32 v33, v36, v37
v_smfmac_f32_16x16x64_bf16 v[52:55], v[68:71], v[208:215], v2
v_add_f32 v40, v40, v42
v_smfmac_f32_16x16x64_bf16 v[52:55], v[72:75], v[216:223], v2
v_add_f32 v41, v41, v43
v_smfmac_f32_16x16x64_bf16 v[56:59], v[68:71], v[224:231], v2
v_cvt_pk_bf16_f32 v34, v40, v41
v_smfmac_f32_16x16x64_bf16 v[56:59], v[72:75], v[232:239], v2
v_add_f32 v44, v44, v46
v_smfmac_f32_16x16x64_bf16 v[60:63], v[68:71], v[240:247], v2
v_add_f32 v45, v45, v47
v_smfmac_f32_16x16x64_bf16 v[60:63], v[72:75], v[248:255], v2
v_cvt_pk_bf16_f32 v35, v44, v45
buffer_store_dwordx4 v[32:35], v8, s[4:7], s46 offen
v_pk_add_f32 v[48:49], v[48:49], v[50:51]
v_cvt_pk_bf16_f32 v48, v48, v49
v_and_or_b32 v48, v48, -2, s42
v_pk_add_f32 v[52:53], v[52:53], v[54:55]
v_cvt_pk_bf16_f32 v49, v52, v53
v_pk_add_f32 v[56:57], v[56:57], v[58:59]
v_cvt_pk_bf16_f32 v50, v56, v57
v_pk_add_f32 v[60:61], v[60:61], v[62:63]
v_cvt_pk_bf16_f32 v51, v60, v61
buffer_store_dwordx4 v[48:51], v8, s[4:7], s61 offen
s_add_u32 s45, s45, 262144
s_add_u32 s51, s51, 262144
v_mfma_f32_32x32x8_bf16 v[96:111], v[14:15], v[14:15], 0
v_mfma_f32_16x16x16_bf16 v[112:115], v[14:15], v[14:15], 0
v_mfma_f32_16x16x16_bf16 v[116:119], v[14:15], v[14:15], 0
ds_read_b128 v[64:67], v1 offset:8192
ds_read_b128 v[68:71], v1 offset:9216
ds_read_b128 v[72:75], v1 offset:10240
ds_read_b128 v[76:79], v1 offset:11264
ds_read_b128 v[80:83], v1 offset:24576
ds_read_b128 v[84:87], v1 offset:25600
ds_read_b128 v[88:91], v1 offset:26624
ds_read_b128 v[92:95], v1 offset:27648
v_mov_b32 v58, -1
v_mov_b32 v59, -1
s_waitcnt vmcnt(0)
L_rf_w2_cgo:
L_rf_w2_pc:
buffer_load_dword v36, v13, s[4:7], s25 offen sc1
buffer_load_dword v37, v13, s[4:7], s25 offen offset:256 sc1
buffer_load_dword v38, v13, s[4:7], s25 offen offset:512 sc1
buffer_load_dword v39, v13, s[4:7], s25 offen offset:768 sc1
buffer_load_dword v40, v13, s[4:7], s25 offen offset:1024 sc1
buffer_load_dword v41, v13, s[4:7], s25 offen offset:1280 sc1
buffer_load_dword v42, v13, s[4:7], s25 offen offset:1536 sc1
buffer_load_dword v43, v13, s[4:7], s25 offen offset:1792 sc1
s_waitcnt vmcnt(4)
v_mfma_f32_16x16x32_bf16 v[52:55], v[36:39], v[24:27], 0
v_bitop3_b32 v3, s42, v36, v37 bitop3:0x7e
v_bitop3_b32 v4, s42, v38, v39 bitop3:0x7e
s_waitcnt vmcnt(2)
v_or_b32 v3, v3, v4
v_bitop3_b32 v4, s42, v40, v41 bitop3:0x7e
s_waitcnt vmcnt(0)
v_mfma_f32_16x16x32_bf16 v[52:55], v[40:43], v[24:27], v[52:55]
v_bitop3_b32 v56, s42, v42, v43 bitop3:0x7e
v_or3_b32 v3, v3, v4, v56
v_and_b32 v3, v0, v3
v_cmp_ne_u32 vcc, 0, v3
s_nop 3
v_cvt_pk_bf16_f32 v56, v52, v53
v_cvt_pk_bf16_f32 v57, v54, v55
v_min_u32 v56, -2, v56
s_cbranch_vccnz L_rf_w2_pc
s_mov_b64 exec, s[26:27]
buffer_store_dwordx2 v[56:57], v9, s[4:7], s35 offen offset:512
buffer_store_dwordx2 v[58:59], v9, s[4:7], s36 offen offset:512
s_mov_b64 exec, -1
s_xor_b32 s42, s42, 1
s_branch L_rf_w2_loop
L_rf_w2_last:
buffer_store_dwordx4 v[64:67], v10, s[4:7], s45 offen offset:128 sc1
buffer_store_dwordx2 v[18:19], v11, s[4:7], s51 offen offset:3072 sc1
s_branch L_rf_end
L_rf_w2_pafail:
s_nop 7
v_mov_b32 v96, 0
v_mov_b32 v97, 0
v_mov_b32 v98, 0
v_mov_b32 v99, 0
v_mov_b32 v100, 0
v_mov_b32 v101, 0
v_mov_b32 v102, 0
v_mov_b32 v103, 0
v_mov_b32 v104, 0
v_mov_b32 v105, 0
v_mov_b32 v106, 0
v_mov_b32 v107, 0
s_branch L_rf_w2_pa
L_rf_w2_xslow:
buffer_load_dwordx2 v[108:109], v11, s[4:7], s38 offen sc1
buffer_load_dwordx2 v[110:111], v11, s[4:7], s38 offen offset:512 sc1
s_waitcnt vmcnt(2)
v_bitop3_b32 v3, s41, v20, v22 bitop3:0x7e
v_mfma_f32_16x16x16_bf16 v[80:83], v[20:21], v[16:17], v[100:103]
v_and_b32 v3, 1, v3
v_mfma_f32_16x16x16_bf16 v[84:87], v[22:23], v[16:17], v[104:107]
v_cmp_ne_u32 vcc, 0, v3
s_cbranch_vccz L_rf_w2_xgot
buffer_load_dwordx2 v[20:21], v11, s[4:7], s38 offen sc1
buffer_load_dwordx2 v[22:23], v11, s[4:7], s38 offen offset:512 sc1
s_waitcnt vmcnt(2)
v_bitop3_b32 v3, s41, v108, v110 bitop3:0x7e
v_mfma_f32_16x16x16_bf16 v[80:83], v[108:109], v[16:17], v[100:103]
v_and_b32 v3, 1, v3
v_mfma_f32_16x16x16_bf16 v[84:87], v[110:111], v[16:17], v[104:107]
v_cmp_ne_u32 vcc, 0, v3
s_cbranch_vccz L_rf_w2_xgot
s_branch L_rf_w2_xslow
L_rf_w2_xgot:
s_nop 3
v_cvt_pk_bf16_f32 v64, v80, v81
v_cvt_pk_bf16_f32 v65, v82, v83
v_cvt_pk_bf16_f32 v66, v84, v85
v_cvt_pk_bf16_f32 v67, v86, v87
ds_write_b128 v6, v[64:67] offset:18432
s_branch L_rf_w2_xok
L_rf_w2_pv0:
s_waitcnt vmcnt(2)
s_branch L_rf_w2_pv1
L_rf_w2_pv:
buffer_load_dwordx2 v[20:21], v11, s[4:7], s40 offen sc1
s_waitcnt vmcnt(0)
L_rf_w2_pv1:
v_and_b32 v3, 1, v20
v_cmp_ne_u32 vcc, s41, v3
v_mov_b32 v113, v20
v_mov_b32 v115, v21
s_cbranch_vccnz L_rf_w2_pv
s_branch L_rf_w2_pv2
L_rf_w3_entry:
v_mfma_f32_32x32x8_bf16 v[96:111], v[14:15], v[14:15], 0
v_mfma_f32_16x16x16_bf16 v[112:115], v[14:15], v[14:15], 0
v_mfma_f32_16x16x16_bf16 v[116:119], v[14:15], v[14:15], 0
ds_read_b128 v[64:67], v1 offset:12288
ds_read_b128 v[68:71], v1 offset:13312
ds_read_b128 v[72:75], v1 offset:14336
ds_read_b128 v[76:79], v1 offset:15360
ds_read_b128 v[80:83], v1 offset:28672
ds_read_b128 v[84:87], v1 offset:29696
ds_read_b128 v[88:91], v1 offset:30720
ds_read_b128 v[92:95], v1 offset:31744
buffer_load_dwordx4 v[120:123], v1, s[4:7], s44 offen sc1
buffer_load_dwordx4 v[124:127], v1, s[4:7], s44 offen offset:1024 sc1
s_add_u32 s44, s44, 262144
L_rf_w3_loop:
s_add_u32 s22, s35, 6144
s_waitcnt vmcnt(0)
buffer_load_dwordx4 v[56:59], v1, s[4:7], s22 offen sc1
buffer_load_dwordx4 v[60:63], v1, s[4:7], s22 offen offset:1024 sc1
L_rf_w3_pa:
s_waitcnt vmcnt(1)
ds_write_b128 v6, v[56:59] offset:6144
s_waitcnt vmcnt(0)
ds_write_b128 v6, v[60:63] offset:7168
v_max3_u32 v3, v56, v58, v60
v_max_u32 v3, v3, v62
v_cmp_eq_u32 vcc, -1, v3
v_smfmac_f32_16x16x64_bf16 v[96:99], v[56:59], a[96:103], v2
buffer_load_dwordx4 v[56:59], v1, s[4:7], s22 offen sc1
v_smfmac_f32_16x16x64_bf16 v[100:103], v[56:59], a[104:111], v2
buffer_load_dwordx4 v[60:63], v1, s[4:7], s22 offen offset:1024 sc1
v_smfmac_f32_16x16x64_bf16 v[104:107], v[56:59], a[224:231], v2
s_cbranch_vccnz L_rf_w3_pafail
s_waitcnt lgkmcnt(0)
s_barrier
ds_read_b128 v[32:35], v6
ds_read_b128 v[36:39], v6 offset:1024
v_smfmac_f32_16x16x64_bf16 v[108:111], v[56:59], a[232:239], v2
ds_read_b128 v[40:43], v6 offset:2048
v_smfmac_f32_16x16x64_bf16 v[96:99], v[60:63], a[112:119], v2
ds_read_b128 v[44:47], v6 offset:3072
v_smfmac_f32_16x16x64_bf16 v[100:103], v[60:63], a[120:127], v2
ds_read_b128 v[48:51], v6 offset:4096
v_smfmac_f32_16x16x64_bf16 v[104:107], v[60:63], a[240:247], v2
ds_read_b128 v[52:55], v6 offset:5120
v_smfmac_f32_16x16x64_bf16 v[108:111], v[60:63], a[248:255], v2
s_waitcnt lgkmcnt(5)
v_smfmac_f32_16x16x64_bf16 v[96:99], v[32:35], a[0:7], v2
v_smfmac_f32_16x16x64_bf16 v[104:107], v[32:35], a[128:135], v2
s_waitcnt lgkmcnt(4)
v_smfmac_f32_16x16x64_bf16 v[96:99], v[36:39], a[16:23], v2
buffer_load_dwordx4 v1, s[4:7], s43 offen sc1 lds
v_smfmac_f32_16x16x64_bf16 v[104:107], v[36:39], a[144:151], v2
s_waitcnt lgkmcnt(3)
v_smfmac_f32_16x16x64_bf16 v[96:99], v[40:43], a[32:39], v2
v_smfmac_f32_16x16x64_bf16 v[104:107], v[40:43], a[160:167], v2
s_waitcnt lgkmcnt(2)
v_smfmac_f32_16x16x64_bf16 v[96:99], v[44:47], a[48:55], v2
buffer_load_dwordx4 v1, s[4:7], s43 offen offset:1024 sc1 lds
v_smfmac_f32_16x16x64_bf16 v[104:107], v[44:47], a[176:183], v2
s_waitcnt lgkmcnt(1)
v_smfmac_f32_16x16x64_bf16 v[96:99], v[48:51], a[64:71], v2
v_smfmac_f32_16x16x64_bf16 v[104:107], v[48:51], a[192:199], v2
s_waitcnt lgkmcnt(0)
v_smfmac_f32_16x16x64_bf16 v[96:99], v[52:55], a[80:87], v2
buffer_load_dword v12, v7, s[4:7], 0 offen sc1
v_smfmac_f32_16x16x64_bf16 v[104:107], v[52:55], a[208:215], v2
v_smfmac_f32_16x16x64_bf16 v[100:103], v[32:35], a[8:15], v2
s_nop 2
v_smfmac_f32_16x16x64_bf16 v[100:103], v[36:39], a[24:31], v2
s_nop 1
v_add_f32 v96, v96, v98
v_smfmac_f32_16x16x64_bf16 v[100:103], v[40:43], a[40:47], v2
v_add_f32 v97, v97, v99
v_add_f32 v104, v104, v106
v_smfmac_f32_16x16x64_bf16 v[100:103], v[44:47], a[56:63], v2
v_add_f32 v105, v105, v107
v_cvt_pk_bf16_f32 v96, v96, v97
v_smfmac_f32_16x16x64_bf16 v[100:103], v[48:51], a[72:79], v2
v_cvt_pk_bf16_f32 v97, v104, v105
v_and_or_b32 v96, v96, -2, s41
v_smfmac_f32_16x16x64_bf16 v[100:103], v[52:55], a[88:95], v2
buffer_store_dwordx2 v[96:97], v11, s[4:7], s37 offen sc1
v_smfmac_f32_16x16x64_bf16 v[108:111], v[32:35], a[136:143], v2
v_smfmac_f32_16x16x64_bf16 v[108:111], v[36:39], a[152:159], v2
v_smfmac_f32_16x16x64_bf16 v[108:111], v[40:43], a[168:175], v2
v_smfmac_f32_16x16x64_bf16 v[108:111], v[44:47], a[184:191], v2
v_smfmac_f32_16x16x64_bf16 v[108:111], v[48:51], a[200:207], v2
s_nop 2
v_add_f32 v100, v100, v102
v_smfmac_f32_16x16x64_bf16 v[108:111], v[52:55], a[216:223], v2
v_add_f32 v101, v101, v103
v_cvt_pk_bf16_f32 v98, v100, v101
v_and_or_b32 v98, v98, -2, s41
s_nop 4
v_pk_add_f32 v[108:109], v[108:109], v[110:111]
v_cvt_pk_bf16_f32 v99, v108, v109
buffer_store_dwordx2 v[98:99], v11, s[4:7], s37 offen offset:512 sc1
v_smfmac_f32_16x16x64_bf16 v[112:115], v[32:35], v[64:71], v2
ds_read_b128 v[64:67], v1 offset:45056
ds_read_b128 v[68:71], v1 offset:46080
v_smfmac_f32_16x16x64_bf16 v[116:119], v[32:35], v[72:79], v2
ds_read_b128 v[72:75], v1 offset:47104
ds_read_b128 v[76:79], v1 offset:48128
v_smfmac_f32_16x16x64_bf16 v[112:115], v[36:39], v[80:87], v2
ds_read_b128 v[80:83], v1 offset:61440
ds_read_b128 v[84:87], v1 offset:62464
v_smfmac_f32_16x16x64_bf16 v[116:119], v[36:39], v[88:95], v2
ds_read_b128 v[88:91], v1 offset:63488
ds_read_b128 v[92:95], v1 offset:64512
s_waitcnt lgkmcnt(6)
v_smfmac_f32_16x16x64_bf16 v[112:115], v[40:43], v[64:71], v2
ds_read_b128 v[64:67], v5 offset:12288
ds_read_b128 v[68:71], v5 offset:13312
s_waitcnt lgkmcnt(6)
v_smfmac_f32_16x16x64_bf16 v[116:119], v[40:43], v[72:79], v2
ds_read_b128 v[72:75], v5 offset:14336
ds_read_b128 v[76:79], v5 offset:15360
s_waitcnt lgkmcnt(6)
v_smfmac_f32_16x16x64_bf16 v[112:115], v[44:47], v[80:87], v2
ds_read_b128 v[80:83], v5 offset:28672
ds_read_b128 v[84:87], v5 offset:29696
s_waitcnt lgkmcnt(6)
v_smfmac_f32_16x16x64_bf16 v[116:119], v[44:47], v[88:95], v2
ds_read_b128 v[88:91], v5 offset:30720
ds_read_b128 v[92:95], v5 offset:31744
s_waitcnt lgkmcnt(6)
v_smfmac_f32_16x16x64_bf16 v[112:115], v[48:51], v[64:71], v2
ds_read_b128 v[64:67], v5 offset:45056
ds_read_b128 v[68:71], v5 offset:46080
s_waitcnt lgkmcnt(6)
v_smfmac_f32_16x16x64_bf16 v[116:119], v[48:51], v[72:79], v2
ds_read_b128 v[72:75], v5 offset:47104
ds_read_b128 v[76:79], v5 offset:48128
s_waitcnt lgkmcnt(6)
v_smfmac_f32_16x16x64_bf16 v[112:115], v[52:55], v[80:87], v2
ds_read_b128 v[80:83], v5 offset:61440
ds_read_b128 v[84:87], v5 offset:62464
s_waitcnt lgkmcnt(6)
v_smfmac_f32_16x16x64_bf16 v[116:119], v[52:55], v[88:95], v2
ds_read_b128 v[88:91], v5 offset:63488
ds_read_b128 v[92:95], v5 offset:64512
s_waitcnt lgkmcnt(6)
v_smfmac_f32_16x16x64_bf16 v[112:115], v[56:59], v[64:71], v2
s_waitcnt lgkmcnt(4)
v_smfmac_f32_16x16x64_bf16 v[116:119], v[56:59], v[72:79], v2
s_waitcnt lgkmcnt(2)
v_smfmac_f32_16x16x64_bf16 v[112:115], v[60:63], v[80:87], v2
s_waitcnt lgkmcnt(0)
v_smfmac_f32_16x16x64_bf16 v[116:119], v[60:63], v[88:95], v2
buffer_load_dwordx2 v[108:109], v11, s[4:7], s38 offen sc1
v_mfma_f32_16x16x16_bf16 v[100:103], v[96:97], v[16:17], 0
v_mfma_f32_16x16x16_bf16 v[104:107], v[98:99], v[16:17], 0
s_nop 4
v_add_f32 v112, v112, v114
v_add_f32 v113, v113, v115
v_add_f32 v114, v116, v118
v_add_f32 v115, v117, v119
v_cvt_pk_bf16_f32 v18, v112, v113
v_cvt_pk_bf16_f32 v19, v114, v115
v_and_or_b32 v18, v18, -2, s41
buffer_load_dwordx2 v[110:111], v11, s[4:7], s38 offen offset:512 sc1
s_barrier
buffer_store_dwordx2 v[18:19], v11, s[4:7], s39 offen sc1
v_mov_b32 v112, v18
v_mov_b32 v114, v19
v_mov_b32 v92, v28
v_mov_b32 v93, 0
s_waitcnt vmcnt(6)
s_barrier
ds_read_b128 v[32:35], v6 offset:24576
ds_read_b128 v[36:39], v6 offset:25600
ds_read_b128 v[40:43], v6 offset:19456
ds_read_b128 v[44:47], v6 offset:20480
ds_read_b128 v[48:51], v6 offset:14336
ds_read_b128 v[52:55], v6 offset:15360
ds_read_b128 v[56:59], v6 offset:9216
ds_read_b128 v[60:63], v6 offset:10240
buffer_load_dwordx2 v[20:21], v11, s[4:7], s38 offen sc1
buffer_load_dwordx2 v[22:23], v11, s[4:7], s38 offen offset:512 sc1
s_waitcnt vmcnt(4)
v_mfma_f32_16x16x16_bf16 v[80:83], v[108:109], v[16:17], v[100:103]
v_and_b32 v3, 1, v108
v_cmp_ne_u32 vcc, s41, v3
s_nop 5
v_cvt_pk_bf16_f32 v64, v80, v81
v_cvt_pk_bf16_f32 v65, v82, v83
s_cbranch_vccnz L_rf_w3_xslow
s_waitcnt vmcnt(3)
v_mfma_f32_16x16x16_bf16 v[84:87], v[110:111], v[16:17], v[104:107]
v_and_b32 v3, 1, v110
v_cmp_ne_u32 vcc, s41, v3
s_nop 5
v_cvt_pk_bf16_f32 v66, v84, v85
v_cvt_pk_bf16_f32 v67, v86, v87
ds_write_b128 v6, v[64:67] offset:23552
s_cbranch_vccnz L_rf_w3_xslow
L_rf_w3_xok:
s_cmp_eq_u32 s21, 63
s_cbranch_scc1 L_rf_w3_last
buffer_load_dwordx2 v[116:117], v11, s[4:7], s40 offen sc1
s_waitcnt lgkmcnt(1)
v_mfma_f32_16x16x32_bf16 v[80:83], v[32:35], v[64:67], 0
s_waitcnt lgkmcnt(0)
s_barrier
ds_read_b128 v[68:71], v6 offset:18432
ds_read_b128 v[72:75], v6 offset:13312
ds_read_b128 v[76:79], v6 offset:8192
v_mfma_f32_16x16x32_bf16 v[84:87], v[36:39], v[64:67], 0
v_mfma_f32_16x16x32_bf16 v[88:91], v[64:67], v[64:67], 0
buffer_load_dwordx2 v[20:21], v11, s[4:7], s40 offen sc1
s_waitcnt lgkmcnt(2)
v_mfma_f32_16x16x32_bf16 v[80:83], v[40:43], v[68:71], v[80:83]
s_waitcnt lgkmcnt(1)
v_mfma_f32_16x16x32_bf16 v[80:83], v[48:51], v[72:75], v[80:83]
s_waitcnt lgkmcnt(0)
v_mfma_f32_16x16x32_bf16 v[80:83], v[56:59], v[76:79], v[80:83]
v_mfma_f32_16x16x32_bf16 v[84:87], v[44:47], v[68:71], v[84:87]
buffer_store_dwordx4 v[64:67], v10, s[4:7], s45 offen offset:192 sc1
v_mfma_f32_16x16x32_bf16 v[84:87], v[52:55], v[72:75], v[84:87]
v_mfma_f32_16x16x32_bf16 v[84:87], v[60:63], v[76:79], v[84:87]
v_mfma_f32_16x16x32_bf16 v[88:91], v[68:71], v[68:71], v[88:91]
v_mfma_f32_16x16x32_bf16 v[88:91], v[72:75], v[72:75], v[88:91]
buffer_store_dwordx2 v[18:19], v11, s[4:7], s51 offen offset:3584 sc1
v_mfma_f32_16x16x32_bf16 v[88:91], v[76:79], v[76:79], v[88:91]
v_mfma_f32_32x32x4_2b_bf16 v[32:63], v[14:15], v[14:15], 0
s_nop 0
v_max3_f32 v4, v80, v81, v82
s_nop 1
v_max3_f32 v4, v4, v83, v84
v_max3_f32 v4, v4, v85, v86
v_max_f32 v4, v4, v87
v_max3_f32 v90, v4, v88, v89
v_max3_f32 v4, v4, v88, v89
s_nop 1
v_permlane16_swap_b32 v4, v90
v_max_f32 v4, v4, v90
v_max_f32 v90, v4, v90
s_nop 1
v_permlane32_swap_b32 v4, v90
v_max_f32 v4, v4, v90
v_mul_f32 v4, s34, v4
v_pk_fma_f32 v[80:81], v[80:81], s[34:35], v[4:5] op_sel_hi:[1,0,0] neg_lo:[0,0,1] neg_hi:[0,0,1]
v_pk_fma_f32 v[82:83], v[82:83], s[34:35], v[4:5] op_sel_hi:[1,0,0] neg_lo:[0,0,1] neg_hi:[0,0,1]
v_pk_fma_f32 v[84:85], v[84:85], s[34:35], v[4:5] op_sel_hi:[1,0,0] neg_lo:[0,0,1] neg_hi:[0,0,1]
v_pk_fma_f32 v[86:87], v[86:87], s[34:35], v[4:5] op_sel_hi:[1,0,0] neg_lo:[0,0,1] neg_hi:[0,0,1]
v_pk_fma_f32 v[88:89], v[88:89], s[34:35], v[4:5] op_sel_hi:[1,0,0] neg_lo:[0,0,1] neg_hi:[0,0,1]
v_exp_f32 v80, v80
v_exp_f32 v81, v81
v_exp_f32 v82, v82
v_cvt_pk_bf16_f32 v68, v80, v81
v_exp_f32 v83, v83
v_exp_f32 v84, v84
v_cvt_pk_bf16_f32 v69, v82, v83
v_exp_f32 v85, v85
v_exp_f32 v86, v86
v_cvt_pk_bf16_f32 v70, v84, v85
v_exp_f32 v87, v87
v_exp_f32 v88, v88
v_cvt_pk_bf16_f32 v71, v86, v87
v_exp_f32 v89, v89
s_waitcnt vmcnt(3)
v_mfma_f32_16x16x32_bf16 v[76:79], v[28:31], v[68:71], 0
v_and_b32 v3, 1, v116
v_cvt_pk_bf16_f32 v72, v88, v89
v_mfma_f32_16x16x32_bf16 v[100:103], v[120:123], v[68:71], 0
v_cmp_ne_u32 vcc, s41, v3
v_cvt_pk_bf16_f32 v73, v88, v89
v_mfma_f32_16x16x32_bf16 v[104:107], v[124:127], v[68:71], 0
v_mov_b32 v113, v116
v_mov_b32 v115, v117
v_mfma_f32_16x16x16_bf16 v[76:79], v[92:93], v[72:73], v[76:79]
s_cbranch_vccnz L_rf_w3_pv0
L_rf_w3_pv2:
v_mfma_f32_16x16x16_bf16 v[100:103], v[112:113], v[72:73], v[100:103]
v_mfma_f32_16x16x16_bf16 v[104:107], v[114:115], v[72:73], v[104:107]
buffer_load_dwordx4 v[120:123], v1, s[4:7], s44 offen sc1
buffer_load_dwordx4 v[124:127], v1, s[4:7], s44 offen offset:1024 sc1
s_nop 2
v_rcp_f32 v76, v76
s_mov_b64 exec, s[28:29]
v_pk_mul_f32 v[100:101], v[100:101], v[76:77] op_sel_hi:[1,0]
v_pk_mul_f32 v[102:103], v[102:103], v[76:77] op_sel_hi:[1,0]
v_pk_mul_f32 v[104:105], v[104:105], v[76:77] op_sel_hi:[1,0]
v_pk_mul_f32 v[106:107], v[106:107], v[76:77] op_sel_hi:[1,0]
v_cvt_pk_bf16_f32 v84, v100, v101
v_cvt_pk_bf16_f32 v85, v102, v103
v_cvt_pk_bf16_f32 v86, v104, v105
v_cvt_pk_bf16_f32 v87, v106, v107
ds_write_b128 v6, v[84:87] offset:29696
s_mov_b64 exec, -1
s_waitcnt lgkmcnt(0)
s_barrier
ds_read_b128 v[68:71], v6 offset:28672
ds_read_b128 v[72:75], v6 offset:29696
s_waitcnt lgkmcnt(1)
v_smfmac_f32_16x16x64_bf16 v[32:35], v[68:71], v[128:135], v2
s_add_u32 s21, s21, 1
s_xor_b32 s38, s38, 1048576
s_xor_b32 s37, s37, 1048576
s_waitcnt lgkmcnt(0)
v_smfmac_f32_16x16x64_bf16 v[32:35], v[72:75], v[136:143], v2
s_xor_b32 s40, s40, 1048576
s_xor_b32 s39, s39, 1048576
s_lshr_b32 s41, s21, 1
v_smfmac_f32_16x16x64_bf16 v[36:39], v[68:71], v[144:151], v2
s_and_b32 s41, s41, 1
s_xor_b32 s41, s41, 1
s_xor_b32 s35, s35, 16384
v_smfmac_f32_16x16x64_bf16 v[36:39], v[72:75], v[152:159], v2
v_add_f32 v32, v32, v34
s_xor_b32 s36, s36, 16384
s_add_u32 s43, s43, 262144
s_add_u32 s44, s44, 262144
v_smfmac_f32_16x16x64_bf16 v[40:43], v[68:71], v[160:167], v2
v_add_f32 v33, v33, v35
v_smfmac_f32_16x16x64_bf16 v[40:43], v[72:75], v[168:175], v2
v_cvt_pk_bf16_f32 v32, v32, v33
v_smfmac_f32_16x16x64_bf16 v[44:47], v[68:71], v[176:183], v2
v_and_or_b32 v32, v32, -2, s42
v_smfmac_f32_16x16x64_bf16 v[44:47], v[72:75], v[184:191], v2
v_add_f32 v36, v36, v38
v_smfmac_f32_16x16x64_bf16 v[48:51], v[68:71], v[192:199], v2
v_add_f32 v37, v37, v39
v_smfmac_f32_16x16x64_bf16 v[48:51], v[72:75], v[200:207], v2
v_cvt_pk_bf16_f32 v33, v36, v37
v_smfmac_f32_16x16x64_bf16 v[52:55], v[68:71], v[208:215], v2
v_add_f32 v40, v40, v42
v_smfmac_f32_16x16x64_bf16 v[52:55], v[72:75], v[216:223], v2
v_add_f32 v41, v41, v43
v_smfmac_f32_16x16x64_bf16 v[56:59], v[68:71], v[224:231], v2
v_cvt_pk_bf16_f32 v34, v40, v41
v_smfmac_f32_16x16x64_bf16 v[56:59], v[72:75], v[232:239], v2
v_add_f32 v44, v44, v46
v_smfmac_f32_16x16x64_bf16 v[60:63], v[68:71], v[240:247], v2
v_add_f32 v45, v45, v47
v_smfmac_f32_16x16x64_bf16 v[60:63], v[72:75], v[248:255], v2
v_cvt_pk_bf16_f32 v35, v44, v45
buffer_store_dwordx4 v[32:35], v8, s[4:7], s46 offen
v_pk_add_f32 v[48:49], v[48:49], v[50:51]
v_cvt_pk_bf16_f32 v48, v48, v49
v_and_or_b32 v48, v48, -2, s42
v_pk_add_f32 v[52:53], v[52:53], v[54:55]
v_cvt_pk_bf16_f32 v49, v52, v53
v_pk_add_f32 v[56:57], v[56:57], v[58:59]
v_cvt_pk_bf16_f32 v50, v56, v57
v_pk_add_f32 v[60:61], v[60:61], v[62:63]
v_cvt_pk_bf16_f32 v51, v60, v61
buffer_store_dwordx4 v[48:51], v8, s[4:7], s61 offen
s_add_u32 s45, s45, 262144
s_add_u32 s51, s51, 262144
v_mfma_f32_32x32x8_bf16 v[96:111], v[14:15], v[14:15], 0
v_mfma_f32_16x16x16_bf16 v[112:115], v[14:15], v[14:15], 0
v_mfma_f32_16x16x16_bf16 v[116:119], v[14:15], v[14:15], 0
ds_read_b128 v[64:67], v1 offset:12288
ds_read_b128 v[68:71], v1 offset:13312
ds_read_b128 v[72:75], v1 offset:14336
ds_read_b128 v[76:79], v1 offset:15360
ds_read_b128 v[80:83], v1 offset:28672
ds_read_b128 v[84:87], v1 offset:29696
ds_read_b128 v[88:91], v1 offset:30720
ds_read_b128 v[92:95], v1 offset:31744
s_add_u32 s22, s21, 2
s_cmp_gt_u32 s50, s22
s_cbranch_scc1 L_rf_w3_kvs
v_readlane_b32 s50, v12, 0
v_readlane_b32 s22, v12, 2
v_readlane_b32 s23, v12, 1
v_readlane_b32 s24, v12, 3
s_nop 3
s_min_u32 s50, s50, s22
s_min_u32 s23, s23, s24
s_lshl_b32 s50, s50, 1
s_lshl_b32 s23, s23, 1
s_add_u32 s23, s23, 1
s_min_u32 s50, s50, s23
L_rf_kvb1:
s_add_u32 s22, s21, 1
s_min_u32 s22, s22, 63
s_cmp_gt_u32 s50, s22
s_cbranch_scc1 L_rf_kvd1
buffer_load_dword v12, v7, s[4:7], 0 offen sc1
s_waitcnt vmcnt(0)
v_readlane_b32 s50, v12, 0
v_readlane_b32 s22, v12, 2
v_readlane_b32 s23, v12, 1
v_readlane_b32 s24, v12, 3
s_nop 3
s_min_u32 s50, s50, s22
s_min_u32 s23, s23, s24
s_lshl_b32 s50, s50, 1
s_lshl_b32 s23, s23, 1
s_add_u32 s23, s23, 1
s_min_u32 s50, s50, s23
s_branch L_rf_kvb1
L_rf_kvd1:
L_rf_w3_kvs:
v_mov_b32 v58, -1
v_mov_b32 v59, -1
s_waitcnt vmcnt(0)
L_rf_w3_cgo:
L_rf_w3_pc:
buffer_load_dword v36, v13, s[4:7], s25 offen sc1
buffer_load_dword v37, v13, s[4:7], s25 offen offset:256 sc1
buffer_load_dword v38, v13, s[4:7], s25 offen offset:512 sc1
buffer_load_dword v39, v13, s[4:7], s25 offen offset:768 sc1
buffer_load_dword v40, v13, s[4:7], s25 offen offset:1024 sc1
buffer_load_dword v41, v13, s[4:7], s25 offen offset:1280 sc1
buffer_load_dword v42, v13, s[4:7], s25 offen offset:1536 sc1
buffer_load_dword v43, v13, s[4:7], s25 offen offset:1792 sc1
s_waitcnt vmcnt(4)
v_mfma_f32_16x16x32_bf16 v[52:55], v[36:39], v[24:27], 0
v_bitop3_b32 v3, s42, v36, v37 bitop3:0x7e
v_bitop3_b32 v4, s42, v38, v39 bitop3:0x7e
s_waitcnt vmcnt(2)
v_or_b32 v3, v3, v4
v_bitop3_b32 v4, s42, v40, v41 bitop3:0x7e
s_waitcnt vmcnt(0)
v_mfma_f32_16x16x32_bf16 v[52:55], v[40:43], v[24:27], v[52:55]
v_bitop3_b32 v56, s42, v42, v43 bitop3:0x7e
v_or3_b32 v3, v3, v4, v56
v_and_b32 v3, v0, v3
v_cmp_ne_u32 vcc, 0, v3
s_nop 3
v_cvt_pk_bf16_f32 v56, v52, v53
v_cvt_pk_bf16_f32 v57, v54, v55
v_min_u32 v56, -2, v56
s_cbranch_vccnz L_rf_w3_pc
s_mov_b64 exec, s[26:27]
buffer_store_dwordx2 v[56:57], v9, s[4:7], s35 offen offset:768
buffer_store_dwordx2 v[58:59], v9, s[4:7], s36 offen offset:768
s_mov_b64 exec, -1
s_xor_b32 s42, s42, 1
s_branch L_rf_w3_loop
L_rf_w3_last:
buffer_store_dwordx4 v[64:67], v10, s[4:7], s45 offen offset:192 sc1
buffer_store_dwordx2 v[18:19], v11, s[4:7], s51 offen offset:3584 sc1
s_branch L_rf_end
L_rf_w3_pafail:
s_nop 7
v_mov_b32 v96, 0
v_mov_b32 v97, 0
v_mov_b32 v98, 0
v_mov_b32 v99, 0
v_mov_b32 v100, 0
v_mov_b32 v101, 0
v_mov_b32 v102, 0
v_mov_b32 v103, 0
v_mov_b32 v104, 0
v_mov_b32 v105, 0
v_mov_b32 v106, 0
v_mov_b32 v107, 0
s_branch L_rf_w3_pa
L_rf_w3_xslow:
buffer_load_dwordx2 v[108:109], v11, s[4:7], s38 offen sc1
buffer_load_dwordx2 v[110:111], v11, s[4:7], s38 offen offset:512 sc1
s_waitcnt vmcnt(2)
v_bitop3_b32 v3, s41, v20, v22 bitop3:0x7e
v_mfma_f32_16x16x16_bf16 v[80:83], v[20:21], v[16:17], v[100:103]
v_and_b32 v3, 1, v3
v_mfma_f32_16x16x16_bf16 v[84:87], v[22:23], v[16:17], v[104:107]
v_cmp_ne_u32 vcc, 0, v3
s_cbranch_vccz L_rf_w3_xgot
buffer_load_dwordx2 v[20:21], v11, s[4:7], s38 offen sc1
buffer_load_dwordx2 v[22:23], v11, s[4:7], s38 offen offset:512 sc1
s_waitcnt vmcnt(2)
v_bitop3_b32 v3, s41, v108, v110 bitop3:0x7e
v_mfma_f32_16x16x16_bf16 v[80:83], v[108:109], v[16:17], v[100:103]
v_and_b32 v3, 1, v3
v_mfma_f32_16x16x16_bf16 v[84:87], v[110:111], v[16:17], v[104:107]
v_cmp_ne_u32 vcc, 0, v3
s_cbranch_vccz L_rf_w3_xgot
s_branch L_rf_w3_xslow
L_rf_w3_xgot:
s_nop 3
v_cvt_pk_bf16_f32 v64, v80, v81
v_cvt_pk_bf16_f32 v65, v82, v83
v_cvt_pk_bf16_f32 v66, v84, v85
v_cvt_pk_bf16_f32 v67, v86, v87
ds_write_b128 v6, v[64:67] offset:23552
s_branch L_rf_w3_xok
L_rf_w3_pv0:
s_waitcnt vmcnt(2)
s_branch L_rf_w3_pv1
L_rf_w3_pv:
buffer_load_dwordx2 v[20:21], v11, s[4:7], s40 offen sc1
s_waitcnt vmcnt(0)
L_rf_w3_pv1:
v_and_b32 v3, 1, v20
v_cmp_ne_u32 vcc, s41, v3
v_mov_b32 v113, v20
v_mov_b32 v115, v21
s_cbranch_vccnz L_rf_w3_pv
s_branch L_rf_w3_pv2
L_rf_end:
s_mov_b64 exec, -1
v_mov_b32 v3, 64
s_waitcnt vmcnt(0)
s_barrier
s_cmp_lg_u32 s20, 0
s_cbranch_scc1 L_rf_end2
buffer_store_dword v3, v7, s[4:7], 0 offen sc1
L_rf_end2:
s_waitcnt vmcnt(0)
s_endpgm
L_recs:
s_load_dwordx2 s[4:5], s[0:1], 96
s_load_dwordx2 s[12:13], s[0:1], 88
s_load_dwordx2 s[50:51], s[0:1], 16
s_load_dwordx2 s[52:53], s[0:1], 24
s_load_dwordx2 s[54:55], s[0:1], 32
s_load_dwordx2 s[56:57], s[0:1], 40
s_load_dwordx2 s[58:59], s[0:1], 8
v_lshrrev_b32 v3, 6, v0
v_and_b32 v40, 63, v0
v_readfirstlane_b32 s20, v3
v_lshrrev_b32 v41, 4, v40
v_and_b32 v42, 15, v40
v_lshlrev_b32 v1, 4, v40
s_mov_b32 s49, 0
s_waitcnt lgkmcnt(0)
s_mov_b32 s6, 268435456
s_mov_b32 s7, 0x00020000
s_mov_b32 s14, 256
s_mov_b32 s15, 0x00020000
s_mov_b32 s10, 8388608
s_mov_b32 s11, 0x00020000
s_mov_b32 s26, 0x00030003
s_mov_b32 s27, 0x00030003
s_mov_b32 s28, 0xcccccccc
s_mov_b32 s29, 0xcccccccc
s_mov_b32 s32, 0x33333333
s_mov_b32 s33, 0x33333333
s_mov_b32 s34, 0x3e0293ee
s_lshl_b32 s22, s20, 2
v_xor_b32 v3, s22, v42
v_lshlrev_b32 v3, 4, v3
v_lshl_add_u32 v4, v41, 4, s20
v_lshl_add_u32 v44, v4, 13, v3
s_lshl_b32 s22, s30, 22
s_lshl_b32 s23, s31, 8
s_add_u32 s22, s22, s23
v_add_u32 v44, s22, v44
s_and_b32 s23, s20, 1
s_lshl_b32 s23, s23, 7
v_xor_b32 v45, s23, v1
s_lshl_b32 s22, s31, 18
s_lshl_b32 s23, s20, 13
s_add_u32 s22, s22, s23
s_lshl_b32 s23, s30, 10
s_add_u32 s22, s22, s23
v_add_u32 v45, s22, v45
v_xor_b32 v61, 32, v45
v_xor_b32 v62, 64, v45
v_xor_b32 v63, 96, v45
s_lshl_b32 s43, s20, 12
s_lshl_b32 s48, s20, 10
s_mov_b32 s8, s50
s_mov_b32 s9, s51
s_add_u32 m0, s48, 0
s_mov_b32 s22, 0
buffer_load_dwordx4 v44, s[8:11], s22 offen  lds
s_add_u32 m0, s48, 4096
s_mov_b32 s22, 32768
buffer_load_dwordx4 v44, s[8:11], s22 offen  lds
s_add_u32 m0, s48, 8192
s_mov_b32 s22, 65536
buffer_load_dwordx4 v44, s[8:11], s22 offen  lds
s_add_u32 m0, s48, 12288
s_mov_b32 s22, 98304
buffer_load_dwordx4 v44, s[8:11], s22 offen  lds
s_add_u32 m0, s48, 16384
s_mov_b32 s22, 524288
buffer_load_dwordx4 v44, s[8:11], s22 offen  lds
s_add_u32 m0, s48, 20480
s_mov_b32 s22, 557056
buffer_load_dwordx4 v44, s[8:11], s22 offen  lds
s_add_u32 m0, s48, 24576
s_mov_b32 s22, 589824
buffer_load_dwordx4 v44, s[8:11], s22 offen  lds
s_add_u32 m0, s48, 28672
s_mov_b32 s22, 622592
buffer_load_dwordx4 v44, s[8:11], s22 offen  lds
s_add_u32 m0, s48, 32768
s_mov_b32 s22, 1048576
buffer_load_dwordx4 v44, s[8:11], s22 offen  lds
s_add_u32 m0, s48, 36864
s_mov_b32 s22, 1081344
buffer_load_dwordx4 v44, s[8:11], s22 offen  lds
s_add_u32 m0, s48, 40960
s_mov_b32 s22, 1114112
buffer_load_dwordx4 v44, s[8:11], s22 offen  lds
s_add_u32 m0, s48, 45056
s_mov_b32 s22, 1146880
buffer_load_dwordx4 v44, s[8:11], s22 offen  lds
s_add_u32 m0, s48, 49152
s_mov_b32 s22, 1572864
buffer_load_dwordx4 v44, s[8:11], s22 offen  lds
s_add_u32 m0, s48, 53248
s_mov_b32 s22, 1605632
buffer_load_dwordx4 v44, s[8:11], s22 offen  lds
s_add_u32 m0, s48, 57344
s_mov_b32 s22, 1638400
buffer_load_dwordx4 v44, s[8:11], s22 offen  lds
s_add_u32 m0, s48, 61440
s_mov_b32 s22, 1671168
buffer_load_dwordx4 v44, s[8:11], s22 offen  lds
s_add_u32 m0, s48, 65536
s_mov_b32 s22, 2097152
buffer_load_dwordx4 v44, s[8:11], s22 offen  lds
s_add_u32 m0, s48, 69632
s_mov_b32 s22, 2129920
buffer_load_dwordx4 v44, s[8:11], s22 offen  lds
s_add_u32 m0, s48, 73728
s_mov_b32 s22, 2162688
buffer_load_dwordx4 v44, s[8:11], s22 offen  lds
s_add_u32 m0, s48, 77824
s_mov_b32 s22, 2195456
buffer_load_dwordx4 v44, s[8:11], s22 offen  lds
s_add_u32 m0, s48, 81920
s_mov_b32 s22, 2621440
buffer_load_dwordx4 v44, s[8:11], s22 offen  lds
s_add_u32 m0, s48, 86016
s_mov_b32 s22, 2654208
buffer_load_dwordx4 v44, s[8:11], s22 offen  lds
s_add_u32 m0, s48, 90112
s_mov_b32 s22, 2686976
buffer_load_dwordx4 v44, s[8:11], s22 offen  lds
s_add_u32 m0, s48, 94208
s_mov_b32 s22, 2719744
buffer_load_dwordx4 v44, s[8:11], s22 offen  lds
s_add_u32 m0, s48, 98304
s_mov_b32 s22, 3145728
buffer_load_dwordx4 v44, s[8:11], s22 offen  lds
s_add_u32 m0, s48, 102400
s_mov_b32 s22, 3178496
buffer_load_dwordx4 v44, s[8:11], s22 offen  lds
s_add_u32 m0, s48, 106496
s_mov_b32 s22, 3211264
buffer_load_dwordx4 v44, s[8:11], s22 offen  lds
s_add_u32 m0, s48, 110592
s_mov_b32 s22, 3244032
buffer_load_dwordx4 v44, s[8:11], s22 offen  lds
s_add_u32 m0, s48, 114688
s_mov_b32 s22, 3670016
buffer_load_dwordx4 v44, s[8:11], s22 offen  lds
s_add_u32 m0, s48, 118784
s_mov_b32 s22, 3702784
buffer_load_dwordx4 v44, s[8:11], s22 offen  lds
s_add_u32 m0, s48, 122880
s_mov_b32 s22, 3735552
buffer_load_dwordx4 v44, s[8:11], s22 offen  lds
s_add_u32 m0, s48, 126976
s_mov_b32 s22, 3768320
buffer_load_dwordx4 v44, s[8:11], s22 offen  lds
s_lshl_b32 s22, s30, 5
s_add_u32 s22, s22, s31
s_lshl_b32 s38, s22, 14
s_xor_b32 s22, s22, 32
s_lshl_b32 s37, s22, 14
s_add_u32 s38, s38, 67108864
s_add_u32 s37, s37, 67108864
s_lshl_b32 s46, s30, 19
s_add_u32 s46, s46, 70254592
s_mul_i32 s22, s31, 8448
s_add_u32 s47, s46, s22
s_mul_i32 s22, s20, 67584
s_add_u32 s46, s46, s22
s_lshl_b32 s22, s31, 6
s_add_u32 s46, s46, s22
s_add_u32 s61, s46, 33792
s_mul_i32 s22, s20, 2048
s_add_u32 s25, s47, s22
s_lshl_b32 s35, s30, 13
s_add_u32 s35, s35, 69206016
v_lshrrev_b32 v53, 2, v42
v_lshlrev_b32 v53, 1, v53
v_and_b32 v54, 1, v42
v_add_u32 v55, v53, v54
v_mov_b32 v14, 0
v_mov_b32 v15, 0
v_mov_b32 v2, 0x4444
v_mov_b32 v3, 0xeeee
v_cndmask_b32 v2, v2, v3, s[28:29]
s_lshl_b32 s22, s20, 12
v_add_u32 v32, s22, v1
v_add_u32 v33, 0x10000, v32
v_add_u32 v5, 0x10000, v1
v_add_u32 v6, 131072, v1
v_and_b32 v3, 3, v42
v_bfe_u32 v43, v40, 1, 1
v_lshlrev_b32 v7, 13, v43
v_and_b32 v43, 1, v40
v_lshl_add_u32 v7, v43, 7, v7
s_lshl_b32 s22, s31, 8
s_add_u32 s23, s22, 71311360
v_add_u32 v7, s23, v7
s_cmp_lg_u32 s20, 0
s_cbranch_scc1 L_rs_flk
s_lshl_b32 s23, s30, 7
s_add_u32 s22, s22, s23
s_add_u32 s22, s22, 71327744
v_bfrev_b32 v7, 1
v_writelane_b32 v7, s22, 0
L_rs_flk:
v_lshlrev_b32 v11, 3, v40
v_lshlrev_b32 v10, 8, v55
v_lshl_add_u32 v10, v41, 4, v10
v_mul_u32_u24 v8, 8448, v41
v_lshl_add_u32 v8, v3, 4, v8
v_lshrrev_b32 v4, 2, v42
v_mul_u32_u24 v4, 2048, v4
v_add_u32 v8, v4, v8
v_lshrrev_b32 v9, 1, v41
v_lshlrev_b32 v9, 5, v9
v_and_b32 v4, 1, v42
v_lshl_add_u32 v9, v4, 4, v9
v_and_b32 v4, 1, v41
v_lshl_add_u32 v9, v4, 3, v9
s_lshr_b32 s22, s31, 2
s_lshl_b32 s22, s22, 10
s_and_b32 s23, s31, 3
s_lshl_b32 s23, s23, 6
s_add_u32 s22, s22, s23
v_add_u32 v9, s22, v9
v_lshrrev_b32 v4, 2, v42
v_lshlrev_b32 v12, 8, v4
v_lshl_add_u32 v12, v41, 6, v12
v_lshl_add_u32 v12, v3, 4, v12
v_lshlrev_b32 v13, 6, v41
v_lshl_add_u32 v13, v42, 2, v13
v_cmp_eq_u32 vcc, 0, v3
v_mov_b32 v28, 0x3f803f80
v_mov_b32 v29, 0x3f803f80
v_cndmask_b32 v34, 0, 1, vcc
v_mov_b32 v30, 0x3f803f80
v_mov_b32 v31, 0x3f803f80
v_and_b32 v49, 1, v42
v_lshlrev_b32 v49, 4, v49
v_mov_b32 v50, 0x3f80
v_lshlrev_b32 v50, v49, v50
v_lshrrev_b32 v51, 2, v42
v_cmp_eq_u32 vcc, v51, v41
v_mov_b32 v24, v50
v_cndmask_b32 v52, 0, v50, s[28:29]
v_cndmask_b32 v53, 0, v50, s[32:33]
v_cndmask_b32 v16, 0, v52, vcc
v_cndmask_b32 v17, 0, v53, vcc
v_mov_b32 v25, v50
v_mov_b32 v26, v50
v_mov_b32 v27, v50
v_bfe_u32 v60, v40, 3, 1
v_bfe_u32 v49, v40, 2, 1
v_and_b32 v50, 1, v41
v_lshrrev_b32 v51, 1, v41
v_lshlrev_b32 v52, 3, v60
v_lshl_add_u32 v52, v50, 2, v52
v_lshl_add_u32 v53, v51, 4, v52
v_add_u32 v53, v53, v49
v_and_b32 v54, 3, v40
s_lshl_b32 s22, s20, 2
v_add_u32 v55, s22, v54
v_xor_b32 v55, v55, v52
v_lshlrev_b32 v55, 4, v55
v_lshl_add_u32 v46, v53, 8, v55
v_lshrrev_b32 v55, 2, v40
v_lshlrev_b32 v47, 10, v55
v_and_b32 v55, 7, v55
v_lshl_add_u32 v47, v55, 5, v47
v_lshl_add_u32 v47, v54, 3, v47
s_lshl_b32 s22, s20, 8
v_add_u32 v47, s22, v47
s_waitcnt vmcnt(28) lgkmcnt(0)
s_barrier
v_add_u32 v48, 0, v46
ds_read_b64_tr_b16 a[0:1], v48
ds_read_b64_tr_b16 a[2:3], v48 offset:512
ds_read_b64_tr_b16 a[4:5], v48 offset:8192
ds_read_b64_tr_b16 a[6:7], v48 offset:8704
ds_read_b64_tr_b16 a[8:9], v48 offset:8
ds_read_b64_tr_b16 a[10:11], v48 offset:520
ds_read_b64_tr_b16 a[12:13], v48 offset:8200
ds_read_b64_tr_b16 a[14:15], v48 offset:8712
s_waitcnt vmcnt(24) lgkmcnt(0)
s_barrier
s_mov_b32 s8, s52
s_mov_b32 s9, s53
s_add_u32 m0, s48, 0
s_mov_b32 s22, 0
buffer_load_dwordx4 v44, s[8:11], s22 offen  lds
s_add_u32 m0, s48, 4096
s_mov_b32 s22, 32768
buffer_load_dwordx4 v44, s[8:11], s22 offen  lds
s_add_u32 m0, s48, 8192
s_mov_b32 s22, 65536
buffer_load_dwordx4 v44, s[8:11], s22 offen  lds
s_add_u32 m0, s48, 12288
s_mov_b32 s22, 98304
buffer_load_dwordx4 v44, s[8:11], s22 offen  lds
v_add_u32 v48, 16384, v46
ds_read_b64_tr_b16 a[16:17], v48
ds_read_b64_tr_b16 a[18:19], v48 offset:512
ds_read_b64_tr_b16 a[20:21], v48 offset:8192
ds_read_b64_tr_b16 a[22:23], v48 offset:8704
ds_read_b64_tr_b16 a[24:25], v48 offset:8
ds_read_b64_tr_b16 a[26:27], v48 offset:520
ds_read_b64_tr_b16 a[28:29], v48 offset:8200
ds_read_b64_tr_b16 a[30:31], v48 offset:8712
s_waitcnt vmcnt(24) lgkmcnt(0)
s_barrier
s_add_u32 m0, s48, 16384
s_mov_b32 s22, 524288
buffer_load_dwordx4 v44, s[8:11], s22 offen  lds
s_add_u32 m0, s48, 20480
s_mov_b32 s22, 557056
buffer_load_dwordx4 v44, s[8:11], s22 offen  lds
s_add_u32 m0, s48, 24576
s_mov_b32 s22, 589824
buffer_load_dwordx4 v44, s[8:11], s22 offen  lds
s_add_u32 m0, s48, 28672
s_mov_b32 s22, 622592
buffer_load_dwordx4 v44, s[8:11], s22 offen  lds
v_add_u32 v48, 32768, v46
ds_read_b64_tr_b16 a[32:33], v48
ds_read_b64_tr_b16 a[34:35], v48 offset:512
ds_read_b64_tr_b16 a[36:37], v48 offset:8192
ds_read_b64_tr_b16 a[38:39], v48 offset:8704
ds_read_b64_tr_b16 a[40:41], v48 offset:8
ds_read_b64_tr_b16 a[42:43], v48 offset:520
ds_read_b64_tr_b16 a[44:45], v48 offset:8200
ds_read_b64_tr_b16 a[46:47], v48 offset:8712
s_waitcnt vmcnt(24) lgkmcnt(0)
s_barrier
s_add_u32 m0, s48, 32768
s_mov_b32 s22, 1048576
buffer_load_dwordx4 v44, s[8:11], s22 offen  lds
s_add_u32 m0, s48, 36864
s_mov_b32 s22, 1081344
buffer_load_dwordx4 v44, s[8:11], s22 offen  lds
s_add_u32 m0, s48, 40960
s_mov_b32 s22, 1114112
buffer_load_dwordx4 v44, s[8:11], s22 offen  lds
s_add_u32 m0, s48, 45056
s_mov_b32 s22, 1146880
buffer_load_dwordx4 v44, s[8:11], s22 offen  lds
v_add_u32 v48, 49152, v46
ds_read_b64_tr_b16 a[48:49], v48
ds_read_b64_tr_b16 a[50:51], v48 offset:512
ds_read_b64_tr_b16 a[52:53], v48 offset:8192
ds_read_b64_tr_b16 a[54:55], v48 offset:8704
ds_read_b64_tr_b16 a[56:57], v48 offset:8
ds_read_b64_tr_b16 a[58:59], v48 offset:520
ds_read_b64_tr_b16 a[60:61], v48 offset:8200
ds_read_b64_tr_b16 a[62:63], v48 offset:8712
s_waitcnt vmcnt(24) lgkmcnt(0)
s_barrier
s_add_u32 m0, s48, 49152
s_mov_b32 s22, 1572864
buffer_load_dwordx4 v44, s[8:11], s22 offen  lds
s_add_u32 m0, s48, 53248
s_mov_b32 s22, 1605632
buffer_load_dwordx4 v44, s[8:11], s22 offen  lds
s_add_u32 m0, s48, 57344
s_mov_b32 s22, 1638400
buffer_load_dwordx4 v44, s[8:11], s22 offen  lds
s_add_u32 m0, s48, 61440
s_mov_b32 s22, 1671168
buffer_load_dwordx4 v44, s[8:11], s22 offen  lds
v_add_u32 v48, 65536, v46
ds_read_b64_tr_b16 a[64:65], v48
ds_read_b64_tr_b16 a[66:67], v48 offset:512
ds_read_b64_tr_b16 a[68:69], v48 offset:8192
ds_read_b64_tr_b16 a[70:71], v48 offset:8704
ds_read_b64_tr_b16 a[72:73], v48 offset:8
ds_read_b64_tr_b16 a[74:75], v48 offset:520
ds_read_b64_tr_b16 a[76:77], v48 offset:8200
ds_read_b64_tr_b16 a[78:79], v48 offset:8712
s_waitcnt vmcnt(24) lgkmcnt(0)
s_barrier
s_add_u32 m0, s48, 65536
s_mov_b32 s22, 2097152
buffer_load_dwordx4 v44, s[8:11], s22 offen  lds
s_add_u32 m0, s48, 69632
s_mov_b32 s22, 2129920
buffer_load_dwordx4 v44, s[8:11], s22 offen  lds
s_add_u32 m0, s48, 73728
s_mov_b32 s22, 2162688
buffer_load_dwordx4 v44, s[8:11], s22 offen  lds
s_add_u32 m0, s48, 77824
s_mov_b32 s22, 2195456
buffer_load_dwordx4 v44, s[8:11], s22 offen  lds
v_add_u32 v48, 81920, v46
ds_read_b64_tr_b16 a[80:81], v48
ds_read_b64_tr_b16 a[82:83], v48 offset:512
ds_read_b64_tr_b16 a[84:85], v48 offset:8192
ds_read_b64_tr_b16 a[86:87], v48 offset:8704
ds_read_b64_tr_b16 a[88:89], v48 offset:8
ds_read_b64_tr_b16 a[90:91], v48 offset:520
ds_read_b64_tr_b16 a[92:93], v48 offset:8200
ds_read_b64_tr_b16 a[94:95], v48 offset:8712
s_waitcnt vmcnt(24) lgkmcnt(0)
s_barrier
s_add_u32 m0, s48, 81920
s_mov_b32 s22, 2621440
buffer_load_dwordx4 v44, s[8:11], s22 offen  lds
s_add_u32 m0, s48, 86016
s_mov_b32 s22, 2654208
buffer_load_dwordx4 v44, s[8:11], s22 offen  lds
s_add_u32 m0, s48, 90112
s_mov_b32 s22, 2686976
buffer_load_dwordx4 v44, s[8:11], s22 offen  lds
s_add_u32 m0, s48, 94208
s_mov_b32 s22, 2719744
buffer_load_dwordx4 v44, s[8:11], s22 offen  lds
v_add_u32 v48, 98304, v46
ds_read_b64_tr_b16 a[96:97], v48
ds_read_b64_tr_b16 a[98:99], v48 offset:512
ds_read_b64_tr_b16 a[100:101], v48 offset:8192
ds_read_b64_tr_b16 a[102:103], v48 offset:8704
ds_read_b64_tr_b16 a[104:105], v48 offset:8
ds_read_b64_tr_b16 a[106:107], v48 offset:520
ds_read_b64_tr_b16 a[108:109], v48 offset:8200
ds_read_b64_tr_b16 a[110:111], v48 offset:8712
s_waitcnt vmcnt(24) lgkmcnt(0)
s_barrier
s_add_u32 m0, s48, 98304
s_mov_b32 s22, 3145728
buffer_load_dwordx4 v44, s[8:11], s22 offen  lds
s_add_u32 m0, s48, 102400
s_mov_b32 s22, 3178496
buffer_load_dwordx4 v44, s[8:11], s22 offen  lds
s_add_u32 m0, s48, 106496
s_mov_b32 s22, 3211264
buffer_load_dwordx4 v44, s[8:11], s22 offen  lds
s_add_u32 m0, s48, 110592
s_mov_b32 s22, 3244032
buffer_load_dwordx4 v44, s[8:11], s22 offen  lds
v_add_u32 v48, 114688, v46
ds_read_b64_tr_b16 a[112:113], v48
ds_read_b64_tr_b16 a[114:115], v48 offset:512
ds_read_b64_tr_b16 a[116:117], v48 offset:8192
ds_read_b64_tr_b16 a[118:119], v48 offset:8704
ds_read_b64_tr_b16 a[120:121], v48 offset:8
ds_read_b64_tr_b16 a[122:123], v48 offset:520
ds_read_b64_tr_b16 a[124:125], v48 offset:8200
ds_read_b64_tr_b16 a[126:127], v48 offset:8712
s_waitcnt vmcnt(24) lgkmcnt(0)
s_barrier
s_add_u32 m0, s48, 114688
s_mov_b32 s22, 3670016
buffer_load_dwordx4 v44, s[8:11], s22 offen  lds
s_add_u32 m0, s48, 118784
s_mov_b32 s22, 3702784
buffer_load_dwordx4 v44, s[8:11], s22 offen  lds
s_add_u32 m0, s48, 122880
s_mov_b32 s22, 3735552
buffer_load_dwordx4 v44, s[8:11], s22 offen  lds
s_add_u32 m0, s48, 126976
s_mov_b32 s22, 3768320
buffer_load_dwordx4 v44, s[8:11], s22 offen  lds
v_add_u32 v48, 0, v46
ds_read_b64_tr_b16 a[128:129], v48
ds_read_b64_tr_b16 a[130:131], v48 offset:512
ds_read_b64_tr_b16 a[132:133], v48 offset:8192
ds_read_b64_tr_b16 a[134:135], v48 offset:8704
ds_read_b64_tr_b16 a[136:137], v48 offset:8
ds_read_b64_tr_b16 a[138:139], v48 offset:520
ds_read_b64_tr_b16 a[140:141], v48 offset:8200
ds_read_b64_tr_b16 a[142:143], v48 offset:8712
s_waitcnt vmcnt(24) lgkmcnt(0)
s_barrier
s_mov_b32 s8, s56
s_mov_b32 s9, s57
s_add_u32 m0, s43, 0
s_mov_b32 s22, 0
buffer_load_dwordx4 v45, s[8:11], s22 offen  lds
s_add_u32 m0, s43, 1024
s_mov_b32 s22, 2048
buffer_load_dwordx4 v61, s[8:11], s22 offen  lds
s_add_u32 m0, s43, 2048
s_mov_b32 s22, 65536
buffer_load_dwordx4 v62, s[8:11], s22 offen  lds
s_add_u32 m0, s43, 3072
s_mov_b32 s22, 67584
buffer_load_dwordx4 v63, s[8:11], s22 offen  lds
v_add_u32 v48, 16384, v46
ds_read_b64_tr_b16 a[144:145], v48
ds_read_b64_tr_b16 a[146:147], v48 offset:512
ds_read_b64_tr_b16 a[148:149], v48 offset:8192
ds_read_b64_tr_b16 a[150:151], v48 offset:8704
ds_read_b64_tr_b16 a[152:153], v48 offset:8
ds_read_b64_tr_b16 a[154:155], v48 offset:520
ds_read_b64_tr_b16 a[156:157], v48 offset:8200
ds_read_b64_tr_b16 a[158:159], v48 offset:8712
s_waitcnt vmcnt(24) lgkmcnt(0)
s_barrier
s_add_u32 m0, s43, 16384
s_mov_b32 s22, 4096
buffer_load_dwordx4 v45, s[8:11], s22 offen  lds
s_add_u32 m0, s43, 17408
s_mov_b32 s22, 6144
buffer_load_dwordx4 v61, s[8:11], s22 offen  lds
s_add_u32 m0, s43, 18432
s_mov_b32 s22, 69632
buffer_load_dwordx4 v62, s[8:11], s22 offen  lds
s_add_u32 m0, s43, 19456
s_mov_b32 s22, 71680
buffer_load_dwordx4 v63, s[8:11], s22 offen  lds
v_add_u32 v48, 32768, v46
ds_read_b64_tr_b16 a[160:161], v48
ds_read_b64_tr_b16 a[162:163], v48 offset:512
ds_read_b64_tr_b16 a[164:165], v48 offset:8192
ds_read_b64_tr_b16 a[166:167], v48 offset:8704
ds_read_b64_tr_b16 a[168:169], v48 offset:8
ds_read_b64_tr_b16 a[170:171], v48 offset:520
ds_read_b64_tr_b16 a[172:173], v48 offset:8200
ds_read_b64_tr_b16 a[174:175], v48 offset:8712
s_waitcnt vmcnt(24) lgkmcnt(0)
s_barrier
s_add_u32 m0, s43, 32768
s_mov_b32 s22, 32768
buffer_load_dwordx4 v45, s[8:11], s22 offen  lds
s_add_u32 m0, s43, 33792
s_mov_b32 s22, 34816
buffer_load_dwordx4 v61, s[8:11], s22 offen  lds
s_add_u32 m0, s43, 34816
s_mov_b32 s22, 98304
buffer_load_dwordx4 v62, s[8:11], s22 offen  lds
s_add_u32 m0, s43, 35840
s_mov_b32 s22, 100352
buffer_load_dwordx4 v63, s[8:11], s22 offen  lds
v_add_u32 v48, 49152, v46
ds_read_b64_tr_b16 a[176:177], v48
ds_read_b64_tr_b16 a[178:179], v48 offset:512
ds_read_b64_tr_b16 a[180:181], v48 offset:8192
ds_read_b64_tr_b16 a[182:183], v48 offset:8704
ds_read_b64_tr_b16 a[184:185], v48 offset:8
ds_read_b64_tr_b16 a[186:187], v48 offset:520
ds_read_b64_tr_b16 a[188:189], v48 offset:8200
ds_read_b64_tr_b16 a[190:191], v48 offset:8712
s_waitcnt vmcnt(24) lgkmcnt(0)
s_barrier
s_add_u32 m0, s43, 49152
s_mov_b32 s22, 36864
buffer_load_dwordx4 v45, s[8:11], s22 offen  lds
s_add_u32 m0, s43, 50176
s_mov_b32 s22, 38912
buffer_load_dwordx4 v61, s[8:11], s22 offen  lds
s_add_u32 m0, s43, 51200
s_mov_b32 s22, 102400
buffer_load_dwordx4 v62, s[8:11], s22 offen  lds
s_add_u32 m0, s43, 52224
s_mov_b32 s22, 104448
buffer_load_dwordx4 v63, s[8:11], s22 offen  lds
v_add_u32 v48, 65536, v46
ds_read_b64_tr_b16 a[192:193], v48
ds_read_b64_tr_b16 a[194:195], v48 offset:512
ds_read_b64_tr_b16 a[196:197], v48 offset:8192
ds_read_b64_tr_b16 a[198:199], v48 offset:8704
ds_read_b64_tr_b16 a[200:201], v48 offset:8
ds_read_b64_tr_b16 a[202:203], v48 offset:520
ds_read_b64_tr_b16 a[204:205], v48 offset:8200
ds_read_b64_tr_b16 a[206:207], v48 offset:8712
s_waitcnt vmcnt(24) lgkmcnt(0)
s_barrier
s_add_u32 m0, s43, 65536
s_mov_b32 s22, 131072
buffer_load_dwordx4 v45, s[8:11], s22 offen  lds
s_add_u32 m0, s43, 66560
s_mov_b32 s22, 133120
buffer_load_dwordx4 v61, s[8:11], s22 offen  lds
s_add_u32 m0, s43, 67584
s_mov_b32 s22, 196608
buffer_load_dwordx4 v62, s[8:11], s22 offen  lds
s_add_u32 m0, s43, 68608
s_mov_b32 s22, 198656
buffer_load_dwordx4 v63, s[8:11], s22 offen  lds
v_add_u32 v48, 81920, v46
ds_read_b64_tr_b16 a[208:209], v48
ds_read_b64_tr_b16 a[210:211], v48 offset:512
ds_read_b64_tr_b16 a[212:213], v48 offset:8192
ds_read_b64_tr_b16 a[214:215], v48 offset:8704
ds_read_b64_tr_b16 a[216:217], v48 offset:8
ds_read_b64_tr_b16 a[218:219], v48 offset:520
ds_read_b64_tr_b16 a[220:221], v48 offset:8200
ds_read_b64_tr_b16 a[222:223], v48 offset:8712
s_waitcnt vmcnt(24) lgkmcnt(0)
s_barrier
s_add_u32 m0, s43, 81920
s_mov_b32 s22, 135168
buffer_load_dwordx4 v45, s[8:11], s22 offen  lds
s_add_u32 m0, s43, 82944
s_mov_b32 s22, 137216
buffer_load_dwordx4 v61, s[8:11], s22 offen  lds
s_add_u32 m0, s43, 83968
s_mov_b32 s22, 200704
buffer_load_dwordx4 v62, s[8:11], s22 offen  lds
s_add_u32 m0, s43, 84992
s_mov_b32 s22, 202752
buffer_load_dwordx4 v63, s[8:11], s22 offen  lds
v_add_u32 v48, 98304, v46
ds_read_b64_tr_b16 a[224:225], v48
ds_read_b64_tr_b16 a[226:227], v48 offset:512
ds_read_b64_tr_b16 a[228:229], v48 offset:8192
ds_read_b64_tr_b16 a[230:231], v48 offset:8704
ds_read_b64_tr_b16 a[232:233], v48 offset:8
ds_read_b64_tr_b16 a[234:235], v48 offset:520
ds_read_b64_tr_b16 a[236:237], v48 offset:8200
ds_read_b64_tr_b16 a[238:239], v48 offset:8712
s_waitcnt vmcnt(24) lgkmcnt(0)
s_barrier
s_add_u32 m0, s43, 98304
s_mov_b32 s22, 163840
buffer_load_dwordx4 v45, s[8:11], s22 offen  lds
s_add_u32 m0, s43, 99328
s_mov_b32 s22, 165888
buffer_load_dwordx4 v61, s[8:11], s22 offen  lds
s_add_u32 m0, s43, 100352
s_mov_b32 s22, 229376
buffer_load_dwordx4 v62, s[8:11], s22 offen  lds
s_add_u32 m0, s43, 101376
s_mov_b32 s22, 231424
buffer_load_dwordx4 v63, s[8:11], s22 offen  lds
v_add_u32 v48, 114688, v46
ds_read_b64_tr_b16 a[240:241], v48
ds_read_b64_tr_b16 a[242:243], v48 offset:512
ds_read_b64_tr_b16 a[244:245], v48 offset:8192
ds_read_b64_tr_b16 a[246:247], v48 offset:8704
ds_read_b64_tr_b16 a[248:249], v48 offset:8
ds_read_b64_tr_b16 a[250:251], v48 offset:520
ds_read_b64_tr_b16 a[252:253], v48 offset:8200
ds_read_b64_tr_b16 a[254:255], v48 offset:8712
s_waitcnt vmcnt(24) lgkmcnt(0)
s_barrier
s_add_u32 m0, s43, 114688
s_mov_b32 s22, 167936
buffer_load_dwordx4 v45, s[8:11], s22 offen  lds
s_add_u32 m0, s43, 115712
s_mov_b32 s22, 169984
buffer_load_dwordx4 v61, s[8:11], s22 offen  lds
s_add_u32 m0, s43, 116736
s_mov_b32 s22, 233472
buffer_load_dwordx4 v62, s[8:11], s22 offen  lds
s_add_u32 m0, s43, 117760
s_mov_b32 s22, 235520
buffer_load_dwordx4 v63, s[8:11], s22 offen  lds
v_add_u32 v48, 0, v47
v_xor_b32 v59, 0, v48
ds_read_b64_tr_b16 v[128:129], v59
v_xor_b32 v59, 32, v48
ds_read_b64_tr_b16 v[144:145], v59
v_xor_b32 v59, 64, v48
ds_read_b64_tr_b16 v[160:161], v59
v_xor_b32 v59, 96, v48
ds_read_b64_tr_b16 v[176:177], v59
v_xor_b32 v59, 128, v48
ds_read_b64_tr_b16 v[192:193], v59
v_xor_b32 v59, 160, v48
ds_read_b64_tr_b16 v[208:209], v59
v_xor_b32 v59, 192, v48
ds_read_b64_tr_b16 v[224:225], v59
v_xor_b32 v59, 224, v48
ds_read_b64_tr_b16 v[240:241], v59
s_waitcnt vmcnt(24) lgkmcnt(0)
s_barrier
s_mov_b32 s8, s54
s_mov_b32 s9, s55
s_add_u32 m0, s48, 0
s_mov_b32 s22, 0
buffer_load_dwordx4 v44, s[8:11], s22 offen  lds
s_add_u32 m0, s48, 4096
s_mov_b32 s22, 32768
buffer_load_dwordx4 v44, s[8:11], s22 offen  lds
s_add_u32 m0, s48, 8192
s_mov_b32 s22, 65536
buffer_load_dwordx4 v44, s[8:11], s22 offen  lds
s_add_u32 m0, s48, 12288
s_mov_b32 s22, 98304
buffer_load_dwordx4 v44, s[8:11], s22 offen  lds
v_add_u32 v48, 16384, v47
v_xor_b32 v59, 0, v48
ds_read_b64_tr_b16 v[130:131], v59
v_xor_b32 v59, 32, v48
ds_read_b64_tr_b16 v[146:147], v59
v_xor_b32 v59, 64, v48
ds_read_b64_tr_b16 v[162:163], v59
v_xor_b32 v59, 96, v48
ds_read_b64_tr_b16 v[178:179], v59
v_xor_b32 v59, 128, v48
ds_read_b64_tr_b16 v[194:195], v59
v_xor_b32 v59, 160, v48
ds_read_b64_tr_b16 v[210:211], v59
v_xor_b32 v59, 192, v48
ds_read_b64_tr_b16 v[226:227], v59
v_xor_b32 v59, 224, v48
ds_read_b64_tr_b16 v[242:243], v59
s_waitcnt vmcnt(24) lgkmcnt(0)
s_barrier
s_add_u32 m0, s48, 16384
s_mov_b32 s22, 524288
buffer_load_dwordx4 v44, s[8:11], s22 offen  lds
s_add_u32 m0, s48, 20480
s_mov_b32 s22, 557056
buffer_load_dwordx4 v44, s[8:11], s22 offen  lds
s_add_u32 m0, s48, 24576
s_mov_b32 s22, 589824
buffer_load_dwordx4 v44, s[8:11], s22 offen  lds
s_add_u32 m0, s48, 28672
s_mov_b32 s22, 622592
buffer_load_dwordx4 v44, s[8:11], s22 offen  lds
v_add_u32 v48, 32768, v47
v_xor_b32 v59, 0, v48
ds_read_b64_tr_b16 v[132:133], v59
v_xor_b32 v59, 32, v48
ds_read_b64_tr_b16 v[148:149], v59
v_xor_b32 v59, 64, v48
ds_read_b64_tr_b16 v[164:165], v59
v_xor_b32 v59, 96, v48
ds_read_b64_tr_b16 v[180:181], v59
v_xor_b32 v59, 128, v48
ds_read_b64_tr_b16 v[196:197], v59
v_xor_b32 v59, 160, v48
ds_read_b64_tr_b16 v[212:213], v59
v_xor_b32 v59, 192, v48
ds_read_b64_tr_b16 v[228:229], v59
v_xor_b32 v59, 224, v48
ds_read_b64_tr_b16 v[244:245], v59
s_waitcnt vmcnt(24) lgkmcnt(0)
s_barrier
s_add_u32 m0, s48, 32768
s_mov_b32 s22, 1048576
buffer_load_dwordx4 v44, s[8:11], s22 offen  lds
s_add_u32 m0, s48, 36864
s_mov_b32 s22, 1081344
buffer_load_dwordx4 v44, s[8:11], s22 offen  lds
s_add_u32 m0, s48, 40960
s_mov_b32 s22, 1114112
buffer_load_dwordx4 v44, s[8:11], s22 offen  lds
s_add_u32 m0, s48, 45056
s_mov_b32 s22, 1146880
buffer_load_dwordx4 v44, s[8:11], s22 offen  lds
v_add_u32 v48, 49152, v47
v_xor_b32 v59, 0, v48
ds_read_b64_tr_b16 v[134:135], v59
v_xor_b32 v59, 32, v48
ds_read_b64_tr_b16 v[150:151], v59
v_xor_b32 v59, 64, v48
ds_read_b64_tr_b16 v[166:167], v59
v_xor_b32 v59, 96, v48
ds_read_b64_tr_b16 v[182:183], v59
v_xor_b32 v59, 128, v48
ds_read_b64_tr_b16 v[198:199], v59
v_xor_b32 v59, 160, v48
ds_read_b64_tr_b16 v[214:215], v59
v_xor_b32 v59, 192, v48
ds_read_b64_tr_b16 v[230:231], v59
v_xor_b32 v59, 224, v48
ds_read_b64_tr_b16 v[246:247], v59
s_waitcnt vmcnt(24) lgkmcnt(0)
s_barrier
s_add_u32 m0, s48, 49152
s_mov_b32 s22, 1572864
buffer_load_dwordx4 v44, s[8:11], s22 offen  lds
s_add_u32 m0, s48, 53248
s_mov_b32 s22, 1605632
buffer_load_dwordx4 v44, s[8:11], s22 offen  lds
s_add_u32 m0, s48, 57344
s_mov_b32 s22, 1638400
buffer_load_dwordx4 v44, s[8:11], s22 offen  lds
s_add_u32 m0, s48, 61440
s_mov_b32 s22, 1671168
buffer_load_dwordx4 v44, s[8:11], s22 offen  lds
v_add_u32 v48, 65536, v47
v_xor_b32 v59, 0, v48
ds_read_b64_tr_b16 v[136:137], v59
v_xor_b32 v59, 32, v48
ds_read_b64_tr_b16 v[152:153], v59
v_xor_b32 v59, 64, v48
ds_read_b64_tr_b16 v[168:169], v59
v_xor_b32 v59, 96, v48
ds_read_b64_tr_b16 v[184:185], v59
v_xor_b32 v59, 128, v48
ds_read_b64_tr_b16 v[200:201], v59
v_xor_b32 v59, 160, v48
ds_read_b64_tr_b16 v[216:217], v59
v_xor_b32 v59, 192, v48
ds_read_b64_tr_b16 v[232:233], v59
v_xor_b32 v59, 224, v48
ds_read_b64_tr_b16 v[248:249], v59
s_waitcnt vmcnt(24) lgkmcnt(0)
s_barrier
s_add_u32 m0, s48, 65536
s_mov_b32 s22, 2097152
buffer_load_dwordx4 v44, s[8:11], s22 offen  lds
s_add_u32 m0, s48, 69632
s_mov_b32 s22, 2129920
buffer_load_dwordx4 v44, s[8:11], s22 offen  lds
s_add_u32 m0, s48, 73728
s_mov_b32 s22, 2162688
buffer_load_dwordx4 v44, s[8:11], s22 offen  lds
s_add_u32 m0, s48, 77824
s_mov_b32 s22, 2195456
buffer_load_dwordx4 v44, s[8:11], s22 offen  lds
v_add_u32 v48, 81920, v47
v_xor_b32 v59, 0, v48
ds_read_b64_tr_b16 v[138:139], v59
v_xor_b32 v59, 32, v48
ds_read_b64_tr_b16 v[154:155], v59
v_xor_b32 v59, 64, v48
ds_read_b64_tr_b16 v[170:171], v59
v_xor_b32 v59, 96, v48
ds_read_b64_tr_b16 v[186:187], v59
v_xor_b32 v59, 128, v48
ds_read_b64_tr_b16 v[202:203], v59
v_xor_b32 v59, 160, v48
ds_read_b64_tr_b16 v[218:219], v59
v_xor_b32 v59, 192, v48
ds_read_b64_tr_b16 v[234:235], v59
v_xor_b32 v59, 224, v48
ds_read_b64_tr_b16 v[250:251], v59
s_waitcnt vmcnt(24) lgkmcnt(0)
s_barrier
s_add_u32 m0, s48, 81920
s_mov_b32 s22, 2621440
buffer_load_dwordx4 v44, s[8:11], s22 offen  lds
s_add_u32 m0, s48, 86016
s_mov_b32 s22, 2654208
buffer_load_dwordx4 v44, s[8:11], s22 offen  lds
s_add_u32 m0, s48, 90112
s_mov_b32 s22, 2686976
buffer_load_dwordx4 v44, s[8:11], s22 offen  lds
s_add_u32 m0, s48, 94208
s_mov_b32 s22, 2719744
buffer_load_dwordx4 v44, s[8:11], s22 offen  lds
v_add_u32 v48, 98304, v47
v_xor_b32 v59, 0, v48
ds_read_b64_tr_b16 v[140:141], v59
v_xor_b32 v59, 32, v48
ds_read_b64_tr_b16 v[156:157], v59
v_xor_b32 v59, 64, v48
ds_read_b64_tr_b16 v[172:173], v59
v_xor_b32 v59, 96, v48
ds_read_b64_tr_b16 v[188:189], v59
v_xor_b32 v59, 128, v48
ds_read_b64_tr_b16 v[204:205], v59
v_xor_b32 v59, 160, v48
ds_read_b64_tr_b16 v[220:221], v59
v_xor_b32 v59, 192, v48
ds_read_b64_tr_b16 v[236:237], v59
v_xor_b32 v59, 224, v48
ds_read_b64_tr_b16 v[252:253], v59
s_waitcnt vmcnt(24) lgkmcnt(0)
s_barrier
s_add_u32 m0, s48, 98304
s_mov_b32 s22, 3145728
buffer_load_dwordx4 v44, s[8:11], s22 offen  lds
s_add_u32 m0, s48, 102400
s_mov_b32 s22, 3178496
buffer_load_dwordx4 v44, s[8:11], s22 offen  lds
s_add_u32 m0, s48, 106496
s_mov_b32 s22, 3211264
buffer_load_dwordx4 v44, s[8:11], s22 offen  lds
s_add_u32 m0, s48, 110592
s_mov_b32 s22, 3244032
buffer_load_dwordx4 v44, s[8:11], s22 offen  lds
v_add_u32 v48, 114688, v47
v_xor_b32 v59, 0, v48
ds_read_b64_tr_b16 v[142:143], v59
v_xor_b32 v59, 32, v48
ds_read_b64_tr_b16 v[158:159], v59
v_xor_b32 v59, 64, v48
ds_read_b64_tr_b16 v[174:175], v59
v_xor_b32 v59, 96, v48
ds_read_b64_tr_b16 v[190:191], v59
v_xor_b32 v59, 128, v48
ds_read_b64_tr_b16 v[206:207], v59
v_xor_b32 v59, 160, v48
ds_read_b64_tr_b16 v[222:223], v59
v_xor_b32 v59, 192, v48
ds_read_b64_tr_b16 v[238:239], v59
v_xor_b32 v59, 224, v48
ds_read_b64_tr_b16 v[254:255], v59
s_waitcnt vmcnt(24) lgkmcnt(0)
s_barrier
s_add_u32 m0, s48, 114688
s_mov_b32 s22, 3670016
buffer_load_dwordx4 v44, s[8:11], s22 offen  lds
s_add_u32 m0, s48, 118784
s_mov_b32 s22, 3702784
buffer_load_dwordx4 v44, s[8:11], s22 offen  lds
s_add_u32 m0, s48, 122880
s_mov_b32 s22, 3735552
buffer_load_dwordx4 v44, s[8:11], s22 offen  lds
s_add_u32 m0, s48, 126976
s_mov_b32 s22, 3768320
buffer_load_dwordx4 v44, s[8:11], s22 offen  lds
v_add_u32 v48, 0, v46
ds_read_b64_tr_b16 v[64:65], v48
ds_read_b64_tr_b16 v[66:67], v48 offset:512
ds_read_b64_tr_b16 v[68:69], v48 offset:8192
ds_read_b64_tr_b16 v[70:71], v48 offset:8704
ds_read_b64_tr_b16 v[72:73], v48 offset:8
ds_read_b64_tr_b16 v[74:75], v48 offset:520
ds_read_b64_tr_b16 v[76:77], v48 offset:8200
ds_read_b64_tr_b16 v[78:79], v48 offset:8712
s_waitcnt vmcnt(24) lgkmcnt(0)
s_barrier
ds_write_b128 v32, v[64:67]
ds_write_b128 v32, v[68:71] offset:1024
ds_write_b128 v32, v[72:75] offset:2048
ds_write_b128 v32, v[76:79] offset:3072
v_add_u32 v48, 16384, v46
ds_read_b64_tr_b16 v[80:81], v48
ds_read_b64_tr_b16 v[82:83], v48 offset:512
ds_read_b64_tr_b16 v[84:85], v48 offset:8192
ds_read_b64_tr_b16 v[86:87], v48 offset:8704
ds_read_b64_tr_b16 v[88:89], v48 offset:8
ds_read_b64_tr_b16 v[90:91], v48 offset:520
ds_read_b64_tr_b16 v[92:93], v48 offset:8200
ds_read_b64_tr_b16 v[94:95], v48 offset:8712
s_waitcnt vmcnt(20) lgkmcnt(0)
s_barrier
ds_write_b128 v32, v[80:83] offset:16384
ds_write_b128 v32, v[84:87] offset:17408
ds_write_b128 v32, v[88:91] offset:18432
ds_write_b128 v32, v[92:95] offset:19456
s_getpc_b64 s[16:17]
L_rs_pc0:
s_add_u32 s16, s16, L_rs_w0_entry - L_rs_pc0
s_addc_u32 s17, s17, 0
v_lshlrev_b32 v49, 7, v0
v_min_u32 v49, L_rs_end - L_rs_w0_entry, v49
global_load_dword v50, v49, s[16:17]
v_lshlrev_b32 v49, 7, v40
s_xor_b32 s23, s35, 16384
s_cmp_eq_u32 s20, 1
s_cselect_b32 s22, s35, s47
s_cmp_eq_u32 s20, 2
s_cselect_b32 s22, s23, s22
s_lshl_b32 s23, s31, 13
s_add_u32 s23, s23, 178257920
s_cmp_eq_u32 s20, 3
s_cselect_b32 s22, s23, s22
buffer_load_dword v51, v49, s[4:7], s22 offen sc1
v_lshlrev_b32 v49, 13, v0
v_and_b32 v49, 0x1fffff, v49
s_mov_b32 s22, 67108864
buffer_load_dword v52, v49, s[4:7], s22 offen sc1
buffer_load_dword v57, v7, s[4:7], 0 offen sc1
v_add_u32 v48, 32768, v46
ds_read_b64_tr_b16 v[64:65], v48
ds_read_b64_tr_b16 v[66:67], v48 offset:512
ds_read_b64_tr_b16 v[68:69], v48 offset:8192
ds_read_b64_tr_b16 v[70:71], v48 offset:8704
ds_read_b64_tr_b16 v[72:73], v48 offset:8
ds_read_b64_tr_b16 v[74:75], v48 offset:520
ds_read_b64_tr_b16 v[76:77], v48 offset:8200
ds_read_b64_tr_b16 v[78:79], v48 offset:8712
s_waitcnt vmcnt(16) lgkmcnt(0)
s_barrier
ds_write_b128 v32, v[64:67] offset:32768
ds_write_b128 v32, v[68:71] offset:33792
ds_write_b128 v32, v[72:75] offset:34816
ds_write_b128 v32, v[76:79] offset:35840
v_add_u32 v48, 49152, v46
ds_read_b64_tr_b16 v[80:81], v48
ds_read_b64_tr_b16 v[82:83], v48 offset:512
ds_read_b64_tr_b16 v[84:85], v48 offset:8192
ds_read_b64_tr_b16 v[86:87], v48 offset:8704
ds_read_b64_tr_b16 v[88:89], v48 offset:8
ds_read_b64_tr_b16 v[90:91], v48 offset:520
ds_read_b64_tr_b16 v[92:93], v48 offset:8200
ds_read_b64_tr_b16 v[94:95], v48 offset:8712
s_waitcnt vmcnt(12) lgkmcnt(0)
s_barrier
ds_write_b128 v32, v[80:83] offset:49152
ds_write_b128 v32, v[84:87] offset:50176
ds_write_b128 v32, v[88:91] offset:51200
ds_write_b128 v32, v[92:95] offset:52224
v_add_u32 v48, 65536, v46
ds_read_b64_tr_b16 v[64:65], v48
ds_read_b64_tr_b16 v[66:67], v48 offset:512
ds_read_b64_tr_b16 v[68:69], v48 offset:8192
ds_read_b64_tr_b16 v[70:71], v48 offset:8704
ds_read_b64_tr_b16 v[72:73], v48 offset:8
ds_read_b64_tr_b16 v[74:75], v48 offset:520
ds_read_b64_tr_b16 v[76:77], v48 offset:8200
ds_read_b64_tr_b16 v[78:79], v48 offset:8712
s_waitcnt vmcnt(8) lgkmcnt(0)
s_barrier
ds_write_b128 v33, v[64:67]
ds_write_b128 v33, v[68:71] offset:1024
ds_write_b128 v33, v[72:75] offset:2048
ds_write_b128 v33, v[76:79] offset:3072
v_add_u32 v48, 81920, v46
ds_read_b64_tr_b16 v[80:81], v48
ds_read_b64_tr_b16 v[82:83], v48 offset:512
ds_read_b64_tr_b16 v[84:85], v48 offset:8192
ds_read_b64_tr_b16 v[86:87], v48 offset:8704
ds_read_b64_tr_b16 v[88:89], v48 offset:8
ds_read_b64_tr_b16 v[90:91], v48 offset:520
ds_read_b64_tr_b16 v[92:93], v48 offset:8200
ds_read_b64_tr_b16 v[94:95], v48 offset:8712
s_waitcnt vmcnt(4) lgkmcnt(0)
s_barrier
ds_write_b128 v33, v[80:83] offset:16384
ds_write_b128 v33, v[84:87] offset:17408
ds_write_b128 v33, v[88:91] offset:18432
ds_write_b128 v33, v[92:95] offset:19456
v_add_u32 v48, 98304, v46
ds_read_b64_tr_b16 v[64:65], v48
ds_read_b64_tr_b16 v[66:67], v48 offset:512
ds_read_b64_tr_b16 v[68:69], v48 offset:8192
ds_read_b64_tr_b16 v[70:71], v48 offset:8704
ds_read_b64_tr_b16 v[72:73], v48 offset:8
ds_read_b64_tr_b16 v[74:75], v48 offset:520
ds_read_b64_tr_b16 v[76:77], v48 offset:8200
ds_read_b64_tr_b16 v[78:79], v48 offset:8712
s_waitcnt vmcnt(0) lgkmcnt(0)
s_barrier
ds_write_b128 v33, v[64:67] offset:32768
ds_write_b128 v33, v[68:71] offset:33792
ds_write_b128 v33, v[72:75] offset:34816
ds_write_b128 v33, v[76:79] offset:35840
v_add_u32 v48, 114688, v46
ds_read_b64_tr_b16 v[80:81], v48
ds_read_b64_tr_b16 v[82:83], v48 offset:512
ds_read_b64_tr_b16 v[84:85], v48 offset:8192
ds_read_b64_tr_b16 v[86:87], v48 offset:8704
ds_read_b64_tr_b16 v[88:89], v48 offset:8
ds_read_b64_tr_b16 v[90:91], v48 offset:520
ds_read_b64_tr_b16 v[92:93], v48 offset:8200
ds_read_b64_tr_b16 v[94:95], v48 offset:8712
s_waitcnt lgkmcnt(0)
s_barrier
ds_write_b128 v33, v[80:83] offset:49152
ds_write_b128 v33, v[84:87] offset:50176
ds_write_b128 v33, v[88:91] offset:51200
ds_write_b128 v33, v[92:95] offset:52224
s_waitcnt lgkmcnt(0)
L_rs_iw:
buffer_load_dword v58, off, s[12:15], 0 offset:204 sc1
s_waitcnt vmcnt(0)
L_rs_iw1:
v_and_b32 v50, 0xffff, v58
v_readfirstlane_b32 s60, v58
v_cmp_ne_u32 vcc, s100, v50
s_cbranch_vccnz L_rs_iw
s_lshr_b32 s60, s60, 15
s_cmp_gt_u32 s60, s100
s_cselect_b32 s60, 8192, 0
s_bfe_u32 s22, s31, 0x10001
s_lshl_b32 s22, s22, 12
s_add_u32 s22, s22, s60
s_lshl_b32 s23, s20, 10
s_add_u32 s22, s22, s23
s_add_u32 s38, s38, s22
s_add_u32 s37, s37, s22
s_xor_b32 s40, s38, 4096
s_xor_b32 s39, s37, 4096
s_xor_b32 s36, s35, 16384
s_mov_b32 s21, 0
s_cmp_eq_u32 s30, 0
s_mov_b32 s22, 0x33003300
s_cselect_b32 s16, 0x00330033, s22
s_mov_b32 s17, s16
s_cselect_b32 s18, -1, 0
s_not_b32 s19, s18
s_lshl_b32 s22, s31, 13
s_lshl_b32 s23, s20, 11
s_add_u32 s22, s22, s23
s_add_u32 s43, s22, 16777216
s_add_u32 s44, s22, 33554432
s_lshl_b32 s45, s31, 13
s_add_u32 s45, s45, 178257920
s_mul_i32 s48, s20, 5120
s_add_u32 m0, s48, 140288
s_mov_b32 s41, 1
s_mov_b32 s42, 1
v_mov_b32 v0, v34
v_bfrev_b32 v12, 1
v_bfrev_b32 v3, 1
v_cndmask_b32 v10, v3, v10, s[16:17]
v_cndmask_b32 v9, v3, v9, s[26:27]
s_sub_u32 s45, s45, 0
s_lshl_b32 s51, s30, 11
s_add_u32 s51, s51, s45
s_mov_b32 s50, 0
s_cmp_lg_u32 s20, 3
s_cbranch_scc1 L_rs_kv0
v_readlane_b32 s50, v57, 0
v_readlane_b32 s22, v57, 2
v_readlane_b32 s23, v57, 1
v_readlane_b32 s24, v57, 3
s_nop 3
s_min_u32 s50, s50, s22
s_min_u32 s23, s23, s24
s_lshl_b32 s50, s50, 1
s_lshl_b32 s23, s23, 1
s_add_u32 s23, s23, 1
s_min_u32 s50, s50, s23
L_rs_kvb0:
s_add_u32 s22, s21, 1
s_min_u32 s22, s22, 63
s_cmp_gt_u32 s50, s22
s_cbranch_scc1 L_rs_kvd0
buffer_load_dword v48, v7, s[4:7], 0 offen sc1
s_waitcnt vmcnt(0)
v_readlane_b32 s50, v48, 0
v_readlane_b32 s22, v48, 2
v_readlane_b32 s23, v48, 1
v_readlane_b32 s24, v48, 3
s_nop 3
s_min_u32 s50, s50, s22
s_min_u32 s23, s23, s24
s_lshl_b32 s50, s50, 1
s_lshl_b32 s23, s23, 1
s_add_u32 s23, s23, 1
s_min_u32 s50, s50, s23
s_branch L_rs_kvb0
L_rs_kvd0:
L_rs_kv0:
s_barrier
s_cmp_eq_u32 s20, 1
s_cbranch_scc1 L_rs_w1_entry
s_cmp_eq_u32 s20, 2
s_cbranch_scc1 L_rs_w2_entry
s_cmp_eq_u32 s20, 3
s_cbranch_scc1 L_rs_w3_entry
L_rs_w0_entry:
v_mfma_f32_32x32x8_bf16 v[96:111], v[14:15], v[14:15], 0
v_mfma_f32_16x16x16_bf16 v[112:115], v[14:15], v[14:15], 0
v_mfma_f32_16x16x16_bf16 v[116:119], v[14:15], v[14:15], 0
ds_read_b128 v[64:67], v1
ds_read_b128 v[68:71], v1 offset:1024
ds_read_b128 v[72:75], v1 offset:2048
ds_read_b128 v[76:79], v1 offset:3072
ds_read_b128 v[80:83], v1 offset:16384
ds_read_b128 v[84:87], v1 offset:17408
ds_read_b128 v[88:91], v1 offset:18432
ds_read_b128 v[92:95], v1 offset:19456
buffer_load_dwordx4 v[120:123], v1, s[4:7], s44 offen sc1
buffer_load_dwordx4 v[124:127], v1, s[4:7], s44 offen offset:1024 sc1
s_add_u32 s44, s44, 262144
L_rs_w0_loop:
s_add_u32 s22, s35, 0
s_waitcnt vmcnt(0)
buffer_load_dwordx4 v[32:35], v1, s[4:7], s22 offen sc1
buffer_load_dwordx4 v[36:39], v1, s[4:7], s22 offen offset:1024 sc1
L_rs_w0_pa:
s_waitcnt vmcnt(1)
ds_write_b128 v6, v[32:35]
s_waitcnt vmcnt(0)
ds_write_b128 v6, v[36:39] offset:1024
v_max3_u32 v3, v32, v34, v36
v_max_u32 v3, v3, v38
v_cmp_eq_u32 vcc, -1, v3
v_smfmac_f32_16x16x64_bf16 v[96:99], v[32:35], a[0:7], v2
buffer_load_dwordx4 v[32:35], v1, s[4:7], s22 offen sc1
v_smfmac_f32_16x16x64_bf16 v[100:103], v[32:35], a[8:15], v2
buffer_load_dwordx4 v[36:39], v1, s[4:7], s22 offen offset:1024 sc1
v_smfmac_f32_16x16x64_bf16 v[104:107], v[32:35], a[128:135], v2
s_cbranch_vccnz L_rs_w0_pafail
s_waitcnt lgkmcnt(0)
s_barrier
ds_read_b128 v[40:43], v6 offset:2048
ds_read_b128 v[44:47], v6 offset:3072
v_smfmac_f32_16x16x64_bf16 v[108:111], v[32:35], a[136:143], v2
ds_read_b128 v[48:51], v6 offset:4096
v_smfmac_f32_16x16x64_bf16 v[96:99], v[36:39], a[16:23], v2
ds_read_b128 v[52:55], v6 offset:5120
v_smfmac_f32_16x16x64_bf16 v[100:103], v[36:39], a[24:31], v2
ds_read_b128 v[56:59], v6 offset:6144
v_smfmac_f32_16x16x64_bf16 v[104:107], v[36:39], a[144:151], v2
ds_read_b128 v[60:63], v6 offset:7168
v_smfmac_f32_16x16x64_bf16 v[108:111], v[36:39], a[152:159], v2
buffer_load_dwordx4 v1, s[4:7], s43 offen sc1 lds
s_waitcnt lgkmcnt(5)
v_smfmac_f32_16x16x64_bf16 v[96:99], v[40:43], a[32:39], v2
v_smfmac_f32_16x16x64_bf16 v[104:107], v[40:43], a[160:167], v2
s_waitcnt lgkmcnt(4)
v_smfmac_f32_16x16x64_bf16 v[96:99], v[44:47], a[48:55], v2
v_smfmac_f32_16x16x64_bf16 v[104:107], v[44:47], a[176:183], v2
buffer_load_dwordx4 v1, s[4:7], s43 offen offset:1024 sc1 lds
s_waitcnt lgkmcnt(3)
v_smfmac_f32_16x16x64_bf16 v[96:99], v[48:51], a[64:71], v2
v_smfmac_f32_16x16x64_bf16 v[104:107], v[48:51], a[192:199], v2
s_waitcnt lgkmcnt(2)
v_smfmac_f32_16x16x64_bf16 v[96:99], v[52:55], a[80:87], v2
v_smfmac_f32_16x16x64_bf16 v[104:107], v[52:55], a[208:215], v2
v_mov_b32 v4, s21
buffer_store_dword v4, v7, s[4:7], 0 offen sc1
s_waitcnt lgkmcnt(1)
v_smfmac_f32_16x16x64_bf16 v[96:99], v[56:59], a[96:103], v2
v_smfmac_f32_16x16x64_bf16 v[104:107], v[56:59], a[224:231], v2
s_waitcnt lgkmcnt(0)
v_smfmac_f32_16x16x64_bf16 v[96:99], v[60:63], a[112:119], v2
v_smfmac_f32_16x16x64_bf16 v[104:107], v[60:63], a[240:247], v2
v_smfmac_f32_16x16x64_bf16 v[100:103], v[40:43], a[40:47], v2
s_nop 2
v_smfmac_f32_16x16x64_bf16 v[100:103], v[44:47], a[56:63], v2
s_nop 1
v_add_f32 v96, v96, v98
v_smfmac_f32_16x16x64_bf16 v[100:103], v[48:51], a[72:79], v2
v_add_f32 v97, v97, v99
v_add_f32 v104, v104, v106
v_smfmac_f32_16x16x64_bf16 v[100:103], v[52:55], a[88:95], v2
v_add_f32 v105, v105, v107
v_cvt_pk_bf16_f32 v96, v96, v97
v_smfmac_f32_16x16x64_bf16 v[100:103], v[56:59], a[104:111], v2
v_cvt_pk_bf16_f32 v97, v104, v105
v_and_or_b32 v96, v96, -2, s41
v_smfmac_f32_16x16x64_bf16 v[100:103], v[60:63], a[120:127], v2
buffer_store_dwordx2 v[96:97], v11, s[4:7], s37 offen sc1
v_smfmac_f32_16x16x64_bf16 v[108:111], v[40:43], a[168:175], v2
v_smfmac_f32_16x16x64_bf16 v[108:111], v[44:47], a[184:191], v2
v_smfmac_f32_16x16x64_bf16 v[108:111], v[48:51], a[200:207], v2
v_smfmac_f32_16x16x64_bf16 v[108:111], v[52:55], a[216:223], v2
v_smfmac_f32_16x16x64_bf16 v[108:111], v[56:59], a[232:239], v2
s_nop 2
v_add_f32 v100, v100, v102
v_smfmac_f32_16x16x64_bf16 v[108:111], v[60:63], a[248:255], v2
v_add_f32 v101, v101, v103
v_cvt_pk_bf16_f32 v98, v100, v101
v_and_or_b32 v98, v98, -2, s41
s_nop 4
v_pk_add_f32 v[108:109], v[108:109], v[110:111]
v_cvt_pk_bf16_f32 v99, v108, v109
buffer_store_dwordx2 v[98:99], v11, s[4:7], s37 offen offset:512 sc1
v_smfmac_f32_16x16x64_bf16 v[112:115], v[32:35], v[64:71], v2
ds_read_b128 v[64:67], v1 offset:32768
ds_read_b128 v[68:71], v1 offset:33792
v_smfmac_f32_16x16x64_bf16 v[116:119], v[32:35], v[72:79], v2
ds_read_b128 v[72:75], v1 offset:34816
ds_read_b128 v[76:79], v1 offset:35840
v_smfmac_f32_16x16x64_bf16 v[112:115], v[36:39], v[80:87], v2
ds_read_b128 v[80:83], v1 offset:49152
ds_read_b128 v[84:87], v1 offset:50176
v_smfmac_f32_16x16x64_bf16 v[116:119], v[36:39], v[88:95], v2
ds_read_b128 v[88:91], v1 offset:51200
ds_read_b128 v[92:95], v1 offset:52224
s_waitcnt lgkmcnt(6)
v_smfmac_f32_16x16x64_bf16 v[112:115], v[40:43], v[64:71], v2
ds_read_b128 v[64:67], v5
ds_read_b128 v[68:71], v5 offset:1024
s_waitcnt lgkmcnt(6)
v_smfmac_f32_16x16x64_bf16 v[116:119], v[40:43], v[72:79], v2
ds_read_b128 v[72:75], v5 offset:2048
ds_read_b128 v[76:79], v5 offset:3072
s_waitcnt lgkmcnt(6)
v_smfmac_f32_16x16x64_bf16 v[112:115], v[44:47], v[80:87], v2
ds_read_b128 v[80:83], v5 offset:16384
ds_read_b128 v[84:87], v5 offset:17408
s_waitcnt lgkmcnt(6)
v_smfmac_f32_16x16x64_bf16 v[116:119], v[44:47], v[88:95], v2
ds_read_b128 v[88:91], v5 offset:18432
ds_read_b128 v[92:95], v5 offset:19456
s_waitcnt lgkmcnt(6)
v_smfmac_f32_16x16x64_bf16 v[112:115], v[48:51], v[64:71], v2
ds_read_b128 v[64:67], v5 offset:32768
ds_read_b128 v[68:71], v5 offset:33792
s_waitcnt lgkmcnt(6)
v_smfmac_f32_16x16x64_bf16 v[116:119], v[48:51], v[72:79], v2
ds_read_b128 v[72:75], v5 offset:34816
ds_read_b128 v[76:79], v5 offset:35840
s_waitcnt lgkmcnt(6)
v_smfmac_f32_16x16x64_bf16 v[112:115], v[52:55], v[80:87], v2
ds_read_b128 v[80:83], v5 offset:49152
ds_read_b128 v[84:87], v5 offset:50176
s_waitcnt lgkmcnt(6)
v_smfmac_f32_16x16x64_bf16 v[116:119], v[52:55], v[88:95], v2
ds_read_b128 v[88:91], v5 offset:51200
ds_read_b128 v[92:95], v5 offset:52224
s_waitcnt lgkmcnt(6)
v_smfmac_f32_16x16x64_bf16 v[112:115], v[56:59], v[64:71], v2
s_waitcnt lgkmcnt(4)
v_smfmac_f32_16x16x64_bf16 v[116:119], v[56:59], v[72:79], v2
s_waitcnt lgkmcnt(2)
v_smfmac_f32_16x16x64_bf16 v[112:115], v[60:63], v[80:87], v2
s_waitcnt lgkmcnt(0)
v_smfmac_f32_16x16x64_bf16 v[116:119], v[60:63], v[88:95], v2
buffer_load_dwordx2 v[108:109], v11, s[4:7], s38 offen sc1
v_mfma_f32_16x16x16_bf16 v[100:103], v[96:97], v[16:17], 0
v_mfma_f32_16x16x16_bf16 v[104:107], v[98:99], v[16:17], 0
s_nop 4
v_add_f32 v112, v112, v114
v_add_f32 v113, v113, v115
v_add_f32 v114, v116, v118
v_add_f32 v115, v117, v119
v_cvt_pk_bf16_f32 v18, v112, v113
v_cvt_pk_bf16_f32 v19, v114, v115
v_and_or_b32 v18, v18, -2, s41
buffer_load_dwordx2 v[110:111], v11, s[4:7], s38 offen offset:512 sc1
s_barrier
buffer_store_dwordx2 v[18:19], v11, s[4:7], s39 offen sc1
v_mov_b32 v112, v18
v_mov_b32 v114, v19
v_mov_b32 v92, v28
v_mov_b32 v93, 0
s_waitcnt vmcnt(6)
s_barrier
ds_read_b128 v[32:35], v6 offset:9216
ds_read_b128 v[36:39], v6 offset:10240
ds_read_b128 v[40:43], v6 offset:14336
ds_read_b128 v[44:47], v6 offset:15360
ds_read_b128 v[48:51], v6 offset:19456
ds_read_b128 v[52:55], v6 offset:20480
ds_read_b128 v[56:59], v6 offset:24576
ds_read_b128 v[60:63], v6 offset:25600
buffer_load_dwordx2 v[20:21], v11, s[4:7], s38 offen sc1
buffer_load_dwordx2 v[22:23], v11, s[4:7], s38 offen offset:512 sc1
s_waitcnt vmcnt(4)
v_mfma_f32_16x16x16_bf16 v[80:83], v[108:109], v[16:17], v[100:103]
v_and_b32 v3, 1, v108
v_cmp_ne_u32 vcc, s41, v3
s_nop 5
v_cvt_pk_bf16_f32 v64, v80, v81
v_cvt_pk_bf16_f32 v65, v82, v83
s_cbranch_vccnz L_rs_w0_xslow
s_waitcnt vmcnt(3)
v_mfma_f32_16x16x16_bf16 v[84:87], v[110:111], v[16:17], v[104:107]
v_and_b32 v3, 1, v110
v_cmp_ne_u32 vcc, s41, v3
s_nop 5
v_cvt_pk_bf16_f32 v66, v84, v85
v_cvt_pk_bf16_f32 v67, v86, v87
ds_write_b128 v6, v[64:67] offset:8192
s_cbranch_vccnz L_rs_w0_xslow
L_rs_w0_xok:
s_cmp_eq_u32 s21, 63
s_cbranch_scc1 L_rs_w0_last
buffer_load_dwordx2 v[116:117], v11, s[4:7], s40 offen sc1
s_waitcnt lgkmcnt(1)
v_mfma_f32_16x16x32_bf16 v[80:83], v[32:35], v[64:67], 0
s_waitcnt lgkmcnt(0)
s_barrier
ds_read_b128 v[68:71], v6 offset:13312
ds_read_b128 v[72:75], v6 offset:18432
ds_read_b128 v[76:79], v6 offset:23552
v_mfma_f32_16x16x32_bf16 v[84:87], v[36:39], v[64:67], 0
v_mfma_f32_16x16x32_bf16 v[88:91], v[64:67], v[64:67], 0
buffer_load_dwordx2 v[20:21], v11, s[4:7], s40 offen sc1
s_waitcnt lgkmcnt(2)
v_mfma_f32_16x16x32_bf16 v[80:83], v[40:43], v[68:71], v[80:83]
buffer_store_dwordx4 v[64:67], v10, s[4:7], s45 offen sc1
s_waitcnt lgkmcnt(1)
v_mfma_f32_16x16x32_bf16 v[80:83], v[48:51], v[72:75], v[80:83]
s_waitcnt lgkmcnt(0)
v_mfma_f32_16x16x32_bf16 v[80:83], v[56:59], v[76:79], v[80:83]
v_mfma_f32_16x16x32_bf16 v[84:87], v[44:47], v[68:71], v[84:87]
v_mfma_f32_16x16x32_bf16 v[84:87], v[52:55], v[72:75], v[84:87]
buffer_store_dwordx2 v[18:19], v11, s[4:7], s51 offen offset:2048 sc1
v_mfma_f32_16x16x32_bf16 v[84:87], v[60:63], v[76:79], v[84:87]
v_mfma_f32_16x16x32_bf16 v[88:91], v[68:71], v[68:71], v[88:91]
v_mfma_f32_16x16x32_bf16 v[88:91], v[72:75], v[72:75], v[88:91]
v_mfma_f32_16x16x32_bf16 v[88:91], v[76:79], v[76:79], v[88:91]
v_mfma_f32_32x32x4_2b_bf16 v[32:63], v[14:15], v[14:15], 0
s_nop 0
v_max3_f32 v4, v80, v81, v82
s_nop 1
v_max3_f32 v4, v4, v83, v84
v_max3_f32 v4, v4, v85, v86
v_max_f32 v4, v4, v87
v_max3_f32 v90, v4, v88, v89
v_max3_f32 v4, v4, v88, v89
s_nop 1
v_permlane16_swap_b32 v4, v90
v_max_f32 v4, v4, v90
v_max_f32 v90, v4, v90
s_nop 1
v_permlane32_swap_b32 v4, v90
v_max_f32 v4, v4, v90
v_mul_f32 v4, s34, v4
v_pk_fma_f32 v[80:81], v[80:81], s[34:35], v[4:5] op_sel_hi:[1,0,0] neg_lo:[0,0,1] neg_hi:[0,0,1]
v_pk_fma_f32 v[82:83], v[82:83], s[34:35], v[4:5] op_sel_hi:[1,0,0] neg_lo:[0,0,1] neg_hi:[0,0,1]
v_pk_fma_f32 v[84:85], v[84:85], s[34:35], v[4:5] op_sel_hi:[1,0,0] neg_lo:[0,0,1] neg_hi:[0,0,1]
v_pk_fma_f32 v[86:87], v[86:87], s[34:35], v[4:5] op_sel_hi:[1,0,0] neg_lo:[0,0,1] neg_hi:[0,0,1]
v_pk_fma_f32 v[88:89], v[88:89], s[34:35], v[4:5] op_sel_hi:[1,0,0] neg_lo:[0,0,1] neg_hi:[0,0,1]
v_exp_f32 v80, v80
v_exp_f32 v81, v81
v_exp_f32 v82, v82
v_cvt_pk_bf16_f32 v68, v80, v81
v_exp_f32 v83, v83
v_exp_f32 v84, v84
v_cvt_pk_bf16_f32 v69, v82, v83
v_exp_f32 v85, v85
v_exp_f32 v86, v86
v_cvt_pk_bf16_f32 v70, v84, v85
v_exp_f32 v87, v87
v_exp_f32 v88, v88
v_cvt_pk_bf16_f32 v71, v86, v87
v_exp_f32 v89, v89
s_waitcnt vmcnt(3)
v_mfma_f32_16x16x32_bf16 v[76:79], v[28:31], v[68:71], 0
v_and_b32 v3, 1, v116
v_cvt_pk_bf16_f32 v72, v88, v89
v_mfma_f32_16x16x32_bf16 v[100:103], v[120:123], v[68:71], 0
v_cmp_ne_u32 vcc, s41, v3
v_cvt_pk_bf16_f32 v73, v88, v89
v_mfma_f32_16x16x32_bf16 v[104:107], v[124:127], v[68:71], 0
v_mov_b32 v113, v116
v_mov_b32 v115, v117
v_mfma_f32_16x16x16_bf16 v[76:79], v[92:93], v[72:73], v[76:79]
s_cbranch_vccnz L_rs_w0_pv0
L_rs_w0_pv2:
v_mfma_f32_16x16x16_bf16 v[100:103], v[112:113], v[72:73], v[100:103]
v_mfma_f32_16x16x16_bf16 v[104:107], v[114:115], v[72:73], v[104:107]
buffer_load_dwordx4 v[120:123], v1, s[4:7], s44 offen sc1
buffer_load_dwordx4 v[124:127], v1, s[4:7], s44 offen offset:1024 sc1
s_nop 2
v_rcp_f32 v76, v76
s_mov_b64 exec, s[28:29]
v_pk_mul_f32 v[100:101], v[100:101], v[76:77] op_sel_hi:[1,0]
v_pk_mul_f32 v[102:103], v[102:103], v[76:77] op_sel_hi:[1,0]
v_pk_mul_f32 v[104:105], v[104:105], v[76:77] op_sel_hi:[1,0]
v_pk_mul_f32 v[106:107], v[106:107], v[76:77] op_sel_hi:[1,0]
v_cvt_pk_bf16_f32 v84, v100, v101
v_cvt_pk_bf16_f32 v85, v102, v103
v_cvt_pk_bf16_f32 v86, v104, v105
v_cvt_pk_bf16_f32 v87, v106, v107
ds_write_b128 v6, v[84:87] offset:28640
s_mov_b64 exec, -1
s_waitcnt lgkmcnt(0)
s_barrier
ds_read_b128 v[68:71], v6 offset:28672
ds_read_b128 v[72:75], v6 offset:29696
s_waitcnt lgkmcnt(1)
v_smfmac_f32_16x16x64_bf16 v[32:35], v[68:71], v[128:135], v2
s_add_u32 s21, s21, 1
s_xor_b32 s38, s38, 1048576
s_xor_b32 s37, s37, 1048576
s_waitcnt lgkmcnt(0)
v_smfmac_f32_16x16x64_bf16 v[32:35], v[72:75], v[136:143], v2
s_xor_b32 s40, s40, 1048576
s_xor_b32 s39, s39, 1048576
s_lshr_b32 s41, s21, 1
v_smfmac_f32_16x16x64_bf16 v[36:39], v[68:71], v[144:151], v2
s_and_b32 s41, s41, 1
s_xor_b32 s41, s41, 1
s_xor_b32 s35, s35, 16384
v_smfmac_f32_16x16x64_bf16 v[36:39], v[72:75], v[152:159], v2
v_add_f32 v32, v32, v34
s_xor_b32 s36, s36, 16384
s_add_u32 s43, s43, 262144
s_add_u32 s44, s44, 262144
v_smfmac_f32_16x16x64_bf16 v[40:43], v[68:71], v[160:167], v2
v_add_f32 v33, v33, v35
v_smfmac_f32_16x16x64_bf16 v[40:43], v[72:75], v[168:175], v2
v_cvt_pk_bf16_f32 v32, v32, v33
v_smfmac_f32_16x16x64_bf16 v[44:47], v[68:71], v[176:183], v2
v_and_or_b32 v32, v32, -2, s42
v_smfmac_f32_16x16x64_bf16 v[44:47], v[72:75], v[184:191], v2
v_add_f32 v36, v36, v38
v_smfmac_f32_16x16x64_bf16 v[48:51], v[68:71], v[192:199], v2
v_add_f32 v37, v37, v39
v_smfmac_f32_16x16x64_bf16 v[48:51], v[72:75], v[200:207], v2
v_cvt_pk_bf16_f32 v33, v36, v37
v_smfmac_f32_16x16x64_bf16 v[52:55], v[68:71], v[208:215], v2
v_add_f32 v40, v40, v42
v_smfmac_f32_16x16x64_bf16 v[52:55], v[72:75], v[216:223], v2
v_add_f32 v41, v41, v43
v_smfmac_f32_16x16x64_bf16 v[56:59], v[68:71], v[224:231], v2
v_cvt_pk_bf16_f32 v34, v40, v41
v_smfmac_f32_16x16x64_bf16 v[56:59], v[72:75], v[232:239], v2
v_add_f32 v44, v44, v46
v_smfmac_f32_16x16x64_bf16 v[60:63], v[68:71], v[240:247], v2
v_add_f32 v45, v45, v47
v_smfmac_f32_16x16x64_bf16 v[60:63], v[72:75], v[248:255], v2
v_cvt_pk_bf16_f32 v35, v44, v45
buffer_store_dwordx4 v[32:35], v8, s[4:7], s46 offen sc1
v_pk_add_f32 v[48:49], v[48:49], v[50:51]
v_cvt_pk_bf16_f32 v48, v48, v49
v_and_or_b32 v48, v48, -2, s42
v_pk_add_f32 v[52:53], v[52:53], v[54:55]
v_cvt_pk_bf16_f32 v49, v52, v53
v_pk_add_f32 v[56:57], v[56:57], v[58:59]
v_cvt_pk_bf16_f32 v50, v56, v57
v_pk_add_f32 v[60:61], v[60:61], v[62:63]
v_cvt_pk_bf16_f32 v51, v60, v61
buffer_store_dwordx4 v[48:51], v8, s[4:7], s61 offen sc1
s_add_u32 s45, s45, 262144
s_add_u32 s51, s51, 262144
v_mfma_f32_32x32x8_bf16 v[96:111], v[14:15], v[14:15], 0
v_mfma_f32_16x16x16_bf16 v[112:115], v[14:15], v[14:15], 0
v_mfma_f32_16x16x16_bf16 v[116:119], v[14:15], v[14:15], 0
ds_read_b128 v[64:67], v1
ds_read_b128 v[68:71], v1 offset:1024
ds_read_b128 v[72:75], v1 offset:2048
ds_read_b128 v[76:79], v1 offset:3072
ds_read_b128 v[80:83], v1 offset:16384
ds_read_b128 v[84:87], v1 offset:17408
ds_read_b128 v[88:91], v1 offset:18432
ds_read_b128 v[92:95], v1 offset:19456
v_mov_b32 v58, -1
v_mov_b32 v59, -1
s_waitcnt vmcnt(0)
L_rs_w0_cgo:
L_rs_w0_pc:
buffer_load_dword v36, v13, s[4:7], s25 offen sc1
buffer_load_dword v37, v13, s[4:7], s25 offen offset:256 sc1
buffer_load_dword v38, v13, s[4:7], s25 offen offset:512 sc1
buffer_load_dword v39, v13, s[4:7], s25 offen offset:768 sc1
buffer_load_dword v40, v13, s[4:7], s25 offen offset:1024 sc1
buffer_load_dword v41, v13, s[4:7], s25 offen offset:1280 sc1
buffer_load_dword v42, v13, s[4:7], s25 offen offset:1536 sc1
buffer_load_dword v43, v13, s[4:7], s25 offen offset:1792 sc1
s_waitcnt vmcnt(4)
v_mfma_f32_16x16x32_bf16 v[52:55], v[36:39], v[24:27], 0
v_bitop3_b32 v3, s42, v36, v37 bitop3:0x7e
v_bitop3_b32 v4, s42, v38, v39 bitop3:0x7e
s_waitcnt vmcnt(2)
v_or_b32 v3, v3, v4
v_bitop3_b32 v4, s42, v40, v41 bitop3:0x7e
s_waitcnt vmcnt(0)
v_mfma_f32_16x16x32_bf16 v[52:55], v[40:43], v[24:27], v[52:55]
v_bitop3_b32 v56, s42, v42, v43 bitop3:0x7e
v_or3_b32 v3, v3, v4, v56
v_and_b32 v3, v0, v3
v_cmp_ne_u32 vcc, 0, v3
s_nop 3
v_cvt_pk_bf16_f32 v56, v52, v53
v_cvt_pk_bf16_f32 v57, v54, v55
v_min_u32 v56, -2, v56
s_cbranch_vccnz L_rs_w0_pc
s_mov_b64 exec, s[26:27]
buffer_store_dwordx2 v[56:57], v9, s[4:7], s35 offen sc1
buffer_store_dwordx2 v[58:59], v9, s[4:7], s36 offen sc1
s_mov_b64 exec, -1
s_xor_b32 s42, s42, 1
s_branch L_rs_w0_loop
L_rs_w0_last:
buffer_store_dwordx4 v[64:67], v10, s[4:7], s45 offen sc1
buffer_store_dwordx2 v[18:19], v11, s[4:7], s51 offen offset:2048 sc1
s_branch L_rs_end
L_rs_w0_pafail:
s_nop 7
v_mov_b32 v96, 0
v_mov_b32 v97, 0
v_mov_b32 v98, 0
v_mov_b32 v99, 0
v_mov_b32 v100, 0
v_mov_b32 v101, 0
v_mov_b32 v102, 0
v_mov_b32 v103, 0
v_mov_b32 v104, 0
v_mov_b32 v105, 0
v_mov_b32 v106, 0
v_mov_b32 v107, 0
s_branch L_rs_w0_pa
L_rs_w0_xslow:
buffer_load_dwordx2 v[108:109], v11, s[4:7], s38 offen sc1
buffer_load_dwordx2 v[110:111], v11, s[4:7], s38 offen offset:512 sc1
s_waitcnt vmcnt(2)
v_bitop3_b32 v3, s41, v20, v22 bitop3:0x7e
v_mfma_f32_16x16x16_bf16 v[80:83], v[20:21], v[16:17], v[100:103]
v_and_b32 v3, 1, v3
v_mfma_f32_16x16x16_bf16 v[84:87], v[22:23], v[16:17], v[104:107]
v_cmp_ne_u32 vcc, 0, v3
s_cbranch_vccz L_rs_w0_xgot
buffer_load_dwordx2 v[20:21], v11, s[4:7], s38 offen sc1
buffer_load_dwordx2 v[22:23], v11, s[4:7], s38 offen offset:512 sc1
s_waitcnt vmcnt(2)
v_bitop3_b32 v3, s41, v108, v110 bitop3:0x7e
v_mfma_f32_16x16x16_bf16 v[80:83], v[108:109], v[16:17], v[100:103]
v_and_b32 v3, 1, v3
v_mfma_f32_16x16x16_bf16 v[84:87], v[110:111], v[16:17], v[104:107]
v_cmp_ne_u32 vcc, 0, v3
s_cbranch_vccz L_rs_w0_xgot
s_branch L_rs_w0_xslow
L_rs_w0_xgot:
s_nop 3
v_cvt_pk_bf16_f32 v64, v80, v81
v_cvt_pk_bf16_f32 v65, v82, v83
v_cvt_pk_bf16_f32 v66, v84, v85
v_cvt_pk_bf16_f32 v67, v86, v87
ds_write_b128 v6, v[64:67] offset:8192
s_branch L_rs_w0_xok
L_rs_w0_pv0:
s_waitcnt vmcnt(2)
s_branch L_rs_w0_pv1
L_rs_w0_pv:
buffer_load_dwordx2 v[20:21], v11, s[4:7], s40 offen sc1
s_waitcnt vmcnt(0)
L_rs_w0_pv1:
v_and_b32 v3, 1, v20
v_cmp_ne_u32 vcc, s41, v3
v_mov_b32 v113, v20
v_mov_b32 v115, v21
s_cbranch_vccnz L_rs_w0_pv
s_branch L_rs_w0_pv2
L_rs_w1_entry:
v_mfma_f32_32x32x8_bf16 v[96:111], v[14:15], v[14:15], 0
v_mfma_f32_16x16x16_bf16 v[112:115], v[14:15], v[14:15], 0
v_mfma_f32_16x16x16_bf16 v[116:119], v[14:15], v[14:15], 0
ds_read_b128 v[64:67], v1 offset:4096
ds_read_b128 v[68:71], v1 offset:5120
ds_read_b128 v[72:75], v1 offset:6144
ds_read_b128 v[76:79], v1 offset:7168
ds_read_b128 v[80:83], v1 offset:20480
ds_read_b128 v[84:87], v1 offset:21504
ds_read_b128 v[88:91], v1 offset:22528
ds_read_b128 v[92:95], v1 offset:23552
buffer_load_dwordx4 v[120:123], v1, s[4:7], s44 offen sc1
buffer_load_dwordx4 v[124:127], v1, s[4:7], s44 offen offset:1024 sc1
s_add_u32 s44, s44, 262144
L_rs_w1_loop:
s_add_u32 s22, s35, 2048
s_waitcnt vmcnt(0)
buffer_load_dwordx4 v[40:43], v1, s[4:7], s22 offen sc1
buffer_load_dwordx4 v[44:47], v1, s[4:7], s22 offen offset:1024 sc1
L_rs_w1_pa:
s_waitcnt vmcnt(1)
ds_write_b128 v6, v[40:43] offset:2048
s_waitcnt vmcnt(0)
ds_write_b128 v6, v[44:47] offset:3072
v_max3_u32 v3, v40, v42, v44
v_max_u32 v3, v3, v46
v_cmp_eq_u32 vcc, -1, v3
v_smfmac_f32_16x16x64_bf16 v[96:99], v[40:43], a[32:39], v2
buffer_load_dwordx4 v[40:43], v1, s[4:7], s22 offen sc1
v_smfmac_f32_16x16x64_bf16 v[100:103], v[40:43], a[40:47], v2
buffer_load_dwordx4 v[44:47], v1, s[4:7], s22 offen offset:1024 sc1
v_smfmac_f32_16x16x64_bf16 v[104:107], v[40:43], a[160:167], v2
s_cbranch_vccnz L_rs_w1_pafail
s_waitcnt lgkmcnt(0)
s_barrier
ds_read_b128 v[48:51], v6 offset:4096
ds_read_b128 v[52:55], v6 offset:5120
v_smfmac_f32_16x16x64_bf16 v[108:111], v[40:43], a[168:175], v2
ds_read_b128 v[56:59], v6 offset:6144
v_smfmac_f32_16x16x64_bf16 v[96:99], v[44:47], a[48:55], v2
ds_read_b128 v[60:63], v6 offset:7168
v_smfmac_f32_16x16x64_bf16 v[100:103], v[44:47], a[56:63], v2
ds_read_b128 v[32:35], v6
v_smfmac_f32_16x16x64_bf16 v[104:107], v[44:47], a[176:183], v2
ds_read_b128 v[36:39], v6 offset:1024
v_smfmac_f32_16x16x64_bf16 v[108:111], v[44:47], a[184:191], v2
s_waitcnt lgkmcnt(5)
v_smfmac_f32_16x16x64_bf16 v[96:99], v[48:51], a[64:71], v2
buffer_load_dwordx4 v1, s[4:7], s43 offen sc1 lds
v_smfmac_f32_16x16x64_bf16 v[104:107], v[48:51], a[192:199], v2
s_waitcnt lgkmcnt(4)
v_smfmac_f32_16x16x64_bf16 v[96:99], v[52:55], a[80:87], v2
v_smfmac_f32_16x16x64_bf16 v[104:107], v[52:55], a[208:215], v2
s_waitcnt lgkmcnt(3)
v_smfmac_f32_16x16x64_bf16 v[96:99], v[56:59], a[96:103], v2
buffer_load_dwordx4 v1, s[4:7], s43 offen offset:1024 sc1 lds
v_smfmac_f32_16x16x64_bf16 v[104:107], v[56:59], a[224:231], v2
s_waitcnt lgkmcnt(2)
v_smfmac_f32_16x16x64_bf16 v[96:99], v[60:63], a[112:119], v2
v_smfmac_f32_16x16x64_bf16 v[104:107], v[60:63], a[240:247], v2
s_waitcnt lgkmcnt(1)
v_smfmac_f32_16x16x64_bf16 v[96:99], v[32:35], a[0:7], v2
v_smfmac_f32_16x16x64_bf16 v[104:107], v[32:35], a[128:135], v2
s_waitcnt lgkmcnt(0)
v_smfmac_f32_16x16x64_bf16 v[96:99], v[36:39], a[16:23], v2
v_smfmac_f32_16x16x64_bf16 v[104:107], v[36:39], a[144:151], v2
v_smfmac_f32_16x16x64_bf16 v[100:103], v[48:51], a[72:79], v2
s_nop 2
v_smfmac_f32_16x16x64_bf16 v[100:103], v[52:55], a[88:95], v2
s_nop 1
v_add_f32 v96, v96, v98
v_smfmac_f32_16x16x64_bf16 v[100:103], v[56:59], a[104:111], v2
v_add_f32 v97, v97, v99
v_add_f32 v104, v104, v106
v_smfmac_f32_16x16x64_bf16 v[100:103], v[60:63], a[120:127], v2
v_add_f32 v105, v105, v107
v_cvt_pk_bf16_f32 v96, v96, v97
v_smfmac_f32_16x16x64_bf16 v[100:103], v[32:35], a[8:15], v2
v_cvt_pk_bf16_f32 v97, v104, v105
v_and_or_b32 v96, v96, -2, s41
v_smfmac_f32_16x16x64_bf16 v[100:103], v[36:39], a[24:31], v2
buffer_store_dwordx2 v[96:97], v11, s[4:7], s37 offen sc1
v_smfmac_f32_16x16x64_bf16 v[108:111], v[48:51], a[200:207], v2
v_smfmac_f32_16x16x64_bf16 v[108:111], v[52:55], a[216:223], v2
v_smfmac_f32_16x16x64_bf16 v[108:111], v[56:59], a[232:239], v2
v_smfmac_f32_16x16x64_bf16 v[108:111], v[60:63], a[248:255], v2
v_smfmac_f32_16x16x64_bf16 v[108:111], v[32:35], a[136:143], v2
s_nop 2
v_add_f32 v100, v100, v102
v_smfmac_f32_16x16x64_bf16 v[108:111], v[36:39], a[152:159], v2
v_add_f32 v101, v101, v103
v_cvt_pk_bf16_f32 v98, v100, v101
v_and_or_b32 v98, v98, -2, s41
s_nop 4
v_pk_add_f32 v[108:109], v[108:109], v[110:111]
v_cvt_pk_bf16_f32 v99, v108, v109
buffer_store_dwordx2 v[98:99], v11, s[4:7], s37 offen offset:512 sc1
v_smfmac_f32_16x16x64_bf16 v[112:115], v[32:35], v[64:71], v2
ds_read_b128 v[64:67], v1 offset:36864
ds_read_b128 v[68:71], v1 offset:37888
v_smfmac_f32_16x16x64_bf16 v[116:119], v[32:35], v[72:79], v2
ds_read_b128 v[72:75], v1 offset:38912
ds_read_b128 v[76:79], v1 offset:39936
v_smfmac_f32_16x16x64_bf16 v[112:115], v[36:39], v[80:87], v2
ds_read_b128 v[80:83], v1 offset:53248
ds_read_b128 v[84:87], v1 offset:54272
v_smfmac_f32_16x16x64_bf16 v[116:119], v[36:39], v[88:95], v2
ds_read_b128 v[88:91], v1 offset:55296
ds_read_b128 v[92:95], v1 offset:56320
s_waitcnt lgkmcnt(6)
v_smfmac_f32_16x16x64_bf16 v[112:115], v[40:43], v[64:71], v2
ds_read_b128 v[64:67], v5 offset:4096
ds_read_b128 v[68:71], v5 offset:5120
s_waitcnt lgkmcnt(6)
v_smfmac_f32_16x16x64_bf16 v[116:119], v[40:43], v[72:79], v2
ds_read_b128 v[72:75], v5 offset:6144
ds_read_b128 v[76:79], v5 offset:7168
s_waitcnt lgkmcnt(6)
v_smfmac_f32_16x16x64_bf16 v[112:115], v[44:47], v[80:87], v2
ds_read_b128 v[80:83], v5 offset:20480
ds_read_b128 v[84:87], v5 offset:21504
s_waitcnt lgkmcnt(6)
v_smfmac_f32_16x16x64_bf16 v[116:119], v[44:47], v[88:95], v2
ds_read_b128 v[88:91], v5 offset:22528
ds_read_b128 v[92:95], v5 offset:23552
s_waitcnt lgkmcnt(6)
v_smfmac_f32_16x16x64_bf16 v[112:115], v[48:51], v[64:71], v2
ds_read_b128 v[64:67], v5 offset:36864
ds_read_b128 v[68:71], v5 offset:37888
s_waitcnt lgkmcnt(6)
v_smfmac_f32_16x16x64_bf16 v[116:119], v[48:51], v[72:79], v2
ds_read_b128 v[72:75], v5 offset:38912
ds_read_b128 v[76:79], v5 offset:39936
s_waitcnt lgkmcnt(6)
v_smfmac_f32_16x16x64_bf16 v[112:115], v[52:55], v[80:87], v2
ds_read_b128 v[80:83], v5 offset:53248
ds_read_b128 v[84:87], v5 offset:54272
s_waitcnt lgkmcnt(6)
v_smfmac_f32_16x16x64_bf16 v[116:119], v[52:55], v[88:95], v2
ds_read_b128 v[88:91], v5 offset:55296
ds_read_b128 v[92:95], v5 offset:56320
s_waitcnt lgkmcnt(6)
v_smfmac_f32_16x16x64_bf16 v[112:115], v[56:59], v[64:71], v2
s_waitcnt lgkmcnt(4)
v_smfmac_f32_16x16x64_bf16 v[116:119], v[56:59], v[72:79], v2
s_waitcnt lgkmcnt(2)
v_smfmac_f32_16x16x64_bf16 v[112:115], v[60:63], v[80:87], v2
s_waitcnt lgkmcnt(0)
v_smfmac_f32_16x16x64_bf16 v[116:119], v[60:63], v[88:95], v2
buffer_load_dwordx2 v[108:109], v11, s[4:7], s38 offen sc1
v_mfma_f32_16x16x16_bf16 v[100:103], v[96:97], v[16:17], 0
v_mfma_f32_16x16x16_bf16 v[104:107], v[98:99], v[16:17], 0
s_nop 4
v_add_f32 v112, v112, v114
v_add_f32 v113, v113, v115
v_add_f32 v114, v116, v118
v_add_f32 v115, v117, v119
v_cvt_pk_bf16_f32 v18, v112, v113
v_cvt_pk_bf16_f32 v19, v114, v115
v_and_or_b32 v18, v18, -2, s41
buffer_load_dwordx2 v[110:111], v11, s[4:7], s38 offen offset:512 sc1
s_barrier
buffer_store_dwordx2 v[18:19], v11, s[4:7], s39 offen sc1
v_mov_b32 v112, v18
v_mov_b32 v114, v19
v_mov_b32 v92, v28
v_mov_b32 v93, 0
s_waitcnt vmcnt(5)
s_barrier
ds_read_b128 v[32:35], v6 offset:14336
ds_read_b128 v[36:39], v6 offset:15360
ds_read_b128 v[40:43], v6 offset:9216
ds_read_b128 v[44:47], v6 offset:10240
ds_read_b128 v[48:51], v6 offset:24576
ds_read_b128 v[52:55], v6 offset:25600
ds_read_b128 v[56:59], v6 offset:19456
ds_read_b128 v[60:63], v6 offset:20480
buffer_load_dwordx2 v[20:21], v11, s[4:7], s38 offen sc1
buffer_load_dwordx2 v[22:23], v11, s[4:7], s38 offen offset:512 sc1
s_waitcnt vmcnt(4)
v_mfma_f32_16x16x16_bf16 v[80:83], v[108:109], v[16:17], v[100:103]
v_and_b32 v3, 1, v108
v_cmp_ne_u32 vcc, s41, v3
s_nop 5
v_cvt_pk_bf16_f32 v64, v80, v81
v_cvt_pk_bf16_f32 v65, v82, v83
s_cbranch_vccnz L_rs_w1_xslow
s_waitcnt vmcnt(3)
v_mfma_f32_16x16x16_bf16 v[84:87], v[110:111], v[16:17], v[104:107]
v_and_b32 v3, 1, v110
v_cmp_ne_u32 vcc, s41, v3
s_nop 5
v_cvt_pk_bf16_f32 v66, v84, v85
v_cvt_pk_bf16_f32 v67, v86, v87
ds_write_b128 v6, v[64:67] offset:13312
s_cbranch_vccnz L_rs_w1_xslow
L_rs_w1_xok:
s_cmp_eq_u32 s21, 63
s_cbranch_scc1 L_rs_w1_last
buffer_load_dwordx2 v[116:117], v11, s[4:7], s40 offen sc1
s_waitcnt lgkmcnt(1)
v_mfma_f32_16x16x32_bf16 v[80:83], v[32:35], v[64:67], 0
s_waitcnt lgkmcnt(0)
s_barrier
ds_read_b128 v[68:71], v6 offset:8192
ds_read_b128 v[72:75], v6 offset:23552
ds_read_b128 v[76:79], v6 offset:18432
v_mfma_f32_16x16x32_bf16 v[84:87], v[36:39], v[64:67], 0
v_mfma_f32_16x16x32_bf16 v[88:91], v[64:67], v[64:67], 0
buffer_load_dwordx2 v[20:21], v11, s[4:7], s40 offen sc1
s_waitcnt lgkmcnt(2)
v_mfma_f32_16x16x32_bf16 v[80:83], v[40:43], v[68:71], v[80:83]
s_waitcnt lgkmcnt(1)
v_mfma_f32_16x16x32_bf16 v[80:83], v[48:51], v[72:75], v[80:83]
buffer_store_dwordx4 v[64:67], v10, s[4:7], s45 offen offset:64 sc1
s_waitcnt lgkmcnt(0)
v_mfma_f32_16x16x32_bf16 v[80:83], v[56:59], v[76:79], v[80:83]
v_mfma_f32_16x16x32_bf16 v[84:87], v[44:47], v[68:71], v[84:87]
v_mfma_f32_16x16x32_bf16 v[84:87], v[52:55], v[72:75], v[84:87]
v_mfma_f32_16x16x32_bf16 v[84:87], v[60:63], v[76:79], v[84:87]
buffer_store_dwordx2 v[18:19], v11, s[4:7], s51 offen offset:2560 sc1
v_mfma_f32_16x16x32_bf16 v[88:91], v[68:71], v[68:71], v[88:91]
v_mfma_f32_16x16x32_bf16 v[88:91], v[72:75], v[72:75], v[88:91]
v_mfma_f32_16x16x32_bf16 v[88:91], v[76:79], v[76:79], v[88:91]
v_mfma_f32_32x32x4_2b_bf16 v[32:63], v[14:15], v[14:15], 0
s_nop 0
v_max3_f32 v4, v80, v81, v82
s_nop 1
v_max3_f32 v4, v4, v83, v84
v_max3_f32 v4, v4, v85, v86
v_max_f32 v4, v4, v87
v_max3_f32 v90, v4, v88, v89
v_max3_f32 v4, v4, v88, v89
s_nop 1
v_permlane16_swap_b32 v4, v90
v_max_f32 v4, v4, v90
v_max_f32 v90, v4, v90
s_nop 1
v_permlane32_swap_b32 v4, v90
v_max_f32 v4, v4, v90
v_mul_f32 v4, s34, v4
v_pk_fma_f32 v[80:81], v[80:81], s[34:35], v[4:5] op_sel_hi:[1,0,0] neg_lo:[0,0,1] neg_hi:[0,0,1]
v_pk_fma_f32 v[82:83], v[82:83], s[34:35], v[4:5] op_sel_hi:[1,0,0] neg_lo:[0,0,1] neg_hi:[0,0,1]
v_pk_fma_f32 v[84:85], v[84:85], s[34:35], v[4:5] op_sel_hi:[1,0,0] neg_lo:[0,0,1] neg_hi:[0,0,1]
v_pk_fma_f32 v[86:87], v[86:87], s[34:35], v[4:5] op_sel_hi:[1,0,0] neg_lo:[0,0,1] neg_hi:[0,0,1]
v_pk_fma_f32 v[88:89], v[88:89], s[34:35], v[4:5] op_sel_hi:[1,0,0] neg_lo:[0,0,1] neg_hi:[0,0,1]
v_exp_f32 v80, v80
v_exp_f32 v81, v81
v_exp_f32 v82, v82
v_cvt_pk_bf16_f32 v68, v80, v81
v_exp_f32 v83, v83
v_exp_f32 v84, v84
v_cvt_pk_bf16_f32 v69, v82, v83
v_exp_f32 v85, v85
v_exp_f32 v86, v86
v_cvt_pk_bf16_f32 v70, v84, v85
v_exp_f32 v87, v87
v_exp_f32 v88, v88
v_cvt_pk_bf16_f32 v71, v86, v87
v_exp_f32 v89, v89
s_waitcnt vmcnt(3)
v_mfma_f32_16x16x32_bf16 v[76:79], v[28:31], v[68:71], 0
v_and_b32 v3, 1, v116
v_cvt_pk_bf16_f32 v72, v88, v89
v_mfma_f32_16x16x32_bf16 v[100:103], v[120:123], v[68:71], 0
v_cmp_ne_u32 vcc, s41, v3
v_cvt_pk_bf16_f32 v73, v88, v89
v_mfma_f32_16x16x32_bf16 v[104:107], v[124:127], v[68:71], 0
v_mov_b32 v113, v116
v_mov_b32 v115, v117
v_mfma_f32_16x16x16_bf16 v[76:79], v[92:93], v[72:73], v[76:79]
s_cbranch_vccnz L_rs_w1_pv0
L_rs_w1_pv2:
v_mfma_f32_16x16x16_bf16 v[100:103], v[112:113], v[72:73], v[100:103]
v_mfma_f32_16x16x16_bf16 v[104:107], v[114:115], v[72:73], v[104:107]
buffer_load_dwordx4 v[120:123], v1, s[4:7], s44 offen sc1
buffer_load_dwordx4 v[124:127], v1, s[4:7], s44 offen offset:1024 sc1
s_nop 2
v_rcp_f32 v76, v76
s_mov_b64 exec, s[28:29]
v_pk_mul_f32 v[100:101], v[100:101], v[76:77] op_sel_hi:[1,0]
v_pk_mul_f32 v[102:103], v[102:103], v[76:77] op_sel_hi:[1,0]
v_pk_mul_f32 v[104:105], v[104:105], v[76:77] op_sel_hi:[1,0]
v_pk_mul_f32 v[106:107], v[106:107], v[76:77] op_sel_hi:[1,0]
v_cvt_pk_bf16_f32 v84, v100, v101
v_cvt_pk_bf16_f32 v85, v102, v103
v_cvt_pk_bf16_f32 v86, v104, v105
v_cvt_pk_bf16_f32 v87, v106, v107
ds_write_b128 v6, v[84:87] offset:28672
s_mov_b64 exec, -1
s_waitcnt lgkmcnt(0)
s_barrier
ds_read_b128 v[68:71], v6 offset:28672
ds_read_b128 v[72:75], v6 offset:29696
s_waitcnt lgkmcnt(1)
v_smfmac_f32_16x16x64_bf16 v[32:35], v[68:71], v[128:135], v2
s_add_u32 s21, s21, 1
s_xor_b32 s38, s38, 1048576
s_xor_b32 s37, s37, 1048576
s_waitcnt lgkmcnt(0)
v_smfmac_f32_16x16x64_bf16 v[32:35], v[72:75], v[136:143], v2
s_xor_b32 s40, s40, 1048576
s_xor_b32 s39, s39, 1048576
s_lshr_b32 s41, s21, 1
v_smfmac_f32_16x16x64_bf16 v[36:39], v[68:71], v[144:151], v2
s_and_b32 s41, s41, 1
s_xor_b32 s41, s41, 1
s_xor_b32 s35, s35, 16384
v_smfmac_f32_16x16x64_bf16 v[36:39], v[72:75], v[152:159], v2
v_add_f32 v32, v32, v34
s_xor_b32 s36, s36, 16384
s_add_u32 s43, s43, 262144
s_add_u32 s44, s44, 262144
v_smfmac_f32_16x16x64_bf16 v[40:43], v[68:71], v[160:167], v2
v_add_f32 v33, v33, v35
v_smfmac_f32_16x16x64_bf16 v[40:43], v[72:75], v[168:175], v2
v_cvt_pk_bf16_f32 v32, v32, v33
v_smfmac_f32_16x16x64_bf16 v[44:47], v[68:71], v[176:183], v2
v_and_or_b32 v32, v32, -2, s42
v_smfmac_f32_16x16x64_bf16 v[44:47], v[72:75], v[184:191], v2
v_add_f32 v36, v36, v38
v_smfmac_f32_16x16x64_bf16 v[48:51], v[68:71], v[192:199], v2
v_add_f32 v37, v37, v39
v_smfmac_f32_16x16x64_bf16 v[48:51], v[72:75], v[200:207], v2
v_cvt_pk_bf16_f32 v33, v36, v37
v_smfmac_f32_16x16x64_bf16 v[52:55], v[68:71], v[208:215], v2
v_add_f32 v40, v40, v42
v_smfmac_f32_16x16x64_bf16 v[52:55], v[72:75], v[216:223], v2
v_add_f32 v41, v41, v43
v_smfmac_f32_16x16x64_bf16 v[56:59], v[68:71], v[224:231], v2
v_cvt_pk_bf16_f32 v34, v40, v41
v_smfmac_f32_16x16x64_bf16 v[56:59], v[72:75], v[232:239], v2
v_add_f32 v44, v44, v46
v_smfmac_f32_16x16x64_bf16 v[60:63], v[68:71], v[240:247], v2
v_add_f32 v45, v45, v47
v_smfmac_f32_16x16x64_bf16 v[60:63], v[72:75], v[248:255], v2
v_cvt_pk_bf16_f32 v35, v44, v45
buffer_store_dwordx4 v[32:35], v8, s[4:7], s46 offen sc1
v_pk_add_f32 v[48:49], v[48:49], v[50:51]
v_cvt_pk_bf16_f32 v48, v48, v49
v_and_or_b32 v48, v48, -2, s42
v_pk_add_f32 v[52:53], v[52:53], v[54:55]
v_cvt_pk_bf16_f32 v49, v52, v53
v_pk_add_f32 v[56:57], v[56:57], v[58:59]
v_cvt_pk_bf16_f32 v50, v56, v57
v_pk_add_f32 v[60:61], v[60:61], v[62:63]
v_cvt_pk_bf16_f32 v51, v60, v61
buffer_store_dwordx4 v[48:51], v8, s[4:7], s61 offen sc1
s_add_u32 s45, s45, 262144
s_add_u32 s51, s51, 262144
v_mfma_f32_32x32x8_bf16 v[96:111], v[14:15], v[14:15], 0
v_mfma_f32_16x16x16_bf16 v[112:115], v[14:15], v[14:15], 0
v_mfma_f32_16x16x16_bf16 v[116:119], v[14:15], v[14:15], 0
ds_read_b128 v[64:67], v1 offset:4096
ds_read_b128 v[68:71], v1 offset:5120
ds_read_b128 v[72:75], v1 offset:6144
ds_read_b128 v[76:79], v1 offset:7168
ds_read_b128 v[80:83], v1 offset:20480
ds_read_b128 v[84:87], v1 offset:21504
ds_read_b128 v[88:91], v1 offset:22528
ds_read_b128 v[92:95], v1 offset:23552
v_mov_b32 v58, -1
v_mov_b32 v59, -1
s_waitcnt vmcnt(0)
L_rs_w1_cgo:
L_rs_w1_pc:
buffer_load_dword v36, v13, s[4:7], s25 offen sc1
buffer_load_dword v37, v13, s[4:7], s25 offen offset:256 sc1
buffer_load_dword v38, v13, s[4:7], s25 offen offset:512 sc1
buffer_load_dword v39, v13, s[4:7], s25 offen offset:768 sc1
buffer_load_dword v40, v13, s[4:7], s25 offen offset:1024 sc1
buffer_load_dword v41, v13, s[4:7], s25 offen offset:1280 sc1
buffer_load_dword v42, v13, s[4:7], s25 offen offset:1536 sc1
buffer_load_dword v43, v13, s[4:7], s25 offen offset:1792 sc1
s_waitcnt vmcnt(4)
v_mfma_f32_16x16x32_bf16 v[52:55], v[36:39], v[24:27], 0
v_bitop3_b32 v3, s42, v36, v37 bitop3:0x7e
v_bitop3_b32 v4, s42, v38, v39 bitop3:0x7e
s_waitcnt vmcnt(2)
v_or_b32 v3, v3, v4
v_bitop3_b32 v4, s42, v40, v41 bitop3:0x7e
s_waitcnt vmcnt(0)
v_mfma_f32_16x16x32_bf16 v[52:55], v[40:43], v[24:27], v[52:55]
v_bitop3_b32 v56, s42, v42, v43 bitop3:0x7e
v_or3_b32 v3, v3, v4, v56
v_and_b32 v3, v0, v3
v_cmp_ne_u32 vcc, 0, v3
s_nop 3
v_cvt_pk_bf16_f32 v56, v52, v53
v_cvt_pk_bf16_f32 v57, v54, v55
v_min_u32 v56, -2, v56
s_cbranch_vccnz L_rs_w1_pc
s_mov_b64 exec, s[26:27]
buffer_store_dwordx2 v[56:57], v9, s[4:7], s35 offen offset:256 sc1
buffer_store_dwordx2 v[58:59], v9, s[4:7], s36 offen offset:256 sc1
s_mov_b64 exec, -1
s_xor_b32 s42, s42, 1
s_branch L_rs_w1_loop
L_rs_w1_last:
buffer_store_dwordx4 v[64:67], v10, s[4:7], s45 offen offset:64 sc1
buffer_store_dwordx2 v[18:19], v11, s[4:7], s51 offen offset:2560 sc1
s_branch L_rs_end
L_rs_w1_pafail:
s_nop 7
v_mov_b32 v96, 0
v_mov_b32 v97, 0
v_mov_b32 v98, 0
v_mov_b32 v99, 0
v_mov_b32 v100, 0
v_mov_b32 v101, 0
v_mov_b32 v102, 0
v_mov_b32 v103, 0
v_mov_b32 v104, 0
v_mov_b32 v105, 0
v_mov_b32 v106, 0
v_mov_b32 v107, 0
s_branch L_rs_w1_pa
L_rs_w1_xslow:
buffer_load_dwordx2 v[108:109], v11, s[4:7], s38 offen sc1
buffer_load_dwordx2 v[110:111], v11, s[4:7], s38 offen offset:512 sc1
s_waitcnt vmcnt(2)
v_bitop3_b32 v3, s41, v20, v22 bitop3:0x7e
v_mfma_f32_16x16x16_bf16 v[80:83], v[20:21], v[16:17], v[100:103]
v_and_b32 v3, 1, v3
v_mfma_f32_16x16x16_bf16 v[84:87], v[22:23], v[16:17], v[104:107]
v_cmp_ne_u32 vcc, 0, v3
s_cbranch_vccz L_rs_w1_xgot
buffer_load_dwordx2 v[20:21], v11, s[4:7], s38 offen sc1
buffer_load_dwordx2 v[22:23], v11, s[4:7], s38 offen offset:512 sc1
s_waitcnt vmcnt(2)
v_bitop3_b32 v3, s41, v108, v110 bitop3:0x7e
v_mfma_f32_16x16x16_bf16 v[80:83], v[108:109], v[16:17], v[100:103]
v_and_b32 v3, 1, v3
v_mfma_f32_16x16x16_bf16 v[84:87], v[110:111], v[16:17], v[104:107]
v_cmp_ne_u32 vcc, 0, v3
s_cbranch_vccz L_rs_w1_xgot
s_branch L_rs_w1_xslow
L_rs_w1_xgot:
s_nop 3
v_cvt_pk_bf16_f32 v64, v80, v81
v_cvt_pk_bf16_f32 v65, v82, v83
v_cvt_pk_bf16_f32 v66, v84, v85
v_cvt_pk_bf16_f32 v67, v86, v87
ds_write_b128 v6, v[64:67] offset:13312
s_branch L_rs_w1_xok
L_rs_w1_pv0:
s_waitcnt vmcnt(2)
s_branch L_rs_w1_pv1
L_rs_w1_pv:
buffer_load_dwordx2 v[20:21], v11, s[4:7], s40 offen sc1
s_waitcnt vmcnt(0)
L_rs_w1_pv1:
v_and_b32 v3, 1, v20
v_cmp_ne_u32 vcc, s41, v3
v_mov_b32 v113, v20
v_mov_b32 v115, v21
s_cbranch_vccnz L_rs_w1_pv
s_branch L_rs_w1_pv2
L_rs_w2_entry:
v_mfma_f32_32x32x8_bf16 v[96:111], v[14:15], v[14:15], 0
v_mfma_f32_16x16x16_bf16 v[112:115], v[14:15], v[14:15], 0
v_mfma_f32_16x16x16_bf16 v[116:119], v[14:15], v[14:15], 0
ds_read_b128 v[64:67], v1 offset:8192
ds_read_b128 v[68:71], v1 offset:9216
ds_read_b128 v[72:75], v1 offset:10240
ds_read_b128 v[76:79], v1 offset:11264
ds_read_b128 v[80:83], v1 offset:24576
ds_read_b128 v[84:87], v1 offset:25600
ds_read_b128 v[88:91], v1 offset:26624
ds_read_b128 v[92:95], v1 offset:27648
buffer_load_dwordx4 v[120:123], v1, s[4:7], s44 offen sc1
buffer_load_dwordx4 v[124:127], v1, s[4:7], s44 offen offset:1024 sc1
s_add_u32 s44, s44, 262144
L_rs_w2_loop:
s_add_u32 s22, s35, 4096
s_waitcnt vmcnt(0)
buffer_load_dwordx4 v[48:51], v1, s[4:7], s22 offen sc1
buffer_load_dwordx4 v[52:55], v1, s[4:7], s22 offen offset:1024 sc1
L_rs_w2_pa:
s_waitcnt vmcnt(1)
ds_write_b128 v6, v[48:51] offset:4096
s_waitcnt vmcnt(0)
ds_write_b128 v6, v[52:55] offset:5120
v_max3_u32 v3, v48, v50, v52
v_max_u32 v3, v3, v54
v_cmp_eq_u32 vcc, -1, v3
v_smfmac_f32_16x16x64_bf16 v[96:99], v[48:51], a[64:71], v2
buffer_load_dwordx4 v[48:51], v1, s[4:7], s22 offen sc1
v_smfmac_f32_16x16x64_bf16 v[100:103], v[48:51], a[72:79], v2
buffer_load_dwordx4 v[52:55], v1, s[4:7], s22 offen offset:1024 sc1
v_smfmac_f32_16x16x64_bf16 v[104:107], v[48:51], a[192:199], v2
s_cbranch_vccnz L_rs_w2_pafail
s_waitcnt lgkmcnt(0)
s_barrier
ds_read_b128 v[56:59], v6 offset:6144
ds_read_b128 v[60:63], v6 offset:7168
v_smfmac_f32_16x16x64_bf16 v[108:111], v[48:51], a[200:207], v2
ds_read_b128 v[32:35], v6
v_smfmac_f32_16x16x64_bf16 v[96:99], v[52:55], a[80:87], v2
ds_read_b128 v[36:39], v6 offset:1024
v_smfmac_f32_16x16x64_bf16 v[100:103], v[52:55], a[88:95], v2
ds_read_b128 v[40:43], v6 offset:2048
v_smfmac_f32_16x16x64_bf16 v[104:107], v[52:55], a[208:215], v2
ds_read_b128 v[44:47], v6 offset:3072
v_smfmac_f32_16x16x64_bf16 v[108:111], v[52:55], a[216:223], v2
s_waitcnt lgkmcnt(5)
v_smfmac_f32_16x16x64_bf16 v[96:99], v[56:59], a[96:103], v2
v_smfmac_f32_16x16x64_bf16 v[104:107], v[56:59], a[224:231], v2
buffer_load_dwordx4 v1, s[4:7], s43 offen sc1 lds
s_waitcnt lgkmcnt(4)
v_smfmac_f32_16x16x64_bf16 v[96:99], v[60:63], a[112:119], v2
v_smfmac_f32_16x16x64_bf16 v[104:107], v[60:63], a[240:247], v2
s_waitcnt lgkmcnt(3)
v_smfmac_f32_16x16x64_bf16 v[96:99], v[32:35], a[0:7], v2
v_smfmac_f32_16x16x64_bf16 v[104:107], v[32:35], a[128:135], v2
buffer_load_dwordx4 v1, s[4:7], s43 offen offset:1024 sc1 lds
s_waitcnt lgkmcnt(2)
v_smfmac_f32_16x16x64_bf16 v[96:99], v[36:39], a[16:23], v2
v_smfmac_f32_16x16x64_bf16 v[104:107], v[36:39], a[144:151], v2
s_waitcnt lgkmcnt(1)
v_smfmac_f32_16x16x64_bf16 v[96:99], v[40:43], a[32:39], v2
v_smfmac_f32_16x16x64_bf16 v[104:107], v[40:43], a[160:167], v2
s_waitcnt lgkmcnt(0)
v_smfmac_f32_16x16x64_bf16 v[96:99], v[44:47], a[48:55], v2
v_smfmac_f32_16x16x64_bf16 v[104:107], v[44:47], a[176:183], v2
v_smfmac_f32_16x16x64_bf16 v[100:103], v[56:59], a[104:111], v2
s_nop 2
v_smfmac_f32_16x16x64_bf16 v[100:103], v[60:63], a[120:127], v2
s_nop 1
v_add_f32 v96, v96, v98
v_smfmac_f32_16x16x64_bf16 v[100:103], v[32:35], a[8:15], v2
v_add_f32 v97, v97, v99
v_add_f32 v104, v104, v106
v_smfmac_f32_16x16x64_bf16 v[100:103], v[36:39], a[24:31], v2
v_add_f32 v105, v105, v107
v_cvt_pk_bf16_f32 v96, v96, v97
v_smfmac_f32_16x16x64_bf16 v[100:103], v[40:43], a[40:47], v2
v_cvt_pk_bf16_f32 v97, v104, v105
v_and_or_b32 v96, v96, -2, s41
v_smfmac_f32_16x16x64_bf16 v[100:103], v[44:47], a[56:63], v2
buffer_store_dwordx2 v[96:97], v11, s[4:7], s37 offen sc1
v_smfmac_f32_16x16x64_bf16 v[108:111], v[56:59], a[232:239], v2
v_smfmac_f32_16x16x64_bf16 v[108:111], v[60:63], a[248:255], v2
v_smfmac_f32_16x16x64_bf16 v[108:111], v[32:35], a[136:143], v2
v_smfmac_f32_16x16x64_bf16 v[108:111], v[36:39], a[152:159], v2
v_smfmac_f32_16x16x64_bf16 v[108:111], v[40:43], a[168:175], v2
s_nop 2
v_add_f32 v100, v100, v102
v_smfmac_f32_16x16x64_bf16 v[108:111], v[44:47], a[184:191], v2
v_add_f32 v101, v101, v103
v_cvt_pk_bf16_f32 v98, v100, v101
v_and_or_b32 v98, v98, -2, s41
s_nop 4
v_pk_add_f32 v[108:109], v[108:109], v[110:111]
v_cvt_pk_bf16_f32 v99, v108, v109
buffer_store_dwordx2 v[98:99], v11, s[4:7], s37 offen offset:512 sc1
v_smfmac_f32_16x16x64_bf16 v[112:115], v[32:35], v[64:71], v2
ds_read_b128 v[64:67], v1 offset:40960
ds_read_b128 v[68:71], v1 offset:41984
v_smfmac_f32_16x16x64_bf16 v[116:119], v[32:35], v[72:79], v2
ds_read_b128 v[72:75], v1 offset:43008
ds_read_b128 v[76:79], v1 offset:44032
v_smfmac_f32_16x16x64_bf16 v[112:115], v[36:39], v[80:87], v2
ds_read_b128 v[80:83], v1 offset:57344
ds_read_b128 v[84:87], v1 offset:58368
v_smfmac_f32_16x16x64_bf16 v[116:119], v[36:39], v[88:95], v2
ds_read_b128 v[88:91], v1 offset:59392
ds_read_b128 v[92:95], v1 offset:60416
s_waitcnt lgkmcnt(6)
v_smfmac_f32_16x16x64_bf16 v[112:115], v[40:43], v[64:71], v2
ds_read_b128 v[64:67], v5 offset:8192
ds_read_b128 v[68:71], v5 offset:9216
s_waitcnt lgkmcnt(6)
v_smfmac_f32_16x16x64_bf16 v[116:119], v[40:43], v[72:79], v2
ds_read_b128 v[72:75], v5 offset:10240
ds_read_b128 v[76:79], v5 offset:11264
s_waitcnt lgkmcnt(6)
v_smfmac_f32_16x16x64_bf16 v[112:115], v[44:47], v[80:87], v2
ds_read_b128 v[80:83], v5 offset:24576
ds_read_b128 v[84:87], v5 offset:25600
s_waitcnt lgkmcnt(6)
v_smfmac_f32_16x16x64_bf16 v[116:119], v[44:47], v[88:95], v2
ds_read_b128 v[88:91], v5 offset:26624
ds_read_b128 v[92:95], v5 offset:27648
s_waitcnt lgkmcnt(6)
v_smfmac_f32_16x16x64_bf16 v[112:115], v[48:51], v[64:71], v2
ds_read_b128 v[64:67], v5 offset:40960
ds_read_b128 v[68:71], v5 offset:41984
s_waitcnt lgkmcnt(6)
v_smfmac_f32_16x16x64_bf16 v[116:119], v[48:51], v[72:79], v2
ds_read_b128 v[72:75], v5 offset:43008
ds_read_b128 v[76:79], v5 offset:44032
s_waitcnt lgkmcnt(6)
v_smfmac_f32_16x16x64_bf16 v[112:115], v[52:55], v[80:87], v2
ds_read_b128 v[80:83], v5 offset:57344
ds_read_b128 v[84:87], v5 offset:58368
s_waitcnt lgkmcnt(6)
v_smfmac_f32_16x16x64_bf16 v[116:119], v[52:55], v[88:95], v2
ds_read_b128 v[88:91], v5 offset:59392
ds_read_b128 v[92:95], v5 offset:60416
s_waitcnt lgkmcnt(6)
v_smfmac_f32_16x16x64_bf16 v[112:115], v[56:59], v[64:71], v2
s_waitcnt lgkmcnt(4)
v_smfmac_f32_16x16x64_bf16 v[116:119], v[56:59], v[72:79], v2
s_waitcnt lgkmcnt(2)
v_smfmac_f32_16x16x64_bf16 v[112:115], v[60:63], v[80:87], v2
s_waitcnt lgkmcnt(0)
v_smfmac_f32_16x16x64_bf16 v[116:119], v[60:63], v[88:95], v2
buffer_load_dwordx2 v[108:109], v11, s[4:7], s38 offen sc1
v_mfma_f32_16x16x16_bf16 v[100:103], v[96:97], v[16:17], 0
v_mfma_f32_16x16x16_bf16 v[104:107], v[98:99], v[16:17], 0
s_nop 4
v_add_f32 v112, v112, v114
v_add_f32 v113, v113, v115
v_add_f32 v114, v116, v118
v_add_f32 v115, v117, v119
v_cvt_pk_bf16_f32 v18, v112, v113
v_cvt_pk_bf16_f32 v19, v114, v115
v_and_or_b32 v18, v18, -2, s41
buffer_load_dwordx2 v[110:111], v11, s[4:7], s38 offen offset:512 sc1
s_barrier
buffer_store_dwordx2 v[18:19], v11, s[4:7], s39 offen sc1
v_mov_b32 v112, v18
v_mov_b32 v114, v19
v_mov_b32 v92, v28
v_mov_b32 v93, 0
s_waitcnt vmcnt(5)
s_barrier
ds_read_b128 v[32:35], v6 offset:19456
ds_read_b128 v[36:39], v6 offset:20480
ds_read_b128 v[40:43], v6 offset:24576
ds_read_b128 v[44:47], v6 offset:25600
ds_read_b128 v[48:51], v6 offset:9216
ds_read_b128 v[52:55], v6 offset:10240
ds_read_b128 v[56:59], v6 offset:14336
ds_read_b128 v[60:63], v6 offset:15360
buffer_load_dwordx2 v[20:21], v11, s[4:7], s38 offen sc1
buffer_load_dwordx2 v[22:23], v11, s[4:7], s38 offen offset:512 sc1
s_waitcnt vmcnt(4)
v_mfma_f32_16x16x16_bf16 v[80:83], v[108:109], v[16:17], v[100:103]
v_and_b32 v3, 1, v108
v_cmp_ne_u32 vcc, s41, v3
s_nop 5
v_cvt_pk_bf16_f32 v64, v80, v81
v_cvt_pk_bf16_f32 v65, v82, v83
s_cbranch_vccnz L_rs_w2_xslow
s_waitcnt vmcnt(3)
v_mfma_f32_16x16x16_bf16 v[84:87], v[110:111], v[16:17], v[104:107]
v_and_b32 v3, 1, v110
v_cmp_ne_u32 vcc, s41, v3
s_nop 5
v_cvt_pk_bf16_f32 v66, v84, v85
v_cvt_pk_bf16_f32 v67, v86, v87
ds_write_b128 v6, v[64:67] offset:18432
s_cbranch_vccnz L_rs_w2_xslow
L_rs_w2_xok:
s_cmp_eq_u32 s21, 63
s_cbranch_scc1 L_rs_w2_last
buffer_load_dwordx2 v[116:117], v11, s[4:7], s40 offen sc1
s_waitcnt lgkmcnt(1)
v_mfma_f32_16x16x32_bf16 v[80:83], v[32:35], v[64:67], 0
s_waitcnt lgkmcnt(0)
s_barrier
ds_read_b128 v[68:71], v6 offset:23552
ds_read_b128 v[72:75], v6 offset:8192
ds_read_b128 v[76:79], v6 offset:13312
v_mfma_f32_16x16x32_bf16 v[84:87], v[36:39], v[64:67], 0
v_mfma_f32_16x16x32_bf16 v[88:91], v[64:67], v[64:67], 0
buffer_load_dwordx2 v[20:21], v11, s[4:7], s40 offen sc1
s_waitcnt lgkmcnt(2)
v_mfma_f32_16x16x32_bf16 v[80:83], v[40:43], v[68:71], v[80:83]
s_waitcnt lgkmcnt(1)
v_mfma_f32_16x16x32_bf16 v[80:83], v[48:51], v[72:75], v[80:83]
s_waitcnt lgkmcnt(0)
v_mfma_f32_16x16x32_bf16 v[80:83], v[56:59], v[76:79], v[80:83]
buffer_store_dwordx4 v[64:67], v10, s[4:7], s45 offen offset:128 sc1
v_mfma_f32_16x16x32_bf16 v[84:87], v[44:47], v[68:71], v[84:87]
v_mfma_f32_16x16x32_bf16 v[84:87], v[52:55], v[72:75], v[84:87]
v_mfma_f32_16x16x32_bf16 v[84:87], v[60:63], v[76:79], v[84:87]
v_mfma_f32_16x16x32_bf16 v[88:91], v[68:71], v[68:71], v[88:91]
buffer_store_dwordx2 v[18:19], v11, s[4:7], s51 offen offset:3072 sc1
v_mfma_f32_16x16x32_bf16 v[88:91], v[72:75], v[72:75], v[88:91]
v_mfma_f32_16x16x32_bf16 v[88:91], v[76:79], v[76:79], v[88:91]
v_mfma_f32_32x32x4_2b_bf16 v[32:63], v[14:15], v[14:15], 0
s_nop 0
v_max3_f32 v4, v80, v81, v82
s_nop 1
v_max3_f32 v4, v4, v83, v84
v_max3_f32 v4, v4, v85, v86
v_max_f32 v4, v4, v87
v_max3_f32 v90, v4, v88, v89
v_max3_f32 v4, v4, v88, v89
s_nop 1
v_permlane16_swap_b32 v4, v90
v_max_f32 v4, v4, v90
v_max_f32 v90, v4, v90
s_nop 1
v_permlane32_swap_b32 v4, v90
v_max_f32 v4, v4, v90
v_mul_f32 v4, s34, v4
v_pk_fma_f32 v[80:81], v[80:81], s[34:35], v[4:5] op_sel_hi:[1,0,0] neg_lo:[0,0,1] neg_hi:[0,0,1]
v_pk_fma_f32 v[82:83], v[82:83], s[34:35], v[4:5] op_sel_hi:[1,0,0] neg_lo:[0,0,1] neg_hi:[0,0,1]
v_pk_fma_f32 v[84:85], v[84:85], s[34:35], v[4:5] op_sel_hi:[1,0,0] neg_lo:[0,0,1] neg_hi:[0,0,1]
v_pk_fma_f32 v[86:87], v[86:87], s[34:35], v[4:5] op_sel_hi:[1,0,0] neg_lo:[0,0,1] neg_hi:[0,0,1]
v_pk_fma_f32 v[88:89], v[88:89], s[34:35], v[4:5] op_sel_hi:[1,0,0] neg_lo:[0,0,1] neg_hi:[0,0,1]
v_exp_f32 v80, v80
v_exp_f32 v81, v81
v_exp_f32 v82, v82
v_cvt_pk_bf16_f32 v68, v80, v81
v_exp_f32 v83, v83
v_exp_f32 v84, v84
v_cvt_pk_bf16_f32 v69, v82, v83
v_exp_f32 v85, v85
v_exp_f32 v86, v86
v_cvt_pk_bf16_f32 v70, v84, v85
v_exp_f32 v87, v87
v_exp_f32 v88, v88
v_cvt_pk_bf16_f32 v71, v86, v87
v_exp_f32 v89, v89
s_waitcnt vmcnt(3)
v_mfma_f32_16x16x32_bf16 v[76:79], v[28:31], v[68:71], 0
v_and_b32 v3, 1, v116
v_cvt_pk_bf16_f32 v72, v88, v89
v_mfma_f32_16x16x32_bf16 v[100:103], v[120:123], v[68:71], 0
v_cmp_ne_u32 vcc, s41, v3
v_cvt_pk_bf16_f32 v73, v88, v89
v_mfma_f32_16x16x32_bf16 v[104:107], v[124:127], v[68:71], 0
v_mov_b32 v113, v116
v_mov_b32 v115, v117
v_mfma_f32_16x16x16_bf16 v[76:79], v[92:93], v[72:73], v[76:79]
s_cbranch_vccnz L_rs_w2_pv0
L_rs_w2_pv2:
v_mfma_f32_16x16x16_bf16 v[100:103], v[112:113], v[72:73], v[100:103]
v_mfma_f32_16x16x16_bf16 v[104:107], v[114:115], v[72:73], v[104:107]
buffer_load_dwordx4 v[120:123], v1, s[4:7], s44 offen sc1
buffer_load_dwordx4 v[124:127], v1, s[4:7], s44 offen offset:1024 sc1
s_nop 2
v_rcp_f32 v76, v76
s_mov_b64 exec, s[28:29]
v_pk_mul_f32 v[100:101], v[100:101], v[76:77] op_sel_hi:[1,0]
v_pk_mul_f32 v[102:103], v[102:103], v[76:77] op_sel_hi:[1,0]
v_pk_mul_f32 v[104:105], v[104:105], v[76:77] op_sel_hi:[1,0]
v_pk_mul_f32 v[106:107], v[106:107], v[76:77] op_sel_hi:[1,0]
v_cvt_pk_bf16_f32 v84, v100, v101
v_cvt_pk_bf16_f32 v85, v102, v103
v_cvt_pk_bf16_f32 v86, v104, v105
v_cvt_pk_bf16_f32 v87, v106, v107
ds_write_b128 v6, v[84:87] offset:29664
s_mov_b64 exec, -1
s_waitcnt lgkmcnt(0)
s_barrier
ds_read_b128 v[68:71], v6 offset:28672
ds_read_b128 v[72:75], v6 offset:29696
s_waitcnt lgkmcnt(1)
v_smfmac_f32_16x16x64_bf16 v[32:35], v[68:71], v[128:135], v2
s_add_u32 s21, s21, 1
s_xor_b32 s38, s38, 1048576
s_xor_b32 s37, s37, 1048576
s_waitcnt lgkmcnt(0)
v_smfmac_f32_16x16x64_bf16 v[32:35], v[72:75], v[136:143], v2
s_xor_b32 s40, s40, 1048576
s_xor_b32 s39, s39, 1048576
s_lshr_b32 s41, s21, 1
v_smfmac_f32_16x16x64_bf16 v[36:39], v[68:71], v[144:151], v2
s_and_b32 s41, s41, 1
s_xor_b32 s41, s41, 1
s_xor_b32 s35, s35, 16384
v_smfmac_f32_16x16x64_bf16 v[36:39], v[72:75], v[152:159], v2
v_add_f32 v32, v32, v34
s_xor_b32 s36, s36, 16384
s_add_u32 s43, s43, 262144
s_add_u32 s44, s44, 262144
v_smfmac_f32_16x16x64_bf16 v[40:43], v[68:71], v[160:167], v2
v_add_f32 v33, v33, v35
v_smfmac_f32_16x16x64_bf16 v[40:43], v[72:75], v[168:175], v2
v_cvt_pk_bf16_f32 v32, v32, v33
v_smfmac_f32_16x16x64_bf16 v[44:47], v[68:71], v[176:183], v2
v_and_or_b32 v32, v32, -2, s42
v_smfmac_f32_16x16x64_bf16 v[44:47], v[72:75], v[184:191], v2
v_add_f32 v36, v36, v38
v_smfmac_f32_16x16x64_bf16 v[48:51], v[68:71], v[192:199], v2
v_add_f32 v37, v37, v39
v_smfmac_f32_16x16x64_bf16 v[48:51], v[72:75], v[200:207], v2
v_cvt_pk_bf16_f32 v33, v36, v37
v_smfmac_f32_16x16x64_bf16 v[52:55], v[68:71], v[208:215], v2
v_add_f32 v40, v40, v42
v_smfmac_f32_16x16x64_bf16 v[52:55], v[72:75], v[216:223], v2
v_add_f32 v41, v41, v43
v_smfmac_f32_16x16x64_bf16 v[56:59], v[68:71], v[224:231], v2
v_cvt_pk_bf16_f32 v34, v40, v41
v_smfmac_f32_16x16x64_bf16 v[56:59], v[72:75], v[232:239], v2
v_add_f32 v44, v44, v46
v_smfmac_f32_16x16x64_bf16 v[60:63], v[68:71], v[240:247], v2
v_add_f32 v45, v45, v47
v_smfmac_f32_16x16x64_bf16 v[60:63], v[72:75], v[248:255], v2
v_cvt_pk_bf16_f32 v35, v44, v45
buffer_store_dwordx4 v[32:35], v8, s[4:7], s46 offen sc1
v_pk_add_f32 v[48:49], v[48:49], v[50:51]
v_cvt_pk_bf16_f32 v48, v48, v49
v_and_or_b32 v48, v48, -2, s42
v_pk_add_f32 v[52:53], v[52:53], v[54:55]
v_cvt_pk_bf16_f32 v49, v52, v53
v_pk_add_f32 v[56:57], v[56:57], v[58:59]
v_cvt_pk_bf16_f32 v50, v56, v57
v_pk_add_f32 v[60:61], v[60:61], v[62:63]
v_cvt_pk_bf16_f32 v51, v60, v61
buffer_store_dwordx4 v[48:51], v8, s[4:7], s61 offen sc1
s_add_u32 s45, s45, 262144
s_add_u32 s51, s51, 262144
v_mfma_f32_32x32x8_bf16 v[96:111], v[14:15], v[14:15], 0
v_mfma_f32_16x16x16_bf16 v[112:115], v[14:15], v[14:15], 0
v_mfma_f32_16x16x16_bf16 v[116:119], v[14:15], v[14:15], 0
ds_read_b128 v[64:67], v1 offset:8192
ds_read_b128 v[68:71], v1 offset:9216
ds_read_b128 v[72:75], v1 offset:10240
ds_read_b128 v[76:79], v1 offset:11264
ds_read_b128 v[80:83], v1 offset:24576
ds_read_b128 v[84:87], v1 offset:25600
ds_read_b128 v[88:91], v1 offset:26624
ds_read_b128 v[92:95], v1 offset:27648
v_mov_b32 v58, -1
v_mov_b32 v59, -1
s_waitcnt vmcnt(0)
L_rs_w2_cgo:
L_rs_w2_pc:
buffer_load_dword v36, v13, s[4:7], s25 offen sc1
buffer_load_dword v37, v13, s[4:7], s25 offen offset:256 sc1
buffer_load_dword v38, v13, s[4:7], s25 offen offset:512 sc1
buffer_load_dword v39, v13, s[4:7], s25 offen offset:768 sc1
buffer_load_dword v40, v13, s[4:7], s25 offen offset:1024 sc1
buffer_load_dword v41, v13, s[4:7], s25 offen offset:1280 sc1
buffer_load_dword v42, v13, s[4:7], s25 offen offset:1536 sc1
buffer_load_dword v43, v13, s[4:7], s25 offen offset:1792 sc1
s_waitcnt vmcnt(4)
v_mfma_f32_16x16x32_bf16 v[52:55], v[36:39], v[24:27], 0
v_bitop3_b32 v3, s42, v36, v37 bitop3:0x7e
v_bitop3_b32 v4, s42, v38, v39 bitop3:0x7e
s_waitcnt vmcnt(2)
v_or_b32 v3, v3, v4
v_bitop3_b32 v4, s42, v40, v41 bitop3:0x7e
s_waitcnt vmcnt(0)
v_mfma_f32_16x16x32_bf16 v[52:55], v[40:43], v[24:27], v[52:55]
v_bitop3_b32 v56, s42, v42, v43 bitop3:0x7e
v_or3_b32 v3, v3, v4, v56
v_and_b32 v3, v0, v3
v_cmp_ne_u32 vcc, 0, v3
s_nop 3
v_cvt_pk_bf16_f32 v56, v52, v53
v_cvt_pk_bf16_f32 v57, v54, v55
v_min_u32 v56, -2, v56
s_cbranch_vccnz L_rs_w2_pc
s_mov_b64 exec, s[26:27]
buffer_store_dwordx2 v[56:57], v9, s[4:7], s35 offen offset:512 sc1
buffer_store_dwordx2 v[58:59], v9, s[4:7], s36 offen offset:512 sc1
s_mov_b64 exec, -1
s_xor_b32 s42, s42, 1
s_branch L_rs_w2_loop
L_rs_w2_last:
buffer_store_dwordx4 v[64:67], v10, s[4:7], s45 offen offset:128 sc1
buffer_store_dwordx2 v[18:19], v11, s[4:7], s51 offen offset:3072 sc1
s_branch L_rs_end
L_rs_w2_pafail:
s_nop 7
v_mov_b32 v96, 0
v_mov_b32 v97, 0
v_mov_b32 v98, 0
v_mov_b32 v99, 0
v_mov_b32 v100, 0
v_mov_b32 v101, 0
v_mov_b32 v102, 0
v_mov_b32 v103, 0
v_mov_b32 v104, 0
v_mov_b32 v105, 0
v_mov_b32 v106, 0
v_mov_b32 v107, 0
s_branch L_rs_w2_pa
L_rs_w2_xslow:
buffer_load_dwordx2 v[108:109], v11, s[4:7], s38 offen sc1
buffer_load_dwordx2 v[110:111], v11, s[4:7], s38 offen offset:512 sc1
s_waitcnt vmcnt(2)
v_bitop3_b32 v3, s41, v20, v22 bitop3:0x7e
v_mfma_f32_16x16x16_bf16 v[80:83], v[20:21], v[16:17], v[100:103]
v_and_b32 v3, 1, v3
v_mfma_f32_16x16x16_bf16 v[84:87], v[22:23], v[16:17], v[104:107]
v_cmp_ne_u32 vcc, 0, v3
s_cbranch_vccz L_rs_w2_xgot
buffer_load_dwordx2 v[20:21], v11, s[4:7], s38 offen sc1
buffer_load_dwordx2 v[22:23], v11, s[4:7], s38 offen offset:512 sc1
s_waitcnt vmcnt(2)
v_bitop3_b32 v3, s41, v108, v110 bitop3:0x7e
v_mfma_f32_16x16x16_bf16 v[80:83], v[108:109], v[16:17], v[100:103]
v_and_b32 v3, 1, v3
v_mfma_f32_16x16x16_bf16 v[84:87], v[110:111], v[16:17], v[104:107]
v_cmp_ne_u32 vcc, 0, v3
s_cbranch_vccz L_rs_w2_xgot
s_branch L_rs_w2_xslow
L_rs_w2_xgot:
s_nop 3
v_cvt_pk_bf16_f32 v64, v80, v81
v_cvt_pk_bf16_f32 v65, v82, v83
v_cvt_pk_bf16_f32 v66, v84, v85
v_cvt_pk_bf16_f32 v67, v86, v87
ds_write_b128 v6, v[64:67] offset:18432
s_branch L_rs_w2_xok
L_rs_w2_pv0:
s_waitcnt vmcnt(2)
s_branch L_rs_w2_pv1
L_rs_w2_pv:
buffer_load_dwordx2 v[20:21], v11, s[4:7], s40 offen sc1
s_waitcnt vmcnt(0)
L_rs_w2_pv1:
v_and_b32 v3, 1, v20
v_cmp_ne_u32 vcc, s41, v3
v_mov_b32 v113, v20
v_mov_b32 v115, v21
s_cbranch_vccnz L_rs_w2_pv
s_branch L_rs_w2_pv2
L_rs_w3_entry:
v_mfma_f32_32x32x8_bf16 v[96:111], v[14:15], v[14:15], 0
v_mfma_f32_16x16x16_bf16 v[112:115], v[14:15], v[14:15], 0
v_mfma_f32_16x16x16_bf16 v[116:119], v[14:15], v[14:15], 0
ds_read_b128 v[64:67], v1 offset:12288
ds_read_b128 v[68:71], v1 offset:13312
ds_read_b128 v[72:75], v1 offset:14336
ds_read_b128 v[76:79], v1 offset:15360
ds_read_b128 v[80:83], v1 offset:28672
ds_read_b128 v[84:87], v1 offset:29696
ds_read_b128 v[88:91], v1 offset:30720
ds_read_b128 v[92:95], v1 offset:31744
buffer_load_dwordx4 v[120:123], v1, s[4:7], s44 offen sc1
buffer_load_dwordx4 v[124:127], v1, s[4:7], s44 offen offset:1024 sc1
s_add_u32 s44, s44, 262144
L_rs_w3_loop:
s_add_u32 s22, s35, 6144
s_waitcnt vmcnt(0)
buffer_load_dwordx4 v[56:59], v1, s[4:7], s22 offen sc1
buffer_load_dwordx4 v[60:63], v1, s[4:7], s22 offen offset:1024 sc1
L_rs_w3_pa:
s_waitcnt vmcnt(1)
ds_write_b128 v6, v[56:59] offset:6144
s_waitcnt vmcnt(0)
ds_write_b128 v6, v[60:63] offset:7168
v_max3_u32 v3, v56, v58, v60
v_max_u32 v3, v3, v62
v_cmp_eq_u32 vcc, -1, v3
v_smfmac_f32_16x16x64_bf16 v[96:99], v[56:59], a[96:103], v2
buffer_load_dwordx4 v[56:59], v1, s[4:7], s22 offen sc1
v_smfmac_f32_16x16x64_bf16 v[100:103], v[56:59], a[104:111], v2
buffer_load_dwordx4 v[60:63], v1, s[4:7], s22 offen offset:1024 sc1
v_smfmac_f32_16x16x64_bf16 v[104:107], v[56:59], a[224:231], v2
s_cbranch_vccnz L_rs_w3_pafail
s_waitcnt lgkmcnt(0)
s_barrier
ds_read_b128 v[32:35], v6
ds_read_b128 v[36:39], v6 offset:1024
v_smfmac_f32_16x16x64_bf16 v[108:111], v[56:59], a[232:239], v2
ds_read_b128 v[40:43], v6 offset:2048
v_smfmac_f32_16x16x64_bf16 v[96:99], v[60:63], a[112:119], v2
ds_read_b128 v[44:47], v6 offset:3072
v_smfmac_f32_16x16x64_bf16 v[100:103], v[60:63], a[120:127], v2
ds_read_b128 v[48:51], v6 offset:4096
v_smfmac_f32_16x16x64_bf16 v[104:107], v[60:63], a[240:247], v2
ds_read_b128 v[52:55], v6 offset:5120
v_smfmac_f32_16x16x64_bf16 v[108:111], v[60:63], a[248:255], v2
s_waitcnt lgkmcnt(5)
v_smfmac_f32_16x16x64_bf16 v[96:99], v[32:35], a[0:7], v2
v_smfmac_f32_16x16x64_bf16 v[104:107], v[32:35], a[128:135], v2
s_waitcnt lgkmcnt(4)
v_smfmac_f32_16x16x64_bf16 v[96:99], v[36:39], a[16:23], v2
buffer_load_dwordx4 v1, s[4:7], s43 offen sc1 lds
v_smfmac_f32_16x16x64_bf16 v[104:107], v[36:39], a[144:151], v2
s_waitcnt lgkmcnt(3)
v_smfmac_f32_16x16x64_bf16 v[96:99], v[40:43], a[32:39], v2
v_smfmac_f32_16x16x64_bf16 v[104:107], v[40:43], a[160:167], v2
s_waitcnt lgkmcnt(2)
v_smfmac_f32_16x16x64_bf16 v[96:99], v[44:47], a[48:55], v2
buffer_load_dwordx4 v1, s[4:7], s43 offen offset:1024 sc1 lds
v_smfmac_f32_16x16x64_bf16 v[104:107], v[44:47], a[176:183], v2
s_waitcnt lgkmcnt(1)
v_smfmac_f32_16x16x64_bf16 v[96:99], v[48:51], a[64:71], v2
v_smfmac_f32_16x16x64_bf16 v[104:107], v[48:51], a[192:199], v2
s_waitcnt lgkmcnt(0)
v_smfmac_f32_16x16x64_bf16 v[96:99], v[52:55], a[80:87], v2
buffer_load_dword v12, v7, s[4:7], 0 offen sc1
v_smfmac_f32_16x16x64_bf16 v[104:107], v[52:55], a[208:215], v2
v_smfmac_f32_16x16x64_bf16 v[100:103], v[32:35], a[8:15], v2
s_nop 2
v_smfmac_f32_16x16x64_bf16 v[100:103], v[36:39], a[24:31], v2
s_nop 1
v_add_f32 v96, v96, v98
v_smfmac_f32_16x16x64_bf16 v[100:103], v[40:43], a[40:47], v2
v_add_f32 v97, v97, v99
v_add_f32 v104, v104, v106
v_smfmac_f32_16x16x64_bf16 v[100:103], v[44:47], a[56:63], v2
v_add_f32 v105, v105, v107
v_cvt_pk_bf16_f32 v96, v96, v97
v_smfmac_f32_16x16x64_bf16 v[100:103], v[48:51], a[72:79], v2
v_cvt_pk_bf16_f32 v97, v104, v105
v_and_or_b32 v96, v96, -2, s41
v_smfmac_f32_16x16x64_bf16 v[100:103], v[52:55], a[88:95], v2
buffer_store_dwordx2 v[96:97], v11, s[4:7], s37 offen sc1
v_smfmac_f32_16x16x64_bf16 v[108:111], v[32:35], a[136:143], v2
v_smfmac_f32_16x16x64_bf16 v[108:111], v[36:39], a[152:159], v2
v_smfmac_f32_16x16x64_bf16 v[108:111], v[40:43], a[168:175], v2
v_smfmac_f32_16x16x64_bf16 v[108:111], v[44:47], a[184:191], v2
v_smfmac_f32_16x16x64_bf16 v[108:111], v[48:51], a[200:207], v2
s_nop 2
v_add_f32 v100, v100, v102
v_smfmac_f32_16x16x64_bf16 v[108:111], v[52:55], a[216:223], v2
v_add_f32 v101, v101, v103
v_cvt_pk_bf16_f32 v98, v100, v101
v_and_or_b32 v98, v98, -2, s41
s_nop 4
v_pk_add_f32 v[108:109], v[108:109], v[110:111]
v_cvt_pk_bf16_f32 v99, v108, v109
buffer_store_dwordx2 v[98:99], v11, s[4:7], s37 offen offset:512 sc1
v_smfmac_f32_16x16x64_bf16 v[112:115], v[32:35], v[64:71], v2
ds_read_b128 v[64:67], v1 offset:45056
ds_read_b128 v[68:71], v1 offset:46080
v_smfmac_f32_16x16x64_bf16 v[116:119], v[32:35], v[72:79], v2
ds_read_b128 v[72:75], v1 offset:47104
ds_read_b128 v[76:79], v1 offset:48128
v_smfmac_f32_16x16x64_bf16 v[112:115], v[36:39], v[80:87], v2
ds_read_b128 v[80:83], v1 offset:61440
ds_read_b128 v[84:87], v1 offset:62464
v_smfmac_f32_16x16x64_bf16 v[116:119], v[36:39], v[88:95], v2
ds_read_b128 v[88:91], v1 offset:63488
ds_read_b128 v[92:95], v1 offset:64512
s_waitcnt lgkmcnt(6)
v_smfmac_f32_16x16x64_bf16 v[112:115], v[40:43], v[64:71], v2
ds_read_b128 v[64:67], v5 offset:12288
ds_read_b128 v[68:71], v5 offset:13312
s_waitcnt lgkmcnt(6)
v_smfmac_f32_16x16x64_bf16 v[116:119], v[40:43], v[72:79], v2
ds_read_b128 v[72:75], v5 offset:14336
ds_read_b128 v[76:79], v5 offset:15360
s_waitcnt lgkmcnt(6)
v_smfmac_f32_16x16x64_bf16 v[112:115], v[44:47], v[80:87], v2
ds_read_b128 v[80:83], v5 offset:28672
ds_read_b128 v[84:87], v5 offset:29696
s_waitcnt lgkmcnt(6)
v_smfmac_f32_16x16x64_bf16 v[116:119], v[44:47], v[88:95], v2
ds_read_b128 v[88:91], v5 offset:30720
ds_read_b128 v[92:95], v5 offset:31744
s_waitcnt lgkmcnt(6)
v_smfmac_f32_16x16x64_bf16 v[112:115], v[48:51], v[64:71], v2
ds_read_b128 v[64:67], v5 offset:45056
ds_read_b128 v[68:71], v5 offset:46080
s_waitcnt lgkmcnt(6)
v_smfmac_f32_16x16x64_bf16 v[116:119], v[48:51], v[72:79], v2
ds_read_b128 v[72:75], v5 offset:47104
ds_read_b128 v[76:79], v5 offset:48128
s_waitcnt lgkmcnt(6)
v_smfmac_f32_16x16x64_bf16 v[112:115], v[52:55], v[80:87], v2
ds_read_b128 v[80:83], v5 offset:61440
ds_read_b128 v[84:87], v5 offset:62464
s_waitcnt lgkmcnt(6)
v_smfmac_f32_16x16x64_bf16 v[116:119], v[52:55], v[88:95], v2
ds_read_b128 v[88:91], v5 offset:63488
ds_read_b128 v[92:95], v5 offset:64512
s_waitcnt lgkmcnt(6)
v_smfmac_f32_16x16x64_bf16 v[112:115], v[56:59], v[64:71], v2
s_waitcnt lgkmcnt(4)
v_smfmac_f32_16x16x64_bf16 v[116:119], v[56:59], v[72:79], v2
s_waitcnt lgkmcnt(2)
v_smfmac_f32_16x16x64_bf16 v[112:115], v[60:63], v[80:87], v2
s_waitcnt lgkmcnt(0)
v_smfmac_f32_16x16x64_bf16 v[116:119], v[60:63], v[88:95], v2
buffer_load_dwordx2 v[108:109], v11, s[4:7], s38 offen sc1
v_mfma_f32_16x16x16_bf16 v[100:103], v[96:97], v[16:17], 0
v_mfma_f32_16x16x16_bf16 v[104:107], v[98:99], v[16:17], 0
s_nop 4
v_add_f32 v112, v112, v114
v_add_f32 v113, v113, v115
v_add_f32 v114, v116, v118
v_add_f32 v115, v117, v119
v_cvt_pk_bf16_f32 v18, v112, v113
v_cvt_pk_bf16_f32 v19, v114, v115
v_and_or_b32 v18, v18, -2, s41
buffer_load_dwordx2 v[110:111], v11, s[4:7], s38 offen offset:512 sc1
s_barrier
buffer_store_dwordx2 v[18:19], v11, s[4:7], s39 offen sc1
v_mov_b32 v112, v18
v_mov_b32 v114, v19
v_mov_b32 v92, v28
v_mov_b32 v93, 0
s_waitcnt vmcnt(6)
s_barrier
ds_read_b128 v[32:35], v6 offset:24576
ds_read_b128 v[36:39], v6 offset:25600
ds_read_b128 v[40:43], v6 offset:19456
ds_read_b128 v[44:47], v6 offset:20480
ds_read_b128 v[48:51], v6 offset:14336
ds_read_b128 v[52:55], v6 offset:15360
ds_read_b128 v[56:59], v6 offset:9216
ds_read_b128 v[60:63], v6 offset:10240
buffer_load_dwordx2 v[20:21], v11, s[4:7], s38 offen sc1
buffer_load_dwordx2 v[22:23], v11, s[4:7], s38 offen offset:512 sc1
s_waitcnt vmcnt(4)
v_mfma_f32_16x16x16_bf16 v[80:83], v[108:109], v[16:17], v[100:103]
v_and_b32 v3, 1, v108
v_cmp_ne_u32 vcc, s41, v3
s_nop 5
v_cvt_pk_bf16_f32 v64, v80, v81
v_cvt_pk_bf16_f32 v65, v82, v83
s_cbranch_vccnz L_rs_w3_xslow
s_waitcnt vmcnt(3)
v_mfma_f32_16x16x16_bf16 v[84:87], v[110:111], v[16:17], v[104:107]
v_and_b32 v3, 1, v110
v_cmp_ne_u32 vcc, s41, v3
s_nop 5
v_cvt_pk_bf16_f32 v66, v84, v85
v_cvt_pk_bf16_f32 v67, v86, v87
ds_write_b128 v6, v[64:67] offset:23552
s_cbranch_vccnz L_rs_w3_xslow
L_rs_w3_xok:
s_cmp_eq_u32 s21, 63
s_cbranch_scc1 L_rs_w3_last
buffer_load_dwordx2 v[116:117], v11, s[4:7], s40 offen sc1
s_waitcnt lgkmcnt(1)
v_mfma_f32_16x16x32_bf16 v[80:83], v[32:35], v[64:67], 0
s_waitcnt lgkmcnt(0)
s_barrier
ds_read_b128 v[68:71], v6 offset:18432
ds_read_b128 v[72:75], v6 offset:13312
ds_read_b128 v[76:79], v6 offset:8192
v_mfma_f32_16x16x32_bf16 v[84:87], v[36:39], v[64:67], 0
v_mfma_f32_16x16x32_bf16 v[88:91], v[64:67], v[64:67], 0
buffer_load_dwordx2 v[20:21], v11, s[4:7], s40 offen sc1
s_waitcnt lgkmcnt(2)
v_mfma_f32_16x16x32_bf16 v[80:83], v[40:43], v[68:71], v[80:83]
s_waitcnt lgkmcnt(1)
v_mfma_f32_16x16x32_bf16 v[80:83], v[48:51], v[72:75], v[80:83]
s_waitcnt lgkmcnt(0)
v_mfma_f32_16x16x32_bf16 v[80:83], v[56:59], v[76:79], v[80:83]
v_mfma_f32_16x16x32_bf16 v[84:87], v[44:47], v[68:71], v[84:87]
buffer_store_dwordx4 v[64:67], v10, s[4:7], s45 offen offset:192 sc1
v_mfma_f32_16x16x32_bf16 v[84:87], v[52:55], v[72:75], v[84:87]
v_mfma_f32_16x16x32_bf16 v[84:87], v[60:63], v[76:79], v[84:87]
v_mfma_f32_16x16x32_bf16 v[88:91], v[68:71], v[68:71], v[88:91]
v_mfma_f32_16x16x32_bf16 v[88:91], v[72:75], v[72:75], v[88:91]
buffer_store_dwordx2 v[18:19], v11, s[4:7], s51 offen offset:3584 sc1
v_mfma_f32_16x16x32_bf16 v[88:91], v[76:79], v[76:79], v[88:91]
v_mfma_f32_32x32x4_2b_bf16 v[32:63], v[14:15], v[14:15], 0
s_nop 0
v_max3_f32 v4, v80, v81, v82
s_nop 1
v_max3_f32 v4, v4, v83, v84
v_max3_f32 v4, v4, v85, v86
v_max_f32 v4, v4, v87
v_max3_f32 v90, v4, v88, v89
v_max3_f32 v4, v4, v88, v89
s_nop 1
v_permlane16_swap_b32 v4, v90
v_max_f32 v4, v4, v90
v_max_f32 v90, v4, v90
s_nop 1
v_permlane32_swap_b32 v4, v90
v_max_f32 v4, v4, v90
v_mul_f32 v4, s34, v4
v_pk_fma_f32 v[80:81], v[80:81], s[34:35], v[4:5] op_sel_hi:[1,0,0] neg_lo:[0,0,1] neg_hi:[0,0,1]
v_pk_fma_f32 v[82:83], v[82:83], s[34:35], v[4:5] op_sel_hi:[1,0,0] neg_lo:[0,0,1] neg_hi:[0,0,1]
v_pk_fma_f32 v[84:85], v[84:85], s[34:35], v[4:5] op_sel_hi:[1,0,0] neg_lo:[0,0,1] neg_hi:[0,0,1]
v_pk_fma_f32 v[86:87], v[86:87], s[34:35], v[4:5] op_sel_hi:[1,0,0] neg_lo:[0,0,1] neg_hi:[0,0,1]
v_pk_fma_f32 v[88:89], v[88:89], s[34:35], v[4:5] op_sel_hi:[1,0,0] neg_lo:[0,0,1] neg_hi:[0,0,1]
v_exp_f32 v80, v80
v_exp_f32 v81, v81
v_exp_f32 v82, v82
v_cvt_pk_bf16_f32 v68, v80, v81
v_exp_f32 v83, v83
v_exp_f32 v84, v84
v_cvt_pk_bf16_f32 v69, v82, v83
v_exp_f32 v85, v85
v_exp_f32 v86, v86
v_cvt_pk_bf16_f32 v70, v84, v85
v_exp_f32 v87, v87
v_exp_f32 v88, v88
v_cvt_pk_bf16_f32 v71, v86, v87
v_exp_f32 v89, v89
s_waitcnt vmcnt(3)
v_mfma_f32_16x16x32_bf16 v[76:79], v[28:31], v[68:71], 0
v_and_b32 v3, 1, v116
v_cvt_pk_bf16_f32 v72, v88, v89
v_mfma_f32_16x16x32_bf16 v[100:103], v[120:123], v[68:71], 0
v_cmp_ne_u32 vcc, s41, v3
v_cvt_pk_bf16_f32 v73, v88, v89
v_mfma_f32_16x16x32_bf16 v[104:107], v[124:127], v[68:71], 0
v_mov_b32 v113, v116
v_mov_b32 v115, v117
v_mfma_f32_16x16x16_bf16 v[76:79], v[92:93], v[72:73], v[76:79]
s_cbranch_vccnz L_rs_w3_pv0
L_rs_w3_pv2:
v_mfma_f32_16x16x16_bf16 v[100:103], v[112:113], v[72:73], v[100:103]
v_mfma_f32_16x16x16_bf16 v[104:107], v[114:115], v[72:73], v[104:107]
buffer_load_dwordx4 v[120:123], v1, s[4:7], s44 offen sc1
buffer_load_dwordx4 v[124:127], v1, s[4:7], s44 offen offset:1024 sc1
s_nop 2
v_rcp_f32 v76, v76
s_mov_b64 exec, s[28:29]
v_pk_mul_f32 v[100:101], v[100:101], v[76:77] op_sel_hi:[1,0]
v_pk_mul_f32 v[102:103], v[102:103], v[76:77] op_sel_hi:[1,0]
v_pk_mul_f32 v[104:105], v[104:105], v[76:77] op_sel_hi:[1,0]
v_pk_mul_f32 v[106:107], v[106:107], v[76:77] op_sel_hi:[1,0]
v_cvt_pk_bf16_f32 v84, v100, v101
v_cvt_pk_bf16_f32 v85, v102, v103
v_cvt_pk_bf16_f32 v86, v104, v105
v_cvt_pk_bf16_f32 v87, v106, v107
ds_write_b128 v6, v[84:87] offset:29696
s_mov_b64 exec, -1
s_waitcnt lgkmcnt(0)
s_barrier
ds_read_b128 v[68:71], v6 offset:28672
ds_read_b128 v[72:75], v6 offset:29696
s_waitcnt lgkmcnt(1)
v_smfmac_f32_16x16x64_bf16 v[32:35], v[68:71], v[128:135], v2
s_add_u32 s21, s21, 1
s_xor_b32 s38, s38, 1048576
s_xor_b32 s37, s37, 1048576
s_waitcnt lgkmcnt(0)
v_smfmac_f32_16x16x64_bf16 v[32:35], v[72:75], v[136:143], v2
s_xor_b32 s40, s40, 1048576
s_xor_b32 s39, s39, 1048576
s_lshr_b32 s41, s21, 1
v_smfmac_f32_16x16x64_bf16 v[36:39], v[68:71], v[144:151], v2
s_and_b32 s41, s41, 1
s_xor_b32 s41, s41, 1
s_xor_b32 s35, s35, 16384
v_smfmac_f32_16x16x64_bf16 v[36:39], v[72:75], v[152:159], v2
v_add_f32 v32, v32, v34
s_xor_b32 s36, s36, 16384
s_add_u32 s43, s43, 262144
s_add_u32 s44, s44, 262144
v_smfmac_f32_16x16x64_bf16 v[40:43], v[68:71], v[160:167], v2
v_add_f32 v33, v33, v35
v_smfmac_f32_16x16x64_bf16 v[40:43], v[72:75], v[168:175], v2
v_cvt_pk_bf16_f32 v32, v32, v33
v_smfmac_f32_16x16x64_bf16 v[44:47], v[68:71], v[176:183], v2
v_and_or_b32 v32, v32, -2, s42
v_smfmac_f32_16x16x64_bf16 v[44:47], v[72:75], v[184:191], v2
v_add_f32 v36, v36, v38
v_smfmac_f32_16x16x64_bf16 v[48:51], v[68:71], v[192:199], v2
v_add_f32 v37, v37, v39
v_smfmac_f32_16x16x64_bf16 v[48:51], v[72:75], v[200:207], v2
v_cvt_pk_bf16_f32 v33, v36, v37
v_smfmac_f32_16x16x64_bf16 v[52:55], v[68:71], v[208:215], v2
v_add_f32 v40, v40, v42
v_smfmac_f32_16x16x64_bf16 v[52:55], v[72:75], v[216:223], v2
v_add_f32 v41, v41, v43
v_smfmac_f32_16x16x64_bf16 v[56:59], v[68:71], v[224:231], v2
v_cvt_pk_bf16_f32 v34, v40, v41
v_smfmac_f32_16x16x64_bf16 v[56:59], v[72:75], v[232:239], v2
v_add_f32 v44, v44, v46
v_smfmac_f32_16x16x64_bf16 v[60:63], v[68:71], v[240:247], v2
v_add_f32 v45, v45, v47
v_smfmac_f32_16x16x64_bf16 v[60:63], v[72:75], v[248:255], v2
v_cvt_pk_bf16_f32 v35, v44, v45
buffer_store_dwordx4 v[32:35], v8, s[4:7], s46 offen sc1
v_pk_add_f32 v[48:49], v[48:49], v[50:51]
v_cvt_pk_bf16_f32 v48, v48, v49
v_and_or_b32 v48, v48, -2, s42
v_pk_add_f32 v[52:53], v[52:53], v[54:55]
v_cvt_pk_bf16_f32 v49, v52, v53
v_pk_add_f32 v[56:57], v[56:57], v[58:59]
v_cvt_pk_bf16_f32 v50, v56, v57
v_pk_add_f32 v[60:61], v[60:61], v[62:63]
v_cvt_pk_bf16_f32 v51, v60, v61
buffer_store_dwordx4 v[48:51], v8, s[4:7], s61 offen sc1
s_add_u32 s45, s45, 262144
s_add_u32 s51, s51, 262144
v_mfma_f32_32x32x8_bf16 v[96:111], v[14:15], v[14:15], 0
v_mfma_f32_16x16x16_bf16 v[112:115], v[14:15], v[14:15], 0
v_mfma_f32_16x16x16_bf16 v[116:119], v[14:15], v[14:15], 0
ds_read_b128 v[64:67], v1 offset:12288
ds_read_b128 v[68:71], v1 offset:13312
ds_read_b128 v[72:75], v1 offset:14336
ds_read_b128 v[76:79], v1 offset:15360
ds_read_b128 v[80:83], v1 offset:28672
ds_read_b128 v[84:87], v1 offset:29696
ds_read_b128 v[88:91], v1 offset:30720
ds_read_b128 v[92:95], v1 offset:31744
s_add_u32 s22, s21, 2
s_cmp_gt_u32 s50, s22
s_cbranch_scc1 L_rs_w3_kvs
v_readlane_b32 s50, v12, 0
v_readlane_b32 s22, v12, 2
v_readlane_b32 s23, v12, 1
v_readlane_b32 s24, v12, 3
s_nop 3
s_min_u32 s50, s50, s22
s_min_u32 s23, s23, s24
s_lshl_b32 s50, s50, 1
s_lshl_b32 s23, s23, 1
s_add_u32 s23, s23, 1
s_min_u32 s50, s50, s23
L_rs_kvb1:
s_add_u32 s22, s21, 1
s_min_u32 s22, s22, 63
s_cmp_gt_u32 s50, s22
s_cbranch_scc1 L_rs_kvd1
buffer_load_dword v12, v7, s[4:7], 0 offen sc1
s_waitcnt vmcnt(0)
v_readlane_b32 s50, v12, 0
v_readlane_b32 s22, v12, 2
v_readlane_b32 s23, v12, 1
v_readlane_b32 s24, v12, 3
s_nop 3
s_min_u32 s50, s50, s22
s_min_u32 s23, s23, s24
s_lshl_b32 s50, s50, 1
s_lshl_b32 s23, s23, 1
s_add_u32 s23, s23, 1
s_min_u32 s50, s50, s23
s_branch L_rs_kvb1
L_rs_kvd1:
L_rs_w3_kvs:
v_mov_b32 v58, -1
v_mov_b32 v59, -1
s_waitcnt vmcnt(0)
L_rs_w3_cgo:
L_rs_w3_pc:
buffer_load_dword v36, v13, s[4:7], s25 offen sc1
buffer_load_dword v37, v13, s[4:7], s25 offen offset:256 sc1
buffer_load_dword v38, v13, s[4:7], s25 offen offset:512 sc1
buffer_load_dword v39, v13, s[4:7], s25 offen offset:768 sc1
buffer_load_dword v40, v13, s[4:7], s25 offen offset:1024 sc1
buffer_load_dword v41, v13, s[4:7], s25 offen offset:1280 sc1
buffer_load_dword v42, v13, s[4:7], s25 offen offset:1536 sc1
buffer_load_dword v43, v13, s[4:7], s25 offen offset:1792 sc1
s_waitcnt vmcnt(4)
v_mfma_f32_16x16x32_bf16 v[52:55], v[36:39], v[24:27], 0
v_bitop3_b32 v3, s42, v36, v37 bitop3:0x7e
v_bitop3_b32 v4, s42, v38, v39 bitop3:0x7e
s_waitcnt vmcnt(2)
v_or_b32 v3, v3, v4
v_bitop3_b32 v4, s42, v40, v41 bitop3:0x7e
s_waitcnt vmcnt(0)
v_mfma_f32_16x16x32_bf16 v[52:55], v[40:43], v[24:27], v[52:55]
v_bitop3_b32 v56, s42, v42, v43 bitop3:0x7e
v_or3_b32 v3, v3, v4, v56
v_and_b32 v3, v0, v3
v_cmp_ne_u32 vcc, 0, v3
s_nop 3
v_cvt_pk_bf16_f32 v56, v52, v53
v_cvt_pk_bf16_f32 v57, v54, v55
v_min_u32 v56, -2, v56
s_cbranch_vccnz L_rs_w3_pc
s_mov_b64 exec, s[26:27]
buffer_store_dwordx2 v[56:57], v9, s[4:7], s35 offen offset:768 sc1
buffer_store_dwordx2 v[58:59], v9, s[4:7], s36 offen offset:768 sc1
s_mov_b64 exec, -1
s_xor_b32 s42, s42, 1
s_branch L_rs_w3_loop
L_rs_w3_last:
buffer_store_dwordx4 v[64:67], v10, s[4:7], s45 offen offset:192 sc1
buffer_store_dwordx2 v[18:19], v11, s[4:7], s51 offen offset:3584 sc1
s_branch L_rs_end
L_rs_w3_pafail:
s_nop 7
v_mov_b32 v96, 0
v_mov_b32 v97, 0
v_mov_b32 v98, 0
v_mov_b32 v99, 0
v_mov_b32 v100, 0
v_mov_b32 v101, 0
v_mov_b32 v102, 0
v_mov_b32 v103, 0
v_mov_b32 v104, 0
v_mov_b32 v105, 0
v_mov_b32 v106, 0
v_mov_b32 v107, 0
s_branch L_rs_w3_pa
L_rs_w3_xslow:
buffer_load_dwordx2 v[108:109], v11, s[4:7], s38 offen sc1
buffer_load_dwordx2 v[110:111], v11, s[4:7], s38 offen offset:512 sc1
s_waitcnt vmcnt(2)
v_bitop3_b32 v3, s41, v20, v22 bitop3:0x7e
v_mfma_f32_16x16x16_bf16 v[80:83], v[20:21], v[16:17], v[100:103]
v_and_b32 v3, 1, v3
v_mfma_f32_16x16x16_bf16 v[84:87], v[22:23], v[16:17], v[104:107]
v_cmp_ne_u32 vcc, 0, v3
s_cbranch_vccz L_rs_w3_xgot
buffer_load_dwordx2 v[20:21], v11, s[4:7], s38 offen sc1
buffer_load_dwordx2 v[22:23], v11, s[4:7], s38 offen offset:512 sc1
s_waitcnt vmcnt(2)
v_bitop3_b32 v3, s41, v108, v110 bitop3:0x7e
v_mfma_f32_16x16x16_bf16 v[80:83], v[108:109], v[16:17], v[100:103]
v_and_b32 v3, 1, v3
v_mfma_f32_16x16x16_bf16 v[84:87], v[110:111], v[16:17], v[104:107]
v_cmp_ne_u32 vcc, 0, v3
s_cbranch_vccz L_rs_w3_xgot
s_branch L_rs_w3_xslow
L_rs_w3_xgot:
s_nop 3
v_cvt_pk_bf16_f32 v64, v80, v81
v_cvt_pk_bf16_f32 v65, v82, v83
v_cvt_pk_bf16_f32 v66, v84, v85
v_cvt_pk_bf16_f32 v67, v86, v87
ds_write_b128 v6, v[64:67] offset:23552
s_branch L_rs_w3_xok
L_rs_w3_pv0:
s_waitcnt vmcnt(2)
s_branch L_rs_w3_pv1
L_rs_w3_pv:
buffer_load_dwordx2 v[20:21], v11, s[4:7], s40 offen sc1
s_waitcnt vmcnt(0)
L_rs_w3_pv1:
v_and_b32 v3, 1, v20
v_cmp_ne_u32 vcc, s41, v3
v_mov_b32 v113, v20
v_mov_b32 v115, v21
s_cbranch_vccnz L_rs_w3_pv
s_branch L_rs_w3_pv2
L_rs_end:
s_mov_b64 exec, -1
v_mov_b32 v3, 64
s_waitcnt vmcnt(0)
s_barrier
s_cmp_lg_u32 s20, 0
s_cbranch_scc1 L_rs_end2
buffer_store_dword v3, v7, s[4:7], 0 offen sc1
L_rs_end2:
s_waitcnt vmcnt(0)
s_endpgm
L_bulk:
s_cmp_lt_u32 s92, 64
s_cbranch_scc1 L_fft
s_mov_b32 s29, 0
L_q_again:
s_load_dwordx2 s[8:9], s[0:1], 0
s_load_dwordx2 s[40:41], s[0:1], 16
s_load_dwordx2 s[42:43], s[0:1], 24
s_load_dwordx2 s[44:45], s[0:1], 32
v_lshrrev_b32 v2, 6, v0
v_and_b32 v1, 63, v0
v_readfirstlane_b32 s16, v2
s_lshr_b32 s17, s92, 6
s_lshr_b32 s20, s29, 5
s_sub_u32 s17, s17, s20
s_bfe_u32 s18, s92, 0x50001
s_and_b32 s19, s92, 1
s_waitcnt lgkmcnt(0)
s_mov_b32 s10, 4194304
s_mov_b32 s11, 0x00020000
s_cmp_eq_u32 s17, 1
s_cselect_b32 s12, s42, s40
s_cselect_b32 s13, s43, s41
s_cmp_eq_u32 s17, 2
s_cselect_b32 s12, s44, s12
s_cselect_b32 s13, s45, s13
s_mov_b32 s14, 8388608
s_mov_b32 s15, 0x00020000
v_lshrrev_b32 v2, 4, v1
v_and_b32 v3, 15, v1
v_lshlrev_b32 v4, 2, v2
v_xor_b32 v4, v4, v3
v_lshlrev_b32 v4, 4, v4
s_lshl_b32 s20, s16, 5
v_add_u32 v11, s20, v2
v_lshl_add_u32 v11, v11, 13, v4
s_lshl_b32 s20, s18, 8
v_add_u32 v11, s20, v11
s_lshl_b32 s22, s16, 13
s_lshl_b32 s27, s19, 23
s_and_b32 s27, s27, 4194304
s_add_u32 m0, s22, 0
s_xor_b32 s20, s27, 0
buffer_load_dwordx4 v11, s[12:15], s20 offen lds
s_add_u32 m0, s22, 1024
s_xor_b32 s20, s27, 32768
buffer_load_dwordx4 v11, s[12:15], s20 offen lds
s_add_u32 m0, s22, 2048
s_xor_b32 s20, s27, 65536
buffer_load_dwordx4 v11, s[12:15], s20 offen lds
s_add_u32 m0, s22, 3072
s_xor_b32 s20, s27, 98304
buffer_load_dwordx4 v11, s[12:15], s20 offen lds
s_add_u32 m0, s22, 4096
s_xor_b32 s20, s27, 131072
buffer_load_dwordx4 v11, s[12:15], s20 offen lds
s_add_u32 m0, s22, 5120
s_xor_b32 s20, s27, 163840
buffer_load_dwordx4 v11, s[12:15], s20 offen lds
s_add_u32 m0, s22, 6144
s_xor_b32 s20, s27, 196608
buffer_load_dwordx4 v11, s[12:15], s20 offen lds
s_add_u32 m0, s22, 7168
s_xor_b32 s20, s27, 229376
buffer_load_dwordx4 v11, s[12:15], s20 offen lds
s_waitcnt vmcnt(8)
s_barrier
s_or_b32 s81, s97, s98
s_cmp_lg_u32 s81, 0
s_cbranch_scc1 L_h0_3
s_lshl_b32 s81, s93, 5
v_mov_b32 v38, 1
s_mov_b64 exec, 1
buffer_atomic_add v38, off, s[88:91], s81 sc1
s_mov_b64 exec, -1
L_h0_3:
s_add_u32 m0, s22, 32768
s_xor_b32 s20, s27, 1048576
buffer_load_dwordx4 v11, s[12:15], s20 offen lds
s_add_u32 m0, s22, 33792
s_xor_b32 s20, s27, 1081344
buffer_load_dwordx4 v11, s[12:15], s20 offen lds
s_add_u32 m0, s22, 34816
s_xor_b32 s20, s27, 1114112
buffer_load_dwordx4 v11, s[12:15], s20 offen lds
s_add_u32 m0, s22, 35840
s_xor_b32 s20, s27, 1146880
buffer_load_dwordx4 v11, s[12:15], s20 offen lds
s_add_u32 m0, s22, 36864
s_xor_b32 s20, s27, 1179648
buffer_load_dwordx4 v11, s[12:15], s20 offen lds
s_add_u32 m0, s22, 37888
s_xor_b32 s20, s27, 1212416
buffer_load_dwordx4 v11, s[12:15], s20 offen lds
s_add_u32 m0, s22, 38912
s_xor_b32 s20, s27, 1245184
buffer_load_dwordx4 v11, s[12:15], s20 offen lds
s_add_u32 m0, s22, 39936
s_xor_b32 s20, s27, 1277952
buffer_load_dwordx4 v11, s[12:15], s20 offen lds
s_add_u32 m0, s22, 65536
s_xor_b32 s20, s27, 2097152
buffer_load_dwordx4 v11, s[12:15], s20 offen lds
s_add_u32 m0, s22, 66560
s_xor_b32 s20, s27, 2129920
buffer_load_dwordx4 v11, s[12:15], s20 offen lds
s_add_u32 m0, s22, 67584
s_xor_b32 s20, s27, 2162688
buffer_load_dwordx4 v11, s[12:15], s20 offen lds
s_add_u32 m0, s22, 68608
s_xor_b32 s20, s27, 2195456
buffer_load_dwordx4 v11, s[12:15], s20 offen lds
s_add_u32 m0, s22, 69632
s_xor_b32 s20, s27, 2228224
buffer_load_dwordx4 v11, s[12:15], s20 offen lds
s_add_u32 m0, s22, 70656
s_xor_b32 s20, s27, 2260992
buffer_load_dwordx4 v11, s[12:15], s20 offen lds
s_add_u32 m0, s22, 71680
s_xor_b32 s20, s27, 2293760
buffer_load_dwordx4 v11, s[12:15], s20 offen lds
s_add_u32 m0, s22, 72704
s_xor_b32 s20, s27, 2326528
buffer_load_dwordx4 v11, s[12:15], s20 offen lds
s_add_u32 m0, s22, 98304
s_xor_b32 s20, s27, 3145728
buffer_load_dwordx4 v11, s[12:15], s20 offen lds
s_add_u32 m0, s22, 99328
s_xor_b32 s20, s27, 3178496
buffer_load_dwordx4 v11, s[12:15], s20 offen lds
s_add_u32 m0, s22, 100352
s_xor_b32 s20, s27, 3211264
buffer_load_dwordx4 v11, s[12:15], s20 offen lds
s_add_u32 m0, s22, 101376
s_xor_b32 s20, s27, 3244032
buffer_load_dwordx4 v11, s[12:15], s20 offen lds
s_add_u32 m0, s22, 102400
s_xor_b32 s20, s27, 3276800
buffer_load_dwordx4 v11, s[12:15], s20 offen lds
s_add_u32 m0, s22, 103424
s_xor_b32 s20, s27, 3309568
buffer_load_dwordx4 v11, s[12:15], s20 offen lds
s_add_u32 m0, s22, 104448
s_xor_b32 s20, s27, 3342336
buffer_load_dwordx4 v11, s[12:15], s20 offen lds
s_add_u32 m0, s22, 105472
s_xor_b32 s20, s27, 3375104
buffer_load_dwordx4 v11, s[12:15], s20 offen lds
v_and_b32 v3, 3, v1
v_bfe_u32 v14, v1, 2, 2
v_xor_b32 v15, s16, v14
v_lshlrev_b32 v15, 6, v15
v_lshl_add_u32 v15, v3, 4, v15
v_lshl_add_u32 v13, v2, 3, v14
v_lshl_add_u32 v12, v13, 8, v15
v_and_b32 v3, 15, v1
s_lshl_b32 s20, s16, 3
v_add_u32 v13, s20, v2
v_add_u32 v13, 0, v13
v_and_b32 v14, 15, v13
v_xor_b32 v14, v14, v3
v_lshlrev_b32 v14, 4, v14
v_lshl_add_u32 v6, v13, 11, v14
v_add_u32 v13, s20, v2
v_add_u32 v13, 4, v13
v_and_b32 v14, 15, v13
v_xor_b32 v14, v14, v3
v_lshlrev_b32 v14, 4, v14
v_lshl_add_u32 v7, v13, 11, v14
v_xor_b32 v14, v2, v3
v_lshlrev_b32 v14, 4, v14
v_lshl_add_u32 v13, v3, 8, v14
v_xor_b32 v16, 0, v13
v_add_u32 v20, 0x10000, v16
v_xor_b32 v17, 64, v13
v_add_u32 v21, 0x10000, v17
v_xor_b32 v18, 128, v13
v_add_u32 v22, 0x10000, v18
v_xor_b32 v19, 192, v13
v_add_u32 v23, 0x10000, v19
v_lshlrev_b32 v8, 4, v1
v_bfrev_b32 v13, 1
s_lshl_b32 s20, s92, 7
s_add_u32 s20, s20, 71303168
v_mov_b32 v14, s20
v_cmp_eq_u32 vcc, 0, v0
s_lshl_b32 s24, s17, 24
s_lshl_b32 s20, s19, 18
v_cndmask_b32 v9, v13, v14, vcc
s_add_u32 s24, s24, s20
s_lshl_b32 s20, s18, 13
s_add_u32 s24, s24, s20
s_lshl_b32 s20, s16, 11
s_add_u32 s24, s24, s20
s_add_u32 s24, s24, 0
s_lshl_b32 s23, s19, 16
s_lshr_b32 s20, s27, 12
s_add_u32 s23, s23, s20
v_mov_b32 v10, s29
s_lshl_b32 s21, s16, 11
s_waitcnt vmcnt(24)
s_barrier
v_add_u32 v13, 0, v12
ds_read_b64_tr_b16 a[0:1], v13
ds_read_b64_tr_b16 a[2:3], v13 offset:1024
ds_read_b64_tr_b16 a[4:5], v13 offset:8
ds_read_b64_tr_b16 a[6:7], v13 offset:1032
ds_read_b64_tr_b16 a[8:9], v13 offset:8192
ds_read_b64_tr_b16 a[10:11], v13 offset:9216
ds_read_b64_tr_b16 a[12:13], v13 offset:8200
ds_read_b64_tr_b16 a[14:15], v13 offset:9224
s_waitcnt lgkmcnt(0)
ds_read_b64_tr_b16 a[16:17], v13 offset:16384
ds_read_b64_tr_b16 a[18:19], v13 offset:17408
ds_read_b64_tr_b16 a[20:21], v13 offset:16392
ds_read_b64_tr_b16 a[22:23], v13 offset:17416
ds_read_b64_tr_b16 a[24:25], v13 offset:24576
ds_read_b64_tr_b16 a[26:27], v13 offset:25600
ds_read_b64_tr_b16 a[28:29], v13 offset:24584
ds_read_b64_tr_b16 a[30:31], v13 offset:25608
s_waitcnt lgkmcnt(0)
s_barrier
s_add_u32 m0, s22, 0
s_xor_b32 s20, s27, 4194304
buffer_load_dwordx4 v11, s[12:15], s20 offen lds
s_add_u32 m0, s22, 1024
s_xor_b32 s20, s27, 4227072
buffer_load_dwordx4 v11, s[12:15], s20 offen lds
s_add_u32 m0, s22, 2048
s_xor_b32 s20, s27, 4259840
buffer_load_dwordx4 v11, s[12:15], s20 offen lds
s_add_u32 m0, s22, 3072
s_xor_b32 s20, s27, 4292608
buffer_load_dwordx4 v11, s[12:15], s20 offen lds
s_add_u32 m0, s22, 4096
s_xor_b32 s20, s27, 4325376
buffer_load_dwordx4 v11, s[12:15], s20 offen lds
s_add_u32 m0, s22, 5120
s_xor_b32 s20, s27, 4358144
buffer_load_dwordx4 v11, s[12:15], s20 offen lds
s_add_u32 m0, s22, 6144
s_xor_b32 s20, s27, 4390912
buffer_load_dwordx4 v11, s[12:15], s20 offen lds
s_add_u32 m0, s22, 7168
s_xor_b32 s20, s27, 4423680
buffer_load_dwordx4 v11, s[12:15], s20 offen lds
s_waitcnt vmcnt(24)
s_barrier
v_add_u32 v13, 32768, v12
ds_read_b64_tr_b16 a[32:33], v13
ds_read_b64_tr_b16 a[34:35], v13 offset:1024
ds_read_b64_tr_b16 a[36:37], v13 offset:8
ds_read_b64_tr_b16 a[38:39], v13 offset:1032
ds_read_b64_tr_b16 a[40:41], v13 offset:8192
ds_read_b64_tr_b16 a[42:43], v13 offset:9216
ds_read_b64_tr_b16 a[44:45], v13 offset:8200
ds_read_b64_tr_b16 a[46:47], v13 offset:9224
s_waitcnt lgkmcnt(0)
ds_read_b64_tr_b16 a[48:49], v13 offset:16384
ds_read_b64_tr_b16 a[50:51], v13 offset:17408
ds_read_b64_tr_b16 a[52:53], v13 offset:16392
ds_read_b64_tr_b16 a[54:55], v13 offset:17416
ds_read_b64_tr_b16 a[56:57], v13 offset:24576
ds_read_b64_tr_b16 a[58:59], v13 offset:25600
ds_read_b64_tr_b16 a[60:61], v13 offset:24584
ds_read_b64_tr_b16 a[62:63], v13 offset:25608
s_waitcnt lgkmcnt(0)
s_barrier
s_add_u32 m0, s22, 32768
s_xor_b32 s20, s27, 5242880
buffer_load_dwordx4 v11, s[12:15], s20 offen lds
s_add_u32 m0, s22, 33792
s_xor_b32 s20, s27, 5275648
buffer_load_dwordx4 v11, s[12:15], s20 offen lds
s_add_u32 m0, s22, 34816
s_xor_b32 s20, s27, 5308416
buffer_load_dwordx4 v11, s[12:15], s20 offen lds
s_add_u32 m0, s22, 35840
s_xor_b32 s20, s27, 5341184
buffer_load_dwordx4 v11, s[12:15], s20 offen lds
s_add_u32 m0, s22, 36864
s_xor_b32 s20, s27, 5373952
buffer_load_dwordx4 v11, s[12:15], s20 offen lds
s_add_u32 m0, s22, 37888
s_xor_b32 s20, s27, 5406720
buffer_load_dwordx4 v11, s[12:15], s20 offen lds
s_add_u32 m0, s22, 38912
s_xor_b32 s20, s27, 5439488
buffer_load_dwordx4 v11, s[12:15], s20 offen lds
s_add_u32 m0, s22, 39936
s_xor_b32 s20, s27, 5472256
buffer_load_dwordx4 v11, s[12:15], s20 offen lds
s_waitcnt vmcnt(24)
s_barrier
v_add_u32 v13, 65536, v12
ds_read_b64_tr_b16 a[64:65], v13
ds_read_b64_tr_b16 a[66:67], v13 offset:1024
ds_read_b64_tr_b16 a[68:69], v13 offset:8
ds_read_b64_tr_b16 a[70:71], v13 offset:1032
ds_read_b64_tr_b16 a[72:73], v13 offset:8192
ds_read_b64_tr_b16 a[74:75], v13 offset:9216
ds_read_b64_tr_b16 a[76:77], v13 offset:8200
ds_read_b64_tr_b16 a[78:79], v13 offset:9224
s_waitcnt lgkmcnt(0)
ds_read_b64_tr_b16 a[80:81], v13 offset:16384
ds_read_b64_tr_b16 a[82:83], v13 offset:17408
ds_read_b64_tr_b16 a[84:85], v13 offset:16392
ds_read_b64_tr_b16 a[86:87], v13 offset:17416
ds_read_b64_tr_b16 a[88:89], v13 offset:24576
ds_read_b64_tr_b16 a[90:91], v13 offset:25600
ds_read_b64_tr_b16 a[92:93], v13 offset:24584
ds_read_b64_tr_b16 a[94:95], v13 offset:25608
s_waitcnt lgkmcnt(0)
s_barrier
s_add_u32 m0, s22, 65536
s_xor_b32 s20, s27, 6291456
buffer_load_dwordx4 v11, s[12:15], s20 offen lds
s_add_u32 m0, s22, 66560
s_xor_b32 s20, s27, 6324224
buffer_load_dwordx4 v11, s[12:15], s20 offen lds
s_add_u32 m0, s22, 67584
s_xor_b32 s20, s27, 6356992
buffer_load_dwordx4 v11, s[12:15], s20 offen lds
s_add_u32 m0, s22, 68608
s_xor_b32 s20, s27, 6389760
buffer_load_dwordx4 v11, s[12:15], s20 offen lds
s_add_u32 m0, s22, 69632
s_xor_b32 s20, s27, 6422528
buffer_load_dwordx4 v11, s[12:15], s20 offen lds
s_add_u32 m0, s22, 70656
s_xor_b32 s20, s27, 6455296
buffer_load_dwordx4 v11, s[12:15], s20 offen lds
s_add_u32 m0, s22, 71680
s_xor_b32 s20, s27, 6488064
buffer_load_dwordx4 v11, s[12:15], s20 offen lds
s_add_u32 m0, s22, 72704
s_xor_b32 s20, s27, 6520832
buffer_load_dwordx4 v11, s[12:15], s20 offen lds
s_waitcnt vmcnt(24)
s_barrier
v_and_b32 v37, 7, v0
v_lshlrev_b32 v37, 5, v37
buffer_load_dword v36, v37, s[88:91], 0 offen sc1
v_add_u32 v13, 98304, v12
ds_read_b64_tr_b16 a[96:97], v13
ds_read_b64_tr_b16 a[98:99], v13 offset:1024
ds_read_b64_tr_b16 a[100:101], v13 offset:8
ds_read_b64_tr_b16 a[102:103], v13 offset:1032
ds_read_b64_tr_b16 a[104:105], v13 offset:8192
ds_read_b64_tr_b16 a[106:107], v13 offset:9216
ds_read_b64_tr_b16 a[108:109], v13 offset:8200
ds_read_b64_tr_b16 a[110:111], v13 offset:9224
s_waitcnt lgkmcnt(0)
ds_read_b64_tr_b16 a[112:113], v13 offset:16384
ds_read_b64_tr_b16 a[114:115], v13 offset:17408
ds_read_b64_tr_b16 a[116:117], v13 offset:16392
ds_read_b64_tr_b16 a[118:119], v13 offset:17416
ds_read_b64_tr_b16 a[120:121], v13 offset:24576
ds_read_b64_tr_b16 a[122:123], v13 offset:25600
ds_read_b64_tr_b16 a[124:125], v13 offset:24584
ds_read_b64_tr_b16 a[126:127], v13 offset:25608
s_waitcnt lgkmcnt(0)
s_barrier
s_add_u32 m0, s22, 98304
s_xor_b32 s20, s27, 7340032
buffer_load_dwordx4 v11, s[12:15], s20 offen lds
s_add_u32 m0, s22, 99328
s_xor_b32 s20, s27, 7372800
buffer_load_dwordx4 v11, s[12:15], s20 offen lds
s_add_u32 m0, s22, 100352
s_xor_b32 s20, s27, 7405568
buffer_load_dwordx4 v11, s[12:15], s20 offen lds
s_add_u32 m0, s22, 101376
s_xor_b32 s20, s27, 7438336
buffer_load_dwordx4 v11, s[12:15], s20 offen lds
s_add_u32 m0, s22, 102400
s_xor_b32 s20, s27, 7471104
buffer_load_dwordx4 v11, s[12:15], s20 offen lds
s_add_u32 m0, s22, 103424
s_xor_b32 s20, s27, 7503872
buffer_load_dwordx4 v11, s[12:15], s20 offen lds
s_add_u32 m0, s22, 104448
s_xor_b32 s20, s27, 7536640
buffer_load_dwordx4 v11, s[12:15], s20 offen lds
s_add_u32 m0, s22, 105472
s_xor_b32 s20, s27, 7569408
buffer_load_dwordx4 v11, s[12:15], s20 offen lds
s_waitcnt vmcnt(24)
s_barrier
v_add_u32 v13, 0, v12
ds_read_b64_tr_b16 a[128:129], v13
ds_read_b64_tr_b16 a[130:131], v13 offset:1024
ds_read_b64_tr_b16 a[132:133], v13 offset:8
ds_read_b64_tr_b16 a[134:135], v13 offset:1032
ds_read_b64_tr_b16 a[136:137], v13 offset:8192
ds_read_b64_tr_b16 a[138:139], v13 offset:9216
ds_read_b64_tr_b16 a[140:141], v13 offset:8200
ds_read_b64_tr_b16 a[142:143], v13 offset:9224
s_waitcnt lgkmcnt(0)
ds_read_b64_tr_b16 a[144:145], v13 offset:16384
ds_read_b64_tr_b16 a[146:147], v13 offset:17408
ds_read_b64_tr_b16 a[148:149], v13 offset:16392
ds_read_b64_tr_b16 a[150:151], v13 offset:17416
ds_read_b64_tr_b16 a[152:153], v13 offset:24576
ds_read_b64_tr_b16 a[154:155], v13 offset:25600
ds_read_b64_tr_b16 a[156:157], v13 offset:24584
ds_read_b64_tr_b16 a[158:159], v13 offset:25608
s_waitcnt lgkmcnt(0)
s_barrier
s_add_u32 m0, s21, 0
s_xor_b32 s20, s23, 0
buffer_load_dwordx4 v6, s[8:11], s20 offen lds
s_add_u32 m0, s21, 1024
s_xor_b32 s20, s23, 0
buffer_load_dwordx4 v7, s[8:11], s20 offen lds
s_add_u32 m0, s21, 8192
s_xor_b32 s20, s23, 256
buffer_load_dwordx4 v6, s[8:11], s20 offen lds
s_add_u32 m0, s21, 9216
s_xor_b32 s20, s23, 256
buffer_load_dwordx4 v7, s[8:11], s20 offen lds
s_add_u32 m0, s21, 16384
s_xor_b32 s20, s23, 512
buffer_load_dwordx4 v6, s[8:11], s20 offen lds
s_add_u32 m0, s21, 17408
s_xor_b32 s20, s23, 512
buffer_load_dwordx4 v7, s[8:11], s20 offen lds
s_add_u32 m0, s21, 24576
s_xor_b32 s20, s23, 768
buffer_load_dwordx4 v6, s[8:11], s20 offen lds
s_add_u32 m0, s21, 25600
s_xor_b32 s20, s23, 768
buffer_load_dwordx4 v7, s[8:11], s20 offen lds
s_waitcnt vmcnt(24)
s_barrier
v_add_u32 v13, 32768, v12
ds_read_b64_tr_b16 a[160:161], v13
ds_read_b64_tr_b16 a[162:163], v13 offset:1024
ds_read_b64_tr_b16 a[164:165], v13 offset:8
ds_read_b64_tr_b16 a[166:167], v13 offset:1032
ds_read_b64_tr_b16 a[168:169], v13 offset:8192
ds_read_b64_tr_b16 a[170:171], v13 offset:9216
ds_read_b64_tr_b16 a[172:173], v13 offset:8200
ds_read_b64_tr_b16 a[174:175], v13 offset:9224
s_waitcnt lgkmcnt(0)
ds_read_b64_tr_b16 a[176:177], v13 offset:16384
ds_read_b64_tr_b16 a[178:179], v13 offset:17408
ds_read_b64_tr_b16 a[180:181], v13 offset:16392
ds_read_b64_tr_b16 a[182:183], v13 offset:17416
ds_read_b64_tr_b16 a[184:185], v13 offset:24576
ds_read_b64_tr_b16 a[186:187], v13 offset:25600
ds_read_b64_tr_b16 a[188:189], v13 offset:24584
ds_read_b64_tr_b16 a[190:191], v13 offset:25608
s_waitcnt lgkmcnt(0)
s_barrier
s_add_u32 m0, s21, 32768
s_xor_b32 s20, s23, 1024
buffer_load_dwordx4 v6, s[8:11], s20 offen lds
s_add_u32 m0, s21, 33792
s_xor_b32 s20, s23, 1024
buffer_load_dwordx4 v7, s[8:11], s20 offen lds
s_add_u32 m0, s21, 40960
s_xor_b32 s20, s23, 1280
buffer_load_dwordx4 v6, s[8:11], s20 offen lds
s_add_u32 m0, s21, 41984
s_xor_b32 s20, s23, 1280
buffer_load_dwordx4 v7, s[8:11], s20 offen lds
s_add_u32 m0, s21, 49152
s_xor_b32 s20, s23, 1536
buffer_load_dwordx4 v6, s[8:11], s20 offen lds
s_add_u32 m0, s21, 50176
s_xor_b32 s20, s23, 1536
buffer_load_dwordx4 v7, s[8:11], s20 offen lds
s_add_u32 m0, s21, 57344
s_xor_b32 s20, s23, 1792
buffer_load_dwordx4 v6, s[8:11], s20 offen lds
s_add_u32 m0, s21, 58368
s_xor_b32 s20, s23, 1792
buffer_load_dwordx4 v7, s[8:11], s20 offen lds
s_waitcnt vmcnt(24)
s_barrier
v_add_u32 v13, 65536, v12
ds_read_b64_tr_b16 a[192:193], v13
ds_read_b64_tr_b16 a[194:195], v13 offset:1024
ds_read_b64_tr_b16 a[196:197], v13 offset:8
ds_read_b64_tr_b16 a[198:199], v13 offset:1032
ds_read_b64_tr_b16 a[200:201], v13 offset:8192
ds_read_b64_tr_b16 a[202:203], v13 offset:9216
ds_read_b64_tr_b16 a[204:205], v13 offset:8200
ds_read_b64_tr_b16 a[206:207], v13 offset:9224
s_waitcnt lgkmcnt(0)
ds_read_b64_tr_b16 a[208:209], v13 offset:16384
ds_read_b64_tr_b16 a[210:211], v13 offset:17408
ds_read_b64_tr_b16 a[212:213], v13 offset:16392
ds_read_b64_tr_b16 a[214:215], v13 offset:17416
ds_read_b64_tr_b16 a[216:217], v13 offset:24576
ds_read_b64_tr_b16 a[218:219], v13 offset:25600
ds_read_b64_tr_b16 a[220:221], v13 offset:24584
ds_read_b64_tr_b16 a[222:223], v13 offset:25608
s_waitcnt lgkmcnt(0)
s_barrier
s_add_u32 s23, s23, 131072
s_add_u32 m0, s21, 65536
s_xor_b32 s20, s23, 0
buffer_load_dwordx4 v6, s[8:11], s20 offen lds
s_add_u32 m0, s21, 66560
s_xor_b32 s20, s23, 0
buffer_load_dwordx4 v7, s[8:11], s20 offen lds
s_add_u32 m0, s21, 73728
s_xor_b32 s20, s23, 256
buffer_load_dwordx4 v6, s[8:11], s20 offen lds
s_add_u32 m0, s21, 74752
s_xor_b32 s20, s23, 256
buffer_load_dwordx4 v7, s[8:11], s20 offen lds
s_add_u32 m0, s21, 81920
s_xor_b32 s20, s23, 512
buffer_load_dwordx4 v6, s[8:11], s20 offen lds
s_add_u32 m0, s21, 82944
s_xor_b32 s20, s23, 512
buffer_load_dwordx4 v7, s[8:11], s20 offen lds
s_add_u32 m0, s21, 90112
s_xor_b32 s20, s23, 768
buffer_load_dwordx4 v6, s[8:11], s20 offen lds
s_add_u32 m0, s21, 91136
s_xor_b32 s20, s23, 768
buffer_load_dwordx4 v7, s[8:11], s20 offen lds
s_waitcnt vmcnt(24)
s_barrier
s_cmp_lg_u32 s97, 0
s_cbranch_scc1 L_h2_4_ok
L_h2_4_ev:
v_cmp_ne_u32 vcc, 32, v36
s_cbranch_vccz L_h2_4_ok
s_mov_b32 s78, 0
v_readlane_b32 s81, v36, 0
s_nop 3
s_add_u32 s78, s78, s81
v_readlane_b32 s81, v36, 1
s_nop 3
s_add_u32 s78, s78, s81
v_readlane_b32 s81, v36, 2
s_nop 3
s_add_u32 s78, s78, s81
v_readlane_b32 s81, v36, 3
s_nop 3
s_add_u32 s78, s78, s81
v_readlane_b32 s81, v36, 4
s_nop 3
s_add_u32 s78, s78, s81
v_readlane_b32 s81, v36, 5
s_nop 3
s_add_u32 s78, s78, s81
v_readlane_b32 s81, v36, 6
s_nop 3
s_add_u32 s78, s78, s81
v_readlane_b32 s81, v36, 7
s_nop 3
s_add_u32 s78, s78, s81
s_cmp_eq_u32 s78, 256
s_cbranch_scc1 L_redo
buffer_load_dword v36, v37, s[88:91], 0 offen sc1
s_waitcnt vmcnt(0)
s_branch L_h2_4_ev
L_h2_4_ok:
s_mov_b32 s97, 1
v_add_u32 v13, 98304, v12
ds_read_b64_tr_b16 a[224:225], v13
ds_read_b64_tr_b16 a[226:227], v13 offset:1024
ds_read_b64_tr_b16 a[228:229], v13 offset:8
ds_read_b64_tr_b16 a[230:231], v13 offset:1032
ds_read_b64_tr_b16 a[232:233], v13 offset:8192
ds_read_b64_tr_b16 a[234:235], v13 offset:9216
ds_read_b64_tr_b16 a[236:237], v13 offset:8200
ds_read_b64_tr_b16 a[238:239], v13 offset:9224
s_waitcnt lgkmcnt(0)
ds_read_b64_tr_b16 a[240:241], v13 offset:16384
ds_read_b64_tr_b16 a[242:243], v13 offset:17408
ds_read_b64_tr_b16 a[244:245], v13 offset:16392
ds_read_b64_tr_b16 a[246:247], v13 offset:17416
ds_read_b64_tr_b16 a[248:249], v13 offset:24576
ds_read_b64_tr_b16 a[250:251], v13 offset:25600
ds_read_b64_tr_b16 a[252:253], v13 offset:24584
ds_read_b64_tr_b16 a[254:255], v13 offset:25608
s_waitcnt lgkmcnt(0)
s_barrier
s_waitcnt vmcnt(16)
s_barrier
s_cmp_eq_u32 s17, 2
s_cbranch_scc1 L_q_v
ds_read_b128 v[32:35], v16
ds_read_b128 v[36:39], v16 offset:4096
ds_read_b128 v[40:43], v17
ds_read_b128 v[44:47], v17 offset:4096
ds_read_b128 v[48:51], v18
ds_read_b128 v[52:55], v18 offset:4096
s_mov_b32 s25, 0
L_q_qk_loop:
s_waitcnt lgkmcnt(5)
v_mfma_f32_16x16x32_bf16 v[64:67], a[0:3], v[32:35], 0
ds_read_b128 v[56:59], v19
v_mfma_f32_16x16x32_bf16 v[68:71], a[4:7], v[32:35], 0
s_waitcnt lgkmcnt(5)
v_mfma_f32_16x16x32_bf16 v[72:75], a[0:3], v[36:39], 0
ds_read_b128 v[60:63], v19 offset:4096
v_mfma_f32_16x16x32_bf16 v[76:79], a[4:7], v[36:39], 0
s_waitcnt lgkmcnt(5)
v_mfma_f32_16x16x32_bf16 v[64:67], a[8:11], v[40:43], v[64:67]
ds_read_b128 v[32:35], v16 offset:8192
v_mfma_f32_16x16x32_bf16 v[68:71], a[12:15], v[40:43], v[68:71]
s_cmp_eq_u32 s25, 0
s_cbranch_scc1 L_q_qk_sk2
s_add_u32 m0, s21, 74752
s_xor_b32 s20, s23, 256
buffer_load_dwordx4 v7, s[8:11], s20 offen lds
L_q_qk_sk2:
s_waitcnt lgkmcnt(5)
v_mfma_f32_16x16x32_bf16 v[72:75], a[8:11], v[44:47], v[72:75]
ds_read_b128 v[36:39], v16 offset:12288
v_mfma_f32_16x16x32_bf16 v[76:79], a[12:15], v[44:47], v[76:79]
s_waitcnt lgkmcnt(5)
v_mfma_f32_16x16x32_bf16 v[64:67], a[16:19], v[48:51], v[64:67]
ds_read_b128 v[40:43], v17 offset:8192
v_mfma_f32_16x16x32_bf16 v[68:71], a[20:23], v[48:51], v[68:71]
s_waitcnt lgkmcnt(5)
v_mfma_f32_16x16x32_bf16 v[72:75], a[16:19], v[52:55], v[72:75]
ds_read_b128 v[44:47], v17 offset:12288
v_mfma_f32_16x16x32_bf16 v[76:79], a[20:23], v[52:55], v[76:79]
s_cmp_eq_u32 s25, 0
s_cbranch_scc1 L_q_qk_sk5
s_add_u32 m0, s21, 81920
s_xor_b32 s20, s23, 512
buffer_load_dwordx4 v6, s[8:11], s20 offen lds
L_q_qk_sk5:
s_waitcnt lgkmcnt(5)
v_mfma_f32_16x16x32_bf16 v[64:67], a[24:27], v[56:59], v[64:67]
ds_read_b128 v[48:51], v18 offset:8192
v_mfma_f32_16x16x32_bf16 v[68:71], a[28:31], v[56:59], v[68:71]
s_waitcnt lgkmcnt(5)
v_mfma_f32_16x16x32_bf16 v[72:75], a[24:27], v[60:63], v[72:75]
ds_read_b128 v[52:55], v18 offset:12288
v_mfma_f32_16x16x32_bf16 v[76:79], a[28:31], v[60:63], v[76:79]
s_waitcnt lgkmcnt(5)
v_mfma_f32_16x16x32_bf16 v[64:67], a[32:35], v[32:35], v[64:67]
ds_read_b128 v[56:59], v19 offset:8192
v_mfma_f32_16x16x32_bf16 v[68:71], a[36:39], v[32:35], v[68:71]
s_cmp_eq_u32 s25, 0
s_cbranch_scc1 L_q_qk_sk8
s_add_u32 m0, s21, 82944
s_xor_b32 s20, s23, 512
buffer_load_dwordx4 v7, s[8:11], s20 offen lds
L_q_qk_sk8:
s_waitcnt lgkmcnt(5)
v_mfma_f32_16x16x32_bf16 v[72:75], a[32:35], v[36:39], v[72:75]
ds_read_b128 v[60:63], v19 offset:12288
v_mfma_f32_16x16x32_bf16 v[76:79], a[36:39], v[36:39], v[76:79]
s_waitcnt lgkmcnt(5)
v_mfma_f32_16x16x32_bf16 v[64:67], a[40:43], v[40:43], v[64:67]
ds_read_b128 v[32:35], v16 offset:16384
v_mfma_f32_16x16x32_bf16 v[68:71], a[44:47], v[40:43], v[68:71]
s_waitcnt lgkmcnt(5)
v_mfma_f32_16x16x32_bf16 v[72:75], a[40:43], v[44:47], v[72:75]
ds_read_b128 v[36:39], v16 offset:20480
v_mfma_f32_16x16x32_bf16 v[76:79], a[44:47], v[44:47], v[76:79]
s_cmp_eq_u32 s25, 0
s_cbranch_scc1 L_q_qk_sk11
s_add_u32 m0, s21, 90112
s_xor_b32 s20, s23, 768
buffer_load_dwordx4 v6, s[8:11], s20 offen lds
L_q_qk_sk11:
s_waitcnt lgkmcnt(5)
v_mfma_f32_16x16x32_bf16 v[64:67], a[48:51], v[48:51], v[64:67]
ds_read_b128 v[40:43], v17 offset:16384
v_mfma_f32_16x16x32_bf16 v[68:71], a[52:55], v[48:51], v[68:71]
s_waitcnt lgkmcnt(5)
v_mfma_f32_16x16x32_bf16 v[72:75], a[48:51], v[52:55], v[72:75]
ds_read_b128 v[44:47], v17 offset:20480
v_mfma_f32_16x16x32_bf16 v[76:79], a[52:55], v[52:55], v[76:79]
s_waitcnt lgkmcnt(5)
v_mfma_f32_16x16x32_bf16 v[64:67], a[56:59], v[56:59], v[64:67]
ds_read_b128 v[48:51], v18 offset:16384
v_mfma_f32_16x16x32_bf16 v[68:71], a[60:63], v[56:59], v[68:71]
s_cmp_eq_u32 s25, 0
s_cbranch_scc1 L_q_qk_sk14
s_add_u32 m0, s21, 91136
s_xor_b32 s20, s23, 768
buffer_load_dwordx4 v7, s[8:11], s20 offen lds
L_q_qk_sk14:
s_waitcnt lgkmcnt(5)
v_mfma_f32_16x16x32_bf16 v[72:75], a[56:59], v[60:63], v[72:75]
ds_read_b128 v[52:55], v18 offset:20480
v_mfma_f32_16x16x32_bf16 v[76:79], a[60:63], v[60:63], v[76:79]
s_cmp_eq_u32 s25, 0
s_cbranch_scc1 L_q_qk_ne0
v_cvt_pk_bf16_f32 v96, v80, v81
v_cvt_pk_bf16_f32 v97, v82, v83
L_q_qk_ne0:
s_waitcnt lgkmcnt(5)
v_mfma_f32_16x16x32_bf16 v[64:67], a[64:67], v[32:35], v[64:67]
ds_read_b128 v[56:59], v19 offset:16384
v_mfma_f32_16x16x32_bf16 v[68:71], a[68:71], v[32:35], v[68:71]
s_cmp_eq_u32 s25, 0
s_cbranch_scc1 L_q_qk_ne1
v_cvt_pk_bf16_f32 v98, v84, v85
v_cvt_pk_bf16_f32 v99, v86, v87
L_q_qk_ne1:
s_waitcnt lgkmcnt(5)
v_mfma_f32_16x16x32_bf16 v[72:75], a[64:67], v[36:39], v[72:75]
ds_read_b128 v[60:63], v19 offset:20480
v_mfma_f32_16x16x32_bf16 v[76:79], a[68:71], v[36:39], v[76:79]
s_cmp_eq_u32 s25, 0
s_cbranch_scc1 L_q_qk_ne2
buffer_store_dwordx4 v[96:99], v8, s[84:87], s24 offen sc1
v_cvt_pk_bf16_f32 v100, v88, v89
L_q_qk_ne2:
s_waitcnt lgkmcnt(5)
v_mfma_f32_16x16x32_bf16 v[64:67], a[72:75], v[40:43], v[64:67]
ds_read_b128 v[32:35], v16 offset:24576
v_mfma_f32_16x16x32_bf16 v[68:71], a[76:79], v[40:43], v[68:71]
s_cmp_eq_u32 s25, 0
s_cbranch_scc1 L_q_qk_ne3
v_cvt_pk_bf16_f32 v101, v90, v91
v_cvt_pk_bf16_f32 v102, v92, v93
L_q_qk_ne3:
s_waitcnt lgkmcnt(5)
v_mfma_f32_16x16x32_bf16 v[72:75], a[72:75], v[44:47], v[72:75]
ds_read_b128 v[36:39], v16 offset:28672
v_mfma_f32_16x16x32_bf16 v[76:79], a[76:79], v[44:47], v[76:79]
s_cmp_eq_u32 s25, 0
s_cbranch_scc1 L_q_qk_ne4
v_cvt_pk_bf16_f32 v103, v94, v95
buffer_store_dwordx4 v[100:103], v8, s[84:87], s24 offen offset:1024 sc1
L_q_qk_ne4:
s_waitcnt lgkmcnt(5)
v_mfma_f32_16x16x32_bf16 v[64:67], a[80:83], v[48:51], v[64:67]
ds_read_b128 v[40:43], v17 offset:24576
v_mfma_f32_16x16x32_bf16 v[68:71], a[84:87], v[48:51], v[68:71]
s_cmp_eq_u32 s25, 0
s_cbranch_scc1 L_q_qk_ne5
s_add_u32 s24, s24, 524288
L_q_qk_ne5:
s_waitcnt lgkmcnt(5)
v_mfma_f32_16x16x32_bf16 v[72:75], a[80:83], v[52:55], v[72:75]
ds_read_b128 v[44:47], v17 offset:28672
v_mfma_f32_16x16x32_bf16 v[76:79], a[84:87], v[52:55], v[76:79]
s_waitcnt lgkmcnt(5)
v_mfma_f32_16x16x32_bf16 v[64:67], a[88:91], v[56:59], v[64:67]
ds_read_b128 v[48:51], v18 offset:24576
v_mfma_f32_16x16x32_bf16 v[68:71], a[92:95], v[56:59], v[68:71]
s_cmp_lg_u32 s25, 2
s_cbranch_scc1 L_q_qk_nx
v_lshlrev_b32 v242, 7, v0
s_mul_i32 s46, s92, 32768
s_sub_u32 s46, s46, 2097152
buffer_load_dword v240, v242, s[8:11], s46 offen
L_q_qk_nx:
s_waitcnt lgkmcnt(5)
v_mfma_f32_16x16x32_bf16 v[72:75], a[88:91], v[60:63], v[72:75]
ds_read_b128 v[52:55], v18 offset:28672
v_mfma_f32_16x16x32_bf16 v[76:79], a[92:95], v[60:63], v[76:79]
s_waitcnt vmcnt(8)
s_barrier
s_waitcnt lgkmcnt(5)
v_mfma_f32_16x16x32_bf16 v[64:67], a[96:99], v[32:35], v[64:67]
ds_read_b128 v[56:59], v19 offset:24576
v_mfma_f32_16x16x32_bf16 v[68:71], a[100:103], v[32:35], v[68:71]
s_waitcnt lgkmcnt(5)
v_mfma_f32_16x16x32_bf16 v[72:75], a[96:99], v[36:39], v[72:75]
ds_read_b128 v[60:63], v19 offset:28672
v_mfma_f32_16x16x32_bf16 v[76:79], a[100:103], v[36:39], v[76:79]
s_add_u32 m0, s21, 98304
s_xor_b32 s20, s23, 1024
buffer_load_dwordx4 v6, s[8:11], s20 offen lds
s_waitcnt lgkmcnt(5)
v_mfma_f32_16x16x32_bf16 v[64:67], a[104:107], v[40:43], v[64:67]
ds_read_b128 v[32:35], v16 offset:32768
v_mfma_f32_16x16x32_bf16 v[68:71], a[108:111], v[40:43], v[68:71]
s_waitcnt lgkmcnt(5)
v_mfma_f32_16x16x32_bf16 v[72:75], a[104:107], v[44:47], v[72:75]
ds_read_b128 v[36:39], v16 offset:36864
v_mfma_f32_16x16x32_bf16 v[76:79], a[108:111], v[44:47], v[76:79]
s_waitcnt lgkmcnt(5)
v_mfma_f32_16x16x32_bf16 v[64:67], a[112:115], v[48:51], v[64:67]
ds_read_b128 v[40:43], v17 offset:32768
v_mfma_f32_16x16x32_bf16 v[68:71], a[116:119], v[48:51], v[68:71]
s_add_u32 m0, s21, 99328
s_xor_b32 s20, s23, 1024
buffer_load_dwordx4 v7, s[8:11], s20 offen lds
s_waitcnt lgkmcnt(5)
v_mfma_f32_16x16x32_bf16 v[72:75], a[112:115], v[52:55], v[72:75]
ds_read_b128 v[44:47], v17 offset:36864
v_mfma_f32_16x16x32_bf16 v[76:79], a[116:119], v[52:55], v[76:79]
s_waitcnt lgkmcnt(5)
v_mfma_f32_16x16x32_bf16 v[64:67], a[120:123], v[56:59], v[64:67]
ds_read_b128 v[48:51], v18 offset:32768
v_mfma_f32_16x16x32_bf16 v[68:71], a[124:127], v[56:59], v[68:71]
s_waitcnt lgkmcnt(5)
v_mfma_f32_16x16x32_bf16 v[72:75], a[120:123], v[60:63], v[72:75]
ds_read_b128 v[52:55], v18 offset:36864
v_mfma_f32_16x16x32_bf16 v[76:79], a[124:127], v[60:63], v[76:79]
s_add_u32 m0, s21, 106496
s_xor_b32 s20, s23, 1280
buffer_load_dwordx4 v6, s[8:11], s20 offen lds
s_waitcnt lgkmcnt(5)
v_mfma_f32_16x16x32_bf16 v[64:67], a[128:131], v[32:35], v[64:67]
ds_read_b128 v[56:59], v19 offset:32768
v_mfma_f32_16x16x32_bf16 v[68:71], a[132:135], v[32:35], v[68:71]
s_waitcnt lgkmcnt(5)
v_mfma_f32_16x16x32_bf16 v[72:75], a[128:131], v[36:39], v[72:75]
ds_read_b128 v[60:63], v19 offset:36864
v_mfma_f32_16x16x32_bf16 v[76:79], a[132:135], v[36:39], v[76:79]
s_waitcnt lgkmcnt(5)
v_mfma_f32_16x16x32_bf16 v[64:67], a[136:139], v[40:43], v[64:67]
ds_read_b128 v[32:35], v16 offset:40960
v_mfma_f32_16x16x32_bf16 v[68:71], a[140:143], v[40:43], v[68:71]
s_add_u32 m0, s21, 107520
s_xor_b32 s20, s23, 1280
buffer_load_dwordx4 v7, s[8:11], s20 offen lds
s_waitcnt lgkmcnt(5)
v_mfma_f32_16x16x32_bf16 v[72:75], a[136:139], v[44:47], v[72:75]
ds_read_b128 v[36:39], v16 offset:45056
v_mfma_f32_16x16x32_bf16 v[76:79], a[140:143], v[44:47], v[76:79]
s_waitcnt lgkmcnt(5)
v_mfma_f32_16x16x32_bf16 v[64:67], a[144:147], v[48:51], v[64:67]
ds_read_b128 v[40:43], v17 offset:40960
v_mfma_f32_16x16x32_bf16 v[68:71], a[148:151], v[48:51], v[68:71]
s_waitcnt lgkmcnt(5)
v_mfma_f32_16x16x32_bf16 v[72:75], a[144:147], v[52:55], v[72:75]
ds_read_b128 v[44:47], v17 offset:45056
v_mfma_f32_16x16x32_bf16 v[76:79], a[148:151], v[52:55], v[76:79]
s_add_u32 m0, s21, 114688
s_xor_b32 s20, s23, 1536
buffer_load_dwordx4 v6, s[8:11], s20 offen lds
s_waitcnt lgkmcnt(5)
v_mfma_f32_16x16x32_bf16 v[64:67], a[152:155], v[56:59], v[64:67]
ds_read_b128 v[48:51], v18 offset:40960
v_mfma_f32_16x16x32_bf16 v[68:71], a[156:159], v[56:59], v[68:71]
s_waitcnt lgkmcnt(5)
v_mfma_f32_16x16x32_bf16 v[72:75], a[152:155], v[60:63], v[72:75]
ds_read_b128 v[52:55], v18 offset:45056
v_mfma_f32_16x16x32_bf16 v[76:79], a[156:159], v[60:63], v[76:79]
s_waitcnt lgkmcnt(5)
v_mfma_f32_16x16x32_bf16 v[64:67], a[160:163], v[32:35], v[64:67]
ds_read_b128 v[56:59], v19 offset:40960
v_mfma_f32_16x16x32_bf16 v[68:71], a[164:167], v[32:35], v[68:71]
s_add_u32 m0, s21, 115712
s_xor_b32 s20, s23, 1536
buffer_load_dwordx4 v7, s[8:11], s20 offen lds
s_waitcnt lgkmcnt(5)
v_mfma_f32_16x16x32_bf16 v[72:75], a[160:163], v[36:39], v[72:75]
ds_read_b128 v[60:63], v19 offset:45056
v_mfma_f32_16x16x32_bf16 v[76:79], a[164:167], v[36:39], v[76:79]
s_waitcnt lgkmcnt(5)
v_mfma_f32_16x16x32_bf16 v[64:67], a[168:171], v[40:43], v[64:67]
ds_read_b128 v[32:35], v16 offset:49152
v_mfma_f32_16x16x32_bf16 v[68:71], a[172:175], v[40:43], v[68:71]
s_waitcnt lgkmcnt(5)
v_mfma_f32_16x16x32_bf16 v[72:75], a[168:171], v[44:47], v[72:75]
ds_read_b128 v[36:39], v16 offset:53248
v_mfma_f32_16x16x32_bf16 v[76:79], a[172:175], v[44:47], v[76:79]
s_add_u32 m0, s21, 122880
s_xor_b32 s20, s23, 1792
buffer_load_dwordx4 v6, s[8:11], s20 offen lds
s_waitcnt lgkmcnt(5)
v_mfma_f32_16x16x32_bf16 v[64:67], a[176:179], v[48:51], v[64:67]
ds_read_b128 v[40:43], v17 offset:49152
v_mfma_f32_16x16x32_bf16 v[68:71], a[180:183], v[48:51], v[68:71]
s_waitcnt lgkmcnt(5)
v_mfma_f32_16x16x32_bf16 v[72:75], a[176:179], v[52:55], v[72:75]
ds_read_b128 v[44:47], v17 offset:53248
v_mfma_f32_16x16x32_bf16 v[76:79], a[180:183], v[52:55], v[76:79]
s_waitcnt lgkmcnt(5)
v_mfma_f32_16x16x32_bf16 v[64:67], a[184:187], v[56:59], v[64:67]
ds_read_b128 v[48:51], v18 offset:49152
v_mfma_f32_16x16x32_bf16 v[68:71], a[188:191], v[56:59], v[68:71]
s_add_u32 m0, s21, 123904
s_xor_b32 s20, s23, 1792
buffer_load_dwordx4 v7, s[8:11], s20 offen lds
s_waitcnt lgkmcnt(5)
v_mfma_f32_16x16x32_bf16 v[72:75], a[184:187], v[60:63], v[72:75]
ds_read_b128 v[52:55], v18 offset:53248
v_mfma_f32_16x16x32_bf16 v[76:79], a[188:191], v[60:63], v[76:79]
s_waitcnt lgkmcnt(5)
v_mfma_f32_16x16x32_bf16 v[64:67], a[192:195], v[32:35], v[64:67]
ds_read_b128 v[56:59], v19 offset:49152
v_mfma_f32_16x16x32_bf16 v[68:71], a[196:199], v[32:35], v[68:71]
s_waitcnt lgkmcnt(5)
v_mfma_f32_16x16x32_bf16 v[72:75], a[192:195], v[36:39], v[72:75]
ds_read_b128 v[60:63], v19 offset:53248
v_mfma_f32_16x16x32_bf16 v[76:79], a[196:199], v[36:39], v[76:79]
s_waitcnt lgkmcnt(5)
v_mfma_f32_16x16x32_bf16 v[64:67], a[200:203], v[40:43], v[64:67]
ds_read_b128 v[32:35], v16 offset:57344
v_mfma_f32_16x16x32_bf16 v[68:71], a[204:207], v[40:43], v[68:71]
s_waitcnt lgkmcnt(5)
v_mfma_f32_16x16x32_bf16 v[72:75], a[200:203], v[44:47], v[72:75]
ds_read_b128 v[36:39], v16 offset:61440
v_mfma_f32_16x16x32_bf16 v[76:79], a[204:207], v[44:47], v[76:79]
s_waitcnt lgkmcnt(5)
v_mfma_f32_16x16x32_bf16 v[64:67], a[208:211], v[48:51], v[64:67]
ds_read_b128 v[40:43], v17 offset:57344
v_mfma_f32_16x16x32_bf16 v[68:71], a[212:215], v[48:51], v[68:71]
s_waitcnt lgkmcnt(5)
v_mfma_f32_16x16x32_bf16 v[72:75], a[208:211], v[52:55], v[72:75]
ds_read_b128 v[44:47], v17 offset:61440
v_mfma_f32_16x16x32_bf16 v[76:79], a[212:215], v[52:55], v[76:79]
s_waitcnt lgkmcnt(5)
v_mfma_f32_16x16x32_bf16 v[64:67], a[216:219], v[56:59], v[64:67]
ds_read_b128 v[48:51], v18 offset:57344
v_mfma_f32_16x16x32_bf16 v[68:71], a[220:223], v[56:59], v[68:71]
s_waitcnt lgkmcnt(5)
v_mfma_f32_16x16x32_bf16 v[72:75], a[216:219], v[60:63], v[72:75]
ds_read_b128 v[52:55], v18 offset:61440
v_mfma_f32_16x16x32_bf16 v[76:79], a[220:223], v[60:63], v[76:79]
s_waitcnt vmcnt(8)
s_barrier
s_waitcnt lgkmcnt(5)
v_mfma_f32_16x16x32_bf16 v[64:67], a[224:227], v[32:35], v[64:67]
ds_read_b128 v[56:59], v19 offset:57344
v_mfma_f32_16x16x32_bf16 v[68:71], a[228:231], v[32:35], v[68:71]
s_waitcnt lgkmcnt(5)
v_mfma_f32_16x16x32_bf16 v[72:75], a[224:227], v[36:39], v[72:75]
ds_read_b128 v[60:63], v19 offset:61440
v_mfma_f32_16x16x32_bf16 v[76:79], a[228:231], v[36:39], v[76:79]
s_add_u32 s23, s23, 131072
s_add_u32 m0, s21, 0
s_xor_b32 s20, s23, 0
buffer_load_dwordx4 v6, s[8:11], s20 offen lds
s_waitcnt lgkmcnt(5)
v_mfma_f32_16x16x32_bf16 v[64:67], a[232:235], v[40:43], v[64:67]
ds_read_b128 v[32:35], v20
v_mfma_f32_16x16x32_bf16 v[68:71], a[236:239], v[40:43], v[68:71]
s_cmp_eq_u32 s25, 0
s_cbranch_scc1 L_q_qk_nf
v_add_u32 v10, 1, v10
buffer_store_dword v10, v9, s[84:87], 0 offen sc1
L_q_qk_nf:
s_waitcnt lgkmcnt(5)
v_mfma_f32_16x16x32_bf16 v[72:75], a[232:235], v[44:47], v[72:75]
ds_read_b128 v[36:39], v20 offset:4096
v_mfma_f32_16x16x32_bf16 v[76:79], a[236:239], v[44:47], v[76:79]
s_waitcnt lgkmcnt(5)
v_mfma_f32_16x16x32_bf16 v[64:67], a[240:243], v[48:51], v[64:67]
ds_read_b128 v[40:43], v21
v_mfma_f32_16x16x32_bf16 v[68:71], a[244:247], v[48:51], v[68:71]
s_add_u32 m0, s21, 1024
s_xor_b32 s20, s23, 0
buffer_load_dwordx4 v7, s[8:11], s20 offen lds
s_waitcnt lgkmcnt(5)
v_mfma_f32_16x16x32_bf16 v[72:75], a[240:243], v[52:55], v[72:75]
ds_read_b128 v[44:47], v21 offset:4096
v_mfma_f32_16x16x32_bf16 v[76:79], a[244:247], v[52:55], v[76:79]
s_waitcnt lgkmcnt(5)
v_mfma_f32_16x16x32_bf16 v[64:67], a[248:251], v[56:59], v[64:67]
ds_read_b128 v[48:51], v22
v_mfma_f32_16x16x32_bf16 v[68:71], a[252:255], v[56:59], v[68:71]
s_waitcnt lgkmcnt(5)
v_mfma_f32_16x16x32_bf16 v[72:75], a[248:251], v[60:63], v[72:75]
ds_read_b128 v[52:55], v22 offset:4096
v_mfma_f32_16x16x32_bf16 v[76:79], a[252:255], v[60:63], v[76:79]
s_add_u32 m0, s21, 8192
s_xor_b32 s20, s23, 256
buffer_load_dwordx4 v6, s[8:11], s20 offen lds
s_waitcnt lgkmcnt(5)
v_mfma_f32_16x16x32_bf16 v[80:83], a[0:3], v[32:35], 0
ds_read_b128 v[56:59], v23
v_mfma_f32_16x16x32_bf16 v[84:87], a[4:7], v[32:35], 0
s_waitcnt lgkmcnt(5)
v_mfma_f32_16x16x32_bf16 v[88:91], a[0:3], v[36:39], 0
ds_read_b128 v[60:63], v23 offset:4096
v_mfma_f32_16x16x32_bf16 v[92:95], a[4:7], v[36:39], 0
s_waitcnt lgkmcnt(5)
v_mfma_f32_16x16x32_bf16 v[80:83], a[8:11], v[40:43], v[80:83]
ds_read_b128 v[32:35], v20 offset:8192
v_mfma_f32_16x16x32_bf16 v[84:87], a[12:15], v[40:43], v[84:87]
s_add_u32 m0, s21, 9216
s_xor_b32 s20, s23, 256
buffer_load_dwordx4 v7, s[8:11], s20 offen lds
s_waitcnt lgkmcnt(5)
v_mfma_f32_16x16x32_bf16 v[88:91], a[8:11], v[44:47], v[88:91]
ds_read_b128 v[36:39], v20 offset:12288
v_mfma_f32_16x16x32_bf16 v[92:95], a[12:15], v[44:47], v[92:95]
s_waitcnt lgkmcnt(5)
v_mfma_f32_16x16x32_bf16 v[80:83], a[16:19], v[48:51], v[80:83]
ds_read_b128 v[40:43], v21 offset:8192
v_mfma_f32_16x16x32_bf16 v[84:87], a[20:23], v[48:51], v[84:87]
s_waitcnt lgkmcnt(5)
v_mfma_f32_16x16x32_bf16 v[88:91], a[16:19], v[52:55], v[88:91]
ds_read_b128 v[44:47], v21 offset:12288
v_mfma_f32_16x16x32_bf16 v[92:95], a[20:23], v[52:55], v[92:95]
s_add_u32 m0, s21, 16384
s_xor_b32 s20, s23, 512
buffer_load_dwordx4 v6, s[8:11], s20 offen lds
s_waitcnt lgkmcnt(5)
v_mfma_f32_16x16x32_bf16 v[80:83], a[24:27], v[56:59], v[80:83]
ds_read_b128 v[48:51], v22 offset:8192
v_mfma_f32_16x16x32_bf16 v[84:87], a[28:31], v[56:59], v[84:87]
s_waitcnt lgkmcnt(5)
v_mfma_f32_16x16x32_bf16 v[88:91], a[24:27], v[60:63], v[88:91]
ds_read_b128 v[52:55], v22 offset:12288
v_mfma_f32_16x16x32_bf16 v[92:95], a[28:31], v[60:63], v[92:95]
s_waitcnt lgkmcnt(5)
v_mfma_f32_16x16x32_bf16 v[80:83], a[32:35], v[32:35], v[80:83]
ds_read_b128 v[56:59], v23 offset:8192
v_mfma_f32_16x16x32_bf16 v[84:87], a[36:39], v[32:35], v[84:87]
s_add_u32 m0, s21, 17408
s_xor_b32 s20, s23, 512
buffer_load_dwordx4 v7, s[8:11], s20 offen lds
s_waitcnt lgkmcnt(5)
v_mfma_f32_16x16x32_bf16 v[88:91], a[32:35], v[36:39], v[88:91]
ds_read_b128 v[60:63], v23 offset:12288
v_mfma_f32_16x16x32_bf16 v[92:95], a[36:39], v[36:39], v[92:95]
s_waitcnt lgkmcnt(5)
v_mfma_f32_16x16x32_bf16 v[80:83], a[40:43], v[40:43], v[80:83]
ds_read_b128 v[32:35], v20 offset:16384
v_mfma_f32_16x16x32_bf16 v[84:87], a[44:47], v[40:43], v[84:87]
s_waitcnt lgkmcnt(5)
v_mfma_f32_16x16x32_bf16 v[88:91], a[40:43], v[44:47], v[88:91]
ds_read_b128 v[36:39], v20 offset:20480
v_mfma_f32_16x16x32_bf16 v[92:95], a[44:47], v[44:47], v[92:95]
s_add_u32 m0, s21, 24576
s_xor_b32 s20, s23, 768
buffer_load_dwordx4 v6, s[8:11], s20 offen lds
s_waitcnt lgkmcnt(5)
v_mfma_f32_16x16x32_bf16 v[80:83], a[48:51], v[48:51], v[80:83]
ds_read_b128 v[40:43], v21 offset:16384
v_mfma_f32_16x16x32_bf16 v[84:87], a[52:55], v[48:51], v[84:87]
s_waitcnt lgkmcnt(5)
v_mfma_f32_16x16x32_bf16 v[88:91], a[48:51], v[52:55], v[88:91]
ds_read_b128 v[44:47], v21 offset:20480
v_mfma_f32_16x16x32_bf16 v[92:95], a[52:55], v[52:55], v[92:95]
s_waitcnt lgkmcnt(5)
v_mfma_f32_16x16x32_bf16 v[80:83], a[56:59], v[56:59], v[80:83]
ds_read_b128 v[48:51], v22 offset:16384
v_mfma_f32_16x16x32_bf16 v[84:87], a[60:63], v[56:59], v[84:87]
s_add_u32 m0, s21, 25600
s_xor_b32 s20, s23, 768
buffer_load_dwordx4 v7, s[8:11], s20 offen lds
s_waitcnt lgkmcnt(5)
v_mfma_f32_16x16x32_bf16 v[88:91], a[56:59], v[60:63], v[88:91]
ds_read_b128 v[52:55], v22 offset:20480
v_mfma_f32_16x16x32_bf16 v[92:95], a[60:63], v[60:63], v[92:95]
v_cvt_pk_bf16_f32 v96, v64, v65
v_cvt_pk_bf16_f32 v97, v66, v67
s_waitcnt lgkmcnt(5)
v_mfma_f32_16x16x32_bf16 v[80:83], a[64:67], v[32:35], v[80:83]
ds_read_b128 v[56:59], v23 offset:16384
v_mfma_f32_16x16x32_bf16 v[84:87], a[68:71], v[32:35], v[84:87]
v_cvt_pk_bf16_f32 v98, v68, v69
v_cvt_pk_bf16_f32 v99, v70, v71
s_waitcnt lgkmcnt(5)
v_mfma_f32_16x16x32_bf16 v[88:91], a[64:67], v[36:39], v[88:91]
ds_read_b128 v[60:63], v23 offset:20480
v_mfma_f32_16x16x32_bf16 v[92:95], a[68:71], v[36:39], v[92:95]
buffer_store_dwordx4 v[96:99], v8, s[84:87], s24 offen sc1
v_cvt_pk_bf16_f32 v100, v72, v73
s_waitcnt lgkmcnt(5)
v_mfma_f32_16x16x32_bf16 v[80:83], a[72:75], v[40:43], v[80:83]
ds_read_b128 v[32:35], v20 offset:24576
v_mfma_f32_16x16x32_bf16 v[84:87], a[76:79], v[40:43], v[84:87]
v_cvt_pk_bf16_f32 v101, v74, v75
v_cvt_pk_bf16_f32 v102, v76, v77
s_waitcnt lgkmcnt(5)
v_mfma_f32_16x16x32_bf16 v[88:91], a[72:75], v[44:47], v[88:91]
ds_read_b128 v[36:39], v20 offset:28672
v_mfma_f32_16x16x32_bf16 v[92:95], a[76:79], v[44:47], v[92:95]
v_cvt_pk_bf16_f32 v103, v78, v79
buffer_store_dwordx4 v[100:103], v8, s[84:87], s24 offen offset:1024 sc1
s_waitcnt lgkmcnt(5)
v_mfma_f32_16x16x32_bf16 v[80:83], a[80:83], v[48:51], v[80:83]
ds_read_b128 v[40:43], v21 offset:24576
v_mfma_f32_16x16x32_bf16 v[84:87], a[84:87], v[48:51], v[84:87]
s_add_u32 s24, s24, 524288
s_waitcnt lgkmcnt(5)
v_mfma_f32_16x16x32_bf16 v[88:91], a[80:83], v[52:55], v[88:91]
ds_read_b128 v[44:47], v21 offset:28672
v_mfma_f32_16x16x32_bf16 v[92:95], a[84:87], v[52:55], v[92:95]
s_waitcnt lgkmcnt(5)
v_mfma_f32_16x16x32_bf16 v[80:83], a[88:91], v[56:59], v[80:83]
ds_read_b128 v[48:51], v22 offset:24576
v_mfma_f32_16x16x32_bf16 v[84:87], a[92:95], v[56:59], v[84:87]
s_waitcnt lgkmcnt(5)
v_mfma_f32_16x16x32_bf16 v[88:91], a[88:91], v[60:63], v[88:91]
ds_read_b128 v[52:55], v22 offset:28672
v_mfma_f32_16x16x32_bf16 v[92:95], a[92:95], v[60:63], v[92:95]
s_waitcnt vmcnt(8)
s_barrier
s_waitcnt lgkmcnt(5)
v_mfma_f32_16x16x32_bf16 v[80:83], a[96:99], v[32:35], v[80:83]
ds_read_b128 v[56:59], v23 offset:24576
v_mfma_f32_16x16x32_bf16 v[84:87], a[100:103], v[32:35], v[84:87]
s_waitcnt lgkmcnt(5)
v_mfma_f32_16x16x32_bf16 v[88:91], a[96:99], v[36:39], v[88:91]
ds_read_b128 v[60:63], v23 offset:28672
v_mfma_f32_16x16x32_bf16 v[92:95], a[100:103], v[36:39], v[92:95]
s_add_u32 m0, s21, 32768
s_xor_b32 s20, s23, 1024
buffer_load_dwordx4 v6, s[8:11], s20 offen lds
s_waitcnt lgkmcnt(5)
v_mfma_f32_16x16x32_bf16 v[80:83], a[104:107], v[40:43], v[80:83]
ds_read_b128 v[32:35], v20 offset:32768
v_mfma_f32_16x16x32_bf16 v[84:87], a[108:111], v[40:43], v[84:87]
s_waitcnt lgkmcnt(5)
v_mfma_f32_16x16x32_bf16 v[88:91], a[104:107], v[44:47], v[88:91]
ds_read_b128 v[36:39], v20 offset:36864
v_mfma_f32_16x16x32_bf16 v[92:95], a[108:111], v[44:47], v[92:95]
s_waitcnt lgkmcnt(5)
v_mfma_f32_16x16x32_bf16 v[80:83], a[112:115], v[48:51], v[80:83]
ds_read_b128 v[40:43], v21 offset:32768
v_mfma_f32_16x16x32_bf16 v[84:87], a[116:119], v[48:51], v[84:87]
s_add_u32 m0, s21, 33792
s_xor_b32 s20, s23, 1024
buffer_load_dwordx4 v7, s[8:11], s20 offen lds
s_waitcnt lgkmcnt(5)
v_mfma_f32_16x16x32_bf16 v[88:91], a[112:115], v[52:55], v[88:91]
ds_read_b128 v[44:47], v21 offset:36864
v_mfma_f32_16x16x32_bf16 v[92:95], a[116:119], v[52:55], v[92:95]
s_waitcnt lgkmcnt(5)
v_mfma_f32_16x16x32_bf16 v[80:83], a[120:123], v[56:59], v[80:83]
ds_read_b128 v[48:51], v22 offset:32768
v_mfma_f32_16x16x32_bf16 v[84:87], a[124:127], v[56:59], v[84:87]
s_waitcnt lgkmcnt(5)
v_mfma_f32_16x16x32_bf16 v[88:91], a[120:123], v[60:63], v[88:91]
ds_read_b128 v[52:55], v22 offset:36864
v_mfma_f32_16x16x32_bf16 v[92:95], a[124:127], v[60:63], v[92:95]
s_add_u32 m0, s21, 40960
s_xor_b32 s20, s23, 1280
buffer_load_dwordx4 v6, s[8:11], s20 offen lds
s_waitcnt lgkmcnt(5)
v_mfma_f32_16x16x32_bf16 v[80:83], a[128:131], v[32:35], v[80:83]
ds_read_b128 v[56:59], v23 offset:32768
v_mfma_f32_16x16x32_bf16 v[84:87], a[132:135], v[32:35], v[84:87]
s_waitcnt lgkmcnt(5)
v_mfma_f32_16x16x32_bf16 v[88:91], a[128:131], v[36:39], v[88:91]
ds_read_b128 v[60:63], v23 offset:36864
v_mfma_f32_16x16x32_bf16 v[92:95], a[132:135], v[36:39], v[92:95]
s_waitcnt lgkmcnt(5)
v_mfma_f32_16x16x32_bf16 v[80:83], a[136:139], v[40:43], v[80:83]
ds_read_b128 v[32:35], v20 offset:40960
v_mfma_f32_16x16x32_bf16 v[84:87], a[140:143], v[40:43], v[84:87]
s_add_u32 m0, s21, 41984
s_xor_b32 s20, s23, 1280
buffer_load_dwordx4 v7, s[8:11], s20 offen lds
s_waitcnt lgkmcnt(5)
v_mfma_f32_16x16x32_bf16 v[88:91], a[136:139], v[44:47], v[88:91]
ds_read_b128 v[36:39], v20 offset:45056
v_mfma_f32_16x16x32_bf16 v[92:95], a[140:143], v[44:47], v[92:95]
s_waitcnt lgkmcnt(5)
v_mfma_f32_16x16x32_bf16 v[80:83], a[144:147], v[48:51], v[80:83]
ds_read_b128 v[40:43], v21 offset:40960
v_mfma_f32_16x16x32_bf16 v[84:87], a[148:151], v[48:51], v[84:87]
s_waitcnt lgkmcnt(5)
v_mfma_f32_16x16x32_bf16 v[88:91], a[144:147], v[52:55], v[88:91]
ds_read_b128 v[44:47], v21 offset:45056
v_mfma_f32_16x16x32_bf16 v[92:95], a[148:151], v[52:55], v[92:95]
s_add_u32 m0, s21, 49152
s_xor_b32 s20, s23, 1536
buffer_load_dwordx4 v6, s[8:11], s20 offen lds
s_waitcnt lgkmcnt(5)
v_mfma_f32_16x16x32_bf16 v[80:83], a[152:155], v[56:59], v[80:83]
ds_read_b128 v[48:51], v22 offset:40960
v_mfma_f32_16x16x32_bf16 v[84:87], a[156:159], v[56:59], v[84:87]
s_waitcnt lgkmcnt(5)
v_mfma_f32_16x16x32_bf16 v[88:91], a[152:155], v[60:63], v[88:91]
ds_read_b128 v[52:55], v22 offset:45056
v_mfma_f32_16x16x32_bf16 v[92:95], a[156:159], v[60:63], v[92:95]
s_waitcnt lgkmcnt(5)
v_mfma_f32_16x16x32_bf16 v[80:83], a[160:163], v[32:35], v[80:83]
ds_read_b128 v[56:59], v23 offset:40960
v_mfma_f32_16x16x32_bf16 v[84:87], a[164:167], v[32:35], v[84:87]
s_add_u32 m0, s21, 50176
s_xor_b32 s20, s23, 1536
buffer_load_dwordx4 v7, s[8:11], s20 offen lds
s_waitcnt lgkmcnt(5)
v_mfma_f32_16x16x32_bf16 v[88:91], a[160:163], v[36:39], v[88:91]
ds_read_b128 v[60:63], v23 offset:45056
v_mfma_f32_16x16x32_bf16 v[92:95], a[164:167], v[36:39], v[92:95]
s_waitcnt lgkmcnt(5)
v_mfma_f32_16x16x32_bf16 v[80:83], a[168:171], v[40:43], v[80:83]
ds_read_b128 v[32:35], v20 offset:49152
v_mfma_f32_16x16x32_bf16 v[84:87], a[172:175], v[40:43], v[84:87]
s_waitcnt lgkmcnt(5)
v_mfma_f32_16x16x32_bf16 v[88:91], a[168:171], v[44:47], v[88:91]
ds_read_b128 v[36:39], v20 offset:53248
v_mfma_f32_16x16x32_bf16 v[92:95], a[172:175], v[44:47], v[92:95]
s_add_u32 m0, s21, 57344
s_xor_b32 s20, s23, 1792
buffer_load_dwordx4 v6, s[8:11], s20 offen lds
s_waitcnt lgkmcnt(5)
v_mfma_f32_16x16x32_bf16 v[80:83], a[176:179], v[48:51], v[80:83]
ds_read_b128 v[40:43], v21 offset:49152
v_mfma_f32_16x16x32_bf16 v[84:87], a[180:183], v[48:51], v[84:87]
s_waitcnt lgkmcnt(5)
v_mfma_f32_16x16x32_bf16 v[88:91], a[176:179], v[52:55], v[88:91]
ds_read_b128 v[44:47], v21 offset:53248
v_mfma_f32_16x16x32_bf16 v[92:95], a[180:183], v[52:55], v[92:95]
s_waitcnt lgkmcnt(5)
v_mfma_f32_16x16x32_bf16 v[80:83], a[184:187], v[56:59], v[80:83]
ds_read_b128 v[48:51], v22 offset:49152
v_mfma_f32_16x16x32_bf16 v[84:87], a[188:191], v[56:59], v[84:87]
s_add_u32 m0, s21, 58368
s_xor_b32 s20, s23, 1792
buffer_load_dwordx4 v7, s[8:11], s20 offen lds
s_waitcnt lgkmcnt(5)
v_mfma_f32_16x16x32_bf16 v[88:91], a[184:187], v[60:63], v[88:91]
ds_read_b128 v[52:55], v22 offset:53248
v_mfma_f32_16x16x32_bf16 v[92:95], a[188:191], v[60:63], v[92:95]
s_waitcnt lgkmcnt(5)
v_mfma_f32_16x16x32_bf16 v[80:83], a[192:195], v[32:35], v[80:83]
ds_read_b128 v[56:59], v23 offset:49152
v_mfma_f32_16x16x32_bf16 v[84:87], a[196:199], v[32:35], v[84:87]
s_waitcnt lgkmcnt(5)
v_mfma_f32_16x16x32_bf16 v[88:91], a[192:195], v[36:39], v[88:91]
ds_read_b128 v[60:63], v23 offset:53248
v_mfma_f32_16x16x32_bf16 v[92:95], a[196:199], v[36:39], v[92:95]
s_waitcnt lgkmcnt(5)
v_mfma_f32_16x16x32_bf16 v[80:83], a[200:203], v[40:43], v[80:83]
ds_read_b128 v[32:35], v20 offset:57344
v_mfma_f32_16x16x32_bf16 v[84:87], a[204:207], v[40:43], v[84:87]
s_waitcnt lgkmcnt(5)
v_mfma_f32_16x16x32_bf16 v[88:91], a[200:203], v[44:47], v[88:91]
ds_read_b128 v[36:39], v20 offset:61440
v_mfma_f32_16x16x32_bf16 v[92:95], a[204:207], v[44:47], v[92:95]
s_waitcnt lgkmcnt(5)
v_mfma_f32_16x16x32_bf16 v[80:83], a[208:211], v[48:51], v[80:83]
ds_read_b128 v[40:43], v21 offset:57344
v_mfma_f32_16x16x32_bf16 v[84:87], a[212:215], v[48:51], v[84:87]
s_waitcnt lgkmcnt(5)
v_mfma_f32_16x16x32_bf16 v[88:91], a[208:211], v[52:55], v[88:91]
ds_read_b128 v[44:47], v21 offset:61440
v_mfma_f32_16x16x32_bf16 v[92:95], a[212:215], v[52:55], v[92:95]
s_waitcnt lgkmcnt(5)
v_mfma_f32_16x16x32_bf16 v[80:83], a[216:219], v[56:59], v[80:83]
ds_read_b128 v[48:51], v22 offset:57344
v_mfma_f32_16x16x32_bf16 v[84:87], a[220:223], v[56:59], v[84:87]
s_waitcnt lgkmcnt(5)
v_mfma_f32_16x16x32_bf16 v[88:91], a[216:219], v[60:63], v[88:91]
ds_read_b128 v[52:55], v22 offset:61440
v_mfma_f32_16x16x32_bf16 v[92:95], a[220:223], v[60:63], v[92:95]
s_waitcnt vmcnt(8)
s_barrier
s_waitcnt lgkmcnt(5)
v_mfma_f32_16x16x32_bf16 v[80:83], a[224:227], v[32:35], v[80:83]
ds_read_b128 v[56:59], v23 offset:57344
v_mfma_f32_16x16x32_bf16 v[84:87], a[228:231], v[32:35], v[84:87]
s_waitcnt lgkmcnt(5)
v_mfma_f32_16x16x32_bf16 v[88:91], a[224:227], v[36:39], v[88:91]
ds_read_b128 v[60:63], v23 offset:61440
v_mfma_f32_16x16x32_bf16 v[92:95], a[228:231], v[36:39], v[92:95]
s_add_u32 s23, s23, 131072
s_add_u32 m0, s21, 65536
s_xor_b32 s20, s23, 0
buffer_load_dwordx4 v6, s[8:11], s20 offen lds
s_waitcnt lgkmcnt(5)
v_mfma_f32_16x16x32_bf16 v[80:83], a[232:235], v[40:43], v[80:83]
ds_read_b128 v[32:35], v16
v_mfma_f32_16x16x32_bf16 v[84:87], a[236:239], v[40:43], v[84:87]
v_add_u32 v10, 1, v10
buffer_store_dword v10, v9, s[84:87], 0 offen sc1
s_waitcnt lgkmcnt(5)
v_mfma_f32_16x16x32_bf16 v[88:91], a[232:235], v[44:47], v[88:91]
ds_read_b128 v[36:39], v16 offset:4096
v_mfma_f32_16x16x32_bf16 v[92:95], a[236:239], v[44:47], v[92:95]
s_waitcnt lgkmcnt(5)
v_mfma_f32_16x16x32_bf16 v[80:83], a[240:243], v[48:51], v[80:83]
ds_read_b128 v[40:43], v17
v_mfma_f32_16x16x32_bf16 v[84:87], a[244:247], v[48:51], v[84:87]
s_add_u32 m0, s21, 66560
s_xor_b32 s20, s23, 0
buffer_load_dwordx4 v7, s[8:11], s20 offen lds
s_waitcnt lgkmcnt(5)
v_mfma_f32_16x16x32_bf16 v[88:91], a[240:243], v[52:55], v[88:91]
ds_read_b128 v[44:47], v17 offset:4096
v_mfma_f32_16x16x32_bf16 v[92:95], a[244:247], v[52:55], v[92:95]
s_waitcnt lgkmcnt(5)
v_mfma_f32_16x16x32_bf16 v[80:83], a[248:251], v[56:59], v[80:83]
ds_read_b128 v[48:51], v18
v_mfma_f32_16x16x32_bf16 v[84:87], a[252:255], v[56:59], v[84:87]
s_waitcnt lgkmcnt(5)
v_mfma_f32_16x16x32_bf16 v[88:91], a[248:251], v[60:63], v[88:91]
ds_read_b128 v[52:55], v18 offset:4096
v_mfma_f32_16x16x32_bf16 v[92:95], a[252:255], v[60:63], v[92:95]
s_add_u32 m0, s21, 73728
s_xor_b32 s20, s23, 256
buffer_load_dwordx4 v6, s[8:11], s20 offen lds
s_add_u32 s25, s25, 1
s_cmp_lt_u32 s25, 16
s_cbranch_scc1 L_q_qk_loop
s_nop 11
v_cvt_pk_bf16_f32 v96, v80, v81
v_cvt_pk_bf16_f32 v97, v82, v83
v_cvt_pk_bf16_f32 v98, v84, v85
v_cvt_pk_bf16_f32 v99, v86, v87
buffer_store_dwordx4 v[96:99], v8, s[84:87], s24 offen sc1
v_cvt_pk_bf16_f32 v100, v88, v89
v_cvt_pk_bf16_f32 v101, v90, v91
v_cvt_pk_bf16_f32 v102, v92, v93
v_cvt_pk_bf16_f32 v103, v94, v95
buffer_store_dwordx4 v[100:103], v8, s[84:87], s24 offen offset:1024 sc1
s_add_u32 s24, s24, 524288
s_waitcnt vmcnt(0) lgkmcnt(0)
s_barrier
v_add_u32 v10, 1, v10
buffer_store_dword v10, v9, s[84:87], 0 offen sc1
s_branch L_q_done
L_q_v:
ds_read_b128 v[32:35], v16
ds_read_b128 v[36:39], v16 offset:4096
ds_read_b128 v[40:43], v17
ds_read_b128 v[44:47], v17 offset:4096
ds_read_b128 v[48:51], v18
ds_read_b128 v[52:55], v18 offset:4096
s_mov_b32 s25, 0
L_q_v_loop:
s_waitcnt lgkmcnt(5)
v_mfma_f32_16x16x32_bf16 v[64:67], v[32:35], a[0:3], 0
ds_read_b128 v[56:59], v19
v_mfma_f32_16x16x32_bf16 v[68:71], v[32:35], a[4:7], 0
s_waitcnt lgkmcnt(5)
v_mfma_f32_16x16x32_bf16 v[72:75], v[36:39], a[0:3], 0
ds_read_b128 v[60:63], v19 offset:4096
v_mfma_f32_16x16x32_bf16 v[76:79], v[36:39], a[4:7], 0
s_waitcnt lgkmcnt(5)
v_mfma_f32_16x16x32_bf16 v[64:67], v[40:43], a[8:11], v[64:67]
ds_read_b128 v[32:35], v16 offset:8192
v_mfma_f32_16x16x32_bf16 v[68:71], v[40:43], a[12:15], v[68:71]
s_cmp_eq_u32 s25, 0
s_cbranch_scc1 L_q_v_sk2
s_add_u32 m0, s21, 74752
s_xor_b32 s20, s23, 256
buffer_load_dwordx4 v7, s[8:11], s20 offen lds
L_q_v_sk2:
s_waitcnt lgkmcnt(5)
v_mfma_f32_16x16x32_bf16 v[72:75], v[44:47], a[8:11], v[72:75]
ds_read_b128 v[36:39], v16 offset:12288
v_mfma_f32_16x16x32_bf16 v[76:79], v[44:47], a[12:15], v[76:79]
s_waitcnt lgkmcnt(5)
v_mfma_f32_16x16x32_bf16 v[64:67], v[48:51], a[16:19], v[64:67]
ds_read_b128 v[40:43], v17 offset:8192
v_mfma_f32_16x16x32_bf16 v[68:71], v[48:51], a[20:23], v[68:71]
s_waitcnt lgkmcnt(5)
v_mfma_f32_16x16x32_bf16 v[72:75], v[52:55], a[16:19], v[72:75]
ds_read_b128 v[44:47], v17 offset:12288
v_mfma_f32_16x16x32_bf16 v[76:79], v[52:55], a[20:23], v[76:79]
s_cmp_eq_u32 s25, 0
s_cbranch_scc1 L_q_v_sk5
s_add_u32 m0, s21, 81920
s_xor_b32 s20, s23, 512
buffer_load_dwordx4 v6, s[8:11], s20 offen lds
L_q_v_sk5:
s_waitcnt lgkmcnt(5)
v_mfma_f32_16x16x32_bf16 v[64:67], v[56:59], a[24:27], v[64:67]
ds_read_b128 v[48:51], v18 offset:8192
v_mfma_f32_16x16x32_bf16 v[68:71], v[56:59], a[28:31], v[68:71]
s_waitcnt lgkmcnt(5)
v_mfma_f32_16x16x32_bf16 v[72:75], v[60:63], a[24:27], v[72:75]
ds_read_b128 v[52:55], v18 offset:12288
v_mfma_f32_16x16x32_bf16 v[76:79], v[60:63], a[28:31], v[76:79]
s_waitcnt lgkmcnt(5)
v_mfma_f32_16x16x32_bf16 v[64:67], v[32:35], a[32:35], v[64:67]
ds_read_b128 v[56:59], v19 offset:8192
v_mfma_f32_16x16x32_bf16 v[68:71], v[32:35], a[36:39], v[68:71]
s_cmp_eq_u32 s25, 0
s_cbranch_scc1 L_q_v_sk8
s_add_u32 m0, s21, 82944
s_xor_b32 s20, s23, 512
buffer_load_dwordx4 v7, s[8:11], s20 offen lds
L_q_v_sk8:
s_waitcnt lgkmcnt(5)
v_mfma_f32_16x16x32_bf16 v[72:75], v[36:39], a[32:35], v[72:75]
ds_read_b128 v[60:63], v19 offset:12288
v_mfma_f32_16x16x32_bf16 v[76:79], v[36:39], a[36:39], v[76:79]
s_waitcnt lgkmcnt(5)
v_mfma_f32_16x16x32_bf16 v[64:67], v[40:43], a[40:43], v[64:67]
ds_read_b128 v[32:35], v16 offset:16384
v_mfma_f32_16x16x32_bf16 v[68:71], v[40:43], a[44:47], v[68:71]
s_waitcnt lgkmcnt(5)
v_mfma_f32_16x16x32_bf16 v[72:75], v[44:47], a[40:43], v[72:75]
ds_read_b128 v[36:39], v16 offset:20480
v_mfma_f32_16x16x32_bf16 v[76:79], v[44:47], a[44:47], v[76:79]
s_cmp_eq_u32 s25, 0
s_cbranch_scc1 L_q_v_sk11
s_add_u32 m0, s21, 90112
s_xor_b32 s20, s23, 768
buffer_load_dwordx4 v6, s[8:11], s20 offen lds
L_q_v_sk11:
s_waitcnt lgkmcnt(5)
v_mfma_f32_16x16x32_bf16 v[64:67], v[48:51], a[48:51], v[64:67]
ds_read_b128 v[40:43], v17 offset:16384
v_mfma_f32_16x16x32_bf16 v[68:71], v[48:51], a[52:55], v[68:71]
s_waitcnt lgkmcnt(5)
v_mfma_f32_16x16x32_bf16 v[72:75], v[52:55], a[48:51], v[72:75]
ds_read_b128 v[44:47], v17 offset:20480
v_mfma_f32_16x16x32_bf16 v[76:79], v[52:55], a[52:55], v[76:79]
s_waitcnt lgkmcnt(5)
v_mfma_f32_16x16x32_bf16 v[64:67], v[56:59], a[56:59], v[64:67]
ds_read_b128 v[48:51], v18 offset:16384
v_mfma_f32_16x16x32_bf16 v[68:71], v[56:59], a[60:63], v[68:71]
s_cmp_eq_u32 s25, 0
s_cbranch_scc1 L_q_v_sk14
s_add_u32 m0, s21, 91136
s_xor_b32 s20, s23, 768
buffer_load_dwordx4 v7, s[8:11], s20 offen lds
L_q_v_sk14:
s_waitcnt lgkmcnt(5)
v_mfma_f32_16x16x32_bf16 v[72:75], v[60:63], a[56:59], v[72:75]
ds_read_b128 v[52:55], v18 offset:20480
v_mfma_f32_16x16x32_bf16 v[76:79], v[60:63], a[60:63], v[76:79]
s_cmp_eq_u32 s25, 0
s_cbranch_scc1 L_q_v_ne0
v_cvt_pk_bf16_f32 v96, v80, v81
v_cvt_pk_bf16_f32 v97, v82, v83
L_q_v_ne0:
s_waitcnt lgkmcnt(5)
v_mfma_f32_16x16x32_bf16 v[64:67], v[32:35], a[64:67], v[64:67]
ds_read_b128 v[56:59], v19 offset:16384
v_mfma_f32_16x16x32_bf16 v[68:71], v[32:35], a[68:71], v[68:71]
s_cmp_eq_u32 s25, 0
s_cbranch_scc1 L_q_v_ne1
v_cvt_pk_bf16_f32 v98, v88, v89
v_cvt_pk_bf16_f32 v99, v90, v91
L_q_v_ne1:
s_waitcnt lgkmcnt(5)
v_mfma_f32_16x16x32_bf16 v[72:75], v[36:39], a[64:67], v[72:75]
ds_read_b128 v[60:63], v19 offset:20480
v_mfma_f32_16x16x32_bf16 v[76:79], v[36:39], a[68:71], v[76:79]
s_cmp_eq_u32 s25, 0
s_cbranch_scc1 L_q_v_ne2
buffer_store_dwordx4 v[96:99], v8, s[84:87], s24 offen sc1
v_cvt_pk_bf16_f32 v100, v84, v85
L_q_v_ne2:
s_waitcnt lgkmcnt(5)
v_mfma_f32_16x16x32_bf16 v[64:67], v[40:43], a[72:75], v[64:67]
ds_read_b128 v[32:35], v16 offset:24576
v_mfma_f32_16x16x32_bf16 v[68:71], v[40:43], a[76:79], v[68:71]
s_cmp_eq_u32 s25, 0
s_cbranch_scc1 L_q_v_ne3
v_cvt_pk_bf16_f32 v101, v86, v87
v_cvt_pk_bf16_f32 v102, v92, v93
L_q_v_ne3:
s_waitcnt lgkmcnt(5)
v_mfma_f32_16x16x32_bf16 v[72:75], v[44:47], a[72:75], v[72:75]
ds_read_b128 v[36:39], v16 offset:28672
v_mfma_f32_16x16x32_bf16 v[76:79], v[44:47], a[76:79], v[76:79]
s_cmp_eq_u32 s25, 0
s_cbranch_scc1 L_q_v_ne4
v_cvt_pk_bf16_f32 v103, v94, v95
buffer_store_dwordx4 v[100:103], v8, s[84:87], s24 offen offset:1024 sc1
L_q_v_ne4:
s_waitcnt lgkmcnt(5)
v_mfma_f32_16x16x32_bf16 v[64:67], v[48:51], a[80:83], v[64:67]
ds_read_b128 v[40:43], v17 offset:24576
v_mfma_f32_16x16x32_bf16 v[68:71], v[48:51], a[84:87], v[68:71]
s_cmp_eq_u32 s25, 0
s_cbranch_scc1 L_q_v_ne5
s_add_u32 s24, s24, 524288
L_q_v_ne5:
s_waitcnt lgkmcnt(5)
v_mfma_f32_16x16x32_bf16 v[72:75], v[52:55], a[80:83], v[72:75]
ds_read_b128 v[44:47], v17 offset:28672
v_mfma_f32_16x16x32_bf16 v[76:79], v[52:55], a[84:87], v[76:79]
s_waitcnt lgkmcnt(5)
v_mfma_f32_16x16x32_bf16 v[64:67], v[56:59], a[88:91], v[64:67]
ds_read_b128 v[48:51], v18 offset:24576
v_mfma_f32_16x16x32_bf16 v[68:71], v[56:59], a[92:95], v[68:71]
s_cmp_lg_u32 s25, 2
s_cbranch_scc1 L_q_v_nx
v_lshlrev_b32 v242, 7, v0
s_mul_i32 s46, s92, 32768
s_sub_u32 s46, s46, 2097152
buffer_load_dword v240, v242, s[8:11], s46 offen
L_q_v_nx:
s_waitcnt lgkmcnt(5)
v_mfma_f32_16x16x32_bf16 v[72:75], v[60:63], a[88:91], v[72:75]
ds_read_b128 v[52:55], v18 offset:28672
v_mfma_f32_16x16x32_bf16 v[76:79], v[60:63], a[92:95], v[76:79]
s_waitcnt vmcnt(8)
s_barrier
s_waitcnt lgkmcnt(5)
v_mfma_f32_16x16x32_bf16 v[64:67], v[32:35], a[96:99], v[64:67]
ds_read_b128 v[56:59], v19 offset:24576
v_mfma_f32_16x16x32_bf16 v[68:71], v[32:35], a[100:103], v[68:71]
s_waitcnt lgkmcnt(5)
v_mfma_f32_16x16x32_bf16 v[72:75], v[36:39], a[96:99], v[72:75]
ds_read_b128 v[60:63], v19 offset:28672
v_mfma_f32_16x16x32_bf16 v[76:79], v[36:39], a[100:103], v[76:79]
s_add_u32 m0, s21, 98304
s_xor_b32 s20, s23, 1024
buffer_load_dwordx4 v6, s[8:11], s20 offen lds
s_waitcnt lgkmcnt(5)
v_mfma_f32_16x16x32_bf16 v[64:67], v[40:43], a[104:107], v[64:67]
ds_read_b128 v[32:35], v16 offset:32768
v_mfma_f32_16x16x32_bf16 v[68:71], v[40:43], a[108:111], v[68:71]
s_waitcnt lgkmcnt(5)
v_mfma_f32_16x16x32_bf16 v[72:75], v[44:47], a[104:107], v[72:75]
ds_read_b128 v[36:39], v16 offset:36864
v_mfma_f32_16x16x32_bf16 v[76:79], v[44:47], a[108:111], v[76:79]
s_waitcnt lgkmcnt(5)
v_mfma_f32_16x16x32_bf16 v[64:67], v[48:51], a[112:115], v[64:67]
ds_read_b128 v[40:43], v17 offset:32768
v_mfma_f32_16x16x32_bf16 v[68:71], v[48:51], a[116:119], v[68:71]
s_add_u32 m0, s21, 99328
s_xor_b32 s20, s23, 1024
buffer_load_dwordx4 v7, s[8:11], s20 offen lds
s_waitcnt lgkmcnt(5)
v_mfma_f32_16x16x32_bf16 v[72:75], v[52:55], a[112:115], v[72:75]
ds_read_b128 v[44:47], v17 offset:36864
v_mfma_f32_16x16x32_bf16 v[76:79], v[52:55], a[116:119], v[76:79]
s_waitcnt lgkmcnt(5)
v_mfma_f32_16x16x32_bf16 v[64:67], v[56:59], a[120:123], v[64:67]
ds_read_b128 v[48:51], v18 offset:32768
v_mfma_f32_16x16x32_bf16 v[68:71], v[56:59], a[124:127], v[68:71]
s_waitcnt lgkmcnt(5)
v_mfma_f32_16x16x32_bf16 v[72:75], v[60:63], a[120:123], v[72:75]
ds_read_b128 v[52:55], v18 offset:36864
v_mfma_f32_16x16x32_bf16 v[76:79], v[60:63], a[124:127], v[76:79]
s_add_u32 m0, s21, 106496
s_xor_b32 s20, s23, 1280
buffer_load_dwordx4 v6, s[8:11], s20 offen lds
s_waitcnt lgkmcnt(5)
v_mfma_f32_16x16x32_bf16 v[64:67], v[32:35], a[128:131], v[64:67]
ds_read_b128 v[56:59], v19 offset:32768
v_mfma_f32_16x16x32_bf16 v[68:71], v[32:35], a[132:135], v[68:71]
s_waitcnt lgkmcnt(5)
v_mfma_f32_16x16x32_bf16 v[72:75], v[36:39], a[128:131], v[72:75]
ds_read_b128 v[60:63], v19 offset:36864
v_mfma_f32_16x16x32_bf16 v[76:79], v[36:39], a[132:135], v[76:79]
s_waitcnt lgkmcnt(5)
v_mfma_f32_16x16x32_bf16 v[64:67], v[40:43], a[136:139], v[64:67]
ds_read_b128 v[32:35], v16 offset:40960
v_mfma_f32_16x16x32_bf16 v[68:71], v[40:43], a[140:143], v[68:71]
s_add_u32 m0, s21, 107520
s_xor_b32 s20, s23, 1280
buffer_load_dwordx4 v7, s[8:11], s20 offen lds
s_waitcnt lgkmcnt(5)
v_mfma_f32_16x16x32_bf16 v[72:75], v[44:47], a[136:139], v[72:75]
ds_read_b128 v[36:39], v16 offset:45056
v_mfma_f32_16x16x32_bf16 v[76:79], v[44:47], a[140:143], v[76:79]
s_waitcnt lgkmcnt(5)
v_mfma_f32_16x16x32_bf16 v[64:67], v[48:51], a[144:147], v[64:67]
ds_read_b128 v[40:43], v17 offset:40960
v_mfma_f32_16x16x32_bf16 v[68:71], v[48:51], a[148:151], v[68:71]
s_waitcnt lgkmcnt(5)
v_mfma_f32_16x16x32_bf16 v[72:75], v[52:55], a[144:147], v[72:75]
ds_read_b128 v[44:47], v17 offset:45056
v_mfma_f32_16x16x32_bf16 v[76:79], v[52:55], a[148:151], v[76:79]
s_add_u32 m0, s21, 114688
s_xor_b32 s20, s23, 1536
buffer_load_dwordx4 v6, s[8:11], s20 offen lds
s_waitcnt lgkmcnt(5)
v_mfma_f32_16x16x32_bf16 v[64:67], v[56:59], a[152:155], v[64:67]
ds_read_b128 v[48:51], v18 offset:40960
v_mfma_f32_16x16x32_bf16 v[68:71], v[56:59], a[156:159], v[68:71]
s_waitcnt lgkmcnt(5)
v_mfma_f32_16x16x32_bf16 v[72:75], v[60:63], a[152:155], v[72:75]
ds_read_b128 v[52:55], v18 offset:45056
v_mfma_f32_16x16x32_bf16 v[76:79], v[60:63], a[156:159], v[76:79]
s_waitcnt lgkmcnt(5)
v_mfma_f32_16x16x32_bf16 v[64:67], v[32:35], a[160:163], v[64:67]
ds_read_b128 v[56:59], v19 offset:40960
v_mfma_f32_16x16x32_bf16 v[68:71], v[32:35], a[164:167], v[68:71]
s_add_u32 m0, s21, 115712
s_xor_b32 s20, s23, 1536
buffer_load_dwordx4 v7, s[8:11], s20 offen lds
s_waitcnt lgkmcnt(5)
v_mfma_f32_16x16x32_bf16 v[72:75], v[36:39], a[160:163], v[72:75]
ds_read_b128 v[60:63], v19 offset:45056
v_mfma_f32_16x16x32_bf16 v[76:79], v[36:39], a[164:167], v[76:79]
s_waitcnt lgkmcnt(5)
v_mfma_f32_16x16x32_bf16 v[64:67], v[40:43], a[168:171], v[64:67]
ds_read_b128 v[32:35], v16 offset:49152
v_mfma_f32_16x16x32_bf16 v[68:71], v[40:43], a[172:175], v[68:71]
s_waitcnt lgkmcnt(5)
v_mfma_f32_16x16x32_bf16 v[72:75], v[44:47], a[168:171], v[72:75]
ds_read_b128 v[36:39], v16 offset:53248
v_mfma_f32_16x16x32_bf16 v[76:79], v[44:47], a[172:175], v[76:79]
s_add_u32 m0, s21, 122880
s_xor_b32 s20, s23, 1792
buffer_load_dwordx4 v6, s[8:11], s20 offen lds
s_waitcnt lgkmcnt(5)
v_mfma_f32_16x16x32_bf16 v[64:67], v[48:51], a[176:179], v[64:67]
ds_read_b128 v[40:43], v17 offset:49152
v_mfma_f32_16x16x32_bf16 v[68:71], v[48:51], a[180:183], v[68:71]
s_waitcnt lgkmcnt(5)
v_mfma_f32_16x16x32_bf16 v[72:75], v[52:55], a[176:179], v[72:75]
ds_read_b128 v[44:47], v17 offset:53248
v_mfma_f32_16x16x32_bf16 v[76:79], v[52:55], a[180:183], v[76:79]
s_waitcnt lgkmcnt(5)
v_mfma_f32_16x16x32_bf16 v[64:67], v[56:59], a[184:187], v[64:67]
ds_read_b128 v[48:51], v18 offset:49152
v_mfma_f32_16x16x32_bf16 v[68:71], v[56:59], a[188:191], v[68:71]
s_add_u32 m0, s21, 123904
s_xor_b32 s20, s23, 1792
buffer_load_dwordx4 v7, s[8:11], s20 offen lds
s_waitcnt lgkmcnt(5)
v_mfma_f32_16x16x32_bf16 v[72:75], v[60:63], a[184:187], v[72:75]
ds_read_b128 v[52:55], v18 offset:53248
v_mfma_f32_16x16x32_bf16 v[76:79], v[60:63], a[188:191], v[76:79]
s_waitcnt lgkmcnt(5)
v_mfma_f32_16x16x32_bf16 v[64:67], v[32:35], a[192:195], v[64:67]
ds_read_b128 v[56:59], v19 offset:49152
v_mfma_f32_16x16x32_bf16 v[68:71], v[32:35], a[196:199], v[68:71]
s_waitcnt lgkmcnt(5)
v_mfma_f32_16x16x32_bf16 v[72:75], v[36:39], a[192:195], v[72:75]
ds_read_b128 v[60:63], v19 offset:53248
v_mfma_f32_16x16x32_bf16 v[76:79], v[36:39], a[196:199], v[76:79]
s_waitcnt lgkmcnt(5)
v_mfma_f32_16x16x32_bf16 v[64:67], v[40:43], a[200:203], v[64:67]
ds_read_b128 v[32:35], v16 offset:57344
v_mfma_f32_16x16x32_bf16 v[68:71], v[40:43], a[204:207], v[68:71]
s_waitcnt lgkmcnt(5)
v_mfma_f32_16x16x32_bf16 v[72:75], v[44:47], a[200:203], v[72:75]
ds_read_b128 v[36:39], v16 offset:61440
v_mfma_f32_16x16x32_bf16 v[76:79], v[44:47], a[204:207], v[76:79]
s_waitcnt lgkmcnt(5)
v_mfma_f32_16x16x32_bf16 v[64:67], v[48:51], a[208:211], v[64:67]
ds_read_b128 v[40:43], v17 offset:57344
v_mfma_f32_16x16x32_bf16 v[68:71], v[48:51], a[212:215], v[68:71]
s_waitcnt lgkmcnt(5)
v_mfma_f32_16x16x32_bf16 v[72:75], v[52:55], a[208:211], v[72:75]
ds_read_b128 v[44:47], v17 offset:61440
v_mfma_f32_16x16x32_bf16 v[76:79], v[52:55], a[212:215], v[76:79]
s_waitcnt lgkmcnt(5)
v_mfma_f32_16x16x32_bf16 v[64:67], v[56:59], a[216:219], v[64:67]
ds_read_b128 v[48:51], v18 offset:57344
v_mfma_f32_16x16x32_bf16 v[68:71], v[56:59], a[220:223], v[68:71]
s_waitcnt lgkmcnt(5)
v_mfma_f32_16x16x32_bf16 v[72:75], v[60:63], a[216:219], v[72:75]
ds_read_b128 v[52:55], v18 offset:61440
v_mfma_f32_16x16x32_bf16 v[76:79], v[60:63], a[220:223], v[76:79]
s_waitcnt vmcnt(8)
s_barrier
s_waitcnt lgkmcnt(5)
v_mfma_f32_16x16x32_bf16 v[64:67], v[32:35], a[224:227], v[64:67]
ds_read_b128 v[56:59], v19 offset:57344
v_mfma_f32_16x16x32_bf16 v[68:71], v[32:35], a[228:231], v[68:71]
s_waitcnt lgkmcnt(5)
v_mfma_f32_16x16x32_bf16 v[72:75], v[36:39], a[224:227], v[72:75]
ds_read_b128 v[60:63], v19 offset:61440
v_mfma_f32_16x16x32_bf16 v[76:79], v[36:39], a[228:231], v[76:79]
s_add_u32 s23, s23, 131072
s_add_u32 m0, s21, 0
s_xor_b32 s20, s23, 0
buffer_load_dwordx4 v6, s[8:11], s20 offen lds
s_waitcnt lgkmcnt(5)
v_mfma_f32_16x16x32_bf16 v[64:67], v[40:43], a[232:235], v[64:67]
ds_read_b128 v[32:35], v20
v_mfma_f32_16x16x32_bf16 v[68:71], v[40:43], a[236:239], v[68:71]
s_cmp_eq_u32 s25, 0
s_cbranch_scc1 L_q_v_nf
v_add_u32 v10, 1, v10
buffer_store_dword v10, v9, s[84:87], 0 offen sc1
L_q_v_nf:
s_waitcnt lgkmcnt(5)
v_mfma_f32_16x16x32_bf16 v[72:75], v[44:47], a[232:235], v[72:75]
ds_read_b128 v[36:39], v20 offset:4096
v_mfma_f32_16x16x32_bf16 v[76:79], v[44:47], a[236:239], v[76:79]
s_waitcnt lgkmcnt(5)
v_mfma_f32_16x16x32_bf16 v[64:67], v[48:51], a[240:243], v[64:67]
ds_read_b128 v[40:43], v21
v_mfma_f32_16x16x32_bf16 v[68:71], v[48:51], a[244:247], v[68:71]
s_add_u32 m0, s21, 1024
s_xor_b32 s20, s23, 0
buffer_load_dwordx4 v7, s[8:11], s20 offen lds
s_waitcnt lgkmcnt(5)
v_mfma_f32_16x16x32_bf16 v[72:75], v[52:55], a[240:243], v[72:75]
ds_read_b128 v[44:47], v21 offset:4096
v_mfma_f32_16x16x32_bf16 v[76:79], v[52:55], a[244:247], v[76:79]
s_waitcnt lgkmcnt(5)
v_mfma_f32_16x16x32_bf16 v[64:67], v[56:59], a[248:251], v[64:67]
ds_read_b128 v[48:51], v22
v_mfma_f32_16x16x32_bf16 v[68:71], v[56:59], a[252:255], v[68:71]
s_waitcnt lgkmcnt(5)
v_mfma_f32_16x16x32_bf16 v[72:75], v[60:63], a[248:251], v[72:75]
ds_read_b128 v[52:55], v22 offset:4096
v_mfma_f32_16x16x32_bf16 v[76:79], v[60:63], a[252:255], v[76:79]
s_add_u32 m0, s21, 8192
s_xor_b32 s20, s23, 256
buffer_load_dwordx4 v6, s[8:11], s20 offen lds
s_waitcnt lgkmcnt(5)
v_mfma_f32_16x16x32_bf16 v[80:83], v[32:35], a[0:3], 0
ds_read_b128 v[56:59], v23
v_mfma_f32_16x16x32_bf16 v[84:87], v[32:35], a[4:7], 0
s_waitcnt lgkmcnt(5)
v_mfma_f32_16x16x32_bf16 v[88:91], v[36:39], a[0:3], 0
ds_read_b128 v[60:63], v23 offset:4096
v_mfma_f32_16x16x32_bf16 v[92:95], v[36:39], a[4:7], 0
s_waitcnt lgkmcnt(5)
v_mfma_f32_16x16x32_bf16 v[80:83], v[40:43], a[8:11], v[80:83]
ds_read_b128 v[32:35], v20 offset:8192
v_mfma_f32_16x16x32_bf16 v[84:87], v[40:43], a[12:15], v[84:87]
s_add_u32 m0, s21, 9216
s_xor_b32 s20, s23, 256
buffer_load_dwordx4 v7, s[8:11], s20 offen lds
s_waitcnt lgkmcnt(5)
v_mfma_f32_16x16x32_bf16 v[88:91], v[44:47], a[8:11], v[88:91]
ds_read_b128 v[36:39], v20 offset:12288
v_mfma_f32_16x16x32_bf16 v[92:95], v[44:47], a[12:15], v[92:95]
s_waitcnt lgkmcnt(5)
v_mfma_f32_16x16x32_bf16 v[80:83], v[48:51], a[16:19], v[80:83]
ds_read_b128 v[40:43], v21 offset:8192
v_mfma_f32_16x16x32_bf16 v[84:87], v[48:51], a[20:23], v[84:87]
s_waitcnt lgkmcnt(5)
v_mfma_f32_16x16x32_bf16 v[88:91], v[52:55], a[16:19], v[88:91]
ds_read_b128 v[44:47], v21 offset:12288
v_mfma_f32_16x16x32_bf16 v[92:95], v[52:55], a[20:23], v[92:95]
s_add_u32 m0, s21, 16384
s_xor_b32 s20, s23, 512
buffer_load_dwordx4 v6, s[8:11], s20 offen lds
s_waitcnt lgkmcnt(5)
v_mfma_f32_16x16x32_bf16 v[80:83], v[56:59], a[24:27], v[80:83]
ds_read_b128 v[48:51], v22 offset:8192
v_mfma_f32_16x16x32_bf16 v[84:87], v[56:59], a[28:31], v[84:87]
s_waitcnt lgkmcnt(5)
v_mfma_f32_16x16x32_bf16 v[88:91], v[60:63], a[24:27], v[88:91]
ds_read_b128 v[52:55], v22 offset:12288
v_mfma_f32_16x16x32_bf16 v[92:95], v[60:63], a[28:31], v[92:95]
s_waitcnt lgkmcnt(5)
v_mfma_f32_16x16x32_bf16 v[80:83], v[32:35], a[32:35], v[80:83]
ds_read_b128 v[56:59], v23 offset:8192
v_mfma_f32_16x16x32_bf16 v[84:87], v[32:35], a[36:39], v[84:87]
s_add_u32 m0, s21, 17408
s_xor_b32 s20, s23, 512
buffer_load_dwordx4 v7, s[8:11], s20 offen lds
s_waitcnt lgkmcnt(5)
v_mfma_f32_16x16x32_bf16 v[88:91], v[36:39], a[32:35], v[88:91]
ds_read_b128 v[60:63], v23 offset:12288
v_mfma_f32_16x16x32_bf16 v[92:95], v[36:39], a[36:39], v[92:95]
s_waitcnt lgkmcnt(5)
v_mfma_f32_16x16x32_bf16 v[80:83], v[40:43], a[40:43], v[80:83]
ds_read_b128 v[32:35], v20 offset:16384
v_mfma_f32_16x16x32_bf16 v[84:87], v[40:43], a[44:47], v[84:87]
s_waitcnt lgkmcnt(5)
v_mfma_f32_16x16x32_bf16 v[88:91], v[44:47], a[40:43], v[88:91]
ds_read_b128 v[36:39], v20 offset:20480
v_mfma_f32_16x16x32_bf16 v[92:95], v[44:47], a[44:47], v[92:95]
s_add_u32 m0, s21, 24576
s_xor_b32 s20, s23, 768
buffer_load_dwordx4 v6, s[8:11], s20 offen lds
s_waitcnt lgkmcnt(5)
v_mfma_f32_16x16x32_bf16 v[80:83], v[48:51], a[48:51], v[80:83]
ds_read_b128 v[40:43], v21 offset:16384
v_mfma_f32_16x16x32_bf16 v[84:87], v[48:51], a[52:55], v[84:87]
s_waitcnt lgkmcnt(5)
v_mfma_f32_16x16x32_bf16 v[88:91], v[52:55], a[48:51], v[88:91]
ds_read_b128 v[44:47], v21 offset:20480
v_mfma_f32_16x16x32_bf16 v[92:95], v[52:55], a[52:55], v[92:95]
s_waitcnt lgkmcnt(5)
v_mfma_f32_16x16x32_bf16 v[80:83], v[56:59], a[56:59], v[80:83]
ds_read_b128 v[48:51], v22 offset:16384
v_mfma_f32_16x16x32_bf16 v[84:87], v[56:59], a[60:63], v[84:87]
s_add_u32 m0, s21, 25600
s_xor_b32 s20, s23, 768
buffer_load_dwordx4 v7, s[8:11], s20 offen lds
s_waitcnt lgkmcnt(5)
v_mfma_f32_16x16x32_bf16 v[88:91], v[60:63], a[56:59], v[88:91]
ds_read_b128 v[52:55], v22 offset:20480
v_mfma_f32_16x16x32_bf16 v[92:95], v[60:63], a[60:63], v[92:95]
v_cvt_pk_bf16_f32 v96, v64, v65
v_cvt_pk_bf16_f32 v97, v66, v67
s_waitcnt lgkmcnt(5)
v_mfma_f32_16x16x32_bf16 v[80:83], v[32:35], a[64:67], v[80:83]
ds_read_b128 v[56:59], v23 offset:16384
v_mfma_f32_16x16x32_bf16 v[84:87], v[32:35], a[68:71], v[84:87]
v_cvt_pk_bf16_f32 v98, v72, v73
v_cvt_pk_bf16_f32 v99, v74, v75
s_waitcnt lgkmcnt(5)
v_mfma_f32_16x16x32_bf16 v[88:91], v[36:39], a[64:67], v[88:91]
ds_read_b128 v[60:63], v23 offset:20480
v_mfma_f32_16x16x32_bf16 v[92:95], v[36:39], a[68:71], v[92:95]
buffer_store_dwordx4 v[96:99], v8, s[84:87], s24 offen sc1
v_cvt_pk_bf16_f32 v100, v68, v69
s_waitcnt lgkmcnt(5)
v_mfma_f32_16x16x32_bf16 v[80:83], v[40:43], a[72:75], v[80:83]
ds_read_b128 v[32:35], v20 offset:24576
v_mfma_f32_16x16x32_bf16 v[84:87], v[40:43], a[76:79], v[84:87]
v_cvt_pk_bf16_f32 v101, v70, v71
v_cvt_pk_bf16_f32 v102, v76, v77
s_waitcnt lgkmcnt(5)
v_mfma_f32_16x16x32_bf16 v[88:91], v[44:47], a[72:75], v[88:91]
ds_read_b128 v[36:39], v20 offset:28672
v_mfma_f32_16x16x32_bf16 v[92:95], v[44:47], a[76:79], v[92:95]
v_cvt_pk_bf16_f32 v103, v78, v79
buffer_store_dwordx4 v[100:103], v8, s[84:87], s24 offen offset:1024 sc1
s_waitcnt lgkmcnt(5)
v_mfma_f32_16x16x32_bf16 v[80:83], v[48:51], a[80:83], v[80:83]
ds_read_b128 v[40:43], v21 offset:24576
v_mfma_f32_16x16x32_bf16 v[84:87], v[48:51], a[84:87], v[84:87]
s_add_u32 s24, s24, 524288
s_waitcnt lgkmcnt(5)
v_mfma_f32_16x16x32_bf16 v[88:91], v[52:55], a[80:83], v[88:91]
ds_read_b128 v[44:47], v21 offset:28672
v_mfma_f32_16x16x32_bf16 v[92:95], v[52:55], a[84:87], v[92:95]
s_waitcnt lgkmcnt(5)
v_mfma_f32_16x16x32_bf16 v[80:83], v[56:59], a[88:91], v[80:83]
ds_read_b128 v[48:51], v22 offset:24576
v_mfma_f32_16x16x32_bf16 v[84:87], v[56:59], a[92:95], v[84:87]
s_waitcnt lgkmcnt(5)
v_mfma_f32_16x16x32_bf16 v[88:91], v[60:63], a[88:91], v[88:91]
ds_read_b128 v[52:55], v22 offset:28672
v_mfma_f32_16x16x32_bf16 v[92:95], v[60:63], a[92:95], v[92:95]
s_waitcnt vmcnt(8)
s_barrier
s_waitcnt lgkmcnt(5)
v_mfma_f32_16x16x32_bf16 v[80:83], v[32:35], a[96:99], v[80:83]
ds_read_b128 v[56:59], v23 offset:24576
v_mfma_f32_16x16x32_bf16 v[84:87], v[32:35], a[100:103], v[84:87]
s_waitcnt lgkmcnt(5)
v_mfma_f32_16x16x32_bf16 v[88:91], v[36:39], a[96:99], v[88:91]
ds_read_b128 v[60:63], v23 offset:28672
v_mfma_f32_16x16x32_bf16 v[92:95], v[36:39], a[100:103], v[92:95]
s_add_u32 m0, s21, 32768
s_xor_b32 s20, s23, 1024
buffer_load_dwordx4 v6, s[8:11], s20 offen lds
s_waitcnt lgkmcnt(5)
v_mfma_f32_16x16x32_bf16 v[80:83], v[40:43], a[104:107], v[80:83]
ds_read_b128 v[32:35], v20 offset:32768
v_mfma_f32_16x16x32_bf16 v[84:87], v[40:43], a[108:111], v[84:87]
s_waitcnt lgkmcnt(5)
v_mfma_f32_16x16x32_bf16 v[88:91], v[44:47], a[104:107], v[88:91]
ds_read_b128 v[36:39], v20 offset:36864
v_mfma_f32_16x16x32_bf16 v[92:95], v[44:47], a[108:111], v[92:95]
s_waitcnt lgkmcnt(5)
v_mfma_f32_16x16x32_bf16 v[80:83], v[48:51], a[112:115], v[80:83]
ds_read_b128 v[40:43], v21 offset:32768
v_mfma_f32_16x16x32_bf16 v[84:87], v[48:51], a[116:119], v[84:87]
s_add_u32 m0, s21, 33792
s_xor_b32 s20, s23, 1024
buffer_load_dwordx4 v7, s[8:11], s20 offen lds
s_waitcnt lgkmcnt(5)
v_mfma_f32_16x16x32_bf16 v[88:91], v[52:55], a[112:115], v[88:91]
ds_read_b128 v[44:47], v21 offset:36864
v_mfma_f32_16x16x32_bf16 v[92:95], v[52:55], a[116:119], v[92:95]
s_waitcnt lgkmcnt(5)
v_mfma_f32_16x16x32_bf16 v[80:83], v[56:59], a[120:123], v[80:83]
ds_read_b128 v[48:51], v22 offset:32768
v_mfma_f32_16x16x32_bf16 v[84:87], v[56:59], a[124:127], v[84:87]
s_waitcnt lgkmcnt(5)
v_mfma_f32_16x16x32_bf16 v[88:91], v[60:63], a[120:123], v[88:91]
ds_read_b128 v[52:55], v22 offset:36864
v_mfma_f32_16x16x32_bf16 v[92:95], v[60:63], a[124:127], v[92:95]
s_add_u32 m0, s21, 40960
s_xor_b32 s20, s23, 1280
buffer_load_dwordx4 v6, s[8:11], s20 offen lds
s_waitcnt lgkmcnt(5)
v_mfma_f32_16x16x32_bf16 v[80:83], v[32:35], a[128:131], v[80:83]
ds_read_b128 v[56:59], v23 offset:32768
v_mfma_f32_16x16x32_bf16 v[84:87], v[32:35], a[132:135], v[84:87]
s_waitcnt lgkmcnt(5)
v_mfma_f32_16x16x32_bf16 v[88:91], v[36:39], a[128:131], v[88:91]
ds_read_b128 v[60:63], v23 offset:36864
v_mfma_f32_16x16x32_bf16 v[92:95], v[36:39], a[132:135], v[92:95]
s_waitcnt lgkmcnt(5)
v_mfma_f32_16x16x32_bf16 v[80:83], v[40:43], a[136:139], v[80:83]
ds_read_b128 v[32:35], v20 offset:40960
v_mfma_f32_16x16x32_bf16 v[84:87], v[40:43], a[140:143], v[84:87]
s_add_u32 m0, s21, 41984
s_xor_b32 s20, s23, 1280
buffer_load_dwordx4 v7, s[8:11], s20 offen lds
s_waitcnt lgkmcnt(5)
v_mfma_f32_16x16x32_bf16 v[88:91], v[44:47], a[136:139], v[88:91]
ds_read_b128 v[36:39], v20 offset:45056
v_mfma_f32_16x16x32_bf16 v[92:95], v[44:47], a[140:143], v[92:95]
s_waitcnt lgkmcnt(5)
v_mfma_f32_16x16x32_bf16 v[80:83], v[48:51], a[144:147], v[80:83]
ds_read_b128 v[40:43], v21 offset:40960
v_mfma_f32_16x16x32_bf16 v[84:87], v[48:51], a[148:151], v[84:87]
s_waitcnt lgkmcnt(5)
v_mfma_f32_16x16x32_bf16 v[88:91], v[52:55], a[144:147], v[88:91]
ds_read_b128 v[44:47], v21 offset:45056
v_mfma_f32_16x16x32_bf16 v[92:95], v[52:55], a[148:151], v[92:95]
s_add_u32 m0, s21, 49152
s_xor_b32 s20, s23, 1536
buffer_load_dwordx4 v6, s[8:11], s20 offen lds
s_waitcnt lgkmcnt(5)
v_mfma_f32_16x16x32_bf16 v[80:83], v[56:59], a[152:155], v[80:83]
ds_read_b128 v[48:51], v22 offset:40960
v_mfma_f32_16x16x32_bf16 v[84:87], v[56:59], a[156:159], v[84:87]
s_waitcnt lgkmcnt(5)
v_mfma_f32_16x16x32_bf16 v[88:91], v[60:63], a[152:155], v[88:91]
ds_read_b128 v[52:55], v22 offset:45056
v_mfma_f32_16x16x32_bf16 v[92:95], v[60:63], a[156:159], v[92:95]
s_waitcnt lgkmcnt(5)
v_mfma_f32_16x16x32_bf16 v[80:83], v[32:35], a[160:163], v[80:83]
ds_read_b128 v[56:59], v23 offset:40960
v_mfma_f32_16x16x32_bf16 v[84:87], v[32:35], a[164:167], v[84:87]
s_add_u32 m0, s21, 50176
s_xor_b32 s20, s23, 1536
buffer_load_dwordx4 v7, s[8:11], s20 offen lds
s_waitcnt lgkmcnt(5)
v_mfma_f32_16x16x32_bf16 v[88:91], v[36:39], a[160:163], v[88:91]
ds_read_b128 v[60:63], v23 offset:45056
v_mfma_f32_16x16x32_bf16 v[92:95], v[36:39], a[164:167], v[92:95]
s_waitcnt lgkmcnt(5)
v_mfma_f32_16x16x32_bf16 v[80:83], v[40:43], a[168:171], v[80:83]
ds_read_b128 v[32:35], v20 offset:49152
v_mfma_f32_16x16x32_bf16 v[84:87], v[40:43], a[172:175], v[84:87]
s_waitcnt lgkmcnt(5)
v_mfma_f32_16x16x32_bf16 v[88:91], v[44:47], a[168:171], v[88:91]
ds_read_b128 v[36:39], v20 offset:53248
v_mfma_f32_16x16x32_bf16 v[92:95], v[44:47], a[172:175], v[92:95]
s_add_u32 m0, s21, 57344
s_xor_b32 s20, s23, 1792
buffer_load_dwordx4 v6, s[8:11], s20 offen lds
s_waitcnt lgkmcnt(5)
v_mfma_f32_16x16x32_bf16 v[80:83], v[48:51], a[176:179], v[80:83]
ds_read_b128 v[40:43], v21 offset:49152
v_mfma_f32_16x16x32_bf16 v[84:87], v[48:51], a[180:183], v[84:87]
s_waitcnt lgkmcnt(5)
v_mfma_f32_16x16x32_bf16 v[88:91], v[52:55], a[176:179], v[88:91]
ds_read_b128 v[44:47], v21 offset:53248
v_mfma_f32_16x16x32_bf16 v[92:95], v[52:55], a[180:183], v[92:95]
s_waitcnt lgkmcnt(5)
v_mfma_f32_16x16x32_bf16 v[80:83], v[56:59], a[184:187], v[80:83]
ds_read_b128 v[48:51], v22 offset:49152
v_mfma_f32_16x16x32_bf16 v[84:87], v[56:59], a[188:191], v[84:87]
s_add_u32 m0, s21, 58368
s_xor_b32 s20, s23, 1792
buffer_load_dwordx4 v7, s[8:11], s20 offen lds
s_waitcnt lgkmcnt(5)
v_mfma_f32_16x16x32_bf16 v[88:91], v[60:63], a[184:187], v[88:91]
ds_read_b128 v[52:55], v22 offset:53248
v_mfma_f32_16x16x32_bf16 v[92:95], v[60:63], a[188:191], v[92:95]
s_waitcnt lgkmcnt(5)
v_mfma_f32_16x16x32_bf16 v[80:83], v[32:35], a[192:195], v[80:83]
ds_read_b128 v[56:59], v23 offset:49152
v_mfma_f32_16x16x32_bf16 v[84:87], v[32:35], a[196:199], v[84:87]
s_waitcnt lgkmcnt(5)
v_mfma_f32_16x16x32_bf16 v[88:91], v[36:39], a[192:195], v[88:91]
ds_read_b128 v[60:63], v23 offset:53248
v_mfma_f32_16x16x32_bf16 v[92:95], v[36:39], a[196:199], v[92:95]
s_waitcnt lgkmcnt(5)
v_mfma_f32_16x16x32_bf16 v[80:83], v[40:43], a[200:203], v[80:83]
ds_read_b128 v[32:35], v20 offset:57344
v_mfma_f32_16x16x32_bf16 v[84:87], v[40:43], a[204:207], v[84:87]
s_waitcnt lgkmcnt(5)
v_mfma_f32_16x16x32_bf16 v[88:91], v[44:47], a[200:203], v[88:91]
ds_read_b128 v[36:39], v20 offset:61440
v_mfma_f32_16x16x32_bf16 v[92:95], v[44:47], a[204:207], v[92:95]
s_waitcnt lgkmcnt(5)
v_mfma_f32_16x16x32_bf16 v[80:83], v[48:51], a[208:211], v[80:83]
ds_read_b128 v[40:43], v21 offset:57344
v_mfma_f32_16x16x32_bf16 v[84:87], v[48:51], a[212:215], v[84:87]
s_waitcnt lgkmcnt(5)
v_mfma_f32_16x16x32_bf16 v[88:91], v[52:55], a[208:211], v[88:91]
ds_read_b128 v[44:47], v21 offset:61440
v_mfma_f32_16x16x32_bf16 v[92:95], v[52:55], a[212:215], v[92:95]
s_waitcnt lgkmcnt(5)
v_mfma_f32_16x16x32_bf16 v[80:83], v[56:59], a[216:219], v[80:83]
ds_read_b128 v[48:51], v22 offset:57344
v_mfma_f32_16x16x32_bf16 v[84:87], v[56:59], a[220:223], v[84:87]
s_waitcnt lgkmcnt(5)
v_mfma_f32_16x16x32_bf16 v[88:91], v[60:63], a[216:219], v[88:91]
ds_read_b128 v[52:55], v22 offset:61440
v_mfma_f32_16x16x32_bf16 v[92:95], v[60:63], a[220:223], v[92:95]
s_waitcnt vmcnt(8)
s_barrier
s_waitcnt lgkmcnt(5)
v_mfma_f32_16x16x32_bf16 v[80:83], v[32:35], a[224:227], v[80:83]
ds_read_b128 v[56:59], v23 offset:57344
v_mfma_f32_16x16x32_bf16 v[84:87], v[32:35], a[228:231], v[84:87]
s_waitcnt lgkmcnt(5)
v_mfma_f32_16x16x32_bf16 v[88:91], v[36:39], a[224:227], v[88:91]
ds_read_b128 v[60:63], v23 offset:61440
v_mfma_f32_16x16x32_bf16 v[92:95], v[36:39], a[228:231], v[92:95]
s_add_u32 s23, s23, 131072
s_add_u32 m0, s21, 65536
s_xor_b32 s20, s23, 0
buffer_load_dwordx4 v6, s[8:11], s20 offen lds
s_waitcnt lgkmcnt(5)
v_mfma_f32_16x16x32_bf16 v[80:83], v[40:43], a[232:235], v[80:83]
ds_read_b128 v[32:35], v16
v_mfma_f32_16x16x32_bf16 v[84:87], v[40:43], a[236:239], v[84:87]
v_add_u32 v10, 1, v10
buffer_store_dword v10, v9, s[84:87], 0 offen sc1
s_waitcnt lgkmcnt(5)
v_mfma_f32_16x16x32_bf16 v[88:91], v[44:47], a[232:235], v[88:91]
ds_read_b128 v[36:39], v16 offset:4096
v_mfma_f32_16x16x32_bf16 v[92:95], v[44:47], a[236:239], v[92:95]
s_waitcnt lgkmcnt(5)
v_mfma_f32_16x16x32_bf16 v[80:83], v[48:51], a[240:243], v[80:83]
ds_read_b128 v[40:43], v17
v_mfma_f32_16x16x32_bf16 v[84:87], v[48:51], a[244:247], v[84:87]
s_add_u32 m0, s21, 66560
s_xor_b32 s20, s23, 0
buffer_load_dwordx4 v7, s[8:11], s20 offen lds
s_waitcnt lgkmcnt(5)
v_mfma_f32_16x16x32_bf16 v[88:91], v[52:55], a[240:243], v[88:91]
ds_read_b128 v[44:47], v17 offset:4096
v_mfma_f32_16x16x32_bf16 v[92:95], v[52:55], a[244:247], v[92:95]
s_waitcnt lgkmcnt(5)
v_mfma_f32_16x16x32_bf16 v[80:83], v[56:59], a[248:251], v[80:83]
ds_read_b128 v[48:51], v18
v_mfma_f32_16x16x32_bf16 v[84:87], v[56:59], a[252:255], v[84:87]
s_waitcnt lgkmcnt(5)
v_mfma_f32_16x16x32_bf16 v[88:91], v[60:63], a[248:251], v[88:91]
ds_read_b128 v[52:55], v18 offset:4096
v_mfma_f32_16x16x32_bf16 v[92:95], v[60:63], a[252:255], v[92:95]
s_add_u32 m0, s21, 73728
s_xor_b32 s20, s23, 256
buffer_load_dwordx4 v6, s[8:11], s20 offen lds
s_add_u32 s25, s25, 1
s_cmp_lt_u32 s25, 16
s_cbranch_scc1 L_q_v_loop
s_nop 11
v_cvt_pk_bf16_f32 v96, v80, v81
v_cvt_pk_bf16_f32 v97, v82, v83
v_cvt_pk_bf16_f32 v98, v88, v89
v_cvt_pk_bf16_f32 v99, v90, v91
buffer_store_dwordx4 v[96:99], v8, s[84:87], s24 offen sc1
v_cvt_pk_bf16_f32 v100, v84, v85
v_cvt_pk_bf16_f32 v101, v86, v87
v_cvt_pk_bf16_f32 v102, v92, v93
v_cvt_pk_bf16_f32 v103, v94, v95
buffer_store_dwordx4 v[100:103], v8, s[84:87], s24 offen offset:1024 sc1
s_add_u32 s24, s24, 524288
s_waitcnt vmcnt(0) lgkmcnt(0)
s_barrier
v_add_u32 v10, 1, v10
buffer_store_dword v10, v9, s[84:87], 0 offen sc1
L_q_done:
s_cmp_lg_u32 s17, 1
s_cbranch_scc1 L_q_end
s_mov_b32 s29, 32
s_branch L_q_again
L_q_end:
s_branch L_wl
L_fft:
s_waitcnt vmcnt(0)
s_barrier
s_or_b32 s81, s97, s98
s_cmp_lg_u32 s81, 0
s_cbranch_scc1 L_h0_5
s_lshl_b32 s81, s93, 5
v_mov_b32 v38, 1
s_mov_b64 exec, 1
buffer_atomic_add v38, off, s[88:91], s81 sc1
s_mov_b64 exec, -1
L_h0_5:
v_and_b32 v37, 7, v0
v_lshlrev_b32 v37, 5, v37
buffer_load_dword v36, v37, s[88:91], 0 offen sc1
s_waitcnt vmcnt(0)
s_cmp_lg_u32 s97, 0
s_cbranch_scc1 L_h2_6_ok
L_h2_6_ev:
v_cmp_ne_u32 vcc, 32, v36
s_cbranch_vccz L_h2_6_ok
s_mov_b32 s78, 0
v_readlane_b32 s81, v36, 0
s_nop 3
s_add_u32 s78, s78, s81
v_readlane_b32 s81, v36, 1
s_nop 3
s_add_u32 s78, s78, s81
v_readlane_b32 s81, v36, 2
s_nop 3
s_add_u32 s78, s78, s81
v_readlane_b32 s81, v36, 3
s_nop 3
s_add_u32 s78, s78, s81
v_readlane_b32 s81, v36, 4
s_nop 3
s_add_u32 s78, s78, s81
v_readlane_b32 s81, v36, 5
s_nop 3
s_add_u32 s78, s78, s81
v_readlane_b32 s81, v36, 6
s_nop 3
s_add_u32 s78, s78, s81
v_readlane_b32 s81, v36, 7
s_nop 3
s_add_u32 s78, s78, s81
s_cmp_eq_u32 s78, 256
s_cbranch_scc1 L_redo
buffer_load_dword v36, v37, s[88:91], 0 offen sc1
s_waitcnt vmcnt(0)
s_branch L_h2_6_ev
L_h2_6_ok:
s_mov_b32 s97, 1
s_load_dwordx2 s[72:73], s[0:1], 8
v_bfe_u32 v2, v0, 1, 1
v_lshlrev_b32 v2, 11, v2
v_bfe_u32 v3, v0, 2, 3
v_lshl_add_u32 v2, v3, 2, v2
v_and_b32 v3, 1, v0
v_lshl_add_u32 v2, v3, 1, v2
s_lshr_b32 s81, s92, 2
s_lshl_b32 s81, s81, 7
s_and_b32 s79, s92, 3
s_lshl_b32 s79, s79, 12
s_add_u32 s81, s81, s79
s_waitcnt lgkmcnt(0)
s_mov_b32 s74, 16384
s_mov_b32 s75, 0x00020000
buffer_load_ushort v4, v2, s[72:75], s81 offen
buffer_load_ushort v5, v2, s[72:75], s81 offen offset:32
buffer_load_ushort v6, v2, s[72:75], s81 offen offset:64
buffer_load_ushort v7, v2, s[72:75], s81 offen offset:96
v_and_b32 v1, 7, v0
v_lshlrev_b32 v1, 3, v1
v_bfe_u32 v3, v0, 3, 2
v_lshl_add_u32 v1, v3, 8, v1
v_cmp_gt_u32 vcc, 32, v0
v_bfrev_b32 v3, 1
s_lshr_b32 s81, s92, 2
s_lshl_b32 s81, s81, 10
v_cndmask_b32 v1, v3, v1, vcc
s_and_b32 s79, s92, 3
s_lshl_b32 s79, s79, 6
s_add_u32 s81, s81, s79
s_add_u32 s81, s81, 69206016
s_waitcnt vmcnt(0)
v_lshl_or_b32 v4, v5, 16, v4
v_lshl_or_b32 v5, v7, 16, v6
v_min_u32 v4, -2, v4
buffer_store_dwordx2 v[4:5], v1, s[84:87], s81 offen sc1
s_mov_b32 s99, s92
L_f2l:
s_load_dwordx2 s[40:41], s[0:1], 64
s_load_dwordx2 s[44:45], s[0:1], 72
v_mul_u32_u24 v156, 1026, v0
v_and_b32 v156, -4, v156
s_lshl_b32 s48, s99, 4
s_waitcnt lgkmcnt(0)
s_mov_b32 s42, 2101248
s_mov_b32 s43, 0x00020000
s_mov_b32 s46, 2101248
s_mov_b32 s47, 0x00020000
s_add_u32 s49, s48, 0
buffer_load_dwordx4 v[160:163], v156, s[40:43], s49 offen
buffer_load_dword v164, v156, s[40:43], s49 offen offset:16
s_add_u32 s49, s48, 262656
buffer_load_dwordx4 v[166:169], v156, s[40:43], s49 offen
buffer_load_dword v170, v156, s[40:43], s49 offen offset:16
s_add_u32 s49, s48, 525312
buffer_load_dwordx4 v[172:175], v156, s[40:43], s49 offen
buffer_load_dword v176, v156, s[40:43], s49 offen offset:16
s_add_u32 s49, s48, 787968
buffer_load_dwordx4 v[178:181], v156, s[40:43], s49 offen
buffer_load_dword v182, v156, s[40:43], s49 offen offset:16
s_add_u32 s49, s48, 1050624
buffer_load_dwordx4 v[184:187], v156, s[40:43], s49 offen
buffer_load_dword v188, v156, s[40:43], s49 offen offset:16
s_add_u32 s49, s48, 1313280
buffer_load_dwordx4 v[190:193], v156, s[40:43], s49 offen
buffer_load_dword v194, v156, s[40:43], s49 offen offset:16
s_add_u32 s49, s48, 1575936
buffer_load_dwordx4 v[196:199], v156, s[40:43], s49 offen
buffer_load_dword v200, v156, s[40:43], s49 offen offset:16
s_add_u32 s49, s48, 1838592
buffer_load_dwordx4 v[202:205], v156, s[40:43], s49 offen
buffer_load_dword v206, v156, s[40:43], s49 offen offset:16
s_add_u32 s49, s48, 0
buffer_load_dwordx4 v[208:211], v156, s[44:47], s49 offen
buffer_load_dword v212, v156, s[44:47], s49 offen offset:16
s_add_u32 s49, s48, 262656
buffer_load_dwordx4 v[214:217], v156, s[44:47], s49 offen
buffer_load_dword v218, v156, s[44:47], s49 offen offset:16
s_add_u32 s49, s48, 525312
buffer_load_dwordx4 v[220:223], v156, s[44:47], s49 offen
buffer_load_dword v224, v156, s[44:47], s49 offen offset:16
s_add_u32 s49, s48, 787968
buffer_load_dwordx4 v[226:229], v156, s[44:47], s49 offen
buffer_load_dword v230, v156, s[44:47], s49 offen offset:16
s_add_u32 s49, s48, 1050624
buffer_load_dwordx4 v[232:235], v156, s[44:47], s49 offen
buffer_load_dword v236, v156, s[44:47], s49 offen offset:16
s_add_u32 s49, s48, 1313280
buffer_load_dwordx4 v[238:241], v156, s[44:47], s49 offen
buffer_load_dword v242, v156, s[44:47], s49 offen offset:16
s_add_u32 s49, s48, 1575936
buffer_load_dwordx4 v[244:247], v156, s[44:47], s49 offen
buffer_load_dword v248, v156, s[44:47], s49 offen offset:16
s_add_u32 s49, s48, 1838592
buffer_load_dwordx4 v[250:253], v156, s[44:47], s49 offen
buffer_load_dword v254, v156, s[44:47], s49 offen offset:16
L_f2p:
v_and_b32 v2, 1, v0
v_lshlrev_b32 v2, 4, v2
v_lshlrev_b32 v3, 4, v0
s_waitcnt vmcnt(0)
s_barrier
v_alignbit_b32 v160, v161, v160, v2
v_alignbit_b32 v161, v162, v161, v2
v_alignbit_b32 v162, v163, v162, v2
v_alignbit_b32 v163, v164, v163, v2
ds_write_b128 v3, v[160:163]
v_alignbit_b32 v166, v167, v166, v2
v_alignbit_b32 v167, v168, v167, v2
v_alignbit_b32 v168, v169, v168, v2
v_alignbit_b32 v169, v170, v169, v2
ds_write_b128 v3, v[166:169] offset:4096
v_alignbit_b32 v172, v173, v172, v2
v_alignbit_b32 v173, v174, v173, v2
v_alignbit_b32 v174, v175, v174, v2
v_alignbit_b32 v175, v176, v175, v2
ds_write_b128 v3, v[172:175] offset:8192
v_alignbit_b32 v178, v179, v178, v2
v_alignbit_b32 v179, v180, v179, v2
v_alignbit_b32 v180, v181, v180, v2
v_alignbit_b32 v181, v182, v181, v2
ds_write_b128 v3, v[178:181] offset:12288
v_alignbit_b32 v184, v185, v184, v2
v_alignbit_b32 v185, v186, v185, v2
v_alignbit_b32 v186, v187, v186, v2
v_alignbit_b32 v187, v188, v187, v2
ds_write_b128 v3, v[184:187] offset:16384
v_alignbit_b32 v190, v191, v190, v2
v_alignbit_b32 v191, v192, v191, v2
v_alignbit_b32 v192, v193, v192, v2
v_alignbit_b32 v193, v194, v193, v2
ds_write_b128 v3, v[190:193] offset:20480
v_alignbit_b32 v196, v197, v196, v2
v_alignbit_b32 v197, v198, v197, v2
v_alignbit_b32 v198, v199, v198, v2
v_alignbit_b32 v199, v200, v199, v2
ds_write_b128 v3, v[196:199] offset:24576
v_alignbit_b32 v202, v203, v202, v2
v_alignbit_b32 v203, v204, v203, v2
v_alignbit_b32 v204, v205, v204, v2
v_alignbit_b32 v205, v206, v205, v2
ds_write_b128 v3, v[202:205] offset:28672
s_waitcnt lgkmcnt(4)
v_alignbit_b32 v208, v209, v208, v2
v_alignbit_b32 v209, v210, v209, v2
v_alignbit_b32 v210, v211, v210, v2
v_alignbit_b32 v211, v212, v211, v2
ds_write_b128 v3, v[208:211] offset:32768
v_alignbit_b32 v214, v215, v214, v2
v_alignbit_b32 v215, v216, v215, v2
v_alignbit_b32 v216, v217, v216, v2
v_alignbit_b32 v217, v218, v217, v2
ds_write_b128 v3, v[214:217] offset:36864
v_alignbit_b32 v220, v221, v220, v2
v_alignbit_b32 v221, v222, v221, v2
v_alignbit_b32 v222, v223, v222, v2
v_alignbit_b32 v223, v224, v223, v2
ds_write_b128 v3, v[220:223] offset:40960
v_alignbit_b32 v226, v227, v226, v2
v_alignbit_b32 v227, v228, v227, v2
v_alignbit_b32 v228, v229, v228, v2
v_alignbit_b32 v229, v230, v229, v2
ds_write_b128 v3, v[226:229] offset:45056
v_alignbit_b32 v232, v233, v232, v2
v_alignbit_b32 v233, v234, v233, v2
v_alignbit_b32 v234, v235, v234, v2
v_alignbit_b32 v235, v236, v235, v2
ds_write_b128 v3, v[232:235] offset:49152
v_alignbit_b32 v238, v239, v238, v2
v_alignbit_b32 v239, v240, v239, v2
v_alignbit_b32 v240, v241, v240, v2
v_alignbit_b32 v241, v242, v241, v2
ds_write_b128 v3, v[238:241] offset:53248
v_alignbit_b32 v244, v245, v244, v2
v_alignbit_b32 v245, v246, v245, v2
v_alignbit_b32 v246, v247, v246, v2
v_alignbit_b32 v247, v248, v247, v2
ds_write_b128 v3, v[244:247] offset:57344
v_alignbit_b32 v250, v251, v250, v2
v_alignbit_b32 v251, v252, v251, v2
v_alignbit_b32 v252, v253, v252, v2
v_alignbit_b32 v253, v254, v253, v2
ds_write_b128 v3, v[250:253] offset:61440
s_waitcnt lgkmcnt(4)
v_and_b32 v1, 1, v0
v_bfe_u32 v2, v0, 1, 5
v_lshlrev_b32 v1, 14, v1
v_lshl_add_u32 v1, v2, 4, v1
v_lshrrev_b32 v2, 6, v0
v_lshl_add_u32 v1, v2, 2, v1
s_waitcnt lgkmcnt(0)
s_barrier
ds_read_b32 v160, v1
ds_read_b32 v161, v1 offset:512
ds_read_b32 v162, v1 offset:1024
ds_read_b32 v163, v1 offset:1536
ds_read_b32 v164, v1 offset:2048
ds_read_b32 v165, v1 offset:2560
ds_read_b32 v166, v1 offset:3072
ds_read_b32 v167, v1 offset:3584
s_waitcnt lgkmcnt(6)
ds_read_b32 v168, v1 offset:4096
ds_read_b32 v169, v1 offset:4608
ds_read_b32 v170, v1 offset:5120
ds_read_b32 v171, v1 offset:5632
ds_read_b32 v172, v1 offset:6144
ds_read_b32 v173, v1 offset:6656
ds_read_b32 v174, v1 offset:7168
ds_read_b32 v175, v1 offset:7680
s_waitcnt lgkmcnt(6)
ds_read_b32 v176, v1 offset:8192
ds_read_b32 v177, v1 offset:8704
ds_read_b32 v178, v1 offset:9216
ds_read_b32 v179, v1 offset:9728
ds_read_b32 v180, v1 offset:10240
ds_read_b32 v181, v1 offset:10752
ds_read_b32 v182, v1 offset:11264
ds_read_b32 v183, v1 offset:11776
s_waitcnt lgkmcnt(6)
ds_read_b32 v184, v1 offset:12288
ds_read_b32 v185, v1 offset:12800
ds_read_b32 v186, v1 offset:13312
ds_read_b32 v187, v1 offset:13824
ds_read_b32 v188, v1 offset:14336
ds_read_b32 v189, v1 offset:14848
ds_read_b32 v190, v1 offset:15360
ds_read_b32 v191, v1 offset:15872
s_waitcnt lgkmcnt(6)
ds_read_b32 v192, v1 offset:32768
ds_read_b32 v193, v1 offset:33280
ds_read_b32 v194, v1 offset:33792
ds_read_b32 v195, v1 offset:34304
ds_read_b32 v196, v1 offset:34816
ds_read_b32 v197, v1 offset:35328
ds_read_b32 v198, v1 offset:35840
ds_read_b32 v199, v1 offset:36352
s_waitcnt lgkmcnt(6)
ds_read_b32 v200, v1 offset:36864
ds_read_b32 v201, v1 offset:37376
ds_read_b32 v202, v1 offset:37888
ds_read_b32 v203, v1 offset:38400
ds_read_b32 v204, v1 offset:38912
ds_read_b32 v205, v1 offset:39424
ds_read_b32 v206, v1 offset:39936
ds_read_b32 v207, v1 offset:40448
s_waitcnt lgkmcnt(6)
ds_read_b32 v208, v1 offset:40960
ds_read_b32 v209, v1 offset:41472
ds_read_b32 v210, v1 offset:41984
ds_read_b32 v211, v1 offset:42496
ds_read_b32 v212, v1 offset:43008
ds_read_b32 v213, v1 offset:43520
ds_read_b32 v214, v1 offset:44032
ds_read_b32 v215, v1 offset:44544
s_waitcnt lgkmcnt(6)
ds_read_b32 v216, v1 offset:45056
ds_read_b32 v217, v1 offset:45568
ds_read_b32 v218, v1 offset:46080
ds_read_b32 v219, v1 offset:46592
ds_read_b32 v220, v1 offset:47104
ds_read_b32 v221, v1 offset:47616
ds_read_b32 v222, v1 offset:48128
ds_read_b32 v223, v1 offset:48640
s_waitcnt lgkmcnt(6)
s_waitcnt lgkmcnt(0)
s_cmp_eq_u32 s99, 64
s_cbranch_scc1 L_f2go
s_barrier
s_load_dwordx2 s[4:5], s[0:1], 56
s_mov_b32 s30, 0x3f7b14be
s_mov_b32 s31, 0x3f6c835e
s_mov_b32 s32, 0x3f54db31
s_mov_b32 s33, 0x3f3504f3
s_mov_b32 s34, 0x3f0e39da
s_mov_b32 s35, 0x3ec3ef15
s_mov_b32 s36, 0x3e47c5c2
v_and_b32 v1, 31, v0
v_lshrrev_b32 v2, 5, v0
v_cvt_f32_u32 v3, v1
v_mul_u32_u24 v6, 16896, v2
v_lshl_add_u32 v4, v1, 4, v6
v_mul_u32_u24 v5, 528, v1
v_add_u32 v5, v5, v6
v_mov_b64 v[16:17], 0
v_mov_b64 v[18:19], 0
v_mov_b64 v[20:21], 0
v_mov_b64 v[22:23], 0
v_mov_b64 v[24:25], 0
v_mov_b64 v[26:27], 0
v_mov_b64 v[28:29], 0
v_mov_b64 v[30:31], 0
v_mov_b64 v[32:33], 0
v_mov_b64 v[34:35], 0
v_mov_b64 v[36:37], 0
v_mov_b64 v[38:39], 0
v_mov_b64 v[40:41], 0
v_mov_b64 v[42:43], 0
v_mov_b64 v[44:45], 0
v_mov_b64 v[46:47], 0
v_mov_b64 v[48:49], 0
v_mov_b64 v[50:51], 0
v_mov_b64 v[52:53], 0
v_mov_b64 v[54:55], 0
v_mov_b64 v[56:57], 0
v_mov_b64 v[58:59], 0
v_mov_b64 v[60:61], 0
v_mov_b64 v[62:63], 0
v_mov_b64 v[64:65], 0
v_mov_b64 v[66:67], 0
v_mov_b64 v[68:69], 0
v_mov_b64 v[70:71], 0
v_mov_b64 v[72:73], 0
v_mov_b64 v[74:75], 0
v_mov_b64 v[76:77], 0
v_mov_b64 v[78:79], 0
v_mov_b64 v[80:81], 0
v_mov_b64 v[82:83], 0
v_mov_b64 v[84:85], 0
v_mov_b64 v[86:87], 0
v_mov_b64 v[88:89], 0
v_mov_b64 v[90:91], 0
v_mov_b64 v[92:93], 0
v_mov_b64 v[94:95], 0
v_mov_b64 v[96:97], 0
v_mov_b64 v[98:99], 0
v_mov_b64 v[100:101], 0
v_mov_b64 v[102:103], 0
v_mov_b64 v[104:105], 0
v_mov_b64 v[106:107], 0
v_mov_b64 v[108:109], 0
v_mov_b64 v[110:111], 0
v_mov_b64 v[112:113], 0
v_mov_b64 v[114:115], 0
v_mov_b64 v[116:117], 0
v_mov_b64 v[118:119], 0
v_mov_b64 v[120:121], 0
v_mov_b64 v[122:123], 0
v_mov_b64 v[124:125], 0
v_mov_b64 v[126:127], 0
v_mov_b64 v[128:129], 0
v_mov_b64 v[130:131], 0
v_mov_b64 v[132:133], 0
v_mov_b64 v[134:135], 0
v_mov_b64 v[136:137], 0
v_mov_b64 v[138:139], 0
v_mov_b64 v[140:141], 0
v_mov_b64 v[142:143], 0
v_lshlrev_b32 v7, 11, v2
v_lshl_add_u32 v7, v1, 1, v7
s_lshl_b32 s12, s92, 16
s_add_u32 s13, s12, 16384
s_add_u32 s14, s12, 32768
s_add_u32 s15, s12, 49152
s_waitcnt lgkmcnt(0)
s_mov_b32 s6, 4194304
s_mov_b32 s7, 0x00020000
buffer_load_short_d16_hi v16, v7, s[4:7], s12 offen
buffer_load_short_d16_hi v20, v7, s[4:7], s12 offen offset:64
buffer_load_short_d16_hi v24, v7, s[4:7], s12 offen offset:128
buffer_load_short_d16_hi v28, v7, s[4:7], s12 offen offset:192
buffer_load_short_d16_hi v32, v7, s[4:7], s12 offen offset:256
buffer_load_short_d16_hi v36, v7, s[4:7], s12 offen offset:320
buffer_load_short_d16_hi v40, v7, s[4:7], s12 offen offset:384
buffer_load_short_d16_hi v44, v7, s[4:7], s12 offen offset:448
buffer_load_short_d16_hi v48, v7, s[4:7], s12 offen offset:512
buffer_load_short_d16_hi v52, v7, s[4:7], s12 offen offset:576
buffer_load_short_d16_hi v56, v7, s[4:7], s12 offen offset:640
buffer_load_short_d16_hi v60, v7, s[4:7], s12 offen offset:704
buffer_load_short_d16_hi v64, v7, s[4:7], s12 offen offset:768
buffer_load_short_d16_hi v68, v7, s[4:7], s12 offen offset:832
buffer_load_short_d16_hi v72, v7, s[4:7], s12 offen offset:896
buffer_load_short_d16_hi v76, v7, s[4:7], s12 offen offset:960
buffer_load_short_d16_hi v80, v7, s[4:7], s12 offen offset:1024
buffer_load_short_d16_hi v84, v7, s[4:7], s12 offen offset:1088
buffer_load_short_d16_hi v88, v7, s[4:7], s12 offen offset:1152
buffer_load_short_d16_hi v92, v7, s[4:7], s12 offen offset:1216
buffer_load_short_d16_hi v96, v7, s[4:7], s12 offen offset:1280
buffer_load_short_d16_hi v100, v7, s[4:7], s12 offen offset:1344
buffer_load_short_d16_hi v104, v7, s[4:7], s12 offen offset:1408
buffer_load_short_d16_hi v108, v7, s[4:7], s12 offen offset:1472
buffer_load_short_d16_hi v112, v7, s[4:7], s12 offen offset:1536
buffer_load_short_d16_hi v116, v7, s[4:7], s12 offen offset:1600
buffer_load_short_d16_hi v120, v7, s[4:7], s12 offen offset:1664
buffer_load_short_d16_hi v124, v7, s[4:7], s12 offen offset:1728
buffer_load_short_d16_hi v128, v7, s[4:7], s12 offen offset:1792
buffer_load_short_d16_hi v132, v7, s[4:7], s12 offen offset:1856
buffer_load_short_d16_hi v136, v7, s[4:7], s12 offen offset:1920
buffer_load_short_d16_hi v140, v7, s[4:7], s12 offen offset:1984
buffer_load_short_d16_hi v18, v7, s[4:7], s13 offen
buffer_load_short_d16_hi v22, v7, s[4:7], s13 offen offset:64
buffer_load_short_d16_hi v26, v7, s[4:7], s13 offen offset:128
buffer_load_short_d16_hi v30, v7, s[4:7], s13 offen offset:192
buffer_load_short_d16_hi v34, v7, s[4:7], s13 offen offset:256
buffer_load_short_d16_hi v38, v7, s[4:7], s13 offen offset:320
buffer_load_short_d16_hi v42, v7, s[4:7], s13 offen offset:384
buffer_load_short_d16_hi v46, v7, s[4:7], s13 offen offset:448
buffer_load_short_d16_hi v50, v7, s[4:7], s13 offen offset:512
buffer_load_short_d16_hi v54, v7, s[4:7], s13 offen offset:576
buffer_load_short_d16_hi v58, v7, s[4:7], s13 offen offset:640
buffer_load_short_d16_hi v62, v7, s[4:7], s13 offen offset:704
buffer_load_short_d16_hi v66, v7, s[4:7], s13 offen offset:768
buffer_load_short_d16_hi v70, v7, s[4:7], s13 offen offset:832
buffer_load_short_d16_hi v74, v7, s[4:7], s13 offen offset:896
buffer_load_short_d16_hi v78, v7, s[4:7], s13 offen offset:960
buffer_load_short_d16_hi v82, v7, s[4:7], s13 offen offset:1024
buffer_load_short_d16_hi v86, v7, s[4:7], s13 offen offset:1088
buffer_load_short_d16_hi v90, v7, s[4:7], s13 offen offset:1152
buffer_load_short_d16_hi v94, v7, s[4:7], s13 offen offset:1216
buffer_load_short_d16_hi v98, v7, s[4:7], s13 offen offset:1280
buffer_load_short_d16_hi v102, v7, s[4:7], s13 offen offset:1344
buffer_load_short_d16_hi v106, v7, s[4:7], s13 offen offset:1408
buffer_load_short_d16_hi v110, v7, s[4:7], s13 offen offset:1472
buffer_load_short_d16_hi v114, v7, s[4:7], s13 offen offset:1536
buffer_load_short_d16_hi v118, v7, s[4:7], s13 offen offset:1600
buffer_load_short_d16_hi v122, v7, s[4:7], s13 offen offset:1664
buffer_load_short_d16_hi v126, v7, s[4:7], s13 offen offset:1728
buffer_load_short_d16_hi v130, v7, s[4:7], s13 offen offset:1792
buffer_load_short_d16_hi v134, v7, s[4:7], s13 offen offset:1856
buffer_load_short_d16_hi v138, v7, s[4:7], s13 offen offset:1920
buffer_load_short_d16_hi v142, v7, s[4:7], s13 offen offset:1984
buffer_load_short_d16_hi v17, v7, s[4:7], s14 offen
buffer_load_short_d16_hi v21, v7, s[4:7], s14 offen offset:64
buffer_load_short_d16_hi v25, v7, s[4:7], s14 offen offset:128
buffer_load_short_d16_hi v29, v7, s[4:7], s14 offen offset:192
buffer_load_short_d16_hi v33, v7, s[4:7], s14 offen offset:256
buffer_load_short_d16_hi v37, v7, s[4:7], s14 offen offset:320
buffer_load_short_d16_hi v41, v7, s[4:7], s14 offen offset:384
buffer_load_short_d16_hi v45, v7, s[4:7], s14 offen offset:448
buffer_load_short_d16_hi v49, v7, s[4:7], s14 offen offset:512
buffer_load_short_d16_hi v53, v7, s[4:7], s14 offen offset:576
buffer_load_short_d16_hi v57, v7, s[4:7], s14 offen offset:640
buffer_load_short_d16_hi v61, v7, s[4:7], s14 offen offset:704
buffer_load_short_d16_hi v65, v7, s[4:7], s14 offen offset:768
buffer_load_short_d16_hi v69, v7, s[4:7], s14 offen offset:832
buffer_load_short_d16_hi v73, v7, s[4:7], s14 offen offset:896
buffer_load_short_d16_hi v77, v7, s[4:7], s14 offen offset:960
buffer_load_short_d16_hi v81, v7, s[4:7], s14 offen offset:1024
buffer_load_short_d16_hi v85, v7, s[4:7], s14 offen offset:1088
buffer_load_short_d16_hi v89, v7, s[4:7], s14 offen offset:1152
buffer_load_short_d16_hi v93, v7, s[4:7], s14 offen offset:1216
buffer_load_short_d16_hi v97, v7, s[4:7], s14 offen offset:1280
buffer_load_short_d16_hi v101, v7, s[4:7], s14 offen offset:1344
buffer_load_short_d16_hi v105, v7, s[4:7], s14 offen offset:1408
buffer_load_short_d16_hi v109, v7, s[4:7], s14 offen offset:1472
buffer_load_short_d16_hi v113, v7, s[4:7], s14 offen offset:1536
buffer_load_short_d16_hi v117, v7, s[4:7], s14 offen offset:1600
buffer_load_short_d16_hi v121, v7, s[4:7], s14 offen offset:1664
buffer_load_short_d16_hi v125, v7, s[4:7], s14 offen offset:1728
buffer_load_short_d16_hi v129, v7, s[4:7], s14 offen offset:1792
buffer_load_short_d16_hi v133, v7, s[4:7], s14 offen offset:1856
buffer_load_short_d16_hi v137, v7, s[4:7], s14 offen offset:1920
buffer_load_short_d16_hi v141, v7, s[4:7], s14 offen offset:1984
buffer_load_short_d16_hi v19, v7, s[4:7], s15 offen
buffer_load_short_d16_hi v23, v7, s[4:7], s15 offen offset:64
buffer_load_short_d16_hi v27, v7, s[4:7], s15 offen offset:128
buffer_load_short_d16_hi v31, v7, s[4:7], s15 offen offset:192
buffer_load_short_d16_hi v35, v7, s[4:7], s15 offen offset:256
buffer_load_short_d16_hi v39, v7, s[4:7], s15 offen offset:320
buffer_load_short_d16_hi v43, v7, s[4:7], s15 offen offset:384
buffer_load_short_d16_hi v47, v7, s[4:7], s15 offen offset:448
buffer_load_short_d16_hi v51, v7, s[4:7], s15 offen offset:512
buffer_load_short_d16_hi v55, v7, s[4:7], s15 offen offset:576
buffer_load_short_d16_hi v59, v7, s[4:7], s15 offen offset:640
buffer_load_short_d16_hi v63, v7, s[4:7], s15 offen offset:704
buffer_load_short_d16_hi v67, v7, s[4:7], s15 offen offset:768
buffer_load_short_d16_hi v71, v7, s[4:7], s15 offen offset:832
buffer_load_short_d16_hi v75, v7, s[4:7], s15 offen offset:896
buffer_load_short_d16_hi v79, v7, s[4:7], s15 offen offset:960
buffer_load_short_d16_hi v83, v7, s[4:7], s15 offen offset:1024
buffer_load_short_d16_hi v87, v7, s[4:7], s15 offen offset:1088
buffer_load_short_d16_hi v91, v7, s[4:7], s15 offen offset:1152
buffer_load_short_d16_hi v95, v7, s[4:7], s15 offen offset:1216
buffer_load_short_d16_hi v99, v7, s[4:7], s15 offen offset:1280
buffer_load_short_d16_hi v103, v7, s[4:7], s15 offen offset:1344
buffer_load_short_d16_hi v107, v7, s[4:7], s15 offen offset:1408
buffer_load_short_d16_hi v111, v7, s[4:7], s15 offen offset:1472
buffer_load_short_d16_hi v115, v7, s[4:7], s15 offen offset:1536
buffer_load_short_d16_hi v119, v7, s[4:7], s15 offen offset:1600
buffer_load_short_d16_hi v123, v7, s[4:7], s15 offen offset:1664
buffer_load_short_d16_hi v127, v7, s[4:7], s15 offen offset:1728
buffer_load_short_d16_hi v131, v7, s[4:7], s15 offen offset:1792
buffer_load_short_d16_hi v135, v7, s[4:7], s15 offen offset:1856
buffer_load_short_d16_hi v139, v7, s[4:7], s15 offen offset:1920
buffer_load_short_d16_hi v143, v7, s[4:7], s15 offen offset:1984
s_waitcnt vmcnt(0)
v_pk_add_f32 v[144:145], v[16:17], v[80:81] neg_lo:[0,1] neg_hi:[0,1]
v_pk_add_f32 v[146:147], v[18:19], v[82:83] neg_lo:[0,1] neg_hi:[0,1]
v_pk_add_f32 v[16:17], v[16:17], v[80:81]
v_pk_add_f32 v[18:19], v[18:19], v[82:83]
v_pk_add_f32 v[80:81], v[20:21], v[84:85] neg_lo:[0,1] neg_hi:[0,1]
v_pk_add_f32 v[82:83], v[22:23], v[86:87] neg_lo:[0,1] neg_hi:[0,1]
v_pk_add_f32 v[20:21], v[20:21], v[84:85]
v_pk_add_f32 v[22:23], v[22:23], v[86:87]
v_pk_mul_f32 v[84:85], v[80:81], s[30:31] op_sel_hi:[1,0]
v_pk_mul_f32 v[86:87], v[80:81], s[36:37] op_sel_hi:[1,0] neg_lo:[0,1] neg_hi:[0,1]
v_pk_fma_f32 v[84:85], v[82:83], s[36:37], v[84:85] op_sel_hi:[1,0,1]
v_pk_fma_f32 v[86:87], v[82:83], s[30:31], v[86:87] op_sel_hi:[1,0,1]
v_pk_add_f32 v[80:81], v[24:25], v[88:89] neg_lo:[0,1] neg_hi:[0,1]
v_pk_add_f32 v[82:83], v[26:27], v[90:91] neg_lo:[0,1] neg_hi:[0,1]
v_pk_add_f32 v[24:25], v[24:25], v[88:89]
v_pk_add_f32 v[26:27], v[26:27], v[90:91]
v_pk_mul_f32 v[88:89], v[80:81], s[30:31] op_sel:[0,1]
v_pk_mul_f32 v[90:91], v[80:81], s[34:35] op_sel:[0,1] neg_lo:[0,1] neg_hi:[0,1]
v_pk_fma_f32 v[88:89], v[82:83], s[34:35], v[88:89] op_sel:[0,1,0]
v_pk_fma_f32 v[90:91], v[82:83], s[30:31], v[90:91] op_sel:[0,1,0]
v_pk_add_f32 v[80:81], v[28:29], v[92:93] neg_lo:[0,1] neg_hi:[0,1]
v_pk_add_f32 v[82:83], v[30:31], v[94:95] neg_lo:[0,1] neg_hi:[0,1]
v_pk_add_f32 v[28:29], v[28:29], v[92:93]
v_pk_add_f32 v[30:31], v[30:31], v[94:95]
v_pk_mul_f32 v[92:93], v[80:81], s[32:33] op_sel_hi:[1,0]
v_pk_mul_f32 v[94:95], v[80:81], s[34:35] op_sel_hi:[1,0] neg_lo:[0,1] neg_hi:[0,1]
v_pk_fma_f32 v[92:93], v[82:83], s[34:35], v[92:93] op_sel_hi:[1,0,1]
v_pk_fma_f32 v[94:95], v[82:83], s[32:33], v[94:95] op_sel_hi:[1,0,1]
v_pk_add_f32 v[80:81], v[32:33], v[96:97] neg_lo:[0,1] neg_hi:[0,1]
v_pk_add_f32 v[82:83], v[34:35], v[98:99] neg_lo:[0,1] neg_hi:[0,1]
v_pk_add_f32 v[32:33], v[32:33], v[96:97]
v_pk_add_f32 v[34:35], v[34:35], v[98:99]
v_pk_mul_f32 v[96:97], v[80:81], s[32:33] op_sel:[0,1]
v_pk_mul_f32 v[98:99], v[80:81], s[32:33] op_sel:[0,1] neg_lo:[0,1] neg_hi:[0,1]
v_pk_fma_f32 v[96:97], v[82:83], s[32:33], v[96:97] op_sel:[0,1,0]
v_pk_fma_f32 v[98:99], v[82:83], s[32:33], v[98:99] op_sel:[0,1,0]
v_pk_add_f32 v[80:81], v[36:37], v[100:101] neg_lo:[0,1] neg_hi:[0,1]
v_pk_add_f32 v[82:83], v[38:39], v[102:103] neg_lo:[0,1] neg_hi:[0,1]
v_pk_add_f32 v[36:37], v[36:37], v[100:101]
v_pk_add_f32 v[38:39], v[38:39], v[102:103]
v_pk_mul_f32 v[100:101], v[80:81], s[34:35] op_sel_hi:[1,0]
v_pk_mul_f32 v[102:103], v[80:81], s[32:33] op_sel_hi:[1,0] neg_lo:[0,1] neg_hi:[0,1]
v_pk_fma_f32 v[100:101], v[82:83], s[32:33], v[100:101] op_sel_hi:[1,0,1]
v_pk_fma_f32 v[102:103], v[82:83], s[34:35], v[102:103] op_sel_hi:[1,0,1]
v_pk_add_f32 v[80:81], v[40:41], v[104:105] neg_lo:[0,1] neg_hi:[0,1]
v_pk_add_f32 v[82:83], v[42:43], v[106:107] neg_lo:[0,1] neg_hi:[0,1]
v_pk_add_f32 v[40:41], v[40:41], v[104:105]
v_pk_add_f32 v[42:43], v[42:43], v[106:107]
v_pk_mul_f32 v[104:105], v[80:81], s[34:35] op_sel:[0,1]
v_pk_mul_f32 v[106:107], v[80:81], s[30:31] op_sel:[0,1] neg_lo:[0,1] neg_hi:[0,1]
v_pk_fma_f32 v[104:105], v[82:83], s[30:31], v[104:105] op_sel:[0,1,0]
v_pk_fma_f32 v[106:107], v[82:83], s[34:35], v[106:107] op_sel:[0,1,0]
v_pk_add_f32 v[80:81], v[44:45], v[108:109] neg_lo:[0,1] neg_hi:[0,1]
v_pk_add_f32 v[82:83], v[46:47], v[110:111] neg_lo:[0,1] neg_hi:[0,1]
v_pk_add_f32 v[44:45], v[44:45], v[108:109]
v_pk_add_f32 v[46:47], v[46:47], v[110:111]
v_pk_mul_f32 v[108:109], v[80:81], s[36:37] op_sel_hi:[1,0]
v_pk_mul_f32 v[110:111], v[80:81], s[30:31] op_sel_hi:[1,0] neg_lo:[0,1] neg_hi:[0,1]
v_pk_fma_f32 v[108:109], v[82:83], s[30:31], v[108:109] op_sel_hi:[1,0,1]
v_pk_fma_f32 v[110:111], v[82:83], s[36:37], v[110:111] op_sel_hi:[1,0,1]
v_pk_add_f32 v[80:81], v[50:51], v[114:115] neg_lo:[0,1] neg_hi:[0,1]
v_pk_add_f32 v[82:83], v[112:113], v[48:49] neg_lo:[0,1] neg_hi:[0,1]
v_pk_add_f32 v[48:49], v[48:49], v[112:113]
v_pk_add_f32 v[50:51], v[50:51], v[114:115]
v_pk_add_f32 v[112:113], v[52:53], v[116:117] neg_lo:[0,1] neg_hi:[0,1]
v_pk_add_f32 v[114:115], v[54:55], v[118:119] neg_lo:[0,1] neg_hi:[0,1]
v_pk_add_f32 v[52:53], v[52:53], v[116:117]
v_pk_add_f32 v[54:55], v[54:55], v[118:119]
v_pk_mul_f32 v[116:117], v[112:113], s[36:37] op_sel_hi:[1,0] neg_lo:[0,1] neg_hi:[0,1]
v_pk_mul_f32 v[118:119], v[112:113], s[30:31] op_sel_hi:[1,0] neg_lo:[0,1] neg_hi:[0,1]
v_pk_fma_f32 v[116:117], v[114:115], s[30:31], v[116:117] op_sel_hi:[1,0,1]
v_pk_fma_f32 v[118:119], v[114:115], s[36:37], v[118:119] op_sel_hi:[1,0,1] neg_lo:[0,1,0] neg_hi:[0,1,0]
v_pk_add_f32 v[112:113], v[56:57], v[120:121] neg_lo:[0,1] neg_hi:[0,1]
v_pk_add_f32 v[114:115], v[58:59], v[122:123] neg_lo:[0,1] neg_hi:[0,1]
v_pk_add_f32 v[56:57], v[56:57], v[120:121]
v_pk_add_f32 v[58:59], v[58:59], v[122:123]
v_pk_mul_f32 v[120:121], v[112:113], s[34:35] op_sel:[0,1] neg_lo:[0,1] neg_hi:[0,1]
v_pk_mul_f32 v[122:123], v[112:113], s[30:31] op_sel:[0,1] neg_lo:[0,1] neg_hi:[0,1]
v_pk_fma_f32 v[120:121], v[114:115], s[30:31], v[120:121] op_sel:[0,1,0]
v_pk_fma_f32 v[122:123], v[114:115], s[34:35], v[122:123] op_sel:[0,1,0] neg_lo:[0,1,0] neg_hi:[0,1,0]
v_pk_add_f32 v[112:113], v[60:61], v[124:125] neg_lo:[0,1] neg_hi:[0,1]
v_pk_add_f32 v[114:115], v[62:63], v[126:127] neg_lo:[0,1] neg_hi:[0,1]
v_pk_add_f32 v[60:61], v[60:61], v[124:125]
v_pk_add_f32 v[62:63], v[62:63], v[126:127]
v_pk_mul_f32 v[124:125], v[112:113], s[34:35] op_sel_hi:[1,0] neg_lo:[0,1] neg_hi:[0,1]
v_pk_mul_f32 v[126:127], v[112:113], s[32:33] op_sel_hi:[1,0] neg_lo:[0,1] neg_hi:[0,1]
v_pk_fma_f32 v[124:125], v[114:115], s[32:33], v[124:125] op_sel_hi:[1,0,1]
v_pk_fma_f32 v[126:127], v[114:115], s[34:35], v[126:127] op_sel_hi:[1,0,1] neg_lo:[0,1,0] neg_hi:[0,1,0]
v_pk_add_f32 v[112:113], v[64:65], v[128:129] neg_lo:[0,1] neg_hi:[0,1]
v_pk_add_f32 v[114:115], v[66:67], v[130:131] neg_lo:[0,1] neg_hi:[0,1]
v_pk_add_f32 v[64:65], v[64:65], v[128:129]
v_pk_add_f32 v[66:67], v[66:67], v[130:131]
v_pk_mul_f32 v[128:129], v[112:113], s[32:33] op_sel:[0,1] neg_lo:[0,1] neg_hi:[0,1]
v_pk_mul_f32 v[130:131], v[112:113], s[32:33] op_sel:[0,1] neg_lo:[0,1] neg_hi:[0,1]
v_pk_fma_f32 v[128:129], v[114:115], s[32:33], v[128:129] op_sel:[0,1,0]
v_pk_fma_f32 v[130:131], v[114:115], s[32:33], v[130:131] op_sel:[0,1,0] neg_lo:[0,1,0] neg_hi:[0,1,0]
v_pk_add_f32 v[112:113], v[68:69], v[132:133] neg_lo:[0,1] neg_hi:[0,1]
v_pk_add_f32 v[114:115], v[70:71], v[134:135] neg_lo:[0,1] neg_hi:[0,1]
v_pk_add_f32 v[68:69], v[68:69], v[132:133]
v_pk_add_f32 v[70:71], v[70:71], v[134:135]
v_pk_mul_f32 v[132:133], v[112:113], s[32:33] op_sel_hi:[1,0] neg_lo:[0,1] neg_hi:[0,1]
v_pk_mul_f32 v[134:135], v[112:113], s[34:35] op_sel_hi:[1,0] neg_lo:[0,1] neg_hi:[0,1]
v_pk_fma_f32 v[132:133], v[114:115], s[34:35], v[132:133] op_sel_hi:[1,0,1]
v_pk_fma_f32 v[134:135], v[114:115], s[32:33], v[134:135] op_sel_hi:[1,0,1] neg_lo:[0,1,0] neg_hi:[0,1,0]
v_pk_add_f32 v[112:113], v[72:73], v[136:137] neg_lo:[0,1] neg_hi:[0,1]
v_pk_add_f32 v[114:115], v[74:75], v[138:139] neg_lo:[0,1] neg_hi:[0,1]
v_pk_add_f32 v[72:73], v[72:73], v[136:137]
v_pk_add_f32 v[74:75], v[74:75], v[138:139]
v_pk_mul_f32 v[136:137], v[112:113], s[30:31] op_sel:[0,1] neg_lo:[0,1] neg_hi:[0,1]
v_pk_mul_f32 v[138:139], v[112:113], s[34:35] op_sel:[0,1] neg_lo:[0,1] neg_hi:[0,1]
v_pk_fma_f32 v[136:137], v[114:115], s[34:35], v[136:137] op_sel:[0,1,0]
v_pk_fma_f32 v[138:139], v[114:115], s[30:31], v[138:139] op_sel:[0,1,0] neg_lo:[0,1,0] neg_hi:[0,1,0]
v_pk_add_f32 v[112:113], v[76:77], v[140:141] neg_lo:[0,1] neg_hi:[0,1]
v_pk_add_f32 v[114:115], v[78:79], v[142:143] neg_lo:[0,1] neg_hi:[0,1]
v_pk_add_f32 v[76:77], v[76:77], v[140:141]
v_pk_add_f32 v[78:79], v[78:79], v[142:143]
v_pk_mul_f32 v[140:141], v[112:113], s[30:31] op_sel_hi:[1,0] neg_lo:[0,1] neg_hi:[0,1]
v_pk_mul_f32 v[142:143], v[112:113], s[36:37] op_sel_hi:[1,0] neg_lo:[0,1] neg_hi:[0,1]
v_pk_fma_f32 v[140:141], v[114:115], s[36:37], v[140:141] op_sel_hi:[1,0,1]
v_pk_fma_f32 v[142:143], v[114:115], s[30:31], v[142:143] op_sel_hi:[1,0,1] neg_lo:[0,1,0] neg_hi:[0,1,0]
v_pk_add_f32 v[112:113], v[16:17], v[48:49] neg_lo:[0,1] neg_hi:[0,1]
v_pk_add_f32 v[114:115], v[18:19], v[50:51] neg_lo:[0,1] neg_hi:[0,1]
v_pk_add_f32 v[16:17], v[16:17], v[48:49]
v_pk_add_f32 v[18:19], v[18:19], v[50:51]
v_pk_add_f32 v[48:49], v[20:21], v[52:53] neg_lo:[0,1] neg_hi:[0,1]
v_pk_add_f32 v[50:51], v[22:23], v[54:55] neg_lo:[0,1] neg_hi:[0,1]
v_pk_add_f32 v[20:21], v[20:21], v[52:53]
v_pk_add_f32 v[22:23], v[22:23], v[54:55]
v_pk_mul_f32 v[52:53], v[48:49], s[30:31] op_sel:[0,1]
v_pk_mul_f32 v[54:55], v[48:49], s[34:35] op_sel:[0,1] neg_lo:[0,1] neg_hi:[0,1]
v_pk_fma_f32 v[52:53], v[50:51], s[34:35], v[52:53] op_sel:[0,1,0]
v_pk_fma_f32 v[54:55], v[50:51], s[30:31], v[54:55] op_sel:[0,1,0]
v_pk_add_f32 v[48:49], v[24:25], v[56:57] neg_lo:[0,1] neg_hi:[0,1]
v_pk_add_f32 v[50:51], v[26:27], v[58:59] neg_lo:[0,1] neg_hi:[0,1]
v_pk_add_f32 v[24:25], v[24:25], v[56:57]
v_pk_add_f32 v[26:27], v[26:27], v[58:59]
v_pk_mul_f32 v[56:57], v[48:49], s[32:33] op_sel:[0,1]
v_pk_mul_f32 v[58:59], v[48:49], s[32:33] op_sel:[0,1] neg_lo:[0,1] neg_hi:[0,1]
v_pk_fma_f32 v[56:57], v[50:51], s[32:33], v[56:57] op_sel:[0,1,0]
v_pk_fma_f32 v[58:59], v[50:51], s[32:33], v[58:59] op_sel:[0,1,0]
v_pk_add_f32 v[48:49], v[28:29], v[60:61] neg_lo:[0,1] neg_hi:[0,1]
v_pk_add_f32 v[50:51], v[30:31], v[62:63] neg_lo:[0,1] neg_hi:[0,1]
v_pk_add_f32 v[28:29], v[28:29], v[60:61]
v_pk_add_f32 v[30:31], v[30:31], v[62:63]
v_pk_mul_f32 v[60:61], v[48:49], s[34:35] op_sel:[0,1]
v_pk_mul_f32 v[62:63], v[48:49], s[30:31] op_sel:[0,1] neg_lo:[0,1] neg_hi:[0,1]
v_pk_fma_f32 v[60:61], v[50:51], s[30:31], v[60:61] op_sel:[0,1,0]
v_pk_fma_f32 v[62:63], v[50:51], s[34:35], v[62:63] op_sel:[0,1,0]
v_pk_add_f32 v[48:49], v[34:35], v[66:67] neg_lo:[0,1] neg_hi:[0,1]
v_pk_add_f32 v[50:51], v[64:65], v[32:33] neg_lo:[0,1] neg_hi:[0,1]
v_pk_add_f32 v[32:33], v[32:33], v[64:65]
v_pk_add_f32 v[34:35], v[34:35], v[66:67]
v_pk_add_f32 v[64:65], v[36:37], v[68:69] neg_lo:[0,1] neg_hi:[0,1]
v_pk_add_f32 v[66:67], v[38:39], v[70:71] neg_lo:[0,1] neg_hi:[0,1]
v_pk_add_f32 v[36:37], v[36:37], v[68:69]
v_pk_add_f32 v[38:39], v[38:39], v[70:71]
v_pk_mul_f32 v[68:69], v[64:65], s[34:35] op_sel:[0,1] neg_lo:[0,1] neg_hi:[0,1]
v_pk_mul_f32 v[70:71], v[64:65], s[30:31] op_sel:[0,1] neg_lo:[0,1] neg_hi:[0,1]
v_pk_fma_f32 v[68:69], v[66:67], s[30:31], v[68:69] op_sel:[0,1,0]
v_pk_fma_f32 v[70:71], v[66:67], s[34:35], v[70:71] op_sel:[0,1,0] neg_lo:[0,1,0] neg_hi:[0,1,0]
v_pk_add_f32 v[64:65], v[40:41], v[72:73] neg_lo:[0,1] neg_hi:[0,1]
v_pk_add_f32 v[66:67], v[42:43], v[74:75] neg_lo:[0,1] neg_hi:[0,1]
v_pk_add_f32 v[40:41], v[40:41], v[72:73]
v_pk_add_f32 v[42:43], v[42:43], v[74:75]
v_pk_mul_f32 v[72:73], v[64:65], s[32:33] op_sel:[0,1] neg_lo:[0,1] neg_hi:[0,1]
v_pk_mul_f32 v[74:75], v[64:65], s[32:33] op_sel:[0,1] neg_lo:[0,1] neg_hi:[0,1]
v_pk_fma_f32 v[72:73], v[66:67], s[32:33], v[72:73] op_sel:[0,1,0]
v_pk_fma_f32 v[74:75], v[66:67], s[32:33], v[74:75] op_sel:[0,1,0] neg_lo:[0,1,0] neg_hi:[0,1,0]
v_pk_add_f32 v[64:65], v[44:45], v[76:77] neg_lo:[0,1] neg_hi:[0,1]
v_pk_add_f32 v[66:67], v[46:47], v[78:79] neg_lo:[0,1] neg_hi:[0,1]
v_pk_add_f32 v[44:45], v[44:45], v[76:77]
v_pk_add_f32 v[46:47], v[46:47], v[78:79]
v_pk_mul_f32 v[76:77], v[64:65], s[30:31] op_sel:[0,1] neg_lo:[0,1] neg_hi:[0,1]
v_pk_mul_f32 v[78:79], v[64:65], s[34:35] op_sel:[0,1] neg_lo:[0,1] neg_hi:[0,1]
v_pk_fma_f32 v[76:77], v[66:67], s[34:35], v[76:77] op_sel:[0,1,0]
v_pk_fma_f32 v[78:79], v[66:67], s[30:31], v[78:79] op_sel:[0,1,0] neg_lo:[0,1,0] neg_hi:[0,1,0]
v_pk_add_f32 v[64:65], v[144:145], v[80:81] neg_lo:[0,1] neg_hi:[0,1]
v_pk_add_f32 v[66:67], v[146:147], v[82:83] neg_lo:[0,1] neg_hi:[0,1]
v_pk_add_f32 v[144:145], v[144:145], v[80:81]
v_pk_add_f32 v[146:147], v[146:147], v[82:83]
v_pk_add_f32 v[80:81], v[84:85], v[116:117] neg_lo:[0,1] neg_hi:[0,1]
v_pk_add_f32 v[82:83], v[86:87], v[118:119] neg_lo:[0,1] neg_hi:[0,1]
v_pk_add_f32 v[84:85], v[84:85], v[116:117]
v_pk_add_f32 v[86:87], v[86:87], v[118:119]
v_pk_mul_f32 v[116:117], v[80:81], s[30:31] op_sel:[0,1]
v_pk_mul_f32 v[118:119], v[80:81], s[34:35] op_sel:[0,1] neg_lo:[0,1] neg_hi:[0,1]
v_pk_fma_f32 v[116:117], v[82:83], s[34:35], v[116:117] op_sel:[0,1,0]
v_pk_fma_f32 v[118:119], v[82:83], s[30:31], v[118:119] op_sel:[0,1,0]
v_pk_add_f32 v[80:81], v[88:89], v[120:121] neg_lo:[0,1] neg_hi:[0,1]
v_pk_add_f32 v[82:83], v[90:91], v[122:123] neg_lo:[0,1] neg_hi:[0,1]
v_pk_add_f32 v[88:89], v[88:89], v[120:121]
v_pk_add_f32 v[90:91], v[90:91], v[122:123]
v_pk_mul_f32 v[120:121], v[80:81], s[32:33] op_sel:[0,1]
v_pk_mul_f32 v[122:123], v[80:81], s[32:33] op_sel:[0,1] neg_lo:[0,1] neg_hi:[0,1]
v_pk_fma_f32 v[120:121], v[82:83], s[32:33], v[120:121] op_sel:[0,1,0]
v_pk_fma_f32 v[122:123], v[82:83], s[32:33], v[122:123] op_sel:[0,1,0]
v_pk_add_f32 v[80:81], v[92:93], v[124:125] neg_lo:[0,1] neg_hi:[0,1]
v_pk_add_f32 v[82:83], v[94:95], v[126:127] neg_lo:[0,1] neg_hi:[0,1]
v_pk_add_f32 v[92:93], v[92:93], v[124:125]
v_pk_add_f32 v[94:95], v[94:95], v[126:127]
v_pk_mul_f32 v[124:125], v[80:81], s[34:35] op_sel:[0,1]
v_pk_mul_f32 v[126:127], v[80:81], s[30:31] op_sel:[0,1] neg_lo:[0,1] neg_hi:[0,1]
v_pk_fma_f32 v[124:125], v[82:83], s[30:31], v[124:125] op_sel:[0,1,0]
v_pk_fma_f32 v[126:127], v[82:83], s[34:35], v[126:127] op_sel:[0,1,0]
v_pk_add_f32 v[80:81], v[98:99], v[130:131] neg_lo:[0,1] neg_hi:[0,1]
v_pk_add_f32 v[82:83], v[128:129], v[96:97] neg_lo:[0,1] neg_hi:[0,1]
v_pk_add_f32 v[96:97], v[96:97], v[128:129]
v_pk_add_f32 v[98:99], v[98:99], v[130:131]
v_pk_add_f32 v[128:129], v[100:101], v[132:133] neg_lo:[0,1] neg_hi:[0,1]
v_pk_add_f32 v[130:131], v[102:103], v[134:135] neg_lo:[0,1] neg_hi:[0,1]
v_pk_add_f32 v[100:101], v[100:101], v[132:133]
v_pk_add_f32 v[102:103], v[102:103], v[134:135]
v_pk_mul_f32 v[132:133], v[128:129], s[34:35] op_sel:[0,1] neg_lo:[0,1] neg_hi:[0,1]
v_pk_mul_f32 v[134:135], v[128:129], s[30:31] op_sel:[0,1] neg_lo:[0,1] neg_hi:[0,1]
v_pk_fma_f32 v[132:133], v[130:131], s[30:31], v[132:133] op_sel:[0,1,0]
v_pk_fma_f32 v[134:135], v[130:131], s[34:35], v[134:135] op_sel:[0,1,0] neg_lo:[0,1,0] neg_hi:[0,1,0]
v_pk_add_f32 v[128:129], v[104:105], v[136:137] neg_lo:[0,1] neg_hi:[0,1]
v_pk_add_f32 v[130:131], v[106:107], v[138:139] neg_lo:[0,1] neg_hi:[0,1]
v_pk_add_f32 v[104:105], v[104:105], v[136:137]
v_pk_add_f32 v[106:107], v[106:107], v[138:139]
v_pk_mul_f32 v[136:137], v[128:129], s[32:33] op_sel:[0,1] neg_lo:[0,1] neg_hi:[0,1]
v_pk_mul_f32 v[138:139], v[128:129], s[32:33] op_sel:[0,1] neg_lo:[0,1] neg_hi:[0,1]
v_pk_fma_f32 v[136:137], v[130:131], s[32:33], v[136:137] op_sel:[0,1,0]
v_pk_fma_f32 v[138:139], v[130:131], s[32:33], v[138:139] op_sel:[0,1,0] neg_lo:[0,1,0] neg_hi:[0,1,0]
v_pk_add_f32 v[128:129], v[108:109], v[140:141] neg_lo:[0,1] neg_hi:[0,1]
v_pk_add_f32 v[130:131], v[110:111], v[142:143] neg_lo:[0,1] neg_hi:[0,1]
v_pk_add_f32 v[108:109], v[108:109], v[140:141]
v_pk_add_f32 v[110:111], v[110:111], v[142:143]
v_pk_mul_f32 v[140:141], v[128:129], s[30:31] op_sel:[0,1] neg_lo:[0,1] neg_hi:[0,1]
v_pk_mul_f32 v[142:143], v[128:129], s[34:35] op_sel:[0,1] neg_lo:[0,1] neg_hi:[0,1]
v_pk_fma_f32 v[140:141], v[130:131], s[34:35], v[140:141] op_sel:[0,1,0]
v_pk_fma_f32 v[142:143], v[130:131], s[30:31], v[142:143] op_sel:[0,1,0] neg_lo:[0,1,0] neg_hi:[0,1,0]
v_pk_add_f32 v[128:129], v[16:17], v[32:33] neg_lo:[0,1] neg_hi:[0,1]
v_pk_add_f32 v[130:131], v[18:19], v[34:35] neg_lo:[0,1] neg_hi:[0,1]
v_pk_add_f32 v[16:17], v[16:17], v[32:33]
v_pk_add_f32 v[18:19], v[18:19], v[34:35]
v_pk_add_f32 v[32:33], v[20:21], v[36:37] neg_lo:[0,1] neg_hi:[0,1]
v_pk_add_f32 v[34:35], v[22:23], v[38:39] neg_lo:[0,1] neg_hi:[0,1]
v_pk_add_f32 v[20:21], v[20:21], v[36:37]
v_pk_add_f32 v[22:23], v[22:23], v[38:39]
v_pk_mul_f32 v[36:37], v[32:33], s[32:33] op_sel:[0,1]
v_pk_mul_f32 v[38:39], v[32:33], s[32:33] op_sel:[0,1] neg_lo:[0,1] neg_hi:[0,1]
v_pk_fma_f32 v[36:37], v[34:35], s[32:33], v[36:37] op_sel:[0,1,0]
v_pk_fma_f32 v[38:39], v[34:35], s[32:33], v[38:39] op_sel:[0,1,0]
v_pk_add_f32 v[32:33], v[26:27], v[42:43] neg_lo:[0,1] neg_hi:[0,1]
v_pk_add_f32 v[34:35], v[40:41], v[24:25] neg_lo:[0,1] neg_hi:[0,1]
v_pk_add_f32 v[24:25], v[24:25], v[40:41]
v_pk_add_f32 v[26:27], v[26:27], v[42:43]
v_pk_add_f32 v[40:41], v[28:29], v[44:45] neg_lo:[0,1] neg_hi:[0,1]
v_pk_add_f32 v[42:43], v[30:31], v[46:47] neg_lo:[0,1] neg_hi:[0,1]
v_pk_add_f32 v[28:29], v[28:29], v[44:45]
v_pk_add_f32 v[30:31], v[30:31], v[46:47]
v_pk_mul_f32 v[44:45], v[40:41], s[32:33] op_sel:[0,1] neg_lo:[0,1] neg_hi:[0,1]
v_pk_mul_f32 v[46:47], v[40:41], s[32:33] op_sel:[0,1] neg_lo:[0,1] neg_hi:[0,1]
v_pk_fma_f32 v[44:45], v[42:43], s[32:33], v[44:45] op_sel:[0,1,0]
v_pk_fma_f32 v[46:47], v[42:43], s[32:33], v[46:47] op_sel:[0,1,0] neg_lo:[0,1,0] neg_hi:[0,1,0]
v_pk_add_f32 v[40:41], v[112:113], v[48:49] neg_lo:[0,1] neg_hi:[0,1]
v_pk_add_f32 v[42:43], v[114:115], v[50:51] neg_lo:[0,1] neg_hi:[0,1]
v_pk_add_f32 v[112:113], v[112:113], v[48:49]
v_pk_add_f32 v[114:115], v[114:115], v[50:51]
v_pk_add_f32 v[48:49], v[52:53], v[68:69] neg_lo:[0,1] neg_hi:[0,1]
v_pk_add_f32 v[50:51], v[54:55], v[70:71] neg_lo:[0,1] neg_hi:[0,1]
v_pk_add_f32 v[52:53], v[52:53], v[68:69]
v_pk_add_f32 v[54:55], v[54:55], v[70:71]
v_pk_mul_f32 v[68:69], v[48:49], s[32:33] op_sel:[0,1]
v_pk_mul_f32 v[70:71], v[48:49], s[32:33] op_sel:[0,1] neg_lo:[0,1] neg_hi:[0,1]
v_pk_fma_f32 v[68:69], v[50:51], s[32:33], v[68:69] op_sel:[0,1,0]
v_pk_fma_f32 v[70:71], v[50:51], s[32:33], v[70:71] op_sel:[0,1,0]
v_pk_add_f32 v[48:49], v[58:59], v[74:75] neg_lo:[0,1] neg_hi:[0,1]
v_pk_add_f32 v[50:51], v[72:73], v[56:57] neg_lo:[0,1] neg_hi:[0,1]
v_pk_add_f32 v[56:57], v[56:57], v[72:73]
v_pk_add_f32 v[58:59], v[58:59], v[74:75]
v_pk_add_f32 v[72:73], v[60:61], v[76:77] neg_lo:[0,1] neg_hi:[0,1]
v_pk_add_f32 v[74:75], v[62:63], v[78:79] neg_lo:[0,1] neg_hi:[0,1]
v_pk_add_f32 v[60:61], v[60:61], v[76:77]
v_pk_add_f32 v[62:63], v[62:63], v[78:79]
v_pk_mul_f32 v[76:77], v[72:73], s[32:33] op_sel:[0,1] neg_lo:[0,1] neg_hi:[0,1]
v_pk_mul_f32 v[78:79], v[72:73], s[32:33] op_sel:[0,1] neg_lo:[0,1] neg_hi:[0,1]
v_pk_fma_f32 v[76:77], v[74:75], s[32:33], v[76:77] op_sel:[0,1,0]
v_pk_fma_f32 v[78:79], v[74:75], s[32:33], v[78:79] op_sel:[0,1,0] neg_lo:[0,1,0] neg_hi:[0,1,0]
v_pk_add_f32 v[72:73], v[144:145], v[96:97] neg_lo:[0,1] neg_hi:[0,1]
v_pk_add_f32 v[74:75], v[146:147], v[98:99] neg_lo:[0,1] neg_hi:[0,1]
v_pk_add_f32 v[144:145], v[144:145], v[96:97]
v_pk_add_f32 v[146:147], v[146:147], v[98:99]
v_pk_add_f32 v[96:97], v[84:85], v[100:101] neg_lo:[0,1] neg_hi:[0,1]
v_pk_add_f32 v[98:99], v[86:87], v[102:103] neg_lo:[0,1] neg_hi:[0,1]
v_pk_add_f32 v[84:85], v[84:85], v[100:101]
v_pk_add_f32 v[86:87], v[86:87], v[102:103]
v_pk_mul_f32 v[100:101], v[96:97], s[32:33] op_sel:[0,1]
v_pk_mul_f32 v[102:103], v[96:97], s[32:33] op_sel:[0,1] neg_lo:[0,1] neg_hi:[0,1]
v_pk_fma_f32 v[100:101], v[98:99], s[32:33], v[100:101] op_sel:[0,1,0]
v_pk_fma_f32 v[102:103], v[98:99], s[32:33], v[102:103] op_sel:[0,1,0]
v_pk_add_f32 v[96:97], v[90:91], v[106:107] neg_lo:[0,1] neg_hi:[0,1]
v_pk_add_f32 v[98:99], v[104:105], v[88:89] neg_lo:[0,1] neg_hi:[0,1]
v_pk_add_f32 v[88:89], v[88:89], v[104:105]
v_pk_add_f32 v[90:91], v[90:91], v[106:107]
v_pk_add_f32 v[104:105], v[92:93], v[108:109] neg_lo:[0,1] neg_hi:[0,1]
v_pk_add_f32 v[106:107], v[94:95], v[110:111] neg_lo:[0,1] neg_hi:[0,1]
v_pk_add_f32 v[92:93], v[92:93], v[108:109]
v_pk_add_f32 v[94:95], v[94:95], v[110:111]
v_pk_mul_f32 v[108:109], v[104:105], s[32:33] op_sel:[0,1] neg_lo:[0,1] neg_hi:[0,1]
v_pk_mul_f32 v[110:111], v[104:105], s[32:33] op_sel:[0,1] neg_lo:[0,1] neg_hi:[0,1]
v_pk_fma_f32 v[108:109], v[106:107], s[32:33], v[108:109] op_sel:[0,1,0]
v_pk_fma_f32 v[110:111], v[106:107], s[32:33], v[110:111] op_sel:[0,1,0] neg_lo:[0,1,0] neg_hi:[0,1,0]
v_pk_add_f32 v[104:105], v[64:65], v[80:81] neg_lo:[0,1] neg_hi:[0,1]
v_pk_add_f32 v[106:107], v[66:67], v[82:83] neg_lo:[0,1] neg_hi:[0,1]
v_pk_add_f32 v[64:65], v[64:65], v[80:81]
v_pk_add_f32 v[66:67], v[66:67], v[82:83]
v_pk_add_f32 v[80:81], v[116:117], v[132:133] neg_lo:[0,1] neg_hi:[0,1]
v_pk_add_f32 v[82:83], v[118:119], v[134:135] neg_lo:[0,1] neg_hi:[0,1]
v_pk_add_f32 v[116:117], v[116:117], v[132:133]
v_pk_add_f32 v[118:119], v[118:119], v[134:135]
v_pk_mul_f32 v[132:133], v[80:81], s[32:33] op_sel:[0,1]
v_pk_mul_f32 v[134:135], v[80:81], s[32:33] op_sel:[0,1] neg_lo:[0,1] neg_hi:[0,1]
v_pk_fma_f32 v[132:133], v[82:83], s[32:33], v[132:133] op_sel:[0,1,0]
v_pk_fma_f32 v[134:135], v[82:83], s[32:33], v[134:135] op_sel:[0,1,0]
v_pk_add_f32 v[80:81], v[122:123], v[138:139] neg_lo:[0,1] neg_hi:[0,1]
v_pk_add_f32 v[82:83], v[136:137], v[120:121] neg_lo:[0,1] neg_hi:[0,1]
v_pk_add_f32 v[120:121], v[120:121], v[136:137]
v_pk_add_f32 v[122:123], v[122:123], v[138:139]
v_pk_add_f32 v[136:137], v[124:125], v[140:141] neg_lo:[0,1] neg_hi:[0,1]
v_pk_add_f32 v[138:139], v[126:127], v[142:143] neg_lo:[0,1] neg_hi:[0,1]
v_pk_add_f32 v[124:125], v[124:125], v[140:141]
v_pk_add_f32 v[126:127], v[126:127], v[142:143]
v_pk_mul_f32 v[140:141], v[136:137], s[32:33] op_sel:[0,1] neg_lo:[0,1] neg_hi:[0,1]
v_pk_mul_f32 v[142:143], v[136:137], s[32:33] op_sel:[0,1] neg_lo:[0,1] neg_hi:[0,1]
v_pk_fma_f32 v[140:141], v[138:139], s[32:33], v[140:141] op_sel:[0,1,0]
v_pk_fma_f32 v[142:143], v[138:139], s[32:33], v[142:143] op_sel:[0,1,0] neg_lo:[0,1,0] neg_hi:[0,1,0]
v_pk_add_f32 v[136:137], v[16:17], v[24:25] neg_lo:[0,1] neg_hi:[0,1]
v_pk_add_f32 v[138:139], v[18:19], v[26:27] neg_lo:[0,1] neg_hi:[0,1]
v_pk_add_f32 v[16:17], v[16:17], v[24:25]
v_pk_add_f32 v[18:19], v[18:19], v[26:27]
v_pk_add_f32 v[24:25], v[22:23], v[30:31] neg_lo:[0,1] neg_hi:[0,1]
v_pk_add_f32 v[26:27], v[28:29], v[20:21] neg_lo:[0,1] neg_hi:[0,1]
v_pk_add_f32 v[20:21], v[20:21], v[28:29]
v_pk_add_f32 v[22:23], v[22:23], v[30:31]
v_pk_add_f32 v[28:29], v[128:129], v[32:33] neg_lo:[0,1] neg_hi:[0,1]
v_pk_add_f32 v[30:31], v[130:131], v[34:35] neg_lo:[0,1] neg_hi:[0,1]
v_pk_add_f32 v[128:129], v[128:129], v[32:33]
v_pk_add_f32 v[130:131], v[130:131], v[34:35]
v_pk_add_f32 v[32:33], v[38:39], v[46:47] neg_lo:[0,1] neg_hi:[0,1]
v_pk_add_f32 v[34:35], v[44:45], v[36:37] neg_lo:[0,1] neg_hi:[0,1]
v_pk_add_f32 v[36:37], v[36:37], v[44:45]
v_pk_add_f32 v[38:39], v[38:39], v[46:47]
v_pk_add_f32 v[44:45], v[112:113], v[56:57] neg_lo:[0,1] neg_hi:[0,1]
v_pk_add_f32 v[46:47], v[114:115], v[58:59] neg_lo:[0,1] neg_hi:[0,1]
v_pk_add_f32 v[112:113], v[112:113], v[56:57]
v_pk_add_f32 v[114:115], v[114:115], v[58:59]
v_pk_add_f32 v[56:57], v[54:55], v[62:63] neg_lo:[0,1] neg_hi:[0,1]
v_pk_add_f32 v[58:59], v[60:61], v[52:53] neg_lo:[0,1] neg_hi:[0,1]
v_pk_add_f32 v[52:53], v[52:53], v[60:61]
v_pk_add_f32 v[54:55], v[54:55], v[62:63]
v_pk_add_f32 v[60:61], v[40:41], v[48:49] neg_lo:[0,1] neg_hi:[0,1]
v_pk_add_f32 v[62:63], v[42:43], v[50:51] neg_lo:[0,1] neg_hi:[0,1]
v_pk_add_f32 v[40:41], v[40:41], v[48:49]
v_pk_add_f32 v[42:43], v[42:43], v[50:51]
v_pk_add_f32 v[48:49], v[70:71], v[78:79] neg_lo:[0,1] neg_hi:[0,1]
v_pk_add_f32 v[50:51], v[76:77], v[68:69] neg_lo:[0,1] neg_hi:[0,1]
v_pk_add_f32 v[68:69], v[68:69], v[76:77]
v_pk_add_f32 v[70:71], v[70:71], v[78:79]
v_pk_add_f32 v[76:77], v[144:145], v[88:89] neg_lo:[0,1] neg_hi:[0,1]
v_pk_add_f32 v[78:79], v[146:147], v[90:91] neg_lo:[0,1] neg_hi:[0,1]
v_pk_add_f32 v[144:145], v[144:145], v[88:89]
v_pk_add_f32 v[146:147], v[146:147], v[90:91]
v_pk_add_f32 v[88:89], v[86:87], v[94:95] neg_lo:[0,1] neg_hi:[0,1]
v_pk_add_f32 v[90:91], v[92:93], v[84:85] neg_lo:[0,1] neg_hi:[0,1]
v_pk_add_f32 v[84:85], v[84:85], v[92:93]
v_pk_add_f32 v[86:87], v[86:87], v[94:95]
v_pk_add_f32 v[92:93], v[72:73], v[96:97] neg_lo:[0,1] neg_hi:[0,1]
v_pk_add_f32 v[94:95], v[74:75], v[98:99] neg_lo:[0,1] neg_hi:[0,1]
v_pk_add_f32 v[72:73], v[72:73], v[96:97]
v_pk_add_f32 v[74:75], v[74:75], v[98:99]
v_pk_add_f32 v[96:97], v[102:103], v[110:111] neg_lo:[0,1] neg_hi:[0,1]
v_pk_add_f32 v[98:99], v[108:109], v[100:101] neg_lo:[0,1] neg_hi:[0,1]
v_pk_add_f32 v[100:101], v[100:101], v[108:109]
v_pk_add_f32 v[102:103], v[102:103], v[110:111]
v_pk_add_f32 v[108:109], v[64:65], v[120:121] neg_lo:[0,1] neg_hi:[0,1]
v_pk_add_f32 v[110:111], v[66:67], v[122:123] neg_lo:[0,1] neg_hi:[0,1]
v_pk_add_f32 v[64:65], v[64:65], v[120:121]
v_pk_add_f32 v[66:67], v[66:67], v[122:123]
v_pk_add_f32 v[120:121], v[118:119], v[126:127] neg_lo:[0,1] neg_hi:[0,1]
v_pk_add_f32 v[122:123], v[124:125], v[116:117] neg_lo:[0,1] neg_hi:[0,1]
v_pk_add_f32 v[116:117], v[116:117], v[124:125]
v_pk_add_f32 v[118:119], v[118:119], v[126:127]
v_pk_add_f32 v[124:125], v[104:105], v[80:81] neg_lo:[0,1] neg_hi:[0,1]
v_pk_add_f32 v[126:127], v[106:107], v[82:83] neg_lo:[0,1] neg_hi:[0,1]
v_pk_add_f32 v[104:105], v[104:105], v[80:81]
v_pk_add_f32 v[106:107], v[106:107], v[82:83]
v_pk_add_f32 v[80:81], v[134:135], v[142:143] neg_lo:[0,1] neg_hi:[0,1]
v_pk_add_f32 v[82:83], v[140:141], v[132:133] neg_lo:[0,1] neg_hi:[0,1]
v_pk_add_f32 v[132:133], v[132:133], v[140:141]
v_pk_add_f32 v[134:135], v[134:135], v[142:143]
v_pk_add_f32 v[140:141], v[16:17], v[20:21] neg_lo:[0,1] neg_hi:[0,1]
v_pk_add_f32 v[142:143], v[18:19], v[22:23] neg_lo:[0,1] neg_hi:[0,1]
v_pk_add_f32 v[16:17], v[16:17], v[20:21]
v_pk_add_f32 v[18:19], v[18:19], v[22:23]
v_pk_add_f32 v[20:21], v[136:137], v[24:25] neg_lo:[0,1] neg_hi:[0,1]
v_pk_add_f32 v[22:23], v[138:139], v[26:27] neg_lo:[0,1] neg_hi:[0,1]
v_pk_add_f32 v[136:137], v[136:137], v[24:25]
v_pk_add_f32 v[138:139], v[138:139], v[26:27]
v_pk_add_f32 v[24:25], v[128:129], v[36:37] neg_lo:[0,1] neg_hi:[0,1]
v_pk_add_f32 v[26:27], v[130:131], v[38:39] neg_lo:[0,1] neg_hi:[0,1]
v_pk_add_f32 v[128:129], v[128:129], v[36:37]
v_pk_add_f32 v[130:131], v[130:131], v[38:39]
v_pk_add_f32 v[36:37], v[28:29], v[32:33] neg_lo:[0,1] neg_hi:[0,1]
v_pk_add_f32 v[38:39], v[30:31], v[34:35] neg_lo:[0,1] neg_hi:[0,1]
v_pk_add_f32 v[28:29], v[28:29], v[32:33]
v_pk_add_f32 v[30:31], v[30:31], v[34:35]
v_pk_add_f32 v[32:33], v[112:113], v[52:53] neg_lo:[0,1] neg_hi:[0,1]
v_pk_add_f32 v[34:35], v[114:115], v[54:55] neg_lo:[0,1] neg_hi:[0,1]
v_pk_add_f32 v[112:113], v[112:113], v[52:53]
v_pk_add_f32 v[114:115], v[114:115], v[54:55]
v_pk_add_f32 v[52:53], v[44:45], v[56:57] neg_lo:[0,1] neg_hi:[0,1]
v_pk_add_f32 v[54:55], v[46:47], v[58:59] neg_lo:[0,1] neg_hi:[0,1]
v_pk_add_f32 v[44:45], v[44:45], v[56:57]
v_pk_add_f32 v[46:47], v[46:47], v[58:59]
v_pk_add_f32 v[56:57], v[40:41], v[68:69] neg_lo:[0,1] neg_hi:[0,1]
v_pk_add_f32 v[58:59], v[42:43], v[70:71] neg_lo:[0,1] neg_hi:[0,1]
v_pk_add_f32 v[40:41], v[40:41], v[68:69]
v_pk_add_f32 v[42:43], v[42:43], v[70:71]
v_pk_add_f32 v[68:69], v[60:61], v[48:49] neg_lo:[0,1] neg_hi:[0,1]
v_pk_add_f32 v[70:71], v[62:63], v[50:51] neg_lo:[0,1] neg_hi:[0,1]
v_pk_add_f32 v[60:61], v[60:61], v[48:49]
v_pk_add_f32 v[62:63], v[62:63], v[50:51]
v_pk_add_f32 v[48:49], v[144:145], v[84:85] neg_lo:[0,1] neg_hi:[0,1]
v_pk_add_f32 v[50:51], v[146:147], v[86:87] neg_lo:[0,1] neg_hi:[0,1]
v_pk_add_f32 v[144:145], v[144:145], v[84:85]
v_pk_add_f32 v[146:147], v[146:147], v[86:87]
v_pk_add_f32 v[84:85], v[76:77], v[88:89] neg_lo:[0,1] neg_hi:[0,1]
v_pk_add_f32 v[86:87], v[78:79], v[90:91] neg_lo:[0,1] neg_hi:[0,1]
v_pk_add_f32 v[76:77], v[76:77], v[88:89]
v_pk_add_f32 v[78:79], v[78:79], v[90:91]
v_pk_add_f32 v[88:89], v[72:73], v[100:101] neg_lo:[0,1] neg_hi:[0,1]
v_pk_add_f32 v[90:91], v[74:75], v[102:103] neg_lo:[0,1] neg_hi:[0,1]
v_pk_add_f32 v[72:73], v[72:73], v[100:101]
v_pk_add_f32 v[74:75], v[74:75], v[102:103]
v_pk_add_f32 v[100:101], v[92:93], v[96:97] neg_lo:[0,1] neg_hi:[0,1]
v_pk_add_f32 v[102:103], v[94:95], v[98:99] neg_lo:[0,1] neg_hi:[0,1]
v_pk_add_f32 v[92:93], v[92:93], v[96:97]
v_pk_add_f32 v[94:95], v[94:95], v[98:99]
v_pk_add_f32 v[96:97], v[64:65], v[116:117] neg_lo:[0,1] neg_hi:[0,1]
v_pk_add_f32 v[98:99], v[66:67], v[118:119] neg_lo:[0,1] neg_hi:[0,1]
v_pk_add_f32 v[64:65], v[64:65], v[116:117]
v_pk_add_f32 v[66:67], v[66:67], v[118:119]
v_pk_add_f32 v[116:117], v[108:109], v[120:121] neg_lo:[0,1] neg_hi:[0,1]
v_pk_add_f32 v[118:119], v[110:111], v[122:123] neg_lo:[0,1] neg_hi:[0,1]
v_pk_add_f32 v[108:109], v[108:109], v[120:121]
v_pk_add_f32 v[110:111], v[110:111], v[122:123]
v_pk_add_f32 v[120:121], v[104:105], v[132:133] neg_lo:[0,1] neg_hi:[0,1]
v_pk_add_f32 v[122:123], v[106:107], v[134:135] neg_lo:[0,1] neg_hi:[0,1]
v_pk_add_f32 v[104:105], v[104:105], v[132:133]
v_pk_add_f32 v[106:107], v[106:107], v[134:135]
v_pk_add_f32 v[132:133], v[124:125], v[80:81] neg_lo:[0,1] neg_hi:[0,1]
v_pk_add_f32 v[134:135], v[126:127], v[82:83] neg_lo:[0,1] neg_hi:[0,1]
v_pk_add_f32 v[124:125], v[124:125], v[80:81]
v_pk_add_f32 v[126:127], v[126:127], v[82:83]
v_mul_f32 v151, 0xba800000, v3
v_cos_f32 v150, v151
v_sin_f32 v151, v151
v_mul_f32 v149, 0xbb000000, v3
v_cos_f32 v148, v149
v_sin_f32 v149, v149
v_pk_mul_f32 v[80:81], v[144:145], v[150:151] op_sel_hi:[1,0]
v_pk_fma_f32 v[80:81], v[146:147], v[150:151], v[80:81] op_sel:[0,1,0] neg_lo:[1,0,0] neg_hi:[1,0,0]
v_pk_mul_f32 v[146:147], v[146:147], v[150:151] op_sel_hi:[1,0]
v_pk_fma_f32 v[146:147], v[144:145], v[150:151], v[146:147] op_sel:[0,1,0]
v_mul_f32 v151, 0xbb400000, v3
v_cos_f32 v150, v151
v_sin_f32 v151, v151
v_pk_mul_f32 v[144:145], v[112:113], v[148:149] op_sel_hi:[1,0]
v_pk_fma_f32 v[144:145], v[114:115], v[148:149], v[144:145] op_sel:[0,1,0] neg_lo:[1,0,0] neg_hi:[1,0,0]
v_pk_mul_f32 v[114:115], v[114:115], v[148:149] op_sel_hi:[1,0]
v_pk_fma_f32 v[114:115], v[112:113], v[148:149], v[114:115] op_sel:[0,1,0]
v_mul_f32 v149, 0xbb800000, v3
v_cos_f32 v148, v149
v_sin_f32 v149, v149
v_pk_mul_f32 v[112:113], v[64:65], v[150:151] op_sel_hi:[1,0]
v_pk_fma_f32 v[112:113], v[66:67], v[150:151], v[112:113] op_sel:[0,1,0] neg_lo:[1,0,0] neg_hi:[1,0,0]
v_pk_mul_f32 v[66:67], v[66:67], v[150:151] op_sel_hi:[1,0]
v_pk_fma_f32 v[66:67], v[64:65], v[150:151], v[66:67] op_sel:[0,1,0]
v_mul_f32 v151, 0xbba00000, v3
v_cos_f32 v150, v151
v_sin_f32 v151, v151
v_pk_mul_f32 v[64:65], v[128:129], v[148:149] op_sel_hi:[1,0]
v_pk_fma_f32 v[64:65], v[130:131], v[148:149], v[64:65] op_sel:[0,1,0] neg_lo:[1,0,0] neg_hi:[1,0,0]
v_pk_mul_f32 v[130:131], v[130:131], v[148:149] op_sel_hi:[1,0]
v_pk_fma_f32 v[130:131], v[128:129], v[148:149], v[130:131] op_sel:[0,1,0]
v_mul_f32 v149, 0xbbc00000, v3
v_cos_f32 v148, v149
v_sin_f32 v149, v149
v_pk_mul_f32 v[128:129], v[72:73], v[150:151] op_sel_hi:[1,0]
v_pk_fma_f32 v[128:129], v[74:75], v[150:151], v[128:129] op_sel:[0,1,0] neg_lo:[1,0,0] neg_hi:[1,0,0]
v_pk_mul_f32 v[74:75], v[74:75], v[150:151] op_sel_hi:[1,0]
v_pk_fma_f32 v[74:75], v[72:73], v[150:151], v[74:75] op_sel:[0,1,0]
v_mul_f32 v151, 0xbbe00000, v3
v_cos_f32 v150, v151
v_sin_f32 v151, v151
v_pk_mul_f32 v[72:73], v[40:41], v[148:149] op_sel_hi:[1,0]
v_pk_fma_f32 v[72:73], v[42:43], v[148:149], v[72:73] op_sel:[0,1,0] neg_lo:[1,0,0] neg_hi:[1,0,0]
v_pk_mul_f32 v[42:43], v[42:43], v[148:149] op_sel_hi:[1,0]
v_pk_fma_f32 v[42:43], v[40:41], v[148:149], v[42:43] op_sel:[0,1,0]
v_mul_f32 v149, 0xbc000000, v3
v_cos_f32 v148, v149
v_sin_f32 v149, v149
v_pk_mul_f32 v[40:41], v[104:105], v[150:151] op_sel_hi:[1,0]
v_pk_fma_f32 v[40:41], v[106:107], v[150:151], v[40:41] op_sel:[0,1,0] neg_lo:[1,0,0] neg_hi:[1,0,0]
v_pk_mul_f32 v[106:107], v[106:107], v[150:151] op_sel_hi:[1,0]
v_pk_fma_f32 v[106:107], v[104:105], v[150:151], v[106:107] op_sel:[0,1,0]
v_mul_f32 v151, 0xbc100000, v3
v_cos_f32 v150, v151
v_sin_f32 v151, v151
v_pk_mul_f32 v[104:105], v[136:137], v[148:149] op_sel_hi:[1,0]
v_pk_fma_f32 v[104:105], v[138:139], v[148:149], v[104:105] op_sel:[0,1,0] neg_lo:[1,0,0] neg_hi:[1,0,0]
v_pk_mul_f32 v[138:139], v[138:139], v[148:149] op_sel_hi:[1,0]
v_pk_fma_f32 v[138:139], v[136:137], v[148:149], v[138:139] op_sel:[0,1,0]
v_mul_f32 v149, 0xbc200000, v3
v_cos_f32 v148, v149
v_sin_f32 v149, v149
v_pk_mul_f32 v[136:137], v[76:77], v[150:151] op_sel_hi:[1,0]
v_pk_fma_f32 v[136:137], v[78:79], v[150:151], v[136:137] op_sel:[0,1,0] neg_lo:[1,0,0] neg_hi:[1,0,0]
v_pk_mul_f32 v[78:79], v[78:79], v[150:151] op_sel_hi:[1,0]
v_pk_fma_f32 v[78:79], v[76:77], v[150:151], v[78:79] op_sel:[0,1,0]
v_mul_f32 v151, 0xbc300000, v3
v_cos_f32 v150, v151
v_sin_f32 v151, v151
v_pk_mul_f32 v[76:77], v[44:45], v[148:149] op_sel_hi:[1,0]
v_pk_fma_f32 v[76:77], v[46:47], v[148:149], v[76:77] op_sel:[0,1,0] neg_lo:[1,0,0] neg_hi:[1,0,0]
v_pk_mul_f32 v[46:47], v[46:47], v[148:149] op_sel_hi:[1,0]
v_pk_fma_f32 v[46:47], v[44:45], v[148:149], v[46:47] op_sel:[0,1,0]
v_mul_f32 v149, 0xbc400000, v3
v_cos_f32 v148, v149
v_sin_f32 v149, v149
v_pk_mul_f32 v[44:45], v[108:109], v[150:151] op_sel_hi:[1,0]
v_pk_fma_f32 v[44:45], v[110:111], v[150:151], v[44:45] op_sel:[0,1,0] neg_lo:[1,0,0] neg_hi:[1,0,0]
v_pk_mul_f32 v[110:111], v[110:111], v[150:151] op_sel_hi:[1,0]
v_pk_fma_f32 v[110:111], v[108:109], v[150:151], v[110:111] op_sel:[0,1,0]
v_mul_f32 v151, 0xbc500000, v3
v_cos_f32 v150, v151
v_sin_f32 v151, v151
v_pk_mul_f32 v[108:109], v[28:29], v[148:149] op_sel_hi:[1,0]
v_pk_fma_f32 v[108:109], v[30:31], v[148:149], v[108:109] op_sel:[0,1,0] neg_lo:[1,0,0] neg_hi:[1,0,0]
v_pk_mul_f32 v[30:31], v[30:31], v[148:149] op_sel_hi:[1,0]
v_pk_fma_f32 v[30:31], v[28:29], v[148:149], v[30:31] op_sel:[0,1,0]
v_mul_f32 v149, 0xbc600000, v3
v_cos_f32 v148, v149
v_sin_f32 v149, v149
v_pk_mul_f32 v[28:29], v[92:93], v[150:151] op_sel_hi:[1,0]
v_pk_fma_f32 v[28:29], v[94:95], v[150:151], v[28:29] op_sel:[0,1,0] neg_lo:[1,0,0] neg_hi:[1,0,0]
v_pk_mul_f32 v[94:95], v[94:95], v[150:151] op_sel_hi:[1,0]
v_pk_fma_f32 v[94:95], v[92:93], v[150:151], v[94:95] op_sel:[0,1,0]
v_mul_f32 v151, 0xbc700000, v3
v_cos_f32 v150, v151
v_sin_f32 v151, v151
v_pk_mul_f32 v[92:93], v[60:61], v[148:149] op_sel_hi:[1,0]
v_pk_fma_f32 v[92:93], v[62:63], v[148:149], v[92:93] op_sel:[0,1,0] neg_lo:[1,0,0] neg_hi:[1,0,0]
v_pk_mul_f32 v[62:63], v[62:63], v[148:149] op_sel_hi:[1,0]
v_pk_fma_f32 v[62:63], v[60:61], v[148:149], v[62:63] op_sel:[0,1,0]
v_mul_f32 v149, 0xbc800000, v3
v_cos_f32 v148, v149
v_sin_f32 v149, v149
v_pk_mul_f32 v[60:61], v[124:125], v[150:151] op_sel_hi:[1,0]
v_pk_fma_f32 v[60:61], v[126:127], v[150:151], v[60:61] op_sel:[0,1,0] neg_lo:[1,0,0] neg_hi:[1,0,0]
v_pk_mul_f32 v[126:127], v[126:127], v[150:151] op_sel_hi:[1,0]
v_pk_fma_f32 v[126:127], v[124:125], v[150:151], v[126:127] op_sel:[0,1,0]
v_mul_f32 v151, 0xbc880000, v3
v_cos_f32 v150, v151
v_sin_f32 v151, v151
v_pk_mul_f32 v[124:125], v[140:141], v[148:149] op_sel_hi:[1,0]
v_pk_fma_f32 v[124:125], v[142:143], v[148:149], v[124:125] op_sel:[0,1,0] neg_lo:[1,0,0] neg_hi:[1,0,0]
v_pk_mul_f32 v[142:143], v[142:143], v[148:149] op_sel_hi:[1,0]
v_pk_fma_f32 v[142:143], v[140:141], v[148:149], v[142:143] op_sel:[0,1,0]
v_mul_f32 v149, 0xbc900000, v3
v_cos_f32 v148, v149
v_sin_f32 v149, v149
v_pk_mul_f32 v[140:141], v[48:49], v[150:151] op_sel_hi:[1,0]
v_pk_fma_f32 v[140:141], v[50:51], v[150:151], v[140:141] op_sel:[0,1,0] neg_lo:[1,0,0] neg_hi:[1,0,0]
v_pk_mul_f32 v[50:51], v[50:51], v[150:151] op_sel_hi:[1,0]
v_pk_fma_f32 v[50:51], v[48:49], v[150:151], v[50:51] op_sel:[0,1,0]
v_mul_f32 v151, 0xbc980000, v3
v_cos_f32 v150, v151
v_sin_f32 v151, v151
v_pk_mul_f32 v[48:49], v[32:33], v[148:149] op_sel_hi:[1,0]
v_pk_fma_f32 v[48:49], v[34:35], v[148:149], v[48:49] op_sel:[0,1,0] neg_lo:[1,0,0] neg_hi:[1,0,0]
v_pk_mul_f32 v[34:35], v[34:35], v[148:149] op_sel_hi:[1,0]
v_pk_fma_f32 v[34:35], v[32:33], v[148:149], v[34:35] op_sel:[0,1,0]
v_mul_f32 v149, 0xbca00000, v3
v_cos_f32 v148, v149
v_sin_f32 v149, v149
v_pk_mul_f32 v[32:33], v[96:97], v[150:151] op_sel_hi:[1,0]
v_pk_fma_f32 v[32:33], v[98:99], v[150:151], v[32:33] op_sel:[0,1,0] neg_lo:[1,0,0] neg_hi:[1,0,0]
v_pk_mul_f32 v[98:99], v[98:99], v[150:151] op_sel_hi:[1,0]
v_pk_fma_f32 v[98:99], v[96:97], v[150:151], v[98:99] op_sel:[0,1,0]
v_mul_f32 v151, 0xbca80000, v3
v_cos_f32 v150, v151
v_sin_f32 v151, v151
v_pk_mul_f32 v[96:97], v[24:25], v[148:149] op_sel_hi:[1,0]
v_pk_fma_f32 v[96:97], v[26:27], v[148:149], v[96:97] op_sel:[0,1,0] neg_lo:[1,0,0] neg_hi:[1,0,0]
v_pk_mul_f32 v[26:27], v[26:27], v[148:149] op_sel_hi:[1,0]
v_pk_fma_f32 v[26:27], v[24:25], v[148:149], v[26:27] op_sel:[0,1,0]
v_mul_f32 v149, 0xbcb00000, v3
v_cos_f32 v148, v149
v_sin_f32 v149, v149
v_pk_mul_f32 v[24:25], v[88:89], v[150:151] op_sel_hi:[1,0]
v_pk_fma_f32 v[24:25], v[90:91], v[150:151], v[24:25] op_sel:[0,1,0] neg_lo:[1,0,0] neg_hi:[1,0,0]
v_pk_mul_f32 v[90:91], v[90:91], v[150:151] op_sel_hi:[1,0]
v_pk_fma_f32 v[90:91], v[88:89], v[150:151], v[90:91] op_sel:[0,1,0]
v_mul_f32 v151, 0xbcb80000, v3
v_cos_f32 v150, v151
v_sin_f32 v151, v151
v_pk_mul_f32 v[88:89], v[56:57], v[148:149] op_sel_hi:[1,0]
v_pk_fma_f32 v[88:89], v[58:59], v[148:149], v[88:89] op_sel:[0,1,0] neg_lo:[1,0,0] neg_hi:[1,0,0]
v_pk_mul_f32 v[58:59], v[58:59], v[148:149] op_sel_hi:[1,0]
v_pk_fma_f32 v[58:59], v[56:57], v[148:149], v[58:59] op_sel:[0,1,0]
v_mul_f32 v149, 0xbcc00000, v3
v_cos_f32 v148, v149
v_sin_f32 v149, v149
v_pk_mul_f32 v[56:57], v[120:121], v[150:151] op_sel_hi:[1,0]
v_pk_fma_f32 v[56:57], v[122:123], v[150:151], v[56:57] op_sel:[0,1,0] neg_lo:[1,0,0] neg_hi:[1,0,0]
v_pk_mul_f32 v[122:123], v[122:123], v[150:151] op_sel_hi:[1,0]
v_pk_fma_f32 v[122:123], v[120:121], v[150:151], v[122:123] op_sel:[0,1,0]
v_mul_f32 v151, 0xbcc80000, v3
v_cos_f32 v150, v151
v_sin_f32 v151, v151
v_pk_mul_f32 v[120:121], v[20:21], v[148:149] op_sel_hi:[1,0]
v_pk_fma_f32 v[120:121], v[22:23], v[148:149], v[120:121] op_sel:[0,1,0] neg_lo:[1,0,0] neg_hi:[1,0,0]
v_pk_mul_f32 v[22:23], v[22:23], v[148:149] op_sel_hi:[1,0]
v_pk_fma_f32 v[22:23], v[20:21], v[148:149], v[22:23] op_sel:[0,1,0]
v_mul_f32 v149, 0xbcd00000, v3
v_cos_f32 v148, v149
v_sin_f32 v149, v149
v_pk_mul_f32 v[20:21], v[84:85], v[150:151] op_sel_hi:[1,0]
v_pk_fma_f32 v[20:21], v[86:87], v[150:151], v[20:21] op_sel:[0,1,0] neg_lo:[1,0,0] neg_hi:[1,0,0]
v_pk_mul_f32 v[86:87], v[86:87], v[150:151] op_sel_hi:[1,0]
v_pk_fma_f32 v[86:87], v[84:85], v[150:151], v[86:87] op_sel:[0,1,0]
v_mul_f32 v151, 0xbcd80000, v3
v_cos_f32 v150, v151
v_sin_f32 v151, v151
v_pk_mul_f32 v[84:85], v[52:53], v[148:149] op_sel_hi:[1,0]
v_pk_fma_f32 v[84:85], v[54:55], v[148:149], v[84:85] op_sel:[0,1,0] neg_lo:[1,0,0] neg_hi:[1,0,0]
v_pk_mul_f32 v[54:55], v[54:55], v[148:149] op_sel_hi:[1,0]
v_pk_fma_f32 v[54:55], v[52:53], v[148:149], v[54:55] op_sel:[0,1,0]
v_mul_f32 v149, 0xbce00000, v3
v_cos_f32 v148, v149
v_sin_f32 v149, v149
v_pk_mul_f32 v[52:53], v[116:117], v[150:151] op_sel_hi:[1,0]
v_pk_fma_f32 v[52:53], v[118:119], v[150:151], v[52:53] op_sel:[0,1,0] neg_lo:[1,0,0] neg_hi:[1,0,0]
v_pk_mul_f32 v[118:119], v[118:119], v[150:151] op_sel_hi:[1,0]
v_pk_fma_f32 v[118:119], v[116:117], v[150:151], v[118:119] op_sel:[0,1,0]
v_mul_f32 v151, 0xbce80000, v3
v_cos_f32 v150, v151
v_sin_f32 v151, v151
v_pk_mul_f32 v[116:117], v[36:37], v[148:149] op_sel_hi:[1,0]
v_pk_fma_f32 v[116:117], v[38:39], v[148:149], v[116:117] op_sel:[0,1,0] neg_lo:[1,0,0] neg_hi:[1,0,0]
v_pk_mul_f32 v[38:39], v[38:39], v[148:149] op_sel_hi:[1,0]
v_pk_fma_f32 v[38:39], v[36:37], v[148:149], v[38:39] op_sel:[0,1,0]
v_mul_f32 v149, 0xbcf00000, v3
v_cos_f32 v148, v149
v_sin_f32 v149, v149
v_pk_mul_f32 v[36:37], v[100:101], v[150:151] op_sel_hi:[1,0]
v_pk_fma_f32 v[36:37], v[102:103], v[150:151], v[36:37] op_sel:[0,1,0] neg_lo:[1,0,0] neg_hi:[1,0,0]
v_pk_mul_f32 v[102:103], v[102:103], v[150:151] op_sel_hi:[1,0]
v_pk_fma_f32 v[102:103], v[100:101], v[150:151], v[102:103] op_sel:[0,1,0]
v_mul_f32 v151, 0xbcf80000, v3
v_cos_f32 v150, v151
v_sin_f32 v151, v151
v_pk_mul_f32 v[100:101], v[68:69], v[148:149] op_sel_hi:[1,0]
v_pk_fma_f32 v[100:101], v[70:71], v[148:149], v[100:101] op_sel:[0,1,0] neg_lo:[1,0,0] neg_hi:[1,0,0]
v_pk_mul_f32 v[70:71], v[70:71], v[148:149] op_sel_hi:[1,0]
v_pk_fma_f32 v[70:71], v[68:69], v[148:149], v[70:71] op_sel:[0,1,0]
s_nop 0
v_pk_mul_f32 v[68:69], v[132:133], v[150:151] op_sel_hi:[1,0]
v_pk_fma_f32 v[68:69], v[134:135], v[150:151], v[68:69] op_sel:[0,1,0] neg_lo:[1,0,0] neg_hi:[1,0,0]
v_pk_mul_f32 v[134:135], v[134:135], v[150:151] op_sel_hi:[1,0]
v_pk_fma_f32 v[134:135], v[132:133], v[150:151], v[134:135] op_sel:[0,1,0]
ds_write_b64 v4, v[16:17]
ds_write_b64 v4, v[18:19] offset:8
ds_write_b64 v4, v[80:81] offset:528
ds_write_b64 v4, v[146:147] offset:536
ds_write_b64 v4, v[144:145] offset:1056
ds_write_b64 v4, v[114:115] offset:1064
ds_write_b64 v4, v[112:113] offset:1584
ds_write_b64 v4, v[66:67] offset:1592
ds_write_b64 v4, v[64:65] offset:2112
ds_write_b64 v4, v[130:131] offset:2120
ds_write_b64 v4, v[128:129] offset:2640
ds_write_b64 v4, v[74:75] offset:2648
ds_write_b64 v4, v[72:73] offset:3168
ds_write_b64 v4, v[42:43] offset:3176
ds_write_b64 v4, v[40:41] offset:3696
ds_write_b64 v4, v[106:107] offset:3704
ds_write_b64 v4, v[104:105] offset:4224
ds_write_b64 v4, v[138:139] offset:4232
ds_write_b64 v4, v[136:137] offset:4752
ds_write_b64 v4, v[78:79] offset:4760
ds_write_b64 v4, v[76:77] offset:5280
ds_write_b64 v4, v[46:47] offset:5288
ds_write_b64 v4, v[44:45] offset:5808
ds_write_b64 v4, v[110:111] offset:5816
ds_write_b64 v4, v[108:109] offset:6336
ds_write_b64 v4, v[30:31] offset:6344
ds_write_b64 v4, v[28:29] offset:6864
ds_write_b64 v4, v[94:95] offset:6872
ds_write_b64 v4, v[92:93] offset:7392
ds_write_b64 v4, v[62:63] offset:7400
ds_write_b64 v4, v[60:61] offset:7920
ds_write_b64 v4, v[126:127] offset:7928
ds_write_b64 v4, v[124:125] offset:8448
ds_write_b64 v4, v[142:143] offset:8456
ds_write_b64 v4, v[140:141] offset:8976
ds_write_b64 v4, v[50:51] offset:8984
ds_write_b64 v4, v[48:49] offset:9504
ds_write_b64 v4, v[34:35] offset:9512
ds_write_b64 v4, v[32:33] offset:10032
ds_write_b64 v4, v[98:99] offset:10040
ds_write_b64 v4, v[96:97] offset:10560
ds_write_b64 v4, v[26:27] offset:10568
ds_write_b64 v4, v[24:25] offset:11088
ds_write_b64 v4, v[90:91] offset:11096
ds_write_b64 v4, v[88:89] offset:11616
ds_write_b64 v4, v[58:59] offset:11624
ds_write_b64 v4, v[56:57] offset:12144
ds_write_b64 v4, v[122:123] offset:12152
ds_write_b64 v4, v[120:121] offset:12672
ds_write_b64 v4, v[22:23] offset:12680
ds_write_b64 v4, v[20:21] offset:13200
ds_write_b64 v4, v[86:87] offset:13208
ds_write_b64 v4, v[84:85] offset:13728
ds_write_b64 v4, v[54:55] offset:13736
ds_write_b64 v4, v[52:53] offset:14256
ds_write_b64 v4, v[118:119] offset:14264
ds_write_b64 v4, v[116:117] offset:14784
ds_write_b64 v4, v[38:39] offset:14792
ds_write_b64 v4, v[36:37] offset:15312
ds_write_b64 v4, v[102:103] offset:15320
ds_write_b64 v4, v[100:101] offset:15840
ds_write_b64 v4, v[70:71] offset:15848
ds_write_b64 v4, v[68:69] offset:16368
ds_write_b64 v4, v[134:135] offset:16376
s_waitcnt lgkmcnt(0)
ds_read_b128 v[16:19], v5
ds_read_b128 v[20:23], v5 offset:16
ds_read_b128 v[24:27], v5 offset:32
ds_read_b128 v[28:31], v5 offset:48
ds_read_b128 v[32:35], v5 offset:64
ds_read_b128 v[36:39], v5 offset:80
ds_read_b128 v[40:43], v5 offset:96
ds_read_b128 v[44:47], v5 offset:112
ds_read_b128 v[48:51], v5 offset:128
ds_read_b128 v[52:55], v5 offset:144
ds_read_b128 v[56:59], v5 offset:160
ds_read_b128 v[60:63], v5 offset:176
s_waitcnt lgkmcnt(4)
ds_read_b128 v[64:67], v5 offset:192
ds_read_b128 v[68:71], v5 offset:208
ds_read_b128 v[72:75], v5 offset:224
ds_read_b128 v[76:79], v5 offset:240
ds_read_b128 v[80:83], v5 offset:256
ds_read_b128 v[84:87], v5 offset:272
ds_read_b128 v[88:91], v5 offset:288
ds_read_b128 v[92:95], v5 offset:304
ds_read_b128 v[96:99], v5 offset:320
ds_read_b128 v[100:103], v5 offset:336
ds_read_b128 v[104:107], v5 offset:352
ds_read_b128 v[108:111], v5 offset:368
s_waitcnt lgkmcnt(4)
ds_read_b128 v[112:115], v5 offset:384
ds_read_b128 v[116:119], v5 offset:400
ds_read_b128 v[120:123], v5 offset:416
ds_read_b128 v[124:127], v5 offset:432
ds_read_b128 v[128:131], v5 offset:448
ds_read_b128 v[132:135], v5 offset:464
ds_read_b128 v[136:139], v5 offset:480
ds_read_b128 v[140:143], v5 offset:496
s_waitcnt lgkmcnt(0)
v_pk_add_f32 v[144:145], v[16:17], v[80:81] neg_lo:[0,1] neg_hi:[0,1]
v_pk_add_f32 v[146:147], v[18:19], v[82:83] neg_lo:[0,1] neg_hi:[0,1]
v_pk_add_f32 v[16:17], v[16:17], v[80:81]
v_pk_add_f32 v[18:19], v[18:19], v[82:83]
v_pk_add_f32 v[80:81], v[20:21], v[84:85] neg_lo:[0,1] neg_hi:[0,1]
v_pk_add_f32 v[82:83], v[22:23], v[86:87] neg_lo:[0,1] neg_hi:[0,1]
v_pk_add_f32 v[20:21], v[20:21], v[84:85]
v_pk_add_f32 v[22:23], v[22:23], v[86:87]
v_pk_mul_f32 v[84:85], v[80:81], s[30:31] op_sel_hi:[1,0]
v_pk_mul_f32 v[86:87], v[80:81], s[36:37] op_sel_hi:[1,0] neg_lo:[0,1] neg_hi:[0,1]
v_pk_fma_f32 v[84:85], v[82:83], s[36:37], v[84:85] op_sel_hi:[1,0,1]
v_pk_fma_f32 v[86:87], v[82:83], s[30:31], v[86:87] op_sel_hi:[1,0,1]
v_pk_add_f32 v[80:81], v[24:25], v[88:89] neg_lo:[0,1] neg_hi:[0,1]
v_pk_add_f32 v[82:83], v[26:27], v[90:91] neg_lo:[0,1] neg_hi:[0,1]
v_pk_add_f32 v[24:25], v[24:25], v[88:89]
v_pk_add_f32 v[26:27], v[26:27], v[90:91]
v_pk_mul_f32 v[88:89], v[80:81], s[30:31] op_sel:[0,1]
v_pk_mul_f32 v[90:91], v[80:81], s[34:35] op_sel:[0,1] neg_lo:[0,1] neg_hi:[0,1]
v_pk_fma_f32 v[88:89], v[82:83], s[34:35], v[88:89] op_sel:[0,1,0]
v_pk_fma_f32 v[90:91], v[82:83], s[30:31], v[90:91] op_sel:[0,1,0]
v_pk_add_f32 v[80:81], v[28:29], v[92:93] neg_lo:[0,1] neg_hi:[0,1]
v_pk_add_f32 v[82:83], v[30:31], v[94:95] neg_lo:[0,1] neg_hi:[0,1]
v_pk_add_f32 v[28:29], v[28:29], v[92:93]
v_pk_add_f32 v[30:31], v[30:31], v[94:95]
v_pk_mul_f32 v[92:93], v[80:81], s[32:33] op_sel_hi:[1,0]
v_pk_mul_f32 v[94:95], v[80:81], s[34:35] op_sel_hi:[1,0] neg_lo:[0,1] neg_hi:[0,1]
v_pk_fma_f32 v[92:93], v[82:83], s[34:35], v[92:93] op_sel_hi:[1,0,1]
v_pk_fma_f32 v[94:95], v[82:83], s[32:33], v[94:95] op_sel_hi:[1,0,1]
v_pk_add_f32 v[80:81], v[32:33], v[96:97] neg_lo:[0,1] neg_hi:[0,1]
v_pk_add_f32 v[82:83], v[34:35], v[98:99] neg_lo:[0,1] neg_hi:[0,1]
v_pk_add_f32 v[32:33], v[32:33], v[96:97]
v_pk_add_f32 v[34:35], v[34:35], v[98:99]
v_pk_mul_f32 v[96:97], v[80:81], s[32:33] op_sel:[0,1]
v_pk_mul_f32 v[98:99], v[80:81], s[32:33] op_sel:[0,1] neg_lo:[0,1] neg_hi:[0,1]
v_pk_fma_f32 v[96:97], v[82:83], s[32:33], v[96:97] op_sel:[0,1,0]
v_pk_fma_f32 v[98:99], v[82:83], s[32:33], v[98:99] op_sel:[0,1,0]
v_pk_add_f32 v[80:81], v[36:37], v[100:101] neg_lo:[0,1] neg_hi:[0,1]
v_pk_add_f32 v[82:83], v[38:39], v[102:103] neg_lo:[0,1] neg_hi:[0,1]
v_pk_add_f32 v[36:37], v[36:37], v[100:101]
v_pk_add_f32 v[38:39], v[38:39], v[102:103]
v_pk_mul_f32 v[100:101], v[80:81], s[34:35] op_sel_hi:[1,0]
v_pk_mul_f32 v[102:103], v[80:81], s[32:33] op_sel_hi:[1,0] neg_lo:[0,1] neg_hi:[0,1]
v_pk_fma_f32 v[100:101], v[82:83], s[32:33], v[100:101] op_sel_hi:[1,0,1]
v_pk_fma_f32 v[102:103], v[82:83], s[34:35], v[102:103] op_sel_hi:[1,0,1]
v_pk_add_f32 v[80:81], v[40:41], v[104:105] neg_lo:[0,1] neg_hi:[0,1]
v_pk_add_f32 v[82:83], v[42:43], v[106:107] neg_lo:[0,1] neg_hi:[0,1]
v_pk_add_f32 v[40:41], v[40:41], v[104:105]
v_pk_add_f32 v[42:43], v[42:43], v[106:107]
v_pk_mul_f32 v[104:105], v[80:81], s[34:35] op_sel:[0,1]
v_pk_mul_f32 v[106:107], v[80:81], s[30:31] op_sel:[0,1] neg_lo:[0,1] neg_hi:[0,1]
v_pk_fma_f32 v[104:105], v[82:83], s[30:31], v[104:105] op_sel:[0,1,0]
v_pk_fma_f32 v[106:107], v[82:83], s[34:35], v[106:107] op_sel:[0,1,0]
v_pk_add_f32 v[80:81], v[44:45], v[108:109] neg_lo:[0,1] neg_hi:[0,1]
v_pk_add_f32 v[82:83], v[46:47], v[110:111] neg_lo:[0,1] neg_hi:[0,1]
v_pk_add_f32 v[44:45], v[44:45], v[108:109]
v_pk_add_f32 v[46:47], v[46:47], v[110:111]
v_pk_mul_f32 v[108:109], v[80:81], s[36:37] op_sel_hi:[1,0]
v_pk_mul_f32 v[110:111], v[80:81], s[30:31] op_sel_hi:[1,0] neg_lo:[0,1] neg_hi:[0,1]
v_pk_fma_f32 v[108:109], v[82:83], s[30:31], v[108:109] op_sel_hi:[1,0,1]
v_pk_fma_f32 v[110:111], v[82:83], s[36:37], v[110:111] op_sel_hi:[1,0,1]
v_pk_add_f32 v[80:81], v[50:51], v[114:115] neg_lo:[0,1] neg_hi:[0,1]
v_pk_add_f32 v[82:83], v[112:113], v[48:49] neg_lo:[0,1] neg_hi:[0,1]
v_pk_add_f32 v[48:49], v[48:49], v[112:113]
v_pk_add_f32 v[50:51], v[50:51], v[114:115]
v_pk_add_f32 v[112:113], v[52:53], v[116:117] neg_lo:[0,1] neg_hi:[0,1]
v_pk_add_f32 v[114:115], v[54:55], v[118:119] neg_lo:[0,1] neg_hi:[0,1]
v_pk_add_f32 v[52:53], v[52:53], v[116:117]
v_pk_add_f32 v[54:55], v[54:55], v[118:119]
v_pk_mul_f32 v[116:117], v[112:113], s[36:37] op_sel_hi:[1,0] neg_lo:[0,1] neg_hi:[0,1]
v_pk_mul_f32 v[118:119], v[112:113], s[30:31] op_sel_hi:[1,0] neg_lo:[0,1] neg_hi:[0,1]
v_pk_fma_f32 v[116:117], v[114:115], s[30:31], v[116:117] op_sel_hi:[1,0,1]
v_pk_fma_f32 v[118:119], v[114:115], s[36:37], v[118:119] op_sel_hi:[1,0,1] neg_lo:[0,1,0] neg_hi:[0,1,0]
v_pk_add_f32 v[112:113], v[56:57], v[120:121] neg_lo:[0,1] neg_hi:[0,1]
v_pk_add_f32 v[114:115], v[58:59], v[122:123] neg_lo:[0,1] neg_hi:[0,1]
v_pk_add_f32 v[56:57], v[56:57], v[120:121]
v_pk_add_f32 v[58:59], v[58:59], v[122:123]
v_pk_mul_f32 v[120:121], v[112:113], s[34:35] op_sel:[0,1] neg_lo:[0,1] neg_hi:[0,1]
v_pk_mul_f32 v[122:123], v[112:113], s[30:31] op_sel:[0,1] neg_lo:[0,1] neg_hi:[0,1]
v_pk_fma_f32 v[120:121], v[114:115], s[30:31], v[120:121] op_sel:[0,1,0]
v_pk_fma_f32 v[122:123], v[114:115], s[34:35], v[122:123] op_sel:[0,1,0] neg_lo:[0,1,0] neg_hi:[0,1,0]
v_pk_add_f32 v[112:113], v[60:61], v[124:125] neg_lo:[0,1] neg_hi:[0,1]
v_pk_add_f32 v[114:115], v[62:63], v[126:127] neg_lo:[0,1] neg_hi:[0,1]
v_pk_add_f32 v[60:61], v[60:61], v[124:125]
v_pk_add_f32 v[62:63], v[62:63], v[126:127]
v_pk_mul_f32 v[124:125], v[112:113], s[34:35] op_sel_hi:[1,0] neg_lo:[0,1] neg_hi:[0,1]
v_pk_mul_f32 v[126:127], v[112:113], s[32:33] op_sel_hi:[1,0] neg_lo:[0,1] neg_hi:[0,1]
v_pk_fma_f32 v[124:125], v[114:115], s[32:33], v[124:125] op_sel_hi:[1,0,1]
v_pk_fma_f32 v[126:127], v[114:115], s[34:35], v[126:127] op_sel_hi:[1,0,1] neg_lo:[0,1,0] neg_hi:[0,1,0]
v_pk_add_f32 v[112:113], v[64:65], v[128:129] neg_lo:[0,1] neg_hi:[0,1]
v_pk_add_f32 v[114:115], v[66:67], v[130:131] neg_lo:[0,1] neg_hi:[0,1]
v_pk_add_f32 v[64:65], v[64:65], v[128:129]
v_pk_add_f32 v[66:67], v[66:67], v[130:131]
v_pk_mul_f32 v[128:129], v[112:113], s[32:33] op_sel:[0,1] neg_lo:[0,1] neg_hi:[0,1]
v_pk_mul_f32 v[130:131], v[112:113], s[32:33] op_sel:[0,1] neg_lo:[0,1] neg_hi:[0,1]
v_pk_fma_f32 v[128:129], v[114:115], s[32:33], v[128:129] op_sel:[0,1,0]
v_pk_fma_f32 v[130:131], v[114:115], s[32:33], v[130:131] op_sel:[0,1,0] neg_lo:[0,1,0] neg_hi:[0,1,0]
v_pk_add_f32 v[112:113], v[68:69], v[132:133] neg_lo:[0,1] neg_hi:[0,1]
v_pk_add_f32 v[114:115], v[70:71], v[134:135] neg_lo:[0,1] neg_hi:[0,1]
v_pk_add_f32 v[68:69], v[68:69], v[132:133]
v_pk_add_f32 v[70:71], v[70:71], v[134:135]
v_pk_mul_f32 v[132:133], v[112:113], s[32:33] op_sel_hi:[1,0] neg_lo:[0,1] neg_hi:[0,1]
v_pk_mul_f32 v[134:135], v[112:113], s[34:35] op_sel_hi:[1,0] neg_lo:[0,1] neg_hi:[0,1]
v_pk_fma_f32 v[132:133], v[114:115], s[34:35], v[132:133] op_sel_hi:[1,0,1]
v_pk_fma_f32 v[134:135], v[114:115], s[32:33], v[134:135] op_sel_hi:[1,0,1] neg_lo:[0,1,0] neg_hi:[0,1,0]
v_pk_add_f32 v[112:113], v[72:73], v[136:137] neg_lo:[0,1] neg_hi:[0,1]
v_pk_add_f32 v[114:115], v[74:75], v[138:139] neg_lo:[0,1] neg_hi:[0,1]
v_pk_add_f32 v[72:73], v[72:73], v[136:137]
v_pk_add_f32 v[74:75], v[74:75], v[138:139]
v_pk_mul_f32 v[136:137], v[112:113], s[30:31] op_sel:[0,1] neg_lo:[0,1] neg_hi:[0,1]
v_pk_mul_f32 v[138:139], v[112:113], s[34:35] op_sel:[0,1] neg_lo:[0,1] neg_hi:[0,1]
v_pk_fma_f32 v[136:137], v[114:115], s[34:35], v[136:137] op_sel:[0,1,0]
v_pk_fma_f32 v[138:139], v[114:115], s[30:31], v[138:139] op_sel:[0,1,0] neg_lo:[0,1,0] neg_hi:[0,1,0]
v_pk_add_f32 v[112:113], v[76:77], v[140:141] neg_lo:[0,1] neg_hi:[0,1]
v_pk_add_f32 v[114:115], v[78:79], v[142:143] neg_lo:[0,1] neg_hi:[0,1]
v_pk_add_f32 v[76:77], v[76:77], v[140:141]
v_pk_add_f32 v[78:79], v[78:79], v[142:143]
v_pk_mul_f32 v[140:141], v[112:113], s[30:31] op_sel_hi:[1,0] neg_lo:[0,1] neg_hi:[0,1]
v_pk_mul_f32 v[142:143], v[112:113], s[36:37] op_sel_hi:[1,0] neg_lo:[0,1] neg_hi:[0,1]
v_pk_fma_f32 v[140:141], v[114:115], s[36:37], v[140:141] op_sel_hi:[1,0,1]
v_pk_fma_f32 v[142:143], v[114:115], s[30:31], v[142:143] op_sel_hi:[1,0,1] neg_lo:[0,1,0] neg_hi:[0,1,0]
v_pk_add_f32 v[112:113], v[16:17], v[48:49] neg_lo:[0,1] neg_hi:[0,1]
v_pk_add_f32 v[114:115], v[18:19], v[50:51] neg_lo:[0,1] neg_hi:[0,1]
v_pk_add_f32 v[16:17], v[16:17], v[48:49]
v_pk_add_f32 v[18:19], v[18:19], v[50:51]
v_pk_add_f32 v[48:49], v[20:21], v[52:53] neg_lo:[0,1] neg_hi:[0,1]
v_pk_add_f32 v[50:51], v[22:23], v[54:55] neg_lo:[0,1] neg_hi:[0,1]
v_pk_add_f32 v[20:21], v[20:21], v[52:53]
v_pk_add_f32 v[22:23], v[22:23], v[54:55]
v_pk_mul_f32 v[52:53], v[48:49], s[30:31] op_sel:[0,1]
v_pk_mul_f32 v[54:55], v[48:49], s[34:35] op_sel:[0,1] neg_lo:[0,1] neg_hi:[0,1]
v_pk_fma_f32 v[52:53], v[50:51], s[34:35], v[52:53] op_sel:[0,1,0]
v_pk_fma_f32 v[54:55], v[50:51], s[30:31], v[54:55] op_sel:[0,1,0]
v_pk_add_f32 v[48:49], v[24:25], v[56:57] neg_lo:[0,1] neg_hi:[0,1]
v_pk_add_f32 v[50:51], v[26:27], v[58:59] neg_lo:[0,1] neg_hi:[0,1]
v_pk_add_f32 v[24:25], v[24:25], v[56:57]
v_pk_add_f32 v[26:27], v[26:27], v[58:59]
v_pk_mul_f32 v[56:57], v[48:49], s[32:33] op_sel:[0,1]
v_pk_mul_f32 v[58:59], v[48:49], s[32:33] op_sel:[0,1] neg_lo:[0,1] neg_hi:[0,1]
v_pk_fma_f32 v[56:57], v[50:51], s[32:33], v[56:57] op_sel:[0,1,0]
v_pk_fma_f32 v[58:59], v[50:51], s[32:33], v[58:59] op_sel:[0,1,0]
v_pk_add_f32 v[48:49], v[28:29], v[60:61] neg_lo:[0,1] neg_hi:[0,1]
v_pk_add_f32 v[50:51], v[30:31], v[62:63] neg_lo:[0,1] neg_hi:[0,1]
v_pk_add_f32 v[28:29], v[28:29], v[60:61]
v_pk_add_f32 v[30:31], v[30:31], v[62:63]
v_pk_mul_f32 v[60:61], v[48:49], s[34:35] op_sel:[0,1]
v_pk_mul_f32 v[62:63], v[48:49], s[30:31] op_sel:[0,1] neg_lo:[0,1] neg_hi:[0,1]
v_pk_fma_f32 v[60:61], v[50:51], s[30:31], v[60:61] op_sel:[0,1,0]
v_pk_fma_f32 v[62:63], v[50:51], s[34:35], v[62:63] op_sel:[0,1,0]
v_pk_add_f32 v[48:49], v[34:35], v[66:67] neg_lo:[0,1] neg_hi:[0,1]
v_pk_add_f32 v[50:51], v[64:65], v[32:33] neg_lo:[0,1] neg_hi:[0,1]
v_pk_add_f32 v[32:33], v[32:33], v[64:65]
v_pk_add_f32 v[34:35], v[34:35], v[66:67]
v_pk_add_f32 v[64:65], v[36:37], v[68:69] neg_lo:[0,1] neg_hi:[0,1]
v_pk_add_f32 v[66:67], v[38:39], v[70:71] neg_lo:[0,1] neg_hi:[0,1]
v_pk_add_f32 v[36:37], v[36:37], v[68:69]
v_pk_add_f32 v[38:39], v[38:39], v[70:71]
v_pk_mul_f32 v[68:69], v[64:65], s[34:35] op_sel:[0,1] neg_lo:[0,1] neg_hi:[0,1]
v_pk_mul_f32 v[70:71], v[64:65], s[30:31] op_sel:[0,1] neg_lo:[0,1] neg_hi:[0,1]
v_pk_fma_f32 v[68:69], v[66:67], s[30:31], v[68:69] op_sel:[0,1,0]
v_pk_fma_f32 v[70:71], v[66:67], s[34:35], v[70:71] op_sel:[0,1,0] neg_lo:[0,1,0] neg_hi:[0,1,0]
v_pk_add_f32 v[64:65], v[40:41], v[72:73] neg_lo:[0,1] neg_hi:[0,1]
v_pk_add_f32 v[66:67], v[42:43], v[74:75] neg_lo:[0,1] neg_hi:[0,1]
v_pk_add_f32 v[40:41], v[40:41], v[72:73]
v_pk_add_f32 v[42:43], v[42:43], v[74:75]
v_pk_mul_f32 v[72:73], v[64:65], s[32:33] op_sel:[0,1] neg_lo:[0,1] neg_hi:[0,1]
v_pk_mul_f32 v[74:75], v[64:65], s[32:33] op_sel:[0,1] neg_lo:[0,1] neg_hi:[0,1]
v_pk_fma_f32 v[72:73], v[66:67], s[32:33], v[72:73] op_sel:[0,1,0]
v_pk_fma_f32 v[74:75], v[66:67], s[32:33], v[74:75] op_sel:[0,1,0] neg_lo:[0,1,0] neg_hi:[0,1,0]
v_pk_add_f32 v[64:65], v[44:45], v[76:77] neg_lo:[0,1] neg_hi:[0,1]
v_pk_add_f32 v[66:67], v[46:47], v[78:79] neg_lo:[0,1] neg_hi:[0,1]
v_pk_add_f32 v[44:45], v[44:45], v[76:77]
v_pk_add_f32 v[46:47], v[46:47], v[78:79]
v_pk_mul_f32 v[76:77], v[64:65], s[30:31] op_sel:[0,1] neg_lo:[0,1] neg_hi:[0,1]
v_pk_mul_f32 v[78:79], v[64:65], s[34:35] op_sel:[0,1] neg_lo:[0,1] neg_hi:[0,1]
v_pk_fma_f32 v[76:77], v[66:67], s[34:35], v[76:77] op_sel:[0,1,0]
v_pk_fma_f32 v[78:79], v[66:67], s[30:31], v[78:79] op_sel:[0,1,0] neg_lo:[0,1,0] neg_hi:[0,1,0]
v_pk_add_f32 v[64:65], v[144:145], v[80:81] neg_lo:[0,1] neg_hi:[0,1]
v_pk_add_f32 v[66:67], v[146:147], v[82:83] neg_lo:[0,1] neg_hi:[0,1]
v_pk_add_f32 v[144:145], v[144:145], v[80:81]
v_pk_add_f32 v[146:147], v[146:147], v[82:83]
v_pk_add_f32 v[80:81], v[84:85], v[116:117] neg_lo:[0,1] neg_hi:[0,1]
v_pk_add_f32 v[82:83], v[86:87], v[118:119] neg_lo:[0,1] neg_hi:[0,1]
v_pk_add_f32 v[84:85], v[84:85], v[116:117]
v_pk_add_f32 v[86:87], v[86:87], v[118:119]
v_pk_mul_f32 v[116:117], v[80:81], s[30:31] op_sel:[0,1]
v_pk_mul_f32 v[118:119], v[80:81], s[34:35] op_sel:[0,1] neg_lo:[0,1] neg_hi:[0,1]
v_pk_fma_f32 v[116:117], v[82:83], s[34:35], v[116:117] op_sel:[0,1,0]
v_pk_fma_f32 v[118:119], v[82:83], s[30:31], v[118:119] op_sel:[0,1,0]
v_pk_add_f32 v[80:81], v[88:89], v[120:121] neg_lo:[0,1] neg_hi:[0,1]
v_pk_add_f32 v[82:83], v[90:91], v[122:123] neg_lo:[0,1] neg_hi:[0,1]
v_pk_add_f32 v[88:89], v[88:89], v[120:121]
v_pk_add_f32 v[90:91], v[90:91], v[122:123]
v_pk_mul_f32 v[120:121], v[80:81], s[32:33] op_sel:[0,1]
v_pk_mul_f32 v[122:123], v[80:81], s[32:33] op_sel:[0,1] neg_lo:[0,1] neg_hi:[0,1]
v_pk_fma_f32 v[120:121], v[82:83], s[32:33], v[120:121] op_sel:[0,1,0]
v_pk_fma_f32 v[122:123], v[82:83], s[32:33], v[122:123] op_sel:[0,1,0]
v_pk_add_f32 v[80:81], v[92:93], v[124:125] neg_lo:[0,1] neg_hi:[0,1]
v_pk_add_f32 v[82:83], v[94:95], v[126:127] neg_lo:[0,1] neg_hi:[0,1]
v_pk_add_f32 v[92:93], v[92:93], v[124:125]
v_pk_add_f32 v[94:95], v[94:95], v[126:127]
v_pk_mul_f32 v[124:125], v[80:81], s[34:35] op_sel:[0,1]
v_pk_mul_f32 v[126:127], v[80:81], s[30:31] op_sel:[0,1] neg_lo:[0,1] neg_hi:[0,1]
v_pk_fma_f32 v[124:125], v[82:83], s[30:31], v[124:125] op_sel:[0,1,0]
v_pk_fma_f32 v[126:127], v[82:83], s[34:35], v[126:127] op_sel:[0,1,0]
v_pk_add_f32 v[80:81], v[98:99], v[130:131] neg_lo:[0,1] neg_hi:[0,1]
v_pk_add_f32 v[82:83], v[128:129], v[96:97] neg_lo:[0,1] neg_hi:[0,1]
v_pk_add_f32 v[96:97], v[96:97], v[128:129]
v_pk_add_f32 v[98:99], v[98:99], v[130:131]
v_pk_add_f32 v[128:129], v[100:101], v[132:133] neg_lo:[0,1] neg_hi:[0,1]
v_pk_add_f32 v[130:131], v[102:103], v[134:135] neg_lo:[0,1] neg_hi:[0,1]
v_pk_add_f32 v[100:101], v[100:101], v[132:133]
v_pk_add_f32 v[102:103], v[102:103], v[134:135]
v_pk_mul_f32 v[132:133], v[128:129], s[34:35] op_sel:[0,1] neg_lo:[0,1] neg_hi:[0,1]
v_pk_mul_f32 v[134:135], v[128:129], s[30:31] op_sel:[0,1] neg_lo:[0,1] neg_hi:[0,1]
v_pk_fma_f32 v[132:133], v[130:131], s[30:31], v[132:133] op_sel:[0,1,0]
v_pk_fma_f32 v[134:135], v[130:131], s[34:35], v[134:135] op_sel:[0,1,0] neg_lo:[0,1,0] neg_hi:[0,1,0]
v_pk_add_f32 v[128:129], v[104:105], v[136:137] neg_lo:[0,1] neg_hi:[0,1]
v_pk_add_f32 v[130:131], v[106:107], v[138:139] neg_lo:[0,1] neg_hi:[0,1]
v_pk_add_f32 v[104:105], v[104:105], v[136:137]
v_pk_add_f32 v[106:107], v[106:107], v[138:139]
v_pk_mul_f32 v[136:137], v[128:129], s[32:33] op_sel:[0,1] neg_lo:[0,1] neg_hi:[0,1]
v_pk_mul_f32 v[138:139], v[128:129], s[32:33] op_sel:[0,1] neg_lo:[0,1] neg_hi:[0,1]
v_pk_fma_f32 v[136:137], v[130:131], s[32:33], v[136:137] op_sel:[0,1,0]
v_pk_fma_f32 v[138:139], v[130:131], s[32:33], v[138:139] op_sel:[0,1,0] neg_lo:[0,1,0] neg_hi:[0,1,0]
v_pk_add_f32 v[128:129], v[108:109], v[140:141] neg_lo:[0,1] neg_hi:[0,1]
v_pk_add_f32 v[130:131], v[110:111], v[142:143] neg_lo:[0,1] neg_hi:[0,1]
v_pk_add_f32 v[108:109], v[108:109], v[140:141]
v_pk_add_f32 v[110:111], v[110:111], v[142:143]
v_pk_mul_f32 v[140:141], v[128:129], s[30:31] op_sel:[0,1] neg_lo:[0,1] neg_hi:[0,1]
v_pk_mul_f32 v[142:143], v[128:129], s[34:35] op_sel:[0,1] neg_lo:[0,1] neg_hi:[0,1]
v_pk_fma_f32 v[140:141], v[130:131], s[34:35], v[140:141] op_sel:[0,1,0]
v_pk_fma_f32 v[142:143], v[130:131], s[30:31], v[142:143] op_sel:[0,1,0] neg_lo:[0,1,0] neg_hi:[0,1,0]
v_pk_add_f32 v[128:129], v[16:17], v[32:33] neg_lo:[0,1] neg_hi:[0,1]
v_pk_add_f32 v[130:131], v[18:19], v[34:35] neg_lo:[0,1] neg_hi:[0,1]
v_pk_add_f32 v[16:17], v[16:17], v[32:33]
v_pk_add_f32 v[18:19], v[18:19], v[34:35]
v_pk_add_f32 v[32:33], v[20:21], v[36:37] neg_lo:[0,1] neg_hi:[0,1]
v_pk_add_f32 v[34:35], v[22:23], v[38:39] neg_lo:[0,1] neg_hi:[0,1]
v_pk_add_f32 v[20:21], v[20:21], v[36:37]
v_pk_add_f32 v[22:23], v[22:23], v[38:39]
v_pk_mul_f32 v[36:37], v[32:33], s[32:33] op_sel:[0,1]
v_pk_mul_f32 v[38:39], v[32:33], s[32:33] op_sel:[0,1] neg_lo:[0,1] neg_hi:[0,1]
v_pk_fma_f32 v[36:37], v[34:35], s[32:33], v[36:37] op_sel:[0,1,0]
v_pk_fma_f32 v[38:39], v[34:35], s[32:33], v[38:39] op_sel:[0,1,0]
v_pk_add_f32 v[32:33], v[26:27], v[42:43] neg_lo:[0,1] neg_hi:[0,1]
v_pk_add_f32 v[34:35], v[40:41], v[24:25] neg_lo:[0,1] neg_hi:[0,1]
v_pk_add_f32 v[24:25], v[24:25], v[40:41]
v_pk_add_f32 v[26:27], v[26:27], v[42:43]
v_pk_add_f32 v[40:41], v[28:29], v[44:45] neg_lo:[0,1] neg_hi:[0,1]
v_pk_add_f32 v[42:43], v[30:31], v[46:47] neg_lo:[0,1] neg_hi:[0,1]
v_pk_add_f32 v[28:29], v[28:29], v[44:45]
v_pk_add_f32 v[30:31], v[30:31], v[46:47]
v_pk_mul_f32 v[44:45], v[40:41], s[32:33] op_sel:[0,1] neg_lo:[0,1] neg_hi:[0,1]
v_pk_mul_f32 v[46:47], v[40:41], s[32:33] op_sel:[0,1] neg_lo:[0,1] neg_hi:[0,1]
v_pk_fma_f32 v[44:45], v[42:43], s[32:33], v[44:45] op_sel:[0,1,0]
v_pk_fma_f32 v[46:47], v[42:43], s[32:33], v[46:47] op_sel:[0,1,0] neg_lo:[0,1,0] neg_hi:[0,1,0]
v_pk_add_f32 v[40:41], v[112:113], v[48:49] neg_lo:[0,1] neg_hi:[0,1]
v_pk_add_f32 v[42:43], v[114:115], v[50:51] neg_lo:[0,1] neg_hi:[0,1]
v_pk_add_f32 v[112:113], v[112:113], v[48:49]
v_pk_add_f32 v[114:115], v[114:115], v[50:51]
v_pk_add_f32 v[48:49], v[52:53], v[68:69] neg_lo:[0,1] neg_hi:[0,1]
v_pk_add_f32 v[50:51], v[54:55], v[70:71] neg_lo:[0,1] neg_hi:[0,1]
v_pk_add_f32 v[52:53], v[52:53], v[68:69]
v_pk_add_f32 v[54:55], v[54:55], v[70:71]
v_pk_mul_f32 v[68:69], v[48:49], s[32:33] op_sel:[0,1]
v_pk_mul_f32 v[70:71], v[48:49], s[32:33] op_sel:[0,1] neg_lo:[0,1] neg_hi:[0,1]
v_pk_fma_f32 v[68:69], v[50:51], s[32:33], v[68:69] op_sel:[0,1,0]
v_pk_fma_f32 v[70:71], v[50:51], s[32:33], v[70:71] op_sel:[0,1,0]
v_pk_add_f32 v[48:49], v[58:59], v[74:75] neg_lo:[0,1] neg_hi:[0,1]
v_pk_add_f32 v[50:51], v[72:73], v[56:57] neg_lo:[0,1] neg_hi:[0,1]
v_pk_add_f32 v[56:57], v[56:57], v[72:73]
v_pk_add_f32 v[58:59], v[58:59], v[74:75]
v_pk_add_f32 v[72:73], v[60:61], v[76:77] neg_lo:[0,1] neg_hi:[0,1]
v_pk_add_f32 v[74:75], v[62:63], v[78:79] neg_lo:[0,1] neg_hi:[0,1]
v_pk_add_f32 v[60:61], v[60:61], v[76:77]
v_pk_add_f32 v[62:63], v[62:63], v[78:79]
v_pk_mul_f32 v[76:77], v[72:73], s[32:33] op_sel:[0,1] neg_lo:[0,1] neg_hi:[0,1]
v_pk_mul_f32 v[78:79], v[72:73], s[32:33] op_sel:[0,1] neg_lo:[0,1] neg_hi:[0,1]
v_pk_fma_f32 v[76:77], v[74:75], s[32:33], v[76:77] op_sel:[0,1,0]
v_pk_fma_f32 v[78:79], v[74:75], s[32:33], v[78:79] op_sel:[0,1,0] neg_lo:[0,1,0] neg_hi:[0,1,0]
v_pk_add_f32 v[72:73], v[144:145], v[96:97] neg_lo:[0,1] neg_hi:[0,1]
v_pk_add_f32 v[74:75], v[146:147], v[98:99] neg_lo:[0,1] neg_hi:[0,1]
v_pk_add_f32 v[144:145], v[144:145], v[96:97]
v_pk_add_f32 v[146:147], v[146:147], v[98:99]
v_pk_add_f32 v[96:97], v[84:85], v[100:101] neg_lo:[0,1] neg_hi:[0,1]
v_pk_add_f32 v[98:99], v[86:87], v[102:103] neg_lo:[0,1] neg_hi:[0,1]
v_pk_add_f32 v[84:85], v[84:85], v[100:101]
v_pk_add_f32 v[86:87], v[86:87], v[102:103]
v_pk_mul_f32 v[100:101], v[96:97], s[32:33] op_sel:[0,1]
v_pk_mul_f32 v[102:103], v[96:97], s[32:33] op_sel:[0,1] neg_lo:[0,1] neg_hi:[0,1]
v_pk_fma_f32 v[100:101], v[98:99], s[32:33], v[100:101] op_sel:[0,1,0]
v_pk_fma_f32 v[102:103], v[98:99], s[32:33], v[102:103] op_sel:[0,1,0]
v_pk_add_f32 v[96:97], v[90:91], v[106:107] neg_lo:[0,1] neg_hi:[0,1]
v_pk_add_f32 v[98:99], v[104:105], v[88:89] neg_lo:[0,1] neg_hi:[0,1]
v_pk_add_f32 v[88:89], v[88:89], v[104:105]
v_pk_add_f32 v[90:91], v[90:91], v[106:107]
v_pk_add_f32 v[104:105], v[92:93], v[108:109] neg_lo:[0,1] neg_hi:[0,1]
v_pk_add_f32 v[106:107], v[94:95], v[110:111] neg_lo:[0,1] neg_hi:[0,1]
v_pk_add_f32 v[92:93], v[92:93], v[108:109]
v_pk_add_f32 v[94:95], v[94:95], v[110:111]
v_pk_mul_f32 v[108:109], v[104:105], s[32:33] op_sel:[0,1] neg_lo:[0,1] neg_hi:[0,1]
v_pk_mul_f32 v[110:111], v[104:105], s[32:33] op_sel:[0,1] neg_lo:[0,1] neg_hi:[0,1]
v_pk_fma_f32 v[108:109], v[106:107], s[32:33], v[108:109] op_sel:[0,1,0]
v_pk_fma_f32 v[110:111], v[106:107], s[32:33], v[110:111] op_sel:[0,1,0] neg_lo:[0,1,0] neg_hi:[0,1,0]
v_pk_add_f32 v[104:105], v[64:65], v[80:81] neg_lo:[0,1] neg_hi:[0,1]
v_pk_add_f32 v[106:107], v[66:67], v[82:83] neg_lo:[0,1] neg_hi:[0,1]
v_pk_add_f32 v[64:65], v[64:65], v[80:81]
v_pk_add_f32 v[66:67], v[66:67], v[82:83]
v_pk_add_f32 v[80:81], v[116:117], v[132:133] neg_lo:[0,1] neg_hi:[0,1]
v_pk_add_f32 v[82:83], v[118:119], v[134:135] neg_lo:[0,1] neg_hi:[0,1]
v_pk_add_f32 v[116:117], v[116:117], v[132:133]
v_pk_add_f32 v[118:119], v[118:119], v[134:135]
v_pk_mul_f32 v[132:133], v[80:81], s[32:33] op_sel:[0,1]
v_pk_mul_f32 v[134:135], v[80:81], s[32:33] op_sel:[0,1] neg_lo:[0,1] neg_hi:[0,1]
v_pk_fma_f32 v[132:133], v[82:83], s[32:33], v[132:133] op_sel:[0,1,0]
v_pk_fma_f32 v[134:135], v[82:83], s[32:33], v[134:135] op_sel:[0,1,0]
v_pk_add_f32 v[80:81], v[122:123], v[138:139] neg_lo:[0,1] neg_hi:[0,1]
v_pk_add_f32 v[82:83], v[136:137], v[120:121] neg_lo:[0,1] neg_hi:[0,1]
v_pk_add_f32 v[120:121], v[120:121], v[136:137]
v_pk_add_f32 v[122:123], v[122:123], v[138:139]
v_pk_add_f32 v[136:137], v[124:125], v[140:141] neg_lo:[0,1] neg_hi:[0,1]
v_pk_add_f32 v[138:139], v[126:127], v[142:143] neg_lo:[0,1] neg_hi:[0,1]
v_pk_add_f32 v[124:125], v[124:125], v[140:141]
v_pk_add_f32 v[126:127], v[126:127], v[142:143]
v_pk_mul_f32 v[140:141], v[136:137], s[32:33] op_sel:[0,1] neg_lo:[0,1] neg_hi:[0,1]
v_pk_mul_f32 v[142:143], v[136:137], s[32:33] op_sel:[0,1] neg_lo:[0,1] neg_hi:[0,1]
v_pk_fma_f32 v[140:141], v[138:139], s[32:33], v[140:141] op_sel:[0,1,0]
v_pk_fma_f32 v[142:143], v[138:139], s[32:33], v[142:143] op_sel:[0,1,0] neg_lo:[0,1,0] neg_hi:[0,1,0]
v_pk_add_f32 v[136:137], v[16:17], v[24:25] neg_lo:[0,1] neg_hi:[0,1]
v_pk_add_f32 v[138:139], v[18:19], v[26:27] neg_lo:[0,1] neg_hi:[0,1]
v_pk_add_f32 v[16:17], v[16:17], v[24:25]
v_pk_add_f32 v[18:19], v[18:19], v[26:27]
v_pk_add_f32 v[24:25], v[22:23], v[30:31] neg_lo:[0,1] neg_hi:[0,1]
v_pk_add_f32 v[26:27], v[28:29], v[20:21] neg_lo:[0,1] neg_hi:[0,1]
v_pk_add_f32 v[20:21], v[20:21], v[28:29]
v_pk_add_f32 v[22:23], v[22:23], v[30:31]
v_pk_add_f32 v[28:29], v[128:129], v[32:33] neg_lo:[0,1] neg_hi:[0,1]
v_pk_add_f32 v[30:31], v[130:131], v[34:35] neg_lo:[0,1] neg_hi:[0,1]
v_pk_add_f32 v[128:129], v[128:129], v[32:33]
v_pk_add_f32 v[130:131], v[130:131], v[34:35]
v_pk_add_f32 v[32:33], v[38:39], v[46:47] neg_lo:[0,1] neg_hi:[0,1]
v_pk_add_f32 v[34:35], v[44:45], v[36:37] neg_lo:[0,1] neg_hi:[0,1]
v_pk_add_f32 v[36:37], v[36:37], v[44:45]
v_pk_add_f32 v[38:39], v[38:39], v[46:47]
v_pk_add_f32 v[44:45], v[112:113], v[56:57] neg_lo:[0,1] neg_hi:[0,1]
v_pk_add_f32 v[46:47], v[114:115], v[58:59] neg_lo:[0,1] neg_hi:[0,1]
v_pk_add_f32 v[112:113], v[112:113], v[56:57]
v_pk_add_f32 v[114:115], v[114:115], v[58:59]
v_pk_add_f32 v[56:57], v[54:55], v[62:63] neg_lo:[0,1] neg_hi:[0,1]
v_pk_add_f32 v[58:59], v[60:61], v[52:53] neg_lo:[0,1] neg_hi:[0,1]
v_pk_add_f32 v[52:53], v[52:53], v[60:61]
v_pk_add_f32 v[54:55], v[54:55], v[62:63]
v_pk_add_f32 v[60:61], v[40:41], v[48:49] neg_lo:[0,1] neg_hi:[0,1]
v_pk_add_f32 v[62:63], v[42:43], v[50:51] neg_lo:[0,1] neg_hi:[0,1]
v_pk_add_f32 v[40:41], v[40:41], v[48:49]
v_pk_add_f32 v[42:43], v[42:43], v[50:51]
v_pk_add_f32 v[48:49], v[70:71], v[78:79] neg_lo:[0,1] neg_hi:[0,1]
v_pk_add_f32 v[50:51], v[76:77], v[68:69] neg_lo:[0,1] neg_hi:[0,1]
v_pk_add_f32 v[68:69], v[68:69], v[76:77]
v_pk_add_f32 v[70:71], v[70:71], v[78:79]
v_pk_add_f32 v[76:77], v[144:145], v[88:89] neg_lo:[0,1] neg_hi:[0,1]
v_pk_add_f32 v[78:79], v[146:147], v[90:91] neg_lo:[0,1] neg_hi:[0,1]
v_pk_add_f32 v[144:145], v[144:145], v[88:89]
v_pk_add_f32 v[146:147], v[146:147], v[90:91]
v_pk_add_f32 v[88:89], v[86:87], v[94:95] neg_lo:[0,1] neg_hi:[0,1]
v_pk_add_f32 v[90:91], v[92:93], v[84:85] neg_lo:[0,1] neg_hi:[0,1]
v_pk_add_f32 v[84:85], v[84:85], v[92:93]
v_pk_add_f32 v[86:87], v[86:87], v[94:95]
v_pk_add_f32 v[92:93], v[72:73], v[96:97] neg_lo:[0,1] neg_hi:[0,1]
v_pk_add_f32 v[94:95], v[74:75], v[98:99] neg_lo:[0,1] neg_hi:[0,1]
v_pk_add_f32 v[72:73], v[72:73], v[96:97]
v_pk_add_f32 v[74:75], v[74:75], v[98:99]
v_pk_add_f32 v[96:97], v[102:103], v[110:111] neg_lo:[0,1] neg_hi:[0,1]
v_pk_add_f32 v[98:99], v[108:109], v[100:101] neg_lo:[0,1] neg_hi:[0,1]
v_pk_add_f32 v[100:101], v[100:101], v[108:109]
v_pk_add_f32 v[102:103], v[102:103], v[110:111]
v_pk_add_f32 v[108:109], v[64:65], v[120:121] neg_lo:[0,1] neg_hi:[0,1]
v_pk_add_f32 v[110:111], v[66:67], v[122:123] neg_lo:[0,1] neg_hi:[0,1]
v_pk_add_f32 v[64:65], v[64:65], v[120:121]
v_pk_add_f32 v[66:67], v[66:67], v[122:123]
v_pk_add_f32 v[120:121], v[118:119], v[126:127] neg_lo:[0,1] neg_hi:[0,1]
v_pk_add_f32 v[122:123], v[124:125], v[116:117] neg_lo:[0,1] neg_hi:[0,1]
v_pk_add_f32 v[116:117], v[116:117], v[124:125]
v_pk_add_f32 v[118:119], v[118:119], v[126:127]
v_pk_add_f32 v[124:125], v[104:105], v[80:81] neg_lo:[0,1] neg_hi:[0,1]
v_pk_add_f32 v[126:127], v[106:107], v[82:83] neg_lo:[0,1] neg_hi:[0,1]
v_pk_add_f32 v[104:105], v[104:105], v[80:81]
v_pk_add_f32 v[106:107], v[106:107], v[82:83]
v_pk_add_f32 v[80:81], v[134:135], v[142:143] neg_lo:[0,1] neg_hi:[0,1]
v_pk_add_f32 v[82:83], v[140:141], v[132:133] neg_lo:[0,1] neg_hi:[0,1]
v_pk_add_f32 v[132:133], v[132:133], v[140:141]
v_pk_add_f32 v[134:135], v[134:135], v[142:143]
v_pk_add_f32 v[140:141], v[16:17], v[20:21] neg_lo:[0,1] neg_hi:[0,1]
v_pk_add_f32 v[142:143], v[18:19], v[22:23] neg_lo:[0,1] neg_hi:[0,1]
v_pk_add_f32 v[16:17], v[16:17], v[20:21]
v_pk_add_f32 v[18:19], v[18:19], v[22:23]
v_pk_add_f32 v[20:21], v[136:137], v[24:25] neg_lo:[0,1] neg_hi:[0,1]
v_pk_add_f32 v[22:23], v[138:139], v[26:27] neg_lo:[0,1] neg_hi:[0,1]
v_pk_add_f32 v[136:137], v[136:137], v[24:25]
v_pk_add_f32 v[138:139], v[138:139], v[26:27]
v_pk_add_f32 v[24:25], v[128:129], v[36:37] neg_lo:[0,1] neg_hi:[0,1]
v_pk_add_f32 v[26:27], v[130:131], v[38:39] neg_lo:[0,1] neg_hi:[0,1]
v_pk_add_f32 v[128:129], v[128:129], v[36:37]
v_pk_add_f32 v[130:131], v[130:131], v[38:39]
v_pk_add_f32 v[36:37], v[28:29], v[32:33] neg_lo:[0,1] neg_hi:[0,1]
v_pk_add_f32 v[38:39], v[30:31], v[34:35] neg_lo:[0,1] neg_hi:[0,1]
v_pk_add_f32 v[28:29], v[28:29], v[32:33]
v_pk_add_f32 v[30:31], v[30:31], v[34:35]
v_pk_add_f32 v[32:33], v[112:113], v[52:53] neg_lo:[0,1] neg_hi:[0,1]
v_pk_add_f32 v[34:35], v[114:115], v[54:55] neg_lo:[0,1] neg_hi:[0,1]
v_pk_add_f32 v[112:113], v[112:113], v[52:53]
v_pk_add_f32 v[114:115], v[114:115], v[54:55]
v_pk_add_f32 v[52:53], v[44:45], v[56:57] neg_lo:[0,1] neg_hi:[0,1]
v_pk_add_f32 v[54:55], v[46:47], v[58:59] neg_lo:[0,1] neg_hi:[0,1]
v_pk_add_f32 v[44:45], v[44:45], v[56:57]
v_pk_add_f32 v[46:47], v[46:47], v[58:59]
v_pk_add_f32 v[56:57], v[40:41], v[68:69] neg_lo:[0,1] neg_hi:[0,1]
v_pk_add_f32 v[58:59], v[42:43], v[70:71] neg_lo:[0,1] neg_hi:[0,1]
v_pk_add_f32 v[40:41], v[40:41], v[68:69]
v_pk_add_f32 v[42:43], v[42:43], v[70:71]
v_pk_add_f32 v[68:69], v[60:61], v[48:49] neg_lo:[0,1] neg_hi:[0,1]
v_pk_add_f32 v[70:71], v[62:63], v[50:51] neg_lo:[0,1] neg_hi:[0,1]
v_pk_add_f32 v[60:61], v[60:61], v[48:49]
v_pk_add_f32 v[62:63], v[62:63], v[50:51]
v_pk_add_f32 v[48:49], v[144:145], v[84:85] neg_lo:[0,1] neg_hi:[0,1]
v_pk_add_f32 v[50:51], v[146:147], v[86:87] neg_lo:[0,1] neg_hi:[0,1]
v_pk_add_f32 v[144:145], v[144:145], v[84:85]
v_pk_add_f32 v[146:147], v[146:147], v[86:87]
v_pk_add_f32 v[84:85], v[76:77], v[88:89] neg_lo:[0,1] neg_hi:[0,1]
v_pk_add_f32 v[86:87], v[78:79], v[90:91] neg_lo:[0,1] neg_hi:[0,1]
v_pk_add_f32 v[76:77], v[76:77], v[88:89]
v_pk_add_f32 v[78:79], v[78:79], v[90:91]
v_pk_add_f32 v[88:89], v[72:73], v[100:101] neg_lo:[0,1] neg_hi:[0,1]
v_pk_add_f32 v[90:91], v[74:75], v[102:103] neg_lo:[0,1] neg_hi:[0,1]
v_pk_add_f32 v[72:73], v[72:73], v[100:101]
v_pk_add_f32 v[74:75], v[74:75], v[102:103]
v_pk_add_f32 v[100:101], v[92:93], v[96:97] neg_lo:[0,1] neg_hi:[0,1]
v_pk_add_f32 v[102:103], v[94:95], v[98:99] neg_lo:[0,1] neg_hi:[0,1]
v_pk_add_f32 v[92:93], v[92:93], v[96:97]
v_pk_add_f32 v[94:95], v[94:95], v[98:99]
v_pk_add_f32 v[96:97], v[64:65], v[116:117] neg_lo:[0,1] neg_hi:[0,1]
v_pk_add_f32 v[98:99], v[66:67], v[118:119] neg_lo:[0,1] neg_hi:[0,1]
v_pk_add_f32 v[64:65], v[64:65], v[116:117]
v_pk_add_f32 v[66:67], v[66:67], v[118:119]
v_pk_add_f32 v[116:117], v[108:109], v[120:121] neg_lo:[0,1] neg_hi:[0,1]
v_pk_add_f32 v[118:119], v[110:111], v[122:123] neg_lo:[0,1] neg_hi:[0,1]
v_pk_add_f32 v[108:109], v[108:109], v[120:121]
v_pk_add_f32 v[110:111], v[110:111], v[122:123]
v_pk_add_f32 v[120:121], v[104:105], v[132:133] neg_lo:[0,1] neg_hi:[0,1]
v_pk_add_f32 v[122:123], v[106:107], v[134:135] neg_lo:[0,1] neg_hi:[0,1]
v_pk_add_f32 v[104:105], v[104:105], v[132:133]
v_pk_add_f32 v[106:107], v[106:107], v[134:135]
v_pk_add_f32 v[132:133], v[124:125], v[80:81] neg_lo:[0,1] neg_hi:[0,1]
v_pk_add_f32 v[134:135], v[126:127], v[82:83] neg_lo:[0,1] neg_hi:[0,1]
v_pk_add_f32 v[124:125], v[124:125], v[80:81]
v_pk_add_f32 v[126:127], v[126:127], v[82:83]
ds_write_b64 v4, v[16:17]
ds_write_b64 v4, v[18:19] offset:8
ds_write_b64 v4, v[144:145] offset:512
ds_write_b64 v4, v[146:147] offset:520
ds_write_b64 v4, v[112:113] offset:1024
ds_write_b64 v4, v[114:115] offset:1032
ds_write_b64 v4, v[64:65] offset:1536
ds_write_b64 v4, v[66:67] offset:1544
ds_write_b64 v4, v[128:129] offset:2048
ds_write_b64 v4, v[130:131] offset:2056
ds_write_b64 v4, v[72:73] offset:2560
ds_write_b64 v4, v[74:75] offset:2568
ds_write_b64 v4, v[40:41] offset:3072
ds_write_b64 v4, v[42:43] offset:3080
ds_write_b64 v4, v[104:105] offset:3584
ds_write_b64 v4, v[106:107] offset:3592
ds_write_b64 v4, v[136:137] offset:4096
ds_write_b64 v4, v[138:139] offset:4104
ds_write_b64 v4, v[76:77] offset:4608
ds_write_b64 v4, v[78:79] offset:4616
ds_write_b64 v4, v[44:45] offset:5120
ds_write_b64 v4, v[46:47] offset:5128
ds_write_b64 v4, v[108:109] offset:5632
ds_write_b64 v4, v[110:111] offset:5640
ds_write_b64 v4, v[28:29] offset:6144
ds_write_b64 v4, v[30:31] offset:6152
ds_write_b64 v4, v[92:93] offset:6656
ds_write_b64 v4, v[94:95] offset:6664
ds_write_b64 v4, v[60:61] offset:7168
ds_write_b64 v4, v[62:63] offset:7176
ds_write_b64 v4, v[124:125] offset:7680
ds_write_b64 v4, v[126:127] offset:7688
ds_write_b64 v4, v[140:141] offset:8192
ds_write_b64 v4, v[142:143] offset:8200
ds_write_b64 v4, v[48:49] offset:8704
ds_write_b64 v4, v[50:51] offset:8712
ds_write_b64 v4, v[32:33] offset:9216
ds_write_b64 v4, v[34:35] offset:9224
ds_write_b64 v4, v[96:97] offset:9728
ds_write_b64 v4, v[98:99] offset:9736
ds_write_b64 v4, v[24:25] offset:10240
ds_write_b64 v4, v[26:27] offset:10248
ds_write_b64 v4, v[88:89] offset:10752
ds_write_b64 v4, v[90:91] offset:10760
ds_write_b64 v4, v[56:57] offset:11264
ds_write_b64 v4, v[58:59] offset:11272
ds_write_b64 v4, v[120:121] offset:11776
ds_write_b64 v4, v[122:123] offset:11784
ds_write_b64 v4, v[20:21] offset:12288
ds_write_b64 v4, v[22:23] offset:12296
ds_write_b64 v4, v[84:85] offset:12800
ds_write_b64 v4, v[86:87] offset:12808
ds_write_b64 v4, v[52:53] offset:13312
ds_write_b64 v4, v[54:55] offset:13320
ds_write_b64 v4, v[116:117] offset:13824
ds_write_b64 v4, v[118:119] offset:13832
ds_write_b64 v4, v[36:37] offset:14336
ds_write_b64 v4, v[38:39] offset:14344
ds_write_b64 v4, v[100:101] offset:14848
ds_write_b64 v4, v[102:103] offset:14856
ds_write_b64 v4, v[68:69] offset:15360
ds_write_b64 v4, v[70:71] offset:15368
ds_write_b64 v4, v[132:133] offset:15872
ds_write_b64 v4, v[134:135] offset:15880
s_waitcnt lgkmcnt(0)
s_barrier
v_and_b32 v5, 7, v0
v_lshrrev_b32 v1, 3, v0
v_mul_u32_u24 v6, 16896, v5
v_lshl_add_u32 v4, v1, 5, v6
v_lshlrev_b32 v5, 4, v5
v_lshl_add_u32 v5, v1, 15, v5
v_lshlrev_b32 v1, 1, v1
s_lshl_b32 s12, s92, 9
s_add_u32 s12, s12, 96468992
v_sub_u32 v7, 1024, v1
v_add_u32 v8, -1, v7
v_and_b32 v7, 1023, v7
v_lshl_add_u32 v7, v7, 4, v6
v_lshl_add_u32 v8, v8, 4, v6
ds_read_b128 v[16:19], v4
ds_read_b128 v[20:23], v4 offset:16
ds_read_b128 v[24:27], v7
ds_read_b128 v[28:31], v8
v_sub_u32 v7, 960, v1
v_add_u32 v8, -1, v7
v_and_b32 v7, 1023, v7
v_lshl_add_u32 v7, v7, 4, v6
v_lshl_add_u32 v8, v8, 4, v6
ds_read_b128 v[32:35], v4 offset:1024
ds_read_b128 v[36:39], v4 offset:1040
ds_read_b128 v[40:43], v7
ds_read_b128 v[44:47], v8
s_waitcnt lgkmcnt(4)
v_add_f32 v48, v16, v24
v_sub_f32 v50, v18, v26
v_add_f32 v52, v18, v26
v_sub_f32 v54, v24, v16
v_add_f32 v49, v20, v28
v_sub_f32 v51, v22, v30
v_add_f32 v53, v22, v30
v_sub_f32 v55, v28, v20
v_add_f32 v56, v17, v25
v_sub_f32 v58, v19, v27
v_add_f32 v60, v19, v27
v_sub_f32 v62, v25, v17
v_add_f32 v57, v21, v29
v_sub_f32 v59, v23, v31
v_add_f32 v61, v23, v31
v_sub_f32 v63, v29, v21
s_add_u32 s13, s12, 0
buffer_store_dwordx4 v[48:51], v5, s[84:87], s13 offen sc1
buffer_store_dwordx4 v[52:55], v5, s[84:87], s13 offen offset:128 sc1
buffer_store_dwordx4 v[56:59], v5, s[84:87], s13 offen offset:256 sc1
buffer_store_dwordx4 v[60:63], v5, s[84:87], s13 offen offset:384 sc1
v_sub_u32 v7, 896, v1
v_add_u32 v8, -1, v7
v_and_b32 v7, 1023, v7
v_lshl_add_u32 v7, v7, 4, v6
v_lshl_add_u32 v8, v8, 4, v6
ds_read_b128 v[16:19], v4 offset:2048
ds_read_b128 v[20:23], v4 offset:2064
ds_read_b128 v[24:27], v7
ds_read_b128 v[28:31], v8
s_waitcnt lgkmcnt(4)
v_add_f32 v64, v32, v40
v_sub_f32 v66, v34, v42
v_add_f32 v68, v34, v42
v_sub_f32 v70, v40, v32
v_add_f32 v65, v36, v44
v_sub_f32 v67, v38, v46
v_add_f32 v69, v38, v46
v_sub_f32 v71, v44, v36
v_add_f32 v72, v33, v41
v_sub_f32 v74, v35, v43
v_add_f32 v76, v35, v43
v_sub_f32 v78, v41, v33
v_add_f32 v73, v37, v45
v_sub_f32 v75, v39, v47
v_add_f32 v77, v39, v47
v_sub_f32 v79, v45, v37
s_add_u32 s13, s12, 1048576
buffer_store_dwordx4 v[64:67], v5, s[84:87], s13 offen sc1
buffer_store_dwordx4 v[68:71], v5, s[84:87], s13 offen offset:128 sc1
buffer_store_dwordx4 v[72:75], v5, s[84:87], s13 offen offset:256 sc1
buffer_store_dwordx4 v[76:79], v5, s[84:87], s13 offen offset:384 sc1
v_sub_u32 v7, 832, v1
v_add_u32 v8, -1, v7
v_and_b32 v7, 1023, v7
v_lshl_add_u32 v7, v7, 4, v6
v_lshl_add_u32 v8, v8, 4, v6
ds_read_b128 v[32:35], v4 offset:3072
ds_read_b128 v[36:39], v4 offset:3088
ds_read_b128 v[40:43], v7
ds_read_b128 v[44:47], v8
s_waitcnt lgkmcnt(4)
v_add_f32 v48, v16, v24
v_sub_f32 v50, v18, v26
v_add_f32 v52, v18, v26
v_sub_f32 v54, v24, v16
v_add_f32 v49, v20, v28
v_sub_f32 v51, v22, v30
v_add_f32 v53, v22, v30
v_sub_f32 v55, v28, v20
v_add_f32 v56, v17, v25
v_sub_f32 v58, v19, v27
v_add_f32 v60, v19, v27
v_sub_f32 v62, v25, v17
v_add_f32 v57, v21, v29
v_sub_f32 v59, v23, v31
v_add_f32 v61, v23, v31
v_sub_f32 v63, v29, v21
s_add_u32 s13, s12, 2097152
buffer_store_dwordx4 v[48:51], v5, s[84:87], s13 offen sc1
buffer_store_dwordx4 v[52:55], v5, s[84:87], s13 offen offset:128 sc1
buffer_store_dwordx4 v[56:59], v5, s[84:87], s13 offen offset:256 sc1
buffer_store_dwordx4 v[60:63], v5, s[84:87], s13 offen offset:384 sc1
v_sub_u32 v7, 768, v1
v_add_u32 v8, -1, v7
v_and_b32 v7, 1023, v7
v_lshl_add_u32 v7, v7, 4, v6
v_lshl_add_u32 v8, v8, 4, v6
ds_read_b128 v[16:19], v4 offset:4096
ds_read_b128 v[20:23], v4 offset:4112
ds_read_b128 v[24:27], v7
ds_read_b128 v[28:31], v8
s_waitcnt lgkmcnt(4)
v_add_f32 v64, v32, v40
v_sub_f32 v66, v34, v42
v_add_f32 v68, v34, v42
v_sub_f32 v70, v40, v32
v_add_f32 v65, v36, v44
v_sub_f32 v67, v38, v46
v_add_f32 v69, v38, v46
v_sub_f32 v71, v44, v36
v_add_f32 v72, v33, v41
v_sub_f32 v74, v35, v43
v_add_f32 v76, v35, v43
v_sub_f32 v78, v41, v33
v_add_f32 v73, v37, v45
v_sub_f32 v75, v39, v47
v_add_f32 v77, v39, v47
v_sub_f32 v79, v45, v37
s_add_u32 s13, s12, 3145728
buffer_store_dwordx4 v[64:67], v5, s[84:87], s13 offen sc1
buffer_store_dwordx4 v[68:71], v5, s[84:87], s13 offen offset:128 sc1
buffer_store_dwordx4 v[72:75], v5, s[84:87], s13 offen offset:256 sc1
buffer_store_dwordx4 v[76:79], v5, s[84:87], s13 offen offset:384 sc1
v_sub_u32 v7, 704, v1
v_add_u32 v8, -1, v7
v_and_b32 v7, 1023, v7
v_lshl_add_u32 v7, v7, 4, v6
v_lshl_add_u32 v8, v8, 4, v6
ds_read_b128 v[32:35], v4 offset:5120
ds_read_b128 v[36:39], v4 offset:5136
ds_read_b128 v[40:43], v7
ds_read_b128 v[44:47], v8
s_waitcnt lgkmcnt(4)
v_add_f32 v48, v16, v24
v_sub_f32 v50, v18, v26
v_add_f32 v52, v18, v26
v_sub_f32 v54, v24, v16
v_add_f32 v49, v20, v28
v_sub_f32 v51, v22, v30
v_add_f32 v53, v22, v30
v_sub_f32 v55, v28, v20
v_add_f32 v56, v17, v25
v_sub_f32 v58, v19, v27
v_add_f32 v60, v19, v27
v_sub_f32 v62, v25, v17
v_add_f32 v57, v21, v29
v_sub_f32 v59, v23, v31
v_add_f32 v61, v23, v31
v_sub_f32 v63, v29, v21
s_add_u32 s13, s12, 4194304
buffer_store_dwordx4 v[48:51], v5, s[84:87], s13 offen sc1
buffer_store_dwordx4 v[52:55], v5, s[84:87], s13 offen offset:128 sc1
buffer_store_dwordx4 v[56:59], v5, s[84:87], s13 offen offset:256 sc1
buffer_store_dwordx4 v[60:63], v5, s[84:87], s13 offen offset:384 sc1
v_sub_u32 v7, 640, v1
v_add_u32 v8, -1, v7
v_and_b32 v7, 1023, v7
v_lshl_add_u32 v7, v7, 4, v6
v_lshl_add_u32 v8, v8, 4, v6
ds_read_b128 v[16:19], v4 offset:6144
ds_read_b128 v[20:23], v4 offset:6160
ds_read_b128 v[24:27], v7
ds_read_b128 v[28:31], v8
s_waitcnt lgkmcnt(4)
v_add_f32 v64, v32, v40
v_sub_f32 v66, v34, v42
v_add_f32 v68, v34, v42
v_sub_f32 v70, v40, v32
v_add_f32 v65, v36, v44
v_sub_f32 v67, v38, v46
v_add_f32 v69, v38, v46
v_sub_f32 v71, v44, v36
v_add_f32 v72, v33, v41
v_sub_f32 v74, v35, v43
v_add_f32 v76, v35, v43
v_sub_f32 v78, v41, v33
v_add_f32 v73, v37, v45
v_sub_f32 v75, v39, v47
v_add_f32 v77, v39, v47
v_sub_f32 v79, v45, v37
s_add_u32 s13, s12, 5242880
buffer_store_dwordx4 v[64:67], v5, s[84:87], s13 offen sc1
buffer_store_dwordx4 v[68:71], v5, s[84:87], s13 offen offset:128 sc1
buffer_store_dwordx4 v[72:75], v5, s[84:87], s13 offen offset:256 sc1
buffer_store_dwordx4 v[76:79], v5, s[84:87], s13 offen offset:384 sc1
v_sub_u32 v7, 576, v1
v_add_u32 v8, -1, v7
v_and_b32 v7, 1023, v7
v_lshl_add_u32 v7, v7, 4, v6
v_lshl_add_u32 v8, v8, 4, v6
ds_read_b128 v[32:35], v4 offset:7168
ds_read_b128 v[36:39], v4 offset:7184
ds_read_b128 v[40:43], v7
ds_read_b128 v[44:47], v8
s_waitcnt lgkmcnt(4)
v_add_f32 v48, v16, v24
v_sub_f32 v50, v18, v26
v_add_f32 v52, v18, v26
v_sub_f32 v54, v24, v16
v_add_f32 v49, v20, v28
v_sub_f32 v51, v22, v30
v_add_f32 v53, v22, v30
v_sub_f32 v55, v28, v20
v_add_f32 v56, v17, v25
v_sub_f32 v58, v19, v27
v_add_f32 v60, v19, v27
v_sub_f32 v62, v25, v17
v_add_f32 v57, v21, v29
v_sub_f32 v59, v23, v31
v_add_f32 v61, v23, v31
v_sub_f32 v63, v29, v21
s_add_u32 s13, s12, 6291456
buffer_store_dwordx4 v[48:51], v5, s[84:87], s13 offen sc1
buffer_store_dwordx4 v[52:55], v5, s[84:87], s13 offen offset:128 sc1
buffer_store_dwordx4 v[56:59], v5, s[84:87], s13 offen offset:256 sc1
buffer_store_dwordx4 v[60:63], v5, s[84:87], s13 offen offset:384 sc1
v_sub_u32 v7, 512, v1
v_add_u32 v8, -1, v7
v_and_b32 v7, 1023, v7
v_lshl_add_u32 v7, v7, 4, v6
v_lshl_add_u32 v8, v8, 4, v6
ds_read_b128 v[16:19], v4 offset:8192
ds_read_b128 v[20:23], v4 offset:8208
ds_read_b128 v[24:27], v7
ds_read_b128 v[28:31], v8
s_waitcnt lgkmcnt(4)
v_add_f32 v64, v32, v40
v_sub_f32 v66, v34, v42
v_add_f32 v68, v34, v42
v_sub_f32 v70, v40, v32
v_add_f32 v65, v36, v44
v_sub_f32 v67, v38, v46
v_add_f32 v69, v38, v46
v_sub_f32 v71, v44, v36
v_add_f32 v72, v33, v41
v_sub_f32 v74, v35, v43
v_add_f32 v76, v35, v43
v_sub_f32 v78, v41, v33
v_add_f32 v73, v37, v45
v_sub_f32 v75, v39, v47
v_add_f32 v77, v39, v47
v_sub_f32 v79, v45, v37
s_add_u32 s13, s12, 7340032
buffer_store_dwordx4 v[64:67], v5, s[84:87], s13 offen sc1
buffer_store_dwordx4 v[68:71], v5, s[84:87], s13 offen offset:128 sc1
buffer_store_dwordx4 v[72:75], v5, s[84:87], s13 offen offset:256 sc1
buffer_store_dwordx4 v[76:79], v5, s[84:87], s13 offen offset:384 sc1
s_waitcnt lgkmcnt(0)
v_add_f32 v48, v16, v24
v_sub_f32 v50, v18, v26
v_add_f32 v52, v18, v26
v_sub_f32 v54, v24, v16
v_add_f32 v49, v20, v28
v_sub_f32 v51, v22, v30
v_add_f32 v53, v22, v30
v_sub_f32 v55, v28, v20
v_add_f32 v56, v17, v25
v_sub_f32 v58, v19, v27
v_add_f32 v60, v19, v27
v_sub_f32 v62, v25, v17
v_add_f32 v57, v21, v29
v_sub_f32 v59, v23, v31
v_add_f32 v61, v23, v31
v_sub_f32 v63, v29, v21
s_add_u32 s13, s12, 8388608
v_cmp_eq_u32 vcc, 0, v1
s_and_saveexec_b64 s[14:15], vcc
s_cbranch_execz L_f1r_e
buffer_store_dwordx4 v[48:51], v5, s[84:87], s13 offen sc1
buffer_store_dwordx4 v[52:55], v5, s[84:87], s13 offen offset:128 sc1
buffer_store_dwordx4 v[56:59], v5, s[84:87], s13 offen offset:256 sc1
buffer_store_dwordx4 v[60:63], v5, s[84:87], s13 offen offset:384 sc1
L_f1r_e:
s_mov_b64 exec, -1
s_waitcnt vmcnt(0)
s_barrier
s_cmp_lg_u32 s98, 0
s_cbranch_scc1 L_sg_7
v_mov_b32 v2, 1
s_mov_b32 s81, 71360512
s_mov_b64 exec, 1
buffer_atomic_add v2, off, s[84:87], s81 sc1
s_mov_b64 exec, -1
L_sg_7:
s_cmp_lg_u32 s98, 0
s_cbranch_scc1 L_wf1d
s_mov_b32 s81, 71360512
L_wf1:
buffer_load_dword v120, off, s[84:87], s81 sc1
s_waitcnt vmcnt(0)
v_cmp_ne_u32 vcc, 64, v120
s_cbranch_vccz L_wf1d
s_sleep 6
s_branch L_wf1
L_wf1d:
L_f2go:
s_barrier
s_mov_b32 s30, 0x3f7b14be
s_mov_b32 s31, 0x3f6c835e
s_mov_b32 s32, 0x3f54db31
s_mov_b32 s33, 0x3f3504f3
s_mov_b32 s34, 0x3f0e39da
s_mov_b32 s35, 0x3ec3ef15
s_mov_b32 s36, 0x3e47c5c2
v_lshrrev_b32 v5, 6, v0
v_and_b32 v1, 63, v0
v_readfirstlane_b32 s12, v5
s_lshl_b32 s13, s99, 2
s_add_u32 s13, s13, s12
s_cmp_ge_u32 s13, 257
s_cbranch_scc1 L_f2_end
v_cvt_f32_u32 v2, v1
s_lshl_b32 s15, s13, 15
s_add_u32 s15, s15, 96468992
v_lshlrev_b32 v10, 4, v1
s_add_u32 s16, s15, 0
buffer_load_dwordx4 v[16:19], v10, s[84:87], s16 offen sc1
buffer_load_dwordx4 v[20:23], v10, s[84:87], s16 offen offset:1024 sc1
buffer_load_dwordx4 v[24:27], v10, s[84:87], s16 offen offset:2048 sc1
buffer_load_dwordx4 v[28:31], v10, s[84:87], s16 offen offset:3072 sc1
s_add_u32 s16, s15, 4096
buffer_load_dwordx4 v[32:35], v10, s[84:87], s16 offen sc1
buffer_load_dwordx4 v[36:39], v10, s[84:87], s16 offen offset:1024 sc1
buffer_load_dwordx4 v[40:43], v10, s[84:87], s16 offen offset:2048 sc1
buffer_load_dwordx4 v[44:47], v10, s[84:87], s16 offen offset:3072 sc1
s_add_u32 s16, s15, 8192
buffer_load_dwordx4 v[48:51], v10, s[84:87], s16 offen sc1
buffer_load_dwordx4 v[52:55], v10, s[84:87], s16 offen offset:1024 sc1
buffer_load_dwordx4 v[56:59], v10, s[84:87], s16 offen offset:2048 sc1
buffer_load_dwordx4 v[60:63], v10, s[84:87], s16 offen offset:3072 sc1
s_add_u32 s16, s15, 12288
buffer_load_dwordx4 v[64:67], v10, s[84:87], s16 offen sc1
buffer_load_dwordx4 v[68:71], v10, s[84:87], s16 offen offset:1024 sc1
buffer_load_dwordx4 v[72:75], v10, s[84:87], s16 offen offset:2048 sc1
buffer_load_dwordx4 v[76:79], v10, s[84:87], s16 offen offset:3072 sc1
s_add_u32 s16, s15, 16384
buffer_load_dwordx4 v[80:83], v10, s[84:87], s16 offen sc1
buffer_load_dwordx4 v[84:87], v10, s[84:87], s16 offen offset:1024 sc1
buffer_load_dwordx4 v[88:91], v10, s[84:87], s16 offen offset:2048 sc1
buffer_load_dwordx4 v[92:95], v10, s[84:87], s16 offen offset:3072 sc1
s_add_u32 s16, s15, 20480
buffer_load_dwordx4 v[96:99], v10, s[84:87], s16 offen sc1
buffer_load_dwordx4 v[100:103], v10, s[84:87], s16 offen offset:1024 sc1
buffer_load_dwordx4 v[104:107], v10, s[84:87], s16 offen offset:2048 sc1
buffer_load_dwordx4 v[108:111], v10, s[84:87], s16 offen offset:3072 sc1
s_add_u32 s16, s15, 24576
buffer_load_dwordx4 v[112:115], v10, s[84:87], s16 offen sc1
buffer_load_dwordx4 v[116:119], v10, s[84:87], s16 offen offset:1024 sc1
buffer_load_dwordx4 v[120:123], v10, s[84:87], s16 offen offset:2048 sc1
buffer_load_dwordx4 v[124:127], v10, s[84:87], s16 offen offset:3072 sc1
s_add_u32 s16, s15, 28672
buffer_load_dwordx4 v[128:131], v10, s[84:87], s16 offen sc1
buffer_load_dwordx4 v[132:135], v10, s[84:87], s16 offen offset:1024 sc1
buffer_load_dwordx4 v[136:139], v10, s[84:87], s16 offen offset:2048 sc1
buffer_load_dwordx4 v[140:143], v10, s[84:87], s16 offen offset:3072 sc1
s_mul_i32 s17, s12, 33792
v_add_u32 v3, s17, v10
v_and_b32 v7, 1, v1
v_lshrrev_b32 v6, 1, v1
v_cvt_f32_u32 v8, v6
v_cvt_f32_u32 v9, v7
v_mul_u32_u24 v4, 1056, v6
v_lshl_add_u32 v4, v7, 4, v4
v_add_u32 v4, s17, v4
v_mov_b32 v14, 1.0
v_fma_f32 v14, v9, -2.0, v14
s_waitcnt vmcnt(0)
v_pk_add_f32 v[144:145], v[16:17], v[80:81] neg_lo:[0,1] neg_hi:[0,1]
v_pk_add_f32 v[146:147], v[18:19], v[82:83] neg_lo:[0,1] neg_hi:[0,1]
v_pk_add_f32 v[16:17], v[16:17], v[80:81]
v_pk_add_f32 v[18:19], v[18:19], v[82:83]
v_pk_add_f32 v[80:81], v[20:21], v[84:85] neg_lo:[0,1] neg_hi:[0,1]
v_pk_add_f32 v[82:83], v[22:23], v[86:87] neg_lo:[0,1] neg_hi:[0,1]
v_pk_add_f32 v[20:21], v[20:21], v[84:85]
v_pk_add_f32 v[22:23], v[22:23], v[86:87]
v_pk_mul_f32 v[84:85], v[80:81], s[30:31] op_sel_hi:[1,0]
v_pk_mul_f32 v[86:87], v[80:81], s[36:37] op_sel_hi:[1,0] neg_lo:[0,1] neg_hi:[0,1]
v_pk_fma_f32 v[84:85], v[82:83], s[36:37], v[84:85] op_sel_hi:[1,0,1]
v_pk_fma_f32 v[86:87], v[82:83], s[30:31], v[86:87] op_sel_hi:[1,0,1]
v_pk_add_f32 v[80:81], v[24:25], v[88:89] neg_lo:[0,1] neg_hi:[0,1]
v_pk_add_f32 v[82:83], v[26:27], v[90:91] neg_lo:[0,1] neg_hi:[0,1]
v_pk_add_f32 v[24:25], v[24:25], v[88:89]
v_pk_add_f32 v[26:27], v[26:27], v[90:91]
v_pk_mul_f32 v[88:89], v[80:81], s[30:31] op_sel:[0,1]
v_pk_mul_f32 v[90:91], v[80:81], s[34:35] op_sel:[0,1] neg_lo:[0,1] neg_hi:[0,1]
v_pk_fma_f32 v[88:89], v[82:83], s[34:35], v[88:89] op_sel:[0,1,0]
v_pk_fma_f32 v[90:91], v[82:83], s[30:31], v[90:91] op_sel:[0,1,0]
v_pk_add_f32 v[80:81], v[28:29], v[92:93] neg_lo:[0,1] neg_hi:[0,1]
v_pk_add_f32 v[82:83], v[30:31], v[94:95] neg_lo:[0,1] neg_hi:[0,1]
v_pk_add_f32 v[28:29], v[28:29], v[92:93]
v_pk_add_f32 v[30:31], v[30:31], v[94:95]
v_pk_mul_f32 v[92:93], v[80:81], s[32:33] op_sel_hi:[1,0]
v_pk_mul_f32 v[94:95], v[80:81], s[34:35] op_sel_hi:[1,0] neg_lo:[0,1] neg_hi:[0,1]
v_pk_fma_f32 v[92:93], v[82:83], s[34:35], v[92:93] op_sel_hi:[1,0,1]
v_pk_fma_f32 v[94:95], v[82:83], s[32:33], v[94:95] op_sel_hi:[1,0,1]
v_pk_add_f32 v[80:81], v[32:33], v[96:97] neg_lo:[0,1] neg_hi:[0,1]
v_pk_add_f32 v[82:83], v[34:35], v[98:99] neg_lo:[0,1] neg_hi:[0,1]
v_pk_add_f32 v[32:33], v[32:33], v[96:97]
v_pk_add_f32 v[34:35], v[34:35], v[98:99]
v_pk_mul_f32 v[96:97], v[80:81], s[32:33] op_sel:[0,1]
v_pk_mul_f32 v[98:99], v[80:81], s[32:33] op_sel:[0,1] neg_lo:[0,1] neg_hi:[0,1]
v_pk_fma_f32 v[96:97], v[82:83], s[32:33], v[96:97] op_sel:[0,1,0]
v_pk_fma_f32 v[98:99], v[82:83], s[32:33], v[98:99] op_sel:[0,1,0]
v_pk_add_f32 v[80:81], v[36:37], v[100:101] neg_lo:[0,1] neg_hi:[0,1]
v_pk_add_f32 v[82:83], v[38:39], v[102:103] neg_lo:[0,1] neg_hi:[0,1]
v_pk_add_f32 v[36:37], v[36:37], v[100:101]
v_pk_add_f32 v[38:39], v[38:39], v[102:103]
v_pk_mul_f32 v[100:101], v[80:81], s[34:35] op_sel_hi:[1,0]
v_pk_mul_f32 v[102:103], v[80:81], s[32:33] op_sel_hi:[1,0] neg_lo:[0,1] neg_hi:[0,1]
v_pk_fma_f32 v[100:101], v[82:83], s[32:33], v[100:101] op_sel_hi:[1,0,1]
v_pk_fma_f32 v[102:103], v[82:83], s[34:35], v[102:103] op_sel_hi:[1,0,1]
v_pk_add_f32 v[80:81], v[40:41], v[104:105] neg_lo:[0,1] neg_hi:[0,1]
v_pk_add_f32 v[82:83], v[42:43], v[106:107] neg_lo:[0,1] neg_hi:[0,1]
v_pk_add_f32 v[40:41], v[40:41], v[104:105]
v_pk_add_f32 v[42:43], v[42:43], v[106:107]
v_pk_mul_f32 v[104:105], v[80:81], s[34:35] op_sel:[0,1]
v_pk_mul_f32 v[106:107], v[80:81], s[30:31] op_sel:[0,1] neg_lo:[0,1] neg_hi:[0,1]
v_pk_fma_f32 v[104:105], v[82:83], s[30:31], v[104:105] op_sel:[0,1,0]
v_pk_fma_f32 v[106:107], v[82:83], s[34:35], v[106:107] op_sel:[0,1,0]
v_pk_add_f32 v[80:81], v[44:45], v[108:109] neg_lo:[0,1] neg_hi:[0,1]
v_pk_add_f32 v[82:83], v[46:47], v[110:111] neg_lo:[0,1] neg_hi:[0,1]
v_pk_add_f32 v[44:45], v[44:45], v[108:109]
v_pk_add_f32 v[46:47], v[46:47], v[110:111]
v_pk_mul_f32 v[108:109], v[80:81], s[36:37] op_sel_hi:[1,0]
v_pk_mul_f32 v[110:111], v[80:81], s[30:31] op_sel_hi:[1,0] neg_lo:[0,1] neg_hi:[0,1]
v_pk_fma_f32 v[108:109], v[82:83], s[30:31], v[108:109] op_sel_hi:[1,0,1]
v_pk_fma_f32 v[110:111], v[82:83], s[36:37], v[110:111] op_sel_hi:[1,0,1]
v_pk_add_f32 v[80:81], v[50:51], v[114:115] neg_lo:[0,1] neg_hi:[0,1]
v_pk_add_f32 v[82:83], v[112:113], v[48:49] neg_lo:[0,1] neg_hi:[0,1]
v_pk_add_f32 v[48:49], v[48:49], v[112:113]
v_pk_add_f32 v[50:51], v[50:51], v[114:115]
v_pk_add_f32 v[112:113], v[52:53], v[116:117] neg_lo:[0,1] neg_hi:[0,1]
v_pk_add_f32 v[114:115], v[54:55], v[118:119] neg_lo:[0,1] neg_hi:[0,1]
v_pk_add_f32 v[52:53], v[52:53], v[116:117]
v_pk_add_f32 v[54:55], v[54:55], v[118:119]
v_pk_mul_f32 v[116:117], v[112:113], s[36:37] op_sel_hi:[1,0] neg_lo:[0,1] neg_hi:[0,1]
v_pk_mul_f32 v[118:119], v[112:113], s[30:31] op_sel_hi:[1,0] neg_lo:[0,1] neg_hi:[0,1]
v_pk_fma_f32 v[116:117], v[114:115], s[30:31], v[116:117] op_sel_hi:[1,0,1]
v_pk_fma_f32 v[118:119], v[114:115], s[36:37], v[118:119] op_sel_hi:[1,0,1] neg_lo:[0,1,0] neg_hi:[0,1,0]
v_pk_add_f32 v[112:113], v[56:57], v[120:121] neg_lo:[0,1] neg_hi:[0,1]
v_pk_add_f32 v[114:115], v[58:59], v[122:123] neg_lo:[0,1] neg_hi:[0,1]
v_pk_add_f32 v[56:57], v[56:57], v[120:121]
v_pk_add_f32 v[58:59], v[58:59], v[122:123]
v_pk_mul_f32 v[120:121], v[112:113], s[34:35] op_sel:[0,1] neg_lo:[0,1] neg_hi:[0,1]
v_pk_mul_f32 v[122:123], v[112:113], s[30:31] op_sel:[0,1] neg_lo:[0,1] neg_hi:[0,1]
v_pk_fma_f32 v[120:121], v[114:115], s[30:31], v[120:121] op_sel:[0,1,0]
v_pk_fma_f32 v[122:123], v[114:115], s[34:35], v[122:123] op_sel:[0,1,0] neg_lo:[0,1,0] neg_hi:[0,1,0]
v_pk_add_f32 v[112:113], v[60:61], v[124:125] neg_lo:[0,1] neg_hi:[0,1]
v_pk_add_f32 v[114:115], v[62:63], v[126:127] neg_lo:[0,1] neg_hi:[0,1]
v_pk_add_f32 v[60:61], v[60:61], v[124:125]
v_pk_add_f32 v[62:63], v[62:63], v[126:127]
v_pk_mul_f32 v[124:125], v[112:113], s[34:35] op_sel_hi:[1,0] neg_lo:[0,1] neg_hi:[0,1]
v_pk_mul_f32 v[126:127], v[112:113], s[32:33] op_sel_hi:[1,0] neg_lo:[0,1] neg_hi:[0,1]
v_pk_fma_f32 v[124:125], v[114:115], s[32:33], v[124:125] op_sel_hi:[1,0,1]
v_pk_fma_f32 v[126:127], v[114:115], s[34:35], v[126:127] op_sel_hi:[1,0,1] neg_lo:[0,1,0] neg_hi:[0,1,0]
v_pk_add_f32 v[112:113], v[64:65], v[128:129] neg_lo:[0,1] neg_hi:[0,1]
v_pk_add_f32 v[114:115], v[66:67], v[130:131] neg_lo:[0,1] neg_hi:[0,1]
v_pk_add_f32 v[64:65], v[64:65], v[128:129]
v_pk_add_f32 v[66:67], v[66:67], v[130:131]
v_pk_mul_f32 v[128:129], v[112:113], s[32:33] op_sel:[0,1] neg_lo:[0,1] neg_hi:[0,1]
v_pk_mul_f32 v[130:131], v[112:113], s[32:33] op_sel:[0,1] neg_lo:[0,1] neg_hi:[0,1]
v_pk_fma_f32 v[128:129], v[114:115], s[32:33], v[128:129] op_sel:[0,1,0]
v_pk_fma_f32 v[130:131], v[114:115], s[32:33], v[130:131] op_sel:[0,1,0] neg_lo:[0,1,0] neg_hi:[0,1,0]
v_pk_add_f32 v[112:113], v[68:69], v[132:133] neg_lo:[0,1] neg_hi:[0,1]
v_pk_add_f32 v[114:115], v[70:71], v[134:135] neg_lo:[0,1] neg_hi:[0,1]
v_pk_add_f32 v[68:69], v[68:69], v[132:133]
v_pk_add_f32 v[70:71], v[70:71], v[134:135]
v_pk_mul_f32 v[132:133], v[112:113], s[32:33] op_sel_hi:[1,0] neg_lo:[0,1] neg_hi:[0,1]
v_pk_mul_f32 v[134:135], v[112:113], s[34:35] op_sel_hi:[1,0] neg_lo:[0,1] neg_hi:[0,1]
v_pk_fma_f32 v[132:133], v[114:115], s[34:35], v[132:133] op_sel_hi:[1,0,1]
v_pk_fma_f32 v[134:135], v[114:115], s[32:33], v[134:135] op_sel_hi:[1,0,1] neg_lo:[0,1,0] neg_hi:[0,1,0]
v_pk_add_f32 v[112:113], v[72:73], v[136:137] neg_lo:[0,1] neg_hi:[0,1]
v_pk_add_f32 v[114:115], v[74:75], v[138:139] neg_lo:[0,1] neg_hi:[0,1]
v_pk_add_f32 v[72:73], v[72:73], v[136:137]
v_pk_add_f32 v[74:75], v[74:75], v[138:139]
v_pk_mul_f32 v[136:137], v[112:113], s[30:31] op_sel:[0,1] neg_lo:[0,1] neg_hi:[0,1]
v_pk_mul_f32 v[138:139], v[112:113], s[34:35] op_sel:[0,1] neg_lo:[0,1] neg_hi:[0,1]
v_pk_fma_f32 v[136:137], v[114:115], s[34:35], v[136:137] op_sel:[0,1,0]
v_pk_fma_f32 v[138:139], v[114:115], s[30:31], v[138:139] op_sel:[0,1,0] neg_lo:[0,1,0] neg_hi:[0,1,0]
v_pk_add_f32 v[112:113], v[76:77], v[140:141] neg_lo:[0,1] neg_hi:[0,1]
v_pk_add_f32 v[114:115], v[78:79], v[142:143] neg_lo:[0,1] neg_hi:[0,1]
v_pk_add_f32 v[76:77], v[76:77], v[140:141]
v_pk_add_f32 v[78:79], v[78:79], v[142:143]
v_pk_mul_f32 v[140:141], v[112:113], s[30:31] op_sel_hi:[1,0] neg_lo:[0,1] neg_hi:[0,1]
v_pk_mul_f32 v[142:143], v[112:113], s[36:37] op_sel_hi:[1,0] neg_lo:[0,1] neg_hi:[0,1]
v_pk_fma_f32 v[140:141], v[114:115], s[36:37], v[140:141] op_sel_hi:[1,0,1]
v_pk_fma_f32 v[142:143], v[114:115], s[30:31], v[142:143] op_sel_hi:[1,0,1] neg_lo:[0,1,0] neg_hi:[0,1,0]
v_pk_add_f32 v[112:113], v[16:17], v[48:49] neg_lo:[0,1] neg_hi:[0,1]
v_pk_add_f32 v[114:115], v[18:19], v[50:51] neg_lo:[0,1] neg_hi:[0,1]
v_pk_add_f32 v[16:17], v[16:17], v[48:49]
v_pk_add_f32 v[18:19], v[18:19], v[50:51]
v_pk_add_f32 v[48:49], v[20:21], v[52:53] neg_lo:[0,1] neg_hi:[0,1]
v_pk_add_f32 v[50:51], v[22:23], v[54:55] neg_lo:[0,1] neg_hi:[0,1]
v_pk_add_f32 v[20:21], v[20:21], v[52:53]
v_pk_add_f32 v[22:23], v[22:23], v[54:55]
v_pk_mul_f32 v[52:53], v[48:49], s[30:31] op_sel:[0,1]
v_pk_mul_f32 v[54:55], v[48:49], s[34:35] op_sel:[0,1] neg_lo:[0,1] neg_hi:[0,1]
v_pk_fma_f32 v[52:53], v[50:51], s[34:35], v[52:53] op_sel:[0,1,0]
v_pk_fma_f32 v[54:55], v[50:51], s[30:31], v[54:55] op_sel:[0,1,0]
v_pk_add_f32 v[48:49], v[24:25], v[56:57] neg_lo:[0,1] neg_hi:[0,1]
v_pk_add_f32 v[50:51], v[26:27], v[58:59] neg_lo:[0,1] neg_hi:[0,1]
v_pk_add_f32 v[24:25], v[24:25], v[56:57]
v_pk_add_f32 v[26:27], v[26:27], v[58:59]
v_pk_mul_f32 v[56:57], v[48:49], s[32:33] op_sel:[0,1]
v_pk_mul_f32 v[58:59], v[48:49], s[32:33] op_sel:[0,1] neg_lo:[0,1] neg_hi:[0,1]
v_pk_fma_f32 v[56:57], v[50:51], s[32:33], v[56:57] op_sel:[0,1,0]
v_pk_fma_f32 v[58:59], v[50:51], s[32:33], v[58:59] op_sel:[0,1,0]
v_pk_add_f32 v[48:49], v[28:29], v[60:61] neg_lo:[0,1] neg_hi:[0,1]
v_pk_add_f32 v[50:51], v[30:31], v[62:63] neg_lo:[0,1] neg_hi:[0,1]
v_pk_add_f32 v[28:29], v[28:29], v[60:61]
v_pk_add_f32 v[30:31], v[30:31], v[62:63]
v_pk_mul_f32 v[60:61], v[48:49], s[34:35] op_sel:[0,1]
v_pk_mul_f32 v[62:63], v[48:49], s[30:31] op_sel:[0,1] neg_lo:[0,1] neg_hi:[0,1]
v_pk_fma_f32 v[60:61], v[50:51], s[30:31], v[60:61] op_sel:[0,1,0]
v_pk_fma_f32 v[62:63], v[50:51], s[34:35], v[62:63] op_sel:[0,1,0]
v_pk_add_f32 v[48:49], v[34:35], v[66:67] neg_lo:[0,1] neg_hi:[0,1]
v_pk_add_f32 v[50:51], v[64:65], v[32:33] neg_lo:[0,1] neg_hi:[0,1]
v_pk_add_f32 v[32:33], v[32:33], v[64:65]
v_pk_add_f32 v[34:35], v[34:35], v[66:67]
v_pk_add_f32 v[64:65], v[36:37], v[68:69] neg_lo:[0,1] neg_hi:[0,1]
v_pk_add_f32 v[66:67], v[38:39], v[70:71] neg_lo:[0,1] neg_hi:[0,1]
v_pk_add_f32 v[36:37], v[36:37], v[68:69]
v_pk_add_f32 v[38:39], v[38:39], v[70:71]
v_pk_mul_f32 v[68:69], v[64:65], s[34:35] op_sel:[0,1] neg_lo:[0,1] neg_hi:[0,1]
v_pk_mul_f32 v[70:71], v[64:65], s[30:31] op_sel:[0,1] neg_lo:[0,1] neg_hi:[0,1]
v_pk_fma_f32 v[68:69], v[66:67], s[30:31], v[68:69] op_sel:[0,1,0]
v_pk_fma_f32 v[70:71], v[66:67], s[34:35], v[70:71] op_sel:[0,1,0] neg_lo:[0,1,0] neg_hi:[0,1,0]
v_pk_add_f32 v[64:65], v[40:41], v[72:73] neg_lo:[0,1] neg_hi:[0,1]
v_pk_add_f32 v[66:67], v[42:43], v[74:75] neg_lo:[0,1] neg_hi:[0,1]
v_pk_add_f32 v[40:41], v[40:41], v[72:73]
v_pk_add_f32 v[42:43], v[42:43], v[74:75]
v_pk_mul_f32 v[72:73], v[64:65], s[32:33] op_sel:[0,1] neg_lo:[0,1] neg_hi:[0,1]
v_pk_mul_f32 v[74:75], v[64:65], s[32:33] op_sel:[0,1] neg_lo:[0,1] neg_hi:[0,1]
v_pk_fma_f32 v[72:73], v[66:67], s[32:33], v[72:73] op_sel:[0,1,0]
v_pk_fma_f32 v[74:75], v[66:67], s[32:33], v[74:75] op_sel:[0,1,0] neg_lo:[0,1,0] neg_hi:[0,1,0]
v_pk_add_f32 v[64:65], v[44:45], v[76:77] neg_lo:[0,1] neg_hi:[0,1]
v_pk_add_f32 v[66:67], v[46:47], v[78:79] neg_lo:[0,1] neg_hi:[0,1]
v_pk_add_f32 v[44:45], v[44:45], v[76:77]
v_pk_add_f32 v[46:47], v[46:47], v[78:79]
v_pk_mul_f32 v[76:77], v[64:65], s[30:31] op_sel:[0,1] neg_lo:[0,1] neg_hi:[0,1]
v_pk_mul_f32 v[78:79], v[64:65], s[34:35] op_sel:[0,1] neg_lo:[0,1] neg_hi:[0,1]
v_pk_fma_f32 v[76:77], v[66:67], s[34:35], v[76:77] op_sel:[0,1,0]
v_pk_fma_f32 v[78:79], v[66:67], s[30:31], v[78:79] op_sel:[0,1,0] neg_lo:[0,1,0] neg_hi:[0,1,0]
v_pk_add_f32 v[64:65], v[144:145], v[80:81] neg_lo:[0,1] neg_hi:[0,1]
v_pk_add_f32 v[66:67], v[146:147], v[82:83] neg_lo:[0,1] neg_hi:[0,1]
v_pk_add_f32 v[144:145], v[144:145], v[80:81]
v_pk_add_f32 v[146:147], v[146:147], v[82:83]
v_pk_add_f32 v[80:81], v[84:85], v[116:117] neg_lo:[0,1] neg_hi:[0,1]
v_pk_add_f32 v[82:83], v[86:87], v[118:119] neg_lo:[0,1] neg_hi:[0,1]
v_pk_add_f32 v[84:85], v[84:85], v[116:117]
v_pk_add_f32 v[86:87], v[86:87], v[118:119]
v_pk_mul_f32 v[116:117], v[80:81], s[30:31] op_sel:[0,1]
v_pk_mul_f32 v[118:119], v[80:81], s[34:35] op_sel:[0,1] neg_lo:[0,1] neg_hi:[0,1]
v_pk_fma_f32 v[116:117], v[82:83], s[34:35], v[116:117] op_sel:[0,1,0]
v_pk_fma_f32 v[118:119], v[82:83], s[30:31], v[118:119] op_sel:[0,1,0]
v_pk_add_f32 v[80:81], v[88:89], v[120:121] neg_lo:[0,1] neg_hi:[0,1]
v_pk_add_f32 v[82:83], v[90:91], v[122:123] neg_lo:[0,1] neg_hi:[0,1]
v_pk_add_f32 v[88:89], v[88:89], v[120:121]
v_pk_add_f32 v[90:91], v[90:91], v[122:123]
v_pk_mul_f32 v[120:121], v[80:81], s[32:33] op_sel:[0,1]
v_pk_mul_f32 v[122:123], v[80:81], s[32:33] op_sel:[0,1] neg_lo:[0,1] neg_hi:[0,1]
v_pk_fma_f32 v[120:121], v[82:83], s[32:33], v[120:121] op_sel:[0,1,0]
v_pk_fma_f32 v[122:123], v[82:83], s[32:33], v[122:123] op_sel:[0,1,0]
v_pk_add_f32 v[80:81], v[92:93], v[124:125] neg_lo:[0,1] neg_hi:[0,1]
v_pk_add_f32 v[82:83], v[94:95], v[126:127] neg_lo:[0,1] neg_hi:[0,1]
v_pk_add_f32 v[92:93], v[92:93], v[124:125]
v_pk_add_f32 v[94:95], v[94:95], v[126:127]
v_pk_mul_f32 v[124:125], v[80:81], s[34:35] op_sel:[0,1]
v_pk_mul_f32 v[126:127], v[80:81], s[30:31] op_sel:[0,1] neg_lo:[0,1] neg_hi:[0,1]
v_pk_fma_f32 v[124:125], v[82:83], s[30:31], v[124:125] op_sel:[0,1,0]
v_pk_fma_f32 v[126:127], v[82:83], s[34:35], v[126:127] op_sel:[0,1,0]
v_pk_add_f32 v[80:81], v[98:99], v[130:131] neg_lo:[0,1] neg_hi:[0,1]
v_pk_add_f32 v[82:83], v[128:129], v[96:97] neg_lo:[0,1] neg_hi:[0,1]
v_pk_add_f32 v[96:97], v[96:97], v[128:129]
v_pk_add_f32 v[98:99], v[98:99], v[130:131]
v_pk_add_f32 v[128:129], v[100:101], v[132:133] neg_lo:[0,1] neg_hi:[0,1]
v_pk_add_f32 v[130:131], v[102:103], v[134:135] neg_lo:[0,1] neg_hi:[0,1]
v_pk_add_f32 v[100:101], v[100:101], v[132:133]
v_pk_add_f32 v[102:103], v[102:103], v[134:135]
v_pk_mul_f32 v[132:133], v[128:129], s[34:35] op_sel:[0,1] neg_lo:[0,1] neg_hi:[0,1]
v_pk_mul_f32 v[134:135], v[128:129], s[30:31] op_sel:[0,1] neg_lo:[0,1] neg_hi:[0,1]
v_pk_fma_f32 v[132:133], v[130:131], s[30:31], v[132:133] op_sel:[0,1,0]
v_pk_fma_f32 v[134:135], v[130:131], s[34:35], v[134:135] op_sel:[0,1,0] neg_lo:[0,1,0] neg_hi:[0,1,0]
v_pk_add_f32 v[128:129], v[104:105], v[136:137] neg_lo:[0,1] neg_hi:[0,1]
v_pk_add_f32 v[130:131], v[106:107], v[138:139] neg_lo:[0,1] neg_hi:[0,1]
v_pk_add_f32 v[104:105], v[104:105], v[136:137]
v_pk_add_f32 v[106:107], v[106:107], v[138:139]
v_pk_mul_f32 v[136:137], v[128:129], s[32:33] op_sel:[0,1] neg_lo:[0,1] neg_hi:[0,1]
v_pk_mul_f32 v[138:139], v[128:129], s[32:33] op_sel:[0,1] neg_lo:[0,1] neg_hi:[0,1]
v_pk_fma_f32 v[136:137], v[130:131], s[32:33], v[136:137] op_sel:[0,1,0]
v_pk_fma_f32 v[138:139], v[130:131], s[32:33], v[138:139] op_sel:[0,1,0] neg_lo:[0,1,0] neg_hi:[0,1,0]
v_pk_add_f32 v[128:129], v[108:109], v[140:141] neg_lo:[0,1] neg_hi:[0,1]
v_pk_add_f32 v[130:131], v[110:111], v[142:143] neg_lo:[0,1] neg_hi:[0,1]
v_pk_add_f32 v[108:109], v[108:109], v[140:141]
v_pk_add_f32 v[110:111], v[110:111], v[142:143]
v_pk_mul_f32 v[140:141], v[128:129], s[30:31] op_sel:[0,1] neg_lo:[0,1] neg_hi:[0,1]
v_pk_mul_f32 v[142:143], v[128:129], s[34:35] op_sel:[0,1] neg_lo:[0,1] neg_hi:[0,1]
v_pk_fma_f32 v[140:141], v[130:131], s[34:35], v[140:141] op_sel:[0,1,0]
v_pk_fma_f32 v[142:143], v[130:131], s[30:31], v[142:143] op_sel:[0,1,0] neg_lo:[0,1,0] neg_hi:[0,1,0]
v_pk_add_f32 v[128:129], v[16:17], v[32:33] neg_lo:[0,1] neg_hi:[0,1]
v_pk_add_f32 v[130:131], v[18:19], v[34:35] neg_lo:[0,1] neg_hi:[0,1]
v_pk_add_f32 v[16:17], v[16:17], v[32:33]
v_pk_add_f32 v[18:19], v[18:19], v[34:35]
v_pk_add_f32 v[32:33], v[20:21], v[36:37] neg_lo:[0,1] neg_hi:[0,1]
v_pk_add_f32 v[34:35], v[22:23], v[38:39] neg_lo:[0,1] neg_hi:[0,1]
v_pk_add_f32 v[20:21], v[20:21], v[36:37]
v_pk_add_f32 v[22:23], v[22:23], v[38:39]
v_pk_mul_f32 v[36:37], v[32:33], s[32:33] op_sel:[0,1]
v_pk_mul_f32 v[38:39], v[32:33], s[32:33] op_sel:[0,1] neg_lo:[0,1] neg_hi:[0,1]
v_pk_fma_f32 v[36:37], v[34:35], s[32:33], v[36:37] op_sel:[0,1,0]
v_pk_fma_f32 v[38:39], v[34:35], s[32:33], v[38:39] op_sel:[0,1,0]
v_pk_add_f32 v[32:33], v[26:27], v[42:43] neg_lo:[0,1] neg_hi:[0,1]
v_pk_add_f32 v[34:35], v[40:41], v[24:25] neg_lo:[0,1] neg_hi:[0,1]
v_pk_add_f32 v[24:25], v[24:25], v[40:41]
v_pk_add_f32 v[26:27], v[26:27], v[42:43]
v_pk_add_f32 v[40:41], v[28:29], v[44:45] neg_lo:[0,1] neg_hi:[0,1]
v_pk_add_f32 v[42:43], v[30:31], v[46:47] neg_lo:[0,1] neg_hi:[0,1]
v_pk_add_f32 v[28:29], v[28:29], v[44:45]
v_pk_add_f32 v[30:31], v[30:31], v[46:47]
v_pk_mul_f32 v[44:45], v[40:41], s[32:33] op_sel:[0,1] neg_lo:[0,1] neg_hi:[0,1]
v_pk_mul_f32 v[46:47], v[40:41], s[32:33] op_sel:[0,1] neg_lo:[0,1] neg_hi:[0,1]
v_pk_fma_f32 v[44:45], v[42:43], s[32:33], v[44:45] op_sel:[0,1,0]
v_pk_fma_f32 v[46:47], v[42:43], s[32:33], v[46:47] op_sel:[0,1,0] neg_lo:[0,1,0] neg_hi:[0,1,0]
v_pk_add_f32 v[40:41], v[112:113], v[48:49] neg_lo:[0,1] neg_hi:[0,1]
v_pk_add_f32 v[42:43], v[114:115], v[50:51] neg_lo:[0,1] neg_hi:[0,1]
v_pk_add_f32 v[112:113], v[112:113], v[48:49]
v_pk_add_f32 v[114:115], v[114:115], v[50:51]
v_pk_add_f32 v[48:49], v[52:53], v[68:69] neg_lo:[0,1] neg_hi:[0,1]
v_pk_add_f32 v[50:51], v[54:55], v[70:71] neg_lo:[0,1] neg_hi:[0,1]
v_pk_add_f32 v[52:53], v[52:53], v[68:69]
v_pk_add_f32 v[54:55], v[54:55], v[70:71]
v_pk_mul_f32 v[68:69], v[48:49], s[32:33] op_sel:[0,1]
v_pk_mul_f32 v[70:71], v[48:49], s[32:33] op_sel:[0,1] neg_lo:[0,1] neg_hi:[0,1]
v_pk_fma_f32 v[68:69], v[50:51], s[32:33], v[68:69] op_sel:[0,1,0]
v_pk_fma_f32 v[70:71], v[50:51], s[32:33], v[70:71] op_sel:[0,1,0]
v_pk_add_f32 v[48:49], v[58:59], v[74:75] neg_lo:[0,1] neg_hi:[0,1]
v_pk_add_f32 v[50:51], v[72:73], v[56:57] neg_lo:[0,1] neg_hi:[0,1]
v_pk_add_f32 v[56:57], v[56:57], v[72:73]
v_pk_add_f32 v[58:59], v[58:59], v[74:75]
v_pk_add_f32 v[72:73], v[60:61], v[76:77] neg_lo:[0,1] neg_hi:[0,1]
v_pk_add_f32 v[74:75], v[62:63], v[78:79] neg_lo:[0,1] neg_hi:[0,1]
v_pk_add_f32 v[60:61], v[60:61], v[76:77]
v_pk_add_f32 v[62:63], v[62:63], v[78:79]
v_pk_mul_f32 v[76:77], v[72:73], s[32:33] op_sel:[0,1] neg_lo:[0,1] neg_hi:[0,1]
v_pk_mul_f32 v[78:79], v[72:73], s[32:33] op_sel:[0,1] neg_lo:[0,1] neg_hi:[0,1]
v_pk_fma_f32 v[76:77], v[74:75], s[32:33], v[76:77] op_sel:[0,1,0]
v_pk_fma_f32 v[78:79], v[74:75], s[32:33], v[78:79] op_sel:[0,1,0] neg_lo:[0,1,0] neg_hi:[0,1,0]
v_pk_add_f32 v[72:73], v[144:145], v[96:97] neg_lo:[0,1] neg_hi:[0,1]
v_pk_add_f32 v[74:75], v[146:147], v[98:99] neg_lo:[0,1] neg_hi:[0,1]
v_pk_add_f32 v[144:145], v[144:145], v[96:97]
v_pk_add_f32 v[146:147], v[146:147], v[98:99]
v_pk_add_f32 v[96:97], v[84:85], v[100:101] neg_lo:[0,1] neg_hi:[0,1]
v_pk_add_f32 v[98:99], v[86:87], v[102:103] neg_lo:[0,1] neg_hi:[0,1]
v_pk_add_f32 v[84:85], v[84:85], v[100:101]
v_pk_add_f32 v[86:87], v[86:87], v[102:103]
v_pk_mul_f32 v[100:101], v[96:97], s[32:33] op_sel:[0,1]
v_pk_mul_f32 v[102:103], v[96:97], s[32:33] op_sel:[0,1] neg_lo:[0,1] neg_hi:[0,1]
v_pk_fma_f32 v[100:101], v[98:99], s[32:33], v[100:101] op_sel:[0,1,0]
v_pk_fma_f32 v[102:103], v[98:99], s[32:33], v[102:103] op_sel:[0,1,0]
v_pk_add_f32 v[96:97], v[90:91], v[106:107] neg_lo:[0,1] neg_hi:[0,1]
v_pk_add_f32 v[98:99], v[104:105], v[88:89] neg_lo:[0,1] neg_hi:[0,1]
v_pk_add_f32 v[88:89], v[88:89], v[104:105]
v_pk_add_f32 v[90:91], v[90:91], v[106:107]
v_pk_add_f32 v[104:105], v[92:93], v[108:109] neg_lo:[0,1] neg_hi:[0,1]
v_pk_add_f32 v[106:107], v[94:95], v[110:111] neg_lo:[0,1] neg_hi:[0,1]
v_pk_add_f32 v[92:93], v[92:93], v[108:109]
v_pk_add_f32 v[94:95], v[94:95], v[110:111]
v_pk_mul_f32 v[108:109], v[104:105], s[32:33] op_sel:[0,1] neg_lo:[0,1] neg_hi:[0,1]
v_pk_mul_f32 v[110:111], v[104:105], s[32:33] op_sel:[0,1] neg_lo:[0,1] neg_hi:[0,1]
v_pk_fma_f32 v[108:109], v[106:107], s[32:33], v[108:109] op_sel:[0,1,0]
v_pk_fma_f32 v[110:111], v[106:107], s[32:33], v[110:111] op_sel:[0,1,0] neg_lo:[0,1,0] neg_hi:[0,1,0]
v_pk_add_f32 v[104:105], v[64:65], v[80:81] neg_lo:[0,1] neg_hi:[0,1]
v_pk_add_f32 v[106:107], v[66:67], v[82:83] neg_lo:[0,1] neg_hi:[0,1]
v_pk_add_f32 v[64:65], v[64:65], v[80:81]
v_pk_add_f32 v[66:67], v[66:67], v[82:83]
v_pk_add_f32 v[80:81], v[116:117], v[132:133] neg_lo:[0,1] neg_hi:[0,1]
v_pk_add_f32 v[82:83], v[118:119], v[134:135] neg_lo:[0,1] neg_hi:[0,1]
v_pk_add_f32 v[116:117], v[116:117], v[132:133]
v_pk_add_f32 v[118:119], v[118:119], v[134:135]
v_pk_mul_f32 v[132:133], v[80:81], s[32:33] op_sel:[0,1]
v_pk_mul_f32 v[134:135], v[80:81], s[32:33] op_sel:[0,1] neg_lo:[0,1] neg_hi:[0,1]
v_pk_fma_f32 v[132:133], v[82:83], s[32:33], v[132:133] op_sel:[0,1,0]
v_pk_fma_f32 v[134:135], v[82:83], s[32:33], v[134:135] op_sel:[0,1,0]
v_pk_add_f32 v[80:81], v[122:123], v[138:139] neg_lo:[0,1] neg_hi:[0,1]
v_pk_add_f32 v[82:83], v[136:137], v[120:121] neg_lo:[0,1] neg_hi:[0,1]
v_pk_add_f32 v[120:121], v[120:121], v[136:137]
v_pk_add_f32 v[122:123], v[122:123], v[138:139]
v_pk_add_f32 v[136:137], v[124:125], v[140:141] neg_lo:[0,1] neg_hi:[0,1]
v_pk_add_f32 v[138:139], v[126:127], v[142:143] neg_lo:[0,1] neg_hi:[0,1]
v_pk_add_f32 v[124:125], v[124:125], v[140:141]
v_pk_add_f32 v[126:127], v[126:127], v[142:143]
v_pk_mul_f32 v[140:141], v[136:137], s[32:33] op_sel:[0,1] neg_lo:[0,1] neg_hi:[0,1]
v_pk_mul_f32 v[142:143], v[136:137], s[32:33] op_sel:[0,1] neg_lo:[0,1] neg_hi:[0,1]
v_pk_fma_f32 v[140:141], v[138:139], s[32:33], v[140:141] op_sel:[0,1,0]
v_pk_fma_f32 v[142:143], v[138:139], s[32:33], v[142:143] op_sel:[0,1,0] neg_lo:[0,1,0] neg_hi:[0,1,0]
v_pk_add_f32 v[136:137], v[16:17], v[24:25] neg_lo:[0,1] neg_hi:[0,1]
v_pk_add_f32 v[138:139], v[18:19], v[26:27] neg_lo:[0,1] neg_hi:[0,1]
v_pk_add_f32 v[16:17], v[16:17], v[24:25]
v_pk_add_f32 v[18:19], v[18:19], v[26:27]
v_pk_add_f32 v[24:25], v[22:23], v[30:31] neg_lo:[0,1] neg_hi:[0,1]
v_pk_add_f32 v[26:27], v[28:29], v[20:21] neg_lo:[0,1] neg_hi:[0,1]
v_pk_add_f32 v[20:21], v[20:21], v[28:29]
v_pk_add_f32 v[22:23], v[22:23], v[30:31]
v_pk_add_f32 v[28:29], v[128:129], v[32:33] neg_lo:[0,1] neg_hi:[0,1]
v_pk_add_f32 v[30:31], v[130:131], v[34:35] neg_lo:[0,1] neg_hi:[0,1]
v_pk_add_f32 v[128:129], v[128:129], v[32:33]
v_pk_add_f32 v[130:131], v[130:131], v[34:35]
v_pk_add_f32 v[32:33], v[38:39], v[46:47] neg_lo:[0,1] neg_hi:[0,1]
v_pk_add_f32 v[34:35], v[44:45], v[36:37] neg_lo:[0,1] neg_hi:[0,1]
v_pk_add_f32 v[36:37], v[36:37], v[44:45]
v_pk_add_f32 v[38:39], v[38:39], v[46:47]
v_pk_add_f32 v[44:45], v[112:113], v[56:57] neg_lo:[0,1] neg_hi:[0,1]
v_pk_add_f32 v[46:47], v[114:115], v[58:59] neg_lo:[0,1] neg_hi:[0,1]
v_pk_add_f32 v[112:113], v[112:113], v[56:57]
v_pk_add_f32 v[114:115], v[114:115], v[58:59]
v_pk_add_f32 v[56:57], v[54:55], v[62:63] neg_lo:[0,1] neg_hi:[0,1]
v_pk_add_f32 v[58:59], v[60:61], v[52:53] neg_lo:[0,1] neg_hi:[0,1]
v_pk_add_f32 v[52:53], v[52:53], v[60:61]
v_pk_add_f32 v[54:55], v[54:55], v[62:63]
v_pk_add_f32 v[60:61], v[40:41], v[48:49] neg_lo:[0,1] neg_hi:[0,1]
v_pk_add_f32 v[62:63], v[42:43], v[50:51] neg_lo:[0,1] neg_hi:[0,1]
v_pk_add_f32 v[40:41], v[40:41], v[48:49]
v_pk_add_f32 v[42:43], v[42:43], v[50:51]
v_pk_add_f32 v[48:49], v[70:71], v[78:79] neg_lo:[0,1] neg_hi:[0,1]
v_pk_add_f32 v[50:51], v[76:77], v[68:69] neg_lo:[0,1] neg_hi:[0,1]
v_pk_add_f32 v[68:69], v[68:69], v[76:77]
v_pk_add_f32 v[70:71], v[70:71], v[78:79]
v_pk_add_f32 v[76:77], v[144:145], v[88:89] neg_lo:[0,1] neg_hi:[0,1]
v_pk_add_f32 v[78:79], v[146:147], v[90:91] neg_lo:[0,1] neg_hi:[0,1]
v_pk_add_f32 v[144:145], v[144:145], v[88:89]
v_pk_add_f32 v[146:147], v[146:147], v[90:91]
v_pk_add_f32 v[88:89], v[86:87], v[94:95] neg_lo:[0,1] neg_hi:[0,1]
v_pk_add_f32 v[90:91], v[92:93], v[84:85] neg_lo:[0,1] neg_hi:[0,1]
v_pk_add_f32 v[84:85], v[84:85], v[92:93]
v_pk_add_f32 v[86:87], v[86:87], v[94:95]
v_pk_add_f32 v[92:93], v[72:73], v[96:97] neg_lo:[0,1] neg_hi:[0,1]
v_pk_add_f32 v[94:95], v[74:75], v[98:99] neg_lo:[0,1] neg_hi:[0,1]
v_pk_add_f32 v[72:73], v[72:73], v[96:97]
v_pk_add_f32 v[74:75], v[74:75], v[98:99]
v_pk_add_f32 v[96:97], v[102:103], v[110:111] neg_lo:[0,1] neg_hi:[0,1]
v_pk_add_f32 v[98:99], v[108:109], v[100:101] neg_lo:[0,1] neg_hi:[0,1]
v_pk_add_f32 v[100:101], v[100:101], v[108:109]
v_pk_add_f32 v[102:103], v[102:103], v[110:111]
v_pk_add_f32 v[108:109], v[64:65], v[120:121] neg_lo:[0,1] neg_hi:[0,1]
v_pk_add_f32 v[110:111], v[66:67], v[122:123] neg_lo:[0,1] neg_hi:[0,1]
v_pk_add_f32 v[64:65], v[64:65], v[120:121]
v_pk_add_f32 v[66:67], v[66:67], v[122:123]
v_pk_add_f32 v[120:121], v[118:119], v[126:127] neg_lo:[0,1] neg_hi:[0,1]
v_pk_add_f32 v[122:123], v[124:125], v[116:117] neg_lo:[0,1] neg_hi:[0,1]
v_pk_add_f32 v[116:117], v[116:117], v[124:125]
v_pk_add_f32 v[118:119], v[118:119], v[126:127]
v_pk_add_f32 v[124:125], v[104:105], v[80:81] neg_lo:[0,1] neg_hi:[0,1]
v_pk_add_f32 v[126:127], v[106:107], v[82:83] neg_lo:[0,1] neg_hi:[0,1]
v_pk_add_f32 v[104:105], v[104:105], v[80:81]
v_pk_add_f32 v[106:107], v[106:107], v[82:83]
v_pk_add_f32 v[80:81], v[134:135], v[142:143] neg_lo:[0,1] neg_hi:[0,1]
v_pk_add_f32 v[82:83], v[140:141], v[132:133] neg_lo:[0,1] neg_hi:[0,1]
v_pk_add_f32 v[132:133], v[132:133], v[140:141]
v_pk_add_f32 v[134:135], v[134:135], v[142:143]
v_pk_add_f32 v[140:141], v[16:17], v[20:21] neg_lo:[0,1] neg_hi:[0,1]
v_pk_add_f32 v[142:143], v[18:19], v[22:23] neg_lo:[0,1] neg_hi:[0,1]
v_pk_add_f32 v[16:17], v[16:17], v[20:21]
v_pk_add_f32 v[18:19], v[18:19], v[22:23]
v_pk_add_f32 v[20:21], v[136:137], v[24:25] neg_lo:[0,1] neg_hi:[0,1]
v_pk_add_f32 v[22:23], v[138:139], v[26:27] neg_lo:[0,1] neg_hi:[0,1]
v_pk_add_f32 v[136:137], v[136:137], v[24:25]
v_pk_add_f32 v[138:139], v[138:139], v[26:27]
v_pk_add_f32 v[24:25], v[128:129], v[36:37] neg_lo:[0,1] neg_hi:[0,1]
v_pk_add_f32 v[26:27], v[130:131], v[38:39] neg_lo:[0,1] neg_hi:[0,1]
v_pk_add_f32 v[128:129], v[128:129], v[36:37]
v_pk_add_f32 v[130:131], v[130:131], v[38:39]
v_pk_add_f32 v[36:37], v[28:29], v[32:33] neg_lo:[0,1] neg_hi:[0,1]
v_pk_add_f32 v[38:39], v[30:31], v[34:35] neg_lo:[0,1] neg_hi:[0,1]
v_pk_add_f32 v[28:29], v[28:29], v[32:33]
v_pk_add_f32 v[30:31], v[30:31], v[34:35]
v_pk_add_f32 v[32:33], v[112:113], v[52:53] neg_lo:[0,1] neg_hi:[0,1]
v_pk_add_f32 v[34:35], v[114:115], v[54:55] neg_lo:[0,1] neg_hi:[0,1]
v_pk_add_f32 v[112:113], v[112:113], v[52:53]
v_pk_add_f32 v[114:115], v[114:115], v[54:55]
v_pk_add_f32 v[52:53], v[44:45], v[56:57] neg_lo:[0,1] neg_hi:[0,1]
v_pk_add_f32 v[54:55], v[46:47], v[58:59] neg_lo:[0,1] neg_hi:[0,1]
v_pk_add_f32 v[44:45], v[44:45], v[56:57]
v_pk_add_f32 v[46:47], v[46:47], v[58:59]
v_pk_add_f32 v[56:57], v[40:41], v[68:69] neg_lo:[0,1] neg_hi:[0,1]
v_pk_add_f32 v[58:59], v[42:43], v[70:71] neg_lo:[0,1] neg_hi:[0,1]
v_pk_add_f32 v[40:41], v[40:41], v[68:69]
v_pk_add_f32 v[42:43], v[42:43], v[70:71]
v_pk_add_f32 v[68:69], v[60:61], v[48:49] neg_lo:[0,1] neg_hi:[0,1]
v_pk_add_f32 v[70:71], v[62:63], v[50:51] neg_lo:[0,1] neg_hi:[0,1]
v_pk_add_f32 v[60:61], v[60:61], v[48:49]
v_pk_add_f32 v[62:63], v[62:63], v[50:51]
v_pk_add_f32 v[48:49], v[144:145], v[84:85] neg_lo:[0,1] neg_hi:[0,1]
v_pk_add_f32 v[50:51], v[146:147], v[86:87] neg_lo:[0,1] neg_hi:[0,1]
v_pk_add_f32 v[144:145], v[144:145], v[84:85]
v_pk_add_f32 v[146:147], v[146:147], v[86:87]
v_pk_add_f32 v[84:85], v[76:77], v[88:89] neg_lo:[0,1] neg_hi:[0,1]
v_pk_add_f32 v[86:87], v[78:79], v[90:91] neg_lo:[0,1] neg_hi:[0,1]
v_pk_add_f32 v[76:77], v[76:77], v[88:89]
v_pk_add_f32 v[78:79], v[78:79], v[90:91]
v_pk_add_f32 v[88:89], v[72:73], v[100:101] neg_lo:[0,1] neg_hi:[0,1]
v_pk_add_f32 v[90:91], v[74:75], v[102:103] neg_lo:[0,1] neg_hi:[0,1]
v_pk_add_f32 v[72:73], v[72:73], v[100:101]
v_pk_add_f32 v[74:75], v[74:75], v[102:103]
v_pk_add_f32 v[100:101], v[92:93], v[96:97] neg_lo:[0,1] neg_hi:[0,1]
v_pk_add_f32 v[102:103], v[94:95], v[98:99] neg_lo:[0,1] neg_hi:[0,1]
v_pk_add_f32 v[92:93], v[92:93], v[96:97]
v_pk_add_f32 v[94:95], v[94:95], v[98:99]
v_pk_add_f32 v[96:97], v[64:65], v[116:117] neg_lo:[0,1] neg_hi:[0,1]
v_pk_add_f32 v[98:99], v[66:67], v[118:119] neg_lo:[0,1] neg_hi:[0,1]
v_pk_add_f32 v[64:65], v[64:65], v[116:117]
v_pk_add_f32 v[66:67], v[66:67], v[118:119]
v_pk_add_f32 v[116:117], v[108:109], v[120:121] neg_lo:[0,1] neg_hi:[0,1]
v_pk_add_f32 v[118:119], v[110:111], v[122:123] neg_lo:[0,1] neg_hi:[0,1]
v_pk_add_f32 v[108:109], v[108:109], v[120:121]
v_pk_add_f32 v[110:111], v[110:111], v[122:123]
v_pk_add_f32 v[120:121], v[104:105], v[132:133] neg_lo:[0,1] neg_hi:[0,1]
v_pk_add_f32 v[122:123], v[106:107], v[134:135] neg_lo:[0,1] neg_hi:[0,1]
v_pk_add_f32 v[104:105], v[104:105], v[132:133]
v_pk_add_f32 v[106:107], v[106:107], v[134:135]
v_pk_add_f32 v[132:133], v[124:125], v[80:81] neg_lo:[0,1] neg_hi:[0,1]
v_pk_add_f32 v[134:135], v[126:127], v[82:83] neg_lo:[0,1] neg_hi:[0,1]
v_pk_add_f32 v[124:125], v[124:125], v[80:81]
v_pk_add_f32 v[126:127], v[126:127], v[82:83]
v_mul_f32 v151, 0xba000000, v2
v_cos_f32 v150, v151
v_sin_f32 v151, v151
v_mul_f32 v149, 0xba800000, v2
v_cos_f32 v148, v149
v_sin_f32 v149, v149
v_pk_mul_f32 v[80:81], v[144:145], v[150:151] op_sel_hi:[1,0]
v_pk_fma_f32 v[80:81], v[146:147], v[150:151], v[80:81] op_sel:[0,1,0] neg_lo:[1,0,0] neg_hi:[1,0,0]
v_pk_mul_f32 v[146:147], v[146:147], v[150:151] op_sel_hi:[1,0]
v_pk_fma_f32 v[146:147], v[144:145], v[150:151], v[146:147] op_sel:[0,1,0]
v_mul_f32 v151, 0xbac00000, v2
v_cos_f32 v150, v151
v_sin_f32 v151, v151
v_pk_mul_f32 v[144:145], v[112:113], v[148:149] op_sel_hi:[1,0]
v_pk_fma_f32 v[144:145], v[114:115], v[148:149], v[144:145] op_sel:[0,1,0] neg_lo:[1,0,0] neg_hi:[1,0,0]
v_pk_mul_f32 v[114:115], v[114:115], v[148:149] op_sel_hi:[1,0]
v_pk_fma_f32 v[114:115], v[112:113], v[148:149], v[114:115] op_sel:[0,1,0]
v_mul_f32 v149, 0xbb000000, v2
v_cos_f32 v148, v149
v_sin_f32 v149, v149
v_pk_mul_f32 v[112:113], v[64:65], v[150:151] op_sel_hi:[1,0]
v_pk_fma_f32 v[112:113], v[66:67], v[150:151], v[112:113] op_sel:[0,1,0] neg_lo:[1,0,0] neg_hi:[1,0,0]
v_pk_mul_f32 v[66:67], v[66:67], v[150:151] op_sel_hi:[1,0]
v_pk_fma_f32 v[66:67], v[64:65], v[150:151], v[66:67] op_sel:[0,1,0]
v_mul_f32 v151, 0xbb200000, v2
v_cos_f32 v150, v151
v_sin_f32 v151, v151
v_pk_mul_f32 v[64:65], v[128:129], v[148:149] op_sel_hi:[1,0]
v_pk_fma_f32 v[64:65], v[130:131], v[148:149], v[64:65] op_sel:[0,1,0] neg_lo:[1,0,0] neg_hi:[1,0,0]
v_pk_mul_f32 v[130:131], v[130:131], v[148:149] op_sel_hi:[1,0]
v_pk_fma_f32 v[130:131], v[128:129], v[148:149], v[130:131] op_sel:[0,1,0]
v_mul_f32 v149, 0xbb400000, v2
v_cos_f32 v148, v149
v_sin_f32 v149, v149
v_pk_mul_f32 v[128:129], v[72:73], v[150:151] op_sel_hi:[1,0]
v_pk_fma_f32 v[128:129], v[74:75], v[150:151], v[128:129] op_sel:[0,1,0] neg_lo:[1,0,0] neg_hi:[1,0,0]
v_pk_mul_f32 v[74:75], v[74:75], v[150:151] op_sel_hi:[1,0]
v_pk_fma_f32 v[74:75], v[72:73], v[150:151], v[74:75] op_sel:[0,1,0]
v_mul_f32 v151, 0xbb600000, v2
v_cos_f32 v150, v151
v_sin_f32 v151, v151
v_pk_mul_f32 v[72:73], v[40:41], v[148:149] op_sel_hi:[1,0]
v_pk_fma_f32 v[72:73], v[42:43], v[148:149], v[72:73] op_sel:[0,1,0] neg_lo:[1,0,0] neg_hi:[1,0,0]
v_pk_mul_f32 v[42:43], v[42:43], v[148:149] op_sel_hi:[1,0]
v_pk_fma_f32 v[42:43], v[40:41], v[148:149], v[42:43] op_sel:[0,1,0]
v_mul_f32 v149, 0xbb800000, v2
v_cos_f32 v148, v149
v_sin_f32 v149, v149
v_pk_mul_f32 v[40:41], v[104:105], v[150:151] op_sel_hi:[1,0]
v_pk_fma_f32 v[40:41], v[106:107], v[150:151], v[40:41] op_sel:[0,1,0] neg_lo:[1,0,0] neg_hi:[1,0,0]
v_pk_mul_f32 v[106:107], v[106:107], v[150:151] op_sel_hi:[1,0]
v_pk_fma_f32 v[106:107], v[104:105], v[150:151], v[106:107] op_sel:[0,1,0]
v_mul_f32 v151, 0xbb900000, v2
v_cos_f32 v150, v151
v_sin_f32 v151, v151
v_pk_mul_f32 v[104:105], v[136:137], v[148:149] op_sel_hi:[1,0]
v_pk_fma_f32 v[104:105], v[138:139], v[148:149], v[104:105] op_sel:[0,1,0] neg_lo:[1,0,0] neg_hi:[1,0,0]
v_pk_mul_f32 v[138:139], v[138:139], v[148:149] op_sel_hi:[1,0]
v_pk_fma_f32 v[138:139], v[136:137], v[148:149], v[138:139] op_sel:[0,1,0]
v_mul_f32 v149, 0xbba00000, v2
v_cos_f32 v148, v149
v_sin_f32 v149, v149
v_pk_mul_f32 v[136:137], v[76:77], v[150:151] op_sel_hi:[1,0]
v_pk_fma_f32 v[136:137], v[78:79], v[150:151], v[136:137] op_sel:[0,1,0] neg_lo:[1,0,0] neg_hi:[1,0,0]
v_pk_mul_f32 v[78:79], v[78:79], v[150:151] op_sel_hi:[1,0]
v_pk_fma_f32 v[78:79], v[76:77], v[150:151], v[78:79] op_sel:[0,1,0]
v_mul_f32 v151, 0xbbb00000, v2
v_cos_f32 v150, v151
v_sin_f32 v151, v151
v_pk_mul_f32 v[76:77], v[44:45], v[148:149] op_sel_hi:[1,0]
v_pk_fma_f32 v[76:77], v[46:47], v[148:149], v[76:77] op_sel:[0,1,0] neg_lo:[1,0,0] neg_hi:[1,0,0]
v_pk_mul_f32 v[46:47], v[46:47], v[148:149] op_sel_hi:[1,0]
v_pk_fma_f32 v[46:47], v[44:45], v[148:149], v[46:47] op_sel:[0,1,0]
v_mul_f32 v149, 0xbbc00000, v2
v_cos_f32 v148, v149
v_sin_f32 v149, v149
v_pk_mul_f32 v[44:45], v[108:109], v[150:151] op_sel_hi:[1,0]
v_pk_fma_f32 v[44:45], v[110:111], v[150:151], v[44:45] op_sel:[0,1,0] neg_lo:[1,0,0] neg_hi:[1,0,0]
v_pk_mul_f32 v[110:111], v[110:111], v[150:151] op_sel_hi:[1,0]
v_pk_fma_f32 v[110:111], v[108:109], v[150:151], v[110:111] op_sel:[0,1,0]
v_mul_f32 v151, 0xbbd00000, v2
v_cos_f32 v150, v151
v_sin_f32 v151, v151
v_pk_mul_f32 v[108:109], v[28:29], v[148:149] op_sel_hi:[1,0]
v_pk_fma_f32 v[108:109], v[30:31], v[148:149], v[108:109] op_sel:[0,1,0] neg_lo:[1,0,0] neg_hi:[1,0,0]
v_pk_mul_f32 v[30:31], v[30:31], v[148:149] op_sel_hi:[1,0]
v_pk_fma_f32 v[30:31], v[28:29], v[148:149], v[30:31] op_sel:[0,1,0]
v_mul_f32 v149, 0xbbe00000, v2
v_cos_f32 v148, v149
v_sin_f32 v149, v149
v_pk_mul_f32 v[28:29], v[92:93], v[150:151] op_sel_hi:[1,0]
v_pk_fma_f32 v[28:29], v[94:95], v[150:151], v[28:29] op_sel:[0,1,0] neg_lo:[1,0,0] neg_hi:[1,0,0]
v_pk_mul_f32 v[94:95], v[94:95], v[150:151] op_sel_hi:[1,0]
v_pk_fma_f32 v[94:95], v[92:93], v[150:151], v[94:95] op_sel:[0,1,0]
v_mul_f32 v151, 0xbbf00000, v2
v_cos_f32 v150, v151
v_sin_f32 v151, v151
v_pk_mul_f32 v[92:93], v[60:61], v[148:149] op_sel_hi:[1,0]
v_pk_fma_f32 v[92:93], v[62:63], v[148:149], v[92:93] op_sel:[0,1,0] neg_lo:[1,0,0] neg_hi:[1,0,0]
v_pk_mul_f32 v[62:63], v[62:63], v[148:149] op_sel_hi:[1,0]
v_pk_fma_f32 v[62:63], v[60:61], v[148:149], v[62:63] op_sel:[0,1,0]
v_mul_f32 v149, 0xbc000000, v2
v_cos_f32 v148, v149
v_sin_f32 v149, v149
v_pk_mul_f32 v[60:61], v[124:125], v[150:151] op_sel_hi:[1,0]
v_pk_fma_f32 v[60:61], v[126:127], v[150:151], v[60:61] op_sel:[0,1,0] neg_lo:[1,0,0] neg_hi:[1,0,0]
v_pk_mul_f32 v[126:127], v[126:127], v[150:151] op_sel_hi:[1,0]
v_pk_fma_f32 v[126:127], v[124:125], v[150:151], v[126:127] op_sel:[0,1,0]
v_mul_f32 v151, 0xbc080000, v2
v_cos_f32 v150, v151
v_sin_f32 v151, v151
v_pk_mul_f32 v[124:125], v[140:141], v[148:149] op_sel_hi:[1,0]
v_pk_fma_f32 v[124:125], v[142:143], v[148:149], v[124:125] op_sel:[0,1,0] neg_lo:[1,0,0] neg_hi:[1,0,0]
v_pk_mul_f32 v[142:143], v[142:143], v[148:149] op_sel_hi:[1,0]
v_pk_fma_f32 v[142:143], v[140:141], v[148:149], v[142:143] op_sel:[0,1,0]
v_mul_f32 v149, 0xbc100000, v2
v_cos_f32 v148, v149
v_sin_f32 v149, v149
v_pk_mul_f32 v[140:141], v[48:49], v[150:151] op_sel_hi:[1,0]
v_pk_fma_f32 v[140:141], v[50:51], v[150:151], v[140:141] op_sel:[0,1,0] neg_lo:[1,0,0] neg_hi:[1,0,0]
v_pk_mul_f32 v[50:51], v[50:51], v[150:151] op_sel_hi:[1,0]
v_pk_fma_f32 v[50:51], v[48:49], v[150:151], v[50:51] op_sel:[0,1,0]
v_mul_f32 v151, 0xbc180000, v2
v_cos_f32 v150, v151
v_sin_f32 v151, v151
v_pk_mul_f32 v[48:49], v[32:33], v[148:149] op_sel_hi:[1,0]
v_pk_fma_f32 v[48:49], v[34:35], v[148:149], v[48:49] op_sel:[0,1,0] neg_lo:[1,0,0] neg_hi:[1,0,0]
v_pk_mul_f32 v[34:35], v[34:35], v[148:149] op_sel_hi:[1,0]
v_pk_fma_f32 v[34:35], v[32:33], v[148:149], v[34:35] op_sel:[0,1,0]
v_mul_f32 v149, 0xbc200000, v2
v_cos_f32 v148, v149
v_sin_f32 v149, v149
v_pk_mul_f32 v[32:33], v[96:97], v[150:151] op_sel_hi:[1,0]
v_pk_fma_f32 v[32:33], v[98:99], v[150:151], v[32:33] op_sel:[0,1,0] neg_lo:[1,0,0] neg_hi:[1,0,0]
v_pk_mul_f32 v[98:99], v[98:99], v[150:151] op_sel_hi:[1,0]
v_pk_fma_f32 v[98:99], v[96:97], v[150:151], v[98:99] op_sel:[0,1,0]
v_mul_f32 v151, 0xbc280000, v2
v_cos_f32 v150, v151
v_sin_f32 v151, v151
v_pk_mul_f32 v[96:97], v[24:25], v[148:149] op_sel_hi:[1,0]
v_pk_fma_f32 v[96:97], v[26:27], v[148:149], v[96:97] op_sel:[0,1,0] neg_lo:[1,0,0] neg_hi:[1,0,0]
v_pk_mul_f32 v[26:27], v[26:27], v[148:149] op_sel_hi:[1,0]
v_pk_fma_f32 v[26:27], v[24:25], v[148:149], v[26:27] op_sel:[0,1,0]
v_mul_f32 v149, 0xbc300000, v2
v_cos_f32 v148, v149
v_sin_f32 v149, v149
v_pk_mul_f32 v[24:25], v[88:89], v[150:151] op_sel_hi:[1,0]
v_pk_fma_f32 v[24:25], v[90:91], v[150:151], v[24:25] op_sel:[0,1,0] neg_lo:[1,0,0] neg_hi:[1,0,0]
v_pk_mul_f32 v[90:91], v[90:91], v[150:151] op_sel_hi:[1,0]
v_pk_fma_f32 v[90:91], v[88:89], v[150:151], v[90:91] op_sel:[0,1,0]
v_mul_f32 v151, 0xbc380000, v2
v_cos_f32 v150, v151
v_sin_f32 v151, v151
v_pk_mul_f32 v[88:89], v[56:57], v[148:149] op_sel_hi:[1,0]
v_pk_fma_f32 v[88:89], v[58:59], v[148:149], v[88:89] op_sel:[0,1,0] neg_lo:[1,0,0] neg_hi:[1,0,0]
v_pk_mul_f32 v[58:59], v[58:59], v[148:149] op_sel_hi:[1,0]
v_pk_fma_f32 v[58:59], v[56:57], v[148:149], v[58:59] op_sel:[0,1,0]
v_mul_f32 v149, 0xbc400000, v2
v_cos_f32 v148, v149
v_sin_f32 v149, v149
v_pk_mul_f32 v[56:57], v[120:121], v[150:151] op_sel_hi:[1,0]
v_pk_fma_f32 v[56:57], v[122:123], v[150:151], v[56:57] op_sel:[0,1,0] neg_lo:[1,0,0] neg_hi:[1,0,0]
v_pk_mul_f32 v[122:123], v[122:123], v[150:151] op_sel_hi:[1,0]
v_pk_fma_f32 v[122:123], v[120:121], v[150:151], v[122:123] op_sel:[0,1,0]
v_mul_f32 v151, 0xbc480000, v2
v_cos_f32 v150, v151
v_sin_f32 v151, v151
v_pk_mul_f32 v[120:121], v[20:21], v[148:149] op_sel_hi:[1,0]
v_pk_fma_f32 v[120:121], v[22:23], v[148:149], v[120:121] op_sel:[0,1,0] neg_lo:[1,0,0] neg_hi:[1,0,0]
v_pk_mul_f32 v[22:23], v[22:23], v[148:149] op_sel_hi:[1,0]
v_pk_fma_f32 v[22:23], v[20:21], v[148:149], v[22:23] op_sel:[0,1,0]
v_mul_f32 v149, 0xbc500000, v2
v_cos_f32 v148, v149
v_sin_f32 v149, v149
v_pk_mul_f32 v[20:21], v[84:85], v[150:151] op_sel_hi:[1,0]
v_pk_fma_f32 v[20:21], v[86:87], v[150:151], v[20:21] op_sel:[0,1,0] neg_lo:[1,0,0] neg_hi:[1,0,0]
v_pk_mul_f32 v[86:87], v[86:87], v[150:151] op_sel_hi:[1,0]
v_pk_fma_f32 v[86:87], v[84:85], v[150:151], v[86:87] op_sel:[0,1,0]
v_mul_f32 v151, 0xbc580000, v2
v_cos_f32 v150, v151
v_sin_f32 v151, v151
v_pk_mul_f32 v[84:85], v[52:53], v[148:149] op_sel_hi:[1,0]
v_pk_fma_f32 v[84:85], v[54:55], v[148:149], v[84:85] op_sel:[0,1,0] neg_lo:[1,0,0] neg_hi:[1,0,0]
v_pk_mul_f32 v[54:55], v[54:55], v[148:149] op_sel_hi:[1,0]
v_pk_fma_f32 v[54:55], v[52:53], v[148:149], v[54:55] op_sel:[0,1,0]
v_mul_f32 v149, 0xbc600000, v2
v_cos_f32 v148, v149
v_sin_f32 v149, v149
v_pk_mul_f32 v[52:53], v[116:117], v[150:151] op_sel_hi:[1,0]
v_pk_fma_f32 v[52:53], v[118:119], v[150:151], v[52:53] op_sel:[0,1,0] neg_lo:[1,0,0] neg_hi:[1,0,0]
v_pk_mul_f32 v[118:119], v[118:119], v[150:151] op_sel_hi:[1,0]
v_pk_fma_f32 v[118:119], v[116:117], v[150:151], v[118:119] op_sel:[0,1,0]
v_mul_f32 v151, 0xbc680000, v2
v_cos_f32 v150, v151
v_sin_f32 v151, v151
v_pk_mul_f32 v[116:117], v[36:37], v[148:149] op_sel_hi:[1,0]
v_pk_fma_f32 v[116:117], v[38:39], v[148:149], v[116:117] op_sel:[0,1,0] neg_lo:[1,0,0] neg_hi:[1,0,0]
v_pk_mul_f32 v[38:39], v[38:39], v[148:149] op_sel_hi:[1,0]
v_pk_fma_f32 v[38:39], v[36:37], v[148:149], v[38:39] op_sel:[0,1,0]
v_mul_f32 v149, 0xbc700000, v2
v_cos_f32 v148, v149
v_sin_f32 v149, v149
v_pk_mul_f32 v[36:37], v[100:101], v[150:151] op_sel_hi:[1,0]
v_pk_fma_f32 v[36:37], v[102:103], v[150:151], v[36:37] op_sel:[0,1,0] neg_lo:[1,0,0] neg_hi:[1,0,0]
v_pk_mul_f32 v[102:103], v[102:103], v[150:151] op_sel_hi:[1,0]
v_pk_fma_f32 v[102:103], v[100:101], v[150:151], v[102:103] op_sel:[0,1,0]
v_mul_f32 v151, 0xbc780000, v2
v_cos_f32 v150, v151
v_sin_f32 v151, v151
v_pk_mul_f32 v[100:101], v[68:69], v[148:149] op_sel_hi:[1,0]
v_pk_fma_f32 v[100:101], v[70:71], v[148:149], v[100:101] op_sel:[0,1,0] neg_lo:[1,0,0] neg_hi:[1,0,0]
v_pk_mul_f32 v[70:71], v[70:71], v[148:149] op_sel_hi:[1,0]
v_pk_fma_f32 v[70:71], v[68:69], v[148:149], v[70:71] op_sel:[0,1,0]
s_nop 0
v_pk_mul_f32 v[68:69], v[132:133], v[150:151] op_sel_hi:[1,0]
v_pk_fma_f32 v[68:69], v[134:135], v[150:151], v[68:69] op_sel:[0,1,0] neg_lo:[1,0,0] neg_hi:[1,0,0]
v_pk_mul_f32 v[134:135], v[134:135], v[150:151] op_sel_hi:[1,0]
v_pk_fma_f32 v[134:135], v[132:133], v[150:151], v[134:135] op_sel:[0,1,0]
ds_write_b64 v3, v[16:17]
ds_write_b64 v3, v[18:19] offset:8
ds_write_b64 v3, v[80:81] offset:1056
ds_write_b64 v3, v[146:147] offset:1064
ds_write_b64 v3, v[144:145] offset:2112
ds_write_b64 v3, v[114:115] offset:2120
ds_write_b64 v3, v[112:113] offset:3168
ds_write_b64 v3, v[66:67] offset:3176
ds_write_b64 v3, v[64:65] offset:4224
ds_write_b64 v3, v[130:131] offset:4232
ds_write_b64 v3, v[128:129] offset:5280
ds_write_b64 v3, v[74:75] offset:5288
ds_write_b64 v3, v[72:73] offset:6336
ds_write_b64 v3, v[42:43] offset:6344
ds_write_b64 v3, v[40:41] offset:7392
ds_write_b64 v3, v[106:107] offset:7400
ds_write_b64 v3, v[104:105] offset:8448
ds_write_b64 v3, v[138:139] offset:8456
ds_write_b64 v3, v[136:137] offset:9504
ds_write_b64 v3, v[78:79] offset:9512
ds_write_b64 v3, v[76:77] offset:10560
ds_write_b64 v3, v[46:47] offset:10568
ds_write_b64 v3, v[44:45] offset:11616
ds_write_b64 v3, v[110:111] offset:11624
ds_write_b64 v3, v[108:109] offset:12672
ds_write_b64 v3, v[30:31] offset:12680
ds_write_b64 v3, v[28:29] offset:13728
ds_write_b64 v3, v[94:95] offset:13736
ds_write_b64 v3, v[92:93] offset:14784
ds_write_b64 v3, v[62:63] offset:14792
ds_write_b64 v3, v[60:61] offset:15840
ds_write_b64 v3, v[126:127] offset:15848
ds_write_b64 v3, v[124:125] offset:16896
ds_write_b64 v3, v[142:143] offset:16904
ds_write_b64 v3, v[140:141] offset:17952
ds_write_b64 v3, v[50:51] offset:17960
ds_write_b64 v3, v[48:49] offset:19008
ds_write_b64 v3, v[34:35] offset:19016
ds_write_b64 v3, v[32:33] offset:20064
ds_write_b64 v3, v[98:99] offset:20072
ds_write_b64 v3, v[96:97] offset:21120
ds_write_b64 v3, v[26:27] offset:21128
ds_write_b64 v3, v[24:25] offset:22176
ds_write_b64 v3, v[90:91] offset:22184
ds_write_b64 v3, v[88:89] offset:23232
ds_write_b64 v3, v[58:59] offset:23240
ds_write_b64 v3, v[56:57] offset:24288
ds_write_b64 v3, v[122:123] offset:24296
ds_write_b64 v3, v[120:121] offset:25344
ds_write_b64 v3, v[22:23] offset:25352
ds_write_b64 v3, v[20:21] offset:26400
ds_write_b64 v3, v[86:87] offset:26408
ds_write_b64 v3, v[84:85] offset:27456
ds_write_b64 v3, v[54:55] offset:27464
ds_write_b64 v3, v[52:53] offset:28512
ds_write_b64 v3, v[118:119] offset:28520
ds_write_b64 v3, v[116:117] offset:29568
ds_write_b64 v3, v[38:39] offset:29576
ds_write_b64 v3, v[36:37] offset:30624
ds_write_b64 v3, v[102:103] offset:30632
ds_write_b64 v3, v[100:101] offset:31680
ds_write_b64 v3, v[70:71] offset:31688
ds_write_b64 v3, v[68:69] offset:32736
ds_write_b64 v3, v[134:135] offset:32744
s_waitcnt lgkmcnt(0)
ds_read_b128 v[16:19], v4
ds_read_b128 v[20:23], v4 offset:32
ds_read_b128 v[24:27], v4 offset:64
ds_read_b128 v[28:31], v4 offset:96
ds_read_b128 v[32:35], v4 offset:128
ds_read_b128 v[36:39], v4 offset:160
ds_read_b128 v[40:43], v4 offset:192
ds_read_b128 v[44:47], v4 offset:224
ds_read_b128 v[48:51], v4 offset:256
ds_read_b128 v[52:55], v4 offset:288
ds_read_b128 v[56:59], v4 offset:320
ds_read_b128 v[60:63], v4 offset:352
s_waitcnt lgkmcnt(4)
ds_read_b128 v[64:67], v4 offset:384
ds_read_b128 v[68:71], v4 offset:416
ds_read_b128 v[72:75], v4 offset:448
ds_read_b128 v[76:79], v4 offset:480
ds_read_b128 v[80:83], v4 offset:512
ds_read_b128 v[84:87], v4 offset:544
ds_read_b128 v[88:91], v4 offset:576
ds_read_b128 v[92:95], v4 offset:608
ds_read_b128 v[96:99], v4 offset:640
ds_read_b128 v[100:103], v4 offset:672
ds_read_b128 v[104:107], v4 offset:704
ds_read_b128 v[108:111], v4 offset:736
s_waitcnt lgkmcnt(4)
ds_read_b128 v[112:115], v4 offset:768
ds_read_b128 v[116:119], v4 offset:800
ds_read_b128 v[120:123], v4 offset:832
ds_read_b128 v[124:127], v4 offset:864
ds_read_b128 v[128:131], v4 offset:896
ds_read_b128 v[132:135], v4 offset:928
ds_read_b128 v[136:139], v4 offset:960
ds_read_b128 v[140:143], v4 offset:992
s_waitcnt lgkmcnt(0)
v_pk_add_f32 v[144:145], v[16:17], v[80:81] neg_lo:[0,1] neg_hi:[0,1]
v_pk_add_f32 v[146:147], v[18:19], v[82:83] neg_lo:[0,1] neg_hi:[0,1]
v_pk_add_f32 v[16:17], v[16:17], v[80:81]
v_pk_add_f32 v[18:19], v[18:19], v[82:83]
v_pk_add_f32 v[80:81], v[20:21], v[84:85] neg_lo:[0,1] neg_hi:[0,1]
v_pk_add_f32 v[82:83], v[22:23], v[86:87] neg_lo:[0,1] neg_hi:[0,1]
v_pk_add_f32 v[20:21], v[20:21], v[84:85]
v_pk_add_f32 v[22:23], v[22:23], v[86:87]
v_pk_mul_f32 v[84:85], v[80:81], s[30:31] op_sel_hi:[1,0]
v_pk_mul_f32 v[86:87], v[80:81], s[36:37] op_sel_hi:[1,0] neg_lo:[0,1] neg_hi:[0,1]
v_pk_fma_f32 v[84:85], v[82:83], s[36:37], v[84:85] op_sel_hi:[1,0,1]
v_pk_fma_f32 v[86:87], v[82:83], s[30:31], v[86:87] op_sel_hi:[1,0,1]
v_pk_add_f32 v[80:81], v[24:25], v[88:89] neg_lo:[0,1] neg_hi:[0,1]
v_pk_add_f32 v[82:83], v[26:27], v[90:91] neg_lo:[0,1] neg_hi:[0,1]
v_pk_add_f32 v[24:25], v[24:25], v[88:89]
v_pk_add_f32 v[26:27], v[26:27], v[90:91]
v_pk_mul_f32 v[88:89], v[80:81], s[30:31] op_sel:[0,1]
v_pk_mul_f32 v[90:91], v[80:81], s[34:35] op_sel:[0,1] neg_lo:[0,1] neg_hi:[0,1]
v_pk_fma_f32 v[88:89], v[82:83], s[34:35], v[88:89] op_sel:[0,1,0]
v_pk_fma_f32 v[90:91], v[82:83], s[30:31], v[90:91] op_sel:[0,1,0]
v_pk_add_f32 v[80:81], v[28:29], v[92:93] neg_lo:[0,1] neg_hi:[0,1]
v_pk_add_f32 v[82:83], v[30:31], v[94:95] neg_lo:[0,1] neg_hi:[0,1]
v_pk_add_f32 v[28:29], v[28:29], v[92:93]
v_pk_add_f32 v[30:31], v[30:31], v[94:95]
v_pk_mul_f32 v[92:93], v[80:81], s[32:33] op_sel_hi:[1,0]
v_pk_mul_f32 v[94:95], v[80:81], s[34:35] op_sel_hi:[1,0] neg_lo:[0,1] neg_hi:[0,1]
v_pk_fma_f32 v[92:93], v[82:83], s[34:35], v[92:93] op_sel_hi:[1,0,1]
v_pk_fma_f32 v[94:95], v[82:83], s[32:33], v[94:95] op_sel_hi:[1,0,1]
v_pk_add_f32 v[80:81], v[32:33], v[96:97] neg_lo:[0,1] neg_hi:[0,1]
v_pk_add_f32 v[82:83], v[34:35], v[98:99] neg_lo:[0,1] neg_hi:[0,1]
v_pk_add_f32 v[32:33], v[32:33], v[96:97]
v_pk_add_f32 v[34:35], v[34:35], v[98:99]
v_pk_mul_f32 v[96:97], v[80:81], s[32:33] op_sel:[0,1]
v_pk_mul_f32 v[98:99], v[80:81], s[32:33] op_sel:[0,1] neg_lo:[0,1] neg_hi:[0,1]
v_pk_fma_f32 v[96:97], v[82:83], s[32:33], v[96:97] op_sel:[0,1,0]
v_pk_fma_f32 v[98:99], v[82:83], s[32:33], v[98:99] op_sel:[0,1,0]
v_pk_add_f32 v[80:81], v[36:37], v[100:101] neg_lo:[0,1] neg_hi:[0,1]
v_pk_add_f32 v[82:83], v[38:39], v[102:103] neg_lo:[0,1] neg_hi:[0,1]
v_pk_add_f32 v[36:37], v[36:37], v[100:101]
v_pk_add_f32 v[38:39], v[38:39], v[102:103]
v_pk_mul_f32 v[100:101], v[80:81], s[34:35] op_sel_hi:[1,0]
v_pk_mul_f32 v[102:103], v[80:81], s[32:33] op_sel_hi:[1,0] neg_lo:[0,1] neg_hi:[0,1]
v_pk_fma_f32 v[100:101], v[82:83], s[32:33], v[100:101] op_sel_hi:[1,0,1]
v_pk_fma_f32 v[102:103], v[82:83], s[34:35], v[102:103] op_sel_hi:[1,0,1]
v_pk_add_f32 v[80:81], v[40:41], v[104:105] neg_lo:[0,1] neg_hi:[0,1]
v_pk_add_f32 v[82:83], v[42:43], v[106:107] neg_lo:[0,1] neg_hi:[0,1]
v_pk_add_f32 v[40:41], v[40:41], v[104:105]
v_pk_add_f32 v[42:43], v[42:43], v[106:107]
v_pk_mul_f32 v[104:105], v[80:81], s[34:35] op_sel:[0,1]
v_pk_mul_f32 v[106:107], v[80:81], s[30:31] op_sel:[0,1] neg_lo:[0,1] neg_hi:[0,1]
v_pk_fma_f32 v[104:105], v[82:83], s[30:31], v[104:105] op_sel:[0,1,0]
v_pk_fma_f32 v[106:107], v[82:83], s[34:35], v[106:107] op_sel:[0,1,0]
v_pk_add_f32 v[80:81], v[44:45], v[108:109] neg_lo:[0,1] neg_hi:[0,1]
v_pk_add_f32 v[82:83], v[46:47], v[110:111] neg_lo:[0,1] neg_hi:[0,1]
v_pk_add_f32 v[44:45], v[44:45], v[108:109]
v_pk_add_f32 v[46:47], v[46:47], v[110:111]
v_pk_mul_f32 v[108:109], v[80:81], s[36:37] op_sel_hi:[1,0]
v_pk_mul_f32 v[110:111], v[80:81], s[30:31] op_sel_hi:[1,0] neg_lo:[0,1] neg_hi:[0,1]
v_pk_fma_f32 v[108:109], v[82:83], s[30:31], v[108:109] op_sel_hi:[1,0,1]
v_pk_fma_f32 v[110:111], v[82:83], s[36:37], v[110:111] op_sel_hi:[1,0,1]
v_pk_add_f32 v[80:81], v[50:51], v[114:115] neg_lo:[0,1] neg_hi:[0,1]
v_pk_add_f32 v[82:83], v[112:113], v[48:49] neg_lo:[0,1] neg_hi:[0,1]
v_pk_add_f32 v[48:49], v[48:49], v[112:113]
v_pk_add_f32 v[50:51], v[50:51], v[114:115]
v_pk_add_f32 v[112:113], v[52:53], v[116:117] neg_lo:[0,1] neg_hi:[0,1]
v_pk_add_f32 v[114:115], v[54:55], v[118:119] neg_lo:[0,1] neg_hi:[0,1]
v_pk_add_f32 v[52:53], v[52:53], v[116:117]
v_pk_add_f32 v[54:55], v[54:55], v[118:119]
v_pk_mul_f32 v[116:117], v[112:113], s[36:37] op_sel_hi:[1,0] neg_lo:[0,1] neg_hi:[0,1]
v_pk_mul_f32 v[118:119], v[112:113], s[30:31] op_sel_hi:[1,0] neg_lo:[0,1] neg_hi:[0,1]
v_pk_fma_f32 v[116:117], v[114:115], s[30:31], v[116:117] op_sel_hi:[1,0,1]
v_pk_fma_f32 v[118:119], v[114:115], s[36:37], v[118:119] op_sel_hi:[1,0,1] neg_lo:[0,1,0] neg_hi:[0,1,0]
v_pk_add_f32 v[112:113], v[56:57], v[120:121] neg_lo:[0,1] neg_hi:[0,1]
v_pk_add_f32 v[114:115], v[58:59], v[122:123] neg_lo:[0,1] neg_hi:[0,1]
v_pk_add_f32 v[56:57], v[56:57], v[120:121]
v_pk_add_f32 v[58:59], v[58:59], v[122:123]
v_pk_mul_f32 v[120:121], v[112:113], s[34:35] op_sel:[0,1] neg_lo:[0,1] neg_hi:[0,1]
v_pk_mul_f32 v[122:123], v[112:113], s[30:31] op_sel:[0,1] neg_lo:[0,1] neg_hi:[0,1]
v_pk_fma_f32 v[120:121], v[114:115], s[30:31], v[120:121] op_sel:[0,1,0]
v_pk_fma_f32 v[122:123], v[114:115], s[34:35], v[122:123] op_sel:[0,1,0] neg_lo:[0,1,0] neg_hi:[0,1,0]
v_pk_add_f32 v[112:113], v[60:61], v[124:125] neg_lo:[0,1] neg_hi:[0,1]
v_pk_add_f32 v[114:115], v[62:63], v[126:127] neg_lo:[0,1] neg_hi:[0,1]
v_pk_add_f32 v[60:61], v[60:61], v[124:125]
v_pk_add_f32 v[62:63], v[62:63], v[126:127]
v_pk_mul_f32 v[124:125], v[112:113], s[34:35] op_sel_hi:[1,0] neg_lo:[0,1] neg_hi:[0,1]
v_pk_mul_f32 v[126:127], v[112:113], s[32:33] op_sel_hi:[1,0] neg_lo:[0,1] neg_hi:[0,1]
v_pk_fma_f32 v[124:125], v[114:115], s[32:33], v[124:125] op_sel_hi:[1,0,1]
v_pk_fma_f32 v[126:127], v[114:115], s[34:35], v[126:127] op_sel_hi:[1,0,1] neg_lo:[0,1,0] neg_hi:[0,1,0]
v_pk_add_f32 v[112:113], v[64:65], v[128:129] neg_lo:[0,1] neg_hi:[0,1]
v_pk_add_f32 v[114:115], v[66:67], v[130:131] neg_lo:[0,1] neg_hi:[0,1]
v_pk_add_f32 v[64:65], v[64:65], v[128:129]
v_pk_add_f32 v[66:67], v[66:67], v[130:131]
v_pk_mul_f32 v[128:129], v[112:113], s[32:33] op_sel:[0,1] neg_lo:[0,1] neg_hi:[0,1]
v_pk_mul_f32 v[130:131], v[112:113], s[32:33] op_sel:[0,1] neg_lo:[0,1] neg_hi:[0,1]
v_pk_fma_f32 v[128:129], v[114:115], s[32:33], v[128:129] op_sel:[0,1,0]
v_pk_fma_f32 v[130:131], v[114:115], s[32:33], v[130:131] op_sel:[0,1,0] neg_lo:[0,1,0] neg_hi:[0,1,0]
v_pk_add_f32 v[112:113], v[68:69], v[132:133] neg_lo:[0,1] neg_hi:[0,1]
v_pk_add_f32 v[114:115], v[70:71], v[134:135] neg_lo:[0,1] neg_hi:[0,1]
v_pk_add_f32 v[68:69], v[68:69], v[132:133]
v_pk_add_f32 v[70:71], v[70:71], v[134:135]
v_pk_mul_f32 v[132:133], v[112:113], s[32:33] op_sel_hi:[1,0] neg_lo:[0,1] neg_hi:[0,1]
v_pk_mul_f32 v[134:135], v[112:113], s[34:35] op_sel_hi:[1,0] neg_lo:[0,1] neg_hi:[0,1]
v_pk_fma_f32 v[132:133], v[114:115], s[34:35], v[132:133] op_sel_hi:[1,0,1]
v_pk_fma_f32 v[134:135], v[114:115], s[32:33], v[134:135] op_sel_hi:[1,0,1] neg_lo:[0,1,0] neg_hi:[0,1,0]
v_pk_add_f32 v[112:113], v[72:73], v[136:137] neg_lo:[0,1] neg_hi:[0,1]
v_pk_add_f32 v[114:115], v[74:75], v[138:139] neg_lo:[0,1] neg_hi:[0,1]
v_pk_add_f32 v[72:73], v[72:73], v[136:137]
v_pk_add_f32 v[74:75], v[74:75], v[138:139]
v_pk_mul_f32 v[136:137], v[112:113], s[30:31] op_sel:[0,1] neg_lo:[0,1] neg_hi:[0,1]
v_pk_mul_f32 v[138:139], v[112:113], s[34:35] op_sel:[0,1] neg_lo:[0,1] neg_hi:[0,1]
v_pk_fma_f32 v[136:137], v[114:115], s[34:35], v[136:137] op_sel:[0,1,0]
v_pk_fma_f32 v[138:139], v[114:115], s[30:31], v[138:139] op_sel:[0,1,0] neg_lo:[0,1,0] neg_hi:[0,1,0]
v_pk_add_f32 v[112:113], v[76:77], v[140:141] neg_lo:[0,1] neg_hi:[0,1]
v_pk_add_f32 v[114:115], v[78:79], v[142:143] neg_lo:[0,1] neg_hi:[0,1]
v_pk_add_f32 v[76:77], v[76:77], v[140:141]
v_pk_add_f32 v[78:79], v[78:79], v[142:143]
v_pk_mul_f32 v[140:141], v[112:113], s[30:31] op_sel_hi:[1,0] neg_lo:[0,1] neg_hi:[0,1]
v_pk_mul_f32 v[142:143], v[112:113], s[36:37] op_sel_hi:[1,0] neg_lo:[0,1] neg_hi:[0,1]
v_pk_fma_f32 v[140:141], v[114:115], s[36:37], v[140:141] op_sel_hi:[1,0,1]
v_pk_fma_f32 v[142:143], v[114:115], s[30:31], v[142:143] op_sel_hi:[1,0,1] neg_lo:[0,1,0] neg_hi:[0,1,0]
v_pk_add_f32 v[112:113], v[16:17], v[48:49] neg_lo:[0,1] neg_hi:[0,1]
v_pk_add_f32 v[114:115], v[18:19], v[50:51] neg_lo:[0,1] neg_hi:[0,1]
v_pk_add_f32 v[16:17], v[16:17], v[48:49]
v_pk_add_f32 v[18:19], v[18:19], v[50:51]
v_pk_add_f32 v[48:49], v[20:21], v[52:53] neg_lo:[0,1] neg_hi:[0,1]
v_pk_add_f32 v[50:51], v[22:23], v[54:55] neg_lo:[0,1] neg_hi:[0,1]
v_pk_add_f32 v[20:21], v[20:21], v[52:53]
v_pk_add_f32 v[22:23], v[22:23], v[54:55]
v_pk_mul_f32 v[52:53], v[48:49], s[30:31] op_sel:[0,1]
v_pk_mul_f32 v[54:55], v[48:49], s[34:35] op_sel:[0,1] neg_lo:[0,1] neg_hi:[0,1]
v_pk_fma_f32 v[52:53], v[50:51], s[34:35], v[52:53] op_sel:[0,1,0]
v_pk_fma_f32 v[54:55], v[50:51], s[30:31], v[54:55] op_sel:[0,1,0]
v_pk_add_f32 v[48:49], v[24:25], v[56:57] neg_lo:[0,1] neg_hi:[0,1]
v_pk_add_f32 v[50:51], v[26:27], v[58:59] neg_lo:[0,1] neg_hi:[0,1]
v_pk_add_f32 v[24:25], v[24:25], v[56:57]
v_pk_add_f32 v[26:27], v[26:27], v[58:59]
v_pk_mul_f32 v[56:57], v[48:49], s[32:33] op_sel:[0,1]
v_pk_mul_f32 v[58:59], v[48:49], s[32:33] op_sel:[0,1] neg_lo:[0,1] neg_hi:[0,1]
v_pk_fma_f32 v[56:57], v[50:51], s[32:33], v[56:57] op_sel:[0,1,0]
v_pk_fma_f32 v[58:59], v[50:51], s[32:33], v[58:59] op_sel:[0,1,0]
v_pk_add_f32 v[48:49], v[28:29], v[60:61] neg_lo:[0,1] neg_hi:[0,1]
v_pk_add_f32 v[50:51], v[30:31], v[62:63] neg_lo:[0,1] neg_hi:[0,1]
v_pk_add_f32 v[28:29], v[28:29], v[60:61]
v_pk_add_f32 v[30:31], v[30:31], v[62:63]
v_pk_mul_f32 v[60:61], v[48:49], s[34:35] op_sel:[0,1]
v_pk_mul_f32 v[62:63], v[48:49], s[30:31] op_sel:[0,1] neg_lo:[0,1] neg_hi:[0,1]
v_pk_fma_f32 v[60:61], v[50:51], s[30:31], v[60:61] op_sel:[0,1,0]
v_pk_fma_f32 v[62:63], v[50:51], s[34:35], v[62:63] op_sel:[0,1,0]
v_pk_add_f32 v[48:49], v[34:35], v[66:67] neg_lo:[0,1] neg_hi:[0,1]
v_pk_add_f32 v[50:51], v[64:65], v[32:33] neg_lo:[0,1] neg_hi:[0,1]
v_pk_add_f32 v[32:33], v[32:33], v[64:65]
v_pk_add_f32 v[34:35], v[34:35], v[66:67]
v_pk_add_f32 v[64:65], v[36:37], v[68:69] neg_lo:[0,1] neg_hi:[0,1]
v_pk_add_f32 v[66:67], v[38:39], v[70:71] neg_lo:[0,1] neg_hi:[0,1]
v_pk_add_f32 v[36:37], v[36:37], v[68:69]
v_pk_add_f32 v[38:39], v[38:39], v[70:71]
v_pk_mul_f32 v[68:69], v[64:65], s[34:35] op_sel:[0,1] neg_lo:[0,1] neg_hi:[0,1]
v_pk_mul_f32 v[70:71], v[64:65], s[30:31] op_sel:[0,1] neg_lo:[0,1] neg_hi:[0,1]
v_pk_fma_f32 v[68:69], v[66:67], s[30:31], v[68:69] op_sel:[0,1,0]
v_pk_fma_f32 v[70:71], v[66:67], s[34:35], v[70:71] op_sel:[0,1,0] neg_lo:[0,1,0] neg_hi:[0,1,0]
v_pk_add_f32 v[64:65], v[40:41], v[72:73] neg_lo:[0,1] neg_hi:[0,1]
v_pk_add_f32 v[66:67], v[42:43], v[74:75] neg_lo:[0,1] neg_hi:[0,1]
v_pk_add_f32 v[40:41], v[40:41], v[72:73]
v_pk_add_f32 v[42:43], v[42:43], v[74:75]
v_pk_mul_f32 v[72:73], v[64:65], s[32:33] op_sel:[0,1] neg_lo:[0,1] neg_hi:[0,1]
v_pk_mul_f32 v[74:75], v[64:65], s[32:33] op_sel:[0,1] neg_lo:[0,1] neg_hi:[0,1]
v_pk_fma_f32 v[72:73], v[66:67], s[32:33], v[72:73] op_sel:[0,1,0]
v_pk_fma_f32 v[74:75], v[66:67], s[32:33], v[74:75] op_sel:[0,1,0] neg_lo:[0,1,0] neg_hi:[0,1,0]
v_pk_add_f32 v[64:65], v[44:45], v[76:77] neg_lo:[0,1] neg_hi:[0,1]
v_pk_add_f32 v[66:67], v[46:47], v[78:79] neg_lo:[0,1] neg_hi:[0,1]
v_pk_add_f32 v[44:45], v[44:45], v[76:77]
v_pk_add_f32 v[46:47], v[46:47], v[78:79]
v_pk_mul_f32 v[76:77], v[64:65], s[30:31] op_sel:[0,1] neg_lo:[0,1] neg_hi:[0,1]
v_pk_mul_f32 v[78:79], v[64:65], s[34:35] op_sel:[0,1] neg_lo:[0,1] neg_hi:[0,1]
v_pk_fma_f32 v[76:77], v[66:67], s[34:35], v[76:77] op_sel:[0,1,0]
v_pk_fma_f32 v[78:79], v[66:67], s[30:31], v[78:79] op_sel:[0,1,0] neg_lo:[0,1,0] neg_hi:[0,1,0]
v_pk_add_f32 v[64:65], v[144:145], v[80:81] neg_lo:[0,1] neg_hi:[0,1]
v_pk_add_f32 v[66:67], v[146:147], v[82:83] neg_lo:[0,1] neg_hi:[0,1]
v_pk_add_f32 v[144:145], v[144:145], v[80:81]
v_pk_add_f32 v[146:147], v[146:147], v[82:83]
v_pk_add_f32 v[80:81], v[84:85], v[116:117] neg_lo:[0,1] neg_hi:[0,1]
v_pk_add_f32 v[82:83], v[86:87], v[118:119] neg_lo:[0,1] neg_hi:[0,1]
v_pk_add_f32 v[84:85], v[84:85], v[116:117]
v_pk_add_f32 v[86:87], v[86:87], v[118:119]
v_pk_mul_f32 v[116:117], v[80:81], s[30:31] op_sel:[0,1]
v_pk_mul_f32 v[118:119], v[80:81], s[34:35] op_sel:[0,1] neg_lo:[0,1] neg_hi:[0,1]
v_pk_fma_f32 v[116:117], v[82:83], s[34:35], v[116:117] op_sel:[0,1,0]
v_pk_fma_f32 v[118:119], v[82:83], s[30:31], v[118:119] op_sel:[0,1,0]
v_pk_add_f32 v[80:81], v[88:89], v[120:121] neg_lo:[0,1] neg_hi:[0,1]
v_pk_add_f32 v[82:83], v[90:91], v[122:123] neg_lo:[0,1] neg_hi:[0,1]
v_pk_add_f32 v[88:89], v[88:89], v[120:121]
v_pk_add_f32 v[90:91], v[90:91], v[122:123]
v_pk_mul_f32 v[120:121], v[80:81], s[32:33] op_sel:[0,1]
v_pk_mul_f32 v[122:123], v[80:81], s[32:33] op_sel:[0,1] neg_lo:[0,1] neg_hi:[0,1]
v_pk_fma_f32 v[120:121], v[82:83], s[32:33], v[120:121] op_sel:[0,1,0]
v_pk_fma_f32 v[122:123], v[82:83], s[32:33], v[122:123] op_sel:[0,1,0]
v_pk_add_f32 v[80:81], v[92:93], v[124:125] neg_lo:[0,1] neg_hi:[0,1]
v_pk_add_f32 v[82:83], v[94:95], v[126:127] neg_lo:[0,1] neg_hi:[0,1]
v_pk_add_f32 v[92:93], v[92:93], v[124:125]
v_pk_add_f32 v[94:95], v[94:95], v[126:127]
v_pk_mul_f32 v[124:125], v[80:81], s[34:35] op_sel:[0,1]
v_pk_mul_f32 v[126:127], v[80:81], s[30:31] op_sel:[0,1] neg_lo:[0,1] neg_hi:[0,1]
v_pk_fma_f32 v[124:125], v[82:83], s[30:31], v[124:125] op_sel:[0,1,0]
v_pk_fma_f32 v[126:127], v[82:83], s[34:35], v[126:127] op_sel:[0,1,0]
v_pk_add_f32 v[80:81], v[98:99], v[130:131] neg_lo:[0,1] neg_hi:[0,1]
v_pk_add_f32 v[82:83], v[128:129], v[96:97] neg_lo:[0,1] neg_hi:[0,1]
v_pk_add_f32 v[96:97], v[96:97], v[128:129]
v_pk_add_f32 v[98:99], v[98:99], v[130:131]
v_pk_add_f32 v[128:129], v[100:101], v[132:133] neg_lo:[0,1] neg_hi:[0,1]
v_pk_add_f32 v[130:131], v[102:103], v[134:135] neg_lo:[0,1] neg_hi:[0,1]
v_pk_add_f32 v[100:101], v[100:101], v[132:133]
v_pk_add_f32 v[102:103], v[102:103], v[134:135]
v_pk_mul_f32 v[132:133], v[128:129], s[34:35] op_sel:[0,1] neg_lo:[0,1] neg_hi:[0,1]
v_pk_mul_f32 v[134:135], v[128:129], s[30:31] op_sel:[0,1] neg_lo:[0,1] neg_hi:[0,1]
v_pk_fma_f32 v[132:133], v[130:131], s[30:31], v[132:133] op_sel:[0,1,0]
v_pk_fma_f32 v[134:135], v[130:131], s[34:35], v[134:135] op_sel:[0,1,0] neg_lo:[0,1,0] neg_hi:[0,1,0]
v_pk_add_f32 v[128:129], v[104:105], v[136:137] neg_lo:[0,1] neg_hi:[0,1]
v_pk_add_f32 v[130:131], v[106:107], v[138:139] neg_lo:[0,1] neg_hi:[0,1]
v_pk_add_f32 v[104:105], v[104:105], v[136:137]
v_pk_add_f32 v[106:107], v[106:107], v[138:139]
v_pk_mul_f32 v[136:137], v[128:129], s[32:33] op_sel:[0,1] neg_lo:[0,1] neg_hi:[0,1]
v_pk_mul_f32 v[138:139], v[128:129], s[32:33] op_sel:[0,1] neg_lo:[0,1] neg_hi:[0,1]
v_pk_fma_f32 v[136:137], v[130:131], s[32:33], v[136:137] op_sel:[0,1,0]
v_pk_fma_f32 v[138:139], v[130:131], s[32:33], v[138:139] op_sel:[0,1,0] neg_lo:[0,1,0] neg_hi:[0,1,0]
v_pk_add_f32 v[128:129], v[108:109], v[140:141] neg_lo:[0,1] neg_hi:[0,1]
v_pk_add_f32 v[130:131], v[110:111], v[142:143] neg_lo:[0,1] neg_hi:[0,1]
v_pk_add_f32 v[108:109], v[108:109], v[140:141]
v_pk_add_f32 v[110:111], v[110:111], v[142:143]
v_pk_mul_f32 v[140:141], v[128:129], s[30:31] op_sel:[0,1] neg_lo:[0,1] neg_hi:[0,1]
v_pk_mul_f32 v[142:143], v[128:129], s[34:35] op_sel:[0,1] neg_lo:[0,1] neg_hi:[0,1]
v_pk_fma_f32 v[140:141], v[130:131], s[34:35], v[140:141] op_sel:[0,1,0]
v_pk_fma_f32 v[142:143], v[130:131], s[30:31], v[142:143] op_sel:[0,1,0] neg_lo:[0,1,0] neg_hi:[0,1,0]
v_pk_add_f32 v[128:129], v[16:17], v[32:33] neg_lo:[0,1] neg_hi:[0,1]
v_pk_add_f32 v[130:131], v[18:19], v[34:35] neg_lo:[0,1] neg_hi:[0,1]
v_pk_add_f32 v[16:17], v[16:17], v[32:33]
v_pk_add_f32 v[18:19], v[18:19], v[34:35]
v_pk_add_f32 v[32:33], v[20:21], v[36:37] neg_lo:[0,1] neg_hi:[0,1]
v_pk_add_f32 v[34:35], v[22:23], v[38:39] neg_lo:[0,1] neg_hi:[0,1]
v_pk_add_f32 v[20:21], v[20:21], v[36:37]
v_pk_add_f32 v[22:23], v[22:23], v[38:39]
v_pk_mul_f32 v[36:37], v[32:33], s[32:33] op_sel:[0,1]
v_pk_mul_f32 v[38:39], v[32:33], s[32:33] op_sel:[0,1] neg_lo:[0,1] neg_hi:[0,1]
v_pk_fma_f32 v[36:37], v[34:35], s[32:33], v[36:37] op_sel:[0,1,0]
v_pk_fma_f32 v[38:39], v[34:35], s[32:33], v[38:39] op_sel:[0,1,0]
v_pk_add_f32 v[32:33], v[26:27], v[42:43] neg_lo:[0,1] neg_hi:[0,1]
v_pk_add_f32 v[34:35], v[40:41], v[24:25] neg_lo:[0,1] neg_hi:[0,1]
v_pk_add_f32 v[24:25], v[24:25], v[40:41]
v_pk_add_f32 v[26:27], v[26:27], v[42:43]
v_pk_add_f32 v[40:41], v[28:29], v[44:45] neg_lo:[0,1] neg_hi:[0,1]
v_pk_add_f32 v[42:43], v[30:31], v[46:47] neg_lo:[0,1] neg_hi:[0,1]
v_pk_add_f32 v[28:29], v[28:29], v[44:45]
v_pk_add_f32 v[30:31], v[30:31], v[46:47]
v_pk_mul_f32 v[44:45], v[40:41], s[32:33] op_sel:[0,1] neg_lo:[0,1] neg_hi:[0,1]
v_pk_mul_f32 v[46:47], v[40:41], s[32:33] op_sel:[0,1] neg_lo:[0,1] neg_hi:[0,1]
v_pk_fma_f32 v[44:45], v[42:43], s[32:33], v[44:45] op_sel:[0,1,0]
v_pk_fma_f32 v[46:47], v[42:43], s[32:33], v[46:47] op_sel:[0,1,0] neg_lo:[0,1,0] neg_hi:[0,1,0]
v_pk_add_f32 v[40:41], v[112:113], v[48:49] neg_lo:[0,1] neg_hi:[0,1]
v_pk_add_f32 v[42:43], v[114:115], v[50:51] neg_lo:[0,1] neg_hi:[0,1]
v_pk_add_f32 v[112:113], v[112:113], v[48:49]
v_pk_add_f32 v[114:115], v[114:115], v[50:51]
v_pk_add_f32 v[48:49], v[52:53], v[68:69] neg_lo:[0,1] neg_hi:[0,1]
v_pk_add_f32 v[50:51], v[54:55], v[70:71] neg_lo:[0,1] neg_hi:[0,1]
v_pk_add_f32 v[52:53], v[52:53], v[68:69]
v_pk_add_f32 v[54:55], v[54:55], v[70:71]
v_pk_mul_f32 v[68:69], v[48:49], s[32:33] op_sel:[0,1]
v_pk_mul_f32 v[70:71], v[48:49], s[32:33] op_sel:[0,1] neg_lo:[0,1] neg_hi:[0,1]
v_pk_fma_f32 v[68:69], v[50:51], s[32:33], v[68:69] op_sel:[0,1,0]
v_pk_fma_f32 v[70:71], v[50:51], s[32:33], v[70:71] op_sel:[0,1,0]
v_pk_add_f32 v[48:49], v[58:59], v[74:75] neg_lo:[0,1] neg_hi:[0,1]
v_pk_add_f32 v[50:51], v[72:73], v[56:57] neg_lo:[0,1] neg_hi:[0,1]
v_pk_add_f32 v[56:57], v[56:57], v[72:73]
v_pk_add_f32 v[58:59], v[58:59], v[74:75]
v_pk_add_f32 v[72:73], v[60:61], v[76:77] neg_lo:[0,1] neg_hi:[0,1]
v_pk_add_f32 v[74:75], v[62:63], v[78:79] neg_lo:[0,1] neg_hi:[0,1]
v_pk_add_f32 v[60:61], v[60:61], v[76:77]
v_pk_add_f32 v[62:63], v[62:63], v[78:79]
v_pk_mul_f32 v[76:77], v[72:73], s[32:33] op_sel:[0,1] neg_lo:[0,1] neg_hi:[0,1]
v_pk_mul_f32 v[78:79], v[72:73], s[32:33] op_sel:[0,1] neg_lo:[0,1] neg_hi:[0,1]
v_pk_fma_f32 v[76:77], v[74:75], s[32:33], v[76:77] op_sel:[0,1,0]
v_pk_fma_f32 v[78:79], v[74:75], s[32:33], v[78:79] op_sel:[0,1,0] neg_lo:[0,1,0] neg_hi:[0,1,0]
v_pk_add_f32 v[72:73], v[144:145], v[96:97] neg_lo:[0,1] neg_hi:[0,1]
v_pk_add_f32 v[74:75], v[146:147], v[98:99] neg_lo:[0,1] neg_hi:[0,1]
v_pk_add_f32 v[144:145], v[144:145], v[96:97]
v_pk_add_f32 v[146:147], v[146:147], v[98:99]
v_pk_add_f32 v[96:97], v[84:85], v[100:101] neg_lo:[0,1] neg_hi:[0,1]
v_pk_add_f32 v[98:99], v[86:87], v[102:103] neg_lo:[0,1] neg_hi:[0,1]
v_pk_add_f32 v[84:85], v[84:85], v[100:101]
v_pk_add_f32 v[86:87], v[86:87], v[102:103]
v_pk_mul_f32 v[100:101], v[96:97], s[32:33] op_sel:[0,1]
v_pk_mul_f32 v[102:103], v[96:97], s[32:33] op_sel:[0,1] neg_lo:[0,1] neg_hi:[0,1]
v_pk_fma_f32 v[100:101], v[98:99], s[32:33], v[100:101] op_sel:[0,1,0]
v_pk_fma_f32 v[102:103], v[98:99], s[32:33], v[102:103] op_sel:[0,1,0]
v_pk_add_f32 v[96:97], v[90:91], v[106:107] neg_lo:[0,1] neg_hi:[0,1]
v_pk_add_f32 v[98:99], v[104:105], v[88:89] neg_lo:[0,1] neg_hi:[0,1]
v_pk_add_f32 v[88:89], v[88:89], v[104:105]
v_pk_add_f32 v[90:91], v[90:91], v[106:107]
v_pk_add_f32 v[104:105], v[92:93], v[108:109] neg_lo:[0,1] neg_hi:[0,1]
v_pk_add_f32 v[106:107], v[94:95], v[110:111] neg_lo:[0,1] neg_hi:[0,1]
v_pk_add_f32 v[92:93], v[92:93], v[108:109]
v_pk_add_f32 v[94:95], v[94:95], v[110:111]
v_pk_mul_f32 v[108:109], v[104:105], s[32:33] op_sel:[0,1] neg_lo:[0,1] neg_hi:[0,1]
v_pk_mul_f32 v[110:111], v[104:105], s[32:33] op_sel:[0,1] neg_lo:[0,1] neg_hi:[0,1]
v_pk_fma_f32 v[108:109], v[106:107], s[32:33], v[108:109] op_sel:[0,1,0]
v_pk_fma_f32 v[110:111], v[106:107], s[32:33], v[110:111] op_sel:[0,1,0] neg_lo:[0,1,0] neg_hi:[0,1,0]
v_pk_add_f32 v[104:105], v[64:65], v[80:81] neg_lo:[0,1] neg_hi:[0,1]
v_pk_add_f32 v[106:107], v[66:67], v[82:83] neg_lo:[0,1] neg_hi:[0,1]
v_pk_add_f32 v[64:65], v[64:65], v[80:81]
v_pk_add_f32 v[66:67], v[66:67], v[82:83]
v_pk_add_f32 v[80:81], v[116:117], v[132:133] neg_lo:[0,1] neg_hi:[0,1]
v_pk_add_f32 v[82:83], v[118:119], v[134:135] neg_lo:[0,1] neg_hi:[0,1]
v_pk_add_f32 v[116:117], v[116:117], v[132:133]
v_pk_add_f32 v[118:119], v[118:119], v[134:135]
v_pk_mul_f32 v[132:133], v[80:81], s[32:33] op_sel:[0,1]
v_pk_mul_f32 v[134:135], v[80:81], s[32:33] op_sel:[0,1] neg_lo:[0,1] neg_hi:[0,1]
v_pk_fma_f32 v[132:133], v[82:83], s[32:33], v[132:133] op_sel:[0,1,0]
v_pk_fma_f32 v[134:135], v[82:83], s[32:33], v[134:135] op_sel:[0,1,0]
v_pk_add_f32 v[80:81], v[122:123], v[138:139] neg_lo:[0,1] neg_hi:[0,1]
v_pk_add_f32 v[82:83], v[136:137], v[120:121] neg_lo:[0,1] neg_hi:[0,1]
v_pk_add_f32 v[120:121], v[120:121], v[136:137]
v_pk_add_f32 v[122:123], v[122:123], v[138:139]
v_pk_add_f32 v[136:137], v[124:125], v[140:141] neg_lo:[0,1] neg_hi:[0,1]
v_pk_add_f32 v[138:139], v[126:127], v[142:143] neg_lo:[0,1] neg_hi:[0,1]
v_pk_add_f32 v[124:125], v[124:125], v[140:141]
v_pk_add_f32 v[126:127], v[126:127], v[142:143]
v_pk_mul_f32 v[140:141], v[136:137], s[32:33] op_sel:[0,1] neg_lo:[0,1] neg_hi:[0,1]
v_pk_mul_f32 v[142:143], v[136:137], s[32:33] op_sel:[0,1] neg_lo:[0,1] neg_hi:[0,1]
v_pk_fma_f32 v[140:141], v[138:139], s[32:33], v[140:141] op_sel:[0,1,0]
v_pk_fma_f32 v[142:143], v[138:139], s[32:33], v[142:143] op_sel:[0,1,0] neg_lo:[0,1,0] neg_hi:[0,1,0]
v_pk_add_f32 v[136:137], v[16:17], v[24:25] neg_lo:[0,1] neg_hi:[0,1]
v_pk_add_f32 v[138:139], v[18:19], v[26:27] neg_lo:[0,1] neg_hi:[0,1]
v_pk_add_f32 v[16:17], v[16:17], v[24:25]
v_pk_add_f32 v[18:19], v[18:19], v[26:27]
v_pk_add_f32 v[24:25], v[22:23], v[30:31] neg_lo:[0,1] neg_hi:[0,1]
v_pk_add_f32 v[26:27], v[28:29], v[20:21] neg_lo:[0,1] neg_hi:[0,1]
v_pk_add_f32 v[20:21], v[20:21], v[28:29]
v_pk_add_f32 v[22:23], v[22:23], v[30:31]
v_pk_add_f32 v[28:29], v[128:129], v[32:33] neg_lo:[0,1] neg_hi:[0,1]
v_pk_add_f32 v[30:31], v[130:131], v[34:35] neg_lo:[0,1] neg_hi:[0,1]
v_pk_add_f32 v[128:129], v[128:129], v[32:33]
v_pk_add_f32 v[130:131], v[130:131], v[34:35]
v_pk_add_f32 v[32:33], v[38:39], v[46:47] neg_lo:[0,1] neg_hi:[0,1]
v_pk_add_f32 v[34:35], v[44:45], v[36:37] neg_lo:[0,1] neg_hi:[0,1]
v_pk_add_f32 v[36:37], v[36:37], v[44:45]
v_pk_add_f32 v[38:39], v[38:39], v[46:47]
v_pk_add_f32 v[44:45], v[112:113], v[56:57] neg_lo:[0,1] neg_hi:[0,1]
v_pk_add_f32 v[46:47], v[114:115], v[58:59] neg_lo:[0,1] neg_hi:[0,1]
v_pk_add_f32 v[112:113], v[112:113], v[56:57]
v_pk_add_f32 v[114:115], v[114:115], v[58:59]
v_pk_add_f32 v[56:57], v[54:55], v[62:63] neg_lo:[0,1] neg_hi:[0,1]
v_pk_add_f32 v[58:59], v[60:61], v[52:53] neg_lo:[0,1] neg_hi:[0,1]
v_pk_add_f32 v[52:53], v[52:53], v[60:61]
v_pk_add_f32 v[54:55], v[54:55], v[62:63]
v_pk_add_f32 v[60:61], v[40:41], v[48:49] neg_lo:[0,1] neg_hi:[0,1]
v_pk_add_f32 v[62:63], v[42:43], v[50:51] neg_lo:[0,1] neg_hi:[0,1]
v_pk_add_f32 v[40:41], v[40:41], v[48:49]
v_pk_add_f32 v[42:43], v[42:43], v[50:51]
v_pk_add_f32 v[48:49], v[70:71], v[78:79] neg_lo:[0,1] neg_hi:[0,1]
v_pk_add_f32 v[50:51], v[76:77], v[68:69] neg_lo:[0,1] neg_hi:[0,1]
v_pk_add_f32 v[68:69], v[68:69], v[76:77]
v_pk_add_f32 v[70:71], v[70:71], v[78:79]
v_pk_add_f32 v[76:77], v[144:145], v[88:89] neg_lo:[0,1] neg_hi:[0,1]
v_pk_add_f32 v[78:79], v[146:147], v[90:91] neg_lo:[0,1] neg_hi:[0,1]
v_pk_add_f32 v[144:145], v[144:145], v[88:89]
v_pk_add_f32 v[146:147], v[146:147], v[90:91]
v_pk_add_f32 v[88:89], v[86:87], v[94:95] neg_lo:[0,1] neg_hi:[0,1]
v_pk_add_f32 v[90:91], v[92:93], v[84:85] neg_lo:[0,1] neg_hi:[0,1]
v_pk_add_f32 v[84:85], v[84:85], v[92:93]
v_pk_add_f32 v[86:87], v[86:87], v[94:95]
v_pk_add_f32 v[92:93], v[72:73], v[96:97] neg_lo:[0,1] neg_hi:[0,1]
v_pk_add_f32 v[94:95], v[74:75], v[98:99] neg_lo:[0,1] neg_hi:[0,1]
v_pk_add_f32 v[72:73], v[72:73], v[96:97]
v_pk_add_f32 v[74:75], v[74:75], v[98:99]
v_pk_add_f32 v[96:97], v[102:103], v[110:111] neg_lo:[0,1] neg_hi:[0,1]
v_pk_add_f32 v[98:99], v[108:109], v[100:101] neg_lo:[0,1] neg_hi:[0,1]
v_pk_add_f32 v[100:101], v[100:101], v[108:109]
v_pk_add_f32 v[102:103], v[102:103], v[110:111]
v_pk_add_f32 v[108:109], v[64:65], v[120:121] neg_lo:[0,1] neg_hi:[0,1]
v_pk_add_f32 v[110:111], v[66:67], v[122:123] neg_lo:[0,1] neg_hi:[0,1]
v_pk_add_f32 v[64:65], v[64:65], v[120:121]
v_pk_add_f32 v[66:67], v[66:67], v[122:123]
v_pk_add_f32 v[120:121], v[118:119], v[126:127] neg_lo:[0,1] neg_hi:[0,1]
v_pk_add_f32 v[122:123], v[124:125], v[116:117] neg_lo:[0,1] neg_hi:[0,1]
v_pk_add_f32 v[116:117], v[116:117], v[124:125]
v_pk_add_f32 v[118:119], v[118:119], v[126:127]
v_pk_add_f32 v[124:125], v[104:105], v[80:81] neg_lo:[0,1] neg_hi:[0,1]
v_pk_add_f32 v[126:127], v[106:107], v[82:83] neg_lo:[0,1] neg_hi:[0,1]
v_pk_add_f32 v[104:105], v[104:105], v[80:81]
v_pk_add_f32 v[106:107], v[106:107], v[82:83]
v_pk_add_f32 v[80:81], v[134:135], v[142:143] neg_lo:[0,1] neg_hi:[0,1]
v_pk_add_f32 v[82:83], v[140:141], v[132:133] neg_lo:[0,1] neg_hi:[0,1]
v_pk_add_f32 v[132:133], v[132:133], v[140:141]
v_pk_add_f32 v[134:135], v[134:135], v[142:143]
v_pk_add_f32 v[140:141], v[16:17], v[20:21] neg_lo:[0,1] neg_hi:[0,1]
v_pk_add_f32 v[142:143], v[18:19], v[22:23] neg_lo:[0,1] neg_hi:[0,1]
v_pk_add_f32 v[16:17], v[16:17], v[20:21]
v_pk_add_f32 v[18:19], v[18:19], v[22:23]
v_pk_add_f32 v[20:21], v[136:137], v[24:25] neg_lo:[0,1] neg_hi:[0,1]
v_pk_add_f32 v[22:23], v[138:139], v[26:27] neg_lo:[0,1] neg_hi:[0,1]
v_pk_add_f32 v[136:137], v[136:137], v[24:25]
v_pk_add_f32 v[138:139], v[138:139], v[26:27]
v_pk_add_f32 v[24:25], v[128:129], v[36:37] neg_lo:[0,1] neg_hi:[0,1]
v_pk_add_f32 v[26:27], v[130:131], v[38:39] neg_lo:[0,1] neg_hi:[0,1]
v_pk_add_f32 v[128:129], v[128:129], v[36:37]
v_pk_add_f32 v[130:131], v[130:131], v[38:39]
v_pk_add_f32 v[36:37], v[28:29], v[32:33] neg_lo:[0,1] neg_hi:[0,1]
v_pk_add_f32 v[38:39], v[30:31], v[34:35] neg_lo:[0,1] neg_hi:[0,1]
v_pk_add_f32 v[28:29], v[28:29], v[32:33]
v_pk_add_f32 v[30:31], v[30:31], v[34:35]
v_pk_add_f32 v[32:33], v[112:113], v[52:53] neg_lo:[0,1] neg_hi:[0,1]
v_pk_add_f32 v[34:35], v[114:115], v[54:55] neg_lo:[0,1] neg_hi:[0,1]
v_pk_add_f32 v[112:113], v[112:113], v[52:53]
v_pk_add_f32 v[114:115], v[114:115], v[54:55]
v_pk_add_f32 v[52:53], v[44:45], v[56:57] neg_lo:[0,1] neg_hi:[0,1]
v_pk_add_f32 v[54:55], v[46:47], v[58:59] neg_lo:[0,1] neg_hi:[0,1]
v_pk_add_f32 v[44:45], v[44:45], v[56:57]
v_pk_add_f32 v[46:47], v[46:47], v[58:59]
v_pk_add_f32 v[56:57], v[40:41], v[68:69] neg_lo:[0,1] neg_hi:[0,1]
v_pk_add_f32 v[58:59], v[42:43], v[70:71] neg_lo:[0,1] neg_hi:[0,1]
v_pk_add_f32 v[40:41], v[40:41], v[68:69]
v_pk_add_f32 v[42:43], v[42:43], v[70:71]
v_pk_add_f32 v[68:69], v[60:61], v[48:49] neg_lo:[0,1] neg_hi:[0,1]
v_pk_add_f32 v[70:71], v[62:63], v[50:51] neg_lo:[0,1] neg_hi:[0,1]
v_pk_add_f32 v[60:61], v[60:61], v[48:49]
v_pk_add_f32 v[62:63], v[62:63], v[50:51]
v_pk_add_f32 v[48:49], v[144:145], v[84:85] neg_lo:[0,1] neg_hi:[0,1]
v_pk_add_f32 v[50:51], v[146:147], v[86:87] neg_lo:[0,1] neg_hi:[0,1]
v_pk_add_f32 v[144:145], v[144:145], v[84:85]
v_pk_add_f32 v[146:147], v[146:147], v[86:87]
v_pk_add_f32 v[84:85], v[76:77], v[88:89] neg_lo:[0,1] neg_hi:[0,1]
v_pk_add_f32 v[86:87], v[78:79], v[90:91] neg_lo:[0,1] neg_hi:[0,1]
v_pk_add_f32 v[76:77], v[76:77], v[88:89]
v_pk_add_f32 v[78:79], v[78:79], v[90:91]
v_pk_add_f32 v[88:89], v[72:73], v[100:101] neg_lo:[0,1] neg_hi:[0,1]
v_pk_add_f32 v[90:91], v[74:75], v[102:103] neg_lo:[0,1] neg_hi:[0,1]
v_pk_add_f32 v[72:73], v[72:73], v[100:101]
v_pk_add_f32 v[74:75], v[74:75], v[102:103]
v_pk_add_f32 v[100:101], v[92:93], v[96:97] neg_lo:[0,1] neg_hi:[0,1]
v_pk_add_f32 v[102:103], v[94:95], v[98:99] neg_lo:[0,1] neg_hi:[0,1]
v_pk_add_f32 v[92:93], v[92:93], v[96:97]
v_pk_add_f32 v[94:95], v[94:95], v[98:99]
v_pk_add_f32 v[96:97], v[64:65], v[116:117] neg_lo:[0,1] neg_hi:[0,1]
v_pk_add_f32 v[98:99], v[66:67], v[118:119] neg_lo:[0,1] neg_hi:[0,1]
v_pk_add_f32 v[64:65], v[64:65], v[116:117]
v_pk_add_f32 v[66:67], v[66:67], v[118:119]
v_pk_add_f32 v[116:117], v[108:109], v[120:121] neg_lo:[0,1] neg_hi:[0,1]
v_pk_add_f32 v[118:119], v[110:111], v[122:123] neg_lo:[0,1] neg_hi:[0,1]
v_pk_add_f32 v[108:109], v[108:109], v[120:121]
v_pk_add_f32 v[110:111], v[110:111], v[122:123]
v_pk_add_f32 v[120:121], v[104:105], v[132:133] neg_lo:[0,1] neg_hi:[0,1]
v_pk_add_f32 v[122:123], v[106:107], v[134:135] neg_lo:[0,1] neg_hi:[0,1]
v_pk_add_f32 v[104:105], v[104:105], v[132:133]
v_pk_add_f32 v[106:107], v[106:107], v[134:135]
v_pk_add_f32 v[132:133], v[124:125], v[80:81] neg_lo:[0,1] neg_hi:[0,1]
v_pk_add_f32 v[134:135], v[126:127], v[82:83] neg_lo:[0,1] neg_hi:[0,1]
v_pk_add_f32 v[124:125], v[124:125], v[80:81]
v_pk_add_f32 v[126:127], v[126:127], v[82:83]
v_mul_f32 v151, 0xbc800000, v9
v_cos_f32 v150, v151
v_sin_f32 v151, v151
v_mul_f32 v149, 0xbd000000, v9
v_cos_f32 v148, v149
v_sin_f32 v149, v149
v_pk_mul_f32 v[80:81], v[144:145], v[150:151] op_sel_hi:[1,0]
v_pk_fma_f32 v[80:81], v[146:147], v[150:151], v[80:81] op_sel:[0,1,0] neg_lo:[1,0,0] neg_hi:[1,0,0]
v_pk_mul_f32 v[146:147], v[146:147], v[150:151] op_sel_hi:[1,0]
v_pk_fma_f32 v[146:147], v[144:145], v[150:151], v[146:147] op_sel:[0,1,0]
v_mul_f32 v151, 0xbd400000, v9
v_cos_f32 v150, v151
v_sin_f32 v151, v151
v_pk_mul_f32 v[144:145], v[112:113], v[148:149] op_sel_hi:[1,0]
v_pk_fma_f32 v[144:145], v[114:115], v[148:149], v[144:145] op_sel:[0,1,0] neg_lo:[1,0,0] neg_hi:[1,0,0]
v_pk_mul_f32 v[114:115], v[114:115], v[148:149] op_sel_hi:[1,0]
v_pk_fma_f32 v[114:115], v[112:113], v[148:149], v[114:115] op_sel:[0,1,0]
v_mul_f32 v149, 0xbd800000, v9
v_cos_f32 v148, v149
v_sin_f32 v149, v149
v_pk_mul_f32 v[112:113], v[64:65], v[150:151] op_sel_hi:[1,0]
v_pk_fma_f32 v[112:113], v[66:67], v[150:151], v[112:113] op_sel:[0,1,0] neg_lo:[1,0,0] neg_hi:[1,0,0]
v_pk_mul_f32 v[66:67], v[66:67], v[150:151] op_sel_hi:[1,0]
v_pk_fma_f32 v[66:67], v[64:65], v[150:151], v[66:67] op_sel:[0,1,0]
v_mul_f32 v151, 0xbda00000, v9
v_cos_f32 v150, v151
v_sin_f32 v151, v151
v_pk_mul_f32 v[64:65], v[128:129], v[148:149] op_sel_hi:[1,0]
v_pk_fma_f32 v[64:65], v[130:131], v[148:149], v[64:65] op_sel:[0,1,0] neg_lo:[1,0,0] neg_hi:[1,0,0]
v_pk_mul_f32 v[130:131], v[130:131], v[148:149] op_sel_hi:[1,0]
v_pk_fma_f32 v[130:131], v[128:129], v[148:149], v[130:131] op_sel:[0,1,0]
v_mul_f32 v149, 0xbdc00000, v9
v_cos_f32 v148, v149
v_sin_f32 v149, v149
v_pk_mul_f32 v[128:129], v[72:73], v[150:151] op_sel_hi:[1,0]
v_pk_fma_f32 v[128:129], v[74:75], v[150:151], v[128:129] op_sel:[0,1,0] neg_lo:[1,0,0] neg_hi:[1,0,0]
v_pk_mul_f32 v[74:75], v[74:75], v[150:151] op_sel_hi:[1,0]
v_pk_fma_f32 v[74:75], v[72:73], v[150:151], v[74:75] op_sel:[0,1,0]
v_mul_f32 v151, 0xbde00000, v9
v_cos_f32 v150, v151
v_sin_f32 v151, v151
v_pk_mul_f32 v[72:73], v[40:41], v[148:149] op_sel_hi:[1,0]
v_pk_fma_f32 v[72:73], v[42:43], v[148:149], v[72:73] op_sel:[0,1,0] neg_lo:[1,0,0] neg_hi:[1,0,0]
v_pk_mul_f32 v[42:43], v[42:43], v[148:149] op_sel_hi:[1,0]
v_pk_fma_f32 v[42:43], v[40:41], v[148:149], v[42:43] op_sel:[0,1,0]
v_mul_f32 v149, 0xbe000000, v9
v_cos_f32 v148, v149
v_sin_f32 v149, v149
v_pk_mul_f32 v[40:41], v[104:105], v[150:151] op_sel_hi:[1,0]
v_pk_fma_f32 v[40:41], v[106:107], v[150:151], v[40:41] op_sel:[0,1,0] neg_lo:[1,0,0] neg_hi:[1,0,0]
v_pk_mul_f32 v[106:107], v[106:107], v[150:151] op_sel_hi:[1,0]
v_pk_fma_f32 v[106:107], v[104:105], v[150:151], v[106:107] op_sel:[0,1,0]
v_mul_f32 v151, 0xbe100000, v9
v_cos_f32 v150, v151
v_sin_f32 v151, v151
v_pk_mul_f32 v[104:105], v[136:137], v[148:149] op_sel_hi:[1,0]
v_pk_fma_f32 v[104:105], v[138:139], v[148:149], v[104:105] op_sel:[0,1,0] neg_lo:[1,0,0] neg_hi:[1,0,0]
v_pk_mul_f32 v[138:139], v[138:139], v[148:149] op_sel_hi:[1,0]
v_pk_fma_f32 v[138:139], v[136:137], v[148:149], v[138:139] op_sel:[0,1,0]
v_mul_f32 v149, 0xbe200000, v9
v_cos_f32 v148, v149
v_sin_f32 v149, v149
v_pk_mul_f32 v[136:137], v[76:77], v[150:151] op_sel_hi:[1,0]
v_pk_fma_f32 v[136:137], v[78:79], v[150:151], v[136:137] op_sel:[0,1,0] neg_lo:[1,0,0] neg_hi:[1,0,0]
v_pk_mul_f32 v[78:79], v[78:79], v[150:151] op_sel_hi:[1,0]
v_pk_fma_f32 v[78:79], v[76:77], v[150:151], v[78:79] op_sel:[0,1,0]
v_mul_f32 v151, 0xbe300000, v9
v_cos_f32 v150, v151
v_sin_f32 v151, v151
v_pk_mul_f32 v[76:77], v[44:45], v[148:149] op_sel_hi:[1,0]
v_pk_fma_f32 v[76:77], v[46:47], v[148:149], v[76:77] op_sel:[0,1,0] neg_lo:[1,0,0] neg_hi:[1,0,0]
v_pk_mul_f32 v[46:47], v[46:47], v[148:149] op_sel_hi:[1,0]
v_pk_fma_f32 v[46:47], v[44:45], v[148:149], v[46:47] op_sel:[0,1,0]
v_mul_f32 v149, 0xbe400000, v9
v_cos_f32 v148, v149
v_sin_f32 v149, v149
v_pk_mul_f32 v[44:45], v[108:109], v[150:151] op_sel_hi:[1,0]
v_pk_fma_f32 v[44:45], v[110:111], v[150:151], v[44:45] op_sel:[0,1,0] neg_lo:[1,0,0] neg_hi:[1,0,0]
v_pk_mul_f32 v[110:111], v[110:111], v[150:151] op_sel_hi:[1,0]
v_pk_fma_f32 v[110:111], v[108:109], v[150:151], v[110:111] op_sel:[0,1,0]
v_mul_f32 v151, 0xbe500000, v9
v_cos_f32 v150, v151
v_sin_f32 v151, v151
v_pk_mul_f32 v[108:109], v[28:29], v[148:149] op_sel_hi:[1,0]
v_pk_fma_f32 v[108:109], v[30:31], v[148:149], v[108:109] op_sel:[0,1,0] neg_lo:[1,0,0] neg_hi:[1,0,0]
v_pk_mul_f32 v[30:31], v[30:31], v[148:149] op_sel_hi:[1,0]
v_pk_fma_f32 v[30:31], v[28:29], v[148:149], v[30:31] op_sel:[0,1,0]
v_mul_f32 v149, 0xbe600000, v9
v_cos_f32 v148, v149
v_sin_f32 v149, v149
v_pk_mul_f32 v[28:29], v[92:93], v[150:151] op_sel_hi:[1,0]
v_pk_fma_f32 v[28:29], v[94:95], v[150:151], v[28:29] op_sel:[0,1,0] neg_lo:[1,0,0] neg_hi:[1,0,0]
v_pk_mul_f32 v[94:95], v[94:95], v[150:151] op_sel_hi:[1,0]
v_pk_fma_f32 v[94:95], v[92:93], v[150:151], v[94:95] op_sel:[0,1,0]
v_mul_f32 v151, 0xbe700000, v9
v_cos_f32 v150, v151
v_sin_f32 v151, v151
v_pk_mul_f32 v[92:93], v[60:61], v[148:149] op_sel_hi:[1,0]
v_pk_fma_f32 v[92:93], v[62:63], v[148:149], v[92:93] op_sel:[0,1,0] neg_lo:[1,0,0] neg_hi:[1,0,0]
v_pk_mul_f32 v[62:63], v[62:63], v[148:149] op_sel_hi:[1,0]
v_pk_fma_f32 v[62:63], v[60:61], v[148:149], v[62:63] op_sel:[0,1,0]
v_mul_f32 v149, 0xbe800000, v9
v_cos_f32 v148, v149
v_sin_f32 v149, v149
v_pk_mul_f32 v[60:61], v[124:125], v[150:151] op_sel_hi:[1,0]
v_pk_fma_f32 v[60:61], v[126:127], v[150:151], v[60:61] op_sel:[0,1,0] neg_lo:[1,0,0] neg_hi:[1,0,0]
v_pk_mul_f32 v[126:127], v[126:127], v[150:151] op_sel_hi:[1,0]
v_pk_fma_f32 v[126:127], v[124:125], v[150:151], v[126:127] op_sel:[0,1,0]
v_mul_f32 v151, 0xbe880000, v9
v_cos_f32 v150, v151
v_sin_f32 v151, v151
v_pk_mul_f32 v[124:125], v[140:141], v[148:149] op_sel_hi:[1,0]
v_pk_fma_f32 v[124:125], v[142:143], v[148:149], v[124:125] op_sel:[0,1,0] neg_lo:[1,0,0] neg_hi:[1,0,0]
v_pk_mul_f32 v[142:143], v[142:143], v[148:149] op_sel_hi:[1,0]
v_pk_fma_f32 v[142:143], v[140:141], v[148:149], v[142:143] op_sel:[0,1,0]
v_mul_f32 v149, 0xbe900000, v9
v_cos_f32 v148, v149
v_sin_f32 v149, v149
v_pk_mul_f32 v[140:141], v[48:49], v[150:151] op_sel_hi:[1,0]
v_pk_fma_f32 v[140:141], v[50:51], v[150:151], v[140:141] op_sel:[0,1,0] neg_lo:[1,0,0] neg_hi:[1,0,0]
v_pk_mul_f32 v[50:51], v[50:51], v[150:151] op_sel_hi:[1,0]
v_pk_fma_f32 v[50:51], v[48:49], v[150:151], v[50:51] op_sel:[0,1,0]
v_mul_f32 v151, 0xbe980000, v9
v_cos_f32 v150, v151
v_sin_f32 v151, v151
v_pk_mul_f32 v[48:49], v[32:33], v[148:149] op_sel_hi:[1,0]
v_pk_fma_f32 v[48:49], v[34:35], v[148:149], v[48:49] op_sel:[0,1,0] neg_lo:[1,0,0] neg_hi:[1,0,0]
v_pk_mul_f32 v[34:35], v[34:35], v[148:149] op_sel_hi:[1,0]
v_pk_fma_f32 v[34:35], v[32:33], v[148:149], v[34:35] op_sel:[0,1,0]
v_mul_f32 v149, 0xbea00000, v9
v_cos_f32 v148, v149
v_sin_f32 v149, v149
v_pk_mul_f32 v[32:33], v[96:97], v[150:151] op_sel_hi:[1,0]
v_pk_fma_f32 v[32:33], v[98:99], v[150:151], v[32:33] op_sel:[0,1,0] neg_lo:[1,0,0] neg_hi:[1,0,0]
v_pk_mul_f32 v[98:99], v[98:99], v[150:151] op_sel_hi:[1,0]
v_pk_fma_f32 v[98:99], v[96:97], v[150:151], v[98:99] op_sel:[0,1,0]
v_mul_f32 v151, 0xbea80000, v9
v_cos_f32 v150, v151
v_sin_f32 v151, v151
v_pk_mul_f32 v[96:97], v[24:25], v[148:149] op_sel_hi:[1,0]
v_pk_fma_f32 v[96:97], v[26:27], v[148:149], v[96:97] op_sel:[0,1,0] neg_lo:[1,0,0] neg_hi:[1,0,0]
v_pk_mul_f32 v[26:27], v[26:27], v[148:149] op_sel_hi:[1,0]
v_pk_fma_f32 v[26:27], v[24:25], v[148:149], v[26:27] op_sel:[0,1,0]
v_mul_f32 v149, 0xbeb00000, v9
v_cos_f32 v148, v149
v_sin_f32 v149, v149
v_pk_mul_f32 v[24:25], v[88:89], v[150:151] op_sel_hi:[1,0]
v_pk_fma_f32 v[24:25], v[90:91], v[150:151], v[24:25] op_sel:[0,1,0] neg_lo:[1,0,0] neg_hi:[1,0,0]
v_pk_mul_f32 v[90:91], v[90:91], v[150:151] op_sel_hi:[1,0]
v_pk_fma_f32 v[90:91], v[88:89], v[150:151], v[90:91] op_sel:[0,1,0]
v_mul_f32 v151, 0xbeb80000, v9
v_cos_f32 v150, v151
v_sin_f32 v151, v151
v_pk_mul_f32 v[88:89], v[56:57], v[148:149] op_sel_hi:[1,0]
v_pk_fma_f32 v[88:89], v[58:59], v[148:149], v[88:89] op_sel:[0,1,0] neg_lo:[1,0,0] neg_hi:[1,0,0]
v_pk_mul_f32 v[58:59], v[58:59], v[148:149] op_sel_hi:[1,0]
v_pk_fma_f32 v[58:59], v[56:57], v[148:149], v[58:59] op_sel:[0,1,0]
v_mul_f32 v149, 0xbec00000, v9
v_cos_f32 v148, v149
v_sin_f32 v149, v149
v_pk_mul_f32 v[56:57], v[120:121], v[150:151] op_sel_hi:[1,0]
v_pk_fma_f32 v[56:57], v[122:123], v[150:151], v[56:57] op_sel:[0,1,0] neg_lo:[1,0,0] neg_hi:[1,0,0]
v_pk_mul_f32 v[122:123], v[122:123], v[150:151] op_sel_hi:[1,0]
v_pk_fma_f32 v[122:123], v[120:121], v[150:151], v[122:123] op_sel:[0,1,0]
v_mul_f32 v151, 0xbec80000, v9
v_cos_f32 v150, v151
v_sin_f32 v151, v151
v_pk_mul_f32 v[120:121], v[20:21], v[148:149] op_sel_hi:[1,0]
v_pk_fma_f32 v[120:121], v[22:23], v[148:149], v[120:121] op_sel:[0,1,0] neg_lo:[1,0,0] neg_hi:[1,0,0]
v_pk_mul_f32 v[22:23], v[22:23], v[148:149] op_sel_hi:[1,0]
v_pk_fma_f32 v[22:23], v[20:21], v[148:149], v[22:23] op_sel:[0,1,0]
v_mul_f32 v149, 0xbed00000, v9
v_cos_f32 v148, v149
v_sin_f32 v149, v149
v_pk_mul_f32 v[20:21], v[84:85], v[150:151] op_sel_hi:[1,0]
v_pk_fma_f32 v[20:21], v[86:87], v[150:151], v[20:21] op_sel:[0,1,0] neg_lo:[1,0,0] neg_hi:[1,0,0]
v_pk_mul_f32 v[86:87], v[86:87], v[150:151] op_sel_hi:[1,0]
v_pk_fma_f32 v[86:87], v[84:85], v[150:151], v[86:87] op_sel:[0,1,0]
v_mul_f32 v151, 0xbed80000, v9
v_cos_f32 v150, v151
v_sin_f32 v151, v151
v_pk_mul_f32 v[84:85], v[52:53], v[148:149] op_sel_hi:[1,0]
v_pk_fma_f32 v[84:85], v[54:55], v[148:149], v[84:85] op_sel:[0,1,0] neg_lo:[1,0,0] neg_hi:[1,0,0]
v_pk_mul_f32 v[54:55], v[54:55], v[148:149] op_sel_hi:[1,0]
v_pk_fma_f32 v[54:55], v[52:53], v[148:149], v[54:55] op_sel:[0,1,0]
v_mul_f32 v149, 0xbee00000, v9
v_cos_f32 v148, v149
v_sin_f32 v149, v149
v_pk_mul_f32 v[52:53], v[116:117], v[150:151] op_sel_hi:[1,0]
v_pk_fma_f32 v[52:53], v[118:119], v[150:151], v[52:53] op_sel:[0,1,0] neg_lo:[1,0,0] neg_hi:[1,0,0]
v_pk_mul_f32 v[118:119], v[118:119], v[150:151] op_sel_hi:[1,0]
v_pk_fma_f32 v[118:119], v[116:117], v[150:151], v[118:119] op_sel:[0,1,0]
v_mul_f32 v151, 0xbee80000, v9
v_cos_f32 v150, v151
v_sin_f32 v151, v151
v_pk_mul_f32 v[116:117], v[36:37], v[148:149] op_sel_hi:[1,0]
v_pk_fma_f32 v[116:117], v[38:39], v[148:149], v[116:117] op_sel:[0,1,0] neg_lo:[1,0,0] neg_hi:[1,0,0]
v_pk_mul_f32 v[38:39], v[38:39], v[148:149] op_sel_hi:[1,0]
v_pk_fma_f32 v[38:39], v[36:37], v[148:149], v[38:39] op_sel:[0,1,0]
v_mul_f32 v149, 0xbef00000, v9
v_cos_f32 v148, v149
v_sin_f32 v149, v149
v_pk_mul_f32 v[36:37], v[100:101], v[150:151] op_sel_hi:[1,0]
v_pk_fma_f32 v[36:37], v[102:103], v[150:151], v[36:37] op_sel:[0,1,0] neg_lo:[1,0,0] neg_hi:[1,0,0]
v_pk_mul_f32 v[102:103], v[102:103], v[150:151] op_sel_hi:[1,0]
v_pk_fma_f32 v[102:103], v[100:101], v[150:151], v[102:103] op_sel:[0,1,0]
v_mul_f32 v151, 0xbef80000, v9
v_cos_f32 v150, v151
v_sin_f32 v151, v151
v_pk_mul_f32 v[100:101], v[68:69], v[148:149] op_sel_hi:[1,0]
v_pk_fma_f32 v[100:101], v[70:71], v[148:149], v[100:101] op_sel:[0,1,0] neg_lo:[1,0,0] neg_hi:[1,0,0]
v_pk_mul_f32 v[70:71], v[70:71], v[148:149] op_sel_hi:[1,0]
v_pk_fma_f32 v[70:71], v[68:69], v[148:149], v[70:71] op_sel:[0,1,0]
s_nop 0
v_pk_mul_f32 v[68:69], v[132:133], v[150:151] op_sel_hi:[1,0]
v_pk_fma_f32 v[68:69], v[134:135], v[150:151], v[68:69] op_sel:[0,1,0] neg_lo:[1,0,0] neg_hi:[1,0,0]
v_pk_mul_f32 v[134:135], v[134:135], v[150:151] op_sel_hi:[1,0]
v_pk_fma_f32 v[134:135], v[132:133], v[150:151], v[134:135] op_sel:[0,1,0]
s_nop 1
v_mov_b32_dpp v132, v16 quad_perm:[1,0,3,2] row_mask:0xf bank_mask:0xf
v_mov_b32_dpp v133, v17 quad_perm:[1,0,3,2] row_mask:0xf bank_mask:0xf
v_pk_fma_f32 v[16:17], v[16:17], v[14:15], v[132:133] op_sel_hi:[1,0,1]
v_mov_b32_dpp v82, v18 quad_perm:[1,0,3,2] row_mask:0xf bank_mask:0xf
v_mov_b32_dpp v83, v19 quad_perm:[1,0,3,2] row_mask:0xf bank_mask:0xf
v_pk_fma_f32 v[18:19], v[18:19], v[14:15], v[82:83] op_sel_hi:[1,0,1]
v_mov_b32_dpp v132, v80 quad_perm:[1,0,3,2] row_mask:0xf bank_mask:0xf
v_mov_b32_dpp v133, v81 quad_perm:[1,0,3,2] row_mask:0xf bank_mask:0xf
v_pk_fma_f32 v[80:81], v[80:81], v[14:15], v[132:133] op_sel_hi:[1,0,1]
v_mov_b32_dpp v82, v146 quad_perm:[1,0,3,2] row_mask:0xf bank_mask:0xf
v_mov_b32_dpp v83, v147 quad_perm:[1,0,3,2] row_mask:0xf bank_mask:0xf
v_pk_fma_f32 v[146:147], v[146:147], v[14:15], v[82:83] op_sel_hi:[1,0,1]
v_mov_b32_dpp v132, v144 quad_perm:[1,0,3,2] row_mask:0xf bank_mask:0xf
v_mov_b32_dpp v133, v145 quad_perm:[1,0,3,2] row_mask:0xf bank_mask:0xf
v_pk_fma_f32 v[144:145], v[144:145], v[14:15], v[132:133] op_sel_hi:[1,0,1]
v_mov_b32_dpp v82, v114 quad_perm:[1,0,3,2] row_mask:0xf bank_mask:0xf
v_mov_b32_dpp v83, v115 quad_perm:[1,0,3,2] row_mask:0xf bank_mask:0xf
v_pk_fma_f32 v[114:115], v[114:115], v[14:15], v[82:83] op_sel_hi:[1,0,1]
v_mov_b32_dpp v132, v112 quad_perm:[1,0,3,2] row_mask:0xf bank_mask:0xf
v_mov_b32_dpp v133, v113 quad_perm:[1,0,3,2] row_mask:0xf bank_mask:0xf
v_pk_fma_f32 v[112:113], v[112:113], v[14:15], v[132:133] op_sel_hi:[1,0,1]
v_mov_b32_dpp v82, v66 quad_perm:[1,0,3,2] row_mask:0xf bank_mask:0xf
v_mov_b32_dpp v83, v67 quad_perm:[1,0,3,2] row_mask:0xf bank_mask:0xf
v_pk_fma_f32 v[66:67], v[66:67], v[14:15], v[82:83] op_sel_hi:[1,0,1]
v_mov_b32_dpp v132, v64 quad_perm:[1,0,3,2] row_mask:0xf bank_mask:0xf
v_mov_b32_dpp v133, v65 quad_perm:[1,0,3,2] row_mask:0xf bank_mask:0xf
v_pk_fma_f32 v[64:65], v[64:65], v[14:15], v[132:133] op_sel_hi:[1,0,1]
v_mov_b32_dpp v82, v130 quad_perm:[1,0,3,2] row_mask:0xf bank_mask:0xf
v_mov_b32_dpp v83, v131 quad_perm:[1,0,3,2] row_mask:0xf bank_mask:0xf
v_pk_fma_f32 v[130:131], v[130:131], v[14:15], v[82:83] op_sel_hi:[1,0,1]
v_mov_b32_dpp v132, v128 quad_perm:[1,0,3,2] row_mask:0xf bank_mask:0xf
v_mov_b32_dpp v133, v129 quad_perm:[1,0,3,2] row_mask:0xf bank_mask:0xf
v_pk_fma_f32 v[128:129], v[128:129], v[14:15], v[132:133] op_sel_hi:[1,0,1]
v_mov_b32_dpp v82, v74 quad_perm:[1,0,3,2] row_mask:0xf bank_mask:0xf
v_mov_b32_dpp v83, v75 quad_perm:[1,0,3,2] row_mask:0xf bank_mask:0xf
v_pk_fma_f32 v[74:75], v[74:75], v[14:15], v[82:83] op_sel_hi:[1,0,1]
v_mov_b32_dpp v132, v72 quad_perm:[1,0,3,2] row_mask:0xf bank_mask:0xf
v_mov_b32_dpp v133, v73 quad_perm:[1,0,3,2] row_mask:0xf bank_mask:0xf
v_pk_fma_f32 v[72:73], v[72:73], v[14:15], v[132:133] op_sel_hi:[1,0,1]
v_mov_b32_dpp v82, v42 quad_perm:[1,0,3,2] row_mask:0xf bank_mask:0xf
v_mov_b32_dpp v83, v43 quad_perm:[1,0,3,2] row_mask:0xf bank_mask:0xf
v_pk_fma_f32 v[42:43], v[42:43], v[14:15], v[82:83] op_sel_hi:[1,0,1]
v_mov_b32_dpp v132, v40 quad_perm:[1,0,3,2] row_mask:0xf bank_mask:0xf
v_mov_b32_dpp v133, v41 quad_perm:[1,0,3,2] row_mask:0xf bank_mask:0xf
v_pk_fma_f32 v[40:41], v[40:41], v[14:15], v[132:133] op_sel_hi:[1,0,1]
v_mov_b32_dpp v82, v106 quad_perm:[1,0,3,2] row_mask:0xf bank_mask:0xf
v_mov_b32_dpp v83, v107 quad_perm:[1,0,3,2] row_mask:0xf bank_mask:0xf
v_pk_fma_f32 v[106:107], v[106:107], v[14:15], v[82:83] op_sel_hi:[1,0,1]
v_mov_b32_dpp v132, v104 quad_perm:[1,0,3,2] row_mask:0xf bank_mask:0xf
v_mov_b32_dpp v133, v105 quad_perm:[1,0,3,2] row_mask:0xf bank_mask:0xf
v_pk_fma_f32 v[104:105], v[104:105], v[14:15], v[132:133] op_sel_hi:[1,0,1]
v_mov_b32_dpp v82, v138 quad_perm:[1,0,3,2] row_mask:0xf bank_mask:0xf
v_mov_b32_dpp v83, v139 quad_perm:[1,0,3,2] row_mask:0xf bank_mask:0xf
v_pk_fma_f32 v[138:139], v[138:139], v[14:15], v[82:83] op_sel_hi:[1,0,1]
v_mov_b32_dpp v132, v136 quad_perm:[1,0,3,2] row_mask:0xf bank_mask:0xf
v_mov_b32_dpp v133, v137 quad_perm:[1,0,3,2] row_mask:0xf bank_mask:0xf
v_pk_fma_f32 v[136:137], v[136:137], v[14:15], v[132:133] op_sel_hi:[1,0,1]
v_mov_b32_dpp v82, v78 quad_perm:[1,0,3,2] row_mask:0xf bank_mask:0xf
v_mov_b32_dpp v83, v79 quad_perm:[1,0,3,2] row_mask:0xf bank_mask:0xf
v_pk_fma_f32 v[78:79], v[78:79], v[14:15], v[82:83] op_sel_hi:[1,0,1]
v_mov_b32_dpp v132, v76 quad_perm:[1,0,3,2] row_mask:0xf bank_mask:0xf
v_mov_b32_dpp v133, v77 quad_perm:[1,0,3,2] row_mask:0xf bank_mask:0xf
v_pk_fma_f32 v[76:77], v[76:77], v[14:15], v[132:133] op_sel_hi:[1,0,1]
v_mov_b32_dpp v82, v46 quad_perm:[1,0,3,2] row_mask:0xf bank_mask:0xf
v_mov_b32_dpp v83, v47 quad_perm:[1,0,3,2] row_mask:0xf bank_mask:0xf
v_pk_fma_f32 v[46:47], v[46:47], v[14:15], v[82:83] op_sel_hi:[1,0,1]
v_mov_b32_dpp v132, v44 quad_perm:[1,0,3,2] row_mask:0xf bank_mask:0xf
v_mov_b32_dpp v133, v45 quad_perm:[1,0,3,2] row_mask:0xf bank_mask:0xf
v_pk_fma_f32 v[44:45], v[44:45], v[14:15], v[132:133] op_sel_hi:[1,0,1]
v_mov_b32_dpp v82, v110 quad_perm:[1,0,3,2] row_mask:0xf bank_mask:0xf
v_mov_b32_dpp v83, v111 quad_perm:[1,0,3,2] row_mask:0xf bank_mask:0xf
v_pk_fma_f32 v[110:111], v[110:111], v[14:15], v[82:83] op_sel_hi:[1,0,1]
v_mov_b32_dpp v132, v108 quad_perm:[1,0,3,2] row_mask:0xf bank_mask:0xf
v_mov_b32_dpp v133, v109 quad_perm:[1,0,3,2] row_mask:0xf bank_mask:0xf
v_pk_fma_f32 v[108:109], v[108:109], v[14:15], v[132:133] op_sel_hi:[1,0,1]
v_mov_b32_dpp v82, v30 quad_perm:[1,0,3,2] row_mask:0xf bank_mask:0xf
v_mov_b32_dpp v83, v31 quad_perm:[1,0,3,2] row_mask:0xf bank_mask:0xf
v_pk_fma_f32 v[30:31], v[30:31], v[14:15], v[82:83] op_sel_hi:[1,0,1]
v_mov_b32_dpp v132, v28 quad_perm:[1,0,3,2] row_mask:0xf bank_mask:0xf
v_mov_b32_dpp v133, v29 quad_perm:[1,0,3,2] row_mask:0xf bank_mask:0xf
v_pk_fma_f32 v[28:29], v[28:29], v[14:15], v[132:133] op_sel_hi:[1,0,1]
v_mov_b32_dpp v82, v94 quad_perm:[1,0,3,2] row_mask:0xf bank_mask:0xf
v_mov_b32_dpp v83, v95 quad_perm:[1,0,3,2] row_mask:0xf bank_mask:0xf
v_pk_fma_f32 v[94:95], v[94:95], v[14:15], v[82:83] op_sel_hi:[1,0,1]
v_mov_b32_dpp v132, v92 quad_perm:[1,0,3,2] row_mask:0xf bank_mask:0xf
v_mov_b32_dpp v133, v93 quad_perm:[1,0,3,2] row_mask:0xf bank_mask:0xf
v_pk_fma_f32 v[92:93], v[92:93], v[14:15], v[132:133] op_sel_hi:[1,0,1]
v_mov_b32_dpp v82, v62 quad_perm:[1,0,3,2] row_mask:0xf bank_mask:0xf
v_mov_b32_dpp v83, v63 quad_perm:[1,0,3,2] row_mask:0xf bank_mask:0xf
v_pk_fma_f32 v[62:63], v[62:63], v[14:15], v[82:83] op_sel_hi:[1,0,1]
v_mov_b32_dpp v132, v60 quad_perm:[1,0,3,2] row_mask:0xf bank_mask:0xf
v_mov_b32_dpp v133, v61 quad_perm:[1,0,3,2] row_mask:0xf bank_mask:0xf
v_pk_fma_f32 v[60:61], v[60:61], v[14:15], v[132:133] op_sel_hi:[1,0,1]
v_mov_b32_dpp v82, v126 quad_perm:[1,0,3,2] row_mask:0xf bank_mask:0xf
v_mov_b32_dpp v83, v127 quad_perm:[1,0,3,2] row_mask:0xf bank_mask:0xf
v_pk_fma_f32 v[126:127], v[126:127], v[14:15], v[82:83] op_sel_hi:[1,0,1]
v_mov_b32_dpp v132, v124 quad_perm:[1,0,3,2] row_mask:0xf bank_mask:0xf
v_mov_b32_dpp v133, v125 quad_perm:[1,0,3,2] row_mask:0xf bank_mask:0xf
v_pk_fma_f32 v[124:125], v[124:125], v[14:15], v[132:133] op_sel_hi:[1,0,1]
v_mov_b32_dpp v82, v142 quad_perm:[1,0,3,2] row_mask:0xf bank_mask:0xf
v_mov_b32_dpp v83, v143 quad_perm:[1,0,3,2] row_mask:0xf bank_mask:0xf
v_pk_fma_f32 v[142:143], v[142:143], v[14:15], v[82:83] op_sel_hi:[1,0,1]
v_mov_b32_dpp v132, v140 quad_perm:[1,0,3,2] row_mask:0xf bank_mask:0xf
v_mov_b32_dpp v133, v141 quad_perm:[1,0,3,2] row_mask:0xf bank_mask:0xf
v_pk_fma_f32 v[140:141], v[140:141], v[14:15], v[132:133] op_sel_hi:[1,0,1]
v_mov_b32_dpp v82, v50 quad_perm:[1,0,3,2] row_mask:0xf bank_mask:0xf
v_mov_b32_dpp v83, v51 quad_perm:[1,0,3,2] row_mask:0xf bank_mask:0xf
v_pk_fma_f32 v[50:51], v[50:51], v[14:15], v[82:83] op_sel_hi:[1,0,1]
v_mov_b32_dpp v132, v48 quad_perm:[1,0,3,2] row_mask:0xf bank_mask:0xf
v_mov_b32_dpp v133, v49 quad_perm:[1,0,3,2] row_mask:0xf bank_mask:0xf
v_pk_fma_f32 v[48:49], v[48:49], v[14:15], v[132:133] op_sel_hi:[1,0,1]
v_mov_b32_dpp v82, v34 quad_perm:[1,0,3,2] row_mask:0xf bank_mask:0xf
v_mov_b32_dpp v83, v35 quad_perm:[1,0,3,2] row_mask:0xf bank_mask:0xf
v_pk_fma_f32 v[34:35], v[34:35], v[14:15], v[82:83] op_sel_hi:[1,0,1]
v_mov_b32_dpp v132, v32 quad_perm:[1,0,3,2] row_mask:0xf bank_mask:0xf
v_mov_b32_dpp v133, v33 quad_perm:[1,0,3,2] row_mask:0xf bank_mask:0xf
v_pk_fma_f32 v[32:33], v[32:33], v[14:15], v[132:133] op_sel_hi:[1,0,1]
v_mov_b32_dpp v82, v98 quad_perm:[1,0,3,2] row_mask:0xf bank_mask:0xf
v_mov_b32_dpp v83, v99 quad_perm:[1,0,3,2] row_mask:0xf bank_mask:0xf
v_pk_fma_f32 v[98:99], v[98:99], v[14:15], v[82:83] op_sel_hi:[1,0,1]
v_mov_b32_dpp v132, v96 quad_perm:[1,0,3,2] row_mask:0xf bank_mask:0xf
v_mov_b32_dpp v133, v97 quad_perm:[1,0,3,2] row_mask:0xf bank_mask:0xf
v_pk_fma_f32 v[96:97], v[96:97], v[14:15], v[132:133] op_sel_hi:[1,0,1]
v_mov_b32_dpp v82, v26 quad_perm:[1,0,3,2] row_mask:0xf bank_mask:0xf
v_mov_b32_dpp v83, v27 quad_perm:[1,0,3,2] row_mask:0xf bank_mask:0xf
v_pk_fma_f32 v[26:27], v[26:27], v[14:15], v[82:83] op_sel_hi:[1,0,1]
v_mov_b32_dpp v132, v24 quad_perm:[1,0,3,2] row_mask:0xf bank_mask:0xf
v_mov_b32_dpp v133, v25 quad_perm:[1,0,3,2] row_mask:0xf bank_mask:0xf
v_pk_fma_f32 v[24:25], v[24:25], v[14:15], v[132:133] op_sel_hi:[1,0,1]
v_mov_b32_dpp v82, v90 quad_perm:[1,0,3,2] row_mask:0xf bank_mask:0xf
v_mov_b32_dpp v83, v91 quad_perm:[1,0,3,2] row_mask:0xf bank_mask:0xf
v_pk_fma_f32 v[90:91], v[90:91], v[14:15], v[82:83] op_sel_hi:[1,0,1]
v_mov_b32_dpp v132, v88 quad_perm:[1,0,3,2] row_mask:0xf bank_mask:0xf
v_mov_b32_dpp v133, v89 quad_perm:[1,0,3,2] row_mask:0xf bank_mask:0xf
v_pk_fma_f32 v[88:89], v[88:89], v[14:15], v[132:133] op_sel_hi:[1,0,1]
v_mov_b32_dpp v82, v58 quad_perm:[1,0,3,2] row_mask:0xf bank_mask:0xf
v_mov_b32_dpp v83, v59 quad_perm:[1,0,3,2] row_mask:0xf bank_mask:0xf
v_pk_fma_f32 v[58:59], v[58:59], v[14:15], v[82:83] op_sel_hi:[1,0,1]
v_mov_b32_dpp v132, v56 quad_perm:[1,0,3,2] row_mask:0xf bank_mask:0xf
v_mov_b32_dpp v133, v57 quad_perm:[1,0,3,2] row_mask:0xf bank_mask:0xf
v_pk_fma_f32 v[56:57], v[56:57], v[14:15], v[132:133] op_sel_hi:[1,0,1]
v_mov_b32_dpp v82, v122 quad_perm:[1,0,3,2] row_mask:0xf bank_mask:0xf
v_mov_b32_dpp v83, v123 quad_perm:[1,0,3,2] row_mask:0xf bank_mask:0xf
v_pk_fma_f32 v[122:123], v[122:123], v[14:15], v[82:83] op_sel_hi:[1,0,1]
v_mov_b32_dpp v132, v120 quad_perm:[1,0,3,2] row_mask:0xf bank_mask:0xf
v_mov_b32_dpp v133, v121 quad_perm:[1,0,3,2] row_mask:0xf bank_mask:0xf
v_pk_fma_f32 v[120:121], v[120:121], v[14:15], v[132:133] op_sel_hi:[1,0,1]
v_mov_b32_dpp v82, v22 quad_perm:[1,0,3,2] row_mask:0xf bank_mask:0xf
v_mov_b32_dpp v83, v23 quad_perm:[1,0,3,2] row_mask:0xf bank_mask:0xf
v_pk_fma_f32 v[22:23], v[22:23], v[14:15], v[82:83] op_sel_hi:[1,0,1]
v_mov_b32_dpp v132, v20 quad_perm:[1,0,3,2] row_mask:0xf bank_mask:0xf
v_mov_b32_dpp v133, v21 quad_perm:[1,0,3,2] row_mask:0xf bank_mask:0xf
v_pk_fma_f32 v[20:21], v[20:21], v[14:15], v[132:133] op_sel_hi:[1,0,1]
v_mov_b32_dpp v82, v86 quad_perm:[1,0,3,2] row_mask:0xf bank_mask:0xf
v_mov_b32_dpp v83, v87 quad_perm:[1,0,3,2] row_mask:0xf bank_mask:0xf
v_pk_fma_f32 v[86:87], v[86:87], v[14:15], v[82:83] op_sel_hi:[1,0,1]
v_mov_b32_dpp v132, v84 quad_perm:[1,0,3,2] row_mask:0xf bank_mask:0xf
v_mov_b32_dpp v133, v85 quad_perm:[1,0,3,2] row_mask:0xf bank_mask:0xf
v_pk_fma_f32 v[84:85], v[84:85], v[14:15], v[132:133] op_sel_hi:[1,0,1]
v_mov_b32_dpp v82, v54 quad_perm:[1,0,3,2] row_mask:0xf bank_mask:0xf
v_mov_b32_dpp v83, v55 quad_perm:[1,0,3,2] row_mask:0xf bank_mask:0xf
v_pk_fma_f32 v[54:55], v[54:55], v[14:15], v[82:83] op_sel_hi:[1,0,1]
v_mov_b32_dpp v132, v52 quad_perm:[1,0,3,2] row_mask:0xf bank_mask:0xf
v_mov_b32_dpp v133, v53 quad_perm:[1,0,3,2] row_mask:0xf bank_mask:0xf
v_pk_fma_f32 v[52:53], v[52:53], v[14:15], v[132:133] op_sel_hi:[1,0,1]
v_mov_b32_dpp v82, v118 quad_perm:[1,0,3,2] row_mask:0xf bank_mask:0xf
v_mov_b32_dpp v83, v119 quad_perm:[1,0,3,2] row_mask:0xf bank_mask:0xf
v_pk_fma_f32 v[118:119], v[118:119], v[14:15], v[82:83] op_sel_hi:[1,0,1]
v_mov_b32_dpp v132, v116 quad_perm:[1,0,3,2] row_mask:0xf bank_mask:0xf
v_mov_b32_dpp v133, v117 quad_perm:[1,0,3,2] row_mask:0xf bank_mask:0xf
v_pk_fma_f32 v[116:117], v[116:117], v[14:15], v[132:133] op_sel_hi:[1,0,1]
v_mov_b32_dpp v82, v38 quad_perm:[1,0,3,2] row_mask:0xf bank_mask:0xf
v_mov_b32_dpp v83, v39 quad_perm:[1,0,3,2] row_mask:0xf bank_mask:0xf
v_pk_fma_f32 v[38:39], v[38:39], v[14:15], v[82:83] op_sel_hi:[1,0,1]
v_mov_b32_dpp v132, v36 quad_perm:[1,0,3,2] row_mask:0xf bank_mask:0xf
v_mov_b32_dpp v133, v37 quad_perm:[1,0,3,2] row_mask:0xf bank_mask:0xf
v_pk_fma_f32 v[36:37], v[36:37], v[14:15], v[132:133] op_sel_hi:[1,0,1]
v_mov_b32_dpp v82, v102 quad_perm:[1,0,3,2] row_mask:0xf bank_mask:0xf
v_mov_b32_dpp v83, v103 quad_perm:[1,0,3,2] row_mask:0xf bank_mask:0xf
v_pk_fma_f32 v[102:103], v[102:103], v[14:15], v[82:83] op_sel_hi:[1,0,1]
v_mov_b32_dpp v132, v100 quad_perm:[1,0,3,2] row_mask:0xf bank_mask:0xf
v_mov_b32_dpp v133, v101 quad_perm:[1,0,3,2] row_mask:0xf bank_mask:0xf
v_pk_fma_f32 v[100:101], v[100:101], v[14:15], v[132:133] op_sel_hi:[1,0,1]
v_mov_b32_dpp v82, v70 quad_perm:[1,0,3,2] row_mask:0xf bank_mask:0xf
v_mov_b32_dpp v83, v71 quad_perm:[1,0,3,2] row_mask:0xf bank_mask:0xf
v_pk_fma_f32 v[70:71], v[70:71], v[14:15], v[82:83] op_sel_hi:[1,0,1]
v_mov_b32_dpp v132, v68 quad_perm:[1,0,3,2] row_mask:0xf bank_mask:0xf
v_mov_b32_dpp v133, v69 quad_perm:[1,0,3,2] row_mask:0xf bank_mask:0xf
v_pk_fma_f32 v[68:69], v[68:69], v[14:15], v[132:133] op_sel_hi:[1,0,1]
v_mov_b32_dpp v82, v134 quad_perm:[1,0,3,2] row_mask:0xf bank_mask:0xf
v_mov_b32_dpp v83, v135 quad_perm:[1,0,3,2] row_mask:0xf bank_mask:0xf
v_pk_fma_f32 v[134:135], v[134:135], v[14:15], v[82:83] op_sel_hi:[1,0,1]
v_lshlrev_b32 v82, 16, v160
v_and_b32 v83, 0xffff0000, v160
v_lshlrev_b32 v148, 16, v192
v_and_b32 v149, 0xffff0000, v192
v_pk_mul_f32 v[132:133], v[16:17], v[82:83]
v_pk_fma_f32 v[132:133], v[18:19], v[148:149], v[132:133] neg_lo:[1,0,0] neg_hi:[1,0,0]
v_pk_mul_f32 v[18:19], v[18:19], v[82:83]
v_pk_fma_f32 v[18:19], v[16:17], v[148:149], v[18:19]
v_lshlrev_b32 v82, 16, v161
v_and_b32 v83, 0xffff0000, v161
v_lshlrev_b32 v148, 16, v193
v_and_b32 v149, 0xffff0000, v193
v_pk_mul_f32 v[16:17], v[80:81], v[82:83]
v_pk_fma_f32 v[16:17], v[146:147], v[148:149], v[16:17] neg_lo:[1,0,0] neg_hi:[1,0,0]
v_pk_mul_f32 v[146:147], v[146:147], v[82:83]
v_pk_fma_f32 v[146:147], v[80:81], v[148:149], v[146:147]
v_lshlrev_b32 v82, 16, v162
v_and_b32 v83, 0xffff0000, v162
v_lshlrev_b32 v148, 16, v194
v_and_b32 v149, 0xffff0000, v194
v_pk_mul_f32 v[80:81], v[144:145], v[82:83]
v_pk_fma_f32 v[80:81], v[114:115], v[148:149], v[80:81] neg_lo:[1,0,0] neg_hi:[1,0,0]
v_pk_mul_f32 v[114:115], v[114:115], v[82:83]
v_pk_fma_f32 v[114:115], v[144:145], v[148:149], v[114:115]
v_lshlrev_b32 v82, 16, v163
v_and_b32 v83, 0xffff0000, v163
v_lshlrev_b32 v148, 16, v195
v_and_b32 v149, 0xffff0000, v195
v_pk_mul_f32 v[144:145], v[112:113], v[82:83]
v_pk_fma_f32 v[144:145], v[66:67], v[148:149], v[144:145] neg_lo:[1,0,0] neg_hi:[1,0,0]
v_pk_mul_f32 v[66:67], v[66:67], v[82:83]
v_pk_fma_f32 v[66:67], v[112:113], v[148:149], v[66:67]
v_lshlrev_b32 v82, 16, v164
v_and_b32 v83, 0xffff0000, v164
v_lshlrev_b32 v148, 16, v196
v_and_b32 v149, 0xffff0000, v196
v_pk_mul_f32 v[112:113], v[64:65], v[82:83]
v_pk_fma_f32 v[112:113], v[130:131], v[148:149], v[112:113] neg_lo:[1,0,0] neg_hi:[1,0,0]
v_pk_mul_f32 v[130:131], v[130:131], v[82:83]
v_pk_fma_f32 v[130:131], v[64:65], v[148:149], v[130:131]
v_lshlrev_b32 v82, 16, v165
v_and_b32 v83, 0xffff0000, v165
v_lshlrev_b32 v148, 16, v197
v_and_b32 v149, 0xffff0000, v197
v_pk_mul_f32 v[64:65], v[128:129], v[82:83]
v_pk_fma_f32 v[64:65], v[74:75], v[148:149], v[64:65] neg_lo:[1,0,0] neg_hi:[1,0,0]
v_pk_mul_f32 v[74:75], v[74:75], v[82:83]
v_pk_fma_f32 v[74:75], v[128:129], v[148:149], v[74:75]
v_lshlrev_b32 v82, 16, v166
v_and_b32 v83, 0xffff0000, v166
v_lshlrev_b32 v148, 16, v198
v_and_b32 v149, 0xffff0000, v198
v_pk_mul_f32 v[128:129], v[72:73], v[82:83]
v_pk_fma_f32 v[128:129], v[42:43], v[148:149], v[128:129] neg_lo:[1,0,0] neg_hi:[1,0,0]
v_pk_mul_f32 v[42:43], v[42:43], v[82:83]
v_pk_fma_f32 v[42:43], v[72:73], v[148:149], v[42:43]
v_lshlrev_b32 v82, 16, v167
v_and_b32 v83, 0xffff0000, v167
v_lshlrev_b32 v148, 16, v199
v_and_b32 v149, 0xffff0000, v199
v_pk_mul_f32 v[72:73], v[40:41], v[82:83]
v_pk_fma_f32 v[72:73], v[106:107], v[148:149], v[72:73] neg_lo:[1,0,0] neg_hi:[1,0,0]
v_pk_mul_f32 v[106:107], v[106:107], v[82:83]
v_pk_fma_f32 v[106:107], v[40:41], v[148:149], v[106:107]
v_lshlrev_b32 v82, 16, v168
v_and_b32 v83, 0xffff0000, v168
v_lshlrev_b32 v148, 16, v200
v_and_b32 v149, 0xffff0000, v200
v_pk_mul_f32 v[40:41], v[104:105], v[82:83]
v_pk_fma_f32 v[40:41], v[138:139], v[148:149], v[40:41] neg_lo:[1,0,0] neg_hi:[1,0,0]
v_pk_mul_f32 v[138:139], v[138:139], v[82:83]
v_pk_fma_f32 v[138:139], v[104:105], v[148:149], v[138:139]
v_lshlrev_b32 v82, 16, v169
v_and_b32 v83, 0xffff0000, v169
v_lshlrev_b32 v148, 16, v201
v_and_b32 v149, 0xffff0000, v201
v_pk_mul_f32 v[104:105], v[136:137], v[82:83]
v_pk_fma_f32 v[104:105], v[78:79], v[148:149], v[104:105] neg_lo:[1,0,0] neg_hi:[1,0,0]
v_pk_mul_f32 v[78:79], v[78:79], v[82:83]
v_pk_fma_f32 v[78:79], v[136:137], v[148:149], v[78:79]
v_lshlrev_b32 v82, 16, v170
v_and_b32 v83, 0xffff0000, v170
v_lshlrev_b32 v148, 16, v202
v_and_b32 v149, 0xffff0000, v202
v_pk_mul_f32 v[136:137], v[76:77], v[82:83]
v_pk_fma_f32 v[136:137], v[46:47], v[148:149], v[136:137] neg_lo:[1,0,0] neg_hi:[1,0,0]
v_pk_mul_f32 v[46:47], v[46:47], v[82:83]
v_pk_fma_f32 v[46:47], v[76:77], v[148:149], v[46:47]
v_lshlrev_b32 v82, 16, v171
v_and_b32 v83, 0xffff0000, v171
v_lshlrev_b32 v148, 16, v203
v_and_b32 v149, 0xffff0000, v203
v_pk_mul_f32 v[76:77], v[44:45], v[82:83]
v_pk_fma_f32 v[76:77], v[110:111], v[148:149], v[76:77] neg_lo:[1,0,0] neg_hi:[1,0,0]
v_pk_mul_f32 v[110:111], v[110:111], v[82:83]
v_pk_fma_f32 v[110:111], v[44:45], v[148:149], v[110:111]
v_lshlrev_b32 v82, 16, v172
v_and_b32 v83, 0xffff0000, v172
v_lshlrev_b32 v148, 16, v204
v_and_b32 v149, 0xffff0000, v204
v_pk_mul_f32 v[44:45], v[108:109], v[82:83]
v_pk_fma_f32 v[44:45], v[30:31], v[148:149], v[44:45] neg_lo:[1,0,0] neg_hi:[1,0,0]
v_pk_mul_f32 v[30:31], v[30:31], v[82:83]
v_pk_fma_f32 v[30:31], v[108:109], v[148:149], v[30:31]
v_lshlrev_b32 v82, 16, v173
v_and_b32 v83, 0xffff0000, v173
v_lshlrev_b32 v148, 16, v205
v_and_b32 v149, 0xffff0000, v205
v_pk_mul_f32 v[108:109], v[28:29], v[82:83]
v_pk_fma_f32 v[108:109], v[94:95], v[148:149], v[108:109] neg_lo:[1,0,0] neg_hi:[1,0,0]
v_pk_mul_f32 v[94:95], v[94:95], v[82:83]
v_pk_fma_f32 v[94:95], v[28:29], v[148:149], v[94:95]
v_lshlrev_b32 v82, 16, v174
v_and_b32 v83, 0xffff0000, v174
v_lshlrev_b32 v148, 16, v206
v_and_b32 v149, 0xffff0000, v206
v_pk_mul_f32 v[28:29], v[92:93], v[82:83]
v_pk_fma_f32 v[28:29], v[62:63], v[148:149], v[28:29] neg_lo:[1,0,0] neg_hi:[1,0,0]
v_pk_mul_f32 v[62:63], v[62:63], v[82:83]
v_pk_fma_f32 v[62:63], v[92:93], v[148:149], v[62:63]
v_lshlrev_b32 v82, 16, v175
v_and_b32 v83, 0xffff0000, v175
v_lshlrev_b32 v148, 16, v207
v_and_b32 v149, 0xffff0000, v207
v_pk_mul_f32 v[92:93], v[60:61], v[82:83]
v_pk_fma_f32 v[92:93], v[126:127], v[148:149], v[92:93] neg_lo:[1,0,0] neg_hi:[1,0,0]
v_pk_mul_f32 v[126:127], v[126:127], v[82:83]
v_pk_fma_f32 v[126:127], v[60:61], v[148:149], v[126:127]
v_lshlrev_b32 v82, 16, v176
v_and_b32 v83, 0xffff0000, v176
v_lshlrev_b32 v148, 16, v208
v_and_b32 v149, 0xffff0000, v208
v_pk_mul_f32 v[60:61], v[124:125], v[82:83]
v_pk_fma_f32 v[60:61], v[142:143], v[148:149], v[60:61] neg_lo:[1,0,0] neg_hi:[1,0,0]
v_pk_mul_f32 v[142:143], v[142:143], v[82:83]
v_pk_fma_f32 v[142:143], v[124:125], v[148:149], v[142:143]
v_lshlrev_b32 v82, 16, v177
v_and_b32 v83, 0xffff0000, v177
v_lshlrev_b32 v148, 16, v209
v_and_b32 v149, 0xffff0000, v209
v_pk_mul_f32 v[124:125], v[140:141], v[82:83]
v_pk_fma_f32 v[124:125], v[50:51], v[148:149], v[124:125] neg_lo:[1,0,0] neg_hi:[1,0,0]
v_pk_mul_f32 v[50:51], v[50:51], v[82:83]
v_pk_fma_f32 v[50:51], v[140:141], v[148:149], v[50:51]
v_lshlrev_b32 v82, 16, v178
v_and_b32 v83, 0xffff0000, v178
v_lshlrev_b32 v148, 16, v210
v_and_b32 v149, 0xffff0000, v210
v_pk_mul_f32 v[140:141], v[48:49], v[82:83]
v_pk_fma_f32 v[140:141], v[34:35], v[148:149], v[140:141] neg_lo:[1,0,0] neg_hi:[1,0,0]
v_pk_mul_f32 v[34:35], v[34:35], v[82:83]
v_pk_fma_f32 v[34:35], v[48:49], v[148:149], v[34:35]
v_lshlrev_b32 v82, 16, v179
v_and_b32 v83, 0xffff0000, v179
v_lshlrev_b32 v148, 16, v211
v_and_b32 v149, 0xffff0000, v211
v_pk_mul_f32 v[48:49], v[32:33], v[82:83]
v_pk_fma_f32 v[48:49], v[98:99], v[148:149], v[48:49] neg_lo:[1,0,0] neg_hi:[1,0,0]
v_pk_mul_f32 v[98:99], v[98:99], v[82:83]
v_pk_fma_f32 v[98:99], v[32:33], v[148:149], v[98:99]
v_lshlrev_b32 v82, 16, v180
v_and_b32 v83, 0xffff0000, v180
v_lshlrev_b32 v148, 16, v212
v_and_b32 v149, 0xffff0000, v212
v_pk_mul_f32 v[32:33], v[96:97], v[82:83]
v_pk_fma_f32 v[32:33], v[26:27], v[148:149], v[32:33] neg_lo:[1,0,0] neg_hi:[1,0,0]
v_pk_mul_f32 v[26:27], v[26:27], v[82:83]
v_pk_fma_f32 v[26:27], v[96:97], v[148:149], v[26:27]
v_lshlrev_b32 v82, 16, v181
v_and_b32 v83, 0xffff0000, v181
v_lshlrev_b32 v148, 16, v213
v_and_b32 v149, 0xffff0000, v213
v_pk_mul_f32 v[96:97], v[24:25], v[82:83]
v_pk_fma_f32 v[96:97], v[90:91], v[148:149], v[96:97] neg_lo:[1,0,0] neg_hi:[1,0,0]
v_pk_mul_f32 v[90:91], v[90:91], v[82:83]
v_pk_fma_f32 v[90:91], v[24:25], v[148:149], v[90:91]
v_lshlrev_b32 v82, 16, v182
v_and_b32 v83, 0xffff0000, v182
v_lshlrev_b32 v148, 16, v214
v_and_b32 v149, 0xffff0000, v214
v_pk_mul_f32 v[24:25], v[88:89], v[82:83]
v_pk_fma_f32 v[24:25], v[58:59], v[148:149], v[24:25] neg_lo:[1,0,0] neg_hi:[1,0,0]
v_pk_mul_f32 v[58:59], v[58:59], v[82:83]
v_pk_fma_f32 v[58:59], v[88:89], v[148:149], v[58:59]
v_lshlrev_b32 v82, 16, v183
v_and_b32 v83, 0xffff0000, v183
v_lshlrev_b32 v148, 16, v215
v_and_b32 v149, 0xffff0000, v215
v_pk_mul_f32 v[88:89], v[56:57], v[82:83]
v_pk_fma_f32 v[88:89], v[122:123], v[148:149], v[88:89] neg_lo:[1,0,0] neg_hi:[1,0,0]
v_pk_mul_f32 v[122:123], v[122:123], v[82:83]
v_pk_fma_f32 v[122:123], v[56:57], v[148:149], v[122:123]
v_lshlrev_b32 v82, 16, v184
v_and_b32 v83, 0xffff0000, v184
v_lshlrev_b32 v148, 16, v216
v_and_b32 v149, 0xffff0000, v216
v_pk_mul_f32 v[56:57], v[120:121], v[82:83]
v_pk_fma_f32 v[56:57], v[22:23], v[148:149], v[56:57] neg_lo:[1,0,0] neg_hi:[1,0,0]
v_pk_mul_f32 v[22:23], v[22:23], v[82:83]
v_pk_fma_f32 v[22:23], v[120:121], v[148:149], v[22:23]
v_lshlrev_b32 v82, 16, v185
v_and_b32 v83, 0xffff0000, v185
v_lshlrev_b32 v148, 16, v217
v_and_b32 v149, 0xffff0000, v217
v_pk_mul_f32 v[120:121], v[20:21], v[82:83]
v_pk_fma_f32 v[120:121], v[86:87], v[148:149], v[120:121] neg_lo:[1,0,0] neg_hi:[1,0,0]
v_pk_mul_f32 v[86:87], v[86:87], v[82:83]
v_pk_fma_f32 v[86:87], v[20:21], v[148:149], v[86:87]
v_lshlrev_b32 v82, 16, v186
v_and_b32 v83, 0xffff0000, v186
v_lshlrev_b32 v148, 16, v218
v_and_b32 v149, 0xffff0000, v218
v_pk_mul_f32 v[20:21], v[84:85], v[82:83]
v_pk_fma_f32 v[20:21], v[54:55], v[148:149], v[20:21] neg_lo:[1,0,0] neg_hi:[1,0,0]
v_pk_mul_f32 v[54:55], v[54:55], v[82:83]
v_pk_fma_f32 v[54:55], v[84:85], v[148:149], v[54:55]
v_lshlrev_b32 v82, 16, v187
v_and_b32 v83, 0xffff0000, v187
v_lshlrev_b32 v148, 16, v219
v_and_b32 v149, 0xffff0000, v219
v_pk_mul_f32 v[84:85], v[52:53], v[82:83]
v_pk_fma_f32 v[84:85], v[118:119], v[148:149], v[84:85] neg_lo:[1,0,0] neg_hi:[1,0,0]
v_pk_mul_f32 v[118:119], v[118:119], v[82:83]
v_pk_fma_f32 v[118:119], v[52:53], v[148:149], v[118:119]
v_lshlrev_b32 v82, 16, v188
v_and_b32 v83, 0xffff0000, v188
v_lshlrev_b32 v148, 16, v220
v_and_b32 v149, 0xffff0000, v220
v_pk_mul_f32 v[52:53], v[116:117], v[82:83]
v_pk_fma_f32 v[52:53], v[38:39], v[148:149], v[52:53] neg_lo:[1,0,0] neg_hi:[1,0,0]
v_pk_mul_f32 v[38:39], v[38:39], v[82:83]
v_pk_fma_f32 v[38:39], v[116:117], v[148:149], v[38:39]
v_lshlrev_b32 v82, 16, v189
v_and_b32 v83, 0xffff0000, v189
v_lshlrev_b32 v148, 16, v221
v_and_b32 v149, 0xffff0000, v221
v_pk_mul_f32 v[116:117], v[36:37], v[82:83]
v_pk_fma_f32 v[116:117], v[102:103], v[148:149], v[116:117] neg_lo:[1,0,0] neg_hi:[1,0,0]
v_pk_mul_f32 v[102:103], v[102:103], v[82:83]
v_pk_fma_f32 v[102:103], v[36:37], v[148:149], v[102:103]
v_lshlrev_b32 v82, 16, v190
v_and_b32 v83, 0xffff0000, v190
v_lshlrev_b32 v148, 16, v222
v_and_b32 v149, 0xffff0000, v222
v_pk_mul_f32 v[36:37], v[100:101], v[82:83]
v_pk_fma_f32 v[36:37], v[70:71], v[148:149], v[36:37] neg_lo:[1,0,0] neg_hi:[1,0,0]
v_pk_mul_f32 v[70:71], v[70:71], v[82:83]
v_pk_fma_f32 v[70:71], v[100:101], v[148:149], v[70:71]
v_lshlrev_b32 v82, 16, v191
v_and_b32 v83, 0xffff0000, v191
v_lshlrev_b32 v148, 16, v223
v_and_b32 v149, 0xffff0000, v223
v_pk_mul_f32 v[100:101], v[68:69], v[82:83]
v_pk_fma_f32 v[100:101], v[134:135], v[148:149], v[100:101] neg_lo:[1,0,0] neg_hi:[1,0,0]
v_pk_mul_f32 v[134:135], v[134:135], v[82:83]
v_pk_fma_f32 v[134:135], v[68:69], v[148:149], v[134:135]
s_nop 1
v_mov_b32_dpp v68, v132 quad_perm:[1,0,3,2] row_mask:0xf bank_mask:0xf
v_mov_b32_dpp v69, v133 quad_perm:[1,0,3,2] row_mask:0xf bank_mask:0xf
v_pk_fma_f32 v[132:133], v[132:133], v[14:15], v[68:69] op_sel_hi:[1,0,1]
v_mov_b32_dpp v82, v18 quad_perm:[1,0,3,2] row_mask:0xf bank_mask:0xf
v_mov_b32_dpp v83, v19 quad_perm:[1,0,3,2] row_mask:0xf bank_mask:0xf
v_pk_fma_f32 v[18:19], v[18:19], v[14:15], v[82:83] op_sel_hi:[1,0,1]
v_mov_b32_dpp v68, v16 quad_perm:[1,0,3,2] row_mask:0xf bank_mask:0xf
v_mov_b32_dpp v69, v17 quad_perm:[1,0,3,2] row_mask:0xf bank_mask:0xf
v_pk_fma_f32 v[16:17], v[16:17], v[14:15], v[68:69] op_sel_hi:[1,0,1]
v_mov_b32_dpp v82, v146 quad_perm:[1,0,3,2] row_mask:0xf bank_mask:0xf
v_mov_b32_dpp v83, v147 quad_perm:[1,0,3,2] row_mask:0xf bank_mask:0xf
v_pk_fma_f32 v[146:147], v[146:147], v[14:15], v[82:83] op_sel_hi:[1,0,1]
v_mov_b32_dpp v68, v80 quad_perm:[1,0,3,2] row_mask:0xf bank_mask:0xf
v_mov_b32_dpp v69, v81 quad_perm:[1,0,3,2] row_mask:0xf bank_mask:0xf
v_pk_fma_f32 v[80:81], v[80:81], v[14:15], v[68:69] op_sel_hi:[1,0,1]
v_mov_b32_dpp v82, v114 quad_perm:[1,0,3,2] row_mask:0xf bank_mask:0xf
v_mov_b32_dpp v83, v115 quad_perm:[1,0,3,2] row_mask:0xf bank_mask:0xf
v_pk_fma_f32 v[114:115], v[114:115], v[14:15], v[82:83] op_sel_hi:[1,0,1]
v_mov_b32_dpp v68, v144 quad_perm:[1,0,3,2] row_mask:0xf bank_mask:0xf
v_mov_b32_dpp v69, v145 quad_perm:[1,0,3,2] row_mask:0xf bank_mask:0xf
v_pk_fma_f32 v[144:145], v[144:145], v[14:15], v[68:69] op_sel_hi:[1,0,1]
v_mov_b32_dpp v82, v66 quad_perm:[1,0,3,2] row_mask:0xf bank_mask:0xf
v_mov_b32_dpp v83, v67 quad_perm:[1,0,3,2] row_mask:0xf bank_mask:0xf
v_pk_fma_f32 v[66:67], v[66:67], v[14:15], v[82:83] op_sel_hi:[1,0,1]
v_mov_b32_dpp v68, v112 quad_perm:[1,0,3,2] row_mask:0xf bank_mask:0xf
v_mov_b32_dpp v69, v113 quad_perm:[1,0,3,2] row_mask:0xf bank_mask:0xf
v_pk_fma_f32 v[112:113], v[112:113], v[14:15], v[68:69] op_sel_hi:[1,0,1]
v_mov_b32_dpp v82, v130 quad_perm:[1,0,3,2] row_mask:0xf bank_mask:0xf
v_mov_b32_dpp v83, v131 quad_perm:[1,0,3,2] row_mask:0xf bank_mask:0xf
v_pk_fma_f32 v[130:131], v[130:131], v[14:15], v[82:83] op_sel_hi:[1,0,1]
v_mov_b32_dpp v68, v64 quad_perm:[1,0,3,2] row_mask:0xf bank_mask:0xf
v_mov_b32_dpp v69, v65 quad_perm:[1,0,3,2] row_mask:0xf bank_mask:0xf
v_pk_fma_f32 v[64:65], v[64:65], v[14:15], v[68:69] op_sel_hi:[1,0,1]
v_mov_b32_dpp v82, v74 quad_perm:[1,0,3,2] row_mask:0xf bank_mask:0xf
v_mov_b32_dpp v83, v75 quad_perm:[1,0,3,2] row_mask:0xf bank_mask:0xf
v_pk_fma_f32 v[74:75], v[74:75], v[14:15], v[82:83] op_sel_hi:[1,0,1]
v_mov_b32_dpp v68, v128 quad_perm:[1,0,3,2] row_mask:0xf bank_mask:0xf
v_mov_b32_dpp v69, v129 quad_perm:[1,0,3,2] row_mask:0xf bank_mask:0xf
v_pk_fma_f32 v[128:129], v[128:129], v[14:15], v[68:69] op_sel_hi:[1,0,1]
v_mov_b32_dpp v82, v42 quad_perm:[1,0,3,2] row_mask:0xf bank_mask:0xf
v_mov_b32_dpp v83, v43 quad_perm:[1,0,3,2] row_mask:0xf bank_mask:0xf
v_pk_fma_f32 v[42:43], v[42:43], v[14:15], v[82:83] op_sel_hi:[1,0,1]
v_mov_b32_dpp v68, v72 quad_perm:[1,0,3,2] row_mask:0xf bank_mask:0xf
v_mov_b32_dpp v69, v73 quad_perm:[1,0,3,2] row_mask:0xf bank_mask:0xf
v_pk_fma_f32 v[72:73], v[72:73], v[14:15], v[68:69] op_sel_hi:[1,0,1]
v_mov_b32_dpp v82, v106 quad_perm:[1,0,3,2] row_mask:0xf bank_mask:0xf
v_mov_b32_dpp v83, v107 quad_perm:[1,0,3,2] row_mask:0xf bank_mask:0xf
v_pk_fma_f32 v[106:107], v[106:107], v[14:15], v[82:83] op_sel_hi:[1,0,1]
v_mov_b32_dpp v68, v40 quad_perm:[1,0,3,2] row_mask:0xf bank_mask:0xf
v_mov_b32_dpp v69, v41 quad_perm:[1,0,3,2] row_mask:0xf bank_mask:0xf
v_pk_fma_f32 v[40:41], v[40:41], v[14:15], v[68:69] op_sel_hi:[1,0,1]
v_mov_b32_dpp v82, v138 quad_perm:[1,0,3,2] row_mask:0xf bank_mask:0xf
v_mov_b32_dpp v83, v139 quad_perm:[1,0,3,2] row_mask:0xf bank_mask:0xf
v_pk_fma_f32 v[138:139], v[138:139], v[14:15], v[82:83] op_sel_hi:[1,0,1]
v_mov_b32_dpp v68, v104 quad_perm:[1,0,3,2] row_mask:0xf bank_mask:0xf
v_mov_b32_dpp v69, v105 quad_perm:[1,0,3,2] row_mask:0xf bank_mask:0xf
v_pk_fma_f32 v[104:105], v[104:105], v[14:15], v[68:69] op_sel_hi:[1,0,1]
v_mov_b32_dpp v82, v78 quad_perm:[1,0,3,2] row_mask:0xf bank_mask:0xf
v_mov_b32_dpp v83, v79 quad_perm:[1,0,3,2] row_mask:0xf bank_mask:0xf
v_pk_fma_f32 v[78:79], v[78:79], v[14:15], v[82:83] op_sel_hi:[1,0,1]
v_mov_b32_dpp v68, v136 quad_perm:[1,0,3,2] row_mask:0xf bank_mask:0xf
v_mov_b32_dpp v69, v137 quad_perm:[1,0,3,2] row_mask:0xf bank_mask:0xf
v_pk_fma_f32 v[136:137], v[136:137], v[14:15], v[68:69] op_sel_hi:[1,0,1]
v_mov_b32_dpp v82, v46 quad_perm:[1,0,3,2] row_mask:0xf bank_mask:0xf
v_mov_b32_dpp v83, v47 quad_perm:[1,0,3,2] row_mask:0xf bank_mask:0xf
v_pk_fma_f32 v[46:47], v[46:47], v[14:15], v[82:83] op_sel_hi:[1,0,1]
v_mov_b32_dpp v68, v76 quad_perm:[1,0,3,2] row_mask:0xf bank_mask:0xf
v_mov_b32_dpp v69, v77 quad_perm:[1,0,3,2] row_mask:0xf bank_mask:0xf
v_pk_fma_f32 v[76:77], v[76:77], v[14:15], v[68:69] op_sel_hi:[1,0,1]
v_mov_b32_dpp v82, v110 quad_perm:[1,0,3,2] row_mask:0xf bank_mask:0xf
v_mov_b32_dpp v83, v111 quad_perm:[1,0,3,2] row_mask:0xf bank_mask:0xf
v_pk_fma_f32 v[110:111], v[110:111], v[14:15], v[82:83] op_sel_hi:[1,0,1]
v_mov_b32_dpp v68, v44 quad_perm:[1,0,3,2] row_mask:0xf bank_mask:0xf
v_mov_b32_dpp v69, v45 quad_perm:[1,0,3,2] row_mask:0xf bank_mask:0xf
v_pk_fma_f32 v[44:45], v[44:45], v[14:15], v[68:69] op_sel_hi:[1,0,1]
v_mov_b32_dpp v82, v30 quad_perm:[1,0,3,2] row_mask:0xf bank_mask:0xf
v_mov_b32_dpp v83, v31 quad_perm:[1,0,3,2] row_mask:0xf bank_mask:0xf
v_pk_fma_f32 v[30:31], v[30:31], v[14:15], v[82:83] op_sel_hi:[1,0,1]
v_mov_b32_dpp v68, v108 quad_perm:[1,0,3,2] row_mask:0xf bank_mask:0xf
v_mov_b32_dpp v69, v109 quad_perm:[1,0,3,2] row_mask:0xf bank_mask:0xf
v_pk_fma_f32 v[108:109], v[108:109], v[14:15], v[68:69] op_sel_hi:[1,0,1]
v_mov_b32_dpp v82, v94 quad_perm:[1,0,3,2] row_mask:0xf bank_mask:0xf
v_mov_b32_dpp v83, v95 quad_perm:[1,0,3,2] row_mask:0xf bank_mask:0xf
v_pk_fma_f32 v[94:95], v[94:95], v[14:15], v[82:83] op_sel_hi:[1,0,1]
v_mov_b32_dpp v68, v28 quad_perm:[1,0,3,2] row_mask:0xf bank_mask:0xf
v_mov_b32_dpp v69, v29 quad_perm:[1,0,3,2] row_mask:0xf bank_mask:0xf
v_pk_fma_f32 v[28:29], v[28:29], v[14:15], v[68:69] op_sel_hi:[1,0,1]
v_mov_b32_dpp v82, v62 quad_perm:[1,0,3,2] row_mask:0xf bank_mask:0xf
v_mov_b32_dpp v83, v63 quad_perm:[1,0,3,2] row_mask:0xf bank_mask:0xf
v_pk_fma_f32 v[62:63], v[62:63], v[14:15], v[82:83] op_sel_hi:[1,0,1]
v_mov_b32_dpp v68, v92 quad_perm:[1,0,3,2] row_mask:0xf bank_mask:0xf
v_mov_b32_dpp v69, v93 quad_perm:[1,0,3,2] row_mask:0xf bank_mask:0xf
v_pk_fma_f32 v[92:93], v[92:93], v[14:15], v[68:69] op_sel_hi:[1,0,1]
v_mov_b32_dpp v82, v126 quad_perm:[1,0,3,2] row_mask:0xf bank_mask:0xf
v_mov_b32_dpp v83, v127 quad_perm:[1,0,3,2] row_mask:0xf bank_mask:0xf
v_pk_fma_f32 v[126:127], v[126:127], v[14:15], v[82:83] op_sel_hi:[1,0,1]
v_mov_b32_dpp v68, v60 quad_perm:[1,0,3,2] row_mask:0xf bank_mask:0xf
v_mov_b32_dpp v69, v61 quad_perm:[1,0,3,2] row_mask:0xf bank_mask:0xf
v_pk_fma_f32 v[60:61], v[60:61], v[14:15], v[68:69] op_sel_hi:[1,0,1]
v_mov_b32_dpp v82, v142 quad_perm:[1,0,3,2] row_mask:0xf bank_mask:0xf
v_mov_b32_dpp v83, v143 quad_perm:[1,0,3,2] row_mask:0xf bank_mask:0xf
v_pk_fma_f32 v[142:143], v[142:143], v[14:15], v[82:83] op_sel_hi:[1,0,1]
v_mov_b32_dpp v68, v124 quad_perm:[1,0,3,2] row_mask:0xf bank_mask:0xf
v_mov_b32_dpp v69, v125 quad_perm:[1,0,3,2] row_mask:0xf bank_mask:0xf
v_pk_fma_f32 v[124:125], v[124:125], v[14:15], v[68:69] op_sel_hi:[1,0,1]
v_mov_b32_dpp v82, v50 quad_perm:[1,0,3,2] row_mask:0xf bank_mask:0xf
v_mov_b32_dpp v83, v51 quad_perm:[1,0,3,2] row_mask:0xf bank_mask:0xf
v_pk_fma_f32 v[50:51], v[50:51], v[14:15], v[82:83] op_sel_hi:[1,0,1]
v_mov_b32_dpp v68, v140 quad_perm:[1,0,3,2] row_mask:0xf bank_mask:0xf
v_mov_b32_dpp v69, v141 quad_perm:[1,0,3,2] row_mask:0xf bank_mask:0xf
v_pk_fma_f32 v[140:141], v[140:141], v[14:15], v[68:69] op_sel_hi:[1,0,1]
v_mov_b32_dpp v82, v34 quad_perm:[1,0,3,2] row_mask:0xf bank_mask:0xf
v_mov_b32_dpp v83, v35 quad_perm:[1,0,3,2] row_mask:0xf bank_mask:0xf
v_pk_fma_f32 v[34:35], v[34:35], v[14:15], v[82:83] op_sel_hi:[1,0,1]
v_mov_b32_dpp v68, v48 quad_perm:[1,0,3,2] row_mask:0xf bank_mask:0xf
v_mov_b32_dpp v69, v49 quad_perm:[1,0,3,2] row_mask:0xf bank_mask:0xf
v_pk_fma_f32 v[48:49], v[48:49], v[14:15], v[68:69] op_sel_hi:[1,0,1]
v_mov_b32_dpp v82, v98 quad_perm:[1,0,3,2] row_mask:0xf bank_mask:0xf
v_mov_b32_dpp v83, v99 quad_perm:[1,0,3,2] row_mask:0xf bank_mask:0xf
v_pk_fma_f32 v[98:99], v[98:99], v[14:15], v[82:83] op_sel_hi:[1,0,1]
v_mov_b32_dpp v68, v32 quad_perm:[1,0,3,2] row_mask:0xf bank_mask:0xf
v_mov_b32_dpp v69, v33 quad_perm:[1,0,3,2] row_mask:0xf bank_mask:0xf
v_pk_fma_f32 v[32:33], v[32:33], v[14:15], v[68:69] op_sel_hi:[1,0,1]
v_mov_b32_dpp v82, v26 quad_perm:[1,0,3,2] row_mask:0xf bank_mask:0xf
v_mov_b32_dpp v83, v27 quad_perm:[1,0,3,2] row_mask:0xf bank_mask:0xf
v_pk_fma_f32 v[26:27], v[26:27], v[14:15], v[82:83] op_sel_hi:[1,0,1]
v_mov_b32_dpp v68, v96 quad_perm:[1,0,3,2] row_mask:0xf bank_mask:0xf
v_mov_b32_dpp v69, v97 quad_perm:[1,0,3,2] row_mask:0xf bank_mask:0xf
v_pk_fma_f32 v[96:97], v[96:97], v[14:15], v[68:69] op_sel_hi:[1,0,1]
v_mov_b32_dpp v82, v90 quad_perm:[1,0,3,2] row_mask:0xf bank_mask:0xf
v_mov_b32_dpp v83, v91 quad_perm:[1,0,3,2] row_mask:0xf bank_mask:0xf
v_pk_fma_f32 v[90:91], v[90:91], v[14:15], v[82:83] op_sel_hi:[1,0,1]
v_mov_b32_dpp v68, v24 quad_perm:[1,0,3,2] row_mask:0xf bank_mask:0xf
v_mov_b32_dpp v69, v25 quad_perm:[1,0,3,2] row_mask:0xf bank_mask:0xf
v_pk_fma_f32 v[24:25], v[24:25], v[14:15], v[68:69] op_sel_hi:[1,0,1]
v_mov_b32_dpp v82, v58 quad_perm:[1,0,3,2] row_mask:0xf bank_mask:0xf
v_mov_b32_dpp v83, v59 quad_perm:[1,0,3,2] row_mask:0xf bank_mask:0xf
v_pk_fma_f32 v[58:59], v[58:59], v[14:15], v[82:83] op_sel_hi:[1,0,1]
v_mov_b32_dpp v68, v88 quad_perm:[1,0,3,2] row_mask:0xf bank_mask:0xf
v_mov_b32_dpp v69, v89 quad_perm:[1,0,3,2] row_mask:0xf bank_mask:0xf
v_pk_fma_f32 v[88:89], v[88:89], v[14:15], v[68:69] op_sel_hi:[1,0,1]
v_mov_b32_dpp v82, v122 quad_perm:[1,0,3,2] row_mask:0xf bank_mask:0xf
v_mov_b32_dpp v83, v123 quad_perm:[1,0,3,2] row_mask:0xf bank_mask:0xf
v_pk_fma_f32 v[122:123], v[122:123], v[14:15], v[82:83] op_sel_hi:[1,0,1]
v_mov_b32_dpp v68, v56 quad_perm:[1,0,3,2] row_mask:0xf bank_mask:0xf
v_mov_b32_dpp v69, v57 quad_perm:[1,0,3,2] row_mask:0xf bank_mask:0xf
v_pk_fma_f32 v[56:57], v[56:57], v[14:15], v[68:69] op_sel_hi:[1,0,1]
v_mov_b32_dpp v82, v22 quad_perm:[1,0,3,2] row_mask:0xf bank_mask:0xf
v_mov_b32_dpp v83, v23 quad_perm:[1,0,3,2] row_mask:0xf bank_mask:0xf
v_pk_fma_f32 v[22:23], v[22:23], v[14:15], v[82:83] op_sel_hi:[1,0,1]
v_mov_b32_dpp v68, v120 quad_perm:[1,0,3,2] row_mask:0xf bank_mask:0xf
v_mov_b32_dpp v69, v121 quad_perm:[1,0,3,2] row_mask:0xf bank_mask:0xf
v_pk_fma_f32 v[120:121], v[120:121], v[14:15], v[68:69] op_sel_hi:[1,0,1]
v_mov_b32_dpp v82, v86 quad_perm:[1,0,3,2] row_mask:0xf bank_mask:0xf
v_mov_b32_dpp v83, v87 quad_perm:[1,0,3,2] row_mask:0xf bank_mask:0xf
v_pk_fma_f32 v[86:87], v[86:87], v[14:15], v[82:83] op_sel_hi:[1,0,1]
v_mov_b32_dpp v68, v20 quad_perm:[1,0,3,2] row_mask:0xf bank_mask:0xf
v_mov_b32_dpp v69, v21 quad_perm:[1,0,3,2] row_mask:0xf bank_mask:0xf
v_pk_fma_f32 v[20:21], v[20:21], v[14:15], v[68:69] op_sel_hi:[1,0,1]
v_mov_b32_dpp v82, v54 quad_perm:[1,0,3,2] row_mask:0xf bank_mask:0xf
v_mov_b32_dpp v83, v55 quad_perm:[1,0,3,2] row_mask:0xf bank_mask:0xf
v_pk_fma_f32 v[54:55], v[54:55], v[14:15], v[82:83] op_sel_hi:[1,0,1]
v_mov_b32_dpp v68, v84 quad_perm:[1,0,3,2] row_mask:0xf bank_mask:0xf
v_mov_b32_dpp v69, v85 quad_perm:[1,0,3,2] row_mask:0xf bank_mask:0xf
v_pk_fma_f32 v[84:85], v[84:85], v[14:15], v[68:69] op_sel_hi:[1,0,1]
v_mov_b32_dpp v82, v118 quad_perm:[1,0,3,2] row_mask:0xf bank_mask:0xf
v_mov_b32_dpp v83, v119 quad_perm:[1,0,3,2] row_mask:0xf bank_mask:0xf
v_pk_fma_f32 v[118:119], v[118:119], v[14:15], v[82:83] op_sel_hi:[1,0,1]
v_mov_b32_dpp v68, v52 quad_perm:[1,0,3,2] row_mask:0xf bank_mask:0xf
v_mov_b32_dpp v69, v53 quad_perm:[1,0,3,2] row_mask:0xf bank_mask:0xf
v_pk_fma_f32 v[52:53], v[52:53], v[14:15], v[68:69] op_sel_hi:[1,0,1]
v_mov_b32_dpp v82, v38 quad_perm:[1,0,3,2] row_mask:0xf bank_mask:0xf
v_mov_b32_dpp v83, v39 quad_perm:[1,0,3,2] row_mask:0xf bank_mask:0xf
v_pk_fma_f32 v[38:39], v[38:39], v[14:15], v[82:83] op_sel_hi:[1,0,1]
v_mov_b32_dpp v68, v116 quad_perm:[1,0,3,2] row_mask:0xf bank_mask:0xf
v_mov_b32_dpp v69, v117 quad_perm:[1,0,3,2] row_mask:0xf bank_mask:0xf
v_pk_fma_f32 v[116:117], v[116:117], v[14:15], v[68:69] op_sel_hi:[1,0,1]
v_mov_b32_dpp v82, v102 quad_perm:[1,0,3,2] row_mask:0xf bank_mask:0xf
v_mov_b32_dpp v83, v103 quad_perm:[1,0,3,2] row_mask:0xf bank_mask:0xf
v_pk_fma_f32 v[102:103], v[102:103], v[14:15], v[82:83] op_sel_hi:[1,0,1]
v_mov_b32_dpp v68, v36 quad_perm:[1,0,3,2] row_mask:0xf bank_mask:0xf
v_mov_b32_dpp v69, v37 quad_perm:[1,0,3,2] row_mask:0xf bank_mask:0xf
v_pk_fma_f32 v[36:37], v[36:37], v[14:15], v[68:69] op_sel_hi:[1,0,1]
v_mov_b32_dpp v82, v70 quad_perm:[1,0,3,2] row_mask:0xf bank_mask:0xf
v_mov_b32_dpp v83, v71 quad_perm:[1,0,3,2] row_mask:0xf bank_mask:0xf
v_pk_fma_f32 v[70:71], v[70:71], v[14:15], v[82:83] op_sel_hi:[1,0,1]
v_mov_b32_dpp v68, v100 quad_perm:[1,0,3,2] row_mask:0xf bank_mask:0xf
v_mov_b32_dpp v69, v101 quad_perm:[1,0,3,2] row_mask:0xf bank_mask:0xf
v_pk_fma_f32 v[100:101], v[100:101], v[14:15], v[68:69] op_sel_hi:[1,0,1]
v_mov_b32_dpp v82, v134 quad_perm:[1,0,3,2] row_mask:0xf bank_mask:0xf
v_mov_b32_dpp v83, v135 quad_perm:[1,0,3,2] row_mask:0xf bank_mask:0xf
v_pk_fma_f32 v[134:135], v[134:135], v[14:15], v[82:83] op_sel_hi:[1,0,1]
v_mul_f32 v151, 0x3c800000, v9
v_cos_f32 v150, v151
v_sin_f32 v151, v151
v_mul_f32 v149, 0x3d000000, v9
v_cos_f32 v148, v149
v_sin_f32 v149, v149
v_pk_mul_f32 v[68:69], v[16:17], v[150:151] op_sel_hi:[1,0]
v_pk_fma_f32 v[68:69], v[146:147], v[150:151], v[68:69] op_sel:[0,1,0] neg_lo:[1,0,0] neg_hi:[1,0,0]
v_pk_mul_f32 v[146:147], v[146:147], v[150:151] op_sel_hi:[1,0]
v_pk_fma_f32 v[146:147], v[16:17], v[150:151], v[146:147] op_sel:[0,1,0]
v_mul_f32 v151, 0x3d400000, v9
v_cos_f32 v150, v151
v_sin_f32 v151, v151
v_pk_mul_f32 v[16:17], v[80:81], v[148:149] op_sel_hi:[1,0]
v_pk_fma_f32 v[16:17], v[114:115], v[148:149], v[16:17] op_sel:[0,1,0] neg_lo:[1,0,0] neg_hi:[1,0,0]
v_pk_mul_f32 v[114:115], v[114:115], v[148:149] op_sel_hi:[1,0]
v_pk_fma_f32 v[114:115], v[80:81], v[148:149], v[114:115] op_sel:[0,1,0]
v_mul_f32 v149, 0x3d800000, v9
v_cos_f32 v148, v149
v_sin_f32 v149, v149
v_pk_mul_f32 v[80:81], v[144:145], v[150:151] op_sel_hi:[1,0]
v_pk_fma_f32 v[80:81], v[66:67], v[150:151], v[80:81] op_sel:[0,1,0] neg_lo:[1,0,0] neg_hi:[1,0,0]
v_pk_mul_f32 v[66:67], v[66:67], v[150:151] op_sel_hi:[1,0]
v_pk_fma_f32 v[66:67], v[144:145], v[150:151], v[66:67] op_sel:[0,1,0]
v_mul_f32 v151, 0x3da00000, v9
v_cos_f32 v150, v151
v_sin_f32 v151, v151
v_pk_mul_f32 v[144:145], v[112:113], v[148:149] op_sel_hi:[1,0]
v_pk_fma_f32 v[144:145], v[130:131], v[148:149], v[144:145] op_sel:[0,1,0] neg_lo:[1,0,0] neg_hi:[1,0,0]
v_pk_mul_f32 v[130:131], v[130:131], v[148:149] op_sel_hi:[1,0]
v_pk_fma_f32 v[130:131], v[112:113], v[148:149], v[130:131] op_sel:[0,1,0]
v_mul_f32 v149, 0x3dc00000, v9
v_cos_f32 v148, v149
v_sin_f32 v149, v149
v_pk_mul_f32 v[112:113], v[64:65], v[150:151] op_sel_hi:[1,0]
v_pk_fma_f32 v[112:113], v[74:75], v[150:151], v[112:113] op_sel:[0,1,0] neg_lo:[1,0,0] neg_hi:[1,0,0]
v_pk_mul_f32 v[74:75], v[74:75], v[150:151] op_sel_hi:[1,0]
v_pk_fma_f32 v[74:75], v[64:65], v[150:151], v[74:75] op_sel:[0,1,0]
v_mul_f32 v151, 0x3de00000, v9
v_cos_f32 v150, v151
v_sin_f32 v151, v151
v_pk_mul_f32 v[64:65], v[128:129], v[148:149] op_sel_hi:[1,0]
v_pk_fma_f32 v[64:65], v[42:43], v[148:149], v[64:65] op_sel:[0,1,0] neg_lo:[1,0,0] neg_hi:[1,0,0]
v_pk_mul_f32 v[42:43], v[42:43], v[148:149] op_sel_hi:[1,0]
v_pk_fma_f32 v[42:43], v[128:129], v[148:149], v[42:43] op_sel:[0,1,0]
v_mul_f32 v149, 0x3e000000, v9
v_cos_f32 v148, v149
v_sin_f32 v149, v149
v_pk_mul_f32 v[128:129], v[72:73], v[150:151] op_sel_hi:[1,0]
v_pk_fma_f32 v[128:129], v[106:107], v[150:151], v[128:129] op_sel:[0,1,0] neg_lo:[1,0,0] neg_hi:[1,0,0]
v_pk_mul_f32 v[106:107], v[106:107], v[150:151] op_sel_hi:[1,0]
v_pk_fma_f32 v[106:107], v[72:73], v[150:151], v[106:107] op_sel:[0,1,0]
v_mul_f32 v151, 0x3e100000, v9
v_cos_f32 v150, v151
v_sin_f32 v151, v151
v_pk_mul_f32 v[72:73], v[40:41], v[148:149] op_sel_hi:[1,0]
v_pk_fma_f32 v[72:73], v[138:139], v[148:149], v[72:73] op_sel:[0,1,0] neg_lo:[1,0,0] neg_hi:[1,0,0]
v_pk_mul_f32 v[138:139], v[138:139], v[148:149] op_sel_hi:[1,0]
v_pk_fma_f32 v[138:139], v[40:41], v[148:149], v[138:139] op_sel:[0,1,0]
v_mul_f32 v149, 0x3e200000, v9
v_cos_f32 v148, v149
v_sin_f32 v149, v149
v_pk_mul_f32 v[40:41], v[104:105], v[150:151] op_sel_hi:[1,0]
v_pk_fma_f32 v[40:41], v[78:79], v[150:151], v[40:41] op_sel:[0,1,0] neg_lo:[1,0,0] neg_hi:[1,0,0]
v_pk_mul_f32 v[78:79], v[78:79], v[150:151] op_sel_hi:[1,0]
v_pk_fma_f32 v[78:79], v[104:105], v[150:151], v[78:79] op_sel:[0,1,0]
v_mul_f32 v151, 0x3e300000, v9
v_cos_f32 v150, v151
v_sin_f32 v151, v151
v_pk_mul_f32 v[104:105], v[136:137], v[148:149] op_sel_hi:[1,0]
v_pk_fma_f32 v[104:105], v[46:47], v[148:149], v[104:105] op_sel:[0,1,0] neg_lo:[1,0,0] neg_hi:[1,0,0]
v_pk_mul_f32 v[46:47], v[46:47], v[148:149] op_sel_hi:[1,0]
v_pk_fma_f32 v[46:47], v[136:137], v[148:149], v[46:47] op_sel:[0,1,0]
v_mul_f32 v149, 0x3e400000, v9
v_cos_f32 v148, v149
v_sin_f32 v149, v149
v_pk_mul_f32 v[136:137], v[76:77], v[150:151] op_sel_hi:[1,0]
v_pk_fma_f32 v[136:137], v[110:111], v[150:151], v[136:137] op_sel:[0,1,0] neg_lo:[1,0,0] neg_hi:[1,0,0]
v_pk_mul_f32 v[110:111], v[110:111], v[150:151] op_sel_hi:[1,0]
v_pk_fma_f32 v[110:111], v[76:77], v[150:151], v[110:111] op_sel:[0,1,0]
v_mul_f32 v151, 0x3e500000, v9
v_cos_f32 v150, v151
v_sin_f32 v151, v151
v_pk_mul_f32 v[76:77], v[44:45], v[148:149] op_sel_hi:[1,0]
v_pk_fma_f32 v[76:77], v[30:31], v[148:149], v[76:77] op_sel:[0,1,0] neg_lo:[1,0,0] neg_hi:[1,0,0]
v_pk_mul_f32 v[30:31], v[30:31], v[148:149] op_sel_hi:[1,0]
v_pk_fma_f32 v[30:31], v[44:45], v[148:149], v[30:31] op_sel:[0,1,0]
v_mul_f32 v149, 0x3e600000, v9
v_cos_f32 v148, v149
v_sin_f32 v149, v149
v_pk_mul_f32 v[44:45], v[108:109], v[150:151] op_sel_hi:[1,0]
v_pk_fma_f32 v[44:45], v[94:95], v[150:151], v[44:45] op_sel:[0,1,0] neg_lo:[1,0,0] neg_hi:[1,0,0]
v_pk_mul_f32 v[94:95], v[94:95], v[150:151] op_sel_hi:[1,0]
v_pk_fma_f32 v[94:95], v[108:109], v[150:151], v[94:95] op_sel:[0,1,0]
v_mul_f32 v151, 0x3e700000, v9
v_cos_f32 v150, v151
v_sin_f32 v151, v151
v_pk_mul_f32 v[108:109], v[28:29], v[148:149] op_sel_hi:[1,0]
v_pk_fma_f32 v[108:109], v[62:63], v[148:149], v[108:109] op_sel:[0,1,0] neg_lo:[1,0,0] neg_hi:[1,0,0]
v_pk_mul_f32 v[62:63], v[62:63], v[148:149] op_sel_hi:[1,0]
v_pk_fma_f32 v[62:63], v[28:29], v[148:149], v[62:63] op_sel:[0,1,0]
v_mul_f32 v149, 0x3e800000, v9
v_cos_f32 v148, v149
v_sin_f32 v149, v149
v_pk_mul_f32 v[28:29], v[92:93], v[150:151] op_sel_hi:[1,0]
v_pk_fma_f32 v[28:29], v[126:127], v[150:151], v[28:29] op_sel:[0,1,0] neg_lo:[1,0,0] neg_hi:[1,0,0]
v_pk_mul_f32 v[126:127], v[126:127], v[150:151] op_sel_hi:[1,0]
v_pk_fma_f32 v[126:127], v[92:93], v[150:151], v[126:127] op_sel:[0,1,0]
v_mul_f32 v151, 0x3e880000, v9
v_cos_f32 v150, v151
v_sin_f32 v151, v151
v_pk_mul_f32 v[92:93], v[60:61], v[148:149] op_sel_hi:[1,0]
v_pk_fma_f32 v[92:93], v[142:143], v[148:149], v[92:93] op_sel:[0,1,0] neg_lo:[1,0,0] neg_hi:[1,0,0]
v_pk_mul_f32 v[142:143], v[142:143], v[148:149] op_sel_hi:[1,0]
v_pk_fma_f32 v[142:143], v[60:61], v[148:149], v[142:143] op_sel:[0,1,0]
v_mul_f32 v149, 0x3e900000, v9
v_cos_f32 v148, v149
v_sin_f32 v149, v149
v_pk_mul_f32 v[60:61], v[124:125], v[150:151] op_sel_hi:[1,0]
v_pk_fma_f32 v[60:61], v[50:51], v[150:151], v[60:61] op_sel:[0,1,0] neg_lo:[1,0,0] neg_hi:[1,0,0]
v_pk_mul_f32 v[50:51], v[50:51], v[150:151] op_sel_hi:[1,0]
v_pk_fma_f32 v[50:51], v[124:125], v[150:151], v[50:51] op_sel:[0,1,0]
v_mul_f32 v151, 0x3e980000, v9
v_cos_f32 v150, v151
v_sin_f32 v151, v151
v_pk_mul_f32 v[124:125], v[140:141], v[148:149] op_sel_hi:[1,0]
v_pk_fma_f32 v[124:125], v[34:35], v[148:149], v[124:125] op_sel:[0,1,0] neg_lo:[1,0,0] neg_hi:[1,0,0]
v_pk_mul_f32 v[34:35], v[34:35], v[148:149] op_sel_hi:[1,0]
v_pk_fma_f32 v[34:35], v[140:141], v[148:149], v[34:35] op_sel:[0,1,0]
v_mul_f32 v149, 0x3ea00000, v9
v_cos_f32 v148, v149
v_sin_f32 v149, v149
v_pk_mul_f32 v[140:141], v[48:49], v[150:151] op_sel_hi:[1,0]
v_pk_fma_f32 v[140:141], v[98:99], v[150:151], v[140:141] op_sel:[0,1,0] neg_lo:[1,0,0] neg_hi:[1,0,0]
v_pk_mul_f32 v[98:99], v[98:99], v[150:151] op_sel_hi:[1,0]
v_pk_fma_f32 v[98:99], v[48:49], v[150:151], v[98:99] op_sel:[0,1,0]
v_mul_f32 v151, 0x3ea80000, v9
v_cos_f32 v150, v151
v_sin_f32 v151, v151
v_pk_mul_f32 v[48:49], v[32:33], v[148:149] op_sel_hi:[1,0]
v_pk_fma_f32 v[48:49], v[26:27], v[148:149], v[48:49] op_sel:[0,1,0] neg_lo:[1,0,0] neg_hi:[1,0,0]
v_pk_mul_f32 v[26:27], v[26:27], v[148:149] op_sel_hi:[1,0]
v_pk_fma_f32 v[26:27], v[32:33], v[148:149], v[26:27] op_sel:[0,1,0]
v_mul_f32 v149, 0x3eb00000, v9
v_cos_f32 v148, v149
v_sin_f32 v149, v149
v_pk_mul_f32 v[32:33], v[96:97], v[150:151] op_sel_hi:[1,0]
v_pk_fma_f32 v[32:33], v[90:91], v[150:151], v[32:33] op_sel:[0,1,0] neg_lo:[1,0,0] neg_hi:[1,0,0]
v_pk_mul_f32 v[90:91], v[90:91], v[150:151] op_sel_hi:[1,0]
v_pk_fma_f32 v[90:91], v[96:97], v[150:151], v[90:91] op_sel:[0,1,0]
v_mul_f32 v151, 0x3eb80000, v9
v_cos_f32 v150, v151
v_sin_f32 v151, v151
v_pk_mul_f32 v[96:97], v[24:25], v[148:149] op_sel_hi:[1,0]
v_pk_fma_f32 v[96:97], v[58:59], v[148:149], v[96:97] op_sel:[0,1,0] neg_lo:[1,0,0] neg_hi:[1,0,0]
v_pk_mul_f32 v[58:59], v[58:59], v[148:149] op_sel_hi:[1,0]
v_pk_fma_f32 v[58:59], v[24:25], v[148:149], v[58:59] op_sel:[0,1,0]
v_mul_f32 v149, 0x3ec00000, v9
v_cos_f32 v148, v149
v_sin_f32 v149, v149
v_pk_mul_f32 v[24:25], v[88:89], v[150:151] op_sel_hi:[1,0]
v_pk_fma_f32 v[24:25], v[122:123], v[150:151], v[24:25] op_sel:[0,1,0] neg_lo:[1,0,0] neg_hi:[1,0,0]
v_pk_mul_f32 v[122:123], v[122:123], v[150:151] op_sel_hi:[1,0]
v_pk_fma_f32 v[122:123], v[88:89], v[150:151], v[122:123] op_sel:[0,1,0]
v_mul_f32 v151, 0x3ec80000, v9
v_cos_f32 v150, v151
v_sin_f32 v151, v151
v_pk_mul_f32 v[88:89], v[56:57], v[148:149] op_sel_hi:[1,0]
v_pk_fma_f32 v[88:89], v[22:23], v[148:149], v[88:89] op_sel:[0,1,0] neg_lo:[1,0,0] neg_hi:[1,0,0]
v_pk_mul_f32 v[22:23], v[22:23], v[148:149] op_sel_hi:[1,0]
v_pk_fma_f32 v[22:23], v[56:57], v[148:149], v[22:23] op_sel:[0,1,0]
v_mul_f32 v149, 0x3ed00000, v9
v_cos_f32 v148, v149
v_sin_f32 v149, v149
v_pk_mul_f32 v[56:57], v[120:121], v[150:151] op_sel_hi:[1,0]
v_pk_fma_f32 v[56:57], v[86:87], v[150:151], v[56:57] op_sel:[0,1,0] neg_lo:[1,0,0] neg_hi:[1,0,0]
v_pk_mul_f32 v[86:87], v[86:87], v[150:151] op_sel_hi:[1,0]
v_pk_fma_f32 v[86:87], v[120:121], v[150:151], v[86:87] op_sel:[0,1,0]
v_mul_f32 v151, 0x3ed80000, v9
v_cos_f32 v150, v151
v_sin_f32 v151, v151
v_pk_mul_f32 v[120:121], v[20:21], v[148:149] op_sel_hi:[1,0]
v_pk_fma_f32 v[120:121], v[54:55], v[148:149], v[120:121] op_sel:[0,1,0] neg_lo:[1,0,0] neg_hi:[1,0,0]
v_pk_mul_f32 v[54:55], v[54:55], v[148:149] op_sel_hi:[1,0]
v_pk_fma_f32 v[54:55], v[20:21], v[148:149], v[54:55] op_sel:[0,1,0]
v_mul_f32 v149, 0x3ee00000, v9
v_cos_f32 v148, v149
v_sin_f32 v149, v149
v_pk_mul_f32 v[20:21], v[84:85], v[150:151] op_sel_hi:[1,0]
v_pk_fma_f32 v[20:21], v[118:119], v[150:151], v[20:21] op_sel:[0,1,0] neg_lo:[1,0,0] neg_hi:[1,0,0]
v_pk_mul_f32 v[118:119], v[118:119], v[150:151] op_sel_hi:[1,0]
v_pk_fma_f32 v[118:119], v[84:85], v[150:151], v[118:119] op_sel:[0,1,0]
v_mul_f32 v151, 0x3ee80000, v9
v_cos_f32 v150, v151
v_sin_f32 v151, v151
v_pk_mul_f32 v[84:85], v[52:53], v[148:149] op_sel_hi:[1,0]
v_pk_fma_f32 v[84:85], v[38:39], v[148:149], v[84:85] op_sel:[0,1,0] neg_lo:[1,0,0] neg_hi:[1,0,0]
v_pk_mul_f32 v[38:39], v[38:39], v[148:149] op_sel_hi:[1,0]
v_pk_fma_f32 v[38:39], v[52:53], v[148:149], v[38:39] op_sel:[0,1,0]
v_mul_f32 v149, 0x3ef00000, v9
v_cos_f32 v148, v149
v_sin_f32 v149, v149
v_pk_mul_f32 v[52:53], v[116:117], v[150:151] op_sel_hi:[1,0]
v_pk_fma_f32 v[52:53], v[102:103], v[150:151], v[52:53] op_sel:[0,1,0] neg_lo:[1,0,0] neg_hi:[1,0,0]
v_pk_mul_f32 v[102:103], v[102:103], v[150:151] op_sel_hi:[1,0]
v_pk_fma_f32 v[102:103], v[116:117], v[150:151], v[102:103] op_sel:[0,1,0]
v_mul_f32 v151, 0x3ef80000, v9
v_cos_f32 v150, v151
v_sin_f32 v151, v151
v_pk_mul_f32 v[116:117], v[36:37], v[148:149] op_sel_hi:[1,0]
v_pk_fma_f32 v[116:117], v[70:71], v[148:149], v[116:117] op_sel:[0,1,0] neg_lo:[1,0,0] neg_hi:[1,0,0]
v_pk_mul_f32 v[70:71], v[70:71], v[148:149] op_sel_hi:[1,0]
v_pk_fma_f32 v[70:71], v[36:37], v[148:149], v[70:71] op_sel:[0,1,0]
s_nop 0
v_pk_mul_f32 v[36:37], v[100:101], v[150:151] op_sel_hi:[1,0]
v_pk_fma_f32 v[36:37], v[134:135], v[150:151], v[36:37] op_sel:[0,1,0] neg_lo:[1,0,0] neg_hi:[1,0,0]
v_pk_mul_f32 v[134:135], v[134:135], v[150:151] op_sel_hi:[1,0]
v_pk_fma_f32 v[134:135], v[100:101], v[150:151], v[134:135] op_sel:[0,1,0]
v_pk_add_f32 v[100:101], v[132:133], v[92:93] neg_lo:[0,1] neg_hi:[0,1]
v_pk_add_f32 v[82:83], v[18:19], v[142:143] neg_lo:[0,1] neg_hi:[0,1]
v_pk_add_f32 v[132:133], v[132:133], v[92:93]
v_pk_add_f32 v[18:19], v[18:19], v[142:143]
v_pk_add_f32 v[92:93], v[68:69], v[60:61] neg_lo:[0,1] neg_hi:[0,1]
v_pk_add_f32 v[142:143], v[146:147], v[50:51] neg_lo:[0,1] neg_hi:[0,1]
v_pk_add_f32 v[68:69], v[68:69], v[60:61]
v_pk_add_f32 v[146:147], v[146:147], v[50:51]
v_pk_mul_f32 v[60:61], v[92:93], s[30:31] op_sel_hi:[1,0]
v_pk_mul_f32 v[50:51], v[92:93], s[36:37] op_sel_hi:[1,0]
v_pk_fma_f32 v[60:61], v[142:143], s[36:37], v[60:61] op_sel_hi:[1,0,1] neg_lo:[0,1,0] neg_hi:[0,1,0]
v_pk_fma_f32 v[50:51], v[142:143], s[30:31], v[50:51] op_sel_hi:[1,0,1]
v_pk_add_f32 v[92:93], v[16:17], v[124:125] neg_lo:[0,1] neg_hi:[0,1]
v_pk_add_f32 v[142:143], v[114:115], v[34:35] neg_lo:[0,1] neg_hi:[0,1]
v_pk_add_f32 v[16:17], v[16:17], v[124:125]
v_pk_add_f32 v[114:115], v[114:115], v[34:35]
v_pk_mul_f32 v[124:125], v[92:93], s[30:31] op_sel:[0,1]
v_pk_mul_f32 v[34:35], v[92:93], s[34:35] op_sel:[0,1]
v_pk_fma_f32 v[124:125], v[142:143], s[34:35], v[124:125] op_sel:[0,1,0] neg_lo:[0,1,0] neg_hi:[0,1,0]
v_pk_fma_f32 v[34:35], v[142:143], s[30:31], v[34:35] op_sel:[0,1,0]
v_pk_add_f32 v[92:93], v[80:81], v[140:141] neg_lo:[0,1] neg_hi:[0,1]
v_pk_add_f32 v[142:143], v[66:67], v[98:99] neg_lo:[0,1] neg_hi:[0,1]
v_pk_add_f32 v[80:81], v[80:81], v[140:141]
v_pk_add_f32 v[66:67], v[66:67], v[98:99]
v_pk_mul_f32 v[140:141], v[92:93], s[32:33] op_sel_hi:[1,0]
v_pk_mul_f32 v[98:99], v[92:93], s[34:35] op_sel_hi:[1,0]
v_pk_fma_f32 v[140:141], v[142:143], s[34:35], v[140:141] op_sel_hi:[1,0,1] neg_lo:[0,1,0] neg_hi:[0,1,0]
v_pk_fma_f32 v[98:99], v[142:143], s[32:33], v[98:99] op_sel_hi:[1,0,1]
v_pk_add_f32 v[92:93], v[144:145], v[48:49] neg_lo:[0,1] neg_hi:[0,1]
v_pk_add_f32 v[142:143], v[130:131], v[26:27] neg_lo:[0,1] neg_hi:[0,1]
v_pk_add_f32 v[144:145], v[144:145], v[48:49]
v_pk_add_f32 v[130:131], v[130:131], v[26:27]
v_pk_mul_f32 v[48:49], v[92:93], s[32:33] op_sel:[0,1]
v_pk_mul_f32 v[26:27], v[92:93], s[32:33] op_sel:[0,1]
v_pk_fma_f32 v[48:49], v[142:143], s[32:33], v[48:49] op_sel:[0,1,0] neg_lo:[0,1,0] neg_hi:[0,1,0]
v_pk_fma_f32 v[26:27], v[142:143], s[32:33], v[26:27] op_sel:[0,1,0]
v_pk_add_f32 v[92:93], v[112:113], v[32:33] neg_lo:[0,1] neg_hi:[0,1]
v_pk_add_f32 v[142:143], v[74:75], v[90:91] neg_lo:[0,1] neg_hi:[0,1]
v_pk_add_f32 v[112:113], v[112:113], v[32:33]
v_pk_add_f32 v[74:75], v[74:75], v[90:91]
v_pk_mul_f32 v[32:33], v[92:93], s[34:35] op_sel_hi:[1,0]
v_pk_mul_f32 v[90:91], v[92:93], s[32:33] op_sel_hi:[1,0]
v_pk_fma_f32 v[32:33], v[142:143], s[32:33], v[32:33] op_sel_hi:[1,0,1] neg_lo:[0,1,0] neg_hi:[0,1,0]
v_pk_fma_f32 v[90:91], v[142:143], s[34:35], v[90:91] op_sel_hi:[1,0,1]
v_pk_add_f32 v[92:93], v[64:65], v[96:97] neg_lo:[0,1] neg_hi:[0,1]
v_pk_add_f32 v[142:143], v[42:43], v[58:59] neg_lo:[0,1] neg_hi:[0,1]
v_pk_add_f32 v[64:65], v[64:65], v[96:97]
v_pk_add_f32 v[42:43], v[42:43], v[58:59]
v_pk_mul_f32 v[96:97], v[92:93], s[34:35] op_sel:[0,1]
v_pk_mul_f32 v[58:59], v[92:93], s[30:31] op_sel:[0,1]
v_pk_fma_f32 v[96:97], v[142:143], s[30:31], v[96:97] op_sel:[0,1,0] neg_lo:[0,1,0] neg_hi:[0,1,0]
v_pk_fma_f32 v[58:59], v[142:143], s[34:35], v[58:59] op_sel:[0,1,0]
v_pk_add_f32 v[92:93], v[128:129], v[24:25] neg_lo:[0,1] neg_hi:[0,1]
v_pk_add_f32 v[142:143], v[106:107], v[122:123] neg_lo:[0,1] neg_hi:[0,1]
v_pk_add_f32 v[128:129], v[128:129], v[24:25]
v_pk_add_f32 v[106:107], v[106:107], v[122:123]
v_pk_mul_f32 v[24:25], v[92:93], s[36:37] op_sel_hi:[1,0]
v_pk_mul_f32 v[122:123], v[92:93], s[30:31] op_sel_hi:[1,0]
v_pk_fma_f32 v[24:25], v[142:143], s[30:31], v[24:25] op_sel_hi:[1,0,1] neg_lo:[0,1,0] neg_hi:[0,1,0]
v_pk_fma_f32 v[122:123], v[142:143], s[36:37], v[122:123] op_sel_hi:[1,0,1]
v_pk_add_f32 v[92:93], v[22:23], v[138:139] neg_lo:[0,1] neg_hi:[0,1]
v_pk_add_f32 v[142:143], v[72:73], v[88:89] neg_lo:[0,1] neg_hi:[0,1]
v_pk_add_f32 v[72:73], v[72:73], v[88:89]
v_pk_add_f32 v[138:139], v[138:139], v[22:23]
v_pk_add_f32 v[88:89], v[40:41], v[56:57] neg_lo:[0,1] neg_hi:[0,1]
v_pk_add_f32 v[22:23], v[78:79], v[86:87] neg_lo:[0,1] neg_hi:[0,1]
v_pk_add_f32 v[40:41], v[40:41], v[56:57]
v_pk_add_f32 v[78:79], v[78:79], v[86:87]
v_pk_mul_f32 v[56:57], v[88:89], s[36:37] op_sel_hi:[1,0] neg_lo:[0,1] neg_hi:[0,1]
v_pk_mul_f32 v[86:87], v[88:89], s[30:31] op_sel_hi:[1,0]
v_pk_fma_f32 v[56:57], v[22:23], s[30:31], v[56:57] op_sel_hi:[1,0,1] neg_lo:[0,1,0] neg_hi:[0,1,0]
v_pk_fma_f32 v[86:87], v[22:23], s[36:37], v[86:87] op_sel_hi:[1,0,1] neg_lo:[0,1,0] neg_hi:[0,1,0]
v_pk_add_f32 v[88:89], v[104:105], v[120:121] neg_lo:[0,1] neg_hi:[0,1]
v_pk_add_f32 v[22:23], v[46:47], v[54:55] neg_lo:[0,1] neg_hi:[0,1]
v_pk_add_f32 v[104:105], v[104:105], v[120:121]
v_pk_add_f32 v[46:47], v[46:47], v[54:55]
v_pk_mul_f32 v[120:121], v[88:89], s[34:35] op_sel:[0,1] neg_lo:[0,1] neg_hi:[0,1]
v_pk_mul_f32 v[54:55], v[88:89], s[30:31] op_sel:[0,1]
v_pk_fma_f32 v[120:121], v[22:23], s[30:31], v[120:121] op_sel:[0,1,0] neg_lo:[0,1,0] neg_hi:[0,1,0]
v_pk_fma_f32 v[54:55], v[22:23], s[34:35], v[54:55] op_sel:[0,1,0] neg_lo:[0,1,0] neg_hi:[0,1,0]
v_pk_add_f32 v[88:89], v[136:137], v[20:21] neg_lo:[0,1] neg_hi:[0,1]
v_pk_add_f32 v[22:23], v[110:111], v[118:119] neg_lo:[0,1] neg_hi:[0,1]
v_pk_add_f32 v[136:137], v[136:137], v[20:21]
v_pk_add_f32 v[110:111], v[110:111], v[118:119]
v_pk_mul_f32 v[20:21], v[88:89], s[34:35] op_sel_hi:[1,0] neg_lo:[0,1] neg_hi:[0,1]
v_pk_mul_f32 v[118:119], v[88:89], s[32:33] op_sel_hi:[1,0]
v_pk_fma_f32 v[20:21], v[22:23], s[32:33], v[20:21] op_sel_hi:[1,0,1] neg_lo:[0,1,0] neg_hi:[0,1,0]
v_pk_fma_f32 v[118:119], v[22:23], s[34:35], v[118:119] op_sel_hi:[1,0,1] neg_lo:[0,1,0] neg_hi:[0,1,0]
v_pk_add_f32 v[88:89], v[76:77], v[84:85] neg_lo:[0,1] neg_hi:[0,1]
v_pk_add_f32 v[22:23], v[30:31], v[38:39] neg_lo:[0,1] neg_hi:[0,1]
v_pk_add_f32 v[76:77], v[76:77], v[84:85]
v_pk_add_f32 v[30:31], v[30:31], v[38:39]
v_pk_mul_f32 v[84:85], v[88:89], s[32:33] op_sel:[0,1] neg_lo:[0,1] neg_hi:[0,1]
v_pk_mul_f32 v[38:39], v[88:89], s[32:33] op_sel:[0,1]
v_pk_fma_f32 v[84:85], v[22:23], s[32:33], v[84:85] op_sel:[0,1,0] neg_lo:[0,1,0] neg_hi:[0,1,0]
v_pk_fma_f32 v[38:39], v[22:23], s[32:33], v[38:39] op_sel:[0,1,0] neg_lo:[0,1,0] neg_hi:[0,1,0]
v_pk_add_f32 v[88:89], v[44:45], v[52:53] neg_lo:[0,1] neg_hi:[0,1]
v_pk_add_f32 v[22:23], v[94:95], v[102:103] neg_lo:[0,1] neg_hi:[0,1]
v_pk_add_f32 v[44:45], v[44:45], v[52:53]
v_pk_add_f32 v[94:95], v[94:95], v[102:103]
v_pk_mul_f32 v[52:53], v[88:89], s[32:33] op_sel_hi:[1,0] neg_lo:[0,1] neg_hi:[0,1]
v_pk_mul_f32 v[102:103], v[88:89], s[34:35] op_sel_hi:[1,0]
v_pk_fma_f32 v[52:53], v[22:23], s[34:35], v[52:53] op_sel_hi:[1,0,1] neg_lo:[0,1,0] neg_hi:[0,1,0]
v_pk_fma_f32 v[102:103], v[22:23], s[32:33], v[102:103] op_sel_hi:[1,0,1] neg_lo:[0,1,0] neg_hi:[0,1,0]
v_pk_add_f32 v[88:89], v[108:109], v[116:117] neg_lo:[0,1] neg_hi:[0,1]
v_pk_add_f32 v[22:23], v[62:63], v[70:71] neg_lo:[0,1] neg_hi:[0,1]
v_pk_add_f32 v[108:109], v[108:109], v[116:117]
v_pk_add_f32 v[62:63], v[62:63], v[70:71]
v_pk_mul_f32 v[116:117], v[88:89], s[30:31] op_sel:[0,1] neg_lo:[0,1] neg_hi:[0,1]
v_pk_mul_f32 v[70:71], v[88:89], s[34:35] op_sel:[0,1]
v_pk_fma_f32 v[116:117], v[22:23], s[34:35], v[116:117] op_sel:[0,1,0] neg_lo:[0,1,0] neg_hi:[0,1,0]
v_pk_fma_f32 v[70:71], v[22:23], s[30:31], v[70:71] op_sel:[0,1,0] neg_lo:[0,1,0] neg_hi:[0,1,0]
v_pk_add_f32 v[88:89], v[28:29], v[36:37] neg_lo:[0,1] neg_hi:[0,1]
v_pk_add_f32 v[22:23], v[126:127], v[134:135] neg_lo:[0,1] neg_hi:[0,1]
v_pk_add_f32 v[28:29], v[28:29], v[36:37]
v_pk_add_f32 v[126:127], v[126:127], v[134:135]
v_pk_mul_f32 v[36:37], v[88:89], s[30:31] op_sel_hi:[1,0] neg_lo:[0,1] neg_hi:[0,1]
v_pk_mul_f32 v[134:135], v[88:89], s[36:37] op_sel_hi:[1,0]
v_pk_fma_f32 v[36:37], v[22:23], s[36:37], v[36:37] op_sel_hi:[1,0,1] neg_lo:[0,1,0] neg_hi:[0,1,0]
v_pk_fma_f32 v[134:135], v[22:23], s[30:31], v[134:135] op_sel_hi:[1,0,1] neg_lo:[0,1,0] neg_hi:[0,1,0]
v_pk_add_f32 v[88:89], v[132:133], v[72:73] neg_lo:[0,1] neg_hi:[0,1]
v_pk_add_f32 v[22:23], v[18:19], v[138:139] neg_lo:[0,1] neg_hi:[0,1]
v_pk_add_f32 v[132:133], v[132:133], v[72:73]
v_pk_add_f32 v[18:19], v[18:19], v[138:139]
v_pk_add_f32 v[72:73], v[68:69], v[40:41] neg_lo:[0,1] neg_hi:[0,1]
v_pk_add_f32 v[138:139], v[146:147], v[78:79] neg_lo:[0,1] neg_hi:[0,1]
v_pk_add_f32 v[68:69], v[68:69], v[40:41]
v_pk_add_f32 v[146:147], v[146:147], v[78:79]
v_pk_mul_f32 v[40:41], v[72:73], s[30:31] op_sel:[0,1]
v_pk_mul_f32 v[78:79], v[72:73], s[34:35] op_sel:[0,1]
v_pk_fma_f32 v[40:41], v[138:139], s[34:35], v[40:41] op_sel:[0,1,0] neg_lo:[0,1,0] neg_hi:[0,1,0]
v_pk_fma_f32 v[78:79], v[138:139], s[30:31], v[78:79] op_sel:[0,1,0]
v_pk_add_f32 v[72:73], v[16:17], v[104:105] neg_lo:[0,1] neg_hi:[0,1]
v_pk_add_f32 v[138:139], v[114:115], v[46:47] neg_lo:[0,1] neg_hi:[0,1]
v_pk_add_f32 v[16:17], v[16:17], v[104:105]
v_pk_add_f32 v[114:115], v[114:115], v[46:47]
v_pk_mul_f32 v[104:105], v[72:73], s[32:33] op_sel:[0,1]
v_pk_mul_f32 v[46:47], v[72:73], s[32:33] op_sel:[0,1]
v_pk_fma_f32 v[104:105], v[138:139], s[32:33], v[104:105] op_sel:[0,1,0] neg_lo:[0,1,0] neg_hi:[0,1,0]
v_pk_fma_f32 v[46:47], v[138:139], s[32:33], v[46:47] op_sel:[0,1,0]
v_pk_add_f32 v[72:73], v[80:81], v[136:137] neg_lo:[0,1] neg_hi:[0,1]
v_pk_add_f32 v[138:139], v[66:67], v[110:111] neg_lo:[0,1] neg_hi:[0,1]
v_pk_add_f32 v[80:81], v[80:81], v[136:137]
v_pk_add_f32 v[66:67], v[66:67], v[110:111]
v_pk_mul_f32 v[136:137], v[72:73], s[34:35] op_sel:[0,1]
v_pk_mul_f32 v[110:111], v[72:73], s[30:31] op_sel:[0,1]
v_pk_fma_f32 v[136:137], v[138:139], s[30:31], v[136:137] op_sel:[0,1,0] neg_lo:[0,1,0] neg_hi:[0,1,0]
v_pk_fma_f32 v[110:111], v[138:139], s[34:35], v[110:111] op_sel:[0,1,0]
v_pk_add_f32 v[72:73], v[30:31], v[130:131] neg_lo:[0,1] neg_hi:[0,1]
v_pk_add_f32 v[138:139], v[144:145], v[76:77] neg_lo:[0,1] neg_hi:[0,1]
v_pk_add_f32 v[144:145], v[144:145], v[76:77]
v_pk_add_f32 v[130:131], v[130:131], v[30:31]
v_pk_add_f32 v[76:77], v[112:113], v[44:45] neg_lo:[0,1] neg_hi:[0,1]
v_pk_add_f32 v[30:31], v[74:75], v[94:95] neg_lo:[0,1] neg_hi:[0,1]
v_pk_add_f32 v[112:113], v[112:113], v[44:45]
v_pk_add_f32 v[74:75], v[74:75], v[94:95]
v_pk_mul_f32 v[44:45], v[76:77], s[34:35] op_sel:[0,1] neg_lo:[0,1] neg_hi:[0,1]
v_pk_mul_f32 v[94:95], v[76:77], s[30:31] op_sel:[0,1]
v_pk_fma_f32 v[44:45], v[30:31], s[30:31], v[44:45] op_sel:[0,1,0] neg_lo:[0,1,0] neg_hi:[0,1,0]
v_pk_fma_f32 v[94:95], v[30:31], s[34:35], v[94:95] op_sel:[0,1,0] neg_lo:[0,1,0] neg_hi:[0,1,0]
v_pk_add_f32 v[76:77], v[64:65], v[108:109] neg_lo:[0,1] neg_hi:[0,1]
v_pk_add_f32 v[30:31], v[42:43], v[62:63] neg_lo:[0,1] neg_hi:[0,1]
v_pk_add_f32 v[64:65], v[64:65], v[108:109]
v_pk_add_f32 v[42:43], v[42:43], v[62:63]
v_pk_mul_f32 v[108:109], v[76:77], s[32:33] op_sel:[0,1] neg_lo:[0,1] neg_hi:[0,1]
v_pk_mul_f32 v[62:63], v[76:77], s[32:33] op_sel:[0,1]
v_pk_fma_f32 v[108:109], v[30:31], s[32:33], v[108:109] op_sel:[0,1,0] neg_lo:[0,1,0] neg_hi:[0,1,0]
v_pk_fma_f32 v[62:63], v[30:31], s[32:33], v[62:63] op_sel:[0,1,0] neg_lo:[0,1,0] neg_hi:[0,1,0]
v_pk_add_f32 v[76:77], v[128:129], v[28:29] neg_lo:[0,1] neg_hi:[0,1]
v_pk_add_f32 v[30:31], v[106:107], v[126:127] neg_lo:[0,1] neg_hi:[0,1]
v_pk_add_f32 v[128:129], v[128:129], v[28:29]
v_pk_add_f32 v[106:107], v[106:107], v[126:127]
v_pk_mul_f32 v[28:29], v[76:77], s[30:31] op_sel:[0,1] neg_lo:[0,1] neg_hi:[0,1]
v_pk_mul_f32 v[126:127], v[76:77], s[34:35] op_sel:[0,1]
v_pk_fma_f32 v[28:29], v[30:31], s[34:35], v[28:29] op_sel:[0,1,0] neg_lo:[0,1,0] neg_hi:[0,1,0]
v_pk_fma_f32 v[126:127], v[30:31], s[30:31], v[126:127] op_sel:[0,1,0] neg_lo:[0,1,0] neg_hi:[0,1,0]
v_pk_add_f32 v[76:77], v[100:101], v[92:93] neg_lo:[0,1] neg_hi:[0,1]
v_pk_add_f32 v[30:31], v[82:83], v[142:143] neg_lo:[0,1] neg_hi:[0,1]
v_pk_add_f32 v[100:101], v[100:101], v[92:93]
v_pk_add_f32 v[82:83], v[82:83], v[142:143]
v_pk_add_f32 v[92:93], v[60:61], v[56:57] neg_lo:[0,1] neg_hi:[0,1]
v_pk_add_f32 v[142:143], v[50:51], v[86:87] neg_lo:[0,1] neg_hi:[0,1]
v_pk_add_f32 v[60:61], v[60:61], v[56:57]
v_pk_add_f32 v[50:51], v[50:51], v[86:87]
v_pk_mul_f32 v[56:57], v[92:93], s[30:31] op_sel:[0,1]
v_pk_mul_f32 v[86:87], v[92:93], s[34:35] op_sel:[0,1]
v_pk_fma_f32 v[56:57], v[142:143], s[34:35], v[56:57] op_sel:[0,1,0] neg_lo:[0,1,0] neg_hi:[0,1,0]
v_pk_fma_f32 v[86:87], v[142:143], s[30:31], v[86:87] op_sel:[0,1,0]
v_pk_add_f32 v[92:93], v[124:125], v[120:121] neg_lo:[0,1] neg_hi:[0,1]
v_pk_add_f32 v[142:143], v[34:35], v[54:55] neg_lo:[0,1] neg_hi:[0,1]
v_pk_add_f32 v[124:125], v[124:125], v[120:121]
v_pk_add_f32 v[34:35], v[34:35], v[54:55]
v_pk_mul_f32 v[120:121], v[92:93], s[32:33] op_sel:[0,1]
v_pk_mul_f32 v[54:55], v[92:93], s[32:33] op_sel:[0,1]
v_pk_fma_f32 v[120:121], v[142:143], s[32:33], v[120:121] op_sel:[0,1,0] neg_lo:[0,1,0] neg_hi:[0,1,0]
v_pk_fma_f32 v[54:55], v[142:143], s[32:33], v[54:55] op_sel:[0,1,0]
v_pk_add_f32 v[92:93], v[140:141], v[20:21] neg_lo:[0,1] neg_hi:[0,1]
v_pk_add_f32 v[142:143], v[98:99], v[118:119] neg_lo:[0,1] neg_hi:[0,1]
v_pk_add_f32 v[140:141], v[140:141], v[20:21]
v_pk_add_f32 v[98:99], v[98:99], v[118:119]
v_pk_mul_f32 v[20:21], v[92:93], s[34:35] op_sel:[0,1]
v_pk_mul_f32 v[118:119], v[92:93], s[30:31] op_sel:[0,1]
v_pk_fma_f32 v[20:21], v[142:143], s[30:31], v[20:21] op_sel:[0,1,0] neg_lo:[0,1,0] neg_hi:[0,1,0]
v_pk_fma_f32 v[118:119], v[142:143], s[34:35], v[118:119] op_sel:[0,1,0]
v_pk_add_f32 v[92:93], v[38:39], v[26:27] neg_lo:[0,1] neg_hi:[0,1]
v_pk_add_f32 v[142:143], v[48:49], v[84:85] neg_lo:[0,1] neg_hi:[0,1]
v_pk_add_f32 v[48:49], v[48:49], v[84:85]
v_pk_add_f32 v[26:27], v[26:27], v[38:39]
v_pk_add_f32 v[84:85], v[32:33], v[52:53] neg_lo:[0,1] neg_hi:[0,1]
v_pk_add_f32 v[38:39], v[90:91], v[102:103] neg_lo:[0,1] neg_hi:[0,1]
v_pk_add_f32 v[32:33], v[32:33], v[52:53]
v_pk_add_f32 v[90:91], v[90:91], v[102:103]
v_pk_mul_f32 v[52:53], v[84:85], s[34:35] op_sel:[0,1] neg_lo:[0,1] neg_hi:[0,1]
v_pk_mul_f32 v[102:103], v[84:85], s[30:31] op_sel:[0,1]
v_pk_fma_f32 v[52:53], v[38:39], s[30:31], v[52:53] op_sel:[0,1,0] neg_lo:[0,1,0] neg_hi:[0,1,0]
v_pk_fma_f32 v[102:103], v[38:39], s[34:35], v[102:103] op_sel:[0,1,0] neg_lo:[0,1,0] neg_hi:[0,1,0]
v_pk_add_f32 v[84:85], v[96:97], v[116:117] neg_lo:[0,1] neg_hi:[0,1]
v_pk_add_f32 v[38:39], v[58:59], v[70:71] neg_lo:[0,1] neg_hi:[0,1]
v_pk_add_f32 v[96:97], v[96:97], v[116:117]
v_pk_add_f32 v[58:59], v[58:59], v[70:71]
v_pk_mul_f32 v[116:117], v[84:85], s[32:33] op_sel:[0,1] neg_lo:[0,1] neg_hi:[0,1]
v_pk_mul_f32 v[70:71], v[84:85], s[32:33] op_sel:[0,1]
v_pk_fma_f32 v[116:117], v[38:39], s[32:33], v[116:117] op_sel:[0,1,0] neg_lo:[0,1,0] neg_hi:[0,1,0]
v_pk_fma_f32 v[70:71], v[38:39], s[32:33], v[70:71] op_sel:[0,1,0] neg_lo:[0,1,0] neg_hi:[0,1,0]
v_pk_add_f32 v[84:85], v[24:25], v[36:37] neg_lo:[0,1] neg_hi:[0,1]
v_pk_add_f32 v[38:39], v[122:123], v[134:135] neg_lo:[0,1] neg_hi:[0,1]
v_pk_add_f32 v[24:25], v[24:25], v[36:37]
v_pk_add_f32 v[122:123], v[122:123], v[134:135]
v_pk_mul_f32 v[36:37], v[84:85], s[30:31] op_sel:[0,1] neg_lo:[0,1] neg_hi:[0,1]
v_pk_mul_f32 v[134:135], v[84:85], s[34:35] op_sel:[0,1]
v_pk_fma_f32 v[36:37], v[38:39], s[34:35], v[36:37] op_sel:[0,1,0] neg_lo:[0,1,0] neg_hi:[0,1,0]
v_pk_fma_f32 v[134:135], v[38:39], s[30:31], v[134:135] op_sel:[0,1,0] neg_lo:[0,1,0] neg_hi:[0,1,0]
v_pk_add_f32 v[84:85], v[132:133], v[144:145] neg_lo:[0,1] neg_hi:[0,1]
v_pk_add_f32 v[38:39], v[18:19], v[130:131] neg_lo:[0,1] neg_hi:[0,1]
v_pk_add_f32 v[132:133], v[132:133], v[144:145]
v_pk_add_f32 v[18:19], v[18:19], v[130:131]
v_pk_add_f32 v[144:145], v[68:69], v[112:113] neg_lo:[0,1] neg_hi:[0,1]
v_pk_add_f32 v[130:131], v[146:147], v[74:75] neg_lo:[0,1] neg_hi:[0,1]
v_pk_add_f32 v[68:69], v[68:69], v[112:113]
v_pk_add_f32 v[146:147], v[146:147], v[74:75]
v_pk_mul_f32 v[112:113], v[144:145], s[32:33] op_sel:[0,1]
v_pk_mul_f32 v[74:75], v[144:145], s[32:33] op_sel:[0,1]
v_pk_fma_f32 v[112:113], v[130:131], s[32:33], v[112:113] op_sel:[0,1,0] neg_lo:[0,1,0] neg_hi:[0,1,0]
v_pk_fma_f32 v[74:75], v[130:131], s[32:33], v[74:75] op_sel:[0,1,0]
v_pk_add_f32 v[144:145], v[42:43], v[114:115] neg_lo:[0,1] neg_hi:[0,1]
v_pk_add_f32 v[130:131], v[16:17], v[64:65] neg_lo:[0,1] neg_hi:[0,1]
v_pk_add_f32 v[16:17], v[16:17], v[64:65]
v_pk_add_f32 v[114:115], v[114:115], v[42:43]
v_pk_add_f32 v[64:65], v[80:81], v[128:129] neg_lo:[0,1] neg_hi:[0,1]
v_pk_add_f32 v[42:43], v[66:67], v[106:107] neg_lo:[0,1] neg_hi:[0,1]
v_pk_add_f32 v[80:81], v[80:81], v[128:129]
v_pk_add_f32 v[66:67], v[66:67], v[106:107]
v_pk_mul_f32 v[128:129], v[64:65], s[32:33] op_sel:[0,1] neg_lo:[0,1] neg_hi:[0,1]
v_pk_mul_f32 v[106:107], v[64:65], s[32:33] op_sel:[0,1]
v_pk_fma_f32 v[128:129], v[42:43], s[32:33], v[128:129] op_sel:[0,1,0] neg_lo:[0,1,0] neg_hi:[0,1,0]
v_pk_fma_f32 v[106:107], v[42:43], s[32:33], v[106:107] op_sel:[0,1,0] neg_lo:[0,1,0] neg_hi:[0,1,0]
v_pk_add_f32 v[64:65], v[88:89], v[72:73] neg_lo:[0,1] neg_hi:[0,1]
v_pk_add_f32 v[42:43], v[22:23], v[138:139] neg_lo:[0,1] neg_hi:[0,1]
v_pk_add_f32 v[88:89], v[88:89], v[72:73]
v_pk_add_f32 v[22:23], v[22:23], v[138:139]
v_pk_add_f32 v[72:73], v[40:41], v[44:45] neg_lo:[0,1] neg_hi:[0,1]
v_pk_add_f32 v[138:139], v[78:79], v[94:95] neg_lo:[0,1] neg_hi:[0,1]
v_pk_add_f32 v[40:41], v[40:41], v[44:45]
v_pk_add_f32 v[78:79], v[78:79], v[94:95]
v_pk_mul_f32 v[44:45], v[72:73], s[32:33] op_sel:[0,1]
v_pk_mul_f32 v[94:95], v[72:73], s[32:33] op_sel:[0,1]
v_pk_fma_f32 v[44:45], v[138:139], s[32:33], v[44:45] op_sel:[0,1,0] neg_lo:[0,1,0] neg_hi:[0,1,0]
v_pk_fma_f32 v[94:95], v[138:139], s[32:33], v[94:95] op_sel:[0,1,0]
v_pk_add_f32 v[72:73], v[62:63], v[46:47] neg_lo:[0,1] neg_hi:[0,1]
v_pk_add_f32 v[138:139], v[104:105], v[108:109] neg_lo:[0,1] neg_hi:[0,1]
v_pk_add_f32 v[104:105], v[104:105], v[108:109]
v_pk_add_f32 v[46:47], v[46:47], v[62:63]
v_pk_add_f32 v[108:109], v[136:137], v[28:29] neg_lo:[0,1] neg_hi:[0,1]
v_pk_add_f32 v[62:63], v[110:111], v[126:127] neg_lo:[0,1] neg_hi:[0,1]
v_pk_add_f32 v[136:137], v[136:137], v[28:29]
v_pk_add_f32 v[110:111], v[110:111], v[126:127]
v_pk_mul_f32 v[28:29], v[108:109], s[32:33] op_sel:[0,1] neg_lo:[0,1] neg_hi:[0,1]
v_pk_mul_f32 v[126:127], v[108:109], s[32:33] op_sel:[0,1]
v_pk_fma_f32 v[28:29], v[62:63], s[32:33], v[28:29] op_sel:[0,1,0] neg_lo:[0,1,0] neg_hi:[0,1,0]
v_pk_fma_f32 v[126:127], v[62:63], s[32:33], v[126:127] op_sel:[0,1,0] neg_lo:[0,1,0] neg_hi:[0,1,0]
v_pk_add_f32 v[108:109], v[100:101], v[48:49] neg_lo:[0,1] neg_hi:[0,1]
v_pk_add_f32 v[62:63], v[82:83], v[26:27] neg_lo:[0,1] neg_hi:[0,1]
v_pk_add_f32 v[100:101], v[100:101], v[48:49]
v_pk_add_f32 v[82:83], v[82:83], v[26:27]
v_pk_add_f32 v[48:49], v[60:61], v[32:33] neg_lo:[0,1] neg_hi:[0,1]
v_pk_add_f32 v[26:27], v[50:51], v[90:91] neg_lo:[0,1] neg_hi:[0,1]
v_pk_add_f32 v[60:61], v[60:61], v[32:33]
v_pk_add_f32 v[50:51], v[50:51], v[90:91]
v_pk_mul_f32 v[32:33], v[48:49], s[32:33] op_sel:[0,1]
v_pk_mul_f32 v[90:91], v[48:49], s[32:33] op_sel:[0,1]
v_pk_fma_f32 v[32:33], v[26:27], s[32:33], v[32:33] op_sel:[0,1,0] neg_lo:[0,1,0] neg_hi:[0,1,0]
v_pk_fma_f32 v[90:91], v[26:27], s[32:33], v[90:91] op_sel:[0,1,0]
v_pk_add_f32 v[48:49], v[58:59], v[34:35] neg_lo:[0,1] neg_hi:[0,1]
v_pk_add_f32 v[26:27], v[124:125], v[96:97] neg_lo:[0,1] neg_hi:[0,1]
v_pk_add_f32 v[124:125], v[124:125], v[96:97]
v_pk_add_f32 v[34:35], v[34:35], v[58:59]
v_pk_add_f32 v[96:97], v[140:141], v[24:25] neg_lo:[0,1] neg_hi:[0,1]
v_pk_add_f32 v[58:59], v[98:99], v[122:123] neg_lo:[0,1] neg_hi:[0,1]
v_pk_add_f32 v[140:141], v[140:141], v[24:25]
v_pk_add_f32 v[98:99], v[98:99], v[122:123]
v_pk_mul_f32 v[24:25], v[96:97], s[32:33] op_sel:[0,1] neg_lo:[0,1] neg_hi:[0,1]
v_pk_mul_f32 v[122:123], v[96:97], s[32:33] op_sel:[0,1]
v_pk_fma_f32 v[24:25], v[58:59], s[32:33], v[24:25] op_sel:[0,1,0] neg_lo:[0,1,0] neg_hi:[0,1,0]
v_pk_fma_f32 v[122:123], v[58:59], s[32:33], v[122:123] op_sel:[0,1,0] neg_lo:[0,1,0] neg_hi:[0,1,0]
v_pk_add_f32 v[96:97], v[76:77], v[92:93] neg_lo:[0,1] neg_hi:[0,1]
v_pk_add_f32 v[58:59], v[30:31], v[142:143] neg_lo:[0,1] neg_hi:[0,1]
v_pk_add_f32 v[76:77], v[76:77], v[92:93]
v_pk_add_f32 v[30:31], v[30:31], v[142:143]
v_pk_add_f32 v[92:93], v[56:57], v[52:53] neg_lo:[0,1] neg_hi:[0,1]
v_pk_add_f32 v[142:143], v[86:87], v[102:103] neg_lo:[0,1] neg_hi:[0,1]
v_pk_add_f32 v[56:57], v[56:57], v[52:53]
v_pk_add_f32 v[86:87], v[86:87], v[102:103]
v_pk_mul_f32 v[52:53], v[92:93], s[32:33] op_sel:[0,1]
v_pk_mul_f32 v[102:103], v[92:93], s[32:33] op_sel:[0,1]
v_pk_fma_f32 v[52:53], v[142:143], s[32:33], v[52:53] op_sel:[0,1,0] neg_lo:[0,1,0] neg_hi:[0,1,0]
v_pk_fma_f32 v[102:103], v[142:143], s[32:33], v[102:103] op_sel:[0,1,0]
v_pk_add_f32 v[92:93], v[70:71], v[54:55] neg_lo:[0,1] neg_hi:[0,1]
v_pk_add_f32 v[142:143], v[120:121], v[116:117] neg_lo:[0,1] neg_hi:[0,1]
v_pk_add_f32 v[120:121], v[120:121], v[116:117]
v_pk_add_f32 v[54:55], v[54:55], v[70:71]
v_pk_add_f32 v[116:117], v[20:21], v[36:37] neg_lo:[0,1] neg_hi:[0,1]
v_pk_add_f32 v[70:71], v[118:119], v[134:135] neg_lo:[0,1] neg_hi:[0,1]
v_pk_add_f32 v[20:21], v[20:21], v[36:37]
v_pk_add_f32 v[118:119], v[118:119], v[134:135]
v_pk_mul_f32 v[36:37], v[116:117], s[32:33] op_sel:[0,1] neg_lo:[0,1] neg_hi:[0,1]
v_pk_mul_f32 v[134:135], v[116:117], s[32:33] op_sel:[0,1]
v_pk_fma_f32 v[36:37], v[70:71], s[32:33], v[36:37] op_sel:[0,1,0] neg_lo:[0,1,0] neg_hi:[0,1,0]
v_pk_fma_f32 v[134:135], v[70:71], s[32:33], v[134:135] op_sel:[0,1,0] neg_lo:[0,1,0] neg_hi:[0,1,0]
v_pk_add_f32 v[116:117], v[132:133], v[16:17] neg_lo:[0,1] neg_hi:[0,1]
v_pk_add_f32 v[70:71], v[18:19], v[114:115] neg_lo:[0,1] neg_hi:[0,1]
v_pk_add_f32 v[132:133], v[132:133], v[16:17]
v_pk_add_f32 v[18:19], v[18:19], v[114:115]
v_pk_add_f32 v[16:17], v[66:67], v[146:147] neg_lo:[0,1] neg_hi:[0,1]
v_pk_add_f32 v[114:115], v[68:69], v[80:81] neg_lo:[0,1] neg_hi:[0,1]
v_pk_add_f32 v[68:69], v[68:69], v[80:81]
v_pk_add_f32 v[146:147], v[146:147], v[66:67]
v_pk_add_f32 v[80:81], v[84:85], v[144:145] neg_lo:[0,1] neg_hi:[0,1]
v_pk_add_f32 v[66:67], v[38:39], v[130:131] neg_lo:[0,1] neg_hi:[0,1]
v_pk_add_f32 v[84:85], v[84:85], v[144:145]
v_pk_add_f32 v[38:39], v[38:39], v[130:131]
v_pk_add_f32 v[144:145], v[106:107], v[74:75] neg_lo:[0,1] neg_hi:[0,1]
v_pk_add_f32 v[130:131], v[112:113], v[128:129] neg_lo:[0,1] neg_hi:[0,1]
v_pk_add_f32 v[112:113], v[112:113], v[128:129]
v_pk_add_f32 v[74:75], v[74:75], v[106:107]
v_pk_add_f32 v[128:129], v[88:89], v[104:105] neg_lo:[0,1] neg_hi:[0,1]
v_pk_add_f32 v[106:107], v[22:23], v[46:47] neg_lo:[0,1] neg_hi:[0,1]
v_pk_add_f32 v[88:89], v[88:89], v[104:105]
v_pk_add_f32 v[22:23], v[22:23], v[46:47]
v_pk_add_f32 v[104:105], v[110:111], v[78:79] neg_lo:[0,1] neg_hi:[0,1]
v_pk_add_f32 v[46:47], v[40:41], v[136:137] neg_lo:[0,1] neg_hi:[0,1]
v_pk_add_f32 v[40:41], v[40:41], v[136:137]
v_pk_add_f32 v[78:79], v[78:79], v[110:111]
v_pk_add_f32 v[136:137], v[64:65], v[72:73] neg_lo:[0,1] neg_hi:[0,1]
v_pk_add_f32 v[110:111], v[42:43], v[138:139] neg_lo:[0,1] neg_hi:[0,1]
v_pk_add_f32 v[64:65], v[64:65], v[72:73]
v_pk_add_f32 v[42:43], v[42:43], v[138:139]
v_pk_add_f32 v[72:73], v[126:127], v[94:95] neg_lo:[0,1] neg_hi:[0,1]
v_pk_add_f32 v[138:139], v[44:45], v[28:29] neg_lo:[0,1] neg_hi:[0,1]
v_pk_add_f32 v[44:45], v[44:45], v[28:29]
v_pk_add_f32 v[94:95], v[94:95], v[126:127]
v_pk_add_f32 v[28:29], v[100:101], v[124:125] neg_lo:[0,1] neg_hi:[0,1]
v_pk_add_f32 v[126:127], v[82:83], v[34:35] neg_lo:[0,1] neg_hi:[0,1]
v_pk_add_f32 v[100:101], v[100:101], v[124:125]
v_pk_add_f32 v[82:83], v[82:83], v[34:35]
v_pk_add_f32 v[124:125], v[98:99], v[50:51] neg_lo:[0,1] neg_hi:[0,1]
v_pk_add_f32 v[34:35], v[60:61], v[140:141] neg_lo:[0,1] neg_hi:[0,1]
v_pk_add_f32 v[60:61], v[60:61], v[140:141]
v_pk_add_f32 v[50:51], v[50:51], v[98:99]
v_pk_add_f32 v[140:141], v[108:109], v[48:49] neg_lo:[0,1] neg_hi:[0,1]
v_pk_add_f32 v[98:99], v[62:63], v[26:27] neg_lo:[0,1] neg_hi:[0,1]
v_pk_add_f32 v[108:109], v[108:109], v[48:49]
v_pk_add_f32 v[62:63], v[62:63], v[26:27]
v_pk_add_f32 v[48:49], v[122:123], v[90:91] neg_lo:[0,1] neg_hi:[0,1]
v_pk_add_f32 v[26:27], v[32:33], v[24:25] neg_lo:[0,1] neg_hi:[0,1]
v_pk_add_f32 v[32:33], v[32:33], v[24:25]
v_pk_add_f32 v[90:91], v[90:91], v[122:123]
v_pk_add_f32 v[24:25], v[76:77], v[120:121] neg_lo:[0,1] neg_hi:[0,1]
v_pk_add_f32 v[122:123], v[30:31], v[54:55] neg_lo:[0,1] neg_hi:[0,1]
v_pk_add_f32 v[76:77], v[76:77], v[120:121]
v_pk_add_f32 v[30:31], v[30:31], v[54:55]
v_pk_add_f32 v[120:121], v[118:119], v[86:87] neg_lo:[0,1] neg_hi:[0,1]
v_pk_add_f32 v[54:55], v[56:57], v[20:21] neg_lo:[0,1] neg_hi:[0,1]
v_pk_add_f32 v[56:57], v[56:57], v[20:21]
v_pk_add_f32 v[86:87], v[86:87], v[118:119]
v_pk_add_f32 v[20:21], v[96:97], v[92:93] neg_lo:[0,1] neg_hi:[0,1]
v_pk_add_f32 v[118:119], v[58:59], v[142:143] neg_lo:[0,1] neg_hi:[0,1]
v_pk_add_f32 v[96:97], v[96:97], v[92:93]
v_pk_add_f32 v[58:59], v[58:59], v[142:143]
v_pk_add_f32 v[92:93], v[134:135], v[102:103] neg_lo:[0,1] neg_hi:[0,1]
v_pk_add_f32 v[142:143], v[52:53], v[36:37] neg_lo:[0,1] neg_hi:[0,1]
v_pk_add_f32 v[52:53], v[52:53], v[36:37]
v_pk_add_f32 v[102:103], v[102:103], v[134:135]
v_pk_add_f32 v[36:37], v[132:133], v[68:69] neg_lo:[0,1] neg_hi:[0,1]
v_pk_add_f32 v[134:135], v[18:19], v[146:147] neg_lo:[0,1] neg_hi:[0,1]
v_pk_add_f32 v[132:133], v[132:133], v[68:69]
v_pk_add_f32 v[18:19], v[18:19], v[146:147]
v_pk_add_f32 v[68:69], v[116:117], v[16:17] neg_lo:[0,1] neg_hi:[0,1]
v_pk_add_f32 v[146:147], v[70:71], v[114:115] neg_lo:[0,1] neg_hi:[0,1]
v_pk_add_f32 v[116:117], v[116:117], v[16:17]
v_pk_add_f32 v[70:71], v[70:71], v[114:115]
v_pk_add_f32 v[16:17], v[84:85], v[112:113] neg_lo:[0,1] neg_hi:[0,1]
v_pk_add_f32 v[114:115], v[38:39], v[74:75] neg_lo:[0,1] neg_hi:[0,1]
v_pk_add_f32 v[84:85], v[84:85], v[112:113]
v_pk_add_f32 v[38:39], v[38:39], v[74:75]
v_pk_add_f32 v[112:113], v[80:81], v[144:145] neg_lo:[0,1] neg_hi:[0,1]
v_pk_add_f32 v[74:75], v[66:67], v[130:131] neg_lo:[0,1] neg_hi:[0,1]
v_pk_add_f32 v[80:81], v[80:81], v[144:145]
v_pk_add_f32 v[66:67], v[66:67], v[130:131]
v_pk_add_f32 v[144:145], v[88:89], v[40:41] neg_lo:[0,1] neg_hi:[0,1]
v_pk_add_f32 v[130:131], v[22:23], v[78:79] neg_lo:[0,1] neg_hi:[0,1]
v_pk_add_f32 v[88:89], v[88:89], v[40:41]
v_pk_add_f32 v[22:23], v[22:23], v[78:79]
v_pk_add_f32 v[40:41], v[128:129], v[104:105] neg_lo:[0,1] neg_hi:[0,1]
v_pk_add_f32 v[78:79], v[106:107], v[46:47] neg_lo:[0,1] neg_hi:[0,1]
v_pk_add_f32 v[128:129], v[128:129], v[104:105]
v_pk_add_f32 v[106:107], v[106:107], v[46:47]
v_pk_add_f32 v[104:105], v[64:65], v[44:45] neg_lo:[0,1] neg_hi:[0,1]
v_pk_add_f32 v[46:47], v[42:43], v[94:95] neg_lo:[0,1] neg_hi:[0,1]
v_pk_add_f32 v[64:65], v[64:65], v[44:45]
v_pk_add_f32 v[42:43], v[42:43], v[94:95]
v_pk_add_f32 v[44:45], v[136:137], v[72:73] neg_lo:[0,1] neg_hi:[0,1]
v_pk_add_f32 v[94:95], v[110:111], v[138:139] neg_lo:[0,1] neg_hi:[0,1]
v_pk_add_f32 v[136:137], v[136:137], v[72:73]
v_pk_add_f32 v[110:111], v[110:111], v[138:139]
v_pk_add_f32 v[72:73], v[100:101], v[60:61] neg_lo:[0,1] neg_hi:[0,1]
v_pk_add_f32 v[138:139], v[82:83], v[50:51] neg_lo:[0,1] neg_hi:[0,1]
v_pk_add_f32 v[100:101], v[100:101], v[60:61]
v_pk_add_f32 v[82:83], v[82:83], v[50:51]
v_pk_add_f32 v[60:61], v[28:29], v[124:125] neg_lo:[0,1] neg_hi:[0,1]
v_pk_add_f32 v[50:51], v[126:127], v[34:35] neg_lo:[0,1] neg_hi:[0,1]
v_pk_add_f32 v[28:29], v[28:29], v[124:125]
v_pk_add_f32 v[126:127], v[126:127], v[34:35]
v_pk_add_f32 v[124:125], v[108:109], v[32:33] neg_lo:[0,1] neg_hi:[0,1]
v_pk_add_f32 v[34:35], v[62:63], v[90:91] neg_lo:[0,1] neg_hi:[0,1]
v_pk_add_f32 v[108:109], v[108:109], v[32:33]
v_pk_add_f32 v[62:63], v[62:63], v[90:91]
v_pk_add_f32 v[32:33], v[140:141], v[48:49] neg_lo:[0,1] neg_hi:[0,1]
v_pk_add_f32 v[90:91], v[98:99], v[26:27] neg_lo:[0,1] neg_hi:[0,1]
v_pk_add_f32 v[140:141], v[140:141], v[48:49]
v_pk_add_f32 v[98:99], v[98:99], v[26:27]
v_pk_add_f32 v[48:49], v[76:77], v[56:57] neg_lo:[0,1] neg_hi:[0,1]
v_pk_add_f32 v[26:27], v[30:31], v[86:87] neg_lo:[0,1] neg_hi:[0,1]
v_pk_add_f32 v[76:77], v[76:77], v[56:57]
v_pk_add_f32 v[30:31], v[30:31], v[86:87]
v_pk_add_f32 v[56:57], v[24:25], v[120:121] neg_lo:[0,1] neg_hi:[0,1]
v_pk_add_f32 v[86:87], v[122:123], v[54:55] neg_lo:[0,1] neg_hi:[0,1]
v_pk_add_f32 v[24:25], v[24:25], v[120:121]
v_pk_add_f32 v[122:123], v[122:123], v[54:55]
v_pk_add_f32 v[120:121], v[96:97], v[52:53] neg_lo:[0,1] neg_hi:[0,1]
v_pk_add_f32 v[54:55], v[58:59], v[102:103] neg_lo:[0,1] neg_hi:[0,1]
v_pk_add_f32 v[96:97], v[96:97], v[52:53]
v_pk_add_f32 v[58:59], v[58:59], v[102:103]
v_pk_add_f32 v[52:53], v[20:21], v[92:93] neg_lo:[0,1] neg_hi:[0,1]
v_pk_add_f32 v[102:103], v[118:119], v[142:143] neg_lo:[0,1] neg_hi:[0,1]
v_pk_add_f32 v[20:21], v[20:21], v[92:93]
v_pk_add_f32 v[118:119], v[118:119], v[142:143]
v_mul_f32 v12, v9, v8
v_mul_f32 v12, 0x3a000000, v12
v_fmamk_f32 v149, v8, 0x00000000, v12
v_cos_f32 v148, v149
v_sin_f32 v149, v149
v_fmamk_f32 v151, v8, 0x3a800000, v12
v_cos_f32 v150, v151
v_sin_f32 v151, v151
v_pk_mul_f32 v[92:93], v[132:133], v[148:149] op_sel_hi:[1,0]
v_pk_fma_f32 v[92:93], v[18:19], v[148:149], v[92:93] op_sel:[0,1,0] neg_lo:[1,0,0] neg_hi:[1,0,0]
v_pk_mul_f32 v[18:19], v[18:19], v[148:149] op_sel_hi:[1,0]
v_pk_fma_f32 v[18:19], v[132:133], v[148:149], v[18:19] op_sel:[0,1,0]
v_fmamk_f32 v149, v8, 0x3b000000, v12
v_cos_f32 v148, v149
v_sin_f32 v149, v149
v_pk_mul_f32 v[132:133], v[100:101], v[150:151] op_sel_hi:[1,0]
v_pk_fma_f32 v[132:133], v[82:83], v[150:151], v[132:133] op_sel:[0,1,0] neg_lo:[1,0,0] neg_hi:[1,0,0]
v_pk_mul_f32 v[82:83], v[82:83], v[150:151] op_sel_hi:[1,0]
v_pk_fma_f32 v[82:83], v[100:101], v[150:151], v[82:83] op_sel:[0,1,0]
v_fmamk_f32 v151, v8, 0x3b400000, v12
v_cos_f32 v150, v151
v_sin_f32 v151, v151
v_pk_mul_f32 v[100:101], v[88:89], v[148:149] op_sel_hi:[1,0]
v_pk_fma_f32 v[100:101], v[22:23], v[148:149], v[100:101] op_sel:[0,1,0] neg_lo:[1,0,0] neg_hi:[1,0,0]
v_pk_mul_f32 v[22:23], v[22:23], v[148:149] op_sel_hi:[1,0]
v_pk_fma_f32 v[22:23], v[88:89], v[148:149], v[22:23] op_sel:[0,1,0]
v_fmamk_f32 v149, v8, 0x3b800000, v12
v_cos_f32 v148, v149
v_sin_f32 v149, v149
v_pk_mul_f32 v[88:89], v[76:77], v[150:151] op_sel_hi:[1,0]
v_pk_fma_f32 v[88:89], v[30:31], v[150:151], v[88:89] op_sel:[0,1,0] neg_lo:[1,0,0] neg_hi:[1,0,0]
v_pk_mul_f32 v[30:31], v[30:31], v[150:151] op_sel_hi:[1,0]
v_pk_fma_f32 v[30:31], v[76:77], v[150:151], v[30:31] op_sel:[0,1,0]
v_fmamk_f32 v151, v8, 0x3ba00000, v12
v_cos_f32 v150, v151
v_sin_f32 v151, v151
v_pk_mul_f32 v[76:77], v[84:85], v[148:149] op_sel_hi:[1,0]
v_pk_fma_f32 v[76:77], v[38:39], v[148:149], v[76:77] op_sel:[0,1,0] neg_lo:[1,0,0] neg_hi:[1,0,0]
v_pk_mul_f32 v[38:39], v[38:39], v[148:149] op_sel_hi:[1,0]
v_pk_fma_f32 v[38:39], v[84:85], v[148:149], v[38:39] op_sel:[0,1,0]
v_fmamk_f32 v149, v8, 0x3bc00000, v12
v_cos_f32 v148, v149
v_sin_f32 v149, v149
v_pk_mul_f32 v[84:85], v[108:109], v[150:151] op_sel_hi:[1,0]
v_pk_fma_f32 v[84:85], v[62:63], v[150:151], v[84:85] op_sel:[0,1,0] neg_lo:[1,0,0] neg_hi:[1,0,0]
v_pk_mul_f32 v[62:63], v[62:63], v[150:151] op_sel_hi:[1,0]
v_pk_fma_f32 v[62:63], v[108:109], v[150:151], v[62:63] op_sel:[0,1,0]
v_fmamk_f32 v151, v8, 0x3be00000, v12
v_cos_f32 v150, v151
v_sin_f32 v151, v151
v_pk_mul_f32 v[108:109], v[64:65], v[148:149] op_sel_hi:[1,0]
v_pk_fma_f32 v[108:109], v[42:43], v[148:149], v[108:109] op_sel:[0,1,0] neg_lo:[1,0,0] neg_hi:[1,0,0]
v_pk_mul_f32 v[42:43], v[42:43], v[148:149] op_sel_hi:[1,0]
v_pk_fma_f32 v[42:43], v[64:65], v[148:149], v[42:43] op_sel:[0,1,0]
v_fmamk_f32 v149, v8, 0x3c000000, v12
v_cos_f32 v148, v149
v_sin_f32 v149, v149
v_pk_mul_f32 v[64:65], v[96:97], v[150:151] op_sel_hi:[1,0]
v_pk_fma_f32 v[64:65], v[58:59], v[150:151], v[64:65] op_sel:[0,1,0] neg_lo:[1,0,0] neg_hi:[1,0,0]
v_pk_mul_f32 v[58:59], v[58:59], v[150:151] op_sel_hi:[1,0]
v_pk_fma_f32 v[58:59], v[96:97], v[150:151], v[58:59] op_sel:[0,1,0]
v_fmamk_f32 v151, v8, 0x3c100000, v12
v_cos_f32 v150, v151
v_sin_f32 v151, v151
v_pk_mul_f32 v[96:97], v[116:117], v[148:149] op_sel_hi:[1,0]
v_pk_fma_f32 v[96:97], v[70:71], v[148:149], v[96:97] op_sel:[0,1,0] neg_lo:[1,0,0] neg_hi:[1,0,0]
v_pk_mul_f32 v[70:71], v[70:71], v[148:149] op_sel_hi:[1,0]
v_pk_fma_f32 v[70:71], v[116:117], v[148:149], v[70:71] op_sel:[0,1,0]
v_fmamk_f32 v149, v8, 0x3c200000, v12
v_cos_f32 v148, v149
v_sin_f32 v149, v149
v_pk_mul_f32 v[116:117], v[28:29], v[150:151] op_sel_hi:[1,0]
v_pk_fma_f32 v[116:117], v[126:127], v[150:151], v[116:117] op_sel:[0,1,0] neg_lo:[1,0,0] neg_hi:[1,0,0]
v_pk_mul_f32 v[126:127], v[126:127], v[150:151] op_sel_hi:[1,0]
v_pk_fma_f32 v[126:127], v[28:29], v[150:151], v[126:127] op_sel:[0,1,0]
v_fmamk_f32 v151, v8, 0x3c300000, v12
v_cos_f32 v150, v151
v_sin_f32 v151, v151
v_pk_mul_f32 v[28:29], v[128:129], v[148:149] op_sel_hi:[1,0]
v_pk_fma_f32 v[28:29], v[106:107], v[148:149], v[28:29] op_sel:[0,1,0] neg_lo:[1,0,0] neg_hi:[1,0,0]
v_pk_mul_f32 v[106:107], v[106:107], v[148:149] op_sel_hi:[1,0]
v_pk_fma_f32 v[106:107], v[128:129], v[148:149], v[106:107] op_sel:[0,1,0]
v_fmamk_f32 v149, v8, 0x3c400000, v12
v_cos_f32 v148, v149
v_sin_f32 v149, v149
v_pk_mul_f32 v[128:129], v[24:25], v[150:151] op_sel_hi:[1,0]
v_pk_fma_f32 v[128:129], v[122:123], v[150:151], v[128:129] op_sel:[0,1,0] neg_lo:[1,0,0] neg_hi:[1,0,0]
v_pk_mul_f32 v[122:123], v[122:123], v[150:151] op_sel_hi:[1,0]
v_pk_fma_f32 v[122:123], v[24:25], v[150:151], v[122:123] op_sel:[0,1,0]
v_fmamk_f32 v151, v8, 0x3c500000, v12
v_cos_f32 v150, v151
v_sin_f32 v151, v151
v_pk_mul_f32 v[24:25], v[80:81], v[148:149] op_sel_hi:[1,0]
v_pk_fma_f32 v[24:25], v[66:67], v[148:149], v[24:25] op_sel:[0,1,0] neg_lo:[1,0,0] neg_hi:[1,0,0]
v_pk_mul_f32 v[66:67], v[66:67], v[148:149] op_sel_hi:[1,0]
v_pk_fma_f32 v[66:67], v[80:81], v[148:149], v[66:67] op_sel:[0,1,0]
v_fmamk_f32 v149, v8, 0x3c600000, v12
v_cos_f32 v148, v149
v_sin_f32 v149, v149
v_pk_mul_f32 v[80:81], v[140:141], v[150:151] op_sel_hi:[1,0]
v_pk_fma_f32 v[80:81], v[98:99], v[150:151], v[80:81] op_sel:[0,1,0] neg_lo:[1,0,0] neg_hi:[1,0,0]
v_pk_mul_f32 v[98:99], v[98:99], v[150:151] op_sel_hi:[1,0]
v_pk_fma_f32 v[98:99], v[140:141], v[150:151], v[98:99] op_sel:[0,1,0]
v_fmamk_f32 v151, v8, 0x3c700000, v12
v_cos_f32 v150, v151
v_sin_f32 v151, v151
v_pk_mul_f32 v[140:141], v[136:137], v[148:149] op_sel_hi:[1,0]
v_pk_fma_f32 v[140:141], v[110:111], v[148:149], v[140:141] op_sel:[0,1,0] neg_lo:[1,0,0] neg_hi:[1,0,0]
v_pk_mul_f32 v[110:111], v[110:111], v[148:149] op_sel_hi:[1,0]
v_pk_fma_f32 v[110:111], v[136:137], v[148:149], v[110:111] op_sel:[0,1,0]
v_fmamk_f32 v149, v8, 0x3c800000, v12
v_cos_f32 v148, v149
v_sin_f32 v149, v149
v_pk_mul_f32 v[136:137], v[20:21], v[150:151] op_sel_hi:[1,0]
v_pk_fma_f32 v[136:137], v[118:119], v[150:151], v[136:137] op_sel:[0,1,0] neg_lo:[1,0,0] neg_hi:[1,0,0]
v_pk_mul_f32 v[118:119], v[118:119], v[150:151] op_sel_hi:[1,0]
v_pk_fma_f32 v[118:119], v[20:21], v[150:151], v[118:119] op_sel:[0,1,0]
v_fmamk_f32 v151, v8, 0x3c880000, v12
v_cos_f32 v150, v151
v_sin_f32 v151, v151
v_pk_mul_f32 v[20:21], v[36:37], v[148:149] op_sel_hi:[1,0]
v_pk_fma_f32 v[20:21], v[134:135], v[148:149], v[20:21] op_sel:[0,1,0] neg_lo:[1,0,0] neg_hi:[1,0,0]
v_pk_mul_f32 v[134:135], v[134:135], v[148:149] op_sel_hi:[1,0]
v_pk_fma_f32 v[134:135], v[36:37], v[148:149], v[134:135] op_sel:[0,1,0]
v_fmamk_f32 v149, v8, 0x3c900000, v12
v_cos_f32 v148, v149
v_sin_f32 v149, v149
v_pk_mul_f32 v[36:37], v[72:73], v[150:151] op_sel_hi:[1,0]
v_pk_fma_f32 v[36:37], v[138:139], v[150:151], v[36:37] op_sel:[0,1,0] neg_lo:[1,0,0] neg_hi:[1,0,0]
v_pk_mul_f32 v[138:139], v[138:139], v[150:151] op_sel_hi:[1,0]
v_pk_fma_f32 v[138:139], v[72:73], v[150:151], v[138:139] op_sel:[0,1,0]
v_fmamk_f32 v151, v8, 0x3c980000, v12
v_cos_f32 v150, v151
v_sin_f32 v151, v151
v_pk_mul_f32 v[72:73], v[144:145], v[148:149] op_sel_hi:[1,0]
v_pk_fma_f32 v[72:73], v[130:131], v[148:149], v[72:73] op_sel:[0,1,0] neg_lo:[1,0,0] neg_hi:[1,0,0]
v_pk_mul_f32 v[130:131], v[130:131], v[148:149] op_sel_hi:[1,0]
v_pk_fma_f32 v[130:131], v[144:145], v[148:149], v[130:131] op_sel:[0,1,0]
v_fmamk_f32 v149, v8, 0x3ca00000, v12
v_cos_f32 v148, v149
v_sin_f32 v149, v149
v_pk_mul_f32 v[144:145], v[48:49], v[150:151] op_sel_hi:[1,0]
v_pk_fma_f32 v[144:145], v[26:27], v[150:151], v[144:145] op_sel:[0,1,0] neg_lo:[1,0,0] neg_hi:[1,0,0]
v_pk_mul_f32 v[26:27], v[26:27], v[150:151] op_sel_hi:[1,0]
v_pk_fma_f32 v[26:27], v[48:49], v[150:151], v[26:27] op_sel:[0,1,0]
v_fmamk_f32 v151, v8, 0x3ca80000, v12
v_cos_f32 v150, v151
v_sin_f32 v151, v151
v_pk_mul_f32 v[48:49], v[16:17], v[148:149] op_sel_hi:[1,0]
v_pk_fma_f32 v[48:49], v[114:115], v[148:149], v[48:49] op_sel:[0,1,0] neg_lo:[1,0,0] neg_hi:[1,0,0]
v_pk_mul_f32 v[114:115], v[114:115], v[148:149] op_sel_hi:[1,0]
v_pk_fma_f32 v[114:115], v[16:17], v[148:149], v[114:115] op_sel:[0,1,0]
v_fmamk_f32 v149, v8, 0x3cb00000, v12
v_cos_f32 v148, v149
v_sin_f32 v149, v149
v_pk_mul_f32 v[16:17], v[124:125], v[150:151] op_sel_hi:[1,0]
v_pk_fma_f32 v[16:17], v[34:35], v[150:151], v[16:17] op_sel:[0,1,0] neg_lo:[1,0,0] neg_hi:[1,0,0]
v_pk_mul_f32 v[34:35], v[34:35], v[150:151] op_sel_hi:[1,0]
v_pk_fma_f32 v[34:35], v[124:125], v[150:151], v[34:35] op_sel:[0,1,0]
v_fmamk_f32 v151, v8, 0x3cb80000, v12
v_cos_f32 v150, v151
v_sin_f32 v151, v151
v_pk_mul_f32 v[124:125], v[104:105], v[148:149] op_sel_hi:[1,0]
v_pk_fma_f32 v[124:125], v[46:47], v[148:149], v[124:125] op_sel:[0,1,0] neg_lo:[1,0,0] neg_hi:[1,0,0]
v_pk_mul_f32 v[46:47], v[46:47], v[148:149] op_sel_hi:[1,0]
v_pk_fma_f32 v[46:47], v[104:105], v[148:149], v[46:47] op_sel:[0,1,0]
v_fmamk_f32 v149, v8, 0x3cc00000, v12
v_cos_f32 v148, v149
v_sin_f32 v149, v149
v_pk_mul_f32 v[104:105], v[120:121], v[150:151] op_sel_hi:[1,0]
v_pk_fma_f32 v[104:105], v[54:55], v[150:151], v[104:105] op_sel:[0,1,0] neg_lo:[1,0,0] neg_hi:[1,0,0]
v_pk_mul_f32 v[54:55], v[54:55], v[150:151] op_sel_hi:[1,0]
v_pk_fma_f32 v[54:55], v[120:121], v[150:151], v[54:55] op_sel:[0,1,0]
v_fmamk_f32 v151, v8, 0x3cc80000, v12
v_cos_f32 v150, v151
v_sin_f32 v151, v151
v_pk_mul_f32 v[120:121], v[68:69], v[148:149] op_sel_hi:[1,0]
v_pk_fma_f32 v[120:121], v[146:147], v[148:149], v[120:121] op_sel:[0,1,0] neg_lo:[1,0,0] neg_hi:[1,0,0]
v_pk_mul_f32 v[146:147], v[146:147], v[148:149] op_sel_hi:[1,0]
v_pk_fma_f32 v[146:147], v[68:69], v[148:149], v[146:147] op_sel:[0,1,0]
v_fmamk_f32 v149, v8, 0x3cd00000, v12
v_cos_f32 v148, v149
v_sin_f32 v149, v149
v_pk_mul_f32 v[68:69], v[60:61], v[150:151] op_sel_hi:[1,0]
v_pk_fma_f32 v[68:69], v[50:51], v[150:151], v[68:69] op_sel:[0,1,0] neg_lo:[1,0,0] neg_hi:[1,0,0]
v_pk_mul_f32 v[50:51], v[50:51], v[150:151] op_sel_hi:[1,0]
v_pk_fma_f32 v[50:51], v[60:61], v[150:151], v[50:51] op_sel:[0,1,0]
v_fmamk_f32 v151, v8, 0x3cd80000, v12
v_cos_f32 v150, v151
v_sin_f32 v151, v151
v_pk_mul_f32 v[60:61], v[40:41], v[148:149] op_sel_hi:[1,0]
v_pk_fma_f32 v[60:61], v[78:79], v[148:149], v[60:61] op_sel:[0,1,0] neg_lo:[1,0,0] neg_hi:[1,0,0]
v_pk_mul_f32 v[78:79], v[78:79], v[148:149] op_sel_hi:[1,0]
v_pk_fma_f32 v[78:79], v[40:41], v[148:149], v[78:79] op_sel:[0,1,0]
v_fmamk_f32 v149, v8, 0x3ce00000, v12
v_cos_f32 v148, v149
v_sin_f32 v149, v149
v_pk_mul_f32 v[40:41], v[56:57], v[150:151] op_sel_hi:[1,0]
v_pk_fma_f32 v[40:41], v[86:87], v[150:151], v[40:41] op_sel:[0,1,0] neg_lo:[1,0,0] neg_hi:[1,0,0]
v_pk_mul_f32 v[86:87], v[86:87], v[150:151] op_sel_hi:[1,0]
v_pk_fma_f32 v[86:87], v[56:57], v[150:151], v[86:87] op_sel:[0,1,0]
v_fmamk_f32 v151, v8, 0x3ce80000, v12
v_cos_f32 v150, v151
v_sin_f32 v151, v151
v_pk_mul_f32 v[56:57], v[112:113], v[148:149] op_sel_hi:[1,0]
v_pk_fma_f32 v[56:57], v[74:75], v[148:149], v[56:57] op_sel:[0,1,0] neg_lo:[1,0,0] neg_hi:[1,0,0]
v_pk_mul_f32 v[74:75], v[74:75], v[148:149] op_sel_hi:[1,0]
v_pk_fma_f32 v[74:75], v[112:113], v[148:149], v[74:75] op_sel:[0,1,0]
v_fmamk_f32 v149, v8, 0x3cf00000, v12
v_cos_f32 v148, v149
v_sin_f32 v149, v149
v_pk_mul_f32 v[112:113], v[32:33], v[150:151] op_sel_hi:[1,0]
v_pk_fma_f32 v[112:113], v[90:91], v[150:151], v[112:113] op_sel:[0,1,0] neg_lo:[1,0,0] neg_hi:[1,0,0]
v_pk_mul_f32 v[90:91], v[90:91], v[150:151] op_sel_hi:[1,0]
v_pk_fma_f32 v[90:91], v[32:33], v[150:151], v[90:91] op_sel:[0,1,0]
v_fmamk_f32 v151, v8, 0x3cf80000, v12
v_cos_f32 v150, v151
v_sin_f32 v151, v151
v_pk_mul_f32 v[32:33], v[44:45], v[148:149] op_sel_hi:[1,0]
v_pk_fma_f32 v[32:33], v[94:95], v[148:149], v[32:33] op_sel:[0,1,0] neg_lo:[1,0,0] neg_hi:[1,0,0]
v_pk_mul_f32 v[94:95], v[94:95], v[148:149] op_sel_hi:[1,0]
v_pk_fma_f32 v[94:95], v[44:45], v[148:149], v[94:95] op_sel:[0,1,0]
s_nop 0
v_pk_mul_f32 v[44:45], v[52:53], v[150:151] op_sel_hi:[1,0]
v_pk_fma_f32 v[44:45], v[102:103], v[150:151], v[44:45] op_sel:[0,1,0] neg_lo:[1,0,0] neg_hi:[1,0,0]
v_pk_mul_f32 v[102:103], v[102:103], v[150:151] op_sel_hi:[1,0]
v_pk_fma_f32 v[102:103], v[52:53], v[150:151], v[102:103] op_sel:[0,1,0]
ds_write_b64 v4, v[92:93]
ds_write_b64 v4, v[18:19] offset:8
ds_write_b64 v4, v[132:133] offset:32
ds_write_b64 v4, v[82:83] offset:40
ds_write_b64 v4, v[100:101] offset:64
ds_write_b64 v4, v[22:23] offset:72
ds_write_b64 v4, v[88:89] offset:96
ds_write_b64 v4, v[30:31] offset:104
ds_write_b64 v4, v[76:77] offset:128
ds_write_b64 v4, v[38:39] offset:136
ds_write_b64 v4, v[84:85] offset:160
ds_write_b64 v4, v[62:63] offset:168
ds_write_b64 v4, v[108:109] offset:192
ds_write_b64 v4, v[42:43] offset:200
ds_write_b64 v4, v[64:65] offset:224
ds_write_b64 v4, v[58:59] offset:232
ds_write_b64 v4, v[96:97] offset:256
ds_write_b64 v4, v[70:71] offset:264
ds_write_b64 v4, v[116:117] offset:288
ds_write_b64 v4, v[126:127] offset:296
ds_write_b64 v4, v[28:29] offset:320
ds_write_b64 v4, v[106:107] offset:328
ds_write_b64 v4, v[128:129] offset:352
ds_write_b64 v4, v[122:123] offset:360
ds_write_b64 v4, v[24:25] offset:384
ds_write_b64 v4, v[66:67] offset:392
ds_write_b64 v4, v[80:81] offset:416
ds_write_b64 v4, v[98:99] offset:424
ds_write_b64 v4, v[140:141] offset:448
ds_write_b64 v4, v[110:111] offset:456
ds_write_b64 v4, v[136:137] offset:480
ds_write_b64 v4, v[118:119] offset:488
ds_write_b64 v4, v[20:21] offset:512
ds_write_b64 v4, v[134:135] offset:520
ds_write_b64 v4, v[36:37] offset:544
ds_write_b64 v4, v[138:139] offset:552
ds_write_b64 v4, v[72:73] offset:576
ds_write_b64 v4, v[130:131] offset:584
ds_write_b64 v4, v[144:145] offset:608
ds_write_b64 v4, v[26:27] offset:616
ds_write_b64 v4, v[48:49] offset:640
ds_write_b64 v4, v[114:115] offset:648
ds_write_b64 v4, v[16:17] offset:672
ds_write_b64 v4, v[34:35] offset:680
ds_write_b64 v4, v[124:125] offset:704
ds_write_b64 v4, v[46:47] offset:712
ds_write_b64 v4, v[104:105] offset:736
ds_write_b64 v4, v[54:55] offset:744
ds_write_b64 v4, v[120:121] offset:768
ds_write_b64 v4, v[146:147] offset:776
ds_write_b64 v4, v[68:69] offset:800
ds_write_b64 v4, v[50:51] offset:808
ds_write_b64 v4, v[60:61] offset:832
ds_write_b64 v4, v[78:79] offset:840
ds_write_b64 v4, v[40:41] offset:864
ds_write_b64 v4, v[86:87] offset:872
ds_write_b64 v4, v[56:57] offset:896
ds_write_b64 v4, v[74:75] offset:904
ds_write_b64 v4, v[112:113] offset:928
ds_write_b64 v4, v[90:91] offset:936
ds_write_b64 v4, v[32:33] offset:960
ds_write_b64 v4, v[94:95] offset:968
ds_write_b64 v4, v[44:45] offset:992
ds_write_b64 v4, v[102:103] offset:1000
s_waitcnt lgkmcnt(0)
ds_read_b128 v[16:19], v3
ds_read_b128 v[20:23], v3 offset:1056
ds_read_b128 v[24:27], v3 offset:2112
ds_read_b128 v[28:31], v3 offset:3168
ds_read_b128 v[32:35], v3 offset:4224
ds_read_b128 v[36:39], v3 offset:5280
ds_read_b128 v[40:43], v3 offset:6336
ds_read_b128 v[44:47], v3 offset:7392
ds_read_b128 v[48:51], v3 offset:8448
ds_read_b128 v[52:55], v3 offset:9504
ds_read_b128 v[56:59], v3 offset:10560
ds_read_b128 v[60:63], v3 offset:11616
s_waitcnt lgkmcnt(4)
ds_read_b128 v[64:67], v3 offset:12672
ds_read_b128 v[68:71], v3 offset:13728
ds_read_b128 v[72:75], v3 offset:14784
ds_read_b128 v[76:79], v3 offset:15840
ds_read_b128 v[80:83], v3 offset:16896
ds_read_b128 v[84:87], v3 offset:17952
ds_read_b128 v[88:91], v3 offset:19008
ds_read_b128 v[92:95], v3 offset:20064
ds_read_b128 v[96:99], v3 offset:21120
ds_read_b128 v[100:103], v3 offset:22176
ds_read_b128 v[104:107], v3 offset:23232
ds_read_b128 v[108:111], v3 offset:24288
s_waitcnt lgkmcnt(4)
ds_read_b128 v[112:115], v3 offset:25344
ds_read_b128 v[116:119], v3 offset:26400
ds_read_b128 v[120:123], v3 offset:27456
ds_read_b128 v[124:127], v3 offset:28512
ds_read_b128 v[128:131], v3 offset:29568
ds_read_b128 v[132:135], v3 offset:30624
ds_read_b128 v[136:139], v3 offset:31680
ds_read_b128 v[140:143], v3 offset:32736
s_waitcnt lgkmcnt(0)
v_pk_add_f32 v[144:145], v[16:17], v[80:81] neg_lo:[0,1] neg_hi:[0,1]
v_pk_add_f32 v[146:147], v[18:19], v[82:83] neg_lo:[0,1] neg_hi:[0,1]
v_pk_add_f32 v[16:17], v[16:17], v[80:81]
v_pk_add_f32 v[18:19], v[18:19], v[82:83]
v_pk_add_f32 v[80:81], v[20:21], v[84:85] neg_lo:[0,1] neg_hi:[0,1]
v_pk_add_f32 v[82:83], v[22:23], v[86:87] neg_lo:[0,1] neg_hi:[0,1]
v_pk_add_f32 v[20:21], v[20:21], v[84:85]
v_pk_add_f32 v[22:23], v[22:23], v[86:87]
v_pk_mul_f32 v[84:85], v[80:81], s[30:31] op_sel_hi:[1,0]
v_pk_mul_f32 v[86:87], v[80:81], s[36:37] op_sel_hi:[1,0]
v_pk_fma_f32 v[84:85], v[82:83], s[36:37], v[84:85] op_sel_hi:[1,0,1] neg_lo:[0,1,0] neg_hi:[0,1,0]
v_pk_fma_f32 v[86:87], v[82:83], s[30:31], v[86:87] op_sel_hi:[1,0,1]
v_pk_add_f32 v[80:81], v[24:25], v[88:89] neg_lo:[0,1] neg_hi:[0,1]
v_pk_add_f32 v[82:83], v[26:27], v[90:91] neg_lo:[0,1] neg_hi:[0,1]
v_pk_add_f32 v[24:25], v[24:25], v[88:89]
v_pk_add_f32 v[26:27], v[26:27], v[90:91]
v_pk_mul_f32 v[88:89], v[80:81], s[30:31] op_sel:[0,1]
v_pk_mul_f32 v[90:91], v[80:81], s[34:35] op_sel:[0,1]
v_pk_fma_f32 v[88:89], v[82:83], s[34:35], v[88:89] op_sel:[0,1,0] neg_lo:[0,1,0] neg_hi:[0,1,0]
v_pk_fma_f32 v[90:91], v[82:83], s[30:31], v[90:91] op_sel:[0,1,0]
v_pk_add_f32 v[80:81], v[28:29], v[92:93] neg_lo:[0,1] neg_hi:[0,1]
v_pk_add_f32 v[82:83], v[30:31], v[94:95] neg_lo:[0,1] neg_hi:[0,1]
v_pk_add_f32 v[28:29], v[28:29], v[92:93]
v_pk_add_f32 v[30:31], v[30:31], v[94:95]
v_pk_mul_f32 v[92:93], v[80:81], s[32:33] op_sel_hi:[1,0]
v_pk_mul_f32 v[94:95], v[80:81], s[34:35] op_sel_hi:[1,0]
v_pk_fma_f32 v[92:93], v[82:83], s[34:35], v[92:93] op_sel_hi:[1,0,1] neg_lo:[0,1,0] neg_hi:[0,1,0]
v_pk_fma_f32 v[94:95], v[82:83], s[32:33], v[94:95] op_sel_hi:[1,0,1]
v_pk_add_f32 v[80:81], v[32:33], v[96:97] neg_lo:[0,1] neg_hi:[0,1]
v_pk_add_f32 v[82:83], v[34:35], v[98:99] neg_lo:[0,1] neg_hi:[0,1]
v_pk_add_f32 v[32:33], v[32:33], v[96:97]
v_pk_add_f32 v[34:35], v[34:35], v[98:99]
v_pk_mul_f32 v[96:97], v[80:81], s[32:33] op_sel:[0,1]
v_pk_mul_f32 v[98:99], v[80:81], s[32:33] op_sel:[0,1]
v_pk_fma_f32 v[96:97], v[82:83], s[32:33], v[96:97] op_sel:[0,1,0] neg_lo:[0,1,0] neg_hi:[0,1,0]
v_pk_fma_f32 v[98:99], v[82:83], s[32:33], v[98:99] op_sel:[0,1,0]
v_pk_add_f32 v[80:81], v[36:37], v[100:101] neg_lo:[0,1] neg_hi:[0,1]
v_pk_add_f32 v[82:83], v[38:39], v[102:103] neg_lo:[0,1] neg_hi:[0,1]
v_pk_add_f32 v[36:37], v[36:37], v[100:101]
v_pk_add_f32 v[38:39], v[38:39], v[102:103]
v_pk_mul_f32 v[100:101], v[80:81], s[34:35] op_sel_hi:[1,0]
v_pk_mul_f32 v[102:103], v[80:81], s[32:33] op_sel_hi:[1,0]
v_pk_fma_f32 v[100:101], v[82:83], s[32:33], v[100:101] op_sel_hi:[1,0,1] neg_lo:[0,1,0] neg_hi:[0,1,0]
v_pk_fma_f32 v[102:103], v[82:83], s[34:35], v[102:103] op_sel_hi:[1,0,1]
v_pk_add_f32 v[80:81], v[40:41], v[104:105] neg_lo:[0,1] neg_hi:[0,1]
v_pk_add_f32 v[82:83], v[42:43], v[106:107] neg_lo:[0,1] neg_hi:[0,1]
v_pk_add_f32 v[40:41], v[40:41], v[104:105]
v_pk_add_f32 v[42:43], v[42:43], v[106:107]
v_pk_mul_f32 v[104:105], v[80:81], s[34:35] op_sel:[0,1]
v_pk_mul_f32 v[106:107], v[80:81], s[30:31] op_sel:[0,1]
v_pk_fma_f32 v[104:105], v[82:83], s[30:31], v[104:105] op_sel:[0,1,0] neg_lo:[0,1,0] neg_hi:[0,1,0]
v_pk_fma_f32 v[106:107], v[82:83], s[34:35], v[106:107] op_sel:[0,1,0]
v_pk_add_f32 v[80:81], v[44:45], v[108:109] neg_lo:[0,1] neg_hi:[0,1]
v_pk_add_f32 v[82:83], v[46:47], v[110:111] neg_lo:[0,1] neg_hi:[0,1]
v_pk_add_f32 v[44:45], v[44:45], v[108:109]
v_pk_add_f32 v[46:47], v[46:47], v[110:111]
v_pk_mul_f32 v[108:109], v[80:81], s[36:37] op_sel_hi:[1,0]
v_pk_mul_f32 v[110:111], v[80:81], s[30:31] op_sel_hi:[1,0]
v_pk_fma_f32 v[108:109], v[82:83], s[30:31], v[108:109] op_sel_hi:[1,0,1] neg_lo:[0,1,0] neg_hi:[0,1,0]
v_pk_fma_f32 v[110:111], v[82:83], s[36:37], v[110:111] op_sel_hi:[1,0,1]
v_pk_add_f32 v[80:81], v[114:115], v[50:51] neg_lo:[0,1] neg_hi:[0,1]
v_pk_add_f32 v[82:83], v[48:49], v[112:113] neg_lo:[0,1] neg_hi:[0,1]
v_pk_add_f32 v[48:49], v[48:49], v[112:113]
v_pk_add_f32 v[50:51], v[50:51], v[114:115]
v_pk_add_f32 v[112:113], v[52:53], v[116:117] neg_lo:[0,1] neg_hi:[0,1]
v_pk_add_f32 v[114:115], v[54:55], v[118:119] neg_lo:[0,1] neg_hi:[0,1]
v_pk_add_f32 v[52:53], v[52:53], v[116:117]
v_pk_add_f32 v[54:55], v[54:55], v[118:119]
v_pk_mul_f32 v[116:117], v[112:113], s[36:37] op_sel_hi:[1,0] neg_lo:[0,1] neg_hi:[0,1]
v_pk_mul_f32 v[118:119], v[112:113], s[30:31] op_sel_hi:[1,0]
v_pk_fma_f32 v[116:117], v[114:115], s[30:31], v[116:117] op_sel_hi:[1,0,1] neg_lo:[0,1,0] neg_hi:[0,1,0]
v_pk_fma_f32 v[118:119], v[114:115], s[36:37], v[118:119] op_sel_hi:[1,0,1] neg_lo:[0,1,0] neg_hi:[0,1,0]
v_pk_add_f32 v[112:113], v[56:57], v[120:121] neg_lo:[0,1] neg_hi:[0,1]
v_pk_add_f32 v[114:115], v[58:59], v[122:123] neg_lo:[0,1] neg_hi:[0,1]
v_pk_add_f32 v[56:57], v[56:57], v[120:121]
v_pk_add_f32 v[58:59], v[58:59], v[122:123]
v_pk_mul_f32 v[120:121], v[112:113], s[34:35] op_sel:[0,1] neg_lo:[0,1] neg_hi:[0,1]
v_pk_mul_f32 v[122:123], v[112:113], s[30:31] op_sel:[0,1]
v_pk_fma_f32 v[120:121], v[114:115], s[30:31], v[120:121] op_sel:[0,1,0] neg_lo:[0,1,0] neg_hi:[0,1,0]
v_pk_fma_f32 v[122:123], v[114:115], s[34:35], v[122:123] op_sel:[0,1,0] neg_lo:[0,1,0] neg_hi:[0,1,0]
v_pk_add_f32 v[112:113], v[60:61], v[124:125] neg_lo:[0,1] neg_hi:[0,1]
v_pk_add_f32 v[114:115], v[62:63], v[126:127] neg_lo:[0,1] neg_hi:[0,1]
v_pk_add_f32 v[60:61], v[60:61], v[124:125]
v_pk_add_f32 v[62:63], v[62:63], v[126:127]
v_pk_mul_f32 v[124:125], v[112:113], s[34:35] op_sel_hi:[1,0] neg_lo:[0,1] neg_hi:[0,1]
v_pk_mul_f32 v[126:127], v[112:113], s[32:33] op_sel_hi:[1,0]
v_pk_fma_f32 v[124:125], v[114:115], s[32:33], v[124:125] op_sel_hi:[1,0,1] neg_lo:[0,1,0] neg_hi:[0,1,0]
v_pk_fma_f32 v[126:127], v[114:115], s[34:35], v[126:127] op_sel_hi:[1,0,1] neg_lo:[0,1,0] neg_hi:[0,1,0]
v_pk_add_f32 v[112:113], v[64:65], v[128:129] neg_lo:[0,1] neg_hi:[0,1]
v_pk_add_f32 v[114:115], v[66:67], v[130:131] neg_lo:[0,1] neg_hi:[0,1]
v_pk_add_f32 v[64:65], v[64:65], v[128:129]
v_pk_add_f32 v[66:67], v[66:67], v[130:131]
v_pk_mul_f32 v[128:129], v[112:113], s[32:33] op_sel:[0,1] neg_lo:[0,1] neg_hi:[0,1]
v_pk_mul_f32 v[130:131], v[112:113], s[32:33] op_sel:[0,1]
v_pk_fma_f32 v[128:129], v[114:115], s[32:33], v[128:129] op_sel:[0,1,0] neg_lo:[0,1,0] neg_hi:[0,1,0]
v_pk_fma_f32 v[130:131], v[114:115], s[32:33], v[130:131] op_sel:[0,1,0] neg_lo:[0,1,0] neg_hi:[0,1,0]
v_pk_add_f32 v[112:113], v[68:69], v[132:133] neg_lo:[0,1] neg_hi:[0,1]
v_pk_add_f32 v[114:115], v[70:71], v[134:135] neg_lo:[0,1] neg_hi:[0,1]
v_pk_add_f32 v[68:69], v[68:69], v[132:133]
v_pk_add_f32 v[70:71], v[70:71], v[134:135]
v_pk_mul_f32 v[132:133], v[112:113], s[32:33] op_sel_hi:[1,0] neg_lo:[0,1] neg_hi:[0,1]
v_pk_mul_f32 v[134:135], v[112:113], s[34:35] op_sel_hi:[1,0]
v_pk_fma_f32 v[132:133], v[114:115], s[34:35], v[132:133] op_sel_hi:[1,0,1] neg_lo:[0,1,0] neg_hi:[0,1,0]
v_pk_fma_f32 v[134:135], v[114:115], s[32:33], v[134:135] op_sel_hi:[1,0,1] neg_lo:[0,1,0] neg_hi:[0,1,0]
v_pk_add_f32 v[112:113], v[72:73], v[136:137] neg_lo:[0,1] neg_hi:[0,1]
v_pk_add_f32 v[114:115], v[74:75], v[138:139] neg_lo:[0,1] neg_hi:[0,1]
v_pk_add_f32 v[72:73], v[72:73], v[136:137]
v_pk_add_f32 v[74:75], v[74:75], v[138:139]
v_pk_mul_f32 v[136:137], v[112:113], s[30:31] op_sel:[0,1] neg_lo:[0,1] neg_hi:[0,1]
v_pk_mul_f32 v[138:139], v[112:113], s[34:35] op_sel:[0,1]
v_pk_fma_f32 v[136:137], v[114:115], s[34:35], v[136:137] op_sel:[0,1,0] neg_lo:[0,1,0] neg_hi:[0,1,0]
v_pk_fma_f32 v[138:139], v[114:115], s[30:31], v[138:139] op_sel:[0,1,0] neg_lo:[0,1,0] neg_hi:[0,1,0]
v_pk_add_f32 v[112:113], v[76:77], v[140:141] neg_lo:[0,1] neg_hi:[0,1]
v_pk_add_f32 v[114:115], v[78:79], v[142:143] neg_lo:[0,1] neg_hi:[0,1]
v_pk_add_f32 v[76:77], v[76:77], v[140:141]
v_pk_add_f32 v[78:79], v[78:79], v[142:143]
v_pk_mul_f32 v[140:141], v[112:113], s[30:31] op_sel_hi:[1,0] neg_lo:[0,1] neg_hi:[0,1]
v_pk_mul_f32 v[142:143], v[112:113], s[36:37] op_sel_hi:[1,0]
v_pk_fma_f32 v[140:141], v[114:115], s[36:37], v[140:141] op_sel_hi:[1,0,1] neg_lo:[0,1,0] neg_hi:[0,1,0]
v_pk_fma_f32 v[142:143], v[114:115], s[30:31], v[142:143] op_sel_hi:[1,0,1] neg_lo:[0,1,0] neg_hi:[0,1,0]
v_pk_add_f32 v[112:113], v[16:17], v[48:49] neg_lo:[0,1] neg_hi:[0,1]
v_pk_add_f32 v[114:115], v[18:19], v[50:51] neg_lo:[0,1] neg_hi:[0,1]
v_pk_add_f32 v[16:17], v[16:17], v[48:49]
v_pk_add_f32 v[18:19], v[18:19], v[50:51]
v_pk_add_f32 v[48:49], v[20:21], v[52:53] neg_lo:[0,1] neg_hi:[0,1]
v_pk_add_f32 v[50:51], v[22:23], v[54:55] neg_lo:[0,1] neg_hi:[0,1]
v_pk_add_f32 v[20:21], v[20:21], v[52:53]
v_pk_add_f32 v[22:23], v[22:23], v[54:55]
v_pk_mul_f32 v[52:53], v[48:49], s[30:31] op_sel:[0,1]
v_pk_mul_f32 v[54:55], v[48:49], s[34:35] op_sel:[0,1]
v_pk_fma_f32 v[52:53], v[50:51], s[34:35], v[52:53] op_sel:[0,1,0] neg_lo:[0,1,0] neg_hi:[0,1,0]
v_pk_fma_f32 v[54:55], v[50:51], s[30:31], v[54:55] op_sel:[0,1,0]
v_pk_add_f32 v[48:49], v[24:25], v[56:57] neg_lo:[0,1] neg_hi:[0,1]
v_pk_add_f32 v[50:51], v[26:27], v[58:59] neg_lo:[0,1] neg_hi:[0,1]
v_pk_add_f32 v[24:25], v[24:25], v[56:57]
v_pk_add_f32 v[26:27], v[26:27], v[58:59]
v_pk_mul_f32 v[56:57], v[48:49], s[32:33] op_sel:[0,1]
v_pk_mul_f32 v[58:59], v[48:49], s[32:33] op_sel:[0,1]
v_pk_fma_f32 v[56:57], v[50:51], s[32:33], v[56:57] op_sel:[0,1,0] neg_lo:[0,1,0] neg_hi:[0,1,0]
v_pk_fma_f32 v[58:59], v[50:51], s[32:33], v[58:59] op_sel:[0,1,0]
v_pk_add_f32 v[48:49], v[28:29], v[60:61] neg_lo:[0,1] neg_hi:[0,1]
v_pk_add_f32 v[50:51], v[30:31], v[62:63] neg_lo:[0,1] neg_hi:[0,1]
v_pk_add_f32 v[28:29], v[28:29], v[60:61]
v_pk_add_f32 v[30:31], v[30:31], v[62:63]
v_pk_mul_f32 v[60:61], v[48:49], s[34:35] op_sel:[0,1]
v_pk_mul_f32 v[62:63], v[48:49], s[30:31] op_sel:[0,1]
v_pk_fma_f32 v[60:61], v[50:51], s[30:31], v[60:61] op_sel:[0,1,0] neg_lo:[0,1,0] neg_hi:[0,1,0]
v_pk_fma_f32 v[62:63], v[50:51], s[34:35], v[62:63] op_sel:[0,1,0]
v_pk_add_f32 v[48:49], v[66:67], v[34:35] neg_lo:[0,1] neg_hi:[0,1]
v_pk_add_f32 v[50:51], v[32:33], v[64:65] neg_lo:[0,1] neg_hi:[0,1]
v_pk_add_f32 v[32:33], v[32:33], v[64:65]
v_pk_add_f32 v[34:35], v[34:35], v[66:67]
v_pk_add_f32 v[64:65], v[36:37], v[68:69] neg_lo:[0,1] neg_hi:[0,1]
v_pk_add_f32 v[66:67], v[38:39], v[70:71] neg_lo:[0,1] neg_hi:[0,1]
v_pk_add_f32 v[36:37], v[36:37], v[68:69]
v_pk_add_f32 v[38:39], v[38:39], v[70:71]
v_pk_mul_f32 v[68:69], v[64:65], s[34:35] op_sel:[0,1] neg_lo:[0,1] neg_hi:[0,1]
v_pk_mul_f32 v[70:71], v[64:65], s[30:31] op_sel:[0,1]
v_pk_fma_f32 v[68:69], v[66:67], s[30:31], v[68:69] op_sel:[0,1,0] neg_lo:[0,1,0] neg_hi:[0,1,0]
v_pk_fma_f32 v[70:71], v[66:67], s[34:35], v[70:71] op_sel:[0,1,0] neg_lo:[0,1,0] neg_hi:[0,1,0]
v_pk_add_f32 v[64:65], v[40:41], v[72:73] neg_lo:[0,1] neg_hi:[0,1]
v_pk_add_f32 v[66:67], v[42:43], v[74:75] neg_lo:[0,1] neg_hi:[0,1]
v_pk_add_f32 v[40:41], v[40:41], v[72:73]
v_pk_add_f32 v[42:43], v[42:43], v[74:75]
v_pk_mul_f32 v[72:73], v[64:65], s[32:33] op_sel:[0,1] neg_lo:[0,1] neg_hi:[0,1]
v_pk_mul_f32 v[74:75], v[64:65], s[32:33] op_sel:[0,1]
v_pk_fma_f32 v[72:73], v[66:67], s[32:33], v[72:73] op_sel:[0,1,0] neg_lo:[0,1,0] neg_hi:[0,1,0]
v_pk_fma_f32 v[74:75], v[66:67], s[32:33], v[74:75] op_sel:[0,1,0] neg_lo:[0,1,0] neg_hi:[0,1,0]
v_pk_add_f32 v[64:65], v[44:45], v[76:77] neg_lo:[0,1] neg_hi:[0,1]
v_pk_add_f32 v[66:67], v[46:47], v[78:79] neg_lo:[0,1] neg_hi:[0,1]
v_pk_add_f32 v[44:45], v[44:45], v[76:77]
v_pk_add_f32 v[46:47], v[46:47], v[78:79]
v_pk_mul_f32 v[76:77], v[64:65], s[30:31] op_sel:[0,1] neg_lo:[0,1] neg_hi:[0,1]
v_pk_mul_f32 v[78:79], v[64:65], s[34:35] op_sel:[0,1]
v_pk_fma_f32 v[76:77], v[66:67], s[34:35], v[76:77] op_sel:[0,1,0] neg_lo:[0,1,0] neg_hi:[0,1,0]
v_pk_fma_f32 v[78:79], v[66:67], s[30:31], v[78:79] op_sel:[0,1,0] neg_lo:[0,1,0] neg_hi:[0,1,0]
v_pk_add_f32 v[64:65], v[144:145], v[80:81] neg_lo:[0,1] neg_hi:[0,1]
v_pk_add_f32 v[66:67], v[146:147], v[82:83] neg_lo:[0,1] neg_hi:[0,1]
v_pk_add_f32 v[144:145], v[144:145], v[80:81]
v_pk_add_f32 v[146:147], v[146:147], v[82:83]
v_pk_add_f32 v[80:81], v[84:85], v[116:117] neg_lo:[0,1] neg_hi:[0,1]
v_pk_add_f32 v[82:83], v[86:87], v[118:119] neg_lo:[0,1] neg_hi:[0,1]
v_pk_add_f32 v[84:85], v[84:85], v[116:117]
v_pk_add_f32 v[86:87], v[86:87], v[118:119]
v_pk_mul_f32 v[116:117], v[80:81], s[30:31] op_sel:[0,1]
v_pk_mul_f32 v[118:119], v[80:81], s[34:35] op_sel:[0,1]
v_pk_fma_f32 v[116:117], v[82:83], s[34:35], v[116:117] op_sel:[0,1,0] neg_lo:[0,1,0] neg_hi:[0,1,0]
v_pk_fma_f32 v[118:119], v[82:83], s[30:31], v[118:119] op_sel:[0,1,0]
v_pk_add_f32 v[80:81], v[88:89], v[120:121] neg_lo:[0,1] neg_hi:[0,1]
v_pk_add_f32 v[82:83], v[90:91], v[122:123] neg_lo:[0,1] neg_hi:[0,1]
v_pk_add_f32 v[88:89], v[88:89], v[120:121]
v_pk_add_f32 v[90:91], v[90:91], v[122:123]
v_pk_mul_f32 v[120:121], v[80:81], s[32:33] op_sel:[0,1]
v_pk_mul_f32 v[122:123], v[80:81], s[32:33] op_sel:[0,1]
v_pk_fma_f32 v[120:121], v[82:83], s[32:33], v[120:121] op_sel:[0,1,0] neg_lo:[0,1,0] neg_hi:[0,1,0]
v_pk_fma_f32 v[122:123], v[82:83], s[32:33], v[122:123] op_sel:[0,1,0]
v_pk_add_f32 v[80:81], v[92:93], v[124:125] neg_lo:[0,1] neg_hi:[0,1]
v_pk_add_f32 v[82:83], v[94:95], v[126:127] neg_lo:[0,1] neg_hi:[0,1]
v_pk_add_f32 v[92:93], v[92:93], v[124:125]
v_pk_add_f32 v[94:95], v[94:95], v[126:127]
v_pk_mul_f32 v[124:125], v[80:81], s[34:35] op_sel:[0,1]
v_pk_mul_f32 v[126:127], v[80:81], s[30:31] op_sel:[0,1]
v_pk_fma_f32 v[124:125], v[82:83], s[30:31], v[124:125] op_sel:[0,1,0] neg_lo:[0,1,0] neg_hi:[0,1,0]
v_pk_fma_f32 v[126:127], v[82:83], s[34:35], v[126:127] op_sel:[0,1,0]
v_pk_add_f32 v[80:81], v[130:131], v[98:99] neg_lo:[0,1] neg_hi:[0,1]
v_pk_add_f32 v[82:83], v[96:97], v[128:129] neg_lo:[0,1] neg_hi:[0,1]
v_pk_add_f32 v[96:97], v[96:97], v[128:129]
v_pk_add_f32 v[98:99], v[98:99], v[130:131]
v_pk_add_f32 v[128:129], v[100:101], v[132:133] neg_lo:[0,1] neg_hi:[0,1]
v_pk_add_f32 v[130:131], v[102:103], v[134:135] neg_lo:[0,1] neg_hi:[0,1]
v_pk_add_f32 v[100:101], v[100:101], v[132:133]
v_pk_add_f32 v[102:103], v[102:103], v[134:135]
v_pk_mul_f32 v[132:133], v[128:129], s[34:35] op_sel:[0,1] neg_lo:[0,1] neg_hi:[0,1]
v_pk_mul_f32 v[134:135], v[128:129], s[30:31] op_sel:[0,1]
v_pk_fma_f32 v[132:133], v[130:131], s[30:31], v[132:133] op_sel:[0,1,0] neg_lo:[0,1,0] neg_hi:[0,1,0]
v_pk_fma_f32 v[134:135], v[130:131], s[34:35], v[134:135] op_sel:[0,1,0] neg_lo:[0,1,0] neg_hi:[0,1,0]
v_pk_add_f32 v[128:129], v[104:105], v[136:137] neg_lo:[0,1] neg_hi:[0,1]
v_pk_add_f32 v[130:131], v[106:107], v[138:139] neg_lo:[0,1] neg_hi:[0,1]
v_pk_add_f32 v[104:105], v[104:105], v[136:137]
v_pk_add_f32 v[106:107], v[106:107], v[138:139]
v_pk_mul_f32 v[136:137], v[128:129], s[32:33] op_sel:[0,1] neg_lo:[0,1] neg_hi:[0,1]
v_pk_mul_f32 v[138:139], v[128:129], s[32:33] op_sel:[0,1]
v_pk_fma_f32 v[136:137], v[130:131], s[32:33], v[136:137] op_sel:[0,1,0] neg_lo:[0,1,0] neg_hi:[0,1,0]
v_pk_fma_f32 v[138:139], v[130:131], s[32:33], v[138:139] op_sel:[0,1,0] neg_lo:[0,1,0] neg_hi:[0,1,0]
v_pk_add_f32 v[128:129], v[108:109], v[140:141] neg_lo:[0,1] neg_hi:[0,1]
v_pk_add_f32 v[130:131], v[110:111], v[142:143] neg_lo:[0,1] neg_hi:[0,1]
v_pk_add_f32 v[108:109], v[108:109], v[140:141]
v_pk_add_f32 v[110:111], v[110:111], v[142:143]
v_pk_mul_f32 v[140:141], v[128:129], s[30:31] op_sel:[0,1] neg_lo:[0,1] neg_hi:[0,1]
v_pk_mul_f32 v[142:143], v[128:129], s[34:35] op_sel:[0,1]
v_pk_fma_f32 v[140:141], v[130:131], s[34:35], v[140:141] op_sel:[0,1,0] neg_lo:[0,1,0] neg_hi:[0,1,0]
v_pk_fma_f32 v[142:143], v[130:131], s[30:31], v[142:143] op_sel:[0,1,0] neg_lo:[0,1,0] neg_hi:[0,1,0]
v_pk_add_f32 v[128:129], v[16:17], v[32:33] neg_lo:[0,1] neg_hi:[0,1]
v_pk_add_f32 v[130:131], v[18:19], v[34:35] neg_lo:[0,1] neg_hi:[0,1]
v_pk_add_f32 v[16:17], v[16:17], v[32:33]
v_pk_add_f32 v[18:19], v[18:19], v[34:35]
v_pk_add_f32 v[32:33], v[20:21], v[36:37] neg_lo:[0,1] neg_hi:[0,1]
v_pk_add_f32 v[34:35], v[22:23], v[38:39] neg_lo:[0,1] neg_hi:[0,1]
v_pk_add_f32 v[20:21], v[20:21], v[36:37]
v_pk_add_f32 v[22:23], v[22:23], v[38:39]
v_pk_mul_f32 v[36:37], v[32:33], s[32:33] op_sel:[0,1]
v_pk_mul_f32 v[38:39], v[32:33], s[32:33] op_sel:[0,1]
v_pk_fma_f32 v[36:37], v[34:35], s[32:33], v[36:37] op_sel:[0,1,0] neg_lo:[0,1,0] neg_hi:[0,1,0]
v_pk_fma_f32 v[38:39], v[34:35], s[32:33], v[38:39] op_sel:[0,1,0]
v_pk_add_f32 v[32:33], v[42:43], v[26:27] neg_lo:[0,1] neg_hi:[0,1]
v_pk_add_f32 v[34:35], v[24:25], v[40:41] neg_lo:[0,1] neg_hi:[0,1]
v_pk_add_f32 v[24:25], v[24:25], v[40:41]
v_pk_add_f32 v[26:27], v[26:27], v[42:43]
v_pk_add_f32 v[40:41], v[28:29], v[44:45] neg_lo:[0,1] neg_hi:[0,1]
v_pk_add_f32 v[42:43], v[30:31], v[46:47] neg_lo:[0,1] neg_hi:[0,1]
v_pk_add_f32 v[28:29], v[28:29], v[44:45]
v_pk_add_f32 v[30:31], v[30:31], v[46:47]
v_pk_mul_f32 v[44:45], v[40:41], s[32:33] op_sel:[0,1] neg_lo:[0,1] neg_hi:[0,1]
v_pk_mul_f32 v[46:47], v[40:41], s[32:33] op_sel:[0,1]
v_pk_fma_f32 v[44:45], v[42:43], s[32:33], v[44:45] op_sel:[0,1,0] neg_lo:[0,1,0] neg_hi:[0,1,0]
v_pk_fma_f32 v[46:47], v[42:43], s[32:33], v[46:47] op_sel:[0,1,0] neg_lo:[0,1,0] neg_hi:[0,1,0]
v_pk_add_f32 v[40:41], v[112:113], v[48:49] neg_lo:[0,1] neg_hi:[0,1]
v_pk_add_f32 v[42:43], v[114:115], v[50:51] neg_lo:[0,1] neg_hi:[0,1]
v_pk_add_f32 v[112:113], v[112:113], v[48:49]
v_pk_add_f32 v[114:115], v[114:115], v[50:51]
v_pk_add_f32 v[48:49], v[52:53], v[68:69] neg_lo:[0,1] neg_hi:[0,1]
v_pk_add_f32 v[50:51], v[54:55], v[70:71] neg_lo:[0,1] neg_hi:[0,1]
v_pk_add_f32 v[52:53], v[52:53], v[68:69]
v_pk_add_f32 v[54:55], v[54:55], v[70:71]
v_pk_mul_f32 v[68:69], v[48:49], s[32:33] op_sel:[0,1]
v_pk_mul_f32 v[70:71], v[48:49], s[32:33] op_sel:[0,1]
v_pk_fma_f32 v[68:69], v[50:51], s[32:33], v[68:69] op_sel:[0,1,0] neg_lo:[0,1,0] neg_hi:[0,1,0]
v_pk_fma_f32 v[70:71], v[50:51], s[32:33], v[70:71] op_sel:[0,1,0]
v_pk_add_f32 v[48:49], v[74:75], v[58:59] neg_lo:[0,1] neg_hi:[0,1]
v_pk_add_f32 v[50:51], v[56:57], v[72:73] neg_lo:[0,1] neg_hi:[0,1]
v_pk_add_f32 v[56:57], v[56:57], v[72:73]
v_pk_add_f32 v[58:59], v[58:59], v[74:75]
v_pk_add_f32 v[72:73], v[60:61], v[76:77] neg_lo:[0,1] neg_hi:[0,1]
v_pk_add_f32 v[74:75], v[62:63], v[78:79] neg_lo:[0,1] neg_hi:[0,1]
v_pk_add_f32 v[60:61], v[60:61], v[76:77]
v_pk_add_f32 v[62:63], v[62:63], v[78:79]
v_pk_mul_f32 v[76:77], v[72:73], s[32:33] op_sel:[0,1] neg_lo:[0,1] neg_hi:[0,1]
v_pk_mul_f32 v[78:79], v[72:73], s[32:33] op_sel:[0,1]
v_pk_fma_f32 v[76:77], v[74:75], s[32:33], v[76:77] op_sel:[0,1,0] neg_lo:[0,1,0] neg_hi:[0,1,0]
v_pk_fma_f32 v[78:79], v[74:75], s[32:33], v[78:79] op_sel:[0,1,0] neg_lo:[0,1,0] neg_hi:[0,1,0]
v_pk_add_f32 v[72:73], v[144:145], v[96:97] neg_lo:[0,1] neg_hi:[0,1]
v_pk_add_f32 v[74:75], v[146:147], v[98:99] neg_lo:[0,1] neg_hi:[0,1]
v_pk_add_f32 v[144:145], v[144:145], v[96:97]
v_pk_add_f32 v[146:147], v[146:147], v[98:99]
v_pk_add_f32 v[96:97], v[84:85], v[100:101] neg_lo:[0,1] neg_hi:[0,1]
v_pk_add_f32 v[98:99], v[86:87], v[102:103] neg_lo:[0,1] neg_hi:[0,1]
v_pk_add_f32 v[84:85], v[84:85], v[100:101]
v_pk_add_f32 v[86:87], v[86:87], v[102:103]
v_pk_mul_f32 v[100:101], v[96:97], s[32:33] op_sel:[0,1]
v_pk_mul_f32 v[102:103], v[96:97], s[32:33] op_sel:[0,1]
v_pk_fma_f32 v[100:101], v[98:99], s[32:33], v[100:101] op_sel:[0,1,0] neg_lo:[0,1,0] neg_hi:[0,1,0]
v_pk_fma_f32 v[102:103], v[98:99], s[32:33], v[102:103] op_sel:[0,1,0]
v_pk_add_f32 v[96:97], v[106:107], v[90:91] neg_lo:[0,1] neg_hi:[0,1]
v_pk_add_f32 v[98:99], v[88:89], v[104:105] neg_lo:[0,1] neg_hi:[0,1]
v_pk_add_f32 v[88:89], v[88:89], v[104:105]
v_pk_add_f32 v[90:91], v[90:91], v[106:107]
v_pk_add_f32 v[104:105], v[92:93], v[108:109] neg_lo:[0,1] neg_hi:[0,1]
v_pk_add_f32 v[106:107], v[94:95], v[110:111] neg_lo:[0,1] neg_hi:[0,1]
v_pk_add_f32 v[92:93], v[92:93], v[108:109]
v_pk_add_f32 v[94:95], v[94:95], v[110:111]
v_pk_mul_f32 v[108:109], v[104:105], s[32:33] op_sel:[0,1] neg_lo:[0,1] neg_hi:[0,1]
v_pk_mul_f32 v[110:111], v[104:105], s[32:33] op_sel:[0,1]
v_pk_fma_f32 v[108:109], v[106:107], s[32:33], v[108:109] op_sel:[0,1,0] neg_lo:[0,1,0] neg_hi:[0,1,0]
v_pk_fma_f32 v[110:111], v[106:107], s[32:33], v[110:111] op_sel:[0,1,0] neg_lo:[0,1,0] neg_hi:[0,1,0]
v_pk_add_f32 v[104:105], v[64:65], v[80:81] neg_lo:[0,1] neg_hi:[0,1]
v_pk_add_f32 v[106:107], v[66:67], v[82:83] neg_lo:[0,1] neg_hi:[0,1]
v_pk_add_f32 v[64:65], v[64:65], v[80:81]
v_pk_add_f32 v[66:67], v[66:67], v[82:83]
v_pk_add_f32 v[80:81], v[116:117], v[132:133] neg_lo:[0,1] neg_hi:[0,1]
v_pk_add_f32 v[82:83], v[118:119], v[134:135] neg_lo:[0,1] neg_hi:[0,1]
v_pk_add_f32 v[116:117], v[116:117], v[132:133]
v_pk_add_f32 v[118:119], v[118:119], v[134:135]
v_pk_mul_f32 v[132:133], v[80:81], s[32:33] op_sel:[0,1]
v_pk_mul_f32 v[134:135], v[80:81], s[32:33] op_sel:[0,1]
v_pk_fma_f32 v[132:133], v[82:83], s[32:33], v[132:133] op_sel:[0,1,0] neg_lo:[0,1,0] neg_hi:[0,1,0]
v_pk_fma_f32 v[134:135], v[82:83], s[32:33], v[134:135] op_sel:[0,1,0]
v_pk_add_f32 v[80:81], v[138:139], v[122:123] neg_lo:[0,1] neg_hi:[0,1]
v_pk_add_f32 v[82:83], v[120:121], v[136:137] neg_lo:[0,1] neg_hi:[0,1]
v_pk_add_f32 v[120:121], v[120:121], v[136:137]
v_pk_add_f32 v[122:123], v[122:123], v[138:139]
v_pk_add_f32 v[136:137], v[124:125], v[140:141] neg_lo:[0,1] neg_hi:[0,1]
v_pk_add_f32 v[138:139], v[126:127], v[142:143] neg_lo:[0,1] neg_hi:[0,1]
v_pk_add_f32 v[124:125], v[124:125], v[140:141]
v_pk_add_f32 v[126:127], v[126:127], v[142:143]
v_pk_mul_f32 v[140:141], v[136:137], s[32:33] op_sel:[0,1] neg_lo:[0,1] neg_hi:[0,1]
v_pk_mul_f32 v[142:143], v[136:137], s[32:33] op_sel:[0,1]
v_pk_fma_f32 v[140:141], v[138:139], s[32:33], v[140:141] op_sel:[0,1,0] neg_lo:[0,1,0] neg_hi:[0,1,0]
v_pk_fma_f32 v[142:143], v[138:139], s[32:33], v[142:143] op_sel:[0,1,0] neg_lo:[0,1,0] neg_hi:[0,1,0]
v_pk_add_f32 v[136:137], v[16:17], v[24:25] neg_lo:[0,1] neg_hi:[0,1]
v_pk_add_f32 v[138:139], v[18:19], v[26:27] neg_lo:[0,1] neg_hi:[0,1]
v_pk_add_f32 v[16:17], v[16:17], v[24:25]
v_pk_add_f32 v[18:19], v[18:19], v[26:27]
v_pk_add_f32 v[24:25], v[30:31], v[22:23] neg_lo:[0,1] neg_hi:[0,1]
v_pk_add_f32 v[26:27], v[20:21], v[28:29] neg_lo:[0,1] neg_hi:[0,1]
v_pk_add_f32 v[20:21], v[20:21], v[28:29]
v_pk_add_f32 v[22:23], v[22:23], v[30:31]
v_pk_add_f32 v[28:29], v[128:129], v[32:33] neg_lo:[0,1] neg_hi:[0,1]
v_pk_add_f32 v[30:31], v[130:131], v[34:35] neg_lo:[0,1] neg_hi:[0,1]
v_pk_add_f32 v[128:129], v[128:129], v[32:33]
v_pk_add_f32 v[130:131], v[130:131], v[34:35]
v_pk_add_f32 v[32:33], v[46:47], v[38:39] neg_lo:[0,1] neg_hi:[0,1]
v_pk_add_f32 v[34:35], v[36:37], v[44:45] neg_lo:[0,1] neg_hi:[0,1]
v_pk_add_f32 v[36:37], v[36:37], v[44:45]
v_pk_add_f32 v[38:39], v[38:39], v[46:47]
v_pk_add_f32 v[44:45], v[112:113], v[56:57] neg_lo:[0,1] neg_hi:[0,1]
v_pk_add_f32 v[46:47], v[114:115], v[58:59] neg_lo:[0,1] neg_hi:[0,1]
v_pk_add_f32 v[112:113], v[112:113], v[56:57]
v_pk_add_f32 v[114:115], v[114:115], v[58:59]
v_pk_add_f32 v[56:57], v[62:63], v[54:55] neg_lo:[0,1] neg_hi:[0,1]
v_pk_add_f32 v[58:59], v[52:53], v[60:61] neg_lo:[0,1] neg_hi:[0,1]
v_pk_add_f32 v[52:53], v[52:53], v[60:61]
v_pk_add_f32 v[54:55], v[54:55], v[62:63]
v_pk_add_f32 v[60:61], v[40:41], v[48:49] neg_lo:[0,1] neg_hi:[0,1]
v_pk_add_f32 v[62:63], v[42:43], v[50:51] neg_lo:[0,1] neg_hi:[0,1]
v_pk_add_f32 v[40:41], v[40:41], v[48:49]
v_pk_add_f32 v[42:43], v[42:43], v[50:51]
v_pk_add_f32 v[48:49], v[78:79], v[70:71] neg_lo:[0,1] neg_hi:[0,1]
v_pk_add_f32 v[50:51], v[68:69], v[76:77] neg_lo:[0,1] neg_hi:[0,1]
v_pk_add_f32 v[68:69], v[68:69], v[76:77]
v_pk_add_f32 v[70:71], v[70:71], v[78:79]
v_pk_add_f32 v[76:77], v[144:145], v[88:89] neg_lo:[0,1] neg_hi:[0,1]
v_pk_add_f32 v[78:79], v[146:147], v[90:91] neg_lo:[0,1] neg_hi:[0,1]
v_pk_add_f32 v[144:145], v[144:145], v[88:89]
v_pk_add_f32 v[146:147], v[146:147], v[90:91]
v_pk_add_f32 v[88:89], v[94:95], v[86:87] neg_lo:[0,1] neg_hi:[0,1]
v_pk_add_f32 v[90:91], v[84:85], v[92:93] neg_lo:[0,1] neg_hi:[0,1]
v_pk_add_f32 v[84:85], v[84:85], v[92:93]
v_pk_add_f32 v[86:87], v[86:87], v[94:95]
v_pk_add_f32 v[92:93], v[72:73], v[96:97] neg_lo:[0,1] neg_hi:[0,1]
v_pk_add_f32 v[94:95], v[74:75], v[98:99] neg_lo:[0,1] neg_hi:[0,1]
v_pk_add_f32 v[72:73], v[72:73], v[96:97]
v_pk_add_f32 v[74:75], v[74:75], v[98:99]
v_pk_add_f32 v[96:97], v[110:111], v[102:103] neg_lo:[0,1] neg_hi:[0,1]
v_pk_add_f32 v[98:99], v[100:101], v[108:109] neg_lo:[0,1] neg_hi:[0,1]
v_pk_add_f32 v[100:101], v[100:101], v[108:109]
v_pk_add_f32 v[102:103], v[102:103], v[110:111]
v_pk_add_f32 v[108:109], v[64:65], v[120:121] neg_lo:[0,1] neg_hi:[0,1]
v_pk_add_f32 v[110:111], v[66:67], v[122:123] neg_lo:[0,1] neg_hi:[0,1]
v_pk_add_f32 v[64:65], v[64:65], v[120:121]
v_pk_add_f32 v[66:67], v[66:67], v[122:123]
v_pk_add_f32 v[120:121], v[126:127], v[118:119] neg_lo:[0,1] neg_hi:[0,1]
v_pk_add_f32 v[122:123], v[116:117], v[124:125] neg_lo:[0,1] neg_hi:[0,1]
v_pk_add_f32 v[116:117], v[116:117], v[124:125]
v_pk_add_f32 v[118:119], v[118:119], v[126:127]
v_pk_add_f32 v[124:125], v[104:105], v[80:81] neg_lo:[0,1] neg_hi:[0,1]
v_pk_add_f32 v[126:127], v[106:107], v[82:83] neg_lo:[0,1] neg_hi:[0,1]
v_pk_add_f32 v[104:105], v[104:105], v[80:81]
v_pk_add_f32 v[106:107], v[106:107], v[82:83]
v_pk_add_f32 v[80:81], v[142:143], v[134:135] neg_lo:[0,1] neg_hi:[0,1]
v_pk_add_f32 v[82:83], v[132:133], v[140:141] neg_lo:[0,1] neg_hi:[0,1]
v_pk_add_f32 v[132:133], v[132:133], v[140:141]
v_pk_add_f32 v[134:135], v[134:135], v[142:143]
v_pk_add_f32 v[140:141], v[16:17], v[20:21] neg_lo:[0,1] neg_hi:[0,1]
v_pk_add_f32 v[142:143], v[18:19], v[22:23] neg_lo:[0,1] neg_hi:[0,1]
v_pk_add_f32 v[16:17], v[16:17], v[20:21]
v_pk_add_f32 v[18:19], v[18:19], v[22:23]
v_pk_add_f32 v[20:21], v[136:137], v[24:25] neg_lo:[0,1] neg_hi:[0,1]
v_pk_add_f32 v[22:23], v[138:139], v[26:27] neg_lo:[0,1] neg_hi:[0,1]
v_pk_add_f32 v[136:137], v[136:137], v[24:25]
v_pk_add_f32 v[138:139], v[138:139], v[26:27]
v_pk_add_f32 v[24:25], v[128:129], v[36:37] neg_lo:[0,1] neg_hi:[0,1]
v_pk_add_f32 v[26:27], v[130:131], v[38:39] neg_lo:[0,1] neg_hi:[0,1]
v_pk_add_f32 v[128:129], v[128:129], v[36:37]
v_pk_add_f32 v[130:131], v[130:131], v[38:39]
v_pk_add_f32 v[36:37], v[28:29], v[32:33] neg_lo:[0,1] neg_hi:[0,1]
v_pk_add_f32 v[38:39], v[30:31], v[34:35] neg_lo:[0,1] neg_hi:[0,1]
v_pk_add_f32 v[28:29], v[28:29], v[32:33]
v_pk_add_f32 v[30:31], v[30:31], v[34:35]
v_pk_add_f32 v[32:33], v[112:113], v[52:53] neg_lo:[0,1] neg_hi:[0,1]
v_pk_add_f32 v[34:35], v[114:115], v[54:55] neg_lo:[0,1] neg_hi:[0,1]
v_pk_add_f32 v[112:113], v[112:113], v[52:53]
v_pk_add_f32 v[114:115], v[114:115], v[54:55]
v_pk_add_f32 v[52:53], v[44:45], v[56:57] neg_lo:[0,1] neg_hi:[0,1]
v_pk_add_f32 v[54:55], v[46:47], v[58:59] neg_lo:[0,1] neg_hi:[0,1]
v_pk_add_f32 v[44:45], v[44:45], v[56:57]
v_pk_add_f32 v[46:47], v[46:47], v[58:59]
v_pk_add_f32 v[56:57], v[40:41], v[68:69] neg_lo:[0,1] neg_hi:[0,1]
v_pk_add_f32 v[58:59], v[42:43], v[70:71] neg_lo:[0,1] neg_hi:[0,1]
v_pk_add_f32 v[40:41], v[40:41], v[68:69]
v_pk_add_f32 v[42:43], v[42:43], v[70:71]
v_pk_add_f32 v[68:69], v[60:61], v[48:49] neg_lo:[0,1] neg_hi:[0,1]
v_pk_add_f32 v[70:71], v[62:63], v[50:51] neg_lo:[0,1] neg_hi:[0,1]
v_pk_add_f32 v[60:61], v[60:61], v[48:49]
v_pk_add_f32 v[62:63], v[62:63], v[50:51]
v_pk_add_f32 v[48:49], v[144:145], v[84:85] neg_lo:[0,1] neg_hi:[0,1]
v_pk_add_f32 v[50:51], v[146:147], v[86:87] neg_lo:[0,1] neg_hi:[0,1]
v_pk_add_f32 v[144:145], v[144:145], v[84:85]
v_pk_add_f32 v[146:147], v[146:147], v[86:87]
v_pk_add_f32 v[84:85], v[76:77], v[88:89] neg_lo:[0,1] neg_hi:[0,1]
v_pk_add_f32 v[86:87], v[78:79], v[90:91] neg_lo:[0,1] neg_hi:[0,1]
v_pk_add_f32 v[76:77], v[76:77], v[88:89]
v_pk_add_f32 v[78:79], v[78:79], v[90:91]
v_pk_add_f32 v[88:89], v[72:73], v[100:101] neg_lo:[0,1] neg_hi:[0,1]
v_pk_add_f32 v[90:91], v[74:75], v[102:103] neg_lo:[0,1] neg_hi:[0,1]
v_pk_add_f32 v[72:73], v[72:73], v[100:101]
v_pk_add_f32 v[74:75], v[74:75], v[102:103]
v_pk_add_f32 v[100:101], v[92:93], v[96:97] neg_lo:[0,1] neg_hi:[0,1]
v_pk_add_f32 v[102:103], v[94:95], v[98:99] neg_lo:[0,1] neg_hi:[0,1]
v_pk_add_f32 v[92:93], v[92:93], v[96:97]
v_pk_add_f32 v[94:95], v[94:95], v[98:99]
v_pk_add_f32 v[96:97], v[64:65], v[116:117] neg_lo:[0,1] neg_hi:[0,1]
v_pk_add_f32 v[98:99], v[66:67], v[118:119] neg_lo:[0,1] neg_hi:[0,1]
v_pk_add_f32 v[64:65], v[64:65], v[116:117]
v_pk_add_f32 v[66:67], v[66:67], v[118:119]
v_pk_add_f32 v[116:117], v[108:109], v[120:121] neg_lo:[0,1] neg_hi:[0,1]
v_pk_add_f32 v[118:119], v[110:111], v[122:123] neg_lo:[0,1] neg_hi:[0,1]
v_pk_add_f32 v[108:109], v[108:109], v[120:121]
v_pk_add_f32 v[110:111], v[110:111], v[122:123]
v_pk_add_f32 v[120:121], v[104:105], v[132:133] neg_lo:[0,1] neg_hi:[0,1]
v_pk_add_f32 v[122:123], v[106:107], v[134:135] neg_lo:[0,1] neg_hi:[0,1]
v_pk_add_f32 v[104:105], v[104:105], v[132:133]
v_pk_add_f32 v[106:107], v[106:107], v[134:135]
v_pk_add_f32 v[132:133], v[124:125], v[80:81] neg_lo:[0,1] neg_hi:[0,1]
v_pk_add_f32 v[134:135], v[126:127], v[82:83] neg_lo:[0,1] neg_hi:[0,1]
v_pk_add_f32 v[124:125], v[124:125], v[80:81]
v_pk_add_f32 v[126:127], v[126:127], v[82:83]
s_mov_b32 s20, 0x34800000
v_pk_mul_f32 v[160:161], v[16:17], s[20:21] op_sel_hi:[1,0]
v_pk_mul_f32 v[162:163], v[18:19], s[20:21] op_sel_hi:[1,0]
s_add_u32 s16, s15, 0
buffer_store_dwordx4 v[160:163], v10, s[84:87], s16 offen sc1
v_pk_mul_f32 v[164:165], v[144:145], s[20:21] op_sel_hi:[1,0]
v_pk_mul_f32 v[166:167], v[146:147], s[20:21] op_sel_hi:[1,0]
buffer_store_dwordx4 v[164:167], v10, s[84:87], s16 offen offset:1024 sc1
v_pk_mul_f32 v[168:169], v[112:113], s[20:21] op_sel_hi:[1,0]
v_pk_mul_f32 v[170:171], v[114:115], s[20:21] op_sel_hi:[1,0]
buffer_store_dwordx4 v[168:171], v10, s[84:87], s16 offen offset:2048 sc1
v_pk_mul_f32 v[172:173], v[64:65], s[20:21] op_sel_hi:[1,0]
v_pk_mul_f32 v[174:175], v[66:67], s[20:21] op_sel_hi:[1,0]
buffer_store_dwordx4 v[172:175], v10, s[84:87], s16 offen offset:3072 sc1
v_pk_mul_f32 v[176:177], v[128:129], s[20:21] op_sel_hi:[1,0]
v_pk_mul_f32 v[178:179], v[130:131], s[20:21] op_sel_hi:[1,0]
s_add_u32 s16, s15, 4096
buffer_store_dwordx4 v[176:179], v10, s[84:87], s16 offen sc1
v_pk_mul_f32 v[180:181], v[72:73], s[20:21] op_sel_hi:[1,0]
v_pk_mul_f32 v[182:183], v[74:75], s[20:21] op_sel_hi:[1,0]
buffer_store_dwordx4 v[180:183], v10, s[84:87], s16 offen offset:1024 sc1
v_pk_mul_f32 v[184:185], v[40:41], s[20:21] op_sel_hi:[1,0]
v_pk_mul_f32 v[186:187], v[42:43], s[20:21] op_sel_hi:[1,0]
buffer_store_dwordx4 v[184:187], v10, s[84:87], s16 offen offset:2048 sc1
v_pk_mul_f32 v[188:189], v[104:105], s[20:21] op_sel_hi:[1,0]
v_pk_mul_f32 v[190:191], v[106:107], s[20:21] op_sel_hi:[1,0]
buffer_store_dwordx4 v[188:191], v10, s[84:87], s16 offen offset:3072 sc1
v_pk_mul_f32 v[160:161], v[136:137], s[20:21] op_sel_hi:[1,0]
v_pk_mul_f32 v[162:163], v[138:139], s[20:21] op_sel_hi:[1,0]
s_add_u32 s16, s15, 8192
buffer_store_dwordx4 v[160:163], v10, s[84:87], s16 offen sc1
v_pk_mul_f32 v[164:165], v[76:77], s[20:21] op_sel_hi:[1,0]
v_pk_mul_f32 v[166:167], v[78:79], s[20:21] op_sel_hi:[1,0]
buffer_store_dwordx4 v[164:167], v10, s[84:87], s16 offen offset:1024 sc1
v_pk_mul_f32 v[168:169], v[44:45], s[20:21] op_sel_hi:[1,0]
v_pk_mul_f32 v[170:171], v[46:47], s[20:21] op_sel_hi:[1,0]
buffer_store_dwordx4 v[168:171], v10, s[84:87], s16 offen offset:2048 sc1
v_pk_mul_f32 v[172:173], v[108:109], s[20:21] op_sel_hi:[1,0]
v_pk_mul_f32 v[174:175], v[110:111], s[20:21] op_sel_hi:[1,0]
buffer_store_dwordx4 v[172:175], v10, s[84:87], s16 offen offset:3072 sc1
v_pk_mul_f32 v[176:177], v[28:29], s[20:21] op_sel_hi:[1,0]
v_pk_mul_f32 v[178:179], v[30:31], s[20:21] op_sel_hi:[1,0]
s_add_u32 s16, s15, 12288
buffer_store_dwordx4 v[176:179], v10, s[84:87], s16 offen sc1
v_pk_mul_f32 v[180:181], v[92:93], s[20:21] op_sel_hi:[1,0]
v_pk_mul_f32 v[182:183], v[94:95], s[20:21] op_sel_hi:[1,0]
buffer_store_dwordx4 v[180:183], v10, s[84:87], s16 offen offset:1024 sc1
v_pk_mul_f32 v[184:185], v[60:61], s[20:21] op_sel_hi:[1,0]
v_pk_mul_f32 v[186:187], v[62:63], s[20:21] op_sel_hi:[1,0]
buffer_store_dwordx4 v[184:187], v10, s[84:87], s16 offen offset:2048 sc1
v_pk_mul_f32 v[188:189], v[124:125], s[20:21] op_sel_hi:[1,0]
v_pk_mul_f32 v[190:191], v[126:127], s[20:21] op_sel_hi:[1,0]
buffer_store_dwordx4 v[188:191], v10, s[84:87], s16 offen offset:3072 sc1
v_pk_mul_f32 v[160:161], v[140:141], s[20:21] op_sel_hi:[1,0]
v_pk_mul_f32 v[162:163], v[142:143], s[20:21] op_sel_hi:[1,0]
s_add_u32 s16, s15, 16384
buffer_store_dwordx4 v[160:163], v10, s[84:87], s16 offen sc1
v_pk_mul_f32 v[164:165], v[48:49], s[20:21] op_sel_hi:[1,0]
v_pk_mul_f32 v[166:167], v[50:51], s[20:21] op_sel_hi:[1,0]
buffer_store_dwordx4 v[164:167], v10, s[84:87], s16 offen offset:1024 sc1
v_pk_mul_f32 v[168:169], v[32:33], s[20:21] op_sel_hi:[1,0]
v_pk_mul_f32 v[170:171], v[34:35], s[20:21] op_sel_hi:[1,0]
buffer_store_dwordx4 v[168:171], v10, s[84:87], s16 offen offset:2048 sc1
v_pk_mul_f32 v[172:173], v[96:97], s[20:21] op_sel_hi:[1,0]
v_pk_mul_f32 v[174:175], v[98:99], s[20:21] op_sel_hi:[1,0]
buffer_store_dwordx4 v[172:175], v10, s[84:87], s16 offen offset:3072 sc1
v_pk_mul_f32 v[176:177], v[24:25], s[20:21] op_sel_hi:[1,0]
v_pk_mul_f32 v[178:179], v[26:27], s[20:21] op_sel_hi:[1,0]
s_add_u32 s16, s15, 20480
buffer_store_dwordx4 v[176:179], v10, s[84:87], s16 offen sc1
v_pk_mul_f32 v[180:181], v[88:89], s[20:21] op_sel_hi:[1,0]
v_pk_mul_f32 v[182:183], v[90:91], s[20:21] op_sel_hi:[1,0]
buffer_store_dwordx4 v[180:183], v10, s[84:87], s16 offen offset:1024 sc1
v_pk_mul_f32 v[184:185], v[56:57], s[20:21] op_sel_hi:[1,0]
v_pk_mul_f32 v[186:187], v[58:59], s[20:21] op_sel_hi:[1,0]
buffer_store_dwordx4 v[184:187], v10, s[84:87], s16 offen offset:2048 sc1
v_pk_mul_f32 v[188:189], v[120:121], s[20:21] op_sel_hi:[1,0]
v_pk_mul_f32 v[190:191], v[122:123], s[20:21] op_sel_hi:[1,0]
buffer_store_dwordx4 v[188:191], v10, s[84:87], s16 offen offset:3072 sc1
v_pk_mul_f32 v[160:161], v[20:21], s[20:21] op_sel_hi:[1,0]
v_pk_mul_f32 v[162:163], v[22:23], s[20:21] op_sel_hi:[1,0]
s_add_u32 s16, s15, 24576
buffer_store_dwordx4 v[160:163], v10, s[84:87], s16 offen sc1
v_pk_mul_f32 v[164:165], v[84:85], s[20:21] op_sel_hi:[1,0]
v_pk_mul_f32 v[166:167], v[86:87], s[20:21] op_sel_hi:[1,0]
buffer_store_dwordx4 v[164:167], v10, s[84:87], s16 offen offset:1024 sc1
v_pk_mul_f32 v[168:169], v[52:53], s[20:21] op_sel_hi:[1,0]
v_pk_mul_f32 v[170:171], v[54:55], s[20:21] op_sel_hi:[1,0]
buffer_store_dwordx4 v[168:171], v10, s[84:87], s16 offen offset:2048 sc1
v_pk_mul_f32 v[172:173], v[116:117], s[20:21] op_sel_hi:[1,0]
v_pk_mul_f32 v[174:175], v[118:119], s[20:21] op_sel_hi:[1,0]
buffer_store_dwordx4 v[172:175], v10, s[84:87], s16 offen offset:3072 sc1
v_pk_mul_f32 v[176:177], v[36:37], s[20:21] op_sel_hi:[1,0]
v_pk_mul_f32 v[178:179], v[38:39], s[20:21] op_sel_hi:[1,0]
s_add_u32 s16, s15, 28672
buffer_store_dwordx4 v[176:179], v10, s[84:87], s16 offen sc1
v_pk_mul_f32 v[180:181], v[100:101], s[20:21] op_sel_hi:[1,0]
v_pk_mul_f32 v[182:183], v[102:103], s[20:21] op_sel_hi:[1,0]
buffer_store_dwordx4 v[180:183], v10, s[84:87], s16 offen offset:1024 sc1
v_pk_mul_f32 v[184:185], v[68:69], s[20:21] op_sel_hi:[1,0]
v_pk_mul_f32 v[186:187], v[70:71], s[20:21] op_sel_hi:[1,0]
buffer_store_dwordx4 v[184:187], v10, s[84:87], s16 offen offset:2048 sc1
v_pk_mul_f32 v[188:189], v[132:133], s[20:21] op_sel_hi:[1,0]
v_pk_mul_f32 v[190:191], v[134:135], s[20:21] op_sel_hi:[1,0]
buffer_store_dwordx4 v[188:191], v10, s[84:87], s16 offen offset:3072 sc1
L_f2_end:
s_add_u32 s99, s99, 64
s_cmp_eq_u32 s99, 64
s_cbranch_scc1 L_f2l
s_waitcnt vmcnt(0)
s_barrier
s_cmp_lg_u32 s98, 0
s_cbranch_scc1 L_sg_8
v_mov_b32 v2, 1
s_mov_b32 s81, 71360768
s_mov_b64 exec, 1
buffer_atomic_add v2, off, s[84:87], s81 sc1
s_mov_b64 exec, -1
L_sg_8:
s_cmp_lg_u32 s98, 0
s_cbranch_scc1 L_wf2d
s_mov_b32 s81, 71360768
L_wf2:
buffer_load_dword v120, off, s[84:87], s81 sc1
s_waitcnt vmcnt(0)
v_cmp_ne_u32 vcc, 64, v120
s_cbranch_vccz L_wf2d
s_sleep 6
s_branch L_wf2
L_wf2d:
s_barrier
s_load_dwordx2 s[4:5], s[0:1], 80
s_mov_b32 s30, 0x3f7b14be
s_mov_b32 s31, 0x3f6c835e
s_mov_b32 s32, 0x3f54db31
s_mov_b32 s33, 0x3f3504f3
s_mov_b32 s34, 0x3f0e39da
s_mov_b32 s35, 0x3ec3ef15
s_mov_b32 s36, 0x3e47c5c2
v_and_b32 v5, 7, v0
v_lshrrev_b32 v1, 3, v0
v_mul_u32_u24 v6, 16896, v5
v_lshl_add_u32 v4, v1, 5, v6
v_lshlrev_b32 v5, 4, v5
v_lshl_add_u32 v5, v1, 15, v5
v_lshlrev_b32 v1, 1, v1
s_lshl_b32 s12, s92, 9
s_add_u32 s12, s12, 96468992
s_add_u32 s13, s12, 0
buffer_load_dwordx4 v[48:51], v5, s[84:87], s13 offen sc1
buffer_load_dwordx4 v[52:55], v5, s[84:87], s13 offen offset:128 sc1
buffer_load_dwordx4 v[56:59], v5, s[84:87], s13 offen offset:256 sc1
buffer_load_dwordx4 v[60:63], v5, s[84:87], s13 offen offset:384 sc1
s_add_u32 s13, s12, 1048576
buffer_load_dwordx4 v[64:67], v5, s[84:87], s13 offen sc1
buffer_load_dwordx4 v[68:71], v5, s[84:87], s13 offen offset:128 sc1
buffer_load_dwordx4 v[72:75], v5, s[84:87], s13 offen offset:256 sc1
buffer_load_dwordx4 v[76:79], v5, s[84:87], s13 offen offset:384 sc1
s_add_u32 s13, s12, 2097152
buffer_load_dwordx4 v[80:83], v5, s[84:87], s13 offen sc1
buffer_load_dwordx4 v[84:87], v5, s[84:87], s13 offen offset:128 sc1
buffer_load_dwordx4 v[88:91], v5, s[84:87], s13 offen offset:256 sc1
buffer_load_dwordx4 v[92:95], v5, s[84:87], s13 offen offset:384 sc1
s_add_u32 s13, s12, 3145728
buffer_load_dwordx4 v[96:99], v5, s[84:87], s13 offen sc1
buffer_load_dwordx4 v[100:103], v5, s[84:87], s13 offen offset:128 sc1
buffer_load_dwordx4 v[104:107], v5, s[84:87], s13 offen offset:256 sc1
buffer_load_dwordx4 v[108:111], v5, s[84:87], s13 offen offset:384 sc1
s_add_u32 s13, s12, 4194304
buffer_load_dwordx4 v[112:115], v5, s[84:87], s13 offen sc1
buffer_load_dwordx4 v[116:119], v5, s[84:87], s13 offen offset:128 sc1
buffer_load_dwordx4 v[120:123], v5, s[84:87], s13 offen offset:256 sc1
buffer_load_dwordx4 v[124:127], v5, s[84:87], s13 offen offset:384 sc1
s_add_u32 s13, s12, 5242880
buffer_load_dwordx4 v[128:131], v5, s[84:87], s13 offen sc1
buffer_load_dwordx4 v[132:135], v5, s[84:87], s13 offen offset:128 sc1
buffer_load_dwordx4 v[136:139], v5, s[84:87], s13 offen offset:256 sc1
buffer_load_dwordx4 v[140:143], v5, s[84:87], s13 offen offset:384 sc1
s_add_u32 s13, s12, 6291456
buffer_load_dwordx4 v[144:147], v5, s[84:87], s13 offen sc1
buffer_load_dwordx4 v[148:151], v5, s[84:87], s13 offen offset:128 sc1
buffer_load_dwordx4 v[152:155], v5, s[84:87], s13 offen offset:256 sc1
buffer_load_dwordx4 v[156:159], v5, s[84:87], s13 offen offset:384 sc1
s_add_u32 s13, s12, 7340032
buffer_load_dwordx4 v[160:163], v5, s[84:87], s13 offen sc1
buffer_load_dwordx4 v[164:167], v5, s[84:87], s13 offen offset:128 sc1
buffer_load_dwordx4 v[168:171], v5, s[84:87], s13 offen offset:256 sc1
buffer_load_dwordx4 v[172:175], v5, s[84:87], s13 offen offset:384 sc1
s_add_u32 s13, s12, 8388608
buffer_load_dwordx4 v[176:179], v5, s[84:87], s13 offen sc1
buffer_load_dwordx4 v[180:183], v5, s[84:87], s13 offen offset:128 sc1
buffer_load_dwordx4 v[184:187], v5, s[84:87], s13 offen offset:256 sc1
buffer_load_dwordx4 v[188:191], v5, s[84:87], s13 offen offset:384 sc1
v_cmp_eq_u32 vcc, 0, v1
s_waitcnt lgkmcnt(0)
s_mov_b32 s6, 8388608
s_mov_b32 s7, 0x00020000
v_sub_u32 v7, 1024, v1
v_add_u32 v8, -1, v7
v_and_b32 v7, 1023, v7
v_lshl_add_u32 v7, v7, 4, v6
v_lshl_add_u32 v8, v8, 4, v6
s_waitcnt vmcnt(32)
v_cndmask_b32 v50, v50, 0, vcc
v_cndmask_b32 v54, v54, 0, vcc
v_cndmask_b32 v58, v58, 0, vcc
v_cndmask_b32 v62, v62, 0, vcc
v_sub_f32 v16, v48, v54
v_add_f32 v18, v50, v52
v_add_f32 v24, v48, v54
v_sub_f32 v26, v52, v50
v_sub_f32 v17, v56, v62
v_add_f32 v19, v58, v60
v_add_f32 v25, v56, v62
v_sub_f32 v27, v60, v58
v_sub_f32 v20, v49, v55
v_add_f32 v22, v51, v53
v_add_f32 v28, v49, v55
v_sub_f32 v30, v53, v51
v_sub_f32 v21, v57, v63
v_add_f32 v23, v59, v61
v_add_f32 v29, v57, v63
v_sub_f32 v31, v61, v59
ds_write_b128 v4, v[16:19]
ds_write_b128 v4, v[20:23] offset:16
ds_write_b128 v7, v[24:27]
ds_write_b128 v8, v[28:31]
v_sub_u32 v7, 960, v1
v_add_u32 v8, -1, v7
v_and_b32 v7, 1023, v7
v_lshl_add_u32 v7, v7, 4, v6
v_lshl_add_u32 v8, v8, 4, v6
s_waitcnt vmcnt(28)
v_sub_f32 v32, v64, v70
v_add_f32 v34, v66, v68
v_add_f32 v40, v64, v70
v_sub_f32 v42, v68, v66
v_sub_f32 v33, v72, v78
v_add_f32 v35, v74, v76
v_add_f32 v41, v72, v78
v_sub_f32 v43, v76, v74
v_sub_f32 v36, v65, v71
v_add_f32 v38, v67, v69
v_add_f32 v44, v65, v71
v_sub_f32 v46, v69, v67
v_sub_f32 v37, v73, v79
v_add_f32 v39, v75, v77
v_add_f32 v45, v73, v79
v_sub_f32 v47, v77, v75
ds_write_b128 v4, v[32:35] offset:1024
ds_write_b128 v4, v[36:39] offset:1040
ds_write_b128 v7, v[40:43]
ds_write_b128 v8, v[44:47]
v_sub_u32 v7, 896, v1
v_add_u32 v8, -1, v7
v_and_b32 v7, 1023, v7
v_lshl_add_u32 v7, v7, 4, v6
v_lshl_add_u32 v8, v8, 4, v6
s_waitcnt vmcnt(24)
s_waitcnt lgkmcnt(4)
v_sub_f32 v16, v80, v86
v_add_f32 v18, v82, v84
v_add_f32 v24, v80, v86
v_sub_f32 v26, v84, v82
v_sub_f32 v17, v88, v94
v_add_f32 v19, v90, v92
v_add_f32 v25, v88, v94
v_sub_f32 v27, v92, v90
v_sub_f32 v20, v81, v87
v_add_f32 v22, v83, v85
v_add_f32 v28, v81, v87
v_sub_f32 v30, v85, v83
v_sub_f32 v21, v89, v95
v_add_f32 v23, v91, v93
v_add_f32 v29, v89, v95
v_sub_f32 v31, v93, v91
ds_write_b128 v4, v[16:19] offset:2048
ds_write_b128 v4, v[20:23] offset:2064
ds_write_b128 v7, v[24:27]
ds_write_b128 v8, v[28:31]
v_sub_u32 v7, 832, v1
v_add_u32 v8, -1, v7
v_and_b32 v7, 1023, v7
v_lshl_add_u32 v7, v7, 4, v6
v_lshl_add_u32 v8, v8, 4, v6
s_waitcnt vmcnt(20)
s_waitcnt lgkmcnt(4)
v_sub_f32 v32, v96, v102
v_add_f32 v34, v98, v100
v_add_f32 v40, v96, v102
v_sub_f32 v42, v100, v98
v_sub_f32 v33, v104, v110
v_add_f32 v35, v106, v108
v_add_f32 v41, v104, v110
v_sub_f32 v43, v108, v106
v_sub_f32 v36, v97, v103
v_add_f32 v38, v99, v101
v_add_f32 v44, v97, v103
v_sub_f32 v46, v101, v99
v_sub_f32 v37, v105, v111
v_add_f32 v39, v107, v109
v_add_f32 v45, v105, v111
v_sub_f32 v47, v109, v107
ds_write_b128 v4, v[32:35] offset:3072
ds_write_b128 v4, v[36:39] offset:3088
ds_write_b128 v7, v[40:43]
ds_write_b128 v8, v[44:47]
v_sub_u32 v7, 768, v1
v_add_u32 v8, -1, v7
v_and_b32 v7, 1023, v7
v_lshl_add_u32 v7, v7, 4, v6
v_lshl_add_u32 v8, v8, 4, v6
s_waitcnt vmcnt(16)
s_waitcnt lgkmcnt(4)
v_sub_f32 v16, v112, v118
v_add_f32 v18, v114, v116
v_add_f32 v24, v112, v118
v_sub_f32 v26, v116, v114
v_sub_f32 v17, v120, v126
v_add_f32 v19, v122, v124
v_add_f32 v25, v120, v126
v_sub_f32 v27, v124, v122
v_sub_f32 v20, v113, v119
v_add_f32 v22, v115, v117
v_add_f32 v28, v113, v119
v_sub_f32 v30, v117, v115
v_sub_f32 v21, v121, v127
v_add_f32 v23, v123, v125
v_add_f32 v29, v121, v127
v_sub_f32 v31, v125, v123
ds_write_b128 v4, v[16:19] offset:4096
ds_write_b128 v4, v[20:23] offset:4112
ds_write_b128 v7, v[24:27]
ds_write_b128 v8, v[28:31]
v_sub_u32 v7, 704, v1
v_add_u32 v8, -1, v7
v_and_b32 v7, 1023, v7
v_lshl_add_u32 v7, v7, 4, v6
v_lshl_add_u32 v8, v8, 4, v6
s_waitcnt vmcnt(12)
s_waitcnt lgkmcnt(4)
v_sub_f32 v32, v128, v134
v_add_f32 v34, v130, v132
v_add_f32 v40, v128, v134
v_sub_f32 v42, v132, v130
v_sub_f32 v33, v136, v142
v_add_f32 v35, v138, v140
v_add_f32 v41, v136, v142
v_sub_f32 v43, v140, v138
v_sub_f32 v36, v129, v135
v_add_f32 v38, v131, v133
v_add_f32 v44, v129, v135
v_sub_f32 v46, v133, v131
v_sub_f32 v37, v137, v143
v_add_f32 v39, v139, v141
v_add_f32 v45, v137, v143
v_sub_f32 v47, v141, v139
ds_write_b128 v4, v[32:35] offset:5120
ds_write_b128 v4, v[36:39] offset:5136
ds_write_b128 v7, v[40:43]
ds_write_b128 v8, v[44:47]
v_sub_u32 v7, 640, v1
v_add_u32 v8, -1, v7
v_and_b32 v7, 1023, v7
v_lshl_add_u32 v7, v7, 4, v6
v_lshl_add_u32 v8, v8, 4, v6
s_waitcnt vmcnt(8)
s_waitcnt lgkmcnt(4)
v_sub_f32 v16, v144, v150
v_add_f32 v18, v146, v148
v_add_f32 v24, v144, v150
v_sub_f32 v26, v148, v146
v_sub_f32 v17, v152, v158
v_add_f32 v19, v154, v156
v_add_f32 v25, v152, v158
v_sub_f32 v27, v156, v154
v_sub_f32 v20, v145, v151
v_add_f32 v22, v147, v149
v_add_f32 v28, v145, v151
v_sub_f32 v30, v149, v147
v_sub_f32 v21, v153, v159
v_add_f32 v23, v155, v157
v_add_f32 v29, v153, v159
v_sub_f32 v31, v157, v155
ds_write_b128 v4, v[16:19] offset:6144
ds_write_b128 v4, v[20:23] offset:6160
ds_write_b128 v7, v[24:27]
ds_write_b128 v8, v[28:31]
v_sub_u32 v7, 576, v1
v_add_u32 v8, -1, v7
v_and_b32 v7, 1023, v7
v_lshl_add_u32 v7, v7, 4, v6
v_lshl_add_u32 v8, v8, 4, v6
s_waitcnt vmcnt(4)
s_waitcnt lgkmcnt(4)
v_sub_f32 v32, v160, v166
v_add_f32 v34, v162, v164
v_add_f32 v40, v160, v166
v_sub_f32 v42, v164, v162
v_sub_f32 v33, v168, v174
v_add_f32 v35, v170, v172
v_add_f32 v41, v168, v174
v_sub_f32 v43, v172, v170
v_sub_f32 v36, v161, v167
v_add_f32 v38, v163, v165
v_add_f32 v44, v161, v167
v_sub_f32 v46, v165, v163
v_sub_f32 v37, v169, v175
v_add_f32 v39, v171, v173
v_add_f32 v45, v169, v175
v_sub_f32 v47, v173, v171
ds_write_b128 v4, v[32:35] offset:7168
ds_write_b128 v4, v[36:39] offset:7184
ds_write_b128 v7, v[40:43]
ds_write_b128 v8, v[44:47]
v_sub_u32 v7, 512, v1
v_add_u32 v8, -1, v7
v_and_b32 v7, 1023, v7
v_lshl_add_u32 v7, v7, 4, v6
v_lshl_add_u32 v8, v8, 4, v6
s_waitcnt vmcnt(0)
v_cndmask_b32 v178, v178, 0, vcc
v_cndmask_b32 v182, v182, 0, vcc
v_cndmask_b32 v186, v186, 0, vcc
v_cndmask_b32 v190, v190, 0, vcc
s_waitcnt lgkmcnt(4)
v_sub_f32 v16, v176, v182
v_add_f32 v18, v178, v180
v_add_f32 v24, v176, v182
v_sub_f32 v26, v180, v178
v_sub_f32 v17, v184, v190
v_add_f32 v19, v186, v188
v_add_f32 v25, v184, v190
v_sub_f32 v27, v188, v186
s_and_saveexec_b64 s[14:15], vcc
ds_write_b128 v4, v[16:19] offset:8192
s_mov_b64 exec, s[14:15]
s_waitcnt lgkmcnt(0)
s_barrier
v_and_b32 v1, 31, v0
v_lshrrev_b32 v2, 5, v0
v_cvt_f32_u32 v3, v1
v_mul_u32_u24 v6, 16896, v2
v_lshl_add_u32 v4, v1, 4, v6
v_mul_u32_u24 v5, 528, v1
v_add_u32 v5, v5, v6
ds_read_b128 v[16:19], v4
ds_read_b128 v[20:23], v4 offset:512
ds_read_b128 v[24:27], v4 offset:1024
ds_read_b128 v[28:31], v4 offset:1536
ds_read_b128 v[32:35], v4 offset:2048
ds_read_b128 v[36:39], v4 offset:2560
ds_read_b128 v[40:43], v4 offset:3072
ds_read_b128 v[44:47], v4 offset:3584
ds_read_b128 v[48:51], v4 offset:4096
ds_read_b128 v[52:55], v4 offset:4608
ds_read_b128 v[56:59], v4 offset:5120
ds_read_b128 v[60:63], v4 offset:5632
s_waitcnt lgkmcnt(4)
ds_read_b128 v[64:67], v4 offset:6144
ds_read_b128 v[68:71], v4 offset:6656
ds_read_b128 v[72:75], v4 offset:7168
ds_read_b128 v[76:79], v4 offset:7680
ds_read_b128 v[80:83], v4 offset:8192
ds_read_b128 v[84:87], v4 offset:8704
ds_read_b128 v[88:91], v4 offset:9216
ds_read_b128 v[92:95], v4 offset:9728
ds_read_b128 v[96:99], v4 offset:10240
ds_read_b128 v[100:103], v4 offset:10752
ds_read_b128 v[104:107], v4 offset:11264
ds_read_b128 v[108:111], v4 offset:11776
s_waitcnt lgkmcnt(4)
ds_read_b128 v[112:115], v4 offset:12288
ds_read_b128 v[116:119], v4 offset:12800
ds_read_b128 v[120:123], v4 offset:13312
ds_read_b128 v[124:127], v4 offset:13824
ds_read_b128 v[128:131], v4 offset:14336
ds_read_b128 v[132:135], v4 offset:14848
ds_read_b128 v[136:139], v4 offset:15360
ds_read_b128 v[140:143], v4 offset:15872
s_waitcnt lgkmcnt(0)
v_pk_add_f32 v[144:145], v[16:17], v[80:81] neg_lo:[0,1] neg_hi:[0,1]
v_pk_add_f32 v[146:147], v[18:19], v[82:83] neg_lo:[0,1] neg_hi:[0,1]
v_pk_add_f32 v[16:17], v[16:17], v[80:81]
v_pk_add_f32 v[18:19], v[18:19], v[82:83]
v_pk_add_f32 v[80:81], v[20:21], v[84:85] neg_lo:[0,1] neg_hi:[0,1]
v_pk_add_f32 v[82:83], v[22:23], v[86:87] neg_lo:[0,1] neg_hi:[0,1]
v_pk_add_f32 v[20:21], v[20:21], v[84:85]
v_pk_add_f32 v[22:23], v[22:23], v[86:87]
v_pk_mul_f32 v[84:85], v[80:81], s[30:31] op_sel_hi:[1,0]
v_pk_mul_f32 v[86:87], v[80:81], s[36:37] op_sel_hi:[1,0]
v_pk_fma_f32 v[84:85], v[82:83], s[36:37], v[84:85] op_sel_hi:[1,0,1] neg_lo:[0,1,0] neg_hi:[0,1,0]
v_pk_fma_f32 v[86:87], v[82:83], s[30:31], v[86:87] op_sel_hi:[1,0,1]
v_pk_add_f32 v[80:81], v[24:25], v[88:89] neg_lo:[0,1] neg_hi:[0,1]
v_pk_add_f32 v[82:83], v[26:27], v[90:91] neg_lo:[0,1] neg_hi:[0,1]
v_pk_add_f32 v[24:25], v[24:25], v[88:89]
v_pk_add_f32 v[26:27], v[26:27], v[90:91]
v_pk_mul_f32 v[88:89], v[80:81], s[30:31] op_sel:[0,1]
v_pk_mul_f32 v[90:91], v[80:81], s[34:35] op_sel:[0,1]
v_pk_fma_f32 v[88:89], v[82:83], s[34:35], v[88:89] op_sel:[0,1,0] neg_lo:[0,1,0] neg_hi:[0,1,0]
v_pk_fma_f32 v[90:91], v[82:83], s[30:31], v[90:91] op_sel:[0,1,0]
v_pk_add_f32 v[80:81], v[28:29], v[92:93] neg_lo:[0,1] neg_hi:[0,1]
v_pk_add_f32 v[82:83], v[30:31], v[94:95] neg_lo:[0,1] neg_hi:[0,1]
v_pk_add_f32 v[28:29], v[28:29], v[92:93]
v_pk_add_f32 v[30:31], v[30:31], v[94:95]
v_pk_mul_f32 v[92:93], v[80:81], s[32:33] op_sel_hi:[1,0]
v_pk_mul_f32 v[94:95], v[80:81], s[34:35] op_sel_hi:[1,0]
v_pk_fma_f32 v[92:93], v[82:83], s[34:35], v[92:93] op_sel_hi:[1,0,1] neg_lo:[0,1,0] neg_hi:[0,1,0]
v_pk_fma_f32 v[94:95], v[82:83], s[32:33], v[94:95] op_sel_hi:[1,0,1]
v_pk_add_f32 v[80:81], v[32:33], v[96:97] neg_lo:[0,1] neg_hi:[0,1]
v_pk_add_f32 v[82:83], v[34:35], v[98:99] neg_lo:[0,1] neg_hi:[0,1]
v_pk_add_f32 v[32:33], v[32:33], v[96:97]
v_pk_add_f32 v[34:35], v[34:35], v[98:99]
v_pk_mul_f32 v[96:97], v[80:81], s[32:33] op_sel:[0,1]
v_pk_mul_f32 v[98:99], v[80:81], s[32:33] op_sel:[0,1]
v_pk_fma_f32 v[96:97], v[82:83], s[32:33], v[96:97] op_sel:[0,1,0] neg_lo:[0,1,0] neg_hi:[0,1,0]
v_pk_fma_f32 v[98:99], v[82:83], s[32:33], v[98:99] op_sel:[0,1,0]
v_pk_add_f32 v[80:81], v[36:37], v[100:101] neg_lo:[0,1] neg_hi:[0,1]
v_pk_add_f32 v[82:83], v[38:39], v[102:103] neg_lo:[0,1] neg_hi:[0,1]
v_pk_add_f32 v[36:37], v[36:37], v[100:101]
v_pk_add_f32 v[38:39], v[38:39], v[102:103]
v_pk_mul_f32 v[100:101], v[80:81], s[34:35] op_sel_hi:[1,0]
v_pk_mul_f32 v[102:103], v[80:81], s[32:33] op_sel_hi:[1,0]
v_pk_fma_f32 v[100:101], v[82:83], s[32:33], v[100:101] op_sel_hi:[1,0,1] neg_lo:[0,1,0] neg_hi:[0,1,0]
v_pk_fma_f32 v[102:103], v[82:83], s[34:35], v[102:103] op_sel_hi:[1,0,1]
v_pk_add_f32 v[80:81], v[40:41], v[104:105] neg_lo:[0,1] neg_hi:[0,1]
v_pk_add_f32 v[82:83], v[42:43], v[106:107] neg_lo:[0,1] neg_hi:[0,1]
v_pk_add_f32 v[40:41], v[40:41], v[104:105]
v_pk_add_f32 v[42:43], v[42:43], v[106:107]
v_pk_mul_f32 v[104:105], v[80:81], s[34:35] op_sel:[0,1]
v_pk_mul_f32 v[106:107], v[80:81], s[30:31] op_sel:[0,1]
v_pk_fma_f32 v[104:105], v[82:83], s[30:31], v[104:105] op_sel:[0,1,0] neg_lo:[0,1,0] neg_hi:[0,1,0]
v_pk_fma_f32 v[106:107], v[82:83], s[34:35], v[106:107] op_sel:[0,1,0]
v_pk_add_f32 v[80:81], v[44:45], v[108:109] neg_lo:[0,1] neg_hi:[0,1]
v_pk_add_f32 v[82:83], v[46:47], v[110:111] neg_lo:[0,1] neg_hi:[0,1]
v_pk_add_f32 v[44:45], v[44:45], v[108:109]
v_pk_add_f32 v[46:47], v[46:47], v[110:111]
v_pk_mul_f32 v[108:109], v[80:81], s[36:37] op_sel_hi:[1,0]
v_pk_mul_f32 v[110:111], v[80:81], s[30:31] op_sel_hi:[1,0]
v_pk_fma_f32 v[108:109], v[82:83], s[30:31], v[108:109] op_sel_hi:[1,0,1] neg_lo:[0,1,0] neg_hi:[0,1,0]
v_pk_fma_f32 v[110:111], v[82:83], s[36:37], v[110:111] op_sel_hi:[1,0,1]
v_pk_add_f32 v[80:81], v[114:115], v[50:51] neg_lo:[0,1] neg_hi:[0,1]
v_pk_add_f32 v[82:83], v[48:49], v[112:113] neg_lo:[0,1] neg_hi:[0,1]
v_pk_add_f32 v[48:49], v[48:49], v[112:113]
v_pk_add_f32 v[50:51], v[50:51], v[114:115]
v_pk_add_f32 v[112:113], v[52:53], v[116:117] neg_lo:[0,1] neg_hi:[0,1]
v_pk_add_f32 v[114:115], v[54:55], v[118:119] neg_lo:[0,1] neg_hi:[0,1]
v_pk_add_f32 v[52:53], v[52:53], v[116:117]
v_pk_add_f32 v[54:55], v[54:55], v[118:119]
v_pk_mul_f32 v[116:117], v[112:113], s[36:37] op_sel_hi:[1,0] neg_lo:[0,1] neg_hi:[0,1]
v_pk_mul_f32 v[118:119], v[112:113], s[30:31] op_sel_hi:[1,0]
v_pk_fma_f32 v[116:117], v[114:115], s[30:31], v[116:117] op_sel_hi:[1,0,1] neg_lo:[0,1,0] neg_hi:[0,1,0]
v_pk_fma_f32 v[118:119], v[114:115], s[36:37], v[118:119] op_sel_hi:[1,0,1] neg_lo:[0,1,0] neg_hi:[0,1,0]
v_pk_add_f32 v[112:113], v[56:57], v[120:121] neg_lo:[0,1] neg_hi:[0,1]
v_pk_add_f32 v[114:115], v[58:59], v[122:123] neg_lo:[0,1] neg_hi:[0,1]
v_pk_add_f32 v[56:57], v[56:57], v[120:121]
v_pk_add_f32 v[58:59], v[58:59], v[122:123]
v_pk_mul_f32 v[120:121], v[112:113], s[34:35] op_sel:[0,1] neg_lo:[0,1] neg_hi:[0,1]
v_pk_mul_f32 v[122:123], v[112:113], s[30:31] op_sel:[0,1]
v_pk_fma_f32 v[120:121], v[114:115], s[30:31], v[120:121] op_sel:[0,1,0] neg_lo:[0,1,0] neg_hi:[0,1,0]
v_pk_fma_f32 v[122:123], v[114:115], s[34:35], v[122:123] op_sel:[0,1,0] neg_lo:[0,1,0] neg_hi:[0,1,0]
v_pk_add_f32 v[112:113], v[60:61], v[124:125] neg_lo:[0,1] neg_hi:[0,1]
v_pk_add_f32 v[114:115], v[62:63], v[126:127] neg_lo:[0,1] neg_hi:[0,1]
v_pk_add_f32 v[60:61], v[60:61], v[124:125]
v_pk_add_f32 v[62:63], v[62:63], v[126:127]
v_pk_mul_f32 v[124:125], v[112:113], s[34:35] op_sel_hi:[1,0] neg_lo:[0,1] neg_hi:[0,1]
v_pk_mul_f32 v[126:127], v[112:113], s[32:33] op_sel_hi:[1,0]
v_pk_fma_f32 v[124:125], v[114:115], s[32:33], v[124:125] op_sel_hi:[1,0,1] neg_lo:[0,1,0] neg_hi:[0,1,0]
v_pk_fma_f32 v[126:127], v[114:115], s[34:35], v[126:127] op_sel_hi:[1,0,1] neg_lo:[0,1,0] neg_hi:[0,1,0]
v_pk_add_f32 v[112:113], v[64:65], v[128:129] neg_lo:[0,1] neg_hi:[0,1]
v_pk_add_f32 v[114:115], v[66:67], v[130:131] neg_lo:[0,1] neg_hi:[0,1]
v_pk_add_f32 v[64:65], v[64:65], v[128:129]
v_pk_add_f32 v[66:67], v[66:67], v[130:131]
v_pk_mul_f32 v[128:129], v[112:113], s[32:33] op_sel:[0,1] neg_lo:[0,1] neg_hi:[0,1]
v_pk_mul_f32 v[130:131], v[112:113], s[32:33] op_sel:[0,1]
v_pk_fma_f32 v[128:129], v[114:115], s[32:33], v[128:129] op_sel:[0,1,0] neg_lo:[0,1,0] neg_hi:[0,1,0]
v_pk_fma_f32 v[130:131], v[114:115], s[32:33], v[130:131] op_sel:[0,1,0] neg_lo:[0,1,0] neg_hi:[0,1,0]
v_pk_add_f32 v[112:113], v[68:69], v[132:133] neg_lo:[0,1] neg_hi:[0,1]
v_pk_add_f32 v[114:115], v[70:71], v[134:135] neg_lo:[0,1] neg_hi:[0,1]
v_pk_add_f32 v[68:69], v[68:69], v[132:133]
v_pk_add_f32 v[70:71], v[70:71], v[134:135]
v_pk_mul_f32 v[132:133], v[112:113], s[32:33] op_sel_hi:[1,0] neg_lo:[0,1] neg_hi:[0,1]
v_pk_mul_f32 v[134:135], v[112:113], s[34:35] op_sel_hi:[1,0]
v_pk_fma_f32 v[132:133], v[114:115], s[34:35], v[132:133] op_sel_hi:[1,0,1] neg_lo:[0,1,0] neg_hi:[0,1,0]
v_pk_fma_f32 v[134:135], v[114:115], s[32:33], v[134:135] op_sel_hi:[1,0,1] neg_lo:[0,1,0] neg_hi:[0,1,0]
v_pk_add_f32 v[112:113], v[72:73], v[136:137] neg_lo:[0,1] neg_hi:[0,1]
v_pk_add_f32 v[114:115], v[74:75], v[138:139] neg_lo:[0,1] neg_hi:[0,1]
v_pk_add_f32 v[72:73], v[72:73], v[136:137]
v_pk_add_f32 v[74:75], v[74:75], v[138:139]
v_pk_mul_f32 v[136:137], v[112:113], s[30:31] op_sel:[0,1] neg_lo:[0,1] neg_hi:[0,1]
v_pk_mul_f32 v[138:139], v[112:113], s[34:35] op_sel:[0,1]
v_pk_fma_f32 v[136:137], v[114:115], s[34:35], v[136:137] op_sel:[0,1,0] neg_lo:[0,1,0] neg_hi:[0,1,0]
v_pk_fma_f32 v[138:139], v[114:115], s[30:31], v[138:139] op_sel:[0,1,0] neg_lo:[0,1,0] neg_hi:[0,1,0]
v_pk_add_f32 v[112:113], v[76:77], v[140:141] neg_lo:[0,1] neg_hi:[0,1]
v_pk_add_f32 v[114:115], v[78:79], v[142:143] neg_lo:[0,1] neg_hi:[0,1]
v_pk_add_f32 v[76:77], v[76:77], v[140:141]
v_pk_add_f32 v[78:79], v[78:79], v[142:143]
v_pk_mul_f32 v[140:141], v[112:113], s[30:31] op_sel_hi:[1,0] neg_lo:[0,1] neg_hi:[0,1]
v_pk_mul_f32 v[142:143], v[112:113], s[36:37] op_sel_hi:[1,0]
v_pk_fma_f32 v[140:141], v[114:115], s[36:37], v[140:141] op_sel_hi:[1,0,1] neg_lo:[0,1,0] neg_hi:[0,1,0]
v_pk_fma_f32 v[142:143], v[114:115], s[30:31], v[142:143] op_sel_hi:[1,0,1] neg_lo:[0,1,0] neg_hi:[0,1,0]
v_pk_add_f32 v[112:113], v[16:17], v[48:49] neg_lo:[0,1] neg_hi:[0,1]
v_pk_add_f32 v[114:115], v[18:19], v[50:51] neg_lo:[0,1] neg_hi:[0,1]
v_pk_add_f32 v[16:17], v[16:17], v[48:49]
v_pk_add_f32 v[18:19], v[18:19], v[50:51]
v_pk_add_f32 v[48:49], v[20:21], v[52:53] neg_lo:[0,1] neg_hi:[0,1]
v_pk_add_f32 v[50:51], v[22:23], v[54:55] neg_lo:[0,1] neg_hi:[0,1]
v_pk_add_f32 v[20:21], v[20:21], v[52:53]
v_pk_add_f32 v[22:23], v[22:23], v[54:55]
v_pk_mul_f32 v[52:53], v[48:49], s[30:31] op_sel:[0,1]
v_pk_mul_f32 v[54:55], v[48:49], s[34:35] op_sel:[0,1]
v_pk_fma_f32 v[52:53], v[50:51], s[34:35], v[52:53] op_sel:[0,1,0] neg_lo:[0,1,0] neg_hi:[0,1,0]
v_pk_fma_f32 v[54:55], v[50:51], s[30:31], v[54:55] op_sel:[0,1,0]
v_pk_add_f32 v[48:49], v[24:25], v[56:57] neg_lo:[0,1] neg_hi:[0,1]
v_pk_add_f32 v[50:51], v[26:27], v[58:59] neg_lo:[0,1] neg_hi:[0,1]
v_pk_add_f32 v[24:25], v[24:25], v[56:57]
v_pk_add_f32 v[26:27], v[26:27], v[58:59]
v_pk_mul_f32 v[56:57], v[48:49], s[32:33] op_sel:[0,1]
v_pk_mul_f32 v[58:59], v[48:49], s[32:33] op_sel:[0,1]
v_pk_fma_f32 v[56:57], v[50:51], s[32:33], v[56:57] op_sel:[0,1,0] neg_lo:[0,1,0] neg_hi:[0,1,0]
v_pk_fma_f32 v[58:59], v[50:51], s[32:33], v[58:59] op_sel:[0,1,0]
v_pk_add_f32 v[48:49], v[28:29], v[60:61] neg_lo:[0,1] neg_hi:[0,1]
v_pk_add_f32 v[50:51], v[30:31], v[62:63] neg_lo:[0,1] neg_hi:[0,1]
v_pk_add_f32 v[28:29], v[28:29], v[60:61]
v_pk_add_f32 v[30:31], v[30:31], v[62:63]
v_pk_mul_f32 v[60:61], v[48:49], s[34:35] op_sel:[0,1]
v_pk_mul_f32 v[62:63], v[48:49], s[30:31] op_sel:[0,1]
v_pk_fma_f32 v[60:61], v[50:51], s[30:31], v[60:61] op_sel:[0,1,0] neg_lo:[0,1,0] neg_hi:[0,1,0]
v_pk_fma_f32 v[62:63], v[50:51], s[34:35], v[62:63] op_sel:[0,1,0]
v_pk_add_f32 v[48:49], v[66:67], v[34:35] neg_lo:[0,1] neg_hi:[0,1]
v_pk_add_f32 v[50:51], v[32:33], v[64:65] neg_lo:[0,1] neg_hi:[0,1]
v_pk_add_f32 v[32:33], v[32:33], v[64:65]
v_pk_add_f32 v[34:35], v[34:35], v[66:67]
v_pk_add_f32 v[64:65], v[36:37], v[68:69] neg_lo:[0,1] neg_hi:[0,1]
v_pk_add_f32 v[66:67], v[38:39], v[70:71] neg_lo:[0,1] neg_hi:[0,1]
v_pk_add_f32 v[36:37], v[36:37], v[68:69]
v_pk_add_f32 v[38:39], v[38:39], v[70:71]
v_pk_mul_f32 v[68:69], v[64:65], s[34:35] op_sel:[0,1] neg_lo:[0,1] neg_hi:[0,1]
v_pk_mul_f32 v[70:71], v[64:65], s[30:31] op_sel:[0,1]
v_pk_fma_f32 v[68:69], v[66:67], s[30:31], v[68:69] op_sel:[0,1,0] neg_lo:[0,1,0] neg_hi:[0,1,0]
v_pk_fma_f32 v[70:71], v[66:67], s[34:35], v[70:71] op_sel:[0,1,0] neg_lo:[0,1,0] neg_hi:[0,1,0]
v_pk_add_f32 v[64:65], v[40:41], v[72:73] neg_lo:[0,1] neg_hi:[0,1]
v_pk_add_f32 v[66:67], v[42:43], v[74:75] neg_lo:[0,1] neg_hi:[0,1]
v_pk_add_f32 v[40:41], v[40:41], v[72:73]
v_pk_add_f32 v[42:43], v[42:43], v[74:75]
v_pk_mul_f32 v[72:73], v[64:65], s[32:33] op_sel:[0,1] neg_lo:[0,1] neg_hi:[0,1]
v_pk_mul_f32 v[74:75], v[64:65], s[32:33] op_sel:[0,1]
v_pk_fma_f32 v[72:73], v[66:67], s[32:33], v[72:73] op_sel:[0,1,0] neg_lo:[0,1,0] neg_hi:[0,1,0]
v_pk_fma_f32 v[74:75], v[66:67], s[32:33], v[74:75] op_sel:[0,1,0] neg_lo:[0,1,0] neg_hi:[0,1,0]
v_pk_add_f32 v[64:65], v[44:45], v[76:77] neg_lo:[0,1] neg_hi:[0,1]
v_pk_add_f32 v[66:67], v[46:47], v[78:79] neg_lo:[0,1] neg_hi:[0,1]
v_pk_add_f32 v[44:45], v[44:45], v[76:77]
v_pk_add_f32 v[46:47], v[46:47], v[78:79]
v_pk_mul_f32 v[76:77], v[64:65], s[30:31] op_sel:[0,1] neg_lo:[0,1] neg_hi:[0,1]
v_pk_mul_f32 v[78:79], v[64:65], s[34:35] op_sel:[0,1]
v_pk_fma_f32 v[76:77], v[66:67], s[34:35], v[76:77] op_sel:[0,1,0] neg_lo:[0,1,0] neg_hi:[0,1,0]
v_pk_fma_f32 v[78:79], v[66:67], s[30:31], v[78:79] op_sel:[0,1,0] neg_lo:[0,1,0] neg_hi:[0,1,0]
v_pk_add_f32 v[64:65], v[144:145], v[80:81] neg_lo:[0,1] neg_hi:[0,1]
v_pk_add_f32 v[66:67], v[146:147], v[82:83] neg_lo:[0,1] neg_hi:[0,1]
v_pk_add_f32 v[144:145], v[144:145], v[80:81]
v_pk_add_f32 v[146:147], v[146:147], v[82:83]
v_pk_add_f32 v[80:81], v[84:85], v[116:117] neg_lo:[0,1] neg_hi:[0,1]
v_pk_add_f32 v[82:83], v[86:87], v[118:119] neg_lo:[0,1] neg_hi:[0,1]
v_pk_add_f32 v[84:85], v[84:85], v[116:117]
v_pk_add_f32 v[86:87], v[86:87], v[118:119]
v_pk_mul_f32 v[116:117], v[80:81], s[30:31] op_sel:[0,1]
v_pk_mul_f32 v[118:119], v[80:81], s[34:35] op_sel:[0,1]
v_pk_fma_f32 v[116:117], v[82:83], s[34:35], v[116:117] op_sel:[0,1,0] neg_lo:[0,1,0] neg_hi:[0,1,0]
v_pk_fma_f32 v[118:119], v[82:83], s[30:31], v[118:119] op_sel:[0,1,0]
v_pk_add_f32 v[80:81], v[88:89], v[120:121] neg_lo:[0,1] neg_hi:[0,1]
v_pk_add_f32 v[82:83], v[90:91], v[122:123] neg_lo:[0,1] neg_hi:[0,1]
v_pk_add_f32 v[88:89], v[88:89], v[120:121]
v_pk_add_f32 v[90:91], v[90:91], v[122:123]
v_pk_mul_f32 v[120:121], v[80:81], s[32:33] op_sel:[0,1]
v_pk_mul_f32 v[122:123], v[80:81], s[32:33] op_sel:[0,1]
v_pk_fma_f32 v[120:121], v[82:83], s[32:33], v[120:121] op_sel:[0,1,0] neg_lo:[0,1,0] neg_hi:[0,1,0]
v_pk_fma_f32 v[122:123], v[82:83], s[32:33], v[122:123] op_sel:[0,1,0]
v_pk_add_f32 v[80:81], v[92:93], v[124:125] neg_lo:[0,1] neg_hi:[0,1]
v_pk_add_f32 v[82:83], v[94:95], v[126:127] neg_lo:[0,1] neg_hi:[0,1]
v_pk_add_f32 v[92:93], v[92:93], v[124:125]
v_pk_add_f32 v[94:95], v[94:95], v[126:127]
v_pk_mul_f32 v[124:125], v[80:81], s[34:35] op_sel:[0,1]
v_pk_mul_f32 v[126:127], v[80:81], s[30:31] op_sel:[0,1]
v_pk_fma_f32 v[124:125], v[82:83], s[30:31], v[124:125] op_sel:[0,1,0] neg_lo:[0,1,0] neg_hi:[0,1,0]
v_pk_fma_f32 v[126:127], v[82:83], s[34:35], v[126:127] op_sel:[0,1,0]
v_pk_add_f32 v[80:81], v[130:131], v[98:99] neg_lo:[0,1] neg_hi:[0,1]
v_pk_add_f32 v[82:83], v[96:97], v[128:129] neg_lo:[0,1] neg_hi:[0,1]
v_pk_add_f32 v[96:97], v[96:97], v[128:129]
v_pk_add_f32 v[98:99], v[98:99], v[130:131]
v_pk_add_f32 v[128:129], v[100:101], v[132:133] neg_lo:[0,1] neg_hi:[0,1]
v_pk_add_f32 v[130:131], v[102:103], v[134:135] neg_lo:[0,1] neg_hi:[0,1]
v_pk_add_f32 v[100:101], v[100:101], v[132:133]
v_pk_add_f32 v[102:103], v[102:103], v[134:135]
v_pk_mul_f32 v[132:133], v[128:129], s[34:35] op_sel:[0,1] neg_lo:[0,1] neg_hi:[0,1]
v_pk_mul_f32 v[134:135], v[128:129], s[30:31] op_sel:[0,1]
v_pk_fma_f32 v[132:133], v[130:131], s[30:31], v[132:133] op_sel:[0,1,0] neg_lo:[0,1,0] neg_hi:[0,1,0]
v_pk_fma_f32 v[134:135], v[130:131], s[34:35], v[134:135] op_sel:[0,1,0] neg_lo:[0,1,0] neg_hi:[0,1,0]
v_pk_add_f32 v[128:129], v[104:105], v[136:137] neg_lo:[0,1] neg_hi:[0,1]
v_pk_add_f32 v[130:131], v[106:107], v[138:139] neg_lo:[0,1] neg_hi:[0,1]
v_pk_add_f32 v[104:105], v[104:105], v[136:137]
v_pk_add_f32 v[106:107], v[106:107], v[138:139]
v_pk_mul_f32 v[136:137], v[128:129], s[32:33] op_sel:[0,1] neg_lo:[0,1] neg_hi:[0,1]
v_pk_mul_f32 v[138:139], v[128:129], s[32:33] op_sel:[0,1]
v_pk_fma_f32 v[136:137], v[130:131], s[32:33], v[136:137] op_sel:[0,1,0] neg_lo:[0,1,0] neg_hi:[0,1,0]
v_pk_fma_f32 v[138:139], v[130:131], s[32:33], v[138:139] op_sel:[0,1,0] neg_lo:[0,1,0] neg_hi:[0,1,0]
v_pk_add_f32 v[128:129], v[108:109], v[140:141] neg_lo:[0,1] neg_hi:[0,1]
v_pk_add_f32 v[130:131], v[110:111], v[142:143] neg_lo:[0,1] neg_hi:[0,1]
v_pk_add_f32 v[108:109], v[108:109], v[140:141]
v_pk_add_f32 v[110:111], v[110:111], v[142:143]
v_pk_mul_f32 v[140:141], v[128:129], s[30:31] op_sel:[0,1] neg_lo:[0,1] neg_hi:[0,1]
v_pk_mul_f32 v[142:143], v[128:129], s[34:35] op_sel:[0,1]
v_pk_fma_f32 v[140:141], v[130:131], s[34:35], v[140:141] op_sel:[0,1,0] neg_lo:[0,1,0] neg_hi:[0,1,0]
v_pk_fma_f32 v[142:143], v[130:131], s[30:31], v[142:143] op_sel:[0,1,0] neg_lo:[0,1,0] neg_hi:[0,1,0]
v_pk_add_f32 v[128:129], v[16:17], v[32:33] neg_lo:[0,1] neg_hi:[0,1]
v_pk_add_f32 v[130:131], v[18:19], v[34:35] neg_lo:[0,1] neg_hi:[0,1]
v_pk_add_f32 v[16:17], v[16:17], v[32:33]
v_pk_add_f32 v[18:19], v[18:19], v[34:35]
v_pk_add_f32 v[32:33], v[20:21], v[36:37] neg_lo:[0,1] neg_hi:[0,1]
v_pk_add_f32 v[34:35], v[22:23], v[38:39] neg_lo:[0,1] neg_hi:[0,1]
v_pk_add_f32 v[20:21], v[20:21], v[36:37]
v_pk_add_f32 v[22:23], v[22:23], v[38:39]
v_pk_mul_f32 v[36:37], v[32:33], s[32:33] op_sel:[0,1]
v_pk_mul_f32 v[38:39], v[32:33], s[32:33] op_sel:[0,1]
v_pk_fma_f32 v[36:37], v[34:35], s[32:33], v[36:37] op_sel:[0,1,0] neg_lo:[0,1,0] neg_hi:[0,1,0]
v_pk_fma_f32 v[38:39], v[34:35], s[32:33], v[38:39] op_sel:[0,1,0]
v_pk_add_f32 v[32:33], v[42:43], v[26:27] neg_lo:[0,1] neg_hi:[0,1]
v_pk_add_f32 v[34:35], v[24:25], v[40:41] neg_lo:[0,1] neg_hi:[0,1]
v_pk_add_f32 v[24:25], v[24:25], v[40:41]
v_pk_add_f32 v[26:27], v[26:27], v[42:43]
v_pk_add_f32 v[40:41], v[28:29], v[44:45] neg_lo:[0,1] neg_hi:[0,1]
v_pk_add_f32 v[42:43], v[30:31], v[46:47] neg_lo:[0,1] neg_hi:[0,1]
v_pk_add_f32 v[28:29], v[28:29], v[44:45]
v_pk_add_f32 v[30:31], v[30:31], v[46:47]
v_pk_mul_f32 v[44:45], v[40:41], s[32:33] op_sel:[0,1] neg_lo:[0,1] neg_hi:[0,1]
v_pk_mul_f32 v[46:47], v[40:41], s[32:33] op_sel:[0,1]
v_pk_fma_f32 v[44:45], v[42:43], s[32:33], v[44:45] op_sel:[0,1,0] neg_lo:[0,1,0] neg_hi:[0,1,0]
v_pk_fma_f32 v[46:47], v[42:43], s[32:33], v[46:47] op_sel:[0,1,0] neg_lo:[0,1,0] neg_hi:[0,1,0]
v_pk_add_f32 v[40:41], v[112:113], v[48:49] neg_lo:[0,1] neg_hi:[0,1]
v_pk_add_f32 v[42:43], v[114:115], v[50:51] neg_lo:[0,1] neg_hi:[0,1]
v_pk_add_f32 v[112:113], v[112:113], v[48:49]
v_pk_add_f32 v[114:115], v[114:115], v[50:51]
v_pk_add_f32 v[48:49], v[52:53], v[68:69] neg_lo:[0,1] neg_hi:[0,1]
v_pk_add_f32 v[50:51], v[54:55], v[70:71] neg_lo:[0,1] neg_hi:[0,1]
v_pk_add_f32 v[52:53], v[52:53], v[68:69]
v_pk_add_f32 v[54:55], v[54:55], v[70:71]
v_pk_mul_f32 v[68:69], v[48:49], s[32:33] op_sel:[0,1]
v_pk_mul_f32 v[70:71], v[48:49], s[32:33] op_sel:[0,1]
v_pk_fma_f32 v[68:69], v[50:51], s[32:33], v[68:69] op_sel:[0,1,0] neg_lo:[0,1,0] neg_hi:[0,1,0]
v_pk_fma_f32 v[70:71], v[50:51], s[32:33], v[70:71] op_sel:[0,1,0]
v_pk_add_f32 v[48:49], v[74:75], v[58:59] neg_lo:[0,1] neg_hi:[0,1]
v_pk_add_f32 v[50:51], v[56:57], v[72:73] neg_lo:[0,1] neg_hi:[0,1]
v_pk_add_f32 v[56:57], v[56:57], v[72:73]
v_pk_add_f32 v[58:59], v[58:59], v[74:75]
v_pk_add_f32 v[72:73], v[60:61], v[76:77] neg_lo:[0,1] neg_hi:[0,1]
v_pk_add_f32 v[74:75], v[62:63], v[78:79] neg_lo:[0,1] neg_hi:[0,1]
v_pk_add_f32 v[60:61], v[60:61], v[76:77]
v_pk_add_f32 v[62:63], v[62:63], v[78:79]
v_pk_mul_f32 v[76:77], v[72:73], s[32:33] op_sel:[0,1] neg_lo:[0,1] neg_hi:[0,1]
v_pk_mul_f32 v[78:79], v[72:73], s[32:33] op_sel:[0,1]
v_pk_fma_f32 v[76:77], v[74:75], s[32:33], v[76:77] op_sel:[0,1,0] neg_lo:[0,1,0] neg_hi:[0,1,0]
v_pk_fma_f32 v[78:79], v[74:75], s[32:33], v[78:79] op_sel:[0,1,0] neg_lo:[0,1,0] neg_hi:[0,1,0]
v_pk_add_f32 v[72:73], v[144:145], v[96:97] neg_lo:[0,1] neg_hi:[0,1]
v_pk_add_f32 v[74:75], v[146:147], v[98:99] neg_lo:[0,1] neg_hi:[0,1]
v_pk_add_f32 v[144:145], v[144:145], v[96:97]
v_pk_add_f32 v[146:147], v[146:147], v[98:99]
v_pk_add_f32 v[96:97], v[84:85], v[100:101] neg_lo:[0,1] neg_hi:[0,1]
v_pk_add_f32 v[98:99], v[86:87], v[102:103] neg_lo:[0,1] neg_hi:[0,1]
v_pk_add_f32 v[84:85], v[84:85], v[100:101]
v_pk_add_f32 v[86:87], v[86:87], v[102:103]
v_pk_mul_f32 v[100:101], v[96:97], s[32:33] op_sel:[0,1]
v_pk_mul_f32 v[102:103], v[96:97], s[32:33] op_sel:[0,1]
v_pk_fma_f32 v[100:101], v[98:99], s[32:33], v[100:101] op_sel:[0,1,0] neg_lo:[0,1,0] neg_hi:[0,1,0]
v_pk_fma_f32 v[102:103], v[98:99], s[32:33], v[102:103] op_sel:[0,1,0]
v_pk_add_f32 v[96:97], v[106:107], v[90:91] neg_lo:[0,1] neg_hi:[0,1]
v_pk_add_f32 v[98:99], v[88:89], v[104:105] neg_lo:[0,1] neg_hi:[0,1]
v_pk_add_f32 v[88:89], v[88:89], v[104:105]
v_pk_add_f32 v[90:91], v[90:91], v[106:107]
v_pk_add_f32 v[104:105], v[92:93], v[108:109] neg_lo:[0,1] neg_hi:[0,1]
v_pk_add_f32 v[106:107], v[94:95], v[110:111] neg_lo:[0,1] neg_hi:[0,1]
v_pk_add_f32 v[92:93], v[92:93], v[108:109]
v_pk_add_f32 v[94:95], v[94:95], v[110:111]
v_pk_mul_f32 v[108:109], v[104:105], s[32:33] op_sel:[0,1] neg_lo:[0,1] neg_hi:[0,1]
v_pk_mul_f32 v[110:111], v[104:105], s[32:33] op_sel:[0,1]
v_pk_fma_f32 v[108:109], v[106:107], s[32:33], v[108:109] op_sel:[0,1,0] neg_lo:[0,1,0] neg_hi:[0,1,0]
v_pk_fma_f32 v[110:111], v[106:107], s[32:33], v[110:111] op_sel:[0,1,0] neg_lo:[0,1,0] neg_hi:[0,1,0]
v_pk_add_f32 v[104:105], v[64:65], v[80:81] neg_lo:[0,1] neg_hi:[0,1]
v_pk_add_f32 v[106:107], v[66:67], v[82:83] neg_lo:[0,1] neg_hi:[0,1]
v_pk_add_f32 v[64:65], v[64:65], v[80:81]
v_pk_add_f32 v[66:67], v[66:67], v[82:83]
v_pk_add_f32 v[80:81], v[116:117], v[132:133] neg_lo:[0,1] neg_hi:[0,1]
v_pk_add_f32 v[82:83], v[118:119], v[134:135] neg_lo:[0,1] neg_hi:[0,1]
v_pk_add_f32 v[116:117], v[116:117], v[132:133]
v_pk_add_f32 v[118:119], v[118:119], v[134:135]
v_pk_mul_f32 v[132:133], v[80:81], s[32:33] op_sel:[0,1]
v_pk_mul_f32 v[134:135], v[80:81], s[32:33] op_sel:[0,1]
v_pk_fma_f32 v[132:133], v[82:83], s[32:33], v[132:133] op_sel:[0,1,0] neg_lo:[0,1,0] neg_hi:[0,1,0]
v_pk_fma_f32 v[134:135], v[82:83], s[32:33], v[134:135] op_sel:[0,1,0]
v_pk_add_f32 v[80:81], v[138:139], v[122:123] neg_lo:[0,1] neg_hi:[0,1]
v_pk_add_f32 v[82:83], v[120:121], v[136:137] neg_lo:[0,1] neg_hi:[0,1]
v_pk_add_f32 v[120:121], v[120:121], v[136:137]
v_pk_add_f32 v[122:123], v[122:123], v[138:139]
v_pk_add_f32 v[136:137], v[124:125], v[140:141] neg_lo:[0,1] neg_hi:[0,1]
v_pk_add_f32 v[138:139], v[126:127], v[142:143] neg_lo:[0,1] neg_hi:[0,1]
v_pk_add_f32 v[124:125], v[124:125], v[140:141]
v_pk_add_f32 v[126:127], v[126:127], v[142:143]
v_pk_mul_f32 v[140:141], v[136:137], s[32:33] op_sel:[0,1] neg_lo:[0,1] neg_hi:[0,1]
v_pk_mul_f32 v[142:143], v[136:137], s[32:33] op_sel:[0,1]
v_pk_fma_f32 v[140:141], v[138:139], s[32:33], v[140:141] op_sel:[0,1,0] neg_lo:[0,1,0] neg_hi:[0,1,0]
v_pk_fma_f32 v[142:143], v[138:139], s[32:33], v[142:143] op_sel:[0,1,0] neg_lo:[0,1,0] neg_hi:[0,1,0]
v_pk_add_f32 v[136:137], v[16:17], v[24:25] neg_lo:[0,1] neg_hi:[0,1]
v_pk_add_f32 v[138:139], v[18:19], v[26:27] neg_lo:[0,1] neg_hi:[0,1]
v_pk_add_f32 v[16:17], v[16:17], v[24:25]
v_pk_add_f32 v[18:19], v[18:19], v[26:27]
v_pk_add_f32 v[24:25], v[30:31], v[22:23] neg_lo:[0,1] neg_hi:[0,1]
v_pk_add_f32 v[26:27], v[20:21], v[28:29] neg_lo:[0,1] neg_hi:[0,1]
v_pk_add_f32 v[20:21], v[20:21], v[28:29]
v_pk_add_f32 v[22:23], v[22:23], v[30:31]
v_pk_add_f32 v[28:29], v[128:129], v[32:33] neg_lo:[0,1] neg_hi:[0,1]
v_pk_add_f32 v[30:31], v[130:131], v[34:35] neg_lo:[0,1] neg_hi:[0,1]
v_pk_add_f32 v[128:129], v[128:129], v[32:33]
v_pk_add_f32 v[130:131], v[130:131], v[34:35]
v_pk_add_f32 v[32:33], v[46:47], v[38:39] neg_lo:[0,1] neg_hi:[0,1]
v_pk_add_f32 v[34:35], v[36:37], v[44:45] neg_lo:[0,1] neg_hi:[0,1]
v_pk_add_f32 v[36:37], v[36:37], v[44:45]
v_pk_add_f32 v[38:39], v[38:39], v[46:47]
v_pk_add_f32 v[44:45], v[112:113], v[56:57] neg_lo:[0,1] neg_hi:[0,1]
v_pk_add_f32 v[46:47], v[114:115], v[58:59] neg_lo:[0,1] neg_hi:[0,1]
v_pk_add_f32 v[112:113], v[112:113], v[56:57]
v_pk_add_f32 v[114:115], v[114:115], v[58:59]
v_pk_add_f32 v[56:57], v[62:63], v[54:55] neg_lo:[0,1] neg_hi:[0,1]
v_pk_add_f32 v[58:59], v[52:53], v[60:61] neg_lo:[0,1] neg_hi:[0,1]
v_pk_add_f32 v[52:53], v[52:53], v[60:61]
v_pk_add_f32 v[54:55], v[54:55], v[62:63]
v_pk_add_f32 v[60:61], v[40:41], v[48:49] neg_lo:[0,1] neg_hi:[0,1]
v_pk_add_f32 v[62:63], v[42:43], v[50:51] neg_lo:[0,1] neg_hi:[0,1]
v_pk_add_f32 v[40:41], v[40:41], v[48:49]
v_pk_add_f32 v[42:43], v[42:43], v[50:51]
v_pk_add_f32 v[48:49], v[78:79], v[70:71] neg_lo:[0,1] neg_hi:[0,1]
v_pk_add_f32 v[50:51], v[68:69], v[76:77] neg_lo:[0,1] neg_hi:[0,1]
v_pk_add_f32 v[68:69], v[68:69], v[76:77]
v_pk_add_f32 v[70:71], v[70:71], v[78:79]
v_pk_add_f32 v[76:77], v[144:145], v[88:89] neg_lo:[0,1] neg_hi:[0,1]
v_pk_add_f32 v[78:79], v[146:147], v[90:91] neg_lo:[0,1] neg_hi:[0,1]
v_pk_add_f32 v[144:145], v[144:145], v[88:89]
v_pk_add_f32 v[146:147], v[146:147], v[90:91]
v_pk_add_f32 v[88:89], v[94:95], v[86:87] neg_lo:[0,1] neg_hi:[0,1]
v_pk_add_f32 v[90:91], v[84:85], v[92:93] neg_lo:[0,1] neg_hi:[0,1]
v_pk_add_f32 v[84:85], v[84:85], v[92:93]
v_pk_add_f32 v[86:87], v[86:87], v[94:95]
v_pk_add_f32 v[92:93], v[72:73], v[96:97] neg_lo:[0,1] neg_hi:[0,1]
v_pk_add_f32 v[94:95], v[74:75], v[98:99] neg_lo:[0,1] neg_hi:[0,1]
v_pk_add_f32 v[72:73], v[72:73], v[96:97]
v_pk_add_f32 v[74:75], v[74:75], v[98:99]
v_pk_add_f32 v[96:97], v[110:111], v[102:103] neg_lo:[0,1] neg_hi:[0,1]
v_pk_add_f32 v[98:99], v[100:101], v[108:109] neg_lo:[0,1] neg_hi:[0,1]
v_pk_add_f32 v[100:101], v[100:101], v[108:109]
v_pk_add_f32 v[102:103], v[102:103], v[110:111]
v_pk_add_f32 v[108:109], v[64:65], v[120:121] neg_lo:[0,1] neg_hi:[0,1]
v_pk_add_f32 v[110:111], v[66:67], v[122:123] neg_lo:[0,1] neg_hi:[0,1]
v_pk_add_f32 v[64:65], v[64:65], v[120:121]
v_pk_add_f32 v[66:67], v[66:67], v[122:123]
v_pk_add_f32 v[120:121], v[126:127], v[118:119] neg_lo:[0,1] neg_hi:[0,1]
v_pk_add_f32 v[122:123], v[116:117], v[124:125] neg_lo:[0,1] neg_hi:[0,1]
v_pk_add_f32 v[116:117], v[116:117], v[124:125]
v_pk_add_f32 v[118:119], v[118:119], v[126:127]
v_pk_add_f32 v[124:125], v[104:105], v[80:81] neg_lo:[0,1] neg_hi:[0,1]
v_pk_add_f32 v[126:127], v[106:107], v[82:83] neg_lo:[0,1] neg_hi:[0,1]
v_pk_add_f32 v[104:105], v[104:105], v[80:81]
v_pk_add_f32 v[106:107], v[106:107], v[82:83]
v_pk_add_f32 v[80:81], v[142:143], v[134:135] neg_lo:[0,1] neg_hi:[0,1]
v_pk_add_f32 v[82:83], v[132:133], v[140:141] neg_lo:[0,1] neg_hi:[0,1]
v_pk_add_f32 v[132:133], v[132:133], v[140:141]
v_pk_add_f32 v[134:135], v[134:135], v[142:143]
v_pk_add_f32 v[140:141], v[16:17], v[20:21] neg_lo:[0,1] neg_hi:[0,1]
v_pk_add_f32 v[142:143], v[18:19], v[22:23] neg_lo:[0,1] neg_hi:[0,1]
v_pk_add_f32 v[16:17], v[16:17], v[20:21]
v_pk_add_f32 v[18:19], v[18:19], v[22:23]
v_pk_add_f32 v[20:21], v[136:137], v[24:25] neg_lo:[0,1] neg_hi:[0,1]
v_pk_add_f32 v[22:23], v[138:139], v[26:27] neg_lo:[0,1] neg_hi:[0,1]
v_pk_add_f32 v[136:137], v[136:137], v[24:25]
v_pk_add_f32 v[138:139], v[138:139], v[26:27]
v_pk_add_f32 v[24:25], v[128:129], v[36:37] neg_lo:[0,1] neg_hi:[0,1]
v_pk_add_f32 v[26:27], v[130:131], v[38:39] neg_lo:[0,1] neg_hi:[0,1]
v_pk_add_f32 v[128:129], v[128:129], v[36:37]
v_pk_add_f32 v[130:131], v[130:131], v[38:39]
v_pk_add_f32 v[36:37], v[28:29], v[32:33] neg_lo:[0,1] neg_hi:[0,1]
v_pk_add_f32 v[38:39], v[30:31], v[34:35] neg_lo:[0,1] neg_hi:[0,1]
v_pk_add_f32 v[28:29], v[28:29], v[32:33]
v_pk_add_f32 v[30:31], v[30:31], v[34:35]
v_pk_add_f32 v[32:33], v[112:113], v[52:53] neg_lo:[0,1] neg_hi:[0,1]
v_pk_add_f32 v[34:35], v[114:115], v[54:55] neg_lo:[0,1] neg_hi:[0,1]
v_pk_add_f32 v[112:113], v[112:113], v[52:53]
v_pk_add_f32 v[114:115], v[114:115], v[54:55]
v_pk_add_f32 v[52:53], v[44:45], v[56:57] neg_lo:[0,1] neg_hi:[0,1]
v_pk_add_f32 v[54:55], v[46:47], v[58:59] neg_lo:[0,1] neg_hi:[0,1]
v_pk_add_f32 v[44:45], v[44:45], v[56:57]
v_pk_add_f32 v[46:47], v[46:47], v[58:59]
v_pk_add_f32 v[56:57], v[40:41], v[68:69] neg_lo:[0,1] neg_hi:[0,1]
v_pk_add_f32 v[58:59], v[42:43], v[70:71] neg_lo:[0,1] neg_hi:[0,1]
v_pk_add_f32 v[40:41], v[40:41], v[68:69]
v_pk_add_f32 v[42:43], v[42:43], v[70:71]
v_pk_add_f32 v[68:69], v[60:61], v[48:49] neg_lo:[0,1] neg_hi:[0,1]
v_pk_add_f32 v[70:71], v[62:63], v[50:51] neg_lo:[0,1] neg_hi:[0,1]
v_pk_add_f32 v[60:61], v[60:61], v[48:49]
v_pk_add_f32 v[62:63], v[62:63], v[50:51]
v_pk_add_f32 v[48:49], v[144:145], v[84:85] neg_lo:[0,1] neg_hi:[0,1]
v_pk_add_f32 v[50:51], v[146:147], v[86:87] neg_lo:[0,1] neg_hi:[0,1]
v_pk_add_f32 v[144:145], v[144:145], v[84:85]
v_pk_add_f32 v[146:147], v[146:147], v[86:87]
v_pk_add_f32 v[84:85], v[76:77], v[88:89] neg_lo:[0,1] neg_hi:[0,1]
v_pk_add_f32 v[86:87], v[78:79], v[90:91] neg_lo:[0,1] neg_hi:[0,1]
v_pk_add_f32 v[76:77], v[76:77], v[88:89]
v_pk_add_f32 v[78:79], v[78:79], v[90:91]
v_pk_add_f32 v[88:89], v[72:73], v[100:101] neg_lo:[0,1] neg_hi:[0,1]
v_pk_add_f32 v[90:91], v[74:75], v[102:103] neg_lo:[0,1] neg_hi:[0,1]
v_pk_add_f32 v[72:73], v[72:73], v[100:101]
v_pk_add_f32 v[74:75], v[74:75], v[102:103]
v_pk_add_f32 v[100:101], v[92:93], v[96:97] neg_lo:[0,1] neg_hi:[0,1]
v_pk_add_f32 v[102:103], v[94:95], v[98:99] neg_lo:[0,1] neg_hi:[0,1]
v_pk_add_f32 v[92:93], v[92:93], v[96:97]
v_pk_add_f32 v[94:95], v[94:95], v[98:99]
v_pk_add_f32 v[96:97], v[64:65], v[116:117] neg_lo:[0,1] neg_hi:[0,1]
v_pk_add_f32 v[98:99], v[66:67], v[118:119] neg_lo:[0,1] neg_hi:[0,1]
v_pk_add_f32 v[64:65], v[64:65], v[116:117]
v_pk_add_f32 v[66:67], v[66:67], v[118:119]
v_pk_add_f32 v[116:117], v[108:109], v[120:121] neg_lo:[0,1] neg_hi:[0,1]
v_pk_add_f32 v[118:119], v[110:111], v[122:123] neg_lo:[0,1] neg_hi:[0,1]
v_pk_add_f32 v[108:109], v[108:109], v[120:121]
v_pk_add_f32 v[110:111], v[110:111], v[122:123]
v_pk_add_f32 v[120:121], v[104:105], v[132:133] neg_lo:[0,1] neg_hi:[0,1]
v_pk_add_f32 v[122:123], v[106:107], v[134:135] neg_lo:[0,1] neg_hi:[0,1]
v_pk_add_f32 v[104:105], v[104:105], v[132:133]
v_pk_add_f32 v[106:107], v[106:107], v[134:135]
v_pk_add_f32 v[132:133], v[124:125], v[80:81] neg_lo:[0,1] neg_hi:[0,1]
v_pk_add_f32 v[134:135], v[126:127], v[82:83] neg_lo:[0,1] neg_hi:[0,1]
v_pk_add_f32 v[124:125], v[124:125], v[80:81]
v_pk_add_f32 v[126:127], v[126:127], v[82:83]
v_mul_f32 v151, 0x3a800000, v3
v_cos_f32 v150, v151
v_sin_f32 v151, v151
v_mul_f32 v149, 0x3b000000, v3
v_cos_f32 v148, v149
v_sin_f32 v149, v149
v_pk_mul_f32 v[80:81], v[144:145], v[150:151] op_sel_hi:[1,0]
v_pk_fma_f32 v[80:81], v[146:147], v[150:151], v[80:81] op_sel:[0,1,0] neg_lo:[1,0,0] neg_hi:[1,0,0]
v_pk_mul_f32 v[146:147], v[146:147], v[150:151] op_sel_hi:[1,0]
v_pk_fma_f32 v[146:147], v[144:145], v[150:151], v[146:147] op_sel:[0,1,0]
v_mul_f32 v151, 0x3b400000, v3
v_cos_f32 v150, v151
v_sin_f32 v151, v151
v_pk_mul_f32 v[144:145], v[112:113], v[148:149] op_sel_hi:[1,0]
v_pk_fma_f32 v[144:145], v[114:115], v[148:149], v[144:145] op_sel:[0,1,0] neg_lo:[1,0,0] neg_hi:[1,0,0]
v_pk_mul_f32 v[114:115], v[114:115], v[148:149] op_sel_hi:[1,0]
v_pk_fma_f32 v[114:115], v[112:113], v[148:149], v[114:115] op_sel:[0,1,0]
v_mul_f32 v149, 0x3b800000, v3
v_cos_f32 v148, v149
v_sin_f32 v149, v149
v_pk_mul_f32 v[112:113], v[64:65], v[150:151] op_sel_hi:[1,0]
v_pk_fma_f32 v[112:113], v[66:67], v[150:151], v[112:113] op_sel:[0,1,0] neg_lo:[1,0,0] neg_hi:[1,0,0]
v_pk_mul_f32 v[66:67], v[66:67], v[150:151] op_sel_hi:[1,0]
v_pk_fma_f32 v[66:67], v[64:65], v[150:151], v[66:67] op_sel:[0,1,0]
v_mul_f32 v151, 0x3ba00000, v3
v_cos_f32 v150, v151
v_sin_f32 v151, v151
v_pk_mul_f32 v[64:65], v[128:129], v[148:149] op_sel_hi:[1,0]
v_pk_fma_f32 v[64:65], v[130:131], v[148:149], v[64:65] op_sel:[0,1,0] neg_lo:[1,0,0] neg_hi:[1,0,0]
v_pk_mul_f32 v[130:131], v[130:131], v[148:149] op_sel_hi:[1,0]
v_pk_fma_f32 v[130:131], v[128:129], v[148:149], v[130:131] op_sel:[0,1,0]
v_mul_f32 v149, 0x3bc00000, v3
v_cos_f32 v148, v149
v_sin_f32 v149, v149
v_pk_mul_f32 v[128:129], v[72:73], v[150:151] op_sel_hi:[1,0]
v_pk_fma_f32 v[128:129], v[74:75], v[150:151], v[128:129] op_sel:[0,1,0] neg_lo:[1,0,0] neg_hi:[1,0,0]
v_pk_mul_f32 v[74:75], v[74:75], v[150:151] op_sel_hi:[1,0]
v_pk_fma_f32 v[74:75], v[72:73], v[150:151], v[74:75] op_sel:[0,1,0]
v_mul_f32 v151, 0x3be00000, v3
v_cos_f32 v150, v151
v_sin_f32 v151, v151
v_pk_mul_f32 v[72:73], v[40:41], v[148:149] op_sel_hi:[1,0]
v_pk_fma_f32 v[72:73], v[42:43], v[148:149], v[72:73] op_sel:[0,1,0] neg_lo:[1,0,0] neg_hi:[1,0,0]
v_pk_mul_f32 v[42:43], v[42:43], v[148:149] op_sel_hi:[1,0]
v_pk_fma_f32 v[42:43], v[40:41], v[148:149], v[42:43] op_sel:[0,1,0]
v_mul_f32 v149, 0x3c000000, v3
v_cos_f32 v148, v149
v_sin_f32 v149, v149
v_pk_mul_f32 v[40:41], v[104:105], v[150:151] op_sel_hi:[1,0]
v_pk_fma_f32 v[40:41], v[106:107], v[150:151], v[40:41] op_sel:[0,1,0] neg_lo:[1,0,0] neg_hi:[1,0,0]
v_pk_mul_f32 v[106:107], v[106:107], v[150:151] op_sel_hi:[1,0]
v_pk_fma_f32 v[106:107], v[104:105], v[150:151], v[106:107] op_sel:[0,1,0]
v_mul_f32 v151, 0x3c100000, v3
v_cos_f32 v150, v151
v_sin_f32 v151, v151
v_pk_mul_f32 v[104:105], v[136:137], v[148:149] op_sel_hi:[1,0]
v_pk_fma_f32 v[104:105], v[138:139], v[148:149], v[104:105] op_sel:[0,1,0] neg_lo:[1,0,0] neg_hi:[1,0,0]
v_pk_mul_f32 v[138:139], v[138:139], v[148:149] op_sel_hi:[1,0]
v_pk_fma_f32 v[138:139], v[136:137], v[148:149], v[138:139] op_sel:[0,1,0]
v_mul_f32 v149, 0x3c200000, v3
v_cos_f32 v148, v149
v_sin_f32 v149, v149
v_pk_mul_f32 v[136:137], v[76:77], v[150:151] op_sel_hi:[1,0]
v_pk_fma_f32 v[136:137], v[78:79], v[150:151], v[136:137] op_sel:[0,1,0] neg_lo:[1,0,0] neg_hi:[1,0,0]
v_pk_mul_f32 v[78:79], v[78:79], v[150:151] op_sel_hi:[1,0]
v_pk_fma_f32 v[78:79], v[76:77], v[150:151], v[78:79] op_sel:[0,1,0]
v_mul_f32 v151, 0x3c300000, v3
v_cos_f32 v150, v151
v_sin_f32 v151, v151
v_pk_mul_f32 v[76:77], v[44:45], v[148:149] op_sel_hi:[1,0]
v_pk_fma_f32 v[76:77], v[46:47], v[148:149], v[76:77] op_sel:[0,1,0] neg_lo:[1,0,0] neg_hi:[1,0,0]
v_pk_mul_f32 v[46:47], v[46:47], v[148:149] op_sel_hi:[1,0]
v_pk_fma_f32 v[46:47], v[44:45], v[148:149], v[46:47] op_sel:[0,1,0]
v_mul_f32 v149, 0x3c400000, v3
v_cos_f32 v148, v149
v_sin_f32 v149, v149
v_pk_mul_f32 v[44:45], v[108:109], v[150:151] op_sel_hi:[1,0]
v_pk_fma_f32 v[44:45], v[110:111], v[150:151], v[44:45] op_sel:[0,1,0] neg_lo:[1,0,0] neg_hi:[1,0,0]
v_pk_mul_f32 v[110:111], v[110:111], v[150:151] op_sel_hi:[1,0]
v_pk_fma_f32 v[110:111], v[108:109], v[150:151], v[110:111] op_sel:[0,1,0]
v_mul_f32 v151, 0x3c500000, v3
v_cos_f32 v150, v151
v_sin_f32 v151, v151
v_pk_mul_f32 v[108:109], v[28:29], v[148:149] op_sel_hi:[1,0]
v_pk_fma_f32 v[108:109], v[30:31], v[148:149], v[108:109] op_sel:[0,1,0] neg_lo:[1,0,0] neg_hi:[1,0,0]
v_pk_mul_f32 v[30:31], v[30:31], v[148:149] op_sel_hi:[1,0]
v_pk_fma_f32 v[30:31], v[28:29], v[148:149], v[30:31] op_sel:[0,1,0]
v_mul_f32 v149, 0x3c600000, v3
v_cos_f32 v148, v149
v_sin_f32 v149, v149
v_pk_mul_f32 v[28:29], v[92:93], v[150:151] op_sel_hi:[1,0]
v_pk_fma_f32 v[28:29], v[94:95], v[150:151], v[28:29] op_sel:[0,1,0] neg_lo:[1,0,0] neg_hi:[1,0,0]
v_pk_mul_f32 v[94:95], v[94:95], v[150:151] op_sel_hi:[1,0]
v_pk_fma_f32 v[94:95], v[92:93], v[150:151], v[94:95] op_sel:[0,1,0]
v_mul_f32 v151, 0x3c700000, v3
v_cos_f32 v150, v151
v_sin_f32 v151, v151
v_pk_mul_f32 v[92:93], v[60:61], v[148:149] op_sel_hi:[1,0]
v_pk_fma_f32 v[92:93], v[62:63], v[148:149], v[92:93] op_sel:[0,1,0] neg_lo:[1,0,0] neg_hi:[1,0,0]
v_pk_mul_f32 v[62:63], v[62:63], v[148:149] op_sel_hi:[1,0]
v_pk_fma_f32 v[62:63], v[60:61], v[148:149], v[62:63] op_sel:[0,1,0]
v_mul_f32 v149, 0x3c800000, v3
v_cos_f32 v148, v149
v_sin_f32 v149, v149
v_pk_mul_f32 v[60:61], v[124:125], v[150:151] op_sel_hi:[1,0]
v_pk_fma_f32 v[60:61], v[126:127], v[150:151], v[60:61] op_sel:[0,1,0] neg_lo:[1,0,0] neg_hi:[1,0,0]
v_pk_mul_f32 v[126:127], v[126:127], v[150:151] op_sel_hi:[1,0]
v_pk_fma_f32 v[126:127], v[124:125], v[150:151], v[126:127] op_sel:[0,1,0]
v_mul_f32 v151, 0x3c880000, v3
v_cos_f32 v150, v151
v_sin_f32 v151, v151
v_pk_mul_f32 v[124:125], v[140:141], v[148:149] op_sel_hi:[1,0]
v_pk_fma_f32 v[124:125], v[142:143], v[148:149], v[124:125] op_sel:[0,1,0] neg_lo:[1,0,0] neg_hi:[1,0,0]
v_pk_mul_f32 v[142:143], v[142:143], v[148:149] op_sel_hi:[1,0]
v_pk_fma_f32 v[142:143], v[140:141], v[148:149], v[142:143] op_sel:[0,1,0]
v_mul_f32 v149, 0x3c900000, v3
v_cos_f32 v148, v149
v_sin_f32 v149, v149
v_pk_mul_f32 v[140:141], v[48:49], v[150:151] op_sel_hi:[1,0]
v_pk_fma_f32 v[140:141], v[50:51], v[150:151], v[140:141] op_sel:[0,1,0] neg_lo:[1,0,0] neg_hi:[1,0,0]
v_pk_mul_f32 v[50:51], v[50:51], v[150:151] op_sel_hi:[1,0]
v_pk_fma_f32 v[50:51], v[48:49], v[150:151], v[50:51] op_sel:[0,1,0]
v_mul_f32 v151, 0x3c980000, v3
v_cos_f32 v150, v151
v_sin_f32 v151, v151
v_pk_mul_f32 v[48:49], v[32:33], v[148:149] op_sel_hi:[1,0]
v_pk_fma_f32 v[48:49], v[34:35], v[148:149], v[48:49] op_sel:[0,1,0] neg_lo:[1,0,0] neg_hi:[1,0,0]
v_pk_mul_f32 v[34:35], v[34:35], v[148:149] op_sel_hi:[1,0]
v_pk_fma_f32 v[34:35], v[32:33], v[148:149], v[34:35] op_sel:[0,1,0]
v_mul_f32 v149, 0x3ca00000, v3
v_cos_f32 v148, v149
v_sin_f32 v149, v149
v_pk_mul_f32 v[32:33], v[96:97], v[150:151] op_sel_hi:[1,0]
v_pk_fma_f32 v[32:33], v[98:99], v[150:151], v[32:33] op_sel:[0,1,0] neg_lo:[1,0,0] neg_hi:[1,0,0]
v_pk_mul_f32 v[98:99], v[98:99], v[150:151] op_sel_hi:[1,0]
v_pk_fma_f32 v[98:99], v[96:97], v[150:151], v[98:99] op_sel:[0,1,0]
v_mul_f32 v151, 0x3ca80000, v3
v_cos_f32 v150, v151
v_sin_f32 v151, v151
v_pk_mul_f32 v[96:97], v[24:25], v[148:149] op_sel_hi:[1,0]
v_pk_fma_f32 v[96:97], v[26:27], v[148:149], v[96:97] op_sel:[0,1,0] neg_lo:[1,0,0] neg_hi:[1,0,0]
v_pk_mul_f32 v[26:27], v[26:27], v[148:149] op_sel_hi:[1,0]
v_pk_fma_f32 v[26:27], v[24:25], v[148:149], v[26:27] op_sel:[0,1,0]
v_mul_f32 v149, 0x3cb00000, v3
v_cos_f32 v148, v149
v_sin_f32 v149, v149
v_pk_mul_f32 v[24:25], v[88:89], v[150:151] op_sel_hi:[1,0]
v_pk_fma_f32 v[24:25], v[90:91], v[150:151], v[24:25] op_sel:[0,1,0] neg_lo:[1,0,0] neg_hi:[1,0,0]
v_pk_mul_f32 v[90:91], v[90:91], v[150:151] op_sel_hi:[1,0]
v_pk_fma_f32 v[90:91], v[88:89], v[150:151], v[90:91] op_sel:[0,1,0]
v_mul_f32 v151, 0x3cb80000, v3
v_cos_f32 v150, v151
v_sin_f32 v151, v151
v_pk_mul_f32 v[88:89], v[56:57], v[148:149] op_sel_hi:[1,0]
v_pk_fma_f32 v[88:89], v[58:59], v[148:149], v[88:89] op_sel:[0,1,0] neg_lo:[1,0,0] neg_hi:[1,0,0]
v_pk_mul_f32 v[58:59], v[58:59], v[148:149] op_sel_hi:[1,0]
v_pk_fma_f32 v[58:59], v[56:57], v[148:149], v[58:59] op_sel:[0,1,0]
v_mul_f32 v149, 0x3cc00000, v3
v_cos_f32 v148, v149
v_sin_f32 v149, v149
v_pk_mul_f32 v[56:57], v[120:121], v[150:151] op_sel_hi:[1,0]
v_pk_fma_f32 v[56:57], v[122:123], v[150:151], v[56:57] op_sel:[0,1,0] neg_lo:[1,0,0] neg_hi:[1,0,0]
v_pk_mul_f32 v[122:123], v[122:123], v[150:151] op_sel_hi:[1,0]
v_pk_fma_f32 v[122:123], v[120:121], v[150:151], v[122:123] op_sel:[0,1,0]
v_mul_f32 v151, 0x3cc80000, v3
v_cos_f32 v150, v151
v_sin_f32 v151, v151
v_pk_mul_f32 v[120:121], v[20:21], v[148:149] op_sel_hi:[1,0]
v_pk_fma_f32 v[120:121], v[22:23], v[148:149], v[120:121] op_sel:[0,1,0] neg_lo:[1,0,0] neg_hi:[1,0,0]
v_pk_mul_f32 v[22:23], v[22:23], v[148:149] op_sel_hi:[1,0]
v_pk_fma_f32 v[22:23], v[20:21], v[148:149], v[22:23] op_sel:[0,1,0]
v_mul_f32 v149, 0x3cd00000, v3
v_cos_f32 v148, v149
v_sin_f32 v149, v149
v_pk_mul_f32 v[20:21], v[84:85], v[150:151] op_sel_hi:[1,0]
v_pk_fma_f32 v[20:21], v[86:87], v[150:151], v[20:21] op_sel:[0,1,0] neg_lo:[1,0,0] neg_hi:[1,0,0]
v_pk_mul_f32 v[86:87], v[86:87], v[150:151] op_sel_hi:[1,0]
v_pk_fma_f32 v[86:87], v[84:85], v[150:151], v[86:87] op_sel:[0,1,0]
v_mul_f32 v151, 0x3cd80000, v3
v_cos_f32 v150, v151
v_sin_f32 v151, v151
v_pk_mul_f32 v[84:85], v[52:53], v[148:149] op_sel_hi:[1,0]
v_pk_fma_f32 v[84:85], v[54:55], v[148:149], v[84:85] op_sel:[0,1,0] neg_lo:[1,0,0] neg_hi:[1,0,0]
v_pk_mul_f32 v[54:55], v[54:55], v[148:149] op_sel_hi:[1,0]
v_pk_fma_f32 v[54:55], v[52:53], v[148:149], v[54:55] op_sel:[0,1,0]
v_mul_f32 v149, 0x3ce00000, v3
v_cos_f32 v148, v149
v_sin_f32 v149, v149
v_pk_mul_f32 v[52:53], v[116:117], v[150:151] op_sel_hi:[1,0]
v_pk_fma_f32 v[52:53], v[118:119], v[150:151], v[52:53] op_sel:[0,1,0] neg_lo:[1,0,0] neg_hi:[1,0,0]
v_pk_mul_f32 v[118:119], v[118:119], v[150:151] op_sel_hi:[1,0]
v_pk_fma_f32 v[118:119], v[116:117], v[150:151], v[118:119] op_sel:[0,1,0]
v_mul_f32 v151, 0x3ce80000, v3
v_cos_f32 v150, v151
v_sin_f32 v151, v151
v_pk_mul_f32 v[116:117], v[36:37], v[148:149] op_sel_hi:[1,0]
v_pk_fma_f32 v[116:117], v[38:39], v[148:149], v[116:117] op_sel:[0,1,0] neg_lo:[1,0,0] neg_hi:[1,0,0]
v_pk_mul_f32 v[38:39], v[38:39], v[148:149] op_sel_hi:[1,0]
v_pk_fma_f32 v[38:39], v[36:37], v[148:149], v[38:39] op_sel:[0,1,0]
v_mul_f32 v149, 0x3cf00000, v3
v_cos_f32 v148, v149
v_sin_f32 v149, v149
v_pk_mul_f32 v[36:37], v[100:101], v[150:151] op_sel_hi:[1,0]
v_pk_fma_f32 v[36:37], v[102:103], v[150:151], v[36:37] op_sel:[0,1,0] neg_lo:[1,0,0] neg_hi:[1,0,0]
v_pk_mul_f32 v[102:103], v[102:103], v[150:151] op_sel_hi:[1,0]
v_pk_fma_f32 v[102:103], v[100:101], v[150:151], v[102:103] op_sel:[0,1,0]
v_mul_f32 v151, 0x3cf80000, v3
v_cos_f32 v150, v151
v_sin_f32 v151, v151
v_pk_mul_f32 v[100:101], v[68:69], v[148:149] op_sel_hi:[1,0]
v_pk_fma_f32 v[100:101], v[70:71], v[148:149], v[100:101] op_sel:[0,1,0] neg_lo:[1,0,0] neg_hi:[1,0,0]
v_pk_mul_f32 v[70:71], v[70:71], v[148:149] op_sel_hi:[1,0]
v_pk_fma_f32 v[70:71], v[68:69], v[148:149], v[70:71] op_sel:[0,1,0]
s_nop 0
v_pk_mul_f32 v[68:69], v[132:133], v[150:151] op_sel_hi:[1,0]
v_pk_fma_f32 v[68:69], v[134:135], v[150:151], v[68:69] op_sel:[0,1,0] neg_lo:[1,0,0] neg_hi:[1,0,0]
v_pk_mul_f32 v[134:135], v[134:135], v[150:151] op_sel_hi:[1,0]
v_pk_fma_f32 v[134:135], v[132:133], v[150:151], v[134:135] op_sel:[0,1,0]
ds_write_b64 v4, v[16:17]
ds_write_b64 v4, v[18:19] offset:8
ds_write_b64 v4, v[80:81] offset:528
ds_write_b64 v4, v[146:147] offset:536
ds_write_b64 v4, v[144:145] offset:1056
ds_write_b64 v4, v[114:115] offset:1064
ds_write_b64 v4, v[112:113] offset:1584
ds_write_b64 v4, v[66:67] offset:1592
ds_write_b64 v4, v[64:65] offset:2112
ds_write_b64 v4, v[130:131] offset:2120
ds_write_b64 v4, v[128:129] offset:2640
ds_write_b64 v4, v[74:75] offset:2648
ds_write_b64 v4, v[72:73] offset:3168
ds_write_b64 v4, v[42:43] offset:3176
ds_write_b64 v4, v[40:41] offset:3696
ds_write_b64 v4, v[106:107] offset:3704
ds_write_b64 v4, v[104:105] offset:4224
ds_write_b64 v4, v[138:139] offset:4232
ds_write_b64 v4, v[136:137] offset:4752
ds_write_b64 v4, v[78:79] offset:4760
ds_write_b64 v4, v[76:77] offset:5280
ds_write_b64 v4, v[46:47] offset:5288
ds_write_b64 v4, v[44:45] offset:5808
ds_write_b64 v4, v[110:111] offset:5816
ds_write_b64 v4, v[108:109] offset:6336
ds_write_b64 v4, v[30:31] offset:6344
ds_write_b64 v4, v[28:29] offset:6864
ds_write_b64 v4, v[94:95] offset:6872
ds_write_b64 v4, v[92:93] offset:7392
ds_write_b64 v4, v[62:63] offset:7400
ds_write_b64 v4, v[60:61] offset:7920
ds_write_b64 v4, v[126:127] offset:7928
ds_write_b64 v4, v[124:125] offset:8448
ds_write_b64 v4, v[142:143] offset:8456
ds_write_b64 v4, v[140:141] offset:8976
ds_write_b64 v4, v[50:51] offset:8984
ds_write_b64 v4, v[48:49] offset:9504
ds_write_b64 v4, v[34:35] offset:9512
ds_write_b64 v4, v[32:33] offset:10032
ds_write_b64 v4, v[98:99] offset:10040
ds_write_b64 v4, v[96:97] offset:10560
ds_write_b64 v4, v[26:27] offset:10568
ds_write_b64 v4, v[24:25] offset:11088
ds_write_b64 v4, v[90:91] offset:11096
ds_write_b64 v4, v[88:89] offset:11616
ds_write_b64 v4, v[58:59] offset:11624
ds_write_b64 v4, v[56:57] offset:12144
ds_write_b64 v4, v[122:123] offset:12152
ds_write_b64 v4, v[120:121] offset:12672
ds_write_b64 v4, v[22:23] offset:12680
ds_write_b64 v4, v[20:21] offset:13200
ds_write_b64 v4, v[86:87] offset:13208
ds_write_b64 v4, v[84:85] offset:13728
ds_write_b64 v4, v[54:55] offset:13736
ds_write_b64 v4, v[52:53] offset:14256
ds_write_b64 v4, v[118:119] offset:14264
ds_write_b64 v4, v[116:117] offset:14784
ds_write_b64 v4, v[38:39] offset:14792
ds_write_b64 v4, v[36:37] offset:15312
ds_write_b64 v4, v[102:103] offset:15320
ds_write_b64 v4, v[100:101] offset:15840
ds_write_b64 v4, v[70:71] offset:15848
ds_write_b64 v4, v[68:69] offset:16368
ds_write_b64 v4, v[134:135] offset:16376
s_waitcnt lgkmcnt(0)
ds_read_b128 v[16:19], v5
ds_read_b128 v[20:23], v5 offset:16
ds_read_b128 v[24:27], v5 offset:32
ds_read_b128 v[28:31], v5 offset:48
ds_read_b128 v[32:35], v5 offset:64
ds_read_b128 v[36:39], v5 offset:80
ds_read_b128 v[40:43], v5 offset:96
ds_read_b128 v[44:47], v5 offset:112
ds_read_b128 v[48:51], v5 offset:128
ds_read_b128 v[52:55], v5 offset:144
ds_read_b128 v[56:59], v5 offset:160
ds_read_b128 v[60:63], v5 offset:176
s_waitcnt lgkmcnt(4)
ds_read_b128 v[64:67], v5 offset:192
ds_read_b128 v[68:71], v5 offset:208
ds_read_b128 v[72:75], v5 offset:224
ds_read_b128 v[76:79], v5 offset:240
ds_read_b128 v[80:83], v5 offset:256
ds_read_b128 v[84:87], v5 offset:272
ds_read_b128 v[88:91], v5 offset:288
ds_read_b128 v[92:95], v5 offset:304
ds_read_b128 v[96:99], v5 offset:320
ds_read_b128 v[100:103], v5 offset:336
ds_read_b128 v[104:107], v5 offset:352
ds_read_b128 v[108:111], v5 offset:368
s_waitcnt lgkmcnt(4)
ds_read_b128 v[112:115], v5 offset:384
ds_read_b128 v[116:119], v5 offset:400
ds_read_b128 v[120:123], v5 offset:416
ds_read_b128 v[124:127], v5 offset:432
ds_read_b128 v[128:131], v5 offset:448
ds_read_b128 v[132:135], v5 offset:464
ds_read_b128 v[136:139], v5 offset:480
ds_read_b128 v[140:143], v5 offset:496
s_waitcnt lgkmcnt(0)
v_pk_add_f32 v[144:145], v[16:17], v[80:81] neg_lo:[0,1] neg_hi:[0,1]
v_pk_add_f32 v[146:147], v[18:19], v[82:83] neg_lo:[0,1] neg_hi:[0,1]
v_pk_add_f32 v[16:17], v[16:17], v[80:81]
v_pk_add_f32 v[18:19], v[18:19], v[82:83]
v_pk_add_f32 v[80:81], v[20:21], v[84:85] neg_lo:[0,1] neg_hi:[0,1]
v_pk_add_f32 v[82:83], v[22:23], v[86:87] neg_lo:[0,1] neg_hi:[0,1]
v_pk_add_f32 v[20:21], v[20:21], v[84:85]
v_pk_add_f32 v[22:23], v[22:23], v[86:87]
v_pk_mul_f32 v[84:85], v[80:81], s[30:31] op_sel_hi:[1,0]
v_pk_mul_f32 v[86:87], v[80:81], s[36:37] op_sel_hi:[1,0]
v_pk_fma_f32 v[84:85], v[82:83], s[36:37], v[84:85] op_sel_hi:[1,0,1] neg_lo:[0,1,0] neg_hi:[0,1,0]
v_pk_fma_f32 v[86:87], v[82:83], s[30:31], v[86:87] op_sel_hi:[1,0,1]
v_pk_add_f32 v[80:81], v[24:25], v[88:89] neg_lo:[0,1] neg_hi:[0,1]
v_pk_add_f32 v[82:83], v[26:27], v[90:91] neg_lo:[0,1] neg_hi:[0,1]
v_pk_add_f32 v[24:25], v[24:25], v[88:89]
v_pk_add_f32 v[26:27], v[26:27], v[90:91]
v_pk_mul_f32 v[88:89], v[80:81], s[30:31] op_sel:[0,1]
v_pk_mul_f32 v[90:91], v[80:81], s[34:35] op_sel:[0,1]
v_pk_fma_f32 v[88:89], v[82:83], s[34:35], v[88:89] op_sel:[0,1,0] neg_lo:[0,1,0] neg_hi:[0,1,0]
v_pk_fma_f32 v[90:91], v[82:83], s[30:31], v[90:91] op_sel:[0,1,0]
v_pk_add_f32 v[80:81], v[28:29], v[92:93] neg_lo:[0,1] neg_hi:[0,1]
v_pk_add_f32 v[82:83], v[30:31], v[94:95] neg_lo:[0,1] neg_hi:[0,1]
v_pk_add_f32 v[28:29], v[28:29], v[92:93]
v_pk_add_f32 v[30:31], v[30:31], v[94:95]
v_pk_mul_f32 v[92:93], v[80:81], s[32:33] op_sel_hi:[1,0]
v_pk_mul_f32 v[94:95], v[80:81], s[34:35] op_sel_hi:[1,0]
v_pk_fma_f32 v[92:93], v[82:83], s[34:35], v[92:93] op_sel_hi:[1,0,1] neg_lo:[0,1,0] neg_hi:[0,1,0]
v_pk_fma_f32 v[94:95], v[82:83], s[32:33], v[94:95] op_sel_hi:[1,0,1]
v_pk_add_f32 v[80:81], v[32:33], v[96:97] neg_lo:[0,1] neg_hi:[0,1]
v_pk_add_f32 v[82:83], v[34:35], v[98:99] neg_lo:[0,1] neg_hi:[0,1]
v_pk_add_f32 v[32:33], v[32:33], v[96:97]
v_pk_add_f32 v[34:35], v[34:35], v[98:99]
v_pk_mul_f32 v[96:97], v[80:81], s[32:33] op_sel:[0,1]
v_pk_mul_f32 v[98:99], v[80:81], s[32:33] op_sel:[0,1]
v_pk_fma_f32 v[96:97], v[82:83], s[32:33], v[96:97] op_sel:[0,1,0] neg_lo:[0,1,0] neg_hi:[0,1,0]
v_pk_fma_f32 v[98:99], v[82:83], s[32:33], v[98:99] op_sel:[0,1,0]
v_pk_add_f32 v[80:81], v[36:37], v[100:101] neg_lo:[0,1] neg_hi:[0,1]
v_pk_add_f32 v[82:83], v[38:39], v[102:103] neg_lo:[0,1] neg_hi:[0,1]
v_pk_add_f32 v[36:37], v[36:37], v[100:101]
v_pk_add_f32 v[38:39], v[38:39], v[102:103]
v_pk_mul_f32 v[100:101], v[80:81], s[34:35] op_sel_hi:[1,0]
v_pk_mul_f32 v[102:103], v[80:81], s[32:33] op_sel_hi:[1,0]
v_pk_fma_f32 v[100:101], v[82:83], s[32:33], v[100:101] op_sel_hi:[1,0,1] neg_lo:[0,1,0] neg_hi:[0,1,0]
v_pk_fma_f32 v[102:103], v[82:83], s[34:35], v[102:103] op_sel_hi:[1,0,1]
v_pk_add_f32 v[80:81], v[40:41], v[104:105] neg_lo:[0,1] neg_hi:[0,1]
v_pk_add_f32 v[82:83], v[42:43], v[106:107] neg_lo:[0,1] neg_hi:[0,1]
v_pk_add_f32 v[40:41], v[40:41], v[104:105]
v_pk_add_f32 v[42:43], v[42:43], v[106:107]
v_pk_mul_f32 v[104:105], v[80:81], s[34:35] op_sel:[0,1]
v_pk_mul_f32 v[106:107], v[80:81], s[30:31] op_sel:[0,1]
v_pk_fma_f32 v[104:105], v[82:83], s[30:31], v[104:105] op_sel:[0,1,0] neg_lo:[0,1,0] neg_hi:[0,1,0]
v_pk_fma_f32 v[106:107], v[82:83], s[34:35], v[106:107] op_sel:[0,1,0]
v_pk_add_f32 v[80:81], v[44:45], v[108:109] neg_lo:[0,1] neg_hi:[0,1]
v_pk_add_f32 v[82:83], v[46:47], v[110:111] neg_lo:[0,1] neg_hi:[0,1]
v_pk_add_f32 v[44:45], v[44:45], v[108:109]
v_pk_add_f32 v[46:47], v[46:47], v[110:111]
v_pk_mul_f32 v[108:109], v[80:81], s[36:37] op_sel_hi:[1,0]
v_pk_mul_f32 v[110:111], v[80:81], s[30:31] op_sel_hi:[1,0]
v_pk_fma_f32 v[108:109], v[82:83], s[30:31], v[108:109] op_sel_hi:[1,0,1] neg_lo:[0,1,0] neg_hi:[0,1,0]
v_pk_fma_f32 v[110:111], v[82:83], s[36:37], v[110:111] op_sel_hi:[1,0,1]
v_pk_add_f32 v[80:81], v[114:115], v[50:51] neg_lo:[0,1] neg_hi:[0,1]
v_pk_add_f32 v[82:83], v[48:49], v[112:113] neg_lo:[0,1] neg_hi:[0,1]
v_pk_add_f32 v[48:49], v[48:49], v[112:113]
v_pk_add_f32 v[50:51], v[50:51], v[114:115]
v_pk_add_f32 v[112:113], v[52:53], v[116:117] neg_lo:[0,1] neg_hi:[0,1]
v_pk_add_f32 v[114:115], v[54:55], v[118:119] neg_lo:[0,1] neg_hi:[0,1]
v_pk_add_f32 v[52:53], v[52:53], v[116:117]
v_pk_add_f32 v[54:55], v[54:55], v[118:119]
v_pk_mul_f32 v[116:117], v[112:113], s[36:37] op_sel_hi:[1,0] neg_lo:[0,1] neg_hi:[0,1]
v_pk_mul_f32 v[118:119], v[112:113], s[30:31] op_sel_hi:[1,0]
v_pk_fma_f32 v[116:117], v[114:115], s[30:31], v[116:117] op_sel_hi:[1,0,1] neg_lo:[0,1,0] neg_hi:[0,1,0]
v_pk_fma_f32 v[118:119], v[114:115], s[36:37], v[118:119] op_sel_hi:[1,0,1] neg_lo:[0,1,0] neg_hi:[0,1,0]
v_pk_add_f32 v[112:113], v[56:57], v[120:121] neg_lo:[0,1] neg_hi:[0,1]
v_pk_add_f32 v[114:115], v[58:59], v[122:123] neg_lo:[0,1] neg_hi:[0,1]
v_pk_add_f32 v[56:57], v[56:57], v[120:121]
v_pk_add_f32 v[58:59], v[58:59], v[122:123]
v_pk_mul_f32 v[120:121], v[112:113], s[34:35] op_sel:[0,1] neg_lo:[0,1] neg_hi:[0,1]
v_pk_mul_f32 v[122:123], v[112:113], s[30:31] op_sel:[0,1]
v_pk_fma_f32 v[120:121], v[114:115], s[30:31], v[120:121] op_sel:[0,1,0] neg_lo:[0,1,0] neg_hi:[0,1,0]
v_pk_fma_f32 v[122:123], v[114:115], s[34:35], v[122:123] op_sel:[0,1,0] neg_lo:[0,1,0] neg_hi:[0,1,0]
v_pk_add_f32 v[112:113], v[60:61], v[124:125] neg_lo:[0,1] neg_hi:[0,1]
v_pk_add_f32 v[114:115], v[62:63], v[126:127] neg_lo:[0,1] neg_hi:[0,1]
v_pk_add_f32 v[60:61], v[60:61], v[124:125]
v_pk_add_f32 v[62:63], v[62:63], v[126:127]
v_pk_mul_f32 v[124:125], v[112:113], s[34:35] op_sel_hi:[1,0] neg_lo:[0,1] neg_hi:[0,1]
v_pk_mul_f32 v[126:127], v[112:113], s[32:33] op_sel_hi:[1,0]
v_pk_fma_f32 v[124:125], v[114:115], s[32:33], v[124:125] op_sel_hi:[1,0,1] neg_lo:[0,1,0] neg_hi:[0,1,0]
v_pk_fma_f32 v[126:127], v[114:115], s[34:35], v[126:127] op_sel_hi:[1,0,1] neg_lo:[0,1,0] neg_hi:[0,1,0]
v_pk_add_f32 v[112:113], v[64:65], v[128:129] neg_lo:[0,1] neg_hi:[0,1]
v_pk_add_f32 v[114:115], v[66:67], v[130:131] neg_lo:[0,1] neg_hi:[0,1]
v_pk_add_f32 v[64:65], v[64:65], v[128:129]
v_pk_add_f32 v[66:67], v[66:67], v[130:131]
v_pk_mul_f32 v[128:129], v[112:113], s[32:33] op_sel:[0,1] neg_lo:[0,1] neg_hi:[0,1]
v_pk_mul_f32 v[130:131], v[112:113], s[32:33] op_sel:[0,1]
v_pk_fma_f32 v[128:129], v[114:115], s[32:33], v[128:129] op_sel:[0,1,0] neg_lo:[0,1,0] neg_hi:[0,1,0]
v_pk_fma_f32 v[130:131], v[114:115], s[32:33], v[130:131] op_sel:[0,1,0] neg_lo:[0,1,0] neg_hi:[0,1,0]
v_pk_add_f32 v[112:113], v[68:69], v[132:133] neg_lo:[0,1] neg_hi:[0,1]
v_pk_add_f32 v[114:115], v[70:71], v[134:135] neg_lo:[0,1] neg_hi:[0,1]
v_pk_add_f32 v[68:69], v[68:69], v[132:133]
v_pk_add_f32 v[70:71], v[70:71], v[134:135]
v_pk_mul_f32 v[132:133], v[112:113], s[32:33] op_sel_hi:[1,0] neg_lo:[0,1] neg_hi:[0,1]
v_pk_mul_f32 v[134:135], v[112:113], s[34:35] op_sel_hi:[1,0]
v_pk_fma_f32 v[132:133], v[114:115], s[34:35], v[132:133] op_sel_hi:[1,0,1] neg_lo:[0,1,0] neg_hi:[0,1,0]
v_pk_fma_f32 v[134:135], v[114:115], s[32:33], v[134:135] op_sel_hi:[1,0,1] neg_lo:[0,1,0] neg_hi:[0,1,0]
v_pk_add_f32 v[112:113], v[72:73], v[136:137] neg_lo:[0,1] neg_hi:[0,1]
v_pk_add_f32 v[114:115], v[74:75], v[138:139] neg_lo:[0,1] neg_hi:[0,1]
v_pk_add_f32 v[72:73], v[72:73], v[136:137]
v_pk_add_f32 v[74:75], v[74:75], v[138:139]
v_pk_mul_f32 v[136:137], v[112:113], s[30:31] op_sel:[0,1] neg_lo:[0,1] neg_hi:[0,1]
v_pk_mul_f32 v[138:139], v[112:113], s[34:35] op_sel:[0,1]
v_pk_fma_f32 v[136:137], v[114:115], s[34:35], v[136:137] op_sel:[0,1,0] neg_lo:[0,1,0] neg_hi:[0,1,0]
v_pk_fma_f32 v[138:139], v[114:115], s[30:31], v[138:139] op_sel:[0,1,0] neg_lo:[0,1,0] neg_hi:[0,1,0]
v_pk_add_f32 v[112:113], v[76:77], v[140:141] neg_lo:[0,1] neg_hi:[0,1]
v_pk_add_f32 v[114:115], v[78:79], v[142:143] neg_lo:[0,1] neg_hi:[0,1]
v_pk_add_f32 v[76:77], v[76:77], v[140:141]
v_pk_add_f32 v[78:79], v[78:79], v[142:143]
v_pk_mul_f32 v[140:141], v[112:113], s[30:31] op_sel_hi:[1,0] neg_lo:[0,1] neg_hi:[0,1]
v_pk_mul_f32 v[142:143], v[112:113], s[36:37] op_sel_hi:[1,0]
v_pk_fma_f32 v[140:141], v[114:115], s[36:37], v[140:141] op_sel_hi:[1,0,1] neg_lo:[0,1,0] neg_hi:[0,1,0]
v_pk_fma_f32 v[142:143], v[114:115], s[30:31], v[142:143] op_sel_hi:[1,0,1] neg_lo:[0,1,0] neg_hi:[0,1,0]
v_pk_add_f32 v[112:113], v[16:17], v[48:49] neg_lo:[0,1] neg_hi:[0,1]
v_pk_add_f32 v[114:115], v[18:19], v[50:51] neg_lo:[0,1] neg_hi:[0,1]
v_pk_add_f32 v[16:17], v[16:17], v[48:49]
v_pk_add_f32 v[18:19], v[18:19], v[50:51]
v_pk_add_f32 v[48:49], v[20:21], v[52:53] neg_lo:[0,1] neg_hi:[0,1]
v_pk_add_f32 v[50:51], v[22:23], v[54:55] neg_lo:[0,1] neg_hi:[0,1]
v_pk_add_f32 v[20:21], v[20:21], v[52:53]
v_pk_add_f32 v[22:23], v[22:23], v[54:55]
v_pk_mul_f32 v[52:53], v[48:49], s[30:31] op_sel:[0,1]
v_pk_mul_f32 v[54:55], v[48:49], s[34:35] op_sel:[0,1]
v_pk_fma_f32 v[52:53], v[50:51], s[34:35], v[52:53] op_sel:[0,1,0] neg_lo:[0,1,0] neg_hi:[0,1,0]
v_pk_fma_f32 v[54:55], v[50:51], s[30:31], v[54:55] op_sel:[0,1,0]
v_pk_add_f32 v[48:49], v[24:25], v[56:57] neg_lo:[0,1] neg_hi:[0,1]
v_pk_add_f32 v[50:51], v[26:27], v[58:59] neg_lo:[0,1] neg_hi:[0,1]
v_pk_add_f32 v[24:25], v[24:25], v[56:57]
v_pk_add_f32 v[26:27], v[26:27], v[58:59]
v_pk_mul_f32 v[56:57], v[48:49], s[32:33] op_sel:[0,1]
v_pk_mul_f32 v[58:59], v[48:49], s[32:33] op_sel:[0,1]
v_pk_fma_f32 v[56:57], v[50:51], s[32:33], v[56:57] op_sel:[0,1,0] neg_lo:[0,1,0] neg_hi:[0,1,0]
v_pk_fma_f32 v[58:59], v[50:51], s[32:33], v[58:59] op_sel:[0,1,0]
v_pk_add_f32 v[48:49], v[28:29], v[60:61] neg_lo:[0,1] neg_hi:[0,1]
v_pk_add_f32 v[50:51], v[30:31], v[62:63] neg_lo:[0,1] neg_hi:[0,1]
v_pk_add_f32 v[28:29], v[28:29], v[60:61]
v_pk_add_f32 v[30:31], v[30:31], v[62:63]
v_pk_mul_f32 v[60:61], v[48:49], s[34:35] op_sel:[0,1]
v_pk_mul_f32 v[62:63], v[48:49], s[30:31] op_sel:[0,1]
v_pk_fma_f32 v[60:61], v[50:51], s[30:31], v[60:61] op_sel:[0,1,0] neg_lo:[0,1,0] neg_hi:[0,1,0]
v_pk_fma_f32 v[62:63], v[50:51], s[34:35], v[62:63] op_sel:[0,1,0]
v_pk_add_f32 v[48:49], v[66:67], v[34:35] neg_lo:[0,1] neg_hi:[0,1]
v_pk_add_f32 v[50:51], v[32:33], v[64:65] neg_lo:[0,1] neg_hi:[0,1]
v_pk_add_f32 v[32:33], v[32:33], v[64:65]
v_pk_add_f32 v[34:35], v[34:35], v[66:67]
v_pk_add_f32 v[64:65], v[36:37], v[68:69] neg_lo:[0,1] neg_hi:[0,1]
v_pk_add_f32 v[66:67], v[38:39], v[70:71] neg_lo:[0,1] neg_hi:[0,1]
v_pk_add_f32 v[36:37], v[36:37], v[68:69]
v_pk_add_f32 v[38:39], v[38:39], v[70:71]
v_pk_mul_f32 v[68:69], v[64:65], s[34:35] op_sel:[0,1] neg_lo:[0,1] neg_hi:[0,1]
v_pk_mul_f32 v[70:71], v[64:65], s[30:31] op_sel:[0,1]
v_pk_fma_f32 v[68:69], v[66:67], s[30:31], v[68:69] op_sel:[0,1,0] neg_lo:[0,1,0] neg_hi:[0,1,0]
v_pk_fma_f32 v[70:71], v[66:67], s[34:35], v[70:71] op_sel:[0,1,0] neg_lo:[0,1,0] neg_hi:[0,1,0]
v_pk_add_f32 v[64:65], v[40:41], v[72:73] neg_lo:[0,1] neg_hi:[0,1]
v_pk_add_f32 v[66:67], v[42:43], v[74:75] neg_lo:[0,1] neg_hi:[0,1]
v_pk_add_f32 v[40:41], v[40:41], v[72:73]
v_pk_add_f32 v[42:43], v[42:43], v[74:75]
v_pk_mul_f32 v[72:73], v[64:65], s[32:33] op_sel:[0,1] neg_lo:[0,1] neg_hi:[0,1]
v_pk_mul_f32 v[74:75], v[64:65], s[32:33] op_sel:[0,1]
v_pk_fma_f32 v[72:73], v[66:67], s[32:33], v[72:73] op_sel:[0,1,0] neg_lo:[0,1,0] neg_hi:[0,1,0]
v_pk_fma_f32 v[74:75], v[66:67], s[32:33], v[74:75] op_sel:[0,1,0] neg_lo:[0,1,0] neg_hi:[0,1,0]
v_pk_add_f32 v[64:65], v[44:45], v[76:77] neg_lo:[0,1] neg_hi:[0,1]
v_pk_add_f32 v[66:67], v[46:47], v[78:79] neg_lo:[0,1] neg_hi:[0,1]
v_pk_add_f32 v[44:45], v[44:45], v[76:77]
v_pk_add_f32 v[46:47], v[46:47], v[78:79]
v_pk_mul_f32 v[76:77], v[64:65], s[30:31] op_sel:[0,1] neg_lo:[0,1] neg_hi:[0,1]
v_pk_mul_f32 v[78:79], v[64:65], s[34:35] op_sel:[0,1]
v_pk_fma_f32 v[76:77], v[66:67], s[34:35], v[76:77] op_sel:[0,1,0] neg_lo:[0,1,0] neg_hi:[0,1,0]
v_pk_fma_f32 v[78:79], v[66:67], s[30:31], v[78:79] op_sel:[0,1,0] neg_lo:[0,1,0] neg_hi:[0,1,0]
v_pk_add_f32 v[64:65], v[144:145], v[80:81] neg_lo:[0,1] neg_hi:[0,1]
v_pk_add_f32 v[66:67], v[146:147], v[82:83] neg_lo:[0,1] neg_hi:[0,1]
v_pk_add_f32 v[144:145], v[144:145], v[80:81]
v_pk_add_f32 v[146:147], v[146:147], v[82:83]
v_pk_add_f32 v[80:81], v[84:85], v[116:117] neg_lo:[0,1] neg_hi:[0,1]
v_pk_add_f32 v[82:83], v[86:87], v[118:119] neg_lo:[0,1] neg_hi:[0,1]
v_pk_add_f32 v[84:85], v[84:85], v[116:117]
v_pk_add_f32 v[86:87], v[86:87], v[118:119]
v_pk_mul_f32 v[116:117], v[80:81], s[30:31] op_sel:[0,1]
v_pk_mul_f32 v[118:119], v[80:81], s[34:35] op_sel:[0,1]
v_pk_fma_f32 v[116:117], v[82:83], s[34:35], v[116:117] op_sel:[0,1,0] neg_lo:[0,1,0] neg_hi:[0,1,0]
v_pk_fma_f32 v[118:119], v[82:83], s[30:31], v[118:119] op_sel:[0,1,0]
v_pk_add_f32 v[80:81], v[88:89], v[120:121] neg_lo:[0,1] neg_hi:[0,1]
v_pk_add_f32 v[82:83], v[90:91], v[122:123] neg_lo:[0,1] neg_hi:[0,1]
v_pk_add_f32 v[88:89], v[88:89], v[120:121]
v_pk_add_f32 v[90:91], v[90:91], v[122:123]
v_pk_mul_f32 v[120:121], v[80:81], s[32:33] op_sel:[0,1]
v_pk_mul_f32 v[122:123], v[80:81], s[32:33] op_sel:[0,1]
v_pk_fma_f32 v[120:121], v[82:83], s[32:33], v[120:121] op_sel:[0,1,0] neg_lo:[0,1,0] neg_hi:[0,1,0]
v_pk_fma_f32 v[122:123], v[82:83], s[32:33], v[122:123] op_sel:[0,1,0]
v_pk_add_f32 v[80:81], v[92:93], v[124:125] neg_lo:[0,1] neg_hi:[0,1]
v_pk_add_f32 v[82:83], v[94:95], v[126:127] neg_lo:[0,1] neg_hi:[0,1]
v_pk_add_f32 v[92:93], v[92:93], v[124:125]
v_pk_add_f32 v[94:95], v[94:95], v[126:127]
v_pk_mul_f32 v[124:125], v[80:81], s[34:35] op_sel:[0,1]
v_pk_mul_f32 v[126:127], v[80:81], s[30:31] op_sel:[0,1]
v_pk_fma_f32 v[124:125], v[82:83], s[30:31], v[124:125] op_sel:[0,1,0] neg_lo:[0,1,0] neg_hi:[0,1,0]
v_pk_fma_f32 v[126:127], v[82:83], s[34:35], v[126:127] op_sel:[0,1,0]
v_pk_add_f32 v[80:81], v[130:131], v[98:99] neg_lo:[0,1] neg_hi:[0,1]
v_pk_add_f32 v[82:83], v[96:97], v[128:129] neg_lo:[0,1] neg_hi:[0,1]
v_pk_add_f32 v[96:97], v[96:97], v[128:129]
v_pk_add_f32 v[98:99], v[98:99], v[130:131]
v_pk_add_f32 v[128:129], v[100:101], v[132:133] neg_lo:[0,1] neg_hi:[0,1]
v_pk_add_f32 v[130:131], v[102:103], v[134:135] neg_lo:[0,1] neg_hi:[0,1]
v_pk_add_f32 v[100:101], v[100:101], v[132:133]
v_pk_add_f32 v[102:103], v[102:103], v[134:135]
v_pk_mul_f32 v[132:133], v[128:129], s[34:35] op_sel:[0,1] neg_lo:[0,1] neg_hi:[0,1]
v_pk_mul_f32 v[134:135], v[128:129], s[30:31] op_sel:[0,1]
v_pk_fma_f32 v[132:133], v[130:131], s[30:31], v[132:133] op_sel:[0,1,0] neg_lo:[0,1,0] neg_hi:[0,1,0]
v_pk_fma_f32 v[134:135], v[130:131], s[34:35], v[134:135] op_sel:[0,1,0] neg_lo:[0,1,0] neg_hi:[0,1,0]
v_pk_add_f32 v[128:129], v[104:105], v[136:137] neg_lo:[0,1] neg_hi:[0,1]
v_pk_add_f32 v[130:131], v[106:107], v[138:139] neg_lo:[0,1] neg_hi:[0,1]
v_pk_add_f32 v[104:105], v[104:105], v[136:137]
v_pk_add_f32 v[106:107], v[106:107], v[138:139]
v_pk_mul_f32 v[136:137], v[128:129], s[32:33] op_sel:[0,1] neg_lo:[0,1] neg_hi:[0,1]
v_pk_mul_f32 v[138:139], v[128:129], s[32:33] op_sel:[0,1]
v_pk_fma_f32 v[136:137], v[130:131], s[32:33], v[136:137] op_sel:[0,1,0] neg_lo:[0,1,0] neg_hi:[0,1,0]
v_pk_fma_f32 v[138:139], v[130:131], s[32:33], v[138:139] op_sel:[0,1,0] neg_lo:[0,1,0] neg_hi:[0,1,0]
v_pk_add_f32 v[128:129], v[108:109], v[140:141] neg_lo:[0,1] neg_hi:[0,1]
v_pk_add_f32 v[130:131], v[110:111], v[142:143] neg_lo:[0,1] neg_hi:[0,1]
v_pk_add_f32 v[108:109], v[108:109], v[140:141]
v_pk_add_f32 v[110:111], v[110:111], v[142:143]
v_pk_mul_f32 v[140:141], v[128:129], s[30:31] op_sel:[0,1] neg_lo:[0,1] neg_hi:[0,1]
v_pk_mul_f32 v[142:143], v[128:129], s[34:35] op_sel:[0,1]
v_pk_fma_f32 v[140:141], v[130:131], s[34:35], v[140:141] op_sel:[0,1,0] neg_lo:[0,1,0] neg_hi:[0,1,0]
v_pk_fma_f32 v[142:143], v[130:131], s[30:31], v[142:143] op_sel:[0,1,0] neg_lo:[0,1,0] neg_hi:[0,1,0]
v_pk_add_f32 v[128:129], v[16:17], v[32:33] neg_lo:[0,1] neg_hi:[0,1]
v_pk_add_f32 v[130:131], v[18:19], v[34:35] neg_lo:[0,1] neg_hi:[0,1]
v_pk_add_f32 v[16:17], v[16:17], v[32:33]
v_pk_add_f32 v[18:19], v[18:19], v[34:35]
v_pk_add_f32 v[32:33], v[20:21], v[36:37] neg_lo:[0,1] neg_hi:[0,1]
v_pk_add_f32 v[34:35], v[22:23], v[38:39] neg_lo:[0,1] neg_hi:[0,1]
v_pk_add_f32 v[20:21], v[20:21], v[36:37]
v_pk_add_f32 v[22:23], v[22:23], v[38:39]
v_pk_mul_f32 v[36:37], v[32:33], s[32:33] op_sel:[0,1]
v_pk_mul_f32 v[38:39], v[32:33], s[32:33] op_sel:[0,1]
v_pk_fma_f32 v[36:37], v[34:35], s[32:33], v[36:37] op_sel:[0,1,0] neg_lo:[0,1,0] neg_hi:[0,1,0]
v_pk_fma_f32 v[38:39], v[34:35], s[32:33], v[38:39] op_sel:[0,1,0]
v_pk_add_f32 v[32:33], v[42:43], v[26:27] neg_lo:[0,1] neg_hi:[0,1]
v_pk_add_f32 v[34:35], v[24:25], v[40:41] neg_lo:[0,1] neg_hi:[0,1]
v_pk_add_f32 v[24:25], v[24:25], v[40:41]
v_pk_add_f32 v[26:27], v[26:27], v[42:43]
v_pk_add_f32 v[40:41], v[28:29], v[44:45] neg_lo:[0,1] neg_hi:[0,1]
v_pk_add_f32 v[42:43], v[30:31], v[46:47] neg_lo:[0,1] neg_hi:[0,1]
v_pk_add_f32 v[28:29], v[28:29], v[44:45]
v_pk_add_f32 v[30:31], v[30:31], v[46:47]
v_pk_mul_f32 v[44:45], v[40:41], s[32:33] op_sel:[0,1] neg_lo:[0,1] neg_hi:[0,1]
v_pk_mul_f32 v[46:47], v[40:41], s[32:33] op_sel:[0,1]
v_pk_fma_f32 v[44:45], v[42:43], s[32:33], v[44:45] op_sel:[0,1,0] neg_lo:[0,1,0] neg_hi:[0,1,0]
v_pk_fma_f32 v[46:47], v[42:43], s[32:33], v[46:47] op_sel:[0,1,0] neg_lo:[0,1,0] neg_hi:[0,1,0]
v_pk_add_f32 v[40:41], v[112:113], v[48:49] neg_lo:[0,1] neg_hi:[0,1]
v_pk_add_f32 v[42:43], v[114:115], v[50:51] neg_lo:[0,1] neg_hi:[0,1]
v_pk_add_f32 v[112:113], v[112:113], v[48:49]
v_pk_add_f32 v[114:115], v[114:115], v[50:51]
v_pk_add_f32 v[48:49], v[52:53], v[68:69] neg_lo:[0,1] neg_hi:[0,1]
v_pk_add_f32 v[50:51], v[54:55], v[70:71] neg_lo:[0,1] neg_hi:[0,1]
v_pk_add_f32 v[52:53], v[52:53], v[68:69]
v_pk_add_f32 v[54:55], v[54:55], v[70:71]
v_pk_mul_f32 v[68:69], v[48:49], s[32:33] op_sel:[0,1]
v_pk_mul_f32 v[70:71], v[48:49], s[32:33] op_sel:[0,1]
v_pk_fma_f32 v[68:69], v[50:51], s[32:33], v[68:69] op_sel:[0,1,0] neg_lo:[0,1,0] neg_hi:[0,1,0]
v_pk_fma_f32 v[70:71], v[50:51], s[32:33], v[70:71] op_sel:[0,1,0]
v_pk_add_f32 v[48:49], v[74:75], v[58:59] neg_lo:[0,1] neg_hi:[0,1]
v_pk_add_f32 v[50:51], v[56:57], v[72:73] neg_lo:[0,1] neg_hi:[0,1]
v_pk_add_f32 v[56:57], v[56:57], v[72:73]
v_pk_add_f32 v[58:59], v[58:59], v[74:75]
v_pk_add_f32 v[72:73], v[60:61], v[76:77] neg_lo:[0,1] neg_hi:[0,1]
v_pk_add_f32 v[74:75], v[62:63], v[78:79] neg_lo:[0,1] neg_hi:[0,1]
v_pk_add_f32 v[60:61], v[60:61], v[76:77]
v_pk_add_f32 v[62:63], v[62:63], v[78:79]
v_pk_mul_f32 v[76:77], v[72:73], s[32:33] op_sel:[0,1] neg_lo:[0,1] neg_hi:[0,1]
v_pk_mul_f32 v[78:79], v[72:73], s[32:33] op_sel:[0,1]
v_pk_fma_f32 v[76:77], v[74:75], s[32:33], v[76:77] op_sel:[0,1,0] neg_lo:[0,1,0] neg_hi:[0,1,0]
v_pk_fma_f32 v[78:79], v[74:75], s[32:33], v[78:79] op_sel:[0,1,0] neg_lo:[0,1,0] neg_hi:[0,1,0]
v_pk_add_f32 v[72:73], v[144:145], v[96:97] neg_lo:[0,1] neg_hi:[0,1]
v_pk_add_f32 v[74:75], v[146:147], v[98:99] neg_lo:[0,1] neg_hi:[0,1]
v_pk_add_f32 v[144:145], v[144:145], v[96:97]
v_pk_add_f32 v[146:147], v[146:147], v[98:99]
v_pk_add_f32 v[96:97], v[84:85], v[100:101] neg_lo:[0,1] neg_hi:[0,1]
v_pk_add_f32 v[98:99], v[86:87], v[102:103] neg_lo:[0,1] neg_hi:[0,1]
v_pk_add_f32 v[84:85], v[84:85], v[100:101]
v_pk_add_f32 v[86:87], v[86:87], v[102:103]
v_pk_mul_f32 v[100:101], v[96:97], s[32:33] op_sel:[0,1]
v_pk_mul_f32 v[102:103], v[96:97], s[32:33] op_sel:[0,1]
v_pk_fma_f32 v[100:101], v[98:99], s[32:33], v[100:101] op_sel:[0,1,0] neg_lo:[0,1,0] neg_hi:[0,1,0]
v_pk_fma_f32 v[102:103], v[98:99], s[32:33], v[102:103] op_sel:[0,1,0]
v_pk_add_f32 v[96:97], v[106:107], v[90:91] neg_lo:[0,1] neg_hi:[0,1]
v_pk_add_f32 v[98:99], v[88:89], v[104:105] neg_lo:[0,1] neg_hi:[0,1]
v_pk_add_f32 v[88:89], v[88:89], v[104:105]
v_pk_add_f32 v[90:91], v[90:91], v[106:107]
v_pk_add_f32 v[104:105], v[92:93], v[108:109] neg_lo:[0,1] neg_hi:[0,1]
v_pk_add_f32 v[106:107], v[94:95], v[110:111] neg_lo:[0,1] neg_hi:[0,1]
v_pk_add_f32 v[92:93], v[92:93], v[108:109]
v_pk_add_f32 v[94:95], v[94:95], v[110:111]
v_pk_mul_f32 v[108:109], v[104:105], s[32:33] op_sel:[0,1] neg_lo:[0,1] neg_hi:[0,1]
v_pk_mul_f32 v[110:111], v[104:105], s[32:33] op_sel:[0,1]
v_pk_fma_f32 v[108:109], v[106:107], s[32:33], v[108:109] op_sel:[0,1,0] neg_lo:[0,1,0] neg_hi:[0,1,0]
v_pk_fma_f32 v[110:111], v[106:107], s[32:33], v[110:111] op_sel:[0,1,0] neg_lo:[0,1,0] neg_hi:[0,1,0]
v_pk_add_f32 v[104:105], v[64:65], v[80:81] neg_lo:[0,1] neg_hi:[0,1]
v_pk_add_f32 v[106:107], v[66:67], v[82:83] neg_lo:[0,1] neg_hi:[0,1]
v_pk_add_f32 v[64:65], v[64:65], v[80:81]
v_pk_add_f32 v[66:67], v[66:67], v[82:83]
v_pk_add_f32 v[80:81], v[116:117], v[132:133] neg_lo:[0,1] neg_hi:[0,1]
v_pk_add_f32 v[82:83], v[118:119], v[134:135] neg_lo:[0,1] neg_hi:[0,1]
v_pk_add_f32 v[116:117], v[116:117], v[132:133]
v_pk_add_f32 v[118:119], v[118:119], v[134:135]
v_pk_mul_f32 v[132:133], v[80:81], s[32:33] op_sel:[0,1]
v_pk_mul_f32 v[134:135], v[80:81], s[32:33] op_sel:[0,1]
v_pk_fma_f32 v[132:133], v[82:83], s[32:33], v[132:133] op_sel:[0,1,0] neg_lo:[0,1,0] neg_hi:[0,1,0]
v_pk_fma_f32 v[134:135], v[82:83], s[32:33], v[134:135] op_sel:[0,1,0]
v_pk_add_f32 v[80:81], v[138:139], v[122:123] neg_lo:[0,1] neg_hi:[0,1]
v_pk_add_f32 v[82:83], v[120:121], v[136:137] neg_lo:[0,1] neg_hi:[0,1]
v_pk_add_f32 v[120:121], v[120:121], v[136:137]
v_pk_add_f32 v[122:123], v[122:123], v[138:139]
v_pk_add_f32 v[136:137], v[124:125], v[140:141] neg_lo:[0,1] neg_hi:[0,1]
v_pk_add_f32 v[138:139], v[126:127], v[142:143] neg_lo:[0,1] neg_hi:[0,1]
v_pk_add_f32 v[124:125], v[124:125], v[140:141]
v_pk_add_f32 v[126:127], v[126:127], v[142:143]
v_pk_mul_f32 v[140:141], v[136:137], s[32:33] op_sel:[0,1] neg_lo:[0,1] neg_hi:[0,1]
v_pk_mul_f32 v[142:143], v[136:137], s[32:33] op_sel:[0,1]
v_pk_fma_f32 v[140:141], v[138:139], s[32:33], v[140:141] op_sel:[0,1,0] neg_lo:[0,1,0] neg_hi:[0,1,0]
v_pk_fma_f32 v[142:143], v[138:139], s[32:33], v[142:143] op_sel:[0,1,0] neg_lo:[0,1,0] neg_hi:[0,1,0]
v_pk_add_f32 v[136:137], v[16:17], v[24:25] neg_lo:[0,1] neg_hi:[0,1]
v_pk_add_f32 v[138:139], v[18:19], v[26:27] neg_lo:[0,1] neg_hi:[0,1]
v_pk_add_f32 v[16:17], v[16:17], v[24:25]
v_pk_add_f32 v[18:19], v[18:19], v[26:27]
v_pk_add_f32 v[24:25], v[30:31], v[22:23] neg_lo:[0,1] neg_hi:[0,1]
v_pk_add_f32 v[26:27], v[20:21], v[28:29] neg_lo:[0,1] neg_hi:[0,1]
v_pk_add_f32 v[20:21], v[20:21], v[28:29]
v_pk_add_f32 v[22:23], v[22:23], v[30:31]
v_pk_add_f32 v[28:29], v[128:129], v[32:33] neg_lo:[0,1] neg_hi:[0,1]
v_pk_add_f32 v[30:31], v[130:131], v[34:35] neg_lo:[0,1] neg_hi:[0,1]
v_pk_add_f32 v[128:129], v[128:129], v[32:33]
v_pk_add_f32 v[130:131], v[130:131], v[34:35]
v_pk_add_f32 v[32:33], v[46:47], v[38:39] neg_lo:[0,1] neg_hi:[0,1]
v_pk_add_f32 v[34:35], v[36:37], v[44:45] neg_lo:[0,1] neg_hi:[0,1]
v_pk_add_f32 v[36:37], v[36:37], v[44:45]
v_pk_add_f32 v[38:39], v[38:39], v[46:47]
v_pk_add_f32 v[44:45], v[112:113], v[56:57] neg_lo:[0,1] neg_hi:[0,1]
v_pk_add_f32 v[46:47], v[114:115], v[58:59] neg_lo:[0,1] neg_hi:[0,1]
v_pk_add_f32 v[112:113], v[112:113], v[56:57]
v_pk_add_f32 v[114:115], v[114:115], v[58:59]
v_pk_add_f32 v[56:57], v[62:63], v[54:55] neg_lo:[0,1] neg_hi:[0,1]
v_pk_add_f32 v[58:59], v[52:53], v[60:61] neg_lo:[0,1] neg_hi:[0,1]
v_pk_add_f32 v[52:53], v[52:53], v[60:61]
v_pk_add_f32 v[54:55], v[54:55], v[62:63]
v_pk_add_f32 v[60:61], v[40:41], v[48:49] neg_lo:[0,1] neg_hi:[0,1]
v_pk_add_f32 v[62:63], v[42:43], v[50:51] neg_lo:[0,1] neg_hi:[0,1]
v_pk_add_f32 v[40:41], v[40:41], v[48:49]
v_pk_add_f32 v[42:43], v[42:43], v[50:51]
v_pk_add_f32 v[48:49], v[78:79], v[70:71] neg_lo:[0,1] neg_hi:[0,1]
v_pk_add_f32 v[50:51], v[68:69], v[76:77] neg_lo:[0,1] neg_hi:[0,1]
v_pk_add_f32 v[68:69], v[68:69], v[76:77]
v_pk_add_f32 v[70:71], v[70:71], v[78:79]
v_pk_add_f32 v[76:77], v[144:145], v[88:89] neg_lo:[0,1] neg_hi:[0,1]
v_pk_add_f32 v[78:79], v[146:147], v[90:91] neg_lo:[0,1] neg_hi:[0,1]
v_pk_add_f32 v[144:145], v[144:145], v[88:89]
v_pk_add_f32 v[146:147], v[146:147], v[90:91]
v_pk_add_f32 v[88:89], v[94:95], v[86:87] neg_lo:[0,1] neg_hi:[0,1]
v_pk_add_f32 v[90:91], v[84:85], v[92:93] neg_lo:[0,1] neg_hi:[0,1]
v_pk_add_f32 v[84:85], v[84:85], v[92:93]
v_pk_add_f32 v[86:87], v[86:87], v[94:95]
v_pk_add_f32 v[92:93], v[72:73], v[96:97] neg_lo:[0,1] neg_hi:[0,1]
v_pk_add_f32 v[94:95], v[74:75], v[98:99] neg_lo:[0,1] neg_hi:[0,1]
v_pk_add_f32 v[72:73], v[72:73], v[96:97]
v_pk_add_f32 v[74:75], v[74:75], v[98:99]
v_pk_add_f32 v[96:97], v[110:111], v[102:103] neg_lo:[0,1] neg_hi:[0,1]
v_pk_add_f32 v[98:99], v[100:101], v[108:109] neg_lo:[0,1] neg_hi:[0,1]
v_pk_add_f32 v[100:101], v[100:101], v[108:109]
v_pk_add_f32 v[102:103], v[102:103], v[110:111]
v_pk_add_f32 v[108:109], v[64:65], v[120:121] neg_lo:[0,1] neg_hi:[0,1]
v_pk_add_f32 v[110:111], v[66:67], v[122:123] neg_lo:[0,1] neg_hi:[0,1]
v_pk_add_f32 v[64:65], v[64:65], v[120:121]
v_pk_add_f32 v[66:67], v[66:67], v[122:123]
v_pk_add_f32 v[120:121], v[126:127], v[118:119] neg_lo:[0,1] neg_hi:[0,1]
v_pk_add_f32 v[122:123], v[116:117], v[124:125] neg_lo:[0,1] neg_hi:[0,1]
v_pk_add_f32 v[116:117], v[116:117], v[124:125]
v_pk_add_f32 v[118:119], v[118:119], v[126:127]
v_pk_add_f32 v[124:125], v[104:105], v[80:81] neg_lo:[0,1] neg_hi:[0,1]
v_pk_add_f32 v[126:127], v[106:107], v[82:83] neg_lo:[0,1] neg_hi:[0,1]
v_pk_add_f32 v[104:105], v[104:105], v[80:81]
v_pk_add_f32 v[106:107], v[106:107], v[82:83]
v_pk_add_f32 v[80:81], v[142:143], v[134:135] neg_lo:[0,1] neg_hi:[0,1]
v_pk_add_f32 v[82:83], v[132:133], v[140:141] neg_lo:[0,1] neg_hi:[0,1]
v_pk_add_f32 v[132:133], v[132:133], v[140:141]
v_pk_add_f32 v[134:135], v[134:135], v[142:143]
v_pk_add_f32 v[140:141], v[16:17], v[20:21] neg_lo:[0,1] neg_hi:[0,1]
v_pk_add_f32 v[142:143], v[18:19], v[22:23] neg_lo:[0,1] neg_hi:[0,1]
v_pk_add_f32 v[16:17], v[16:17], v[20:21]
v_pk_add_f32 v[18:19], v[18:19], v[22:23]
v_pk_add_f32 v[20:21], v[136:137], v[24:25] neg_lo:[0,1] neg_hi:[0,1]
v_pk_add_f32 v[22:23], v[138:139], v[26:27] neg_lo:[0,1] neg_hi:[0,1]
v_pk_add_f32 v[136:137], v[136:137], v[24:25]
v_pk_add_f32 v[138:139], v[138:139], v[26:27]
v_pk_add_f32 v[24:25], v[128:129], v[36:37] neg_lo:[0,1] neg_hi:[0,1]
v_pk_add_f32 v[26:27], v[130:131], v[38:39] neg_lo:[0,1] neg_hi:[0,1]
v_pk_add_f32 v[128:129], v[128:129], v[36:37]
v_pk_add_f32 v[130:131], v[130:131], v[38:39]
v_pk_add_f32 v[36:37], v[28:29], v[32:33] neg_lo:[0,1] neg_hi:[0,1]
v_pk_add_f32 v[38:39], v[30:31], v[34:35] neg_lo:[0,1] neg_hi:[0,1]
v_pk_add_f32 v[28:29], v[28:29], v[32:33]
v_pk_add_f32 v[30:31], v[30:31], v[34:35]
v_pk_add_f32 v[32:33], v[112:113], v[52:53] neg_lo:[0,1] neg_hi:[0,1]
v_pk_add_f32 v[34:35], v[114:115], v[54:55] neg_lo:[0,1] neg_hi:[0,1]
v_pk_add_f32 v[112:113], v[112:113], v[52:53]
v_pk_add_f32 v[114:115], v[114:115], v[54:55]
v_pk_add_f32 v[52:53], v[44:45], v[56:57] neg_lo:[0,1] neg_hi:[0,1]
v_pk_add_f32 v[54:55], v[46:47], v[58:59] neg_lo:[0,1] neg_hi:[0,1]
v_pk_add_f32 v[44:45], v[44:45], v[56:57]
v_pk_add_f32 v[46:47], v[46:47], v[58:59]
v_pk_add_f32 v[56:57], v[40:41], v[68:69] neg_lo:[0,1] neg_hi:[0,1]
v_pk_add_f32 v[58:59], v[42:43], v[70:71] neg_lo:[0,1] neg_hi:[0,1]
v_pk_add_f32 v[40:41], v[40:41], v[68:69]
v_pk_add_f32 v[42:43], v[42:43], v[70:71]
v_pk_add_f32 v[68:69], v[60:61], v[48:49] neg_lo:[0,1] neg_hi:[0,1]
v_pk_add_f32 v[70:71], v[62:63], v[50:51] neg_lo:[0,1] neg_hi:[0,1]
v_pk_add_f32 v[60:61], v[60:61], v[48:49]
v_pk_add_f32 v[62:63], v[62:63], v[50:51]
v_pk_add_f32 v[48:49], v[144:145], v[84:85] neg_lo:[0,1] neg_hi:[0,1]
v_pk_add_f32 v[50:51], v[146:147], v[86:87] neg_lo:[0,1] neg_hi:[0,1]
v_pk_add_f32 v[144:145], v[144:145], v[84:85]
v_pk_add_f32 v[146:147], v[146:147], v[86:87]
v_pk_add_f32 v[84:85], v[76:77], v[88:89] neg_lo:[0,1] neg_hi:[0,1]
v_pk_add_f32 v[86:87], v[78:79], v[90:91] neg_lo:[0,1] neg_hi:[0,1]
v_pk_add_f32 v[76:77], v[76:77], v[88:89]
v_pk_add_f32 v[78:79], v[78:79], v[90:91]
v_pk_add_f32 v[88:89], v[72:73], v[100:101] neg_lo:[0,1] neg_hi:[0,1]
v_pk_add_f32 v[90:91], v[74:75], v[102:103] neg_lo:[0,1] neg_hi:[0,1]
v_pk_add_f32 v[72:73], v[72:73], v[100:101]
v_pk_add_f32 v[74:75], v[74:75], v[102:103]
v_pk_add_f32 v[100:101], v[92:93], v[96:97] neg_lo:[0,1] neg_hi:[0,1]
v_pk_add_f32 v[102:103], v[94:95], v[98:99] neg_lo:[0,1] neg_hi:[0,1]
v_pk_add_f32 v[92:93], v[92:93], v[96:97]
v_pk_add_f32 v[94:95], v[94:95], v[98:99]
v_pk_add_f32 v[96:97], v[64:65], v[116:117] neg_lo:[0,1] neg_hi:[0,1]
v_pk_add_f32 v[98:99], v[66:67], v[118:119] neg_lo:[0,1] neg_hi:[0,1]
v_pk_add_f32 v[64:65], v[64:65], v[116:117]
v_pk_add_f32 v[66:67], v[66:67], v[118:119]
v_pk_add_f32 v[116:117], v[108:109], v[120:121] neg_lo:[0,1] neg_hi:[0,1]
v_pk_add_f32 v[118:119], v[110:111], v[122:123] neg_lo:[0,1] neg_hi:[0,1]
v_pk_add_f32 v[108:109], v[108:109], v[120:121]
v_pk_add_f32 v[110:111], v[110:111], v[122:123]
v_pk_add_f32 v[120:121], v[104:105], v[132:133] neg_lo:[0,1] neg_hi:[0,1]
v_pk_add_f32 v[122:123], v[106:107], v[134:135] neg_lo:[0,1] neg_hi:[0,1]
v_pk_add_f32 v[104:105], v[104:105], v[132:133]
v_pk_add_f32 v[106:107], v[106:107], v[134:135]
v_pk_add_f32 v[132:133], v[124:125], v[80:81] neg_lo:[0,1] neg_hi:[0,1]
v_pk_add_f32 v[134:135], v[126:127], v[82:83] neg_lo:[0,1] neg_hi:[0,1]
v_pk_add_f32 v[124:125], v[124:125], v[80:81]
v_pk_add_f32 v[126:127], v[126:127], v[82:83]
v_lshl_add_u32 v7, v1, 3, v6
ds_write_b64 v7, v[16:17]
ds_write_b64 v7, v[18:19] offset:8192
ds_write_b64 v7, v[144:145] offset:256
ds_write_b64 v7, v[146:147] offset:8448
ds_write_b64 v7, v[112:113] offset:512
ds_write_b64 v7, v[114:115] offset:8704
ds_write_b64 v7, v[64:65] offset:768
ds_write_b64 v7, v[66:67] offset:8960
ds_write_b64 v7, v[128:129] offset:1024
ds_write_b64 v7, v[130:131] offset:9216
ds_write_b64 v7, v[72:73] offset:1280
ds_write_b64 v7, v[74:75] offset:9472
ds_write_b64 v7, v[40:41] offset:1536
ds_write_b64 v7, v[42:43] offset:9728
ds_write_b64 v7, v[104:105] offset:1792
ds_write_b64 v7, v[106:107] offset:9984
ds_write_b64 v7, v[136:137] offset:2048
ds_write_b64 v7, v[138:139] offset:10240
ds_write_b64 v7, v[76:77] offset:2304
ds_write_b64 v7, v[78:79] offset:10496
ds_write_b64 v7, v[44:45] offset:2560
ds_write_b64 v7, v[46:47] offset:10752
ds_write_b64 v7, v[108:109] offset:2816
ds_write_b64 v7, v[110:111] offset:11008
ds_write_b64 v7, v[28:29] offset:3072
ds_write_b64 v7, v[30:31] offset:11264
ds_write_b64 v7, v[92:93] offset:3328
ds_write_b64 v7, v[94:95] offset:11520
ds_write_b64 v7, v[60:61] offset:3584
ds_write_b64 v7, v[62:63] offset:11776
ds_write_b64 v7, v[124:125] offset:3840
ds_write_b64 v7, v[126:127] offset:12032
ds_write_b64 v7, v[140:141] offset:4096
ds_write_b64 v7, v[142:143] offset:12288
ds_write_b64 v7, v[48:49] offset:4352
ds_write_b64 v7, v[50:51] offset:12544
ds_write_b64 v7, v[32:33] offset:4608
ds_write_b64 v7, v[34:35] offset:12800
ds_write_b64 v7, v[96:97] offset:4864
ds_write_b64 v7, v[98:99] offset:13056
ds_write_b64 v7, v[24:25] offset:5120
ds_write_b64 v7, v[26:27] offset:13312
ds_write_b64 v7, v[88:89] offset:5376
ds_write_b64 v7, v[90:91] offset:13568
ds_write_b64 v7, v[56:57] offset:5632
ds_write_b64 v7, v[58:59] offset:13824
ds_write_b64 v7, v[120:121] offset:5888
ds_write_b64 v7, v[122:123] offset:14080
ds_write_b64 v7, v[20:21] offset:6144
ds_write_b64 v7, v[22:23] offset:14336
ds_write_b64 v7, v[84:85] offset:6400
ds_write_b64 v7, v[86:87] offset:14592
ds_write_b64 v7, v[52:53] offset:6656
ds_write_b64 v7, v[54:55] offset:14848
ds_write_b64 v7, v[116:117] offset:6912
ds_write_b64 v7, v[118:119] offset:15104
ds_write_b64 v7, v[36:37] offset:7168
ds_write_b64 v7, v[38:39] offset:15360
ds_write_b64 v7, v[100:101] offset:7424
ds_write_b64 v7, v[102:103] offset:15616
ds_write_b64 v7, v[68:69] offset:7680
ds_write_b64 v7, v[70:71] offset:15872
ds_write_b64 v7, v[132:133] offset:7936
ds_write_b64 v7, v[134:135] offset:16128
s_waitcnt lgkmcnt(0)
s_barrier
v_and_b32 v1, 127, v0
v_lshrrev_b32 v2, 7, v0
v_lshlrev_b32 v3, 6, v1
v_lshl_add_u32 v3, v2, 13, v3
v_add_u32 v4, 67584, v3
v_lshlrev_b32 v5, 4, v1
v_lshl_add_u32 v5, v2, 15, v5
s_lshl_b32 s12, s92, 17
ds_read_b128 v[16:19], v3
ds_read_b128 v[20:23], v3 offset:16
ds_read_b128 v[24:27], v3 offset:32
ds_read_b128 v[28:31], v3 offset:48
ds_read_b128 v[32:35], v3 offset:16896
ds_read_b128 v[36:39], v3 offset:16912
ds_read_b128 v[40:43], v3 offset:16928
ds_read_b128 v[44:47], v3 offset:16944
s_waitcnt lgkmcnt(4)
v_cvt_pk_bf16_f32 v48, v16, v18
v_cvt_pk_bf16_f32 v49, v20, v22
v_cvt_pk_bf16_f32 v50, v24, v26
v_cvt_pk_bf16_f32 v51, v28, v30
v_cvt_pk_bf16_f32 v52, v17, v19
v_cvt_pk_bf16_f32 v53, v21, v23
v_cvt_pk_bf16_f32 v54, v25, v27
v_cvt_pk_bf16_f32 v55, v29, v31
s_add_u32 s13, s12, 0
buffer_store_dwordx4 v[48:51], v5, s[4:7], s13 offen offset:2048
s_add_u32 s13, s12, 65536
buffer_store_dwordx4 v[52:55], v5, s[4:7], s13 offen offset:2048
ds_read_b128 v[16:19], v3 offset:33792
ds_read_b128 v[20:23], v3 offset:33808
ds_read_b128 v[24:27], v3 offset:33824
ds_read_b128 v[28:31], v3 offset:33840
s_waitcnt lgkmcnt(4)
v_cvt_pk_bf16_f32 v56, v32, v34
v_cvt_pk_bf16_f32 v57, v36, v38
v_cvt_pk_bf16_f32 v58, v40, v42
v_cvt_pk_bf16_f32 v59, v44, v46
v_cvt_pk_bf16_f32 v60, v33, v35
v_cvt_pk_bf16_f32 v61, v37, v39
v_cvt_pk_bf16_f32 v62, v41, v43
v_cvt_pk_bf16_f32 v63, v45, v47
s_add_u32 s13, s12, 4096
buffer_store_dwordx4 v[56:59], v5, s[4:7], s13 offen offset:2048
s_add_u32 s13, s12, 69632
buffer_store_dwordx4 v[60:63], v5, s[4:7], s13 offen offset:2048
ds_read_b128 v[32:35], v3 offset:50688
ds_read_b128 v[36:39], v3 offset:50704
ds_read_b128 v[40:43], v3 offset:50720
ds_read_b128 v[44:47], v3 offset:50736
s_waitcnt lgkmcnt(4)
v_cvt_pk_bf16_f32 v48, v16, v18
v_cvt_pk_bf16_f32 v49, v20, v22
v_cvt_pk_bf16_f32 v50, v24, v26
v_cvt_pk_bf16_f32 v51, v28, v30
v_cvt_pk_bf16_f32 v52, v17, v19
v_cvt_pk_bf16_f32 v53, v21, v23
v_cvt_pk_bf16_f32 v54, v25, v27
v_cvt_pk_bf16_f32 v55, v29, v31
s_add_u32 s13, s12, 8192
buffer_store_dwordx4 v[48:51], v5, s[4:7], s13 offen offset:2048
s_add_u32 s13, s12, 73728
buffer_store_dwordx4 v[52:55], v5, s[4:7], s13 offen offset:2048
ds_read_b128 v[16:19], v4
ds_read_b128 v[20:23], v4 offset:16
ds_read_b128 v[24:27], v4 offset:32
ds_read_b128 v[28:31], v4 offset:48
s_waitcnt lgkmcnt(4)
v_cvt_pk_bf16_f32 v56, v32, v34
v_cvt_pk_bf16_f32 v57, v36, v38
v_cvt_pk_bf16_f32 v58, v40, v42
v_cvt_pk_bf16_f32 v59, v44, v46
v_cvt_pk_bf16_f32 v60, v33, v35
v_cvt_pk_bf16_f32 v61, v37, v39
v_cvt_pk_bf16_f32 v62, v41, v43
v_cvt_pk_bf16_f32 v63, v45, v47
s_add_u32 s13, s12, 12288
buffer_store_dwordx4 v[56:59], v5, s[4:7], s13 offen offset:2048
s_add_u32 s13, s12, 77824
buffer_store_dwordx4 v[60:63], v5, s[4:7], s13 offen offset:2048
ds_read_b128 v[32:35], v4 offset:16896
ds_read_b128 v[36:39], v4 offset:16912
ds_read_b128 v[40:43], v4 offset:16928
ds_read_b128 v[44:47], v4 offset:16944
s_waitcnt lgkmcnt(4)
v_cvt_pk_bf16_f32 v48, v16, v18
v_cvt_pk_bf16_f32 v49, v20, v22
v_cvt_pk_bf16_f32 v50, v24, v26
v_cvt_pk_bf16_f32 v51, v28, v30
v_cvt_pk_bf16_f32 v52, v17, v19
v_cvt_pk_bf16_f32 v53, v21, v23
v_cvt_pk_bf16_f32 v54, v25, v27
v_cvt_pk_bf16_f32 v55, v29, v31
s_add_u32 s13, s12, 16384
buffer_store_dwordx4 v[48:51], v5, s[4:7], s13 offen offset:2048
s_add_u32 s13, s12, 81920
buffer_store_dwordx4 v[52:55], v5, s[4:7], s13 offen offset:2048
ds_read_b128 v[16:19], v4 offset:33792
ds_read_b128 v[20:23], v4 offset:33808
ds_read_b128 v[24:27], v4 offset:33824
ds_read_b128 v[28:31], v4 offset:33840
s_waitcnt lgkmcnt(4)
v_cvt_pk_bf16_f32 v56, v32, v34
v_cvt_pk_bf16_f32 v57, v36, v38
v_cvt_pk_bf16_f32 v58, v40, v42
v_cvt_pk_bf16_f32 v59, v44, v46
v_cvt_pk_bf16_f32 v60, v33, v35
v_cvt_pk_bf16_f32 v61, v37, v39
v_cvt_pk_bf16_f32 v62, v41, v43
v_cvt_pk_bf16_f32 v63, v45, v47
s_add_u32 s13, s12, 20480
buffer_store_dwordx4 v[56:59], v5, s[4:7], s13 offen offset:2048
s_add_u32 s13, s12, 86016
buffer_store_dwordx4 v[60:63], v5, s[4:7], s13 offen offset:2048
ds_read_b128 v[32:35], v4 offset:50688
ds_read_b128 v[36:39], v4 offset:50704
ds_read_b128 v[40:43], v4 offset:50720
ds_read_b128 v[44:47], v4 offset:50736
s_waitcnt lgkmcnt(4)
v_cvt_pk_bf16_f32 v48, v16, v18
v_cvt_pk_bf16_f32 v49, v20, v22
v_cvt_pk_bf16_f32 v50, v24, v26
v_cvt_pk_bf16_f32 v51, v28, v30
v_cvt_pk_bf16_f32 v52, v17, v19
v_cvt_pk_bf16_f32 v53, v21, v23
v_cvt_pk_bf16_f32 v54, v25, v27
v_cvt_pk_bf16_f32 v55, v29, v31
s_add_u32 s13, s12, 24576
buffer_store_dwordx4 v[48:51], v5, s[4:7], s13 offen offset:2048
s_add_u32 s13, s12, 90112
buffer_store_dwordx4 v[52:55], v5, s[4:7], s13 offen offset:2048
s_waitcnt lgkmcnt(0)
v_cvt_pk_bf16_f32 v56, v32, v34
v_cvt_pk_bf16_f32 v57, v36, v38
v_cvt_pk_bf16_f32 v58, v40, v42
v_cvt_pk_bf16_f32 v59, v44, v46
v_cvt_pk_bf16_f32 v60, v33, v35
v_cvt_pk_bf16_f32 v61, v37, v39
v_cvt_pk_bf16_f32 v62, v41, v43
v_cvt_pk_bf16_f32 v63, v45, v47
s_add_u32 s13, s12, 28672
buffer_store_dwordx4 v[56:59], v5, s[4:7], s13 offen offset:2048
s_add_u32 s13, s12, 94208
buffer_store_dwordx4 v[60:63], v5, s[4:7], s13 offen offset:2048
s_waitcnt vmcnt(0) lgkmcnt(0)
s_barrier
s_lshr_b32 s81, s92, 5
s_cmp_lg_u32 s81, 0
s_cbranch_scc1 L_nx0
s_endpgm
L_nx0:
s_lshr_b32 s81, s92, 5
s_cmp_lg_u32 s81, 1
s_cbranch_scc1 L_nx1
s_endpgm
L_nx1:
L_wl:
s_load_dwordx2 s[52:53], s[0:1], 40
v_and_b32 v202, 63, v0
v_lshrrev_b32 v200, 3, v202
v_lshlrev_b32 v200, 11, v200
v_and_b32 v203, 7, v202
v_lshl_add_u32 v200, v203, 4, v200
s_and_b32 s56, s92, 1
s_lshl_b32 s56, s56, 2
s_add_u32 s56, s56, s98
s_lshl_b32 s56, s56, 20
s_bfe_u32 s58, s92, 0x40001
s_lshl_b32 s57, s58, 7
s_add_u32 s56, s56, s57
v_add_u32 v200, s56, v200
s_lshl_b32 s56, s98, 15
s_lshl_b32 s57, s58, 12
v_lshrrev_b32 v201, 5, v202
v_bfe_u32 v204, v202, 2, 2
v_lshl_add_u32 v201, v201, 3, v204
v_lshlrev_b32 v201, 7, v201
v_bfe_u32 v204, v202, 4, 1
v_lshl_add_u32 v201, v204, 5, v201
v_and_b32 v203, 3, v202
v_lshl_add_u32 v201, v203, 3, v201
v_add_u32 v201, s56, v201
s_waitcnt lgkmcnt(0)
s_mov_b32 s54, 8388608
s_mov_b32 s55, 0x00020000
s_add_u32 m0, s56, 0
s_add_u32 s58, s57, 0
s_and_b32 s58, s58, 0x7fff
s_lshl_b32 s58, s58, 5
buffer_load_dwordx4 v200, s[52:55], s58 offen lds
s_add_u32 m0, s56, 1024
s_add_u32 s58, s57, 512
s_and_b32 s58, s58, 0x7fff
s_lshl_b32 s58, s58, 5
buffer_load_dwordx4 v200, s[52:55], s58 offen lds
s_add_u32 m0, s56, 2048
s_add_u32 s58, s57, 1024
s_and_b32 s58, s58, 0x7fff
s_lshl_b32 s58, s58, 5
buffer_load_dwordx4 v200, s[52:55], s58 offen lds
s_add_u32 m0, s56, 3072
s_add_u32 s58, s57, 1536
s_and_b32 s58, s58, 0x7fff
s_lshl_b32 s58, s58, 5
buffer_load_dwordx4 v200, s[52:55], s58 offen lds
s_waitcnt vmcnt(0)
ds_read_b64_tr_b16 a[0:1], v201
ds_read_b64_tr_b16 a[2:3], v201 offset:512
ds_read_b64_tr_b16 a[4:5], v201 offset:64
ds_read_b64_tr_b16 a[6:7], v201 offset:576
ds_read_b64_tr_b16 a[8:9], v201 offset:2048
ds_read_b64_tr_b16 a[10:11], v201 offset:2560
ds_read_b64_tr_b16 a[12:13], v201 offset:2112
ds_read_b64_tr_b16 a[14:15], v201 offset:2624
s_waitcnt lgkmcnt(0)
s_add_u32 m0, s56, 4096
s_add_u32 s58, s57, 2048
s_and_b32 s58, s58, 0x7fff
s_lshl_b32 s58, s58, 5
buffer_load_dwordx4 v200, s[52:55], s58 offen lds
s_add_u32 m0, s56, 5120
s_add_u32 s58, s57, 2560
s_and_b32 s58, s58, 0x7fff
s_lshl_b32 s58, s58, 5
buffer_load_dwordx4 v200, s[52:55], s58 offen lds
s_add_u32 m0, s56, 6144
s_add_u32 s58, s57, 3072
s_and_b32 s58, s58, 0x7fff
s_lshl_b32 s58, s58, 5
buffer_load_dwordx4 v200, s[52:55], s58 offen lds
s_add_u32 m0, s56, 7168
s_add_u32 s58, s57, 3584
s_and_b32 s58, s58, 0x7fff
s_lshl_b32 s58, s58, 5
buffer_load_dwordx4 v200, s[52:55], s58 offen lds
s_waitcnt vmcnt(0)
ds_read_b64_tr_b16 a[16:17], v201 offset:4096
ds_read_b64_tr_b16 a[18:19], v201 offset:4608
ds_read_b64_tr_b16 a[20:21], v201 offset:4160
ds_read_b64_tr_b16 a[22:23], v201 offset:4672
ds_read_b64_tr_b16 a[24:25], v201 offset:6144
ds_read_b64_tr_b16 a[26:27], v201 offset:6656
ds_read_b64_tr_b16 a[28:29], v201 offset:6208
ds_read_b64_tr_b16 a[30:31], v201 offset:6720
s_waitcnt lgkmcnt(0)
s_add_u32 m0, s56, 8192
s_add_u32 s58, s57, 4096
s_and_b32 s58, s58, 0x7fff
s_lshl_b32 s58, s58, 5
buffer_load_dwordx4 v200, s[52:55], s58 offen lds
s_add_u32 m0, s56, 9216
s_add_u32 s58, s57, 4608
s_and_b32 s58, s58, 0x7fff
s_lshl_b32 s58, s58, 5
buffer_load_dwordx4 v200, s[52:55], s58 offen lds
s_add_u32 m0, s56, 10240
s_add_u32 s58, s57, 5120
s_and_b32 s58, s58, 0x7fff
s_lshl_b32 s58, s58, 5
buffer_load_dwordx4 v200, s[52:55], s58 offen lds
s_add_u32 m0, s56, 11264
s_add_u32 s58, s57, 5632
s_and_b32 s58, s58, 0x7fff
s_lshl_b32 s58, s58, 5
buffer_load_dwordx4 v200, s[52:55], s58 offen lds
s_waitcnt vmcnt(0)
ds_read_b64_tr_b16 a[32:33], v201 offset:8192
ds_read_b64_tr_b16 a[34:35], v201 offset:8704
ds_read_b64_tr_b16 a[36:37], v201 offset:8256
ds_read_b64_tr_b16 a[38:39], v201 offset:8768
ds_read_b64_tr_b16 a[40:41], v201 offset:10240
ds_read_b64_tr_b16 a[42:43], v201 offset:10752
ds_read_b64_tr_b16 a[44:45], v201 offset:10304
ds_read_b64_tr_b16 a[46:47], v201 offset:10816
s_waitcnt lgkmcnt(0)
s_add_u32 m0, s56, 12288
s_add_u32 s58, s57, 6144
s_and_b32 s58, s58, 0x7fff
s_lshl_b32 s58, s58, 5
buffer_load_dwordx4 v200, s[52:55], s58 offen lds
s_add_u32 m0, s56, 13312
s_add_u32 s58, s57, 6656
s_and_b32 s58, s58, 0x7fff
s_lshl_b32 s58, s58, 5
buffer_load_dwordx4 v200, s[52:55], s58 offen lds
s_add_u32 m0, s56, 14336
s_add_u32 s58, s57, 7168
s_and_b32 s58, s58, 0x7fff
s_lshl_b32 s58, s58, 5
buffer_load_dwordx4 v200, s[52:55], s58 offen lds
s_add_u32 m0, s56, 15360
s_add_u32 s58, s57, 7680
s_and_b32 s58, s58, 0x7fff
s_lshl_b32 s58, s58, 5
buffer_load_dwordx4 v200, s[52:55], s58 offen lds
s_waitcnt vmcnt(0)
ds_read_b64_tr_b16 a[48:49], v201 offset:12288
ds_read_b64_tr_b16 a[50:51], v201 offset:12800
ds_read_b64_tr_b16 a[52:53], v201 offset:12352
ds_read_b64_tr_b16 a[54:55], v201 offset:12864
ds_read_b64_tr_b16 a[56:57], v201 offset:14336
ds_read_b64_tr_b16 a[58:59], v201 offset:14848
ds_read_b64_tr_b16 a[60:61], v201 offset:14400
ds_read_b64_tr_b16 a[62:63], v201 offset:14912
s_waitcnt lgkmcnt(0)
s_add_u32 m0, s56, 16384
s_add_u32 s58, s57, 8192
s_and_b32 s58, s58, 0x7fff
s_lshl_b32 s58, s58, 5
buffer_load_dwordx4 v200, s[52:55], s58 offen lds
s_add_u32 m0, s56, 17408
s_add_u32 s58, s57, 8704
s_and_b32 s58, s58, 0x7fff
s_lshl_b32 s58, s58, 5
buffer_load_dwordx4 v200, s[52:55], s58 offen lds
s_add_u32 m0, s56, 18432
s_add_u32 s58, s57, 9216
s_and_b32 s58, s58, 0x7fff
s_lshl_b32 s58, s58, 5
buffer_load_dwordx4 v200, s[52:55], s58 offen lds
s_add_u32 m0, s56, 19456
s_add_u32 s58, s57, 9728
s_and_b32 s58, s58, 0x7fff
s_lshl_b32 s58, s58, 5
buffer_load_dwordx4 v200, s[52:55], s58 offen lds
s_waitcnt vmcnt(0)
ds_read_b64_tr_b16 a[64:65], v201 offset:16384
ds_read_b64_tr_b16 a[66:67], v201 offset:16896
ds_read_b64_tr_b16 a[68:69], v201 offset:16448
ds_read_b64_tr_b16 a[70:71], v201 offset:16960
ds_read_b64_tr_b16 a[72:73], v201 offset:18432
ds_read_b64_tr_b16 a[74:75], v201 offset:18944
ds_read_b64_tr_b16 a[76:77], v201 offset:18496
ds_read_b64_tr_b16 a[78:79], v201 offset:19008
s_waitcnt lgkmcnt(0)
s_add_u32 m0, s56, 20480
s_add_u32 s58, s57, 10240
s_and_b32 s58, s58, 0x7fff
s_lshl_b32 s58, s58, 5
buffer_load_dwordx4 v200, s[52:55], s58 offen lds
s_add_u32 m0, s56, 21504
s_add_u32 s58, s57, 10752
s_and_b32 s58, s58, 0x7fff
s_lshl_b32 s58, s58, 5
buffer_load_dwordx4 v200, s[52:55], s58 offen lds
s_add_u32 m0, s56, 22528
s_add_u32 s58, s57, 11264
s_and_b32 s58, s58, 0x7fff
s_lshl_b32 s58, s58, 5
buffer_load_dwordx4 v200, s[52:55], s58 offen lds
s_add_u32 m0, s56, 23552
s_add_u32 s58, s57, 11776
s_and_b32 s58, s58, 0x7fff
s_lshl_b32 s58, s58, 5
buffer_load_dwordx4 v200, s[52:55], s58 offen lds
s_waitcnt vmcnt(0)
ds_read_b64_tr_b16 a[80:81], v201 offset:20480
ds_read_b64_tr_b16 a[82:83], v201 offset:20992
ds_read_b64_tr_b16 a[84:85], v201 offset:20544
ds_read_b64_tr_b16 a[86:87], v201 offset:21056
ds_read_b64_tr_b16 a[88:89], v201 offset:22528
ds_read_b64_tr_b16 a[90:91], v201 offset:23040
ds_read_b64_tr_b16 a[92:93], v201 offset:22592
ds_read_b64_tr_b16 a[94:95], v201 offset:23104
s_waitcnt lgkmcnt(0)
s_add_u32 m0, s56, 24576
s_add_u32 s58, s57, 12288
s_and_b32 s58, s58, 0x7fff
s_lshl_b32 s58, s58, 5
buffer_load_dwordx4 v200, s[52:55], s58 offen lds
s_add_u32 m0, s56, 25600
s_add_u32 s58, s57, 12800
s_and_b32 s58, s58, 0x7fff
s_lshl_b32 s58, s58, 5
buffer_load_dwordx4 v200, s[52:55], s58 offen lds
s_add_u32 m0, s56, 26624
s_add_u32 s58, s57, 13312
s_and_b32 s58, s58, 0x7fff
s_lshl_b32 s58, s58, 5
buffer_load_dwordx4 v200, s[52:55], s58 offen lds
s_add_u32 m0, s56, 27648
s_add_u32 s58, s57, 13824
s_and_b32 s58, s58, 0x7fff
s_lshl_b32 s58, s58, 5
buffer_load_dwordx4 v200, s[52:55], s58 offen lds
s_waitcnt vmcnt(0)
ds_read_b64_tr_b16 a[96:97], v201 offset:24576
ds_read_b64_tr_b16 a[98:99], v201 offset:25088
ds_read_b64_tr_b16 a[100:101], v201 offset:24640
ds_read_b64_tr_b16 a[102:103], v201 offset:25152
ds_read_b64_tr_b16 a[104:105], v201 offset:26624
ds_read_b64_tr_b16 a[106:107], v201 offset:27136
ds_read_b64_tr_b16 a[108:109], v201 offset:26688
ds_read_b64_tr_b16 a[110:111], v201 offset:27200
s_waitcnt lgkmcnt(0)
s_add_u32 m0, s56, 28672
s_add_u32 s58, s57, 14336
s_and_b32 s58, s58, 0x7fff
s_lshl_b32 s58, s58, 5
buffer_load_dwordx4 v200, s[52:55], s58 offen lds
s_add_u32 m0, s56, 29696
s_add_u32 s58, s57, 14848
s_and_b32 s58, s58, 0x7fff
s_lshl_b32 s58, s58, 5
buffer_load_dwordx4 v200, s[52:55], s58 offen lds
s_add_u32 m0, s56, 30720
s_add_u32 s58, s57, 15360
s_and_b32 s58, s58, 0x7fff
s_lshl_b32 s58, s58, 5
buffer_load_dwordx4 v200, s[52:55], s58 offen lds
s_add_u32 m0, s56, 31744
s_add_u32 s58, s57, 15872
s_and_b32 s58, s58, 0x7fff
s_lshl_b32 s58, s58, 5
buffer_load_dwordx4 v200, s[52:55], s58 offen lds
s_waitcnt vmcnt(0)
ds_read_b64_tr_b16 a[112:113], v201 offset:28672
ds_read_b64_tr_b16 a[114:115], v201 offset:29184
ds_read_b64_tr_b16 a[116:117], v201 offset:28736
ds_read_b64_tr_b16 a[118:119], v201 offset:29248
ds_read_b64_tr_b16 a[120:121], v201 offset:30720
ds_read_b64_tr_b16 a[122:123], v201 offset:31232
ds_read_b64_tr_b16 a[124:125], v201 offset:30784
ds_read_b64_tr_b16 a[126:127], v201 offset:31296
s_waitcnt lgkmcnt(0)
s_add_u32 m0, s56, 0
s_add_u32 s58, s57, 16384
s_and_b32 s58, s58, 0x7fff
s_lshl_b32 s58, s58, 5
buffer_load_dwordx4 v200, s[52:55], s58 offen lds
s_add_u32 m0, s56, 1024
s_add_u32 s58, s57, 16896
s_and_b32 s58, s58, 0x7fff
s_lshl_b32 s58, s58, 5
buffer_load_dwordx4 v200, s[52:55], s58 offen lds
s_add_u32 m0, s56, 2048
s_add_u32 s58, s57, 17408
s_and_b32 s58, s58, 0x7fff
s_lshl_b32 s58, s58, 5
buffer_load_dwordx4 v200, s[52:55], s58 offen lds
s_add_u32 m0, s56, 3072
s_add_u32 s58, s57, 17920
s_and_b32 s58, s58, 0x7fff
s_lshl_b32 s58, s58, 5
buffer_load_dwordx4 v200, s[52:55], s58 offen lds
s_waitcnt vmcnt(0)
ds_read_b64_tr_b16 a[128:129], v201
ds_read_b64_tr_b16 a[130:131], v201 offset:512
ds_read_b64_tr_b16 a[132:133], v201 offset:64
ds_read_b64_tr_b16 a[134:135], v201 offset:576
ds_read_b64_tr_b16 a[136:137], v201 offset:2048
ds_read_b64_tr_b16 a[138:139], v201 offset:2560
ds_read_b64_tr_b16 a[140:141], v201 offset:2112
ds_read_b64_tr_b16 a[142:143], v201 offset:2624
s_waitcnt lgkmcnt(0)
s_add_u32 m0, s56, 4096
s_add_u32 s58, s57, 18432
s_and_b32 s58, s58, 0x7fff
s_lshl_b32 s58, s58, 5
buffer_load_dwordx4 v200, s[52:55], s58 offen lds
s_add_u32 m0, s56, 5120
s_add_u32 s58, s57, 18944
s_and_b32 s58, s58, 0x7fff
s_lshl_b32 s58, s58, 5
buffer_load_dwordx4 v200, s[52:55], s58 offen lds
s_add_u32 m0, s56, 6144
s_add_u32 s58, s57, 19456
s_and_b32 s58, s58, 0x7fff
s_lshl_b32 s58, s58, 5
buffer_load_dwordx4 v200, s[52:55], s58 offen lds
s_add_u32 m0, s56, 7168
s_add_u32 s58, s57, 19968
s_and_b32 s58, s58, 0x7fff
s_lshl_b32 s58, s58, 5
buffer_load_dwordx4 v200, s[52:55], s58 offen lds
s_waitcnt vmcnt(0)
ds_read_b64_tr_b16 a[144:145], v201 offset:4096
ds_read_b64_tr_b16 a[146:147], v201 offset:4608
ds_read_b64_tr_b16 a[148:149], v201 offset:4160
ds_read_b64_tr_b16 a[150:151], v201 offset:4672
ds_read_b64_tr_b16 a[152:153], v201 offset:6144
ds_read_b64_tr_b16 a[154:155], v201 offset:6656
ds_read_b64_tr_b16 a[156:157], v201 offset:6208
ds_read_b64_tr_b16 a[158:159], v201 offset:6720
s_waitcnt lgkmcnt(0)
s_add_u32 m0, s56, 8192
s_add_u32 s58, s57, 20480
s_and_b32 s58, s58, 0x7fff
s_lshl_b32 s58, s58, 5
buffer_load_dwordx4 v200, s[52:55], s58 offen lds
s_add_u32 m0, s56, 9216
s_add_u32 s58, s57, 20992
s_and_b32 s58, s58, 0x7fff
s_lshl_b32 s58, s58, 5
buffer_load_dwordx4 v200, s[52:55], s58 offen lds
s_add_u32 m0, s56, 10240
s_add_u32 s58, s57, 21504
s_and_b32 s58, s58, 0x7fff
s_lshl_b32 s58, s58, 5
buffer_load_dwordx4 v200, s[52:55], s58 offen lds
s_add_u32 m0, s56, 11264
s_add_u32 s58, s57, 22016
s_and_b32 s58, s58, 0x7fff
s_lshl_b32 s58, s58, 5
buffer_load_dwordx4 v200, s[52:55], s58 offen lds
s_waitcnt vmcnt(0)
ds_read_b64_tr_b16 a[160:161], v201 offset:8192
ds_read_b64_tr_b16 a[162:163], v201 offset:8704
ds_read_b64_tr_b16 a[164:165], v201 offset:8256
ds_read_b64_tr_b16 a[166:167], v201 offset:8768
ds_read_b64_tr_b16 a[168:169], v201 offset:10240
ds_read_b64_tr_b16 a[170:171], v201 offset:10752
ds_read_b64_tr_b16 a[172:173], v201 offset:10304
ds_read_b64_tr_b16 a[174:175], v201 offset:10816
s_waitcnt lgkmcnt(0)
s_add_u32 m0, s56, 12288
s_add_u32 s58, s57, 22528
s_and_b32 s58, s58, 0x7fff
s_lshl_b32 s58, s58, 5
buffer_load_dwordx4 v200, s[52:55], s58 offen lds
s_add_u32 m0, s56, 13312
s_add_u32 s58, s57, 23040
s_and_b32 s58, s58, 0x7fff
s_lshl_b32 s58, s58, 5
buffer_load_dwordx4 v200, s[52:55], s58 offen lds
s_add_u32 m0, s56, 14336
s_add_u32 s58, s57, 23552
s_and_b32 s58, s58, 0x7fff
s_lshl_b32 s58, s58, 5
buffer_load_dwordx4 v200, s[52:55], s58 offen lds
s_add_u32 m0, s56, 15360
s_add_u32 s58, s57, 24064
s_and_b32 s58, s58, 0x7fff
s_lshl_b32 s58, s58, 5
buffer_load_dwordx4 v200, s[52:55], s58 offen lds
s_waitcnt vmcnt(0)
ds_read_b64_tr_b16 a[176:177], v201 offset:12288
ds_read_b64_tr_b16 a[178:179], v201 offset:12800
ds_read_b64_tr_b16 a[180:181], v201 offset:12352
ds_read_b64_tr_b16 a[182:183], v201 offset:12864
ds_read_b64_tr_b16 a[184:185], v201 offset:14336
ds_read_b64_tr_b16 a[186:187], v201 offset:14848
ds_read_b64_tr_b16 a[188:189], v201 offset:14400
ds_read_b64_tr_b16 a[190:191], v201 offset:14912
s_waitcnt lgkmcnt(0)
s_add_u32 m0, s56, 16384
s_add_u32 s58, s57, 24576
s_and_b32 s58, s58, 0x7fff
s_lshl_b32 s58, s58, 5
buffer_load_dwordx4 v200, s[52:55], s58 offen lds
s_add_u32 m0, s56, 17408
s_add_u32 s58, s57, 25088
s_and_b32 s58, s58, 0x7fff
s_lshl_b32 s58, s58, 5
buffer_load_dwordx4 v200, s[52:55], s58 offen lds
s_add_u32 m0, s56, 18432
s_add_u32 s58, s57, 25600
s_and_b32 s58, s58, 0x7fff
s_lshl_b32 s58, s58, 5
buffer_load_dwordx4 v200, s[52:55], s58 offen lds
s_add_u32 m0, s56, 19456
s_add_u32 s58, s57, 26112
s_and_b32 s58, s58, 0x7fff
s_lshl_b32 s58, s58, 5
buffer_load_dwordx4 v200, s[52:55], s58 offen lds
s_waitcnt vmcnt(0)
ds_read_b64_tr_b16 a[192:193], v201 offset:16384
ds_read_b64_tr_b16 a[194:195], v201 offset:16896
ds_read_b64_tr_b16 a[196:197], v201 offset:16448
ds_read_b64_tr_b16 a[198:199], v201 offset:16960
ds_read_b64_tr_b16 a[200:201], v201 offset:18432
ds_read_b64_tr_b16 a[202:203], v201 offset:18944
ds_read_b64_tr_b16 a[204:205], v201 offset:18496
ds_read_b64_tr_b16 a[206:207], v201 offset:19008
s_waitcnt lgkmcnt(0)
s_add_u32 m0, s56, 20480
s_add_u32 s58, s57, 26624
s_and_b32 s58, s58, 0x7fff
s_lshl_b32 s58, s58, 5
buffer_load_dwordx4 v200, s[52:55], s58 offen lds
s_add_u32 m0, s56, 21504
s_add_u32 s58, s57, 27136
s_and_b32 s58, s58, 0x7fff
s_lshl_b32 s58, s58, 5
buffer_load_dwordx4 v200, s[52:55], s58 offen lds
s_add_u32 m0, s56, 22528
s_add_u32 s58, s57, 27648
s_and_b32 s58, s58, 0x7fff
s_lshl_b32 s58, s58, 5
buffer_load_dwordx4 v200, s[52:55], s58 offen lds
s_add_u32 m0, s56, 23552
s_add_u32 s58, s57, 28160
s_and_b32 s58, s58, 0x7fff
s_lshl_b32 s58, s58, 5
buffer_load_dwordx4 v200, s[52:55], s58 offen lds
s_waitcnt vmcnt(0)
ds_read_b64_tr_b16 a[208:209], v201 offset:20480
ds_read_b64_tr_b16 a[210:211], v201 offset:20992
ds_read_b64_tr_b16 a[212:213], v201 offset:20544
ds_read_b64_tr_b16 a[214:215], v201 offset:21056
ds_read_b64_tr_b16 a[216:217], v201 offset:22528
ds_read_b64_tr_b16 a[218:219], v201 offset:23040
ds_read_b64_tr_b16 a[220:221], v201 offset:22592
ds_read_b64_tr_b16 a[222:223], v201 offset:23104
s_waitcnt lgkmcnt(0)
s_add_u32 m0, s56, 24576
s_add_u32 s58, s57, 28672
s_and_b32 s58, s58, 0x7fff
s_lshl_b32 s58, s58, 5
buffer_load_dwordx4 v200, s[52:55], s58 offen lds
s_add_u32 m0, s56, 25600
s_add_u32 s58, s57, 29184
s_and_b32 s58, s58, 0x7fff
s_lshl_b32 s58, s58, 5
buffer_load_dwordx4 v200, s[52:55], s58 offen lds
s_add_u32 m0, s56, 26624
s_add_u32 s58, s57, 29696
s_and_b32 s58, s58, 0x7fff
s_lshl_b32 s58, s58, 5
buffer_load_dwordx4 v200, s[52:55], s58 offen lds
s_add_u32 m0, s56, 27648
s_add_u32 s58, s57, 30208
s_and_b32 s58, s58, 0x7fff
s_lshl_b32 s58, s58, 5
buffer_load_dwordx4 v200, s[52:55], s58 offen lds
s_waitcnt vmcnt(0)
ds_read_b64_tr_b16 a[224:225], v201 offset:24576
ds_read_b64_tr_b16 a[226:227], v201 offset:25088
ds_read_b64_tr_b16 a[228:229], v201 offset:24640
ds_read_b64_tr_b16 a[230:231], v201 offset:25152
ds_read_b64_tr_b16 a[232:233], v201 offset:26624
ds_read_b64_tr_b16 a[234:235], v201 offset:27136
ds_read_b64_tr_b16 a[236:237], v201 offset:26688
ds_read_b64_tr_b16 a[238:239], v201 offset:27200
s_waitcnt lgkmcnt(0)
s_add_u32 m0, s56, 28672
s_add_u32 s58, s57, 30720
s_and_b32 s58, s58, 0x7fff
s_lshl_b32 s58, s58, 5
buffer_load_dwordx4 v200, s[52:55], s58 offen lds
s_add_u32 m0, s56, 29696
s_add_u32 s58, s57, 31232
s_and_b32 s58, s58, 0x7fff
s_lshl_b32 s58, s58, 5
buffer_load_dwordx4 v200, s[52:55], s58 offen lds
s_add_u32 m0, s56, 30720
s_add_u32 s58, s57, 31744
s_and_b32 s58, s58, 0x7fff
s_lshl_b32 s58, s58, 5
buffer_load_dwordx4 v200, s[52:55], s58 offen lds
s_add_u32 m0, s56, 31744
s_add_u32 s58, s57, 32256
s_and_b32 s58, s58, 0x7fff
s_lshl_b32 s58, s58, 5
buffer_load_dwordx4 v200, s[52:55], s58 offen lds
s_waitcnt vmcnt(0)
ds_read_b64_tr_b16 a[240:241], v201 offset:28672
ds_read_b64_tr_b16 a[242:243], v201 offset:29184
ds_read_b64_tr_b16 a[244:245], v201 offset:28736
ds_read_b64_tr_b16 a[246:247], v201 offset:29248
ds_read_b64_tr_b16 a[248:249], v201 offset:30720
ds_read_b64_tr_b16 a[250:251], v201 offset:31232
ds_read_b64_tr_b16 a[252:253], v201 offset:30784
ds_read_b64_tr_b16 a[254:255], v201 offset:31296
s_waitcnt lgkmcnt(0)
s_load_dwordx2 s[12:13], s[0:1], 80
v_lshrrev_b32 v3, 6, v0
v_and_b32 v1, 63, v0
v_readfirstlane_b32 s16, v3
s_lshr_b32 s17, s92, 5
s_and_b32 s18, s92, 31
v_lshlrev_b32 v2, 4, v1
v_lshlrev_b32 v19, 4, v0
v_lshlrev_b32 v7, 3, v1
s_waitcnt lgkmcnt(0)
s_mov_b32 s14, 8388608
s_mov_b32 s15, 0x00020000
s_mov_b32 s24, 0x3e0293ee
s_mov_b64 s[60:61], 0
s_lshr_b32 s50, s18, 1
s_lshl_b32 s50, s50, 12
s_mov_b32 s47, 0
s_mov_b32 s51, 0
s_lshl_b32 s20, s17, 3
s_add_u32 s20, s20, s16
s_lshl_b32 s20, s20, 18
s_lshl_b32 s21, s18, 13
s_add_u32 s20, s20, s21
s_add_u32 s20, s20, 50331648
v_lshlrev_b32 v26, 7, v1
buffer_load_dword v28, v26, s[84:87], s20 offen sc1
buffer_load_dword v30, v26, s[84:87], s20 offen offset:64 sc1
s_add_u32 s20, s20, 1048576
buffer_load_dword v29, v26, s[84:87], s20 offen sc1
buffer_load_dword v31, v26, s[84:87], s20 offen offset:64 sc1
s_lshl_b32 s20, s92, 15
s_add_u32 s20, s20, 75497472
v_lshlrev_b32 v26, 7, v0
buffer_load_dword v32, v26, s[84:87], s20 offen sc1
buffer_load_dword v33, v26, s[84:87], s20 offen offset:64 sc1
v_and_b32 v4, 15, v1
v_lshrrev_b32 v5, 4, v1
v_lshrrev_b32 v3, 2, v4
v_lshlrev_b32 v3, 1, v3
v_and_b32 v26, 1, v4
v_add_u32 v3, v3, v26
v_lshlrev_b32 v6, 8, v3
v_lshl_add_u32 v6, v5, 4, v6
v_lshlrev_b32 v8, 9, v5
v_lshl_add_u32 v8, v4, 4, v8
v_lshlrev_b32 v26, 2, v5
v_sub_u32 v248, v4, v26
s_and_b32 s21, s16, 1
s_lshl_b32 s21, s21, 4
v_add_u32 v9, s21, v248
v_add_u32 v10, -16, v9
v_mov_b32 v11, 0xff7fffff
v_mov_b32 v20, 0x3f803f80
v_mov_b32 v21, 0x3f803f80
v_mov_b32 v22, 0x3f803f80
v_mov_b32 v23, 0x3f803f80
v_bfe_u32 v26, v1, 1, 2
v_min_u32 v26, 2, v26
s_lshl_b32 s20, s18, 8
s_add_u32 s20, s20, 71303168
v_lshlrev_b32 v12, 13, v26
v_and_b32 v26, 1, v1
v_lshl_add_u32 v12, v26, 7, v12
v_add_u32 v12, s20, v12
v_lshlrev_b32 v13, 7, v26
s_add_u32 s43, s20, 24576
v_add_u32 v13, s43, v13
s_lshl_b32 s21, s21, 3
s_add_u32 s20, s20, s21
s_add_u32 s20, s20, 8192
v_mov_b32 v249, s20
s_mov_b32 vcc_lo, 0xcccccccc
s_mov_b32 vcc_hi, 0xcccccccc
v_cndmask_b32 v249, v13, v249, vcc
v_and_b32 v26, 3, v1
s_and_b32 s20, s18, 1
s_lshl_b32 s20, s20, 2
s_add_u32 s20, s20, s16
s_lshl_b32 s20, s20, 2
s_lshl_b32 s21, s17, 5
s_add_u32 s20, s20, s21
v_add_u32 v26, s20, v26
v_lshlrev_b32 v14, 7, v26
v_add_u32 v14, 71335936, v14
v_bfrev_b32 v26, 1
s_lshl_b32 s20, s92, 7
s_add_u32 s20, s20, 71335936
v_mov_b32 v27, s20
s_xor_b32 s20, s20, 128
v_mov_b32 v251, s20
v_cmp_eq_u32 vcc, 0, v0
s_mul_i32 s20, s16, 8704
v_lshrrev_b32 v17, 5, v1
v_lshl_add_u32 v17, v17, 5, v2
v_add_u32 v17, s20, v17
v_cndmask_b32 v15, v26, v27, vcc
v_lshrrev_b32 v26, 3, v0
v_and_b32 v27, 7, v0
v_mul_u32_u24 v16, 544, v27
v_lshl_add_u32 v16, v26, 4, v16
s_and_b32 s20, s18, 1
s_mul_i32 s20, s20, 4352
s_xor_b32 s21, s20, 4352
v_add_u32 v252, s21, v16
v_add_u32 v16, s20, v16
v_lshlrev_b32 v18, 12, v26
v_and_b32 v27, 7, v0
v_lshl_add_u32 v18, v27, 3, v18
s_lshl_b32 s20, s18, 6
v_add_u32 v18, s20, v18
s_barrier
s_cmp_eq_u32 s17, 0
s_cselect_b32 s60, 0x0, s60
s_cselect_b32 s61, 0x0, s61
s_cmp_eq_u32 s17, 1
s_cselect_b32 s60, 0x0, s60
s_cselect_b32 s61, 0x0, s61
s_cmp_eq_u32 s17, 2
s_cselect_b32 s60, 0x0, s60
s_cselect_b32 s61, 0x45000100, s61
s_cmp_eq_u32 s17, 3
s_cselect_b32 s60, 0x0, s60
s_cselect_b32 s61, 0x8a001000, s61
s_cmp_eq_u32 s17, 4
s_cselect_b32 s60, 0x1010101, s60
s_cselect_b32 s61, 0x10010001, s61
s_cmp_eq_u32 s17, 5
s_cselect_b32 s60, 0x10101010, s60
s_cselect_b32 s61, 0x20100010, s61
s_ff1_i32_b64 s22, s[60:61]
s_cmp_ge_u32 s22, 64
s_cbranch_scc1 L_x_fin
L_x_gp:
buffer_load_dword v3, v12, s[84:87], 0 offen sc1
s_waitcnt vmcnt(0)
v_cmp_gt_u32 vcc, 32, v3
s_and_b32 vcc_lo, vcc_lo, 252
s_cbranch_scc0 L_x_gk
s_sleep 8
s_branch L_x_gp
L_x_gk:
L_x_job:
s_cmp_ge_u32 s22, 56
s_cbranch_scc1 L_x_single
s_add_u32 s43, s22, s16
s_lshl_b32 s26, s43, 18
s_lshl_b32 s20, s18, 13
s_add_u32 s26, s26, s20
s_lshr_b32 s20, s43, 1
s_add_u32 s20, s20, 32
v_mov_b32 v250, s43
v_mov_b32 v3, s20
s_mov_b32 vcc_lo, 0xcccccccc
s_mov_b32 vcc_hi, 0xcccccccc
v_cndmask_b32 v250, v250, v3, vcc
L_x_btop:
buffer_load_dword v3, v249, s[84:87], 0 offen sc1
s_waitcnt vmcnt(0)
v_cmp_ge_u32 vcc, v250, v3
s_cbranch_vccz L_x_bk
s_sleep 8
s_branch L_x_btop
L_x_bk:
s_add_u32 s21, s26, 0
buffer_load_dwordx4 v[24:27], v2, s[84:87], s21 offen sc1
buffer_load_dwordx4 v[28:31], v2, s[84:87], s21 offen offset:1024 sc1
buffer_load_dwordx4 v[32:35], v2, s[84:87], s21 offen offset:2048 sc1
buffer_load_dwordx4 v[36:39], v2, s[84:87], s21 offen offset:3072 sc1
s_add_u32 s21, s26, 4096
buffer_load_dwordx4 v[40:43], v2, s[84:87], s21 offen sc1
buffer_load_dwordx4 v[44:47], v2, s[84:87], s21 offen offset:1024 sc1
buffer_load_dwordx4 v[48:51], v2, s[84:87], s21 offen offset:2048 sc1
buffer_load_dwordx4 v[52:55], v2, s[84:87], s21 offen offset:3072 sc1
s_add_u32 s21, s26, 16777216
buffer_load_dwordx4 v[56:59], v2, s[84:87], s21 offen sc1
buffer_load_dwordx4 v[60:63], v2, s[84:87], s21 offen offset:1024 sc1
buffer_load_dwordx4 v[64:67], v2, s[84:87], s21 offen offset:2048 sc1
buffer_load_dwordx4 v[68:71], v2, s[84:87], s21 offen offset:3072 sc1
s_add_u32 s21, s26, 16781312
buffer_load_dwordx4 v[72:75], v2, s[84:87], s21 offen sc1
buffer_load_dwordx4 v[76:79], v2, s[84:87], s21 offen offset:1024 sc1
buffer_load_dwordx4 v[80:83], v2, s[84:87], s21 offen offset:2048 sc1
buffer_load_dwordx4 v[84:87], v2, s[84:87], s21 offen offset:3072 sc1
s_add_u32 s21, s26, 33554432
buffer_load_dwordx4 v[88:91], v2, s[84:87], s21 offen sc1
buffer_load_dwordx4 v[92:95], v2, s[84:87], s21 offen offset:1024 sc1
buffer_load_dwordx4 v[96:99], v2, s[84:87], s21 offen offset:2048 sc1
buffer_load_dwordx4 v[100:103], v2, s[84:87], s21 offen offset:3072 sc1
s_add_u32 s21, s26, 33558528
buffer_load_dwordx4 v[104:107], v2, s[84:87], s21 offen sc1
buffer_load_dwordx4 v[108:111], v2, s[84:87], s21 offen offset:1024 sc1
buffer_load_dwordx4 v[112:115], v2, s[84:87], s21 offen offset:2048 sc1
buffer_load_dwordx4 v[116:119], v2, s[84:87], s21 offen offset:3072 sc1
s_add_u32 s21, s26, 178257920
buffer_load_dwordx4 v[120:123], v6, s[84:87], s21 offen sc1
buffer_load_dwordx4 v[124:127], v6, s[84:87], s21 offen offset:64 sc1
buffer_load_dwordx4 v[128:131], v6, s[84:87], s21 offen offset:128 sc1
buffer_load_dwordx4 v[132:135], v6, s[84:87], s21 offen offset:192 sc1
s_add_u32 s21, s26, 178259968
buffer_load_dwordx2 v[136:137], v7, s[84:87], s21 offen sc1
buffer_load_dwordx2 v[138:139], v7, s[84:87], s21 offen offset:2048 sc1
buffer_load_dwordx2 v[140:141], v7, s[84:87], s21 offen offset:512 sc1
buffer_load_dwordx2 v[142:143], v7, s[84:87], s21 offen offset:2560 sc1
buffer_load_dwordx2 v[144:145], v7, s[84:87], s21 offen offset:1024 sc1
buffer_load_dwordx2 v[146:147], v7, s[84:87], s21 offen offset:3072 sc1
buffer_load_dwordx2 v[148:149], v7, s[84:87], s21 offen offset:1536 sc1
buffer_load_dwordx2 v[150:151], v7, s[84:87], s21 offen offset:3584 sc1
L_x_batt:
s_lshl_b32 s40, s17, 3
s_add_u32 s40, s40, s47
s_add_u32 s40, s40, s16
s_lshl_b32 s40, s40, 18
s_add_u32 s40, s40, 50331648
s_lshl_b32 s20, s18, 13
s_add_u32 s40, s40, s20
v_mov_b32 v218, v20
v_mov_b32 v219, 0
s_add_u32 s27, s40, 4096
s_mov_b32 s8, 4
s_waitcnt vmcnt(0)
v_swap_b32 v137, v138
v_swap_b32 v141, v142
v_swap_b32 v145, v146
v_swap_b32 v149, v150
v_mfma_f32_16x16x32_bf16 v[200:203], v[56:59], v[24:27], 0
v_mfma_f32_16x16x32_bf16 v[208:211], v[120:123], v[24:27], 0
v_mfma_f32_16x16x32_bf16 v[200:203], v[64:67], v[32:35], v[200:203]
v_mfma_f32_16x16x32_bf16 v[208:211], v[124:127], v[32:35], v[208:211]
v_mfma_f32_16x16x32_bf16 v[200:203], v[72:75], v[40:43], v[200:203]
v_mfma_f32_16x16x32_bf16 v[208:211], v[128:131], v[40:43], v[208:211]
v_mfma_f32_16x16x32_bf16 v[200:203], v[80:83], v[48:51], v[200:203]
v_mfma_f32_16x16x32_bf16 v[208:211], v[132:135], v[48:51], v[208:211]
s_nop 5
v_cmp_gt_i32 vcc, 0, v248
s_nop 1
v_cndmask_b32 v200, v200, v11, vcc
v_cmp_gt_i32 vcc, 1, v248
s_nop 1
v_cndmask_b32 v201, v201, v11, vcc
v_cmp_gt_i32 vcc, 2, v248
s_nop 1
v_cndmask_b32 v202, v202, v11, vcc
v_cmp_gt_i32 vcc, 3, v248
s_nop 1
v_cndmask_b32 v203, v203, v11, vcc
v_max3_f32 v4, v200, v201, v202
v_max3_f32 v4, v4, v203, v208
v_max_f32 v3, v4, v209
v_max_f32 v4, v4, v209
s_nop 1
v_permlane16_swap_b32 v4, v3
v_max_f32 v4, v4, v3
v_max_f32 v3, v4, v3
s_nop 1
v_permlane32_swap_b32 v4, v3
v_max_f32 v4, v4, v3
v_mul_f32 v4, s24, v4
v_fma_f32 v200, v200, s24, -v4
v_fma_f32 v201, v201, s24, -v4
v_fma_f32 v202, v202, s24, -v4
v_fma_f32 v203, v203, s24, -v4
v_fma_f32 v208, v208, s24, -v4
v_fma_f32 v209, v209, s24, -v4
v_exp_f32 v200, v200
v_exp_f32 v201, v201
v_exp_f32 v202, v202
v_exp_f32 v203, v203
v_exp_f32 v208, v208
v_exp_f32 v209, v209
s_nop 0
v_cvt_pk_bf16_f32 v212, v200, v201
v_cvt_pk_bf16_f32 v213, v202, v203
v_mov_b32 v214, 0
v_mov_b32 v215, 0
v_cvt_pk_bf16_f32 v216, v208, v209
v_cvt_pk_bf16_f32 v217, v208, v209
v_mfma_f32_16x16x32_bf16 v[220:223], v[20:23], v[212:215], 0
v_mfma_f32_16x16x32_bf16 v[152:155], v[88:91], v[212:215], 0
v_mfma_f32_16x16x32_bf16 v[156:159], v[92:95], v[212:215], 0
v_mfma_f32_16x16x32_bf16 v[160:163], v[96:99], v[212:215], 0
v_mfma_f32_16x16x32_bf16 v[164:167], v[100:103], v[212:215], 0
v_mfma_f32_16x16x32_bf16 v[168:171], v[104:107], v[212:215], 0
v_mfma_f32_16x16x32_bf16 v[172:175], v[108:111], v[212:215], 0
v_mfma_f32_16x16x32_bf16 v[176:179], v[112:115], v[212:215], 0
v_mfma_f32_16x16x32_bf16 v[180:183], v[116:119], v[212:215], 0
v_mfma_f32_16x16x16_bf16 v[220:223], v[218:219], v[216:217], v[220:223]
v_mfma_f32_16x16x16_bf16 v[152:155], v[136:137], v[216:217], v[152:155]
v_mfma_f32_16x16x16_bf16 v[156:159], v[138:139], v[216:217], v[156:159]
v_mfma_f32_16x16x16_bf16 v[160:163], v[140:141], v[216:217], v[160:163]
v_mfma_f32_16x16x16_bf16 v[164:167], v[142:143], v[216:217], v[164:167]
v_mfma_f32_16x16x16_bf16 v[168:171], v[144:145], v[216:217], v[168:171]
v_mfma_f32_16x16x16_bf16 v[172:175], v[146:147], v[216:217], v[172:175]
v_mfma_f32_16x16x16_bf16 v[176:179], v[148:149], v[216:217], v[176:179]
v_mfma_f32_16x16x16_bf16 v[180:183], v[150:151], v[216:217], v[180:183]
v_rcp_f32 v220, v220
s_nop 1
v_pk_mul_f32 v[152:153], v[152:153], v[220:221] op_sel_hi:[1,0]
v_pk_mul_f32 v[154:155], v[154:155], v[220:221] op_sel_hi:[1,0]
v_pk_mul_f32 v[156:157], v[156:157], v[220:221] op_sel_hi:[1,0]
v_pk_mul_f32 v[158:159], v[158:159], v[220:221] op_sel_hi:[1,0]
v_pk_mul_f32 v[160:161], v[160:161], v[220:221] op_sel_hi:[1,0]
v_pk_mul_f32 v[162:163], v[162:163], v[220:221] op_sel_hi:[1,0]
v_pk_mul_f32 v[164:165], v[164:165], v[220:221] op_sel_hi:[1,0]
v_pk_mul_f32 v[166:167], v[166:167], v[220:221] op_sel_hi:[1,0]
v_pk_mul_f32 v[168:169], v[168:169], v[220:221] op_sel_hi:[1,0]
v_pk_mul_f32 v[170:171], v[170:171], v[220:221] op_sel_hi:[1,0]
v_pk_mul_f32 v[172:173], v[172:173], v[220:221] op_sel_hi:[1,0]
v_pk_mul_f32 v[174:175], v[174:175], v[220:221] op_sel_hi:[1,0]
v_pk_mul_f32 v[176:177], v[176:177], v[220:221] op_sel_hi:[1,0]
v_pk_mul_f32 v[178:179], v[178:179], v[220:221] op_sel_hi:[1,0]
v_pk_mul_f32 v[180:181], v[180:181], v[220:221] op_sel_hi:[1,0]
v_pk_mul_f32 v[182:183], v[182:183], v[220:221] op_sel_hi:[1,0]
v_cvt_pk_bf16_f32 v184, v152, v153
v_cvt_pk_bf16_f32 v185, v154, v155
v_cvt_pk_bf16_f32 v186, v156, v157
v_cvt_pk_bf16_f32 v187, v158, v159
v_cvt_pk_bf16_f32 v188, v160, v161
v_cvt_pk_bf16_f32 v189, v162, v163
v_cvt_pk_bf16_f32 v190, v164, v165
v_cvt_pk_bf16_f32 v191, v166, v167
v_cvt_pk_bf16_f32 v192, v168, v169
v_cvt_pk_bf16_f32 v193, v170, v171
v_cvt_pk_bf16_f32 v194, v172, v173
v_cvt_pk_bf16_f32 v195, v174, v175
v_cvt_pk_bf16_f32 v196, v176, v177
v_cvt_pk_bf16_f32 v197, v178, v179
v_cvt_pk_bf16_f32 v198, v180, v181
v_cvt_pk_bf16_f32 v199, v182, v183
s_cmp_eq_u32 s96, 1
s_cbranch_scc1 L_x_st_9f
buffer_store_dwordx4 v[184:187], v8, s[84:87], s40 offen sc1
buffer_store_dwordx4 v[188:191], v8, s[84:87], s40 offen offset:2048 sc1
buffer_store_dwordx4 v[192:195], v8, s[84:87], s27 offen sc1
buffer_store_dwordx4 v[196:199], v8, s[84:87], s27 offen offset:2048 sc1
s_branch L_x_st_9d
L_x_st_9f:
buffer_store_dwordx4 v[184:187], v8, s[84:87], s40 offen
buffer_store_dwordx4 v[188:191], v8, s[84:87], s40 offen offset:2048
buffer_store_dwordx4 v[192:195], v8, s[84:87], s27 offen
buffer_store_dwordx4 v[196:199], v8, s[84:87], s27 offen offset:2048
L_x_st_9d:
v_mfma_f32_16x16x32_bf16 v[200:203], v[56:59], v[28:31], 0
v_mfma_f32_16x16x32_bf16 v[204:207], v[60:63], v[28:31], 0
v_mfma_f32_16x16x32_bf16 v[208:211], v[120:123], v[28:31], 0
v_mfma_f32_16x16x32_bf16 v[200:203], v[64:67], v[36:39], v[200:203]
v_mfma_f32_16x16x32_bf16 v[204:207], v[68:71], v[36:39], v[204:207]
v_mfma_f32_16x16x32_bf16 v[208:211], v[124:127], v[36:39], v[208:211]
v_mfma_f32_16x16x32_bf16 v[200:203], v[72:75], v[44:47], v[200:203]
v_mfma_f32_16x16x32_bf16 v[204:207], v[76:79], v[44:47], v[204:207]
v_mfma_f32_16x16x32_bf16 v[208:211], v[128:131], v[44:47], v[208:211]
v_mfma_f32_16x16x32_bf16 v[200:203], v[80:83], v[52:55], v[200:203]
v_mfma_f32_16x16x32_bf16 v[204:207], v[84:87], v[52:55], v[204:207]
v_mfma_f32_16x16x32_bf16 v[208:211], v[132:135], v[52:55], v[208:211]
s_nop 5
v_cmp_gt_i32 vcc, 0, v248
s_nop 1
v_cndmask_b32 v204, v204, v11, vcc
v_cmp_gt_i32 vcc, 1, v248
s_nop 1
v_cndmask_b32 v205, v205, v11, vcc
v_cmp_gt_i32 vcc, 2, v248
s_nop 1
v_cndmask_b32 v206, v206, v11, vcc
v_cmp_gt_i32 vcc, 3, v248
s_nop 1
v_cndmask_b32 v207, v207, v11, vcc
v_max3_f32 v4, v200, v201, v202
v_max3_f32 v4, v4, v203, v204
v_max3_f32 v4, v4, v205, v206
v_max3_f32 v4, v4, v207, v208
v_max_f32 v3, v4, v209
v_max_f32 v4, v4, v209
s_nop 1
v_permlane16_swap_b32 v4, v3
v_max_f32 v4, v4, v3
v_max_f32 v3, v4, v3
s_nop 1
v_permlane32_swap_b32 v4, v3
v_max_f32 v4, v4, v3
v_mul_f32 v4, s24, v4
v_fma_f32 v200, v200, s24, -v4
v_fma_f32 v201, v201, s24, -v4
v_fma_f32 v202, v202, s24, -v4
v_fma_f32 v203, v203, s24, -v4
v_fma_f32 v204, v204, s24, -v4
v_fma_f32 v205, v205, s24, -v4
v_fma_f32 v206, v206, s24, -v4
v_fma_f32 v207, v207, s24, -v4
v_fma_f32 v208, v208, s24, -v4
v_fma_f32 v209, v209, s24, -v4
v_exp_f32 v200, v200
v_exp_f32 v201, v201
v_exp_f32 v202, v202
v_exp_f32 v203, v203
v_exp_f32 v204, v204
v_exp_f32 v205, v205
v_exp_f32 v206, v206
v_exp_f32 v207, v207
v_exp_f32 v208, v208
v_exp_f32 v209, v209
s_nop 0
v_cvt_pk_bf16_f32 v212, v200, v201
v_cvt_pk_bf16_f32 v213, v202, v203
v_cvt_pk_bf16_f32 v214, v204, v205
v_cvt_pk_bf16_f32 v215, v206, v207
v_cvt_pk_bf16_f32 v216, v208, v209
v_cvt_pk_bf16_f32 v217, v208, v209
v_mfma_f32_16x16x32_bf16 v[220:223], v[20:23], v[212:215], 0
v_mfma_f32_16x16x32_bf16 v[152:155], v[88:91], v[212:215], 0
v_mfma_f32_16x16x32_bf16 v[156:159], v[92:95], v[212:215], 0
v_mfma_f32_16x16x32_bf16 v[160:163], v[96:99], v[212:215], 0
v_mfma_f32_16x16x32_bf16 v[164:167], v[100:103], v[212:215], 0
v_mfma_f32_16x16x32_bf16 v[168:171], v[104:107], v[212:215], 0
v_mfma_f32_16x16x32_bf16 v[172:175], v[108:111], v[212:215], 0
v_mfma_f32_16x16x32_bf16 v[176:179], v[112:115], v[212:215], 0
v_mfma_f32_16x16x32_bf16 v[180:183], v[116:119], v[212:215], 0
v_mfma_f32_16x16x16_bf16 v[220:223], v[218:219], v[216:217], v[220:223]
v_mfma_f32_16x16x16_bf16 v[152:155], v[136:137], v[216:217], v[152:155]
v_mfma_f32_16x16x16_bf16 v[156:159], v[138:139], v[216:217], v[156:159]
v_mfma_f32_16x16x16_bf16 v[160:163], v[140:141], v[216:217], v[160:163]
v_mfma_f32_16x16x16_bf16 v[164:167], v[142:143], v[216:217], v[164:167]
v_mfma_f32_16x16x16_bf16 v[168:171], v[144:145], v[216:217], v[168:171]
v_mfma_f32_16x16x16_bf16 v[172:175], v[146:147], v[216:217], v[172:175]
v_mfma_f32_16x16x16_bf16 v[176:179], v[148:149], v[216:217], v[176:179]
v_mfma_f32_16x16x16_bf16 v[180:183], v[150:151], v[216:217], v[180:183]
v_rcp_f32 v220, v220
s_nop 1
v_pk_mul_f32 v[152:153], v[152:153], v[220:221] op_sel_hi:[1,0]
v_pk_mul_f32 v[154:155], v[154:155], v[220:221] op_sel_hi:[1,0]
v_pk_mul_f32 v[156:157], v[156:157], v[220:221] op_sel_hi:[1,0]
v_pk_mul_f32 v[158:159], v[158:159], v[220:221] op_sel_hi:[1,0]
v_pk_mul_f32 v[160:161], v[160:161], v[220:221] op_sel_hi:[1,0]
v_pk_mul_f32 v[162:163], v[162:163], v[220:221] op_sel_hi:[1,0]
v_pk_mul_f32 v[164:165], v[164:165], v[220:221] op_sel_hi:[1,0]
v_pk_mul_f32 v[166:167], v[166:167], v[220:221] op_sel_hi:[1,0]
v_pk_mul_f32 v[168:169], v[168:169], v[220:221] op_sel_hi:[1,0]
v_pk_mul_f32 v[170:171], v[170:171], v[220:221] op_sel_hi:[1,0]
v_pk_mul_f32 v[172:173], v[172:173], v[220:221] op_sel_hi:[1,0]
v_pk_mul_f32 v[174:175], v[174:175], v[220:221] op_sel_hi:[1,0]
v_pk_mul_f32 v[176:177], v[176:177], v[220:221] op_sel_hi:[1,0]
v_pk_mul_f32 v[178:179], v[178:179], v[220:221] op_sel_hi:[1,0]
v_pk_mul_f32 v[180:181], v[180:181], v[220:221] op_sel_hi:[1,0]
v_pk_mul_f32 v[182:183], v[182:183], v[220:221] op_sel_hi:[1,0]
v_cvt_pk_bf16_f32 v184, v152, v153
v_cvt_pk_bf16_f32 v185, v154, v155
v_cvt_pk_bf16_f32 v186, v156, v157
v_cvt_pk_bf16_f32 v187, v158, v159
v_cvt_pk_bf16_f32 v188, v160, v161
v_cvt_pk_bf16_f32 v189, v162, v163
v_cvt_pk_bf16_f32 v190, v164, v165
v_cvt_pk_bf16_f32 v191, v166, v167
v_cvt_pk_bf16_f32 v192, v168, v169
v_cvt_pk_bf16_f32 v193, v170, v171
v_cvt_pk_bf16_f32 v194, v172, v173
v_cvt_pk_bf16_f32 v195, v174, v175
v_cvt_pk_bf16_f32 v196, v176, v177
v_cvt_pk_bf16_f32 v197, v178, v179
v_cvt_pk_bf16_f32 v198, v180, v181
v_cvt_pk_bf16_f32 v199, v182, v183
s_cmp_eq_u32 s96, 1
s_cbranch_scc1 L_x_st_10f
buffer_store_dwordx4 v[184:187], v8, s[84:87], s40 offen offset:256 sc1
buffer_store_dwordx4 v[188:191], v8, s[84:87], s40 offen offset:2304 sc1
buffer_store_dwordx4 v[192:195], v8, s[84:87], s27 offen offset:256 sc1
buffer_store_dwordx4 v[196:199], v8, s[84:87], s27 offen offset:2304 sc1
s_branch L_x_st_10d
L_x_st_10f:
buffer_store_dwordx4 v[184:187], v8, s[84:87], s40 offen offset:256
buffer_store_dwordx4 v[188:191], v8, s[84:87], s40 offen offset:2304
buffer_store_dwordx4 v[192:195], v8, s[84:87], s27 offen offset:256
buffer_store_dwordx4 v[196:199], v8, s[84:87], s27 offen offset:2304
L_x_st_10d:
s_branch L_x_pub
L_x_single:
s_cmp_eq_u32 s51, 1
s_cbranch_scc1 L_x_gqd
L_x_gq:
buffer_load_dword v3, v12, s[84:87], 0 offen sc1
s_waitcnt vmcnt(0)
v_cmp_ne_u32 vcc, 64, v3
s_and_b32 vcc_lo, vcc_lo, 0xc
s_cbranch_scc0 L_x_gqd
s_sleep 8
s_branch L_x_gq
L_x_gqd:
s_mov_b32 s51, 1
s_lshl_b32 s27, s22, 18
s_lshl_b32 s20, s18, 13
s_add_u32 s27, s27, s20
s_add_u32 s29, s27, 178257920
s_and_b32 s20, s16, 1
s_lshl_b32 s20, s20, 10
s_add_u32 s26, s27, s20
s_add_u32 s26, s26, 0
s_lshr_b32 s20, s16, 1
s_lshl_b32 s20, s20, 12
s_add_u32 s28, s27, s20
s_add_u32 s28, s28, 33554432
s_add_u32 s27, s27, 16777216
s_add_u32 s48, s26, 4096
s_add_u32 s49, s27, 4096
buffer_load_dwordx4 v[24:27], v2, s[84:87], s26 offen sc1
buffer_load_dwordx4 v[28:31], v2, s[84:87], s26 offen offset:2048 sc1
buffer_load_dwordx4 v[32:35], v2, s[84:87], s48 offen sc1
buffer_load_dwordx4 v[36:39], v2, s[84:87], s48 offen offset:2048 sc1
buffer_load_dwordx4 v[56:59], v2, s[84:87], s27 offen sc1
buffer_load_dwordx4 v[60:63], v2, s[84:87], s27 offen offset:1024 sc1
buffer_load_dwordx4 v[64:67], v2, s[84:87], s27 offen offset:2048 sc1
buffer_load_dwordx4 v[68:71], v2, s[84:87], s27 offen offset:3072 sc1
buffer_load_dwordx4 v[72:75], v2, s[84:87], s49 offen sc1
buffer_load_dwordx4 v[76:79], v2, s[84:87], s49 offen offset:1024 sc1
buffer_load_dwordx4 v[80:83], v2, s[84:87], s49 offen offset:2048 sc1
buffer_load_dwordx4 v[84:87], v2, s[84:87], s49 offen offset:3072 sc1
buffer_load_dwordx4 v[88:91], v2, s[84:87], s28 offen sc1
buffer_load_dwordx4 v[92:95], v2, s[84:87], s28 offen offset:1024 sc1
buffer_load_dwordx4 v[96:99], v2, s[84:87], s28 offen offset:2048 sc1
buffer_load_dwordx4 v[100:103], v2, s[84:87], s28 offen offset:3072 sc1
L_x_satt:
s_lshl_b32 s40, s17, 3
s_add_u32 s40, s40, s47
s_lshl_b32 s40, s40, 18
s_add_u32 s40, s40, 50331648
s_lshl_b32 s20, s18, 13
s_add_u32 s40, s40, s20
v_mov_b32 v218, v20
v_mov_b32 v219, 0
s_lshr_b32 s20, s16, 1
s_lshl_b32 s21, s20, 12
s_add_u32 s40, s40, s21
s_lshl_b32 s20, s20, 10
s_add_u32 s28, s29, s20
s_add_u32 s28, s28, 2048
s_and_b32 s20, s16, 1
s_lshl_b32 s20, s20, 8
s_add_u32 s40, s40, s20
s_mov_b32 s8, 1
s_waitcnt vmcnt(0)
v_mfma_f32_16x16x32_bf16 v[200:203], v[56:59], v[24:27], 0
v_mfma_f32_16x16x32_bf16 v[204:207], v[60:63], v[24:27], 0
v_mfma_f32_16x16x32_bf16 v[200:203], v[64:67], v[28:31], v[200:203]
v_mfma_f32_16x16x32_bf16 v[204:207], v[68:71], v[28:31], v[204:207]
v_mfma_f32_16x16x32_bf16 v[200:203], v[72:75], v[32:35], v[200:203]
v_mfma_f32_16x16x32_bf16 v[204:207], v[76:79], v[32:35], v[204:207]
v_mfma_f32_16x16x32_bf16 v[200:203], v[80:83], v[36:39], v[200:203]
v_mfma_f32_16x16x32_bf16 v[204:207], v[84:87], v[36:39], v[204:207]
s_nop 5
v_cmp_gt_i32 vcc, 0, v9
s_nop 1
v_cndmask_b32 v200, v200, v11, vcc
v_cmp_gt_i32 vcc, 1, v9
s_nop 1
v_cndmask_b32 v201, v201, v11, vcc
v_cmp_gt_i32 vcc, 2, v9
s_nop 1
v_cndmask_b32 v202, v202, v11, vcc
v_cmp_gt_i32 vcc, 3, v9
s_nop 1
v_cndmask_b32 v203, v203, v11, vcc
v_cmp_gt_i32 vcc, 0, v10
s_nop 1
v_cndmask_b32 v204, v204, v11, vcc
v_cmp_gt_i32 vcc, 1, v10
s_nop 1
v_cndmask_b32 v205, v205, v11, vcc
v_cmp_gt_i32 vcc, 2, v10
s_nop 1
v_cndmask_b32 v206, v206, v11, vcc
v_cmp_gt_i32 vcc, 3, v10
s_nop 1
v_cndmask_b32 v207, v207, v11, vcc
s_cmp_ge_u32 s22, 63
s_cbranch_scc1 L_x_dx
L_x_rp:
buffer_load_dword v3, v13, s[84:87], 0 offen sc1
s_waitcnt vmcnt(0)
v_cmp_ge_u32 vcc, s22, v3
s_cbranch_vccz L_x_rk
s_sleep 2
s_branch L_x_rp
L_x_rk:
buffer_load_dwordx4 v[120:123], v6, s[84:87], s29 offen sc1
buffer_load_dwordx4 v[124:127], v6, s[84:87], s29 offen offset:64 sc1
buffer_load_dwordx4 v[128:131], v6, s[84:87], s29 offen offset:128 sc1
buffer_load_dwordx4 v[132:135], v6, s[84:87], s29 offen offset:192 sc1
buffer_load_dwordx2 v[136:137], v7, s[84:87], s28 offen sc1
buffer_load_dwordx2 v[138:139], v7, s[84:87], s28 offen offset:2048 sc1
buffer_load_dwordx2 v[140:141], v7, s[84:87], s28 offen offset:512 sc1
buffer_load_dwordx2 v[142:143], v7, s[84:87], s28 offen offset:2560 sc1
L_x_rd:
s_waitcnt vmcnt(7)
v_mfma_f32_16x16x32_bf16 v[208:211], v[120:123], v[24:27], 0
s_waitcnt vmcnt(6)
v_mfma_f32_16x16x32_bf16 v[208:211], v[124:127], v[28:31], v[208:211]
s_waitcnt vmcnt(5)
v_mfma_f32_16x16x32_bf16 v[208:211], v[128:131], v[32:35], v[208:211]
s_waitcnt vmcnt(4)
v_mfma_f32_16x16x32_bf16 v[208:211], v[132:135], v[36:39], v[208:211]
s_waitcnt vmcnt(0)
v_swap_b32 v137, v138
v_swap_b32 v141, v142
s_nop 1
v_max3_f32 v4, v200, v201, v202
v_max3_f32 v4, v4, v203, v204
v_max3_f32 v4, v4, v205, v206
v_max3_f32 v4, v4, v207, v208
v_max_f32 v3, v4, v209
v_max_f32 v4, v4, v209
s_nop 1
v_permlane16_swap_b32 v4, v3
v_max_f32 v4, v4, v3
v_max_f32 v3, v4, v3
s_nop 1
v_permlane32_swap_b32 v4, v3
v_max_f32 v4, v4, v3
v_mul_f32 v4, s24, v4
v_fma_f32 v200, v200, s24, -v4
v_fma_f32 v201, v201, s24, -v4
v_fma_f32 v202, v202, s24, -v4
v_fma_f32 v203, v203, s24, -v4
v_fma_f32 v204, v204, s24, -v4
v_fma_f32 v205, v205, s24, -v4
v_fma_f32 v206, v206, s24, -v4
v_fma_f32 v207, v207, s24, -v4
v_fma_f32 v208, v208, s24, -v4
v_fma_f32 v209, v209, s24, -v4
v_exp_f32 v200, v200
v_exp_f32 v201, v201
v_exp_f32 v202, v202
v_exp_f32 v203, v203
v_exp_f32 v204, v204
v_exp_f32 v205, v205
v_exp_f32 v206, v206
v_exp_f32 v207, v207
v_exp_f32 v208, v208
v_exp_f32 v209, v209
s_nop 0
v_cvt_pk_bf16_f32 v212, v200, v201
v_cvt_pk_bf16_f32 v213, v202, v203
v_cvt_pk_bf16_f32 v214, v204, v205
v_cvt_pk_bf16_f32 v215, v206, v207
v_cvt_pk_bf16_f32 v216, v208, v209
v_cvt_pk_bf16_f32 v217, v208, v209
v_mfma_f32_16x16x32_bf16 v[220:223], v[20:23], v[212:215], 0
v_mfma_f32_16x16x32_bf16 v[152:155], v[88:91], v[212:215], 0
v_mfma_f32_16x16x32_bf16 v[156:159], v[92:95], v[212:215], 0
v_mfma_f32_16x16x32_bf16 v[160:163], v[96:99], v[212:215], 0
v_mfma_f32_16x16x32_bf16 v[164:167], v[100:103], v[212:215], 0
s_nop 1
v_mfma_f32_16x16x16_bf16 v[220:223], v[218:219], v[216:217], v[220:223]
v_mfma_f32_16x16x16_bf16 v[152:155], v[136:137], v[216:217], v[152:155]
v_mfma_f32_16x16x16_bf16 v[156:159], v[138:139], v[216:217], v[156:159]
v_mfma_f32_16x16x16_bf16 v[160:163], v[140:141], v[216:217], v[160:163]
v_mfma_f32_16x16x16_bf16 v[164:167], v[142:143], v[216:217], v[164:167]
s_nop 3
v_rcp_f32 v220, v220
s_nop 1
v_pk_mul_f32 v[152:153], v[152:153], v[220:221] op_sel_hi:[1,0]
v_pk_mul_f32 v[154:155], v[154:155], v[220:221] op_sel_hi:[1,0]
v_pk_mul_f32 v[156:157], v[156:157], v[220:221] op_sel_hi:[1,0]
v_pk_mul_f32 v[158:159], v[158:159], v[220:221] op_sel_hi:[1,0]
v_pk_mul_f32 v[160:161], v[160:161], v[220:221] op_sel_hi:[1,0]
v_pk_mul_f32 v[162:163], v[162:163], v[220:221] op_sel_hi:[1,0]
v_pk_mul_f32 v[164:165], v[164:165], v[220:221] op_sel_hi:[1,0]
v_pk_mul_f32 v[166:167], v[166:167], v[220:221] op_sel_hi:[1,0]
v_cvt_pk_bf16_f32 v184, v152, v153
v_cvt_pk_bf16_f32 v185, v154, v155
v_cvt_pk_bf16_f32 v186, v156, v157
v_cvt_pk_bf16_f32 v187, v158, v159
v_cvt_pk_bf16_f32 v188, v160, v161
v_cvt_pk_bf16_f32 v189, v162, v163
v_cvt_pk_bf16_f32 v190, v164, v165
v_cvt_pk_bf16_f32 v191, v166, v167
s_cmp_eq_u32 s96, 1
s_cbranch_scc1 L_x_st_11f
buffer_store_dwordx4 v[184:187], v8, s[84:87], s40 offen sc1
buffer_store_dwordx4 v[188:191], v8, s[84:87], s40 offen offset:2048 sc1
s_branch L_x_st_11d
L_x_st_11f:
buffer_store_dwordx4 v[184:187], v8, s[84:87], s40 offen
buffer_store_dwordx4 v[188:191], v8, s[84:87], s40 offen offset:2048
L_x_st_11d:
L_x_pub:
s_add_u32 s45, s22, s8
v_mov_b32 v4, s45
s_waitcnt vmcnt(0)
s_barrier
s_cmp_eq_u32 s96, 1
s_cbranch_scc1 L_x_st_12f
buffer_store_dword v4, v15, s[84:87], 0 offen sc1
s_branch L_x_st_12d
L_x_st_12f:
buffer_store_dword v4, v15, s[84:87], 0 offen
L_x_st_12d:
s_lshl_b32 s41, s17, 3
s_add_u32 s41, s41, s47
s_lshl_b32 s41, s41, 3
s_and_b32 s20, s18, 1
s_lshl_b32 s20, s20, 2
s_add_u32 s41, s41, s20
s_add_u32 s41, s41, s16
s_lshl_b32 s41, s41, 15
s_add_u32 s41, s41, 50331648
s_lshl_b32 s10, s92, 3
s_add_u32 s10, s10, s47
s_lshl_b32 s10, s10, 12
s_add_u32 s10, s10, 75497472
s_xor_b32 s9, s10, 32768
s_lshl_b32 s42, s22, 17
s_xor_b32 s47, s47, 4
s_bitset0_b64 s[60:61], s22
s_ff1_i32_b64 s22, s[60:61]
s_min_u32 s22, s22, 64
s_add_u32 s43, s22, s16
s_lshl_b32 s26, s43, 18
s_lshl_b32 s20, s18, 13
s_add_u32 s26, s26, s20
s_lshr_b32 s20, s43, 1
s_add_u32 s20, s20, 32
v_mov_b32 v250, s43
v_mov_b32 v3, s20
s_mov_b32 vcc_lo, 0xcccccccc
s_mov_b32 vcc_hi, 0xcccccccc
v_cndmask_b32 v250, v250, v3, vcc
s_cmp_ge_u32 s22, 64
s_cbranch_scc1 L_x_xp
buffer_load_dword v5, v249, s[84:87], 0 offen sc1
buffer_load_dword v4, v12, s[84:87], 0 offen sc1
L_x_xp:
buffer_load_dword v3, v14, s[84:87], 0 offen sc1
s_waitcnt vmcnt(0)
v_cmp_gt_u32 vcc, s45, v3
s_cbranch_vccnz L_x_xp
v_cmp_ne_u32 vcc, 64, v4
s_and_b32 vcc_lo, vcc_lo, 0xc
s_cselect_b32 s51, s51, 1
v_cmp_ge_u32 vcc, v250, v5
s_cmp_eq_u64 vcc, 0
s_cselect_b32 s46, 1, 0
s_cmp_lt_u32 s22, 56
s_cselect_b32 s46, s46, 0
s_cmp_eq_u32 s46, 1
s_cselect_b32 s26, s26, 0x80000000
s_cmp_eq_u32 s8, 1
s_cbranch_scc1 L_x_f1
s_add_u32 s20, s50, 0
s_and_b32 s20, s20, 0x7fff
s_add_u32 s20, s20, s41
buffer_load_dwordx4 v[152:155], v2, s[84:87], s20 offen sc1
buffer_load_dwordx4 v[156:159], v2, s[84:87], s20 offen offset:1024 sc1
buffer_load_dwordx4 v[160:163], v2, s[84:87], s20 offen offset:2048 sc1
buffer_load_dwordx4 v[164:167], v2, s[84:87], s20 offen offset:3072 sc1
s_add_u32 s20, s50, 4096
s_and_b32 s20, s20, 0x7fff
s_add_u32 s20, s20, s41
buffer_load_dwordx4 v[168:171], v2, s[84:87], s20 offen sc1
buffer_load_dwordx4 v[172:175], v2, s[84:87], s20 offen offset:1024 sc1
buffer_load_dwordx4 v[176:179], v2, s[84:87], s20 offen offset:2048 sc1
buffer_load_dwordx4 v[180:183], v2, s[84:87], s20 offen offset:3072 sc1
s_add_u32 s20, s50, 8192
s_and_b32 s20, s20, 0x7fff
s_add_u32 s20, s20, s41
buffer_load_dwordx4 v[184:187], v2, s[84:87], s20 offen sc1
buffer_load_dwordx4 v[188:191], v2, s[84:87], s20 offen offset:1024 sc1
s_waitcnt vmcnt(9)
v_mfma_f32_32x32x16_bf16 v[200:215], a[0:3], v[152:155], 0
v_mfma_f32_32x32x16_bf16 v[216:231], a[4:7], v[152:155], 0
buffer_load_dwordx4 v[192:195], v2, s[84:87], s20 offen offset:2048 sc1
s_waitcnt vmcnt(9)
v_mfma_f32_32x32x16_bf16 v[200:215], a[8:11], v[156:159], v[200:215]
v_mfma_f32_32x32x16_bf16 v[216:231], a[12:15], v[156:159], v[216:231]
buffer_load_dwordx4 v[196:199], v2, s[84:87], s20 offen offset:3072 sc1
s_add_u32 s21, s26, 0
buffer_load_dwordx4 v[24:27], v2, s[84:87], s21 offen sc1
s_waitcnt vmcnt(10)
v_mfma_f32_32x32x16_bf16 v[200:215], a[16:19], v[160:163], v[200:215]
v_mfma_f32_32x32x16_bf16 v[216:231], a[20:23], v[160:163], v[216:231]
s_add_u32 s20, s50, 12288
s_and_b32 s20, s20, 0x7fff
s_add_u32 s20, s20, s41
buffer_load_dwordx4 v[152:155], v2, s[84:87], s20 offen sc1
s_waitcnt vmcnt(10)
v_mfma_f32_32x32x16_bf16 v[200:215], a[24:27], v[164:167], v[200:215]
v_mfma_f32_32x32x16_bf16 v[216:231], a[28:31], v[164:167], v[216:231]
buffer_load_dwordx4 v[156:159], v2, s[84:87], s20 offen offset:1024 sc1
s_waitcnt vmcnt(10)
v_mfma_f32_32x32x16_bf16 v[200:215], a[32:35], v[168:171], v[200:215]
v_mfma_f32_32x32x16_bf16 v[216:231], a[36:39], v[168:171], v[216:231]
buffer_load_dwordx4 v[160:163], v2, s[84:87], s20 offen offset:2048 sc1
buffer_load_dwordx4 v[28:31], v2, s[84:87], s21 offen offset:1024 sc1
s_waitcnt vmcnt(11)
v_mfma_f32_32x32x16_bf16 v[200:215], a[40:43], v[172:175], v[200:215]
v_mfma_f32_32x32x16_bf16 v[216:231], a[44:47], v[172:175], v[216:231]
buffer_load_dwordx4 v[164:167], v2, s[84:87], s20 offen offset:3072 sc1
s_waitcnt vmcnt(11)
v_mfma_f32_32x32x16_bf16 v[200:215], a[48:51], v[176:179], v[200:215]
v_mfma_f32_32x32x16_bf16 v[216:231], a[52:55], v[176:179], v[216:231]
s_add_u32 s20, s50, 16384
s_and_b32 s20, s20, 0x7fff
s_add_u32 s20, s20, s41
buffer_load_dwordx4 v[168:171], v2, s[84:87], s20 offen sc1
s_waitcnt vmcnt(11)
v_mfma_f32_32x32x16_bf16 v[200:215], a[56:59], v[180:183], v[200:215]
v_mfma_f32_32x32x16_bf16 v[216:231], a[60:63], v[180:183], v[216:231]
buffer_load_dwordx4 v[172:175], v2, s[84:87], s20 offen offset:1024 sc1
buffer_load_dwordx4 v[32:35], v2, s[84:87], s21 offen offset:2048 sc1
s_waitcnt vmcnt(12)
v_mfma_f32_32x32x16_bf16 v[200:215], a[64:67], v[184:187], v[200:215]
v_mfma_f32_32x32x16_bf16 v[216:231], a[68:71], v[184:187], v[216:231]
buffer_load_dwordx4 v[176:179], v2, s[84:87], s20 offen offset:2048 sc1
s_waitcnt vmcnt(12)
v_mfma_f32_32x32x16_bf16 v[200:215], a[72:75], v[188:191], v[200:215]
v_mfma_f32_32x32x16_bf16 v[216:231], a[76:79], v[188:191], v[216:231]
buffer_load_dwordx4 v[180:183], v2, s[84:87], s20 offen offset:3072 sc1
s_waitcnt vmcnt(12)
v_mfma_f32_32x32x16_bf16 v[200:215], a[80:83], v[192:195], v[200:215]
v_mfma_f32_32x32x16_bf16 v[216:231], a[84:87], v[192:195], v[216:231]
s_add_u32 s20, s50, 20480
s_and_b32 s20, s20, 0x7fff
s_add_u32 s20, s20, s41
buffer_load_dwordx4 v[184:187], v2, s[84:87], s20 offen sc1
buffer_load_dwordx4 v[36:39], v2, s[84:87], s21 offen offset:3072 sc1
s_waitcnt vmcnt(13)
v_mfma_f32_32x32x16_bf16 v[200:215], a[88:91], v[196:199], v[200:215]
v_mfma_f32_32x32x16_bf16 v[216:231], a[92:95], v[196:199], v[216:231]
buffer_load_dwordx4 v[188:191], v2, s[84:87], s20 offen offset:1024 sc1
s_waitcnt vmcnt(12)
v_mfma_f32_32x32x16_bf16 v[200:215], a[96:99], v[152:155], v[200:215]
v_mfma_f32_32x32x16_bf16 v[216:231], a[100:103], v[152:155], v[216:231]
buffer_load_dwordx4 v[192:195], v2, s[84:87], s20 offen offset:2048 sc1
s_waitcnt vmcnt(12)
v_mfma_f32_32x32x16_bf16 v[200:215], a[104:107], v[156:159], v[200:215]
v_mfma_f32_32x32x16_bf16 v[216:231], a[108:111], v[156:159], v[216:231]
buffer_load_dwordx4 v[196:199], v2, s[84:87], s20 offen offset:3072 sc1
s_add_u32 s21, s26, 4096
buffer_load_dwordx4 v[40:43], v2, s[84:87], s21 offen sc1
s_waitcnt vmcnt(13)
v_mfma_f32_32x32x16_bf16 v[200:215], a[112:115], v[160:163], v[200:215]
v_mfma_f32_32x32x16_bf16 v[216:231], a[116:119], v[160:163], v[216:231]
s_add_u32 s20, s50, 24576
s_and_b32 s20, s20, 0x7fff
s_add_u32 s20, s20, s41
buffer_load_dwordx4 v[152:155], v2, s[84:87], s20 offen sc1
s_waitcnt vmcnt(12)
v_mfma_f32_32x32x16_bf16 v[200:215], a[120:123], v[164:167], v[200:215]
v_mfma_f32_32x32x16_bf16 v[216:231], a[124:127], v[164:167], v[216:231]
buffer_load_dwordx4 v[156:159], v2, s[84:87], s20 offen offset:1024 sc1
s_waitcnt vmcnt(12)
v_mfma_f32_32x32x16_bf16 v[200:215], a[128:131], v[168:171], v[200:215]
v_mfma_f32_32x32x16_bf16 v[216:231], a[132:135], v[168:171], v[216:231]
buffer_load_dwordx4 v[160:163], v2, s[84:87], s20 offen offset:2048 sc1
buffer_load_dwordx4 v[44:47], v2, s[84:87], s21 offen offset:1024 sc1
s_waitcnt vmcnt(13)
v_mfma_f32_32x32x16_bf16 v[200:215], a[136:139], v[172:175], v[200:215]
v_mfma_f32_32x32x16_bf16 v[216:231], a[140:143], v[172:175], v[216:231]
buffer_load_dwordx4 v[164:167], v2, s[84:87], s20 offen offset:3072 sc1
s_waitcnt vmcnt(12)
v_mfma_f32_32x32x16_bf16 v[200:215], a[144:147], v[176:179], v[200:215]
v_mfma_f32_32x32x16_bf16 v[216:231], a[148:151], v[176:179], v[216:231]
s_add_u32 s20, s50, 28672
s_and_b32 s20, s20, 0x7fff
s_add_u32 s20, s20, s41
buffer_load_dwordx4 v[168:171], v2, s[84:87], s20 offen sc1
s_waitcnt vmcnt(12)
v_mfma_f32_32x32x16_bf16 v[200:215], a[152:155], v[180:183], v[200:215]
v_mfma_f32_32x32x16_bf16 v[216:231], a[156:159], v[180:183], v[216:231]
buffer_load_dwordx4 v[172:175], v2, s[84:87], s20 offen offset:1024 sc1
buffer_load_dwordx4 v[48:51], v2, s[84:87], s21 offen offset:2048 sc1
s_waitcnt vmcnt(13)
v_mfma_f32_32x32x16_bf16 v[200:215], a[160:163], v[184:187], v[200:215]
v_mfma_f32_32x32x16_bf16 v[216:231], a[164:167], v[184:187], v[216:231]
buffer_load_dwordx4 v[176:179], v2, s[84:87], s20 offen offset:2048 sc1
s_waitcnt vmcnt(12)
v_mfma_f32_32x32x16_bf16 v[200:215], a[168:171], v[188:191], v[200:215]
v_mfma_f32_32x32x16_bf16 v[216:231], a[172:175], v[188:191], v[216:231]
buffer_load_dwordx4 v[180:183], v2, s[84:87], s20 offen offset:3072 sc1
s_waitcnt vmcnt(12)
v_mfma_f32_32x32x16_bf16 v[200:215], a[176:179], v[192:195], v[200:215]
v_mfma_f32_32x32x16_bf16 v[216:231], a[180:183], v[192:195], v[216:231]
s_add_u32 s41, s41, 262144
s_add_u32 s20, s50, 0
s_and_b32 s20, s20, 0x7fff
s_add_u32 s20, s20, s41
buffer_load_dwordx4 v[184:187], v2, s[84:87], s20 offen sc1
buffer_load_dwordx4 v[52:55], v2, s[84:87], s21 offen offset:3072 sc1
s_waitcnt vmcnt(13)
v_mfma_f32_32x32x16_bf16 v[200:215], a[184:187], v[196:199], v[200:215]
v_mfma_f32_32x32x16_bf16 v[216:231], a[188:191], v[196:199], v[216:231]
buffer_load_dwordx4 v[188:191], v2, s[84:87], s20 offen offset:1024 sc1
s_waitcnt vmcnt(12)
v_mfma_f32_32x32x16_bf16 v[200:215], a[192:195], v[152:155], v[200:215]
v_mfma_f32_32x32x16_bf16 v[216:231], a[196:199], v[152:155], v[216:231]
buffer_load_dwordx4 v[192:195], v2, s[84:87], s20 offen offset:2048 sc1
s_waitcnt vmcnt(12)
v_mfma_f32_32x32x16_bf16 v[200:215], a[200:203], v[156:159], v[200:215]
v_mfma_f32_32x32x16_bf16 v[216:231], a[204:207], v[156:159], v[216:231]
buffer_load_dwordx4 v[196:199], v2, s[84:87], s20 offen offset:3072 sc1
s_add_u32 s21, s26, 16777216
buffer_load_dwordx4 v[56:59], v2, s[84:87], s21 offen sc1
s_waitcnt vmcnt(13)
v_mfma_f32_32x32x16_bf16 v[200:215], a[208:211], v[160:163], v[200:215]
v_mfma_f32_32x32x16_bf16 v[216:231], a[212:215], v[160:163], v[216:231]
s_add_u32 s20, s50, 4096
s_and_b32 s20, s20, 0x7fff
s_add_u32 s20, s20, s41
buffer_load_dwordx4 v[152:155], v2, s[84:87], s20 offen sc1
s_waitcnt vmcnt(12)
v_mfma_f32_32x32x16_bf16 v[200:215], a[216:219], v[164:167], v[200:215]
v_mfma_f32_32x32x16_bf16 v[216:231], a[220:223], v[164:167], v[216:231]
buffer_load_dwordx4 v[156:159], v2, s[84:87], s20 offen offset:1024 sc1
s_waitcnt vmcnt(12)
v_mfma_f32_32x32x16_bf16 v[200:215], a[224:227], v[168:171], v[200:215]
v_mfma_f32_32x32x16_bf16 v[216:231], a[228:231], v[168:171], v[216:231]
buffer_load_dwordx4 v[160:163], v2, s[84:87], s20 offen offset:2048 sc1
buffer_load_dwordx4 v[60:63], v2, s[84:87], s21 offen offset:1024 sc1
s_waitcnt vmcnt(13)
v_mfma_f32_32x32x16_bf16 v[200:215], a[232:235], v[172:175], v[200:215]
v_mfma_f32_32x32x16_bf16 v[216:231], a[236:239], v[172:175], v[216:231]
buffer_load_dwordx4 v[164:167], v2, s[84:87], s20 offen offset:3072 sc1
s_waitcnt vmcnt(12)
v_mfma_f32_32x32x16_bf16 v[200:215], a[240:243], v[176:179], v[200:215]
v_mfma_f32_32x32x16_bf16 v[216:231], a[244:247], v[176:179], v[216:231]
s_add_u32 s20, s50, 8192
s_and_b32 s20, s20, 0x7fff
s_add_u32 s20, s20, s41
buffer_load_dwordx4 v[168:171], v2, s[84:87], s20 offen sc1
s_waitcnt vmcnt(12)
v_mfma_f32_32x32x16_bf16 v[200:215], a[248:251], v[180:183], v[200:215]
v_mfma_f32_32x32x16_bf16 v[216:231], a[252:255], v[180:183], v[216:231]
buffer_load_dwordx4 v[172:175], v2, s[84:87], s20 offen offset:1024 sc1
buffer_load_dwordx4 v[64:67], v2, s[84:87], s21 offen offset:2048 sc1
s_nop 11
ds_write_b128 v17, v[200:203]
ds_write_b128 v17, v[204:207] offset:1088
ds_write_b128 v17, v[208:211] offset:2176
ds_write_b128 v17, v[212:215] offset:3264
ds_write_b128 v17, v[216:219] offset:4352
ds_write_b128 v17, v[220:223] offset:5440
ds_write_b128 v17, v[224:227] offset:6528
ds_write_b128 v17, v[228:231] offset:7616
s_waitcnt vmcnt(13)
s_waitcnt lgkmcnt(0)
v_mfma_f32_32x32x16_bf16 v[200:215], a[0:3], v[184:187], 0
v_mfma_f32_32x32x16_bf16 v[216:231], a[4:7], v[184:187], 0
buffer_load_dwordx4 v[176:179], v2, s[84:87], s20 offen offset:2048 sc1
s_waitcnt vmcnt(12)
v_mfma_f32_32x32x16_bf16 v[200:215], a[8:11], v[188:191], v[200:215]
v_mfma_f32_32x32x16_bf16 v[216:231], a[12:15], v[188:191], v[216:231]
buffer_load_dwordx4 v[180:183], v2, s[84:87], s20 offen offset:3072 sc1
s_waitcnt vmcnt(12)
v_mfma_f32_32x32x16_bf16 v[200:215], a[16:19], v[192:195], v[200:215]
v_mfma_f32_32x32x16_bf16 v[216:231], a[20:23], v[192:195], v[216:231]
s_add_u32 s20, s50, 12288
s_and_b32 s20, s20, 0x7fff
s_add_u32 s20, s20, s41
buffer_load_dwordx4 v[184:187], v2, s[84:87], s20 offen sc1
buffer_load_dwordx4 v[68:71], v2, s[84:87], s21 offen offset:3072 sc1
s_waitcnt vmcnt(13)
v_mfma_f32_32x32x16_bf16 v[200:215], a[24:27], v[196:199], v[200:215]
v_mfma_f32_32x32x16_bf16 v[216:231], a[28:31], v[196:199], v[216:231]
buffer_load_dwordx4 v[188:191], v2, s[84:87], s20 offen offset:1024 sc1
s_waitcnt vmcnt(12)
v_mfma_f32_32x32x16_bf16 v[200:215], a[32:35], v[152:155], v[200:215]
v_mfma_f32_32x32x16_bf16 v[216:231], a[36:39], v[152:155], v[216:231]
buffer_load_dwordx4 v[192:195], v2, s[84:87], s20 offen offset:2048 sc1
s_waitcnt vmcnt(12)
v_mfma_f32_32x32x16_bf16 v[200:215], a[40:43], v[156:159], v[200:215]
v_mfma_f32_32x32x16_bf16 v[216:231], a[44:47], v[156:159], v[216:231]
buffer_load_dwordx4 v[196:199], v2, s[84:87], s20 offen offset:3072 sc1
s_add_u32 s21, s26, 16781312
buffer_load_dwordx4 v[72:75], v2, s[84:87], s21 offen sc1
s_waitcnt vmcnt(13)
v_mfma_f32_32x32x16_bf16 v[200:215], a[48:51], v[160:163], v[200:215]
v_mfma_f32_32x32x16_bf16 v[216:231], a[52:55], v[160:163], v[216:231]
s_add_u32 s20, s50, 16384
s_and_b32 s20, s20, 0x7fff
s_add_u32 s20, s20, s41
buffer_load_dwordx4 v[152:155], v2, s[84:87], s20 offen sc1
s_waitcnt vmcnt(12)
v_mfma_f32_32x32x16_bf16 v[200:215], a[56:59], v[164:167], v[200:215]
v_mfma_f32_32x32x16_bf16 v[216:231], a[60:63], v[164:167], v[216:231]
buffer_load_dwordx4 v[156:159], v2, s[84:87], s20 offen offset:1024 sc1
s_waitcnt vmcnt(12)
v_mfma_f32_32x32x16_bf16 v[200:215], a[64:67], v[168:171], v[200:215]
v_mfma_f32_32x32x16_bf16 v[216:231], a[68:71], v[168:171], v[216:231]
buffer_load_dwordx4 v[160:163], v2, s[84:87], s20 offen offset:2048 sc1
buffer_load_dwordx4 v[76:79], v2, s[84:87], s21 offen offset:1024 sc1
s_waitcnt vmcnt(13)
v_mfma_f32_32x32x16_bf16 v[200:215], a[72:75], v[172:175], v[200:215]
v_mfma_f32_32x32x16_bf16 v[216:231], a[76:79], v[172:175], v[216:231]
buffer_load_dwordx4 v[164:167], v2, s[84:87], s20 offen offset:3072 sc1
s_waitcnt vmcnt(12)
v_mfma_f32_32x32x16_bf16 v[200:215], a[80:83], v[176:179], v[200:215]
v_mfma_f32_32x32x16_bf16 v[216:231], a[84:87], v[176:179], v[216:231]
s_add_u32 s20, s50, 20480
s_and_b32 s20, s20, 0x7fff
s_add_u32 s20, s20, s41
buffer_load_dwordx4 v[168:171], v2, s[84:87], s20 offen sc1
s_waitcnt vmcnt(12)
v_mfma_f32_32x32x16_bf16 v[200:215], a[88:91], v[180:183], v[200:215]
v_mfma_f32_32x32x16_bf16 v[216:231], a[92:95], v[180:183], v[216:231]
buffer_load_dwordx4 v[172:175], v2, s[84:87], s20 offen offset:1024 sc1
buffer_load_dwordx4 v[80:83], v2, s[84:87], s21 offen offset:2048 sc1
s_waitcnt vmcnt(13)
v_mfma_f32_32x32x16_bf16 v[200:215], a[96:99], v[184:187], v[200:215]
v_mfma_f32_32x32x16_bf16 v[216:231], a[100:103], v[184:187], v[216:231]
buffer_load_dwordx4 v[176:179], v2, s[84:87], s20 offen offset:2048 sc1
s_waitcnt vmcnt(12)
v_mfma_f32_32x32x16_bf16 v[200:215], a[104:107], v[188:191], v[200:215]
v_mfma_f32_32x32x16_bf16 v[216:231], a[108:111], v[188:191], v[216:231]
buffer_load_dwordx4 v[180:183], v2, s[84:87], s20 offen offset:3072 sc1
s_waitcnt vmcnt(12)
v_mfma_f32_32x32x16_bf16 v[200:215], a[112:115], v[192:195], v[200:215]
v_mfma_f32_32x32x16_bf16 v[216:231], a[116:119], v[192:195], v[216:231]
s_add_u32 s20, s50, 24576
s_and_b32 s20, s20, 0x7fff
s_add_u32 s20, s20, s41
buffer_load_dwordx4 v[184:187], v2, s[84:87], s20 offen sc1
buffer_load_dwordx4 v[84:87], v2, s[84:87], s21 offen offset:3072 sc1
s_waitcnt vmcnt(13)
v_mfma_f32_32x32x16_bf16 v[200:215], a[120:123], v[196:199], v[200:215]
v_mfma_f32_32x32x16_bf16 v[216:231], a[124:127], v[196:199], v[216:231]
buffer_load_dwordx4 v[188:191], v2, s[84:87], s20 offen offset:1024 sc1
s_waitcnt vmcnt(12)
v_mfma_f32_32x32x16_bf16 v[200:215], a[128:131], v[152:155], v[200:215]
v_mfma_f32_32x32x16_bf16 v[216:231], a[132:135], v[152:155], v[216:231]
buffer_load_dwordx4 v[192:195], v2, s[84:87], s20 offen offset:2048 sc1
s_waitcnt vmcnt(12)
v_mfma_f32_32x32x16_bf16 v[200:215], a[136:139], v[156:159], v[200:215]
v_mfma_f32_32x32x16_bf16 v[216:231], a[140:143], v[156:159], v[216:231]
buffer_load_dwordx4 v[196:199], v2, s[84:87], s20 offen offset:3072 sc1
s_add_u32 s21, s26, 33554432
buffer_load_dwordx4 v[88:91], v2, s[84:87], s21 offen sc1
s_waitcnt vmcnt(13)
v_mfma_f32_32x32x16_bf16 v[200:215], a[144:147], v[160:163], v[200:215]
v_mfma_f32_32x32x16_bf16 v[216:231], a[148:151], v[160:163], v[216:231]
s_add_u32 s20, s50, 28672
s_and_b32 s20, s20, 0x7fff
s_add_u32 s20, s20, s41
buffer_load_dwordx4 v[152:155], v2, s[84:87], s20 offen sc1
s_waitcnt vmcnt(12)
v_mfma_f32_32x32x16_bf16 v[200:215], a[152:155], v[164:167], v[200:215]
v_mfma_f32_32x32x16_bf16 v[216:231], a[156:159], v[164:167], v[216:231]
buffer_load_dwordx4 v[156:159], v2, s[84:87], s20 offen offset:1024 sc1
s_waitcnt vmcnt(12)
v_mfma_f32_32x32x16_bf16 v[200:215], a[160:163], v[168:171], v[200:215]
v_mfma_f32_32x32x16_bf16 v[216:231], a[164:167], v[168:171], v[216:231]
buffer_load_dwordx4 v[160:163], v2, s[84:87], s20 offen offset:2048 sc1
buffer_load_dwordx4 v[92:95], v2, s[84:87], s21 offen offset:1024 sc1
s_waitcnt vmcnt(13)
v_mfma_f32_32x32x16_bf16 v[200:215], a[168:171], v[172:175], v[200:215]
v_mfma_f32_32x32x16_bf16 v[216:231], a[172:175], v[172:175], v[216:231]
buffer_load_dwordx4 v[164:167], v2, s[84:87], s20 offen offset:3072 sc1
s_waitcnt vmcnt(12)
v_mfma_f32_32x32x16_bf16 v[200:215], a[176:179], v[176:179], v[200:215]
v_mfma_f32_32x32x16_bf16 v[216:231], a[180:183], v[176:179], v[216:231]
s_add_u32 s41, s41, 262144
s_add_u32 s20, s50, 0
s_and_b32 s20, s20, 0x7fff
s_add_u32 s20, s20, s41
buffer_load_dwordx4 v[168:171], v2, s[84:87], s20 offen sc1
s_waitcnt vmcnt(12)
v_mfma_f32_32x32x16_bf16 v[200:215], a[184:187], v[180:183], v[200:215]
v_mfma_f32_32x32x16_bf16 v[216:231], a[188:191], v[180:183], v[216:231]
buffer_load_dwordx4 v[172:175], v2, s[84:87], s20 offen offset:1024 sc1
buffer_load_dwordx4 v[96:99], v2, s[84:87], s21 offen offset:2048 sc1
s_waitcnt vmcnt(13)
v_mfma_f32_32x32x16_bf16 v[200:215], a[192:195], v[184:187], v[200:215]
v_mfma_f32_32x32x16_bf16 v[216:231], a[196:199], v[184:187], v[216:231]
buffer_load_dwordx4 v[176:179], v2, s[84:87], s20 offen offset:2048 sc1
s_waitcnt vmcnt(12)
v_mfma_f32_32x32x16_bf16 v[200:215], a[200:203], v[188:191], v[200:215]
v_mfma_f32_32x32x16_bf16 v[216:231], a[204:207], v[188:191], v[216:231]
buffer_load_dwordx4 v[180:183], v2, s[84:87], s20 offen offset:3072 sc1
s_waitcnt vmcnt(12)
v_mfma_f32_32x32x16_bf16 v[200:215], a[208:211], v[192:195], v[200:215]
v_mfma_f32_32x32x16_bf16 v[216:231], a[212:215], v[192:195], v[216:231]
s_add_u32 s20, s50, 4096
s_and_b32 s20, s20, 0x7fff
s_add_u32 s20, s20, s41
buffer_load_dwordx4 v[184:187], v2, s[84:87], s20 offen sc1
buffer_load_dwordx4 v[100:103], v2, s[84:87], s21 offen offset:3072 sc1
s_waitcnt vmcnt(13)
v_mfma_f32_32x32x16_bf16 v[200:215], a[216:219], v[196:199], v[200:215]
v_mfma_f32_32x32x16_bf16 v[216:231], a[220:223], v[196:199], v[216:231]
buffer_load_dwordx4 v[188:191], v2, s[84:87], s20 offen offset:1024 sc1
s_waitcnt vmcnt(12)
v_mfma_f32_32x32x16_bf16 v[200:215], a[224:227], v[152:155], v[200:215]
v_mfma_f32_32x32x16_bf16 v[216:231], a[228:231], v[152:155], v[216:231]
buffer_load_dwordx4 v[192:195], v2, s[84:87], s20 offen offset:2048 sc1
s_waitcnt vmcnt(12)
v_mfma_f32_32x32x16_bf16 v[200:215], a[232:235], v[156:159], v[200:215]
v_mfma_f32_32x32x16_bf16 v[216:231], a[236:239], v[156:159], v[216:231]
buffer_load_dwordx4 v[196:199], v2, s[84:87], s20 offen offset:3072 sc1
s_add_u32 s21, s26, 33558528
buffer_load_dwordx4 v[104:107], v2, s[84:87], s21 offen sc1
s_waitcnt vmcnt(13)
v_mfma_f32_32x32x16_bf16 v[200:215], a[240:243], v[160:163], v[200:215]
v_mfma_f32_32x32x16_bf16 v[216:231], a[244:247], v[160:163], v[216:231]
s_add_u32 s20, s50, 8192
s_and_b32 s20, s20, 0x7fff
s_add_u32 s20, s20, s41
buffer_load_dwordx4 v[152:155], v2, s[84:87], s20 offen sc1
s_waitcnt vmcnt(12)
v_mfma_f32_32x32x16_bf16 v[200:215], a[248:251], v[164:167], v[200:215]
v_mfma_f32_32x32x16_bf16 v[216:231], a[252:255], v[164:167], v[216:231]
buffer_load_dwordx4 v[156:159], v2, s[84:87], s20 offen offset:1024 sc1
s_nop 11
ds_write_b128 v17, v[200:203] offset:34816
ds_write_b128 v17, v[204:207] offset:35904
ds_write_b128 v17, v[208:211] offset:36992
ds_write_b128 v17, v[212:215] offset:38080
ds_write_b128 v17, v[216:219] offset:39168
ds_write_b128 v17, v[220:223] offset:40256
ds_write_b128 v17, v[224:227] offset:41344
ds_write_b128 v17, v[228:231] offset:42432
s_waitcnt vmcnt(12)
s_waitcnt lgkmcnt(0)
v_mfma_f32_32x32x16_bf16 v[200:215], a[0:3], v[168:171], 0
v_mfma_f32_32x32x16_bf16 v[216:231], a[4:7], v[168:171], 0
buffer_load_dwordx4 v[160:163], v2, s[84:87], s20 offen offset:2048 sc1
buffer_load_dwordx4 v[108:111], v2, s[84:87], s21 offen offset:1024 sc1
s_waitcnt vmcnt(13)
v_mfma_f32_32x32x16_bf16 v[200:215], a[8:11], v[172:175], v[200:215]
v_mfma_f32_32x32x16_bf16 v[216:231], a[12:15], v[172:175], v[216:231]
buffer_load_dwordx4 v[164:167], v2, s[84:87], s20 offen offset:3072 sc1
s_waitcnt vmcnt(12)
v_mfma_f32_32x32x16_bf16 v[200:215], a[16:19], v[176:179], v[200:215]
v_mfma_f32_32x32x16_bf16 v[216:231], a[20:23], v[176:179], v[216:231]
s_add_u32 s20, s50, 12288
s_and_b32 s20, s20, 0x7fff
s_add_u32 s20, s20, s41
buffer_load_dwordx4 v[168:171], v2, s[84:87], s20 offen sc1
s_waitcnt vmcnt(12)
v_mfma_f32_32x32x16_bf16 v[200:215], a[24:27], v[180:183], v[200:215]
v_mfma_f32_32x32x16_bf16 v[216:231], a[28:31], v[180:183], v[216:231]
buffer_load_dwordx4 v[172:175], v2, s[84:87], s20 offen offset:1024 sc1
buffer_load_dwordx4 v[112:115], v2, s[84:87], s21 offen offset:2048 sc1
s_waitcnt vmcnt(13)
v_mfma_f32_32x32x16_bf16 v[200:215], a[32:35], v[184:187], v[200:215]
v_mfma_f32_32x32x16_bf16 v[216:231], a[36:39], v[184:187], v[216:231]
buffer_load_dwordx4 v[176:179], v2, s[84:87], s20 offen offset:2048 sc1
s_waitcnt vmcnt(12)
v_mfma_f32_32x32x16_bf16 v[200:215], a[40:43], v[188:191], v[200:215]
v_mfma_f32_32x32x16_bf16 v[216:231], a[44:47], v[188:191], v[216:231]
buffer_load_dwordx4 v[180:183], v2, s[84:87], s20 offen offset:3072 sc1
s_waitcnt vmcnt(12)
v_mfma_f32_32x32x16_bf16 v[200:215], a[48:51], v[192:195], v[200:215]
v_mfma_f32_32x32x16_bf16 v[216:231], a[52:55], v[192:195], v[216:231]
s_add_u32 s20, s50, 16384
s_and_b32 s20, s20, 0x7fff
s_add_u32 s20, s20, s41
buffer_load_dwordx4 v[184:187], v2, s[84:87], s20 offen sc1
buffer_load_dwordx4 v[116:119], v2, s[84:87], s21 offen offset:3072 sc1
s_waitcnt vmcnt(13)
v_mfma_f32_32x32x16_bf16 v[200:215], a[56:59], v[196:199], v[200:215]
v_mfma_f32_32x32x16_bf16 v[216:231], a[60:63], v[196:199], v[216:231]
buffer_load_dwordx4 v[188:191], v2, s[84:87], s20 offen offset:1024 sc1
s_waitcnt vmcnt(12)
v_mfma_f32_32x32x16_bf16 v[200:215], a[64:67], v[152:155], v[200:215]
v_mfma_f32_32x32x16_bf16 v[216:231], a[68:71], v[152:155], v[216:231]
buffer_load_dwordx4 v[192:195], v2, s[84:87], s20 offen offset:2048 sc1
s_waitcnt vmcnt(12)
v_mfma_f32_32x32x16_bf16 v[200:215], a[72:75], v[156:159], v[200:215]
v_mfma_f32_32x32x16_bf16 v[216:231], a[76:79], v[156:159], v[216:231]
buffer_load_dwordx4 v[196:199], v2, s[84:87], s20 offen offset:3072 sc1
s_add_u32 s21, s26, 178257920
buffer_load_dwordx4 v[120:123], v6, s[84:87], s21 offen sc1
s_waitcnt vmcnt(13)
v_mfma_f32_32x32x16_bf16 v[200:215], a[80:83], v[160:163], v[200:215]
v_mfma_f32_32x32x16_bf16 v[216:231], a[84:87], v[160:163], v[216:231]
s_add_u32 s20, s50, 20480
s_and_b32 s20, s20, 0x7fff
s_add_u32 s20, s20, s41
buffer_load_dwordx4 v[152:155], v2, s[84:87], s20 offen sc1
s_waitcnt vmcnt(12)
v_mfma_f32_32x32x16_bf16 v[200:215], a[88:91], v[164:167], v[200:215]
v_mfma_f32_32x32x16_bf16 v[216:231], a[92:95], v[164:167], v[216:231]
buffer_load_dwordx4 v[156:159], v2, s[84:87], s20 offen offset:1024 sc1
s_waitcnt vmcnt(12)
v_mfma_f32_32x32x16_bf16 v[200:215], a[96:99], v[168:171], v[200:215]
v_mfma_f32_32x32x16_bf16 v[216:231], a[100:103], v[168:171], v[216:231]
buffer_load_dwordx4 v[160:163], v2, s[84:87], s20 offen offset:2048 sc1
buffer_load_dwordx4 v[124:127], v6, s[84:87], s21 offen offset:64 sc1
s_waitcnt vmcnt(13)
v_mfma_f32_32x32x16_bf16 v[200:215], a[104:107], v[172:175], v[200:215]
v_mfma_f32_32x32x16_bf16 v[216:231], a[108:111], v[172:175], v[216:231]
buffer_load_dwordx4 v[164:167], v2, s[84:87], s20 offen offset:3072 sc1
s_waitcnt vmcnt(12)
v_mfma_f32_32x32x16_bf16 v[200:215], a[112:115], v[176:179], v[200:215]
v_mfma_f32_32x32x16_bf16 v[216:231], a[116:119], v[176:179], v[216:231]
s_add_u32 s20, s50, 24576
s_and_b32 s20, s20, 0x7fff
s_add_u32 s20, s20, s41
buffer_load_dwordx4 v[168:171], v2, s[84:87], s20 offen sc1
s_waitcnt vmcnt(12)
v_mfma_f32_32x32x16_bf16 v[200:215], a[120:123], v[180:183], v[200:215]
v_mfma_f32_32x32x16_bf16 v[216:231], a[124:127], v[180:183], v[216:231]
buffer_load_dwordx4 v[172:175], v2, s[84:87], s20 offen offset:1024 sc1
buffer_load_dwordx4 v[128:131], v6, s[84:87], s21 offen offset:128 sc1
s_waitcnt vmcnt(13)
v_mfma_f32_32x32x16_bf16 v[200:215], a[128:131], v[184:187], v[200:215]
v_mfma_f32_32x32x16_bf16 v[216:231], a[132:135], v[184:187], v[216:231]
buffer_load_dwordx4 v[176:179], v2, s[84:87], s20 offen offset:2048 sc1
s_waitcnt vmcnt(12)
v_mfma_f32_32x32x16_bf16 v[200:215], a[136:139], v[188:191], v[200:215]
v_mfma_f32_32x32x16_bf16 v[216:231], a[140:143], v[188:191], v[216:231]
buffer_load_dwordx4 v[180:183], v2, s[84:87], s20 offen offset:3072 sc1
s_waitcnt vmcnt(12)
v_mfma_f32_32x32x16_bf16 v[200:215], a[144:147], v[192:195], v[200:215]
v_mfma_f32_32x32x16_bf16 v[216:231], a[148:151], v[192:195], v[216:231]
s_add_u32 s20, s50, 28672
s_and_b32 s20, s20, 0x7fff
s_add_u32 s20, s20, s41
buffer_load_dwordx4 v[184:187], v2, s[84:87], s20 offen sc1
buffer_load_dwordx4 v[132:135], v6, s[84:87], s21 offen offset:192 sc1
s_waitcnt vmcnt(13)
v_mfma_f32_32x32x16_bf16 v[200:215], a[152:155], v[196:199], v[200:215]
v_mfma_f32_32x32x16_bf16 v[216:231], a[156:159], v[196:199], v[216:231]
buffer_load_dwordx4 v[188:191], v2, s[84:87], s20 offen offset:1024 sc1
s_waitcnt vmcnt(12)
v_mfma_f32_32x32x16_bf16 v[200:215], a[160:163], v[152:155], v[200:215]
v_mfma_f32_32x32x16_bf16 v[216:231], a[164:167], v[152:155], v[216:231]
buffer_load_dwordx4 v[192:195], v2, s[84:87], s20 offen offset:2048 sc1
s_waitcnt vmcnt(12)
v_mfma_f32_32x32x16_bf16 v[200:215], a[168:171], v[156:159], v[200:215]
v_mfma_f32_32x32x16_bf16 v[216:231], a[172:175], v[156:159], v[216:231]
buffer_load_dwordx4 v[196:199], v2, s[84:87], s20 offen offset:3072 sc1
s_add_u32 s21, s26, 178259968
buffer_load_dwordx2 v[136:137], v7, s[84:87], s21 offen sc1
s_waitcnt vmcnt(13)
v_mfma_f32_32x32x16_bf16 v[200:215], a[176:179], v[160:163], v[200:215]
v_mfma_f32_32x32x16_bf16 v[216:231], a[180:183], v[160:163], v[216:231]
s_add_u32 s41, s41, 262144
s_add_u32 s20, s50, 0
s_and_b32 s20, s20, 0x7fff
s_add_u32 s20, s20, s41
buffer_load_dwordx4 v[152:155], v2, s[84:87], s20 offen sc1
s_waitcnt vmcnt(12)
v_mfma_f32_32x32x16_bf16 v[200:215], a[184:187], v[164:167], v[200:215]
v_mfma_f32_32x32x16_bf16 v[216:231], a[188:191], v[164:167], v[216:231]
buffer_load_dwordx4 v[156:159], v2, s[84:87], s20 offen offset:1024 sc1
s_waitcnt vmcnt(12)
v_mfma_f32_32x32x16_bf16 v[200:215], a[192:195], v[168:171], v[200:215]
v_mfma_f32_32x32x16_bf16 v[216:231], a[196:199], v[168:171], v[216:231]
buffer_load_dwordx4 v[160:163], v2, s[84:87], s20 offen offset:2048 sc1
buffer_load_dwordx2 v[138:139], v7, s[84:87], s21 offen offset:2048 sc1
s_waitcnt vmcnt(13)
v_mfma_f32_32x32x16_bf16 v[200:215], a[200:203], v[172:175], v[200:215]
v_mfma_f32_32x32x16_bf16 v[216:231], a[204:207], v[172:175], v[216:231]
buffer_load_dwordx4 v[164:167], v2, s[84:87], s20 offen offset:3072 sc1
s_waitcnt vmcnt(12)
v_mfma_f32_32x32x16_bf16 v[200:215], a[208:211], v[176:179], v[200:215]
v_mfma_f32_32x32x16_bf16 v[216:231], a[212:215], v[176:179], v[216:231]
s_add_u32 s20, s50, 4096
s_and_b32 s20, s20, 0x7fff
s_add_u32 s20, s20, s41
buffer_load_dwordx4 v[168:171], v2, s[84:87], s20 offen sc1
s_waitcnt vmcnt(12)
v_mfma_f32_32x32x16_bf16 v[200:215], a[216:219], v[180:183], v[200:215]
v_mfma_f32_32x32x16_bf16 v[216:231], a[220:223], v[180:183], v[216:231]
buffer_load_dwordx4 v[172:175], v2, s[84:87], s20 offen offset:1024 sc1
buffer_load_dwordx2 v[140:141], v7, s[84:87], s21 offen offset:512 sc1
s_waitcnt vmcnt(13)
v_mfma_f32_32x32x16_bf16 v[200:215], a[224:227], v[184:187], v[200:215]
v_mfma_f32_32x32x16_bf16 v[216:231], a[228:231], v[184:187], v[216:231]
buffer_load_dwordx4 v[176:179], v2, s[84:87], s20 offen offset:2048 sc1
s_waitcnt vmcnt(12)
v_mfma_f32_32x32x16_bf16 v[200:215], a[232:235], v[188:191], v[200:215]
v_mfma_f32_32x32x16_bf16 v[216:231], a[236:239], v[188:191], v[216:231]
buffer_load_dwordx4 v[180:183], v2, s[84:87], s20 offen offset:3072 sc1
s_waitcnt vmcnt(12)
v_mfma_f32_32x32x16_bf16 v[200:215], a[240:243], v[192:195], v[200:215]
v_mfma_f32_32x32x16_bf16 v[216:231], a[244:247], v[192:195], v[216:231]
s_add_u32 s20, s50, 8192
s_and_b32 s20, s20, 0x7fff
s_add_u32 s20, s20, s41
buffer_load_dwordx4 v[184:187], v2, s[84:87], s20 offen sc1
buffer_load_dwordx2 v[142:143], v7, s[84:87], s21 offen offset:2560 sc1
s_waitcnt vmcnt(13)
v_mfma_f32_32x32x16_bf16 v[200:215], a[248:251], v[196:199], v[200:215]
v_mfma_f32_32x32x16_bf16 v[216:231], a[252:255], v[196:199], v[216:231]
buffer_load_dwordx4 v[188:191], v2, s[84:87], s20 offen offset:1024 sc1
v_add_u32 v5, 69632, v17
s_nop 11
ds_write_b128 v5, v[200:203]
ds_write_b128 v5, v[204:207] offset:1088
ds_write_b128 v5, v[208:211] offset:2176
ds_write_b128 v5, v[212:215] offset:3264
ds_write_b128 v5, v[216:219] offset:4352
ds_write_b128 v5, v[220:223] offset:5440
ds_write_b128 v5, v[224:227] offset:6528
ds_write_b128 v5, v[228:231] offset:7616
s_waitcnt vmcnt(12)
s_waitcnt lgkmcnt(0)
v_mfma_f32_32x32x16_bf16 v[200:215], a[0:3], v[152:155], 0
v_mfma_f32_32x32x16_bf16 v[216:231], a[4:7], v[152:155], 0
buffer_load_dwordx4 v[192:195], v2, s[84:87], s20 offen offset:2048 sc1
s_waitcnt vmcnt(12)
v_mfma_f32_32x32x16_bf16 v[200:215], a[8:11], v[156:159], v[200:215]
v_mfma_f32_32x32x16_bf16 v[216:231], a[12:15], v[156:159], v[216:231]
buffer_load_dwordx4 v[196:199], v2, s[84:87], s20 offen offset:3072 sc1
buffer_load_dwordx2 v[144:145], v7, s[84:87], s21 offen offset:1024 sc1
s_waitcnt vmcnt(13)
v_mfma_f32_32x32x16_bf16 v[200:215], a[16:19], v[160:163], v[200:215]
v_mfma_f32_32x32x16_bf16 v[216:231], a[20:23], v[160:163], v[216:231]
s_add_u32 s20, s50, 12288
s_and_b32 s20, s20, 0x7fff
s_add_u32 s20, s20, s41
buffer_load_dwordx4 v[152:155], v2, s[84:87], s20 offen sc1
s_waitcnt vmcnt(12)
v_mfma_f32_32x32x16_bf16 v[200:215], a[24:27], v[164:167], v[200:215]
v_mfma_f32_32x32x16_bf16 v[216:231], a[28:31], v[164:167], v[216:231]
buffer_load_dwordx4 v[156:159], v2, s[84:87], s20 offen offset:1024 sc1
s_waitcnt vmcnt(12)
v_mfma_f32_32x32x16_bf16 v[200:215], a[32:35], v[168:171], v[200:215]
v_mfma_f32_32x32x16_bf16 v[216:231], a[36:39], v[168:171], v[216:231]
buffer_load_dwordx4 v[160:163], v2, s[84:87], s20 offen offset:2048 sc1
buffer_load_dwordx2 v[146:147], v7, s[84:87], s21 offen offset:3072 sc1
s_waitcnt vmcnt(13)
v_mfma_f32_32x32x16_bf16 v[200:215], a[40:43], v[172:175], v[200:215]
v_mfma_f32_32x32x16_bf16 v[216:231], a[44:47], v[172:175], v[216:231]
buffer_load_dwordx4 v[164:167], v2, s[84:87], s20 offen offset:3072 sc1
s_waitcnt vmcnt(12)
v_mfma_f32_32x32x16_bf16 v[200:215], a[48:51], v[176:179], v[200:215]
v_mfma_f32_32x32x16_bf16 v[216:231], a[52:55], v[176:179], v[216:231]
s_add_u32 s20, s50, 16384
s_and_b32 s20, s20, 0x7fff
s_add_u32 s20, s20, s41
buffer_load_dwordx4 v[168:171], v2, s[84:87], s20 offen sc1
s_waitcnt vmcnt(12)
v_mfma_f32_32x32x16_bf16 v[200:215], a[56:59], v[180:183], v[200:215]
v_mfma_f32_32x32x16_bf16 v[216:231], a[60:63], v[180:183], v[216:231]
buffer_load_dwordx4 v[172:175], v2, s[84:87], s20 offen offset:1024 sc1
buffer_load_dwordx2 v[148:149], v7, s[84:87], s21 offen offset:1536 sc1
s_waitcnt vmcnt(13)
v_mfma_f32_32x32x16_bf16 v[200:215], a[64:67], v[184:187], v[200:215]
v_mfma_f32_32x32x16_bf16 v[216:231], a[68:71], v[184:187], v[216:231]
buffer_load_dwordx4 v[176:179], v2, s[84:87], s20 offen offset:2048 sc1
s_waitcnt vmcnt(12)
v_mfma_f32_32x32x16_bf16 v[200:215], a[72:75], v[188:191], v[200:215]
v_mfma_f32_32x32x16_bf16 v[216:231], a[76:79], v[188:191], v[216:231]
buffer_load_dwordx4 v[180:183], v2, s[84:87], s20 offen offset:3072 sc1
s_waitcnt vmcnt(12)
v_mfma_f32_32x32x16_bf16 v[200:215], a[80:83], v[192:195], v[200:215]
v_mfma_f32_32x32x16_bf16 v[216:231], a[84:87], v[192:195], v[216:231]
s_add_u32 s20, s50, 20480
s_and_b32 s20, s20, 0x7fff
s_add_u32 s20, s20, s41
buffer_load_dwordx4 v[184:187], v2, s[84:87], s20 offen sc1
buffer_load_dwordx2 v[150:151], v7, s[84:87], s21 offen offset:3584 sc1
s_waitcnt vmcnt(13)
v_mfma_f32_32x32x16_bf16 v[200:215], a[88:91], v[196:199], v[200:215]
v_mfma_f32_32x32x16_bf16 v[216:231], a[92:95], v[196:199], v[216:231]
buffer_load_dwordx4 v[188:191], v2, s[84:87], s20 offen offset:1024 sc1
s_waitcnt vmcnt(12)
v_mfma_f32_32x32x16_bf16 v[200:215], a[96:99], v[152:155], v[200:215]
v_mfma_f32_32x32x16_bf16 v[216:231], a[100:103], v[152:155], v[216:231]
buffer_load_dwordx4 v[192:195], v2, s[84:87], s20 offen offset:2048 sc1
s_waitcnt vmcnt(12)
v_mfma_f32_32x32x16_bf16 v[200:215], a[104:107], v[156:159], v[200:215]
v_mfma_f32_32x32x16_bf16 v[216:231], a[108:111], v[156:159], v[216:231]
buffer_load_dwordx4 v[196:199], v2, s[84:87], s20 offen offset:3072 sc1
s_waitcnt vmcnt(12)
v_mfma_f32_32x32x16_bf16 v[200:215], a[112:115], v[160:163], v[200:215]
v_mfma_f32_32x32x16_bf16 v[216:231], a[116:119], v[160:163], v[216:231]
s_add_u32 s20, s50, 24576
s_and_b32 s20, s20, 0x7fff
s_add_u32 s20, s20, s41
buffer_load_dwordx4 v[152:155], v2, s[84:87], s20 offen sc1
s_waitcnt vmcnt(11)
v_mfma_f32_32x32x16_bf16 v[200:215], a[120:123], v[164:167], v[200:215]
v_mfma_f32_32x32x16_bf16 v[216:231], a[124:127], v[164:167], v[216:231]
buffer_load_dwordx4 v[156:159], v2, s[84:87], s20 offen offset:1024 sc1
s_waitcnt vmcnt(11)
v_mfma_f32_32x32x16_bf16 v[200:215], a[128:131], v[168:171], v[200:215]
v_mfma_f32_32x32x16_bf16 v[216:231], a[132:135], v[168:171], v[216:231]
buffer_load_dwordx4 v[160:163], v2, s[84:87], s20 offen offset:2048 sc1
s_waitcnt vmcnt(11)
v_mfma_f32_32x32x16_bf16 v[200:215], a[136:139], v[172:175], v[200:215]
v_mfma_f32_32x32x16_bf16 v[216:231], a[140:143], v[172:175], v[216:231]
buffer_load_dwordx4 v[164:167], v2, s[84:87], s20 offen offset:3072 sc1
s_waitcnt vmcnt(10)
v_mfma_f32_32x32x16_bf16 v[200:215], a[144:147], v[176:179], v[200:215]
v_mfma_f32_32x32x16_bf16 v[216:231], a[148:151], v[176:179], v[216:231]
s_add_u32 s20, s50, 28672
s_and_b32 s20, s20, 0x7fff
s_add_u32 s20, s20, s41
buffer_load_dwordx4 v[168:171], v2, s[84:87], s20 offen sc1
s_waitcnt vmcnt(10)
v_mfma_f32_32x32x16_bf16 v[200:215], a[152:155], v[180:183], v[200:215]
v_mfma_f32_32x32x16_bf16 v[216:231], a[156:159], v[180:183], v[216:231]
buffer_load_dwordx4 v[172:175], v2, s[84:87], s20 offen offset:1024 sc1
s_waitcnt vmcnt(10)
v_mfma_f32_32x32x16_bf16 v[200:215], a[160:163], v[184:187], v[200:215]
v_mfma_f32_32x32x16_bf16 v[216:231], a[164:167], v[184:187], v[216:231]
buffer_load_dwordx4 v[176:179], v2, s[84:87], s20 offen offset:2048 sc1
s_waitcnt vmcnt(9)
v_mfma_f32_32x32x16_bf16 v[200:215], a[168:171], v[188:191], v[200:215]
v_mfma_f32_32x32x16_bf16 v[216:231], a[172:175], v[188:191], v[216:231]
buffer_load_dwordx4 v[180:183], v2, s[84:87], s20 offen offset:3072 sc1
s_waitcnt vmcnt(9)
v_mfma_f32_32x32x16_bf16 v[200:215], a[176:179], v[192:195], v[200:215]
v_mfma_f32_32x32x16_bf16 v[216:231], a[180:183], v[192:195], v[216:231]
s_waitcnt vmcnt(8)
v_mfma_f32_32x32x16_bf16 v[200:215], a[184:187], v[196:199], v[200:215]
v_mfma_f32_32x32x16_bf16 v[216:231], a[188:191], v[196:199], v[216:231]
s_waitcnt vmcnt(7)
v_mfma_f32_32x32x16_bf16 v[200:215], a[192:195], v[152:155], v[200:215]
v_mfma_f32_32x32x16_bf16 v[216:231], a[196:199], v[152:155], v[216:231]
s_waitcnt vmcnt(6)
v_mfma_f32_32x32x16_bf16 v[200:215], a[200:203], v[156:159], v[200:215]
v_mfma_f32_32x32x16_bf16 v[216:231], a[204:207], v[156:159], v[216:231]
s_waitcnt vmcnt(5)
v_mfma_f32_32x32x16_bf16 v[200:215], a[208:211], v[160:163], v[200:215]
v_mfma_f32_32x32x16_bf16 v[216:231], a[212:215], v[160:163], v[216:231]
s_waitcnt vmcnt(4)
v_mfma_f32_32x32x16_bf16 v[200:215], a[216:219], v[164:167], v[200:215]
v_mfma_f32_32x32x16_bf16 v[216:231], a[220:223], v[164:167], v[216:231]
s_waitcnt vmcnt(3)
v_mfma_f32_32x32x16_bf16 v[200:215], a[224:227], v[168:171], v[200:215]
v_mfma_f32_32x32x16_bf16 v[216:231], a[228:231], v[168:171], v[216:231]
s_waitcnt vmcnt(2)
v_mfma_f32_32x32x16_bf16 v[200:215], a[232:235], v[172:175], v[200:215]
v_mfma_f32_32x32x16_bf16 v[216:231], a[236:239], v[172:175], v[216:231]
s_waitcnt vmcnt(1)
v_mfma_f32_32x32x16_bf16 v[200:215], a[240:243], v[176:179], v[200:215]
v_mfma_f32_32x32x16_bf16 v[216:231], a[244:247], v[176:179], v[216:231]
s_waitcnt vmcnt(0)
v_mfma_f32_32x32x16_bf16 v[200:215], a[248:251], v[180:183], v[200:215]
v_mfma_f32_32x32x16_bf16 v[216:231], a[252:255], v[180:183], v[216:231]
s_nop 11
ds_write_b128 v5, v[200:203] offset:34816
ds_write_b128 v5, v[204:207] offset:35904
ds_write_b128 v5, v[208:211] offset:36992
ds_write_b128 v5, v[212:215] offset:38080
ds_write_b128 v5, v[216:219] offset:39168
ds_write_b128 v5, v[220:223] offset:40256
ds_write_b128 v5, v[224:227] offset:41344
ds_write_b128 v5, v[228:231] offset:42432
s_sub_u32 s20, s22, 56
s_cmp_lt_u32 s20, 8
s_cselect_b32 s20, s51, 0
s_cmp_eq_u32 s20, 1
s_cbranch_scc0 L_x_sp_13
s_mov_b32 s46, 2
s_lshl_b32 s27, s22, 18
s_lshl_b32 s20, s18, 13
s_add_u32 s27, s27, s20
s_add_u32 s29, s27, 178257920
s_and_b32 s20, s16, 1
s_lshl_b32 s20, s20, 10
s_add_u32 s26, s27, s20
s_add_u32 s26, s26, 0
s_lshr_b32 s20, s16, 1
s_lshl_b32 s20, s20, 12
s_add_u32 s28, s27, s20
s_add_u32 s28, s28, 33554432
s_add_u32 s27, s27, 16777216
s_add_u32 s48, s26, 4096
s_add_u32 s49, s27, 4096
buffer_load_dwordx4 v[24:27], v2, s[84:87], s26 offen sc1
buffer_load_dwordx4 v[28:31], v2, s[84:87], s26 offen offset:2048 sc1
buffer_load_dwordx4 v[32:35], v2, s[84:87], s48 offen sc1
buffer_load_dwordx4 v[36:39], v2, s[84:87], s48 offen offset:2048 sc1
buffer_load_dwordx4 v[56:59], v2, s[84:87], s27 offen sc1
buffer_load_dwordx4 v[60:63], v2, s[84:87], s27 offen offset:1024 sc1
buffer_load_dwordx4 v[64:67], v2, s[84:87], s27 offen offset:2048 sc1
buffer_load_dwordx4 v[68:71], v2, s[84:87], s27 offen offset:3072 sc1
buffer_load_dwordx4 v[72:75], v2, s[84:87], s49 offen sc1
buffer_load_dwordx4 v[76:79], v2, s[84:87], s49 offen offset:1024 sc1
buffer_load_dwordx4 v[80:83], v2, s[84:87], s49 offen offset:2048 sc1
buffer_load_dwordx4 v[84:87], v2, s[84:87], s49 offen offset:3072 sc1
buffer_load_dwordx4 v[88:91], v2, s[84:87], s28 offen sc1
buffer_load_dwordx4 v[92:95], v2, s[84:87], s28 offen offset:1024 sc1
buffer_load_dwordx4 v[96:99], v2, s[84:87], s28 offen offset:2048 sc1
buffer_load_dwordx4 v[100:103], v2, s[84:87], s28 offen offset:3072 sc1
L_x_sp_13:
v_mov_b32 v3, v252
v_mov_b32 v4, s45
s_waitcnt lgkmcnt(0)
v_mov_b32 v5, v16
s_barrier
ds_read_b128 v[152:155], v3
ds_read_b128 v[156:159], v3 offset:8704
ds_read_b128 v[160:163], v3 offset:17408
ds_read_b128 v[164:167], v3 offset:26112
ds_read_b128 v[168:171], v3 offset:34816
ds_read_b128 v[172:175], v3 offset:43520
ds_read_b128 v[176:179], v3 offset:52224
ds_read_b128 v[180:183], v3 offset:60928
v_add_u32 v3, 69632, v3
ds_read_b128 v[184:187], v3
ds_read_b128 v[188:191], v3 offset:8704
ds_read_b128 v[192:195], v3 offset:17408
ds_read_b128 v[196:199], v3 offset:26112
s_waitcnt lgkmcnt(8)
v_pk_add_f32 v[152:153], v[152:153], v[156:157]
v_pk_add_f32 v[154:155], v[154:155], v[158:159]
v_pk_add_f32 v[160:161], v[160:161], v[164:165]
v_pk_add_f32 v[162:163], v[162:163], v[166:167]
v_pk_add_f32 v[152:153], v[152:153], v[160:161]
v_pk_add_f32 v[154:155], v[154:155], v[162:163]
ds_read_b128 v[200:203], v3 offset:34816
ds_read_b128 v[204:207], v3 offset:43520
ds_read_b128 v[208:211], v3 offset:52224
ds_read_b128 v[212:215], v3 offset:60928
s_waitcnt lgkmcnt(8)
v_pk_add_f32 v[168:169], v[168:169], v[172:173]
v_pk_add_f32 v[170:171], v[170:171], v[174:175]
v_pk_add_f32 v[176:177], v[176:177], v[180:181]
v_pk_add_f32 v[178:179], v[178:179], v[182:183]
v_pk_add_f32 v[168:169], v[168:169], v[176:177]
v_pk_add_f32 v[170:171], v[170:171], v[178:179]
s_waitcnt lgkmcnt(4)
v_pk_add_f32 v[184:185], v[184:185], v[188:189]
v_pk_add_f32 v[186:187], v[186:187], v[190:191]
v_pk_add_f32 v[192:193], v[192:193], v[196:197]
v_pk_add_f32 v[194:195], v[194:195], v[198:199]
v_pk_add_f32 v[184:185], v[184:185], v[192:193]
v_pk_add_f32 v[186:187], v[186:187], v[194:195]
s_waitcnt lgkmcnt(0)
v_pk_add_f32 v[200:201], v[200:201], v[204:205]
v_pk_add_f32 v[202:203], v[202:203], v[206:207]
v_pk_add_f32 v[208:209], v[208:209], v[212:213]
v_pk_add_f32 v[210:211], v[210:211], v[214:215]
v_pk_add_f32 v[200:201], v[200:201], v[208:209]
v_pk_add_f32 v[202:203], v[202:203], v[210:211]
s_add_u32 s48, s9, 0
s_add_u32 s49, s9, 4096
s_add_u32 s27, s9, 8192
s_add_u32 s28, s9, 12288
s_cmp_eq_u32 s96, 1
s_cbranch_scc1 L_x_st_14f
buffer_store_dwordx4 v[152:155], v19, s[84:87], s48 offen sc1
buffer_store_dwordx4 v[168:171], v19, s[84:87], s49 offen sc1
buffer_store_dwordx4 v[184:187], v19, s[84:87], s27 offen sc1
buffer_store_dwordx4 v[200:203], v19, s[84:87], s28 offen sc1
s_branch L_x_st_14d
L_x_st_14f:
buffer_store_dwordx4 v[152:155], v19, s[84:87], s48 offen
buffer_store_dwordx4 v[168:171], v19, s[84:87], s49 offen
buffer_store_dwordx4 v[184:187], v19, s[84:87], s27 offen
buffer_store_dwordx4 v[200:203], v19, s[84:87], s28 offen
L_x_st_14d:
ds_read_b128 v[216:219], v5
ds_read_b128 v[220:223], v5 offset:8704
ds_read_b128 v[224:227], v5 offset:17408
ds_read_b128 v[228:231], v5 offset:26112
s_waitcnt lgkmcnt(0)
v_pk_add_f32 v[216:217], v[216:217], v[220:221]
v_pk_add_f32 v[218:219], v[218:219], v[222:223]
v_pk_add_f32 v[224:225], v[224:225], v[228:229]
v_pk_add_f32 v[226:227], v[226:227], v[230:231]
v_pk_add_f32 v[232:233], v[216:217], v[224:225]
v_pk_add_f32 v[234:235], v[218:219], v[226:227]
ds_read_b128 v[216:219], v5 offset:34816
ds_read_b128 v[220:223], v5 offset:43520
ds_read_b128 v[224:227], v5 offset:52224
ds_read_b128 v[228:231], v5 offset:60928
s_waitcnt lgkmcnt(0)
v_pk_add_f32 v[216:217], v[216:217], v[220:221]
v_pk_add_f32 v[218:219], v[218:219], v[222:223]
v_pk_add_f32 v[224:225], v[224:225], v[228:229]
v_pk_add_f32 v[226:227], v[226:227], v[230:231]
v_pk_add_f32 v[236:237], v[216:217], v[224:225]
v_pk_add_f32 v[238:239], v[218:219], v[226:227]
v_add_u32 v5, 69632, v5
ds_read_b128 v[216:219], v5
ds_read_b128 v[220:223], v5 offset:8704
ds_read_b128 v[224:227], v5 offset:17408
ds_read_b128 v[228:231], v5 offset:26112
s_waitcnt lgkmcnt(0)
v_pk_add_f32 v[216:217], v[216:217], v[220:221]
v_pk_add_f32 v[218:219], v[218:219], v[222:223]
v_pk_add_f32 v[224:225], v[224:225], v[228:229]
v_pk_add_f32 v[226:227], v[226:227], v[230:231]
v_pk_add_f32 v[240:241], v[216:217], v[224:225]
v_pk_add_f32 v[242:243], v[218:219], v[226:227]
ds_read_b128 v[216:219], v5 offset:34816
ds_read_b128 v[220:223], v5 offset:43520
ds_read_b128 v[224:227], v5 offset:52224
ds_read_b128 v[228:231], v5 offset:60928
s_waitcnt lgkmcnt(0)
v_pk_add_f32 v[216:217], v[216:217], v[220:221]
v_pk_add_f32 v[218:219], v[218:219], v[222:223]
v_pk_add_f32 v[224:225], v[224:225], v[228:229]
v_pk_add_f32 v[226:227], v[226:227], v[230:231]
v_pk_add_f32 v[244:245], v[216:217], v[224:225]
v_pk_add_f32 v[246:247], v[218:219], v[226:227]
s_waitcnt vmcnt(0)
s_barrier
s_cmp_eq_u32 s96, 1
s_cbranch_scc1 L_x_st_15f
buffer_store_dword v4, v15, s[84:87], 0 offen offset:64 sc1
s_branch L_x_st_15d
L_x_st_15f:
buffer_store_dword v4, v15, s[84:87], 0 offen offset:64
L_x_st_15d:
L_x_pfa:
buffer_load_dword v3, v251, s[84:87], 0 offen offset:64 sc1
s_waitcnt vmcnt(0)
v_cmp_gt_u32 vcc, s45, v3
s_cbranch_vccnz L_x_pfa
buffer_load_dwordx4 v[216:219], v19, s[84:87], s10 offen sc1
s_add_u32 s10, s10, 4096
buffer_load_dwordx4 v[220:223], v19, s[84:87], s10 offen sc1
s_add_u32 s10, s10, 4096
buffer_load_dwordx4 v[224:227], v19, s[84:87], s10 offen sc1
s_add_u32 s10, s10, 4096
buffer_load_dwordx4 v[228:231], v19, s[84:87], s10 offen sc1
s_waitcnt vmcnt(3)
v_pk_add_f32 v[216:217], v[216:217], v[232:233]
v_pk_add_f32 v[218:219], v[218:219], v[234:235]
v_cvt_pk_bf16_f32 v216, v216, v217
v_cvt_pk_bf16_f32 v217, v218, v219
buffer_store_dwordx2 v[216:217], v18, s[12:15], s42 offen
s_add_u32 s42, s42, 131072
s_waitcnt vmcnt(3)
v_pk_add_f32 v[220:221], v[220:221], v[236:237]
v_pk_add_f32 v[222:223], v[222:223], v[238:239]
v_cvt_pk_bf16_f32 v220, v220, v221
v_cvt_pk_bf16_f32 v221, v222, v223
buffer_store_dwordx2 v[220:221], v18, s[12:15], s42 offen
s_add_u32 s42, s42, 131072
s_waitcnt vmcnt(3)
v_pk_add_f32 v[224:225], v[224:225], v[240:241]
v_pk_add_f32 v[226:227], v[226:227], v[242:243]
v_cvt_pk_bf16_f32 v224, v224, v225
v_cvt_pk_bf16_f32 v225, v226, v227
buffer_store_dwordx2 v[224:225], v18, s[12:15], s42 offen
s_add_u32 s42, s42, 131072
s_waitcnt vmcnt(3)
v_pk_add_f32 v[228:229], v[228:229], v[244:245]
v_pk_add_f32 v[230:231], v[230:231], v[246:247]
v_cvt_pk_bf16_f32 v228, v228, v229
v_cvt_pk_bf16_f32 v229, v230, v231
buffer_store_dwordx2 v[228:229], v18, s[12:15], s42 offen
s_add_u32 s42, s42, 131072
s_branch L_x_f2
L_x_f1:
s_add_u32 s20, s50, 0
s_and_b32 s20, s20, 0x7fff
s_add_u32 s20, s20, s41
buffer_load_dwordx4 v[152:155], v2, s[84:87], s20 offen sc1
buffer_load_dwordx4 v[156:159], v2, s[84:87], s20 offen offset:1024 sc1
buffer_load_dwordx4 v[160:163], v2, s[84:87], s20 offen offset:2048 sc1
buffer_load_dwordx4 v[164:167], v2, s[84:87], s20 offen offset:3072 sc1
s_add_u32 s20, s50, 4096
s_and_b32 s20, s20, 0x7fff
s_add_u32 s20, s20, s41
buffer_load_dwordx4 v[168:171], v2, s[84:87], s20 offen sc1
buffer_load_dwordx4 v[172:175], v2, s[84:87], s20 offen offset:1024 sc1
buffer_load_dwordx4 v[176:179], v2, s[84:87], s20 offen offset:2048 sc1
buffer_load_dwordx4 v[180:183], v2, s[84:87], s20 offen offset:3072 sc1
s_add_u32 s20, s50, 8192
s_and_b32 s20, s20, 0x7fff
s_add_u32 s20, s20, s41
buffer_load_dwordx4 v[184:187], v2, s[84:87], s20 offen sc1
buffer_load_dwordx4 v[188:191], v2, s[84:87], s20 offen offset:1024 sc1
s_waitcnt vmcnt(9)
v_mfma_f32_32x32x16_bf16 v[200:215], a[0:3], v[152:155], 0
v_mfma_f32_32x32x16_bf16 v[216:231], a[4:7], v[152:155], 0
buffer_load_dwordx4 v[192:195], v2, s[84:87], s20 offen offset:2048 sc1
s_waitcnt vmcnt(9)
v_mfma_f32_32x32x16_bf16 v[200:215], a[8:11], v[156:159], v[200:215]
v_mfma_f32_32x32x16_bf16 v[216:231], a[12:15], v[156:159], v[216:231]
buffer_load_dwordx4 v[196:199], v2, s[84:87], s20 offen offset:3072 sc1
s_waitcnt vmcnt(9)
v_mfma_f32_32x32x16_bf16 v[200:215], a[16:19], v[160:163], v[200:215]
v_mfma_f32_32x32x16_bf16 v[216:231], a[20:23], v[160:163], v[216:231]
s_add_u32 s20, s50, 12288
s_and_b32 s20, s20, 0x7fff
s_add_u32 s20, s20, s41
buffer_load_dwordx4 v[152:155], v2, s[84:87], s20 offen sc1
s_waitcnt vmcnt(9)
v_mfma_f32_32x32x16_bf16 v[200:215], a[24:27], v[164:167], v[200:215]
v_mfma_f32_32x32x16_bf16 v[216:231], a[28:31], v[164:167], v[216:231]
buffer_load_dwordx4 v[156:159], v2, s[84:87], s20 offen offset:1024 sc1
s_waitcnt vmcnt(9)
v_mfma_f32_32x32x16_bf16 v[200:215], a[32:35], v[168:171], v[200:215]
v_mfma_f32_32x32x16_bf16 v[216:231], a[36:39], v[168:171], v[216:231]
buffer_load_dwordx4 v[160:163], v2, s[84:87], s20 offen offset:2048 sc1
s_waitcnt vmcnt(9)
v_mfma_f32_32x32x16_bf16 v[200:215], a[40:43], v[172:175], v[200:215]
v_mfma_f32_32x32x16_bf16 v[216:231], a[44:47], v[172:175], v[216:231]
buffer_load_dwordx4 v[164:167], v2, s[84:87], s20 offen offset:3072 sc1
s_waitcnt vmcnt(9)
v_mfma_f32_32x32x16_bf16 v[200:215], a[48:51], v[176:179], v[200:215]
v_mfma_f32_32x32x16_bf16 v[216:231], a[52:55], v[176:179], v[216:231]
s_add_u32 s20, s50, 16384
s_and_b32 s20, s20, 0x7fff
s_add_u32 s20, s20, s41
buffer_load_dwordx4 v[168:171], v2, s[84:87], s20 offen sc1
s_waitcnt vmcnt(9)
v_mfma_f32_32x32x16_bf16 v[200:215], a[56:59], v[180:183], v[200:215]
v_mfma_f32_32x32x16_bf16 v[216:231], a[60:63], v[180:183], v[216:231]
buffer_load_dwordx4 v[172:175], v2, s[84:87], s20 offen offset:1024 sc1
s_waitcnt vmcnt(9)
v_mfma_f32_32x32x16_bf16 v[200:215], a[64:67], v[184:187], v[200:215]
v_mfma_f32_32x32x16_bf16 v[216:231], a[68:71], v[184:187], v[216:231]
buffer_load_dwordx4 v[176:179], v2, s[84:87], s20 offen offset:2048 sc1
s_waitcnt vmcnt(9)
v_mfma_f32_32x32x16_bf16 v[200:215], a[72:75], v[188:191], v[200:215]
v_mfma_f32_32x32x16_bf16 v[216:231], a[76:79], v[188:191], v[216:231]
buffer_load_dwordx4 v[180:183], v2, s[84:87], s20 offen offset:3072 sc1
s_waitcnt vmcnt(9)
v_mfma_f32_32x32x16_bf16 v[200:215], a[80:83], v[192:195], v[200:215]
v_mfma_f32_32x32x16_bf16 v[216:231], a[84:87], v[192:195], v[216:231]
s_add_u32 s20, s50, 20480
s_and_b32 s20, s20, 0x7fff
s_add_u32 s20, s20, s41
buffer_load_dwordx4 v[184:187], v2, s[84:87], s20 offen sc1
s_waitcnt vmcnt(9)
v_mfma_f32_32x32x16_bf16 v[200:215], a[88:91], v[196:199], v[200:215]
v_mfma_f32_32x32x16_bf16 v[216:231], a[92:95], v[196:199], v[216:231]
buffer_load_dwordx4 v[188:191], v2, s[84:87], s20 offen offset:1024 sc1
s_waitcnt vmcnt(9)
v_mfma_f32_32x32x16_bf16 v[200:215], a[96:99], v[152:155], v[200:215]
v_mfma_f32_32x32x16_bf16 v[216:231], a[100:103], v[152:155], v[216:231]
buffer_load_dwordx4 v[192:195], v2, s[84:87], s20 offen offset:2048 sc1
s_waitcnt vmcnt(9)
v_mfma_f32_32x32x16_bf16 v[200:215], a[104:107], v[156:159], v[200:215]
v_mfma_f32_32x32x16_bf16 v[216:231], a[108:111], v[156:159], v[216:231]
buffer_load_dwordx4 v[196:199], v2, s[84:87], s20 offen offset:3072 sc1
s_waitcnt vmcnt(9)
v_mfma_f32_32x32x16_bf16 v[200:215], a[112:115], v[160:163], v[200:215]
v_mfma_f32_32x32x16_bf16 v[216:231], a[116:119], v[160:163], v[216:231]
s_add_u32 s20, s50, 24576
s_and_b32 s20, s20, 0x7fff
s_add_u32 s20, s20, s41
buffer_load_dwordx4 v[152:155], v2, s[84:87], s20 offen sc1
s_waitcnt vmcnt(9)
v_mfma_f32_32x32x16_bf16 v[200:215], a[120:123], v[164:167], v[200:215]
v_mfma_f32_32x32x16_bf16 v[216:231], a[124:127], v[164:167], v[216:231]
buffer_load_dwordx4 v[156:159], v2, s[84:87], s20 offen offset:1024 sc1
s_waitcnt vmcnt(9)
v_mfma_f32_32x32x16_bf16 v[200:215], a[128:131], v[168:171], v[200:215]
v_mfma_f32_32x32x16_bf16 v[216:231], a[132:135], v[168:171], v[216:231]
buffer_load_dwordx4 v[160:163], v2, s[84:87], s20 offen offset:2048 sc1
s_waitcnt vmcnt(9)
v_mfma_f32_32x32x16_bf16 v[200:215], a[136:139], v[172:175], v[200:215]
v_mfma_f32_32x32x16_bf16 v[216:231], a[140:143], v[172:175], v[216:231]
buffer_load_dwordx4 v[164:167], v2, s[84:87], s20 offen offset:3072 sc1
s_waitcnt vmcnt(9)
v_mfma_f32_32x32x16_bf16 v[200:215], a[144:147], v[176:179], v[200:215]
v_mfma_f32_32x32x16_bf16 v[216:231], a[148:151], v[176:179], v[216:231]
s_add_u32 s20, s50, 28672
s_and_b32 s20, s20, 0x7fff
s_add_u32 s20, s20, s41
buffer_load_dwordx4 v[168:171], v2, s[84:87], s20 offen sc1
s_waitcnt vmcnt(9)
v_mfma_f32_32x32x16_bf16 v[200:215], a[152:155], v[180:183], v[200:215]
v_mfma_f32_32x32x16_bf16 v[216:231], a[156:159], v[180:183], v[216:231]
buffer_load_dwordx4 v[172:175], v2, s[84:87], s20 offen offset:1024 sc1
s_waitcnt vmcnt(9)
v_mfma_f32_32x32x16_bf16 v[200:215], a[160:163], v[184:187], v[200:215]
v_mfma_f32_32x32x16_bf16 v[216:231], a[164:167], v[184:187], v[216:231]
buffer_load_dwordx4 v[176:179], v2, s[84:87], s20 offen offset:2048 sc1
s_waitcnt vmcnt(9)
v_mfma_f32_32x32x16_bf16 v[200:215], a[168:171], v[188:191], v[200:215]
v_mfma_f32_32x32x16_bf16 v[216:231], a[172:175], v[188:191], v[216:231]
buffer_load_dwordx4 v[180:183], v2, s[84:87], s20 offen offset:3072 sc1
s_waitcnt vmcnt(9)
v_mfma_f32_32x32x16_bf16 v[200:215], a[176:179], v[192:195], v[200:215]
v_mfma_f32_32x32x16_bf16 v[216:231], a[180:183], v[192:195], v[216:231]
s_waitcnt vmcnt(8)
v_mfma_f32_32x32x16_bf16 v[200:215], a[184:187], v[196:199], v[200:215]
v_mfma_f32_32x32x16_bf16 v[216:231], a[188:191], v[196:199], v[216:231]
s_waitcnt vmcnt(7)
v_mfma_f32_32x32x16_bf16 v[200:215], a[192:195], v[152:155], v[200:215]
v_mfma_f32_32x32x16_bf16 v[216:231], a[196:199], v[152:155], v[216:231]
s_waitcnt vmcnt(6)
v_mfma_f32_32x32x16_bf16 v[200:215], a[200:203], v[156:159], v[200:215]
v_mfma_f32_32x32x16_bf16 v[216:231], a[204:207], v[156:159], v[216:231]
s_waitcnt vmcnt(5)
v_mfma_f32_32x32x16_bf16 v[200:215], a[208:211], v[160:163], v[200:215]
v_mfma_f32_32x32x16_bf16 v[216:231], a[212:215], v[160:163], v[216:231]
s_waitcnt vmcnt(4)
v_mfma_f32_32x32x16_bf16 v[200:215], a[216:219], v[164:167], v[200:215]
v_mfma_f32_32x32x16_bf16 v[216:231], a[220:223], v[164:167], v[216:231]
s_waitcnt vmcnt(3)
v_mfma_f32_32x32x16_bf16 v[200:215], a[224:227], v[168:171], v[200:215]
v_mfma_f32_32x32x16_bf16 v[216:231], a[228:231], v[168:171], v[216:231]
s_waitcnt vmcnt(2)
v_mfma_f32_32x32x16_bf16 v[200:215], a[232:235], v[172:175], v[200:215]
v_mfma_f32_32x32x16_bf16 v[216:231], a[236:239], v[172:175], v[216:231]
s_waitcnt vmcnt(1)
v_mfma_f32_32x32x16_bf16 v[200:215], a[240:243], v[176:179], v[200:215]
v_mfma_f32_32x32x16_bf16 v[216:231], a[244:247], v[176:179], v[216:231]
s_waitcnt vmcnt(0)
v_mfma_f32_32x32x16_bf16 v[200:215], a[248:251], v[180:183], v[200:215]
v_mfma_f32_32x32x16_bf16 v[216:231], a[252:255], v[180:183], v[216:231]
s_nop 11
ds_write_b128 v17, v[200:203]
ds_write_b128 v17, v[204:207] offset:1088
ds_write_b128 v17, v[208:211] offset:2176
ds_write_b128 v17, v[212:215] offset:3264
ds_write_b128 v17, v[216:219] offset:4352
ds_write_b128 v17, v[220:223] offset:5440
ds_write_b128 v17, v[224:227] offset:6528
ds_write_b128 v17, v[228:231] offset:7616
s_sub_u32 s20, s22, 56
s_cmp_lt_u32 s20, 8
s_cselect_b32 s20, s51, 0
s_cmp_eq_u32 s20, 1
s_cbranch_scc0 L_x_sp_16
s_mov_b32 s46, 2
s_lshl_b32 s27, s22, 18
s_lshl_b32 s20, s18, 13
s_add_u32 s27, s27, s20
s_add_u32 s29, s27, 178257920
s_and_b32 s20, s16, 1
s_lshl_b32 s20, s20, 10
s_add_u32 s26, s27, s20
s_add_u32 s26, s26, 0
s_lshr_b32 s20, s16, 1
s_lshl_b32 s20, s20, 12
s_add_u32 s28, s27, s20
s_add_u32 s28, s28, 33554432
s_add_u32 s27, s27, 16777216
s_add_u32 s48, s26, 4096
s_add_u32 s49, s27, 4096
buffer_load_dwordx4 v[24:27], v2, s[84:87], s26 offen sc1
buffer_load_dwordx4 v[28:31], v2, s[84:87], s26 offen offset:2048 sc1
buffer_load_dwordx4 v[32:35], v2, s[84:87], s48 offen sc1
buffer_load_dwordx4 v[36:39], v2, s[84:87], s48 offen offset:2048 sc1
buffer_load_dwordx4 v[56:59], v2, s[84:87], s27 offen sc1
buffer_load_dwordx4 v[60:63], v2, s[84:87], s27 offen offset:1024 sc1
buffer_load_dwordx4 v[64:67], v2, s[84:87], s27 offen offset:2048 sc1
buffer_load_dwordx4 v[68:71], v2, s[84:87], s27 offen offset:3072 sc1
buffer_load_dwordx4 v[72:75], v2, s[84:87], s49 offen sc1
buffer_load_dwordx4 v[76:79], v2, s[84:87], s49 offen offset:1024 sc1
buffer_load_dwordx4 v[80:83], v2, s[84:87], s49 offen offset:2048 sc1
buffer_load_dwordx4 v[84:87], v2, s[84:87], s49 offen offset:3072 sc1
buffer_load_dwordx4 v[88:91], v2, s[84:87], s28 offen sc1
buffer_load_dwordx4 v[92:95], v2, s[84:87], s28 offen offset:1024 sc1
buffer_load_dwordx4 v[96:99], v2, s[84:87], s28 offen offset:2048 sc1
buffer_load_dwordx4 v[100:103], v2, s[84:87], s28 offen offset:3072 sc1
L_x_sp_16:
v_mov_b32 v3, v252
v_mov_b32 v4, s45
s_waitcnt lgkmcnt(0)
v_mov_b32 v5, v16
s_barrier
ds_read_b128 v[152:155], v3
ds_read_b128 v[156:159], v3 offset:8704
ds_read_b128 v[160:163], v3 offset:17408
ds_read_b128 v[164:167], v3 offset:26112
s_waitcnt lgkmcnt(0)
v_pk_add_f32 v[152:153], v[152:153], v[156:157]
v_pk_add_f32 v[154:155], v[154:155], v[158:159]
v_pk_add_f32 v[160:161], v[160:161], v[164:165]
v_pk_add_f32 v[162:163], v[162:163], v[166:167]
v_pk_add_f32 v[152:153], v[152:153], v[160:161]
v_pk_add_f32 v[154:155], v[154:155], v[162:163]
s_add_u32 s48, s9, 0
s_cmp_eq_u32 s96, 1
s_cbranch_scc1 L_x_st_17f
buffer_store_dwordx4 v[152:155], v19, s[84:87], s48 offen sc1
s_branch L_x_st_17d
L_x_st_17f:
buffer_store_dwordx4 v[152:155], v19, s[84:87], s48 offen
L_x_st_17d:
ds_read_b128 v[216:219], v5
ds_read_b128 v[220:223], v5 offset:8704
ds_read_b128 v[224:227], v5 offset:17408
ds_read_b128 v[228:231], v5 offset:26112
s_waitcnt lgkmcnt(0)
v_pk_add_f32 v[216:217], v[216:217], v[220:221]
v_pk_add_f32 v[218:219], v[218:219], v[222:223]
v_pk_add_f32 v[224:225], v[224:225], v[228:229]
v_pk_add_f32 v[226:227], v[226:227], v[230:231]
v_pk_add_f32 v[232:233], v[216:217], v[224:225]
v_pk_add_f32 v[234:235], v[218:219], v[226:227]
s_waitcnt vmcnt(0)
s_barrier
s_cmp_eq_u32 s96, 1
s_cbranch_scc1 L_x_st_18f
buffer_store_dword v4, v15, s[84:87], 0 offen offset:64 sc1
s_branch L_x_st_18d
L_x_st_18f:
buffer_store_dword v4, v15, s[84:87], 0 offen offset:64
L_x_st_18d:
L_x_pfb:
buffer_load_dword v3, v251, s[84:87], 0 offen offset:64 sc1
s_waitcnt vmcnt(0)
v_cmp_gt_u32 vcc, s45, v3
s_cbranch_vccnz L_x_pfb
buffer_load_dwordx4 v[216:219], v19, s[84:87], s10 offen sc1
s_waitcnt vmcnt(0)
v_pk_add_f32 v[216:217], v[216:217], v[232:233]
v_pk_add_f32 v[218:219], v[218:219], v[234:235]
v_cvt_pk_bf16_f32 v216, v216, v217
v_cvt_pk_bf16_f32 v217, v218, v219
buffer_store_dwordx2 v[216:217], v18, s[12:15], s42 offen
s_add_u32 s42, s42, 131072
L_x_f2:
s_cmp_eq_u32 s46, 1
s_cbranch_scc1 L_x_batt
s_cmp_eq_u32 s46, 2
s_cbranch_scc1 L_x_satt
s_cmp_lt_u32 s22, 64
s_cbranch_scc1 L_x_job
s_branch L_x_fin
L_x_dx:
buffer_load_dword v3, off, s[88:91], 0 offset:204 sc1
v_and_b32 v4, 15, v1
v_lshrrev_b32 v5, 4, v1
v_and_b32 v160, 1, v4
v_lshlrev_b32 v160, 4, v160
v_mov_b32 v161, 0x3f80
v_lshlrev_b32 v161, v160, v161
v_lshrrev_b32 v4, 2, v4
v_cmp_eq_u32 vcc, v4, v5
v_mov_b32 v160, 0
s_waitcnt vmcnt(0)
v_cndmask_b32 v161, 0, v161, vcc
v_readfirstlane_b32 s20, v3
s_and_b32 s21, s22, 1
s_lshl_b32 s21, s21, 20
s_lshl_b32 s26, s18, 14
s_add_u32 s26, s26, s21
s_add_u32 s26, s26, 67108864
s_lshr_b32 s20, s20, 15
s_cmp_gt_u32 s20, s100
s_cselect_b32 s20, 8192, 0
s_add_u32 s26, s26, s20
s_bfe_u32 s20, s18, 0x10001
s_lshl_b32 s20, s20, 12
s_add_u32 s26, s26, s20
s_add_u32 s48, s26, 524288
s_lshr_b32 s20, s16, 1
s_lshl_b32 s20, s20, 11
s_xor_b32 s27, s26, 4096
s_add_u32 s27, s27, s20
s_add_u32 s49, s27, 524288
s_lshl_b32 s20, s16, 10
s_add_u32 s26, s26, s20
s_add_u32 s48, s48, s20
v_add_u32 v162, s20, v2
L_x_dr:
buffer_load_dword v3, v13, s[84:87], 0 offen sc1
s_waitcnt vmcnt(0)
v_cmp_gt_u32 vcc, s22, v3
s_cbranch_vccz L_x_dp
s_sleep 2
s_branch L_x_dr
L_x_dp:
buffer_load_dwordx2 v[152:153], v7, s[84:87], s26 offen sc1
buffer_load_dwordx2 v[154:155], v7, s[84:87], s26 offen offset:512 sc1
buffer_load_dwordx2 v[156:157], v7, s[84:87], s48 offen sc1
buffer_load_dwordx2 v[158:159], v7, s[84:87], s48 offen offset:512 sc1
s_waitcnt vmcnt(0)
v_mfma_f32_16x16x16_bf16 v[164:167], v[152:153], v[160:161], 0
v_mfma_f32_16x16x16_bf16 v[168:171], v[154:155], v[160:161], 0
v_mfma_f32_16x16x16_bf16 v[164:167], v[156:157], v[160:161], v[164:167]
v_mfma_f32_16x16x16_bf16 v[168:171], v[158:159], v[160:161], v[168:171]
v_or3_b32 v3, v152, v154, v156
v_or_b32 v3, v3, v158
v_and_b32 v3, 1, v3
v_cmp_ne_u32 vcc, 0, v3
s_nop 3
s_cbranch_vccnz L_x_dp
v_cvt_pk_bf16_f32 v152, v164, v165
v_cvt_pk_bf16_f32 v153, v166, v167
v_cvt_pk_bf16_f32 v154, v168, v169
v_cvt_pk_bf16_f32 v155, v170, v171
ds_write_b128 v162, v[152:155] offset:40960
s_waitcnt lgkmcnt(0)
s_barrier
ds_read_b128 v[120:123], v2 offset:40960
ds_read_b128 v[124:127], v2 offset:41984
ds_read_b128 v[128:131], v2 offset:43008
ds_read_b128 v[132:135], v2 offset:44032
L_x_dv:
buffer_load_dwordx2 v[136:137], v7, s[84:87], s27 offen sc1
buffer_load_dwordx2 v[138:139], v7, s[84:87], s49 offen sc1
buffer_load_dwordx2 v[140:141], v7, s[84:87], s27 offen offset:1024 sc1
buffer_load_dwordx2 v[142:143], v7, s[84:87], s49 offen offset:1024 sc1
s_waitcnt vmcnt(0) lgkmcnt(0)
v_or3_b32 v3, v136, v138, v140
v_or_b32 v3, v3, v142
v_and_b32 v3, 1, v3
v_cmp_ne_u32 vcc, 0, v3
s_cbranch_vccnz L_x_dv
s_branch L_x_rd
L_x_fin:
s_endpgm
.section .rodata,"a"
.p2align 6
.amdhsa_kernel mega_kernel
  .amdhsa_next_free_vgpr 512
  .amdhsa_next_free_sgpr 102
  .amdhsa_accum_offset 256
  .amdhsa_group_segment_fixed_size 0
  .amdhsa_kernarg_size 104
  .amdhsa_user_sgpr_count 2
  .amdhsa_user_sgpr_kernarg_segment_ptr 1
  .amdhsa_system_sgpr_workgroup_id_x 1
.end_amdhsa_kernel
```
